```python
import torch

def _softmax(x, axis=-1):
    return torch.softmax(x, dim=axis)

def _gelu(x):
    return torch.nn.functional.gelu(x, approximate='tanh')

def _silu(x):
    return torch.nn.functional.silu(x)

def _sigmoid(x):
    return torch.sigmoid(x)

def _layernorm(x, axis=-1, eps=1e-05):
    m = x.mean(dim=axis, keepdim=True)
    v = x.var(dim=axis, keepdim=True, unbiased=False)
    return (x - m) / torch.sqrt(v + eps)

def _scatter_add(tgt, idx, src, axis=0):
    return tgt.clone().index_add_(axis, idx, src)

def _segment_sum(src, seg, n):
    out = torch.zeros((n,) + src.shape[1:], dtype=src.dtype)
    return out.index_add_(0, seg, src)

def _pad(x, pw):
    flat = tuple((v for pair in reversed(pw) for v in pair))
    return torch.nn.functional.pad(x, flat)
kernel_name = 'standalone__tensor_product_equiv_equiformer__graph'

def setup_inputs():

    _w = lambda a: (lambda t: t.to(torch.bfloat16) if t.is_floating_point() else t)(torch.as_tensor(a))
    N, deg, C, De = (10000, 32, 128, max(16, 1))
    E = N * deg
    src = (lambda lo, hi, *s: torch.randint(lo, hi, s))(0, N, E).to(torch.int64)
    dst = (lambda lo, hi, *s: torch.randint(lo, hi, s))(0, N, E).to(torch.int64)
    rvec = (lambda *s: torch.randn(*s, dtype=torch.bfloat16) * 0.05)(E, 3).to(float)
    rn = (torch.linalg.norm(rvec, dim=-1, keepdim=True) + 1e-06).to(float)
    rhat = (rvec / rn).to(float)
    eps = torch.zeros((3, 3, 3), dtype=float)
    eps[0, 1, 2] = eps[1, 2, 0] = eps[2, 0, 1] = 1.0
    eps[0, 2, 1] = eps[2, 1, 0] = eps[1, 0, 2] = -1.0
    return {'x': _w((lambda *s: torch.randn(*s, dtype=torch.bfloat16) * 0.2)(N, 4 * C).to(float)), 'rhat': _w(rhat), 'e_attr': _w((lambda *s: torch.randn(*s, dtype=torch.bfloat16) * 0.2)(E, De).to(float)), 'src': _w(src), 'dst': _w(dst), 'w_rad': _w((lambda *s: torch.randn(*s, dtype=torch.bfloat16) * 0.2)(De, 5 * C).to(float)), 'w_si0': _w((lambda *s: torch.randn(*s, dtype=torch.bfloat16) * 0.2)(2 * C, C).to(float)), 'w_si1': _w((lambda *s: torch.randn(*s, dtype=torch.bfloat16) * 0.05)(3 * C, C).to(float)), 'cg_eps': _w(eps)}

def reference(x, rhat, e_attr, src, dst, w_rad, w_si0, w_si1, cg_eps):
    N = x.shape[0]
    C = w_si0.shape[1]
    E = rhat.shape[0]
    x0 = x[:, :C].clone()
    x1 = x[:, C:].reshape(N, 3, C)
    R = (e_attr @ w_rad).reshape(E, 5, C)
    f0 = x0[src]
    f1 = x1[src]
    Y1 = rhat
    p00_0 = f0 * R[:, 0, :]
    p11_0 = torch.einsum('ejc,ej->ec', f1, Y1) * R[:, 1, :]
    p01_1 = torch.einsum('ec,ej->ejc', f0, Y1) * R[:, 2, :][:, None, :]
    p10_1 = f1 * R[:, 3, :][:, None, :]
    p11_1 = torch.einsum('ijk,ekc,ej->eic', cg_eps, f1, Y1) * R[:, 4, :][:, None, :]
    m0 = torch.concatenate([p00_0, p11_0], axis=-1) @ w_si0
    m1 = torch.einsum('ejp,pc->ejc', torch.concatenate([p01_1, p10_1, p11_1], axis=-1), w_si1)
    agg0 = _segment_sum(m0, dst, N)
    agg1 = _segment_sum(m1.reshape(E, 3 * C), dst, N).reshape(N, 3, C)
    gate = _sigmoid(agg0)
    out1 = agg1 * gate[:, None, :]
    return torch.concatenate([agg0, out1.reshape(N, 3 * C)], axis=-1)
```

```asm
; @launch kernel=tp_prep_kernel grid=(145,1,1) block=(640,1,1) lds=97280
; @launch kernel=standalone__tensor_product_equiv_equiformer__graph_kernel grid=(250,1,1) block=(512,1,1) lds=163840
.amdgcn_target "amdgcn-amd-amdhsa--gfx950"
.text
.globl tp_prep_kernel
.p2align 8
.type tp_prep_kernel,@function
tp_prep_kernel:
    s_cmp_ge_u32 s2, 145
    s_cbranch_scc1 K1_end
    s_load_dwordx2 s[4:5], s[0:1], 8
    s_load_dwordx4 s[8:11], s[0:1], 24
    s_load_dwordx4 s[12:15], s[0:1], 40
    s_load_dwordx2 s[16:17], s[0:1], 56
    s_load_dwordx2 s[18:19], s[0:1], 88
    s_cmp_ge_u32 s2, 125
    s_cbranch_scc1 K1_wprep
    v_and_b32 v1, 255, v0
    v_lshlrev_b32 v1, 2, v1
    v_mov_b32 v2, 0
    v_add_u32 v1, 96000, v1
    ds_write_b32 v1, v2
    v_lshlrev_b32 v3, 4, v0
    v_mul_u32_u24 v4, 24, v0
    s_mul_i32 s3, s2, 10240
    s_mul_i32 s20, s2, 15360
    s_mul_i32 s21, s2, 2560
    s_waitcnt lgkmcnt(0)
    s_mov_b32 s24, s10
    s_and_b32 s25, s11, 0xffff
    s_mov_b32 s26, 1280000
    s_mov_b32 s27, 0x20000
    s_mov_b32 s28, s8
    s_and_b32 s29, s9, 0xffff
    s_mov_b32 s30, 1280000
    s_mov_b32 s31, 0x20000
    s_mov_b32 s32, s4
    s_and_b32 s33, s5, 0xffff
    s_mov_b32 s34, 1920000
    s_mov_b32 s35, 0x20000
    s_mov_b32 s36, s18
    s_and_b32 s37, s19, 0xffff
    s_mov_b32 s38, 12492800
    s_mov_b32 s39, 0x20000
    buffer_load_dwordx4 v[8:11], v3, s[24:27], s3 offen
    buffer_load_dwordx4 v[12:15], v3, s[28:31], s3 offen
    buffer_load_dwordx4 v[16:19], v4, s[32:35], s20 offen
    buffer_load_dwordx2 v[20:21], v4, s[32:35], s20 offen offset:16
    v_lshl_add_u32 v5, v0, 2, s21
    v_mov_b32 v6, 1
    s_mov_b32 s22, 52429
    s_mov_b32 s23, 0x05040100
    s_barrier
    s_waitcnt vmcnt(3)
    v_mul_u32_u24 v22, s22, v8
    v_mul_u32_u24 v23, s22, v9
    v_mul_u32_u24 v24, s22, v10
    v_mul_u32_u24 v25, s22, v11
    v_lshrrev_b32 v22, 21, v22
    v_lshrrev_b32 v23, 21, v23
    v_lshrrev_b32 v24, 21, v24
    v_lshrrev_b32 v25, 21, v25
    v_min_u32 v22, 249, v22
    v_min_u32 v23, 249, v23
    v_min_u32 v24, 249, v24
    v_min_u32 v25, 249, v25
    v_lshlrev_b32 v34, 2, v22
    v_lshlrev_b32 v35, 2, v23
    v_lshlrev_b32 v36, 2, v24
    v_lshlrev_b32 v37, 2, v25
    v_add_u32 v34, 96000, v34
    ds_add_rtn_u32 v26, v34, v6
    v_add_u32 v35, 96000, v35
    ds_add_rtn_u32 v27, v35, v6
    v_add_u32 v36, 96000, v36
    ds_add_rtn_u32 v28, v36, v6
    v_add_u32 v37, 96000, v37
    ds_add_rtn_u32 v29, v37, v6
    v_mul_u32_u24 v30, 40, v22
    v_sub_u32 v30, v8, v30
    v_and_b32 v30, 63, v30
    v_add_u32 v7, 0, v5
    v_lshl_or_b32 v30, v30, 19, v7
    v_mul_u32_u24 v22, 384, v22
    v_mul_u32_u24 v31, 40, v23
    v_sub_u32 v31, v9, v31
    v_and_b32 v31, 63, v31
    v_add_u32 v7, 1, v5
    v_lshl_or_b32 v31, v31, 19, v7
    v_mul_u32_u24 v23, 384, v23
    v_mul_u32_u24 v32, 40, v24
    v_sub_u32 v32, v10, v32
    v_and_b32 v32, 63, v32
    v_add_u32 v7, 2, v5
    v_lshl_or_b32 v32, v32, 19, v7
    v_mul_u32_u24 v24, 384, v24
    v_mul_u32_u24 v33, 40, v25
    v_sub_u32 v33, v11, v33
    v_and_b32 v33, 63, v33
    v_add_u32 v7, 3, v5
    v_lshl_or_b32 v33, v33, 19, v7
    v_mul_u32_u24 v25, 384, v25
    s_waitcnt vmcnt(0)
    v_mov_b32 v40, v16
    v_perm_b32 v41, v12, v17, s23
    v_alignbit_b32 v42, v18, v17, 16
    v_alignbit_b32 v43, v13, v18, 16
    v_mov_b32 v44, v19
    v_perm_b32 v45, v14, v20, s23
    v_alignbit_b32 v46, v21, v20, 16
    v_alignbit_b32 v47, v15, v21, 16
    v_mov_b32 v48, 97024
    s_waitcnt lgkmcnt(0)
    v_cmp_gt_u32 vcc, 32, v26
    v_lshl_add_u32 v34, v26, 2, v22
    v_lshl_add_u32 v8, v26, 3, v22
    v_cndmask_b32 v34, v48, v34, vcc
    v_cndmask_b32 v8, v48, v8, vcc
    ds_write_b32 v34, v30
    ds_write_b64 v8, v[40:41] offset:128
    v_cmp_gt_u32 vcc, 32, v27
    v_lshl_add_u32 v35, v27, 2, v23
    v_lshl_add_u32 v9, v27, 3, v23
    v_cndmask_b32 v35, v48, v35, vcc
    v_cndmask_b32 v9, v48, v9, vcc
    ds_write_b32 v35, v31
    ds_write_b64 v9, v[42:43] offset:128
    v_cmp_gt_u32 vcc, 32, v28
    v_lshl_add_u32 v36, v28, 2, v24
    v_lshl_add_u32 v10, v28, 3, v24
    v_cndmask_b32 v36, v48, v36, vcc
    v_cndmask_b32 v10, v48, v10, vcc
    ds_write_b32 v36, v32
    ds_write_b64 v10, v[44:45] offset:128
    v_cmp_gt_u32 vcc, 32, v29
    v_lshl_add_u32 v37, v29, 2, v25
    v_lshl_add_u32 v11, v29, 3, v25
    v_cndmask_b32 v37, v48, v37, vcc
    v_cndmask_b32 v11, v48, v11, vcc
    ds_write_b32 v37, v33
    ds_write_b64 v11, v[46:47] offset:128
    v_lshrrev_b32 v1, 4, v0
    v_and_b32 v2, 15, v0
    v_mul_u32_u24 v3, 384, v1
    v_lshl_add_u32 v3, v2, 4, v3
    v_lshlrev_b32 v4, 2, v1
    v_add_u32 v4, 96000, v4
    s_mov_b32 s22, 49152
    v_mul_lo_u32 v5, s22, v1
    v_lshl_add_u32 v5, v2, 4, v5
    s_mul_i32 s3, s2, 384
    v_lshlrev_b32 v6, 2, v2
    v_subrev_u32 v7, 8, v2
    v_lshlrev_b32 v7, 1, v7
    v_cmp_gt_u32 vcc, 8, v2
    s_nop 1
    v_cndmask_b32 v6, v7, v6, vcc
    v_cmp_eq_u32 s[40:41], 0, v2
    v_lshl_add_u32 v7, v2, 1, 16
    s_waitcnt lgkmcnt(0)
    s_barrier
    ds_read_b128 v[52:55], v3 offset:0
    ds_read_b32 v8, v4 offset:0
    ds_read_b128 v[56:59], v3 offset:15360
    ds_read_b32 v9, v4 offset:160
    ds_read_b128 v[60:63], v3 offset:30720
    ds_read_b32 v10, v4 offset:320
    ds_read_b128 v[64:67], v3 offset:46080
    ds_read_b32 v11, v4 offset:480
    ds_read_b128 v[68:71], v3 offset:61440
    ds_read_b32 v12, v4 offset:640
    v_add_u32 v49, 76800, v3
    ds_read_b128 v[72:75], v49 offset:0
    ds_read_b32 v13, v4 offset:800
    ds_read_b128 v[76:79], v49 offset:15360
    ds_read_b32 v14, v4 offset:960
    s_waitcnt lgkmcnt(12)
    v_min_u32 v20, 127, v8
    v_and_b32 v21, 0x1ffffff, v52
    v_lshl_or_b32 v21, v20, 25, v21
    v_cndmask_b32 v52, v52, v21, s[40:41]
    v_cmp_lt_u32 vcc, v6, v8
    s_or_b64 vcc, vcc, s[40:41]
    s_and_saveexec_b64 s[44:45], vcc
    s_cbranch_execz K1_skip0
    buffer_store_dwordx4 v[52:55], v5, s[36:39], s3 offen
K1_skip0:
    s_mov_b64 exec, s[44:45]
    v_cmp_lt_u32 vcc, v7, v8
    v_cmp_gt_u32 s[42:43], 8, v2
    s_and_b64 vcc, vcc, s[42:43]
    s_and_saveexec_b64 s[44:45], vcc
    s_cbranch_execz K1_skipb0
    v_add_u32 v20, 256, v3
    ds_read_b128 v[24:27], v20
    s_waitcnt lgkmcnt(0)
    buffer_store_dwordx4 v[24:27], v5, s[36:39], s3 offen offset:256
    s_nop 1
K1_skipb0:
    s_mov_b64 exec, s[44:45]
    s_add_u32 s3, s3, 1966080
    s_waitcnt lgkmcnt(10)
    v_min_u32 v20, 127, v9
    v_and_b32 v21, 0x1ffffff, v56
    v_lshl_or_b32 v21, v20, 25, v21
    v_cndmask_b32 v56, v56, v21, s[40:41]
    v_cmp_lt_u32 vcc, v6, v9
    s_or_b64 vcc, vcc, s[40:41]
    s_and_saveexec_b64 s[44:45], vcc
    s_cbranch_execz K1_skip1
    buffer_store_dwordx4 v[56:59], v5, s[36:39], s3 offen
K1_skip1:
    s_mov_b64 exec, s[44:45]
    v_cmp_lt_u32 vcc, v7, v9
    v_cmp_gt_u32 s[42:43], 8, v2
    s_and_b64 vcc, vcc, s[42:43]
    s_and_saveexec_b64 s[44:45], vcc
    s_cbranch_execz K1_skipb1
    v_add_u32 v20, 15616, v3
    ds_read_b128 v[24:27], v20
    s_waitcnt lgkmcnt(0)
    buffer_store_dwordx4 v[24:27], v5, s[36:39], s3 offen offset:256
    s_nop 1
K1_skipb1:
    s_mov_b64 exec, s[44:45]
    s_add_u32 s3, s3, 1966080
    s_waitcnt lgkmcnt(8)
    v_min_u32 v20, 127, v10
    v_and_b32 v21, 0x1ffffff, v60
    v_lshl_or_b32 v21, v20, 25, v21
    v_cndmask_b32 v60, v60, v21, s[40:41]
    v_cmp_lt_u32 vcc, v6, v10
    s_or_b64 vcc, vcc, s[40:41]
    s_and_saveexec_b64 s[44:45], vcc
    s_cbranch_execz K1_skip2
    buffer_store_dwordx4 v[60:63], v5, s[36:39], s3 offen
K1_skip2:
    s_mov_b64 exec, s[44:45]
    v_cmp_lt_u32 vcc, v7, v10
    v_cmp_gt_u32 s[42:43], 8, v2
    s_and_b64 vcc, vcc, s[42:43]
    s_and_saveexec_b64 s[44:45], vcc
    s_cbranch_execz K1_skipb2
    v_add_u32 v20, 30976, v3
    ds_read_b128 v[24:27], v20
    s_waitcnt lgkmcnt(0)
    buffer_store_dwordx4 v[24:27], v5, s[36:39], s3 offen offset:256
    s_nop 1
K1_skipb2:
    s_mov_b64 exec, s[44:45]
    s_add_u32 s3, s3, 1966080
    s_waitcnt lgkmcnt(6)
    v_min_u32 v20, 127, v11
    v_and_b32 v21, 0x1ffffff, v64
    v_lshl_or_b32 v21, v20, 25, v21
    v_cndmask_b32 v64, v64, v21, s[40:41]
    v_cmp_lt_u32 vcc, v6, v11
    s_or_b64 vcc, vcc, s[40:41]
    s_and_saveexec_b64 s[44:45], vcc
    s_cbranch_execz K1_skip3
    buffer_store_dwordx4 v[64:67], v5, s[36:39], s3 offen
K1_skip3:
    s_mov_b64 exec, s[44:45]
    v_cmp_lt_u32 vcc, v7, v11
    v_cmp_gt_u32 s[42:43], 8, v2
    s_and_b64 vcc, vcc, s[42:43]
    s_and_saveexec_b64 s[44:45], vcc
    s_cbranch_execz K1_skipb3
    v_add_u32 v20, 46336, v3
    ds_read_b128 v[24:27], v20
    s_waitcnt lgkmcnt(0)
    buffer_store_dwordx4 v[24:27], v5, s[36:39], s3 offen offset:256
    s_nop 1
K1_skipb3:
    s_mov_b64 exec, s[44:45]
    s_add_u32 s3, s3, 1966080
    s_waitcnt lgkmcnt(4)
    v_min_u32 v20, 127, v12
    v_and_b32 v21, 0x1ffffff, v68
    v_lshl_or_b32 v21, v20, 25, v21
    v_cndmask_b32 v68, v68, v21, s[40:41]
    v_cmp_lt_u32 vcc, v6, v12
    s_or_b64 vcc, vcc, s[40:41]
    s_and_saveexec_b64 s[44:45], vcc
    s_cbranch_execz K1_skip4
    buffer_store_dwordx4 v[68:71], v5, s[36:39], s3 offen
K1_skip4:
    s_mov_b64 exec, s[44:45]
    v_cmp_lt_u32 vcc, v7, v12
    v_cmp_gt_u32 s[42:43], 8, v2
    s_and_b64 vcc, vcc, s[42:43]
    s_and_saveexec_b64 s[44:45], vcc
    s_cbranch_execz K1_skipb4
    v_add_u32 v20, 61696, v3
    ds_read_b128 v[24:27], v20
    s_waitcnt lgkmcnt(0)
    buffer_store_dwordx4 v[24:27], v5, s[36:39], s3 offen offset:256
    s_nop 1
K1_skipb4:
    s_mov_b64 exec, s[44:45]
    s_add_u32 s3, s3, 1966080
    s_waitcnt lgkmcnt(2)
    v_min_u32 v20, 127, v13
    v_and_b32 v21, 0x1ffffff, v72
    v_lshl_or_b32 v21, v20, 25, v21
    v_cndmask_b32 v72, v72, v21, s[40:41]
    v_cmp_lt_u32 vcc, v6, v13
    s_or_b64 vcc, vcc, s[40:41]
    s_and_saveexec_b64 s[44:45], vcc
    s_cbranch_execz K1_skip5
    buffer_store_dwordx4 v[72:75], v5, s[36:39], s3 offen
K1_skip5:
    s_mov_b64 exec, s[44:45]
    v_cmp_lt_u32 vcc, v7, v13
    v_cmp_gt_u32 s[42:43], 8, v2
    s_and_b64 vcc, vcc, s[42:43]
    s_and_saveexec_b64 s[44:45], vcc
    s_cbranch_execz K1_skipb5
    v_add_u32 v20, 77056, v3
    ds_read_b128 v[24:27], v20
    s_waitcnt lgkmcnt(0)
    buffer_store_dwordx4 v[24:27], v5, s[36:39], s3 offen offset:256
    s_nop 1
K1_skipb5:
    s_mov_b64 exec, s[44:45]
    s_add_u32 s3, s3, 1966080
    s_waitcnt lgkmcnt(0)
    v_min_u32 v20, 127, v14
    v_and_b32 v21, 0x1ffffff, v76
    v_lshl_or_b32 v21, v20, 25, v21
    v_cndmask_b32 v76, v76, v21, s[40:41]
    v_cmp_lt_u32 vcc, v6, v14
    s_or_b64 vcc, vcc, s[40:41]
    v_cmp_gt_u32 s[42:43], 10, v1
    s_and_b64 vcc, vcc, s[42:43]
    s_and_saveexec_b64 s[44:45], vcc
    s_cbranch_execz K1_skip6
    buffer_store_dwordx4 v[76:79], v5, s[36:39], s3 offen
K1_skip6:
    s_mov_b64 exec, s[44:45]
    v_cmp_lt_u32 vcc, v7, v14
    v_cmp_gt_u32 s[42:43], 8, v2
    s_and_b64 vcc, vcc, s[42:43]
    v_cmp_gt_u32 s[42:43], 10, v1
    s_and_b64 vcc, vcc, s[42:43]
    s_and_saveexec_b64 s[44:45], vcc
    s_cbranch_execz K1_skipb6
    v_add_u32 v20, 92416, v3
    ds_read_b128 v[24:27], v20
    s_waitcnt lgkmcnt(0)
    buffer_store_dwordx4 v[24:27], v5, s[36:39], s3 offen offset:256
    s_nop 1
K1_skipb6:
    s_mov_b64 exec, s[44:45]
    s_add_u32 s3, s3, 1966080
    s_endpgm
K1_wprep:
    v_lshrrev_b32 v1, 6, v0
    v_and_b32 v2, 63, v0
    v_readfirstlane_b32 s3, v1
    s_sub_u32 s20, s2, 125
    s_mul_i32 s20, s20, 10
    s_add_u32 s20, s20, s3
    s_waitcnt lgkmcnt(0)
    s_mov_b32 s36, s18
    s_and_b32 s37, s19, 0xffff
    s_mov_b32 s38, 12492800
    s_mov_b32 s39, 0x20000
    s_mov_b32 s24, s14
    s_and_b32 s25, s15, 0xffff
    s_mov_b32 s26, 65536
    s_mov_b32 s27, 0x20000
    s_mov_b32 s28, s12
    s_and_b32 s29, s13, 0xffff
    s_mov_b32 s30, 20480
    s_mov_b32 s31, 0x20000
    v_lshlrev_b32 v3, 4, v2
    s_cmp_ge_u32 s20, 160
    s_cbranch_scc1 K1_wrad
    s_mul_i32 s21, s20, 3277
    s_lshr_b32 s21, s21, 16
    s_mul_i32 s22, s21, 20
    s_sub_u32 s22, s20, s22
    s_cmp_lt_u32 s22, 8
    s_cbranch_scc1 K1_w0
    s_mov_b32 s24, s16
    s_and_b32 s25, s17, 0xffff
    s_mov_b32 s26, 98304
    s_mov_b32 s27, 0x20000
    s_sub_u32 s22, s22, 8
K1_w0:
    s_lshr_b32 s23, s22, 1
    s_lshl_b32 s23, s23, 6
    s_and_b32 s40, s22, 1
    s_lshl_b32 s40, s40, 4
    s_add_u32 s23, s23, s40
    s_lshl_b32 s23, s23, 8
    s_lshl_b32 s40, s21, 5
    s_add_u32 s23, s23, s40
    s_add_u32 s41, s23, 8192
    v_lshrrev_b32 v4, 4, v2
    v_lshlrev_b32 v4, 10, v4
    v_and_b32 v5, 15, v2
    v_lshl_add_u32 v4, v5, 1, v4
    buffer_load_ushort v8, v4, s[24:27], s23 offen offset:0
    buffer_load_ushort v12, v4, s[24:27], s41 offen offset:0
    buffer_load_ushort v9, v4, s[24:27], s23 offen offset:256
    buffer_load_ushort v13, v4, s[24:27], s41 offen offset:256
    buffer_load_ushort v10, v4, s[24:27], s23 offen offset:512
    buffer_load_ushort v14, v4, s[24:27], s41 offen offset:512
    buffer_load_ushort v11, v4, s[24:27], s23 offen offset:768
    buffer_load_ushort v15, v4, s[24:27], s41 offen offset:768
    s_lshl_b32 s40, s20, 10
    s_add_u32 s40, s40, 12288000
    s_waitcnt vmcnt(0)
    v_lshl_or_b32 v8, v12, 16, v8
    v_lshl_or_b32 v9, v13, 16, v9
    v_lshl_or_b32 v10, v14, 16, v10
    v_lshl_or_b32 v11, v15, 16, v11
    buffer_store_dwordx4 v[8:11], v3, s[36:39], s40 offen
    s_endpgm
K1_wrad:
    s_sub_u32 s20, s20, 160
    s_cmp_ge_u32 s20, 20
    s_cselect_b32 s21, 1, 0
    s_mul_i32 s22, s21, 20
    s_sub_u32 s22, s20, s22
    s_lshr_b32 s23, s22, 2
    s_lshl_b32 s23, s23, 8
    s_lshl_b32 s40, s21, 7
    s_add_u32 s23, s23, s40
    s_bfe_u32 s40, s22, 0x10001
    s_lshl_b32 s40, s40, 6
    s_add_u32 s23, s23, s40
    s_and_b32 s40, s22, 1
    s_mul_i32 s40, s40, 8*1280
    s_add_u32 s23, s23, s40
    v_lshrrev_b32 v4, 5, v2
    v_mul_u32_u24 v4, 5120, v4
    v_and_b32 v5, 31, v2
    v_lshl_add_u32 v4, v5, 1, v4
    buffer_load_ushort v8, v4, s[28:31], s23 offen offset:0
    buffer_load_ushort v9, v4, s[28:31], s23 offen offset:1280
    buffer_load_ushort v10, v4, s[28:31], s23 offen offset:2560
    buffer_load_ushort v11, v4, s[28:31], s23 offen offset:3840
    s_lshl_b32 s40, s20, 10
    s_add_u32 s40, s40, 12451840
    s_waitcnt vmcnt(0)
    v_lshlrev_b32 v8, 16, v8
    v_lshlrev_b32 v9, 16, v9
    v_lshlrev_b32 v10, 16, v10
    v_lshlrev_b32 v11, 16, v11
    buffer_store_dwordx4 v[8:11], v3, s[36:39], s40 offen
K1_end:
    s_endpgm
.globl standalone__tensor_product_equiv_equiformer__graph_kernel
.p2align 8
.type standalone__tensor_product_equiv_equiformer__graph_kernel,@function
standalone__tensor_product_equiv_equiformer__graph_kernel:
    s_cmp_ge_u32 s2, 250
    s_cbranch_scc1 K2_end
    s_load_dwordx2 s[20:21], s[0:1], 0
    s_load_dwordx2 s[22:23], s[0:1], 16
    s_load_dwordx2 s[24:25], s[0:1], 72
    s_load_dwordx2 s[26:27], s[0:1], 88
    s_mov_b32 s88, s2
    v_lshrrev_b32 v2, 6, v0
    v_and_b32 v250, 63, v0
    v_readfirstlane_b32 s28, v2
    v_lshrrev_b32 v2, 5, v250
    v_mul_u32_u24 v2, 384, v2
    v_and_b32 v3, 31, v250
    v_lshl_add_u32 v48, v3, 2, v2
    v_lshl_add_u32 v49, v3, 3, v2
    v_lshlrev_b32 v50, 4, v250
    s_mul_i32 s62, s2, 49152
    s_mul_i32 s63, s28, 6144
    s_add_u32 s62, s62, s63
    s_add_u32 s63, s62, 3072
    s_lshl_b32 s29, s28, 13
    s_waitcnt lgkmcnt(0)
    s_mov_b32 s12, s26
    s_and_b32 s13, s27, 0xffff
    s_mov_b32 s14, 12492800
    s_mov_b32 s15, 0x20000
    buffer_load_dword v8, v48, s[12:15], s62 offen offset:0
    buffer_load_dwordx2 v[16:17], v49, s[12:15], s62 offen offset:128
    buffer_load_dword v9, v48, s[12:15], s62 offen offset:768
    buffer_load_dwordx2 v[18:19], v49, s[12:15], s62 offen offset:896
    buffer_load_dword v10, v48, s[12:15], s62 offen offset:1536
    buffer_load_dwordx2 v[20:21], v49, s[12:15], s62 offen offset:1664
    buffer_load_dword v11, v48, s[12:15], s62 offen offset:2304
    buffer_load_dwordx2 v[22:23], v49, s[12:15], s62 offen offset:2432
    buffer_load_dword v12, v48, s[12:15], s63 offen offset:0
    buffer_load_dwordx2 v[24:25], v49, s[12:15], s63 offen offset:128
    buffer_load_dword v13, v48, s[12:15], s63 offen offset:768
    buffer_load_dwordx2 v[26:27], v49, s[12:15], s63 offen offset:896
    buffer_load_dword v14, v48, s[12:15], s63 offen offset:1536
    buffer_load_dwordx2 v[28:29], v49, s[12:15], s63 offen offset:1664
    buffer_load_dword v15, v48, s[12:15], s63 offen offset:2304
    buffer_load_dwordx2 v[30:31], v49, s[12:15], s63 offen offset:2432
    s_mov_b32 s4, s20
    s_and_b32 s5, s21, 0xffff
    s_mov_b32 s6, 10240000
    s_mov_b32 s7, 0x20000
    s_mov_b32 s8, s22
    s_and_b32 s9, s23, 0xffff
    s_mov_b32 s10, 10240000
    s_mov_b32 s11, 0x20000
    s_mov_b32 s16, s24
    s_and_b32 s17, s25, 0xffff
    s_mov_b32 s18, 10240000
    s_mov_b32 s19, 0x20000
    s_mul_i32 s64, s28, 5120
    s_add_u32 s65, s64, 12451840
    s_cmp_ge_u32 s28, 4
    s_cselect_b32 s66, 45056, 0
    s_add_u32 s64, s64, s66
    s_add_u32 m0, s64, 0
    s_add_u32 s66, s65, 0
    buffer_load_dwordx4 v50, s[12:15], s66 offen lds
    s_add_u32 m0, s64, 1024
    s_add_u32 s66, s65, 1024
    buffer_load_dwordx4 v50, s[12:15], s66 offen lds
    s_add_u32 m0, s64, 2048
    s_add_u32 s66, s65, 2048
    buffer_load_dwordx4 v50, s[12:15], s66 offen lds
    s_add_u32 m0, s64, 3072
    s_add_u32 s66, s65, 3072
    buffer_load_dwordx4 v50, s[12:15], s66 offen lds
    s_add_u32 m0, s64, 4096
    s_add_u32 s66, s65, 4096
    buffer_load_dwordx4 v50, s[12:15], s66 offen lds
    v_mov_b32 v4, 2130738944
    v_mov_b32 v5, 2130738944
    v_mov_b32 v6, 2130738944
    v_mov_b32 v7, 2130738944
    v_lshlrev_b32 v2, 4, v0
    v_add_u32 v2, 86784, v2
    ds_write_b128 v2, v[4:7] offset:0
    ds_write_b128 v2, v[4:7] offset:8192
    ds_write_b128 v2, v[4:7] offset:16384
    ds_write_b128 v2, v[4:7] offset:24576
    ds_write_b128 v2, v[4:7] offset:32768
    ds_write_b128 v2, v[4:7] offset:40960
    ds_write_b128 v2, v[4:7] offset:49152
    ds_write_b128 v2, v[4:7] offset:57344
    v_add_u32 v2, 0x10000, v2
    ds_write_b128 v2, v[4:7] offset:0
    v_lshlrev_b32 v2, 4, v0
    v_min_u32 v2, 3312, v2
    v_add_u32 v2, 160512, v2
    ds_write_b128 v2, v[4:7]
    v_lshlrev_b32 v240, 2, v250
    v_mov_b32 v3, 0
    v_add_u32 v2, 86016, v240
    ds_write_b32 v2, v3
    v_lshrrev_b32 v2, 5, v250
    v_bfe_u32 v3, v250, 2, 2
    v_and_b32 v4, 3, v250
    v_bfe_u32 v5, v250, 4, 1
    v_lshlrev_b32 v6, 10, v2
    v_lshl_add_u32 v6, v3, 7, v6
    v_lshl_add_u32 v6, v5, 5, v6
    v_lshl_add_u32 v6, v4, 3, v6
    v_lshrrev_b32 v7, 1, v3
    v_lshl_add_u32 v6, v7, 6, v6
    v_add_u32 v234, s29, v6
    v_xor_b32 v235, 64, v234
    v_lshlrev_b32 v6, 8, v2
    v_lshl_add_u32 v6, v3, 5, v6
    v_lshl_add_u32 v237, v4, 3, v6
    v_and_b32 v6, 7, v250
    v_lshl_add_u32 v6, v2, 3, v6
    v_lshlrev_b32 v6, 3, v6
    v_bfe_u32 v7, v250, 3, 1
    v_add_u32 v5, 1, v5
    v_mul_u32_u24 v7, v7, v5
    v_lshl_add_u32 v238, v7, 1, v6
    v_and_b32 v6, 0x38, v250
    v_add_u32 v239, 6, v6
    v_lshrrev_b32 v6, 2, v250
    v_lshrrev_b32 v7, 4, v250
    v_xor_b32 v6, v6, v7
    v_and_b32 v6, 1, v6
    v_lshlrev_b32 v6, 6, v6
    v_lshl_add_u32 v236, v4, 4, v6
    v_lshrrev_b32 v6, 1, v250
    v_lshlrev_b32 v248, 5, v6
    v_and_b32 v6, 1, v250
    v_lshlrev_b32 v249, 4, v6
    v_mov_b32 v230, 1.0
    v_mov_b32 v231, 1.0
    v_mov_b32 v232, 1.0
    v_mov_b32 v233, 1.0
    s_mov_b32 s54, 0xffffff00
    s_mov_b32 s55, 0xffffff00
    s_mov_b32 s70, 1103642624
    s_mov_b32 s71, 52511253
    v_mov_b32 v3, 1
    s_mov_b32 s67, 0
    s_waitcnt lgkmcnt(0)
    s_barrier
    s_waitcnt vmcnt(20)
    v_readlane_b32 s62, v8, 0
    v_readlane_b32 s63, v8, 32
    v_bfe_u32 v40, v8, 19, 6
    v_lshlrev_b32 v40, 2, v40
    s_lshr_b32 s62, s62, 25
    s_lshr_b32 s63, s63, 25
    s_max_u32 s67, s67, s62
    s_max_u32 s67, s67, s63
    s_min_u32 s62, s62, 32
    s_min_u32 s63, s63, 32
    s_bfm_b64 s[64:65], s62, 0
    s_mov_b32 s72, s64
    s_bfm_b64 s[64:65], s63, 0
    s_mov_b32 s73, s64
    v_add_u32 v2, 86016, v40
    s_mov_b64 exec, s[72:73]
    ds_add_rtn_u32 v32, v2, v3
    s_mov_b64 exec, -1
    s_waitcnt vmcnt(18)
    v_readlane_b32 s62, v9, 0
    v_readlane_b32 s63, v9, 32
    v_bfe_u32 v41, v9, 19, 6
    v_lshlrev_b32 v41, 2, v41
    s_lshr_b32 s62, s62, 25
    s_lshr_b32 s63, s63, 25
    s_max_u32 s67, s67, s62
    s_max_u32 s67, s67, s63
    s_min_u32 s62, s62, 32
    s_min_u32 s63, s63, 32
    s_bfm_b64 s[64:65], s62, 0
    s_mov_b32 s74, s64
    s_bfm_b64 s[64:65], s63, 0
    s_mov_b32 s75, s64
    v_add_u32 v2, 86016, v41
    s_mov_b64 exec, s[74:75]
    ds_add_rtn_u32 v33, v2, v3
    s_mov_b64 exec, -1
    s_waitcnt vmcnt(16)
    v_readlane_b32 s62, v10, 0
    v_readlane_b32 s63, v10, 32
    v_bfe_u32 v42, v10, 19, 6
    v_lshlrev_b32 v42, 2, v42
    s_lshr_b32 s62, s62, 25
    s_lshr_b32 s63, s63, 25
    s_max_u32 s67, s67, s62
    s_max_u32 s67, s67, s63
    s_min_u32 s62, s62, 32
    s_min_u32 s63, s63, 32
    s_bfm_b64 s[64:65], s62, 0
    s_mov_b32 s76, s64
    s_bfm_b64 s[64:65], s63, 0
    s_mov_b32 s77, s64
    v_add_u32 v2, 86016, v42
    s_mov_b64 exec, s[76:77]
    ds_add_rtn_u32 v34, v2, v3
    s_mov_b64 exec, -1
    s_waitcnt vmcnt(14)
    v_readlane_b32 s62, v11, 0
    v_readlane_b32 s63, v11, 32
    v_bfe_u32 v43, v11, 19, 6
    v_lshlrev_b32 v43, 2, v43
    s_lshr_b32 s62, s62, 25
    s_lshr_b32 s63, s63, 25
    s_max_u32 s67, s67, s62
    s_max_u32 s67, s67, s63
    s_min_u32 s62, s62, 32
    s_min_u32 s63, s63, 32
    s_bfm_b64 s[64:65], s62, 0
    s_mov_b32 s78, s64
    s_bfm_b64 s[64:65], s63, 0
    s_mov_b32 s79, s64
    v_add_u32 v2, 86016, v43
    s_mov_b64 exec, s[78:79]
    ds_add_rtn_u32 v35, v2, v3
    s_mov_b64 exec, -1
    s_waitcnt vmcnt(12)
    v_readlane_b32 s62, v12, 0
    v_readlane_b32 s63, v12, 32
    v_bfe_u32 v44, v12, 19, 6
    v_lshlrev_b32 v44, 2, v44
    s_lshr_b32 s62, s62, 25
    s_lshr_b32 s63, s63, 25
    s_max_u32 s67, s67, s62
    s_max_u32 s67, s67, s63
    s_min_u32 s62, s62, 32
    s_min_u32 s63, s63, 32
    s_bfm_b64 s[64:65], s62, 0
    s_mov_b32 s80, s64
    s_bfm_b64 s[64:65], s63, 0
    s_mov_b32 s81, s64
    v_add_u32 v2, 86016, v44
    s_mov_b64 exec, s[80:81]
    ds_add_rtn_u32 v36, v2, v3
    s_mov_b64 exec, -1
    s_waitcnt vmcnt(10)
    v_readlane_b32 s62, v13, 0
    v_readlane_b32 s63, v13, 32
    v_bfe_u32 v45, v13, 19, 6
    v_lshlrev_b32 v45, 2, v45
    s_lshr_b32 s62, s62, 25
    s_lshr_b32 s63, s63, 25
    s_max_u32 s67, s67, s62
    s_max_u32 s67, s67, s63
    s_min_u32 s62, s62, 32
    s_min_u32 s63, s63, 32
    s_bfm_b64 s[64:65], s62, 0
    s_mov_b32 s82, s64
    s_bfm_b64 s[64:65], s63, 0
    s_mov_b32 s83, s64
    v_add_u32 v2, 86016, v45
    s_mov_b64 exec, s[82:83]
    ds_add_rtn_u32 v37, v2, v3
    s_mov_b64 exec, -1
    s_waitcnt vmcnt(8)
    v_readlane_b32 s62, v14, 0
    v_readlane_b32 s63, v14, 32
    v_bfe_u32 v46, v14, 19, 6
    v_lshlrev_b32 v46, 2, v46
    s_lshr_b32 s62, s62, 25
    s_lshr_b32 s63, s63, 25
    s_cmp_eq_u32 s28, 7
    s_cselect_b32 s63, 0, s63
    s_max_u32 s67, s67, s62
    s_max_u32 s67, s67, s63
    s_min_u32 s62, s62, 32
    s_min_u32 s63, s63, 32
    s_bfm_b64 s[64:65], s62, 0
    s_mov_b32 s84, s64
    s_bfm_b64 s[64:65], s63, 0
    s_mov_b32 s85, s64
    v_add_u32 v2, 86016, v46
    s_mov_b64 exec, s[84:85]
    ds_add_rtn_u32 v38, v2, v3
    s_mov_b64 exec, -1
    s_waitcnt vmcnt(6)
    v_readlane_b32 s62, v15, 0
    v_readlane_b32 s63, v15, 32
    v_bfe_u32 v47, v15, 19, 6
    v_lshlrev_b32 v47, 2, v47
    s_lshr_b32 s62, s62, 25
    s_lshr_b32 s63, s63, 25
    s_cmp_eq_u32 s28, 7
    s_cselect_b32 s62, 0, s62
    s_cselect_b32 s63, 0, s63
    s_max_u32 s67, s67, s62
    s_max_u32 s67, s67, s63
    s_min_u32 s62, s62, 32
    s_min_u32 s63, s63, 32
    s_bfm_b64 s[64:65], s62, 0
    s_mov_b32 s86, s64
    s_bfm_b64 s[64:65], s63, 0
    s_mov_b32 s87, s64
    v_add_u32 v2, 86016, v47
    s_mov_b64 exec, s[86:87]
    ds_add_rtn_u32 v39, v2, v3
    s_mov_b64 exec, -1
    s_cmp_gt_u32 s67, 32
    s_cselect_b32 s62, 1000, 0
    v_mov_b32 v2, 86268
    v_mov_b32 v4, s62
    ds_max_u32 v2, v4
    s_waitcnt vmcnt(0) lgkmcnt(0)
    s_barrier
    v_add_u32 v2, 86016, v240
    ds_read_b32 v4, v2
    v_lshlrev_b32 v2, 4, v250
    ds_read_b128 v[96:99], v2 offset:0
    ds_read_b128 v[100:103], v2 offset:1024
    ds_read_b128 v[104:107], v2 offset:2048
    ds_read_b128 v[108:111], v2 offset:3072
    ds_read_b128 v[112:115], v2 offset:4096
    ds_read_b128 v[116:119], v2 offset:5120
    ds_read_b128 v[120:123], v2 offset:6144
    ds_read_b128 v[124:127], v2 offset:7168
    ds_read_b128 v[128:131], v2 offset:8192
    ds_read_b128 v[132:135], v2 offset:9216
    ds_read_b128 v[136:139], v2 offset:10240
    ds_read_b128 v[140:143], v2 offset:11264
    ds_read_b128 v[144:147], v2 offset:12288
    ds_read_b128 v[148:151], v2 offset:13312
    ds_read_b128 v[152:155], v2 offset:14336
    ds_read_b128 v[156:159], v2 offset:15360
    ds_read_b128 v[160:163], v2 offset:16384
    ds_read_b128 v[164:167], v2 offset:17408
    ds_read_b128 v[168:171], v2 offset:18432
    ds_read_b128 v[172:175], v2 offset:19456
    s_waitcnt lgkmcnt(15)
    v_cmp_lt_u32 vcc, 64, v4
    v_add_u32 v5, 15, v4
    v_lshrrev_b32 v5, 4, v5
    v_max_u32 v5, 1, v5
    v_min_u32 v5, 4, v5
    s_cmp_lg_u64 vcc, 0
    s_cbranch_scc1 SLOW
    v_mul_u32_u24 v6, 640, v5
    v_max_u32 v6, 1536, v6
    v_cmp_gt_u32 vcc, 40, v250
    s_nop 1
    v_cndmask_b32 v6, 0, v6, vcc
    v_cndmask_b32 v5, 0, v5, vcc
    v_mov_b32 v7, v6
    s_nop 1
    v_add_u32_dpp v7, v7, v7 row_shr:1 row_mask:0xf bank_mask:0xf
    s_nop 1
    v_add_u32_dpp v7, v7, v7 row_shr:2 row_mask:0xf bank_mask:0xf
    s_nop 1
    v_add_u32_dpp v7, v7, v7 row_shr:4 row_mask:0xf bank_mask:0xf
    s_nop 1
    v_add_u32_dpp v7, v7, v7 row_shr:8 row_mask:0xf bank_mask:0xf
    s_nop 1
    v_add_u32_dpp v7, v7, v7 row_bcast:15 row_mask:0xa bank_mask:0xf
    s_nop 1
    v_add_u32_dpp v7, v7, v7 row_bcast:31 row_mask:0xc bank_mask:0xf
    s_nop 0
    v_readlane_b32 s62, v7, 63
    v_sub_u32 v7, v7, v6
    v_add_u32 v7, 86784, v7
    s_cmp_gt_u32 s62, 77056
    s_cbranch_scc1 SLOW
    v_lshl_or_b32 v6, v5, 18, v7
    v_lshl_or_b32 v6, v250, 21, v6
    ds_bpermute_b32 v40, v40, v6
    ds_bpermute_b32 v41, v41, v6
    ds_bpermute_b32 v42, v42, v6
    ds_bpermute_b32 v43, v43, v6
    ds_bpermute_b32 v44, v44, v6
    ds_bpermute_b32 v45, v45, v6
    ds_bpermute_b32 v46, v46, v6
    ds_bpermute_b32 v47, v47, v6
    s_mov_b32 s66, 0
    v_mov_b32 v48, 63
    v_cmp_eq_u32 vcc, 4, v5
    s_nop 1
    v_mbcnt_lo_u32_b32 v2, vcc_lo, 0
    v_mbcnt_hi_u32_b32 v2, vcc_hi, v2
    v_add_u32 v2, s66, v2
    v_cndmask_b32 v48, v48, v2, vcc
    s_bcnt1_i32_b64 s67, vcc
    s_add_u32 s66, s66, s67
    v_cmp_eq_u32 vcc, 3, v5
    s_nop 1
    v_mbcnt_lo_u32_b32 v2, vcc_lo, 0
    v_mbcnt_hi_u32_b32 v2, vcc_hi, v2
    v_add_u32 v2, s66, v2
    v_cndmask_b32 v48, v48, v2, vcc
    s_bcnt1_i32_b64 s67, vcc
    s_add_u32 s66, s66, s67
    v_cmp_eq_u32 vcc, 2, v5
    s_nop 1
    v_mbcnt_lo_u32_b32 v2, vcc_lo, 0
    v_mbcnt_hi_u32_b32 v2, vcc_hi, v2
    v_add_u32 v2, s66, v2
    v_cndmask_b32 v48, v48, v2, vcc
    s_bcnt1_i32_b64 s67, vcc
    s_add_u32 s66, s66, s67
    v_cmp_eq_u32 vcc, 1, v5
    s_nop 1
    v_mbcnt_lo_u32_b32 v2, vcc_lo, 0
    v_mbcnt_hi_u32_b32 v2, vcc_hi, v2
    v_add_u32 v2, s66, v2
    v_cndmask_b32 v48, v48, v2, vcc
    s_bcnt1_i32_b64 s67, vcc
    s_add_u32 s66, s66, s67
    v_lshrrev_b32 v2, 3, v48
    v_and_b32 v3, 1, v2
    v_mul_u32_u24 v3, 7, v3
    v_xor_b32 v48, v48, v3
    s_add_u32 s62, s28, 0
    v_cmp_eq_u32 vcc, s62, v48
    s_ff1_i32_b64 s63, vcc
    v_readlane_b32 s30, v6, s63
    s_add_u32 s62, s28, 8
    v_cmp_eq_u32 vcc, s62, v48
    s_ff1_i32_b64 s63, vcc
    v_readlane_b32 s31, v6, s63
    s_add_u32 s62, s28, 16
    v_cmp_eq_u32 vcc, s62, v48
    s_ff1_i32_b64 s63, vcc
    v_readlane_b32 s32, v6, s63
    s_add_u32 s62, s28, 24
    v_cmp_eq_u32 vcc, s62, v48
    s_ff1_i32_b64 s63, vcc
    v_readlane_b32 s33, v6, s63
    s_add_u32 s62, s28, 32
    v_cmp_eq_u32 vcc, s62, v48
    s_ff1_i32_b64 s63, vcc
    v_readlane_b32 s34, v6, s63
    v_and_b32 v3, 7, v48
    v_lshlrev_b32 v3, 13, v3
    v_mul_u32_u24 v2, 1536, v2
    v_add_u32 v2, v2, v3
    v_mov_b32 v3, v7
    v_lshlrev_b32 v4, 3, v250
    v_add_u32 v4, 86272, v4
    s_mov_b32 exec_hi, 0xff
    ds_write_b64 v4, v[2:3]
    s_mov_b32 exec_hi, -1
    s_waitcnt lgkmcnt(0)
    v_and_b32 v2, 0x3ffff, v40
    v_bfe_u32 v3, v40, 18, 3
    v_lshl_add_u32 v3, v3, 9, v2
    v_lshl_add_u32 v2, v32, 5, v2
    v_lshl_add_u32 v3, v32, 3, v3
    v_and_b32 v8, 0x7ffff, v8
    s_mov_b64 exec, s[72:73]
    ds_write_b32 v2, v8
    ds_write_b64 v3, v[16:17]
    s_mov_b64 exec, -1
    v_and_b32 v2, 0x3ffff, v41
    v_bfe_u32 v3, v41, 18, 3
    v_lshl_add_u32 v3, v3, 9, v2
    v_lshl_add_u32 v2, v33, 5, v2
    v_lshl_add_u32 v3, v33, 3, v3
    v_and_b32 v9, 0x7ffff, v9
    s_mov_b64 exec, s[74:75]
    ds_write_b32 v2, v9
    ds_write_b64 v3, v[18:19]
    s_mov_b64 exec, -1
    v_and_b32 v2, 0x3ffff, v42
    v_bfe_u32 v3, v42, 18, 3
    v_lshl_add_u32 v3, v3, 9, v2
    v_lshl_add_u32 v2, v34, 5, v2
    v_lshl_add_u32 v3, v34, 3, v3
    v_and_b32 v10, 0x7ffff, v10
    s_mov_b64 exec, s[76:77]
    ds_write_b32 v2, v10
    ds_write_b64 v3, v[20:21]
    s_mov_b64 exec, -1
    v_and_b32 v2, 0x3ffff, v43
    v_bfe_u32 v3, v43, 18, 3
    v_lshl_add_u32 v3, v3, 9, v2
    v_lshl_add_u32 v2, v35, 5, v2
    v_lshl_add_u32 v3, v35, 3, v3
    v_and_b32 v11, 0x7ffff, v11
    s_mov_b64 exec, s[78:79]
    ds_write_b32 v2, v11
    ds_write_b64 v3, v[22:23]
    s_mov_b64 exec, -1
    v_and_b32 v2, 0x3ffff, v44
    v_bfe_u32 v3, v44, 18, 3
    v_lshl_add_u32 v3, v3, 9, v2
    v_lshl_add_u32 v2, v36, 5, v2
    v_lshl_add_u32 v3, v36, 3, v3
    v_and_b32 v12, 0x7ffff, v12
    s_mov_b64 exec, s[80:81]
    ds_write_b32 v2, v12
    ds_write_b64 v3, v[24:25]
    s_mov_b64 exec, -1
    v_and_b32 v2, 0x3ffff, v45
    v_bfe_u32 v3, v45, 18, 3
    v_lshl_add_u32 v3, v3, 9, v2
    v_lshl_add_u32 v2, v37, 5, v2
    v_lshl_add_u32 v3, v37, 3, v3
    v_and_b32 v13, 0x7ffff, v13
    s_mov_b64 exec, s[82:83]
    ds_write_b32 v2, v13
    ds_write_b64 v3, v[26:27]
    s_mov_b64 exec, -1
    v_and_b32 v2, 0x3ffff, v46
    v_bfe_u32 v3, v46, 18, 3
    v_lshl_add_u32 v3, v3, 9, v2
    v_lshl_add_u32 v2, v38, 5, v2
    v_lshl_add_u32 v3, v38, 3, v3
    v_and_b32 v14, 0x7ffff, v14
    s_mov_b64 exec, s[84:85]
    ds_write_b32 v2, v14
    ds_write_b64 v3, v[28:29]
    s_mov_b64 exec, -1
    v_and_b32 v2, 0x3ffff, v47
    v_bfe_u32 v3, v47, 18, 3
    v_lshl_add_u32 v3, v3, 9, v2
    v_lshl_add_u32 v2, v39, 5, v2
    v_lshl_add_u32 v3, v39, 3, v3
    v_and_b32 v15, 0x7ffff, v15
    s_mov_b64 exec, s[86:87]
    ds_write_b32 v2, v15
    ds_write_b64 v3, v[30:31]
    s_mov_b64 exec, -1
    s_mov_b32 s68, 0
    s_mov_b32 s69, s31
    s_mov_b32 s31, s30
    s_and_b32 s49, s31, 0x3ffff
    s_bfe_u32 s48, s31, 0x30012
    s_lshl_b32 s62, s48, 9
    s_add_u32 s43, s49, s62
    s_mul_i32 s62, s48, 12
    s_lshr_b64 s[64:65], s[70:71], s62
    s_mov_b32 s39, s68
    s_bfe_u32 s62, s64, 131072
    s_lshl_b32 s62, s62, 7
    s_add_u32 s44, s43, s62
    s_bfe_u32 s62, s64, 131074
    s_lshl_b32 s62, s62, 8
    s_add_u32 s40, s62, s68
    s_bfe_u32 s62, s64, 131076
    s_lshl_b32 s62, s62, 7
    s_add_u32 s45, s43, s62
    s_bfe_u32 s62, s64, 131078
    s_lshl_b32 s62, s62, 8
    s_add_u32 s41, s62, s68
    s_bfe_u32 s62, s64, 131080
    s_lshl_b32 s62, s62, 7
    s_add_u32 s46, s43, s62
    s_bfe_u32 s62, s64, 131082
    s_lshl_b32 s62, s62, 8
    s_add_u32 s42, s62, s68
    s_mov_b32 s56, -1
    s_cmp_ge_u32 s48, 2
    s_cselect_b32 s57, -1, 0
    s_mov_b32 s60, s49
    s_add_u32 s61, s49, 1024
    s_cmp_ge_u32 s48, 3
    s_cselect_b32 s58, -1, 1
    s_cselect_b32 s61, s61, 86656
    s_cmp_ge_u32 s48, 4
    s_cselect_b32 s59, -1, 0
    s_mov_b32 s31, s69
    s_mov_b32 s35, 0
    s_mov_b32 s36, 256
    s_mov_b32 s37, 512
    s_mov_b32 s38, 768
    s_waitcnt lgkmcnt(0)
    s_barrier
    v_add_u32 v244, s43, v239
    ds_read_u16 v222, v244
    ds_read_u16 v223, v244 offset:64
    v_add_u32 v244, s44, v239
    ds_read_u16 v224, v244
    ds_read_u16 v225, v244 offset:64
    v_add_u32 v244, s45, v239
    ds_read_u16 v226, v244
    ds_read_u16 v227, v244 offset:64
    v_add_u32 v244, s46, v239
    ds_read_u16 v228, v244
    ds_read_u16 v229, v244 offset:64
    v_add_u32 v245, s49, v248
    ds_read_b32 v246, v245
    ds_read_b32 v247, v245 offset:1024
    s_waitcnt lgkmcnt(0)
    v_lshl_add_u32 v246, v246, 5, v249
    v_lshl_add_u32 v247, v247, 5, v249
    s_mov_b32 m0, s60
    s_mov_b64 exec, s[56:57]
    buffer_load_dwordx4 v246, s[8:11], 0 offen  lds
    s_mov_b32 m0, s61
    s_mov_b64 exec, s[58:59]
    buffer_load_dwordx4 v247, s[8:11], 0 offen  lds
    s_mov_b64 exec, -1
    v_lshl_add_u32 v222, v222, 10, v236
    v_lshl_add_u32 v223, v223, 10, v236
    s_add_u32 m0, s29, 0
    s_nop 0
    buffer_load_dwordx4 v222, s[4:7], s39 offen lds
    s_add_u32 m0, s29, 1024
    s_nop 0
    buffer_load_dwordx4 v223, s[4:7], s39 offen lds
    v_lshl_add_u32 v224, v224, 10, v236
    v_lshl_add_u32 v225, v225, 10, v236
    s_add_u32 m0, s29, 2048
    s_nop 0
    buffer_load_dwordx4 v224, s[4:7], s40 offen lds
    s_add_u32 m0, s29, 3072
    s_nop 0
    buffer_load_dwordx4 v225, s[4:7], s40 offen lds
    v_lshl_add_u32 v226, v226, 10, v236
    v_lshl_add_u32 v227, v227, 10, v236
    s_add_u32 m0, s29, 4096
    s_nop 0
    buffer_load_dwordx4 v226, s[4:7], s41 offen lds
    s_add_u32 m0, s29, 5120
    s_nop 0
    buffer_load_dwordx4 v227, s[4:7], s41 offen lds
    v_lshl_add_u32 v228, v228, 10, v236
    v_lshl_add_u32 v229, v229, 10, v236
    s_add_u32 m0, s29, 6144
    s_nop 0
    buffer_load_dwordx4 v228, s[4:7], s42 offen lds
    s_add_u32 m0, s29, 7168
    s_nop 0
    buffer_load_dwordx4 v229, s[4:7], s42 offen lds
    v_add_u32 v241, s49, v237
    v_add_u32 v242, s43, v238
    s_mov_b32 s47, s48
    s_mov_b32 s50, s49
    s_and_b32 s49, s31, 0x3ffff
    s_bfe_u32 s48, s31, 0x30012
    s_lshl_b32 s62, s48, 9
    s_add_u32 s43, s49, s62
    s_mul_i32 s62, s48, 12
    s_lshr_b64 s[64:65], s[70:71], s62
    s_mov_b32 s39, s68
    s_bfe_u32 s62, s64, 131072
    s_lshl_b32 s62, s62, 7
    s_add_u32 s44, s43, s62
    s_bfe_u32 s62, s64, 131074
    s_lshl_b32 s62, s62, 8
    s_add_u32 s40, s62, s68
    s_bfe_u32 s62, s64, 131076
    s_lshl_b32 s62, s62, 7
    s_add_u32 s45, s43, s62
    s_bfe_u32 s62, s64, 131078
    s_lshl_b32 s62, s62, 8
    s_add_u32 s41, s62, s68
    s_bfe_u32 s62, s64, 131080
    s_lshl_b32 s62, s62, 7
    s_add_u32 s46, s43, s62
    s_bfe_u32 s62, s64, 131082
    s_lshl_b32 s62, s62, 8
    s_add_u32 s42, s62, s68
    s_mov_b32 s56, -1
    s_cmp_ge_u32 s48, 2
    s_cselect_b32 s57, -1, 0
    s_mov_b32 s60, s49
    s_add_u32 s61, s49, 1024
    s_cmp_ge_u32 s48, 3
    s_cselect_b32 s58, -1, 1
    s_cselect_b32 s61, s61, 86656
    s_cmp_ge_u32 s48, 4
    s_cselect_b32 s59, -1, 0
    s_mov_b32 s51, 0
    s_mov_b32 s52, 0
    s_waitcnt vmcnt(6)
    ds_read_b64_tr_b16 v[176:177], v234 offset:0
    ds_read_b64_tr_b16 v[178:179], v234 offset:512
    ds_read_b64_tr_b16 v[180:181], v235 offset:0
    ds_read_b64_tr_b16 v[182:183], v235 offset:512
    ds_read_b64_tr_b16 v[68:69], v241 offset:0
    ds_read_b64_tr_b16 v[70:71], v241 offset:128
    s_mov_b64 exec, s[54:55]
    ds_read_u16_d16_hi v230, v242 offset:0
    s_mov_b64 exec, -1
    s_cmp_eq_u32 s47, 2
    s_cbranch_scc1 ITEM_0_2
    s_cmp_eq_u32 s47, 3
    s_cbranch_scc1 ITEM_0_3
    s_cmp_eq_u32 s47, 4
    s_cbranch_scc1 ITEM_0_4
    s_branch ITEM_0_1
NEXT_0:
    s_mov_b32 s62, s30
    s_mov_b32 s30, s31
    s_mov_b32 s31, s32
    s_mov_b32 s32, s33
    s_mov_b32 s33, s34
    s_mov_b32 s34, s62
    s_mov_b32 s47, s48
    s_mov_b32 s50, s49
    s_add_u32 s51, s51, 1
    s_add_u32 s52, s52, 6
    s_cmp_eq_u32 s51, 5
    s_cbranch_scc1 TO_PHASE1
    s_cmp_eq_u32 s51, 4
    s_cselect_b32 s68, 128, 0
    s_and_b32 s49, s31, 0x3ffff
    s_bfe_u32 s48, s31, 0x30012
    s_lshl_b32 s62, s48, 9
    s_add_u32 s43, s49, s62
    s_mul_i32 s62, s48, 12
    s_lshr_b64 s[64:65], s[70:71], s62
    s_mov_b32 s39, s68
    s_bfe_u32 s62, s64, 131072
    s_lshl_b32 s62, s62, 7
    s_add_u32 s44, s43, s62
    s_bfe_u32 s62, s64, 131074
    s_lshl_b32 s62, s62, 8
    s_add_u32 s40, s62, s68
    s_bfe_u32 s62, s64, 131076
    s_lshl_b32 s62, s62, 7
    s_add_u32 s45, s43, s62
    s_bfe_u32 s62, s64, 131078
    s_lshl_b32 s62, s62, 8
    s_add_u32 s41, s62, s68
    s_bfe_u32 s62, s64, 131080
    s_lshl_b32 s62, s62, 7
    s_add_u32 s46, s43, s62
    s_bfe_u32 s62, s64, 131082
    s_lshl_b32 s62, s62, 8
    s_add_u32 s42, s62, s68
    s_mov_b32 s56, -1
    s_cmp_ge_u32 s48, 2
    s_cselect_b32 s57, -1, 0
    s_mov_b32 s60, s49
    s_add_u32 s61, s49, 1024
    s_cmp_ge_u32 s48, 3
    s_cselect_b32 s58, -1, 1
    s_cselect_b32 s61, s61, 86656
    s_cmp_ge_u32 s48, 4
    s_cselect_b32 s59, -1, 0
    s_cmp_eq_u32 s51, 4
    s_cbranch_scc0 NEXT_0_go
    s_mov_b64 s[56:57], 1
    s_mov_b32 s60, 86656
    s_mov_b64 s[58:59], 1
    s_mov_b32 s61, 86656
NEXT_0_go:
    s_cmp_eq_u32 s47, 2
    s_cbranch_scc1 ITEM_0_2
    s_cmp_eq_u32 s47, 3
    s_cbranch_scc1 ITEM_0_3
    s_cmp_eq_u32 s47, 4
    s_cbranch_scc1 ITEM_0_4
    s_branch ITEM_0_1
TO_PHASE1:
    v_lshlrev_b32 v244, 4, v250
    v_add_u32 v244, 65536, v244
    ds_read_b128 v[96:99], v244 offset:0
    ds_read_b128 v[100:103], v244 offset:1024
    ds_read_b128 v[104:107], v244 offset:2048
    ds_read_b128 v[108:111], v244 offset:3072
    ds_read_b128 v[112:115], v244 offset:4096
    ds_read_b128 v[116:119], v244 offset:5120
    ds_read_b128 v[120:123], v244 offset:6144
    ds_read_b128 v[124:127], v244 offset:7168
    ds_read_b128 v[128:131], v244 offset:8192
    ds_read_b128 v[132:135], v244 offset:9216
    ds_read_b128 v[136:139], v244 offset:10240
    ds_read_b128 v[140:143], v244 offset:11264
    ds_read_b128 v[144:147], v244 offset:12288
    ds_read_b128 v[148:151], v244 offset:13312
    ds_read_b128 v[152:155], v244 offset:14336
    ds_read_b128 v[156:159], v244 offset:15360
    ds_read_b128 v[160:163], v244 offset:16384
    ds_read_b128 v[164:167], v244 offset:17408
    ds_read_b128 v[168:171], v244 offset:18432
    ds_read_b128 v[172:175], v244 offset:19456
    s_mov_b32 s35, 128
    s_mov_b32 s36, 384
    s_mov_b32 s37, 640
    s_mov_b32 s38, 896
    s_mov_b32 s51, 0
    s_waitcnt lgkmcnt(0)
    s_branch NEXT_1_go
NEXT_1:
    s_mov_b32 s62, s30
    s_mov_b32 s30, s31
    s_mov_b32 s31, s32
    s_mov_b32 s32, s33
    s_mov_b32 s33, s34
    s_mov_b32 s34, s62
    s_mov_b32 s47, s48
    s_mov_b32 s50, s49
    s_add_u32 s51, s51, 1
    s_cmp_eq_u32 s51, 5
    s_cbranch_scc1 TAIL
NEXT_1_go:
    s_and_b32 s49, s31, 0x3ffff
    s_bfe_u32 s48, s31, 0x30012
    s_lshl_b32 s62, s48, 9
    s_add_u32 s43, s49, s62
    s_mul_i32 s62, s48, 12
    s_lshr_b64 s[64:65], s[70:71], s62
    s_mov_b32 s39, s68
    s_bfe_u32 s62, s64, 131072
    s_lshl_b32 s62, s62, 7
    s_add_u32 s44, s43, s62
    s_bfe_u32 s62, s64, 131074
    s_lshl_b32 s62, s62, 8
    s_add_u32 s40, s62, s68
    s_bfe_u32 s62, s64, 131076
    s_lshl_b32 s62, s62, 7
    s_add_u32 s45, s43, s62
    s_bfe_u32 s62, s64, 131078
    s_lshl_b32 s62, s62, 8
    s_add_u32 s41, s62, s68
    s_bfe_u32 s62, s64, 131080
    s_lshl_b32 s62, s62, 7
    s_add_u32 s46, s43, s62
    s_bfe_u32 s62, s64, 131082
    s_lshl_b32 s62, s62, 8
    s_add_u32 s42, s62, s68
    s_bfe_u32 s69, s30, 0x40015
    s_bfe_u32 s62, s30, 0x10007
    s_lshl_b32 s62, s62, 3
    s_xor_b32 s69, s69, s62
    s_lshl_b32 s69, s69, 4
    s_cmp_eq_u32 s47, 2
    s_cbranch_scc1 ITEM_1_2
    s_cmp_eq_u32 s47, 3
    s_cbranch_scc1 ITEM_1_3
    s_cmp_eq_u32 s47, 4
    s_cbranch_scc1 ITEM_1_4
    s_branch ITEM_1_1
.p2align 6
ITEM_0_2:
    ds_read_b64_tr_b16 v[76:77], v241 offset:512
    ds_read_b64_tr_b16 v[78:79], v241 offset:640
    s_mov_b64 exec, s[54:55]
    ds_read_u16_d16_hi v231, v242 offset:128
    s_mov_b64 exec, -1
    v_add_u32 v244, s45, v239
    ds_read_u16 v226, v244
    ds_read_u16 v227, v244 offset:64
    v_add_u32 v244, s46, v239
    ds_read_u16 v228, v244
    ds_read_u16 v229, v244 offset:64
    v_add_u32 v245, s49, v248
    ds_read_b32 v246, v245
    ds_read_b32 v247, v245 offset:1024
    s_waitcnt lgkmcnt(9)
    v_lshlrev_b32 v184, 16, v68
    v_and_b32 v185, 0xffff0000, v68
    v_lshlrev_b32 v186, 16, v69
    v_and_b32 v187, 0xffff0000, v69
    v_mul_f32_dpp v188, v230, v184 row_newbcast:0 row_mask:0xf bank_mask:0xf
    v_mul_f32_dpp v189, v230, v185 row_newbcast:1 row_mask:0xf bank_mask:0xf
    v_mul_f32_dpp v190, v230, v184 row_newbcast:8 row_mask:0xf bank_mask:0xf
    v_mul_f32_dpp v191, v230, v185 row_newbcast:9 row_mask:0xf bank_mask:0xf
    v_lshlrev_b32 v184, 16, v70
    v_and_b32 v185, 0xffff0000, v70
    v_cvt_pk_bf16_f32 v64, v188, v189
    v_cvt_pk_bf16_f32 v68, v190, v191
    v_mul_f32_dpp v188, v230, v186 row_newbcast:2 row_mask:0xf bank_mask:0xf
    v_mul_f32_dpp v189, v230, v187 row_newbcast:3 row_mask:0xf bank_mask:0xf
    v_mul_f32_dpp v190, v230, v186 row_newbcast:10 row_mask:0xf bank_mask:0xf
    v_mul_f32_dpp v191, v230, v187 row_newbcast:11 row_mask:0xf bank_mask:0xf
    v_lshlrev_b32 v186, 16, v71
    v_and_b32 v187, 0xffff0000, v71
    v_cvt_pk_bf16_f32 v65, v188, v189
    v_cvt_pk_bf16_f32 v69, v190, v191
    v_mul_f32_dpp v188, v230, v184 row_newbcast:4 row_mask:0xf bank_mask:0xf
    v_mul_f32_dpp v189, v230, v185 row_newbcast:5 row_mask:0xf bank_mask:0xf
    v_mul_f32_dpp v190, v230, v184 row_newbcast:12 row_mask:0xf bank_mask:0xf
    v_mul_f32_dpp v191, v230, v185 row_newbcast:13 row_mask:0xf bank_mask:0xf
    v_cvt_pk_bf16_f32 v66, v188, v189
    v_cvt_pk_bf16_f32 v70, v190, v191
    v_mul_f32_dpp v188, v230, v186 row_newbcast:6 row_mask:0xf bank_mask:0xf
    v_mul_f32_dpp v189, v230, v187 row_newbcast:7 row_mask:0xf bank_mask:0xf
    v_mul_f32_dpp v190, v230, v186 row_newbcast:14 row_mask:0xf bank_mask:0xf
    v_mul_f32_dpp v191, v230, v187 row_newbcast:15 row_mask:0xf bank_mask:0xf
    v_cvt_pk_bf16_f32 v67, v188, v189
    v_cvt_pk_bf16_f32 v71, v190, v191
    s_nop 0
    s_waitcnt lgkmcnt(6)
    v_mfma_f32_32x32x16_bf16 v[0:15], v[64:67], v[176:179], 0
    v_lshlrev_b32 v184, 16, v76
    v_and_b32 v185, 0xffff0000, v76
    v_lshlrev_b32 v186, 16, v77
    v_and_b32 v187, 0xffff0000, v77
    v_mul_f32_dpp v188, v231, v184 row_newbcast:0 row_mask:0xf bank_mask:0xf
    v_mul_f32_dpp v189, v231, v185 row_newbcast:1 row_mask:0xf bank_mask:0xf
    v_mul_f32_dpp v190, v231, v184 row_newbcast:8 row_mask:0xf bank_mask:0xf
    v_mul_f32_dpp v191, v231, v185 row_newbcast:9 row_mask:0xf bank_mask:0xf
    v_mfma_f32_32x32x16_bf16 v[16:31], v[68:71], v[176:179], 0
    v_lshlrev_b32 v184, 16, v78
    v_and_b32 v185, 0xffff0000, v78
    v_cvt_pk_bf16_f32 v72, v188, v189
    v_cvt_pk_bf16_f32 v76, v190, v191
    v_mul_f32_dpp v188, v231, v186 row_newbcast:2 row_mask:0xf bank_mask:0xf
    v_mul_f32_dpp v189, v231, v187 row_newbcast:3 row_mask:0xf bank_mask:0xf
    v_mul_f32_dpp v190, v231, v186 row_newbcast:10 row_mask:0xf bank_mask:0xf
    v_mul_f32_dpp v191, v231, v187 row_newbcast:11 row_mask:0xf bank_mask:0xf
    s_add_u32 m0, s29, 0
    s_nop 0
    buffer_load_dwordx4 v222, s[4:7], s37 offen lds
    s_add_u32 m0, s29, 1024
    s_nop 0
    buffer_load_dwordx4 v223, s[4:7], s37 offen lds
    s_waitcnt lgkmcnt(0)
    v_lshl_add_u32 v246, v246, 5, v249
    v_lshl_add_u32 v247, v247, 5, v249
    s_mov_b32 m0, s60
    s_mov_b64 exec, s[56:57]
    buffer_load_dwordx4 v246, s[8:11], 0 offen  lds
    s_mov_b32 m0, s61
    s_mov_b64 exec, s[58:59]
    buffer_load_dwordx4 v247, s[8:11], 0 offen  lds
    s_mov_b64 exec, -1
    s_waitcnt vmcnt(8)
    ds_read_b64_tr_b16 v[176:177], v234 offset:2048
    ds_read_b64_tr_b16 v[178:179], v234 offset:2560
    v_mfma_f32_32x32x16_bf16 v[32:47], v[64:67], v[180:183], 0
    v_lshlrev_b32 v186, 16, v79
    v_and_b32 v187, 0xffff0000, v79
    v_cvt_pk_bf16_f32 v73, v188, v189
    v_cvt_pk_bf16_f32 v77, v190, v191
    v_mul_f32_dpp v188, v231, v184 row_newbcast:4 row_mask:0xf bank_mask:0xf
    v_mul_f32_dpp v189, v231, v185 row_newbcast:5 row_mask:0xf bank_mask:0xf
    v_mul_f32_dpp v190, v231, v184 row_newbcast:12 row_mask:0xf bank_mask:0xf
    v_mul_f32_dpp v191, v231, v185 row_newbcast:13 row_mask:0xf bank_mask:0xf
    v_mfma_f32_32x32x16_bf16 v[48:63], v[68:71], v[180:183], 0
    ds_read_b64_tr_b16 v[180:181], v235 offset:2048
    ds_read_b64_tr_b16 v[182:183], v235 offset:2560
    v_cvt_pk_bf16_f32 v74, v188, v189
    v_cvt_pk_bf16_f32 v78, v190, v191
    v_mul_f32_dpp v188, v231, v186 row_newbcast:6 row_mask:0xf bank_mask:0xf
    v_mul_f32_dpp v189, v231, v187 row_newbcast:7 row_mask:0xf bank_mask:0xf
    v_mul_f32_dpp v190, v231, v186 row_newbcast:14 row_mask:0xf bank_mask:0xf
    v_mul_f32_dpp v191, v231, v187 row_newbcast:15 row_mask:0xf bank_mask:0xf
    v_cvt_pk_bf16_f32 v75, v188, v189
    v_cvt_pk_bf16_f32 v79, v190, v191
    s_nop 0
    s_waitcnt lgkmcnt(2)
    v_mfma_f32_32x32x16_bf16 v[0:15], v[72:75], v[176:179], v[0:15]
    v_mfma_f32_32x32x16_bf16 v[16:31], v[76:79], v[176:179], v[16:31]
    s_waitcnt lgkmcnt(0)
    s_add_u32 m0, s29, 2048
    s_nop 0
    buffer_load_dwordx4 v224, s[4:7], s37 offen lds
    s_add_u32 m0, s29, 3072
    s_nop 0
    buffer_load_dwordx4 v225, s[4:7], s37 offen lds
    s_waitcnt vmcnt(8)
    ds_read_b64_tr_b16 v[176:177], v234 offset:4096
    ds_read_b64_tr_b16 v[178:179], v234 offset:4608
    v_mfma_f32_32x32x16_bf16 v[32:47], v[72:75], v[180:183], v[32:47]
    v_mfma_f32_32x32x16_bf16 v[48:63], v[76:79], v[180:183], v[48:63]
    ds_read_b64_tr_b16 v[180:181], v235 offset:4096
    ds_read_b64_tr_b16 v[182:183], v235 offset:4608
    v_mul_f32 v0, v0, v96
    v_fmac_f32 v0, v1, v97
    v_fmac_f32 v0, v2, v98
    v_fmac_f32 v0, v3, v99
    v_fmac_f32 v0, v4, v100
    v_fmac_f32 v0, v5, v101
    v_fmac_f32 v0, v6, v102
    v_fmac_f32 v0, v7, v103
    v_mul_f32 v8, v8, v128
    v_fmac_f32 v8, v9, v129
    v_fmac_f32 v8, v10, v130
    v_fmac_f32 v8, v11, v131
    v_fmac_f32 v8, v12, v132
    v_fmac_f32 v8, v13, v133
    v_fmac_f32 v8, v14, v134
    v_fmac_f32 v8, v15, v135
    v_mul_f32 v16, v16, v128
    v_fmac_f32 v16, v17, v129
    v_fmac_f32 v16, v18, v130
    v_fmac_f32 v16, v19, v131
    v_fmac_f32 v16, v20, v132
    v_fmac_f32 v16, v21, v133
    v_fmac_f32 v16, v22, v134
    v_fmac_f32 v16, v23, v135
    v_mul_f32 v24, v24, v128
    v_fmac_f32 v24, v25, v129
    v_fmac_f32 v24, v26, v130
    v_fmac_f32 v24, v27, v131
    v_fmac_f32 v24, v28, v132
    v_fmac_f32 v24, v29, v133
    v_fmac_f32 v24, v30, v134
    v_fmac_f32 v24, v31, v135
    v_mul_f32 v32, v32, v104
    v_fmac_f32 v32, v33, v105
    v_fmac_f32 v32, v34, v106
    v_fmac_f32 v32, v35, v107
    v_fmac_f32 v32, v36, v108
    v_fmac_f32 v32, v37, v109
    v_fmac_f32 v32, v38, v110
    v_fmac_f32 v32, v39, v111
    v_mul_f32 v40, v40, v136
    v_fmac_f32 v40, v41, v137
    v_fmac_f32 v40, v42, v138
    v_fmac_f32 v40, v43, v139
    v_fmac_f32 v40, v44, v140
    v_fmac_f32 v40, v45, v141
    v_fmac_f32 v40, v46, v142
    v_fmac_f32 v40, v47, v143
    v_mul_f32 v48, v48, v136
    v_fmac_f32 v48, v49, v137
    v_fmac_f32 v48, v50, v138
    v_fmac_f32 v48, v51, v139
    v_fmac_f32 v48, v52, v140
    v_fmac_f32 v48, v53, v141
    v_fmac_f32 v48, v54, v142
    v_fmac_f32 v48, v55, v143
    v_mul_f32 v56, v56, v136
    v_fmac_f32 v56, v57, v137
    v_fmac_f32 v56, v58, v138
    v_fmac_f32 v56, v59, v139
    v_fmac_f32 v56, v60, v140
    v_fmac_f32 v56, v61, v141
    v_fmac_f32 v56, v62, v142
    v_fmac_f32 v56, v63, v143
    s_nop 0
    v_permlane32_swap_b32 v0, v8
    v_permlane32_swap_b32 v16, v24
    v_permlane32_swap_b32 v32, v40
    v_permlane32_swap_b32 v48, v56
    v_add_f32 v8, v0, v8
    v_add_f32 v24, v16, v24
    v_add_f32 v40, v32, v40
    v_add_f32 v56, v48, v56
    s_set_gpr_idx_on s52, gpr_idx(DST)
    s_nop 0
    v_cvt_pk_bf16_f32 v192, v8, v40
    v_cvt_pk_bf16_f32 v193, v24, v56
    s_set_gpr_idx_off
    s_waitcnt lgkmcnt(2)
    v_mfma_f32_32x32x16_bf16 v[0:15], v[64:67], v[176:179], 0
    v_mfma_f32_32x32x16_bf16 v[16:31], v[68:71], v[176:179], 0
    s_waitcnt lgkmcnt(0)
    s_add_u32 m0, s29, 4096
    s_nop 0
    buffer_load_dwordx4 v222, s[4:7], s38 offen lds
    s_add_u32 m0, s29, 5120
    s_nop 0
    buffer_load_dwordx4 v223, s[4:7], s38 offen lds
    v_add_u32 v244, s43, v239
    ds_read_u16 v222, v244
    ds_read_u16 v223, v244 offset:64
    s_waitcnt vmcnt(8)
    ds_read_b64_tr_b16 v[176:177], v234 offset:6144
    ds_read_b64_tr_b16 v[178:179], v234 offset:6656
    v_mfma_f32_32x32x16_bf16 v[32:47], v[64:67], v[180:183], 0
    v_mfma_f32_32x32x16_bf16 v[48:63], v[68:71], v[180:183], 0
    ds_read_b64_tr_b16 v[180:181], v235 offset:6144
    ds_read_b64_tr_b16 v[182:183], v235 offset:6656
    s_waitcnt lgkmcnt(2)
    v_mfma_f32_32x32x16_bf16 v[0:15], v[72:75], v[176:179], v[0:15]
    v_mfma_f32_32x32x16_bf16 v[16:31], v[76:79], v[176:179], v[16:31]
    s_waitcnt lgkmcnt(0)
    s_add_u32 m0, s29, 6144
    s_nop 0
    buffer_load_dwordx4 v224, s[4:7], s38 offen lds
    s_add_u32 m0, s29, 7168
    s_nop 0
    buffer_load_dwordx4 v225, s[4:7], s38 offen lds
    v_add_u32 v244, s44, v239
    ds_read_u16 v224, v244
    ds_read_u16 v225, v244 offset:64
    s_waitcnt vmcnt(8)
    ds_read_b64_tr_b16 v[176:177], v234 offset:0
    ds_read_b64_tr_b16 v[178:179], v234 offset:512
    v_mfma_f32_32x32x16_bf16 v[32:47], v[72:75], v[180:183], v[32:47]
    v_mfma_f32_32x32x16_bf16 v[48:63], v[76:79], v[180:183], v[48:63]
    ds_read_b64_tr_b16 v[180:181], v235 offset:0
    ds_read_b64_tr_b16 v[182:183], v235 offset:512
    v_mul_f32 v184, v0, v144
    v_fmac_f32 v184, v1, v145
    v_fmac_f32 v184, v2, v146
    v_fmac_f32 v184, v3, v147
    v_fmac_f32 v184, v4, v148
    v_fmac_f32 v184, v5, v149
    v_fmac_f32 v184, v6, v150
    v_fmac_f32 v184, v7, v151
    v_mul_f32 v186, v8, v112
    v_fmac_f32 v186, v9, v113
    v_fmac_f32 v186, v10, v114
    v_fmac_f32 v186, v11, v115
    v_fmac_f32 v186, v12, v116
    v_fmac_f32 v186, v13, v117
    v_fmac_f32 v186, v14, v118
    v_fmac_f32 v186, v15, v119
    v_mul_f32_e64 v188, v16, -v160
    v_fma_f32 v188, v17, -v161, v188
    v_fma_f32 v188, v18, -v162, v188
    v_fma_f32 v188, v19, -v163, v188
    v_fma_f32 v188, v20, -v164, v188
    v_fma_f32 v188, v21, -v165, v188
    v_fma_f32 v188, v22, -v166, v188
    v_fma_f32 v188, v23, -v167, v188
    v_mul_f32 v190, v24, v160
    v_fmac_f32 v190, v25, v161
    v_fmac_f32 v190, v26, v162
    v_fmac_f32 v190, v27, v163
    v_fmac_f32 v190, v28, v164
    v_fmac_f32 v190, v29, v165
    v_fmac_f32 v190, v30, v166
    v_fmac_f32 v190, v31, v167
    v_mul_f32 v185, v32, v152
    v_fmac_f32 v185, v33, v153
    v_fmac_f32 v185, v34, v154
    v_fmac_f32 v185, v35, v155
    v_fmac_f32 v185, v36, v156
    v_fmac_f32 v185, v37, v157
    v_fmac_f32 v185, v38, v158
    v_fmac_f32 v185, v39, v159
    v_mul_f32 v187, v40, v120
    v_fmac_f32 v187, v41, v121
    v_fmac_f32 v187, v42, v122
    v_fmac_f32 v187, v43, v123
    v_fmac_f32 v187, v44, v124
    v_fmac_f32 v187, v45, v125
    v_fmac_f32 v187, v46, v126
    v_fmac_f32 v187, v47, v127
    v_mul_f32_e64 v189, v48, -v168
    v_fma_f32 v189, v49, -v169, v189
    v_fma_f32 v189, v50, -v170, v189
    v_fma_f32 v189, v51, -v171, v189
    v_fma_f32 v189, v52, -v172, v189
    v_fma_f32 v189, v53, -v173, v189
    v_fma_f32 v189, v54, -v174, v189
    v_fma_f32 v189, v55, -v175, v189
    v_mul_f32 v191, v56, v168
    v_fmac_f32 v191, v57, v169
    v_fmac_f32 v191, v58, v170
    v_fmac_f32 v191, v59, v171
    v_fmac_f32 v191, v60, v172
    v_fmac_f32 v191, v61, v173
    v_fmac_f32 v191, v62, v174
    v_fmac_f32 v191, v63, v175
    s_waitcnt lgkmcnt(2)
    v_mfma_f32_32x32x16_bf16 v[0:15], v[64:67], v[176:179], 0
    v_mfma_f32_32x32x16_bf16 v[16:31], v[68:71], v[176:179], 0
    v_lshl_add_u32 v222, v222, 10, v236
    v_lshl_add_u32 v223, v223, 10, v236
    s_waitcnt lgkmcnt(0)
    s_add_u32 m0, s29, 0
    s_nop 0
    buffer_load_dwordx4 v222, s[4:7], s39 offen lds
    s_add_u32 m0, s29, 1024
    s_nop 0
    buffer_load_dwordx4 v223, s[4:7], s39 offen lds
    s_waitcnt vmcnt(6)
    ds_read_b64_tr_b16 v[176:177], v234 offset:2048
    ds_read_b64_tr_b16 v[178:179], v234 offset:2560
    v_mfma_f32_32x32x16_bf16 v[32:47], v[64:67], v[180:183], 0
    v_mfma_f32_32x32x16_bf16 v[48:63], v[68:71], v[180:183], 0
    ds_read_b64_tr_b16 v[180:181], v235 offset:2048
    ds_read_b64_tr_b16 v[182:183], v235 offset:2560
    s_waitcnt lgkmcnt(2)
    v_mfma_f32_32x32x16_bf16 v[0:15], v[72:75], v[176:179], v[0:15]
    v_mfma_f32_32x32x16_bf16 v[16:31], v[76:79], v[176:179], v[16:31]
    v_lshl_add_u32 v224, v224, 10, v236
    v_lshl_add_u32 v225, v225, 10, v236
    s_waitcnt lgkmcnt(0)
    s_add_u32 m0, s29, 2048
    s_nop 0
    buffer_load_dwordx4 v224, s[4:7], s40 offen lds
    s_add_u32 m0, s29, 3072
    s_nop 0
    buffer_load_dwordx4 v225, s[4:7], s40 offen lds
    s_waitcnt vmcnt(6)
    ds_read_b64_tr_b16 v[176:177], v234 offset:4096
    ds_read_b64_tr_b16 v[178:179], v234 offset:4608
    v_mfma_f32_32x32x16_bf16 v[32:47], v[72:75], v[180:183], v[32:47]
    v_mfma_f32_32x32x16_bf16 v[48:63], v[76:79], v[180:183], v[48:63]
    ds_read_b64_tr_b16 v[180:181], v235 offset:4096
    ds_read_b64_tr_b16 v[182:183], v235 offset:4608
    v_mul_f32 v0, v0, v144
    v_fmac_f32 v0, v1, v145
    v_fmac_f32 v0, v2, v146
    v_fmac_f32 v0, v3, v147
    v_fmac_f32 v0, v4, v148
    v_fmac_f32 v0, v5, v149
    v_fmac_f32 v0, v6, v150
    v_fmac_f32 v0, v7, v151
    v_fmac_f32 v188, v8, v160
    v_fmac_f32 v188, v9, v161
    v_fmac_f32 v188, v10, v162
    v_fmac_f32 v188, v11, v163
    v_fmac_f32 v188, v12, v164
    v_fmac_f32 v188, v13, v165
    v_fmac_f32 v188, v14, v166
    v_fmac_f32 v188, v15, v167
    v_fmac_f32 v186, v16, v112
    v_fmac_f32 v186, v17, v113
    v_fmac_f32 v186, v18, v114
    v_fmac_f32 v186, v19, v115
    v_fmac_f32 v186, v20, v116
    v_fmac_f32 v186, v21, v117
    v_fmac_f32 v186, v22, v118
    v_fmac_f32 v186, v23, v119
    v_mul_f32_e64 v24, v24, -v160
    v_fma_f32 v24, v25, -v161, v24
    v_fma_f32 v24, v26, -v162, v24
    v_fma_f32 v24, v27, -v163, v24
    v_fma_f32 v24, v28, -v164, v24
    v_fma_f32 v24, v29, -v165, v24
    v_fma_f32 v24, v30, -v166, v24
    v_fma_f32 v24, v31, -v167, v24
    v_mul_f32 v32, v32, v152
    v_fmac_f32 v32, v33, v153
    v_fmac_f32 v32, v34, v154
    v_fmac_f32 v32, v35, v155
    v_fmac_f32 v32, v36, v156
    v_fmac_f32 v32, v37, v157
    v_fmac_f32 v32, v38, v158
    v_fmac_f32 v32, v39, v159
    v_fmac_f32 v189, v40, v168
    v_fmac_f32 v189, v41, v169
    v_fmac_f32 v189, v42, v170
    v_fmac_f32 v189, v43, v171
    v_fmac_f32 v189, v44, v172
    v_fmac_f32 v189, v45, v173
    v_fmac_f32 v189, v46, v174
    v_fmac_f32 v189, v47, v175
    v_fmac_f32 v187, v48, v120
    v_fmac_f32 v187, v49, v121
    v_fmac_f32 v187, v50, v122
    v_fmac_f32 v187, v51, v123
    v_fmac_f32 v187, v52, v124
    v_fmac_f32 v187, v53, v125
    v_fmac_f32 v187, v54, v126
    v_fmac_f32 v187, v55, v127
    v_mul_f32_e64 v56, v56, -v168
    v_fma_f32 v56, v57, -v169, v56
    v_fma_f32 v56, v58, -v170, v56
    v_fma_f32 v56, v59, -v171, v56
    v_fma_f32 v56, v60, -v172, v56
    v_fma_f32 v56, v61, -v173, v56
    v_fma_f32 v56, v62, -v174, v56
    v_fma_f32 v56, v63, -v175, v56
    s_nop 0
    s_nop 0
    v_permlane32_swap_b32 v184, v0
    v_permlane32_swap_b32 v185, v32
    v_add_f32 v0, v184, v0
    v_add_f32 v32, v185, v32
    v_mov_b32 v184, v24
    v_mov_b32 v185, v56
    s_set_gpr_idx_on s52, gpr_idx(DST)
    s_nop 0
    v_cvt_pk_bf16_f32 v194, v0, v32
    s_set_gpr_idx_off
    s_waitcnt lgkmcnt(2)
    v_mfma_f32_32x32x16_bf16 v[0:15], v[64:67], v[176:179], 0
    v_mfma_f32_32x32x16_bf16 v[16:31], v[68:71], v[176:179], 0
    v_lshl_add_u32 v226, v226, 10, v236
    v_lshl_add_u32 v227, v227, 10, v236
    s_waitcnt lgkmcnt(0)
    s_add_u32 m0, s29, 4096
    s_nop 0
    buffer_load_dwordx4 v226, s[4:7], s41 offen lds
    s_add_u32 m0, s29, 5120
    s_nop 0
    buffer_load_dwordx4 v227, s[4:7], s41 offen lds
    s_waitcnt vmcnt(6)
    ds_read_b64_tr_b16 v[176:177], v234 offset:6144
    ds_read_b64_tr_b16 v[178:179], v234 offset:6656
    v_mfma_f32_32x32x16_bf16 v[32:47], v[64:67], v[180:183], 0
    v_mfma_f32_32x32x16_bf16 v[48:63], v[68:71], v[180:183], 0
    ds_read_b64_tr_b16 v[180:181], v235 offset:6144
    ds_read_b64_tr_b16 v[182:183], v235 offset:6656
    s_waitcnt lgkmcnt(2)
    v_mfma_f32_32x32x16_bf16 v[0:15], v[72:75], v[176:179], v[0:15]
    v_mfma_f32_32x32x16_bf16 v[16:31], v[76:79], v[176:179], v[16:31]
    v_lshl_add_u32 v228, v228, 10, v236
    v_lshl_add_u32 v229, v229, 10, v236
    s_waitcnt lgkmcnt(0)
    s_add_u32 m0, s29, 6144
    s_nop 0
    buffer_load_dwordx4 v228, s[4:7], s42 offen lds
    s_add_u32 m0, s29, 7168
    s_nop 0
    buffer_load_dwordx4 v229, s[4:7], s42 offen lds
    s_waitcnt vmcnt(6)
    ds_read_b64_tr_b16 v[176:177], v234 offset:0
    ds_read_b64_tr_b16 v[178:179], v234 offset:512
    v_mfma_f32_32x32x16_bf16 v[32:47], v[72:75], v[180:183], v[32:47]
    v_mfma_f32_32x32x16_bf16 v[48:63], v[76:79], v[180:183], v[48:63]
    ds_read_b64_tr_b16 v[180:181], v235 offset:0
    ds_read_b64_tr_b16 v[182:183], v235 offset:512
    v_add_u32 v241, s49, v237
    v_add_u32 v242, s43, v238
    ds_read_b64_tr_b16 v[68:69], v241 offset:0
    ds_read_b64_tr_b16 v[70:71], v241 offset:128
    s_mov_b64 exec, s[54:55]
    ds_read_u16_d16_hi v230, v242 offset:0
    s_mov_b64 exec, -1
    v_mul_f32 v0, v0, v144
    v_fmac_f32 v0, v1, v145
    v_fmac_f32 v0, v2, v146
    v_fmac_f32 v0, v3, v147
    v_fmac_f32 v0, v4, v148
    v_fmac_f32 v0, v5, v149
    v_fmac_f32 v0, v6, v150
    v_fmac_f32 v0, v7, v151
    v_fma_f32 v190, v8, -v160, v190
    v_fma_f32 v190, v9, -v161, v190
    v_fma_f32 v190, v10, -v162, v190
    v_fma_f32 v190, v11, -v163, v190
    v_fma_f32 v190, v12, -v164, v190
    v_fma_f32 v190, v13, -v165, v190
    v_fma_f32 v190, v14, -v166, v190
    v_fma_f32 v190, v15, -v167, v190
    v_fmac_f32 v184, v16, v160
    v_fmac_f32 v184, v17, v161
    v_fmac_f32 v184, v18, v162
    v_fmac_f32 v184, v19, v163
    v_fmac_f32 v184, v20, v164
    v_fmac_f32 v184, v21, v165
    v_fmac_f32 v184, v22, v166
    v_fmac_f32 v184, v23, v167
    v_fmac_f32 v186, v24, v112
    v_fmac_f32 v186, v25, v113
    v_fmac_f32 v186, v26, v114
    v_fmac_f32 v186, v27, v115
    v_fmac_f32 v186, v28, v116
    v_fmac_f32 v186, v29, v117
    v_fmac_f32 v186, v30, v118
    v_fmac_f32 v186, v31, v119
    v_mul_f32 v32, v32, v152
    v_fmac_f32 v32, v33, v153
    v_fmac_f32 v32, v34, v154
    v_fmac_f32 v32, v35, v155
    v_fmac_f32 v32, v36, v156
    v_fmac_f32 v32, v37, v157
    v_fmac_f32 v32, v38, v158
    v_fmac_f32 v32, v39, v159
    v_fma_f32 v191, v40, -v168, v191
    v_fma_f32 v191, v41, -v169, v191
    v_fma_f32 v191, v42, -v170, v191
    v_fma_f32 v191, v43, -v171, v191
    v_fma_f32 v191, v44, -v172, v191
    v_fma_f32 v191, v45, -v173, v191
    v_fma_f32 v191, v46, -v174, v191
    v_fma_f32 v191, v47, -v175, v191
    v_fmac_f32 v185, v48, v168
    v_fmac_f32 v185, v49, v169
    v_fmac_f32 v185, v50, v170
    v_fmac_f32 v185, v51, v171
    v_fmac_f32 v185, v52, v172
    v_fmac_f32 v185, v53, v173
    v_fmac_f32 v185, v54, v174
    v_fmac_f32 v185, v55, v175
    v_fmac_f32 v187, v56, v120
    v_fmac_f32 v187, v57, v121
    v_fmac_f32 v187, v58, v122
    v_fmac_f32 v187, v59, v123
    v_fmac_f32 v187, v60, v124
    v_fmac_f32 v187, v61, v125
    v_fmac_f32 v187, v62, v126
    v_fmac_f32 v187, v63, v127
    s_nop 0
    s_nop 0
    v_permlane32_swap_b32 v0, v188
    v_permlane32_swap_b32 v190, v8
    v_permlane32_swap_b32 v186, v184
    v_permlane32_swap_b32 v32, v189
    v_permlane32_swap_b32 v191, v40
    v_permlane32_swap_b32 v187, v185
    v_add_f32 v188, v0, v188
    v_add_f32 v8, v190, v8
    v_add_f32 v184, v186, v184
    v_add_f32 v189, v32, v189
    v_add_f32 v40, v191, v40
    v_add_f32 v185, v187, v185
    s_set_gpr_idx_on s52, gpr_idx(DST)
    s_nop 0
    v_cvt_pk_bf16_f32 v195, v188, v189
    v_cvt_pk_bf16_f32 v197, v8, v40
    v_cvt_pk_bf16_f32 v196, v184, v185
    s_set_gpr_idx_off
    s_branch NEXT_0
.p2align 6
ITEM_0_3:
    ds_read_b64_tr_b16 v[76:77], v241 offset:512
    ds_read_b64_tr_b16 v[78:79], v241 offset:640
    s_mov_b64 exec, s[54:55]
    ds_read_u16_d16_hi v231, v242 offset:128
    s_mov_b64 exec, -1
    ds_read_b64_tr_b16 v[84:85], v241 offset:1024
    ds_read_b64_tr_b16 v[86:87], v241 offset:1152
    s_mov_b64 exec, s[54:55]
    ds_read_u16_d16_hi v232, v242 offset:256
    s_mov_b64 exec, -1
    v_add_u32 v244, s46, v239
    ds_read_u16 v228, v244
    ds_read_u16 v229, v244 offset:64
    v_add_u32 v245, s49, v248
    ds_read_b32 v246, v245
    ds_read_b32 v247, v245 offset:1024
    s_waitcnt lgkmcnt(10)
    v_lshlrev_b32 v184, 16, v68
    v_and_b32 v185, 0xffff0000, v68
    v_lshlrev_b32 v186, 16, v69
    v_and_b32 v187, 0xffff0000, v69
    v_mul_f32_dpp v188, v230, v184 row_newbcast:0 row_mask:0xf bank_mask:0xf
    v_mul_f32_dpp v189, v230, v185 row_newbcast:1 row_mask:0xf bank_mask:0xf
    v_mul_f32_dpp v190, v230, v184 row_newbcast:8 row_mask:0xf bank_mask:0xf
    v_mul_f32_dpp v191, v230, v185 row_newbcast:9 row_mask:0xf bank_mask:0xf
    v_lshlrev_b32 v184, 16, v70
    v_and_b32 v185, 0xffff0000, v70
    v_cvt_pk_bf16_f32 v64, v188, v189
    v_cvt_pk_bf16_f32 v68, v190, v191
    v_mul_f32_dpp v188, v230, v186 row_newbcast:2 row_mask:0xf bank_mask:0xf
    v_mul_f32_dpp v189, v230, v187 row_newbcast:3 row_mask:0xf bank_mask:0xf
    v_mul_f32_dpp v190, v230, v186 row_newbcast:10 row_mask:0xf bank_mask:0xf
    v_mul_f32_dpp v191, v230, v187 row_newbcast:11 row_mask:0xf bank_mask:0xf
    v_lshlrev_b32 v186, 16, v71
    v_and_b32 v187, 0xffff0000, v71
    v_cvt_pk_bf16_f32 v65, v188, v189
    v_cvt_pk_bf16_f32 v69, v190, v191
    v_mul_f32_dpp v188, v230, v184 row_newbcast:4 row_mask:0xf bank_mask:0xf
    v_mul_f32_dpp v189, v230, v185 row_newbcast:5 row_mask:0xf bank_mask:0xf
    v_mul_f32_dpp v190, v230, v184 row_newbcast:12 row_mask:0xf bank_mask:0xf
    v_mul_f32_dpp v191, v230, v185 row_newbcast:13 row_mask:0xf bank_mask:0xf
    v_cvt_pk_bf16_f32 v66, v188, v189
    v_cvt_pk_bf16_f32 v70, v190, v191
    v_mul_f32_dpp v188, v230, v186 row_newbcast:6 row_mask:0xf bank_mask:0xf
    v_mul_f32_dpp v189, v230, v187 row_newbcast:7 row_mask:0xf bank_mask:0xf
    v_mul_f32_dpp v190, v230, v186 row_newbcast:14 row_mask:0xf bank_mask:0xf
    v_mul_f32_dpp v191, v230, v187 row_newbcast:15 row_mask:0xf bank_mask:0xf
    v_cvt_pk_bf16_f32 v67, v188, v189
    v_cvt_pk_bf16_f32 v71, v190, v191
    s_nop 0
    s_waitcnt lgkmcnt(7)
    v_mfma_f32_32x32x16_bf16 v[0:15], v[64:67], v[176:179], 0
    v_lshlrev_b32 v184, 16, v76
    v_and_b32 v185, 0xffff0000, v76
    v_lshlrev_b32 v186, 16, v77
    v_and_b32 v187, 0xffff0000, v77
    v_mul_f32_dpp v188, v231, v184 row_newbcast:0 row_mask:0xf bank_mask:0xf
    v_mul_f32_dpp v189, v231, v185 row_newbcast:1 row_mask:0xf bank_mask:0xf
    v_mul_f32_dpp v190, v231, v184 row_newbcast:8 row_mask:0xf bank_mask:0xf
    v_mul_f32_dpp v191, v231, v185 row_newbcast:9 row_mask:0xf bank_mask:0xf
    v_mfma_f32_32x32x16_bf16 v[16:31], v[68:71], v[176:179], 0
    v_lshlrev_b32 v184, 16, v78
    v_and_b32 v185, 0xffff0000, v78
    v_cvt_pk_bf16_f32 v72, v188, v189
    v_cvt_pk_bf16_f32 v76, v190, v191
    v_mul_f32_dpp v188, v231, v186 row_newbcast:2 row_mask:0xf bank_mask:0xf
    v_mul_f32_dpp v189, v231, v187 row_newbcast:3 row_mask:0xf bank_mask:0xf
    v_mul_f32_dpp v190, v231, v186 row_newbcast:10 row_mask:0xf bank_mask:0xf
    v_mul_f32_dpp v191, v231, v187 row_newbcast:11 row_mask:0xf bank_mask:0xf
    s_add_u32 m0, s29, 0
    s_nop 0
    buffer_load_dwordx4 v224, s[4:7], s36 offen lds
    s_add_u32 m0, s29, 1024
    s_nop 0
    buffer_load_dwordx4 v225, s[4:7], s36 offen lds
    s_waitcnt lgkmcnt(0)
    v_lshl_add_u32 v246, v246, 5, v249
    v_lshl_add_u32 v247, v247, 5, v249
    s_mov_b32 m0, s60
    s_mov_b64 exec, s[56:57]
    buffer_load_dwordx4 v246, s[8:11], 0 offen  lds
    s_mov_b32 m0, s61
    s_mov_b64 exec, s[58:59]
    buffer_load_dwordx4 v247, s[8:11], 0 offen  lds
    s_mov_b64 exec, -1
    s_waitcnt vmcnt(8)
    ds_read_b64_tr_b16 v[176:177], v234 offset:2048
    ds_read_b64_tr_b16 v[178:179], v234 offset:2560
    v_mfma_f32_32x32x16_bf16 v[32:47], v[64:67], v[180:183], 0
    v_lshlrev_b32 v186, 16, v79
    v_and_b32 v187, 0xffff0000, v79
    v_cvt_pk_bf16_f32 v73, v188, v189
    v_cvt_pk_bf16_f32 v77, v190, v191
    v_mul_f32_dpp v188, v231, v184 row_newbcast:4 row_mask:0xf bank_mask:0xf
    v_mul_f32_dpp v189, v231, v185 row_newbcast:5 row_mask:0xf bank_mask:0xf
    v_mul_f32_dpp v190, v231, v184 row_newbcast:12 row_mask:0xf bank_mask:0xf
    v_mul_f32_dpp v191, v231, v185 row_newbcast:13 row_mask:0xf bank_mask:0xf
    v_mfma_f32_32x32x16_bf16 v[48:63], v[68:71], v[180:183], 0
    ds_read_b64_tr_b16 v[180:181], v235 offset:2048
    ds_read_b64_tr_b16 v[182:183], v235 offset:2560
    v_cvt_pk_bf16_f32 v74, v188, v189
    v_cvt_pk_bf16_f32 v78, v190, v191
    v_mul_f32_dpp v188, v231, v186 row_newbcast:6 row_mask:0xf bank_mask:0xf
    v_mul_f32_dpp v189, v231, v187 row_newbcast:7 row_mask:0xf bank_mask:0xf
    v_mul_f32_dpp v190, v231, v186 row_newbcast:14 row_mask:0xf bank_mask:0xf
    v_mul_f32_dpp v191, v231, v187 row_newbcast:15 row_mask:0xf bank_mask:0xf
    v_cvt_pk_bf16_f32 v75, v188, v189
    v_cvt_pk_bf16_f32 v79, v190, v191
    s_nop 0
    s_waitcnt lgkmcnt(2)
    v_mfma_f32_32x32x16_bf16 v[0:15], v[72:75], v[176:179], v[0:15]
    v_lshlrev_b32 v184, 16, v84
    v_and_b32 v185, 0xffff0000, v84
    v_lshlrev_b32 v186, 16, v85
    v_and_b32 v187, 0xffff0000, v85
    v_mul_f32_dpp v188, v232, v184 row_newbcast:0 row_mask:0xf bank_mask:0xf
    v_mul_f32_dpp v189, v232, v185 row_newbcast:1 row_mask:0xf bank_mask:0xf
    v_mul_f32_dpp v190, v232, v184 row_newbcast:8 row_mask:0xf bank_mask:0xf
    v_mul_f32_dpp v191, v232, v185 row_newbcast:9 row_mask:0xf bank_mask:0xf
    v_mfma_f32_32x32x16_bf16 v[16:31], v[76:79], v[176:179], v[16:31]
    v_lshlrev_b32 v184, 16, v86
    v_and_b32 v185, 0xffff0000, v86
    v_cvt_pk_bf16_f32 v80, v188, v189
    v_cvt_pk_bf16_f32 v84, v190, v191
    v_mul_f32_dpp v188, v232, v186 row_newbcast:2 row_mask:0xf bank_mask:0xf
    v_mul_f32_dpp v189, v232, v187 row_newbcast:3 row_mask:0xf bank_mask:0xf
    v_mul_f32_dpp v190, v232, v186 row_newbcast:10 row_mask:0xf bank_mask:0xf
    v_mul_f32_dpp v191, v232, v187 row_newbcast:11 row_mask:0xf bank_mask:0xf
    s_waitcnt lgkmcnt(0)
    s_add_u32 m0, s29, 2048
    s_nop 0
    buffer_load_dwordx4 v226, s[4:7], s36 offen lds
    s_add_u32 m0, s29, 3072
    s_nop 0
    buffer_load_dwordx4 v227, s[4:7], s36 offen lds
    s_waitcnt vmcnt(8)
    ds_read_b64_tr_b16 v[176:177], v234 offset:4096
    ds_read_b64_tr_b16 v[178:179], v234 offset:4608
    v_mfma_f32_32x32x16_bf16 v[32:47], v[72:75], v[180:183], v[32:47]
    v_lshlrev_b32 v186, 16, v87
    v_and_b32 v187, 0xffff0000, v87
    v_cvt_pk_bf16_f32 v81, v188, v189
    v_cvt_pk_bf16_f32 v85, v190, v191
    v_mul_f32_dpp v188, v232, v184 row_newbcast:4 row_mask:0xf bank_mask:0xf
    v_mul_f32_dpp v189, v232, v185 row_newbcast:5 row_mask:0xf bank_mask:0xf
    v_mul_f32_dpp v190, v232, v184 row_newbcast:12 row_mask:0xf bank_mask:0xf
    v_mul_f32_dpp v191, v232, v185 row_newbcast:13 row_mask:0xf bank_mask:0xf
    v_mfma_f32_32x32x16_bf16 v[48:63], v[76:79], v[180:183], v[48:63]
    ds_read_b64_tr_b16 v[180:181], v235 offset:4096
    ds_read_b64_tr_b16 v[182:183], v235 offset:4608
    v_cvt_pk_bf16_f32 v82, v188, v189
    v_cvt_pk_bf16_f32 v86, v190, v191
    v_mul_f32_dpp v188, v232, v186 row_newbcast:6 row_mask:0xf bank_mask:0xf
    v_mul_f32_dpp v189, v232, v187 row_newbcast:7 row_mask:0xf bank_mask:0xf
    v_mul_f32_dpp v190, v232, v186 row_newbcast:14 row_mask:0xf bank_mask:0xf
    v_mul_f32_dpp v191, v232, v187 row_newbcast:15 row_mask:0xf bank_mask:0xf
    v_cvt_pk_bf16_f32 v83, v188, v189
    v_cvt_pk_bf16_f32 v87, v190, v191
    s_nop 0
    s_waitcnt lgkmcnt(2)
    v_mfma_f32_32x32x16_bf16 v[0:15], v[80:83], v[176:179], v[0:15]
    v_mfma_f32_32x32x16_bf16 v[16:31], v[84:87], v[176:179], v[16:31]
    s_waitcnt lgkmcnt(0)
    s_add_u32 m0, s29, 4096
    s_nop 0
    buffer_load_dwordx4 v222, s[4:7], s37 offen lds
    s_add_u32 m0, s29, 5120
    s_nop 0
    buffer_load_dwordx4 v223, s[4:7], s37 offen lds
    s_waitcnt vmcnt(8)
    ds_read_b64_tr_b16 v[176:177], v234 offset:6144
    ds_read_b64_tr_b16 v[178:179], v234 offset:6656
    v_mfma_f32_32x32x16_bf16 v[32:47], v[80:83], v[180:183], v[32:47]
    v_mfma_f32_32x32x16_bf16 v[48:63], v[84:87], v[180:183], v[48:63]
    ds_read_b64_tr_b16 v[180:181], v235 offset:6144
    ds_read_b64_tr_b16 v[182:183], v235 offset:6656
    v_mul_f32 v0, v0, v96
    v_fmac_f32 v0, v1, v97
    v_fmac_f32 v0, v2, v98
    v_fmac_f32 v0, v3, v99
    v_fmac_f32 v0, v4, v100
    v_fmac_f32 v0, v5, v101
    v_fmac_f32 v0, v6, v102
    v_fmac_f32 v0, v7, v103
    v_mul_f32 v8, v8, v128
    v_fmac_f32 v8, v9, v129
    v_fmac_f32 v8, v10, v130
    v_fmac_f32 v8, v11, v131
    v_fmac_f32 v8, v12, v132
    v_fmac_f32 v8, v13, v133
    v_fmac_f32 v8, v14, v134
    v_fmac_f32 v8, v15, v135
    v_mul_f32 v16, v16, v128
    v_fmac_f32 v16, v17, v129
    v_fmac_f32 v16, v18, v130
    v_fmac_f32 v16, v19, v131
    v_fmac_f32 v16, v20, v132
    v_fmac_f32 v16, v21, v133
    v_fmac_f32 v16, v22, v134
    v_fmac_f32 v16, v23, v135
    v_mul_f32 v24, v24, v128
    v_fmac_f32 v24, v25, v129
    v_fmac_f32 v24, v26, v130
    v_fmac_f32 v24, v27, v131
    v_fmac_f32 v24, v28, v132
    v_fmac_f32 v24, v29, v133
    v_fmac_f32 v24, v30, v134
    v_fmac_f32 v24, v31, v135
    v_mul_f32 v32, v32, v104
    v_fmac_f32 v32, v33, v105
    v_fmac_f32 v32, v34, v106
    v_fmac_f32 v32, v35, v107
    v_fmac_f32 v32, v36, v108
    v_fmac_f32 v32, v37, v109
    v_fmac_f32 v32, v38, v110
    v_fmac_f32 v32, v39, v111
    v_mul_f32 v40, v40, v136
    v_fmac_f32 v40, v41, v137
    v_fmac_f32 v40, v42, v138
    v_fmac_f32 v40, v43, v139
    v_fmac_f32 v40, v44, v140
    v_fmac_f32 v40, v45, v141
    v_fmac_f32 v40, v46, v142
    v_fmac_f32 v40, v47, v143
    v_mul_f32 v48, v48, v136
    v_fmac_f32 v48, v49, v137
    v_fmac_f32 v48, v50, v138
    v_fmac_f32 v48, v51, v139
    v_fmac_f32 v48, v52, v140
    v_fmac_f32 v48, v53, v141
    v_fmac_f32 v48, v54, v142
    v_fmac_f32 v48, v55, v143
    v_mul_f32 v56, v56, v136
    v_fmac_f32 v56, v57, v137
    v_fmac_f32 v56, v58, v138
    v_fmac_f32 v56, v59, v139
    v_fmac_f32 v56, v60, v140
    v_fmac_f32 v56, v61, v141
    v_fmac_f32 v56, v62, v142
    v_fmac_f32 v56, v63, v143
    s_nop 0
    v_permlane32_swap_b32 v0, v8
    v_permlane32_swap_b32 v16, v24
    v_permlane32_swap_b32 v32, v40
    v_permlane32_swap_b32 v48, v56
    v_add_f32 v8, v0, v8
    v_add_f32 v24, v16, v24
    v_add_f32 v40, v32, v40
    v_add_f32 v56, v48, v56
    s_set_gpr_idx_on s52, gpr_idx(DST)
    s_nop 0
    v_cvt_pk_bf16_f32 v192, v8, v40
    v_cvt_pk_bf16_f32 v193, v24, v56
    s_set_gpr_idx_off
    s_waitcnt lgkmcnt(2)
    v_mfma_f32_32x32x16_bf16 v[0:15], v[64:67], v[176:179], 0
    v_mfma_f32_32x32x16_bf16 v[16:31], v[68:71], v[176:179], 0
    s_waitcnt lgkmcnt(0)
    s_add_u32 m0, s29, 6144
    s_nop 0
    buffer_load_dwordx4 v224, s[4:7], s37 offen lds
    s_add_u32 m0, s29, 7168
    s_nop 0
    buffer_load_dwordx4 v225, s[4:7], s37 offen lds
    s_waitcnt vmcnt(8)
    ds_read_b64_tr_b16 v[176:177], v234 offset:0
    ds_read_b64_tr_b16 v[178:179], v234 offset:512
    v_mfma_f32_32x32x16_bf16 v[32:47], v[64:67], v[180:183], 0
    v_mfma_f32_32x32x16_bf16 v[48:63], v[68:71], v[180:183], 0
    ds_read_b64_tr_b16 v[180:181], v235 offset:0
    ds_read_b64_tr_b16 v[182:183], v235 offset:512
    s_waitcnt lgkmcnt(2)
    v_mfma_f32_32x32x16_bf16 v[0:15], v[72:75], v[176:179], v[0:15]
    v_mfma_f32_32x32x16_bf16 v[16:31], v[76:79], v[176:179], v[16:31]
    s_waitcnt lgkmcnt(0)
    s_add_u32 m0, s29, 0
    s_nop 0
    buffer_load_dwordx4 v226, s[4:7], s37 offen lds
    s_add_u32 m0, s29, 1024
    s_nop 0
    buffer_load_dwordx4 v227, s[4:7], s37 offen lds
    s_waitcnt vmcnt(6)
    ds_read_b64_tr_b16 v[176:177], v234 offset:2048
    ds_read_b64_tr_b16 v[178:179], v234 offset:2560
    v_mfma_f32_32x32x16_bf16 v[32:47], v[72:75], v[180:183], v[32:47]
    v_mfma_f32_32x32x16_bf16 v[48:63], v[76:79], v[180:183], v[48:63]
    ds_read_b64_tr_b16 v[180:181], v235 offset:2048
    ds_read_b64_tr_b16 v[182:183], v235 offset:2560
    s_waitcnt lgkmcnt(2)
    v_mfma_f32_32x32x16_bf16 v[0:15], v[80:83], v[176:179], v[0:15]
    v_mfma_f32_32x32x16_bf16 v[16:31], v[84:87], v[176:179], v[16:31]
    s_waitcnt lgkmcnt(0)
    s_add_u32 m0, s29, 2048
    s_nop 0
    buffer_load_dwordx4 v222, s[4:7], s38 offen lds
    s_add_u32 m0, s29, 3072
    s_nop 0
    buffer_load_dwordx4 v223, s[4:7], s38 offen lds
    v_add_u32 v244, s43, v239
    ds_read_u16 v222, v244
    ds_read_u16 v223, v244 offset:64
    s_waitcnt vmcnt(6)
    ds_read_b64_tr_b16 v[176:177], v234 offset:4096
    ds_read_b64_tr_b16 v[178:179], v234 offset:4608
    v_mfma_f32_32x32x16_bf16 v[32:47], v[80:83], v[180:183], v[32:47]
    v_mfma_f32_32x32x16_bf16 v[48:63], v[84:87], v[180:183], v[48:63]
    ds_read_b64_tr_b16 v[180:181], v235 offset:4096
    ds_read_b64_tr_b16 v[182:183], v235 offset:4608
    v_mul_f32 v184, v0, v144
    v_fmac_f32 v184, v1, v145
    v_fmac_f32 v184, v2, v146
    v_fmac_f32 v184, v3, v147
    v_fmac_f32 v184, v4, v148
    v_fmac_f32 v184, v5, v149
    v_fmac_f32 v184, v6, v150
    v_fmac_f32 v184, v7, v151
    v_mul_f32 v186, v8, v112
    v_fmac_f32 v186, v9, v113
    v_fmac_f32 v186, v10, v114
    v_fmac_f32 v186, v11, v115
    v_fmac_f32 v186, v12, v116
    v_fmac_f32 v186, v13, v117
    v_fmac_f32 v186, v14, v118
    v_fmac_f32 v186, v15, v119
    v_mul_f32_e64 v188, v16, -v160
    v_fma_f32 v188, v17, -v161, v188
    v_fma_f32 v188, v18, -v162, v188
    v_fma_f32 v188, v19, -v163, v188
    v_fma_f32 v188, v20, -v164, v188
    v_fma_f32 v188, v21, -v165, v188
    v_fma_f32 v188, v22, -v166, v188
    v_fma_f32 v188, v23, -v167, v188
    v_mul_f32 v190, v24, v160
    v_fmac_f32 v190, v25, v161
    v_fmac_f32 v190, v26, v162
    v_fmac_f32 v190, v27, v163
    v_fmac_f32 v190, v28, v164
    v_fmac_f32 v190, v29, v165
    v_fmac_f32 v190, v30, v166
    v_fmac_f32 v190, v31, v167
    v_mul_f32 v185, v32, v152
    v_fmac_f32 v185, v33, v153
    v_fmac_f32 v185, v34, v154
    v_fmac_f32 v185, v35, v155
    v_fmac_f32 v185, v36, v156
    v_fmac_f32 v185, v37, v157
    v_fmac_f32 v185, v38, v158
    v_fmac_f32 v185, v39, v159
    v_mul_f32 v187, v40, v120
    v_fmac_f32 v187, v41, v121
    v_fmac_f32 v187, v42, v122
    v_fmac_f32 v187, v43, v123
    v_fmac_f32 v187, v44, v124
    v_fmac_f32 v187, v45, v125
    v_fmac_f32 v187, v46, v126
    v_fmac_f32 v187, v47, v127
    v_mul_f32_e64 v189, v48, -v168
    v_fma_f32 v189, v49, -v169, v189
    v_fma_f32 v189, v50, -v170, v189
    v_fma_f32 v189, v51, -v171, v189
    v_fma_f32 v189, v52, -v172, v189
    v_fma_f32 v189, v53, -v173, v189
    v_fma_f32 v189, v54, -v174, v189
    v_fma_f32 v189, v55, -v175, v189
    v_mul_f32 v191, v56, v168
    v_fmac_f32 v191, v57, v169
    v_fmac_f32 v191, v58, v170
    v_fmac_f32 v191, v59, v171
    v_fmac_f32 v191, v60, v172
    v_fmac_f32 v191, v61, v173
    v_fmac_f32 v191, v62, v174
    v_fmac_f32 v191, v63, v175
    s_waitcnt lgkmcnt(2)
    v_mfma_f32_32x32x16_bf16 v[0:15], v[64:67], v[176:179], 0
    v_mfma_f32_32x32x16_bf16 v[16:31], v[68:71], v[176:179], 0
    s_waitcnt lgkmcnt(0)
    s_add_u32 m0, s29, 4096
    s_nop 0
    buffer_load_dwordx4 v224, s[4:7], s38 offen lds
    s_add_u32 m0, s29, 5120
    s_nop 0
    buffer_load_dwordx4 v225, s[4:7], s38 offen lds
    v_add_u32 v244, s44, v239
    ds_read_u16 v224, v244
    ds_read_u16 v225, v244 offset:64
    s_waitcnt vmcnt(6)
    ds_read_b64_tr_b16 v[176:177], v234 offset:6144
    ds_read_b64_tr_b16 v[178:179], v234 offset:6656
    v_mfma_f32_32x32x16_bf16 v[32:47], v[64:67], v[180:183], 0
    v_mfma_f32_32x32x16_bf16 v[48:63], v[68:71], v[180:183], 0
    ds_read_b64_tr_b16 v[180:181], v235 offset:6144
    ds_read_b64_tr_b16 v[182:183], v235 offset:6656
    s_waitcnt lgkmcnt(2)
    v_mfma_f32_32x32x16_bf16 v[0:15], v[72:75], v[176:179], v[0:15]
    v_mfma_f32_32x32x16_bf16 v[16:31], v[76:79], v[176:179], v[16:31]
    s_waitcnt lgkmcnt(0)
    s_add_u32 m0, s29, 6144
    s_nop 0
    buffer_load_dwordx4 v226, s[4:7], s38 offen lds
    s_add_u32 m0, s29, 7168
    s_nop 0
    buffer_load_dwordx4 v227, s[4:7], s38 offen lds
    v_add_u32 v244, s45, v239
    ds_read_u16 v226, v244
    ds_read_u16 v227, v244 offset:64
    s_waitcnt vmcnt(6)
    ds_read_b64_tr_b16 v[176:177], v234 offset:0
    ds_read_b64_tr_b16 v[178:179], v234 offset:512
    v_mfma_f32_32x32x16_bf16 v[32:47], v[72:75], v[180:183], v[32:47]
    v_mfma_f32_32x32x16_bf16 v[48:63], v[76:79], v[180:183], v[48:63]
    ds_read_b64_tr_b16 v[180:181], v235 offset:0
    ds_read_b64_tr_b16 v[182:183], v235 offset:512
    s_waitcnt lgkmcnt(2)
    v_mfma_f32_32x32x16_bf16 v[0:15], v[80:83], v[176:179], v[0:15]
    v_mfma_f32_32x32x16_bf16 v[16:31], v[84:87], v[176:179], v[16:31]
    v_lshl_add_u32 v222, v222, 10, v236
    v_lshl_add_u32 v223, v223, 10, v236
    s_waitcnt lgkmcnt(0)
    s_add_u32 m0, s29, 0
    s_nop 0
    buffer_load_dwordx4 v222, s[4:7], s39 offen lds
    s_add_u32 m0, s29, 1024
    s_nop 0
    buffer_load_dwordx4 v223, s[4:7], s39 offen lds
    s_waitcnt vmcnt(6)
    ds_read_b64_tr_b16 v[176:177], v234 offset:2048
    ds_read_b64_tr_b16 v[178:179], v234 offset:2560
    v_mfma_f32_32x32x16_bf16 v[32:47], v[80:83], v[180:183], v[32:47]
    v_mfma_f32_32x32x16_bf16 v[48:63], v[84:87], v[180:183], v[48:63]
    ds_read_b64_tr_b16 v[180:181], v235 offset:2048
    ds_read_b64_tr_b16 v[182:183], v235 offset:2560
    v_mul_f32 v0, v0, v144
    v_fmac_f32 v0, v1, v145
    v_fmac_f32 v0, v2, v146
    v_fmac_f32 v0, v3, v147
    v_fmac_f32 v0, v4, v148
    v_fmac_f32 v0, v5, v149
    v_fmac_f32 v0, v6, v150
    v_fmac_f32 v0, v7, v151
    v_fmac_f32 v188, v8, v160
    v_fmac_f32 v188, v9, v161
    v_fmac_f32 v188, v10, v162
    v_fmac_f32 v188, v11, v163
    v_fmac_f32 v188, v12, v164
    v_fmac_f32 v188, v13, v165
    v_fmac_f32 v188, v14, v166
    v_fmac_f32 v188, v15, v167
    v_fmac_f32 v186, v16, v112
    v_fmac_f32 v186, v17, v113
    v_fmac_f32 v186, v18, v114
    v_fmac_f32 v186, v19, v115
    v_fmac_f32 v186, v20, v116
    v_fmac_f32 v186, v21, v117
    v_fmac_f32 v186, v22, v118
    v_fmac_f32 v186, v23, v119
    v_mul_f32_e64 v24, v24, -v160
    v_fma_f32 v24, v25, -v161, v24
    v_fma_f32 v24, v26, -v162, v24
    v_fma_f32 v24, v27, -v163, v24
    v_fma_f32 v24, v28, -v164, v24
    v_fma_f32 v24, v29, -v165, v24
    v_fma_f32 v24, v30, -v166, v24
    v_fma_f32 v24, v31, -v167, v24
    v_mul_f32 v32, v32, v152
    v_fmac_f32 v32, v33, v153
    v_fmac_f32 v32, v34, v154
    v_fmac_f32 v32, v35, v155
    v_fmac_f32 v32, v36, v156
    v_fmac_f32 v32, v37, v157
    v_fmac_f32 v32, v38, v158
    v_fmac_f32 v32, v39, v159
    v_fmac_f32 v189, v40, v168
    v_fmac_f32 v189, v41, v169
    v_fmac_f32 v189, v42, v170
    v_fmac_f32 v189, v43, v171
    v_fmac_f32 v189, v44, v172
    v_fmac_f32 v189, v45, v173
    v_fmac_f32 v189, v46, v174
    v_fmac_f32 v189, v47, v175
    v_fmac_f32 v187, v48, v120
    v_fmac_f32 v187, v49, v121
    v_fmac_f32 v187, v50, v122
    v_fmac_f32 v187, v51, v123
    v_fmac_f32 v187, v52, v124
    v_fmac_f32 v187, v53, v125
    v_fmac_f32 v187, v54, v126
    v_fmac_f32 v187, v55, v127
    v_mul_f32_e64 v56, v56, -v168
    v_fma_f32 v56, v57, -v169, v56
    v_fma_f32 v56, v58, -v170, v56
    v_fma_f32 v56, v59, -v171, v56
    v_fma_f32 v56, v60, -v172, v56
    v_fma_f32 v56, v61, -v173, v56
    v_fma_f32 v56, v62, -v174, v56
    v_fma_f32 v56, v63, -v175, v56
    s_nop 0
    s_nop 0
    v_permlane32_swap_b32 v184, v0
    v_permlane32_swap_b32 v185, v32
    v_add_f32 v0, v184, v0
    v_add_f32 v32, v185, v32
    v_mov_b32 v184, v24
    v_mov_b32 v185, v56
    s_set_gpr_idx_on s52, gpr_idx(DST)
    s_nop 0
    v_cvt_pk_bf16_f32 v194, v0, v32
    s_set_gpr_idx_off
    s_waitcnt lgkmcnt(2)
    v_mfma_f32_32x32x16_bf16 v[0:15], v[64:67], v[176:179], 0
    v_mfma_f32_32x32x16_bf16 v[16:31], v[68:71], v[176:179], 0
    v_lshl_add_u32 v224, v224, 10, v236
    v_lshl_add_u32 v225, v225, 10, v236
    s_waitcnt lgkmcnt(0)
    s_add_u32 m0, s29, 2048
    s_nop 0
    buffer_load_dwordx4 v224, s[4:7], s40 offen lds
    s_add_u32 m0, s29, 3072
    s_nop 0
    buffer_load_dwordx4 v225, s[4:7], s40 offen lds
    s_waitcnt vmcnt(6)
    ds_read_b64_tr_b16 v[176:177], v234 offset:4096
    ds_read_b64_tr_b16 v[178:179], v234 offset:4608
    v_mfma_f32_32x32x16_bf16 v[32:47], v[64:67], v[180:183], 0
    v_mfma_f32_32x32x16_bf16 v[48:63], v[68:71], v[180:183], 0
    ds_read_b64_tr_b16 v[180:181], v235 offset:4096
    ds_read_b64_tr_b16 v[182:183], v235 offset:4608
    s_waitcnt lgkmcnt(2)
    v_mfma_f32_32x32x16_bf16 v[0:15], v[72:75], v[176:179], v[0:15]
    v_mfma_f32_32x32x16_bf16 v[16:31], v[76:79], v[176:179], v[16:31]
    v_lshl_add_u32 v226, v226, 10, v236
    v_lshl_add_u32 v227, v227, 10, v236
    s_waitcnt lgkmcnt(0)
    s_add_u32 m0, s29, 4096
    s_nop 0
    buffer_load_dwordx4 v226, s[4:7], s41 offen lds
    s_add_u32 m0, s29, 5120
    s_nop 0
    buffer_load_dwordx4 v227, s[4:7], s41 offen lds
    s_waitcnt vmcnt(6)
    ds_read_b64_tr_b16 v[176:177], v234 offset:6144
    ds_read_b64_tr_b16 v[178:179], v234 offset:6656
    v_mfma_f32_32x32x16_bf16 v[32:47], v[72:75], v[180:183], v[32:47]
    v_mfma_f32_32x32x16_bf16 v[48:63], v[76:79], v[180:183], v[48:63]
    ds_read_b64_tr_b16 v[180:181], v235 offset:6144
    ds_read_b64_tr_b16 v[182:183], v235 offset:6656
    s_waitcnt lgkmcnt(2)
    v_mfma_f32_32x32x16_bf16 v[0:15], v[80:83], v[176:179], v[0:15]
    v_mfma_f32_32x32x16_bf16 v[16:31], v[84:87], v[176:179], v[16:31]
    v_lshl_add_u32 v228, v228, 10, v236
    v_lshl_add_u32 v229, v229, 10, v236
    s_waitcnt lgkmcnt(0)
    s_add_u32 m0, s29, 6144
    s_nop 0
    buffer_load_dwordx4 v228, s[4:7], s42 offen lds
    s_add_u32 m0, s29, 7168
    s_nop 0
    buffer_load_dwordx4 v229, s[4:7], s42 offen lds
    s_waitcnt vmcnt(6)
    ds_read_b64_tr_b16 v[176:177], v234 offset:0
    ds_read_b64_tr_b16 v[178:179], v234 offset:512
    v_mfma_f32_32x32x16_bf16 v[32:47], v[80:83], v[180:183], v[32:47]
    v_mfma_f32_32x32x16_bf16 v[48:63], v[84:87], v[180:183], v[48:63]
    ds_read_b64_tr_b16 v[180:181], v235 offset:0
    ds_read_b64_tr_b16 v[182:183], v235 offset:512
    v_add_u32 v241, s49, v237
    v_add_u32 v242, s43, v238
    ds_read_b64_tr_b16 v[68:69], v241 offset:0
    ds_read_b64_tr_b16 v[70:71], v241 offset:128
    s_mov_b64 exec, s[54:55]
    ds_read_u16_d16_hi v230, v242 offset:0
    s_mov_b64 exec, -1
    v_mul_f32 v0, v0, v144
    v_fmac_f32 v0, v1, v145
    v_fmac_f32 v0, v2, v146
    v_fmac_f32 v0, v3, v147
    v_fmac_f32 v0, v4, v148
    v_fmac_f32 v0, v5, v149
    v_fmac_f32 v0, v6, v150
    v_fmac_f32 v0, v7, v151
    v_fma_f32 v190, v8, -v160, v190
    v_fma_f32 v190, v9, -v161, v190
    v_fma_f32 v190, v10, -v162, v190
    v_fma_f32 v190, v11, -v163, v190
    v_fma_f32 v190, v12, -v164, v190
    v_fma_f32 v190, v13, -v165, v190
    v_fma_f32 v190, v14, -v166, v190
    v_fma_f32 v190, v15, -v167, v190
    v_fmac_f32 v184, v16, v160
    v_fmac_f32 v184, v17, v161
    v_fmac_f32 v184, v18, v162
    v_fmac_f32 v184, v19, v163
    v_fmac_f32 v184, v20, v164
    v_fmac_f32 v184, v21, v165
    v_fmac_f32 v184, v22, v166
    v_fmac_f32 v184, v23, v167
    v_fmac_f32 v186, v24, v112
    v_fmac_f32 v186, v25, v113
    v_fmac_f32 v186, v26, v114
    v_fmac_f32 v186, v27, v115
    v_fmac_f32 v186, v28, v116
    v_fmac_f32 v186, v29, v117
    v_fmac_f32 v186, v30, v118
    v_fmac_f32 v186, v31, v119
    v_mul_f32 v32, v32, v152
    v_fmac_f32 v32, v33, v153
    v_fmac_f32 v32, v34, v154
    v_fmac_f32 v32, v35, v155
    v_fmac_f32 v32, v36, v156
    v_fmac_f32 v32, v37, v157
    v_fmac_f32 v32, v38, v158
    v_fmac_f32 v32, v39, v159
    v_fma_f32 v191, v40, -v168, v191
    v_fma_f32 v191, v41, -v169, v191
    v_fma_f32 v191, v42, -v170, v191
    v_fma_f32 v191, v43, -v171, v191
    v_fma_f32 v191, v44, -v172, v191
    v_fma_f32 v191, v45, -v173, v191
    v_fma_f32 v191, v46, -v174, v191
    v_fma_f32 v191, v47, -v175, v191
    v_fmac_f32 v185, v48, v168
    v_fmac_f32 v185, v49, v169
    v_fmac_f32 v185, v50, v170
    v_fmac_f32 v185, v51, v171
    v_fmac_f32 v185, v52, v172
    v_fmac_f32 v185, v53, v173
    v_fmac_f32 v185, v54, v174
    v_fmac_f32 v185, v55, v175
    v_fmac_f32 v187, v56, v120
    v_fmac_f32 v187, v57, v121
    v_fmac_f32 v187, v58, v122
    v_fmac_f32 v187, v59, v123
    v_fmac_f32 v187, v60, v124
    v_fmac_f32 v187, v61, v125
    v_fmac_f32 v187, v62, v126
    v_fmac_f32 v187, v63, v127
    s_nop 0
    s_nop 0
    v_permlane32_swap_b32 v0, v188
    v_permlane32_swap_b32 v190, v8
    v_permlane32_swap_b32 v186, v184
    v_permlane32_swap_b32 v32, v189
    v_permlane32_swap_b32 v191, v40
    v_permlane32_swap_b32 v187, v185
    v_add_f32 v188, v0, v188
    v_add_f32 v8, v190, v8
    v_add_f32 v184, v186, v184
    v_add_f32 v189, v32, v189
    v_add_f32 v40, v191, v40
    v_add_f32 v185, v187, v185
    s_set_gpr_idx_on s52, gpr_idx(DST)
    s_nop 0
    v_cvt_pk_bf16_f32 v195, v188, v189
    v_cvt_pk_bf16_f32 v197, v8, v40
    v_cvt_pk_bf16_f32 v196, v184, v185
    s_set_gpr_idx_off
    s_branch NEXT_0
.p2align 6
ITEM_0_4:
    ds_read_b64_tr_b16 v[76:77], v241 offset:512
    ds_read_b64_tr_b16 v[78:79], v241 offset:640
    s_mov_b64 exec, s[54:55]
    ds_read_u16_d16_hi v231, v242 offset:128
    s_mov_b64 exec, -1
    ds_read_b64_tr_b16 v[84:85], v241 offset:1024
    ds_read_b64_tr_b16 v[86:87], v241 offset:1152
    s_mov_b64 exec, s[54:55]
    ds_read_u16_d16_hi v232, v242 offset:256
    s_mov_b64 exec, -1
    ds_read_b64_tr_b16 v[92:93], v241 offset:1536
    ds_read_b64_tr_b16 v[94:95], v241 offset:1664
    s_mov_b64 exec, s[54:55]
    ds_read_u16_d16_hi v233, v242 offset:384
    s_mov_b64 exec, -1
    v_add_u32 v245, s49, v248
    ds_read_b32 v246, v245
    ds_read_b32 v247, v245 offset:1024
    s_waitcnt lgkmcnt(11)
    v_lshlrev_b32 v184, 16, v68
    v_and_b32 v185, 0xffff0000, v68
    v_lshlrev_b32 v186, 16, v69
    v_and_b32 v187, 0xffff0000, v69
    v_mul_f32_dpp v188, v230, v184 row_newbcast:0 row_mask:0xf bank_mask:0xf
    v_mul_f32_dpp v189, v230, v185 row_newbcast:1 row_mask:0xf bank_mask:0xf
    v_mul_f32_dpp v190, v230, v184 row_newbcast:8 row_mask:0xf bank_mask:0xf
    v_mul_f32_dpp v191, v230, v185 row_newbcast:9 row_mask:0xf bank_mask:0xf
    v_lshlrev_b32 v184, 16, v70
    v_and_b32 v185, 0xffff0000, v70
    v_cvt_pk_bf16_f32 v64, v188, v189
    v_cvt_pk_bf16_f32 v68, v190, v191
    v_mul_f32_dpp v188, v230, v186 row_newbcast:2 row_mask:0xf bank_mask:0xf
    v_mul_f32_dpp v189, v230, v187 row_newbcast:3 row_mask:0xf bank_mask:0xf
    v_mul_f32_dpp v190, v230, v186 row_newbcast:10 row_mask:0xf bank_mask:0xf
    v_mul_f32_dpp v191, v230, v187 row_newbcast:11 row_mask:0xf bank_mask:0xf
    v_lshlrev_b32 v186, 16, v71
    v_and_b32 v187, 0xffff0000, v71
    v_cvt_pk_bf16_f32 v65, v188, v189
    v_cvt_pk_bf16_f32 v69, v190, v191
    v_mul_f32_dpp v188, v230, v184 row_newbcast:4 row_mask:0xf bank_mask:0xf
    v_mul_f32_dpp v189, v230, v185 row_newbcast:5 row_mask:0xf bank_mask:0xf
    v_mul_f32_dpp v190, v230, v184 row_newbcast:12 row_mask:0xf bank_mask:0xf
    v_mul_f32_dpp v191, v230, v185 row_newbcast:13 row_mask:0xf bank_mask:0xf
    v_cvt_pk_bf16_f32 v66, v188, v189
    v_cvt_pk_bf16_f32 v70, v190, v191
    v_mul_f32_dpp v188, v230, v186 row_newbcast:6 row_mask:0xf bank_mask:0xf
    v_mul_f32_dpp v189, v230, v187 row_newbcast:7 row_mask:0xf bank_mask:0xf
    v_mul_f32_dpp v190, v230, v186 row_newbcast:14 row_mask:0xf bank_mask:0xf
    v_mul_f32_dpp v191, v230, v187 row_newbcast:15 row_mask:0xf bank_mask:0xf
    v_cvt_pk_bf16_f32 v67, v188, v189
    v_cvt_pk_bf16_f32 v71, v190, v191
    s_nop 0
    s_waitcnt lgkmcnt(8)
    v_mfma_f32_32x32x16_bf16 v[0:15], v[64:67], v[176:179], 0
    v_lshlrev_b32 v184, 16, v76
    v_and_b32 v185, 0xffff0000, v76
    v_lshlrev_b32 v186, 16, v77
    v_and_b32 v187, 0xffff0000, v77
    v_mul_f32_dpp v188, v231, v184 row_newbcast:0 row_mask:0xf bank_mask:0xf
    v_mul_f32_dpp v189, v231, v185 row_newbcast:1 row_mask:0xf bank_mask:0xf
    v_mul_f32_dpp v190, v231, v184 row_newbcast:8 row_mask:0xf bank_mask:0xf
    v_mul_f32_dpp v191, v231, v185 row_newbcast:9 row_mask:0xf bank_mask:0xf
    v_mfma_f32_32x32x16_bf16 v[16:31], v[68:71], v[176:179], 0
    v_lshlrev_b32 v184, 16, v78
    v_and_b32 v185, 0xffff0000, v78
    v_cvt_pk_bf16_f32 v72, v188, v189
    v_cvt_pk_bf16_f32 v76, v190, v191
    v_mul_f32_dpp v188, v231, v186 row_newbcast:2 row_mask:0xf bank_mask:0xf
    v_mul_f32_dpp v189, v231, v187 row_newbcast:3 row_mask:0xf bank_mask:0xf
    v_mul_f32_dpp v190, v231, v186 row_newbcast:10 row_mask:0xf bank_mask:0xf
    v_mul_f32_dpp v191, v231, v187 row_newbcast:11 row_mask:0xf bank_mask:0xf
    s_add_u32 m0, s29, 0
    s_nop 0
    buffer_load_dwordx4 v222, s[4:7], s36 offen lds
    s_add_u32 m0, s29, 1024
    s_nop 0
    buffer_load_dwordx4 v223, s[4:7], s36 offen lds
    s_waitcnt lgkmcnt(0)
    v_lshl_add_u32 v246, v246, 5, v249
    v_lshl_add_u32 v247, v247, 5, v249
    s_mov_b32 m0, s60
    s_mov_b64 exec, s[56:57]
    buffer_load_dwordx4 v246, s[8:11], 0 offen  lds
    s_mov_b32 m0, s61
    s_mov_b64 exec, s[58:59]
    buffer_load_dwordx4 v247, s[8:11], 0 offen  lds
    s_mov_b64 exec, -1
    s_waitcnt vmcnt(8)
    ds_read_b64_tr_b16 v[176:177], v234 offset:2048
    ds_read_b64_tr_b16 v[178:179], v234 offset:2560
    v_mfma_f32_32x32x16_bf16 v[32:47], v[64:67], v[180:183], 0
    v_lshlrev_b32 v186, 16, v79
    v_and_b32 v187, 0xffff0000, v79
    v_cvt_pk_bf16_f32 v73, v188, v189
    v_cvt_pk_bf16_f32 v77, v190, v191
    v_mul_f32_dpp v188, v231, v184 row_newbcast:4 row_mask:0xf bank_mask:0xf
    v_mul_f32_dpp v189, v231, v185 row_newbcast:5 row_mask:0xf bank_mask:0xf
    v_mul_f32_dpp v190, v231, v184 row_newbcast:12 row_mask:0xf bank_mask:0xf
    v_mul_f32_dpp v191, v231, v185 row_newbcast:13 row_mask:0xf bank_mask:0xf
    v_mfma_f32_32x32x16_bf16 v[48:63], v[68:71], v[180:183], 0
    ds_read_b64_tr_b16 v[180:181], v235 offset:2048
    ds_read_b64_tr_b16 v[182:183], v235 offset:2560
    v_cvt_pk_bf16_f32 v74, v188, v189
    v_cvt_pk_bf16_f32 v78, v190, v191
    v_mul_f32_dpp v188, v231, v186 row_newbcast:6 row_mask:0xf bank_mask:0xf
    v_mul_f32_dpp v189, v231, v187 row_newbcast:7 row_mask:0xf bank_mask:0xf
    v_mul_f32_dpp v190, v231, v186 row_newbcast:14 row_mask:0xf bank_mask:0xf
    v_mul_f32_dpp v191, v231, v187 row_newbcast:15 row_mask:0xf bank_mask:0xf
    v_cvt_pk_bf16_f32 v75, v188, v189
    v_cvt_pk_bf16_f32 v79, v190, v191
    s_nop 0
    s_waitcnt lgkmcnt(2)
    v_mfma_f32_32x32x16_bf16 v[0:15], v[72:75], v[176:179], v[0:15]
    v_lshlrev_b32 v184, 16, v84
    v_and_b32 v185, 0xffff0000, v84
    v_lshlrev_b32 v186, 16, v85
    v_and_b32 v187, 0xffff0000, v85
    v_mul_f32_dpp v188, v232, v184 row_newbcast:0 row_mask:0xf bank_mask:0xf
    v_mul_f32_dpp v189, v232, v185 row_newbcast:1 row_mask:0xf bank_mask:0xf
    v_mul_f32_dpp v190, v232, v184 row_newbcast:8 row_mask:0xf bank_mask:0xf
    v_mul_f32_dpp v191, v232, v185 row_newbcast:9 row_mask:0xf bank_mask:0xf
    v_mfma_f32_32x32x16_bf16 v[16:31], v[76:79], v[176:179], v[16:31]
    v_lshlrev_b32 v184, 16, v86
    v_and_b32 v185, 0xffff0000, v86
    v_cvt_pk_bf16_f32 v80, v188, v189
    v_cvt_pk_bf16_f32 v84, v190, v191
    v_mul_f32_dpp v188, v232, v186 row_newbcast:2 row_mask:0xf bank_mask:0xf
    v_mul_f32_dpp v189, v232, v187 row_newbcast:3 row_mask:0xf bank_mask:0xf
    v_mul_f32_dpp v190, v232, v186 row_newbcast:10 row_mask:0xf bank_mask:0xf
    v_mul_f32_dpp v191, v232, v187 row_newbcast:11 row_mask:0xf bank_mask:0xf
    s_waitcnt lgkmcnt(0)
    s_add_u32 m0, s29, 2048
    s_nop 0
    buffer_load_dwordx4 v224, s[4:7], s36 offen lds
    s_add_u32 m0, s29, 3072
    s_nop 0
    buffer_load_dwordx4 v225, s[4:7], s36 offen lds
    s_waitcnt vmcnt(8)
    ds_read_b64_tr_b16 v[176:177], v234 offset:4096
    ds_read_b64_tr_b16 v[178:179], v234 offset:4608
    v_mfma_f32_32x32x16_bf16 v[32:47], v[72:75], v[180:183], v[32:47]
    v_lshlrev_b32 v186, 16, v87
    v_and_b32 v187, 0xffff0000, v87
    v_cvt_pk_bf16_f32 v81, v188, v189
    v_cvt_pk_bf16_f32 v85, v190, v191
    v_mul_f32_dpp v188, v232, v184 row_newbcast:4 row_mask:0xf bank_mask:0xf
    v_mul_f32_dpp v189, v232, v185 row_newbcast:5 row_mask:0xf bank_mask:0xf
    v_mul_f32_dpp v190, v232, v184 row_newbcast:12 row_mask:0xf bank_mask:0xf
    v_mul_f32_dpp v191, v232, v185 row_newbcast:13 row_mask:0xf bank_mask:0xf
    v_mfma_f32_32x32x16_bf16 v[48:63], v[76:79], v[180:183], v[48:63]
    ds_read_b64_tr_b16 v[180:181], v235 offset:4096
    ds_read_b64_tr_b16 v[182:183], v235 offset:4608
    v_cvt_pk_bf16_f32 v82, v188, v189
    v_cvt_pk_bf16_f32 v86, v190, v191
    v_mul_f32_dpp v188, v232, v186 row_newbcast:6 row_mask:0xf bank_mask:0xf
    v_mul_f32_dpp v189, v232, v187 row_newbcast:7 row_mask:0xf bank_mask:0xf
    v_mul_f32_dpp v190, v232, v186 row_newbcast:14 row_mask:0xf bank_mask:0xf
    v_mul_f32_dpp v191, v232, v187 row_newbcast:15 row_mask:0xf bank_mask:0xf
    v_cvt_pk_bf16_f32 v83, v188, v189
    v_cvt_pk_bf16_f32 v87, v190, v191
    s_nop 0
    s_waitcnt lgkmcnt(2)
    v_mfma_f32_32x32x16_bf16 v[0:15], v[80:83], v[176:179], v[0:15]
    v_lshlrev_b32 v184, 16, v92
    v_and_b32 v185, 0xffff0000, v92
    v_lshlrev_b32 v186, 16, v93
    v_and_b32 v187, 0xffff0000, v93
    v_mul_f32_dpp v188, v233, v184 row_newbcast:0 row_mask:0xf bank_mask:0xf
    v_mul_f32_dpp v189, v233, v185 row_newbcast:1 row_mask:0xf bank_mask:0xf
    v_mul_f32_dpp v190, v233, v184 row_newbcast:8 row_mask:0xf bank_mask:0xf
    v_mul_f32_dpp v191, v233, v185 row_newbcast:9 row_mask:0xf bank_mask:0xf
    v_mfma_f32_32x32x16_bf16 v[16:31], v[84:87], v[176:179], v[16:31]
    v_lshlrev_b32 v184, 16, v94
    v_and_b32 v185, 0xffff0000, v94
    v_cvt_pk_bf16_f32 v88, v188, v189
    v_cvt_pk_bf16_f32 v92, v190, v191
    v_mul_f32_dpp v188, v233, v186 row_newbcast:2 row_mask:0xf bank_mask:0xf
    v_mul_f32_dpp v189, v233, v187 row_newbcast:3 row_mask:0xf bank_mask:0xf
    v_mul_f32_dpp v190, v233, v186 row_newbcast:10 row_mask:0xf bank_mask:0xf
    v_mul_f32_dpp v191, v233, v187 row_newbcast:11 row_mask:0xf bank_mask:0xf
    s_waitcnt lgkmcnt(0)
    s_add_u32 m0, s29, 4096
    s_nop 0
    buffer_load_dwordx4 v226, s[4:7], s36 offen lds
    s_add_u32 m0, s29, 5120
    s_nop 0
    buffer_load_dwordx4 v227, s[4:7], s36 offen lds
    s_waitcnt vmcnt(8)
    ds_read_b64_tr_b16 v[176:177], v234 offset:6144
    ds_read_b64_tr_b16 v[178:179], v234 offset:6656
    v_mfma_f32_32x32x16_bf16 v[32:47], v[80:83], v[180:183], v[32:47]
    v_lshlrev_b32 v186, 16, v95
    v_and_b32 v187, 0xffff0000, v95
    v_cvt_pk_bf16_f32 v89, v188, v189
    v_cvt_pk_bf16_f32 v93, v190, v191
    v_mul_f32_dpp v188, v233, v184 row_newbcast:4 row_mask:0xf bank_mask:0xf
    v_mul_f32_dpp v189, v233, v185 row_newbcast:5 row_mask:0xf bank_mask:0xf
    v_mul_f32_dpp v190, v233, v184 row_newbcast:12 row_mask:0xf bank_mask:0xf
    v_mul_f32_dpp v191, v233, v185 row_newbcast:13 row_mask:0xf bank_mask:0xf
    v_mfma_f32_32x32x16_bf16 v[48:63], v[84:87], v[180:183], v[48:63]
    ds_read_b64_tr_b16 v[180:181], v235 offset:6144
    ds_read_b64_tr_b16 v[182:183], v235 offset:6656
    v_cvt_pk_bf16_f32 v90, v188, v189
    v_cvt_pk_bf16_f32 v94, v190, v191
    v_mul_f32_dpp v188, v233, v186 row_newbcast:6 row_mask:0xf bank_mask:0xf
    v_mul_f32_dpp v189, v233, v187 row_newbcast:7 row_mask:0xf bank_mask:0xf
    v_mul_f32_dpp v190, v233, v186 row_newbcast:14 row_mask:0xf bank_mask:0xf
    v_mul_f32_dpp v191, v233, v187 row_newbcast:15 row_mask:0xf bank_mask:0xf
    v_cvt_pk_bf16_f32 v91, v188, v189
    v_cvt_pk_bf16_f32 v95, v190, v191
    s_nop 0
    s_waitcnt lgkmcnt(2)
    v_mfma_f32_32x32x16_bf16 v[0:15], v[88:91], v[176:179], v[0:15]
    v_mfma_f32_32x32x16_bf16 v[16:31], v[92:95], v[176:179], v[16:31]
    s_waitcnt lgkmcnt(0)
    s_add_u32 m0, s29, 6144
    s_nop 0
    buffer_load_dwordx4 v228, s[4:7], s36 offen lds
    s_add_u32 m0, s29, 7168
    s_nop 0
    buffer_load_dwordx4 v229, s[4:7], s36 offen lds
    s_waitcnt vmcnt(8)
    ds_read_b64_tr_b16 v[176:177], v234 offset:0
    ds_read_b64_tr_b16 v[178:179], v234 offset:512
    v_mfma_f32_32x32x16_bf16 v[32:47], v[88:91], v[180:183], v[32:47]
    v_mfma_f32_32x32x16_bf16 v[48:63], v[92:95], v[180:183], v[48:63]
    ds_read_b64_tr_b16 v[180:181], v235 offset:0
    ds_read_b64_tr_b16 v[182:183], v235 offset:512
    v_mul_f32 v0, v0, v96
    v_fmac_f32 v0, v1, v97
    v_fmac_f32 v0, v2, v98
    v_fmac_f32 v0, v3, v99
    v_fmac_f32 v0, v4, v100
    v_fmac_f32 v0, v5, v101
    v_fmac_f32 v0, v6, v102
    v_fmac_f32 v0, v7, v103
    v_mul_f32 v8, v8, v128
    v_fmac_f32 v8, v9, v129
    v_fmac_f32 v8, v10, v130
    v_fmac_f32 v8, v11, v131
    v_fmac_f32 v8, v12, v132
    v_fmac_f32 v8, v13, v133
    v_fmac_f32 v8, v14, v134
    v_fmac_f32 v8, v15, v135
    v_mul_f32 v16, v16, v128
    v_fmac_f32 v16, v17, v129
    v_fmac_f32 v16, v18, v130
    v_fmac_f32 v16, v19, v131
    v_fmac_f32 v16, v20, v132
    v_fmac_f32 v16, v21, v133
    v_fmac_f32 v16, v22, v134
    v_fmac_f32 v16, v23, v135
    v_mul_f32 v24, v24, v128
    v_fmac_f32 v24, v25, v129
    v_fmac_f32 v24, v26, v130
    v_fmac_f32 v24, v27, v131
    v_fmac_f32 v24, v28, v132
    v_fmac_f32 v24, v29, v133
    v_fmac_f32 v24, v30, v134
    v_fmac_f32 v24, v31, v135
    v_mul_f32 v32, v32, v104
    v_fmac_f32 v32, v33, v105
    v_fmac_f32 v32, v34, v106
    v_fmac_f32 v32, v35, v107
    v_fmac_f32 v32, v36, v108
    v_fmac_f32 v32, v37, v109
    v_fmac_f32 v32, v38, v110
    v_fmac_f32 v32, v39, v111
    v_mul_f32 v40, v40, v136
    v_fmac_f32 v40, v41, v137
    v_fmac_f32 v40, v42, v138
    v_fmac_f32 v40, v43, v139
    v_fmac_f32 v40, v44, v140
    v_fmac_f32 v40, v45, v141
    v_fmac_f32 v40, v46, v142
    v_fmac_f32 v40, v47, v143
    v_mul_f32 v48, v48, v136
    v_fmac_f32 v48, v49, v137
    v_fmac_f32 v48, v50, v138
    v_fmac_f32 v48, v51, v139
    v_fmac_f32 v48, v52, v140
    v_fmac_f32 v48, v53, v141
    v_fmac_f32 v48, v54, v142
    v_fmac_f32 v48, v55, v143
    v_mul_f32 v56, v56, v136
    v_fmac_f32 v56, v57, v137
    v_fmac_f32 v56, v58, v138
    v_fmac_f32 v56, v59, v139
    v_fmac_f32 v56, v60, v140
    v_fmac_f32 v56, v61, v141
    v_fmac_f32 v56, v62, v142
    v_fmac_f32 v56, v63, v143
    s_nop 0
    v_permlane32_swap_b32 v0, v8
    v_permlane32_swap_b32 v16, v24
    v_permlane32_swap_b32 v32, v40
    v_permlane32_swap_b32 v48, v56
    v_add_f32 v8, v0, v8
    v_add_f32 v24, v16, v24
    v_add_f32 v40, v32, v40
    v_add_f32 v56, v48, v56
    s_set_gpr_idx_on s52, gpr_idx(DST)
    s_nop 0
    v_cvt_pk_bf16_f32 v192, v8, v40
    v_cvt_pk_bf16_f32 v193, v24, v56
    s_set_gpr_idx_off
    s_waitcnt lgkmcnt(2)
    v_mfma_f32_32x32x16_bf16 v[0:15], v[64:67], v[176:179], 0
    v_mfma_f32_32x32x16_bf16 v[16:31], v[68:71], v[176:179], 0
    s_waitcnt lgkmcnt(0)
    s_add_u32 m0, s29, 0
    s_nop 0
    buffer_load_dwordx4 v222, s[4:7], s37 offen lds
    s_add_u32 m0, s29, 1024
    s_nop 0
    buffer_load_dwordx4 v223, s[4:7], s37 offen lds
    s_waitcnt vmcnt(6)
    ds_read_b64_tr_b16 v[176:177], v234 offset:2048
    ds_read_b64_tr_b16 v[178:179], v234 offset:2560
    v_mfma_f32_32x32x16_bf16 v[32:47], v[64:67], v[180:183], 0
    v_mfma_f32_32x32x16_bf16 v[48:63], v[68:71], v[180:183], 0
    ds_read_b64_tr_b16 v[180:181], v235 offset:2048
    ds_read_b64_tr_b16 v[182:183], v235 offset:2560
    s_waitcnt lgkmcnt(2)
    v_mfma_f32_32x32x16_bf16 v[0:15], v[72:75], v[176:179], v[0:15]
    v_mfma_f32_32x32x16_bf16 v[16:31], v[76:79], v[176:179], v[16:31]
    s_waitcnt lgkmcnt(0)
    s_add_u32 m0, s29, 2048
    s_nop 0
    buffer_load_dwordx4 v224, s[4:7], s37 offen lds
    s_add_u32 m0, s29, 3072
    s_nop 0
    buffer_load_dwordx4 v225, s[4:7], s37 offen lds
    s_waitcnt vmcnt(6)
    ds_read_b64_tr_b16 v[176:177], v234 offset:4096
    ds_read_b64_tr_b16 v[178:179], v234 offset:4608
    v_mfma_f32_32x32x16_bf16 v[32:47], v[72:75], v[180:183], v[32:47]
    v_mfma_f32_32x32x16_bf16 v[48:63], v[76:79], v[180:183], v[48:63]
    ds_read_b64_tr_b16 v[180:181], v235 offset:4096
    ds_read_b64_tr_b16 v[182:183], v235 offset:4608
    s_waitcnt lgkmcnt(2)
    v_mfma_f32_32x32x16_bf16 v[0:15], v[80:83], v[176:179], v[0:15]
    v_mfma_f32_32x32x16_bf16 v[16:31], v[84:87], v[176:179], v[16:31]
    s_waitcnt lgkmcnt(0)
    s_add_u32 m0, s29, 4096
    s_nop 0
    buffer_load_dwordx4 v226, s[4:7], s37 offen lds
    s_add_u32 m0, s29, 5120
    s_nop 0
    buffer_load_dwordx4 v227, s[4:7], s37 offen lds
    s_waitcnt vmcnt(6)
    ds_read_b64_tr_b16 v[176:177], v234 offset:6144
    ds_read_b64_tr_b16 v[178:179], v234 offset:6656
    v_mfma_f32_32x32x16_bf16 v[32:47], v[80:83], v[180:183], v[32:47]
    v_mfma_f32_32x32x16_bf16 v[48:63], v[84:87], v[180:183], v[48:63]
    ds_read_b64_tr_b16 v[180:181], v235 offset:6144
    ds_read_b64_tr_b16 v[182:183], v235 offset:6656
    s_waitcnt lgkmcnt(2)
    v_mfma_f32_32x32x16_bf16 v[0:15], v[88:91], v[176:179], v[0:15]
    v_mfma_f32_32x32x16_bf16 v[16:31], v[92:95], v[176:179], v[16:31]
    s_waitcnt lgkmcnt(0)
    s_add_u32 m0, s29, 6144
    s_nop 0
    buffer_load_dwordx4 v228, s[4:7], s37 offen lds
    s_add_u32 m0, s29, 7168
    s_nop 0
    buffer_load_dwordx4 v229, s[4:7], s37 offen lds
    s_waitcnt vmcnt(6)
    ds_read_b64_tr_b16 v[176:177], v234 offset:0
    ds_read_b64_tr_b16 v[178:179], v234 offset:512
    v_mfma_f32_32x32x16_bf16 v[32:47], v[88:91], v[180:183], v[32:47]
    v_mfma_f32_32x32x16_bf16 v[48:63], v[92:95], v[180:183], v[48:63]
    ds_read_b64_tr_b16 v[180:181], v235 offset:0
    ds_read_b64_tr_b16 v[182:183], v235 offset:512
    v_mul_f32 v184, v0, v144
    v_fmac_f32 v184, v1, v145
    v_fmac_f32 v184, v2, v146
    v_fmac_f32 v184, v3, v147
    v_fmac_f32 v184, v4, v148
    v_fmac_f32 v184, v5, v149
    v_fmac_f32 v184, v6, v150
    v_fmac_f32 v184, v7, v151
    v_mul_f32 v186, v8, v112
    v_fmac_f32 v186, v9, v113
    v_fmac_f32 v186, v10, v114
    v_fmac_f32 v186, v11, v115
    v_fmac_f32 v186, v12, v116
    v_fmac_f32 v186, v13, v117
    v_fmac_f32 v186, v14, v118
    v_fmac_f32 v186, v15, v119
    v_mul_f32_e64 v188, v16, -v160
    v_fma_f32 v188, v17, -v161, v188
    v_fma_f32 v188, v18, -v162, v188
    v_fma_f32 v188, v19, -v163, v188
    v_fma_f32 v188, v20, -v164, v188
    v_fma_f32 v188, v21, -v165, v188
    v_fma_f32 v188, v22, -v166, v188
    v_fma_f32 v188, v23, -v167, v188
    v_mul_f32 v190, v24, v160
    v_fmac_f32 v190, v25, v161
    v_fmac_f32 v190, v26, v162
    v_fmac_f32 v190, v27, v163
    v_fmac_f32 v190, v28, v164
    v_fmac_f32 v190, v29, v165
    v_fmac_f32 v190, v30, v166
    v_fmac_f32 v190, v31, v167
    v_mul_f32 v185, v32, v152
    v_fmac_f32 v185, v33, v153
    v_fmac_f32 v185, v34, v154
    v_fmac_f32 v185, v35, v155
    v_fmac_f32 v185, v36, v156
    v_fmac_f32 v185, v37, v157
    v_fmac_f32 v185, v38, v158
    v_fmac_f32 v185, v39, v159
    v_mul_f32 v187, v40, v120
    v_fmac_f32 v187, v41, v121
    v_fmac_f32 v187, v42, v122
    v_fmac_f32 v187, v43, v123
    v_fmac_f32 v187, v44, v124
    v_fmac_f32 v187, v45, v125
    v_fmac_f32 v187, v46, v126
    v_fmac_f32 v187, v47, v127
    v_mul_f32_e64 v189, v48, -v168
    v_fma_f32 v189, v49, -v169, v189
    v_fma_f32 v189, v50, -v170, v189
    v_fma_f32 v189, v51, -v171, v189
    v_fma_f32 v189, v52, -v172, v189
    v_fma_f32 v189, v53, -v173, v189
    v_fma_f32 v189, v54, -v174, v189
    v_fma_f32 v189, v55, -v175, v189
    v_mul_f32 v191, v56, v168
    v_fmac_f32 v191, v57, v169
    v_fmac_f32 v191, v58, v170
    v_fmac_f32 v191, v59, v171
    v_fmac_f32 v191, v60, v172
    v_fmac_f32 v191, v61, v173
    v_fmac_f32 v191, v62, v174
    v_fmac_f32 v191, v63, v175
    s_waitcnt lgkmcnt(2)
    v_mfma_f32_32x32x16_bf16 v[0:15], v[64:67], v[176:179], 0
    v_mfma_f32_32x32x16_bf16 v[16:31], v[68:71], v[176:179], 0
    s_waitcnt lgkmcnt(0)
    s_add_u32 m0, s29, 0
    s_nop 0
    buffer_load_dwordx4 v222, s[4:7], s38 offen lds
    s_add_u32 m0, s29, 1024
    s_nop 0
    buffer_load_dwordx4 v223, s[4:7], s38 offen lds
    v_add_u32 v244, s43, v239
    ds_read_u16 v222, v244
    ds_read_u16 v223, v244 offset:64
    s_waitcnt vmcnt(6)
    ds_read_b64_tr_b16 v[176:177], v234 offset:2048
    ds_read_b64_tr_b16 v[178:179], v234 offset:2560
    v_mfma_f32_32x32x16_bf16 v[32:47], v[64:67], v[180:183], 0
    v_mfma_f32_32x32x16_bf16 v[48:63], v[68:71], v[180:183], 0
    ds_read_b64_tr_b16 v[180:181], v235 offset:2048
    ds_read_b64_tr_b16 v[182:183], v235 offset:2560
    s_waitcnt lgkmcnt(2)
    v_mfma_f32_32x32x16_bf16 v[0:15], v[72:75], v[176:179], v[0:15]
    v_mfma_f32_32x32x16_bf16 v[16:31], v[76:79], v[176:179], v[16:31]
    s_waitcnt lgkmcnt(0)
    s_add_u32 m0, s29, 2048
    s_nop 0
    buffer_load_dwordx4 v224, s[4:7], s38 offen lds
    s_add_u32 m0, s29, 3072
    s_nop 0
    buffer_load_dwordx4 v225, s[4:7], s38 offen lds
    v_add_u32 v244, s44, v239
    ds_read_u16 v224, v244
    ds_read_u16 v225, v244 offset:64
    s_waitcnt vmcnt(6)
    ds_read_b64_tr_b16 v[176:177], v234 offset:4096
    ds_read_b64_tr_b16 v[178:179], v234 offset:4608
    v_mfma_f32_32x32x16_bf16 v[32:47], v[72:75], v[180:183], v[32:47]
    v_mfma_f32_32x32x16_bf16 v[48:63], v[76:79], v[180:183], v[48:63]
    ds_read_b64_tr_b16 v[180:181], v235 offset:4096
    ds_read_b64_tr_b16 v[182:183], v235 offset:4608
    s_waitcnt lgkmcnt(2)
    v_mfma_f32_32x32x16_bf16 v[0:15], v[80:83], v[176:179], v[0:15]
    v_mfma_f32_32x32x16_bf16 v[16:31], v[84:87], v[176:179], v[16:31]
    s_waitcnt lgkmcnt(0)
    s_add_u32 m0, s29, 4096
    s_nop 0
    buffer_load_dwordx4 v226, s[4:7], s38 offen lds
    s_add_u32 m0, s29, 5120
    s_nop 0
    buffer_load_dwordx4 v227, s[4:7], s38 offen lds
    v_add_u32 v244, s45, v239
    ds_read_u16 v226, v244
    ds_read_u16 v227, v244 offset:64
    s_waitcnt vmcnt(6)
    ds_read_b64_tr_b16 v[176:177], v234 offset:6144
    ds_read_b64_tr_b16 v[178:179], v234 offset:6656
    v_mfma_f32_32x32x16_bf16 v[32:47], v[80:83], v[180:183], v[32:47]
    v_mfma_f32_32x32x16_bf16 v[48:63], v[84:87], v[180:183], v[48:63]
    ds_read_b64_tr_b16 v[180:181], v235 offset:6144
    ds_read_b64_tr_b16 v[182:183], v235 offset:6656
    s_waitcnt lgkmcnt(2)
    v_mfma_f32_32x32x16_bf16 v[0:15], v[88:91], v[176:179], v[0:15]
    v_mfma_f32_32x32x16_bf16 v[16:31], v[92:95], v[176:179], v[16:31]
    s_waitcnt lgkmcnt(0)
    s_add_u32 m0, s29, 6144
    s_nop 0
    buffer_load_dwordx4 v228, s[4:7], s38 offen lds
    s_add_u32 m0, s29, 7168
    s_nop 0
    buffer_load_dwordx4 v229, s[4:7], s38 offen lds
    v_add_u32 v244, s46, v239
    ds_read_u16 v228, v244
    ds_read_u16 v229, v244 offset:64
    s_waitcnt vmcnt(6)
    ds_read_b64_tr_b16 v[176:177], v234 offset:0
    ds_read_b64_tr_b16 v[178:179], v234 offset:512
    v_mfma_f32_32x32x16_bf16 v[32:47], v[88:91], v[180:183], v[32:47]
    v_mfma_f32_32x32x16_bf16 v[48:63], v[92:95], v[180:183], v[48:63]
    ds_read_b64_tr_b16 v[180:181], v235 offset:0
    ds_read_b64_tr_b16 v[182:183], v235 offset:512
    v_mul_f32 v0, v0, v144
    v_fmac_f32 v0, v1, v145
    v_fmac_f32 v0, v2, v146
    v_fmac_f32 v0, v3, v147
    v_fmac_f32 v0, v4, v148
    v_fmac_f32 v0, v5, v149
    v_fmac_f32 v0, v6, v150
    v_fmac_f32 v0, v7, v151
    v_fmac_f32 v188, v8, v160
    v_fmac_f32 v188, v9, v161
    v_fmac_f32 v188, v10, v162
    v_fmac_f32 v188, v11, v163
    v_fmac_f32 v188, v12, v164
    v_fmac_f32 v188, v13, v165
    v_fmac_f32 v188, v14, v166
    v_fmac_f32 v188, v15, v167
    v_fmac_f32 v186, v16, v112
    v_fmac_f32 v186, v17, v113
    v_fmac_f32 v186, v18, v114
    v_fmac_f32 v186, v19, v115
    v_fmac_f32 v186, v20, v116
    v_fmac_f32 v186, v21, v117
    v_fmac_f32 v186, v22, v118
    v_fmac_f32 v186, v23, v119
    v_mul_f32_e64 v24, v24, -v160
    v_fma_f32 v24, v25, -v161, v24
    v_fma_f32 v24, v26, -v162, v24
    v_fma_f32 v24, v27, -v163, v24
    v_fma_f32 v24, v28, -v164, v24
    v_fma_f32 v24, v29, -v165, v24
    v_fma_f32 v24, v30, -v166, v24
    v_fma_f32 v24, v31, -v167, v24
    v_mul_f32 v32, v32, v152
    v_fmac_f32 v32, v33, v153
    v_fmac_f32 v32, v34, v154
    v_fmac_f32 v32, v35, v155
    v_fmac_f32 v32, v36, v156
    v_fmac_f32 v32, v37, v157
    v_fmac_f32 v32, v38, v158
    v_fmac_f32 v32, v39, v159
    v_fmac_f32 v189, v40, v168
    v_fmac_f32 v189, v41, v169
    v_fmac_f32 v189, v42, v170
    v_fmac_f32 v189, v43, v171
    v_fmac_f32 v189, v44, v172
    v_fmac_f32 v189, v45, v173
    v_fmac_f32 v189, v46, v174
    v_fmac_f32 v189, v47, v175
    v_fmac_f32 v187, v48, v120
    v_fmac_f32 v187, v49, v121
    v_fmac_f32 v187, v50, v122
    v_fmac_f32 v187, v51, v123
    v_fmac_f32 v187, v52, v124
    v_fmac_f32 v187, v53, v125
    v_fmac_f32 v187, v54, v126
    v_fmac_f32 v187, v55, v127
    v_mul_f32_e64 v56, v56, -v168
    v_fma_f32 v56, v57, -v169, v56
    v_fma_f32 v56, v58, -v170, v56
    v_fma_f32 v56, v59, -v171, v56
    v_fma_f32 v56, v60, -v172, v56
    v_fma_f32 v56, v61, -v173, v56
    v_fma_f32 v56, v62, -v174, v56
    v_fma_f32 v56, v63, -v175, v56
    s_nop 0
    s_nop 0
    v_permlane32_swap_b32 v184, v0
    v_permlane32_swap_b32 v185, v32
    v_add_f32 v0, v184, v0
    v_add_f32 v32, v185, v32
    v_mov_b32 v184, v24
    v_mov_b32 v185, v56
    s_set_gpr_idx_on s52, gpr_idx(DST)
    s_nop 0
    v_cvt_pk_bf16_f32 v194, v0, v32
    s_set_gpr_idx_off
    s_waitcnt lgkmcnt(2)
    v_mfma_f32_32x32x16_bf16 v[0:15], v[64:67], v[176:179], 0
    v_mfma_f32_32x32x16_bf16 v[16:31], v[68:71], v[176:179], 0
    v_lshl_add_u32 v222, v222, 10, v236
    v_lshl_add_u32 v223, v223, 10, v236
    s_waitcnt lgkmcnt(0)
    s_add_u32 m0, s29, 0
    s_nop 0
    buffer_load_dwordx4 v222, s[4:7], s39 offen lds
    s_add_u32 m0, s29, 1024
    s_nop 0
    buffer_load_dwordx4 v223, s[4:7], s39 offen lds
    s_waitcnt vmcnt(6)
    ds_read_b64_tr_b16 v[176:177], v234 offset:2048
    ds_read_b64_tr_b16 v[178:179], v234 offset:2560
    v_mfma_f32_32x32x16_bf16 v[32:47], v[64:67], v[180:183], 0
    v_mfma_f32_32x32x16_bf16 v[48:63], v[68:71], v[180:183], 0
    ds_read_b64_tr_b16 v[180:181], v235 offset:2048
    ds_read_b64_tr_b16 v[182:183], v235 offset:2560
    s_waitcnt lgkmcnt(2)
    v_mfma_f32_32x32x16_bf16 v[0:15], v[72:75], v[176:179], v[0:15]
    v_mfma_f32_32x32x16_bf16 v[16:31], v[76:79], v[176:179], v[16:31]
    v_lshl_add_u32 v224, v224, 10, v236
    v_lshl_add_u32 v225, v225, 10, v236
    s_waitcnt lgkmcnt(0)
    s_add_u32 m0, s29, 2048
    s_nop 0
    buffer_load_dwordx4 v224, s[4:7], s40 offen lds
    s_add_u32 m0, s29, 3072
    s_nop 0
    buffer_load_dwordx4 v225, s[4:7], s40 offen lds
    s_waitcnt vmcnt(6)
    ds_read_b64_tr_b16 v[176:177], v234 offset:4096
    ds_read_b64_tr_b16 v[178:179], v234 offset:4608
    v_mfma_f32_32x32x16_bf16 v[32:47], v[72:75], v[180:183], v[32:47]
    v_mfma_f32_32x32x16_bf16 v[48:63], v[76:79], v[180:183], v[48:63]
    ds_read_b64_tr_b16 v[180:181], v235 offset:4096
    ds_read_b64_tr_b16 v[182:183], v235 offset:4608
    s_waitcnt lgkmcnt(2)
    v_mfma_f32_32x32x16_bf16 v[0:15], v[80:83], v[176:179], v[0:15]
    v_mfma_f32_32x32x16_bf16 v[16:31], v[84:87], v[176:179], v[16:31]
    v_lshl_add_u32 v226, v226, 10, v236
    v_lshl_add_u32 v227, v227, 10, v236
    s_waitcnt lgkmcnt(0)
    s_add_u32 m0, s29, 4096
    s_nop 0
    buffer_load_dwordx4 v226, s[4:7], s41 offen lds
    s_add_u32 m0, s29, 5120
    s_nop 0
    buffer_load_dwordx4 v227, s[4:7], s41 offen lds
    s_waitcnt vmcnt(6)
    ds_read_b64_tr_b16 v[176:177], v234 offset:6144
    ds_read_b64_tr_b16 v[178:179], v234 offset:6656
    v_mfma_f32_32x32x16_bf16 v[32:47], v[80:83], v[180:183], v[32:47]
    v_mfma_f32_32x32x16_bf16 v[48:63], v[84:87], v[180:183], v[48:63]
    ds_read_b64_tr_b16 v[180:181], v235 offset:6144
    ds_read_b64_tr_b16 v[182:183], v235 offset:6656
    s_waitcnt lgkmcnt(2)
    v_mfma_f32_32x32x16_bf16 v[0:15], v[88:91], v[176:179], v[0:15]
    v_mfma_f32_32x32x16_bf16 v[16:31], v[92:95], v[176:179], v[16:31]
    v_lshl_add_u32 v228, v228, 10, v236
    v_lshl_add_u32 v229, v229, 10, v236
    s_waitcnt lgkmcnt(0)
    s_add_u32 m0, s29, 6144
    s_nop 0
    buffer_load_dwordx4 v228, s[4:7], s42 offen lds
    s_add_u32 m0, s29, 7168
    s_nop 0
    buffer_load_dwordx4 v229, s[4:7], s42 offen lds
    s_waitcnt vmcnt(6)
    ds_read_b64_tr_b16 v[176:177], v234 offset:0
    ds_read_b64_tr_b16 v[178:179], v234 offset:512
    v_mfma_f32_32x32x16_bf16 v[32:47], v[88:91], v[180:183], v[32:47]
    v_mfma_f32_32x32x16_bf16 v[48:63], v[92:95], v[180:183], v[48:63]
    ds_read_b64_tr_b16 v[180:181], v235 offset:0
    ds_read_b64_tr_b16 v[182:183], v235 offset:512
    v_add_u32 v241, s49, v237
    v_add_u32 v242, s43, v238
    ds_read_b64_tr_b16 v[68:69], v241 offset:0
    ds_read_b64_tr_b16 v[70:71], v241 offset:128
    s_mov_b64 exec, s[54:55]
    ds_read_u16_d16_hi v230, v242 offset:0
    s_mov_b64 exec, -1
    v_mul_f32 v0, v0, v144
    v_fmac_f32 v0, v1, v145
    v_fmac_f32 v0, v2, v146
    v_fmac_f32 v0, v3, v147
    v_fmac_f32 v0, v4, v148
    v_fmac_f32 v0, v5, v149
    v_fmac_f32 v0, v6, v150
    v_fmac_f32 v0, v7, v151
    v_fma_f32 v190, v8, -v160, v190
    v_fma_f32 v190, v9, -v161, v190
    v_fma_f32 v190, v10, -v162, v190
    v_fma_f32 v190, v11, -v163, v190
    v_fma_f32 v190, v12, -v164, v190
    v_fma_f32 v190, v13, -v165, v190
    v_fma_f32 v190, v14, -v166, v190
    v_fma_f32 v190, v15, -v167, v190
    v_fmac_f32 v184, v16, v160
    v_fmac_f32 v184, v17, v161
    v_fmac_f32 v184, v18, v162
    v_fmac_f32 v184, v19, v163
    v_fmac_f32 v184, v20, v164
    v_fmac_f32 v184, v21, v165
    v_fmac_f32 v184, v22, v166
    v_fmac_f32 v184, v23, v167
    v_fmac_f32 v186, v24, v112
    v_fmac_f32 v186, v25, v113
    v_fmac_f32 v186, v26, v114
    v_fmac_f32 v186, v27, v115
    v_fmac_f32 v186, v28, v116
    v_fmac_f32 v186, v29, v117
    v_fmac_f32 v186, v30, v118
    v_fmac_f32 v186, v31, v119
    v_mul_f32 v32, v32, v152
    v_fmac_f32 v32, v33, v153
    v_fmac_f32 v32, v34, v154
    v_fmac_f32 v32, v35, v155
    v_fmac_f32 v32, v36, v156
    v_fmac_f32 v32, v37, v157
    v_fmac_f32 v32, v38, v158
    v_fmac_f32 v32, v39, v159
    v_fma_f32 v191, v40, -v168, v191
    v_fma_f32 v191, v41, -v169, v191
    v_fma_f32 v191, v42, -v170, v191
    v_fma_f32 v191, v43, -v171, v191
    v_fma_f32 v191, v44, -v172, v191
    v_fma_f32 v191, v45, -v173, v191
    v_fma_f32 v191, v46, -v174, v191
    v_fma_f32 v191, v47, -v175, v191
    v_fmac_f32 v185, v48, v168
    v_fmac_f32 v185, v49, v169
    v_fmac_f32 v185, v50, v170
    v_fmac_f32 v185, v51, v171
    v_fmac_f32 v185, v52, v172
    v_fmac_f32 v185, v53, v173
    v_fmac_f32 v185, v54, v174
    v_fmac_f32 v185, v55, v175
    v_fmac_f32 v187, v56, v120
    v_fmac_f32 v187, v57, v121
    v_fmac_f32 v187, v58, v122
    v_fmac_f32 v187, v59, v123
    v_fmac_f32 v187, v60, v124
    v_fmac_f32 v187, v61, v125
    v_fmac_f32 v187, v62, v126
    v_fmac_f32 v187, v63, v127
    s_nop 0
    s_nop 0
    v_permlane32_swap_b32 v0, v188
    v_permlane32_swap_b32 v190, v8
    v_permlane32_swap_b32 v186, v184
    v_permlane32_swap_b32 v32, v189
    v_permlane32_swap_b32 v191, v40
    v_permlane32_swap_b32 v187, v185
    v_add_f32 v188, v0, v188
    v_add_f32 v8, v190, v8
    v_add_f32 v184, v186, v184
    v_add_f32 v189, v32, v189
    v_add_f32 v40, v191, v40
    v_add_f32 v185, v187, v185
    s_set_gpr_idx_on s52, gpr_idx(DST)
    s_nop 0
    v_cvt_pk_bf16_f32 v195, v188, v189
    v_cvt_pk_bf16_f32 v197, v8, v40
    v_cvt_pk_bf16_f32 v196, v184, v185
    s_set_gpr_idx_off
    s_branch NEXT_0
.p2align 6
ITEM_0_1:
    v_add_u32 v244, s43, v239
    ds_read_u16 v222, v244
    ds_read_u16 v223, v244 offset:64
    v_add_u32 v244, s44, v239
    ds_read_u16 v224, v244
    ds_read_u16 v225, v244 offset:64
    v_add_u32 v244, s45, v239
    ds_read_u16 v226, v244
    ds_read_u16 v227, v244 offset:64
    v_add_u32 v244, s46, v239
    ds_read_u16 v228, v244
    ds_read_u16 v229, v244 offset:64
    v_add_u32 v245, s49, v248
    ds_read_b32 v246, v245
    ds_read_b32 v247, v245 offset:1024
    s_waitcnt lgkmcnt(10)
    v_lshlrev_b32 v184, 16, v68
    v_and_b32 v185, 0xffff0000, v68
    v_lshlrev_b32 v186, 16, v69
    v_and_b32 v187, 0xffff0000, v69
    v_mul_f32_dpp v188, v230, v184 row_newbcast:0 row_mask:0xf bank_mask:0xf
    v_mul_f32_dpp v189, v230, v185 row_newbcast:1 row_mask:0xf bank_mask:0xf
    v_mul_f32_dpp v190, v230, v184 row_newbcast:8 row_mask:0xf bank_mask:0xf
    v_mul_f32_dpp v191, v230, v185 row_newbcast:9 row_mask:0xf bank_mask:0xf
    v_lshlrev_b32 v184, 16, v70
    v_and_b32 v185, 0xffff0000, v70
    v_cvt_pk_bf16_f32 v64, v188, v189
    v_cvt_pk_bf16_f32 v68, v190, v191
    v_mul_f32_dpp v188, v230, v186 row_newbcast:2 row_mask:0xf bank_mask:0xf
    v_mul_f32_dpp v189, v230, v187 row_newbcast:3 row_mask:0xf bank_mask:0xf
    v_mul_f32_dpp v190, v230, v186 row_newbcast:10 row_mask:0xf bank_mask:0xf
    v_mul_f32_dpp v191, v230, v187 row_newbcast:11 row_mask:0xf bank_mask:0xf
    v_lshlrev_b32 v186, 16, v71
    v_and_b32 v187, 0xffff0000, v71
    v_cvt_pk_bf16_f32 v65, v188, v189
    v_cvt_pk_bf16_f32 v69, v190, v191
    v_mul_f32_dpp v188, v230, v184 row_newbcast:4 row_mask:0xf bank_mask:0xf
    v_mul_f32_dpp v189, v230, v185 row_newbcast:5 row_mask:0xf bank_mask:0xf
    v_mul_f32_dpp v190, v230, v184 row_newbcast:12 row_mask:0xf bank_mask:0xf
    v_mul_f32_dpp v191, v230, v185 row_newbcast:13 row_mask:0xf bank_mask:0xf
    v_cvt_pk_bf16_f32 v66, v188, v189
    v_cvt_pk_bf16_f32 v70, v190, v191
    v_mul_f32_dpp v188, v230, v186 row_newbcast:6 row_mask:0xf bank_mask:0xf
    v_mul_f32_dpp v189, v230, v187 row_newbcast:7 row_mask:0xf bank_mask:0xf
    v_mul_f32_dpp v190, v230, v186 row_newbcast:14 row_mask:0xf bank_mask:0xf
    v_mul_f32_dpp v191, v230, v187 row_newbcast:15 row_mask:0xf bank_mask:0xf
    v_cvt_pk_bf16_f32 v67, v188, v189
    v_cvt_pk_bf16_f32 v71, v190, v191
    s_nop 0
    v_mfma_f32_32x32x16_bf16 v[0:15], v[64:67], v[176:179], 0
    v_mfma_f32_32x32x16_bf16 v[16:31], v[68:71], v[176:179], 0
    s_waitcnt lgkmcnt(8)
    v_lshl_add_u32 v222, v222, 10, v236
    v_lshl_add_u32 v223, v223, 10, v236
    s_add_u32 m0, s29, 0
    s_nop 0
    buffer_load_dwordx4 v222, s[4:7], s39 offen lds
    s_add_u32 m0, s29, 1024
    s_nop 0
    buffer_load_dwordx4 v223, s[4:7], s39 offen lds
    s_waitcnt lgkmcnt(0)
    v_lshl_add_u32 v246, v246, 5, v249
    v_lshl_add_u32 v247, v247, 5, v249
    s_mov_b32 m0, s60
    s_mov_b64 exec, s[56:57]
    buffer_load_dwordx4 v246, s[8:11], 0 offen  lds
    s_mov_b32 m0, s61
    s_mov_b64 exec, s[58:59]
    buffer_load_dwordx4 v247, s[8:11], 0 offen  lds
    s_mov_b64 exec, -1
    s_waitcnt vmcnt(8)
    ds_read_b64_tr_b16 v[176:177], v234 offset:2048
    ds_read_b64_tr_b16 v[178:179], v234 offset:2560
    v_mfma_f32_32x32x16_bf16 v[32:47], v[64:67], v[180:183], 0
    v_mfma_f32_32x32x16_bf16 v[48:63], v[68:71], v[180:183], 0
    ds_read_b64_tr_b16 v[180:181], v235 offset:2048
    ds_read_b64_tr_b16 v[182:183], v235 offset:2560
    v_mul_f32 v0, v0, v96
    v_fmac_f32 v0, v1, v97
    v_fmac_f32 v0, v2, v98
    v_fmac_f32 v0, v3, v99
    v_fmac_f32 v0, v4, v100
    v_fmac_f32 v0, v5, v101
    v_fmac_f32 v0, v6, v102
    v_fmac_f32 v0, v7, v103
    v_mul_f32 v8, v8, v128
    v_fmac_f32 v8, v9, v129
    v_fmac_f32 v8, v10, v130
    v_fmac_f32 v8, v11, v131
    v_fmac_f32 v8, v12, v132
    v_fmac_f32 v8, v13, v133
    v_fmac_f32 v8, v14, v134
    v_fmac_f32 v8, v15, v135
    v_mul_f32 v16, v16, v128
    v_fmac_f32 v16, v17, v129
    v_fmac_f32 v16, v18, v130
    v_fmac_f32 v16, v19, v131
    v_fmac_f32 v16, v20, v132
    v_fmac_f32 v16, v21, v133
    v_fmac_f32 v16, v22, v134
    v_fmac_f32 v16, v23, v135
    v_mul_f32 v24, v24, v128
    v_fmac_f32 v24, v25, v129
    v_fmac_f32 v24, v26, v130
    v_fmac_f32 v24, v27, v131
    v_fmac_f32 v24, v28, v132
    v_fmac_f32 v24, v29, v133
    v_fmac_f32 v24, v30, v134
    v_fmac_f32 v24, v31, v135
    v_mul_f32 v32, v32, v104
    v_fmac_f32 v32, v33, v105
    v_fmac_f32 v32, v34, v106
    v_fmac_f32 v32, v35, v107
    v_fmac_f32 v32, v36, v108
    v_fmac_f32 v32, v37, v109
    v_fmac_f32 v32, v38, v110
    v_fmac_f32 v32, v39, v111
    v_mul_f32 v40, v40, v136
    v_fmac_f32 v40, v41, v137
    v_fmac_f32 v40, v42, v138
    v_fmac_f32 v40, v43, v139
    v_fmac_f32 v40, v44, v140
    v_fmac_f32 v40, v45, v141
    v_fmac_f32 v40, v46, v142
    v_fmac_f32 v40, v47, v143
    v_mul_f32 v48, v48, v136
    v_fmac_f32 v48, v49, v137
    v_fmac_f32 v48, v50, v138
    v_fmac_f32 v48, v51, v139
    v_fmac_f32 v48, v52, v140
    v_fmac_f32 v48, v53, v141
    v_fmac_f32 v48, v54, v142
    v_fmac_f32 v48, v55, v143
    v_mul_f32 v56, v56, v136
    v_fmac_f32 v56, v57, v137
    v_fmac_f32 v56, v58, v138
    v_fmac_f32 v56, v59, v139
    v_fmac_f32 v56, v60, v140
    v_fmac_f32 v56, v61, v141
    v_fmac_f32 v56, v62, v142
    v_fmac_f32 v56, v63, v143
    s_nop 0
    v_permlane32_swap_b32 v0, v8
    v_permlane32_swap_b32 v16, v24
    v_permlane32_swap_b32 v32, v40
    v_permlane32_swap_b32 v48, v56
    v_add_f32 v8, v0, v8
    v_add_f32 v24, v16, v24
    v_add_f32 v40, v32, v40
    v_add_f32 v56, v48, v56
    s_set_gpr_idx_on s52, gpr_idx(DST)
    s_nop 0
    v_cvt_pk_bf16_f32 v192, v8, v40
    v_cvt_pk_bf16_f32 v193, v24, v56
    s_set_gpr_idx_off
    s_waitcnt lgkmcnt(2)
    v_mfma_f32_32x32x16_bf16 v[0:15], v[64:67], v[176:179], 0
    v_mfma_f32_32x32x16_bf16 v[16:31], v[68:71], v[176:179], 0
    v_lshl_add_u32 v224, v224, 10, v236
    v_lshl_add_u32 v225, v225, 10, v236
    s_waitcnt lgkmcnt(0)
    s_add_u32 m0, s29, 2048
    s_nop 0
    buffer_load_dwordx4 v224, s[4:7], s40 offen lds
    s_add_u32 m0, s29, 3072
    s_nop 0
    buffer_load_dwordx4 v225, s[4:7], s40 offen lds
    s_waitcnt vmcnt(8)
    ds_read_b64_tr_b16 v[176:177], v234 offset:4096
    ds_read_b64_tr_b16 v[178:179], v234 offset:4608
    v_mfma_f32_32x32x16_bf16 v[32:47], v[64:67], v[180:183], 0
    v_mfma_f32_32x32x16_bf16 v[48:63], v[68:71], v[180:183], 0
    ds_read_b64_tr_b16 v[180:181], v235 offset:4096
    ds_read_b64_tr_b16 v[182:183], v235 offset:4608
    v_mul_f32 v184, v0, v144
    v_fmac_f32 v184, v1, v145
    v_fmac_f32 v184, v2, v146
    v_fmac_f32 v184, v3, v147
    v_fmac_f32 v184, v4, v148
    v_fmac_f32 v184, v5, v149
    v_fmac_f32 v184, v6, v150
    v_fmac_f32 v184, v7, v151
    v_mul_f32 v186, v8, v112
    v_fmac_f32 v186, v9, v113
    v_fmac_f32 v186, v10, v114
    v_fmac_f32 v186, v11, v115
    v_fmac_f32 v186, v12, v116
    v_fmac_f32 v186, v13, v117
    v_fmac_f32 v186, v14, v118
    v_fmac_f32 v186, v15, v119
    v_mul_f32_e64 v188, v16, -v160
    v_fma_f32 v188, v17, -v161, v188
    v_fma_f32 v188, v18, -v162, v188
    v_fma_f32 v188, v19, -v163, v188
    v_fma_f32 v188, v20, -v164, v188
    v_fma_f32 v188, v21, -v165, v188
    v_fma_f32 v188, v22, -v166, v188
    v_fma_f32 v188, v23, -v167, v188
    v_mul_f32 v190, v24, v160
    v_fmac_f32 v190, v25, v161
    v_fmac_f32 v190, v26, v162
    v_fmac_f32 v190, v27, v163
    v_fmac_f32 v190, v28, v164
    v_fmac_f32 v190, v29, v165
    v_fmac_f32 v190, v30, v166
    v_fmac_f32 v190, v31, v167
    v_mul_f32 v185, v32, v152
    v_fmac_f32 v185, v33, v153
    v_fmac_f32 v185, v34, v154
    v_fmac_f32 v185, v35, v155
    v_fmac_f32 v185, v36, v156
    v_fmac_f32 v185, v37, v157
    v_fmac_f32 v185, v38, v158
    v_fmac_f32 v185, v39, v159
    v_mul_f32 v187, v40, v120
    v_fmac_f32 v187, v41, v121
    v_fmac_f32 v187, v42, v122
    v_fmac_f32 v187, v43, v123
    v_fmac_f32 v187, v44, v124
    v_fmac_f32 v187, v45, v125
    v_fmac_f32 v187, v46, v126
    v_fmac_f32 v187, v47, v127
    v_mul_f32_e64 v189, v48, -v168
    v_fma_f32 v189, v49, -v169, v189
    v_fma_f32 v189, v50, -v170, v189
    v_fma_f32 v189, v51, -v171, v189
    v_fma_f32 v189, v52, -v172, v189
    v_fma_f32 v189, v53, -v173, v189
    v_fma_f32 v189, v54, -v174, v189
    v_fma_f32 v189, v55, -v175, v189
    v_mul_f32 v191, v56, v168
    v_fmac_f32 v191, v57, v169
    v_fmac_f32 v191, v58, v170
    v_fmac_f32 v191, v59, v171
    v_fmac_f32 v191, v60, v172
    v_fmac_f32 v191, v61, v173
    v_fmac_f32 v191, v62, v174
    v_fmac_f32 v191, v63, v175
    s_waitcnt lgkmcnt(2)
    v_mfma_f32_32x32x16_bf16 v[0:15], v[64:67], v[176:179], 0
    v_mfma_f32_32x32x16_bf16 v[16:31], v[68:71], v[176:179], 0
    v_lshl_add_u32 v226, v226, 10, v236
    v_lshl_add_u32 v227, v227, 10, v236
    s_waitcnt lgkmcnt(0)
    s_add_u32 m0, s29, 4096
    s_nop 0
    buffer_load_dwordx4 v226, s[4:7], s41 offen lds
    s_add_u32 m0, s29, 5120
    s_nop 0
    buffer_load_dwordx4 v227, s[4:7], s41 offen lds
    s_waitcnt vmcnt(8)
    ds_read_b64_tr_b16 v[176:177], v234 offset:6144
    ds_read_b64_tr_b16 v[178:179], v234 offset:6656
    v_mfma_f32_32x32x16_bf16 v[32:47], v[64:67], v[180:183], 0
    v_mfma_f32_32x32x16_bf16 v[48:63], v[68:71], v[180:183], 0
    ds_read_b64_tr_b16 v[180:181], v235 offset:6144
    ds_read_b64_tr_b16 v[182:183], v235 offset:6656
    v_mul_f32 v0, v0, v144
    v_fmac_f32 v0, v1, v145
    v_fmac_f32 v0, v2, v146
    v_fmac_f32 v0, v3, v147
    v_fmac_f32 v0, v4, v148
    v_fmac_f32 v0, v5, v149
    v_fmac_f32 v0, v6, v150
    v_fmac_f32 v0, v7, v151
    v_fmac_f32 v188, v8, v160
    v_fmac_f32 v188, v9, v161
    v_fmac_f32 v188, v10, v162
    v_fmac_f32 v188, v11, v163
    v_fmac_f32 v188, v12, v164
    v_fmac_f32 v188, v13, v165
    v_fmac_f32 v188, v14, v166
    v_fmac_f32 v188, v15, v167
    v_fmac_f32 v186, v16, v112
    v_fmac_f32 v186, v17, v113
    v_fmac_f32 v186, v18, v114
    v_fmac_f32 v186, v19, v115
    v_fmac_f32 v186, v20, v116
    v_fmac_f32 v186, v21, v117
    v_fmac_f32 v186, v22, v118
    v_fmac_f32 v186, v23, v119
    v_mul_f32_e64 v24, v24, -v160
    v_fma_f32 v24, v25, -v161, v24
    v_fma_f32 v24, v26, -v162, v24
    v_fma_f32 v24, v27, -v163, v24
    v_fma_f32 v24, v28, -v164, v24
    v_fma_f32 v24, v29, -v165, v24
    v_fma_f32 v24, v30, -v166, v24
    v_fma_f32 v24, v31, -v167, v24
    v_mul_f32 v32, v32, v152
    v_fmac_f32 v32, v33, v153
    v_fmac_f32 v32, v34, v154
    v_fmac_f32 v32, v35, v155
    v_fmac_f32 v32, v36, v156
    v_fmac_f32 v32, v37, v157
    v_fmac_f32 v32, v38, v158
    v_fmac_f32 v32, v39, v159
    v_fmac_f32 v189, v40, v168
    v_fmac_f32 v189, v41, v169
    v_fmac_f32 v189, v42, v170
    v_fmac_f32 v189, v43, v171
    v_fmac_f32 v189, v44, v172
    v_fmac_f32 v189, v45, v173
    v_fmac_f32 v189, v46, v174
    v_fmac_f32 v189, v47, v175
    v_fmac_f32 v187, v48, v120
    v_fmac_f32 v187, v49, v121
    v_fmac_f32 v187, v50, v122
    v_fmac_f32 v187, v51, v123
    v_fmac_f32 v187, v52, v124
    v_fmac_f32 v187, v53, v125
    v_fmac_f32 v187, v54, v126
    v_fmac_f32 v187, v55, v127
    v_mul_f32_e64 v56, v56, -v168
    v_fma_f32 v56, v57, -v169, v56
    v_fma_f32 v56, v58, -v170, v56
    v_fma_f32 v56, v59, -v171, v56
    v_fma_f32 v56, v60, -v172, v56
    v_fma_f32 v56, v61, -v173, v56
    v_fma_f32 v56, v62, -v174, v56
    v_fma_f32 v56, v63, -v175, v56
    s_nop 0
    s_nop 0
    v_permlane32_swap_b32 v184, v0
    v_permlane32_swap_b32 v185, v32
    v_add_f32 v0, v184, v0
    v_add_f32 v32, v185, v32
    v_mov_b32 v184, v24
    v_mov_b32 v185, v56
    s_set_gpr_idx_on s52, gpr_idx(DST)
    s_nop 0
    v_cvt_pk_bf16_f32 v194, v0, v32
    s_set_gpr_idx_off
    s_waitcnt lgkmcnt(2)
    v_mfma_f32_32x32x16_bf16 v[0:15], v[64:67], v[176:179], 0
    v_mfma_f32_32x32x16_bf16 v[16:31], v[68:71], v[176:179], 0
    v_lshl_add_u32 v228, v228, 10, v236
    v_lshl_add_u32 v229, v229, 10, v236
    s_waitcnt lgkmcnt(0)
    s_add_u32 m0, s29, 6144
    s_nop 0
    buffer_load_dwordx4 v228, s[4:7], s42 offen lds
    s_add_u32 m0, s29, 7168
    s_nop 0
    buffer_load_dwordx4 v229, s[4:7], s42 offen lds
    s_waitcnt vmcnt(8)
    ds_read_b64_tr_b16 v[176:177], v234 offset:0
    ds_read_b64_tr_b16 v[178:179], v234 offset:512
    v_mfma_f32_32x32x16_bf16 v[32:47], v[64:67], v[180:183], 0
    v_mfma_f32_32x32x16_bf16 v[48:63], v[68:71], v[180:183], 0
    ds_read_b64_tr_b16 v[180:181], v235 offset:0
    ds_read_b64_tr_b16 v[182:183], v235 offset:512
    s_waitcnt vmcnt(6)
    v_add_u32 v241, s49, v237
    v_add_u32 v242, s43, v238
    ds_read_b64_tr_b16 v[68:69], v241 offset:0
    ds_read_b64_tr_b16 v[70:71], v241 offset:128
    s_mov_b64 exec, s[54:55]
    ds_read_u16_d16_hi v230, v242 offset:0
    s_mov_b64 exec, -1
    v_mul_f32 v0, v0, v144
    v_fmac_f32 v0, v1, v145
    v_fmac_f32 v0, v2, v146
    v_fmac_f32 v0, v3, v147
    v_fmac_f32 v0, v4, v148
    v_fmac_f32 v0, v5, v149
    v_fmac_f32 v0, v6, v150
    v_fmac_f32 v0, v7, v151
    v_fma_f32 v190, v8, -v160, v190
    v_fma_f32 v190, v9, -v161, v190
    v_fma_f32 v190, v10, -v162, v190
    v_fma_f32 v190, v11, -v163, v190
    v_fma_f32 v190, v12, -v164, v190
    v_fma_f32 v190, v13, -v165, v190
    v_fma_f32 v190, v14, -v166, v190
    v_fma_f32 v190, v15, -v167, v190
    v_fmac_f32 v184, v16, v160
    v_fmac_f32 v184, v17, v161
    v_fmac_f32 v184, v18, v162
    v_fmac_f32 v184, v19, v163
    v_fmac_f32 v184, v20, v164
    v_fmac_f32 v184, v21, v165
    v_fmac_f32 v184, v22, v166
    v_fmac_f32 v184, v23, v167
    v_fmac_f32 v186, v24, v112
    v_fmac_f32 v186, v25, v113
    v_fmac_f32 v186, v26, v114
    v_fmac_f32 v186, v27, v115
    v_fmac_f32 v186, v28, v116
    v_fmac_f32 v186, v29, v117
    v_fmac_f32 v186, v30, v118
    v_fmac_f32 v186, v31, v119
    v_mul_f32 v32, v32, v152
    v_fmac_f32 v32, v33, v153
    v_fmac_f32 v32, v34, v154
    v_fmac_f32 v32, v35, v155
    v_fmac_f32 v32, v36, v156
    v_fmac_f32 v32, v37, v157
    v_fmac_f32 v32, v38, v158
    v_fmac_f32 v32, v39, v159
    v_fma_f32 v191, v40, -v168, v191
    v_fma_f32 v191, v41, -v169, v191
    v_fma_f32 v191, v42, -v170, v191
    v_fma_f32 v191, v43, -v171, v191
    v_fma_f32 v191, v44, -v172, v191
    v_fma_f32 v191, v45, -v173, v191
    v_fma_f32 v191, v46, -v174, v191
    v_fma_f32 v191, v47, -v175, v191
    v_fmac_f32 v185, v48, v168
    v_fmac_f32 v185, v49, v169
    v_fmac_f32 v185, v50, v170
    v_fmac_f32 v185, v51, v171
    v_fmac_f32 v185, v52, v172
    v_fmac_f32 v185, v53, v173
    v_fmac_f32 v185, v54, v174
    v_fmac_f32 v185, v55, v175
    v_fmac_f32 v187, v56, v120
    v_fmac_f32 v187, v57, v121
    v_fmac_f32 v187, v58, v122
    v_fmac_f32 v187, v59, v123
    v_fmac_f32 v187, v60, v124
    v_fmac_f32 v187, v61, v125
    v_fmac_f32 v187, v62, v126
    v_fmac_f32 v187, v63, v127
    s_nop 0
    s_nop 0
    v_permlane32_swap_b32 v0, v188
    v_permlane32_swap_b32 v190, v8
    v_permlane32_swap_b32 v186, v184
    v_permlane32_swap_b32 v32, v189
    v_permlane32_swap_b32 v191, v40
    v_permlane32_swap_b32 v187, v185
    v_add_f32 v188, v0, v188
    v_add_f32 v8, v190, v8
    v_add_f32 v184, v186, v184
    v_add_f32 v189, v32, v189
    v_add_f32 v40, v191, v40
    v_add_f32 v185, v187, v185
    s_set_gpr_idx_on s52, gpr_idx(DST)
    s_nop 0
    v_cvt_pk_bf16_f32 v195, v188, v189
    v_cvt_pk_bf16_f32 v197, v8, v40
    v_cvt_pk_bf16_f32 v196, v184, v185
    s_set_gpr_idx_off
    s_branch NEXT_0
.p2align 6
ITEM_1_2:
    ds_read_b64_tr_b16 v[76:77], v241 offset:512
    ds_read_b64_tr_b16 v[78:79], v241 offset:640
    s_mov_b64 exec, s[54:55]
    ds_read_u16_d16_hi v231, v242 offset:128
    s_mov_b64 exec, -1
    v_add_u32 v244, s45, v239
    ds_read_u16 v226, v244
    ds_read_u16 v227, v244 offset:64
    v_add_u32 v244, s46, v239
    ds_read_u16 v228, v244
    ds_read_u16 v229, v244 offset:64
    v_xor_b32 v243, s69, v240
    v_add_u32 v243, s50, v243
    s_waitcnt lgkmcnt(7)
    v_lshlrev_b32 v184, 16, v68
    v_and_b32 v185, 0xffff0000, v68
    v_lshlrev_b32 v186, 16, v69
    v_and_b32 v187, 0xffff0000, v69
    v_mul_f32_dpp v188, v230, v184 row_newbcast:0 row_mask:0xf bank_mask:0xf
    v_mul_f32_dpp v189, v230, v185 row_newbcast:1 row_mask:0xf bank_mask:0xf
    v_mul_f32_dpp v190, v230, v184 row_newbcast:8 row_mask:0xf bank_mask:0xf
    v_mul_f32_dpp v191, v230, v185 row_newbcast:9 row_mask:0xf bank_mask:0xf
    v_lshlrev_b32 v184, 16, v70
    v_and_b32 v185, 0xffff0000, v70
    v_cvt_pk_bf16_f32 v64, v188, v189
    v_cvt_pk_bf16_f32 v68, v190, v191
    v_mul_f32_dpp v188, v230, v186 row_newbcast:2 row_mask:0xf bank_mask:0xf
    v_mul_f32_dpp v189, v230, v187 row_newbcast:3 row_mask:0xf bank_mask:0xf
    v_mul_f32_dpp v190, v230, v186 row_newbcast:10 row_mask:0xf bank_mask:0xf
    v_mul_f32_dpp v191, v230, v187 row_newbcast:11 row_mask:0xf bank_mask:0xf
    v_lshlrev_b32 v186, 16, v71
    v_and_b32 v187, 0xffff0000, v71
    v_cvt_pk_bf16_f32 v65, v188, v189
    v_cvt_pk_bf16_f32 v69, v190, v191
    v_mul_f32_dpp v188, v230, v184 row_newbcast:4 row_mask:0xf bank_mask:0xf
    v_mul_f32_dpp v189, v230, v185 row_newbcast:5 row_mask:0xf bank_mask:0xf
    v_mul_f32_dpp v190, v230, v184 row_newbcast:12 row_mask:0xf bank_mask:0xf
    v_mul_f32_dpp v191, v230, v185 row_newbcast:13 row_mask:0xf bank_mask:0xf
    v_cvt_pk_bf16_f32 v66, v188, v189
    v_cvt_pk_bf16_f32 v70, v190, v191
    v_mul_f32_dpp v188, v230, v186 row_newbcast:6 row_mask:0xf bank_mask:0xf
    v_mul_f32_dpp v189, v230, v187 row_newbcast:7 row_mask:0xf bank_mask:0xf
    v_mul_f32_dpp v190, v230, v186 row_newbcast:14 row_mask:0xf bank_mask:0xf
    v_mul_f32_dpp v191, v230, v187 row_newbcast:15 row_mask:0xf bank_mask:0xf
    v_cvt_pk_bf16_f32 v67, v188, v189
    v_cvt_pk_bf16_f32 v71, v190, v191
    s_nop 0
    s_waitcnt lgkmcnt(4)
    v_mfma_f32_32x32x16_bf16 v[0:15], v[64:67], v[176:179], 0
    v_lshlrev_b32 v184, 16, v76
    v_and_b32 v185, 0xffff0000, v76
    v_lshlrev_b32 v186, 16, v77
    v_and_b32 v187, 0xffff0000, v77
    v_mul_f32_dpp v188, v231, v184 row_newbcast:0 row_mask:0xf bank_mask:0xf
    v_mul_f32_dpp v189, v231, v185 row_newbcast:1 row_mask:0xf bank_mask:0xf
    v_mul_f32_dpp v190, v231, v184 row_newbcast:8 row_mask:0xf bank_mask:0xf
    v_mul_f32_dpp v191, v231, v185 row_newbcast:9 row_mask:0xf bank_mask:0xf
    v_mfma_f32_32x32x16_bf16 v[16:31], v[68:71], v[176:179], 0
    v_lshlrev_b32 v184, 16, v78
    v_and_b32 v185, 0xffff0000, v78
    v_cvt_pk_bf16_f32 v72, v188, v189
    v_cvt_pk_bf16_f32 v76, v190, v191
    v_mul_f32_dpp v188, v231, v186 row_newbcast:2 row_mask:0xf bank_mask:0xf
    v_mul_f32_dpp v189, v231, v187 row_newbcast:3 row_mask:0xf bank_mask:0xf
    v_mul_f32_dpp v190, v231, v186 row_newbcast:10 row_mask:0xf bank_mask:0xf
    v_mul_f32_dpp v191, v231, v187 row_newbcast:11 row_mask:0xf bank_mask:0xf
    s_add_u32 m0, s29, 0
    s_nop 0
    buffer_load_dwordx4 v222, s[4:7], s37 offen lds
    s_add_u32 m0, s29, 1024
    s_nop 0
    buffer_load_dwordx4 v223, s[4:7], s37 offen lds
    s_waitcnt vmcnt(6)
    ds_read_b64_tr_b16 v[176:177], v234 offset:2048
    ds_read_b64_tr_b16 v[178:179], v234 offset:2560
    v_mfma_f32_32x32x16_bf16 v[32:47], v[64:67], v[180:183], 0
    v_lshlrev_b32 v186, 16, v79
    v_and_b32 v187, 0xffff0000, v79
    v_cvt_pk_bf16_f32 v73, v188, v189
    v_cvt_pk_bf16_f32 v77, v190, v191
    v_mul_f32_dpp v188, v231, v184 row_newbcast:4 row_mask:0xf bank_mask:0xf
    v_mul_f32_dpp v189, v231, v185 row_newbcast:5 row_mask:0xf bank_mask:0xf
    v_mul_f32_dpp v190, v231, v184 row_newbcast:12 row_mask:0xf bank_mask:0xf
    v_mul_f32_dpp v191, v231, v185 row_newbcast:13 row_mask:0xf bank_mask:0xf
    v_mfma_f32_32x32x16_bf16 v[48:63], v[68:71], v[180:183], 0
    ds_read_b64_tr_b16 v[180:181], v235 offset:2048
    ds_read_b64_tr_b16 v[182:183], v235 offset:2560
    v_cvt_pk_bf16_f32 v74, v188, v189
    v_cvt_pk_bf16_f32 v78, v190, v191
    v_mul_f32_dpp v188, v231, v186 row_newbcast:6 row_mask:0xf bank_mask:0xf
    v_mul_f32_dpp v189, v231, v187 row_newbcast:7 row_mask:0xf bank_mask:0xf
    v_mul_f32_dpp v190, v231, v186 row_newbcast:14 row_mask:0xf bank_mask:0xf
    v_mul_f32_dpp v191, v231, v187 row_newbcast:15 row_mask:0xf bank_mask:0xf
    v_cvt_pk_bf16_f32 v75, v188, v189
    v_cvt_pk_bf16_f32 v79, v190, v191
    s_nop 0
    s_waitcnt lgkmcnt(2)
    v_mfma_f32_32x32x16_bf16 v[0:15], v[72:75], v[176:179], v[0:15]
    v_mfma_f32_32x32x16_bf16 v[16:31], v[76:79], v[176:179], v[16:31]
    s_waitcnt lgkmcnt(0)
    s_add_u32 m0, s29, 2048
    s_nop 0
    buffer_load_dwordx4 v224, s[4:7], s37 offen lds
    s_add_u32 m0, s29, 3072
    s_nop 0
    buffer_load_dwordx4 v225, s[4:7], s37 offen lds
    s_waitcnt vmcnt(6)
    ds_read_b64_tr_b16 v[176:177], v234 offset:4096
    ds_read_b64_tr_b16 v[178:179], v234 offset:4608
    v_mfma_f32_32x32x16_bf16 v[32:47], v[72:75], v[180:183], v[32:47]
    v_mfma_f32_32x32x16_bf16 v[48:63], v[76:79], v[180:183], v[48:63]
    ds_read_b64_tr_b16 v[180:181], v235 offset:4096
    ds_read_b64_tr_b16 v[182:183], v235 offset:4608
    v_mul_f32 v0, v0, v96
    v_fmac_f32 v0, v1, v97
    v_fmac_f32 v0, v2, v98
    v_fmac_f32 v0, v3, v99
    v_fmac_f32 v0, v4, v100
    v_fmac_f32 v0, v5, v101
    v_fmac_f32 v0, v6, v102
    v_fmac_f32 v0, v7, v103
    v_mul_f32 v8, v8, v128
    v_fmac_f32 v8, v9, v129
    v_fmac_f32 v8, v10, v130
    v_fmac_f32 v8, v11, v131
    v_fmac_f32 v8, v12, v132
    v_fmac_f32 v8, v13, v133
    v_fmac_f32 v8, v14, v134
    v_fmac_f32 v8, v15, v135
    v_mul_f32 v16, v16, v128
    v_fmac_f32 v16, v17, v129
    v_fmac_f32 v16, v18, v130
    v_fmac_f32 v16, v19, v131
    v_fmac_f32 v16, v20, v132
    v_fmac_f32 v16, v21, v133
    v_fmac_f32 v16, v22, v134
    v_fmac_f32 v16, v23, v135
    v_mul_f32 v24, v24, v128
    v_fmac_f32 v24, v25, v129
    v_fmac_f32 v24, v26, v130
    v_fmac_f32 v24, v27, v131
    v_fmac_f32 v24, v28, v132
    v_fmac_f32 v24, v29, v133
    v_fmac_f32 v24, v30, v134
    v_fmac_f32 v24, v31, v135
    v_mul_f32 v32, v32, v104
    v_fmac_f32 v32, v33, v105
    v_fmac_f32 v32, v34, v106
    v_fmac_f32 v32, v35, v107
    v_fmac_f32 v32, v36, v108
    v_fmac_f32 v32, v37, v109
    v_fmac_f32 v32, v38, v110
    v_fmac_f32 v32, v39, v111
    v_mul_f32 v40, v40, v136
    v_fmac_f32 v40, v41, v137
    v_fmac_f32 v40, v42, v138
    v_fmac_f32 v40, v43, v139
    v_fmac_f32 v40, v44, v140
    v_fmac_f32 v40, v45, v141
    v_fmac_f32 v40, v46, v142
    v_fmac_f32 v40, v47, v143
    v_mul_f32 v48, v48, v136
    v_fmac_f32 v48, v49, v137
    v_fmac_f32 v48, v50, v138
    v_fmac_f32 v48, v51, v139
    v_fmac_f32 v48, v52, v140
    v_fmac_f32 v48, v53, v141
    v_fmac_f32 v48, v54, v142
    v_fmac_f32 v48, v55, v143
    v_mul_f32 v56, v56, v136
    v_fmac_f32 v56, v57, v137
    v_fmac_f32 v56, v58, v138
    v_fmac_f32 v56, v59, v139
    v_fmac_f32 v56, v60, v140
    v_fmac_f32 v56, v61, v141
    v_fmac_f32 v56, v62, v142
    v_fmac_f32 v56, v63, v143
    s_nop 0
    v_permlane32_swap_b32 v0, v8
    v_permlane32_swap_b32 v16, v24
    v_permlane32_swap_b32 v32, v40
    v_permlane32_swap_b32 v48, v56
    v_add_f32 v8, v0, v8
    v_add_f32 v24, v16, v24
    v_add_f32 v40, v32, v40
    v_add_f32 v56, v48, v56
    v_cvt_pk_bf16_f32 v8, v8, v40
    v_cvt_pk_bf16_f32 v24, v24, v56
    ds_write_b32 v243, v8 offset:0
    ds_write_b32 v243, v24 offset:256
    s_waitcnt lgkmcnt(4)
    v_mfma_f32_32x32x16_bf16 v[0:15], v[64:67], v[176:179], 0
    v_mfma_f32_32x32x16_bf16 v[16:31], v[68:71], v[176:179], 0
    s_waitcnt lgkmcnt(2)
    s_add_u32 m0, s29, 4096
    s_nop 0
    buffer_load_dwordx4 v222, s[4:7], s38 offen lds
    s_add_u32 m0, s29, 5120
    s_nop 0
    buffer_load_dwordx4 v223, s[4:7], s38 offen lds
    v_add_u32 v244, s43, v239
    ds_read_u16 v222, v244
    ds_read_u16 v223, v244 offset:64
    s_waitcnt vmcnt(6)
    ds_read_b64_tr_b16 v[176:177], v234 offset:6144
    ds_read_b64_tr_b16 v[178:179], v234 offset:6656
    v_mfma_f32_32x32x16_bf16 v[32:47], v[64:67], v[180:183], 0
    v_mfma_f32_32x32x16_bf16 v[48:63], v[68:71], v[180:183], 0
    ds_read_b64_tr_b16 v[180:181], v235 offset:6144
    ds_read_b64_tr_b16 v[182:183], v235 offset:6656
    s_waitcnt lgkmcnt(2)
    v_mfma_f32_32x32x16_bf16 v[0:15], v[72:75], v[176:179], v[0:15]
    v_mfma_f32_32x32x16_bf16 v[16:31], v[76:79], v[176:179], v[16:31]
    s_waitcnt lgkmcnt(0)
    s_add_u32 m0, s29, 6144
    s_nop 0
    buffer_load_dwordx4 v224, s[4:7], s38 offen lds
    s_add_u32 m0, s29, 7168
    s_nop 0
    buffer_load_dwordx4 v225, s[4:7], s38 offen lds
    v_add_u32 v244, s44, v239
    ds_read_u16 v224, v244
    ds_read_u16 v225, v244 offset:64
    s_waitcnt vmcnt(6)
    ds_read_b64_tr_b16 v[176:177], v234 offset:0
    ds_read_b64_tr_b16 v[178:179], v234 offset:512
    v_mfma_f32_32x32x16_bf16 v[32:47], v[72:75], v[180:183], v[32:47]
    v_mfma_f32_32x32x16_bf16 v[48:63], v[76:79], v[180:183], v[48:63]
    ds_read_b64_tr_b16 v[180:181], v235 offset:0
    ds_read_b64_tr_b16 v[182:183], v235 offset:512
    v_mul_f32 v184, v0, v144
    v_fmac_f32 v184, v1, v145
    v_fmac_f32 v184, v2, v146
    v_fmac_f32 v184, v3, v147
    v_fmac_f32 v184, v4, v148
    v_fmac_f32 v184, v5, v149
    v_fmac_f32 v184, v6, v150
    v_fmac_f32 v184, v7, v151
    v_mul_f32 v186, v8, v112
    v_fmac_f32 v186, v9, v113
    v_fmac_f32 v186, v10, v114
    v_fmac_f32 v186, v11, v115
    v_fmac_f32 v186, v12, v116
    v_fmac_f32 v186, v13, v117
    v_fmac_f32 v186, v14, v118
    v_fmac_f32 v186, v15, v119
    v_mul_f32_e64 v188, v16, -v160
    v_fma_f32 v188, v17, -v161, v188
    v_fma_f32 v188, v18, -v162, v188
    v_fma_f32 v188, v19, -v163, v188
    v_fma_f32 v188, v20, -v164, v188
    v_fma_f32 v188, v21, -v165, v188
    v_fma_f32 v188, v22, -v166, v188
    v_fma_f32 v188, v23, -v167, v188
    v_mul_f32 v190, v24, v160
    v_fmac_f32 v190, v25, v161
    v_fmac_f32 v190, v26, v162
    v_fmac_f32 v190, v27, v163
    v_fmac_f32 v190, v28, v164
    v_fmac_f32 v190, v29, v165
    v_fmac_f32 v190, v30, v166
    v_fmac_f32 v190, v31, v167
    v_mul_f32 v185, v32, v152
    v_fmac_f32 v185, v33, v153
    v_fmac_f32 v185, v34, v154
    v_fmac_f32 v185, v35, v155
    v_fmac_f32 v185, v36, v156
    v_fmac_f32 v185, v37, v157
    v_fmac_f32 v185, v38, v158
    v_fmac_f32 v185, v39, v159
    v_mul_f32 v187, v40, v120
    v_fmac_f32 v187, v41, v121
    v_fmac_f32 v187, v42, v122
    v_fmac_f32 v187, v43, v123
    v_fmac_f32 v187, v44, v124
    v_fmac_f32 v187, v45, v125
    v_fmac_f32 v187, v46, v126
    v_fmac_f32 v187, v47, v127
    v_mul_f32_e64 v189, v48, -v168
    v_fma_f32 v189, v49, -v169, v189
    v_fma_f32 v189, v50, -v170, v189
    v_fma_f32 v189, v51, -v171, v189
    v_fma_f32 v189, v52, -v172, v189
    v_fma_f32 v189, v53, -v173, v189
    v_fma_f32 v189, v54, -v174, v189
    v_fma_f32 v189, v55, -v175, v189
    v_mul_f32 v191, v56, v168
    v_fmac_f32 v191, v57, v169
    v_fmac_f32 v191, v58, v170
    v_fmac_f32 v191, v59, v171
    v_fmac_f32 v191, v60, v172
    v_fmac_f32 v191, v61, v173
    v_fmac_f32 v191, v62, v174
    v_fmac_f32 v191, v63, v175
    s_waitcnt lgkmcnt(2)
    v_mfma_f32_32x32x16_bf16 v[0:15], v[64:67], v[176:179], 0
    v_mfma_f32_32x32x16_bf16 v[16:31], v[68:71], v[176:179], 0
    v_lshl_add_u32 v222, v222, 10, v236
    v_lshl_add_u32 v223, v223, 10, v236
    s_waitcnt lgkmcnt(0)
    s_add_u32 m0, s29, 0
    s_nop 0
    buffer_load_dwordx4 v222, s[4:7], s39 offen lds
    s_add_u32 m0, s29, 1024
    s_nop 0
    buffer_load_dwordx4 v223, s[4:7], s39 offen lds
    s_waitcnt vmcnt(6)
    ds_read_b64_tr_b16 v[176:177], v234 offset:2048
    ds_read_b64_tr_b16 v[178:179], v234 offset:2560
    v_mfma_f32_32x32x16_bf16 v[32:47], v[64:67], v[180:183], 0
    v_mfma_f32_32x32x16_bf16 v[48:63], v[68:71], v[180:183], 0
    ds_read_b64_tr_b16 v[180:181], v235 offset:2048
    ds_read_b64_tr_b16 v[182:183], v235 offset:2560
    s_waitcnt lgkmcnt(2)
    v_mfma_f32_32x32x16_bf16 v[0:15], v[72:75], v[176:179], v[0:15]
    v_mfma_f32_32x32x16_bf16 v[16:31], v[76:79], v[176:179], v[16:31]
    v_lshl_add_u32 v224, v224, 10, v236
    v_lshl_add_u32 v225, v225, 10, v236
    s_waitcnt lgkmcnt(0)
    s_add_u32 m0, s29, 2048
    s_nop 0
    buffer_load_dwordx4 v224, s[4:7], s40 offen lds
    s_add_u32 m0, s29, 3072
    s_nop 0
    buffer_load_dwordx4 v225, s[4:7], s40 offen lds
    s_waitcnt vmcnt(6)
    ds_read_b64_tr_b16 v[176:177], v234 offset:4096
    ds_read_b64_tr_b16 v[178:179], v234 offset:4608
    v_mfma_f32_32x32x16_bf16 v[32:47], v[72:75], v[180:183], v[32:47]
    v_mfma_f32_32x32x16_bf16 v[48:63], v[76:79], v[180:183], v[48:63]
    ds_read_b64_tr_b16 v[180:181], v235 offset:4096
    ds_read_b64_tr_b16 v[182:183], v235 offset:4608
    v_mul_f32 v0, v0, v144
    v_fmac_f32 v0, v1, v145
    v_fmac_f32 v0, v2, v146
    v_fmac_f32 v0, v3, v147
    v_fmac_f32 v0, v4, v148
    v_fmac_f32 v0, v5, v149
    v_fmac_f32 v0, v6, v150
    v_fmac_f32 v0, v7, v151
    v_fmac_f32 v188, v8, v160
    v_fmac_f32 v188, v9, v161
    v_fmac_f32 v188, v10, v162
    v_fmac_f32 v188, v11, v163
    v_fmac_f32 v188, v12, v164
    v_fmac_f32 v188, v13, v165
    v_fmac_f32 v188, v14, v166
    v_fmac_f32 v188, v15, v167
    v_fmac_f32 v186, v16, v112
    v_fmac_f32 v186, v17, v113
    v_fmac_f32 v186, v18, v114
    v_fmac_f32 v186, v19, v115
    v_fmac_f32 v186, v20, v116
    v_fmac_f32 v186, v21, v117
    v_fmac_f32 v186, v22, v118
    v_fmac_f32 v186, v23, v119
    v_mul_f32_e64 v24, v24, -v160
    v_fma_f32 v24, v25, -v161, v24
    v_fma_f32 v24, v26, -v162, v24
    v_fma_f32 v24, v27, -v163, v24
    v_fma_f32 v24, v28, -v164, v24
    v_fma_f32 v24, v29, -v165, v24
    v_fma_f32 v24, v30, -v166, v24
    v_fma_f32 v24, v31, -v167, v24
    v_mul_f32 v32, v32, v152
    v_fmac_f32 v32, v33, v153
    v_fmac_f32 v32, v34, v154
    v_fmac_f32 v32, v35, v155
    v_fmac_f32 v32, v36, v156
    v_fmac_f32 v32, v37, v157
    v_fmac_f32 v32, v38, v158
    v_fmac_f32 v32, v39, v159
    v_fmac_f32 v189, v40, v168
    v_fmac_f32 v189, v41, v169
    v_fmac_f32 v189, v42, v170
    v_fmac_f32 v189, v43, v171
    v_fmac_f32 v189, v44, v172
    v_fmac_f32 v189, v45, v173
    v_fmac_f32 v189, v46, v174
    v_fmac_f32 v189, v47, v175
    v_fmac_f32 v187, v48, v120
    v_fmac_f32 v187, v49, v121
    v_fmac_f32 v187, v50, v122
    v_fmac_f32 v187, v51, v123
    v_fmac_f32 v187, v52, v124
    v_fmac_f32 v187, v53, v125
    v_fmac_f32 v187, v54, v126
    v_fmac_f32 v187, v55, v127
    v_mul_f32_e64 v56, v56, -v168
    v_fma_f32 v56, v57, -v169, v56
    v_fma_f32 v56, v58, -v170, v56
    v_fma_f32 v56, v59, -v171, v56
    v_fma_f32 v56, v60, -v172, v56
    v_fma_f32 v56, v61, -v173, v56
    v_fma_f32 v56, v62, -v174, v56
    v_fma_f32 v56, v63, -v175, v56
    s_nop 0
    s_nop 0
    v_permlane32_swap_b32 v184, v0
    v_permlane32_swap_b32 v185, v32
    v_add_f32 v0, v184, v0
    v_add_f32 v32, v185, v32
    v_mov_b32 v184, v24
    v_mov_b32 v185, v56
    v_cvt_pk_bf16_f32 v0, v0, v32
    ds_write_b32 v243, v0 offset:512
    s_waitcnt lgkmcnt(3)
    v_mfma_f32_32x32x16_bf16 v[0:15], v[64:67], v[176:179], 0
    v_mfma_f32_32x32x16_bf16 v[16:31], v[68:71], v[176:179], 0
    v_lshl_add_u32 v226, v226, 10, v236
    v_lshl_add_u32 v227, v227, 10, v236
    s_waitcnt lgkmcnt(1)
    s_add_u32 m0, s29, 4096
    s_nop 0
    buffer_load_dwordx4 v226, s[4:7], s41 offen lds
    s_add_u32 m0, s29, 5120
    s_nop 0
    buffer_load_dwordx4 v227, s[4:7], s41 offen lds
    s_waitcnt vmcnt(6)
    ds_read_b64_tr_b16 v[176:177], v234 offset:6144
    ds_read_b64_tr_b16 v[178:179], v234 offset:6656
    v_mfma_f32_32x32x16_bf16 v[32:47], v[64:67], v[180:183], 0
    v_mfma_f32_32x32x16_bf16 v[48:63], v[68:71], v[180:183], 0
    ds_read_b64_tr_b16 v[180:181], v235 offset:6144
    ds_read_b64_tr_b16 v[182:183], v235 offset:6656
    s_waitcnt lgkmcnt(2)
    v_mfma_f32_32x32x16_bf16 v[0:15], v[72:75], v[176:179], v[0:15]
    v_mfma_f32_32x32x16_bf16 v[16:31], v[76:79], v[176:179], v[16:31]
    v_lshl_add_u32 v228, v228, 10, v236
    v_lshl_add_u32 v229, v229, 10, v236
    s_waitcnt lgkmcnt(0)
    s_add_u32 m0, s29, 6144
    s_nop 0
    buffer_load_dwordx4 v228, s[4:7], s42 offen lds
    s_add_u32 m0, s29, 7168
    s_nop 0
    buffer_load_dwordx4 v229, s[4:7], s42 offen lds
    s_waitcnt vmcnt(6)
    ds_read_b64_tr_b16 v[176:177], v234 offset:0
    ds_read_b64_tr_b16 v[178:179], v234 offset:512
    v_mfma_f32_32x32x16_bf16 v[32:47], v[72:75], v[180:183], v[32:47]
    v_mfma_f32_32x32x16_bf16 v[48:63], v[76:79], v[180:183], v[48:63]
    ds_read_b64_tr_b16 v[180:181], v235 offset:0
    ds_read_b64_tr_b16 v[182:183], v235 offset:512
    v_add_u32 v241, s49, v237
    v_add_u32 v242, s43, v238
    ds_read_b64_tr_b16 v[68:69], v241 offset:0
    ds_read_b64_tr_b16 v[70:71], v241 offset:128
    s_mov_b64 exec, s[54:55]
    ds_read_u16_d16_hi v230, v242 offset:0
    s_mov_b64 exec, -1
    v_mul_f32 v0, v0, v144
    v_fmac_f32 v0, v1, v145
    v_fmac_f32 v0, v2, v146
    v_fmac_f32 v0, v3, v147
    v_fmac_f32 v0, v4, v148
    v_fmac_f32 v0, v5, v149
    v_fmac_f32 v0, v6, v150
    v_fmac_f32 v0, v7, v151
    v_fma_f32 v190, v8, -v160, v190
    v_fma_f32 v190, v9, -v161, v190
    v_fma_f32 v190, v10, -v162, v190
    v_fma_f32 v190, v11, -v163, v190
    v_fma_f32 v190, v12, -v164, v190
    v_fma_f32 v190, v13, -v165, v190
    v_fma_f32 v190, v14, -v166, v190
    v_fma_f32 v190, v15, -v167, v190
    v_fmac_f32 v184, v16, v160
    v_fmac_f32 v184, v17, v161
    v_fmac_f32 v184, v18, v162
    v_fmac_f32 v184, v19, v163
    v_fmac_f32 v184, v20, v164
    v_fmac_f32 v184, v21, v165
    v_fmac_f32 v184, v22, v166
    v_fmac_f32 v184, v23, v167
    v_fmac_f32 v186, v24, v112
    v_fmac_f32 v186, v25, v113
    v_fmac_f32 v186, v26, v114
    v_fmac_f32 v186, v27, v115
    v_fmac_f32 v186, v28, v116
    v_fmac_f32 v186, v29, v117
    v_fmac_f32 v186, v30, v118
    v_fmac_f32 v186, v31, v119
    v_mul_f32 v32, v32, v152
    v_fmac_f32 v32, v33, v153
    v_fmac_f32 v32, v34, v154
    v_fmac_f32 v32, v35, v155
    v_fmac_f32 v32, v36, v156
    v_fmac_f32 v32, v37, v157
    v_fmac_f32 v32, v38, v158
    v_fmac_f32 v32, v39, v159
    v_fma_f32 v191, v40, -v168, v191
    v_fma_f32 v191, v41, -v169, v191
    v_fma_f32 v191, v42, -v170, v191
    v_fma_f32 v191, v43, -v171, v191
    v_fma_f32 v191, v44, -v172, v191
    v_fma_f32 v191, v45, -v173, v191
    v_fma_f32 v191, v46, -v174, v191
    v_fma_f32 v191, v47, -v175, v191
    v_fmac_f32 v185, v48, v168
    v_fmac_f32 v185, v49, v169
    v_fmac_f32 v185, v50, v170
    v_fmac_f32 v185, v51, v171
    v_fmac_f32 v185, v52, v172
    v_fmac_f32 v185, v53, v173
    v_fmac_f32 v185, v54, v174
    v_fmac_f32 v185, v55, v175
    v_fmac_f32 v187, v56, v120
    v_fmac_f32 v187, v57, v121
    v_fmac_f32 v187, v58, v122
    v_fmac_f32 v187, v59, v123
    v_fmac_f32 v187, v60, v124
    v_fmac_f32 v187, v61, v125
    v_fmac_f32 v187, v62, v126
    v_fmac_f32 v187, v63, v127
    s_nop 0
    s_nop 0
    v_permlane32_swap_b32 v0, v188
    v_permlane32_swap_b32 v190, v8
    v_permlane32_swap_b32 v186, v184
    v_permlane32_swap_b32 v32, v189
    v_permlane32_swap_b32 v191, v40
    v_permlane32_swap_b32 v187, v185
    v_add_f32 v188, v0, v188
    v_add_f32 v8, v190, v8
    v_add_f32 v184, v186, v184
    v_add_f32 v189, v32, v189
    v_add_f32 v40, v191, v40
    v_add_f32 v185, v187, v185
    v_cvt_pk_bf16_f32 v188, v188, v189
    v_cvt_pk_bf16_f32 v8, v8, v40
    v_cvt_pk_bf16_f32 v184, v184, v185
    ds_write_b32 v243, v188 offset:768
    ds_write_b32 v243, v8 offset:1280
    ds_write_b32 v243, v184 offset:1024
    s_branch NEXT_1
.p2align 6
ITEM_1_3:
    ds_read_b64_tr_b16 v[76:77], v241 offset:512
    ds_read_b64_tr_b16 v[78:79], v241 offset:640
    s_mov_b64 exec, s[54:55]
    ds_read_u16_d16_hi v231, v242 offset:128
    s_mov_b64 exec, -1
    ds_read_b64_tr_b16 v[84:85], v241 offset:1024
    ds_read_b64_tr_b16 v[86:87], v241 offset:1152
    s_mov_b64 exec, s[54:55]
    ds_read_u16_d16_hi v232, v242 offset:256
    s_mov_b64 exec, -1
    v_add_u32 v244, s46, v239
    ds_read_u16 v228, v244
    ds_read_u16 v229, v244 offset:64
    v_xor_b32 v243, s69, v240
    v_add_u32 v243, s50, v243
    s_waitcnt lgkmcnt(8)
    v_lshlrev_b32 v184, 16, v68
    v_and_b32 v185, 0xffff0000, v68
    v_lshlrev_b32 v186, 16, v69
    v_and_b32 v187, 0xffff0000, v69
    v_mul_f32_dpp v188, v230, v184 row_newbcast:0 row_mask:0xf bank_mask:0xf
    v_mul_f32_dpp v189, v230, v185 row_newbcast:1 row_mask:0xf bank_mask:0xf
    v_mul_f32_dpp v190, v230, v184 row_newbcast:8 row_mask:0xf bank_mask:0xf
    v_mul_f32_dpp v191, v230, v185 row_newbcast:9 row_mask:0xf bank_mask:0xf
    v_lshlrev_b32 v184, 16, v70
    v_and_b32 v185, 0xffff0000, v70
    v_cvt_pk_bf16_f32 v64, v188, v189
    v_cvt_pk_bf16_f32 v68, v190, v191
    v_mul_f32_dpp v188, v230, v186 row_newbcast:2 row_mask:0xf bank_mask:0xf
    v_mul_f32_dpp v189, v230, v187 row_newbcast:3 row_mask:0xf bank_mask:0xf
    v_mul_f32_dpp v190, v230, v186 row_newbcast:10 row_mask:0xf bank_mask:0xf
    v_mul_f32_dpp v191, v230, v187 row_newbcast:11 row_mask:0xf bank_mask:0xf
    v_lshlrev_b32 v186, 16, v71
    v_and_b32 v187, 0xffff0000, v71
    v_cvt_pk_bf16_f32 v65, v188, v189
    v_cvt_pk_bf16_f32 v69, v190, v191
    v_mul_f32_dpp v188, v230, v184 row_newbcast:4 row_mask:0xf bank_mask:0xf
    v_mul_f32_dpp v189, v230, v185 row_newbcast:5 row_mask:0xf bank_mask:0xf
    v_mul_f32_dpp v190, v230, v184 row_newbcast:12 row_mask:0xf bank_mask:0xf
    v_mul_f32_dpp v191, v230, v185 row_newbcast:13 row_mask:0xf bank_mask:0xf
    v_cvt_pk_bf16_f32 v66, v188, v189
    v_cvt_pk_bf16_f32 v70, v190, v191
    v_mul_f32_dpp v188, v230, v186 row_newbcast:6 row_mask:0xf bank_mask:0xf
    v_mul_f32_dpp v189, v230, v187 row_newbcast:7 row_mask:0xf bank_mask:0xf
    v_mul_f32_dpp v190, v230, v186 row_newbcast:14 row_mask:0xf bank_mask:0xf
    v_mul_f32_dpp v191, v230, v187 row_newbcast:15 row_mask:0xf bank_mask:0xf
    v_cvt_pk_bf16_f32 v67, v188, v189
    v_cvt_pk_bf16_f32 v71, v190, v191
    s_nop 0
    s_waitcnt lgkmcnt(5)
    v_mfma_f32_32x32x16_bf16 v[0:15], v[64:67], v[176:179], 0
    v_lshlrev_b32 v184, 16, v76
    v_and_b32 v185, 0xffff0000, v76
    v_lshlrev_b32 v186, 16, v77
    v_and_b32 v187, 0xffff0000, v77
    v_mul_f32_dpp v188, v231, v184 row_newbcast:0 row_mask:0xf bank_mask:0xf
    v_mul_f32_dpp v189, v231, v185 row_newbcast:1 row_mask:0xf bank_mask:0xf
    v_mul_f32_dpp v190, v231, v184 row_newbcast:8 row_mask:0xf bank_mask:0xf
    v_mul_f32_dpp v191, v231, v185 row_newbcast:9 row_mask:0xf bank_mask:0xf
    v_mfma_f32_32x32x16_bf16 v[16:31], v[68:71], v[176:179], 0
    v_lshlrev_b32 v184, 16, v78
    v_and_b32 v185, 0xffff0000, v78
    v_cvt_pk_bf16_f32 v72, v188, v189
    v_cvt_pk_bf16_f32 v76, v190, v191
    v_mul_f32_dpp v188, v231, v186 row_newbcast:2 row_mask:0xf bank_mask:0xf
    v_mul_f32_dpp v189, v231, v187 row_newbcast:3 row_mask:0xf bank_mask:0xf
    v_mul_f32_dpp v190, v231, v186 row_newbcast:10 row_mask:0xf bank_mask:0xf
    v_mul_f32_dpp v191, v231, v187 row_newbcast:11 row_mask:0xf bank_mask:0xf
    s_add_u32 m0, s29, 0
    s_nop 0
    buffer_load_dwordx4 v224, s[4:7], s36 offen lds
    s_add_u32 m0, s29, 1024
    s_nop 0
    buffer_load_dwordx4 v225, s[4:7], s36 offen lds
    s_waitcnt vmcnt(6)
    ds_read_b64_tr_b16 v[176:177], v234 offset:2048
    ds_read_b64_tr_b16 v[178:179], v234 offset:2560
    v_mfma_f32_32x32x16_bf16 v[32:47], v[64:67], v[180:183], 0
    v_lshlrev_b32 v186, 16, v79
    v_and_b32 v187, 0xffff0000, v79
    v_cvt_pk_bf16_f32 v73, v188, v189
    v_cvt_pk_bf16_f32 v77, v190, v191
    v_mul_f32_dpp v188, v231, v184 row_newbcast:4 row_mask:0xf bank_mask:0xf
    v_mul_f32_dpp v189, v231, v185 row_newbcast:5 row_mask:0xf bank_mask:0xf
    v_mul_f32_dpp v190, v231, v184 row_newbcast:12 row_mask:0xf bank_mask:0xf
    v_mul_f32_dpp v191, v231, v185 row_newbcast:13 row_mask:0xf bank_mask:0xf
    v_mfma_f32_32x32x16_bf16 v[48:63], v[68:71], v[180:183], 0
    ds_read_b64_tr_b16 v[180:181], v235 offset:2048
    ds_read_b64_tr_b16 v[182:183], v235 offset:2560
    v_cvt_pk_bf16_f32 v74, v188, v189
    v_cvt_pk_bf16_f32 v78, v190, v191
    v_mul_f32_dpp v188, v231, v186 row_newbcast:6 row_mask:0xf bank_mask:0xf
    v_mul_f32_dpp v189, v231, v187 row_newbcast:7 row_mask:0xf bank_mask:0xf
    v_mul_f32_dpp v190, v231, v186 row_newbcast:14 row_mask:0xf bank_mask:0xf
    v_mul_f32_dpp v191, v231, v187 row_newbcast:15 row_mask:0xf bank_mask:0xf
    v_cvt_pk_bf16_f32 v75, v188, v189
    v_cvt_pk_bf16_f32 v79, v190, v191
    s_nop 0
    s_waitcnt lgkmcnt(6)
    s_waitcnt lgkmcnt(2)
    v_mfma_f32_32x32x16_bf16 v[0:15], v[72:75], v[176:179], v[0:15]
    v_lshlrev_b32 v184, 16, v84
    v_and_b32 v185, 0xffff0000, v84
    v_lshlrev_b32 v186, 16, v85
    v_and_b32 v187, 0xffff0000, v85
    v_mul_f32_dpp v188, v232, v184 row_newbcast:0 row_mask:0xf bank_mask:0xf
    v_mul_f32_dpp v189, v232, v185 row_newbcast:1 row_mask:0xf bank_mask:0xf
    v_mul_f32_dpp v190, v232, v184 row_newbcast:8 row_mask:0xf bank_mask:0xf
    v_mul_f32_dpp v191, v232, v185 row_newbcast:9 row_mask:0xf bank_mask:0xf
    v_mfma_f32_32x32x16_bf16 v[16:31], v[76:79], v[176:179], v[16:31]
    v_lshlrev_b32 v184, 16, v86
    v_and_b32 v185, 0xffff0000, v86
    v_cvt_pk_bf16_f32 v80, v188, v189
    v_cvt_pk_bf16_f32 v84, v190, v191
    v_mul_f32_dpp v188, v232, v186 row_newbcast:2 row_mask:0xf bank_mask:0xf
    v_mul_f32_dpp v189, v232, v187 row_newbcast:3 row_mask:0xf bank_mask:0xf
    v_mul_f32_dpp v190, v232, v186 row_newbcast:10 row_mask:0xf bank_mask:0xf
    v_mul_f32_dpp v191, v232, v187 row_newbcast:11 row_mask:0xf bank_mask:0xf
    s_waitcnt lgkmcnt(0)
    s_add_u32 m0, s29, 2048
    s_nop 0
    buffer_load_dwordx4 v226, s[4:7], s36 offen lds
    s_add_u32 m0, s29, 3072
    s_nop 0
    buffer_load_dwordx4 v227, s[4:7], s36 offen lds
    s_waitcnt vmcnt(6)
    ds_read_b64_tr_b16 v[176:177], v234 offset:4096
    ds_read_b64_tr_b16 v[178:179], v234 offset:4608
    v_mfma_f32_32x32x16_bf16 v[32:47], v[72:75], v[180:183], v[32:47]
    v_lshlrev_b32 v186, 16, v87
    v_and_b32 v187, 0xffff0000, v87
    v_cvt_pk_bf16_f32 v81, v188, v189
    v_cvt_pk_bf16_f32 v85, v190, v191
    v_mul_f32_dpp v188, v232, v184 row_newbcast:4 row_mask:0xf bank_mask:0xf
    v_mul_f32_dpp v189, v232, v185 row_newbcast:5 row_mask:0xf bank_mask:0xf
    v_mul_f32_dpp v190, v232, v184 row_newbcast:12 row_mask:0xf bank_mask:0xf
    v_mul_f32_dpp v191, v232, v185 row_newbcast:13 row_mask:0xf bank_mask:0xf
    v_mfma_f32_32x32x16_bf16 v[48:63], v[76:79], v[180:183], v[48:63]
    ds_read_b64_tr_b16 v[180:181], v235 offset:4096
    ds_read_b64_tr_b16 v[182:183], v235 offset:4608
    v_cvt_pk_bf16_f32 v82, v188, v189
    v_cvt_pk_bf16_f32 v86, v190, v191
    v_mul_f32_dpp v188, v232, v186 row_newbcast:6 row_mask:0xf bank_mask:0xf
    v_mul_f32_dpp v189, v232, v187 row_newbcast:7 row_mask:0xf bank_mask:0xf
    v_mul_f32_dpp v190, v232, v186 row_newbcast:14 row_mask:0xf bank_mask:0xf
    v_mul_f32_dpp v191, v232, v187 row_newbcast:15 row_mask:0xf bank_mask:0xf
    v_cvt_pk_bf16_f32 v83, v188, v189
    v_cvt_pk_bf16_f32 v87, v190, v191
    s_nop 0
    s_waitcnt lgkmcnt(2)
    v_mfma_f32_32x32x16_bf16 v[0:15], v[80:83], v[176:179], v[0:15]
    v_mfma_f32_32x32x16_bf16 v[16:31], v[84:87], v[176:179], v[16:31]
    s_waitcnt lgkmcnt(0)
    s_add_u32 m0, s29, 4096
    s_nop 0
    buffer_load_dwordx4 v222, s[4:7], s37 offen lds
    s_add_u32 m0, s29, 5120
    s_nop 0
    buffer_load_dwordx4 v223, s[4:7], s37 offen lds
    s_waitcnt vmcnt(6)
    ds_read_b64_tr_b16 v[176:177], v234 offset:6144
    ds_read_b64_tr_b16 v[178:179], v234 offset:6656
    v_mfma_f32_32x32x16_bf16 v[32:47], v[80:83], v[180:183], v[32:47]
    v_mfma_f32_32x32x16_bf16 v[48:63], v[84:87], v[180:183], v[48:63]
    ds_read_b64_tr_b16 v[180:181], v235 offset:6144
    ds_read_b64_tr_b16 v[182:183], v235 offset:6656
    v_mul_f32 v0, v0, v96
    v_fmac_f32 v0, v1, v97
    v_fmac_f32 v0, v2, v98
    v_fmac_f32 v0, v3, v99
    v_fmac_f32 v0, v4, v100
    v_fmac_f32 v0, v5, v101
    v_fmac_f32 v0, v6, v102
    v_fmac_f32 v0, v7, v103
    v_mul_f32 v8, v8, v128
    v_fmac_f32 v8, v9, v129
    v_fmac_f32 v8, v10, v130
    v_fmac_f32 v8, v11, v131
    v_fmac_f32 v8, v12, v132
    v_fmac_f32 v8, v13, v133
    v_fmac_f32 v8, v14, v134
    v_fmac_f32 v8, v15, v135
    v_mul_f32 v16, v16, v128
    v_fmac_f32 v16, v17, v129
    v_fmac_f32 v16, v18, v130
    v_fmac_f32 v16, v19, v131
    v_fmac_f32 v16, v20, v132
    v_fmac_f32 v16, v21, v133
    v_fmac_f32 v16, v22, v134
    v_fmac_f32 v16, v23, v135
    v_mul_f32 v24, v24, v128
    v_fmac_f32 v24, v25, v129
    v_fmac_f32 v24, v26, v130
    v_fmac_f32 v24, v27, v131
    v_fmac_f32 v24, v28, v132
    v_fmac_f32 v24, v29, v133
    v_fmac_f32 v24, v30, v134
    v_fmac_f32 v24, v31, v135
    v_mul_f32 v32, v32, v104
    v_fmac_f32 v32, v33, v105
    v_fmac_f32 v32, v34, v106
    v_fmac_f32 v32, v35, v107
    v_fmac_f32 v32, v36, v108
    v_fmac_f32 v32, v37, v109
    v_fmac_f32 v32, v38, v110
    v_fmac_f32 v32, v39, v111
    v_mul_f32 v40, v40, v136
    v_fmac_f32 v40, v41, v137
    v_fmac_f32 v40, v42, v138
    v_fmac_f32 v40, v43, v139
    v_fmac_f32 v40, v44, v140
    v_fmac_f32 v40, v45, v141
    v_fmac_f32 v40, v46, v142
    v_fmac_f32 v40, v47, v143
    v_mul_f32 v48, v48, v136
    v_fmac_f32 v48, v49, v137
    v_fmac_f32 v48, v50, v138
    v_fmac_f32 v48, v51, v139
    v_fmac_f32 v48, v52, v140
    v_fmac_f32 v48, v53, v141
    v_fmac_f32 v48, v54, v142
    v_fmac_f32 v48, v55, v143
    v_mul_f32 v56, v56, v136
    v_fmac_f32 v56, v57, v137
    v_fmac_f32 v56, v58, v138
    v_fmac_f32 v56, v59, v139
    v_fmac_f32 v56, v60, v140
    v_fmac_f32 v56, v61, v141
    v_fmac_f32 v56, v62, v142
    v_fmac_f32 v56, v63, v143
    s_nop 0
    v_permlane32_swap_b32 v0, v8
    v_permlane32_swap_b32 v16, v24
    v_permlane32_swap_b32 v32, v40
    v_permlane32_swap_b32 v48, v56
    v_add_f32 v8, v0, v8
    v_add_f32 v24, v16, v24
    v_add_f32 v40, v32, v40
    v_add_f32 v56, v48, v56
    v_cvt_pk_bf16_f32 v8, v8, v40
    v_cvt_pk_bf16_f32 v24, v24, v56
    ds_write_b32 v243, v8 offset:0
    ds_write_b32 v243, v24 offset:256
    s_waitcnt lgkmcnt(4)
    v_mfma_f32_32x32x16_bf16 v[0:15], v[64:67], v[176:179], 0
    v_mfma_f32_32x32x16_bf16 v[16:31], v[68:71], v[176:179], 0
    s_waitcnt lgkmcnt(2)
    s_add_u32 m0, s29, 6144
    s_nop 0
    buffer_load_dwordx4 v224, s[4:7], s37 offen lds
    s_add_u32 m0, s29, 7168
    s_nop 0
    buffer_load_dwordx4 v225, s[4:7], s37 offen lds
    s_waitcnt vmcnt(6)
    ds_read_b64_tr_b16 v[176:177], v234 offset:0
    ds_read_b64_tr_b16 v[178:179], v234 offset:512
    v_mfma_f32_32x32x16_bf16 v[32:47], v[64:67], v[180:183], 0
    v_mfma_f32_32x32x16_bf16 v[48:63], v[68:71], v[180:183], 0
    ds_read_b64_tr_b16 v[180:181], v235 offset:0
    ds_read_b64_tr_b16 v[182:183], v235 offset:512
    s_waitcnt lgkmcnt(2)
    v_mfma_f32_32x32x16_bf16 v[0:15], v[72:75], v[176:179], v[0:15]
    v_mfma_f32_32x32x16_bf16 v[16:31], v[76:79], v[176:179], v[16:31]
    s_waitcnt lgkmcnt(0)
    s_add_u32 m0, s29, 0
    s_nop 0
    buffer_load_dwordx4 v226, s[4:7], s37 offen lds
    s_add_u32 m0, s29, 1024
    s_nop 0
    buffer_load_dwordx4 v227, s[4:7], s37 offen lds
    s_waitcnt vmcnt(6)
    ds_read_b64_tr_b16 v[176:177], v234 offset:2048
    ds_read_b64_tr_b16 v[178:179], v234 offset:2560
    v_mfma_f32_32x32x16_bf16 v[32:47], v[72:75], v[180:183], v[32:47]
    v_mfma_f32_32x32x16_bf16 v[48:63], v[76:79], v[180:183], v[48:63]
    ds_read_b64_tr_b16 v[180:181], v235 offset:2048
    ds_read_b64_tr_b16 v[182:183], v235 offset:2560
    s_waitcnt lgkmcnt(2)
    v_mfma_f32_32x32x16_bf16 v[0:15], v[80:83], v[176:179], v[0:15]
    v_mfma_f32_32x32x16_bf16 v[16:31], v[84:87], v[176:179], v[16:31]
    s_waitcnt lgkmcnt(0)
    s_add_u32 m0, s29, 2048
    s_nop 0
    buffer_load_dwordx4 v222, s[4:7], s38 offen lds
    s_add_u32 m0, s29, 3072
    s_nop 0
    buffer_load_dwordx4 v223, s[4:7], s38 offen lds
    v_add_u32 v244, s43, v239
    ds_read_u16 v222, v244
    ds_read_u16 v223, v244 offset:64
    s_waitcnt vmcnt(6)
    ds_read_b64_tr_b16 v[176:177], v234 offset:4096
    ds_read_b64_tr_b16 v[178:179], v234 offset:4608
    v_mfma_f32_32x32x16_bf16 v[32:47], v[80:83], v[180:183], v[32:47]
    v_mfma_f32_32x32x16_bf16 v[48:63], v[84:87], v[180:183], v[48:63]
    ds_read_b64_tr_b16 v[180:181], v235 offset:4096
    ds_read_b64_tr_b16 v[182:183], v235 offset:4608
    v_mul_f32 v184, v0, v144
    v_fmac_f32 v184, v1, v145
    v_fmac_f32 v184, v2, v146
    v_fmac_f32 v184, v3, v147
    v_fmac_f32 v184, v4, v148
    v_fmac_f32 v184, v5, v149
    v_fmac_f32 v184, v6, v150
    v_fmac_f32 v184, v7, v151
    v_mul_f32 v186, v8, v112
    v_fmac_f32 v186, v9, v113
    v_fmac_f32 v186, v10, v114
    v_fmac_f32 v186, v11, v115
    v_fmac_f32 v186, v12, v116
    v_fmac_f32 v186, v13, v117
    v_fmac_f32 v186, v14, v118
    v_fmac_f32 v186, v15, v119
    v_mul_f32_e64 v188, v16, -v160
    v_fma_f32 v188, v17, -v161, v188
    v_fma_f32 v188, v18, -v162, v188
    v_fma_f32 v188, v19, -v163, v188
    v_fma_f32 v188, v20, -v164, v188
    v_fma_f32 v188, v21, -v165, v188
    v_fma_f32 v188, v22, -v166, v188
    v_fma_f32 v188, v23, -v167, v188
    v_mul_f32 v190, v24, v160
    v_fmac_f32 v190, v25, v161
    v_fmac_f32 v190, v26, v162
    v_fmac_f32 v190, v27, v163
    v_fmac_f32 v190, v28, v164
    v_fmac_f32 v190, v29, v165
    v_fmac_f32 v190, v30, v166
    v_fmac_f32 v190, v31, v167
    v_mul_f32 v185, v32, v152
    v_fmac_f32 v185, v33, v153
    v_fmac_f32 v185, v34, v154
    v_fmac_f32 v185, v35, v155
    v_fmac_f32 v185, v36, v156
    v_fmac_f32 v185, v37, v157
    v_fmac_f32 v185, v38, v158
    v_fmac_f32 v185, v39, v159
    v_mul_f32 v187, v40, v120
    v_fmac_f32 v187, v41, v121
    v_fmac_f32 v187, v42, v122
    v_fmac_f32 v187, v43, v123
    v_fmac_f32 v187, v44, v124
    v_fmac_f32 v187, v45, v125
    v_fmac_f32 v187, v46, v126
    v_fmac_f32 v187, v47, v127
    v_mul_f32_e64 v189, v48, -v168
    v_fma_f32 v189, v49, -v169, v189
    v_fma_f32 v189, v50, -v170, v189
    v_fma_f32 v189, v51, -v171, v189
    v_fma_f32 v189, v52, -v172, v189
    v_fma_f32 v189, v53, -v173, v189
    v_fma_f32 v189, v54, -v174, v189
    v_fma_f32 v189, v55, -v175, v189
    v_mul_f32 v191, v56, v168
    v_fmac_f32 v191, v57, v169
    v_fmac_f32 v191, v58, v170
    v_fmac_f32 v191, v59, v171
    v_fmac_f32 v191, v60, v172
    v_fmac_f32 v191, v61, v173
    v_fmac_f32 v191, v62, v174
    v_fmac_f32 v191, v63, v175
    s_waitcnt lgkmcnt(2)
    v_mfma_f32_32x32x16_bf16 v[0:15], v[64:67], v[176:179], 0
    v_mfma_f32_32x32x16_bf16 v[16:31], v[68:71], v[176:179], 0
    s_waitcnt lgkmcnt(0)
    s_add_u32 m0, s29, 4096
    s_nop 0
    buffer_load_dwordx4 v224, s[4:7], s38 offen lds
    s_add_u32 m0, s29, 5120
    s_nop 0
    buffer_load_dwordx4 v225, s[4:7], s38 offen lds
    v_add_u32 v244, s44, v239
    ds_read_u16 v224, v244
    ds_read_u16 v225, v244 offset:64
    s_waitcnt vmcnt(6)
    ds_read_b64_tr_b16 v[176:177], v234 offset:6144
    ds_read_b64_tr_b16 v[178:179], v234 offset:6656
    v_mfma_f32_32x32x16_bf16 v[32:47], v[64:67], v[180:183], 0
    v_mfma_f32_32x32x16_bf16 v[48:63], v[68:71], v[180:183], 0
    ds_read_b64_tr_b16 v[180:181], v235 offset:6144
    ds_read_b64_tr_b16 v[182:183], v235 offset:6656
    s_waitcnt lgkmcnt(2)
    v_mfma_f32_32x32x16_bf16 v[0:15], v[72:75], v[176:179], v[0:15]
    v_mfma_f32_32x32x16_bf16 v[16:31], v[76:79], v[176:179], v[16:31]
    s_waitcnt lgkmcnt(0)
    s_add_u32 m0, s29, 6144
    s_nop 0
    buffer_load_dwordx4 v226, s[4:7], s38 offen lds
    s_add_u32 m0, s29, 7168
    s_nop 0
    buffer_load_dwordx4 v227, s[4:7], s38 offen lds
    v_add_u32 v244, s45, v239
    ds_read_u16 v226, v244
    ds_read_u16 v227, v244 offset:64
    s_waitcnt vmcnt(6)
    ds_read_b64_tr_b16 v[176:177], v234 offset:0
    ds_read_b64_tr_b16 v[178:179], v234 offset:512
    v_mfma_f32_32x32x16_bf16 v[32:47], v[72:75], v[180:183], v[32:47]
    v_mfma_f32_32x32x16_bf16 v[48:63], v[76:79], v[180:183], v[48:63]
    ds_read_b64_tr_b16 v[180:181], v235 offset:0
    ds_read_b64_tr_b16 v[182:183], v235 offset:512
    s_waitcnt lgkmcnt(2)
    v_mfma_f32_32x32x16_bf16 v[0:15], v[80:83], v[176:179], v[0:15]
    v_mfma_f32_32x32x16_bf16 v[16:31], v[84:87], v[176:179], v[16:31]
    v_lshl_add_u32 v222, v222, 10, v236
    v_lshl_add_u32 v223, v223, 10, v236
    s_waitcnt lgkmcnt(0)
    s_add_u32 m0, s29, 0
    s_nop 0
    buffer_load_dwordx4 v222, s[4:7], s39 offen lds
    s_add_u32 m0, s29, 1024
    s_nop 0
    buffer_load_dwordx4 v223, s[4:7], s39 offen lds
    s_waitcnt vmcnt(6)
    ds_read_b64_tr_b16 v[176:177], v234 offset:2048
    ds_read_b64_tr_b16 v[178:179], v234 offset:2560
    v_mfma_f32_32x32x16_bf16 v[32:47], v[80:83], v[180:183], v[32:47]
    v_mfma_f32_32x32x16_bf16 v[48:63], v[84:87], v[180:183], v[48:63]
    ds_read_b64_tr_b16 v[180:181], v235 offset:2048
    ds_read_b64_tr_b16 v[182:183], v235 offset:2560
    v_mul_f32 v0, v0, v144
    v_fmac_f32 v0, v1, v145
    v_fmac_f32 v0, v2, v146
    v_fmac_f32 v0, v3, v147
    v_fmac_f32 v0, v4, v148
    v_fmac_f32 v0, v5, v149
    v_fmac_f32 v0, v6, v150
    v_fmac_f32 v0, v7, v151
    v_fmac_f32 v188, v8, v160
    v_fmac_f32 v188, v9, v161
    v_fmac_f32 v188, v10, v162
    v_fmac_f32 v188, v11, v163
    v_fmac_f32 v188, v12, v164
    v_fmac_f32 v188, v13, v165
    v_fmac_f32 v188, v14, v166
    v_fmac_f32 v188, v15, v167
    v_fmac_f32 v186, v16, v112
    v_fmac_f32 v186, v17, v113
    v_fmac_f32 v186, v18, v114
    v_fmac_f32 v186, v19, v115
    v_fmac_f32 v186, v20, v116
    v_fmac_f32 v186, v21, v117
    v_fmac_f32 v186, v22, v118
    v_fmac_f32 v186, v23, v119
    v_mul_f32_e64 v24, v24, -v160
    v_fma_f32 v24, v25, -v161, v24
    v_fma_f32 v24, v26, -v162, v24
    v_fma_f32 v24, v27, -v163, v24
    v_fma_f32 v24, v28, -v164, v24
    v_fma_f32 v24, v29, -v165, v24
    v_fma_f32 v24, v30, -v166, v24
    v_fma_f32 v24, v31, -v167, v24
    v_mul_f32 v32, v32, v152
    v_fmac_f32 v32, v33, v153
    v_fmac_f32 v32, v34, v154
    v_fmac_f32 v32, v35, v155
    v_fmac_f32 v32, v36, v156
    v_fmac_f32 v32, v37, v157
    v_fmac_f32 v32, v38, v158
    v_fmac_f32 v32, v39, v159
    v_fmac_f32 v189, v40, v168
    v_fmac_f32 v189, v41, v169
    v_fmac_f32 v189, v42, v170
    v_fmac_f32 v189, v43, v171
    v_fmac_f32 v189, v44, v172
    v_fmac_f32 v189, v45, v173
    v_fmac_f32 v189, v46, v174
    v_fmac_f32 v189, v47, v175
    v_fmac_f32 v187, v48, v120
    v_fmac_f32 v187, v49, v121
    v_fmac_f32 v187, v50, v122
    v_fmac_f32 v187, v51, v123
    v_fmac_f32 v187, v52, v124
    v_fmac_f32 v187, v53, v125
    v_fmac_f32 v187, v54, v126
    v_fmac_f32 v187, v55, v127
    v_mul_f32_e64 v56, v56, -v168
    v_fma_f32 v56, v57, -v169, v56
    v_fma_f32 v56, v58, -v170, v56
    v_fma_f32 v56, v59, -v171, v56
    v_fma_f32 v56, v60, -v172, v56
    v_fma_f32 v56, v61, -v173, v56
    v_fma_f32 v56, v62, -v174, v56
    v_fma_f32 v56, v63, -v175, v56
    s_nop 0
    s_nop 0
    v_permlane32_swap_b32 v184, v0
    v_permlane32_swap_b32 v185, v32
    v_add_f32 v0, v184, v0
    v_add_f32 v32, v185, v32
    v_mov_b32 v184, v24
    v_mov_b32 v185, v56
    v_cvt_pk_bf16_f32 v0, v0, v32
    ds_write_b32 v243, v0 offset:512
    s_waitcnt lgkmcnt(3)
    v_mfma_f32_32x32x16_bf16 v[0:15], v[64:67], v[176:179], 0
    v_mfma_f32_32x32x16_bf16 v[16:31], v[68:71], v[176:179], 0
    v_lshl_add_u32 v224, v224, 10, v236
    v_lshl_add_u32 v225, v225, 10, v236
    s_waitcnt lgkmcnt(1)
    s_add_u32 m0, s29, 2048
    s_nop 0
    buffer_load_dwordx4 v224, s[4:7], s40 offen lds
    s_add_u32 m0, s29, 3072
    s_nop 0
    buffer_load_dwordx4 v225, s[4:7], s40 offen lds
    s_waitcnt vmcnt(6)
    ds_read_b64_tr_b16 v[176:177], v234 offset:4096
    ds_read_b64_tr_b16 v[178:179], v234 offset:4608
    v_mfma_f32_32x32x16_bf16 v[32:47], v[64:67], v[180:183], 0
    v_mfma_f32_32x32x16_bf16 v[48:63], v[68:71], v[180:183], 0
    ds_read_b64_tr_b16 v[180:181], v235 offset:4096
    ds_read_b64_tr_b16 v[182:183], v235 offset:4608
    s_waitcnt lgkmcnt(2)
    v_mfma_f32_32x32x16_bf16 v[0:15], v[72:75], v[176:179], v[0:15]
    v_mfma_f32_32x32x16_bf16 v[16:31], v[76:79], v[176:179], v[16:31]
    v_lshl_add_u32 v226, v226, 10, v236
    v_lshl_add_u32 v227, v227, 10, v236
    s_waitcnt lgkmcnt(0)
    s_add_u32 m0, s29, 4096
    s_nop 0
    buffer_load_dwordx4 v226, s[4:7], s41 offen lds
    s_add_u32 m0, s29, 5120
    s_nop 0
    buffer_load_dwordx4 v227, s[4:7], s41 offen lds
    s_waitcnt vmcnt(6)
    ds_read_b64_tr_b16 v[176:177], v234 offset:6144
    ds_read_b64_tr_b16 v[178:179], v234 offset:6656
    v_mfma_f32_32x32x16_bf16 v[32:47], v[72:75], v[180:183], v[32:47]
    v_mfma_f32_32x32x16_bf16 v[48:63], v[76:79], v[180:183], v[48:63]
    ds_read_b64_tr_b16 v[180:181], v235 offset:6144
    ds_read_b64_tr_b16 v[182:183], v235 offset:6656
    s_waitcnt lgkmcnt(2)
    v_mfma_f32_32x32x16_bf16 v[0:15], v[80:83], v[176:179], v[0:15]
    v_mfma_f32_32x32x16_bf16 v[16:31], v[84:87], v[176:179], v[16:31]
    v_lshl_add_u32 v228, v228, 10, v236
    v_lshl_add_u32 v229, v229, 10, v236
    s_waitcnt lgkmcnt(0)
    s_add_u32 m0, s29, 6144
    s_nop 0
    buffer_load_dwordx4 v228, s[4:7], s42 offen lds
    s_add_u32 m0, s29, 7168
    s_nop 0
    buffer_load_dwordx4 v229, s[4:7], s42 offen lds
    s_waitcnt vmcnt(6)
    ds_read_b64_tr_b16 v[176:177], v234 offset:0
    ds_read_b64_tr_b16 v[178:179], v234 offset:512
    v_mfma_f32_32x32x16_bf16 v[32:47], v[80:83], v[180:183], v[32:47]
    v_mfma_f32_32x32x16_bf16 v[48:63], v[84:87], v[180:183], v[48:63]
    ds_read_b64_tr_b16 v[180:181], v235 offset:0
    ds_read_b64_tr_b16 v[182:183], v235 offset:512
    v_add_u32 v241, s49, v237
    v_add_u32 v242, s43, v238
    ds_read_b64_tr_b16 v[68:69], v241 offset:0
    ds_read_b64_tr_b16 v[70:71], v241 offset:128
    s_mov_b64 exec, s[54:55]
    ds_read_u16_d16_hi v230, v242 offset:0
    s_mov_b64 exec, -1
    v_mul_f32 v0, v0, v144
    v_fmac_f32 v0, v1, v145
    v_fmac_f32 v0, v2, v146
    v_fmac_f32 v0, v3, v147
    v_fmac_f32 v0, v4, v148
    v_fmac_f32 v0, v5, v149
    v_fmac_f32 v0, v6, v150
    v_fmac_f32 v0, v7, v151
    v_fma_f32 v190, v8, -v160, v190
    v_fma_f32 v190, v9, -v161, v190
    v_fma_f32 v190, v10, -v162, v190
    v_fma_f32 v190, v11, -v163, v190
    v_fma_f32 v190, v12, -v164, v190
    v_fma_f32 v190, v13, -v165, v190
    v_fma_f32 v190, v14, -v166, v190
    v_fma_f32 v190, v15, -v167, v190
    v_fmac_f32 v184, v16, v160
    v_fmac_f32 v184, v17, v161
    v_fmac_f32 v184, v18, v162
    v_fmac_f32 v184, v19, v163
    v_fmac_f32 v184, v20, v164
    v_fmac_f32 v184, v21, v165
    v_fmac_f32 v184, v22, v166
    v_fmac_f32 v184, v23, v167
    v_fmac_f32 v186, v24, v112
    v_fmac_f32 v186, v25, v113
    v_fmac_f32 v186, v26, v114
    v_fmac_f32 v186, v27, v115
    v_fmac_f32 v186, v28, v116
    v_fmac_f32 v186, v29, v117
    v_fmac_f32 v186, v30, v118
    v_fmac_f32 v186, v31, v119
    v_mul_f32 v32, v32, v152
    v_fmac_f32 v32, v33, v153
    v_fmac_f32 v32, v34, v154
    v_fmac_f32 v32, v35, v155
    v_fmac_f32 v32, v36, v156
    v_fmac_f32 v32, v37, v157
    v_fmac_f32 v32, v38, v158
    v_fmac_f32 v32, v39, v159
    v_fma_f32 v191, v40, -v168, v191
    v_fma_f32 v191, v41, -v169, v191
    v_fma_f32 v191, v42, -v170, v191
    v_fma_f32 v191, v43, -v171, v191
    v_fma_f32 v191, v44, -v172, v191
    v_fma_f32 v191, v45, -v173, v191
    v_fma_f32 v191, v46, -v174, v191
    v_fma_f32 v191, v47, -v175, v191
    v_fmac_f32 v185, v48, v168
    v_fmac_f32 v185, v49, v169
    v_fmac_f32 v185, v50, v170
    v_fmac_f32 v185, v51, v171
    v_fmac_f32 v185, v52, v172
    v_fmac_f32 v185, v53, v173
    v_fmac_f32 v185, v54, v174
    v_fmac_f32 v185, v55, v175
    v_fmac_f32 v187, v56, v120
    v_fmac_f32 v187, v57, v121
    v_fmac_f32 v187, v58, v122
    v_fmac_f32 v187, v59, v123
    v_fmac_f32 v187, v60, v124
    v_fmac_f32 v187, v61, v125
    v_fmac_f32 v187, v62, v126
    v_fmac_f32 v187, v63, v127
    s_nop 0
    s_nop 0
    v_permlane32_swap_b32 v0, v188
    v_permlane32_swap_b32 v190, v8
    v_permlane32_swap_b32 v186, v184
    v_permlane32_swap_b32 v32, v189
    v_permlane32_swap_b32 v191, v40
    v_permlane32_swap_b32 v187, v185
    v_add_f32 v188, v0, v188
    v_add_f32 v8, v190, v8
    v_add_f32 v184, v186, v184
    v_add_f32 v189, v32, v189
    v_add_f32 v40, v191, v40
    v_add_f32 v185, v187, v185
    v_cvt_pk_bf16_f32 v188, v188, v189
    v_cvt_pk_bf16_f32 v8, v8, v40
    v_cvt_pk_bf16_f32 v184, v184, v185
    ds_write_b32 v243, v188 offset:768
    ds_write_b32 v243, v8 offset:1280
    ds_write_b32 v243, v184 offset:1024
    s_branch NEXT_1
.p2align 6
ITEM_1_4:
    ds_read_b64_tr_b16 v[76:77], v241 offset:512
    ds_read_b64_tr_b16 v[78:79], v241 offset:640
    s_mov_b64 exec, s[54:55]
    ds_read_u16_d16_hi v231, v242 offset:128
    s_mov_b64 exec, -1
    ds_read_b64_tr_b16 v[84:85], v241 offset:1024
    ds_read_b64_tr_b16 v[86:87], v241 offset:1152
    s_mov_b64 exec, s[54:55]
    ds_read_u16_d16_hi v232, v242 offset:256
    s_mov_b64 exec, -1
    ds_read_b64_tr_b16 v[92:93], v241 offset:1536
    ds_read_b64_tr_b16 v[94:95], v241 offset:1664
    s_mov_b64 exec, s[54:55]
    ds_read_u16_d16_hi v233, v242 offset:384
    s_mov_b64 exec, -1
    v_xor_b32 v243, s69, v240
    v_add_u32 v243, s50, v243
    s_waitcnt lgkmcnt(9)
    v_lshlrev_b32 v184, 16, v68
    v_and_b32 v185, 0xffff0000, v68
    v_lshlrev_b32 v186, 16, v69
    v_and_b32 v187, 0xffff0000, v69
    v_mul_f32_dpp v188, v230, v184 row_newbcast:0 row_mask:0xf bank_mask:0xf
    v_mul_f32_dpp v189, v230, v185 row_newbcast:1 row_mask:0xf bank_mask:0xf
    v_mul_f32_dpp v190, v230, v184 row_newbcast:8 row_mask:0xf bank_mask:0xf
    v_mul_f32_dpp v191, v230, v185 row_newbcast:9 row_mask:0xf bank_mask:0xf
    v_lshlrev_b32 v184, 16, v70
    v_and_b32 v185, 0xffff0000, v70
    v_cvt_pk_bf16_f32 v64, v188, v189
    v_cvt_pk_bf16_f32 v68, v190, v191
    v_mul_f32_dpp v188, v230, v186 row_newbcast:2 row_mask:0xf bank_mask:0xf
    v_mul_f32_dpp v189, v230, v187 row_newbcast:3 row_mask:0xf bank_mask:0xf
    v_mul_f32_dpp v190, v230, v186 row_newbcast:10 row_mask:0xf bank_mask:0xf
    v_mul_f32_dpp v191, v230, v187 row_newbcast:11 row_mask:0xf bank_mask:0xf
    v_lshlrev_b32 v186, 16, v71
    v_and_b32 v187, 0xffff0000, v71
    v_cvt_pk_bf16_f32 v65, v188, v189
    v_cvt_pk_bf16_f32 v69, v190, v191
    v_mul_f32_dpp v188, v230, v184 row_newbcast:4 row_mask:0xf bank_mask:0xf
    v_mul_f32_dpp v189, v230, v185 row_newbcast:5 row_mask:0xf bank_mask:0xf
    v_mul_f32_dpp v190, v230, v184 row_newbcast:12 row_mask:0xf bank_mask:0xf
    v_mul_f32_dpp v191, v230, v185 row_newbcast:13 row_mask:0xf bank_mask:0xf
    v_cvt_pk_bf16_f32 v66, v188, v189
    v_cvt_pk_bf16_f32 v70, v190, v191
    v_mul_f32_dpp v188, v230, v186 row_newbcast:6 row_mask:0xf bank_mask:0xf
    v_mul_f32_dpp v189, v230, v187 row_newbcast:7 row_mask:0xf bank_mask:0xf
    v_mul_f32_dpp v190, v230, v186 row_newbcast:14 row_mask:0xf bank_mask:0xf
    v_mul_f32_dpp v191, v230, v187 row_newbcast:15 row_mask:0xf bank_mask:0xf
    v_cvt_pk_bf16_f32 v67, v188, v189
    v_cvt_pk_bf16_f32 v71, v190, v191
    s_nop 0
    s_waitcnt lgkmcnt(6)
    v_mfma_f32_32x32x16_bf16 v[0:15], v[64:67], v[176:179], 0
    v_lshlrev_b32 v184, 16, v76
    v_and_b32 v185, 0xffff0000, v76
    v_lshlrev_b32 v186, 16, v77
    v_and_b32 v187, 0xffff0000, v77
    v_mul_f32_dpp v188, v231, v184 row_newbcast:0 row_mask:0xf bank_mask:0xf
    v_mul_f32_dpp v189, v231, v185 row_newbcast:1 row_mask:0xf bank_mask:0xf
    v_mul_f32_dpp v190, v231, v184 row_newbcast:8 row_mask:0xf bank_mask:0xf
    v_mul_f32_dpp v191, v231, v185 row_newbcast:9 row_mask:0xf bank_mask:0xf
    v_mfma_f32_32x32x16_bf16 v[16:31], v[68:71], v[176:179], 0
    v_lshlrev_b32 v184, 16, v78
    v_and_b32 v185, 0xffff0000, v78
    v_cvt_pk_bf16_f32 v72, v188, v189
    v_cvt_pk_bf16_f32 v76, v190, v191
    v_mul_f32_dpp v188, v231, v186 row_newbcast:2 row_mask:0xf bank_mask:0xf
    v_mul_f32_dpp v189, v231, v187 row_newbcast:3 row_mask:0xf bank_mask:0xf
    v_mul_f32_dpp v190, v231, v186 row_newbcast:10 row_mask:0xf bank_mask:0xf
    v_mul_f32_dpp v191, v231, v187 row_newbcast:11 row_mask:0xf bank_mask:0xf
    s_add_u32 m0, s29, 0
    s_nop 0
    buffer_load_dwordx4 v222, s[4:7], s36 offen lds
    s_add_u32 m0, s29, 1024
    s_nop 0
    buffer_load_dwordx4 v223, s[4:7], s36 offen lds
    s_waitcnt vmcnt(6)
    ds_read_b64_tr_b16 v[176:177], v234 offset:2048
    ds_read_b64_tr_b16 v[178:179], v234 offset:2560
    v_mfma_f32_32x32x16_bf16 v[32:47], v[64:67], v[180:183], 0
    v_lshlrev_b32 v186, 16, v79
    v_and_b32 v187, 0xffff0000, v79
    v_cvt_pk_bf16_f32 v73, v188, v189
    v_cvt_pk_bf16_f32 v77, v190, v191
    v_mul_f32_dpp v188, v231, v184 row_newbcast:4 row_mask:0xf bank_mask:0xf
    v_mul_f32_dpp v189, v231, v185 row_newbcast:5 row_mask:0xf bank_mask:0xf
    v_mul_f32_dpp v190, v231, v184 row_newbcast:12 row_mask:0xf bank_mask:0xf
    v_mul_f32_dpp v191, v231, v185 row_newbcast:13 row_mask:0xf bank_mask:0xf
    v_mfma_f32_32x32x16_bf16 v[48:63], v[68:71], v[180:183], 0
    ds_read_b64_tr_b16 v[180:181], v235 offset:2048
    ds_read_b64_tr_b16 v[182:183], v235 offset:2560
    v_cvt_pk_bf16_f32 v74, v188, v189
    v_cvt_pk_bf16_f32 v78, v190, v191
    v_mul_f32_dpp v188, v231, v186 row_newbcast:6 row_mask:0xf bank_mask:0xf
    v_mul_f32_dpp v189, v231, v187 row_newbcast:7 row_mask:0xf bank_mask:0xf
    v_mul_f32_dpp v190, v231, v186 row_newbcast:14 row_mask:0xf bank_mask:0xf
    v_mul_f32_dpp v191, v231, v187 row_newbcast:15 row_mask:0xf bank_mask:0xf
    v_cvt_pk_bf16_f32 v75, v188, v189
    v_cvt_pk_bf16_f32 v79, v190, v191
    s_nop 0
    s_waitcnt lgkmcnt(7)
    s_waitcnt lgkmcnt(2)
    v_mfma_f32_32x32x16_bf16 v[0:15], v[72:75], v[176:179], v[0:15]
    v_lshlrev_b32 v184, 16, v84
    v_and_b32 v185, 0xffff0000, v84
    v_lshlrev_b32 v186, 16, v85
    v_and_b32 v187, 0xffff0000, v85
    v_mul_f32_dpp v188, v232, v184 row_newbcast:0 row_mask:0xf bank_mask:0xf
    v_mul_f32_dpp v189, v232, v185 row_newbcast:1 row_mask:0xf bank_mask:0xf
    v_mul_f32_dpp v190, v232, v184 row_newbcast:8 row_mask:0xf bank_mask:0xf
    v_mul_f32_dpp v191, v232, v185 row_newbcast:9 row_mask:0xf bank_mask:0xf
    v_mfma_f32_32x32x16_bf16 v[16:31], v[76:79], v[176:179], v[16:31]
    v_lshlrev_b32 v184, 16, v86
    v_and_b32 v185, 0xffff0000, v86
    v_cvt_pk_bf16_f32 v80, v188, v189
    v_cvt_pk_bf16_f32 v84, v190, v191
    v_mul_f32_dpp v188, v232, v186 row_newbcast:2 row_mask:0xf bank_mask:0xf
    v_mul_f32_dpp v189, v232, v187 row_newbcast:3 row_mask:0xf bank_mask:0xf
    v_mul_f32_dpp v190, v232, v186 row_newbcast:10 row_mask:0xf bank_mask:0xf
    v_mul_f32_dpp v191, v232, v187 row_newbcast:11 row_mask:0xf bank_mask:0xf
    s_waitcnt lgkmcnt(0)
    s_add_u32 m0, s29, 2048
    s_nop 0
    buffer_load_dwordx4 v224, s[4:7], s36 offen lds
    s_add_u32 m0, s29, 3072
    s_nop 0
    buffer_load_dwordx4 v225, s[4:7], s36 offen lds
    s_waitcnt vmcnt(6)
    ds_read_b64_tr_b16 v[176:177], v234 offset:4096
    ds_read_b64_tr_b16 v[178:179], v234 offset:4608
    v_mfma_f32_32x32x16_bf16 v[32:47], v[72:75], v[180:183], v[32:47]
    v_lshlrev_b32 v186, 16, v87
    v_and_b32 v187, 0xffff0000, v87
    v_cvt_pk_bf16_f32 v81, v188, v189
    v_cvt_pk_bf16_f32 v85, v190, v191
    v_mul_f32_dpp v188, v232, v184 row_newbcast:4 row_mask:0xf bank_mask:0xf
    v_mul_f32_dpp v189, v232, v185 row_newbcast:5 row_mask:0xf bank_mask:0xf
    v_mul_f32_dpp v190, v232, v184 row_newbcast:12 row_mask:0xf bank_mask:0xf
    v_mul_f32_dpp v191, v232, v185 row_newbcast:13 row_mask:0xf bank_mask:0xf
    v_mfma_f32_32x32x16_bf16 v[48:63], v[76:79], v[180:183], v[48:63]
    ds_read_b64_tr_b16 v[180:181], v235 offset:4096
    ds_read_b64_tr_b16 v[182:183], v235 offset:4608
    v_cvt_pk_bf16_f32 v82, v188, v189
    v_cvt_pk_bf16_f32 v86, v190, v191
    v_mul_f32_dpp v188, v232, v186 row_newbcast:6 row_mask:0xf bank_mask:0xf
    v_mul_f32_dpp v189, v232, v187 row_newbcast:7 row_mask:0xf bank_mask:0xf
    v_mul_f32_dpp v190, v232, v186 row_newbcast:14 row_mask:0xf bank_mask:0xf
    v_mul_f32_dpp v191, v232, v187 row_newbcast:15 row_mask:0xf bank_mask:0xf
    v_cvt_pk_bf16_f32 v83, v188, v189
    v_cvt_pk_bf16_f32 v87, v190, v191
    s_nop 0
    s_waitcnt lgkmcnt(2)
    v_mfma_f32_32x32x16_bf16 v[0:15], v[80:83], v[176:179], v[0:15]
    v_lshlrev_b32 v184, 16, v92
    v_and_b32 v185, 0xffff0000, v92
    v_lshlrev_b32 v186, 16, v93
    v_and_b32 v187, 0xffff0000, v93
    v_mul_f32_dpp v188, v233, v184 row_newbcast:0 row_mask:0xf bank_mask:0xf
    v_mul_f32_dpp v189, v233, v185 row_newbcast:1 row_mask:0xf bank_mask:0xf
    v_mul_f32_dpp v190, v233, v184 row_newbcast:8 row_mask:0xf bank_mask:0xf
    v_mul_f32_dpp v191, v233, v185 row_newbcast:9 row_mask:0xf bank_mask:0xf
    v_mfma_f32_32x32x16_bf16 v[16:31], v[84:87], v[176:179], v[16:31]
    v_lshlrev_b32 v184, 16, v94
    v_and_b32 v185, 0xffff0000, v94
    v_cvt_pk_bf16_f32 v88, v188, v189
    v_cvt_pk_bf16_f32 v92, v190, v191
    v_mul_f32_dpp v188, v233, v186 row_newbcast:2 row_mask:0xf bank_mask:0xf
    v_mul_f32_dpp v189, v233, v187 row_newbcast:3 row_mask:0xf bank_mask:0xf
    v_mul_f32_dpp v190, v233, v186 row_newbcast:10 row_mask:0xf bank_mask:0xf
    v_mul_f32_dpp v191, v233, v187 row_newbcast:11 row_mask:0xf bank_mask:0xf
    s_waitcnt lgkmcnt(0)
    s_add_u32 m0, s29, 4096
    s_nop 0
    buffer_load_dwordx4 v226, s[4:7], s36 offen lds
    s_add_u32 m0, s29, 5120
    s_nop 0
    buffer_load_dwordx4 v227, s[4:7], s36 offen lds
    s_waitcnt vmcnt(6)
    ds_read_b64_tr_b16 v[176:177], v234 offset:6144
    ds_read_b64_tr_b16 v[178:179], v234 offset:6656
    v_mfma_f32_32x32x16_bf16 v[32:47], v[80:83], v[180:183], v[32:47]
    v_lshlrev_b32 v186, 16, v95
    v_and_b32 v187, 0xffff0000, v95
    v_cvt_pk_bf16_f32 v89, v188, v189
    v_cvt_pk_bf16_f32 v93, v190, v191
    v_mul_f32_dpp v188, v233, v184 row_newbcast:4 row_mask:0xf bank_mask:0xf
    v_mul_f32_dpp v189, v233, v185 row_newbcast:5 row_mask:0xf bank_mask:0xf
    v_mul_f32_dpp v190, v233, v184 row_newbcast:12 row_mask:0xf bank_mask:0xf
    v_mul_f32_dpp v191, v233, v185 row_newbcast:13 row_mask:0xf bank_mask:0xf
    v_mfma_f32_32x32x16_bf16 v[48:63], v[84:87], v[180:183], v[48:63]
    ds_read_b64_tr_b16 v[180:181], v235 offset:6144
    ds_read_b64_tr_b16 v[182:183], v235 offset:6656
    v_cvt_pk_bf16_f32 v90, v188, v189
    v_cvt_pk_bf16_f32 v94, v190, v191
    v_mul_f32_dpp v188, v233, v186 row_newbcast:6 row_mask:0xf bank_mask:0xf
    v_mul_f32_dpp v189, v233, v187 row_newbcast:7 row_mask:0xf bank_mask:0xf
    v_mul_f32_dpp v190, v233, v186 row_newbcast:14 row_mask:0xf bank_mask:0xf
    v_mul_f32_dpp v191, v233, v187 row_newbcast:15 row_mask:0xf bank_mask:0xf
    v_cvt_pk_bf16_f32 v91, v188, v189
    v_cvt_pk_bf16_f32 v95, v190, v191
    s_nop 0
    s_waitcnt lgkmcnt(2)
    v_mfma_f32_32x32x16_bf16 v[0:15], v[88:91], v[176:179], v[0:15]
    v_mfma_f32_32x32x16_bf16 v[16:31], v[92:95], v[176:179], v[16:31]
    s_waitcnt lgkmcnt(0)
    s_add_u32 m0, s29, 6144
    s_nop 0
    buffer_load_dwordx4 v228, s[4:7], s36 offen lds
    s_add_u32 m0, s29, 7168
    s_nop 0
    buffer_load_dwordx4 v229, s[4:7], s36 offen lds
    s_waitcnt vmcnt(6)
    ds_read_b64_tr_b16 v[176:177], v234 offset:0
    ds_read_b64_tr_b16 v[178:179], v234 offset:512
    v_mfma_f32_32x32x16_bf16 v[32:47], v[88:91], v[180:183], v[32:47]
    v_mfma_f32_32x32x16_bf16 v[48:63], v[92:95], v[180:183], v[48:63]
    ds_read_b64_tr_b16 v[180:181], v235 offset:0
    ds_read_b64_tr_b16 v[182:183], v235 offset:512
    v_mul_f32 v0, v0, v96
    v_fmac_f32 v0, v1, v97
    v_fmac_f32 v0, v2, v98
    v_fmac_f32 v0, v3, v99
    v_fmac_f32 v0, v4, v100
    v_fmac_f32 v0, v5, v101
    v_fmac_f32 v0, v6, v102
    v_fmac_f32 v0, v7, v103
    v_mul_f32 v8, v8, v128
    v_fmac_f32 v8, v9, v129
    v_fmac_f32 v8, v10, v130
    v_fmac_f32 v8, v11, v131
    v_fmac_f32 v8, v12, v132
    v_fmac_f32 v8, v13, v133
    v_fmac_f32 v8, v14, v134
    v_fmac_f32 v8, v15, v135
    v_mul_f32 v16, v16, v128
    v_fmac_f32 v16, v17, v129
    v_fmac_f32 v16, v18, v130
    v_fmac_f32 v16, v19, v131
    v_fmac_f32 v16, v20, v132
    v_fmac_f32 v16, v21, v133
    v_fmac_f32 v16, v22, v134
    v_fmac_f32 v16, v23, v135
    v_mul_f32 v24, v24, v128
    v_fmac_f32 v24, v25, v129
    v_fmac_f32 v24, v26, v130
    v_fmac_f32 v24, v27, v131
    v_fmac_f32 v24, v28, v132
    v_fmac_f32 v24, v29, v133
    v_fmac_f32 v24, v30, v134
    v_fmac_f32 v24, v31, v135
    v_mul_f32 v32, v32, v104
    v_fmac_f32 v32, v33, v105
    v_fmac_f32 v32, v34, v106
    v_fmac_f32 v32, v35, v107
    v_fmac_f32 v32, v36, v108
    v_fmac_f32 v32, v37, v109
    v_fmac_f32 v32, v38, v110
    v_fmac_f32 v32, v39, v111
    v_mul_f32 v40, v40, v136
    v_fmac_f32 v40, v41, v137
    v_fmac_f32 v40, v42, v138
    v_fmac_f32 v40, v43, v139
    v_fmac_f32 v40, v44, v140
    v_fmac_f32 v40, v45, v141
    v_fmac_f32 v40, v46, v142
    v_fmac_f32 v40, v47, v143
    v_mul_f32 v48, v48, v136
    v_fmac_f32 v48, v49, v137
    v_fmac_f32 v48, v50, v138
    v_fmac_f32 v48, v51, v139
    v_fmac_f32 v48, v52, v140
    v_fmac_f32 v48, v53, v141
    v_fmac_f32 v48, v54, v142
    v_fmac_f32 v48, v55, v143
    v_mul_f32 v56, v56, v136
    v_fmac_f32 v56, v57, v137
    v_fmac_f32 v56, v58, v138
    v_fmac_f32 v56, v59, v139
    v_fmac_f32 v56, v60, v140
    v_fmac_f32 v56, v61, v141
    v_fmac_f32 v56, v62, v142
    v_fmac_f32 v56, v63, v143
    s_nop 0
    v_permlane32_swap_b32 v0, v8
    v_permlane32_swap_b32 v16, v24
    v_permlane32_swap_b32 v32, v40
    v_permlane32_swap_b32 v48, v56
    v_add_f32 v8, v0, v8
    v_add_f32 v24, v16, v24
    v_add_f32 v40, v32, v40
    v_add_f32 v56, v48, v56
    v_cvt_pk_bf16_f32 v8, v8, v40
    v_cvt_pk_bf16_f32 v24, v24, v56
    ds_write_b32 v243, v8 offset:0
    ds_write_b32 v243, v24 offset:256
    s_waitcnt lgkmcnt(4)
    v_mfma_f32_32x32x16_bf16 v[0:15], v[64:67], v[176:179], 0
    v_mfma_f32_32x32x16_bf16 v[16:31], v[68:71], v[176:179], 0
    s_waitcnt lgkmcnt(2)
    s_add_u32 m0, s29, 0
    s_nop 0
    buffer_load_dwordx4 v222, s[4:7], s37 offen lds
    s_add_u32 m0, s29, 1024
    s_nop 0
    buffer_load_dwordx4 v223, s[4:7], s37 offen lds
    s_waitcnt vmcnt(6)
    ds_read_b64_tr_b16 v[176:177], v234 offset:2048
    ds_read_b64_tr_b16 v[178:179], v234 offset:2560
    v_mfma_f32_32x32x16_bf16 v[32:47], v[64:67], v[180:183], 0
    v_mfma_f32_32x32x16_bf16 v[48:63], v[68:71], v[180:183], 0
    ds_read_b64_tr_b16 v[180:181], v235 offset:2048
    ds_read_b64_tr_b16 v[182:183], v235 offset:2560
    s_waitcnt lgkmcnt(2)
    v_mfma_f32_32x32x16_bf16 v[0:15], v[72:75], v[176:179], v[0:15]
    v_mfma_f32_32x32x16_bf16 v[16:31], v[76:79], v[176:179], v[16:31]
    s_waitcnt lgkmcnt(0)
    s_add_u32 m0, s29, 2048
    s_nop 0
    buffer_load_dwordx4 v224, s[4:7], s37 offen lds
    s_add_u32 m0, s29, 3072
    s_nop 0
    buffer_load_dwordx4 v225, s[4:7], s37 offen lds
    s_waitcnt vmcnt(6)
    ds_read_b64_tr_b16 v[176:177], v234 offset:4096
    ds_read_b64_tr_b16 v[178:179], v234 offset:4608
    v_mfma_f32_32x32x16_bf16 v[32:47], v[72:75], v[180:183], v[32:47]
    v_mfma_f32_32x32x16_bf16 v[48:63], v[76:79], v[180:183], v[48:63]
    ds_read_b64_tr_b16 v[180:181], v235 offset:4096
    ds_read_b64_tr_b16 v[182:183], v235 offset:4608
    s_waitcnt lgkmcnt(2)
    v_mfma_f32_32x32x16_bf16 v[0:15], v[80:83], v[176:179], v[0:15]
    v_mfma_f32_32x32x16_bf16 v[16:31], v[84:87], v[176:179], v[16:31]
    s_waitcnt lgkmcnt(0)
    s_add_u32 m0, s29, 4096
    s_nop 0
    buffer_load_dwordx4 v226, s[4:7], s37 offen lds
    s_add_u32 m0, s29, 5120
    s_nop 0
    buffer_load_dwordx4 v227, s[4:7], s37 offen lds
    s_waitcnt vmcnt(6)
    ds_read_b64_tr_b16 v[176:177], v234 offset:6144
    ds_read_b64_tr_b16 v[178:179], v234 offset:6656
    v_mfma_f32_32x32x16_bf16 v[32:47], v[80:83], v[180:183], v[32:47]
    v_mfma_f32_32x32x16_bf16 v[48:63], v[84:87], v[180:183], v[48:63]
    ds_read_b64_tr_b16 v[180:181], v235 offset:6144
    ds_read_b64_tr_b16 v[182:183], v235 offset:6656
    s_waitcnt lgkmcnt(2)
    v_mfma_f32_32x32x16_bf16 v[0:15], v[88:91], v[176:179], v[0:15]
    v_mfma_f32_32x32x16_bf16 v[16:31], v[92:95], v[176:179], v[16:31]
    s_waitcnt lgkmcnt(0)
    s_add_u32 m0, s29, 6144
    s_nop 0
    buffer_load_dwordx4 v228, s[4:7], s37 offen lds
    s_add_u32 m0, s29, 7168
    s_nop 0
    buffer_load_dwordx4 v229, s[4:7], s37 offen lds
    s_waitcnt vmcnt(6)
    ds_read_b64_tr_b16 v[176:177], v234 offset:0
    ds_read_b64_tr_b16 v[178:179], v234 offset:512
    v_mfma_f32_32x32x16_bf16 v[32:47], v[88:91], v[180:183], v[32:47]
    v_mfma_f32_32x32x16_bf16 v[48:63], v[92:95], v[180:183], v[48:63]
    ds_read_b64_tr_b16 v[180:181], v235 offset:0
    ds_read_b64_tr_b16 v[182:183], v235 offset:512
    v_mul_f32 v184, v0, v144
    v_fmac_f32 v184, v1, v145
    v_fmac_f32 v184, v2, v146
    v_fmac_f32 v184, v3, v147
    v_fmac_f32 v184, v4, v148
    v_fmac_f32 v184, v5, v149
    v_fmac_f32 v184, v6, v150
    v_fmac_f32 v184, v7, v151
    v_mul_f32 v186, v8, v112
    v_fmac_f32 v186, v9, v113
    v_fmac_f32 v186, v10, v114
    v_fmac_f32 v186, v11, v115
    v_fmac_f32 v186, v12, v116
    v_fmac_f32 v186, v13, v117
    v_fmac_f32 v186, v14, v118
    v_fmac_f32 v186, v15, v119
    v_mul_f32_e64 v188, v16, -v160
    v_fma_f32 v188, v17, -v161, v188
    v_fma_f32 v188, v18, -v162, v188
    v_fma_f32 v188, v19, -v163, v188
    v_fma_f32 v188, v20, -v164, v188
    v_fma_f32 v188, v21, -v165, v188
    v_fma_f32 v188, v22, -v166, v188
    v_fma_f32 v188, v23, -v167, v188
    v_mul_f32 v190, v24, v160
    v_fmac_f32 v190, v25, v161
    v_fmac_f32 v190, v26, v162
    v_fmac_f32 v190, v27, v163
    v_fmac_f32 v190, v28, v164
    v_fmac_f32 v190, v29, v165
    v_fmac_f32 v190, v30, v166
    v_fmac_f32 v190, v31, v167
    v_mul_f32 v185, v32, v152
    v_fmac_f32 v185, v33, v153
    v_fmac_f32 v185, v34, v154
    v_fmac_f32 v185, v35, v155
    v_fmac_f32 v185, v36, v156
    v_fmac_f32 v185, v37, v157
    v_fmac_f32 v185, v38, v158
    v_fmac_f32 v185, v39, v159
    v_mul_f32 v187, v40, v120
    v_fmac_f32 v187, v41, v121
    v_fmac_f32 v187, v42, v122
    v_fmac_f32 v187, v43, v123
    v_fmac_f32 v187, v44, v124
    v_fmac_f32 v187, v45, v125
    v_fmac_f32 v187, v46, v126
    v_fmac_f32 v187, v47, v127
    v_mul_f32_e64 v189, v48, -v168
    v_fma_f32 v189, v49, -v169, v189
    v_fma_f32 v189, v50, -v170, v189
    v_fma_f32 v189, v51, -v171, v189
    v_fma_f32 v189, v52, -v172, v189
    v_fma_f32 v189, v53, -v173, v189
    v_fma_f32 v189, v54, -v174, v189
    v_fma_f32 v189, v55, -v175, v189
    v_mul_f32 v191, v56, v168
    v_fmac_f32 v191, v57, v169
    v_fmac_f32 v191, v58, v170
    v_fmac_f32 v191, v59, v171
    v_fmac_f32 v191, v60, v172
    v_fmac_f32 v191, v61, v173
    v_fmac_f32 v191, v62, v174
    v_fmac_f32 v191, v63, v175
    s_waitcnt lgkmcnt(2)
    v_mfma_f32_32x32x16_bf16 v[0:15], v[64:67], v[176:179], 0
    v_mfma_f32_32x32x16_bf16 v[16:31], v[68:71], v[176:179], 0
    s_waitcnt lgkmcnt(0)
    s_add_u32 m0, s29, 0
    s_nop 0
    buffer_load_dwordx4 v222, s[4:7], s38 offen lds
    s_add_u32 m0, s29, 1024
    s_nop 0
    buffer_load_dwordx4 v223, s[4:7], s38 offen lds
    v_add_u32 v244, s43, v239
    ds_read_u16 v222, v244
    ds_read_u16 v223, v244 offset:64
    s_waitcnt vmcnt(6)
    ds_read_b64_tr_b16 v[176:177], v234 offset:2048
    ds_read_b64_tr_b16 v[178:179], v234 offset:2560
    v_mfma_f32_32x32x16_bf16 v[32:47], v[64:67], v[180:183], 0
    v_mfma_f32_32x32x16_bf16 v[48:63], v[68:71], v[180:183], 0
    ds_read_b64_tr_b16 v[180:181], v235 offset:2048
    ds_read_b64_tr_b16 v[182:183], v235 offset:2560
    s_waitcnt lgkmcnt(2)
    v_mfma_f32_32x32x16_bf16 v[0:15], v[72:75], v[176:179], v[0:15]
    v_mfma_f32_32x32x16_bf16 v[16:31], v[76:79], v[176:179], v[16:31]
    s_waitcnt lgkmcnt(0)
    s_add_u32 m0, s29, 2048
    s_nop 0
    buffer_load_dwordx4 v224, s[4:7], s38 offen lds
    s_add_u32 m0, s29, 3072
    s_nop 0
    buffer_load_dwordx4 v225, s[4:7], s38 offen lds
    v_add_u32 v244, s44, v239
    ds_read_u16 v224, v244
    ds_read_u16 v225, v244 offset:64
    s_waitcnt vmcnt(6)
    ds_read_b64_tr_b16 v[176:177], v234 offset:4096
    ds_read_b64_tr_b16 v[178:179], v234 offset:4608
    v_mfma_f32_32x32x16_bf16 v[32:47], v[72:75], v[180:183], v[32:47]
    v_mfma_f32_32x32x16_bf16 v[48:63], v[76:79], v[180:183], v[48:63]
    ds_read_b64_tr_b16 v[180:181], v235 offset:4096
    ds_read_b64_tr_b16 v[182:183], v235 offset:4608
    s_waitcnt lgkmcnt(2)
    v_mfma_f32_32x32x16_bf16 v[0:15], v[80:83], v[176:179], v[0:15]
    v_mfma_f32_32x32x16_bf16 v[16:31], v[84:87], v[176:179], v[16:31]
    s_waitcnt lgkmcnt(0)
    s_add_u32 m0, s29, 4096
    s_nop 0
    buffer_load_dwordx4 v226, s[4:7], s38 offen lds
    s_add_u32 m0, s29, 5120
    s_nop 0
    buffer_load_dwordx4 v227, s[4:7], s38 offen lds
    v_add_u32 v244, s45, v239
    ds_read_u16 v226, v244
    ds_read_u16 v227, v244 offset:64
    s_waitcnt vmcnt(6)
    ds_read_b64_tr_b16 v[176:177], v234 offset:6144
    ds_read_b64_tr_b16 v[178:179], v234 offset:6656
    v_mfma_f32_32x32x16_bf16 v[32:47], v[80:83], v[180:183], v[32:47]
    v_mfma_f32_32x32x16_bf16 v[48:63], v[84:87], v[180:183], v[48:63]
    ds_read_b64_tr_b16 v[180:181], v235 offset:6144
    ds_read_b64_tr_b16 v[182:183], v235 offset:6656
    s_waitcnt lgkmcnt(2)
    v_mfma_f32_32x32x16_bf16 v[0:15], v[88:91], v[176:179], v[0:15]
    v_mfma_f32_32x32x16_bf16 v[16:31], v[92:95], v[176:179], v[16:31]
    s_waitcnt lgkmcnt(0)
    s_add_u32 m0, s29, 6144
    s_nop 0
    buffer_load_dwordx4 v228, s[4:7], s38 offen lds
    s_add_u32 m0, s29, 7168
    s_nop 0
    buffer_load_dwordx4 v229, s[4:7], s38 offen lds
    v_add_u32 v244, s46, v239
    ds_read_u16 v228, v244
    ds_read_u16 v229, v244 offset:64
    s_waitcnt vmcnt(6)
    ds_read_b64_tr_b16 v[176:177], v234 offset:0
    ds_read_b64_tr_b16 v[178:179], v234 offset:512
    v_mfma_f32_32x32x16_bf16 v[32:47], v[88:91], v[180:183], v[32:47]
    v_mfma_f32_32x32x16_bf16 v[48:63], v[92:95], v[180:183], v[48:63]
    ds_read_b64_tr_b16 v[180:181], v235 offset:0
    ds_read_b64_tr_b16 v[182:183], v235 offset:512
    v_mul_f32 v0, v0, v144
    v_fmac_f32 v0, v1, v145
    v_fmac_f32 v0, v2, v146
    v_fmac_f32 v0, v3, v147
    v_fmac_f32 v0, v4, v148
    v_fmac_f32 v0, v5, v149
    v_fmac_f32 v0, v6, v150
    v_fmac_f32 v0, v7, v151
    v_fmac_f32 v188, v8, v160
    v_fmac_f32 v188, v9, v161
    v_fmac_f32 v188, v10, v162
    v_fmac_f32 v188, v11, v163
    v_fmac_f32 v188, v12, v164
    v_fmac_f32 v188, v13, v165
    v_fmac_f32 v188, v14, v166
    v_fmac_f32 v188, v15, v167
    v_fmac_f32 v186, v16, v112
    v_fmac_f32 v186, v17, v113
    v_fmac_f32 v186, v18, v114
    v_fmac_f32 v186, v19, v115
    v_fmac_f32 v186, v20, v116
    v_fmac_f32 v186, v21, v117
    v_fmac_f32 v186, v22, v118
    v_fmac_f32 v186, v23, v119
    v_mul_f32_e64 v24, v24, -v160
    v_fma_f32 v24, v25, -v161, v24
    v_fma_f32 v24, v26, -v162, v24
    v_fma_f32 v24, v27, -v163, v24
    v_fma_f32 v24, v28, -v164, v24
    v_fma_f32 v24, v29, -v165, v24
    v_fma_f32 v24, v30, -v166, v24
    v_fma_f32 v24, v31, -v167, v24
    v_mul_f32 v32, v32, v152
    v_fmac_f32 v32, v33, v153
    v_fmac_f32 v32, v34, v154
    v_fmac_f32 v32, v35, v155
    v_fmac_f32 v32, v36, v156
    v_fmac_f32 v32, v37, v157
    v_fmac_f32 v32, v38, v158
    v_fmac_f32 v32, v39, v159
    v_fmac_f32 v189, v40, v168
    v_fmac_f32 v189, v41, v169
    v_fmac_f32 v189, v42, v170
    v_fmac_f32 v189, v43, v171
    v_fmac_f32 v189, v44, v172
    v_fmac_f32 v189, v45, v173
    v_fmac_f32 v189, v46, v174
    v_fmac_f32 v189, v47, v175
    v_fmac_f32 v187, v48, v120
    v_fmac_f32 v187, v49, v121
    v_fmac_f32 v187, v50, v122
    v_fmac_f32 v187, v51, v123
    v_fmac_f32 v187, v52, v124
    v_fmac_f32 v187, v53, v125
    v_fmac_f32 v187, v54, v126
    v_fmac_f32 v187, v55, v127
    v_mul_f32_e64 v56, v56, -v168
    v_fma_f32 v56, v57, -v169, v56
    v_fma_f32 v56, v58, -v170, v56
    v_fma_f32 v56, v59, -v171, v56
    v_fma_f32 v56, v60, -v172, v56
    v_fma_f32 v56, v61, -v173, v56
    v_fma_f32 v56, v62, -v174, v56
    v_fma_f32 v56, v63, -v175, v56
    s_nop 0
    s_nop 0
    v_permlane32_swap_b32 v184, v0
    v_permlane32_swap_b32 v185, v32
    v_add_f32 v0, v184, v0
    v_add_f32 v32, v185, v32
    v_mov_b32 v184, v24
    v_mov_b32 v185, v56
    v_cvt_pk_bf16_f32 v0, v0, v32
    ds_write_b32 v243, v0 offset:512
    s_waitcnt lgkmcnt(3)
    v_mfma_f32_32x32x16_bf16 v[0:15], v[64:67], v[176:179], 0
    v_mfma_f32_32x32x16_bf16 v[16:31], v[68:71], v[176:179], 0
    v_lshl_add_u32 v222, v222, 10, v236
    v_lshl_add_u32 v223, v223, 10, v236
    s_waitcnt lgkmcnt(1)
    s_add_u32 m0, s29, 0
    s_nop 0
    buffer_load_dwordx4 v222, s[4:7], s39 offen lds
    s_add_u32 m0, s29, 1024
    s_nop 0
    buffer_load_dwordx4 v223, s[4:7], s39 offen lds
    s_waitcnt vmcnt(6)
    ds_read_b64_tr_b16 v[176:177], v234 offset:2048
    ds_read_b64_tr_b16 v[178:179], v234 offset:2560
    v_mfma_f32_32x32x16_bf16 v[32:47], v[64:67], v[180:183], 0
    v_mfma_f32_32x32x16_bf16 v[48:63], v[68:71], v[180:183], 0
    ds_read_b64_tr_b16 v[180:181], v235 offset:2048
    ds_read_b64_tr_b16 v[182:183], v235 offset:2560
    s_waitcnt lgkmcnt(2)
    v_mfma_f32_32x32x16_bf16 v[0:15], v[72:75], v[176:179], v[0:15]
    v_mfma_f32_32x32x16_bf16 v[16:31], v[76:79], v[176:179], v[16:31]
    v_lshl_add_u32 v224, v224, 10, v236
    v_lshl_add_u32 v225, v225, 10, v236
    s_waitcnt lgkmcnt(0)
    s_add_u32 m0, s29, 2048
    s_nop 0
    buffer_load_dwordx4 v224, s[4:7], s40 offen lds
    s_add_u32 m0, s29, 3072
    s_nop 0
    buffer_load_dwordx4 v225, s[4:7], s40 offen lds
    s_waitcnt vmcnt(6)
    ds_read_b64_tr_b16 v[176:177], v234 offset:4096
    ds_read_b64_tr_b16 v[178:179], v234 offset:4608
    v_mfma_f32_32x32x16_bf16 v[32:47], v[72:75], v[180:183], v[32:47]
    v_mfma_f32_32x32x16_bf16 v[48:63], v[76:79], v[180:183], v[48:63]
    ds_read_b64_tr_b16 v[180:181], v235 offset:4096
    ds_read_b64_tr_b16 v[182:183], v235 offset:4608
    s_waitcnt lgkmcnt(2)
    v_mfma_f32_32x32x16_bf16 v[0:15], v[80:83], v[176:179], v[0:15]
    v_mfma_f32_32x32x16_bf16 v[16:31], v[84:87], v[176:179], v[16:31]
    v_lshl_add_u32 v226, v226, 10, v236
    v_lshl_add_u32 v227, v227, 10, v236
    s_waitcnt lgkmcnt(0)
    s_add_u32 m0, s29, 4096
    s_nop 0
    buffer_load_dwordx4 v226, s[4:7], s41 offen lds
    s_add_u32 m0, s29, 5120
    s_nop 0
    buffer_load_dwordx4 v227, s[4:7], s41 offen lds
    s_waitcnt vmcnt(6)
    ds_read_b64_tr_b16 v[176:177], v234 offset:6144
    ds_read_b64_tr_b16 v[178:179], v234 offset:6656
    v_mfma_f32_32x32x16_bf16 v[32:47], v[80:83], v[180:183], v[32:47]
    v_mfma_f32_32x32x16_bf16 v[48:63], v[84:87], v[180:183], v[48:63]
    ds_read_b64_tr_b16 v[180:181], v235 offset:6144
    ds_read_b64_tr_b16 v[182:183], v235 offset:6656
    s_waitcnt lgkmcnt(2)
    v_mfma_f32_32x32x16_bf16 v[0:15], v[88:91], v[176:179], v[0:15]
    v_mfma_f32_32x32x16_bf16 v[16:31], v[92:95], v[176:179], v[16:31]
    v_lshl_add_u32 v228, v228, 10, v236
    v_lshl_add_u32 v229, v229, 10, v236
    s_waitcnt lgkmcnt(0)
    s_add_u32 m0, s29, 6144
    s_nop 0
    buffer_load_dwordx4 v228, s[4:7], s42 offen lds
    s_add_u32 m0, s29, 7168
    s_nop 0
    buffer_load_dwordx4 v229, s[4:7], s42 offen lds
    s_waitcnt vmcnt(6)
    ds_read_b64_tr_b16 v[176:177], v234 offset:0
    ds_read_b64_tr_b16 v[178:179], v234 offset:512
    v_mfma_f32_32x32x16_bf16 v[32:47], v[88:91], v[180:183], v[32:47]
    v_mfma_f32_32x32x16_bf16 v[48:63], v[92:95], v[180:183], v[48:63]
    ds_read_b64_tr_b16 v[180:181], v235 offset:0
    ds_read_b64_tr_b16 v[182:183], v235 offset:512
    v_add_u32 v241, s49, v237
    v_add_u32 v242, s43, v238
    ds_read_b64_tr_b16 v[68:69], v241 offset:0
    ds_read_b64_tr_b16 v[70:71], v241 offset:128
    s_mov_b64 exec, s[54:55]
    ds_read_u16_d16_hi v230, v242 offset:0
    s_mov_b64 exec, -1
    v_mul_f32 v0, v0, v144
    v_fmac_f32 v0, v1, v145
    v_fmac_f32 v0, v2, v146
    v_fmac_f32 v0, v3, v147
    v_fmac_f32 v0, v4, v148
    v_fmac_f32 v0, v5, v149
    v_fmac_f32 v0, v6, v150
    v_fmac_f32 v0, v7, v151
    v_fma_f32 v190, v8, -v160, v190
    v_fma_f32 v190, v9, -v161, v190
    v_fma_f32 v190, v10, -v162, v190
    v_fma_f32 v190, v11, -v163, v190
    v_fma_f32 v190, v12, -v164, v190
    v_fma_f32 v190, v13, -v165, v190
    v_fma_f32 v190, v14, -v166, v190
    v_fma_f32 v190, v15, -v167, v190
    v_fmac_f32 v184, v16, v160
    v_fmac_f32 v184, v17, v161
    v_fmac_f32 v184, v18, v162
    v_fmac_f32 v184, v19, v163
    v_fmac_f32 v184, v20, v164
    v_fmac_f32 v184, v21, v165
    v_fmac_f32 v184, v22, v166
    v_fmac_f32 v184, v23, v167
    v_fmac_f32 v186, v24, v112
    v_fmac_f32 v186, v25, v113
    v_fmac_f32 v186, v26, v114
    v_fmac_f32 v186, v27, v115
    v_fmac_f32 v186, v28, v116
    v_fmac_f32 v186, v29, v117
    v_fmac_f32 v186, v30, v118
    v_fmac_f32 v186, v31, v119
    v_mul_f32 v32, v32, v152
    v_fmac_f32 v32, v33, v153
    v_fmac_f32 v32, v34, v154
    v_fmac_f32 v32, v35, v155
    v_fmac_f32 v32, v36, v156
    v_fmac_f32 v32, v37, v157
    v_fmac_f32 v32, v38, v158
    v_fmac_f32 v32, v39, v159
    v_fma_f32 v191, v40, -v168, v191
    v_fma_f32 v191, v41, -v169, v191
    v_fma_f32 v191, v42, -v170, v191
    v_fma_f32 v191, v43, -v171, v191
    v_fma_f32 v191, v44, -v172, v191
    v_fma_f32 v191, v45, -v173, v191
    v_fma_f32 v191, v46, -v174, v191
    v_fma_f32 v191, v47, -v175, v191
    v_fmac_f32 v185, v48, v168
    v_fmac_f32 v185, v49, v169
    v_fmac_f32 v185, v50, v170
    v_fmac_f32 v185, v51, v171
    v_fmac_f32 v185, v52, v172
    v_fmac_f32 v185, v53, v173
    v_fmac_f32 v185, v54, v174
    v_fmac_f32 v185, v55, v175
    v_fmac_f32 v187, v56, v120
    v_fmac_f32 v187, v57, v121
    v_fmac_f32 v187, v58, v122
    v_fmac_f32 v187, v59, v123
    v_fmac_f32 v187, v60, v124
    v_fmac_f32 v187, v61, v125
    v_fmac_f32 v187, v62, v126
    v_fmac_f32 v187, v63, v127
    s_nop 0
    s_nop 0
    v_permlane32_swap_b32 v0, v188
    v_permlane32_swap_b32 v190, v8
    v_permlane32_swap_b32 v186, v184
    v_permlane32_swap_b32 v32, v189
    v_permlane32_swap_b32 v191, v40
    v_permlane32_swap_b32 v187, v185
    v_add_f32 v188, v0, v188
    v_add_f32 v8, v190, v8
    v_add_f32 v184, v186, v184
    v_add_f32 v189, v32, v189
    v_add_f32 v40, v191, v40
    v_add_f32 v185, v187, v185
    v_cvt_pk_bf16_f32 v188, v188, v189
    v_cvt_pk_bf16_f32 v8, v8, v40
    v_cvt_pk_bf16_f32 v184, v184, v185
    ds_write_b32 v243, v188 offset:768
    ds_write_b32 v243, v8 offset:1280
    ds_write_b32 v243, v184 offset:1024
    s_branch NEXT_1
.p2align 6
ITEM_1_1:
    v_add_u32 v244, s43, v239
    ds_read_u16 v222, v244
    ds_read_u16 v223, v244 offset:64
    v_add_u32 v244, s44, v239
    ds_read_u16 v224, v244
    ds_read_u16 v225, v244 offset:64
    v_add_u32 v244, s45, v239
    ds_read_u16 v226, v244
    ds_read_u16 v227, v244 offset:64
    v_add_u32 v244, s46, v239
    ds_read_u16 v228, v244
    ds_read_u16 v229, v244 offset:64
    v_xor_b32 v243, s69, v240
    v_add_u32 v243, s50, v243
    s_waitcnt lgkmcnt(8)
    v_lshlrev_b32 v184, 16, v68
    v_and_b32 v185, 0xffff0000, v68
    v_lshlrev_b32 v186, 16, v69
    v_and_b32 v187, 0xffff0000, v69
    v_mul_f32_dpp v188, v230, v184 row_newbcast:0 row_mask:0xf bank_mask:0xf
    v_mul_f32_dpp v189, v230, v185 row_newbcast:1 row_mask:0xf bank_mask:0xf
    v_mul_f32_dpp v190, v230, v184 row_newbcast:8 row_mask:0xf bank_mask:0xf
    v_mul_f32_dpp v191, v230, v185 row_newbcast:9 row_mask:0xf bank_mask:0xf
    v_lshlrev_b32 v184, 16, v70
    v_and_b32 v185, 0xffff0000, v70
    v_cvt_pk_bf16_f32 v64, v188, v189
    v_cvt_pk_bf16_f32 v68, v190, v191
    v_mul_f32_dpp v188, v230, v186 row_newbcast:2 row_mask:0xf bank_mask:0xf
    v_mul_f32_dpp v189, v230, v187 row_newbcast:3 row_mask:0xf bank_mask:0xf
    v_mul_f32_dpp v190, v230, v186 row_newbcast:10 row_mask:0xf bank_mask:0xf
    v_mul_f32_dpp v191, v230, v187 row_newbcast:11 row_mask:0xf bank_mask:0xf
    v_lshlrev_b32 v186, 16, v71
    v_and_b32 v187, 0xffff0000, v71
    v_cvt_pk_bf16_f32 v65, v188, v189
    v_cvt_pk_bf16_f32 v69, v190, v191
    v_mul_f32_dpp v188, v230, v184 row_newbcast:4 row_mask:0xf bank_mask:0xf
    v_mul_f32_dpp v189, v230, v185 row_newbcast:5 row_mask:0xf bank_mask:0xf
    v_mul_f32_dpp v190, v230, v184 row_newbcast:12 row_mask:0xf bank_mask:0xf
    v_mul_f32_dpp v191, v230, v185 row_newbcast:13 row_mask:0xf bank_mask:0xf
    v_cvt_pk_bf16_f32 v66, v188, v189
    v_cvt_pk_bf16_f32 v70, v190, v191
    v_mul_f32_dpp v188, v230, v186 row_newbcast:6 row_mask:0xf bank_mask:0xf
    v_mul_f32_dpp v189, v230, v187 row_newbcast:7 row_mask:0xf bank_mask:0xf
    v_mul_f32_dpp v190, v230, v186 row_newbcast:14 row_mask:0xf bank_mask:0xf
    v_mul_f32_dpp v191, v230, v187 row_newbcast:15 row_mask:0xf bank_mask:0xf
    v_cvt_pk_bf16_f32 v67, v188, v189
    v_cvt_pk_bf16_f32 v71, v190, v191
    s_nop 0
    v_mfma_f32_32x32x16_bf16 v[0:15], v[64:67], v[176:179], 0
    v_mfma_f32_32x32x16_bf16 v[16:31], v[68:71], v[176:179], 0
    s_waitcnt lgkmcnt(6)
    v_lshl_add_u32 v222, v222, 10, v236
    v_lshl_add_u32 v223, v223, 10, v236
    s_add_u32 m0, s29, 0
    s_nop 0
    buffer_load_dwordx4 v222, s[4:7], s39 offen lds
    s_add_u32 m0, s29, 1024
    s_nop 0
    buffer_load_dwordx4 v223, s[4:7], s39 offen lds
    s_waitcnt vmcnt(6)
    ds_read_b64_tr_b16 v[176:177], v234 offset:2048
    ds_read_b64_tr_b16 v[178:179], v234 offset:2560
    v_mfma_f32_32x32x16_bf16 v[32:47], v[64:67], v[180:183], 0
    v_mfma_f32_32x32x16_bf16 v[48:63], v[68:71], v[180:183], 0
    ds_read_b64_tr_b16 v[180:181], v235 offset:2048
    ds_read_b64_tr_b16 v[182:183], v235 offset:2560
    v_mul_f32 v0, v0, v96
    v_fmac_f32 v0, v1, v97
    v_fmac_f32 v0, v2, v98
    v_fmac_f32 v0, v3, v99
    v_fmac_f32 v0, v4, v100
    v_fmac_f32 v0, v5, v101
    v_fmac_f32 v0, v6, v102
    v_fmac_f32 v0, v7, v103
    v_mul_f32 v8, v8, v128
    v_fmac_f32 v8, v9, v129
    v_fmac_f32 v8, v10, v130
    v_fmac_f32 v8, v11, v131
    v_fmac_f32 v8, v12, v132
    v_fmac_f32 v8, v13, v133
    v_fmac_f32 v8, v14, v134
    v_fmac_f32 v8, v15, v135
    v_mul_f32 v16, v16, v128
    v_fmac_f32 v16, v17, v129
    v_fmac_f32 v16, v18, v130
    v_fmac_f32 v16, v19, v131
    v_fmac_f32 v16, v20, v132
    v_fmac_f32 v16, v21, v133
    v_fmac_f32 v16, v22, v134
    v_fmac_f32 v16, v23, v135
    v_mul_f32 v24, v24, v128
    v_fmac_f32 v24, v25, v129
    v_fmac_f32 v24, v26, v130
    v_fmac_f32 v24, v27, v131
    v_fmac_f32 v24, v28, v132
    v_fmac_f32 v24, v29, v133
    v_fmac_f32 v24, v30, v134
    v_fmac_f32 v24, v31, v135
    v_mul_f32 v32, v32, v104
    v_fmac_f32 v32, v33, v105
    v_fmac_f32 v32, v34, v106
    v_fmac_f32 v32, v35, v107
    v_fmac_f32 v32, v36, v108
    v_fmac_f32 v32, v37, v109
    v_fmac_f32 v32, v38, v110
    v_fmac_f32 v32, v39, v111
    v_mul_f32 v40, v40, v136
    v_fmac_f32 v40, v41, v137
    v_fmac_f32 v40, v42, v138
    v_fmac_f32 v40, v43, v139
    v_fmac_f32 v40, v44, v140
    v_fmac_f32 v40, v45, v141
    v_fmac_f32 v40, v46, v142
    v_fmac_f32 v40, v47, v143
    v_mul_f32 v48, v48, v136
    v_fmac_f32 v48, v49, v137
    v_fmac_f32 v48, v50, v138
    v_fmac_f32 v48, v51, v139
    v_fmac_f32 v48, v52, v140
    v_fmac_f32 v48, v53, v141
    v_fmac_f32 v48, v54, v142
    v_fmac_f32 v48, v55, v143
    v_mul_f32 v56, v56, v136
    v_fmac_f32 v56, v57, v137
    v_fmac_f32 v56, v58, v138
    v_fmac_f32 v56, v59, v139
    v_fmac_f32 v56, v60, v140
    v_fmac_f32 v56, v61, v141
    v_fmac_f32 v56, v62, v142
    v_fmac_f32 v56, v63, v143
    s_nop 0
    v_permlane32_swap_b32 v0, v8
    v_permlane32_swap_b32 v16, v24
    v_permlane32_swap_b32 v32, v40
    v_permlane32_swap_b32 v48, v56
    v_add_f32 v8, v0, v8
    v_add_f32 v24, v16, v24
    v_add_f32 v40, v32, v40
    v_add_f32 v56, v48, v56
    v_cvt_pk_bf16_f32 v8, v8, v40
    v_cvt_pk_bf16_f32 v24, v24, v56
    ds_write_b32 v243, v8 offset:0
    ds_write_b32 v243, v24 offset:256
    s_waitcnt lgkmcnt(4)
    v_mfma_f32_32x32x16_bf16 v[0:15], v[64:67], v[176:179], 0
    v_mfma_f32_32x32x16_bf16 v[16:31], v[68:71], v[176:179], 0
    v_lshl_add_u32 v224, v224, 10, v236
    v_lshl_add_u32 v225, v225, 10, v236
    s_waitcnt lgkmcnt(2)
    s_add_u32 m0, s29, 2048
    s_nop 0
    buffer_load_dwordx4 v224, s[4:7], s40 offen lds
    s_add_u32 m0, s29, 3072
    s_nop 0
    buffer_load_dwordx4 v225, s[4:7], s40 offen lds
    s_waitcnt vmcnt(6)
    ds_read_b64_tr_b16 v[176:177], v234 offset:4096
    ds_read_b64_tr_b16 v[178:179], v234 offset:4608
    v_mfma_f32_32x32x16_bf16 v[32:47], v[64:67], v[180:183], 0
    v_mfma_f32_32x32x16_bf16 v[48:63], v[68:71], v[180:183], 0
    ds_read_b64_tr_b16 v[180:181], v235 offset:4096
    ds_read_b64_tr_b16 v[182:183], v235 offset:4608
    v_mul_f32 v184, v0, v144
    v_fmac_f32 v184, v1, v145
    v_fmac_f32 v184, v2, v146
    v_fmac_f32 v184, v3, v147
    v_fmac_f32 v184, v4, v148
    v_fmac_f32 v184, v5, v149
    v_fmac_f32 v184, v6, v150
    v_fmac_f32 v184, v7, v151
    v_mul_f32 v186, v8, v112
    v_fmac_f32 v186, v9, v113
    v_fmac_f32 v186, v10, v114
    v_fmac_f32 v186, v11, v115
    v_fmac_f32 v186, v12, v116
    v_fmac_f32 v186, v13, v117
    v_fmac_f32 v186, v14, v118
    v_fmac_f32 v186, v15, v119
    v_mul_f32_e64 v188, v16, -v160
    v_fma_f32 v188, v17, -v161, v188
    v_fma_f32 v188, v18, -v162, v188
    v_fma_f32 v188, v19, -v163, v188
    v_fma_f32 v188, v20, -v164, v188
    v_fma_f32 v188, v21, -v165, v188
    v_fma_f32 v188, v22, -v166, v188
    v_fma_f32 v188, v23, -v167, v188
    v_mul_f32 v190, v24, v160
    v_fmac_f32 v190, v25, v161
    v_fmac_f32 v190, v26, v162
    v_fmac_f32 v190, v27, v163
    v_fmac_f32 v190, v28, v164
    v_fmac_f32 v190, v29, v165
    v_fmac_f32 v190, v30, v166
    v_fmac_f32 v190, v31, v167
    v_mul_f32 v185, v32, v152
    v_fmac_f32 v185, v33, v153
    v_fmac_f32 v185, v34, v154
    v_fmac_f32 v185, v35, v155
    v_fmac_f32 v185, v36, v156
    v_fmac_f32 v185, v37, v157
    v_fmac_f32 v185, v38, v158
    v_fmac_f32 v185, v39, v159
    v_mul_f32 v187, v40, v120
    v_fmac_f32 v187, v41, v121
    v_fmac_f32 v187, v42, v122
    v_fmac_f32 v187, v43, v123
    v_fmac_f32 v187, v44, v124
    v_fmac_f32 v187, v45, v125
    v_fmac_f32 v187, v46, v126
    v_fmac_f32 v187, v47, v127
    v_mul_f32_e64 v189, v48, -v168
    v_fma_f32 v189, v49, -v169, v189
    v_fma_f32 v189, v50, -v170, v189
    v_fma_f32 v189, v51, -v171, v189
    v_fma_f32 v189, v52, -v172, v189
    v_fma_f32 v189, v53, -v173, v189
    v_fma_f32 v189, v54, -v174, v189
    v_fma_f32 v189, v55, -v175, v189
    v_mul_f32 v191, v56, v168
    v_fmac_f32 v191, v57, v169
    v_fmac_f32 v191, v58, v170
    v_fmac_f32 v191, v59, v171
    v_fmac_f32 v191, v60, v172
    v_fmac_f32 v191, v61, v173
    v_fmac_f32 v191, v62, v174
    v_fmac_f32 v191, v63, v175
    s_waitcnt lgkmcnt(2)
    v_mfma_f32_32x32x16_bf16 v[0:15], v[64:67], v[176:179], 0
    v_mfma_f32_32x32x16_bf16 v[16:31], v[68:71], v[176:179], 0
    v_lshl_add_u32 v226, v226, 10, v236
    v_lshl_add_u32 v227, v227, 10, v236
    s_waitcnt lgkmcnt(0)
    s_add_u32 m0, s29, 4096
    s_nop 0
    buffer_load_dwordx4 v226, s[4:7], s41 offen lds
    s_add_u32 m0, s29, 5120
    s_nop 0
    buffer_load_dwordx4 v227, s[4:7], s41 offen lds
    s_waitcnt vmcnt(6)
    ds_read_b64_tr_b16 v[176:177], v234 offset:6144
    ds_read_b64_tr_b16 v[178:179], v234 offset:6656
    v_mfma_f32_32x32x16_bf16 v[32:47], v[64:67], v[180:183], 0
    v_mfma_f32_32x32x16_bf16 v[48:63], v[68:71], v[180:183], 0
    ds_read_b64_tr_b16 v[180:181], v235 offset:6144
    ds_read_b64_tr_b16 v[182:183], v235 offset:6656
    v_mul_f32 v0, v0, v144
    v_fmac_f32 v0, v1, v145
    v_fmac_f32 v0, v2, v146
    v_fmac_f32 v0, v3, v147
    v_fmac_f32 v0, v4, v148
    v_fmac_f32 v0, v5, v149
    v_fmac_f32 v0, v6, v150
    v_fmac_f32 v0, v7, v151
    v_fmac_f32 v188, v8, v160
    v_fmac_f32 v188, v9, v161
    v_fmac_f32 v188, v10, v162
    v_fmac_f32 v188, v11, v163
    v_fmac_f32 v188, v12, v164
    v_fmac_f32 v188, v13, v165
    v_fmac_f32 v188, v14, v166
    v_fmac_f32 v188, v15, v167
    v_fmac_f32 v186, v16, v112
    v_fmac_f32 v186, v17, v113
    v_fmac_f32 v186, v18, v114
    v_fmac_f32 v186, v19, v115
    v_fmac_f32 v186, v20, v116
    v_fmac_f32 v186, v21, v117
    v_fmac_f32 v186, v22, v118
    v_fmac_f32 v186, v23, v119
    v_mul_f32_e64 v24, v24, -v160
    v_fma_f32 v24, v25, -v161, v24
    v_fma_f32 v24, v26, -v162, v24
    v_fma_f32 v24, v27, -v163, v24
    v_fma_f32 v24, v28, -v164, v24
    v_fma_f32 v24, v29, -v165, v24
    v_fma_f32 v24, v30, -v166, v24
    v_fma_f32 v24, v31, -v167, v24
    v_mul_f32 v32, v32, v152
    v_fmac_f32 v32, v33, v153
    v_fmac_f32 v32, v34, v154
    v_fmac_f32 v32, v35, v155
    v_fmac_f32 v32, v36, v156
    v_fmac_f32 v32, v37, v157
    v_fmac_f32 v32, v38, v158
    v_fmac_f32 v32, v39, v159
    v_fmac_f32 v189, v40, v168
    v_fmac_f32 v189, v41, v169
    v_fmac_f32 v189, v42, v170
    v_fmac_f32 v189, v43, v171
    v_fmac_f32 v189, v44, v172
    v_fmac_f32 v189, v45, v173
    v_fmac_f32 v189, v46, v174
    v_fmac_f32 v189, v47, v175
    v_fmac_f32 v187, v48, v120
    v_fmac_f32 v187, v49, v121
    v_fmac_f32 v187, v50, v122
    v_fmac_f32 v187, v51, v123
    v_fmac_f32 v187, v52, v124
    v_fmac_f32 v187, v53, v125
    v_fmac_f32 v187, v54, v126
    v_fmac_f32 v187, v55, v127
    v_mul_f32_e64 v56, v56, -v168
    v_fma_f32 v56, v57, -v169, v56
    v_fma_f32 v56, v58, -v170, v56
    v_fma_f32 v56, v59, -v171, v56
    v_fma_f32 v56, v60, -v172, v56
    v_fma_f32 v56, v61, -v173, v56
    v_fma_f32 v56, v62, -v174, v56
    v_fma_f32 v56, v63, -v175, v56
    s_nop 0
    s_nop 0
    v_permlane32_swap_b32 v184, v0
    v_permlane32_swap_b32 v185, v32
    v_add_f32 v0, v184, v0
    v_add_f32 v32, v185, v32
    v_mov_b32 v184, v24
    v_mov_b32 v185, v56
    v_cvt_pk_bf16_f32 v0, v0, v32
    ds_write_b32 v243, v0 offset:512
    s_waitcnt lgkmcnt(3)
    v_mfma_f32_32x32x16_bf16 v[0:15], v[64:67], v[176:179], 0
    v_mfma_f32_32x32x16_bf16 v[16:31], v[68:71], v[176:179], 0
    v_lshl_add_u32 v228, v228, 10, v236
    v_lshl_add_u32 v229, v229, 10, v236
    s_waitcnt lgkmcnt(1)
    s_add_u32 m0, s29, 6144
    s_nop 0
    buffer_load_dwordx4 v228, s[4:7], s42 offen lds
    s_add_u32 m0, s29, 7168
    s_nop 0
    buffer_load_dwordx4 v229, s[4:7], s42 offen lds
    s_waitcnt vmcnt(6)
    ds_read_b64_tr_b16 v[176:177], v234 offset:0
    ds_read_b64_tr_b16 v[178:179], v234 offset:512
    v_mfma_f32_32x32x16_bf16 v[32:47], v[64:67], v[180:183], 0
    v_mfma_f32_32x32x16_bf16 v[48:63], v[68:71], v[180:183], 0
    ds_read_b64_tr_b16 v[180:181], v235 offset:0
    ds_read_b64_tr_b16 v[182:183], v235 offset:512
    v_add_u32 v241, s49, v237
    v_add_u32 v242, s43, v238
    ds_read_b64_tr_b16 v[68:69], v241 offset:0
    ds_read_b64_tr_b16 v[70:71], v241 offset:128
    s_mov_b64 exec, s[54:55]
    ds_read_u16_d16_hi v230, v242 offset:0
    s_mov_b64 exec, -1
    v_mul_f32 v0, v0, v144
    v_fmac_f32 v0, v1, v145
    v_fmac_f32 v0, v2, v146
    v_fmac_f32 v0, v3, v147
    v_fmac_f32 v0, v4, v148
    v_fmac_f32 v0, v5, v149
    v_fmac_f32 v0, v6, v150
    v_fmac_f32 v0, v7, v151
    v_fma_f32 v190, v8, -v160, v190
    v_fma_f32 v190, v9, -v161, v190
    v_fma_f32 v190, v10, -v162, v190
    v_fma_f32 v190, v11, -v163, v190
    v_fma_f32 v190, v12, -v164, v190
    v_fma_f32 v190, v13, -v165, v190
    v_fma_f32 v190, v14, -v166, v190
    v_fma_f32 v190, v15, -v167, v190
    v_fmac_f32 v184, v16, v160
    v_fmac_f32 v184, v17, v161
    v_fmac_f32 v184, v18, v162
    v_fmac_f32 v184, v19, v163
    v_fmac_f32 v184, v20, v164
    v_fmac_f32 v184, v21, v165
    v_fmac_f32 v184, v22, v166
    v_fmac_f32 v184, v23, v167
    v_fmac_f32 v186, v24, v112
    v_fmac_f32 v186, v25, v113
    v_fmac_f32 v186, v26, v114
    v_fmac_f32 v186, v27, v115
    v_fmac_f32 v186, v28, v116
    v_fmac_f32 v186, v29, v117
    v_fmac_f32 v186, v30, v118
    v_fmac_f32 v186, v31, v119
    v_mul_f32 v32, v32, v152
    v_fmac_f32 v32, v33, v153
    v_fmac_f32 v32, v34, v154
    v_fmac_f32 v32, v35, v155
    v_fmac_f32 v32, v36, v156
    v_fmac_f32 v32, v37, v157
    v_fmac_f32 v32, v38, v158
    v_fmac_f32 v32, v39, v159
    v_fma_f32 v191, v40, -v168, v191
    v_fma_f32 v191, v41, -v169, v191
    v_fma_f32 v191, v42, -v170, v191
    v_fma_f32 v191, v43, -v171, v191
    v_fma_f32 v191, v44, -v172, v191
    v_fma_f32 v191, v45, -v173, v191
    v_fma_f32 v191, v46, -v174, v191
    v_fma_f32 v191, v47, -v175, v191
    v_fmac_f32 v185, v48, v168
    v_fmac_f32 v185, v49, v169
    v_fmac_f32 v185, v50, v170
    v_fmac_f32 v185, v51, v171
    v_fmac_f32 v185, v52, v172
    v_fmac_f32 v185, v53, v173
    v_fmac_f32 v185, v54, v174
    v_fmac_f32 v185, v55, v175
    v_fmac_f32 v187, v56, v120
    v_fmac_f32 v187, v57, v121
    v_fmac_f32 v187, v58, v122
    v_fmac_f32 v187, v59, v123
    v_fmac_f32 v187, v60, v124
    v_fmac_f32 v187, v61, v125
    v_fmac_f32 v187, v62, v126
    v_fmac_f32 v187, v63, v127
    s_nop 0
    s_nop 0
    v_permlane32_swap_b32 v0, v188
    v_permlane32_swap_b32 v190, v8
    v_permlane32_swap_b32 v186, v184
    v_permlane32_swap_b32 v32, v189
    v_permlane32_swap_b32 v191, v40
    v_permlane32_swap_b32 v187, v185
    v_add_f32 v188, v0, v188
    v_add_f32 v8, v190, v8
    v_add_f32 v184, v186, v184
    v_add_f32 v189, v32, v189
    v_add_f32 v40, v191, v40
    v_add_f32 v185, v187, v185
    v_cvt_pk_bf16_f32 v188, v188, v189
    v_cvt_pk_bf16_f32 v8, v8, v40
    v_cvt_pk_bf16_f32 v184, v184, v185
    ds_write_b32 v243, v188 offset:768
    ds_write_b32 v243, v8 offset:1280
    ds_write_b32 v243, v184 offset:1024
    s_branch NEXT_1
.p2align 6
TAIL:
    s_waitcnt vmcnt(0) lgkmcnt(0)
    v_lshlrev_b32 v244, 4, v250
    s_mul_i32 s62, s28, 20480
    s_add_u32 s62, s62, 12288000
    buffer_load_dwordx4 v[96:99], v244, s[12:15], s62 offen offset:0
    buffer_load_dwordx4 v[100:103], v244, s[12:15], s62 offen offset:1024
    buffer_load_dwordx4 v[104:107], v244, s[12:15], s62 offen offset:2048
    buffer_load_dwordx4 v[108:111], v244, s[12:15], s62 offen offset:3072
    s_add_u32 s62, s62, 4096
    buffer_load_dwordx4 v[112:115], v244, s[12:15], s62 offen offset:0
    buffer_load_dwordx4 v[116:119], v244, s[12:15], s62 offen offset:1024
    buffer_load_dwordx4 v[120:123], v244, s[12:15], s62 offen offset:2048
    buffer_load_dwordx4 v[124:127], v244, s[12:15], s62 offen offset:3072
    s_add_u32 s62, s62, 4096
    buffer_load_dwordx4 v[128:131], v244, s[12:15], s62 offen offset:0
    buffer_load_dwordx4 v[132:135], v244, s[12:15], s62 offen offset:1024
    buffer_load_dwordx4 v[136:139], v244, s[12:15], s62 offen offset:2048
    buffer_load_dwordx4 v[140:143], v244, s[12:15], s62 offen offset:3072
    s_add_u32 s62, s62, 4096
    buffer_load_dwordx4 v[144:147], v244, s[12:15], s62 offen offset:0
    buffer_load_dwordx4 v[148:151], v244, s[12:15], s62 offen offset:1024
    buffer_load_dwordx4 v[152:155], v244, s[12:15], s62 offen offset:2048
    buffer_load_dwordx4 v[156:159], v244, s[12:15], s62 offen offset:3072
    s_add_u32 s62, s62, 4096
    buffer_load_dwordx4 v[160:163], v244, s[12:15], s62 offen offset:0
    buffer_load_dwordx4 v[164:167], v244, s[12:15], s62 offen offset:1024
    buffer_load_dwordx4 v[168:171], v244, s[12:15], s62 offen offset:2048
    buffer_load_dwordx4 v[172:175], v244, s[12:15], s62 offen offset:3072
    s_add_u32 s62, s62, 4096
    s_bfe_u32 s63, s30, 0x40015
    s_lshl_b32 s63, s63, 4
    s_add_u32 s64, s29, 0
    v_xor_b32 v243, s63, v240
    v_add_u32 v243, s64, v243
    ds_write_b32 v243, v192 offset:0
    ds_write_b32 v243, v193 offset:256
    ds_write_b32 v243, v194 offset:512
    ds_write_b32 v243, v195 offset:768
    ds_write_b32 v243, v196 offset:1024
    ds_write_b32 v243, v197 offset:1280
    s_bfe_u32 s63, s31, 0x40015
    s_lshl_b32 s63, s63, 4
    s_add_u32 s64, s29, 1536
    v_xor_b32 v243, s63, v240
    v_add_u32 v243, s64, v243
    ds_write_b32 v243, v198 offset:0
    ds_write_b32 v243, v199 offset:256
    ds_write_b32 v243, v200 offset:512
    ds_write_b32 v243, v201 offset:768
    ds_write_b32 v243, v202 offset:1024
    ds_write_b32 v243, v203 offset:1280
    s_bfe_u32 s63, s32, 0x40015
    s_lshl_b32 s63, s63, 4
    s_add_u32 s64, s29, 3072
    v_xor_b32 v243, s63, v240
    v_add_u32 v243, s64, v243
    ds_write_b32 v243, v204 offset:0
    ds_write_b32 v243, v205 offset:256
    ds_write_b32 v243, v206 offset:512
    ds_write_b32 v243, v207 offset:768
    ds_write_b32 v243, v208 offset:1024
    ds_write_b32 v243, v209 offset:1280
    s_bfe_u32 s63, s33, 0x40015
    s_lshl_b32 s63, s63, 4
    s_add_u32 s64, s29, 4608
    v_xor_b32 v243, s63, v240
    v_add_u32 v243, s64, v243
    ds_write_b32 v243, v210 offset:0
    ds_write_b32 v243, v211 offset:256
    ds_write_b32 v243, v212 offset:512
    ds_write_b32 v243, v213 offset:768
    ds_write_b32 v243, v214 offset:1024
    ds_write_b32 v243, v215 offset:1280
    s_bfe_u32 s63, s34, 0x40015
    s_lshl_b32 s63, s63, 4
    s_add_u32 s64, s29, 6144
    v_xor_b32 v243, s63, v240
    v_add_u32 v243, s64, v243
    ds_write_b32 v243, v216 offset:0
    ds_write_b32 v243, v217 offset:256
    ds_write_b32 v243, v218 offset:512
    ds_write_b32 v243, v219 offset:768
    ds_write_b32 v243, v220 offset:1024
    ds_write_b32 v243, v221 offset:1280
GEMM:
    v_and_b32 v179, 15, v250
    v_lshrrev_b32 v180, 4, v250
    v_lshlrev_b32 v182, 3, v179
    v_add_u32 v182, 86272, v182
    v_min_u32 v183, 86328, v182
    ds_read_b64 v[184:185], v182
    ds_read_b64 v[186:187], v182 offset:128
    ds_read_b64 v[188:189], v183 offset:256
    v_min_u32 v178, 7, v179
    s_waitcnt lgkmcnt(0)
    v_bfe_u32 v177, v184, 7, 1
    v_lshlrev_b32 v177, 3, v177
    v_xor_b32 v177, v177, v179
    v_xor_b32 v177, v177, v180
    v_xor_b32 v176, 0, v177
    v_lshl_add_u32 v48, v176, 4, v184
    v_xor_b32 v176, 4, v177
    v_lshl_add_u32 v49, v176, 4, v184
    v_xor_b32 v176, 8, v177
    v_lshl_add_u32 v50, v176, 4, v184
    v_xor_b32 v176, 12, v177
    v_lshl_add_u32 v51, v176, 4, v184
    v_bfe_u32 v177, v185, 7, 1
    v_lshlrev_b32 v177, 3, v177
    v_xor_b32 v177, v177, v179
    v_xor_b32 v177, v177, v180
    v_xor_b32 v176, 0, v177
    v_lshl_add_u32 v52, v176, 4, v185
    v_xor_b32 v176, 4, v177
    v_lshl_add_u32 v53, v176, 4, v185
    v_xor_b32 v176, 8, v177
    v_lshl_add_u32 v54, v176, 4, v185
    v_xor_b32 v176, 12, v177
    v_lshl_add_u32 v55, v176, 4, v185
    v_bfe_u32 v177, v186, 7, 1
    v_lshlrev_b32 v177, 3, v177
    v_xor_b32 v177, v177, v179
    v_xor_b32 v177, v177, v180
    v_xor_b32 v176, 0, v177
    v_lshl_add_u32 v56, v176, 4, v186
    v_xor_b32 v176, 4, v177
    v_lshl_add_u32 v57, v176, 4, v186
    v_xor_b32 v176, 8, v177
    v_lshl_add_u32 v58, v176, 4, v186
    v_xor_b32 v176, 12, v177
    v_lshl_add_u32 v59, v176, 4, v186
    v_bfe_u32 v177, v187, 7, 1
    v_lshlrev_b32 v177, 3, v177
    v_xor_b32 v177, v177, v179
    v_xor_b32 v177, v177, v180
    v_xor_b32 v176, 0, v177
    v_lshl_add_u32 v60, v176, 4, v187
    v_xor_b32 v176, 4, v177
    v_lshl_add_u32 v61, v176, 4, v187
    v_xor_b32 v176, 8, v177
    v_lshl_add_u32 v62, v176, 4, v187
    v_xor_b32 v176, 12, v177
    v_lshl_add_u32 v63, v176, 4, v187
    v_bfe_u32 v177, v188, 7, 1
    v_lshlrev_b32 v177, 3, v177
    v_xor_b32 v177, v177, v178
    v_xor_b32 v177, v177, v180
    v_xor_b32 v176, 0, v177
    v_lshl_add_u32 v64, v176, 4, v188
    v_xor_b32 v176, 4, v177
    v_lshl_add_u32 v65, v176, 4, v188
    v_xor_b32 v176, 8, v177
    v_lshl_add_u32 v66, v176, 4, v188
    v_xor_b32 v176, 12, v177
    v_lshl_add_u32 v67, v176, 4, v188
    v_bfe_u32 v177, v189, 7, 1
    v_lshlrev_b32 v177, 3, v177
    v_xor_b32 v177, v177, v178
    v_xor_b32 v177, v177, v180
    v_xor_b32 v176, 0, v177
    v_lshl_add_u32 v68, v176, 4, v189
    v_xor_b32 v176, 4, v177
    v_lshl_add_u32 v69, v176, 4, v189
    v_xor_b32 v176, 8, v177
    v_lshl_add_u32 v70, v176, 4, v189
    v_xor_b32 v176, 12, v177
    v_lshl_add_u32 v71, v176, 4, v189
    s_barrier
    ds_read_b128 v[72:75], v48 offset:0
    ds_read_b128 v[76:79], v56 offset:0
    ds_read_b128 v[80:83], v64 offset:0
    ds_read_b128 v[84:87], v49 offset:0
    ds_read_b128 v[88:91], v57 offset:0
    ds_read_b128 v[92:95], v65 offset:0
    s_waitcnt vmcnt(19) lgkmcnt(5)
    v_mfma_f32_16x16x32_bf16 v[0:3], v[96:99], v[72:75], 0
    ds_read_b128 v[72:75], v52 offset:0
    s_waitcnt lgkmcnt(5)
    v_mfma_f32_16x16x32_bf16 v[4:7], v[96:99], v[76:79], 0
    ds_read_b128 v[76:79], v60 offset:0
    s_waitcnt lgkmcnt(5)
    v_mfma_f32_16x16x32_bf16 v[8:11], v[96:99], v[80:83], 0
    ds_read_b128 v[80:83], v68 offset:0
    s_waitcnt vmcnt(18) lgkmcnt(5)
    v_mfma_f32_16x16x32_bf16 v[0:3], v[100:103], v[84:87], v[0:3]
    ds_read_b128 v[84:87], v53 offset:0
    s_waitcnt lgkmcnt(5)
    v_mfma_f32_16x16x32_bf16 v[4:7], v[100:103], v[88:91], v[4:7]
    ds_read_b128 v[88:91], v61 offset:0
    s_waitcnt lgkmcnt(5)
    v_mfma_f32_16x16x32_bf16 v[8:11], v[100:103], v[92:95], v[8:11]
    ds_read_b128 v[92:95], v69 offset:0
    s_waitcnt vmcnt(17) lgkmcnt(5)
    v_mfma_f32_16x16x32_bf16 v[0:3], v[104:107], v[72:75], v[0:3]
    ds_read_b128 v[72:75], v48 offset:1024
    s_waitcnt lgkmcnt(5)
    v_mfma_f32_16x16x32_bf16 v[4:7], v[104:107], v[76:79], v[4:7]
    ds_read_b128 v[76:79], v56 offset:1024
    s_waitcnt lgkmcnt(5)
    v_mfma_f32_16x16x32_bf16 v[8:11], v[104:107], v[80:83], v[8:11]
    ds_read_b128 v[80:83], v64 offset:1024
    s_waitcnt vmcnt(16) lgkmcnt(5)
    v_mfma_f32_16x16x32_bf16 v[0:3], v[108:111], v[84:87], v[0:3]
    ds_read_b128 v[84:87], v49 offset:1024
    s_waitcnt lgkmcnt(5)
    v_mfma_f32_16x16x32_bf16 v[4:7], v[108:111], v[88:91], v[4:7]
    ds_read_b128 v[88:91], v57 offset:1024
    s_waitcnt lgkmcnt(5)
    v_mfma_f32_16x16x32_bf16 v[8:11], v[108:111], v[92:95], v[8:11]
    ds_read_b128 v[92:95], v65 offset:1024
    s_waitcnt vmcnt(15) lgkmcnt(5)
    v_mfma_f32_16x16x32_bf16 v[0:3], v[112:115], v[72:75], v[0:3]
    ds_read_b128 v[72:75], v52 offset:1024
    s_waitcnt lgkmcnt(5)
    v_mfma_f32_16x16x32_bf16 v[4:7], v[112:115], v[76:79], v[4:7]
    ds_read_b128 v[76:79], v60 offset:1024
    s_waitcnt lgkmcnt(5)
    v_mfma_f32_16x16x32_bf16 v[8:11], v[112:115], v[80:83], v[8:11]
    ds_read_b128 v[80:83], v68 offset:1024
    s_waitcnt vmcnt(14) lgkmcnt(5)
    v_mfma_f32_16x16x32_bf16 v[0:3], v[116:119], v[84:87], v[0:3]
    ds_read_b128 v[84:87], v53 offset:1024
    s_waitcnt lgkmcnt(5)
    v_mfma_f32_16x16x32_bf16 v[4:7], v[116:119], v[88:91], v[4:7]
    ds_read_b128 v[88:91], v61 offset:1024
    s_waitcnt lgkmcnt(5)
    v_mfma_f32_16x16x32_bf16 v[8:11], v[116:119], v[92:95], v[8:11]
    ds_read_b128 v[92:95], v69 offset:1024
    s_waitcnt vmcnt(13) lgkmcnt(5)
    v_mfma_f32_16x16x32_bf16 v[0:3], v[120:123], v[72:75], v[0:3]
    ds_read_b128 v[72:75], v50 offset:0
    s_waitcnt lgkmcnt(5)
    v_mfma_f32_16x16x32_bf16 v[4:7], v[120:123], v[76:79], v[4:7]
    ds_read_b128 v[76:79], v58 offset:0
    s_waitcnt lgkmcnt(5)
    v_mfma_f32_16x16x32_bf16 v[8:11], v[120:123], v[80:83], v[8:11]
    ds_read_b128 v[80:83], v66 offset:0
    s_waitcnt vmcnt(12) lgkmcnt(5)
    v_mfma_f32_16x16x32_bf16 v[0:3], v[124:127], v[84:87], v[0:3]
    ds_read_b128 v[84:87], v48 offset:256
    s_waitcnt lgkmcnt(5)
    v_mfma_f32_16x16x32_bf16 v[4:7], v[124:127], v[88:91], v[4:7]
    ds_read_b128 v[88:91], v56 offset:256
    s_waitcnt lgkmcnt(5)
    v_mfma_f32_16x16x32_bf16 v[8:11], v[124:127], v[92:95], v[8:11]
    ds_read_b128 v[92:95], v64 offset:256
    s_waitcnt vmcnt(11) lgkmcnt(5)
    v_mfma_f32_16x16x32_bf16 v[12:15], v[128:131], v[72:75], 0
    ds_read_b128 v[72:75], v50 offset:256
    s_waitcnt lgkmcnt(5)
    v_mfma_f32_16x16x32_bf16 v[16:19], v[128:131], v[76:79], 0
    ds_read_b128 v[76:79], v58 offset:256
    s_waitcnt lgkmcnt(5)
    v_mfma_f32_16x16x32_bf16 v[20:23], v[128:131], v[80:83], 0
    ds_read_b128 v[80:83], v66 offset:256
    s_waitcnt lgkmcnt(5)
    v_mfma_f32_16x16x32_bf16 v[24:27], v[128:131], v[84:87], 0
    ds_read_b128 v[84:87], v51 offset:0
    s_waitcnt lgkmcnt(5)
    v_mfma_f32_16x16x32_bf16 v[28:31], v[128:131], v[88:91], 0
    ds_read_b128 v[88:91], v59 offset:0
    s_waitcnt lgkmcnt(5)
    v_mfma_f32_16x16x32_bf16 v[32:35], v[128:131], v[92:95], 0
    ds_read_b128 v[92:95], v67 offset:0
    s_waitcnt lgkmcnt(5)
    v_mfma_f32_16x16x32_bf16 v[36:39], v[128:131], v[72:75], 0
    ds_read_b128 v[72:75], v49 offset:256
    s_waitcnt lgkmcnt(5)
    v_mfma_f32_16x16x32_bf16 v[40:43], v[128:131], v[76:79], 0
    ds_read_b128 v[76:79], v57 offset:256
    s_waitcnt lgkmcnt(5)
    v_mfma_f32_16x16x32_bf16 v[44:47], v[128:131], v[80:83], 0
    ds_read_b128 v[80:83], v65 offset:256
    s_waitcnt vmcnt(10) lgkmcnt(5)
    v_mfma_f32_16x16x32_bf16 v[12:15], v[132:135], v[84:87], v[12:15]
    ds_read_b128 v[84:87], v51 offset:256
    s_waitcnt lgkmcnt(5)
    v_mfma_f32_16x16x32_bf16 v[16:19], v[132:135], v[88:91], v[16:19]
    ds_read_b128 v[88:91], v59 offset:256
    s_waitcnt lgkmcnt(5)
    v_mfma_f32_16x16x32_bf16 v[20:23], v[132:135], v[92:95], v[20:23]
    ds_read_b128 v[92:95], v67 offset:256
    s_waitcnt lgkmcnt(5)
    v_mfma_f32_16x16x32_bf16 v[24:27], v[132:135], v[72:75], v[24:27]
    ds_read_b128 v[72:75], v54 offset:0
    s_waitcnt lgkmcnt(5)
    v_mfma_f32_16x16x32_bf16 v[28:31], v[132:135], v[76:79], v[28:31]
    ds_read_b128 v[76:79], v62 offset:0
    s_waitcnt lgkmcnt(5)
    v_mfma_f32_16x16x32_bf16 v[32:35], v[132:135], v[80:83], v[32:35]
    ds_read_b128 v[80:83], v70 offset:0
    s_waitcnt lgkmcnt(5)
    v_mfma_f32_16x16x32_bf16 v[36:39], v[132:135], v[84:87], v[36:39]
    ds_read_b128 v[84:87], v52 offset:256
    s_waitcnt lgkmcnt(5)
    v_mfma_f32_16x16x32_bf16 v[40:43], v[132:135], v[88:91], v[40:43]
    ds_read_b128 v[88:91], v60 offset:256
    s_waitcnt lgkmcnt(5)
    v_mfma_f32_16x16x32_bf16 v[44:47], v[132:135], v[92:95], v[44:47]
    ds_read_b128 v[92:95], v68 offset:256
    s_waitcnt vmcnt(9) lgkmcnt(5)
    v_mfma_f32_16x16x32_bf16 v[12:15], v[136:139], v[72:75], v[12:15]
    ds_read_b128 v[72:75], v54 offset:256
    s_waitcnt lgkmcnt(5)
    v_mfma_f32_16x16x32_bf16 v[16:19], v[136:139], v[76:79], v[16:19]
    ds_read_b128 v[76:79], v62 offset:256
    s_waitcnt lgkmcnt(5)
    v_mfma_f32_16x16x32_bf16 v[20:23], v[136:139], v[80:83], v[20:23]
    ds_read_b128 v[80:83], v70 offset:256
    s_waitcnt lgkmcnt(5)
    v_mfma_f32_16x16x32_bf16 v[24:27], v[136:139], v[84:87], v[24:27]
    ds_read_b128 v[84:87], v55 offset:0
    s_waitcnt lgkmcnt(5)
    v_mfma_f32_16x16x32_bf16 v[28:31], v[136:139], v[88:91], v[28:31]
    ds_read_b128 v[88:91], v63 offset:0
    s_waitcnt lgkmcnt(5)
    v_mfma_f32_16x16x32_bf16 v[32:35], v[136:139], v[92:95], v[32:35]
    ds_read_b128 v[92:95], v71 offset:0
    s_waitcnt lgkmcnt(5)
    v_mfma_f32_16x16x32_bf16 v[36:39], v[136:139], v[72:75], v[36:39]
    ds_read_b128 v[72:75], v53 offset:256
    s_waitcnt lgkmcnt(5)
    v_mfma_f32_16x16x32_bf16 v[40:43], v[136:139], v[76:79], v[40:43]
    ds_read_b128 v[76:79], v61 offset:256
    s_waitcnt lgkmcnt(5)
    v_mfma_f32_16x16x32_bf16 v[44:47], v[136:139], v[80:83], v[44:47]
    ds_read_b128 v[80:83], v69 offset:256
    s_waitcnt vmcnt(8) lgkmcnt(5)
    v_mfma_f32_16x16x32_bf16 v[12:15], v[140:143], v[84:87], v[12:15]
    ds_read_b128 v[84:87], v55 offset:256
    s_waitcnt lgkmcnt(5)
    v_mfma_f32_16x16x32_bf16 v[16:19], v[140:143], v[88:91], v[16:19]
    ds_read_b128 v[88:91], v63 offset:256
    s_waitcnt lgkmcnt(5)
    v_mfma_f32_16x16x32_bf16 v[20:23], v[140:143], v[92:95], v[20:23]
    ds_read_b128 v[92:95], v71 offset:256
    s_waitcnt lgkmcnt(5)
    v_mfma_f32_16x16x32_bf16 v[24:27], v[140:143], v[72:75], v[24:27]
    ds_read_b128 v[72:75], v48 offset:512
    s_waitcnt lgkmcnt(5)
    v_mfma_f32_16x16x32_bf16 v[28:31], v[140:143], v[76:79], v[28:31]
    ds_read_b128 v[76:79], v56 offset:512
    s_waitcnt lgkmcnt(5)
    v_mfma_f32_16x16x32_bf16 v[32:35], v[140:143], v[80:83], v[32:35]
    ds_read_b128 v[80:83], v64 offset:512
    s_waitcnt lgkmcnt(5)
    v_mfma_f32_16x16x32_bf16 v[36:39], v[140:143], v[84:87], v[36:39]
    ds_read_b128 v[84:87], v50 offset:512
    s_waitcnt lgkmcnt(5)
    v_mfma_f32_16x16x32_bf16 v[40:43], v[140:143], v[88:91], v[40:43]
    ds_read_b128 v[88:91], v58 offset:512
    s_waitcnt lgkmcnt(5)
    v_mfma_f32_16x16x32_bf16 v[44:47], v[140:143], v[92:95], v[44:47]
    ds_read_b128 v[92:95], v66 offset:512
    s_waitcnt vmcnt(7) lgkmcnt(5)
    v_mfma_f32_16x16x32_bf16 v[12:15], v[144:147], v[72:75], v[12:15]
    ds_read_b128 v[72:75], v48 offset:768
    s_waitcnt lgkmcnt(5)
    v_mfma_f32_16x16x32_bf16 v[16:19], v[144:147], v[76:79], v[16:19]
    ds_read_b128 v[76:79], v56 offset:768
    s_waitcnt lgkmcnt(5)
    v_mfma_f32_16x16x32_bf16 v[20:23], v[144:147], v[80:83], v[20:23]
    ds_read_b128 v[80:83], v64 offset:768
    s_waitcnt lgkmcnt(5)
    v_mfma_f32_16x16x32_bf16 v[24:27], v[144:147], v[84:87], v[24:27]
    ds_read_b128 v[84:87], v49 offset:512
    s_waitcnt lgkmcnt(5)
    v_mfma_f32_16x16x32_bf16 v[28:31], v[144:147], v[88:91], v[28:31]
    ds_read_b128 v[88:91], v57 offset:512
    s_waitcnt lgkmcnt(5)
    v_mfma_f32_16x16x32_bf16 v[32:35], v[144:147], v[92:95], v[32:35]
    ds_read_b128 v[92:95], v65 offset:512
    s_waitcnt lgkmcnt(5)
    v_mfma_f32_16x16x32_bf16 v[36:39], v[144:147], v[72:75], v[36:39]
    ds_read_b128 v[72:75], v51 offset:512
    s_waitcnt lgkmcnt(5)
    v_mfma_f32_16x16x32_bf16 v[40:43], v[144:147], v[76:79], v[40:43]
    ds_read_b128 v[76:79], v59 offset:512
    s_waitcnt lgkmcnt(5)
    v_mfma_f32_16x16x32_bf16 v[44:47], v[144:147], v[80:83], v[44:47]
    ds_read_b128 v[80:83], v67 offset:512
    s_waitcnt vmcnt(6) lgkmcnt(5)
    v_mfma_f32_16x16x32_bf16 v[12:15], v[148:151], v[84:87], v[12:15]
    ds_read_b128 v[84:87], v49 offset:768
    s_waitcnt lgkmcnt(5)
    v_mfma_f32_16x16x32_bf16 v[16:19], v[148:151], v[88:91], v[16:19]
    ds_read_b128 v[88:91], v57 offset:768
    s_waitcnt lgkmcnt(5)
    v_mfma_f32_16x16x32_bf16 v[20:23], v[148:151], v[92:95], v[20:23]
    ds_read_b128 v[92:95], v65 offset:768
    s_waitcnt lgkmcnt(5)
    v_mfma_f32_16x16x32_bf16 v[24:27], v[148:151], v[72:75], v[24:27]
    ds_read_b128 v[72:75], v52 offset:512
    s_waitcnt lgkmcnt(5)
    v_mfma_f32_16x16x32_bf16 v[28:31], v[148:151], v[76:79], v[28:31]
    ds_read_b128 v[76:79], v60 offset:512
    s_waitcnt lgkmcnt(5)
    v_mfma_f32_16x16x32_bf16 v[32:35], v[148:151], v[80:83], v[32:35]
    ds_read_b128 v[80:83], v68 offset:512
    s_waitcnt lgkmcnt(5)
    v_mfma_f32_16x16x32_bf16 v[36:39], v[148:151], v[84:87], v[36:39]
    ds_read_b128 v[84:87], v54 offset:512
    s_waitcnt lgkmcnt(5)
    v_mfma_f32_16x16x32_bf16 v[40:43], v[148:151], v[88:91], v[40:43]
    ds_read_b128 v[88:91], v62 offset:512
    s_waitcnt lgkmcnt(5)
    v_mfma_f32_16x16x32_bf16 v[44:47], v[148:151], v[92:95], v[44:47]
    ds_read_b128 v[92:95], v70 offset:512
    s_waitcnt vmcnt(5) lgkmcnt(5)
    v_mfma_f32_16x16x32_bf16 v[12:15], v[152:155], v[72:75], v[12:15]
    ds_read_b128 v[72:75], v52 offset:768
    s_waitcnt lgkmcnt(5)
    v_mfma_f32_16x16x32_bf16 v[16:19], v[152:155], v[76:79], v[16:19]
    ds_read_b128 v[76:79], v60 offset:768
    s_waitcnt lgkmcnt(5)
    v_mfma_f32_16x16x32_bf16 v[20:23], v[152:155], v[80:83], v[20:23]
    ds_read_b128 v[80:83], v68 offset:768
    s_waitcnt lgkmcnt(5)
    v_mfma_f32_16x16x32_bf16 v[24:27], v[152:155], v[84:87], v[24:27]
    ds_read_b128 v[84:87], v53 offset:512
    s_waitcnt lgkmcnt(5)
    v_mfma_f32_16x16x32_bf16 v[28:31], v[152:155], v[88:91], v[28:31]
    ds_read_b128 v[88:91], v61 offset:512
    s_waitcnt lgkmcnt(5)
    v_mfma_f32_16x16x32_bf16 v[32:35], v[152:155], v[92:95], v[32:35]
    ds_read_b128 v[92:95], v69 offset:512
    s_waitcnt lgkmcnt(5)
    v_mfma_f32_16x16x32_bf16 v[36:39], v[152:155], v[72:75], v[36:39]
    ds_read_b128 v[72:75], v55 offset:512
    s_waitcnt lgkmcnt(5)
    v_mfma_f32_16x16x32_bf16 v[40:43], v[152:155], v[76:79], v[40:43]
    ds_read_b128 v[76:79], v63 offset:512
    s_waitcnt lgkmcnt(5)
    v_mfma_f32_16x16x32_bf16 v[44:47], v[152:155], v[80:83], v[44:47]
    ds_read_b128 v[80:83], v71 offset:512
    s_waitcnt vmcnt(4) lgkmcnt(5)
    v_mfma_f32_16x16x32_bf16 v[12:15], v[156:159], v[84:87], v[12:15]
    ds_read_b128 v[84:87], v53 offset:768
    s_waitcnt lgkmcnt(5)
    v_mfma_f32_16x16x32_bf16 v[16:19], v[156:159], v[88:91], v[16:19]
    ds_read_b128 v[88:91], v61 offset:768
    s_waitcnt lgkmcnt(5)
    v_mfma_f32_16x16x32_bf16 v[20:23], v[156:159], v[92:95], v[20:23]
    ds_read_b128 v[92:95], v69 offset:768
    s_waitcnt lgkmcnt(5)
    v_mfma_f32_16x16x32_bf16 v[24:27], v[156:159], v[72:75], v[24:27]
    ds_read_b128 v[72:75], v50 offset:1024
    s_waitcnt lgkmcnt(5)
    v_mfma_f32_16x16x32_bf16 v[28:31], v[156:159], v[76:79], v[28:31]
    ds_read_b128 v[76:79], v58 offset:1024
    s_waitcnt lgkmcnt(5)
    v_mfma_f32_16x16x32_bf16 v[32:35], v[156:159], v[80:83], v[32:35]
    ds_read_b128 v[80:83], v66 offset:1024
    s_waitcnt lgkmcnt(5)
    v_mfma_f32_16x16x32_bf16 v[36:39], v[156:159], v[84:87], v[36:39]
    ds_read_b128 v[84:87], v48 offset:1280
    s_waitcnt lgkmcnt(5)
    v_mfma_f32_16x16x32_bf16 v[40:43], v[156:159], v[88:91], v[40:43]
    ds_read_b128 v[88:91], v56 offset:1280
    s_waitcnt lgkmcnt(5)
    v_mfma_f32_16x16x32_bf16 v[44:47], v[156:159], v[92:95], v[44:47]
    ds_read_b128 v[92:95], v64 offset:1280
    s_waitcnt vmcnt(3) lgkmcnt(5)
    v_mfma_f32_16x16x32_bf16 v[12:15], v[160:163], v[72:75], v[12:15]
    ds_read_b128 v[72:75], v50 offset:768
    s_waitcnt lgkmcnt(5)
    v_mfma_f32_16x16x32_bf16 v[16:19], v[160:163], v[76:79], v[16:19]
    ds_read_b128 v[76:79], v58 offset:768
    s_waitcnt lgkmcnt(5)
    v_mfma_f32_16x16x32_bf16 v[20:23], v[160:163], v[80:83], v[20:23]
    ds_read_b128 v[80:83], v66 offset:768
    s_waitcnt lgkmcnt(5)
    v_mfma_f32_16x16x32_bf16 v[24:27], v[160:163], v[84:87], v[24:27]
    ds_read_b128 v[84:87], v51 offset:1024
    s_waitcnt lgkmcnt(5)
    v_mfma_f32_16x16x32_bf16 v[28:31], v[160:163], v[88:91], v[28:31]
    ds_read_b128 v[88:91], v59 offset:1024
    s_waitcnt lgkmcnt(5)
    v_mfma_f32_16x16x32_bf16 v[32:35], v[160:163], v[92:95], v[32:35]
    ds_read_b128 v[92:95], v67 offset:1024
    s_waitcnt lgkmcnt(5)
    v_mfma_f32_16x16x32_bf16 v[36:39], v[160:163], v[72:75], v[36:39]
    ds_read_b128 v[72:75], v49 offset:1280
    s_waitcnt lgkmcnt(5)
    v_mfma_f32_16x16x32_bf16 v[40:43], v[160:163], v[76:79], v[40:43]
    ds_read_b128 v[76:79], v57 offset:1280
    s_waitcnt lgkmcnt(5)
    v_mfma_f32_16x16x32_bf16 v[44:47], v[160:163], v[80:83], v[44:47]
    ds_read_b128 v[80:83], v65 offset:1280
    s_waitcnt vmcnt(2) lgkmcnt(5)
    v_mfma_f32_16x16x32_bf16 v[12:15], v[164:167], v[84:87], v[12:15]
    ds_read_b128 v[84:87], v51 offset:768
    s_waitcnt lgkmcnt(5)
    v_mfma_f32_16x16x32_bf16 v[16:19], v[164:167], v[88:91], v[16:19]
    ds_read_b128 v[88:91], v59 offset:768
    s_waitcnt lgkmcnt(5)
    v_mfma_f32_16x16x32_bf16 v[20:23], v[164:167], v[92:95], v[20:23]
    ds_read_b128 v[92:95], v67 offset:768
    s_waitcnt lgkmcnt(5)
    v_mfma_f32_16x16x32_bf16 v[24:27], v[164:167], v[72:75], v[24:27]
    ds_read_b128 v[72:75], v54 offset:1024
    s_waitcnt lgkmcnt(5)
    v_mfma_f32_16x16x32_bf16 v[28:31], v[164:167], v[76:79], v[28:31]
    ds_read_b128 v[76:79], v62 offset:1024
    s_waitcnt lgkmcnt(5)
    v_mfma_f32_16x16x32_bf16 v[32:35], v[164:167], v[80:83], v[32:35]
    ds_read_b128 v[80:83], v70 offset:1024
    s_waitcnt lgkmcnt(5)
    v_mfma_f32_16x16x32_bf16 v[36:39], v[164:167], v[84:87], v[36:39]
    ds_read_b128 v[84:87], v52 offset:1280
    s_waitcnt lgkmcnt(5)
    v_mfma_f32_16x16x32_bf16 v[40:43], v[164:167], v[88:91], v[40:43]
    ds_read_b128 v[88:91], v60 offset:1280
    s_waitcnt lgkmcnt(5)
    v_mfma_f32_16x16x32_bf16 v[44:47], v[164:167], v[92:95], v[44:47]
    ds_read_b128 v[92:95], v68 offset:1280
    s_waitcnt vmcnt(1) lgkmcnt(5)
    v_mfma_f32_16x16x32_bf16 v[12:15], v[168:171], v[72:75], v[12:15]
    ds_read_b128 v[72:75], v54 offset:768
    s_waitcnt lgkmcnt(5)
    v_mfma_f32_16x16x32_bf16 v[16:19], v[168:171], v[76:79], v[16:19]
    ds_read_b128 v[76:79], v62 offset:768
    s_waitcnt lgkmcnt(5)
    v_mfma_f32_16x16x32_bf16 v[20:23], v[168:171], v[80:83], v[20:23]
    ds_read_b128 v[80:83], v70 offset:768
    s_waitcnt lgkmcnt(5)
    v_mfma_f32_16x16x32_bf16 v[24:27], v[168:171], v[84:87], v[24:27]
    ds_read_b128 v[84:87], v55 offset:1024
    s_waitcnt lgkmcnt(5)
    v_mfma_f32_16x16x32_bf16 v[28:31], v[168:171], v[88:91], v[28:31]
    ds_read_b128 v[88:91], v63 offset:1024
    s_waitcnt lgkmcnt(5)
    v_mfma_f32_16x16x32_bf16 v[32:35], v[168:171], v[92:95], v[32:35]
    ds_read_b128 v[92:95], v71 offset:1024
    s_waitcnt lgkmcnt(5)
    v_mfma_f32_16x16x32_bf16 v[36:39], v[168:171], v[72:75], v[36:39]
    ds_read_b128 v[72:75], v53 offset:1280
    s_waitcnt lgkmcnt(5)
    v_mfma_f32_16x16x32_bf16 v[40:43], v[168:171], v[76:79], v[40:43]
    ds_read_b128 v[76:79], v61 offset:1280
    s_waitcnt lgkmcnt(5)
    v_mfma_f32_16x16x32_bf16 v[44:47], v[168:171], v[80:83], v[44:47]
    ds_read_b128 v[80:83], v69 offset:1280
    s_waitcnt vmcnt(0) lgkmcnt(5)
    v_mfma_f32_16x16x32_bf16 v[12:15], v[172:175], v[84:87], v[12:15]
    ds_read_b128 v[84:87], v55 offset:768
    s_waitcnt lgkmcnt(5)
    v_mfma_f32_16x16x32_bf16 v[16:19], v[172:175], v[88:91], v[16:19]
    ds_read_b128 v[88:91], v63 offset:768
    s_waitcnt lgkmcnt(5)
    v_mfma_f32_16x16x32_bf16 v[20:23], v[172:175], v[92:95], v[20:23]
    ds_read_b128 v[92:95], v71 offset:768
    s_waitcnt lgkmcnt(5)
    v_mfma_f32_16x16x32_bf16 v[24:27], v[172:175], v[72:75], v[24:27]
    s_waitcnt lgkmcnt(4)
    v_mfma_f32_16x16x32_bf16 v[28:31], v[172:175], v[76:79], v[28:31]
    s_waitcnt lgkmcnt(3)
    v_mfma_f32_16x16x32_bf16 v[32:35], v[172:175], v[80:83], v[32:35]
    s_waitcnt lgkmcnt(2)
    v_mfma_f32_16x16x32_bf16 v[36:39], v[172:175], v[84:87], v[36:39]
    s_waitcnt lgkmcnt(1)
    v_mfma_f32_16x16x32_bf16 v[40:43], v[172:175], v[88:91], v[40:43]
    s_waitcnt lgkmcnt(0)
    v_mfma_f32_16x16x32_bf16 v[44:47], v[172:175], v[92:95], v[44:47]
    s_mov_b32 s62, 0xbfb8aa3b
    v_mul_f32 v72, s62, v0
    v_mul_f32 v73, s62, v1
    v_mul_f32 v74, s62, v2
    v_mul_f32 v75, s62, v3
    v_mul_f32 v76, s62, v4
    v_mul_f32 v77, s62, v5
    v_mul_f32 v78, s62, v6
    v_mul_f32 v79, s62, v7
    v_mul_f32 v80, s62, v8
    v_mul_f32 v81, s62, v9
    v_mul_f32 v82, s62, v10
    v_mul_f32 v83, s62, v11
    v_exp_f32 v72, v72
    v_exp_f32 v73, v73
    v_exp_f32 v74, v74
    v_exp_f32 v75, v75
    v_exp_f32 v76, v76
    v_exp_f32 v77, v77
    v_exp_f32 v78, v78
    v_exp_f32 v79, v79
    v_exp_f32 v80, v80
    v_exp_f32 v81, v81
    v_exp_f32 v82, v82
    v_exp_f32 v83, v83
    v_add_f32 v72, 1.0, v72
    v_add_f32 v73, 1.0, v73
    v_add_f32 v74, 1.0, v74
    v_add_f32 v75, 1.0, v75
    v_add_f32 v76, 1.0, v76
    v_add_f32 v77, 1.0, v77
    v_add_f32 v78, 1.0, v78
    v_add_f32 v79, 1.0, v79
    v_add_f32 v80, 1.0, v80
    v_add_f32 v81, 1.0, v81
    v_add_f32 v82, 1.0, v82
    v_add_f32 v83, 1.0, v83
    v_rcp_f32 v72, v72
    v_rcp_f32 v73, v73
    v_rcp_f32 v74, v74
    v_rcp_f32 v75, v75
    v_rcp_f32 v76, v76
    v_rcp_f32 v77, v77
    v_rcp_f32 v78, v78
    v_rcp_f32 v79, v79
    v_rcp_f32 v80, v80
    v_rcp_f32 v81, v81
    v_rcp_f32 v82, v82
    v_rcp_f32 v83, v83
    s_mul_i32 s62, s88, 40960
    s_lshl_b32 s63, s28, 5
    s_add_u32 s62, s62, s63
    v_lshlrev_b32 v182, 10, v179
    v_lshl_add_u32 v182, v180, 3, v182
    v_add_u32 v183, 0x4000, v182
    v_add_u32 v184, 0x8000, v182
    v_mov_b32 v185, 0x7f000000
    v_cmp_gt_u32 vcc, 8, v179
    v_mul_f32 v12, v12, v72
    v_mul_f32 v13, v13, v73
    v_mul_f32 v14, v14, v74
    v_mul_f32 v15, v15, v75
    v_mul_f32 v16, v16, v76
    v_mul_f32 v17, v17, v77
    v_mul_f32 v18, v18, v78
    v_mul_f32 v19, v19, v79
    v_mul_f32 v20, v20, v80
    v_mul_f32 v21, v21, v81
    v_mul_f32 v22, v22, v82
    v_mul_f32 v23, v23, v83
    v_mul_f32 v24, v24, v72
    v_mul_f32 v25, v25, v73
    v_mul_f32 v26, v26, v74
    v_mul_f32 v27, v27, v75
    v_mul_f32 v28, v28, v76
    v_mul_f32 v29, v29, v77
    v_mul_f32 v30, v30, v78
    v_mul_f32 v31, v31, v79
    v_mul_f32 v32, v32, v80
    v_mul_f32 v33, v33, v81
    v_mul_f32 v34, v34, v82
    v_mul_f32 v35, v35, v83
    v_mul_f32 v36, v36, v72
    v_mul_f32 v37, v37, v73
    v_mul_f32 v38, v38, v74
    v_mul_f32 v39, v39, v75
    v_mul_f32 v40, v40, v76
    v_mul_f32 v41, v41, v77
    v_mul_f32 v42, v42, v78
    v_mul_f32 v43, v43, v79
    v_mul_f32 v44, v44, v80
    v_mul_f32 v45, v45, v81
    v_mul_f32 v46, v46, v82
    v_mul_f32 v47, v47, v83
    v_cndmask_b32 v184, v185, v184, vcc
    v_cvt_pk_bf16_f32 v0, v0, v1
    v_cvt_pk_bf16_f32 v1, v2, v3
    buffer_store_dwordx2 v[0:1], v182, s[16:19], s62 offen offset:0
    v_cvt_pk_bf16_f32 v4, v4, v5
    v_cvt_pk_bf16_f32 v5, v6, v7
    buffer_store_dwordx2 v[4:5], v183, s[16:19], s62 offen offset:0
    v_cvt_pk_bf16_f32 v8, v8, v9
    v_cvt_pk_bf16_f32 v9, v10, v11
    buffer_store_dwordx2 v[8:9], v184, s[16:19], s62 offen offset:0
    v_cvt_pk_bf16_f32 v12, v12, v13
    v_cvt_pk_bf16_f32 v13, v14, v15
    buffer_store_dwordx2 v[12:13], v182, s[16:19], s62 offen offset:256
    v_cvt_pk_bf16_f32 v16, v16, v17
    v_cvt_pk_bf16_f32 v17, v18, v19
    buffer_store_dwordx2 v[16:17], v183, s[16:19], s62 offen offset:256
    v_cvt_pk_bf16_f32 v20, v20, v21
    v_cvt_pk_bf16_f32 v21, v22, v23
    buffer_store_dwordx2 v[20:21], v184, s[16:19], s62 offen offset:256
    v_cvt_pk_bf16_f32 v24, v24, v25
    v_cvt_pk_bf16_f32 v25, v26, v27
    buffer_store_dwordx2 v[24:25], v182, s[16:19], s62 offen offset:512
    v_cvt_pk_bf16_f32 v28, v28, v29
    v_cvt_pk_bf16_f32 v29, v30, v31
    buffer_store_dwordx2 v[28:29], v183, s[16:19], s62 offen offset:512
    v_cvt_pk_bf16_f32 v32, v32, v33
    v_cvt_pk_bf16_f32 v33, v34, v35
    buffer_store_dwordx2 v[32:33], v184, s[16:19], s62 offen offset:512
    v_cvt_pk_bf16_f32 v36, v36, v37
    v_cvt_pk_bf16_f32 v37, v38, v39
    buffer_store_dwordx2 v[36:37], v182, s[16:19], s62 offen offset:768
    v_cvt_pk_bf16_f32 v40, v40, v41
    v_cvt_pk_bf16_f32 v41, v42, v43
    buffer_store_dwordx2 v[40:41], v183, s[16:19], s62 offen offset:768
    v_cvt_pk_bf16_f32 v44, v44, v45
    v_cvt_pk_bf16_f32 v45, v46, v47
    buffer_store_dwordx2 v[44:45], v184, s[16:19], s62 offen offset:768
K2_end:
    s_endpgm
SLOW:
    s_endpgm
.section .rodata,"a"
.p2align 6
.amdhsa_kernel tp_prep_kernel
  .amdhsa_next_free_vgpr 88
  .amdhsa_next_free_sgpr 48
  .amdhsa_accum_offset 88
  .amdhsa_group_segment_fixed_size 0
  .amdhsa_kernarg_size 96
  .amdhsa_user_sgpr_count 2
  .amdhsa_user_sgpr_kernarg_segment_ptr 1
  .amdhsa_system_sgpr_workgroup_id_x 1
.end_amdhsa_kernel
.p2align 6
.amdhsa_kernel standalone__tensor_product_equiv_equiformer__graph_kernel
  .amdhsa_next_free_vgpr 256
  .amdhsa_next_free_sgpr 89
  .amdhsa_accum_offset 256
  .amdhsa_group_segment_fixed_size 0
  .amdhsa_kernarg_size 96
  .amdhsa_user_sgpr_count 2
  .amdhsa_user_sgpr_kernarg_segment_ptr 1
  .amdhsa_system_sgpr_workgroup_id_x 1
.end_amdhsa_kernel
```

```asm
; @launch kernel=tp_prep_kernel grid=(256,1,1) block=(640,1,1) lds=97280
; @launch kernel=standalone__tensor_product_equiv_equiformer__graph_kernel grid=(250,1,1) block=(512,1,1) lds=163840
.amdgcn_target "amdgcn-amd-amdhsa--gfx950"
.text
.globl tp_prep_kernel
.p2align 8
.type tp_prep_kernel,@function
tp_prep_kernel:
    s_cmp_ge_u32 s2, 256
    s_cbranch_scc1 K1_end
    s_load_dwordx2 s[4:5], s[0:1], 8
    s_load_dwordx4 s[8:11], s[0:1], 24
    s_load_dwordx4 s[12:15], s[0:1], 40
    s_load_dwordx2 s[16:17], s[0:1], 56
    s_load_dwordx2 s[18:19], s[0:1], 88
    s_cmp_ge_u32 s2, 125
    s_cbranch_scc1 K1_wprep
    v_and_b32 v1, 255, v0
    v_lshlrev_b32 v1, 2, v1
    v_mov_b32 v2, 0
    v_add_u32 v1, 96000, v1
    ds_write_b32 v1, v2
    v_lshlrev_b32 v3, 4, v0
    v_mul_u32_u24 v4, 24, v0
    s_mul_i32 s3, s2, 10240
    s_mul_i32 s20, s2, 15360
    s_mul_i32 s21, s2, 2560
    s_waitcnt lgkmcnt(0)
    s_mov_b32 s24, s10
    s_and_b32 s25, s11, 0xffff
    s_mov_b32 s26, 1280000
    s_mov_b32 s27, 0x20000
    s_mov_b32 s28, s8
    s_and_b32 s29, s9, 0xffff
    s_mov_b32 s30, 1280000
    s_mov_b32 s31, 0x20000
    s_mov_b32 s32, s4
    s_and_b32 s33, s5, 0xffff
    s_mov_b32 s34, 1920000
    s_mov_b32 s35, 0x20000
    s_mov_b32 s36, s18
    s_and_b32 s37, s19, 0xffff
    s_mov_b32 s38, 12492800
    s_mov_b32 s39, 0x20000
    buffer_load_dwordx4 v[8:11], v3, s[24:27], s3 offen
    buffer_load_dwordx4 v[12:15], v3, s[28:31], s3 offen
    buffer_load_dwordx4 v[16:19], v4, s[32:35], s20 offen
    buffer_load_dwordx2 v[20:21], v4, s[32:35], s20 offen offset:16
    v_lshl_add_u32 v5, v0, 2, s21
    v_mov_b32 v6, 1
    s_mov_b32 s22, 52429
    s_mov_b32 s23, 0x05040100
    s_barrier
    s_waitcnt vmcnt(3)
    v_mul_u32_u24 v22, s22, v8
    v_mul_u32_u24 v23, s22, v9
    v_mul_u32_u24 v24, s22, v10
    v_mul_u32_u24 v25, s22, v11
    v_lshrrev_b32 v22, 21, v22
    v_lshrrev_b32 v23, 21, v23
    v_lshrrev_b32 v24, 21, v24
    v_lshrrev_b32 v25, 21, v25
    v_min_u32 v22, 249, v22
    v_min_u32 v23, 249, v23
    v_min_u32 v24, 249, v24
    v_min_u32 v25, 249, v25
    v_lshlrev_b32 v34, 2, v22
    v_lshlrev_b32 v35, 2, v23
    v_lshlrev_b32 v36, 2, v24
    v_lshlrev_b32 v37, 2, v25
    v_add_u32 v34, 96000, v34
    ds_add_rtn_u32 v26, v34, v6
    v_add_u32 v35, 96000, v35
    ds_add_rtn_u32 v27, v35, v6
    v_add_u32 v36, 96000, v36
    ds_add_rtn_u32 v28, v36, v6
    v_add_u32 v37, 96000, v37
    ds_add_rtn_u32 v29, v37, v6
    v_mul_u32_u24 v30, 40, v22
    v_sub_u32 v30, v8, v30
    v_and_b32 v30, 63, v30
    v_add_u32 v7, 0, v5
    v_lshl_or_b32 v30, v30, 19, v7
    v_mul_u32_u24 v22, 384, v22
    v_mul_u32_u24 v31, 40, v23
    v_sub_u32 v31, v9, v31
    v_and_b32 v31, 63, v31
    v_add_u32 v7, 1, v5
    v_lshl_or_b32 v31, v31, 19, v7
    v_mul_u32_u24 v23, 384, v23
    v_mul_u32_u24 v32, 40, v24
    v_sub_u32 v32, v10, v32
    v_and_b32 v32, 63, v32
    v_add_u32 v7, 2, v5
    v_lshl_or_b32 v32, v32, 19, v7
    v_mul_u32_u24 v24, 384, v24
    v_mul_u32_u24 v33, 40, v25
    v_sub_u32 v33, v11, v33
    v_and_b32 v33, 63, v33
    v_add_u32 v7, 3, v5
    v_lshl_or_b32 v33, v33, 19, v7
    v_mul_u32_u24 v25, 384, v25
    s_waitcnt vmcnt(0)
    v_mov_b32 v40, v16
    v_perm_b32 v41, v12, v17, s23
    v_alignbit_b32 v42, v18, v17, 16
    v_alignbit_b32 v43, v13, v18, 16
    v_mov_b32 v44, v19
    v_perm_b32 v45, v14, v20, s23
    v_alignbit_b32 v46, v21, v20, 16
    v_alignbit_b32 v47, v15, v21, 16
    v_mov_b32 v48, 97024
    s_waitcnt lgkmcnt(0)
    v_cmp_gt_u32 vcc, 32, v26
    v_lshl_add_u32 v34, v26, 2, v22
    v_lshl_add_u32 v8, v26, 3, v22
    v_cndmask_b32 v34, v48, v34, vcc
    v_cndmask_b32 v8, v48, v8, vcc
    ds_write_b32 v34, v30
    ds_write_b64 v8, v[40:41] offset:128
    v_cmp_gt_u32 vcc, 32, v27
    v_lshl_add_u32 v35, v27, 2, v23
    v_lshl_add_u32 v9, v27, 3, v23
    v_cndmask_b32 v35, v48, v35, vcc
    v_cndmask_b32 v9, v48, v9, vcc
    ds_write_b32 v35, v31
    ds_write_b64 v9, v[42:43] offset:128
    v_cmp_gt_u32 vcc, 32, v28
    v_lshl_add_u32 v36, v28, 2, v24
    v_lshl_add_u32 v10, v28, 3, v24
    v_cndmask_b32 v36, v48, v36, vcc
    v_cndmask_b32 v10, v48, v10, vcc
    ds_write_b32 v36, v32
    ds_write_b64 v10, v[44:45] offset:128
    v_cmp_gt_u32 vcc, 32, v29
    v_lshl_add_u32 v37, v29, 2, v25
    v_lshl_add_u32 v11, v29, 3, v25
    v_cndmask_b32 v37, v48, v37, vcc
    v_cndmask_b32 v11, v48, v11, vcc
    ds_write_b32 v37, v33
    ds_write_b64 v11, v[46:47] offset:128
    v_lshrrev_b32 v1, 4, v0
    v_and_b32 v2, 15, v0
    v_mul_u32_u24 v3, 384, v1
    v_lshl_add_u32 v3, v2, 4, v3
    v_lshlrev_b32 v4, 2, v1
    v_add_u32 v4, 96000, v4
    s_mov_b32 s22, 49152
    v_mul_lo_u32 v5, s22, v1
    v_lshl_add_u32 v5, v2, 4, v5
    s_mul_i32 s3, s2, 384
    v_lshlrev_b32 v6, 2, v2
    v_subrev_u32 v7, 8, v2
    v_lshlrev_b32 v7, 1, v7
    v_cmp_gt_u32 vcc, 8, v2
    s_nop 1
    v_cndmask_b32 v6, v7, v6, vcc
    v_cmp_eq_u32 s[40:41], 0, v2
    v_lshl_add_u32 v7, v2, 1, 16
    s_waitcnt lgkmcnt(0)
    s_barrier
    ds_read_b128 v[52:55], v3 offset:0
    ds_read_b32 v8, v4 offset:0
    ds_read_b128 v[56:59], v3 offset:15360
    ds_read_b32 v9, v4 offset:160
    ds_read_b128 v[60:63], v3 offset:30720
    ds_read_b32 v10, v4 offset:320
    ds_read_b128 v[64:67], v3 offset:46080
    ds_read_b32 v11, v4 offset:480
    ds_read_b128 v[68:71], v3 offset:61440
    ds_read_b32 v12, v4 offset:640
    v_add_u32 v49, 76800, v3
    ds_read_b128 v[72:75], v49 offset:0
    ds_read_b32 v13, v4 offset:800
    ds_read_b128 v[76:79], v49 offset:15360
    ds_read_b32 v14, v4 offset:960
    s_waitcnt lgkmcnt(12)
    v_min_u32 v20, 127, v8
    v_and_b32 v21, 0x1ffffff, v52
    v_lshl_or_b32 v21, v20, 25, v21
    v_cndmask_b32 v52, v52, v21, s[40:41]
    v_cmp_lt_u32 vcc, v6, v8
    s_or_b64 vcc, vcc, s[40:41]
    s_and_saveexec_b64 s[44:45], vcc
    s_cbranch_execz K1_skip0
    buffer_store_dwordx4 v[52:55], v5, s[36:39], s3 offen
K1_skip0:
    s_mov_b64 exec, s[44:45]
    v_cmp_lt_u32 vcc, v7, v8
    v_cmp_gt_u32 s[42:43], 8, v2
    s_and_b64 vcc, vcc, s[42:43]
    s_and_saveexec_b64 s[44:45], vcc
    s_cbranch_execz K1_skipb0
    v_add_u32 v20, 256, v3
    ds_read_b128 v[24:27], v20
    s_waitcnt lgkmcnt(0)
    buffer_store_dwordx4 v[24:27], v5, s[36:39], s3 offen offset:256
    s_nop 1
K1_skipb0:
    s_mov_b64 exec, s[44:45]
    s_add_u32 s3, s3, 1966080
    s_waitcnt lgkmcnt(10)
    v_min_u32 v20, 127, v9
    v_and_b32 v21, 0x1ffffff, v56
    v_lshl_or_b32 v21, v20, 25, v21
    v_cndmask_b32 v56, v56, v21, s[40:41]
    v_cmp_lt_u32 vcc, v6, v9
    s_or_b64 vcc, vcc, s[40:41]
    s_and_saveexec_b64 s[44:45], vcc
    s_cbranch_execz K1_skip1
    buffer_store_dwordx4 v[56:59], v5, s[36:39], s3 offen
K1_skip1:
    s_mov_b64 exec, s[44:45]
    v_cmp_lt_u32 vcc, v7, v9
    v_cmp_gt_u32 s[42:43], 8, v2
    s_and_b64 vcc, vcc, s[42:43]
    s_and_saveexec_b64 s[44:45], vcc
    s_cbranch_execz K1_skipb1
    v_add_u32 v20, 15616, v3
    ds_read_b128 v[24:27], v20
    s_waitcnt lgkmcnt(0)
    buffer_store_dwordx4 v[24:27], v5, s[36:39], s3 offen offset:256
    s_nop 1
K1_skipb1:
    s_mov_b64 exec, s[44:45]
    s_add_u32 s3, s3, 1966080
    s_waitcnt lgkmcnt(8)
    v_min_u32 v20, 127, v10
    v_and_b32 v21, 0x1ffffff, v60
    v_lshl_or_b32 v21, v20, 25, v21
    v_cndmask_b32 v60, v60, v21, s[40:41]
    v_cmp_lt_u32 vcc, v6, v10
    s_or_b64 vcc, vcc, s[40:41]
    s_and_saveexec_b64 s[44:45], vcc
    s_cbranch_execz K1_skip2
    buffer_store_dwordx4 v[60:63], v5, s[36:39], s3 offen
K1_skip2:
    s_mov_b64 exec, s[44:45]
    v_cmp_lt_u32 vcc, v7, v10
    v_cmp_gt_u32 s[42:43], 8, v2
    s_and_b64 vcc, vcc, s[42:43]
    s_and_saveexec_b64 s[44:45], vcc
    s_cbranch_execz K1_skipb2
    v_add_u32 v20, 30976, v3
    ds_read_b128 v[24:27], v20
    s_waitcnt lgkmcnt(0)
    buffer_store_dwordx4 v[24:27], v5, s[36:39], s3 offen offset:256
    s_nop 1
K1_skipb2:
    s_mov_b64 exec, s[44:45]
    s_add_u32 s3, s3, 1966080
    s_waitcnt lgkmcnt(6)
    v_min_u32 v20, 127, v11
    v_and_b32 v21, 0x1ffffff, v64
    v_lshl_or_b32 v21, v20, 25, v21
    v_cndmask_b32 v64, v64, v21, s[40:41]
    v_cmp_lt_u32 vcc, v6, v11
    s_or_b64 vcc, vcc, s[40:41]
    s_and_saveexec_b64 s[44:45], vcc
    s_cbranch_execz K1_skip3
    buffer_store_dwordx4 v[64:67], v5, s[36:39], s3 offen
K1_skip3:
    s_mov_b64 exec, s[44:45]
    v_cmp_lt_u32 vcc, v7, v11
    v_cmp_gt_u32 s[42:43], 8, v2
    s_and_b64 vcc, vcc, s[42:43]
    s_and_saveexec_b64 s[44:45], vcc
    s_cbranch_execz K1_skipb3
    v_add_u32 v20, 46336, v3
    ds_read_b128 v[24:27], v20
    s_waitcnt lgkmcnt(0)
    buffer_store_dwordx4 v[24:27], v5, s[36:39], s3 offen offset:256
    s_nop 1
K1_skipb3:
    s_mov_b64 exec, s[44:45]
    s_add_u32 s3, s3, 1966080
    s_waitcnt lgkmcnt(4)
    v_min_u32 v20, 127, v12
    v_and_b32 v21, 0x1ffffff, v68
    v_lshl_or_b32 v21, v20, 25, v21
    v_cndmask_b32 v68, v68, v21, s[40:41]
    v_cmp_lt_u32 vcc, v6, v12
    s_or_b64 vcc, vcc, s[40:41]
    s_and_saveexec_b64 s[44:45], vcc
    s_cbranch_execz K1_skip4
    buffer_store_dwordx4 v[68:71], v5, s[36:39], s3 offen
K1_skip4:
    s_mov_b64 exec, s[44:45]
    v_cmp_lt_u32 vcc, v7, v12
    v_cmp_gt_u32 s[42:43], 8, v2
    s_and_b64 vcc, vcc, s[42:43]
    s_and_saveexec_b64 s[44:45], vcc
    s_cbranch_execz K1_skipb4
    v_add_u32 v20, 61696, v3
    ds_read_b128 v[24:27], v20
    s_waitcnt lgkmcnt(0)
    buffer_store_dwordx4 v[24:27], v5, s[36:39], s3 offen offset:256
    s_nop 1
K1_skipb4:
    s_mov_b64 exec, s[44:45]
    s_add_u32 s3, s3, 1966080
    s_waitcnt lgkmcnt(2)
    v_min_u32 v20, 127, v13
    v_and_b32 v21, 0x1ffffff, v72
    v_lshl_or_b32 v21, v20, 25, v21
    v_cndmask_b32 v72, v72, v21, s[40:41]
    v_cmp_lt_u32 vcc, v6, v13
    s_or_b64 vcc, vcc, s[40:41]
    s_and_saveexec_b64 s[44:45], vcc
    s_cbranch_execz K1_skip5
    buffer_store_dwordx4 v[72:75], v5, s[36:39], s3 offen
K1_skip5:
    s_mov_b64 exec, s[44:45]
    v_cmp_lt_u32 vcc, v7, v13
    v_cmp_gt_u32 s[42:43], 8, v2
    s_and_b64 vcc, vcc, s[42:43]
    s_and_saveexec_b64 s[44:45], vcc
    s_cbranch_execz K1_skipb5
    v_add_u32 v20, 77056, v3
    ds_read_b128 v[24:27], v20
    s_waitcnt lgkmcnt(0)
    buffer_store_dwordx4 v[24:27], v5, s[36:39], s3 offen offset:256
    s_nop 1
K1_skipb5:
    s_mov_b64 exec, s[44:45]
    s_add_u32 s3, s3, 1966080
    s_waitcnt lgkmcnt(0)
    v_min_u32 v20, 127, v14
    v_and_b32 v21, 0x1ffffff, v76
    v_lshl_or_b32 v21, v20, 25, v21
    v_cndmask_b32 v76, v76, v21, s[40:41]
    v_cmp_lt_u32 vcc, v6, v14
    s_or_b64 vcc, vcc, s[40:41]
    v_cmp_gt_u32 s[42:43], 10, v1
    s_and_b64 vcc, vcc, s[42:43]
    s_and_saveexec_b64 s[44:45], vcc
    s_cbranch_execz K1_skip6
    buffer_store_dwordx4 v[76:79], v5, s[36:39], s3 offen
K1_skip6:
    s_mov_b64 exec, s[44:45]
    v_cmp_lt_u32 vcc, v7, v14
    v_cmp_gt_u32 s[42:43], 8, v2
    s_and_b64 vcc, vcc, s[42:43]
    v_cmp_gt_u32 s[42:43], 10, v1
    s_and_b64 vcc, vcc, s[42:43]
    s_and_saveexec_b64 s[44:45], vcc
    s_cbranch_execz K1_skipb6
    v_add_u32 v20, 92416, v3
    ds_read_b128 v[24:27], v20
    s_waitcnt lgkmcnt(0)
    buffer_store_dwordx4 v[24:27], v5, s[36:39], s3 offen offset:256
    s_nop 1
K1_skipb6:
    s_mov_b64 exec, s[44:45]
    s_add_u32 s3, s3, 1966080
    s_endpgm
K1_wprep:
    v_lshrrev_b32 v1, 6, v0
    v_and_b32 v2, 63, v0
    v_readfirstlane_b32 s3, v1
    s_sub_u32 s20, s2, 125
    s_mul_i32 s20, s20, 10
    s_add_u32 s20, s20, s3
    s_waitcnt lgkmcnt(0)
    s_mov_b32 s36, s18
    s_and_b32 s37, s19, 0xffff
    s_mov_b32 s38, 12492800
    s_mov_b32 s39, 0x20000
    s_mov_b32 s24, s14
    s_and_b32 s25, s15, 0xffff
    s_mov_b32 s26, 65536
    s_mov_b32 s27, 0x20000
    s_mov_b32 s28, s12
    s_and_b32 s29, s13, 0xffff
    s_mov_b32 s30, 20480
    s_mov_b32 s31, 0x20000
    v_lshlrev_b32 v3, 4, v2
    s_cmp_ge_u32 s20, 200
    s_cbranch_scc1 K1_warm
    s_cmp_ge_u32 s20, 160
    s_cbranch_scc1 K1_wrad
    s_mul_i32 s21, s20, 3277
    s_lshr_b32 s21, s21, 16
    s_mul_i32 s22, s21, 20
    s_sub_u32 s22, s20, s22
    s_cmp_lt_u32 s22, 8
    s_cbranch_scc1 K1_w0
    s_mov_b32 s24, s16
    s_and_b32 s25, s17, 0xffff
    s_mov_b32 s26, 98304
    s_mov_b32 s27, 0x20000
    s_sub_u32 s22, s22, 8
K1_w0:
    s_lshr_b32 s23, s22, 1
    s_lshl_b32 s23, s23, 6
    s_and_b32 s40, s22, 1
    s_lshl_b32 s40, s40, 4
    s_add_u32 s23, s23, s40
    s_lshl_b32 s23, s23, 8
    s_lshl_b32 s40, s21, 5
    s_add_u32 s23, s23, s40
    s_add_u32 s41, s23, 8192
    v_lshrrev_b32 v4, 4, v2
    v_lshlrev_b32 v4, 10, v4
    v_and_b32 v5, 15, v2
    v_lshl_add_u32 v4, v5, 1, v4
    buffer_load_ushort v8, v4, s[24:27], s23 offen offset:0
    buffer_load_ushort v12, v4, s[24:27], s41 offen offset:0
    buffer_load_ushort v9, v4, s[24:27], s23 offen offset:256
    buffer_load_ushort v13, v4, s[24:27], s41 offen offset:256
    buffer_load_ushort v10, v4, s[24:27], s23 offen offset:512
    buffer_load_ushort v14, v4, s[24:27], s41 offen offset:512
    buffer_load_ushort v11, v4, s[24:27], s23 offen offset:768
    buffer_load_ushort v15, v4, s[24:27], s41 offen offset:768
    s_lshl_b32 s40, s20, 10
    s_add_u32 s40, s40, 12288000
    s_waitcnt vmcnt(0)
    v_lshl_or_b32 v8, v12, 16, v8
    v_lshl_or_b32 v9, v13, 16, v9
    v_lshl_or_b32 v10, v14, 16, v10
    v_lshl_or_b32 v11, v15, 16, v11
    buffer_store_dwordx4 v[8:11], v3, s[36:39], s40 offen
    s_endpgm
K1_wrad:
    s_sub_u32 s20, s20, 160
    s_cmp_ge_u32 s20, 20
    s_cselect_b32 s21, 1, 0
    s_mul_i32 s22, s21, 20
    s_sub_u32 s22, s20, s22
    s_lshr_b32 s23, s22, 2
    s_lshl_b32 s23, s23, 8
    s_lshl_b32 s40, s21, 7
    s_add_u32 s23, s23, s40
    s_bfe_u32 s40, s22, 0x10001
    s_lshl_b32 s40, s40, 6
    s_add_u32 s23, s23, s40
    s_and_b32 s40, s22, 1
    s_mul_i32 s40, s40, 8*1280
    s_add_u32 s23, s23, s40
    v_lshrrev_b32 v4, 5, v2
    v_mul_u32_u24 v4, 5120, v4
    v_and_b32 v5, 31, v2
    v_lshl_add_u32 v4, v5, 1, v4
    buffer_load_ushort v8, v4, s[28:31], s23 offen offset:0
    buffer_load_ushort v9, v4, s[28:31], s23 offen offset:1280
    buffer_load_ushort v10, v4, s[28:31], s23 offen offset:2560
    buffer_load_ushort v11, v4, s[28:31], s23 offen offset:3840
    s_lshl_b32 s40, s20, 10
    s_add_u32 s40, s40, 12451840
    s_waitcnt vmcnt(0)
    v_lshlrev_b32 v8, 16, v8
    v_lshlrev_b32 v9, 16, v9
    v_lshlrev_b32 v10, 16, v10
    v_lshlrev_b32 v11, 16, v11
    buffer_store_dwordx4 v[8:11], v3, s[36:39], s40 offen
    s_endpgm
K1_warm:
    s_cmp_lt_u32 s2, 152
    s_cbranch_scc1 K1_end
    s_load_dwordx2 s[4:5], s[0:1], 0
    s_sub_u32 s20, s2, 152
    s_lshr_b32 s20, s20, 3
    s_cmp_lg_u32 s20, 0
    s_cbranch_scc1 K1_warm_x
    s_getpc_b64 s[6:7]
K1_pc:
    s_add_u32 s6, s6, standalone__tensor_product_equiv_equiformer__graph_kernel-K1_pc
    s_addc_u32 s7, s7, 0
    v_lshlrev_b32 v4, 7, v0
    v_min_u32 v4, K2_last-standalone__tensor_product_equiv_equiformer__graph_kernel, v4
    v_mov_b32 v5, s7
    v_add_co_u32 v4, vcc, s6, v4
    s_nop 1
    v_addc_co_u32 v5, vcc, 0, v5, vcc
    global_load_dword v6, v[4:5], off
K1_warm_x:
    s_mul_i32 s20, s20, 10
    s_add_u32 s20, s20, s3
    s_mul_i32 s20, s20, 49152
    v_lshlrev_b32 v4, 8, v2
    s_waitcnt lgkmcnt(0)
    s_mov_b32 s24, s4
    s_and_b32 s25, s5, 0xffff
    s_mov_b32 s26, 10240000
    s_mov_b32 s27, 0x20000
    buffer_load_dword v8, v4, s[24:27], s20 offen
    s_add_u32 s20, s20, 16384
    buffer_load_dword v9, v4, s[24:27], s20 offen
    s_add_u32 s20, s20, 16384
    buffer_load_dword v10, v4, s[24:27], s20 offen
    s_add_u32 s20, s20, 16384
K1_end:
    s_endpgm
.globl standalone__tensor_product_equiv_equiformer__graph_kernel
.p2align 8
.type standalone__tensor_product_equiv_equiformer__graph_kernel,@function
standalone__tensor_product_equiv_equiformer__graph_kernel:
    s_cmp_ge_u32 s2, 250
    s_cbranch_scc1 K2_end
    s_load_dwordx2 s[68:69], s[0:1], 0
    s_load_dwordx2 s[70:71], s[0:1], 16
    s_load_dwordx2 s[72:73], s[0:1], 72
    s_load_dwordx2 s[74:75], s[0:1], 88
    s_mov_b32 s84, s2
    v_lshrrev_b32 v2, 6, v0
    v_and_b32 v250, 63, v0
    v_readfirstlane_b32 s24, v2
    v_lshrrev_b32 v2, 5, v250
    v_mul_u32_u24 v2, 384, v2
    v_and_b32 v3, 31, v250
    v_lshl_add_u32 v48, v3, 2, v2
    v_lshl_add_u32 v49, v3, 3, v2
    v_lshlrev_b32 v50, 4, v250
    s_mul_i32 s58, s2, 49152
    s_mul_i32 s59, s24, 6144
    s_add_u32 s58, s58, s59
    s_add_u32 s59, s58, 3072
    s_lshl_b32 s25, s24, 13
    s_waitcnt lgkmcnt(0)
    s_mov_b32 s16, s74
    s_and_b32 s17, s75, 0xffff
    s_mov_b32 s18, 12492800
    s_mov_b32 s19, 0x20000
    buffer_load_dword v8, v48, s[16:19], s58 offen offset:0
    buffer_load_dwordx2 v[16:17], v49, s[16:19], s58 offen offset:128
    buffer_load_dword v9, v48, s[16:19], s58 offen offset:768
    buffer_load_dwordx2 v[18:19], v49, s[16:19], s58 offen offset:896
    buffer_load_dword v10, v48, s[16:19], s58 offen offset:1536
    buffer_load_dwordx2 v[20:21], v49, s[16:19], s58 offen offset:1664
    buffer_load_dword v11, v48, s[16:19], s58 offen offset:2304
    buffer_load_dwordx2 v[22:23], v49, s[16:19], s58 offen offset:2432
    buffer_load_dword v12, v48, s[16:19], s59 offen offset:0
    buffer_load_dwordx2 v[24:25], v49, s[16:19], s59 offen offset:128
    buffer_load_dword v13, v48, s[16:19], s59 offen offset:768
    buffer_load_dwordx2 v[26:27], v49, s[16:19], s59 offen offset:896
    buffer_load_dword v14, v48, s[16:19], s59 offen offset:1536
    buffer_load_dwordx2 v[28:29], v49, s[16:19], s59 offen offset:1664
    buffer_load_dword v15, v48, s[16:19], s59 offen offset:2304
    buffer_load_dwordx2 v[30:31], v49, s[16:19], s59 offen offset:2432
    s_mov_b32 s4, s68
    s_and_b32 s5, s69, 0xffff
    s_mov_b32 s6, 10240000
    s_mov_b32 s7, 0x20000
    s_sub_u32 s68, s68, 1024
    s_subb_u32 s69, s69, 0
    s_mov_b32 s8, s68
    s_and_b32 s9, s69, 0xffff
    s_mov_b32 s10, 10241024
    s_mov_b32 s11, 0x20000
    s_mov_b32 s12, s70
    s_and_b32 s13, s71, 0xffff
    s_mov_b32 s14, 10240000
    s_mov_b32 s15, 0x20000
    s_mov_b32 s20, s72
    s_and_b32 s21, s73, 0xffff
    s_mov_b32 s22, 10240000
    s_mov_b32 s23, 0x20000
    s_mul_i32 s60, s24, 5120
    s_add_u32 s61, s60, 12451840
    s_cmp_ge_u32 s24, 4
    s_cselect_b32 s62, 45056, 0
    s_add_u32 s60, s60, s62
    s_add_u32 m0, s60, 0
    s_add_u32 s62, s61, 0
    buffer_load_dwordx4 v50, s[16:19], s62 offen lds
    s_add_u32 m0, s60, 1024
    s_add_u32 s62, s61, 1024
    buffer_load_dwordx4 v50, s[16:19], s62 offen lds
    s_add_u32 m0, s60, 2048
    s_add_u32 s62, s61, 2048
    buffer_load_dwordx4 v50, s[16:19], s62 offen lds
    s_add_u32 m0, s60, 3072
    s_add_u32 s62, s61, 3072
    buffer_load_dwordx4 v50, s[16:19], s62 offen lds
    s_add_u32 m0, s60, 4096
    s_add_u32 s62, s61, 4096
    buffer_load_dwordx4 v50, s[16:19], s62 offen lds
    v_mov_b32 v4, 2130738944
    v_mov_b32 v5, 2130738944
    v_mov_b32 v6, 2130738944
    v_mov_b32 v7, 2130738944
    v_lshlrev_b32 v2, 4, v0
    v_add_u32 v2, 87040, v2
    ds_write_b128 v2, v[4:7] offset:0
    ds_write_b128 v2, v[4:7] offset:8192
    ds_write_b128 v2, v[4:7] offset:16384
    ds_write_b128 v2, v[4:7] offset:24576
    ds_write_b128 v2, v[4:7] offset:32768
    ds_write_b128 v2, v[4:7] offset:40960
    ds_write_b128 v2, v[4:7] offset:49152
    ds_write_b128 v2, v[4:7] offset:57344
    v_add_u32 v2, 0x10000, v2
    ds_write_b128 v2, v[4:7] offset:0
    v_lshlrev_b32 v2, 4, v0
    v_min_u32 v2, 3056, v2
    v_add_u32 v2, 160768, v2
    ds_write_b128 v2, v[4:7]
    v_lshlrev_b32 v240, 2, v250
    v_mov_b32 v3, 0
    v_add_u32 v2, 86016, v240
    ds_write_b32 v2, v3
    ds_write_b32 v2, v3 offset:256
    v_lshrrev_b32 v2, 5, v250
    v_bfe_u32 v3, v250, 2, 2
    v_and_b32 v4, 3, v250
    v_bfe_u32 v5, v250, 4, 1
    v_lshlrev_b32 v6, 9, v2
    v_lshl_add_u32 v6, v3, 7, v6
    v_lshl_add_u32 v6, v5, 5, v6
    v_lshl_add_u32 v6, v4, 3, v6
    v_lshrrev_b32 v7, 1, v3
    v_lshl_add_u32 v6, v7, 6, v6
    v_add_u32 v234, s25, v6
    v_xor_b32 v235, 64, v234
    v_lshlrev_b32 v6, 7, v2
    v_lshl_add_u32 v6, v3, 5, v6
    v_lshl_add_u32 v237, v4, 3, v6
    v_lshl_add_u32 v6, v2, 2, v4
    v_bfe_u32 v7, v250, 2, 1
    v_lshl_add_u32 v6, v7, 3, v6
    v_lshlrev_b32 v6, 3, v6
    v_bfe_u32 v7, v250, 3, 1
    v_add_u32 v5, 1, v5
    v_mul_u32_u24 v7, v7, v5
    v_lshl_add_u32 v238, v7, 1, v6
    v_and_b32 v6, 0x38, v250
    v_add_u32 v239, 6, v6
    v_lshrrev_b32 v6, 2, v250
    v_lshrrev_b32 v7, 4, v250
    v_xor_b32 v6, v6, v7
    v_and_b32 v6, 1, v6
    v_lshlrev_b32 v6, 6, v6
    v_lshl_add_u32 v236, v4, 4, v6
    v_lshrrev_b32 v6, 1, v250
    v_lshlrev_b32 v248, 5, v6
    v_and_b32 v6, 1, v250
    v_lshlrev_b32 v249, 4, v6
    v_mov_b32 v230, 1.0
    v_mov_b32 v231, 1.0
    v_mov_b32 v232, 1.0
    v_mov_b32 v233, 1.0
    s_mov_b32 s50, 0xffffff00
    s_mov_b32 s51, 0xffffff00
    s_mov_b32 s66, 1103642624
    s_mov_b32 s67, 52511253
    v_mov_b32 v3, 1
    s_mov_b32 s63, 0
    s_waitcnt lgkmcnt(0)
    s_barrier
    s_waitcnt vmcnt(20)
    v_readlane_b32 s58, v8, 0
    v_readlane_b32 s59, v8, 32
    v_bfe_u32 v40, v8, 19, 6
    v_lshlrev_b32 v40, 2, v40
    s_lshr_b32 s58, s58, 25
    s_lshr_b32 s59, s59, 25
    s_max_u32 s63, s63, s58
    s_max_u32 s63, s63, s59
    s_min_u32 s58, s58, 32
    s_min_u32 s59, s59, 32
    s_bfm_b64 s[60:61], s58, 0
    s_mov_b32 s68, s60
    s_bfm_b64 s[60:61], s59, 0
    s_mov_b32 s69, s60
    v_add_u32 v2, 86016, v40
    s_mov_b64 exec, s[68:69]
    ds_add_rtn_u32 v32, v2, v3
    s_mov_b64 exec, -1
    s_waitcnt vmcnt(18)
    v_readlane_b32 s58, v9, 0
    v_readlane_b32 s59, v9, 32
    v_bfe_u32 v41, v9, 19, 6
    v_lshlrev_b32 v41, 2, v41
    s_lshr_b32 s58, s58, 25
    s_lshr_b32 s59, s59, 25
    s_max_u32 s63, s63, s58
    s_max_u32 s63, s63, s59
    s_min_u32 s58, s58, 32
    s_min_u32 s59, s59, 32
    s_bfm_b64 s[60:61], s58, 0
    s_mov_b32 s70, s60
    s_bfm_b64 s[60:61], s59, 0
    s_mov_b32 s71, s60
    v_add_u32 v2, 86016, v41
    s_mov_b64 exec, s[70:71]
    ds_add_rtn_u32 v33, v2, v3
    s_mov_b64 exec, -1
    s_waitcnt vmcnt(16)
    v_readlane_b32 s58, v10, 0
    v_readlane_b32 s59, v10, 32
    v_bfe_u32 v42, v10, 19, 6
    v_lshlrev_b32 v42, 2, v42
    s_lshr_b32 s58, s58, 25
    s_lshr_b32 s59, s59, 25
    s_max_u32 s63, s63, s58
    s_max_u32 s63, s63, s59
    s_min_u32 s58, s58, 32
    s_min_u32 s59, s59, 32
    s_bfm_b64 s[60:61], s58, 0
    s_mov_b32 s72, s60
    s_bfm_b64 s[60:61], s59, 0
    s_mov_b32 s73, s60
    v_add_u32 v2, 86016, v42
    s_mov_b64 exec, s[72:73]
    ds_add_rtn_u32 v34, v2, v3
    s_mov_b64 exec, -1
    s_waitcnt vmcnt(14)
    v_readlane_b32 s58, v11, 0
    v_readlane_b32 s59, v11, 32
    v_bfe_u32 v43, v11, 19, 6
    v_lshlrev_b32 v43, 2, v43
    s_lshr_b32 s58, s58, 25
    s_lshr_b32 s59, s59, 25
    s_max_u32 s63, s63, s58
    s_max_u32 s63, s63, s59
    s_min_u32 s58, s58, 32
    s_min_u32 s59, s59, 32
    s_bfm_b64 s[60:61], s58, 0
    s_mov_b32 s74, s60
    s_bfm_b64 s[60:61], s59, 0
    s_mov_b32 s75, s60
    v_add_u32 v2, 86016, v43
    s_mov_b64 exec, s[74:75]
    ds_add_rtn_u32 v35, v2, v3
    s_mov_b64 exec, -1
    s_waitcnt vmcnt(12)
    v_readlane_b32 s58, v12, 0
    v_readlane_b32 s59, v12, 32
    v_bfe_u32 v44, v12, 19, 6
    v_lshlrev_b32 v44, 2, v44
    s_lshr_b32 s58, s58, 25
    s_lshr_b32 s59, s59, 25
    s_max_u32 s63, s63, s58
    s_max_u32 s63, s63, s59
    s_min_u32 s58, s58, 32
    s_min_u32 s59, s59, 32
    s_bfm_b64 s[60:61], s58, 0
    s_mov_b32 s76, s60
    s_bfm_b64 s[60:61], s59, 0
    s_mov_b32 s77, s60
    v_add_u32 v2, 86016, v44
    s_mov_b64 exec, s[76:77]
    ds_add_rtn_u32 v36, v2, v3
    s_mov_b64 exec, -1
    s_waitcnt vmcnt(10)
    v_readlane_b32 s58, v13, 0
    v_readlane_b32 s59, v13, 32
    v_bfe_u32 v45, v13, 19, 6
    v_lshlrev_b32 v45, 2, v45
    s_lshr_b32 s58, s58, 25
    s_lshr_b32 s59, s59, 25
    s_max_u32 s63, s63, s58
    s_max_u32 s63, s63, s59
    s_min_u32 s58, s58, 32
    s_min_u32 s59, s59, 32
    s_bfm_b64 s[60:61], s58, 0
    s_mov_b32 s78, s60
    s_bfm_b64 s[60:61], s59, 0
    s_mov_b32 s79, s60
    v_add_u32 v2, 86016, v45
    s_mov_b64 exec, s[78:79]
    ds_add_rtn_u32 v37, v2, v3
    s_mov_b64 exec, -1
    s_waitcnt vmcnt(8)
    v_readlane_b32 s58, v14, 0
    v_readlane_b32 s59, v14, 32
    v_bfe_u32 v46, v14, 19, 6
    v_lshlrev_b32 v46, 2, v46
    s_lshr_b32 s58, s58, 25
    s_lshr_b32 s59, s59, 25
    s_cmp_eq_u32 s24, 7
    s_cselect_b32 s59, 0, s59
    s_max_u32 s63, s63, s58
    s_max_u32 s63, s63, s59
    s_min_u32 s58, s58, 32
    s_min_u32 s59, s59, 32
    s_bfm_b64 s[60:61], s58, 0
    s_mov_b32 s80, s60
    s_bfm_b64 s[60:61], s59, 0
    s_mov_b32 s81, s60
    v_add_u32 v2, 86016, v46
    s_mov_b64 exec, s[80:81]
    ds_add_rtn_u32 v38, v2, v3
    s_mov_b64 exec, -1
    s_waitcnt vmcnt(6)
    v_readlane_b32 s58, v15, 0
    v_readlane_b32 s59, v15, 32
    v_bfe_u32 v47, v15, 19, 6
    v_lshlrev_b32 v47, 2, v47
    s_lshr_b32 s58, s58, 25
    s_lshr_b32 s59, s59, 25
    s_cmp_eq_u32 s24, 7
    s_cselect_b32 s58, 0, s58
    s_cselect_b32 s59, 0, s59
    s_max_u32 s63, s63, s58
    s_max_u32 s63, s63, s59
    s_min_u32 s58, s58, 32
    s_min_u32 s59, s59, 32
    s_bfm_b64 s[60:61], s58, 0
    s_mov_b32 s82, s60
    s_bfm_b64 s[60:61], s59, 0
    s_mov_b32 s83, s60
    v_add_u32 v2, 86016, v47
    s_mov_b64 exec, s[82:83]
    ds_add_rtn_u32 v39, v2, v3
    s_mov_b64 exec, -1
    s_cmp_gt_u32 s63, 32
    s_cselect_b32 s58, 1000, 0
    v_mov_b32 v2, 86268
    v_mov_b32 v4, s58
    ds_max_u32 v2, v4
    s_waitcnt vmcnt(0) lgkmcnt(0)
    s_barrier
    v_add_u32 v2, 86016, v240
    ds_read_b32 v4, v2
    v_lshlrev_b32 v2, 4, v250
    ds_read_b128 v[96:99], v2 offset:0
    ds_read_b128 v[100:103], v2 offset:1024
    ds_read_b128 v[104:107], v2 offset:2048
    ds_read_b128 v[108:111], v2 offset:3072
    ds_read_b128 v[112:115], v2 offset:4096
    ds_read_b128 v[116:119], v2 offset:5120
    ds_read_b128 v[120:123], v2 offset:6144
    ds_read_b128 v[124:127], v2 offset:7168
    ds_read_b128 v[128:131], v2 offset:8192
    ds_read_b128 v[132:135], v2 offset:9216
    ds_read_b128 v[136:139], v2 offset:10240
    ds_read_b128 v[140:143], v2 offset:11264
    ds_read_b128 v[144:147], v2 offset:12288
    ds_read_b128 v[148:151], v2 offset:13312
    ds_read_b128 v[152:155], v2 offset:14336
    ds_read_b128 v[156:159], v2 offset:15360
    ds_read_b128 v[160:163], v2 offset:16384
    ds_read_b128 v[164:167], v2 offset:17408
    ds_read_b128 v[168:171], v2 offset:18432
    ds_read_b128 v[172:175], v2 offset:19456
    s_waitcnt lgkmcnt(15)
    v_cmp_lt_u32 vcc, 64, v4
    v_add_u32 v5, 15, v4
    v_lshrrev_b32 v5, 4, v5
    v_max_u32 v5, 1, v5
    v_min_u32 v5, 4, v5
    s_cmp_lg_u64 vcc, 0
    s_cbranch_scc1 SLOW
    v_mul_u32_u24 v6, 640, v5
    v_max_u32 v6, 1536, v6
    v_cmp_gt_u32 vcc, 40, v250
    s_nop 1
    v_cndmask_b32 v6, 0, v6, vcc
    v_cndmask_b32 v5, 0, v5, vcc
    v_mov_b32 v7, v6
    s_nop 1
    v_add_u32_dpp v7, v7, v7 row_shr:1 row_mask:0xf bank_mask:0xf
    s_nop 1
    v_add_u32_dpp v7, v7, v7 row_shr:2 row_mask:0xf bank_mask:0xf
    s_nop 1
    v_add_u32_dpp v7, v7, v7 row_shr:4 row_mask:0xf bank_mask:0xf
    s_nop 1
    v_add_u32_dpp v7, v7, v7 row_shr:8 row_mask:0xf bank_mask:0xf
    s_nop 1
    v_add_u32_dpp v7, v7, v7 row_bcast:15 row_mask:0xa bank_mask:0xf
    s_nop 1
    v_add_u32_dpp v7, v7, v7 row_bcast:31 row_mask:0xc bank_mask:0xf
    s_nop 0
    v_readlane_b32 s58, v7, 63
    v_sub_u32 v7, v7, v6
    v_add_u32 v7, 87040, v7
    s_cmp_gt_u32 s58, 76800
    s_cbranch_scc1 SLOW
    v_lshl_or_b32 v6, v5, 18, v7
    v_lshl_or_b32 v6, v250, 21, v6
    v_add_u32 v2, 7, v4
    v_lshrrev_b32 v2, 3, v2
    v_max_u32 v2, 2, v2
    v_cmp_eq_u32 vcc, 7, v2
    s_nop 1
    v_addc_co_u32 v2, vcc, 0, v2, vcc
    v_lshl_or_b32 v6, v2, 28, v6
    ds_bpermute_b32 v40, v40, v6
    ds_bpermute_b32 v41, v41, v6
    ds_bpermute_b32 v42, v42, v6
    ds_bpermute_b32 v43, v43, v6
    ds_bpermute_b32 v44, v44, v6
    ds_bpermute_b32 v45, v45, v6
    ds_bpermute_b32 v46, v46, v6
    ds_bpermute_b32 v47, v47, v6
    s_mov_b32 s62, 0
    v_mov_b32 v48, 63
    v_cmp_eq_u32 vcc, 4, v5
    s_nop 1
    v_mbcnt_lo_u32_b32 v2, vcc_lo, 0
    v_mbcnt_hi_u32_b32 v2, vcc_hi, v2
    v_add_u32 v2, s62, v2
    v_cndmask_b32 v48, v48, v2, vcc
    s_bcnt1_i32_b64 s63, vcc
    s_add_u32 s62, s62, s63
    v_cmp_eq_u32 vcc, 3, v5
    s_nop 1
    v_mbcnt_lo_u32_b32 v2, vcc_lo, 0
    v_mbcnt_hi_u32_b32 v2, vcc_hi, v2
    v_add_u32 v2, s62, v2
    v_cndmask_b32 v48, v48, v2, vcc
    s_bcnt1_i32_b64 s63, vcc
    s_add_u32 s62, s62, s63
    v_cmp_eq_u32 vcc, 2, v5
    s_nop 1
    v_mbcnt_lo_u32_b32 v2, vcc_lo, 0
    v_mbcnt_hi_u32_b32 v2, vcc_hi, v2
    v_add_u32 v2, s62, v2
    v_cndmask_b32 v48, v48, v2, vcc
    s_bcnt1_i32_b64 s63, vcc
    s_add_u32 s62, s62, s63
    v_cmp_eq_u32 vcc, 1, v5
    s_nop 1
    v_mbcnt_lo_u32_b32 v2, vcc_lo, 0
    v_mbcnt_hi_u32_b32 v2, vcc_hi, v2
    v_add_u32 v2, s62, v2
    v_cndmask_b32 v48, v48, v2, vcc
    s_bcnt1_i32_b64 s63, vcc
    s_add_u32 s62, s62, s63
    v_lshrrev_b32 v2, 3, v48
    v_and_b32 v3, 1, v2
    v_mul_u32_u24 v3, 7, v3
    v_xor_b32 v48, v48, v3
    s_add_u32 s58, s24, 0
    v_cmp_eq_u32 vcc, s58, v48
    s_ff1_i32_b64 s59, vcc
    v_readlane_b32 s26, v6, s59
    s_add_u32 s58, s24, 8
    v_cmp_eq_u32 vcc, s58, v48
    s_ff1_i32_b64 s59, vcc
    v_readlane_b32 s27, v6, s59
    s_add_u32 s58, s24, 16
    v_cmp_eq_u32 vcc, s58, v48
    s_ff1_i32_b64 s59, vcc
    v_readlane_b32 s28, v6, s59
    s_add_u32 s58, s24, 24
    v_cmp_eq_u32 vcc, s58, v48
    s_ff1_i32_b64 s59, vcc
    v_readlane_b32 s29, v6, s59
    s_add_u32 s58, s24, 32
    v_cmp_eq_u32 vcc, s58, v48
    s_ff1_i32_b64 s59, vcc
    v_readlane_b32 s30, v6, s59
    v_and_b32 v3, 7, v48
    v_lshlrev_b32 v3, 13, v3
    v_mul_u32_u24 v2, 1536, v2
    v_add_u32 v2, v2, v3
    v_mov_b32 v3, v7
    v_lshlrev_b32 v4, 3, v250
    v_add_u32 v4, 86528, v4
    s_mov_b32 exec_hi, 0xff
    ds_write_b64 v4, v[2:3]
    s_mov_b32 exec_hi, -1
    s_waitcnt lgkmcnt(0)
    v_and_b32 v2, 0x3ffff, v40
    v_bfe_u32 v3, v40, 18, 3
    v_lshl_add_u32 v3, v3, 9, v2
    v_lshl_add_u32 v2, v32, 5, v2
    v_lshl_add_u32 v3, v32, 3, v3
    v_and_b32 v8, 0x7ffff, v8
    s_mov_b64 exec, s[68:69]
    ds_write_b32 v2, v8
    ds_write_b64 v3, v[16:17]
    s_mov_b64 exec, -1
    v_and_b32 v2, 0x3ffff, v41
    v_bfe_u32 v3, v41, 18, 3
    v_lshl_add_u32 v3, v3, 9, v2
    v_lshl_add_u32 v2, v33, 5, v2
    v_lshl_add_u32 v3, v33, 3, v3
    v_and_b32 v9, 0x7ffff, v9
    s_mov_b64 exec, s[70:71]
    ds_write_b32 v2, v9
    ds_write_b64 v3, v[18:19]
    s_mov_b64 exec, -1
    v_and_b32 v2, 0x3ffff, v42
    v_bfe_u32 v3, v42, 18, 3
    v_lshl_add_u32 v3, v3, 9, v2
    v_lshl_add_u32 v2, v34, 5, v2
    v_lshl_add_u32 v3, v34, 3, v3
    v_and_b32 v10, 0x7ffff, v10
    s_mov_b64 exec, s[72:73]
    ds_write_b32 v2, v10
    ds_write_b64 v3, v[20:21]
    s_mov_b64 exec, -1
    v_and_b32 v2, 0x3ffff, v43
    v_bfe_u32 v3, v43, 18, 3
    v_lshl_add_u32 v3, v3, 9, v2
    v_lshl_add_u32 v2, v35, 5, v2
    v_lshl_add_u32 v3, v35, 3, v3
    v_and_b32 v11, 0x7ffff, v11
    s_mov_b64 exec, s[74:75]
    ds_write_b32 v2, v11
    ds_write_b64 v3, v[22:23]
    s_mov_b64 exec, -1
    v_and_b32 v2, 0x3ffff, v44
    v_bfe_u32 v3, v44, 18, 3
    v_lshl_add_u32 v3, v3, 9, v2
    v_lshl_add_u32 v2, v36, 5, v2
    v_lshl_add_u32 v3, v36, 3, v3
    v_and_b32 v12, 0x7ffff, v12
    s_mov_b64 exec, s[76:77]
    ds_write_b32 v2, v12
    ds_write_b64 v3, v[24:25]
    s_mov_b64 exec, -1
    v_and_b32 v2, 0x3ffff, v45
    v_bfe_u32 v3, v45, 18, 3
    v_lshl_add_u32 v3, v3, 9, v2
    v_lshl_add_u32 v2, v37, 5, v2
    v_lshl_add_u32 v3, v37, 3, v3
    v_and_b32 v13, 0x7ffff, v13
    s_mov_b64 exec, s[78:79]
    ds_write_b32 v2, v13
    ds_write_b64 v3, v[26:27]
    s_mov_b64 exec, -1
    v_and_b32 v2, 0x3ffff, v46
    v_bfe_u32 v3, v46, 18, 3
    v_lshl_add_u32 v3, v3, 9, v2
    v_lshl_add_u32 v2, v38, 5, v2
    v_lshl_add_u32 v3, v38, 3, v3
    v_and_b32 v14, 0x7ffff, v14
    s_mov_b64 exec, s[80:81]
    ds_write_b32 v2, v14
    ds_write_b64 v3, v[28:29]
    s_mov_b64 exec, -1
    v_and_b32 v2, 0x3ffff, v47
    v_bfe_u32 v3, v47, 18, 3
    v_lshl_add_u32 v3, v3, 9, v2
    v_lshl_add_u32 v2, v39, 5, v2
    v_lshl_add_u32 v3, v39, 3, v3
    v_and_b32 v15, 0x7ffff, v15
    s_mov_b64 exec, s[82:83]
    ds_write_b32 v2, v15
    ds_write_b64 v3, v[30:31]
    s_mov_b64 exec, -1
    s_mov_b32 s64, 0
    s_mov_b32 s65, s27
    s_mov_b32 s27, s26
    s_and_b32 s45, s27, 0x3ffff
    s_bfe_u32 s44, s27, 0x30012
    s_lshr_b32 s86, s27, 28
    s_lshl_b32 s58, s44, 9
    s_add_u32 s39, s45, s58
    s_mul_i32 s58, s44, 12
    s_lshr_b64 s[60:61], s[66:67], s58
    s_mov_b32 s35, s64
    s_bfe_u32 s58, s60, 131072
    s_lshl_b32 s58, s58, 7
    s_add_u32 s40, s39, s58
    s_bfe_u32 s58, s60, 131074
    s_lshl_b32 s58, s58, 8
    s_add_u32 s36, s58, s64
    s_bfe_u32 s58, s60, 131076
    s_lshl_b32 s58, s58, 7
    s_add_u32 s41, s39, s58
    s_bfe_u32 s58, s60, 131078
    s_lshl_b32 s58, s58, 8
    s_add_u32 s37, s58, s64
    s_bfe_u32 s58, s60, 131080
    s_lshl_b32 s58, s58, 7
    s_add_u32 s42, s39, s58
    s_bfe_u32 s58, s60, 131082
    s_lshl_b32 s58, s58, 8
    s_add_u32 s38, s58, s64
    s_mov_b32 s52, -1
    s_cmp_ge_u32 s44, 2
    s_cselect_b32 s53, -1, 0
    s_mov_b32 s56, s45
    s_add_u32 s57, s45, 1024
    s_cmp_ge_u32 s44, 3
    s_cselect_b32 s54, -1, 1
    s_cselect_b32 s57, s57, 86912
    s_cmp_ge_u32 s44, 4
    s_cselect_b32 s55, -1, 0
    s_mov_b32 s27, s65
    s_mov_b32 s31, 0
    s_mov_b32 s32, 256
    s_mov_b32 s33, 512
    s_mov_b32 s34, 768
    s_waitcnt lgkmcnt(0)
    s_barrier
    v_add_u32 v244, s39, v239
    ds_read_u16 v222, v244
    ds_read_u16 v223, v244 offset:64
    v_add_u32 v244, s40, v239
    ds_read_u16 v224, v244
    ds_read_u16 v225, v244 offset:64
    v_add_u32 v244, s41, v239
    ds_read_u16 v226, v244
    ds_read_u16 v227, v244 offset:64
    v_add_u32 v244, s42, v239
    ds_read_u16 v228, v244
    ds_read_u16 v229, v244 offset:64
    v_add_u32 v245, s45, v248
    ds_read_b32 v246, v245
    ds_read_b32 v247, v245 offset:1024
    s_waitcnt lgkmcnt(0)
    v_lshl_add_u32 v246, v246, 5, v249
    v_lshl_add_u32 v247, v247, 5, v249
    s_mov_b32 m0, s56
    s_mov_b64 exec, s[52:53]
    buffer_load_dwordx4 v246, s[12:15], 0 offen  lds
    s_mov_b32 m0, s57
    s_mov_b64 exec, s[54:55]
    buffer_load_dwordx4 v247, s[12:15], 0 offen  lds
    s_mov_b64 exec, -1
    s_add_u32 m0, s25, 0
    v_lshl_add_u32 v222, v222, 10, v236
    v_lshl_add_u32 v223, v223, 10, v236
    buffer_load_dwordx4 v222, s[4:7], s35 offen lds
    buffer_load_dwordx4 v223, s[8:11], s35 offen offset:1024 lds
    s_add_u32 m0, s25, 2048
    v_lshl_add_u32 v224, v224, 10, v236
    v_lshl_add_u32 v225, v225, 10, v236
    buffer_load_dwordx4 v224, s[4:7], s36 offen lds
    buffer_load_dwordx4 v225, s[8:11], s36 offen offset:1024 lds
    s_add_u32 m0, s25, 4096
    v_lshl_add_u32 v226, v226, 10, v236
    v_lshl_add_u32 v227, v227, 10, v236
    buffer_load_dwordx4 v226, s[4:7], s37 offen lds
    buffer_load_dwordx4 v227, s[8:11], s37 offen offset:1024 lds
    s_add_u32 m0, s25, 6144
    v_lshl_add_u32 v228, v228, 10, v236
    v_lshl_add_u32 v229, v229, 10, v236
    buffer_load_dwordx4 v228, s[4:7], s38 offen lds
    buffer_load_dwordx4 v229, s[8:11], s38 offen offset:1024 lds
    v_add_u32 v241, s45, v237
    v_add_u32 v242, s39, v238
    s_mov_b32 s85, s86
    s_mov_b32 s46, s45
    s_and_b32 s45, s27, 0x3ffff
    s_bfe_u32 s44, s27, 0x30012
    s_lshr_b32 s86, s27, 28
    s_lshl_b32 s58, s44, 9
    s_add_u32 s39, s45, s58
    s_mul_i32 s58, s44, 12
    s_lshr_b64 s[60:61], s[66:67], s58
    s_mov_b32 s35, s64
    s_bfe_u32 s58, s60, 131072
    s_lshl_b32 s58, s58, 7
    s_add_u32 s40, s39, s58
    s_bfe_u32 s58, s60, 131074
    s_lshl_b32 s58, s58, 8
    s_add_u32 s36, s58, s64
    s_bfe_u32 s58, s60, 131076
    s_lshl_b32 s58, s58, 7
    s_add_u32 s41, s39, s58
    s_bfe_u32 s58, s60, 131078
    s_lshl_b32 s58, s58, 8
    s_add_u32 s37, s58, s64
    s_bfe_u32 s58, s60, 131080
    s_lshl_b32 s58, s58, 7
    s_add_u32 s42, s39, s58
    s_bfe_u32 s58, s60, 131082
    s_lshl_b32 s58, s58, 8
    s_add_u32 s38, s58, s64
    s_mov_b32 s52, -1
    s_cmp_ge_u32 s44, 2
    s_cselect_b32 s53, -1, 0
    s_mov_b32 s56, s45
    s_add_u32 s57, s45, 1024
    s_cmp_ge_u32 s44, 3
    s_cselect_b32 s54, -1, 1
    s_cselect_b32 s57, s57, 86912
    s_cmp_ge_u32 s44, 4
    s_cselect_b32 s55, -1, 0
    s_mov_b32 s47, 0
    s_mov_b32 s48, 0
    s_lshr_b32 s43, s24, 2
    s_and_b32 s58, s24, 3
    s_lshl_b32 s58, s58, 2
    s_add_u32 s58, s58, s43
    s_lshl_b32 s58, s58, 4
    s_add_u32 s58, s58, 86272
    v_mov_b32 v251, s58
    s_mov_b32 s43, 0
    v_mov_b32 v252, 0
    s_waitcnt vmcnt(6)
    ds_read_b64_tr_b16 v[176:177], v234 offset:0
    ds_read_b64_tr_b16 v[178:179], v234 offset:1024
    ds_read_b64_tr_b16 v[180:181], v235 offset:0
    ds_read_b64_tr_b16 v[182:183], v235 offset:1024
    ds_read_b64_tr_b16 v[68:69], v241 offset:0
    ds_read_b64_tr_b16 v[70:71], v241 offset:256
    s_mov_b64 exec, s[50:51]
    ds_read_u16_d16_hi v230, v242 offset:0
    s_mov_b64 exec, -1
    s_waitcnt lgkmcnt(3)
    v_readfirstlane_b32 s58, v252
    s_add_u32 s43, s43, 1
    v_mov_b32 v252, s43
    s_cmp_le_u32 s43, s58
    ds_write2_b32 v251, v252, v252 offset0:0 offset1:8
    s_setprio 1
    s_cbranch_scc1 PRIO_1
    s_setprio 0
PRIO_1:
    s_cmp_eq_u32 s85, 4
    s_cbranch_scc1 ITEM_0_4
    s_cmp_eq_u32 s85, 5
    s_cbranch_scc1 ITEM_0_5
    s_cmp_eq_u32 s85, 6
    s_cbranch_scc1 ITEM_0_6
    s_cmp_eq_u32 s85, 3
    s_cbranch_scc1 ITEM_0_3
    s_cmp_eq_u32 s85, 8
    s_cbranch_scc1 ITEM_0_8
    s_branch ITEM_0_2
NEXT_0:
    s_mov_b32 s58, s26
    s_mov_b32 s26, s27
    s_mov_b32 s27, s28
    s_mov_b32 s28, s29
    s_mov_b32 s29, s30
    s_mov_b32 s30, s58
    s_mov_b32 s85, s86
    s_mov_b32 s46, s45
    s_add_u32 s47, s47, 1
    s_add_u32 s48, s48, 6
    s_cmp_eq_u32 s47, 5
    s_cbranch_scc1 TO_PHASE1
    s_cmp_eq_u32 s47, 4
    s_cselect_b32 s64, 128, 0
    s_and_b32 s45, s27, 0x3ffff
    s_bfe_u32 s44, s27, 0x30012
    s_lshr_b32 s86, s27, 28
    s_lshl_b32 s58, s44, 9
    s_add_u32 s39, s45, s58
    s_mul_i32 s58, s44, 12
    s_lshr_b64 s[60:61], s[66:67], s58
    s_mov_b32 s35, s64
    s_bfe_u32 s58, s60, 131072
    s_lshl_b32 s58, s58, 7
    s_add_u32 s40, s39, s58
    s_bfe_u32 s58, s60, 131074
    s_lshl_b32 s58, s58, 8
    s_add_u32 s36, s58, s64
    s_bfe_u32 s58, s60, 131076
    s_lshl_b32 s58, s58, 7
    s_add_u32 s41, s39, s58
    s_bfe_u32 s58, s60, 131078
    s_lshl_b32 s58, s58, 8
    s_add_u32 s37, s58, s64
    s_bfe_u32 s58, s60, 131080
    s_lshl_b32 s58, s58, 7
    s_add_u32 s42, s39, s58
    s_bfe_u32 s58, s60, 131082
    s_lshl_b32 s58, s58, 8
    s_add_u32 s38, s58, s64
    s_mov_b32 s52, -1
    s_cmp_ge_u32 s44, 2
    s_cselect_b32 s53, -1, 0
    s_mov_b32 s56, s45
    s_add_u32 s57, s45, 1024
    s_cmp_ge_u32 s44, 3
    s_cselect_b32 s54, -1, 1
    s_cselect_b32 s57, s57, 86912
    s_cmp_ge_u32 s44, 4
    s_cselect_b32 s55, -1, 0
    s_cmp_eq_u32 s47, 4
    s_cbranch_scc0 NEXT_0_go
    s_mov_b64 s[52:53], 1
    s_mov_b32 s56, 86912
    s_mov_b64 s[54:55], 1
    s_mov_b32 s57, 86912
NEXT_0_go:
    s_waitcnt lgkmcnt(3)
    v_readfirstlane_b32 s58, v252
    s_add_u32 s43, s43, 1
    v_mov_b32 v252, s43
    s_cmp_le_u32 s43, s58
    ds_write2_b32 v251, v252, v252 offset0:0 offset1:8
    s_setprio 1
    s_cbranch_scc1 PRIO_2
    s_setprio 0
PRIO_2:
    s_cmp_eq_u32 s85, 4
    s_cbranch_scc1 ITEM_0_4
    s_cmp_eq_u32 s85, 5
    s_cbranch_scc1 ITEM_0_5
    s_cmp_eq_u32 s85, 6
    s_cbranch_scc1 ITEM_0_6
    s_cmp_eq_u32 s85, 3
    s_cbranch_scc1 ITEM_0_3
    s_cmp_eq_u32 s85, 8
    s_cbranch_scc1 ITEM_0_8
    s_branch ITEM_0_2
TO_PHASE1:
    v_lshlrev_b32 v244, 4, v250
    v_add_u32 v244, 65536, v244
    ds_read_b128 v[96:99], v244 offset:0
    ds_read_b128 v[100:103], v244 offset:1024
    ds_read_b128 v[104:107], v244 offset:2048
    ds_read_b128 v[108:111], v244 offset:3072
    ds_read_b128 v[112:115], v244 offset:4096
    ds_read_b128 v[116:119], v244 offset:5120
    ds_read_b128 v[120:123], v244 offset:6144
    ds_read_b128 v[124:127], v244 offset:7168
    ds_read_b128 v[128:131], v244 offset:8192
    ds_read_b128 v[132:135], v244 offset:9216
    ds_read_b128 v[136:139], v244 offset:10240
    ds_read_b128 v[140:143], v244 offset:11264
    ds_read_b128 v[144:147], v244 offset:12288
    ds_read_b128 v[148:151], v244 offset:13312
    ds_read_b128 v[152:155], v244 offset:14336
    ds_read_b128 v[156:159], v244 offset:15360
    ds_read_b128 v[160:163], v244 offset:16384
    ds_read_b128 v[164:167], v244 offset:17408
    ds_read_b128 v[168:171], v244 offset:18432
    ds_read_b128 v[172:175], v244 offset:19456
    s_mov_b32 s31, 128
    s_mov_b32 s32, 384
    s_mov_b32 s33, 640
    s_mov_b32 s34, 896
    s_mov_b32 s47, 0
    s_waitcnt lgkmcnt(0)
    s_branch NEXT_1_go
NEXT_1:
    s_mov_b32 s58, s26
    s_mov_b32 s26, s27
    s_mov_b32 s27, s28
    s_mov_b32 s28, s29
    s_mov_b32 s29, s30
    s_mov_b32 s30, s58
    s_mov_b32 s85, s86
    s_mov_b32 s46, s45
    s_add_u32 s47, s47, 1
    s_cmp_eq_u32 s47, 5
    s_cbranch_scc1 TAIL
NEXT_1_go:
    s_and_b32 s45, s27, 0x3ffff
    s_bfe_u32 s44, s27, 0x30012
    s_lshr_b32 s86, s27, 28
    s_lshl_b32 s58, s44, 9
    s_add_u32 s39, s45, s58
    s_mul_i32 s58, s44, 12
    s_lshr_b64 s[60:61], s[66:67], s58
    s_mov_b32 s35, s64
    s_bfe_u32 s58, s60, 131072
    s_lshl_b32 s58, s58, 7
    s_add_u32 s40, s39, s58
    s_bfe_u32 s58, s60, 131074
    s_lshl_b32 s58, s58, 8
    s_add_u32 s36, s58, s64
    s_bfe_u32 s58, s60, 131076
    s_lshl_b32 s58, s58, 7
    s_add_u32 s41, s39, s58
    s_bfe_u32 s58, s60, 131078
    s_lshl_b32 s58, s58, 8
    s_add_u32 s37, s58, s64
    s_bfe_u32 s58, s60, 131080
    s_lshl_b32 s58, s58, 7
    s_add_u32 s42, s39, s58
    s_bfe_u32 s58, s60, 131082
    s_lshl_b32 s58, s58, 8
    s_add_u32 s38, s58, s64
    s_bfe_u32 s65, s26, 0x40015
    s_bfe_u32 s58, s26, 0x10007
    s_lshl_b32 s58, s58, 3
    s_xor_b32 s65, s65, s58
    s_lshl_b32 s65, s65, 4
    s_waitcnt lgkmcnt(6)
    v_readfirstlane_b32 s58, v252
    s_add_u32 s43, s43, 1
    v_mov_b32 v252, s43
    s_cmp_le_u32 s43, s58
    ds_write2_b32 v251, v252, v252 offset0:0 offset1:8
    s_setprio 1
    s_cbranch_scc1 PRIO_3
    s_setprio 0
PRIO_3:
    s_cmp_eq_u32 s85, 4
    s_cbranch_scc1 ITEM_1_4
    s_cmp_eq_u32 s85, 5
    s_cbranch_scc1 ITEM_1_5
    s_cmp_eq_u32 s85, 6
    s_cbranch_scc1 ITEM_1_6
    s_cmp_eq_u32 s85, 3
    s_cbranch_scc1 ITEM_1_3
    s_cmp_eq_u32 s85, 8
    s_cbranch_scc1 ITEM_1_8
    s_branch ITEM_1_2
.p2align 6
ITEM_0_4:
    ds_read_b64_tr_b16 v[76:77], v241 offset:512
    ds_read_b64_tr_b16 v[78:79], v241 offset:768
    s_mov_b64 exec, s[50:51]
    ds_read_u16_d16_hi v231, v242 offset:128
    s_mov_b64 exec, -1
    v_add_u32 v244, s41, v239
    ds_read_u16 v226, v244
    ds_read_u16 v227, v244 offset:64
    v_add_u32 v244, s42, v239
    ds_read_u16 v228, v244
    ds_read_u16 v229, v244 offset:64
    v_add_u32 v245, s45, v248
    ds_read_b32 v246, v245
    ds_read_b32 v247, v245 offset:1024
    s_waitcnt lgkmcnt(9)
    v_lshlrev_b32 v184, 16, v68
    v_and_b32 v185, 0xffff0000, v68
    v_lshlrev_b32 v186, 16, v69
    v_and_b32 v187, 0xffff0000, v69
    v_mul_f32_dpp v188, v230, v184 row_newbcast:0 row_mask:0xf bank_mask:0xf
    v_mul_f32_dpp v189, v230, v185 row_newbcast:1 row_mask:0xf bank_mask:0xf
    v_mul_f32_dpp v190, v230, v184 row_newbcast:8 row_mask:0xf bank_mask:0xf
    v_mul_f32_dpp v191, v230, v185 row_newbcast:9 row_mask:0xf bank_mask:0xf
    v_lshlrev_b32 v184, 16, v70
    v_and_b32 v185, 0xffff0000, v70
    v_cvt_pk_bf16_f32 v64, v188, v189
    v_cvt_pk_bf16_f32 v68, v190, v191
    v_mul_f32_dpp v188, v230, v186 row_newbcast:2 row_mask:0xf bank_mask:0xf
    v_mul_f32_dpp v189, v230, v187 row_newbcast:3 row_mask:0xf bank_mask:0xf
    v_mul_f32_dpp v190, v230, v186 row_newbcast:10 row_mask:0xf bank_mask:0xf
    v_mul_f32_dpp v191, v230, v187 row_newbcast:11 row_mask:0xf bank_mask:0xf
    v_lshlrev_b32 v186, 16, v71
    v_and_b32 v187, 0xffff0000, v71
    v_cvt_pk_bf16_f32 v65, v188, v189
    v_cvt_pk_bf16_f32 v69, v190, v191
    v_mul_f32_dpp v188, v230, v184 row_newbcast:4 row_mask:0xf bank_mask:0xf
    v_mul_f32_dpp v189, v230, v185 row_newbcast:5 row_mask:0xf bank_mask:0xf
    v_mul_f32_dpp v190, v230, v184 row_newbcast:12 row_mask:0xf bank_mask:0xf
    v_mul_f32_dpp v191, v230, v185 row_newbcast:13 row_mask:0xf bank_mask:0xf
    v_cvt_pk_bf16_f32 v66, v188, v189
    v_cvt_pk_bf16_f32 v70, v190, v191
    v_mul_f32_dpp v188, v230, v186 row_newbcast:6 row_mask:0xf bank_mask:0xf
    v_mul_f32_dpp v189, v230, v187 row_newbcast:7 row_mask:0xf bank_mask:0xf
    v_mul_f32_dpp v190, v230, v186 row_newbcast:14 row_mask:0xf bank_mask:0xf
    v_mul_f32_dpp v191, v230, v187 row_newbcast:15 row_mask:0xf bank_mask:0xf
    v_cvt_pk_bf16_f32 v67, v188, v189
    v_cvt_pk_bf16_f32 v71, v190, v191
    s_nop 0
    s_waitcnt lgkmcnt(6)
    v_mfma_f32_32x32x16_bf16 v[0:15], v[64:67], v[176:179], 0
    v_lshlrev_b32 v184, 16, v76
    v_and_b32 v185, 0xffff0000, v76
    v_lshlrev_b32 v186, 16, v77
    v_and_b32 v187, 0xffff0000, v77
    v_mul_f32_dpp v188, v231, v184 row_newbcast:0 row_mask:0xf bank_mask:0xf
    v_mul_f32_dpp v189, v231, v185 row_newbcast:1 row_mask:0xf bank_mask:0xf
    v_mul_f32_dpp v190, v231, v184 row_newbcast:8 row_mask:0xf bank_mask:0xf
    v_mul_f32_dpp v191, v231, v185 row_newbcast:9 row_mask:0xf bank_mask:0xf
    v_mfma_f32_32x32x16_bf16 v[16:31], v[68:71], v[176:179], 0
    s_add_u32 m0, s25, 0
    s_waitcnt vmcnt(4)
    buffer_load_dwordx4 v222, s[4:7], s33 offen lds
    buffer_load_dwordx4 v223, s[8:11], s33 offen offset:1024 lds
    ds_read_b64_tr_b16 v[176:177], v234 offset:2048
    ds_read_b64_tr_b16 v[178:179], v234 offset:3072
    s_waitcnt lgkmcnt(2)
    v_lshl_add_u32 v246, v246, 5, v249
    v_lshl_add_u32 v247, v247, 5, v249
    s_mov_b32 m0, s56
    s_mov_b64 exec, s[52:53]
    buffer_load_dwordx4 v246, s[12:15], 0 offen  lds
    s_mov_b32 m0, s57
    s_mov_b64 exec, s[54:55]
    buffer_load_dwordx4 v247, s[12:15], 0 offen  lds
    s_mov_b64 exec, -1
    v_lshlrev_b32 v184, 16, v78
    v_and_b32 v185, 0xffff0000, v78
    v_cvt_pk_bf16_f32 v72, v188, v189
    v_cvt_pk_bf16_f32 v76, v190, v191
    v_mul_f32_dpp v188, v231, v186 row_newbcast:2 row_mask:0xf bank_mask:0xf
    v_mul_f32_dpp v189, v231, v187 row_newbcast:3 row_mask:0xf bank_mask:0xf
    v_mul_f32_dpp v190, v231, v186 row_newbcast:10 row_mask:0xf bank_mask:0xf
    v_mul_f32_dpp v191, v231, v187 row_newbcast:11 row_mask:0xf bank_mask:0xf
    v_mfma_f32_32x32x16_bf16 v[32:47], v[64:67], v[180:183], 0
    v_lshlrev_b32 v186, 16, v79
    v_and_b32 v187, 0xffff0000, v79
    v_cvt_pk_bf16_f32 v73, v188, v189
    v_cvt_pk_bf16_f32 v77, v190, v191
    v_mul_f32_dpp v188, v231, v184 row_newbcast:4 row_mask:0xf bank_mask:0xf
    v_mul_f32_dpp v189, v231, v185 row_newbcast:5 row_mask:0xf bank_mask:0xf
    v_mul_f32_dpp v190, v231, v184 row_newbcast:12 row_mask:0xf bank_mask:0xf
    v_mul_f32_dpp v191, v231, v185 row_newbcast:13 row_mask:0xf bank_mask:0xf
    v_mfma_f32_32x32x16_bf16 v[48:63], v[68:71], v[180:183], 0
    ds_read_b64_tr_b16 v[180:181], v235 offset:2048
    ds_read_b64_tr_b16 v[182:183], v235 offset:3072
    v_cvt_pk_bf16_f32 v74, v188, v189
    v_cvt_pk_bf16_f32 v78, v190, v191
    v_mul_f32_dpp v188, v231, v186 row_newbcast:6 row_mask:0xf bank_mask:0xf
    v_mul_f32_dpp v189, v231, v187 row_newbcast:7 row_mask:0xf bank_mask:0xf
    v_mul_f32_dpp v190, v231, v186 row_newbcast:14 row_mask:0xf bank_mask:0xf
    v_mul_f32_dpp v191, v231, v187 row_newbcast:15 row_mask:0xf bank_mask:0xf
    v_cvt_pk_bf16_f32 v75, v188, v189
    v_cvt_pk_bf16_f32 v79, v190, v191
    s_nop 0
    s_waitcnt lgkmcnt(2)
    v_mfma_f32_32x32x16_bf16 v[0:15], v[72:75], v[176:179], v[0:15]
    v_mfma_f32_32x32x16_bf16 v[16:31], v[76:79], v[176:179], v[16:31]
    s_add_u32 m0, s25, 2048
    s_waitcnt vmcnt(6) lgkmcnt(0)
    buffer_load_dwordx4 v224, s[4:7], s33 offen lds
    buffer_load_dwordx4 v225, s[8:11], s33 offen offset:1024 lds
    ds_read_b64_tr_b16 v[176:177], v234 offset:4096
    ds_read_b64_tr_b16 v[178:179], v234 offset:5120
    v_mfma_f32_32x32x16_bf16 v[32:47], v[72:75], v[180:183], v[32:47]
    v_mfma_f32_32x32x16_bf16 v[48:63], v[76:79], v[180:183], v[48:63]
    ds_read_b64_tr_b16 v[180:181], v235 offset:4096
    ds_read_b64_tr_b16 v[182:183], v235 offset:5120
    s_nop 0
    v_mul_f32 v184, v0, v96
    v_fmac_f32 v184, v1, v97
    v_fmac_f32 v184, v2, v98
    v_fmac_f32 v184, v3, v99
    v_fmac_f32 v184, v4, v100
    v_fmac_f32 v184, v5, v101
    v_fmac_f32 v184, v6, v102
    v_fmac_f32 v184, v7, v103
    v_mul_f32 v186, v8, v128
    v_fmac_f32 v186, v9, v129
    v_fmac_f32 v186, v10, v130
    v_fmac_f32 v186, v11, v131
    v_fmac_f32 v186, v12, v132
    v_fmac_f32 v186, v13, v133
    v_fmac_f32 v186, v14, v134
    v_fmac_f32 v186, v15, v135
    s_waitcnt lgkmcnt(2)
    v_mfma_f32_32x32x16_bf16 v[0:15], v[64:67], v[176:179], 0
    v_mul_f32 v188, v16, v128
    v_fmac_f32 v188, v17, v129
    v_fmac_f32 v188, v18, v130
    v_fmac_f32 v188, v19, v131
    v_fmac_f32 v188, v20, v132
    v_fmac_f32 v188, v21, v133
    v_fmac_f32 v188, v22, v134
    v_fmac_f32 v188, v23, v135
    v_mul_f32 v190, v24, v128
    v_fmac_f32 v190, v25, v129
    v_fmac_f32 v190, v26, v130
    v_fmac_f32 v190, v27, v131
    v_fmac_f32 v190, v28, v132
    v_fmac_f32 v190, v29, v133
    v_fmac_f32 v190, v30, v134
    v_fmac_f32 v190, v31, v135
    v_mfma_f32_32x32x16_bf16 v[16:31], v[68:71], v[176:179], 0
    s_add_u32 m0, s25, 4096
    s_waitcnt vmcnt(6) lgkmcnt(0)
    buffer_load_dwordx4 v222, s[4:7], s34 offen lds
    buffer_load_dwordx4 v223, s[8:11], s34 offen offset:1024 lds
    ds_read_b64_tr_b16 v[176:177], v234 offset:6144
    ds_read_b64_tr_b16 v[178:179], v234 offset:7168
    v_mul_f32 v185, v32, v104
    v_fmac_f32 v185, v33, v105
    v_fmac_f32 v185, v34, v106
    v_fmac_f32 v185, v35, v107
    v_fmac_f32 v185, v36, v108
    v_fmac_f32 v185, v37, v109
    v_fmac_f32 v185, v38, v110
    v_fmac_f32 v185, v39, v111
    v_mul_f32 v187, v40, v136
    v_fmac_f32 v187, v41, v137
    v_fmac_f32 v187, v42, v138
    v_fmac_f32 v187, v43, v139
    v_fmac_f32 v187, v44, v140
    v_fmac_f32 v187, v45, v141
    v_fmac_f32 v187, v46, v142
    v_fmac_f32 v187, v47, v143
    v_mfma_f32_32x32x16_bf16 v[32:47], v[64:67], v[180:183], 0
    v_add_u32 v244, s39, v239
    ds_read_u16 v222, v244
    ds_read_u16 v223, v244 offset:64
    v_mul_f32 v189, v48, v136
    v_fmac_f32 v189, v49, v137
    v_fmac_f32 v189, v50, v138
    v_fmac_f32 v189, v51, v139
    v_fmac_f32 v189, v52, v140
    v_fmac_f32 v189, v53, v141
    v_fmac_f32 v189, v54, v142
    v_fmac_f32 v189, v55, v143
    v_mul_f32 v191, v56, v136
    v_fmac_f32 v191, v57, v137
    v_fmac_f32 v191, v58, v138
    v_fmac_f32 v191, v59, v139
    v_fmac_f32 v191, v60, v140
    v_fmac_f32 v191, v61, v141
    v_fmac_f32 v191, v62, v142
    v_fmac_f32 v191, v63, v143
    v_mfma_f32_32x32x16_bf16 v[48:63], v[68:71], v[180:183], 0
    ds_read_b64_tr_b16 v[180:181], v235 offset:6144
    ds_read_b64_tr_b16 v[182:183], v235 offset:7168
    v_permlane32_swap_b32 v184, v186
    v_permlane32_swap_b32 v188, v190
    v_permlane32_swap_b32 v185, v187
    v_permlane32_swap_b32 v189, v191
    v_add_f32 v186, v184, v186
    v_add_f32 v190, v188, v190
    v_add_f32 v187, v185, v187
    v_add_f32 v191, v189, v191
    s_set_gpr_idx_on s48, gpr_idx(DST)
    s_nop 0
    v_cvt_pk_bf16_f32 v192, v186, v187
    v_cvt_pk_bf16_f32 v193, v190, v191
    s_set_gpr_idx_off
    s_waitcnt lgkmcnt(4)
    v_mfma_f32_32x32x16_bf16 v[0:15], v[72:75], v[176:179], v[0:15]
    v_mfma_f32_32x32x16_bf16 v[16:31], v[76:79], v[176:179], v[16:31]
    s_add_u32 m0, s25, 6144
    s_waitcnt vmcnt(6) lgkmcnt(0)
    buffer_load_dwordx4 v224, s[4:7], s34 offen lds
    buffer_load_dwordx4 v225, s[8:11], s34 offen offset:1024 lds
    ds_read_b64_tr_b16 v[176:177], v234 offset:0
    ds_read_b64_tr_b16 v[178:179], v234 offset:1024
    v_mfma_f32_32x32x16_bf16 v[32:47], v[72:75], v[180:183], v[32:47]
    v_add_u32 v244, s40, v239
    ds_read_u16 v224, v244
    ds_read_u16 v225, v244 offset:64
    v_mfma_f32_32x32x16_bf16 v[48:63], v[76:79], v[180:183], v[48:63]
    ds_read_b64_tr_b16 v[180:181], v235 offset:0
    ds_read_b64_tr_b16 v[182:183], v235 offset:1024
    v_mul_f32 v184, v0, v144
    v_fmac_f32 v184, v1, v145
    v_fmac_f32 v184, v2, v146
    v_fmac_f32 v184, v3, v147
    v_fmac_f32 v184, v4, v148
    v_fmac_f32 v184, v5, v149
    v_fmac_f32 v184, v6, v150
    v_fmac_f32 v184, v7, v151
    v_mul_f32 v186, v8, v112
    v_fmac_f32 v186, v9, v113
    v_fmac_f32 v186, v10, v114
    v_fmac_f32 v186, v11, v115
    v_fmac_f32 v186, v12, v116
    v_fmac_f32 v186, v13, v117
    v_fmac_f32 v186, v14, v118
    v_fmac_f32 v186, v15, v119
    s_waitcnt lgkmcnt(4)
    v_mfma_f32_32x32x16_bf16 v[0:15], v[64:67], v[176:179], 0
    v_mul_f32_e64 v188, v16, -v160
    v_fma_f32 v188, v17, -v161, v188
    v_fma_f32 v188, v18, -v162, v188
    v_fma_f32 v188, v19, -v163, v188
    v_fma_f32 v188, v20, -v164, v188
    v_fma_f32 v188, v21, -v165, v188
    v_fma_f32 v188, v22, -v166, v188
    v_fma_f32 v188, v23, -v167, v188
    v_mul_f32 v190, v24, v160
    v_fmac_f32 v190, v25, v161
    v_fmac_f32 v190, v26, v162
    v_fmac_f32 v190, v27, v163
    v_fmac_f32 v190, v28, v164
    v_fmac_f32 v190, v29, v165
    v_fmac_f32 v190, v30, v166
    v_fmac_f32 v190, v31, v167
    v_mfma_f32_32x32x16_bf16 v[16:31], v[68:71], v[176:179], 0
    v_lshl_add_u32 v222, v222, 10, v236
    v_lshl_add_u32 v223, v223, 10, v236
    s_add_u32 m0, s25, 0
    s_waitcnt vmcnt(4) lgkmcnt(0)
    buffer_load_dwordx4 v222, s[4:7], s35 offen lds
    buffer_load_dwordx4 v223, s[8:11], s35 offen offset:1024 lds
    ds_read_b64_tr_b16 v[176:177], v234 offset:2048
    ds_read_b64_tr_b16 v[178:179], v234 offset:3072
    v_mul_f32 v185, v32, v152
    v_fmac_f32 v185, v33, v153
    v_fmac_f32 v185, v34, v154
    v_fmac_f32 v185, v35, v155
    v_fmac_f32 v185, v36, v156
    v_fmac_f32 v185, v37, v157
    v_fmac_f32 v185, v38, v158
    v_fmac_f32 v185, v39, v159
    v_mul_f32 v187, v40, v120
    v_fmac_f32 v187, v41, v121
    v_fmac_f32 v187, v42, v122
    v_fmac_f32 v187, v43, v123
    v_fmac_f32 v187, v44, v124
    v_fmac_f32 v187, v45, v125
    v_fmac_f32 v187, v46, v126
    v_fmac_f32 v187, v47, v127
    v_mfma_f32_32x32x16_bf16 v[32:47], v[64:67], v[180:183], 0
    v_mul_f32_e64 v189, v48, -v168
    v_fma_f32 v189, v49, -v169, v189
    v_fma_f32 v189, v50, -v170, v189
    v_fma_f32 v189, v51, -v171, v189
    v_fma_f32 v189, v52, -v172, v189
    v_fma_f32 v189, v53, -v173, v189
    v_fma_f32 v189, v54, -v174, v189
    v_fma_f32 v189, v55, -v175, v189
    v_mul_f32 v191, v56, v168
    v_fmac_f32 v191, v57, v169
    v_fmac_f32 v191, v58, v170
    v_fmac_f32 v191, v59, v171
    v_fmac_f32 v191, v60, v172
    v_fmac_f32 v191, v61, v173
    v_fmac_f32 v191, v62, v174
    v_fmac_f32 v191, v63, v175
    v_mfma_f32_32x32x16_bf16 v[48:63], v[68:71], v[180:183], 0
    ds_read_b64_tr_b16 v[180:181], v235 offset:2048
    ds_read_b64_tr_b16 v[182:183], v235 offset:3072
    s_waitcnt lgkmcnt(2)
    v_mfma_f32_32x32x16_bf16 v[0:15], v[72:75], v[176:179], v[0:15]
    v_mfma_f32_32x32x16_bf16 v[16:31], v[76:79], v[176:179], v[16:31]
    v_lshl_add_u32 v224, v224, 10, v236
    v_lshl_add_u32 v225, v225, 10, v236
    s_add_u32 m0, s25, 2048
    s_waitcnt vmcnt(4) lgkmcnt(0)
    buffer_load_dwordx4 v224, s[4:7], s36 offen lds
    buffer_load_dwordx4 v225, s[8:11], s36 offen offset:1024 lds
    ds_read_b64_tr_b16 v[176:177], v234 offset:4096
    ds_read_b64_tr_b16 v[178:179], v234 offset:5120
    v_mfma_f32_32x32x16_bf16 v[32:47], v[72:75], v[180:183], v[32:47]
    v_mfma_f32_32x32x16_bf16 v[48:63], v[76:79], v[180:183], v[48:63]
    ds_read_b64_tr_b16 v[180:181], v235 offset:4096
    ds_read_b64_tr_b16 v[182:183], v235 offset:5120
    v_mul_f32 v246, v0, v144
    v_fmac_f32 v246, v1, v145
    v_fmac_f32 v246, v2, v146
    v_fmac_f32 v246, v3, v147
    v_fmac_f32 v246, v4, v148
    v_fmac_f32 v246, v5, v149
    v_fmac_f32 v246, v6, v150
    v_fmac_f32 v246, v7, v151
    v_fmac_f32 v188, v8, v160
    v_fmac_f32 v188, v9, v161
    v_fmac_f32 v188, v10, v162
    v_fmac_f32 v188, v11, v163
    v_fmac_f32 v188, v12, v164
    v_fmac_f32 v188, v13, v165
    v_fmac_f32 v188, v14, v166
    v_fmac_f32 v188, v15, v167
    s_waitcnt lgkmcnt(2)
    v_mfma_f32_32x32x16_bf16 v[0:15], v[64:67], v[176:179], 0
    v_permlane32_swap_b32 v184, v246
    v_fmac_f32 v186, v16, v112
    v_fmac_f32 v186, v17, v113
    v_fmac_f32 v186, v18, v114
    v_fmac_f32 v186, v19, v115
    v_fmac_f32 v186, v20, v116
    v_fmac_f32 v186, v21, v117
    v_fmac_f32 v186, v22, v118
    v_fmac_f32 v186, v23, v119
    v_add_f32 v246, v184, v246
    v_mul_f32_e64 v184, v24, -v160
    v_fma_f32 v184, v25, -v161, v184
    v_fma_f32 v184, v26, -v162, v184
    v_fma_f32 v184, v27, -v163, v184
    v_fma_f32 v184, v28, -v164, v184
    v_fma_f32 v184, v29, -v165, v184
    v_fma_f32 v184, v30, -v166, v184
    v_fma_f32 v184, v31, -v167, v184
    v_mfma_f32_32x32x16_bf16 v[16:31], v[68:71], v[176:179], 0
    v_lshl_add_u32 v226, v226, 10, v236
    v_lshl_add_u32 v227, v227, 10, v236
    s_add_u32 m0, s25, 4096
    s_waitcnt vmcnt(4) lgkmcnt(0)
    buffer_load_dwordx4 v226, s[4:7], s37 offen lds
    buffer_load_dwordx4 v227, s[8:11], s37 offen offset:1024 lds
    ds_read_b64_tr_b16 v[176:177], v234 offset:6144
    ds_read_b64_tr_b16 v[178:179], v234 offset:7168
    v_mul_f32 v247, v32, v152
    v_fmac_f32 v247, v33, v153
    v_fmac_f32 v247, v34, v154
    v_fmac_f32 v247, v35, v155
    v_fmac_f32 v247, v36, v156
    v_fmac_f32 v247, v37, v157
    v_fmac_f32 v247, v38, v158
    v_fmac_f32 v247, v39, v159
    v_fmac_f32 v189, v40, v168
    v_fmac_f32 v189, v41, v169
    v_fmac_f32 v189, v42, v170
    v_fmac_f32 v189, v43, v171
    v_fmac_f32 v189, v44, v172
    v_fmac_f32 v189, v45, v173
    v_fmac_f32 v189, v46, v174
    v_fmac_f32 v189, v47, v175
    v_mfma_f32_32x32x16_bf16 v[32:47], v[64:67], v[180:183], 0
    v_permlane32_swap_b32 v185, v247
    v_fmac_f32 v187, v48, v120
    v_fmac_f32 v187, v49, v121
    v_fmac_f32 v187, v50, v122
    v_fmac_f32 v187, v51, v123
    v_fmac_f32 v187, v52, v124
    v_fmac_f32 v187, v53, v125
    v_fmac_f32 v187, v54, v126
    v_fmac_f32 v187, v55, v127
    v_add_f32 v247, v185, v247
    v_mul_f32_e64 v185, v56, -v168
    v_fma_f32 v185, v57, -v169, v185
    v_fma_f32 v185, v58, -v170, v185
    v_fma_f32 v185, v59, -v171, v185
    v_fma_f32 v185, v60, -v172, v185
    v_fma_f32 v185, v61, -v173, v185
    v_fma_f32 v185, v62, -v174, v185
    v_fma_f32 v185, v63, -v175, v185
    v_mfma_f32_32x32x16_bf16 v[48:63], v[68:71], v[180:183], 0
    ds_read_b64_tr_b16 v[180:181], v235 offset:6144
    ds_read_b64_tr_b16 v[182:183], v235 offset:7168
    s_set_gpr_idx_on s48, gpr_idx(DST)
    s_nop 0
    v_cvt_pk_bf16_f32 v194, v246, v247
    s_set_gpr_idx_off
    s_waitcnt lgkmcnt(2)
    v_mfma_f32_32x32x16_bf16 v[0:15], v[72:75], v[176:179], v[0:15]
    v_mfma_f32_32x32x16_bf16 v[16:31], v[76:79], v[176:179], v[16:31]
    v_lshl_add_u32 v228, v228, 10, v236
    v_lshl_add_u32 v229, v229, 10, v236
    s_add_u32 m0, s25, 6144
    s_waitcnt vmcnt(4) lgkmcnt(0)
    buffer_load_dwordx4 v228, s[4:7], s38 offen lds
    buffer_load_dwordx4 v229, s[8:11], s38 offen offset:1024 lds
    ds_read_b64_tr_b16 v[176:177], v234 offset:0
    ds_read_b64_tr_b16 v[178:179], v234 offset:1024
    v_mfma_f32_32x32x16_bf16 v[32:47], v[72:75], v[180:183], v[32:47]
    v_mfma_f32_32x32x16_bf16 v[48:63], v[76:79], v[180:183], v[48:63]
    ds_read_b64_tr_b16 v[180:181], v235 offset:0
    ds_read_b64_tr_b16 v[182:183], v235 offset:1024
    v_add_u32 v241, s45, v237
    v_add_u32 v242, s39, v238
    ds_read_b32 v252, v251 offset:16
    ds_read_b64_tr_b16 v[68:69], v241 offset:0
    ds_read_b64_tr_b16 v[70:71], v241 offset:256
    s_mov_b64 exec, s[50:51]
    ds_read_u16_d16_hi v230, v242 offset:0
    s_mov_b64 exec, -1
    v_mul_f32 v246, v0, v144
    v_fmac_f32 v246, v1, v145
    v_fmac_f32 v246, v2, v146
    v_fmac_f32 v246, v3, v147
    v_fmac_f32 v246, v4, v148
    v_fmac_f32 v246, v5, v149
    v_fmac_f32 v246, v6, v150
    v_fmac_f32 v246, v7, v151
    v_fma_f32 v190, v8, -v160, v190
    v_fma_f32 v190, v9, -v161, v190
    v_fma_f32 v190, v10, -v162, v190
    v_fma_f32 v190, v11, -v163, v190
    v_fma_f32 v190, v12, -v164, v190
    v_fma_f32 v190, v13, -v165, v190
    v_fma_f32 v190, v14, -v166, v190
    v_fma_f32 v190, v15, -v167, v190
    v_fmac_f32 v184, v16, v160
    v_fmac_f32 v184, v17, v161
    v_fmac_f32 v184, v18, v162
    v_fmac_f32 v184, v19, v163
    v_fmac_f32 v184, v20, v164
    v_fmac_f32 v184, v21, v165
    v_fmac_f32 v184, v22, v166
    v_fmac_f32 v184, v23, v167
    v_fmac_f32 v186, v24, v112
    v_fmac_f32 v186, v25, v113
    v_fmac_f32 v186, v26, v114
    v_fmac_f32 v186, v27, v115
    v_fmac_f32 v186, v28, v116
    v_fmac_f32 v186, v29, v117
    v_fmac_f32 v186, v30, v118
    v_fmac_f32 v186, v31, v119
    v_mul_f32 v247, v32, v152
    v_fmac_f32 v247, v33, v153
    v_fmac_f32 v247, v34, v154
    v_fmac_f32 v247, v35, v155
    v_fmac_f32 v247, v36, v156
    v_fmac_f32 v247, v37, v157
    v_fmac_f32 v247, v38, v158
    v_fmac_f32 v247, v39, v159
    v_fma_f32 v191, v40, -v168, v191
    v_fma_f32 v191, v41, -v169, v191
    v_fma_f32 v191, v42, -v170, v191
    v_fma_f32 v191, v43, -v171, v191
    v_fma_f32 v191, v44, -v172, v191
    v_fma_f32 v191, v45, -v173, v191
    v_fma_f32 v191, v46, -v174, v191
    v_fma_f32 v191, v47, -v175, v191
    v_fmac_f32 v185, v48, v168
    v_fmac_f32 v185, v49, v169
    v_fmac_f32 v185, v50, v170
    v_fmac_f32 v185, v51, v171
    v_fmac_f32 v185, v52, v172
    v_fmac_f32 v185, v53, v173
    v_fmac_f32 v185, v54, v174
    v_fmac_f32 v185, v55, v175
    v_fmac_f32 v187, v56, v120
    v_fmac_f32 v187, v57, v121
    v_fmac_f32 v187, v58, v122
    v_fmac_f32 v187, v59, v123
    v_fmac_f32 v187, v60, v124
    v_fmac_f32 v187, v61, v125
    v_fmac_f32 v187, v62, v126
    v_fmac_f32 v187, v63, v127
    s_nop 0
    v_permlane32_swap_b32 v246, v188
    v_permlane32_swap_b32 v190, v244
    v_permlane32_swap_b32 v186, v184
    v_permlane32_swap_b32 v247, v189
    v_permlane32_swap_b32 v191, v245
    v_permlane32_swap_b32 v187, v185
    v_add_f32 v188, v246, v188
    v_add_f32 v244, v190, v244
    v_add_f32 v184, v186, v184
    v_add_f32 v189, v247, v189
    v_add_f32 v245, v191, v245
    v_add_f32 v185, v187, v185
    s_set_gpr_idx_on s48, gpr_idx(DST)
    s_nop 0
    v_cvt_pk_bf16_f32 v195, v188, v189
    v_cvt_pk_bf16_f32 v197, v244, v245
    v_cvt_pk_bf16_f32 v196, v184, v185
    s_set_gpr_idx_off
    s_branch NEXT_0
.p2align 6
ITEM_0_5:
    ds_read_b64_tr_b16 v[76:77], v241 offset:512
    ds_read_b64_tr_b16 v[78:79], v241 offset:768
    ds_read_b64_tr_b16 v[84:85], v241 offset:1024
    s_mov_b64 exec, s[50:51]
    ds_read_u16_d16_hi v231, v242 offset:128
    ds_read_u16_d16_hi v232, v242 offset:256
    s_mov_b64 exec, -1
    v_add_u32 v244, s42, v239
    ds_read_u16 v228, v244
    ds_read_u16 v229, v244 offset:64
    v_add_u32 v245, s45, v248
    ds_read_b32 v246, v245
    ds_read_b32 v247, v245 offset:1024
    s_waitcnt lgkmcnt(9)
    v_lshlrev_b32 v184, 16, v68
    v_and_b32 v185, 0xffff0000, v68
    v_lshlrev_b32 v186, 16, v69
    v_and_b32 v187, 0xffff0000, v69
    v_mul_f32_dpp v188, v230, v184 row_newbcast:0 row_mask:0xf bank_mask:0xf
    v_mul_f32_dpp v189, v230, v185 row_newbcast:1 row_mask:0xf bank_mask:0xf
    v_mul_f32_dpp v190, v230, v184 row_newbcast:8 row_mask:0xf bank_mask:0xf
    v_mul_f32_dpp v191, v230, v185 row_newbcast:9 row_mask:0xf bank_mask:0xf
    v_lshlrev_b32 v184, 16, v70
    v_and_b32 v185, 0xffff0000, v70
    v_cvt_pk_bf16_f32 v64, v188, v189
    v_cvt_pk_bf16_f32 v68, v190, v191
    v_mul_f32_dpp v188, v230, v186 row_newbcast:2 row_mask:0xf bank_mask:0xf
    v_mul_f32_dpp v189, v230, v187 row_newbcast:3 row_mask:0xf bank_mask:0xf
    v_mul_f32_dpp v190, v230, v186 row_newbcast:10 row_mask:0xf bank_mask:0xf
    v_mul_f32_dpp v191, v230, v187 row_newbcast:11 row_mask:0xf bank_mask:0xf
    v_lshlrev_b32 v186, 16, v71
    v_and_b32 v187, 0xffff0000, v71
    v_cvt_pk_bf16_f32 v65, v188, v189
    v_cvt_pk_bf16_f32 v69, v190, v191
    v_mul_f32_dpp v188, v230, v184 row_newbcast:4 row_mask:0xf bank_mask:0xf
    v_mul_f32_dpp v189, v230, v185 row_newbcast:5 row_mask:0xf bank_mask:0xf
    v_mul_f32_dpp v190, v230, v184 row_newbcast:12 row_mask:0xf bank_mask:0xf
    v_mul_f32_dpp v191, v230, v185 row_newbcast:13 row_mask:0xf bank_mask:0xf
    v_cvt_pk_bf16_f32 v66, v188, v189
    v_cvt_pk_bf16_f32 v70, v190, v191
    v_mul_f32_dpp v188, v230, v186 row_newbcast:6 row_mask:0xf bank_mask:0xf
    v_mul_f32_dpp v189, v230, v187 row_newbcast:7 row_mask:0xf bank_mask:0xf
    v_mul_f32_dpp v190, v230, v186 row_newbcast:14 row_mask:0xf bank_mask:0xf
    v_mul_f32_dpp v191, v230, v187 row_newbcast:15 row_mask:0xf bank_mask:0xf
    v_cvt_pk_bf16_f32 v67, v188, v189
    v_cvt_pk_bf16_f32 v71, v190, v191
    s_nop 0
    s_waitcnt lgkmcnt(4)
    v_mfma_f32_32x32x16_bf16 v[0:15], v[64:67], v[176:179], 0
    v_lshlrev_b32 v184, 16, v76
    v_and_b32 v185, 0xffff0000, v76
    v_lshlrev_b32 v186, 16, v77
    v_and_b32 v187, 0xffff0000, v77
    v_mul_f32_dpp v188, v231, v184 row_newbcast:0 row_mask:0xf bank_mask:0xf
    v_mul_f32_dpp v189, v231, v185 row_newbcast:1 row_mask:0xf bank_mask:0xf
    v_mul_f32_dpp v190, v231, v184 row_newbcast:8 row_mask:0xf bank_mask:0xf
    v_mul_f32_dpp v191, v231, v185 row_newbcast:9 row_mask:0xf bank_mask:0xf
    v_mfma_f32_32x32x16_bf16 v[16:31], v[68:71], v[176:179], 0
    s_add_u32 m0, s25, 0
    s_waitcnt vmcnt(4)
    buffer_load_dwordx4 v224, s[4:7], s32 offen lds
    buffer_load_dwordx4 v225, s[8:11], s32 offen offset:1024 lds
    ds_read_b64_tr_b16 v[176:177], v234 offset:2048
    ds_read_b64_tr_b16 v[178:179], v234 offset:3072
    s_waitcnt lgkmcnt(2)
    v_lshl_add_u32 v246, v246, 5, v249
    v_lshl_add_u32 v247, v247, 5, v249
    s_mov_b32 m0, s56
    s_mov_b64 exec, s[52:53]
    buffer_load_dwordx4 v246, s[12:15], 0 offen  lds
    s_mov_b32 m0, s57
    s_mov_b64 exec, s[54:55]
    buffer_load_dwordx4 v247, s[12:15], 0 offen  lds
    s_mov_b64 exec, -1
    v_lshlrev_b32 v184, 16, v78
    v_and_b32 v185, 0xffff0000, v78
    v_cvt_pk_bf16_f32 v72, v188, v189
    v_cvt_pk_bf16_f32 v76, v190, v191
    v_mul_f32_dpp v188, v231, v186 row_newbcast:2 row_mask:0xf bank_mask:0xf
    v_mul_f32_dpp v189, v231, v187 row_newbcast:3 row_mask:0xf bank_mask:0xf
    v_mul_f32_dpp v190, v231, v186 row_newbcast:10 row_mask:0xf bank_mask:0xf
    v_mul_f32_dpp v191, v231, v187 row_newbcast:11 row_mask:0xf bank_mask:0xf
    v_mfma_f32_32x32x16_bf16 v[32:47], v[64:67], v[180:183], 0
    v_lshlrev_b32 v186, 16, v79
    v_and_b32 v187, 0xffff0000, v79
    v_cvt_pk_bf16_f32 v73, v188, v189
    v_cvt_pk_bf16_f32 v77, v190, v191
    v_mul_f32_dpp v188, v231, v184 row_newbcast:4 row_mask:0xf bank_mask:0xf
    v_mul_f32_dpp v189, v231, v185 row_newbcast:5 row_mask:0xf bank_mask:0xf
    v_mul_f32_dpp v190, v231, v184 row_newbcast:12 row_mask:0xf bank_mask:0xf
    v_mul_f32_dpp v191, v231, v185 row_newbcast:13 row_mask:0xf bank_mask:0xf
    v_mfma_f32_32x32x16_bf16 v[48:63], v[68:71], v[180:183], 0
    ds_read_b64_tr_b16 v[180:181], v235 offset:2048
    ds_read_b64_tr_b16 v[182:183], v235 offset:3072
    v_cvt_pk_bf16_f32 v74, v188, v189
    v_cvt_pk_bf16_f32 v78, v190, v191
    v_mul_f32_dpp v188, v231, v186 row_newbcast:6 row_mask:0xf bank_mask:0xf
    v_mul_f32_dpp v189, v231, v187 row_newbcast:7 row_mask:0xf bank_mask:0xf
    v_mul_f32_dpp v190, v231, v186 row_newbcast:14 row_mask:0xf bank_mask:0xf
    v_mul_f32_dpp v191, v231, v187 row_newbcast:15 row_mask:0xf bank_mask:0xf
    v_cvt_pk_bf16_f32 v75, v188, v189
    v_cvt_pk_bf16_f32 v79, v190, v191
    s_nop 0
    s_waitcnt lgkmcnt(2)
    v_mfma_f32_32x32x16_bf16 v[0:15], v[72:75], v[176:179], v[0:15]
    v_lshlrev_b32 v184, 16, v84
    v_and_b32 v185, 0xffff0000, v84
    v_lshlrev_b32 v186, 16, v85
    v_and_b32 v187, 0xffff0000, v85
    v_mfma_f32_32x32x16_bf16 v[16:31], v[76:79], v[176:179], v[16:31]
    s_add_u32 m0, s25, 2048
    s_waitcnt vmcnt(6) lgkmcnt(0)
    buffer_load_dwordx4 v226, s[4:7], s32 offen lds
    ds_read_b64_tr_b16 v[176:177], v234 offset:4096
    v_mul_f32_dpp v188, v232, v184 row_newbcast:0 row_mask:0xf bank_mask:0xf
    v_mul_f32_dpp v189, v232, v185 row_newbcast:1 row_mask:0xf bank_mask:0xf
    v_mul_f32_dpp v190, v232, v184 row_newbcast:8 row_mask:0xf bank_mask:0xf
    v_mul_f32_dpp v191, v232, v185 row_newbcast:9 row_mask:0xf bank_mask:0xf
    v_mfma_f32_32x32x16_bf16 v[32:47], v[72:75], v[180:183], v[32:47]
    v_cvt_pk_bf16_f32 v80, v188, v189
    v_cvt_pk_bf16_f32 v84, v190, v191
    v_mul_f32_dpp v188, v232, v186 row_newbcast:2 row_mask:0xf bank_mask:0xf
    v_mul_f32_dpp v189, v232, v187 row_newbcast:3 row_mask:0xf bank_mask:0xf
    v_mfma_f32_32x32x16_bf16 v[48:63], v[76:79], v[180:183], v[48:63]
    ds_read_b64_tr_b16 v[180:181], v235 offset:4096
    v_mul_f32_dpp v190, v232, v186 row_newbcast:10 row_mask:0xf bank_mask:0xf
    v_mul_f32_dpp v191, v232, v187 row_newbcast:11 row_mask:0xf bank_mask:0xf
    v_cvt_pk_bf16_f32 v81, v188, v189
    v_cvt_pk_bf16_f32 v85, v190, v191
    s_nop 0
    s_waitcnt lgkmcnt(1)
    v_mfma_f32_32x32x8_bf16 v[0:15], v[80:81], v[176:177], v[0:15]
    v_mfma_f32_32x32x8_bf16 v[16:31], v[84:85], v[176:177], v[16:31]
    s_add_u32 m0, s25, 4096
    s_waitcnt vmcnt(5) lgkmcnt(0)
    buffer_load_dwordx4 v222, s[4:7], s33 offen lds
    buffer_load_dwordx4 v223, s[8:11], s33 offen offset:1024 lds
    ds_read_b64_tr_b16 v[176:177], v234 offset:6144
    ds_read_b64_tr_b16 v[178:179], v234 offset:7168
    v_mfma_f32_32x32x8_bf16 v[32:47], v[80:81], v[180:181], v[32:47]
    v_mfma_f32_32x32x8_bf16 v[48:63], v[84:85], v[180:181], v[48:63]
    ds_read_b64_tr_b16 v[180:181], v235 offset:6144
    ds_read_b64_tr_b16 v[182:183], v235 offset:7168
    s_nop 0
    v_mul_f32 v184, v0, v96
    v_fmac_f32 v184, v1, v97
    v_fmac_f32 v184, v2, v98
    v_fmac_f32 v184, v3, v99
    v_fmac_f32 v184, v4, v100
    v_fmac_f32 v184, v5, v101
    v_fmac_f32 v184, v6, v102
    v_fmac_f32 v184, v7, v103
    v_mul_f32 v186, v8, v128
    v_fmac_f32 v186, v9, v129
    v_fmac_f32 v186, v10, v130
    v_fmac_f32 v186, v11, v131
    v_fmac_f32 v186, v12, v132
    v_fmac_f32 v186, v13, v133
    v_fmac_f32 v186, v14, v134
    v_fmac_f32 v186, v15, v135
    s_waitcnt lgkmcnt(2)
    v_mfma_f32_32x32x16_bf16 v[0:15], v[64:67], v[176:179], 0
    v_mul_f32 v188, v16, v128
    v_fmac_f32 v188, v17, v129
    v_fmac_f32 v188, v18, v130
    v_fmac_f32 v188, v19, v131
    v_fmac_f32 v188, v20, v132
    v_fmac_f32 v188, v21, v133
    v_fmac_f32 v188, v22, v134
    v_fmac_f32 v188, v23, v135
    v_mul_f32 v190, v24, v128
    v_fmac_f32 v190, v25, v129
    v_fmac_f32 v190, v26, v130
    v_fmac_f32 v190, v27, v131
    v_fmac_f32 v190, v28, v132
    v_fmac_f32 v190, v29, v133
    v_fmac_f32 v190, v30, v134
    v_fmac_f32 v190, v31, v135
    v_mfma_f32_32x32x16_bf16 v[16:31], v[68:71], v[176:179], 0
    s_add_u32 m0, s25, 6144
    s_waitcnt vmcnt(5) lgkmcnt(0)
    buffer_load_dwordx4 v224, s[4:7], s33 offen lds
    buffer_load_dwordx4 v225, s[8:11], s33 offen offset:1024 lds
    ds_read_b64_tr_b16 v[176:177], v234 offset:0
    ds_read_b64_tr_b16 v[178:179], v234 offset:1024
    v_mul_f32 v185, v32, v104
    v_fmac_f32 v185, v33, v105
    v_fmac_f32 v185, v34, v106
    v_fmac_f32 v185, v35, v107
    v_fmac_f32 v185, v36, v108
    v_fmac_f32 v185, v37, v109
    v_fmac_f32 v185, v38, v110
    v_fmac_f32 v185, v39, v111
    v_mul_f32 v187, v40, v136
    v_fmac_f32 v187, v41, v137
    v_fmac_f32 v187, v42, v138
    v_fmac_f32 v187, v43, v139
    v_fmac_f32 v187, v44, v140
    v_fmac_f32 v187, v45, v141
    v_fmac_f32 v187, v46, v142
    v_fmac_f32 v187, v47, v143
    v_mfma_f32_32x32x16_bf16 v[32:47], v[64:67], v[180:183], 0
    v_mul_f32 v189, v48, v136
    v_fmac_f32 v189, v49, v137
    v_fmac_f32 v189, v50, v138
    v_fmac_f32 v189, v51, v139
    v_fmac_f32 v189, v52, v140
    v_fmac_f32 v189, v53, v141
    v_fmac_f32 v189, v54, v142
    v_fmac_f32 v189, v55, v143
    v_mul_f32 v191, v56, v136
    v_fmac_f32 v191, v57, v137
    v_fmac_f32 v191, v58, v138
    v_fmac_f32 v191, v59, v139
    v_fmac_f32 v191, v60, v140
    v_fmac_f32 v191, v61, v141
    v_fmac_f32 v191, v62, v142
    v_fmac_f32 v191, v63, v143
    v_mfma_f32_32x32x16_bf16 v[48:63], v[68:71], v[180:183], 0
    ds_read_b64_tr_b16 v[180:181], v235 offset:0
    ds_read_b64_tr_b16 v[182:183], v235 offset:1024
    v_permlane32_swap_b32 v184, v186
    v_permlane32_swap_b32 v188, v190
    v_permlane32_swap_b32 v185, v187
    v_permlane32_swap_b32 v189, v191
    v_add_f32 v186, v184, v186
    v_add_f32 v190, v188, v190
    v_add_f32 v187, v185, v187
    v_add_f32 v191, v189, v191
    s_set_gpr_idx_on s48, gpr_idx(DST)
    s_nop 0
    v_cvt_pk_bf16_f32 v192, v186, v187
    v_cvt_pk_bf16_f32 v193, v190, v191
    s_set_gpr_idx_off
    s_waitcnt lgkmcnt(2)
    v_mfma_f32_32x32x16_bf16 v[0:15], v[72:75], v[176:179], v[0:15]
    v_mfma_f32_32x32x16_bf16 v[16:31], v[76:79], v[176:179], v[16:31]
    s_add_u32 m0, s25, 0
    s_waitcnt vmcnt(4) lgkmcnt(0)
    buffer_load_dwordx4 v226, s[4:7], s33 offen lds
    ds_read_b64_tr_b16 v[176:177], v234 offset:2048
    v_mfma_f32_32x32x16_bf16 v[32:47], v[72:75], v[180:183], v[32:47]
    v_mfma_f32_32x32x16_bf16 v[48:63], v[76:79], v[180:183], v[48:63]
    ds_read_b64_tr_b16 v[180:181], v235 offset:2048
    s_waitcnt lgkmcnt(1)
    v_mfma_f32_32x32x8_bf16 v[0:15], v[80:81], v[176:177], v[0:15]
    v_mfma_f32_32x32x8_bf16 v[16:31], v[84:85], v[176:177], v[16:31]
    s_add_u32 m0, s25, 2048
    s_waitcnt vmcnt(3) lgkmcnt(0)
    buffer_load_dwordx4 v222, s[4:7], s34 offen lds
    buffer_load_dwordx4 v223, s[8:11], s34 offen offset:1024 lds
    ds_read_b64_tr_b16 v[176:177], v234 offset:4096
    ds_read_b64_tr_b16 v[178:179], v234 offset:5120
    v_mfma_f32_32x32x8_bf16 v[32:47], v[80:81], v[180:181], v[32:47]
    v_add_u32 v244, s39, v239
    ds_read_u16 v222, v244
    ds_read_u16 v223, v244 offset:64
    v_mfma_f32_32x32x8_bf16 v[48:63], v[84:85], v[180:181], v[48:63]
    ds_read_b64_tr_b16 v[180:181], v235 offset:4096
    ds_read_b64_tr_b16 v[182:183], v235 offset:5120
    v_mul_f32 v184, v0, v144
    v_fmac_f32 v184, v1, v145
    v_fmac_f32 v184, v2, v146
    v_fmac_f32 v184, v3, v147
    v_fmac_f32 v184, v4, v148
    v_fmac_f32 v184, v5, v149
    v_fmac_f32 v184, v6, v150
    v_fmac_f32 v184, v7, v151
    v_mul_f32 v186, v8, v112
    v_fmac_f32 v186, v9, v113
    v_fmac_f32 v186, v10, v114
    v_fmac_f32 v186, v11, v115
    v_fmac_f32 v186, v12, v116
    v_fmac_f32 v186, v13, v117
    v_fmac_f32 v186, v14, v118
    v_fmac_f32 v186, v15, v119
    s_waitcnt lgkmcnt(4)
    v_mfma_f32_32x32x16_bf16 v[0:15], v[64:67], v[176:179], 0
    v_mul_f32_e64 v188, v16, -v160
    v_fma_f32 v188, v17, -v161, v188
    v_fma_f32 v188, v18, -v162, v188
    v_fma_f32 v188, v19, -v163, v188
    v_fma_f32 v188, v20, -v164, v188
    v_fma_f32 v188, v21, -v165, v188
    v_fma_f32 v188, v22, -v166, v188
    v_fma_f32 v188, v23, -v167, v188
    v_mul_f32 v190, v24, v160
    v_fmac_f32 v190, v25, v161
    v_fmac_f32 v190, v26, v162
    v_fmac_f32 v190, v27, v163
    v_fmac_f32 v190, v28, v164
    v_fmac_f32 v190, v29, v165
    v_fmac_f32 v190, v30, v166
    v_fmac_f32 v190, v31, v167
    v_mfma_f32_32x32x16_bf16 v[16:31], v[68:71], v[176:179], 0
    s_add_u32 m0, s25, 4096
    s_waitcnt vmcnt(3) lgkmcnt(0)
    buffer_load_dwordx4 v224, s[4:7], s34 offen lds
    buffer_load_dwordx4 v225, s[8:11], s34 offen offset:1024 lds
    ds_read_b64_tr_b16 v[176:177], v234 offset:6144
    ds_read_b64_tr_b16 v[178:179], v234 offset:7168
    v_mul_f32 v185, v32, v152
    v_fmac_f32 v185, v33, v153
    v_fmac_f32 v185, v34, v154
    v_fmac_f32 v185, v35, v155
    v_fmac_f32 v185, v36, v156
    v_fmac_f32 v185, v37, v157
    v_fmac_f32 v185, v38, v158
    v_fmac_f32 v185, v39, v159
    v_mul_f32 v187, v40, v120
    v_fmac_f32 v187, v41, v121
    v_fmac_f32 v187, v42, v122
    v_fmac_f32 v187, v43, v123
    v_fmac_f32 v187, v44, v124
    v_fmac_f32 v187, v45, v125
    v_fmac_f32 v187, v46, v126
    v_fmac_f32 v187, v47, v127
    v_mfma_f32_32x32x16_bf16 v[32:47], v[64:67], v[180:183], 0
    v_add_u32 v244, s40, v239
    ds_read_u16 v224, v244
    ds_read_u16 v225, v244 offset:64
    v_mul_f32_e64 v189, v48, -v168
    v_fma_f32 v189, v49, -v169, v189
    v_fma_f32 v189, v50, -v170, v189
    v_fma_f32 v189, v51, -v171, v189
    v_fma_f32 v189, v52, -v172, v189
    v_fma_f32 v189, v53, -v173, v189
    v_fma_f32 v189, v54, -v174, v189
    v_fma_f32 v189, v55, -v175, v189
    v_mul_f32 v191, v56, v168
    v_fmac_f32 v191, v57, v169
    v_fmac_f32 v191, v58, v170
    v_fmac_f32 v191, v59, v171
    v_fmac_f32 v191, v60, v172
    v_fmac_f32 v191, v61, v173
    v_fmac_f32 v191, v62, v174
    v_fmac_f32 v191, v63, v175
    v_mfma_f32_32x32x16_bf16 v[48:63], v[68:71], v[180:183], 0
    ds_read_b64_tr_b16 v[180:181], v235 offset:6144
    ds_read_b64_tr_b16 v[182:183], v235 offset:7168
    s_waitcnt lgkmcnt(4)
    v_mfma_f32_32x32x16_bf16 v[0:15], v[72:75], v[176:179], v[0:15]
    v_mfma_f32_32x32x16_bf16 v[16:31], v[76:79], v[176:179], v[16:31]
    s_add_u32 m0, s25, 6144
    s_waitcnt vmcnt(4) lgkmcnt(0)
    buffer_load_dwordx4 v226, s[4:7], s34 offen lds
    ds_read_b64_tr_b16 v[176:177], v234 offset:0
    v_mfma_f32_32x32x16_bf16 v[32:47], v[72:75], v[180:183], v[32:47]
    v_add_u32 v244, s41, v239
    ds_read_u16 v226, v244
    ds_read_u16 v227, v244 offset:64
    v_mfma_f32_32x32x16_bf16 v[48:63], v[76:79], v[180:183], v[48:63]
    ds_read_b64_tr_b16 v[180:181], v235 offset:0
    s_waitcnt lgkmcnt(3)
    v_mfma_f32_32x32x8_bf16 v[0:15], v[80:81], v[176:177], v[0:15]
    v_mfma_f32_32x32x8_bf16 v[16:31], v[84:85], v[176:177], v[16:31]
    v_lshl_add_u32 v222, v222, 10, v236
    v_lshl_add_u32 v223, v223, 10, v236
    s_add_u32 m0, s25, 0
    s_waitcnt vmcnt(3) lgkmcnt(0)
    buffer_load_dwordx4 v222, s[4:7], s35 offen lds
    buffer_load_dwordx4 v223, s[8:11], s35 offen offset:1024 lds
    ds_read_b64_tr_b16 v[176:177], v234 offset:2048
    ds_read_b64_tr_b16 v[178:179], v234 offset:3072
    v_mfma_f32_32x32x8_bf16 v[32:47], v[80:81], v[180:181], v[32:47]
    v_mfma_f32_32x32x8_bf16 v[48:63], v[84:85], v[180:181], v[48:63]
    ds_read_b64_tr_b16 v[180:181], v235 offset:2048
    ds_read_b64_tr_b16 v[182:183], v235 offset:3072
    v_mul_f32 v246, v0, v144
    v_fmac_f32 v246, v1, v145
    v_fmac_f32 v246, v2, v146
    v_fmac_f32 v246, v3, v147
    v_fmac_f32 v246, v4, v148
    v_fmac_f32 v246, v5, v149
    v_fmac_f32 v246, v6, v150
    v_fmac_f32 v246, v7, v151
    v_fmac_f32 v188, v8, v160
    v_fmac_f32 v188, v9, v161
    v_fmac_f32 v188, v10, v162
    v_fmac_f32 v188, v11, v163
    v_fmac_f32 v188, v12, v164
    v_fmac_f32 v188, v13, v165
    v_fmac_f32 v188, v14, v166
    v_fmac_f32 v188, v15, v167
    s_waitcnt lgkmcnt(2)
    v_mfma_f32_32x32x16_bf16 v[0:15], v[64:67], v[176:179], 0
    v_permlane32_swap_b32 v184, v246
    v_fmac_f32 v186, v16, v112
    v_fmac_f32 v186, v17, v113
    v_fmac_f32 v186, v18, v114
    v_fmac_f32 v186, v19, v115
    v_fmac_f32 v186, v20, v116
    v_fmac_f32 v186, v21, v117
    v_fmac_f32 v186, v22, v118
    v_fmac_f32 v186, v23, v119
    v_add_f32 v246, v184, v246
    v_mul_f32_e64 v184, v24, -v160
    v_fma_f32 v184, v25, -v161, v184
    v_fma_f32 v184, v26, -v162, v184
    v_fma_f32 v184, v27, -v163, v184
    v_fma_f32 v184, v28, -v164, v184
    v_fma_f32 v184, v29, -v165, v184
    v_fma_f32 v184, v30, -v166, v184
    v_fma_f32 v184, v31, -v167, v184
    v_mfma_f32_32x32x16_bf16 v[16:31], v[68:71], v[176:179], 0
    v_lshl_add_u32 v224, v224, 10, v236
    v_lshl_add_u32 v225, v225, 10, v236
    s_add_u32 m0, s25, 2048
    s_waitcnt vmcnt(3) lgkmcnt(0)
    buffer_load_dwordx4 v224, s[4:7], s36 offen lds
    buffer_load_dwordx4 v225, s[8:11], s36 offen offset:1024 lds
    ds_read_b64_tr_b16 v[176:177], v234 offset:4096
    ds_read_b64_tr_b16 v[178:179], v234 offset:5120
    v_mul_f32 v247, v32, v152
    v_fmac_f32 v247, v33, v153
    v_fmac_f32 v247, v34, v154
    v_fmac_f32 v247, v35, v155
    v_fmac_f32 v247, v36, v156
    v_fmac_f32 v247, v37, v157
    v_fmac_f32 v247, v38, v158
    v_fmac_f32 v247, v39, v159
    v_fmac_f32 v189, v40, v168
    v_fmac_f32 v189, v41, v169
    v_fmac_f32 v189, v42, v170
    v_fmac_f32 v189, v43, v171
    v_fmac_f32 v189, v44, v172
    v_fmac_f32 v189, v45, v173
    v_fmac_f32 v189, v46, v174
    v_fmac_f32 v189, v47, v175
    v_mfma_f32_32x32x16_bf16 v[32:47], v[64:67], v[180:183], 0
    v_permlane32_swap_b32 v185, v247
    v_fmac_f32 v187, v48, v120
    v_fmac_f32 v187, v49, v121
    v_fmac_f32 v187, v50, v122
    v_fmac_f32 v187, v51, v123
    v_fmac_f32 v187, v52, v124
    v_fmac_f32 v187, v53, v125
    v_fmac_f32 v187, v54, v126
    v_fmac_f32 v187, v55, v127
    v_add_f32 v247, v185, v247
    v_mul_f32_e64 v185, v56, -v168
    v_fma_f32 v185, v57, -v169, v185
    v_fma_f32 v185, v58, -v170, v185
    v_fma_f32 v185, v59, -v171, v185
    v_fma_f32 v185, v60, -v172, v185
    v_fma_f32 v185, v61, -v173, v185
    v_fma_f32 v185, v62, -v174, v185
    v_fma_f32 v185, v63, -v175, v185
    v_mfma_f32_32x32x16_bf16 v[48:63], v[68:71], v[180:183], 0
    ds_read_b64_tr_b16 v[180:181], v235 offset:4096
    ds_read_b64_tr_b16 v[182:183], v235 offset:5120
    s_set_gpr_idx_on s48, gpr_idx(DST)
    s_nop 0
    v_cvt_pk_bf16_f32 v194, v246, v247
    s_set_gpr_idx_off
    s_waitcnt lgkmcnt(2)
    v_mfma_f32_32x32x16_bf16 v[0:15], v[72:75], v[176:179], v[0:15]
    v_mfma_f32_32x32x16_bf16 v[16:31], v[76:79], v[176:179], v[16:31]
    v_lshl_add_u32 v226, v226, 10, v236
    v_lshl_add_u32 v227, v227, 10, v236
    s_add_u32 m0, s25, 4096
    s_waitcnt vmcnt(4) lgkmcnt(0)
    buffer_load_dwordx4 v226, s[4:7], s37 offen lds
    buffer_load_dwordx4 v227, s[8:11], s37 offen offset:1024 lds
    ds_read_b64_tr_b16 v[176:177], v234 offset:6144
    v_mfma_f32_32x32x16_bf16 v[32:47], v[72:75], v[180:183], v[32:47]
    v_mfma_f32_32x32x16_bf16 v[48:63], v[76:79], v[180:183], v[48:63]
    ds_read_b64_tr_b16 v[180:181], v235 offset:6144
    s_waitcnt lgkmcnt(1)
    v_mfma_f32_32x32x8_bf16 v[0:15], v[80:81], v[176:177], v[0:15]
    v_mfma_f32_32x32x8_bf16 v[16:31], v[84:85], v[176:177], v[16:31]
    v_lshl_add_u32 v228, v228, 10, v236
    v_lshl_add_u32 v229, v229, 10, v236
    s_add_u32 m0, s25, 6144
    s_waitcnt vmcnt(4) lgkmcnt(0)
    buffer_load_dwordx4 v228, s[4:7], s38 offen lds
    buffer_load_dwordx4 v229, s[8:11], s38 offen offset:1024 lds
    ds_read_b64_tr_b16 v[176:177], v234 offset:0
    ds_read_b64_tr_b16 v[178:179], v234 offset:1024
    v_mfma_f32_32x32x8_bf16 v[32:47], v[80:81], v[180:181], v[32:47]
    v_mfma_f32_32x32x8_bf16 v[48:63], v[84:85], v[180:181], v[48:63]
    ds_read_b64_tr_b16 v[180:181], v235 offset:0
    ds_read_b64_tr_b16 v[182:183], v235 offset:1024
    v_add_u32 v241, s45, v237
    v_add_u32 v242, s39, v238
    ds_read_b32 v252, v251 offset:16
    ds_read_b64_tr_b16 v[68:69], v241 offset:0
    ds_read_b64_tr_b16 v[70:71], v241 offset:256
    s_mov_b64 exec, s[50:51]
    ds_read_u16_d16_hi v230, v242 offset:0
    s_mov_b64 exec, -1
    v_mul_f32 v246, v0, v144
    v_fmac_f32 v246, v1, v145
    v_fmac_f32 v246, v2, v146
    v_fmac_f32 v246, v3, v147
    v_fmac_f32 v246, v4, v148
    v_fmac_f32 v246, v5, v149
    v_fmac_f32 v246, v6, v150
    v_fmac_f32 v246, v7, v151
    v_fma_f32 v190, v8, -v160, v190
    v_fma_f32 v190, v9, -v161, v190
    v_fma_f32 v190, v10, -v162, v190
    v_fma_f32 v190, v11, -v163, v190
    v_fma_f32 v190, v12, -v164, v190
    v_fma_f32 v190, v13, -v165, v190
    v_fma_f32 v190, v14, -v166, v190
    v_fma_f32 v190, v15, -v167, v190
    v_fmac_f32 v184, v16, v160
    v_fmac_f32 v184, v17, v161
    v_fmac_f32 v184, v18, v162
    v_fmac_f32 v184, v19, v163
    v_fmac_f32 v184, v20, v164
    v_fmac_f32 v184, v21, v165
    v_fmac_f32 v184, v22, v166
    v_fmac_f32 v184, v23, v167
    v_fmac_f32 v186, v24, v112
    v_fmac_f32 v186, v25, v113
    v_fmac_f32 v186, v26, v114
    v_fmac_f32 v186, v27, v115
    v_fmac_f32 v186, v28, v116
    v_fmac_f32 v186, v29, v117
    v_fmac_f32 v186, v30, v118
    v_fmac_f32 v186, v31, v119
    v_mul_f32 v247, v32, v152
    v_fmac_f32 v247, v33, v153
    v_fmac_f32 v247, v34, v154
    v_fmac_f32 v247, v35, v155
    v_fmac_f32 v247, v36, v156
    v_fmac_f32 v247, v37, v157
    v_fmac_f32 v247, v38, v158
    v_fmac_f32 v247, v39, v159
    v_fma_f32 v191, v40, -v168, v191
    v_fma_f32 v191, v41, -v169, v191
    v_fma_f32 v191, v42, -v170, v191
    v_fma_f32 v191, v43, -v171, v191
    v_fma_f32 v191, v44, -v172, v191
    v_fma_f32 v191, v45, -v173, v191
    v_fma_f32 v191, v46, -v174, v191
    v_fma_f32 v191, v47, -v175, v191
    v_fmac_f32 v185, v48, v168
    v_fmac_f32 v185, v49, v169
    v_fmac_f32 v185, v50, v170
    v_fmac_f32 v185, v51, v171
    v_fmac_f32 v185, v52, v172
    v_fmac_f32 v185, v53, v173
    v_fmac_f32 v185, v54, v174
    v_fmac_f32 v185, v55, v175
    v_fmac_f32 v187, v56, v120
    v_fmac_f32 v187, v57, v121
    v_fmac_f32 v187, v58, v122
    v_fmac_f32 v187, v59, v123
    v_fmac_f32 v187, v60, v124
    v_fmac_f32 v187, v61, v125
    v_fmac_f32 v187, v62, v126
    v_fmac_f32 v187, v63, v127
    s_nop 0
    v_permlane32_swap_b32 v246, v188
    v_permlane32_swap_b32 v190, v244
    v_permlane32_swap_b32 v186, v184
    v_permlane32_swap_b32 v247, v189
    v_permlane32_swap_b32 v191, v245
    v_permlane32_swap_b32 v187, v185
    v_add_f32 v188, v246, v188
    v_add_f32 v244, v190, v244
    v_add_f32 v184, v186, v184
    v_add_f32 v189, v247, v189
    v_add_f32 v245, v191, v245
    v_add_f32 v185, v187, v185
    s_set_gpr_idx_on s48, gpr_idx(DST)
    s_nop 0
    v_cvt_pk_bf16_f32 v195, v188, v189
    v_cvt_pk_bf16_f32 v197, v244, v245
    v_cvt_pk_bf16_f32 v196, v184, v185
    s_set_gpr_idx_off
    s_branch NEXT_0
.p2align 6
ITEM_0_6:
    ds_read_b64_tr_b16 v[76:77], v241 offset:512
    ds_read_b64_tr_b16 v[78:79], v241 offset:768
    ds_read_b64_tr_b16 v[84:85], v241 offset:1024
    ds_read_b64_tr_b16 v[86:87], v241 offset:1280
    s_mov_b64 exec, s[50:51]
    ds_read_u16_d16_hi v231, v242 offset:128
    ds_read_u16_d16_hi v232, v242 offset:256
    s_mov_b64 exec, -1
    v_add_u32 v244, s42, v239
    ds_read_u16 v228, v244
    ds_read_u16 v229, v244 offset:64
    v_add_u32 v245, s45, v248
    ds_read_b32 v246, v245
    ds_read_b32 v247, v245 offset:1024
    s_waitcnt lgkmcnt(10)
    v_lshlrev_b32 v184, 16, v68
    v_and_b32 v185, 0xffff0000, v68
    v_lshlrev_b32 v186, 16, v69
    v_and_b32 v187, 0xffff0000, v69
    v_mul_f32_dpp v188, v230, v184 row_newbcast:0 row_mask:0xf bank_mask:0xf
    v_mul_f32_dpp v189, v230, v185 row_newbcast:1 row_mask:0xf bank_mask:0xf
    v_mul_f32_dpp v190, v230, v184 row_newbcast:8 row_mask:0xf bank_mask:0xf
    v_mul_f32_dpp v191, v230, v185 row_newbcast:9 row_mask:0xf bank_mask:0xf
    v_lshlrev_b32 v184, 16, v70
    v_and_b32 v185, 0xffff0000, v70
    v_cvt_pk_bf16_f32 v64, v188, v189
    v_cvt_pk_bf16_f32 v68, v190, v191
    v_mul_f32_dpp v188, v230, v186 row_newbcast:2 row_mask:0xf bank_mask:0xf
    v_mul_f32_dpp v189, v230, v187 row_newbcast:3 row_mask:0xf bank_mask:0xf
    v_mul_f32_dpp v190, v230, v186 row_newbcast:10 row_mask:0xf bank_mask:0xf
    v_mul_f32_dpp v191, v230, v187 row_newbcast:11 row_mask:0xf bank_mask:0xf
    v_lshlrev_b32 v186, 16, v71
    v_and_b32 v187, 0xffff0000, v71
    v_cvt_pk_bf16_f32 v65, v188, v189
    v_cvt_pk_bf16_f32 v69, v190, v191
    v_mul_f32_dpp v188, v230, v184 row_newbcast:4 row_mask:0xf bank_mask:0xf
    v_mul_f32_dpp v189, v230, v185 row_newbcast:5 row_mask:0xf bank_mask:0xf
    v_mul_f32_dpp v190, v230, v184 row_newbcast:12 row_mask:0xf bank_mask:0xf
    v_mul_f32_dpp v191, v230, v185 row_newbcast:13 row_mask:0xf bank_mask:0xf
    v_cvt_pk_bf16_f32 v66, v188, v189
    v_cvt_pk_bf16_f32 v70, v190, v191
    v_mul_f32_dpp v188, v230, v186 row_newbcast:6 row_mask:0xf bank_mask:0xf
    v_mul_f32_dpp v189, v230, v187 row_newbcast:7 row_mask:0xf bank_mask:0xf
    v_mul_f32_dpp v190, v230, v186 row_newbcast:14 row_mask:0xf bank_mask:0xf
    v_mul_f32_dpp v191, v230, v187 row_newbcast:15 row_mask:0xf bank_mask:0xf
    v_cvt_pk_bf16_f32 v67, v188, v189
    v_cvt_pk_bf16_f32 v71, v190, v191
    s_nop 0
    s_waitcnt lgkmcnt(4)
    v_mfma_f32_32x32x16_bf16 v[0:15], v[64:67], v[176:179], 0
    v_lshlrev_b32 v184, 16, v76
    v_and_b32 v185, 0xffff0000, v76
    v_lshlrev_b32 v186, 16, v77
    v_and_b32 v187, 0xffff0000, v77
    v_mul_f32_dpp v188, v231, v184 row_newbcast:0 row_mask:0xf bank_mask:0xf
    v_mul_f32_dpp v189, v231, v185 row_newbcast:1 row_mask:0xf bank_mask:0xf
    v_mul_f32_dpp v190, v231, v184 row_newbcast:8 row_mask:0xf bank_mask:0xf
    v_mul_f32_dpp v191, v231, v185 row_newbcast:9 row_mask:0xf bank_mask:0xf
    v_mfma_f32_32x32x16_bf16 v[16:31], v[68:71], v[176:179], 0
    s_add_u32 m0, s25, 0
    s_waitcnt vmcnt(4)
    buffer_load_dwordx4 v224, s[4:7], s32 offen lds
    buffer_load_dwordx4 v225, s[8:11], s32 offen offset:1024 lds
    ds_read_b64_tr_b16 v[176:177], v234 offset:2048
    ds_read_b64_tr_b16 v[178:179], v234 offset:3072
    s_waitcnt lgkmcnt(2)
    v_lshl_add_u32 v246, v246, 5, v249
    v_lshl_add_u32 v247, v247, 5, v249
    s_mov_b32 m0, s56
    s_mov_b64 exec, s[52:53]
    buffer_load_dwordx4 v246, s[12:15], 0 offen  lds
    s_mov_b32 m0, s57
    s_mov_b64 exec, s[54:55]
    buffer_load_dwordx4 v247, s[12:15], 0 offen  lds
    s_mov_b64 exec, -1
    v_lshlrev_b32 v184, 16, v78
    v_and_b32 v185, 0xffff0000, v78
    v_cvt_pk_bf16_f32 v72, v188, v189
    v_cvt_pk_bf16_f32 v76, v190, v191
    v_mul_f32_dpp v188, v231, v186 row_newbcast:2 row_mask:0xf bank_mask:0xf
    v_mul_f32_dpp v189, v231, v187 row_newbcast:3 row_mask:0xf bank_mask:0xf
    v_mul_f32_dpp v190, v231, v186 row_newbcast:10 row_mask:0xf bank_mask:0xf
    v_mul_f32_dpp v191, v231, v187 row_newbcast:11 row_mask:0xf bank_mask:0xf
    v_mfma_f32_32x32x16_bf16 v[32:47], v[64:67], v[180:183], 0
    v_lshlrev_b32 v186, 16, v79
    v_and_b32 v187, 0xffff0000, v79
    v_cvt_pk_bf16_f32 v73, v188, v189
    v_cvt_pk_bf16_f32 v77, v190, v191
    v_mul_f32_dpp v188, v231, v184 row_newbcast:4 row_mask:0xf bank_mask:0xf
    v_mul_f32_dpp v189, v231, v185 row_newbcast:5 row_mask:0xf bank_mask:0xf
    v_mul_f32_dpp v190, v231, v184 row_newbcast:12 row_mask:0xf bank_mask:0xf
    v_mul_f32_dpp v191, v231, v185 row_newbcast:13 row_mask:0xf bank_mask:0xf
    v_mfma_f32_32x32x16_bf16 v[48:63], v[68:71], v[180:183], 0
    ds_read_b64_tr_b16 v[180:181], v235 offset:2048
    ds_read_b64_tr_b16 v[182:183], v235 offset:3072
    v_cvt_pk_bf16_f32 v74, v188, v189
    v_cvt_pk_bf16_f32 v78, v190, v191
    v_mul_f32_dpp v188, v231, v186 row_newbcast:6 row_mask:0xf bank_mask:0xf
    v_mul_f32_dpp v189, v231, v187 row_newbcast:7 row_mask:0xf bank_mask:0xf
    v_mul_f32_dpp v190, v231, v186 row_newbcast:14 row_mask:0xf bank_mask:0xf
    v_mul_f32_dpp v191, v231, v187 row_newbcast:15 row_mask:0xf bank_mask:0xf
    v_cvt_pk_bf16_f32 v75, v188, v189
    v_cvt_pk_bf16_f32 v79, v190, v191
    s_nop 0
    s_waitcnt lgkmcnt(2)
    v_mfma_f32_32x32x16_bf16 v[0:15], v[72:75], v[176:179], v[0:15]
    v_lshlrev_b32 v184, 16, v84
    v_and_b32 v185, 0xffff0000, v84
    v_lshlrev_b32 v186, 16, v85
    v_and_b32 v187, 0xffff0000, v85
    v_mul_f32_dpp v188, v232, v184 row_newbcast:0 row_mask:0xf bank_mask:0xf
    v_mul_f32_dpp v189, v232, v185 row_newbcast:1 row_mask:0xf bank_mask:0xf
    v_mul_f32_dpp v190, v232, v184 row_newbcast:8 row_mask:0xf bank_mask:0xf
    v_mul_f32_dpp v191, v232, v185 row_newbcast:9 row_mask:0xf bank_mask:0xf
    v_mfma_f32_32x32x16_bf16 v[16:31], v[76:79], v[176:179], v[16:31]
    s_add_u32 m0, s25, 2048
    s_waitcnt vmcnt(6) lgkmcnt(0)
    buffer_load_dwordx4 v226, s[4:7], s32 offen lds
    buffer_load_dwordx4 v227, s[8:11], s32 offen offset:1024 lds
    ds_read_b64_tr_b16 v[176:177], v234 offset:4096
    ds_read_b64_tr_b16 v[178:179], v234 offset:5120
    v_lshlrev_b32 v184, 16, v86
    v_and_b32 v185, 0xffff0000, v86
    v_cvt_pk_bf16_f32 v80, v188, v189
    v_cvt_pk_bf16_f32 v84, v190, v191
    v_mul_f32_dpp v188, v232, v186 row_newbcast:2 row_mask:0xf bank_mask:0xf
    v_mul_f32_dpp v189, v232, v187 row_newbcast:3 row_mask:0xf bank_mask:0xf
    v_mul_f32_dpp v190, v232, v186 row_newbcast:10 row_mask:0xf bank_mask:0xf
    v_mul_f32_dpp v191, v232, v187 row_newbcast:11 row_mask:0xf bank_mask:0xf
    v_mfma_f32_32x32x16_bf16 v[32:47], v[72:75], v[180:183], v[32:47]
    v_lshlrev_b32 v186, 16, v87
    v_and_b32 v187, 0xffff0000, v87
    v_cvt_pk_bf16_f32 v81, v188, v189
    v_cvt_pk_bf16_f32 v85, v190, v191
    v_mul_f32_dpp v188, v232, v184 row_newbcast:4 row_mask:0xf bank_mask:0xf
    v_mul_f32_dpp v189, v232, v185 row_newbcast:5 row_mask:0xf bank_mask:0xf
    v_mul_f32_dpp v190, v232, v184 row_newbcast:12 row_mask:0xf bank_mask:0xf
    v_mul_f32_dpp v191, v232, v185 row_newbcast:13 row_mask:0xf bank_mask:0xf
    v_mfma_f32_32x32x16_bf16 v[48:63], v[76:79], v[180:183], v[48:63]
    ds_read_b64_tr_b16 v[180:181], v235 offset:4096
    ds_read_b64_tr_b16 v[182:183], v235 offset:5120
    v_cvt_pk_bf16_f32 v82, v188, v189
    v_cvt_pk_bf16_f32 v86, v190, v191
    v_mul_f32_dpp v188, v232, v186 row_newbcast:6 row_mask:0xf bank_mask:0xf
    v_mul_f32_dpp v189, v232, v187 row_newbcast:7 row_mask:0xf bank_mask:0xf
    v_mul_f32_dpp v190, v232, v186 row_newbcast:14 row_mask:0xf bank_mask:0xf
    v_mul_f32_dpp v191, v232, v187 row_newbcast:15 row_mask:0xf bank_mask:0xf
    v_cvt_pk_bf16_f32 v83, v188, v189
    v_cvt_pk_bf16_f32 v87, v190, v191
    s_nop 0
    s_waitcnt lgkmcnt(2)
    v_mfma_f32_32x32x16_bf16 v[0:15], v[80:83], v[176:179], v[0:15]
    v_mfma_f32_32x32x16_bf16 v[16:31], v[84:87], v[176:179], v[16:31]
    s_add_u32 m0, s25, 4096
    s_waitcnt vmcnt(6) lgkmcnt(0)
    buffer_load_dwordx4 v222, s[4:7], s33 offen lds
    buffer_load_dwordx4 v223, s[8:11], s33 offen offset:1024 lds
    ds_read_b64_tr_b16 v[176:177], v234 offset:6144
    ds_read_b64_tr_b16 v[178:179], v234 offset:7168
    v_mfma_f32_32x32x16_bf16 v[32:47], v[80:83], v[180:183], v[32:47]
    v_mfma_f32_32x32x16_bf16 v[48:63], v[84:87], v[180:183], v[48:63]
    ds_read_b64_tr_b16 v[180:181], v235 offset:6144
    ds_read_b64_tr_b16 v[182:183], v235 offset:7168
    s_nop 0
    v_mul_f32 v184, v0, v96
    v_fmac_f32 v184, v1, v97
    v_fmac_f32 v184, v2, v98
    v_fmac_f32 v184, v3, v99
    v_fmac_f32 v184, v4, v100
    v_fmac_f32 v184, v5, v101
    v_fmac_f32 v184, v6, v102
    v_fmac_f32 v184, v7, v103
    v_mul_f32 v186, v8, v128
    v_fmac_f32 v186, v9, v129
    v_fmac_f32 v186, v10, v130
    v_fmac_f32 v186, v11, v131
    v_fmac_f32 v186, v12, v132
    v_fmac_f32 v186, v13, v133
    v_fmac_f32 v186, v14, v134
    v_fmac_f32 v186, v15, v135
    s_waitcnt lgkmcnt(2)
    v_mfma_f32_32x32x16_bf16 v[0:15], v[64:67], v[176:179], 0
    v_mul_f32 v188, v16, v128
    v_fmac_f32 v188, v17, v129
    v_fmac_f32 v188, v18, v130
    v_fmac_f32 v188, v19, v131
    v_fmac_f32 v188, v20, v132
    v_fmac_f32 v188, v21, v133
    v_fmac_f32 v188, v22, v134
    v_fmac_f32 v188, v23, v135
    v_mul_f32 v190, v24, v128
    v_fmac_f32 v190, v25, v129
    v_fmac_f32 v190, v26, v130
    v_fmac_f32 v190, v27, v131
    v_fmac_f32 v190, v28, v132
    v_fmac_f32 v190, v29, v133
    v_fmac_f32 v190, v30, v134
    v_fmac_f32 v190, v31, v135
    v_mfma_f32_32x32x16_bf16 v[16:31], v[68:71], v[176:179], 0
    s_add_u32 m0, s25, 6144
    s_waitcnt vmcnt(6) lgkmcnt(0)
    buffer_load_dwordx4 v224, s[4:7], s33 offen lds
    buffer_load_dwordx4 v225, s[8:11], s33 offen offset:1024 lds
    ds_read_b64_tr_b16 v[176:177], v234 offset:0
    ds_read_b64_tr_b16 v[178:179], v234 offset:1024
    v_mul_f32 v185, v32, v104
    v_fmac_f32 v185, v33, v105
    v_fmac_f32 v185, v34, v106
    v_fmac_f32 v185, v35, v107
    v_fmac_f32 v185, v36, v108
    v_fmac_f32 v185, v37, v109
    v_fmac_f32 v185, v38, v110
    v_fmac_f32 v185, v39, v111
    v_mul_f32 v187, v40, v136
    v_fmac_f32 v187, v41, v137
    v_fmac_f32 v187, v42, v138
    v_fmac_f32 v187, v43, v139
    v_fmac_f32 v187, v44, v140
    v_fmac_f32 v187, v45, v141
    v_fmac_f32 v187, v46, v142
    v_fmac_f32 v187, v47, v143
    v_mfma_f32_32x32x16_bf16 v[32:47], v[64:67], v[180:183], 0
    v_mul_f32 v189, v48, v136
    v_fmac_f32 v189, v49, v137
    v_fmac_f32 v189, v50, v138
    v_fmac_f32 v189, v51, v139
    v_fmac_f32 v189, v52, v140
    v_fmac_f32 v189, v53, v141
    v_fmac_f32 v189, v54, v142
    v_fmac_f32 v189, v55, v143
    v_mul_f32 v191, v56, v136
    v_fmac_f32 v191, v57, v137
    v_fmac_f32 v191, v58, v138
    v_fmac_f32 v191, v59, v139
    v_fmac_f32 v191, v60, v140
    v_fmac_f32 v191, v61, v141
    v_fmac_f32 v191, v62, v142
    v_fmac_f32 v191, v63, v143
    v_mfma_f32_32x32x16_bf16 v[48:63], v[68:71], v[180:183], 0
    ds_read_b64_tr_b16 v[180:181], v235 offset:0
    ds_read_b64_tr_b16 v[182:183], v235 offset:1024
    v_permlane32_swap_b32 v184, v186
    v_permlane32_swap_b32 v188, v190
    v_permlane32_swap_b32 v185, v187
    v_permlane32_swap_b32 v189, v191
    v_add_f32 v186, v184, v186
    v_add_f32 v190, v188, v190
    v_add_f32 v187, v185, v187
    v_add_f32 v191, v189, v191
    s_set_gpr_idx_on s48, gpr_idx(DST)
    s_nop 0
    v_cvt_pk_bf16_f32 v192, v186, v187
    v_cvt_pk_bf16_f32 v193, v190, v191
    s_set_gpr_idx_off
    s_waitcnt lgkmcnt(2)
    v_mfma_f32_32x32x16_bf16 v[0:15], v[72:75], v[176:179], v[0:15]
    v_mfma_f32_32x32x16_bf16 v[16:31], v[76:79], v[176:179], v[16:31]
    s_add_u32 m0, s25, 0
    s_waitcnt vmcnt(4) lgkmcnt(0)
    buffer_load_dwordx4 v226, s[4:7], s33 offen lds
    buffer_load_dwordx4 v227, s[8:11], s33 offen offset:1024 lds
    ds_read_b64_tr_b16 v[176:177], v234 offset:2048
    ds_read_b64_tr_b16 v[178:179], v234 offset:3072
    v_mfma_f32_32x32x16_bf16 v[32:47], v[72:75], v[180:183], v[32:47]
    v_mfma_f32_32x32x16_bf16 v[48:63], v[76:79], v[180:183], v[48:63]
    ds_read_b64_tr_b16 v[180:181], v235 offset:2048
    ds_read_b64_tr_b16 v[182:183], v235 offset:3072
    s_waitcnt lgkmcnt(2)
    v_mfma_f32_32x32x16_bf16 v[0:15], v[80:83], v[176:179], v[0:15]
    v_mfma_f32_32x32x16_bf16 v[16:31], v[84:87], v[176:179], v[16:31]
    s_add_u32 m0, s25, 2048
    s_waitcnt vmcnt(4) lgkmcnt(0)
    buffer_load_dwordx4 v222, s[4:7], s34 offen lds
    buffer_load_dwordx4 v223, s[8:11], s34 offen offset:1024 lds
    ds_read_b64_tr_b16 v[176:177], v234 offset:4096
    ds_read_b64_tr_b16 v[178:179], v234 offset:5120
    v_mfma_f32_32x32x16_bf16 v[32:47], v[80:83], v[180:183], v[32:47]
    v_add_u32 v244, s39, v239
    ds_read_u16 v222, v244
    ds_read_u16 v223, v244 offset:64
    v_mfma_f32_32x32x16_bf16 v[48:63], v[84:87], v[180:183], v[48:63]
    ds_read_b64_tr_b16 v[180:181], v235 offset:4096
    ds_read_b64_tr_b16 v[182:183], v235 offset:5120
    v_mul_f32 v184, v0, v144
    v_fmac_f32 v184, v1, v145
    v_fmac_f32 v184, v2, v146
    v_fmac_f32 v184, v3, v147
    v_fmac_f32 v184, v4, v148
    v_fmac_f32 v184, v5, v149
    v_fmac_f32 v184, v6, v150
    v_fmac_f32 v184, v7, v151
    v_mul_f32 v186, v8, v112
    v_fmac_f32 v186, v9, v113
    v_fmac_f32 v186, v10, v114
    v_fmac_f32 v186, v11, v115
    v_fmac_f32 v186, v12, v116
    v_fmac_f32 v186, v13, v117
    v_fmac_f32 v186, v14, v118
    v_fmac_f32 v186, v15, v119
    s_waitcnt lgkmcnt(4)
    v_mfma_f32_32x32x16_bf16 v[0:15], v[64:67], v[176:179], 0
    v_mul_f32_e64 v188, v16, -v160
    v_fma_f32 v188, v17, -v161, v188
    v_fma_f32 v188, v18, -v162, v188
    v_fma_f32 v188, v19, -v163, v188
    v_fma_f32 v188, v20, -v164, v188
    v_fma_f32 v188, v21, -v165, v188
    v_fma_f32 v188, v22, -v166, v188
    v_fma_f32 v188, v23, -v167, v188
    v_mul_f32 v190, v24, v160
    v_fmac_f32 v190, v25, v161
    v_fmac_f32 v190, v26, v162
    v_fmac_f32 v190, v27, v163
    v_fmac_f32 v190, v28, v164
    v_fmac_f32 v190, v29, v165
    v_fmac_f32 v190, v30, v166
    v_fmac_f32 v190, v31, v167
    v_mfma_f32_32x32x16_bf16 v[16:31], v[68:71], v[176:179], 0
    s_add_u32 m0, s25, 4096
    s_waitcnt vmcnt(4) lgkmcnt(0)
    buffer_load_dwordx4 v224, s[4:7], s34 offen lds
    buffer_load_dwordx4 v225, s[8:11], s34 offen offset:1024 lds
    ds_read_b64_tr_b16 v[176:177], v234 offset:6144
    ds_read_b64_tr_b16 v[178:179], v234 offset:7168
    v_mul_f32 v185, v32, v152
    v_fmac_f32 v185, v33, v153
    v_fmac_f32 v185, v34, v154
    v_fmac_f32 v185, v35, v155
    v_fmac_f32 v185, v36, v156
    v_fmac_f32 v185, v37, v157
    v_fmac_f32 v185, v38, v158
    v_fmac_f32 v185, v39, v159
    v_mul_f32 v187, v40, v120
    v_fmac_f32 v187, v41, v121
    v_fmac_f32 v187, v42, v122
    v_fmac_f32 v187, v43, v123
    v_fmac_f32 v187, v44, v124
    v_fmac_f32 v187, v45, v125
    v_fmac_f32 v187, v46, v126
    v_fmac_f32 v187, v47, v127
    v_mfma_f32_32x32x16_bf16 v[32:47], v[64:67], v[180:183], 0
    v_add_u32 v244, s40, v239
    ds_read_u16 v224, v244
    ds_read_u16 v225, v244 offset:64
    v_mul_f32_e64 v189, v48, -v168
    v_fma_f32 v189, v49, -v169, v189
    v_fma_f32 v189, v50, -v170, v189
    v_fma_f32 v189, v51, -v171, v189
    v_fma_f32 v189, v52, -v172, v189
    v_fma_f32 v189, v53, -v173, v189
    v_fma_f32 v189, v54, -v174, v189
    v_fma_f32 v189, v55, -v175, v189
    v_mul_f32 v191, v56, v168
    v_fmac_f32 v191, v57, v169
    v_fmac_f32 v191, v58, v170
    v_fmac_f32 v191, v59, v171
    v_fmac_f32 v191, v60, v172
    v_fmac_f32 v191, v61, v173
    v_fmac_f32 v191, v62, v174
    v_fmac_f32 v191, v63, v175
    v_mfma_f32_32x32x16_bf16 v[48:63], v[68:71], v[180:183], 0
    ds_read_b64_tr_b16 v[180:181], v235 offset:6144
    ds_read_b64_tr_b16 v[182:183], v235 offset:7168
    s_waitcnt lgkmcnt(4)
    v_mfma_f32_32x32x16_bf16 v[0:15], v[72:75], v[176:179], v[0:15]
    v_mfma_f32_32x32x16_bf16 v[16:31], v[76:79], v[176:179], v[16:31]
    s_add_u32 m0, s25, 6144
    s_waitcnt vmcnt(4) lgkmcnt(0)
    buffer_load_dwordx4 v226, s[4:7], s34 offen lds
    buffer_load_dwordx4 v227, s[8:11], s34 offen offset:1024 lds
    ds_read_b64_tr_b16 v[176:177], v234 offset:0
    ds_read_b64_tr_b16 v[178:179], v234 offset:1024
    v_mfma_f32_32x32x16_bf16 v[32:47], v[72:75], v[180:183], v[32:47]
    v_add_u32 v244, s41, v239
    ds_read_u16 v226, v244
    ds_read_u16 v227, v244 offset:64
    v_mfma_f32_32x32x16_bf16 v[48:63], v[76:79], v[180:183], v[48:63]
    ds_read_b64_tr_b16 v[180:181], v235 offset:0
    ds_read_b64_tr_b16 v[182:183], v235 offset:1024
    s_waitcnt lgkmcnt(4)
    v_mfma_f32_32x32x16_bf16 v[0:15], v[80:83], v[176:179], v[0:15]
    v_mfma_f32_32x32x16_bf16 v[16:31], v[84:87], v[176:179], v[16:31]
    v_lshl_add_u32 v222, v222, 10, v236
    v_lshl_add_u32 v223, v223, 10, v236
    s_add_u32 m0, s25, 0
    s_waitcnt vmcnt(4) lgkmcnt(0)
    buffer_load_dwordx4 v222, s[4:7], s35 offen lds
    buffer_load_dwordx4 v223, s[8:11], s35 offen offset:1024 lds
    ds_read_b64_tr_b16 v[176:177], v234 offset:2048
    ds_read_b64_tr_b16 v[178:179], v234 offset:3072
    v_mfma_f32_32x32x16_bf16 v[32:47], v[80:83], v[180:183], v[32:47]
    v_mfma_f32_32x32x16_bf16 v[48:63], v[84:87], v[180:183], v[48:63]
    ds_read_b64_tr_b16 v[180:181], v235 offset:2048
    ds_read_b64_tr_b16 v[182:183], v235 offset:3072
    v_mul_f32 v246, v0, v144
    v_fmac_f32 v246, v1, v145
    v_fmac_f32 v246, v2, v146
    v_fmac_f32 v246, v3, v147
    v_fmac_f32 v246, v4, v148
    v_fmac_f32 v246, v5, v149
    v_fmac_f32 v246, v6, v150
    v_fmac_f32 v246, v7, v151
    v_fmac_f32 v188, v8, v160
    v_fmac_f32 v188, v9, v161
    v_fmac_f32 v188, v10, v162
    v_fmac_f32 v188, v11, v163
    v_fmac_f32 v188, v12, v164
    v_fmac_f32 v188, v13, v165
    v_fmac_f32 v188, v14, v166
    v_fmac_f32 v188, v15, v167
    s_waitcnt lgkmcnt(2)
    v_mfma_f32_32x32x16_bf16 v[0:15], v[64:67], v[176:179], 0
    v_permlane32_swap_b32 v184, v246
    v_fmac_f32 v186, v16, v112
    v_fmac_f32 v186, v17, v113
    v_fmac_f32 v186, v18, v114
    v_fmac_f32 v186, v19, v115
    v_fmac_f32 v186, v20, v116
    v_fmac_f32 v186, v21, v117
    v_fmac_f32 v186, v22, v118
    v_fmac_f32 v186, v23, v119
    v_add_f32 v246, v184, v246
    v_mul_f32_e64 v184, v24, -v160
    v_fma_f32 v184, v25, -v161, v184
    v_fma_f32 v184, v26, -v162, v184
    v_fma_f32 v184, v27, -v163, v184
    v_fma_f32 v184, v28, -v164, v184
    v_fma_f32 v184, v29, -v165, v184
    v_fma_f32 v184, v30, -v166, v184
    v_fma_f32 v184, v31, -v167, v184
    v_mfma_f32_32x32x16_bf16 v[16:31], v[68:71], v[176:179], 0
    v_lshl_add_u32 v224, v224, 10, v236
    v_lshl_add_u32 v225, v225, 10, v236
    s_add_u32 m0, s25, 2048
    s_waitcnt vmcnt(4) lgkmcnt(0)
    buffer_load_dwordx4 v224, s[4:7], s36 offen lds
    buffer_load_dwordx4 v225, s[8:11], s36 offen offset:1024 lds
    ds_read_b64_tr_b16 v[176:177], v234 offset:4096
    ds_read_b64_tr_b16 v[178:179], v234 offset:5120
    v_mul_f32 v247, v32, v152
    v_fmac_f32 v247, v33, v153
    v_fmac_f32 v247, v34, v154
    v_fmac_f32 v247, v35, v155
    v_fmac_f32 v247, v36, v156
    v_fmac_f32 v247, v37, v157
    v_fmac_f32 v247, v38, v158
    v_fmac_f32 v247, v39, v159
    v_fmac_f32 v189, v40, v168
    v_fmac_f32 v189, v41, v169
    v_fmac_f32 v189, v42, v170
    v_fmac_f32 v189, v43, v171
    v_fmac_f32 v189, v44, v172
    v_fmac_f32 v189, v45, v173
    v_fmac_f32 v189, v46, v174
    v_fmac_f32 v189, v47, v175
    v_mfma_f32_32x32x16_bf16 v[32:47], v[64:67], v[180:183], 0
    v_permlane32_swap_b32 v185, v247
    v_fmac_f32 v187, v48, v120
    v_fmac_f32 v187, v49, v121
    v_fmac_f32 v187, v50, v122
    v_fmac_f32 v187, v51, v123
    v_fmac_f32 v187, v52, v124
    v_fmac_f32 v187, v53, v125
    v_fmac_f32 v187, v54, v126
    v_fmac_f32 v187, v55, v127
    v_add_f32 v247, v185, v247
    v_mul_f32_e64 v185, v56, -v168
    v_fma_f32 v185, v57, -v169, v185
    v_fma_f32 v185, v58, -v170, v185
    v_fma_f32 v185, v59, -v171, v185
    v_fma_f32 v185, v60, -v172, v185
    v_fma_f32 v185, v61, -v173, v185
    v_fma_f32 v185, v62, -v174, v185
    v_fma_f32 v185, v63, -v175, v185
    v_mfma_f32_32x32x16_bf16 v[48:63], v[68:71], v[180:183], 0
    ds_read_b64_tr_b16 v[180:181], v235 offset:4096
    ds_read_b64_tr_b16 v[182:183], v235 offset:5120
    s_set_gpr_idx_on s48, gpr_idx(DST)
    s_nop 0
    v_cvt_pk_bf16_f32 v194, v246, v247
    s_set_gpr_idx_off
    s_waitcnt lgkmcnt(2)
    v_mfma_f32_32x32x16_bf16 v[0:15], v[72:75], v[176:179], v[0:15]
    v_mfma_f32_32x32x16_bf16 v[16:31], v[76:79], v[176:179], v[16:31]
    v_lshl_add_u32 v226, v226, 10, v236
    v_lshl_add_u32 v227, v227, 10, v236
    s_add_u32 m0, s25, 4096
    s_waitcnt vmcnt(4) lgkmcnt(0)
    buffer_load_dwordx4 v226, s[4:7], s37 offen lds
    buffer_load_dwordx4 v227, s[8:11], s37 offen offset:1024 lds
    ds_read_b64_tr_b16 v[176:177], v234 offset:6144
    ds_read_b64_tr_b16 v[178:179], v234 offset:7168
    v_mfma_f32_32x32x16_bf16 v[32:47], v[72:75], v[180:183], v[32:47]
    v_mfma_f32_32x32x16_bf16 v[48:63], v[76:79], v[180:183], v[48:63]
    ds_read_b64_tr_b16 v[180:181], v235 offset:6144
    ds_read_b64_tr_b16 v[182:183], v235 offset:7168
    s_waitcnt lgkmcnt(2)
    v_mfma_f32_32x32x16_bf16 v[0:15], v[80:83], v[176:179], v[0:15]
    v_mfma_f32_32x32x16_bf16 v[16:31], v[84:87], v[176:179], v[16:31]
    v_lshl_add_u32 v228, v228, 10, v236
    v_lshl_add_u32 v229, v229, 10, v236
    s_add_u32 m0, s25, 6144
    s_waitcnt vmcnt(4) lgkmcnt(0)
    buffer_load_dwordx4 v228, s[4:7], s38 offen lds
    buffer_load_dwordx4 v229, s[8:11], s38 offen offset:1024 lds
    ds_read_b64_tr_b16 v[176:177], v234 offset:0
    ds_read_b64_tr_b16 v[178:179], v234 offset:1024
    v_mfma_f32_32x32x16_bf16 v[32:47], v[80:83], v[180:183], v[32:47]
    v_mfma_f32_32x32x16_bf16 v[48:63], v[84:87], v[180:183], v[48:63]
    ds_read_b64_tr_b16 v[180:181], v235 offset:0
    ds_read_b64_tr_b16 v[182:183], v235 offset:1024
    v_add_u32 v241, s45, v237
    v_add_u32 v242, s39, v238
    ds_read_b32 v252, v251 offset:16
    ds_read_b64_tr_b16 v[68:69], v241 offset:0
    ds_read_b64_tr_b16 v[70:71], v241 offset:256
    s_mov_b64 exec, s[50:51]
    ds_read_u16_d16_hi v230, v242 offset:0
    s_mov_b64 exec, -1
    v_mul_f32 v246, v0, v144
    v_fmac_f32 v246, v1, v145
    v_fmac_f32 v246, v2, v146
    v_fmac_f32 v246, v3, v147
    v_fmac_f32 v246, v4, v148
    v_fmac_f32 v246, v5, v149
    v_fmac_f32 v246, v6, v150
    v_fmac_f32 v246, v7, v151
    v_fma_f32 v190, v8, -v160, v190
    v_fma_f32 v190, v9, -v161, v190
    v_fma_f32 v190, v10, -v162, v190
    v_fma_f32 v190, v11, -v163, v190
    v_fma_f32 v190, v12, -v164, v190
    v_fma_f32 v190, v13, -v165, v190
    v_fma_f32 v190, v14, -v166, v190
    v_fma_f32 v190, v15, -v167, v190
    v_fmac_f32 v184, v16, v160
    v_fmac_f32 v184, v17, v161
    v_fmac_f32 v184, v18, v162
    v_fmac_f32 v184, v19, v163
    v_fmac_f32 v184, v20, v164
    v_fmac_f32 v184, v21, v165
    v_fmac_f32 v184, v22, v166
    v_fmac_f32 v184, v23, v167
    v_fmac_f32 v186, v24, v112
    v_fmac_f32 v186, v25, v113
    v_fmac_f32 v186, v26, v114
    v_fmac_f32 v186, v27, v115
    v_fmac_f32 v186, v28, v116
    v_fmac_f32 v186, v29, v117
    v_fmac_f32 v186, v30, v118
    v_fmac_f32 v186, v31, v119
    v_mul_f32 v247, v32, v152
    v_fmac_f32 v247, v33, v153
    v_fmac_f32 v247, v34, v154
    v_fmac_f32 v247, v35, v155
    v_fmac_f32 v247, v36, v156
    v_fmac_f32 v247, v37, v157
    v_fmac_f32 v247, v38, v158
    v_fmac_f32 v247, v39, v159
    v_fma_f32 v191, v40, -v168, v191
    v_fma_f32 v191, v41, -v169, v191
    v_fma_f32 v191, v42, -v170, v191
    v_fma_f32 v191, v43, -v171, v191
    v_fma_f32 v191, v44, -v172, v191
    v_fma_f32 v191, v45, -v173, v191
    v_fma_f32 v191, v46, -v174, v191
    v_fma_f32 v191, v47, -v175, v191
    v_fmac_f32 v185, v48, v168
    v_fmac_f32 v185, v49, v169
    v_fmac_f32 v185, v50, v170
    v_fmac_f32 v185, v51, v171
    v_fmac_f32 v185, v52, v172
    v_fmac_f32 v185, v53, v173
    v_fmac_f32 v185, v54, v174
    v_fmac_f32 v185, v55, v175
    v_fmac_f32 v187, v56, v120
    v_fmac_f32 v187, v57, v121
    v_fmac_f32 v187, v58, v122
    v_fmac_f32 v187, v59, v123
    v_fmac_f32 v187, v60, v124
    v_fmac_f32 v187, v61, v125
    v_fmac_f32 v187, v62, v126
    v_fmac_f32 v187, v63, v127
    s_nop 0
    v_permlane32_swap_b32 v246, v188
    v_permlane32_swap_b32 v190, v244
    v_permlane32_swap_b32 v186, v184
    v_permlane32_swap_b32 v247, v189
    v_permlane32_swap_b32 v191, v245
    v_permlane32_swap_b32 v187, v185
    v_add_f32 v188, v246, v188
    v_add_f32 v244, v190, v244
    v_add_f32 v184, v186, v184
    v_add_f32 v189, v247, v189
    v_add_f32 v245, v191, v245
    v_add_f32 v185, v187, v185
    s_set_gpr_idx_on s48, gpr_idx(DST)
    s_nop 0
    v_cvt_pk_bf16_f32 v195, v188, v189
    v_cvt_pk_bf16_f32 v197, v244, v245
    v_cvt_pk_bf16_f32 v196, v184, v185
    s_set_gpr_idx_off
    s_branch NEXT_0
.p2align 6
ITEM_0_3:
    ds_read_b64_tr_b16 v[76:77], v241 offset:512
    s_mov_b64 exec, s[50:51]
    ds_read_u16_d16_hi v231, v242 offset:128
    s_mov_b64 exec, -1
    v_add_u32 v244, s41, v239
    ds_read_u16 v226, v244
    ds_read_u16 v227, v244 offset:64
    v_add_u32 v244, s42, v239
    ds_read_u16 v228, v244
    ds_read_u16 v229, v244 offset:64
    v_add_u32 v245, s45, v248
    ds_read_b32 v246, v245
    ds_read_b32 v247, v245 offset:1024
    s_waitcnt lgkmcnt(8)
    v_lshlrev_b32 v184, 16, v68
    v_and_b32 v185, 0xffff0000, v68
    v_lshlrev_b32 v186, 16, v69
    v_and_b32 v187, 0xffff0000, v69
    v_mul_f32_dpp v188, v230, v184 row_newbcast:0 row_mask:0xf bank_mask:0xf
    v_mul_f32_dpp v189, v230, v185 row_newbcast:1 row_mask:0xf bank_mask:0xf
    v_mul_f32_dpp v190, v230, v184 row_newbcast:8 row_mask:0xf bank_mask:0xf
    v_mul_f32_dpp v191, v230, v185 row_newbcast:9 row_mask:0xf bank_mask:0xf
    v_lshlrev_b32 v184, 16, v70
    v_and_b32 v185, 0xffff0000, v70
    v_cvt_pk_bf16_f32 v64, v188, v189
    v_cvt_pk_bf16_f32 v68, v190, v191
    v_mul_f32_dpp v188, v230, v186 row_newbcast:2 row_mask:0xf bank_mask:0xf
    v_mul_f32_dpp v189, v230, v187 row_newbcast:3 row_mask:0xf bank_mask:0xf
    v_mul_f32_dpp v190, v230, v186 row_newbcast:10 row_mask:0xf bank_mask:0xf
    v_mul_f32_dpp v191, v230, v187 row_newbcast:11 row_mask:0xf bank_mask:0xf
    v_lshlrev_b32 v186, 16, v71
    v_and_b32 v187, 0xffff0000, v71
    v_cvt_pk_bf16_f32 v65, v188, v189
    v_cvt_pk_bf16_f32 v69, v190, v191
    v_mul_f32_dpp v188, v230, v184 row_newbcast:4 row_mask:0xf bank_mask:0xf
    v_mul_f32_dpp v189, v230, v185 row_newbcast:5 row_mask:0xf bank_mask:0xf
    v_mul_f32_dpp v190, v230, v184 row_newbcast:12 row_mask:0xf bank_mask:0xf
    v_mul_f32_dpp v191, v230, v185 row_newbcast:13 row_mask:0xf bank_mask:0xf
    v_cvt_pk_bf16_f32 v66, v188, v189
    v_cvt_pk_bf16_f32 v70, v190, v191
    v_mul_f32_dpp v188, v230, v186 row_newbcast:6 row_mask:0xf bank_mask:0xf
    v_mul_f32_dpp v189, v230, v187 row_newbcast:7 row_mask:0xf bank_mask:0xf
    v_mul_f32_dpp v190, v230, v186 row_newbcast:14 row_mask:0xf bank_mask:0xf
    v_mul_f32_dpp v191, v230, v187 row_newbcast:15 row_mask:0xf bank_mask:0xf
    v_cvt_pk_bf16_f32 v67, v188, v189
    v_cvt_pk_bf16_f32 v71, v190, v191
    s_nop 0
    s_waitcnt lgkmcnt(6)
    v_mfma_f32_32x32x16_bf16 v[0:15], v[64:67], v[176:179], 0
    v_lshlrev_b32 v184, 16, v76
    v_and_b32 v185, 0xffff0000, v76
    v_lshlrev_b32 v186, 16, v77
    v_and_b32 v187, 0xffff0000, v77
    v_mfma_f32_32x32x16_bf16 v[16:31], v[68:71], v[176:179], 0
    s_add_u32 m0, s25, 0
    s_waitcnt vmcnt(4)
    buffer_load_dwordx4 v222, s[4:7], s33 offen lds
    buffer_load_dwordx4 v223, s[8:11], s33 offen offset:1024 lds
    ds_read_b64_tr_b16 v[176:177], v234 offset:2048
    s_waitcnt lgkmcnt(1)
    v_lshl_add_u32 v246, v246, 5, v249
    v_lshl_add_u32 v247, v247, 5, v249
    s_mov_b32 m0, s56
    s_mov_b64 exec, s[52:53]
    buffer_load_dwordx4 v246, s[12:15], 0 offen  lds
    s_mov_b32 m0, s57
    s_mov_b64 exec, s[54:55]
    buffer_load_dwordx4 v247, s[12:15], 0 offen  lds
    s_mov_b64 exec, -1
    v_mul_f32_dpp v188, v231, v184 row_newbcast:0 row_mask:0xf bank_mask:0xf
    v_mul_f32_dpp v189, v231, v185 row_newbcast:1 row_mask:0xf bank_mask:0xf
    v_mul_f32_dpp v190, v231, v184 row_newbcast:8 row_mask:0xf bank_mask:0xf
    v_mul_f32_dpp v191, v231, v185 row_newbcast:9 row_mask:0xf bank_mask:0xf
    v_mfma_f32_32x32x16_bf16 v[32:47], v[64:67], v[180:183], 0
    v_cvt_pk_bf16_f32 v72, v188, v189
    v_cvt_pk_bf16_f32 v76, v190, v191
    v_mul_f32_dpp v188, v231, v186 row_newbcast:2 row_mask:0xf bank_mask:0xf
    v_mul_f32_dpp v189, v231, v187 row_newbcast:3 row_mask:0xf bank_mask:0xf
    v_mfma_f32_32x32x16_bf16 v[48:63], v[68:71], v[180:183], 0
    ds_read_b64_tr_b16 v[180:181], v235 offset:2048
    v_mul_f32_dpp v190, v231, v186 row_newbcast:10 row_mask:0xf bank_mask:0xf
    v_mul_f32_dpp v191, v231, v187 row_newbcast:11 row_mask:0xf bank_mask:0xf
    v_cvt_pk_bf16_f32 v73, v188, v189
    v_cvt_pk_bf16_f32 v77, v190, v191
    s_nop 0
    s_waitcnt lgkmcnt(1)
    v_mfma_f32_32x32x8_bf16 v[0:15], v[72:73], v[176:177], v[0:15]
    v_mfma_f32_32x32x8_bf16 v[16:31], v[76:77], v[176:177], v[16:31]
    s_add_u32 m0, s25, 2048
    s_waitcnt vmcnt(6) lgkmcnt(0)
    buffer_load_dwordx4 v224, s[4:7], s33 offen lds
    ds_read_b64_tr_b16 v[176:177], v234 offset:4096
    ds_read_b64_tr_b16 v[178:179], v234 offset:5120
    v_mfma_f32_32x32x8_bf16 v[32:47], v[72:73], v[180:181], v[32:47]
    v_mfma_f32_32x32x8_bf16 v[48:63], v[76:77], v[180:181], v[48:63]
    ds_read_b64_tr_b16 v[180:181], v235 offset:4096
    ds_read_b64_tr_b16 v[182:183], v235 offset:5120
    s_nop 1
    v_mul_f32 v184, v0, v96
    v_fmac_f32 v184, v1, v97
    v_fmac_f32 v184, v2, v98
    v_fmac_f32 v184, v3, v99
    v_fmac_f32 v184, v4, v100
    v_fmac_f32 v184, v5, v101
    v_fmac_f32 v184, v6, v102
    v_fmac_f32 v184, v7, v103
    v_mul_f32 v186, v8, v128
    v_fmac_f32 v186, v9, v129
    v_fmac_f32 v186, v10, v130
    v_fmac_f32 v186, v11, v131
    v_fmac_f32 v186, v12, v132
    v_fmac_f32 v186, v13, v133
    v_fmac_f32 v186, v14, v134
    v_fmac_f32 v186, v15, v135
    s_waitcnt lgkmcnt(2)
    v_mfma_f32_32x32x16_bf16 v[0:15], v[64:67], v[176:179], 0
    v_mul_f32 v188, v16, v128
    v_fmac_f32 v188, v17, v129
    v_fmac_f32 v188, v18, v130
    v_fmac_f32 v188, v19, v131
    v_fmac_f32 v188, v20, v132
    v_fmac_f32 v188, v21, v133
    v_fmac_f32 v188, v22, v134
    v_fmac_f32 v188, v23, v135
    v_mul_f32 v190, v24, v128
    v_fmac_f32 v190, v25, v129
    v_fmac_f32 v190, v26, v130
    v_fmac_f32 v190, v27, v131
    v_fmac_f32 v190, v28, v132
    v_fmac_f32 v190, v29, v133
    v_fmac_f32 v190, v30, v134
    v_fmac_f32 v190, v31, v135
    v_mfma_f32_32x32x16_bf16 v[16:31], v[68:71], v[176:179], 0
    s_add_u32 m0, s25, 4096
    s_waitcnt vmcnt(5) lgkmcnt(0)
    buffer_load_dwordx4 v222, s[4:7], s34 offen lds
    buffer_load_dwordx4 v223, s[8:11], s34 offen offset:1024 lds
    ds_read_b64_tr_b16 v[176:177], v234 offset:6144
    v_mul_f32 v185, v32, v104
    v_fmac_f32 v185, v33, v105
    v_fmac_f32 v185, v34, v106
    v_fmac_f32 v185, v35, v107
    v_fmac_f32 v185, v36, v108
    v_fmac_f32 v185, v37, v109
    v_fmac_f32 v185, v38, v110
    v_fmac_f32 v185, v39, v111
    v_mul_f32 v187, v40, v136
    v_fmac_f32 v187, v41, v137
    v_fmac_f32 v187, v42, v138
    v_fmac_f32 v187, v43, v139
    v_fmac_f32 v187, v44, v140
    v_fmac_f32 v187, v45, v141
    v_fmac_f32 v187, v46, v142
    v_fmac_f32 v187, v47, v143
    v_mfma_f32_32x32x16_bf16 v[32:47], v[64:67], v[180:183], 0
    v_add_u32 v244, s39, v239
    ds_read_u16 v222, v244
    ds_read_u16 v223, v244 offset:64
    v_mul_f32 v189, v48, v136
    v_fmac_f32 v189, v49, v137
    v_fmac_f32 v189, v50, v138
    v_fmac_f32 v189, v51, v139
    v_fmac_f32 v189, v52, v140
    v_fmac_f32 v189, v53, v141
    v_fmac_f32 v189, v54, v142
    v_fmac_f32 v189, v55, v143
    v_mul_f32 v191, v56, v136
    v_fmac_f32 v191, v57, v137
    v_fmac_f32 v191, v58, v138
    v_fmac_f32 v191, v59, v139
    v_fmac_f32 v191, v60, v140
    v_fmac_f32 v191, v61, v141
    v_fmac_f32 v191, v62, v142
    v_fmac_f32 v191, v63, v143
    v_mfma_f32_32x32x16_bf16 v[48:63], v[68:71], v[180:183], 0
    ds_read_b64_tr_b16 v[180:181], v235 offset:6144
    v_permlane32_swap_b32 v184, v186
    v_permlane32_swap_b32 v188, v190
    v_permlane32_swap_b32 v185, v187
    v_permlane32_swap_b32 v189, v191
    v_add_f32 v186, v184, v186
    v_add_f32 v190, v188, v190
    v_add_f32 v187, v185, v187
    v_add_f32 v191, v189, v191
    s_set_gpr_idx_on s48, gpr_idx(DST)
    s_nop 0
    v_cvt_pk_bf16_f32 v192, v186, v187
    v_cvt_pk_bf16_f32 v193, v190, v191
    s_set_gpr_idx_off
    s_waitcnt lgkmcnt(3)
    v_mfma_f32_32x32x8_bf16 v[0:15], v[72:73], v[176:177], v[0:15]
    v_mfma_f32_32x32x8_bf16 v[16:31], v[76:77], v[176:177], v[16:31]
    s_add_u32 m0, s25, 6144
    s_waitcnt vmcnt(5) lgkmcnt(0)
    buffer_load_dwordx4 v224, s[4:7], s34 offen lds
    ds_read_b64_tr_b16 v[176:177], v234 offset:0
    ds_read_b64_tr_b16 v[178:179], v234 offset:1024
    v_mfma_f32_32x32x8_bf16 v[32:47], v[72:73], v[180:181], v[32:47]
    v_add_u32 v244, s40, v239
    ds_read_u16 v224, v244
    ds_read_u16 v225, v244 offset:64
    v_mfma_f32_32x32x8_bf16 v[48:63], v[76:77], v[180:181], v[48:63]
    ds_read_b64_tr_b16 v[180:181], v235 offset:0
    ds_read_b64_tr_b16 v[182:183], v235 offset:1024
    v_mul_f32 v184, v0, v144
    v_fmac_f32 v184, v1, v145
    v_fmac_f32 v184, v2, v146
    v_fmac_f32 v184, v3, v147
    v_fmac_f32 v184, v4, v148
    v_fmac_f32 v184, v5, v149
    v_fmac_f32 v184, v6, v150
    v_fmac_f32 v184, v7, v151
    v_mul_f32 v186, v8, v112
    v_fmac_f32 v186, v9, v113
    v_fmac_f32 v186, v10, v114
    v_fmac_f32 v186, v11, v115
    v_fmac_f32 v186, v12, v116
    v_fmac_f32 v186, v13, v117
    v_fmac_f32 v186, v14, v118
    v_fmac_f32 v186, v15, v119
    s_waitcnt lgkmcnt(4)
    v_mfma_f32_32x32x16_bf16 v[0:15], v[64:67], v[176:179], 0
    v_mul_f32_e64 v188, v16, -v160
    v_fma_f32 v188, v17, -v161, v188
    v_fma_f32 v188, v18, -v162, v188
    v_fma_f32 v188, v19, -v163, v188
    v_fma_f32 v188, v20, -v164, v188
    v_fma_f32 v188, v21, -v165, v188
    v_fma_f32 v188, v22, -v166, v188
    v_fma_f32 v188, v23, -v167, v188
    v_mul_f32 v190, v24, v160
    v_fmac_f32 v190, v25, v161
    v_fmac_f32 v190, v26, v162
    v_fmac_f32 v190, v27, v163
    v_fmac_f32 v190, v28, v164
    v_fmac_f32 v190, v29, v165
    v_fmac_f32 v190, v30, v166
    v_fmac_f32 v190, v31, v167
    v_mfma_f32_32x32x16_bf16 v[16:31], v[68:71], v[176:179], 0
    v_lshl_add_u32 v222, v222, 10, v236
    v_lshl_add_u32 v223, v223, 10, v236
    s_add_u32 m0, s25, 0
    s_waitcnt vmcnt(3) lgkmcnt(0)
    buffer_load_dwordx4 v222, s[4:7], s35 offen lds
    buffer_load_dwordx4 v223, s[8:11], s35 offen offset:1024 lds
    ds_read_b64_tr_b16 v[176:177], v234 offset:2048
    v_mul_f32 v185, v32, v152
    v_fmac_f32 v185, v33, v153
    v_fmac_f32 v185, v34, v154
    v_fmac_f32 v185, v35, v155
    v_fmac_f32 v185, v36, v156
    v_fmac_f32 v185, v37, v157
    v_fmac_f32 v185, v38, v158
    v_fmac_f32 v185, v39, v159
    v_mul_f32 v187, v40, v120
    v_fmac_f32 v187, v41, v121
    v_fmac_f32 v187, v42, v122
    v_fmac_f32 v187, v43, v123
    v_fmac_f32 v187, v44, v124
    v_fmac_f32 v187, v45, v125
    v_fmac_f32 v187, v46, v126
    v_fmac_f32 v187, v47, v127
    v_mfma_f32_32x32x16_bf16 v[32:47], v[64:67], v[180:183], 0
    v_mul_f32_e64 v189, v48, -v168
    v_fma_f32 v189, v49, -v169, v189
    v_fma_f32 v189, v50, -v170, v189
    v_fma_f32 v189, v51, -v171, v189
    v_fma_f32 v189, v52, -v172, v189
    v_fma_f32 v189, v53, -v173, v189
    v_fma_f32 v189, v54, -v174, v189
    v_fma_f32 v189, v55, -v175, v189
    v_mul_f32 v191, v56, v168
    v_fmac_f32 v191, v57, v169
    v_fmac_f32 v191, v58, v170
    v_fmac_f32 v191, v59, v171
    v_fmac_f32 v191, v60, v172
    v_fmac_f32 v191, v61, v173
    v_fmac_f32 v191, v62, v174
    v_fmac_f32 v191, v63, v175
    v_mfma_f32_32x32x16_bf16 v[48:63], v[68:71], v[180:183], 0
    ds_read_b64_tr_b16 v[180:181], v235 offset:2048
    s_waitcnt lgkmcnt(1)
    v_mfma_f32_32x32x8_bf16 v[0:15], v[72:73], v[176:177], v[0:15]
    v_mfma_f32_32x32x8_bf16 v[16:31], v[76:77], v[176:177], v[16:31]
    v_lshl_add_u32 v224, v224, 10, v236
    v_lshl_add_u32 v225, v225, 10, v236
    s_add_u32 m0, s25, 2048
    s_waitcnt vmcnt(3) lgkmcnt(0)
    buffer_load_dwordx4 v224, s[4:7], s36 offen lds
    buffer_load_dwordx4 v225, s[8:11], s36 offen offset:1024 lds
    ds_read_b64_tr_b16 v[176:177], v234 offset:4096
    ds_read_b64_tr_b16 v[178:179], v234 offset:5120
    v_mfma_f32_32x32x8_bf16 v[32:47], v[72:73], v[180:181], v[32:47]
    v_mfma_f32_32x32x8_bf16 v[48:63], v[76:77], v[180:181], v[48:63]
    ds_read_b64_tr_b16 v[180:181], v235 offset:4096
    ds_read_b64_tr_b16 v[182:183], v235 offset:5120
    v_mul_f32 v246, v0, v144
    v_fmac_f32 v246, v1, v145
    v_fmac_f32 v246, v2, v146
    v_fmac_f32 v246, v3, v147
    v_fmac_f32 v246, v4, v148
    v_fmac_f32 v246, v5, v149
    v_fmac_f32 v246, v6, v150
    v_fmac_f32 v246, v7, v151
    v_fmac_f32 v188, v8, v160
    v_fmac_f32 v188, v9, v161
    v_fmac_f32 v188, v10, v162
    v_fmac_f32 v188, v11, v163
    v_fmac_f32 v188, v12, v164
    v_fmac_f32 v188, v13, v165
    v_fmac_f32 v188, v14, v166
    v_fmac_f32 v188, v15, v167
    s_waitcnt lgkmcnt(2)
    v_mfma_f32_32x32x16_bf16 v[0:15], v[64:67], v[176:179], 0
    v_permlane32_swap_b32 v184, v246
    v_fmac_f32 v186, v16, v112
    v_fmac_f32 v186, v17, v113
    v_fmac_f32 v186, v18, v114
    v_fmac_f32 v186, v19, v115
    v_fmac_f32 v186, v20, v116
    v_fmac_f32 v186, v21, v117
    v_fmac_f32 v186, v22, v118
    v_fmac_f32 v186, v23, v119
    v_add_f32 v246, v184, v246
    v_mul_f32_e64 v184, v24, -v160
    v_fma_f32 v184, v25, -v161, v184
    v_fma_f32 v184, v26, -v162, v184
    v_fma_f32 v184, v27, -v163, v184
    v_fma_f32 v184, v28, -v164, v184
    v_fma_f32 v184, v29, -v165, v184
    v_fma_f32 v184, v30, -v166, v184
    v_fma_f32 v184, v31, -v167, v184
    v_mfma_f32_32x32x16_bf16 v[16:31], v[68:71], v[176:179], 0
    v_lshl_add_u32 v226, v226, 10, v236
    v_lshl_add_u32 v227, v227, 10, v236
    s_add_u32 m0, s25, 4096
    s_waitcnt vmcnt(4) lgkmcnt(0)
    buffer_load_dwordx4 v226, s[4:7], s37 offen lds
    buffer_load_dwordx4 v227, s[8:11], s37 offen offset:1024 lds
    ds_read_b64_tr_b16 v[176:177], v234 offset:6144
    v_mul_f32 v247, v32, v152
    v_fmac_f32 v247, v33, v153
    v_fmac_f32 v247, v34, v154
    v_fmac_f32 v247, v35, v155
    v_fmac_f32 v247, v36, v156
    v_fmac_f32 v247, v37, v157
    v_fmac_f32 v247, v38, v158
    v_fmac_f32 v247, v39, v159
    v_fmac_f32 v189, v40, v168
    v_fmac_f32 v189, v41, v169
    v_fmac_f32 v189, v42, v170
    v_fmac_f32 v189, v43, v171
    v_fmac_f32 v189, v44, v172
    v_fmac_f32 v189, v45, v173
    v_fmac_f32 v189, v46, v174
    v_fmac_f32 v189, v47, v175
    v_mfma_f32_32x32x16_bf16 v[32:47], v[64:67], v[180:183], 0
    v_permlane32_swap_b32 v185, v247
    v_fmac_f32 v187, v48, v120
    v_fmac_f32 v187, v49, v121
    v_fmac_f32 v187, v50, v122
    v_fmac_f32 v187, v51, v123
    v_fmac_f32 v187, v52, v124
    v_fmac_f32 v187, v53, v125
    v_fmac_f32 v187, v54, v126
    v_fmac_f32 v187, v55, v127
    v_add_f32 v247, v185, v247
    v_mul_f32_e64 v185, v56, -v168
    v_fma_f32 v185, v57, -v169, v185
    v_fma_f32 v185, v58, -v170, v185
    v_fma_f32 v185, v59, -v171, v185
    v_fma_f32 v185, v60, -v172, v185
    v_fma_f32 v185, v61, -v173, v185
    v_fma_f32 v185, v62, -v174, v185
    v_fma_f32 v185, v63, -v175, v185
    v_mfma_f32_32x32x16_bf16 v[48:63], v[68:71], v[180:183], 0
    ds_read_b64_tr_b16 v[180:181], v235 offset:6144
    s_set_gpr_idx_on s48, gpr_idx(DST)
    s_nop 0
    v_cvt_pk_bf16_f32 v194, v246, v247
    s_set_gpr_idx_off
    s_waitcnt lgkmcnt(1)
    v_mfma_f32_32x32x8_bf16 v[0:15], v[72:73], v[176:177], v[0:15]
    v_mfma_f32_32x32x8_bf16 v[16:31], v[76:77], v[176:177], v[16:31]
    v_lshl_add_u32 v228, v228, 10, v236
    v_lshl_add_u32 v229, v229, 10, v236
    s_add_u32 m0, s25, 6144
    s_waitcnt vmcnt(4) lgkmcnt(0)
    buffer_load_dwordx4 v228, s[4:7], s38 offen lds
    buffer_load_dwordx4 v229, s[8:11], s38 offen offset:1024 lds
    ds_read_b64_tr_b16 v[176:177], v234 offset:0
    ds_read_b64_tr_b16 v[178:179], v234 offset:1024
    v_mfma_f32_32x32x8_bf16 v[32:47], v[72:73], v[180:181], v[32:47]
    v_mfma_f32_32x32x8_bf16 v[48:63], v[76:77], v[180:181], v[48:63]
    ds_read_b64_tr_b16 v[180:181], v235 offset:0
    ds_read_b64_tr_b16 v[182:183], v235 offset:1024
    v_add_u32 v241, s45, v237
    v_add_u32 v242, s39, v238
    ds_read_b32 v252, v251 offset:16
    ds_read_b64_tr_b16 v[68:69], v241 offset:0
    ds_read_b64_tr_b16 v[70:71], v241 offset:256
    s_mov_b64 exec, s[50:51]
    ds_read_u16_d16_hi v230, v242 offset:0
    s_mov_b64 exec, -1
    v_mul_f32 v246, v0, v144
    v_fmac_f32 v246, v1, v145
    v_fmac_f32 v246, v2, v146
    v_fmac_f32 v246, v3, v147
    v_fmac_f32 v246, v4, v148
    v_fmac_f32 v246, v5, v149
    v_fmac_f32 v246, v6, v150
    v_fmac_f32 v246, v7, v151
    v_fma_f32 v190, v8, -v160, v190
    v_fma_f32 v190, v9, -v161, v190
    v_fma_f32 v190, v10, -v162, v190
    v_fma_f32 v190, v11, -v163, v190
    v_fma_f32 v190, v12, -v164, v190
    v_fma_f32 v190, v13, -v165, v190
    v_fma_f32 v190, v14, -v166, v190
    v_fma_f32 v190, v15, -v167, v190
    v_fmac_f32 v184, v16, v160
    v_fmac_f32 v184, v17, v161
    v_fmac_f32 v184, v18, v162
    v_fmac_f32 v184, v19, v163
    v_fmac_f32 v184, v20, v164
    v_fmac_f32 v184, v21, v165
    v_fmac_f32 v184, v22, v166
    v_fmac_f32 v184, v23, v167
    v_fmac_f32 v186, v24, v112
    v_fmac_f32 v186, v25, v113
    v_fmac_f32 v186, v26, v114
    v_fmac_f32 v186, v27, v115
    v_fmac_f32 v186, v28, v116
    v_fmac_f32 v186, v29, v117
    v_fmac_f32 v186, v30, v118
    v_fmac_f32 v186, v31, v119
    v_mul_f32 v247, v32, v152
    v_fmac_f32 v247, v33, v153
    v_fmac_f32 v247, v34, v154
    v_fmac_f32 v247, v35, v155
    v_fmac_f32 v247, v36, v156
    v_fmac_f32 v247, v37, v157
    v_fmac_f32 v247, v38, v158
    v_fmac_f32 v247, v39, v159
    v_fma_f32 v191, v40, -v168, v191
    v_fma_f32 v191, v41, -v169, v191
    v_fma_f32 v191, v42, -v170, v191
    v_fma_f32 v191, v43, -v171, v191
    v_fma_f32 v191, v44, -v172, v191
    v_fma_f32 v191, v45, -v173, v191
    v_fma_f32 v191, v46, -v174, v191
    v_fma_f32 v191, v47, -v175, v191
    v_fmac_f32 v185, v48, v168
    v_fmac_f32 v185, v49, v169
    v_fmac_f32 v185, v50, v170
    v_fmac_f32 v185, v51, v171
    v_fmac_f32 v185, v52, v172
    v_fmac_f32 v185, v53, v173
    v_fmac_f32 v185, v54, v174
    v_fmac_f32 v185, v55, v175
    v_fmac_f32 v187, v56, v120
    v_fmac_f32 v187, v57, v121
    v_fmac_f32 v187, v58, v122
    v_fmac_f32 v187, v59, v123
    v_fmac_f32 v187, v60, v124
    v_fmac_f32 v187, v61, v125
    v_fmac_f32 v187, v62, v126
    v_fmac_f32 v187, v63, v127
    s_nop 0
    v_permlane32_swap_b32 v246, v188
    v_permlane32_swap_b32 v190, v244
    v_permlane32_swap_b32 v186, v184
    v_permlane32_swap_b32 v247, v189
    v_permlane32_swap_b32 v191, v245
    v_permlane32_swap_b32 v187, v185
    v_add_f32 v188, v246, v188
    v_add_f32 v244, v190, v244
    v_add_f32 v184, v186, v184
    v_add_f32 v189, v247, v189
    v_add_f32 v245, v191, v245
    v_add_f32 v185, v187, v185
    s_set_gpr_idx_on s48, gpr_idx(DST)
    s_nop 0
    v_cvt_pk_bf16_f32 v195, v188, v189
    v_cvt_pk_bf16_f32 v197, v244, v245
    v_cvt_pk_bf16_f32 v196, v184, v185
    s_set_gpr_idx_off
    s_branch NEXT_0
.p2align 6
ITEM_0_8:
    ds_read_b64_tr_b16 v[76:77], v241 offset:512
    ds_read_b64_tr_b16 v[78:79], v241 offset:768
    ds_read_b64_tr_b16 v[84:85], v241 offset:1024
    ds_read_b64_tr_b16 v[86:87], v241 offset:1280
    ds_read_b64_tr_b16 v[92:93], v241 offset:1536
    ds_read_b64_tr_b16 v[94:95], v241 offset:1792
    s_mov_b64 exec, s[50:51]
    ds_read_u16_d16_hi v231, v242 offset:128
    ds_read_u16_d16_hi v232, v242 offset:256
    ds_read_u16_d16_hi v233, v242 offset:384
    s_mov_b64 exec, -1
    v_add_u32 v245, s45, v248
    ds_read_b32 v246, v245
    ds_read_b32 v247, v245 offset:1024
    s_waitcnt lgkmcnt(11)
    v_lshlrev_b32 v184, 16, v68
    v_and_b32 v185, 0xffff0000, v68
    v_lshlrev_b32 v186, 16, v69
    v_and_b32 v187, 0xffff0000, v69
    v_mul_f32_dpp v188, v230, v184 row_newbcast:0 row_mask:0xf bank_mask:0xf
    v_mul_f32_dpp v189, v230, v185 row_newbcast:1 row_mask:0xf bank_mask:0xf
    v_mul_f32_dpp v190, v230, v184 row_newbcast:8 row_mask:0xf bank_mask:0xf
    v_mul_f32_dpp v191, v230, v185 row_newbcast:9 row_mask:0xf bank_mask:0xf
    v_lshlrev_b32 v184, 16, v70
    v_and_b32 v185, 0xffff0000, v70
    v_cvt_pk_bf16_f32 v64, v188, v189
    v_cvt_pk_bf16_f32 v68, v190, v191
    v_mul_f32_dpp v188, v230, v186 row_newbcast:2 row_mask:0xf bank_mask:0xf
    v_mul_f32_dpp v189, v230, v187 row_newbcast:3 row_mask:0xf bank_mask:0xf
    v_mul_f32_dpp v190, v230, v186 row_newbcast:10 row_mask:0xf bank_mask:0xf
    v_mul_f32_dpp v191, v230, v187 row_newbcast:11 row_mask:0xf bank_mask:0xf
    v_lshlrev_b32 v186, 16, v71
    v_and_b32 v187, 0xffff0000, v71
    v_cvt_pk_bf16_f32 v65, v188, v189
    v_cvt_pk_bf16_f32 v69, v190, v191
    v_mul_f32_dpp v188, v230, v184 row_newbcast:4 row_mask:0xf bank_mask:0xf
    v_mul_f32_dpp v189, v230, v185 row_newbcast:5 row_mask:0xf bank_mask:0xf
    v_mul_f32_dpp v190, v230, v184 row_newbcast:12 row_mask:0xf bank_mask:0xf
    v_mul_f32_dpp v191, v230, v185 row_newbcast:13 row_mask:0xf bank_mask:0xf
    v_cvt_pk_bf16_f32 v66, v188, v189
    v_cvt_pk_bf16_f32 v70, v190, v191
    v_mul_f32_dpp v188, v230, v186 row_newbcast:6 row_mask:0xf bank_mask:0xf
    v_mul_f32_dpp v189, v230, v187 row_newbcast:7 row_mask:0xf bank_mask:0xf
    v_mul_f32_dpp v190, v230, v186 row_newbcast:14 row_mask:0xf bank_mask:0xf
    v_mul_f32_dpp v191, v230, v187 row_newbcast:15 row_mask:0xf bank_mask:0xf
    v_cvt_pk_bf16_f32 v67, v188, v189
    v_cvt_pk_bf16_f32 v71, v190, v191
    s_nop 0
    s_waitcnt lgkmcnt(2)
    v_mfma_f32_32x32x16_bf16 v[0:15], v[64:67], v[176:179], 0
    v_lshlrev_b32 v184, 16, v76
    v_and_b32 v185, 0xffff0000, v76
    v_lshlrev_b32 v186, 16, v77
    v_and_b32 v187, 0xffff0000, v77
    v_mul_f32_dpp v188, v231, v184 row_newbcast:0 row_mask:0xf bank_mask:0xf
    v_mul_f32_dpp v189, v231, v185 row_newbcast:1 row_mask:0xf bank_mask:0xf
    v_mul_f32_dpp v190, v231, v184 row_newbcast:8 row_mask:0xf bank_mask:0xf
    v_mul_f32_dpp v191, v231, v185 row_newbcast:9 row_mask:0xf bank_mask:0xf
    v_mfma_f32_32x32x16_bf16 v[16:31], v[68:71], v[176:179], 0
    s_add_u32 m0, s25, 0
    s_waitcnt vmcnt(4)
    buffer_load_dwordx4 v222, s[4:7], s32 offen lds
    buffer_load_dwordx4 v223, s[8:11], s32 offen offset:1024 lds
    ds_read_b64_tr_b16 v[176:177], v234 offset:2048
    ds_read_b64_tr_b16 v[178:179], v234 offset:3072
    s_waitcnt lgkmcnt(2)
    v_lshl_add_u32 v246, v246, 5, v249
    v_lshl_add_u32 v247, v247, 5, v249
    s_mov_b32 m0, s56
    s_mov_b64 exec, s[52:53]
    buffer_load_dwordx4 v246, s[12:15], 0 offen  lds
    s_mov_b32 m0, s57
    s_mov_b64 exec, s[54:55]
    buffer_load_dwordx4 v247, s[12:15], 0 offen  lds
    s_mov_b64 exec, -1
    v_lshlrev_b32 v184, 16, v78
    v_and_b32 v185, 0xffff0000, v78
    v_cvt_pk_bf16_f32 v72, v188, v189
    v_cvt_pk_bf16_f32 v76, v190, v191
    v_mul_f32_dpp v188, v231, v186 row_newbcast:2 row_mask:0xf bank_mask:0xf
    v_mul_f32_dpp v189, v231, v187 row_newbcast:3 row_mask:0xf bank_mask:0xf
    v_mul_f32_dpp v190, v231, v186 row_newbcast:10 row_mask:0xf bank_mask:0xf
    v_mul_f32_dpp v191, v231, v187 row_newbcast:11 row_mask:0xf bank_mask:0xf
    v_mfma_f32_32x32x16_bf16 v[32:47], v[64:67], v[180:183], 0
    v_lshlrev_b32 v186, 16, v79
    v_and_b32 v187, 0xffff0000, v79
    v_cvt_pk_bf16_f32 v73, v188, v189
    v_cvt_pk_bf16_f32 v77, v190, v191
    v_mul_f32_dpp v188, v231, v184 row_newbcast:4 row_mask:0xf bank_mask:0xf
    v_mul_f32_dpp v189, v231, v185 row_newbcast:5 row_mask:0xf bank_mask:0xf
    v_mul_f32_dpp v190, v231, v184 row_newbcast:12 row_mask:0xf bank_mask:0xf
    v_mul_f32_dpp v191, v231, v185 row_newbcast:13 row_mask:0xf bank_mask:0xf
    v_mfma_f32_32x32x16_bf16 v[48:63], v[68:71], v[180:183], 0
    ds_read_b64_tr_b16 v[180:181], v235 offset:2048
    ds_read_b64_tr_b16 v[182:183], v235 offset:3072
    v_cvt_pk_bf16_f32 v74, v188, v189
    v_cvt_pk_bf16_f32 v78, v190, v191
    v_mul_f32_dpp v188, v231, v186 row_newbcast:6 row_mask:0xf bank_mask:0xf
    v_mul_f32_dpp v189, v231, v187 row_newbcast:7 row_mask:0xf bank_mask:0xf
    v_mul_f32_dpp v190, v231, v186 row_newbcast:14 row_mask:0xf bank_mask:0xf
    v_mul_f32_dpp v191, v231, v187 row_newbcast:15 row_mask:0xf bank_mask:0xf
    v_cvt_pk_bf16_f32 v75, v188, v189
    v_cvt_pk_bf16_f32 v79, v190, v191
    s_nop 0
    s_waitcnt lgkmcnt(2)
    v_mfma_f32_32x32x16_bf16 v[0:15], v[72:75], v[176:179], v[0:15]
    v_lshlrev_b32 v184, 16, v84
    v_and_b32 v185, 0xffff0000, v84
    v_lshlrev_b32 v186, 16, v85
    v_and_b32 v187, 0xffff0000, v85
    v_mul_f32_dpp v188, v232, v184 row_newbcast:0 row_mask:0xf bank_mask:0xf
    v_mul_f32_dpp v189, v232, v185 row_newbcast:1 row_mask:0xf bank_mask:0xf
    v_mul_f32_dpp v190, v232, v184 row_newbcast:8 row_mask:0xf bank_mask:0xf
    v_mul_f32_dpp v191, v232, v185 row_newbcast:9 row_mask:0xf bank_mask:0xf
    v_mfma_f32_32x32x16_bf16 v[16:31], v[76:79], v[176:179], v[16:31]
    s_add_u32 m0, s25, 2048
    s_waitcnt vmcnt(6) lgkmcnt(0)
    buffer_load_dwordx4 v224, s[4:7], s32 offen lds
    buffer_load_dwordx4 v225, s[8:11], s32 offen offset:1024 lds
    ds_read_b64_tr_b16 v[176:177], v234 offset:4096
    ds_read_b64_tr_b16 v[178:179], v234 offset:5120
    v_lshlrev_b32 v184, 16, v86
    v_and_b32 v185, 0xffff0000, v86
    v_cvt_pk_bf16_f32 v80, v188, v189
    v_cvt_pk_bf16_f32 v84, v190, v191
    v_mul_f32_dpp v188, v232, v186 row_newbcast:2 row_mask:0xf bank_mask:0xf
    v_mul_f32_dpp v189, v232, v187 row_newbcast:3 row_mask:0xf bank_mask:0xf
    v_mul_f32_dpp v190, v232, v186 row_newbcast:10 row_mask:0xf bank_mask:0xf
    v_mul_f32_dpp v191, v232, v187 row_newbcast:11 row_mask:0xf bank_mask:0xf
    v_mfma_f32_32x32x16_bf16 v[32:47], v[72:75], v[180:183], v[32:47]
    v_lshlrev_b32 v186, 16, v87
    v_and_b32 v187, 0xffff0000, v87
    v_cvt_pk_bf16_f32 v81, v188, v189
    v_cvt_pk_bf16_f32 v85, v190, v191
    v_mul_f32_dpp v188, v232, v184 row_newbcast:4 row_mask:0xf bank_mask:0xf
    v_mul_f32_dpp v189, v232, v185 row_newbcast:5 row_mask:0xf bank_mask:0xf
    v_mul_f32_dpp v190, v232, v184 row_newbcast:12 row_mask:0xf bank_mask:0xf
    v_mul_f32_dpp v191, v232, v185 row_newbcast:13 row_mask:0xf bank_mask:0xf
    v_mfma_f32_32x32x16_bf16 v[48:63], v[76:79], v[180:183], v[48:63]
    ds_read_b64_tr_b16 v[180:181], v235 offset:4096
    ds_read_b64_tr_b16 v[182:183], v235 offset:5120
    v_cvt_pk_bf16_f32 v82, v188, v189
    v_cvt_pk_bf16_f32 v86, v190, v191
    v_mul_f32_dpp v188, v232, v186 row_newbcast:6 row_mask:0xf bank_mask:0xf
    v_mul_f32_dpp v189, v232, v187 row_newbcast:7 row_mask:0xf bank_mask:0xf
    v_mul_f32_dpp v190, v232, v186 row_newbcast:14 row_mask:0xf bank_mask:0xf
    v_mul_f32_dpp v191, v232, v187 row_newbcast:15 row_mask:0xf bank_mask:0xf
    v_cvt_pk_bf16_f32 v83, v188, v189
    v_cvt_pk_bf16_f32 v87, v190, v191
    s_nop 0
    s_waitcnt lgkmcnt(2)
    v_mfma_f32_32x32x16_bf16 v[0:15], v[80:83], v[176:179], v[0:15]
    v_lshlrev_b32 v184, 16, v92
    v_and_b32 v185, 0xffff0000, v92
    v_lshlrev_b32 v186, 16, v93
    v_and_b32 v187, 0xffff0000, v93
    v_mul_f32_dpp v188, v233, v184 row_newbcast:0 row_mask:0xf bank_mask:0xf
    v_mul_f32_dpp v189, v233, v185 row_newbcast:1 row_mask:0xf bank_mask:0xf
    v_mul_f32_dpp v190, v233, v184 row_newbcast:8 row_mask:0xf bank_mask:0xf
    v_mul_f32_dpp v191, v233, v185 row_newbcast:9 row_mask:0xf bank_mask:0xf
    v_mfma_f32_32x32x16_bf16 v[16:31], v[84:87], v[176:179], v[16:31]
    s_add_u32 m0, s25, 4096
    s_waitcnt vmcnt(6) lgkmcnt(0)
    buffer_load_dwordx4 v226, s[4:7], s32 offen lds
    buffer_load_dwordx4 v227, s[8:11], s32 offen offset:1024 lds
    ds_read_b64_tr_b16 v[176:177], v234 offset:6144
    ds_read_b64_tr_b16 v[178:179], v234 offset:7168
    v_lshlrev_b32 v184, 16, v94
    v_and_b32 v185, 0xffff0000, v94
    v_cvt_pk_bf16_f32 v88, v188, v189
    v_cvt_pk_bf16_f32 v92, v190, v191
    v_mul_f32_dpp v188, v233, v186 row_newbcast:2 row_mask:0xf bank_mask:0xf
    v_mul_f32_dpp v189, v233, v187 row_newbcast:3 row_mask:0xf bank_mask:0xf
    v_mul_f32_dpp v190, v233, v186 row_newbcast:10 row_mask:0xf bank_mask:0xf
    v_mul_f32_dpp v191, v233, v187 row_newbcast:11 row_mask:0xf bank_mask:0xf
    v_mfma_f32_32x32x16_bf16 v[32:47], v[80:83], v[180:183], v[32:47]
    v_lshlrev_b32 v186, 16, v95
    v_and_b32 v187, 0xffff0000, v95
    v_cvt_pk_bf16_f32 v89, v188, v189
    v_cvt_pk_bf16_f32 v93, v190, v191
    v_mul_f32_dpp v188, v233, v184 row_newbcast:4 row_mask:0xf bank_mask:0xf
    v_mul_f32_dpp v189, v233, v185 row_newbcast:5 row_mask:0xf bank_mask:0xf
    v_mul_f32_dpp v190, v233, v184 row_newbcast:12 row_mask:0xf bank_mask:0xf
    v_mul_f32_dpp v191, v233, v185 row_newbcast:13 row_mask:0xf bank_mask:0xf
    v_mfma_f32_32x32x16_bf16 v[48:63], v[84:87], v[180:183], v[48:63]
    ds_read_b64_tr_b16 v[180:181], v235 offset:6144
    ds_read_b64_tr_b16 v[182:183], v235 offset:7168
    v_cvt_pk_bf16_f32 v90, v188, v189
    v_cvt_pk_bf16_f32 v94, v190, v191
    v_mul_f32_dpp v188, v233, v186 row_newbcast:6 row_mask:0xf bank_mask:0xf
    v_mul_f32_dpp v189, v233, v187 row_newbcast:7 row_mask:0xf bank_mask:0xf
    v_mul_f32_dpp v190, v233, v186 row_newbcast:14 row_mask:0xf bank_mask:0xf
    v_mul_f32_dpp v191, v233, v187 row_newbcast:15 row_mask:0xf bank_mask:0xf
    v_cvt_pk_bf16_f32 v91, v188, v189
    v_cvt_pk_bf16_f32 v95, v190, v191
    s_nop 0
    s_waitcnt lgkmcnt(2)
    v_mfma_f32_32x32x16_bf16 v[0:15], v[88:91], v[176:179], v[0:15]
    v_mfma_f32_32x32x16_bf16 v[16:31], v[92:95], v[176:179], v[16:31]
    s_add_u32 m0, s25, 6144
    s_waitcnt vmcnt(6) lgkmcnt(0)
    buffer_load_dwordx4 v228, s[4:7], s32 offen lds
    buffer_load_dwordx4 v229, s[8:11], s32 offen offset:1024 lds
    ds_read_b64_tr_b16 v[176:177], v234 offset:0
    ds_read_b64_tr_b16 v[178:179], v234 offset:1024
    v_mfma_f32_32x32x16_bf16 v[32:47], v[88:91], v[180:183], v[32:47]
    v_mfma_f32_32x32x16_bf16 v[48:63], v[92:95], v[180:183], v[48:63]
    ds_read_b64_tr_b16 v[180:181], v235 offset:0
    ds_read_b64_tr_b16 v[182:183], v235 offset:1024
    s_nop 0
    v_mul_f32 v184, v0, v96
    v_fmac_f32 v184, v1, v97
    v_fmac_f32 v184, v2, v98
    v_fmac_f32 v184, v3, v99
    v_fmac_f32 v184, v4, v100
    v_fmac_f32 v184, v5, v101
    v_fmac_f32 v184, v6, v102
    v_fmac_f32 v184, v7, v103
    v_mul_f32 v186, v8, v128
    v_fmac_f32 v186, v9, v129
    v_fmac_f32 v186, v10, v130
    v_fmac_f32 v186, v11, v131
    v_fmac_f32 v186, v12, v132
    v_fmac_f32 v186, v13, v133
    v_fmac_f32 v186, v14, v134
    v_fmac_f32 v186, v15, v135
    s_waitcnt lgkmcnt(2)
    v_mfma_f32_32x32x16_bf16 v[0:15], v[64:67], v[176:179], 0
    v_mul_f32 v188, v16, v128
    v_fmac_f32 v188, v17, v129
    v_fmac_f32 v188, v18, v130
    v_fmac_f32 v188, v19, v131
    v_fmac_f32 v188, v20, v132
    v_fmac_f32 v188, v21, v133
    v_fmac_f32 v188, v22, v134
    v_fmac_f32 v188, v23, v135
    v_mul_f32 v190, v24, v128
    v_fmac_f32 v190, v25, v129
    v_fmac_f32 v190, v26, v130
    v_fmac_f32 v190, v27, v131
    v_fmac_f32 v190, v28, v132
    v_fmac_f32 v190, v29, v133
    v_fmac_f32 v190, v30, v134
    v_fmac_f32 v190, v31, v135
    v_mfma_f32_32x32x16_bf16 v[16:31], v[68:71], v[176:179], 0
    s_add_u32 m0, s25, 0
    s_waitcnt vmcnt(4) lgkmcnt(0)
    buffer_load_dwordx4 v222, s[4:7], s33 offen lds
    buffer_load_dwordx4 v223, s[8:11], s33 offen offset:1024 lds
    ds_read_b64_tr_b16 v[176:177], v234 offset:2048
    ds_read_b64_tr_b16 v[178:179], v234 offset:3072
    v_mul_f32 v185, v32, v104
    v_fmac_f32 v185, v33, v105
    v_fmac_f32 v185, v34, v106
    v_fmac_f32 v185, v35, v107
    v_fmac_f32 v185, v36, v108
    v_fmac_f32 v185, v37, v109
    v_fmac_f32 v185, v38, v110
    v_fmac_f32 v185, v39, v111
    v_mul_f32 v187, v40, v136
    v_fmac_f32 v187, v41, v137
    v_fmac_f32 v187, v42, v138
    v_fmac_f32 v187, v43, v139
    v_fmac_f32 v187, v44, v140
    v_fmac_f32 v187, v45, v141
    v_fmac_f32 v187, v46, v142
    v_fmac_f32 v187, v47, v143
    v_mfma_f32_32x32x16_bf16 v[32:47], v[64:67], v[180:183], 0
    v_mul_f32 v189, v48, v136
    v_fmac_f32 v189, v49, v137
    v_fmac_f32 v189, v50, v138
    v_fmac_f32 v189, v51, v139
    v_fmac_f32 v189, v52, v140
    v_fmac_f32 v189, v53, v141
    v_fmac_f32 v189, v54, v142
    v_fmac_f32 v189, v55, v143
    v_mul_f32 v191, v56, v136
    v_fmac_f32 v191, v57, v137
    v_fmac_f32 v191, v58, v138
    v_fmac_f32 v191, v59, v139
    v_fmac_f32 v191, v60, v140
    v_fmac_f32 v191, v61, v141
    v_fmac_f32 v191, v62, v142
    v_fmac_f32 v191, v63, v143
    v_mfma_f32_32x32x16_bf16 v[48:63], v[68:71], v[180:183], 0
    ds_read_b64_tr_b16 v[180:181], v235 offset:2048
    ds_read_b64_tr_b16 v[182:183], v235 offset:3072
    v_permlane32_swap_b32 v184, v186
    v_permlane32_swap_b32 v188, v190
    v_permlane32_swap_b32 v185, v187
    v_permlane32_swap_b32 v189, v191
    v_add_f32 v186, v184, v186
    v_add_f32 v190, v188, v190
    v_add_f32 v187, v185, v187
    v_add_f32 v191, v189, v191
    s_set_gpr_idx_on s48, gpr_idx(DST)
    s_nop 0
    v_cvt_pk_bf16_f32 v192, v186, v187
    v_cvt_pk_bf16_f32 v193, v190, v191
    s_set_gpr_idx_off
    s_waitcnt lgkmcnt(2)
    v_mfma_f32_32x32x16_bf16 v[0:15], v[72:75], v[176:179], v[0:15]
    v_mfma_f32_32x32x16_bf16 v[16:31], v[76:79], v[176:179], v[16:31]
    s_add_u32 m0, s25, 2048
    s_waitcnt vmcnt(4) lgkmcnt(0)
    buffer_load_dwordx4 v224, s[4:7], s33 offen lds
    buffer_load_dwordx4 v225, s[8:11], s33 offen offset:1024 lds
    ds_read_b64_tr_b16 v[176:177], v234 offset:4096
    ds_read_b64_tr_b16 v[178:179], v234 offset:5120
    v_mfma_f32_32x32x16_bf16 v[32:47], v[72:75], v[180:183], v[32:47]
    v_mfma_f32_32x32x16_bf16 v[48:63], v[76:79], v[180:183], v[48:63]
    ds_read_b64_tr_b16 v[180:181], v235 offset:4096
    ds_read_b64_tr_b16 v[182:183], v235 offset:5120
    s_waitcnt lgkmcnt(2)
    v_mfma_f32_32x32x16_bf16 v[0:15], v[80:83], v[176:179], v[0:15]
    v_mfma_f32_32x32x16_bf16 v[16:31], v[84:87], v[176:179], v[16:31]
    s_add_u32 m0, s25, 4096
    s_waitcnt vmcnt(4) lgkmcnt(0)
    buffer_load_dwordx4 v226, s[4:7], s33 offen lds
    buffer_load_dwordx4 v227, s[8:11], s33 offen offset:1024 lds
    ds_read_b64_tr_b16 v[176:177], v234 offset:6144
    ds_read_b64_tr_b16 v[178:179], v234 offset:7168
    v_mfma_f32_32x32x16_bf16 v[32:47], v[80:83], v[180:183], v[32:47]
    v_mfma_f32_32x32x16_bf16 v[48:63], v[84:87], v[180:183], v[48:63]
    ds_read_b64_tr_b16 v[180:181], v235 offset:6144
    ds_read_b64_tr_b16 v[182:183], v235 offset:7168
    s_waitcnt lgkmcnt(2)
    v_mfma_f32_32x32x16_bf16 v[0:15], v[88:91], v[176:179], v[0:15]
    v_mfma_f32_32x32x16_bf16 v[16:31], v[92:95], v[176:179], v[16:31]
    s_add_u32 m0, s25, 6144
    s_waitcnt vmcnt(4) lgkmcnt(0)
    buffer_load_dwordx4 v228, s[4:7], s33 offen lds
    buffer_load_dwordx4 v229, s[8:11], s33 offen offset:1024 lds
    ds_read_b64_tr_b16 v[176:177], v234 offset:0
    ds_read_b64_tr_b16 v[178:179], v234 offset:1024
    v_mfma_f32_32x32x16_bf16 v[32:47], v[88:91], v[180:183], v[32:47]
    v_mfma_f32_32x32x16_bf16 v[48:63], v[92:95], v[180:183], v[48:63]
    ds_read_b64_tr_b16 v[180:181], v235 offset:0
    ds_read_b64_tr_b16 v[182:183], v235 offset:1024
    s_nop 0
    v_mul_f32 v184, v0, v144
    v_fmac_f32 v184, v1, v145
    v_fmac_f32 v184, v2, v146
    v_fmac_f32 v184, v3, v147
    v_fmac_f32 v184, v4, v148
    v_fmac_f32 v184, v5, v149
    v_fmac_f32 v184, v6, v150
    v_fmac_f32 v184, v7, v151
    v_mul_f32 v186, v8, v112
    v_fmac_f32 v186, v9, v113
    v_fmac_f32 v186, v10, v114
    v_fmac_f32 v186, v11, v115
    v_fmac_f32 v186, v12, v116
    v_fmac_f32 v186, v13, v117
    v_fmac_f32 v186, v14, v118
    v_fmac_f32 v186, v15, v119
    s_waitcnt lgkmcnt(2)
    v_mfma_f32_32x32x16_bf16 v[0:15], v[64:67], v[176:179], 0
    v_mul_f32_e64 v188, v16, -v160
    v_fma_f32 v188, v17, -v161, v188
    v_fma_f32 v188, v18, -v162, v188
    v_fma_f32 v188, v19, -v163, v188
    v_fma_f32 v188, v20, -v164, v188
    v_fma_f32 v188, v21, -v165, v188
    v_fma_f32 v188, v22, -v166, v188
    v_fma_f32 v188, v23, -v167, v188
    v_mul_f32 v190, v24, v160
    v_fmac_f32 v190, v25, v161
    v_fmac_f32 v190, v26, v162
    v_fmac_f32 v190, v27, v163
    v_fmac_f32 v190, v28, v164
    v_fmac_f32 v190, v29, v165
    v_fmac_f32 v190, v30, v166
    v_fmac_f32 v190, v31, v167
    v_mfma_f32_32x32x16_bf16 v[16:31], v[68:71], v[176:179], 0
    s_add_u32 m0, s25, 0
    s_waitcnt vmcnt(4) lgkmcnt(0)
    buffer_load_dwordx4 v222, s[4:7], s34 offen lds
    buffer_load_dwordx4 v223, s[8:11], s34 offen offset:1024 lds
    ds_read_b64_tr_b16 v[176:177], v234 offset:2048
    ds_read_b64_tr_b16 v[178:179], v234 offset:3072
    v_mul_f32 v185, v32, v152
    v_fmac_f32 v185, v33, v153
    v_fmac_f32 v185, v34, v154
    v_fmac_f32 v185, v35, v155
    v_fmac_f32 v185, v36, v156
    v_fmac_f32 v185, v37, v157
    v_fmac_f32 v185, v38, v158
    v_fmac_f32 v185, v39, v159
    v_mul_f32 v187, v40, v120
    v_fmac_f32 v187, v41, v121
    v_fmac_f32 v187, v42, v122
    v_fmac_f32 v187, v43, v123
    v_fmac_f32 v187, v44, v124
    v_fmac_f32 v187, v45, v125
    v_fmac_f32 v187, v46, v126
    v_fmac_f32 v187, v47, v127
    v_mfma_f32_32x32x16_bf16 v[32:47], v[64:67], v[180:183], 0
    v_add_u32 v244, s39, v239
    ds_read_u16 v222, v244
    ds_read_u16 v223, v244 offset:64
    v_mul_f32_e64 v189, v48, -v168
    v_fma_f32 v189, v49, -v169, v189
    v_fma_f32 v189, v50, -v170, v189
    v_fma_f32 v189, v51, -v171, v189
    v_fma_f32 v189, v52, -v172, v189
    v_fma_f32 v189, v53, -v173, v189
    v_fma_f32 v189, v54, -v174, v189
    v_fma_f32 v189, v55, -v175, v189
    v_mul_f32 v191, v56, v168
    v_fmac_f32 v191, v57, v169
    v_fmac_f32 v191, v58, v170
    v_fmac_f32 v191, v59, v171
    v_fmac_f32 v191, v60, v172
    v_fmac_f32 v191, v61, v173
    v_fmac_f32 v191, v62, v174
    v_fmac_f32 v191, v63, v175
    v_mfma_f32_32x32x16_bf16 v[48:63], v[68:71], v[180:183], 0
    ds_read_b64_tr_b16 v[180:181], v235 offset:2048
    ds_read_b64_tr_b16 v[182:183], v235 offset:3072
    s_waitcnt lgkmcnt(4)
    v_mfma_f32_32x32x16_bf16 v[0:15], v[72:75], v[176:179], v[0:15]
    v_mfma_f32_32x32x16_bf16 v[16:31], v[76:79], v[176:179], v[16:31]
    s_add_u32 m0, s25, 2048
    s_waitcnt vmcnt(4) lgkmcnt(0)
    buffer_load_dwordx4 v224, s[4:7], s34 offen lds
    buffer_load_dwordx4 v225, s[8:11], s34 offen offset:1024 lds
    ds_read_b64_tr_b16 v[176:177], v234 offset:4096
    ds_read_b64_tr_b16 v[178:179], v234 offset:5120
    v_mfma_f32_32x32x16_bf16 v[32:47], v[72:75], v[180:183], v[32:47]
    v_add_u32 v244, s40, v239
    ds_read_u16 v224, v244
    ds_read_u16 v225, v244 offset:64
    v_mfma_f32_32x32x16_bf16 v[48:63], v[76:79], v[180:183], v[48:63]
    ds_read_b64_tr_b16 v[180:181], v235 offset:4096
    ds_read_b64_tr_b16 v[182:183], v235 offset:5120
    s_waitcnt lgkmcnt(4)
    v_mfma_f32_32x32x16_bf16 v[0:15], v[80:83], v[176:179], v[0:15]
    v_mfma_f32_32x32x16_bf16 v[16:31], v[84:87], v[176:179], v[16:31]
    s_add_u32 m0, s25, 4096
    s_waitcnt vmcnt(4) lgkmcnt(0)
    buffer_load_dwordx4 v226, s[4:7], s34 offen lds
    buffer_load_dwordx4 v227, s[8:11], s34 offen offset:1024 lds
    ds_read_b64_tr_b16 v[176:177], v234 offset:6144
    ds_read_b64_tr_b16 v[178:179], v234 offset:7168
    v_mfma_f32_32x32x16_bf16 v[32:47], v[80:83], v[180:183], v[32:47]
    v_add_u32 v244, s41, v239
    ds_read_u16 v226, v244
    ds_read_u16 v227, v244 offset:64
    v_mfma_f32_32x32x16_bf16 v[48:63], v[84:87], v[180:183], v[48:63]
    ds_read_b64_tr_b16 v[180:181], v235 offset:6144
    ds_read_b64_tr_b16 v[182:183], v235 offset:7168
    s_waitcnt lgkmcnt(4)
    v_mfma_f32_32x32x16_bf16 v[0:15], v[88:91], v[176:179], v[0:15]
    v_mfma_f32_32x32x16_bf16 v[16:31], v[92:95], v[176:179], v[16:31]
    s_add_u32 m0, s25, 6144
    s_waitcnt vmcnt(4) lgkmcnt(0)
    buffer_load_dwordx4 v228, s[4:7], s34 offen lds
    buffer_load_dwordx4 v229, s[8:11], s34 offen offset:1024 lds
    ds_read_b64_tr_b16 v[176:177], v234 offset:0
    ds_read_b64_tr_b16 v[178:179], v234 offset:1024
    v_mfma_f32_32x32x16_bf16 v[32:47], v[88:91], v[180:183], v[32:47]
    v_add_u32 v244, s42, v239
    ds_read_u16 v228, v244
    ds_read_u16 v229, v244 offset:64
    v_mfma_f32_32x32x16_bf16 v[48:63], v[92:95], v[180:183], v[48:63]
    ds_read_b64_tr_b16 v[180:181], v235 offset:0
    ds_read_b64_tr_b16 v[182:183], v235 offset:1024
    v_mul_f32 v246, v0, v144
    v_fmac_f32 v246, v1, v145
    v_fmac_f32 v246, v2, v146
    v_fmac_f32 v246, v3, v147
    v_fmac_f32 v246, v4, v148
    v_fmac_f32 v246, v5, v149
    v_fmac_f32 v246, v6, v150
    v_fmac_f32 v246, v7, v151
    v_fmac_f32 v188, v8, v160
    v_fmac_f32 v188, v9, v161
    v_fmac_f32 v188, v10, v162
    v_fmac_f32 v188, v11, v163
    v_fmac_f32 v188, v12, v164
    v_fmac_f32 v188, v13, v165
    v_fmac_f32 v188, v14, v166
    v_fmac_f32 v188, v15, v167
    s_waitcnt lgkmcnt(4)
    v_mfma_f32_32x32x16_bf16 v[0:15], v[64:67], v[176:179], 0
    v_permlane32_swap_b32 v184, v246
    v_fmac_f32 v186, v16, v112
    v_fmac_f32 v186, v17, v113
    v_fmac_f32 v186, v18, v114
    v_fmac_f32 v186, v19, v115
    v_fmac_f32 v186, v20, v116
    v_fmac_f32 v186, v21, v117
    v_fmac_f32 v186, v22, v118
    v_fmac_f32 v186, v23, v119
    v_add_f32 v246, v184, v246
    v_mul_f32_e64 v184, v24, -v160
    v_fma_f32 v184, v25, -v161, v184
    v_fma_f32 v184, v26, -v162, v184
    v_fma_f32 v184, v27, -v163, v184
    v_fma_f32 v184, v28, -v164, v184
    v_fma_f32 v184, v29, -v165, v184
    v_fma_f32 v184, v30, -v166, v184
    v_fma_f32 v184, v31, -v167, v184
    v_mfma_f32_32x32x16_bf16 v[16:31], v[68:71], v[176:179], 0
    v_lshl_add_u32 v222, v222, 10, v236
    v_lshl_add_u32 v223, v223, 10, v236
    s_add_u32 m0, s25, 0
    s_waitcnt vmcnt(4) lgkmcnt(0)
    buffer_load_dwordx4 v222, s[4:7], s35 offen lds
    buffer_load_dwordx4 v223, s[8:11], s35 offen offset:1024 lds
    ds_read_b64_tr_b16 v[176:177], v234 offset:2048
    ds_read_b64_tr_b16 v[178:179], v234 offset:3072
    v_mul_f32 v247, v32, v152
    v_fmac_f32 v247, v33, v153
    v_fmac_f32 v247, v34, v154
    v_fmac_f32 v247, v35, v155
    v_fmac_f32 v247, v36, v156
    v_fmac_f32 v247, v37, v157
    v_fmac_f32 v247, v38, v158
    v_fmac_f32 v247, v39, v159
    v_fmac_f32 v189, v40, v168
    v_fmac_f32 v189, v41, v169
    v_fmac_f32 v189, v42, v170
    v_fmac_f32 v189, v43, v171
    v_fmac_f32 v189, v44, v172
    v_fmac_f32 v189, v45, v173
    v_fmac_f32 v189, v46, v174
    v_fmac_f32 v189, v47, v175
    v_mfma_f32_32x32x16_bf16 v[32:47], v[64:67], v[180:183], 0
    v_permlane32_swap_b32 v185, v247
    v_fmac_f32 v187, v48, v120
    v_fmac_f32 v187, v49, v121
    v_fmac_f32 v187, v50, v122
    v_fmac_f32 v187, v51, v123
    v_fmac_f32 v187, v52, v124
    v_fmac_f32 v187, v53, v125
    v_fmac_f32 v187, v54, v126
    v_fmac_f32 v187, v55, v127
    v_add_f32 v247, v185, v247
    v_mul_f32_e64 v185, v56, -v168
    v_fma_f32 v185, v57, -v169, v185
    v_fma_f32 v185, v58, -v170, v185
    v_fma_f32 v185, v59, -v171, v185
    v_fma_f32 v185, v60, -v172, v185
    v_fma_f32 v185, v61, -v173, v185
    v_fma_f32 v185, v62, -v174, v185
    v_fma_f32 v185, v63, -v175, v185
    v_mfma_f32_32x32x16_bf16 v[48:63], v[68:71], v[180:183], 0
    ds_read_b64_tr_b16 v[180:181], v235 offset:2048
    ds_read_b64_tr_b16 v[182:183], v235 offset:3072
    s_set_gpr_idx_on s48, gpr_idx(DST)
    s_nop 0
    v_cvt_pk_bf16_f32 v194, v246, v247
    s_set_gpr_idx_off
    s_waitcnt lgkmcnt(2)
    v_mfma_f32_32x32x16_bf16 v[0:15], v[72:75], v[176:179], v[0:15]
    v_mfma_f32_32x32x16_bf16 v[16:31], v[76:79], v[176:179], v[16:31]
    v_lshl_add_u32 v224, v224, 10, v236
    v_lshl_add_u32 v225, v225, 10, v236
    s_add_u32 m0, s25, 2048
    s_waitcnt vmcnt(4) lgkmcnt(0)
    buffer_load_dwordx4 v224, s[4:7], s36 offen lds
    buffer_load_dwordx4 v225, s[8:11], s36 offen offset:1024 lds
    ds_read_b64_tr_b16 v[176:177], v234 offset:4096
    ds_read_b64_tr_b16 v[178:179], v234 offset:5120
    v_mfma_f32_32x32x16_bf16 v[32:47], v[72:75], v[180:183], v[32:47]
    v_mfma_f32_32x32x16_bf16 v[48:63], v[76:79], v[180:183], v[48:63]
    ds_read_b64_tr_b16 v[180:181], v235 offset:4096
    ds_read_b64_tr_b16 v[182:183], v235 offset:5120
    s_waitcnt lgkmcnt(2)
    v_mfma_f32_32x32x16_bf16 v[0:15], v[80:83], v[176:179], v[0:15]
    v_mfma_f32_32x32x16_bf16 v[16:31], v[84:87], v[176:179], v[16:31]
    v_lshl_add_u32 v226, v226, 10, v236
    v_lshl_add_u32 v227, v227, 10, v236
    s_add_u32 m0, s25, 4096
    s_waitcnt vmcnt(4) lgkmcnt(0)
    buffer_load_dwordx4 v226, s[4:7], s37 offen lds
    buffer_load_dwordx4 v227, s[8:11], s37 offen offset:1024 lds
    ds_read_b64_tr_b16 v[176:177], v234 offset:6144
    ds_read_b64_tr_b16 v[178:179], v234 offset:7168
    v_mfma_f32_32x32x16_bf16 v[32:47], v[80:83], v[180:183], v[32:47]
    v_mfma_f32_32x32x16_bf16 v[48:63], v[84:87], v[180:183], v[48:63]
    ds_read_b64_tr_b16 v[180:181], v235 offset:6144
    ds_read_b64_tr_b16 v[182:183], v235 offset:7168
    s_waitcnt lgkmcnt(2)
    v_mfma_f32_32x32x16_bf16 v[0:15], v[88:91], v[176:179], v[0:15]
    v_mfma_f32_32x32x16_bf16 v[16:31], v[92:95], v[176:179], v[16:31]
    v_lshl_add_u32 v228, v228, 10, v236
    v_lshl_add_u32 v229, v229, 10, v236
    s_add_u32 m0, s25, 6144
    s_waitcnt vmcnt(4) lgkmcnt(0)
    buffer_load_dwordx4 v228, s[4:7], s38 offen lds
    buffer_load_dwordx4 v229, s[8:11], s38 offen offset:1024 lds
    ds_read_b64_tr_b16 v[176:177], v234 offset:0
    ds_read_b64_tr_b16 v[178:179], v234 offset:1024
    v_mfma_f32_32x32x16_bf16 v[32:47], v[88:91], v[180:183], v[32:47]
    v_mfma_f32_32x32x16_bf16 v[48:63], v[92:95], v[180:183], v[48:63]
    ds_read_b64_tr_b16 v[180:181], v235 offset:0
    ds_read_b64_tr_b16 v[182:183], v235 offset:1024
    v_add_u32 v241, s45, v237
    v_add_u32 v242, s39, v238
    ds_read_b32 v252, v251 offset:16
    ds_read_b64_tr_b16 v[68:69], v241 offset:0
    ds_read_b64_tr_b16 v[70:71], v241 offset:256
    s_mov_b64 exec, s[50:51]
    ds_read_u16_d16_hi v230, v242 offset:0
    s_mov_b64 exec, -1
    v_mul_f32 v246, v0, v144
    v_fmac_f32 v246, v1, v145
    v_fmac_f32 v246, v2, v146
    v_fmac_f32 v246, v3, v147
    v_fmac_f32 v246, v4, v148
    v_fmac_f32 v246, v5, v149
    v_fmac_f32 v246, v6, v150
    v_fmac_f32 v246, v7, v151
    v_fma_f32 v190, v8, -v160, v190
    v_fma_f32 v190, v9, -v161, v190
    v_fma_f32 v190, v10, -v162, v190
    v_fma_f32 v190, v11, -v163, v190
    v_fma_f32 v190, v12, -v164, v190
    v_fma_f32 v190, v13, -v165, v190
    v_fma_f32 v190, v14, -v166, v190
    v_fma_f32 v190, v15, -v167, v190
    v_fmac_f32 v184, v16, v160
    v_fmac_f32 v184, v17, v161
    v_fmac_f32 v184, v18, v162
    v_fmac_f32 v184, v19, v163
    v_fmac_f32 v184, v20, v164
    v_fmac_f32 v184, v21, v165
    v_fmac_f32 v184, v22, v166
    v_fmac_f32 v184, v23, v167
    v_fmac_f32 v186, v24, v112
    v_fmac_f32 v186, v25, v113
    v_fmac_f32 v186, v26, v114
    v_fmac_f32 v186, v27, v115
    v_fmac_f32 v186, v28, v116
    v_fmac_f32 v186, v29, v117
    v_fmac_f32 v186, v30, v118
    v_fmac_f32 v186, v31, v119
    v_mul_f32 v247, v32, v152
    v_fmac_f32 v247, v33, v153
    v_fmac_f32 v247, v34, v154
    v_fmac_f32 v247, v35, v155
    v_fmac_f32 v247, v36, v156
    v_fmac_f32 v247, v37, v157
    v_fmac_f32 v247, v38, v158
    v_fmac_f32 v247, v39, v159
    v_fma_f32 v191, v40, -v168, v191
    v_fma_f32 v191, v41, -v169, v191
    v_fma_f32 v191, v42, -v170, v191
    v_fma_f32 v191, v43, -v171, v191
    v_fma_f32 v191, v44, -v172, v191
    v_fma_f32 v191, v45, -v173, v191
    v_fma_f32 v191, v46, -v174, v191
    v_fma_f32 v191, v47, -v175, v191
    v_fmac_f32 v185, v48, v168
    v_fmac_f32 v185, v49, v169
    v_fmac_f32 v185, v50, v170
    v_fmac_f32 v185, v51, v171
    v_fmac_f32 v185, v52, v172
    v_fmac_f32 v185, v53, v173
    v_fmac_f32 v185, v54, v174
    v_fmac_f32 v185, v55, v175
    v_fmac_f32 v187, v56, v120
    v_fmac_f32 v187, v57, v121
    v_fmac_f32 v187, v58, v122
    v_fmac_f32 v187, v59, v123
    v_fmac_f32 v187, v60, v124
    v_fmac_f32 v187, v61, v125
    v_fmac_f32 v187, v62, v126
    v_fmac_f32 v187, v63, v127
    s_nop 0
    v_permlane32_swap_b32 v246, v188
    v_permlane32_swap_b32 v190, v244
    v_permlane32_swap_b32 v186, v184
    v_permlane32_swap_b32 v247, v189
    v_permlane32_swap_b32 v191, v245
    v_permlane32_swap_b32 v187, v185
    v_add_f32 v188, v246, v188
    v_add_f32 v244, v190, v244
    v_add_f32 v184, v186, v184
    v_add_f32 v189, v247, v189
    v_add_f32 v245, v191, v245
    v_add_f32 v185, v187, v185
    s_set_gpr_idx_on s48, gpr_idx(DST)
    s_nop 0
    v_cvt_pk_bf16_f32 v195, v188, v189
    v_cvt_pk_bf16_f32 v197, v244, v245
    v_cvt_pk_bf16_f32 v196, v184, v185
    s_set_gpr_idx_off
    s_branch NEXT_0
.p2align 6
ITEM_0_2:
    v_add_u32 v244, s39, v239
    ds_read_u16 v222, v244
    ds_read_u16 v223, v244 offset:64
    v_add_u32 v244, s40, v239
    ds_read_u16 v224, v244
    ds_read_u16 v225, v244 offset:64
    v_add_u32 v244, s41, v239
    ds_read_u16 v226, v244
    ds_read_u16 v227, v244 offset:64
    v_add_u32 v244, s42, v239
    ds_read_u16 v228, v244
    ds_read_u16 v229, v244 offset:64
    v_add_u32 v245, s45, v248
    ds_read_b32 v246, v245
    ds_read_b32 v247, v245 offset:1024
    s_waitcnt lgkmcnt(10)
    v_lshlrev_b32 v184, 16, v68
    v_and_b32 v185, 0xffff0000, v68
    v_lshlrev_b32 v186, 16, v69
    v_and_b32 v187, 0xffff0000, v69
    v_mul_f32_dpp v188, v230, v184 row_newbcast:0 row_mask:0xf bank_mask:0xf
    v_mul_f32_dpp v189, v230, v185 row_newbcast:1 row_mask:0xf bank_mask:0xf
    v_mul_f32_dpp v190, v230, v184 row_newbcast:8 row_mask:0xf bank_mask:0xf
    v_mul_f32_dpp v191, v230, v185 row_newbcast:9 row_mask:0xf bank_mask:0xf
    v_lshlrev_b32 v184, 16, v70
    v_and_b32 v185, 0xffff0000, v70
    v_cvt_pk_bf16_f32 v64, v188, v189
    v_cvt_pk_bf16_f32 v68, v190, v191
    v_mul_f32_dpp v188, v230, v186 row_newbcast:2 row_mask:0xf bank_mask:0xf
    v_mul_f32_dpp v189, v230, v187 row_newbcast:3 row_mask:0xf bank_mask:0xf
    v_mul_f32_dpp v190, v230, v186 row_newbcast:10 row_mask:0xf bank_mask:0xf
    v_mul_f32_dpp v191, v230, v187 row_newbcast:11 row_mask:0xf bank_mask:0xf
    v_lshlrev_b32 v186, 16, v71
    v_and_b32 v187, 0xffff0000, v71
    v_cvt_pk_bf16_f32 v65, v188, v189
    v_cvt_pk_bf16_f32 v69, v190, v191
    v_mul_f32_dpp v188, v230, v184 row_newbcast:4 row_mask:0xf bank_mask:0xf
    v_mul_f32_dpp v189, v230, v185 row_newbcast:5 row_mask:0xf bank_mask:0xf
    v_mul_f32_dpp v190, v230, v184 row_newbcast:12 row_mask:0xf bank_mask:0xf
    v_mul_f32_dpp v191, v230, v185 row_newbcast:13 row_mask:0xf bank_mask:0xf
    v_cvt_pk_bf16_f32 v66, v188, v189
    v_cvt_pk_bf16_f32 v70, v190, v191
    v_mul_f32_dpp v188, v230, v186 row_newbcast:6 row_mask:0xf bank_mask:0xf
    v_mul_f32_dpp v189, v230, v187 row_newbcast:7 row_mask:0xf bank_mask:0xf
    v_mul_f32_dpp v190, v230, v186 row_newbcast:14 row_mask:0xf bank_mask:0xf
    v_mul_f32_dpp v191, v230, v187 row_newbcast:15 row_mask:0xf bank_mask:0xf
    v_cvt_pk_bf16_f32 v67, v188, v189
    v_cvt_pk_bf16_f32 v71, v190, v191
    s_nop 0
    v_mfma_f32_32x32x16_bf16 v[0:15], v[64:67], v[176:179], 0
    v_mfma_f32_32x32x16_bf16 v[16:31], v[68:71], v[176:179], 0
    s_waitcnt lgkmcnt(8)
    v_lshl_add_u32 v222, v222, 10, v236
    v_lshl_add_u32 v223, v223, 10, v236
    s_add_u32 m0, s25, 0
    s_waitcnt vmcnt(4)
    buffer_load_dwordx4 v222, s[4:7], s35 offen lds
    buffer_load_dwordx4 v223, s[8:11], s35 offen offset:1024 lds
    ds_read_b64_tr_b16 v[176:177], v234 offset:2048
    ds_read_b64_tr_b16 v[178:179], v234 offset:3072
    s_waitcnt lgkmcnt(2)
    v_lshl_add_u32 v246, v246, 5, v249
    v_lshl_add_u32 v247, v247, 5, v249
    s_mov_b32 m0, s56
    s_mov_b64 exec, s[52:53]
    buffer_load_dwordx4 v246, s[12:15], 0 offen  lds
    s_mov_b32 m0, s57
    s_mov_b64 exec, s[54:55]
    buffer_load_dwordx4 v247, s[12:15], 0 offen  lds
    s_mov_b64 exec, -1
    v_mfma_f32_32x32x16_bf16 v[32:47], v[64:67], v[180:183], 0
    v_mfma_f32_32x32x16_bf16 v[48:63], v[68:71], v[180:183], 0
    ds_read_b64_tr_b16 v[180:181], v235 offset:2048
    ds_read_b64_tr_b16 v[182:183], v235 offset:3072
    v_mul_f32 v184, v0, v96
    v_fmac_f32 v184, v1, v97
    v_fmac_f32 v184, v2, v98
    v_fmac_f32 v184, v3, v99
    v_fmac_f32 v184, v4, v100
    v_fmac_f32 v184, v5, v101
    v_fmac_f32 v184, v6, v102
    v_fmac_f32 v184, v7, v103
    v_mul_f32 v186, v8, v128
    v_fmac_f32 v186, v9, v129
    v_fmac_f32 v186, v10, v130
    v_fmac_f32 v186, v11, v131
    v_fmac_f32 v186, v12, v132
    v_fmac_f32 v186, v13, v133
    v_fmac_f32 v186, v14, v134
    v_fmac_f32 v186, v15, v135
    s_waitcnt lgkmcnt(2)
    v_mfma_f32_32x32x16_bf16 v[0:15], v[64:67], v[176:179], 0
    v_mul_f32 v188, v16, v128
    v_fmac_f32 v188, v17, v129
    v_fmac_f32 v188, v18, v130
    v_fmac_f32 v188, v19, v131
    v_fmac_f32 v188, v20, v132
    v_fmac_f32 v188, v21, v133
    v_fmac_f32 v188, v22, v134
    v_fmac_f32 v188, v23, v135
    v_mul_f32 v190, v24, v128
    v_fmac_f32 v190, v25, v129
    v_fmac_f32 v190, v26, v130
    v_fmac_f32 v190, v27, v131
    v_fmac_f32 v190, v28, v132
    v_fmac_f32 v190, v29, v133
    v_fmac_f32 v190, v30, v134
    v_fmac_f32 v190, v31, v135
    v_mfma_f32_32x32x16_bf16 v[16:31], v[68:71], v[176:179], 0
    v_lshl_add_u32 v224, v224, 10, v236
    v_lshl_add_u32 v225, v225, 10, v236
    s_add_u32 m0, s25, 2048
    s_waitcnt vmcnt(6) lgkmcnt(0)
    buffer_load_dwordx4 v224, s[4:7], s36 offen lds
    buffer_load_dwordx4 v225, s[8:11], s36 offen offset:1024 lds
    ds_read_b64_tr_b16 v[176:177], v234 offset:4096
    ds_read_b64_tr_b16 v[178:179], v234 offset:5120
    v_mul_f32 v185, v32, v104
    v_fmac_f32 v185, v33, v105
    v_fmac_f32 v185, v34, v106
    v_fmac_f32 v185, v35, v107
    v_fmac_f32 v185, v36, v108
    v_fmac_f32 v185, v37, v109
    v_fmac_f32 v185, v38, v110
    v_fmac_f32 v185, v39, v111
    v_mul_f32 v187, v40, v136
    v_fmac_f32 v187, v41, v137
    v_fmac_f32 v187, v42, v138
    v_fmac_f32 v187, v43, v139
    v_fmac_f32 v187, v44, v140
    v_fmac_f32 v187, v45, v141
    v_fmac_f32 v187, v46, v142
    v_fmac_f32 v187, v47, v143
    v_mfma_f32_32x32x16_bf16 v[32:47], v[64:67], v[180:183], 0
    v_mul_f32 v189, v48, v136
    v_fmac_f32 v189, v49, v137
    v_fmac_f32 v189, v50, v138
    v_fmac_f32 v189, v51, v139
    v_fmac_f32 v189, v52, v140
    v_fmac_f32 v189, v53, v141
    v_fmac_f32 v189, v54, v142
    v_fmac_f32 v189, v55, v143
    v_mul_f32 v191, v56, v136
    v_fmac_f32 v191, v57, v137
    v_fmac_f32 v191, v58, v138
    v_fmac_f32 v191, v59, v139
    v_fmac_f32 v191, v60, v140
    v_fmac_f32 v191, v61, v141
    v_fmac_f32 v191, v62, v142
    v_fmac_f32 v191, v63, v143
    v_mfma_f32_32x32x16_bf16 v[48:63], v[68:71], v[180:183], 0
    ds_read_b64_tr_b16 v[180:181], v235 offset:4096
    ds_read_b64_tr_b16 v[182:183], v235 offset:5120
    v_permlane32_swap_b32 v184, v186
    v_permlane32_swap_b32 v188, v190
    v_permlane32_swap_b32 v185, v187
    v_permlane32_swap_b32 v189, v191
    v_add_f32 v186, v184, v186
    v_add_f32 v190, v188, v190
    v_add_f32 v187, v185, v187
    v_add_f32 v191, v189, v191
    s_set_gpr_idx_on s48, gpr_idx(DST)
    s_nop 0
    v_cvt_pk_bf16_f32 v192, v186, v187
    v_cvt_pk_bf16_f32 v193, v190, v191
    s_set_gpr_idx_off
    v_mul_f32 v184, v0, v144
    v_fmac_f32 v184, v1, v145
    v_fmac_f32 v184, v2, v146
    v_fmac_f32 v184, v3, v147
    v_fmac_f32 v184, v4, v148
    v_fmac_f32 v184, v5, v149
    v_fmac_f32 v184, v6, v150
    v_fmac_f32 v184, v7, v151
    v_mul_f32 v186, v8, v112
    v_fmac_f32 v186, v9, v113
    v_fmac_f32 v186, v10, v114
    v_fmac_f32 v186, v11, v115
    v_fmac_f32 v186, v12, v116
    v_fmac_f32 v186, v13, v117
    v_fmac_f32 v186, v14, v118
    v_fmac_f32 v186, v15, v119
    s_waitcnt lgkmcnt(2)
    v_mfma_f32_32x32x16_bf16 v[0:15], v[64:67], v[176:179], 0
    v_mul_f32_e64 v188, v16, -v160
    v_fma_f32 v188, v17, -v161, v188
    v_fma_f32 v188, v18, -v162, v188
    v_fma_f32 v188, v19, -v163, v188
    v_fma_f32 v188, v20, -v164, v188
    v_fma_f32 v188, v21, -v165, v188
    v_fma_f32 v188, v22, -v166, v188
    v_fma_f32 v188, v23, -v167, v188
    v_mul_f32 v190, v24, v160
    v_fmac_f32 v190, v25, v161
    v_fmac_f32 v190, v26, v162
    v_fmac_f32 v190, v27, v163
    v_fmac_f32 v190, v28, v164
    v_fmac_f32 v190, v29, v165
    v_fmac_f32 v190, v30, v166
    v_fmac_f32 v190, v31, v167
    v_mfma_f32_32x32x16_bf16 v[16:31], v[68:71], v[176:179], 0
    v_lshl_add_u32 v226, v226, 10, v236
    v_lshl_add_u32 v227, v227, 10, v236
    s_add_u32 m0, s25, 4096
    s_waitcnt vmcnt(6) lgkmcnt(0)
    buffer_load_dwordx4 v226, s[4:7], s37 offen lds
    buffer_load_dwordx4 v227, s[8:11], s37 offen offset:1024 lds
    ds_read_b64_tr_b16 v[176:177], v234 offset:6144
    ds_read_b64_tr_b16 v[178:179], v234 offset:7168
    v_mul_f32 v185, v32, v152
    v_fmac_f32 v185, v33, v153
    v_fmac_f32 v185, v34, v154
    v_fmac_f32 v185, v35, v155
    v_fmac_f32 v185, v36, v156
    v_fmac_f32 v185, v37, v157
    v_fmac_f32 v185, v38, v158
    v_fmac_f32 v185, v39, v159
    v_mul_f32 v187, v40, v120
    v_fmac_f32 v187, v41, v121
    v_fmac_f32 v187, v42, v122
    v_fmac_f32 v187, v43, v123
    v_fmac_f32 v187, v44, v124
    v_fmac_f32 v187, v45, v125
    v_fmac_f32 v187, v46, v126
    v_fmac_f32 v187, v47, v127
    v_mfma_f32_32x32x16_bf16 v[32:47], v[64:67], v[180:183], 0
    v_mul_f32_e64 v189, v48, -v168
    v_fma_f32 v189, v49, -v169, v189
    v_fma_f32 v189, v50, -v170, v189
    v_fma_f32 v189, v51, -v171, v189
    v_fma_f32 v189, v52, -v172, v189
    v_fma_f32 v189, v53, -v173, v189
    v_fma_f32 v189, v54, -v174, v189
    v_fma_f32 v189, v55, -v175, v189
    v_mul_f32 v191, v56, v168
    v_fmac_f32 v191, v57, v169
    v_fmac_f32 v191, v58, v170
    v_fmac_f32 v191, v59, v171
    v_fmac_f32 v191, v60, v172
    v_fmac_f32 v191, v61, v173
    v_fmac_f32 v191, v62, v174
    v_fmac_f32 v191, v63, v175
    v_mfma_f32_32x32x16_bf16 v[48:63], v[68:71], v[180:183], 0
    ds_read_b64_tr_b16 v[180:181], v235 offset:6144
    ds_read_b64_tr_b16 v[182:183], v235 offset:7168
    v_mul_f32 v246, v0, v144
    v_fmac_f32 v246, v1, v145
    v_fmac_f32 v246, v2, v146
    v_fmac_f32 v246, v3, v147
    v_fmac_f32 v246, v4, v148
    v_fmac_f32 v246, v5, v149
    v_fmac_f32 v246, v6, v150
    v_fmac_f32 v246, v7, v151
    v_fmac_f32 v188, v8, v160
    v_fmac_f32 v188, v9, v161
    v_fmac_f32 v188, v10, v162
    v_fmac_f32 v188, v11, v163
    v_fmac_f32 v188, v12, v164
    v_fmac_f32 v188, v13, v165
    v_fmac_f32 v188, v14, v166
    v_fmac_f32 v188, v15, v167
    s_waitcnt lgkmcnt(2)
    v_mfma_f32_32x32x16_bf16 v[0:15], v[64:67], v[176:179], 0
    v_permlane32_swap_b32 v184, v246
    v_fmac_f32 v186, v16, v112
    v_fmac_f32 v186, v17, v113
    v_fmac_f32 v186, v18, v114
    v_fmac_f32 v186, v19, v115
    v_fmac_f32 v186, v20, v116
    v_fmac_f32 v186, v21, v117
    v_fmac_f32 v186, v22, v118
    v_fmac_f32 v186, v23, v119
    v_add_f32 v246, v184, v246
    v_mul_f32_e64 v184, v24, -v160
    v_fma_f32 v184, v25, -v161, v184
    v_fma_f32 v184, v26, -v162, v184
    v_fma_f32 v184, v27, -v163, v184
    v_fma_f32 v184, v28, -v164, v184
    v_fma_f32 v184, v29, -v165, v184
    v_fma_f32 v184, v30, -v166, v184
    v_fma_f32 v184, v31, -v167, v184
    v_mfma_f32_32x32x16_bf16 v[16:31], v[68:71], v[176:179], 0
    v_lshl_add_u32 v228, v228, 10, v236
    v_lshl_add_u32 v229, v229, 10, v236
    s_add_u32 m0, s25, 6144
    s_waitcnt vmcnt(6) lgkmcnt(0)
    buffer_load_dwordx4 v228, s[4:7], s38 offen lds
    buffer_load_dwordx4 v229, s[8:11], s38 offen offset:1024 lds
    ds_read_b64_tr_b16 v[176:177], v234 offset:0
    ds_read_b64_tr_b16 v[178:179], v234 offset:1024
    v_mul_f32 v247, v32, v152
    v_fmac_f32 v247, v33, v153
    v_fmac_f32 v247, v34, v154
    v_fmac_f32 v247, v35, v155
    v_fmac_f32 v247, v36, v156
    v_fmac_f32 v247, v37, v157
    v_fmac_f32 v247, v38, v158
    v_fmac_f32 v247, v39, v159
    v_fmac_f32 v189, v40, v168
    v_fmac_f32 v189, v41, v169
    v_fmac_f32 v189, v42, v170
    v_fmac_f32 v189, v43, v171
    v_fmac_f32 v189, v44, v172
    v_fmac_f32 v189, v45, v173
    v_fmac_f32 v189, v46, v174
    v_fmac_f32 v189, v47, v175
    v_mfma_f32_32x32x16_bf16 v[32:47], v[64:67], v[180:183], 0
    v_permlane32_swap_b32 v185, v247
    v_fmac_f32 v187, v48, v120
    v_fmac_f32 v187, v49, v121
    v_fmac_f32 v187, v50, v122
    v_fmac_f32 v187, v51, v123
    v_fmac_f32 v187, v52, v124
    v_fmac_f32 v187, v53, v125
    v_fmac_f32 v187, v54, v126
    v_fmac_f32 v187, v55, v127
    v_add_f32 v247, v185, v247
    v_mul_f32_e64 v185, v56, -v168
    v_fma_f32 v185, v57, -v169, v185
    v_fma_f32 v185, v58, -v170, v185
    v_fma_f32 v185, v59, -v171, v185
    v_fma_f32 v185, v60, -v172, v185
    v_fma_f32 v185, v61, -v173, v185
    v_fma_f32 v185, v62, -v174, v185
    v_fma_f32 v185, v63, -v175, v185
    v_mfma_f32_32x32x16_bf16 v[48:63], v[68:71], v[180:183], 0
    ds_read_b64_tr_b16 v[180:181], v235 offset:0
    ds_read_b64_tr_b16 v[182:183], v235 offset:1024
    s_set_gpr_idx_on s48, gpr_idx(DST)
    s_nop 0
    v_cvt_pk_bf16_f32 v194, v246, v247
    s_set_gpr_idx_off
    s_waitcnt vmcnt(6)
    v_add_u32 v241, s45, v237
    v_add_u32 v242, s39, v238
    ds_read_b32 v252, v251 offset:16
    ds_read_b64_tr_b16 v[68:69], v241 offset:0
    ds_read_b64_tr_b16 v[70:71], v241 offset:256
    s_mov_b64 exec, s[50:51]
    ds_read_u16_d16_hi v230, v242 offset:0
    s_mov_b64 exec, -1
    v_mul_f32 v246, v0, v144
    v_fmac_f32 v246, v1, v145
    v_fmac_f32 v246, v2, v146
    v_fmac_f32 v246, v3, v147
    v_fmac_f32 v246, v4, v148
    v_fmac_f32 v246, v5, v149
    v_fmac_f32 v246, v6, v150
    v_fmac_f32 v246, v7, v151
    v_fma_f32 v190, v8, -v160, v190
    v_fma_f32 v190, v9, -v161, v190
    v_fma_f32 v190, v10, -v162, v190
    v_fma_f32 v190, v11, -v163, v190
    v_fma_f32 v190, v12, -v164, v190
    v_fma_f32 v190, v13, -v165, v190
    v_fma_f32 v190, v14, -v166, v190
    v_fma_f32 v190, v15, -v167, v190
    v_fmac_f32 v184, v16, v160
    v_fmac_f32 v184, v17, v161
    v_fmac_f32 v184, v18, v162
    v_fmac_f32 v184, v19, v163
    v_fmac_f32 v184, v20, v164
    v_fmac_f32 v184, v21, v165
    v_fmac_f32 v184, v22, v166
    v_fmac_f32 v184, v23, v167
    v_fmac_f32 v186, v24, v112
    v_fmac_f32 v186, v25, v113
    v_fmac_f32 v186, v26, v114
    v_fmac_f32 v186, v27, v115
    v_fmac_f32 v186, v28, v116
    v_fmac_f32 v186, v29, v117
    v_fmac_f32 v186, v30, v118
    v_fmac_f32 v186, v31, v119
    v_mul_f32 v247, v32, v152
    v_fmac_f32 v247, v33, v153
    v_fmac_f32 v247, v34, v154
    v_fmac_f32 v247, v35, v155
    v_fmac_f32 v247, v36, v156
    v_fmac_f32 v247, v37, v157
    v_fmac_f32 v247, v38, v158
    v_fmac_f32 v247, v39, v159
    v_fma_f32 v191, v40, -v168, v191
    v_fma_f32 v191, v41, -v169, v191
    v_fma_f32 v191, v42, -v170, v191
    v_fma_f32 v191, v43, -v171, v191
    v_fma_f32 v191, v44, -v172, v191
    v_fma_f32 v191, v45, -v173, v191
    v_fma_f32 v191, v46, -v174, v191
    v_fma_f32 v191, v47, -v175, v191
    v_fmac_f32 v185, v48, v168
    v_fmac_f32 v185, v49, v169
    v_fmac_f32 v185, v50, v170
    v_fmac_f32 v185, v51, v171
    v_fmac_f32 v185, v52, v172
    v_fmac_f32 v185, v53, v173
    v_fmac_f32 v185, v54, v174
    v_fmac_f32 v185, v55, v175
    v_fmac_f32 v187, v56, v120
    v_fmac_f32 v187, v57, v121
    v_fmac_f32 v187, v58, v122
    v_fmac_f32 v187, v59, v123
    v_fmac_f32 v187, v60, v124
    v_fmac_f32 v187, v61, v125
    v_fmac_f32 v187, v62, v126
    v_fmac_f32 v187, v63, v127
    s_nop 0
    v_permlane32_swap_b32 v246, v188
    v_permlane32_swap_b32 v190, v244
    v_permlane32_swap_b32 v186, v184
    v_permlane32_swap_b32 v247, v189
    v_permlane32_swap_b32 v191, v245
    v_permlane32_swap_b32 v187, v185
    v_add_f32 v188, v246, v188
    v_add_f32 v244, v190, v244
    v_add_f32 v184, v186, v184
    v_add_f32 v189, v247, v189
    v_add_f32 v245, v191, v245
    v_add_f32 v185, v187, v185
    s_set_gpr_idx_on s48, gpr_idx(DST)
    s_nop 0
    v_cvt_pk_bf16_f32 v195, v188, v189
    v_cvt_pk_bf16_f32 v197, v244, v245
    v_cvt_pk_bf16_f32 v196, v184, v185
    s_set_gpr_idx_off
    s_branch NEXT_0
.p2align 6
ITEM_1_4:
    ds_read_b64_tr_b16 v[76:77], v241 offset:512
    ds_read_b64_tr_b16 v[78:79], v241 offset:768
    s_mov_b64 exec, s[50:51]
    ds_read_u16_d16_hi v231, v242 offset:128
    s_mov_b64 exec, -1
    v_add_u32 v244, s41, v239
    ds_read_u16 v226, v244
    ds_read_u16 v227, v244 offset:64
    v_add_u32 v244, s42, v239
    ds_read_u16 v228, v244
    ds_read_u16 v229, v244 offset:64
    v_xor_b32 v243, s65, v240
    v_add_u32 v243, s46, v243
    s_waitcnt lgkmcnt(7)
    v_lshlrev_b32 v184, 16, v68
    v_and_b32 v185, 0xffff0000, v68
    v_lshlrev_b32 v186, 16, v69
    v_and_b32 v187, 0xffff0000, v69
    v_mul_f32_dpp v188, v230, v184 row_newbcast:0 row_mask:0xf bank_mask:0xf
    v_mul_f32_dpp v189, v230, v185 row_newbcast:1 row_mask:0xf bank_mask:0xf
    v_mul_f32_dpp v190, v230, v184 row_newbcast:8 row_mask:0xf bank_mask:0xf
    v_mul_f32_dpp v191, v230, v185 row_newbcast:9 row_mask:0xf bank_mask:0xf
    v_lshlrev_b32 v184, 16, v70
    v_and_b32 v185, 0xffff0000, v70
    v_cvt_pk_bf16_f32 v64, v188, v189
    v_cvt_pk_bf16_f32 v68, v190, v191
    v_mul_f32_dpp v188, v230, v186 row_newbcast:2 row_mask:0xf bank_mask:0xf
    v_mul_f32_dpp v189, v230, v187 row_newbcast:3 row_mask:0xf bank_mask:0xf
    v_mul_f32_dpp v190, v230, v186 row_newbcast:10 row_mask:0xf bank_mask:0xf
    v_mul_f32_dpp v191, v230, v187 row_newbcast:11 row_mask:0xf bank_mask:0xf
    v_lshlrev_b32 v186, 16, v71
    v_and_b32 v187, 0xffff0000, v71
    v_cvt_pk_bf16_f32 v65, v188, v189
    v_cvt_pk_bf16_f32 v69, v190, v191
    v_mul_f32_dpp v188, v230, v184 row_newbcast:4 row_mask:0xf bank_mask:0xf
    v_mul_f32_dpp v189, v230, v185 row_newbcast:5 row_mask:0xf bank_mask:0xf
    v_mul_f32_dpp v190, v230, v184 row_newbcast:12 row_mask:0xf bank_mask:0xf
    v_mul_f32_dpp v191, v230, v185 row_newbcast:13 row_mask:0xf bank_mask:0xf
    v_cvt_pk_bf16_f32 v66, v188, v189
    v_cvt_pk_bf16_f32 v70, v190, v191
    v_mul_f32_dpp v188, v230, v186 row_newbcast:6 row_mask:0xf bank_mask:0xf
    v_mul_f32_dpp v189, v230, v187 row_newbcast:7 row_mask:0xf bank_mask:0xf
    v_mul_f32_dpp v190, v230, v186 row_newbcast:14 row_mask:0xf bank_mask:0xf
    v_mul_f32_dpp v191, v230, v187 row_newbcast:15 row_mask:0xf bank_mask:0xf
    v_cvt_pk_bf16_f32 v67, v188, v189
    v_cvt_pk_bf16_f32 v71, v190, v191
    s_nop 0
    s_waitcnt lgkmcnt(4)
    v_mfma_f32_32x32x16_bf16 v[0:15], v[64:67], v[176:179], 0
    v_lshlrev_b32 v184, 16, v76
    v_and_b32 v185, 0xffff0000, v76
    v_lshlrev_b32 v186, 16, v77
    v_and_b32 v187, 0xffff0000, v77
    v_mul_f32_dpp v188, v231, v184 row_newbcast:0 row_mask:0xf bank_mask:0xf
    v_mul_f32_dpp v189, v231, v185 row_newbcast:1 row_mask:0xf bank_mask:0xf
    v_mul_f32_dpp v190, v231, v184 row_newbcast:8 row_mask:0xf bank_mask:0xf
    v_mul_f32_dpp v191, v231, v185 row_newbcast:9 row_mask:0xf bank_mask:0xf
    v_mfma_f32_32x32x16_bf16 v[16:31], v[68:71], v[176:179], 0
    s_add_u32 m0, s25, 0
    s_waitcnt vmcnt(4)
    buffer_load_dwordx4 v222, s[4:7], s33 offen lds
    buffer_load_dwordx4 v223, s[8:11], s33 offen offset:1024 lds
    ds_read_b64_tr_b16 v[176:177], v234 offset:2048
    ds_read_b64_tr_b16 v[178:179], v234 offset:3072
    v_lshlrev_b32 v184, 16, v78
    v_and_b32 v185, 0xffff0000, v78
    v_cvt_pk_bf16_f32 v72, v188, v189
    v_cvt_pk_bf16_f32 v76, v190, v191
    v_mul_f32_dpp v188, v231, v186 row_newbcast:2 row_mask:0xf bank_mask:0xf
    v_mul_f32_dpp v189, v231, v187 row_newbcast:3 row_mask:0xf bank_mask:0xf
    v_mul_f32_dpp v190, v231, v186 row_newbcast:10 row_mask:0xf bank_mask:0xf
    v_mul_f32_dpp v191, v231, v187 row_newbcast:11 row_mask:0xf bank_mask:0xf
    v_mfma_f32_32x32x16_bf16 v[32:47], v[64:67], v[180:183], 0
    v_lshlrev_b32 v186, 16, v79
    v_and_b32 v187, 0xffff0000, v79
    v_cvt_pk_bf16_f32 v73, v188, v189
    v_cvt_pk_bf16_f32 v77, v190, v191
    v_mul_f32_dpp v188, v231, v184 row_newbcast:4 row_mask:0xf bank_mask:0xf
    v_mul_f32_dpp v189, v231, v185 row_newbcast:5 row_mask:0xf bank_mask:0xf
    v_mul_f32_dpp v190, v231, v184 row_newbcast:12 row_mask:0xf bank_mask:0xf
    v_mul_f32_dpp v191, v231, v185 row_newbcast:13 row_mask:0xf bank_mask:0xf
    v_mfma_f32_32x32x16_bf16 v[48:63], v[68:71], v[180:183], 0
    ds_read_b64_tr_b16 v[180:181], v235 offset:2048
    ds_read_b64_tr_b16 v[182:183], v235 offset:3072
    v_cvt_pk_bf16_f32 v74, v188, v189
    v_cvt_pk_bf16_f32 v78, v190, v191
    v_mul_f32_dpp v188, v231, v186 row_newbcast:6 row_mask:0xf bank_mask:0xf
    v_mul_f32_dpp v189, v231, v187 row_newbcast:7 row_mask:0xf bank_mask:0xf
    v_mul_f32_dpp v190, v231, v186 row_newbcast:14 row_mask:0xf bank_mask:0xf
    v_mul_f32_dpp v191, v231, v187 row_newbcast:15 row_mask:0xf bank_mask:0xf
    v_cvt_pk_bf16_f32 v75, v188, v189
    v_cvt_pk_bf16_f32 v79, v190, v191
    s_nop 0
    s_waitcnt lgkmcnt(2)
    v_mfma_f32_32x32x16_bf16 v[0:15], v[72:75], v[176:179], v[0:15]
    v_mfma_f32_32x32x16_bf16 v[16:31], v[76:79], v[176:179], v[16:31]
    s_add_u32 m0, s25, 2048
    s_waitcnt vmcnt(4) lgkmcnt(0)
    buffer_load_dwordx4 v224, s[4:7], s33 offen lds
    buffer_load_dwordx4 v225, s[8:11], s33 offen offset:1024 lds
    ds_read_b64_tr_b16 v[176:177], v234 offset:4096
    ds_read_b64_tr_b16 v[178:179], v234 offset:5120
    v_mfma_f32_32x32x16_bf16 v[32:47], v[72:75], v[180:183], v[32:47]
    v_mfma_f32_32x32x16_bf16 v[48:63], v[76:79], v[180:183], v[48:63]
    ds_read_b64_tr_b16 v[180:181], v235 offset:4096
    ds_read_b64_tr_b16 v[182:183], v235 offset:5120
    s_nop 0
    v_mul_f32 v184, v0, v96
    v_fmac_f32 v184, v1, v97
    v_fmac_f32 v184, v2, v98
    v_fmac_f32 v184, v3, v99
    v_fmac_f32 v184, v4, v100
    v_fmac_f32 v184, v5, v101
    v_fmac_f32 v184, v6, v102
    v_fmac_f32 v184, v7, v103
    v_mul_f32 v186, v8, v128
    v_fmac_f32 v186, v9, v129
    v_fmac_f32 v186, v10, v130
    v_fmac_f32 v186, v11, v131
    v_fmac_f32 v186, v12, v132
    v_fmac_f32 v186, v13, v133
    v_fmac_f32 v186, v14, v134
    v_fmac_f32 v186, v15, v135
    s_waitcnt lgkmcnt(2)
    v_mfma_f32_32x32x16_bf16 v[0:15], v[64:67], v[176:179], 0
    v_mul_f32 v188, v16, v128
    v_fmac_f32 v188, v17, v129
    v_fmac_f32 v188, v18, v130
    v_fmac_f32 v188, v19, v131
    v_fmac_f32 v188, v20, v132
    v_fmac_f32 v188, v21, v133
    v_fmac_f32 v188, v22, v134
    v_fmac_f32 v188, v23, v135
    v_mul_f32 v190, v24, v128
    v_fmac_f32 v190, v25, v129
    v_fmac_f32 v190, v26, v130
    v_fmac_f32 v190, v27, v131
    v_fmac_f32 v190, v28, v132
    v_fmac_f32 v190, v29, v133
    v_fmac_f32 v190, v30, v134
    v_fmac_f32 v190, v31, v135
    v_mfma_f32_32x32x16_bf16 v[16:31], v[68:71], v[176:179], 0
    s_add_u32 m0, s25, 4096
    s_waitcnt vmcnt(4) lgkmcnt(0)
    buffer_load_dwordx4 v222, s[4:7], s34 offen lds
    buffer_load_dwordx4 v223, s[8:11], s34 offen offset:1024 lds
    ds_read_b64_tr_b16 v[176:177], v234 offset:6144
    ds_read_b64_tr_b16 v[178:179], v234 offset:7168
    v_mul_f32 v185, v32, v104
    v_fmac_f32 v185, v33, v105
    v_fmac_f32 v185, v34, v106
    v_fmac_f32 v185, v35, v107
    v_fmac_f32 v185, v36, v108
    v_fmac_f32 v185, v37, v109
    v_fmac_f32 v185, v38, v110
    v_fmac_f32 v185, v39, v111
    v_mul_f32 v187, v40, v136
    v_fmac_f32 v187, v41, v137
    v_fmac_f32 v187, v42, v138
    v_fmac_f32 v187, v43, v139
    v_fmac_f32 v187, v44, v140
    v_fmac_f32 v187, v45, v141
    v_fmac_f32 v187, v46, v142
    v_fmac_f32 v187, v47, v143
    v_mfma_f32_32x32x16_bf16 v[32:47], v[64:67], v[180:183], 0
    v_add_u32 v244, s39, v239
    ds_read_u16 v222, v244
    ds_read_u16 v223, v244 offset:64
    v_mul_f32 v189, v48, v136
    v_fmac_f32 v189, v49, v137
    v_fmac_f32 v189, v50, v138
    v_fmac_f32 v189, v51, v139
    v_fmac_f32 v189, v52, v140
    v_fmac_f32 v189, v53, v141
    v_fmac_f32 v189, v54, v142
    v_fmac_f32 v189, v55, v143
    v_mul_f32 v191, v56, v136
    v_fmac_f32 v191, v57, v137
    v_fmac_f32 v191, v58, v138
    v_fmac_f32 v191, v59, v139
    v_fmac_f32 v191, v60, v140
    v_fmac_f32 v191, v61, v141
    v_fmac_f32 v191, v62, v142
    v_fmac_f32 v191, v63, v143
    v_mfma_f32_32x32x16_bf16 v[48:63], v[68:71], v[180:183], 0
    ds_read_b64_tr_b16 v[180:181], v235 offset:6144
    ds_read_b64_tr_b16 v[182:183], v235 offset:7168
    v_permlane32_swap_b32 v184, v186
    v_permlane32_swap_b32 v188, v190
    v_permlane32_swap_b32 v185, v187
    v_permlane32_swap_b32 v189, v191
    v_add_f32 v186, v184, v186
    v_add_f32 v190, v188, v190
    v_add_f32 v187, v185, v187
    v_add_f32 v191, v189, v191
    v_cvt_pk_bf16_f32 v186, v186, v187
    v_cvt_pk_bf16_f32 v190, v190, v191
    ds_write_b32 v243, v186 offset:0
    ds_write_b32 v243, v190 offset:256
    s_waitcnt lgkmcnt(6)
    v_mfma_f32_32x32x16_bf16 v[0:15], v[72:75], v[176:179], v[0:15]
    v_mfma_f32_32x32x16_bf16 v[16:31], v[76:79], v[176:179], v[16:31]
    s_add_u32 m0, s25, 6144
    s_waitcnt vmcnt(4) lgkmcnt(2)
    buffer_load_dwordx4 v224, s[4:7], s34 offen lds
    buffer_load_dwordx4 v225, s[8:11], s34 offen offset:1024 lds
    ds_read_b64_tr_b16 v[176:177], v234 offset:0
    ds_read_b64_tr_b16 v[178:179], v234 offset:1024
    v_mfma_f32_32x32x16_bf16 v[32:47], v[72:75], v[180:183], v[32:47]
    v_add_u32 v244, s40, v239
    ds_read_u16 v224, v244
    ds_read_u16 v225, v244 offset:64
    v_mfma_f32_32x32x16_bf16 v[48:63], v[76:79], v[180:183], v[48:63]
    ds_read_b64_tr_b16 v[180:181], v235 offset:0
    ds_read_b64_tr_b16 v[182:183], v235 offset:1024
    v_mul_f32 v184, v0, v144
    v_fmac_f32 v184, v1, v145
    v_fmac_f32 v184, v2, v146
    v_fmac_f32 v184, v3, v147
    v_fmac_f32 v184, v4, v148
    v_fmac_f32 v184, v5, v149
    v_fmac_f32 v184, v6, v150
    v_fmac_f32 v184, v7, v151
    v_mul_f32 v186, v8, v112
    v_fmac_f32 v186, v9, v113
    v_fmac_f32 v186, v10, v114
    v_fmac_f32 v186, v11, v115
    v_fmac_f32 v186, v12, v116
    v_fmac_f32 v186, v13, v117
    v_fmac_f32 v186, v14, v118
    v_fmac_f32 v186, v15, v119
    s_waitcnt lgkmcnt(4)
    v_mfma_f32_32x32x16_bf16 v[0:15], v[64:67], v[176:179], 0
    v_mul_f32_e64 v188, v16, -v160
    v_fma_f32 v188, v17, -v161, v188
    v_fma_f32 v188, v18, -v162, v188
    v_fma_f32 v188, v19, -v163, v188
    v_fma_f32 v188, v20, -v164, v188
    v_fma_f32 v188, v21, -v165, v188
    v_fma_f32 v188, v22, -v166, v188
    v_fma_f32 v188, v23, -v167, v188
    v_mul_f32 v190, v24, v160
    v_fmac_f32 v190, v25, v161
    v_fmac_f32 v190, v26, v162
    v_fmac_f32 v190, v27, v163
    v_fmac_f32 v190, v28, v164
    v_fmac_f32 v190, v29, v165
    v_fmac_f32 v190, v30, v166
    v_fmac_f32 v190, v31, v167
    v_mfma_f32_32x32x16_bf16 v[16:31], v[68:71], v[176:179], 0
    v_lshl_add_u32 v222, v222, 10, v236
    v_lshl_add_u32 v223, v223, 10, v236
    s_add_u32 m0, s25, 0
    s_waitcnt vmcnt(4) lgkmcnt(0)
    buffer_load_dwordx4 v222, s[4:7], s35 offen lds
    buffer_load_dwordx4 v223, s[8:11], s35 offen offset:1024 lds
    ds_read_b64_tr_b16 v[176:177], v234 offset:2048
    ds_read_b64_tr_b16 v[178:179], v234 offset:3072
    v_mul_f32 v185, v32, v152
    v_fmac_f32 v185, v33, v153
    v_fmac_f32 v185, v34, v154
    v_fmac_f32 v185, v35, v155
    v_fmac_f32 v185, v36, v156
    v_fmac_f32 v185, v37, v157
    v_fmac_f32 v185, v38, v158
    v_fmac_f32 v185, v39, v159
    v_mul_f32 v187, v40, v120
    v_fmac_f32 v187, v41, v121
    v_fmac_f32 v187, v42, v122
    v_fmac_f32 v187, v43, v123
    v_fmac_f32 v187, v44, v124
    v_fmac_f32 v187, v45, v125
    v_fmac_f32 v187, v46, v126
    v_fmac_f32 v187, v47, v127
    v_mfma_f32_32x32x16_bf16 v[32:47], v[64:67], v[180:183], 0
    v_mul_f32_e64 v189, v48, -v168
    v_fma_f32 v189, v49, -v169, v189
    v_fma_f32 v189, v50, -v170, v189
    v_fma_f32 v189, v51, -v171, v189
    v_fma_f32 v189, v52, -v172, v189
    v_fma_f32 v189, v53, -v173, v189
    v_fma_f32 v189, v54, -v174, v189
    v_fma_f32 v189, v55, -v175, v189
    v_mul_f32 v191, v56, v168
    v_fmac_f32 v191, v57, v169
    v_fmac_f32 v191, v58, v170
    v_fmac_f32 v191, v59, v171
    v_fmac_f32 v191, v60, v172
    v_fmac_f32 v191, v61, v173
    v_fmac_f32 v191, v62, v174
    v_fmac_f32 v191, v63, v175
    v_mfma_f32_32x32x16_bf16 v[48:63], v[68:71], v[180:183], 0
    ds_read_b64_tr_b16 v[180:181], v235 offset:2048
    ds_read_b64_tr_b16 v[182:183], v235 offset:3072
    s_waitcnt lgkmcnt(2)
    v_mfma_f32_32x32x16_bf16 v[0:15], v[72:75], v[176:179], v[0:15]
    v_mfma_f32_32x32x16_bf16 v[16:31], v[76:79], v[176:179], v[16:31]
    v_lshl_add_u32 v224, v224, 10, v236
    v_lshl_add_u32 v225, v225, 10, v236
    s_add_u32 m0, s25, 2048
    s_waitcnt vmcnt(4) lgkmcnt(0)
    buffer_load_dwordx4 v224, s[4:7], s36 offen lds
    buffer_load_dwordx4 v225, s[8:11], s36 offen offset:1024 lds
    ds_read_b64_tr_b16 v[176:177], v234 offset:4096
    ds_read_b64_tr_b16 v[178:179], v234 offset:5120
    v_mfma_f32_32x32x16_bf16 v[32:47], v[72:75], v[180:183], v[32:47]
    v_mfma_f32_32x32x16_bf16 v[48:63], v[76:79], v[180:183], v[48:63]
    ds_read_b64_tr_b16 v[180:181], v235 offset:4096
    ds_read_b64_tr_b16 v[182:183], v235 offset:5120
    v_mul_f32 v246, v0, v144
    v_fmac_f32 v246, v1, v145
    v_fmac_f32 v246, v2, v146
    v_fmac_f32 v246, v3, v147
    v_fmac_f32 v246, v4, v148
    v_fmac_f32 v246, v5, v149
    v_fmac_f32 v246, v6, v150
    v_fmac_f32 v246, v7, v151
    v_fmac_f32 v188, v8, v160
    v_fmac_f32 v188, v9, v161
    v_fmac_f32 v188, v10, v162
    v_fmac_f32 v188, v11, v163
    v_fmac_f32 v188, v12, v164
    v_fmac_f32 v188, v13, v165
    v_fmac_f32 v188, v14, v166
    v_fmac_f32 v188, v15, v167
    s_waitcnt lgkmcnt(2)
    v_mfma_f32_32x32x16_bf16 v[0:15], v[64:67], v[176:179], 0
    v_permlane32_swap_b32 v184, v246
    v_fmac_f32 v186, v16, v112
    v_fmac_f32 v186, v17, v113
    v_fmac_f32 v186, v18, v114
    v_fmac_f32 v186, v19, v115
    v_fmac_f32 v186, v20, v116
    v_fmac_f32 v186, v21, v117
    v_fmac_f32 v186, v22, v118
    v_fmac_f32 v186, v23, v119
    v_add_f32 v246, v184, v246
    v_mul_f32_e64 v184, v24, -v160
    v_fma_f32 v184, v25, -v161, v184
    v_fma_f32 v184, v26, -v162, v184
    v_fma_f32 v184, v27, -v163, v184
    v_fma_f32 v184, v28, -v164, v184
    v_fma_f32 v184, v29, -v165, v184
    v_fma_f32 v184, v30, -v166, v184
    v_fma_f32 v184, v31, -v167, v184
    v_mfma_f32_32x32x16_bf16 v[16:31], v[68:71], v[176:179], 0
    v_lshl_add_u32 v226, v226, 10, v236
    v_lshl_add_u32 v227, v227, 10, v236
    s_add_u32 m0, s25, 4096
    s_waitcnt vmcnt(4) lgkmcnt(0)
    buffer_load_dwordx4 v226, s[4:7], s37 offen lds
    buffer_load_dwordx4 v227, s[8:11], s37 offen offset:1024 lds
    ds_read_b64_tr_b16 v[176:177], v234 offset:6144
    ds_read_b64_tr_b16 v[178:179], v234 offset:7168
    v_mul_f32 v247, v32, v152
    v_fmac_f32 v247, v33, v153
    v_fmac_f32 v247, v34, v154
    v_fmac_f32 v247, v35, v155
    v_fmac_f32 v247, v36, v156
    v_fmac_f32 v247, v37, v157
    v_fmac_f32 v247, v38, v158
    v_fmac_f32 v247, v39, v159
    v_fmac_f32 v189, v40, v168
    v_fmac_f32 v189, v41, v169
    v_fmac_f32 v189, v42, v170
    v_fmac_f32 v189, v43, v171
    v_fmac_f32 v189, v44, v172
    v_fmac_f32 v189, v45, v173
    v_fmac_f32 v189, v46, v174
    v_fmac_f32 v189, v47, v175
    v_mfma_f32_32x32x16_bf16 v[32:47], v[64:67], v[180:183], 0
    v_permlane32_swap_b32 v185, v247
    v_fmac_f32 v187, v48, v120
    v_fmac_f32 v187, v49, v121
    v_fmac_f32 v187, v50, v122
    v_fmac_f32 v187, v51, v123
    v_fmac_f32 v187, v52, v124
    v_fmac_f32 v187, v53, v125
    v_fmac_f32 v187, v54, v126
    v_fmac_f32 v187, v55, v127
    v_add_f32 v247, v185, v247
    v_mul_f32_e64 v185, v56, -v168
    v_fma_f32 v185, v57, -v169, v185
    v_fma_f32 v185, v58, -v170, v185
    v_fma_f32 v185, v59, -v171, v185
    v_fma_f32 v185, v60, -v172, v185
    v_fma_f32 v185, v61, -v173, v185
    v_fma_f32 v185, v62, -v174, v185
    v_fma_f32 v185, v63, -v175, v185
    v_mfma_f32_32x32x16_bf16 v[48:63], v[68:71], v[180:183], 0
    ds_read_b64_tr_b16 v[180:181], v235 offset:6144
    ds_read_b64_tr_b16 v[182:183], v235 offset:7168
    v_cvt_pk_bf16_f32 v246, v246, v247
    ds_write_b32 v243, v246 offset:512
    s_waitcnt lgkmcnt(3)
    v_mfma_f32_32x32x16_bf16 v[0:15], v[72:75], v[176:179], v[0:15]
    v_mfma_f32_32x32x16_bf16 v[16:31], v[76:79], v[176:179], v[16:31]
    v_lshl_add_u32 v228, v228, 10, v236
    v_lshl_add_u32 v229, v229, 10, v236
    s_add_u32 m0, s25, 6144
    s_waitcnt vmcnt(4) lgkmcnt(1)
    buffer_load_dwordx4 v228, s[4:7], s38 offen lds
    buffer_load_dwordx4 v229, s[8:11], s38 offen offset:1024 lds
    ds_read_b64_tr_b16 v[176:177], v234 offset:0
    ds_read_b64_tr_b16 v[178:179], v234 offset:1024
    v_mfma_f32_32x32x16_bf16 v[32:47], v[72:75], v[180:183], v[32:47]
    v_mfma_f32_32x32x16_bf16 v[48:63], v[76:79], v[180:183], v[48:63]
    ds_read_b64_tr_b16 v[180:181], v235 offset:0
    ds_read_b64_tr_b16 v[182:183], v235 offset:1024
    v_add_u32 v241, s45, v237
    v_add_u32 v242, s39, v238
    ds_read_b32 v252, v251 offset:16
    ds_read_b64_tr_b16 v[68:69], v241 offset:0
    ds_read_b64_tr_b16 v[70:71], v241 offset:256
    s_mov_b64 exec, s[50:51]
    ds_read_u16_d16_hi v230, v242 offset:0
    s_mov_b64 exec, -1
    v_mul_f32 v246, v0, v144
    v_fmac_f32 v246, v1, v145
    v_fmac_f32 v246, v2, v146
    v_fmac_f32 v246, v3, v147
    v_fmac_f32 v246, v4, v148
    v_fmac_f32 v246, v5, v149
    v_fmac_f32 v246, v6, v150
    v_fmac_f32 v246, v7, v151
    v_fma_f32 v190, v8, -v160, v190
    v_fma_f32 v190, v9, -v161, v190
    v_fma_f32 v190, v10, -v162, v190
    v_fma_f32 v190, v11, -v163, v190
    v_fma_f32 v190, v12, -v164, v190
    v_fma_f32 v190, v13, -v165, v190
    v_fma_f32 v190, v14, -v166, v190
    v_fma_f32 v190, v15, -v167, v190
    v_fmac_f32 v184, v16, v160
    v_fmac_f32 v184, v17, v161
    v_fmac_f32 v184, v18, v162
    v_fmac_f32 v184, v19, v163
    v_fmac_f32 v184, v20, v164
    v_fmac_f32 v184, v21, v165
    v_fmac_f32 v184, v22, v166
    v_fmac_f32 v184, v23, v167
    v_fmac_f32 v186, v24, v112
    v_fmac_f32 v186, v25, v113
    v_fmac_f32 v186, v26, v114
    v_fmac_f32 v186, v27, v115
    v_fmac_f32 v186, v28, v116
    v_fmac_f32 v186, v29, v117
    v_fmac_f32 v186, v30, v118
    v_fmac_f32 v186, v31, v119
    v_mul_f32 v247, v32, v152
    v_fmac_f32 v247, v33, v153
    v_fmac_f32 v247, v34, v154
    v_fmac_f32 v247, v35, v155
    v_fmac_f32 v247, v36, v156
    v_fmac_f32 v247, v37, v157
    v_fmac_f32 v247, v38, v158
    v_fmac_f32 v247, v39, v159
    v_fma_f32 v191, v40, -v168, v191
    v_fma_f32 v191, v41, -v169, v191
    v_fma_f32 v191, v42, -v170, v191
    v_fma_f32 v191, v43, -v171, v191
    v_fma_f32 v191, v44, -v172, v191
    v_fma_f32 v191, v45, -v173, v191
    v_fma_f32 v191, v46, -v174, v191
    v_fma_f32 v191, v47, -v175, v191
    v_fmac_f32 v185, v48, v168
    v_fmac_f32 v185, v49, v169
    v_fmac_f32 v185, v50, v170
    v_fmac_f32 v185, v51, v171
    v_fmac_f32 v185, v52, v172
    v_fmac_f32 v185, v53, v173
    v_fmac_f32 v185, v54, v174
    v_fmac_f32 v185, v55, v175
    v_fmac_f32 v187, v56, v120
    v_fmac_f32 v187, v57, v121
    v_fmac_f32 v187, v58, v122
    v_fmac_f32 v187, v59, v123
    v_fmac_f32 v187, v60, v124
    v_fmac_f32 v187, v61, v125
    v_fmac_f32 v187, v62, v126
    v_fmac_f32 v187, v63, v127
    s_nop 0
    v_permlane32_swap_b32 v246, v188
    v_permlane32_swap_b32 v190, v244
    v_permlane32_swap_b32 v186, v184
    v_permlane32_swap_b32 v247, v189
    v_permlane32_swap_b32 v191, v245
    v_permlane32_swap_b32 v187, v185
    v_add_f32 v188, v246, v188
    v_add_f32 v244, v190, v244
    v_add_f32 v184, v186, v184
    v_add_f32 v189, v247, v189
    v_add_f32 v245, v191, v245
    v_add_f32 v185, v187, v185
    v_cvt_pk_bf16_f32 v188, v188, v189
    v_cvt_pk_bf16_f32 v244, v244, v245
    v_cvt_pk_bf16_f32 v184, v184, v185
    ds_write_b32 v243, v188 offset:768
    ds_write_b32 v243, v244 offset:1280
    ds_write_b32 v243, v184 offset:1024
    s_branch NEXT_1
.p2align 6
ITEM_1_5:
    ds_read_b64_tr_b16 v[76:77], v241 offset:512
    ds_read_b64_tr_b16 v[78:79], v241 offset:768
    ds_read_b64_tr_b16 v[84:85], v241 offset:1024
    s_mov_b64 exec, s[50:51]
    ds_read_u16_d16_hi v231, v242 offset:128
    ds_read_u16_d16_hi v232, v242 offset:256
    s_mov_b64 exec, -1
    v_add_u32 v244, s42, v239
    ds_read_u16 v228, v244
    ds_read_u16 v229, v244 offset:64
    v_xor_b32 v243, s65, v240
    v_add_u32 v243, s46, v243
    s_waitcnt lgkmcnt(7)
    v_lshlrev_b32 v184, 16, v68
    v_and_b32 v185, 0xffff0000, v68
    v_lshlrev_b32 v186, 16, v69
    v_and_b32 v187, 0xffff0000, v69
    v_mul_f32_dpp v188, v230, v184 row_newbcast:0 row_mask:0xf bank_mask:0xf
    v_mul_f32_dpp v189, v230, v185 row_newbcast:1 row_mask:0xf bank_mask:0xf
    v_mul_f32_dpp v190, v230, v184 row_newbcast:8 row_mask:0xf bank_mask:0xf
    v_mul_f32_dpp v191, v230, v185 row_newbcast:9 row_mask:0xf bank_mask:0xf
    v_lshlrev_b32 v184, 16, v70
    v_and_b32 v185, 0xffff0000, v70
    v_cvt_pk_bf16_f32 v64, v188, v189
    v_cvt_pk_bf16_f32 v68, v190, v191
    v_mul_f32_dpp v188, v230, v186 row_newbcast:2 row_mask:0xf bank_mask:0xf
    v_mul_f32_dpp v189, v230, v187 row_newbcast:3 row_mask:0xf bank_mask:0xf
    v_mul_f32_dpp v190, v230, v186 row_newbcast:10 row_mask:0xf bank_mask:0xf
    v_mul_f32_dpp v191, v230, v187 row_newbcast:11 row_mask:0xf bank_mask:0xf
    v_lshlrev_b32 v186, 16, v71
    v_and_b32 v187, 0xffff0000, v71
    v_cvt_pk_bf16_f32 v65, v188, v189
    v_cvt_pk_bf16_f32 v69, v190, v191
    v_mul_f32_dpp v188, v230, v184 row_newbcast:4 row_mask:0xf bank_mask:0xf
    v_mul_f32_dpp v189, v230, v185 row_newbcast:5 row_mask:0xf bank_mask:0xf
    v_mul_f32_dpp v190, v230, v184 row_newbcast:12 row_mask:0xf bank_mask:0xf
    v_mul_f32_dpp v191, v230, v185 row_newbcast:13 row_mask:0xf bank_mask:0xf
    v_cvt_pk_bf16_f32 v66, v188, v189
    v_cvt_pk_bf16_f32 v70, v190, v191
    v_mul_f32_dpp v188, v230, v186 row_newbcast:6 row_mask:0xf bank_mask:0xf
    v_mul_f32_dpp v189, v230, v187 row_newbcast:7 row_mask:0xf bank_mask:0xf
    v_mul_f32_dpp v190, v230, v186 row_newbcast:14 row_mask:0xf bank_mask:0xf
    v_mul_f32_dpp v191, v230, v187 row_newbcast:15 row_mask:0xf bank_mask:0xf
    v_cvt_pk_bf16_f32 v67, v188, v189
    v_cvt_pk_bf16_f32 v71, v190, v191
    s_nop 0
    s_waitcnt lgkmcnt(2)
    v_mfma_f32_32x32x16_bf16 v[0:15], v[64:67], v[176:179], 0
    v_lshlrev_b32 v184, 16, v76
    v_and_b32 v185, 0xffff0000, v76
    v_lshlrev_b32 v186, 16, v77
    v_and_b32 v187, 0xffff0000, v77
    v_mul_f32_dpp v188, v231, v184 row_newbcast:0 row_mask:0xf bank_mask:0xf
    v_mul_f32_dpp v189, v231, v185 row_newbcast:1 row_mask:0xf bank_mask:0xf
    v_mul_f32_dpp v190, v231, v184 row_newbcast:8 row_mask:0xf bank_mask:0xf
    v_mul_f32_dpp v191, v231, v185 row_newbcast:9 row_mask:0xf bank_mask:0xf
    v_mfma_f32_32x32x16_bf16 v[16:31], v[68:71], v[176:179], 0
    s_add_u32 m0, s25, 0
    s_waitcnt vmcnt(4)
    buffer_load_dwordx4 v224, s[4:7], s32 offen lds
    buffer_load_dwordx4 v225, s[8:11], s32 offen offset:1024 lds
    ds_read_b64_tr_b16 v[176:177], v234 offset:2048
    ds_read_b64_tr_b16 v[178:179], v234 offset:3072
    v_lshlrev_b32 v184, 16, v78
    v_and_b32 v185, 0xffff0000, v78
    v_cvt_pk_bf16_f32 v72, v188, v189
    v_cvt_pk_bf16_f32 v76, v190, v191
    v_mul_f32_dpp v188, v231, v186 row_newbcast:2 row_mask:0xf bank_mask:0xf
    v_mul_f32_dpp v189, v231, v187 row_newbcast:3 row_mask:0xf bank_mask:0xf
    v_mul_f32_dpp v190, v231, v186 row_newbcast:10 row_mask:0xf bank_mask:0xf
    v_mul_f32_dpp v191, v231, v187 row_newbcast:11 row_mask:0xf bank_mask:0xf
    v_mfma_f32_32x32x16_bf16 v[32:47], v[64:67], v[180:183], 0
    v_lshlrev_b32 v186, 16, v79
    v_and_b32 v187, 0xffff0000, v79
    v_cvt_pk_bf16_f32 v73, v188, v189
    v_cvt_pk_bf16_f32 v77, v190, v191
    v_mul_f32_dpp v188, v231, v184 row_newbcast:4 row_mask:0xf bank_mask:0xf
    v_mul_f32_dpp v189, v231, v185 row_newbcast:5 row_mask:0xf bank_mask:0xf
    v_mul_f32_dpp v190, v231, v184 row_newbcast:12 row_mask:0xf bank_mask:0xf
    v_mul_f32_dpp v191, v231, v185 row_newbcast:13 row_mask:0xf bank_mask:0xf
    v_mfma_f32_32x32x16_bf16 v[48:63], v[68:71], v[180:183], 0
    ds_read_b64_tr_b16 v[180:181], v235 offset:2048
    ds_read_b64_tr_b16 v[182:183], v235 offset:3072
    v_cvt_pk_bf16_f32 v74, v188, v189
    v_cvt_pk_bf16_f32 v78, v190, v191
    v_mul_f32_dpp v188, v231, v186 row_newbcast:6 row_mask:0xf bank_mask:0xf
    v_mul_f32_dpp v189, v231, v187 row_newbcast:7 row_mask:0xf bank_mask:0xf
    v_mul_f32_dpp v190, v231, v186 row_newbcast:14 row_mask:0xf bank_mask:0xf
    v_mul_f32_dpp v191, v231, v187 row_newbcast:15 row_mask:0xf bank_mask:0xf
    v_cvt_pk_bf16_f32 v75, v188, v189
    v_cvt_pk_bf16_f32 v79, v190, v191
    s_nop 0
    s_waitcnt lgkmcnt(2)
    v_mfma_f32_32x32x16_bf16 v[0:15], v[72:75], v[176:179], v[0:15]
    v_lshlrev_b32 v184, 16, v84
    v_and_b32 v185, 0xffff0000, v84
    v_lshlrev_b32 v186, 16, v85
    v_and_b32 v187, 0xffff0000, v85
    v_mfma_f32_32x32x16_bf16 v[16:31], v[76:79], v[176:179], v[16:31]
    s_add_u32 m0, s25, 2048
    s_waitcnt vmcnt(4) lgkmcnt(0)
    buffer_load_dwordx4 v226, s[4:7], s32 offen lds
    ds_read_b64_tr_b16 v[176:177], v234 offset:4096
    v_mul_f32_dpp v188, v232, v184 row_newbcast:0 row_mask:0xf bank_mask:0xf
    v_mul_f32_dpp v189, v232, v185 row_newbcast:1 row_mask:0xf bank_mask:0xf
    v_mul_f32_dpp v190, v232, v184 row_newbcast:8 row_mask:0xf bank_mask:0xf
    v_mul_f32_dpp v191, v232, v185 row_newbcast:9 row_mask:0xf bank_mask:0xf
    v_mfma_f32_32x32x16_bf16 v[32:47], v[72:75], v[180:183], v[32:47]
    v_cvt_pk_bf16_f32 v80, v188, v189
    v_cvt_pk_bf16_f32 v84, v190, v191
    v_mul_f32_dpp v188, v232, v186 row_newbcast:2 row_mask:0xf bank_mask:0xf
    v_mul_f32_dpp v189, v232, v187 row_newbcast:3 row_mask:0xf bank_mask:0xf
    v_mfma_f32_32x32x16_bf16 v[48:63], v[76:79], v[180:183], v[48:63]
    ds_read_b64_tr_b16 v[180:181], v235 offset:4096
    v_mul_f32_dpp v190, v232, v186 row_newbcast:10 row_mask:0xf bank_mask:0xf
    v_mul_f32_dpp v191, v232, v187 row_newbcast:11 row_mask:0xf bank_mask:0xf
    v_cvt_pk_bf16_f32 v81, v188, v189
    v_cvt_pk_bf16_f32 v85, v190, v191
    s_nop 0
    s_waitcnt lgkmcnt(1)
    v_mfma_f32_32x32x8_bf16 v[0:15], v[80:81], v[176:177], v[0:15]
    v_mfma_f32_32x32x8_bf16 v[16:31], v[84:85], v[176:177], v[16:31]
    s_add_u32 m0, s25, 4096
    s_waitcnt vmcnt(3) lgkmcnt(0)
    buffer_load_dwordx4 v222, s[4:7], s33 offen lds
    buffer_load_dwordx4 v223, s[8:11], s33 offen offset:1024 lds
    ds_read_b64_tr_b16 v[176:177], v234 offset:6144
    ds_read_b64_tr_b16 v[178:179], v234 offset:7168
    v_mfma_f32_32x32x8_bf16 v[32:47], v[80:81], v[180:181], v[32:47]
    v_mfma_f32_32x32x8_bf16 v[48:63], v[84:85], v[180:181], v[48:63]
    ds_read_b64_tr_b16 v[180:181], v235 offset:6144
    ds_read_b64_tr_b16 v[182:183], v235 offset:7168
    s_nop 0
    v_mul_f32 v184, v0, v96
    v_fmac_f32 v184, v1, v97
    v_fmac_f32 v184, v2, v98
    v_fmac_f32 v184, v3, v99
    v_fmac_f32 v184, v4, v100
    v_fmac_f32 v184, v5, v101
    v_fmac_f32 v184, v6, v102
    v_fmac_f32 v184, v7, v103
    v_mul_f32 v186, v8, v128
    v_fmac_f32 v186, v9, v129
    v_fmac_f32 v186, v10, v130
    v_fmac_f32 v186, v11, v131
    v_fmac_f32 v186, v12, v132
    v_fmac_f32 v186, v13, v133
    v_fmac_f32 v186, v14, v134
    v_fmac_f32 v186, v15, v135
    s_waitcnt lgkmcnt(2)
    v_mfma_f32_32x32x16_bf16 v[0:15], v[64:67], v[176:179], 0
    v_mul_f32 v188, v16, v128
    v_fmac_f32 v188, v17, v129
    v_fmac_f32 v188, v18, v130
    v_fmac_f32 v188, v19, v131
    v_fmac_f32 v188, v20, v132
    v_fmac_f32 v188, v21, v133
    v_fmac_f32 v188, v22, v134
    v_fmac_f32 v188, v23, v135
    v_mul_f32 v190, v24, v128
    v_fmac_f32 v190, v25, v129
    v_fmac_f32 v190, v26, v130
    v_fmac_f32 v190, v27, v131
    v_fmac_f32 v190, v28, v132
    v_fmac_f32 v190, v29, v133
    v_fmac_f32 v190, v30, v134
    v_fmac_f32 v190, v31, v135
    v_mfma_f32_32x32x16_bf16 v[16:31], v[68:71], v[176:179], 0
    s_add_u32 m0, s25, 6144
    s_waitcnt vmcnt(3) lgkmcnt(0)
    buffer_load_dwordx4 v224, s[4:7], s33 offen lds
    buffer_load_dwordx4 v225, s[8:11], s33 offen offset:1024 lds
    ds_read_b64_tr_b16 v[176:177], v234 offset:0
    ds_read_b64_tr_b16 v[178:179], v234 offset:1024
    v_mul_f32 v185, v32, v104
    v_fmac_f32 v185, v33, v105
    v_fmac_f32 v185, v34, v106
    v_fmac_f32 v185, v35, v107
    v_fmac_f32 v185, v36, v108
    v_fmac_f32 v185, v37, v109
    v_fmac_f32 v185, v38, v110
    v_fmac_f32 v185, v39, v111
    v_mul_f32 v187, v40, v136
    v_fmac_f32 v187, v41, v137
    v_fmac_f32 v187, v42, v138
    v_fmac_f32 v187, v43, v139
    v_fmac_f32 v187, v44, v140
    v_fmac_f32 v187, v45, v141
    v_fmac_f32 v187, v46, v142
    v_fmac_f32 v187, v47, v143
    v_mfma_f32_32x32x16_bf16 v[32:47], v[64:67], v[180:183], 0
    v_mul_f32 v189, v48, v136
    v_fmac_f32 v189, v49, v137
    v_fmac_f32 v189, v50, v138
    v_fmac_f32 v189, v51, v139
    v_fmac_f32 v189, v52, v140
    v_fmac_f32 v189, v53, v141
    v_fmac_f32 v189, v54, v142
    v_fmac_f32 v189, v55, v143
    v_mul_f32 v191, v56, v136
    v_fmac_f32 v191, v57, v137
    v_fmac_f32 v191, v58, v138
    v_fmac_f32 v191, v59, v139
    v_fmac_f32 v191, v60, v140
    v_fmac_f32 v191, v61, v141
    v_fmac_f32 v191, v62, v142
    v_fmac_f32 v191, v63, v143
    v_mfma_f32_32x32x16_bf16 v[48:63], v[68:71], v[180:183], 0
    ds_read_b64_tr_b16 v[180:181], v235 offset:0
    ds_read_b64_tr_b16 v[182:183], v235 offset:1024
    v_permlane32_swap_b32 v184, v186
    v_permlane32_swap_b32 v188, v190
    v_permlane32_swap_b32 v185, v187
    v_permlane32_swap_b32 v189, v191
    v_add_f32 v186, v184, v186
    v_add_f32 v190, v188, v190
    v_add_f32 v187, v185, v187
    v_add_f32 v191, v189, v191
    v_cvt_pk_bf16_f32 v186, v186, v187
    v_cvt_pk_bf16_f32 v190, v190, v191
    ds_write_b32 v243, v186 offset:0
    ds_write_b32 v243, v190 offset:256
    s_waitcnt lgkmcnt(4)
    v_mfma_f32_32x32x16_bf16 v[0:15], v[72:75], v[176:179], v[0:15]
    v_mfma_f32_32x32x16_bf16 v[16:31], v[76:79], v[176:179], v[16:31]
    s_add_u32 m0, s25, 0
    s_waitcnt vmcnt(4) lgkmcnt(2)
    buffer_load_dwordx4 v226, s[4:7], s33 offen lds
    ds_read_b64_tr_b16 v[176:177], v234 offset:2048
    v_mfma_f32_32x32x16_bf16 v[32:47], v[72:75], v[180:183], v[32:47]
    v_mfma_f32_32x32x16_bf16 v[48:63], v[76:79], v[180:183], v[48:63]
    ds_read_b64_tr_b16 v[180:181], v235 offset:2048
    s_waitcnt lgkmcnt(1)
    v_mfma_f32_32x32x8_bf16 v[0:15], v[80:81], v[176:177], v[0:15]
    v_mfma_f32_32x32x8_bf16 v[16:31], v[84:85], v[176:177], v[16:31]
    s_add_u32 m0, s25, 2048
    s_waitcnt vmcnt(3) lgkmcnt(0)
    buffer_load_dwordx4 v222, s[4:7], s34 offen lds
    buffer_load_dwordx4 v223, s[8:11], s34 offen offset:1024 lds
    ds_read_b64_tr_b16 v[176:177], v234 offset:4096
    ds_read_b64_tr_b16 v[178:179], v234 offset:5120
    v_mfma_f32_32x32x8_bf16 v[32:47], v[80:81], v[180:181], v[32:47]
    v_add_u32 v244, s39, v239
    ds_read_u16 v222, v244
    ds_read_u16 v223, v244 offset:64
    v_mfma_f32_32x32x8_bf16 v[48:63], v[84:85], v[180:181], v[48:63]
    ds_read_b64_tr_b16 v[180:181], v235 offset:4096
    ds_read_b64_tr_b16 v[182:183], v235 offset:5120
    v_mul_f32 v184, v0, v144
    v_fmac_f32 v184, v1, v145
    v_fmac_f32 v184, v2, v146
    v_fmac_f32 v184, v3, v147
    v_fmac_f32 v184, v4, v148
    v_fmac_f32 v184, v5, v149
    v_fmac_f32 v184, v6, v150
    v_fmac_f32 v184, v7, v151
    v_mul_f32 v186, v8, v112
    v_fmac_f32 v186, v9, v113
    v_fmac_f32 v186, v10, v114
    v_fmac_f32 v186, v11, v115
    v_fmac_f32 v186, v12, v116
    v_fmac_f32 v186, v13, v117
    v_fmac_f32 v186, v14, v118
    v_fmac_f32 v186, v15, v119
    s_waitcnt lgkmcnt(4)
    v_mfma_f32_32x32x16_bf16 v[0:15], v[64:67], v[176:179], 0
    v_mul_f32_e64 v188, v16, -v160
    v_fma_f32 v188, v17, -v161, v188
    v_fma_f32 v188, v18, -v162, v188
    v_fma_f32 v188, v19, -v163, v188
    v_fma_f32 v188, v20, -v164, v188
    v_fma_f32 v188, v21, -v165, v188
    v_fma_f32 v188, v22, -v166, v188
    v_fma_f32 v188, v23, -v167, v188
    v_mul_f32 v190, v24, v160
    v_fmac_f32 v190, v25, v161
    v_fmac_f32 v190, v26, v162
    v_fmac_f32 v190, v27, v163
    v_fmac_f32 v190, v28, v164
    v_fmac_f32 v190, v29, v165
    v_fmac_f32 v190, v30, v166
    v_fmac_f32 v190, v31, v167
    v_mfma_f32_32x32x16_bf16 v[16:31], v[68:71], v[176:179], 0
    s_add_u32 m0, s25, 4096
    s_waitcnt vmcnt(3) lgkmcnt(0)
    buffer_load_dwordx4 v224, s[4:7], s34 offen lds
    buffer_load_dwordx4 v225, s[8:11], s34 offen offset:1024 lds
    ds_read_b64_tr_b16 v[176:177], v234 offset:6144
    ds_read_b64_tr_b16 v[178:179], v234 offset:7168
    v_mul_f32 v185, v32, v152
    v_fmac_f32 v185, v33, v153
    v_fmac_f32 v185, v34, v154
    v_fmac_f32 v185, v35, v155
    v_fmac_f32 v185, v36, v156
    v_fmac_f32 v185, v37, v157
    v_fmac_f32 v185, v38, v158
    v_fmac_f32 v185, v39, v159
    v_mul_f32 v187, v40, v120
    v_fmac_f32 v187, v41, v121
    v_fmac_f32 v187, v42, v122
    v_fmac_f32 v187, v43, v123
    v_fmac_f32 v187, v44, v124
    v_fmac_f32 v187, v45, v125
    v_fmac_f32 v187, v46, v126
    v_fmac_f32 v187, v47, v127
    v_mfma_f32_32x32x16_bf16 v[32:47], v[64:67], v[180:183], 0
    v_add_u32 v244, s40, v239
    ds_read_u16 v224, v244
    ds_read_u16 v225, v244 offset:64
    v_mul_f32_e64 v189, v48, -v168
    v_fma_f32 v189, v49, -v169, v189
    v_fma_f32 v189, v50, -v170, v189
    v_fma_f32 v189, v51, -v171, v189
    v_fma_f32 v189, v52, -v172, v189
    v_fma_f32 v189, v53, -v173, v189
    v_fma_f32 v189, v54, -v174, v189
    v_fma_f32 v189, v55, -v175, v189
    v_mul_f32 v191, v56, v168
    v_fmac_f32 v191, v57, v169
    v_fmac_f32 v191, v58, v170
    v_fmac_f32 v191, v59, v171
    v_fmac_f32 v191, v60, v172
    v_fmac_f32 v191, v61, v173
    v_fmac_f32 v191, v62, v174
    v_fmac_f32 v191, v63, v175
    v_mfma_f32_32x32x16_bf16 v[48:63], v[68:71], v[180:183], 0
    ds_read_b64_tr_b16 v[180:181], v235 offset:6144
    ds_read_b64_tr_b16 v[182:183], v235 offset:7168
    s_waitcnt lgkmcnt(4)
    v_mfma_f32_32x32x16_bf16 v[0:15], v[72:75], v[176:179], v[0:15]
    v_mfma_f32_32x32x16_bf16 v[16:31], v[76:79], v[176:179], v[16:31]
    s_add_u32 m0, s25, 6144
    s_waitcnt vmcnt(4) lgkmcnt(0)
    buffer_load_dwordx4 v226, s[4:7], s34 offen lds
    ds_read_b64_tr_b16 v[176:177], v234 offset:0
    v_mfma_f32_32x32x16_bf16 v[32:47], v[72:75], v[180:183], v[32:47]
    v_add_u32 v244, s41, v239
    ds_read_u16 v226, v244
    ds_read_u16 v227, v244 offset:64
    v_mfma_f32_32x32x16_bf16 v[48:63], v[76:79], v[180:183], v[48:63]
    ds_read_b64_tr_b16 v[180:181], v235 offset:0
    s_waitcnt lgkmcnt(3)
    v_mfma_f32_32x32x8_bf16 v[0:15], v[80:81], v[176:177], v[0:15]
    v_mfma_f32_32x32x8_bf16 v[16:31], v[84:85], v[176:177], v[16:31]
    v_lshl_add_u32 v222, v222, 10, v236
    v_lshl_add_u32 v223, v223, 10, v236
    s_add_u32 m0, s25, 0
    s_waitcnt vmcnt(3) lgkmcnt(0)
    buffer_load_dwordx4 v222, s[4:7], s35 offen lds
    buffer_load_dwordx4 v223, s[8:11], s35 offen offset:1024 lds
    ds_read_b64_tr_b16 v[176:177], v234 offset:2048
    ds_read_b64_tr_b16 v[178:179], v234 offset:3072
    v_mfma_f32_32x32x8_bf16 v[32:47], v[80:81], v[180:181], v[32:47]
    v_mfma_f32_32x32x8_bf16 v[48:63], v[84:85], v[180:181], v[48:63]
    ds_read_b64_tr_b16 v[180:181], v235 offset:2048
    ds_read_b64_tr_b16 v[182:183], v235 offset:3072
    v_mul_f32 v246, v0, v144
    v_fmac_f32 v246, v1, v145
    v_fmac_f32 v246, v2, v146
    v_fmac_f32 v246, v3, v147
    v_fmac_f32 v246, v4, v148
    v_fmac_f32 v246, v5, v149
    v_fmac_f32 v246, v6, v150
    v_fmac_f32 v246, v7, v151
    v_fmac_f32 v188, v8, v160
    v_fmac_f32 v188, v9, v161
    v_fmac_f32 v188, v10, v162
    v_fmac_f32 v188, v11, v163
    v_fmac_f32 v188, v12, v164
    v_fmac_f32 v188, v13, v165
    v_fmac_f32 v188, v14, v166
    v_fmac_f32 v188, v15, v167
    s_waitcnt lgkmcnt(2)
    v_mfma_f32_32x32x16_bf16 v[0:15], v[64:67], v[176:179], 0
    v_permlane32_swap_b32 v184, v246
    v_fmac_f32 v186, v16, v112
    v_fmac_f32 v186, v17, v113
    v_fmac_f32 v186, v18, v114
    v_fmac_f32 v186, v19, v115
    v_fmac_f32 v186, v20, v116
    v_fmac_f32 v186, v21, v117
    v_fmac_f32 v186, v22, v118
    v_fmac_f32 v186, v23, v119
    v_add_f32 v246, v184, v246
    v_mul_f32_e64 v184, v24, -v160
    v_fma_f32 v184, v25, -v161, v184
    v_fma_f32 v184, v26, -v162, v184
    v_fma_f32 v184, v27, -v163, v184
    v_fma_f32 v184, v28, -v164, v184
    v_fma_f32 v184, v29, -v165, v184
    v_fma_f32 v184, v30, -v166, v184
    v_fma_f32 v184, v31, -v167, v184
    v_mfma_f32_32x32x16_bf16 v[16:31], v[68:71], v[176:179], 0
    v_lshl_add_u32 v224, v224, 10, v236
    v_lshl_add_u32 v225, v225, 10, v236
    s_add_u32 m0, s25, 2048
    s_waitcnt vmcnt(3) lgkmcnt(0)
    buffer_load_dwordx4 v224, s[4:7], s36 offen lds
    buffer_load_dwordx4 v225, s[8:11], s36 offen offset:1024 lds
    ds_read_b64_tr_b16 v[176:177], v234 offset:4096
    ds_read_b64_tr_b16 v[178:179], v234 offset:5120
    v_mul_f32 v247, v32, v152
    v_fmac_f32 v247, v33, v153
    v_fmac_f32 v247, v34, v154
    v_fmac_f32 v247, v35, v155
    v_fmac_f32 v247, v36, v156
    v_fmac_f32 v247, v37, v157
    v_fmac_f32 v247, v38, v158
    v_fmac_f32 v247, v39, v159
    v_fmac_f32 v189, v40, v168
    v_fmac_f32 v189, v41, v169
    v_fmac_f32 v189, v42, v170
    v_fmac_f32 v189, v43, v171
    v_fmac_f32 v189, v44, v172
    v_fmac_f32 v189, v45, v173
    v_fmac_f32 v189, v46, v174
    v_fmac_f32 v189, v47, v175
    v_mfma_f32_32x32x16_bf16 v[32:47], v[64:67], v[180:183], 0
    v_permlane32_swap_b32 v185, v247
    v_fmac_f32 v187, v48, v120
    v_fmac_f32 v187, v49, v121
    v_fmac_f32 v187, v50, v122
    v_fmac_f32 v187, v51, v123
    v_fmac_f32 v187, v52, v124
    v_fmac_f32 v187, v53, v125
    v_fmac_f32 v187, v54, v126
    v_fmac_f32 v187, v55, v127
    v_add_f32 v247, v185, v247
    v_mul_f32_e64 v185, v56, -v168
    v_fma_f32 v185, v57, -v169, v185
    v_fma_f32 v185, v58, -v170, v185
    v_fma_f32 v185, v59, -v171, v185
    v_fma_f32 v185, v60, -v172, v185
    v_fma_f32 v185, v61, -v173, v185
    v_fma_f32 v185, v62, -v174, v185
    v_fma_f32 v185, v63, -v175, v185
    v_mfma_f32_32x32x16_bf16 v[48:63], v[68:71], v[180:183], 0
    ds_read_b64_tr_b16 v[180:181], v235 offset:4096
    ds_read_b64_tr_b16 v[182:183], v235 offset:5120
    v_cvt_pk_bf16_f32 v246, v246, v247
    ds_write_b32 v243, v246 offset:512
    s_waitcnt lgkmcnt(3)
    v_mfma_f32_32x32x16_bf16 v[0:15], v[72:75], v[176:179], v[0:15]
    v_mfma_f32_32x32x16_bf16 v[16:31], v[76:79], v[176:179], v[16:31]
    v_lshl_add_u32 v226, v226, 10, v236
    v_lshl_add_u32 v227, v227, 10, v236
    s_add_u32 m0, s25, 4096
    s_waitcnt vmcnt(4) lgkmcnt(1)
    buffer_load_dwordx4 v226, s[4:7], s37 offen lds
    buffer_load_dwordx4 v227, s[8:11], s37 offen offset:1024 lds
    ds_read_b64_tr_b16 v[176:177], v234 offset:6144
    v_mfma_f32_32x32x16_bf16 v[32:47], v[72:75], v[180:183], v[32:47]
    v_mfma_f32_32x32x16_bf16 v[48:63], v[76:79], v[180:183], v[48:63]
    ds_read_b64_tr_b16 v[180:181], v235 offset:6144
    s_waitcnt lgkmcnt(1)
    v_mfma_f32_32x32x8_bf16 v[0:15], v[80:81], v[176:177], v[0:15]
    v_mfma_f32_32x32x8_bf16 v[16:31], v[84:85], v[176:177], v[16:31]
    v_lshl_add_u32 v228, v228, 10, v236
    v_lshl_add_u32 v229, v229, 10, v236
    s_add_u32 m0, s25, 6144
    s_waitcnt vmcnt(4) lgkmcnt(0)
    buffer_load_dwordx4 v228, s[4:7], s38 offen lds
    buffer_load_dwordx4 v229, s[8:11], s38 offen offset:1024 lds
    ds_read_b64_tr_b16 v[176:177], v234 offset:0
    ds_read_b64_tr_b16 v[178:179], v234 offset:1024
    v_mfma_f32_32x32x8_bf16 v[32:47], v[80:81], v[180:181], v[32:47]
    v_mfma_f32_32x32x8_bf16 v[48:63], v[84:85], v[180:181], v[48:63]
    ds_read_b64_tr_b16 v[180:181], v235 offset:0
    ds_read_b64_tr_b16 v[182:183], v235 offset:1024
    v_add_u32 v241, s45, v237
    v_add_u32 v242, s39, v238
    ds_read_b32 v252, v251 offset:16
    ds_read_b64_tr_b16 v[68:69], v241 offset:0
    ds_read_b64_tr_b16 v[70:71], v241 offset:256
    s_mov_b64 exec, s[50:51]
    ds_read_u16_d16_hi v230, v242 offset:0
    s_mov_b64 exec, -1
    v_mul_f32 v246, v0, v144
    v_fmac_f32 v246, v1, v145
    v_fmac_f32 v246, v2, v146
    v_fmac_f32 v246, v3, v147
    v_fmac_f32 v246, v4, v148
    v_fmac_f32 v246, v5, v149
    v_fmac_f32 v246, v6, v150
    v_fmac_f32 v246, v7, v151
    v_fma_f32 v190, v8, -v160, v190
    v_fma_f32 v190, v9, -v161, v190
    v_fma_f32 v190, v10, -v162, v190
    v_fma_f32 v190, v11, -v163, v190
    v_fma_f32 v190, v12, -v164, v190
    v_fma_f32 v190, v13, -v165, v190
    v_fma_f32 v190, v14, -v166, v190
    v_fma_f32 v190, v15, -v167, v190
    v_fmac_f32 v184, v16, v160
    v_fmac_f32 v184, v17, v161
    v_fmac_f32 v184, v18, v162
    v_fmac_f32 v184, v19, v163
    v_fmac_f32 v184, v20, v164
    v_fmac_f32 v184, v21, v165
    v_fmac_f32 v184, v22, v166
    v_fmac_f32 v184, v23, v167
    v_fmac_f32 v186, v24, v112
    v_fmac_f32 v186, v25, v113
    v_fmac_f32 v186, v26, v114
    v_fmac_f32 v186, v27, v115
    v_fmac_f32 v186, v28, v116
    v_fmac_f32 v186, v29, v117
    v_fmac_f32 v186, v30, v118
    v_fmac_f32 v186, v31, v119
    v_mul_f32 v247, v32, v152
    v_fmac_f32 v247, v33, v153
    v_fmac_f32 v247, v34, v154
    v_fmac_f32 v247, v35, v155
    v_fmac_f32 v247, v36, v156
    v_fmac_f32 v247, v37, v157
    v_fmac_f32 v247, v38, v158
    v_fmac_f32 v247, v39, v159
    v_fma_f32 v191, v40, -v168, v191
    v_fma_f32 v191, v41, -v169, v191
    v_fma_f32 v191, v42, -v170, v191
    v_fma_f32 v191, v43, -v171, v191
    v_fma_f32 v191, v44, -v172, v191
    v_fma_f32 v191, v45, -v173, v191
    v_fma_f32 v191, v46, -v174, v191
    v_fma_f32 v191, v47, -v175, v191
    v_fmac_f32 v185, v48, v168
    v_fmac_f32 v185, v49, v169
    v_fmac_f32 v185, v50, v170
    v_fmac_f32 v185, v51, v171
    v_fmac_f32 v185, v52, v172
    v_fmac_f32 v185, v53, v173
    v_fmac_f32 v185, v54, v174
    v_fmac_f32 v185, v55, v175
    v_fmac_f32 v187, v56, v120
    v_fmac_f32 v187, v57, v121
    v_fmac_f32 v187, v58, v122
    v_fmac_f32 v187, v59, v123
    v_fmac_f32 v187, v60, v124
    v_fmac_f32 v187, v61, v125
    v_fmac_f32 v187, v62, v126
    v_fmac_f32 v187, v63, v127
    s_nop 0
    v_permlane32_swap_b32 v246, v188
    v_permlane32_swap_b32 v190, v244
    v_permlane32_swap_b32 v186, v184
    v_permlane32_swap_b32 v247, v189
    v_permlane32_swap_b32 v191, v245
    v_permlane32_swap_b32 v187, v185
    v_add_f32 v188, v246, v188
    v_add_f32 v244, v190, v244
    v_add_f32 v184, v186, v184
    v_add_f32 v189, v247, v189
    v_add_f32 v245, v191, v245
    v_add_f32 v185, v187, v185
    v_cvt_pk_bf16_f32 v188, v188, v189
    v_cvt_pk_bf16_f32 v244, v244, v245
    v_cvt_pk_bf16_f32 v184, v184, v185
    ds_write_b32 v243, v188 offset:768
    ds_write_b32 v243, v244 offset:1280
    ds_write_b32 v243, v184 offset:1024
    s_branch NEXT_1
.p2align 6
ITEM_1_6:
    ds_read_b64_tr_b16 v[76:77], v241 offset:512
    ds_read_b64_tr_b16 v[78:79], v241 offset:768
    ds_read_b64_tr_b16 v[84:85], v241 offset:1024
    ds_read_b64_tr_b16 v[86:87], v241 offset:1280
    s_mov_b64 exec, s[50:51]
    ds_read_u16_d16_hi v231, v242 offset:128
    ds_read_u16_d16_hi v232, v242 offset:256
    s_mov_b64 exec, -1
    v_add_u32 v244, s42, v239
    ds_read_u16 v228, v244
    ds_read_u16 v229, v244 offset:64
    v_xor_b32 v243, s65, v240
    v_add_u32 v243, s46, v243
    s_waitcnt lgkmcnt(8)
    v_lshlrev_b32 v184, 16, v68
    v_and_b32 v185, 0xffff0000, v68
    v_lshlrev_b32 v186, 16, v69
    v_and_b32 v187, 0xffff0000, v69
    v_mul_f32_dpp v188, v230, v184 row_newbcast:0 row_mask:0xf bank_mask:0xf
    v_mul_f32_dpp v189, v230, v185 row_newbcast:1 row_mask:0xf bank_mask:0xf
    v_mul_f32_dpp v190, v230, v184 row_newbcast:8 row_mask:0xf bank_mask:0xf
    v_mul_f32_dpp v191, v230, v185 row_newbcast:9 row_mask:0xf bank_mask:0xf
    v_lshlrev_b32 v184, 16, v70
    v_and_b32 v185, 0xffff0000, v70
    v_cvt_pk_bf16_f32 v64, v188, v189
    v_cvt_pk_bf16_f32 v68, v190, v191
    v_mul_f32_dpp v188, v230, v186 row_newbcast:2 row_mask:0xf bank_mask:0xf
    v_mul_f32_dpp v189, v230, v187 row_newbcast:3 row_mask:0xf bank_mask:0xf
    v_mul_f32_dpp v190, v230, v186 row_newbcast:10 row_mask:0xf bank_mask:0xf
    v_mul_f32_dpp v191, v230, v187 row_newbcast:11 row_mask:0xf bank_mask:0xf
    v_lshlrev_b32 v186, 16, v71
    v_and_b32 v187, 0xffff0000, v71
    v_cvt_pk_bf16_f32 v65, v188, v189
    v_cvt_pk_bf16_f32 v69, v190, v191
    v_mul_f32_dpp v188, v230, v184 row_newbcast:4 row_mask:0xf bank_mask:0xf
    v_mul_f32_dpp v189, v230, v185 row_newbcast:5 row_mask:0xf bank_mask:0xf
    v_mul_f32_dpp v190, v230, v184 row_newbcast:12 row_mask:0xf bank_mask:0xf
    v_mul_f32_dpp v191, v230, v185 row_newbcast:13 row_mask:0xf bank_mask:0xf
    v_cvt_pk_bf16_f32 v66, v188, v189
    v_cvt_pk_bf16_f32 v70, v190, v191
    v_mul_f32_dpp v188, v230, v186 row_newbcast:6 row_mask:0xf bank_mask:0xf
    v_mul_f32_dpp v189, v230, v187 row_newbcast:7 row_mask:0xf bank_mask:0xf
    v_mul_f32_dpp v190, v230, v186 row_newbcast:14 row_mask:0xf bank_mask:0xf
    v_mul_f32_dpp v191, v230, v187 row_newbcast:15 row_mask:0xf bank_mask:0xf
    v_cvt_pk_bf16_f32 v67, v188, v189
    v_cvt_pk_bf16_f32 v71, v190, v191
    s_nop 0
    s_waitcnt lgkmcnt(2)
    v_mfma_f32_32x32x16_bf16 v[0:15], v[64:67], v[176:179], 0
    v_lshlrev_b32 v184, 16, v76
    v_and_b32 v185, 0xffff0000, v76
    v_lshlrev_b32 v186, 16, v77
    v_and_b32 v187, 0xffff0000, v77
    v_mul_f32_dpp v188, v231, v184 row_newbcast:0 row_mask:0xf bank_mask:0xf
    v_mul_f32_dpp v189, v231, v185 row_newbcast:1 row_mask:0xf bank_mask:0xf
    v_mul_f32_dpp v190, v231, v184 row_newbcast:8 row_mask:0xf bank_mask:0xf
    v_mul_f32_dpp v191, v231, v185 row_newbcast:9 row_mask:0xf bank_mask:0xf
    v_mfma_f32_32x32x16_bf16 v[16:31], v[68:71], v[176:179], 0
    s_add_u32 m0, s25, 0
    s_waitcnt vmcnt(4)
    buffer_load_dwordx4 v224, s[4:7], s32 offen lds
    buffer_load_dwordx4 v225, s[8:11], s32 offen offset:1024 lds
    ds_read_b64_tr_b16 v[176:177], v234 offset:2048
    ds_read_b64_tr_b16 v[178:179], v234 offset:3072
    v_lshlrev_b32 v184, 16, v78
    v_and_b32 v185, 0xffff0000, v78
    v_cvt_pk_bf16_f32 v72, v188, v189
    v_cvt_pk_bf16_f32 v76, v190, v191
    v_mul_f32_dpp v188, v231, v186 row_newbcast:2 row_mask:0xf bank_mask:0xf
    v_mul_f32_dpp v189, v231, v187 row_newbcast:3 row_mask:0xf bank_mask:0xf
    v_mul_f32_dpp v190, v231, v186 row_newbcast:10 row_mask:0xf bank_mask:0xf
    v_mul_f32_dpp v191, v231, v187 row_newbcast:11 row_mask:0xf bank_mask:0xf
    v_mfma_f32_32x32x16_bf16 v[32:47], v[64:67], v[180:183], 0
    v_lshlrev_b32 v186, 16, v79
    v_and_b32 v187, 0xffff0000, v79
    v_cvt_pk_bf16_f32 v73, v188, v189
    v_cvt_pk_bf16_f32 v77, v190, v191
    v_mul_f32_dpp v188, v231, v184 row_newbcast:4 row_mask:0xf bank_mask:0xf
    v_mul_f32_dpp v189, v231, v185 row_newbcast:5 row_mask:0xf bank_mask:0xf
    v_mul_f32_dpp v190, v231, v184 row_newbcast:12 row_mask:0xf bank_mask:0xf
    v_mul_f32_dpp v191, v231, v185 row_newbcast:13 row_mask:0xf bank_mask:0xf
    v_mfma_f32_32x32x16_bf16 v[48:63], v[68:71], v[180:183], 0
    ds_read_b64_tr_b16 v[180:181], v235 offset:2048
    ds_read_b64_tr_b16 v[182:183], v235 offset:3072
    v_cvt_pk_bf16_f32 v74, v188, v189
    v_cvt_pk_bf16_f32 v78, v190, v191
    v_mul_f32_dpp v188, v231, v186 row_newbcast:6 row_mask:0xf bank_mask:0xf
    v_mul_f32_dpp v189, v231, v187 row_newbcast:7 row_mask:0xf bank_mask:0xf
    v_mul_f32_dpp v190, v231, v186 row_newbcast:14 row_mask:0xf bank_mask:0xf
    v_mul_f32_dpp v191, v231, v187 row_newbcast:15 row_mask:0xf bank_mask:0xf
    v_cvt_pk_bf16_f32 v75, v188, v189
    v_cvt_pk_bf16_f32 v79, v190, v191
    s_nop 0
    s_waitcnt lgkmcnt(2)
    v_mfma_f32_32x32x16_bf16 v[0:15], v[72:75], v[176:179], v[0:15]
    v_lshlrev_b32 v184, 16, v84
    v_and_b32 v185, 0xffff0000, v84
    v_lshlrev_b32 v186, 16, v85
    v_and_b32 v187, 0xffff0000, v85
    v_mul_f32_dpp v188, v232, v184 row_newbcast:0 row_mask:0xf bank_mask:0xf
    v_mul_f32_dpp v189, v232, v185 row_newbcast:1 row_mask:0xf bank_mask:0xf
    v_mul_f32_dpp v190, v232, v184 row_newbcast:8 row_mask:0xf bank_mask:0xf
    v_mul_f32_dpp v191, v232, v185 row_newbcast:9 row_mask:0xf bank_mask:0xf
    v_mfma_f32_32x32x16_bf16 v[16:31], v[76:79], v[176:179], v[16:31]
    s_add_u32 m0, s25, 2048
    s_waitcnt vmcnt(4) lgkmcnt(0)
    buffer_load_dwordx4 v226, s[4:7], s32 offen lds
    buffer_load_dwordx4 v227, s[8:11], s32 offen offset:1024 lds
    ds_read_b64_tr_b16 v[176:177], v234 offset:4096
    ds_read_b64_tr_b16 v[178:179], v234 offset:5120
    v_lshlrev_b32 v184, 16, v86
    v_and_b32 v185, 0xffff0000, v86
    v_cvt_pk_bf16_f32 v80, v188, v189
    v_cvt_pk_bf16_f32 v84, v190, v191
    v_mul_f32_dpp v188, v232, v186 row_newbcast:2 row_mask:0xf bank_mask:0xf
    v_mul_f32_dpp v189, v232, v187 row_newbcast:3 row_mask:0xf bank_mask:0xf
    v_mul_f32_dpp v190, v232, v186 row_newbcast:10 row_mask:0xf bank_mask:0xf
    v_mul_f32_dpp v191, v232, v187 row_newbcast:11 row_mask:0xf bank_mask:0xf
    v_mfma_f32_32x32x16_bf16 v[32:47], v[72:75], v[180:183], v[32:47]
    v_lshlrev_b32 v186, 16, v87
    v_and_b32 v187, 0xffff0000, v87
    v_cvt_pk_bf16_f32 v81, v188, v189
    v_cvt_pk_bf16_f32 v85, v190, v191
    v_mul_f32_dpp v188, v232, v184 row_newbcast:4 row_mask:0xf bank_mask:0xf
    v_mul_f32_dpp v189, v232, v185 row_newbcast:5 row_mask:0xf bank_mask:0xf
    v_mul_f32_dpp v190, v232, v184 row_newbcast:12 row_mask:0xf bank_mask:0xf
    v_mul_f32_dpp v191, v232, v185 row_newbcast:13 row_mask:0xf bank_mask:0xf
    v_mfma_f32_32x32x16_bf16 v[48:63], v[76:79], v[180:183], v[48:63]
    ds_read_b64_tr_b16 v[180:181], v235 offset:4096
    ds_read_b64_tr_b16 v[182:183], v235 offset:5120
    v_cvt_pk_bf16_f32 v82, v188, v189
    v_cvt_pk_bf16_f32 v86, v190, v191
    v_mul_f32_dpp v188, v232, v186 row_newbcast:6 row_mask:0xf bank_mask:0xf
    v_mul_f32_dpp v189, v232, v187 row_newbcast:7 row_mask:0xf bank_mask:0xf
    v_mul_f32_dpp v190, v232, v186 row_newbcast:14 row_mask:0xf bank_mask:0xf
    v_mul_f32_dpp v191, v232, v187 row_newbcast:15 row_mask:0xf bank_mask:0xf
    v_cvt_pk_bf16_f32 v83, v188, v189
    v_cvt_pk_bf16_f32 v87, v190, v191
    s_nop 0
    s_waitcnt lgkmcnt(2)
    v_mfma_f32_32x32x16_bf16 v[0:15], v[80:83], v[176:179], v[0:15]
    v_mfma_f32_32x32x16_bf16 v[16:31], v[84:87], v[176:179], v[16:31]
    s_add_u32 m0, s25, 4096
    s_waitcnt vmcnt(4) lgkmcnt(0)
    buffer_load_dwordx4 v222, s[4:7], s33 offen lds
    buffer_load_dwordx4 v223, s[8:11], s33 offen offset:1024 lds
    ds_read_b64_tr_b16 v[176:177], v234 offset:6144
    ds_read_b64_tr_b16 v[178:179], v234 offset:7168
    v_mfma_f32_32x32x16_bf16 v[32:47], v[80:83], v[180:183], v[32:47]
    v_mfma_f32_32x32x16_bf16 v[48:63], v[84:87], v[180:183], v[48:63]
    ds_read_b64_tr_b16 v[180:181], v235 offset:6144
    ds_read_b64_tr_b16 v[182:183], v235 offset:7168
    s_nop 0
    v_mul_f32 v184, v0, v96
    v_fmac_f32 v184, v1, v97
    v_fmac_f32 v184, v2, v98
    v_fmac_f32 v184, v3, v99
    v_fmac_f32 v184, v4, v100
    v_fmac_f32 v184, v5, v101
    v_fmac_f32 v184, v6, v102
    v_fmac_f32 v184, v7, v103
    v_mul_f32 v186, v8, v128
    v_fmac_f32 v186, v9, v129
    v_fmac_f32 v186, v10, v130
    v_fmac_f32 v186, v11, v131
    v_fmac_f32 v186, v12, v132
    v_fmac_f32 v186, v13, v133
    v_fmac_f32 v186, v14, v134
    v_fmac_f32 v186, v15, v135
    s_waitcnt lgkmcnt(2)
    v_mfma_f32_32x32x16_bf16 v[0:15], v[64:67], v[176:179], 0
    v_mul_f32 v188, v16, v128
    v_fmac_f32 v188, v17, v129
    v_fmac_f32 v188, v18, v130
    v_fmac_f32 v188, v19, v131
    v_fmac_f32 v188, v20, v132
    v_fmac_f32 v188, v21, v133
    v_fmac_f32 v188, v22, v134
    v_fmac_f32 v188, v23, v135
    v_mul_f32 v190, v24, v128
    v_fmac_f32 v190, v25, v129
    v_fmac_f32 v190, v26, v130
    v_fmac_f32 v190, v27, v131
    v_fmac_f32 v190, v28, v132
    v_fmac_f32 v190, v29, v133
    v_fmac_f32 v190, v30, v134
    v_fmac_f32 v190, v31, v135
    v_mfma_f32_32x32x16_bf16 v[16:31], v[68:71], v[176:179], 0
    s_add_u32 m0, s25, 6144
    s_waitcnt vmcnt(4) lgkmcnt(0)
    buffer_load_dwordx4 v224, s[4:7], s33 offen lds
    buffer_load_dwordx4 v225, s[8:11], s33 offen offset:1024 lds
    ds_read_b64_tr_b16 v[176:177], v234 offset:0
    ds_read_b64_tr_b16 v[178:179], v234 offset:1024
    v_mul_f32 v185, v32, v104
    v_fmac_f32 v185, v33, v105
    v_fmac_f32 v185, v34, v106
    v_fmac_f32 v185, v35, v107
    v_fmac_f32 v185, v36, v108
    v_fmac_f32 v185, v37, v109
    v_fmac_f32 v185, v38, v110
    v_fmac_f32 v185, v39, v111
    v_mul_f32 v187, v40, v136
    v_fmac_f32 v187, v41, v137
    v_fmac_f32 v187, v42, v138
    v_fmac_f32 v187, v43, v139
    v_fmac_f32 v187, v44, v140
    v_fmac_f32 v187, v45, v141
    v_fmac_f32 v187, v46, v142
    v_fmac_f32 v187, v47, v143
    v_mfma_f32_32x32x16_bf16 v[32:47], v[64:67], v[180:183], 0
    v_mul_f32 v189, v48, v136
    v_fmac_f32 v189, v49, v137
    v_fmac_f32 v189, v50, v138
    v_fmac_f32 v189, v51, v139
    v_fmac_f32 v189, v52, v140
    v_fmac_f32 v189, v53, v141
    v_fmac_f32 v189, v54, v142
    v_fmac_f32 v189, v55, v143
    v_mul_f32 v191, v56, v136
    v_fmac_f32 v191, v57, v137
    v_fmac_f32 v191, v58, v138
    v_fmac_f32 v191, v59, v139
    v_fmac_f32 v191, v60, v140
    v_fmac_f32 v191, v61, v141
    v_fmac_f32 v191, v62, v142
    v_fmac_f32 v191, v63, v143
    v_mfma_f32_32x32x16_bf16 v[48:63], v[68:71], v[180:183], 0
    ds_read_b64_tr_b16 v[180:181], v235 offset:0
    ds_read_b64_tr_b16 v[182:183], v235 offset:1024
    v_permlane32_swap_b32 v184, v186
    v_permlane32_swap_b32 v188, v190
    v_permlane32_swap_b32 v185, v187
    v_permlane32_swap_b32 v189, v191
    v_add_f32 v186, v184, v186
    v_add_f32 v190, v188, v190
    v_add_f32 v187, v185, v187
    v_add_f32 v191, v189, v191
    v_cvt_pk_bf16_f32 v186, v186, v187
    v_cvt_pk_bf16_f32 v190, v190, v191
    ds_write_b32 v243, v186 offset:0
    ds_write_b32 v243, v190 offset:256
    s_waitcnt lgkmcnt(4)
    v_mfma_f32_32x32x16_bf16 v[0:15], v[72:75], v[176:179], v[0:15]
    v_mfma_f32_32x32x16_bf16 v[16:31], v[76:79], v[176:179], v[16:31]
    s_add_u32 m0, s25, 0
    s_waitcnt vmcnt(4) lgkmcnt(2)
    buffer_load_dwordx4 v226, s[4:7], s33 offen lds
    buffer_load_dwordx4 v227, s[8:11], s33 offen offset:1024 lds
    ds_read_b64_tr_b16 v[176:177], v234 offset:2048
    ds_read_b64_tr_b16 v[178:179], v234 offset:3072
    v_mfma_f32_32x32x16_bf16 v[32:47], v[72:75], v[180:183], v[32:47]
    v_mfma_f32_32x32x16_bf16 v[48:63], v[76:79], v[180:183], v[48:63]
    ds_read_b64_tr_b16 v[180:181], v235 offset:2048
    ds_read_b64_tr_b16 v[182:183], v235 offset:3072
    s_waitcnt lgkmcnt(2)
    v_mfma_f32_32x32x16_bf16 v[0:15], v[80:83], v[176:179], v[0:15]
    v_mfma_f32_32x32x16_bf16 v[16:31], v[84:87], v[176:179], v[16:31]
    s_add_u32 m0, s25, 2048
    s_waitcnt vmcnt(4) lgkmcnt(0)
    buffer_load_dwordx4 v222, s[4:7], s34 offen lds
    buffer_load_dwordx4 v223, s[8:11], s34 offen offset:1024 lds
    ds_read_b64_tr_b16 v[176:177], v234 offset:4096
    ds_read_b64_tr_b16 v[178:179], v234 offset:5120
    v_mfma_f32_32x32x16_bf16 v[32:47], v[80:83], v[180:183], v[32:47]
    v_add_u32 v244, s39, v239
    ds_read_u16 v222, v244
    ds_read_u16 v223, v244 offset:64
    v_mfma_f32_32x32x16_bf16 v[48:63], v[84:87], v[180:183], v[48:63]
    ds_read_b64_tr_b16 v[180:181], v235 offset:4096
    ds_read_b64_tr_b16 v[182:183], v235 offset:5120
    v_mul_f32 v184, v0, v144
    v_fmac_f32 v184, v1, v145
    v_fmac_f32 v184, v2, v146
    v_fmac_f32 v184, v3, v147
    v_fmac_f32 v184, v4, v148
    v_fmac_f32 v184, v5, v149
    v_fmac_f32 v184, v6, v150
    v_fmac_f32 v184, v7, v151
    v_mul_f32 v186, v8, v112
    v_fmac_f32 v186, v9, v113
    v_fmac_f32 v186, v10, v114
    v_fmac_f32 v186, v11, v115
    v_fmac_f32 v186, v12, v116
    v_fmac_f32 v186, v13, v117
    v_fmac_f32 v186, v14, v118
    v_fmac_f32 v186, v15, v119
    s_waitcnt lgkmcnt(4)
    v_mfma_f32_32x32x16_bf16 v[0:15], v[64:67], v[176:179], 0
    v_mul_f32_e64 v188, v16, -v160
    v_fma_f32 v188, v17, -v161, v188
    v_fma_f32 v188, v18, -v162, v188
    v_fma_f32 v188, v19, -v163, v188
    v_fma_f32 v188, v20, -v164, v188
    v_fma_f32 v188, v21, -v165, v188
    v_fma_f32 v188, v22, -v166, v188
    v_fma_f32 v188, v23, -v167, v188
    v_mul_f32 v190, v24, v160
    v_fmac_f32 v190, v25, v161
    v_fmac_f32 v190, v26, v162
    v_fmac_f32 v190, v27, v163
    v_fmac_f32 v190, v28, v164
    v_fmac_f32 v190, v29, v165
    v_fmac_f32 v190, v30, v166
    v_fmac_f32 v190, v31, v167
    v_mfma_f32_32x32x16_bf16 v[16:31], v[68:71], v[176:179], 0
    s_add_u32 m0, s25, 4096
    s_waitcnt vmcnt(4) lgkmcnt(0)
    buffer_load_dwordx4 v224, s[4:7], s34 offen lds
    buffer_load_dwordx4 v225, s[8:11], s34 offen offset:1024 lds
    ds_read_b64_tr_b16 v[176:177], v234 offset:6144
    ds_read_b64_tr_b16 v[178:179], v234 offset:7168
    v_mul_f32 v185, v32, v152
    v_fmac_f32 v185, v33, v153
    v_fmac_f32 v185, v34, v154
    v_fmac_f32 v185, v35, v155
    v_fmac_f32 v185, v36, v156
    v_fmac_f32 v185, v37, v157
    v_fmac_f32 v185, v38, v158
    v_fmac_f32 v185, v39, v159
    v_mul_f32 v187, v40, v120
    v_fmac_f32 v187, v41, v121
    v_fmac_f32 v187, v42, v122
    v_fmac_f32 v187, v43, v123
    v_fmac_f32 v187, v44, v124
    v_fmac_f32 v187, v45, v125
    v_fmac_f32 v187, v46, v126
    v_fmac_f32 v187, v47, v127
    v_mfma_f32_32x32x16_bf16 v[32:47], v[64:67], v[180:183], 0
    v_add_u32 v244, s40, v239
    ds_read_u16 v224, v244
    ds_read_u16 v225, v244 offset:64
    v_mul_f32_e64 v189, v48, -v168
    v_fma_f32 v189, v49, -v169, v189
    v_fma_f32 v189, v50, -v170, v189
    v_fma_f32 v189, v51, -v171, v189
    v_fma_f32 v189, v52, -v172, v189
    v_fma_f32 v189, v53, -v173, v189
    v_fma_f32 v189, v54, -v174, v189
    v_fma_f32 v189, v55, -v175, v189
    v_mul_f32 v191, v56, v168
    v_fmac_f32 v191, v57, v169
    v_fmac_f32 v191, v58, v170
    v_fmac_f32 v191, v59, v171
    v_fmac_f32 v191, v60, v172
    v_fmac_f32 v191, v61, v173
    v_fmac_f32 v191, v62, v174
    v_fmac_f32 v191, v63, v175
    v_mfma_f32_32x32x16_bf16 v[48:63], v[68:71], v[180:183], 0
    ds_read_b64_tr_b16 v[180:181], v235 offset:6144
    ds_read_b64_tr_b16 v[182:183], v235 offset:7168
    s_waitcnt lgkmcnt(4)
    v_mfma_f32_32x32x16_bf16 v[0:15], v[72:75], v[176:179], v[0:15]
    v_mfma_f32_32x32x16_bf16 v[16:31], v[76:79], v[176:179], v[16:31]
    s_add_u32 m0, s25, 6144
    s_waitcnt vmcnt(4) lgkmcnt(0)
    buffer_load_dwordx4 v226, s[4:7], s34 offen lds
    buffer_load_dwordx4 v227, s[8:11], s34 offen offset:1024 lds
    ds_read_b64_tr_b16 v[176:177], v234 offset:0
    ds_read_b64_tr_b16 v[178:179], v234 offset:1024
    v_mfma_f32_32x32x16_bf16 v[32:47], v[72:75], v[180:183], v[32:47]
    v_add_u32 v244, s41, v239
    ds_read_u16 v226, v244
    ds_read_u16 v227, v244 offset:64
    v_mfma_f32_32x32x16_bf16 v[48:63], v[76:79], v[180:183], v[48:63]
    ds_read_b64_tr_b16 v[180:181], v235 offset:0
    ds_read_b64_tr_b16 v[182:183], v235 offset:1024
    s_waitcnt lgkmcnt(4)
    v_mfma_f32_32x32x16_bf16 v[0:15], v[80:83], v[176:179], v[0:15]
    v_mfma_f32_32x32x16_bf16 v[16:31], v[84:87], v[176:179], v[16:31]
    v_lshl_add_u32 v222, v222, 10, v236
    v_lshl_add_u32 v223, v223, 10, v236
    s_add_u32 m0, s25, 0
    s_waitcnt vmcnt(4) lgkmcnt(0)
    buffer_load_dwordx4 v222, s[4:7], s35 offen lds
    buffer_load_dwordx4 v223, s[8:11], s35 offen offset:1024 lds
    ds_read_b64_tr_b16 v[176:177], v234 offset:2048
    ds_read_b64_tr_b16 v[178:179], v234 offset:3072
    v_mfma_f32_32x32x16_bf16 v[32:47], v[80:83], v[180:183], v[32:47]
    v_mfma_f32_32x32x16_bf16 v[48:63], v[84:87], v[180:183], v[48:63]
    ds_read_b64_tr_b16 v[180:181], v235 offset:2048
    ds_read_b64_tr_b16 v[182:183], v235 offset:3072
    v_mul_f32 v246, v0, v144
    v_fmac_f32 v246, v1, v145
    v_fmac_f32 v246, v2, v146
    v_fmac_f32 v246, v3, v147
    v_fmac_f32 v246, v4, v148
    v_fmac_f32 v246, v5, v149
    v_fmac_f32 v246, v6, v150
    v_fmac_f32 v246, v7, v151
    v_fmac_f32 v188, v8, v160
    v_fmac_f32 v188, v9, v161
    v_fmac_f32 v188, v10, v162
    v_fmac_f32 v188, v11, v163
    v_fmac_f32 v188, v12, v164
    v_fmac_f32 v188, v13, v165
    v_fmac_f32 v188, v14, v166
    v_fmac_f32 v188, v15, v167
    s_waitcnt lgkmcnt(2)
    v_mfma_f32_32x32x16_bf16 v[0:15], v[64:67], v[176:179], 0
    v_permlane32_swap_b32 v184, v246
    v_fmac_f32 v186, v16, v112
    v_fmac_f32 v186, v17, v113
    v_fmac_f32 v186, v18, v114
    v_fmac_f32 v186, v19, v115
    v_fmac_f32 v186, v20, v116
    v_fmac_f32 v186, v21, v117
    v_fmac_f32 v186, v22, v118
    v_fmac_f32 v186, v23, v119
    v_add_f32 v246, v184, v246
    v_mul_f32_e64 v184, v24, -v160
    v_fma_f32 v184, v25, -v161, v184
    v_fma_f32 v184, v26, -v162, v184
    v_fma_f32 v184, v27, -v163, v184
    v_fma_f32 v184, v28, -v164, v184
    v_fma_f32 v184, v29, -v165, v184
    v_fma_f32 v184, v30, -v166, v184
    v_fma_f32 v184, v31, -v167, v184
    v_mfma_f32_32x32x16_bf16 v[16:31], v[68:71], v[176:179], 0
    v_lshl_add_u32 v224, v224, 10, v236
    v_lshl_add_u32 v225, v225, 10, v236
    s_add_u32 m0, s25, 2048
    s_waitcnt vmcnt(4) lgkmcnt(0)
    buffer_load_dwordx4 v224, s[4:7], s36 offen lds
    buffer_load_dwordx4 v225, s[8:11], s36 offen offset:1024 lds
    ds_read_b64_tr_b16 v[176:177], v234 offset:4096
    ds_read_b64_tr_b16 v[178:179], v234 offset:5120
    v_mul_f32 v247, v32, v152
    v_fmac_f32 v247, v33, v153
    v_fmac_f32 v247, v34, v154
    v_fmac_f32 v247, v35, v155
    v_fmac_f32 v247, v36, v156
    v_fmac_f32 v247, v37, v157
    v_fmac_f32 v247, v38, v158
    v_fmac_f32 v247, v39, v159
    v_fmac_f32 v189, v40, v168
    v_fmac_f32 v189, v41, v169
    v_fmac_f32 v189, v42, v170
    v_fmac_f32 v189, v43, v171
    v_fmac_f32 v189, v44, v172
    v_fmac_f32 v189, v45, v173
    v_fmac_f32 v189, v46, v174
    v_fmac_f32 v189, v47, v175
    v_mfma_f32_32x32x16_bf16 v[32:47], v[64:67], v[180:183], 0
    v_permlane32_swap_b32 v185, v247
    v_fmac_f32 v187, v48, v120
    v_fmac_f32 v187, v49, v121
    v_fmac_f32 v187, v50, v122
    v_fmac_f32 v187, v51, v123
    v_fmac_f32 v187, v52, v124
    v_fmac_f32 v187, v53, v125
    v_fmac_f32 v187, v54, v126
    v_fmac_f32 v187, v55, v127
    v_add_f32 v247, v185, v247
    v_mul_f32_e64 v185, v56, -v168
    v_fma_f32 v185, v57, -v169, v185
    v_fma_f32 v185, v58, -v170, v185
    v_fma_f32 v185, v59, -v171, v185
    v_fma_f32 v185, v60, -v172, v185
    v_fma_f32 v185, v61, -v173, v185
    v_fma_f32 v185, v62, -v174, v185
    v_fma_f32 v185, v63, -v175, v185
    v_mfma_f32_32x32x16_bf16 v[48:63], v[68:71], v[180:183], 0
    ds_read_b64_tr_b16 v[180:181], v235 offset:4096
    ds_read_b64_tr_b16 v[182:183], v235 offset:5120
    v_cvt_pk_bf16_f32 v246, v246, v247
    ds_write_b32 v243, v246 offset:512
    s_waitcnt lgkmcnt(3)
    v_mfma_f32_32x32x16_bf16 v[0:15], v[72:75], v[176:179], v[0:15]
    v_mfma_f32_32x32x16_bf16 v[16:31], v[76:79], v[176:179], v[16:31]
    v_lshl_add_u32 v226, v226, 10, v236
    v_lshl_add_u32 v227, v227, 10, v236
    s_add_u32 m0, s25, 4096
    s_waitcnt vmcnt(4) lgkmcnt(1)
    buffer_load_dwordx4 v226, s[4:7], s37 offen lds
    buffer_load_dwordx4 v227, s[8:11], s37 offen offset:1024 lds
    ds_read_b64_tr_b16 v[176:177], v234 offset:6144
    ds_read_b64_tr_b16 v[178:179], v234 offset:7168
    v_mfma_f32_32x32x16_bf16 v[32:47], v[72:75], v[180:183], v[32:47]
    v_mfma_f32_32x32x16_bf16 v[48:63], v[76:79], v[180:183], v[48:63]
    ds_read_b64_tr_b16 v[180:181], v235 offset:6144
    ds_read_b64_tr_b16 v[182:183], v235 offset:7168
    s_waitcnt lgkmcnt(2)
    v_mfma_f32_32x32x16_bf16 v[0:15], v[80:83], v[176:179], v[0:15]
    v_mfma_f32_32x32x16_bf16 v[16:31], v[84:87], v[176:179], v[16:31]
    v_lshl_add_u32 v228, v228, 10, v236
    v_lshl_add_u32 v229, v229, 10, v236
    s_add_u32 m0, s25, 6144
    s_waitcnt vmcnt(4) lgkmcnt(0)
    buffer_load_dwordx4 v228, s[4:7], s38 offen lds
    buffer_load_dwordx4 v229, s[8:11], s38 offen offset:1024 lds
    ds_read_b64_tr_b16 v[176:177], v234 offset:0
    ds_read_b64_tr_b16 v[178:179], v234 offset:1024
    v_mfma_f32_32x32x16_bf16 v[32:47], v[80:83], v[180:183], v[32:47]
    v_mfma_f32_32x32x16_bf16 v[48:63], v[84:87], v[180:183], v[48:63]
    ds_read_b64_tr_b16 v[180:181], v235 offset:0
    ds_read_b64_tr_b16 v[182:183], v235 offset:1024
    v_add_u32 v241, s45, v237
    v_add_u32 v242, s39, v238
    ds_read_b32 v252, v251 offset:16
    ds_read_b64_tr_b16 v[68:69], v241 offset:0
    ds_read_b64_tr_b16 v[70:71], v241 offset:256
    s_mov_b64 exec, s[50:51]
    ds_read_u16_d16_hi v230, v242 offset:0
    s_mov_b64 exec, -1
    v_mul_f32 v246, v0, v144
    v_fmac_f32 v246, v1, v145
    v_fmac_f32 v246, v2, v146
    v_fmac_f32 v246, v3, v147
    v_fmac_f32 v246, v4, v148
    v_fmac_f32 v246, v5, v149
    v_fmac_f32 v246, v6, v150
    v_fmac_f32 v246, v7, v151
    v_fma_f32 v190, v8, -v160, v190
    v_fma_f32 v190, v9, -v161, v190
    v_fma_f32 v190, v10, -v162, v190
    v_fma_f32 v190, v11, -v163, v190
    v_fma_f32 v190, v12, -v164, v190
    v_fma_f32 v190, v13, -v165, v190
    v_fma_f32 v190, v14, -v166, v190
    v_fma_f32 v190, v15, -v167, v190
    v_fmac_f32 v184, v16, v160
    v_fmac_f32 v184, v17, v161
    v_fmac_f32 v184, v18, v162
    v_fmac_f32 v184, v19, v163
    v_fmac_f32 v184, v20, v164
    v_fmac_f32 v184, v21, v165
    v_fmac_f32 v184, v22, v166
    v_fmac_f32 v184, v23, v167
    v_fmac_f32 v186, v24, v112
    v_fmac_f32 v186, v25, v113
    v_fmac_f32 v186, v26, v114
    v_fmac_f32 v186, v27, v115
    v_fmac_f32 v186, v28, v116
    v_fmac_f32 v186, v29, v117
    v_fmac_f32 v186, v30, v118
    v_fmac_f32 v186, v31, v119
    v_mul_f32 v247, v32, v152
    v_fmac_f32 v247, v33, v153
    v_fmac_f32 v247, v34, v154
    v_fmac_f32 v247, v35, v155
    v_fmac_f32 v247, v36, v156
    v_fmac_f32 v247, v37, v157
    v_fmac_f32 v247, v38, v158
    v_fmac_f32 v247, v39, v159
    v_fma_f32 v191, v40, -v168, v191
    v_fma_f32 v191, v41, -v169, v191
    v_fma_f32 v191, v42, -v170, v191
    v_fma_f32 v191, v43, -v171, v191
    v_fma_f32 v191, v44, -v172, v191
    v_fma_f32 v191, v45, -v173, v191
    v_fma_f32 v191, v46, -v174, v191
    v_fma_f32 v191, v47, -v175, v191
    v_fmac_f32 v185, v48, v168
    v_fmac_f32 v185, v49, v169
    v_fmac_f32 v185, v50, v170
    v_fmac_f32 v185, v51, v171
    v_fmac_f32 v185, v52, v172
    v_fmac_f32 v185, v53, v173
    v_fmac_f32 v185, v54, v174
    v_fmac_f32 v185, v55, v175
    v_fmac_f32 v187, v56, v120
    v_fmac_f32 v187, v57, v121
    v_fmac_f32 v187, v58, v122
    v_fmac_f32 v187, v59, v123
    v_fmac_f32 v187, v60, v124
    v_fmac_f32 v187, v61, v125
    v_fmac_f32 v187, v62, v126
    v_fmac_f32 v187, v63, v127
    s_nop 0
    v_permlane32_swap_b32 v246, v188
    v_permlane32_swap_b32 v190, v244
    v_permlane32_swap_b32 v186, v184
    v_permlane32_swap_b32 v247, v189
    v_permlane32_swap_b32 v191, v245
    v_permlane32_swap_b32 v187, v185
    v_add_f32 v188, v246, v188
    v_add_f32 v244, v190, v244
    v_add_f32 v184, v186, v184
    v_add_f32 v189, v247, v189
    v_add_f32 v245, v191, v245
    v_add_f32 v185, v187, v185
    v_cvt_pk_bf16_f32 v188, v188, v189
    v_cvt_pk_bf16_f32 v244, v244, v245
    v_cvt_pk_bf16_f32 v184, v184, v185
    ds_write_b32 v243, v188 offset:768
    ds_write_b32 v243, v244 offset:1280
    ds_write_b32 v243, v184 offset:1024
    s_branch NEXT_1
.p2align 6
ITEM_1_3:
    ds_read_b64_tr_b16 v[76:77], v241 offset:512
    s_mov_b64 exec, s[50:51]
    ds_read_u16_d16_hi v231, v242 offset:128
    s_mov_b64 exec, -1
    v_add_u32 v244, s41, v239
    ds_read_u16 v226, v244
    ds_read_u16 v227, v244 offset:64
    v_add_u32 v244, s42, v239
    ds_read_u16 v228, v244
    ds_read_u16 v229, v244 offset:64
    v_xor_b32 v243, s65, v240
    v_add_u32 v243, s46, v243
    s_waitcnt lgkmcnt(6)
    v_lshlrev_b32 v184, 16, v68
    v_and_b32 v185, 0xffff0000, v68
    v_lshlrev_b32 v186, 16, v69
    v_and_b32 v187, 0xffff0000, v69
    v_mul_f32_dpp v188, v230, v184 row_newbcast:0 row_mask:0xf bank_mask:0xf
    v_mul_f32_dpp v189, v230, v185 row_newbcast:1 row_mask:0xf bank_mask:0xf
    v_mul_f32_dpp v190, v230, v184 row_newbcast:8 row_mask:0xf bank_mask:0xf
    v_mul_f32_dpp v191, v230, v185 row_newbcast:9 row_mask:0xf bank_mask:0xf
    v_lshlrev_b32 v184, 16, v70
    v_and_b32 v185, 0xffff0000, v70
    v_cvt_pk_bf16_f32 v64, v188, v189
    v_cvt_pk_bf16_f32 v68, v190, v191
    v_mul_f32_dpp v188, v230, v186 row_newbcast:2 row_mask:0xf bank_mask:0xf
    v_mul_f32_dpp v189, v230, v187 row_newbcast:3 row_mask:0xf bank_mask:0xf
    v_mul_f32_dpp v190, v230, v186 row_newbcast:10 row_mask:0xf bank_mask:0xf
    v_mul_f32_dpp v191, v230, v187 row_newbcast:11 row_mask:0xf bank_mask:0xf
    v_lshlrev_b32 v186, 16, v71
    v_and_b32 v187, 0xffff0000, v71
    v_cvt_pk_bf16_f32 v65, v188, v189
    v_cvt_pk_bf16_f32 v69, v190, v191
    v_mul_f32_dpp v188, v230, v184 row_newbcast:4 row_mask:0xf bank_mask:0xf
    v_mul_f32_dpp v189, v230, v185 row_newbcast:5 row_mask:0xf bank_mask:0xf
    v_mul_f32_dpp v190, v230, v184 row_newbcast:12 row_mask:0xf bank_mask:0xf
    v_mul_f32_dpp v191, v230, v185 row_newbcast:13 row_mask:0xf bank_mask:0xf
    v_cvt_pk_bf16_f32 v66, v188, v189
    v_cvt_pk_bf16_f32 v70, v190, v191
    v_mul_f32_dpp v188, v230, v186 row_newbcast:6 row_mask:0xf bank_mask:0xf
    v_mul_f32_dpp v189, v230, v187 row_newbcast:7 row_mask:0xf bank_mask:0xf
    v_mul_f32_dpp v190, v230, v186 row_newbcast:14 row_mask:0xf bank_mask:0xf
    v_mul_f32_dpp v191, v230, v187 row_newbcast:15 row_mask:0xf bank_mask:0xf
    v_cvt_pk_bf16_f32 v67, v188, v189
    v_cvt_pk_bf16_f32 v71, v190, v191
    s_nop 0
    s_waitcnt lgkmcnt(4)
    v_mfma_f32_32x32x16_bf16 v[0:15], v[64:67], v[176:179], 0
    v_lshlrev_b32 v184, 16, v76
    v_and_b32 v185, 0xffff0000, v76
    v_lshlrev_b32 v186, 16, v77
    v_and_b32 v187, 0xffff0000, v77
    v_mfma_f32_32x32x16_bf16 v[16:31], v[68:71], v[176:179], 0
    s_add_u32 m0, s25, 0
    s_waitcnt vmcnt(4)
    buffer_load_dwordx4 v222, s[4:7], s33 offen lds
    buffer_load_dwordx4 v223, s[8:11], s33 offen offset:1024 lds
    ds_read_b64_tr_b16 v[176:177], v234 offset:2048
    v_mul_f32_dpp v188, v231, v184 row_newbcast:0 row_mask:0xf bank_mask:0xf
    v_mul_f32_dpp v189, v231, v185 row_newbcast:1 row_mask:0xf bank_mask:0xf
    v_mul_f32_dpp v190, v231, v184 row_newbcast:8 row_mask:0xf bank_mask:0xf
    v_mul_f32_dpp v191, v231, v185 row_newbcast:9 row_mask:0xf bank_mask:0xf
    v_mfma_f32_32x32x16_bf16 v[32:47], v[64:67], v[180:183], 0
    v_cvt_pk_bf16_f32 v72, v188, v189
    v_cvt_pk_bf16_f32 v76, v190, v191
    v_mul_f32_dpp v188, v231, v186 row_newbcast:2 row_mask:0xf bank_mask:0xf
    v_mul_f32_dpp v189, v231, v187 row_newbcast:3 row_mask:0xf bank_mask:0xf
    v_mfma_f32_32x32x16_bf16 v[48:63], v[68:71], v[180:183], 0
    ds_read_b64_tr_b16 v[180:181], v235 offset:2048
    v_mul_f32_dpp v190, v231, v186 row_newbcast:10 row_mask:0xf bank_mask:0xf
    v_mul_f32_dpp v191, v231, v187 row_newbcast:11 row_mask:0xf bank_mask:0xf
    v_cvt_pk_bf16_f32 v73, v188, v189
    v_cvt_pk_bf16_f32 v77, v190, v191
    s_nop 0
    s_waitcnt lgkmcnt(1)
    v_mfma_f32_32x32x8_bf16 v[0:15], v[72:73], v[176:177], v[0:15]
    v_mfma_f32_32x32x8_bf16 v[16:31], v[76:77], v[176:177], v[16:31]
    s_add_u32 m0, s25, 2048
    s_waitcnt vmcnt(4) lgkmcnt(0)
    buffer_load_dwordx4 v224, s[4:7], s33 offen lds
    ds_read_b64_tr_b16 v[176:177], v234 offset:4096
    ds_read_b64_tr_b16 v[178:179], v234 offset:5120
    v_mfma_f32_32x32x8_bf16 v[32:47], v[72:73], v[180:181], v[32:47]
    v_mfma_f32_32x32x8_bf16 v[48:63], v[76:77], v[180:181], v[48:63]
    ds_read_b64_tr_b16 v[180:181], v235 offset:4096
    ds_read_b64_tr_b16 v[182:183], v235 offset:5120
    s_nop 1
    v_mul_f32 v184, v0, v96
    v_fmac_f32 v184, v1, v97
    v_fmac_f32 v184, v2, v98
    v_fmac_f32 v184, v3, v99
    v_fmac_f32 v184, v4, v100
    v_fmac_f32 v184, v5, v101
    v_fmac_f32 v184, v6, v102
    v_fmac_f32 v184, v7, v103
    v_mul_f32 v186, v8, v128
    v_fmac_f32 v186, v9, v129
    v_fmac_f32 v186, v10, v130
    v_fmac_f32 v186, v11, v131
    v_fmac_f32 v186, v12, v132
    v_fmac_f32 v186, v13, v133
    v_fmac_f32 v186, v14, v134
    v_fmac_f32 v186, v15, v135
    s_waitcnt lgkmcnt(2)
    v_mfma_f32_32x32x16_bf16 v[0:15], v[64:67], v[176:179], 0
    v_mul_f32 v188, v16, v128
    v_fmac_f32 v188, v17, v129
    v_fmac_f32 v188, v18, v130
    v_fmac_f32 v188, v19, v131
    v_fmac_f32 v188, v20, v132
    v_fmac_f32 v188, v21, v133
    v_fmac_f32 v188, v22, v134
    v_fmac_f32 v188, v23, v135
    v_mul_f32 v190, v24, v128
    v_fmac_f32 v190, v25, v129
    v_fmac_f32 v190, v26, v130
    v_fmac_f32 v190, v27, v131
    v_fmac_f32 v190, v28, v132
    v_fmac_f32 v190, v29, v133
    v_fmac_f32 v190, v30, v134
    v_fmac_f32 v190, v31, v135
    v_mfma_f32_32x32x16_bf16 v[16:31], v[68:71], v[176:179], 0
    s_add_u32 m0, s25, 4096
    s_waitcnt vmcnt(3) lgkmcnt(0)
    buffer_load_dwordx4 v222, s[4:7], s34 offen lds
    buffer_load_dwordx4 v223, s[8:11], s34 offen offset:1024 lds
    ds_read_b64_tr_b16 v[176:177], v234 offset:6144
    v_mul_f32 v185, v32, v104
    v_fmac_f32 v185, v33, v105
    v_fmac_f32 v185, v34, v106
    v_fmac_f32 v185, v35, v107
    v_fmac_f32 v185, v36, v108
    v_fmac_f32 v185, v37, v109
    v_fmac_f32 v185, v38, v110
    v_fmac_f32 v185, v39, v111
    v_mul_f32 v187, v40, v136
    v_fmac_f32 v187, v41, v137
    v_fmac_f32 v187, v42, v138
    v_fmac_f32 v187, v43, v139
    v_fmac_f32 v187, v44, v140
    v_fmac_f32 v187, v45, v141
    v_fmac_f32 v187, v46, v142
    v_fmac_f32 v187, v47, v143
    v_mfma_f32_32x32x16_bf16 v[32:47], v[64:67], v[180:183], 0
    v_add_u32 v244, s39, v239
    ds_read_u16 v222, v244
    ds_read_u16 v223, v244 offset:64
    v_mul_f32 v189, v48, v136
    v_fmac_f32 v189, v49, v137
    v_fmac_f32 v189, v50, v138
    v_fmac_f32 v189, v51, v139
    v_fmac_f32 v189, v52, v140
    v_fmac_f32 v189, v53, v141
    v_fmac_f32 v189, v54, v142
    v_fmac_f32 v189, v55, v143
    v_mul_f32 v191, v56, v136
    v_fmac_f32 v191, v57, v137
    v_fmac_f32 v191, v58, v138
    v_fmac_f32 v191, v59, v139
    v_fmac_f32 v191, v60, v140
    v_fmac_f32 v191, v61, v141
    v_fmac_f32 v191, v62, v142
    v_fmac_f32 v191, v63, v143
    v_mfma_f32_32x32x16_bf16 v[48:63], v[68:71], v[180:183], 0
    ds_read_b64_tr_b16 v[180:181], v235 offset:6144
    v_permlane32_swap_b32 v184, v186
    v_permlane32_swap_b32 v188, v190
    v_permlane32_swap_b32 v185, v187
    v_permlane32_swap_b32 v189, v191
    v_add_f32 v186, v184, v186
    v_add_f32 v190, v188, v190
    v_add_f32 v187, v185, v187
    v_add_f32 v191, v189, v191
    v_cvt_pk_bf16_f32 v186, v186, v187
    v_cvt_pk_bf16_f32 v190, v190, v191
    ds_write_b32 v243, v186 offset:0
    ds_write_b32 v243, v190 offset:256
    s_waitcnt lgkmcnt(5)
    v_mfma_f32_32x32x8_bf16 v[0:15], v[72:73], v[176:177], v[0:15]
    v_mfma_f32_32x32x8_bf16 v[16:31], v[76:77], v[176:177], v[16:31]
    s_add_u32 m0, s25, 6144
    s_waitcnt vmcnt(3) lgkmcnt(2)
    buffer_load_dwordx4 v224, s[4:7], s34 offen lds
    ds_read_b64_tr_b16 v[176:177], v234 offset:0
    ds_read_b64_tr_b16 v[178:179], v234 offset:1024
    v_mfma_f32_32x32x8_bf16 v[32:47], v[72:73], v[180:181], v[32:47]
    v_add_u32 v244, s40, v239
    ds_read_u16 v224, v244
    ds_read_u16 v225, v244 offset:64
    v_mfma_f32_32x32x8_bf16 v[48:63], v[76:77], v[180:181], v[48:63]
    ds_read_b64_tr_b16 v[180:181], v235 offset:0
    ds_read_b64_tr_b16 v[182:183], v235 offset:1024
    v_mul_f32 v184, v0, v144
    v_fmac_f32 v184, v1, v145
    v_fmac_f32 v184, v2, v146
    v_fmac_f32 v184, v3, v147
    v_fmac_f32 v184, v4, v148
    v_fmac_f32 v184, v5, v149
    v_fmac_f32 v184, v6, v150
    v_fmac_f32 v184, v7, v151
    v_mul_f32 v186, v8, v112
    v_fmac_f32 v186, v9, v113
    v_fmac_f32 v186, v10, v114
    v_fmac_f32 v186, v11, v115
    v_fmac_f32 v186, v12, v116
    v_fmac_f32 v186, v13, v117
    v_fmac_f32 v186, v14, v118
    v_fmac_f32 v186, v15, v119
    s_waitcnt lgkmcnt(4)
    v_mfma_f32_32x32x16_bf16 v[0:15], v[64:67], v[176:179], 0
    v_mul_f32_e64 v188, v16, -v160
    v_fma_f32 v188, v17, -v161, v188
    v_fma_f32 v188, v18, -v162, v188
    v_fma_f32 v188, v19, -v163, v188
    v_fma_f32 v188, v20, -v164, v188
    v_fma_f32 v188, v21, -v165, v188
    v_fma_f32 v188, v22, -v166, v188
    v_fma_f32 v188, v23, -v167, v188
    v_mul_f32 v190, v24, v160
    v_fmac_f32 v190, v25, v161
    v_fmac_f32 v190, v26, v162
    v_fmac_f32 v190, v27, v163
    v_fmac_f32 v190, v28, v164
    v_fmac_f32 v190, v29, v165
    v_fmac_f32 v190, v30, v166
    v_fmac_f32 v190, v31, v167
    v_mfma_f32_32x32x16_bf16 v[16:31], v[68:71], v[176:179], 0
    v_lshl_add_u32 v222, v222, 10, v236
    v_lshl_add_u32 v223, v223, 10, v236
    s_add_u32 m0, s25, 0
    s_waitcnt vmcnt(3) lgkmcnt(0)
    buffer_load_dwordx4 v222, s[4:7], s35 offen lds
    buffer_load_dwordx4 v223, s[8:11], s35 offen offset:1024 lds
    ds_read_b64_tr_b16 v[176:177], v234 offset:2048
    v_mul_f32 v185, v32, v152
    v_fmac_f32 v185, v33, v153
    v_fmac_f32 v185, v34, v154
    v_fmac_f32 v185, v35, v155
    v_fmac_f32 v185, v36, v156
    v_fmac_f32 v185, v37, v157
    v_fmac_f32 v185, v38, v158
    v_fmac_f32 v185, v39, v159
    v_mul_f32 v187, v40, v120
    v_fmac_f32 v187, v41, v121
    v_fmac_f32 v187, v42, v122
    v_fmac_f32 v187, v43, v123
    v_fmac_f32 v187, v44, v124
    v_fmac_f32 v187, v45, v125
    v_fmac_f32 v187, v46, v126
    v_fmac_f32 v187, v47, v127
    v_mfma_f32_32x32x16_bf16 v[32:47], v[64:67], v[180:183], 0
    v_mul_f32_e64 v189, v48, -v168
    v_fma_f32 v189, v49, -v169, v189
    v_fma_f32 v189, v50, -v170, v189
    v_fma_f32 v189, v51, -v171, v189
    v_fma_f32 v189, v52, -v172, v189
    v_fma_f32 v189, v53, -v173, v189
    v_fma_f32 v189, v54, -v174, v189
    v_fma_f32 v189, v55, -v175, v189
    v_mul_f32 v191, v56, v168
    v_fmac_f32 v191, v57, v169
    v_fmac_f32 v191, v58, v170
    v_fmac_f32 v191, v59, v171
    v_fmac_f32 v191, v60, v172
    v_fmac_f32 v191, v61, v173
    v_fmac_f32 v191, v62, v174
    v_fmac_f32 v191, v63, v175
    v_mfma_f32_32x32x16_bf16 v[48:63], v[68:71], v[180:183], 0
    ds_read_b64_tr_b16 v[180:181], v235 offset:2048
    s_waitcnt lgkmcnt(1)
    v_mfma_f32_32x32x8_bf16 v[0:15], v[72:73], v[176:177], v[0:15]
    v_mfma_f32_32x32x8_bf16 v[16:31], v[76:77], v[176:177], v[16:31]
    v_lshl_add_u32 v224, v224, 10, v236
    v_lshl_add_u32 v225, v225, 10, v236
    s_add_u32 m0, s25, 2048
    s_waitcnt vmcnt(3) lgkmcnt(0)
    buffer_load_dwordx4 v224, s[4:7], s36 offen lds
    buffer_load_dwordx4 v225, s[8:11], s36 offen offset:1024 lds
    ds_read_b64_tr_b16 v[176:177], v234 offset:4096
    ds_read_b64_tr_b16 v[178:179], v234 offset:5120
    v_mfma_f32_32x32x8_bf16 v[32:47], v[72:73], v[180:181], v[32:47]
    v_mfma_f32_32x32x8_bf16 v[48:63], v[76:77], v[180:181], v[48:63]
    ds_read_b64_tr_b16 v[180:181], v235 offset:4096
    ds_read_b64_tr_b16 v[182:183], v235 offset:5120
    v_mul_f32 v246, v0, v144
    v_fmac_f32 v246, v1, v145
    v_fmac_f32 v246, v2, v146
    v_fmac_f32 v246, v3, v147
    v_fmac_f32 v246, v4, v148
    v_fmac_f32 v246, v5, v149
    v_fmac_f32 v246, v6, v150
    v_fmac_f32 v246, v7, v151
    v_fmac_f32 v188, v8, v160
    v_fmac_f32 v188, v9, v161
    v_fmac_f32 v188, v10, v162
    v_fmac_f32 v188, v11, v163
    v_fmac_f32 v188, v12, v164
    v_fmac_f32 v188, v13, v165
    v_fmac_f32 v188, v14, v166
    v_fmac_f32 v188, v15, v167
    s_waitcnt lgkmcnt(2)
    v_mfma_f32_32x32x16_bf16 v[0:15], v[64:67], v[176:179], 0
    v_permlane32_swap_b32 v184, v246
    v_fmac_f32 v186, v16, v112
    v_fmac_f32 v186, v17, v113
    v_fmac_f32 v186, v18, v114
    v_fmac_f32 v186, v19, v115
    v_fmac_f32 v186, v20, v116
    v_fmac_f32 v186, v21, v117
    v_fmac_f32 v186, v22, v118
    v_fmac_f32 v186, v23, v119
    v_add_f32 v246, v184, v246
    v_mul_f32_e64 v184, v24, -v160
    v_fma_f32 v184, v25, -v161, v184
    v_fma_f32 v184, v26, -v162, v184
    v_fma_f32 v184, v27, -v163, v184
    v_fma_f32 v184, v28, -v164, v184
    v_fma_f32 v184, v29, -v165, v184
    v_fma_f32 v184, v30, -v166, v184
    v_fma_f32 v184, v31, -v167, v184
    v_mfma_f32_32x32x16_bf16 v[16:31], v[68:71], v[176:179], 0
    v_lshl_add_u32 v226, v226, 10, v236
    v_lshl_add_u32 v227, v227, 10, v236
    s_add_u32 m0, s25, 4096
    s_waitcnt vmcnt(4) lgkmcnt(0)
    buffer_load_dwordx4 v226, s[4:7], s37 offen lds
    buffer_load_dwordx4 v227, s[8:11], s37 offen offset:1024 lds
    ds_read_b64_tr_b16 v[176:177], v234 offset:6144
    v_mul_f32 v247, v32, v152
    v_fmac_f32 v247, v33, v153
    v_fmac_f32 v247, v34, v154
    v_fmac_f32 v247, v35, v155
    v_fmac_f32 v247, v36, v156
    v_fmac_f32 v247, v37, v157
    v_fmac_f32 v247, v38, v158
    v_fmac_f32 v247, v39, v159
    v_fmac_f32 v189, v40, v168
    v_fmac_f32 v189, v41, v169
    v_fmac_f32 v189, v42, v170
    v_fmac_f32 v189, v43, v171
    v_fmac_f32 v189, v44, v172
    v_fmac_f32 v189, v45, v173
    v_fmac_f32 v189, v46, v174
    v_fmac_f32 v189, v47, v175
    v_mfma_f32_32x32x16_bf16 v[32:47], v[64:67], v[180:183], 0
    v_permlane32_swap_b32 v185, v247
    v_fmac_f32 v187, v48, v120
    v_fmac_f32 v187, v49, v121
    v_fmac_f32 v187, v50, v122
    v_fmac_f32 v187, v51, v123
    v_fmac_f32 v187, v52, v124
    v_fmac_f32 v187, v53, v125
    v_fmac_f32 v187, v54, v126
    v_fmac_f32 v187, v55, v127
    v_add_f32 v247, v185, v247
    v_mul_f32_e64 v185, v56, -v168
    v_fma_f32 v185, v57, -v169, v185
    v_fma_f32 v185, v58, -v170, v185
    v_fma_f32 v185, v59, -v171, v185
    v_fma_f32 v185, v60, -v172, v185
    v_fma_f32 v185, v61, -v173, v185
    v_fma_f32 v185, v62, -v174, v185
    v_fma_f32 v185, v63, -v175, v185
    v_mfma_f32_32x32x16_bf16 v[48:63], v[68:71], v[180:183], 0
    ds_read_b64_tr_b16 v[180:181], v235 offset:6144
    v_cvt_pk_bf16_f32 v246, v246, v247
    ds_write_b32 v243, v246 offset:512
    s_waitcnt lgkmcnt(2)
    v_mfma_f32_32x32x8_bf16 v[0:15], v[72:73], v[176:177], v[0:15]
    v_mfma_f32_32x32x8_bf16 v[16:31], v[76:77], v[176:177], v[16:31]
    v_lshl_add_u32 v228, v228, 10, v236
    v_lshl_add_u32 v229, v229, 10, v236
    s_add_u32 m0, s25, 6144
    s_waitcnt vmcnt(4) lgkmcnt(1)
    buffer_load_dwordx4 v228, s[4:7], s38 offen lds
    buffer_load_dwordx4 v229, s[8:11], s38 offen offset:1024 lds
    ds_read_b64_tr_b16 v[176:177], v234 offset:0
    ds_read_b64_tr_b16 v[178:179], v234 offset:1024
    v_mfma_f32_32x32x8_bf16 v[32:47], v[72:73], v[180:181], v[32:47]
    v_mfma_f32_32x32x8_bf16 v[48:63], v[76:77], v[180:181], v[48:63]
    ds_read_b64_tr_b16 v[180:181], v235 offset:0
    ds_read_b64_tr_b16 v[182:183], v235 offset:1024
    v_add_u32 v241, s45, v237
    v_add_u32 v242, s39, v238
    ds_read_b32 v252, v251 offset:16
    ds_read_b64_tr_b16 v[68:69], v241 offset:0
    ds_read_b64_tr_b16 v[70:71], v241 offset:256
    s_mov_b64 exec, s[50:51]
    ds_read_u16_d16_hi v230, v242 offset:0
    s_mov_b64 exec, -1
    v_mul_f32 v246, v0, v144
    v_fmac_f32 v246, v1, v145
    v_fmac_f32 v246, v2, v146
    v_fmac_f32 v246, v3, v147
    v_fmac_f32 v246, v4, v148
    v_fmac_f32 v246, v5, v149
    v_fmac_f32 v246, v6, v150
    v_fmac_f32 v246, v7, v151
    v_fma_f32 v190, v8, -v160, v190
    v_fma_f32 v190, v9, -v161, v190
    v_fma_f32 v190, v10, -v162, v190
    v_fma_f32 v190, v11, -v163, v190
    v_fma_f32 v190, v12, -v164, v190
    v_fma_f32 v190, v13, -v165, v190
    v_fma_f32 v190, v14, -v166, v190
    v_fma_f32 v190, v15, -v167, v190
    v_fmac_f32 v184, v16, v160
    v_fmac_f32 v184, v17, v161
    v_fmac_f32 v184, v18, v162
    v_fmac_f32 v184, v19, v163
    v_fmac_f32 v184, v20, v164
    v_fmac_f32 v184, v21, v165
    v_fmac_f32 v184, v22, v166
    v_fmac_f32 v184, v23, v167
    v_fmac_f32 v186, v24, v112
    v_fmac_f32 v186, v25, v113
    v_fmac_f32 v186, v26, v114
    v_fmac_f32 v186, v27, v115
    v_fmac_f32 v186, v28, v116
    v_fmac_f32 v186, v29, v117
    v_fmac_f32 v186, v30, v118
    v_fmac_f32 v186, v31, v119
    v_mul_f32 v247, v32, v152
    v_fmac_f32 v247, v33, v153
    v_fmac_f32 v247, v34, v154
    v_fmac_f32 v247, v35, v155
    v_fmac_f32 v247, v36, v156
    v_fmac_f32 v247, v37, v157
    v_fmac_f32 v247, v38, v158
    v_fmac_f32 v247, v39, v159
    v_fma_f32 v191, v40, -v168, v191
    v_fma_f32 v191, v41, -v169, v191
    v_fma_f32 v191, v42, -v170, v191
    v_fma_f32 v191, v43, -v171, v191
    v_fma_f32 v191, v44, -v172, v191
    v_fma_f32 v191, v45, -v173, v191
    v_fma_f32 v191, v46, -v174, v191
    v_fma_f32 v191, v47, -v175, v191
    v_fmac_f32 v185, v48, v168
    v_fmac_f32 v185, v49, v169
    v_fmac_f32 v185, v50, v170
    v_fmac_f32 v185, v51, v171
    v_fmac_f32 v185, v52, v172
    v_fmac_f32 v185, v53, v173
    v_fmac_f32 v185, v54, v174
    v_fmac_f32 v185, v55, v175
    v_fmac_f32 v187, v56, v120
    v_fmac_f32 v187, v57, v121
    v_fmac_f32 v187, v58, v122
    v_fmac_f32 v187, v59, v123
    v_fmac_f32 v187, v60, v124
    v_fmac_f32 v187, v61, v125
    v_fmac_f32 v187, v62, v126
    v_fmac_f32 v187, v63, v127
    s_nop 0
    v_permlane32_swap_b32 v246, v188
    v_permlane32_swap_b32 v190, v244
    v_permlane32_swap_b32 v186, v184
    v_permlane32_swap_b32 v247, v189
    v_permlane32_swap_b32 v191, v245
    v_permlane32_swap_b32 v187, v185
    v_add_f32 v188, v246, v188
    v_add_f32 v244, v190, v244
    v_add_f32 v184, v186, v184
    v_add_f32 v189, v247, v189
    v_add_f32 v245, v191, v245
    v_add_f32 v185, v187, v185
    v_cvt_pk_bf16_f32 v188, v188, v189
    v_cvt_pk_bf16_f32 v244, v244, v245
    v_cvt_pk_bf16_f32 v184, v184, v185
    ds_write_b32 v243, v188 offset:768
    ds_write_b32 v243, v244 offset:1280
    ds_write_b32 v243, v184 offset:1024
    s_branch NEXT_1
.p2align 6
ITEM_1_8:
    ds_read_b64_tr_b16 v[76:77], v241 offset:512
    ds_read_b64_tr_b16 v[78:79], v241 offset:768
    ds_read_b64_tr_b16 v[84:85], v241 offset:1024
    ds_read_b64_tr_b16 v[86:87], v241 offset:1280
    ds_read_b64_tr_b16 v[92:93], v241 offset:1536
    ds_read_b64_tr_b16 v[94:95], v241 offset:1792
    s_mov_b64 exec, s[50:51]
    ds_read_u16_d16_hi v231, v242 offset:128
    ds_read_u16_d16_hi v232, v242 offset:256
    ds_read_u16_d16_hi v233, v242 offset:384
    s_mov_b64 exec, -1
    v_xor_b32 v243, s65, v240
    v_add_u32 v243, s46, v243
    s_waitcnt lgkmcnt(9)
    v_lshlrev_b32 v184, 16, v68
    v_and_b32 v185, 0xffff0000, v68
    v_lshlrev_b32 v186, 16, v69
    v_and_b32 v187, 0xffff0000, v69
    v_mul_f32_dpp v188, v230, v184 row_newbcast:0 row_mask:0xf bank_mask:0xf
    v_mul_f32_dpp v189, v230, v185 row_newbcast:1 row_mask:0xf bank_mask:0xf
    v_mul_f32_dpp v190, v230, v184 row_newbcast:8 row_mask:0xf bank_mask:0xf
    v_mul_f32_dpp v191, v230, v185 row_newbcast:9 row_mask:0xf bank_mask:0xf
    v_lshlrev_b32 v184, 16, v70
    v_and_b32 v185, 0xffff0000, v70
    v_cvt_pk_bf16_f32 v64, v188, v189
    v_cvt_pk_bf16_f32 v68, v190, v191
    v_mul_f32_dpp v188, v230, v186 row_newbcast:2 row_mask:0xf bank_mask:0xf
    v_mul_f32_dpp v189, v230, v187 row_newbcast:3 row_mask:0xf bank_mask:0xf
    v_mul_f32_dpp v190, v230, v186 row_newbcast:10 row_mask:0xf bank_mask:0xf
    v_mul_f32_dpp v191, v230, v187 row_newbcast:11 row_mask:0xf bank_mask:0xf
    v_lshlrev_b32 v186, 16, v71
    v_and_b32 v187, 0xffff0000, v71
    v_cvt_pk_bf16_f32 v65, v188, v189
    v_cvt_pk_bf16_f32 v69, v190, v191
    v_mul_f32_dpp v188, v230, v184 row_newbcast:4 row_mask:0xf bank_mask:0xf
    v_mul_f32_dpp v189, v230, v185 row_newbcast:5 row_mask:0xf bank_mask:0xf
    v_mul_f32_dpp v190, v230, v184 row_newbcast:12 row_mask:0xf bank_mask:0xf
    v_mul_f32_dpp v191, v230, v185 row_newbcast:13 row_mask:0xf bank_mask:0xf
    v_cvt_pk_bf16_f32 v66, v188, v189
    v_cvt_pk_bf16_f32 v70, v190, v191
    v_mul_f32_dpp v188, v230, v186 row_newbcast:6 row_mask:0xf bank_mask:0xf
    v_mul_f32_dpp v189, v230, v187 row_newbcast:7 row_mask:0xf bank_mask:0xf
    v_mul_f32_dpp v190, v230, v186 row_newbcast:14 row_mask:0xf bank_mask:0xf
    v_mul_f32_dpp v191, v230, v187 row_newbcast:15 row_mask:0xf bank_mask:0xf
    v_cvt_pk_bf16_f32 v67, v188, v189
    v_cvt_pk_bf16_f32 v71, v190, v191
    s_nop 0
    s_waitcnt lgkmcnt(0)
    v_mfma_f32_32x32x16_bf16 v[0:15], v[64:67], v[176:179], 0
    v_lshlrev_b32 v184, 16, v76
    v_and_b32 v185, 0xffff0000, v76
    v_lshlrev_b32 v186, 16, v77
    v_and_b32 v187, 0xffff0000, v77
    v_mul_f32_dpp v188, v231, v184 row_newbcast:0 row_mask:0xf bank_mask:0xf
    v_mul_f32_dpp v189, v231, v185 row_newbcast:1 row_mask:0xf bank_mask:0xf
    v_mul_f32_dpp v190, v231, v184 row_newbcast:8 row_mask:0xf bank_mask:0xf
    v_mul_f32_dpp v191, v231, v185 row_newbcast:9 row_mask:0xf bank_mask:0xf
    v_mfma_f32_32x32x16_bf16 v[16:31], v[68:71], v[176:179], 0
    s_add_u32 m0, s25, 0
    s_waitcnt vmcnt(4)
    buffer_load_dwordx4 v222, s[4:7], s32 offen lds
    buffer_load_dwordx4 v223, s[8:11], s32 offen offset:1024 lds
    ds_read_b64_tr_b16 v[176:177], v234 offset:2048
    ds_read_b64_tr_b16 v[178:179], v234 offset:3072
    v_lshlrev_b32 v184, 16, v78
    v_and_b32 v185, 0xffff0000, v78
    v_cvt_pk_bf16_f32 v72, v188, v189
    v_cvt_pk_bf16_f32 v76, v190, v191
    v_mul_f32_dpp v188, v231, v186 row_newbcast:2 row_mask:0xf bank_mask:0xf
    v_mul_f32_dpp v189, v231, v187 row_newbcast:3 row_mask:0xf bank_mask:0xf
    v_mul_f32_dpp v190, v231, v186 row_newbcast:10 row_mask:0xf bank_mask:0xf
    v_mul_f32_dpp v191, v231, v187 row_newbcast:11 row_mask:0xf bank_mask:0xf
    v_mfma_f32_32x32x16_bf16 v[32:47], v[64:67], v[180:183], 0
    v_lshlrev_b32 v186, 16, v79
    v_and_b32 v187, 0xffff0000, v79
    v_cvt_pk_bf16_f32 v73, v188, v189
    v_cvt_pk_bf16_f32 v77, v190, v191
    v_mul_f32_dpp v188, v231, v184 row_newbcast:4 row_mask:0xf bank_mask:0xf
    v_mul_f32_dpp v189, v231, v185 row_newbcast:5 row_mask:0xf bank_mask:0xf
    v_mul_f32_dpp v190, v231, v184 row_newbcast:12 row_mask:0xf bank_mask:0xf
    v_mul_f32_dpp v191, v231, v185 row_newbcast:13 row_mask:0xf bank_mask:0xf
    v_mfma_f32_32x32x16_bf16 v[48:63], v[68:71], v[180:183], 0
    ds_read_b64_tr_b16 v[180:181], v235 offset:2048
    ds_read_b64_tr_b16 v[182:183], v235 offset:3072
    v_cvt_pk_bf16_f32 v74, v188, v189
    v_cvt_pk_bf16_f32 v78, v190, v191
    v_mul_f32_dpp v188, v231, v186 row_newbcast:6 row_mask:0xf bank_mask:0xf
    v_mul_f32_dpp v189, v231, v187 row_newbcast:7 row_mask:0xf bank_mask:0xf
    v_mul_f32_dpp v190, v231, v186 row_newbcast:14 row_mask:0xf bank_mask:0xf
    v_mul_f32_dpp v191, v231, v187 row_newbcast:15 row_mask:0xf bank_mask:0xf
    v_cvt_pk_bf16_f32 v75, v188, v189
    v_cvt_pk_bf16_f32 v79, v190, v191
    s_nop 0
    s_waitcnt lgkmcnt(2)
    v_mfma_f32_32x32x16_bf16 v[0:15], v[72:75], v[176:179], v[0:15]
    v_lshlrev_b32 v184, 16, v84
    v_and_b32 v185, 0xffff0000, v84
    v_lshlrev_b32 v186, 16, v85
    v_and_b32 v187, 0xffff0000, v85
    v_mul_f32_dpp v188, v232, v184 row_newbcast:0 row_mask:0xf bank_mask:0xf
    v_mul_f32_dpp v189, v232, v185 row_newbcast:1 row_mask:0xf bank_mask:0xf
    v_mul_f32_dpp v190, v232, v184 row_newbcast:8 row_mask:0xf bank_mask:0xf
    v_mul_f32_dpp v191, v232, v185 row_newbcast:9 row_mask:0xf bank_mask:0xf
    v_mfma_f32_32x32x16_bf16 v[16:31], v[76:79], v[176:179], v[16:31]
    s_add_u32 m0, s25, 2048
    s_waitcnt vmcnt(4) lgkmcnt(0)
    buffer_load_dwordx4 v224, s[4:7], s32 offen lds
    buffer_load_dwordx4 v225, s[8:11], s32 offen offset:1024 lds
    ds_read_b64_tr_b16 v[176:177], v234 offset:4096
    ds_read_b64_tr_b16 v[178:179], v234 offset:5120
    v_lshlrev_b32 v184, 16, v86
    v_and_b32 v185, 0xffff0000, v86
    v_cvt_pk_bf16_f32 v80, v188, v189
    v_cvt_pk_bf16_f32 v84, v190, v191
    v_mul_f32_dpp v188, v232, v186 row_newbcast:2 row_mask:0xf bank_mask:0xf
    v_mul_f32_dpp v189, v232, v187 row_newbcast:3 row_mask:0xf bank_mask:0xf
    v_mul_f32_dpp v190, v232, v186 row_newbcast:10 row_mask:0xf bank_mask:0xf
    v_mul_f32_dpp v191, v232, v187 row_newbcast:11 row_mask:0xf bank_mask:0xf
    v_mfma_f32_32x32x16_bf16 v[32:47], v[72:75], v[180:183], v[32:47]
    v_lshlrev_b32 v186, 16, v87
    v_and_b32 v187, 0xffff0000, v87
    v_cvt_pk_bf16_f32 v81, v188, v189
    v_cvt_pk_bf16_f32 v85, v190, v191
    v_mul_f32_dpp v188, v232, v184 row_newbcast:4 row_mask:0xf bank_mask:0xf
    v_mul_f32_dpp v189, v232, v185 row_newbcast:5 row_mask:0xf bank_mask:0xf
    v_mul_f32_dpp v190, v232, v184 row_newbcast:12 row_mask:0xf bank_mask:0xf
    v_mul_f32_dpp v191, v232, v185 row_newbcast:13 row_mask:0xf bank_mask:0xf
    v_mfma_f32_32x32x16_bf16 v[48:63], v[76:79], v[180:183], v[48:63]
    ds_read_b64_tr_b16 v[180:181], v235 offset:4096
    ds_read_b64_tr_b16 v[182:183], v235 offset:5120
    v_cvt_pk_bf16_f32 v82, v188, v189
    v_cvt_pk_bf16_f32 v86, v190, v191
    v_mul_f32_dpp v188, v232, v186 row_newbcast:6 row_mask:0xf bank_mask:0xf
    v_mul_f32_dpp v189, v232, v187 row_newbcast:7 row_mask:0xf bank_mask:0xf
    v_mul_f32_dpp v190, v232, v186 row_newbcast:14 row_mask:0xf bank_mask:0xf
    v_mul_f32_dpp v191, v232, v187 row_newbcast:15 row_mask:0xf bank_mask:0xf
    v_cvt_pk_bf16_f32 v83, v188, v189
    v_cvt_pk_bf16_f32 v87, v190, v191
    s_nop 0
    s_waitcnt lgkmcnt(2)
    v_mfma_f32_32x32x16_bf16 v[0:15], v[80:83], v[176:179], v[0:15]
    v_lshlrev_b32 v184, 16, v92
    v_and_b32 v185, 0xffff0000, v92
    v_lshlrev_b32 v186, 16, v93
    v_and_b32 v187, 0xffff0000, v93
    v_mul_f32_dpp v188, v233, v184 row_newbcast:0 row_mask:0xf bank_mask:0xf
    v_mul_f32_dpp v189, v233, v185 row_newbcast:1 row_mask:0xf bank_mask:0xf
    v_mul_f32_dpp v190, v233, v184 row_newbcast:8 row_mask:0xf bank_mask:0xf
    v_mul_f32_dpp v191, v233, v185 row_newbcast:9 row_mask:0xf bank_mask:0xf
    v_mfma_f32_32x32x16_bf16 v[16:31], v[84:87], v[176:179], v[16:31]
    s_add_u32 m0, s25, 4096
    s_waitcnt vmcnt(4) lgkmcnt(0)
    buffer_load_dwordx4 v226, s[4:7], s32 offen lds
    buffer_load_dwordx4 v227, s[8:11], s32 offen offset:1024 lds
    ds_read_b64_tr_b16 v[176:177], v234 offset:6144
    ds_read_b64_tr_b16 v[178:179], v234 offset:7168
    v_lshlrev_b32 v184, 16, v94
    v_and_b32 v185, 0xffff0000, v94
    v_cvt_pk_bf16_f32 v88, v188, v189
    v_cvt_pk_bf16_f32 v92, v190, v191
    v_mul_f32_dpp v188, v233, v186 row_newbcast:2 row_mask:0xf bank_mask:0xf
    v_mul_f32_dpp v189, v233, v187 row_newbcast:3 row_mask:0xf bank_mask:0xf
    v_mul_f32_dpp v190, v233, v186 row_newbcast:10 row_mask:0xf bank_mask:0xf
    v_mul_f32_dpp v191, v233, v187 row_newbcast:11 row_mask:0xf bank_mask:0xf
    v_mfma_f32_32x32x16_bf16 v[32:47], v[80:83], v[180:183], v[32:47]
    v_lshlrev_b32 v186, 16, v95
    v_and_b32 v187, 0xffff0000, v95
    v_cvt_pk_bf16_f32 v89, v188, v189
    v_cvt_pk_bf16_f32 v93, v190, v191
    v_mul_f32_dpp v188, v233, v184 row_newbcast:4 row_mask:0xf bank_mask:0xf
    v_mul_f32_dpp v189, v233, v185 row_newbcast:5 row_mask:0xf bank_mask:0xf
    v_mul_f32_dpp v190, v233, v184 row_newbcast:12 row_mask:0xf bank_mask:0xf
    v_mul_f32_dpp v191, v233, v185 row_newbcast:13 row_mask:0xf bank_mask:0xf
    v_mfma_f32_32x32x16_bf16 v[48:63], v[84:87], v[180:183], v[48:63]
    ds_read_b64_tr_b16 v[180:181], v235 offset:6144
    ds_read_b64_tr_b16 v[182:183], v235 offset:7168
    v_cvt_pk_bf16_f32 v90, v188, v189
    v_cvt_pk_bf16_f32 v94, v190, v191
    v_mul_f32_dpp v188, v233, v186 row_newbcast:6 row_mask:0xf bank_mask:0xf
    v_mul_f32_dpp v189, v233, v187 row_newbcast:7 row_mask:0xf bank_mask:0xf
    v_mul_f32_dpp v190, v233, v186 row_newbcast:14 row_mask:0xf bank_mask:0xf
    v_mul_f32_dpp v191, v233, v187 row_newbcast:15 row_mask:0xf bank_mask:0xf
    v_cvt_pk_bf16_f32 v91, v188, v189
    v_cvt_pk_bf16_f32 v95, v190, v191
    s_nop 0
    s_waitcnt lgkmcnt(2)
    v_mfma_f32_32x32x16_bf16 v[0:15], v[88:91], v[176:179], v[0:15]
    v_mfma_f32_32x32x16_bf16 v[16:31], v[92:95], v[176:179], v[16:31]
    s_add_u32 m0, s25, 6144
    s_waitcnt vmcnt(4) lgkmcnt(0)
    buffer_load_dwordx4 v228, s[4:7], s32 offen lds
    buffer_load_dwordx4 v229, s[8:11], s32 offen offset:1024 lds
    ds_read_b64_tr_b16 v[176:177], v234 offset:0
    ds_read_b64_tr_b16 v[178:179], v234 offset:1024
    v_mfma_f32_32x32x16_bf16 v[32:47], v[88:91], v[180:183], v[32:47]
    v_mfma_f32_32x32x16_bf16 v[48:63], v[92:95], v[180:183], v[48:63]
    ds_read_b64_tr_b16 v[180:181], v235 offset:0
    ds_read_b64_tr_b16 v[182:183], v235 offset:1024
    s_nop 0
    v_mul_f32 v184, v0, v96
    v_fmac_f32 v184, v1, v97
    v_fmac_f32 v184, v2, v98
    v_fmac_f32 v184, v3, v99
    v_fmac_f32 v184, v4, v100
    v_fmac_f32 v184, v5, v101
    v_fmac_f32 v184, v6, v102
    v_fmac_f32 v184, v7, v103
    v_mul_f32 v186, v8, v128
    v_fmac_f32 v186, v9, v129
    v_fmac_f32 v186, v10, v130
    v_fmac_f32 v186, v11, v131
    v_fmac_f32 v186, v12, v132
    v_fmac_f32 v186, v13, v133
    v_fmac_f32 v186, v14, v134
    v_fmac_f32 v186, v15, v135
    s_waitcnt lgkmcnt(2)
    v_mfma_f32_32x32x16_bf16 v[0:15], v[64:67], v[176:179], 0
    v_mul_f32 v188, v16, v128
    v_fmac_f32 v188, v17, v129
    v_fmac_f32 v188, v18, v130
    v_fmac_f32 v188, v19, v131
    v_fmac_f32 v188, v20, v132
    v_fmac_f32 v188, v21, v133
    v_fmac_f32 v188, v22, v134
    v_fmac_f32 v188, v23, v135
    v_mul_f32 v190, v24, v128
    v_fmac_f32 v190, v25, v129
    v_fmac_f32 v190, v26, v130
    v_fmac_f32 v190, v27, v131
    v_fmac_f32 v190, v28, v132
    v_fmac_f32 v190, v29, v133
    v_fmac_f32 v190, v30, v134
    v_fmac_f32 v190, v31, v135
    v_mfma_f32_32x32x16_bf16 v[16:31], v[68:71], v[176:179], 0
    s_add_u32 m0, s25, 0
    s_waitcnt vmcnt(4) lgkmcnt(0)
    buffer_load_dwordx4 v222, s[4:7], s33 offen lds
    buffer_load_dwordx4 v223, s[8:11], s33 offen offset:1024 lds
    ds_read_b64_tr_b16 v[176:177], v234 offset:2048
    ds_read_b64_tr_b16 v[178:179], v234 offset:3072
    v_mul_f32 v185, v32, v104
    v_fmac_f32 v185, v33, v105
    v_fmac_f32 v185, v34, v106
    v_fmac_f32 v185, v35, v107
    v_fmac_f32 v185, v36, v108
    v_fmac_f32 v185, v37, v109
    v_fmac_f32 v185, v38, v110
    v_fmac_f32 v185, v39, v111
    v_mul_f32 v187, v40, v136
    v_fmac_f32 v187, v41, v137
    v_fmac_f32 v187, v42, v138
    v_fmac_f32 v187, v43, v139
    v_fmac_f32 v187, v44, v140
    v_fmac_f32 v187, v45, v141
    v_fmac_f32 v187, v46, v142
    v_fmac_f32 v187, v47, v143
    v_mfma_f32_32x32x16_bf16 v[32:47], v[64:67], v[180:183], 0
    v_mul_f32 v189, v48, v136
    v_fmac_f32 v189, v49, v137
    v_fmac_f32 v189, v50, v138
    v_fmac_f32 v189, v51, v139
    v_fmac_f32 v189, v52, v140
    v_fmac_f32 v189, v53, v141
    v_fmac_f32 v189, v54, v142
    v_fmac_f32 v189, v55, v143
    v_mul_f32 v191, v56, v136
    v_fmac_f32 v191, v57, v137
    v_fmac_f32 v191, v58, v138
    v_fmac_f32 v191, v59, v139
    v_fmac_f32 v191, v60, v140
    v_fmac_f32 v191, v61, v141
    v_fmac_f32 v191, v62, v142
    v_fmac_f32 v191, v63, v143
    v_mfma_f32_32x32x16_bf16 v[48:63], v[68:71], v[180:183], 0
    ds_read_b64_tr_b16 v[180:181], v235 offset:2048
    ds_read_b64_tr_b16 v[182:183], v235 offset:3072
    v_permlane32_swap_b32 v184, v186
    v_permlane32_swap_b32 v188, v190
    v_permlane32_swap_b32 v185, v187
    v_permlane32_swap_b32 v189, v191
    v_add_f32 v186, v184, v186
    v_add_f32 v190, v188, v190
    v_add_f32 v187, v185, v187
    v_add_f32 v191, v189, v191
    v_cvt_pk_bf16_f32 v186, v186, v187
    v_cvt_pk_bf16_f32 v190, v190, v191
    ds_write_b32 v243, v186 offset:0
    ds_write_b32 v243, v190 offset:256
    s_waitcnt lgkmcnt(4)
    v_mfma_f32_32x32x16_bf16 v[0:15], v[72:75], v[176:179], v[0:15]
    v_mfma_f32_32x32x16_bf16 v[16:31], v[76:79], v[176:179], v[16:31]
    s_add_u32 m0, s25, 2048
    s_waitcnt vmcnt(4) lgkmcnt(2)
    buffer_load_dwordx4 v224, s[4:7], s33 offen lds
    buffer_load_dwordx4 v225, s[8:11], s33 offen offset:1024 lds
    ds_read_b64_tr_b16 v[176:177], v234 offset:4096
    ds_read_b64_tr_b16 v[178:179], v234 offset:5120
    v_mfma_f32_32x32x16_bf16 v[32:47], v[72:75], v[180:183], v[32:47]
    v_mfma_f32_32x32x16_bf16 v[48:63], v[76:79], v[180:183], v[48:63]
    ds_read_b64_tr_b16 v[180:181], v235 offset:4096
    ds_read_b64_tr_b16 v[182:183], v235 offset:5120
    s_waitcnt lgkmcnt(2)
    v_mfma_f32_32x32x16_bf16 v[0:15], v[80:83], v[176:179], v[0:15]
    v_mfma_f32_32x32x16_bf16 v[16:31], v[84:87], v[176:179], v[16:31]
    s_add_u32 m0, s25, 4096
    s_waitcnt vmcnt(4) lgkmcnt(0)
    buffer_load_dwordx4 v226, s[4:7], s33 offen lds
    buffer_load_dwordx4 v227, s[8:11], s33 offen offset:1024 lds
    ds_read_b64_tr_b16 v[176:177], v234 offset:6144
    ds_read_b64_tr_b16 v[178:179], v234 offset:7168
    v_mfma_f32_32x32x16_bf16 v[32:47], v[80:83], v[180:183], v[32:47]
    v_mfma_f32_32x32x16_bf16 v[48:63], v[84:87], v[180:183], v[48:63]
    ds_read_b64_tr_b16 v[180:181], v235 offset:6144
    ds_read_b64_tr_b16 v[182:183], v235 offset:7168
    s_waitcnt lgkmcnt(2)
    v_mfma_f32_32x32x16_bf16 v[0:15], v[88:91], v[176:179], v[0:15]
    v_mfma_f32_32x32x16_bf16 v[16:31], v[92:95], v[176:179], v[16:31]
    s_add_u32 m0, s25, 6144
    s_waitcnt vmcnt(4) lgkmcnt(0)
    buffer_load_dwordx4 v228, s[4:7], s33 offen lds
    buffer_load_dwordx4 v229, s[8:11], s33 offen offset:1024 lds
    ds_read_b64_tr_b16 v[176:177], v234 offset:0
    ds_read_b64_tr_b16 v[178:179], v234 offset:1024
    v_mfma_f32_32x32x16_bf16 v[32:47], v[88:91], v[180:183], v[32:47]
    v_mfma_f32_32x32x16_bf16 v[48:63], v[92:95], v[180:183], v[48:63]
    ds_read_b64_tr_b16 v[180:181], v235 offset:0
    ds_read_b64_tr_b16 v[182:183], v235 offset:1024
    s_nop 0
    v_mul_f32 v184, v0, v144
    v_fmac_f32 v184, v1, v145
    v_fmac_f32 v184, v2, v146
    v_fmac_f32 v184, v3, v147
    v_fmac_f32 v184, v4, v148
    v_fmac_f32 v184, v5, v149
    v_fmac_f32 v184, v6, v150
    v_fmac_f32 v184, v7, v151
    v_mul_f32 v186, v8, v112
    v_fmac_f32 v186, v9, v113
    v_fmac_f32 v186, v10, v114
    v_fmac_f32 v186, v11, v115
    v_fmac_f32 v186, v12, v116
    v_fmac_f32 v186, v13, v117
    v_fmac_f32 v186, v14, v118
    v_fmac_f32 v186, v15, v119
    s_waitcnt lgkmcnt(2)
    v_mfma_f32_32x32x16_bf16 v[0:15], v[64:67], v[176:179], 0
    v_mul_f32_e64 v188, v16, -v160
    v_fma_f32 v188, v17, -v161, v188
    v_fma_f32 v188, v18, -v162, v188
    v_fma_f32 v188, v19, -v163, v188
    v_fma_f32 v188, v20, -v164, v188
    v_fma_f32 v188, v21, -v165, v188
    v_fma_f32 v188, v22, -v166, v188
    v_fma_f32 v188, v23, -v167, v188
    v_mul_f32 v190, v24, v160
    v_fmac_f32 v190, v25, v161
    v_fmac_f32 v190, v26, v162
    v_fmac_f32 v190, v27, v163
    v_fmac_f32 v190, v28, v164
    v_fmac_f32 v190, v29, v165
    v_fmac_f32 v190, v30, v166
    v_fmac_f32 v190, v31, v167
    v_mfma_f32_32x32x16_bf16 v[16:31], v[68:71], v[176:179], 0
    s_add_u32 m0, s25, 0
    s_waitcnt vmcnt(4) lgkmcnt(0)
    buffer_load_dwordx4 v222, s[4:7], s34 offen lds
    buffer_load_dwordx4 v223, s[8:11], s34 offen offset:1024 lds
    ds_read_b64_tr_b16 v[176:177], v234 offset:2048
    ds_read_b64_tr_b16 v[178:179], v234 offset:3072
    v_mul_f32 v185, v32, v152
    v_fmac_f32 v185, v33, v153
    v_fmac_f32 v185, v34, v154
    v_fmac_f32 v185, v35, v155
    v_fmac_f32 v185, v36, v156
    v_fmac_f32 v185, v37, v157
    v_fmac_f32 v185, v38, v158
    v_fmac_f32 v185, v39, v159
    v_mul_f32 v187, v40, v120
    v_fmac_f32 v187, v41, v121
    v_fmac_f32 v187, v42, v122
    v_fmac_f32 v187, v43, v123
    v_fmac_f32 v187, v44, v124
    v_fmac_f32 v187, v45, v125
    v_fmac_f32 v187, v46, v126
    v_fmac_f32 v187, v47, v127
    v_mfma_f32_32x32x16_bf16 v[32:47], v[64:67], v[180:183], 0
    v_add_u32 v244, s39, v239
    ds_read_u16 v222, v244
    ds_read_u16 v223, v244 offset:64
    v_mul_f32_e64 v189, v48, -v168
    v_fma_f32 v189, v49, -v169, v189
    v_fma_f32 v189, v50, -v170, v189
    v_fma_f32 v189, v51, -v171, v189
    v_fma_f32 v189, v52, -v172, v189
    v_fma_f32 v189, v53, -v173, v189
    v_fma_f32 v189, v54, -v174, v189
    v_fma_f32 v189, v55, -v175, v189
    v_mul_f32 v191, v56, v168
    v_fmac_f32 v191, v57, v169
    v_fmac_f32 v191, v58, v170
    v_fmac_f32 v191, v59, v171
    v_fmac_f32 v191, v60, v172
    v_fmac_f32 v191, v61, v173
    v_fmac_f32 v191, v62, v174
    v_fmac_f32 v191, v63, v175
    v_mfma_f32_32x32x16_bf16 v[48:63], v[68:71], v[180:183], 0
    ds_read_b64_tr_b16 v[180:181], v235 offset:2048
    ds_read_b64_tr_b16 v[182:183], v235 offset:3072
    s_waitcnt lgkmcnt(4)
    v_mfma_f32_32x32x16_bf16 v[0:15], v[72:75], v[176:179], v[0:15]
    v_mfma_f32_32x32x16_bf16 v[16:31], v[76:79], v[176:179], v[16:31]
    s_add_u32 m0, s25, 2048
    s_waitcnt vmcnt(4) lgkmcnt(0)
    buffer_load_dwordx4 v224, s[4:7], s34 offen lds
    buffer_load_dwordx4 v225, s[8:11], s34 offen offset:1024 lds
    ds_read_b64_tr_b16 v[176:177], v234 offset:4096
    ds_read_b64_tr_b16 v[178:179], v234 offset:5120
    v_mfma_f32_32x32x16_bf16 v[32:47], v[72:75], v[180:183], v[32:47]
    v_add_u32 v244, s40, v239
    ds_read_u16 v224, v244
    ds_read_u16 v225, v244 offset:64
    v_mfma_f32_32x32x16_bf16 v[48:63], v[76:79], v[180:183], v[48:63]
    ds_read_b64_tr_b16 v[180:181], v235 offset:4096
    ds_read_b64_tr_b16 v[182:183], v235 offset:5120
    s_waitcnt lgkmcnt(4)
    v_mfma_f32_32x32x16_bf16 v[0:15], v[80:83], v[176:179], v[0:15]
    v_mfma_f32_32x32x16_bf16 v[16:31], v[84:87], v[176:179], v[16:31]
    s_add_u32 m0, s25, 4096
    s_waitcnt vmcnt(4) lgkmcnt(0)
    buffer_load_dwordx4 v226, s[4:7], s34 offen lds
    buffer_load_dwordx4 v227, s[8:11], s34 offen offset:1024 lds
    ds_read_b64_tr_b16 v[176:177], v234 offset:6144
    ds_read_b64_tr_b16 v[178:179], v234 offset:7168
    v_mfma_f32_32x32x16_bf16 v[32:47], v[80:83], v[180:183], v[32:47]
    v_add_u32 v244, s41, v239
    ds_read_u16 v226, v244
    ds_read_u16 v227, v244 offset:64
    v_mfma_f32_32x32x16_bf16 v[48:63], v[84:87], v[180:183], v[48:63]
    ds_read_b64_tr_b16 v[180:181], v235 offset:6144
    ds_read_b64_tr_b16 v[182:183], v235 offset:7168
    s_waitcnt lgkmcnt(4)
    v_mfma_f32_32x32x16_bf16 v[0:15], v[88:91], v[176:179], v[0:15]
    v_mfma_f32_32x32x16_bf16 v[16:31], v[92:95], v[176:179], v[16:31]
    s_add_u32 m0, s25, 6144
    s_waitcnt vmcnt(4) lgkmcnt(0)
    buffer_load_dwordx4 v228, s[4:7], s34 offen lds
    buffer_load_dwordx4 v229, s[8:11], s34 offen offset:1024 lds
    ds_read_b64_tr_b16 v[176:177], v234 offset:0
    ds_read_b64_tr_b16 v[178:179], v234 offset:1024
    v_mfma_f32_32x32x16_bf16 v[32:47], v[88:91], v[180:183], v[32:47]
    v_add_u32 v244, s42, v239
    ds_read_u16 v228, v244
    ds_read_u16 v229, v244 offset:64
    v_mfma_f32_32x32x16_bf16 v[48:63], v[92:95], v[180:183], v[48:63]
    ds_read_b64_tr_b16 v[180:181], v235 offset:0
    ds_read_b64_tr_b16 v[182:183], v235 offset:1024
    v_mul_f32 v246, v0, v144
    v_fmac_f32 v246, v1, v145
    v_fmac_f32 v246, v2, v146
    v_fmac_f32 v246, v3, v147
    v_fmac_f32 v246, v4, v148
    v_fmac_f32 v246, v5, v149
    v_fmac_f32 v246, v6, v150
    v_fmac_f32 v246, v7, v151
    v_fmac_f32 v188, v8, v160
    v_fmac_f32 v188, v9, v161
    v_fmac_f32 v188, v10, v162
    v_fmac_f32 v188, v11, v163
    v_fmac_f32 v188, v12, v164
    v_fmac_f32 v188, v13, v165
    v_fmac_f32 v188, v14, v166
    v_fmac_f32 v188, v15, v167
    s_waitcnt lgkmcnt(4)
    v_mfma_f32_32x32x16_bf16 v[0:15], v[64:67], v[176:179], 0
    v_permlane32_swap_b32 v184, v246
    v_fmac_f32 v186, v16, v112
    v_fmac_f32 v186, v17, v113
    v_fmac_f32 v186, v18, v114
    v_fmac_f32 v186, v19, v115
    v_fmac_f32 v186, v20, v116
    v_fmac_f32 v186, v21, v117
    v_fmac_f32 v186, v22, v118
    v_fmac_f32 v186, v23, v119
    v_add_f32 v246, v184, v246
    v_mul_f32_e64 v184, v24, -v160
    v_fma_f32 v184, v25, -v161, v184
    v_fma_f32 v184, v26, -v162, v184
    v_fma_f32 v184, v27, -v163, v184
    v_fma_f32 v184, v28, -v164, v184
    v_fma_f32 v184, v29, -v165, v184
    v_fma_f32 v184, v30, -v166, v184
    v_fma_f32 v184, v31, -v167, v184
    v_mfma_f32_32x32x16_bf16 v[16:31], v[68:71], v[176:179], 0
    v_lshl_add_u32 v222, v222, 10, v236
    v_lshl_add_u32 v223, v223, 10, v236
    s_add_u32 m0, s25, 0
    s_waitcnt vmcnt(4) lgkmcnt(0)
    buffer_load_dwordx4 v222, s[4:7], s35 offen lds
    buffer_load_dwordx4 v223, s[8:11], s35 offen offset:1024 lds
    ds_read_b64_tr_b16 v[176:177], v234 offset:2048
    ds_read_b64_tr_b16 v[178:179], v234 offset:3072
    v_mul_f32 v247, v32, v152
    v_fmac_f32 v247, v33, v153
    v_fmac_f32 v247, v34, v154
    v_fmac_f32 v247, v35, v155
    v_fmac_f32 v247, v36, v156
    v_fmac_f32 v247, v37, v157
    v_fmac_f32 v247, v38, v158
    v_fmac_f32 v247, v39, v159
    v_fmac_f32 v189, v40, v168
    v_fmac_f32 v189, v41, v169
    v_fmac_f32 v189, v42, v170
    v_fmac_f32 v189, v43, v171
    v_fmac_f32 v189, v44, v172
    v_fmac_f32 v189, v45, v173
    v_fmac_f32 v189, v46, v174
    v_fmac_f32 v189, v47, v175
    v_mfma_f32_32x32x16_bf16 v[32:47], v[64:67], v[180:183], 0
    v_permlane32_swap_b32 v185, v247
    v_fmac_f32 v187, v48, v120
    v_fmac_f32 v187, v49, v121
    v_fmac_f32 v187, v50, v122
    v_fmac_f32 v187, v51, v123
    v_fmac_f32 v187, v52, v124
    v_fmac_f32 v187, v53, v125
    v_fmac_f32 v187, v54, v126
    v_fmac_f32 v187, v55, v127
    v_add_f32 v247, v185, v247
    v_mul_f32_e64 v185, v56, -v168
    v_fma_f32 v185, v57, -v169, v185
    v_fma_f32 v185, v58, -v170, v185
    v_fma_f32 v185, v59, -v171, v185
    v_fma_f32 v185, v60, -v172, v185
    v_fma_f32 v185, v61, -v173, v185
    v_fma_f32 v185, v62, -v174, v185
    v_fma_f32 v185, v63, -v175, v185
    v_mfma_f32_32x32x16_bf16 v[48:63], v[68:71], v[180:183], 0
    ds_read_b64_tr_b16 v[180:181], v235 offset:2048
    ds_read_b64_tr_b16 v[182:183], v235 offset:3072
    v_cvt_pk_bf16_f32 v246, v246, v247
    ds_write_b32 v243, v246 offset:512
    s_waitcnt lgkmcnt(3)
    v_mfma_f32_32x32x16_bf16 v[0:15], v[72:75], v[176:179], v[0:15]
    v_mfma_f32_32x32x16_bf16 v[16:31], v[76:79], v[176:179], v[16:31]
    v_lshl_add_u32 v224, v224, 10, v236
    v_lshl_add_u32 v225, v225, 10, v236
    s_add_u32 m0, s25, 2048
    s_waitcnt vmcnt(4) lgkmcnt(1)
    buffer_load_dwordx4 v224, s[4:7], s36 offen lds
    buffer_load_dwordx4 v225, s[8:11], s36 offen offset:1024 lds
    ds_read_b64_tr_b16 v[176:177], v234 offset:4096
    ds_read_b64_tr_b16 v[178:179], v234 offset:5120
    v_mfma_f32_32x32x16_bf16 v[32:47], v[72:75], v[180:183], v[32:47]
    v_mfma_f32_32x32x16_bf16 v[48:63], v[76:79], v[180:183], v[48:63]
    ds_read_b64_tr_b16 v[180:181], v235 offset:4096
    ds_read_b64_tr_b16 v[182:183], v235 offset:5120
    s_waitcnt lgkmcnt(2)
    v_mfma_f32_32x32x16_bf16 v[0:15], v[80:83], v[176:179], v[0:15]
    v_mfma_f32_32x32x16_bf16 v[16:31], v[84:87], v[176:179], v[16:31]
    v_lshl_add_u32 v226, v226, 10, v236
    v_lshl_add_u32 v227, v227, 10, v236
    s_add_u32 m0, s25, 4096
    s_waitcnt vmcnt(4) lgkmcnt(0)
    buffer_load_dwordx4 v226, s[4:7], s37 offen lds
    buffer_load_dwordx4 v227, s[8:11], s37 offen offset:1024 lds
    ds_read_b64_tr_b16 v[176:177], v234 offset:6144
    ds_read_b64_tr_b16 v[178:179], v234 offset:7168
    v_mfma_f32_32x32x16_bf16 v[32:47], v[80:83], v[180:183], v[32:47]
    v_mfma_f32_32x32x16_bf16 v[48:63], v[84:87], v[180:183], v[48:63]
    ds_read_b64_tr_b16 v[180:181], v235 offset:6144
    ds_read_b64_tr_b16 v[182:183], v235 offset:7168
    s_waitcnt lgkmcnt(2)
    v_mfma_f32_32x32x16_bf16 v[0:15], v[88:91], v[176:179], v[0:15]
    v_mfma_f32_32x32x16_bf16 v[16:31], v[92:95], v[176:179], v[16:31]
    v_lshl_add_u32 v228, v228, 10, v236
    v_lshl_add_u32 v229, v229, 10, v236
    s_add_u32 m0, s25, 6144
    s_waitcnt vmcnt(4) lgkmcnt(0)
    buffer_load_dwordx4 v228, s[4:7], s38 offen lds
    buffer_load_dwordx4 v229, s[8:11], s38 offen offset:1024 lds
    ds_read_b64_tr_b16 v[176:177], v234 offset:0
    ds_read_b64_tr_b16 v[178:179], v234 offset:1024
    v_mfma_f32_32x32x16_bf16 v[32:47], v[88:91], v[180:183], v[32:47]
    v_mfma_f32_32x32x16_bf16 v[48:63], v[92:95], v[180:183], v[48:63]
    ds_read_b64_tr_b16 v[180:181], v235 offset:0
    ds_read_b64_tr_b16 v[182:183], v235 offset:1024
    v_add_u32 v241, s45, v237
    v_add_u32 v242, s39, v238
    ds_read_b32 v252, v251 offset:16
    ds_read_b64_tr_b16 v[68:69], v241 offset:0
    ds_read_b64_tr_b16 v[70:71], v241 offset:256
    s_mov_b64 exec, s[50:51]
    ds_read_u16_d16_hi v230, v242 offset:0
    s_mov_b64 exec, -1
    v_mul_f32 v246, v0, v144
    v_fmac_f32 v246, v1, v145
    v_fmac_f32 v246, v2, v146
    v_fmac_f32 v246, v3, v147
    v_fmac_f32 v246, v4, v148
    v_fmac_f32 v246, v5, v149
    v_fmac_f32 v246, v6, v150
    v_fmac_f32 v246, v7, v151
    v_fma_f32 v190, v8, -v160, v190
    v_fma_f32 v190, v9, -v161, v190
    v_fma_f32 v190, v10, -v162, v190
    v_fma_f32 v190, v11, -v163, v190
    v_fma_f32 v190, v12, -v164, v190
    v_fma_f32 v190, v13, -v165, v190
    v_fma_f32 v190, v14, -v166, v190
    v_fma_f32 v190, v15, -v167, v190
    v_fmac_f32 v184, v16, v160
    v_fmac_f32 v184, v17, v161
    v_fmac_f32 v184, v18, v162
    v_fmac_f32 v184, v19, v163
    v_fmac_f32 v184, v20, v164
    v_fmac_f32 v184, v21, v165
    v_fmac_f32 v184, v22, v166
    v_fmac_f32 v184, v23, v167
    v_fmac_f32 v186, v24, v112
    v_fmac_f32 v186, v25, v113
    v_fmac_f32 v186, v26, v114
    v_fmac_f32 v186, v27, v115
    v_fmac_f32 v186, v28, v116
    v_fmac_f32 v186, v29, v117
    v_fmac_f32 v186, v30, v118
    v_fmac_f32 v186, v31, v119
    v_mul_f32 v247, v32, v152
    v_fmac_f32 v247, v33, v153
    v_fmac_f32 v247, v34, v154
    v_fmac_f32 v247, v35, v155
    v_fmac_f32 v247, v36, v156
    v_fmac_f32 v247, v37, v157
    v_fmac_f32 v247, v38, v158
    v_fmac_f32 v247, v39, v159
    v_fma_f32 v191, v40, -v168, v191
    v_fma_f32 v191, v41, -v169, v191
    v_fma_f32 v191, v42, -v170, v191
    v_fma_f32 v191, v43, -v171, v191
    v_fma_f32 v191, v44, -v172, v191
    v_fma_f32 v191, v45, -v173, v191
    v_fma_f32 v191, v46, -v174, v191
    v_fma_f32 v191, v47, -v175, v191
    v_fmac_f32 v185, v48, v168
    v_fmac_f32 v185, v49, v169
    v_fmac_f32 v185, v50, v170
    v_fmac_f32 v185, v51, v171
    v_fmac_f32 v185, v52, v172
    v_fmac_f32 v185, v53, v173
    v_fmac_f32 v185, v54, v174
    v_fmac_f32 v185, v55, v175
    v_fmac_f32 v187, v56, v120
    v_fmac_f32 v187, v57, v121
    v_fmac_f32 v187, v58, v122
    v_fmac_f32 v187, v59, v123
    v_fmac_f32 v187, v60, v124
    v_fmac_f32 v187, v61, v125
    v_fmac_f32 v187, v62, v126
    v_fmac_f32 v187, v63, v127
    s_nop 0
    v_permlane32_swap_b32 v246, v188
    v_permlane32_swap_b32 v190, v244
    v_permlane32_swap_b32 v186, v184
    v_permlane32_swap_b32 v247, v189
    v_permlane32_swap_b32 v191, v245
    v_permlane32_swap_b32 v187, v185
    v_add_f32 v188, v246, v188
    v_add_f32 v244, v190, v244
    v_add_f32 v184, v186, v184
    v_add_f32 v189, v247, v189
    v_add_f32 v245, v191, v245
    v_add_f32 v185, v187, v185
    v_cvt_pk_bf16_f32 v188, v188, v189
    v_cvt_pk_bf16_f32 v244, v244, v245
    v_cvt_pk_bf16_f32 v184, v184, v185
    ds_write_b32 v243, v188 offset:768
    ds_write_b32 v243, v244 offset:1280
    ds_write_b32 v243, v184 offset:1024
    s_branch NEXT_1
.p2align 6
ITEM_1_2:
    v_add_u32 v244, s39, v239
    ds_read_u16 v222, v244
    ds_read_u16 v223, v244 offset:64
    v_add_u32 v244, s40, v239
    ds_read_u16 v224, v244
    ds_read_u16 v225, v244 offset:64
    v_add_u32 v244, s41, v239
    ds_read_u16 v226, v244
    ds_read_u16 v227, v244 offset:64
    v_add_u32 v244, s42, v239
    ds_read_u16 v228, v244
    ds_read_u16 v229, v244 offset:64
    v_xor_b32 v243, s65, v240
    v_add_u32 v243, s46, v243
    s_waitcnt lgkmcnt(8)
    v_lshlrev_b32 v184, 16, v68
    v_and_b32 v185, 0xffff0000, v68
    v_lshlrev_b32 v186, 16, v69
    v_and_b32 v187, 0xffff0000, v69
    v_mul_f32_dpp v188, v230, v184 row_newbcast:0 row_mask:0xf bank_mask:0xf
    v_mul_f32_dpp v189, v230, v185 row_newbcast:1 row_mask:0xf bank_mask:0xf
    v_mul_f32_dpp v190, v230, v184 row_newbcast:8 row_mask:0xf bank_mask:0xf
    v_mul_f32_dpp v191, v230, v185 row_newbcast:9 row_mask:0xf bank_mask:0xf
    v_lshlrev_b32 v184, 16, v70
    v_and_b32 v185, 0xffff0000, v70
    v_cvt_pk_bf16_f32 v64, v188, v189
    v_cvt_pk_bf16_f32 v68, v190, v191
    v_mul_f32_dpp v188, v230, v186 row_newbcast:2 row_mask:0xf bank_mask:0xf
    v_mul_f32_dpp v189, v230, v187 row_newbcast:3 row_mask:0xf bank_mask:0xf
    v_mul_f32_dpp v190, v230, v186 row_newbcast:10 row_mask:0xf bank_mask:0xf
    v_mul_f32_dpp v191, v230, v187 row_newbcast:11 row_mask:0xf bank_mask:0xf
    v_lshlrev_b32 v186, 16, v71
    v_and_b32 v187, 0xffff0000, v71
    v_cvt_pk_bf16_f32 v65, v188, v189
    v_cvt_pk_bf16_f32 v69, v190, v191
    v_mul_f32_dpp v188, v230, v184 row_newbcast:4 row_mask:0xf bank_mask:0xf
    v_mul_f32_dpp v189, v230, v185 row_newbcast:5 row_mask:0xf bank_mask:0xf
    v_mul_f32_dpp v190, v230, v184 row_newbcast:12 row_mask:0xf bank_mask:0xf
    v_mul_f32_dpp v191, v230, v185 row_newbcast:13 row_mask:0xf bank_mask:0xf
    v_cvt_pk_bf16_f32 v66, v188, v189
    v_cvt_pk_bf16_f32 v70, v190, v191
    v_mul_f32_dpp v188, v230, v186 row_newbcast:6 row_mask:0xf bank_mask:0xf
    v_mul_f32_dpp v189, v230, v187 row_newbcast:7 row_mask:0xf bank_mask:0xf
    v_mul_f32_dpp v190, v230, v186 row_newbcast:14 row_mask:0xf bank_mask:0xf
    v_mul_f32_dpp v191, v230, v187 row_newbcast:15 row_mask:0xf bank_mask:0xf
    v_cvt_pk_bf16_f32 v67, v188, v189
    v_cvt_pk_bf16_f32 v71, v190, v191
    s_nop 0
    v_mfma_f32_32x32x16_bf16 v[0:15], v[64:67], v[176:179], 0
    v_mfma_f32_32x32x16_bf16 v[16:31], v[68:71], v[176:179], 0
    s_waitcnt lgkmcnt(6)
    v_lshl_add_u32 v222, v222, 10, v236
    v_lshl_add_u32 v223, v223, 10, v236
    s_add_u32 m0, s25, 0
    s_waitcnt vmcnt(4)
    buffer_load_dwordx4 v222, s[4:7], s35 offen lds
    buffer_load_dwordx4 v223, s[8:11], s35 offen offset:1024 lds
    ds_read_b64_tr_b16 v[176:177], v234 offset:2048
    ds_read_b64_tr_b16 v[178:179], v234 offset:3072
    v_mfma_f32_32x32x16_bf16 v[32:47], v[64:67], v[180:183], 0
    v_mfma_f32_32x32x16_bf16 v[48:63], v[68:71], v[180:183], 0
    ds_read_b64_tr_b16 v[180:181], v235 offset:2048
    ds_read_b64_tr_b16 v[182:183], v235 offset:3072
    v_mul_f32 v184, v0, v96
    v_fmac_f32 v184, v1, v97
    v_fmac_f32 v184, v2, v98
    v_fmac_f32 v184, v3, v99
    v_fmac_f32 v184, v4, v100
    v_fmac_f32 v184, v5, v101
    v_fmac_f32 v184, v6, v102
    v_fmac_f32 v184, v7, v103
    v_mul_f32 v186, v8, v128
    v_fmac_f32 v186, v9, v129
    v_fmac_f32 v186, v10, v130
    v_fmac_f32 v186, v11, v131
    v_fmac_f32 v186, v12, v132
    v_fmac_f32 v186, v13, v133
    v_fmac_f32 v186, v14, v134
    v_fmac_f32 v186, v15, v135
    s_waitcnt lgkmcnt(2)
    v_mfma_f32_32x32x16_bf16 v[0:15], v[64:67], v[176:179], 0
    v_mul_f32 v188, v16, v128
    v_fmac_f32 v188, v17, v129
    v_fmac_f32 v188, v18, v130
    v_fmac_f32 v188, v19, v131
    v_fmac_f32 v188, v20, v132
    v_fmac_f32 v188, v21, v133
    v_fmac_f32 v188, v22, v134
    v_fmac_f32 v188, v23, v135
    v_mul_f32 v190, v24, v128
    v_fmac_f32 v190, v25, v129
    v_fmac_f32 v190, v26, v130
    v_fmac_f32 v190, v27, v131
    v_fmac_f32 v190, v28, v132
    v_fmac_f32 v190, v29, v133
    v_fmac_f32 v190, v30, v134
    v_fmac_f32 v190, v31, v135
    v_mfma_f32_32x32x16_bf16 v[16:31], v[68:71], v[176:179], 0
    v_lshl_add_u32 v224, v224, 10, v236
    v_lshl_add_u32 v225, v225, 10, v236
    s_add_u32 m0, s25, 2048
    s_waitcnt vmcnt(4) lgkmcnt(0)
    buffer_load_dwordx4 v224, s[4:7], s36 offen lds
    buffer_load_dwordx4 v225, s[8:11], s36 offen offset:1024 lds
    ds_read_b64_tr_b16 v[176:177], v234 offset:4096
    ds_read_b64_tr_b16 v[178:179], v234 offset:5120
    v_mul_f32 v185, v32, v104
    v_fmac_f32 v185, v33, v105
    v_fmac_f32 v185, v34, v106
    v_fmac_f32 v185, v35, v107
    v_fmac_f32 v185, v36, v108
    v_fmac_f32 v185, v37, v109
    v_fmac_f32 v185, v38, v110
    v_fmac_f32 v185, v39, v111
    v_mul_f32 v187, v40, v136
    v_fmac_f32 v187, v41, v137
    v_fmac_f32 v187, v42, v138
    v_fmac_f32 v187, v43, v139
    v_fmac_f32 v187, v44, v140
    v_fmac_f32 v187, v45, v141
    v_fmac_f32 v187, v46, v142
    v_fmac_f32 v187, v47, v143
    v_mfma_f32_32x32x16_bf16 v[32:47], v[64:67], v[180:183], 0
    v_mul_f32 v189, v48, v136
    v_fmac_f32 v189, v49, v137
    v_fmac_f32 v189, v50, v138
    v_fmac_f32 v189, v51, v139
    v_fmac_f32 v189, v52, v140
    v_fmac_f32 v189, v53, v141
    v_fmac_f32 v189, v54, v142
    v_fmac_f32 v189, v55, v143
    v_mul_f32 v191, v56, v136
    v_fmac_f32 v191, v57, v137
    v_fmac_f32 v191, v58, v138
    v_fmac_f32 v191, v59, v139
    v_fmac_f32 v191, v60, v140
    v_fmac_f32 v191, v61, v141
    v_fmac_f32 v191, v62, v142
    v_fmac_f32 v191, v63, v143
    v_mfma_f32_32x32x16_bf16 v[48:63], v[68:71], v[180:183], 0
    ds_read_b64_tr_b16 v[180:181], v235 offset:4096
    ds_read_b64_tr_b16 v[182:183], v235 offset:5120
    v_permlane32_swap_b32 v184, v186
    v_permlane32_swap_b32 v188, v190
    v_permlane32_swap_b32 v185, v187
    v_permlane32_swap_b32 v189, v191
    v_add_f32 v186, v184, v186
    v_add_f32 v190, v188, v190
    v_add_f32 v187, v185, v187
    v_add_f32 v191, v189, v191
    v_cvt_pk_bf16_f32 v186, v186, v187
    v_cvt_pk_bf16_f32 v190, v190, v191
    ds_write_b32 v243, v186 offset:0
    ds_write_b32 v243, v190 offset:256
    v_mul_f32 v184, v0, v144
    v_fmac_f32 v184, v1, v145
    v_fmac_f32 v184, v2, v146
    v_fmac_f32 v184, v3, v147
    v_fmac_f32 v184, v4, v148
    v_fmac_f32 v184, v5, v149
    v_fmac_f32 v184, v6, v150
    v_fmac_f32 v184, v7, v151
    v_mul_f32 v186, v8, v112
    v_fmac_f32 v186, v9, v113
    v_fmac_f32 v186, v10, v114
    v_fmac_f32 v186, v11, v115
    v_fmac_f32 v186, v12, v116
    v_fmac_f32 v186, v13, v117
    v_fmac_f32 v186, v14, v118
    v_fmac_f32 v186, v15, v119
    s_waitcnt lgkmcnt(4)
    v_mfma_f32_32x32x16_bf16 v[0:15], v[64:67], v[176:179], 0
    v_mul_f32_e64 v188, v16, -v160
    v_fma_f32 v188, v17, -v161, v188
    v_fma_f32 v188, v18, -v162, v188
    v_fma_f32 v188, v19, -v163, v188
    v_fma_f32 v188, v20, -v164, v188
    v_fma_f32 v188, v21, -v165, v188
    v_fma_f32 v188, v22, -v166, v188
    v_fma_f32 v188, v23, -v167, v188
    v_mul_f32 v190, v24, v160
    v_fmac_f32 v190, v25, v161
    v_fmac_f32 v190, v26, v162
    v_fmac_f32 v190, v27, v163
    v_fmac_f32 v190, v28, v164
    v_fmac_f32 v190, v29, v165
    v_fmac_f32 v190, v30, v166
    v_fmac_f32 v190, v31, v167
    v_mfma_f32_32x32x16_bf16 v[16:31], v[68:71], v[176:179], 0
    v_lshl_add_u32 v226, v226, 10, v236
    v_lshl_add_u32 v227, v227, 10, v236
    s_add_u32 m0, s25, 4096
    s_waitcnt vmcnt(4) lgkmcnt(2)
    buffer_load_dwordx4 v226, s[4:7], s37 offen lds
    buffer_load_dwordx4 v227, s[8:11], s37 offen offset:1024 lds
    ds_read_b64_tr_b16 v[176:177], v234 offset:6144
    ds_read_b64_tr_b16 v[178:179], v234 offset:7168
    v_mul_f32 v185, v32, v152
    v_fmac_f32 v185, v33, v153
    v_fmac_f32 v185, v34, v154
    v_fmac_f32 v185, v35, v155
    v_fmac_f32 v185, v36, v156
    v_fmac_f32 v185, v37, v157
    v_fmac_f32 v185, v38, v158
    v_fmac_f32 v185, v39, v159
    v_mul_f32 v187, v40, v120
    v_fmac_f32 v187, v41, v121
    v_fmac_f32 v187, v42, v122
    v_fmac_f32 v187, v43, v123
    v_fmac_f32 v187, v44, v124
    v_fmac_f32 v187, v45, v125
    v_fmac_f32 v187, v46, v126
    v_fmac_f32 v187, v47, v127
    v_mfma_f32_32x32x16_bf16 v[32:47], v[64:67], v[180:183], 0
    v_mul_f32_e64 v189, v48, -v168
    v_fma_f32 v189, v49, -v169, v189
    v_fma_f32 v189, v50, -v170, v189
    v_fma_f32 v189, v51, -v171, v189
    v_fma_f32 v189, v52, -v172, v189
    v_fma_f32 v189, v53, -v173, v189
    v_fma_f32 v189, v54, -v174, v189
    v_fma_f32 v189, v55, -v175, v189
    v_mul_f32 v191, v56, v168
    v_fmac_f32 v191, v57, v169
    v_fmac_f32 v191, v58, v170
    v_fmac_f32 v191, v59, v171
    v_fmac_f32 v191, v60, v172
    v_fmac_f32 v191, v61, v173
    v_fmac_f32 v191, v62, v174
    v_fmac_f32 v191, v63, v175
    v_mfma_f32_32x32x16_bf16 v[48:63], v[68:71], v[180:183], 0
    ds_read_b64_tr_b16 v[180:181], v235 offset:6144
    ds_read_b64_tr_b16 v[182:183], v235 offset:7168
    v_mul_f32 v246, v0, v144
    v_fmac_f32 v246, v1, v145
    v_fmac_f32 v246, v2, v146
    v_fmac_f32 v246, v3, v147
    v_fmac_f32 v246, v4, v148
    v_fmac_f32 v246, v5, v149
    v_fmac_f32 v246, v6, v150
    v_fmac_f32 v246, v7, v151
    v_fmac_f32 v188, v8, v160
    v_fmac_f32 v188, v9, v161
    v_fmac_f32 v188, v10, v162
    v_fmac_f32 v188, v11, v163
    v_fmac_f32 v188, v12, v164
    v_fmac_f32 v188, v13, v165
    v_fmac_f32 v188, v14, v166
    v_fmac_f32 v188, v15, v167
    s_waitcnt lgkmcnt(2)
    v_mfma_f32_32x32x16_bf16 v[0:15], v[64:67], v[176:179], 0
    v_permlane32_swap_b32 v184, v246
    v_fmac_f32 v186, v16, v112
    v_fmac_f32 v186, v17, v113
    v_fmac_f32 v186, v18, v114
    v_fmac_f32 v186, v19, v115
    v_fmac_f32 v186, v20, v116
    v_fmac_f32 v186, v21, v117
    v_fmac_f32 v186, v22, v118
    v_fmac_f32 v186, v23, v119
    v_add_f32 v246, v184, v246
    v_mul_f32_e64 v184, v24, -v160
    v_fma_f32 v184, v25, -v161, v184
    v_fma_f32 v184, v26, -v162, v184
    v_fma_f32 v184, v27, -v163, v184
    v_fma_f32 v184, v28, -v164, v184
    v_fma_f32 v184, v29, -v165, v184
    v_fma_f32 v184, v30, -v166, v184
    v_fma_f32 v184, v31, -v167, v184
    v_mfma_f32_32x32x16_bf16 v[16:31], v[68:71], v[176:179], 0
    v_lshl_add_u32 v228, v228, 10, v236
    v_lshl_add_u32 v229, v229, 10, v236
    s_add_u32 m0, s25, 6144
    s_waitcnt vmcnt(4) lgkmcnt(0)
    buffer_load_dwordx4 v228, s[4:7], s38 offen lds
    buffer_load_dwordx4 v229, s[8:11], s38 offen offset:1024 lds
    ds_read_b64_tr_b16 v[176:177], v234 offset:0
    ds_read_b64_tr_b16 v[178:179], v234 offset:1024
    v_mul_f32 v247, v32, v152
    v_fmac_f32 v247, v33, v153
    v_fmac_f32 v247, v34, v154
    v_fmac_f32 v247, v35, v155
    v_fmac_f32 v247, v36, v156
    v_fmac_f32 v247, v37, v157
    v_fmac_f32 v247, v38, v158
    v_fmac_f32 v247, v39, v159
    v_fmac_f32 v189, v40, v168
    v_fmac_f32 v189, v41, v169
    v_fmac_f32 v189, v42, v170
    v_fmac_f32 v189, v43, v171
    v_fmac_f32 v189, v44, v172
    v_fmac_f32 v189, v45, v173
    v_fmac_f32 v189, v46, v174
    v_fmac_f32 v189, v47, v175
    v_mfma_f32_32x32x16_bf16 v[32:47], v[64:67], v[180:183], 0
    v_permlane32_swap_b32 v185, v247
    v_fmac_f32 v187, v48, v120
    v_fmac_f32 v187, v49, v121
    v_fmac_f32 v187, v50, v122
    v_fmac_f32 v187, v51, v123
    v_fmac_f32 v187, v52, v124
    v_fmac_f32 v187, v53, v125
    v_fmac_f32 v187, v54, v126
    v_fmac_f32 v187, v55, v127
    v_add_f32 v247, v185, v247
    v_mul_f32_e64 v185, v56, -v168
    v_fma_f32 v185, v57, -v169, v185
    v_fma_f32 v185, v58, -v170, v185
    v_fma_f32 v185, v59, -v171, v185
    v_fma_f32 v185, v60, -v172, v185
    v_fma_f32 v185, v61, -v173, v185
    v_fma_f32 v185, v62, -v174, v185
    v_fma_f32 v185, v63, -v175, v185
    v_mfma_f32_32x32x16_bf16 v[48:63], v[68:71], v[180:183], 0
    ds_read_b64_tr_b16 v[180:181], v235 offset:0
    ds_read_b64_tr_b16 v[182:183], v235 offset:1024
    v_cvt_pk_bf16_f32 v246, v246, v247
    ds_write_b32 v243, v246 offset:512
    v_add_u32 v241, s45, v237
    v_add_u32 v242, s39, v238
    ds_read_b32 v252, v251 offset:16
    ds_read_b64_tr_b16 v[68:69], v241 offset:0
    ds_read_b64_tr_b16 v[70:71], v241 offset:256
    s_mov_b64 exec, s[50:51]
    ds_read_u16_d16_hi v230, v242 offset:0
    s_mov_b64 exec, -1
    v_mul_f32 v246, v0, v144
    v_fmac_f32 v246, v1, v145
    v_fmac_f32 v246, v2, v146
    v_fmac_f32 v246, v3, v147
    v_fmac_f32 v246, v4, v148
    v_fmac_f32 v246, v5, v149
    v_fmac_f32 v246, v6, v150
    v_fmac_f32 v246, v7, v151
    v_fma_f32 v190, v8, -v160, v190
    v_fma_f32 v190, v9, -v161, v190
    v_fma_f32 v190, v10, -v162, v190
    v_fma_f32 v190, v11, -v163, v190
    v_fma_f32 v190, v12, -v164, v190
    v_fma_f32 v190, v13, -v165, v190
    v_fma_f32 v190, v14, -v166, v190
    v_fma_f32 v190, v15, -v167, v190
    v_fmac_f32 v184, v16, v160
    v_fmac_f32 v184, v17, v161
    v_fmac_f32 v184, v18, v162
    v_fmac_f32 v184, v19, v163
    v_fmac_f32 v184, v20, v164
    v_fmac_f32 v184, v21, v165
    v_fmac_f32 v184, v22, v166
    v_fmac_f32 v184, v23, v167
    v_fmac_f32 v186, v24, v112
    v_fmac_f32 v186, v25, v113
    v_fmac_f32 v186, v26, v114
    v_fmac_f32 v186, v27, v115
    v_fmac_f32 v186, v28, v116
    v_fmac_f32 v186, v29, v117
    v_fmac_f32 v186, v30, v118
    v_fmac_f32 v186, v31, v119
    v_mul_f32 v247, v32, v152
    v_fmac_f32 v247, v33, v153
    v_fmac_f32 v247, v34, v154
    v_fmac_f32 v247, v35, v155
    v_fmac_f32 v247, v36, v156
    v_fmac_f32 v247, v37, v157
    v_fmac_f32 v247, v38, v158
    v_fmac_f32 v247, v39, v159
    v_fma_f32 v191, v40, -v168, v191
    v_fma_f32 v191, v41, -v169, v191
    v_fma_f32 v191, v42, -v170, v191
    v_fma_f32 v191, v43, -v171, v191
    v_fma_f32 v191, v44, -v172, v191
    v_fma_f32 v191, v45, -v173, v191
    v_fma_f32 v191, v46, -v174, v191
    v_fma_f32 v191, v47, -v175, v191
    v_fmac_f32 v185, v48, v168
    v_fmac_f32 v185, v49, v169
    v_fmac_f32 v185, v50, v170
    v_fmac_f32 v185, v51, v171
    v_fmac_f32 v185, v52, v172
    v_fmac_f32 v185, v53, v173
    v_fmac_f32 v185, v54, v174
    v_fmac_f32 v185, v55, v175
    v_fmac_f32 v187, v56, v120
    v_fmac_f32 v187, v57, v121
    v_fmac_f32 v187, v58, v122
    v_fmac_f32 v187, v59, v123
    v_fmac_f32 v187, v60, v124
    v_fmac_f32 v187, v61, v125
    v_fmac_f32 v187, v62, v126
    v_fmac_f32 v187, v63, v127
    s_nop 0
    v_permlane32_swap_b32 v246, v188
    v_permlane32_swap_b32 v190, v244
    v_permlane32_swap_b32 v186, v184
    v_permlane32_swap_b32 v247, v189
    v_permlane32_swap_b32 v191, v245
    v_permlane32_swap_b32 v187, v185
    v_add_f32 v188, v246, v188
    v_add_f32 v244, v190, v244
    v_add_f32 v184, v186, v184
    v_add_f32 v189, v247, v189
    v_add_f32 v245, v191, v245
    v_add_f32 v185, v187, v185
    v_cvt_pk_bf16_f32 v188, v188, v189
    v_cvt_pk_bf16_f32 v244, v244, v245
    v_cvt_pk_bf16_f32 v184, v184, v185
    ds_write_b32 v243, v188 offset:768
    ds_write_b32 v243, v244 offset:1280
    ds_write_b32 v243, v184 offset:1024
    s_branch NEXT_1
.p2align 6
TAIL:
    s_setprio 0
    s_waitcnt vmcnt(0) lgkmcnt(0)
    v_lshlrev_b32 v244, 4, v250
    s_mul_i32 s58, s24, 20480
    s_add_u32 s58, s58, 12288000
    buffer_load_dwordx4 v[96:99], v244, s[16:19], s58 offen offset:0
    buffer_load_dwordx4 v[100:103], v244, s[16:19], s58 offen offset:1024
    buffer_load_dwordx4 v[104:107], v244, s[16:19], s58 offen offset:2048
    buffer_load_dwordx4 v[108:111], v244, s[16:19], s58 offen offset:3072
    s_add_u32 s58, s58, 4096
    buffer_load_dwordx4 v[112:115], v244, s[16:19], s58 offen offset:0
    buffer_load_dwordx4 v[116:119], v244, s[16:19], s58 offen offset:1024
    buffer_load_dwordx4 v[120:123], v244, s[16:19], s58 offen offset:2048
    buffer_load_dwordx4 v[124:127], v244, s[16:19], s58 offen offset:3072
    s_add_u32 s58, s58, 4096
    buffer_load_dwordx4 v[128:131], v244, s[16:19], s58 offen offset:0
    buffer_load_dwordx4 v[132:135], v244, s[16:19], s58 offen offset:1024
    buffer_load_dwordx4 v[136:139], v244, s[16:19], s58 offen offset:2048
    buffer_load_dwordx4 v[140:143], v244, s[16:19], s58 offen offset:3072
    s_add_u32 s58, s58, 4096
    buffer_load_dwordx4 v[144:147], v244, s[16:19], s58 offen offset:0
    buffer_load_dwordx4 v[148:151], v244, s[16:19], s58 offen offset:1024
    buffer_load_dwordx4 v[152:155], v244, s[16:19], s58 offen offset:2048
    buffer_load_dwordx4 v[156:159], v244, s[16:19], s58 offen offset:3072
    s_add_u32 s58, s58, 4096
    buffer_load_dwordx4 v[160:163], v244, s[16:19], s58 offen offset:0
    buffer_load_dwordx4 v[164:167], v244, s[16:19], s58 offen offset:1024
    buffer_load_dwordx4 v[168:171], v244, s[16:19], s58 offen offset:2048
    buffer_load_dwordx4 v[172:175], v244, s[16:19], s58 offen offset:3072
    s_add_u32 s58, s58, 4096
    s_bfe_u32 s59, s26, 0x40015
    s_lshl_b32 s59, s59, 4
    s_add_u32 s60, s25, 0
    v_xor_b32 v243, s59, v240
    v_add_u32 v243, s60, v243
    ds_write_b32 v243, v192 offset:0
    ds_write_b32 v243, v193 offset:256
    ds_write_b32 v243, v194 offset:512
    ds_write_b32 v243, v195 offset:768
    ds_write_b32 v243, v196 offset:1024
    ds_write_b32 v243, v197 offset:1280
    s_bfe_u32 s59, s27, 0x40015
    s_lshl_b32 s59, s59, 4
    s_add_u32 s60, s25, 1536
    v_xor_b32 v243, s59, v240
    v_add_u32 v243, s60, v243
    ds_write_b32 v243, v198 offset:0
    ds_write_b32 v243, v199 offset:256
    ds_write_b32 v243, v200 offset:512
    ds_write_b32 v243, v201 offset:768
    ds_write_b32 v243, v202 offset:1024
    ds_write_b32 v243, v203 offset:1280
    s_bfe_u32 s59, s28, 0x40015
    s_lshl_b32 s59, s59, 4
    s_add_u32 s60, s25, 3072
    v_xor_b32 v243, s59, v240
    v_add_u32 v243, s60, v243
    ds_write_b32 v243, v204 offset:0
    ds_write_b32 v243, v205 offset:256
    ds_write_b32 v243, v206 offset:512
    ds_write_b32 v243, v207 offset:768
    ds_write_b32 v243, v208 offset:1024
    ds_write_b32 v243, v209 offset:1280
    s_bfe_u32 s59, s29, 0x40015
    s_lshl_b32 s59, s59, 4
    s_add_u32 s60, s25, 4608
    v_xor_b32 v243, s59, v240
    v_add_u32 v243, s60, v243
    ds_write_b32 v243, v210 offset:0
    ds_write_b32 v243, v211 offset:256
    ds_write_b32 v243, v212 offset:512
    ds_write_b32 v243, v213 offset:768
    ds_write_b32 v243, v214 offset:1024
    ds_write_b32 v243, v215 offset:1280
    s_bfe_u32 s59, s30, 0x40015
    s_lshl_b32 s59, s59, 4
    s_add_u32 s60, s25, 6144
    v_xor_b32 v243, s59, v240
    v_add_u32 v243, s60, v243
    ds_write_b32 v243, v216 offset:0
    ds_write_b32 v243, v217 offset:256
    ds_write_b32 v243, v218 offset:512
    ds_write_b32 v243, v219 offset:768
    ds_write_b32 v243, v220 offset:1024
    ds_write_b32 v243, v221 offset:1280
GEMM:
    v_and_b32 v179, 15, v250
    v_lshrrev_b32 v180, 4, v250
    v_lshlrev_b32 v182, 3, v179
    v_add_u32 v182, 86528, v182
    v_min_u32 v183, 86584, v182
    ds_read_b64 v[184:185], v182
    ds_read_b64 v[186:187], v182 offset:128
    ds_read_b64 v[188:189], v183 offset:256
    v_min_u32 v178, 7, v179
    s_waitcnt lgkmcnt(0)
    v_bfe_u32 v177, v184, 7, 1
    v_lshlrev_b32 v177, 3, v177
    v_xor_b32 v177, v177, v179
    v_xor_b32 v177, v177, v180
    v_xor_b32 v176, 0, v177
    v_lshl_add_u32 v48, v176, 4, v184
    v_xor_b32 v176, 4, v177
    v_lshl_add_u32 v49, v176, 4, v184
    v_xor_b32 v176, 8, v177
    v_lshl_add_u32 v50, v176, 4, v184
    v_xor_b32 v176, 12, v177
    v_lshl_add_u32 v51, v176, 4, v184
    v_bfe_u32 v177, v185, 7, 1
    v_lshlrev_b32 v177, 3, v177
    v_xor_b32 v177, v177, v179
    v_xor_b32 v177, v177, v180
    v_xor_b32 v176, 0, v177
    v_lshl_add_u32 v52, v176, 4, v185
    v_xor_b32 v176, 4, v177
    v_lshl_add_u32 v53, v176, 4, v185
    v_xor_b32 v176, 8, v177
    v_lshl_add_u32 v54, v176, 4, v185
    v_xor_b32 v176, 12, v177
    v_lshl_add_u32 v55, v176, 4, v185
    v_bfe_u32 v177, v186, 7, 1
    v_lshlrev_b32 v177, 3, v177
    v_xor_b32 v177, v177, v179
    v_xor_b32 v177, v177, v180
    v_xor_b32 v176, 0, v177
    v_lshl_add_u32 v56, v176, 4, v186
    v_xor_b32 v176, 4, v177
    v_lshl_add_u32 v57, v176, 4, v186
    v_xor_b32 v176, 8, v177
    v_lshl_add_u32 v58, v176, 4, v186
    v_xor_b32 v176, 12, v177
    v_lshl_add_u32 v59, v176, 4, v186
    v_bfe_u32 v177, v187, 7, 1
    v_lshlrev_b32 v177, 3, v177
    v_xor_b32 v177, v177, v179
    v_xor_b32 v177, v177, v180
    v_xor_b32 v176, 0, v177
    v_lshl_add_u32 v60, v176, 4, v187
    v_xor_b32 v176, 4, v177
    v_lshl_add_u32 v61, v176, 4, v187
    v_xor_b32 v176, 8, v177
    v_lshl_add_u32 v62, v176, 4, v187
    v_xor_b32 v176, 12, v177
    v_lshl_add_u32 v63, v176, 4, v187
    v_bfe_u32 v177, v188, 7, 1
    v_lshlrev_b32 v177, 3, v177
    v_xor_b32 v177, v177, v178
    v_xor_b32 v177, v177, v180
    v_xor_b32 v176, 0, v177
    v_lshl_add_u32 v64, v176, 4, v188
    v_xor_b32 v176, 4, v177
    v_lshl_add_u32 v65, v176, 4, v188
    v_xor_b32 v176, 8, v177
    v_lshl_add_u32 v66, v176, 4, v188
    v_xor_b32 v176, 12, v177
    v_lshl_add_u32 v67, v176, 4, v188
    v_bfe_u32 v177, v189, 7, 1
    v_lshlrev_b32 v177, 3, v177
    v_xor_b32 v177, v177, v178
    v_xor_b32 v177, v177, v180
    v_xor_b32 v176, 0, v177
    v_lshl_add_u32 v68, v176, 4, v189
    v_xor_b32 v176, 4, v177
    v_lshl_add_u32 v69, v176, 4, v189
    v_xor_b32 v176, 8, v177
    v_lshl_add_u32 v70, v176, 4, v189
    v_xor_b32 v176, 12, v177
    v_lshl_add_u32 v71, v176, 4, v189
    s_barrier
    ds_read_b128 v[72:75], v48 offset:0
    ds_read_b128 v[76:79], v56 offset:0
    ds_read_b128 v[80:83], v64 offset:0
    ds_read_b128 v[84:87], v49 offset:0
    ds_read_b128 v[88:91], v57 offset:0
    ds_read_b128 v[92:95], v65 offset:0
    s_waitcnt vmcnt(19) lgkmcnt(5)
    v_mfma_f32_16x16x32_bf16 v[0:3], v[96:99], v[72:75], 0
    ds_read_b128 v[72:75], v52 offset:0
    s_waitcnt lgkmcnt(5)
    v_mfma_f32_16x16x32_bf16 v[4:7], v[96:99], v[76:79], 0
    ds_read_b128 v[76:79], v60 offset:0
    s_waitcnt lgkmcnt(5)
    v_mfma_f32_16x16x32_bf16 v[8:11], v[96:99], v[80:83], 0
    ds_read_b128 v[80:83], v68 offset:0
    s_waitcnt vmcnt(18) lgkmcnt(5)
    v_mfma_f32_16x16x32_bf16 v[0:3], v[100:103], v[84:87], v[0:3]
    ds_read_b128 v[84:87], v53 offset:0
    s_waitcnt lgkmcnt(5)
    v_mfma_f32_16x16x32_bf16 v[4:7], v[100:103], v[88:91], v[4:7]
    ds_read_b128 v[88:91], v61 offset:0
    s_waitcnt lgkmcnt(5)
    v_mfma_f32_16x16x32_bf16 v[8:11], v[100:103], v[92:95], v[8:11]
    ds_read_b128 v[92:95], v69 offset:0
    s_waitcnt vmcnt(17) lgkmcnt(5)
    v_mfma_f32_16x16x32_bf16 v[0:3], v[104:107], v[72:75], v[0:3]
    ds_read_b128 v[72:75], v48 offset:1024
    s_waitcnt lgkmcnt(5)
    v_mfma_f32_16x16x32_bf16 v[4:7], v[104:107], v[76:79], v[4:7]
    ds_read_b128 v[76:79], v56 offset:1024
    s_waitcnt lgkmcnt(5)
    v_mfma_f32_16x16x32_bf16 v[8:11], v[104:107], v[80:83], v[8:11]
    ds_read_b128 v[80:83], v64 offset:1024
    s_waitcnt vmcnt(16) lgkmcnt(5)
    v_mfma_f32_16x16x32_bf16 v[0:3], v[108:111], v[84:87], v[0:3]
    ds_read_b128 v[84:87], v49 offset:1024
    s_waitcnt lgkmcnt(5)
    v_mfma_f32_16x16x32_bf16 v[4:7], v[108:111], v[88:91], v[4:7]
    ds_read_b128 v[88:91], v57 offset:1024
    s_waitcnt lgkmcnt(5)
    v_mfma_f32_16x16x32_bf16 v[8:11], v[108:111], v[92:95], v[8:11]
    ds_read_b128 v[92:95], v65 offset:1024
    s_waitcnt vmcnt(15) lgkmcnt(5)
    v_mfma_f32_16x16x32_bf16 v[0:3], v[112:115], v[72:75], v[0:3]
    ds_read_b128 v[72:75], v52 offset:1024
    s_waitcnt lgkmcnt(5)
    v_mfma_f32_16x16x32_bf16 v[4:7], v[112:115], v[76:79], v[4:7]
    ds_read_b128 v[76:79], v60 offset:1024
    s_waitcnt lgkmcnt(5)
    v_mfma_f32_16x16x32_bf16 v[8:11], v[112:115], v[80:83], v[8:11]
    ds_read_b128 v[80:83], v68 offset:1024
    s_waitcnt vmcnt(14) lgkmcnt(5)
    v_mfma_f32_16x16x32_bf16 v[0:3], v[116:119], v[84:87], v[0:3]
    ds_read_b128 v[84:87], v53 offset:1024
    s_waitcnt lgkmcnt(5)
    v_mfma_f32_16x16x32_bf16 v[4:7], v[116:119], v[88:91], v[4:7]
    ds_read_b128 v[88:91], v61 offset:1024
    s_waitcnt lgkmcnt(5)
    v_mfma_f32_16x16x32_bf16 v[8:11], v[116:119], v[92:95], v[8:11]
    ds_read_b128 v[92:95], v69 offset:1024
    s_waitcnt vmcnt(13) lgkmcnt(5)
    v_mfma_f32_16x16x32_bf16 v[0:3], v[120:123], v[72:75], v[0:3]
    ds_read_b128 v[72:75], v50 offset:0
    s_waitcnt lgkmcnt(5)
    v_mfma_f32_16x16x32_bf16 v[4:7], v[120:123], v[76:79], v[4:7]
    ds_read_b128 v[76:79], v58 offset:0
    s_waitcnt lgkmcnt(5)
    v_mfma_f32_16x16x32_bf16 v[8:11], v[120:123], v[80:83], v[8:11]
    ds_read_b128 v[80:83], v66 offset:0
    s_waitcnt vmcnt(12) lgkmcnt(5)
    v_mfma_f32_16x16x32_bf16 v[0:3], v[124:127], v[84:87], v[0:3]
    ds_read_b128 v[84:87], v48 offset:256
    s_waitcnt lgkmcnt(5)
    v_mfma_f32_16x16x32_bf16 v[4:7], v[124:127], v[88:91], v[4:7]
    ds_read_b128 v[88:91], v56 offset:256
    s_waitcnt lgkmcnt(5)
    v_mfma_f32_16x16x32_bf16 v[8:11], v[124:127], v[92:95], v[8:11]
    ds_read_b128 v[92:95], v64 offset:256
    s_waitcnt vmcnt(11) lgkmcnt(5)
    v_mfma_f32_16x16x32_bf16 v[12:15], v[128:131], v[72:75], 0
    ds_read_b128 v[72:75], v50 offset:256
    s_waitcnt lgkmcnt(5)
    v_mfma_f32_16x16x32_bf16 v[16:19], v[128:131], v[76:79], 0
    ds_read_b128 v[76:79], v58 offset:256
    s_waitcnt lgkmcnt(5)
    v_mfma_f32_16x16x32_bf16 v[20:23], v[128:131], v[80:83], 0
    ds_read_b128 v[80:83], v66 offset:256
    s_waitcnt lgkmcnt(5)
    v_mfma_f32_16x16x32_bf16 v[24:27], v[128:131], v[84:87], 0
    ds_read_b128 v[84:87], v51 offset:0
    s_waitcnt lgkmcnt(5)
    v_mfma_f32_16x16x32_bf16 v[28:31], v[128:131], v[88:91], 0
    ds_read_b128 v[88:91], v59 offset:0
    s_waitcnt lgkmcnt(5)
    v_mfma_f32_16x16x32_bf16 v[32:35], v[128:131], v[92:95], 0
    ds_read_b128 v[92:95], v67 offset:0
    s_waitcnt lgkmcnt(5)
    v_mfma_f32_16x16x32_bf16 v[36:39], v[128:131], v[72:75], 0
    ds_read_b128 v[72:75], v49 offset:256
    s_waitcnt lgkmcnt(5)
    v_mfma_f32_16x16x32_bf16 v[40:43], v[128:131], v[76:79], 0
    ds_read_b128 v[76:79], v57 offset:256
    s_waitcnt lgkmcnt(5)
    v_mfma_f32_16x16x32_bf16 v[44:47], v[128:131], v[80:83], 0
    ds_read_b128 v[80:83], v65 offset:256
    s_waitcnt vmcnt(10) lgkmcnt(5)
    v_mfma_f32_16x16x32_bf16 v[12:15], v[132:135], v[84:87], v[12:15]
    ds_read_b128 v[84:87], v51 offset:256
    s_waitcnt lgkmcnt(5)
    v_mfma_f32_16x16x32_bf16 v[16:19], v[132:135], v[88:91], v[16:19]
    ds_read_b128 v[88:91], v59 offset:256
    s_waitcnt lgkmcnt(5)
    v_mfma_f32_16x16x32_bf16 v[20:23], v[132:135], v[92:95], v[20:23]
    ds_read_b128 v[92:95], v67 offset:256
    s_waitcnt lgkmcnt(5)
    v_mfma_f32_16x16x32_bf16 v[24:27], v[132:135], v[72:75], v[24:27]
    ds_read_b128 v[72:75], v54 offset:0
    s_waitcnt lgkmcnt(5)
    v_mfma_f32_16x16x32_bf16 v[28:31], v[132:135], v[76:79], v[28:31]
    ds_read_b128 v[76:79], v62 offset:0
    s_waitcnt lgkmcnt(5)
    v_mfma_f32_16x16x32_bf16 v[32:35], v[132:135], v[80:83], v[32:35]
    ds_read_b128 v[80:83], v70 offset:0
    s_waitcnt lgkmcnt(5)
    v_mfma_f32_16x16x32_bf16 v[36:39], v[132:135], v[84:87], v[36:39]
    ds_read_b128 v[84:87], v52 offset:256
    s_waitcnt lgkmcnt(5)
    v_mfma_f32_16x16x32_bf16 v[40:43], v[132:135], v[88:91], v[40:43]
    ds_read_b128 v[88:91], v60 offset:256
    s_waitcnt lgkmcnt(5)
    v_mfma_f32_16x16x32_bf16 v[44:47], v[132:135], v[92:95], v[44:47]
    ds_read_b128 v[92:95], v68 offset:256
    s_waitcnt vmcnt(9) lgkmcnt(5)
    v_mfma_f32_16x16x32_bf16 v[12:15], v[136:139], v[72:75], v[12:15]
    ds_read_b128 v[72:75], v54 offset:256
    s_waitcnt lgkmcnt(5)
    v_mfma_f32_16x16x32_bf16 v[16:19], v[136:139], v[76:79], v[16:19]
    ds_read_b128 v[76:79], v62 offset:256
    s_waitcnt lgkmcnt(5)
    v_mfma_f32_16x16x32_bf16 v[20:23], v[136:139], v[80:83], v[20:23]
    ds_read_b128 v[80:83], v70 offset:256
    s_waitcnt lgkmcnt(5)
    v_mfma_f32_16x16x32_bf16 v[24:27], v[136:139], v[84:87], v[24:27]
    ds_read_b128 v[84:87], v55 offset:0
    s_waitcnt lgkmcnt(5)
    v_mfma_f32_16x16x32_bf16 v[28:31], v[136:139], v[88:91], v[28:31]
    ds_read_b128 v[88:91], v63 offset:0
    s_waitcnt lgkmcnt(5)
    v_mfma_f32_16x16x32_bf16 v[32:35], v[136:139], v[92:95], v[32:35]
    ds_read_b128 v[92:95], v71 offset:0
    s_waitcnt lgkmcnt(5)
    v_mfma_f32_16x16x32_bf16 v[36:39], v[136:139], v[72:75], v[36:39]
    ds_read_b128 v[72:75], v53 offset:256
    s_waitcnt lgkmcnt(5)
    v_mfma_f32_16x16x32_bf16 v[40:43], v[136:139], v[76:79], v[40:43]
    ds_read_b128 v[76:79], v61 offset:256
    s_waitcnt lgkmcnt(5)
    v_mfma_f32_16x16x32_bf16 v[44:47], v[136:139], v[80:83], v[44:47]
    ds_read_b128 v[80:83], v69 offset:256
    s_waitcnt vmcnt(8) lgkmcnt(5)
    v_mfma_f32_16x16x32_bf16 v[12:15], v[140:143], v[84:87], v[12:15]
    ds_read_b128 v[84:87], v55 offset:256
    s_waitcnt lgkmcnt(5)
    v_mfma_f32_16x16x32_bf16 v[16:19], v[140:143], v[88:91], v[16:19]
    ds_read_b128 v[88:91], v63 offset:256
    s_waitcnt lgkmcnt(5)
    v_mfma_f32_16x16x32_bf16 v[20:23], v[140:143], v[92:95], v[20:23]
    ds_read_b128 v[92:95], v71 offset:256
    s_waitcnt lgkmcnt(5)
    v_mfma_f32_16x16x32_bf16 v[24:27], v[140:143], v[72:75], v[24:27]
    ds_read_b128 v[72:75], v48 offset:512
    s_waitcnt lgkmcnt(5)
    v_mfma_f32_16x16x32_bf16 v[28:31], v[140:143], v[76:79], v[28:31]
    ds_read_b128 v[76:79], v56 offset:512
    s_waitcnt lgkmcnt(5)
    v_mfma_f32_16x16x32_bf16 v[32:35], v[140:143], v[80:83], v[32:35]
    ds_read_b128 v[80:83], v64 offset:512
    s_waitcnt lgkmcnt(5)
    v_mfma_f32_16x16x32_bf16 v[36:39], v[140:143], v[84:87], v[36:39]
    ds_read_b128 v[84:87], v50 offset:512
    s_waitcnt lgkmcnt(5)
    v_mfma_f32_16x16x32_bf16 v[40:43], v[140:143], v[88:91], v[40:43]
    ds_read_b128 v[88:91], v58 offset:512
    s_waitcnt lgkmcnt(5)
    v_mfma_f32_16x16x32_bf16 v[44:47], v[140:143], v[92:95], v[44:47]
    ds_read_b128 v[92:95], v66 offset:512
    s_waitcnt vmcnt(7) lgkmcnt(5)
    v_mfma_f32_16x16x32_bf16 v[12:15], v[144:147], v[72:75], v[12:15]
    ds_read_b128 v[72:75], v48 offset:768
    s_waitcnt lgkmcnt(5)
    v_mfma_f32_16x16x32_bf16 v[16:19], v[144:147], v[76:79], v[16:19]
    ds_read_b128 v[76:79], v56 offset:768
    s_waitcnt lgkmcnt(5)
    v_mfma_f32_16x16x32_bf16 v[20:23], v[144:147], v[80:83], v[20:23]
    ds_read_b128 v[80:83], v64 offset:768
    s_waitcnt lgkmcnt(5)
    v_mfma_f32_16x16x32_bf16 v[24:27], v[144:147], v[84:87], v[24:27]
    ds_read_b128 v[84:87], v49 offset:512
    s_waitcnt lgkmcnt(5)
    v_mfma_f32_16x16x32_bf16 v[28:31], v[144:147], v[88:91], v[28:31]
    ds_read_b128 v[88:91], v57 offset:512
    s_waitcnt lgkmcnt(5)
    v_mfma_f32_16x16x32_bf16 v[32:35], v[144:147], v[92:95], v[32:35]
    ds_read_b128 v[92:95], v65 offset:512
    s_waitcnt lgkmcnt(5)
    v_mfma_f32_16x16x32_bf16 v[36:39], v[144:147], v[72:75], v[36:39]
    ds_read_b128 v[72:75], v51 offset:512
    s_waitcnt lgkmcnt(5)
    v_mfma_f32_16x16x32_bf16 v[40:43], v[144:147], v[76:79], v[40:43]
    ds_read_b128 v[76:79], v59 offset:512
    s_waitcnt lgkmcnt(5)
    v_mfma_f32_16x16x32_bf16 v[44:47], v[144:147], v[80:83], v[44:47]
    ds_read_b128 v[80:83], v67 offset:512
    s_waitcnt vmcnt(6) lgkmcnt(5)
    v_mfma_f32_16x16x32_bf16 v[12:15], v[148:151], v[84:87], v[12:15]
    ds_read_b128 v[84:87], v49 offset:768
    s_waitcnt lgkmcnt(5)
    v_mfma_f32_16x16x32_bf16 v[16:19], v[148:151], v[88:91], v[16:19]
    ds_read_b128 v[88:91], v57 offset:768
    s_waitcnt lgkmcnt(5)
    v_mfma_f32_16x16x32_bf16 v[20:23], v[148:151], v[92:95], v[20:23]
    ds_read_b128 v[92:95], v65 offset:768
    s_waitcnt lgkmcnt(5)
    v_mfma_f32_16x16x32_bf16 v[24:27], v[148:151], v[72:75], v[24:27]
    ds_read_b128 v[72:75], v52 offset:512
    s_waitcnt lgkmcnt(5)
    v_mfma_f32_16x16x32_bf16 v[28:31], v[148:151], v[76:79], v[28:31]
    ds_read_b128 v[76:79], v60 offset:512
    s_waitcnt lgkmcnt(5)
    v_mfma_f32_16x16x32_bf16 v[32:35], v[148:151], v[80:83], v[32:35]
    ds_read_b128 v[80:83], v68 offset:512
    s_waitcnt lgkmcnt(5)
    v_mfma_f32_16x16x32_bf16 v[36:39], v[148:151], v[84:87], v[36:39]
    ds_read_b128 v[84:87], v54 offset:512
    s_waitcnt lgkmcnt(5)
    v_mfma_f32_16x16x32_bf16 v[40:43], v[148:151], v[88:91], v[40:43]
    ds_read_b128 v[88:91], v62 offset:512
    s_waitcnt lgkmcnt(5)
    v_mfma_f32_16x16x32_bf16 v[44:47], v[148:151], v[92:95], v[44:47]
    ds_read_b128 v[92:95], v70 offset:512
    s_waitcnt vmcnt(5) lgkmcnt(5)
    v_mfma_f32_16x16x32_bf16 v[12:15], v[152:155], v[72:75], v[12:15]
    ds_read_b128 v[72:75], v52 offset:768
    s_waitcnt lgkmcnt(5)
    v_mfma_f32_16x16x32_bf16 v[16:19], v[152:155], v[76:79], v[16:19]
    ds_read_b128 v[76:79], v60 offset:768
    s_waitcnt lgkmcnt(5)
    v_mfma_f32_16x16x32_bf16 v[20:23], v[152:155], v[80:83], v[20:23]
    ds_read_b128 v[80:83], v68 offset:768
    s_waitcnt lgkmcnt(5)
    v_mfma_f32_16x16x32_bf16 v[24:27], v[152:155], v[84:87], v[24:27]
    ds_read_b128 v[84:87], v53 offset:512
    s_waitcnt lgkmcnt(5)
    v_mfma_f32_16x16x32_bf16 v[28:31], v[152:155], v[88:91], v[28:31]
    ds_read_b128 v[88:91], v61 offset:512
    s_waitcnt lgkmcnt(5)
    v_mfma_f32_16x16x32_bf16 v[32:35], v[152:155], v[92:95], v[32:35]
    ds_read_b128 v[92:95], v69 offset:512
    s_waitcnt lgkmcnt(5)
    v_mfma_f32_16x16x32_bf16 v[36:39], v[152:155], v[72:75], v[36:39]
    ds_read_b128 v[72:75], v55 offset:512
    s_waitcnt lgkmcnt(5)
    v_mfma_f32_16x16x32_bf16 v[40:43], v[152:155], v[76:79], v[40:43]
    ds_read_b128 v[76:79], v63 offset:512
    s_waitcnt lgkmcnt(5)
    v_mfma_f32_16x16x32_bf16 v[44:47], v[152:155], v[80:83], v[44:47]
    ds_read_b128 v[80:83], v71 offset:512
    s_waitcnt vmcnt(4) lgkmcnt(5)
    v_mfma_f32_16x16x32_bf16 v[12:15], v[156:159], v[84:87], v[12:15]
    ds_read_b128 v[84:87], v53 offset:768
    s_waitcnt lgkmcnt(5)
    v_mfma_f32_16x16x32_bf16 v[16:19], v[156:159], v[88:91], v[16:19]
    ds_read_b128 v[88:91], v61 offset:768
    s_waitcnt lgkmcnt(5)
    v_mfma_f32_16x16x32_bf16 v[20:23], v[156:159], v[92:95], v[20:23]
    ds_read_b128 v[92:95], v69 offset:768
    s_waitcnt lgkmcnt(5)
    v_mfma_f32_16x16x32_bf16 v[24:27], v[156:159], v[72:75], v[24:27]
    ds_read_b128 v[72:75], v50 offset:1024
    s_waitcnt lgkmcnt(5)
    v_mfma_f32_16x16x32_bf16 v[28:31], v[156:159], v[76:79], v[28:31]
    ds_read_b128 v[76:79], v58 offset:1024
    s_waitcnt lgkmcnt(5)
    v_mfma_f32_16x16x32_bf16 v[32:35], v[156:159], v[80:83], v[32:35]
    ds_read_b128 v[80:83], v66 offset:1024
    s_waitcnt lgkmcnt(5)
    v_mfma_f32_16x16x32_bf16 v[36:39], v[156:159], v[84:87], v[36:39]
    ds_read_b128 v[84:87], v48 offset:1280
    s_waitcnt lgkmcnt(5)
    v_mfma_f32_16x16x32_bf16 v[40:43], v[156:159], v[88:91], v[40:43]
    ds_read_b128 v[88:91], v56 offset:1280
    s_waitcnt lgkmcnt(5)
    v_mfma_f32_16x16x32_bf16 v[44:47], v[156:159], v[92:95], v[44:47]
    ds_read_b128 v[92:95], v64 offset:1280
    s_waitcnt vmcnt(3) lgkmcnt(5)
    v_mfma_f32_16x16x32_bf16 v[12:15], v[160:163], v[72:75], v[12:15]
    ds_read_b128 v[72:75], v50 offset:768
    s_waitcnt lgkmcnt(5)
    v_mfma_f32_16x16x32_bf16 v[16:19], v[160:163], v[76:79], v[16:19]
    ds_read_b128 v[76:79], v58 offset:768
    s_waitcnt lgkmcnt(5)
    v_mfma_f32_16x16x32_bf16 v[20:23], v[160:163], v[80:83], v[20:23]
    ds_read_b128 v[80:83], v66 offset:768
    s_waitcnt lgkmcnt(5)
    v_mfma_f32_16x16x32_bf16 v[24:27], v[160:163], v[84:87], v[24:27]
    ds_read_b128 v[84:87], v51 offset:1024
    s_waitcnt lgkmcnt(5)
    v_mfma_f32_16x16x32_bf16 v[28:31], v[160:163], v[88:91], v[28:31]
    ds_read_b128 v[88:91], v59 offset:1024
    s_waitcnt lgkmcnt(5)
    v_mfma_f32_16x16x32_bf16 v[32:35], v[160:163], v[92:95], v[32:35]
    ds_read_b128 v[92:95], v67 offset:1024
    s_waitcnt lgkmcnt(5)
    v_mfma_f32_16x16x32_bf16 v[36:39], v[160:163], v[72:75], v[36:39]
    ds_read_b128 v[72:75], v49 offset:1280
    s_waitcnt lgkmcnt(5)
    v_mfma_f32_16x16x32_bf16 v[40:43], v[160:163], v[76:79], v[40:43]
    ds_read_b128 v[76:79], v57 offset:1280
    s_waitcnt lgkmcnt(5)
    v_mfma_f32_16x16x32_bf16 v[44:47], v[160:163], v[80:83], v[44:47]
    ds_read_b128 v[80:83], v65 offset:1280
    s_waitcnt vmcnt(2) lgkmcnt(5)
    v_mfma_f32_16x16x32_bf16 v[12:15], v[164:167], v[84:87], v[12:15]
    ds_read_b128 v[84:87], v51 offset:768
    s_waitcnt lgkmcnt(5)
    v_mfma_f32_16x16x32_bf16 v[16:19], v[164:167], v[88:91], v[16:19]
    ds_read_b128 v[88:91], v59 offset:768
    s_waitcnt lgkmcnt(5)
    v_mfma_f32_16x16x32_bf16 v[20:23], v[164:167], v[92:95], v[20:23]
    ds_read_b128 v[92:95], v67 offset:768
    s_waitcnt lgkmcnt(5)
    v_mfma_f32_16x16x32_bf16 v[24:27], v[164:167], v[72:75], v[24:27]
    ds_read_b128 v[72:75], v54 offset:1024
    s_waitcnt lgkmcnt(5)
    v_mfma_f32_16x16x32_bf16 v[28:31], v[164:167], v[76:79], v[28:31]
    ds_read_b128 v[76:79], v62 offset:1024
    s_waitcnt lgkmcnt(5)
    v_mfma_f32_16x16x32_bf16 v[32:35], v[164:167], v[80:83], v[32:35]
    ds_read_b128 v[80:83], v70 offset:1024
    s_waitcnt lgkmcnt(5)
    v_mfma_f32_16x16x32_bf16 v[36:39], v[164:167], v[84:87], v[36:39]
    ds_read_b128 v[84:87], v52 offset:1280
    s_waitcnt lgkmcnt(5)
    v_mfma_f32_16x16x32_bf16 v[40:43], v[164:167], v[88:91], v[40:43]
    ds_read_b128 v[88:91], v60 offset:1280
    s_waitcnt lgkmcnt(5)
    v_mfma_f32_16x16x32_bf16 v[44:47], v[164:167], v[92:95], v[44:47]
    ds_read_b128 v[92:95], v68 offset:1280
    s_waitcnt vmcnt(1) lgkmcnt(5)
    v_mfma_f32_16x16x32_bf16 v[12:15], v[168:171], v[72:75], v[12:15]
    ds_read_b128 v[72:75], v54 offset:768
    s_waitcnt lgkmcnt(5)
    v_mfma_f32_16x16x32_bf16 v[16:19], v[168:171], v[76:79], v[16:19]
    ds_read_b128 v[76:79], v62 offset:768
    s_waitcnt lgkmcnt(5)
    v_mfma_f32_16x16x32_bf16 v[20:23], v[168:171], v[80:83], v[20:23]
    ds_read_b128 v[80:83], v70 offset:768
    s_waitcnt lgkmcnt(5)
    v_mfma_f32_16x16x32_bf16 v[24:27], v[168:171], v[84:87], v[24:27]
    ds_read_b128 v[84:87], v55 offset:1024
    s_waitcnt lgkmcnt(5)
    v_mfma_f32_16x16x32_bf16 v[28:31], v[168:171], v[88:91], v[28:31]
    ds_read_b128 v[88:91], v63 offset:1024
    s_waitcnt lgkmcnt(5)
    v_mfma_f32_16x16x32_bf16 v[32:35], v[168:171], v[92:95], v[32:35]
    ds_read_b128 v[92:95], v71 offset:1024
    s_waitcnt lgkmcnt(5)
    v_mfma_f32_16x16x32_bf16 v[36:39], v[168:171], v[72:75], v[36:39]
    ds_read_b128 v[72:75], v53 offset:1280
    s_waitcnt lgkmcnt(5)
    v_mfma_f32_16x16x32_bf16 v[40:43], v[168:171], v[76:79], v[40:43]
    ds_read_b128 v[76:79], v61 offset:1280
    s_waitcnt lgkmcnt(5)
    v_mfma_f32_16x16x32_bf16 v[44:47], v[168:171], v[80:83], v[44:47]
    ds_read_b128 v[80:83], v69 offset:1280
    s_waitcnt vmcnt(0) lgkmcnt(5)
    v_mfma_f32_16x16x32_bf16 v[12:15], v[172:175], v[84:87], v[12:15]
    ds_read_b128 v[84:87], v55 offset:768
    s_waitcnt lgkmcnt(5)
    v_mfma_f32_16x16x32_bf16 v[16:19], v[172:175], v[88:91], v[16:19]
    ds_read_b128 v[88:91], v63 offset:768
    s_waitcnt lgkmcnt(5)
    v_mfma_f32_16x16x32_bf16 v[20:23], v[172:175], v[92:95], v[20:23]
    ds_read_b128 v[92:95], v71 offset:768
    s_waitcnt lgkmcnt(5)
    v_mfma_f32_16x16x32_bf16 v[24:27], v[172:175], v[72:75], v[24:27]
    s_waitcnt lgkmcnt(4)
    v_mfma_f32_16x16x32_bf16 v[28:31], v[172:175], v[76:79], v[28:31]
    s_waitcnt lgkmcnt(3)
    v_mfma_f32_16x16x32_bf16 v[32:35], v[172:175], v[80:83], v[32:35]
    s_waitcnt lgkmcnt(2)
    v_mfma_f32_16x16x32_bf16 v[36:39], v[172:175], v[84:87], v[36:39]
    s_waitcnt lgkmcnt(1)
    v_mfma_f32_16x16x32_bf16 v[40:43], v[172:175], v[88:91], v[40:43]
    s_waitcnt lgkmcnt(0)
    v_mfma_f32_16x16x32_bf16 v[44:47], v[172:175], v[92:95], v[44:47]
    s_mov_b32 s58, 0xbfb8aa3b
    v_mul_f32 v72, s58, v0
    v_mul_f32 v73, s58, v1
    v_mul_f32 v74, s58, v2
    v_mul_f32 v75, s58, v3
    v_mul_f32 v76, s58, v4
    v_mul_f32 v77, s58, v5
    v_mul_f32 v78, s58, v6
    v_mul_f32 v79, s58, v7
    v_mul_f32 v80, s58, v8
    v_mul_f32 v81, s58, v9
    v_mul_f32 v82, s58, v10
    v_mul_f32 v83, s58, v11
    v_exp_f32 v72, v72
    v_exp_f32 v73, v73
    v_exp_f32 v74, v74
    v_exp_f32 v75, v75
    v_exp_f32 v76, v76
    v_exp_f32 v77, v77
    v_exp_f32 v78, v78
    v_exp_f32 v79, v79
    v_exp_f32 v80, v80
    v_exp_f32 v81, v81
    v_exp_f32 v82, v82
    v_exp_f32 v83, v83
    v_add_f32 v72, 1.0, v72
    v_add_f32 v73, 1.0, v73
    v_add_f32 v74, 1.0, v74
    v_add_f32 v75, 1.0, v75
    v_add_f32 v76, 1.0, v76
    v_add_f32 v77, 1.0, v77
    v_add_f32 v78, 1.0, v78
    v_add_f32 v79, 1.0, v79
    v_add_f32 v80, 1.0, v80
    v_add_f32 v81, 1.0, v81
    v_add_f32 v82, 1.0, v82
    v_add_f32 v83, 1.0, v83
    v_rcp_f32 v72, v72
    v_rcp_f32 v73, v73
    v_rcp_f32 v74, v74
    v_rcp_f32 v75, v75
    v_rcp_f32 v76, v76
    v_rcp_f32 v77, v77
    v_rcp_f32 v78, v78
    v_rcp_f32 v79, v79
    v_rcp_f32 v80, v80
    v_rcp_f32 v81, v81
    v_rcp_f32 v82, v82
    v_rcp_f32 v83, v83
    s_mul_i32 s58, s84, 40960
    s_lshl_b32 s59, s24, 5
    s_add_u32 s58, s58, s59
    v_lshlrev_b32 v182, 10, v179
    v_lshl_add_u32 v182, v180, 3, v182
    v_add_u32 v183, 0x4000, v182
    v_add_u32 v184, 0x8000, v182
    v_mov_b32 v185, 0x7f000000
    v_cmp_gt_u32 vcc, 8, v179
    v_mul_f32 v12, v12, v72
    v_mul_f32 v13, v13, v73
    v_mul_f32 v14, v14, v74
    v_mul_f32 v15, v15, v75
    v_mul_f32 v16, v16, v76
    v_mul_f32 v17, v17, v77
    v_mul_f32 v18, v18, v78
    v_mul_f32 v19, v19, v79
    v_mul_f32 v20, v20, v80
    v_mul_f32 v21, v21, v81
    v_mul_f32 v22, v22, v82
    v_mul_f32 v23, v23, v83
    v_mul_f32 v24, v24, v72
    v_mul_f32 v25, v25, v73
    v_mul_f32 v26, v26, v74
    v_mul_f32 v27, v27, v75
    v_mul_f32 v28, v28, v76
    v_mul_f32 v29, v29, v77
    v_mul_f32 v30, v30, v78
    v_mul_f32 v31, v31, v79
    v_mul_f32 v32, v32, v80
    v_mul_f32 v33, v33, v81
    v_mul_f32 v34, v34, v82
    v_mul_f32 v35, v35, v83
    v_mul_f32 v36, v36, v72
    v_mul_f32 v37, v37, v73
    v_mul_f32 v38, v38, v74
    v_mul_f32 v39, v39, v75
    v_mul_f32 v40, v40, v76
    v_mul_f32 v41, v41, v77
    v_mul_f32 v42, v42, v78
    v_mul_f32 v43, v43, v79
    v_mul_f32 v44, v44, v80
    v_mul_f32 v45, v45, v81
    v_mul_f32 v46, v46, v82
    v_mul_f32 v47, v47, v83
    v_cndmask_b32 v184, v185, v184, vcc
    v_cvt_pk_bf16_f32 v0, v0, v1
    v_cvt_pk_bf16_f32 v1, v2, v3
    buffer_store_dwordx2 v[0:1], v182, s[20:23], s58 offen offset:0
    v_cvt_pk_bf16_f32 v4, v4, v5
    v_cvt_pk_bf16_f32 v5, v6, v7
    buffer_store_dwordx2 v[4:5], v183, s[20:23], s58 offen offset:0
    v_cvt_pk_bf16_f32 v8, v8, v9
    v_cvt_pk_bf16_f32 v9, v10, v11
    buffer_store_dwordx2 v[8:9], v184, s[20:23], s58 offen offset:0
    v_cvt_pk_bf16_f32 v12, v12, v13
    v_cvt_pk_bf16_f32 v13, v14, v15
    buffer_store_dwordx2 v[12:13], v182, s[20:23], s58 offen offset:256
    v_cvt_pk_bf16_f32 v16, v16, v17
    v_cvt_pk_bf16_f32 v17, v18, v19
    buffer_store_dwordx2 v[16:17], v183, s[20:23], s58 offen offset:256
    v_cvt_pk_bf16_f32 v20, v20, v21
    v_cvt_pk_bf16_f32 v21, v22, v23
    buffer_store_dwordx2 v[20:21], v184, s[20:23], s58 offen offset:256
    v_cvt_pk_bf16_f32 v24, v24, v25
    v_cvt_pk_bf16_f32 v25, v26, v27
    buffer_store_dwordx2 v[24:25], v182, s[20:23], s58 offen offset:512
    v_cvt_pk_bf16_f32 v28, v28, v29
    v_cvt_pk_bf16_f32 v29, v30, v31
    buffer_store_dwordx2 v[28:29], v183, s[20:23], s58 offen offset:512
    v_cvt_pk_bf16_f32 v32, v32, v33
    v_cvt_pk_bf16_f32 v33, v34, v35
    buffer_store_dwordx2 v[32:33], v184, s[20:23], s58 offen offset:512
    v_cvt_pk_bf16_f32 v36, v36, v37
    v_cvt_pk_bf16_f32 v37, v38, v39
    buffer_store_dwordx2 v[36:37], v182, s[20:23], s58 offen offset:768
    v_cvt_pk_bf16_f32 v40, v40, v41
    v_cvt_pk_bf16_f32 v41, v42, v43
    buffer_store_dwordx2 v[40:41], v183, s[20:23], s58 offen offset:768
    v_cvt_pk_bf16_f32 v44, v44, v45
    v_cvt_pk_bf16_f32 v45, v46, v47
    buffer_store_dwordx2 v[44:45], v184, s[20:23], s58 offen offset:768
K2_end:
K2_last:
    s_endpgm
SLOW:
    s_endpgm
.section .rodata,"a"
.p2align 6
.amdhsa_kernel tp_prep_kernel
  .amdhsa_next_free_vgpr 88
  .amdhsa_next_free_sgpr 48
  .amdhsa_accum_offset 88
  .amdhsa_group_segment_fixed_size 0
  .amdhsa_kernarg_size 96
  .amdhsa_user_sgpr_count 2
  .amdhsa_user_sgpr_kernarg_segment_ptr 1
  .amdhsa_system_sgpr_workgroup_id_x 1
.end_amdhsa_kernel
.p2align 6
.amdhsa_kernel standalone__tensor_product_equiv_equiformer__graph_kernel
  .amdhsa_next_free_vgpr 256
  .amdhsa_next_free_sgpr 100
  .amdhsa_accum_offset 256
  .amdhsa_group_segment_fixed_size 0
  .amdhsa_kernarg_size 96
  .amdhsa_user_sgpr_count 2
  .amdhsa_user_sgpr_kernarg_segment_ptr 1
  .amdhsa_system_sgpr_workgroup_id_x 1
.end_amdhsa_kernel
```

```asm
; @launch kernel=tp_prep_kernel grid=(156,1,1) block=(640,1,1) lds=97280
; @launch kernel=standalone__tensor_product_equiv_equiformer__graph_kernel grid=(250,1,1) block=(512,1,1) lds=163840
.amdgcn_target "amdgcn-amd-amdhsa--gfx950"
.text
.globl tp_prep_kernel
.p2align 8
.type tp_prep_kernel,@function
tp_prep_kernel:
    s_cmp_ge_u32 s2, 156
    s_cbranch_scc1 K1_end
    s_load_dwordx2 s[4:5], s[0:1], 8
    s_load_dwordx4 s[8:11], s[0:1], 24
    s_load_dwordx4 s[12:15], s[0:1], 40
    s_load_dwordx2 s[16:17], s[0:1], 56
    s_load_dwordx2 s[18:19], s[0:1], 88
    s_cmp_ge_u32 s2, 125
    s_cbranch_scc1 K1_wprep
    v_and_b32 v1, 255, v0
    v_lshlrev_b32 v1, 2, v1
    v_mov_b32 v2, 0
    v_add_u32 v1, 96000, v1
    ds_write_b32 v1, v2
    v_lshlrev_b32 v3, 4, v0
    v_mul_u32_u24 v4, 24, v0
    s_mul_i32 s3, s2, 10240
    s_mul_i32 s20, s2, 15360
    s_mul_i32 s21, s2, 2560
    s_waitcnt lgkmcnt(0)
    s_mov_b32 s24, s10
    s_and_b32 s25, s11, 0xffff
    s_mov_b32 s26, 1280000
    s_mov_b32 s27, 0x20000
    s_mov_b32 s28, s8
    s_and_b32 s29, s9, 0xffff
    s_mov_b32 s30, 1280000
    s_mov_b32 s31, 0x20000
    s_mov_b32 s32, s4
    s_and_b32 s33, s5, 0xffff
    s_mov_b32 s34, 1920000
    s_mov_b32 s35, 0x20000
    s_mov_b32 s36, s18
    s_and_b32 s37, s19, 0xffff
    s_mov_b32 s38, 12492800
    s_mov_b32 s39, 0x20000
    buffer_load_dwordx4 v[8:11], v3, s[24:27], s3 offen
    buffer_load_dwordx4 v[12:15], v3, s[28:31], s3 offen
    buffer_load_dwordx4 v[16:19], v4, s[32:35], s20 offen
    buffer_load_dwordx2 v[20:21], v4, s[32:35], s20 offen offset:16
    v_lshl_add_u32 v5, v0, 2, s21
    v_mov_b32 v6, 1
    s_mov_b32 s22, 52429
    s_mov_b32 s23, 0x05040100
    s_barrier
    s_waitcnt vmcnt(3)
    v_mul_u32_u24 v22, s22, v8
    v_mul_u32_u24 v23, s22, v9
    v_mul_u32_u24 v24, s22, v10
    v_mul_u32_u24 v25, s22, v11
    v_lshrrev_b32 v22, 21, v22
    v_lshrrev_b32 v23, 21, v23
    v_lshrrev_b32 v24, 21, v24
    v_lshrrev_b32 v25, 21, v25
    v_min_u32 v22, 249, v22
    v_min_u32 v23, 249, v23
    v_min_u32 v24, 249, v24
    v_min_u32 v25, 249, v25
    v_lshlrev_b32 v34, 2, v22
    v_lshlrev_b32 v35, 2, v23
    v_lshlrev_b32 v36, 2, v24
    v_lshlrev_b32 v37, 2, v25
    v_add_u32 v34, 96000, v34
    ds_add_rtn_u32 v26, v34, v6
    v_add_u32 v35, 96000, v35
    ds_add_rtn_u32 v27, v35, v6
    v_add_u32 v36, 96000, v36
    ds_add_rtn_u32 v28, v36, v6
    v_add_u32 v37, 96000, v37
    ds_add_rtn_u32 v29, v37, v6
    v_mul_u32_u24 v30, 40, v22
    v_sub_u32 v30, v8, v30
    v_and_b32 v30, 63, v30
    v_add_u32 v7, 0, v5
    v_lshl_or_b32 v30, v30, 19, v7
    v_mul_u32_u24 v22, 384, v22
    v_mul_u32_u24 v31, 40, v23
    v_sub_u32 v31, v9, v31
    v_and_b32 v31, 63, v31
    v_add_u32 v7, 1, v5
    v_lshl_or_b32 v31, v31, 19, v7
    v_mul_u32_u24 v23, 384, v23
    v_mul_u32_u24 v32, 40, v24
    v_sub_u32 v32, v10, v32
    v_and_b32 v32, 63, v32
    v_add_u32 v7, 2, v5
    v_lshl_or_b32 v32, v32, 19, v7
    v_mul_u32_u24 v24, 384, v24
    v_mul_u32_u24 v33, 40, v25
    v_sub_u32 v33, v11, v33
    v_and_b32 v33, 63, v33
    v_add_u32 v7, 3, v5
    v_lshl_or_b32 v33, v33, 19, v7
    v_mul_u32_u24 v25, 384, v25
    s_waitcnt vmcnt(0)
    v_mov_b32 v40, v16
    v_perm_b32 v41, v12, v17, s23
    v_alignbit_b32 v42, v18, v17, 16
    v_alignbit_b32 v43, v13, v18, 16
    v_mov_b32 v44, v19
    v_perm_b32 v45, v14, v20, s23
    v_alignbit_b32 v46, v21, v20, 16
    v_alignbit_b32 v47, v15, v21, 16
    v_xor_b32 v41, 0x8000, v41
    v_xor_b32 v43, 0x8000, v43
    v_xor_b32 v45, 0x8000, v45
    v_xor_b32 v47, 0x8000, v47
    v_mov_b32 v48, 97024
    s_waitcnt lgkmcnt(0)
    v_cmp_gt_u32 vcc, 32, v26
    v_lshl_add_u32 v34, v26, 2, v22
    v_lshl_add_u32 v8, v26, 3, v22
    v_cndmask_b32 v34, v48, v34, vcc
    v_cndmask_b32 v8, v48, v8, vcc
    ds_write_b32 v34, v30
    ds_write_b64 v8, v[40:41] offset:128
    v_cmp_gt_u32 vcc, 32, v27
    v_lshl_add_u32 v35, v27, 2, v23
    v_lshl_add_u32 v9, v27, 3, v23
    v_cndmask_b32 v35, v48, v35, vcc
    v_cndmask_b32 v9, v48, v9, vcc
    ds_write_b32 v35, v31
    ds_write_b64 v9, v[42:43] offset:128
    v_cmp_gt_u32 vcc, 32, v28
    v_lshl_add_u32 v36, v28, 2, v24
    v_lshl_add_u32 v10, v28, 3, v24
    v_cndmask_b32 v36, v48, v36, vcc
    v_cndmask_b32 v10, v48, v10, vcc
    ds_write_b32 v36, v32
    ds_write_b64 v10, v[44:45] offset:128
    v_cmp_gt_u32 vcc, 32, v29
    v_lshl_add_u32 v37, v29, 2, v25
    v_lshl_add_u32 v11, v29, 3, v25
    v_cndmask_b32 v37, v48, v37, vcc
    v_cndmask_b32 v11, v48, v11, vcc
    ds_write_b32 v37, v33
    ds_write_b64 v11, v[46:47] offset:128
    v_lshrrev_b32 v1, 4, v0
    v_and_b32 v2, 15, v0
    v_mul_u32_u24 v3, 384, v1
    v_lshl_add_u32 v3, v2, 4, v3
    v_lshlrev_b32 v4, 2, v1
    v_add_u32 v4, 96000, v4
    s_mov_b32 s22, 49152
    v_mul_lo_u32 v5, s22, v1
    v_lshl_add_u32 v5, v2, 4, v5
    s_mul_i32 s3, s2, 384
    v_cmp_eq_u32 s[40:41], 0, v2
    v_cmp_gt_u32 s[46:47], 8, v2
    s_waitcnt lgkmcnt(0)
    s_barrier
    ds_read_b128 v[52:55], v3 offset:0
    ds_read_b32 v8, v4 offset:0
    ds_read_b128 v[56:59], v3 offset:15360
    ds_read_b32 v9, v4 offset:160
    ds_read_b128 v[60:63], v3 offset:30720
    ds_read_b32 v10, v4 offset:320
    ds_read_b128 v[64:67], v3 offset:46080
    ds_read_b32 v11, v4 offset:480
    ds_read_b128 v[68:71], v3 offset:61440
    ds_read_b32 v12, v4 offset:640
    v_add_u32 v49, 76800, v3
    ds_read_b128 v[72:75], v49 offset:0
    ds_read_b32 v13, v4 offset:800
    ds_read_b128 v[76:79], v49 offset:15360
    ds_read_b32 v14, v4 offset:960
    s_waitcnt lgkmcnt(12)
    v_min_u32 v20, 127, v8
    v_and_b32 v21, 0x1ffffff, v52
    v_lshl_or_b32 v21, v20, 25, v21
    v_cndmask_b32 v52, v52, v21, s[40:41]
    buffer_store_dwordx4 v[52:55], v5, s[36:39], s3 offen
    v_cmp_lt_u32 vcc, 16, v8
    s_and_b64 vcc, vcc, s[46:47]
    s_and_saveexec_b64 s[44:45], vcc
    s_cbranch_execz K1_skipb0
    v_add_u32 v20, 256, v3
    ds_read_b128 v[24:27], v20
    s_waitcnt lgkmcnt(0)
    buffer_store_dwordx4 v[24:27], v5, s[36:39], s3 offen offset:256
    s_nop 1
K1_skipb0:
    s_mov_b64 exec, -1
    s_add_u32 s3, s3, 1966080
    s_waitcnt lgkmcnt(10)
    v_min_u32 v20, 127, v9
    v_and_b32 v21, 0x1ffffff, v56
    v_lshl_or_b32 v21, v20, 25, v21
    v_cndmask_b32 v56, v56, v21, s[40:41]
    buffer_store_dwordx4 v[56:59], v5, s[36:39], s3 offen
    v_cmp_lt_u32 vcc, 16, v9
    s_and_b64 vcc, vcc, s[46:47]
    s_and_saveexec_b64 s[44:45], vcc
    s_cbranch_execz K1_skipb1
    v_add_u32 v20, 15616, v3
    ds_read_b128 v[24:27], v20
    s_waitcnt lgkmcnt(0)
    buffer_store_dwordx4 v[24:27], v5, s[36:39], s3 offen offset:256
    s_nop 1
K1_skipb1:
    s_mov_b64 exec, -1
    s_add_u32 s3, s3, 1966080
    s_waitcnt lgkmcnt(8)
    v_min_u32 v20, 127, v10
    v_and_b32 v21, 0x1ffffff, v60
    v_lshl_or_b32 v21, v20, 25, v21
    v_cndmask_b32 v60, v60, v21, s[40:41]
    buffer_store_dwordx4 v[60:63], v5, s[36:39], s3 offen
    v_cmp_lt_u32 vcc, 16, v10
    s_and_b64 vcc, vcc, s[46:47]
    s_and_saveexec_b64 s[44:45], vcc
    s_cbranch_execz K1_skipb2
    v_add_u32 v20, 30976, v3
    ds_read_b128 v[24:27], v20
    s_waitcnt lgkmcnt(0)
    buffer_store_dwordx4 v[24:27], v5, s[36:39], s3 offen offset:256
    s_nop 1
K1_skipb2:
    s_mov_b64 exec, -1
    s_add_u32 s3, s3, 1966080
    s_waitcnt lgkmcnt(6)
    v_min_u32 v20, 127, v11
    v_and_b32 v21, 0x1ffffff, v64
    v_lshl_or_b32 v21, v20, 25, v21
    v_cndmask_b32 v64, v64, v21, s[40:41]
    buffer_store_dwordx4 v[64:67], v5, s[36:39], s3 offen
    v_cmp_lt_u32 vcc, 16, v11
    s_and_b64 vcc, vcc, s[46:47]
    s_and_saveexec_b64 s[44:45], vcc
    s_cbranch_execz K1_skipb3
    v_add_u32 v20, 46336, v3
    ds_read_b128 v[24:27], v20
    s_waitcnt lgkmcnt(0)
    buffer_store_dwordx4 v[24:27], v5, s[36:39], s3 offen offset:256
    s_nop 1
K1_skipb3:
    s_mov_b64 exec, -1
    s_add_u32 s3, s3, 1966080
    s_waitcnt lgkmcnt(4)
    v_min_u32 v20, 127, v12
    v_and_b32 v21, 0x1ffffff, v68
    v_lshl_or_b32 v21, v20, 25, v21
    v_cndmask_b32 v68, v68, v21, s[40:41]
    buffer_store_dwordx4 v[68:71], v5, s[36:39], s3 offen
    v_cmp_lt_u32 vcc, 16, v12
    s_and_b64 vcc, vcc, s[46:47]
    s_and_saveexec_b64 s[44:45], vcc
    s_cbranch_execz K1_skipb4
    v_add_u32 v20, 61696, v3
    ds_read_b128 v[24:27], v20
    s_waitcnt lgkmcnt(0)
    buffer_store_dwordx4 v[24:27], v5, s[36:39], s3 offen offset:256
    s_nop 1
K1_skipb4:
    s_mov_b64 exec, -1
    s_add_u32 s3, s3, 1966080
    s_waitcnt lgkmcnt(2)
    v_min_u32 v20, 127, v13
    v_and_b32 v21, 0x1ffffff, v72
    v_lshl_or_b32 v21, v20, 25, v21
    v_cndmask_b32 v72, v72, v21, s[40:41]
    buffer_store_dwordx4 v[72:75], v5, s[36:39], s3 offen
    v_cmp_lt_u32 vcc, 16, v13
    s_and_b64 vcc, vcc, s[46:47]
    s_and_saveexec_b64 s[44:45], vcc
    s_cbranch_execz K1_skipb5
    v_add_u32 v20, 77056, v3
    ds_read_b128 v[24:27], v20
    s_waitcnt lgkmcnt(0)
    buffer_store_dwordx4 v[24:27], v5, s[36:39], s3 offen offset:256
    s_nop 1
K1_skipb5:
    s_mov_b64 exec, -1
    s_add_u32 s3, s3, 1966080
    s_waitcnt lgkmcnt(0)
    v_min_u32 v20, 127, v14
    v_and_b32 v21, 0x1ffffff, v76
    v_lshl_or_b32 v21, v20, 25, v21
    v_cndmask_b32 v76, v76, v21, s[40:41]
    v_cmp_gt_u32 vcc, 10, v1
    s_and_saveexec_b64 s[44:45], vcc
    s_cbranch_execz K1_skipb6
    buffer_store_dwordx4 v[76:79], v5, s[36:39], s3 offen
    v_cmp_lt_u32 vcc, 16, v14
    s_and_b64 vcc, vcc, s[46:47]
    s_and_saveexec_b64 s[44:45], vcc
    s_cbranch_execz K1_skipb6
    v_add_u32 v20, 92416, v3
    ds_read_b128 v[24:27], v20
    s_waitcnt lgkmcnt(0)
    buffer_store_dwordx4 v[24:27], v5, s[36:39], s3 offen offset:256
    s_nop 1
K1_skipb6:
    s_mov_b64 exec, -1
    s_add_u32 s3, s3, 1966080
    s_endpgm
K1_wprep:
    v_lshrrev_b32 v1, 6, v0
    v_and_b32 v2, 63, v0
    v_readfirstlane_b32 s3, v1
    s_sub_u32 s20, s2, 125
    s_mul_i32 s20, s20, 10
    s_add_u32 s20, s20, s3
    s_waitcnt lgkmcnt(0)
    s_mov_b32 s36, s18
    s_and_b32 s37, s19, 0xffff
    s_mov_b32 s38, 12492800
    s_mov_b32 s39, 0x20000
    s_mov_b32 s24, s14
    s_and_b32 s25, s15, 0xffff
    s_mov_b32 s26, 65536
    s_mov_b32 s27, 0x20000
    s_mov_b32 s28, s12
    s_and_b32 s29, s13, 0xffff
    s_mov_b32 s30, 20480
    s_mov_b32 s31, 0x20000
    v_lshlrev_b32 v3, 4, v2
    s_cmp_ge_u32 s20, 200
    s_cbranch_scc1 K1_warm
    s_cmp_ge_u32 s20, 160
    s_cbranch_scc1 K1_wrad
    s_mul_i32 s21, s20, 3277
    s_lshr_b32 s21, s21, 16
    s_mul_i32 s22, s21, 20
    s_sub_u32 s22, s20, s22
    s_cmp_lt_u32 s22, 8
    s_cbranch_scc1 K1_w0
    s_mov_b32 s24, s16
    s_and_b32 s25, s17, 0xffff
    s_mov_b32 s26, 98304
    s_mov_b32 s27, 0x20000
    s_sub_u32 s22, s22, 8
K1_w0:
    s_lshr_b32 s23, s22, 1
    s_lshl_b32 s23, s23, 6
    s_and_b32 s40, s22, 1
    s_lshl_b32 s40, s40, 4
    s_add_u32 s23, s23, s40
    s_lshl_b32 s23, s23, 8
    s_lshl_b32 s40, s21, 5
    s_add_u32 s23, s23, s40
    s_add_u32 s41, s23, 8192
    v_lshrrev_b32 v4, 4, v2
    v_lshlrev_b32 v4, 10, v4
    v_and_b32 v5, 15, v2
    v_lshl_add_u32 v4, v5, 1, v4
    buffer_load_ushort v8, v4, s[24:27], s23 offen offset:0
    buffer_load_ushort v12, v4, s[24:27], s41 offen offset:0
    buffer_load_ushort v9, v4, s[24:27], s23 offen offset:256
    buffer_load_ushort v13, v4, s[24:27], s41 offen offset:256
    buffer_load_ushort v10, v4, s[24:27], s23 offen offset:512
    buffer_load_ushort v14, v4, s[24:27], s41 offen offset:512
    buffer_load_ushort v11, v4, s[24:27], s23 offen offset:768
    buffer_load_ushort v15, v4, s[24:27], s41 offen offset:768
    s_lshl_b32 s40, s20, 10
    s_add_u32 s40, s40, 12288000
    s_waitcnt vmcnt(0)
    v_lshl_or_b32 v8, v12, 16, v8
    v_lshl_or_b32 v9, v13, 16, v9
    v_lshl_or_b32 v10, v14, 16, v10
    v_lshl_or_b32 v11, v15, 16, v11
    buffer_store_dwordx4 v[8:11], v3, s[36:39], s40 offen
    s_endpgm
K1_wrad:
    s_sub_u32 s20, s20, 160
    s_cmp_ge_u32 s20, 20
    s_cselect_b32 s21, 1, 0
    s_mul_i32 s22, s21, 20
    s_sub_u32 s22, s20, s22
    s_lshr_b32 s23, s22, 2
    s_lshl_b32 s23, s23, 8
    s_lshl_b32 s40, s21, 7
    s_add_u32 s23, s23, s40
    s_bfe_u32 s40, s22, 0x10001
    s_lshl_b32 s40, s40, 6
    s_add_u32 s23, s23, s40
    s_and_b32 s40, s22, 1
    s_mul_i32 s40, s40, 8*1280
    s_add_u32 s23, s23, s40
    v_lshrrev_b32 v4, 5, v2
    v_mul_u32_u24 v4, 5120, v4
    v_and_b32 v5, 31, v2
    v_lshl_add_u32 v4, v5, 1, v4
    buffer_load_ushort v8, v4, s[28:31], s23 offen offset:0
    buffer_load_ushort v9, v4, s[28:31], s23 offen offset:1280
    buffer_load_ushort v10, v4, s[28:31], s23 offen offset:2560
    buffer_load_ushort v11, v4, s[28:31], s23 offen offset:3840
    s_lshl_b32 s40, s20, 10
    s_add_u32 s40, s40, 12451840
    s_waitcnt vmcnt(0)
    v_lshlrev_b32 v8, 16, v8
    v_lshlrev_b32 v9, 16, v9
    v_lshlrev_b32 v10, 16, v10
    v_lshlrev_b32 v11, 16, v11
    buffer_store_dwordx4 v[8:11], v3, s[36:39], s40 offen
    s_endpgm
K1_warm:
    s_cmp_ge_u32 s2, 148
    s_cbranch_scc1 K1_warm2
    s_sub_u32 s20, s2, 20
    s_mul_i32 s20, s20, 384
    s_mov_b32 s22, 49152
    v_mul_lo_u32 v5, s22, v0
    v_mov_b32 v6, 0
    v_cmp_gt_u32 vcc, 250, v0
    s_and_saveexec_b64 s[44:45], vcc
    s_cbranch_execz K1_end
    buffer_store_dword v6, v5, s[36:39], s20 offen
    s_endpgm
K1_warm2:
    s_load_dwordx2 s[4:5], s[0:1], 0
    s_sub_u32 s20, s2, 148
    s_lshr_b32 s20, s20, 3
    s_cmp_lg_u32 s20, 0
    s_cbranch_scc1 K1_warm_x
    s_getpc_b64 s[6:7]
K1_pc:
    s_add_u32 s6, s6, standalone__tensor_product_equiv_equiformer__graph_kernel-K1_pc
    s_addc_u32 s7, s7, 0
    v_lshlrev_b32 v4, 7, v0
    v_min_u32 v4, K2_last-standalone__tensor_product_equiv_equiformer__graph_kernel, v4
    v_mov_b32 v5, s7
    v_add_co_u32 v4, vcc, s6, v4
    s_nop 1
    v_addc_co_u32 v5, vcc, 0, v5, vcc
    global_load_dword v6, v[4:5], off
K1_warm_x:
    s_mul_i32 s20, s20, 10
    s_add_u32 s20, s20, s3
    s_mul_i32 s20, s20, 0
    v_lshlrev_b32 v4, 8, v2
    s_waitcnt lgkmcnt(0)
    s_mov_b32 s24, s4
    s_and_b32 s25, s5, 0xffff
    s_mov_b32 s26, 10240000
    s_mov_b32 s27, 0x20000
K1_end:
    s_endpgm
.globl standalone__tensor_product_equiv_equiformer__graph_kernel
.p2align 8
.type standalone__tensor_product_equiv_equiformer__graph_kernel,@function
standalone__tensor_product_equiv_equiformer__graph_kernel:
    s_cmp_ge_u32 s2, 250
    s_cbranch_scc1 K2_end
    s_load_dwordx2 s[72:73], s[0:1], 0
    s_load_dwordx2 s[74:75], s[0:1], 16
    s_load_dwordx2 s[78:79], s[0:1], 88
    v_lshrrev_b32 v2, 6, v0
    v_and_b32 v1, 63, v0
    v_readfirstlane_b32 s20, v2
    v_lshrrev_b32 v2, 5, v1
    v_mul_u32_u24 v2, 384, v2
    v_and_b32 v52, 31, v1
    v_lshl_add_u32 v48, v52, 2, v2
    v_lshl_add_u32 v49, v52, 3, v2
    v_lshlrev_b32 v50, 4, v1
    s_mul_i32 s66, s2, 49152
    s_mul_i32 s67, s20, 6144
    s_add_u32 s66, s66, s67
    s_add_u32 s67, s66, 3072
    s_lshl_b32 s21, s20, 13
    v_lshlrev_b32 v248, 2, v1
    v_mov_b32 v53, 0
    v_add_u32 v54, 86016, v248
    ds_write_b32 v54, v53
    ds_write_b32 v54, v53 offset:256
    s_mov_b32 s56, 0xffff
    s_mov_b32 s57, 0xffff
    s_waitcnt lgkmcnt(0)
    s_mov_b32 s16, s78
    s_and_b32 s17, s79, 0xffff
    s_mov_b32 s18, 12492800
    s_mov_b32 s19, 0x20000
    buffer_load_dword v8, v48, s[16:19], s66 offen offset:0
    buffer_load_dword v9, v48, s[16:19], s66 offen offset:768
    buffer_load_dword v10, v48, s[16:19], s66 offen offset:1536
    buffer_load_dword v11, v48, s[16:19], s66 offen offset:2304
    buffer_load_dword v12, v48, s[16:19], s67 offen offset:0
    buffer_load_dword v13, v48, s[16:19], s67 offen offset:768
    buffer_load_dword v14, v48, s[16:19], s67 offen offset:1536
    buffer_load_dword v15, v48, s[16:19], s67 offen offset:2304
    s_mov_b64 exec, s[56:57]
    buffer_load_dwordx2 v[16:17], v49, s[16:19], s66 offen offset:128
    buffer_load_dwordx2 v[18:19], v49, s[16:19], s66 offen offset:896
    buffer_load_dwordx2 v[20:21], v49, s[16:19], s66 offen offset:1664
    buffer_load_dwordx2 v[22:23], v49, s[16:19], s66 offen offset:2432
    buffer_load_dwordx2 v[24:25], v49, s[16:19], s67 offen offset:128
    buffer_load_dwordx2 v[26:27], v49, s[16:19], s67 offen offset:896
    buffer_load_dwordx2 v[28:29], v49, s[16:19], s67 offen offset:1664
    buffer_load_dwordx2 v[30:31], v49, s[16:19], s67 offen offset:2432
    s_mov_b64 exec, -1
    s_barrier
    s_mul_i32 s68, s20, 5120
    s_add_u32 s69, s68, 12451840
    s_cmp_ge_u32 s20, 4
    s_cselect_b32 s70, 45056, 0
    s_add_u32 s68, s68, s70
    s_add_u32 m0, s68, 0
    s_add_u32 s70, s69, 0
    buffer_load_dwordx4 v50, s[16:19], s70 offen lds
    s_add_u32 m0, s68, 1024
    s_add_u32 s70, s69, 1024
    buffer_load_dwordx4 v50, s[16:19], s70 offen lds
    s_add_u32 m0, s68, 2048
    s_add_u32 s70, s69, 2048
    buffer_load_dwordx4 v50, s[16:19], s70 offen lds
    s_add_u32 m0, s68, 3072
    s_add_u32 s70, s69, 3072
    buffer_load_dwordx4 v50, s[16:19], s70 offen lds
    s_add_u32 m0, s68, 4096
    s_add_u32 s70, s69, 4096
    buffer_load_dwordx4 v50, s[16:19], s70 offen lds
    s_sub_u32 s72, s72, 128
    s_subb_u32 s73, s73, 0
    s_mov_b32 s4, s72
    s_and_b32 s5, s73, 0xffff
    s_mov_b32 s6, 10240000
    s_mov_b32 s7, 0x20000
    s_sub_u32 s72, s72, 1024
    s_subb_u32 s73, s73, 0
    s_mov_b32 s8, s72
    s_and_b32 s9, s73, 0xffff
    s_mov_b32 s10, 10241024
    s_mov_b32 s11, 0x20000
    s_mov_b32 s12, s74
    s_and_b32 s13, s75, 0xffff
    s_mov_b32 s14, 10240000
    s_mov_b32 s15, 0x20000
    v_mov_b32 v4, 2130738944
    v_mov_b32 v5, 2130738944
    v_mov_b32 v6, 2130738944
    v_mov_b32 v7, 2130738944
    v_lshlrev_b32 v2, 4, v0
    v_add_u32 v3, 87040, v2
    ds_write_b128 v3, v[4:7] offset:0
    ds_write_b128 v3, v[4:7] offset:8192
    ds_write_b128 v3, v[4:7] offset:16384
    ds_write_b128 v3, v[4:7] offset:24576
    ds_write_b128 v3, v[4:7] offset:32768
    ds_write_b128 v3, v[4:7] offset:40960
    ds_write_b128 v3, v[4:7] offset:49152
    ds_write_b128 v3, v[4:7] offset:57344
    v_add_u32 v3, 0x10000, v3
    ds_write_b128 v3, v[4:7] offset:0
    v_min_u32 v2, 3056, v2
    v_add_u32 v2, 160768, v2
    ds_write_b128 v2, v[4:7]
    v_lshrrev_b32 v2, 5, v1
    v_bfe_u32 v3, v1, 2, 2
    v_and_b32 v4, 3, v1
    v_bfe_u32 v5, v1, 4, 1
    v_lshlrev_b32 v6, 9, v2
    v_lshl_add_u32 v6, v3, 7, v6
    v_lshl_add_u32 v6, v5, 5, v6
    v_lshl_add_u32 v6, v4, 3, v6
    v_lshrrev_b32 v7, 1, v3
    v_lshl_add_u32 v6, v7, 6, v6
    v_add_u32 v244, s21, v6
    v_xor_b32 v245, 64, v244
    v_lshlrev_b32 v6, 7, v2
    v_lshl_add_u32 v6, v3, 5, v6
    v_lshl_add_u32 v249, v4, 3, v6
    v_lshl_add_u32 v6, v2, 2, v4
    v_bfe_u32 v7, v1, 2, 1
    v_lshl_add_u32 v6, v7, 3, v6
    v_lshlrev_b32 v6, 3, v6
    v_bfe_u32 v7, v1, 3, 1
    v_add_u32 v5, 1, v5
    v_mul_u32_u24 v7, v7, v5
    v_lshl_add_u32 v250, v7, 1, v6
    v_and_b32 v6, 0x38, v1
    v_add_u32 v247, 6, v6
    v_lshrrev_b32 v6, 2, v1
    v_lshrrev_b32 v7, 4, v1
    v_xor_b32 v6, v6, v7
    v_and_b32 v6, 1, v6
    v_lshlrev_b32 v6, 6, v6
    v_lshl_add_u32 v246, v4, 4, v6
    v_mov_b32 v242, 1.0
    v_mov_b32 v243, 1.0
    s_mov_b32 s54, 0xffffff00
    s_mov_b32 s55, 0xffffff00
    s_mov_b32 s58, 0
    s_mov_b32 s59, 134217856
    s_mov_b32 s60, 262272
    s_mov_b32 s61, 402915456
    s_mov_b32 s62, 940179840
    s_mov_b32 s63, 403046528
    s_mov_b32 s64, 402784384
    s_mov_b32 s65, 134348928
    s_mov_b32 s38, 128
    s_mov_b32 s33, -1
    s_and_b32 s68, s20, 3
    s_lshl_b32 s68, s68, 2
    s_lshr_b32 s69, s20, 2
    s_add_u32 s68, s68, s69
    s_lshl_b32 s68, s68, 4
    s_add_u32 s68, s68, 86272
    v_mov_b32 v251, s68
    s_mov_b32 s53, 0
    s_mov_b32 s50, 0
    s_mov_b32 s51, 0
    s_mov_b32 s47, 0
    s_mov_b32 s42, 0
    s_mov_b32 s3, 0
    s_mov_b32 s34, 128
    s_mov_b32 s35, 384
    s_mov_b32 s36, 640
    s_mov_b32 s37, 896
    s_mov_b32 s71, 86016
    v_mov_b32 v3, 1
    s_waitcnt vmcnt(20)
    v_mov_b32_dpp v2, v8 row_newbcast:0 row_mask:0xf bank_mask:0xf
    v_bfe_u32 v40, v8, 19, 6
    v_lshl_add_u32 v40, v40, 2, s71
    v_mov_b32_dpp v2, v2 row_bcast:15 row_mask:0xa bank_mask:0xf
    v_lshrrev_b32 v2, 25, v2
    v_cmp_lt_u32 s[72:73], v52, v2
    v_max_u32 v53, v53, v2
    s_mov_b64 exec, s[72:73]
    ds_add_rtn_u32 v32, v40, v3
    s_mov_b64 exec, -1
    s_waitcnt vmcnt(19)
    v_mov_b32_dpp v2, v9 row_newbcast:0 row_mask:0xf bank_mask:0xf
    v_bfe_u32 v41, v9, 19, 6
    v_lshl_add_u32 v41, v41, 2, s71
    v_mov_b32_dpp v2, v2 row_bcast:15 row_mask:0xa bank_mask:0xf
    v_lshrrev_b32 v2, 25, v2
    v_cmp_lt_u32 s[74:75], v52, v2
    v_max_u32 v53, v53, v2
    s_mov_b64 exec, s[74:75]
    ds_add_rtn_u32 v33, v41, v3
    s_mov_b64 exec, -1
    s_waitcnt vmcnt(18)
    v_mov_b32_dpp v2, v10 row_newbcast:0 row_mask:0xf bank_mask:0xf
    v_bfe_u32 v42, v10, 19, 6
    v_lshl_add_u32 v42, v42, 2, s71
    v_mov_b32_dpp v2, v2 row_bcast:15 row_mask:0xa bank_mask:0xf
    v_lshrrev_b32 v2, 25, v2
    v_cmp_lt_u32 s[76:77], v52, v2
    v_max_u32 v53, v53, v2
    s_mov_b64 exec, s[76:77]
    ds_add_rtn_u32 v34, v42, v3
    s_mov_b64 exec, -1
    s_waitcnt vmcnt(17)
    v_mov_b32_dpp v2, v11 row_newbcast:0 row_mask:0xf bank_mask:0xf
    v_bfe_u32 v43, v11, 19, 6
    v_lshl_add_u32 v43, v43, 2, s71
    v_mov_b32_dpp v2, v2 row_bcast:15 row_mask:0xa bank_mask:0xf
    v_lshrrev_b32 v2, 25, v2
    v_cmp_lt_u32 s[78:79], v52, v2
    v_max_u32 v53, v53, v2
    s_mov_b64 exec, s[78:79]
    ds_add_rtn_u32 v35, v43, v3
    s_mov_b64 exec, -1
    s_waitcnt vmcnt(16)
    v_mov_b32_dpp v2, v12 row_newbcast:0 row_mask:0xf bank_mask:0xf
    v_bfe_u32 v44, v12, 19, 6
    v_lshl_add_u32 v44, v44, 2, s71
    v_mov_b32_dpp v2, v2 row_bcast:15 row_mask:0xa bank_mask:0xf
    v_lshrrev_b32 v2, 25, v2
    v_cmp_lt_u32 s[80:81], v52, v2
    v_max_u32 v53, v53, v2
    s_mov_b64 exec, s[80:81]
    ds_add_rtn_u32 v36, v44, v3
    s_mov_b64 exec, -1
    s_waitcnt vmcnt(15)
    v_mov_b32_dpp v2, v13 row_newbcast:0 row_mask:0xf bank_mask:0xf
    v_bfe_u32 v45, v13, 19, 6
    v_lshl_add_u32 v45, v45, 2, s71
    v_mov_b32_dpp v2, v2 row_bcast:15 row_mask:0xa bank_mask:0xf
    v_lshrrev_b32 v2, 25, v2
    v_cmp_lt_u32 s[82:83], v52, v2
    v_max_u32 v53, v53, v2
    s_mov_b64 exec, s[82:83]
    ds_add_rtn_u32 v37, v45, v3
    s_mov_b64 exec, -1
    s_waitcnt vmcnt(14)
    v_mov_b32_dpp v2, v14 row_newbcast:0 row_mask:0xf bank_mask:0xf
    v_bfe_u32 v46, v14, 19, 6
    v_lshl_add_u32 v46, v46, 2, s71
    v_mov_b32_dpp v2, v2 row_bcast:15 row_mask:0xa bank_mask:0xf
    v_lshrrev_b32 v2, 25, v2
    v_cmp_lt_u32 s[84:85], v52, v2
    v_max_u32 v53, v53, v2
    s_mov_b64 exec, s[84:85]
    ds_add_rtn_u32 v38, v46, v3
    s_mov_b64 exec, -1
    s_waitcnt vmcnt(13)
    v_mov_b32_dpp v2, v15 row_newbcast:0 row_mask:0xf bank_mask:0xf
    v_bfe_u32 v47, v15, 19, 6
    v_lshl_add_u32 v47, v47, 2, s71
    v_mov_b32_dpp v2, v2 row_bcast:15 row_mask:0xa bank_mask:0xf
    v_lshrrev_b32 v2, 25, v2
    v_cmp_lt_u32 s[86:87], v52, v2
    v_max_u32 v53, v53, v2
    s_mov_b64 exec, s[86:87]
    ds_add_rtn_u32 v39, v47, v3
    s_mov_b64 exec, -1
    s_waitcnt vmcnt(0)
    v_cmp_lt_u32 vcc, 16, v53
    s_cmp_eq_u64 vcc, 0
    s_cbranch_scc1 NO_UPPER
    s_andn2_b64 exec, s[72:73], s[56:57]
    s_cbranch_execz NO_UP0
    buffer_load_dwordx2 v[16:17], v49, s[16:19], s66 offen offset:128
NO_UP0:
    s_andn2_b64 exec, s[74:75], s[56:57]
    s_cbranch_execz NO_UP1
    buffer_load_dwordx2 v[18:19], v49, s[16:19], s66 offen offset:896
NO_UP1:
    s_andn2_b64 exec, s[76:77], s[56:57]
    s_cbranch_execz NO_UP2
    buffer_load_dwordx2 v[20:21], v49, s[16:19], s66 offen offset:1664
NO_UP2:
    s_andn2_b64 exec, s[78:79], s[56:57]
    s_cbranch_execz NO_UP3
    buffer_load_dwordx2 v[22:23], v49, s[16:19], s66 offen offset:2432
NO_UP3:
    s_andn2_b64 exec, s[80:81], s[56:57]
    s_cbranch_execz NO_UP4
    buffer_load_dwordx2 v[24:25], v49, s[16:19], s67 offen offset:128
NO_UP4:
    s_andn2_b64 exec, s[82:83], s[56:57]
    s_cbranch_execz NO_UP5
    buffer_load_dwordx2 v[26:27], v49, s[16:19], s67 offen offset:896
NO_UP5:
    s_andn2_b64 exec, s[84:85], s[56:57]
    s_cbranch_execz NO_UP6
    buffer_load_dwordx2 v[28:29], v49, s[16:19], s67 offen offset:1664
NO_UP6:
    s_andn2_b64 exec, s[86:87], s[56:57]
    s_cbranch_execz NO_UP7
    buffer_load_dwordx2 v[30:31], v49, s[16:19], s67 offen offset:2432
NO_UP7:
    s_mov_b64 exec, -1
NO_UPPER:
    v_cmp_lt_u32 vcc, 32, v53
    v_mov_b32 v2, 86268
    v_mov_b32 v4, 1000
    s_mov_b64 exec, vcc
    ds_write_b32 v2, v4
    s_mov_b64 exec, -1
    s_waitcnt lgkmcnt(0)
    s_barrier
    ds_read_b32 v4, v54
    ds_read_b128 v[96:99], v50 offset:0
    ds_read_b128 v[100:103], v50 offset:1024
    ds_read_b128 v[104:107], v50 offset:2048
    ds_read_b128 v[108:111], v50 offset:3072
    ds_read_b128 v[112:115], v50 offset:4096
    ds_read_b128 v[116:119], v50 offset:5120
    ds_read_b128 v[120:123], v50 offset:6144
    ds_read_b128 v[124:127], v50 offset:7168
    ds_read_b128 v[128:131], v50 offset:8192
    ds_read_b128 v[132:135], v50 offset:9216
    ds_read_b128 v[136:139], v50 offset:10240
    ds_read_b128 v[140:143], v50 offset:11264
    ds_read_b128 v[144:147], v50 offset:12288
    ds_read_b128 v[148:151], v50 offset:13312
    ds_read_b128 v[152:155], v50 offset:14336
    ds_read_b128 v[156:159], v50 offset:15360
    ds_read_b128 v[160:163], v50 offset:16384
    ds_read_b128 v[164:167], v50 offset:17408
    ds_read_b128 v[168:171], v50 offset:18432
    ds_read_b128 v[172:175], v50 offset:19456
    v_cmp_gt_u32 s[68:69], 40, v1
    s_waitcnt lgkmcnt(15)
    v_cmp_lt_u32 vcc, 64, v4
    v_add_u32 v5, 15, v4
    v_lshrrev_b32 v5, 4, v5
    v_med3_u32 v5, v5, 1, 4
    v_mul_u32_u24 v6, 640, v5
    v_max_u32 v6, 1536, v6
    v_cndmask_b32 v6, 0, v6, s[68:69]
    s_cmp_lg_u64 vcc, 0
    s_cbranch_scc1 SLOW
    v_mov_b32 v7, v6
    v_add_u32 v2, 7, v4
    v_lshrrev_b32 v2, 3, v2
    v_add_u32_dpp v7, v7, v7 row_shr:1 row_mask:0xf bank_mask:0xf
    v_max_u32 v2, 2, v2
    v_cmp_eq_u32 vcc, 7, v2
    v_add_u32_dpp v7, v7, v7 row_shr:2 row_mask:0xf bank_mask:0xf
    v_lshlrev_b32 v5, 18, v5
    v_lshl_or_b32 v5, v1, 21, v5
    v_add_u32_dpp v7, v7, v7 row_shr:4 row_mask:0xf bank_mask:0xf
    v_addc_co_u32 v2, vcc, 0, v2, vcc
    v_lshl_or_b32 v5, v2, 28, v5
    v_add_u32_dpp v7, v7, v7 row_shr:8 row_mask:0xf bank_mask:0xf
    v_med3_u32 v2, v2, 3, 6
    v_cndmask_b32 v2, 0, v2, s[68:69]
    v_add_u32_dpp v7, v7, v7 row_bcast:15 row_mask:0xa bank_mask:0xf
    v_mov_b32 v48, 63
    s_mov_b32 s70, 0
    v_add_u32_dpp v7, v7, v7 row_bcast:31 row_mask:0xc bank_mask:0xf
    v_cmp_eq_u32 vcc, 6, v2
    v_readlane_b32 s66, v7, 63
    v_sub_u32 v7, v7, v6
    v_add_u32 v7, 87040, v7
    v_or_b32 v6, v5, v7
    s_cmp_gt_u32 s66, 76800
    s_cbranch_scc1 SLOW
    ds_bpermute_b32 v40, v40, v6
    ds_bpermute_b32 v41, v41, v6
    ds_bpermute_b32 v42, v42, v6
    ds_bpermute_b32 v43, v43, v6
    ds_bpermute_b32 v44, v44, v6
    ds_bpermute_b32 v45, v45, v6
    ds_bpermute_b32 v46, v46, v6
    ds_bpermute_b32 v47, v47, v6
    v_mbcnt_lo_u32_b32 v5, vcc_lo, 0
    v_mbcnt_hi_u32_b32 v5, vcc_hi, v5
    v_add_u32 v5, s70, v5
    v_cndmask_b32 v48, v48, v5, vcc
    s_bcnt1_i32_b64 s71, vcc
    v_cmp_eq_u32 vcc, 5, v2
    s_add_u32 s70, s70, s71
    s_nop 0
    v_mbcnt_lo_u32_b32 v5, vcc_lo, 0
    v_mbcnt_hi_u32_b32 v5, vcc_hi, v5
    v_add_u32 v5, s70, v5
    v_cndmask_b32 v48, v48, v5, vcc
    s_bcnt1_i32_b64 s71, vcc
    v_cmp_eq_u32 vcc, 4, v2
    s_add_u32 s70, s70, s71
    s_nop 0
    v_mbcnt_lo_u32_b32 v5, vcc_lo, 0
    v_mbcnt_hi_u32_b32 v5, vcc_hi, v5
    v_add_u32 v5, s70, v5
    v_cndmask_b32 v48, v48, v5, vcc
    s_bcnt1_i32_b64 s71, vcc
    v_cmp_eq_u32 vcc, 3, v2
    s_add_u32 s70, s70, s71
    s_nop 0
    v_mbcnt_lo_u32_b32 v5, vcc_lo, 0
    v_mbcnt_hi_u32_b32 v5, vcc_hi, v5
    v_add_u32 v5, s70, v5
    v_cndmask_b32 v48, v48, v5, vcc
    v_lshrrev_b32 v2, 3, v48
    v_and_b32 v3, 1, v2
    v_mul_u32_u24 v3, 7, v3
    v_xor_b32 v48, v48, v3
    v_and_b32 v3, 7, v48
    v_lshlrev_b32 v3, 13, v3
    v_mul_u32_u24 v2, 1536, v2
    v_lshlrev_b32 v4, 4, v1
    v_and_b32 v5, 128, v4
    v_add3_u32 v2, v2, v3, v5
    v_xor_b32 v3, v4, v7
    v_and_b32 v3, 128, v3
    v_add_u32 v3, v3, v7
    v_and_b32 v4, 0x70, v4
    v_or_b32 v5, v3, v4
    s_add_u32 s66, s20, 0
    v_cmp_eq_u32 vcc, s66, v48
    s_ff1_i32_b64 s67, vcc
    v_readlane_b32 s22, v6, s67
    v_readlane_b32 s28, v5, s67
    s_add_u32 s66, s20, 8
    v_cmp_eq_u32 vcc, s66, v48
    s_ff1_i32_b64 s67, vcc
    v_readlane_b32 s23, v6, s67
    v_readlane_b32 s29, v5, s67
    s_add_u32 s66, s20, 16
    v_cmp_eq_u32 vcc, s66, v48
    s_ff1_i32_b64 s67, vcc
    v_readlane_b32 s24, v6, s67
    v_readlane_b32 s30, v5, s67
    s_add_u32 s66, s20, 24
    v_cmp_eq_u32 vcc, s66, v48
    s_ff1_i32_b64 s67, vcc
    v_readlane_b32 s25, v6, s67
    v_readlane_b32 s31, v5, s67
    s_add_u32 s66, s20, 32
    v_cmp_eq_u32 vcc, s66, v48
    s_ff1_i32_b64 s67, vcc
    v_readlane_b32 s26, v6, s67
    v_readlane_b32 s32, v5, s67
    v_lshlrev_b32 v4, 3, v1
    v_add_u32 v4, 86528, v4
    s_mov_b32 exec_hi, 0xff
    ds_write_b64 v4, v[2:3]
    s_mov_b32 exec_hi, -1
    s_mov_b32 s27, s22
    s_mov_b32 s71, s22
    s_waitcnt vmcnt(0) lgkmcnt(0)
    v_and_b32 v2, 0x3ffff, v40
    v_bfe_u32 v3, v40, 18, 3
    v_lshlrev_b32 v4, 5, v8
    v_lshl_add_u32 v3, v3, 9, v2
    v_and_b32 v4, 0xffffe0, v4
    v_lshl_add_u32 v2, v32, 5, v2
    v_lshl_add_u32 v3, v32, 3, v3
    v_or_b32 v5, 16, v4
    s_mov_b64 exec, s[72:73]
    ds_write2_b32 v2, v4, v5 offset0:0 offset1:4
    ds_write_b64 v3, v[16:17]
    s_mov_b64 exec, -1
    v_and_b32 v2, 0x3ffff, v41
    v_bfe_u32 v3, v41, 18, 3
    v_lshlrev_b32 v4, 5, v9
    v_lshl_add_u32 v3, v3, 9, v2
    v_and_b32 v4, 0xffffe0, v4
    v_lshl_add_u32 v2, v33, 5, v2
    v_lshl_add_u32 v3, v33, 3, v3
    v_or_b32 v5, 16, v4
    s_mov_b64 exec, s[74:75]
    ds_write2_b32 v2, v4, v5 offset0:0 offset1:4
    ds_write_b64 v3, v[18:19]
    s_mov_b64 exec, -1
    v_and_b32 v2, 0x3ffff, v42
    v_bfe_u32 v3, v42, 18, 3
    v_lshlrev_b32 v4, 5, v10
    v_lshl_add_u32 v3, v3, 9, v2
    v_and_b32 v4, 0xffffe0, v4
    v_lshl_add_u32 v2, v34, 5, v2
    v_lshl_add_u32 v3, v34, 3, v3
    v_or_b32 v5, 16, v4
    s_mov_b64 exec, s[76:77]
    ds_write2_b32 v2, v4, v5 offset0:0 offset1:4
    ds_write_b64 v3, v[20:21]
    s_mov_b64 exec, -1
    v_and_b32 v2, 0x3ffff, v43
    v_bfe_u32 v3, v43, 18, 3
    v_lshlrev_b32 v4, 5, v11
    v_lshl_add_u32 v3, v3, 9, v2
    v_and_b32 v4, 0xffffe0, v4
    v_lshl_add_u32 v2, v35, 5, v2
    v_lshl_add_u32 v3, v35, 3, v3
    v_or_b32 v5, 16, v4
    s_mov_b64 exec, s[78:79]
    ds_write2_b32 v2, v4, v5 offset0:0 offset1:4
    ds_write_b64 v3, v[22:23]
    s_mov_b64 exec, -1
    v_and_b32 v2, 0x3ffff, v44
    v_bfe_u32 v3, v44, 18, 3
    v_lshlrev_b32 v4, 5, v12
    v_lshl_add_u32 v3, v3, 9, v2
    v_and_b32 v4, 0xffffe0, v4
    v_lshl_add_u32 v2, v36, 5, v2
    v_lshl_add_u32 v3, v36, 3, v3
    v_or_b32 v5, 16, v4
    s_mov_b64 exec, s[80:81]
    ds_write2_b32 v2, v4, v5 offset0:0 offset1:4
    ds_write_b64 v3, v[24:25]
    s_mov_b64 exec, -1
    v_and_b32 v2, 0x3ffff, v45
    v_bfe_u32 v3, v45, 18, 3
    v_lshlrev_b32 v4, 5, v13
    v_lshl_add_u32 v3, v3, 9, v2
    v_and_b32 v4, 0xffffe0, v4
    v_lshl_add_u32 v2, v37, 5, v2
    v_lshl_add_u32 v3, v37, 3, v3
    v_or_b32 v5, 16, v4
    s_mov_b64 exec, s[82:83]
    ds_write2_b32 v2, v4, v5 offset0:0 offset1:4
    ds_write_b64 v3, v[26:27]
    s_mov_b64 exec, -1
    v_and_b32 v2, 0x3ffff, v46
    v_bfe_u32 v3, v46, 18, 3
    v_lshlrev_b32 v4, 5, v14
    v_lshl_add_u32 v3, v3, 9, v2
    v_and_b32 v4, 0xffffe0, v4
    v_lshl_add_u32 v2, v38, 5, v2
    v_lshl_add_u32 v3, v38, 3, v3
    v_or_b32 v5, 16, v4
    s_mov_b64 exec, s[84:85]
    ds_write2_b32 v2, v4, v5 offset0:0 offset1:4
    ds_write_b64 v3, v[28:29]
    s_mov_b64 exec, -1
    v_and_b32 v2, 0x3ffff, v47
    v_bfe_u32 v3, v47, 18, 3
    v_lshlrev_b32 v4, 5, v15
    v_lshl_add_u32 v3, v3, 9, v2
    v_and_b32 v4, 0xffffe0, v4
    v_lshl_add_u32 v2, v39, 5, v2
    v_lshl_add_u32 v3, v39, 3, v3
    v_or_b32 v5, 16, v4
    s_mov_b64 exec, s[86:87]
    ds_write2_b32 v2, v4, v5 offset0:0 offset1:4
    ds_write_b64 v3, v[30:31]
    s_mov_b64 exec, -1
    s_bfe_u32 s46, s71, 0x30012
    s_mov_b32 m0, s46
    s_and_b32 s66, s71, 0x3ffff
    s_movrels_b32 s68, s57
    s_movrels_b32 s69, s61
    s_sub_u32 s48, s66, s47
    s_mov_b32 s47, s66
    s_lshr_b32 s52, s71, 28
    s_lshl_b32 s67, s46, 9
    s_add_u32 s66, s66, s67
    s_sub_u32 s49, s66, s42
    s_mov_b32 s42, s66
    s_bfe_u32 s66, s68, 655360
    s_add_u32 s43, s42, s66
    s_bfe_u32 s39, s69, 655360
    s_bfe_u32 s66, s68, 655370
    s_add_u32 s44, s42, s66
    s_bfe_u32 s40, s69, 655370
    s_bfe_u32 s66, s68, 655380
    s_add_u32 s45, s42, s66
    s_bfe_u32 s41, s69, 655380
    s_and_b32 s66, s46, s33
    s_cselect_b32 s72, -1, 1
    s_cselect_b32 s76, s47, 86912
    s_cmp_ge_u32 s66, 2
    s_cselect_b32 s73, -1, 0
    s_add_u32 s77, s47, 1024
    s_cmp_ge_u32 s66, 4
    s_cselect_b32 s75, -1, 0
    s_cmp_ge_u32 s66, 3
    s_cselect_b32 s74, -1, 1
    s_cselect_b32 s77, s77, 86912
    s_waitcnt lgkmcnt(0)
    s_barrier
    v_lshl_add_u32 v253, v248, 2, s47
    ds_read_b32 v254, v253
    ds_read_b32 v255, v253 offset:1024
    v_add_u32 v252, s42, v247
    ds_read_u16 v234, v252
    ds_read_u16 v235, v252 offset:64
    v_add_u32 v252, s43, v247
    ds_read_u16 v236, v252
    ds_read_u16 v237, v252 offset:64
    v_add_u32 v252, s44, v247
    ds_read_u16 v238, v252
    ds_read_u16 v239, v252 offset:64
    v_add_u32 v252, s45, v247
    ds_read_u16 v240, v252
    ds_read_u16 v241, v252 offset:64
    v_add_u32 v249, s48, v249
    v_add_u32 v250, s49, v250
    s_waitcnt lgkmcnt(8)
    s_mov_b32 m0, s76
    s_mov_b64 exec, s[72:73]
    buffer_load_dwordx4 v254, s[12:15], 0 offen  lds
    s_mov_b32 m0, s77
    s_mov_b64 exec, s[74:75]
    buffer_load_dwordx4 v255, s[12:15], 0 offen  lds
    s_mov_b64 exec, -1
    s_waitcnt lgkmcnt(0)
    s_add_u32 m0, s21, 0
    v_lshl_add_u32 v234, v234, 10, v246
    v_lshl_add_u32 v235, v235, 10, v246
    buffer_load_dwordx4 v234, s[4:7], s38 offen lds
    buffer_load_dwordx4 v235, s[8:11], s38 offen offset:1024 lds
    s_add_u32 m0, s21, 2048
    v_lshl_add_u32 v236, v236, 10, v246
    v_lshl_add_u32 v237, v237, 10, v246
    buffer_load_dwordx4 v236, s[4:7], s39 offen lds
    buffer_load_dwordx4 v237, s[8:11], s39 offen offset:1024 lds
    s_add_u32 m0, s21, 4096
    v_lshl_add_u32 v238, v238, 10, v246
    v_lshl_add_u32 v239, v239, 10, v246
    buffer_load_dwordx4 v238, s[4:7], s40 offen lds
    buffer_load_dwordx4 v239, s[8:11], s40 offen offset:1024 lds
    s_add_u32 m0, s21, 6144
    v_lshl_add_u32 v240, v240, 10, v246
    v_lshl_add_u32 v241, v241, 10, v246
    buffer_load_dwordx4 v240, s[4:7], s41 offen lds
    buffer_load_dwordx4 v241, s[8:11], s41 offen offset:1024 lds
    v_mov_b32 v252, 0
    s_waitcnt vmcnt(6)
    ds_read_b64_tr_b16 v[176:177], v244 offset:0
    ds_read_b64_tr_b16 v[178:179], v244 offset:1024
    ds_read_b64_tr_b16 v[180:181], v245 offset:0
    ds_read_b64_tr_b16 v[182:183], v245 offset:1024
    ds_read_b64_tr_b16 v[68:69], v249 offset:0
    ds_read_b64_tr_b16 v[70:71], v249 offset:256
    s_mov_b64 exec, s[54:55]
    ds_read_u16_d16_hi v242, v250 offset:0
    s_mov_b64 exec, -1
    s_waitcnt lgkmcnt(3)
    v_readfirstlane_b32 s66, v252
    s_add_u32 s53, s53, 1
    v_mov_b32 v252, s53
    s_cmp_le_u32 s53, s66
    ds_write2_b32 v251, v252, v252 offset0:0 offset1:8
    s_setprio 1
    s_cbranch_scc1 PRIO_1
    s_setprio 0
PRIO_1:
    s_cmp_eq_u32 s52, 4
    s_cbranch_scc1 ITEM_0_4
    s_cmp_eq_u32 s52, 5
    s_cbranch_scc1 ITEM_0_5
    s_cmp_eq_u32 s52, 3
    s_cbranch_scc1 ITEM_0_3
    s_cmp_eq_u32 s52, 6
    s_cbranch_scc1 ITEM_0_6
    s_cmp_eq_u32 s52, 8
    s_cbranch_scc1 ITEM_0_8
    s_branch ITEM_0_2
LAST0:
    s_cmp_eq_u32 s50, 5
    s_cbranch_scc1 TO_PHASE1
    s_add_u32 s4, s4, 128
    s_addc_u32 s5, s5, 0
    s_add_u32 s8, s8, 128
    s_addc_u32 s9, s9, 0
    s_mov_b32 s34, 0
    s_mov_b32 s35, 256
    s_mov_b32 s36, 512
    s_mov_b32 s37, 768
    s_mov_b32 s33, 0
    s_waitcnt lgkmcnt(3)
    v_readfirstlane_b32 s66, v252
    s_add_u32 s53, s53, 1
    v_mov_b32 v252, s53
    s_cmp_le_u32 s53, s66
    ds_write2_b32 v251, v252, v252 offset0:0 offset1:8
    s_setprio 1
    s_cbranch_scc1 PRIO_2
    s_setprio 0
PRIO_2:
    s_cmp_eq_u32 s52, 4
    s_cbranch_scc1 ITEM_0_4
    s_cmp_eq_u32 s52, 5
    s_cbranch_scc1 ITEM_0_5
    s_cmp_eq_u32 s52, 3
    s_cbranch_scc1 ITEM_0_3
    s_cmp_eq_u32 s52, 6
    s_cbranch_scc1 ITEM_0_6
    s_cmp_eq_u32 s52, 8
    s_cbranch_scc1 ITEM_0_8
    s_branch ITEM_0_2
TO_PHASE1:
    v_lshlrev_b32 v253, 2, v248
    v_add_u32 v253, 65536, v253
    ds_read_b128 v[96:99], v253 offset:0
    ds_read_b128 v[100:103], v253 offset:1024
    ds_read_b128 v[104:107], v253 offset:2048
    ds_read_b128 v[108:111], v253 offset:3072
    ds_read_b128 v[112:115], v253 offset:4096
    ds_read_b128 v[116:119], v253 offset:5120
    ds_read_b128 v[120:123], v253 offset:6144
    ds_read_b128 v[124:127], v253 offset:7168
    ds_read_b128 v[128:131], v253 offset:8192
    ds_read_b128 v[132:135], v253 offset:9216
    ds_read_b128 v[136:139], v253 offset:10240
    ds_read_b128 v[140:143], v253 offset:11264
    ds_read_b128 v[144:147], v253 offset:12288
    ds_read_b128 v[148:151], v253 offset:13312
    ds_read_b128 v[152:155], v253 offset:14336
    ds_read_b128 v[156:159], v253 offset:15360
    ds_read_b128 v[160:163], v253 offset:16384
    ds_read_b128 v[164:167], v253 offset:17408
    ds_read_b128 v[168:171], v253 offset:18432
    ds_read_b128 v[172:175], v253 offset:19456
    s_mov_b32 s34, 128
    s_mov_b32 s35, 384
    s_mov_b32 s36, 640
    s_mov_b32 s37, 896
    s_mov_b32 s50, 0
    s_waitcnt lgkmcnt(0)
    s_waitcnt lgkmcnt(0)
    v_readfirstlane_b32 s66, v252
    s_add_u32 s53, s53, 1
    v_mov_b32 v252, s53
    s_cmp_le_u32 s53, s66
    ds_write2_b32 v251, v252, v252 offset0:0 offset1:8
    s_setprio 1
    s_cbranch_scc1 PRIO_3
    s_setprio 0
PRIO_3:
    s_cmp_eq_u32 s52, 4
    s_cbranch_scc1 ITEM_1_4
    s_cmp_eq_u32 s52, 5
    s_cbranch_scc1 ITEM_1_5
    s_cmp_eq_u32 s52, 3
    s_cbranch_scc1 ITEM_1_3
    s_cmp_eq_u32 s52, 6
    s_cbranch_scc1 ITEM_1_6
    s_cmp_eq_u32 s52, 8
    s_cbranch_scc1 ITEM_1_8
    s_branch ITEM_1_2
.p2align 6
ITEM_0_4:
    s_mov_b64 exec, s[54:55]
    ds_read_u16_d16_hi v243, v250 offset:128
    s_mov_b64 exec, -1
    ds_read_b64_tr_b16 v[76:77], v249 offset:512
    ds_read_b64_tr_b16 v[78:79], v249 offset:768
    s_waitcnt lgkmcnt(3)
    v_lshlrev_b32 v196, 16, v68
    v_and_b32 v197, 0xffff0000, v68
    v_lshlrev_b32 v198, 16, v69
    v_and_b32 v199, 0xffff0000, v69
    v_mul_f32_dpp v200, v242, v196 row_newbcast:0 row_mask:0xf bank_mask:0xf
    v_mul_f32_dpp v201, v242, v197 row_newbcast:1 row_mask:0xf bank_mask:0xf
    v_mul_f32_dpp v202, v242, v196 row_newbcast:8 row_mask:0xf bank_mask:0xf
    v_mul_f32_dpp v203, v242, v197 row_newbcast:9 row_mask:0xf bank_mask:0xf
    v_lshlrev_b32 v196, 16, v70
    v_and_b32 v197, 0xffff0000, v70
    v_cvt_pk_bf16_f32 v64, v200, v201
    v_cvt_pk_bf16_f32 v68, v202, v203
    v_mul_f32_dpp v200, v242, v198 row_newbcast:2 row_mask:0xf bank_mask:0xf
    v_mul_f32_dpp v201, v242, v199 row_newbcast:3 row_mask:0xf bank_mask:0xf
    v_mul_f32_dpp v202, v242, v198 row_newbcast:10 row_mask:0xf bank_mask:0xf
    v_mul_f32_dpp v203, v242, v199 row_newbcast:11 row_mask:0xf bank_mask:0xf
    v_lshlrev_b32 v198, 16, v71
    v_and_b32 v199, 0xffff0000, v71
    v_cvt_pk_bf16_f32 v65, v200, v201
    v_cvt_pk_bf16_f32 v69, v202, v203
    v_mul_f32_dpp v200, v242, v196 row_newbcast:4 row_mask:0xf bank_mask:0xf
    v_mul_f32_dpp v201, v242, v197 row_newbcast:5 row_mask:0xf bank_mask:0xf
    v_mul_f32_dpp v202, v242, v196 row_newbcast:12 row_mask:0xf bank_mask:0xf
    v_mul_f32_dpp v203, v242, v197 row_newbcast:13 row_mask:0xf bank_mask:0xf
    v_cvt_pk_bf16_f32 v66, v200, v201
    v_cvt_pk_bf16_f32 v70, v202, v203
    v_mul_f32_dpp v200, v242, v198 row_newbcast:6 row_mask:0xf bank_mask:0xf
    v_mul_f32_dpp v201, v242, v199 row_newbcast:7 row_mask:0xf bank_mask:0xf
    v_mul_f32_dpp v202, v242, v198 row_newbcast:14 row_mask:0xf bank_mask:0xf
    v_mul_f32_dpp v203, v242, v199 row_newbcast:15 row_mask:0xf bank_mask:0xf
    v_cvt_pk_bf16_f32 v67, v200, v201
    v_cvt_pk_bf16_f32 v71, v202, v203
    s_nop 0
    s_waitcnt vmcnt(4) lgkmcnt(0)
    v_mfma_f32_32x32x16_bf16 v[0:15], v[64:67], v[176:179], 0
    v_lshlrev_b32 v196, 16, v76
    v_and_b32 v197, 0xffff0000, v76
    v_lshlrev_b32 v198, 16, v77
    v_and_b32 v199, 0xffff0000, v77
    v_mul_f32_dpp v200, v243, v196 row_newbcast:0 row_mask:0xf bank_mask:0xf
    v_mul_f32_dpp v201, v243, v197 row_newbcast:1 row_mask:0xf bank_mask:0xf
    v_mul_f32_dpp v202, v243, v196 row_newbcast:8 row_mask:0xf bank_mask:0xf
    v_mul_f32_dpp v203, v243, v197 row_newbcast:9 row_mask:0xf bank_mask:0xf
    v_lshlrev_b32 v196, 16, v78
    v_and_b32 v197, 0xffff0000, v78
    v_cvt_pk_bf16_f32 v72, v200, v201
    v_cvt_pk_bf16_f32 v76, v202, v203
    v_mul_f32_dpp v200, v243, v198 row_newbcast:2 row_mask:0xf bank_mask:0xf
    v_mul_f32_dpp v201, v243, v199 row_newbcast:3 row_mask:0xf bank_mask:0xf
    v_mul_f32_dpp v202, v243, v198 row_newbcast:10 row_mask:0xf bank_mask:0xf
    v_mul_f32_dpp v203, v243, v199 row_newbcast:11 row_mask:0xf bank_mask:0xf
    s_add_u32 m0, s21, 0
    v_mfma_f32_32x32x16_bf16 v[16:31], v[68:71], v[176:179], 0
    buffer_load_dwordx4 v234, s[4:7], s36 offen lds
    buffer_load_dwordx4 v235, s[8:11], s36 offen offset:1024 lds
    ds_read_b64_tr_b16 v[176:177], v244 offset:2048
    ds_read_b64_tr_b16 v[178:179], v244 offset:3072
    ds_read_b64_tr_b16 v[184:185], v245 offset:2048
    ds_read_b64_tr_b16 v[186:187], v245 offset:3072
    v_lshlrev_b32 v198, 16, v79
    v_and_b32 v199, 0xffff0000, v79
    v_cvt_pk_bf16_f32 v73, v200, v201
    v_cvt_pk_bf16_f32 v77, v202, v203
    v_mul_f32_dpp v200, v243, v196 row_newbcast:4 row_mask:0xf bank_mask:0xf
    v_mul_f32_dpp v201, v243, v197 row_newbcast:5 row_mask:0xf bank_mask:0xf
    v_mul_f32_dpp v202, v243, v196 row_newbcast:12 row_mask:0xf bank_mask:0xf
    v_mul_f32_dpp v203, v243, v197 row_newbcast:13 row_mask:0xf bank_mask:0xf
    v_cvt_pk_bf16_f32 v74, v200, v201
    v_cvt_pk_bf16_f32 v78, v202, v203
    v_mul_f32_dpp v200, v243, v198 row_newbcast:6 row_mask:0xf bank_mask:0xf
    v_mul_f32_dpp v201, v243, v199 row_newbcast:7 row_mask:0xf bank_mask:0xf
    v_mul_f32_dpp v202, v243, v198 row_newbcast:14 row_mask:0xf bank_mask:0xf
    v_mul_f32_dpp v203, v243, v199 row_newbcast:15 row_mask:0xf bank_mask:0xf
    v_cvt_pk_bf16_f32 v75, v200, v201
    v_cvt_pk_bf16_f32 v79, v202, v203
    s_nop 0
    s_waitcnt lgkmcnt(0)
    v_mfma_f32_32x32x16_bf16 v[0:15], v[72:75], v[176:179], v[0:15]
    s_add_u32 m0, s21, 2048
    v_mfma_f32_32x32x16_bf16 v[16:31], v[76:79], v[176:179], v[16:31]
    buffer_load_dwordx4 v236, s[4:7], s36 offen lds
    buffer_load_dwordx4 v237, s[8:11], s36 offen offset:1024 lds
    s_mov_b32 m0, s50
    s_nop 0
    s_movrels_b32 s71, s23
    s_bfe_u32 s46, s71, 0x30012
    s_mov_b32 m0, s46
    s_and_b32 s66, s71, 0x3ffff
    s_movrels_b32 s68, s57
    s_movrels_b32 s69, s61
    s_sub_u32 s48, s66, s47
    s_mov_b32 s47, s66
    s_lshr_b32 s52, s71, 28
    s_lshl_b32 s67, s46, 9
    s_add_u32 s66, s66, s67
    s_sub_u32 s49, s66, s42
    s_mov_b32 s42, s66
    s_bfe_u32 s66, s68, 655360
    s_add_u32 s43, s42, s66
    s_bfe_u32 s39, s69, 655360
    s_bfe_u32 s66, s68, 655370
    s_add_u32 s44, s42, s66
    s_bfe_u32 s40, s69, 655370
    s_bfe_u32 s66, s68, 655380
    s_add_u32 s45, s42, s66
    s_bfe_u32 s41, s69, 655380
    s_and_b32 s66, s46, s33
    s_cselect_b32 s72, -1, 1
    s_cselect_b32 s76, s47, 86912
    s_cmp_ge_u32 s66, 2
    s_cselect_b32 s73, -1, 0
    s_add_u32 s77, s47, 1024
    s_cmp_ge_u32 s66, 4
    s_cselect_b32 s75, -1, 0
    s_cmp_ge_u32 s66, 3
    s_cselect_b32 s74, -1, 1
    s_cselect_b32 s77, s77, 86912
    v_add_u32 v252, s44, v247
    ds_read_u16 v238, v252
    ds_read_u16 v239, v252 offset:64
    v_add_u32 v252, s45, v247
    ds_read_u16 v240, v252
    ds_read_u16 v241, v252 offset:64
    v_mfma_f32_32x32x16_bf16 v[32:47], v[64:67], v[180:183], 0
    v_mul_f32 v196, v0, v96
    v_fmac_f32 v196, v1, v97
    v_fmac_f32 v196, v2, v98
    v_fmac_f32 v196, v3, v99
    v_fmac_f32 v196, v4, v100
    v_fmac_f32 v196, v5, v101
    v_fmac_f32 v196, v6, v102
    v_fmac_f32 v196, v7, v103
    v_mul_f32 v198, v8, v128
    v_fmac_f32 v198, v9, v129
    v_mfma_f32_32x32x16_bf16 v[48:63], v[68:71], v[180:183], 0
    v_lshl_add_u32 v253, v248, 2, s47
    ds_read_b32 v254, v253
    ds_read_b32 v255, v253 offset:1024
    s_waitcnt vmcnt(6)
    ds_read_b64_tr_b16 v[176:177], v244 offset:4096
    ds_read_b64_tr_b16 v[178:179], v244 offset:5120
    ds_read_b64_tr_b16 v[180:181], v245 offset:4096
    ds_read_b64_tr_b16 v[182:183], v245 offset:5120
    v_fmac_f32 v198, v10, v130
    v_fmac_f32 v198, v11, v131
    v_fmac_f32 v198, v12, v132
    v_fmac_f32 v198, v13, v133
    v_fmac_f32 v198, v14, v134
    v_fmac_f32 v198, v15, v135
    v_mul_f32 v200, v16, v128
    v_fmac_f32 v200, v17, v129
    v_permlane32_swap_b32 v196, v198
    v_mfma_f32_32x32x16_bf16 v[32:47], v[72:75], v[184:187], v[32:47]
    v_fmac_f32 v200, v18, v130
    v_fmac_f32 v200, v19, v131
    v_fmac_f32 v200, v20, v132
    v_fmac_f32 v200, v21, v133
    v_fmac_f32 v200, v22, v134
    v_fmac_f32 v200, v23, v135
    v_add_f32 v198, v196, v198
    v_mul_f32_e64 v202, v24, -v128
    v_fma_f32 v202, v25, -v129, v202
    v_mfma_f32_32x32x16_bf16 v[48:63], v[76:79], v[184:187], v[48:63]
    v_fma_f32 v202, v26, -v130, v202
    v_fma_f32 v202, v27, -v131, v202
    v_fma_f32 v202, v28, -v132, v202
    v_fma_f32 v202, v29, -v133, v202
    v_fma_f32 v202, v30, -v134, v202
    v_fma_f32 v202, v31, -v135, v202
    s_nop 1
    v_permlane32_swap_b32 v200, v202
    v_add_f32 v202, v200, v202
    s_waitcnt vmcnt(4) lgkmcnt(0)
    v_mfma_f32_32x32x16_bf16 v[0:15], v[64:67], v[176:179], 0
    v_mul_f32 v197, v32, v104
    v_fmac_f32 v197, v33, v105
    v_fmac_f32 v197, v34, v106
    v_fmac_f32 v197, v35, v107
    v_fmac_f32 v197, v36, v108
    v_fmac_f32 v197, v37, v109
    v_fmac_f32 v197, v38, v110
    v_fmac_f32 v197, v39, v111
    v_mul_f32 v199, v40, v136
    v_fmac_f32 v199, v41, v137
    v_fmac_f32 v199, v42, v138
    s_add_u32 m0, s21, 4096
    v_mfma_f32_32x32x16_bf16 v[16:31], v[68:71], v[176:179], 0
    buffer_load_dwordx4 v234, s[4:7], s37 offen lds
    buffer_load_dwordx4 v235, s[8:11], s37 offen offset:1024 lds
    ds_read_b64_tr_b16 v[176:177], v244 offset:6144
    ds_read_b64_tr_b16 v[178:179], v244 offset:7168
    ds_read_b64_tr_b16 v[184:185], v245 offset:6144
    ds_read_b64_tr_b16 v[186:187], v245 offset:7168
    v_add_u32 v252, s42, v247
    ds_read_u16 v234, v252
    ds_read_u16 v235, v252 offset:64
    s_mov_b32 m0, s76
    s_mov_b64 exec, s[72:73]
    buffer_load_dwordx4 v254, s[12:15], 0 offen  lds
    s_mov_b32 m0, s77
    s_mov_b64 exec, s[74:75]
    buffer_load_dwordx4 v255, s[12:15], 0 offen  lds
    s_mov_b64 exec, -1
    v_fmac_f32 v199, v43, v139
    v_fmac_f32 v199, v44, v140
    v_fmac_f32 v199, v45, v141
    v_fmac_f32 v199, v46, v142
    v_fmac_f32 v199, v47, v143
    v_mul_f32 v201, v48, v136
    v_fmac_f32 v201, v49, v137
    v_permlane32_swap_b32 v197, v199
    v_fmac_f32 v201, v50, v138
    v_fmac_f32 v201, v51, v139
    s_waitcnt lgkmcnt(2)
    v_mfma_f32_32x32x16_bf16 v[0:15], v[72:75], v[176:179], v[0:15]
    v_fmac_f32 v201, v52, v140
    v_fmac_f32 v201, v53, v141
    v_fmac_f32 v201, v54, v142
    v_fmac_f32 v201, v55, v143
    v_add_f32 v199, v197, v199
    v_mul_f32_e64 v203, v56, -v136
    v_fma_f32 v203, v57, -v137, v203
    v_fma_f32 v203, v58, -v138, v203
    v_fma_f32 v203, v59, -v139, v203
    v_fma_f32 v203, v60, -v140, v203
    v_fma_f32 v203, v61, -v141, v203
    s_add_u32 m0, s21, 6144
    v_mfma_f32_32x32x16_bf16 v[16:31], v[76:79], v[176:179], v[16:31]
    buffer_load_dwordx4 v236, s[4:7], s37 offen lds
    buffer_load_dwordx4 v237, s[8:11], s37 offen offset:1024 lds
    v_add_u32 v252, s43, v247
    ds_read_u16 v236, v252
    ds_read_u16 v237, v252 offset:64
    v_fma_f32 v203, v62, -v142, v203
    v_fma_f32 v203, v63, -v143, v203
    s_nop 1
    v_permlane32_swap_b32 v201, v203
    v_add_f32 v203, v201, v203
    s_set_gpr_idx_on s51, gpr_idx(DST)
    s_nop 0
    v_cvt_pk_bf16_f32 v204, v198, v199
    v_cvt_pk_bf16_f32 v205, v202, v203
    s_set_gpr_idx_off
    v_mfma_f32_32x32x16_bf16 v[32:47], v[64:67], v[180:183], 0
    v_mul_f32 v196, v0, v144
    v_fmac_f32 v196, v1, v145
    v_fmac_f32 v196, v2, v146
    v_fmac_f32 v196, v3, v147
    v_fmac_f32 v196, v4, v148
    v_fmac_f32 v196, v5, v149
    v_fmac_f32 v196, v6, v150
    v_fmac_f32 v196, v7, v151
    v_mfma_f32_32x32x16_bf16 v[48:63], v[68:71], v[180:183], 0
    s_waitcnt vmcnt(8)
    ds_read_b64_tr_b16 v[176:177], v244 offset:0
    ds_read_b64_tr_b16 v[178:179], v244 offset:1024
    ds_read_b64_tr_b16 v[180:181], v245 offset:0
    ds_read_b64_tr_b16 v[182:183], v245 offset:1024
    v_mul_f32 v198, v8, v112
    v_fmac_f32 v198, v9, v113
    v_fmac_f32 v198, v10, v114
    v_fmac_f32 v198, v11, v115
    v_fmac_f32 v198, v12, v116
    v_fmac_f32 v198, v13, v117
    v_fmac_f32 v198, v14, v118
    v_fmac_f32 v198, v15, v119
    v_mfma_f32_32x32x16_bf16 v[32:47], v[72:75], v[184:187], v[32:47]
    v_mul_f32_e64 v200, v16, -v160
    v_fma_f32 v200, v17, -v161, v200
    v_fma_f32 v200, v18, -v162, v200
    v_fma_f32 v200, v19, -v163, v200
    v_fma_f32 v200, v20, -v164, v200
    v_fma_f32 v200, v21, -v165, v200
    v_fma_f32 v200, v22, -v166, v200
    v_fma_f32 v200, v23, -v167, v200
    v_mfma_f32_32x32x16_bf16 v[48:63], v[76:79], v[184:187], v[48:63]
    v_mul_f32_e64 v202, v24, -v160
    v_fma_f32 v202, v25, -v161, v202
    v_fma_f32 v202, v26, -v162, v202
    v_fma_f32 v202, v27, -v163, v202
    v_fma_f32 v202, v28, -v164, v202
    v_fma_f32 v202, v29, -v165, v202
    v_fma_f32 v202, v30, -v166, v202
    v_fma_f32 v202, v31, -v167, v202
    s_waitcnt vmcnt(6) lgkmcnt(0)
    v_mfma_f32_32x32x16_bf16 v[0:15], v[64:67], v[176:179], 0
    v_mul_f32 v197, v32, v152
    v_fmac_f32 v197, v33, v153
    v_fmac_f32 v197, v34, v154
    v_fmac_f32 v197, v35, v155
    v_fmac_f32 v197, v36, v156
    v_fmac_f32 v197, v37, v157
    v_fmac_f32 v197, v38, v158
    v_fmac_f32 v197, v39, v159
    s_add_u32 m0, s21, 0
    v_mfma_f32_32x32x16_bf16 v[16:31], v[68:71], v[176:179], 0
    v_lshl_add_u32 v234, v234, 10, v246
    v_lshl_add_u32 v235, v235, 10, v246
    buffer_load_dwordx4 v234, s[4:7], s38 offen lds
    buffer_load_dwordx4 v235, s[8:11], s38 offen offset:1024 lds
    ds_read_b64_tr_b16 v[176:177], v244 offset:2048
    ds_read_b64_tr_b16 v[178:179], v244 offset:3072
    ds_read_b64_tr_b16 v[184:185], v245 offset:2048
    ds_read_b64_tr_b16 v[186:187], v245 offset:3072
    v_mul_f32 v199, v40, v120
    v_fmac_f32 v199, v41, v121
    v_fmac_f32 v199, v42, v122
    v_fmac_f32 v199, v43, v123
    v_fmac_f32 v199, v44, v124
    v_fmac_f32 v199, v45, v125
    v_fmac_f32 v199, v46, v126
    v_fmac_f32 v199, v47, v127
    s_waitcnt lgkmcnt(0)
    v_mfma_f32_32x32x16_bf16 v[0:15], v[72:75], v[176:179], v[0:15]
    v_mul_f32_e64 v201, v48, -v168
    v_fma_f32 v201, v49, -v169, v201
    v_fma_f32 v201, v50, -v170, v201
    v_fma_f32 v201, v51, -v171, v201
    v_fma_f32 v201, v52, -v172, v201
    v_fma_f32 v201, v53, -v173, v201
    v_fma_f32 v201, v54, -v174, v201
    v_fma_f32 v201, v55, -v175, v201
    s_add_u32 m0, s21, 2048
    v_mfma_f32_32x32x16_bf16 v[16:31], v[76:79], v[176:179], v[16:31]
    v_lshl_add_u32 v236, v236, 10, v246
    v_lshl_add_u32 v237, v237, 10, v246
    buffer_load_dwordx4 v236, s[4:7], s39 offen lds
    buffer_load_dwordx4 v237, s[8:11], s39 offen offset:1024 lds
    v_mul_f32_e64 v203, v56, -v168
    v_fma_f32 v203, v57, -v169, v203
    v_fma_f32 v203, v58, -v170, v203
    v_fma_f32 v203, v59, -v171, v203
    v_fma_f32 v203, v60, -v172, v203
    v_fma_f32 v203, v61, -v173, v203
    v_fma_f32 v203, v62, -v174, v203
    v_fma_f32 v203, v63, -v175, v203
    v_mfma_f32_32x32x16_bf16 v[32:47], v[64:67], v[180:183], 0
    v_mul_f32 v254, v0, v144
    v_fmac_f32 v254, v1, v145
    v_fmac_f32 v254, v2, v146
    v_fmac_f32 v254, v3, v147
    v_fmac_f32 v254, v4, v148
    v_mfma_f32_32x32x16_bf16 v[48:63], v[68:71], v[180:183], 0
    ds_swizzle_b32 v68, v68 offset:0x401F
    ds_swizzle_b32 v69, v69 offset:0x401F
    ds_swizzle_b32 v70, v70 offset:0x401F
    ds_swizzle_b32 v71, v71 offset:0x401F
    s_waitcnt vmcnt(8)
    ds_read_b64_tr_b16 v[176:177], v244 offset:4096
    ds_read_b64_tr_b16 v[178:179], v244 offset:5120
    ds_read_b64_tr_b16 v[180:181], v245 offset:4096
    ds_read_b64_tr_b16 v[182:183], v245 offset:5120
    v_fmac_f32 v254, v5, v149
    v_fmac_f32 v254, v6, v150
    v_fmac_f32 v254, v7, v151
    v_fmac_f32 v200, v8, v160
    v_mfma_f32_32x32x16_bf16 v[32:47], v[72:75], v[184:187], v[32:47]
    v_fmac_f32 v200, v9, v161
    v_permlane32_swap_b32 v196, v254
    v_fmac_f32 v200, v10, v162
    v_fmac_f32 v200, v11, v163
    v_fmac_f32 v200, v12, v164
    v_mfma_f32_32x32x16_bf16 v[48:63], v[76:79], v[184:187], v[48:63]
    ds_swizzle_b32 v76, v76 offset:0x401F
    ds_swizzle_b32 v77, v77 offset:0x401F
    ds_swizzle_b32 v78, v78 offset:0x401F
    ds_swizzle_b32 v79, v79 offset:0x401F
    v_fmac_f32 v200, v13, v165
    v_fmac_f32 v200, v14, v166
    v_fmac_f32 v200, v15, v167
    v_add_f32 v254, v196, v254
    s_waitcnt lgkmcnt(8)
    s_mov_b64 exec, s[56:57]
    v_xor_b32 v68, 0x80008000, v68
    v_xor_b32 v69, 0x80008000, v69
    v_xor_b32 v70, 0x80008000, v70
    v_xor_b32 v71, 0x80008000, v71
    s_mov_b64 exec, -1
    s_waitcnt vmcnt(4) lgkmcnt(4)
    v_mfma_f32_32x32x16_bf16 v[0:15], v[64:67], v[176:179], 0
    v_mul_f32 v255, v32, v152
    v_fmac_f32 v255, v33, v153
    v_fmac_f32 v255, v34, v154
    v_fmac_f32 v255, v35, v155
    v_fmac_f32 v255, v36, v156
    v_fmac_f32 v255, v37, v157
    s_add_u32 m0, s21, 4096
    v_mfma_f32_32x32x16_bf16 v[16:31], v[68:71], v[176:179], v[16:31]
    v_lshl_add_u32 v238, v238, 10, v246
    v_lshl_add_u32 v239, v239, 10, v246
    buffer_load_dwordx4 v238, s[4:7], s40 offen lds
    buffer_load_dwordx4 v239, s[8:11], s40 offen offset:1024 lds
    ds_read_b64_tr_b16 v[176:177], v244 offset:6144
    ds_read_b64_tr_b16 v[178:179], v244 offset:7168
    ds_read_b64_tr_b16 v[184:185], v245 offset:6144
    ds_read_b64_tr_b16 v[186:187], v245 offset:7168
    v_fmac_f32 v255, v38, v158
    v_fmac_f32 v255, v39, v159
    v_fmac_f32 v201, v40, v168
    v_fmac_f32 v201, v41, v169
    v_permlane32_swap_b32 v197, v255
    s_waitcnt lgkmcnt(0)
    s_mov_b64 exec, s[56:57]
    v_xor_b32 v76, 0x80008000, v76
    v_xor_b32 v77, 0x80008000, v77
    v_xor_b32 v78, 0x80008000, v78
    v_xor_b32 v79, 0x80008000, v79
    s_mov_b64 exec, -1
    v_mfma_f32_32x32x16_bf16 v[0:15], v[72:75], v[176:179], v[0:15]
    v_fmac_f32 v201, v42, v170
    v_fmac_f32 v201, v43, v171
    v_fmac_f32 v201, v44, v172
    v_fmac_f32 v201, v45, v173
    v_fmac_f32 v201, v46, v174
    v_fmac_f32 v201, v47, v175
    s_add_u32 m0, s21, 6144
    v_mfma_f32_32x32x16_bf16 v[16:31], v[76:79], v[176:179], v[16:31]
    v_lshl_add_u32 v240, v240, 10, v246
    v_lshl_add_u32 v241, v241, 10, v246
    buffer_load_dwordx4 v240, s[4:7], s41 offen lds
    buffer_load_dwordx4 v241, s[8:11], s41 offen offset:1024 lds
    v_add_f32 v255, v197, v255
    s_set_gpr_idx_on s51, gpr_idx(DST)
    s_nop 0
    v_cvt_pk_bf16_f32 v206, v254, v255
    s_set_gpr_idx_off
    v_mfma_f32_32x32x16_bf16 v[32:47], v[64:67], v[180:183], 0
    v_mul_f32 v254, v0, v144
    v_fmac_f32 v254, v1, v145
    v_fmac_f32 v254, v2, v146
    v_fmac_f32 v254, v3, v147
    v_fmac_f32 v254, v4, v148
    v_fmac_f32 v254, v5, v149
    v_fmac_f32 v254, v6, v150
    v_fmac_f32 v254, v7, v151
    v_fma_f32 v202, v8, -v160, v202
    v_fma_f32 v202, v9, -v161, v202
    v_mfma_f32_32x32x16_bf16 v[48:63], v[68:71], v[180:183], v[48:63]
    s_waitcnt vmcnt(6)
    ds_read_b64_tr_b16 v[176:177], v244 offset:0
    ds_read_b64_tr_b16 v[178:179], v244 offset:1024
    ds_read_b64_tr_b16 v[180:181], v245 offset:0
    ds_read_b64_tr_b16 v[182:183], v245 offset:1024
    v_permlane32_swap_b32 v254, v200
    v_fma_f32 v202, v10, -v162, v202
    v_fma_f32 v202, v11, -v163, v202
    v_fma_f32 v202, v12, -v164, v202
    v_fma_f32 v202, v13, -v165, v202
    v_fma_f32 v202, v14, -v166, v202
    v_fma_f32 v202, v15, -v167, v202
    v_add_f32 v200, v254, v200
    v_fmac_f32 v198, v16, v112
    v_permlane32_swap_b32 v202, v254
    v_mfma_f32_32x32x16_bf16 v[32:47], v[72:75], v[184:187], v[32:47]
    v_fmac_f32 v198, v17, v113
    v_fmac_f32 v198, v18, v114
    v_fmac_f32 v198, v19, v115
    v_fmac_f32 v198, v20, v116
    v_fmac_f32 v198, v21, v117
    v_fmac_f32 v198, v22, v118
    v_fmac_f32 v198, v23, v119
    v_add_f32 v254, v202, v254
    v_mul_f32 v196, v24, v160
    v_fmac_f32 v196, v25, v161
    v_mfma_f32_32x32x16_bf16 v[48:63], v[76:79], v[184:187], v[48:63]
    v_add_u32 v249, s48, v249
    v_add_u32 v250, s49, v250
    ds_read_b32 v252, v251 offset:16
    ds_read_b64_tr_b16 v[68:69], v249 offset:0
    ds_read_b64_tr_b16 v[70:71], v249 offset:256
    s_mov_b64 exec, s[54:55]
    ds_read_u16_d16_hi v242, v250 offset:0
    s_mov_b64 exec, -1
    v_fmac_f32 v196, v26, v162
    v_fmac_f32 v196, v27, v163
    v_fmac_f32 v196, v28, v164
    v_fmac_f32 v196, v29, v165
    v_fmac_f32 v196, v30, v166
    v_fmac_f32 v196, v31, v167
    s_nop 1
    v_permlane32_swap_b32 v198, v196
    v_add_f32 v196, v198, v196
    v_mul_f32 v255, v32, v152
    v_fmac_f32 v255, v33, v153
    v_fmac_f32 v255, v34, v154
    v_fmac_f32 v255, v35, v155
    v_fmac_f32 v255, v36, v156
    v_fmac_f32 v255, v37, v157
    v_fmac_f32 v255, v38, v158
    v_fmac_f32 v255, v39, v159
    v_fma_f32 v203, v40, -v168, v203
    v_fma_f32 v203, v41, -v169, v203
    v_permlane32_swap_b32 v255, v201
    v_fma_f32 v203, v42, -v170, v203
    v_fma_f32 v203, v43, -v171, v203
    v_fma_f32 v203, v44, -v172, v203
    v_fma_f32 v203, v45, -v173, v203
    v_fma_f32 v203, v46, -v174, v203
    v_fma_f32 v203, v47, -v175, v203
    v_add_f32 v201, v255, v201
    v_fmac_f32 v199, v48, v120
    v_permlane32_swap_b32 v203, v255
    v_fmac_f32 v199, v49, v121
    v_fmac_f32 v199, v50, v122
    v_fmac_f32 v199, v51, v123
    v_fmac_f32 v199, v52, v124
    v_fmac_f32 v199, v53, v125
    v_fmac_f32 v199, v54, v126
    v_fmac_f32 v199, v55, v127
    v_add_f32 v255, v203, v255
    v_mul_f32 v197, v56, v168
    v_fmac_f32 v197, v57, v169
    v_fmac_f32 v197, v58, v170
    v_fmac_f32 v197, v59, v171
    v_fmac_f32 v197, v60, v172
    v_fmac_f32 v197, v61, v173
    v_fmac_f32 v197, v62, v174
    v_fmac_f32 v197, v63, v175
    s_nop 1
    v_permlane32_swap_b32 v199, v197
    v_add_f32 v197, v199, v197
    s_set_gpr_idx_on s51, gpr_idx(DST)
    s_nop 0
    v_cvt_pk_bf16_f32 v207, v200, v201
    v_cvt_pk_bf16_f32 v209, v254, v255
    v_cvt_pk_bf16_f32 v208, v196, v197
    s_set_gpr_idx_off
    s_add_u32 s50, s50, 1
    s_add_u32 s51, s51, 6
    s_cmp_ge_u32 s50, 4
    s_cbranch_scc1 LAST0
    s_waitcnt lgkmcnt(3)
    v_readfirstlane_b32 s66, v252
    s_add_u32 s53, s53, 1
    v_mov_b32 v252, s53
    s_cmp_le_u32 s53, s66
    ds_write2_b32 v251, v252, v252 offset0:0 offset1:8
    s_setprio 1
    s_cbranch_scc1 PRIO_4
    s_setprio 0
PRIO_4:
    s_cmp_eq_u32 s52, 4
    s_cbranch_scc1 ITEM_0_4
    s_cmp_eq_u32 s52, 5
    s_cbranch_scc1 ITEM_0_5
    s_cmp_eq_u32 s52, 3
    s_cbranch_scc1 ITEM_0_3
    s_cmp_eq_u32 s52, 6
    s_cbranch_scc1 ITEM_0_6
    s_cmp_eq_u32 s52, 8
    s_cbranch_scc1 ITEM_0_8
    s_branch ITEM_0_2
.p2align 6
ITEM_0_5:
    s_mov_b64 exec, s[54:55]
    ds_read_u16_d16_hi v243, v250 offset:128
    s_mov_b64 exec, -1
    ds_read_b64_tr_b16 v[76:77], v249 offset:512
    ds_read_b64_tr_b16 v[78:79], v249 offset:768
    ds_read_b64_tr_b16 v[84:85], v249 offset:1024
    s_waitcnt lgkmcnt(4)
    v_lshlrev_b32 v196, 16, v68
    v_and_b32 v197, 0xffff0000, v68
    v_lshlrev_b32 v198, 16, v69
    v_and_b32 v199, 0xffff0000, v69
    v_mul_f32_dpp v200, v242, v196 row_newbcast:0 row_mask:0xf bank_mask:0xf
    v_mul_f32_dpp v201, v242, v197 row_newbcast:1 row_mask:0xf bank_mask:0xf
    v_mul_f32_dpp v202, v242, v196 row_newbcast:8 row_mask:0xf bank_mask:0xf
    v_mul_f32_dpp v203, v242, v197 row_newbcast:9 row_mask:0xf bank_mask:0xf
    v_lshlrev_b32 v196, 16, v70
    v_and_b32 v197, 0xffff0000, v70
    v_cvt_pk_bf16_f32 v64, v200, v201
    v_cvt_pk_bf16_f32 v68, v202, v203
    v_mul_f32_dpp v200, v242, v198 row_newbcast:2 row_mask:0xf bank_mask:0xf
    v_mul_f32_dpp v201, v242, v199 row_newbcast:3 row_mask:0xf bank_mask:0xf
    v_mul_f32_dpp v202, v242, v198 row_newbcast:10 row_mask:0xf bank_mask:0xf
    v_mul_f32_dpp v203, v242, v199 row_newbcast:11 row_mask:0xf bank_mask:0xf
    v_lshlrev_b32 v198, 16, v71
    v_and_b32 v199, 0xffff0000, v71
    v_cvt_pk_bf16_f32 v65, v200, v201
    v_cvt_pk_bf16_f32 v69, v202, v203
    v_mul_f32_dpp v200, v242, v196 row_newbcast:4 row_mask:0xf bank_mask:0xf
    v_mul_f32_dpp v201, v242, v197 row_newbcast:5 row_mask:0xf bank_mask:0xf
    v_mul_f32_dpp v202, v242, v196 row_newbcast:12 row_mask:0xf bank_mask:0xf
    v_mul_f32_dpp v203, v242, v197 row_newbcast:13 row_mask:0xf bank_mask:0xf
    v_cvt_pk_bf16_f32 v66, v200, v201
    v_cvt_pk_bf16_f32 v70, v202, v203
    v_mul_f32_dpp v200, v242, v198 row_newbcast:6 row_mask:0xf bank_mask:0xf
    v_mul_f32_dpp v201, v242, v199 row_newbcast:7 row_mask:0xf bank_mask:0xf
    v_mul_f32_dpp v202, v242, v198 row_newbcast:14 row_mask:0xf bank_mask:0xf
    v_mul_f32_dpp v203, v242, v199 row_newbcast:15 row_mask:0xf bank_mask:0xf
    v_cvt_pk_bf16_f32 v67, v200, v201
    v_cvt_pk_bf16_f32 v71, v202, v203
    s_mov_b64 exec, s[54:55]
    ds_read_u16_d16_hi v242, v250 offset:256
    s_mov_b64 exec, -1
    s_waitcnt vmcnt(4) lgkmcnt(2)
    v_mfma_f32_32x32x16_bf16 v[0:15], v[64:67], v[176:179], 0
    v_lshlrev_b32 v196, 16, v76
    v_and_b32 v197, 0xffff0000, v76
    v_lshlrev_b32 v198, 16, v77
    v_and_b32 v199, 0xffff0000, v77
    v_mul_f32_dpp v200, v243, v196 row_newbcast:0 row_mask:0xf bank_mask:0xf
    v_mul_f32_dpp v201, v243, v197 row_newbcast:1 row_mask:0xf bank_mask:0xf
    v_mul_f32_dpp v202, v243, v196 row_newbcast:8 row_mask:0xf bank_mask:0xf
    v_mul_f32_dpp v203, v243, v197 row_newbcast:9 row_mask:0xf bank_mask:0xf
    v_lshlrev_b32 v196, 16, v78
    v_and_b32 v197, 0xffff0000, v78
    v_cvt_pk_bf16_f32 v72, v200, v201
    v_cvt_pk_bf16_f32 v76, v202, v203
    v_mul_f32_dpp v200, v243, v198 row_newbcast:2 row_mask:0xf bank_mask:0xf
    v_mul_f32_dpp v201, v243, v199 row_newbcast:3 row_mask:0xf bank_mask:0xf
    v_mul_f32_dpp v202, v243, v198 row_newbcast:10 row_mask:0xf bank_mask:0xf
    v_mul_f32_dpp v203, v243, v199 row_newbcast:11 row_mask:0xf bank_mask:0xf
    s_add_u32 m0, s21, 0
    v_mfma_f32_32x32x16_bf16 v[16:31], v[68:71], v[176:179], 0
    buffer_load_dwordx4 v236, s[4:7], s35 offen lds
    buffer_load_dwordx4 v237, s[8:11], s35 offen offset:1024 lds
    ds_read_b64_tr_b16 v[176:177], v244 offset:2048
    ds_read_b64_tr_b16 v[178:179], v244 offset:3072
    ds_read_b64_tr_b16 v[184:185], v245 offset:2048
    ds_read_b64_tr_b16 v[186:187], v245 offset:3072
    v_lshlrev_b32 v198, 16, v79
    v_and_b32 v199, 0xffff0000, v79
    v_cvt_pk_bf16_f32 v73, v200, v201
    v_cvt_pk_bf16_f32 v77, v202, v203
    v_mul_f32_dpp v200, v243, v196 row_newbcast:4 row_mask:0xf bank_mask:0xf
    v_mul_f32_dpp v201, v243, v197 row_newbcast:5 row_mask:0xf bank_mask:0xf
    v_mul_f32_dpp v202, v243, v196 row_newbcast:12 row_mask:0xf bank_mask:0xf
    v_mul_f32_dpp v203, v243, v197 row_newbcast:13 row_mask:0xf bank_mask:0xf
    v_cvt_pk_bf16_f32 v74, v200, v201
    v_cvt_pk_bf16_f32 v78, v202, v203
    v_mul_f32_dpp v200, v243, v198 row_newbcast:6 row_mask:0xf bank_mask:0xf
    v_mul_f32_dpp v201, v243, v199 row_newbcast:7 row_mask:0xf bank_mask:0xf
    v_mul_f32_dpp v202, v243, v198 row_newbcast:14 row_mask:0xf bank_mask:0xf
    v_mul_f32_dpp v203, v243, v199 row_newbcast:15 row_mask:0xf bank_mask:0xf
    v_cvt_pk_bf16_f32 v75, v200, v201
    v_cvt_pk_bf16_f32 v79, v202, v203
    s_nop 0
    s_waitcnt vmcnt(4) lgkmcnt(0)
    v_mfma_f32_32x32x16_bf16 v[0:15], v[72:75], v[176:179], v[0:15]
    v_lshlrev_b32 v196, 16, v84
    v_and_b32 v197, 0xffff0000, v84
    v_lshlrev_b32 v198, 16, v85
    v_and_b32 v199, 0xffff0000, v85
    v_mul_f32_dpp v200, v242, v196 row_newbcast:0 row_mask:0xf bank_mask:0xf
    v_mul_f32_dpp v201, v242, v197 row_newbcast:1 row_mask:0xf bank_mask:0xf
    v_mul_f32_dpp v202, v242, v196 row_newbcast:8 row_mask:0xf bank_mask:0xf
    v_mul_f32_dpp v203, v242, v197 row_newbcast:9 row_mask:0xf bank_mask:0xf
    s_add_u32 m0, s21, 2048
    v_mfma_f32_32x32x16_bf16 v[16:31], v[76:79], v[176:179], v[16:31]
    buffer_load_dwordx4 v238, s[4:7], s35 offen lds
    ds_read_b64_tr_b16 v[176:177], v244 offset:4096
    ds_read_b64_tr_b16 v[188:189], v245 offset:4096
    v_cvt_pk_bf16_f32 v80, v200, v201
    v_cvt_pk_bf16_f32 v84, v202, v203
    v_mul_f32_dpp v200, v242, v198 row_newbcast:2 row_mask:0xf bank_mask:0xf
    v_mul_f32_dpp v201, v242, v199 row_newbcast:3 row_mask:0xf bank_mask:0xf
    v_mul_f32_dpp v202, v242, v198 row_newbcast:10 row_mask:0xf bank_mask:0xf
    v_mul_f32_dpp v203, v242, v199 row_newbcast:11 row_mask:0xf bank_mask:0xf
    v_cvt_pk_bf16_f32 v81, v200, v201
    v_cvt_pk_bf16_f32 v85, v202, v203
    s_nop 0
    s_waitcnt lgkmcnt(0)
    v_mfma_f32_32x32x8_bf16 v[0:15], v[80:81], v[176:177], v[0:15]
    s_add_u32 m0, s21, 4096
    v_mfma_f32_32x32x8_bf16 v[16:31], v[84:85], v[176:177], v[16:31]
    buffer_load_dwordx4 v234, s[4:7], s36 offen lds
    buffer_load_dwordx4 v235, s[8:11], s36 offen offset:1024 lds
    s_mov_b32 m0, s50
    s_nop 0
    s_movrels_b32 s71, s23
    s_bfe_u32 s46, s71, 0x30012
    s_mov_b32 m0, s46
    s_and_b32 s66, s71, 0x3ffff
    s_movrels_b32 s68, s57
    s_movrels_b32 s69, s61
    s_sub_u32 s48, s66, s47
    s_mov_b32 s47, s66
    s_lshr_b32 s52, s71, 28
    s_lshl_b32 s67, s46, 9
    s_add_u32 s66, s66, s67
    s_sub_u32 s49, s66, s42
    s_mov_b32 s42, s66
    s_bfe_u32 s66, s68, 655360
    s_add_u32 s43, s42, s66
    s_bfe_u32 s39, s69, 655360
    s_bfe_u32 s66, s68, 655370
    s_add_u32 s44, s42, s66
    s_bfe_u32 s40, s69, 655370
    s_bfe_u32 s66, s68, 655380
    s_add_u32 s45, s42, s66
    s_bfe_u32 s41, s69, 655380
    s_and_b32 s66, s46, s33
    s_cselect_b32 s72, -1, 1
    s_cselect_b32 s76, s47, 86912
    s_cmp_ge_u32 s66, 2
    s_cselect_b32 s73, -1, 0
    s_add_u32 s77, s47, 1024
    s_cmp_ge_u32 s66, 4
    s_cselect_b32 s75, -1, 0
    s_cmp_ge_u32 s66, 3
    s_cselect_b32 s74, -1, 1
    s_cselect_b32 s77, s77, 86912
    v_add_u32 v252, s45, v247
    ds_read_u16 v240, v252
    ds_read_u16 v241, v252 offset:64
    v_mfma_f32_32x32x16_bf16 v[32:47], v[64:67], v[180:183], 0
    v_mul_f32 v196, v0, v96
    v_fmac_f32 v196, v1, v97
    v_fmac_f32 v196, v2, v98
    v_fmac_f32 v196, v3, v99
    v_fmac_f32 v196, v4, v100
    v_fmac_f32 v196, v5, v101
    v_fmac_f32 v196, v6, v102
    v_mfma_f32_32x32x16_bf16 v[48:63], v[68:71], v[180:183], 0
    v_lshl_add_u32 v253, v248, 2, s47
    ds_read_b32 v254, v253
    ds_read_b32 v255, v253 offset:1024
    v_fmac_f32 v196, v7, v103
    v_mul_f32 v198, v8, v128
    v_fmac_f32 v198, v9, v129
    v_fmac_f32 v198, v10, v130
    v_fmac_f32 v198, v11, v131
    v_fmac_f32 v198, v12, v132
    v_mfma_f32_32x32x16_bf16 v[32:47], v[72:75], v[184:187], v[32:47]
    v_fmac_f32 v198, v13, v133
    v_fmac_f32 v198, v14, v134
    v_fmac_f32 v198, v15, v135
    v_mul_f32 v200, v16, v128
    v_fmac_f32 v200, v17, v129
    v_permlane32_swap_b32 v196, v198
    v_mfma_f32_32x32x16_bf16 v[48:63], v[76:79], v[184:187], v[48:63]
    s_waitcnt vmcnt(5)
    ds_read_b64_tr_b16 v[176:177], v244 offset:6144
    ds_read_b64_tr_b16 v[178:179], v244 offset:7168
    ds_read_b64_tr_b16 v[180:181], v245 offset:6144
    ds_read_b64_tr_b16 v[182:183], v245 offset:7168
    v_fmac_f32 v200, v18, v130
    v_fmac_f32 v200, v19, v131
    v_fmac_f32 v200, v20, v132
    v_fmac_f32 v200, v21, v133
    v_fmac_f32 v200, v22, v134
    v_fmac_f32 v200, v23, v135
    v_mfma_f32_32x32x8_bf16 v[32:47], v[80:81], v[188:189], v[32:47]
    v_add_f32 v198, v196, v198
    v_mul_f32_e64 v202, v24, -v128
    v_fma_f32 v202, v25, -v129, v202
    v_fma_f32 v202, v26, -v130, v202
    v_fma_f32 v202, v27, -v131, v202
    v_fma_f32 v202, v28, -v132, v202
    v_mfma_f32_32x32x8_bf16 v[48:63], v[84:85], v[188:189], v[48:63]
    v_fma_f32 v202, v29, -v133, v202
    v_fma_f32 v202, v30, -v134, v202
    v_fma_f32 v202, v31, -v135, v202
    s_nop 1
    v_permlane32_swap_b32 v200, v202
    v_add_f32 v202, v200, v202
    s_waitcnt vmcnt(3) lgkmcnt(0)
    v_mfma_f32_32x32x16_bf16 v[0:15], v[64:67], v[176:179], 0
    v_mul_f32 v197, v32, v104
    v_fmac_f32 v197, v33, v105
    v_fmac_f32 v197, v34, v106
    v_fmac_f32 v197, v35, v107
    v_fmac_f32 v197, v36, v108
    v_fmac_f32 v197, v37, v109
    v_fmac_f32 v197, v38, v110
    s_add_u32 m0, s21, 6144
    v_mfma_f32_32x32x16_bf16 v[16:31], v[68:71], v[176:179], 0
    buffer_load_dwordx4 v236, s[4:7], s36 offen lds
    buffer_load_dwordx4 v237, s[8:11], s36 offen offset:1024 lds
    ds_read_b64_tr_b16 v[176:177], v244 offset:0
    ds_read_b64_tr_b16 v[178:179], v244 offset:1024
    ds_read_b64_tr_b16 v[184:185], v245 offset:0
    ds_read_b64_tr_b16 v[186:187], v245 offset:1024
    s_mov_b32 m0, s76
    s_mov_b64 exec, s[72:73]
    buffer_load_dwordx4 v254, s[12:15], 0 offen  lds
    s_mov_b32 m0, s77
    s_mov_b64 exec, s[74:75]
    buffer_load_dwordx4 v255, s[12:15], 0 offen  lds
    s_mov_b64 exec, -1
    v_fmac_f32 v197, v39, v111
    v_mul_f32 v199, v40, v136
    v_fmac_f32 v199, v41, v137
    v_fmac_f32 v199, v42, v138
    v_fmac_f32 v199, v43, v139
    v_fmac_f32 v199, v44, v140
    v_fmac_f32 v199, v45, v141
    s_waitcnt vmcnt(6) lgkmcnt(0)
    v_mfma_f32_32x32x16_bf16 v[0:15], v[72:75], v[176:179], v[0:15]
    v_fmac_f32 v199, v46, v142
    v_fmac_f32 v199, v47, v143
    v_mul_f32 v201, v48, v136
    v_fmac_f32 v201, v49, v137
    v_permlane32_swap_b32 v197, v199
    v_fmac_f32 v201, v50, v138
    v_fmac_f32 v201, v51, v139
    s_add_u32 m0, s21, 0
    v_mfma_f32_32x32x16_bf16 v[16:31], v[76:79], v[176:179], v[16:31]
    buffer_load_dwordx4 v238, s[4:7], s36 offen lds
    ds_read_b64_tr_b16 v[176:177], v244 offset:2048
    ds_read_b64_tr_b16 v[188:189], v245 offset:2048
    v_fmac_f32 v201, v52, v140
    v_fmac_f32 v201, v53, v141
    v_fmac_f32 v201, v54, v142
    v_fmac_f32 v201, v55, v143
    v_add_f32 v199, v197, v199
    v_mul_f32_e64 v203, v56, -v136
    v_fma_f32 v203, v57, -v137, v203
    s_waitcnt lgkmcnt(0)
    v_mfma_f32_32x32x8_bf16 v[0:15], v[80:81], v[176:177], v[0:15]
    v_fma_f32 v203, v58, -v138, v203
    v_fma_f32 v203, v59, -v139, v203
    v_fma_f32 v203, v60, -v140, v203
    v_fma_f32 v203, v61, -v141, v203
    v_fma_f32 v203, v62, -v142, v203
    v_fma_f32 v203, v63, -v143, v203
    s_nop 1
    s_add_u32 m0, s21, 2048
    v_mfma_f32_32x32x8_bf16 v[16:31], v[84:85], v[176:177], v[16:31]
    buffer_load_dwordx4 v234, s[4:7], s37 offen lds
    buffer_load_dwordx4 v235, s[8:11], s37 offen offset:1024 lds
    v_add_u32 v252, s42, v247
    ds_read_u16 v234, v252
    ds_read_u16 v235, v252 offset:64
    v_permlane32_swap_b32 v201, v203
    v_add_f32 v203, v201, v203
    s_set_gpr_idx_on s51, gpr_idx(DST)
    s_nop 0
    v_cvt_pk_bf16_f32 v204, v198, v199
    v_cvt_pk_bf16_f32 v205, v202, v203
    s_set_gpr_idx_off
    v_mfma_f32_32x32x16_bf16 v[32:47], v[64:67], v[180:183], 0
    v_mul_f32 v196, v0, v144
    v_fmac_f32 v196, v1, v145
    v_fmac_f32 v196, v2, v146
    v_fmac_f32 v196, v3, v147
    v_fmac_f32 v196, v4, v148
    v_fmac_f32 v196, v5, v149
    v_mfma_f32_32x32x16_bf16 v[48:63], v[68:71], v[180:183], 0
    v_fmac_f32 v196, v6, v150
    v_fmac_f32 v196, v7, v151
    v_mul_f32 v198, v8, v112
    v_fmac_f32 v198, v9, v113
    v_fmac_f32 v198, v10, v114
    v_mfma_f32_32x32x16_bf16 v[32:47], v[72:75], v[184:187], v[32:47]
    v_fmac_f32 v198, v11, v115
    v_fmac_f32 v198, v12, v116
    v_fmac_f32 v198, v13, v117
    v_fmac_f32 v198, v14, v118
    v_fmac_f32 v198, v15, v119
    v_mfma_f32_32x32x16_bf16 v[48:63], v[76:79], v[184:187], v[48:63]
    s_waitcnt vmcnt(7)
    ds_read_b64_tr_b16 v[176:177], v244 offset:4096
    ds_read_b64_tr_b16 v[178:179], v244 offset:5120
    ds_read_b64_tr_b16 v[180:181], v245 offset:4096
    ds_read_b64_tr_b16 v[182:183], v245 offset:5120
    v_mul_f32_e64 v200, v16, -v160
    v_fma_f32 v200, v17, -v161, v200
    v_fma_f32 v200, v18, -v162, v200
    v_fma_f32 v200, v19, -v163, v200
    v_fma_f32 v200, v20, -v164, v200
    v_fma_f32 v200, v21, -v165, v200
    v_mfma_f32_32x32x8_bf16 v[32:47], v[80:81], v[188:189], v[32:47]
    v_fma_f32 v200, v22, -v166, v200
    v_fma_f32 v200, v23, -v167, v200
    v_mul_f32_e64 v202, v24, -v160
    v_fma_f32 v202, v25, -v161, v202
    v_fma_f32 v202, v26, -v162, v202
    v_mfma_f32_32x32x8_bf16 v[48:63], v[84:85], v[188:189], v[48:63]
    v_fma_f32 v202, v27, -v163, v202
    v_fma_f32 v202, v28, -v164, v202
    v_fma_f32 v202, v29, -v165, v202
    v_fma_f32 v202, v30, -v166, v202
    v_fma_f32 v202, v31, -v167, v202
    s_waitcnt vmcnt(5) lgkmcnt(0)
    v_mfma_f32_32x32x16_bf16 v[0:15], v[64:67], v[176:179], 0
    v_mul_f32 v197, v32, v152
    v_fmac_f32 v197, v33, v153
    v_fmac_f32 v197, v34, v154
    v_fmac_f32 v197, v35, v155
    v_fmac_f32 v197, v36, v156
    v_fmac_f32 v197, v37, v157
    s_add_u32 m0, s21, 4096
    v_mfma_f32_32x32x16_bf16 v[16:31], v[68:71], v[176:179], 0
    buffer_load_dwordx4 v236, s[4:7], s37 offen lds
    buffer_load_dwordx4 v237, s[8:11], s37 offen offset:1024 lds
    ds_read_b64_tr_b16 v[176:177], v244 offset:6144
    ds_read_b64_tr_b16 v[178:179], v244 offset:7168
    ds_read_b64_tr_b16 v[184:185], v245 offset:6144
    ds_read_b64_tr_b16 v[186:187], v245 offset:7168
    v_add_u32 v252, s43, v247
    ds_read_u16 v236, v252
    ds_read_u16 v237, v252 offset:64
    v_fmac_f32 v197, v38, v158
    v_fmac_f32 v197, v39, v159
    v_mul_f32 v199, v40, v120
    v_fmac_f32 v199, v41, v121
    v_fmac_f32 v199, v42, v122
    s_waitcnt vmcnt(4) lgkmcnt(2)
    v_mfma_f32_32x32x16_bf16 v[0:15], v[72:75], v[176:179], v[0:15]
    v_fmac_f32 v199, v43, v123
    v_fmac_f32 v199, v44, v124
    v_fmac_f32 v199, v45, v125
    v_fmac_f32 v199, v46, v126
    v_fmac_f32 v199, v47, v127
    s_add_u32 m0, s21, 6144
    v_mfma_f32_32x32x16_bf16 v[16:31], v[76:79], v[176:179], v[16:31]
    buffer_load_dwordx4 v238, s[4:7], s37 offen lds
    ds_read_b64_tr_b16 v[176:177], v244 offset:0
    ds_read_b64_tr_b16 v[188:189], v245 offset:0
    v_add_u32 v252, s44, v247
    ds_read_u16 v238, v252
    ds_read_u16 v239, v252 offset:64
    v_mul_f32_e64 v201, v48, -v168
    v_fma_f32 v201, v49, -v169, v201
    v_fma_f32 v201, v50, -v170, v201
    v_fma_f32 v201, v51, -v171, v201
    v_fma_f32 v201, v52, -v172, v201
    v_fma_f32 v201, v53, -v173, v201
    s_waitcnt lgkmcnt(2)
    v_mfma_f32_32x32x8_bf16 v[0:15], v[80:81], v[176:177], v[0:15]
    v_fma_f32 v201, v54, -v174, v201
    v_fma_f32 v201, v55, -v175, v201
    v_mul_f32_e64 v203, v56, -v168
    v_fma_f32 v203, v57, -v169, v203
    v_fma_f32 v203, v58, -v170, v203
    s_add_u32 m0, s21, 0
    v_mfma_f32_32x32x8_bf16 v[16:31], v[84:85], v[176:177], v[16:31]
    v_lshl_add_u32 v234, v234, 10, v246
    v_lshl_add_u32 v235, v235, 10, v246
    buffer_load_dwordx4 v234, s[4:7], s38 offen lds
    buffer_load_dwordx4 v235, s[8:11], s38 offen offset:1024 lds
    v_fma_f32 v203, v59, -v171, v203
    v_fma_f32 v203, v60, -v172, v203
    v_fma_f32 v203, v61, -v173, v203
    v_fma_f32 v203, v62, -v174, v203
    v_fma_f32 v203, v63, -v175, v203
    v_mfma_f32_32x32x16_bf16 v[32:47], v[64:67], v[180:183], 0
    v_mul_f32 v254, v0, v144
    v_fmac_f32 v254, v1, v145
    v_fmac_f32 v254, v2, v146
    v_mfma_f32_32x32x16_bf16 v[48:63], v[68:71], v[180:183], 0
    ds_swizzle_b32 v68, v68 offset:0x401F
    ds_swizzle_b32 v69, v69 offset:0x401F
    ds_swizzle_b32 v70, v70 offset:0x401F
    ds_swizzle_b32 v71, v71 offset:0x401F
    v_fmac_f32 v254, v3, v147
    v_fmac_f32 v254, v4, v148
    v_fmac_f32 v254, v5, v149
    v_mfma_f32_32x32x16_bf16 v[32:47], v[72:75], v[184:187], v[32:47]
    v_fmac_f32 v254, v6, v150
    v_fmac_f32 v254, v7, v151
    v_fmac_f32 v200, v8, v160
    v_mfma_f32_32x32x16_bf16 v[48:63], v[76:79], v[184:187], v[48:63]
    ds_swizzle_b32 v76, v76 offset:0x401F
    ds_swizzle_b32 v77, v77 offset:0x401F
    ds_swizzle_b32 v78, v78 offset:0x401F
    ds_swizzle_b32 v79, v79 offset:0x401F
    s_waitcnt vmcnt(5)
    ds_read_b64_tr_b16 v[176:177], v244 offset:2048
    ds_read_b64_tr_b16 v[178:179], v244 offset:3072
    ds_read_b64_tr_b16 v[180:181], v245 offset:2048
    ds_read_b64_tr_b16 v[182:183], v245 offset:3072
    v_fmac_f32 v200, v9, v161
    v_permlane32_swap_b32 v196, v254
    v_fmac_f32 v200, v10, v162
    v_mfma_f32_32x32x8_bf16 v[32:47], v[80:81], v[188:189], v[32:47]
    v_fmac_f32 v200, v11, v163
    v_fmac_f32 v200, v12, v164
    v_fmac_f32 v200, v13, v165
    v_mfma_f32_32x32x8_bf16 v[48:63], v[84:85], v[188:189], v[48:63]
    ds_swizzle_b32 v84, v84 offset:0x401F
    ds_swizzle_b32 v85, v85 offset:0x401F
    v_fmac_f32 v200, v14, v166
    v_fmac_f32 v200, v15, v167
    v_add_f32 v254, v196, v254
    s_waitcnt lgkmcnt(6)
    s_mov_b64 exec, s[56:57]
    v_xor_b32 v68, 0x80008000, v68
    v_xor_b32 v69, 0x80008000, v69
    v_xor_b32 v70, 0x80008000, v70
    v_xor_b32 v71, 0x80008000, v71
    v_xor_b32 v76, 0x80008000, v76
    v_xor_b32 v77, 0x80008000, v77
    v_xor_b32 v78, 0x80008000, v78
    v_xor_b32 v79, 0x80008000, v79
    s_mov_b64 exec, -1
    s_waitcnt vmcnt(3) lgkmcnt(2)
    v_mfma_f32_32x32x16_bf16 v[0:15], v[64:67], v[176:179], 0
    v_mul_f32 v255, v32, v152
    v_fmac_f32 v255, v33, v153
    v_fmac_f32 v255, v34, v154
    v_fmac_f32 v255, v35, v155
    s_add_u32 m0, s21, 2048
    v_mfma_f32_32x32x16_bf16 v[16:31], v[68:71], v[176:179], v[16:31]
    v_lshl_add_u32 v236, v236, 10, v246
    v_lshl_add_u32 v237, v237, 10, v246
    buffer_load_dwordx4 v236, s[4:7], s39 offen lds
    buffer_load_dwordx4 v237, s[8:11], s39 offen offset:1024 lds
    ds_read_b64_tr_b16 v[176:177], v244 offset:4096
    ds_read_b64_tr_b16 v[178:179], v244 offset:5120
    ds_read_b64_tr_b16 v[184:185], v245 offset:4096
    ds_read_b64_tr_b16 v[186:187], v245 offset:5120
    v_fmac_f32 v255, v36, v156
    v_fmac_f32 v255, v37, v157
    v_fmac_f32 v255, v38, v158
    v_fmac_f32 v255, v39, v159
    s_waitcnt vmcnt(4) lgkmcnt(0)
    v_mfma_f32_32x32x16_bf16 v[0:15], v[72:75], v[176:179], v[0:15]
    v_fmac_f32 v201, v40, v168
    v_fmac_f32 v201, v41, v169
    v_permlane32_swap_b32 v197, v255
    s_add_u32 m0, s21, 4096
    v_mfma_f32_32x32x16_bf16 v[16:31], v[76:79], v[176:179], v[16:31]
    v_lshl_add_u32 v238, v238, 10, v246
    v_lshl_add_u32 v239, v239, 10, v246
    buffer_load_dwordx4 v238, s[4:7], s40 offen lds
    buffer_load_dwordx4 v239, s[8:11], s40 offen offset:1024 lds
    ds_read_b64_tr_b16 v[176:177], v244 offset:6144
    ds_read_b64_tr_b16 v[188:189], v245 offset:6144
    v_fmac_f32 v201, v42, v170
    v_fmac_f32 v201, v43, v171
    v_fmac_f32 v201, v44, v172
    v_fmac_f32 v201, v45, v173
    s_waitcnt lgkmcnt(0)
    s_mov_b64 exec, s[56:57]
    v_xor_b32 v84, 0x80008000, v84
    v_xor_b32 v85, 0x80008000, v85
    s_mov_b64 exec, -1
    v_mfma_f32_32x32x8_bf16 v[0:15], v[80:81], v[176:177], v[0:15]
    v_fmac_f32 v201, v46, v174
    v_fmac_f32 v201, v47, v175
    v_add_f32 v255, v197, v255
    s_set_gpr_idx_on s51, gpr_idx(DST)
    s_nop 0
    v_cvt_pk_bf16_f32 v206, v254, v255
    s_set_gpr_idx_off
    s_add_u32 m0, s21, 6144
    v_mfma_f32_32x32x8_bf16 v[16:31], v[84:85], v[176:177], v[16:31]
    v_lshl_add_u32 v240, v240, 10, v246
    v_lshl_add_u32 v241, v241, 10, v246
    buffer_load_dwordx4 v240, s[4:7], s41 offen lds
    buffer_load_dwordx4 v241, s[8:11], s41 offen offset:1024 lds
    v_mfma_f32_32x32x16_bf16 v[32:47], v[64:67], v[180:183], 0
    v_mul_f32 v254, v0, v144
    v_fmac_f32 v254, v1, v145
    v_fmac_f32 v254, v2, v146
    v_fmac_f32 v254, v3, v147
    v_fmac_f32 v254, v4, v148
    v_fmac_f32 v254, v5, v149
    v_fmac_f32 v254, v6, v150
    v_mfma_f32_32x32x16_bf16 v[48:63], v[68:71], v[180:183], v[48:63]
    v_fmac_f32 v254, v7, v151
    v_fma_f32 v202, v8, -v160, v202
    v_fma_f32 v202, v9, -v161, v202
    v_permlane32_swap_b32 v254, v200
    v_fma_f32 v202, v10, -v162, v202
    v_fma_f32 v202, v11, -v163, v202
    v_mfma_f32_32x32x16_bf16 v[32:47], v[72:75], v[184:187], v[32:47]
    v_fma_f32 v202, v12, -v164, v202
    v_fma_f32 v202, v13, -v165, v202
    v_fma_f32 v202, v14, -v166, v202
    v_fma_f32 v202, v15, -v167, v202
    v_add_f32 v200, v254, v200
    v_fmac_f32 v198, v16, v112
    v_permlane32_swap_b32 v202, v254
    v_mfma_f32_32x32x16_bf16 v[48:63], v[76:79], v[184:187], v[48:63]
    s_waitcnt vmcnt(6)
    ds_read_b64_tr_b16 v[176:177], v244 offset:0
    ds_read_b64_tr_b16 v[178:179], v244 offset:1024
    ds_read_b64_tr_b16 v[180:181], v245 offset:0
    ds_read_b64_tr_b16 v[182:183], v245 offset:1024
    v_fmac_f32 v198, v17, v113
    v_fmac_f32 v198, v18, v114
    v_fmac_f32 v198, v19, v115
    v_fmac_f32 v198, v20, v116
    v_fmac_f32 v198, v21, v117
    v_fmac_f32 v198, v22, v118
    v_mfma_f32_32x32x8_bf16 v[32:47], v[80:81], v[188:189], v[32:47]
    v_fmac_f32 v198, v23, v119
    v_add_f32 v254, v202, v254
    v_mul_f32 v196, v24, v160
    v_fmac_f32 v196, v25, v161
    v_fmac_f32 v196, v26, v162
    v_fmac_f32 v196, v27, v163
    v_fmac_f32 v196, v28, v164
    v_mfma_f32_32x32x8_bf16 v[48:63], v[84:85], v[188:189], v[48:63]
    v_add_u32 v249, s48, v249
    v_add_u32 v250, s49, v250
    ds_read_b32 v252, v251 offset:16
    ds_read_b64_tr_b16 v[68:69], v249 offset:0
    ds_read_b64_tr_b16 v[70:71], v249 offset:256
    s_mov_b64 exec, s[54:55]
    ds_read_u16_d16_hi v242, v250 offset:0
    s_mov_b64 exec, -1
    v_fmac_f32 v196, v29, v165
    v_fmac_f32 v196, v30, v166
    v_fmac_f32 v196, v31, v167
    s_nop 1
    v_permlane32_swap_b32 v198, v196
    v_add_f32 v196, v198, v196
    v_mul_f32 v255, v32, v152
    v_fmac_f32 v255, v33, v153
    v_fmac_f32 v255, v34, v154
    v_fmac_f32 v255, v35, v155
    v_fmac_f32 v255, v36, v156
    v_fmac_f32 v255, v37, v157
    v_fmac_f32 v255, v38, v158
    v_fmac_f32 v255, v39, v159
    v_fma_f32 v203, v40, -v168, v203
    v_fma_f32 v203, v41, -v169, v203
    v_permlane32_swap_b32 v255, v201
    v_fma_f32 v203, v42, -v170, v203
    v_fma_f32 v203, v43, -v171, v203
    v_fma_f32 v203, v44, -v172, v203
    v_fma_f32 v203, v45, -v173, v203
    v_fma_f32 v203, v46, -v174, v203
    v_fma_f32 v203, v47, -v175, v203
    v_add_f32 v201, v255, v201
    v_fmac_f32 v199, v48, v120
    v_permlane32_swap_b32 v203, v255
    v_fmac_f32 v199, v49, v121
    v_fmac_f32 v199, v50, v122
    v_fmac_f32 v199, v51, v123
    v_fmac_f32 v199, v52, v124
    v_fmac_f32 v199, v53, v125
    v_fmac_f32 v199, v54, v126
    v_fmac_f32 v199, v55, v127
    v_add_f32 v255, v203, v255
    v_mul_f32 v197, v56, v168
    v_fmac_f32 v197, v57, v169
    v_fmac_f32 v197, v58, v170
    v_fmac_f32 v197, v59, v171
    v_fmac_f32 v197, v60, v172
    v_fmac_f32 v197, v61, v173
    v_fmac_f32 v197, v62, v174
    v_fmac_f32 v197, v63, v175
    s_nop 1
    v_permlane32_swap_b32 v199, v197
    v_add_f32 v197, v199, v197
    s_set_gpr_idx_on s51, gpr_idx(DST)
    s_nop 0
    v_cvt_pk_bf16_f32 v207, v200, v201
    v_cvt_pk_bf16_f32 v209, v254, v255
    v_cvt_pk_bf16_f32 v208, v196, v197
    s_set_gpr_idx_off
    s_add_u32 s50, s50, 1
    s_add_u32 s51, s51, 6
    s_cmp_ge_u32 s50, 4
    s_cbranch_scc1 LAST0
    s_waitcnt lgkmcnt(3)
    v_readfirstlane_b32 s66, v252
    s_add_u32 s53, s53, 1
    v_mov_b32 v252, s53
    s_cmp_le_u32 s53, s66
    ds_write2_b32 v251, v252, v252 offset0:0 offset1:8
    s_setprio 1
    s_cbranch_scc1 PRIO_5
    s_setprio 0
PRIO_5:
    s_cmp_eq_u32 s52, 4
    s_cbranch_scc1 ITEM_0_4
    s_cmp_eq_u32 s52, 5
    s_cbranch_scc1 ITEM_0_5
    s_cmp_eq_u32 s52, 3
    s_cbranch_scc1 ITEM_0_3
    s_cmp_eq_u32 s52, 6
    s_cbranch_scc1 ITEM_0_6
    s_cmp_eq_u32 s52, 8
    s_cbranch_scc1 ITEM_0_8
    s_branch ITEM_0_2
.p2align 6
ITEM_0_3:
    s_mov_b64 exec, s[54:55]
    ds_read_u16_d16_hi v243, v250 offset:128
    s_mov_b64 exec, -1
    ds_read_b64_tr_b16 v[76:77], v249 offset:512
    s_waitcnt lgkmcnt(2)
    v_lshlrev_b32 v196, 16, v68
    v_and_b32 v197, 0xffff0000, v68
    v_lshlrev_b32 v198, 16, v69
    v_and_b32 v199, 0xffff0000, v69
    v_mul_f32_dpp v200, v242, v196 row_newbcast:0 row_mask:0xf bank_mask:0xf
    v_mul_f32_dpp v201, v242, v197 row_newbcast:1 row_mask:0xf bank_mask:0xf
    v_mul_f32_dpp v202, v242, v196 row_newbcast:8 row_mask:0xf bank_mask:0xf
    v_mul_f32_dpp v203, v242, v197 row_newbcast:9 row_mask:0xf bank_mask:0xf
    v_lshlrev_b32 v196, 16, v70
    v_and_b32 v197, 0xffff0000, v70
    v_cvt_pk_bf16_f32 v64, v200, v201
    v_cvt_pk_bf16_f32 v68, v202, v203
    v_mul_f32_dpp v200, v242, v198 row_newbcast:2 row_mask:0xf bank_mask:0xf
    v_mul_f32_dpp v201, v242, v199 row_newbcast:3 row_mask:0xf bank_mask:0xf
    v_mul_f32_dpp v202, v242, v198 row_newbcast:10 row_mask:0xf bank_mask:0xf
    v_mul_f32_dpp v203, v242, v199 row_newbcast:11 row_mask:0xf bank_mask:0xf
    v_lshlrev_b32 v198, 16, v71
    v_and_b32 v199, 0xffff0000, v71
    v_cvt_pk_bf16_f32 v65, v200, v201
    v_cvt_pk_bf16_f32 v69, v202, v203
    v_mul_f32_dpp v200, v242, v196 row_newbcast:4 row_mask:0xf bank_mask:0xf
    v_mul_f32_dpp v201, v242, v197 row_newbcast:5 row_mask:0xf bank_mask:0xf
    v_mul_f32_dpp v202, v242, v196 row_newbcast:12 row_mask:0xf bank_mask:0xf
    v_mul_f32_dpp v203, v242, v197 row_newbcast:13 row_mask:0xf bank_mask:0xf
    v_cvt_pk_bf16_f32 v66, v200, v201
    v_cvt_pk_bf16_f32 v70, v202, v203
    v_mul_f32_dpp v200, v242, v198 row_newbcast:6 row_mask:0xf bank_mask:0xf
    v_mul_f32_dpp v201, v242, v199 row_newbcast:7 row_mask:0xf bank_mask:0xf
    v_mul_f32_dpp v202, v242, v198 row_newbcast:14 row_mask:0xf bank_mask:0xf
    v_mul_f32_dpp v203, v242, v199 row_newbcast:15 row_mask:0xf bank_mask:0xf
    v_cvt_pk_bf16_f32 v67, v200, v201
    v_cvt_pk_bf16_f32 v71, v202, v203
    s_nop 0
    s_waitcnt vmcnt(4) lgkmcnt(0)
    v_mfma_f32_32x32x16_bf16 v[0:15], v[64:67], v[176:179], 0
    v_lshlrev_b32 v196, 16, v76
    v_and_b32 v197, 0xffff0000, v76
    v_lshlrev_b32 v198, 16, v77
    v_and_b32 v199, 0xffff0000, v77
    v_mul_f32_dpp v200, v243, v196 row_newbcast:0 row_mask:0xf bank_mask:0xf
    v_mul_f32_dpp v201, v243, v197 row_newbcast:1 row_mask:0xf bank_mask:0xf
    v_mul_f32_dpp v202, v243, v196 row_newbcast:8 row_mask:0xf bank_mask:0xf
    v_mul_f32_dpp v203, v243, v197 row_newbcast:9 row_mask:0xf bank_mask:0xf
    s_add_u32 m0, s21, 0
    v_mfma_f32_32x32x16_bf16 v[16:31], v[68:71], v[176:179], 0
    buffer_load_dwordx4 v234, s[4:7], s36 offen lds
    buffer_load_dwordx4 v235, s[8:11], s36 offen offset:1024 lds
    ds_read_b64_tr_b16 v[176:177], v244 offset:2048
    ds_read_b64_tr_b16 v[184:185], v245 offset:2048
    v_cvt_pk_bf16_f32 v72, v200, v201
    v_cvt_pk_bf16_f32 v76, v202, v203
    v_mul_f32_dpp v200, v243, v198 row_newbcast:2 row_mask:0xf bank_mask:0xf
    v_mul_f32_dpp v201, v243, v199 row_newbcast:3 row_mask:0xf bank_mask:0xf
    v_mul_f32_dpp v202, v243, v198 row_newbcast:10 row_mask:0xf bank_mask:0xf
    v_mul_f32_dpp v203, v243, v199 row_newbcast:11 row_mask:0xf bank_mask:0xf
    v_cvt_pk_bf16_f32 v73, v200, v201
    v_cvt_pk_bf16_f32 v77, v202, v203
    s_nop 0
    s_waitcnt lgkmcnt(0)
    v_mfma_f32_32x32x8_bf16 v[0:15], v[72:73], v[176:177], v[0:15]
    s_add_u32 m0, s21, 2048
    v_mfma_f32_32x32x8_bf16 v[16:31], v[76:77], v[176:177], v[16:31]
    buffer_load_dwordx4 v236, s[4:7], s36 offen lds
    s_mov_b32 m0, s50
    s_nop 0
    s_movrels_b32 s71, s23
    s_bfe_u32 s46, s71, 0x30012
    s_mov_b32 m0, s46
    s_and_b32 s66, s71, 0x3ffff
    s_movrels_b32 s68, s57
    s_movrels_b32 s69, s61
    s_sub_u32 s48, s66, s47
    s_mov_b32 s47, s66
    s_lshr_b32 s52, s71, 28
    s_lshl_b32 s67, s46, 9
    s_add_u32 s66, s66, s67
    s_sub_u32 s49, s66, s42
    s_mov_b32 s42, s66
    s_bfe_u32 s66, s68, 655360
    s_add_u32 s43, s42, s66
    s_bfe_u32 s39, s69, 655360
    s_bfe_u32 s66, s68, 655370
    s_add_u32 s44, s42, s66
    s_bfe_u32 s40, s69, 655370
    s_bfe_u32 s66, s68, 655380
    s_add_u32 s45, s42, s66
    s_bfe_u32 s41, s69, 655380
    s_and_b32 s66, s46, s33
    s_cselect_b32 s72, -1, 1
    s_cselect_b32 s76, s47, 86912
    s_cmp_ge_u32 s66, 2
    s_cselect_b32 s73, -1, 0
    s_add_u32 s77, s47, 1024
    s_cmp_ge_u32 s66, 4
    s_cselect_b32 s75, -1, 0
    s_cmp_ge_u32 s66, 3
    s_cselect_b32 s74, -1, 1
    s_cselect_b32 s77, s77, 86912
    v_add_u32 v252, s44, v247
    ds_read_u16 v238, v252
    ds_read_u16 v239, v252 offset:64
    v_add_u32 v252, s45, v247
    ds_read_u16 v240, v252
    ds_read_u16 v241, v252 offset:64
    v_mfma_f32_32x32x16_bf16 v[32:47], v[64:67], v[180:183], 0
    v_mul_f32 v196, v0, v96
    v_fmac_f32 v196, v1, v97
    v_fmac_f32 v196, v2, v98
    v_fmac_f32 v196, v3, v99
    v_fmac_f32 v196, v4, v100
    v_fmac_f32 v196, v5, v101
    v_fmac_f32 v196, v6, v102
    v_fmac_f32 v196, v7, v103
    v_mul_f32 v198, v8, v128
    v_fmac_f32 v198, v9, v129
    v_mfma_f32_32x32x16_bf16 v[48:63], v[68:71], v[180:183], 0
    v_lshl_add_u32 v253, v248, 2, s47
    ds_read_b32 v254, v253
    ds_read_b32 v255, v253 offset:1024
    s_waitcnt vmcnt(5)
    ds_read_b64_tr_b16 v[176:177], v244 offset:4096
    ds_read_b64_tr_b16 v[178:179], v244 offset:5120
    ds_read_b64_tr_b16 v[180:181], v245 offset:4096
    ds_read_b64_tr_b16 v[182:183], v245 offset:5120
    v_fmac_f32 v198, v10, v130
    v_fmac_f32 v198, v11, v131
    v_fmac_f32 v198, v12, v132
    v_fmac_f32 v198, v13, v133
    v_fmac_f32 v198, v14, v134
    v_fmac_f32 v198, v15, v135
    v_mul_f32 v200, v16, v128
    v_fmac_f32 v200, v17, v129
    v_permlane32_swap_b32 v196, v198
    v_mfma_f32_32x32x8_bf16 v[32:47], v[72:73], v[184:185], v[32:47]
    v_fmac_f32 v200, v18, v130
    v_fmac_f32 v200, v19, v131
    v_fmac_f32 v200, v20, v132
    v_fmac_f32 v200, v21, v133
    v_fmac_f32 v200, v22, v134
    v_fmac_f32 v200, v23, v135
    v_add_f32 v198, v196, v198
    v_mul_f32_e64 v202, v24, -v128
    v_fma_f32 v202, v25, -v129, v202
    v_mfma_f32_32x32x8_bf16 v[48:63], v[76:77], v[184:185], v[48:63]
    v_fma_f32 v202, v26, -v130, v202
    v_fma_f32 v202, v27, -v131, v202
    v_fma_f32 v202, v28, -v132, v202
    v_fma_f32 v202, v29, -v133, v202
    v_fma_f32 v202, v30, -v134, v202
    v_fma_f32 v202, v31, -v135, v202
    s_nop 1
    v_permlane32_swap_b32 v200, v202
    v_add_f32 v202, v200, v202
    s_waitcnt vmcnt(3) lgkmcnt(0)
    v_mfma_f32_32x32x16_bf16 v[0:15], v[64:67], v[176:179], 0
    v_mul_f32 v197, v32, v104
    v_fmac_f32 v197, v33, v105
    v_fmac_f32 v197, v34, v106
    v_fmac_f32 v197, v35, v107
    v_fmac_f32 v197, v36, v108
    v_fmac_f32 v197, v37, v109
    v_fmac_f32 v197, v38, v110
    v_fmac_f32 v197, v39, v111
    v_mul_f32 v199, v40, v136
    v_fmac_f32 v199, v41, v137
    v_fmac_f32 v199, v42, v138
    s_add_u32 m0, s21, 4096
    v_mfma_f32_32x32x16_bf16 v[16:31], v[68:71], v[176:179], 0
    buffer_load_dwordx4 v234, s[4:7], s37 offen lds
    buffer_load_dwordx4 v235, s[8:11], s37 offen offset:1024 lds
    ds_read_b64_tr_b16 v[176:177], v244 offset:6144
    ds_read_b64_tr_b16 v[184:185], v245 offset:6144
    v_add_u32 v252, s42, v247
    ds_read_u16 v234, v252
    ds_read_u16 v235, v252 offset:64
    s_mov_b32 m0, s76
    s_mov_b64 exec, s[72:73]
    buffer_load_dwordx4 v254, s[12:15], 0 offen  lds
    s_mov_b32 m0, s77
    s_mov_b64 exec, s[74:75]
    buffer_load_dwordx4 v255, s[12:15], 0 offen  lds
    s_mov_b64 exec, -1
    v_fmac_f32 v199, v43, v139
    v_fmac_f32 v199, v44, v140
    v_fmac_f32 v199, v45, v141
    v_fmac_f32 v199, v46, v142
    v_fmac_f32 v199, v47, v143
    v_mul_f32 v201, v48, v136
    v_fmac_f32 v201, v49, v137
    v_permlane32_swap_b32 v197, v199
    v_fmac_f32 v201, v50, v138
    v_fmac_f32 v201, v51, v139
    s_waitcnt lgkmcnt(2)
    v_mfma_f32_32x32x8_bf16 v[0:15], v[72:73], v[176:177], v[0:15]
    v_fmac_f32 v201, v52, v140
    v_fmac_f32 v201, v53, v141
    v_fmac_f32 v201, v54, v142
    v_fmac_f32 v201, v55, v143
    v_add_f32 v199, v197, v199
    v_mul_f32_e64 v203, v56, -v136
    v_fma_f32 v203, v57, -v137, v203
    v_fma_f32 v203, v58, -v138, v203
    v_fma_f32 v203, v59, -v139, v203
    v_fma_f32 v203, v60, -v140, v203
    v_fma_f32 v203, v61, -v141, v203
    s_add_u32 m0, s21, 6144
    v_mfma_f32_32x32x8_bf16 v[16:31], v[76:77], v[176:177], v[16:31]
    buffer_load_dwordx4 v236, s[4:7], s37 offen lds
    v_add_u32 v252, s43, v247
    ds_read_u16 v236, v252
    ds_read_u16 v237, v252 offset:64
    v_fma_f32 v203, v62, -v142, v203
    v_fma_f32 v203, v63, -v143, v203
    s_nop 1
    v_permlane32_swap_b32 v201, v203
    v_add_f32 v203, v201, v203
    s_set_gpr_idx_on s51, gpr_idx(DST)
    s_nop 0
    v_cvt_pk_bf16_f32 v204, v198, v199
    v_cvt_pk_bf16_f32 v205, v202, v203
    s_set_gpr_idx_off
    v_mfma_f32_32x32x16_bf16 v[32:47], v[64:67], v[180:183], 0
    v_mul_f32 v196, v0, v144
    v_fmac_f32 v196, v1, v145
    v_fmac_f32 v196, v2, v146
    v_fmac_f32 v196, v3, v147
    v_fmac_f32 v196, v4, v148
    v_fmac_f32 v196, v5, v149
    v_fmac_f32 v196, v6, v150
    v_fmac_f32 v196, v7, v151
    v_mfma_f32_32x32x16_bf16 v[48:63], v[68:71], v[180:183], 0
    s_waitcnt vmcnt(6)
    ds_read_b64_tr_b16 v[176:177], v244 offset:0
    ds_read_b64_tr_b16 v[178:179], v244 offset:1024
    ds_read_b64_tr_b16 v[180:181], v245 offset:0
    ds_read_b64_tr_b16 v[182:183], v245 offset:1024
    v_mul_f32 v198, v8, v112
    v_fmac_f32 v198, v9, v113
    v_fmac_f32 v198, v10, v114
    v_fmac_f32 v198, v11, v115
    v_fmac_f32 v198, v12, v116
    v_fmac_f32 v198, v13, v117
    v_fmac_f32 v198, v14, v118
    v_fmac_f32 v198, v15, v119
    v_mfma_f32_32x32x8_bf16 v[32:47], v[72:73], v[184:185], v[32:47]
    v_mul_f32_e64 v200, v16, -v160
    v_fma_f32 v200, v17, -v161, v200
    v_fma_f32 v200, v18, -v162, v200
    v_fma_f32 v200, v19, -v163, v200
    v_fma_f32 v200, v20, -v164, v200
    v_fma_f32 v200, v21, -v165, v200
    v_fma_f32 v200, v22, -v166, v200
    v_fma_f32 v200, v23, -v167, v200
    v_mfma_f32_32x32x8_bf16 v[48:63], v[76:77], v[184:185], v[48:63]
    v_mul_f32_e64 v202, v24, -v160
    v_fma_f32 v202, v25, -v161, v202
    v_fma_f32 v202, v26, -v162, v202
    v_fma_f32 v202, v27, -v163, v202
    v_fma_f32 v202, v28, -v164, v202
    v_fma_f32 v202, v29, -v165, v202
    v_fma_f32 v202, v30, -v166, v202
    v_fma_f32 v202, v31, -v167, v202
    s_waitcnt vmcnt(5) lgkmcnt(0)
    v_mfma_f32_32x32x16_bf16 v[0:15], v[64:67], v[176:179], 0
    v_mul_f32 v197, v32, v152
    v_fmac_f32 v197, v33, v153
    v_fmac_f32 v197, v34, v154
    v_fmac_f32 v197, v35, v155
    v_fmac_f32 v197, v36, v156
    v_fmac_f32 v197, v37, v157
    v_fmac_f32 v197, v38, v158
    v_fmac_f32 v197, v39, v159
    s_add_u32 m0, s21, 0
    v_mfma_f32_32x32x16_bf16 v[16:31], v[68:71], v[176:179], 0
    v_lshl_add_u32 v234, v234, 10, v246
    v_lshl_add_u32 v235, v235, 10, v246
    buffer_load_dwordx4 v234, s[4:7], s38 offen lds
    buffer_load_dwordx4 v235, s[8:11], s38 offen offset:1024 lds
    ds_read_b64_tr_b16 v[176:177], v244 offset:2048
    ds_read_b64_tr_b16 v[184:185], v245 offset:2048
    v_mul_f32 v199, v40, v120
    v_fmac_f32 v199, v41, v121
    v_fmac_f32 v199, v42, v122
    v_fmac_f32 v199, v43, v123
    v_fmac_f32 v199, v44, v124
    v_fmac_f32 v199, v45, v125
    v_fmac_f32 v199, v46, v126
    v_fmac_f32 v199, v47, v127
    s_waitcnt lgkmcnt(0)
    v_mfma_f32_32x32x8_bf16 v[0:15], v[72:73], v[176:177], v[0:15]
    v_mul_f32_e64 v201, v48, -v168
    v_fma_f32 v201, v49, -v169, v201
    v_fma_f32 v201, v50, -v170, v201
    v_fma_f32 v201, v51, -v171, v201
    v_fma_f32 v201, v52, -v172, v201
    v_fma_f32 v201, v53, -v173, v201
    v_fma_f32 v201, v54, -v174, v201
    v_fma_f32 v201, v55, -v175, v201
    s_add_u32 m0, s21, 2048
    v_mfma_f32_32x32x8_bf16 v[16:31], v[76:77], v[176:177], v[16:31]
    v_lshl_add_u32 v236, v236, 10, v246
    v_lshl_add_u32 v237, v237, 10, v246
    buffer_load_dwordx4 v236, s[4:7], s39 offen lds
    buffer_load_dwordx4 v237, s[8:11], s39 offen offset:1024 lds
    v_mul_f32_e64 v203, v56, -v168
    v_fma_f32 v203, v57, -v169, v203
    v_fma_f32 v203, v58, -v170, v203
    v_fma_f32 v203, v59, -v171, v203
    v_fma_f32 v203, v60, -v172, v203
    v_fma_f32 v203, v61, -v173, v203
    v_fma_f32 v203, v62, -v174, v203
    v_fma_f32 v203, v63, -v175, v203
    v_mfma_f32_32x32x16_bf16 v[32:47], v[64:67], v[180:183], 0
    v_mul_f32 v254, v0, v144
    v_fmac_f32 v254, v1, v145
    v_fmac_f32 v254, v2, v146
    v_fmac_f32 v254, v3, v147
    v_fmac_f32 v254, v4, v148
    v_mfma_f32_32x32x16_bf16 v[48:63], v[68:71], v[180:183], 0
    ds_swizzle_b32 v68, v68 offset:0x401F
    ds_swizzle_b32 v69, v69 offset:0x401F
    ds_swizzle_b32 v70, v70 offset:0x401F
    ds_swizzle_b32 v71, v71 offset:0x401F
    s_waitcnt vmcnt(7)
    ds_read_b64_tr_b16 v[176:177], v244 offset:4096
    ds_read_b64_tr_b16 v[178:179], v244 offset:5120
    ds_read_b64_tr_b16 v[180:181], v245 offset:4096
    ds_read_b64_tr_b16 v[182:183], v245 offset:5120
    v_fmac_f32 v254, v5, v149
    v_fmac_f32 v254, v6, v150
    v_fmac_f32 v254, v7, v151
    v_fmac_f32 v200, v8, v160
    v_mfma_f32_32x32x8_bf16 v[32:47], v[72:73], v[184:185], v[32:47]
    v_fmac_f32 v200, v9, v161
    v_permlane32_swap_b32 v196, v254
    v_fmac_f32 v200, v10, v162
    v_fmac_f32 v200, v11, v163
    v_fmac_f32 v200, v12, v164
    v_mfma_f32_32x32x8_bf16 v[48:63], v[76:77], v[184:185], v[48:63]
    ds_swizzle_b32 v76, v76 offset:0x401F
    ds_swizzle_b32 v77, v77 offset:0x401F
    v_fmac_f32 v200, v13, v165
    v_fmac_f32 v200, v14, v166
    v_fmac_f32 v200, v15, v167
    v_add_f32 v254, v196, v254
    s_waitcnt lgkmcnt(6)
    s_mov_b64 exec, s[56:57]
    v_xor_b32 v68, 0x80008000, v68
    v_xor_b32 v69, 0x80008000, v69
    v_xor_b32 v70, 0x80008000, v70
    v_xor_b32 v71, 0x80008000, v71
    s_mov_b64 exec, -1
    s_waitcnt vmcnt(4) lgkmcnt(2)
    v_mfma_f32_32x32x16_bf16 v[0:15], v[64:67], v[176:179], 0
    v_mul_f32 v255, v32, v152
    v_fmac_f32 v255, v33, v153
    v_fmac_f32 v255, v34, v154
    v_fmac_f32 v255, v35, v155
    v_fmac_f32 v255, v36, v156
    v_fmac_f32 v255, v37, v157
    s_add_u32 m0, s21, 4096
    v_mfma_f32_32x32x16_bf16 v[16:31], v[68:71], v[176:179], v[16:31]
    v_lshl_add_u32 v238, v238, 10, v246
    v_lshl_add_u32 v239, v239, 10, v246
    buffer_load_dwordx4 v238, s[4:7], s40 offen lds
    buffer_load_dwordx4 v239, s[8:11], s40 offen offset:1024 lds
    ds_read_b64_tr_b16 v[176:177], v244 offset:6144
    ds_read_b64_tr_b16 v[184:185], v245 offset:6144
    v_fmac_f32 v255, v38, v158
    v_fmac_f32 v255, v39, v159
    v_fmac_f32 v201, v40, v168
    v_fmac_f32 v201, v41, v169
    v_permlane32_swap_b32 v197, v255
    s_waitcnt lgkmcnt(0)
    s_mov_b64 exec, s[56:57]
    v_xor_b32 v76, 0x80008000, v76
    v_xor_b32 v77, 0x80008000, v77
    s_mov_b64 exec, -1
    v_mfma_f32_32x32x8_bf16 v[0:15], v[72:73], v[176:177], v[0:15]
    v_fmac_f32 v201, v42, v170
    v_fmac_f32 v201, v43, v171
    v_fmac_f32 v201, v44, v172
    v_fmac_f32 v201, v45, v173
    v_fmac_f32 v201, v46, v174
    v_fmac_f32 v201, v47, v175
    s_add_u32 m0, s21, 6144
    v_mfma_f32_32x32x8_bf16 v[16:31], v[76:77], v[176:177], v[16:31]
    v_lshl_add_u32 v240, v240, 10, v246
    v_lshl_add_u32 v241, v241, 10, v246
    buffer_load_dwordx4 v240, s[4:7], s41 offen lds
    buffer_load_dwordx4 v241, s[8:11], s41 offen offset:1024 lds
    v_add_f32 v255, v197, v255
    s_set_gpr_idx_on s51, gpr_idx(DST)
    s_nop 0
    v_cvt_pk_bf16_f32 v206, v254, v255
    s_set_gpr_idx_off
    v_mfma_f32_32x32x16_bf16 v[32:47], v[64:67], v[180:183], 0
    v_mul_f32 v254, v0, v144
    v_fmac_f32 v254, v1, v145
    v_fmac_f32 v254, v2, v146
    v_fmac_f32 v254, v3, v147
    v_fmac_f32 v254, v4, v148
    v_fmac_f32 v254, v5, v149
    v_fmac_f32 v254, v6, v150
    v_fmac_f32 v254, v7, v151
    v_fma_f32 v202, v8, -v160, v202
    v_fma_f32 v202, v9, -v161, v202
    v_mfma_f32_32x32x16_bf16 v[48:63], v[68:71], v[180:183], v[48:63]
    s_waitcnt vmcnt(6)
    ds_read_b64_tr_b16 v[176:177], v244 offset:0
    ds_read_b64_tr_b16 v[178:179], v244 offset:1024
    ds_read_b64_tr_b16 v[180:181], v245 offset:0
    ds_read_b64_tr_b16 v[182:183], v245 offset:1024
    v_permlane32_swap_b32 v254, v200
    v_fma_f32 v202, v10, -v162, v202
    v_fma_f32 v202, v11, -v163, v202
    v_fma_f32 v202, v12, -v164, v202
    v_fma_f32 v202, v13, -v165, v202
    v_fma_f32 v202, v14, -v166, v202
    v_fma_f32 v202, v15, -v167, v202
    v_add_f32 v200, v254, v200
    v_fmac_f32 v198, v16, v112
    v_permlane32_swap_b32 v202, v254
    v_mfma_f32_32x32x8_bf16 v[32:47], v[72:73], v[184:185], v[32:47]
    v_fmac_f32 v198, v17, v113
    v_fmac_f32 v198, v18, v114
    v_fmac_f32 v198, v19, v115
    v_fmac_f32 v198, v20, v116
    v_fmac_f32 v198, v21, v117
    v_fmac_f32 v198, v22, v118
    v_fmac_f32 v198, v23, v119
    v_add_f32 v254, v202, v254
    v_mul_f32 v196, v24, v160
    v_fmac_f32 v196, v25, v161
    v_mfma_f32_32x32x8_bf16 v[48:63], v[76:77], v[184:185], v[48:63]
    v_add_u32 v249, s48, v249
    v_add_u32 v250, s49, v250
    ds_read_b32 v252, v251 offset:16
    ds_read_b64_tr_b16 v[68:69], v249 offset:0
    ds_read_b64_tr_b16 v[70:71], v249 offset:256
    s_mov_b64 exec, s[54:55]
    ds_read_u16_d16_hi v242, v250 offset:0
    s_mov_b64 exec, -1
    v_fmac_f32 v196, v26, v162
    v_fmac_f32 v196, v27, v163
    v_fmac_f32 v196, v28, v164
    v_fmac_f32 v196, v29, v165
    v_fmac_f32 v196, v30, v166
    v_fmac_f32 v196, v31, v167
    s_nop 1
    v_permlane32_swap_b32 v198, v196
    v_add_f32 v196, v198, v196
    v_mul_f32 v255, v32, v152
    v_fmac_f32 v255, v33, v153
    v_fmac_f32 v255, v34, v154
    v_fmac_f32 v255, v35, v155
    v_fmac_f32 v255, v36, v156
    v_fmac_f32 v255, v37, v157
    v_fmac_f32 v255, v38, v158
    v_fmac_f32 v255, v39, v159
    v_fma_f32 v203, v40, -v168, v203
    v_fma_f32 v203, v41, -v169, v203
    v_permlane32_swap_b32 v255, v201
    v_fma_f32 v203, v42, -v170, v203
    v_fma_f32 v203, v43, -v171, v203
    v_fma_f32 v203, v44, -v172, v203
    v_fma_f32 v203, v45, -v173, v203
    v_fma_f32 v203, v46, -v174, v203
    v_fma_f32 v203, v47, -v175, v203
    v_add_f32 v201, v255, v201
    v_fmac_f32 v199, v48, v120
    v_permlane32_swap_b32 v203, v255
    v_fmac_f32 v199, v49, v121
    v_fmac_f32 v199, v50, v122
    v_fmac_f32 v199, v51, v123
    v_fmac_f32 v199, v52, v124
    v_fmac_f32 v199, v53, v125
    v_fmac_f32 v199, v54, v126
    v_fmac_f32 v199, v55, v127
    v_add_f32 v255, v203, v255
    v_mul_f32 v197, v56, v168
    v_fmac_f32 v197, v57, v169
    v_fmac_f32 v197, v58, v170
    v_fmac_f32 v197, v59, v171
    v_fmac_f32 v197, v60, v172
    v_fmac_f32 v197, v61, v173
    v_fmac_f32 v197, v62, v174
    v_fmac_f32 v197, v63, v175
    s_nop 1
    v_permlane32_swap_b32 v199, v197
    v_add_f32 v197, v199, v197
    s_set_gpr_idx_on s51, gpr_idx(DST)
    s_nop 0
    v_cvt_pk_bf16_f32 v207, v200, v201
    v_cvt_pk_bf16_f32 v209, v254, v255
    v_cvt_pk_bf16_f32 v208, v196, v197
    s_set_gpr_idx_off
    s_add_u32 s50, s50, 1
    s_add_u32 s51, s51, 6
    s_cmp_ge_u32 s50, 4
    s_cbranch_scc1 LAST0
    s_waitcnt lgkmcnt(3)
    v_readfirstlane_b32 s66, v252
    s_add_u32 s53, s53, 1
    v_mov_b32 v252, s53
    s_cmp_le_u32 s53, s66
    ds_write2_b32 v251, v252, v252 offset0:0 offset1:8
    s_setprio 1
    s_cbranch_scc1 PRIO_6
    s_setprio 0
PRIO_6:
    s_cmp_eq_u32 s52, 4
    s_cbranch_scc1 ITEM_0_4
    s_cmp_eq_u32 s52, 5
    s_cbranch_scc1 ITEM_0_5
    s_cmp_eq_u32 s52, 3
    s_cbranch_scc1 ITEM_0_3
    s_cmp_eq_u32 s52, 6
    s_cbranch_scc1 ITEM_0_6
    s_cmp_eq_u32 s52, 8
    s_cbranch_scc1 ITEM_0_8
    s_branch ITEM_0_2
.p2align 6
ITEM_0_6:
    s_mov_b64 exec, s[54:55]
    ds_read_u16_d16_hi v243, v250 offset:128
    s_mov_b64 exec, -1
    ds_read_b64_tr_b16 v[76:77], v249 offset:512
    ds_read_b64_tr_b16 v[78:79], v249 offset:768
    ds_read_b64_tr_b16 v[84:85], v249 offset:1024
    ds_read_b64_tr_b16 v[86:87], v249 offset:1280
    s_waitcnt lgkmcnt(5)
    v_lshlrev_b32 v196, 16, v68
    v_and_b32 v197, 0xffff0000, v68
    v_lshlrev_b32 v198, 16, v69
    v_and_b32 v199, 0xffff0000, v69
    v_mul_f32_dpp v200, v242, v196 row_newbcast:0 row_mask:0xf bank_mask:0xf
    v_mul_f32_dpp v201, v242, v197 row_newbcast:1 row_mask:0xf bank_mask:0xf
    v_mul_f32_dpp v202, v242, v196 row_newbcast:8 row_mask:0xf bank_mask:0xf
    v_mul_f32_dpp v203, v242, v197 row_newbcast:9 row_mask:0xf bank_mask:0xf
    v_lshlrev_b32 v196, 16, v70
    v_and_b32 v197, 0xffff0000, v70
    v_cvt_pk_bf16_f32 v64, v200, v201
    v_cvt_pk_bf16_f32 v68, v202, v203
    v_mul_f32_dpp v200, v242, v198 row_newbcast:2 row_mask:0xf bank_mask:0xf
    v_mul_f32_dpp v201, v242, v199 row_newbcast:3 row_mask:0xf bank_mask:0xf
    v_mul_f32_dpp v202, v242, v198 row_newbcast:10 row_mask:0xf bank_mask:0xf
    v_mul_f32_dpp v203, v242, v199 row_newbcast:11 row_mask:0xf bank_mask:0xf
    v_lshlrev_b32 v198, 16, v71
    v_and_b32 v199, 0xffff0000, v71
    v_cvt_pk_bf16_f32 v65, v200, v201
    v_cvt_pk_bf16_f32 v69, v202, v203
    v_mul_f32_dpp v200, v242, v196 row_newbcast:4 row_mask:0xf bank_mask:0xf
    v_mul_f32_dpp v201, v242, v197 row_newbcast:5 row_mask:0xf bank_mask:0xf
    v_mul_f32_dpp v202, v242, v196 row_newbcast:12 row_mask:0xf bank_mask:0xf
    v_mul_f32_dpp v203, v242, v197 row_newbcast:13 row_mask:0xf bank_mask:0xf
    v_cvt_pk_bf16_f32 v66, v200, v201
    v_cvt_pk_bf16_f32 v70, v202, v203
    v_mul_f32_dpp v200, v242, v198 row_newbcast:6 row_mask:0xf bank_mask:0xf
    v_mul_f32_dpp v201, v242, v199 row_newbcast:7 row_mask:0xf bank_mask:0xf
    v_mul_f32_dpp v202, v242, v198 row_newbcast:14 row_mask:0xf bank_mask:0xf
    v_mul_f32_dpp v203, v242, v199 row_newbcast:15 row_mask:0xf bank_mask:0xf
    v_cvt_pk_bf16_f32 v67, v200, v201
    v_cvt_pk_bf16_f32 v71, v202, v203
    s_mov_b64 exec, s[54:55]
    ds_read_u16_d16_hi v242, v250 offset:256
    s_mov_b64 exec, -1
    s_waitcnt vmcnt(4) lgkmcnt(3)
    v_mfma_f32_32x32x16_bf16 v[0:15], v[64:67], v[176:179], 0
    v_lshlrev_b32 v196, 16, v76
    v_and_b32 v197, 0xffff0000, v76
    v_lshlrev_b32 v198, 16, v77
    v_and_b32 v199, 0xffff0000, v77
    v_mul_f32_dpp v200, v243, v196 row_newbcast:0 row_mask:0xf bank_mask:0xf
    v_mul_f32_dpp v201, v243, v197 row_newbcast:1 row_mask:0xf bank_mask:0xf
    v_mul_f32_dpp v202, v243, v196 row_newbcast:8 row_mask:0xf bank_mask:0xf
    v_mul_f32_dpp v203, v243, v197 row_newbcast:9 row_mask:0xf bank_mask:0xf
    v_lshlrev_b32 v196, 16, v78
    v_and_b32 v197, 0xffff0000, v78
    v_cvt_pk_bf16_f32 v72, v200, v201
    v_cvt_pk_bf16_f32 v76, v202, v203
    v_mul_f32_dpp v200, v243, v198 row_newbcast:2 row_mask:0xf bank_mask:0xf
    v_mul_f32_dpp v201, v243, v199 row_newbcast:3 row_mask:0xf bank_mask:0xf
    v_mul_f32_dpp v202, v243, v198 row_newbcast:10 row_mask:0xf bank_mask:0xf
    v_mul_f32_dpp v203, v243, v199 row_newbcast:11 row_mask:0xf bank_mask:0xf
    s_add_u32 m0, s21, 0
    v_mfma_f32_32x32x16_bf16 v[16:31], v[68:71], v[176:179], 0
    buffer_load_dwordx4 v236, s[4:7], s35 offen lds
    buffer_load_dwordx4 v237, s[8:11], s35 offen offset:1024 lds
    ds_read_b64_tr_b16 v[176:177], v244 offset:2048
    ds_read_b64_tr_b16 v[178:179], v244 offset:3072
    ds_read_b64_tr_b16 v[184:185], v245 offset:2048
    ds_read_b64_tr_b16 v[186:187], v245 offset:3072
    v_lshlrev_b32 v198, 16, v79
    v_and_b32 v199, 0xffff0000, v79
    v_cvt_pk_bf16_f32 v73, v200, v201
    v_cvt_pk_bf16_f32 v77, v202, v203
    v_mul_f32_dpp v200, v243, v196 row_newbcast:4 row_mask:0xf bank_mask:0xf
    v_mul_f32_dpp v201, v243, v197 row_newbcast:5 row_mask:0xf bank_mask:0xf
    v_mul_f32_dpp v202, v243, v196 row_newbcast:12 row_mask:0xf bank_mask:0xf
    v_mul_f32_dpp v203, v243, v197 row_newbcast:13 row_mask:0xf bank_mask:0xf
    v_cvt_pk_bf16_f32 v74, v200, v201
    v_cvt_pk_bf16_f32 v78, v202, v203
    v_mul_f32_dpp v200, v243, v198 row_newbcast:6 row_mask:0xf bank_mask:0xf
    v_mul_f32_dpp v201, v243, v199 row_newbcast:7 row_mask:0xf bank_mask:0xf
    v_mul_f32_dpp v202, v243, v198 row_newbcast:14 row_mask:0xf bank_mask:0xf
    v_mul_f32_dpp v203, v243, v199 row_newbcast:15 row_mask:0xf bank_mask:0xf
    v_cvt_pk_bf16_f32 v75, v200, v201
    v_cvt_pk_bf16_f32 v79, v202, v203
    s_nop 0
    s_waitcnt vmcnt(4) lgkmcnt(0)
    v_mfma_f32_32x32x16_bf16 v[0:15], v[72:75], v[176:179], v[0:15]
    v_lshlrev_b32 v196, 16, v84
    v_and_b32 v197, 0xffff0000, v84
    v_lshlrev_b32 v198, 16, v85
    v_and_b32 v199, 0xffff0000, v85
    v_mul_f32_dpp v200, v242, v196 row_newbcast:0 row_mask:0xf bank_mask:0xf
    v_mul_f32_dpp v201, v242, v197 row_newbcast:1 row_mask:0xf bank_mask:0xf
    v_mul_f32_dpp v202, v242, v196 row_newbcast:8 row_mask:0xf bank_mask:0xf
    v_mul_f32_dpp v203, v242, v197 row_newbcast:9 row_mask:0xf bank_mask:0xf
    v_lshlrev_b32 v196, 16, v86
    v_and_b32 v197, 0xffff0000, v86
    v_cvt_pk_bf16_f32 v80, v200, v201
    v_cvt_pk_bf16_f32 v84, v202, v203
    v_mul_f32_dpp v200, v242, v198 row_newbcast:2 row_mask:0xf bank_mask:0xf
    v_mul_f32_dpp v201, v242, v199 row_newbcast:3 row_mask:0xf bank_mask:0xf
    v_mul_f32_dpp v202, v242, v198 row_newbcast:10 row_mask:0xf bank_mask:0xf
    v_mul_f32_dpp v203, v242, v199 row_newbcast:11 row_mask:0xf bank_mask:0xf
    s_add_u32 m0, s21, 2048
    v_mfma_f32_32x32x16_bf16 v[16:31], v[76:79], v[176:179], v[16:31]
    buffer_load_dwordx4 v238, s[4:7], s35 offen lds
    buffer_load_dwordx4 v239, s[8:11], s35 offen offset:1024 lds
    ds_read_b64_tr_b16 v[176:177], v244 offset:4096
    ds_read_b64_tr_b16 v[178:179], v244 offset:5120
    ds_read_b64_tr_b16 v[188:189], v245 offset:4096
    ds_read_b64_tr_b16 v[190:191], v245 offset:5120
    v_lshlrev_b32 v198, 16, v87
    v_and_b32 v199, 0xffff0000, v87
    v_cvt_pk_bf16_f32 v81, v200, v201
    v_cvt_pk_bf16_f32 v85, v202, v203
    v_mul_f32_dpp v200, v242, v196 row_newbcast:4 row_mask:0xf bank_mask:0xf
    v_mul_f32_dpp v201, v242, v197 row_newbcast:5 row_mask:0xf bank_mask:0xf
    v_mul_f32_dpp v202, v242, v196 row_newbcast:12 row_mask:0xf bank_mask:0xf
    v_mul_f32_dpp v203, v242, v197 row_newbcast:13 row_mask:0xf bank_mask:0xf
    v_cvt_pk_bf16_f32 v82, v200, v201
    v_cvt_pk_bf16_f32 v86, v202, v203
    v_mul_f32_dpp v200, v242, v198 row_newbcast:6 row_mask:0xf bank_mask:0xf
    v_mul_f32_dpp v201, v242, v199 row_newbcast:7 row_mask:0xf bank_mask:0xf
    v_mul_f32_dpp v202, v242, v198 row_newbcast:14 row_mask:0xf bank_mask:0xf
    v_mul_f32_dpp v203, v242, v199 row_newbcast:15 row_mask:0xf bank_mask:0xf
    v_cvt_pk_bf16_f32 v83, v200, v201
    v_cvt_pk_bf16_f32 v87, v202, v203
    s_nop 0
    s_waitcnt lgkmcnt(0)
    v_mfma_f32_32x32x16_bf16 v[0:15], v[80:83], v[176:179], v[0:15]
    s_add_u32 m0, s21, 4096
    v_mfma_f32_32x32x16_bf16 v[16:31], v[84:87], v[176:179], v[16:31]
    buffer_load_dwordx4 v234, s[4:7], s36 offen lds
    buffer_load_dwordx4 v235, s[8:11], s36 offen offset:1024 lds
    s_mov_b32 m0, s50
    s_nop 0
    s_movrels_b32 s71, s23
    s_bfe_u32 s46, s71, 0x30012
    s_mov_b32 m0, s46
    s_and_b32 s66, s71, 0x3ffff
    s_movrels_b32 s68, s57
    s_movrels_b32 s69, s61
    s_sub_u32 s48, s66, s47
    s_mov_b32 s47, s66
    s_lshr_b32 s52, s71, 28
    s_lshl_b32 s67, s46, 9
    s_add_u32 s66, s66, s67
    s_sub_u32 s49, s66, s42
    s_mov_b32 s42, s66
    s_bfe_u32 s66, s68, 655360
    s_add_u32 s43, s42, s66
    s_bfe_u32 s39, s69, 655360
    s_bfe_u32 s66, s68, 655370
    s_add_u32 s44, s42, s66
    s_bfe_u32 s40, s69, 655370
    s_bfe_u32 s66, s68, 655380
    s_add_u32 s45, s42, s66
    s_bfe_u32 s41, s69, 655380
    s_and_b32 s66, s46, s33
    s_cselect_b32 s72, -1, 1
    s_cselect_b32 s76, s47, 86912
    s_cmp_ge_u32 s66, 2
    s_cselect_b32 s73, -1, 0
    s_add_u32 s77, s47, 1024
    s_cmp_ge_u32 s66, 4
    s_cselect_b32 s75, -1, 0
    s_cmp_ge_u32 s66, 3
    s_cselect_b32 s74, -1, 1
    s_cselect_b32 s77, s77, 86912
    v_add_u32 v252, s45, v247
    ds_read_u16 v240, v252
    ds_read_u16 v241, v252 offset:64
    v_mfma_f32_32x32x16_bf16 v[32:47], v[64:67], v[180:183], 0
    v_mul_f32 v196, v0, v96
    v_fmac_f32 v196, v1, v97
    v_fmac_f32 v196, v2, v98
    v_fmac_f32 v196, v3, v99
    v_fmac_f32 v196, v4, v100
    v_fmac_f32 v196, v5, v101
    v_fmac_f32 v196, v6, v102
    v_mfma_f32_32x32x16_bf16 v[48:63], v[68:71], v[180:183], 0
    v_lshl_add_u32 v253, v248, 2, s47
    ds_read_b32 v254, v253
    ds_read_b32 v255, v253 offset:1024
    v_fmac_f32 v196, v7, v103
    v_mul_f32 v198, v8, v128
    v_fmac_f32 v198, v9, v129
    v_fmac_f32 v198, v10, v130
    v_fmac_f32 v198, v11, v131
    v_fmac_f32 v198, v12, v132
    v_mfma_f32_32x32x16_bf16 v[32:47], v[72:75], v[184:187], v[32:47]
    v_fmac_f32 v198, v13, v133
    v_fmac_f32 v198, v14, v134
    v_fmac_f32 v198, v15, v135
    v_mul_f32 v200, v16, v128
    v_fmac_f32 v200, v17, v129
    v_permlane32_swap_b32 v196, v198
    v_mfma_f32_32x32x16_bf16 v[48:63], v[76:79], v[184:187], v[48:63]
    s_waitcnt vmcnt(6)
    ds_read_b64_tr_b16 v[176:177], v244 offset:6144
    ds_read_b64_tr_b16 v[178:179], v244 offset:7168
    ds_read_b64_tr_b16 v[180:181], v245 offset:6144
    ds_read_b64_tr_b16 v[182:183], v245 offset:7168
    v_fmac_f32 v200, v18, v130
    v_fmac_f32 v200, v19, v131
    v_fmac_f32 v200, v20, v132
    v_fmac_f32 v200, v21, v133
    v_fmac_f32 v200, v22, v134
    v_fmac_f32 v200, v23, v135
    v_mfma_f32_32x32x16_bf16 v[32:47], v[80:83], v[188:191], v[32:47]
    v_add_f32 v198, v196, v198
    v_mul_f32_e64 v202, v24, -v128
    v_fma_f32 v202, v25, -v129, v202
    v_fma_f32 v202, v26, -v130, v202
    v_fma_f32 v202, v27, -v131, v202
    v_fma_f32 v202, v28, -v132, v202
    v_mfma_f32_32x32x16_bf16 v[48:63], v[84:87], v[188:191], v[48:63]
    v_fma_f32 v202, v29, -v133, v202
    v_fma_f32 v202, v30, -v134, v202
    v_fma_f32 v202, v31, -v135, v202
    s_nop 1
    v_permlane32_swap_b32 v200, v202
    v_add_f32 v202, v200, v202
    s_waitcnt vmcnt(4) lgkmcnt(0)
    v_mfma_f32_32x32x16_bf16 v[0:15], v[64:67], v[176:179], 0
    v_mul_f32 v197, v32, v104
    v_fmac_f32 v197, v33, v105
    v_fmac_f32 v197, v34, v106
    v_fmac_f32 v197, v35, v107
    v_fmac_f32 v197, v36, v108
    v_fmac_f32 v197, v37, v109
    v_fmac_f32 v197, v38, v110
    s_add_u32 m0, s21, 6144
    v_mfma_f32_32x32x16_bf16 v[16:31], v[68:71], v[176:179], 0
    buffer_load_dwordx4 v236, s[4:7], s36 offen lds
    buffer_load_dwordx4 v237, s[8:11], s36 offen offset:1024 lds
    ds_read_b64_tr_b16 v[176:177], v244 offset:0
    ds_read_b64_tr_b16 v[178:179], v244 offset:1024
    ds_read_b64_tr_b16 v[184:185], v245 offset:0
    ds_read_b64_tr_b16 v[186:187], v245 offset:1024
    s_mov_b32 m0, s76
    s_mov_b64 exec, s[72:73]
    buffer_load_dwordx4 v254, s[12:15], 0 offen  lds
    s_mov_b32 m0, s77
    s_mov_b64 exec, s[74:75]
    buffer_load_dwordx4 v255, s[12:15], 0 offen  lds
    s_mov_b64 exec, -1
    v_fmac_f32 v197, v39, v111
    v_mul_f32 v199, v40, v136
    v_fmac_f32 v199, v41, v137
    v_fmac_f32 v199, v42, v138
    v_fmac_f32 v199, v43, v139
    v_fmac_f32 v199, v44, v140
    v_fmac_f32 v199, v45, v141
    s_waitcnt vmcnt(6) lgkmcnt(0)
    v_mfma_f32_32x32x16_bf16 v[0:15], v[72:75], v[176:179], v[0:15]
    v_fmac_f32 v199, v46, v142
    v_fmac_f32 v199, v47, v143
    v_mul_f32 v201, v48, v136
    v_fmac_f32 v201, v49, v137
    v_permlane32_swap_b32 v197, v199
    v_fmac_f32 v201, v50, v138
    v_fmac_f32 v201, v51, v139
    s_add_u32 m0, s21, 0
    v_mfma_f32_32x32x16_bf16 v[16:31], v[76:79], v[176:179], v[16:31]
    buffer_load_dwordx4 v238, s[4:7], s36 offen lds
    buffer_load_dwordx4 v239, s[8:11], s36 offen offset:1024 lds
    ds_read_b64_tr_b16 v[176:177], v244 offset:2048
    ds_read_b64_tr_b16 v[178:179], v244 offset:3072
    ds_read_b64_tr_b16 v[188:189], v245 offset:2048
    ds_read_b64_tr_b16 v[190:191], v245 offset:3072
    v_fmac_f32 v201, v52, v140
    v_fmac_f32 v201, v53, v141
    v_fmac_f32 v201, v54, v142
    v_fmac_f32 v201, v55, v143
    v_add_f32 v199, v197, v199
    v_mul_f32_e64 v203, v56, -v136
    v_fma_f32 v203, v57, -v137, v203
    s_waitcnt lgkmcnt(0)
    v_mfma_f32_32x32x16_bf16 v[0:15], v[80:83], v[176:179], v[0:15]
    v_fma_f32 v203, v58, -v138, v203
    v_fma_f32 v203, v59, -v139, v203
    v_fma_f32 v203, v60, -v140, v203
    v_fma_f32 v203, v61, -v141, v203
    v_fma_f32 v203, v62, -v142, v203
    v_fma_f32 v203, v63, -v143, v203
    s_nop 1
    s_add_u32 m0, s21, 2048
    v_mfma_f32_32x32x16_bf16 v[16:31], v[84:87], v[176:179], v[16:31]
    buffer_load_dwordx4 v234, s[4:7], s37 offen lds
    buffer_load_dwordx4 v235, s[8:11], s37 offen offset:1024 lds
    v_add_u32 v252, s42, v247
    ds_read_u16 v234, v252
    ds_read_u16 v235, v252 offset:64
    v_permlane32_swap_b32 v201, v203
    v_add_f32 v203, v201, v203
    s_set_gpr_idx_on s51, gpr_idx(DST)
    s_nop 0
    v_cvt_pk_bf16_f32 v204, v198, v199
    v_cvt_pk_bf16_f32 v205, v202, v203
    s_set_gpr_idx_off
    v_mfma_f32_32x32x16_bf16 v[32:47], v[64:67], v[180:183], 0
    v_mul_f32 v196, v0, v144
    v_fmac_f32 v196, v1, v145
    v_fmac_f32 v196, v2, v146
    v_fmac_f32 v196, v3, v147
    v_fmac_f32 v196, v4, v148
    v_fmac_f32 v196, v5, v149
    v_mfma_f32_32x32x16_bf16 v[48:63], v[68:71], v[180:183], 0
    v_fmac_f32 v196, v6, v150
    v_fmac_f32 v196, v7, v151
    v_mul_f32 v198, v8, v112
    v_fmac_f32 v198, v9, v113
    v_fmac_f32 v198, v10, v114
    v_mfma_f32_32x32x16_bf16 v[32:47], v[72:75], v[184:187], v[32:47]
    v_fmac_f32 v198, v11, v115
    v_fmac_f32 v198, v12, v116
    v_fmac_f32 v198, v13, v117
    v_fmac_f32 v198, v14, v118
    v_fmac_f32 v198, v15, v119
    v_mfma_f32_32x32x16_bf16 v[48:63], v[76:79], v[184:187], v[48:63]
    s_waitcnt vmcnt(8)
    ds_read_b64_tr_b16 v[176:177], v244 offset:4096
    ds_read_b64_tr_b16 v[178:179], v244 offset:5120
    ds_read_b64_tr_b16 v[180:181], v245 offset:4096
    ds_read_b64_tr_b16 v[182:183], v245 offset:5120
    v_mul_f32_e64 v200, v16, -v160
    v_fma_f32 v200, v17, -v161, v200
    v_fma_f32 v200, v18, -v162, v200
    v_fma_f32 v200, v19, -v163, v200
    v_fma_f32 v200, v20, -v164, v200
    v_fma_f32 v200, v21, -v165, v200
    v_mfma_f32_32x32x16_bf16 v[32:47], v[80:83], v[188:191], v[32:47]
    v_fma_f32 v200, v22, -v166, v200
    v_fma_f32 v200, v23, -v167, v200
    v_mul_f32_e64 v202, v24, -v160
    v_fma_f32 v202, v25, -v161, v202
    v_fma_f32 v202, v26, -v162, v202
    v_mfma_f32_32x32x16_bf16 v[48:63], v[84:87], v[188:191], v[48:63]
    v_fma_f32 v202, v27, -v163, v202
    v_fma_f32 v202, v28, -v164, v202
    v_fma_f32 v202, v29, -v165, v202
    v_fma_f32 v202, v30, -v166, v202
    v_fma_f32 v202, v31, -v167, v202
    s_waitcnt vmcnt(6) lgkmcnt(0)
    v_mfma_f32_32x32x16_bf16 v[0:15], v[64:67], v[176:179], 0
    v_mul_f32 v197, v32, v152
    v_fmac_f32 v197, v33, v153
    v_fmac_f32 v197, v34, v154
    v_fmac_f32 v197, v35, v155
    v_fmac_f32 v197, v36, v156
    v_fmac_f32 v197, v37, v157
    s_add_u32 m0, s21, 4096
    v_mfma_f32_32x32x16_bf16 v[16:31], v[68:71], v[176:179], 0
    buffer_load_dwordx4 v236, s[4:7], s37 offen lds
    buffer_load_dwordx4 v237, s[8:11], s37 offen offset:1024 lds
    ds_read_b64_tr_b16 v[176:177], v244 offset:6144
    ds_read_b64_tr_b16 v[178:179], v244 offset:7168
    ds_read_b64_tr_b16 v[184:185], v245 offset:6144
    ds_read_b64_tr_b16 v[186:187], v245 offset:7168
    v_add_u32 v252, s43, v247
    ds_read_u16 v236, v252
    ds_read_u16 v237, v252 offset:64
    v_fmac_f32 v197, v38, v158
    v_fmac_f32 v197, v39, v159
    v_mul_f32 v199, v40, v120
    v_fmac_f32 v199, v41, v121
    v_fmac_f32 v199, v42, v122
    s_waitcnt vmcnt(4) lgkmcnt(2)
    v_mfma_f32_32x32x16_bf16 v[0:15], v[72:75], v[176:179], v[0:15]
    v_fmac_f32 v199, v43, v123
    v_fmac_f32 v199, v44, v124
    v_fmac_f32 v199, v45, v125
    v_fmac_f32 v199, v46, v126
    v_fmac_f32 v199, v47, v127
    s_add_u32 m0, s21, 6144
    v_mfma_f32_32x32x16_bf16 v[16:31], v[76:79], v[176:179], v[16:31]
    buffer_load_dwordx4 v238, s[4:7], s37 offen lds
    buffer_load_dwordx4 v239, s[8:11], s37 offen offset:1024 lds
    ds_read_b64_tr_b16 v[176:177], v244 offset:0
    ds_read_b64_tr_b16 v[178:179], v244 offset:1024
    ds_read_b64_tr_b16 v[188:189], v245 offset:0
    ds_read_b64_tr_b16 v[190:191], v245 offset:1024
    v_add_u32 v252, s44, v247
    ds_read_u16 v238, v252
    ds_read_u16 v239, v252 offset:64
    v_mul_f32_e64 v201, v48, -v168
    v_fma_f32 v201, v49, -v169, v201
    v_fma_f32 v201, v50, -v170, v201
    v_fma_f32 v201, v51, -v171, v201
    v_fma_f32 v201, v52, -v172, v201
    v_fma_f32 v201, v53, -v173, v201
    s_waitcnt lgkmcnt(2)
    v_mfma_f32_32x32x16_bf16 v[0:15], v[80:83], v[176:179], v[0:15]
    v_fma_f32 v201, v54, -v174, v201
    v_fma_f32 v201, v55, -v175, v201
    v_mul_f32_e64 v203, v56, -v168
    v_fma_f32 v203, v57, -v169, v203
    v_fma_f32 v203, v58, -v170, v203
    s_add_u32 m0, s21, 0
    v_mfma_f32_32x32x16_bf16 v[16:31], v[84:87], v[176:179], v[16:31]
    v_lshl_add_u32 v234, v234, 10, v246
    v_lshl_add_u32 v235, v235, 10, v246
    buffer_load_dwordx4 v234, s[4:7], s38 offen lds
    buffer_load_dwordx4 v235, s[8:11], s38 offen offset:1024 lds
    v_fma_f32 v203, v59, -v171, v203
    v_fma_f32 v203, v60, -v172, v203
    v_fma_f32 v203, v61, -v173, v203
    v_fma_f32 v203, v62, -v174, v203
    v_fma_f32 v203, v63, -v175, v203
    v_mfma_f32_32x32x16_bf16 v[32:47], v[64:67], v[180:183], 0
    v_mul_f32 v254, v0, v144
    v_fmac_f32 v254, v1, v145
    v_fmac_f32 v254, v2, v146
    v_mfma_f32_32x32x16_bf16 v[48:63], v[68:71], v[180:183], 0
    ds_swizzle_b32 v68, v68 offset:0x401F
    ds_swizzle_b32 v69, v69 offset:0x401F
    ds_swizzle_b32 v70, v70 offset:0x401F
    ds_swizzle_b32 v71, v71 offset:0x401F
    v_fmac_f32 v254, v3, v147
    v_fmac_f32 v254, v4, v148
    v_fmac_f32 v254, v5, v149
    v_mfma_f32_32x32x16_bf16 v[32:47], v[72:75], v[184:187], v[32:47]
    v_fmac_f32 v254, v6, v150
    v_fmac_f32 v254, v7, v151
    v_fmac_f32 v200, v8, v160
    v_mfma_f32_32x32x16_bf16 v[48:63], v[76:79], v[184:187], v[48:63]
    ds_swizzle_b32 v76, v76 offset:0x401F
    ds_swizzle_b32 v77, v77 offset:0x401F
    ds_swizzle_b32 v78, v78 offset:0x401F
    ds_swizzle_b32 v79, v79 offset:0x401F
    s_waitcnt vmcnt(6)
    ds_read_b64_tr_b16 v[176:177], v244 offset:2048
    ds_read_b64_tr_b16 v[178:179], v244 offset:3072
    ds_read_b64_tr_b16 v[180:181], v245 offset:2048
    ds_read_b64_tr_b16 v[182:183], v245 offset:3072
    v_fmac_f32 v200, v9, v161
    v_permlane32_swap_b32 v196, v254
    v_fmac_f32 v200, v10, v162
    v_mfma_f32_32x32x16_bf16 v[32:47], v[80:83], v[188:191], v[32:47]
    v_fmac_f32 v200, v11, v163
    v_fmac_f32 v200, v12, v164
    v_fmac_f32 v200, v13, v165
    v_mfma_f32_32x32x16_bf16 v[48:63], v[84:87], v[188:191], v[48:63]
    ds_swizzle_b32 v84, v84 offset:0x401F
    ds_swizzle_b32 v85, v85 offset:0x401F
    ds_swizzle_b32 v86, v86 offset:0x401F
    ds_swizzle_b32 v87, v87 offset:0x401F
    v_fmac_f32 v200, v14, v166
    v_fmac_f32 v200, v15, v167
    v_add_f32 v254, v196, v254
    s_waitcnt lgkmcnt(8)
    s_mov_b64 exec, s[56:57]
    v_xor_b32 v68, 0x80008000, v68
    v_xor_b32 v69, 0x80008000, v69
    v_xor_b32 v70, 0x80008000, v70
    v_xor_b32 v71, 0x80008000, v71
    v_xor_b32 v76, 0x80008000, v76
    v_xor_b32 v77, 0x80008000, v77
    v_xor_b32 v78, 0x80008000, v78
    v_xor_b32 v79, 0x80008000, v79
    s_mov_b64 exec, -1
    s_waitcnt vmcnt(4) lgkmcnt(4)
    v_mfma_f32_32x32x16_bf16 v[0:15], v[64:67], v[176:179], 0
    v_mul_f32 v255, v32, v152
    v_fmac_f32 v255, v33, v153
    v_fmac_f32 v255, v34, v154
    v_fmac_f32 v255, v35, v155
    s_add_u32 m0, s21, 2048
    v_mfma_f32_32x32x16_bf16 v[16:31], v[68:71], v[176:179], v[16:31]
    v_lshl_add_u32 v236, v236, 10, v246
    v_lshl_add_u32 v237, v237, 10, v246
    buffer_load_dwordx4 v236, s[4:7], s39 offen lds
    buffer_load_dwordx4 v237, s[8:11], s39 offen offset:1024 lds
    ds_read_b64_tr_b16 v[176:177], v244 offset:4096
    ds_read_b64_tr_b16 v[178:179], v244 offset:5120
    ds_read_b64_tr_b16 v[184:185], v245 offset:4096
    ds_read_b64_tr_b16 v[186:187], v245 offset:5120
    v_fmac_f32 v255, v36, v156
    v_fmac_f32 v255, v37, v157
    v_fmac_f32 v255, v38, v158
    v_fmac_f32 v255, v39, v159
    s_waitcnt vmcnt(4) lgkmcnt(0)
    v_mfma_f32_32x32x16_bf16 v[0:15], v[72:75], v[176:179], v[0:15]
    v_fmac_f32 v201, v40, v168
    v_fmac_f32 v201, v41, v169
    v_permlane32_swap_b32 v197, v255
    s_add_u32 m0, s21, 4096
    v_mfma_f32_32x32x16_bf16 v[16:31], v[76:79], v[176:179], v[16:31]
    v_lshl_add_u32 v238, v238, 10, v246
    v_lshl_add_u32 v239, v239, 10, v246
    buffer_load_dwordx4 v238, s[4:7], s40 offen lds
    buffer_load_dwordx4 v239, s[8:11], s40 offen offset:1024 lds
    ds_read_b64_tr_b16 v[176:177], v244 offset:6144
    ds_read_b64_tr_b16 v[178:179], v244 offset:7168
    ds_read_b64_tr_b16 v[188:189], v245 offset:6144
    ds_read_b64_tr_b16 v[190:191], v245 offset:7168
    v_fmac_f32 v201, v42, v170
    v_fmac_f32 v201, v43, v171
    v_fmac_f32 v201, v44, v172
    v_fmac_f32 v201, v45, v173
    s_waitcnt lgkmcnt(0)
    s_mov_b64 exec, s[56:57]
    v_xor_b32 v84, 0x80008000, v84
    v_xor_b32 v85, 0x80008000, v85
    v_xor_b32 v86, 0x80008000, v86
    v_xor_b32 v87, 0x80008000, v87
    s_mov_b64 exec, -1
    v_mfma_f32_32x32x16_bf16 v[0:15], v[80:83], v[176:179], v[0:15]
    v_fmac_f32 v201, v46, v174
    v_fmac_f32 v201, v47, v175
    v_add_f32 v255, v197, v255
    s_set_gpr_idx_on s51, gpr_idx(DST)
    s_nop 0
    v_cvt_pk_bf16_f32 v206, v254, v255
    s_set_gpr_idx_off
    s_add_u32 m0, s21, 6144
    v_mfma_f32_32x32x16_bf16 v[16:31], v[84:87], v[176:179], v[16:31]
    v_lshl_add_u32 v240, v240, 10, v246
    v_lshl_add_u32 v241, v241, 10, v246
    buffer_load_dwordx4 v240, s[4:7], s41 offen lds
    buffer_load_dwordx4 v241, s[8:11], s41 offen offset:1024 lds
    v_mfma_f32_32x32x16_bf16 v[32:47], v[64:67], v[180:183], 0
    v_mul_f32 v254, v0, v144
    v_fmac_f32 v254, v1, v145
    v_fmac_f32 v254, v2, v146
    v_fmac_f32 v254, v3, v147
    v_fmac_f32 v254, v4, v148
    v_fmac_f32 v254, v5, v149
    v_fmac_f32 v254, v6, v150
    v_mfma_f32_32x32x16_bf16 v[48:63], v[68:71], v[180:183], v[48:63]
    v_fmac_f32 v254, v7, v151
    v_fma_f32 v202, v8, -v160, v202
    v_fma_f32 v202, v9, -v161, v202
    v_permlane32_swap_b32 v254, v200
    v_fma_f32 v202, v10, -v162, v202
    v_fma_f32 v202, v11, -v163, v202
    v_mfma_f32_32x32x16_bf16 v[32:47], v[72:75], v[184:187], v[32:47]
    v_fma_f32 v202, v12, -v164, v202
    v_fma_f32 v202, v13, -v165, v202
    v_fma_f32 v202, v14, -v166, v202
    v_fma_f32 v202, v15, -v167, v202
    v_add_f32 v200, v254, v200
    v_fmac_f32 v198, v16, v112
    v_permlane32_swap_b32 v202, v254
    v_mfma_f32_32x32x16_bf16 v[48:63], v[76:79], v[184:187], v[48:63]
    s_waitcnt vmcnt(6)
    ds_read_b64_tr_b16 v[176:177], v244 offset:0
    ds_read_b64_tr_b16 v[178:179], v244 offset:1024
    ds_read_b64_tr_b16 v[180:181], v245 offset:0
    ds_read_b64_tr_b16 v[182:183], v245 offset:1024
    v_fmac_f32 v198, v17, v113
    v_fmac_f32 v198, v18, v114
    v_fmac_f32 v198, v19, v115
    v_fmac_f32 v198, v20, v116
    v_fmac_f32 v198, v21, v117
    v_fmac_f32 v198, v22, v118
    v_mfma_f32_32x32x16_bf16 v[32:47], v[80:83], v[188:191], v[32:47]
    v_fmac_f32 v198, v23, v119
    v_add_f32 v254, v202, v254
    v_mul_f32 v196, v24, v160
    v_fmac_f32 v196, v25, v161
    v_fmac_f32 v196, v26, v162
    v_fmac_f32 v196, v27, v163
    v_fmac_f32 v196, v28, v164
    v_mfma_f32_32x32x16_bf16 v[48:63], v[84:87], v[188:191], v[48:63]
    v_add_u32 v249, s48, v249
    v_add_u32 v250, s49, v250
    ds_read_b32 v252, v251 offset:16
    ds_read_b64_tr_b16 v[68:69], v249 offset:0
    ds_read_b64_tr_b16 v[70:71], v249 offset:256
    s_mov_b64 exec, s[54:55]
    ds_read_u16_d16_hi v242, v250 offset:0
    s_mov_b64 exec, -1
    v_fmac_f32 v196, v29, v165
    v_fmac_f32 v196, v30, v166
    v_fmac_f32 v196, v31, v167
    s_nop 1
    v_permlane32_swap_b32 v198, v196
    v_add_f32 v196, v198, v196
    v_mul_f32 v255, v32, v152
    v_fmac_f32 v255, v33, v153
    v_fmac_f32 v255, v34, v154
    v_fmac_f32 v255, v35, v155
    v_fmac_f32 v255, v36, v156
    v_fmac_f32 v255, v37, v157
    v_fmac_f32 v255, v38, v158
    v_fmac_f32 v255, v39, v159
    v_fma_f32 v203, v40, -v168, v203
    v_fma_f32 v203, v41, -v169, v203
    v_permlane32_swap_b32 v255, v201
    v_fma_f32 v203, v42, -v170, v203
    v_fma_f32 v203, v43, -v171, v203
    v_fma_f32 v203, v44, -v172, v203
    v_fma_f32 v203, v45, -v173, v203
    v_fma_f32 v203, v46, -v174, v203
    v_fma_f32 v203, v47, -v175, v203
    v_add_f32 v201, v255, v201
    v_fmac_f32 v199, v48, v120
    v_permlane32_swap_b32 v203, v255
    v_fmac_f32 v199, v49, v121
    v_fmac_f32 v199, v50, v122
    v_fmac_f32 v199, v51, v123
    v_fmac_f32 v199, v52, v124
    v_fmac_f32 v199, v53, v125
    v_fmac_f32 v199, v54, v126
    v_fmac_f32 v199, v55, v127
    v_add_f32 v255, v203, v255
    v_mul_f32 v197, v56, v168
    v_fmac_f32 v197, v57, v169
    v_fmac_f32 v197, v58, v170
    v_fmac_f32 v197, v59, v171
    v_fmac_f32 v197, v60, v172
    v_fmac_f32 v197, v61, v173
    v_fmac_f32 v197, v62, v174
    v_fmac_f32 v197, v63, v175
    s_nop 1
    v_permlane32_swap_b32 v199, v197
    v_add_f32 v197, v199, v197
    s_set_gpr_idx_on s51, gpr_idx(DST)
    s_nop 0
    v_cvt_pk_bf16_f32 v207, v200, v201
    v_cvt_pk_bf16_f32 v209, v254, v255
    v_cvt_pk_bf16_f32 v208, v196, v197
    s_set_gpr_idx_off
    s_add_u32 s50, s50, 1
    s_add_u32 s51, s51, 6
    s_cmp_ge_u32 s50, 4
    s_cbranch_scc1 LAST0
    s_waitcnt lgkmcnt(3)
    v_readfirstlane_b32 s66, v252
    s_add_u32 s53, s53, 1
    v_mov_b32 v252, s53
    s_cmp_le_u32 s53, s66
    ds_write2_b32 v251, v252, v252 offset0:0 offset1:8
    s_setprio 1
    s_cbranch_scc1 PRIO_7
    s_setprio 0
PRIO_7:
    s_cmp_eq_u32 s52, 4
    s_cbranch_scc1 ITEM_0_4
    s_cmp_eq_u32 s52, 5
    s_cbranch_scc1 ITEM_0_5
    s_cmp_eq_u32 s52, 3
    s_cbranch_scc1 ITEM_0_3
    s_cmp_eq_u32 s52, 6
    s_cbranch_scc1 ITEM_0_6
    s_cmp_eq_u32 s52, 8
    s_cbranch_scc1 ITEM_0_8
    s_branch ITEM_0_2
.p2align 6
ITEM_0_8:
    s_mov_b64 exec, s[54:55]
    ds_read_u16_d16_hi v243, v250 offset:128
    s_mov_b64 exec, -1
    ds_read_b64_tr_b16 v[76:77], v249 offset:512
    ds_read_b64_tr_b16 v[78:79], v249 offset:768
    ds_read_b64_tr_b16 v[84:85], v249 offset:1024
    ds_read_b64_tr_b16 v[86:87], v249 offset:1280
    ds_read_b64_tr_b16 v[92:93], v249 offset:1536
    ds_read_b64_tr_b16 v[94:95], v249 offset:1792
    s_waitcnt lgkmcnt(7)
    v_lshlrev_b32 v196, 16, v68
    v_and_b32 v197, 0xffff0000, v68
    v_lshlrev_b32 v198, 16, v69
    v_and_b32 v199, 0xffff0000, v69
    v_mul_f32_dpp v200, v242, v196 row_newbcast:0 row_mask:0xf bank_mask:0xf
    v_mul_f32_dpp v201, v242, v197 row_newbcast:1 row_mask:0xf bank_mask:0xf
    v_mul_f32_dpp v202, v242, v196 row_newbcast:8 row_mask:0xf bank_mask:0xf
    v_mul_f32_dpp v203, v242, v197 row_newbcast:9 row_mask:0xf bank_mask:0xf
    v_lshlrev_b32 v196, 16, v70
    v_and_b32 v197, 0xffff0000, v70
    v_cvt_pk_bf16_f32 v64, v200, v201
    v_cvt_pk_bf16_f32 v68, v202, v203
    v_mul_f32_dpp v200, v242, v198 row_newbcast:2 row_mask:0xf bank_mask:0xf
    v_mul_f32_dpp v201, v242, v199 row_newbcast:3 row_mask:0xf bank_mask:0xf
    v_mul_f32_dpp v202, v242, v198 row_newbcast:10 row_mask:0xf bank_mask:0xf
    v_mul_f32_dpp v203, v242, v199 row_newbcast:11 row_mask:0xf bank_mask:0xf
    v_lshlrev_b32 v198, 16, v71
    v_and_b32 v199, 0xffff0000, v71
    v_cvt_pk_bf16_f32 v65, v200, v201
    v_cvt_pk_bf16_f32 v69, v202, v203
    v_mul_f32_dpp v200, v242, v196 row_newbcast:4 row_mask:0xf bank_mask:0xf
    v_mul_f32_dpp v201, v242, v197 row_newbcast:5 row_mask:0xf bank_mask:0xf
    v_mul_f32_dpp v202, v242, v196 row_newbcast:12 row_mask:0xf bank_mask:0xf
    v_mul_f32_dpp v203, v242, v197 row_newbcast:13 row_mask:0xf bank_mask:0xf
    v_cvt_pk_bf16_f32 v66, v200, v201
    v_cvt_pk_bf16_f32 v70, v202, v203
    v_mul_f32_dpp v200, v242, v198 row_newbcast:6 row_mask:0xf bank_mask:0xf
    v_mul_f32_dpp v201, v242, v199 row_newbcast:7 row_mask:0xf bank_mask:0xf
    v_mul_f32_dpp v202, v242, v198 row_newbcast:14 row_mask:0xf bank_mask:0xf
    v_mul_f32_dpp v203, v242, v199 row_newbcast:15 row_mask:0xf bank_mask:0xf
    v_cvt_pk_bf16_f32 v67, v200, v201
    v_cvt_pk_bf16_f32 v71, v202, v203
    s_mov_b64 exec, s[54:55]
    ds_read_u16_d16_hi v242, v250 offset:256
    s_mov_b64 exec, -1
    s_waitcnt vmcnt(4) lgkmcnt(5)
    v_mfma_f32_32x32x16_bf16 v[0:15], v[64:67], v[176:179], 0
    v_lshlrev_b32 v196, 16, v76
    v_and_b32 v197, 0xffff0000, v76
    v_lshlrev_b32 v198, 16, v77
    v_and_b32 v199, 0xffff0000, v77
    v_mul_f32_dpp v200, v243, v196 row_newbcast:0 row_mask:0xf bank_mask:0xf
    v_mul_f32_dpp v201, v243, v197 row_newbcast:1 row_mask:0xf bank_mask:0xf
    v_mul_f32_dpp v202, v243, v196 row_newbcast:8 row_mask:0xf bank_mask:0xf
    v_mul_f32_dpp v203, v243, v197 row_newbcast:9 row_mask:0xf bank_mask:0xf
    v_lshlrev_b32 v196, 16, v78
    v_and_b32 v197, 0xffff0000, v78
    v_cvt_pk_bf16_f32 v72, v200, v201
    v_cvt_pk_bf16_f32 v76, v202, v203
    v_mul_f32_dpp v200, v243, v198 row_newbcast:2 row_mask:0xf bank_mask:0xf
    v_mul_f32_dpp v201, v243, v199 row_newbcast:3 row_mask:0xf bank_mask:0xf
    v_mul_f32_dpp v202, v243, v198 row_newbcast:10 row_mask:0xf bank_mask:0xf
    v_mul_f32_dpp v203, v243, v199 row_newbcast:11 row_mask:0xf bank_mask:0xf
    s_add_u32 m0, s21, 0
    v_mfma_f32_32x32x16_bf16 v[16:31], v[68:71], v[176:179], 0
    buffer_load_dwordx4 v234, s[4:7], s35 offen lds
    buffer_load_dwordx4 v235, s[8:11], s35 offen offset:1024 lds
    ds_read_b64_tr_b16 v[176:177], v244 offset:2048
    ds_read_b64_tr_b16 v[178:179], v244 offset:3072
    ds_read_b64_tr_b16 v[184:185], v245 offset:2048
    ds_read_b64_tr_b16 v[186:187], v245 offset:3072
    v_lshlrev_b32 v198, 16, v79
    v_and_b32 v199, 0xffff0000, v79
    v_cvt_pk_bf16_f32 v73, v200, v201
    v_cvt_pk_bf16_f32 v77, v202, v203
    v_mul_f32_dpp v200, v243, v196 row_newbcast:4 row_mask:0xf bank_mask:0xf
    v_mul_f32_dpp v201, v243, v197 row_newbcast:5 row_mask:0xf bank_mask:0xf
    v_mul_f32_dpp v202, v243, v196 row_newbcast:12 row_mask:0xf bank_mask:0xf
    v_mul_f32_dpp v203, v243, v197 row_newbcast:13 row_mask:0xf bank_mask:0xf
    v_cvt_pk_bf16_f32 v74, v200, v201
    v_cvt_pk_bf16_f32 v78, v202, v203
    v_mul_f32_dpp v200, v243, v198 row_newbcast:6 row_mask:0xf bank_mask:0xf
    v_mul_f32_dpp v201, v243, v199 row_newbcast:7 row_mask:0xf bank_mask:0xf
    v_mul_f32_dpp v202, v243, v198 row_newbcast:14 row_mask:0xf bank_mask:0xf
    v_mul_f32_dpp v203, v243, v199 row_newbcast:15 row_mask:0xf bank_mask:0xf
    v_cvt_pk_bf16_f32 v75, v200, v201
    v_cvt_pk_bf16_f32 v79, v202, v203
    s_mov_b64 exec, s[54:55]
    ds_read_u16_d16_hi v243, v250 offset:384
    s_mov_b64 exec, -1
    s_waitcnt vmcnt(4) lgkmcnt(1)
    v_mfma_f32_32x32x16_bf16 v[0:15], v[72:75], v[176:179], v[0:15]
    v_lshlrev_b32 v196, 16, v84
    v_and_b32 v197, 0xffff0000, v84
    v_lshlrev_b32 v198, 16, v85
    v_and_b32 v199, 0xffff0000, v85
    v_mul_f32_dpp v200, v242, v196 row_newbcast:0 row_mask:0xf bank_mask:0xf
    v_mul_f32_dpp v201, v242, v197 row_newbcast:1 row_mask:0xf bank_mask:0xf
    v_mul_f32_dpp v202, v242, v196 row_newbcast:8 row_mask:0xf bank_mask:0xf
    v_mul_f32_dpp v203, v242, v197 row_newbcast:9 row_mask:0xf bank_mask:0xf
    v_lshlrev_b32 v196, 16, v86
    v_and_b32 v197, 0xffff0000, v86
    v_cvt_pk_bf16_f32 v80, v200, v201
    v_cvt_pk_bf16_f32 v84, v202, v203
    v_mul_f32_dpp v200, v242, v198 row_newbcast:2 row_mask:0xf bank_mask:0xf
    v_mul_f32_dpp v201, v242, v199 row_newbcast:3 row_mask:0xf bank_mask:0xf
    v_mul_f32_dpp v202, v242, v198 row_newbcast:10 row_mask:0xf bank_mask:0xf
    v_mul_f32_dpp v203, v242, v199 row_newbcast:11 row_mask:0xf bank_mask:0xf
    s_add_u32 m0, s21, 2048
    v_mfma_f32_32x32x16_bf16 v[16:31], v[76:79], v[176:179], v[16:31]
    buffer_load_dwordx4 v236, s[4:7], s35 offen lds
    buffer_load_dwordx4 v237, s[8:11], s35 offen offset:1024 lds
    ds_read_b64_tr_b16 v[176:177], v244 offset:4096
    ds_read_b64_tr_b16 v[178:179], v244 offset:5120
    ds_read_b64_tr_b16 v[188:189], v245 offset:4096
    ds_read_b64_tr_b16 v[190:191], v245 offset:5120
    v_lshlrev_b32 v198, 16, v87
    v_and_b32 v199, 0xffff0000, v87
    v_cvt_pk_bf16_f32 v81, v200, v201
    v_cvt_pk_bf16_f32 v85, v202, v203
    v_mul_f32_dpp v200, v242, v196 row_newbcast:4 row_mask:0xf bank_mask:0xf
    v_mul_f32_dpp v201, v242, v197 row_newbcast:5 row_mask:0xf bank_mask:0xf
    v_mul_f32_dpp v202, v242, v196 row_newbcast:12 row_mask:0xf bank_mask:0xf
    v_mul_f32_dpp v203, v242, v197 row_newbcast:13 row_mask:0xf bank_mask:0xf
    v_cvt_pk_bf16_f32 v82, v200, v201
    v_cvt_pk_bf16_f32 v86, v202, v203
    v_mul_f32_dpp v200, v242, v198 row_newbcast:6 row_mask:0xf bank_mask:0xf
    v_mul_f32_dpp v201, v242, v199 row_newbcast:7 row_mask:0xf bank_mask:0xf
    v_mul_f32_dpp v202, v242, v198 row_newbcast:14 row_mask:0xf bank_mask:0xf
    v_mul_f32_dpp v203, v242, v199 row_newbcast:15 row_mask:0xf bank_mask:0xf
    v_cvt_pk_bf16_f32 v83, v200, v201
    v_cvt_pk_bf16_f32 v87, v202, v203
    s_nop 0
    s_waitcnt vmcnt(4) lgkmcnt(0)
    v_mfma_f32_32x32x16_bf16 v[0:15], v[80:83], v[176:179], v[0:15]
    v_lshlrev_b32 v196, 16, v92
    v_and_b32 v197, 0xffff0000, v92
    v_lshlrev_b32 v198, 16, v93
    v_and_b32 v199, 0xffff0000, v93
    v_mul_f32_dpp v200, v243, v196 row_newbcast:0 row_mask:0xf bank_mask:0xf
    v_mul_f32_dpp v201, v243, v197 row_newbcast:1 row_mask:0xf bank_mask:0xf
    v_mul_f32_dpp v202, v243, v196 row_newbcast:8 row_mask:0xf bank_mask:0xf
    v_mul_f32_dpp v203, v243, v197 row_newbcast:9 row_mask:0xf bank_mask:0xf
    v_lshlrev_b32 v196, 16, v94
    v_and_b32 v197, 0xffff0000, v94
    v_cvt_pk_bf16_f32 v88, v200, v201
    v_cvt_pk_bf16_f32 v92, v202, v203
    v_mul_f32_dpp v200, v243, v198 row_newbcast:2 row_mask:0xf bank_mask:0xf
    v_mul_f32_dpp v201, v243, v199 row_newbcast:3 row_mask:0xf bank_mask:0xf
    v_mul_f32_dpp v202, v243, v198 row_newbcast:10 row_mask:0xf bank_mask:0xf
    v_mul_f32_dpp v203, v243, v199 row_newbcast:11 row_mask:0xf bank_mask:0xf
    s_add_u32 m0, s21, 4096
    v_mfma_f32_32x32x16_bf16 v[16:31], v[84:87], v[176:179], v[16:31]
    buffer_load_dwordx4 v238, s[4:7], s35 offen lds
    buffer_load_dwordx4 v239, s[8:11], s35 offen offset:1024 lds
    ds_read_b64_tr_b16 v[176:177], v244 offset:6144
    ds_read_b64_tr_b16 v[178:179], v244 offset:7168
    ds_read_b64_tr_b16 v[192:193], v245 offset:6144
    ds_read_b64_tr_b16 v[194:195], v245 offset:7168
    v_lshlrev_b32 v198, 16, v95
    v_and_b32 v199, 0xffff0000, v95
    v_cvt_pk_bf16_f32 v89, v200, v201
    v_cvt_pk_bf16_f32 v93, v202, v203
    v_mul_f32_dpp v200, v243, v196 row_newbcast:4 row_mask:0xf bank_mask:0xf
    v_mul_f32_dpp v201, v243, v197 row_newbcast:5 row_mask:0xf bank_mask:0xf
    v_mul_f32_dpp v202, v243, v196 row_newbcast:12 row_mask:0xf bank_mask:0xf
    v_mul_f32_dpp v203, v243, v197 row_newbcast:13 row_mask:0xf bank_mask:0xf
    v_cvt_pk_bf16_f32 v90, v200, v201
    v_cvt_pk_bf16_f32 v94, v202, v203
    v_mul_f32_dpp v200, v243, v198 row_newbcast:6 row_mask:0xf bank_mask:0xf
    v_mul_f32_dpp v201, v243, v199 row_newbcast:7 row_mask:0xf bank_mask:0xf
    v_mul_f32_dpp v202, v243, v198 row_newbcast:14 row_mask:0xf bank_mask:0xf
    v_mul_f32_dpp v203, v243, v199 row_newbcast:15 row_mask:0xf bank_mask:0xf
    v_cvt_pk_bf16_f32 v91, v200, v201
    v_cvt_pk_bf16_f32 v95, v202, v203
    s_nop 0
    s_waitcnt lgkmcnt(0)
    v_mfma_f32_32x32x16_bf16 v[0:15], v[88:91], v[176:179], v[0:15]
    s_add_u32 m0, s21, 6144
    v_mfma_f32_32x32x16_bf16 v[16:31], v[92:95], v[176:179], v[16:31]
    buffer_load_dwordx4 v240, s[4:7], s35 offen lds
    buffer_load_dwordx4 v241, s[8:11], s35 offen offset:1024 lds
    s_mov_b32 m0, s50
    s_nop 0
    s_movrels_b32 s71, s23
    s_bfe_u32 s46, s71, 0x30012
    s_mov_b32 m0, s46
    s_and_b32 s66, s71, 0x3ffff
    s_movrels_b32 s68, s57
    s_movrels_b32 s69, s61
    s_sub_u32 s48, s66, s47
    s_mov_b32 s47, s66
    s_lshr_b32 s52, s71, 28
    s_lshl_b32 s67, s46, 9
    s_add_u32 s66, s66, s67
    s_sub_u32 s49, s66, s42
    s_mov_b32 s42, s66
    s_bfe_u32 s66, s68, 655360
    s_add_u32 s43, s42, s66
    s_bfe_u32 s39, s69, 655360
    s_bfe_u32 s66, s68, 655370
    s_add_u32 s44, s42, s66
    s_bfe_u32 s40, s69, 655370
    s_bfe_u32 s66, s68, 655380
    s_add_u32 s45, s42, s66
    s_bfe_u32 s41, s69, 655380
    s_and_b32 s66, s46, s33
    s_cselect_b32 s72, -1, 1
    s_cselect_b32 s76, s47, 86912
    s_cmp_ge_u32 s66, 2
    s_cselect_b32 s73, -1, 0
    s_add_u32 s77, s47, 1024
    s_cmp_ge_u32 s66, 4
    s_cselect_b32 s75, -1, 0
    s_cmp_ge_u32 s66, 3
    s_cselect_b32 s74, -1, 1
    s_cselect_b32 s77, s77, 86912
    v_mfma_f32_32x32x16_bf16 v[32:47], v[64:67], v[180:183], 0
    v_mul_f32 v196, v0, v96
    v_fmac_f32 v196, v1, v97
    v_fmac_f32 v196, v2, v98
    v_fmac_f32 v196, v3, v99
    v_fmac_f32 v196, v4, v100
    v_mfma_f32_32x32x16_bf16 v[48:63], v[68:71], v[180:183], 0
    v_lshl_add_u32 v253, v248, 2, s47
    ds_read_b32 v254, v253
    ds_read_b32 v255, v253 offset:1024
    v_fmac_f32 v196, v5, v101
    v_fmac_f32 v196, v6, v102
    v_fmac_f32 v196, v7, v103
    v_mul_f32 v198, v8, v128
    v_fmac_f32 v198, v9, v129
    v_mfma_f32_32x32x16_bf16 v[32:47], v[72:75], v[184:187], v[32:47]
    v_fmac_f32 v198, v10, v130
    v_fmac_f32 v198, v11, v131
    v_fmac_f32 v198, v12, v132
    v_fmac_f32 v198, v13, v133
    v_mfma_f32_32x32x16_bf16 v[48:63], v[76:79], v[184:187], v[48:63]
    v_fmac_f32 v198, v14, v134
    v_fmac_f32 v198, v15, v135
    v_mul_f32 v200, v16, v128
    v_fmac_f32 v200, v17, v129
    v_permlane32_swap_b32 v196, v198
    v_mfma_f32_32x32x16_bf16 v[32:47], v[80:83], v[188:191], v[32:47]
    v_fmac_f32 v200, v18, v130
    v_fmac_f32 v200, v19, v131
    v_fmac_f32 v200, v20, v132
    v_fmac_f32 v200, v21, v133
    v_fmac_f32 v200, v22, v134
    v_mfma_f32_32x32x16_bf16 v[48:63], v[84:87], v[188:191], v[48:63]
    s_waitcnt vmcnt(6)
    ds_read_b64_tr_b16 v[176:177], v244 offset:0
    ds_read_b64_tr_b16 v[178:179], v244 offset:1024
    ds_read_b64_tr_b16 v[180:181], v245 offset:0
    ds_read_b64_tr_b16 v[182:183], v245 offset:1024
    v_fmac_f32 v200, v23, v135
    v_add_f32 v198, v196, v198
    v_mul_f32_e64 v202, v24, -v128
    v_fma_f32 v202, v25, -v129, v202
    v_mfma_f32_32x32x16_bf16 v[32:47], v[88:91], v[192:195], v[32:47]
    v_fma_f32 v202, v26, -v130, v202
    v_fma_f32 v202, v27, -v131, v202
    v_fma_f32 v202, v28, -v132, v202
    v_fma_f32 v202, v29, -v133, v202
    v_fma_f32 v202, v30, -v134, v202
    v_mfma_f32_32x32x16_bf16 v[48:63], v[92:95], v[192:195], v[48:63]
    v_fma_f32 v202, v31, -v135, v202
    s_nop 1
    v_permlane32_swap_b32 v200, v202
    v_add_f32 v202, v200, v202
    s_waitcnt vmcnt(4) lgkmcnt(0)
    v_mfma_f32_32x32x16_bf16 v[0:15], v[64:67], v[176:179], 0
    v_mul_f32 v197, v32, v104
    v_fmac_f32 v197, v33, v105
    v_fmac_f32 v197, v34, v106
    v_fmac_f32 v197, v35, v107
    v_fmac_f32 v197, v36, v108
    v_fmac_f32 v197, v37, v109
    s_add_u32 m0, s21, 0
    v_mfma_f32_32x32x16_bf16 v[16:31], v[68:71], v[176:179], 0
    buffer_load_dwordx4 v234, s[4:7], s36 offen lds
    buffer_load_dwordx4 v235, s[8:11], s36 offen offset:1024 lds
    ds_read_b64_tr_b16 v[176:177], v244 offset:2048
    ds_read_b64_tr_b16 v[178:179], v244 offset:3072
    ds_read_b64_tr_b16 v[184:185], v245 offset:2048
    ds_read_b64_tr_b16 v[186:187], v245 offset:3072
    s_mov_b32 m0, s76
    s_mov_b64 exec, s[72:73]
    buffer_load_dwordx4 v254, s[12:15], 0 offen  lds
    s_mov_b32 m0, s77
    s_mov_b64 exec, s[74:75]
    buffer_load_dwordx4 v255, s[12:15], 0 offen  lds
    s_mov_b64 exec, -1
    v_fmac_f32 v197, v38, v110
    v_fmac_f32 v197, v39, v111
    v_mul_f32 v199, v40, v136
    v_fmac_f32 v199, v41, v137
    v_fmac_f32 v199, v42, v138
    s_waitcnt vmcnt(6) lgkmcnt(0)
    v_mfma_f32_32x32x16_bf16 v[0:15], v[72:75], v[176:179], v[0:15]
    v_fmac_f32 v199, v43, v139
    v_fmac_f32 v199, v44, v140
    v_fmac_f32 v199, v45, v141
    v_fmac_f32 v199, v46, v142
    v_fmac_f32 v199, v47, v143
    s_add_u32 m0, s21, 2048
    v_mfma_f32_32x32x16_bf16 v[16:31], v[76:79], v[176:179], v[16:31]
    buffer_load_dwordx4 v236, s[4:7], s36 offen lds
    buffer_load_dwordx4 v237, s[8:11], s36 offen offset:1024 lds
    ds_read_b64_tr_b16 v[176:177], v244 offset:4096
    ds_read_b64_tr_b16 v[178:179], v244 offset:5120
    ds_read_b64_tr_b16 v[188:189], v245 offset:4096
    ds_read_b64_tr_b16 v[190:191], v245 offset:5120
    v_mul_f32 v201, v48, v136
    v_fmac_f32 v201, v49, v137
    v_permlane32_swap_b32 v197, v199
    v_fmac_f32 v201, v50, v138
    v_fmac_f32 v201, v51, v139
    s_waitcnt vmcnt(6) lgkmcnt(0)
    v_mfma_f32_32x32x16_bf16 v[0:15], v[80:83], v[176:179], v[0:15]
    v_fmac_f32 v201, v52, v140
    v_fmac_f32 v201, v53, v141
    v_fmac_f32 v201, v54, v142
    v_fmac_f32 v201, v55, v143
    v_add_f32 v199, v197, v199
    v_mul_f32_e64 v203, v56, -v136
    s_add_u32 m0, s21, 4096
    v_mfma_f32_32x32x16_bf16 v[16:31], v[84:87], v[176:179], v[16:31]
    buffer_load_dwordx4 v238, s[4:7], s36 offen lds
    buffer_load_dwordx4 v239, s[8:11], s36 offen offset:1024 lds
    ds_read_b64_tr_b16 v[176:177], v244 offset:6144
    ds_read_b64_tr_b16 v[178:179], v244 offset:7168
    ds_read_b64_tr_b16 v[192:193], v245 offset:6144
    ds_read_b64_tr_b16 v[194:195], v245 offset:7168
    v_fma_f32 v203, v57, -v137, v203
    v_fma_f32 v203, v58, -v138, v203
    v_fma_f32 v203, v59, -v139, v203
    v_fma_f32 v203, v60, -v140, v203
    v_fma_f32 v203, v61, -v141, v203
    s_waitcnt lgkmcnt(0)
    v_mfma_f32_32x32x16_bf16 v[0:15], v[88:91], v[176:179], v[0:15]
    v_fma_f32 v203, v62, -v142, v203
    v_fma_f32 v203, v63, -v143, v203
    s_nop 1
    v_permlane32_swap_b32 v201, v203
    v_add_f32 v203, v201, v203
    s_add_u32 m0, s21, 6144
    v_mfma_f32_32x32x16_bf16 v[16:31], v[92:95], v[176:179], v[16:31]
    buffer_load_dwordx4 v240, s[4:7], s36 offen lds
    buffer_load_dwordx4 v241, s[8:11], s36 offen offset:1024 lds
    s_set_gpr_idx_on s51, gpr_idx(DST)
    s_nop 0
    v_cvt_pk_bf16_f32 v204, v198, v199
    v_cvt_pk_bf16_f32 v205, v202, v203
    s_set_gpr_idx_off
    v_mfma_f32_32x32x16_bf16 v[32:47], v[64:67], v[180:183], 0
    v_mul_f32 v196, v0, v144
    v_fmac_f32 v196, v1, v145
    v_fmac_f32 v196, v2, v146
    v_fmac_f32 v196, v3, v147
    v_mfma_f32_32x32x16_bf16 v[48:63], v[68:71], v[180:183], 0
    v_fmac_f32 v196, v4, v148
    v_fmac_f32 v196, v5, v149
    v_fmac_f32 v196, v6, v150
    v_fmac_f32 v196, v7, v151
    v_mfma_f32_32x32x16_bf16 v[32:47], v[72:75], v[184:187], v[32:47]
    v_mul_f32 v198, v8, v112
    v_fmac_f32 v198, v9, v113
    v_fmac_f32 v198, v10, v114
    v_fmac_f32 v198, v11, v115
    v_mfma_f32_32x32x16_bf16 v[48:63], v[76:79], v[184:187], v[48:63]
    v_fmac_f32 v198, v12, v116
    v_fmac_f32 v198, v13, v117
    v_fmac_f32 v198, v14, v118
    v_fmac_f32 v198, v15, v119
    v_mfma_f32_32x32x16_bf16 v[32:47], v[80:83], v[188:191], v[32:47]
    v_mul_f32_e64 v200, v16, -v160
    v_fma_f32 v200, v17, -v161, v200
    v_fma_f32 v200, v18, -v162, v200
    v_fma_f32 v200, v19, -v163, v200
    v_mfma_f32_32x32x16_bf16 v[48:63], v[84:87], v[188:191], v[48:63]
    s_waitcnt vmcnt(8)
    ds_read_b64_tr_b16 v[176:177], v244 offset:0
    ds_read_b64_tr_b16 v[178:179], v244 offset:1024
    ds_read_b64_tr_b16 v[180:181], v245 offset:0
    ds_read_b64_tr_b16 v[182:183], v245 offset:1024
    v_fma_f32 v200, v20, -v164, v200
    v_fma_f32 v200, v21, -v165, v200
    v_fma_f32 v200, v22, -v166, v200
    v_fma_f32 v200, v23, -v167, v200
    v_mfma_f32_32x32x16_bf16 v[32:47], v[88:91], v[192:195], v[32:47]
    v_mul_f32_e64 v202, v24, -v160
    v_fma_f32 v202, v25, -v161, v202
    v_fma_f32 v202, v26, -v162, v202
    v_fma_f32 v202, v27, -v163, v202
    v_mfma_f32_32x32x16_bf16 v[48:63], v[92:95], v[192:195], v[48:63]
    v_fma_f32 v202, v28, -v164, v202
    v_fma_f32 v202, v29, -v165, v202
    v_fma_f32 v202, v30, -v166, v202
    v_fma_f32 v202, v31, -v167, v202
    s_waitcnt vmcnt(4) lgkmcnt(0)
    v_mfma_f32_32x32x16_bf16 v[0:15], v[64:67], v[176:179], 0
    s_nop 0
    v_mul_f32 v197, v32, v152
    v_fmac_f32 v197, v33, v153
    v_fmac_f32 v197, v34, v154
    v_fmac_f32 v197, v35, v155
    s_add_u32 m0, s21, 0
    v_mfma_f32_32x32x16_bf16 v[16:31], v[68:71], v[176:179], 0
    buffer_load_dwordx4 v234, s[4:7], s37 offen lds
    buffer_load_dwordx4 v235, s[8:11], s37 offen offset:1024 lds
    ds_read_b64_tr_b16 v[176:177], v244 offset:2048
    ds_read_b64_tr_b16 v[178:179], v244 offset:3072
    ds_read_b64_tr_b16 v[184:185], v245 offset:2048
    ds_read_b64_tr_b16 v[186:187], v245 offset:3072
    v_add_u32 v252, s42, v247
    ds_read_u16 v234, v252
    ds_read_u16 v235, v252 offset:64
    v_fmac_f32 v197, v36, v156
    v_fmac_f32 v197, v37, v157
    v_fmac_f32 v197, v38, v158
    v_fmac_f32 v197, v39, v159
    s_waitcnt vmcnt(4) lgkmcnt(2)
    v_mfma_f32_32x32x16_bf16 v[0:15], v[72:75], v[176:179], v[0:15]
    v_mul_f32 v199, v40, v120
    v_fmac_f32 v199, v41, v121
    v_fmac_f32 v199, v42, v122
    v_fmac_f32 v199, v43, v123
    s_add_u32 m0, s21, 2048
    v_mfma_f32_32x32x16_bf16 v[16:31], v[76:79], v[176:179], v[16:31]
    buffer_load_dwordx4 v236, s[4:7], s37 offen lds
    buffer_load_dwordx4 v237, s[8:11], s37 offen offset:1024 lds
    ds_read_b64_tr_b16 v[176:177], v244 offset:4096
    ds_read_b64_tr_b16 v[178:179], v244 offset:5120
    ds_read_b64_tr_b16 v[188:189], v245 offset:4096
    ds_read_b64_tr_b16 v[190:191], v245 offset:5120
    v_add_u32 v252, s43, v247
    ds_read_u16 v236, v252
    ds_read_u16 v237, v252 offset:64
    v_fmac_f32 v199, v44, v124
    v_fmac_f32 v199, v45, v125
    v_fmac_f32 v199, v46, v126
    v_fmac_f32 v199, v47, v127
    s_waitcnt vmcnt(4) lgkmcnt(2)
    v_mfma_f32_32x32x16_bf16 v[0:15], v[80:83], v[176:179], v[0:15]
    v_mul_f32_e64 v201, v48, -v168
    v_fma_f32 v201, v49, -v169, v201
    v_fma_f32 v201, v50, -v170, v201
    v_fma_f32 v201, v51, -v171, v201
    s_add_u32 m0, s21, 4096
    v_mfma_f32_32x32x16_bf16 v[16:31], v[84:87], v[176:179], v[16:31]
    buffer_load_dwordx4 v238, s[4:7], s37 offen lds
    buffer_load_dwordx4 v239, s[8:11], s37 offen offset:1024 lds
    ds_read_b64_tr_b16 v[176:177], v244 offset:6144
    ds_read_b64_tr_b16 v[178:179], v244 offset:7168
    ds_read_b64_tr_b16 v[192:193], v245 offset:6144
    ds_read_b64_tr_b16 v[194:195], v245 offset:7168
    v_add_u32 v252, s44, v247
    ds_read_u16 v238, v252
    ds_read_u16 v239, v252 offset:64
    v_fma_f32 v201, v52, -v172, v201
    v_fma_f32 v201, v53, -v173, v201
    v_fma_f32 v201, v54, -v174, v201
    v_fma_f32 v201, v55, -v175, v201
    s_waitcnt lgkmcnt(2)
    v_mfma_f32_32x32x16_bf16 v[0:15], v[88:91], v[176:179], v[0:15]
    v_mul_f32_e64 v203, v56, -v168
    v_fma_f32 v203, v57, -v169, v203
    v_fma_f32 v203, v58, -v170, v203
    v_fma_f32 v203, v59, -v171, v203
    s_add_u32 m0, s21, 6144
    v_mfma_f32_32x32x16_bf16 v[16:31], v[92:95], v[176:179], v[16:31]
    buffer_load_dwordx4 v240, s[4:7], s37 offen lds
    buffer_load_dwordx4 v241, s[8:11], s37 offen offset:1024 lds
    v_add_u32 v252, s45, v247
    ds_read_u16 v240, v252
    ds_read_u16 v241, v252 offset:64
    v_fma_f32 v203, v60, -v172, v203
    v_fma_f32 v203, v61, -v173, v203
    v_fma_f32 v203, v62, -v174, v203
    v_fma_f32 v203, v63, -v175, v203
    v_mfma_f32_32x32x16_bf16 v[32:47], v[64:67], v[180:183], 0
    v_mul_f32 v254, v0, v144
    v_fmac_f32 v254, v1, v145
    v_fmac_f32 v254, v2, v146
    v_mfma_f32_32x32x16_bf16 v[48:63], v[68:71], v[180:183], 0
    ds_swizzle_b32 v68, v68 offset:0x401F
    ds_swizzle_b32 v69, v69 offset:0x401F
    ds_swizzle_b32 v70, v70 offset:0x401F
    ds_swizzle_b32 v71, v71 offset:0x401F
    v_fmac_f32 v254, v3, v147
    v_fmac_f32 v254, v4, v148
    v_mfma_f32_32x32x16_bf16 v[32:47], v[72:75], v[184:187], v[32:47]
    v_fmac_f32 v254, v5, v149
    v_fmac_f32 v254, v6, v150
    v_mfma_f32_32x32x16_bf16 v[48:63], v[76:79], v[184:187], v[48:63]
    ds_swizzle_b32 v76, v76 offset:0x401F
    ds_swizzle_b32 v77, v77 offset:0x401F
    ds_swizzle_b32 v78, v78 offset:0x401F
    ds_swizzle_b32 v79, v79 offset:0x401F
    v_fmac_f32 v254, v7, v151
    v_fmac_f32 v200, v8, v160
    v_mfma_f32_32x32x16_bf16 v[32:47], v[80:83], v[188:191], v[32:47]
    v_fmac_f32 v200, v9, v161
    v_permlane32_swap_b32 v196, v254
    v_fmac_f32 v200, v10, v162
    v_mfma_f32_32x32x16_bf16 v[48:63], v[84:87], v[188:191], v[48:63]
    ds_swizzle_b32 v84, v84 offset:0x401F
    ds_swizzle_b32 v85, v85 offset:0x401F
    ds_swizzle_b32 v86, v86 offset:0x401F
    ds_swizzle_b32 v87, v87 offset:0x401F
    s_waitcnt vmcnt(6)
    ds_read_b64_tr_b16 v[176:177], v244 offset:0
    ds_read_b64_tr_b16 v[178:179], v244 offset:1024
    ds_read_b64_tr_b16 v[180:181], v245 offset:0
    ds_read_b64_tr_b16 v[182:183], v245 offset:1024
    v_fmac_f32 v200, v11, v163
    v_fmac_f32 v200, v12, v164
    v_mfma_f32_32x32x16_bf16 v[32:47], v[88:91], v[192:195], v[32:47]
    v_fmac_f32 v200, v13, v165
    v_fmac_f32 v200, v14, v166
    v_mfma_f32_32x32x16_bf16 v[48:63], v[92:95], v[192:195], v[48:63]
    ds_swizzle_b32 v92, v92 offset:0x401F
    ds_swizzle_b32 v93, v93 offset:0x401F
    ds_swizzle_b32 v94, v94 offset:0x401F
    ds_swizzle_b32 v95, v95 offset:0x401F
    v_fmac_f32 v200, v15, v167
    v_add_f32 v254, v196, v254
    s_waitcnt lgkmcnt(8)
    s_mov_b64 exec, s[56:57]
    v_xor_b32 v68, 0x80008000, v68
    v_xor_b32 v69, 0x80008000, v69
    v_xor_b32 v70, 0x80008000, v70
    v_xor_b32 v71, 0x80008000, v71
    v_xor_b32 v76, 0x80008000, v76
    v_xor_b32 v77, 0x80008000, v77
    v_xor_b32 v78, 0x80008000, v78
    v_xor_b32 v79, 0x80008000, v79
    v_xor_b32 v84, 0x80008000, v84
    v_xor_b32 v85, 0x80008000, v85
    v_xor_b32 v86, 0x80008000, v86
    v_xor_b32 v87, 0x80008000, v87
    s_mov_b64 exec, -1
    s_waitcnt vmcnt(4) lgkmcnt(4)
    v_mfma_f32_32x32x16_bf16 v[0:15], v[64:67], v[176:179], 0
    v_mul_f32 v255, v32, v152
    v_fmac_f32 v255, v33, v153
    v_fmac_f32 v255, v34, v154
    s_add_u32 m0, s21, 0
    v_mfma_f32_32x32x16_bf16 v[16:31], v[68:71], v[176:179], v[16:31]
    v_lshl_add_u32 v234, v234, 10, v246
    v_lshl_add_u32 v235, v235, 10, v246
    buffer_load_dwordx4 v234, s[4:7], s38 offen lds
    buffer_load_dwordx4 v235, s[8:11], s38 offen offset:1024 lds
    ds_read_b64_tr_b16 v[176:177], v244 offset:2048
    ds_read_b64_tr_b16 v[178:179], v244 offset:3072
    ds_read_b64_tr_b16 v[184:185], v245 offset:2048
    ds_read_b64_tr_b16 v[186:187], v245 offset:3072
    v_fmac_f32 v255, v35, v155
    v_fmac_f32 v255, v36, v156
    v_fmac_f32 v255, v37, v157
    s_waitcnt vmcnt(4) lgkmcnt(0)
    v_mfma_f32_32x32x16_bf16 v[0:15], v[72:75], v[176:179], v[0:15]
    v_fmac_f32 v255, v38, v158
    v_fmac_f32 v255, v39, v159
    v_fmac_f32 v201, v40, v168
    s_add_u32 m0, s21, 2048
    v_mfma_f32_32x32x16_bf16 v[16:31], v[76:79], v[176:179], v[16:31]
    v_lshl_add_u32 v236, v236, 10, v246
    v_lshl_add_u32 v237, v237, 10, v246
    buffer_load_dwordx4 v236, s[4:7], s39 offen lds
    buffer_load_dwordx4 v237, s[8:11], s39 offen offset:1024 lds
    ds_read_b64_tr_b16 v[176:177], v244 offset:4096
    ds_read_b64_tr_b16 v[178:179], v244 offset:5120
    ds_read_b64_tr_b16 v[188:189], v245 offset:4096
    ds_read_b64_tr_b16 v[190:191], v245 offset:5120
    v_fmac_f32 v201, v41, v169
    v_permlane32_swap_b32 v197, v255
    s_waitcnt vmcnt(4) lgkmcnt(0)
    v_mfma_f32_32x32x16_bf16 v[0:15], v[80:83], v[176:179], v[0:15]
    v_fmac_f32 v201, v42, v170
    v_fmac_f32 v201, v43, v171
    v_fmac_f32 v201, v44, v172
    s_add_u32 m0, s21, 4096
    v_mfma_f32_32x32x16_bf16 v[16:31], v[84:87], v[176:179], v[16:31]
    v_lshl_add_u32 v238, v238, 10, v246
    v_lshl_add_u32 v239, v239, 10, v246
    buffer_load_dwordx4 v238, s[4:7], s40 offen lds
    buffer_load_dwordx4 v239, s[8:11], s40 offen offset:1024 lds
    ds_read_b64_tr_b16 v[176:177], v244 offset:6144
    ds_read_b64_tr_b16 v[178:179], v244 offset:7168
    ds_read_b64_tr_b16 v[192:193], v245 offset:6144
    ds_read_b64_tr_b16 v[194:195], v245 offset:7168
    v_fmac_f32 v201, v45, v173
    v_fmac_f32 v201, v46, v174
    v_fmac_f32 v201, v47, v175
    s_waitcnt lgkmcnt(0)
    s_mov_b64 exec, s[56:57]
    v_xor_b32 v92, 0x80008000, v92
    v_xor_b32 v93, 0x80008000, v93
    v_xor_b32 v94, 0x80008000, v94
    v_xor_b32 v95, 0x80008000, v95
    s_mov_b64 exec, -1
    v_mfma_f32_32x32x16_bf16 v[0:15], v[88:91], v[176:179], v[0:15]
    v_add_f32 v255, v197, v255
    s_set_gpr_idx_on s51, gpr_idx(DST)
    s_nop 0
    v_cvt_pk_bf16_f32 v206, v254, v255
    s_set_gpr_idx_off
    s_add_u32 m0, s21, 6144
    v_mfma_f32_32x32x16_bf16 v[16:31], v[92:95], v[176:179], v[16:31]
    v_lshl_add_u32 v240, v240, 10, v246
    v_lshl_add_u32 v241, v241, 10, v246
    buffer_load_dwordx4 v240, s[4:7], s41 offen lds
    buffer_load_dwordx4 v241, s[8:11], s41 offen offset:1024 lds
    v_mfma_f32_32x32x16_bf16 v[32:47], v[64:67], v[180:183], 0
    v_mul_f32 v254, v0, v144
    v_fmac_f32 v254, v1, v145
    v_fmac_f32 v254, v2, v146
    v_fmac_f32 v254, v3, v147
    v_fmac_f32 v254, v4, v148
    v_mfma_f32_32x32x16_bf16 v[48:63], v[68:71], v[180:183], v[48:63]
    v_fmac_f32 v254, v5, v149
    v_fmac_f32 v254, v6, v150
    v_fmac_f32 v254, v7, v151
    v_fma_f32 v202, v8, -v160, v202
    v_fma_f32 v202, v9, -v161, v202
    v_mfma_f32_32x32x16_bf16 v[32:47], v[72:75], v[184:187], v[32:47]
    v_permlane32_swap_b32 v254, v200
    v_fma_f32 v202, v10, -v162, v202
    v_fma_f32 v202, v11, -v163, v202
    v_fma_f32 v202, v12, -v164, v202
    v_fma_f32 v202, v13, -v165, v202
    v_mfma_f32_32x32x16_bf16 v[48:63], v[76:79], v[184:187], v[48:63]
    v_fma_f32 v202, v14, -v166, v202
    v_fma_f32 v202, v15, -v167, v202
    v_add_f32 v200, v254, v200
    v_fmac_f32 v198, v16, v112
    v_permlane32_swap_b32 v202, v254
    v_mfma_f32_32x32x16_bf16 v[32:47], v[80:83], v[188:191], v[32:47]
    v_fmac_f32 v198, v17, v113
    v_fmac_f32 v198, v18, v114
    v_fmac_f32 v198, v19, v115
    v_fmac_f32 v198, v20, v116
    v_fmac_f32 v198, v21, v117
    v_mfma_f32_32x32x16_bf16 v[48:63], v[84:87], v[188:191], v[48:63]
    s_waitcnt vmcnt(6)
    ds_read_b64_tr_b16 v[176:177], v244 offset:0
    ds_read_b64_tr_b16 v[178:179], v244 offset:1024
    ds_read_b64_tr_b16 v[180:181], v245 offset:0
    ds_read_b64_tr_b16 v[182:183], v245 offset:1024
    v_fmac_f32 v198, v22, v118
    v_fmac_f32 v198, v23, v119
    v_add_f32 v254, v202, v254
    v_mul_f32 v196, v24, v160
    v_fmac_f32 v196, v25, v161
    v_mfma_f32_32x32x16_bf16 v[32:47], v[88:91], v[192:195], v[32:47]
    v_fmac_f32 v196, v26, v162
    v_fmac_f32 v196, v27, v163
    v_fmac_f32 v196, v28, v164
    v_fmac_f32 v196, v29, v165
    v_fmac_f32 v196, v30, v166
    v_mfma_f32_32x32x16_bf16 v[48:63], v[92:95], v[192:195], v[48:63]
    v_add_u32 v249, s48, v249
    v_add_u32 v250, s49, v250
    ds_read_b32 v252, v251 offset:16
    ds_read_b64_tr_b16 v[68:69], v249 offset:0
    ds_read_b64_tr_b16 v[70:71], v249 offset:256
    s_mov_b64 exec, s[54:55]
    ds_read_u16_d16_hi v242, v250 offset:0
    s_mov_b64 exec, -1
    v_fmac_f32 v196, v31, v167
    s_nop 1
    v_permlane32_swap_b32 v198, v196
    v_add_f32 v196, v198, v196
    v_mul_f32 v255, v32, v152
    v_fmac_f32 v255, v33, v153
    v_fmac_f32 v255, v34, v154
    v_fmac_f32 v255, v35, v155
    v_fmac_f32 v255, v36, v156
    v_fmac_f32 v255, v37, v157
    v_fmac_f32 v255, v38, v158
    v_fmac_f32 v255, v39, v159
    v_fma_f32 v203, v40, -v168, v203
    v_fma_f32 v203, v41, -v169, v203
    v_permlane32_swap_b32 v255, v201
    v_fma_f32 v203, v42, -v170, v203
    v_fma_f32 v203, v43, -v171, v203
    v_fma_f32 v203, v44, -v172, v203
    v_fma_f32 v203, v45, -v173, v203
    v_fma_f32 v203, v46, -v174, v203
    v_fma_f32 v203, v47, -v175, v203
    v_add_f32 v201, v255, v201
    v_fmac_f32 v199, v48, v120
    v_permlane32_swap_b32 v203, v255
    v_fmac_f32 v199, v49, v121
    v_fmac_f32 v199, v50, v122
    v_fmac_f32 v199, v51, v123
    v_fmac_f32 v199, v52, v124
    v_fmac_f32 v199, v53, v125
    v_fmac_f32 v199, v54, v126
    v_fmac_f32 v199, v55, v127
    v_add_f32 v255, v203, v255
    v_mul_f32 v197, v56, v168
    v_fmac_f32 v197, v57, v169
    v_fmac_f32 v197, v58, v170
    v_fmac_f32 v197, v59, v171
    v_fmac_f32 v197, v60, v172
    v_fmac_f32 v197, v61, v173
    v_fmac_f32 v197, v62, v174
    v_fmac_f32 v197, v63, v175
    s_nop 1
    v_permlane32_swap_b32 v199, v197
    v_add_f32 v197, v199, v197
    s_set_gpr_idx_on s51, gpr_idx(DST)
    s_nop 0
    v_cvt_pk_bf16_f32 v207, v200, v201
    v_cvt_pk_bf16_f32 v209, v254, v255
    v_cvt_pk_bf16_f32 v208, v196, v197
    s_set_gpr_idx_off
    s_add_u32 s50, s50, 1
    s_add_u32 s51, s51, 6
    s_cmp_ge_u32 s50, 4
    s_cbranch_scc1 LAST0
    s_waitcnt lgkmcnt(3)
    v_readfirstlane_b32 s66, v252
    s_add_u32 s53, s53, 1
    v_mov_b32 v252, s53
    s_cmp_le_u32 s53, s66
    ds_write2_b32 v251, v252, v252 offset0:0 offset1:8
    s_setprio 1
    s_cbranch_scc1 PRIO_8
    s_setprio 0
PRIO_8:
    s_cmp_eq_u32 s52, 4
    s_cbranch_scc1 ITEM_0_4
    s_cmp_eq_u32 s52, 5
    s_cbranch_scc1 ITEM_0_5
    s_cmp_eq_u32 s52, 3
    s_cbranch_scc1 ITEM_0_3
    s_cmp_eq_u32 s52, 6
    s_cbranch_scc1 ITEM_0_6
    s_cmp_eq_u32 s52, 8
    s_cbranch_scc1 ITEM_0_8
    s_branch ITEM_0_2
.p2align 6
ITEM_0_2:
    s_mov_b32 m0, s50
    s_nop 0
    s_movrels_b32 s71, s23
    s_bfe_u32 s46, s71, 0x30012
    s_mov_b32 m0, s46
    s_and_b32 s66, s71, 0x3ffff
    s_movrels_b32 s68, s57
    s_movrels_b32 s69, s61
    s_sub_u32 s48, s66, s47
    s_mov_b32 s47, s66
    s_lshr_b32 s52, s71, 28
    s_lshl_b32 s67, s46, 9
    s_add_u32 s66, s66, s67
    s_sub_u32 s49, s66, s42
    s_mov_b32 s42, s66
    s_bfe_u32 s66, s68, 655360
    s_add_u32 s43, s42, s66
    s_bfe_u32 s39, s69, 655360
    s_bfe_u32 s66, s68, 655370
    s_add_u32 s44, s42, s66
    s_bfe_u32 s40, s69, 655370
    s_bfe_u32 s66, s68, 655380
    s_add_u32 s45, s42, s66
    s_bfe_u32 s41, s69, 655380
    s_and_b32 s66, s46, s33
    s_cselect_b32 s72, -1, 1
    s_cselect_b32 s76, s47, 86912
    s_cmp_ge_u32 s66, 2
    s_cselect_b32 s73, -1, 0
    s_add_u32 s77, s47, 1024
    s_cmp_ge_u32 s66, 4
    s_cselect_b32 s75, -1, 0
    s_cmp_ge_u32 s66, 3
    s_cselect_b32 s74, -1, 1
    s_cselect_b32 s77, s77, 86912
    v_add_u32 v252, s42, v247
    ds_read_u16 v234, v252
    ds_read_u16 v235, v252 offset:64
    v_add_u32 v252, s43, v247
    ds_read_u16 v236, v252
    ds_read_u16 v237, v252 offset:64
    v_add_u32 v252, s44, v247
    ds_read_u16 v238, v252
    ds_read_u16 v239, v252 offset:64
    v_add_u32 v252, s45, v247
    ds_read_u16 v240, v252
    ds_read_u16 v241, v252 offset:64
    s_waitcnt lgkmcnt(8)
    v_lshlrev_b32 v196, 16, v68
    v_and_b32 v197, 0xffff0000, v68
    v_lshlrev_b32 v198, 16, v69
    v_and_b32 v199, 0xffff0000, v69
    v_mul_f32_dpp v200, v242, v196 row_newbcast:0 row_mask:0xf bank_mask:0xf
    v_mul_f32_dpp v201, v242, v197 row_newbcast:1 row_mask:0xf bank_mask:0xf
    v_mul_f32_dpp v202, v242, v196 row_newbcast:8 row_mask:0xf bank_mask:0xf
    v_mul_f32_dpp v203, v242, v197 row_newbcast:9 row_mask:0xf bank_mask:0xf
    v_lshlrev_b32 v196, 16, v70
    v_and_b32 v197, 0xffff0000, v70
    v_cvt_pk_bf16_f32 v64, v200, v201
    v_cvt_pk_bf16_f32 v68, v202, v203
    v_mul_f32_dpp v200, v242, v198 row_newbcast:2 row_mask:0xf bank_mask:0xf
    v_mul_f32_dpp v201, v242, v199 row_newbcast:3 row_mask:0xf bank_mask:0xf
    v_mul_f32_dpp v202, v242, v198 row_newbcast:10 row_mask:0xf bank_mask:0xf
    v_mul_f32_dpp v203, v242, v199 row_newbcast:11 row_mask:0xf bank_mask:0xf
    v_lshlrev_b32 v198, 16, v71
    v_and_b32 v199, 0xffff0000, v71
    v_cvt_pk_bf16_f32 v65, v200, v201
    v_cvt_pk_bf16_f32 v69, v202, v203
    v_mul_f32_dpp v200, v242, v196 row_newbcast:4 row_mask:0xf bank_mask:0xf
    v_mul_f32_dpp v201, v242, v197 row_newbcast:5 row_mask:0xf bank_mask:0xf
    v_mul_f32_dpp v202, v242, v196 row_newbcast:12 row_mask:0xf bank_mask:0xf
    v_mul_f32_dpp v203, v242, v197 row_newbcast:13 row_mask:0xf bank_mask:0xf
    v_cvt_pk_bf16_f32 v66, v200, v201
    v_cvt_pk_bf16_f32 v70, v202, v203
    v_mul_f32_dpp v200, v242, v198 row_newbcast:6 row_mask:0xf bank_mask:0xf
    v_mul_f32_dpp v201, v242, v199 row_newbcast:7 row_mask:0xf bank_mask:0xf
    v_mul_f32_dpp v202, v242, v198 row_newbcast:14 row_mask:0xf bank_mask:0xf
    v_mul_f32_dpp v203, v242, v199 row_newbcast:15 row_mask:0xf bank_mask:0xf
    v_cvt_pk_bf16_f32 v67, v200, v201
    v_cvt_pk_bf16_f32 v71, v202, v203
    s_nop 0
    s_waitcnt lgkmcnt(6)
    v_mfma_f32_32x32x16_bf16 v[0:15], v[64:67], v[176:179], 0
    s_add_u32 m0, s21, 0
    v_mfma_f32_32x32x16_bf16 v[16:31], v[68:71], v[176:179], 0
    v_lshl_add_u32 v234, v234, 10, v246
    v_lshl_add_u32 v235, v235, 10, v246
    buffer_load_dwordx4 v234, s[4:7], s38 offen lds
    buffer_load_dwordx4 v235, s[8:11], s38 offen offset:1024 lds
    v_mfma_f32_32x32x16_bf16 v[32:47], v[64:67], v[180:183], 0
    s_nop 4
    v_mul_f32 v196, v0, v96
    v_fmac_f32 v196, v1, v97
    v_fmac_f32 v196, v2, v98
    v_fmac_f32 v196, v3, v99
    v_fmac_f32 v196, v4, v100
    v_fmac_f32 v196, v5, v101
    v_fmac_f32 v196, v6, v102
    v_fmac_f32 v196, v7, v103
    v_mul_f32 v198, v8, v128
    v_fmac_f32 v198, v9, v129
    v_fmac_f32 v198, v10, v130
    v_fmac_f32 v198, v11, v131
    v_fmac_f32 v198, v12, v132
    v_fmac_f32 v198, v13, v133
    v_fmac_f32 v198, v14, v134
    v_fmac_f32 v198, v15, v135
    v_mul_f32 v200, v16, v128
    v_fmac_f32 v200, v17, v129
    v_permlane32_swap_b32 v196, v198
    v_mfma_f32_32x32x16_bf16 v[48:63], v[68:71], v[180:183], 0
    v_lshl_add_u32 v253, v248, 2, s47
    ds_read_b32 v254, v253
    ds_read_b32 v255, v253 offset:1024
    s_waitcnt vmcnt(6)
    ds_read_b64_tr_b16 v[176:177], v244 offset:2048
    ds_read_b64_tr_b16 v[178:179], v244 offset:3072
    ds_read_b64_tr_b16 v[180:181], v245 offset:2048
    ds_read_b64_tr_b16 v[182:183], v245 offset:3072
    v_fmac_f32 v200, v18, v130
    v_fmac_f32 v200, v19, v131
    v_fmac_f32 v200, v20, v132
    v_fmac_f32 v200, v21, v133
    v_fmac_f32 v200, v22, v134
    v_fmac_f32 v200, v23, v135
    v_add_f32 v198, v196, v198
    v_mul_f32_e64 v202, v24, -v128
    v_fma_f32 v202, v25, -v129, v202
    v_fma_f32 v202, v26, -v130, v202
    v_fma_f32 v202, v27, -v131, v202
    v_fma_f32 v202, v28, -v132, v202
    v_fma_f32 v202, v29, -v133, v202
    v_fma_f32 v202, v30, -v134, v202
    v_fma_f32 v202, v31, -v135, v202
    s_nop 1
    v_permlane32_swap_b32 v200, v202
    v_add_f32 v202, v200, v202
    s_waitcnt lgkmcnt(0)
    v_mfma_f32_32x32x16_bf16 v[0:15], v[64:67], v[176:179], 0
    v_mul_f32 v197, v32, v104
    v_fmac_f32 v197, v33, v105
    v_fmac_f32 v197, v34, v106
    v_fmac_f32 v197, v35, v107
    v_fmac_f32 v197, v36, v108
    v_fmac_f32 v197, v37, v109
    v_fmac_f32 v197, v38, v110
    v_fmac_f32 v197, v39, v111
    v_mul_f32 v199, v40, v136
    v_fmac_f32 v199, v41, v137
    v_fmac_f32 v199, v42, v138
    v_fmac_f32 v199, v43, v139
    v_fmac_f32 v199, v44, v140
    v_fmac_f32 v199, v45, v141
    v_fmac_f32 v199, v46, v142
    v_fmac_f32 v199, v47, v143
    v_mul_f32 v201, v48, v136
    v_fmac_f32 v201, v49, v137
    v_permlane32_swap_b32 v197, v199
    v_fmac_f32 v201, v50, v138
    v_fmac_f32 v201, v51, v139
    s_add_u32 m0, s21, 2048
    v_mfma_f32_32x32x16_bf16 v[16:31], v[68:71], v[176:179], 0
    v_lshl_add_u32 v236, v236, 10, v246
    v_lshl_add_u32 v237, v237, 10, v246
    buffer_load_dwordx4 v236, s[4:7], s39 offen lds
    buffer_load_dwordx4 v237, s[8:11], s39 offen offset:1024 lds
    s_mov_b32 m0, s76
    s_mov_b64 exec, s[72:73]
    buffer_load_dwordx4 v254, s[12:15], 0 offen  lds
    s_mov_b32 m0, s77
    s_mov_b64 exec, s[74:75]
    buffer_load_dwordx4 v255, s[12:15], 0 offen  lds
    s_mov_b64 exec, -1
    v_fmac_f32 v201, v52, v140
    v_fmac_f32 v201, v53, v141
    v_fmac_f32 v201, v54, v142
    v_fmac_f32 v201, v55, v143
    v_add_f32 v199, v197, v199
    v_mul_f32_e64 v203, v56, -v136
    v_fma_f32 v203, v57, -v137, v203
    v_fma_f32 v203, v58, -v138, v203
    v_fma_f32 v203, v59, -v139, v203
    v_fma_f32 v203, v60, -v140, v203
    v_fma_f32 v203, v61, -v141, v203
    v_fma_f32 v203, v62, -v142, v203
    v_fma_f32 v203, v63, -v143, v203
    s_nop 1
    v_permlane32_swap_b32 v201, v203
    v_add_f32 v203, v201, v203
    s_set_gpr_idx_on s51, gpr_idx(DST)
    s_nop 0
    v_cvt_pk_bf16_f32 v204, v198, v199
    v_cvt_pk_bf16_f32 v205, v202, v203
    s_set_gpr_idx_off
    v_mfma_f32_32x32x16_bf16 v[32:47], v[64:67], v[180:183], 0
    v_mul_f32 v196, v0, v144
    v_fmac_f32 v196, v1, v145
    v_fmac_f32 v196, v2, v146
    v_fmac_f32 v196, v3, v147
    v_fmac_f32 v196, v4, v148
    v_fmac_f32 v196, v5, v149
    v_fmac_f32 v196, v6, v150
    v_fmac_f32 v196, v7, v151
    v_mul_f32 v198, v8, v112
    v_fmac_f32 v198, v9, v113
    v_fmac_f32 v198, v10, v114
    v_fmac_f32 v198, v11, v115
    v_fmac_f32 v198, v12, v116
    v_fmac_f32 v198, v13, v117
    v_fmac_f32 v198, v14, v118
    v_fmac_f32 v198, v15, v119
    v_mfma_f32_32x32x16_bf16 v[48:63], v[68:71], v[180:183], 0
    s_waitcnt vmcnt(8)
    ds_read_b64_tr_b16 v[176:177], v244 offset:4096
    ds_read_b64_tr_b16 v[178:179], v244 offset:5120
    ds_read_b64_tr_b16 v[180:181], v245 offset:4096
    ds_read_b64_tr_b16 v[182:183], v245 offset:5120
    v_mul_f32_e64 v200, v16, -v160
    v_fma_f32 v200, v17, -v161, v200
    v_fma_f32 v200, v18, -v162, v200
    v_fma_f32 v200, v19, -v163, v200
    v_fma_f32 v200, v20, -v164, v200
    v_fma_f32 v200, v21, -v165, v200
    v_fma_f32 v200, v22, -v166, v200
    v_fma_f32 v200, v23, -v167, v200
    v_mul_f32_e64 v202, v24, -v160
    v_fma_f32 v202, v25, -v161, v202
    v_fma_f32 v202, v26, -v162, v202
    v_fma_f32 v202, v27, -v163, v202
    v_fma_f32 v202, v28, -v164, v202
    v_fma_f32 v202, v29, -v165, v202
    v_fma_f32 v202, v30, -v166, v202
    v_fma_f32 v202, v31, -v167, v202
    s_waitcnt lgkmcnt(0)
    v_mfma_f32_32x32x16_bf16 v[0:15], v[64:67], v[176:179], 0
    v_mul_f32 v197, v32, v152
    v_fmac_f32 v197, v33, v153
    v_fmac_f32 v197, v34, v154
    v_fmac_f32 v197, v35, v155
    v_fmac_f32 v197, v36, v156
    v_fmac_f32 v197, v37, v157
    v_fmac_f32 v197, v38, v158
    v_fmac_f32 v197, v39, v159
    v_mul_f32 v199, v40, v120
    v_fmac_f32 v199, v41, v121
    v_fmac_f32 v199, v42, v122
    v_fmac_f32 v199, v43, v123
    v_fmac_f32 v199, v44, v124
    v_fmac_f32 v199, v45, v125
    v_fmac_f32 v199, v46, v126
    v_fmac_f32 v199, v47, v127
    s_add_u32 m0, s21, 4096
    v_mfma_f32_32x32x16_bf16 v[16:31], v[68:71], v[176:179], 0
    v_lshl_add_u32 v238, v238, 10, v246
    v_lshl_add_u32 v239, v239, 10, v246
    buffer_load_dwordx4 v238, s[4:7], s40 offen lds
    buffer_load_dwordx4 v239, s[8:11], s40 offen offset:1024 lds
    v_mul_f32_e64 v201, v48, -v168
    v_fma_f32 v201, v49, -v169, v201
    v_fma_f32 v201, v50, -v170, v201
    v_fma_f32 v201, v51, -v171, v201
    v_fma_f32 v201, v52, -v172, v201
    v_fma_f32 v201, v53, -v173, v201
    v_fma_f32 v201, v54, -v174, v201
    v_fma_f32 v201, v55, -v175, v201
    v_mul_f32_e64 v203, v56, -v168
    v_fma_f32 v203, v57, -v169, v203
    v_fma_f32 v203, v58, -v170, v203
    v_fma_f32 v203, v59, -v171, v203
    v_fma_f32 v203, v60, -v172, v203
    v_fma_f32 v203, v61, -v173, v203
    v_fma_f32 v203, v62, -v174, v203
    v_fma_f32 v203, v63, -v175, v203
    v_mfma_f32_32x32x16_bf16 v[32:47], v[64:67], v[180:183], 0
    v_mul_f32 v254, v0, v144
    v_fmac_f32 v254, v1, v145
    v_fmac_f32 v254, v2, v146
    v_fmac_f32 v254, v3, v147
    v_fmac_f32 v254, v4, v148
    v_fmac_f32 v254, v5, v149
    v_fmac_f32 v254, v6, v150
    v_fmac_f32 v254, v7, v151
    v_fmac_f32 v200, v8, v160
    v_mfma_f32_32x32x16_bf16 v[48:63], v[68:71], v[180:183], 0
    ds_swizzle_b32 v68, v68 offset:0x401F
    ds_swizzle_b32 v69, v69 offset:0x401F
    ds_swizzle_b32 v70, v70 offset:0x401F
    ds_swizzle_b32 v71, v71 offset:0x401F
    s_waitcnt vmcnt(8)
    ds_read_b64_tr_b16 v[176:177], v244 offset:6144
    ds_read_b64_tr_b16 v[178:179], v244 offset:7168
    ds_read_b64_tr_b16 v[180:181], v245 offset:6144
    ds_read_b64_tr_b16 v[182:183], v245 offset:7168
    v_fmac_f32 v200, v9, v161
    v_permlane32_swap_b32 v196, v254
    v_fmac_f32 v200, v10, v162
    v_fmac_f32 v200, v11, v163
    v_fmac_f32 v200, v12, v164
    v_fmac_f32 v200, v13, v165
    v_fmac_f32 v200, v14, v166
    v_fmac_f32 v200, v15, v167
    v_add_f32 v254, v196, v254
    s_waitcnt lgkmcnt(0)
    s_mov_b64 exec, s[56:57]
    v_xor_b32 v68, 0x80008000, v68
    v_xor_b32 v69, 0x80008000, v69
    v_xor_b32 v70, 0x80008000, v70
    v_xor_b32 v71, 0x80008000, v71
    s_mov_b64 exec, -1
    s_nop 0
    v_mfma_f32_32x32x16_bf16 v[0:15], v[64:67], v[176:179], 0
    v_mul_f32 v255, v32, v152
    v_fmac_f32 v255, v33, v153
    v_fmac_f32 v255, v34, v154
    v_fmac_f32 v255, v35, v155
    v_fmac_f32 v255, v36, v156
    v_fmac_f32 v255, v37, v157
    v_fmac_f32 v255, v38, v158
    v_fmac_f32 v255, v39, v159
    v_fmac_f32 v201, v40, v168
    v_fmac_f32 v201, v41, v169
    v_permlane32_swap_b32 v197, v255
    s_add_u32 m0, s21, 6144
    v_mfma_f32_32x32x16_bf16 v[16:31], v[68:71], v[176:179], v[16:31]
    v_lshl_add_u32 v240, v240, 10, v246
    v_lshl_add_u32 v241, v241, 10, v246
    buffer_load_dwordx4 v240, s[4:7], s41 offen lds
    buffer_load_dwordx4 v241, s[8:11], s41 offen offset:1024 lds
    v_fmac_f32 v201, v42, v170
    v_fmac_f32 v201, v43, v171
    v_fmac_f32 v201, v44, v172
    v_fmac_f32 v201, v45, v173
    v_fmac_f32 v201, v46, v174
    v_fmac_f32 v201, v47, v175
    v_add_f32 v255, v197, v255
    s_set_gpr_idx_on s51, gpr_idx(DST)
    s_nop 0
    v_cvt_pk_bf16_f32 v206, v254, v255
    s_set_gpr_idx_off
    v_mfma_f32_32x32x16_bf16 v[32:47], v[64:67], v[180:183], 0
    v_mul_f32 v254, v0, v144
    v_fmac_f32 v254, v1, v145
    v_fmac_f32 v254, v2, v146
    v_fmac_f32 v254, v3, v147
    v_fmac_f32 v254, v4, v148
    v_fmac_f32 v254, v5, v149
    v_fmac_f32 v254, v6, v150
    v_fmac_f32 v254, v7, v151
    v_fma_f32 v202, v8, -v160, v202
    v_fma_f32 v202, v9, -v161, v202
    v_permlane32_swap_b32 v254, v200
    v_fma_f32 v202, v10, -v162, v202
    v_fma_f32 v202, v11, -v163, v202
    v_fma_f32 v202, v12, -v164, v202
    v_fma_f32 v202, v13, -v165, v202
    v_fma_f32 v202, v14, -v166, v202
    v_fma_f32 v202, v15, -v167, v202
    v_add_f32 v200, v254, v200
    v_fmac_f32 v198, v16, v112
    v_permlane32_swap_b32 v202, v254
    v_mfma_f32_32x32x16_bf16 v[48:63], v[68:71], v[180:183], v[48:63]
    s_waitcnt vmcnt(4)
    ds_read_b64_tr_b16 v[176:177], v244 offset:0
    ds_read_b64_tr_b16 v[178:179], v244 offset:1024
    ds_read_b64_tr_b16 v[180:181], v245 offset:0
    ds_read_b64_tr_b16 v[182:183], v245 offset:1024
    v_add_u32 v249, s48, v249
    v_add_u32 v250, s49, v250
    ds_read_b32 v252, v251 offset:16
    ds_read_b64_tr_b16 v[68:69], v249 offset:0
    ds_read_b64_tr_b16 v[70:71], v249 offset:256
    s_mov_b64 exec, s[54:55]
    ds_read_u16_d16_hi v242, v250 offset:0
    s_mov_b64 exec, -1
    v_fmac_f32 v198, v17, v113
    v_fmac_f32 v198, v18, v114
    v_fmac_f32 v198, v19, v115
    v_fmac_f32 v198, v20, v116
    v_fmac_f32 v198, v21, v117
    v_fmac_f32 v198, v22, v118
    v_fmac_f32 v198, v23, v119
    v_add_f32 v254, v202, v254
    v_mul_f32 v196, v24, v160
    v_fmac_f32 v196, v25, v161
    v_fmac_f32 v196, v26, v162
    v_fmac_f32 v196, v27, v163
    v_fmac_f32 v196, v28, v164
    v_fmac_f32 v196, v29, v165
    v_fmac_f32 v196, v30, v166
    v_fmac_f32 v196, v31, v167
    s_nop 1
    v_permlane32_swap_b32 v198, v196
    v_add_f32 v196, v198, v196
    v_mul_f32 v255, v32, v152
    v_fmac_f32 v255, v33, v153
    v_fmac_f32 v255, v34, v154
    v_fmac_f32 v255, v35, v155
    v_fmac_f32 v255, v36, v156
    v_fmac_f32 v255, v37, v157
    v_fmac_f32 v255, v38, v158
    v_fmac_f32 v255, v39, v159
    v_fma_f32 v203, v40, -v168, v203
    v_fma_f32 v203, v41, -v169, v203
    v_permlane32_swap_b32 v255, v201
    v_fma_f32 v203, v42, -v170, v203
    v_fma_f32 v203, v43, -v171, v203
    v_fma_f32 v203, v44, -v172, v203
    v_fma_f32 v203, v45, -v173, v203
    v_fma_f32 v203, v46, -v174, v203
    v_fma_f32 v203, v47, -v175, v203
    v_add_f32 v201, v255, v201
    v_fmac_f32 v199, v48, v120
    v_permlane32_swap_b32 v203, v255
    v_fmac_f32 v199, v49, v121
    v_fmac_f32 v199, v50, v122
    v_fmac_f32 v199, v51, v123
    v_fmac_f32 v199, v52, v124
    v_fmac_f32 v199, v53, v125
    v_fmac_f32 v199, v54, v126
    v_fmac_f32 v199, v55, v127
    v_add_f32 v255, v203, v255
    v_mul_f32 v197, v56, v168
    v_fmac_f32 v197, v57, v169
    v_fmac_f32 v197, v58, v170
    v_fmac_f32 v197, v59, v171
    v_fmac_f32 v197, v60, v172
    v_fmac_f32 v197, v61, v173
    v_fmac_f32 v197, v62, v174
    v_fmac_f32 v197, v63, v175
    s_nop 1
    v_permlane32_swap_b32 v199, v197
    v_add_f32 v197, v199, v197
    s_set_gpr_idx_on s51, gpr_idx(DST)
    s_nop 0
    v_cvt_pk_bf16_f32 v207, v200, v201
    v_cvt_pk_bf16_f32 v209, v254, v255
    v_cvt_pk_bf16_f32 v208, v196, v197
    s_set_gpr_idx_off
    s_add_u32 s50, s50, 1
    s_add_u32 s51, s51, 6
    s_cmp_ge_u32 s50, 4
    s_cbranch_scc1 LAST0
    s_waitcnt lgkmcnt(3)
    v_readfirstlane_b32 s66, v252
    s_add_u32 s53, s53, 1
    v_mov_b32 v252, s53
    s_cmp_le_u32 s53, s66
    ds_write2_b32 v251, v252, v252 offset0:0 offset1:8
    s_setprio 1
    s_cbranch_scc1 PRIO_9
    s_setprio 0
PRIO_9:
    s_cmp_eq_u32 s52, 4
    s_cbranch_scc1 ITEM_0_4
    s_cmp_eq_u32 s52, 5
    s_cbranch_scc1 ITEM_0_5
    s_cmp_eq_u32 s52, 3
    s_cbranch_scc1 ITEM_0_3
    s_cmp_eq_u32 s52, 6
    s_cbranch_scc1 ITEM_0_6
    s_cmp_eq_u32 s52, 8
    s_cbranch_scc1 ITEM_0_8
    s_branch ITEM_0_2
.p2align 6
ITEM_1_4:
    s_mov_b64 exec, s[54:55]
    ds_read_u16_d16_hi v243, v250 offset:128
    s_mov_b64 exec, -1
    ds_read_b64_tr_b16 v[76:77], v249 offset:512
    ds_read_b64_tr_b16 v[78:79], v249 offset:768
    s_waitcnt lgkmcnt(3)
    v_lshlrev_b32 v196, 16, v68
    v_and_b32 v197, 0xffff0000, v68
    v_lshlrev_b32 v198, 16, v69
    v_and_b32 v199, 0xffff0000, v69
    v_mul_f32_dpp v200, v242, v196 row_newbcast:0 row_mask:0xf bank_mask:0xf
    v_mul_f32_dpp v201, v242, v197 row_newbcast:1 row_mask:0xf bank_mask:0xf
    v_mul_f32_dpp v202, v242, v196 row_newbcast:8 row_mask:0xf bank_mask:0xf
    v_mul_f32_dpp v203, v242, v197 row_newbcast:9 row_mask:0xf bank_mask:0xf
    v_lshlrev_b32 v196, 16, v70
    v_and_b32 v197, 0xffff0000, v70
    v_cvt_pk_bf16_f32 v64, v200, v201
    v_cvt_pk_bf16_f32 v68, v202, v203
    v_mul_f32_dpp v200, v242, v198 row_newbcast:2 row_mask:0xf bank_mask:0xf
    v_mul_f32_dpp v201, v242, v199 row_newbcast:3 row_mask:0xf bank_mask:0xf
    v_mul_f32_dpp v202, v242, v198 row_newbcast:10 row_mask:0xf bank_mask:0xf
    v_mul_f32_dpp v203, v242, v199 row_newbcast:11 row_mask:0xf bank_mask:0xf
    v_lshlrev_b32 v198, 16, v71
    v_and_b32 v199, 0xffff0000, v71
    v_cvt_pk_bf16_f32 v65, v200, v201
    v_cvt_pk_bf16_f32 v69, v202, v203
    v_mul_f32_dpp v200, v242, v196 row_newbcast:4 row_mask:0xf bank_mask:0xf
    v_mul_f32_dpp v201, v242, v197 row_newbcast:5 row_mask:0xf bank_mask:0xf
    v_mul_f32_dpp v202, v242, v196 row_newbcast:12 row_mask:0xf bank_mask:0xf
    v_mul_f32_dpp v203, v242, v197 row_newbcast:13 row_mask:0xf bank_mask:0xf
    v_cvt_pk_bf16_f32 v66, v200, v201
    v_cvt_pk_bf16_f32 v70, v202, v203
    v_mul_f32_dpp v200, v242, v198 row_newbcast:6 row_mask:0xf bank_mask:0xf
    v_mul_f32_dpp v201, v242, v199 row_newbcast:7 row_mask:0xf bank_mask:0xf
    v_mul_f32_dpp v202, v242, v198 row_newbcast:14 row_mask:0xf bank_mask:0xf
    v_mul_f32_dpp v203, v242, v199 row_newbcast:15 row_mask:0xf bank_mask:0xf
    v_cvt_pk_bf16_f32 v67, v200, v201
    v_cvt_pk_bf16_f32 v71, v202, v203
    s_nop 0
    s_waitcnt vmcnt(4) lgkmcnt(0)
    v_mfma_f32_32x32x16_bf16 v[0:15], v[64:67], v[176:179], 0
    v_lshlrev_b32 v196, 16, v76
    v_and_b32 v197, 0xffff0000, v76
    v_lshlrev_b32 v198, 16, v77
    v_and_b32 v199, 0xffff0000, v77
    v_mul_f32_dpp v200, v243, v196 row_newbcast:0 row_mask:0xf bank_mask:0xf
    v_mul_f32_dpp v201, v243, v197 row_newbcast:1 row_mask:0xf bank_mask:0xf
    v_mul_f32_dpp v202, v243, v196 row_newbcast:8 row_mask:0xf bank_mask:0xf
    v_mul_f32_dpp v203, v243, v197 row_newbcast:9 row_mask:0xf bank_mask:0xf
    v_lshlrev_b32 v196, 16, v78
    v_and_b32 v197, 0xffff0000, v78
    v_cvt_pk_bf16_f32 v72, v200, v201
    v_cvt_pk_bf16_f32 v76, v202, v203
    v_mul_f32_dpp v200, v243, v198 row_newbcast:2 row_mask:0xf bank_mask:0xf
    v_mul_f32_dpp v201, v243, v199 row_newbcast:3 row_mask:0xf bank_mask:0xf
    v_mul_f32_dpp v202, v243, v198 row_newbcast:10 row_mask:0xf bank_mask:0xf
    v_mul_f32_dpp v203, v243, v199 row_newbcast:11 row_mask:0xf bank_mask:0xf
    s_add_u32 m0, s21, 0
    v_mfma_f32_32x32x16_bf16 v[16:31], v[68:71], v[176:179], 0
    buffer_load_dwordx4 v234, s[4:7], s36 offen lds
    buffer_load_dwordx4 v235, s[8:11], s36 offen offset:1024 lds
    ds_read_b64_tr_b16 v[176:177], v244 offset:2048
    ds_read_b64_tr_b16 v[178:179], v244 offset:3072
    ds_read_b64_tr_b16 v[184:185], v245 offset:2048
    ds_read_b64_tr_b16 v[186:187], v245 offset:3072
    v_lshlrev_b32 v198, 16, v79
    v_and_b32 v199, 0xffff0000, v79
    v_cvt_pk_bf16_f32 v73, v200, v201
    v_cvt_pk_bf16_f32 v77, v202, v203
    v_mul_f32_dpp v200, v243, v196 row_newbcast:4 row_mask:0xf bank_mask:0xf
    v_mul_f32_dpp v201, v243, v197 row_newbcast:5 row_mask:0xf bank_mask:0xf
    v_mul_f32_dpp v202, v243, v196 row_newbcast:12 row_mask:0xf bank_mask:0xf
    v_mul_f32_dpp v203, v243, v197 row_newbcast:13 row_mask:0xf bank_mask:0xf
    v_cvt_pk_bf16_f32 v74, v200, v201
    v_cvt_pk_bf16_f32 v78, v202, v203
    v_mul_f32_dpp v200, v243, v198 row_newbcast:6 row_mask:0xf bank_mask:0xf
    v_mul_f32_dpp v201, v243, v199 row_newbcast:7 row_mask:0xf bank_mask:0xf
    v_mul_f32_dpp v202, v243, v198 row_newbcast:14 row_mask:0xf bank_mask:0xf
    v_mul_f32_dpp v203, v243, v199 row_newbcast:15 row_mask:0xf bank_mask:0xf
    v_cvt_pk_bf16_f32 v75, v200, v201
    v_cvt_pk_bf16_f32 v79, v202, v203
    s_nop 0
    s_waitcnt lgkmcnt(0)
    v_mfma_f32_32x32x16_bf16 v[0:15], v[72:75], v[176:179], v[0:15]
    s_add_u32 m0, s21, 2048
    v_mfma_f32_32x32x16_bf16 v[16:31], v[76:79], v[176:179], v[16:31]
    buffer_load_dwordx4 v236, s[4:7], s36 offen lds
    buffer_load_dwordx4 v237, s[8:11], s36 offen offset:1024 lds
    s_mov_b32 m0, s50
    s_nop 0
    s_movrels_b32 s71, s23
    s_movrels_b32 s33, s28
    s_and_b32 s70, s33, 0x70
    s_andn2_b32 s33, s33, 0x70
    v_xor_b32 v253, s70, v248
    v_add_u32 v253, s33, v253
    s_bfe_u32 s46, s71, 0x30012
    s_mov_b32 m0, s46
    s_and_b32 s66, s71, 0x3ffff
    s_movrels_b32 s68, s57
    s_movrels_b32 s69, s61
    s_sub_u32 s48, s66, s47
    s_mov_b32 s47, s66
    s_lshr_b32 s52, s71, 28
    s_lshl_b32 s67, s46, 9
    s_add_u32 s66, s66, s67
    s_sub_u32 s49, s66, s42
    s_mov_b32 s42, s66
    s_bfe_u32 s66, s68, 655360
    s_add_u32 s43, s42, s66
    s_bfe_u32 s39, s69, 655360
    s_bfe_u32 s66, s68, 655370
    s_add_u32 s44, s42, s66
    s_bfe_u32 s40, s69, 655370
    s_bfe_u32 s66, s68, 655380
    s_add_u32 s45, s42, s66
    s_bfe_u32 s41, s69, 655380
    v_add_u32 v252, s44, v247
    ds_read_u16 v238, v252
    ds_read_u16 v239, v252 offset:64
    v_add_u32 v252, s45, v247
    ds_read_u16 v240, v252
    ds_read_u16 v241, v252 offset:64
    v_mfma_f32_32x32x16_bf16 v[32:47], v[64:67], v[180:183], 0
    v_mul_f32 v196, v0, v96
    v_fmac_f32 v196, v1, v97
    v_fmac_f32 v196, v2, v98
    v_fmac_f32 v196, v3, v99
    v_fmac_f32 v196, v4, v100
    v_fmac_f32 v196, v5, v101
    v_fmac_f32 v196, v6, v102
    v_fmac_f32 v196, v7, v103
    v_mul_f32 v198, v8, v128
    v_fmac_f32 v198, v9, v129
    v_mfma_f32_32x32x16_bf16 v[48:63], v[68:71], v[180:183], 0
    s_waitcnt vmcnt(6)
    ds_read_b64_tr_b16 v[176:177], v244 offset:4096
    ds_read_b64_tr_b16 v[178:179], v244 offset:5120
    ds_read_b64_tr_b16 v[180:181], v245 offset:4096
    ds_read_b64_tr_b16 v[182:183], v245 offset:5120
    v_fmac_f32 v198, v10, v130
    v_fmac_f32 v198, v11, v131
    v_fmac_f32 v198, v12, v132
    v_fmac_f32 v198, v13, v133
    v_fmac_f32 v198, v14, v134
    v_fmac_f32 v198, v15, v135
    v_mul_f32 v200, v16, v128
    v_fmac_f32 v200, v17, v129
    v_permlane32_swap_b32 v196, v198
    v_mfma_f32_32x32x16_bf16 v[32:47], v[72:75], v[184:187], v[32:47]
    v_fmac_f32 v200, v18, v130
    v_fmac_f32 v200, v19, v131
    v_fmac_f32 v200, v20, v132
    v_fmac_f32 v200, v21, v133
    v_fmac_f32 v200, v22, v134
    v_fmac_f32 v200, v23, v135
    v_add_f32 v198, v196, v198
    v_mul_f32_e64 v202, v24, -v128
    v_fma_f32 v202, v25, -v129, v202
    v_mfma_f32_32x32x16_bf16 v[48:63], v[76:79], v[184:187], v[48:63]
    v_fma_f32 v202, v26, -v130, v202
    v_fma_f32 v202, v27, -v131, v202
    v_fma_f32 v202, v28, -v132, v202
    v_fma_f32 v202, v29, -v133, v202
    v_fma_f32 v202, v30, -v134, v202
    v_fma_f32 v202, v31, -v135, v202
    s_nop 1
    v_permlane32_swap_b32 v200, v202
    v_add_f32 v202, v200, v202
    s_waitcnt vmcnt(4) lgkmcnt(0)
    v_mfma_f32_32x32x16_bf16 v[0:15], v[64:67], v[176:179], 0
    v_mul_f32 v197, v32, v104
    v_fmac_f32 v197, v33, v105
    v_fmac_f32 v197, v34, v106
    v_fmac_f32 v197, v35, v107
    v_fmac_f32 v197, v36, v108
    v_fmac_f32 v197, v37, v109
    v_fmac_f32 v197, v38, v110
    v_fmac_f32 v197, v39, v111
    v_mul_f32 v199, v40, v136
    v_fmac_f32 v199, v41, v137
    v_fmac_f32 v199, v42, v138
    s_add_u32 m0, s21, 4096
    v_mfma_f32_32x32x16_bf16 v[16:31], v[68:71], v[176:179], 0
    buffer_load_dwordx4 v234, s[4:7], s37 offen lds
    buffer_load_dwordx4 v235, s[8:11], s37 offen offset:1024 lds
    ds_read_b64_tr_b16 v[176:177], v244 offset:6144
    ds_read_b64_tr_b16 v[178:179], v244 offset:7168
    ds_read_b64_tr_b16 v[184:185], v245 offset:6144
    ds_read_b64_tr_b16 v[186:187], v245 offset:7168
    v_add_u32 v252, s42, v247
    ds_read_u16 v234, v252
    ds_read_u16 v235, v252 offset:64
    v_fmac_f32 v199, v43, v139
    v_fmac_f32 v199, v44, v140
    v_fmac_f32 v199, v45, v141
    v_fmac_f32 v199, v46, v142
    v_fmac_f32 v199, v47, v143
    v_mul_f32 v201, v48, v136
    v_fmac_f32 v201, v49, v137
    v_permlane32_swap_b32 v197, v199
    v_fmac_f32 v201, v50, v138
    v_fmac_f32 v201, v51, v139
    s_waitcnt lgkmcnt(2)
    v_mfma_f32_32x32x16_bf16 v[0:15], v[72:75], v[176:179], v[0:15]
    v_fmac_f32 v201, v52, v140
    v_fmac_f32 v201, v53, v141
    v_fmac_f32 v201, v54, v142
    v_fmac_f32 v201, v55, v143
    v_add_f32 v199, v197, v199
    v_mul_f32_e64 v203, v56, -v136
    v_fma_f32 v203, v57, -v137, v203
    v_fma_f32 v203, v58, -v138, v203
    v_fma_f32 v203, v59, -v139, v203
    v_fma_f32 v203, v60, -v140, v203
    s_add_u32 m0, s21, 6144
    v_mfma_f32_32x32x16_bf16 v[16:31], v[76:79], v[176:179], v[16:31]
    buffer_load_dwordx4 v236, s[4:7], s37 offen lds
    buffer_load_dwordx4 v237, s[8:11], s37 offen offset:1024 lds
    v_add_u32 v252, s43, v247
    ds_read_u16 v236, v252
    ds_read_u16 v237, v252 offset:64
    v_fma_f32 v203, v61, -v141, v203
    v_fma_f32 v203, v62, -v142, v203
    v_fma_f32 v203, v63, -v143, v203
    s_nop 1
    v_permlane32_swap_b32 v201, v203
    v_add_f32 v203, v201, v203
    v_cvt_pk_bf16_f32 v198, v198, v199
    v_cvt_pk_bf16_f32 v202, v202, v203
    ds_write_b32 v253, v198 offset:0
    ds_write_b32 v253, v202 offset:256
    v_mfma_f32_32x32x16_bf16 v[32:47], v[64:67], v[180:183], 0
    v_mul_f32 v196, v0, v144
    v_fmac_f32 v196, v1, v145
    v_fmac_f32 v196, v2, v146
    v_fmac_f32 v196, v3, v147
    v_fmac_f32 v196, v4, v148
    v_fmac_f32 v196, v5, v149
    v_fmac_f32 v196, v6, v150
    v_fmac_f32 v196, v7, v151
    v_mfma_f32_32x32x16_bf16 v[48:63], v[68:71], v[180:183], 0
    s_waitcnt vmcnt(6)
    ds_read_b64_tr_b16 v[176:177], v244 offset:0
    ds_read_b64_tr_b16 v[178:179], v244 offset:1024
    ds_read_b64_tr_b16 v[180:181], v245 offset:0
    ds_read_b64_tr_b16 v[182:183], v245 offset:1024
    v_mul_f32 v198, v8, v112
    v_fmac_f32 v198, v9, v113
    v_fmac_f32 v198, v10, v114
    v_fmac_f32 v198, v11, v115
    v_fmac_f32 v198, v12, v116
    v_fmac_f32 v198, v13, v117
    v_fmac_f32 v198, v14, v118
    v_fmac_f32 v198, v15, v119
    v_mfma_f32_32x32x16_bf16 v[32:47], v[72:75], v[184:187], v[32:47]
    v_mul_f32_e64 v200, v16, -v160
    v_fma_f32 v200, v17, -v161, v200
    v_fma_f32 v200, v18, -v162, v200
    v_fma_f32 v200, v19, -v163, v200
    v_fma_f32 v200, v20, -v164, v200
    v_fma_f32 v200, v21, -v165, v200
    v_fma_f32 v200, v22, -v166, v200
    v_fma_f32 v200, v23, -v167, v200
    v_mfma_f32_32x32x16_bf16 v[48:63], v[76:79], v[184:187], v[48:63]
    v_mul_f32_e64 v202, v24, -v160
    v_fma_f32 v202, v25, -v161, v202
    v_fma_f32 v202, v26, -v162, v202
    v_fma_f32 v202, v27, -v163, v202
    v_fma_f32 v202, v28, -v164, v202
    v_fma_f32 v202, v29, -v165, v202
    v_fma_f32 v202, v30, -v166, v202
    v_fma_f32 v202, v31, -v167, v202
    s_waitcnt vmcnt(4) lgkmcnt(0)
    v_mfma_f32_32x32x16_bf16 v[0:15], v[64:67], v[176:179], 0
    v_mul_f32 v197, v32, v152
    v_fmac_f32 v197, v33, v153
    v_fmac_f32 v197, v34, v154
    v_fmac_f32 v197, v35, v155
    v_fmac_f32 v197, v36, v156
    v_fmac_f32 v197, v37, v157
    v_fmac_f32 v197, v38, v158
    v_fmac_f32 v197, v39, v159
    s_add_u32 m0, s21, 0
    v_mfma_f32_32x32x16_bf16 v[16:31], v[68:71], v[176:179], 0
    v_lshl_add_u32 v234, v234, 10, v246
    v_lshl_add_u32 v235, v235, 10, v246
    buffer_load_dwordx4 v234, s[4:7], s38 offen lds
    buffer_load_dwordx4 v235, s[8:11], s38 offen offset:1024 lds
    ds_read_b64_tr_b16 v[176:177], v244 offset:2048
    ds_read_b64_tr_b16 v[178:179], v244 offset:3072
    ds_read_b64_tr_b16 v[184:185], v245 offset:2048
    ds_read_b64_tr_b16 v[186:187], v245 offset:3072
    v_mul_f32 v199, v40, v120
    v_fmac_f32 v199, v41, v121
    v_fmac_f32 v199, v42, v122
    v_fmac_f32 v199, v43, v123
    v_fmac_f32 v199, v44, v124
    v_fmac_f32 v199, v45, v125
    v_fmac_f32 v199, v46, v126
    v_fmac_f32 v199, v47, v127
    s_waitcnt lgkmcnt(0)
    v_mfma_f32_32x32x16_bf16 v[0:15], v[72:75], v[176:179], v[0:15]
    v_mul_f32_e64 v201, v48, -v168
    v_fma_f32 v201, v49, -v169, v201
    v_fma_f32 v201, v50, -v170, v201
    v_fma_f32 v201, v51, -v171, v201
    v_fma_f32 v201, v52, -v172, v201
    v_fma_f32 v201, v53, -v173, v201
    v_fma_f32 v201, v54, -v174, v201
    v_fma_f32 v201, v55, -v175, v201
    s_add_u32 m0, s21, 2048
    v_mfma_f32_32x32x16_bf16 v[16:31], v[76:79], v[176:179], v[16:31]
    v_lshl_add_u32 v236, v236, 10, v246
    v_lshl_add_u32 v237, v237, 10, v246
    buffer_load_dwordx4 v236, s[4:7], s39 offen lds
    buffer_load_dwordx4 v237, s[8:11], s39 offen offset:1024 lds
    v_mul_f32_e64 v203, v56, -v168
    v_fma_f32 v203, v57, -v169, v203
    v_fma_f32 v203, v58, -v170, v203
    v_fma_f32 v203, v59, -v171, v203
    v_fma_f32 v203, v60, -v172, v203
    v_fma_f32 v203, v61, -v173, v203
    v_fma_f32 v203, v62, -v174, v203
    v_fma_f32 v203, v63, -v175, v203
    v_mfma_f32_32x32x16_bf16 v[32:47], v[64:67], v[180:183], 0
    v_mul_f32 v254, v0, v144
    v_fmac_f32 v254, v1, v145
    v_fmac_f32 v254, v2, v146
    v_fmac_f32 v254, v3, v147
    v_fmac_f32 v254, v4, v148
    v_mfma_f32_32x32x16_bf16 v[48:63], v[68:71], v[180:183], 0
    ds_swizzle_b32 v68, v68 offset:0x401F
    ds_swizzle_b32 v69, v69 offset:0x401F
    ds_swizzle_b32 v70, v70 offset:0x401F
    ds_swizzle_b32 v71, v71 offset:0x401F
    s_waitcnt vmcnt(6)
    ds_read_b64_tr_b16 v[176:177], v244 offset:4096
    ds_read_b64_tr_b16 v[178:179], v244 offset:5120
    ds_read_b64_tr_b16 v[180:181], v245 offset:4096
    ds_read_b64_tr_b16 v[182:183], v245 offset:5120
    v_fmac_f32 v254, v5, v149
    v_fmac_f32 v254, v6, v150
    v_fmac_f32 v254, v7, v151
    v_fmac_f32 v200, v8, v160
    v_mfma_f32_32x32x16_bf16 v[32:47], v[72:75], v[184:187], v[32:47]
    v_fmac_f32 v200, v9, v161
    v_permlane32_swap_b32 v196, v254
    v_fmac_f32 v200, v10, v162
    v_fmac_f32 v200, v11, v163
    v_fmac_f32 v200, v12, v164
    v_mfma_f32_32x32x16_bf16 v[48:63], v[76:79], v[184:187], v[48:63]
    ds_swizzle_b32 v76, v76 offset:0x401F
    ds_swizzle_b32 v77, v77 offset:0x401F
    ds_swizzle_b32 v78, v78 offset:0x401F
    ds_swizzle_b32 v79, v79 offset:0x401F
    v_fmac_f32 v200, v13, v165
    v_fmac_f32 v200, v14, v166
    v_fmac_f32 v200, v15, v167
    v_add_f32 v254, v196, v254
    s_waitcnt lgkmcnt(8)
    s_mov_b64 exec, s[56:57]
    v_xor_b32 v68, 0x80008000, v68
    v_xor_b32 v69, 0x80008000, v69
    v_xor_b32 v70, 0x80008000, v70
    v_xor_b32 v71, 0x80008000, v71
    s_mov_b64 exec, -1
    s_waitcnt vmcnt(4) lgkmcnt(4)
    v_mfma_f32_32x32x16_bf16 v[0:15], v[64:67], v[176:179], 0
    v_mul_f32 v255, v32, v152
    v_fmac_f32 v255, v33, v153
    v_fmac_f32 v255, v34, v154
    v_fmac_f32 v255, v35, v155
    v_fmac_f32 v255, v36, v156
    s_add_u32 m0, s21, 4096
    v_mfma_f32_32x32x16_bf16 v[16:31], v[68:71], v[176:179], v[16:31]
    v_lshl_add_u32 v238, v238, 10, v246
    v_lshl_add_u32 v239, v239, 10, v246
    buffer_load_dwordx4 v238, s[4:7], s40 offen lds
    buffer_load_dwordx4 v239, s[8:11], s40 offen offset:1024 lds
    ds_read_b64_tr_b16 v[176:177], v244 offset:6144
    ds_read_b64_tr_b16 v[178:179], v244 offset:7168
    ds_read_b64_tr_b16 v[184:185], v245 offset:6144
    ds_read_b64_tr_b16 v[186:187], v245 offset:7168
    v_fmac_f32 v255, v37, v157
    v_fmac_f32 v255, v38, v158
    v_fmac_f32 v255, v39, v159
    v_fmac_f32 v201, v40, v168
    v_fmac_f32 v201, v41, v169
    s_waitcnt lgkmcnt(0)
    s_mov_b64 exec, s[56:57]
    v_xor_b32 v76, 0x80008000, v76
    v_xor_b32 v77, 0x80008000, v77
    v_xor_b32 v78, 0x80008000, v78
    v_xor_b32 v79, 0x80008000, v79
    s_mov_b64 exec, -1
    v_mfma_f32_32x32x16_bf16 v[0:15], v[72:75], v[176:179], v[0:15]
    v_permlane32_swap_b32 v197, v255
    v_fmac_f32 v201, v42, v170
    v_fmac_f32 v201, v43, v171
    v_fmac_f32 v201, v44, v172
    v_fmac_f32 v201, v45, v173
    s_add_u32 m0, s21, 6144
    v_mfma_f32_32x32x16_bf16 v[16:31], v[76:79], v[176:179], v[16:31]
    v_lshl_add_u32 v240, v240, 10, v246
    v_lshl_add_u32 v241, v241, 10, v246
    buffer_load_dwordx4 v240, s[4:7], s41 offen lds
    buffer_load_dwordx4 v241, s[8:11], s41 offen offset:1024 lds
    v_fmac_f32 v201, v46, v174
    v_fmac_f32 v201, v47, v175
    v_add_f32 v255, v197, v255
    v_cvt_pk_bf16_f32 v254, v254, v255
    ds_write_b32 v253, v254 offset:512
    v_mfma_f32_32x32x16_bf16 v[32:47], v[64:67], v[180:183], 0
    v_mul_f32 v254, v0, v144
    v_fmac_f32 v254, v1, v145
    v_fmac_f32 v254, v2, v146
    v_fmac_f32 v254, v3, v147
    v_fmac_f32 v254, v4, v148
    v_fmac_f32 v254, v5, v149
    v_fmac_f32 v254, v6, v150
    v_fmac_f32 v254, v7, v151
    v_fma_f32 v202, v8, -v160, v202
    v_fma_f32 v202, v9, -v161, v202
    v_mfma_f32_32x32x16_bf16 v[48:63], v[68:71], v[180:183], v[48:63]
    s_waitcnt vmcnt(6)
    ds_read_b64_tr_b16 v[176:177], v244 offset:0
    ds_read_b64_tr_b16 v[178:179], v244 offset:1024
    ds_read_b64_tr_b16 v[180:181], v245 offset:0
    ds_read_b64_tr_b16 v[182:183], v245 offset:1024
    v_permlane32_swap_b32 v254, v200
    v_fma_f32 v202, v10, -v162, v202
    v_fma_f32 v202, v11, -v163, v202
    v_fma_f32 v202, v12, -v164, v202
    v_fma_f32 v202, v13, -v165, v202
    v_fma_f32 v202, v14, -v166, v202
    v_fma_f32 v202, v15, -v167, v202
    v_add_f32 v200, v254, v200
    v_fmac_f32 v198, v16, v112
    v_permlane32_swap_b32 v202, v254
    v_mfma_f32_32x32x16_bf16 v[32:47], v[72:75], v[184:187], v[32:47]
    v_fmac_f32 v198, v17, v113
    v_fmac_f32 v198, v18, v114
    v_fmac_f32 v198, v19, v115
    v_fmac_f32 v198, v20, v116
    v_fmac_f32 v198, v21, v117
    v_fmac_f32 v198, v22, v118
    v_fmac_f32 v198, v23, v119
    v_add_f32 v254, v202, v254
    v_mul_f32 v196, v24, v160
    v_fmac_f32 v196, v25, v161
    v_mfma_f32_32x32x16_bf16 v[48:63], v[76:79], v[184:187], v[48:63]
    v_add_u32 v249, s48, v249
    v_add_u32 v250, s49, v250
    ds_read_b32 v252, v251 offset:16
    ds_read_b64_tr_b16 v[68:69], v249 offset:0
    ds_read_b64_tr_b16 v[70:71], v249 offset:256
    s_mov_b64 exec, s[54:55]
    ds_read_u16_d16_hi v242, v250 offset:0
    s_mov_b64 exec, -1
    v_fmac_f32 v196, v26, v162
    v_fmac_f32 v196, v27, v163
    v_fmac_f32 v196, v28, v164
    v_fmac_f32 v196, v29, v165
    v_fmac_f32 v196, v30, v166
    v_fmac_f32 v196, v31, v167
    s_nop 1
    v_permlane32_swap_b32 v198, v196
    v_add_f32 v196, v198, v196
    v_mul_f32 v255, v32, v152
    v_fmac_f32 v255, v33, v153
    v_fmac_f32 v255, v34, v154
    v_fmac_f32 v255, v35, v155
    v_fmac_f32 v255, v36, v156
    v_fmac_f32 v255, v37, v157
    v_fmac_f32 v255, v38, v158
    v_fmac_f32 v255, v39, v159
    v_fma_f32 v203, v40, -v168, v203
    v_fma_f32 v203, v41, -v169, v203
    v_permlane32_swap_b32 v255, v201
    v_fma_f32 v203, v42, -v170, v203
    v_fma_f32 v203, v43, -v171, v203
    v_fma_f32 v203, v44, -v172, v203
    v_fma_f32 v203, v45, -v173, v203
    v_fma_f32 v203, v46, -v174, v203
    v_fma_f32 v203, v47, -v175, v203
    v_add_f32 v201, v255, v201
    v_fmac_f32 v199, v48, v120
    v_permlane32_swap_b32 v203, v255
    v_fmac_f32 v199, v49, v121
    v_fmac_f32 v199, v50, v122
    v_fmac_f32 v199, v51, v123
    v_fmac_f32 v199, v52, v124
    v_fmac_f32 v199, v53, v125
    v_fmac_f32 v199, v54, v126
    v_fmac_f32 v199, v55, v127
    v_add_f32 v255, v203, v255
    v_mul_f32 v197, v56, v168
    v_fmac_f32 v197, v57, v169
    v_fmac_f32 v197, v58, v170
    v_fmac_f32 v197, v59, v171
    v_fmac_f32 v197, v60, v172
    v_fmac_f32 v197, v61, v173
    v_fmac_f32 v197, v62, v174
    v_fmac_f32 v197, v63, v175
    s_nop 1
    v_permlane32_swap_b32 v199, v197
    v_add_f32 v197, v199, v197
    v_cvt_pk_bf16_f32 v200, v200, v201
    v_cvt_pk_bf16_f32 v254, v254, v255
    v_cvt_pk_bf16_f32 v196, v196, v197
    ds_write_b32 v253, v200 offset:768
    s_mov_b64 exec, 0xffffffff
    ds_write_b32 v253, v254 offset:1280
    s_mov_b64 exec, -1
    ds_write_b32 v253, v196 offset:1024
    s_add_u32 s50, s50, 1
    s_cmp_ge_u32 s50, 5
    s_cbranch_scc1 TAIL
    s_waitcnt lgkmcnt(6)
    v_readfirstlane_b32 s66, v252
    s_add_u32 s53, s53, 1
    v_mov_b32 v252, s53
    s_cmp_le_u32 s53, s66
    ds_write2_b32 v251, v252, v252 offset0:0 offset1:8
    s_setprio 1
    s_cbranch_scc1 PRIO_10
    s_setprio 0
PRIO_10:
    s_cmp_eq_u32 s52, 4
    s_cbranch_scc1 ITEM_1_4
    s_cmp_eq_u32 s52, 5
    s_cbranch_scc1 ITEM_1_5
    s_cmp_eq_u32 s52, 3
    s_cbranch_scc1 ITEM_1_3
    s_cmp_eq_u32 s52, 6
    s_cbranch_scc1 ITEM_1_6
    s_cmp_eq_u32 s52, 8
    s_cbranch_scc1 ITEM_1_8
    s_branch ITEM_1_2
.p2align 6
ITEM_1_5:
    s_mov_b64 exec, s[54:55]
    ds_read_u16_d16_hi v243, v250 offset:128
    s_mov_b64 exec, -1
    ds_read_b64_tr_b16 v[76:77], v249 offset:512
    ds_read_b64_tr_b16 v[78:79], v249 offset:768
    ds_read_b64_tr_b16 v[84:85], v249 offset:1024
    s_waitcnt lgkmcnt(4)
    v_lshlrev_b32 v196, 16, v68
    v_and_b32 v197, 0xffff0000, v68
    v_lshlrev_b32 v198, 16, v69
    v_and_b32 v199, 0xffff0000, v69
    v_mul_f32_dpp v200, v242, v196 row_newbcast:0 row_mask:0xf bank_mask:0xf
    v_mul_f32_dpp v201, v242, v197 row_newbcast:1 row_mask:0xf bank_mask:0xf
    v_mul_f32_dpp v202, v242, v196 row_newbcast:8 row_mask:0xf bank_mask:0xf
    v_mul_f32_dpp v203, v242, v197 row_newbcast:9 row_mask:0xf bank_mask:0xf
    v_lshlrev_b32 v196, 16, v70
    v_and_b32 v197, 0xffff0000, v70
    v_cvt_pk_bf16_f32 v64, v200, v201
    v_cvt_pk_bf16_f32 v68, v202, v203
    v_mul_f32_dpp v200, v242, v198 row_newbcast:2 row_mask:0xf bank_mask:0xf
    v_mul_f32_dpp v201, v242, v199 row_newbcast:3 row_mask:0xf bank_mask:0xf
    v_mul_f32_dpp v202, v242, v198 row_newbcast:10 row_mask:0xf bank_mask:0xf
    v_mul_f32_dpp v203, v242, v199 row_newbcast:11 row_mask:0xf bank_mask:0xf
    v_lshlrev_b32 v198, 16, v71
    v_and_b32 v199, 0xffff0000, v71
    v_cvt_pk_bf16_f32 v65, v200, v201
    v_cvt_pk_bf16_f32 v69, v202, v203
    v_mul_f32_dpp v200, v242, v196 row_newbcast:4 row_mask:0xf bank_mask:0xf
    v_mul_f32_dpp v201, v242, v197 row_newbcast:5 row_mask:0xf bank_mask:0xf
    v_mul_f32_dpp v202, v242, v196 row_newbcast:12 row_mask:0xf bank_mask:0xf
    v_mul_f32_dpp v203, v242, v197 row_newbcast:13 row_mask:0xf bank_mask:0xf
    v_cvt_pk_bf16_f32 v66, v200, v201
    v_cvt_pk_bf16_f32 v70, v202, v203
    v_mul_f32_dpp v200, v242, v198 row_newbcast:6 row_mask:0xf bank_mask:0xf
    v_mul_f32_dpp v201, v242, v199 row_newbcast:7 row_mask:0xf bank_mask:0xf
    v_mul_f32_dpp v202, v242, v198 row_newbcast:14 row_mask:0xf bank_mask:0xf
    v_mul_f32_dpp v203, v242, v199 row_newbcast:15 row_mask:0xf bank_mask:0xf
    v_cvt_pk_bf16_f32 v67, v200, v201
    v_cvt_pk_bf16_f32 v71, v202, v203
    s_mov_b64 exec, s[54:55]
    ds_read_u16_d16_hi v242, v250 offset:256
    s_mov_b64 exec, -1
    s_waitcnt vmcnt(4) lgkmcnt(2)
    v_mfma_f32_32x32x16_bf16 v[0:15], v[64:67], v[176:179], 0
    v_lshlrev_b32 v196, 16, v76
    v_and_b32 v197, 0xffff0000, v76
    v_lshlrev_b32 v198, 16, v77
    v_and_b32 v199, 0xffff0000, v77
    v_mul_f32_dpp v200, v243, v196 row_newbcast:0 row_mask:0xf bank_mask:0xf
    v_mul_f32_dpp v201, v243, v197 row_newbcast:1 row_mask:0xf bank_mask:0xf
    v_mul_f32_dpp v202, v243, v196 row_newbcast:8 row_mask:0xf bank_mask:0xf
    v_mul_f32_dpp v203, v243, v197 row_newbcast:9 row_mask:0xf bank_mask:0xf
    v_lshlrev_b32 v196, 16, v78
    v_and_b32 v197, 0xffff0000, v78
    v_cvt_pk_bf16_f32 v72, v200, v201
    v_cvt_pk_bf16_f32 v76, v202, v203
    v_mul_f32_dpp v200, v243, v198 row_newbcast:2 row_mask:0xf bank_mask:0xf
    v_mul_f32_dpp v201, v243, v199 row_newbcast:3 row_mask:0xf bank_mask:0xf
    v_mul_f32_dpp v202, v243, v198 row_newbcast:10 row_mask:0xf bank_mask:0xf
    v_mul_f32_dpp v203, v243, v199 row_newbcast:11 row_mask:0xf bank_mask:0xf
    s_add_u32 m0, s21, 0
    v_mfma_f32_32x32x16_bf16 v[16:31], v[68:71], v[176:179], 0
    buffer_load_dwordx4 v236, s[4:7], s35 offen lds
    buffer_load_dwordx4 v237, s[8:11], s35 offen offset:1024 lds
    ds_read_b64_tr_b16 v[176:177], v244 offset:2048
    ds_read_b64_tr_b16 v[178:179], v244 offset:3072
    ds_read_b64_tr_b16 v[184:185], v245 offset:2048
    ds_read_b64_tr_b16 v[186:187], v245 offset:3072
    v_lshlrev_b32 v198, 16, v79
    v_and_b32 v199, 0xffff0000, v79
    v_cvt_pk_bf16_f32 v73, v200, v201
    v_cvt_pk_bf16_f32 v77, v202, v203
    v_mul_f32_dpp v200, v243, v196 row_newbcast:4 row_mask:0xf bank_mask:0xf
    v_mul_f32_dpp v201, v243, v197 row_newbcast:5 row_mask:0xf bank_mask:0xf
    v_mul_f32_dpp v202, v243, v196 row_newbcast:12 row_mask:0xf bank_mask:0xf
    v_mul_f32_dpp v203, v243, v197 row_newbcast:13 row_mask:0xf bank_mask:0xf
    v_cvt_pk_bf16_f32 v74, v200, v201
    v_cvt_pk_bf16_f32 v78, v202, v203
    v_mul_f32_dpp v200, v243, v198 row_newbcast:6 row_mask:0xf bank_mask:0xf
    v_mul_f32_dpp v201, v243, v199 row_newbcast:7 row_mask:0xf bank_mask:0xf
    v_mul_f32_dpp v202, v243, v198 row_newbcast:14 row_mask:0xf bank_mask:0xf
    v_mul_f32_dpp v203, v243, v199 row_newbcast:15 row_mask:0xf bank_mask:0xf
    v_cvt_pk_bf16_f32 v75, v200, v201
    v_cvt_pk_bf16_f32 v79, v202, v203
    s_nop 0
    s_waitcnt vmcnt(4) lgkmcnt(0)
    v_mfma_f32_32x32x16_bf16 v[0:15], v[72:75], v[176:179], v[0:15]
    v_lshlrev_b32 v196, 16, v84
    v_and_b32 v197, 0xffff0000, v84
    v_lshlrev_b32 v198, 16, v85
    v_and_b32 v199, 0xffff0000, v85
    v_mul_f32_dpp v200, v242, v196 row_newbcast:0 row_mask:0xf bank_mask:0xf
    v_mul_f32_dpp v201, v242, v197 row_newbcast:1 row_mask:0xf bank_mask:0xf
    v_mul_f32_dpp v202, v242, v196 row_newbcast:8 row_mask:0xf bank_mask:0xf
    v_mul_f32_dpp v203, v242, v197 row_newbcast:9 row_mask:0xf bank_mask:0xf
    s_add_u32 m0, s21, 2048
    v_mfma_f32_32x32x16_bf16 v[16:31], v[76:79], v[176:179], v[16:31]
    buffer_load_dwordx4 v238, s[4:7], s35 offen lds
    ds_read_b64_tr_b16 v[176:177], v244 offset:4096
    ds_read_b64_tr_b16 v[188:189], v245 offset:4096
    v_cvt_pk_bf16_f32 v80, v200, v201
    v_cvt_pk_bf16_f32 v84, v202, v203
    v_mul_f32_dpp v200, v242, v198 row_newbcast:2 row_mask:0xf bank_mask:0xf
    v_mul_f32_dpp v201, v242, v199 row_newbcast:3 row_mask:0xf bank_mask:0xf
    v_mul_f32_dpp v202, v242, v198 row_newbcast:10 row_mask:0xf bank_mask:0xf
    v_mul_f32_dpp v203, v242, v199 row_newbcast:11 row_mask:0xf bank_mask:0xf
    v_cvt_pk_bf16_f32 v81, v200, v201
    v_cvt_pk_bf16_f32 v85, v202, v203
    s_nop 0
    s_waitcnt lgkmcnt(0)
    v_mfma_f32_32x32x8_bf16 v[0:15], v[80:81], v[176:177], v[0:15]
    s_add_u32 m0, s21, 4096
    v_mfma_f32_32x32x8_bf16 v[16:31], v[84:85], v[176:177], v[16:31]
    buffer_load_dwordx4 v234, s[4:7], s36 offen lds
    buffer_load_dwordx4 v235, s[8:11], s36 offen offset:1024 lds
    s_mov_b32 m0, s50
    s_nop 0
    s_movrels_b32 s71, s23
    s_movrels_b32 s33, s28
    s_and_b32 s70, s33, 0x70
    s_andn2_b32 s33, s33, 0x70
    v_xor_b32 v253, s70, v248
    v_add_u32 v253, s33, v253
    s_bfe_u32 s46, s71, 0x30012
    s_mov_b32 m0, s46
    s_and_b32 s66, s71, 0x3ffff
    s_movrels_b32 s68, s57
    s_movrels_b32 s69, s61
    s_sub_u32 s48, s66, s47
    s_mov_b32 s47, s66
    s_lshr_b32 s52, s71, 28
    s_lshl_b32 s67, s46, 9
    s_add_u32 s66, s66, s67
    s_sub_u32 s49, s66, s42
    s_mov_b32 s42, s66
    s_bfe_u32 s66, s68, 655360
    s_add_u32 s43, s42, s66
    s_bfe_u32 s39, s69, 655360
    s_bfe_u32 s66, s68, 655370
    s_add_u32 s44, s42, s66
    s_bfe_u32 s40, s69, 655370
    s_bfe_u32 s66, s68, 655380
    s_add_u32 s45, s42, s66
    s_bfe_u32 s41, s69, 655380
    v_add_u32 v252, s45, v247
    ds_read_u16 v240, v252
    ds_read_u16 v241, v252 offset:64
    v_mfma_f32_32x32x16_bf16 v[32:47], v[64:67], v[180:183], 0
    v_mul_f32 v196, v0, v96
    v_fmac_f32 v196, v1, v97
    v_fmac_f32 v196, v2, v98
    v_fmac_f32 v196, v3, v99
    v_fmac_f32 v196, v4, v100
    v_fmac_f32 v196, v5, v101
    v_fmac_f32 v196, v6, v102
    v_mfma_f32_32x32x16_bf16 v[48:63], v[68:71], v[180:183], 0
    v_fmac_f32 v196, v7, v103
    v_mul_f32 v198, v8, v128
    v_fmac_f32 v198, v9, v129
    v_fmac_f32 v198, v10, v130
    v_fmac_f32 v198, v11, v131
    v_fmac_f32 v198, v12, v132
    v_mfma_f32_32x32x16_bf16 v[32:47], v[72:75], v[184:187], v[32:47]
    v_fmac_f32 v198, v13, v133
    v_fmac_f32 v198, v14, v134
    v_fmac_f32 v198, v15, v135
    v_mul_f32 v200, v16, v128
    v_fmac_f32 v200, v17, v129
    v_permlane32_swap_b32 v196, v198
    v_mfma_f32_32x32x16_bf16 v[48:63], v[76:79], v[184:187], v[48:63]
    s_waitcnt vmcnt(5)
    ds_read_b64_tr_b16 v[176:177], v244 offset:6144
    ds_read_b64_tr_b16 v[178:179], v244 offset:7168
    ds_read_b64_tr_b16 v[180:181], v245 offset:6144
    ds_read_b64_tr_b16 v[182:183], v245 offset:7168
    v_fmac_f32 v200, v18, v130
    v_fmac_f32 v200, v19, v131
    v_fmac_f32 v200, v20, v132
    v_fmac_f32 v200, v21, v133
    v_fmac_f32 v200, v22, v134
    v_fmac_f32 v200, v23, v135
    v_mfma_f32_32x32x8_bf16 v[32:47], v[80:81], v[188:189], v[32:47]
    v_add_f32 v198, v196, v198
    v_mul_f32_e64 v202, v24, -v128
    v_fma_f32 v202, v25, -v129, v202
    v_fma_f32 v202, v26, -v130, v202
    v_fma_f32 v202, v27, -v131, v202
    v_fma_f32 v202, v28, -v132, v202
    v_mfma_f32_32x32x8_bf16 v[48:63], v[84:85], v[188:189], v[48:63]
    v_fma_f32 v202, v29, -v133, v202
    v_fma_f32 v202, v30, -v134, v202
    v_fma_f32 v202, v31, -v135, v202
    s_nop 1
    v_permlane32_swap_b32 v200, v202
    v_add_f32 v202, v200, v202
    s_waitcnt vmcnt(3) lgkmcnt(0)
    v_mfma_f32_32x32x16_bf16 v[0:15], v[64:67], v[176:179], 0
    v_mul_f32 v197, v32, v104
    v_fmac_f32 v197, v33, v105
    v_fmac_f32 v197, v34, v106
    v_fmac_f32 v197, v35, v107
    v_fmac_f32 v197, v36, v108
    v_fmac_f32 v197, v37, v109
    v_fmac_f32 v197, v38, v110
    s_add_u32 m0, s21, 6144
    v_mfma_f32_32x32x16_bf16 v[16:31], v[68:71], v[176:179], 0
    buffer_load_dwordx4 v236, s[4:7], s36 offen lds
    buffer_load_dwordx4 v237, s[8:11], s36 offen offset:1024 lds
    ds_read_b64_tr_b16 v[176:177], v244 offset:0
    ds_read_b64_tr_b16 v[178:179], v244 offset:1024
    ds_read_b64_tr_b16 v[184:185], v245 offset:0
    ds_read_b64_tr_b16 v[186:187], v245 offset:1024
    v_fmac_f32 v197, v39, v111
    v_mul_f32 v199, v40, v136
    v_fmac_f32 v199, v41, v137
    v_fmac_f32 v199, v42, v138
    v_fmac_f32 v199, v43, v139
    v_fmac_f32 v199, v44, v140
    v_fmac_f32 v199, v45, v141
    s_waitcnt vmcnt(4) lgkmcnt(0)
    v_mfma_f32_32x32x16_bf16 v[0:15], v[72:75], v[176:179], v[0:15]
    v_fmac_f32 v199, v46, v142
    v_fmac_f32 v199, v47, v143
    v_mul_f32 v201, v48, v136
    v_fmac_f32 v201, v49, v137
    v_permlane32_swap_b32 v197, v199
    v_fmac_f32 v201, v50, v138
    v_fmac_f32 v201, v51, v139
    s_add_u32 m0, s21, 0
    v_mfma_f32_32x32x16_bf16 v[16:31], v[76:79], v[176:179], v[16:31]
    buffer_load_dwordx4 v238, s[4:7], s36 offen lds
    ds_read_b64_tr_b16 v[176:177], v244 offset:2048
    ds_read_b64_tr_b16 v[188:189], v245 offset:2048
    v_fmac_f32 v201, v52, v140
    v_fmac_f32 v201, v53, v141
    v_fmac_f32 v201, v54, v142
    v_fmac_f32 v201, v55, v143
    v_add_f32 v199, v197, v199
    v_mul_f32_e64 v203, v56, -v136
    v_fma_f32 v203, v57, -v137, v203
    s_waitcnt lgkmcnt(0)
    v_mfma_f32_32x32x8_bf16 v[0:15], v[80:81], v[176:177], v[0:15]
    v_fma_f32 v203, v58, -v138, v203
    v_fma_f32 v203, v59, -v139, v203
    v_fma_f32 v203, v60, -v140, v203
    v_fma_f32 v203, v61, -v141, v203
    v_fma_f32 v203, v62, -v142, v203
    v_fma_f32 v203, v63, -v143, v203
    s_nop 1
    s_add_u32 m0, s21, 2048
    v_mfma_f32_32x32x8_bf16 v[16:31], v[84:85], v[176:177], v[16:31]
    buffer_load_dwordx4 v234, s[4:7], s37 offen lds
    buffer_load_dwordx4 v235, s[8:11], s37 offen offset:1024 lds
    v_add_u32 v252, s42, v247
    ds_read_u16 v234, v252
    ds_read_u16 v235, v252 offset:64
    v_permlane32_swap_b32 v201, v203
    v_add_f32 v203, v201, v203
    v_cvt_pk_bf16_f32 v198, v198, v199
    v_cvt_pk_bf16_f32 v202, v202, v203
    ds_write_b32 v253, v198 offset:0
    ds_write_b32 v253, v202 offset:256
    v_mfma_f32_32x32x16_bf16 v[32:47], v[64:67], v[180:183], 0
    v_mul_f32 v196, v0, v144
    v_fmac_f32 v196, v1, v145
    v_fmac_f32 v196, v2, v146
    v_fmac_f32 v196, v3, v147
    v_fmac_f32 v196, v4, v148
    v_fmac_f32 v196, v5, v149
    v_mfma_f32_32x32x16_bf16 v[48:63], v[68:71], v[180:183], 0
    v_fmac_f32 v196, v6, v150
    v_fmac_f32 v196, v7, v151
    v_mul_f32 v198, v8, v112
    v_fmac_f32 v198, v9, v113
    v_fmac_f32 v198, v10, v114
    v_mfma_f32_32x32x16_bf16 v[32:47], v[72:75], v[184:187], v[32:47]
    v_fmac_f32 v198, v11, v115
    v_fmac_f32 v198, v12, v116
    v_fmac_f32 v198, v13, v117
    v_fmac_f32 v198, v14, v118
    v_fmac_f32 v198, v15, v119
    v_mfma_f32_32x32x16_bf16 v[48:63], v[76:79], v[184:187], v[48:63]
    s_waitcnt vmcnt(5)
    ds_read_b64_tr_b16 v[176:177], v244 offset:4096
    ds_read_b64_tr_b16 v[178:179], v244 offset:5120
    ds_read_b64_tr_b16 v[180:181], v245 offset:4096
    ds_read_b64_tr_b16 v[182:183], v245 offset:5120
    v_mul_f32_e64 v200, v16, -v160
    v_fma_f32 v200, v17, -v161, v200
    v_fma_f32 v200, v18, -v162, v200
    v_fma_f32 v200, v19, -v163, v200
    v_fma_f32 v200, v20, -v164, v200
    v_fma_f32 v200, v21, -v165, v200
    v_mfma_f32_32x32x8_bf16 v[32:47], v[80:81], v[188:189], v[32:47]
    v_fma_f32 v200, v22, -v166, v200
    v_fma_f32 v200, v23, -v167, v200
    v_mul_f32_e64 v202, v24, -v160
    v_fma_f32 v202, v25, -v161, v202
    v_fma_f32 v202, v26, -v162, v202
    v_mfma_f32_32x32x8_bf16 v[48:63], v[84:85], v[188:189], v[48:63]
    v_fma_f32 v202, v27, -v163, v202
    v_fma_f32 v202, v28, -v164, v202
    v_fma_f32 v202, v29, -v165, v202
    v_fma_f32 v202, v30, -v166, v202
    v_fma_f32 v202, v31, -v167, v202
    s_waitcnt vmcnt(3) lgkmcnt(0)
    v_mfma_f32_32x32x16_bf16 v[0:15], v[64:67], v[176:179], 0
    v_mul_f32 v197, v32, v152
    v_fmac_f32 v197, v33, v153
    v_fmac_f32 v197, v34, v154
    v_fmac_f32 v197, v35, v155
    v_fmac_f32 v197, v36, v156
    v_fmac_f32 v197, v37, v157
    s_add_u32 m0, s21, 4096
    v_mfma_f32_32x32x16_bf16 v[16:31], v[68:71], v[176:179], 0
    buffer_load_dwordx4 v236, s[4:7], s37 offen lds
    buffer_load_dwordx4 v237, s[8:11], s37 offen offset:1024 lds
    ds_read_b64_tr_b16 v[176:177], v244 offset:6144
    ds_read_b64_tr_b16 v[178:179], v244 offset:7168
    ds_read_b64_tr_b16 v[184:185], v245 offset:6144
    ds_read_b64_tr_b16 v[186:187], v245 offset:7168
    v_add_u32 v252, s43, v247
    ds_read_u16 v236, v252
    ds_read_u16 v237, v252 offset:64
    v_fmac_f32 v197, v38, v158
    v_fmac_f32 v197, v39, v159
    v_mul_f32 v199, v40, v120
    v_fmac_f32 v199, v41, v121
    v_fmac_f32 v199, v42, v122
    s_waitcnt vmcnt(4) lgkmcnt(2)
    v_mfma_f32_32x32x16_bf16 v[0:15], v[72:75], v[176:179], v[0:15]
    v_fmac_f32 v199, v43, v123
    v_fmac_f32 v199, v44, v124
    v_fmac_f32 v199, v45, v125
    v_fmac_f32 v199, v46, v126
    v_fmac_f32 v199, v47, v127
    s_add_u32 m0, s21, 6144
    v_mfma_f32_32x32x16_bf16 v[16:31], v[76:79], v[176:179], v[16:31]
    buffer_load_dwordx4 v238, s[4:7], s37 offen lds
    ds_read_b64_tr_b16 v[176:177], v244 offset:0
    ds_read_b64_tr_b16 v[188:189], v245 offset:0
    v_add_u32 v252, s44, v247
    ds_read_u16 v238, v252
    ds_read_u16 v239, v252 offset:64
    v_mul_f32_e64 v201, v48, -v168
    v_fma_f32 v201, v49, -v169, v201
    v_fma_f32 v201, v50, -v170, v201
    v_fma_f32 v201, v51, -v171, v201
    v_fma_f32 v201, v52, -v172, v201
    v_fma_f32 v201, v53, -v173, v201
    s_waitcnt lgkmcnt(2)
    v_mfma_f32_32x32x8_bf16 v[0:15], v[80:81], v[176:177], v[0:15]
    v_fma_f32 v201, v54, -v174, v201
    v_fma_f32 v201, v55, -v175, v201
    v_mul_f32_e64 v203, v56, -v168
    v_fma_f32 v203, v57, -v169, v203
    v_fma_f32 v203, v58, -v170, v203
    s_add_u32 m0, s21, 0
    v_mfma_f32_32x32x8_bf16 v[16:31], v[84:85], v[176:177], v[16:31]
    v_lshl_add_u32 v234, v234, 10, v246
    v_lshl_add_u32 v235, v235, 10, v246
    buffer_load_dwordx4 v234, s[4:7], s38 offen lds
    buffer_load_dwordx4 v235, s[8:11], s38 offen offset:1024 lds
    v_fma_f32 v203, v59, -v171, v203
    v_fma_f32 v203, v60, -v172, v203
    v_fma_f32 v203, v61, -v173, v203
    v_fma_f32 v203, v62, -v174, v203
    v_fma_f32 v203, v63, -v175, v203
    v_mfma_f32_32x32x16_bf16 v[32:47], v[64:67], v[180:183], 0
    v_mul_f32 v254, v0, v144
    v_fmac_f32 v254, v1, v145
    v_fmac_f32 v254, v2, v146
    v_mfma_f32_32x32x16_bf16 v[48:63], v[68:71], v[180:183], 0
    ds_swizzle_b32 v68, v68 offset:0x401F
    ds_swizzle_b32 v69, v69 offset:0x401F
    ds_swizzle_b32 v70, v70 offset:0x401F
    ds_swizzle_b32 v71, v71 offset:0x401F
    v_fmac_f32 v254, v3, v147
    v_fmac_f32 v254, v4, v148
    v_fmac_f32 v254, v5, v149
    v_mfma_f32_32x32x16_bf16 v[32:47], v[72:75], v[184:187], v[32:47]
    v_fmac_f32 v254, v6, v150
    v_fmac_f32 v254, v7, v151
    v_fmac_f32 v200, v8, v160
    v_mfma_f32_32x32x16_bf16 v[48:63], v[76:79], v[184:187], v[48:63]
    ds_swizzle_b32 v76, v76 offset:0x401F
    ds_swizzle_b32 v77, v77 offset:0x401F
    ds_swizzle_b32 v78, v78 offset:0x401F
    ds_swizzle_b32 v79, v79 offset:0x401F
    s_waitcnt vmcnt(5)
    ds_read_b64_tr_b16 v[176:177], v244 offset:2048
    ds_read_b64_tr_b16 v[178:179], v244 offset:3072
    ds_read_b64_tr_b16 v[180:181], v245 offset:2048
    ds_read_b64_tr_b16 v[182:183], v245 offset:3072
    v_fmac_f32 v200, v9, v161
    v_permlane32_swap_b32 v196, v254
    v_fmac_f32 v200, v10, v162
    v_mfma_f32_32x32x8_bf16 v[32:47], v[80:81], v[188:189], v[32:47]
    v_fmac_f32 v200, v11, v163
    v_fmac_f32 v200, v12, v164
    v_fmac_f32 v200, v13, v165
    v_mfma_f32_32x32x8_bf16 v[48:63], v[84:85], v[188:189], v[48:63]
    ds_swizzle_b32 v84, v84 offset:0x401F
    ds_swizzle_b32 v85, v85 offset:0x401F
    v_fmac_f32 v200, v14, v166
    v_fmac_f32 v200, v15, v167
    v_add_f32 v254, v196, v254
    s_waitcnt lgkmcnt(6)
    s_mov_b64 exec, s[56:57]
    v_xor_b32 v68, 0x80008000, v68
    v_xor_b32 v69, 0x80008000, v69
    v_xor_b32 v70, 0x80008000, v70
    v_xor_b32 v71, 0x80008000, v71
    v_xor_b32 v76, 0x80008000, v76
    v_xor_b32 v77, 0x80008000, v77
    v_xor_b32 v78, 0x80008000, v78
    v_xor_b32 v79, 0x80008000, v79
    s_mov_b64 exec, -1
    s_waitcnt vmcnt(3) lgkmcnt(2)
    v_mfma_f32_32x32x16_bf16 v[0:15], v[64:67], v[176:179], 0
    v_mul_f32 v255, v32, v152
    v_fmac_f32 v255, v33, v153
    v_fmac_f32 v255, v34, v154
    v_fmac_f32 v255, v35, v155
    s_add_u32 m0, s21, 2048
    v_mfma_f32_32x32x16_bf16 v[16:31], v[68:71], v[176:179], v[16:31]
    v_lshl_add_u32 v236, v236, 10, v246
    v_lshl_add_u32 v237, v237, 10, v246
    buffer_load_dwordx4 v236, s[4:7], s39 offen lds
    buffer_load_dwordx4 v237, s[8:11], s39 offen offset:1024 lds
    ds_read_b64_tr_b16 v[176:177], v244 offset:4096
    ds_read_b64_tr_b16 v[178:179], v244 offset:5120
    ds_read_b64_tr_b16 v[184:185], v245 offset:4096
    ds_read_b64_tr_b16 v[186:187], v245 offset:5120
    v_fmac_f32 v255, v36, v156
    v_fmac_f32 v255, v37, v157
    v_fmac_f32 v255, v38, v158
    s_waitcnt vmcnt(4) lgkmcnt(0)
    v_mfma_f32_32x32x16_bf16 v[0:15], v[72:75], v[176:179], v[0:15]
    v_fmac_f32 v255, v39, v159
    v_fmac_f32 v201, v40, v168
    v_fmac_f32 v201, v41, v169
    s_add_u32 m0, s21, 4096
    v_mfma_f32_32x32x16_bf16 v[16:31], v[76:79], v[176:179], v[16:31]
    v_lshl_add_u32 v238, v238, 10, v246
    v_lshl_add_u32 v239, v239, 10, v246
    buffer_load_dwordx4 v238, s[4:7], s40 offen lds
    buffer_load_dwordx4 v239, s[8:11], s40 offen offset:1024 lds
    ds_read_b64_tr_b16 v[176:177], v244 offset:6144
    ds_read_b64_tr_b16 v[188:189], v245 offset:6144
    v_permlane32_swap_b32 v197, v255
    v_fmac_f32 v201, v42, v170
    v_fmac_f32 v201, v43, v171
    v_fmac_f32 v201, v44, v172
    s_waitcnt lgkmcnt(0)
    s_mov_b64 exec, s[56:57]
    v_xor_b32 v84, 0x80008000, v84
    v_xor_b32 v85, 0x80008000, v85
    s_mov_b64 exec, -1
    v_mfma_f32_32x32x8_bf16 v[0:15], v[80:81], v[176:177], v[0:15]
    v_fmac_f32 v201, v45, v173
    v_fmac_f32 v201, v46, v174
    v_fmac_f32 v201, v47, v175
    s_add_u32 m0, s21, 6144
    v_mfma_f32_32x32x8_bf16 v[16:31], v[84:85], v[176:177], v[16:31]
    v_lshl_add_u32 v240, v240, 10, v246
    v_lshl_add_u32 v241, v241, 10, v246
    buffer_load_dwordx4 v240, s[4:7], s41 offen lds
    buffer_load_dwordx4 v241, s[8:11], s41 offen offset:1024 lds
    v_add_f32 v255, v197, v255
    v_cvt_pk_bf16_f32 v254, v254, v255
    ds_write_b32 v253, v254 offset:512
    v_mfma_f32_32x32x16_bf16 v[32:47], v[64:67], v[180:183], 0
    v_mul_f32 v254, v0, v144
    v_fmac_f32 v254, v1, v145
    v_fmac_f32 v254, v2, v146
    v_fmac_f32 v254, v3, v147
    v_fmac_f32 v254, v4, v148
    v_fmac_f32 v254, v5, v149
    v_fmac_f32 v254, v6, v150
    v_mfma_f32_32x32x16_bf16 v[48:63], v[68:71], v[180:183], v[48:63]
    v_fmac_f32 v254, v7, v151
    v_fma_f32 v202, v8, -v160, v202
    v_fma_f32 v202, v9, -v161, v202
    v_permlane32_swap_b32 v254, v200
    v_fma_f32 v202, v10, -v162, v202
    v_fma_f32 v202, v11, -v163, v202
    v_mfma_f32_32x32x16_bf16 v[32:47], v[72:75], v[184:187], v[32:47]
    v_fma_f32 v202, v12, -v164, v202
    v_fma_f32 v202, v13, -v165, v202
    v_fma_f32 v202, v14, -v166, v202
    v_fma_f32 v202, v15, -v167, v202
    v_add_f32 v200, v254, v200
    v_fmac_f32 v198, v16, v112
    v_permlane32_swap_b32 v202, v254
    v_mfma_f32_32x32x16_bf16 v[48:63], v[76:79], v[184:187], v[48:63]
    s_waitcnt vmcnt(6)
    ds_read_b64_tr_b16 v[176:177], v244 offset:0
    ds_read_b64_tr_b16 v[178:179], v244 offset:1024
    ds_read_b64_tr_b16 v[180:181], v245 offset:0
    ds_read_b64_tr_b16 v[182:183], v245 offset:1024
    v_fmac_f32 v198, v17, v113
    v_fmac_f32 v198, v18, v114
    v_fmac_f32 v198, v19, v115
    v_fmac_f32 v198, v20, v116
    v_fmac_f32 v198, v21, v117
    v_fmac_f32 v198, v22, v118
    v_mfma_f32_32x32x8_bf16 v[32:47], v[80:81], v[188:189], v[32:47]
    v_fmac_f32 v198, v23, v119
    v_add_f32 v254, v202, v254
    v_mul_f32 v196, v24, v160
    v_fmac_f32 v196, v25, v161
    v_fmac_f32 v196, v26, v162
    v_fmac_f32 v196, v27, v163
    v_fmac_f32 v196, v28, v164
    v_mfma_f32_32x32x8_bf16 v[48:63], v[84:85], v[188:189], v[48:63]
    v_add_u32 v249, s48, v249
    v_add_u32 v250, s49, v250
    ds_read_b32 v252, v251 offset:16
    ds_read_b64_tr_b16 v[68:69], v249 offset:0
    ds_read_b64_tr_b16 v[70:71], v249 offset:256
    s_mov_b64 exec, s[54:55]
    ds_read_u16_d16_hi v242, v250 offset:0
    s_mov_b64 exec, -1
    v_fmac_f32 v196, v29, v165
    v_fmac_f32 v196, v30, v166
    v_fmac_f32 v196, v31, v167
    s_nop 1
    v_permlane32_swap_b32 v198, v196
    v_add_f32 v196, v198, v196
    v_mul_f32 v255, v32, v152
    v_fmac_f32 v255, v33, v153
    v_fmac_f32 v255, v34, v154
    v_fmac_f32 v255, v35, v155
    v_fmac_f32 v255, v36, v156
    v_fmac_f32 v255, v37, v157
    v_fmac_f32 v255, v38, v158
    v_fmac_f32 v255, v39, v159
    v_fma_f32 v203, v40, -v168, v203
    v_fma_f32 v203, v41, -v169, v203
    v_permlane32_swap_b32 v255, v201
    v_fma_f32 v203, v42, -v170, v203
    v_fma_f32 v203, v43, -v171, v203
    v_fma_f32 v203, v44, -v172, v203
    v_fma_f32 v203, v45, -v173, v203
    v_fma_f32 v203, v46, -v174, v203
    v_fma_f32 v203, v47, -v175, v203
    v_add_f32 v201, v255, v201
    v_fmac_f32 v199, v48, v120
    v_permlane32_swap_b32 v203, v255
    v_fmac_f32 v199, v49, v121
    v_fmac_f32 v199, v50, v122
    v_fmac_f32 v199, v51, v123
    v_fmac_f32 v199, v52, v124
    v_fmac_f32 v199, v53, v125
    v_fmac_f32 v199, v54, v126
    v_fmac_f32 v199, v55, v127
    v_add_f32 v255, v203, v255
    v_mul_f32 v197, v56, v168
    v_fmac_f32 v197, v57, v169
    v_fmac_f32 v197, v58, v170
    v_fmac_f32 v197, v59, v171
    v_fmac_f32 v197, v60, v172
    v_fmac_f32 v197, v61, v173
    v_fmac_f32 v197, v62, v174
    v_fmac_f32 v197, v63, v175
    s_nop 1
    v_permlane32_swap_b32 v199, v197
    v_add_f32 v197, v199, v197
    v_cvt_pk_bf16_f32 v200, v200, v201
    v_cvt_pk_bf16_f32 v254, v254, v255
    v_cvt_pk_bf16_f32 v196, v196, v197
    ds_write_b32 v253, v200 offset:768
    s_mov_b64 exec, 0xffffffff
    ds_write_b32 v253, v254 offset:1280
    s_mov_b64 exec, -1
    ds_write_b32 v253, v196 offset:1024
    s_add_u32 s50, s50, 1
    s_cmp_ge_u32 s50, 5
    s_cbranch_scc1 TAIL
    s_waitcnt lgkmcnt(6)
    v_readfirstlane_b32 s66, v252
    s_add_u32 s53, s53, 1
    v_mov_b32 v252, s53
    s_cmp_le_u32 s53, s66
    ds_write2_b32 v251, v252, v252 offset0:0 offset1:8
    s_setprio 1
    s_cbranch_scc1 PRIO_11
    s_setprio 0
PRIO_11:
    s_cmp_eq_u32 s52, 4
    s_cbranch_scc1 ITEM_1_4
    s_cmp_eq_u32 s52, 5
    s_cbranch_scc1 ITEM_1_5
    s_cmp_eq_u32 s52, 3
    s_cbranch_scc1 ITEM_1_3
    s_cmp_eq_u32 s52, 6
    s_cbranch_scc1 ITEM_1_6
    s_cmp_eq_u32 s52, 8
    s_cbranch_scc1 ITEM_1_8
    s_branch ITEM_1_2
.p2align 6
ITEM_1_3:
    s_mov_b64 exec, s[54:55]
    ds_read_u16_d16_hi v243, v250 offset:128
    s_mov_b64 exec, -1
    ds_read_b64_tr_b16 v[76:77], v249 offset:512
    s_waitcnt lgkmcnt(2)
    v_lshlrev_b32 v196, 16, v68
    v_and_b32 v197, 0xffff0000, v68
    v_lshlrev_b32 v198, 16, v69
    v_and_b32 v199, 0xffff0000, v69
    v_mul_f32_dpp v200, v242, v196 row_newbcast:0 row_mask:0xf bank_mask:0xf
    v_mul_f32_dpp v201, v242, v197 row_newbcast:1 row_mask:0xf bank_mask:0xf
    v_mul_f32_dpp v202, v242, v196 row_newbcast:8 row_mask:0xf bank_mask:0xf
    v_mul_f32_dpp v203, v242, v197 row_newbcast:9 row_mask:0xf bank_mask:0xf
    v_lshlrev_b32 v196, 16, v70
    v_and_b32 v197, 0xffff0000, v70
    v_cvt_pk_bf16_f32 v64, v200, v201
    v_cvt_pk_bf16_f32 v68, v202, v203
    v_mul_f32_dpp v200, v242, v198 row_newbcast:2 row_mask:0xf bank_mask:0xf
    v_mul_f32_dpp v201, v242, v199 row_newbcast:3 row_mask:0xf bank_mask:0xf
    v_mul_f32_dpp v202, v242, v198 row_newbcast:10 row_mask:0xf bank_mask:0xf
    v_mul_f32_dpp v203, v242, v199 row_newbcast:11 row_mask:0xf bank_mask:0xf
    v_lshlrev_b32 v198, 16, v71
    v_and_b32 v199, 0xffff0000, v71
    v_cvt_pk_bf16_f32 v65, v200, v201
    v_cvt_pk_bf16_f32 v69, v202, v203
    v_mul_f32_dpp v200, v242, v196 row_newbcast:4 row_mask:0xf bank_mask:0xf
    v_mul_f32_dpp v201, v242, v197 row_newbcast:5 row_mask:0xf bank_mask:0xf
    v_mul_f32_dpp v202, v242, v196 row_newbcast:12 row_mask:0xf bank_mask:0xf
    v_mul_f32_dpp v203, v242, v197 row_newbcast:13 row_mask:0xf bank_mask:0xf
    v_cvt_pk_bf16_f32 v66, v200, v201
    v_cvt_pk_bf16_f32 v70, v202, v203
    v_mul_f32_dpp v200, v242, v198 row_newbcast:6 row_mask:0xf bank_mask:0xf
    v_mul_f32_dpp v201, v242, v199 row_newbcast:7 row_mask:0xf bank_mask:0xf
    v_mul_f32_dpp v202, v242, v198 row_newbcast:14 row_mask:0xf bank_mask:0xf
    v_mul_f32_dpp v203, v242, v199 row_newbcast:15 row_mask:0xf bank_mask:0xf
    v_cvt_pk_bf16_f32 v67, v200, v201
    v_cvt_pk_bf16_f32 v71, v202, v203
    s_nop 0
    s_waitcnt vmcnt(4) lgkmcnt(0)
    v_mfma_f32_32x32x16_bf16 v[0:15], v[64:67], v[176:179], 0
    v_lshlrev_b32 v196, 16, v76
    v_and_b32 v197, 0xffff0000, v76
    v_lshlrev_b32 v198, 16, v77
    v_and_b32 v199, 0xffff0000, v77
    v_mul_f32_dpp v200, v243, v196 row_newbcast:0 row_mask:0xf bank_mask:0xf
    v_mul_f32_dpp v201, v243, v197 row_newbcast:1 row_mask:0xf bank_mask:0xf
    v_mul_f32_dpp v202, v243, v196 row_newbcast:8 row_mask:0xf bank_mask:0xf
    v_mul_f32_dpp v203, v243, v197 row_newbcast:9 row_mask:0xf bank_mask:0xf
    s_add_u32 m0, s21, 0
    v_mfma_f32_32x32x16_bf16 v[16:31], v[68:71], v[176:179], 0
    buffer_load_dwordx4 v234, s[4:7], s36 offen lds
    buffer_load_dwordx4 v235, s[8:11], s36 offen offset:1024 lds
    ds_read_b64_tr_b16 v[176:177], v244 offset:2048
    ds_read_b64_tr_b16 v[184:185], v245 offset:2048
    v_cvt_pk_bf16_f32 v72, v200, v201
    v_cvt_pk_bf16_f32 v76, v202, v203
    v_mul_f32_dpp v200, v243, v198 row_newbcast:2 row_mask:0xf bank_mask:0xf
    v_mul_f32_dpp v201, v243, v199 row_newbcast:3 row_mask:0xf bank_mask:0xf
    v_mul_f32_dpp v202, v243, v198 row_newbcast:10 row_mask:0xf bank_mask:0xf
    v_mul_f32_dpp v203, v243, v199 row_newbcast:11 row_mask:0xf bank_mask:0xf
    v_cvt_pk_bf16_f32 v73, v200, v201
    v_cvt_pk_bf16_f32 v77, v202, v203
    s_nop 0
    s_waitcnt lgkmcnt(0)
    v_mfma_f32_32x32x8_bf16 v[0:15], v[72:73], v[176:177], v[0:15]
    s_add_u32 m0, s21, 2048
    v_mfma_f32_32x32x8_bf16 v[16:31], v[76:77], v[176:177], v[16:31]
    buffer_load_dwordx4 v236, s[4:7], s36 offen lds
    s_mov_b32 m0, s50
    s_nop 0
    s_movrels_b32 s71, s23
    s_movrels_b32 s33, s28
    s_and_b32 s70, s33, 0x70
    s_andn2_b32 s33, s33, 0x70
    v_xor_b32 v253, s70, v248
    v_add_u32 v253, s33, v253
    s_bfe_u32 s46, s71, 0x30012
    s_mov_b32 m0, s46
    s_and_b32 s66, s71, 0x3ffff
    s_movrels_b32 s68, s57
    s_movrels_b32 s69, s61
    s_sub_u32 s48, s66, s47
    s_mov_b32 s47, s66
    s_lshr_b32 s52, s71, 28
    s_lshl_b32 s67, s46, 9
    s_add_u32 s66, s66, s67
    s_sub_u32 s49, s66, s42
    s_mov_b32 s42, s66
    s_bfe_u32 s66, s68, 655360
    s_add_u32 s43, s42, s66
    s_bfe_u32 s39, s69, 655360
    s_bfe_u32 s66, s68, 655370
    s_add_u32 s44, s42, s66
    s_bfe_u32 s40, s69, 655370
    s_bfe_u32 s66, s68, 655380
    s_add_u32 s45, s42, s66
    s_bfe_u32 s41, s69, 655380
    v_add_u32 v252, s44, v247
    ds_read_u16 v238, v252
    ds_read_u16 v239, v252 offset:64
    v_add_u32 v252, s45, v247
    ds_read_u16 v240, v252
    ds_read_u16 v241, v252 offset:64
    v_mfma_f32_32x32x16_bf16 v[32:47], v[64:67], v[180:183], 0
    v_mul_f32 v196, v0, v96
    v_fmac_f32 v196, v1, v97
    v_fmac_f32 v196, v2, v98
    v_fmac_f32 v196, v3, v99
    v_fmac_f32 v196, v4, v100
    v_fmac_f32 v196, v5, v101
    v_fmac_f32 v196, v6, v102
    v_fmac_f32 v196, v7, v103
    v_mul_f32 v198, v8, v128
    v_fmac_f32 v198, v9, v129
    v_mfma_f32_32x32x16_bf16 v[48:63], v[68:71], v[180:183], 0
    s_waitcnt vmcnt(5)
    ds_read_b64_tr_b16 v[176:177], v244 offset:4096
    ds_read_b64_tr_b16 v[178:179], v244 offset:5120
    ds_read_b64_tr_b16 v[180:181], v245 offset:4096
    ds_read_b64_tr_b16 v[182:183], v245 offset:5120
    v_fmac_f32 v198, v10, v130
    v_fmac_f32 v198, v11, v131
    v_fmac_f32 v198, v12, v132
    v_fmac_f32 v198, v13, v133
    v_fmac_f32 v198, v14, v134
    v_fmac_f32 v198, v15, v135
    v_mul_f32 v200, v16, v128
    v_fmac_f32 v200, v17, v129
    v_permlane32_swap_b32 v196, v198
    v_mfma_f32_32x32x8_bf16 v[32:47], v[72:73], v[184:185], v[32:47]
    v_fmac_f32 v200, v18, v130
    v_fmac_f32 v200, v19, v131
    v_fmac_f32 v200, v20, v132
    v_fmac_f32 v200, v21, v133
    v_fmac_f32 v200, v22, v134
    v_fmac_f32 v200, v23, v135
    v_add_f32 v198, v196, v198
    v_mul_f32_e64 v202, v24, -v128
    v_fma_f32 v202, v25, -v129, v202
    v_mfma_f32_32x32x8_bf16 v[48:63], v[76:77], v[184:185], v[48:63]
    v_fma_f32 v202, v26, -v130, v202
    v_fma_f32 v202, v27, -v131, v202
    v_fma_f32 v202, v28, -v132, v202
    v_fma_f32 v202, v29, -v133, v202
    v_fma_f32 v202, v30, -v134, v202
    v_fma_f32 v202, v31, -v135, v202
    s_nop 1
    v_permlane32_swap_b32 v200, v202
    v_add_f32 v202, v200, v202
    s_waitcnt vmcnt(3) lgkmcnt(0)
    v_mfma_f32_32x32x16_bf16 v[0:15], v[64:67], v[176:179], 0
    v_mul_f32 v197, v32, v104
    v_fmac_f32 v197, v33, v105
    v_fmac_f32 v197, v34, v106
    v_fmac_f32 v197, v35, v107
    v_fmac_f32 v197, v36, v108
    v_fmac_f32 v197, v37, v109
    v_fmac_f32 v197, v38, v110
    v_fmac_f32 v197, v39, v111
    v_mul_f32 v199, v40, v136
    v_fmac_f32 v199, v41, v137
    v_fmac_f32 v199, v42, v138
    s_add_u32 m0, s21, 4096
    v_mfma_f32_32x32x16_bf16 v[16:31], v[68:71], v[176:179], 0
    buffer_load_dwordx4 v234, s[4:7], s37 offen lds
    buffer_load_dwordx4 v235, s[8:11], s37 offen offset:1024 lds
    ds_read_b64_tr_b16 v[176:177], v244 offset:6144
    ds_read_b64_tr_b16 v[184:185], v245 offset:6144
    v_add_u32 v252, s42, v247
    ds_read_u16 v234, v252
    ds_read_u16 v235, v252 offset:64
    v_fmac_f32 v199, v43, v139
    v_fmac_f32 v199, v44, v140
    v_fmac_f32 v199, v45, v141
    v_fmac_f32 v199, v46, v142
    v_fmac_f32 v199, v47, v143
    v_mul_f32 v201, v48, v136
    v_fmac_f32 v201, v49, v137
    v_permlane32_swap_b32 v197, v199
    v_fmac_f32 v201, v50, v138
    v_fmac_f32 v201, v51, v139
    s_waitcnt lgkmcnt(2)
    v_mfma_f32_32x32x8_bf16 v[0:15], v[72:73], v[176:177], v[0:15]
    v_fmac_f32 v201, v52, v140
    v_fmac_f32 v201, v53, v141
    v_fmac_f32 v201, v54, v142
    v_fmac_f32 v201, v55, v143
    v_add_f32 v199, v197, v199
    v_mul_f32_e64 v203, v56, -v136
    v_fma_f32 v203, v57, -v137, v203
    v_fma_f32 v203, v58, -v138, v203
    v_fma_f32 v203, v59, -v139, v203
    v_fma_f32 v203, v60, -v140, v203
    s_add_u32 m0, s21, 6144
    v_mfma_f32_32x32x8_bf16 v[16:31], v[76:77], v[176:177], v[16:31]
    buffer_load_dwordx4 v236, s[4:7], s37 offen lds
    v_add_u32 v252, s43, v247
    ds_read_u16 v236, v252
    ds_read_u16 v237, v252 offset:64
    v_fma_f32 v203, v61, -v141, v203
    v_fma_f32 v203, v62, -v142, v203
    v_fma_f32 v203, v63, -v143, v203
    s_nop 1
    v_permlane32_swap_b32 v201, v203
    v_add_f32 v203, v201, v203
    v_cvt_pk_bf16_f32 v198, v198, v199
    v_cvt_pk_bf16_f32 v202, v202, v203
    ds_write_b32 v253, v198 offset:0
    ds_write_b32 v253, v202 offset:256
    v_mfma_f32_32x32x16_bf16 v[32:47], v[64:67], v[180:183], 0
    v_mul_f32 v196, v0, v144
    v_fmac_f32 v196, v1, v145
    v_fmac_f32 v196, v2, v146
    v_fmac_f32 v196, v3, v147
    v_fmac_f32 v196, v4, v148
    v_fmac_f32 v196, v5, v149
    v_fmac_f32 v196, v6, v150
    v_fmac_f32 v196, v7, v151
    v_mfma_f32_32x32x16_bf16 v[48:63], v[68:71], v[180:183], 0
    s_waitcnt vmcnt(4)
    ds_read_b64_tr_b16 v[176:177], v244 offset:0
    ds_read_b64_tr_b16 v[178:179], v244 offset:1024
    ds_read_b64_tr_b16 v[180:181], v245 offset:0
    ds_read_b64_tr_b16 v[182:183], v245 offset:1024
    v_mul_f32 v198, v8, v112
    v_fmac_f32 v198, v9, v113
    v_fmac_f32 v198, v10, v114
    v_fmac_f32 v198, v11, v115
    v_fmac_f32 v198, v12, v116
    v_fmac_f32 v198, v13, v117
    v_fmac_f32 v198, v14, v118
    v_fmac_f32 v198, v15, v119
    v_mfma_f32_32x32x8_bf16 v[32:47], v[72:73], v[184:185], v[32:47]
    v_mul_f32_e64 v200, v16, -v160
    v_fma_f32 v200, v17, -v161, v200
    v_fma_f32 v200, v18, -v162, v200
    v_fma_f32 v200, v19, -v163, v200
    v_fma_f32 v200, v20, -v164, v200
    v_fma_f32 v200, v21, -v165, v200
    v_fma_f32 v200, v22, -v166, v200
    v_fma_f32 v200, v23, -v167, v200
    v_mfma_f32_32x32x8_bf16 v[48:63], v[76:77], v[184:185], v[48:63]
    v_mul_f32_e64 v202, v24, -v160
    v_fma_f32 v202, v25, -v161, v202
    v_fma_f32 v202, v26, -v162, v202
    v_fma_f32 v202, v27, -v163, v202
    v_fma_f32 v202, v28, -v164, v202
    v_fma_f32 v202, v29, -v165, v202
    v_fma_f32 v202, v30, -v166, v202
    v_fma_f32 v202, v31, -v167, v202
    s_waitcnt vmcnt(3) lgkmcnt(0)
    v_mfma_f32_32x32x16_bf16 v[0:15], v[64:67], v[176:179], 0
    v_mul_f32 v197, v32, v152
    v_fmac_f32 v197, v33, v153
    v_fmac_f32 v197, v34, v154
    v_fmac_f32 v197, v35, v155
    v_fmac_f32 v197, v36, v156
    v_fmac_f32 v197, v37, v157
    v_fmac_f32 v197, v38, v158
    v_fmac_f32 v197, v39, v159
    s_add_u32 m0, s21, 0
    v_mfma_f32_32x32x16_bf16 v[16:31], v[68:71], v[176:179], 0
    v_lshl_add_u32 v234, v234, 10, v246
    v_lshl_add_u32 v235, v235, 10, v246
    buffer_load_dwordx4 v234, s[4:7], s38 offen lds
    buffer_load_dwordx4 v235, s[8:11], s38 offen offset:1024 lds
    ds_read_b64_tr_b16 v[176:177], v244 offset:2048
    ds_read_b64_tr_b16 v[184:185], v245 offset:2048
    v_mul_f32 v199, v40, v120
    v_fmac_f32 v199, v41, v121
    v_fmac_f32 v199, v42, v122
    v_fmac_f32 v199, v43, v123
    v_fmac_f32 v199, v44, v124
    v_fmac_f32 v199, v45, v125
    v_fmac_f32 v199, v46, v126
    v_fmac_f32 v199, v47, v127
    s_waitcnt lgkmcnt(0)
    v_mfma_f32_32x32x8_bf16 v[0:15], v[72:73], v[176:177], v[0:15]
    v_mul_f32_e64 v201, v48, -v168
    v_fma_f32 v201, v49, -v169, v201
    v_fma_f32 v201, v50, -v170, v201
    v_fma_f32 v201, v51, -v171, v201
    v_fma_f32 v201, v52, -v172, v201
    v_fma_f32 v201, v53, -v173, v201
    v_fma_f32 v201, v54, -v174, v201
    v_fma_f32 v201, v55, -v175, v201
    s_add_u32 m0, s21, 2048
    v_mfma_f32_32x32x8_bf16 v[16:31], v[76:77], v[176:177], v[16:31]
    v_lshl_add_u32 v236, v236, 10, v246
    v_lshl_add_u32 v237, v237, 10, v246
    buffer_load_dwordx4 v236, s[4:7], s39 offen lds
    buffer_load_dwordx4 v237, s[8:11], s39 offen offset:1024 lds
    v_mul_f32_e64 v203, v56, -v168
    v_fma_f32 v203, v57, -v169, v203
    v_fma_f32 v203, v58, -v170, v203
    v_fma_f32 v203, v59, -v171, v203
    v_fma_f32 v203, v60, -v172, v203
    v_fma_f32 v203, v61, -v173, v203
    v_fma_f32 v203, v62, -v174, v203
    v_fma_f32 v203, v63, -v175, v203
    v_mfma_f32_32x32x16_bf16 v[32:47], v[64:67], v[180:183], 0
    v_mul_f32 v254, v0, v144
    v_fmac_f32 v254, v1, v145
    v_fmac_f32 v254, v2, v146
    v_fmac_f32 v254, v3, v147
    v_fmac_f32 v254, v4, v148
    v_mfma_f32_32x32x16_bf16 v[48:63], v[68:71], v[180:183], 0
    ds_swizzle_b32 v68, v68 offset:0x401F
    ds_swizzle_b32 v69, v69 offset:0x401F
    ds_swizzle_b32 v70, v70 offset:0x401F
    ds_swizzle_b32 v71, v71 offset:0x401F
    s_waitcnt vmcnt(5)
    ds_read_b64_tr_b16 v[176:177], v244 offset:4096
    ds_read_b64_tr_b16 v[178:179], v244 offset:5120
    ds_read_b64_tr_b16 v[180:181], v245 offset:4096
    ds_read_b64_tr_b16 v[182:183], v245 offset:5120
    v_fmac_f32 v254, v5, v149
    v_fmac_f32 v254, v6, v150
    v_fmac_f32 v254, v7, v151
    v_fmac_f32 v200, v8, v160
    v_mfma_f32_32x32x8_bf16 v[32:47], v[72:73], v[184:185], v[32:47]
    v_fmac_f32 v200, v9, v161
    v_permlane32_swap_b32 v196, v254
    v_fmac_f32 v200, v10, v162
    v_fmac_f32 v200, v11, v163
    v_fmac_f32 v200, v12, v164
    v_mfma_f32_32x32x8_bf16 v[48:63], v[76:77], v[184:185], v[48:63]
    ds_swizzle_b32 v76, v76 offset:0x401F
    ds_swizzle_b32 v77, v77 offset:0x401F
    v_fmac_f32 v200, v13, v165
    v_fmac_f32 v200, v14, v166
    v_fmac_f32 v200, v15, v167
    v_add_f32 v254, v196, v254
    s_waitcnt lgkmcnt(6)
    s_mov_b64 exec, s[56:57]
    v_xor_b32 v68, 0x80008000, v68
    v_xor_b32 v69, 0x80008000, v69
    v_xor_b32 v70, 0x80008000, v70
    v_xor_b32 v71, 0x80008000, v71
    s_mov_b64 exec, -1
    s_waitcnt vmcnt(4) lgkmcnt(2)
    v_mfma_f32_32x32x16_bf16 v[0:15], v[64:67], v[176:179], 0
    v_mul_f32 v255, v32, v152
    v_fmac_f32 v255, v33, v153
    v_fmac_f32 v255, v34, v154
    v_fmac_f32 v255, v35, v155
    v_fmac_f32 v255, v36, v156
    s_add_u32 m0, s21, 4096
    v_mfma_f32_32x32x16_bf16 v[16:31], v[68:71], v[176:179], v[16:31]
    v_lshl_add_u32 v238, v238, 10, v246
    v_lshl_add_u32 v239, v239, 10, v246
    buffer_load_dwordx4 v238, s[4:7], s40 offen lds
    buffer_load_dwordx4 v239, s[8:11], s40 offen offset:1024 lds
    ds_read_b64_tr_b16 v[176:177], v244 offset:6144
    ds_read_b64_tr_b16 v[184:185], v245 offset:6144
    v_fmac_f32 v255, v37, v157
    v_fmac_f32 v255, v38, v158
    v_fmac_f32 v255, v39, v159
    v_fmac_f32 v201, v40, v168
    v_fmac_f32 v201, v41, v169
    s_waitcnt lgkmcnt(0)
    s_mov_b64 exec, s[56:57]
    v_xor_b32 v76, 0x80008000, v76
    v_xor_b32 v77, 0x80008000, v77
    s_mov_b64 exec, -1
    v_mfma_f32_32x32x8_bf16 v[0:15], v[72:73], v[176:177], v[0:15]
    v_permlane32_swap_b32 v197, v255
    v_fmac_f32 v201, v42, v170
    v_fmac_f32 v201, v43, v171
    v_fmac_f32 v201, v44, v172
    v_fmac_f32 v201, v45, v173
    s_add_u32 m0, s21, 6144
    v_mfma_f32_32x32x8_bf16 v[16:31], v[76:77], v[176:177], v[16:31]
    v_lshl_add_u32 v240, v240, 10, v246
    v_lshl_add_u32 v241, v241, 10, v246
    buffer_load_dwordx4 v240, s[4:7], s41 offen lds
    buffer_load_dwordx4 v241, s[8:11], s41 offen offset:1024 lds
    v_fmac_f32 v201, v46, v174
    v_fmac_f32 v201, v47, v175
    v_add_f32 v255, v197, v255
    v_cvt_pk_bf16_f32 v254, v254, v255
    ds_write_b32 v253, v254 offset:512
    v_mfma_f32_32x32x16_bf16 v[32:47], v[64:67], v[180:183], 0
    v_mul_f32 v254, v0, v144
    v_fmac_f32 v254, v1, v145
    v_fmac_f32 v254, v2, v146
    v_fmac_f32 v254, v3, v147
    v_fmac_f32 v254, v4, v148
    v_fmac_f32 v254, v5, v149
    v_fmac_f32 v254, v6, v150
    v_fmac_f32 v254, v7, v151
    v_fma_f32 v202, v8, -v160, v202
    v_fma_f32 v202, v9, -v161, v202
    v_mfma_f32_32x32x16_bf16 v[48:63], v[68:71], v[180:183], v[48:63]
    s_waitcnt vmcnt(6)
    ds_read_b64_tr_b16 v[176:177], v244 offset:0
    ds_read_b64_tr_b16 v[178:179], v244 offset:1024
    ds_read_b64_tr_b16 v[180:181], v245 offset:0
    ds_read_b64_tr_b16 v[182:183], v245 offset:1024
    v_permlane32_swap_b32 v254, v200
    v_fma_f32 v202, v10, -v162, v202
    v_fma_f32 v202, v11, -v163, v202
    v_fma_f32 v202, v12, -v164, v202
    v_fma_f32 v202, v13, -v165, v202
    v_fma_f32 v202, v14, -v166, v202
    v_fma_f32 v202, v15, -v167, v202
    v_add_f32 v200, v254, v200
    v_fmac_f32 v198, v16, v112
    v_permlane32_swap_b32 v202, v254
    v_mfma_f32_32x32x8_bf16 v[32:47], v[72:73], v[184:185], v[32:47]
    v_fmac_f32 v198, v17, v113
    v_fmac_f32 v198, v18, v114
    v_fmac_f32 v198, v19, v115
    v_fmac_f32 v198, v20, v116
    v_fmac_f32 v198, v21, v117
    v_fmac_f32 v198, v22, v118
    v_fmac_f32 v198, v23, v119
    v_add_f32 v254, v202, v254
    v_mul_f32 v196, v24, v160
    v_fmac_f32 v196, v25, v161
    v_mfma_f32_32x32x8_bf16 v[48:63], v[76:77], v[184:185], v[48:63]
    v_add_u32 v249, s48, v249
    v_add_u32 v250, s49, v250
    ds_read_b32 v252, v251 offset:16
    ds_read_b64_tr_b16 v[68:69], v249 offset:0
    ds_read_b64_tr_b16 v[70:71], v249 offset:256
    s_mov_b64 exec, s[54:55]
    ds_read_u16_d16_hi v242, v250 offset:0
    s_mov_b64 exec, -1
    v_fmac_f32 v196, v26, v162
    v_fmac_f32 v196, v27, v163
    v_fmac_f32 v196, v28, v164
    v_fmac_f32 v196, v29, v165
    v_fmac_f32 v196, v30, v166
    v_fmac_f32 v196, v31, v167
    s_nop 1
    v_permlane32_swap_b32 v198, v196
    v_add_f32 v196, v198, v196
    v_mul_f32 v255, v32, v152
    v_fmac_f32 v255, v33, v153
    v_fmac_f32 v255, v34, v154
    v_fmac_f32 v255, v35, v155
    v_fmac_f32 v255, v36, v156
    v_fmac_f32 v255, v37, v157
    v_fmac_f32 v255, v38, v158
    v_fmac_f32 v255, v39, v159
    v_fma_f32 v203, v40, -v168, v203
    v_fma_f32 v203, v41, -v169, v203
    v_permlane32_swap_b32 v255, v201
    v_fma_f32 v203, v42, -v170, v203
    v_fma_f32 v203, v43, -v171, v203
    v_fma_f32 v203, v44, -v172, v203
    v_fma_f32 v203, v45, -v173, v203
    v_fma_f32 v203, v46, -v174, v203
    v_fma_f32 v203, v47, -v175, v203
    v_add_f32 v201, v255, v201
    v_fmac_f32 v199, v48, v120
    v_permlane32_swap_b32 v203, v255
    v_fmac_f32 v199, v49, v121
    v_fmac_f32 v199, v50, v122
    v_fmac_f32 v199, v51, v123
    v_fmac_f32 v199, v52, v124
    v_fmac_f32 v199, v53, v125
    v_fmac_f32 v199, v54, v126
    v_fmac_f32 v199, v55, v127
    v_add_f32 v255, v203, v255
    v_mul_f32 v197, v56, v168
    v_fmac_f32 v197, v57, v169
    v_fmac_f32 v197, v58, v170
    v_fmac_f32 v197, v59, v171
    v_fmac_f32 v197, v60, v172
    v_fmac_f32 v197, v61, v173
    v_fmac_f32 v197, v62, v174
    v_fmac_f32 v197, v63, v175
    s_nop 1
    v_permlane32_swap_b32 v199, v197
    v_add_f32 v197, v199, v197
    v_cvt_pk_bf16_f32 v200, v200, v201
    v_cvt_pk_bf16_f32 v254, v254, v255
    v_cvt_pk_bf16_f32 v196, v196, v197
    ds_write_b32 v253, v200 offset:768
    s_mov_b64 exec, 0xffffffff
    ds_write_b32 v253, v254 offset:1280
    s_mov_b64 exec, -1
    ds_write_b32 v253, v196 offset:1024
    s_add_u32 s50, s50, 1
    s_cmp_ge_u32 s50, 5
    s_cbranch_scc1 TAIL
    s_waitcnt lgkmcnt(6)
    v_readfirstlane_b32 s66, v252
    s_add_u32 s53, s53, 1
    v_mov_b32 v252, s53
    s_cmp_le_u32 s53, s66
    ds_write2_b32 v251, v252, v252 offset0:0 offset1:8
    s_setprio 1
    s_cbranch_scc1 PRIO_12
    s_setprio 0
PRIO_12:
    s_cmp_eq_u32 s52, 4
    s_cbranch_scc1 ITEM_1_4
    s_cmp_eq_u32 s52, 5
    s_cbranch_scc1 ITEM_1_5
    s_cmp_eq_u32 s52, 3
    s_cbranch_scc1 ITEM_1_3
    s_cmp_eq_u32 s52, 6
    s_cbranch_scc1 ITEM_1_6
    s_cmp_eq_u32 s52, 8
    s_cbranch_scc1 ITEM_1_8
    s_branch ITEM_1_2
.p2align 6
ITEM_1_6:
    s_mov_b64 exec, s[54:55]
    ds_read_u16_d16_hi v243, v250 offset:128
    s_mov_b64 exec, -1
    ds_read_b64_tr_b16 v[76:77], v249 offset:512
    ds_read_b64_tr_b16 v[78:79], v249 offset:768
    ds_read_b64_tr_b16 v[84:85], v249 offset:1024
    ds_read_b64_tr_b16 v[86:87], v249 offset:1280
    s_waitcnt lgkmcnt(5)
    v_lshlrev_b32 v196, 16, v68
    v_and_b32 v197, 0xffff0000, v68
    v_lshlrev_b32 v198, 16, v69
    v_and_b32 v199, 0xffff0000, v69
    v_mul_f32_dpp v200, v242, v196 row_newbcast:0 row_mask:0xf bank_mask:0xf
    v_mul_f32_dpp v201, v242, v197 row_newbcast:1 row_mask:0xf bank_mask:0xf
    v_mul_f32_dpp v202, v242, v196 row_newbcast:8 row_mask:0xf bank_mask:0xf
    v_mul_f32_dpp v203, v242, v197 row_newbcast:9 row_mask:0xf bank_mask:0xf
    v_lshlrev_b32 v196, 16, v70
    v_and_b32 v197, 0xffff0000, v70
    v_cvt_pk_bf16_f32 v64, v200, v201
    v_cvt_pk_bf16_f32 v68, v202, v203
    v_mul_f32_dpp v200, v242, v198 row_newbcast:2 row_mask:0xf bank_mask:0xf
    v_mul_f32_dpp v201, v242, v199 row_newbcast:3 row_mask:0xf bank_mask:0xf
    v_mul_f32_dpp v202, v242, v198 row_newbcast:10 row_mask:0xf bank_mask:0xf
    v_mul_f32_dpp v203, v242, v199 row_newbcast:11 row_mask:0xf bank_mask:0xf
    v_lshlrev_b32 v198, 16, v71
    v_and_b32 v199, 0xffff0000, v71
    v_cvt_pk_bf16_f32 v65, v200, v201
    v_cvt_pk_bf16_f32 v69, v202, v203
    v_mul_f32_dpp v200, v242, v196 row_newbcast:4 row_mask:0xf bank_mask:0xf
    v_mul_f32_dpp v201, v242, v197 row_newbcast:5 row_mask:0xf bank_mask:0xf
    v_mul_f32_dpp v202, v242, v196 row_newbcast:12 row_mask:0xf bank_mask:0xf
    v_mul_f32_dpp v203, v242, v197 row_newbcast:13 row_mask:0xf bank_mask:0xf
    v_cvt_pk_bf16_f32 v66, v200, v201
    v_cvt_pk_bf16_f32 v70, v202, v203
    v_mul_f32_dpp v200, v242, v198 row_newbcast:6 row_mask:0xf bank_mask:0xf
    v_mul_f32_dpp v201, v242, v199 row_newbcast:7 row_mask:0xf bank_mask:0xf
    v_mul_f32_dpp v202, v242, v198 row_newbcast:14 row_mask:0xf bank_mask:0xf
    v_mul_f32_dpp v203, v242, v199 row_newbcast:15 row_mask:0xf bank_mask:0xf
    v_cvt_pk_bf16_f32 v67, v200, v201
    v_cvt_pk_bf16_f32 v71, v202, v203
    s_mov_b64 exec, s[54:55]
    ds_read_u16_d16_hi v242, v250 offset:256
    s_mov_b64 exec, -1
    s_waitcnt vmcnt(4) lgkmcnt(3)
    v_mfma_f32_32x32x16_bf16 v[0:15], v[64:67], v[176:179], 0
    v_lshlrev_b32 v196, 16, v76
    v_and_b32 v197, 0xffff0000, v76
    v_lshlrev_b32 v198, 16, v77
    v_and_b32 v199, 0xffff0000, v77
    v_mul_f32_dpp v200, v243, v196 row_newbcast:0 row_mask:0xf bank_mask:0xf
    v_mul_f32_dpp v201, v243, v197 row_newbcast:1 row_mask:0xf bank_mask:0xf
    v_mul_f32_dpp v202, v243, v196 row_newbcast:8 row_mask:0xf bank_mask:0xf
    v_mul_f32_dpp v203, v243, v197 row_newbcast:9 row_mask:0xf bank_mask:0xf
    v_lshlrev_b32 v196, 16, v78
    v_and_b32 v197, 0xffff0000, v78
    v_cvt_pk_bf16_f32 v72, v200, v201
    v_cvt_pk_bf16_f32 v76, v202, v203
    v_mul_f32_dpp v200, v243, v198 row_newbcast:2 row_mask:0xf bank_mask:0xf
    v_mul_f32_dpp v201, v243, v199 row_newbcast:3 row_mask:0xf bank_mask:0xf
    v_mul_f32_dpp v202, v243, v198 row_newbcast:10 row_mask:0xf bank_mask:0xf
    v_mul_f32_dpp v203, v243, v199 row_newbcast:11 row_mask:0xf bank_mask:0xf
    s_add_u32 m0, s21, 0
    v_mfma_f32_32x32x16_bf16 v[16:31], v[68:71], v[176:179], 0
    buffer_load_dwordx4 v236, s[4:7], s35 offen lds
    buffer_load_dwordx4 v237, s[8:11], s35 offen offset:1024 lds
    ds_read_b64_tr_b16 v[176:177], v244 offset:2048
    ds_read_b64_tr_b16 v[178:179], v244 offset:3072
    ds_read_b64_tr_b16 v[184:185], v245 offset:2048
    ds_read_b64_tr_b16 v[186:187], v245 offset:3072
    v_lshlrev_b32 v198, 16, v79
    v_and_b32 v199, 0xffff0000, v79
    v_cvt_pk_bf16_f32 v73, v200, v201
    v_cvt_pk_bf16_f32 v77, v202, v203
    v_mul_f32_dpp v200, v243, v196 row_newbcast:4 row_mask:0xf bank_mask:0xf
    v_mul_f32_dpp v201, v243, v197 row_newbcast:5 row_mask:0xf bank_mask:0xf
    v_mul_f32_dpp v202, v243, v196 row_newbcast:12 row_mask:0xf bank_mask:0xf
    v_mul_f32_dpp v203, v243, v197 row_newbcast:13 row_mask:0xf bank_mask:0xf
    v_cvt_pk_bf16_f32 v74, v200, v201
    v_cvt_pk_bf16_f32 v78, v202, v203
    v_mul_f32_dpp v200, v243, v198 row_newbcast:6 row_mask:0xf bank_mask:0xf
    v_mul_f32_dpp v201, v243, v199 row_newbcast:7 row_mask:0xf bank_mask:0xf
    v_mul_f32_dpp v202, v243, v198 row_newbcast:14 row_mask:0xf bank_mask:0xf
    v_mul_f32_dpp v203, v243, v199 row_newbcast:15 row_mask:0xf bank_mask:0xf
    v_cvt_pk_bf16_f32 v75, v200, v201
    v_cvt_pk_bf16_f32 v79, v202, v203
    s_nop 0
    s_waitcnt vmcnt(4) lgkmcnt(0)
    v_mfma_f32_32x32x16_bf16 v[0:15], v[72:75], v[176:179], v[0:15]
    v_lshlrev_b32 v196, 16, v84
    v_and_b32 v197, 0xffff0000, v84
    v_lshlrev_b32 v198, 16, v85
    v_and_b32 v199, 0xffff0000, v85
    v_mul_f32_dpp v200, v242, v196 row_newbcast:0 row_mask:0xf bank_mask:0xf
    v_mul_f32_dpp v201, v242, v197 row_newbcast:1 row_mask:0xf bank_mask:0xf
    v_mul_f32_dpp v202, v242, v196 row_newbcast:8 row_mask:0xf bank_mask:0xf
    v_mul_f32_dpp v203, v242, v197 row_newbcast:9 row_mask:0xf bank_mask:0xf
    v_lshlrev_b32 v196, 16, v86
    v_and_b32 v197, 0xffff0000, v86
    v_cvt_pk_bf16_f32 v80, v200, v201
    v_cvt_pk_bf16_f32 v84, v202, v203
    v_mul_f32_dpp v200, v242, v198 row_newbcast:2 row_mask:0xf bank_mask:0xf
    v_mul_f32_dpp v201, v242, v199 row_newbcast:3 row_mask:0xf bank_mask:0xf
    v_mul_f32_dpp v202, v242, v198 row_newbcast:10 row_mask:0xf bank_mask:0xf
    v_mul_f32_dpp v203, v242, v199 row_newbcast:11 row_mask:0xf bank_mask:0xf
    s_add_u32 m0, s21, 2048
    v_mfma_f32_32x32x16_bf16 v[16:31], v[76:79], v[176:179], v[16:31]
    buffer_load_dwordx4 v238, s[4:7], s35 offen lds
    buffer_load_dwordx4 v239, s[8:11], s35 offen offset:1024 lds
    ds_read_b64_tr_b16 v[176:177], v244 offset:4096
    ds_read_b64_tr_b16 v[178:179], v244 offset:5120
    ds_read_b64_tr_b16 v[188:189], v245 offset:4096
    ds_read_b64_tr_b16 v[190:191], v245 offset:5120
    v_lshlrev_b32 v198, 16, v87
    v_and_b32 v199, 0xffff0000, v87
    v_cvt_pk_bf16_f32 v81, v200, v201
    v_cvt_pk_bf16_f32 v85, v202, v203
    v_mul_f32_dpp v200, v242, v196 row_newbcast:4 row_mask:0xf bank_mask:0xf
    v_mul_f32_dpp v201, v242, v197 row_newbcast:5 row_mask:0xf bank_mask:0xf
    v_mul_f32_dpp v202, v242, v196 row_newbcast:12 row_mask:0xf bank_mask:0xf
    v_mul_f32_dpp v203, v242, v197 row_newbcast:13 row_mask:0xf bank_mask:0xf
    v_cvt_pk_bf16_f32 v82, v200, v201
    v_cvt_pk_bf16_f32 v86, v202, v203
    v_mul_f32_dpp v200, v242, v198 row_newbcast:6 row_mask:0xf bank_mask:0xf
    v_mul_f32_dpp v201, v242, v199 row_newbcast:7 row_mask:0xf bank_mask:0xf
    v_mul_f32_dpp v202, v242, v198 row_newbcast:14 row_mask:0xf bank_mask:0xf
    v_mul_f32_dpp v203, v242, v199 row_newbcast:15 row_mask:0xf bank_mask:0xf
    v_cvt_pk_bf16_f32 v83, v200, v201
    v_cvt_pk_bf16_f32 v87, v202, v203
    s_nop 0
    s_waitcnt lgkmcnt(0)
    v_mfma_f32_32x32x16_bf16 v[0:15], v[80:83], v[176:179], v[0:15]
    s_add_u32 m0, s21, 4096
    v_mfma_f32_32x32x16_bf16 v[16:31], v[84:87], v[176:179], v[16:31]
    buffer_load_dwordx4 v234, s[4:7], s36 offen lds
    buffer_load_dwordx4 v235, s[8:11], s36 offen offset:1024 lds
    s_mov_b32 m0, s50
    s_nop 0
    s_movrels_b32 s71, s23
    s_movrels_b32 s33, s28
    s_and_b32 s70, s33, 0x70
    s_andn2_b32 s33, s33, 0x70
    v_xor_b32 v253, s70, v248
    v_add_u32 v253, s33, v253
    s_bfe_u32 s46, s71, 0x30012
    s_mov_b32 m0, s46
    s_and_b32 s66, s71, 0x3ffff
    s_movrels_b32 s68, s57
    s_movrels_b32 s69, s61
    s_sub_u32 s48, s66, s47
    s_mov_b32 s47, s66
    s_lshr_b32 s52, s71, 28
    s_lshl_b32 s67, s46, 9
    s_add_u32 s66, s66, s67
    s_sub_u32 s49, s66, s42
    s_mov_b32 s42, s66
    s_bfe_u32 s66, s68, 655360
    s_add_u32 s43, s42, s66
    s_bfe_u32 s39, s69, 655360
    s_bfe_u32 s66, s68, 655370
    s_add_u32 s44, s42, s66
    s_bfe_u32 s40, s69, 655370
    s_bfe_u32 s66, s68, 655380
    s_add_u32 s45, s42, s66
    s_bfe_u32 s41, s69, 655380
    v_add_u32 v252, s45, v247
    ds_read_u16 v240, v252
    ds_read_u16 v241, v252 offset:64
    v_mfma_f32_32x32x16_bf16 v[32:47], v[64:67], v[180:183], 0
    v_mul_f32 v196, v0, v96
    v_fmac_f32 v196, v1, v97
    v_fmac_f32 v196, v2, v98
    v_fmac_f32 v196, v3, v99
    v_fmac_f32 v196, v4, v100
    v_fmac_f32 v196, v5, v101
    v_fmac_f32 v196, v6, v102
    v_mfma_f32_32x32x16_bf16 v[48:63], v[68:71], v[180:183], 0
    v_fmac_f32 v196, v7, v103
    v_mul_f32 v198, v8, v128
    v_fmac_f32 v198, v9, v129
    v_fmac_f32 v198, v10, v130
    v_fmac_f32 v198, v11, v131
    v_fmac_f32 v198, v12, v132
    v_mfma_f32_32x32x16_bf16 v[32:47], v[72:75], v[184:187], v[32:47]
    v_fmac_f32 v198, v13, v133
    v_fmac_f32 v198, v14, v134
    v_fmac_f32 v198, v15, v135
    v_mul_f32 v200, v16, v128
    v_fmac_f32 v200, v17, v129
    v_permlane32_swap_b32 v196, v198
    v_mfma_f32_32x32x16_bf16 v[48:63], v[76:79], v[184:187], v[48:63]
    s_waitcnt vmcnt(6)
    ds_read_b64_tr_b16 v[176:177], v244 offset:6144
    ds_read_b64_tr_b16 v[178:179], v244 offset:7168
    ds_read_b64_tr_b16 v[180:181], v245 offset:6144
    ds_read_b64_tr_b16 v[182:183], v245 offset:7168
    v_fmac_f32 v200, v18, v130
    v_fmac_f32 v200, v19, v131
    v_fmac_f32 v200, v20, v132
    v_fmac_f32 v200, v21, v133
    v_fmac_f32 v200, v22, v134
    v_fmac_f32 v200, v23, v135
    v_mfma_f32_32x32x16_bf16 v[32:47], v[80:83], v[188:191], v[32:47]
    v_add_f32 v198, v196, v198
    v_mul_f32_e64 v202, v24, -v128
    v_fma_f32 v202, v25, -v129, v202
    v_fma_f32 v202, v26, -v130, v202
    v_fma_f32 v202, v27, -v131, v202
    v_fma_f32 v202, v28, -v132, v202
    v_mfma_f32_32x32x16_bf16 v[48:63], v[84:87], v[188:191], v[48:63]
    v_fma_f32 v202, v29, -v133, v202
    v_fma_f32 v202, v30, -v134, v202
    v_fma_f32 v202, v31, -v135, v202
    s_nop 1
    v_permlane32_swap_b32 v200, v202
    v_add_f32 v202, v200, v202
    s_waitcnt vmcnt(4) lgkmcnt(0)
    v_mfma_f32_32x32x16_bf16 v[0:15], v[64:67], v[176:179], 0
    v_mul_f32 v197, v32, v104
    v_fmac_f32 v197, v33, v105
    v_fmac_f32 v197, v34, v106
    v_fmac_f32 v197, v35, v107
    v_fmac_f32 v197, v36, v108
    v_fmac_f32 v197, v37, v109
    v_fmac_f32 v197, v38, v110
    s_add_u32 m0, s21, 6144
    v_mfma_f32_32x32x16_bf16 v[16:31], v[68:71], v[176:179], 0
    buffer_load_dwordx4 v236, s[4:7], s36 offen lds
    buffer_load_dwordx4 v237, s[8:11], s36 offen offset:1024 lds
    ds_read_b64_tr_b16 v[176:177], v244 offset:0
    ds_read_b64_tr_b16 v[178:179], v244 offset:1024
    ds_read_b64_tr_b16 v[184:185], v245 offset:0
    ds_read_b64_tr_b16 v[186:187], v245 offset:1024
    v_fmac_f32 v197, v39, v111
    v_mul_f32 v199, v40, v136
    v_fmac_f32 v199, v41, v137
    v_fmac_f32 v199, v42, v138
    v_fmac_f32 v199, v43, v139
    v_fmac_f32 v199, v44, v140
    v_fmac_f32 v199, v45, v141
    s_waitcnt vmcnt(4) lgkmcnt(0)
    v_mfma_f32_32x32x16_bf16 v[0:15], v[72:75], v[176:179], v[0:15]
    v_fmac_f32 v199, v46, v142
    v_fmac_f32 v199, v47, v143
    v_mul_f32 v201, v48, v136
    v_fmac_f32 v201, v49, v137
    v_permlane32_swap_b32 v197, v199
    v_fmac_f32 v201, v50, v138
    v_fmac_f32 v201, v51, v139
    s_add_u32 m0, s21, 0
    v_mfma_f32_32x32x16_bf16 v[16:31], v[76:79], v[176:179], v[16:31]
    buffer_load_dwordx4 v238, s[4:7], s36 offen lds
    buffer_load_dwordx4 v239, s[8:11], s36 offen offset:1024 lds
    ds_read_b64_tr_b16 v[176:177], v244 offset:2048
    ds_read_b64_tr_b16 v[178:179], v244 offset:3072
    ds_read_b64_tr_b16 v[188:189], v245 offset:2048
    ds_read_b64_tr_b16 v[190:191], v245 offset:3072
    v_fmac_f32 v201, v52, v140
    v_fmac_f32 v201, v53, v141
    v_fmac_f32 v201, v54, v142
    v_fmac_f32 v201, v55, v143
    v_add_f32 v199, v197, v199
    v_mul_f32_e64 v203, v56, -v136
    v_fma_f32 v203, v57, -v137, v203
    s_waitcnt lgkmcnt(0)
    v_mfma_f32_32x32x16_bf16 v[0:15], v[80:83], v[176:179], v[0:15]
    v_fma_f32 v203, v58, -v138, v203
    v_fma_f32 v203, v59, -v139, v203
    v_fma_f32 v203, v60, -v140, v203
    v_fma_f32 v203, v61, -v141, v203
    v_fma_f32 v203, v62, -v142, v203
    v_fma_f32 v203, v63, -v143, v203
    s_nop 1
    s_add_u32 m0, s21, 2048
    v_mfma_f32_32x32x16_bf16 v[16:31], v[84:87], v[176:179], v[16:31]
    buffer_load_dwordx4 v234, s[4:7], s37 offen lds
    buffer_load_dwordx4 v235, s[8:11], s37 offen offset:1024 lds
    v_add_u32 v252, s42, v247
    ds_read_u16 v234, v252
    ds_read_u16 v235, v252 offset:64
    v_permlane32_swap_b32 v201, v203
    v_add_f32 v203, v201, v203
    v_cvt_pk_bf16_f32 v198, v198, v199
    v_cvt_pk_bf16_f32 v202, v202, v203
    ds_write_b32 v253, v198 offset:0
    ds_write_b32 v253, v202 offset:256
    v_mfma_f32_32x32x16_bf16 v[32:47], v[64:67], v[180:183], 0
    v_mul_f32 v196, v0, v144
    v_fmac_f32 v196, v1, v145
    v_fmac_f32 v196, v2, v146
    v_fmac_f32 v196, v3, v147
    v_fmac_f32 v196, v4, v148
    v_fmac_f32 v196, v5, v149
    v_mfma_f32_32x32x16_bf16 v[48:63], v[68:71], v[180:183], 0
    v_fmac_f32 v196, v6, v150
    v_fmac_f32 v196, v7, v151
    v_mul_f32 v198, v8, v112
    v_fmac_f32 v198, v9, v113
    v_fmac_f32 v198, v10, v114
    v_mfma_f32_32x32x16_bf16 v[32:47], v[72:75], v[184:187], v[32:47]
    v_fmac_f32 v198, v11, v115
    v_fmac_f32 v198, v12, v116
    v_fmac_f32 v198, v13, v117
    v_fmac_f32 v198, v14, v118
    v_fmac_f32 v198, v15, v119
    v_mfma_f32_32x32x16_bf16 v[48:63], v[76:79], v[184:187], v[48:63]
    s_waitcnt vmcnt(6)
    ds_read_b64_tr_b16 v[176:177], v244 offset:4096
    ds_read_b64_tr_b16 v[178:179], v244 offset:5120
    ds_read_b64_tr_b16 v[180:181], v245 offset:4096
    ds_read_b64_tr_b16 v[182:183], v245 offset:5120
    v_mul_f32_e64 v200, v16, -v160
    v_fma_f32 v200, v17, -v161, v200
    v_fma_f32 v200, v18, -v162, v200
    v_fma_f32 v200, v19, -v163, v200
    v_fma_f32 v200, v20, -v164, v200
    v_fma_f32 v200, v21, -v165, v200
    v_mfma_f32_32x32x16_bf16 v[32:47], v[80:83], v[188:191], v[32:47]
    v_fma_f32 v200, v22, -v166, v200
    v_fma_f32 v200, v23, -v167, v200
    v_mul_f32_e64 v202, v24, -v160
    v_fma_f32 v202, v25, -v161, v202
    v_fma_f32 v202, v26, -v162, v202
    v_mfma_f32_32x32x16_bf16 v[48:63], v[84:87], v[188:191], v[48:63]
    v_fma_f32 v202, v27, -v163, v202
    v_fma_f32 v202, v28, -v164, v202
    v_fma_f32 v202, v29, -v165, v202
    v_fma_f32 v202, v30, -v166, v202
    v_fma_f32 v202, v31, -v167, v202
    s_waitcnt vmcnt(4) lgkmcnt(0)
    v_mfma_f32_32x32x16_bf16 v[0:15], v[64:67], v[176:179], 0
    v_mul_f32 v197, v32, v152
    v_fmac_f32 v197, v33, v153
    v_fmac_f32 v197, v34, v154
    v_fmac_f32 v197, v35, v155
    v_fmac_f32 v197, v36, v156
    v_fmac_f32 v197, v37, v157
    s_add_u32 m0, s21, 4096
    v_mfma_f32_32x32x16_bf16 v[16:31], v[68:71], v[176:179], 0
    buffer_load_dwordx4 v236, s[4:7], s37 offen lds
    buffer_load_dwordx4 v237, s[8:11], s37 offen offset:1024 lds
    ds_read_b64_tr_b16 v[176:177], v244 offset:6144
    ds_read_b64_tr_b16 v[178:179], v244 offset:7168
    ds_read_b64_tr_b16 v[184:185], v245 offset:6144
    ds_read_b64_tr_b16 v[186:187], v245 offset:7168
    v_add_u32 v252, s43, v247
    ds_read_u16 v236, v252
    ds_read_u16 v237, v252 offset:64
    v_fmac_f32 v197, v38, v158
    v_fmac_f32 v197, v39, v159
    v_mul_f32 v199, v40, v120
    v_fmac_f32 v199, v41, v121
    v_fmac_f32 v199, v42, v122
    s_waitcnt vmcnt(4) lgkmcnt(2)
    v_mfma_f32_32x32x16_bf16 v[0:15], v[72:75], v[176:179], v[0:15]
    v_fmac_f32 v199, v43, v123
    v_fmac_f32 v199, v44, v124
    v_fmac_f32 v199, v45, v125
    v_fmac_f32 v199, v46, v126
    v_fmac_f32 v199, v47, v127
    s_add_u32 m0, s21, 6144
    v_mfma_f32_32x32x16_bf16 v[16:31], v[76:79], v[176:179], v[16:31]
    buffer_load_dwordx4 v238, s[4:7], s37 offen lds
    buffer_load_dwordx4 v239, s[8:11], s37 offen offset:1024 lds
    ds_read_b64_tr_b16 v[176:177], v244 offset:0
    ds_read_b64_tr_b16 v[178:179], v244 offset:1024
    ds_read_b64_tr_b16 v[188:189], v245 offset:0
    ds_read_b64_tr_b16 v[190:191], v245 offset:1024
    v_add_u32 v252, s44, v247
    ds_read_u16 v238, v252
    ds_read_u16 v239, v252 offset:64
    v_mul_f32_e64 v201, v48, -v168
    v_fma_f32 v201, v49, -v169, v201
    v_fma_f32 v201, v50, -v170, v201
    v_fma_f32 v201, v51, -v171, v201
    v_fma_f32 v201, v52, -v172, v201
    v_fma_f32 v201, v53, -v173, v201
    s_waitcnt lgkmcnt(2)
    v_mfma_f32_32x32x16_bf16 v[0:15], v[80:83], v[176:179], v[0:15]
    v_fma_f32 v201, v54, -v174, v201
    v_fma_f32 v201, v55, -v175, v201
    v_mul_f32_e64 v203, v56, -v168
    v_fma_f32 v203, v57, -v169, v203
    v_fma_f32 v203, v58, -v170, v203
    s_add_u32 m0, s21, 0
    v_mfma_f32_32x32x16_bf16 v[16:31], v[84:87], v[176:179], v[16:31]
    v_lshl_add_u32 v234, v234, 10, v246
    v_lshl_add_u32 v235, v235, 10, v246
    buffer_load_dwordx4 v234, s[4:7], s38 offen lds
    buffer_load_dwordx4 v235, s[8:11], s38 offen offset:1024 lds
    v_fma_f32 v203, v59, -v171, v203
    v_fma_f32 v203, v60, -v172, v203
    v_fma_f32 v203, v61, -v173, v203
    v_fma_f32 v203, v62, -v174, v203
    v_fma_f32 v203, v63, -v175, v203
    v_mfma_f32_32x32x16_bf16 v[32:47], v[64:67], v[180:183], 0
    v_mul_f32 v254, v0, v144
    v_fmac_f32 v254, v1, v145
    v_fmac_f32 v254, v2, v146
    v_mfma_f32_32x32x16_bf16 v[48:63], v[68:71], v[180:183], 0
    ds_swizzle_b32 v68, v68 offset:0x401F
    ds_swizzle_b32 v69, v69 offset:0x401F
    ds_swizzle_b32 v70, v70 offset:0x401F
    ds_swizzle_b32 v71, v71 offset:0x401F
    v_fmac_f32 v254, v3, v147
    v_fmac_f32 v254, v4, v148
    v_fmac_f32 v254, v5, v149
    v_mfma_f32_32x32x16_bf16 v[32:47], v[72:75], v[184:187], v[32:47]
    v_fmac_f32 v254, v6, v150
    v_fmac_f32 v254, v7, v151
    v_fmac_f32 v200, v8, v160
    v_mfma_f32_32x32x16_bf16 v[48:63], v[76:79], v[184:187], v[48:63]
    ds_swizzle_b32 v76, v76 offset:0x401F
    ds_swizzle_b32 v77, v77 offset:0x401F
    ds_swizzle_b32 v78, v78 offset:0x401F
    ds_swizzle_b32 v79, v79 offset:0x401F
    s_waitcnt vmcnt(6)
    ds_read_b64_tr_b16 v[176:177], v244 offset:2048
    ds_read_b64_tr_b16 v[178:179], v244 offset:3072
    ds_read_b64_tr_b16 v[180:181], v245 offset:2048
    ds_read_b64_tr_b16 v[182:183], v245 offset:3072
    v_fmac_f32 v200, v9, v161
    v_permlane32_swap_b32 v196, v254
    v_fmac_f32 v200, v10, v162
    v_mfma_f32_32x32x16_bf16 v[32:47], v[80:83], v[188:191], v[32:47]
    v_fmac_f32 v200, v11, v163
    v_fmac_f32 v200, v12, v164
    v_fmac_f32 v200, v13, v165
    v_mfma_f32_32x32x16_bf16 v[48:63], v[84:87], v[188:191], v[48:63]
    ds_swizzle_b32 v84, v84 offset:0x401F
    ds_swizzle_b32 v85, v85 offset:0x401F
    ds_swizzle_b32 v86, v86 offset:0x401F
    ds_swizzle_b32 v87, v87 offset:0x401F
    v_fmac_f32 v200, v14, v166
    v_fmac_f32 v200, v15, v167
    v_add_f32 v254, v196, v254
    s_waitcnt lgkmcnt(8)
    s_mov_b64 exec, s[56:57]
    v_xor_b32 v68, 0x80008000, v68
    v_xor_b32 v69, 0x80008000, v69
    v_xor_b32 v70, 0x80008000, v70
    v_xor_b32 v71, 0x80008000, v71
    v_xor_b32 v76, 0x80008000, v76
    v_xor_b32 v77, 0x80008000, v77
    v_xor_b32 v78, 0x80008000, v78
    v_xor_b32 v79, 0x80008000, v79
    s_mov_b64 exec, -1
    s_waitcnt vmcnt(4) lgkmcnt(4)
    v_mfma_f32_32x32x16_bf16 v[0:15], v[64:67], v[176:179], 0
    v_mul_f32 v255, v32, v152
    v_fmac_f32 v255, v33, v153
    v_fmac_f32 v255, v34, v154
    v_fmac_f32 v255, v35, v155
    s_add_u32 m0, s21, 2048
    v_mfma_f32_32x32x16_bf16 v[16:31], v[68:71], v[176:179], v[16:31]
    v_lshl_add_u32 v236, v236, 10, v246
    v_lshl_add_u32 v237, v237, 10, v246
    buffer_load_dwordx4 v236, s[4:7], s39 offen lds
    buffer_load_dwordx4 v237, s[8:11], s39 offen offset:1024 lds
    ds_read_b64_tr_b16 v[176:177], v244 offset:4096
    ds_read_b64_tr_b16 v[178:179], v244 offset:5120
    ds_read_b64_tr_b16 v[184:185], v245 offset:4096
    ds_read_b64_tr_b16 v[186:187], v245 offset:5120
    v_fmac_f32 v255, v36, v156
    v_fmac_f32 v255, v37, v157
    v_fmac_f32 v255, v38, v158
    s_waitcnt vmcnt(4) lgkmcnt(0)
    v_mfma_f32_32x32x16_bf16 v[0:15], v[72:75], v[176:179], v[0:15]
    v_fmac_f32 v255, v39, v159
    v_fmac_f32 v201, v40, v168
    v_fmac_f32 v201, v41, v169
    s_add_u32 m0, s21, 4096
    v_mfma_f32_32x32x16_bf16 v[16:31], v[76:79], v[176:179], v[16:31]
    v_lshl_add_u32 v238, v238, 10, v246
    v_lshl_add_u32 v239, v239, 10, v246
    buffer_load_dwordx4 v238, s[4:7], s40 offen lds
    buffer_load_dwordx4 v239, s[8:11], s40 offen offset:1024 lds
    ds_read_b64_tr_b16 v[176:177], v244 offset:6144
    ds_read_b64_tr_b16 v[178:179], v244 offset:7168
    ds_read_b64_tr_b16 v[188:189], v245 offset:6144
    ds_read_b64_tr_b16 v[190:191], v245 offset:7168
    v_permlane32_swap_b32 v197, v255
    v_fmac_f32 v201, v42, v170
    v_fmac_f32 v201, v43, v171
    v_fmac_f32 v201, v44, v172
    s_waitcnt lgkmcnt(0)
    s_mov_b64 exec, s[56:57]
    v_xor_b32 v84, 0x80008000, v84
    v_xor_b32 v85, 0x80008000, v85
    v_xor_b32 v86, 0x80008000, v86
    v_xor_b32 v87, 0x80008000, v87
    s_mov_b64 exec, -1
    v_mfma_f32_32x32x16_bf16 v[0:15], v[80:83], v[176:179], v[0:15]
    v_fmac_f32 v201, v45, v173
    v_fmac_f32 v201, v46, v174
    v_fmac_f32 v201, v47, v175
    s_add_u32 m0, s21, 6144
    v_mfma_f32_32x32x16_bf16 v[16:31], v[84:87], v[176:179], v[16:31]
    v_lshl_add_u32 v240, v240, 10, v246
    v_lshl_add_u32 v241, v241, 10, v246
    buffer_load_dwordx4 v240, s[4:7], s41 offen lds
    buffer_load_dwordx4 v241, s[8:11], s41 offen offset:1024 lds
    v_add_f32 v255, v197, v255
    v_cvt_pk_bf16_f32 v254, v254, v255
    ds_write_b32 v253, v254 offset:512
    v_mfma_f32_32x32x16_bf16 v[32:47], v[64:67], v[180:183], 0
    v_mul_f32 v254, v0, v144
    v_fmac_f32 v254, v1, v145
    v_fmac_f32 v254, v2, v146
    v_fmac_f32 v254, v3, v147
    v_fmac_f32 v254, v4, v148
    v_fmac_f32 v254, v5, v149
    v_fmac_f32 v254, v6, v150
    v_mfma_f32_32x32x16_bf16 v[48:63], v[68:71], v[180:183], v[48:63]
    v_fmac_f32 v254, v7, v151
    v_fma_f32 v202, v8, -v160, v202
    v_fma_f32 v202, v9, -v161, v202
    v_permlane32_swap_b32 v254, v200
    v_fma_f32 v202, v10, -v162, v202
    v_fma_f32 v202, v11, -v163, v202
    v_mfma_f32_32x32x16_bf16 v[32:47], v[72:75], v[184:187], v[32:47]
    v_fma_f32 v202, v12, -v164, v202
    v_fma_f32 v202, v13, -v165, v202
    v_fma_f32 v202, v14, -v166, v202
    v_fma_f32 v202, v15, -v167, v202
    v_add_f32 v200, v254, v200
    v_fmac_f32 v198, v16, v112
    v_permlane32_swap_b32 v202, v254
    v_mfma_f32_32x32x16_bf16 v[48:63], v[76:79], v[184:187], v[48:63]
    s_waitcnt vmcnt(6)
    ds_read_b64_tr_b16 v[176:177], v244 offset:0
    ds_read_b64_tr_b16 v[178:179], v244 offset:1024
    ds_read_b64_tr_b16 v[180:181], v245 offset:0
    ds_read_b64_tr_b16 v[182:183], v245 offset:1024
    v_fmac_f32 v198, v17, v113
    v_fmac_f32 v198, v18, v114
    v_fmac_f32 v198, v19, v115
    v_fmac_f32 v198, v20, v116
    v_fmac_f32 v198, v21, v117
    v_fmac_f32 v198, v22, v118
    v_mfma_f32_32x32x16_bf16 v[32:47], v[80:83], v[188:191], v[32:47]
    v_fmac_f32 v198, v23, v119
    v_add_f32 v254, v202, v254
    v_mul_f32 v196, v24, v160
    v_fmac_f32 v196, v25, v161
    v_fmac_f32 v196, v26, v162
    v_fmac_f32 v196, v27, v163
    v_fmac_f32 v196, v28, v164
    v_mfma_f32_32x32x16_bf16 v[48:63], v[84:87], v[188:191], v[48:63]
    v_add_u32 v249, s48, v249
    v_add_u32 v250, s49, v250
    ds_read_b32 v252, v251 offset:16
    ds_read_b64_tr_b16 v[68:69], v249 offset:0
    ds_read_b64_tr_b16 v[70:71], v249 offset:256
    s_mov_b64 exec, s[54:55]
    ds_read_u16_d16_hi v242, v250 offset:0
    s_mov_b64 exec, -1
    v_fmac_f32 v196, v29, v165
    v_fmac_f32 v196, v30, v166
    v_fmac_f32 v196, v31, v167
    s_nop 1
    v_permlane32_swap_b32 v198, v196
    v_add_f32 v196, v198, v196
    v_mul_f32 v255, v32, v152
    v_fmac_f32 v255, v33, v153
    v_fmac_f32 v255, v34, v154
    v_fmac_f32 v255, v35, v155
    v_fmac_f32 v255, v36, v156
    v_fmac_f32 v255, v37, v157
    v_fmac_f32 v255, v38, v158
    v_fmac_f32 v255, v39, v159
    v_fma_f32 v203, v40, -v168, v203
    v_fma_f32 v203, v41, -v169, v203
    v_permlane32_swap_b32 v255, v201
    v_fma_f32 v203, v42, -v170, v203
    v_fma_f32 v203, v43, -v171, v203
    v_fma_f32 v203, v44, -v172, v203
    v_fma_f32 v203, v45, -v173, v203
    v_fma_f32 v203, v46, -v174, v203
    v_fma_f32 v203, v47, -v175, v203
    v_add_f32 v201, v255, v201
    v_fmac_f32 v199, v48, v120
    v_permlane32_swap_b32 v203, v255
    v_fmac_f32 v199, v49, v121
    v_fmac_f32 v199, v50, v122
    v_fmac_f32 v199, v51, v123
    v_fmac_f32 v199, v52, v124
    v_fmac_f32 v199, v53, v125
    v_fmac_f32 v199, v54, v126
    v_fmac_f32 v199, v55, v127
    v_add_f32 v255, v203, v255
    v_mul_f32 v197, v56, v168
    v_fmac_f32 v197, v57, v169
    v_fmac_f32 v197, v58, v170
    v_fmac_f32 v197, v59, v171
    v_fmac_f32 v197, v60, v172
    v_fmac_f32 v197, v61, v173
    v_fmac_f32 v197, v62, v174
    v_fmac_f32 v197, v63, v175
    s_nop 1
    v_permlane32_swap_b32 v199, v197
    v_add_f32 v197, v199, v197
    v_cvt_pk_bf16_f32 v200, v200, v201
    v_cvt_pk_bf16_f32 v254, v254, v255
    v_cvt_pk_bf16_f32 v196, v196, v197
    ds_write_b32 v253, v200 offset:768
    s_mov_b64 exec, 0xffffffff
    ds_write_b32 v253, v254 offset:1280
    s_mov_b64 exec, -1
    ds_write_b32 v253, v196 offset:1024
    s_add_u32 s50, s50, 1
    s_cmp_ge_u32 s50, 5
    s_cbranch_scc1 TAIL
    s_waitcnt lgkmcnt(6)
    v_readfirstlane_b32 s66, v252
    s_add_u32 s53, s53, 1
    v_mov_b32 v252, s53
    s_cmp_le_u32 s53, s66
    ds_write2_b32 v251, v252, v252 offset0:0 offset1:8
    s_setprio 1
    s_cbranch_scc1 PRIO_13
    s_setprio 0
PRIO_13:
    s_cmp_eq_u32 s52, 4
    s_cbranch_scc1 ITEM_1_4
    s_cmp_eq_u32 s52, 5
    s_cbranch_scc1 ITEM_1_5
    s_cmp_eq_u32 s52, 3
    s_cbranch_scc1 ITEM_1_3
    s_cmp_eq_u32 s52, 6
    s_cbranch_scc1 ITEM_1_6
    s_cmp_eq_u32 s52, 8
    s_cbranch_scc1 ITEM_1_8
    s_branch ITEM_1_2
.p2align 6
ITEM_1_8:
    s_mov_b64 exec, s[54:55]
    ds_read_u16_d16_hi v243, v250 offset:128
    s_mov_b64 exec, -1
    ds_read_b64_tr_b16 v[76:77], v249 offset:512
    ds_read_b64_tr_b16 v[78:79], v249 offset:768
    ds_read_b64_tr_b16 v[84:85], v249 offset:1024
    ds_read_b64_tr_b16 v[86:87], v249 offset:1280
    ds_read_b64_tr_b16 v[92:93], v249 offset:1536
    ds_read_b64_tr_b16 v[94:95], v249 offset:1792
    s_waitcnt lgkmcnt(7)
    v_lshlrev_b32 v196, 16, v68
    v_and_b32 v197, 0xffff0000, v68
    v_lshlrev_b32 v198, 16, v69
    v_and_b32 v199, 0xffff0000, v69
    v_mul_f32_dpp v200, v242, v196 row_newbcast:0 row_mask:0xf bank_mask:0xf
    v_mul_f32_dpp v201, v242, v197 row_newbcast:1 row_mask:0xf bank_mask:0xf
    v_mul_f32_dpp v202, v242, v196 row_newbcast:8 row_mask:0xf bank_mask:0xf
    v_mul_f32_dpp v203, v242, v197 row_newbcast:9 row_mask:0xf bank_mask:0xf
    v_lshlrev_b32 v196, 16, v70
    v_and_b32 v197, 0xffff0000, v70
    v_cvt_pk_bf16_f32 v64, v200, v201
    v_cvt_pk_bf16_f32 v68, v202, v203
    v_mul_f32_dpp v200, v242, v198 row_newbcast:2 row_mask:0xf bank_mask:0xf
    v_mul_f32_dpp v201, v242, v199 row_newbcast:3 row_mask:0xf bank_mask:0xf
    v_mul_f32_dpp v202, v242, v198 row_newbcast:10 row_mask:0xf bank_mask:0xf
    v_mul_f32_dpp v203, v242, v199 row_newbcast:11 row_mask:0xf bank_mask:0xf
    v_lshlrev_b32 v198, 16, v71
    v_and_b32 v199, 0xffff0000, v71
    v_cvt_pk_bf16_f32 v65, v200, v201
    v_cvt_pk_bf16_f32 v69, v202, v203
    v_mul_f32_dpp v200, v242, v196 row_newbcast:4 row_mask:0xf bank_mask:0xf
    v_mul_f32_dpp v201, v242, v197 row_newbcast:5 row_mask:0xf bank_mask:0xf
    v_mul_f32_dpp v202, v242, v196 row_newbcast:12 row_mask:0xf bank_mask:0xf
    v_mul_f32_dpp v203, v242, v197 row_newbcast:13 row_mask:0xf bank_mask:0xf
    v_cvt_pk_bf16_f32 v66, v200, v201
    v_cvt_pk_bf16_f32 v70, v202, v203
    v_mul_f32_dpp v200, v242, v198 row_newbcast:6 row_mask:0xf bank_mask:0xf
    v_mul_f32_dpp v201, v242, v199 row_newbcast:7 row_mask:0xf bank_mask:0xf
    v_mul_f32_dpp v202, v242, v198 row_newbcast:14 row_mask:0xf bank_mask:0xf
    v_mul_f32_dpp v203, v242, v199 row_newbcast:15 row_mask:0xf bank_mask:0xf
    v_cvt_pk_bf16_f32 v67, v200, v201
    v_cvt_pk_bf16_f32 v71, v202, v203
    s_mov_b64 exec, s[54:55]
    ds_read_u16_d16_hi v242, v250 offset:256
    s_mov_b64 exec, -1
    s_waitcnt vmcnt(4) lgkmcnt(5)
    v_mfma_f32_32x32x16_bf16 v[0:15], v[64:67], v[176:179], 0
    v_lshlrev_b32 v196, 16, v76
    v_and_b32 v197, 0xffff0000, v76
    v_lshlrev_b32 v198, 16, v77
    v_and_b32 v199, 0xffff0000, v77
    v_mul_f32_dpp v200, v243, v196 row_newbcast:0 row_mask:0xf bank_mask:0xf
    v_mul_f32_dpp v201, v243, v197 row_newbcast:1 row_mask:0xf bank_mask:0xf
    v_mul_f32_dpp v202, v243, v196 row_newbcast:8 row_mask:0xf bank_mask:0xf
    v_mul_f32_dpp v203, v243, v197 row_newbcast:9 row_mask:0xf bank_mask:0xf
    v_lshlrev_b32 v196, 16, v78
    v_and_b32 v197, 0xffff0000, v78
    v_cvt_pk_bf16_f32 v72, v200, v201
    v_cvt_pk_bf16_f32 v76, v202, v203
    v_mul_f32_dpp v200, v243, v198 row_newbcast:2 row_mask:0xf bank_mask:0xf
    v_mul_f32_dpp v201, v243, v199 row_newbcast:3 row_mask:0xf bank_mask:0xf
    v_mul_f32_dpp v202, v243, v198 row_newbcast:10 row_mask:0xf bank_mask:0xf
    v_mul_f32_dpp v203, v243, v199 row_newbcast:11 row_mask:0xf bank_mask:0xf
    s_add_u32 m0, s21, 0
    v_mfma_f32_32x32x16_bf16 v[16:31], v[68:71], v[176:179], 0
    buffer_load_dwordx4 v234, s[4:7], s35 offen lds
    buffer_load_dwordx4 v235, s[8:11], s35 offen offset:1024 lds
    ds_read_b64_tr_b16 v[176:177], v244 offset:2048
    ds_read_b64_tr_b16 v[178:179], v244 offset:3072
    ds_read_b64_tr_b16 v[184:185], v245 offset:2048
    ds_read_b64_tr_b16 v[186:187], v245 offset:3072
    v_lshlrev_b32 v198, 16, v79
    v_and_b32 v199, 0xffff0000, v79
    v_cvt_pk_bf16_f32 v73, v200, v201
    v_cvt_pk_bf16_f32 v77, v202, v203
    v_mul_f32_dpp v200, v243, v196 row_newbcast:4 row_mask:0xf bank_mask:0xf
    v_mul_f32_dpp v201, v243, v197 row_newbcast:5 row_mask:0xf bank_mask:0xf
    v_mul_f32_dpp v202, v243, v196 row_newbcast:12 row_mask:0xf bank_mask:0xf
    v_mul_f32_dpp v203, v243, v197 row_newbcast:13 row_mask:0xf bank_mask:0xf
    v_cvt_pk_bf16_f32 v74, v200, v201
    v_cvt_pk_bf16_f32 v78, v202, v203
    v_mul_f32_dpp v200, v243, v198 row_newbcast:6 row_mask:0xf bank_mask:0xf
    v_mul_f32_dpp v201, v243, v199 row_newbcast:7 row_mask:0xf bank_mask:0xf
    v_mul_f32_dpp v202, v243, v198 row_newbcast:14 row_mask:0xf bank_mask:0xf
    v_mul_f32_dpp v203, v243, v199 row_newbcast:15 row_mask:0xf bank_mask:0xf
    v_cvt_pk_bf16_f32 v75, v200, v201
    v_cvt_pk_bf16_f32 v79, v202, v203
    s_mov_b64 exec, s[54:55]
    ds_read_u16_d16_hi v243, v250 offset:384
    s_mov_b64 exec, -1
    s_waitcnt vmcnt(4) lgkmcnt(1)
    v_mfma_f32_32x32x16_bf16 v[0:15], v[72:75], v[176:179], v[0:15]
    v_lshlrev_b32 v196, 16, v84
    v_and_b32 v197, 0xffff0000, v84
    v_lshlrev_b32 v198, 16, v85
    v_and_b32 v199, 0xffff0000, v85
    v_mul_f32_dpp v200, v242, v196 row_newbcast:0 row_mask:0xf bank_mask:0xf
    v_mul_f32_dpp v201, v242, v197 row_newbcast:1 row_mask:0xf bank_mask:0xf
    v_mul_f32_dpp v202, v242, v196 row_newbcast:8 row_mask:0xf bank_mask:0xf
    v_mul_f32_dpp v203, v242, v197 row_newbcast:9 row_mask:0xf bank_mask:0xf
    v_lshlrev_b32 v196, 16, v86
    v_and_b32 v197, 0xffff0000, v86
    v_cvt_pk_bf16_f32 v80, v200, v201
    v_cvt_pk_bf16_f32 v84, v202, v203
    v_mul_f32_dpp v200, v242, v198 row_newbcast:2 row_mask:0xf bank_mask:0xf
    v_mul_f32_dpp v201, v242, v199 row_newbcast:3 row_mask:0xf bank_mask:0xf
    v_mul_f32_dpp v202, v242, v198 row_newbcast:10 row_mask:0xf bank_mask:0xf
    v_mul_f32_dpp v203, v242, v199 row_newbcast:11 row_mask:0xf bank_mask:0xf
    s_add_u32 m0, s21, 2048
    v_mfma_f32_32x32x16_bf16 v[16:31], v[76:79], v[176:179], v[16:31]
    buffer_load_dwordx4 v236, s[4:7], s35 offen lds
    buffer_load_dwordx4 v237, s[8:11], s35 offen offset:1024 lds
    ds_read_b64_tr_b16 v[176:177], v244 offset:4096
    ds_read_b64_tr_b16 v[178:179], v244 offset:5120
    ds_read_b64_tr_b16 v[188:189], v245 offset:4096
    ds_read_b64_tr_b16 v[190:191], v245 offset:5120
    v_lshlrev_b32 v198, 16, v87
    v_and_b32 v199, 0xffff0000, v87
    v_cvt_pk_bf16_f32 v81, v200, v201
    v_cvt_pk_bf16_f32 v85, v202, v203
    v_mul_f32_dpp v200, v242, v196 row_newbcast:4 row_mask:0xf bank_mask:0xf
    v_mul_f32_dpp v201, v242, v197 row_newbcast:5 row_mask:0xf bank_mask:0xf
    v_mul_f32_dpp v202, v242, v196 row_newbcast:12 row_mask:0xf bank_mask:0xf
    v_mul_f32_dpp v203, v242, v197 row_newbcast:13 row_mask:0xf bank_mask:0xf
    v_cvt_pk_bf16_f32 v82, v200, v201
    v_cvt_pk_bf16_f32 v86, v202, v203
    v_mul_f32_dpp v200, v242, v198 row_newbcast:6 row_mask:0xf bank_mask:0xf
    v_mul_f32_dpp v201, v242, v199 row_newbcast:7 row_mask:0xf bank_mask:0xf
    v_mul_f32_dpp v202, v242, v198 row_newbcast:14 row_mask:0xf bank_mask:0xf
    v_mul_f32_dpp v203, v242, v199 row_newbcast:15 row_mask:0xf bank_mask:0xf
    v_cvt_pk_bf16_f32 v83, v200, v201
    v_cvt_pk_bf16_f32 v87, v202, v203
    s_nop 0
    s_waitcnt vmcnt(4) lgkmcnt(0)
    v_mfma_f32_32x32x16_bf16 v[0:15], v[80:83], v[176:179], v[0:15]
    v_lshlrev_b32 v196, 16, v92
    v_and_b32 v197, 0xffff0000, v92
    v_lshlrev_b32 v198, 16, v93
    v_and_b32 v199, 0xffff0000, v93
    v_mul_f32_dpp v200, v243, v196 row_newbcast:0 row_mask:0xf bank_mask:0xf
    v_mul_f32_dpp v201, v243, v197 row_newbcast:1 row_mask:0xf bank_mask:0xf
    v_mul_f32_dpp v202, v243, v196 row_newbcast:8 row_mask:0xf bank_mask:0xf
    v_mul_f32_dpp v203, v243, v197 row_newbcast:9 row_mask:0xf bank_mask:0xf
    v_lshlrev_b32 v196, 16, v94
    v_and_b32 v197, 0xffff0000, v94
    v_cvt_pk_bf16_f32 v88, v200, v201
    v_cvt_pk_bf16_f32 v92, v202, v203
    v_mul_f32_dpp v200, v243, v198 row_newbcast:2 row_mask:0xf bank_mask:0xf
    v_mul_f32_dpp v201, v243, v199 row_newbcast:3 row_mask:0xf bank_mask:0xf
    v_mul_f32_dpp v202, v243, v198 row_newbcast:10 row_mask:0xf bank_mask:0xf
    v_mul_f32_dpp v203, v243, v199 row_newbcast:11 row_mask:0xf bank_mask:0xf
    s_add_u32 m0, s21, 4096
    v_mfma_f32_32x32x16_bf16 v[16:31], v[84:87], v[176:179], v[16:31]
    buffer_load_dwordx4 v238, s[4:7], s35 offen lds
    buffer_load_dwordx4 v239, s[8:11], s35 offen offset:1024 lds
    ds_read_b64_tr_b16 v[176:177], v244 offset:6144
    ds_read_b64_tr_b16 v[178:179], v244 offset:7168
    ds_read_b64_tr_b16 v[192:193], v245 offset:6144
    ds_read_b64_tr_b16 v[194:195], v245 offset:7168
    v_lshlrev_b32 v198, 16, v95
    v_and_b32 v199, 0xffff0000, v95
    v_cvt_pk_bf16_f32 v89, v200, v201
    v_cvt_pk_bf16_f32 v93, v202, v203
    v_mul_f32_dpp v200, v243, v196 row_newbcast:4 row_mask:0xf bank_mask:0xf
    v_mul_f32_dpp v201, v243, v197 row_newbcast:5 row_mask:0xf bank_mask:0xf
    v_mul_f32_dpp v202, v243, v196 row_newbcast:12 row_mask:0xf bank_mask:0xf
    v_mul_f32_dpp v203, v243, v197 row_newbcast:13 row_mask:0xf bank_mask:0xf
    v_cvt_pk_bf16_f32 v90, v200, v201
    v_cvt_pk_bf16_f32 v94, v202, v203
    v_mul_f32_dpp v200, v243, v198 row_newbcast:6 row_mask:0xf bank_mask:0xf
    v_mul_f32_dpp v201, v243, v199 row_newbcast:7 row_mask:0xf bank_mask:0xf
    v_mul_f32_dpp v202, v243, v198 row_newbcast:14 row_mask:0xf bank_mask:0xf
    v_mul_f32_dpp v203, v243, v199 row_newbcast:15 row_mask:0xf bank_mask:0xf
    v_cvt_pk_bf16_f32 v91, v200, v201
    v_cvt_pk_bf16_f32 v95, v202, v203
    s_nop 0
    s_waitcnt lgkmcnt(0)
    v_mfma_f32_32x32x16_bf16 v[0:15], v[88:91], v[176:179], v[0:15]
    s_add_u32 m0, s21, 6144
    v_mfma_f32_32x32x16_bf16 v[16:31], v[92:95], v[176:179], v[16:31]
    buffer_load_dwordx4 v240, s[4:7], s35 offen lds
    buffer_load_dwordx4 v241, s[8:11], s35 offen offset:1024 lds
    s_mov_b32 m0, s50
    s_nop 0
    s_movrels_b32 s71, s23
    s_movrels_b32 s33, s28
    s_and_b32 s70, s33, 0x70
    s_andn2_b32 s33, s33, 0x70
    v_xor_b32 v253, s70, v248
    v_add_u32 v253, s33, v253
    s_bfe_u32 s46, s71, 0x30012
    s_mov_b32 m0, s46
    s_and_b32 s66, s71, 0x3ffff
    s_movrels_b32 s68, s57
    s_movrels_b32 s69, s61
    s_sub_u32 s48, s66, s47
    s_mov_b32 s47, s66
    s_lshr_b32 s52, s71, 28
    s_lshl_b32 s67, s46, 9
    s_add_u32 s66, s66, s67
    s_sub_u32 s49, s66, s42
    s_mov_b32 s42, s66
    s_bfe_u32 s66, s68, 655360
    s_add_u32 s43, s42, s66
    s_bfe_u32 s39, s69, 655360
    s_bfe_u32 s66, s68, 655370
    s_add_u32 s44, s42, s66
    s_bfe_u32 s40, s69, 655370
    s_bfe_u32 s66, s68, 655380
    s_add_u32 s45, s42, s66
    s_bfe_u32 s41, s69, 655380
    v_mfma_f32_32x32x16_bf16 v[32:47], v[64:67], v[180:183], 0
    v_mul_f32 v196, v0, v96
    v_fmac_f32 v196, v1, v97
    v_fmac_f32 v196, v2, v98
    v_fmac_f32 v196, v3, v99
    v_fmac_f32 v196, v4, v100
    v_mfma_f32_32x32x16_bf16 v[48:63], v[68:71], v[180:183], 0
    v_fmac_f32 v196, v5, v101
    v_fmac_f32 v196, v6, v102
    v_fmac_f32 v196, v7, v103
    v_mul_f32 v198, v8, v128
    v_fmac_f32 v198, v9, v129
    v_mfma_f32_32x32x16_bf16 v[32:47], v[72:75], v[184:187], v[32:47]
    v_fmac_f32 v198, v10, v130
    v_fmac_f32 v198, v11, v131
    v_fmac_f32 v198, v12, v132
    v_fmac_f32 v198, v13, v133
    v_mfma_f32_32x32x16_bf16 v[48:63], v[76:79], v[184:187], v[48:63]
    v_fmac_f32 v198, v14, v134
    v_fmac_f32 v198, v15, v135
    v_mul_f32 v200, v16, v128
    v_fmac_f32 v200, v17, v129
    v_permlane32_swap_b32 v196, v198
    v_mfma_f32_32x32x16_bf16 v[32:47], v[80:83], v[188:191], v[32:47]
    v_fmac_f32 v200, v18, v130
    v_fmac_f32 v200, v19, v131
    v_fmac_f32 v200, v20, v132
    v_fmac_f32 v200, v21, v133
    v_fmac_f32 v200, v22, v134
    v_mfma_f32_32x32x16_bf16 v[48:63], v[84:87], v[188:191], v[48:63]
    s_waitcnt vmcnt(6)
    ds_read_b64_tr_b16 v[176:177], v244 offset:0
    ds_read_b64_tr_b16 v[178:179], v244 offset:1024
    ds_read_b64_tr_b16 v[180:181], v245 offset:0
    ds_read_b64_tr_b16 v[182:183], v245 offset:1024
    v_fmac_f32 v200, v23, v135
    v_add_f32 v198, v196, v198
    v_mul_f32_e64 v202, v24, -v128
    v_fma_f32 v202, v25, -v129, v202
    v_mfma_f32_32x32x16_bf16 v[32:47], v[88:91], v[192:195], v[32:47]
    v_fma_f32 v202, v26, -v130, v202
    v_fma_f32 v202, v27, -v131, v202
    v_fma_f32 v202, v28, -v132, v202
    v_fma_f32 v202, v29, -v133, v202
    v_fma_f32 v202, v30, -v134, v202
    v_mfma_f32_32x32x16_bf16 v[48:63], v[92:95], v[192:195], v[48:63]
    v_fma_f32 v202, v31, -v135, v202
    s_nop 1
    v_permlane32_swap_b32 v200, v202
    v_add_f32 v202, v200, v202
    s_waitcnt vmcnt(4) lgkmcnt(0)
    v_mfma_f32_32x32x16_bf16 v[0:15], v[64:67], v[176:179], 0
    v_mul_f32 v197, v32, v104
    v_fmac_f32 v197, v33, v105
    v_fmac_f32 v197, v34, v106
    v_fmac_f32 v197, v35, v107
    v_fmac_f32 v197, v36, v108
    v_fmac_f32 v197, v37, v109
    s_add_u32 m0, s21, 0
    v_mfma_f32_32x32x16_bf16 v[16:31], v[68:71], v[176:179], 0
    buffer_load_dwordx4 v234, s[4:7], s36 offen lds
    buffer_load_dwordx4 v235, s[8:11], s36 offen offset:1024 lds
    ds_read_b64_tr_b16 v[176:177], v244 offset:2048
    ds_read_b64_tr_b16 v[178:179], v244 offset:3072
    ds_read_b64_tr_b16 v[184:185], v245 offset:2048
    ds_read_b64_tr_b16 v[186:187], v245 offset:3072
    v_fmac_f32 v197, v38, v110
    v_fmac_f32 v197, v39, v111
    v_mul_f32 v199, v40, v136
    v_fmac_f32 v199, v41, v137
    v_fmac_f32 v199, v42, v138
    s_waitcnt vmcnt(4) lgkmcnt(0)
    v_mfma_f32_32x32x16_bf16 v[0:15], v[72:75], v[176:179], v[0:15]
    v_fmac_f32 v199, v43, v139
    v_fmac_f32 v199, v44, v140
    v_fmac_f32 v199, v45, v141
    v_fmac_f32 v199, v46, v142
    v_fmac_f32 v199, v47, v143
    s_add_u32 m0, s21, 2048
    v_mfma_f32_32x32x16_bf16 v[16:31], v[76:79], v[176:179], v[16:31]
    buffer_load_dwordx4 v236, s[4:7], s36 offen lds
    buffer_load_dwordx4 v237, s[8:11], s36 offen offset:1024 lds
    ds_read_b64_tr_b16 v[176:177], v244 offset:4096
    ds_read_b64_tr_b16 v[178:179], v244 offset:5120
    ds_read_b64_tr_b16 v[188:189], v245 offset:4096
    ds_read_b64_tr_b16 v[190:191], v245 offset:5120
    v_mul_f32 v201, v48, v136
    v_fmac_f32 v201, v49, v137
    v_permlane32_swap_b32 v197, v199
    v_fmac_f32 v201, v50, v138
    v_fmac_f32 v201, v51, v139
    s_waitcnt vmcnt(4) lgkmcnt(0)
    v_mfma_f32_32x32x16_bf16 v[0:15], v[80:83], v[176:179], v[0:15]
    v_fmac_f32 v201, v52, v140
    v_fmac_f32 v201, v53, v141
    v_fmac_f32 v201, v54, v142
    v_fmac_f32 v201, v55, v143
    v_add_f32 v199, v197, v199
    s_add_u32 m0, s21, 4096
    v_mfma_f32_32x32x16_bf16 v[16:31], v[84:87], v[176:179], v[16:31]
    buffer_load_dwordx4 v238, s[4:7], s36 offen lds
    buffer_load_dwordx4 v239, s[8:11], s36 offen offset:1024 lds
    ds_read_b64_tr_b16 v[176:177], v244 offset:6144
    ds_read_b64_tr_b16 v[178:179], v244 offset:7168
    ds_read_b64_tr_b16 v[192:193], v245 offset:6144
    ds_read_b64_tr_b16 v[194:195], v245 offset:7168
    v_mul_f32_e64 v203, v56, -v136
    v_fma_f32 v203, v57, -v137, v203
    v_fma_f32 v203, v58, -v138, v203
    v_fma_f32 v203, v59, -v139, v203
    v_fma_f32 v203, v60, -v140, v203
    s_waitcnt lgkmcnt(0)
    v_mfma_f32_32x32x16_bf16 v[0:15], v[88:91], v[176:179], v[0:15]
    v_fma_f32 v203, v61, -v141, v203
    v_fma_f32 v203, v62, -v142, v203
    v_fma_f32 v203, v63, -v143, v203
    s_nop 1
    v_permlane32_swap_b32 v201, v203
    s_add_u32 m0, s21, 6144
    v_mfma_f32_32x32x16_bf16 v[16:31], v[92:95], v[176:179], v[16:31]
    buffer_load_dwordx4 v240, s[4:7], s36 offen lds
    buffer_load_dwordx4 v241, s[8:11], s36 offen offset:1024 lds
    v_add_f32 v203, v201, v203
    v_cvt_pk_bf16_f32 v198, v198, v199
    v_cvt_pk_bf16_f32 v202, v202, v203
    ds_write_b32 v253, v198 offset:0
    ds_write_b32 v253, v202 offset:256
    v_mfma_f32_32x32x16_bf16 v[32:47], v[64:67], v[180:183], 0
    v_mul_f32 v196, v0, v144
    v_fmac_f32 v196, v1, v145
    v_fmac_f32 v196, v2, v146
    v_fmac_f32 v196, v3, v147
    v_mfma_f32_32x32x16_bf16 v[48:63], v[68:71], v[180:183], 0
    v_fmac_f32 v196, v4, v148
    v_fmac_f32 v196, v5, v149
    v_fmac_f32 v196, v6, v150
    v_fmac_f32 v196, v7, v151
    v_mfma_f32_32x32x16_bf16 v[32:47], v[72:75], v[184:187], v[32:47]
    v_mul_f32 v198, v8, v112
    v_fmac_f32 v198, v9, v113
    v_fmac_f32 v198, v10, v114
    v_fmac_f32 v198, v11, v115
    v_mfma_f32_32x32x16_bf16 v[48:63], v[76:79], v[184:187], v[48:63]
    v_fmac_f32 v198, v12, v116
    v_fmac_f32 v198, v13, v117
    v_fmac_f32 v198, v14, v118
    v_fmac_f32 v198, v15, v119
    v_mfma_f32_32x32x16_bf16 v[32:47], v[80:83], v[188:191], v[32:47]
    v_mul_f32_e64 v200, v16, -v160
    v_fma_f32 v200, v17, -v161, v200
    v_fma_f32 v200, v18, -v162, v200
    v_fma_f32 v200, v19, -v163, v200
    v_mfma_f32_32x32x16_bf16 v[48:63], v[84:87], v[188:191], v[48:63]
    s_waitcnt vmcnt(6)
    ds_read_b64_tr_b16 v[176:177], v244 offset:0
    ds_read_b64_tr_b16 v[178:179], v244 offset:1024
    ds_read_b64_tr_b16 v[180:181], v245 offset:0
    ds_read_b64_tr_b16 v[182:183], v245 offset:1024
    v_fma_f32 v200, v20, -v164, v200
    v_fma_f32 v200, v21, -v165, v200
    v_fma_f32 v200, v22, -v166, v200
    v_fma_f32 v200, v23, -v167, v200
    v_mfma_f32_32x32x16_bf16 v[32:47], v[88:91], v[192:195], v[32:47]
    v_mul_f32_e64 v202, v24, -v160
    v_fma_f32 v202, v25, -v161, v202
    v_fma_f32 v202, v26, -v162, v202
    v_fma_f32 v202, v27, -v163, v202
    v_mfma_f32_32x32x16_bf16 v[48:63], v[92:95], v[192:195], v[48:63]
    v_fma_f32 v202, v28, -v164, v202
    v_fma_f32 v202, v29, -v165, v202
    v_fma_f32 v202, v30, -v166, v202
    v_fma_f32 v202, v31, -v167, v202
    s_waitcnt vmcnt(4) lgkmcnt(0)
    v_mfma_f32_32x32x16_bf16 v[0:15], v[64:67], v[176:179], 0
    s_nop 0
    v_mul_f32 v197, v32, v152
    v_fmac_f32 v197, v33, v153
    v_fmac_f32 v197, v34, v154
    v_fmac_f32 v197, v35, v155
    s_add_u32 m0, s21, 0
    v_mfma_f32_32x32x16_bf16 v[16:31], v[68:71], v[176:179], 0
    buffer_load_dwordx4 v234, s[4:7], s37 offen lds
    buffer_load_dwordx4 v235, s[8:11], s37 offen offset:1024 lds
    ds_read_b64_tr_b16 v[176:177], v244 offset:2048
    ds_read_b64_tr_b16 v[178:179], v244 offset:3072
    ds_read_b64_tr_b16 v[184:185], v245 offset:2048
    ds_read_b64_tr_b16 v[186:187], v245 offset:3072
    v_add_u32 v252, s42, v247
    ds_read_u16 v234, v252
    ds_read_u16 v235, v252 offset:64
    v_fmac_f32 v197, v36, v156
    v_fmac_f32 v197, v37, v157
    v_fmac_f32 v197, v38, v158
    v_fmac_f32 v197, v39, v159
    s_waitcnt vmcnt(4) lgkmcnt(2)
    v_mfma_f32_32x32x16_bf16 v[0:15], v[72:75], v[176:179], v[0:15]
    v_mul_f32 v199, v40, v120
    v_fmac_f32 v199, v41, v121
    v_fmac_f32 v199, v42, v122
    v_fmac_f32 v199, v43, v123
    s_add_u32 m0, s21, 2048
    v_mfma_f32_32x32x16_bf16 v[16:31], v[76:79], v[176:179], v[16:31]
    buffer_load_dwordx4 v236, s[4:7], s37 offen lds
    buffer_load_dwordx4 v237, s[8:11], s37 offen offset:1024 lds
    ds_read_b64_tr_b16 v[176:177], v244 offset:4096
    ds_read_b64_tr_b16 v[178:179], v244 offset:5120
    ds_read_b64_tr_b16 v[188:189], v245 offset:4096
    ds_read_b64_tr_b16 v[190:191], v245 offset:5120
    v_add_u32 v252, s43, v247
    ds_read_u16 v236, v252
    ds_read_u16 v237, v252 offset:64
    v_fmac_f32 v199, v44, v124
    v_fmac_f32 v199, v45, v125
    v_fmac_f32 v199, v46, v126
    v_fmac_f32 v199, v47, v127
    s_waitcnt vmcnt(4) lgkmcnt(2)
    v_mfma_f32_32x32x16_bf16 v[0:15], v[80:83], v[176:179], v[0:15]
    v_mul_f32_e64 v201, v48, -v168
    v_fma_f32 v201, v49, -v169, v201
    v_fma_f32 v201, v50, -v170, v201
    v_fma_f32 v201, v51, -v171, v201
    s_add_u32 m0, s21, 4096
    v_mfma_f32_32x32x16_bf16 v[16:31], v[84:87], v[176:179], v[16:31]
    buffer_load_dwordx4 v238, s[4:7], s37 offen lds
    buffer_load_dwordx4 v239, s[8:11], s37 offen offset:1024 lds
    ds_read_b64_tr_b16 v[176:177], v244 offset:6144
    ds_read_b64_tr_b16 v[178:179], v244 offset:7168
    ds_read_b64_tr_b16 v[192:193], v245 offset:6144
    ds_read_b64_tr_b16 v[194:195], v245 offset:7168
    v_add_u32 v252, s44, v247
    ds_read_u16 v238, v252
    ds_read_u16 v239, v252 offset:64
    v_fma_f32 v201, v52, -v172, v201
    v_fma_f32 v201, v53, -v173, v201
    v_fma_f32 v201, v54, -v174, v201
    v_fma_f32 v201, v55, -v175, v201
    s_waitcnt lgkmcnt(2)
    v_mfma_f32_32x32x16_bf16 v[0:15], v[88:91], v[176:179], v[0:15]
    v_mul_f32_e64 v203, v56, -v168
    v_fma_f32 v203, v57, -v169, v203
    v_fma_f32 v203, v58, -v170, v203
    v_fma_f32 v203, v59, -v171, v203
    s_add_u32 m0, s21, 6144
    v_mfma_f32_32x32x16_bf16 v[16:31], v[92:95], v[176:179], v[16:31]
    buffer_load_dwordx4 v240, s[4:7], s37 offen lds
    buffer_load_dwordx4 v241, s[8:11], s37 offen offset:1024 lds
    v_add_u32 v252, s45, v247
    ds_read_u16 v240, v252
    ds_read_u16 v241, v252 offset:64
    v_fma_f32 v203, v60, -v172, v203
    v_fma_f32 v203, v61, -v173, v203
    v_fma_f32 v203, v62, -v174, v203
    v_fma_f32 v203, v63, -v175, v203
    v_mfma_f32_32x32x16_bf16 v[32:47], v[64:67], v[180:183], 0
    v_mul_f32 v254, v0, v144
    v_fmac_f32 v254, v1, v145
    v_fmac_f32 v254, v2, v146
    v_mfma_f32_32x32x16_bf16 v[48:63], v[68:71], v[180:183], 0
    ds_swizzle_b32 v68, v68 offset:0x401F
    ds_swizzle_b32 v69, v69 offset:0x401F
    ds_swizzle_b32 v70, v70 offset:0x401F
    ds_swizzle_b32 v71, v71 offset:0x401F
    v_fmac_f32 v254, v3, v147
    v_fmac_f32 v254, v4, v148
    v_mfma_f32_32x32x16_bf16 v[32:47], v[72:75], v[184:187], v[32:47]
    v_fmac_f32 v254, v5, v149
    v_fmac_f32 v254, v6, v150
    v_mfma_f32_32x32x16_bf16 v[48:63], v[76:79], v[184:187], v[48:63]
    ds_swizzle_b32 v76, v76 offset:0x401F
    ds_swizzle_b32 v77, v77 offset:0x401F
    ds_swizzle_b32 v78, v78 offset:0x401F
    ds_swizzle_b32 v79, v79 offset:0x401F
    v_fmac_f32 v254, v7, v151
    v_fmac_f32 v200, v8, v160
    v_mfma_f32_32x32x16_bf16 v[32:47], v[80:83], v[188:191], v[32:47]
    v_fmac_f32 v200, v9, v161
    v_permlane32_swap_b32 v196, v254
    v_fmac_f32 v200, v10, v162
    v_mfma_f32_32x32x16_bf16 v[48:63], v[84:87], v[188:191], v[48:63]
    ds_swizzle_b32 v84, v84 offset:0x401F
    ds_swizzle_b32 v85, v85 offset:0x401F
    ds_swizzle_b32 v86, v86 offset:0x401F
    ds_swizzle_b32 v87, v87 offset:0x401F
    s_waitcnt vmcnt(6)
    ds_read_b64_tr_b16 v[176:177], v244 offset:0
    ds_read_b64_tr_b16 v[178:179], v244 offset:1024
    ds_read_b64_tr_b16 v[180:181], v245 offset:0
    ds_read_b64_tr_b16 v[182:183], v245 offset:1024
    v_fmac_f32 v200, v11, v163
    v_fmac_f32 v200, v12, v164
    v_mfma_f32_32x32x16_bf16 v[32:47], v[88:91], v[192:195], v[32:47]
    v_fmac_f32 v200, v13, v165
    v_fmac_f32 v200, v14, v166
    v_mfma_f32_32x32x16_bf16 v[48:63], v[92:95], v[192:195], v[48:63]
    ds_swizzle_b32 v92, v92 offset:0x401F
    ds_swizzle_b32 v93, v93 offset:0x401F
    ds_swizzle_b32 v94, v94 offset:0x401F
    ds_swizzle_b32 v95, v95 offset:0x401F
    v_fmac_f32 v200, v15, v167
    v_add_f32 v254, v196, v254
    s_waitcnt lgkmcnt(8)
    s_mov_b64 exec, s[56:57]
    v_xor_b32 v68, 0x80008000, v68
    v_xor_b32 v69, 0x80008000, v69
    v_xor_b32 v70, 0x80008000, v70
    v_xor_b32 v71, 0x80008000, v71
    v_xor_b32 v76, 0x80008000, v76
    v_xor_b32 v77, 0x80008000, v77
    v_xor_b32 v78, 0x80008000, v78
    v_xor_b32 v79, 0x80008000, v79
    v_xor_b32 v84, 0x80008000, v84
    v_xor_b32 v85, 0x80008000, v85
    v_xor_b32 v86, 0x80008000, v86
    v_xor_b32 v87, 0x80008000, v87
    s_mov_b64 exec, -1
    s_waitcnt vmcnt(4) lgkmcnt(4)
    v_mfma_f32_32x32x16_bf16 v[0:15], v[64:67], v[176:179], 0
    v_mul_f32 v255, v32, v152
    v_fmac_f32 v255, v33, v153
    v_fmac_f32 v255, v34, v154
    s_add_u32 m0, s21, 0
    v_mfma_f32_32x32x16_bf16 v[16:31], v[68:71], v[176:179], v[16:31]
    v_lshl_add_u32 v234, v234, 10, v246
    v_lshl_add_u32 v235, v235, 10, v246
    buffer_load_dwordx4 v234, s[4:7], s38 offen lds
    buffer_load_dwordx4 v235, s[8:11], s38 offen offset:1024 lds
    ds_read_b64_tr_b16 v[176:177], v244 offset:2048
    ds_read_b64_tr_b16 v[178:179], v244 offset:3072
    ds_read_b64_tr_b16 v[184:185], v245 offset:2048
    ds_read_b64_tr_b16 v[186:187], v245 offset:3072
    v_fmac_f32 v255, v35, v155
    v_fmac_f32 v255, v36, v156
    s_waitcnt vmcnt(4) lgkmcnt(0)
    v_mfma_f32_32x32x16_bf16 v[0:15], v[72:75], v[176:179], v[0:15]
    v_fmac_f32 v255, v37, v157
    v_fmac_f32 v255, v38, v158
    v_fmac_f32 v255, v39, v159
    s_add_u32 m0, s21, 2048
    v_mfma_f32_32x32x16_bf16 v[16:31], v[76:79], v[176:179], v[16:31]
    v_lshl_add_u32 v236, v236, 10, v246
    v_lshl_add_u32 v237, v237, 10, v246
    buffer_load_dwordx4 v236, s[4:7], s39 offen lds
    buffer_load_dwordx4 v237, s[8:11], s39 offen offset:1024 lds
    ds_read_b64_tr_b16 v[176:177], v244 offset:4096
    ds_read_b64_tr_b16 v[178:179], v244 offset:5120
    ds_read_b64_tr_b16 v[188:189], v245 offset:4096
    ds_read_b64_tr_b16 v[190:191], v245 offset:5120
    v_fmac_f32 v201, v40, v168
    v_fmac_f32 v201, v41, v169
    s_waitcnt vmcnt(4) lgkmcnt(0)
    v_mfma_f32_32x32x16_bf16 v[0:15], v[80:83], v[176:179], v[0:15]
    v_permlane32_swap_b32 v197, v255
    v_fmac_f32 v201, v42, v170
    v_fmac_f32 v201, v43, v171
    s_add_u32 m0, s21, 4096
    v_mfma_f32_32x32x16_bf16 v[16:31], v[84:87], v[176:179], v[16:31]
    v_lshl_add_u32 v238, v238, 10, v246
    v_lshl_add_u32 v239, v239, 10, v246
    buffer_load_dwordx4 v238, s[4:7], s40 offen lds
    buffer_load_dwordx4 v239, s[8:11], s40 offen offset:1024 lds
    ds_read_b64_tr_b16 v[176:177], v244 offset:6144
    ds_read_b64_tr_b16 v[178:179], v244 offset:7168
    ds_read_b64_tr_b16 v[192:193], v245 offset:6144
    ds_read_b64_tr_b16 v[194:195], v245 offset:7168
    v_fmac_f32 v201, v44, v172
    v_fmac_f32 v201, v45, v173
    s_waitcnt lgkmcnt(0)
    s_mov_b64 exec, s[56:57]
    v_xor_b32 v92, 0x80008000, v92
    v_xor_b32 v93, 0x80008000, v93
    v_xor_b32 v94, 0x80008000, v94
    v_xor_b32 v95, 0x80008000, v95
    s_mov_b64 exec, -1
    v_mfma_f32_32x32x16_bf16 v[0:15], v[88:91], v[176:179], v[0:15]
    v_fmac_f32 v201, v46, v174
    v_fmac_f32 v201, v47, v175
    v_add_f32 v255, v197, v255
    s_add_u32 m0, s21, 6144
    v_mfma_f32_32x32x16_bf16 v[16:31], v[92:95], v[176:179], v[16:31]
    v_lshl_add_u32 v240, v240, 10, v246
    v_lshl_add_u32 v241, v241, 10, v246
    buffer_load_dwordx4 v240, s[4:7], s41 offen lds
    buffer_load_dwordx4 v241, s[8:11], s41 offen offset:1024 lds
    v_cvt_pk_bf16_f32 v254, v254, v255
    ds_write_b32 v253, v254 offset:512
    v_mfma_f32_32x32x16_bf16 v[32:47], v[64:67], v[180:183], 0
    v_mul_f32 v254, v0, v144
    v_fmac_f32 v254, v1, v145
    v_fmac_f32 v254, v2, v146
    v_fmac_f32 v254, v3, v147
    v_fmac_f32 v254, v4, v148
    v_mfma_f32_32x32x16_bf16 v[48:63], v[68:71], v[180:183], v[48:63]
    v_fmac_f32 v254, v5, v149
    v_fmac_f32 v254, v6, v150
    v_fmac_f32 v254, v7, v151
    v_fma_f32 v202, v8, -v160, v202
    v_fma_f32 v202, v9, -v161, v202
    v_mfma_f32_32x32x16_bf16 v[32:47], v[72:75], v[184:187], v[32:47]
    v_permlane32_swap_b32 v254, v200
    v_fma_f32 v202, v10, -v162, v202
    v_fma_f32 v202, v11, -v163, v202
    v_fma_f32 v202, v12, -v164, v202
    v_fma_f32 v202, v13, -v165, v202
    v_mfma_f32_32x32x16_bf16 v[48:63], v[76:79], v[184:187], v[48:63]
    v_fma_f32 v202, v14, -v166, v202
    v_fma_f32 v202, v15, -v167, v202
    v_add_f32 v200, v254, v200
    v_fmac_f32 v198, v16, v112
    v_permlane32_swap_b32 v202, v254
    v_mfma_f32_32x32x16_bf16 v[32:47], v[80:83], v[188:191], v[32:47]
    v_fmac_f32 v198, v17, v113
    v_fmac_f32 v198, v18, v114
    v_fmac_f32 v198, v19, v115
    v_fmac_f32 v198, v20, v116
    v_fmac_f32 v198, v21, v117
    v_mfma_f32_32x32x16_bf16 v[48:63], v[84:87], v[188:191], v[48:63]
    s_waitcnt vmcnt(6)
    ds_read_b64_tr_b16 v[176:177], v244 offset:0
    ds_read_b64_tr_b16 v[178:179], v244 offset:1024
    ds_read_b64_tr_b16 v[180:181], v245 offset:0
    ds_read_b64_tr_b16 v[182:183], v245 offset:1024
    v_fmac_f32 v198, v22, v118
    v_fmac_f32 v198, v23, v119
    v_add_f32 v254, v202, v254
    v_mul_f32 v196, v24, v160
    v_fmac_f32 v196, v25, v161
    v_mfma_f32_32x32x16_bf16 v[32:47], v[88:91], v[192:195], v[32:47]
    v_fmac_f32 v196, v26, v162
    v_fmac_f32 v196, v27, v163
    v_fmac_f32 v196, v28, v164
    v_fmac_f32 v196, v29, v165
    v_fmac_f32 v196, v30, v166
    v_mfma_f32_32x32x16_bf16 v[48:63], v[92:95], v[192:195], v[48:63]
    v_add_u32 v249, s48, v249
    v_add_u32 v250, s49, v250
    ds_read_b32 v252, v251 offset:16
    ds_read_b64_tr_b16 v[68:69], v249 offset:0
    ds_read_b64_tr_b16 v[70:71], v249 offset:256
    s_mov_b64 exec, s[54:55]
    ds_read_u16_d16_hi v242, v250 offset:0
    s_mov_b64 exec, -1
    v_fmac_f32 v196, v31, v167
    s_nop 1
    v_permlane32_swap_b32 v198, v196
    v_add_f32 v196, v198, v196
    v_mul_f32 v255, v32, v152
    v_fmac_f32 v255, v33, v153
    v_fmac_f32 v255, v34, v154
    v_fmac_f32 v255, v35, v155
    v_fmac_f32 v255, v36, v156
    v_fmac_f32 v255, v37, v157
    v_fmac_f32 v255, v38, v158
    v_fmac_f32 v255, v39, v159
    v_fma_f32 v203, v40, -v168, v203
    v_fma_f32 v203, v41, -v169, v203
    v_permlane32_swap_b32 v255, v201
    v_fma_f32 v203, v42, -v170, v203
    v_fma_f32 v203, v43, -v171, v203
    v_fma_f32 v203, v44, -v172, v203
    v_fma_f32 v203, v45, -v173, v203
    v_fma_f32 v203, v46, -v174, v203
    v_fma_f32 v203, v47, -v175, v203
    v_add_f32 v201, v255, v201
    v_fmac_f32 v199, v48, v120
    v_permlane32_swap_b32 v203, v255
    v_fmac_f32 v199, v49, v121
    v_fmac_f32 v199, v50, v122
    v_fmac_f32 v199, v51, v123
    v_fmac_f32 v199, v52, v124
    v_fmac_f32 v199, v53, v125
    v_fmac_f32 v199, v54, v126
    v_fmac_f32 v199, v55, v127
    v_add_f32 v255, v203, v255
    v_mul_f32 v197, v56, v168
    v_fmac_f32 v197, v57, v169
    v_fmac_f32 v197, v58, v170
    v_fmac_f32 v197, v59, v171
    v_fmac_f32 v197, v60, v172
    v_fmac_f32 v197, v61, v173
    v_fmac_f32 v197, v62, v174
    v_fmac_f32 v197, v63, v175
    s_nop 1
    v_permlane32_swap_b32 v199, v197
    v_add_f32 v197, v199, v197
    v_cvt_pk_bf16_f32 v200, v200, v201
    v_cvt_pk_bf16_f32 v254, v254, v255
    v_cvt_pk_bf16_f32 v196, v196, v197
    ds_write_b32 v253, v200 offset:768
    s_mov_b64 exec, 0xffffffff
    ds_write_b32 v253, v254 offset:1280
    s_mov_b64 exec, -1
    ds_write_b32 v253, v196 offset:1024
    s_add_u32 s50, s50, 1
    s_cmp_ge_u32 s50, 5
    s_cbranch_scc1 TAIL
    s_waitcnt lgkmcnt(6)
    v_readfirstlane_b32 s66, v252
    s_add_u32 s53, s53, 1
    v_mov_b32 v252, s53
    s_cmp_le_u32 s53, s66
    ds_write2_b32 v251, v252, v252 offset0:0 offset1:8
    s_setprio 1
    s_cbranch_scc1 PRIO_14
    s_setprio 0
PRIO_14:
    s_cmp_eq_u32 s52, 4
    s_cbranch_scc1 ITEM_1_4
    s_cmp_eq_u32 s52, 5
    s_cbranch_scc1 ITEM_1_5
    s_cmp_eq_u32 s52, 3
    s_cbranch_scc1 ITEM_1_3
    s_cmp_eq_u32 s52, 6
    s_cbranch_scc1 ITEM_1_6
    s_cmp_eq_u32 s52, 8
    s_cbranch_scc1 ITEM_1_8
    s_branch ITEM_1_2
.p2align 6
ITEM_1_2:
    s_mov_b32 m0, s50
    s_nop 0
    s_movrels_b32 s71, s23
    s_movrels_b32 s33, s28
    s_and_b32 s70, s33, 0x70
    s_andn2_b32 s33, s33, 0x70
    v_xor_b32 v253, s70, v248
    v_add_u32 v253, s33, v253
    s_bfe_u32 s46, s71, 0x30012
    s_mov_b32 m0, s46
    s_and_b32 s66, s71, 0x3ffff
    s_movrels_b32 s68, s57
    s_movrels_b32 s69, s61
    s_sub_u32 s48, s66, s47
    s_mov_b32 s47, s66
    s_lshr_b32 s52, s71, 28
    s_lshl_b32 s67, s46, 9
    s_add_u32 s66, s66, s67
    s_sub_u32 s49, s66, s42
    s_mov_b32 s42, s66
    s_bfe_u32 s66, s68, 655360
    s_add_u32 s43, s42, s66
    s_bfe_u32 s39, s69, 655360
    s_bfe_u32 s66, s68, 655370
    s_add_u32 s44, s42, s66
    s_bfe_u32 s40, s69, 655370
    s_bfe_u32 s66, s68, 655380
    s_add_u32 s45, s42, s66
    s_bfe_u32 s41, s69, 655380
    v_add_u32 v252, s42, v247
    ds_read_u16 v234, v252
    ds_read_u16 v235, v252 offset:64
    v_add_u32 v252, s43, v247
    ds_read_u16 v236, v252
    ds_read_u16 v237, v252 offset:64
    v_add_u32 v252, s44, v247
    ds_read_u16 v238, v252
    ds_read_u16 v239, v252 offset:64
    v_add_u32 v252, s45, v247
    ds_read_u16 v240, v252
    ds_read_u16 v241, v252 offset:64
    s_waitcnt lgkmcnt(8)
    v_lshlrev_b32 v196, 16, v68
    v_and_b32 v197, 0xffff0000, v68
    v_lshlrev_b32 v198, 16, v69
    v_and_b32 v199, 0xffff0000, v69
    v_mul_f32_dpp v200, v242, v196 row_newbcast:0 row_mask:0xf bank_mask:0xf
    v_mul_f32_dpp v201, v242, v197 row_newbcast:1 row_mask:0xf bank_mask:0xf
    v_mul_f32_dpp v202, v242, v196 row_newbcast:8 row_mask:0xf bank_mask:0xf
    v_mul_f32_dpp v203, v242, v197 row_newbcast:9 row_mask:0xf bank_mask:0xf
    v_lshlrev_b32 v196, 16, v70
    v_and_b32 v197, 0xffff0000, v70
    v_cvt_pk_bf16_f32 v64, v200, v201
    v_cvt_pk_bf16_f32 v68, v202, v203
    v_mul_f32_dpp v200, v242, v198 row_newbcast:2 row_mask:0xf bank_mask:0xf
    v_mul_f32_dpp v201, v242, v199 row_newbcast:3 row_mask:0xf bank_mask:0xf
    v_mul_f32_dpp v202, v242, v198 row_newbcast:10 row_mask:0xf bank_mask:0xf
    v_mul_f32_dpp v203, v242, v199 row_newbcast:11 row_mask:0xf bank_mask:0xf
    v_lshlrev_b32 v198, 16, v71
    v_and_b32 v199, 0xffff0000, v71
    v_cvt_pk_bf16_f32 v65, v200, v201
    v_cvt_pk_bf16_f32 v69, v202, v203
    v_mul_f32_dpp v200, v242, v196 row_newbcast:4 row_mask:0xf bank_mask:0xf
    v_mul_f32_dpp v201, v242, v197 row_newbcast:5 row_mask:0xf bank_mask:0xf
    v_mul_f32_dpp v202, v242, v196 row_newbcast:12 row_mask:0xf bank_mask:0xf
    v_mul_f32_dpp v203, v242, v197 row_newbcast:13 row_mask:0xf bank_mask:0xf
    v_cvt_pk_bf16_f32 v66, v200, v201
    v_cvt_pk_bf16_f32 v70, v202, v203
    v_mul_f32_dpp v200, v242, v198 row_newbcast:6 row_mask:0xf bank_mask:0xf
    v_mul_f32_dpp v201, v242, v199 row_newbcast:7 row_mask:0xf bank_mask:0xf
    v_mul_f32_dpp v202, v242, v198 row_newbcast:14 row_mask:0xf bank_mask:0xf
    v_mul_f32_dpp v203, v242, v199 row_newbcast:15 row_mask:0xf bank_mask:0xf
    v_cvt_pk_bf16_f32 v67, v200, v201
    v_cvt_pk_bf16_f32 v71, v202, v203
    s_nop 0
    s_waitcnt lgkmcnt(6)
    v_mfma_f32_32x32x16_bf16 v[0:15], v[64:67], v[176:179], 0
    s_add_u32 m0, s21, 0
    v_mfma_f32_32x32x16_bf16 v[16:31], v[68:71], v[176:179], 0
    v_lshl_add_u32 v234, v234, 10, v246
    v_lshl_add_u32 v235, v235, 10, v246
    buffer_load_dwordx4 v234, s[4:7], s38 offen lds
    buffer_load_dwordx4 v235, s[8:11], s38 offen offset:1024 lds
    v_mfma_f32_32x32x16_bf16 v[32:47], v[64:67], v[180:183], 0
    s_nop 4
    v_mul_f32 v196, v0, v96
    v_fmac_f32 v196, v1, v97
    v_fmac_f32 v196, v2, v98
    v_fmac_f32 v196, v3, v99
    v_fmac_f32 v196, v4, v100
    v_fmac_f32 v196, v5, v101
    v_fmac_f32 v196, v6, v102
    v_fmac_f32 v196, v7, v103
    v_mul_f32 v198, v8, v128
    v_fmac_f32 v198, v9, v129
    v_fmac_f32 v198, v10, v130
    v_fmac_f32 v198, v11, v131
    v_fmac_f32 v198, v12, v132
    v_fmac_f32 v198, v13, v133
    v_fmac_f32 v198, v14, v134
    v_fmac_f32 v198, v15, v135
    v_mul_f32 v200, v16, v128
    v_fmac_f32 v200, v17, v129
    v_permlane32_swap_b32 v196, v198
    v_mfma_f32_32x32x16_bf16 v[48:63], v[68:71], v[180:183], 0
    s_waitcnt vmcnt(6)
    ds_read_b64_tr_b16 v[176:177], v244 offset:2048
    ds_read_b64_tr_b16 v[178:179], v244 offset:3072
    ds_read_b64_tr_b16 v[180:181], v245 offset:2048
    ds_read_b64_tr_b16 v[182:183], v245 offset:3072
    v_fmac_f32 v200, v18, v130
    v_fmac_f32 v200, v19, v131
    v_fmac_f32 v200, v20, v132
    v_fmac_f32 v200, v21, v133
    v_fmac_f32 v200, v22, v134
    v_fmac_f32 v200, v23, v135
    v_add_f32 v198, v196, v198
    v_mul_f32_e64 v202, v24, -v128
    v_fma_f32 v202, v25, -v129, v202
    v_fma_f32 v202, v26, -v130, v202
    v_fma_f32 v202, v27, -v131, v202
    v_fma_f32 v202, v28, -v132, v202
    v_fma_f32 v202, v29, -v133, v202
    v_fma_f32 v202, v30, -v134, v202
    v_fma_f32 v202, v31, -v135, v202
    s_nop 1
    v_permlane32_swap_b32 v200, v202
    v_add_f32 v202, v200, v202
    s_waitcnt lgkmcnt(0)
    v_mfma_f32_32x32x16_bf16 v[0:15], v[64:67], v[176:179], 0
    v_mul_f32 v197, v32, v104
    v_fmac_f32 v197, v33, v105
    v_fmac_f32 v197, v34, v106
    v_fmac_f32 v197, v35, v107
    v_fmac_f32 v197, v36, v108
    v_fmac_f32 v197, v37, v109
    v_fmac_f32 v197, v38, v110
    v_fmac_f32 v197, v39, v111
    v_mul_f32 v199, v40, v136
    v_fmac_f32 v199, v41, v137
    v_fmac_f32 v199, v42, v138
    v_fmac_f32 v199, v43, v139
    v_fmac_f32 v199, v44, v140
    v_fmac_f32 v199, v45, v141
    v_fmac_f32 v199, v46, v142
    v_fmac_f32 v199, v47, v143
    v_mul_f32 v201, v48, v136
    v_fmac_f32 v201, v49, v137
    v_permlane32_swap_b32 v197, v199
    v_fmac_f32 v201, v50, v138
    v_fmac_f32 v201, v51, v139
    s_add_u32 m0, s21, 2048
    v_mfma_f32_32x32x16_bf16 v[16:31], v[68:71], v[176:179], 0
    v_lshl_add_u32 v236, v236, 10, v246
    v_lshl_add_u32 v237, v237, 10, v246
    buffer_load_dwordx4 v236, s[4:7], s39 offen lds
    buffer_load_dwordx4 v237, s[8:11], s39 offen offset:1024 lds
    v_fmac_f32 v201, v52, v140
    v_fmac_f32 v201, v53, v141
    v_fmac_f32 v201, v54, v142
    v_fmac_f32 v201, v55, v143
    v_add_f32 v199, v197, v199
    v_mul_f32_e64 v203, v56, -v136
    v_fma_f32 v203, v57, -v137, v203
    v_fma_f32 v203, v58, -v138, v203
    v_fma_f32 v203, v59, -v139, v203
    v_fma_f32 v203, v60, -v140, v203
    v_fma_f32 v203, v61, -v141, v203
    v_fma_f32 v203, v62, -v142, v203
    v_fma_f32 v203, v63, -v143, v203
    s_nop 1
    v_permlane32_swap_b32 v201, v203
    v_add_f32 v203, v201, v203
    v_cvt_pk_bf16_f32 v198, v198, v199
    v_cvt_pk_bf16_f32 v202, v202, v203
    ds_write_b32 v253, v198 offset:0
    ds_write_b32 v253, v202 offset:256
    v_mfma_f32_32x32x16_bf16 v[32:47], v[64:67], v[180:183], 0
    v_mul_f32 v196, v0, v144
    v_fmac_f32 v196, v1, v145
    v_fmac_f32 v196, v2, v146
    v_fmac_f32 v196, v3, v147
    v_fmac_f32 v196, v4, v148
    v_fmac_f32 v196, v5, v149
    v_fmac_f32 v196, v6, v150
    v_fmac_f32 v196, v7, v151
    v_mul_f32 v198, v8, v112
    v_fmac_f32 v198, v9, v113
    v_fmac_f32 v198, v10, v114
    v_fmac_f32 v198, v11, v115
    v_fmac_f32 v198, v12, v116
    v_fmac_f32 v198, v13, v117
    v_fmac_f32 v198, v14, v118
    v_fmac_f32 v198, v15, v119
    v_mfma_f32_32x32x16_bf16 v[48:63], v[68:71], v[180:183], 0
    s_waitcnt vmcnt(6)
    ds_read_b64_tr_b16 v[176:177], v244 offset:4096
    ds_read_b64_tr_b16 v[178:179], v244 offset:5120
    ds_read_b64_tr_b16 v[180:181], v245 offset:4096
    ds_read_b64_tr_b16 v[182:183], v245 offset:5120
    v_mul_f32_e64 v200, v16, -v160
    v_fma_f32 v200, v17, -v161, v200
    v_fma_f32 v200, v18, -v162, v200
    v_fma_f32 v200, v19, -v163, v200
    v_fma_f32 v200, v20, -v164, v200
    v_fma_f32 v200, v21, -v165, v200
    v_fma_f32 v200, v22, -v166, v200
    v_fma_f32 v200, v23, -v167, v200
    v_mul_f32_e64 v202, v24, -v160
    v_fma_f32 v202, v25, -v161, v202
    v_fma_f32 v202, v26, -v162, v202
    v_fma_f32 v202, v27, -v163, v202
    v_fma_f32 v202, v28, -v164, v202
    v_fma_f32 v202, v29, -v165, v202
    v_fma_f32 v202, v30, -v166, v202
    v_fma_f32 v202, v31, -v167, v202
    s_waitcnt lgkmcnt(0)
    v_mfma_f32_32x32x16_bf16 v[0:15], v[64:67], v[176:179], 0
    v_mul_f32 v197, v32, v152
    v_fmac_f32 v197, v33, v153
    v_fmac_f32 v197, v34, v154
    v_fmac_f32 v197, v35, v155
    v_fmac_f32 v197, v36, v156
    v_fmac_f32 v197, v37, v157
    v_fmac_f32 v197, v38, v158
    v_fmac_f32 v197, v39, v159
    v_mul_f32 v199, v40, v120
    v_fmac_f32 v199, v41, v121
    v_fmac_f32 v199, v42, v122
    v_fmac_f32 v199, v43, v123
    v_fmac_f32 v199, v44, v124
    v_fmac_f32 v199, v45, v125
    v_fmac_f32 v199, v46, v126
    v_fmac_f32 v199, v47, v127
    s_add_u32 m0, s21, 4096
    v_mfma_f32_32x32x16_bf16 v[16:31], v[68:71], v[176:179], 0
    v_lshl_add_u32 v238, v238, 10, v246
    v_lshl_add_u32 v239, v239, 10, v246
    buffer_load_dwordx4 v238, s[4:7], s40 offen lds
    buffer_load_dwordx4 v239, s[8:11], s40 offen offset:1024 lds
    v_mul_f32_e64 v201, v48, -v168
    v_fma_f32 v201, v49, -v169, v201
    v_fma_f32 v201, v50, -v170, v201
    v_fma_f32 v201, v51, -v171, v201
    v_fma_f32 v201, v52, -v172, v201
    v_fma_f32 v201, v53, -v173, v201
    v_fma_f32 v201, v54, -v174, v201
    v_fma_f32 v201, v55, -v175, v201
    v_mul_f32_e64 v203, v56, -v168
    v_fma_f32 v203, v57, -v169, v203
    v_fma_f32 v203, v58, -v170, v203
    v_fma_f32 v203, v59, -v171, v203
    v_fma_f32 v203, v60, -v172, v203
    v_fma_f32 v203, v61, -v173, v203
    v_fma_f32 v203, v62, -v174, v203
    v_fma_f32 v203, v63, -v175, v203
    v_mfma_f32_32x32x16_bf16 v[32:47], v[64:67], v[180:183], 0
    v_mul_f32 v254, v0, v144
    v_fmac_f32 v254, v1, v145
    v_fmac_f32 v254, v2, v146
    v_fmac_f32 v254, v3, v147
    v_fmac_f32 v254, v4, v148
    v_fmac_f32 v254, v5, v149
    v_fmac_f32 v254, v6, v150
    v_fmac_f32 v254, v7, v151
    v_fmac_f32 v200, v8, v160
    v_mfma_f32_32x32x16_bf16 v[48:63], v[68:71], v[180:183], 0
    ds_swizzle_b32 v68, v68 offset:0x401F
    ds_swizzle_b32 v69, v69 offset:0x401F
    ds_swizzle_b32 v70, v70 offset:0x401F
    ds_swizzle_b32 v71, v71 offset:0x401F
    s_waitcnt vmcnt(6)
    ds_read_b64_tr_b16 v[176:177], v244 offset:6144
    ds_read_b64_tr_b16 v[178:179], v244 offset:7168
    ds_read_b64_tr_b16 v[180:181], v245 offset:6144
    ds_read_b64_tr_b16 v[182:183], v245 offset:7168
    v_fmac_f32 v200, v9, v161
    v_permlane32_swap_b32 v196, v254
    v_fmac_f32 v200, v10, v162
    v_fmac_f32 v200, v11, v163
    v_fmac_f32 v200, v12, v164
    v_fmac_f32 v200, v13, v165
    v_fmac_f32 v200, v14, v166
    v_fmac_f32 v200, v15, v167
    v_add_f32 v254, v196, v254
    s_waitcnt lgkmcnt(0)
    s_mov_b64 exec, s[56:57]
    v_xor_b32 v68, 0x80008000, v68
    v_xor_b32 v69, 0x80008000, v69
    v_xor_b32 v70, 0x80008000, v70
    v_xor_b32 v71, 0x80008000, v71
    s_mov_b64 exec, -1
    s_nop 0
    v_mfma_f32_32x32x16_bf16 v[0:15], v[64:67], v[176:179], 0
    v_mul_f32 v255, v32, v152
    v_fmac_f32 v255, v33, v153
    v_fmac_f32 v255, v34, v154
    v_fmac_f32 v255, v35, v155
    v_fmac_f32 v255, v36, v156
    v_fmac_f32 v255, v37, v157
    v_fmac_f32 v255, v38, v158
    v_fmac_f32 v255, v39, v159
    v_fmac_f32 v201, v40, v168
    v_fmac_f32 v201, v41, v169
    s_add_u32 m0, s21, 6144
    v_mfma_f32_32x32x16_bf16 v[16:31], v[68:71], v[176:179], v[16:31]
    v_lshl_add_u32 v240, v240, 10, v246
    v_lshl_add_u32 v241, v241, 10, v246
    buffer_load_dwordx4 v240, s[4:7], s41 offen lds
    buffer_load_dwordx4 v241, s[8:11], s41 offen offset:1024 lds
    v_permlane32_swap_b32 v197, v255
    v_fmac_f32 v201, v42, v170
    v_fmac_f32 v201, v43, v171
    v_fmac_f32 v201, v44, v172
    v_fmac_f32 v201, v45, v173
    v_fmac_f32 v201, v46, v174
    v_fmac_f32 v201, v47, v175
    v_add_f32 v255, v197, v255
    v_cvt_pk_bf16_f32 v254, v254, v255
    ds_write_b32 v253, v254 offset:512
    v_mfma_f32_32x32x16_bf16 v[32:47], v[64:67], v[180:183], 0
    v_mul_f32 v254, v0, v144
    v_fmac_f32 v254, v1, v145
    v_fmac_f32 v254, v2, v146
    v_fmac_f32 v254, v3, v147
    v_fmac_f32 v254, v4, v148
    v_fmac_f32 v254, v5, v149
    v_fmac_f32 v254, v6, v150
    v_fmac_f32 v254, v7, v151
    v_fma_f32 v202, v8, -v160, v202
    v_fma_f32 v202, v9, -v161, v202
    v_permlane32_swap_b32 v254, v200
    v_fma_f32 v202, v10, -v162, v202
    v_fma_f32 v202, v11, -v163, v202
    v_fma_f32 v202, v12, -v164, v202
    v_fma_f32 v202, v13, -v165, v202
    v_fma_f32 v202, v14, -v166, v202
    v_fma_f32 v202, v15, -v167, v202
    v_add_f32 v200, v254, v200
    v_fmac_f32 v198, v16, v112
    v_permlane32_swap_b32 v202, v254
    v_mfma_f32_32x32x16_bf16 v[48:63], v[68:71], v[180:183], v[48:63]
    s_waitcnt vmcnt(6)
    ds_read_b64_tr_b16 v[176:177], v244 offset:0
    ds_read_b64_tr_b16 v[178:179], v244 offset:1024
    ds_read_b64_tr_b16 v[180:181], v245 offset:0
    ds_read_b64_tr_b16 v[182:183], v245 offset:1024
    v_add_u32 v249, s48, v249
    v_add_u32 v250, s49, v250
    ds_read_b32 v252, v251 offset:16
    ds_read_b64_tr_b16 v[68:69], v249 offset:0
    ds_read_b64_tr_b16 v[70:71], v249 offset:256
    s_mov_b64 exec, s[54:55]
    ds_read_u16_d16_hi v242, v250 offset:0
    s_mov_b64 exec, -1
    v_fmac_f32 v198, v17, v113
    v_fmac_f32 v198, v18, v114
    v_fmac_f32 v198, v19, v115
    v_fmac_f32 v198, v20, v116
    v_fmac_f32 v198, v21, v117
    v_fmac_f32 v198, v22, v118
    v_fmac_f32 v198, v23, v119
    v_add_f32 v254, v202, v254
    v_mul_f32 v196, v24, v160
    v_fmac_f32 v196, v25, v161
    v_fmac_f32 v196, v26, v162
    v_fmac_f32 v196, v27, v163
    v_fmac_f32 v196, v28, v164
    v_fmac_f32 v196, v29, v165
    v_fmac_f32 v196, v30, v166
    v_fmac_f32 v196, v31, v167
    s_nop 1
    v_permlane32_swap_b32 v198, v196
    v_add_f32 v196, v198, v196
    v_mul_f32 v255, v32, v152
    v_fmac_f32 v255, v33, v153
    v_fmac_f32 v255, v34, v154
    v_fmac_f32 v255, v35, v155
    v_fmac_f32 v255, v36, v156
    v_fmac_f32 v255, v37, v157
    v_fmac_f32 v255, v38, v158
    v_fmac_f32 v255, v39, v159
    v_fma_f32 v203, v40, -v168, v203
    v_fma_f32 v203, v41, -v169, v203
    v_permlane32_swap_b32 v255, v201
    v_fma_f32 v203, v42, -v170, v203
    v_fma_f32 v203, v43, -v171, v203
    v_fma_f32 v203, v44, -v172, v203
    v_fma_f32 v203, v45, -v173, v203
    v_fma_f32 v203, v46, -v174, v203
    v_fma_f32 v203, v47, -v175, v203
    v_add_f32 v201, v255, v201
    v_fmac_f32 v199, v48, v120
    v_permlane32_swap_b32 v203, v255
    v_fmac_f32 v199, v49, v121
    v_fmac_f32 v199, v50, v122
    v_fmac_f32 v199, v51, v123
    v_fmac_f32 v199, v52, v124
    v_fmac_f32 v199, v53, v125
    v_fmac_f32 v199, v54, v126
    v_fmac_f32 v199, v55, v127
    v_add_f32 v255, v203, v255
    v_mul_f32 v197, v56, v168
    v_fmac_f32 v197, v57, v169
    v_fmac_f32 v197, v58, v170
    v_fmac_f32 v197, v59, v171
    v_fmac_f32 v197, v60, v172
    v_fmac_f32 v197, v61, v173
    v_fmac_f32 v197, v62, v174
    v_fmac_f32 v197, v63, v175
    s_nop 1
    v_permlane32_swap_b32 v199, v197
    v_add_f32 v197, v199, v197
    v_cvt_pk_bf16_f32 v200, v200, v201
    v_cvt_pk_bf16_f32 v254, v254, v255
    v_cvt_pk_bf16_f32 v196, v196, v197
    ds_write_b32 v253, v200 offset:768
    s_mov_b64 exec, 0xffffffff
    ds_write_b32 v253, v254 offset:1280
    s_mov_b64 exec, -1
    ds_write_b32 v253, v196 offset:1024
    s_add_u32 s50, s50, 1
    s_cmp_ge_u32 s50, 5
    s_cbranch_scc1 TAIL
    s_waitcnt lgkmcnt(6)
    v_readfirstlane_b32 s66, v252
    s_add_u32 s53, s53, 1
    v_mov_b32 v252, s53
    s_cmp_le_u32 s53, s66
    ds_write2_b32 v251, v252, v252 offset0:0 offset1:8
    s_setprio 1
    s_cbranch_scc1 PRIO_15
    s_setprio 0
PRIO_15:
    s_cmp_eq_u32 s52, 4
    s_cbranch_scc1 ITEM_1_4
    s_cmp_eq_u32 s52, 5
    s_cbranch_scc1 ITEM_1_5
    s_cmp_eq_u32 s52, 3
    s_cbranch_scc1 ITEM_1_3
    s_cmp_eq_u32 s52, 6
    s_cbranch_scc1 ITEM_1_6
    s_cmp_eq_u32 s52, 8
    s_cbranch_scc1 ITEM_1_8
    s_branch ITEM_1_2
.p2align 6
TAIL:
    s_setprio 0
    s_waitcnt vmcnt(0) lgkmcnt(0)
    v_mbcnt_lo_u32_b32 v176, -1, 0
    v_mbcnt_hi_u32_b32 v176, -1, v176
    v_lshlrev_b32 v180, 4, v176
    s_mul_i32 s66, s20, 20480
    s_add_u32 s66, s66, 12288000
    buffer_load_dwordx4 v[96:99], v180, s[16:19], s66 offen offset:0
    buffer_load_dwordx4 v[100:103], v180, s[16:19], s66 offen offset:1024
    buffer_load_dwordx4 v[104:107], v180, s[16:19], s66 offen offset:2048
    buffer_load_dwordx4 v[108:111], v180, s[16:19], s66 offen offset:3072
    s_add_u32 s66, s66, 4096
    buffer_load_dwordx4 v[112:115], v180, s[16:19], s66 offen offset:0
    buffer_load_dwordx4 v[116:119], v180, s[16:19], s66 offen offset:1024
    buffer_load_dwordx4 v[120:123], v180, s[16:19], s66 offen offset:2048
    buffer_load_dwordx4 v[124:127], v180, s[16:19], s66 offen offset:3072
    s_add_u32 s66, s66, 4096
    buffer_load_dwordx4 v[128:131], v180, s[16:19], s66 offen offset:0
    buffer_load_dwordx4 v[132:135], v180, s[16:19], s66 offen offset:1024
    buffer_load_dwordx4 v[136:139], v180, s[16:19], s66 offen offset:2048
    buffer_load_dwordx4 v[140:143], v180, s[16:19], s66 offen offset:3072
    s_add_u32 s66, s66, 4096
    buffer_load_dwordx4 v[144:147], v180, s[16:19], s66 offen offset:0
    buffer_load_dwordx4 v[148:151], v180, s[16:19], s66 offen offset:1024
    buffer_load_dwordx4 v[152:155], v180, s[16:19], s66 offen offset:2048
    buffer_load_dwordx4 v[156:159], v180, s[16:19], s66 offen offset:3072
    s_add_u32 s66, s66, 4096
    buffer_load_dwordx4 v[160:163], v180, s[16:19], s66 offen offset:0
    buffer_load_dwordx4 v[164:167], v180, s[16:19], s66 offen offset:1024
    buffer_load_dwordx4 v[168:171], v180, s[16:19], s66 offen offset:2048
    buffer_load_dwordx4 v[172:175], v180, s[16:19], s66 offen offset:3072
    v_lshlrev_b32 v181, 2, v176
    s_bfe_u32 s67, s22, 0x40015
    s_lshl_b32 s67, s67, 4
    s_and_b32 s68, s67, 128
    s_and_b32 s67, s67, 0x70
    s_add_u32 s68, s68, s21
    v_xor_b32 v180, s67, v181
    v_add_u32 v180, s68, v180
    ds_write_b32 v180, v204 offset:0
    ds_write_b32 v180, v205 offset:256
    ds_write_b32 v180, v206 offset:512
    ds_write_b32 v180, v207 offset:768
    ds_write_b32 v180, v208 offset:1024
    s_mov_b64 exec, 0xffffffff
    ds_write_b32 v180, v209 offset:1280
    s_mov_b64 exec, -1
    s_bfe_u32 s67, s23, 0x40015
    s_lshl_b32 s67, s67, 4
    s_and_b32 s68, s67, 128
    s_and_b32 s67, s67, 0x70
    s_add_u32 s68, s68, s21
    v_xor_b32 v180, s67, v181
    v_add_u32 v180, s68, v180
    ds_write_b32 v180, v210 offset:1536
    ds_write_b32 v180, v211 offset:1792
    ds_write_b32 v180, v212 offset:2048
    ds_write_b32 v180, v213 offset:2304
    ds_write_b32 v180, v214 offset:2560
    s_mov_b64 exec, 0xffffffff
    ds_write_b32 v180, v215 offset:2816
    s_mov_b64 exec, -1
    s_bfe_u32 s67, s24, 0x40015
    s_lshl_b32 s67, s67, 4
    s_and_b32 s68, s67, 128
    s_and_b32 s67, s67, 0x70
    s_add_u32 s68, s68, s21
    v_xor_b32 v180, s67, v181
    v_add_u32 v180, s68, v180
    ds_write_b32 v180, v216 offset:3072
    ds_write_b32 v180, v217 offset:3328
    ds_write_b32 v180, v218 offset:3584
    ds_write_b32 v180, v219 offset:3840
    ds_write_b32 v180, v220 offset:4096
    s_mov_b64 exec, 0xffffffff
    ds_write_b32 v180, v221 offset:4352
    s_mov_b64 exec, -1
    s_bfe_u32 s67, s25, 0x40015
    s_lshl_b32 s67, s67, 4
    s_and_b32 s68, s67, 128
    s_and_b32 s67, s67, 0x70
    s_add_u32 s68, s68, s21
    v_xor_b32 v180, s67, v181
    v_add_u32 v180, s68, v180
    ds_write_b32 v180, v222 offset:4608
    ds_write_b32 v180, v223 offset:4864
    ds_write_b32 v180, v224 offset:5120
    ds_write_b32 v180, v225 offset:5376
    ds_write_b32 v180, v226 offset:5632
    s_mov_b64 exec, 0xffffffff
    ds_write_b32 v180, v227 offset:5888
    s_mov_b64 exec, -1
    s_bfe_u32 s67, s26, 0x40015
    s_lshl_b32 s67, s67, 4
    s_and_b32 s68, s67, 128
    s_and_b32 s67, s67, 0x70
    s_add_u32 s68, s68, s21
    v_xor_b32 v180, s67, v181
    v_add_u32 v180, s68, v180
    ds_write_b32 v180, v228 offset:6144
    ds_write_b32 v180, v229 offset:6400
    ds_write_b32 v180, v230 offset:6656
    ds_write_b32 v180, v231 offset:6912
    ds_write_b32 v180, v232 offset:7168
    s_mov_b64 exec, 0xffffffff
    ds_write_b32 v180, v233 offset:7424
    s_mov_b64 exec, -1
GEMM:
    s_load_dwordx2 s[72:73], s[0:1], 72
    v_and_b32 v177, 15, v176
    v_lshrrev_b32 v178, 4, v176
    v_min_u32 v179, 7, v177
    v_lshlrev_b32 v180, 3, v177
    v_lshlrev_b32 v181, 3, v179
    v_add_u32 v180, 86528, v180
    v_add_u32 v181, 86528, v181
    ds_read_b64 v[182:183], v180
    ds_read_b64 v[184:185], v180 offset:128
    ds_read_b64 v[186:187], v181 offset:256
    v_and_b32 v180, 7, v177
    v_xor_b32 v180, v180, v178
    v_xor_b32 v181, v179, v178
    v_xor_b32 v188, 4, v180
    v_xor_b32 v189, 4, v181
    s_waitcnt lgkmcnt(0)
    s_mov_b32 s4, s72
    s_and_b32 s5, s73, 0xffff
    s_mov_b32 s6, 10240000
    s_mov_b32 s7, 0x20000
    v_lshl_add_u32 v48, v180, 4, v182
    v_lshl_add_u32 v49, v188, 4, v182
    v_lshl_add_u32 v50, v180, 4, v183
    v_lshl_add_u32 v51, v188, 4, v183
    v_lshl_add_u32 v52, v180, 4, v184
    v_lshl_add_u32 v53, v188, 4, v184
    v_lshl_add_u32 v54, v180, 4, v185
    v_lshl_add_u32 v55, v188, 4, v185
    v_lshl_add_u32 v56, v181, 4, v186
    v_lshl_add_u32 v57, v189, 4, v186
    v_lshl_add_u32 v58, v181, 4, v187
    v_lshl_add_u32 v59, v189, 4, v187
    s_barrier
    ds_read_b128 v[72:75], v48 offset:0
    ds_read_b128 v[76:79], v52 offset:0
    ds_read_b128 v[80:83], v56 offset:0
    ds_read_b128 v[84:87], v49 offset:0
    ds_read_b128 v[88:91], v53 offset:0
    ds_read_b128 v[92:95], v57 offset:0
    s_waitcnt vmcnt(19) lgkmcnt(5)
    v_mfma_f32_16x16x32_bf16 v[0:3], v[96:99], v[72:75], 0
    ds_read_b128 v[72:75], v50 offset:0
    s_waitcnt lgkmcnt(5)
    v_mfma_f32_16x16x32_bf16 v[4:7], v[96:99], v[76:79], 0
    ds_read_b128 v[76:79], v54 offset:0
    s_waitcnt lgkmcnt(5)
    v_mfma_f32_16x16x32_bf16 v[8:11], v[96:99], v[80:83], 0
    ds_read_b128 v[80:83], v58 offset:0
    s_waitcnt vmcnt(18) lgkmcnt(5)
    v_mfma_f32_16x16x32_bf16 v[0:3], v[100:103], v[84:87], v[0:3]
    ds_read_b128 v[84:87], v51 offset:0
    s_waitcnt lgkmcnt(5)
    v_mfma_f32_16x16x32_bf16 v[4:7], v[100:103], v[88:91], v[4:7]
    ds_read_b128 v[88:91], v55 offset:0
    s_waitcnt lgkmcnt(5)
    v_mfma_f32_16x16x32_bf16 v[8:11], v[100:103], v[92:95], v[8:11]
    ds_read_b128 v[92:95], v59 offset:0
    s_waitcnt vmcnt(17) lgkmcnt(5)
    v_mfma_f32_16x16x32_bf16 v[0:3], v[104:107], v[72:75], v[0:3]
    ds_read_b128 v[72:75], v48 offset:1024
    s_waitcnt lgkmcnt(5)
    v_mfma_f32_16x16x32_bf16 v[4:7], v[104:107], v[76:79], v[4:7]
    ds_read_b128 v[76:79], v52 offset:1024
    s_waitcnt lgkmcnt(5)
    v_mfma_f32_16x16x32_bf16 v[8:11], v[104:107], v[80:83], v[8:11]
    ds_read_b128 v[80:83], v56 offset:1024
    s_waitcnt vmcnt(16) lgkmcnt(5)
    v_mfma_f32_16x16x32_bf16 v[0:3], v[108:111], v[84:87], v[0:3]
    ds_read_b128 v[84:87], v49 offset:1024
    s_waitcnt lgkmcnt(5)
    v_mfma_f32_16x16x32_bf16 v[4:7], v[108:111], v[88:91], v[4:7]
    ds_read_b128 v[88:91], v53 offset:1024
    s_waitcnt lgkmcnt(5)
    v_mfma_f32_16x16x32_bf16 v[8:11], v[108:111], v[92:95], v[8:11]
    ds_read_b128 v[92:95], v57 offset:1024
    s_waitcnt vmcnt(15) lgkmcnt(5)
    v_mfma_f32_16x16x32_bf16 v[0:3], v[112:115], v[72:75], v[0:3]
    ds_read_b128 v[72:75], v50 offset:1024
    s_waitcnt lgkmcnt(5)
    v_mfma_f32_16x16x32_bf16 v[4:7], v[112:115], v[76:79], v[4:7]
    ds_read_b128 v[76:79], v54 offset:1024
    s_waitcnt lgkmcnt(5)
    v_mfma_f32_16x16x32_bf16 v[8:11], v[112:115], v[80:83], v[8:11]
    ds_read_b128 v[80:83], v58 offset:1024
    s_waitcnt vmcnt(14) lgkmcnt(5)
    v_mfma_f32_16x16x32_bf16 v[0:3], v[116:119], v[84:87], v[0:3]
    ds_read_b128 v[84:87], v51 offset:1024
    s_waitcnt lgkmcnt(5)
    v_mfma_f32_16x16x32_bf16 v[4:7], v[116:119], v[88:91], v[4:7]
    ds_read_b128 v[88:91], v55 offset:1024
    s_waitcnt lgkmcnt(5)
    v_mfma_f32_16x16x32_bf16 v[8:11], v[116:119], v[92:95], v[8:11]
    ds_read_b128 v[92:95], v59 offset:1024
    s_waitcnt vmcnt(13) lgkmcnt(5)
    v_mfma_f32_16x16x32_bf16 v[0:3], v[120:123], v[72:75], v[0:3]
    ds_read_b128 v[72:75], v48 offset:128
    s_waitcnt lgkmcnt(5)
    v_mfma_f32_16x16x32_bf16 v[4:7], v[120:123], v[76:79], v[4:7]
    ds_read_b128 v[76:79], v52 offset:128
    s_waitcnt lgkmcnt(5)
    v_mfma_f32_16x16x32_bf16 v[8:11], v[120:123], v[80:83], v[8:11]
    ds_read_b128 v[80:83], v56 offset:128
    s_waitcnt vmcnt(12) lgkmcnt(5)
    v_mfma_f32_16x16x32_bf16 v[0:3], v[124:127], v[84:87], v[0:3]
    ds_read_b128 v[84:87], v48 offset:256
    s_waitcnt lgkmcnt(5)
    v_mfma_f32_16x16x32_bf16 v[4:7], v[124:127], v[88:91], v[4:7]
    ds_read_b128 v[88:91], v52 offset:256
    s_waitcnt lgkmcnt(5)
    v_mfma_f32_16x16x32_bf16 v[8:11], v[124:127], v[92:95], v[8:11]
    ds_read_b128 v[92:95], v56 offset:256
    s_waitcnt vmcnt(11) lgkmcnt(5)
    v_mfma_f32_16x16x32_bf16 v[12:15], v[128:131], v[72:75], 0
    ds_read_b128 v[72:75], v48 offset:384
    s_waitcnt lgkmcnt(5)
    v_mfma_f32_16x16x32_bf16 v[16:19], v[128:131], v[76:79], 0
    ds_read_b128 v[76:79], v52 offset:384
    s_waitcnt lgkmcnt(5)
    v_mfma_f32_16x16x32_bf16 v[20:23], v[128:131], v[80:83], 0
    ds_read_b128 v[80:83], v56 offset:384
    s_waitcnt lgkmcnt(5)
    v_mfma_f32_16x16x32_bf16 v[24:27], v[128:131], v[84:87], 0
    ds_read_b128 v[84:87], v49 offset:128
    s_waitcnt lgkmcnt(5)
    v_mfma_f32_16x16x32_bf16 v[28:31], v[128:131], v[88:91], 0
    ds_read_b128 v[88:91], v53 offset:128
    s_waitcnt lgkmcnt(5)
    v_mfma_f32_16x16x32_bf16 v[32:35], v[128:131], v[92:95], 0
    ds_read_b128 v[92:95], v57 offset:128
    s_waitcnt lgkmcnt(5)
    v_mfma_f32_16x16x32_bf16 v[36:39], v[128:131], v[72:75], 0
    ds_read_b128 v[72:75], v49 offset:256
    s_waitcnt lgkmcnt(5)
    v_mfma_f32_16x16x32_bf16 v[40:43], v[128:131], v[76:79], 0
    ds_read_b128 v[76:79], v53 offset:256
    s_waitcnt lgkmcnt(5)
    v_mfma_f32_16x16x32_bf16 v[44:47], v[128:131], v[80:83], 0
    ds_read_b128 v[80:83], v57 offset:256
    s_waitcnt vmcnt(10) lgkmcnt(5)
    v_mfma_f32_16x16x32_bf16 v[12:15], v[132:135], v[84:87], v[12:15]
    ds_read_b128 v[84:87], v49 offset:384
    s_waitcnt lgkmcnt(5)
    v_mfma_f32_16x16x32_bf16 v[16:19], v[132:135], v[88:91], v[16:19]
    ds_read_b128 v[88:91], v53 offset:384
    s_waitcnt lgkmcnt(5)
    v_mfma_f32_16x16x32_bf16 v[20:23], v[132:135], v[92:95], v[20:23]
    ds_read_b128 v[92:95], v57 offset:384
    s_waitcnt lgkmcnt(5)
    v_mfma_f32_16x16x32_bf16 v[24:27], v[132:135], v[72:75], v[24:27]
    ds_read_b128 v[72:75], v50 offset:128
    s_waitcnt lgkmcnt(5)
    v_mfma_f32_16x16x32_bf16 v[28:31], v[132:135], v[76:79], v[28:31]
    ds_read_b128 v[76:79], v54 offset:128
    s_waitcnt lgkmcnt(5)
    v_mfma_f32_16x16x32_bf16 v[32:35], v[132:135], v[80:83], v[32:35]
    ds_read_b128 v[80:83], v58 offset:128
    s_waitcnt lgkmcnt(5)
    v_mfma_f32_16x16x32_bf16 v[36:39], v[132:135], v[84:87], v[36:39]
    ds_read_b128 v[84:87], v50 offset:256
    s_waitcnt lgkmcnt(5)
    v_mfma_f32_16x16x32_bf16 v[40:43], v[132:135], v[88:91], v[40:43]
    ds_read_b128 v[88:91], v54 offset:256
    s_waitcnt lgkmcnt(5)
    v_mfma_f32_16x16x32_bf16 v[44:47], v[132:135], v[92:95], v[44:47]
    ds_read_b128 v[92:95], v58 offset:256
    s_waitcnt vmcnt(9) lgkmcnt(5)
    v_mfma_f32_16x16x32_bf16 v[12:15], v[136:139], v[72:75], v[12:15]
    ds_read_b128 v[72:75], v50 offset:384
    s_waitcnt lgkmcnt(5)
    v_mfma_f32_16x16x32_bf16 v[16:19], v[136:139], v[76:79], v[16:19]
    ds_read_b128 v[76:79], v54 offset:384
    s_waitcnt lgkmcnt(5)
    v_mfma_f32_16x16x32_bf16 v[20:23], v[136:139], v[80:83], v[20:23]
    ds_read_b128 v[80:83], v58 offset:384
    s_waitcnt lgkmcnt(5)
    v_mfma_f32_16x16x32_bf16 v[24:27], v[136:139], v[84:87], v[24:27]
    ds_read_b128 v[84:87], v51 offset:128
    s_waitcnt lgkmcnt(5)
    v_mfma_f32_16x16x32_bf16 v[28:31], v[136:139], v[88:91], v[28:31]
    ds_read_b128 v[88:91], v55 offset:128
    s_waitcnt lgkmcnt(5)
    v_mfma_f32_16x16x32_bf16 v[32:35], v[136:139], v[92:95], v[32:35]
    ds_read_b128 v[92:95], v59 offset:128
    s_waitcnt lgkmcnt(5)
    v_mfma_f32_16x16x32_bf16 v[36:39], v[136:139], v[72:75], v[36:39]
    ds_read_b128 v[72:75], v51 offset:256
    s_waitcnt lgkmcnt(5)
    v_mfma_f32_16x16x32_bf16 v[40:43], v[136:139], v[76:79], v[40:43]
    ds_read_b128 v[76:79], v55 offset:256
    s_waitcnt lgkmcnt(5)
    v_mfma_f32_16x16x32_bf16 v[44:47], v[136:139], v[80:83], v[44:47]
    ds_read_b128 v[80:83], v59 offset:256
    s_waitcnt vmcnt(8) lgkmcnt(5)
    v_mfma_f32_16x16x32_bf16 v[12:15], v[140:143], v[84:87], v[12:15]
    ds_read_b128 v[84:87], v51 offset:384
    s_waitcnt lgkmcnt(5)
    v_mfma_f32_16x16x32_bf16 v[16:19], v[140:143], v[88:91], v[16:19]
    ds_read_b128 v[88:91], v55 offset:384
    s_waitcnt lgkmcnt(5)
    v_mfma_f32_16x16x32_bf16 v[20:23], v[140:143], v[92:95], v[20:23]
    ds_read_b128 v[92:95], v59 offset:384
    s_waitcnt lgkmcnt(5)
    v_mfma_f32_16x16x32_bf16 v[24:27], v[140:143], v[72:75], v[24:27]
    ds_read_b128 v[72:75], v48 offset:512
    s_waitcnt lgkmcnt(5)
    v_mfma_f32_16x16x32_bf16 v[28:31], v[140:143], v[76:79], v[28:31]
    ds_read_b128 v[76:79], v52 offset:512
    s_waitcnt lgkmcnt(5)
    v_mfma_f32_16x16x32_bf16 v[32:35], v[140:143], v[80:83], v[32:35]
    ds_read_b128 v[80:83], v56 offset:512
    s_waitcnt lgkmcnt(5)
    v_mfma_f32_16x16x32_bf16 v[36:39], v[140:143], v[84:87], v[36:39]
    ds_read_b128 v[84:87], v48 offset:640
    s_waitcnt lgkmcnt(5)
    v_mfma_f32_16x16x32_bf16 v[40:43], v[140:143], v[88:91], v[40:43]
    ds_read_b128 v[88:91], v52 offset:640
    s_waitcnt lgkmcnt(5)
    v_mfma_f32_16x16x32_bf16 v[44:47], v[140:143], v[92:95], v[44:47]
    ds_read_b128 v[92:95], v56 offset:640
    s_waitcnt vmcnt(7) lgkmcnt(5)
    v_mfma_f32_16x16x32_bf16 v[12:15], v[144:147], v[72:75], v[12:15]
    ds_read_b128 v[72:75], v48 offset:768
    s_waitcnt lgkmcnt(5)
    v_mfma_f32_16x16x32_bf16 v[16:19], v[144:147], v[76:79], v[16:19]
    ds_read_b128 v[76:79], v52 offset:768
    s_waitcnt lgkmcnt(5)
    v_mfma_f32_16x16x32_bf16 v[20:23], v[144:147], v[80:83], v[20:23]
    ds_read_b128 v[80:83], v56 offset:768
    s_waitcnt lgkmcnt(5)
    v_mfma_f32_16x16x32_bf16 v[24:27], v[144:147], v[84:87], v[24:27]
    ds_read_b128 v[84:87], v49 offset:512
    s_waitcnt lgkmcnt(5)
    v_mfma_f32_16x16x32_bf16 v[28:31], v[144:147], v[88:91], v[28:31]
    ds_read_b128 v[88:91], v53 offset:512
    s_waitcnt lgkmcnt(5)
    v_mfma_f32_16x16x32_bf16 v[32:35], v[144:147], v[92:95], v[32:35]
    ds_read_b128 v[92:95], v57 offset:512
    s_waitcnt lgkmcnt(5)
    v_mfma_f32_16x16x32_bf16 v[36:39], v[144:147], v[72:75], v[36:39]
    ds_read_b128 v[72:75], v49 offset:640
    s_waitcnt lgkmcnt(5)
    v_mfma_f32_16x16x32_bf16 v[40:43], v[144:147], v[76:79], v[40:43]
    ds_read_b128 v[76:79], v53 offset:640
    s_waitcnt lgkmcnt(5)
    v_mfma_f32_16x16x32_bf16 v[44:47], v[144:147], v[80:83], v[44:47]
    ds_read_b128 v[80:83], v57 offset:640
    s_waitcnt vmcnt(6) lgkmcnt(5)
    v_mfma_f32_16x16x32_bf16 v[12:15], v[148:151], v[84:87], v[12:15]
    ds_read_b128 v[84:87], v49 offset:768
    s_waitcnt lgkmcnt(5)
    v_mfma_f32_16x16x32_bf16 v[16:19], v[148:151], v[88:91], v[16:19]
    ds_read_b128 v[88:91], v53 offset:768
    s_waitcnt lgkmcnt(5)
    v_mfma_f32_16x16x32_bf16 v[20:23], v[148:151], v[92:95], v[20:23]
    ds_read_b128 v[92:95], v57 offset:768
    s_waitcnt lgkmcnt(5)
    v_mfma_f32_16x16x32_bf16 v[24:27], v[148:151], v[72:75], v[24:27]
    ds_read_b128 v[72:75], v50 offset:512
    s_waitcnt lgkmcnt(5)
    v_mfma_f32_16x16x32_bf16 v[28:31], v[148:151], v[76:79], v[28:31]
    ds_read_b128 v[76:79], v54 offset:512
    s_waitcnt lgkmcnt(5)
    v_mfma_f32_16x16x32_bf16 v[32:35], v[148:151], v[80:83], v[32:35]
    ds_read_b128 v[80:83], v58 offset:512
    s_waitcnt lgkmcnt(5)
    v_mfma_f32_16x16x32_bf16 v[36:39], v[148:151], v[84:87], v[36:39]
    ds_read_b128 v[84:87], v50 offset:640
    s_waitcnt lgkmcnt(5)
    v_mfma_f32_16x16x32_bf16 v[40:43], v[148:151], v[88:91], v[40:43]
    ds_read_b128 v[88:91], v54 offset:640
    s_waitcnt lgkmcnt(5)
    v_mfma_f32_16x16x32_bf16 v[44:47], v[148:151], v[92:95], v[44:47]
    ds_read_b128 v[92:95], v58 offset:640
    s_waitcnt vmcnt(5) lgkmcnt(5)
    v_mfma_f32_16x16x32_bf16 v[12:15], v[152:155], v[72:75], v[12:15]
    ds_read_b128 v[72:75], v50 offset:768
    s_waitcnt lgkmcnt(5)
    v_mfma_f32_16x16x32_bf16 v[16:19], v[152:155], v[76:79], v[16:19]
    ds_read_b128 v[76:79], v54 offset:768
    s_waitcnt lgkmcnt(5)
    v_mfma_f32_16x16x32_bf16 v[20:23], v[152:155], v[80:83], v[20:23]
    ds_read_b128 v[80:83], v58 offset:768
    s_waitcnt lgkmcnt(5)
    v_mfma_f32_16x16x32_bf16 v[24:27], v[152:155], v[84:87], v[24:27]
    ds_read_b128 v[84:87], v51 offset:512
    s_waitcnt lgkmcnt(5)
    v_mfma_f32_16x16x32_bf16 v[28:31], v[152:155], v[88:91], v[28:31]
    ds_read_b128 v[88:91], v55 offset:512
    s_waitcnt lgkmcnt(5)
    v_mfma_f32_16x16x32_bf16 v[32:35], v[152:155], v[92:95], v[32:35]
    ds_read_b128 v[92:95], v59 offset:512
    s_waitcnt lgkmcnt(5)
    v_mfma_f32_16x16x32_bf16 v[36:39], v[152:155], v[72:75], v[36:39]
    ds_read_b128 v[72:75], v51 offset:640
    s_waitcnt lgkmcnt(5)
    v_mfma_f32_16x16x32_bf16 v[40:43], v[152:155], v[76:79], v[40:43]
    ds_read_b128 v[76:79], v55 offset:640
    s_waitcnt lgkmcnt(5)
    v_mfma_f32_16x16x32_bf16 v[44:47], v[152:155], v[80:83], v[44:47]
    ds_read_b128 v[80:83], v59 offset:640
    s_waitcnt vmcnt(4) lgkmcnt(5)
    v_mfma_f32_16x16x32_bf16 v[12:15], v[156:159], v[84:87], v[12:15]
    ds_read_b128 v[84:87], v51 offset:768
    s_waitcnt lgkmcnt(5)
    v_mfma_f32_16x16x32_bf16 v[16:19], v[156:159], v[88:91], v[16:19]
    ds_read_b128 v[88:91], v55 offset:768
    s_waitcnt lgkmcnt(5)
    v_mfma_f32_16x16x32_bf16 v[20:23], v[156:159], v[92:95], v[20:23]
    ds_read_b128 v[92:95], v59 offset:768
    s_waitcnt lgkmcnt(5)
    v_mfma_f32_16x16x32_bf16 v[24:27], v[156:159], v[72:75], v[24:27]
    ds_read_b128 v[72:75], v48 offset:1152
    s_waitcnt lgkmcnt(5)
    v_mfma_f32_16x16x32_bf16 v[28:31], v[156:159], v[76:79], v[28:31]
    ds_read_b128 v[76:79], v52 offset:1152
    s_waitcnt lgkmcnt(5)
    v_mfma_f32_16x16x32_bf16 v[32:35], v[156:159], v[80:83], v[32:35]
    ds_read_b128 v[80:83], v56 offset:1152
    s_waitcnt lgkmcnt(5)
    v_mfma_f32_16x16x32_bf16 v[36:39], v[156:159], v[84:87], v[36:39]
    ds_read_b128 v[84:87], v48 offset:1280
    s_waitcnt lgkmcnt(5)
    v_mfma_f32_16x16x32_bf16 v[40:43], v[156:159], v[88:91], v[40:43]
    ds_read_b128 v[88:91], v52 offset:1280
    s_waitcnt lgkmcnt(5)
    v_mfma_f32_16x16x32_bf16 v[44:47], v[156:159], v[92:95], v[44:47]
    ds_read_b128 v[92:95], v56 offset:1280
    s_waitcnt vmcnt(3) lgkmcnt(5)
    v_mfma_f32_16x16x32_bf16 v[12:15], v[160:163], v[72:75], v[12:15]
    ds_read_b128 v[72:75], v48 offset:896
    s_waitcnt lgkmcnt(5)
    v_mfma_f32_16x16x32_bf16 v[16:19], v[160:163], v[76:79], v[16:19]
    ds_read_b128 v[76:79], v52 offset:896
    s_waitcnt lgkmcnt(5)
    v_mfma_f32_16x16x32_bf16 v[20:23], v[160:163], v[80:83], v[20:23]
    ds_read_b128 v[80:83], v56 offset:896
    s_waitcnt lgkmcnt(5)
    v_mfma_f32_16x16x32_bf16 v[24:27], v[160:163], v[84:87], v[24:27]
    ds_read_b128 v[84:87], v49 offset:1152
    s_waitcnt lgkmcnt(5)
    v_mfma_f32_16x16x32_bf16 v[28:31], v[160:163], v[88:91], v[28:31]
    ds_read_b128 v[88:91], v53 offset:1152
    s_waitcnt lgkmcnt(5)
    v_mfma_f32_16x16x32_bf16 v[32:35], v[160:163], v[92:95], v[32:35]
    ds_read_b128 v[92:95], v57 offset:1152
    s_waitcnt lgkmcnt(5)
    v_mfma_f32_16x16x32_bf16 v[36:39], v[160:163], v[72:75], v[36:39]
    ds_read_b128 v[72:75], v49 offset:1280
    s_waitcnt lgkmcnt(5)
    v_mfma_f32_16x16x32_bf16 v[40:43], v[160:163], v[76:79], v[40:43]
    ds_read_b128 v[76:79], v53 offset:1280
    s_waitcnt lgkmcnt(5)
    v_mfma_f32_16x16x32_bf16 v[44:47], v[160:163], v[80:83], v[44:47]
    ds_read_b128 v[80:83], v57 offset:1280
    s_waitcnt vmcnt(2) lgkmcnt(5)
    v_mfma_f32_16x16x32_bf16 v[12:15], v[164:167], v[84:87], v[12:15]
    ds_read_b128 v[84:87], v49 offset:896
    s_waitcnt lgkmcnt(5)
    v_mfma_f32_16x16x32_bf16 v[16:19], v[164:167], v[88:91], v[16:19]
    ds_read_b128 v[88:91], v53 offset:896
    s_waitcnt lgkmcnt(5)
    v_mfma_f32_16x16x32_bf16 v[20:23], v[164:167], v[92:95], v[20:23]
    ds_read_b128 v[92:95], v57 offset:896
    s_waitcnt lgkmcnt(5)
    v_mfma_f32_16x16x32_bf16 v[24:27], v[164:167], v[72:75], v[24:27]
    ds_read_b128 v[72:75], v50 offset:1152
    s_waitcnt lgkmcnt(5)
    v_mfma_f32_16x16x32_bf16 v[28:31], v[164:167], v[76:79], v[28:31]
    ds_read_b128 v[76:79], v54 offset:1152
    s_waitcnt lgkmcnt(5)
    v_mfma_f32_16x16x32_bf16 v[32:35], v[164:167], v[80:83], v[32:35]
    ds_read_b128 v[80:83], v58 offset:1152
    s_waitcnt lgkmcnt(5)
    v_mfma_f32_16x16x32_bf16 v[36:39], v[164:167], v[84:87], v[36:39]
    ds_read_b128 v[84:87], v50 offset:1280
    s_waitcnt lgkmcnt(5)
    v_mfma_f32_16x16x32_bf16 v[40:43], v[164:167], v[88:91], v[40:43]
    ds_read_b128 v[88:91], v54 offset:1280
    s_waitcnt lgkmcnt(5)
    v_mfma_f32_16x16x32_bf16 v[44:47], v[164:167], v[92:95], v[44:47]
    ds_read_b128 v[92:95], v58 offset:1280
    s_waitcnt vmcnt(1) lgkmcnt(5)
    v_mfma_f32_16x16x32_bf16 v[12:15], v[168:171], v[72:75], v[12:15]
    ds_read_b128 v[72:75], v50 offset:896
    s_waitcnt lgkmcnt(5)
    v_mfma_f32_16x16x32_bf16 v[16:19], v[168:171], v[76:79], v[16:19]
    ds_read_b128 v[76:79], v54 offset:896
    s_waitcnt lgkmcnt(5)
    v_mfma_f32_16x16x32_bf16 v[20:23], v[168:171], v[80:83], v[20:23]
    ds_read_b128 v[80:83], v58 offset:896
    s_waitcnt lgkmcnt(5)
    v_mfma_f32_16x16x32_bf16 v[24:27], v[168:171], v[84:87], v[24:27]
    ds_read_b128 v[84:87], v51 offset:1152
    s_waitcnt lgkmcnt(5)
    v_mfma_f32_16x16x32_bf16 v[28:31], v[168:171], v[88:91], v[28:31]
    ds_read_b128 v[88:91], v55 offset:1152
    s_waitcnt lgkmcnt(5)
    v_mfma_f32_16x16x32_bf16 v[32:35], v[168:171], v[92:95], v[32:35]
    ds_read_b128 v[92:95], v59 offset:1152
    s_waitcnt lgkmcnt(5)
    v_mfma_f32_16x16x32_bf16 v[36:39], v[168:171], v[72:75], v[36:39]
    ds_read_b128 v[72:75], v51 offset:1280
    s_waitcnt lgkmcnt(5)
    v_mfma_f32_16x16x32_bf16 v[40:43], v[168:171], v[76:79], v[40:43]
    ds_read_b128 v[76:79], v55 offset:1280
    s_waitcnt lgkmcnt(5)
    v_mfma_f32_16x16x32_bf16 v[44:47], v[168:171], v[80:83], v[44:47]
    ds_read_b128 v[80:83], v59 offset:1280
    s_waitcnt vmcnt(0) lgkmcnt(5)
    v_mfma_f32_16x16x32_bf16 v[12:15], v[172:175], v[84:87], v[12:15]
    ds_read_b128 v[84:87], v51 offset:896
    s_waitcnt lgkmcnt(5)
    v_mfma_f32_16x16x32_bf16 v[16:19], v[172:175], v[88:91], v[16:19]
    ds_read_b128 v[88:91], v55 offset:896
    s_waitcnt lgkmcnt(5)
    v_mfma_f32_16x16x32_bf16 v[20:23], v[172:175], v[92:95], v[20:23]
    ds_read_b128 v[92:95], v59 offset:896
    s_waitcnt lgkmcnt(5)
    v_mfma_f32_16x16x32_bf16 v[24:27], v[172:175], v[72:75], v[24:27]
    s_waitcnt lgkmcnt(4)
    v_mfma_f32_16x16x32_bf16 v[28:31], v[172:175], v[76:79], v[28:31]
    s_waitcnt lgkmcnt(3)
    v_mfma_f32_16x16x32_bf16 v[32:35], v[172:175], v[80:83], v[32:35]
    s_waitcnt lgkmcnt(2)
    v_mfma_f32_16x16x32_bf16 v[36:39], v[172:175], v[84:87], v[36:39]
    s_waitcnt lgkmcnt(1)
    v_mfma_f32_16x16x32_bf16 v[40:43], v[172:175], v[88:91], v[40:43]
    s_waitcnt lgkmcnt(0)
    v_mfma_f32_16x16x32_bf16 v[44:47], v[172:175], v[92:95], v[44:47]
    s_mov_b32 s66, 0xbfb8aa3b
    v_mul_f32 v72, s66, v0
    v_mul_f32 v73, s66, v1
    v_mul_f32 v74, s66, v2
    v_mul_f32 v75, s66, v3
    v_mul_f32 v76, s66, v4
    v_mul_f32 v77, s66, v5
    v_mul_f32 v78, s66, v6
    v_mul_f32 v79, s66, v7
    v_mul_f32 v80, s66, v8
    v_mul_f32 v81, s66, v9
    v_mul_f32 v82, s66, v10
    v_mul_f32 v83, s66, v11
    v_exp_f32 v72, v72
    v_exp_f32 v73, v73
    v_exp_f32 v74, v74
    v_exp_f32 v75, v75
    v_exp_f32 v76, v76
    v_exp_f32 v77, v77
    v_exp_f32 v78, v78
    v_exp_f32 v79, v79
    v_exp_f32 v80, v80
    v_exp_f32 v81, v81
    v_exp_f32 v82, v82
    v_exp_f32 v83, v83
    v_add_f32 v72, 1.0, v72
    v_add_f32 v73, 1.0, v73
    v_add_f32 v74, 1.0, v74
    v_add_f32 v75, 1.0, v75
    v_add_f32 v76, 1.0, v76
    v_add_f32 v77, 1.0, v77
    v_add_f32 v78, 1.0, v78
    v_add_f32 v79, 1.0, v79
    v_add_f32 v80, 1.0, v80
    v_add_f32 v81, 1.0, v81
    v_add_f32 v82, 1.0, v82
    v_add_f32 v83, 1.0, v83
    v_rcp_f32 v72, v72
    v_rcp_f32 v73, v73
    v_rcp_f32 v74, v74
    v_rcp_f32 v75, v75
    v_rcp_f32 v76, v76
    v_rcp_f32 v77, v77
    v_rcp_f32 v78, v78
    v_rcp_f32 v79, v79
    v_rcp_f32 v80, v80
    v_rcp_f32 v81, v81
    v_rcp_f32 v82, v82
    v_rcp_f32 v83, v83
    s_mul_i32 s66, s2, 40960
    s_lshl_b32 s67, s20, 5
    s_add_u32 s66, s66, s67
    v_lshlrev_b32 v188, 10, v177
    v_lshl_add_u32 v188, v178, 3, v188
    v_add_u32 v189, 0x4000, v188
    v_add_u32 v190, 0x8000, v188
    v_mov_b32 v191, 0x7f000000
    v_cmp_gt_u32 vcc, 8, v177
    v_mul_f32 v12, v12, v72
    v_mul_f32 v13, v13, v73
    v_mul_f32 v14, v14, v74
    v_mul_f32 v15, v15, v75
    v_mul_f32 v16, v16, v76
    v_mul_f32 v17, v17, v77
    v_mul_f32 v18, v18, v78
    v_mul_f32 v19, v19, v79
    v_mul_f32 v20, v20, v80
    v_mul_f32 v21, v21, v81
    v_mul_f32 v22, v22, v82
    v_mul_f32 v23, v23, v83
    v_mul_f32 v24, v24, v72
    v_mul_f32 v25, v25, v73
    v_mul_f32 v26, v26, v74
    v_mul_f32 v27, v27, v75
    v_mul_f32 v28, v28, v76
    v_mul_f32 v29, v29, v77
    v_mul_f32 v30, v30, v78
    v_mul_f32 v31, v31, v79
    v_mul_f32 v32, v32, v80
    v_mul_f32 v33, v33, v81
    v_mul_f32 v34, v34, v82
    v_mul_f32 v35, v35, v83
    v_mul_f32 v36, v36, v72
    v_mul_f32 v37, v37, v73
    v_mul_f32 v38, v38, v74
    v_mul_f32 v39, v39, v75
    v_mul_f32 v40, v40, v76
    v_mul_f32 v41, v41, v77
    v_mul_f32 v42, v42, v78
    v_mul_f32 v43, v43, v79
    v_mul_f32 v44, v44, v80
    v_mul_f32 v45, v45, v81
    v_mul_f32 v46, v46, v82
    v_mul_f32 v47, v47, v83
    v_cndmask_b32 v190, v191, v190, vcc
    v_cvt_pk_bf16_f32 v0, v0, v1
    v_cvt_pk_bf16_f32 v1, v2, v3
    buffer_store_dwordx2 v[0:1], v188, s[4:7], s66 offen offset:0
    v_cvt_pk_bf16_f32 v4, v4, v5
    v_cvt_pk_bf16_f32 v5, v6, v7
    buffer_store_dwordx2 v[4:5], v189, s[4:7], s66 offen offset:0
    v_cvt_pk_bf16_f32 v8, v8, v9
    v_cvt_pk_bf16_f32 v9, v10, v11
    buffer_store_dwordx2 v[8:9], v190, s[4:7], s66 offen offset:0
    v_cvt_pk_bf16_f32 v12, v12, v13
    v_cvt_pk_bf16_f32 v13, v14, v15
    buffer_store_dwordx2 v[12:13], v188, s[4:7], s66 offen offset:256
    v_cvt_pk_bf16_f32 v16, v16, v17
    v_cvt_pk_bf16_f32 v17, v18, v19
    buffer_store_dwordx2 v[16:17], v189, s[4:7], s66 offen offset:256
    v_cvt_pk_bf16_f32 v20, v20, v21
    v_cvt_pk_bf16_f32 v21, v22, v23
    buffer_store_dwordx2 v[20:21], v190, s[4:7], s66 offen offset:256
    v_cvt_pk_bf16_f32 v24, v24, v25
    v_cvt_pk_bf16_f32 v25, v26, v27
    buffer_store_dwordx2 v[24:25], v188, s[4:7], s66 offen offset:512
    v_cvt_pk_bf16_f32 v28, v28, v29
    v_cvt_pk_bf16_f32 v29, v30, v31
    buffer_store_dwordx2 v[28:29], v189, s[4:7], s66 offen offset:512
    v_cvt_pk_bf16_f32 v32, v32, v33
    v_cvt_pk_bf16_f32 v33, v34, v35
    buffer_store_dwordx2 v[32:33], v190, s[4:7], s66 offen offset:512
    v_cvt_pk_bf16_f32 v36, v36, v37
    v_cvt_pk_bf16_f32 v37, v38, v39
    buffer_store_dwordx2 v[36:37], v188, s[4:7], s66 offen offset:768
    v_cvt_pk_bf16_f32 v40, v40, v41
    v_cvt_pk_bf16_f32 v41, v42, v43
    buffer_store_dwordx2 v[40:41], v189, s[4:7], s66 offen offset:768
    v_cvt_pk_bf16_f32 v44, v44, v45
    v_cvt_pk_bf16_f32 v45, v46, v47
    buffer_store_dwordx2 v[44:45], v190, s[4:7], s66 offen offset:768
K2_end:
K2_last:
    s_endpgm
SLOW:
    s_waitcnt vmcnt(0) lgkmcnt(0)
    s_barrier
    s_load_dwordx2 s[22:23], s[0:1], 8
    s_load_dwordx2 s[24:25], s[0:1], 24
    s_load_dwordx2 s[26:27], s[0:1], 32
    s_load_dwordx2 s[28:29], s[0:1], 40
    s_load_dwordx2 s[30:31], s[0:1], 0
    v_mbcnt_lo_u32_b32 v240, -1, 0
    v_mbcnt_hi_u32_b32 v240, -1, v240
    v_lshrrev_b32 v229, 5, v240
    v_and_b32 v230, 31, v240
    v_lshlrev_b32 v241, 7, v229
    v_lshl_add_u32 v241, v230, 1, v241
    v_lshlrev_b32 v245, 4, v240
    v_mov_b32 v242, 0
    s_waitcnt lgkmcnt(0)
    s_mov_b32 s80, s22
    s_and_b32 s81, s23, 0xffff
    s_mov_b32 s82, 1920000
    s_mov_b32 s83, 0x20000
    s_mov_b32 s76, s24
    s_and_b32 s77, s25, 0xffff
    s_mov_b32 s78, 1280000
    s_mov_b32 s79, 0x20000
    s_mov_b32 s72, s26
    s_and_b32 s73, s27, 0xffff
    s_mov_b32 s74, 1280000
    s_mov_b32 s75, 0x20000
    s_mov_b32 s84, s28
    s_and_b32 s85, s29, 0xffff
    s_mov_b32 s86, 20480
    s_mov_b32 s87, 0x20000
    s_mov_b32 s4, s30
    s_and_b32 s5, s31, 0xffff
    s_mov_b32 s6, 10240000
    s_mov_b32 s7, 0x20000
    s_mov_b32 s66, 0
    buffer_load_ushort v0, v241, s[84:87], s66 offen offset:0
    buffer_load_ushort v1, v241, s[84:87], s66 offen offset:64
    buffer_load_ushort v2, v241, s[84:87], s66 offen offset:256
    buffer_load_ushort v3, v241, s[84:87], s66 offen offset:320
    buffer_load_ushort v4, v241, s[84:87], s66 offen offset:512
    buffer_load_ushort v5, v241, s[84:87], s66 offen offset:576
    buffer_load_ushort v6, v241, s[84:87], s66 offen offset:768
    buffer_load_ushort v7, v241, s[84:87], s66 offen offset:832
    buffer_load_ushort v8, v241, s[84:87], s66 offen offset:1024
    buffer_load_ushort v9, v241, s[84:87], s66 offen offset:1088
    s_waitcnt vmcnt(0)
    s_mov_b32 s66, 1280
    buffer_load_ushort v10, v241, s[84:87], s66 offen offset:0
    buffer_load_ushort v11, v241, s[84:87], s66 offen offset:64
    buffer_load_ushort v12, v241, s[84:87], s66 offen offset:256
    buffer_load_ushort v13, v241, s[84:87], s66 offen offset:320
    buffer_load_ushort v14, v241, s[84:87], s66 offen offset:512
    buffer_load_ushort v15, v241, s[84:87], s66 offen offset:576
    buffer_load_ushort v16, v241, s[84:87], s66 offen offset:768
    buffer_load_ushort v17, v241, s[84:87], s66 offen offset:832
    buffer_load_ushort v18, v241, s[84:87], s66 offen offset:1024
    buffer_load_ushort v19, v241, s[84:87], s66 offen offset:1088
    s_waitcnt vmcnt(0)
    s_mov_b32 s66, 2560
    buffer_load_ushort v20, v241, s[84:87], s66 offen offset:0
    buffer_load_ushort v21, v241, s[84:87], s66 offen offset:64
    buffer_load_ushort v22, v241, s[84:87], s66 offen offset:256
    buffer_load_ushort v23, v241, s[84:87], s66 offen offset:320
    buffer_load_ushort v24, v241, s[84:87], s66 offen offset:512
    buffer_load_ushort v25, v241, s[84:87], s66 offen offset:576
    buffer_load_ushort v26, v241, s[84:87], s66 offen offset:768
    buffer_load_ushort v27, v241, s[84:87], s66 offen offset:832
    buffer_load_ushort v28, v241, s[84:87], s66 offen offset:1024
    buffer_load_ushort v29, v241, s[84:87], s66 offen offset:1088
    s_waitcnt vmcnt(0)
    s_mov_b32 s66, 3840
    buffer_load_ushort v30, v241, s[84:87], s66 offen offset:0
    buffer_load_ushort v31, v241, s[84:87], s66 offen offset:64
    buffer_load_ushort v32, v241, s[84:87], s66 offen offset:256
    buffer_load_ushort v33, v241, s[84:87], s66 offen offset:320
    buffer_load_ushort v34, v241, s[84:87], s66 offen offset:512
    buffer_load_ushort v35, v241, s[84:87], s66 offen offset:576
    buffer_load_ushort v36, v241, s[84:87], s66 offen offset:768
    buffer_load_ushort v37, v241, s[84:87], s66 offen offset:832
    buffer_load_ushort v38, v241, s[84:87], s66 offen offset:1024
    buffer_load_ushort v39, v241, s[84:87], s66 offen offset:1088
    s_waitcnt vmcnt(0)
    s_mov_b32 s66, 5120
    buffer_load_ushort v40, v241, s[84:87], s66 offen offset:0
    buffer_load_ushort v41, v241, s[84:87], s66 offen offset:64
    buffer_load_ushort v42, v241, s[84:87], s66 offen offset:256
    buffer_load_ushort v43, v241, s[84:87], s66 offen offset:320
    buffer_load_ushort v44, v241, s[84:87], s66 offen offset:512
    buffer_load_ushort v45, v241, s[84:87], s66 offen offset:576
    buffer_load_ushort v46, v241, s[84:87], s66 offen offset:768
    buffer_load_ushort v47, v241, s[84:87], s66 offen offset:832
    buffer_load_ushort v48, v241, s[84:87], s66 offen offset:1024
    buffer_load_ushort v49, v241, s[84:87], s66 offen offset:1088
    s_waitcnt vmcnt(0)
    s_mov_b32 s66, 6400
    buffer_load_ushort v50, v241, s[84:87], s66 offen offset:0
    buffer_load_ushort v51, v241, s[84:87], s66 offen offset:64
    buffer_load_ushort v52, v241, s[84:87], s66 offen offset:256
    buffer_load_ushort v53, v241, s[84:87], s66 offen offset:320
    buffer_load_ushort v54, v241, s[84:87], s66 offen offset:512
    buffer_load_ushort v55, v241, s[84:87], s66 offen offset:576
    buffer_load_ushort v56, v241, s[84:87], s66 offen offset:768
    buffer_load_ushort v57, v241, s[84:87], s66 offen offset:832
    buffer_load_ushort v58, v241, s[84:87], s66 offen offset:1024
    buffer_load_ushort v59, v241, s[84:87], s66 offen offset:1088
    s_waitcnt vmcnt(0)
    s_mov_b32 s66, 7680
    buffer_load_ushort v60, v241, s[84:87], s66 offen offset:0
    buffer_load_ushort v61, v241, s[84:87], s66 offen offset:64
    buffer_load_ushort v62, v241, s[84:87], s66 offen offset:256
    buffer_load_ushort v63, v241, s[84:87], s66 offen offset:320
    buffer_load_ushort v64, v241, s[84:87], s66 offen offset:512
    buffer_load_ushort v65, v241, s[84:87], s66 offen offset:576
    buffer_load_ushort v66, v241, s[84:87], s66 offen offset:768
    buffer_load_ushort v67, v241, s[84:87], s66 offen offset:832
    buffer_load_ushort v68, v241, s[84:87], s66 offen offset:1024
    buffer_load_ushort v69, v241, s[84:87], s66 offen offset:1088
    s_waitcnt vmcnt(0)
    s_mov_b32 s66, 8960
    buffer_load_ushort v70, v241, s[84:87], s66 offen offset:0
    buffer_load_ushort v71, v241, s[84:87], s66 offen offset:64
    buffer_load_ushort v72, v241, s[84:87], s66 offen offset:256
    buffer_load_ushort v73, v241, s[84:87], s66 offen offset:320
    buffer_load_ushort v74, v241, s[84:87], s66 offen offset:512
    buffer_load_ushort v75, v241, s[84:87], s66 offen offset:576
    buffer_load_ushort v76, v241, s[84:87], s66 offen offset:768
    buffer_load_ushort v77, v241, s[84:87], s66 offen offset:832
    buffer_load_ushort v78, v241, s[84:87], s66 offen offset:1024
    buffer_load_ushort v79, v241, s[84:87], s66 offen offset:1088
    s_waitcnt vmcnt(0)
    s_mov_b32 s66, 10240
    buffer_load_ushort v80, v241, s[84:87], s66 offen offset:0
    buffer_load_ushort v81, v241, s[84:87], s66 offen offset:64
    buffer_load_ushort v82, v241, s[84:87], s66 offen offset:256
    buffer_load_ushort v83, v241, s[84:87], s66 offen offset:320
    buffer_load_ushort v84, v241, s[84:87], s66 offen offset:512
    buffer_load_ushort v85, v241, s[84:87], s66 offen offset:576
    buffer_load_ushort v86, v241, s[84:87], s66 offen offset:768
    buffer_load_ushort v87, v241, s[84:87], s66 offen offset:832
    buffer_load_ushort v88, v241, s[84:87], s66 offen offset:1024
    buffer_load_ushort v89, v241, s[84:87], s66 offen offset:1088
    s_waitcnt vmcnt(0)
    s_mov_b32 s66, 11520
    buffer_load_ushort v90, v241, s[84:87], s66 offen offset:0
    buffer_load_ushort v91, v241, s[84:87], s66 offen offset:64
    buffer_load_ushort v92, v241, s[84:87], s66 offen offset:256
    buffer_load_ushort v93, v241, s[84:87], s66 offen offset:320
    buffer_load_ushort v94, v241, s[84:87], s66 offen offset:512
    buffer_load_ushort v95, v241, s[84:87], s66 offen offset:576
    buffer_load_ushort v96, v241, s[84:87], s66 offen offset:768
    buffer_load_ushort v97, v241, s[84:87], s66 offen offset:832
    buffer_load_ushort v98, v241, s[84:87], s66 offen offset:1024
    buffer_load_ushort v99, v241, s[84:87], s66 offen offset:1088
    s_waitcnt vmcnt(0)
    s_mov_b32 s66, 12800
    buffer_load_ushort v100, v241, s[84:87], s66 offen offset:0
    buffer_load_ushort v101, v241, s[84:87], s66 offen offset:64
    buffer_load_ushort v102, v241, s[84:87], s66 offen offset:256
    buffer_load_ushort v103, v241, s[84:87], s66 offen offset:320
    buffer_load_ushort v104, v241, s[84:87], s66 offen offset:512
    buffer_load_ushort v105, v241, s[84:87], s66 offen offset:576
    buffer_load_ushort v106, v241, s[84:87], s66 offen offset:768
    buffer_load_ushort v107, v241, s[84:87], s66 offen offset:832
    buffer_load_ushort v108, v241, s[84:87], s66 offen offset:1024
    buffer_load_ushort v109, v241, s[84:87], s66 offen offset:1088
    s_waitcnt vmcnt(0)
    s_mov_b32 s66, 14080
    buffer_load_ushort v110, v241, s[84:87], s66 offen offset:0
    buffer_load_ushort v111, v241, s[84:87], s66 offen offset:64
    buffer_load_ushort v112, v241, s[84:87], s66 offen offset:256
    buffer_load_ushort v113, v241, s[84:87], s66 offen offset:320
    buffer_load_ushort v114, v241, s[84:87], s66 offen offset:512
    buffer_load_ushort v115, v241, s[84:87], s66 offen offset:576
    buffer_load_ushort v116, v241, s[84:87], s66 offen offset:768
    buffer_load_ushort v117, v241, s[84:87], s66 offen offset:832
    buffer_load_ushort v118, v241, s[84:87], s66 offen offset:1024
    buffer_load_ushort v119, v241, s[84:87], s66 offen offset:1088
    s_waitcnt vmcnt(0)
    s_mov_b32 s66, 15360
    buffer_load_ushort v120, v241, s[84:87], s66 offen offset:0
    buffer_load_ushort v121, v241, s[84:87], s66 offen offset:64
    buffer_load_ushort v122, v241, s[84:87], s66 offen offset:256
    buffer_load_ushort v123, v241, s[84:87], s66 offen offset:320
    buffer_load_ushort v124, v241, s[84:87], s66 offen offset:512
    buffer_load_ushort v125, v241, s[84:87], s66 offen offset:576
    buffer_load_ushort v126, v241, s[84:87], s66 offen offset:768
    buffer_load_ushort v127, v241, s[84:87], s66 offen offset:832
    buffer_load_ushort v128, v241, s[84:87], s66 offen offset:1024
    buffer_load_ushort v129, v241, s[84:87], s66 offen offset:1088
    s_waitcnt vmcnt(0)
    s_mov_b32 s66, 16640
    buffer_load_ushort v130, v241, s[84:87], s66 offen offset:0
    buffer_load_ushort v131, v241, s[84:87], s66 offen offset:64
    buffer_load_ushort v132, v241, s[84:87], s66 offen offset:256
    buffer_load_ushort v133, v241, s[84:87], s66 offen offset:320
    buffer_load_ushort v134, v241, s[84:87], s66 offen offset:512
    buffer_load_ushort v135, v241, s[84:87], s66 offen offset:576
    buffer_load_ushort v136, v241, s[84:87], s66 offen offset:768
    buffer_load_ushort v137, v241, s[84:87], s66 offen offset:832
    buffer_load_ushort v138, v241, s[84:87], s66 offen offset:1024
    buffer_load_ushort v139, v241, s[84:87], s66 offen offset:1088
    s_waitcnt vmcnt(0)
    s_mov_b32 s66, 17920
    buffer_load_ushort v140, v241, s[84:87], s66 offen offset:0
    buffer_load_ushort v141, v241, s[84:87], s66 offen offset:64
    buffer_load_ushort v142, v241, s[84:87], s66 offen offset:256
    buffer_load_ushort v143, v241, s[84:87], s66 offen offset:320
    buffer_load_ushort v144, v241, s[84:87], s66 offen offset:512
    buffer_load_ushort v145, v241, s[84:87], s66 offen offset:576
    buffer_load_ushort v146, v241, s[84:87], s66 offen offset:768
    buffer_load_ushort v147, v241, s[84:87], s66 offen offset:832
    buffer_load_ushort v148, v241, s[84:87], s66 offen offset:1024
    buffer_load_ushort v149, v241, s[84:87], s66 offen offset:1088
    s_waitcnt vmcnt(0)
    s_mov_b32 s66, 19200
    buffer_load_ushort v150, v241, s[84:87], s66 offen offset:0
    buffer_load_ushort v151, v241, s[84:87], s66 offen offset:64
    buffer_load_ushort v152, v241, s[84:87], s66 offen offset:256
    buffer_load_ushort v153, v241, s[84:87], s66 offen offset:320
    buffer_load_ushort v154, v241, s[84:87], s66 offen offset:512
    buffer_load_ushort v155, v241, s[84:87], s66 offen offset:576
    buffer_load_ushort v156, v241, s[84:87], s66 offen offset:768
    buffer_load_ushort v157, v241, s[84:87], s66 offen offset:832
    buffer_load_ushort v158, v241, s[84:87], s66 offen offset:1024
    buffer_load_ushort v159, v241, s[84:87], s66 offen offset:1088
    s_waitcnt vmcnt(0)
    v_lshlrev_b32 v0, 16, v0
    v_lshlrev_b32 v1, 16, v1
    v_lshlrev_b32 v2, 16, v2
    v_lshlrev_b32 v3, 16, v3
    v_lshlrev_b32 v4, 16, v4
    v_lshlrev_b32 v5, 16, v5
    v_lshlrev_b32 v6, 16, v6
    v_lshlrev_b32 v7, 16, v7
    v_lshlrev_b32 v8, 16, v8
    v_lshlrev_b32 v9, 16, v9
    v_lshlrev_b32 v10, 16, v10
    v_lshlrev_b32 v11, 16, v11
    v_lshlrev_b32 v12, 16, v12
    v_lshlrev_b32 v13, 16, v13
    v_lshlrev_b32 v14, 16, v14
    v_lshlrev_b32 v15, 16, v15
    v_lshlrev_b32 v16, 16, v16
    v_lshlrev_b32 v17, 16, v17
    v_lshlrev_b32 v18, 16, v18
    v_lshlrev_b32 v19, 16, v19
    v_lshlrev_b32 v20, 16, v20
    v_lshlrev_b32 v21, 16, v21
    v_lshlrev_b32 v22, 16, v22
    v_lshlrev_b32 v23, 16, v23
    v_lshlrev_b32 v24, 16, v24
    v_lshlrev_b32 v25, 16, v25
    v_lshlrev_b32 v26, 16, v26
    v_lshlrev_b32 v27, 16, v27
    v_lshlrev_b32 v28, 16, v28
    v_lshlrev_b32 v29, 16, v29
    v_lshlrev_b32 v30, 16, v30
    v_lshlrev_b32 v31, 16, v31
    v_lshlrev_b32 v32, 16, v32
    v_lshlrev_b32 v33, 16, v33
    v_lshlrev_b32 v34, 16, v34
    v_lshlrev_b32 v35, 16, v35
    v_lshlrev_b32 v36, 16, v36
    v_lshlrev_b32 v37, 16, v37
    v_lshlrev_b32 v38, 16, v38
    v_lshlrev_b32 v39, 16, v39
    v_lshlrev_b32 v40, 16, v40
    v_lshlrev_b32 v41, 16, v41
    v_lshlrev_b32 v42, 16, v42
    v_lshlrev_b32 v43, 16, v43
    v_lshlrev_b32 v44, 16, v44
    v_lshlrev_b32 v45, 16, v45
    v_lshlrev_b32 v46, 16, v46
    v_lshlrev_b32 v47, 16, v47
    v_lshlrev_b32 v48, 16, v48
    v_lshlrev_b32 v49, 16, v49
    v_lshlrev_b32 v50, 16, v50
    v_lshlrev_b32 v51, 16, v51
    v_lshlrev_b32 v52, 16, v52
    v_lshlrev_b32 v53, 16, v53
    v_lshlrev_b32 v54, 16, v54
    v_lshlrev_b32 v55, 16, v55
    v_lshlrev_b32 v56, 16, v56
    v_lshlrev_b32 v57, 16, v57
    v_lshlrev_b32 v58, 16, v58
    v_lshlrev_b32 v59, 16, v59
    v_lshlrev_b32 v60, 16, v60
    v_lshlrev_b32 v61, 16, v61
    v_lshlrev_b32 v62, 16, v62
    v_lshlrev_b32 v63, 16, v63
    v_lshlrev_b32 v64, 16, v64
    v_lshlrev_b32 v65, 16, v65
    v_lshlrev_b32 v66, 16, v66
    v_lshlrev_b32 v67, 16, v67
    v_lshlrev_b32 v68, 16, v68
    v_lshlrev_b32 v69, 16, v69
    v_lshlrev_b32 v70, 16, v70
    v_lshlrev_b32 v71, 16, v71
    v_lshlrev_b32 v72, 16, v72
    v_lshlrev_b32 v73, 16, v73
    v_lshlrev_b32 v74, 16, v74
    v_lshlrev_b32 v75, 16, v75
    v_lshlrev_b32 v76, 16, v76
    v_lshlrev_b32 v77, 16, v77
    v_lshlrev_b32 v78, 16, v78
    v_lshlrev_b32 v79, 16, v79
    v_lshlrev_b32 v80, 16, v80
    v_lshlrev_b32 v81, 16, v81
    v_lshlrev_b32 v82, 16, v82
    v_lshlrev_b32 v83, 16, v83
    v_lshlrev_b32 v84, 16, v84
    v_lshlrev_b32 v85, 16, v85
    v_lshlrev_b32 v86, 16, v86
    v_lshlrev_b32 v87, 16, v87
    v_lshlrev_b32 v88, 16, v88
    v_lshlrev_b32 v89, 16, v89
    v_lshlrev_b32 v90, 16, v90
    v_lshlrev_b32 v91, 16, v91
    v_lshlrev_b32 v92, 16, v92
    v_lshlrev_b32 v93, 16, v93
    v_lshlrev_b32 v94, 16, v94
    v_lshlrev_b32 v95, 16, v95
    v_lshlrev_b32 v96, 16, v96
    v_lshlrev_b32 v97, 16, v97
    v_lshlrev_b32 v98, 16, v98
    v_lshlrev_b32 v99, 16, v99
    v_lshlrev_b32 v100, 16, v100
    v_lshlrev_b32 v101, 16, v101
    v_lshlrev_b32 v102, 16, v102
    v_lshlrev_b32 v103, 16, v103
    v_lshlrev_b32 v104, 16, v104
    v_lshlrev_b32 v105, 16, v105
    v_lshlrev_b32 v106, 16, v106
    v_lshlrev_b32 v107, 16, v107
    v_lshlrev_b32 v108, 16, v108
    v_lshlrev_b32 v109, 16, v109
    v_lshlrev_b32 v110, 16, v110
    v_lshlrev_b32 v111, 16, v111
    v_lshlrev_b32 v112, 16, v112
    v_lshlrev_b32 v113, 16, v113
    v_lshlrev_b32 v114, 16, v114
    v_lshlrev_b32 v115, 16, v115
    v_lshlrev_b32 v116, 16, v116
    v_lshlrev_b32 v117, 16, v117
    v_lshlrev_b32 v118, 16, v118
    v_lshlrev_b32 v119, 16, v119
    v_lshlrev_b32 v120, 16, v120
    v_lshlrev_b32 v121, 16, v121
    v_lshlrev_b32 v122, 16, v122
    v_lshlrev_b32 v123, 16, v123
    v_lshlrev_b32 v124, 16, v124
    v_lshlrev_b32 v125, 16, v125
    v_lshlrev_b32 v126, 16, v126
    v_lshlrev_b32 v127, 16, v127
    v_lshlrev_b32 v128, 16, v128
    v_lshlrev_b32 v129, 16, v129
    v_lshlrev_b32 v130, 16, v130
    v_lshlrev_b32 v131, 16, v131
    v_lshlrev_b32 v132, 16, v132
    v_lshlrev_b32 v133, 16, v133
    v_lshlrev_b32 v134, 16, v134
    v_lshlrev_b32 v135, 16, v135
    v_lshlrev_b32 v136, 16, v136
    v_lshlrev_b32 v137, 16, v137
    v_lshlrev_b32 v138, 16, v138
    v_lshlrev_b32 v139, 16, v139
    v_lshlrev_b32 v140, 16, v140
    v_lshlrev_b32 v141, 16, v141
    v_lshlrev_b32 v142, 16, v142
    v_lshlrev_b32 v143, 16, v143
    v_lshlrev_b32 v144, 16, v144
    v_lshlrev_b32 v145, 16, v145
    v_lshlrev_b32 v146, 16, v146
    v_lshlrev_b32 v147, 16, v147
    v_lshlrev_b32 v148, 16, v148
    v_lshlrev_b32 v149, 16, v149
    v_lshlrev_b32 v150, 16, v150
    v_lshlrev_b32 v151, 16, v151
    v_lshlrev_b32 v152, 16, v152
    v_lshlrev_b32 v153, 16, v153
    v_lshlrev_b32 v154, 16, v154
    v_lshlrev_b32 v155, 16, v155
    v_lshlrev_b32 v156, 16, v156
    v_lshlrev_b32 v157, 16, v157
    v_lshlrev_b32 v158, 16, v158
    v_lshlrev_b32 v159, 16, v159
    s_mov_b32 s50, 0
SL_node:
    s_mul_i32 s34, s2, 40
    s_mul_i32 s66, s20, 5
    s_add_u32 s66, s66, s50
    s_add_u32 s34, s34, s66
    v_mov_b32 v160, 0
    v_mov_b32 v161, 0
    v_mov_b32 v162, 0
    v_mov_b32 v163, 0
    v_mov_b32 v164, 0
    v_mov_b32 v165, 0
    v_mov_b32 v166, 0
    v_mov_b32 v167, 0
    v_mov_b32 v168, 0
    v_mov_b32 v169, 0
    v_mov_b32 v170, 0
    v_mov_b32 v171, 0
    v_mov_b32 v172, 0
    v_mov_b32 v173, 0
    v_mov_b32 v174, 0
    v_mov_b32 v175, 0
    v_mov_b32 v176, 0
    v_mov_b32 v177, 0
    v_mov_b32 v178, 0
    v_mov_b32 v179, 0
    v_mov_b32 v180, 0
    v_mov_b32 v181, 0
    s_mov_b32 s35, 0
SL_scan:
    s_lshl_b32 s66, s35, 2
    buffer_load_dwordx4 v[236:239], v245, s[72:75], s66 offen
    s_waitcnt vmcnt(0)
    v_cmp_eq_u32 s[38:39], s34, v236
    v_cmp_eq_u32 s[40:41], s34, v237
    v_cmp_eq_u32 s[42:43], s34, v238
    v_cmp_eq_u32 s[44:45], s34, v239
    s_mov_b32 s36, 0
SL_bits:
    s_cmp_eq_u64 s[38:39], 0
    s_cbranch_scc1 SL_nexti
    s_ff1_i32_b64 s66, s[38:39]
    s_bitset0_b64 s[38:39], s66
    s_lshl_b32 s66, s66, 2
    s_add_u32 s37, s66, s36
    s_add_u32 s37, s37, s35
    s_lshl_b32 s66, s37, 2
    s_lshl_b32 s67, s37, 5
    s_mul_i32 s68, s37, 6
    buffer_load_dword v243, v242, s[76:79], s66 offen
    buffer_load_dwordx4 v[184:187], v242, s[12:15], s67 offen
    buffer_load_dwordx4 v[188:191], v242, s[12:15], s67 offen offset:16
    buffer_load_ushort v226, v242, s[80:83], s68 offen offset:0
    buffer_load_ushort v227, v242, s[80:83], s68 offen offset:2
    buffer_load_ushort v228, v242, s[80:83], s68 offen offset:4
    s_waitcnt vmcnt(5)
    v_lshl_add_u32 v243, v243, 10, v241
    buffer_load_ushort v208, v243, s[4:7], 0 offen offset:0
    buffer_load_ushort v209, v243, s[4:7], 0 offen offset:64
    buffer_load_ushort v210, v243, s[4:7], 0 offen offset:256
    buffer_load_ushort v211, v243, s[4:7], 0 offen offset:320
    buffer_load_ushort v212, v243, s[4:7], 0 offen offset:512
    buffer_load_ushort v213, v243, s[4:7], 0 offen offset:576
    buffer_load_ushort v214, v243, s[4:7], 0 offen offset:768
    buffer_load_ushort v215, v243, s[4:7], 0 offen offset:832
    s_waitcnt vmcnt(8)
    v_lshlrev_b32 v192, 16, v184
    v_and_b32 v193, 0xffff0000, v184
    v_lshlrev_b32 v194, 16, v185
    v_and_b32 v195, 0xffff0000, v185
    v_lshlrev_b32 v196, 16, v186
    v_and_b32 v197, 0xffff0000, v186
    v_lshlrev_b32 v198, 16, v187
    v_and_b32 v199, 0xffff0000, v187
    v_lshlrev_b32 v200, 16, v188
    v_and_b32 v201, 0xffff0000, v188
    v_lshlrev_b32 v202, 16, v189
    v_and_b32 v203, 0xffff0000, v189
    v_lshlrev_b32 v204, 16, v190
    v_and_b32 v205, 0xffff0000, v190
    v_lshlrev_b32 v206, 16, v191
    v_and_b32 v207, 0xffff0000, v191
    v_lshlrev_b32 v226, 16, v226
    v_lshlrev_b32 v227, 16, v227
    v_lshlrev_b32 v228, 16, v228
    v_mul_f32 v216, v192, v0
    v_mul_f32 v217, v192, v1
    v_mul_f32 v218, v192, v2
    v_mul_f32 v219, v192, v3
    v_mul_f32 v220, v192, v4
    v_mul_f32 v221, v192, v5
    v_mul_f32 v222, v192, v6
    v_mul_f32 v223, v192, v7
    v_mul_f32 v224, v192, v8
    v_mul_f32 v225, v192, v9
    v_fmac_f32 v216, v193, v10
    v_fmac_f32 v217, v193, v11
    v_fmac_f32 v218, v193, v12
    v_fmac_f32 v219, v193, v13
    v_fmac_f32 v220, v193, v14
    v_fmac_f32 v221, v193, v15
    v_fmac_f32 v222, v193, v16
    v_fmac_f32 v223, v193, v17
    v_fmac_f32 v224, v193, v18
    v_fmac_f32 v225, v193, v19
    v_fmac_f32 v216, v194, v20
    v_fmac_f32 v217, v194, v21
    v_fmac_f32 v218, v194, v22
    v_fmac_f32 v219, v194, v23
    v_fmac_f32 v220, v194, v24
    v_fmac_f32 v221, v194, v25
    v_fmac_f32 v222, v194, v26
    v_fmac_f32 v223, v194, v27
    v_fmac_f32 v224, v194, v28
    v_fmac_f32 v225, v194, v29
    v_fmac_f32 v216, v195, v30
    v_fmac_f32 v217, v195, v31
    v_fmac_f32 v218, v195, v32
    v_fmac_f32 v219, v195, v33
    v_fmac_f32 v220, v195, v34
    v_fmac_f32 v221, v195, v35
    v_fmac_f32 v222, v195, v36
    v_fmac_f32 v223, v195, v37
    v_fmac_f32 v224, v195, v38
    v_fmac_f32 v225, v195, v39
    v_fmac_f32 v216, v196, v40
    v_fmac_f32 v217, v196, v41
    v_fmac_f32 v218, v196, v42
    v_fmac_f32 v219, v196, v43
    v_fmac_f32 v220, v196, v44
    v_fmac_f32 v221, v196, v45
    v_fmac_f32 v222, v196, v46
    v_fmac_f32 v223, v196, v47
    v_fmac_f32 v224, v196, v48
    v_fmac_f32 v225, v196, v49
    v_fmac_f32 v216, v197, v50
    v_fmac_f32 v217, v197, v51
    v_fmac_f32 v218, v197, v52
    v_fmac_f32 v219, v197, v53
    v_fmac_f32 v220, v197, v54
    v_fmac_f32 v221, v197, v55
    v_fmac_f32 v222, v197, v56
    v_fmac_f32 v223, v197, v57
    v_fmac_f32 v224, v197, v58
    v_fmac_f32 v225, v197, v59
    v_fmac_f32 v216, v198, v60
    v_fmac_f32 v217, v198, v61
    v_fmac_f32 v218, v198, v62
    v_fmac_f32 v219, v198, v63
    v_fmac_f32 v220, v198, v64
    v_fmac_f32 v221, v198, v65
    v_fmac_f32 v222, v198, v66
    v_fmac_f32 v223, v198, v67
    v_fmac_f32 v224, v198, v68
    v_fmac_f32 v225, v198, v69
    v_fmac_f32 v216, v199, v70
    v_fmac_f32 v217, v199, v71
    v_fmac_f32 v218, v199, v72
    v_fmac_f32 v219, v199, v73
    v_fmac_f32 v220, v199, v74
    v_fmac_f32 v221, v199, v75
    v_fmac_f32 v222, v199, v76
    v_fmac_f32 v223, v199, v77
    v_fmac_f32 v224, v199, v78
    v_fmac_f32 v225, v199, v79
    v_fmac_f32 v216, v200, v80
    v_fmac_f32 v217, v200, v81
    v_fmac_f32 v218, v200, v82
    v_fmac_f32 v219, v200, v83
    v_fmac_f32 v220, v200, v84
    v_fmac_f32 v221, v200, v85
    v_fmac_f32 v222, v200, v86
    v_fmac_f32 v223, v200, v87
    v_fmac_f32 v224, v200, v88
    v_fmac_f32 v225, v200, v89
    v_fmac_f32 v216, v201, v90
    v_fmac_f32 v217, v201, v91
    v_fmac_f32 v218, v201, v92
    v_fmac_f32 v219, v201, v93
    v_fmac_f32 v220, v201, v94
    v_fmac_f32 v221, v201, v95
    v_fmac_f32 v222, v201, v96
    v_fmac_f32 v223, v201, v97
    v_fmac_f32 v224, v201, v98
    v_fmac_f32 v225, v201, v99
    v_fmac_f32 v216, v202, v100
    v_fmac_f32 v217, v202, v101
    v_fmac_f32 v218, v202, v102
    v_fmac_f32 v219, v202, v103
    v_fmac_f32 v220, v202, v104
    v_fmac_f32 v221, v202, v105
    v_fmac_f32 v222, v202, v106
    v_fmac_f32 v223, v202, v107
    v_fmac_f32 v224, v202, v108
    v_fmac_f32 v225, v202, v109
    v_fmac_f32 v216, v203, v110
    v_fmac_f32 v217, v203, v111
    v_fmac_f32 v218, v203, v112
    v_fmac_f32 v219, v203, v113
    v_fmac_f32 v220, v203, v114
    v_fmac_f32 v221, v203, v115
    v_fmac_f32 v222, v203, v116
    v_fmac_f32 v223, v203, v117
    v_fmac_f32 v224, v203, v118
    v_fmac_f32 v225, v203, v119
    v_fmac_f32 v216, v204, v120
    v_fmac_f32 v217, v204, v121
    v_fmac_f32 v218, v204, v122
    v_fmac_f32 v219, v204, v123
    v_fmac_f32 v220, v204, v124
    v_fmac_f32 v221, v204, v125
    v_fmac_f32 v222, v204, v126
    v_fmac_f32 v223, v204, v127
    v_fmac_f32 v224, v204, v128
    v_fmac_f32 v225, v204, v129
    v_fmac_f32 v216, v205, v130
    v_fmac_f32 v217, v205, v131
    v_fmac_f32 v218, v205, v132
    v_fmac_f32 v219, v205, v133
    v_fmac_f32 v220, v205, v134
    v_fmac_f32 v221, v205, v135
    v_fmac_f32 v222, v205, v136
    v_fmac_f32 v223, v205, v137
    v_fmac_f32 v224, v205, v138
    v_fmac_f32 v225, v205, v139
    v_fmac_f32 v216, v206, v140
    v_fmac_f32 v217, v206, v141
    v_fmac_f32 v218, v206, v142
    v_fmac_f32 v219, v206, v143
    v_fmac_f32 v220, v206, v144
    v_fmac_f32 v221, v206, v145
    v_fmac_f32 v222, v206, v146
    v_fmac_f32 v223, v206, v147
    v_fmac_f32 v224, v206, v148
    v_fmac_f32 v225, v206, v149
    v_fmac_f32 v216, v207, v150
    v_fmac_f32 v217, v207, v151
    v_fmac_f32 v218, v207, v152
    v_fmac_f32 v219, v207, v153
    v_fmac_f32 v220, v207, v154
    v_fmac_f32 v221, v207, v155
    v_fmac_f32 v222, v207, v156
    v_fmac_f32 v223, v207, v157
    v_fmac_f32 v224, v207, v158
    v_fmac_f32 v225, v207, v159
    s_waitcnt vmcnt(0)
    v_lshlrev_b32 v208, 16, v208
    v_lshlrev_b32 v209, 16, v209
    v_lshlrev_b32 v210, 16, v210
    v_lshlrev_b32 v211, 16, v211
    v_lshlrev_b32 v212, 16, v212
    v_lshlrev_b32 v213, 16, v213
    v_lshlrev_b32 v214, 16, v214
    v_lshlrev_b32 v215, 16, v215
    v_fmac_f32 v160, v208, v216
    v_mul_f32 v229, v210, v226
    v_fmac_f32 v229, v212, v227
    v_fmac_f32 v229, v214, v228
    v_fmac_f32 v176, v229, v218
    v_mul_f32 v229, v208, v220
    v_fmac_f32 v162, v229, v226
    v_fmac_f32 v168, v210, v222
    v_mul_f32 v230, v227, v214
    v_fma_f32 v230, -v228, v212, v230
    v_fmac_f32 v178, v230, v224
    v_fmac_f32 v164, v229, v227
    v_fmac_f32 v170, v212, v222
    v_mul_f32 v230, v228, v210
    v_fma_f32 v230, -v226, v214, v230
    v_fmac_f32 v180, v230, v224
    v_fmac_f32 v166, v229, v228
    v_fmac_f32 v172, v214, v222
    v_mul_f32 v230, v226, v212
    v_fma_f32 v230, -v227, v210, v230
    v_fmac_f32 v174, v230, v224
    v_fmac_f32 v161, v209, v217
    v_mul_f32 v229, v211, v226
    v_fmac_f32 v229, v213, v227
    v_fmac_f32 v229, v215, v228
    v_fmac_f32 v177, v229, v219
    v_mul_f32 v229, v209, v221
    v_fmac_f32 v163, v229, v226
    v_fmac_f32 v169, v211, v223
    v_mul_f32 v230, v227, v215
    v_fma_f32 v230, -v228, v213, v230
    v_fmac_f32 v179, v230, v225
    v_fmac_f32 v165, v229, v227
    v_fmac_f32 v171, v213, v223
    v_mul_f32 v230, v228, v211
    v_fma_f32 v230, -v226, v215, v230
    v_fmac_f32 v181, v230, v225
    v_fmac_f32 v167, v229, v228
    v_fmac_f32 v173, v215, v223
    v_mul_f32 v230, v226, v213
    v_fma_f32 v230, -v227, v211, v230
    v_fmac_f32 v175, v230, v225
    s_branch SL_bits
SL_nexti:
    s_mov_b64 s[38:39], s[40:41]
    s_mov_b64 s[40:41], s[42:43]
    s_mov_b64 s[42:43], s[44:45]
    s_add_u32 s36, s36, 1
    s_cmp_lt_u32 s36, 4
    s_cbranch_scc1 SL_bits
    s_add_u32 s35, s35, 256
    s_cmp_lt_u32 s35, 320000
    s_cbranch_scc1 SL_scan
    s_mul_i32 s66, s20, 5
    s_add_u32 s66, s66, s50
    s_lshl_b32 s67, s66, 4
    s_and_b32 s68, s67, 128
    s_and_b32 s67, s67, 0x70
    s_mul_i32 s69, s50, 1536
    s_add_u32 s69, s69, s21
    s_add_u32 s69, s69, s68
    s_mul_i32 s70, s66, 1536
    s_add_u32 s70, s70, 87040
    s_add_u32 s70, s70, s68
    v_mov_b32 v230, s69
    v_mov_b32 v231, s70
    v_cmp_gt_u32 vcc, 32, v240
    v_and_b32 v229, 31, v240
    v_lshlrev_b32 v229, 2, v229
    v_xor_b32 v229, s67, v229
    v_cndmask_b32 v244, v231, v230, vcc
    v_add_u32 v244, v244, v229
    v_cvt_pk_bf16_f32 v160, v160, v161
    ds_write_b32 v244, v160 offset:0
    v_cvt_pk_bf16_f32 v162, v162, v163
    ds_write_b32 v244, v162 offset:128
    v_cvt_pk_bf16_f32 v164, v164, v165
    ds_write_b32 v244, v164 offset:256
    v_cvt_pk_bf16_f32 v166, v166, v167
    ds_write_b32 v244, v166 offset:384
    v_cvt_pk_bf16_f32 v168, v168, v169
    ds_write_b32 v244, v168 offset:512
    v_cvt_pk_bf16_f32 v170, v170, v171
    ds_write_b32 v244, v170 offset:640
    v_cvt_pk_bf16_f32 v172, v172, v173
    ds_write_b32 v244, v172 offset:768
    v_cvt_pk_bf16_f32 v174, v174, v175
    ds_write_b32 v244, v174 offset:896
    v_cvt_pk_bf16_f32 v176, v176, v177
    ds_write_b32 v244, v176 offset:1024
    v_cvt_pk_bf16_f32 v178, v178, v179
    ds_write_b32 v244, v178 offset:1152
    v_cvt_pk_bf16_f32 v180, v180, v181
    ds_write_b32 v244, v180 offset:1280
    s_lshl_b32 s66, s66, 3
    s_add_u32 s66, s66, 86528
    v_mov_b32 v229, s66
    ds_write_b64 v229, v[230:231]
    s_add_u32 s50, s50, 1
    s_cmp_lt_u32 s50, 5
    s_cbranch_scc1 SL_node
    s_waitcnt lgkmcnt(0)
    s_barrier
    v_mov_b32 v176, v240
    s_mul_i32 s66, s20, 20480
    s_add_u32 s66, s66, 12288000
    buffer_load_dwordx4 v[96:99], v245, s[16:19], s66 offen offset:0
    buffer_load_dwordx4 v[100:103], v245, s[16:19], s66 offen offset:1024
    buffer_load_dwordx4 v[104:107], v245, s[16:19], s66 offen offset:2048
    buffer_load_dwordx4 v[108:111], v245, s[16:19], s66 offen offset:3072
    s_add_u32 s66, s66, 4096
    buffer_load_dwordx4 v[112:115], v245, s[16:19], s66 offen offset:0
    buffer_load_dwordx4 v[116:119], v245, s[16:19], s66 offen offset:1024
    buffer_load_dwordx4 v[120:123], v245, s[16:19], s66 offen offset:2048
    buffer_load_dwordx4 v[124:127], v245, s[16:19], s66 offen offset:3072
    s_add_u32 s66, s66, 4096
    buffer_load_dwordx4 v[128:131], v245, s[16:19], s66 offen offset:0
    buffer_load_dwordx4 v[132:135], v245, s[16:19], s66 offen offset:1024
    buffer_load_dwordx4 v[136:139], v245, s[16:19], s66 offen offset:2048
    buffer_load_dwordx4 v[140:143], v245, s[16:19], s66 offen offset:3072
    s_add_u32 s66, s66, 4096
    buffer_load_dwordx4 v[144:147], v245, s[16:19], s66 offen offset:0
    buffer_load_dwordx4 v[148:151], v245, s[16:19], s66 offen offset:1024
    buffer_load_dwordx4 v[152:155], v245, s[16:19], s66 offen offset:2048
    buffer_load_dwordx4 v[156:159], v245, s[16:19], s66 offen offset:3072
    s_add_u32 s66, s66, 4096
    buffer_load_dwordx4 v[160:163], v245, s[16:19], s66 offen offset:0
    buffer_load_dwordx4 v[164:167], v245, s[16:19], s66 offen offset:1024
    buffer_load_dwordx4 v[168:171], v245, s[16:19], s66 offen offset:2048
    buffer_load_dwordx4 v[172:175], v245, s[16:19], s66 offen offset:3072
    s_branch GEMM
.section .rodata,"a"
.p2align 6
.amdhsa_kernel tp_prep_kernel
  .amdhsa_next_free_vgpr 88
  .amdhsa_next_free_sgpr 52
  .amdhsa_accum_offset 88
  .amdhsa_group_segment_fixed_size 0
  .amdhsa_kernarg_size 96
  .amdhsa_user_sgpr_count 2
  .amdhsa_user_sgpr_kernarg_segment_ptr 1
  .amdhsa_system_sgpr_workgroup_id_x 1
.end_amdhsa_kernel
.p2align 6
.amdhsa_kernel standalone__tensor_product_equiv_equiformer__graph_kernel
  .amdhsa_next_free_vgpr 256
  .amdhsa_next_free_sgpr 88
  .amdhsa_accum_offset 256
  .amdhsa_group_segment_fixed_size 0
  .amdhsa_kernarg_size 96
  .amdhsa_user_sgpr_count 2
  .amdhsa_user_sgpr_kernarg_segment_ptr 1
  .amdhsa_system_sgpr_workgroup_id_x 1
.end_amdhsa_kernel
```

```asm
; @launch grid=(250,1,1) block=(512,1,1) lds=163840
.amdgcn_target "amdgcn-amd-amdhsa--gfx950"
.text
.globl standalone__tensor_product_equiv_equiformer__graph_kernel
.p2align 8
.type standalone__tensor_product_equiv_equiformer__graph_kernel,@function
standalone__tensor_product_equiv_equiformer__graph_kernel:
    s_cmp_ge_u32 s2, 250
    s_cbranch_scc1 K2_end
    s_load_dwordx16 s[72:87], s[0:1], 0
    s_load_dwordx2 s[70:71], s[0:1], 88
    v_lshrrev_b32 v2, 6, v0
    v_and_b32 v1, 63, v0
    v_readfirstlane_b32 s20, v2
    s_getpc_b64 s[66:67]
    v_lshlrev_b32 v94, 7, v1
    s_cmp_eq_u32 s20, 6
    s_cbranch_scc0 F_nopf0
    global_load_dword v94, v94, s[66:67]
F_nopf0:
    s_mul_i32 s66, s2, 5120
    s_mul_i32 s67, s2, 7680
    v_lshl_add_u32 v3, v0, 4, s66
    v_mul_u32_u24 v4, 24, v0
    v_add_u32 v4, s67, v4
    v_lshlrev_b32 v5, 2, v0
    v_mov_b32 v89, 0
    v_add_u32 v6, 98304, v5
    ds_write_b32 v6, v89
    s_cmp_ge_u32 s20, 5
    s_waitcnt lgkmcnt(0)
    s_cbranch_scc1 F_noload
    global_load_dwordx4 v[8:11], v3, s[80:81]
    global_load_dwordx4 v[12:15], v3, s[78:79]
    global_load_dwordx4 v[16:19], v4, s[74:75]
    global_load_dwordx2 v[20:21], v4, s[74:75] offset:16
F_noload:
    s_load_dword s88, s[70:71], 0
    s_barrier
    v_lshlrev_b32 v248, 2, v1
    v_add_u32 v88, 162816, v248
    ds_write_b32 v88, v89
    ds_write_b32 v88, v89 offset:256
    v_lshlrev_b32 v86, 4, v1
    s_lshl_b32 s21, s20, 13
    v_lshrrev_b32 v6, 5, v1
    v_mul_u32_u24 v6, 5120, v6
    v_and_b32 v7, 31, v1
    v_lshl_add_u32 v6, v7, 1, v6
    s_lshr_b32 s66, s20, 2
    s_lshl_b32 s66, s66, 7
    s_and_b32 s67, s20, 3
    s_mul_i32 s67, s67, 5
    s_add_u32 s68, s67, 0
    s_lshr_b32 s24, s68, 2
    s_lshl_b32 s24, s24, 8
    s_bfe_u32 s69, s68, 0x10001
    s_lshl_b32 s69, s69, 6
    s_add_u32 s24, s24, s69
    s_and_b32 s69, s68, 1
    s_mul_i32 s69, s69, 10240
    s_add_u32 s24, s24, s69
    s_add_u32 s24, s24, s66
    s_add_u32 s68, s67, 1
    s_lshr_b32 s25, s68, 2
    s_lshl_b32 s25, s25, 8
    s_bfe_u32 s69, s68, 0x10001
    s_lshl_b32 s69, s69, 6
    s_add_u32 s25, s25, s69
    s_and_b32 s69, s68, 1
    s_mul_i32 s69, s69, 10240
    s_add_u32 s25, s25, s69
    s_add_u32 s25, s25, s66
    s_add_u32 s68, s67, 2
    s_lshr_b32 s26, s68, 2
    s_lshl_b32 s26, s26, 8
    s_bfe_u32 s69, s68, 0x10001
    s_lshl_b32 s69, s69, 6
    s_add_u32 s26, s26, s69
    s_and_b32 s69, s68, 1
    s_mul_i32 s69, s69, 10240
    s_add_u32 s26, s26, s69
    s_add_u32 s26, s26, s66
    s_add_u32 s68, s67, 3
    s_lshr_b32 s27, s68, 2
    s_lshl_b32 s27, s27, 8
    s_bfe_u32 s69, s68, 0x10001
    s_lshl_b32 s69, s69, 6
    s_add_u32 s27, s27, s69
    s_and_b32 s69, s68, 1
    s_mul_i32 s69, s69, 10240
    s_add_u32 s27, s27, s69
    s_add_u32 s27, s27, s66
    s_add_u32 s68, s67, 4
    s_lshr_b32 s28, s68, 2
    s_lshl_b32 s28, s28, 8
    s_bfe_u32 s69, s68, 0x10001
    s_lshl_b32 s69, s69, 6
    s_add_u32 s28, s28, s69
    s_and_b32 s69, s68, 1
    s_mul_i32 s69, s69, 10240
    s_add_u32 s28, s28, s69
    s_add_u32 s28, s28, s66
    v_mov_b32 v96, 0
    v_mov_b32 v97, 0
    v_mov_b32 v98, 0
    v_mov_b32 v99, 0
    v_mov_b32 v100, 0
    v_mov_b32 v101, 0
    v_mov_b32 v102, 0
    v_mov_b32 v103, 0
    v_mov_b32 v104, 0
    v_mov_b32 v105, 0
    v_mov_b32 v106, 0
    v_mov_b32 v107, 0
    v_mov_b32 v108, 0
    v_mov_b32 v109, 0
    v_mov_b32 v110, 0
    v_mov_b32 v111, 0
    v_mov_b32 v112, 0
    v_mov_b32 v113, 0
    v_mov_b32 v114, 0
    v_mov_b32 v115, 0
    v_mov_b32 v180, 0
    v_mov_b32 v181, 0
    v_mov_b32 v182, 0
    v_mov_b32 v183, 0
    s_mov_b32 s16, s70
    s_and_b32 s17, s71, 0xffff
    s_mov_b32 s18, 24165888
    s_mov_b32 s19, 0x20000
    s_mov_b32 s32, s82
    s_and_b32 s33, s83, 0xffff
    s_mov_b32 s34, 20480
    s_mov_b32 s35, 0x20000
    s_cmp_ge_u32 s20, 5
    s_cbranch_scc1 F_helper
    s_mov_b32 s22, 52429
    s_mov_b32 s23, 0x05040100
    s_mov_b32 s66, 98304
    s_movk_i32 s67, -40
    v_mov_b32 v7, 1
    s_waitcnt vmcnt(3)
    v_mul_u32_u24 v22, s22, v8
    v_mul_u32_u24 v23, s22, v9
    v_mul_u32_u24 v24, s22, v10
    v_mul_u32_u24 v25, s22, v11
    v_lshrrev_b32 v22, 21, v22
    v_lshrrev_b32 v23, 21, v23
    v_lshrrev_b32 v24, 21, v24
    v_lshrrev_b32 v25, 21, v25
    v_min_u32 v22, 249, v22
    v_min_u32 v23, 249, v23
    v_min_u32 v24, 249, v24
    v_min_u32 v25, 249, v25
    v_lshl_add_u32 v34, v22, 2, s66
    ds_add_rtn_u32 v26, v34, v7
    v_lshl_add_u32 v35, v23, 2, s66
    ds_add_rtn_u32 v27, v35, v7
    v_lshl_add_u32 v36, v24, 2, s66
    ds_add_rtn_u32 v28, v36, v7
    v_lshl_add_u32 v37, v25, 2, s66
    ds_add_rtn_u32 v29, v37, v7
    buffer_load_short_d16_hi v96, v6, s[32:35], s24 offen offset:0
    buffer_load_short_d16_hi v97, v6, s[32:35], s24 offen offset:1280
    buffer_load_short_d16_hi v98, v6, s[32:35], s24 offen offset:2560
    buffer_load_short_d16_hi v99, v6, s[32:35], s24 offen offset:3840
    buffer_load_short_d16_hi v100, v6, s[32:35], s25 offen offset:0
    buffer_load_short_d16_hi v101, v6, s[32:35], s25 offen offset:1280
    buffer_load_short_d16_hi v102, v6, s[32:35], s25 offen offset:2560
    buffer_load_short_d16_hi v103, v6, s[32:35], s25 offen offset:3840
    buffer_load_short_d16_hi v104, v6, s[32:35], s26 offen offset:0
    buffer_load_short_d16_hi v105, v6, s[32:35], s26 offen offset:1280
    buffer_load_short_d16_hi v106, v6, s[32:35], s26 offen offset:2560
    buffer_load_short_d16_hi v107, v6, s[32:35], s26 offen offset:3840
    buffer_load_short_d16_hi v108, v6, s[32:35], s27 offen offset:0
    buffer_load_short_d16_hi v109, v6, s[32:35], s27 offen offset:1280
    buffer_load_short_d16_hi v110, v6, s[32:35], s27 offen offset:2560
    buffer_load_short_d16_hi v111, v6, s[32:35], s27 offen offset:3840
    buffer_load_short_d16_hi v112, v6, s[32:35], s28 offen offset:0
    buffer_load_short_d16_hi v113, v6, s[32:35], s28 offen offset:1280
    buffer_load_short_d16_hi v114, v6, s[32:35], s28 offen offset:2560
    buffer_load_short_d16_hi v115, v6, s[32:35], s28 offen offset:3840
    v_mad_i32_i24 v30, v22, s67, v8
    v_and_b32 v30, 63, v30
    v_add_u32 v2, 0, v5
    v_lshl_or_b32 v42, v30, 11, v2
    v_mul_u32_u24 v22, 384, v22
    v_mad_i32_i24 v31, v23, s67, v9
    v_and_b32 v31, 63, v31
    v_add_u32 v2, 1, v5
    v_lshl_or_b32 v46, v31, 11, v2
    v_mul_u32_u24 v23, 384, v23
    v_mad_i32_i24 v32, v24, s67, v10
    v_and_b32 v32, 63, v32
    v_add_u32 v2, 2, v5
    v_lshl_or_b32 v50, v32, 11, v2
    v_mul_u32_u24 v24, 384, v24
    v_mad_i32_i24 v33, v25, s67, v11
    v_and_b32 v33, 63, v33
    v_add_u32 v2, 3, v5
    v_lshl_or_b32 v54, v33, 11, v2
    v_mul_u32_u24 v25, 384, v25
    s_waitcnt vmcnt(20)
    v_mov_b32 v40, v16
    v_perm_b32 v41, v12, v17, s23
    v_alignbit_b32 v44, v18, v17, 16
    v_alignbit_b32 v45, v13, v18, 16
    v_mov_b32 v48, v19
    v_perm_b32 v49, v14, v20, s23
    v_alignbit_b32 v52, v21, v20, 16
    v_alignbit_b32 v53, v15, v21, 16
    v_xor_b32 v41, 0x8000, v41
    v_xor_b32 v45, 0x8000, v45
    v_xor_b32 v49, 0x8000, v49
    v_xor_b32 v53, 0x8000, v53
    v_mov_b32 v2, 163712
    s_waitcnt lgkmcnt(0)
    v_cmp_gt_u32 vcc, 24, v26
    v_lshl_add_u32 v34, v26, 4, v22
    s_nop 0
    v_cndmask_b32 v34, v2, v34, vcc
    ds_write_b128 v34, v[40:43]
    v_cmp_gt_u32 vcc, 24, v27
    v_lshl_add_u32 v35, v27, 4, v23
    s_nop 0
    v_cndmask_b32 v35, v2, v35, vcc
    ds_write_b128 v35, v[44:47]
    v_cmp_gt_u32 vcc, 24, v28
    v_lshl_add_u32 v36, v28, 4, v24
    s_nop 0
    v_cndmask_b32 v36, v2, v36, vcc
    ds_write_b128 v36, v[48:51]
    v_cmp_gt_u32 vcc, 24, v29
    v_lshl_add_u32 v37, v29, 4, v25
    s_nop 0
    v_cndmask_b32 v37, v2, v37, vcc
    ds_write_b128 v37, v[52:55]
    s_branch F_staged
F_helper:
    buffer_load_short_d16_hi v96, v6, s[32:35], s24 offen offset:0
    buffer_load_short_d16_hi v97, v6, s[32:35], s24 offen offset:1280
    buffer_load_short_d16_hi v98, v6, s[32:35], s24 offen offset:2560
    buffer_load_short_d16_hi v99, v6, s[32:35], s24 offen offset:3840
    buffer_load_short_d16_hi v100, v6, s[32:35], s25 offen offset:0
    buffer_load_short_d16_hi v101, v6, s[32:35], s25 offen offset:1280
    buffer_load_short_d16_hi v102, v6, s[32:35], s25 offen offset:2560
    buffer_load_short_d16_hi v103, v6, s[32:35], s25 offen offset:3840
    buffer_load_short_d16_hi v104, v6, s[32:35], s26 offen offset:0
    buffer_load_short_d16_hi v105, v6, s[32:35], s26 offen offset:1280
    buffer_load_short_d16_hi v106, v6, s[32:35], s26 offen offset:2560
    buffer_load_short_d16_hi v107, v6, s[32:35], s26 offen offset:3840
    buffer_load_short_d16_hi v108, v6, s[32:35], s27 offen offset:0
    buffer_load_short_d16_hi v109, v6, s[32:35], s27 offen offset:1280
    buffer_load_short_d16_hi v110, v6, s[32:35], s27 offen offset:2560
    buffer_load_short_d16_hi v111, v6, s[32:35], s27 offen offset:3840
    buffer_load_short_d16_hi v112, v6, s[32:35], s28 offen offset:0
    buffer_load_short_d16_hi v113, v6, s[32:35], s28 offen offset:1280
    buffer_load_short_d16_hi v114, v6, s[32:35], s28 offen offset:2560
    buffer_load_short_d16_hi v115, v6, s[32:35], s28 offen offset:3840
    s_cmp_eq_u32 s20, 6
    s_cbranch_scc0 F_nopf
    s_getpc_b64 s[66:67]
F_pc:
    s_lshr_b32 s68, s2, 3
    s_mul_i32 s68, s68, ((K2_last-F_pc)/128/31+1)*128
    v_lshl_add_u32 v2, v1, 7, s68
    v_min_u32 v2, K2_last-F_pc-4, v2
    v_cmp_gt_u32 vcc, (K2_last-F_pc)/128/31+1, v1
    s_mov_b64 exec, vcc
    global_load_dword v95, v2, s[66:67]
    s_mov_b64 exec, -1
F_nopf:
    s_cmp_eq_u32 s20, 7
    s_cbranch_scc0 F_staged
    s_cmp_lt_u32 s2, 160
    s_cbranch_scc0 F_staged
    s_mul_i32 s22, s2, 3277
    s_lshr_b32 s22, s22, 16
    s_mul_i32 s68, s22, 20
    s_sub_u32 s68, s2, s68
    s_cmp_lt_u32 s68, 8
    s_cselect_b64 s[66:67], s[84:85], s[86:87]
    s_cselect_b32 s23, 0, 8
    s_sub_u32 s68, s68, s23
    s_and_b32 s23, s68, 1
    s_lshr_b32 s68, s68, 1
    s_lshl_b32 s68, s68, 14
    s_lshl_b32 s23, s23, 12
    s_add_u32 s68, s68, s23
    s_lshl_b32 s22, s22, 5
    s_add_u32 s68, s68, s22
    v_lshrrev_b32 v2, 4, v1
    v_lshlrev_b32 v2, 10, v2
    v_and_b32 v3, 15, v1
    v_lshl_add_u32 v2, v3, 1, v2
    v_add_u32 v2, s68, v2
    v_add_u32 v3, 8192, v2
    global_load_ushort v176, v2, s[66:67] offset:0
    global_load_short_d16_hi v180, v3, s[66:67] offset:0
    global_load_ushort v177, v2, s[66:67] offset:256
    global_load_short_d16_hi v181, v3, s[66:67] offset:256
    global_load_ushort v178, v2, s[66:67] offset:512
    global_load_short_d16_hi v182, v3, s[66:67] offset:512
    global_load_ushort v179, v2, s[66:67] offset:768
    global_load_short_d16_hi v183, v3, s[66:67] offset:768
F_staged:
    v_lshrrev_b32 v2, 3, v1
    v_lshl_add_u32 v2, s20, 5, v2
    v_and_b32 v91, 7, v1
    v_mul_u32_u24 v3, 384, v2
    v_lshl_add_u32 v3, v91, 4, v3
    v_lshlrev_b32 v4, 2, v2
    v_add_u32 v4, 98304, v4
    v_mul_u32_u24 v92, 32000, v2
    v_lshl_add_u32 v92, v91, 4, v92
    v_mul_u32_u24 v90, 40960, v2
    s_lshl_b32 s66, s2, 7
    s_add_u32 s66, s66, 164864
    s_cmp_eq_u32 s20, 7
    s_cselect_b32 s22, 0xffff, -1
    s_cselect_b32 s23, 0, -1
    s_waitcnt lgkmcnt(0)
    s_add_u32 s88, s88, 1
    s_barrier
    ds_read_b32 v40, v4 offset:0
    ds_read_b128 v[8:11], v3 offset:0
    ds_read_b128 v[12:15], v3 offset:128
    ds_read_b32 v41, v4 offset:32
    ds_read_b128 v[16:19], v3 offset:3072
    ds_read_b128 v[20:23], v3 offset:3200
    ds_read_b32 v42, v4 offset:64
    ds_read_b128 v[24:27], v3 offset:6144
    ds_read_b128 v[28:31], v3 offset:6272
    ds_read_b32 v43, v4 offset:96
    ds_read_b128 v[32:35], v3 offset:9216
    ds_read_b128 v[36:39], v3 offset:9344
    s_waitcnt vmcnt(0)
    s_waitcnt lgkmcnt(9)
    v_min_u32 v5, 31, v40
    v_bfe_u32 v6, v14, 11, 6
    v_and_b32 v10, 0x1ffff, v10
    v_lshl_or_b32 v6, v5, 6, v6
    v_mov_b32 v11, s88
    v_lshl_or_b32 v10, v6, 17, v10
    v_mov_b32 v15, s88
    buffer_store_dwordx4 v[8:11], v92, s[16:19], s66 offen sc1
    v_cmp_lt_u32 vcc, 8, v40
    s_add_u32 s67, s66, 8000000
    s_mov_b64 exec, vcc
    s_cbranch_execz F_w0
    buffer_store_dwordx4 v[12:15], v92, s[16:19], s67 offen sc1
    v_cmp_lt_u32 vcc, 16, v40
    s_add_u32 s67, s67, 8000000
    s_mov_b64 exec, vcc
    s_cbranch_execz F_w0
    ds_read_b128 v[44:47], v3 offset:256
    s_waitcnt lgkmcnt(0)
    v_mov_b32 v47, s88
    buffer_store_dwordx4 v[44:47], v92, s[16:19], s67 offen sc1
    s_nop 1
F_w0:
    s_mov_b64 exec, -1
    s_add_u32 s66, s66, 256000
    s_waitcnt lgkmcnt(6)
    v_min_u32 v5, 31, v41
    v_bfe_u32 v6, v22, 11, 6
    v_and_b32 v18, 0x1ffff, v18
    v_lshl_or_b32 v6, v5, 6, v6
    v_mov_b32 v19, s88
    v_lshl_or_b32 v18, v6, 17, v18
    v_mov_b32 v23, s88
    buffer_store_dwordx4 v[16:19], v92, s[16:19], s66 offen sc1
    v_cmp_lt_u32 vcc, 8, v41
    s_add_u32 s67, s66, 8000000
    s_mov_b64 exec, vcc
    s_cbranch_execz F_w1
    buffer_store_dwordx4 v[20:23], v92, s[16:19], s67 offen sc1
    v_cmp_lt_u32 vcc, 16, v41
    s_add_u32 s67, s67, 8000000
    s_mov_b64 exec, vcc
    s_cbranch_execz F_w1
    ds_read_b128 v[44:47], v3 offset:3328
    s_waitcnt lgkmcnt(0)
    v_mov_b32 v47, s88
    buffer_store_dwordx4 v[44:47], v92, s[16:19], s67 offen sc1
    s_nop 1
F_w1:
    s_mov_b64 exec, -1
    s_add_u32 s66, s66, 256000
    s_waitcnt lgkmcnt(3)
    v_min_u32 v5, 31, v42
    v_bfe_u32 v6, v30, 11, 6
    v_and_b32 v26, 0x1ffff, v26
    v_lshl_or_b32 v6, v5, 6, v6
    v_mov_b32 v27, s88
    v_lshl_or_b32 v26, v6, 17, v26
    v_mov_b32 v31, s88
    buffer_store_dwordx4 v[24:27], v92, s[16:19], s66 offen sc1
    v_cmp_lt_u32 vcc, 8, v42
    s_add_u32 s67, s66, 8000000
    s_mov_b64 exec, vcc
    s_cbranch_execz F_w2
    buffer_store_dwordx4 v[28:31], v92, s[16:19], s67 offen sc1
    v_cmp_lt_u32 vcc, 16, v42
    s_add_u32 s67, s67, 8000000
    s_mov_b64 exec, vcc
    s_cbranch_execz F_w2
    ds_read_b128 v[44:47], v3 offset:6400
    s_waitcnt lgkmcnt(0)
    v_mov_b32 v47, s88
    buffer_store_dwordx4 v[44:47], v92, s[16:19], s67 offen sc1
    s_nop 1
F_w2:
    s_mov_b64 exec, -1
    s_add_u32 s66, s66, 256000
    s_waitcnt lgkmcnt(0)
    v_min_u32 v5, 31, v43
    v_bfe_u32 v6, v38, 11, 6
    v_and_b32 v34, 0x1ffff, v34
    v_lshl_or_b32 v6, v5, 6, v6
    v_mov_b32 v35, s88
    v_lshl_or_b32 v34, v6, 17, v34
    v_mov_b32 v39, s88
    s_mov_b64 exec, s[22:23]
    buffer_store_dwordx4 v[32:35], v92, s[16:19], s66 offen sc1
    v_cmp_lt_u32 vcc, 8, v43
    s_add_u32 s67, s66, 8000000
    s_mov_b64 exec, vcc
    s_cbranch_execz F_w3
    buffer_store_dwordx4 v[36:39], v92, s[16:19], s67 offen sc1
    v_cmp_lt_u32 vcc, 16, v43
    s_add_u32 s67, s67, 8000000
    s_mov_b64 exec, vcc
    s_cbranch_execz F_w3
    ds_read_b128 v[44:47], v3 offset:9472
    s_waitcnt lgkmcnt(0)
    v_mov_b32 v47, s88
    buffer_store_dwordx4 v[44:47], v92, s[16:19], s67 offen sc1
    s_nop 1
F_w3:
    s_mov_b64 exec, -1
    s_cmp_eq_u32 s20, 7
    s_cbranch_scc0 F_nofrag
    s_cmp_lt_u32 s2, 160
    s_cbranch_scc0 F_nofrag
    v_or_b32 v176, v176, v180
    v_or_b32 v177, v177, v181
    v_or_b32 v178, v178, v182
    v_or_b32 v179, v179, v183
    s_lshl_b32 s66, s2, 10
    s_add_u32 s66, s66, 1024
    buffer_store_dwordx4 v[176:179], v86, s[16:19], s66 offen sc1
F_nofrag:
    s_barrier
    s_mul_i32 s24, s2, 32000
    s_lshl_b32 s25, s20, 12
    s_add_u32 s24, s24, s25
    s_add_u32 s24, s24, 164864
    s_add_u32 s25, s24, 8000000
    s_add_u32 s26, s25, 8000000
    v_mov_b32 v22, 0
    v_mov_b32 v23, s88
    s_mul_i32 s68, s20, 5120
    s_cmp_ge_u32 s20, 4
    s_cselect_b32 s70, 45056, 0
    s_add_u32 s68, s68, s70
    v_add_u32 v2, s68, v86
    ds_write_b128 v2, v[96:99] offset:0
    ds_write_b128 v2, v[100:103] offset:1024
    ds_write_b128 v2, v[104:107] offset:2048
    ds_write_b128 v2, v[108:111] offset:3072
    ds_write_b128 v2, v[112:115] offset:4096
    v_mov_b32 v4, 2130738944
    v_mov_b32 v5, 2130738944
    v_mov_b32 v6, 2130738944
    v_mov_b32 v7, 2130738944
    v_lshlrev_b32 v2, 4, v0
    v_add_u32 v3, 86016, v2
    ds_write_b128 v3, v[4:7] offset:0
    ds_write_b128 v3, v[4:7] offset:8192
    ds_write_b128 v3, v[4:7] offset:16384
    ds_write_b128 v3, v[4:7] offset:24576
    ds_write_b128 v3, v[4:7] offset:32768
    ds_write_b128 v3, v[4:7] offset:40960
    ds_write_b128 v3, v[4:7] offset:49152
    ds_write_b128 v3, v[4:7] offset:57344
    v_add_u32 v3, 0x10000, v3
    ds_write_b128 v3, v[4:7] offset:0
    v_min_u32 v2, 3056, v2
    v_add_u32 v2, 159744, v2
    ds_write_b128 v2, v[4:7]
    s_sub_u32 s72, s72, 128
    s_subb_u32 s73, s73, 0
    s_mov_b32 s4, s72
    s_and_b32 s5, s73, 0xffff
    s_mov_b32 s6, 10240000
    s_mov_b32 s7, 0x20000
    s_sub_u32 s72, s72, 1024
    s_subb_u32 s73, s73, 0
    s_mov_b32 s8, s72
    s_and_b32 s9, s73, 0xffff
    s_mov_b32 s10, 10241024
    s_mov_b32 s11, 0x20000
    s_mov_b32 s12, s76
    s_and_b32 s13, s77, 0xffff
    s_mov_b32 s14, 10240000
    s_mov_b32 s15, 0x20000
    v_lshrrev_b32 v2, 5, v1
    v_bfe_u32 v3, v1, 2, 2
    v_and_b32 v4, 3, v1
    v_bfe_u32 v5, v1, 4, 1
    v_lshlrev_b32 v6, 9, v2
    v_lshl_add_u32 v6, v3, 7, v6
    v_lshl_add_u32 v6, v5, 5, v6
    v_lshl_add_u32 v6, v4, 3, v6
    v_lshrrev_b32 v7, 1, v3
    v_lshl_add_u32 v6, v7, 6, v6
    v_add_u32 v244, s21, v6
    v_xor_b32 v245, 64, v244
    v_lshlrev_b32 v6, 7, v2
    v_lshl_add_u32 v6, v3, 5, v6
    v_lshl_add_u32 v249, v4, 3, v6
    v_lshl_add_u32 v6, v2, 2, v4
    v_bfe_u32 v7, v1, 2, 1
    v_lshl_add_u32 v6, v7, 3, v6
    v_lshlrev_b32 v6, 3, v6
    v_bfe_u32 v7, v1, 3, 1
    v_add_u32 v5, 1, v5
    v_mul_u32_u24 v7, v7, v5
    v_lshl_add_u32 v250, v7, 1, v6
    v_and_b32 v6, 0x38, v1
    v_add_u32 v247, 6, v6
    v_lshrrev_b32 v6, 2, v1
    v_lshrrev_b32 v7, 4, v1
    v_xor_b32 v6, v6, v7
    v_and_b32 v6, 1, v6
    v_lshlrev_b32 v6, 6, v6
    v_lshl_add_u32 v246, v4, 4, v6
    v_mov_b32 v242, 1.0
    v_mov_b32 v243, 1.0
    s_mov_b32 s54, 0xffffff00
    s_mov_b32 s55, 0xffffff00
    s_mov_b32 s56, 0xffff
    s_mov_b32 s57, 0xffff
    s_mov_b32 s58, 0
    s_mov_b32 s59, 134217856
    s_mov_b32 s60, 262272
    s_mov_b32 s61, 402915456
    s_mov_b32 s62, 940179840
    s_mov_b32 s63, 403046528
    s_mov_b32 s64, 402784384
    s_mov_b32 s65, 134348928
    s_mov_b32 s38, 128
    s_mov_b32 s33, -1
    s_and_b32 s68, s20, 3
    s_lshl_b32 s68, s68, 2
    s_lshr_b32 s69, s20, 2
    s_add_u32 s68, s68, s69
    s_lshl_b32 s68, s68, 4
    s_add_u32 s68, s68, 163072
    v_mov_b32 v251, s68
    s_mov_b32 s53, 0
    s_mov_b32 s50, 0
    s_mov_b32 s51, 0
    s_mov_b32 s47, 0
    s_mov_b32 s42, 0
    s_mov_b32 s3, 0
    s_mov_b32 s89, 0
    s_mov_b32 s34, 128
    s_mov_b32 s35, 384
    s_mov_b32 s36, 640
    s_mov_b32 s37, 896
    s_waitcnt lgkmcnt(0)
    s_barrier
    buffer_load_dwordx4 v[8:11], v86, s[16:19], s24 offen offset:0 sc1
    buffer_load_dwordx4 v[12:15], v86, s[16:19], s24 offen offset:1024 sc1
    buffer_load_dwordx4 v[16:19], v86, s[16:19], s24 offen offset:2048 sc1
    s_mov_b64 exec, s[22:23]
    buffer_load_dwordx4 v[20:23], v86, s[16:19], s24 offen offset:3072 sc1
    s_mov_b64 exec, -1
    ds_read_b128 v[96:99], v86 offset:0
    ds_read_b128 v[100:103], v86 offset:1024
    ds_read_b128 v[104:107], v86 offset:2048
    ds_read_b128 v[108:111], v86 offset:3072
    ds_read_b128 v[112:115], v86 offset:4096
    ds_read_b128 v[116:119], v86 offset:5120
    ds_read_b128 v[120:123], v86 offset:6144
    ds_read_b128 v[124:127], v86 offset:7168
    ds_read_b128 v[128:131], v86 offset:8192
    ds_read_b128 v[132:135], v86 offset:9216
    ds_read_b128 v[136:139], v86 offset:10240
    ds_read_b128 v[140:143], v86 offset:11264
    ds_read_b128 v[144:147], v86 offset:12288
    ds_read_b128 v[148:151], v86 offset:13312
    ds_read_b128 v[152:155], v86 offset:14336
    ds_read_b128 v[156:159], v86 offset:15360
    ds_read_b128 v[160:163], v86 offset:16384
    ds_read_b128 v[164:167], v86 offset:17408
    ds_read_b128 v[168:171], v86 offset:18432
    ds_read_b128 v[172:175], v86 offset:19456
    s_mov_b32 s27, 32768
F_poll:
    s_waitcnt vmcnt(0)
    v_cmp_ne_u32 s[72:73], s88, v11
    v_cmp_ne_u32 s[74:75], s88, v15
    v_cmp_ne_u32 s[76:77], s88, v19
    v_cmp_ne_u32 s[78:79], s88, v23
    s_or_b64 s[80:81], s[72:73], s[74:75]
    s_or_b64 s[82:83], s[76:77], s[78:79]
    s_or_b64 s[80:81], s[80:81], s[82:83]
    s_cbranch_scc0 F_got
    s_sub_u32 s27, s27, 1
    s_cbranch_scc1 F_late
    s_cmp_eq_u64 s[72:73], 0
    s_cbranch_scc1 F_p0
    buffer_load_dwordx4 v[8:11], v86, s[16:19], s24 offen offset:0 sc1
F_p0:
    s_cmp_eq_u64 s[74:75], 0
    s_cbranch_scc1 F_p1
    buffer_load_dwordx4 v[12:15], v86, s[16:19], s24 offen offset:1024 sc1
F_p1:
    s_cmp_eq_u64 s[76:77], 0
    s_cbranch_scc1 F_p2
    buffer_load_dwordx4 v[16:19], v86, s[16:19], s24 offen offset:2048 sc1
F_p2:
    s_cmp_eq_u64 s[78:79], 0
    s_cbranch_scc1 F_p3
    s_mov_b64 exec, s[22:23]
    buffer_load_dwordx4 v[20:23], v86, s[16:19], s24 offen offset:3072 sc1
    s_mov_b64 exec, -1
F_p3:
    s_branch F_poll
F_late:
    v_mov_b32 v2, 163064
    v_mov_b32 v3, 1000
    ds_write_b32 v2, v3
    v_mov_b32 v10, 0
    v_mov_b32 v14, 0
    v_mov_b32 v18, 0
    v_mov_b32 v22, 0
F_got:
    s_cmp_eq_u32 s20, 7
    s_cbranch_scc0 F_noflag
    s_cmp_lt_u32 s2, 160
    s_cbranch_scc0 F_noflag
    s_lshl_b32 s66, s2, 2
    v_mov_b32 v2, 128
    v_mov_b32 v3, s88
    s_mov_b64 exec, 1
    buffer_store_dword v3, v2, s[16:19], s66 offen sc1
    s_mov_b64 exec, -1
F_noflag:
    s_mov_b32 s27, 262144
    s_mov_b32 s71, 162816
    v_mov_b32 v3, 1
    v_bfe_u32 v2, v10, 23, 5
    v_bfe_u32 v60, v10, 11, 6
    v_sub_u32 v56, v2, v91
    v_max_u32 v89, v89, v2
    v_lshl_add_u32 v60, v60, 2, s71
    v_bfe_u32 v64, v10, 17, 6
    v_cmp_lt_u32 s[72:73], 8, v2
    v_cmp_lt_i32 vcc, 0, v56
    v_cmp_lt_i32 s[80:81], 8, v56
    s_mov_b64 exec, vcc
    ds_add_rtn_u32 v72, v60, v3
    s_mov_b64 exec, s[80:81]
    s_cbranch_execz F_h0
    v_lshl_add_u32 v64, v64, 2, s71
    ds_add_rtn_u32 v76, v64, v3
    s_mov_b64 exec, s[72:73]
    buffer_load_dwordx4 v[24:27], v86, s[16:19], s25 offen offset:0 sc1
F_h0:
    s_mov_b64 exec, -1
    v_bfe_u32 v2, v14, 23, 5
    v_bfe_u32 v61, v14, 11, 6
    v_sub_u32 v57, v2, v91
    v_max_u32 v89, v89, v2
    v_lshl_add_u32 v61, v61, 2, s71
    v_bfe_u32 v65, v14, 17, 6
    v_cmp_lt_u32 s[74:75], 8, v2
    v_cmp_lt_i32 vcc, 0, v57
    v_cmp_lt_i32 s[80:81], 8, v57
    s_mov_b64 exec, vcc
    ds_add_rtn_u32 v73, v61, v3
    s_mov_b64 exec, s[80:81]
    s_cbranch_execz F_h1
    v_lshl_add_u32 v65, v65, 2, s71
    ds_add_rtn_u32 v77, v65, v3
    s_mov_b64 exec, s[74:75]
    buffer_load_dwordx4 v[28:31], v86, s[16:19], s25 offen offset:1024 sc1
F_h1:
    s_mov_b64 exec, -1
    v_bfe_u32 v2, v18, 23, 5
    v_bfe_u32 v62, v18, 11, 6
    v_sub_u32 v58, v2, v91
    v_max_u32 v89, v89, v2
    v_lshl_add_u32 v62, v62, 2, s71
    v_bfe_u32 v66, v18, 17, 6
    v_cmp_lt_u32 s[76:77], 8, v2
    v_cmp_lt_i32 vcc, 0, v58
    v_cmp_lt_i32 s[80:81], 8, v58
    s_mov_b64 exec, vcc
    ds_add_rtn_u32 v74, v62, v3
    s_mov_b64 exec, s[80:81]
    s_cbranch_execz F_h2
    v_lshl_add_u32 v66, v66, 2, s71
    ds_add_rtn_u32 v78, v66, v3
    s_mov_b64 exec, s[76:77]
    buffer_load_dwordx4 v[32:35], v86, s[16:19], s25 offen offset:2048 sc1
F_h2:
    s_mov_b64 exec, -1
    v_bfe_u32 v2, v22, 23, 5
    v_bfe_u32 v63, v22, 11, 6
    v_sub_u32 v59, v2, v91
    v_max_u32 v89, v89, v2
    v_lshl_add_u32 v63, v63, 2, s71
    v_bfe_u32 v67, v22, 17, 6
    v_cmp_lt_u32 s[78:79], 8, v2
    v_cmp_lt_i32 vcc, 0, v59
    v_cmp_lt_i32 s[80:81], 8, v59
    s_mov_b64 exec, vcc
    ds_add_rtn_u32 v75, v63, v3
    s_mov_b64 exec, s[80:81]
    s_cbranch_execz F_h3
    v_lshl_add_u32 v67, v67, 2, s71
    ds_add_rtn_u32 v79, v67, v3
    s_mov_b64 exec, s[78:79]
    buffer_load_dwordx4 v[36:39], v86, s[16:19], s25 offen offset:3072 sc1
F_h3:
    s_mov_b64 exec, -1
    v_cmp_lt_u32 vcc, 16, v89
    s_cmp_eq_u64 vcc, 0
    s_cbranch_scc1 F_no3
    v_add_u32 v2, v56, v91
    v_cmp_lt_u32 vcc, 16, v2
    s_mov_b64 exec, vcc
    s_cbranch_execz F_t0
F_tp0:
    buffer_load_dwordx4 v[40:43], v86, s[16:19], s26 offen offset:0 sc1
    s_waitcnt vmcnt(0)
    v_cmp_ne_u32 vcc, s88, v43
    s_sub_u32 s27, s27, 1
    s_cselect_b64 vcc, 0, vcc
    s_cmp_eq_u64 vcc, 0
    s_cbranch_scc0 F_tp0
    v_bfe_u32 v68, v42, 11, 6
    v_lshl_add_u32 v68, v68, 2, s71
    v_cmp_lt_i32 vcc, 16, v56
    s_mov_b64 exec, vcc
    ds_add_rtn_u32 v80, v68, v3
F_t0:
    s_mov_b64 exec, -1
    v_add_u32 v2, v57, v91
    v_cmp_lt_u32 vcc, 16, v2
    s_mov_b64 exec, vcc
    s_cbranch_execz F_t1
F_tp1:
    buffer_load_dwordx4 v[44:47], v86, s[16:19], s26 offen offset:1024 sc1
    s_waitcnt vmcnt(0)
    v_cmp_ne_u32 vcc, s88, v47
    s_sub_u32 s27, s27, 1
    s_cselect_b64 vcc, 0, vcc
    s_cmp_eq_u64 vcc, 0
    s_cbranch_scc0 F_tp1
    v_bfe_u32 v69, v46, 11, 6
    v_lshl_add_u32 v69, v69, 2, s71
    v_cmp_lt_i32 vcc, 16, v57
    s_mov_b64 exec, vcc
    ds_add_rtn_u32 v81, v69, v3
F_t1:
    s_mov_b64 exec, -1
    v_add_u32 v2, v58, v91
    v_cmp_lt_u32 vcc, 16, v2
    s_mov_b64 exec, vcc
    s_cbranch_execz F_t2
F_tp2:
    buffer_load_dwordx4 v[48:51], v86, s[16:19], s26 offen offset:2048 sc1
    s_waitcnt vmcnt(0)
    v_cmp_ne_u32 vcc, s88, v51
    s_sub_u32 s27, s27, 1
    s_cselect_b64 vcc, 0, vcc
    s_cmp_eq_u64 vcc, 0
    s_cbranch_scc0 F_tp2
    v_bfe_u32 v70, v50, 11, 6
    v_lshl_add_u32 v70, v70, 2, s71
    v_cmp_lt_i32 vcc, 16, v58
    s_mov_b64 exec, vcc
    ds_add_rtn_u32 v82, v70, v3
F_t2:
    s_mov_b64 exec, -1
    v_add_u32 v2, v59, v91
    v_cmp_lt_u32 vcc, 16, v2
    s_mov_b64 exec, vcc
    s_cbranch_execz F_t3
F_tp3:
    buffer_load_dwordx4 v[52:55], v86, s[16:19], s26 offen offset:3072 sc1
    s_waitcnt vmcnt(0)
    v_cmp_ne_u32 vcc, s88, v55
    s_sub_u32 s27, s27, 1
    s_cselect_b64 vcc, 0, vcc
    s_cmp_eq_u64 vcc, 0
    s_cbranch_scc0 F_tp3
    v_bfe_u32 v71, v54, 11, 6
    v_lshl_add_u32 v71, v71, 2, s71
    v_cmp_lt_i32 vcc, 16, v59
    s_mov_b64 exec, vcc
    ds_add_rtn_u32 v83, v71, v3
F_t3:
    s_mov_b64 exec, -1
    v_mov_b32 v2, 163068
    v_mov_b32 v4, 1000
    v_cmp_lt_u32 vcc, 24, v89
    s_mov_b64 exec, vcc
    ds_write_b32 v2, v4
    s_mov_b64 exec, -1
F_no3:
    s_waitcnt lgkmcnt(0)
    s_barrier
    ds_read_b32 v4, v88
    v_cmp_gt_u32 s[68:69], 40, v1
    s_waitcnt lgkmcnt(0)
    v_cmp_lt_u32 vcc, 64, v4
    v_add_u32 v5, 15, v4
    v_lshrrev_b32 v5, 4, v5
    v_med3_u32 v5, v5, 1, 4
    v_mul_u32_u24 v6, 640, v5
    v_max_u32 v6, 1536, v6
    v_cndmask_b32 v6, 0, v6, s[68:69]
    s_cmp_lg_u64 vcc, 0
    s_cbranch_scc1 SLOW
    v_mov_b32 v7, v6
    v_add_u32 v2, 7, v4
    v_lshrrev_b32 v2, 3, v2
    v_add_u32_dpp v7, v7, v7 row_shr:1 row_mask:0xf bank_mask:0xf
    v_max_u32 v2, 2, v2
    v_cmp_eq_u32 vcc, 7, v2
    v_add_u32_dpp v7, v7, v7 row_shr:2 row_mask:0xf bank_mask:0xf
    v_lshlrev_b32 v5, 18, v5
    v_lshl_or_b32 v5, v1, 21, v5
    v_add_u32_dpp v7, v7, v7 row_shr:4 row_mask:0xf bank_mask:0xf
    v_addc_co_u32 v2, vcc, 0, v2, vcc
    v_lshl_or_b32 v5, v2, 28, v5
    v_add_u32_dpp v7, v7, v7 row_shr:8 row_mask:0xf bank_mask:0xf
    v_med3_u32 v2, v2, 3, 6
    v_cndmask_b32 v2, 0, v2, s[68:69]
    v_add_u32_dpp v7, v7, v7 row_bcast:15 row_mask:0xa bank_mask:0xf
    v_mov_b32 v84, 63
    s_mov_b32 s70, 0
    v_add_u32_dpp v7, v7, v7 row_bcast:31 row_mask:0xc bank_mask:0xf
    v_cmp_eq_u32 vcc, 6, v2
    v_readlane_b32 s66, v7, 63
    v_sub_u32 v7, v7, v6
    v_add_u32 v7, 86016, v7
    v_or_b32 v6, v5, v7
    s_cmp_gt_u32 s66, 76800
    s_cbranch_scc1 SLOW
    ds_bpermute_b32 v60, v60, v6
    ds_bpermute_b32 v61, v61, v6
    ds_bpermute_b32 v62, v62, v6
    ds_bpermute_b32 v63, v63, v6
    ds_bpermute_b32 v64, v64, v6
    ds_bpermute_b32 v65, v65, v6
    ds_bpermute_b32 v66, v66, v6
    ds_bpermute_b32 v67, v67, v6
    v_mbcnt_lo_u32_b32 v5, vcc_lo, 0
    v_mbcnt_hi_u32_b32 v5, vcc_hi, v5
    v_add_u32 v5, s70, v5
    v_cndmask_b32 v84, v84, v5, vcc
    s_bcnt1_i32_b64 s71, vcc
    v_cmp_eq_u32 vcc, 5, v2
    s_add_u32 s70, s70, s71
    s_nop 0
    v_mbcnt_lo_u32_b32 v5, vcc_lo, 0
    v_mbcnt_hi_u32_b32 v5, vcc_hi, v5
    v_add_u32 v5, s70, v5
    v_cndmask_b32 v84, v84, v5, vcc
    s_bcnt1_i32_b64 s71, vcc
    v_cmp_eq_u32 vcc, 4, v2
    s_add_u32 s70, s70, s71
    s_nop 0
    v_mbcnt_lo_u32_b32 v5, vcc_lo, 0
    v_mbcnt_hi_u32_b32 v5, vcc_hi, v5
    v_add_u32 v5, s70, v5
    v_cndmask_b32 v84, v84, v5, vcc
    s_bcnt1_i32_b64 s71, vcc
    v_cmp_eq_u32 vcc, 3, v2
    s_add_u32 s70, s70, s71
    s_nop 0
    v_mbcnt_lo_u32_b32 v5, vcc_lo, 0
    v_mbcnt_hi_u32_b32 v5, vcc_hi, v5
    v_add_u32 v5, s70, v5
    v_cndmask_b32 v84, v84, v5, vcc
    v_lshrrev_b32 v2, 3, v84
    v_and_b32 v3, 1, v2
    v_mul_u32_u24 v3, 7, v3
    v_xor_b32 v84, v84, v3
    v_and_b32 v3, 7, v84
    v_lshlrev_b32 v3, 13, v3
    v_mul_u32_u24 v2, 1536, v2
    v_lshlrev_b32 v4, 4, v1
    v_and_b32 v5, 128, v4
    v_add3_u32 v2, v2, v3, v5
    v_xor_b32 v3, v4, v7
    v_and_b32 v3, 128, v3
    v_add_u32 v3, v3, v7
    v_and_b32 v4, 0x70, v4
    v_or_b32 v5, v3, v4
    s_add_u32 s66, s20, 0
    v_cmp_eq_u32 vcc, s66, v84
    s_ff1_i32_b64 s67, vcc
    v_readlane_b32 s28, v5, s67
    v_readlane_b32 s80, v6, s67
    s_add_u32 s66, s20, 8
    v_cmp_eq_u32 vcc, s66, v84
    s_ff1_i32_b64 s67, vcc
    v_readlane_b32 s29, v5, s67
    v_readlane_b32 s81, v6, s67
    s_add_u32 s66, s20, 16
    v_cmp_eq_u32 vcc, s66, v84
    s_ff1_i32_b64 s67, vcc
    v_readlane_b32 s30, v5, s67
    v_readlane_b32 s82, v6, s67
    s_add_u32 s66, s20, 24
    v_cmp_eq_u32 vcc, s66, v84
    s_ff1_i32_b64 s67, vcc
    v_readlane_b32 s31, v5, s67
    v_readlane_b32 s83, v6, s67
    s_add_u32 s66, s20, 32
    v_cmp_eq_u32 vcc, s66, v84
    s_ff1_i32_b64 s67, vcc
    v_readlane_b32 s32, v5, s67
    v_readlane_b32 s84, v6, s67
    v_lshlrev_b32 v4, 3, v1
    v_add_u32 v4, 163328, v4
    s_mov_b32 exec_hi, 0xff
    ds_write_b64 v4, v[2:3]
    s_mov_b32 exec_hi, -1
    s_waitcnt lgkmcnt(0)
    v_cmpx_lt_i32 vcc, 0, v56
    v_and_b32 v2, 0x3ffff, v60
    v_bfe_u32 v3, v60, 18, 3
    v_and_b32 v4, 0x7ff, v10
    v_lshl_add_u32 v3, v3, 9, v2
    v_lshl_add_u32 v4, v4, 5, v90
    v_lshl_add_u32 v2, v72, 5, v2
    v_lshl_add_u32 v3, v72, 3, v3
    v_or_b32 v5, 16, v4
    ds_write2_b32 v2, v4, v5 offset0:0 offset1:4
    ds_write_b64 v3, v[8:9]
    s_mov_b64 exec, -1
    v_cmpx_lt_i32 vcc, 0, v57
    v_and_b32 v2, 0x3ffff, v61
    v_bfe_u32 v3, v61, 18, 3
    v_and_b32 v4, 0x7ff, v14
    v_lshl_add_u32 v3, v3, 9, v2
    v_lshl_add_u32 v4, v4, 5, v90
    v_lshl_add_u32 v2, v73, 5, v2
    v_add_u32 v4, 327680, v4
    v_lshl_add_u32 v3, v73, 3, v3
    v_or_b32 v5, 16, v4
    ds_write2_b32 v2, v4, v5 offset0:0 offset1:4
    ds_write_b64 v3, v[12:13]
    s_mov_b64 exec, -1
    v_cmpx_lt_i32 vcc, 0, v58
    v_and_b32 v2, 0x3ffff, v62
    v_bfe_u32 v3, v62, 18, 3
    v_and_b32 v4, 0x7ff, v18
    v_lshl_add_u32 v3, v3, 9, v2
    v_lshl_add_u32 v4, v4, 5, v90
    v_lshl_add_u32 v2, v74, 5, v2
    v_add_u32 v4, 655360, v4
    v_lshl_add_u32 v3, v74, 3, v3
    v_or_b32 v5, 16, v4
    ds_write2_b32 v2, v4, v5 offset0:0 offset1:4
    ds_write_b64 v3, v[16:17]
    s_mov_b64 exec, -1
    v_cmpx_lt_i32 vcc, 0, v59
    v_and_b32 v2, 0x3ffff, v63
    v_bfe_u32 v3, v63, 18, 3
    v_and_b32 v4, 0x7ff, v22
    v_lshl_add_u32 v3, v3, 9, v2
    v_lshl_add_u32 v4, v4, 5, v90
    v_lshl_add_u32 v2, v75, 5, v2
    v_add_u32 v4, 983040, v4
    v_lshl_add_u32 v3, v75, 3, v3
    v_or_b32 v5, 16, v4
    ds_write2_b32 v2, v4, v5 offset0:0 offset1:4
    ds_write_b64 v3, v[20:21]
    s_mov_b64 exec, -1
    s_mov_b64 exec, s[72:73]
    s_cbranch_execz F_s0
F_sp0:
    s_waitcnt vmcnt(0)
    v_cmp_ne_u32 vcc, s88, v27
    s_cmp_eq_u64 vcc, 0
    s_cbranch_scc1 F_sg0
    s_sub_u32 s27, s27, 1
    s_cbranch_scc1 F_sg0
    buffer_load_dwordx4 v[24:27], v86, s[16:19], s25 offen offset:0 sc1
    s_branch F_sp0
F_sg0:
    v_cmpx_lt_i32 vcc, 8, v56
    v_and_b32 v2, 0x3ffff, v64
    v_bfe_u32 v3, v64, 18, 3
    v_and_b32 v4, 0x7ff, v26
    v_lshl_add_u32 v3, v3, 9, v2
    v_lshl_add_u32 v4, v4, 5, v90
    v_lshl_add_u32 v2, v76, 5, v2
    v_lshl_add_u32 v3, v76, 3, v3
    v_or_b32 v5, 16, v4
    ds_write2_b32 v2, v4, v5 offset0:0 offset1:4
    ds_write_b64 v3, v[24:25]
F_s0:
    s_mov_b64 exec, s[74:75]
    s_cbranch_execz F_s1
F_sp1:
    s_waitcnt vmcnt(0)
    v_cmp_ne_u32 vcc, s88, v31
    s_cmp_eq_u64 vcc, 0
    s_cbranch_scc1 F_sg1
    s_sub_u32 s27, s27, 1
    s_cbranch_scc1 F_sg1
    buffer_load_dwordx4 v[28:31], v86, s[16:19], s25 offen offset:1024 sc1
    s_branch F_sp1
F_sg1:
    v_cmpx_lt_i32 vcc, 8, v57
    v_and_b32 v2, 0x3ffff, v65
    v_bfe_u32 v3, v65, 18, 3
    v_and_b32 v4, 0x7ff, v30
    v_lshl_add_u32 v3, v3, 9, v2
    v_lshl_add_u32 v4, v4, 5, v90
    v_lshl_add_u32 v2, v77, 5, v2
    v_add_u32 v4, 327680, v4
    v_lshl_add_u32 v3, v77, 3, v3
    v_or_b32 v5, 16, v4
    ds_write2_b32 v2, v4, v5 offset0:0 offset1:4
    ds_write_b64 v3, v[28:29]
F_s1:
    s_mov_b64 exec, s[76:77]
    s_cbranch_execz F_s2
F_sp2:
    s_waitcnt vmcnt(0)
    v_cmp_ne_u32 vcc, s88, v35
    s_cmp_eq_u64 vcc, 0
    s_cbranch_scc1 F_sg2
    s_sub_u32 s27, s27, 1
    s_cbranch_scc1 F_sg2
    buffer_load_dwordx4 v[32:35], v86, s[16:19], s25 offen offset:2048 sc1
    s_branch F_sp2
F_sg2:
    v_cmpx_lt_i32 vcc, 8, v58
    v_and_b32 v2, 0x3ffff, v66
    v_bfe_u32 v3, v66, 18, 3
    v_and_b32 v4, 0x7ff, v34
    v_lshl_add_u32 v3, v3, 9, v2
    v_lshl_add_u32 v4, v4, 5, v90
    v_lshl_add_u32 v2, v78, 5, v2
    v_add_u32 v4, 655360, v4
    v_lshl_add_u32 v3, v78, 3, v3
    v_or_b32 v5, 16, v4
    ds_write2_b32 v2, v4, v5 offset0:0 offset1:4
    ds_write_b64 v3, v[32:33]
F_s2:
    s_mov_b64 exec, s[78:79]
    s_cbranch_execz F_s3
F_sp3:
    s_waitcnt vmcnt(0)
    v_cmp_ne_u32 vcc, s88, v39
    s_cmp_eq_u64 vcc, 0
    s_cbranch_scc1 F_sg3
    s_sub_u32 s27, s27, 1
    s_cbranch_scc1 F_sg3
    buffer_load_dwordx4 v[36:39], v86, s[16:19], s25 offen offset:3072 sc1
    s_branch F_sp3
F_sg3:
    v_cmpx_lt_i32 vcc, 8, v59
    v_and_b32 v2, 0x3ffff, v67
    v_bfe_u32 v3, v67, 18, 3
    v_and_b32 v4, 0x7ff, v38
    v_lshl_add_u32 v3, v3, 9, v2
    v_lshl_add_u32 v4, v4, 5, v90
    v_lshl_add_u32 v2, v79, 5, v2
    v_add_u32 v4, 983040, v4
    v_lshl_add_u32 v3, v79, 3, v3
    v_or_b32 v5, 16, v4
    ds_write2_b32 v2, v4, v5 offset0:0 offset1:4
    ds_write_b64 v3, v[36:37]
F_s3:
    s_mov_b64 exec, -1
    v_cmp_lt_u32 vcc, 16, v89
    s_cmp_eq_u64 vcc, 0
    s_cbranch_scc1 F_no3b
    ds_bpermute_b32 v68, v68, v6
    ds_bpermute_b32 v69, v69, v6
    ds_bpermute_b32 v70, v70, v6
    ds_bpermute_b32 v71, v71, v6
    s_waitcnt lgkmcnt(0)
    v_cmp_lt_i32 vcc, 16, v56
    s_mov_b64 exec, vcc
    s_cbranch_execz F_u0
    v_and_b32 v2, 0x3ffff, v68
    v_bfe_u32 v3, v68, 18, 3
    v_and_b32 v4, 0x7ff, v42
    v_lshl_add_u32 v3, v3, 9, v2
    v_lshl_add_u32 v4, v4, 5, v90
    v_lshl_add_u32 v2, v80, 5, v2
    v_lshl_add_u32 v3, v80, 3, v3
    v_or_b32 v5, 16, v4
    ds_write2_b32 v2, v4, v5 offset0:0 offset1:4
    ds_write_b64 v3, v[40:41]
F_u0:
    s_mov_b64 exec, -1
    v_cmp_lt_i32 vcc, 16, v57
    s_mov_b64 exec, vcc
    s_cbranch_execz F_u1
    v_and_b32 v2, 0x3ffff, v69
    v_bfe_u32 v3, v69, 18, 3
    v_and_b32 v4, 0x7ff, v46
    v_lshl_add_u32 v3, v3, 9, v2
    v_lshl_add_u32 v4, v4, 5, v90
    v_lshl_add_u32 v2, v81, 5, v2
    v_add_u32 v4, 327680, v4
    v_lshl_add_u32 v3, v81, 3, v3
    v_or_b32 v5, 16, v4
    ds_write2_b32 v2, v4, v5 offset0:0 offset1:4
    ds_write_b64 v3, v[44:45]
F_u1:
    s_mov_b64 exec, -1
    v_cmp_lt_i32 vcc, 16, v58
    s_mov_b64 exec, vcc
    s_cbranch_execz F_u2
    v_and_b32 v2, 0x3ffff, v70
    v_bfe_u32 v3, v70, 18, 3
    v_and_b32 v4, 0x7ff, v50
    v_lshl_add_u32 v3, v3, 9, v2
    v_lshl_add_u32 v4, v4, 5, v90
    v_lshl_add_u32 v2, v82, 5, v2
    v_add_u32 v4, 655360, v4
    v_lshl_add_u32 v3, v82, 3, v3
    v_or_b32 v5, 16, v4
    ds_write2_b32 v2, v4, v5 offset0:0 offset1:4
    ds_write_b64 v3, v[48:49]
F_u2:
    s_mov_b64 exec, -1
    v_cmp_lt_i32 vcc, 16, v59
    s_mov_b64 exec, vcc
    s_cbranch_execz F_u3
    v_and_b32 v2, 0x3ffff, v71
    v_bfe_u32 v3, v71, 18, 3
    v_and_b32 v4, 0x7ff, v54
    v_lshl_add_u32 v3, v3, 9, v2
    v_lshl_add_u32 v4, v4, 5, v90
    v_lshl_add_u32 v2, v83, 5, v2
    v_add_u32 v4, 983040, v4
    v_lshl_add_u32 v3, v83, 3, v3
    v_or_b32 v5, 16, v4
    ds_write2_b32 v2, v4, v5 offset0:0 offset1:4
    ds_write_b64 v3, v[52:53]
F_u3:
    s_mov_b64 exec, -1
F_no3b:
    s_mov_b32 s22, s80
    s_mov_b32 s23, s81
    s_mov_b32 s24, s82
    s_mov_b32 s25, s83
    s_mov_b32 s26, s84
    s_mov_b32 s27, s80
    s_mov_b32 s71, s80
    s_bfe_u32 s46, s71, 0x30012
    s_mov_b32 m0, s46
    s_and_b32 s66, s71, 0x3ffff
    s_movrels_b32 s68, s57
    s_movrels_b32 s69, s61
    s_sub_u32 s48, s66, s47
    s_mov_b32 s47, s66
    s_lshr_b32 s52, s71, 28
    s_lshl_b32 s67, s46, 9
    s_add_u32 s66, s66, s67
    s_sub_u32 s49, s66, s42
    s_mov_b32 s42, s66
    s_bfe_u32 s66, s68, 655360
    s_add_u32 s43, s42, s66
    s_bfe_u32 s39, s69, 655360
    s_bfe_u32 s66, s68, 655370
    s_add_u32 s44, s42, s66
    s_bfe_u32 s40, s69, 655370
    s_bfe_u32 s66, s68, 655380
    s_add_u32 s45, s42, s66
    s_bfe_u32 s41, s69, 655380
    s_and_b32 s66, s46, s33
    s_cselect_b32 s72, -1, 1
    s_cselect_b32 s76, s47, 163712
    s_cmp_ge_u32 s66, 2
    s_cselect_b32 s73, -1, 0
    s_add_u32 s77, s47, 1024
    s_cmp_ge_u32 s66, 4
    s_cselect_b32 s75, -1, 0
    s_cmp_ge_u32 s66, 3
    s_cselect_b32 s74, -1, 1
    s_cselect_b32 s77, s77, 163712
    s_mul_i32 s66, s20, 80
    v_min_u32 v2, 76, v248
    s_waitcnt lgkmcnt(0)
    s_barrier
    v_lshl_add_u32 v253, v248, 2, s47
    ds_read_b32 v254, v253
    ds_read_b32 v255, v253 offset:1024
    v_add_u32 v252, s42, v247
    ds_read_u16 v234, v252
    ds_read_u16 v235, v252 offset:64
    v_add_u32 v252, s43, v247
    ds_read_u16 v236, v252
    ds_read_u16 v237, v252 offset:64
    v_add_u32 v252, s44, v247
    ds_read_u16 v238, v252
    ds_read_u16 v239, v252 offset:64
    v_add_u32 v252, s45, v247
    ds_read_u16 v240, v252
    ds_read_u16 v241, v252 offset:64
    buffer_load_dword v3, v2, s[16:19], s66 offen offset:128 sc1
    v_add_u32 v249, s48, v249
    v_add_u32 v250, s49, v250
    s_waitcnt lgkmcnt(8)
    s_mov_b32 m0, s76
    s_mov_b64 exec, s[72:73]
    buffer_load_dwordx4 v254, s[12:15], 0 offen  lds
    s_mov_b32 m0, s77
    s_mov_b64 exec, s[74:75]
    buffer_load_dwordx4 v255, s[12:15], 0 offen  lds
    s_mov_b64 exec, -1
    s_waitcnt lgkmcnt(0)
    s_add_u32 m0, s21, 0
    v_lshl_add_u32 v234, v234, 10, v246
    v_lshl_add_u32 v235, v235, 10, v246
    buffer_load_dwordx4 v234, s[4:7], s38 offen lds
    buffer_load_dwordx4 v235, s[8:11], s38 offen offset:1024 lds
    s_add_u32 m0, s21, 2048
    v_lshl_add_u32 v236, v236, 10, v246
    v_lshl_add_u32 v237, v237, 10, v246
    buffer_load_dwordx4 v236, s[4:7], s39 offen lds
    buffer_load_dwordx4 v237, s[8:11], s39 offen offset:1024 lds
    s_add_u32 m0, s21, 4096
    v_lshl_add_u32 v238, v238, 10, v246
    v_lshl_add_u32 v239, v239, 10, v246
    buffer_load_dwordx4 v238, s[4:7], s40 offen lds
    buffer_load_dwordx4 v239, s[8:11], s40 offen offset:1024 lds
    s_add_u32 m0, s21, 6144
    v_lshl_add_u32 v240, v240, 10, v246
    v_lshl_add_u32 v241, v241, 10, v246
    buffer_load_dwordx4 v240, s[4:7], s41 offen lds
    buffer_load_dwordx4 v241, s[8:11], s41 offen offset:1024 lds
    v_mov_b32 v252, 0
    s_waitcnt vmcnt(6)
    v_cmp_ne_u32 vcc, s88, v3
    ds_read_b64_tr_b16 v[176:177], v244 offset:0
    ds_read_b64_tr_b16 v[178:179], v244 offset:1024
    ds_read_b64_tr_b16 v[180:181], v245 offset:0
    ds_read_b64_tr_b16 v[182:183], v245 offset:1024
    ds_read_b64_tr_b16 v[68:69], v249 offset:0
    ds_read_b64_tr_b16 v[70:71], v249 offset:256
    s_mov_b64 exec, s[54:55]
    ds_read_u16_d16_hi v242, v250 offset:0
    s_mov_b64 exec, -1
    s_or_b32 s89, vcc_lo, vcc_hi
    s_waitcnt lgkmcnt(3)
    v_readfirstlane_b32 s66, v252
    s_add_u32 s53, s53, 1
    v_mov_b32 v252, s53
    s_cmp_le_u32 s53, s66
    ds_write2_b32 v251, v252, v252 offset0:0 offset1:8
    s_setprio 1
    s_cbranch_scc1 PRIO_1
    s_setprio 0
PRIO_1:
    s_cmp_eq_u32 s52, 4
    s_cbranch_scc1 ITEM_0_4
    s_cmp_eq_u32 s52, 5
    s_cbranch_scc1 ITEM_0_5
    s_cmp_eq_u32 s52, 3
    s_cbranch_scc1 ITEM_0_3
    s_cmp_eq_u32 s52, 6
    s_cbranch_scc1 ITEM_0_6
    s_cmp_eq_u32 s52, 8
    s_cbranch_scc1 ITEM_0_8
    s_branch ITEM_0_2
LAST0:
    s_cmp_eq_u32 s50, 5
    s_cbranch_scc1 TO_PHASE1
    s_add_u32 s4, s4, 128
    s_addc_u32 s5, s5, 0
    s_add_u32 s8, s8, 128
    s_addc_u32 s9, s9, 0
    s_mov_b32 s34, 0
    s_mov_b32 s35, 256
    s_mov_b32 s36, 512
    s_mov_b32 s37, 768
    s_mov_b32 s33, 0
    s_waitcnt lgkmcnt(3)
    v_readfirstlane_b32 s66, v252
    s_add_u32 s53, s53, 1
    v_mov_b32 v252, s53
    s_cmp_le_u32 s53, s66
    ds_write2_b32 v251, v252, v252 offset0:0 offset1:8
    s_setprio 1
    s_cbranch_scc1 PRIO_2
    s_setprio 0
PRIO_2:
    s_cmp_eq_u32 s52, 4
    s_cbranch_scc1 ITEM_0_4
    s_cmp_eq_u32 s52, 5
    s_cbranch_scc1 ITEM_0_5
    s_cmp_eq_u32 s52, 3
    s_cbranch_scc1 ITEM_0_3
    s_cmp_eq_u32 s52, 6
    s_cbranch_scc1 ITEM_0_6
    s_cmp_eq_u32 s52, 8
    s_cbranch_scc1 ITEM_0_8
    s_branch ITEM_0_2
TO_PHASE1:
    v_lshlrev_b32 v253, 2, v248
    v_add_u32 v253, 65536, v253
    ds_read_b128 v[96:99], v253 offset:0
    ds_read_b128 v[100:103], v253 offset:1024
    ds_read_b128 v[104:107], v253 offset:2048
    ds_read_b128 v[108:111], v253 offset:3072
    ds_read_b128 v[112:115], v253 offset:4096
    ds_read_b128 v[116:119], v253 offset:5120
    ds_read_b128 v[120:123], v253 offset:6144
    ds_read_b128 v[124:127], v253 offset:7168
    ds_read_b128 v[128:131], v253 offset:8192
    ds_read_b128 v[132:135], v253 offset:9216
    ds_read_b128 v[136:139], v253 offset:10240
    ds_read_b128 v[140:143], v253 offset:11264
    ds_read_b128 v[144:147], v253 offset:12288
    ds_read_b128 v[148:151], v253 offset:13312
    ds_read_b128 v[152:155], v253 offset:14336
    ds_read_b128 v[156:159], v253 offset:15360
    ds_read_b128 v[160:163], v253 offset:16384
    ds_read_b128 v[164:167], v253 offset:17408
    ds_read_b128 v[168:171], v253 offset:18432
    ds_read_b128 v[172:175], v253 offset:19456
    s_mov_b32 s34, 128
    s_mov_b32 s35, 384
    s_mov_b32 s36, 640
    s_mov_b32 s37, 896
    s_mov_b32 s50, 0
    s_waitcnt lgkmcnt(0)
    s_waitcnt lgkmcnt(0)
    v_readfirstlane_b32 s66, v252
    s_add_u32 s53, s53, 1
    v_mov_b32 v252, s53
    s_cmp_le_u32 s53, s66
    ds_write2_b32 v251, v252, v252 offset0:0 offset1:8
    s_setprio 1
    s_cbranch_scc1 PRIO_3
    s_setprio 0
PRIO_3:
    s_cmp_eq_u32 s52, 4
    s_cbranch_scc1 ITEM_1_4
    s_cmp_eq_u32 s52, 5
    s_cbranch_scc1 ITEM_1_5
    s_cmp_eq_u32 s52, 3
    s_cbranch_scc1 ITEM_1_3
    s_cmp_eq_u32 s52, 6
    s_cbranch_scc1 ITEM_1_6
    s_cmp_eq_u32 s52, 8
    s_cbranch_scc1 ITEM_1_8
    s_branch ITEM_1_2
.p2align 6
ITEM_0_4:
    s_mov_b64 exec, s[54:55]
    ds_read_u16_d16_hi v243, v250 offset:128
    s_mov_b64 exec, -1
    ds_read_b64_tr_b16 v[76:77], v249 offset:512
    ds_read_b64_tr_b16 v[78:79], v249 offset:768
    s_waitcnt lgkmcnt(3)
    v_lshlrev_b32 v196, 16, v68
    v_and_b32 v197, 0xffff0000, v68
    v_lshlrev_b32 v198, 16, v69
    v_and_b32 v199, 0xffff0000, v69
    v_mul_f32_dpp v200, v242, v196 row_newbcast:0 row_mask:0xf bank_mask:0xf
    v_mul_f32_dpp v201, v242, v197 row_newbcast:1 row_mask:0xf bank_mask:0xf
    v_mul_f32_dpp v202, v242, v196 row_newbcast:8 row_mask:0xf bank_mask:0xf
    v_mul_f32_dpp v203, v242, v197 row_newbcast:9 row_mask:0xf bank_mask:0xf
    v_lshlrev_b32 v196, 16, v70
    v_and_b32 v197, 0xffff0000, v70
    v_cvt_pk_bf16_f32 v64, v200, v201
    v_cvt_pk_bf16_f32 v68, v202, v203
    v_mul_f32_dpp v200, v242, v198 row_newbcast:2 row_mask:0xf bank_mask:0xf
    v_mul_f32_dpp v201, v242, v199 row_newbcast:3 row_mask:0xf bank_mask:0xf
    v_mul_f32_dpp v202, v242, v198 row_newbcast:10 row_mask:0xf bank_mask:0xf
    v_mul_f32_dpp v203, v242, v199 row_newbcast:11 row_mask:0xf bank_mask:0xf
    v_lshlrev_b32 v198, 16, v71
    v_and_b32 v199, 0xffff0000, v71
    v_cvt_pk_bf16_f32 v65, v200, v201
    v_cvt_pk_bf16_f32 v69, v202, v203
    v_mul_f32_dpp v200, v242, v196 row_newbcast:4 row_mask:0xf bank_mask:0xf
    v_mul_f32_dpp v201, v242, v197 row_newbcast:5 row_mask:0xf bank_mask:0xf
    v_mul_f32_dpp v202, v242, v196 row_newbcast:12 row_mask:0xf bank_mask:0xf
    v_mul_f32_dpp v203, v242, v197 row_newbcast:13 row_mask:0xf bank_mask:0xf
    v_cvt_pk_bf16_f32 v66, v200, v201
    v_cvt_pk_bf16_f32 v70, v202, v203
    v_mul_f32_dpp v200, v242, v198 row_newbcast:6 row_mask:0xf bank_mask:0xf
    v_mul_f32_dpp v201, v242, v199 row_newbcast:7 row_mask:0xf bank_mask:0xf
    v_mul_f32_dpp v202, v242, v198 row_newbcast:14 row_mask:0xf bank_mask:0xf
    v_mul_f32_dpp v203, v242, v199 row_newbcast:15 row_mask:0xf bank_mask:0xf
    v_cvt_pk_bf16_f32 v67, v200, v201
    v_cvt_pk_bf16_f32 v71, v202, v203
    s_nop 0
    s_waitcnt vmcnt(4) lgkmcnt(0)
    v_mfma_f32_32x32x16_bf16 v[0:15], v[64:67], v[176:179], 0
    v_lshlrev_b32 v196, 16, v76
    v_and_b32 v197, 0xffff0000, v76
    v_lshlrev_b32 v198, 16, v77
    v_and_b32 v199, 0xffff0000, v77
    v_mul_f32_dpp v200, v243, v196 row_newbcast:0 row_mask:0xf bank_mask:0xf
    v_mul_f32_dpp v201, v243, v197 row_newbcast:1 row_mask:0xf bank_mask:0xf
    v_mul_f32_dpp v202, v243, v196 row_newbcast:8 row_mask:0xf bank_mask:0xf
    v_mul_f32_dpp v203, v243, v197 row_newbcast:9 row_mask:0xf bank_mask:0xf
    v_lshlrev_b32 v196, 16, v78
    v_and_b32 v197, 0xffff0000, v78
    v_cvt_pk_bf16_f32 v72, v200, v201
    v_cvt_pk_bf16_f32 v76, v202, v203
    v_mul_f32_dpp v200, v243, v198 row_newbcast:2 row_mask:0xf bank_mask:0xf
    v_mul_f32_dpp v201, v243, v199 row_newbcast:3 row_mask:0xf bank_mask:0xf
    v_mul_f32_dpp v202, v243, v198 row_newbcast:10 row_mask:0xf bank_mask:0xf
    v_mul_f32_dpp v203, v243, v199 row_newbcast:11 row_mask:0xf bank_mask:0xf
    s_add_u32 m0, s21, 0
    v_mfma_f32_32x32x16_bf16 v[16:31], v[68:71], v[176:179], 0
    buffer_load_dwordx4 v234, s[4:7], s36 offen lds
    buffer_load_dwordx4 v235, s[8:11], s36 offen offset:1024 lds
    ds_read_b64_tr_b16 v[176:177], v244 offset:2048
    ds_read_b64_tr_b16 v[178:179], v244 offset:3072
    ds_read_b64_tr_b16 v[184:185], v245 offset:2048
    ds_read_b64_tr_b16 v[186:187], v245 offset:3072
    v_lshlrev_b32 v198, 16, v79
    v_and_b32 v199, 0xffff0000, v79
    v_cvt_pk_bf16_f32 v73, v200, v201
    v_cvt_pk_bf16_f32 v77, v202, v203
    v_mul_f32_dpp v200, v243, v196 row_newbcast:4 row_mask:0xf bank_mask:0xf
    v_mul_f32_dpp v201, v243, v197 row_newbcast:5 row_mask:0xf bank_mask:0xf
    v_mul_f32_dpp v202, v243, v196 row_newbcast:12 row_mask:0xf bank_mask:0xf
    v_mul_f32_dpp v203, v243, v197 row_newbcast:13 row_mask:0xf bank_mask:0xf
    v_cvt_pk_bf16_f32 v74, v200, v201
    v_cvt_pk_bf16_f32 v78, v202, v203
    v_mul_f32_dpp v200, v243, v198 row_newbcast:6 row_mask:0xf bank_mask:0xf
    v_mul_f32_dpp v201, v243, v199 row_newbcast:7 row_mask:0xf bank_mask:0xf
    v_mul_f32_dpp v202, v243, v198 row_newbcast:14 row_mask:0xf bank_mask:0xf
    v_mul_f32_dpp v203, v243, v199 row_newbcast:15 row_mask:0xf bank_mask:0xf
    v_cvt_pk_bf16_f32 v75, v200, v201
    v_cvt_pk_bf16_f32 v79, v202, v203
    s_nop 0
    s_waitcnt lgkmcnt(0)
    v_mfma_f32_32x32x16_bf16 v[0:15], v[72:75], v[176:179], v[0:15]
    s_add_u32 m0, s21, 2048
    v_mfma_f32_32x32x16_bf16 v[16:31], v[76:79], v[176:179], v[16:31]
    buffer_load_dwordx4 v236, s[4:7], s36 offen lds
    buffer_load_dwordx4 v237, s[8:11], s36 offen offset:1024 lds
    s_mov_b32 m0, s50
    s_nop 0
    s_movrels_b32 s71, s23
    s_bfe_u32 s46, s71, 0x30012
    s_mov_b32 m0, s46
    s_and_b32 s66, s71, 0x3ffff
    s_movrels_b32 s68, s57
    s_movrels_b32 s69, s61
    s_sub_u32 s48, s66, s47
    s_mov_b32 s47, s66
    s_lshr_b32 s52, s71, 28
    s_lshl_b32 s67, s46, 9
    s_add_u32 s66, s66, s67
    s_sub_u32 s49, s66, s42
    s_mov_b32 s42, s66
    s_bfe_u32 s66, s68, 655360
    s_add_u32 s43, s42, s66
    s_bfe_u32 s39, s69, 655360
    s_bfe_u32 s66, s68, 655370
    s_add_u32 s44, s42, s66
    s_bfe_u32 s40, s69, 655370
    s_bfe_u32 s66, s68, 655380
    s_add_u32 s45, s42, s66
    s_bfe_u32 s41, s69, 655380
    s_and_b32 s66, s46, s33
    s_cselect_b32 s72, -1, 1
    s_cselect_b32 s76, s47, 163712
    s_cmp_ge_u32 s66, 2
    s_cselect_b32 s73, -1, 0
    s_add_u32 s77, s47, 1024
    s_cmp_ge_u32 s66, 4
    s_cselect_b32 s75, -1, 0
    s_cmp_ge_u32 s66, 3
    s_cselect_b32 s74, -1, 1
    s_cselect_b32 s77, s77, 163712
    v_add_u32 v252, s44, v247
    ds_read_u16 v238, v252
    ds_read_u16 v239, v252 offset:64
    v_add_u32 v252, s45, v247
    ds_read_u16 v240, v252
    ds_read_u16 v241, v252 offset:64
    v_mfma_f32_32x32x16_bf16 v[32:47], v[64:67], v[180:183], 0
    v_mul_f32 v196, v0, v96
    v_fmac_f32 v196, v1, v97
    v_fmac_f32 v196, v2, v98
    v_fmac_f32 v196, v3, v99
    v_fmac_f32 v196, v4, v100
    v_fmac_f32 v196, v5, v101
    v_fmac_f32 v196, v6, v102
    v_fmac_f32 v196, v7, v103
    v_mul_f32 v198, v8, v128
    v_fmac_f32 v198, v9, v129
    v_mfma_f32_32x32x16_bf16 v[48:63], v[68:71], v[180:183], 0
    v_lshl_add_u32 v253, v248, 2, s47
    ds_read_b32 v254, v253
    ds_read_b32 v255, v253 offset:1024
    s_waitcnt vmcnt(6)
    ds_read_b64_tr_b16 v[176:177], v244 offset:4096
    ds_read_b64_tr_b16 v[178:179], v244 offset:5120
    ds_read_b64_tr_b16 v[180:181], v245 offset:4096
    ds_read_b64_tr_b16 v[182:183], v245 offset:5120
    v_fmac_f32 v198, v10, v130
    v_fmac_f32 v198, v11, v131
    v_fmac_f32 v198, v12, v132
    v_fmac_f32 v198, v13, v133
    v_fmac_f32 v198, v14, v134
    v_fmac_f32 v198, v15, v135
    v_mul_f32 v200, v16, v128
    v_fmac_f32 v200, v17, v129
    v_permlane32_swap_b32 v196, v198
    v_mfma_f32_32x32x16_bf16 v[32:47], v[72:75], v[184:187], v[32:47]
    v_fmac_f32 v200, v18, v130
    v_fmac_f32 v200, v19, v131
    v_fmac_f32 v200, v20, v132
    v_fmac_f32 v200, v21, v133
    v_fmac_f32 v200, v22, v134
    v_fmac_f32 v200, v23, v135
    v_add_f32 v198, v196, v198
    v_mul_f32_e64 v202, v24, -v128
    v_fma_f32 v202, v25, -v129, v202
    v_mfma_f32_32x32x16_bf16 v[48:63], v[76:79], v[184:187], v[48:63]
    v_fma_f32 v202, v26, -v130, v202
    v_fma_f32 v202, v27, -v131, v202
    v_fma_f32 v202, v28, -v132, v202
    v_fma_f32 v202, v29, -v133, v202
    v_fma_f32 v202, v30, -v134, v202
    v_fma_f32 v202, v31, -v135, v202
    s_nop 1
    v_permlane32_swap_b32 v200, v202
    v_add_f32 v202, v200, v202
    s_waitcnt vmcnt(4) lgkmcnt(0)
    v_mfma_f32_32x32x16_bf16 v[0:15], v[64:67], v[176:179], 0
    v_mul_f32 v197, v32, v104
    v_fmac_f32 v197, v33, v105
    v_fmac_f32 v197, v34, v106
    v_fmac_f32 v197, v35, v107
    v_fmac_f32 v197, v36, v108
    v_fmac_f32 v197, v37, v109
    v_fmac_f32 v197, v38, v110
    v_fmac_f32 v197, v39, v111
    v_mul_f32 v199, v40, v136
    v_fmac_f32 v199, v41, v137
    v_fmac_f32 v199, v42, v138
    s_add_u32 m0, s21, 4096
    v_mfma_f32_32x32x16_bf16 v[16:31], v[68:71], v[176:179], 0
    buffer_load_dwordx4 v234, s[4:7], s37 offen lds
    buffer_load_dwordx4 v235, s[8:11], s37 offen offset:1024 lds
    ds_read_b64_tr_b16 v[176:177], v244 offset:6144
    ds_read_b64_tr_b16 v[178:179], v244 offset:7168
    ds_read_b64_tr_b16 v[184:185], v245 offset:6144
    ds_read_b64_tr_b16 v[186:187], v245 offset:7168
    v_add_u32 v252, s42, v247
    ds_read_u16 v234, v252
    ds_read_u16 v235, v252 offset:64
    s_mov_b32 m0, s76
    s_mov_b64 exec, s[72:73]
    buffer_load_dwordx4 v254, s[12:15], 0 offen  lds
    s_mov_b32 m0, s77
    s_mov_b64 exec, s[74:75]
    buffer_load_dwordx4 v255, s[12:15], 0 offen  lds
    s_mov_b64 exec, -1
    v_fmac_f32 v199, v43, v139
    v_fmac_f32 v199, v44, v140
    v_fmac_f32 v199, v45, v141
    v_fmac_f32 v199, v46, v142
    v_fmac_f32 v199, v47, v143
    v_mul_f32 v201, v48, v136
    v_fmac_f32 v201, v49, v137
    v_permlane32_swap_b32 v197, v199
    v_fmac_f32 v201, v50, v138
    v_fmac_f32 v201, v51, v139
    s_waitcnt lgkmcnt(2)
    v_mfma_f32_32x32x16_bf16 v[0:15], v[72:75], v[176:179], v[0:15]
    v_fmac_f32 v201, v52, v140
    v_fmac_f32 v201, v53, v141
    v_fmac_f32 v201, v54, v142
    v_fmac_f32 v201, v55, v143
    v_add_f32 v199, v197, v199
    v_mul_f32_e64 v203, v56, -v136
    v_fma_f32 v203, v57, -v137, v203
    v_fma_f32 v203, v58, -v138, v203
    v_fma_f32 v203, v59, -v139, v203
    v_fma_f32 v203, v60, -v140, v203
    v_fma_f32 v203, v61, -v141, v203
    s_add_u32 m0, s21, 6144
    v_mfma_f32_32x32x16_bf16 v[16:31], v[76:79], v[176:179], v[16:31]
    buffer_load_dwordx4 v236, s[4:7], s37 offen lds
    buffer_load_dwordx4 v237, s[8:11], s37 offen offset:1024 lds
    v_add_u32 v252, s43, v247
    ds_read_u16 v236, v252
    ds_read_u16 v237, v252 offset:64
    v_fma_f32 v203, v62, -v142, v203
    v_fma_f32 v203, v63, -v143, v203
    s_nop 1
    v_permlane32_swap_b32 v201, v203
    v_add_f32 v203, v201, v203
    s_set_gpr_idx_on s51, gpr_idx(DST)
    s_nop 0
    v_cvt_pk_bf16_f32 v204, v198, v199
    v_cvt_pk_bf16_f32 v205, v202, v203
    s_set_gpr_idx_off
    v_mfma_f32_32x32x16_bf16 v[32:47], v[64:67], v[180:183], 0
    v_mul_f32 v196, v0, v144
    v_fmac_f32 v196, v1, v145
    v_fmac_f32 v196, v2, v146
    v_fmac_f32 v196, v3, v147
    v_fmac_f32 v196, v4, v148
    v_fmac_f32 v196, v5, v149
    v_fmac_f32 v196, v6, v150
    v_fmac_f32 v196, v7, v151
    v_mfma_f32_32x32x16_bf16 v[48:63], v[68:71], v[180:183], 0
    s_waitcnt vmcnt(8)
    ds_read_b64_tr_b16 v[176:177], v244 offset:0
    ds_read_b64_tr_b16 v[178:179], v244 offset:1024
    ds_read_b64_tr_b16 v[180:181], v245 offset:0
    ds_read_b64_tr_b16 v[182:183], v245 offset:1024
    v_mul_f32 v198, v8, v112
    v_fmac_f32 v198, v9, v113
    v_fmac_f32 v198, v10, v114
    v_fmac_f32 v198, v11, v115
    v_fmac_f32 v198, v12, v116
    v_fmac_f32 v198, v13, v117
    v_fmac_f32 v198, v14, v118
    v_fmac_f32 v198, v15, v119
    v_mfma_f32_32x32x16_bf16 v[32:47], v[72:75], v[184:187], v[32:47]
    v_mul_f32_e64 v200, v16, -v160
    v_fma_f32 v200, v17, -v161, v200
    v_fma_f32 v200, v18, -v162, v200
    v_fma_f32 v200, v19, -v163, v200
    v_fma_f32 v200, v20, -v164, v200
    v_fma_f32 v200, v21, -v165, v200
    v_fma_f32 v200, v22, -v166, v200
    v_fma_f32 v200, v23, -v167, v200
    v_mfma_f32_32x32x16_bf16 v[48:63], v[76:79], v[184:187], v[48:63]
    v_mul_f32_e64 v202, v24, -v160
    v_fma_f32 v202, v25, -v161, v202
    v_fma_f32 v202, v26, -v162, v202
    v_fma_f32 v202, v27, -v163, v202
    v_fma_f32 v202, v28, -v164, v202
    v_fma_f32 v202, v29, -v165, v202
    v_fma_f32 v202, v30, -v166, v202
    v_fma_f32 v202, v31, -v167, v202
    s_waitcnt vmcnt(6) lgkmcnt(0)
    v_mfma_f32_32x32x16_bf16 v[0:15], v[64:67], v[176:179], 0
    v_mul_f32 v197, v32, v152
    v_fmac_f32 v197, v33, v153
    v_fmac_f32 v197, v34, v154
    v_fmac_f32 v197, v35, v155
    v_fmac_f32 v197, v36, v156
    v_fmac_f32 v197, v37, v157
    v_fmac_f32 v197, v38, v158
    v_fmac_f32 v197, v39, v159
    s_add_u32 m0, s21, 0
    v_mfma_f32_32x32x16_bf16 v[16:31], v[68:71], v[176:179], 0
    v_lshl_add_u32 v234, v234, 10, v246
    v_lshl_add_u32 v235, v235, 10, v246
    buffer_load_dwordx4 v234, s[4:7], s38 offen lds
    buffer_load_dwordx4 v235, s[8:11], s38 offen offset:1024 lds
    ds_read_b64_tr_b16 v[176:177], v244 offset:2048
    ds_read_b64_tr_b16 v[178:179], v244 offset:3072
    ds_read_b64_tr_b16 v[184:185], v245 offset:2048
    ds_read_b64_tr_b16 v[186:187], v245 offset:3072
    v_mul_f32 v199, v40, v120
    v_fmac_f32 v199, v41, v121
    v_fmac_f32 v199, v42, v122
    v_fmac_f32 v199, v43, v123
    v_fmac_f32 v199, v44, v124
    v_fmac_f32 v199, v45, v125
    v_fmac_f32 v199, v46, v126
    v_fmac_f32 v199, v47, v127
    s_waitcnt lgkmcnt(0)
    v_mfma_f32_32x32x16_bf16 v[0:15], v[72:75], v[176:179], v[0:15]
    v_mul_f32_e64 v201, v48, -v168
    v_fma_f32 v201, v49, -v169, v201
    v_fma_f32 v201, v50, -v170, v201
    v_fma_f32 v201, v51, -v171, v201
    v_fma_f32 v201, v52, -v172, v201
    v_fma_f32 v201, v53, -v173, v201
    v_fma_f32 v201, v54, -v174, v201
    v_fma_f32 v201, v55, -v175, v201
    s_add_u32 m0, s21, 2048
    v_mfma_f32_32x32x16_bf16 v[16:31], v[76:79], v[176:179], v[16:31]
    v_lshl_add_u32 v236, v236, 10, v246
    v_lshl_add_u32 v237, v237, 10, v246
    buffer_load_dwordx4 v236, s[4:7], s39 offen lds
    buffer_load_dwordx4 v237, s[8:11], s39 offen offset:1024 lds
    v_mul_f32_e64 v203, v56, -v168
    v_fma_f32 v203, v57, -v169, v203
    v_fma_f32 v203, v58, -v170, v203
    v_fma_f32 v203, v59, -v171, v203
    v_fma_f32 v203, v60, -v172, v203
    v_fma_f32 v203, v61, -v173, v203
    v_fma_f32 v203, v62, -v174, v203
    v_fma_f32 v203, v63, -v175, v203
    v_mfma_f32_32x32x16_bf16 v[32:47], v[64:67], v[180:183], 0
    v_mul_f32 v254, v0, v144
    v_fmac_f32 v254, v1, v145
    v_fmac_f32 v254, v2, v146
    v_fmac_f32 v254, v3, v147
    v_fmac_f32 v254, v4, v148
    v_mfma_f32_32x32x16_bf16 v[48:63], v[68:71], v[180:183], 0
    ds_swizzle_b32 v68, v68 offset:0x401F
    ds_swizzle_b32 v69, v69 offset:0x401F
    ds_swizzle_b32 v70, v70 offset:0x401F
    ds_swizzle_b32 v71, v71 offset:0x401F
    s_waitcnt vmcnt(8)
    ds_read_b64_tr_b16 v[176:177], v244 offset:4096
    ds_read_b64_tr_b16 v[178:179], v244 offset:5120
    ds_read_b64_tr_b16 v[180:181], v245 offset:4096
    ds_read_b64_tr_b16 v[182:183], v245 offset:5120
    v_fmac_f32 v254, v5, v149
    v_fmac_f32 v254, v6, v150
    v_fmac_f32 v254, v7, v151
    v_fmac_f32 v200, v8, v160
    v_mfma_f32_32x32x16_bf16 v[32:47], v[72:75], v[184:187], v[32:47]
    v_fmac_f32 v200, v9, v161
    v_permlane32_swap_b32 v196, v254
    v_fmac_f32 v200, v10, v162
    v_fmac_f32 v200, v11, v163
    v_fmac_f32 v200, v12, v164
    v_mfma_f32_32x32x16_bf16 v[48:63], v[76:79], v[184:187], v[48:63]
    ds_swizzle_b32 v76, v76 offset:0x401F
    ds_swizzle_b32 v77, v77 offset:0x401F
    ds_swizzle_b32 v78, v78 offset:0x401F
    ds_swizzle_b32 v79, v79 offset:0x401F
    v_fmac_f32 v200, v13, v165
    v_fmac_f32 v200, v14, v166
    v_fmac_f32 v200, v15, v167
    v_add_f32 v254, v196, v254
    s_waitcnt lgkmcnt(8)
    s_mov_b64 exec, s[56:57]
    v_xor_b32 v68, 0x80008000, v68
    v_xor_b32 v69, 0x80008000, v69
    v_xor_b32 v70, 0x80008000, v70
    v_xor_b32 v71, 0x80008000, v71
    s_mov_b64 exec, -1
    s_waitcnt vmcnt(4) lgkmcnt(4)
    v_mfma_f32_32x32x16_bf16 v[0:15], v[64:67], v[176:179], 0
    v_mul_f32 v255, v32, v152
    v_fmac_f32 v255, v33, v153
    v_fmac_f32 v255, v34, v154
    v_fmac_f32 v255, v35, v155
    v_fmac_f32 v255, v36, v156
    v_fmac_f32 v255, v37, v157
    s_add_u32 m0, s21, 4096
    v_mfma_f32_32x32x16_bf16 v[16:31], v[68:71], v[176:179], v[16:31]
    v_lshl_add_u32 v238, v238, 10, v246
    v_lshl_add_u32 v239, v239, 10, v246
    buffer_load_dwordx4 v238, s[4:7], s40 offen lds
    buffer_load_dwordx4 v239, s[8:11], s40 offen offset:1024 lds
    ds_read_b64_tr_b16 v[176:177], v244 offset:6144
    ds_read_b64_tr_b16 v[178:179], v244 offset:7168
    ds_read_b64_tr_b16 v[184:185], v245 offset:6144
    ds_read_b64_tr_b16 v[186:187], v245 offset:7168
    v_fmac_f32 v255, v38, v158
    v_fmac_f32 v255, v39, v159
    v_fmac_f32 v201, v40, v168
    v_fmac_f32 v201, v41, v169
    v_permlane32_swap_b32 v197, v255
    s_waitcnt lgkmcnt(0)
    s_mov_b64 exec, s[56:57]
    v_xor_b32 v76, 0x80008000, v76
    v_xor_b32 v77, 0x80008000, v77
    v_xor_b32 v78, 0x80008000, v78
    v_xor_b32 v79, 0x80008000, v79
    s_mov_b64 exec, -1
    v_mfma_f32_32x32x16_bf16 v[0:15], v[72:75], v[176:179], v[0:15]
    v_fmac_f32 v201, v42, v170
    v_fmac_f32 v201, v43, v171
    v_fmac_f32 v201, v44, v172
    v_fmac_f32 v201, v45, v173
    v_fmac_f32 v201, v46, v174
    v_fmac_f32 v201, v47, v175
    s_add_u32 m0, s21, 6144
    v_mfma_f32_32x32x16_bf16 v[16:31], v[76:79], v[176:179], v[16:31]
    v_lshl_add_u32 v240, v240, 10, v246
    v_lshl_add_u32 v241, v241, 10, v246
    buffer_load_dwordx4 v240, s[4:7], s41 offen lds
    buffer_load_dwordx4 v241, s[8:11], s41 offen offset:1024 lds
    v_add_f32 v255, v197, v255
    s_set_gpr_idx_on s51, gpr_idx(DST)
    s_nop 0
    v_cvt_pk_bf16_f32 v206, v254, v255
    s_set_gpr_idx_off
    v_mfma_f32_32x32x16_bf16 v[32:47], v[64:67], v[180:183], 0
    v_mul_f32 v254, v0, v144
    v_fmac_f32 v254, v1, v145
    v_fmac_f32 v254, v2, v146
    v_fmac_f32 v254, v3, v147
    v_fmac_f32 v254, v4, v148
    v_fmac_f32 v254, v5, v149
    v_fmac_f32 v254, v6, v150
    v_fmac_f32 v254, v7, v151
    v_fma_f32 v202, v8, -v160, v202
    v_fma_f32 v202, v9, -v161, v202
    v_mfma_f32_32x32x16_bf16 v[48:63], v[68:71], v[180:183], v[48:63]
    s_waitcnt vmcnt(6)
    ds_read_b64_tr_b16 v[176:177], v244 offset:0
    ds_read_b64_tr_b16 v[178:179], v244 offset:1024
    ds_read_b64_tr_b16 v[180:181], v245 offset:0
    ds_read_b64_tr_b16 v[182:183], v245 offset:1024
    v_permlane32_swap_b32 v254, v200
    v_fma_f32 v202, v10, -v162, v202
    v_fma_f32 v202, v11, -v163, v202
    v_fma_f32 v202, v12, -v164, v202
    v_fma_f32 v202, v13, -v165, v202
    v_fma_f32 v202, v14, -v166, v202
    v_fma_f32 v202, v15, -v167, v202
    v_add_f32 v200, v254, v200
    v_fmac_f32 v198, v16, v112
    v_permlane32_swap_b32 v202, v254
    v_mfma_f32_32x32x16_bf16 v[32:47], v[72:75], v[184:187], v[32:47]
    v_fmac_f32 v198, v17, v113
    v_fmac_f32 v198, v18, v114
    v_fmac_f32 v198, v19, v115
    v_fmac_f32 v198, v20, v116
    v_fmac_f32 v198, v21, v117
    v_fmac_f32 v198, v22, v118
    v_fmac_f32 v198, v23, v119
    v_add_f32 v254, v202, v254
    v_mul_f32 v196, v24, v160
    v_fmac_f32 v196, v25, v161
    v_mfma_f32_32x32x16_bf16 v[48:63], v[76:79], v[184:187], v[48:63]
    v_add_u32 v249, s48, v249
    v_add_u32 v250, s49, v250
    ds_read_b32 v252, v251 offset:16
    ds_read_b64_tr_b16 v[68:69], v249 offset:0
    ds_read_b64_tr_b16 v[70:71], v249 offset:256
    s_mov_b64 exec, s[54:55]
    ds_read_u16_d16_hi v242, v250 offset:0
    s_mov_b64 exec, -1
    v_fmac_f32 v196, v26, v162
    v_fmac_f32 v196, v27, v163
    v_fmac_f32 v196, v28, v164
    v_fmac_f32 v196, v29, v165
    v_fmac_f32 v196, v30, v166
    v_fmac_f32 v196, v31, v167
    s_nop 1
    v_permlane32_swap_b32 v198, v196
    v_add_f32 v196, v198, v196
    v_mul_f32 v255, v32, v152
    v_fmac_f32 v255, v33, v153
    v_fmac_f32 v255, v34, v154
    v_fmac_f32 v255, v35, v155
    v_fmac_f32 v255, v36, v156
    v_fmac_f32 v255, v37, v157
    v_fmac_f32 v255, v38, v158
    v_fmac_f32 v255, v39, v159
    v_fma_f32 v203, v40, -v168, v203
    v_fma_f32 v203, v41, -v169, v203
    v_permlane32_swap_b32 v255, v201
    v_fma_f32 v203, v42, -v170, v203
    v_fma_f32 v203, v43, -v171, v203
    v_fma_f32 v203, v44, -v172, v203
    v_fma_f32 v203, v45, -v173, v203
    v_fma_f32 v203, v46, -v174, v203
    v_fma_f32 v203, v47, -v175, v203
    v_add_f32 v201, v255, v201
    v_fmac_f32 v199, v48, v120
    v_permlane32_swap_b32 v203, v255
    v_fmac_f32 v199, v49, v121
    v_fmac_f32 v199, v50, v122
    v_fmac_f32 v199, v51, v123
    v_fmac_f32 v199, v52, v124
    v_fmac_f32 v199, v53, v125
    v_fmac_f32 v199, v54, v126
    v_fmac_f32 v199, v55, v127
    v_add_f32 v255, v203, v255
    v_mul_f32 v197, v56, v168
    v_fmac_f32 v197, v57, v169
    v_fmac_f32 v197, v58, v170
    v_fmac_f32 v197, v59, v171
    v_fmac_f32 v197, v60, v172
    v_fmac_f32 v197, v61, v173
    v_fmac_f32 v197, v62, v174
    v_fmac_f32 v197, v63, v175
    s_nop 1
    v_permlane32_swap_b32 v199, v197
    v_add_f32 v197, v199, v197
    s_set_gpr_idx_on s51, gpr_idx(DST)
    s_nop 0
    v_cvt_pk_bf16_f32 v207, v200, v201
    v_cvt_pk_bf16_f32 v209, v254, v255
    v_cvt_pk_bf16_f32 v208, v196, v197
    s_set_gpr_idx_off
    s_add_u32 s50, s50, 1
    s_add_u32 s51, s51, 6
    s_cmp_ge_u32 s50, 4
    s_cbranch_scc1 LAST0
    s_waitcnt lgkmcnt(3)
    v_readfirstlane_b32 s66, v252
    s_add_u32 s53, s53, 1
    v_mov_b32 v252, s53
    s_cmp_le_u32 s53, s66
    ds_write2_b32 v251, v252, v252 offset0:0 offset1:8
    s_setprio 1
    s_cbranch_scc1 PRIO_4
    s_setprio 0
PRIO_4:
    s_cmp_eq_u32 s52, 4
    s_cbranch_scc1 ITEM_0_4
    s_cmp_eq_u32 s52, 5
    s_cbranch_scc1 ITEM_0_5
    s_cmp_eq_u32 s52, 3
    s_cbranch_scc1 ITEM_0_3
    s_cmp_eq_u32 s52, 6
    s_cbranch_scc1 ITEM_0_6
    s_cmp_eq_u32 s52, 8
    s_cbranch_scc1 ITEM_0_8
    s_branch ITEM_0_2
.p2align 6
ITEM_0_5:
    s_mov_b64 exec, s[54:55]
    ds_read_u16_d16_hi v243, v250 offset:128
    s_mov_b64 exec, -1
    ds_read_b64_tr_b16 v[76:77], v249 offset:512
    ds_read_b64_tr_b16 v[78:79], v249 offset:768
    ds_read_b64_tr_b16 v[84:85], v249 offset:1024
    s_waitcnt lgkmcnt(4)
    v_lshlrev_b32 v196, 16, v68
    v_and_b32 v197, 0xffff0000, v68
    v_lshlrev_b32 v198, 16, v69
    v_and_b32 v199, 0xffff0000, v69
    v_mul_f32_dpp v200, v242, v196 row_newbcast:0 row_mask:0xf bank_mask:0xf
    v_mul_f32_dpp v201, v242, v197 row_newbcast:1 row_mask:0xf bank_mask:0xf
    v_mul_f32_dpp v202, v242, v196 row_newbcast:8 row_mask:0xf bank_mask:0xf
    v_mul_f32_dpp v203, v242, v197 row_newbcast:9 row_mask:0xf bank_mask:0xf
    v_lshlrev_b32 v196, 16, v70
    v_and_b32 v197, 0xffff0000, v70
    v_cvt_pk_bf16_f32 v64, v200, v201
    v_cvt_pk_bf16_f32 v68, v202, v203
    v_mul_f32_dpp v200, v242, v198 row_newbcast:2 row_mask:0xf bank_mask:0xf
    v_mul_f32_dpp v201, v242, v199 row_newbcast:3 row_mask:0xf bank_mask:0xf
    v_mul_f32_dpp v202, v242, v198 row_newbcast:10 row_mask:0xf bank_mask:0xf
    v_mul_f32_dpp v203, v242, v199 row_newbcast:11 row_mask:0xf bank_mask:0xf
    v_lshlrev_b32 v198, 16, v71
    v_and_b32 v199, 0xffff0000, v71
    v_cvt_pk_bf16_f32 v65, v200, v201
    v_cvt_pk_bf16_f32 v69, v202, v203
    v_mul_f32_dpp v200, v242, v196 row_newbcast:4 row_mask:0xf bank_mask:0xf
    v_mul_f32_dpp v201, v242, v197 row_newbcast:5 row_mask:0xf bank_mask:0xf
    v_mul_f32_dpp v202, v242, v196 row_newbcast:12 row_mask:0xf bank_mask:0xf
    v_mul_f32_dpp v203, v242, v197 row_newbcast:13 row_mask:0xf bank_mask:0xf
    v_cvt_pk_bf16_f32 v66, v200, v201
    v_cvt_pk_bf16_f32 v70, v202, v203
    v_mul_f32_dpp v200, v242, v198 row_newbcast:6 row_mask:0xf bank_mask:0xf
    v_mul_f32_dpp v201, v242, v199 row_newbcast:7 row_mask:0xf bank_mask:0xf
    v_mul_f32_dpp v202, v242, v198 row_newbcast:14 row_mask:0xf bank_mask:0xf
    v_mul_f32_dpp v203, v242, v199 row_newbcast:15 row_mask:0xf bank_mask:0xf
    v_cvt_pk_bf16_f32 v67, v200, v201
    v_cvt_pk_bf16_f32 v71, v202, v203
    s_mov_b64 exec, s[54:55]
    ds_read_u16_d16_hi v242, v250 offset:256
    s_mov_b64 exec, -1
    s_waitcnt vmcnt(4) lgkmcnt(2)
    v_mfma_f32_32x32x16_bf16 v[0:15], v[64:67], v[176:179], 0
    v_lshlrev_b32 v196, 16, v76
    v_and_b32 v197, 0xffff0000, v76
    v_lshlrev_b32 v198, 16, v77
    v_and_b32 v199, 0xffff0000, v77
    v_mul_f32_dpp v200, v243, v196 row_newbcast:0 row_mask:0xf bank_mask:0xf
    v_mul_f32_dpp v201, v243, v197 row_newbcast:1 row_mask:0xf bank_mask:0xf
    v_mul_f32_dpp v202, v243, v196 row_newbcast:8 row_mask:0xf bank_mask:0xf
    v_mul_f32_dpp v203, v243, v197 row_newbcast:9 row_mask:0xf bank_mask:0xf
    v_lshlrev_b32 v196, 16, v78
    v_and_b32 v197, 0xffff0000, v78
    v_cvt_pk_bf16_f32 v72, v200, v201
    v_cvt_pk_bf16_f32 v76, v202, v203
    v_mul_f32_dpp v200, v243, v198 row_newbcast:2 row_mask:0xf bank_mask:0xf
    v_mul_f32_dpp v201, v243, v199 row_newbcast:3 row_mask:0xf bank_mask:0xf
    v_mul_f32_dpp v202, v243, v198 row_newbcast:10 row_mask:0xf bank_mask:0xf
    v_mul_f32_dpp v203, v243, v199 row_newbcast:11 row_mask:0xf bank_mask:0xf
    s_add_u32 m0, s21, 0
    v_mfma_f32_32x32x16_bf16 v[16:31], v[68:71], v[176:179], 0
    buffer_load_dwordx4 v236, s[4:7], s35 offen lds
    buffer_load_dwordx4 v237, s[8:11], s35 offen offset:1024 lds
    ds_read_b64_tr_b16 v[176:177], v244 offset:2048
    ds_read_b64_tr_b16 v[178:179], v244 offset:3072
    ds_read_b64_tr_b16 v[184:185], v245 offset:2048
    ds_read_b64_tr_b16 v[186:187], v245 offset:3072
    v_lshlrev_b32 v198, 16, v79
    v_and_b32 v199, 0xffff0000, v79
    v_cvt_pk_bf16_f32 v73, v200, v201
    v_cvt_pk_bf16_f32 v77, v202, v203
    v_mul_f32_dpp v200, v243, v196 row_newbcast:4 row_mask:0xf bank_mask:0xf
    v_mul_f32_dpp v201, v243, v197 row_newbcast:5 row_mask:0xf bank_mask:0xf
    v_mul_f32_dpp v202, v243, v196 row_newbcast:12 row_mask:0xf bank_mask:0xf
    v_mul_f32_dpp v203, v243, v197 row_newbcast:13 row_mask:0xf bank_mask:0xf
    v_cvt_pk_bf16_f32 v74, v200, v201
    v_cvt_pk_bf16_f32 v78, v202, v203
    v_mul_f32_dpp v200, v243, v198 row_newbcast:6 row_mask:0xf bank_mask:0xf
    v_mul_f32_dpp v201, v243, v199 row_newbcast:7 row_mask:0xf bank_mask:0xf
    v_mul_f32_dpp v202, v243, v198 row_newbcast:14 row_mask:0xf bank_mask:0xf
    v_mul_f32_dpp v203, v243, v199 row_newbcast:15 row_mask:0xf bank_mask:0xf
    v_cvt_pk_bf16_f32 v75, v200, v201
    v_cvt_pk_bf16_f32 v79, v202, v203
    s_nop 0
    s_waitcnt vmcnt(4) lgkmcnt(0)
    v_mfma_f32_32x32x16_bf16 v[0:15], v[72:75], v[176:179], v[0:15]
    v_lshlrev_b32 v196, 16, v84
    v_and_b32 v197, 0xffff0000, v84
    v_lshlrev_b32 v198, 16, v85
    v_and_b32 v199, 0xffff0000, v85
    v_mul_f32_dpp v200, v242, v196 row_newbcast:0 row_mask:0xf bank_mask:0xf
    v_mul_f32_dpp v201, v242, v197 row_newbcast:1 row_mask:0xf bank_mask:0xf
    v_mul_f32_dpp v202, v242, v196 row_newbcast:8 row_mask:0xf bank_mask:0xf
    v_mul_f32_dpp v203, v242, v197 row_newbcast:9 row_mask:0xf bank_mask:0xf
    s_add_u32 m0, s21, 2048
    v_mfma_f32_32x32x16_bf16 v[16:31], v[76:79], v[176:179], v[16:31]
    buffer_load_dwordx4 v238, s[4:7], s35 offen lds
    ds_read_b64_tr_b16 v[176:177], v244 offset:4096
    ds_read_b64_tr_b16 v[188:189], v245 offset:4096
    v_cvt_pk_bf16_f32 v80, v200, v201
    v_cvt_pk_bf16_f32 v84, v202, v203
    v_mul_f32_dpp v200, v242, v198 row_newbcast:2 row_mask:0xf bank_mask:0xf
    v_mul_f32_dpp v201, v242, v199 row_newbcast:3 row_mask:0xf bank_mask:0xf
    v_mul_f32_dpp v202, v242, v198 row_newbcast:10 row_mask:0xf bank_mask:0xf
    v_mul_f32_dpp v203, v242, v199 row_newbcast:11 row_mask:0xf bank_mask:0xf
    v_cvt_pk_bf16_f32 v81, v200, v201
    v_cvt_pk_bf16_f32 v85, v202, v203
    s_nop 0
    s_waitcnt lgkmcnt(0)
    v_mfma_f32_32x32x8_bf16 v[0:15], v[80:81], v[176:177], v[0:15]
    s_add_u32 m0, s21, 4096
    v_mfma_f32_32x32x8_bf16 v[16:31], v[84:85], v[176:177], v[16:31]
    buffer_load_dwordx4 v234, s[4:7], s36 offen lds
    buffer_load_dwordx4 v235, s[8:11], s36 offen offset:1024 lds
    s_mov_b32 m0, s50
    s_nop 0
    s_movrels_b32 s71, s23
    s_bfe_u32 s46, s71, 0x30012
    s_mov_b32 m0, s46
    s_and_b32 s66, s71, 0x3ffff
    s_movrels_b32 s68, s57
    s_movrels_b32 s69, s61
    s_sub_u32 s48, s66, s47
    s_mov_b32 s47, s66
    s_lshr_b32 s52, s71, 28
    s_lshl_b32 s67, s46, 9
    s_add_u32 s66, s66, s67
    s_sub_u32 s49, s66, s42
    s_mov_b32 s42, s66
    s_bfe_u32 s66, s68, 655360
    s_add_u32 s43, s42, s66
    s_bfe_u32 s39, s69, 655360
    s_bfe_u32 s66, s68, 655370
    s_add_u32 s44, s42, s66
    s_bfe_u32 s40, s69, 655370
    s_bfe_u32 s66, s68, 655380
    s_add_u32 s45, s42, s66
    s_bfe_u32 s41, s69, 655380
    s_and_b32 s66, s46, s33
    s_cselect_b32 s72, -1, 1
    s_cselect_b32 s76, s47, 163712
    s_cmp_ge_u32 s66, 2
    s_cselect_b32 s73, -1, 0
    s_add_u32 s77, s47, 1024
    s_cmp_ge_u32 s66, 4
    s_cselect_b32 s75, -1, 0
    s_cmp_ge_u32 s66, 3
    s_cselect_b32 s74, -1, 1
    s_cselect_b32 s77, s77, 163712
    v_add_u32 v252, s45, v247
    ds_read_u16 v240, v252
    ds_read_u16 v241, v252 offset:64
    v_mfma_f32_32x32x16_bf16 v[32:47], v[64:67], v[180:183], 0
    v_mul_f32 v196, v0, v96
    v_fmac_f32 v196, v1, v97
    v_fmac_f32 v196, v2, v98
    v_fmac_f32 v196, v3, v99
    v_fmac_f32 v196, v4, v100
    v_fmac_f32 v196, v5, v101
    v_fmac_f32 v196, v6, v102
    v_mfma_f32_32x32x16_bf16 v[48:63], v[68:71], v[180:183], 0
    v_lshl_add_u32 v253, v248, 2, s47
    ds_read_b32 v254, v253
    ds_read_b32 v255, v253 offset:1024
    v_fmac_f32 v196, v7, v103
    v_mul_f32 v198, v8, v128
    v_fmac_f32 v198, v9, v129
    v_fmac_f32 v198, v10, v130
    v_fmac_f32 v198, v11, v131
    v_fmac_f32 v198, v12, v132
    v_mfma_f32_32x32x16_bf16 v[32:47], v[72:75], v[184:187], v[32:47]
    v_fmac_f32 v198, v13, v133
    v_fmac_f32 v198, v14, v134
    v_fmac_f32 v198, v15, v135
    v_mul_f32 v200, v16, v128
    v_fmac_f32 v200, v17, v129
    v_permlane32_swap_b32 v196, v198
    v_mfma_f32_32x32x16_bf16 v[48:63], v[76:79], v[184:187], v[48:63]
    s_waitcnt vmcnt(5)
    ds_read_b64_tr_b16 v[176:177], v244 offset:6144
    ds_read_b64_tr_b16 v[178:179], v244 offset:7168
    ds_read_b64_tr_b16 v[180:181], v245 offset:6144
    ds_read_b64_tr_b16 v[182:183], v245 offset:7168
    v_fmac_f32 v200, v18, v130
    v_fmac_f32 v200, v19, v131
    v_fmac_f32 v200, v20, v132
    v_fmac_f32 v200, v21, v133
    v_fmac_f32 v200, v22, v134
    v_fmac_f32 v200, v23, v135
    v_mfma_f32_32x32x8_bf16 v[32:47], v[80:81], v[188:189], v[32:47]
    v_add_f32 v198, v196, v198
    v_mul_f32_e64 v202, v24, -v128
    v_fma_f32 v202, v25, -v129, v202
    v_fma_f32 v202, v26, -v130, v202
    v_fma_f32 v202, v27, -v131, v202
    v_fma_f32 v202, v28, -v132, v202
    v_mfma_f32_32x32x8_bf16 v[48:63], v[84:85], v[188:189], v[48:63]
    v_fma_f32 v202, v29, -v133, v202
    v_fma_f32 v202, v30, -v134, v202
    v_fma_f32 v202, v31, -v135, v202
    s_nop 1
    v_permlane32_swap_b32 v200, v202
    v_add_f32 v202, v200, v202
    s_waitcnt vmcnt(3) lgkmcnt(0)
    v_mfma_f32_32x32x16_bf16 v[0:15], v[64:67], v[176:179], 0
    v_mul_f32 v197, v32, v104
    v_fmac_f32 v197, v33, v105
    v_fmac_f32 v197, v34, v106
    v_fmac_f32 v197, v35, v107
    v_fmac_f32 v197, v36, v108
    v_fmac_f32 v197, v37, v109
    v_fmac_f32 v197, v38, v110
    s_add_u32 m0, s21, 6144
    v_mfma_f32_32x32x16_bf16 v[16:31], v[68:71], v[176:179], 0
    buffer_load_dwordx4 v236, s[4:7], s36 offen lds
    buffer_load_dwordx4 v237, s[8:11], s36 offen offset:1024 lds
    ds_read_b64_tr_b16 v[176:177], v244 offset:0
    ds_read_b64_tr_b16 v[178:179], v244 offset:1024
    ds_read_b64_tr_b16 v[184:185], v245 offset:0
    ds_read_b64_tr_b16 v[186:187], v245 offset:1024
    s_mov_b32 m0, s76
    s_mov_b64 exec, s[72:73]
    buffer_load_dwordx4 v254, s[12:15], 0 offen  lds
    s_mov_b32 m0, s77
    s_mov_b64 exec, s[74:75]
    buffer_load_dwordx4 v255, s[12:15], 0 offen  lds
    s_mov_b64 exec, -1
    v_fmac_f32 v197, v39, v111
    v_mul_f32 v199, v40, v136
    v_fmac_f32 v199, v41, v137
    v_fmac_f32 v199, v42, v138
    v_fmac_f32 v199, v43, v139
    v_fmac_f32 v199, v44, v140
    v_fmac_f32 v199, v45, v141
    s_waitcnt vmcnt(6) lgkmcnt(0)
    v_mfma_f32_32x32x16_bf16 v[0:15], v[72:75], v[176:179], v[0:15]
    v_fmac_f32 v199, v46, v142
    v_fmac_f32 v199, v47, v143
    v_mul_f32 v201, v48, v136
    v_fmac_f32 v201, v49, v137
    v_permlane32_swap_b32 v197, v199
    v_fmac_f32 v201, v50, v138
    v_fmac_f32 v201, v51, v139
    s_add_u32 m0, s21, 0
    v_mfma_f32_32x32x16_bf16 v[16:31], v[76:79], v[176:179], v[16:31]
    buffer_load_dwordx4 v238, s[4:7], s36 offen lds
    ds_read_b64_tr_b16 v[176:177], v244 offset:2048
    ds_read_b64_tr_b16 v[188:189], v245 offset:2048
    v_fmac_f32 v201, v52, v140
    v_fmac_f32 v201, v53, v141
    v_fmac_f32 v201, v54, v142
    v_fmac_f32 v201, v55, v143
    v_add_f32 v199, v197, v199
    v_mul_f32_e64 v203, v56, -v136
    v_fma_f32 v203, v57, -v137, v203
    s_waitcnt lgkmcnt(0)
    v_mfma_f32_32x32x8_bf16 v[0:15], v[80:81], v[176:177], v[0:15]
    v_fma_f32 v203, v58, -v138, v203
    v_fma_f32 v203, v59, -v139, v203
    v_fma_f32 v203, v60, -v140, v203
    v_fma_f32 v203, v61, -v141, v203
    v_fma_f32 v203, v62, -v142, v203
    v_fma_f32 v203, v63, -v143, v203
    s_nop 1
    s_add_u32 m0, s21, 2048
    v_mfma_f32_32x32x8_bf16 v[16:31], v[84:85], v[176:177], v[16:31]
    buffer_load_dwordx4 v234, s[4:7], s37 offen lds
    buffer_load_dwordx4 v235, s[8:11], s37 offen offset:1024 lds
    v_add_u32 v252, s42, v247
    ds_read_u16 v234, v252
    ds_read_u16 v235, v252 offset:64
    v_permlane32_swap_b32 v201, v203
    v_add_f32 v203, v201, v203
    s_set_gpr_idx_on s51, gpr_idx(DST)
    s_nop 0
    v_cvt_pk_bf16_f32 v204, v198, v199
    v_cvt_pk_bf16_f32 v205, v202, v203
    s_set_gpr_idx_off
    v_mfma_f32_32x32x16_bf16 v[32:47], v[64:67], v[180:183], 0
    v_mul_f32 v196, v0, v144
    v_fmac_f32 v196, v1, v145
    v_fmac_f32 v196, v2, v146
    v_fmac_f32 v196, v3, v147
    v_fmac_f32 v196, v4, v148
    v_fmac_f32 v196, v5, v149
    v_mfma_f32_32x32x16_bf16 v[48:63], v[68:71], v[180:183], 0
    v_fmac_f32 v196, v6, v150
    v_fmac_f32 v196, v7, v151
    v_mul_f32 v198, v8, v112
    v_fmac_f32 v198, v9, v113
    v_fmac_f32 v198, v10, v114
    v_mfma_f32_32x32x16_bf16 v[32:47], v[72:75], v[184:187], v[32:47]
    v_fmac_f32 v198, v11, v115
    v_fmac_f32 v198, v12, v116
    v_fmac_f32 v198, v13, v117
    v_fmac_f32 v198, v14, v118
    v_fmac_f32 v198, v15, v119
    v_mfma_f32_32x32x16_bf16 v[48:63], v[76:79], v[184:187], v[48:63]
    s_waitcnt vmcnt(7)
    ds_read_b64_tr_b16 v[176:177], v244 offset:4096
    ds_read_b64_tr_b16 v[178:179], v244 offset:5120
    ds_read_b64_tr_b16 v[180:181], v245 offset:4096
    ds_read_b64_tr_b16 v[182:183], v245 offset:5120
    v_mul_f32_e64 v200, v16, -v160
    v_fma_f32 v200, v17, -v161, v200
    v_fma_f32 v200, v18, -v162, v200
    v_fma_f32 v200, v19, -v163, v200
    v_fma_f32 v200, v20, -v164, v200
    v_fma_f32 v200, v21, -v165, v200
    v_mfma_f32_32x32x8_bf16 v[32:47], v[80:81], v[188:189], v[32:47]
    v_fma_f32 v200, v22, -v166, v200
    v_fma_f32 v200, v23, -v167, v200
    v_mul_f32_e64 v202, v24, -v160
    v_fma_f32 v202, v25, -v161, v202
    v_fma_f32 v202, v26, -v162, v202
    v_mfma_f32_32x32x8_bf16 v[48:63], v[84:85], v[188:189], v[48:63]
    v_fma_f32 v202, v27, -v163, v202
    v_fma_f32 v202, v28, -v164, v202
    v_fma_f32 v202, v29, -v165, v202
    v_fma_f32 v202, v30, -v166, v202
    v_fma_f32 v202, v31, -v167, v202
    s_waitcnt vmcnt(5) lgkmcnt(0)
    v_mfma_f32_32x32x16_bf16 v[0:15], v[64:67], v[176:179], 0
    v_mul_f32 v197, v32, v152
    v_fmac_f32 v197, v33, v153
    v_fmac_f32 v197, v34, v154
    v_fmac_f32 v197, v35, v155
    v_fmac_f32 v197, v36, v156
    v_fmac_f32 v197, v37, v157
    s_add_u32 m0, s21, 4096
    v_mfma_f32_32x32x16_bf16 v[16:31], v[68:71], v[176:179], 0
    buffer_load_dwordx4 v236, s[4:7], s37 offen lds
    buffer_load_dwordx4 v237, s[8:11], s37 offen offset:1024 lds
    ds_read_b64_tr_b16 v[176:177], v244 offset:6144
    ds_read_b64_tr_b16 v[178:179], v244 offset:7168
    ds_read_b64_tr_b16 v[184:185], v245 offset:6144
    ds_read_b64_tr_b16 v[186:187], v245 offset:7168
    v_add_u32 v252, s43, v247
    ds_read_u16 v236, v252
    ds_read_u16 v237, v252 offset:64
    v_fmac_f32 v197, v38, v158
    v_fmac_f32 v197, v39, v159
    v_mul_f32 v199, v40, v120
    v_fmac_f32 v199, v41, v121
    v_fmac_f32 v199, v42, v122
    s_waitcnt vmcnt(4) lgkmcnt(2)
    v_mfma_f32_32x32x16_bf16 v[0:15], v[72:75], v[176:179], v[0:15]
    v_fmac_f32 v199, v43, v123
    v_fmac_f32 v199, v44, v124
    v_fmac_f32 v199, v45, v125
    v_fmac_f32 v199, v46, v126
    v_fmac_f32 v199, v47, v127
    s_add_u32 m0, s21, 6144
    v_mfma_f32_32x32x16_bf16 v[16:31], v[76:79], v[176:179], v[16:31]
    buffer_load_dwordx4 v238, s[4:7], s37 offen lds
    ds_read_b64_tr_b16 v[176:177], v244 offset:0
    ds_read_b64_tr_b16 v[188:189], v245 offset:0
    v_add_u32 v252, s44, v247
    ds_read_u16 v238, v252
    ds_read_u16 v239, v252 offset:64
    v_mul_f32_e64 v201, v48, -v168
    v_fma_f32 v201, v49, -v169, v201
    v_fma_f32 v201, v50, -v170, v201
    v_fma_f32 v201, v51, -v171, v201
    v_fma_f32 v201, v52, -v172, v201
    v_fma_f32 v201, v53, -v173, v201
    s_waitcnt lgkmcnt(2)
    v_mfma_f32_32x32x8_bf16 v[0:15], v[80:81], v[176:177], v[0:15]
    v_fma_f32 v201, v54, -v174, v201
    v_fma_f32 v201, v55, -v175, v201
    v_mul_f32_e64 v203, v56, -v168
    v_fma_f32 v203, v57, -v169, v203
    v_fma_f32 v203, v58, -v170, v203
    s_add_u32 m0, s21, 0
    v_mfma_f32_32x32x8_bf16 v[16:31], v[84:85], v[176:177], v[16:31]
    v_lshl_add_u32 v234, v234, 10, v246
    v_lshl_add_u32 v235, v235, 10, v246
    buffer_load_dwordx4 v234, s[4:7], s38 offen lds
    buffer_load_dwordx4 v235, s[8:11], s38 offen offset:1024 lds
    v_fma_f32 v203, v59, -v171, v203
    v_fma_f32 v203, v60, -v172, v203
    v_fma_f32 v203, v61, -v173, v203
    v_fma_f32 v203, v62, -v174, v203
    v_fma_f32 v203, v63, -v175, v203
    v_mfma_f32_32x32x16_bf16 v[32:47], v[64:67], v[180:183], 0
    v_mul_f32 v254, v0, v144
    v_fmac_f32 v254, v1, v145
    v_fmac_f32 v254, v2, v146
    v_mfma_f32_32x32x16_bf16 v[48:63], v[68:71], v[180:183], 0
    ds_swizzle_b32 v68, v68 offset:0x401F
    ds_swizzle_b32 v69, v69 offset:0x401F
    ds_swizzle_b32 v70, v70 offset:0x401F
    ds_swizzle_b32 v71, v71 offset:0x401F
    v_fmac_f32 v254, v3, v147
    v_fmac_f32 v254, v4, v148
    v_fmac_f32 v254, v5, v149
    v_mfma_f32_32x32x16_bf16 v[32:47], v[72:75], v[184:187], v[32:47]
    v_fmac_f32 v254, v6, v150
    v_fmac_f32 v254, v7, v151
    v_fmac_f32 v200, v8, v160
    v_mfma_f32_32x32x16_bf16 v[48:63], v[76:79], v[184:187], v[48:63]
    ds_swizzle_b32 v76, v76 offset:0x401F
    ds_swizzle_b32 v77, v77 offset:0x401F
    ds_swizzle_b32 v78, v78 offset:0x401F
    ds_swizzle_b32 v79, v79 offset:0x401F
    s_waitcnt vmcnt(5)
    ds_read_b64_tr_b16 v[176:177], v244 offset:2048
    ds_read_b64_tr_b16 v[178:179], v244 offset:3072
    ds_read_b64_tr_b16 v[180:181], v245 offset:2048
    ds_read_b64_tr_b16 v[182:183], v245 offset:3072
    v_fmac_f32 v200, v9, v161
    v_permlane32_swap_b32 v196, v254
    v_fmac_f32 v200, v10, v162
    v_mfma_f32_32x32x8_bf16 v[32:47], v[80:81], v[188:189], v[32:47]
    v_fmac_f32 v200, v11, v163
    v_fmac_f32 v200, v12, v164
    v_fmac_f32 v200, v13, v165
    v_mfma_f32_32x32x8_bf16 v[48:63], v[84:85], v[188:189], v[48:63]
    ds_swizzle_b32 v84, v84 offset:0x401F
    ds_swizzle_b32 v85, v85 offset:0x401F
    v_fmac_f32 v200, v14, v166
    v_fmac_f32 v200, v15, v167
    v_add_f32 v254, v196, v254
    s_waitcnt lgkmcnt(6)
    s_mov_b64 exec, s[56:57]
    v_xor_b32 v68, 0x80008000, v68
    v_xor_b32 v69, 0x80008000, v69
    v_xor_b32 v70, 0x80008000, v70
    v_xor_b32 v71, 0x80008000, v71
    v_xor_b32 v76, 0x80008000, v76
    v_xor_b32 v77, 0x80008000, v77
    v_xor_b32 v78, 0x80008000, v78
    v_xor_b32 v79, 0x80008000, v79
    s_mov_b64 exec, -1
    s_waitcnt vmcnt(3) lgkmcnt(2)
    v_mfma_f32_32x32x16_bf16 v[0:15], v[64:67], v[176:179], 0
    v_mul_f32 v255, v32, v152
    v_fmac_f32 v255, v33, v153
    v_fmac_f32 v255, v34, v154
    v_fmac_f32 v255, v35, v155
    s_add_u32 m0, s21, 2048
    v_mfma_f32_32x32x16_bf16 v[16:31], v[68:71], v[176:179], v[16:31]
    v_lshl_add_u32 v236, v236, 10, v246
    v_lshl_add_u32 v237, v237, 10, v246
    buffer_load_dwordx4 v236, s[4:7], s39 offen lds
    buffer_load_dwordx4 v237, s[8:11], s39 offen offset:1024 lds
    ds_read_b64_tr_b16 v[176:177], v244 offset:4096
    ds_read_b64_tr_b16 v[178:179], v244 offset:5120
    ds_read_b64_tr_b16 v[184:185], v245 offset:4096
    ds_read_b64_tr_b16 v[186:187], v245 offset:5120
    v_fmac_f32 v255, v36, v156
    v_fmac_f32 v255, v37, v157
    v_fmac_f32 v255, v38, v158
    v_fmac_f32 v255, v39, v159
    s_waitcnt vmcnt(4) lgkmcnt(0)
    v_mfma_f32_32x32x16_bf16 v[0:15], v[72:75], v[176:179], v[0:15]
    v_fmac_f32 v201, v40, v168
    v_fmac_f32 v201, v41, v169
    v_permlane32_swap_b32 v197, v255
    s_add_u32 m0, s21, 4096
    v_mfma_f32_32x32x16_bf16 v[16:31], v[76:79], v[176:179], v[16:31]
    v_lshl_add_u32 v238, v238, 10, v246
    v_lshl_add_u32 v239, v239, 10, v246
    buffer_load_dwordx4 v238, s[4:7], s40 offen lds
    buffer_load_dwordx4 v239, s[8:11], s40 offen offset:1024 lds
    ds_read_b64_tr_b16 v[176:177], v244 offset:6144
    ds_read_b64_tr_b16 v[188:189], v245 offset:6144
    v_fmac_f32 v201, v42, v170
    v_fmac_f32 v201, v43, v171
    v_fmac_f32 v201, v44, v172
    v_fmac_f32 v201, v45, v173
    s_waitcnt lgkmcnt(0)
    s_mov_b64 exec, s[56:57]
    v_xor_b32 v84, 0x80008000, v84
    v_xor_b32 v85, 0x80008000, v85
    s_mov_b64 exec, -1
    v_mfma_f32_32x32x8_bf16 v[0:15], v[80:81], v[176:177], v[0:15]
    v_fmac_f32 v201, v46, v174
    v_fmac_f32 v201, v47, v175
    v_add_f32 v255, v197, v255
    s_set_gpr_idx_on s51, gpr_idx(DST)
    s_nop 0
    v_cvt_pk_bf16_f32 v206, v254, v255
    s_set_gpr_idx_off
    s_add_u32 m0, s21, 6144
    v_mfma_f32_32x32x8_bf16 v[16:31], v[84:85], v[176:177], v[16:31]
    v_lshl_add_u32 v240, v240, 10, v246
    v_lshl_add_u32 v241, v241, 10, v246
    buffer_load_dwordx4 v240, s[4:7], s41 offen lds
    buffer_load_dwordx4 v241, s[8:11], s41 offen offset:1024 lds
    v_mfma_f32_32x32x16_bf16 v[32:47], v[64:67], v[180:183], 0
    v_mul_f32 v254, v0, v144
    v_fmac_f32 v254, v1, v145
    v_fmac_f32 v254, v2, v146
    v_fmac_f32 v254, v3, v147
    v_fmac_f32 v254, v4, v148
    v_fmac_f32 v254, v5, v149
    v_fmac_f32 v254, v6, v150
    v_mfma_f32_32x32x16_bf16 v[48:63], v[68:71], v[180:183], v[48:63]
    v_fmac_f32 v254, v7, v151
    v_fma_f32 v202, v8, -v160, v202
    v_fma_f32 v202, v9, -v161, v202
    v_permlane32_swap_b32 v254, v200
    v_fma_f32 v202, v10, -v162, v202
    v_fma_f32 v202, v11, -v163, v202
    v_mfma_f32_32x32x16_bf16 v[32:47], v[72:75], v[184:187], v[32:47]
    v_fma_f32 v202, v12, -v164, v202
    v_fma_f32 v202, v13, -v165, v202
    v_fma_f32 v202, v14, -v166, v202
    v_fma_f32 v202, v15, -v167, v202
    v_add_f32 v200, v254, v200
    v_fmac_f32 v198, v16, v112
    v_permlane32_swap_b32 v202, v254
    v_mfma_f32_32x32x16_bf16 v[48:63], v[76:79], v[184:187], v[48:63]
    s_waitcnt vmcnt(6)
    ds_read_b64_tr_b16 v[176:177], v244 offset:0
    ds_read_b64_tr_b16 v[178:179], v244 offset:1024
    ds_read_b64_tr_b16 v[180:181], v245 offset:0
    ds_read_b64_tr_b16 v[182:183], v245 offset:1024
    v_fmac_f32 v198, v17, v113
    v_fmac_f32 v198, v18, v114
    v_fmac_f32 v198, v19, v115
    v_fmac_f32 v198, v20, v116
    v_fmac_f32 v198, v21, v117
    v_fmac_f32 v198, v22, v118
    v_mfma_f32_32x32x8_bf16 v[32:47], v[80:81], v[188:189], v[32:47]
    v_fmac_f32 v198, v23, v119
    v_add_f32 v254, v202, v254
    v_mul_f32 v196, v24, v160
    v_fmac_f32 v196, v25, v161
    v_fmac_f32 v196, v26, v162
    v_fmac_f32 v196, v27, v163
    v_fmac_f32 v196, v28, v164
    v_mfma_f32_32x32x8_bf16 v[48:63], v[84:85], v[188:189], v[48:63]
    v_add_u32 v249, s48, v249
    v_add_u32 v250, s49, v250
    ds_read_b32 v252, v251 offset:16
    ds_read_b64_tr_b16 v[68:69], v249 offset:0
    ds_read_b64_tr_b16 v[70:71], v249 offset:256
    s_mov_b64 exec, s[54:55]
    ds_read_u16_d16_hi v242, v250 offset:0
    s_mov_b64 exec, -1
    v_fmac_f32 v196, v29, v165
    v_fmac_f32 v196, v30, v166
    v_fmac_f32 v196, v31, v167
    s_nop 1
    v_permlane32_swap_b32 v198, v196
    v_add_f32 v196, v198, v196
    v_mul_f32 v255, v32, v152
    v_fmac_f32 v255, v33, v153
    v_fmac_f32 v255, v34, v154
    v_fmac_f32 v255, v35, v155
    v_fmac_f32 v255, v36, v156
    v_fmac_f32 v255, v37, v157
    v_fmac_f32 v255, v38, v158
    v_fmac_f32 v255, v39, v159
    v_fma_f32 v203, v40, -v168, v203
    v_fma_f32 v203, v41, -v169, v203
    v_permlane32_swap_b32 v255, v201
    v_fma_f32 v203, v42, -v170, v203
    v_fma_f32 v203, v43, -v171, v203
    v_fma_f32 v203, v44, -v172, v203
    v_fma_f32 v203, v45, -v173, v203
    v_fma_f32 v203, v46, -v174, v203
    v_fma_f32 v203, v47, -v175, v203
    v_add_f32 v201, v255, v201
    v_fmac_f32 v199, v48, v120
    v_permlane32_swap_b32 v203, v255
    v_fmac_f32 v199, v49, v121
    v_fmac_f32 v199, v50, v122
    v_fmac_f32 v199, v51, v123
    v_fmac_f32 v199, v52, v124
    v_fmac_f32 v199, v53, v125
    v_fmac_f32 v199, v54, v126
    v_fmac_f32 v199, v55, v127
    v_add_f32 v255, v203, v255
    v_mul_f32 v197, v56, v168
    v_fmac_f32 v197, v57, v169
    v_fmac_f32 v197, v58, v170
    v_fmac_f32 v197, v59, v171
    v_fmac_f32 v197, v60, v172
    v_fmac_f32 v197, v61, v173
    v_fmac_f32 v197, v62, v174
    v_fmac_f32 v197, v63, v175
    s_nop 1
    v_permlane32_swap_b32 v199, v197
    v_add_f32 v197, v199, v197
    s_set_gpr_idx_on s51, gpr_idx(DST)
    s_nop 0
    v_cvt_pk_bf16_f32 v207, v200, v201
    v_cvt_pk_bf16_f32 v209, v254, v255
    v_cvt_pk_bf16_f32 v208, v196, v197
    s_set_gpr_idx_off
    s_add_u32 s50, s50, 1
    s_add_u32 s51, s51, 6
    s_cmp_ge_u32 s50, 4
    s_cbranch_scc1 LAST0
    s_waitcnt lgkmcnt(3)
    v_readfirstlane_b32 s66, v252
    s_add_u32 s53, s53, 1
    v_mov_b32 v252, s53
    s_cmp_le_u32 s53, s66
    ds_write2_b32 v251, v252, v252 offset0:0 offset1:8
    s_setprio 1
    s_cbranch_scc1 PRIO_5
    s_setprio 0
PRIO_5:
    s_cmp_eq_u32 s52, 4
    s_cbranch_scc1 ITEM_0_4
    s_cmp_eq_u32 s52, 5
    s_cbranch_scc1 ITEM_0_5
    s_cmp_eq_u32 s52, 3
    s_cbranch_scc1 ITEM_0_3
    s_cmp_eq_u32 s52, 6
    s_cbranch_scc1 ITEM_0_6
    s_cmp_eq_u32 s52, 8
    s_cbranch_scc1 ITEM_0_8
    s_branch ITEM_0_2
.p2align 6
ITEM_0_3:
    s_mov_b64 exec, s[54:55]
    ds_read_u16_d16_hi v243, v250 offset:128
    s_mov_b64 exec, -1
    ds_read_b64_tr_b16 v[76:77], v249 offset:512
    s_waitcnt lgkmcnt(2)
    v_lshlrev_b32 v196, 16, v68
    v_and_b32 v197, 0xffff0000, v68
    v_lshlrev_b32 v198, 16, v69
    v_and_b32 v199, 0xffff0000, v69
    v_mul_f32_dpp v200, v242, v196 row_newbcast:0 row_mask:0xf bank_mask:0xf
    v_mul_f32_dpp v201, v242, v197 row_newbcast:1 row_mask:0xf bank_mask:0xf
    v_mul_f32_dpp v202, v242, v196 row_newbcast:8 row_mask:0xf bank_mask:0xf
    v_mul_f32_dpp v203, v242, v197 row_newbcast:9 row_mask:0xf bank_mask:0xf
    v_lshlrev_b32 v196, 16, v70
    v_and_b32 v197, 0xffff0000, v70
    v_cvt_pk_bf16_f32 v64, v200, v201
    v_cvt_pk_bf16_f32 v68, v202, v203
    v_mul_f32_dpp v200, v242, v198 row_newbcast:2 row_mask:0xf bank_mask:0xf
    v_mul_f32_dpp v201, v242, v199 row_newbcast:3 row_mask:0xf bank_mask:0xf
    v_mul_f32_dpp v202, v242, v198 row_newbcast:10 row_mask:0xf bank_mask:0xf
    v_mul_f32_dpp v203, v242, v199 row_newbcast:11 row_mask:0xf bank_mask:0xf
    v_lshlrev_b32 v198, 16, v71
    v_and_b32 v199, 0xffff0000, v71
    v_cvt_pk_bf16_f32 v65, v200, v201
    v_cvt_pk_bf16_f32 v69, v202, v203
    v_mul_f32_dpp v200, v242, v196 row_newbcast:4 row_mask:0xf bank_mask:0xf
    v_mul_f32_dpp v201, v242, v197 row_newbcast:5 row_mask:0xf bank_mask:0xf
    v_mul_f32_dpp v202, v242, v196 row_newbcast:12 row_mask:0xf bank_mask:0xf
    v_mul_f32_dpp v203, v242, v197 row_newbcast:13 row_mask:0xf bank_mask:0xf
    v_cvt_pk_bf16_f32 v66, v200, v201
    v_cvt_pk_bf16_f32 v70, v202, v203
    v_mul_f32_dpp v200, v242, v198 row_newbcast:6 row_mask:0xf bank_mask:0xf
    v_mul_f32_dpp v201, v242, v199 row_newbcast:7 row_mask:0xf bank_mask:0xf
    v_mul_f32_dpp v202, v242, v198 row_newbcast:14 row_mask:0xf bank_mask:0xf
    v_mul_f32_dpp v203, v242, v199 row_newbcast:15 row_mask:0xf bank_mask:0xf
    v_cvt_pk_bf16_f32 v67, v200, v201
    v_cvt_pk_bf16_f32 v71, v202, v203
    s_nop 0
    s_waitcnt vmcnt(4) lgkmcnt(0)
    v_mfma_f32_32x32x16_bf16 v[0:15], v[64:67], v[176:179], 0
    v_lshlrev_b32 v196, 16, v76
    v_and_b32 v197, 0xffff0000, v76
    v_lshlrev_b32 v198, 16, v77
    v_and_b32 v199, 0xffff0000, v77
    v_mul_f32_dpp v200, v243, v196 row_newbcast:0 row_mask:0xf bank_mask:0xf
    v_mul_f32_dpp v201, v243, v197 row_newbcast:1 row_mask:0xf bank_mask:0xf
    v_mul_f32_dpp v202, v243, v196 row_newbcast:8 row_mask:0xf bank_mask:0xf
    v_mul_f32_dpp v203, v243, v197 row_newbcast:9 row_mask:0xf bank_mask:0xf
    s_add_u32 m0, s21, 0
    v_mfma_f32_32x32x16_bf16 v[16:31], v[68:71], v[176:179], 0
    buffer_load_dwordx4 v234, s[4:7], s36 offen lds
    buffer_load_dwordx4 v235, s[8:11], s36 offen offset:1024 lds
    ds_read_b64_tr_b16 v[176:177], v244 offset:2048
    ds_read_b64_tr_b16 v[184:185], v245 offset:2048
    v_cvt_pk_bf16_f32 v72, v200, v201
    v_cvt_pk_bf16_f32 v76, v202, v203
    v_mul_f32_dpp v200, v243, v198 row_newbcast:2 row_mask:0xf bank_mask:0xf
    v_mul_f32_dpp v201, v243, v199 row_newbcast:3 row_mask:0xf bank_mask:0xf
    v_mul_f32_dpp v202, v243, v198 row_newbcast:10 row_mask:0xf bank_mask:0xf
    v_mul_f32_dpp v203, v243, v199 row_newbcast:11 row_mask:0xf bank_mask:0xf
    v_cvt_pk_bf16_f32 v73, v200, v201
    v_cvt_pk_bf16_f32 v77, v202, v203
    s_nop 0
    s_waitcnt lgkmcnt(0)
    v_mfma_f32_32x32x8_bf16 v[0:15], v[72:73], v[176:177], v[0:15]
    s_add_u32 m0, s21, 2048
    v_mfma_f32_32x32x8_bf16 v[16:31], v[76:77], v[176:177], v[16:31]
    buffer_load_dwordx4 v236, s[4:7], s36 offen lds
    s_mov_b32 m0, s50
    s_nop 0
    s_movrels_b32 s71, s23
    s_bfe_u32 s46, s71, 0x30012
    s_mov_b32 m0, s46
    s_and_b32 s66, s71, 0x3ffff
    s_movrels_b32 s68, s57
    s_movrels_b32 s69, s61
    s_sub_u32 s48, s66, s47
    s_mov_b32 s47, s66
    s_lshr_b32 s52, s71, 28
    s_lshl_b32 s67, s46, 9
    s_add_u32 s66, s66, s67
    s_sub_u32 s49, s66, s42
    s_mov_b32 s42, s66
    s_bfe_u32 s66, s68, 655360
    s_add_u32 s43, s42, s66
    s_bfe_u32 s39, s69, 655360
    s_bfe_u32 s66, s68, 655370
    s_add_u32 s44, s42, s66
    s_bfe_u32 s40, s69, 655370
    s_bfe_u32 s66, s68, 655380
    s_add_u32 s45, s42, s66
    s_bfe_u32 s41, s69, 655380
    s_and_b32 s66, s46, s33
    s_cselect_b32 s72, -1, 1
    s_cselect_b32 s76, s47, 163712
    s_cmp_ge_u32 s66, 2
    s_cselect_b32 s73, -1, 0
    s_add_u32 s77, s47, 1024
    s_cmp_ge_u32 s66, 4
    s_cselect_b32 s75, -1, 0
    s_cmp_ge_u32 s66, 3
    s_cselect_b32 s74, -1, 1
    s_cselect_b32 s77, s77, 163712
    v_add_u32 v252, s44, v247
    ds_read_u16 v238, v252
    ds_read_u16 v239, v252 offset:64
    v_add_u32 v252, s45, v247
    ds_read_u16 v240, v252
    ds_read_u16 v241, v252 offset:64
    v_mfma_f32_32x32x16_bf16 v[32:47], v[64:67], v[180:183], 0
    v_mul_f32 v196, v0, v96
    v_fmac_f32 v196, v1, v97
    v_fmac_f32 v196, v2, v98
    v_fmac_f32 v196, v3, v99
    v_fmac_f32 v196, v4, v100
    v_fmac_f32 v196, v5, v101
    v_fmac_f32 v196, v6, v102
    v_fmac_f32 v196, v7, v103
    v_mul_f32 v198, v8, v128
    v_fmac_f32 v198, v9, v129
    v_mfma_f32_32x32x16_bf16 v[48:63], v[68:71], v[180:183], 0
    v_lshl_add_u32 v253, v248, 2, s47
    ds_read_b32 v254, v253
    ds_read_b32 v255, v253 offset:1024
    s_waitcnt vmcnt(5)
    ds_read_b64_tr_b16 v[176:177], v244 offset:4096
    ds_read_b64_tr_b16 v[178:179], v244 offset:5120
    ds_read_b64_tr_b16 v[180:181], v245 offset:4096
    ds_read_b64_tr_b16 v[182:183], v245 offset:5120
    v_fmac_f32 v198, v10, v130
    v_fmac_f32 v198, v11, v131
    v_fmac_f32 v198, v12, v132
    v_fmac_f32 v198, v13, v133
    v_fmac_f32 v198, v14, v134
    v_fmac_f32 v198, v15, v135
    v_mul_f32 v200, v16, v128
    v_fmac_f32 v200, v17, v129
    v_permlane32_swap_b32 v196, v198
    v_mfma_f32_32x32x8_bf16 v[32:47], v[72:73], v[184:185], v[32:47]
    v_fmac_f32 v200, v18, v130
    v_fmac_f32 v200, v19, v131
    v_fmac_f32 v200, v20, v132
    v_fmac_f32 v200, v21, v133
    v_fmac_f32 v200, v22, v134
    v_fmac_f32 v200, v23, v135
    v_add_f32 v198, v196, v198
    v_mul_f32_e64 v202, v24, -v128
    v_fma_f32 v202, v25, -v129, v202
    v_mfma_f32_32x32x8_bf16 v[48:63], v[76:77], v[184:185], v[48:63]
    v_fma_f32 v202, v26, -v130, v202
    v_fma_f32 v202, v27, -v131, v202
    v_fma_f32 v202, v28, -v132, v202
    v_fma_f32 v202, v29, -v133, v202
    v_fma_f32 v202, v30, -v134, v202
    v_fma_f32 v202, v31, -v135, v202
    s_nop 1
    v_permlane32_swap_b32 v200, v202
    v_add_f32 v202, v200, v202
    s_waitcnt vmcnt(3) lgkmcnt(0)
    v_mfma_f32_32x32x16_bf16 v[0:15], v[64:67], v[176:179], 0
    v_mul_f32 v197, v32, v104
    v_fmac_f32 v197, v33, v105
    v_fmac_f32 v197, v34, v106
    v_fmac_f32 v197, v35, v107
    v_fmac_f32 v197, v36, v108
    v_fmac_f32 v197, v37, v109
    v_fmac_f32 v197, v38, v110
    v_fmac_f32 v197, v39, v111
    v_mul_f32 v199, v40, v136
    v_fmac_f32 v199, v41, v137
    v_fmac_f32 v199, v42, v138
    s_add_u32 m0, s21, 4096
    v_mfma_f32_32x32x16_bf16 v[16:31], v[68:71], v[176:179], 0
    buffer_load_dwordx4 v234, s[4:7], s37 offen lds
    buffer_load_dwordx4 v235, s[8:11], s37 offen offset:1024 lds
    ds_read_b64_tr_b16 v[176:177], v244 offset:6144
    ds_read_b64_tr_b16 v[184:185], v245 offset:6144
    v_add_u32 v252, s42, v247
    ds_read_u16 v234, v252
    ds_read_u16 v235, v252 offset:64
    s_mov_b32 m0, s76
    s_mov_b64 exec, s[72:73]
    buffer_load_dwordx4 v254, s[12:15], 0 offen  lds
    s_mov_b32 m0, s77
    s_mov_b64 exec, s[74:75]
    buffer_load_dwordx4 v255, s[12:15], 0 offen  lds
    s_mov_b64 exec, -1
    v_fmac_f32 v199, v43, v139
    v_fmac_f32 v199, v44, v140
    v_fmac_f32 v199, v45, v141
    v_fmac_f32 v199, v46, v142
    v_fmac_f32 v199, v47, v143
    v_mul_f32 v201, v48, v136
    v_fmac_f32 v201, v49, v137
    v_permlane32_swap_b32 v197, v199
    v_fmac_f32 v201, v50, v138
    v_fmac_f32 v201, v51, v139
    s_waitcnt lgkmcnt(2)
    v_mfma_f32_32x32x8_bf16 v[0:15], v[72:73], v[176:177], v[0:15]
    v_fmac_f32 v201, v52, v140
    v_fmac_f32 v201, v53, v141
    v_fmac_f32 v201, v54, v142
    v_fmac_f32 v201, v55, v143
    v_add_f32 v199, v197, v199
    v_mul_f32_e64 v203, v56, -v136
    v_fma_f32 v203, v57, -v137, v203
    v_fma_f32 v203, v58, -v138, v203
    v_fma_f32 v203, v59, -v139, v203
    v_fma_f32 v203, v60, -v140, v203
    v_fma_f32 v203, v61, -v141, v203
    s_add_u32 m0, s21, 6144
    v_mfma_f32_32x32x8_bf16 v[16:31], v[76:77], v[176:177], v[16:31]
    buffer_load_dwordx4 v236, s[4:7], s37 offen lds
    v_add_u32 v252, s43, v247
    ds_read_u16 v236, v252
    ds_read_u16 v237, v252 offset:64
    v_fma_f32 v203, v62, -v142, v203
    v_fma_f32 v203, v63, -v143, v203
    s_nop 1
    v_permlane32_swap_b32 v201, v203
    v_add_f32 v203, v201, v203
    s_set_gpr_idx_on s51, gpr_idx(DST)
    s_nop 0
    v_cvt_pk_bf16_f32 v204, v198, v199
    v_cvt_pk_bf16_f32 v205, v202, v203
    s_set_gpr_idx_off
    v_mfma_f32_32x32x16_bf16 v[32:47], v[64:67], v[180:183], 0
    v_mul_f32 v196, v0, v144
    v_fmac_f32 v196, v1, v145
    v_fmac_f32 v196, v2, v146
    v_fmac_f32 v196, v3, v147
    v_fmac_f32 v196, v4, v148
    v_fmac_f32 v196, v5, v149
    v_fmac_f32 v196, v6, v150
    v_fmac_f32 v196, v7, v151
    v_mfma_f32_32x32x16_bf16 v[48:63], v[68:71], v[180:183], 0
    s_waitcnt vmcnt(6)
    ds_read_b64_tr_b16 v[176:177], v244 offset:0
    ds_read_b64_tr_b16 v[178:179], v244 offset:1024
    ds_read_b64_tr_b16 v[180:181], v245 offset:0
    ds_read_b64_tr_b16 v[182:183], v245 offset:1024
    v_mul_f32 v198, v8, v112
    v_fmac_f32 v198, v9, v113
    v_fmac_f32 v198, v10, v114
    v_fmac_f32 v198, v11, v115
    v_fmac_f32 v198, v12, v116
    v_fmac_f32 v198, v13, v117
    v_fmac_f32 v198, v14, v118
    v_fmac_f32 v198, v15, v119
    v_mfma_f32_32x32x8_bf16 v[32:47], v[72:73], v[184:185], v[32:47]
    v_mul_f32_e64 v200, v16, -v160
    v_fma_f32 v200, v17, -v161, v200
    v_fma_f32 v200, v18, -v162, v200
    v_fma_f32 v200, v19, -v163, v200
    v_fma_f32 v200, v20, -v164, v200
    v_fma_f32 v200, v21, -v165, v200
    v_fma_f32 v200, v22, -v166, v200
    v_fma_f32 v200, v23, -v167, v200
    v_mfma_f32_32x32x8_bf16 v[48:63], v[76:77], v[184:185], v[48:63]
    v_mul_f32_e64 v202, v24, -v160
    v_fma_f32 v202, v25, -v161, v202
    v_fma_f32 v202, v26, -v162, v202
    v_fma_f32 v202, v27, -v163, v202
    v_fma_f32 v202, v28, -v164, v202
    v_fma_f32 v202, v29, -v165, v202
    v_fma_f32 v202, v30, -v166, v202
    v_fma_f32 v202, v31, -v167, v202
    s_waitcnt vmcnt(5) lgkmcnt(0)
    v_mfma_f32_32x32x16_bf16 v[0:15], v[64:67], v[176:179], 0
    v_mul_f32 v197, v32, v152
    v_fmac_f32 v197, v33, v153
    v_fmac_f32 v197, v34, v154
    v_fmac_f32 v197, v35, v155
    v_fmac_f32 v197, v36, v156
    v_fmac_f32 v197, v37, v157
    v_fmac_f32 v197, v38, v158
    v_fmac_f32 v197, v39, v159
    s_add_u32 m0, s21, 0
    v_mfma_f32_32x32x16_bf16 v[16:31], v[68:71], v[176:179], 0
    v_lshl_add_u32 v234, v234, 10, v246
    v_lshl_add_u32 v235, v235, 10, v246
    buffer_load_dwordx4 v234, s[4:7], s38 offen lds
    buffer_load_dwordx4 v235, s[8:11], s38 offen offset:1024 lds
    ds_read_b64_tr_b16 v[176:177], v244 offset:2048
    ds_read_b64_tr_b16 v[184:185], v245 offset:2048
    v_mul_f32 v199, v40, v120
    v_fmac_f32 v199, v41, v121
    v_fmac_f32 v199, v42, v122
    v_fmac_f32 v199, v43, v123
    v_fmac_f32 v199, v44, v124
    v_fmac_f32 v199, v45, v125
    v_fmac_f32 v199, v46, v126
    v_fmac_f32 v199, v47, v127
    s_waitcnt lgkmcnt(0)
    v_mfma_f32_32x32x8_bf16 v[0:15], v[72:73], v[176:177], v[0:15]
    v_mul_f32_e64 v201, v48, -v168
    v_fma_f32 v201, v49, -v169, v201
    v_fma_f32 v201, v50, -v170, v201
    v_fma_f32 v201, v51, -v171, v201
    v_fma_f32 v201, v52, -v172, v201
    v_fma_f32 v201, v53, -v173, v201
    v_fma_f32 v201, v54, -v174, v201
    v_fma_f32 v201, v55, -v175, v201
    s_add_u32 m0, s21, 2048
    v_mfma_f32_32x32x8_bf16 v[16:31], v[76:77], v[176:177], v[16:31]
    v_lshl_add_u32 v236, v236, 10, v246
    v_lshl_add_u32 v237, v237, 10, v246
    buffer_load_dwordx4 v236, s[4:7], s39 offen lds
    buffer_load_dwordx4 v237, s[8:11], s39 offen offset:1024 lds
    v_mul_f32_e64 v203, v56, -v168
    v_fma_f32 v203, v57, -v169, v203
    v_fma_f32 v203, v58, -v170, v203
    v_fma_f32 v203, v59, -v171, v203
    v_fma_f32 v203, v60, -v172, v203
    v_fma_f32 v203, v61, -v173, v203
    v_fma_f32 v203, v62, -v174, v203
    v_fma_f32 v203, v63, -v175, v203
    v_mfma_f32_32x32x16_bf16 v[32:47], v[64:67], v[180:183], 0
    v_mul_f32 v254, v0, v144
    v_fmac_f32 v254, v1, v145
    v_fmac_f32 v254, v2, v146
    v_fmac_f32 v254, v3, v147
    v_fmac_f32 v254, v4, v148
    v_mfma_f32_32x32x16_bf16 v[48:63], v[68:71], v[180:183], 0
    ds_swizzle_b32 v68, v68 offset:0x401F
    ds_swizzle_b32 v69, v69 offset:0x401F
    ds_swizzle_b32 v70, v70 offset:0x401F
    ds_swizzle_b32 v71, v71 offset:0x401F
    s_waitcnt vmcnt(7)
    ds_read_b64_tr_b16 v[176:177], v244 offset:4096
    ds_read_b64_tr_b16 v[178:179], v244 offset:5120
    ds_read_b64_tr_b16 v[180:181], v245 offset:4096
    ds_read_b64_tr_b16 v[182:183], v245 offset:5120
    v_fmac_f32 v254, v5, v149
    v_fmac_f32 v254, v6, v150
    v_fmac_f32 v254, v7, v151
    v_fmac_f32 v200, v8, v160
    v_mfma_f32_32x32x8_bf16 v[32:47], v[72:73], v[184:185], v[32:47]
    v_fmac_f32 v200, v9, v161
    v_permlane32_swap_b32 v196, v254
    v_fmac_f32 v200, v10, v162
    v_fmac_f32 v200, v11, v163
    v_fmac_f32 v200, v12, v164
    v_mfma_f32_32x32x8_bf16 v[48:63], v[76:77], v[184:185], v[48:63]
    ds_swizzle_b32 v76, v76 offset:0x401F
    ds_swizzle_b32 v77, v77 offset:0x401F
    v_fmac_f32 v200, v13, v165
    v_fmac_f32 v200, v14, v166
    v_fmac_f32 v200, v15, v167
    v_add_f32 v254, v196, v254
    s_waitcnt lgkmcnt(6)
    s_mov_b64 exec, s[56:57]
    v_xor_b32 v68, 0x80008000, v68
    v_xor_b32 v69, 0x80008000, v69
    v_xor_b32 v70, 0x80008000, v70
    v_xor_b32 v71, 0x80008000, v71
    s_mov_b64 exec, -1
    s_waitcnt vmcnt(4) lgkmcnt(2)
    v_mfma_f32_32x32x16_bf16 v[0:15], v[64:67], v[176:179], 0
    v_mul_f32 v255, v32, v152
    v_fmac_f32 v255, v33, v153
    v_fmac_f32 v255, v34, v154
    v_fmac_f32 v255, v35, v155
    v_fmac_f32 v255, v36, v156
    v_fmac_f32 v255, v37, v157
    s_add_u32 m0, s21, 4096
    v_mfma_f32_32x32x16_bf16 v[16:31], v[68:71], v[176:179], v[16:31]
    v_lshl_add_u32 v238, v238, 10, v246
    v_lshl_add_u32 v239, v239, 10, v246
    buffer_load_dwordx4 v238, s[4:7], s40 offen lds
    buffer_load_dwordx4 v239, s[8:11], s40 offen offset:1024 lds
    ds_read_b64_tr_b16 v[176:177], v244 offset:6144
    ds_read_b64_tr_b16 v[184:185], v245 offset:6144
    v_fmac_f32 v255, v38, v158
    v_fmac_f32 v255, v39, v159
    v_fmac_f32 v201, v40, v168
    v_fmac_f32 v201, v41, v169
    v_permlane32_swap_b32 v197, v255
    s_waitcnt lgkmcnt(0)
    s_mov_b64 exec, s[56:57]
    v_xor_b32 v76, 0x80008000, v76
    v_xor_b32 v77, 0x80008000, v77
    s_mov_b64 exec, -1
    v_mfma_f32_32x32x8_bf16 v[0:15], v[72:73], v[176:177], v[0:15]
    v_fmac_f32 v201, v42, v170
    v_fmac_f32 v201, v43, v171
    v_fmac_f32 v201, v44, v172
    v_fmac_f32 v201, v45, v173
    v_fmac_f32 v201, v46, v174
    v_fmac_f32 v201, v47, v175
    s_add_u32 m0, s21, 6144
    v_mfma_f32_32x32x8_bf16 v[16:31], v[76:77], v[176:177], v[16:31]
    v_lshl_add_u32 v240, v240, 10, v246
    v_lshl_add_u32 v241, v241, 10, v246
    buffer_load_dwordx4 v240, s[4:7], s41 offen lds
    buffer_load_dwordx4 v241, s[8:11], s41 offen offset:1024 lds
    v_add_f32 v255, v197, v255
    s_set_gpr_idx_on s51, gpr_idx(DST)
    s_nop 0
    v_cvt_pk_bf16_f32 v206, v254, v255
    s_set_gpr_idx_off
    v_mfma_f32_32x32x16_bf16 v[32:47], v[64:67], v[180:183], 0
    v_mul_f32 v254, v0, v144
    v_fmac_f32 v254, v1, v145
    v_fmac_f32 v254, v2, v146
    v_fmac_f32 v254, v3, v147
    v_fmac_f32 v254, v4, v148
    v_fmac_f32 v254, v5, v149
    v_fmac_f32 v254, v6, v150
    v_fmac_f32 v254, v7, v151
    v_fma_f32 v202, v8, -v160, v202
    v_fma_f32 v202, v9, -v161, v202
    v_mfma_f32_32x32x16_bf16 v[48:63], v[68:71], v[180:183], v[48:63]
    s_waitcnt vmcnt(6)
    ds_read_b64_tr_b16 v[176:177], v244 offset:0
    ds_read_b64_tr_b16 v[178:179], v244 offset:1024
    ds_read_b64_tr_b16 v[180:181], v245 offset:0
    ds_read_b64_tr_b16 v[182:183], v245 offset:1024
    v_permlane32_swap_b32 v254, v200
    v_fma_f32 v202, v10, -v162, v202
    v_fma_f32 v202, v11, -v163, v202
    v_fma_f32 v202, v12, -v164, v202
    v_fma_f32 v202, v13, -v165, v202
    v_fma_f32 v202, v14, -v166, v202
    v_fma_f32 v202, v15, -v167, v202
    v_add_f32 v200, v254, v200
    v_fmac_f32 v198, v16, v112
    v_permlane32_swap_b32 v202, v254
    v_mfma_f32_32x32x8_bf16 v[32:47], v[72:73], v[184:185], v[32:47]
    v_fmac_f32 v198, v17, v113
    v_fmac_f32 v198, v18, v114
    v_fmac_f32 v198, v19, v115
    v_fmac_f32 v198, v20, v116
    v_fmac_f32 v198, v21, v117
    v_fmac_f32 v198, v22, v118
    v_fmac_f32 v198, v23, v119
    v_add_f32 v254, v202, v254
    v_mul_f32 v196, v24, v160
    v_fmac_f32 v196, v25, v161
    v_mfma_f32_32x32x8_bf16 v[48:63], v[76:77], v[184:185], v[48:63]
    v_add_u32 v249, s48, v249
    v_add_u32 v250, s49, v250
    ds_read_b32 v252, v251 offset:16
    ds_read_b64_tr_b16 v[68:69], v249 offset:0
    ds_read_b64_tr_b16 v[70:71], v249 offset:256
    s_mov_b64 exec, s[54:55]
    ds_read_u16_d16_hi v242, v250 offset:0
    s_mov_b64 exec, -1
    v_fmac_f32 v196, v26, v162
    v_fmac_f32 v196, v27, v163
    v_fmac_f32 v196, v28, v164
    v_fmac_f32 v196, v29, v165
    v_fmac_f32 v196, v30, v166
    v_fmac_f32 v196, v31, v167
    s_nop 1
    v_permlane32_swap_b32 v198, v196
    v_add_f32 v196, v198, v196
    v_mul_f32 v255, v32, v152
    v_fmac_f32 v255, v33, v153
    v_fmac_f32 v255, v34, v154
    v_fmac_f32 v255, v35, v155
    v_fmac_f32 v255, v36, v156
    v_fmac_f32 v255, v37, v157
    v_fmac_f32 v255, v38, v158
    v_fmac_f32 v255, v39, v159
    v_fma_f32 v203, v40, -v168, v203
    v_fma_f32 v203, v41, -v169, v203
    v_permlane32_swap_b32 v255, v201
    v_fma_f32 v203, v42, -v170, v203
    v_fma_f32 v203, v43, -v171, v203
    v_fma_f32 v203, v44, -v172, v203
    v_fma_f32 v203, v45, -v173, v203
    v_fma_f32 v203, v46, -v174, v203
    v_fma_f32 v203, v47, -v175, v203
    v_add_f32 v201, v255, v201
    v_fmac_f32 v199, v48, v120
    v_permlane32_swap_b32 v203, v255
    v_fmac_f32 v199, v49, v121
    v_fmac_f32 v199, v50, v122
    v_fmac_f32 v199, v51, v123
    v_fmac_f32 v199, v52, v124
    v_fmac_f32 v199, v53, v125
    v_fmac_f32 v199, v54, v126
    v_fmac_f32 v199, v55, v127
    v_add_f32 v255, v203, v255
    v_mul_f32 v197, v56, v168
    v_fmac_f32 v197, v57, v169
    v_fmac_f32 v197, v58, v170
    v_fmac_f32 v197, v59, v171
    v_fmac_f32 v197, v60, v172
    v_fmac_f32 v197, v61, v173
    v_fmac_f32 v197, v62, v174
    v_fmac_f32 v197, v63, v175
    s_nop 1
    v_permlane32_swap_b32 v199, v197
    v_add_f32 v197, v199, v197
    s_set_gpr_idx_on s51, gpr_idx(DST)
    s_nop 0
    v_cvt_pk_bf16_f32 v207, v200, v201
    v_cvt_pk_bf16_f32 v209, v254, v255
    v_cvt_pk_bf16_f32 v208, v196, v197
    s_set_gpr_idx_off
    s_add_u32 s50, s50, 1
    s_add_u32 s51, s51, 6
    s_cmp_ge_u32 s50, 4
    s_cbranch_scc1 LAST0
    s_waitcnt lgkmcnt(3)
    v_readfirstlane_b32 s66, v252
    s_add_u32 s53, s53, 1
    v_mov_b32 v252, s53
    s_cmp_le_u32 s53, s66
    ds_write2_b32 v251, v252, v252 offset0:0 offset1:8
    s_setprio 1
    s_cbranch_scc1 PRIO_6
    s_setprio 0
PRIO_6:
    s_cmp_eq_u32 s52, 4
    s_cbranch_scc1 ITEM_0_4
    s_cmp_eq_u32 s52, 5
    s_cbranch_scc1 ITEM_0_5
    s_cmp_eq_u32 s52, 3
    s_cbranch_scc1 ITEM_0_3
    s_cmp_eq_u32 s52, 6
    s_cbranch_scc1 ITEM_0_6
    s_cmp_eq_u32 s52, 8
    s_cbranch_scc1 ITEM_0_8
    s_branch ITEM_0_2
.p2align 6
ITEM_0_6:
    s_mov_b64 exec, s[54:55]
    ds_read_u16_d16_hi v243, v250 offset:128
    s_mov_b64 exec, -1
    ds_read_b64_tr_b16 v[76:77], v249 offset:512
    ds_read_b64_tr_b16 v[78:79], v249 offset:768
    ds_read_b64_tr_b16 v[84:85], v249 offset:1024
    ds_read_b64_tr_b16 v[86:87], v249 offset:1280
    s_waitcnt lgkmcnt(5)
    v_lshlrev_b32 v196, 16, v68
    v_and_b32 v197, 0xffff0000, v68
    v_lshlrev_b32 v198, 16, v69
    v_and_b32 v199, 0xffff0000, v69
    v_mul_f32_dpp v200, v242, v196 row_newbcast:0 row_mask:0xf bank_mask:0xf
    v_mul_f32_dpp v201, v242, v197 row_newbcast:1 row_mask:0xf bank_mask:0xf
    v_mul_f32_dpp v202, v242, v196 row_newbcast:8 row_mask:0xf bank_mask:0xf
    v_mul_f32_dpp v203, v242, v197 row_newbcast:9 row_mask:0xf bank_mask:0xf
    v_lshlrev_b32 v196, 16, v70
    v_and_b32 v197, 0xffff0000, v70
    v_cvt_pk_bf16_f32 v64, v200, v201
    v_cvt_pk_bf16_f32 v68, v202, v203
    v_mul_f32_dpp v200, v242, v198 row_newbcast:2 row_mask:0xf bank_mask:0xf
    v_mul_f32_dpp v201, v242, v199 row_newbcast:3 row_mask:0xf bank_mask:0xf
    v_mul_f32_dpp v202, v242, v198 row_newbcast:10 row_mask:0xf bank_mask:0xf
    v_mul_f32_dpp v203, v242, v199 row_newbcast:11 row_mask:0xf bank_mask:0xf
    v_lshlrev_b32 v198, 16, v71
    v_and_b32 v199, 0xffff0000, v71
    v_cvt_pk_bf16_f32 v65, v200, v201
    v_cvt_pk_bf16_f32 v69, v202, v203
    v_mul_f32_dpp v200, v242, v196 row_newbcast:4 row_mask:0xf bank_mask:0xf
    v_mul_f32_dpp v201, v242, v197 row_newbcast:5 row_mask:0xf bank_mask:0xf
    v_mul_f32_dpp v202, v242, v196 row_newbcast:12 row_mask:0xf bank_mask:0xf
    v_mul_f32_dpp v203, v242, v197 row_newbcast:13 row_mask:0xf bank_mask:0xf
    v_cvt_pk_bf16_f32 v66, v200, v201
    v_cvt_pk_bf16_f32 v70, v202, v203
    v_mul_f32_dpp v200, v242, v198 row_newbcast:6 row_mask:0xf bank_mask:0xf
    v_mul_f32_dpp v201, v242, v199 row_newbcast:7 row_mask:0xf bank_mask:0xf
    v_mul_f32_dpp v202, v242, v198 row_newbcast:14 row_mask:0xf bank_mask:0xf
    v_mul_f32_dpp v203, v242, v199 row_newbcast:15 row_mask:0xf bank_mask:0xf
    v_cvt_pk_bf16_f32 v67, v200, v201
    v_cvt_pk_bf16_f32 v71, v202, v203
    s_mov_b64 exec, s[54:55]
    ds_read_u16_d16_hi v242, v250 offset:256
    s_mov_b64 exec, -1
    s_waitcnt vmcnt(4) lgkmcnt(3)
    v_mfma_f32_32x32x16_bf16 v[0:15], v[64:67], v[176:179], 0
    v_lshlrev_b32 v196, 16, v76
    v_and_b32 v197, 0xffff0000, v76
    v_lshlrev_b32 v198, 16, v77
    v_and_b32 v199, 0xffff0000, v77
    v_mul_f32_dpp v200, v243, v196 row_newbcast:0 row_mask:0xf bank_mask:0xf
    v_mul_f32_dpp v201, v243, v197 row_newbcast:1 row_mask:0xf bank_mask:0xf
    v_mul_f32_dpp v202, v243, v196 row_newbcast:8 row_mask:0xf bank_mask:0xf
    v_mul_f32_dpp v203, v243, v197 row_newbcast:9 row_mask:0xf bank_mask:0xf
    v_lshlrev_b32 v196, 16, v78
    v_and_b32 v197, 0xffff0000, v78
    v_cvt_pk_bf16_f32 v72, v200, v201
    v_cvt_pk_bf16_f32 v76, v202, v203
    v_mul_f32_dpp v200, v243, v198 row_newbcast:2 row_mask:0xf bank_mask:0xf
    v_mul_f32_dpp v201, v243, v199 row_newbcast:3 row_mask:0xf bank_mask:0xf
    v_mul_f32_dpp v202, v243, v198 row_newbcast:10 row_mask:0xf bank_mask:0xf
    v_mul_f32_dpp v203, v243, v199 row_newbcast:11 row_mask:0xf bank_mask:0xf
    s_add_u32 m0, s21, 0
    v_mfma_f32_32x32x16_bf16 v[16:31], v[68:71], v[176:179], 0
    buffer_load_dwordx4 v236, s[4:7], s35 offen lds
    buffer_load_dwordx4 v237, s[8:11], s35 offen offset:1024 lds
    ds_read_b64_tr_b16 v[176:177], v244 offset:2048
    ds_read_b64_tr_b16 v[178:179], v244 offset:3072
    ds_read_b64_tr_b16 v[184:185], v245 offset:2048
    ds_read_b64_tr_b16 v[186:187], v245 offset:3072
    v_lshlrev_b32 v198, 16, v79
    v_and_b32 v199, 0xffff0000, v79
    v_cvt_pk_bf16_f32 v73, v200, v201
    v_cvt_pk_bf16_f32 v77, v202, v203
    v_mul_f32_dpp v200, v243, v196 row_newbcast:4 row_mask:0xf bank_mask:0xf
    v_mul_f32_dpp v201, v243, v197 row_newbcast:5 row_mask:0xf bank_mask:0xf
    v_mul_f32_dpp v202, v243, v196 row_newbcast:12 row_mask:0xf bank_mask:0xf
    v_mul_f32_dpp v203, v243, v197 row_newbcast:13 row_mask:0xf bank_mask:0xf
    v_cvt_pk_bf16_f32 v74, v200, v201
    v_cvt_pk_bf16_f32 v78, v202, v203
    v_mul_f32_dpp v200, v243, v198 row_newbcast:6 row_mask:0xf bank_mask:0xf
    v_mul_f32_dpp v201, v243, v199 row_newbcast:7 row_mask:0xf bank_mask:0xf
    v_mul_f32_dpp v202, v243, v198 row_newbcast:14 row_mask:0xf bank_mask:0xf
    v_mul_f32_dpp v203, v243, v199 row_newbcast:15 row_mask:0xf bank_mask:0xf
    v_cvt_pk_bf16_f32 v75, v200, v201
    v_cvt_pk_bf16_f32 v79, v202, v203
    s_nop 0
    s_waitcnt vmcnt(4) lgkmcnt(0)
    v_mfma_f32_32x32x16_bf16 v[0:15], v[72:75], v[176:179], v[0:15]
    v_lshlrev_b32 v196, 16, v84
    v_and_b32 v197, 0xffff0000, v84
    v_lshlrev_b32 v198, 16, v85
    v_and_b32 v199, 0xffff0000, v85
    v_mul_f32_dpp v200, v242, v196 row_newbcast:0 row_mask:0xf bank_mask:0xf
    v_mul_f32_dpp v201, v242, v197 row_newbcast:1 row_mask:0xf bank_mask:0xf
    v_mul_f32_dpp v202, v242, v196 row_newbcast:8 row_mask:0xf bank_mask:0xf
    v_mul_f32_dpp v203, v242, v197 row_newbcast:9 row_mask:0xf bank_mask:0xf
    v_lshlrev_b32 v196, 16, v86
    v_and_b32 v197, 0xffff0000, v86
    v_cvt_pk_bf16_f32 v80, v200, v201
    v_cvt_pk_bf16_f32 v84, v202, v203
    v_mul_f32_dpp v200, v242, v198 row_newbcast:2 row_mask:0xf bank_mask:0xf
    v_mul_f32_dpp v201, v242, v199 row_newbcast:3 row_mask:0xf bank_mask:0xf
    v_mul_f32_dpp v202, v242, v198 row_newbcast:10 row_mask:0xf bank_mask:0xf
    v_mul_f32_dpp v203, v242, v199 row_newbcast:11 row_mask:0xf bank_mask:0xf
    s_add_u32 m0, s21, 2048
    v_mfma_f32_32x32x16_bf16 v[16:31], v[76:79], v[176:179], v[16:31]
    buffer_load_dwordx4 v238, s[4:7], s35 offen lds
    buffer_load_dwordx4 v239, s[8:11], s35 offen offset:1024 lds
    ds_read_b64_tr_b16 v[176:177], v244 offset:4096
    ds_read_b64_tr_b16 v[178:179], v244 offset:5120
    ds_read_b64_tr_b16 v[188:189], v245 offset:4096
    ds_read_b64_tr_b16 v[190:191], v245 offset:5120
    v_lshlrev_b32 v198, 16, v87
    v_and_b32 v199, 0xffff0000, v87
    v_cvt_pk_bf16_f32 v81, v200, v201
    v_cvt_pk_bf16_f32 v85, v202, v203
    v_mul_f32_dpp v200, v242, v196 row_newbcast:4 row_mask:0xf bank_mask:0xf
    v_mul_f32_dpp v201, v242, v197 row_newbcast:5 row_mask:0xf bank_mask:0xf
    v_mul_f32_dpp v202, v242, v196 row_newbcast:12 row_mask:0xf bank_mask:0xf
    v_mul_f32_dpp v203, v242, v197 row_newbcast:13 row_mask:0xf bank_mask:0xf
    v_cvt_pk_bf16_f32 v82, v200, v201
    v_cvt_pk_bf16_f32 v86, v202, v203
    v_mul_f32_dpp v200, v242, v198 row_newbcast:6 row_mask:0xf bank_mask:0xf
    v_mul_f32_dpp v201, v242, v199 row_newbcast:7 row_mask:0xf bank_mask:0xf
    v_mul_f32_dpp v202, v242, v198 row_newbcast:14 row_mask:0xf bank_mask:0xf
    v_mul_f32_dpp v203, v242, v199 row_newbcast:15 row_mask:0xf bank_mask:0xf
    v_cvt_pk_bf16_f32 v83, v200, v201
    v_cvt_pk_bf16_f32 v87, v202, v203
    s_nop 0
    s_waitcnt lgkmcnt(0)
    v_mfma_f32_32x32x16_bf16 v[0:15], v[80:83], v[176:179], v[0:15]
    s_add_u32 m0, s21, 4096
    v_mfma_f32_32x32x16_bf16 v[16:31], v[84:87], v[176:179], v[16:31]
    buffer_load_dwordx4 v234, s[4:7], s36 offen lds
    buffer_load_dwordx4 v235, s[8:11], s36 offen offset:1024 lds
    s_mov_b32 m0, s50
    s_nop 0
    s_movrels_b32 s71, s23
    s_bfe_u32 s46, s71, 0x30012
    s_mov_b32 m0, s46
    s_and_b32 s66, s71, 0x3ffff
    s_movrels_b32 s68, s57
    s_movrels_b32 s69, s61
    s_sub_u32 s48, s66, s47
    s_mov_b32 s47, s66
    s_lshr_b32 s52, s71, 28
    s_lshl_b32 s67, s46, 9
    s_add_u32 s66, s66, s67
    s_sub_u32 s49, s66, s42
    s_mov_b32 s42, s66
    s_bfe_u32 s66, s68, 655360
    s_add_u32 s43, s42, s66
    s_bfe_u32 s39, s69, 655360
    s_bfe_u32 s66, s68, 655370
    s_add_u32 s44, s42, s66
    s_bfe_u32 s40, s69, 655370
    s_bfe_u32 s66, s68, 655380
    s_add_u32 s45, s42, s66
    s_bfe_u32 s41, s69, 655380
    s_and_b32 s66, s46, s33
    s_cselect_b32 s72, -1, 1
    s_cselect_b32 s76, s47, 163712
    s_cmp_ge_u32 s66, 2
    s_cselect_b32 s73, -1, 0
    s_add_u32 s77, s47, 1024
    s_cmp_ge_u32 s66, 4
    s_cselect_b32 s75, -1, 0
    s_cmp_ge_u32 s66, 3
    s_cselect_b32 s74, -1, 1
    s_cselect_b32 s77, s77, 163712
    v_add_u32 v252, s45, v247
    ds_read_u16 v240, v252
    ds_read_u16 v241, v252 offset:64
    v_mfma_f32_32x32x16_bf16 v[32:47], v[64:67], v[180:183], 0
    v_mul_f32 v196, v0, v96
    v_fmac_f32 v196, v1, v97
    v_fmac_f32 v196, v2, v98
    v_fmac_f32 v196, v3, v99
    v_fmac_f32 v196, v4, v100
    v_fmac_f32 v196, v5, v101
    v_fmac_f32 v196, v6, v102
    v_mfma_f32_32x32x16_bf16 v[48:63], v[68:71], v[180:183], 0
    v_lshl_add_u32 v253, v248, 2, s47
    ds_read_b32 v254, v253
    ds_read_b32 v255, v253 offset:1024
    v_fmac_f32 v196, v7, v103
    v_mul_f32 v198, v8, v128
    v_fmac_f32 v198, v9, v129
    v_fmac_f32 v198, v10, v130
    v_fmac_f32 v198, v11, v131
    v_fmac_f32 v198, v12, v132
    v_mfma_f32_32x32x16_bf16 v[32:47], v[72:75], v[184:187], v[32:47]
    v_fmac_f32 v198, v13, v133
    v_fmac_f32 v198, v14, v134
    v_fmac_f32 v198, v15, v135
    v_mul_f32 v200, v16, v128
    v_fmac_f32 v200, v17, v129
    v_permlane32_swap_b32 v196, v198
    v_mfma_f32_32x32x16_bf16 v[48:63], v[76:79], v[184:187], v[48:63]
    s_waitcnt vmcnt(6)
    ds_read_b64_tr_b16 v[176:177], v244 offset:6144
    ds_read_b64_tr_b16 v[178:179], v244 offset:7168
    ds_read_b64_tr_b16 v[180:181], v245 offset:6144
    ds_read_b64_tr_b16 v[182:183], v245 offset:7168
    v_fmac_f32 v200, v18, v130
    v_fmac_f32 v200, v19, v131
    v_fmac_f32 v200, v20, v132
    v_fmac_f32 v200, v21, v133
    v_fmac_f32 v200, v22, v134
    v_fmac_f32 v200, v23, v135
    v_mfma_f32_32x32x16_bf16 v[32:47], v[80:83], v[188:191], v[32:47]
    v_add_f32 v198, v196, v198
    v_mul_f32_e64 v202, v24, -v128
    v_fma_f32 v202, v25, -v129, v202
    v_fma_f32 v202, v26, -v130, v202
    v_fma_f32 v202, v27, -v131, v202
    v_fma_f32 v202, v28, -v132, v202
    v_mfma_f32_32x32x16_bf16 v[48:63], v[84:87], v[188:191], v[48:63]
    v_fma_f32 v202, v29, -v133, v202
    v_fma_f32 v202, v30, -v134, v202
    v_fma_f32 v202, v31, -v135, v202
    s_nop 1
    v_permlane32_swap_b32 v200, v202
    v_add_f32 v202, v200, v202
    s_waitcnt vmcnt(4) lgkmcnt(0)
    v_mfma_f32_32x32x16_bf16 v[0:15], v[64:67], v[176:179], 0
    v_mul_f32 v197, v32, v104
    v_fmac_f32 v197, v33, v105
    v_fmac_f32 v197, v34, v106
    v_fmac_f32 v197, v35, v107
    v_fmac_f32 v197, v36, v108
    v_fmac_f32 v197, v37, v109
    v_fmac_f32 v197, v38, v110
    s_add_u32 m0, s21, 6144
    v_mfma_f32_32x32x16_bf16 v[16:31], v[68:71], v[176:179], 0
    buffer_load_dwordx4 v236, s[4:7], s36 offen lds
    buffer_load_dwordx4 v237, s[8:11], s36 offen offset:1024 lds
    ds_read_b64_tr_b16 v[176:177], v244 offset:0
    ds_read_b64_tr_b16 v[178:179], v244 offset:1024
    ds_read_b64_tr_b16 v[184:185], v245 offset:0
    ds_read_b64_tr_b16 v[186:187], v245 offset:1024
    s_mov_b32 m0, s76
    s_mov_b64 exec, s[72:73]
    buffer_load_dwordx4 v254, s[12:15], 0 offen  lds
    s_mov_b32 m0, s77
    s_mov_b64 exec, s[74:75]
    buffer_load_dwordx4 v255, s[12:15], 0 offen  lds
    s_mov_b64 exec, -1
    v_fmac_f32 v197, v39, v111
    v_mul_f32 v199, v40, v136
    v_fmac_f32 v199, v41, v137
    v_fmac_f32 v199, v42, v138
    v_fmac_f32 v199, v43, v139
    v_fmac_f32 v199, v44, v140
    v_fmac_f32 v199, v45, v141
    s_waitcnt vmcnt(6) lgkmcnt(0)
    v_mfma_f32_32x32x16_bf16 v[0:15], v[72:75], v[176:179], v[0:15]
    v_fmac_f32 v199, v46, v142
    v_fmac_f32 v199, v47, v143
    v_mul_f32 v201, v48, v136
    v_fmac_f32 v201, v49, v137
    v_permlane32_swap_b32 v197, v199
    v_fmac_f32 v201, v50, v138
    v_fmac_f32 v201, v51, v139
    s_add_u32 m0, s21, 0
    v_mfma_f32_32x32x16_bf16 v[16:31], v[76:79], v[176:179], v[16:31]
    buffer_load_dwordx4 v238, s[4:7], s36 offen lds
    buffer_load_dwordx4 v239, s[8:11], s36 offen offset:1024 lds
    ds_read_b64_tr_b16 v[176:177], v244 offset:2048
    ds_read_b64_tr_b16 v[178:179], v244 offset:3072
    ds_read_b64_tr_b16 v[188:189], v245 offset:2048
    ds_read_b64_tr_b16 v[190:191], v245 offset:3072
    v_fmac_f32 v201, v52, v140
    v_fmac_f32 v201, v53, v141
    v_fmac_f32 v201, v54, v142
    v_fmac_f32 v201, v55, v143
    v_add_f32 v199, v197, v199
    v_mul_f32_e64 v203, v56, -v136
    v_fma_f32 v203, v57, -v137, v203
    s_waitcnt lgkmcnt(0)
    v_mfma_f32_32x32x16_bf16 v[0:15], v[80:83], v[176:179], v[0:15]
    v_fma_f32 v203, v58, -v138, v203
    v_fma_f32 v203, v59, -v139, v203
    v_fma_f32 v203, v60, -v140, v203
    v_fma_f32 v203, v61, -v141, v203
    v_fma_f32 v203, v62, -v142, v203
    v_fma_f32 v203, v63, -v143, v203
    s_nop 1
    s_add_u32 m0, s21, 2048
    v_mfma_f32_32x32x16_bf16 v[16:31], v[84:87], v[176:179], v[16:31]
    buffer_load_dwordx4 v234, s[4:7], s37 offen lds
    buffer_load_dwordx4 v235, s[8:11], s37 offen offset:1024 lds
    v_add_u32 v252, s42, v247
    ds_read_u16 v234, v252
    ds_read_u16 v235, v252 offset:64
    v_permlane32_swap_b32 v201, v203
    v_add_f32 v203, v201, v203
    s_set_gpr_idx_on s51, gpr_idx(DST)
    s_nop 0
    v_cvt_pk_bf16_f32 v204, v198, v199
    v_cvt_pk_bf16_f32 v205, v202, v203
    s_set_gpr_idx_off
    v_mfma_f32_32x32x16_bf16 v[32:47], v[64:67], v[180:183], 0
    v_mul_f32 v196, v0, v144
    v_fmac_f32 v196, v1, v145
    v_fmac_f32 v196, v2, v146
    v_fmac_f32 v196, v3, v147
    v_fmac_f32 v196, v4, v148
    v_fmac_f32 v196, v5, v149
    v_mfma_f32_32x32x16_bf16 v[48:63], v[68:71], v[180:183], 0
    v_fmac_f32 v196, v6, v150
    v_fmac_f32 v196, v7, v151
    v_mul_f32 v198, v8, v112
    v_fmac_f32 v198, v9, v113
    v_fmac_f32 v198, v10, v114
    v_mfma_f32_32x32x16_bf16 v[32:47], v[72:75], v[184:187], v[32:47]
    v_fmac_f32 v198, v11, v115
    v_fmac_f32 v198, v12, v116
    v_fmac_f32 v198, v13, v117
    v_fmac_f32 v198, v14, v118
    v_fmac_f32 v198, v15, v119
    v_mfma_f32_32x32x16_bf16 v[48:63], v[76:79], v[184:187], v[48:63]
    s_waitcnt vmcnt(8)
    ds_read_b64_tr_b16 v[176:177], v244 offset:4096
    ds_read_b64_tr_b16 v[178:179], v244 offset:5120
    ds_read_b64_tr_b16 v[180:181], v245 offset:4096
    ds_read_b64_tr_b16 v[182:183], v245 offset:5120
    v_mul_f32_e64 v200, v16, -v160
    v_fma_f32 v200, v17, -v161, v200
    v_fma_f32 v200, v18, -v162, v200
    v_fma_f32 v200, v19, -v163, v200
    v_fma_f32 v200, v20, -v164, v200
    v_fma_f32 v200, v21, -v165, v200
    v_mfma_f32_32x32x16_bf16 v[32:47], v[80:83], v[188:191], v[32:47]
    v_fma_f32 v200, v22, -v166, v200
    v_fma_f32 v200, v23, -v167, v200
    v_mul_f32_e64 v202, v24, -v160
    v_fma_f32 v202, v25, -v161, v202
    v_fma_f32 v202, v26, -v162, v202
    v_mfma_f32_32x32x16_bf16 v[48:63], v[84:87], v[188:191], v[48:63]
    v_fma_f32 v202, v27, -v163, v202
    v_fma_f32 v202, v28, -v164, v202
    v_fma_f32 v202, v29, -v165, v202
    v_fma_f32 v202, v30, -v166, v202
    v_fma_f32 v202, v31, -v167, v202
    s_waitcnt vmcnt(6) lgkmcnt(0)
    v_mfma_f32_32x32x16_bf16 v[0:15], v[64:67], v[176:179], 0
    v_mul_f32 v197, v32, v152
    v_fmac_f32 v197, v33, v153
    v_fmac_f32 v197, v34, v154
    v_fmac_f32 v197, v35, v155
    v_fmac_f32 v197, v36, v156
    v_fmac_f32 v197, v37, v157
    s_add_u32 m0, s21, 4096
    v_mfma_f32_32x32x16_bf16 v[16:31], v[68:71], v[176:179], 0
    buffer_load_dwordx4 v236, s[4:7], s37 offen lds
    buffer_load_dwordx4 v237, s[8:11], s37 offen offset:1024 lds
    ds_read_b64_tr_b16 v[176:177], v244 offset:6144
    ds_read_b64_tr_b16 v[178:179], v244 offset:7168
    ds_read_b64_tr_b16 v[184:185], v245 offset:6144
    ds_read_b64_tr_b16 v[186:187], v245 offset:7168
    v_add_u32 v252, s43, v247
    ds_read_u16 v236, v252
    ds_read_u16 v237, v252 offset:64
    v_fmac_f32 v197, v38, v158
    v_fmac_f32 v197, v39, v159
    v_mul_f32 v199, v40, v120
    v_fmac_f32 v199, v41, v121
    v_fmac_f32 v199, v42, v122
    s_waitcnt vmcnt(4) lgkmcnt(2)
    v_mfma_f32_32x32x16_bf16 v[0:15], v[72:75], v[176:179], v[0:15]
    v_fmac_f32 v199, v43, v123
    v_fmac_f32 v199, v44, v124
    v_fmac_f32 v199, v45, v125
    v_fmac_f32 v199, v46, v126
    v_fmac_f32 v199, v47, v127
    s_add_u32 m0, s21, 6144
    v_mfma_f32_32x32x16_bf16 v[16:31], v[76:79], v[176:179], v[16:31]
    buffer_load_dwordx4 v238, s[4:7], s37 offen lds
    buffer_load_dwordx4 v239, s[8:11], s37 offen offset:1024 lds
    ds_read_b64_tr_b16 v[176:177], v244 offset:0
    ds_read_b64_tr_b16 v[178:179], v244 offset:1024
    ds_read_b64_tr_b16 v[188:189], v245 offset:0
    ds_read_b64_tr_b16 v[190:191], v245 offset:1024
    v_add_u32 v252, s44, v247
    ds_read_u16 v238, v252
    ds_read_u16 v239, v252 offset:64
    v_mul_f32_e64 v201, v48, -v168
    v_fma_f32 v201, v49, -v169, v201
    v_fma_f32 v201, v50, -v170, v201
    v_fma_f32 v201, v51, -v171, v201
    v_fma_f32 v201, v52, -v172, v201
    v_fma_f32 v201, v53, -v173, v201
    s_waitcnt lgkmcnt(2)
    v_mfma_f32_32x32x16_bf16 v[0:15], v[80:83], v[176:179], v[0:15]
    v_fma_f32 v201, v54, -v174, v201
    v_fma_f32 v201, v55, -v175, v201
    v_mul_f32_e64 v203, v56, -v168
    v_fma_f32 v203, v57, -v169, v203
    v_fma_f32 v203, v58, -v170, v203
    s_add_u32 m0, s21, 0
    v_mfma_f32_32x32x16_bf16 v[16:31], v[84:87], v[176:179], v[16:31]
    v_lshl_add_u32 v234, v234, 10, v246
    v_lshl_add_u32 v235, v235, 10, v246
    buffer_load_dwordx4 v234, s[4:7], s38 offen lds
    buffer_load_dwordx4 v235, s[8:11], s38 offen offset:1024 lds
    v_fma_f32 v203, v59, -v171, v203
    v_fma_f32 v203, v60, -v172, v203
    v_fma_f32 v203, v61, -v173, v203
    v_fma_f32 v203, v62, -v174, v203
    v_fma_f32 v203, v63, -v175, v203
    v_mfma_f32_32x32x16_bf16 v[32:47], v[64:67], v[180:183], 0
    v_mul_f32 v254, v0, v144
    v_fmac_f32 v254, v1, v145
    v_fmac_f32 v254, v2, v146
    v_mfma_f32_32x32x16_bf16 v[48:63], v[68:71], v[180:183], 0
    ds_swizzle_b32 v68, v68 offset:0x401F
    ds_swizzle_b32 v69, v69 offset:0x401F
    ds_swizzle_b32 v70, v70 offset:0x401F
    ds_swizzle_b32 v71, v71 offset:0x401F
    v_fmac_f32 v254, v3, v147
    v_fmac_f32 v254, v4, v148
    v_fmac_f32 v254, v5, v149
    v_mfma_f32_32x32x16_bf16 v[32:47], v[72:75], v[184:187], v[32:47]
    v_fmac_f32 v254, v6, v150
    v_fmac_f32 v254, v7, v151
    v_fmac_f32 v200, v8, v160
    v_mfma_f32_32x32x16_bf16 v[48:63], v[76:79], v[184:187], v[48:63]
    ds_swizzle_b32 v76, v76 offset:0x401F
    ds_swizzle_b32 v77, v77 offset:0x401F
    ds_swizzle_b32 v78, v78 offset:0x401F
    ds_swizzle_b32 v79, v79 offset:0x401F
    s_waitcnt vmcnt(6)
    ds_read_b64_tr_b16 v[176:177], v244 offset:2048
    ds_read_b64_tr_b16 v[178:179], v244 offset:3072
    ds_read_b64_tr_b16 v[180:181], v245 offset:2048
    ds_read_b64_tr_b16 v[182:183], v245 offset:3072
    v_fmac_f32 v200, v9, v161
    v_permlane32_swap_b32 v196, v254
    v_fmac_f32 v200, v10, v162
    v_mfma_f32_32x32x16_bf16 v[32:47], v[80:83], v[188:191], v[32:47]
    v_fmac_f32 v200, v11, v163
    v_fmac_f32 v200, v12, v164
    v_fmac_f32 v200, v13, v165
    v_mfma_f32_32x32x16_bf16 v[48:63], v[84:87], v[188:191], v[48:63]
    ds_swizzle_b32 v84, v84 offset:0x401F
    ds_swizzle_b32 v85, v85 offset:0x401F
    ds_swizzle_b32 v86, v86 offset:0x401F
    ds_swizzle_b32 v87, v87 offset:0x401F
    v_fmac_f32 v200, v14, v166
    v_fmac_f32 v200, v15, v167
    v_add_f32 v254, v196, v254
    s_waitcnt lgkmcnt(8)
    s_mov_b64 exec, s[56:57]
    v_xor_b32 v68, 0x80008000, v68
    v_xor_b32 v69, 0x80008000, v69
    v_xor_b32 v70, 0x80008000, v70
    v_xor_b32 v71, 0x80008000, v71
    v_xor_b32 v76, 0x80008000, v76
    v_xor_b32 v77, 0x80008000, v77
    v_xor_b32 v78, 0x80008000, v78
    v_xor_b32 v79, 0x80008000, v79
    s_mov_b64 exec, -1
    s_waitcnt vmcnt(4) lgkmcnt(4)
    v_mfma_f32_32x32x16_bf16 v[0:15], v[64:67], v[176:179], 0
    v_mul_f32 v255, v32, v152
    v_fmac_f32 v255, v33, v153
    v_fmac_f32 v255, v34, v154
    v_fmac_f32 v255, v35, v155
    s_add_u32 m0, s21, 2048
    v_mfma_f32_32x32x16_bf16 v[16:31], v[68:71], v[176:179], v[16:31]
    v_lshl_add_u32 v236, v236, 10, v246
    v_lshl_add_u32 v237, v237, 10, v246
    buffer_load_dwordx4 v236, s[4:7], s39 offen lds
    buffer_load_dwordx4 v237, s[8:11], s39 offen offset:1024 lds
    ds_read_b64_tr_b16 v[176:177], v244 offset:4096
    ds_read_b64_tr_b16 v[178:179], v244 offset:5120
    ds_read_b64_tr_b16 v[184:185], v245 offset:4096
    ds_read_b64_tr_b16 v[186:187], v245 offset:5120
    v_fmac_f32 v255, v36, v156
    v_fmac_f32 v255, v37, v157
    v_fmac_f32 v255, v38, v158
    v_fmac_f32 v255, v39, v159
    s_waitcnt vmcnt(4) lgkmcnt(0)
    v_mfma_f32_32x32x16_bf16 v[0:15], v[72:75], v[176:179], v[0:15]
    v_fmac_f32 v201, v40, v168
    v_fmac_f32 v201, v41, v169
    v_permlane32_swap_b32 v197, v255
    s_add_u32 m0, s21, 4096
    v_mfma_f32_32x32x16_bf16 v[16:31], v[76:79], v[176:179], v[16:31]
    v_lshl_add_u32 v238, v238, 10, v246
    v_lshl_add_u32 v239, v239, 10, v246
    buffer_load_dwordx4 v238, s[4:7], s40 offen lds
    buffer_load_dwordx4 v239, s[8:11], s40 offen offset:1024 lds
    ds_read_b64_tr_b16 v[176:177], v244 offset:6144
    ds_read_b64_tr_b16 v[178:179], v244 offset:7168
    ds_read_b64_tr_b16 v[188:189], v245 offset:6144
    ds_read_b64_tr_b16 v[190:191], v245 offset:7168
    v_fmac_f32 v201, v42, v170
    v_fmac_f32 v201, v43, v171
    v_fmac_f32 v201, v44, v172
    v_fmac_f32 v201, v45, v173
    s_waitcnt lgkmcnt(0)
    s_mov_b64 exec, s[56:57]
    v_xor_b32 v84, 0x80008000, v84
    v_xor_b32 v85, 0x80008000, v85
    v_xor_b32 v86, 0x80008000, v86
    v_xor_b32 v87, 0x80008000, v87
    s_mov_b64 exec, -1
    v_mfma_f32_32x32x16_bf16 v[0:15], v[80:83], v[176:179], v[0:15]
    v_fmac_f32 v201, v46, v174
    v_fmac_f32 v201, v47, v175
    v_add_f32 v255, v197, v255
    s_set_gpr_idx_on s51, gpr_idx(DST)
    s_nop 0
    v_cvt_pk_bf16_f32 v206, v254, v255
    s_set_gpr_idx_off
    s_add_u32 m0, s21, 6144
    v_mfma_f32_32x32x16_bf16 v[16:31], v[84:87], v[176:179], v[16:31]
    v_lshl_add_u32 v240, v240, 10, v246
    v_lshl_add_u32 v241, v241, 10, v246
    buffer_load_dwordx4 v240, s[4:7], s41 offen lds
    buffer_load_dwordx4 v241, s[8:11], s41 offen offset:1024 lds
    v_mfma_f32_32x32x16_bf16 v[32:47], v[64:67], v[180:183], 0
    v_mul_f32 v254, v0, v144
    v_fmac_f32 v254, v1, v145
    v_fmac_f32 v254, v2, v146
    v_fmac_f32 v254, v3, v147
    v_fmac_f32 v254, v4, v148
    v_fmac_f32 v254, v5, v149
    v_fmac_f32 v254, v6, v150
    v_mfma_f32_32x32x16_bf16 v[48:63], v[68:71], v[180:183], v[48:63]
    v_fmac_f32 v254, v7, v151
    v_fma_f32 v202, v8, -v160, v202
    v_fma_f32 v202, v9, -v161, v202
    v_permlane32_swap_b32 v254, v200
    v_fma_f32 v202, v10, -v162, v202
    v_fma_f32 v202, v11, -v163, v202
    v_mfma_f32_32x32x16_bf16 v[32:47], v[72:75], v[184:187], v[32:47]
    v_fma_f32 v202, v12, -v164, v202
    v_fma_f32 v202, v13, -v165, v202
    v_fma_f32 v202, v14, -v166, v202
    v_fma_f32 v202, v15, -v167, v202
    v_add_f32 v200, v254, v200
    v_fmac_f32 v198, v16, v112
    v_permlane32_swap_b32 v202, v254
    v_mfma_f32_32x32x16_bf16 v[48:63], v[76:79], v[184:187], v[48:63]
    s_waitcnt vmcnt(6)
    ds_read_b64_tr_b16 v[176:177], v244 offset:0
    ds_read_b64_tr_b16 v[178:179], v244 offset:1024
    ds_read_b64_tr_b16 v[180:181], v245 offset:0
    ds_read_b64_tr_b16 v[182:183], v245 offset:1024
    v_fmac_f32 v198, v17, v113
    v_fmac_f32 v198, v18, v114
    v_fmac_f32 v198, v19, v115
    v_fmac_f32 v198, v20, v116
    v_fmac_f32 v198, v21, v117
    v_fmac_f32 v198, v22, v118
    v_mfma_f32_32x32x16_bf16 v[32:47], v[80:83], v[188:191], v[32:47]
    v_fmac_f32 v198, v23, v119
    v_add_f32 v254, v202, v254
    v_mul_f32 v196, v24, v160
    v_fmac_f32 v196, v25, v161
    v_fmac_f32 v196, v26, v162
    v_fmac_f32 v196, v27, v163
    v_fmac_f32 v196, v28, v164
    v_mfma_f32_32x32x16_bf16 v[48:63], v[84:87], v[188:191], v[48:63]
    v_add_u32 v249, s48, v249
    v_add_u32 v250, s49, v250
    ds_read_b32 v252, v251 offset:16
    ds_read_b64_tr_b16 v[68:69], v249 offset:0
    ds_read_b64_tr_b16 v[70:71], v249 offset:256
    s_mov_b64 exec, s[54:55]
    ds_read_u16_d16_hi v242, v250 offset:0
    s_mov_b64 exec, -1
    v_fmac_f32 v196, v29, v165
    v_fmac_f32 v196, v30, v166
    v_fmac_f32 v196, v31, v167
    s_nop 1
    v_permlane32_swap_b32 v198, v196
    v_add_f32 v196, v198, v196
    v_mul_f32 v255, v32, v152
    v_fmac_f32 v255, v33, v153
    v_fmac_f32 v255, v34, v154
    v_fmac_f32 v255, v35, v155
    v_fmac_f32 v255, v36, v156
    v_fmac_f32 v255, v37, v157
    v_fmac_f32 v255, v38, v158
    v_fmac_f32 v255, v39, v159
    v_fma_f32 v203, v40, -v168, v203
    v_fma_f32 v203, v41, -v169, v203
    v_permlane32_swap_b32 v255, v201
    v_fma_f32 v203, v42, -v170, v203
    v_fma_f32 v203, v43, -v171, v203
    v_fma_f32 v203, v44, -v172, v203
    v_fma_f32 v203, v45, -v173, v203
    v_fma_f32 v203, v46, -v174, v203
    v_fma_f32 v203, v47, -v175, v203
    v_add_f32 v201, v255, v201
    v_fmac_f32 v199, v48, v120
    v_permlane32_swap_b32 v203, v255
    v_fmac_f32 v199, v49, v121
    v_fmac_f32 v199, v50, v122
    v_fmac_f32 v199, v51, v123
    v_fmac_f32 v199, v52, v124
    v_fmac_f32 v199, v53, v125
    v_fmac_f32 v199, v54, v126
    v_fmac_f32 v199, v55, v127
    v_add_f32 v255, v203, v255
    v_mul_f32 v197, v56, v168
    v_fmac_f32 v197, v57, v169
    v_fmac_f32 v197, v58, v170
    v_fmac_f32 v197, v59, v171
    v_fmac_f32 v197, v60, v172
    v_fmac_f32 v197, v61, v173
    v_fmac_f32 v197, v62, v174
    v_fmac_f32 v197, v63, v175
    s_nop 1
    v_permlane32_swap_b32 v199, v197
    v_add_f32 v197, v199, v197
    s_set_gpr_idx_on s51, gpr_idx(DST)
    s_nop 0
    v_cvt_pk_bf16_f32 v207, v200, v201
    v_cvt_pk_bf16_f32 v209, v254, v255
    v_cvt_pk_bf16_f32 v208, v196, v197
    s_set_gpr_idx_off
    s_add_u32 s50, s50, 1
    s_add_u32 s51, s51, 6
    s_cmp_ge_u32 s50, 4
    s_cbranch_scc1 LAST0
    s_waitcnt lgkmcnt(3)
    v_readfirstlane_b32 s66, v252
    s_add_u32 s53, s53, 1
    v_mov_b32 v252, s53
    s_cmp_le_u32 s53, s66
    ds_write2_b32 v251, v252, v252 offset0:0 offset1:8
    s_setprio 1
    s_cbranch_scc1 PRIO_7
    s_setprio 0
PRIO_7:
    s_cmp_eq_u32 s52, 4
    s_cbranch_scc1 ITEM_0_4
    s_cmp_eq_u32 s52, 5
    s_cbranch_scc1 ITEM_0_5
    s_cmp_eq_u32 s52, 3
    s_cbranch_scc1 ITEM_0_3
    s_cmp_eq_u32 s52, 6
    s_cbranch_scc1 ITEM_0_6
    s_cmp_eq_u32 s52, 8
    s_cbranch_scc1 ITEM_0_8
    s_branch ITEM_0_2
.p2align 6
ITEM_0_8:
    s_mov_b64 exec, s[54:55]
    ds_read_u16_d16_hi v243, v250 offset:128
    s_mov_b64 exec, -1
    ds_read_b64_tr_b16 v[76:77], v249 offset:512
    ds_read_b64_tr_b16 v[78:79], v249 offset:768
    ds_read_b64_tr_b16 v[84:85], v249 offset:1024
    ds_read_b64_tr_b16 v[86:87], v249 offset:1280
    ds_read_b64_tr_b16 v[92:93], v249 offset:1536
    ds_read_b64_tr_b16 v[94:95], v249 offset:1792
    s_waitcnt lgkmcnt(7)
    v_lshlrev_b32 v196, 16, v68
    v_and_b32 v197, 0xffff0000, v68
    v_lshlrev_b32 v198, 16, v69
    v_and_b32 v199, 0xffff0000, v69
    v_mul_f32_dpp v200, v242, v196 row_newbcast:0 row_mask:0xf bank_mask:0xf
    v_mul_f32_dpp v201, v242, v197 row_newbcast:1 row_mask:0xf bank_mask:0xf
    v_mul_f32_dpp v202, v242, v196 row_newbcast:8 row_mask:0xf bank_mask:0xf
    v_mul_f32_dpp v203, v242, v197 row_newbcast:9 row_mask:0xf bank_mask:0xf
    v_lshlrev_b32 v196, 16, v70
    v_and_b32 v197, 0xffff0000, v70
    v_cvt_pk_bf16_f32 v64, v200, v201
    v_cvt_pk_bf16_f32 v68, v202, v203
    v_mul_f32_dpp v200, v242, v198 row_newbcast:2 row_mask:0xf bank_mask:0xf
    v_mul_f32_dpp v201, v242, v199 row_newbcast:3 row_mask:0xf bank_mask:0xf
    v_mul_f32_dpp v202, v242, v198 row_newbcast:10 row_mask:0xf bank_mask:0xf
    v_mul_f32_dpp v203, v242, v199 row_newbcast:11 row_mask:0xf bank_mask:0xf
    v_lshlrev_b32 v198, 16, v71
    v_and_b32 v199, 0xffff0000, v71
    v_cvt_pk_bf16_f32 v65, v200, v201
    v_cvt_pk_bf16_f32 v69, v202, v203
    v_mul_f32_dpp v200, v242, v196 row_newbcast:4 row_mask:0xf bank_mask:0xf
    v_mul_f32_dpp v201, v242, v197 row_newbcast:5 row_mask:0xf bank_mask:0xf
    v_mul_f32_dpp v202, v242, v196 row_newbcast:12 row_mask:0xf bank_mask:0xf
    v_mul_f32_dpp v203, v242, v197 row_newbcast:13 row_mask:0xf bank_mask:0xf
    v_cvt_pk_bf16_f32 v66, v200, v201
    v_cvt_pk_bf16_f32 v70, v202, v203
    v_mul_f32_dpp v200, v242, v198 row_newbcast:6 row_mask:0xf bank_mask:0xf
    v_mul_f32_dpp v201, v242, v199 row_newbcast:7 row_mask:0xf bank_mask:0xf
    v_mul_f32_dpp v202, v242, v198 row_newbcast:14 row_mask:0xf bank_mask:0xf
    v_mul_f32_dpp v203, v242, v199 row_newbcast:15 row_mask:0xf bank_mask:0xf
    v_cvt_pk_bf16_f32 v67, v200, v201
    v_cvt_pk_bf16_f32 v71, v202, v203
    s_mov_b64 exec, s[54:55]
    ds_read_u16_d16_hi v242, v250 offset:256
    s_mov_b64 exec, -1
    s_waitcnt vmcnt(4) lgkmcnt(5)
    v_mfma_f32_32x32x16_bf16 v[0:15], v[64:67], v[176:179], 0
    v_lshlrev_b32 v196, 16, v76
    v_and_b32 v197, 0xffff0000, v76
    v_lshlrev_b32 v198, 16, v77
    v_and_b32 v199, 0xffff0000, v77
    v_mul_f32_dpp v200, v243, v196 row_newbcast:0 row_mask:0xf bank_mask:0xf
    v_mul_f32_dpp v201, v243, v197 row_newbcast:1 row_mask:0xf bank_mask:0xf
    v_mul_f32_dpp v202, v243, v196 row_newbcast:8 row_mask:0xf bank_mask:0xf
    v_mul_f32_dpp v203, v243, v197 row_newbcast:9 row_mask:0xf bank_mask:0xf
    v_lshlrev_b32 v196, 16, v78
    v_and_b32 v197, 0xffff0000, v78
    v_cvt_pk_bf16_f32 v72, v200, v201
    v_cvt_pk_bf16_f32 v76, v202, v203
    v_mul_f32_dpp v200, v243, v198 row_newbcast:2 row_mask:0xf bank_mask:0xf
    v_mul_f32_dpp v201, v243, v199 row_newbcast:3 row_mask:0xf bank_mask:0xf
    v_mul_f32_dpp v202, v243, v198 row_newbcast:10 row_mask:0xf bank_mask:0xf
    v_mul_f32_dpp v203, v243, v199 row_newbcast:11 row_mask:0xf bank_mask:0xf
    s_add_u32 m0, s21, 0
    v_mfma_f32_32x32x16_bf16 v[16:31], v[68:71], v[176:179], 0
    buffer_load_dwordx4 v234, s[4:7], s35 offen lds
    buffer_load_dwordx4 v235, s[8:11], s35 offen offset:1024 lds
    ds_read_b64_tr_b16 v[176:177], v244 offset:2048
    ds_read_b64_tr_b16 v[178:179], v244 offset:3072
    ds_read_b64_tr_b16 v[184:185], v245 offset:2048
    ds_read_b64_tr_b16 v[186:187], v245 offset:3072
    v_lshlrev_b32 v198, 16, v79
    v_and_b32 v199, 0xffff0000, v79
    v_cvt_pk_bf16_f32 v73, v200, v201
    v_cvt_pk_bf16_f32 v77, v202, v203
    v_mul_f32_dpp v200, v243, v196 row_newbcast:4 row_mask:0xf bank_mask:0xf
    v_mul_f32_dpp v201, v243, v197 row_newbcast:5 row_mask:0xf bank_mask:0xf
    v_mul_f32_dpp v202, v243, v196 row_newbcast:12 row_mask:0xf bank_mask:0xf
    v_mul_f32_dpp v203, v243, v197 row_newbcast:13 row_mask:0xf bank_mask:0xf
    v_cvt_pk_bf16_f32 v74, v200, v201
    v_cvt_pk_bf16_f32 v78, v202, v203
    v_mul_f32_dpp v200, v243, v198 row_newbcast:6 row_mask:0xf bank_mask:0xf
    v_mul_f32_dpp v201, v243, v199 row_newbcast:7 row_mask:0xf bank_mask:0xf
    v_mul_f32_dpp v202, v243, v198 row_newbcast:14 row_mask:0xf bank_mask:0xf
    v_mul_f32_dpp v203, v243, v199 row_newbcast:15 row_mask:0xf bank_mask:0xf
    v_cvt_pk_bf16_f32 v75, v200, v201
    v_cvt_pk_bf16_f32 v79, v202, v203
    s_mov_b64 exec, s[54:55]
    ds_read_u16_d16_hi v243, v250 offset:384
    s_mov_b64 exec, -1
    s_waitcnt vmcnt(4) lgkmcnt(1)
    v_mfma_f32_32x32x16_bf16 v[0:15], v[72:75], v[176:179], v[0:15]
    v_lshlrev_b32 v196, 16, v84
    v_and_b32 v197, 0xffff0000, v84
    v_lshlrev_b32 v198, 16, v85
    v_and_b32 v199, 0xffff0000, v85
    v_mul_f32_dpp v200, v242, v196 row_newbcast:0 row_mask:0xf bank_mask:0xf
    v_mul_f32_dpp v201, v242, v197 row_newbcast:1 row_mask:0xf bank_mask:0xf
    v_mul_f32_dpp v202, v242, v196 row_newbcast:8 row_mask:0xf bank_mask:0xf
    v_mul_f32_dpp v203, v242, v197 row_newbcast:9 row_mask:0xf bank_mask:0xf
    v_lshlrev_b32 v196, 16, v86
    v_and_b32 v197, 0xffff0000, v86
    v_cvt_pk_bf16_f32 v80, v200, v201
    v_cvt_pk_bf16_f32 v84, v202, v203
    v_mul_f32_dpp v200, v242, v198 row_newbcast:2 row_mask:0xf bank_mask:0xf
    v_mul_f32_dpp v201, v242, v199 row_newbcast:3 row_mask:0xf bank_mask:0xf
    v_mul_f32_dpp v202, v242, v198 row_newbcast:10 row_mask:0xf bank_mask:0xf
    v_mul_f32_dpp v203, v242, v199 row_newbcast:11 row_mask:0xf bank_mask:0xf
    s_add_u32 m0, s21, 2048
    v_mfma_f32_32x32x16_bf16 v[16:31], v[76:79], v[176:179], v[16:31]
    buffer_load_dwordx4 v236, s[4:7], s35 offen lds
    buffer_load_dwordx4 v237, s[8:11], s35 offen offset:1024 lds
    ds_read_b64_tr_b16 v[176:177], v244 offset:4096
    ds_read_b64_tr_b16 v[178:179], v244 offset:5120
    ds_read_b64_tr_b16 v[188:189], v245 offset:4096
    ds_read_b64_tr_b16 v[190:191], v245 offset:5120
    v_lshlrev_b32 v198, 16, v87
    v_and_b32 v199, 0xffff0000, v87
    v_cvt_pk_bf16_f32 v81, v200, v201
    v_cvt_pk_bf16_f32 v85, v202, v203
    v_mul_f32_dpp v200, v242, v196 row_newbcast:4 row_mask:0xf bank_mask:0xf
    v_mul_f32_dpp v201, v242, v197 row_newbcast:5 row_mask:0xf bank_mask:0xf
    v_mul_f32_dpp v202, v242, v196 row_newbcast:12 row_mask:0xf bank_mask:0xf
    v_mul_f32_dpp v203, v242, v197 row_newbcast:13 row_mask:0xf bank_mask:0xf
    v_cvt_pk_bf16_f32 v82, v200, v201
    v_cvt_pk_bf16_f32 v86, v202, v203
    v_mul_f32_dpp v200, v242, v198 row_newbcast:6 row_mask:0xf bank_mask:0xf
    v_mul_f32_dpp v201, v242, v199 row_newbcast:7 row_mask:0xf bank_mask:0xf
    v_mul_f32_dpp v202, v242, v198 row_newbcast:14 row_mask:0xf bank_mask:0xf
    v_mul_f32_dpp v203, v242, v199 row_newbcast:15 row_mask:0xf bank_mask:0xf
    v_cvt_pk_bf16_f32 v83, v200, v201
    v_cvt_pk_bf16_f32 v87, v202, v203
    s_nop 0
    s_waitcnt vmcnt(4) lgkmcnt(0)
    v_mfma_f32_32x32x16_bf16 v[0:15], v[80:83], v[176:179], v[0:15]
    v_lshlrev_b32 v196, 16, v92
    v_and_b32 v197, 0xffff0000, v92
    v_lshlrev_b32 v198, 16, v93
    v_and_b32 v199, 0xffff0000, v93
    v_mul_f32_dpp v200, v243, v196 row_newbcast:0 row_mask:0xf bank_mask:0xf
    v_mul_f32_dpp v201, v243, v197 row_newbcast:1 row_mask:0xf bank_mask:0xf
    v_mul_f32_dpp v202, v243, v196 row_newbcast:8 row_mask:0xf bank_mask:0xf
    v_mul_f32_dpp v203, v243, v197 row_newbcast:9 row_mask:0xf bank_mask:0xf
    v_lshlrev_b32 v196, 16, v94
    v_and_b32 v197, 0xffff0000, v94
    v_cvt_pk_bf16_f32 v88, v200, v201
    v_cvt_pk_bf16_f32 v92, v202, v203
    v_mul_f32_dpp v200, v243, v198 row_newbcast:2 row_mask:0xf bank_mask:0xf
    v_mul_f32_dpp v201, v243, v199 row_newbcast:3 row_mask:0xf bank_mask:0xf
    v_mul_f32_dpp v202, v243, v198 row_newbcast:10 row_mask:0xf bank_mask:0xf
    v_mul_f32_dpp v203, v243, v199 row_newbcast:11 row_mask:0xf bank_mask:0xf
    s_add_u32 m0, s21, 4096
    v_mfma_f32_32x32x16_bf16 v[16:31], v[84:87], v[176:179], v[16:31]
    buffer_load_dwordx4 v238, s[4:7], s35 offen lds
    buffer_load_dwordx4 v239, s[8:11], s35 offen offset:1024 lds
    ds_read_b64_tr_b16 v[176:177], v244 offset:6144
    ds_read_b64_tr_b16 v[178:179], v244 offset:7168
    ds_read_b64_tr_b16 v[192:193], v245 offset:6144
    ds_read_b64_tr_b16 v[194:195], v245 offset:7168
    v_lshlrev_b32 v198, 16, v95
    v_and_b32 v199, 0xffff0000, v95
    v_cvt_pk_bf16_f32 v89, v200, v201
    v_cvt_pk_bf16_f32 v93, v202, v203
    v_mul_f32_dpp v200, v243, v196 row_newbcast:4 row_mask:0xf bank_mask:0xf
    v_mul_f32_dpp v201, v243, v197 row_newbcast:5 row_mask:0xf bank_mask:0xf
    v_mul_f32_dpp v202, v243, v196 row_newbcast:12 row_mask:0xf bank_mask:0xf
    v_mul_f32_dpp v203, v243, v197 row_newbcast:13 row_mask:0xf bank_mask:0xf
    v_cvt_pk_bf16_f32 v90, v200, v201
    v_cvt_pk_bf16_f32 v94, v202, v203
    v_mul_f32_dpp v200, v243, v198 row_newbcast:6 row_mask:0xf bank_mask:0xf
    v_mul_f32_dpp v201, v243, v199 row_newbcast:7 row_mask:0xf bank_mask:0xf
    v_mul_f32_dpp v202, v243, v198 row_newbcast:14 row_mask:0xf bank_mask:0xf
    v_mul_f32_dpp v203, v243, v199 row_newbcast:15 row_mask:0xf bank_mask:0xf
    v_cvt_pk_bf16_f32 v91, v200, v201
    v_cvt_pk_bf16_f32 v95, v202, v203
    s_nop 0
    s_waitcnt lgkmcnt(0)
    v_mfma_f32_32x32x16_bf16 v[0:15], v[88:91], v[176:179], v[0:15]
    s_add_u32 m0, s21, 6144
    v_mfma_f32_32x32x16_bf16 v[16:31], v[92:95], v[176:179], v[16:31]
    buffer_load_dwordx4 v240, s[4:7], s35 offen lds
    buffer_load_dwordx4 v241, s[8:11], s35 offen offset:1024 lds
    s_mov_b32 m0, s50
    s_nop 0
    s_movrels_b32 s71, s23
    s_bfe_u32 s46, s71, 0x30012
    s_mov_b32 m0, s46
    s_and_b32 s66, s71, 0x3ffff
    s_movrels_b32 s68, s57
    s_movrels_b32 s69, s61
    s_sub_u32 s48, s66, s47
    s_mov_b32 s47, s66
    s_lshr_b32 s52, s71, 28
    s_lshl_b32 s67, s46, 9
    s_add_u32 s66, s66, s67
    s_sub_u32 s49, s66, s42
    s_mov_b32 s42, s66
    s_bfe_u32 s66, s68, 655360
    s_add_u32 s43, s42, s66
    s_bfe_u32 s39, s69, 655360
    s_bfe_u32 s66, s68, 655370
    s_add_u32 s44, s42, s66
    s_bfe_u32 s40, s69, 655370
    s_bfe_u32 s66, s68, 655380
    s_add_u32 s45, s42, s66
    s_bfe_u32 s41, s69, 655380
    s_and_b32 s66, s46, s33
    s_cselect_b32 s72, -1, 1
    s_cselect_b32 s76, s47, 163712
    s_cmp_ge_u32 s66, 2
    s_cselect_b32 s73, -1, 0
    s_add_u32 s77, s47, 1024
    s_cmp_ge_u32 s66, 4
    s_cselect_b32 s75, -1, 0
    s_cmp_ge_u32 s66, 3
    s_cselect_b32 s74, -1, 1
    s_cselect_b32 s77, s77, 163712
    v_mfma_f32_32x32x16_bf16 v[32:47], v[64:67], v[180:183], 0
    v_mul_f32 v196, v0, v96
    v_fmac_f32 v196, v1, v97
    v_fmac_f32 v196, v2, v98
    v_fmac_f32 v196, v3, v99
    v_fmac_f32 v196, v4, v100
    v_mfma_f32_32x32x16_bf16 v[48:63], v[68:71], v[180:183], 0
    v_lshl_add_u32 v253, v248, 2, s47
    ds_read_b32 v254, v253
    ds_read_b32 v255, v253 offset:1024
    v_fmac_f32 v196, v5, v101
    v_fmac_f32 v196, v6, v102
    v_fmac_f32 v196, v7, v103
    v_mul_f32 v198, v8, v128
    v_fmac_f32 v198, v9, v129
    v_mfma_f32_32x32x16_bf16 v[32:47], v[72:75], v[184:187], v[32:47]
    v_fmac_f32 v198, v10, v130
    v_fmac_f32 v198, v11, v131
    v_fmac_f32 v198, v12, v132
    v_fmac_f32 v198, v13, v133
    v_mfma_f32_32x32x16_bf16 v[48:63], v[76:79], v[184:187], v[48:63]
    v_fmac_f32 v198, v14, v134
    v_fmac_f32 v198, v15, v135
    v_mul_f32 v200, v16, v128
    v_fmac_f32 v200, v17, v129
    v_permlane32_swap_b32 v196, v198
    v_mfma_f32_32x32x16_bf16 v[32:47], v[80:83], v[188:191], v[32:47]
    v_fmac_f32 v200, v18, v130
    v_fmac_f32 v200, v19, v131
    v_fmac_f32 v200, v20, v132
    v_fmac_f32 v200, v21, v133
    v_fmac_f32 v200, v22, v134
    v_mfma_f32_32x32x16_bf16 v[48:63], v[84:87], v[188:191], v[48:63]
    s_waitcnt vmcnt(6)
    ds_read_b64_tr_b16 v[176:177], v244 offset:0
    ds_read_b64_tr_b16 v[178:179], v244 offset:1024
    ds_read_b64_tr_b16 v[180:181], v245 offset:0
    ds_read_b64_tr_b16 v[182:183], v245 offset:1024
    v_fmac_f32 v200, v23, v135
    v_add_f32 v198, v196, v198
    v_mul_f32_e64 v202, v24, -v128
    v_fma_f32 v202, v25, -v129, v202
    v_mfma_f32_32x32x16_bf16 v[32:47], v[88:91], v[192:195], v[32:47]
    v_fma_f32 v202, v26, -v130, v202
    v_fma_f32 v202, v27, -v131, v202
    v_fma_f32 v202, v28, -v132, v202
    v_fma_f32 v202, v29, -v133, v202
    v_fma_f32 v202, v30, -v134, v202
    v_mfma_f32_32x32x16_bf16 v[48:63], v[92:95], v[192:195], v[48:63]
    v_fma_f32 v202, v31, -v135, v202
    s_nop 1
    v_permlane32_swap_b32 v200, v202
    v_add_f32 v202, v200, v202
    s_waitcnt vmcnt(4) lgkmcnt(0)
    v_mfma_f32_32x32x16_bf16 v[0:15], v[64:67], v[176:179], 0
    v_mul_f32 v197, v32, v104
    v_fmac_f32 v197, v33, v105
    v_fmac_f32 v197, v34, v106
    v_fmac_f32 v197, v35, v107
    v_fmac_f32 v197, v36, v108
    v_fmac_f32 v197, v37, v109
    s_add_u32 m0, s21, 0
    v_mfma_f32_32x32x16_bf16 v[16:31], v[68:71], v[176:179], 0
    buffer_load_dwordx4 v234, s[4:7], s36 offen lds
    buffer_load_dwordx4 v235, s[8:11], s36 offen offset:1024 lds
    ds_read_b64_tr_b16 v[176:177], v244 offset:2048
    ds_read_b64_tr_b16 v[178:179], v244 offset:3072
    ds_read_b64_tr_b16 v[184:185], v245 offset:2048
    ds_read_b64_tr_b16 v[186:187], v245 offset:3072
    s_mov_b32 m0, s76
    s_mov_b64 exec, s[72:73]
    buffer_load_dwordx4 v254, s[12:15], 0 offen  lds
    s_mov_b32 m0, s77
    s_mov_b64 exec, s[74:75]
    buffer_load_dwordx4 v255, s[12:15], 0 offen  lds
    s_mov_b64 exec, -1
    v_fmac_f32 v197, v38, v110
    v_fmac_f32 v197, v39, v111
    v_mul_f32 v199, v40, v136
    v_fmac_f32 v199, v41, v137
    v_fmac_f32 v199, v42, v138
    s_waitcnt vmcnt(6) lgkmcnt(0)
    v_mfma_f32_32x32x16_bf16 v[0:15], v[72:75], v[176:179], v[0:15]
    v_fmac_f32 v199, v43, v139
    v_fmac_f32 v199, v44, v140
    v_fmac_f32 v199, v45, v141
    v_fmac_f32 v199, v46, v142
    v_fmac_f32 v199, v47, v143
    s_add_u32 m0, s21, 2048
    v_mfma_f32_32x32x16_bf16 v[16:31], v[76:79], v[176:179], v[16:31]
    buffer_load_dwordx4 v236, s[4:7], s36 offen lds
    buffer_load_dwordx4 v237, s[8:11], s36 offen offset:1024 lds
    ds_read_b64_tr_b16 v[176:177], v244 offset:4096
    ds_read_b64_tr_b16 v[178:179], v244 offset:5120
    ds_read_b64_tr_b16 v[188:189], v245 offset:4096
    ds_read_b64_tr_b16 v[190:191], v245 offset:5120
    v_mul_f32 v201, v48, v136
    v_fmac_f32 v201, v49, v137
    v_permlane32_swap_b32 v197, v199
    v_fmac_f32 v201, v50, v138
    v_fmac_f32 v201, v51, v139
    s_waitcnt vmcnt(6) lgkmcnt(0)
    v_mfma_f32_32x32x16_bf16 v[0:15], v[80:83], v[176:179], v[0:15]
    v_fmac_f32 v201, v52, v140
    v_fmac_f32 v201, v53, v141
    v_fmac_f32 v201, v54, v142
    v_fmac_f32 v201, v55, v143
    v_add_f32 v199, v197, v199
    v_mul_f32_e64 v203, v56, -v136
    s_add_u32 m0, s21, 4096
    v_mfma_f32_32x32x16_bf16 v[16:31], v[84:87], v[176:179], v[16:31]
    buffer_load_dwordx4 v238, s[4:7], s36 offen lds
    buffer_load_dwordx4 v239, s[8:11], s36 offen offset:1024 lds
    ds_read_b64_tr_b16 v[176:177], v244 offset:6144
    ds_read_b64_tr_b16 v[178:179], v244 offset:7168
    ds_read_b64_tr_b16 v[192:193], v245 offset:6144
    ds_read_b64_tr_b16 v[194:195], v245 offset:7168
    v_fma_f32 v203, v57, -v137, v203
    v_fma_f32 v203, v58, -v138, v203
    v_fma_f32 v203, v59, -v139, v203
    v_fma_f32 v203, v60, -v140, v203
    v_fma_f32 v203, v61, -v141, v203
    s_waitcnt lgkmcnt(0)
    v_mfma_f32_32x32x16_bf16 v[0:15], v[88:91], v[176:179], v[0:15]
    v_fma_f32 v203, v62, -v142, v203
    v_fma_f32 v203, v63, -v143, v203
    s_nop 1
    v_permlane32_swap_b32 v201, v203
    v_add_f32 v203, v201, v203
    s_add_u32 m0, s21, 6144
    v_mfma_f32_32x32x16_bf16 v[16:31], v[92:95], v[176:179], v[16:31]
    buffer_load_dwordx4 v240, s[4:7], s36 offen lds
    buffer_load_dwordx4 v241, s[8:11], s36 offen offset:1024 lds
    s_set_gpr_idx_on s51, gpr_idx(DST)
    s_nop 0
    v_cvt_pk_bf16_f32 v204, v198, v199
    v_cvt_pk_bf16_f32 v205, v202, v203
    s_set_gpr_idx_off
    v_mfma_f32_32x32x16_bf16 v[32:47], v[64:67], v[180:183], 0
    v_mul_f32 v196, v0, v144
    v_fmac_f32 v196, v1, v145
    v_fmac_f32 v196, v2, v146
    v_fmac_f32 v196, v3, v147
    v_mfma_f32_32x32x16_bf16 v[48:63], v[68:71], v[180:183], 0
    v_fmac_f32 v196, v4, v148
    v_fmac_f32 v196, v5, v149
    v_fmac_f32 v196, v6, v150
    v_fmac_f32 v196, v7, v151
    v_mfma_f32_32x32x16_bf16 v[32:47], v[72:75], v[184:187], v[32:47]
    v_mul_f32 v198, v8, v112
    v_fmac_f32 v198, v9, v113
    v_fmac_f32 v198, v10, v114
    v_fmac_f32 v198, v11, v115
    v_mfma_f32_32x32x16_bf16 v[48:63], v[76:79], v[184:187], v[48:63]
    v_fmac_f32 v198, v12, v116
    v_fmac_f32 v198, v13, v117
    v_fmac_f32 v198, v14, v118
    v_fmac_f32 v198, v15, v119
    v_mfma_f32_32x32x16_bf16 v[32:47], v[80:83], v[188:191], v[32:47]
    v_mul_f32_e64 v200, v16, -v160
    v_fma_f32 v200, v17, -v161, v200
    v_fma_f32 v200, v18, -v162, v200
    v_fma_f32 v200, v19, -v163, v200
    v_mfma_f32_32x32x16_bf16 v[48:63], v[84:87], v[188:191], v[48:63]
    s_waitcnt vmcnt(8)
    ds_read_b64_tr_b16 v[176:177], v244 offset:0
    ds_read_b64_tr_b16 v[178:179], v244 offset:1024
    ds_read_b64_tr_b16 v[180:181], v245 offset:0
    ds_read_b64_tr_b16 v[182:183], v245 offset:1024
    v_fma_f32 v200, v20, -v164, v200
    v_fma_f32 v200, v21, -v165, v200
    v_fma_f32 v200, v22, -v166, v200
    v_fma_f32 v200, v23, -v167, v200
    v_mfma_f32_32x32x16_bf16 v[32:47], v[88:91], v[192:195], v[32:47]
    v_mul_f32_e64 v202, v24, -v160
    v_fma_f32 v202, v25, -v161, v202
    v_fma_f32 v202, v26, -v162, v202
    v_fma_f32 v202, v27, -v163, v202
    v_mfma_f32_32x32x16_bf16 v[48:63], v[92:95], v[192:195], v[48:63]
    v_fma_f32 v202, v28, -v164, v202
    v_fma_f32 v202, v29, -v165, v202
    v_fma_f32 v202, v30, -v166, v202
    v_fma_f32 v202, v31, -v167, v202
    s_waitcnt vmcnt(4) lgkmcnt(0)
    v_mfma_f32_32x32x16_bf16 v[0:15], v[64:67], v[176:179], 0
    s_nop 0
    v_mul_f32 v197, v32, v152
    v_fmac_f32 v197, v33, v153
    v_fmac_f32 v197, v34, v154
    v_fmac_f32 v197, v35, v155
    s_add_u32 m0, s21, 0
    v_mfma_f32_32x32x16_bf16 v[16:31], v[68:71], v[176:179], 0
    buffer_load_dwordx4 v234, s[4:7], s37 offen lds
    buffer_load_dwordx4 v235, s[8:11], s37 offen offset:1024 lds
    ds_read_b64_tr_b16 v[176:177], v244 offset:2048
    ds_read_b64_tr_b16 v[178:179], v244 offset:3072
    ds_read_b64_tr_b16 v[184:185], v245 offset:2048
    ds_read_b64_tr_b16 v[186:187], v245 offset:3072
    v_add_u32 v252, s42, v247
    ds_read_u16 v234, v252
    ds_read_u16 v235, v252 offset:64
    v_fmac_f32 v197, v36, v156
    v_fmac_f32 v197, v37, v157
    v_fmac_f32 v197, v38, v158
    v_fmac_f32 v197, v39, v159
    s_waitcnt vmcnt(4) lgkmcnt(2)
    v_mfma_f32_32x32x16_bf16 v[0:15], v[72:75], v[176:179], v[0:15]
    v_mul_f32 v199, v40, v120
    v_fmac_f32 v199, v41, v121
    v_fmac_f32 v199, v42, v122
    v_fmac_f32 v199, v43, v123
    s_add_u32 m0, s21, 2048
    v_mfma_f32_32x32x16_bf16 v[16:31], v[76:79], v[176:179], v[16:31]
    buffer_load_dwordx4 v236, s[4:7], s37 offen lds
    buffer_load_dwordx4 v237, s[8:11], s37 offen offset:1024 lds
    ds_read_b64_tr_b16 v[176:177], v244 offset:4096
    ds_read_b64_tr_b16 v[178:179], v244 offset:5120
    ds_read_b64_tr_b16 v[188:189], v245 offset:4096
    ds_read_b64_tr_b16 v[190:191], v245 offset:5120
    v_add_u32 v252, s43, v247
    ds_read_u16 v236, v252
    ds_read_u16 v237, v252 offset:64
    v_fmac_f32 v199, v44, v124
    v_fmac_f32 v199, v45, v125
    v_fmac_f32 v199, v46, v126
    v_fmac_f32 v199, v47, v127
    s_waitcnt vmcnt(4) lgkmcnt(2)
    v_mfma_f32_32x32x16_bf16 v[0:15], v[80:83], v[176:179], v[0:15]
    v_mul_f32_e64 v201, v48, -v168
    v_fma_f32 v201, v49, -v169, v201
    v_fma_f32 v201, v50, -v170, v201
    v_fma_f32 v201, v51, -v171, v201
    s_add_u32 m0, s21, 4096
    v_mfma_f32_32x32x16_bf16 v[16:31], v[84:87], v[176:179], v[16:31]
    buffer_load_dwordx4 v238, s[4:7], s37 offen lds
    buffer_load_dwordx4 v239, s[8:11], s37 offen offset:1024 lds
    ds_read_b64_tr_b16 v[176:177], v244 offset:6144
    ds_read_b64_tr_b16 v[178:179], v244 offset:7168
    ds_read_b64_tr_b16 v[192:193], v245 offset:6144
    ds_read_b64_tr_b16 v[194:195], v245 offset:7168
    v_add_u32 v252, s44, v247
    ds_read_u16 v238, v252
    ds_read_u16 v239, v252 offset:64
    v_fma_f32 v201, v52, -v172, v201
    v_fma_f32 v201, v53, -v173, v201
    v_fma_f32 v201, v54, -v174, v201
    v_fma_f32 v201, v55, -v175, v201
    s_waitcnt lgkmcnt(2)
    v_mfma_f32_32x32x16_bf16 v[0:15], v[88:91], v[176:179], v[0:15]
    v_mul_f32_e64 v203, v56, -v168
    v_fma_f32 v203, v57, -v169, v203
    v_fma_f32 v203, v58, -v170, v203
    v_fma_f32 v203, v59, -v171, v203
    s_add_u32 m0, s21, 6144
    v_mfma_f32_32x32x16_bf16 v[16:31], v[92:95], v[176:179], v[16:31]
    buffer_load_dwordx4 v240, s[4:7], s37 offen lds
    buffer_load_dwordx4 v241, s[8:11], s37 offen offset:1024 lds
    v_add_u32 v252, s45, v247
    ds_read_u16 v240, v252
    ds_read_u16 v241, v252 offset:64
    v_fma_f32 v203, v60, -v172, v203
    v_fma_f32 v203, v61, -v173, v203
    v_fma_f32 v203, v62, -v174, v203
    v_fma_f32 v203, v63, -v175, v203
    v_mfma_f32_32x32x16_bf16 v[32:47], v[64:67], v[180:183], 0
    v_mul_f32 v254, v0, v144
    v_fmac_f32 v254, v1, v145
    v_fmac_f32 v254, v2, v146
    v_mfma_f32_32x32x16_bf16 v[48:63], v[68:71], v[180:183], 0
    ds_swizzle_b32 v68, v68 offset:0x401F
    ds_swizzle_b32 v69, v69 offset:0x401F
    ds_swizzle_b32 v70, v70 offset:0x401F
    ds_swizzle_b32 v71, v71 offset:0x401F
    v_fmac_f32 v254, v3, v147
    v_fmac_f32 v254, v4, v148
    v_mfma_f32_32x32x16_bf16 v[32:47], v[72:75], v[184:187], v[32:47]
    v_fmac_f32 v254, v5, v149
    v_fmac_f32 v254, v6, v150
    v_mfma_f32_32x32x16_bf16 v[48:63], v[76:79], v[184:187], v[48:63]
    ds_swizzle_b32 v76, v76 offset:0x401F
    ds_swizzle_b32 v77, v77 offset:0x401F
    ds_swizzle_b32 v78, v78 offset:0x401F
    ds_swizzle_b32 v79, v79 offset:0x401F
    v_fmac_f32 v254, v7, v151
    v_fmac_f32 v200, v8, v160
    v_mfma_f32_32x32x16_bf16 v[32:47], v[80:83], v[188:191], v[32:47]
    v_fmac_f32 v200, v9, v161
    v_permlane32_swap_b32 v196, v254
    v_fmac_f32 v200, v10, v162
    v_mfma_f32_32x32x16_bf16 v[48:63], v[84:87], v[188:191], v[48:63]
    ds_swizzle_b32 v84, v84 offset:0x401F
    ds_swizzle_b32 v85, v85 offset:0x401F
    ds_swizzle_b32 v86, v86 offset:0x401F
    ds_swizzle_b32 v87, v87 offset:0x401F
    s_waitcnt vmcnt(6)
    ds_read_b64_tr_b16 v[176:177], v244 offset:0
    ds_read_b64_tr_b16 v[178:179], v244 offset:1024
    ds_read_b64_tr_b16 v[180:181], v245 offset:0
    ds_read_b64_tr_b16 v[182:183], v245 offset:1024
    v_fmac_f32 v200, v11, v163
    v_fmac_f32 v200, v12, v164
    v_mfma_f32_32x32x16_bf16 v[32:47], v[88:91], v[192:195], v[32:47]
    v_fmac_f32 v200, v13, v165
    v_fmac_f32 v200, v14, v166
    v_mfma_f32_32x32x16_bf16 v[48:63], v[92:95], v[192:195], v[48:63]
    ds_swizzle_b32 v92, v92 offset:0x401F
    ds_swizzle_b32 v93, v93 offset:0x401F
    ds_swizzle_b32 v94, v94 offset:0x401F
    ds_swizzle_b32 v95, v95 offset:0x401F
    v_fmac_f32 v200, v15, v167
    v_add_f32 v254, v196, v254
    s_waitcnt lgkmcnt(8)
    s_mov_b64 exec, s[56:57]
    v_xor_b32 v68, 0x80008000, v68
    v_xor_b32 v69, 0x80008000, v69
    v_xor_b32 v70, 0x80008000, v70
    v_xor_b32 v71, 0x80008000, v71
    v_xor_b32 v76, 0x80008000, v76
    v_xor_b32 v77, 0x80008000, v77
    v_xor_b32 v78, 0x80008000, v78
    v_xor_b32 v79, 0x80008000, v79
    v_xor_b32 v84, 0x80008000, v84
    v_xor_b32 v85, 0x80008000, v85
    v_xor_b32 v86, 0x80008000, v86
    v_xor_b32 v87, 0x80008000, v87
    s_mov_b64 exec, -1
    s_waitcnt vmcnt(4) lgkmcnt(4)
    v_mfma_f32_32x32x16_bf16 v[0:15], v[64:67], v[176:179], 0
    v_mul_f32 v255, v32, v152
    v_fmac_f32 v255, v33, v153
    v_fmac_f32 v255, v34, v154
    s_add_u32 m0, s21, 0
    v_mfma_f32_32x32x16_bf16 v[16:31], v[68:71], v[176:179], v[16:31]
    v_lshl_add_u32 v234, v234, 10, v246
    v_lshl_add_u32 v235, v235, 10, v246
    buffer_load_dwordx4 v234, s[4:7], s38 offen lds
    buffer_load_dwordx4 v235, s[8:11], s38 offen offset:1024 lds
    ds_read_b64_tr_b16 v[176:177], v244 offset:2048
    ds_read_b64_tr_b16 v[178:179], v244 offset:3072
    ds_read_b64_tr_b16 v[184:185], v245 offset:2048
    ds_read_b64_tr_b16 v[186:187], v245 offset:3072
    v_fmac_f32 v255, v35, v155
    v_fmac_f32 v255, v36, v156
    v_fmac_f32 v255, v37, v157
    s_waitcnt vmcnt(4) lgkmcnt(0)
    v_mfma_f32_32x32x16_bf16 v[0:15], v[72:75], v[176:179], v[0:15]
    v_fmac_f32 v255, v38, v158
    v_fmac_f32 v255, v39, v159
    v_fmac_f32 v201, v40, v168
    s_add_u32 m0, s21, 2048
    v_mfma_f32_32x32x16_bf16 v[16:31], v[76:79], v[176:179], v[16:31]
    v_lshl_add_u32 v236, v236, 10, v246
    v_lshl_add_u32 v237, v237, 10, v246
    buffer_load_dwordx4 v236, s[4:7], s39 offen lds
    buffer_load_dwordx4 v237, s[8:11], s39 offen offset:1024 lds
    ds_read_b64_tr_b16 v[176:177], v244 offset:4096
    ds_read_b64_tr_b16 v[178:179], v244 offset:5120
    ds_read_b64_tr_b16 v[188:189], v245 offset:4096
    ds_read_b64_tr_b16 v[190:191], v245 offset:5120
    v_fmac_f32 v201, v41, v169
    v_permlane32_swap_b32 v197, v255
    s_waitcnt vmcnt(4) lgkmcnt(0)
    v_mfma_f32_32x32x16_bf16 v[0:15], v[80:83], v[176:179], v[0:15]
    v_fmac_f32 v201, v42, v170
    v_fmac_f32 v201, v43, v171
    v_fmac_f32 v201, v44, v172
    s_add_u32 m0, s21, 4096
    v_mfma_f32_32x32x16_bf16 v[16:31], v[84:87], v[176:179], v[16:31]
    v_lshl_add_u32 v238, v238, 10, v246
    v_lshl_add_u32 v239, v239, 10, v246
    buffer_load_dwordx4 v238, s[4:7], s40 offen lds
    buffer_load_dwordx4 v239, s[8:11], s40 offen offset:1024 lds
    ds_read_b64_tr_b16 v[176:177], v244 offset:6144
    ds_read_b64_tr_b16 v[178:179], v244 offset:7168
    ds_read_b64_tr_b16 v[192:193], v245 offset:6144
    ds_read_b64_tr_b16 v[194:195], v245 offset:7168
    v_fmac_f32 v201, v45, v173
    v_fmac_f32 v201, v46, v174
    v_fmac_f32 v201, v47, v175
    s_waitcnt lgkmcnt(0)
    s_mov_b64 exec, s[56:57]
    v_xor_b32 v92, 0x80008000, v92
    v_xor_b32 v93, 0x80008000, v93
    v_xor_b32 v94, 0x80008000, v94
    v_xor_b32 v95, 0x80008000, v95
    s_mov_b64 exec, -1
    v_mfma_f32_32x32x16_bf16 v[0:15], v[88:91], v[176:179], v[0:15]
    v_add_f32 v255, v197, v255
    s_set_gpr_idx_on s51, gpr_idx(DST)
    s_nop 0
    v_cvt_pk_bf16_f32 v206, v254, v255
    s_set_gpr_idx_off
    s_add_u32 m0, s21, 6144
    v_mfma_f32_32x32x16_bf16 v[16:31], v[92:95], v[176:179], v[16:31]
    v_lshl_add_u32 v240, v240, 10, v246
    v_lshl_add_u32 v241, v241, 10, v246
    buffer_load_dwordx4 v240, s[4:7], s41 offen lds
    buffer_load_dwordx4 v241, s[8:11], s41 offen offset:1024 lds
    v_mfma_f32_32x32x16_bf16 v[32:47], v[64:67], v[180:183], 0
    v_mul_f32 v254, v0, v144
    v_fmac_f32 v254, v1, v145
    v_fmac_f32 v254, v2, v146
    v_fmac_f32 v254, v3, v147
    v_fmac_f32 v254, v4, v148
    v_mfma_f32_32x32x16_bf16 v[48:63], v[68:71], v[180:183], v[48:63]
    v_fmac_f32 v254, v5, v149
    v_fmac_f32 v254, v6, v150
    v_fmac_f32 v254, v7, v151
    v_fma_f32 v202, v8, -v160, v202
    v_fma_f32 v202, v9, -v161, v202
    v_mfma_f32_32x32x16_bf16 v[32:47], v[72:75], v[184:187], v[32:47]
    v_permlane32_swap_b32 v254, v200
    v_fma_f32 v202, v10, -v162, v202
    v_fma_f32 v202, v11, -v163, v202
    v_fma_f32 v202, v12, -v164, v202
    v_fma_f32 v202, v13, -v165, v202
    v_mfma_f32_32x32x16_bf16 v[48:63], v[76:79], v[184:187], v[48:63]
    v_fma_f32 v202, v14, -v166, v202
    v_fma_f32 v202, v15, -v167, v202
    v_add_f32 v200, v254, v200
    v_fmac_f32 v198, v16, v112
    v_permlane32_swap_b32 v202, v254
    v_mfma_f32_32x32x16_bf16 v[32:47], v[80:83], v[188:191], v[32:47]
    v_fmac_f32 v198, v17, v113
    v_fmac_f32 v198, v18, v114
    v_fmac_f32 v198, v19, v115
    v_fmac_f32 v198, v20, v116
    v_fmac_f32 v198, v21, v117
    v_mfma_f32_32x32x16_bf16 v[48:63], v[84:87], v[188:191], v[48:63]
    s_waitcnt vmcnt(6)
    ds_read_b64_tr_b16 v[176:177], v244 offset:0
    ds_read_b64_tr_b16 v[178:179], v244 offset:1024
    ds_read_b64_tr_b16 v[180:181], v245 offset:0
    ds_read_b64_tr_b16 v[182:183], v245 offset:1024
    v_fmac_f32 v198, v22, v118
    v_fmac_f32 v198, v23, v119
    v_add_f32 v254, v202, v254
    v_mul_f32 v196, v24, v160
    v_fmac_f32 v196, v25, v161
    v_mfma_f32_32x32x16_bf16 v[32:47], v[88:91], v[192:195], v[32:47]
    v_fmac_f32 v196, v26, v162
    v_fmac_f32 v196, v27, v163
    v_fmac_f32 v196, v28, v164
    v_fmac_f32 v196, v29, v165
    v_fmac_f32 v196, v30, v166
    v_mfma_f32_32x32x16_bf16 v[48:63], v[92:95], v[192:195], v[48:63]
    v_add_u32 v249, s48, v249
    v_add_u32 v250, s49, v250
    ds_read_b32 v252, v251 offset:16
    ds_read_b64_tr_b16 v[68:69], v249 offset:0
    ds_read_b64_tr_b16 v[70:71], v249 offset:256
    s_mov_b64 exec, s[54:55]
    ds_read_u16_d16_hi v242, v250 offset:0
    s_mov_b64 exec, -1
    v_fmac_f32 v196, v31, v167
    s_nop 1
    v_permlane32_swap_b32 v198, v196
    v_add_f32 v196, v198, v196
    v_mul_f32 v255, v32, v152
    v_fmac_f32 v255, v33, v153
    v_fmac_f32 v255, v34, v154
    v_fmac_f32 v255, v35, v155
    v_fmac_f32 v255, v36, v156
    v_fmac_f32 v255, v37, v157
    v_fmac_f32 v255, v38, v158
    v_fmac_f32 v255, v39, v159
    v_fma_f32 v203, v40, -v168, v203
    v_fma_f32 v203, v41, -v169, v203
    v_permlane32_swap_b32 v255, v201
    v_fma_f32 v203, v42, -v170, v203
    v_fma_f32 v203, v43, -v171, v203
    v_fma_f32 v203, v44, -v172, v203
    v_fma_f32 v203, v45, -v173, v203
    v_fma_f32 v203, v46, -v174, v203
    v_fma_f32 v203, v47, -v175, v203
    v_add_f32 v201, v255, v201
    v_fmac_f32 v199, v48, v120
    v_permlane32_swap_b32 v203, v255
    v_fmac_f32 v199, v49, v121
    v_fmac_f32 v199, v50, v122
    v_fmac_f32 v199, v51, v123
    v_fmac_f32 v199, v52, v124
    v_fmac_f32 v199, v53, v125
    v_fmac_f32 v199, v54, v126
    v_fmac_f32 v199, v55, v127
    v_add_f32 v255, v203, v255
    v_mul_f32 v197, v56, v168
    v_fmac_f32 v197, v57, v169
    v_fmac_f32 v197, v58, v170
    v_fmac_f32 v197, v59, v171
    v_fmac_f32 v197, v60, v172
    v_fmac_f32 v197, v61, v173
    v_fmac_f32 v197, v62, v174
    v_fmac_f32 v197, v63, v175
    s_nop 1
    v_permlane32_swap_b32 v199, v197
    v_add_f32 v197, v199, v197
    s_set_gpr_idx_on s51, gpr_idx(DST)
    s_nop 0
    v_cvt_pk_bf16_f32 v207, v200, v201
    v_cvt_pk_bf16_f32 v209, v254, v255
    v_cvt_pk_bf16_f32 v208, v196, v197
    s_set_gpr_idx_off
    s_add_u32 s50, s50, 1
    s_add_u32 s51, s51, 6
    s_cmp_ge_u32 s50, 4
    s_cbranch_scc1 LAST0
    s_waitcnt lgkmcnt(3)
    v_readfirstlane_b32 s66, v252
    s_add_u32 s53, s53, 1
    v_mov_b32 v252, s53
    s_cmp_le_u32 s53, s66
    ds_write2_b32 v251, v252, v252 offset0:0 offset1:8
    s_setprio 1
    s_cbranch_scc1 PRIO_8
    s_setprio 0
PRIO_8:
    s_cmp_eq_u32 s52, 4
    s_cbranch_scc1 ITEM_0_4
    s_cmp_eq_u32 s52, 5
    s_cbranch_scc1 ITEM_0_5
    s_cmp_eq_u32 s52, 3
    s_cbranch_scc1 ITEM_0_3
    s_cmp_eq_u32 s52, 6
    s_cbranch_scc1 ITEM_0_6
    s_cmp_eq_u32 s52, 8
    s_cbranch_scc1 ITEM_0_8
    s_branch ITEM_0_2
.p2align 6
ITEM_0_2:
    s_mov_b32 m0, s50
    s_nop 0
    s_movrels_b32 s71, s23
    s_bfe_u32 s46, s71, 0x30012
    s_mov_b32 m0, s46
    s_and_b32 s66, s71, 0x3ffff
    s_movrels_b32 s68, s57
    s_movrels_b32 s69, s61
    s_sub_u32 s48, s66, s47
    s_mov_b32 s47, s66
    s_lshr_b32 s52, s71, 28
    s_lshl_b32 s67, s46, 9
    s_add_u32 s66, s66, s67
    s_sub_u32 s49, s66, s42
    s_mov_b32 s42, s66
    s_bfe_u32 s66, s68, 655360
    s_add_u32 s43, s42, s66
    s_bfe_u32 s39, s69, 655360
    s_bfe_u32 s66, s68, 655370
    s_add_u32 s44, s42, s66
    s_bfe_u32 s40, s69, 655370
    s_bfe_u32 s66, s68, 655380
    s_add_u32 s45, s42, s66
    s_bfe_u32 s41, s69, 655380
    s_and_b32 s66, s46, s33
    s_cselect_b32 s72, -1, 1
    s_cselect_b32 s76, s47, 163712
    s_cmp_ge_u32 s66, 2
    s_cselect_b32 s73, -1, 0
    s_add_u32 s77, s47, 1024
    s_cmp_ge_u32 s66, 4
    s_cselect_b32 s75, -1, 0
    s_cmp_ge_u32 s66, 3
    s_cselect_b32 s74, -1, 1
    s_cselect_b32 s77, s77, 163712
    v_add_u32 v252, s42, v247
    ds_read_u16 v234, v252
    ds_read_u16 v235, v252 offset:64
    v_add_u32 v252, s43, v247
    ds_read_u16 v236, v252
    ds_read_u16 v237, v252 offset:64
    v_add_u32 v252, s44, v247
    ds_read_u16 v238, v252
    ds_read_u16 v239, v252 offset:64
    v_add_u32 v252, s45, v247
    ds_read_u16 v240, v252
    ds_read_u16 v241, v252 offset:64
    s_waitcnt lgkmcnt(8)
    v_lshlrev_b32 v196, 16, v68
    v_and_b32 v197, 0xffff0000, v68
    v_lshlrev_b32 v198, 16, v69
    v_and_b32 v199, 0xffff0000, v69
    v_mul_f32_dpp v200, v242, v196 row_newbcast:0 row_mask:0xf bank_mask:0xf
    v_mul_f32_dpp v201, v242, v197 row_newbcast:1 row_mask:0xf bank_mask:0xf
    v_mul_f32_dpp v202, v242, v196 row_newbcast:8 row_mask:0xf bank_mask:0xf
    v_mul_f32_dpp v203, v242, v197 row_newbcast:9 row_mask:0xf bank_mask:0xf
    v_lshlrev_b32 v196, 16, v70
    v_and_b32 v197, 0xffff0000, v70
    v_cvt_pk_bf16_f32 v64, v200, v201
    v_cvt_pk_bf16_f32 v68, v202, v203
    v_mul_f32_dpp v200, v242, v198 row_newbcast:2 row_mask:0xf bank_mask:0xf
    v_mul_f32_dpp v201, v242, v199 row_newbcast:3 row_mask:0xf bank_mask:0xf
    v_mul_f32_dpp v202, v242, v198 row_newbcast:10 row_mask:0xf bank_mask:0xf
    v_mul_f32_dpp v203, v242, v199 row_newbcast:11 row_mask:0xf bank_mask:0xf
    v_lshlrev_b32 v198, 16, v71
    v_and_b32 v199, 0xffff0000, v71
    v_cvt_pk_bf16_f32 v65, v200, v201
    v_cvt_pk_bf16_f32 v69, v202, v203
    v_mul_f32_dpp v200, v242, v196 row_newbcast:4 row_mask:0xf bank_mask:0xf
    v_mul_f32_dpp v201, v242, v197 row_newbcast:5 row_mask:0xf bank_mask:0xf
    v_mul_f32_dpp v202, v242, v196 row_newbcast:12 row_mask:0xf bank_mask:0xf
    v_mul_f32_dpp v203, v242, v197 row_newbcast:13 row_mask:0xf bank_mask:0xf
    v_cvt_pk_bf16_f32 v66, v200, v201
    v_cvt_pk_bf16_f32 v70, v202, v203
    v_mul_f32_dpp v200, v242, v198 row_newbcast:6 row_mask:0xf bank_mask:0xf
    v_mul_f32_dpp v201, v242, v199 row_newbcast:7 row_mask:0xf bank_mask:0xf
    v_mul_f32_dpp v202, v242, v198 row_newbcast:14 row_mask:0xf bank_mask:0xf
    v_mul_f32_dpp v203, v242, v199 row_newbcast:15 row_mask:0xf bank_mask:0xf
    v_cvt_pk_bf16_f32 v67, v200, v201
    v_cvt_pk_bf16_f32 v71, v202, v203
    s_nop 0
    s_waitcnt lgkmcnt(6)
    v_mfma_f32_32x32x16_bf16 v[0:15], v[64:67], v[176:179], 0
    s_add_u32 m0, s21, 0
    v_mfma_f32_32x32x16_bf16 v[16:31], v[68:71], v[176:179], 0
    v_lshl_add_u32 v234, v234, 10, v246
    v_lshl_add_u32 v235, v235, 10, v246
    buffer_load_dwordx4 v234, s[4:7], s38 offen lds
    buffer_load_dwordx4 v235, s[8:11], s38 offen offset:1024 lds
    v_mfma_f32_32x32x16_bf16 v[32:47], v[64:67], v[180:183], 0
    s_nop 4
    v_mul_f32 v196, v0, v96
    v_fmac_f32 v196, v1, v97
    v_fmac_f32 v196, v2, v98
    v_fmac_f32 v196, v3, v99
    v_fmac_f32 v196, v4, v100
    v_fmac_f32 v196, v5, v101
    v_fmac_f32 v196, v6, v102
    v_fmac_f32 v196, v7, v103
    v_mul_f32 v198, v8, v128
    v_fmac_f32 v198, v9, v129
    v_fmac_f32 v198, v10, v130
    v_fmac_f32 v198, v11, v131
    v_fmac_f32 v198, v12, v132
    v_fmac_f32 v198, v13, v133
    v_fmac_f32 v198, v14, v134
    v_fmac_f32 v198, v15, v135
    v_mul_f32 v200, v16, v128
    v_fmac_f32 v200, v17, v129
    v_permlane32_swap_b32 v196, v198
    v_mfma_f32_32x32x16_bf16 v[48:63], v[68:71], v[180:183], 0
    v_lshl_add_u32 v253, v248, 2, s47
    ds_read_b32 v254, v253
    ds_read_b32 v255, v253 offset:1024
    s_waitcnt vmcnt(6)
    ds_read_b64_tr_b16 v[176:177], v244 offset:2048
    ds_read_b64_tr_b16 v[178:179], v244 offset:3072
    ds_read_b64_tr_b16 v[180:181], v245 offset:2048
    ds_read_b64_tr_b16 v[182:183], v245 offset:3072
    v_fmac_f32 v200, v18, v130
    v_fmac_f32 v200, v19, v131
    v_fmac_f32 v200, v20, v132
    v_fmac_f32 v200, v21, v133
    v_fmac_f32 v200, v22, v134
    v_fmac_f32 v200, v23, v135
    v_add_f32 v198, v196, v198
    v_mul_f32_e64 v202, v24, -v128
    v_fma_f32 v202, v25, -v129, v202
    v_fma_f32 v202, v26, -v130, v202
    v_fma_f32 v202, v27, -v131, v202
    v_fma_f32 v202, v28, -v132, v202
    v_fma_f32 v202, v29, -v133, v202
    v_fma_f32 v202, v30, -v134, v202
    v_fma_f32 v202, v31, -v135, v202
    s_nop 1
    v_permlane32_swap_b32 v200, v202
    v_add_f32 v202, v200, v202
    s_waitcnt lgkmcnt(0)
    v_mfma_f32_32x32x16_bf16 v[0:15], v[64:67], v[176:179], 0
    v_mul_f32 v197, v32, v104
    v_fmac_f32 v197, v33, v105
    v_fmac_f32 v197, v34, v106
    v_fmac_f32 v197, v35, v107
    v_fmac_f32 v197, v36, v108
    v_fmac_f32 v197, v37, v109
    v_fmac_f32 v197, v38, v110
    v_fmac_f32 v197, v39, v111
    v_mul_f32 v199, v40, v136
    v_fmac_f32 v199, v41, v137
    v_fmac_f32 v199, v42, v138
    v_fmac_f32 v199, v43, v139
    v_fmac_f32 v199, v44, v140
    v_fmac_f32 v199, v45, v141
    v_fmac_f32 v199, v46, v142
    v_fmac_f32 v199, v47, v143
    v_mul_f32 v201, v48, v136
    v_fmac_f32 v201, v49, v137
    v_permlane32_swap_b32 v197, v199
    v_fmac_f32 v201, v50, v138
    v_fmac_f32 v201, v51, v139
    s_add_u32 m0, s21, 2048
    v_mfma_f32_32x32x16_bf16 v[16:31], v[68:71], v[176:179], 0
    v_lshl_add_u32 v236, v236, 10, v246
    v_lshl_add_u32 v237, v237, 10, v246
    buffer_load_dwordx4 v236, s[4:7], s39 offen lds
    buffer_load_dwordx4 v237, s[8:11], s39 offen offset:1024 lds
    s_mov_b32 m0, s76
    s_mov_b64 exec, s[72:73]
    buffer_load_dwordx4 v254, s[12:15], 0 offen  lds
    s_mov_b32 m0, s77
    s_mov_b64 exec, s[74:75]
    buffer_load_dwordx4 v255, s[12:15], 0 offen  lds
    s_mov_b64 exec, -1
    v_fmac_f32 v201, v52, v140
    v_fmac_f32 v201, v53, v141
    v_fmac_f32 v201, v54, v142
    v_fmac_f32 v201, v55, v143
    v_add_f32 v199, v197, v199
    v_mul_f32_e64 v203, v56, -v136
    v_fma_f32 v203, v57, -v137, v203
    v_fma_f32 v203, v58, -v138, v203
    v_fma_f32 v203, v59, -v139, v203
    v_fma_f32 v203, v60, -v140, v203
    v_fma_f32 v203, v61, -v141, v203
    v_fma_f32 v203, v62, -v142, v203
    v_fma_f32 v203, v63, -v143, v203
    s_nop 1
    v_permlane32_swap_b32 v201, v203
    v_add_f32 v203, v201, v203
    s_set_gpr_idx_on s51, gpr_idx(DST)
    s_nop 0
    v_cvt_pk_bf16_f32 v204, v198, v199
    v_cvt_pk_bf16_f32 v205, v202, v203
    s_set_gpr_idx_off
    v_mfma_f32_32x32x16_bf16 v[32:47], v[64:67], v[180:183], 0
    v_mul_f32 v196, v0, v144
    v_fmac_f32 v196, v1, v145
    v_fmac_f32 v196, v2, v146
    v_fmac_f32 v196, v3, v147
    v_fmac_f32 v196, v4, v148
    v_fmac_f32 v196, v5, v149
    v_fmac_f32 v196, v6, v150
    v_fmac_f32 v196, v7, v151
    v_mul_f32 v198, v8, v112
    v_fmac_f32 v198, v9, v113
    v_fmac_f32 v198, v10, v114
    v_fmac_f32 v198, v11, v115
    v_fmac_f32 v198, v12, v116
    v_fmac_f32 v198, v13, v117
    v_fmac_f32 v198, v14, v118
    v_fmac_f32 v198, v15, v119
    v_mfma_f32_32x32x16_bf16 v[48:63], v[68:71], v[180:183], 0
    s_waitcnt vmcnt(8)
    ds_read_b64_tr_b16 v[176:177], v244 offset:4096
    ds_read_b64_tr_b16 v[178:179], v244 offset:5120
    ds_read_b64_tr_b16 v[180:181], v245 offset:4096
    ds_read_b64_tr_b16 v[182:183], v245 offset:5120
    v_mul_f32_e64 v200, v16, -v160
    v_fma_f32 v200, v17, -v161, v200
    v_fma_f32 v200, v18, -v162, v200
    v_fma_f32 v200, v19, -v163, v200
    v_fma_f32 v200, v20, -v164, v200
    v_fma_f32 v200, v21, -v165, v200
    v_fma_f32 v200, v22, -v166, v200
    v_fma_f32 v200, v23, -v167, v200
    v_mul_f32_e64 v202, v24, -v160
    v_fma_f32 v202, v25, -v161, v202
    v_fma_f32 v202, v26, -v162, v202
    v_fma_f32 v202, v27, -v163, v202
    v_fma_f32 v202, v28, -v164, v202
    v_fma_f32 v202, v29, -v165, v202
    v_fma_f32 v202, v30, -v166, v202
    v_fma_f32 v202, v31, -v167, v202
    s_waitcnt lgkmcnt(0)
    v_mfma_f32_32x32x16_bf16 v[0:15], v[64:67], v[176:179], 0
    v_mul_f32 v197, v32, v152
    v_fmac_f32 v197, v33, v153
    v_fmac_f32 v197, v34, v154
    v_fmac_f32 v197, v35, v155
    v_fmac_f32 v197, v36, v156
    v_fmac_f32 v197, v37, v157
    v_fmac_f32 v197, v38, v158
    v_fmac_f32 v197, v39, v159
    v_mul_f32 v199, v40, v120
    v_fmac_f32 v199, v41, v121
    v_fmac_f32 v199, v42, v122
    v_fmac_f32 v199, v43, v123
    v_fmac_f32 v199, v44, v124
    v_fmac_f32 v199, v45, v125
    v_fmac_f32 v199, v46, v126
    v_fmac_f32 v199, v47, v127
    s_add_u32 m0, s21, 4096
    v_mfma_f32_32x32x16_bf16 v[16:31], v[68:71], v[176:179], 0
    v_lshl_add_u32 v238, v238, 10, v246
    v_lshl_add_u32 v239, v239, 10, v246
    buffer_load_dwordx4 v238, s[4:7], s40 offen lds
    buffer_load_dwordx4 v239, s[8:11], s40 offen offset:1024 lds
    v_mul_f32_e64 v201, v48, -v168
    v_fma_f32 v201, v49, -v169, v201
    v_fma_f32 v201, v50, -v170, v201
    v_fma_f32 v201, v51, -v171, v201
    v_fma_f32 v201, v52, -v172, v201
    v_fma_f32 v201, v53, -v173, v201
    v_fma_f32 v201, v54, -v174, v201
    v_fma_f32 v201, v55, -v175, v201
    v_mul_f32_e64 v203, v56, -v168
    v_fma_f32 v203, v57, -v169, v203
    v_fma_f32 v203, v58, -v170, v203
    v_fma_f32 v203, v59, -v171, v203
    v_fma_f32 v203, v60, -v172, v203
    v_fma_f32 v203, v61, -v173, v203
    v_fma_f32 v203, v62, -v174, v203
    v_fma_f32 v203, v63, -v175, v203
    v_mfma_f32_32x32x16_bf16 v[32:47], v[64:67], v[180:183], 0
    v_mul_f32 v254, v0, v144
    v_fmac_f32 v254, v1, v145
    v_fmac_f32 v254, v2, v146
    v_fmac_f32 v254, v3, v147
    v_fmac_f32 v254, v4, v148
    v_fmac_f32 v254, v5, v149
    v_fmac_f32 v254, v6, v150
    v_fmac_f32 v254, v7, v151
    v_fmac_f32 v200, v8, v160
    v_mfma_f32_32x32x16_bf16 v[48:63], v[68:71], v[180:183], 0
    ds_swizzle_b32 v68, v68 offset:0x401F
    ds_swizzle_b32 v69, v69 offset:0x401F
    ds_swizzle_b32 v70, v70 offset:0x401F
    ds_swizzle_b32 v71, v71 offset:0x401F
    s_waitcnt vmcnt(8)
    ds_read_b64_tr_b16 v[176:177], v244 offset:6144
    ds_read_b64_tr_b16 v[178:179], v244 offset:7168
    ds_read_b64_tr_b16 v[180:181], v245 offset:6144
    ds_read_b64_tr_b16 v[182:183], v245 offset:7168
    v_fmac_f32 v200, v9, v161
    v_permlane32_swap_b32 v196, v254
    v_fmac_f32 v200, v10, v162
    v_fmac_f32 v200, v11, v163
    v_fmac_f32 v200, v12, v164
    v_fmac_f32 v200, v13, v165
    v_fmac_f32 v200, v14, v166
    v_fmac_f32 v200, v15, v167
    v_add_f32 v254, v196, v254
    s_waitcnt lgkmcnt(0)
    s_mov_b64 exec, s[56:57]
    v_xor_b32 v68, 0x80008000, v68
    v_xor_b32 v69, 0x80008000, v69
    v_xor_b32 v70, 0x80008000, v70
    v_xor_b32 v71, 0x80008000, v71
    s_mov_b64 exec, -1
    s_nop 0
    v_mfma_f32_32x32x16_bf16 v[0:15], v[64:67], v[176:179], 0
    v_mul_f32 v255, v32, v152
    v_fmac_f32 v255, v33, v153
    v_fmac_f32 v255, v34, v154
    v_fmac_f32 v255, v35, v155
    v_fmac_f32 v255, v36, v156
    v_fmac_f32 v255, v37, v157
    v_fmac_f32 v255, v38, v158
    v_fmac_f32 v255, v39, v159
    v_fmac_f32 v201, v40, v168
    v_fmac_f32 v201, v41, v169
    v_permlane32_swap_b32 v197, v255
    s_add_u32 m0, s21, 6144
    v_mfma_f32_32x32x16_bf16 v[16:31], v[68:71], v[176:179], v[16:31]
    v_lshl_add_u32 v240, v240, 10, v246
    v_lshl_add_u32 v241, v241, 10, v246
    buffer_load_dwordx4 v240, s[4:7], s41 offen lds
    buffer_load_dwordx4 v241, s[8:11], s41 offen offset:1024 lds
    v_fmac_f32 v201, v42, v170
    v_fmac_f32 v201, v43, v171
    v_fmac_f32 v201, v44, v172
    v_fmac_f32 v201, v45, v173
    v_fmac_f32 v201, v46, v174
    v_fmac_f32 v201, v47, v175
    v_add_f32 v255, v197, v255
    s_set_gpr_idx_on s51, gpr_idx(DST)
    s_nop 0
    v_cvt_pk_bf16_f32 v206, v254, v255
    s_set_gpr_idx_off
    v_mfma_f32_32x32x16_bf16 v[32:47], v[64:67], v[180:183], 0
    v_mul_f32 v254, v0, v144
    v_fmac_f32 v254, v1, v145
    v_fmac_f32 v254, v2, v146
    v_fmac_f32 v254, v3, v147
    v_fmac_f32 v254, v4, v148
    v_fmac_f32 v254, v5, v149
    v_fmac_f32 v254, v6, v150
    v_fmac_f32 v254, v7, v151
    v_fma_f32 v202, v8, -v160, v202
    v_fma_f32 v202, v9, -v161, v202
    v_permlane32_swap_b32 v254, v200
    v_fma_f32 v202, v10, -v162, v202
    v_fma_f32 v202, v11, -v163, v202
    v_fma_f32 v202, v12, -v164, v202
    v_fma_f32 v202, v13, -v165, v202
    v_fma_f32 v202, v14, -v166, v202
    v_fma_f32 v202, v15, -v167, v202
    v_add_f32 v200, v254, v200
    v_fmac_f32 v198, v16, v112
    v_permlane32_swap_b32 v202, v254
    v_mfma_f32_32x32x16_bf16 v[48:63], v[68:71], v[180:183], v[48:63]
    s_waitcnt vmcnt(4)
    ds_read_b64_tr_b16 v[176:177], v244 offset:0
    ds_read_b64_tr_b16 v[178:179], v244 offset:1024
    ds_read_b64_tr_b16 v[180:181], v245 offset:0
    ds_read_b64_tr_b16 v[182:183], v245 offset:1024
    v_add_u32 v249, s48, v249
    v_add_u32 v250, s49, v250
    ds_read_b32 v252, v251 offset:16
    ds_read_b64_tr_b16 v[68:69], v249 offset:0
    ds_read_b64_tr_b16 v[70:71], v249 offset:256
    s_mov_b64 exec, s[54:55]
    ds_read_u16_d16_hi v242, v250 offset:0
    s_mov_b64 exec, -1
    v_fmac_f32 v198, v17, v113
    v_fmac_f32 v198, v18, v114
    v_fmac_f32 v198, v19, v115
    v_fmac_f32 v198, v20, v116
    v_fmac_f32 v198, v21, v117
    v_fmac_f32 v198, v22, v118
    v_fmac_f32 v198, v23, v119
    v_add_f32 v254, v202, v254
    v_mul_f32 v196, v24, v160
    v_fmac_f32 v196, v25, v161
    v_fmac_f32 v196, v26, v162
    v_fmac_f32 v196, v27, v163
    v_fmac_f32 v196, v28, v164
    v_fmac_f32 v196, v29, v165
    v_fmac_f32 v196, v30, v166
    v_fmac_f32 v196, v31, v167
    s_nop 1
    v_permlane32_swap_b32 v198, v196
    v_add_f32 v196, v198, v196
    v_mul_f32 v255, v32, v152
    v_fmac_f32 v255, v33, v153
    v_fmac_f32 v255, v34, v154
    v_fmac_f32 v255, v35, v155
    v_fmac_f32 v255, v36, v156
    v_fmac_f32 v255, v37, v157
    v_fmac_f32 v255, v38, v158
    v_fmac_f32 v255, v39, v159
    v_fma_f32 v203, v40, -v168, v203
    v_fma_f32 v203, v41, -v169, v203
    v_permlane32_swap_b32 v255, v201
    v_fma_f32 v203, v42, -v170, v203
    v_fma_f32 v203, v43, -v171, v203
    v_fma_f32 v203, v44, -v172, v203
    v_fma_f32 v203, v45, -v173, v203
    v_fma_f32 v203, v46, -v174, v203
    v_fma_f32 v203, v47, -v175, v203
    v_add_f32 v201, v255, v201
    v_fmac_f32 v199, v48, v120
    v_permlane32_swap_b32 v203, v255
    v_fmac_f32 v199, v49, v121
    v_fmac_f32 v199, v50, v122
    v_fmac_f32 v199, v51, v123
    v_fmac_f32 v199, v52, v124
    v_fmac_f32 v199, v53, v125
    v_fmac_f32 v199, v54, v126
    v_fmac_f32 v199, v55, v127
    v_add_f32 v255, v203, v255
    v_mul_f32 v197, v56, v168
    v_fmac_f32 v197, v57, v169
    v_fmac_f32 v197, v58, v170
    v_fmac_f32 v197, v59, v171
    v_fmac_f32 v197, v60, v172
    v_fmac_f32 v197, v61, v173
    v_fmac_f32 v197, v62, v174
    v_fmac_f32 v197, v63, v175
    s_nop 1
    v_permlane32_swap_b32 v199, v197
    v_add_f32 v197, v199, v197
    s_set_gpr_idx_on s51, gpr_idx(DST)
    s_nop 0
    v_cvt_pk_bf16_f32 v207, v200, v201
    v_cvt_pk_bf16_f32 v209, v254, v255
    v_cvt_pk_bf16_f32 v208, v196, v197
    s_set_gpr_idx_off
    s_add_u32 s50, s50, 1
    s_add_u32 s51, s51, 6
    s_cmp_ge_u32 s50, 4
    s_cbranch_scc1 LAST0
    s_waitcnt lgkmcnt(3)
    v_readfirstlane_b32 s66, v252
    s_add_u32 s53, s53, 1
    v_mov_b32 v252, s53
    s_cmp_le_u32 s53, s66
    ds_write2_b32 v251, v252, v252 offset0:0 offset1:8
    s_setprio 1
    s_cbranch_scc1 PRIO_9
    s_setprio 0
PRIO_9:
    s_cmp_eq_u32 s52, 4
    s_cbranch_scc1 ITEM_0_4
    s_cmp_eq_u32 s52, 5
    s_cbranch_scc1 ITEM_0_5
    s_cmp_eq_u32 s52, 3
    s_cbranch_scc1 ITEM_0_3
    s_cmp_eq_u32 s52, 6
    s_cbranch_scc1 ITEM_0_6
    s_cmp_eq_u32 s52, 8
    s_cbranch_scc1 ITEM_0_8
    s_branch ITEM_0_2
.p2align 6
ITEM_1_4:
    s_mov_b64 exec, s[54:55]
    ds_read_u16_d16_hi v243, v250 offset:128
    s_mov_b64 exec, -1
    ds_read_b64_tr_b16 v[76:77], v249 offset:512
    ds_read_b64_tr_b16 v[78:79], v249 offset:768
    s_waitcnt lgkmcnt(3)
    v_lshlrev_b32 v196, 16, v68
    v_and_b32 v197, 0xffff0000, v68
    v_lshlrev_b32 v198, 16, v69
    v_and_b32 v199, 0xffff0000, v69
    v_mul_f32_dpp v200, v242, v196 row_newbcast:0 row_mask:0xf bank_mask:0xf
    v_mul_f32_dpp v201, v242, v197 row_newbcast:1 row_mask:0xf bank_mask:0xf
    v_mul_f32_dpp v202, v242, v196 row_newbcast:8 row_mask:0xf bank_mask:0xf
    v_mul_f32_dpp v203, v242, v197 row_newbcast:9 row_mask:0xf bank_mask:0xf
    v_lshlrev_b32 v196, 16, v70
    v_and_b32 v197, 0xffff0000, v70
    v_cvt_pk_bf16_f32 v64, v200, v201
    v_cvt_pk_bf16_f32 v68, v202, v203
    v_mul_f32_dpp v200, v242, v198 row_newbcast:2 row_mask:0xf bank_mask:0xf
    v_mul_f32_dpp v201, v242, v199 row_newbcast:3 row_mask:0xf bank_mask:0xf
    v_mul_f32_dpp v202, v242, v198 row_newbcast:10 row_mask:0xf bank_mask:0xf
    v_mul_f32_dpp v203, v242, v199 row_newbcast:11 row_mask:0xf bank_mask:0xf
    v_lshlrev_b32 v198, 16, v71
    v_and_b32 v199, 0xffff0000, v71
    v_cvt_pk_bf16_f32 v65, v200, v201
    v_cvt_pk_bf16_f32 v69, v202, v203
    v_mul_f32_dpp v200, v242, v196 row_newbcast:4 row_mask:0xf bank_mask:0xf
    v_mul_f32_dpp v201, v242, v197 row_newbcast:5 row_mask:0xf bank_mask:0xf
    v_mul_f32_dpp v202, v242, v196 row_newbcast:12 row_mask:0xf bank_mask:0xf
    v_mul_f32_dpp v203, v242, v197 row_newbcast:13 row_mask:0xf bank_mask:0xf
    v_cvt_pk_bf16_f32 v66, v200, v201
    v_cvt_pk_bf16_f32 v70, v202, v203
    v_mul_f32_dpp v200, v242, v198 row_newbcast:6 row_mask:0xf bank_mask:0xf
    v_mul_f32_dpp v201, v242, v199 row_newbcast:7 row_mask:0xf bank_mask:0xf
    v_mul_f32_dpp v202, v242, v198 row_newbcast:14 row_mask:0xf bank_mask:0xf
    v_mul_f32_dpp v203, v242, v199 row_newbcast:15 row_mask:0xf bank_mask:0xf
    v_cvt_pk_bf16_f32 v67, v200, v201
    v_cvt_pk_bf16_f32 v71, v202, v203
    s_nop 0
    s_waitcnt vmcnt(4) lgkmcnt(0)
    v_mfma_f32_32x32x16_bf16 v[0:15], v[64:67], v[176:179], 0
    v_lshlrev_b32 v196, 16, v76
    v_and_b32 v197, 0xffff0000, v76
    v_lshlrev_b32 v198, 16, v77
    v_and_b32 v199, 0xffff0000, v77
    v_mul_f32_dpp v200, v243, v196 row_newbcast:0 row_mask:0xf bank_mask:0xf
    v_mul_f32_dpp v201, v243, v197 row_newbcast:1 row_mask:0xf bank_mask:0xf
    v_mul_f32_dpp v202, v243, v196 row_newbcast:8 row_mask:0xf bank_mask:0xf
    v_mul_f32_dpp v203, v243, v197 row_newbcast:9 row_mask:0xf bank_mask:0xf
    v_lshlrev_b32 v196, 16, v78
    v_and_b32 v197, 0xffff0000, v78
    v_cvt_pk_bf16_f32 v72, v200, v201
    v_cvt_pk_bf16_f32 v76, v202, v203
    v_mul_f32_dpp v200, v243, v198 row_newbcast:2 row_mask:0xf bank_mask:0xf
    v_mul_f32_dpp v201, v243, v199 row_newbcast:3 row_mask:0xf bank_mask:0xf
    v_mul_f32_dpp v202, v243, v198 row_newbcast:10 row_mask:0xf bank_mask:0xf
    v_mul_f32_dpp v203, v243, v199 row_newbcast:11 row_mask:0xf bank_mask:0xf
    s_add_u32 m0, s21, 0
    v_mfma_f32_32x32x16_bf16 v[16:31], v[68:71], v[176:179], 0
    buffer_load_dwordx4 v234, s[4:7], s36 offen lds
    buffer_load_dwordx4 v235, s[8:11], s36 offen offset:1024 lds
    ds_read_b64_tr_b16 v[176:177], v244 offset:2048
    ds_read_b64_tr_b16 v[178:179], v244 offset:3072
    ds_read_b64_tr_b16 v[184:185], v245 offset:2048
    ds_read_b64_tr_b16 v[186:187], v245 offset:3072
    v_lshlrev_b32 v198, 16, v79
    v_and_b32 v199, 0xffff0000, v79
    v_cvt_pk_bf16_f32 v73, v200, v201
    v_cvt_pk_bf16_f32 v77, v202, v203
    v_mul_f32_dpp v200, v243, v196 row_newbcast:4 row_mask:0xf bank_mask:0xf
    v_mul_f32_dpp v201, v243, v197 row_newbcast:5 row_mask:0xf bank_mask:0xf
    v_mul_f32_dpp v202, v243, v196 row_newbcast:12 row_mask:0xf bank_mask:0xf
    v_mul_f32_dpp v203, v243, v197 row_newbcast:13 row_mask:0xf bank_mask:0xf
    v_cvt_pk_bf16_f32 v74, v200, v201
    v_cvt_pk_bf16_f32 v78, v202, v203
    v_mul_f32_dpp v200, v243, v198 row_newbcast:6 row_mask:0xf bank_mask:0xf
    v_mul_f32_dpp v201, v243, v199 row_newbcast:7 row_mask:0xf bank_mask:0xf
    v_mul_f32_dpp v202, v243, v198 row_newbcast:14 row_mask:0xf bank_mask:0xf
    v_mul_f32_dpp v203, v243, v199 row_newbcast:15 row_mask:0xf bank_mask:0xf
    v_cvt_pk_bf16_f32 v75, v200, v201
    v_cvt_pk_bf16_f32 v79, v202, v203
    s_nop 0
    s_waitcnt lgkmcnt(0)
    v_mfma_f32_32x32x16_bf16 v[0:15], v[72:75], v[176:179], v[0:15]
    s_add_u32 m0, s21, 2048
    v_mfma_f32_32x32x16_bf16 v[16:31], v[76:79], v[176:179], v[16:31]
    buffer_load_dwordx4 v236, s[4:7], s36 offen lds
    buffer_load_dwordx4 v237, s[8:11], s36 offen offset:1024 lds
    s_mov_b32 m0, s50
    s_nop 0
    s_movrels_b32 s71, s23
    s_movrels_b32 s33, s28
    s_and_b32 s70, s33, 0x70
    s_andn2_b32 s33, s33, 0x70
    v_xor_b32 v253, s70, v248
    v_add_u32 v253, s33, v253
    s_bfe_u32 s46, s71, 0x30012
    s_mov_b32 m0, s46
    s_and_b32 s66, s71, 0x3ffff
    s_movrels_b32 s68, s57
    s_movrels_b32 s69, s61
    s_sub_u32 s48, s66, s47
    s_mov_b32 s47, s66
    s_lshr_b32 s52, s71, 28
    s_lshl_b32 s67, s46, 9
    s_add_u32 s66, s66, s67
    s_sub_u32 s49, s66, s42
    s_mov_b32 s42, s66
    s_bfe_u32 s66, s68, 655360
    s_add_u32 s43, s42, s66
    s_bfe_u32 s39, s69, 655360
    s_bfe_u32 s66, s68, 655370
    s_add_u32 s44, s42, s66
    s_bfe_u32 s40, s69, 655370
    s_bfe_u32 s66, s68, 655380
    s_add_u32 s45, s42, s66
    s_bfe_u32 s41, s69, 655380
    v_add_u32 v252, s44, v247
    ds_read_u16 v238, v252
    ds_read_u16 v239, v252 offset:64
    v_add_u32 v252, s45, v247
    ds_read_u16 v240, v252
    ds_read_u16 v241, v252 offset:64
    v_mfma_f32_32x32x16_bf16 v[32:47], v[64:67], v[180:183], 0
    v_mul_f32 v196, v0, v96
    v_fmac_f32 v196, v1, v97
    v_fmac_f32 v196, v2, v98
    v_fmac_f32 v196, v3, v99
    v_fmac_f32 v196, v4, v100
    v_fmac_f32 v196, v5, v101
    v_fmac_f32 v196, v6, v102
    v_fmac_f32 v196, v7, v103
    v_mul_f32 v198, v8, v128
    v_fmac_f32 v198, v9, v129
    v_mfma_f32_32x32x16_bf16 v[48:63], v[68:71], v[180:183], 0
    s_waitcnt vmcnt(6)
    ds_read_b64_tr_b16 v[176:177], v244 offset:4096
    ds_read_b64_tr_b16 v[178:179], v244 offset:5120
    ds_read_b64_tr_b16 v[180:181], v245 offset:4096
    ds_read_b64_tr_b16 v[182:183], v245 offset:5120
    v_fmac_f32 v198, v10, v130
    v_fmac_f32 v198, v11, v131
    v_fmac_f32 v198, v12, v132
    v_fmac_f32 v198, v13, v133
    v_fmac_f32 v198, v14, v134
    v_fmac_f32 v198, v15, v135
    v_mul_f32 v200, v16, v128
    v_fmac_f32 v200, v17, v129
    v_permlane32_swap_b32 v196, v198
    v_mfma_f32_32x32x16_bf16 v[32:47], v[72:75], v[184:187], v[32:47]
    v_fmac_f32 v200, v18, v130
    v_fmac_f32 v200, v19, v131
    v_fmac_f32 v200, v20, v132
    v_fmac_f32 v200, v21, v133
    v_fmac_f32 v200, v22, v134
    v_fmac_f32 v200, v23, v135
    v_add_f32 v198, v196, v198
    v_mul_f32_e64 v202, v24, -v128
    v_fma_f32 v202, v25, -v129, v202
    v_mfma_f32_32x32x16_bf16 v[48:63], v[76:79], v[184:187], v[48:63]
    v_fma_f32 v202, v26, -v130, v202
    v_fma_f32 v202, v27, -v131, v202
    v_fma_f32 v202, v28, -v132, v202
    v_fma_f32 v202, v29, -v133, v202
    v_fma_f32 v202, v30, -v134, v202
    v_fma_f32 v202, v31, -v135, v202
    s_nop 1
    v_permlane32_swap_b32 v200, v202
    v_add_f32 v202, v200, v202
    s_waitcnt vmcnt(4) lgkmcnt(0)
    v_mfma_f32_32x32x16_bf16 v[0:15], v[64:67], v[176:179], 0
    v_mul_f32 v197, v32, v104
    v_fmac_f32 v197, v33, v105
    v_fmac_f32 v197, v34, v106
    v_fmac_f32 v197, v35, v107
    v_fmac_f32 v197, v36, v108
    v_fmac_f32 v197, v37, v109
    v_fmac_f32 v197, v38, v110
    v_fmac_f32 v197, v39, v111
    v_mul_f32 v199, v40, v136
    v_fmac_f32 v199, v41, v137
    v_fmac_f32 v199, v42, v138
    s_add_u32 m0, s21, 4096
    v_mfma_f32_32x32x16_bf16 v[16:31], v[68:71], v[176:179], 0
    buffer_load_dwordx4 v234, s[4:7], s37 offen lds
    buffer_load_dwordx4 v235, s[8:11], s37 offen offset:1024 lds
    ds_read_b64_tr_b16 v[176:177], v244 offset:6144
    ds_read_b64_tr_b16 v[178:179], v244 offset:7168
    ds_read_b64_tr_b16 v[184:185], v245 offset:6144
    ds_read_b64_tr_b16 v[186:187], v245 offset:7168
    v_add_u32 v252, s42, v247
    ds_read_u16 v234, v252
    ds_read_u16 v235, v252 offset:64
    v_fmac_f32 v199, v43, v139
    v_fmac_f32 v199, v44, v140
    v_fmac_f32 v199, v45, v141
    v_fmac_f32 v199, v46, v142
    v_fmac_f32 v199, v47, v143
    v_mul_f32 v201, v48, v136
    v_fmac_f32 v201, v49, v137
    v_permlane32_swap_b32 v197, v199
    v_fmac_f32 v201, v50, v138
    v_fmac_f32 v201, v51, v139
    s_waitcnt lgkmcnt(2)
    v_mfma_f32_32x32x16_bf16 v[0:15], v[72:75], v[176:179], v[0:15]
    v_fmac_f32 v201, v52, v140
    v_fmac_f32 v201, v53, v141
    v_fmac_f32 v201, v54, v142
    v_fmac_f32 v201, v55, v143
    v_add_f32 v199, v197, v199
    v_mul_f32_e64 v203, v56, -v136
    v_fma_f32 v203, v57, -v137, v203
    v_fma_f32 v203, v58, -v138, v203
    v_fma_f32 v203, v59, -v139, v203
    v_fma_f32 v203, v60, -v140, v203
    s_add_u32 m0, s21, 6144
    v_mfma_f32_32x32x16_bf16 v[16:31], v[76:79], v[176:179], v[16:31]
    buffer_load_dwordx4 v236, s[4:7], s37 offen lds
    buffer_load_dwordx4 v237, s[8:11], s37 offen offset:1024 lds
    v_add_u32 v252, s43, v247
    ds_read_u16 v236, v252
    ds_read_u16 v237, v252 offset:64
    v_fma_f32 v203, v61, -v141, v203
    v_fma_f32 v203, v62, -v142, v203
    v_fma_f32 v203, v63, -v143, v203
    s_nop 1
    v_permlane32_swap_b32 v201, v203
    v_add_f32 v203, v201, v203
    v_cvt_pk_bf16_f32 v198, v198, v199
    v_cvt_pk_bf16_f32 v202, v202, v203
    ds_write_b32 v253, v198 offset:0
    ds_write_b32 v253, v202 offset:256
    v_mfma_f32_32x32x16_bf16 v[32:47], v[64:67], v[180:183], 0
    v_mul_f32 v196, v0, v144
    v_fmac_f32 v196, v1, v145
    v_fmac_f32 v196, v2, v146
    v_fmac_f32 v196, v3, v147
    v_fmac_f32 v196, v4, v148
    v_fmac_f32 v196, v5, v149
    v_fmac_f32 v196, v6, v150
    v_fmac_f32 v196, v7, v151
    v_mfma_f32_32x32x16_bf16 v[48:63], v[68:71], v[180:183], 0
    s_waitcnt vmcnt(6)
    ds_read_b64_tr_b16 v[176:177], v244 offset:0
    ds_read_b64_tr_b16 v[178:179], v244 offset:1024
    ds_read_b64_tr_b16 v[180:181], v245 offset:0
    ds_read_b64_tr_b16 v[182:183], v245 offset:1024
    v_mul_f32 v198, v8, v112
    v_fmac_f32 v198, v9, v113
    v_fmac_f32 v198, v10, v114
    v_fmac_f32 v198, v11, v115
    v_fmac_f32 v198, v12, v116
    v_fmac_f32 v198, v13, v117
    v_fmac_f32 v198, v14, v118
    v_fmac_f32 v198, v15, v119
    v_mfma_f32_32x32x16_bf16 v[32:47], v[72:75], v[184:187], v[32:47]
    v_mul_f32_e64 v200, v16, -v160
    v_fma_f32 v200, v17, -v161, v200
    v_fma_f32 v200, v18, -v162, v200
    v_fma_f32 v200, v19, -v163, v200
    v_fma_f32 v200, v20, -v164, v200
    v_fma_f32 v200, v21, -v165, v200
    v_fma_f32 v200, v22, -v166, v200
    v_fma_f32 v200, v23, -v167, v200
    v_mfma_f32_32x32x16_bf16 v[48:63], v[76:79], v[184:187], v[48:63]
    v_mul_f32_e64 v202, v24, -v160
    v_fma_f32 v202, v25, -v161, v202
    v_fma_f32 v202, v26, -v162, v202
    v_fma_f32 v202, v27, -v163, v202
    v_fma_f32 v202, v28, -v164, v202
    v_fma_f32 v202, v29, -v165, v202
    v_fma_f32 v202, v30, -v166, v202
    v_fma_f32 v202, v31, -v167, v202
    s_waitcnt vmcnt(4) lgkmcnt(0)
    v_mfma_f32_32x32x16_bf16 v[0:15], v[64:67], v[176:179], 0
    v_mul_f32 v197, v32, v152
    v_fmac_f32 v197, v33, v153
    v_fmac_f32 v197, v34, v154
    v_fmac_f32 v197, v35, v155
    v_fmac_f32 v197, v36, v156
    v_fmac_f32 v197, v37, v157
    v_fmac_f32 v197, v38, v158
    v_fmac_f32 v197, v39, v159
    s_add_u32 m0, s21, 0
    v_mfma_f32_32x32x16_bf16 v[16:31], v[68:71], v[176:179], 0
    v_lshl_add_u32 v234, v234, 10, v246
    v_lshl_add_u32 v235, v235, 10, v246
    buffer_load_dwordx4 v234, s[4:7], s38 offen lds
    buffer_load_dwordx4 v235, s[8:11], s38 offen offset:1024 lds
    ds_read_b64_tr_b16 v[176:177], v244 offset:2048
    ds_read_b64_tr_b16 v[178:179], v244 offset:3072
    ds_read_b64_tr_b16 v[184:185], v245 offset:2048
    ds_read_b64_tr_b16 v[186:187], v245 offset:3072
    v_mul_f32 v199, v40, v120
    v_fmac_f32 v199, v41, v121
    v_fmac_f32 v199, v42, v122
    v_fmac_f32 v199, v43, v123
    v_fmac_f32 v199, v44, v124
    v_fmac_f32 v199, v45, v125
    v_fmac_f32 v199, v46, v126
    v_fmac_f32 v199, v47, v127
    s_waitcnt lgkmcnt(0)
    v_mfma_f32_32x32x16_bf16 v[0:15], v[72:75], v[176:179], v[0:15]
    v_mul_f32_e64 v201, v48, -v168
    v_fma_f32 v201, v49, -v169, v201
    v_fma_f32 v201, v50, -v170, v201
    v_fma_f32 v201, v51, -v171, v201
    v_fma_f32 v201, v52, -v172, v201
    v_fma_f32 v201, v53, -v173, v201
    v_fma_f32 v201, v54, -v174, v201
    v_fma_f32 v201, v55, -v175, v201
    s_add_u32 m0, s21, 2048
    v_mfma_f32_32x32x16_bf16 v[16:31], v[76:79], v[176:179], v[16:31]
    v_lshl_add_u32 v236, v236, 10, v246
    v_lshl_add_u32 v237, v237, 10, v246
    buffer_load_dwordx4 v236, s[4:7], s39 offen lds
    buffer_load_dwordx4 v237, s[8:11], s39 offen offset:1024 lds
    v_mul_f32_e64 v203, v56, -v168
    v_fma_f32 v203, v57, -v169, v203
    v_fma_f32 v203, v58, -v170, v203
    v_fma_f32 v203, v59, -v171, v203
    v_fma_f32 v203, v60, -v172, v203
    v_fma_f32 v203, v61, -v173, v203
    v_fma_f32 v203, v62, -v174, v203
    v_fma_f32 v203, v63, -v175, v203
    v_mfma_f32_32x32x16_bf16 v[32:47], v[64:67], v[180:183], 0
    v_mul_f32 v254, v0, v144
    v_fmac_f32 v254, v1, v145
    v_fmac_f32 v254, v2, v146
    v_fmac_f32 v254, v3, v147
    v_fmac_f32 v254, v4, v148
    v_mfma_f32_32x32x16_bf16 v[48:63], v[68:71], v[180:183], 0
    ds_swizzle_b32 v68, v68 offset:0x401F
    ds_swizzle_b32 v69, v69 offset:0x401F
    ds_swizzle_b32 v70, v70 offset:0x401F
    ds_swizzle_b32 v71, v71 offset:0x401F
    s_waitcnt vmcnt(6)
    ds_read_b64_tr_b16 v[176:177], v244 offset:4096
    ds_read_b64_tr_b16 v[178:179], v244 offset:5120
    ds_read_b64_tr_b16 v[180:181], v245 offset:4096
    ds_read_b64_tr_b16 v[182:183], v245 offset:5120
    v_fmac_f32 v254, v5, v149
    v_fmac_f32 v254, v6, v150
    v_fmac_f32 v254, v7, v151
    v_fmac_f32 v200, v8, v160
    v_mfma_f32_32x32x16_bf16 v[32:47], v[72:75], v[184:187], v[32:47]
    v_fmac_f32 v200, v9, v161
    v_permlane32_swap_b32 v196, v254
    v_fmac_f32 v200, v10, v162
    v_fmac_f32 v200, v11, v163
    v_fmac_f32 v200, v12, v164
    v_mfma_f32_32x32x16_bf16 v[48:63], v[76:79], v[184:187], v[48:63]
    ds_swizzle_b32 v76, v76 offset:0x401F
    ds_swizzle_b32 v77, v77 offset:0x401F
    ds_swizzle_b32 v78, v78 offset:0x401F
    ds_swizzle_b32 v79, v79 offset:0x401F
    v_fmac_f32 v200, v13, v165
    v_fmac_f32 v200, v14, v166
    v_fmac_f32 v200, v15, v167
    v_add_f32 v254, v196, v254
    s_waitcnt lgkmcnt(8)
    s_mov_b64 exec, s[56:57]
    v_xor_b32 v68, 0x80008000, v68
    v_xor_b32 v69, 0x80008000, v69
    v_xor_b32 v70, 0x80008000, v70
    v_xor_b32 v71, 0x80008000, v71
    s_mov_b64 exec, -1
    s_waitcnt vmcnt(4) lgkmcnt(4)
    v_mfma_f32_32x32x16_bf16 v[0:15], v[64:67], v[176:179], 0
    v_mul_f32 v255, v32, v152
    v_fmac_f32 v255, v33, v153
    v_fmac_f32 v255, v34, v154
    v_fmac_f32 v255, v35, v155
    v_fmac_f32 v255, v36, v156
    s_add_u32 m0, s21, 4096
    v_mfma_f32_32x32x16_bf16 v[16:31], v[68:71], v[176:179], v[16:31]
    v_lshl_add_u32 v238, v238, 10, v246
    v_lshl_add_u32 v239, v239, 10, v246
    buffer_load_dwordx4 v238, s[4:7], s40 offen lds
    buffer_load_dwordx4 v239, s[8:11], s40 offen offset:1024 lds
    ds_read_b64_tr_b16 v[176:177], v244 offset:6144
    ds_read_b64_tr_b16 v[178:179], v244 offset:7168
    ds_read_b64_tr_b16 v[184:185], v245 offset:6144
    ds_read_b64_tr_b16 v[186:187], v245 offset:7168
    v_fmac_f32 v255, v37, v157
    v_fmac_f32 v255, v38, v158
    v_fmac_f32 v255, v39, v159
    v_fmac_f32 v201, v40, v168
    v_fmac_f32 v201, v41, v169
    s_waitcnt lgkmcnt(0)
    s_mov_b64 exec, s[56:57]
    v_xor_b32 v76, 0x80008000, v76
    v_xor_b32 v77, 0x80008000, v77
    v_xor_b32 v78, 0x80008000, v78
    v_xor_b32 v79, 0x80008000, v79
    s_mov_b64 exec, -1
    v_mfma_f32_32x32x16_bf16 v[0:15], v[72:75], v[176:179], v[0:15]
    v_permlane32_swap_b32 v197, v255
    v_fmac_f32 v201, v42, v170
    v_fmac_f32 v201, v43, v171
    v_fmac_f32 v201, v44, v172
    v_fmac_f32 v201, v45, v173
    s_add_u32 m0, s21, 6144
    v_mfma_f32_32x32x16_bf16 v[16:31], v[76:79], v[176:179], v[16:31]
    v_lshl_add_u32 v240, v240, 10, v246
    v_lshl_add_u32 v241, v241, 10, v246
    buffer_load_dwordx4 v240, s[4:7], s41 offen lds
    buffer_load_dwordx4 v241, s[8:11], s41 offen offset:1024 lds
    v_fmac_f32 v201, v46, v174
    v_fmac_f32 v201, v47, v175
    v_add_f32 v255, v197, v255
    v_cvt_pk_bf16_f32 v254, v254, v255
    ds_write_b32 v253, v254 offset:512
    v_mfma_f32_32x32x16_bf16 v[32:47], v[64:67], v[180:183], 0
    v_mul_f32 v254, v0, v144
    v_fmac_f32 v254, v1, v145
    v_fmac_f32 v254, v2, v146
    v_fmac_f32 v254, v3, v147
    v_fmac_f32 v254, v4, v148
    v_fmac_f32 v254, v5, v149
    v_fmac_f32 v254, v6, v150
    v_fmac_f32 v254, v7, v151
    v_fma_f32 v202, v8, -v160, v202
    v_fma_f32 v202, v9, -v161, v202
    v_mfma_f32_32x32x16_bf16 v[48:63], v[68:71], v[180:183], v[48:63]
    s_waitcnt vmcnt(6)
    ds_read_b64_tr_b16 v[176:177], v244 offset:0
    ds_read_b64_tr_b16 v[178:179], v244 offset:1024
    ds_read_b64_tr_b16 v[180:181], v245 offset:0
    ds_read_b64_tr_b16 v[182:183], v245 offset:1024
    v_permlane32_swap_b32 v254, v200
    v_fma_f32 v202, v10, -v162, v202
    v_fma_f32 v202, v11, -v163, v202
    v_fma_f32 v202, v12, -v164, v202
    v_fma_f32 v202, v13, -v165, v202
    v_fma_f32 v202, v14, -v166, v202
    v_fma_f32 v202, v15, -v167, v202
    v_add_f32 v200, v254, v200
    v_fmac_f32 v198, v16, v112
    v_permlane32_swap_b32 v202, v254
    v_mfma_f32_32x32x16_bf16 v[32:47], v[72:75], v[184:187], v[32:47]
    v_fmac_f32 v198, v17, v113
    v_fmac_f32 v198, v18, v114
    v_fmac_f32 v198, v19, v115
    v_fmac_f32 v198, v20, v116
    v_fmac_f32 v198, v21, v117
    v_fmac_f32 v198, v22, v118
    v_fmac_f32 v198, v23, v119
    v_add_f32 v254, v202, v254
    v_mul_f32 v196, v24, v160
    v_fmac_f32 v196, v25, v161
    v_mfma_f32_32x32x16_bf16 v[48:63], v[76:79], v[184:187], v[48:63]
    v_add_u32 v249, s48, v249
    v_add_u32 v250, s49, v250
    ds_read_b32 v252, v251 offset:16
    ds_read_b64_tr_b16 v[68:69], v249 offset:0
    ds_read_b64_tr_b16 v[70:71], v249 offset:256
    s_mov_b64 exec, s[54:55]
    ds_read_u16_d16_hi v242, v250 offset:0
    s_mov_b64 exec, -1
    v_fmac_f32 v196, v26, v162
    v_fmac_f32 v196, v27, v163
    v_fmac_f32 v196, v28, v164
    v_fmac_f32 v196, v29, v165
    v_fmac_f32 v196, v30, v166
    v_fmac_f32 v196, v31, v167
    s_nop 1
    v_permlane32_swap_b32 v198, v196
    v_add_f32 v196, v198, v196
    v_mul_f32 v255, v32, v152
    v_fmac_f32 v255, v33, v153
    v_fmac_f32 v255, v34, v154
    v_fmac_f32 v255, v35, v155
    v_fmac_f32 v255, v36, v156
    v_fmac_f32 v255, v37, v157
    v_fmac_f32 v255, v38, v158
    v_fmac_f32 v255, v39, v159
    v_fma_f32 v203, v40, -v168, v203
    v_fma_f32 v203, v41, -v169, v203
    v_permlane32_swap_b32 v255, v201
    v_fma_f32 v203, v42, -v170, v203
    v_fma_f32 v203, v43, -v171, v203
    v_fma_f32 v203, v44, -v172, v203
    v_fma_f32 v203, v45, -v173, v203
    v_fma_f32 v203, v46, -v174, v203
    v_fma_f32 v203, v47, -v175, v203
    v_add_f32 v201, v255, v201
    v_fmac_f32 v199, v48, v120
    v_permlane32_swap_b32 v203, v255
    v_fmac_f32 v199, v49, v121
    v_fmac_f32 v199, v50, v122
    v_fmac_f32 v199, v51, v123
    v_fmac_f32 v199, v52, v124
    v_fmac_f32 v199, v53, v125
    v_fmac_f32 v199, v54, v126
    v_fmac_f32 v199, v55, v127
    v_add_f32 v255, v203, v255
    v_mul_f32 v197, v56, v168
    v_fmac_f32 v197, v57, v169
    v_fmac_f32 v197, v58, v170
    v_fmac_f32 v197, v59, v171
    v_fmac_f32 v197, v60, v172
    v_fmac_f32 v197, v61, v173
    v_fmac_f32 v197, v62, v174
    v_fmac_f32 v197, v63, v175
    s_nop 1
    v_permlane32_swap_b32 v199, v197
    v_add_f32 v197, v199, v197
    v_cvt_pk_bf16_f32 v200, v200, v201
    v_cvt_pk_bf16_f32 v254, v254, v255
    v_cvt_pk_bf16_f32 v196, v196, v197
    ds_write_b32 v253, v200 offset:768
    s_mov_b64 exec, 0xffffffff
    ds_write_b32 v253, v254 offset:1280
    s_mov_b64 exec, -1
    ds_write_b32 v253, v196 offset:1024
    s_add_u32 s50, s50, 1
    s_cmp_ge_u32 s50, 5
    s_cbranch_scc1 TAIL
    s_waitcnt lgkmcnt(6)
    v_readfirstlane_b32 s66, v252
    s_add_u32 s53, s53, 1
    v_mov_b32 v252, s53
    s_cmp_le_u32 s53, s66
    ds_write2_b32 v251, v252, v252 offset0:0 offset1:8
    s_setprio 1
    s_cbranch_scc1 PRIO_10
    s_setprio 0
PRIO_10:
    s_cmp_eq_u32 s52, 4
    s_cbranch_scc1 ITEM_1_4
    s_cmp_eq_u32 s52, 5
    s_cbranch_scc1 ITEM_1_5
    s_cmp_eq_u32 s52, 3
    s_cbranch_scc1 ITEM_1_3
    s_cmp_eq_u32 s52, 6
    s_cbranch_scc1 ITEM_1_6
    s_cmp_eq_u32 s52, 8
    s_cbranch_scc1 ITEM_1_8
    s_branch ITEM_1_2
.p2align 6
ITEM_1_5:
    s_mov_b64 exec, s[54:55]
    ds_read_u16_d16_hi v243, v250 offset:128
    s_mov_b64 exec, -1
    ds_read_b64_tr_b16 v[76:77], v249 offset:512
    ds_read_b64_tr_b16 v[78:79], v249 offset:768
    ds_read_b64_tr_b16 v[84:85], v249 offset:1024
    s_waitcnt lgkmcnt(4)
    v_lshlrev_b32 v196, 16, v68
    v_and_b32 v197, 0xffff0000, v68
    v_lshlrev_b32 v198, 16, v69
    v_and_b32 v199, 0xffff0000, v69
    v_mul_f32_dpp v200, v242, v196 row_newbcast:0 row_mask:0xf bank_mask:0xf
    v_mul_f32_dpp v201, v242, v197 row_newbcast:1 row_mask:0xf bank_mask:0xf
    v_mul_f32_dpp v202, v242, v196 row_newbcast:8 row_mask:0xf bank_mask:0xf
    v_mul_f32_dpp v203, v242, v197 row_newbcast:9 row_mask:0xf bank_mask:0xf
    v_lshlrev_b32 v196, 16, v70
    v_and_b32 v197, 0xffff0000, v70
    v_cvt_pk_bf16_f32 v64, v200, v201
    v_cvt_pk_bf16_f32 v68, v202, v203
    v_mul_f32_dpp v200, v242, v198 row_newbcast:2 row_mask:0xf bank_mask:0xf
    v_mul_f32_dpp v201, v242, v199 row_newbcast:3 row_mask:0xf bank_mask:0xf
    v_mul_f32_dpp v202, v242, v198 row_newbcast:10 row_mask:0xf bank_mask:0xf
    v_mul_f32_dpp v203, v242, v199 row_newbcast:11 row_mask:0xf bank_mask:0xf
    v_lshlrev_b32 v198, 16, v71
    v_and_b32 v199, 0xffff0000, v71
    v_cvt_pk_bf16_f32 v65, v200, v201
    v_cvt_pk_bf16_f32 v69, v202, v203
    v_mul_f32_dpp v200, v242, v196 row_newbcast:4 row_mask:0xf bank_mask:0xf
    v_mul_f32_dpp v201, v242, v197 row_newbcast:5 row_mask:0xf bank_mask:0xf
    v_mul_f32_dpp v202, v242, v196 row_newbcast:12 row_mask:0xf bank_mask:0xf
    v_mul_f32_dpp v203, v242, v197 row_newbcast:13 row_mask:0xf bank_mask:0xf
    v_cvt_pk_bf16_f32 v66, v200, v201
    v_cvt_pk_bf16_f32 v70, v202, v203
    v_mul_f32_dpp v200, v242, v198 row_newbcast:6 row_mask:0xf bank_mask:0xf
    v_mul_f32_dpp v201, v242, v199 row_newbcast:7 row_mask:0xf bank_mask:0xf
    v_mul_f32_dpp v202, v242, v198 row_newbcast:14 row_mask:0xf bank_mask:0xf
    v_mul_f32_dpp v203, v242, v199 row_newbcast:15 row_mask:0xf bank_mask:0xf
    v_cvt_pk_bf16_f32 v67, v200, v201
    v_cvt_pk_bf16_f32 v71, v202, v203
    s_mov_b64 exec, s[54:55]
    ds_read_u16_d16_hi v242, v250 offset:256
    s_mov_b64 exec, -1
    s_waitcnt vmcnt(4) lgkmcnt(2)
    v_mfma_f32_32x32x16_bf16 v[0:15], v[64:67], v[176:179], 0
    v_lshlrev_b32 v196, 16, v76
    v_and_b32 v197, 0xffff0000, v76
    v_lshlrev_b32 v198, 16, v77
    v_and_b32 v199, 0xffff0000, v77
    v_mul_f32_dpp v200, v243, v196 row_newbcast:0 row_mask:0xf bank_mask:0xf
    v_mul_f32_dpp v201, v243, v197 row_newbcast:1 row_mask:0xf bank_mask:0xf
    v_mul_f32_dpp v202, v243, v196 row_newbcast:8 row_mask:0xf bank_mask:0xf
    v_mul_f32_dpp v203, v243, v197 row_newbcast:9 row_mask:0xf bank_mask:0xf
    v_lshlrev_b32 v196, 16, v78
    v_and_b32 v197, 0xffff0000, v78
    v_cvt_pk_bf16_f32 v72, v200, v201
    v_cvt_pk_bf16_f32 v76, v202, v203
    v_mul_f32_dpp v200, v243, v198 row_newbcast:2 row_mask:0xf bank_mask:0xf
    v_mul_f32_dpp v201, v243, v199 row_newbcast:3 row_mask:0xf bank_mask:0xf
    v_mul_f32_dpp v202, v243, v198 row_newbcast:10 row_mask:0xf bank_mask:0xf
    v_mul_f32_dpp v203, v243, v199 row_newbcast:11 row_mask:0xf bank_mask:0xf
    s_add_u32 m0, s21, 0
    v_mfma_f32_32x32x16_bf16 v[16:31], v[68:71], v[176:179], 0
    buffer_load_dwordx4 v236, s[4:7], s35 offen lds
    buffer_load_dwordx4 v237, s[8:11], s35 offen offset:1024 lds
    ds_read_b64_tr_b16 v[176:177], v244 offset:2048
    ds_read_b64_tr_b16 v[178:179], v244 offset:3072
    ds_read_b64_tr_b16 v[184:185], v245 offset:2048
    ds_read_b64_tr_b16 v[186:187], v245 offset:3072
    v_lshlrev_b32 v198, 16, v79
    v_and_b32 v199, 0xffff0000, v79
    v_cvt_pk_bf16_f32 v73, v200, v201
    v_cvt_pk_bf16_f32 v77, v202, v203
    v_mul_f32_dpp v200, v243, v196 row_newbcast:4 row_mask:0xf bank_mask:0xf
    v_mul_f32_dpp v201, v243, v197 row_newbcast:5 row_mask:0xf bank_mask:0xf
    v_mul_f32_dpp v202, v243, v196 row_newbcast:12 row_mask:0xf bank_mask:0xf
    v_mul_f32_dpp v203, v243, v197 row_newbcast:13 row_mask:0xf bank_mask:0xf
    v_cvt_pk_bf16_f32 v74, v200, v201
    v_cvt_pk_bf16_f32 v78, v202, v203
    v_mul_f32_dpp v200, v243, v198 row_newbcast:6 row_mask:0xf bank_mask:0xf
    v_mul_f32_dpp v201, v243, v199 row_newbcast:7 row_mask:0xf bank_mask:0xf
    v_mul_f32_dpp v202, v243, v198 row_newbcast:14 row_mask:0xf bank_mask:0xf
    v_mul_f32_dpp v203, v243, v199 row_newbcast:15 row_mask:0xf bank_mask:0xf
    v_cvt_pk_bf16_f32 v75, v200, v201
    v_cvt_pk_bf16_f32 v79, v202, v203
    s_nop 0
    s_waitcnt vmcnt(4) lgkmcnt(0)
    v_mfma_f32_32x32x16_bf16 v[0:15], v[72:75], v[176:179], v[0:15]
    v_lshlrev_b32 v196, 16, v84
    v_and_b32 v197, 0xffff0000, v84
    v_lshlrev_b32 v198, 16, v85
    v_and_b32 v199, 0xffff0000, v85
    v_mul_f32_dpp v200, v242, v196 row_newbcast:0 row_mask:0xf bank_mask:0xf
    v_mul_f32_dpp v201, v242, v197 row_newbcast:1 row_mask:0xf bank_mask:0xf
    v_mul_f32_dpp v202, v242, v196 row_newbcast:8 row_mask:0xf bank_mask:0xf
    v_mul_f32_dpp v203, v242, v197 row_newbcast:9 row_mask:0xf bank_mask:0xf
    s_add_u32 m0, s21, 2048
    v_mfma_f32_32x32x16_bf16 v[16:31], v[76:79], v[176:179], v[16:31]
    buffer_load_dwordx4 v238, s[4:7], s35 offen lds
    ds_read_b64_tr_b16 v[176:177], v244 offset:4096
    ds_read_b64_tr_b16 v[188:189], v245 offset:4096
    v_cvt_pk_bf16_f32 v80, v200, v201
    v_cvt_pk_bf16_f32 v84, v202, v203
    v_mul_f32_dpp v200, v242, v198 row_newbcast:2 row_mask:0xf bank_mask:0xf
    v_mul_f32_dpp v201, v242, v199 row_newbcast:3 row_mask:0xf bank_mask:0xf
    v_mul_f32_dpp v202, v242, v198 row_newbcast:10 row_mask:0xf bank_mask:0xf
    v_mul_f32_dpp v203, v242, v199 row_newbcast:11 row_mask:0xf bank_mask:0xf
    v_cvt_pk_bf16_f32 v81, v200, v201
    v_cvt_pk_bf16_f32 v85, v202, v203
    s_nop 0
    s_waitcnt lgkmcnt(0)
    v_mfma_f32_32x32x8_bf16 v[0:15], v[80:81], v[176:177], v[0:15]
    s_add_u32 m0, s21, 4096
    v_mfma_f32_32x32x8_bf16 v[16:31], v[84:85], v[176:177], v[16:31]
    buffer_load_dwordx4 v234, s[4:7], s36 offen lds
    buffer_load_dwordx4 v235, s[8:11], s36 offen offset:1024 lds
    s_mov_b32 m0, s50
    s_nop 0
    s_movrels_b32 s71, s23
    s_movrels_b32 s33, s28
    s_and_b32 s70, s33, 0x70
    s_andn2_b32 s33, s33, 0x70
    v_xor_b32 v253, s70, v248
    v_add_u32 v253, s33, v253
    s_bfe_u32 s46, s71, 0x30012
    s_mov_b32 m0, s46
    s_and_b32 s66, s71, 0x3ffff
    s_movrels_b32 s68, s57
    s_movrels_b32 s69, s61
    s_sub_u32 s48, s66, s47
    s_mov_b32 s47, s66
    s_lshr_b32 s52, s71, 28
    s_lshl_b32 s67, s46, 9
    s_add_u32 s66, s66, s67
    s_sub_u32 s49, s66, s42
    s_mov_b32 s42, s66
    s_bfe_u32 s66, s68, 655360
    s_add_u32 s43, s42, s66
    s_bfe_u32 s39, s69, 655360
    s_bfe_u32 s66, s68, 655370
    s_add_u32 s44, s42, s66
    s_bfe_u32 s40, s69, 655370
    s_bfe_u32 s66, s68, 655380
    s_add_u32 s45, s42, s66
    s_bfe_u32 s41, s69, 655380
    v_add_u32 v252, s45, v247
    ds_read_u16 v240, v252
    ds_read_u16 v241, v252 offset:64
    v_mfma_f32_32x32x16_bf16 v[32:47], v[64:67], v[180:183], 0
    v_mul_f32 v196, v0, v96
    v_fmac_f32 v196, v1, v97
    v_fmac_f32 v196, v2, v98
    v_fmac_f32 v196, v3, v99
    v_fmac_f32 v196, v4, v100
    v_fmac_f32 v196, v5, v101
    v_fmac_f32 v196, v6, v102
    v_mfma_f32_32x32x16_bf16 v[48:63], v[68:71], v[180:183], 0
    v_fmac_f32 v196, v7, v103
    v_mul_f32 v198, v8, v128
    v_fmac_f32 v198, v9, v129
    v_fmac_f32 v198, v10, v130
    v_fmac_f32 v198, v11, v131
    v_fmac_f32 v198, v12, v132
    v_mfma_f32_32x32x16_bf16 v[32:47], v[72:75], v[184:187], v[32:47]
    v_fmac_f32 v198, v13, v133
    v_fmac_f32 v198, v14, v134
    v_fmac_f32 v198, v15, v135
    v_mul_f32 v200, v16, v128
    v_fmac_f32 v200, v17, v129
    v_permlane32_swap_b32 v196, v198
    v_mfma_f32_32x32x16_bf16 v[48:63], v[76:79], v[184:187], v[48:63]
    s_waitcnt vmcnt(5)
    ds_read_b64_tr_b16 v[176:177], v244 offset:6144
    ds_read_b64_tr_b16 v[178:179], v244 offset:7168
    ds_read_b64_tr_b16 v[180:181], v245 offset:6144
    ds_read_b64_tr_b16 v[182:183], v245 offset:7168
    v_fmac_f32 v200, v18, v130
    v_fmac_f32 v200, v19, v131
    v_fmac_f32 v200, v20, v132
    v_fmac_f32 v200, v21, v133
    v_fmac_f32 v200, v22, v134
    v_fmac_f32 v200, v23, v135
    v_mfma_f32_32x32x8_bf16 v[32:47], v[80:81], v[188:189], v[32:47]
    v_add_f32 v198, v196, v198
    v_mul_f32_e64 v202, v24, -v128
    v_fma_f32 v202, v25, -v129, v202
    v_fma_f32 v202, v26, -v130, v202
    v_fma_f32 v202, v27, -v131, v202
    v_fma_f32 v202, v28, -v132, v202
    v_mfma_f32_32x32x8_bf16 v[48:63], v[84:85], v[188:189], v[48:63]
    v_fma_f32 v202, v29, -v133, v202
    v_fma_f32 v202, v30, -v134, v202
    v_fma_f32 v202, v31, -v135, v202
    s_nop 1
    v_permlane32_swap_b32 v200, v202
    v_add_f32 v202, v200, v202
    s_waitcnt vmcnt(3) lgkmcnt(0)
    v_mfma_f32_32x32x16_bf16 v[0:15], v[64:67], v[176:179], 0
    v_mul_f32 v197, v32, v104
    v_fmac_f32 v197, v33, v105
    v_fmac_f32 v197, v34, v106
    v_fmac_f32 v197, v35, v107
    v_fmac_f32 v197, v36, v108
    v_fmac_f32 v197, v37, v109
    v_fmac_f32 v197, v38, v110
    s_add_u32 m0, s21, 6144
    v_mfma_f32_32x32x16_bf16 v[16:31], v[68:71], v[176:179], 0
    buffer_load_dwordx4 v236, s[4:7], s36 offen lds
    buffer_load_dwordx4 v237, s[8:11], s36 offen offset:1024 lds
    ds_read_b64_tr_b16 v[176:177], v244 offset:0
    ds_read_b64_tr_b16 v[178:179], v244 offset:1024
    ds_read_b64_tr_b16 v[184:185], v245 offset:0
    ds_read_b64_tr_b16 v[186:187], v245 offset:1024
    v_fmac_f32 v197, v39, v111
    v_mul_f32 v199, v40, v136
    v_fmac_f32 v199, v41, v137
    v_fmac_f32 v199, v42, v138
    v_fmac_f32 v199, v43, v139
    v_fmac_f32 v199, v44, v140
    v_fmac_f32 v199, v45, v141
    s_waitcnt vmcnt(4) lgkmcnt(0)
    v_mfma_f32_32x32x16_bf16 v[0:15], v[72:75], v[176:179], v[0:15]
    v_fmac_f32 v199, v46, v142
    v_fmac_f32 v199, v47, v143
    v_mul_f32 v201, v48, v136
    v_fmac_f32 v201, v49, v137
    v_permlane32_swap_b32 v197, v199
    v_fmac_f32 v201, v50, v138
    v_fmac_f32 v201, v51, v139
    s_add_u32 m0, s21, 0
    v_mfma_f32_32x32x16_bf16 v[16:31], v[76:79], v[176:179], v[16:31]
    buffer_load_dwordx4 v238, s[4:7], s36 offen lds
    ds_read_b64_tr_b16 v[176:177], v244 offset:2048
    ds_read_b64_tr_b16 v[188:189], v245 offset:2048
    v_fmac_f32 v201, v52, v140
    v_fmac_f32 v201, v53, v141
    v_fmac_f32 v201, v54, v142
    v_fmac_f32 v201, v55, v143
    v_add_f32 v199, v197, v199
    v_mul_f32_e64 v203, v56, -v136
    v_fma_f32 v203, v57, -v137, v203
    s_waitcnt lgkmcnt(0)
    v_mfma_f32_32x32x8_bf16 v[0:15], v[80:81], v[176:177], v[0:15]
    v_fma_f32 v203, v58, -v138, v203
    v_fma_f32 v203, v59, -v139, v203
    v_fma_f32 v203, v60, -v140, v203
    v_fma_f32 v203, v61, -v141, v203
    v_fma_f32 v203, v62, -v142, v203
    v_fma_f32 v203, v63, -v143, v203
    s_nop 1
    s_add_u32 m0, s21, 2048
    v_mfma_f32_32x32x8_bf16 v[16:31], v[84:85], v[176:177], v[16:31]
    buffer_load_dwordx4 v234, s[4:7], s37 offen lds
    buffer_load_dwordx4 v235, s[8:11], s37 offen offset:1024 lds
    v_add_u32 v252, s42, v247
    ds_read_u16 v234, v252
    ds_read_u16 v235, v252 offset:64
    v_permlane32_swap_b32 v201, v203
    v_add_f32 v203, v201, v203
    v_cvt_pk_bf16_f32 v198, v198, v199
    v_cvt_pk_bf16_f32 v202, v202, v203
    ds_write_b32 v253, v198 offset:0
    ds_write_b32 v253, v202 offset:256
    v_mfma_f32_32x32x16_bf16 v[32:47], v[64:67], v[180:183], 0
    v_mul_f32 v196, v0, v144
    v_fmac_f32 v196, v1, v145
    v_fmac_f32 v196, v2, v146
    v_fmac_f32 v196, v3, v147
    v_fmac_f32 v196, v4, v148
    v_fmac_f32 v196, v5, v149
    v_mfma_f32_32x32x16_bf16 v[48:63], v[68:71], v[180:183], 0
    v_fmac_f32 v196, v6, v150
    v_fmac_f32 v196, v7, v151
    v_mul_f32 v198, v8, v112
    v_fmac_f32 v198, v9, v113
    v_fmac_f32 v198, v10, v114
    v_mfma_f32_32x32x16_bf16 v[32:47], v[72:75], v[184:187], v[32:47]
    v_fmac_f32 v198, v11, v115
    v_fmac_f32 v198, v12, v116
    v_fmac_f32 v198, v13, v117
    v_fmac_f32 v198, v14, v118
    v_fmac_f32 v198, v15, v119
    v_mfma_f32_32x32x16_bf16 v[48:63], v[76:79], v[184:187], v[48:63]
    s_waitcnt vmcnt(5)
    ds_read_b64_tr_b16 v[176:177], v244 offset:4096
    ds_read_b64_tr_b16 v[178:179], v244 offset:5120
    ds_read_b64_tr_b16 v[180:181], v245 offset:4096
    ds_read_b64_tr_b16 v[182:183], v245 offset:5120
    v_mul_f32_e64 v200, v16, -v160
    v_fma_f32 v200, v17, -v161, v200
    v_fma_f32 v200, v18, -v162, v200
    v_fma_f32 v200, v19, -v163, v200
    v_fma_f32 v200, v20, -v164, v200
    v_fma_f32 v200, v21, -v165, v200
    v_mfma_f32_32x32x8_bf16 v[32:47], v[80:81], v[188:189], v[32:47]
    v_fma_f32 v200, v22, -v166, v200
    v_fma_f32 v200, v23, -v167, v200
    v_mul_f32_e64 v202, v24, -v160
    v_fma_f32 v202, v25, -v161, v202
    v_fma_f32 v202, v26, -v162, v202
    v_mfma_f32_32x32x8_bf16 v[48:63], v[84:85], v[188:189], v[48:63]
    v_fma_f32 v202, v27, -v163, v202
    v_fma_f32 v202, v28, -v164, v202
    v_fma_f32 v202, v29, -v165, v202
    v_fma_f32 v202, v30, -v166, v202
    v_fma_f32 v202, v31, -v167, v202
    s_waitcnt vmcnt(3) lgkmcnt(0)
    v_mfma_f32_32x32x16_bf16 v[0:15], v[64:67], v[176:179], 0
    v_mul_f32 v197, v32, v152
    v_fmac_f32 v197, v33, v153
    v_fmac_f32 v197, v34, v154
    v_fmac_f32 v197, v35, v155
    v_fmac_f32 v197, v36, v156
    v_fmac_f32 v197, v37, v157
    s_add_u32 m0, s21, 4096
    v_mfma_f32_32x32x16_bf16 v[16:31], v[68:71], v[176:179], 0
    buffer_load_dwordx4 v236, s[4:7], s37 offen lds
    buffer_load_dwordx4 v237, s[8:11], s37 offen offset:1024 lds
    ds_read_b64_tr_b16 v[176:177], v244 offset:6144
    ds_read_b64_tr_b16 v[178:179], v244 offset:7168
    ds_read_b64_tr_b16 v[184:185], v245 offset:6144
    ds_read_b64_tr_b16 v[186:187], v245 offset:7168
    v_add_u32 v252, s43, v247
    ds_read_u16 v236, v252
    ds_read_u16 v237, v252 offset:64
    v_fmac_f32 v197, v38, v158
    v_fmac_f32 v197, v39, v159
    v_mul_f32 v199, v40, v120
    v_fmac_f32 v199, v41, v121
    v_fmac_f32 v199, v42, v122
    s_waitcnt vmcnt(4) lgkmcnt(2)
    v_mfma_f32_32x32x16_bf16 v[0:15], v[72:75], v[176:179], v[0:15]
    v_fmac_f32 v199, v43, v123
    v_fmac_f32 v199, v44, v124
    v_fmac_f32 v199, v45, v125
    v_fmac_f32 v199, v46, v126
    v_fmac_f32 v199, v47, v127
    s_add_u32 m0, s21, 6144
    v_mfma_f32_32x32x16_bf16 v[16:31], v[76:79], v[176:179], v[16:31]
    buffer_load_dwordx4 v238, s[4:7], s37 offen lds
    ds_read_b64_tr_b16 v[176:177], v244 offset:0
    ds_read_b64_tr_b16 v[188:189], v245 offset:0
    v_add_u32 v252, s44, v247
    ds_read_u16 v238, v252
    ds_read_u16 v239, v252 offset:64
    v_mul_f32_e64 v201, v48, -v168
    v_fma_f32 v201, v49, -v169, v201
    v_fma_f32 v201, v50, -v170, v201
    v_fma_f32 v201, v51, -v171, v201
    v_fma_f32 v201, v52, -v172, v201
    v_fma_f32 v201, v53, -v173, v201
    s_waitcnt lgkmcnt(2)
    v_mfma_f32_32x32x8_bf16 v[0:15], v[80:81], v[176:177], v[0:15]
    v_fma_f32 v201, v54, -v174, v201
    v_fma_f32 v201, v55, -v175, v201
    v_mul_f32_e64 v203, v56, -v168
    v_fma_f32 v203, v57, -v169, v203
    v_fma_f32 v203, v58, -v170, v203
    s_add_u32 m0, s21, 0
    v_mfma_f32_32x32x8_bf16 v[16:31], v[84:85], v[176:177], v[16:31]
    v_lshl_add_u32 v234, v234, 10, v246
    v_lshl_add_u32 v235, v235, 10, v246
    buffer_load_dwordx4 v234, s[4:7], s38 offen lds
    buffer_load_dwordx4 v235, s[8:11], s38 offen offset:1024 lds
    v_fma_f32 v203, v59, -v171, v203
    v_fma_f32 v203, v60, -v172, v203
    v_fma_f32 v203, v61, -v173, v203
    v_fma_f32 v203, v62, -v174, v203
    v_fma_f32 v203, v63, -v175, v203
    v_mfma_f32_32x32x16_bf16 v[32:47], v[64:67], v[180:183], 0
    v_mul_f32 v254, v0, v144
    v_fmac_f32 v254, v1, v145
    v_fmac_f32 v254, v2, v146
    v_mfma_f32_32x32x16_bf16 v[48:63], v[68:71], v[180:183], 0
    ds_swizzle_b32 v68, v68 offset:0x401F
    ds_swizzle_b32 v69, v69 offset:0x401F
    ds_swizzle_b32 v70, v70 offset:0x401F
    ds_swizzle_b32 v71, v71 offset:0x401F
    v_fmac_f32 v254, v3, v147
    v_fmac_f32 v254, v4, v148
    v_fmac_f32 v254, v5, v149
    v_mfma_f32_32x32x16_bf16 v[32:47], v[72:75], v[184:187], v[32:47]
    v_fmac_f32 v254, v6, v150
    v_fmac_f32 v254, v7, v151
    v_fmac_f32 v200, v8, v160
    v_mfma_f32_32x32x16_bf16 v[48:63], v[76:79], v[184:187], v[48:63]
    ds_swizzle_b32 v76, v76 offset:0x401F
    ds_swizzle_b32 v77, v77 offset:0x401F
    ds_swizzle_b32 v78, v78 offset:0x401F
    ds_swizzle_b32 v79, v79 offset:0x401F
    s_waitcnt vmcnt(5)
    ds_read_b64_tr_b16 v[176:177], v244 offset:2048
    ds_read_b64_tr_b16 v[178:179], v244 offset:3072
    ds_read_b64_tr_b16 v[180:181], v245 offset:2048
    ds_read_b64_tr_b16 v[182:183], v245 offset:3072
    v_fmac_f32 v200, v9, v161
    v_permlane32_swap_b32 v196, v254
    v_fmac_f32 v200, v10, v162
    v_mfma_f32_32x32x8_bf16 v[32:47], v[80:81], v[188:189], v[32:47]
    v_fmac_f32 v200, v11, v163
    v_fmac_f32 v200, v12, v164
    v_fmac_f32 v200, v13, v165
    v_mfma_f32_32x32x8_bf16 v[48:63], v[84:85], v[188:189], v[48:63]
    ds_swizzle_b32 v84, v84 offset:0x401F
    ds_swizzle_b32 v85, v85 offset:0x401F
    v_fmac_f32 v200, v14, v166
    v_fmac_f32 v200, v15, v167
    v_add_f32 v254, v196, v254
    s_waitcnt lgkmcnt(6)
    s_mov_b64 exec, s[56:57]
    v_xor_b32 v68, 0x80008000, v68
    v_xor_b32 v69, 0x80008000, v69
    v_xor_b32 v70, 0x80008000, v70
    v_xor_b32 v71, 0x80008000, v71
    v_xor_b32 v76, 0x80008000, v76
    v_xor_b32 v77, 0x80008000, v77
    v_xor_b32 v78, 0x80008000, v78
    v_xor_b32 v79, 0x80008000, v79
    s_mov_b64 exec, -1
    s_waitcnt vmcnt(3) lgkmcnt(2)
    v_mfma_f32_32x32x16_bf16 v[0:15], v[64:67], v[176:179], 0
    v_mul_f32 v255, v32, v152
    v_fmac_f32 v255, v33, v153
    v_fmac_f32 v255, v34, v154
    v_fmac_f32 v255, v35, v155
    s_add_u32 m0, s21, 2048
    v_mfma_f32_32x32x16_bf16 v[16:31], v[68:71], v[176:179], v[16:31]
    v_lshl_add_u32 v236, v236, 10, v246
    v_lshl_add_u32 v237, v237, 10, v246
    buffer_load_dwordx4 v236, s[4:7], s39 offen lds
    buffer_load_dwordx4 v237, s[8:11], s39 offen offset:1024 lds
    ds_read_b64_tr_b16 v[176:177], v244 offset:4096
    ds_read_b64_tr_b16 v[178:179], v244 offset:5120
    ds_read_b64_tr_b16 v[184:185], v245 offset:4096
    ds_read_b64_tr_b16 v[186:187], v245 offset:5120
    v_fmac_f32 v255, v36, v156
    v_fmac_f32 v255, v37, v157
    v_fmac_f32 v255, v38, v158
    s_waitcnt vmcnt(4) lgkmcnt(0)
    v_mfma_f32_32x32x16_bf16 v[0:15], v[72:75], v[176:179], v[0:15]
    v_fmac_f32 v255, v39, v159
    v_fmac_f32 v201, v40, v168
    v_fmac_f32 v201, v41, v169
    s_add_u32 m0, s21, 4096
    v_mfma_f32_32x32x16_bf16 v[16:31], v[76:79], v[176:179], v[16:31]
    v_lshl_add_u32 v238, v238, 10, v246
    v_lshl_add_u32 v239, v239, 10, v246
    buffer_load_dwordx4 v238, s[4:7], s40 offen lds
    buffer_load_dwordx4 v239, s[8:11], s40 offen offset:1024 lds
    ds_read_b64_tr_b16 v[176:177], v244 offset:6144
    ds_read_b64_tr_b16 v[188:189], v245 offset:6144
    v_permlane32_swap_b32 v197, v255
    v_fmac_f32 v201, v42, v170
    v_fmac_f32 v201, v43, v171
    v_fmac_f32 v201, v44, v172
    s_waitcnt lgkmcnt(0)
    s_mov_b64 exec, s[56:57]
    v_xor_b32 v84, 0x80008000, v84
    v_xor_b32 v85, 0x80008000, v85
    s_mov_b64 exec, -1
    v_mfma_f32_32x32x8_bf16 v[0:15], v[80:81], v[176:177], v[0:15]
    v_fmac_f32 v201, v45, v173
    v_fmac_f32 v201, v46, v174
    v_fmac_f32 v201, v47, v175
    s_add_u32 m0, s21, 6144
    v_mfma_f32_32x32x8_bf16 v[16:31], v[84:85], v[176:177], v[16:31]
    v_lshl_add_u32 v240, v240, 10, v246
    v_lshl_add_u32 v241, v241, 10, v246
    buffer_load_dwordx4 v240, s[4:7], s41 offen lds
    buffer_load_dwordx4 v241, s[8:11], s41 offen offset:1024 lds
    v_add_f32 v255, v197, v255
    v_cvt_pk_bf16_f32 v254, v254, v255
    ds_write_b32 v253, v254 offset:512
    v_mfma_f32_32x32x16_bf16 v[32:47], v[64:67], v[180:183], 0
    v_mul_f32 v254, v0, v144
    v_fmac_f32 v254, v1, v145
    v_fmac_f32 v254, v2, v146
    v_fmac_f32 v254, v3, v147
    v_fmac_f32 v254, v4, v148
    v_fmac_f32 v254, v5, v149
    v_fmac_f32 v254, v6, v150
    v_mfma_f32_32x32x16_bf16 v[48:63], v[68:71], v[180:183], v[48:63]
    v_fmac_f32 v254, v7, v151
    v_fma_f32 v202, v8, -v160, v202
    v_fma_f32 v202, v9, -v161, v202
    v_permlane32_swap_b32 v254, v200
    v_fma_f32 v202, v10, -v162, v202
    v_fma_f32 v202, v11, -v163, v202
    v_mfma_f32_32x32x16_bf16 v[32:47], v[72:75], v[184:187], v[32:47]
    v_fma_f32 v202, v12, -v164, v202
    v_fma_f32 v202, v13, -v165, v202
    v_fma_f32 v202, v14, -v166, v202
    v_fma_f32 v202, v15, -v167, v202
    v_add_f32 v200, v254, v200
    v_fmac_f32 v198, v16, v112
    v_permlane32_swap_b32 v202, v254
    v_mfma_f32_32x32x16_bf16 v[48:63], v[76:79], v[184:187], v[48:63]
    s_waitcnt vmcnt(6)
    ds_read_b64_tr_b16 v[176:177], v244 offset:0
    ds_read_b64_tr_b16 v[178:179], v244 offset:1024
    ds_read_b64_tr_b16 v[180:181], v245 offset:0
    ds_read_b64_tr_b16 v[182:183], v245 offset:1024
    v_fmac_f32 v198, v17, v113
    v_fmac_f32 v198, v18, v114
    v_fmac_f32 v198, v19, v115
    v_fmac_f32 v198, v20, v116
    v_fmac_f32 v198, v21, v117
    v_fmac_f32 v198, v22, v118
    v_mfma_f32_32x32x8_bf16 v[32:47], v[80:81], v[188:189], v[32:47]
    v_fmac_f32 v198, v23, v119
    v_add_f32 v254, v202, v254
    v_mul_f32 v196, v24, v160
    v_fmac_f32 v196, v25, v161
    v_fmac_f32 v196, v26, v162
    v_fmac_f32 v196, v27, v163
    v_fmac_f32 v196, v28, v164
    v_mfma_f32_32x32x8_bf16 v[48:63], v[84:85], v[188:189], v[48:63]
    v_add_u32 v249, s48, v249
    v_add_u32 v250, s49, v250
    ds_read_b32 v252, v251 offset:16
    ds_read_b64_tr_b16 v[68:69], v249 offset:0
    ds_read_b64_tr_b16 v[70:71], v249 offset:256
    s_mov_b64 exec, s[54:55]
    ds_read_u16_d16_hi v242, v250 offset:0
    s_mov_b64 exec, -1
    v_fmac_f32 v196, v29, v165
    v_fmac_f32 v196, v30, v166
    v_fmac_f32 v196, v31, v167
    s_nop 1
    v_permlane32_swap_b32 v198, v196
    v_add_f32 v196, v198, v196
    v_mul_f32 v255, v32, v152
    v_fmac_f32 v255, v33, v153
    v_fmac_f32 v255, v34, v154
    v_fmac_f32 v255, v35, v155
    v_fmac_f32 v255, v36, v156
    v_fmac_f32 v255, v37, v157
    v_fmac_f32 v255, v38, v158
    v_fmac_f32 v255, v39, v159
    v_fma_f32 v203, v40, -v168, v203
    v_fma_f32 v203, v41, -v169, v203
    v_permlane32_swap_b32 v255, v201
    v_fma_f32 v203, v42, -v170, v203
    v_fma_f32 v203, v43, -v171, v203
    v_fma_f32 v203, v44, -v172, v203
    v_fma_f32 v203, v45, -v173, v203
    v_fma_f32 v203, v46, -v174, v203
    v_fma_f32 v203, v47, -v175, v203
    v_add_f32 v201, v255, v201
    v_fmac_f32 v199, v48, v120
    v_permlane32_swap_b32 v203, v255
    v_fmac_f32 v199, v49, v121
    v_fmac_f32 v199, v50, v122
    v_fmac_f32 v199, v51, v123
    v_fmac_f32 v199, v52, v124
    v_fmac_f32 v199, v53, v125
    v_fmac_f32 v199, v54, v126
    v_fmac_f32 v199, v55, v127
    v_add_f32 v255, v203, v255
    v_mul_f32 v197, v56, v168
    v_fmac_f32 v197, v57, v169
    v_fmac_f32 v197, v58, v170
    v_fmac_f32 v197, v59, v171
    v_fmac_f32 v197, v60, v172
    v_fmac_f32 v197, v61, v173
    v_fmac_f32 v197, v62, v174
    v_fmac_f32 v197, v63, v175
    s_nop 1
    v_permlane32_swap_b32 v199, v197
    v_add_f32 v197, v199, v197
    v_cvt_pk_bf16_f32 v200, v200, v201
    v_cvt_pk_bf16_f32 v254, v254, v255
    v_cvt_pk_bf16_f32 v196, v196, v197
    ds_write_b32 v253, v200 offset:768
    s_mov_b64 exec, 0xffffffff
    ds_write_b32 v253, v254 offset:1280
    s_mov_b64 exec, -1
    ds_write_b32 v253, v196 offset:1024
    s_add_u32 s50, s50, 1
    s_cmp_ge_u32 s50, 5
    s_cbranch_scc1 TAIL
    s_waitcnt lgkmcnt(6)
    v_readfirstlane_b32 s66, v252
    s_add_u32 s53, s53, 1
    v_mov_b32 v252, s53
    s_cmp_le_u32 s53, s66
    ds_write2_b32 v251, v252, v252 offset0:0 offset1:8
    s_setprio 1
    s_cbranch_scc1 PRIO_11
    s_setprio 0
PRIO_11:
    s_cmp_eq_u32 s52, 4
    s_cbranch_scc1 ITEM_1_4
    s_cmp_eq_u32 s52, 5
    s_cbranch_scc1 ITEM_1_5
    s_cmp_eq_u32 s52, 3
    s_cbranch_scc1 ITEM_1_3
    s_cmp_eq_u32 s52, 6
    s_cbranch_scc1 ITEM_1_6
    s_cmp_eq_u32 s52, 8
    s_cbranch_scc1 ITEM_1_8
    s_branch ITEM_1_2
.p2align 6
ITEM_1_3:
    s_mov_b64 exec, s[54:55]
    ds_read_u16_d16_hi v243, v250 offset:128
    s_mov_b64 exec, -1
    ds_read_b64_tr_b16 v[76:77], v249 offset:512
    s_waitcnt lgkmcnt(2)
    v_lshlrev_b32 v196, 16, v68
    v_and_b32 v197, 0xffff0000, v68
    v_lshlrev_b32 v198, 16, v69
    v_and_b32 v199, 0xffff0000, v69
    v_mul_f32_dpp v200, v242, v196 row_newbcast:0 row_mask:0xf bank_mask:0xf
    v_mul_f32_dpp v201, v242, v197 row_newbcast:1 row_mask:0xf bank_mask:0xf
    v_mul_f32_dpp v202, v242, v196 row_newbcast:8 row_mask:0xf bank_mask:0xf
    v_mul_f32_dpp v203, v242, v197 row_newbcast:9 row_mask:0xf bank_mask:0xf
    v_lshlrev_b32 v196, 16, v70
    v_and_b32 v197, 0xffff0000, v70
    v_cvt_pk_bf16_f32 v64, v200, v201
    v_cvt_pk_bf16_f32 v68, v202, v203
    v_mul_f32_dpp v200, v242, v198 row_newbcast:2 row_mask:0xf bank_mask:0xf
    v_mul_f32_dpp v201, v242, v199 row_newbcast:3 row_mask:0xf bank_mask:0xf
    v_mul_f32_dpp v202, v242, v198 row_newbcast:10 row_mask:0xf bank_mask:0xf
    v_mul_f32_dpp v203, v242, v199 row_newbcast:11 row_mask:0xf bank_mask:0xf
    v_lshlrev_b32 v198, 16, v71
    v_and_b32 v199, 0xffff0000, v71
    v_cvt_pk_bf16_f32 v65, v200, v201
    v_cvt_pk_bf16_f32 v69, v202, v203
    v_mul_f32_dpp v200, v242, v196 row_newbcast:4 row_mask:0xf bank_mask:0xf
    v_mul_f32_dpp v201, v242, v197 row_newbcast:5 row_mask:0xf bank_mask:0xf
    v_mul_f32_dpp v202, v242, v196 row_newbcast:12 row_mask:0xf bank_mask:0xf
    v_mul_f32_dpp v203, v242, v197 row_newbcast:13 row_mask:0xf bank_mask:0xf
    v_cvt_pk_bf16_f32 v66, v200, v201
    v_cvt_pk_bf16_f32 v70, v202, v203
    v_mul_f32_dpp v200, v242, v198 row_newbcast:6 row_mask:0xf bank_mask:0xf
    v_mul_f32_dpp v201, v242, v199 row_newbcast:7 row_mask:0xf bank_mask:0xf
    v_mul_f32_dpp v202, v242, v198 row_newbcast:14 row_mask:0xf bank_mask:0xf
    v_mul_f32_dpp v203, v242, v199 row_newbcast:15 row_mask:0xf bank_mask:0xf
    v_cvt_pk_bf16_f32 v67, v200, v201
    v_cvt_pk_bf16_f32 v71, v202, v203
    s_nop 0
    s_waitcnt vmcnt(4) lgkmcnt(0)
    v_mfma_f32_32x32x16_bf16 v[0:15], v[64:67], v[176:179], 0
    v_lshlrev_b32 v196, 16, v76
    v_and_b32 v197, 0xffff0000, v76
    v_lshlrev_b32 v198, 16, v77
    v_and_b32 v199, 0xffff0000, v77
    v_mul_f32_dpp v200, v243, v196 row_newbcast:0 row_mask:0xf bank_mask:0xf
    v_mul_f32_dpp v201, v243, v197 row_newbcast:1 row_mask:0xf bank_mask:0xf
    v_mul_f32_dpp v202, v243, v196 row_newbcast:8 row_mask:0xf bank_mask:0xf
    v_mul_f32_dpp v203, v243, v197 row_newbcast:9 row_mask:0xf bank_mask:0xf
    s_add_u32 m0, s21, 0
    v_mfma_f32_32x32x16_bf16 v[16:31], v[68:71], v[176:179], 0
    buffer_load_dwordx4 v234, s[4:7], s36 offen lds
    buffer_load_dwordx4 v235, s[8:11], s36 offen offset:1024 lds
    ds_read_b64_tr_b16 v[176:177], v244 offset:2048
    ds_read_b64_tr_b16 v[184:185], v245 offset:2048
    v_cvt_pk_bf16_f32 v72, v200, v201
    v_cvt_pk_bf16_f32 v76, v202, v203
    v_mul_f32_dpp v200, v243, v198 row_newbcast:2 row_mask:0xf bank_mask:0xf
    v_mul_f32_dpp v201, v243, v199 row_newbcast:3 row_mask:0xf bank_mask:0xf
    v_mul_f32_dpp v202, v243, v198 row_newbcast:10 row_mask:0xf bank_mask:0xf
    v_mul_f32_dpp v203, v243, v199 row_newbcast:11 row_mask:0xf bank_mask:0xf
    v_cvt_pk_bf16_f32 v73, v200, v201
    v_cvt_pk_bf16_f32 v77, v202, v203
    s_nop 0
    s_waitcnt lgkmcnt(0)
    v_mfma_f32_32x32x8_bf16 v[0:15], v[72:73], v[176:177], v[0:15]
    s_add_u32 m0, s21, 2048
    v_mfma_f32_32x32x8_bf16 v[16:31], v[76:77], v[176:177], v[16:31]
    buffer_load_dwordx4 v236, s[4:7], s36 offen lds
    s_mov_b32 m0, s50
    s_nop 0
    s_movrels_b32 s71, s23
    s_movrels_b32 s33, s28
    s_and_b32 s70, s33, 0x70
    s_andn2_b32 s33, s33, 0x70
    v_xor_b32 v253, s70, v248
    v_add_u32 v253, s33, v253
    s_bfe_u32 s46, s71, 0x30012
    s_mov_b32 m0, s46
    s_and_b32 s66, s71, 0x3ffff
    s_movrels_b32 s68, s57
    s_movrels_b32 s69, s61
    s_sub_u32 s48, s66, s47
    s_mov_b32 s47, s66
    s_lshr_b32 s52, s71, 28
    s_lshl_b32 s67, s46, 9
    s_add_u32 s66, s66, s67
    s_sub_u32 s49, s66, s42
    s_mov_b32 s42, s66
    s_bfe_u32 s66, s68, 655360
    s_add_u32 s43, s42, s66
    s_bfe_u32 s39, s69, 655360
    s_bfe_u32 s66, s68, 655370
    s_add_u32 s44, s42, s66
    s_bfe_u32 s40, s69, 655370
    s_bfe_u32 s66, s68, 655380
    s_add_u32 s45, s42, s66
    s_bfe_u32 s41, s69, 655380
    v_add_u32 v252, s44, v247
    ds_read_u16 v238, v252
    ds_read_u16 v239, v252 offset:64
    v_add_u32 v252, s45, v247
    ds_read_u16 v240, v252
    ds_read_u16 v241, v252 offset:64
    v_mfma_f32_32x32x16_bf16 v[32:47], v[64:67], v[180:183], 0
    v_mul_f32 v196, v0, v96
    v_fmac_f32 v196, v1, v97
    v_fmac_f32 v196, v2, v98
    v_fmac_f32 v196, v3, v99
    v_fmac_f32 v196, v4, v100
    v_fmac_f32 v196, v5, v101
    v_fmac_f32 v196, v6, v102
    v_fmac_f32 v196, v7, v103
    v_mul_f32 v198, v8, v128
    v_fmac_f32 v198, v9, v129
    v_mfma_f32_32x32x16_bf16 v[48:63], v[68:71], v[180:183], 0
    s_waitcnt vmcnt(5)
    ds_read_b64_tr_b16 v[176:177], v244 offset:4096
    ds_read_b64_tr_b16 v[178:179], v244 offset:5120
    ds_read_b64_tr_b16 v[180:181], v245 offset:4096
    ds_read_b64_tr_b16 v[182:183], v245 offset:5120
    v_fmac_f32 v198, v10, v130
    v_fmac_f32 v198, v11, v131
    v_fmac_f32 v198, v12, v132
    v_fmac_f32 v198, v13, v133
    v_fmac_f32 v198, v14, v134
    v_fmac_f32 v198, v15, v135
    v_mul_f32 v200, v16, v128
    v_fmac_f32 v200, v17, v129
    v_permlane32_swap_b32 v196, v198
    v_mfma_f32_32x32x8_bf16 v[32:47], v[72:73], v[184:185], v[32:47]
    v_fmac_f32 v200, v18, v130
    v_fmac_f32 v200, v19, v131
    v_fmac_f32 v200, v20, v132
    v_fmac_f32 v200, v21, v133
    v_fmac_f32 v200, v22, v134
    v_fmac_f32 v200, v23, v135
    v_add_f32 v198, v196, v198
    v_mul_f32_e64 v202, v24, -v128
    v_fma_f32 v202, v25, -v129, v202
    v_mfma_f32_32x32x8_bf16 v[48:63], v[76:77], v[184:185], v[48:63]
    v_fma_f32 v202, v26, -v130, v202
    v_fma_f32 v202, v27, -v131, v202
    v_fma_f32 v202, v28, -v132, v202
    v_fma_f32 v202, v29, -v133, v202
    v_fma_f32 v202, v30, -v134, v202
    v_fma_f32 v202, v31, -v135, v202
    s_nop 1
    v_permlane32_swap_b32 v200, v202
    v_add_f32 v202, v200, v202
    s_waitcnt vmcnt(3) lgkmcnt(0)
    v_mfma_f32_32x32x16_bf16 v[0:15], v[64:67], v[176:179], 0
    v_mul_f32 v197, v32, v104
    v_fmac_f32 v197, v33, v105
    v_fmac_f32 v197, v34, v106
    v_fmac_f32 v197, v35, v107
    v_fmac_f32 v197, v36, v108
    v_fmac_f32 v197, v37, v109
    v_fmac_f32 v197, v38, v110
    v_fmac_f32 v197, v39, v111
    v_mul_f32 v199, v40, v136
    v_fmac_f32 v199, v41, v137
    v_fmac_f32 v199, v42, v138
    s_add_u32 m0, s21, 4096
    v_mfma_f32_32x32x16_bf16 v[16:31], v[68:71], v[176:179], 0
    buffer_load_dwordx4 v234, s[4:7], s37 offen lds
    buffer_load_dwordx4 v235, s[8:11], s37 offen offset:1024 lds
    ds_read_b64_tr_b16 v[176:177], v244 offset:6144
    ds_read_b64_tr_b16 v[184:185], v245 offset:6144
    v_add_u32 v252, s42, v247
    ds_read_u16 v234, v252
    ds_read_u16 v235, v252 offset:64
    v_fmac_f32 v199, v43, v139
    v_fmac_f32 v199, v44, v140
    v_fmac_f32 v199, v45, v141
    v_fmac_f32 v199, v46, v142
    v_fmac_f32 v199, v47, v143
    v_mul_f32 v201, v48, v136
    v_fmac_f32 v201, v49, v137
    v_permlane32_swap_b32 v197, v199
    v_fmac_f32 v201, v50, v138
    v_fmac_f32 v201, v51, v139
    s_waitcnt lgkmcnt(2)
    v_mfma_f32_32x32x8_bf16 v[0:15], v[72:73], v[176:177], v[0:15]
    v_fmac_f32 v201, v52, v140
    v_fmac_f32 v201, v53, v141
    v_fmac_f32 v201, v54, v142
    v_fmac_f32 v201, v55, v143
    v_add_f32 v199, v197, v199
    v_mul_f32_e64 v203, v56, -v136
    v_fma_f32 v203, v57, -v137, v203
    v_fma_f32 v203, v58, -v138, v203
    v_fma_f32 v203, v59, -v139, v203
    v_fma_f32 v203, v60, -v140, v203
    s_add_u32 m0, s21, 6144
    v_mfma_f32_32x32x8_bf16 v[16:31], v[76:77], v[176:177], v[16:31]
    buffer_load_dwordx4 v236, s[4:7], s37 offen lds
    v_add_u32 v252, s43, v247
    ds_read_u16 v236, v252
    ds_read_u16 v237, v252 offset:64
    v_fma_f32 v203, v61, -v141, v203
    v_fma_f32 v203, v62, -v142, v203
    v_fma_f32 v203, v63, -v143, v203
    s_nop 1
    v_permlane32_swap_b32 v201, v203
    v_add_f32 v203, v201, v203
    v_cvt_pk_bf16_f32 v198, v198, v199
    v_cvt_pk_bf16_f32 v202, v202, v203
    ds_write_b32 v253, v198 offset:0
    ds_write_b32 v253, v202 offset:256
    v_mfma_f32_32x32x16_bf16 v[32:47], v[64:67], v[180:183], 0
    v_mul_f32 v196, v0, v144
    v_fmac_f32 v196, v1, v145
    v_fmac_f32 v196, v2, v146
    v_fmac_f32 v196, v3, v147
    v_fmac_f32 v196, v4, v148
    v_fmac_f32 v196, v5, v149
    v_fmac_f32 v196, v6, v150
    v_fmac_f32 v196, v7, v151
    v_mfma_f32_32x32x16_bf16 v[48:63], v[68:71], v[180:183], 0
    s_waitcnt vmcnt(4)
    ds_read_b64_tr_b16 v[176:177], v244 offset:0
    ds_read_b64_tr_b16 v[178:179], v244 offset:1024
    ds_read_b64_tr_b16 v[180:181], v245 offset:0
    ds_read_b64_tr_b16 v[182:183], v245 offset:1024
    v_mul_f32 v198, v8, v112
    v_fmac_f32 v198, v9, v113
    v_fmac_f32 v198, v10, v114
    v_fmac_f32 v198, v11, v115
    v_fmac_f32 v198, v12, v116
    v_fmac_f32 v198, v13, v117
    v_fmac_f32 v198, v14, v118
    v_fmac_f32 v198, v15, v119
    v_mfma_f32_32x32x8_bf16 v[32:47], v[72:73], v[184:185], v[32:47]
    v_mul_f32_e64 v200, v16, -v160
    v_fma_f32 v200, v17, -v161, v200
    v_fma_f32 v200, v18, -v162, v200
    v_fma_f32 v200, v19, -v163, v200
    v_fma_f32 v200, v20, -v164, v200
    v_fma_f32 v200, v21, -v165, v200
    v_fma_f32 v200, v22, -v166, v200
    v_fma_f32 v200, v23, -v167, v200
    v_mfma_f32_32x32x8_bf16 v[48:63], v[76:77], v[184:185], v[48:63]
    v_mul_f32_e64 v202, v24, -v160
    v_fma_f32 v202, v25, -v161, v202
    v_fma_f32 v202, v26, -v162, v202
    v_fma_f32 v202, v27, -v163, v202
    v_fma_f32 v202, v28, -v164, v202
    v_fma_f32 v202, v29, -v165, v202
    v_fma_f32 v202, v30, -v166, v202
    v_fma_f32 v202, v31, -v167, v202
    s_waitcnt vmcnt(3) lgkmcnt(0)
    v_mfma_f32_32x32x16_bf16 v[0:15], v[64:67], v[176:179], 0
    v_mul_f32 v197, v32, v152
    v_fmac_f32 v197, v33, v153
    v_fmac_f32 v197, v34, v154
    v_fmac_f32 v197, v35, v155
    v_fmac_f32 v197, v36, v156
    v_fmac_f32 v197, v37, v157
    v_fmac_f32 v197, v38, v158
    v_fmac_f32 v197, v39, v159
    s_add_u32 m0, s21, 0
    v_mfma_f32_32x32x16_bf16 v[16:31], v[68:71], v[176:179], 0
    v_lshl_add_u32 v234, v234, 10, v246
    v_lshl_add_u32 v235, v235, 10, v246
    buffer_load_dwordx4 v234, s[4:7], s38 offen lds
    buffer_load_dwordx4 v235, s[8:11], s38 offen offset:1024 lds
    ds_read_b64_tr_b16 v[176:177], v244 offset:2048
    ds_read_b64_tr_b16 v[184:185], v245 offset:2048
    v_mul_f32 v199, v40, v120
    v_fmac_f32 v199, v41, v121
    v_fmac_f32 v199, v42, v122
    v_fmac_f32 v199, v43, v123
    v_fmac_f32 v199, v44, v124
    v_fmac_f32 v199, v45, v125
    v_fmac_f32 v199, v46, v126
    v_fmac_f32 v199, v47, v127
    s_waitcnt lgkmcnt(0)
    v_mfma_f32_32x32x8_bf16 v[0:15], v[72:73], v[176:177], v[0:15]
    v_mul_f32_e64 v201, v48, -v168
    v_fma_f32 v201, v49, -v169, v201
    v_fma_f32 v201, v50, -v170, v201
    v_fma_f32 v201, v51, -v171, v201
    v_fma_f32 v201, v52, -v172, v201
    v_fma_f32 v201, v53, -v173, v201
    v_fma_f32 v201, v54, -v174, v201
    v_fma_f32 v201, v55, -v175, v201
    s_add_u32 m0, s21, 2048
    v_mfma_f32_32x32x8_bf16 v[16:31], v[76:77], v[176:177], v[16:31]
    v_lshl_add_u32 v236, v236, 10, v246
    v_lshl_add_u32 v237, v237, 10, v246
    buffer_load_dwordx4 v236, s[4:7], s39 offen lds
    buffer_load_dwordx4 v237, s[8:11], s39 offen offset:1024 lds
    v_mul_f32_e64 v203, v56, -v168
    v_fma_f32 v203, v57, -v169, v203
    v_fma_f32 v203, v58, -v170, v203
    v_fma_f32 v203, v59, -v171, v203
    v_fma_f32 v203, v60, -v172, v203
    v_fma_f32 v203, v61, -v173, v203
    v_fma_f32 v203, v62, -v174, v203
    v_fma_f32 v203, v63, -v175, v203
    v_mfma_f32_32x32x16_bf16 v[32:47], v[64:67], v[180:183], 0
    v_mul_f32 v254, v0, v144
    v_fmac_f32 v254, v1, v145
    v_fmac_f32 v254, v2, v146
    v_fmac_f32 v254, v3, v147
    v_fmac_f32 v254, v4, v148
    v_mfma_f32_32x32x16_bf16 v[48:63], v[68:71], v[180:183], 0
    ds_swizzle_b32 v68, v68 offset:0x401F
    ds_swizzle_b32 v69, v69 offset:0x401F
    ds_swizzle_b32 v70, v70 offset:0x401F
    ds_swizzle_b32 v71, v71 offset:0x401F
    s_waitcnt vmcnt(5)
    ds_read_b64_tr_b16 v[176:177], v244 offset:4096
    ds_read_b64_tr_b16 v[178:179], v244 offset:5120
    ds_read_b64_tr_b16 v[180:181], v245 offset:4096
    ds_read_b64_tr_b16 v[182:183], v245 offset:5120
    v_fmac_f32 v254, v5, v149
    v_fmac_f32 v254, v6, v150
    v_fmac_f32 v254, v7, v151
    v_fmac_f32 v200, v8, v160
    v_mfma_f32_32x32x8_bf16 v[32:47], v[72:73], v[184:185], v[32:47]
    v_fmac_f32 v200, v9, v161
    v_permlane32_swap_b32 v196, v254
    v_fmac_f32 v200, v10, v162
    v_fmac_f32 v200, v11, v163
    v_fmac_f32 v200, v12, v164
    v_mfma_f32_32x32x8_bf16 v[48:63], v[76:77], v[184:185], v[48:63]
    ds_swizzle_b32 v76, v76 offset:0x401F
    ds_swizzle_b32 v77, v77 offset:0x401F
    v_fmac_f32 v200, v13, v165
    v_fmac_f32 v200, v14, v166
    v_fmac_f32 v200, v15, v167
    v_add_f32 v254, v196, v254
    s_waitcnt lgkmcnt(6)
    s_mov_b64 exec, s[56:57]
    v_xor_b32 v68, 0x80008000, v68
    v_xor_b32 v69, 0x80008000, v69
    v_xor_b32 v70, 0x80008000, v70
    v_xor_b32 v71, 0x80008000, v71
    s_mov_b64 exec, -1
    s_waitcnt vmcnt(4) lgkmcnt(2)
    v_mfma_f32_32x32x16_bf16 v[0:15], v[64:67], v[176:179], 0
    v_mul_f32 v255, v32, v152
    v_fmac_f32 v255, v33, v153
    v_fmac_f32 v255, v34, v154
    v_fmac_f32 v255, v35, v155
    v_fmac_f32 v255, v36, v156
    s_add_u32 m0, s21, 4096
    v_mfma_f32_32x32x16_bf16 v[16:31], v[68:71], v[176:179], v[16:31]
    v_lshl_add_u32 v238, v238, 10, v246
    v_lshl_add_u32 v239, v239, 10, v246
    buffer_load_dwordx4 v238, s[4:7], s40 offen lds
    buffer_load_dwordx4 v239, s[8:11], s40 offen offset:1024 lds
    ds_read_b64_tr_b16 v[176:177], v244 offset:6144
    ds_read_b64_tr_b16 v[184:185], v245 offset:6144
    v_fmac_f32 v255, v37, v157
    v_fmac_f32 v255, v38, v158
    v_fmac_f32 v255, v39, v159
    v_fmac_f32 v201, v40, v168
    v_fmac_f32 v201, v41, v169
    s_waitcnt lgkmcnt(0)
    s_mov_b64 exec, s[56:57]
    v_xor_b32 v76, 0x80008000, v76
    v_xor_b32 v77, 0x80008000, v77
    s_mov_b64 exec, -1
    v_mfma_f32_32x32x8_bf16 v[0:15], v[72:73], v[176:177], v[0:15]
    v_permlane32_swap_b32 v197, v255
    v_fmac_f32 v201, v42, v170
    v_fmac_f32 v201, v43, v171
    v_fmac_f32 v201, v44, v172
    v_fmac_f32 v201, v45, v173
    s_add_u32 m0, s21, 6144
    v_mfma_f32_32x32x8_bf16 v[16:31], v[76:77], v[176:177], v[16:31]
    v_lshl_add_u32 v240, v240, 10, v246
    v_lshl_add_u32 v241, v241, 10, v246
    buffer_load_dwordx4 v240, s[4:7], s41 offen lds
    buffer_load_dwordx4 v241, s[8:11], s41 offen offset:1024 lds
    v_fmac_f32 v201, v46, v174
    v_fmac_f32 v201, v47, v175
    v_add_f32 v255, v197, v255
    v_cvt_pk_bf16_f32 v254, v254, v255
    ds_write_b32 v253, v254 offset:512
    v_mfma_f32_32x32x16_bf16 v[32:47], v[64:67], v[180:183], 0
    v_mul_f32 v254, v0, v144
    v_fmac_f32 v254, v1, v145
    v_fmac_f32 v254, v2, v146
    v_fmac_f32 v254, v3, v147
    v_fmac_f32 v254, v4, v148
    v_fmac_f32 v254, v5, v149
    v_fmac_f32 v254, v6, v150
    v_fmac_f32 v254, v7, v151
    v_fma_f32 v202, v8, -v160, v202
    v_fma_f32 v202, v9, -v161, v202
    v_mfma_f32_32x32x16_bf16 v[48:63], v[68:71], v[180:183], v[48:63]
    s_waitcnt vmcnt(6)
    ds_read_b64_tr_b16 v[176:177], v244 offset:0
    ds_read_b64_tr_b16 v[178:179], v244 offset:1024
    ds_read_b64_tr_b16 v[180:181], v245 offset:0
    ds_read_b64_tr_b16 v[182:183], v245 offset:1024
    v_permlane32_swap_b32 v254, v200
    v_fma_f32 v202, v10, -v162, v202
    v_fma_f32 v202, v11, -v163, v202
    v_fma_f32 v202, v12, -v164, v202
    v_fma_f32 v202, v13, -v165, v202
    v_fma_f32 v202, v14, -v166, v202
    v_fma_f32 v202, v15, -v167, v202
    v_add_f32 v200, v254, v200
    v_fmac_f32 v198, v16, v112
    v_permlane32_swap_b32 v202, v254
    v_mfma_f32_32x32x8_bf16 v[32:47], v[72:73], v[184:185], v[32:47]
    v_fmac_f32 v198, v17, v113
    v_fmac_f32 v198, v18, v114
    v_fmac_f32 v198, v19, v115
    v_fmac_f32 v198, v20, v116
    v_fmac_f32 v198, v21, v117
    v_fmac_f32 v198, v22, v118
    v_fmac_f32 v198, v23, v119
    v_add_f32 v254, v202, v254
    v_mul_f32 v196, v24, v160
    v_fmac_f32 v196, v25, v161
    v_mfma_f32_32x32x8_bf16 v[48:63], v[76:77], v[184:185], v[48:63]
    v_add_u32 v249, s48, v249
    v_add_u32 v250, s49, v250
    ds_read_b32 v252, v251 offset:16
    ds_read_b64_tr_b16 v[68:69], v249 offset:0
    ds_read_b64_tr_b16 v[70:71], v249 offset:256
    s_mov_b64 exec, s[54:55]
    ds_read_u16_d16_hi v242, v250 offset:0
    s_mov_b64 exec, -1
    v_fmac_f32 v196, v26, v162
    v_fmac_f32 v196, v27, v163
    v_fmac_f32 v196, v28, v164
    v_fmac_f32 v196, v29, v165
    v_fmac_f32 v196, v30, v166
    v_fmac_f32 v196, v31, v167
    s_nop 1
    v_permlane32_swap_b32 v198, v196
    v_add_f32 v196, v198, v196
    v_mul_f32 v255, v32, v152
    v_fmac_f32 v255, v33, v153
    v_fmac_f32 v255, v34, v154
    v_fmac_f32 v255, v35, v155
    v_fmac_f32 v255, v36, v156
    v_fmac_f32 v255, v37, v157
    v_fmac_f32 v255, v38, v158
    v_fmac_f32 v255, v39, v159
    v_fma_f32 v203, v40, -v168, v203
    v_fma_f32 v203, v41, -v169, v203
    v_permlane32_swap_b32 v255, v201
    v_fma_f32 v203, v42, -v170, v203
    v_fma_f32 v203, v43, -v171, v203
    v_fma_f32 v203, v44, -v172, v203
    v_fma_f32 v203, v45, -v173, v203
    v_fma_f32 v203, v46, -v174, v203
    v_fma_f32 v203, v47, -v175, v203
    v_add_f32 v201, v255, v201
    v_fmac_f32 v199, v48, v120
    v_permlane32_swap_b32 v203, v255
    v_fmac_f32 v199, v49, v121
    v_fmac_f32 v199, v50, v122
    v_fmac_f32 v199, v51, v123
    v_fmac_f32 v199, v52, v124
    v_fmac_f32 v199, v53, v125
    v_fmac_f32 v199, v54, v126
    v_fmac_f32 v199, v55, v127
    v_add_f32 v255, v203, v255
    v_mul_f32 v197, v56, v168
    v_fmac_f32 v197, v57, v169
    v_fmac_f32 v197, v58, v170
    v_fmac_f32 v197, v59, v171
    v_fmac_f32 v197, v60, v172
    v_fmac_f32 v197, v61, v173
    v_fmac_f32 v197, v62, v174
    v_fmac_f32 v197, v63, v175
    s_nop 1
    v_permlane32_swap_b32 v199, v197
    v_add_f32 v197, v199, v197
    v_cvt_pk_bf16_f32 v200, v200, v201
    v_cvt_pk_bf16_f32 v254, v254, v255
    v_cvt_pk_bf16_f32 v196, v196, v197
    ds_write_b32 v253, v200 offset:768
    s_mov_b64 exec, 0xffffffff
    ds_write_b32 v253, v254 offset:1280
    s_mov_b64 exec, -1
    ds_write_b32 v253, v196 offset:1024
    s_add_u32 s50, s50, 1
    s_cmp_ge_u32 s50, 5
    s_cbranch_scc1 TAIL
    s_waitcnt lgkmcnt(6)
    v_readfirstlane_b32 s66, v252
    s_add_u32 s53, s53, 1
    v_mov_b32 v252, s53
    s_cmp_le_u32 s53, s66
    ds_write2_b32 v251, v252, v252 offset0:0 offset1:8
    s_setprio 1
    s_cbranch_scc1 PRIO_12
    s_setprio 0
PRIO_12:
    s_cmp_eq_u32 s52, 4
    s_cbranch_scc1 ITEM_1_4
    s_cmp_eq_u32 s52, 5
    s_cbranch_scc1 ITEM_1_5
    s_cmp_eq_u32 s52, 3
    s_cbranch_scc1 ITEM_1_3
    s_cmp_eq_u32 s52, 6
    s_cbranch_scc1 ITEM_1_6
    s_cmp_eq_u32 s52, 8
    s_cbranch_scc1 ITEM_1_8
    s_branch ITEM_1_2
.p2align 6
ITEM_1_6:
    s_mov_b64 exec, s[54:55]
    ds_read_u16_d16_hi v243, v250 offset:128
    s_mov_b64 exec, -1
    ds_read_b64_tr_b16 v[76:77], v249 offset:512
    ds_read_b64_tr_b16 v[78:79], v249 offset:768
    ds_read_b64_tr_b16 v[84:85], v249 offset:1024
    ds_read_b64_tr_b16 v[86:87], v249 offset:1280
    s_waitcnt lgkmcnt(5)
    v_lshlrev_b32 v196, 16, v68
    v_and_b32 v197, 0xffff0000, v68
    v_lshlrev_b32 v198, 16, v69
    v_and_b32 v199, 0xffff0000, v69
    v_mul_f32_dpp v200, v242, v196 row_newbcast:0 row_mask:0xf bank_mask:0xf
    v_mul_f32_dpp v201, v242, v197 row_newbcast:1 row_mask:0xf bank_mask:0xf
    v_mul_f32_dpp v202, v242, v196 row_newbcast:8 row_mask:0xf bank_mask:0xf
    v_mul_f32_dpp v203, v242, v197 row_newbcast:9 row_mask:0xf bank_mask:0xf
    v_lshlrev_b32 v196, 16, v70
    v_and_b32 v197, 0xffff0000, v70
    v_cvt_pk_bf16_f32 v64, v200, v201
    v_cvt_pk_bf16_f32 v68, v202, v203
    v_mul_f32_dpp v200, v242, v198 row_newbcast:2 row_mask:0xf bank_mask:0xf
    v_mul_f32_dpp v201, v242, v199 row_newbcast:3 row_mask:0xf bank_mask:0xf
    v_mul_f32_dpp v202, v242, v198 row_newbcast:10 row_mask:0xf bank_mask:0xf
    v_mul_f32_dpp v203, v242, v199 row_newbcast:11 row_mask:0xf bank_mask:0xf
    v_lshlrev_b32 v198, 16, v71
    v_and_b32 v199, 0xffff0000, v71
    v_cvt_pk_bf16_f32 v65, v200, v201
    v_cvt_pk_bf16_f32 v69, v202, v203
    v_mul_f32_dpp v200, v242, v196 row_newbcast:4 row_mask:0xf bank_mask:0xf
    v_mul_f32_dpp v201, v242, v197 row_newbcast:5 row_mask:0xf bank_mask:0xf
    v_mul_f32_dpp v202, v242, v196 row_newbcast:12 row_mask:0xf bank_mask:0xf
    v_mul_f32_dpp v203, v242, v197 row_newbcast:13 row_mask:0xf bank_mask:0xf
    v_cvt_pk_bf16_f32 v66, v200, v201
    v_cvt_pk_bf16_f32 v70, v202, v203
    v_mul_f32_dpp v200, v242, v198 row_newbcast:6 row_mask:0xf bank_mask:0xf
    v_mul_f32_dpp v201, v242, v199 row_newbcast:7 row_mask:0xf bank_mask:0xf
    v_mul_f32_dpp v202, v242, v198 row_newbcast:14 row_mask:0xf bank_mask:0xf
    v_mul_f32_dpp v203, v242, v199 row_newbcast:15 row_mask:0xf bank_mask:0xf
    v_cvt_pk_bf16_f32 v67, v200, v201
    v_cvt_pk_bf16_f32 v71, v202, v203
    s_mov_b64 exec, s[54:55]
    ds_read_u16_d16_hi v242, v250 offset:256
    s_mov_b64 exec, -1
    s_waitcnt vmcnt(4) lgkmcnt(3)
    v_mfma_f32_32x32x16_bf16 v[0:15], v[64:67], v[176:179], 0
    v_lshlrev_b32 v196, 16, v76
    v_and_b32 v197, 0xffff0000, v76
    v_lshlrev_b32 v198, 16, v77
    v_and_b32 v199, 0xffff0000, v77
    v_mul_f32_dpp v200, v243, v196 row_newbcast:0 row_mask:0xf bank_mask:0xf
    v_mul_f32_dpp v201, v243, v197 row_newbcast:1 row_mask:0xf bank_mask:0xf
    v_mul_f32_dpp v202, v243, v196 row_newbcast:8 row_mask:0xf bank_mask:0xf
    v_mul_f32_dpp v203, v243, v197 row_newbcast:9 row_mask:0xf bank_mask:0xf
    v_lshlrev_b32 v196, 16, v78
    v_and_b32 v197, 0xffff0000, v78
    v_cvt_pk_bf16_f32 v72, v200, v201
    v_cvt_pk_bf16_f32 v76, v202, v203
    v_mul_f32_dpp v200, v243, v198 row_newbcast:2 row_mask:0xf bank_mask:0xf
    v_mul_f32_dpp v201, v243, v199 row_newbcast:3 row_mask:0xf bank_mask:0xf
    v_mul_f32_dpp v202, v243, v198 row_newbcast:10 row_mask:0xf bank_mask:0xf
    v_mul_f32_dpp v203, v243, v199 row_newbcast:11 row_mask:0xf bank_mask:0xf
    s_add_u32 m0, s21, 0
    v_mfma_f32_32x32x16_bf16 v[16:31], v[68:71], v[176:179], 0
    buffer_load_dwordx4 v236, s[4:7], s35 offen lds
    buffer_load_dwordx4 v237, s[8:11], s35 offen offset:1024 lds
    ds_read_b64_tr_b16 v[176:177], v244 offset:2048
    ds_read_b64_tr_b16 v[178:179], v244 offset:3072
    ds_read_b64_tr_b16 v[184:185], v245 offset:2048
    ds_read_b64_tr_b16 v[186:187], v245 offset:3072
    v_lshlrev_b32 v198, 16, v79
    v_and_b32 v199, 0xffff0000, v79
    v_cvt_pk_bf16_f32 v73, v200, v201
    v_cvt_pk_bf16_f32 v77, v202, v203
    v_mul_f32_dpp v200, v243, v196 row_newbcast:4 row_mask:0xf bank_mask:0xf
    v_mul_f32_dpp v201, v243, v197 row_newbcast:5 row_mask:0xf bank_mask:0xf
    v_mul_f32_dpp v202, v243, v196 row_newbcast:12 row_mask:0xf bank_mask:0xf
    v_mul_f32_dpp v203, v243, v197 row_newbcast:13 row_mask:0xf bank_mask:0xf
    v_cvt_pk_bf16_f32 v74, v200, v201
    v_cvt_pk_bf16_f32 v78, v202, v203
    v_mul_f32_dpp v200, v243, v198 row_newbcast:6 row_mask:0xf bank_mask:0xf
    v_mul_f32_dpp v201, v243, v199 row_newbcast:7 row_mask:0xf bank_mask:0xf
    v_mul_f32_dpp v202, v243, v198 row_newbcast:14 row_mask:0xf bank_mask:0xf
    v_mul_f32_dpp v203, v243, v199 row_newbcast:15 row_mask:0xf bank_mask:0xf
    v_cvt_pk_bf16_f32 v75, v200, v201
    v_cvt_pk_bf16_f32 v79, v202, v203
    s_nop 0
    s_waitcnt vmcnt(4) lgkmcnt(0)
    v_mfma_f32_32x32x16_bf16 v[0:15], v[72:75], v[176:179], v[0:15]
    v_lshlrev_b32 v196, 16, v84
    v_and_b32 v197, 0xffff0000, v84
    v_lshlrev_b32 v198, 16, v85
    v_and_b32 v199, 0xffff0000, v85
    v_mul_f32_dpp v200, v242, v196 row_newbcast:0 row_mask:0xf bank_mask:0xf
    v_mul_f32_dpp v201, v242, v197 row_newbcast:1 row_mask:0xf bank_mask:0xf
    v_mul_f32_dpp v202, v242, v196 row_newbcast:8 row_mask:0xf bank_mask:0xf
    v_mul_f32_dpp v203, v242, v197 row_newbcast:9 row_mask:0xf bank_mask:0xf
    v_lshlrev_b32 v196, 16, v86
    v_and_b32 v197, 0xffff0000, v86
    v_cvt_pk_bf16_f32 v80, v200, v201
    v_cvt_pk_bf16_f32 v84, v202, v203
    v_mul_f32_dpp v200, v242, v198 row_newbcast:2 row_mask:0xf bank_mask:0xf
    v_mul_f32_dpp v201, v242, v199 row_newbcast:3 row_mask:0xf bank_mask:0xf
    v_mul_f32_dpp v202, v242, v198 row_newbcast:10 row_mask:0xf bank_mask:0xf
    v_mul_f32_dpp v203, v242, v199 row_newbcast:11 row_mask:0xf bank_mask:0xf
    s_add_u32 m0, s21, 2048
    v_mfma_f32_32x32x16_bf16 v[16:31], v[76:79], v[176:179], v[16:31]
    buffer_load_dwordx4 v238, s[4:7], s35 offen lds
    buffer_load_dwordx4 v239, s[8:11], s35 offen offset:1024 lds
    ds_read_b64_tr_b16 v[176:177], v244 offset:4096
    ds_read_b64_tr_b16 v[178:179], v244 offset:5120
    ds_read_b64_tr_b16 v[188:189], v245 offset:4096
    ds_read_b64_tr_b16 v[190:191], v245 offset:5120
    v_lshlrev_b32 v198, 16, v87
    v_and_b32 v199, 0xffff0000, v87
    v_cvt_pk_bf16_f32 v81, v200, v201
    v_cvt_pk_bf16_f32 v85, v202, v203
    v_mul_f32_dpp v200, v242, v196 row_newbcast:4 row_mask:0xf bank_mask:0xf
    v_mul_f32_dpp v201, v242, v197 row_newbcast:5 row_mask:0xf bank_mask:0xf
    v_mul_f32_dpp v202, v242, v196 row_newbcast:12 row_mask:0xf bank_mask:0xf
    v_mul_f32_dpp v203, v242, v197 row_newbcast:13 row_mask:0xf bank_mask:0xf
    v_cvt_pk_bf16_f32 v82, v200, v201
    v_cvt_pk_bf16_f32 v86, v202, v203
    v_mul_f32_dpp v200, v242, v198 row_newbcast:6 row_mask:0xf bank_mask:0xf
    v_mul_f32_dpp v201, v242, v199 row_newbcast:7 row_mask:0xf bank_mask:0xf
    v_mul_f32_dpp v202, v242, v198 row_newbcast:14 row_mask:0xf bank_mask:0xf
    v_mul_f32_dpp v203, v242, v199 row_newbcast:15 row_mask:0xf bank_mask:0xf
    v_cvt_pk_bf16_f32 v83, v200, v201
    v_cvt_pk_bf16_f32 v87, v202, v203
    s_nop 0
    s_waitcnt lgkmcnt(0)
    v_mfma_f32_32x32x16_bf16 v[0:15], v[80:83], v[176:179], v[0:15]
    s_add_u32 m0, s21, 4096
    v_mfma_f32_32x32x16_bf16 v[16:31], v[84:87], v[176:179], v[16:31]
    buffer_load_dwordx4 v234, s[4:7], s36 offen lds
    buffer_load_dwordx4 v235, s[8:11], s36 offen offset:1024 lds
    s_mov_b32 m0, s50
    s_nop 0
    s_movrels_b32 s71, s23
    s_movrels_b32 s33, s28
    s_and_b32 s70, s33, 0x70
    s_andn2_b32 s33, s33, 0x70
    v_xor_b32 v253, s70, v248
    v_add_u32 v253, s33, v253
    s_bfe_u32 s46, s71, 0x30012
    s_mov_b32 m0, s46
    s_and_b32 s66, s71, 0x3ffff
    s_movrels_b32 s68, s57
    s_movrels_b32 s69, s61
    s_sub_u32 s48, s66, s47
    s_mov_b32 s47, s66
    s_lshr_b32 s52, s71, 28
    s_lshl_b32 s67, s46, 9
    s_add_u32 s66, s66, s67
    s_sub_u32 s49, s66, s42
    s_mov_b32 s42, s66
    s_bfe_u32 s66, s68, 655360
    s_add_u32 s43, s42, s66
    s_bfe_u32 s39, s69, 655360
    s_bfe_u32 s66, s68, 655370
    s_add_u32 s44, s42, s66
    s_bfe_u32 s40, s69, 655370
    s_bfe_u32 s66, s68, 655380
    s_add_u32 s45, s42, s66
    s_bfe_u32 s41, s69, 655380
    v_add_u32 v252, s45, v247
    ds_read_u16 v240, v252
    ds_read_u16 v241, v252 offset:64
    v_mfma_f32_32x32x16_bf16 v[32:47], v[64:67], v[180:183], 0
    v_mul_f32 v196, v0, v96
    v_fmac_f32 v196, v1, v97
    v_fmac_f32 v196, v2, v98
    v_fmac_f32 v196, v3, v99
    v_fmac_f32 v196, v4, v100
    v_fmac_f32 v196, v5, v101
    v_fmac_f32 v196, v6, v102
    v_mfma_f32_32x32x16_bf16 v[48:63], v[68:71], v[180:183], 0
    v_fmac_f32 v196, v7, v103
    v_mul_f32 v198, v8, v128
    v_fmac_f32 v198, v9, v129
    v_fmac_f32 v198, v10, v130
    v_fmac_f32 v198, v11, v131
    v_fmac_f32 v198, v12, v132
    v_mfma_f32_32x32x16_bf16 v[32:47], v[72:75], v[184:187], v[32:47]
    v_fmac_f32 v198, v13, v133
    v_fmac_f32 v198, v14, v134
    v_fmac_f32 v198, v15, v135
    v_mul_f32 v200, v16, v128
    v_fmac_f32 v200, v17, v129
    v_permlane32_swap_b32 v196, v198
    v_mfma_f32_32x32x16_bf16 v[48:63], v[76:79], v[184:187], v[48:63]
    s_waitcnt vmcnt(6)
    ds_read_b64_tr_b16 v[176:177], v244 offset:6144
    ds_read_b64_tr_b16 v[178:179], v244 offset:7168
    ds_read_b64_tr_b16 v[180:181], v245 offset:6144
    ds_read_b64_tr_b16 v[182:183], v245 offset:7168
    v_fmac_f32 v200, v18, v130
    v_fmac_f32 v200, v19, v131
    v_fmac_f32 v200, v20, v132
    v_fmac_f32 v200, v21, v133
    v_fmac_f32 v200, v22, v134
    v_fmac_f32 v200, v23, v135
    v_mfma_f32_32x32x16_bf16 v[32:47], v[80:83], v[188:191], v[32:47]
    v_add_f32 v198, v196, v198
    v_mul_f32_e64 v202, v24, -v128
    v_fma_f32 v202, v25, -v129, v202
    v_fma_f32 v202, v26, -v130, v202
    v_fma_f32 v202, v27, -v131, v202
    v_fma_f32 v202, v28, -v132, v202
    v_mfma_f32_32x32x16_bf16 v[48:63], v[84:87], v[188:191], v[48:63]
    v_fma_f32 v202, v29, -v133, v202
    v_fma_f32 v202, v30, -v134, v202
    v_fma_f32 v202, v31, -v135, v202
    s_nop 1
    v_permlane32_swap_b32 v200, v202
    v_add_f32 v202, v200, v202
    s_waitcnt vmcnt(4) lgkmcnt(0)
    v_mfma_f32_32x32x16_bf16 v[0:15], v[64:67], v[176:179], 0
    v_mul_f32 v197, v32, v104
    v_fmac_f32 v197, v33, v105
    v_fmac_f32 v197, v34, v106
    v_fmac_f32 v197, v35, v107
    v_fmac_f32 v197, v36, v108
    v_fmac_f32 v197, v37, v109
    v_fmac_f32 v197, v38, v110
    s_add_u32 m0, s21, 6144
    v_mfma_f32_32x32x16_bf16 v[16:31], v[68:71], v[176:179], 0
    buffer_load_dwordx4 v236, s[4:7], s36 offen lds
    buffer_load_dwordx4 v237, s[8:11], s36 offen offset:1024 lds
    ds_read_b64_tr_b16 v[176:177], v244 offset:0
    ds_read_b64_tr_b16 v[178:179], v244 offset:1024
    ds_read_b64_tr_b16 v[184:185], v245 offset:0
    ds_read_b64_tr_b16 v[186:187], v245 offset:1024
    v_fmac_f32 v197, v39, v111
    v_mul_f32 v199, v40, v136
    v_fmac_f32 v199, v41, v137
    v_fmac_f32 v199, v42, v138
    v_fmac_f32 v199, v43, v139
    v_fmac_f32 v199, v44, v140
    v_fmac_f32 v199, v45, v141
    s_waitcnt vmcnt(4) lgkmcnt(0)
    v_mfma_f32_32x32x16_bf16 v[0:15], v[72:75], v[176:179], v[0:15]
    v_fmac_f32 v199, v46, v142
    v_fmac_f32 v199, v47, v143
    v_mul_f32 v201, v48, v136
    v_fmac_f32 v201, v49, v137
    v_permlane32_swap_b32 v197, v199
    v_fmac_f32 v201, v50, v138
    v_fmac_f32 v201, v51, v139
    s_add_u32 m0, s21, 0
    v_mfma_f32_32x32x16_bf16 v[16:31], v[76:79], v[176:179], v[16:31]
    buffer_load_dwordx4 v238, s[4:7], s36 offen lds
    buffer_load_dwordx4 v239, s[8:11], s36 offen offset:1024 lds
    ds_read_b64_tr_b16 v[176:177], v244 offset:2048
    ds_read_b64_tr_b16 v[178:179], v244 offset:3072
    ds_read_b64_tr_b16 v[188:189], v245 offset:2048
    ds_read_b64_tr_b16 v[190:191], v245 offset:3072
    v_fmac_f32 v201, v52, v140
    v_fmac_f32 v201, v53, v141
    v_fmac_f32 v201, v54, v142
    v_fmac_f32 v201, v55, v143
    v_add_f32 v199, v197, v199
    v_mul_f32_e64 v203, v56, -v136
    v_fma_f32 v203, v57, -v137, v203
    s_waitcnt lgkmcnt(0)
    v_mfma_f32_32x32x16_bf16 v[0:15], v[80:83], v[176:179], v[0:15]
    v_fma_f32 v203, v58, -v138, v203
    v_fma_f32 v203, v59, -v139, v203
    v_fma_f32 v203, v60, -v140, v203
    v_fma_f32 v203, v61, -v141, v203
    v_fma_f32 v203, v62, -v142, v203
    v_fma_f32 v203, v63, -v143, v203
    s_nop 1
    s_add_u32 m0, s21, 2048
    v_mfma_f32_32x32x16_bf16 v[16:31], v[84:87], v[176:179], v[16:31]
    buffer_load_dwordx4 v234, s[4:7], s37 offen lds
    buffer_load_dwordx4 v235, s[8:11], s37 offen offset:1024 lds
    v_add_u32 v252, s42, v247
    ds_read_u16 v234, v252
    ds_read_u16 v235, v252 offset:64
    v_permlane32_swap_b32 v201, v203
    v_add_f32 v203, v201, v203
    v_cvt_pk_bf16_f32 v198, v198, v199
    v_cvt_pk_bf16_f32 v202, v202, v203
    ds_write_b32 v253, v198 offset:0
    ds_write_b32 v253, v202 offset:256
    v_mfma_f32_32x32x16_bf16 v[32:47], v[64:67], v[180:183], 0
    v_mul_f32 v196, v0, v144
    v_fmac_f32 v196, v1, v145
    v_fmac_f32 v196, v2, v146
    v_fmac_f32 v196, v3, v147
    v_fmac_f32 v196, v4, v148
    v_fmac_f32 v196, v5, v149
    v_mfma_f32_32x32x16_bf16 v[48:63], v[68:71], v[180:183], 0
    v_fmac_f32 v196, v6, v150
    v_fmac_f32 v196, v7, v151
    v_mul_f32 v198, v8, v112
    v_fmac_f32 v198, v9, v113
    v_fmac_f32 v198, v10, v114
    v_mfma_f32_32x32x16_bf16 v[32:47], v[72:75], v[184:187], v[32:47]
    v_fmac_f32 v198, v11, v115
    v_fmac_f32 v198, v12, v116
    v_fmac_f32 v198, v13, v117
    v_fmac_f32 v198, v14, v118
    v_fmac_f32 v198, v15, v119
    v_mfma_f32_32x32x16_bf16 v[48:63], v[76:79], v[184:187], v[48:63]
    s_waitcnt vmcnt(6)
    ds_read_b64_tr_b16 v[176:177], v244 offset:4096
    ds_read_b64_tr_b16 v[178:179], v244 offset:5120
    ds_read_b64_tr_b16 v[180:181], v245 offset:4096
    ds_read_b64_tr_b16 v[182:183], v245 offset:5120
    v_mul_f32_e64 v200, v16, -v160
    v_fma_f32 v200, v17, -v161, v200
    v_fma_f32 v200, v18, -v162, v200
    v_fma_f32 v200, v19, -v163, v200
    v_fma_f32 v200, v20, -v164, v200
    v_fma_f32 v200, v21, -v165, v200
    v_mfma_f32_32x32x16_bf16 v[32:47], v[80:83], v[188:191], v[32:47]
    v_fma_f32 v200, v22, -v166, v200
    v_fma_f32 v200, v23, -v167, v200
    v_mul_f32_e64 v202, v24, -v160
    v_fma_f32 v202, v25, -v161, v202
    v_fma_f32 v202, v26, -v162, v202
    v_mfma_f32_32x32x16_bf16 v[48:63], v[84:87], v[188:191], v[48:63]
    v_fma_f32 v202, v27, -v163, v202
    v_fma_f32 v202, v28, -v164, v202
    v_fma_f32 v202, v29, -v165, v202
    v_fma_f32 v202, v30, -v166, v202
    v_fma_f32 v202, v31, -v167, v202
    s_waitcnt vmcnt(4) lgkmcnt(0)
    v_mfma_f32_32x32x16_bf16 v[0:15], v[64:67], v[176:179], 0
    v_mul_f32 v197, v32, v152
    v_fmac_f32 v197, v33, v153
    v_fmac_f32 v197, v34, v154
    v_fmac_f32 v197, v35, v155
    v_fmac_f32 v197, v36, v156
    v_fmac_f32 v197, v37, v157
    s_add_u32 m0, s21, 4096
    v_mfma_f32_32x32x16_bf16 v[16:31], v[68:71], v[176:179], 0
    buffer_load_dwordx4 v236, s[4:7], s37 offen lds
    buffer_load_dwordx4 v237, s[8:11], s37 offen offset:1024 lds
    ds_read_b64_tr_b16 v[176:177], v244 offset:6144
    ds_read_b64_tr_b16 v[178:179], v244 offset:7168
    ds_read_b64_tr_b16 v[184:185], v245 offset:6144
    ds_read_b64_tr_b16 v[186:187], v245 offset:7168
    v_add_u32 v252, s43, v247
    ds_read_u16 v236, v252
    ds_read_u16 v237, v252 offset:64
    v_fmac_f32 v197, v38, v158
    v_fmac_f32 v197, v39, v159
    v_mul_f32 v199, v40, v120
    v_fmac_f32 v199, v41, v121
    v_fmac_f32 v199, v42, v122
    s_waitcnt vmcnt(4) lgkmcnt(2)
    v_mfma_f32_32x32x16_bf16 v[0:15], v[72:75], v[176:179], v[0:15]
    v_fmac_f32 v199, v43, v123
    v_fmac_f32 v199, v44, v124
    v_fmac_f32 v199, v45, v125
    v_fmac_f32 v199, v46, v126
    v_fmac_f32 v199, v47, v127
    s_add_u32 m0, s21, 6144
    v_mfma_f32_32x32x16_bf16 v[16:31], v[76:79], v[176:179], v[16:31]
    buffer_load_dwordx4 v238, s[4:7], s37 offen lds
    buffer_load_dwordx4 v239, s[8:11], s37 offen offset:1024 lds
    ds_read_b64_tr_b16 v[176:177], v244 offset:0
    ds_read_b64_tr_b16 v[178:179], v244 offset:1024
    ds_read_b64_tr_b16 v[188:189], v245 offset:0
    ds_read_b64_tr_b16 v[190:191], v245 offset:1024
    v_add_u32 v252, s44, v247
    ds_read_u16 v238, v252
    ds_read_u16 v239, v252 offset:64
    v_mul_f32_e64 v201, v48, -v168
    v_fma_f32 v201, v49, -v169, v201
    v_fma_f32 v201, v50, -v170, v201
    v_fma_f32 v201, v51, -v171, v201
    v_fma_f32 v201, v52, -v172, v201
    v_fma_f32 v201, v53, -v173, v201
    s_waitcnt lgkmcnt(2)
    v_mfma_f32_32x32x16_bf16 v[0:15], v[80:83], v[176:179], v[0:15]
    v_fma_f32 v201, v54, -v174, v201
    v_fma_f32 v201, v55, -v175, v201
    v_mul_f32_e64 v203, v56, -v168
    v_fma_f32 v203, v57, -v169, v203
    v_fma_f32 v203, v58, -v170, v203
    s_add_u32 m0, s21, 0
    v_mfma_f32_32x32x16_bf16 v[16:31], v[84:87], v[176:179], v[16:31]
    v_lshl_add_u32 v234, v234, 10, v246
    v_lshl_add_u32 v235, v235, 10, v246
    buffer_load_dwordx4 v234, s[4:7], s38 offen lds
    buffer_load_dwordx4 v235, s[8:11], s38 offen offset:1024 lds
    v_fma_f32 v203, v59, -v171, v203
    v_fma_f32 v203, v60, -v172, v203
    v_fma_f32 v203, v61, -v173, v203
    v_fma_f32 v203, v62, -v174, v203
    v_fma_f32 v203, v63, -v175, v203
    v_mfma_f32_32x32x16_bf16 v[32:47], v[64:67], v[180:183], 0
    v_mul_f32 v254, v0, v144
    v_fmac_f32 v254, v1, v145
    v_fmac_f32 v254, v2, v146
    v_mfma_f32_32x32x16_bf16 v[48:63], v[68:71], v[180:183], 0
    ds_swizzle_b32 v68, v68 offset:0x401F
    ds_swizzle_b32 v69, v69 offset:0x401F
    ds_swizzle_b32 v70, v70 offset:0x401F
    ds_swizzle_b32 v71, v71 offset:0x401F
    v_fmac_f32 v254, v3, v147
    v_fmac_f32 v254, v4, v148
    v_fmac_f32 v254, v5, v149
    v_mfma_f32_32x32x16_bf16 v[32:47], v[72:75], v[184:187], v[32:47]
    v_fmac_f32 v254, v6, v150
    v_fmac_f32 v254, v7, v151
    v_fmac_f32 v200, v8, v160
    v_mfma_f32_32x32x16_bf16 v[48:63], v[76:79], v[184:187], v[48:63]
    ds_swizzle_b32 v76, v76 offset:0x401F
    ds_swizzle_b32 v77, v77 offset:0x401F
    ds_swizzle_b32 v78, v78 offset:0x401F
    ds_swizzle_b32 v79, v79 offset:0x401F
    s_waitcnt vmcnt(6)
    ds_read_b64_tr_b16 v[176:177], v244 offset:2048
    ds_read_b64_tr_b16 v[178:179], v244 offset:3072
    ds_read_b64_tr_b16 v[180:181], v245 offset:2048
    ds_read_b64_tr_b16 v[182:183], v245 offset:3072
    v_fmac_f32 v200, v9, v161
    v_permlane32_swap_b32 v196, v254
    v_fmac_f32 v200, v10, v162
    v_mfma_f32_32x32x16_bf16 v[32:47], v[80:83], v[188:191], v[32:47]
    v_fmac_f32 v200, v11, v163
    v_fmac_f32 v200, v12, v164
    v_fmac_f32 v200, v13, v165
    v_mfma_f32_32x32x16_bf16 v[48:63], v[84:87], v[188:191], v[48:63]
    ds_swizzle_b32 v84, v84 offset:0x401F
    ds_swizzle_b32 v85, v85 offset:0x401F
    ds_swizzle_b32 v86, v86 offset:0x401F
    ds_swizzle_b32 v87, v87 offset:0x401F
    v_fmac_f32 v200, v14, v166
    v_fmac_f32 v200, v15, v167
    v_add_f32 v254, v196, v254
    s_waitcnt lgkmcnt(8)
    s_mov_b64 exec, s[56:57]
    v_xor_b32 v68, 0x80008000, v68
    v_xor_b32 v69, 0x80008000, v69
    v_xor_b32 v70, 0x80008000, v70
    v_xor_b32 v71, 0x80008000, v71
    v_xor_b32 v76, 0x80008000, v76
    v_xor_b32 v77, 0x80008000, v77
    v_xor_b32 v78, 0x80008000, v78
    v_xor_b32 v79, 0x80008000, v79
    s_mov_b64 exec, -1
    s_waitcnt vmcnt(4) lgkmcnt(4)
    v_mfma_f32_32x32x16_bf16 v[0:15], v[64:67], v[176:179], 0
    v_mul_f32 v255, v32, v152
    v_fmac_f32 v255, v33, v153
    v_fmac_f32 v255, v34, v154
    v_fmac_f32 v255, v35, v155
    s_add_u32 m0, s21, 2048
    v_mfma_f32_32x32x16_bf16 v[16:31], v[68:71], v[176:179], v[16:31]
    v_lshl_add_u32 v236, v236, 10, v246
    v_lshl_add_u32 v237, v237, 10, v246
    buffer_load_dwordx4 v236, s[4:7], s39 offen lds
    buffer_load_dwordx4 v237, s[8:11], s39 offen offset:1024 lds
    ds_read_b64_tr_b16 v[176:177], v244 offset:4096
    ds_read_b64_tr_b16 v[178:179], v244 offset:5120
    ds_read_b64_tr_b16 v[184:185], v245 offset:4096
    ds_read_b64_tr_b16 v[186:187], v245 offset:5120
    v_fmac_f32 v255, v36, v156
    v_fmac_f32 v255, v37, v157
    v_fmac_f32 v255, v38, v158
    s_waitcnt vmcnt(4) lgkmcnt(0)
    v_mfma_f32_32x32x16_bf16 v[0:15], v[72:75], v[176:179], v[0:15]
    v_fmac_f32 v255, v39, v159
    v_fmac_f32 v201, v40, v168
    v_fmac_f32 v201, v41, v169
    s_add_u32 m0, s21, 4096
    v_mfma_f32_32x32x16_bf16 v[16:31], v[76:79], v[176:179], v[16:31]
    v_lshl_add_u32 v238, v238, 10, v246
    v_lshl_add_u32 v239, v239, 10, v246
    buffer_load_dwordx4 v238, s[4:7], s40 offen lds
    buffer_load_dwordx4 v239, s[8:11], s40 offen offset:1024 lds
    ds_read_b64_tr_b16 v[176:177], v244 offset:6144
    ds_read_b64_tr_b16 v[178:179], v244 offset:7168
    ds_read_b64_tr_b16 v[188:189], v245 offset:6144
    ds_read_b64_tr_b16 v[190:191], v245 offset:7168
    v_permlane32_swap_b32 v197, v255
    v_fmac_f32 v201, v42, v170
    v_fmac_f32 v201, v43, v171
    v_fmac_f32 v201, v44, v172
    s_waitcnt lgkmcnt(0)
    s_mov_b64 exec, s[56:57]
    v_xor_b32 v84, 0x80008000, v84
    v_xor_b32 v85, 0x80008000, v85
    v_xor_b32 v86, 0x80008000, v86
    v_xor_b32 v87, 0x80008000, v87
    s_mov_b64 exec, -1
    v_mfma_f32_32x32x16_bf16 v[0:15], v[80:83], v[176:179], v[0:15]
    v_fmac_f32 v201, v45, v173
    v_fmac_f32 v201, v46, v174
    v_fmac_f32 v201, v47, v175
    s_add_u32 m0, s21, 6144
    v_mfma_f32_32x32x16_bf16 v[16:31], v[84:87], v[176:179], v[16:31]
    v_lshl_add_u32 v240, v240, 10, v246
    v_lshl_add_u32 v241, v241, 10, v246
    buffer_load_dwordx4 v240, s[4:7], s41 offen lds
    buffer_load_dwordx4 v241, s[8:11], s41 offen offset:1024 lds
    v_add_f32 v255, v197, v255
    v_cvt_pk_bf16_f32 v254, v254, v255
    ds_write_b32 v253, v254 offset:512
    v_mfma_f32_32x32x16_bf16 v[32:47], v[64:67], v[180:183], 0
    v_mul_f32 v254, v0, v144
    v_fmac_f32 v254, v1, v145
    v_fmac_f32 v254, v2, v146
    v_fmac_f32 v254, v3, v147
    v_fmac_f32 v254, v4, v148
    v_fmac_f32 v254, v5, v149
    v_fmac_f32 v254, v6, v150
    v_mfma_f32_32x32x16_bf16 v[48:63], v[68:71], v[180:183], v[48:63]
    v_fmac_f32 v254, v7, v151
    v_fma_f32 v202, v8, -v160, v202
    v_fma_f32 v202, v9, -v161, v202
    v_permlane32_swap_b32 v254, v200
    v_fma_f32 v202, v10, -v162, v202
    v_fma_f32 v202, v11, -v163, v202
    v_mfma_f32_32x32x16_bf16 v[32:47], v[72:75], v[184:187], v[32:47]
    v_fma_f32 v202, v12, -v164, v202
    v_fma_f32 v202, v13, -v165, v202
    v_fma_f32 v202, v14, -v166, v202
    v_fma_f32 v202, v15, -v167, v202
    v_add_f32 v200, v254, v200
    v_fmac_f32 v198, v16, v112
    v_permlane32_swap_b32 v202, v254
    v_mfma_f32_32x32x16_bf16 v[48:63], v[76:79], v[184:187], v[48:63]
    s_waitcnt vmcnt(6)
    ds_read_b64_tr_b16 v[176:177], v244 offset:0
    ds_read_b64_tr_b16 v[178:179], v244 offset:1024
    ds_read_b64_tr_b16 v[180:181], v245 offset:0
    ds_read_b64_tr_b16 v[182:183], v245 offset:1024
    v_fmac_f32 v198, v17, v113
    v_fmac_f32 v198, v18, v114
    v_fmac_f32 v198, v19, v115
    v_fmac_f32 v198, v20, v116
    v_fmac_f32 v198, v21, v117
    v_fmac_f32 v198, v22, v118
    v_mfma_f32_32x32x16_bf16 v[32:47], v[80:83], v[188:191], v[32:47]
    v_fmac_f32 v198, v23, v119
    v_add_f32 v254, v202, v254
    v_mul_f32 v196, v24, v160
    v_fmac_f32 v196, v25, v161
    v_fmac_f32 v196, v26, v162
    v_fmac_f32 v196, v27, v163
    v_fmac_f32 v196, v28, v164
    v_mfma_f32_32x32x16_bf16 v[48:63], v[84:87], v[188:191], v[48:63]
    v_add_u32 v249, s48, v249
    v_add_u32 v250, s49, v250
    ds_read_b32 v252, v251 offset:16
    ds_read_b64_tr_b16 v[68:69], v249 offset:0
    ds_read_b64_tr_b16 v[70:71], v249 offset:256
    s_mov_b64 exec, s[54:55]
    ds_read_u16_d16_hi v242, v250 offset:0
    s_mov_b64 exec, -1
    v_fmac_f32 v196, v29, v165
    v_fmac_f32 v196, v30, v166
    v_fmac_f32 v196, v31, v167
    s_nop 1
    v_permlane32_swap_b32 v198, v196
    v_add_f32 v196, v198, v196
    v_mul_f32 v255, v32, v152
    v_fmac_f32 v255, v33, v153
    v_fmac_f32 v255, v34, v154
    v_fmac_f32 v255, v35, v155
    v_fmac_f32 v255, v36, v156
    v_fmac_f32 v255, v37, v157
    v_fmac_f32 v255, v38, v158
    v_fmac_f32 v255, v39, v159
    v_fma_f32 v203, v40, -v168, v203
    v_fma_f32 v203, v41, -v169, v203
    v_permlane32_swap_b32 v255, v201
    v_fma_f32 v203, v42, -v170, v203
    v_fma_f32 v203, v43, -v171, v203
    v_fma_f32 v203, v44, -v172, v203
    v_fma_f32 v203, v45, -v173, v203
    v_fma_f32 v203, v46, -v174, v203
    v_fma_f32 v203, v47, -v175, v203
    v_add_f32 v201, v255, v201
    v_fmac_f32 v199, v48, v120
    v_permlane32_swap_b32 v203, v255
    v_fmac_f32 v199, v49, v121
    v_fmac_f32 v199, v50, v122
    v_fmac_f32 v199, v51, v123
    v_fmac_f32 v199, v52, v124
    v_fmac_f32 v199, v53, v125
    v_fmac_f32 v199, v54, v126
    v_fmac_f32 v199, v55, v127
    v_add_f32 v255, v203, v255
    v_mul_f32 v197, v56, v168
    v_fmac_f32 v197, v57, v169
    v_fmac_f32 v197, v58, v170
    v_fmac_f32 v197, v59, v171
    v_fmac_f32 v197, v60, v172
    v_fmac_f32 v197, v61, v173
    v_fmac_f32 v197, v62, v174
    v_fmac_f32 v197, v63, v175
    s_nop 1
    v_permlane32_swap_b32 v199, v197
    v_add_f32 v197, v199, v197
    v_cvt_pk_bf16_f32 v200, v200, v201
    v_cvt_pk_bf16_f32 v254, v254, v255
    v_cvt_pk_bf16_f32 v196, v196, v197
    ds_write_b32 v253, v200 offset:768
    s_mov_b64 exec, 0xffffffff
    ds_write_b32 v253, v254 offset:1280
    s_mov_b64 exec, -1
    ds_write_b32 v253, v196 offset:1024
    s_add_u32 s50, s50, 1
    s_cmp_ge_u32 s50, 5
    s_cbranch_scc1 TAIL
    s_waitcnt lgkmcnt(6)
    v_readfirstlane_b32 s66, v252
    s_add_u32 s53, s53, 1
    v_mov_b32 v252, s53
    s_cmp_le_u32 s53, s66
    ds_write2_b32 v251, v252, v252 offset0:0 offset1:8
    s_setprio 1
    s_cbranch_scc1 PRIO_13
    s_setprio 0
PRIO_13:
    s_cmp_eq_u32 s52, 4
    s_cbranch_scc1 ITEM_1_4
    s_cmp_eq_u32 s52, 5
    s_cbranch_scc1 ITEM_1_5
    s_cmp_eq_u32 s52, 3
    s_cbranch_scc1 ITEM_1_3
    s_cmp_eq_u32 s52, 6
    s_cbranch_scc1 ITEM_1_6
    s_cmp_eq_u32 s52, 8
    s_cbranch_scc1 ITEM_1_8
    s_branch ITEM_1_2
.p2align 6
ITEM_1_8:
    s_mov_b64 exec, s[54:55]
    ds_read_u16_d16_hi v243, v250 offset:128
    s_mov_b64 exec, -1
    ds_read_b64_tr_b16 v[76:77], v249 offset:512
    ds_read_b64_tr_b16 v[78:79], v249 offset:768
    ds_read_b64_tr_b16 v[84:85], v249 offset:1024
    ds_read_b64_tr_b16 v[86:87], v249 offset:1280
    ds_read_b64_tr_b16 v[92:93], v249 offset:1536
    ds_read_b64_tr_b16 v[94:95], v249 offset:1792
    s_waitcnt lgkmcnt(7)
    v_lshlrev_b32 v196, 16, v68
    v_and_b32 v197, 0xffff0000, v68
    v_lshlrev_b32 v198, 16, v69
    v_and_b32 v199, 0xffff0000, v69
    v_mul_f32_dpp v200, v242, v196 row_newbcast:0 row_mask:0xf bank_mask:0xf
    v_mul_f32_dpp v201, v242, v197 row_newbcast:1 row_mask:0xf bank_mask:0xf
    v_mul_f32_dpp v202, v242, v196 row_newbcast:8 row_mask:0xf bank_mask:0xf
    v_mul_f32_dpp v203, v242, v197 row_newbcast:9 row_mask:0xf bank_mask:0xf
    v_lshlrev_b32 v196, 16, v70
    v_and_b32 v197, 0xffff0000, v70
    v_cvt_pk_bf16_f32 v64, v200, v201
    v_cvt_pk_bf16_f32 v68, v202, v203
    v_mul_f32_dpp v200, v242, v198 row_newbcast:2 row_mask:0xf bank_mask:0xf
    v_mul_f32_dpp v201, v242, v199 row_newbcast:3 row_mask:0xf bank_mask:0xf
    v_mul_f32_dpp v202, v242, v198 row_newbcast:10 row_mask:0xf bank_mask:0xf
    v_mul_f32_dpp v203, v242, v199 row_newbcast:11 row_mask:0xf bank_mask:0xf
    v_lshlrev_b32 v198, 16, v71
    v_and_b32 v199, 0xffff0000, v71
    v_cvt_pk_bf16_f32 v65, v200, v201
    v_cvt_pk_bf16_f32 v69, v202, v203
    v_mul_f32_dpp v200, v242, v196 row_newbcast:4 row_mask:0xf bank_mask:0xf
    v_mul_f32_dpp v201, v242, v197 row_newbcast:5 row_mask:0xf bank_mask:0xf
    v_mul_f32_dpp v202, v242, v196 row_newbcast:12 row_mask:0xf bank_mask:0xf
    v_mul_f32_dpp v203, v242, v197 row_newbcast:13 row_mask:0xf bank_mask:0xf
    v_cvt_pk_bf16_f32 v66, v200, v201
    v_cvt_pk_bf16_f32 v70, v202, v203
    v_mul_f32_dpp v200, v242, v198 row_newbcast:6 row_mask:0xf bank_mask:0xf
    v_mul_f32_dpp v201, v242, v199 row_newbcast:7 row_mask:0xf bank_mask:0xf
    v_mul_f32_dpp v202, v242, v198 row_newbcast:14 row_mask:0xf bank_mask:0xf
    v_mul_f32_dpp v203, v242, v199 row_newbcast:15 row_mask:0xf bank_mask:0xf
    v_cvt_pk_bf16_f32 v67, v200, v201
    v_cvt_pk_bf16_f32 v71, v202, v203
    s_mov_b64 exec, s[54:55]
    ds_read_u16_d16_hi v242, v250 offset:256
    s_mov_b64 exec, -1
    s_waitcnt vmcnt(4) lgkmcnt(5)
    v_mfma_f32_32x32x16_bf16 v[0:15], v[64:67], v[176:179], 0
    v_lshlrev_b32 v196, 16, v76
    v_and_b32 v197, 0xffff0000, v76
    v_lshlrev_b32 v198, 16, v77
    v_and_b32 v199, 0xffff0000, v77
    v_mul_f32_dpp v200, v243, v196 row_newbcast:0 row_mask:0xf bank_mask:0xf
    v_mul_f32_dpp v201, v243, v197 row_newbcast:1 row_mask:0xf bank_mask:0xf
    v_mul_f32_dpp v202, v243, v196 row_newbcast:8 row_mask:0xf bank_mask:0xf
    v_mul_f32_dpp v203, v243, v197 row_newbcast:9 row_mask:0xf bank_mask:0xf
    v_lshlrev_b32 v196, 16, v78
    v_and_b32 v197, 0xffff0000, v78
    v_cvt_pk_bf16_f32 v72, v200, v201
    v_cvt_pk_bf16_f32 v76, v202, v203
    v_mul_f32_dpp v200, v243, v198 row_newbcast:2 row_mask:0xf bank_mask:0xf
    v_mul_f32_dpp v201, v243, v199 row_newbcast:3 row_mask:0xf bank_mask:0xf
    v_mul_f32_dpp v202, v243, v198 row_newbcast:10 row_mask:0xf bank_mask:0xf
    v_mul_f32_dpp v203, v243, v199 row_newbcast:11 row_mask:0xf bank_mask:0xf
    s_add_u32 m0, s21, 0
    v_mfma_f32_32x32x16_bf16 v[16:31], v[68:71], v[176:179], 0
    buffer_load_dwordx4 v234, s[4:7], s35 offen lds
    buffer_load_dwordx4 v235, s[8:11], s35 offen offset:1024 lds
    ds_read_b64_tr_b16 v[176:177], v244 offset:2048
    ds_read_b64_tr_b16 v[178:179], v244 offset:3072
    ds_read_b64_tr_b16 v[184:185], v245 offset:2048
    ds_read_b64_tr_b16 v[186:187], v245 offset:3072
    v_lshlrev_b32 v198, 16, v79
    v_and_b32 v199, 0xffff0000, v79
    v_cvt_pk_bf16_f32 v73, v200, v201
    v_cvt_pk_bf16_f32 v77, v202, v203
    v_mul_f32_dpp v200, v243, v196 row_newbcast:4 row_mask:0xf bank_mask:0xf
    v_mul_f32_dpp v201, v243, v197 row_newbcast:5 row_mask:0xf bank_mask:0xf
    v_mul_f32_dpp v202, v243, v196 row_newbcast:12 row_mask:0xf bank_mask:0xf
    v_mul_f32_dpp v203, v243, v197 row_newbcast:13 row_mask:0xf bank_mask:0xf
    v_cvt_pk_bf16_f32 v74, v200, v201
    v_cvt_pk_bf16_f32 v78, v202, v203
    v_mul_f32_dpp v200, v243, v198 row_newbcast:6 row_mask:0xf bank_mask:0xf
    v_mul_f32_dpp v201, v243, v199 row_newbcast:7 row_mask:0xf bank_mask:0xf
    v_mul_f32_dpp v202, v243, v198 row_newbcast:14 row_mask:0xf bank_mask:0xf
    v_mul_f32_dpp v203, v243, v199 row_newbcast:15 row_mask:0xf bank_mask:0xf
    v_cvt_pk_bf16_f32 v75, v200, v201
    v_cvt_pk_bf16_f32 v79, v202, v203
    s_mov_b64 exec, s[54:55]
    ds_read_u16_d16_hi v243, v250 offset:384
    s_mov_b64 exec, -1
    s_waitcnt vmcnt(4) lgkmcnt(1)
    v_mfma_f32_32x32x16_bf16 v[0:15], v[72:75], v[176:179], v[0:15]
    v_lshlrev_b32 v196, 16, v84
    v_and_b32 v197, 0xffff0000, v84
    v_lshlrev_b32 v198, 16, v85
    v_and_b32 v199, 0xffff0000, v85
    v_mul_f32_dpp v200, v242, v196 row_newbcast:0 row_mask:0xf bank_mask:0xf
    v_mul_f32_dpp v201, v242, v197 row_newbcast:1 row_mask:0xf bank_mask:0xf
    v_mul_f32_dpp v202, v242, v196 row_newbcast:8 row_mask:0xf bank_mask:0xf
    v_mul_f32_dpp v203, v242, v197 row_newbcast:9 row_mask:0xf bank_mask:0xf
    v_lshlrev_b32 v196, 16, v86
    v_and_b32 v197, 0xffff0000, v86
    v_cvt_pk_bf16_f32 v80, v200, v201
    v_cvt_pk_bf16_f32 v84, v202, v203
    v_mul_f32_dpp v200, v242, v198 row_newbcast:2 row_mask:0xf bank_mask:0xf
    v_mul_f32_dpp v201, v242, v199 row_newbcast:3 row_mask:0xf bank_mask:0xf
    v_mul_f32_dpp v202, v242, v198 row_newbcast:10 row_mask:0xf bank_mask:0xf
    v_mul_f32_dpp v203, v242, v199 row_newbcast:11 row_mask:0xf bank_mask:0xf
    s_add_u32 m0, s21, 2048
    v_mfma_f32_32x32x16_bf16 v[16:31], v[76:79], v[176:179], v[16:31]
    buffer_load_dwordx4 v236, s[4:7], s35 offen lds
    buffer_load_dwordx4 v237, s[8:11], s35 offen offset:1024 lds
    ds_read_b64_tr_b16 v[176:177], v244 offset:4096
    ds_read_b64_tr_b16 v[178:179], v244 offset:5120
    ds_read_b64_tr_b16 v[188:189], v245 offset:4096
    ds_read_b64_tr_b16 v[190:191], v245 offset:5120
    v_lshlrev_b32 v198, 16, v87
    v_and_b32 v199, 0xffff0000, v87
    v_cvt_pk_bf16_f32 v81, v200, v201
    v_cvt_pk_bf16_f32 v85, v202, v203
    v_mul_f32_dpp v200, v242, v196 row_newbcast:4 row_mask:0xf bank_mask:0xf
    v_mul_f32_dpp v201, v242, v197 row_newbcast:5 row_mask:0xf bank_mask:0xf
    v_mul_f32_dpp v202, v242, v196 row_newbcast:12 row_mask:0xf bank_mask:0xf
    v_mul_f32_dpp v203, v242, v197 row_newbcast:13 row_mask:0xf bank_mask:0xf
    v_cvt_pk_bf16_f32 v82, v200, v201
    v_cvt_pk_bf16_f32 v86, v202, v203
    v_mul_f32_dpp v200, v242, v198 row_newbcast:6 row_mask:0xf bank_mask:0xf
    v_mul_f32_dpp v201, v242, v199 row_newbcast:7 row_mask:0xf bank_mask:0xf
    v_mul_f32_dpp v202, v242, v198 row_newbcast:14 row_mask:0xf bank_mask:0xf
    v_mul_f32_dpp v203, v242, v199 row_newbcast:15 row_mask:0xf bank_mask:0xf
    v_cvt_pk_bf16_f32 v83, v200, v201
    v_cvt_pk_bf16_f32 v87, v202, v203
    s_nop 0
    s_waitcnt vmcnt(4) lgkmcnt(0)
    v_mfma_f32_32x32x16_bf16 v[0:15], v[80:83], v[176:179], v[0:15]
    v_lshlrev_b32 v196, 16, v92
    v_and_b32 v197, 0xffff0000, v92
    v_lshlrev_b32 v198, 16, v93
    v_and_b32 v199, 0xffff0000, v93
    v_mul_f32_dpp v200, v243, v196 row_newbcast:0 row_mask:0xf bank_mask:0xf
    v_mul_f32_dpp v201, v243, v197 row_newbcast:1 row_mask:0xf bank_mask:0xf
    v_mul_f32_dpp v202, v243, v196 row_newbcast:8 row_mask:0xf bank_mask:0xf
    v_mul_f32_dpp v203, v243, v197 row_newbcast:9 row_mask:0xf bank_mask:0xf
    v_lshlrev_b32 v196, 16, v94
    v_and_b32 v197, 0xffff0000, v94
    v_cvt_pk_bf16_f32 v88, v200, v201
    v_cvt_pk_bf16_f32 v92, v202, v203
    v_mul_f32_dpp v200, v243, v198 row_newbcast:2 row_mask:0xf bank_mask:0xf
    v_mul_f32_dpp v201, v243, v199 row_newbcast:3 row_mask:0xf bank_mask:0xf
    v_mul_f32_dpp v202, v243, v198 row_newbcast:10 row_mask:0xf bank_mask:0xf
    v_mul_f32_dpp v203, v243, v199 row_newbcast:11 row_mask:0xf bank_mask:0xf
    s_add_u32 m0, s21, 4096
    v_mfma_f32_32x32x16_bf16 v[16:31], v[84:87], v[176:179], v[16:31]
    buffer_load_dwordx4 v238, s[4:7], s35 offen lds
    buffer_load_dwordx4 v239, s[8:11], s35 offen offset:1024 lds
    ds_read_b64_tr_b16 v[176:177], v244 offset:6144
    ds_read_b64_tr_b16 v[178:179], v244 offset:7168
    ds_read_b64_tr_b16 v[192:193], v245 offset:6144
    ds_read_b64_tr_b16 v[194:195], v245 offset:7168
    v_lshlrev_b32 v198, 16, v95
    v_and_b32 v199, 0xffff0000, v95
    v_cvt_pk_bf16_f32 v89, v200, v201
    v_cvt_pk_bf16_f32 v93, v202, v203
    v_mul_f32_dpp v200, v243, v196 row_newbcast:4 row_mask:0xf bank_mask:0xf
    v_mul_f32_dpp v201, v243, v197 row_newbcast:5 row_mask:0xf bank_mask:0xf
    v_mul_f32_dpp v202, v243, v196 row_newbcast:12 row_mask:0xf bank_mask:0xf
    v_mul_f32_dpp v203, v243, v197 row_newbcast:13 row_mask:0xf bank_mask:0xf
    v_cvt_pk_bf16_f32 v90, v200, v201
    v_cvt_pk_bf16_f32 v94, v202, v203
    v_mul_f32_dpp v200, v243, v198 row_newbcast:6 row_mask:0xf bank_mask:0xf
    v_mul_f32_dpp v201, v243, v199 row_newbcast:7 row_mask:0xf bank_mask:0xf
    v_mul_f32_dpp v202, v243, v198 row_newbcast:14 row_mask:0xf bank_mask:0xf
    v_mul_f32_dpp v203, v243, v199 row_newbcast:15 row_mask:0xf bank_mask:0xf
    v_cvt_pk_bf16_f32 v91, v200, v201
    v_cvt_pk_bf16_f32 v95, v202, v203
    s_nop 0
    s_waitcnt lgkmcnt(0)
    v_mfma_f32_32x32x16_bf16 v[0:15], v[88:91], v[176:179], v[0:15]
    s_add_u32 m0, s21, 6144
    v_mfma_f32_32x32x16_bf16 v[16:31], v[92:95], v[176:179], v[16:31]
    buffer_load_dwordx4 v240, s[4:7], s35 offen lds
    buffer_load_dwordx4 v241, s[8:11], s35 offen offset:1024 lds
    s_mov_b32 m0, s50
    s_nop 0
    s_movrels_b32 s71, s23
    s_movrels_b32 s33, s28
    s_and_b32 s70, s33, 0x70
    s_andn2_b32 s33, s33, 0x70
    v_xor_b32 v253, s70, v248
    v_add_u32 v253, s33, v253
    s_bfe_u32 s46, s71, 0x30012
    s_mov_b32 m0, s46
    s_and_b32 s66, s71, 0x3ffff
    s_movrels_b32 s68, s57
    s_movrels_b32 s69, s61
    s_sub_u32 s48, s66, s47
    s_mov_b32 s47, s66
    s_lshr_b32 s52, s71, 28
    s_lshl_b32 s67, s46, 9
    s_add_u32 s66, s66, s67
    s_sub_u32 s49, s66, s42
    s_mov_b32 s42, s66
    s_bfe_u32 s66, s68, 655360
    s_add_u32 s43, s42, s66
    s_bfe_u32 s39, s69, 655360
    s_bfe_u32 s66, s68, 655370
    s_add_u32 s44, s42, s66
    s_bfe_u32 s40, s69, 655370
    s_bfe_u32 s66, s68, 655380
    s_add_u32 s45, s42, s66
    s_bfe_u32 s41, s69, 655380
    v_mfma_f32_32x32x16_bf16 v[32:47], v[64:67], v[180:183], 0
    v_mul_f32 v196, v0, v96
    v_fmac_f32 v196, v1, v97
    v_fmac_f32 v196, v2, v98
    v_fmac_f32 v196, v3, v99
    v_fmac_f32 v196, v4, v100
    v_mfma_f32_32x32x16_bf16 v[48:63], v[68:71], v[180:183], 0
    v_fmac_f32 v196, v5, v101
    v_fmac_f32 v196, v6, v102
    v_fmac_f32 v196, v7, v103
    v_mul_f32 v198, v8, v128
    v_fmac_f32 v198, v9, v129
    v_mfma_f32_32x32x16_bf16 v[32:47], v[72:75], v[184:187], v[32:47]
    v_fmac_f32 v198, v10, v130
    v_fmac_f32 v198, v11, v131
    v_fmac_f32 v198, v12, v132
    v_fmac_f32 v198, v13, v133
    v_mfma_f32_32x32x16_bf16 v[48:63], v[76:79], v[184:187], v[48:63]
    v_fmac_f32 v198, v14, v134
    v_fmac_f32 v198, v15, v135
    v_mul_f32 v200, v16, v128
    v_fmac_f32 v200, v17, v129
    v_permlane32_swap_b32 v196, v198
    v_mfma_f32_32x32x16_bf16 v[32:47], v[80:83], v[188:191], v[32:47]
    v_fmac_f32 v200, v18, v130
    v_fmac_f32 v200, v19, v131
    v_fmac_f32 v200, v20, v132
    v_fmac_f32 v200, v21, v133
    v_fmac_f32 v200, v22, v134
    v_mfma_f32_32x32x16_bf16 v[48:63], v[84:87], v[188:191], v[48:63]
    s_waitcnt vmcnt(6)
    ds_read_b64_tr_b16 v[176:177], v244 offset:0
    ds_read_b64_tr_b16 v[178:179], v244 offset:1024
    ds_read_b64_tr_b16 v[180:181], v245 offset:0
    ds_read_b64_tr_b16 v[182:183], v245 offset:1024
    v_fmac_f32 v200, v23, v135
    v_add_f32 v198, v196, v198
    v_mul_f32_e64 v202, v24, -v128
    v_fma_f32 v202, v25, -v129, v202
    v_mfma_f32_32x32x16_bf16 v[32:47], v[88:91], v[192:195], v[32:47]
    v_fma_f32 v202, v26, -v130, v202
    v_fma_f32 v202, v27, -v131, v202
    v_fma_f32 v202, v28, -v132, v202
    v_fma_f32 v202, v29, -v133, v202
    v_fma_f32 v202, v30, -v134, v202
    v_mfma_f32_32x32x16_bf16 v[48:63], v[92:95], v[192:195], v[48:63]
    v_fma_f32 v202, v31, -v135, v202
    s_nop 1
    v_permlane32_swap_b32 v200, v202
    v_add_f32 v202, v200, v202
    s_waitcnt vmcnt(4) lgkmcnt(0)
    v_mfma_f32_32x32x16_bf16 v[0:15], v[64:67], v[176:179], 0
    v_mul_f32 v197, v32, v104
    v_fmac_f32 v197, v33, v105
    v_fmac_f32 v197, v34, v106
    v_fmac_f32 v197, v35, v107
    v_fmac_f32 v197, v36, v108
    v_fmac_f32 v197, v37, v109
    s_add_u32 m0, s21, 0
    v_mfma_f32_32x32x16_bf16 v[16:31], v[68:71], v[176:179], 0
    buffer_load_dwordx4 v234, s[4:7], s36 offen lds
    buffer_load_dwordx4 v235, s[8:11], s36 offen offset:1024 lds
    ds_read_b64_tr_b16 v[176:177], v244 offset:2048
    ds_read_b64_tr_b16 v[178:179], v244 offset:3072
    ds_read_b64_tr_b16 v[184:185], v245 offset:2048
    ds_read_b64_tr_b16 v[186:187], v245 offset:3072
    v_fmac_f32 v197, v38, v110
    v_fmac_f32 v197, v39, v111
    v_mul_f32 v199, v40, v136
    v_fmac_f32 v199, v41, v137
    v_fmac_f32 v199, v42, v138
    s_waitcnt vmcnt(4) lgkmcnt(0)
    v_mfma_f32_32x32x16_bf16 v[0:15], v[72:75], v[176:179], v[0:15]
    v_fmac_f32 v199, v43, v139
    v_fmac_f32 v199, v44, v140
    v_fmac_f32 v199, v45, v141
    v_fmac_f32 v199, v46, v142
    v_fmac_f32 v199, v47, v143
    s_add_u32 m0, s21, 2048
    v_mfma_f32_32x32x16_bf16 v[16:31], v[76:79], v[176:179], v[16:31]
    buffer_load_dwordx4 v236, s[4:7], s36 offen lds
    buffer_load_dwordx4 v237, s[8:11], s36 offen offset:1024 lds
    ds_read_b64_tr_b16 v[176:177], v244 offset:4096
    ds_read_b64_tr_b16 v[178:179], v244 offset:5120
    ds_read_b64_tr_b16 v[188:189], v245 offset:4096
    ds_read_b64_tr_b16 v[190:191], v245 offset:5120
    v_mul_f32 v201, v48, v136
    v_fmac_f32 v201, v49, v137
    v_permlane32_swap_b32 v197, v199
    v_fmac_f32 v201, v50, v138
    v_fmac_f32 v201, v51, v139
    s_waitcnt vmcnt(4) lgkmcnt(0)
    v_mfma_f32_32x32x16_bf16 v[0:15], v[80:83], v[176:179], v[0:15]
    v_fmac_f32 v201, v52, v140
    v_fmac_f32 v201, v53, v141
    v_fmac_f32 v201, v54, v142
    v_fmac_f32 v201, v55, v143
    v_add_f32 v199, v197, v199
    s_add_u32 m0, s21, 4096
    v_mfma_f32_32x32x16_bf16 v[16:31], v[84:87], v[176:179], v[16:31]
    buffer_load_dwordx4 v238, s[4:7], s36 offen lds
    buffer_load_dwordx4 v239, s[8:11], s36 offen offset:1024 lds
    ds_read_b64_tr_b16 v[176:177], v244 offset:6144
    ds_read_b64_tr_b16 v[178:179], v244 offset:7168
    ds_read_b64_tr_b16 v[192:193], v245 offset:6144
    ds_read_b64_tr_b16 v[194:195], v245 offset:7168
    v_mul_f32_e64 v203, v56, -v136
    v_fma_f32 v203, v57, -v137, v203
    v_fma_f32 v203, v58, -v138, v203
    v_fma_f32 v203, v59, -v139, v203
    v_fma_f32 v203, v60, -v140, v203
    s_waitcnt lgkmcnt(0)
    v_mfma_f32_32x32x16_bf16 v[0:15], v[88:91], v[176:179], v[0:15]
    v_fma_f32 v203, v61, -v141, v203
    v_fma_f32 v203, v62, -v142, v203
    v_fma_f32 v203, v63, -v143, v203
    s_nop 1
    v_permlane32_swap_b32 v201, v203
    s_add_u32 m0, s21, 6144
    v_mfma_f32_32x32x16_bf16 v[16:31], v[92:95], v[176:179], v[16:31]
    buffer_load_dwordx4 v240, s[4:7], s36 offen lds
    buffer_load_dwordx4 v241, s[8:11], s36 offen offset:1024 lds
    v_add_f32 v203, v201, v203
    v_cvt_pk_bf16_f32 v198, v198, v199
    v_cvt_pk_bf16_f32 v202, v202, v203
    ds_write_b32 v253, v198 offset:0
    ds_write_b32 v253, v202 offset:256
    v_mfma_f32_32x32x16_bf16 v[32:47], v[64:67], v[180:183], 0
    v_mul_f32 v196, v0, v144
    v_fmac_f32 v196, v1, v145
    v_fmac_f32 v196, v2, v146
    v_fmac_f32 v196, v3, v147
    v_mfma_f32_32x32x16_bf16 v[48:63], v[68:71], v[180:183], 0
    v_fmac_f32 v196, v4, v148
    v_fmac_f32 v196, v5, v149
    v_fmac_f32 v196, v6, v150
    v_fmac_f32 v196, v7, v151
    v_mfma_f32_32x32x16_bf16 v[32:47], v[72:75], v[184:187], v[32:47]
    v_mul_f32 v198, v8, v112
    v_fmac_f32 v198, v9, v113
    v_fmac_f32 v198, v10, v114
    v_fmac_f32 v198, v11, v115
    v_mfma_f32_32x32x16_bf16 v[48:63], v[76:79], v[184:187], v[48:63]
    v_fmac_f32 v198, v12, v116
    v_fmac_f32 v198, v13, v117
    v_fmac_f32 v198, v14, v118
    v_fmac_f32 v198, v15, v119
    v_mfma_f32_32x32x16_bf16 v[32:47], v[80:83], v[188:191], v[32:47]
    v_mul_f32_e64 v200, v16, -v160
    v_fma_f32 v200, v17, -v161, v200
    v_fma_f32 v200, v18, -v162, v200
    v_fma_f32 v200, v19, -v163, v200
    v_mfma_f32_32x32x16_bf16 v[48:63], v[84:87], v[188:191], v[48:63]
    s_waitcnt vmcnt(6)
    ds_read_b64_tr_b16 v[176:177], v244 offset:0
    ds_read_b64_tr_b16 v[178:179], v244 offset:1024
    ds_read_b64_tr_b16 v[180:181], v245 offset:0
    ds_read_b64_tr_b16 v[182:183], v245 offset:1024
    v_fma_f32 v200, v20, -v164, v200
    v_fma_f32 v200, v21, -v165, v200
    v_fma_f32 v200, v22, -v166, v200
    v_fma_f32 v200, v23, -v167, v200
    v_mfma_f32_32x32x16_bf16 v[32:47], v[88:91], v[192:195], v[32:47]
    v_mul_f32_e64 v202, v24, -v160
    v_fma_f32 v202, v25, -v161, v202
    v_fma_f32 v202, v26, -v162, v202
    v_fma_f32 v202, v27, -v163, v202
    v_mfma_f32_32x32x16_bf16 v[48:63], v[92:95], v[192:195], v[48:63]
    v_fma_f32 v202, v28, -v164, v202
    v_fma_f32 v202, v29, -v165, v202
    v_fma_f32 v202, v30, -v166, v202
    v_fma_f32 v202, v31, -v167, v202
    s_waitcnt vmcnt(4) lgkmcnt(0)
    v_mfma_f32_32x32x16_bf16 v[0:15], v[64:67], v[176:179], 0
    s_nop 0
    v_mul_f32 v197, v32, v152
    v_fmac_f32 v197, v33, v153
    v_fmac_f32 v197, v34, v154
    v_fmac_f32 v197, v35, v155
    s_add_u32 m0, s21, 0
    v_mfma_f32_32x32x16_bf16 v[16:31], v[68:71], v[176:179], 0
    buffer_load_dwordx4 v234, s[4:7], s37 offen lds
    buffer_load_dwordx4 v235, s[8:11], s37 offen offset:1024 lds
    ds_read_b64_tr_b16 v[176:177], v244 offset:2048
    ds_read_b64_tr_b16 v[178:179], v244 offset:3072
    ds_read_b64_tr_b16 v[184:185], v245 offset:2048
    ds_read_b64_tr_b16 v[186:187], v245 offset:3072
    v_add_u32 v252, s42, v247
    ds_read_u16 v234, v252
    ds_read_u16 v235, v252 offset:64
    v_fmac_f32 v197, v36, v156
    v_fmac_f32 v197, v37, v157
    v_fmac_f32 v197, v38, v158
    v_fmac_f32 v197, v39, v159
    s_waitcnt vmcnt(4) lgkmcnt(2)
    v_mfma_f32_32x32x16_bf16 v[0:15], v[72:75], v[176:179], v[0:15]
    v_mul_f32 v199, v40, v120
    v_fmac_f32 v199, v41, v121
    v_fmac_f32 v199, v42, v122
    v_fmac_f32 v199, v43, v123
    s_add_u32 m0, s21, 2048
    v_mfma_f32_32x32x16_bf16 v[16:31], v[76:79], v[176:179], v[16:31]
    buffer_load_dwordx4 v236, s[4:7], s37 offen lds
    buffer_load_dwordx4 v237, s[8:11], s37 offen offset:1024 lds
    ds_read_b64_tr_b16 v[176:177], v244 offset:4096
    ds_read_b64_tr_b16 v[178:179], v244 offset:5120
    ds_read_b64_tr_b16 v[188:189], v245 offset:4096
    ds_read_b64_tr_b16 v[190:191], v245 offset:5120
    v_add_u32 v252, s43, v247
    ds_read_u16 v236, v252
    ds_read_u16 v237, v252 offset:64
    v_fmac_f32 v199, v44, v124
    v_fmac_f32 v199, v45, v125
    v_fmac_f32 v199, v46, v126
    v_fmac_f32 v199, v47, v127
    s_waitcnt vmcnt(4) lgkmcnt(2)
    v_mfma_f32_32x32x16_bf16 v[0:15], v[80:83], v[176:179], v[0:15]
    v_mul_f32_e64 v201, v48, -v168
    v_fma_f32 v201, v49, -v169, v201
    v_fma_f32 v201, v50, -v170, v201
    v_fma_f32 v201, v51, -v171, v201
    s_add_u32 m0, s21, 4096
    v_mfma_f32_32x32x16_bf16 v[16:31], v[84:87], v[176:179], v[16:31]
    buffer_load_dwordx4 v238, s[4:7], s37 offen lds
    buffer_load_dwordx4 v239, s[8:11], s37 offen offset:1024 lds
    ds_read_b64_tr_b16 v[176:177], v244 offset:6144
    ds_read_b64_tr_b16 v[178:179], v244 offset:7168
    ds_read_b64_tr_b16 v[192:193], v245 offset:6144
    ds_read_b64_tr_b16 v[194:195], v245 offset:7168
    v_add_u32 v252, s44, v247
    ds_read_u16 v238, v252
    ds_read_u16 v239, v252 offset:64
    v_fma_f32 v201, v52, -v172, v201
    v_fma_f32 v201, v53, -v173, v201
    v_fma_f32 v201, v54, -v174, v201
    v_fma_f32 v201, v55, -v175, v201
    s_waitcnt lgkmcnt(2)
    v_mfma_f32_32x32x16_bf16 v[0:15], v[88:91], v[176:179], v[0:15]
    v_mul_f32_e64 v203, v56, -v168
    v_fma_f32 v203, v57, -v169, v203
    v_fma_f32 v203, v58, -v170, v203
    v_fma_f32 v203, v59, -v171, v203
    s_add_u32 m0, s21, 6144
    v_mfma_f32_32x32x16_bf16 v[16:31], v[92:95], v[176:179], v[16:31]
    buffer_load_dwordx4 v240, s[4:7], s37 offen lds
    buffer_load_dwordx4 v241, s[8:11], s37 offen offset:1024 lds
    v_add_u32 v252, s45, v247
    ds_read_u16 v240, v252
    ds_read_u16 v241, v252 offset:64
    v_fma_f32 v203, v60, -v172, v203
    v_fma_f32 v203, v61, -v173, v203
    v_fma_f32 v203, v62, -v174, v203
    v_fma_f32 v203, v63, -v175, v203
    v_mfma_f32_32x32x16_bf16 v[32:47], v[64:67], v[180:183], 0
    v_mul_f32 v254, v0, v144
    v_fmac_f32 v254, v1, v145
    v_fmac_f32 v254, v2, v146
    v_mfma_f32_32x32x16_bf16 v[48:63], v[68:71], v[180:183], 0
    ds_swizzle_b32 v68, v68 offset:0x401F
    ds_swizzle_b32 v69, v69 offset:0x401F
    ds_swizzle_b32 v70, v70 offset:0x401F
    ds_swizzle_b32 v71, v71 offset:0x401F
    v_fmac_f32 v254, v3, v147
    v_fmac_f32 v254, v4, v148
    v_mfma_f32_32x32x16_bf16 v[32:47], v[72:75], v[184:187], v[32:47]
    v_fmac_f32 v254, v5, v149
    v_fmac_f32 v254, v6, v150
    v_mfma_f32_32x32x16_bf16 v[48:63], v[76:79], v[184:187], v[48:63]
    ds_swizzle_b32 v76, v76 offset:0x401F
    ds_swizzle_b32 v77, v77 offset:0x401F
    ds_swizzle_b32 v78, v78 offset:0x401F
    ds_swizzle_b32 v79, v79 offset:0x401F
    v_fmac_f32 v254, v7, v151
    v_fmac_f32 v200, v8, v160
    v_mfma_f32_32x32x16_bf16 v[32:47], v[80:83], v[188:191], v[32:47]
    v_fmac_f32 v200, v9, v161
    v_permlane32_swap_b32 v196, v254
    v_fmac_f32 v200, v10, v162
    v_mfma_f32_32x32x16_bf16 v[48:63], v[84:87], v[188:191], v[48:63]
    ds_swizzle_b32 v84, v84 offset:0x401F
    ds_swizzle_b32 v85, v85 offset:0x401F
    ds_swizzle_b32 v86, v86 offset:0x401F
    ds_swizzle_b32 v87, v87 offset:0x401F
    s_waitcnt vmcnt(6)
    ds_read_b64_tr_b16 v[176:177], v244 offset:0
    ds_read_b64_tr_b16 v[178:179], v244 offset:1024
    ds_read_b64_tr_b16 v[180:181], v245 offset:0
    ds_read_b64_tr_b16 v[182:183], v245 offset:1024
    v_fmac_f32 v200, v11, v163
    v_fmac_f32 v200, v12, v164
    v_mfma_f32_32x32x16_bf16 v[32:47], v[88:91], v[192:195], v[32:47]
    v_fmac_f32 v200, v13, v165
    v_fmac_f32 v200, v14, v166
    v_mfma_f32_32x32x16_bf16 v[48:63], v[92:95], v[192:195], v[48:63]
    ds_swizzle_b32 v92, v92 offset:0x401F
    ds_swizzle_b32 v93, v93 offset:0x401F
    ds_swizzle_b32 v94, v94 offset:0x401F
    ds_swizzle_b32 v95, v95 offset:0x401F
    v_fmac_f32 v200, v15, v167
    v_add_f32 v254, v196, v254
    s_waitcnt lgkmcnt(8)
    s_mov_b64 exec, s[56:57]
    v_xor_b32 v68, 0x80008000, v68
    v_xor_b32 v69, 0x80008000, v69
    v_xor_b32 v70, 0x80008000, v70
    v_xor_b32 v71, 0x80008000, v71
    v_xor_b32 v76, 0x80008000, v76
    v_xor_b32 v77, 0x80008000, v77
    v_xor_b32 v78, 0x80008000, v78
    v_xor_b32 v79, 0x80008000, v79
    v_xor_b32 v84, 0x80008000, v84
    v_xor_b32 v85, 0x80008000, v85
    v_xor_b32 v86, 0x80008000, v86
    v_xor_b32 v87, 0x80008000, v87
    s_mov_b64 exec, -1
    s_waitcnt vmcnt(4) lgkmcnt(4)
    v_mfma_f32_32x32x16_bf16 v[0:15], v[64:67], v[176:179], 0
    v_mul_f32 v255, v32, v152
    v_fmac_f32 v255, v33, v153
    v_fmac_f32 v255, v34, v154
    s_add_u32 m0, s21, 0
    v_mfma_f32_32x32x16_bf16 v[16:31], v[68:71], v[176:179], v[16:31]
    v_lshl_add_u32 v234, v234, 10, v246
    v_lshl_add_u32 v235, v235, 10, v246
    buffer_load_dwordx4 v234, s[4:7], s38 offen lds
    buffer_load_dwordx4 v235, s[8:11], s38 offen offset:1024 lds
    ds_read_b64_tr_b16 v[176:177], v244 offset:2048
    ds_read_b64_tr_b16 v[178:179], v244 offset:3072
    ds_read_b64_tr_b16 v[184:185], v245 offset:2048
    ds_read_b64_tr_b16 v[186:187], v245 offset:3072
    v_fmac_f32 v255, v35, v155
    v_fmac_f32 v255, v36, v156
    s_waitcnt vmcnt(4) lgkmcnt(0)
    v_mfma_f32_32x32x16_bf16 v[0:15], v[72:75], v[176:179], v[0:15]
    v_fmac_f32 v255, v37, v157
    v_fmac_f32 v255, v38, v158
    v_fmac_f32 v255, v39, v159
    s_add_u32 m0, s21, 2048
    v_mfma_f32_32x32x16_bf16 v[16:31], v[76:79], v[176:179], v[16:31]
    v_lshl_add_u32 v236, v236, 10, v246
    v_lshl_add_u32 v237, v237, 10, v246
    buffer_load_dwordx4 v236, s[4:7], s39 offen lds
    buffer_load_dwordx4 v237, s[8:11], s39 offen offset:1024 lds
    ds_read_b64_tr_b16 v[176:177], v244 offset:4096
    ds_read_b64_tr_b16 v[178:179], v244 offset:5120
    ds_read_b64_tr_b16 v[188:189], v245 offset:4096
    ds_read_b64_tr_b16 v[190:191], v245 offset:5120
    v_fmac_f32 v201, v40, v168
    v_fmac_f32 v201, v41, v169
    s_waitcnt vmcnt(4) lgkmcnt(0)
    v_mfma_f32_32x32x16_bf16 v[0:15], v[80:83], v[176:179], v[0:15]
    v_permlane32_swap_b32 v197, v255
    v_fmac_f32 v201, v42, v170
    v_fmac_f32 v201, v43, v171
    s_add_u32 m0, s21, 4096
    v_mfma_f32_32x32x16_bf16 v[16:31], v[84:87], v[176:179], v[16:31]
    v_lshl_add_u32 v238, v238, 10, v246
    v_lshl_add_u32 v239, v239, 10, v246
    buffer_load_dwordx4 v238, s[4:7], s40 offen lds
    buffer_load_dwordx4 v239, s[8:11], s40 offen offset:1024 lds
    ds_read_b64_tr_b16 v[176:177], v244 offset:6144
    ds_read_b64_tr_b16 v[178:179], v244 offset:7168
    ds_read_b64_tr_b16 v[192:193], v245 offset:6144
    ds_read_b64_tr_b16 v[194:195], v245 offset:7168
    v_fmac_f32 v201, v44, v172
    v_fmac_f32 v201, v45, v173
    s_waitcnt lgkmcnt(0)
    s_mov_b64 exec, s[56:57]
    v_xor_b32 v92, 0x80008000, v92
    v_xor_b32 v93, 0x80008000, v93
    v_xor_b32 v94, 0x80008000, v94
    v_xor_b32 v95, 0x80008000, v95
    s_mov_b64 exec, -1
    v_mfma_f32_32x32x16_bf16 v[0:15], v[88:91], v[176:179], v[0:15]
    v_fmac_f32 v201, v46, v174
    v_fmac_f32 v201, v47, v175
    v_add_f32 v255, v197, v255
    s_add_u32 m0, s21, 6144
    v_mfma_f32_32x32x16_bf16 v[16:31], v[92:95], v[176:179], v[16:31]
    v_lshl_add_u32 v240, v240, 10, v246
    v_lshl_add_u32 v241, v241, 10, v246
    buffer_load_dwordx4 v240, s[4:7], s41 offen lds
    buffer_load_dwordx4 v241, s[8:11], s41 offen offset:1024 lds
    v_cvt_pk_bf16_f32 v254, v254, v255
    ds_write_b32 v253, v254 offset:512
    v_mfma_f32_32x32x16_bf16 v[32:47], v[64:67], v[180:183], 0
    v_mul_f32 v254, v0, v144
    v_fmac_f32 v254, v1, v145
    v_fmac_f32 v254, v2, v146
    v_fmac_f32 v254, v3, v147
    v_fmac_f32 v254, v4, v148
    v_mfma_f32_32x32x16_bf16 v[48:63], v[68:71], v[180:183], v[48:63]
    v_fmac_f32 v254, v5, v149
    v_fmac_f32 v254, v6, v150
    v_fmac_f32 v254, v7, v151
    v_fma_f32 v202, v8, -v160, v202
    v_fma_f32 v202, v9, -v161, v202
    v_mfma_f32_32x32x16_bf16 v[32:47], v[72:75], v[184:187], v[32:47]
    v_permlane32_swap_b32 v254, v200
    v_fma_f32 v202, v10, -v162, v202
    v_fma_f32 v202, v11, -v163, v202
    v_fma_f32 v202, v12, -v164, v202
    v_fma_f32 v202, v13, -v165, v202
    v_mfma_f32_32x32x16_bf16 v[48:63], v[76:79], v[184:187], v[48:63]
    v_fma_f32 v202, v14, -v166, v202
    v_fma_f32 v202, v15, -v167, v202
    v_add_f32 v200, v254, v200
    v_fmac_f32 v198, v16, v112
    v_permlane32_swap_b32 v202, v254
    v_mfma_f32_32x32x16_bf16 v[32:47], v[80:83], v[188:191], v[32:47]
    v_fmac_f32 v198, v17, v113
    v_fmac_f32 v198, v18, v114
    v_fmac_f32 v198, v19, v115
    v_fmac_f32 v198, v20, v116
    v_fmac_f32 v198, v21, v117
    v_mfma_f32_32x32x16_bf16 v[48:63], v[84:87], v[188:191], v[48:63]
    s_waitcnt vmcnt(6)
    ds_read_b64_tr_b16 v[176:177], v244 offset:0
    ds_read_b64_tr_b16 v[178:179], v244 offset:1024
    ds_read_b64_tr_b16 v[180:181], v245 offset:0
    ds_read_b64_tr_b16 v[182:183], v245 offset:1024
    v_fmac_f32 v198, v22, v118
    v_fmac_f32 v198, v23, v119
    v_add_f32 v254, v202, v254
    v_mul_f32 v196, v24, v160
    v_fmac_f32 v196, v25, v161
    v_mfma_f32_32x32x16_bf16 v[32:47], v[88:91], v[192:195], v[32:47]
    v_fmac_f32 v196, v26, v162
    v_fmac_f32 v196, v27, v163
    v_fmac_f32 v196, v28, v164
    v_fmac_f32 v196, v29, v165
    v_fmac_f32 v196, v30, v166
    v_mfma_f32_32x32x16_bf16 v[48:63], v[92:95], v[192:195], v[48:63]
    v_add_u32 v249, s48, v249
    v_add_u32 v250, s49, v250
    ds_read_b32 v252, v251 offset:16
    ds_read_b64_tr_b16 v[68:69], v249 offset:0
    ds_read_b64_tr_b16 v[70:71], v249 offset:256
    s_mov_b64 exec, s[54:55]
    ds_read_u16_d16_hi v242, v250 offset:0
    s_mov_b64 exec, -1
    v_fmac_f32 v196, v31, v167
    s_nop 1
    v_permlane32_swap_b32 v198, v196
    v_add_f32 v196, v198, v196
    v_mul_f32 v255, v32, v152
    v_fmac_f32 v255, v33, v153
    v_fmac_f32 v255, v34, v154
    v_fmac_f32 v255, v35, v155
    v_fmac_f32 v255, v36, v156
    v_fmac_f32 v255, v37, v157
    v_fmac_f32 v255, v38, v158
    v_fmac_f32 v255, v39, v159
    v_fma_f32 v203, v40, -v168, v203
    v_fma_f32 v203, v41, -v169, v203
    v_permlane32_swap_b32 v255, v201
    v_fma_f32 v203, v42, -v170, v203
    v_fma_f32 v203, v43, -v171, v203
    v_fma_f32 v203, v44, -v172, v203
    v_fma_f32 v203, v45, -v173, v203
    v_fma_f32 v203, v46, -v174, v203
    v_fma_f32 v203, v47, -v175, v203
    v_add_f32 v201, v255, v201
    v_fmac_f32 v199, v48, v120
    v_permlane32_swap_b32 v203, v255
    v_fmac_f32 v199, v49, v121
    v_fmac_f32 v199, v50, v122
    v_fmac_f32 v199, v51, v123
    v_fmac_f32 v199, v52, v124
    v_fmac_f32 v199, v53, v125
    v_fmac_f32 v199, v54, v126
    v_fmac_f32 v199, v55, v127
    v_add_f32 v255, v203, v255
    v_mul_f32 v197, v56, v168
    v_fmac_f32 v197, v57, v169
    v_fmac_f32 v197, v58, v170
    v_fmac_f32 v197, v59, v171
    v_fmac_f32 v197, v60, v172
    v_fmac_f32 v197, v61, v173
    v_fmac_f32 v197, v62, v174
    v_fmac_f32 v197, v63, v175
    s_nop 1
    v_permlane32_swap_b32 v199, v197
    v_add_f32 v197, v199, v197
    v_cvt_pk_bf16_f32 v200, v200, v201
    v_cvt_pk_bf16_f32 v254, v254, v255
    v_cvt_pk_bf16_f32 v196, v196, v197
    ds_write_b32 v253, v200 offset:768
    s_mov_b64 exec, 0xffffffff
    ds_write_b32 v253, v254 offset:1280
    s_mov_b64 exec, -1
    ds_write_b32 v253, v196 offset:1024
    s_add_u32 s50, s50, 1
    s_cmp_ge_u32 s50, 5
    s_cbranch_scc1 TAIL
    s_waitcnt lgkmcnt(6)
    v_readfirstlane_b32 s66, v252
    s_add_u32 s53, s53, 1
    v_mov_b32 v252, s53
    s_cmp_le_u32 s53, s66
    ds_write2_b32 v251, v252, v252 offset0:0 offset1:8
    s_setprio 1
    s_cbranch_scc1 PRIO_14
    s_setprio 0
PRIO_14:
    s_cmp_eq_u32 s52, 4
    s_cbranch_scc1 ITEM_1_4
    s_cmp_eq_u32 s52, 5
    s_cbranch_scc1 ITEM_1_5
    s_cmp_eq_u32 s52, 3
    s_cbranch_scc1 ITEM_1_3
    s_cmp_eq_u32 s52, 6
    s_cbranch_scc1 ITEM_1_6
    s_cmp_eq_u32 s52, 8
    s_cbranch_scc1 ITEM_1_8
    s_branch ITEM_1_2
.p2align 6
ITEM_1_2:
    s_mov_b32 m0, s50
    s_nop 0
    s_movrels_b32 s71, s23
    s_movrels_b32 s33, s28
    s_and_b32 s70, s33, 0x70
    s_andn2_b32 s33, s33, 0x70
    v_xor_b32 v253, s70, v248
    v_add_u32 v253, s33, v253
    s_bfe_u32 s46, s71, 0x30012
    s_mov_b32 m0, s46
    s_and_b32 s66, s71, 0x3ffff
    s_movrels_b32 s68, s57
    s_movrels_b32 s69, s61
    s_sub_u32 s48, s66, s47
    s_mov_b32 s47, s66
    s_lshr_b32 s52, s71, 28
    s_lshl_b32 s67, s46, 9
    s_add_u32 s66, s66, s67
    s_sub_u32 s49, s66, s42
    s_mov_b32 s42, s66
    s_bfe_u32 s66, s68, 655360
    s_add_u32 s43, s42, s66
    s_bfe_u32 s39, s69, 655360
    s_bfe_u32 s66, s68, 655370
    s_add_u32 s44, s42, s66
    s_bfe_u32 s40, s69, 655370
    s_bfe_u32 s66, s68, 655380
    s_add_u32 s45, s42, s66
    s_bfe_u32 s41, s69, 655380
    v_add_u32 v252, s42, v247
    ds_read_u16 v234, v252
    ds_read_u16 v235, v252 offset:64
    v_add_u32 v252, s43, v247
    ds_read_u16 v236, v252
    ds_read_u16 v237, v252 offset:64
    v_add_u32 v252, s44, v247
    ds_read_u16 v238, v252
    ds_read_u16 v239, v252 offset:64
    v_add_u32 v252, s45, v247
    ds_read_u16 v240, v252
    ds_read_u16 v241, v252 offset:64
    s_waitcnt lgkmcnt(8)
    v_lshlrev_b32 v196, 16, v68
    v_and_b32 v197, 0xffff0000, v68
    v_lshlrev_b32 v198, 16, v69
    v_and_b32 v199, 0xffff0000, v69
    v_mul_f32_dpp v200, v242, v196 row_newbcast:0 row_mask:0xf bank_mask:0xf
    v_mul_f32_dpp v201, v242, v197 row_newbcast:1 row_mask:0xf bank_mask:0xf
    v_mul_f32_dpp v202, v242, v196 row_newbcast:8 row_mask:0xf bank_mask:0xf
    v_mul_f32_dpp v203, v242, v197 row_newbcast:9 row_mask:0xf bank_mask:0xf
    v_lshlrev_b32 v196, 16, v70
    v_and_b32 v197, 0xffff0000, v70
    v_cvt_pk_bf16_f32 v64, v200, v201
    v_cvt_pk_bf16_f32 v68, v202, v203
    v_mul_f32_dpp v200, v242, v198 row_newbcast:2 row_mask:0xf bank_mask:0xf
    v_mul_f32_dpp v201, v242, v199 row_newbcast:3 row_mask:0xf bank_mask:0xf
    v_mul_f32_dpp v202, v242, v198 row_newbcast:10 row_mask:0xf bank_mask:0xf
    v_mul_f32_dpp v203, v242, v199 row_newbcast:11 row_mask:0xf bank_mask:0xf
    v_lshlrev_b32 v198, 16, v71
    v_and_b32 v199, 0xffff0000, v71
    v_cvt_pk_bf16_f32 v65, v200, v201
    v_cvt_pk_bf16_f32 v69, v202, v203
    v_mul_f32_dpp v200, v242, v196 row_newbcast:4 row_mask:0xf bank_mask:0xf
    v_mul_f32_dpp v201, v242, v197 row_newbcast:5 row_mask:0xf bank_mask:0xf
    v_mul_f32_dpp v202, v242, v196 row_newbcast:12 row_mask:0xf bank_mask:0xf
    v_mul_f32_dpp v203, v242, v197 row_newbcast:13 row_mask:0xf bank_mask:0xf
    v_cvt_pk_bf16_f32 v66, v200, v201
    v_cvt_pk_bf16_f32 v70, v202, v203
    v_mul_f32_dpp v200, v242, v198 row_newbcast:6 row_mask:0xf bank_mask:0xf
    v_mul_f32_dpp v201, v242, v199 row_newbcast:7 row_mask:0xf bank_mask:0xf
    v_mul_f32_dpp v202, v242, v198 row_newbcast:14 row_mask:0xf bank_mask:0xf
    v_mul_f32_dpp v203, v242, v199 row_newbcast:15 row_mask:0xf bank_mask:0xf
    v_cvt_pk_bf16_f32 v67, v200, v201
    v_cvt_pk_bf16_f32 v71, v202, v203
    s_nop 0
    s_waitcnt lgkmcnt(6)
    v_mfma_f32_32x32x16_bf16 v[0:15], v[64:67], v[176:179], 0
    s_add_u32 m0, s21, 0
    v_mfma_f32_32x32x16_bf16 v[16:31], v[68:71], v[176:179], 0
    v_lshl_add_u32 v234, v234, 10, v246
    v_lshl_add_u32 v235, v235, 10, v246
    buffer_load_dwordx4 v234, s[4:7], s38 offen lds
    buffer_load_dwordx4 v235, s[8:11], s38 offen offset:1024 lds
    v_mfma_f32_32x32x16_bf16 v[32:47], v[64:67], v[180:183], 0
    s_nop 4
    v_mul_f32 v196, v0, v96
    v_fmac_f32 v196, v1, v97
    v_fmac_f32 v196, v2, v98
    v_fmac_f32 v196, v3, v99
    v_fmac_f32 v196, v4, v100
    v_fmac_f32 v196, v5, v101
    v_fmac_f32 v196, v6, v102
    v_fmac_f32 v196, v7, v103
    v_mul_f32 v198, v8, v128
    v_fmac_f32 v198, v9, v129
    v_fmac_f32 v198, v10, v130
    v_fmac_f32 v198, v11, v131
    v_fmac_f32 v198, v12, v132
    v_fmac_f32 v198, v13, v133
    v_fmac_f32 v198, v14, v134
    v_fmac_f32 v198, v15, v135
    v_mul_f32 v200, v16, v128
    v_fmac_f32 v200, v17, v129
    v_permlane32_swap_b32 v196, v198
    v_mfma_f32_32x32x16_bf16 v[48:63], v[68:71], v[180:183], 0
    s_waitcnt vmcnt(6)
    ds_read_b64_tr_b16 v[176:177], v244 offset:2048
    ds_read_b64_tr_b16 v[178:179], v244 offset:3072
    ds_read_b64_tr_b16 v[180:181], v245 offset:2048
    ds_read_b64_tr_b16 v[182:183], v245 offset:3072
    v_fmac_f32 v200, v18, v130
    v_fmac_f32 v200, v19, v131
    v_fmac_f32 v200, v20, v132
    v_fmac_f32 v200, v21, v133
    v_fmac_f32 v200, v22, v134
    v_fmac_f32 v200, v23, v135
    v_add_f32 v198, v196, v198
    v_mul_f32_e64 v202, v24, -v128
    v_fma_f32 v202, v25, -v129, v202
    v_fma_f32 v202, v26, -v130, v202
    v_fma_f32 v202, v27, -v131, v202
    v_fma_f32 v202, v28, -v132, v202
    v_fma_f32 v202, v29, -v133, v202
    v_fma_f32 v202, v30, -v134, v202
    v_fma_f32 v202, v31, -v135, v202
    s_nop 1
    v_permlane32_swap_b32 v200, v202
    v_add_f32 v202, v200, v202
    s_waitcnt lgkmcnt(0)
    v_mfma_f32_32x32x16_bf16 v[0:15], v[64:67], v[176:179], 0
    v_mul_f32 v197, v32, v104
    v_fmac_f32 v197, v33, v105
    v_fmac_f32 v197, v34, v106
    v_fmac_f32 v197, v35, v107
    v_fmac_f32 v197, v36, v108
    v_fmac_f32 v197, v37, v109
    v_fmac_f32 v197, v38, v110
    v_fmac_f32 v197, v39, v111
    v_mul_f32 v199, v40, v136
    v_fmac_f32 v199, v41, v137
    v_fmac_f32 v199, v42, v138
    v_fmac_f32 v199, v43, v139
    v_fmac_f32 v199, v44, v140
    v_fmac_f32 v199, v45, v141
    v_fmac_f32 v199, v46, v142
    v_fmac_f32 v199, v47, v143
    v_mul_f32 v201, v48, v136
    v_fmac_f32 v201, v49, v137
    v_permlane32_swap_b32 v197, v199
    v_fmac_f32 v201, v50, v138
    v_fmac_f32 v201, v51, v139
    s_add_u32 m0, s21, 2048
    v_mfma_f32_32x32x16_bf16 v[16:31], v[68:71], v[176:179], 0
    v_lshl_add_u32 v236, v236, 10, v246
    v_lshl_add_u32 v237, v237, 10, v246
    buffer_load_dwordx4 v236, s[4:7], s39 offen lds
    buffer_load_dwordx4 v237, s[8:11], s39 offen offset:1024 lds
    v_fmac_f32 v201, v52, v140
    v_fmac_f32 v201, v53, v141
    v_fmac_f32 v201, v54, v142
    v_fmac_f32 v201, v55, v143
    v_add_f32 v199, v197, v199
    v_mul_f32_e64 v203, v56, -v136
    v_fma_f32 v203, v57, -v137, v203
    v_fma_f32 v203, v58, -v138, v203
    v_fma_f32 v203, v59, -v139, v203
    v_fma_f32 v203, v60, -v140, v203
    v_fma_f32 v203, v61, -v141, v203
    v_fma_f32 v203, v62, -v142, v203
    v_fma_f32 v203, v63, -v143, v203
    s_nop 1
    v_permlane32_swap_b32 v201, v203
    v_add_f32 v203, v201, v203
    v_cvt_pk_bf16_f32 v198, v198, v199
    v_cvt_pk_bf16_f32 v202, v202, v203
    ds_write_b32 v253, v198 offset:0
    ds_write_b32 v253, v202 offset:256
    v_mfma_f32_32x32x16_bf16 v[32:47], v[64:67], v[180:183], 0
    v_mul_f32 v196, v0, v144
    v_fmac_f32 v196, v1, v145
    v_fmac_f32 v196, v2, v146
    v_fmac_f32 v196, v3, v147
    v_fmac_f32 v196, v4, v148
    v_fmac_f32 v196, v5, v149
    v_fmac_f32 v196, v6, v150
    v_fmac_f32 v196, v7, v151
    v_mul_f32 v198, v8, v112
    v_fmac_f32 v198, v9, v113
    v_fmac_f32 v198, v10, v114
    v_fmac_f32 v198, v11, v115
    v_fmac_f32 v198, v12, v116
    v_fmac_f32 v198, v13, v117
    v_fmac_f32 v198, v14, v118
    v_fmac_f32 v198, v15, v119
    v_mfma_f32_32x32x16_bf16 v[48:63], v[68:71], v[180:183], 0
    s_waitcnt vmcnt(6)
    ds_read_b64_tr_b16 v[176:177], v244 offset:4096
    ds_read_b64_tr_b16 v[178:179], v244 offset:5120
    ds_read_b64_tr_b16 v[180:181], v245 offset:4096
    ds_read_b64_tr_b16 v[182:183], v245 offset:5120
    v_mul_f32_e64 v200, v16, -v160
    v_fma_f32 v200, v17, -v161, v200
    v_fma_f32 v200, v18, -v162, v200
    v_fma_f32 v200, v19, -v163, v200
    v_fma_f32 v200, v20, -v164, v200
    v_fma_f32 v200, v21, -v165, v200
    v_fma_f32 v200, v22, -v166, v200
    v_fma_f32 v200, v23, -v167, v200
    v_mul_f32_e64 v202, v24, -v160
    v_fma_f32 v202, v25, -v161, v202
    v_fma_f32 v202, v26, -v162, v202
    v_fma_f32 v202, v27, -v163, v202
    v_fma_f32 v202, v28, -v164, v202
    v_fma_f32 v202, v29, -v165, v202
    v_fma_f32 v202, v30, -v166, v202
    v_fma_f32 v202, v31, -v167, v202
    s_waitcnt lgkmcnt(0)
    v_mfma_f32_32x32x16_bf16 v[0:15], v[64:67], v[176:179], 0
    v_mul_f32 v197, v32, v152
    v_fmac_f32 v197, v33, v153
    v_fmac_f32 v197, v34, v154
    v_fmac_f32 v197, v35, v155
    v_fmac_f32 v197, v36, v156
    v_fmac_f32 v197, v37, v157
    v_fmac_f32 v197, v38, v158
    v_fmac_f32 v197, v39, v159
    v_mul_f32 v199, v40, v120
    v_fmac_f32 v199, v41, v121
    v_fmac_f32 v199, v42, v122
    v_fmac_f32 v199, v43, v123
    v_fmac_f32 v199, v44, v124
    v_fmac_f32 v199, v45, v125
    v_fmac_f32 v199, v46, v126
    v_fmac_f32 v199, v47, v127
    s_add_u32 m0, s21, 4096
    v_mfma_f32_32x32x16_bf16 v[16:31], v[68:71], v[176:179], 0
    v_lshl_add_u32 v238, v238, 10, v246
    v_lshl_add_u32 v239, v239, 10, v246
    buffer_load_dwordx4 v238, s[4:7], s40 offen lds
    buffer_load_dwordx4 v239, s[8:11], s40 offen offset:1024 lds
    v_mul_f32_e64 v201, v48, -v168
    v_fma_f32 v201, v49, -v169, v201
    v_fma_f32 v201, v50, -v170, v201
    v_fma_f32 v201, v51, -v171, v201
    v_fma_f32 v201, v52, -v172, v201
    v_fma_f32 v201, v53, -v173, v201
    v_fma_f32 v201, v54, -v174, v201
    v_fma_f32 v201, v55, -v175, v201
    v_mul_f32_e64 v203, v56, -v168
    v_fma_f32 v203, v57, -v169, v203
    v_fma_f32 v203, v58, -v170, v203
    v_fma_f32 v203, v59, -v171, v203
    v_fma_f32 v203, v60, -v172, v203
    v_fma_f32 v203, v61, -v173, v203
    v_fma_f32 v203, v62, -v174, v203
    v_fma_f32 v203, v63, -v175, v203
    v_mfma_f32_32x32x16_bf16 v[32:47], v[64:67], v[180:183], 0
    v_mul_f32 v254, v0, v144
    v_fmac_f32 v254, v1, v145
    v_fmac_f32 v254, v2, v146
    v_fmac_f32 v254, v3, v147
    v_fmac_f32 v254, v4, v148
    v_fmac_f32 v254, v5, v149
    v_fmac_f32 v254, v6, v150
    v_fmac_f32 v254, v7, v151
    v_fmac_f32 v200, v8, v160
    v_mfma_f32_32x32x16_bf16 v[48:63], v[68:71], v[180:183], 0
    ds_swizzle_b32 v68, v68 offset:0x401F
    ds_swizzle_b32 v69, v69 offset:0x401F
    ds_swizzle_b32 v70, v70 offset:0x401F
    ds_swizzle_b32 v71, v71 offset:0x401F
    s_waitcnt vmcnt(6)
    ds_read_b64_tr_b16 v[176:177], v244 offset:6144
    ds_read_b64_tr_b16 v[178:179], v244 offset:7168
    ds_read_b64_tr_b16 v[180:181], v245 offset:6144
    ds_read_b64_tr_b16 v[182:183], v245 offset:7168
    v_fmac_f32 v200, v9, v161
    v_permlane32_swap_b32 v196, v254
    v_fmac_f32 v200, v10, v162
    v_fmac_f32 v200, v11, v163
    v_fmac_f32 v200, v12, v164
    v_fmac_f32 v200, v13, v165
    v_fmac_f32 v200, v14, v166
    v_fmac_f32 v200, v15, v167
    v_add_f32 v254, v196, v254
    s_waitcnt lgkmcnt(0)
    s_mov_b64 exec, s[56:57]
    v_xor_b32 v68, 0x80008000, v68
    v_xor_b32 v69, 0x80008000, v69
    v_xor_b32 v70, 0x80008000, v70
    v_xor_b32 v71, 0x80008000, v71
    s_mov_b64 exec, -1
    s_nop 0
    v_mfma_f32_32x32x16_bf16 v[0:15], v[64:67], v[176:179], 0
    v_mul_f32 v255, v32, v152
    v_fmac_f32 v255, v33, v153
    v_fmac_f32 v255, v34, v154
    v_fmac_f32 v255, v35, v155
    v_fmac_f32 v255, v36, v156
    v_fmac_f32 v255, v37, v157
    v_fmac_f32 v255, v38, v158
    v_fmac_f32 v255, v39, v159
    v_fmac_f32 v201, v40, v168
    v_fmac_f32 v201, v41, v169
    s_add_u32 m0, s21, 6144
    v_mfma_f32_32x32x16_bf16 v[16:31], v[68:71], v[176:179], v[16:31]
    v_lshl_add_u32 v240, v240, 10, v246
    v_lshl_add_u32 v241, v241, 10, v246
    buffer_load_dwordx4 v240, s[4:7], s41 offen lds
    buffer_load_dwordx4 v241, s[8:11], s41 offen offset:1024 lds
    v_permlane32_swap_b32 v197, v255
    v_fmac_f32 v201, v42, v170
    v_fmac_f32 v201, v43, v171
    v_fmac_f32 v201, v44, v172
    v_fmac_f32 v201, v45, v173
    v_fmac_f32 v201, v46, v174
    v_fmac_f32 v201, v47, v175
    v_add_f32 v255, v197, v255
    v_cvt_pk_bf16_f32 v254, v254, v255
    ds_write_b32 v253, v254 offset:512
    v_mfma_f32_32x32x16_bf16 v[32:47], v[64:67], v[180:183], 0
    v_mul_f32 v254, v0, v144
    v_fmac_f32 v254, v1, v145
    v_fmac_f32 v254, v2, v146
    v_fmac_f32 v254, v3, v147
    v_fmac_f32 v254, v4, v148
    v_fmac_f32 v254, v5, v149
    v_fmac_f32 v254, v6, v150
    v_fmac_f32 v254, v7, v151
    v_fma_f32 v202, v8, -v160, v202
    v_fma_f32 v202, v9, -v161, v202
    v_permlane32_swap_b32 v254, v200
    v_fma_f32 v202, v10, -v162, v202
    v_fma_f32 v202, v11, -v163, v202
    v_fma_f32 v202, v12, -v164, v202
    v_fma_f32 v202, v13, -v165, v202
    v_fma_f32 v202, v14, -v166, v202
    v_fma_f32 v202, v15, -v167, v202
    v_add_f32 v200, v254, v200
    v_fmac_f32 v198, v16, v112
    v_permlane32_swap_b32 v202, v254
    v_mfma_f32_32x32x16_bf16 v[48:63], v[68:71], v[180:183], v[48:63]
    s_waitcnt vmcnt(6)
    ds_read_b64_tr_b16 v[176:177], v244 offset:0
    ds_read_b64_tr_b16 v[178:179], v244 offset:1024
    ds_read_b64_tr_b16 v[180:181], v245 offset:0
    ds_read_b64_tr_b16 v[182:183], v245 offset:1024
    v_add_u32 v249, s48, v249
    v_add_u32 v250, s49, v250
    ds_read_b32 v252, v251 offset:16
    ds_read_b64_tr_b16 v[68:69], v249 offset:0
    ds_read_b64_tr_b16 v[70:71], v249 offset:256
    s_mov_b64 exec, s[54:55]
    ds_read_u16_d16_hi v242, v250 offset:0
    s_mov_b64 exec, -1
    v_fmac_f32 v198, v17, v113
    v_fmac_f32 v198, v18, v114
    v_fmac_f32 v198, v19, v115
    v_fmac_f32 v198, v20, v116
    v_fmac_f32 v198, v21, v117
    v_fmac_f32 v198, v22, v118
    v_fmac_f32 v198, v23, v119
    v_add_f32 v254, v202, v254
    v_mul_f32 v196, v24, v160
    v_fmac_f32 v196, v25, v161
    v_fmac_f32 v196, v26, v162
    v_fmac_f32 v196, v27, v163
    v_fmac_f32 v196, v28, v164
    v_fmac_f32 v196, v29, v165
    v_fmac_f32 v196, v30, v166
    v_fmac_f32 v196, v31, v167
    s_nop 1
    v_permlane32_swap_b32 v198, v196
    v_add_f32 v196, v198, v196
    v_mul_f32 v255, v32, v152
    v_fmac_f32 v255, v33, v153
    v_fmac_f32 v255, v34, v154
    v_fmac_f32 v255, v35, v155
    v_fmac_f32 v255, v36, v156
    v_fmac_f32 v255, v37, v157
    v_fmac_f32 v255, v38, v158
    v_fmac_f32 v255, v39, v159
    v_fma_f32 v203, v40, -v168, v203
    v_fma_f32 v203, v41, -v169, v203
    v_permlane32_swap_b32 v255, v201
    v_fma_f32 v203, v42, -v170, v203
    v_fma_f32 v203, v43, -v171, v203
    v_fma_f32 v203, v44, -v172, v203
    v_fma_f32 v203, v45, -v173, v203
    v_fma_f32 v203, v46, -v174, v203
    v_fma_f32 v203, v47, -v175, v203
    v_add_f32 v201, v255, v201
    v_fmac_f32 v199, v48, v120
    v_permlane32_swap_b32 v203, v255
    v_fmac_f32 v199, v49, v121
    v_fmac_f32 v199, v50, v122
    v_fmac_f32 v199, v51, v123
    v_fmac_f32 v199, v52, v124
    v_fmac_f32 v199, v53, v125
    v_fmac_f32 v199, v54, v126
    v_fmac_f32 v199, v55, v127
    v_add_f32 v255, v203, v255
    v_mul_f32 v197, v56, v168
    v_fmac_f32 v197, v57, v169
    v_fmac_f32 v197, v58, v170
    v_fmac_f32 v197, v59, v171
    v_fmac_f32 v197, v60, v172
    v_fmac_f32 v197, v61, v173
    v_fmac_f32 v197, v62, v174
    v_fmac_f32 v197, v63, v175
    s_nop 1
    v_permlane32_swap_b32 v199, v197
    v_add_f32 v197, v199, v197
    v_cvt_pk_bf16_f32 v200, v200, v201
    v_cvt_pk_bf16_f32 v254, v254, v255
    v_cvt_pk_bf16_f32 v196, v196, v197
    ds_write_b32 v253, v200 offset:768
    s_mov_b64 exec, 0xffffffff
    ds_write_b32 v253, v254 offset:1280
    s_mov_b64 exec, -1
    ds_write_b32 v253, v196 offset:1024
    s_add_u32 s50, s50, 1
    s_cmp_ge_u32 s50, 5
    s_cbranch_scc1 TAIL
    s_waitcnt lgkmcnt(6)
    v_readfirstlane_b32 s66, v252
    s_add_u32 s53, s53, 1
    v_mov_b32 v252, s53
    s_cmp_le_u32 s53, s66
    ds_write2_b32 v251, v252, v252 offset0:0 offset1:8
    s_setprio 1
    s_cbranch_scc1 PRIO_15
    s_setprio 0
PRIO_15:
    s_cmp_eq_u32 s52, 4
    s_cbranch_scc1 ITEM_1_4
    s_cmp_eq_u32 s52, 5
    s_cbranch_scc1 ITEM_1_5
    s_cmp_eq_u32 s52, 3
    s_cbranch_scc1 ITEM_1_3
    s_cmp_eq_u32 s52, 6
    s_cbranch_scc1 ITEM_1_6
    s_cmp_eq_u32 s52, 8
    s_cbranch_scc1 ITEM_1_8
    s_branch ITEM_1_2
.p2align 6
TAIL:
    s_setprio 0
    s_waitcnt vmcnt(0) lgkmcnt(0)
    v_mbcnt_lo_u32_b32 v176, -1, 0
    v_mbcnt_hi_u32_b32 v176, -1, v176
    v_lshlrev_b32 v180, 4, v176
    s_cmp_eq_u32 s89, 0
    s_cbranch_scc1 T_flags
    s_mul_i32 s66, s20, 80
    v_lshlrev_b32 v2, 2, v176
    v_min_u32 v2, 76, v2
    s_mov_b32 s67, 262144
T_poll:
    buffer_load_dword v3, v2, s[16:19], s66 offen offset:128 sc1
    s_waitcnt vmcnt(0)
    v_cmp_ne_u32 vcc, s88, v3
    s_sub_u32 s67, s67, 1
    s_cselect_b64 vcc, 0, vcc
    s_cmp_eq_u64 vcc, 0
    s_cbranch_scc0 T_poll
    s_mov_b32 s89, 0
T_flags:
    s_mul_i32 s66, s20, 20480
    s_add_u32 s66, s66, 1024
    buffer_load_dwordx4 v[96:99], v180, s[16:19], s66 offen offset:0 sc1
    buffer_load_dwordx4 v[100:103], v180, s[16:19], s66 offen offset:1024 sc1
    buffer_load_dwordx4 v[104:107], v180, s[16:19], s66 offen offset:2048 sc1
    buffer_load_dwordx4 v[108:111], v180, s[16:19], s66 offen offset:3072 sc1
    s_add_u32 s66, s66, 4096
    buffer_load_dwordx4 v[112:115], v180, s[16:19], s66 offen offset:0 sc1
    buffer_load_dwordx4 v[116:119], v180, s[16:19], s66 offen offset:1024 sc1
    buffer_load_dwordx4 v[120:123], v180, s[16:19], s66 offen offset:2048 sc1
    buffer_load_dwordx4 v[124:127], v180, s[16:19], s66 offen offset:3072 sc1
    s_add_u32 s66, s66, 4096
    buffer_load_dwordx4 v[128:131], v180, s[16:19], s66 offen offset:0 sc1
    buffer_load_dwordx4 v[132:135], v180, s[16:19], s66 offen offset:1024 sc1
    buffer_load_dwordx4 v[136:139], v180, s[16:19], s66 offen offset:2048 sc1
    buffer_load_dwordx4 v[140:143], v180, s[16:19], s66 offen offset:3072 sc1
    s_add_u32 s66, s66, 4096
    buffer_load_dwordx4 v[144:147], v180, s[16:19], s66 offen offset:0 sc1
    buffer_load_dwordx4 v[148:151], v180, s[16:19], s66 offen offset:1024 sc1
    buffer_load_dwordx4 v[152:155], v180, s[16:19], s66 offen offset:2048 sc1
    buffer_load_dwordx4 v[156:159], v180, s[16:19], s66 offen offset:3072 sc1
    s_add_u32 s66, s66, 4096
    buffer_load_dwordx4 v[160:163], v180, s[16:19], s66 offen offset:0 sc1
    buffer_load_dwordx4 v[164:167], v180, s[16:19], s66 offen offset:1024 sc1
    buffer_load_dwordx4 v[168:171], v180, s[16:19], s66 offen offset:2048 sc1
    buffer_load_dwordx4 v[172:175], v180, s[16:19], s66 offen offset:3072 sc1
    v_lshlrev_b32 v181, 2, v176
    s_bfe_u32 s67, s22, 0x40015
    s_lshl_b32 s67, s67, 4
    s_and_b32 s68, s67, 128
    s_and_b32 s67, s67, 0x70
    s_add_u32 s68, s68, s21
    v_xor_b32 v180, s67, v181
    v_add_u32 v180, s68, v180
    ds_write_b32 v180, v204 offset:0
    ds_write_b32 v180, v205 offset:256
    ds_write_b32 v180, v206 offset:512
    ds_write_b32 v180, v207 offset:768
    ds_write_b32 v180, v208 offset:1024
    s_mov_b64 exec, 0xffffffff
    ds_write_b32 v180, v209 offset:1280
    s_mov_b64 exec, -1
    s_bfe_u32 s67, s23, 0x40015
    s_lshl_b32 s67, s67, 4
    s_and_b32 s68, s67, 128
    s_and_b32 s67, s67, 0x70
    s_add_u32 s68, s68, s21
    v_xor_b32 v180, s67, v181
    v_add_u32 v180, s68, v180
    ds_write_b32 v180, v210 offset:1536
    ds_write_b32 v180, v211 offset:1792
    ds_write_b32 v180, v212 offset:2048
    ds_write_b32 v180, v213 offset:2304
    ds_write_b32 v180, v214 offset:2560
    s_mov_b64 exec, 0xffffffff
    ds_write_b32 v180, v215 offset:2816
    s_mov_b64 exec, -1
    s_bfe_u32 s67, s24, 0x40015
    s_lshl_b32 s67, s67, 4
    s_and_b32 s68, s67, 128
    s_and_b32 s67, s67, 0x70
    s_add_u32 s68, s68, s21
    v_xor_b32 v180, s67, v181
    v_add_u32 v180, s68, v180
    ds_write_b32 v180, v216 offset:3072
    ds_write_b32 v180, v217 offset:3328
    ds_write_b32 v180, v218 offset:3584
    ds_write_b32 v180, v219 offset:3840
    ds_write_b32 v180, v220 offset:4096
    s_mov_b64 exec, 0xffffffff
    ds_write_b32 v180, v221 offset:4352
    s_mov_b64 exec, -1
    s_bfe_u32 s67, s25, 0x40015
    s_lshl_b32 s67, s67, 4
    s_and_b32 s68, s67, 128
    s_and_b32 s67, s67, 0x70
    s_add_u32 s68, s68, s21
    v_xor_b32 v180, s67, v181
    v_add_u32 v180, s68, v180
    ds_write_b32 v180, v222 offset:4608
    ds_write_b32 v180, v223 offset:4864
    ds_write_b32 v180, v224 offset:5120
    ds_write_b32 v180, v225 offset:5376
    ds_write_b32 v180, v226 offset:5632
    s_mov_b64 exec, 0xffffffff
    ds_write_b32 v180, v227 offset:5888
    s_mov_b64 exec, -1
    s_bfe_u32 s67, s26, 0x40015
    s_lshl_b32 s67, s67, 4
    s_and_b32 s68, s67, 128
    s_and_b32 s67, s67, 0x70
    s_add_u32 s68, s68, s21
    v_xor_b32 v180, s67, v181
    v_add_u32 v180, s68, v180
    ds_write_b32 v180, v228 offset:6144
    ds_write_b32 v180, v229 offset:6400
    ds_write_b32 v180, v230 offset:6656
    ds_write_b32 v180, v231 offset:6912
    ds_write_b32 v180, v232 offset:7168
    s_mov_b64 exec, 0xffffffff
    ds_write_b32 v180, v233 offset:7424
    s_mov_b64 exec, -1
GEMM:
    s_load_dwordx2 s[72:73], s[0:1], 72
    v_and_b32 v177, 15, v176
    v_lshrrev_b32 v178, 4, v176
    v_and_b32 v179, 7, v177
    v_lshlrev_b32 v180, 3, v177
    v_lshlrev_b32 v181, 3, v179
    v_add_u32 v180, 163328, v180
    v_add_u32 v181, 163328, v181
    ds_read_b64 v[182:183], v180
    ds_read_b64 v[184:185], v180 offset:128
    ds_read_b64 v[186:187], v181 offset:256
    v_xor_b32 v180, v179, v178
    v_and_b32 v181, 8, v177
    v_xor_b32 v188, 4, v180
    v_add_u32 v189, v188, v181
    v_add_u32 v181, v180, v181
    s_waitcnt lgkmcnt(0)
    s_mov_b32 s4, s72
    s_and_b32 s5, s73, 0xffff
    s_mov_b32 s6, 10240000
    s_mov_b32 s7, 0x20000
    v_lshl_add_u32 v48, v180, 4, v182
    v_lshl_add_u32 v49, v188, 4, v182
    v_lshl_add_u32 v50, v180, 4, v183
    v_lshl_add_u32 v51, v188, 4, v183
    v_lshl_add_u32 v52, v180, 4, v184
    v_lshl_add_u32 v53, v188, 4, v184
    v_lshl_add_u32 v54, v180, 4, v185
    v_lshl_add_u32 v55, v188, 4, v185
    v_lshl_add_u32 v56, v181, 4, v186
    v_lshl_add_u32 v57, v189, 4, v186
    v_lshl_add_u32 v58, v181, 4, v187
    v_lshl_add_u32 v59, v189, 4, v187
    s_mov_b32 s67, 0xbfb8aa3b
    v_lshrrev_b32 v205, 1, v178
    v_lshl_add_u32 v205, s20, 1, v205
    v_and_b32 v204, 7, v177
    v_xor_b32 v205, v205, v204
    v_and_b32 v204, 1, v178
    v_lshlrev_b32 v204, 3, v204
    v_lshl_add_u32 v205, v205, 4, v204
    v_and_b32 v204, 8, v177
    v_lshl_add_u32 v204, v204, 4, v205
    v_lshl_add_u32 v204, v177, 10, v204
    v_add_u32 v204, 65536, v204
    v_add_u32 v205, v205, v182
    v_lshlrev_b32 v210, 4, v176
    s_lshl_b32 s68, s20, 1
    s_add_u32 s69, s68, 1
    v_readlane_b32 s24, v182, s68
    v_readlane_b32 s25, v182, s69
    s_and_b32 s70, s68, 7
    s_lshl_b32 s70, s70, 4
    v_xor_b32 v206, s70, v210
    v_xor_b32 v207, 16, v206
    v_add_u32 v208, s24, v206
    v_add_u32 v209, s25, v207
    s_lshl_b32 s70, s68, 10
    s_and_b32 s71, s68, 8
    s_lshl_b32 s71, s71, 4
    s_add_u32 s71, s71, s70
    s_add_u32 s71, s71, 65536
    v_add_u32 v206, s71, v206
    v_add_u32 v207, s71, v207
    s_mul_i32 s66, s2, 40960
    s_add_u32 s22, s66, s70
    s_add_u32 s23, s22, 0x4000
    s_lshl_b32 s70, s20, 10
    s_add_u32 s66, s66, s70
    s_add_u32 s66, s66, 0x8000
    s_add_u32 s70, s70, 65536
    s_lshl_b32 s71, s20, 4
    v_xor_b32 v211, s71, v210
    v_add_u32 v211, s70, v211
    s_barrier
    ds_read_b128 v[72:75], v48 offset:0
    ds_read_b128 v[76:79], v52 offset:0
    ds_read_b128 v[80:83], v56 offset:0
    ds_read_b128 v[84:87], v49 offset:0
    ds_read_b128 v[88:91], v53 offset:0
    ds_read_b128 v[92:95], v57 offset:0
    s_waitcnt vmcnt(19) lgkmcnt(5)
    v_mfma_f32_16x16x32_bf16 v[0:3], v[96:99], v[72:75], 0
    ds_read_b128 v[72:75], v50 offset:0
    s_waitcnt lgkmcnt(5)
    v_mfma_f32_16x16x32_bf16 v[4:7], v[96:99], v[76:79], 0
    ds_read_b128 v[76:79], v54 offset:0
    s_waitcnt lgkmcnt(5)
    v_mfma_f32_16x16x32_bf16 v[8:11], v[96:99], v[80:83], 0
    ds_read_b128 v[80:83], v58 offset:0
    s_waitcnt vmcnt(18) lgkmcnt(5)
    v_mfma_f32_16x16x32_bf16 v[0:3], v[100:103], v[84:87], v[0:3]
    ds_read_b128 v[84:87], v51 offset:0
    s_waitcnt lgkmcnt(5)
    v_mfma_f32_16x16x32_bf16 v[4:7], v[100:103], v[88:91], v[4:7]
    ds_read_b128 v[88:91], v55 offset:0
    s_waitcnt lgkmcnt(5)
    v_mfma_f32_16x16x32_bf16 v[8:11], v[100:103], v[92:95], v[8:11]
    ds_read_b128 v[92:95], v59 offset:0
    s_waitcnt vmcnt(17) lgkmcnt(5)
    v_mfma_f32_16x16x32_bf16 v[0:3], v[104:107], v[72:75], v[0:3]
    ds_read_b128 v[72:75], v48 offset:1024
    s_waitcnt lgkmcnt(5)
    v_mfma_f32_16x16x32_bf16 v[4:7], v[104:107], v[76:79], v[4:7]
    ds_read_b128 v[76:79], v52 offset:1024
    s_waitcnt lgkmcnt(5)
    v_mfma_f32_16x16x32_bf16 v[8:11], v[104:107], v[80:83], v[8:11]
    ds_read_b128 v[80:83], v56 offset:1024
    s_waitcnt vmcnt(16) lgkmcnt(5)
    v_mfma_f32_16x16x32_bf16 v[0:3], v[108:111], v[84:87], v[0:3]
    ds_read_b128 v[84:87], v49 offset:1024
    s_waitcnt lgkmcnt(5)
    v_mfma_f32_16x16x32_bf16 v[4:7], v[108:111], v[88:91], v[4:7]
    ds_read_b128 v[88:91], v53 offset:1024
    s_waitcnt lgkmcnt(5)
    v_mfma_f32_16x16x32_bf16 v[8:11], v[108:111], v[92:95], v[8:11]
    ds_read_b128 v[92:95], v57 offset:1024
    s_waitcnt vmcnt(15) lgkmcnt(5)
    v_mfma_f32_16x16x32_bf16 v[0:3], v[112:115], v[72:75], v[0:3]
    ds_read_b128 v[72:75], v50 offset:1024
    s_waitcnt lgkmcnt(5)
    v_mfma_f32_16x16x32_bf16 v[4:7], v[112:115], v[76:79], v[4:7]
    ds_read_b128 v[76:79], v54 offset:1024
    s_waitcnt lgkmcnt(5)
    v_mfma_f32_16x16x32_bf16 v[8:11], v[112:115], v[80:83], v[8:11]
    ds_read_b128 v[80:83], v58 offset:1024
    s_waitcnt vmcnt(14) lgkmcnt(5)
    v_mfma_f32_16x16x32_bf16 v[0:3], v[116:119], v[84:87], v[0:3]
    ds_read_b128 v[84:87], v51 offset:1024
    s_waitcnt lgkmcnt(5)
    v_mfma_f32_16x16x32_bf16 v[4:7], v[116:119], v[88:91], v[4:7]
    ds_read_b128 v[88:91], v55 offset:1024
    s_waitcnt lgkmcnt(5)
    v_mfma_f32_16x16x32_bf16 v[8:11], v[116:119], v[92:95], v[8:11]
    ds_read_b128 v[92:95], v59 offset:1024
    s_waitcnt vmcnt(13) lgkmcnt(5)
    v_mfma_f32_16x16x32_bf16 v[0:3], v[120:123], v[72:75], v[0:3]
    ds_read_b128 v[72:75], v48 offset:128
    s_waitcnt lgkmcnt(5)
    v_mfma_f32_16x16x32_bf16 v[4:7], v[120:123], v[76:79], v[4:7]
    ds_read_b128 v[76:79], v48 offset:256
    s_waitcnt lgkmcnt(5)
    v_mfma_f32_16x16x32_bf16 v[8:11], v[120:123], v[80:83], v[8:11]
    ds_read_b128 v[80:83], v48 offset:384
    s_waitcnt vmcnt(12) lgkmcnt(5)
    v_mfma_f32_16x16x32_bf16 v[0:3], v[124:127], v[84:87], v[0:3]
    ds_read_b128 v[84:87], v49 offset:128
    s_waitcnt lgkmcnt(5)
    v_mfma_f32_16x16x32_bf16 v[4:7], v[124:127], v[88:91], v[4:7]
    ds_read_b128 v[88:91], v49 offset:256
    s_waitcnt lgkmcnt(5)
    v_mfma_f32_16x16x32_bf16 v[8:11], v[124:127], v[92:95], v[8:11]
    ds_read_b128 v[92:95], v49 offset:384
    s_waitcnt vmcnt(11) lgkmcnt(5)
    v_mfma_f32_16x16x32_bf16 v[12:15], v[128:131], v[72:75], 0
    ds_read_b128 v[72:75], v50 offset:128
    s_waitcnt lgkmcnt(5)
    v_mfma_f32_16x16x32_bf16 v[24:27], v[128:131], v[76:79], 0
    ds_read_b128 v[76:79], v50 offset:256
    s_waitcnt lgkmcnt(5)
    v_mfma_f32_16x16x32_bf16 v[36:39], v[128:131], v[80:83], 0
    ds_read_b128 v[80:83], v50 offset:384
    s_waitcnt vmcnt(10) lgkmcnt(5)
    v_mfma_f32_16x16x32_bf16 v[12:15], v[132:135], v[84:87], v[12:15]
    v_mul_f32 v192, s67, v0
    v_mul_f32 v193, s67, v1
    ds_read_b128 v[84:87], v51 offset:128
    s_waitcnt lgkmcnt(5)
    v_mfma_f32_16x16x32_bf16 v[24:27], v[132:135], v[88:91], v[24:27]
    v_mul_f32 v194, s67, v2
    v_mul_f32 v195, s67, v3
    ds_read_b128 v[88:91], v51 offset:256
    s_waitcnt lgkmcnt(5)
    v_mfma_f32_16x16x32_bf16 v[36:39], v[132:135], v[92:95], v[36:39]
    v_exp_f32 v192, v192
    v_exp_f32 v193, v193
    ds_read_b128 v[92:95], v51 offset:384
    s_waitcnt vmcnt(9) lgkmcnt(5)
    v_mfma_f32_16x16x32_bf16 v[12:15], v[136:139], v[72:75], v[12:15]
    v_exp_f32 v194, v194
    v_exp_f32 v195, v195
    ds_read_b128 v[72:75], v48 offset:512
    s_waitcnt lgkmcnt(5)
    v_mfma_f32_16x16x32_bf16 v[24:27], v[136:139], v[76:79], v[24:27]
    v_add_f32 v192, 1.0, v192
    v_add_f32 v193, 1.0, v193
    ds_read_b128 v[76:79], v48 offset:640
    s_waitcnt lgkmcnt(5)
    v_mfma_f32_16x16x32_bf16 v[36:39], v[136:139], v[80:83], v[36:39]
    v_add_f32 v194, 1.0, v194
    v_add_f32 v195, 1.0, v195
    ds_read_b128 v[80:83], v48 offset:768
    s_waitcnt vmcnt(8) lgkmcnt(5)
    v_mfma_f32_16x16x32_bf16 v[12:15], v[140:143], v[84:87], v[12:15]
    v_rcp_f32 v192, v192
    v_rcp_f32 v193, v193
    ds_read_b128 v[84:87], v49 offset:512
    s_waitcnt lgkmcnt(5)
    v_mfma_f32_16x16x32_bf16 v[24:27], v[140:143], v[88:91], v[24:27]
    v_rcp_f32 v194, v194
    v_rcp_f32 v195, v195
    ds_read_b128 v[88:91], v49 offset:640
    s_waitcnt lgkmcnt(5)
    v_mfma_f32_16x16x32_bf16 v[36:39], v[140:143], v[92:95], v[36:39]
    v_mul_f32 v196, s67, v4
    v_mul_f32 v197, s67, v5
    ds_read_b128 v[92:95], v49 offset:768
    s_waitcnt vmcnt(7) lgkmcnt(5)
    v_mfma_f32_16x16x32_bf16 v[12:15], v[144:147], v[72:75], v[12:15]
    v_mul_f32 v198, s67, v6
    v_mul_f32 v199, s67, v7
    ds_read_b128 v[72:75], v50 offset:512
    s_waitcnt lgkmcnt(5)
    v_mfma_f32_16x16x32_bf16 v[24:27], v[144:147], v[76:79], v[24:27]
    v_exp_f32 v196, v196
    v_exp_f32 v197, v197
    ds_read_b128 v[76:79], v50 offset:640
    s_waitcnt lgkmcnt(5)
    v_mfma_f32_16x16x32_bf16 v[36:39], v[144:147], v[80:83], v[36:39]
    v_exp_f32 v198, v198
    v_exp_f32 v199, v199
    ds_read_b128 v[80:83], v50 offset:768
    s_waitcnt vmcnt(6) lgkmcnt(5)
    v_mfma_f32_16x16x32_bf16 v[12:15], v[148:151], v[84:87], v[12:15]
    v_add_f32 v196, 1.0, v196
    v_add_f32 v197, 1.0, v197
    ds_read_b128 v[84:87], v51 offset:512
    s_waitcnt lgkmcnt(5)
    v_mfma_f32_16x16x32_bf16 v[24:27], v[148:151], v[88:91], v[24:27]
    v_add_f32 v198, 1.0, v198
    v_add_f32 v199, 1.0, v199
    ds_read_b128 v[88:91], v51 offset:640
    s_waitcnt lgkmcnt(5)
    v_mfma_f32_16x16x32_bf16 v[36:39], v[148:151], v[92:95], v[36:39]
    v_rcp_f32 v196, v196
    v_rcp_f32 v197, v197
    ds_read_b128 v[92:95], v51 offset:768
    s_waitcnt vmcnt(5) lgkmcnt(5)
    v_mfma_f32_16x16x32_bf16 v[12:15], v[152:155], v[72:75], v[12:15]
    v_rcp_f32 v198, v198
    v_rcp_f32 v199, v199
    ds_read_b128 v[72:75], v48 offset:1152
    s_waitcnt lgkmcnt(5)
    v_mfma_f32_16x16x32_bf16 v[24:27], v[152:155], v[76:79], v[24:27]
    v_mul_f32 v200, s67, v8
    v_mul_f32 v201, s67, v9
    ds_read_b128 v[76:79], v48 offset:1280
    s_waitcnt lgkmcnt(5)
    v_mfma_f32_16x16x32_bf16 v[36:39], v[152:155], v[80:83], v[36:39]
    v_mul_f32 v202, s67, v10
    v_mul_f32 v203, s67, v11
    ds_read_b128 v[80:83], v48 offset:896
    s_waitcnt vmcnt(4) lgkmcnt(5)
    v_mfma_f32_16x16x32_bf16 v[12:15], v[156:159], v[84:87], v[12:15]
    v_exp_f32 v200, v200
    v_exp_f32 v201, v201
    ds_read_b128 v[84:87], v49 offset:1152
    s_waitcnt lgkmcnt(5)
    v_mfma_f32_16x16x32_bf16 v[24:27], v[156:159], v[88:91], v[24:27]
    v_exp_f32 v202, v202
    v_exp_f32 v203, v203
    ds_read_b128 v[88:91], v49 offset:1280
    s_waitcnt lgkmcnt(5)
    v_mfma_f32_16x16x32_bf16 v[36:39], v[156:159], v[92:95], v[36:39]
    v_add_f32 v200, 1.0, v200
    v_add_f32 v201, 1.0, v201
    ds_read_b128 v[92:95], v49 offset:896
    s_waitcnt vmcnt(3) lgkmcnt(5)
    v_mfma_f32_16x16x32_bf16 v[12:15], v[160:163], v[72:75], v[12:15]
    v_add_f32 v202, 1.0, v202
    v_add_f32 v203, 1.0, v203
    ds_read_b128 v[72:75], v50 offset:1152
    s_waitcnt lgkmcnt(5)
    v_mfma_f32_16x16x32_bf16 v[24:27], v[160:163], v[76:79], v[24:27]
    v_rcp_f32 v200, v200
    v_rcp_f32 v201, v201
    ds_read_b128 v[76:79], v50 offset:1280
    s_waitcnt lgkmcnt(5)
    v_mfma_f32_16x16x32_bf16 v[36:39], v[160:163], v[80:83], v[36:39]
    v_rcp_f32 v202, v202
    v_rcp_f32 v203, v203
    ds_read_b128 v[80:83], v50 offset:896
    s_waitcnt vmcnt(2) lgkmcnt(5)
    v_mfma_f32_16x16x32_bf16 v[12:15], v[164:167], v[84:87], v[12:15]
    v_cvt_pk_bf16_f32 v0, v0, v1
    v_cvt_pk_bf16_f32 v1, v2, v3
    ds_read_b128 v[84:87], v51 offset:1152
    s_waitcnt lgkmcnt(5)
    v_mfma_f32_16x16x32_bf16 v[24:27], v[164:167], v[88:91], v[24:27]
    ds_write_b64 v204, v[0:1] offset:0
    ds_read_b128 v[88:91], v51 offset:1280
    s_waitcnt lgkmcnt(6)
    v_mfma_f32_16x16x32_bf16 v[36:39], v[164:167], v[92:95], v[36:39]
    ds_read_b128 v[92:95], v51 offset:896
    s_waitcnt vmcnt(1) lgkmcnt(6)
    v_mfma_f32_16x16x32_bf16 v[12:15], v[168:171], v[72:75], v[12:15]
    ds_read_b128 v[72:75], v52 offset:128
    s_waitcnt lgkmcnt(6)
    v_mfma_f32_16x16x32_bf16 v[24:27], v[168:171], v[76:79], v[24:27]
    ds_read_b128 v[76:79], v53 offset:128
    s_waitcnt lgkmcnt(6)
    v_mfma_f32_16x16x32_bf16 v[36:39], v[168:171], v[80:83], v[36:39]
    ds_read_b128 v[80:83], v54 offset:128
    s_waitcnt vmcnt(0) lgkmcnt(6)
    v_mfma_f32_16x16x32_bf16 v[12:15], v[172:175], v[84:87], v[12:15]
    ds_read_b128 v[84:87], v55 offset:128
    s_waitcnt lgkmcnt(5)
    v_mfma_f32_16x16x32_bf16 v[24:27], v[172:175], v[88:91], v[24:27]
    ds_read_b128 v[88:91], v52 offset:512
    s_waitcnt lgkmcnt(5)
    v_mfma_f32_16x16x32_bf16 v[36:39], v[172:175], v[92:95], v[36:39]
    ds_read_b128 v[92:95], v53 offset:512
    s_waitcnt lgkmcnt(5)
    v_mfma_f32_16x16x32_bf16 v[16:19], v[128:131], v[72:75], 0
    ds_read_b128 v[72:75], v54 offset:512
    s_waitcnt lgkmcnt(5)
    v_mfma_f32_16x16x32_bf16 v[16:19], v[132:135], v[76:79], v[16:19]
    ds_read_b128 v[76:79], v55 offset:512
    s_waitcnt lgkmcnt(5)
    v_mfma_f32_16x16x32_bf16 v[16:19], v[136:139], v[80:83], v[16:19]
    v_mul_f32 v12, v12, v192
    v_mul_f32 v13, v13, v193
    ds_read_b128 v[80:83], v52 offset:1152
    s_waitcnt lgkmcnt(5)
    v_mfma_f32_16x16x32_bf16 v[16:19], v[140:143], v[84:87], v[16:19]
    v_mul_f32 v14, v14, v194
    v_mul_f32 v15, v15, v195
    ds_read_b128 v[84:87], v53 offset:1152
    s_waitcnt lgkmcnt(5)
    v_mfma_f32_16x16x32_bf16 v[16:19], v[144:147], v[88:91], v[16:19]
    v_cvt_pk_bf16_f32 v12, v12, v13
    v_cvt_pk_bf16_f32 v13, v14, v15
    ds_read_b128 v[88:91], v54 offset:1152
    s_waitcnt lgkmcnt(5)
    v_mfma_f32_16x16x32_bf16 v[16:19], v[148:151], v[92:95], v[16:19]
    ds_write_b64 v204, v[12:13] offset:256
    v_mul_f32 v24, v24, v192
    ds_read_b128 v[92:95], v55 offset:1152
    s_waitcnt lgkmcnt(6)
    v_mfma_f32_16x16x32_bf16 v[16:19], v[152:155], v[72:75], v[16:19]
    v_mul_f32 v25, v25, v193
    v_mul_f32 v26, v26, v194
    ds_read_b128 v[72:75], v52 offset:256
    s_waitcnt lgkmcnt(6)
    v_mfma_f32_16x16x32_bf16 v[16:19], v[156:159], v[76:79], v[16:19]
    v_mul_f32 v27, v27, v195
    v_cvt_pk_bf16_f32 v24, v24, v25
    ds_read_b128 v[76:79], v53 offset:256
    s_waitcnt lgkmcnt(6)
    v_mfma_f32_16x16x32_bf16 v[16:19], v[160:163], v[80:83], v[16:19]
    v_cvt_pk_bf16_f32 v25, v26, v27
    ds_write_b64 v204, v[24:25] offset:512
    ds_read_b128 v[80:83], v54 offset:256
    s_waitcnt lgkmcnt(7)
    v_mfma_f32_16x16x32_bf16 v[16:19], v[164:167], v[84:87], v[16:19]
    v_mul_f32 v36, v36, v192
    v_mul_f32 v37, v37, v193
    ds_read_b128 v[84:87], v55 offset:256
    s_waitcnt lgkmcnt(7)
    v_mfma_f32_16x16x32_bf16 v[16:19], v[168:171], v[88:91], v[16:19]
    v_mul_f32 v38, v38, v194
    v_mul_f32 v39, v39, v195
    ds_read_b128 v[88:91], v52 offset:640
    s_waitcnt lgkmcnt(6)
    v_mfma_f32_16x16x32_bf16 v[16:19], v[172:175], v[92:95], v[16:19]
    v_cvt_pk_bf16_f32 v36, v36, v37
    v_cvt_pk_bf16_f32 v37, v38, v39
    ds_read_b128 v[92:95], v53 offset:640
    s_waitcnt lgkmcnt(6)
    v_mfma_f32_16x16x32_bf16 v[28:31], v[128:131], v[72:75], 0
    ds_write_b64 v204, v[36:37] offset:768
    ds_read_b128 v[72:75], v54 offset:640
    s_waitcnt lgkmcnt(7)
    v_mfma_f32_16x16x32_bf16 v[28:31], v[132:135], v[76:79], v[28:31]
    ds_read_b128 v[76:79], v55 offset:640
    s_waitcnt lgkmcnt(6)
    v_mfma_f32_16x16x32_bf16 v[28:31], v[136:139], v[80:83], v[28:31]
    ds_read_b128 v[80:83], v52 offset:1280
    s_waitcnt lgkmcnt(6)
    v_mfma_f32_16x16x32_bf16 v[28:31], v[140:143], v[84:87], v[28:31]
    ds_read_b128 v[84:87], v53 offset:1280
    s_waitcnt lgkmcnt(6)
    v_mfma_f32_16x16x32_bf16 v[28:31], v[144:147], v[88:91], v[28:31]
    ds_read_b128 v[88:91], v54 offset:1280
    s_waitcnt lgkmcnt(6)
    v_mfma_f32_16x16x32_bf16 v[28:31], v[148:151], v[92:95], v[28:31]
    ds_read_b128 v[92:95], v55 offset:1280
    s_waitcnt lgkmcnt(5)
    v_mfma_f32_16x16x32_bf16 v[28:31], v[152:155], v[72:75], v[28:31]
    s_barrier
    ds_read_b128 v[72:75], v52 offset:384
    s_waitcnt lgkmcnt(5)
    v_mfma_f32_16x16x32_bf16 v[28:31], v[156:159], v[76:79], v[28:31]
    ds_read_b128 v[212:215], v206 offset:0
    ds_read_b128 v[216:219], v207 offset:1024
    ds_read_b128 v[76:79], v53 offset:384
    s_waitcnt lgkmcnt(7)
    v_mfma_f32_16x16x32_bf16 v[28:31], v[160:163], v[80:83], v[28:31]
    ds_read_b128 v[80:83], v54 offset:384
    s_waitcnt lgkmcnt(7)
    v_mfma_f32_16x16x32_bf16 v[28:31], v[164:167], v[84:87], v[28:31]
    ds_read_b128 v[84:87], v55 offset:384
    s_waitcnt lgkmcnt(7)
    v_mfma_f32_16x16x32_bf16 v[28:31], v[168:171], v[88:91], v[28:31]
    ds_read_b128 v[88:91], v52 offset:768
    s_waitcnt lgkmcnt(7)
    v_mfma_f32_16x16x32_bf16 v[28:31], v[172:175], v[92:95], v[28:31]
    ds_read_b128 v[92:95], v53 offset:768
    s_waitcnt lgkmcnt(7)
    v_mfma_f32_16x16x32_bf16 v[40:43], v[128:131], v[72:75], 0
    ds_read_b128 v[72:75], v54 offset:768
    s_waitcnt lgkmcnt(5)
    v_mfma_f32_16x16x32_bf16 v[40:43], v[132:135], v[76:79], v[40:43]
    buffer_store_dwordx4 v[212:215], v210, s[4:7], s22 offen offset:0 sc1
    ds_read_b128 v[76:79], v55 offset:768
    s_waitcnt lgkmcnt(5)
    v_mfma_f32_16x16x32_bf16 v[40:43], v[136:139], v[80:83], v[40:43]
    buffer_store_dwordx4 v[216:219], v210, s[4:7], s22 offen offset:1024 sc1
    ds_read_b128 v[80:83], v52 offset:896
    s_waitcnt lgkmcnt(5)
    v_mfma_f32_16x16x32_bf16 v[40:43], v[140:143], v[84:87], v[40:43]
    ds_read_b128 v[84:87], v53 offset:896
    s_waitcnt lgkmcnt(5)
    v_mfma_f32_16x16x32_bf16 v[40:43], v[144:147], v[88:91], v[40:43]
    ds_read_b128 v[88:91], v54 offset:896
    s_waitcnt lgkmcnt(5)
    v_mfma_f32_16x16x32_bf16 v[40:43], v[148:151], v[92:95], v[40:43]
    ds_read_b128 v[92:95], v55 offset:896
    s_waitcnt lgkmcnt(5)
    v_mfma_f32_16x16x32_bf16 v[40:43], v[152:155], v[72:75], v[40:43]
    v_cvt_pk_bf16_f32 v4, v4, v5
    v_cvt_pk_bf16_f32 v5, v6, v7
    ds_read_b128 v[72:75], v56 offset:128
    s_waitcnt lgkmcnt(5)
    v_mfma_f32_16x16x32_bf16 v[40:43], v[156:159], v[76:79], v[40:43]
    ds_write_b64 v205, v[4:5] offset:0
    v_mul_f32 v16, v16, v196
    ds_read_b128 v[76:79], v57 offset:128
    s_waitcnt lgkmcnt(6)
    v_mfma_f32_16x16x32_bf16 v[40:43], v[160:163], v[80:83], v[40:43]
    v_mul_f32 v17, v17, v197
    v_mul_f32 v18, v18, v198
    ds_read_b128 v[80:83], v58 offset:128
    s_waitcnt lgkmcnt(6)
    v_mfma_f32_16x16x32_bf16 v[40:43], v[164:167], v[84:87], v[40:43]
    v_mul_f32 v19, v19, v199
    v_cvt_pk_bf16_f32 v16, v16, v17
    ds_read_b128 v[84:87], v59 offset:128
    s_waitcnt lgkmcnt(6)
    v_mfma_f32_16x16x32_bf16 v[40:43], v[168:171], v[88:91], v[40:43]
    v_cvt_pk_bf16_f32 v17, v18, v19
    ds_write_b64 v205, v[16:17] offset:256
    ds_read_b128 v[88:91], v56 offset:512
    s_waitcnt lgkmcnt(7)
    v_mfma_f32_16x16x32_bf16 v[40:43], v[172:175], v[92:95], v[40:43]
    v_mul_f32 v28, v28, v196
    v_mul_f32 v29, v29, v197
    ds_read_b128 v[92:95], v57 offset:512
    s_waitcnt lgkmcnt(7)
    v_mfma_f32_16x16x32_bf16 v[20:23], v[128:131], v[72:75], 0
    v_mul_f32 v30, v30, v198
    v_mul_f32 v31, v31, v199
    ds_read_b128 v[72:75], v58 offset:512
    s_waitcnt lgkmcnt(6)
    v_mfma_f32_16x16x32_bf16 v[20:23], v[132:135], v[76:79], v[20:23]
    v_cvt_pk_bf16_f32 v28, v28, v29
    v_cvt_pk_bf16_f32 v29, v30, v31
    ds_read_b128 v[76:79], v59 offset:512
    s_waitcnt lgkmcnt(6)
    v_mfma_f32_16x16x32_bf16 v[20:23], v[136:139], v[80:83], v[20:23]
    ds_write_b64 v205, v[28:29] offset:512
    ds_read_b128 v[80:83], v56 offset:1152
    s_waitcnt lgkmcnt(7)
    v_mfma_f32_16x16x32_bf16 v[20:23], v[140:143], v[84:87], v[20:23]
    v_mul_f32 v40, v40, v196
    v_mul_f32 v41, v41, v197
    ds_read_b128 v[84:87], v57 offset:1152
    s_waitcnt lgkmcnt(6)
    v_mfma_f32_16x16x32_bf16 v[20:23], v[144:147], v[88:91], v[20:23]
    v_mul_f32 v42, v42, v198
    v_mul_f32 v43, v43, v199
    ds_read_b128 v[88:91], v58 offset:1152
    s_waitcnt lgkmcnt(6)
    v_mfma_f32_16x16x32_bf16 v[20:23], v[148:151], v[92:95], v[20:23]
    v_cvt_pk_bf16_f32 v40, v40, v41
    v_cvt_pk_bf16_f32 v41, v42, v43
    ds_read_b128 v[92:95], v59 offset:1152
    s_waitcnt lgkmcnt(6)
    v_mfma_f32_16x16x32_bf16 v[20:23], v[152:155], v[72:75], v[20:23]
    ds_write_b64 v205, v[40:41] offset:768
    ds_read_b128 v[72:75], v56 offset:256
    s_waitcnt lgkmcnt(7)
    v_mfma_f32_16x16x32_bf16 v[20:23], v[156:159], v[76:79], v[20:23]
    ds_read_b128 v[76:79], v57 offset:256
    s_waitcnt lgkmcnt(6)
    v_mfma_f32_16x16x32_bf16 v[20:23], v[160:163], v[80:83], v[20:23]
    ds_read_b128 v[80:83], v58 offset:256
    s_waitcnt lgkmcnt(6)
    v_mfma_f32_16x16x32_bf16 v[20:23], v[164:167], v[84:87], v[20:23]
    ds_read_b128 v[84:87], v59 offset:256
    s_waitcnt lgkmcnt(6)
    v_mfma_f32_16x16x32_bf16 v[20:23], v[168:171], v[88:91], v[20:23]
    ds_read_b128 v[88:91], v56 offset:640
    s_waitcnt lgkmcnt(6)
    v_mfma_f32_16x16x32_bf16 v[20:23], v[172:175], v[92:95], v[20:23]
    ds_read_b128 v[92:95], v57 offset:640
    s_waitcnt lgkmcnt(5)
    v_mfma_f32_16x16x32_bf16 v[32:35], v[128:131], v[72:75], 0
    s_barrier
    ds_read_b128 v[72:75], v58 offset:640
    s_waitcnt lgkmcnt(5)
    v_mfma_f32_16x16x32_bf16 v[32:35], v[132:135], v[76:79], v[32:35]
    ds_read_b128 v[212:215], v208 offset:0
    ds_read_b128 v[216:219], v209 offset:0
    ds_read_b128 v[76:79], v59 offset:640
    s_waitcnt lgkmcnt(7)
    v_mfma_f32_16x16x32_bf16 v[32:35], v[136:139], v[80:83], v[32:35]
    ds_read_b128 v[80:83], v56 offset:1280
    s_waitcnt lgkmcnt(7)
    v_mfma_f32_16x16x32_bf16 v[32:35], v[140:143], v[84:87], v[32:35]
    ds_read_b128 v[84:87], v57 offset:1280
    s_waitcnt lgkmcnt(7)
    v_mfma_f32_16x16x32_bf16 v[32:35], v[144:147], v[88:91], v[32:35]
    ds_read_b128 v[88:91], v58 offset:1280
    s_waitcnt lgkmcnt(7)
    v_mfma_f32_16x16x32_bf16 v[32:35], v[148:151], v[92:95], v[32:35]
    ds_read_b128 v[92:95], v59 offset:1280
    s_waitcnt lgkmcnt(7)
    v_mfma_f32_16x16x32_bf16 v[32:35], v[152:155], v[72:75], v[32:35]
    ds_read_b128 v[72:75], v56 offset:384
    s_waitcnt lgkmcnt(5)
    v_mfma_f32_16x16x32_bf16 v[32:35], v[156:159], v[76:79], v[32:35]
    buffer_store_dwordx4 v[212:215], v210, s[4:7], s23 offen offset:0 sc1
    ds_read_b128 v[76:79], v57 offset:384
    s_waitcnt lgkmcnt(5)
    v_mfma_f32_16x16x32_bf16 v[32:35], v[160:163], v[80:83], v[32:35]
    buffer_store_dwordx4 v[216:219], v210, s[4:7], s23 offen offset:1024 sc1
    ds_read_b128 v[80:83], v58 offset:384
    s_waitcnt lgkmcnt(5)
    v_mfma_f32_16x16x32_bf16 v[32:35], v[164:167], v[84:87], v[32:35]
    ds_read_b128 v[84:87], v59 offset:384
    s_waitcnt lgkmcnt(5)
    v_mfma_f32_16x16x32_bf16 v[32:35], v[168:171], v[88:91], v[32:35]
    ds_read_b128 v[88:91], v56 offset:768
    s_waitcnt lgkmcnt(5)
    v_mfma_f32_16x16x32_bf16 v[32:35], v[172:175], v[92:95], v[32:35]
    ds_read_b128 v[92:95], v57 offset:768
    s_waitcnt lgkmcnt(5)
    v_mfma_f32_16x16x32_bf16 v[44:47], v[128:131], v[72:75], 0
    ds_read_b128 v[72:75], v58 offset:768
    s_waitcnt lgkmcnt(5)
    v_mfma_f32_16x16x32_bf16 v[44:47], v[132:135], v[76:79], v[44:47]
    ds_read_b128 v[76:79], v59 offset:768
    s_waitcnt lgkmcnt(5)
    v_mfma_f32_16x16x32_bf16 v[44:47], v[136:139], v[80:83], v[44:47]
    ds_read_b128 v[80:83], v56 offset:896
    s_waitcnt lgkmcnt(5)
    v_mfma_f32_16x16x32_bf16 v[44:47], v[140:143], v[84:87], v[44:47]
    v_cvt_pk_bf16_f32 v8, v8, v9
    v_cvt_pk_bf16_f32 v9, v10, v11
    ds_read_b128 v[84:87], v57 offset:896
    s_waitcnt lgkmcnt(5)
    v_mfma_f32_16x16x32_bf16 v[44:47], v[144:147], v[88:91], v[44:47]
    ds_write_b64 v204, v[8:9] offset:0
    v_mul_f32 v20, v20, v200
    ds_read_b128 v[88:91], v58 offset:896
    s_waitcnt lgkmcnt(6)
    v_mfma_f32_16x16x32_bf16 v[44:47], v[148:151], v[92:95], v[44:47]
    v_mul_f32 v21, v21, v201
    v_mul_f32 v22, v22, v202
    ds_read_b128 v[92:95], v59 offset:896
    s_waitcnt lgkmcnt(6)
    v_mfma_f32_16x16x32_bf16 v[44:47], v[152:155], v[72:75], v[44:47]
    v_mul_f32 v23, v23, v203
    v_cvt_pk_bf16_f32 v20, v20, v21
    s_waitcnt lgkmcnt(5)
    v_mfma_f32_16x16x32_bf16 v[44:47], v[156:159], v[76:79], v[44:47]
    v_cvt_pk_bf16_f32 v21, v22, v23
    ds_write_b64 v204, v[20:21] offset:256
    s_waitcnt lgkmcnt(5)
    v_mfma_f32_16x16x32_bf16 v[44:47], v[160:163], v[80:83], v[44:47]
    v_mul_f32 v32, v32, v200
    v_mul_f32 v33, v33, v201
    s_waitcnt lgkmcnt(4)
    v_mfma_f32_16x16x32_bf16 v[44:47], v[164:167], v[84:87], v[44:47]
    v_mul_f32 v34, v34, v202
    v_mul_f32 v35, v35, v203
    s_waitcnt lgkmcnt(2)
    v_mfma_f32_16x16x32_bf16 v[44:47], v[168:171], v[88:91], v[44:47]
    v_cvt_pk_bf16_f32 v32, v32, v33
    v_cvt_pk_bf16_f32 v33, v34, v35
    s_waitcnt lgkmcnt(1)
    v_mfma_f32_16x16x32_bf16 v[44:47], v[172:175], v[92:95], v[44:47]
    ds_write_b64 v204, v[32:33] offset:512
    s_nop 6
    v_mul_f32 v44, v44, v200
    v_mul_f32 v45, v45, v201
    v_mul_f32 v46, v46, v202
    v_mul_f32 v47, v47, v203
    v_cvt_pk_bf16_f32 v44, v44, v45
    v_cvt_pk_bf16_f32 v45, v46, v47
    ds_write_b64 v204, v[44:45] offset:768
    s_waitcnt lgkmcnt(0)
    s_barrier
    ds_read_b128 v[212:215], v211 offset:0
    s_waitcnt lgkmcnt(0)
    buffer_store_dwordx4 v[212:215], v210, s[4:7], s66 offen offset:0 sc1
    s_or_b32 s89, s89, s20
    s_cbranch_scc1 K2_end
    v_mov_b32 v0, 0
    v_mov_b32 v1, s88
    s_mov_b64 exec, 1
    buffer_store_dword v1, v0, s[16:19], 0 offen
K2_end:
K2_last:
    s_endpgm
SLOW:
    v_readlane_b32 s89, v4, 62
    s_waitcnt vmcnt(0) lgkmcnt(0)
    s_barrier
    s_load_dwordx2 s[22:23], s[0:1], 8
    s_load_dwordx2 s[24:25], s[0:1], 24
    s_load_dwordx2 s[26:27], s[0:1], 32
    s_load_dwordx2 s[28:29], s[0:1], 40
    s_load_dwordx2 s[30:31], s[0:1], 0
    v_mbcnt_lo_u32_b32 v240, -1, 0
    v_mbcnt_hi_u32_b32 v240, -1, v240
    v_lshrrev_b32 v229, 5, v240
    v_and_b32 v230, 31, v240
    v_lshlrev_b32 v241, 7, v229
    v_lshl_add_u32 v241, v230, 1, v241
    v_lshlrev_b32 v245, 4, v240
    v_mov_b32 v242, 0
    s_waitcnt lgkmcnt(0)
    s_mov_b32 s80, s22
    s_and_b32 s81, s23, 0xffff
    s_mov_b32 s82, 1920000
    s_mov_b32 s83, 0x20000
    s_mov_b32 s76, s24
    s_and_b32 s77, s25, 0xffff
    s_mov_b32 s78, 1280000
    s_mov_b32 s79, 0x20000
    s_mov_b32 s72, s26
    s_and_b32 s73, s27, 0xffff
    s_mov_b32 s74, 1280000
    s_mov_b32 s75, 0x20000
    s_mov_b32 s84, s28
    s_and_b32 s85, s29, 0xffff
    s_mov_b32 s86, 20480
    s_mov_b32 s87, 0x20000
    s_mov_b32 s4, s30
    s_and_b32 s5, s31, 0xffff
    s_mov_b32 s6, 10240000
    s_mov_b32 s7, 0x20000
    s_mov_b32 s66, 0
    buffer_load_ushort v0, v241, s[84:87], s66 offen offset:0
    buffer_load_ushort v1, v241, s[84:87], s66 offen offset:64
    buffer_load_ushort v2, v241, s[84:87], s66 offen offset:256
    buffer_load_ushort v3, v241, s[84:87], s66 offen offset:320
    buffer_load_ushort v4, v241, s[84:87], s66 offen offset:512
    buffer_load_ushort v5, v241, s[84:87], s66 offen offset:576
    buffer_load_ushort v6, v241, s[84:87], s66 offen offset:768
    buffer_load_ushort v7, v241, s[84:87], s66 offen offset:832
    buffer_load_ushort v8, v241, s[84:87], s66 offen offset:1024
    buffer_load_ushort v9, v241, s[84:87], s66 offen offset:1088
    s_waitcnt vmcnt(0)
    s_mov_b32 s66, 1280
    buffer_load_ushort v10, v241, s[84:87], s66 offen offset:0
    buffer_load_ushort v11, v241, s[84:87], s66 offen offset:64
    buffer_load_ushort v12, v241, s[84:87], s66 offen offset:256
    buffer_load_ushort v13, v241, s[84:87], s66 offen offset:320
    buffer_load_ushort v14, v241, s[84:87], s66 offen offset:512
    buffer_load_ushort v15, v241, s[84:87], s66 offen offset:576
    buffer_load_ushort v16, v241, s[84:87], s66 offen offset:768
    buffer_load_ushort v17, v241, s[84:87], s66 offen offset:832
    buffer_load_ushort v18, v241, s[84:87], s66 offen offset:1024
    buffer_load_ushort v19, v241, s[84:87], s66 offen offset:1088
    s_waitcnt vmcnt(0)
    s_mov_b32 s66, 2560
    buffer_load_ushort v20, v241, s[84:87], s66 offen offset:0
    buffer_load_ushort v21, v241, s[84:87], s66 offen offset:64
    buffer_load_ushort v22, v241, s[84:87], s66 offen offset:256
    buffer_load_ushort v23, v241, s[84:87], s66 offen offset:320
    buffer_load_ushort v24, v241, s[84:87], s66 offen offset:512
    buffer_load_ushort v25, v241, s[84:87], s66 offen offset:576
    buffer_load_ushort v26, v241, s[84:87], s66 offen offset:768
    buffer_load_ushort v27, v241, s[84:87], s66 offen offset:832
    buffer_load_ushort v28, v241, s[84:87], s66 offen offset:1024
    buffer_load_ushort v29, v241, s[84:87], s66 offen offset:1088
    s_waitcnt vmcnt(0)
    s_mov_b32 s66, 3840
    buffer_load_ushort v30, v241, s[84:87], s66 offen offset:0
    buffer_load_ushort v31, v241, s[84:87], s66 offen offset:64
    buffer_load_ushort v32, v241, s[84:87], s66 offen offset:256
    buffer_load_ushort v33, v241, s[84:87], s66 offen offset:320
    buffer_load_ushort v34, v241, s[84:87], s66 offen offset:512
    buffer_load_ushort v35, v241, s[84:87], s66 offen offset:576
    buffer_load_ushort v36, v241, s[84:87], s66 offen offset:768
    buffer_load_ushort v37, v241, s[84:87], s66 offen offset:832
    buffer_load_ushort v38, v241, s[84:87], s66 offen offset:1024
    buffer_load_ushort v39, v241, s[84:87], s66 offen offset:1088
    s_waitcnt vmcnt(0)
    s_mov_b32 s66, 5120
    buffer_load_ushort v40, v241, s[84:87], s66 offen offset:0
    buffer_load_ushort v41, v241, s[84:87], s66 offen offset:64
    buffer_load_ushort v42, v241, s[84:87], s66 offen offset:256
    buffer_load_ushort v43, v241, s[84:87], s66 offen offset:320
    buffer_load_ushort v44, v241, s[84:87], s66 offen offset:512
    buffer_load_ushort v45, v241, s[84:87], s66 offen offset:576
    buffer_load_ushort v46, v241, s[84:87], s66 offen offset:768
    buffer_load_ushort v47, v241, s[84:87], s66 offen offset:832
    buffer_load_ushort v48, v241, s[84:87], s66 offen offset:1024
    buffer_load_ushort v49, v241, s[84:87], s66 offen offset:1088
    s_waitcnt vmcnt(0)
    s_mov_b32 s66, 6400
    buffer_load_ushort v50, v241, s[84:87], s66 offen offset:0
    buffer_load_ushort v51, v241, s[84:87], s66 offen offset:64
    buffer_load_ushort v52, v241, s[84:87], s66 offen offset:256
    buffer_load_ushort v53, v241, s[84:87], s66 offen offset:320
    buffer_load_ushort v54, v241, s[84:87], s66 offen offset:512
    buffer_load_ushort v55, v241, s[84:87], s66 offen offset:576
    buffer_load_ushort v56, v241, s[84:87], s66 offen offset:768
    buffer_load_ushort v57, v241, s[84:87], s66 offen offset:832
    buffer_load_ushort v58, v241, s[84:87], s66 offen offset:1024
    buffer_load_ushort v59, v241, s[84:87], s66 offen offset:1088
    s_waitcnt vmcnt(0)
    s_mov_b32 s66, 7680
    buffer_load_ushort v60, v241, s[84:87], s66 offen offset:0
    buffer_load_ushort v61, v241, s[84:87], s66 offen offset:64
    buffer_load_ushort v62, v241, s[84:87], s66 offen offset:256
    buffer_load_ushort v63, v241, s[84:87], s66 offen offset:320
    buffer_load_ushort v64, v241, s[84:87], s66 offen offset:512
    buffer_load_ushort v65, v241, s[84:87], s66 offen offset:576
    buffer_load_ushort v66, v241, s[84:87], s66 offen offset:768
    buffer_load_ushort v67, v241, s[84:87], s66 offen offset:832
    buffer_load_ushort v68, v241, s[84:87], s66 offen offset:1024
    buffer_load_ushort v69, v241, s[84:87], s66 offen offset:1088
    s_waitcnt vmcnt(0)
    s_mov_b32 s66, 8960
    buffer_load_ushort v70, v241, s[84:87], s66 offen offset:0
    buffer_load_ushort v71, v241, s[84:87], s66 offen offset:64
    buffer_load_ushort v72, v241, s[84:87], s66 offen offset:256
    buffer_load_ushort v73, v241, s[84:87], s66 offen offset:320
    buffer_load_ushort v74, v241, s[84:87], s66 offen offset:512
    buffer_load_ushort v75, v241, s[84:87], s66 offen offset:576
    buffer_load_ushort v76, v241, s[84:87], s66 offen offset:768
    buffer_load_ushort v77, v241, s[84:87], s66 offen offset:832
    buffer_load_ushort v78, v241, s[84:87], s66 offen offset:1024
    buffer_load_ushort v79, v241, s[84:87], s66 offen offset:1088
    s_waitcnt vmcnt(0)
    s_mov_b32 s66, 10240
    buffer_load_ushort v80, v241, s[84:87], s66 offen offset:0
    buffer_load_ushort v81, v241, s[84:87], s66 offen offset:64
    buffer_load_ushort v82, v241, s[84:87], s66 offen offset:256
    buffer_load_ushort v83, v241, s[84:87], s66 offen offset:320
    buffer_load_ushort v84, v241, s[84:87], s66 offen offset:512
    buffer_load_ushort v85, v241, s[84:87], s66 offen offset:576
    buffer_load_ushort v86, v241, s[84:87], s66 offen offset:768
    buffer_load_ushort v87, v241, s[84:87], s66 offen offset:832
    buffer_load_ushort v88, v241, s[84:87], s66 offen offset:1024
    buffer_load_ushort v89, v241, s[84:87], s66 offen offset:1088
    s_waitcnt vmcnt(0)
    s_mov_b32 s66, 11520
    buffer_load_ushort v90, v241, s[84:87], s66 offen offset:0
    buffer_load_ushort v91, v241, s[84:87], s66 offen offset:64
    buffer_load_ushort v92, v241, s[84:87], s66 offen offset:256
    buffer_load_ushort v93, v241, s[84:87], s66 offen offset:320
    buffer_load_ushort v94, v241, s[84:87], s66 offen offset:512
    buffer_load_ushort v95, v241, s[84:87], s66 offen offset:576
    buffer_load_ushort v96, v241, s[84:87], s66 offen offset:768
    buffer_load_ushort v97, v241, s[84:87], s66 offen offset:832
    buffer_load_ushort v98, v241, s[84:87], s66 offen offset:1024
    buffer_load_ushort v99, v241, s[84:87], s66 offen offset:1088
    s_waitcnt vmcnt(0)
    s_mov_b32 s66, 12800
    buffer_load_ushort v100, v241, s[84:87], s66 offen offset:0
    buffer_load_ushort v101, v241, s[84:87], s66 offen offset:64
    buffer_load_ushort v102, v241, s[84:87], s66 offen offset:256
    buffer_load_ushort v103, v241, s[84:87], s66 offen offset:320
    buffer_load_ushort v104, v241, s[84:87], s66 offen offset:512
    buffer_load_ushort v105, v241, s[84:87], s66 offen offset:576
    buffer_load_ushort v106, v241, s[84:87], s66 offen offset:768
    buffer_load_ushort v107, v241, s[84:87], s66 offen offset:832
    buffer_load_ushort v108, v241, s[84:87], s66 offen offset:1024
    buffer_load_ushort v109, v241, s[84:87], s66 offen offset:1088
    s_waitcnt vmcnt(0)
    s_mov_b32 s66, 14080
    buffer_load_ushort v110, v241, s[84:87], s66 offen offset:0
    buffer_load_ushort v111, v241, s[84:87], s66 offen offset:64
    buffer_load_ushort v112, v241, s[84:87], s66 offen offset:256
    buffer_load_ushort v113, v241, s[84:87], s66 offen offset:320
    buffer_load_ushort v114, v241, s[84:87], s66 offen offset:512
    buffer_load_ushort v115, v241, s[84:87], s66 offen offset:576
    buffer_load_ushort v116, v241, s[84:87], s66 offen offset:768
    buffer_load_ushort v117, v241, s[84:87], s66 offen offset:832
    buffer_load_ushort v118, v241, s[84:87], s66 offen offset:1024
    buffer_load_ushort v119, v241, s[84:87], s66 offen offset:1088
    s_waitcnt vmcnt(0)
    s_mov_b32 s66, 15360
    buffer_load_ushort v120, v241, s[84:87], s66 offen offset:0
    buffer_load_ushort v121, v241, s[84:87], s66 offen offset:64
    buffer_load_ushort v122, v241, s[84:87], s66 offen offset:256
    buffer_load_ushort v123, v241, s[84:87], s66 offen offset:320
    buffer_load_ushort v124, v241, s[84:87], s66 offen offset:512
    buffer_load_ushort v125, v241, s[84:87], s66 offen offset:576
    buffer_load_ushort v126, v241, s[84:87], s66 offen offset:768
    buffer_load_ushort v127, v241, s[84:87], s66 offen offset:832
    buffer_load_ushort v128, v241, s[84:87], s66 offen offset:1024
    buffer_load_ushort v129, v241, s[84:87], s66 offen offset:1088
    s_waitcnt vmcnt(0)
    s_mov_b32 s66, 16640
    buffer_load_ushort v130, v241, s[84:87], s66 offen offset:0
    buffer_load_ushort v131, v241, s[84:87], s66 offen offset:64
    buffer_load_ushort v132, v241, s[84:87], s66 offen offset:256
    buffer_load_ushort v133, v241, s[84:87], s66 offen offset:320
    buffer_load_ushort v134, v241, s[84:87], s66 offen offset:512
    buffer_load_ushort v135, v241, s[84:87], s66 offen offset:576
    buffer_load_ushort v136, v241, s[84:87], s66 offen offset:768
    buffer_load_ushort v137, v241, s[84:87], s66 offen offset:832
    buffer_load_ushort v138, v241, s[84:87], s66 offen offset:1024
    buffer_load_ushort v139, v241, s[84:87], s66 offen offset:1088
    s_waitcnt vmcnt(0)
    s_mov_b32 s66, 17920
    buffer_load_ushort v140, v241, s[84:87], s66 offen offset:0
    buffer_load_ushort v141, v241, s[84:87], s66 offen offset:64
    buffer_load_ushort v142, v241, s[84:87], s66 offen offset:256
    buffer_load_ushort v143, v241, s[84:87], s66 offen offset:320
    buffer_load_ushort v144, v241, s[84:87], s66 offen offset:512
    buffer_load_ushort v145, v241, s[84:87], s66 offen offset:576
    buffer_load_ushort v146, v241, s[84:87], s66 offen offset:768
    buffer_load_ushort v147, v241, s[84:87], s66 offen offset:832
    buffer_load_ushort v148, v241, s[84:87], s66 offen offset:1024
    buffer_load_ushort v149, v241, s[84:87], s66 offen offset:1088
    s_waitcnt vmcnt(0)
    s_mov_b32 s66, 19200
    buffer_load_ushort v150, v241, s[84:87], s66 offen offset:0
    buffer_load_ushort v151, v241, s[84:87], s66 offen offset:64
    buffer_load_ushort v152, v241, s[84:87], s66 offen offset:256
    buffer_load_ushort v153, v241, s[84:87], s66 offen offset:320
    buffer_load_ushort v154, v241, s[84:87], s66 offen offset:512
    buffer_load_ushort v155, v241, s[84:87], s66 offen offset:576
    buffer_load_ushort v156, v241, s[84:87], s66 offen offset:768
    buffer_load_ushort v157, v241, s[84:87], s66 offen offset:832
    buffer_load_ushort v158, v241, s[84:87], s66 offen offset:1024
    buffer_load_ushort v159, v241, s[84:87], s66 offen offset:1088
    s_waitcnt vmcnt(0)
    v_lshlrev_b32 v0, 16, v0
    v_lshlrev_b32 v1, 16, v1
    v_lshlrev_b32 v2, 16, v2
    v_lshlrev_b32 v3, 16, v3
    v_lshlrev_b32 v4, 16, v4
    v_lshlrev_b32 v5, 16, v5
    v_lshlrev_b32 v6, 16, v6
    v_lshlrev_b32 v7, 16, v7
    v_lshlrev_b32 v8, 16, v8
    v_lshlrev_b32 v9, 16, v9
    v_lshlrev_b32 v10, 16, v10
    v_lshlrev_b32 v11, 16, v11
    v_lshlrev_b32 v12, 16, v12
    v_lshlrev_b32 v13, 16, v13
    v_lshlrev_b32 v14, 16, v14
    v_lshlrev_b32 v15, 16, v15
    v_lshlrev_b32 v16, 16, v16
    v_lshlrev_b32 v17, 16, v17
    v_lshlrev_b32 v18, 16, v18
    v_lshlrev_b32 v19, 16, v19
    v_lshlrev_b32 v20, 16, v20
    v_lshlrev_b32 v21, 16, v21
    v_lshlrev_b32 v22, 16, v22
    v_lshlrev_b32 v23, 16, v23
    v_lshlrev_b32 v24, 16, v24
    v_lshlrev_b32 v25, 16, v25
    v_lshlrev_b32 v26, 16, v26
    v_lshlrev_b32 v27, 16, v27
    v_lshlrev_b32 v28, 16, v28
    v_lshlrev_b32 v29, 16, v29
    v_lshlrev_b32 v30, 16, v30
    v_lshlrev_b32 v31, 16, v31
    v_lshlrev_b32 v32, 16, v32
    v_lshlrev_b32 v33, 16, v33
    v_lshlrev_b32 v34, 16, v34
    v_lshlrev_b32 v35, 16, v35
    v_lshlrev_b32 v36, 16, v36
    v_lshlrev_b32 v37, 16, v37
    v_lshlrev_b32 v38, 16, v38
    v_lshlrev_b32 v39, 16, v39
    v_lshlrev_b32 v40, 16, v40
    v_lshlrev_b32 v41, 16, v41
    v_lshlrev_b32 v42, 16, v42
    v_lshlrev_b32 v43, 16, v43
    v_lshlrev_b32 v44, 16, v44
    v_lshlrev_b32 v45, 16, v45
    v_lshlrev_b32 v46, 16, v46
    v_lshlrev_b32 v47, 16, v47
    v_lshlrev_b32 v48, 16, v48
    v_lshlrev_b32 v49, 16, v49
    v_lshlrev_b32 v50, 16, v50
    v_lshlrev_b32 v51, 16, v51
    v_lshlrev_b32 v52, 16, v52
    v_lshlrev_b32 v53, 16, v53
    v_lshlrev_b32 v54, 16, v54
    v_lshlrev_b32 v55, 16, v55
    v_lshlrev_b32 v56, 16, v56
    v_lshlrev_b32 v57, 16, v57
    v_lshlrev_b32 v58, 16, v58
    v_lshlrev_b32 v59, 16, v59
    v_lshlrev_b32 v60, 16, v60
    v_lshlrev_b32 v61, 16, v61
    v_lshlrev_b32 v62, 16, v62
    v_lshlrev_b32 v63, 16, v63
    v_lshlrev_b32 v64, 16, v64
    v_lshlrev_b32 v65, 16, v65
    v_lshlrev_b32 v66, 16, v66
    v_lshlrev_b32 v67, 16, v67
    v_lshlrev_b32 v68, 16, v68
    v_lshlrev_b32 v69, 16, v69
    v_lshlrev_b32 v70, 16, v70
    v_lshlrev_b32 v71, 16, v71
    v_lshlrev_b32 v72, 16, v72
    v_lshlrev_b32 v73, 16, v73
    v_lshlrev_b32 v74, 16, v74
    v_lshlrev_b32 v75, 16, v75
    v_lshlrev_b32 v76, 16, v76
    v_lshlrev_b32 v77, 16, v77
    v_lshlrev_b32 v78, 16, v78
    v_lshlrev_b32 v79, 16, v79
    v_lshlrev_b32 v80, 16, v80
    v_lshlrev_b32 v81, 16, v81
    v_lshlrev_b32 v82, 16, v82
    v_lshlrev_b32 v83, 16, v83
    v_lshlrev_b32 v84, 16, v84
    v_lshlrev_b32 v85, 16, v85
    v_lshlrev_b32 v86, 16, v86
    v_lshlrev_b32 v87, 16, v87
    v_lshlrev_b32 v88, 16, v88
    v_lshlrev_b32 v89, 16, v89
    v_lshlrev_b32 v90, 16, v90
    v_lshlrev_b32 v91, 16, v91
    v_lshlrev_b32 v92, 16, v92
    v_lshlrev_b32 v93, 16, v93
    v_lshlrev_b32 v94, 16, v94
    v_lshlrev_b32 v95, 16, v95
    v_lshlrev_b32 v96, 16, v96
    v_lshlrev_b32 v97, 16, v97
    v_lshlrev_b32 v98, 16, v98
    v_lshlrev_b32 v99, 16, v99
    v_lshlrev_b32 v100, 16, v100
    v_lshlrev_b32 v101, 16, v101
    v_lshlrev_b32 v102, 16, v102
    v_lshlrev_b32 v103, 16, v103
    v_lshlrev_b32 v104, 16, v104
    v_lshlrev_b32 v105, 16, v105
    v_lshlrev_b32 v106, 16, v106
    v_lshlrev_b32 v107, 16, v107
    v_lshlrev_b32 v108, 16, v108
    v_lshlrev_b32 v109, 16, v109
    v_lshlrev_b32 v110, 16, v110
    v_lshlrev_b32 v111, 16, v111
    v_lshlrev_b32 v112, 16, v112
    v_lshlrev_b32 v113, 16, v113
    v_lshlrev_b32 v114, 16, v114
    v_lshlrev_b32 v115, 16, v115
    v_lshlrev_b32 v116, 16, v116
    v_lshlrev_b32 v117, 16, v117
    v_lshlrev_b32 v118, 16, v118
    v_lshlrev_b32 v119, 16, v119
    v_lshlrev_b32 v120, 16, v120
    v_lshlrev_b32 v121, 16, v121
    v_lshlrev_b32 v122, 16, v122
    v_lshlrev_b32 v123, 16, v123
    v_lshlrev_b32 v124, 16, v124
    v_lshlrev_b32 v125, 16, v125
    v_lshlrev_b32 v126, 16, v126
    v_lshlrev_b32 v127, 16, v127
    v_lshlrev_b32 v128, 16, v128
    v_lshlrev_b32 v129, 16, v129
    v_lshlrev_b32 v130, 16, v130
    v_lshlrev_b32 v131, 16, v131
    v_lshlrev_b32 v132, 16, v132
    v_lshlrev_b32 v133, 16, v133
    v_lshlrev_b32 v134, 16, v134
    v_lshlrev_b32 v135, 16, v135
    v_lshlrev_b32 v136, 16, v136
    v_lshlrev_b32 v137, 16, v137
    v_lshlrev_b32 v138, 16, v138
    v_lshlrev_b32 v139, 16, v139
    v_lshlrev_b32 v140, 16, v140
    v_lshlrev_b32 v141, 16, v141
    v_lshlrev_b32 v142, 16, v142
    v_lshlrev_b32 v143, 16, v143
    v_lshlrev_b32 v144, 16, v144
    v_lshlrev_b32 v145, 16, v145
    v_lshlrev_b32 v146, 16, v146
    v_lshlrev_b32 v147, 16, v147
    v_lshlrev_b32 v148, 16, v148
    v_lshlrev_b32 v149, 16, v149
    v_lshlrev_b32 v150, 16, v150
    v_lshlrev_b32 v151, 16, v151
    v_lshlrev_b32 v152, 16, v152
    v_lshlrev_b32 v153, 16, v153
    v_lshlrev_b32 v154, 16, v154
    v_lshlrev_b32 v155, 16, v155
    v_lshlrev_b32 v156, 16, v156
    v_lshlrev_b32 v157, 16, v157
    v_lshlrev_b32 v158, 16, v158
    v_lshlrev_b32 v159, 16, v159
    s_mov_b32 s50, 0
SL_node:
    s_mul_i32 s34, s2, 40
    s_mul_i32 s66, s20, 5
    s_add_u32 s66, s66, s50
    s_add_u32 s34, s34, s66
    v_mov_b32 v160, 0
    v_mov_b32 v161, 0
    v_mov_b32 v162, 0
    v_mov_b32 v163, 0
    v_mov_b32 v164, 0
    v_mov_b32 v165, 0
    v_mov_b32 v166, 0
    v_mov_b32 v167, 0
    v_mov_b32 v168, 0
    v_mov_b32 v169, 0
    v_mov_b32 v170, 0
    v_mov_b32 v171, 0
    v_mov_b32 v172, 0
    v_mov_b32 v173, 0
    v_mov_b32 v174, 0
    v_mov_b32 v175, 0
    v_mov_b32 v176, 0
    v_mov_b32 v177, 0
    v_mov_b32 v178, 0
    v_mov_b32 v179, 0
    v_mov_b32 v180, 0
    v_mov_b32 v181, 0
    s_mov_b32 s35, 0
SL_scan:
    s_lshl_b32 s66, s35, 2
    buffer_load_dwordx4 v[236:239], v245, s[72:75], s66 offen
    s_waitcnt vmcnt(0)
    v_cmp_eq_u32 s[38:39], s34, v236
    v_cmp_eq_u32 s[40:41], s34, v237
    v_cmp_eq_u32 s[42:43], s34, v238
    v_cmp_eq_u32 s[44:45], s34, v239
    s_mov_b32 s36, 0
SL_bits:
    s_cmp_eq_u64 s[38:39], 0
    s_cbranch_scc1 SL_nexti
    s_ff1_i32_b64 s66, s[38:39]
    s_bitset0_b64 s[38:39], s66
    s_lshl_b32 s66, s66, 2
    s_add_u32 s37, s66, s36
    s_add_u32 s37, s37, s35
    s_lshl_b32 s66, s37, 2
    s_lshl_b32 s67, s37, 5
    s_mul_i32 s68, s37, 6
    buffer_load_dword v243, v242, s[76:79], s66 offen
    buffer_load_dwordx4 v[184:187], v242, s[12:15], s67 offen
    buffer_load_dwordx4 v[188:191], v242, s[12:15], s67 offen offset:16
    buffer_load_ushort v226, v242, s[80:83], s68 offen offset:0
    buffer_load_ushort v227, v242, s[80:83], s68 offen offset:2
    buffer_load_ushort v228, v242, s[80:83], s68 offen offset:4
    s_waitcnt vmcnt(5)
    v_lshl_add_u32 v243, v243, 10, v241
    buffer_load_ushort v208, v243, s[4:7], 0 offen offset:0
    buffer_load_ushort v209, v243, s[4:7], 0 offen offset:64
    buffer_load_ushort v210, v243, s[4:7], 0 offen offset:256
    buffer_load_ushort v211, v243, s[4:7], 0 offen offset:320
    buffer_load_ushort v212, v243, s[4:7], 0 offen offset:512
    buffer_load_ushort v213, v243, s[4:7], 0 offen offset:576
    buffer_load_ushort v214, v243, s[4:7], 0 offen offset:768
    buffer_load_ushort v215, v243, s[4:7], 0 offen offset:832
    s_waitcnt vmcnt(8)
    v_lshlrev_b32 v192, 16, v184
    v_and_b32 v193, 0xffff0000, v184
    v_lshlrev_b32 v194, 16, v185
    v_and_b32 v195, 0xffff0000, v185
    v_lshlrev_b32 v196, 16, v186
    v_and_b32 v197, 0xffff0000, v186
    v_lshlrev_b32 v198, 16, v187
    v_and_b32 v199, 0xffff0000, v187
    v_lshlrev_b32 v200, 16, v188
    v_and_b32 v201, 0xffff0000, v188
    v_lshlrev_b32 v202, 16, v189
    v_and_b32 v203, 0xffff0000, v189
    v_lshlrev_b32 v204, 16, v190
    v_and_b32 v205, 0xffff0000, v190
    v_lshlrev_b32 v206, 16, v191
    v_and_b32 v207, 0xffff0000, v191
    v_lshlrev_b32 v226, 16, v226
    v_lshlrev_b32 v227, 16, v227
    v_lshlrev_b32 v228, 16, v228
    v_mul_f32 v216, v192, v0
    v_mul_f32 v217, v192, v1
    v_mul_f32 v218, v192, v2
    v_mul_f32 v219, v192, v3
    v_mul_f32 v220, v192, v4
    v_mul_f32 v221, v192, v5
    v_mul_f32 v222, v192, v6
    v_mul_f32 v223, v192, v7
    v_mul_f32 v224, v192, v8
    v_mul_f32 v225, v192, v9
    v_fmac_f32 v216, v193, v10
    v_fmac_f32 v217, v193, v11
    v_fmac_f32 v218, v193, v12
    v_fmac_f32 v219, v193, v13
    v_fmac_f32 v220, v193, v14
    v_fmac_f32 v221, v193, v15
    v_fmac_f32 v222, v193, v16
    v_fmac_f32 v223, v193, v17
    v_fmac_f32 v224, v193, v18
    v_fmac_f32 v225, v193, v19
    v_fmac_f32 v216, v194, v20
    v_fmac_f32 v217, v194, v21
    v_fmac_f32 v218, v194, v22
    v_fmac_f32 v219, v194, v23
    v_fmac_f32 v220, v194, v24
    v_fmac_f32 v221, v194, v25
    v_fmac_f32 v222, v194, v26
    v_fmac_f32 v223, v194, v27
    v_fmac_f32 v224, v194, v28
    v_fmac_f32 v225, v194, v29
    v_fmac_f32 v216, v195, v30
    v_fmac_f32 v217, v195, v31
    v_fmac_f32 v218, v195, v32
    v_fmac_f32 v219, v195, v33
    v_fmac_f32 v220, v195, v34
    v_fmac_f32 v221, v195, v35
    v_fmac_f32 v222, v195, v36
    v_fmac_f32 v223, v195, v37
    v_fmac_f32 v224, v195, v38
    v_fmac_f32 v225, v195, v39
    v_fmac_f32 v216, v196, v40
    v_fmac_f32 v217, v196, v41
    v_fmac_f32 v218, v196, v42
    v_fmac_f32 v219, v196, v43
    v_fmac_f32 v220, v196, v44
    v_fmac_f32 v221, v196, v45
    v_fmac_f32 v222, v196, v46
    v_fmac_f32 v223, v196, v47
    v_fmac_f32 v224, v196, v48
    v_fmac_f32 v225, v196, v49
    v_fmac_f32 v216, v197, v50
    v_fmac_f32 v217, v197, v51
    v_fmac_f32 v218, v197, v52
    v_fmac_f32 v219, v197, v53
    v_fmac_f32 v220, v197, v54
    v_fmac_f32 v221, v197, v55
    v_fmac_f32 v222, v197, v56
    v_fmac_f32 v223, v197, v57
    v_fmac_f32 v224, v197, v58
    v_fmac_f32 v225, v197, v59
    v_fmac_f32 v216, v198, v60
    v_fmac_f32 v217, v198, v61
    v_fmac_f32 v218, v198, v62
    v_fmac_f32 v219, v198, v63
    v_fmac_f32 v220, v198, v64
    v_fmac_f32 v221, v198, v65
    v_fmac_f32 v222, v198, v66
    v_fmac_f32 v223, v198, v67
    v_fmac_f32 v224, v198, v68
    v_fmac_f32 v225, v198, v69
    v_fmac_f32 v216, v199, v70
    v_fmac_f32 v217, v199, v71
    v_fmac_f32 v218, v199, v72
    v_fmac_f32 v219, v199, v73
    v_fmac_f32 v220, v199, v74
    v_fmac_f32 v221, v199, v75
    v_fmac_f32 v222, v199, v76
    v_fmac_f32 v223, v199, v77
    v_fmac_f32 v224, v199, v78
    v_fmac_f32 v225, v199, v79
    v_fmac_f32 v216, v200, v80
    v_fmac_f32 v217, v200, v81
    v_fmac_f32 v218, v200, v82
    v_fmac_f32 v219, v200, v83
    v_fmac_f32 v220, v200, v84
    v_fmac_f32 v221, v200, v85
    v_fmac_f32 v222, v200, v86
    v_fmac_f32 v223, v200, v87
    v_fmac_f32 v224, v200, v88
    v_fmac_f32 v225, v200, v89
    v_fmac_f32 v216, v201, v90
    v_fmac_f32 v217, v201, v91
    v_fmac_f32 v218, v201, v92
    v_fmac_f32 v219, v201, v93
    v_fmac_f32 v220, v201, v94
    v_fmac_f32 v221, v201, v95
    v_fmac_f32 v222, v201, v96
    v_fmac_f32 v223, v201, v97
    v_fmac_f32 v224, v201, v98
    v_fmac_f32 v225, v201, v99
    v_fmac_f32 v216, v202, v100
    v_fmac_f32 v217, v202, v101
    v_fmac_f32 v218, v202, v102
    v_fmac_f32 v219, v202, v103
    v_fmac_f32 v220, v202, v104
    v_fmac_f32 v221, v202, v105
    v_fmac_f32 v222, v202, v106
    v_fmac_f32 v223, v202, v107
    v_fmac_f32 v224, v202, v108
    v_fmac_f32 v225, v202, v109
    v_fmac_f32 v216, v203, v110
    v_fmac_f32 v217, v203, v111
    v_fmac_f32 v218, v203, v112
    v_fmac_f32 v219, v203, v113
    v_fmac_f32 v220, v203, v114
    v_fmac_f32 v221, v203, v115
    v_fmac_f32 v222, v203, v116
    v_fmac_f32 v223, v203, v117
    v_fmac_f32 v224, v203, v118
    v_fmac_f32 v225, v203, v119
    v_fmac_f32 v216, v204, v120
    v_fmac_f32 v217, v204, v121
    v_fmac_f32 v218, v204, v122
    v_fmac_f32 v219, v204, v123
    v_fmac_f32 v220, v204, v124
    v_fmac_f32 v221, v204, v125
    v_fmac_f32 v222, v204, v126
    v_fmac_f32 v223, v204, v127
    v_fmac_f32 v224, v204, v128
    v_fmac_f32 v225, v204, v129
    v_fmac_f32 v216, v205, v130
    v_fmac_f32 v217, v205, v131
    v_fmac_f32 v218, v205, v132
    v_fmac_f32 v219, v205, v133
    v_fmac_f32 v220, v205, v134
    v_fmac_f32 v221, v205, v135
    v_fmac_f32 v222, v205, v136
    v_fmac_f32 v223, v205, v137
    v_fmac_f32 v224, v205, v138
    v_fmac_f32 v225, v205, v139
    v_fmac_f32 v216, v206, v140
    v_fmac_f32 v217, v206, v141
    v_fmac_f32 v218, v206, v142
    v_fmac_f32 v219, v206, v143
    v_fmac_f32 v220, v206, v144
    v_fmac_f32 v221, v206, v145
    v_fmac_f32 v222, v206, v146
    v_fmac_f32 v223, v206, v147
    v_fmac_f32 v224, v206, v148
    v_fmac_f32 v225, v206, v149
    v_fmac_f32 v216, v207, v150
    v_fmac_f32 v217, v207, v151
    v_fmac_f32 v218, v207, v152
    v_fmac_f32 v219, v207, v153
    v_fmac_f32 v220, v207, v154
    v_fmac_f32 v221, v207, v155
    v_fmac_f32 v222, v207, v156
    v_fmac_f32 v223, v207, v157
    v_fmac_f32 v224, v207, v158
    v_fmac_f32 v225, v207, v159
    s_waitcnt vmcnt(0)
    v_lshlrev_b32 v208, 16, v208
    v_lshlrev_b32 v209, 16, v209
    v_lshlrev_b32 v210, 16, v210
    v_lshlrev_b32 v211, 16, v211
    v_lshlrev_b32 v212, 16, v212
    v_lshlrev_b32 v213, 16, v213
    v_lshlrev_b32 v214, 16, v214
    v_lshlrev_b32 v215, 16, v215
    v_fmac_f32 v160, v208, v216
    v_mul_f32 v229, v210, v226
    v_fmac_f32 v229, v212, v227
    v_fmac_f32 v229, v214, v228
    v_fmac_f32 v176, v229, v218
    v_mul_f32 v229, v208, v220
    v_fmac_f32 v162, v229, v226
    v_fmac_f32 v168, v210, v222
    v_mul_f32 v230, v227, v214
    v_fma_f32 v230, -v228, v212, v230
    v_fmac_f32 v178, v230, v224
    v_fmac_f32 v164, v229, v227
    v_fmac_f32 v170, v212, v222
    v_mul_f32 v230, v228, v210
    v_fma_f32 v230, -v226, v214, v230
    v_fmac_f32 v180, v230, v224
    v_fmac_f32 v166, v229, v228
    v_fmac_f32 v172, v214, v222
    v_mul_f32 v230, v226, v212
    v_fma_f32 v230, -v227, v210, v230
    v_fmac_f32 v174, v230, v224
    v_fmac_f32 v161, v209, v217
    v_mul_f32 v229, v211, v226
    v_fmac_f32 v229, v213, v227
    v_fmac_f32 v229, v215, v228
    v_fmac_f32 v177, v229, v219
    v_mul_f32 v229, v209, v221
    v_fmac_f32 v163, v229, v226
    v_fmac_f32 v169, v211, v223
    v_mul_f32 v230, v227, v215
    v_fma_f32 v230, -v228, v213, v230
    v_fmac_f32 v179, v230, v225
    v_fmac_f32 v165, v229, v227
    v_fmac_f32 v171, v213, v223
    v_mul_f32 v230, v228, v211
    v_fma_f32 v230, -v226, v215, v230
    v_fmac_f32 v181, v230, v225
    v_fmac_f32 v167, v229, v228
    v_fmac_f32 v173, v215, v223
    v_mul_f32 v230, v226, v213
    v_fma_f32 v230, -v227, v211, v230
    v_fmac_f32 v175, v230, v225
    s_branch SL_bits
SL_nexti:
    s_mov_b64 s[38:39], s[40:41]
    s_mov_b64 s[40:41], s[42:43]
    s_mov_b64 s[42:43], s[44:45]
    s_add_u32 s36, s36, 1
    s_cmp_lt_u32 s36, 4
    s_cbranch_scc1 SL_bits
    s_add_u32 s35, s35, 256
    s_cmp_lt_u32 s35, 320000
    s_cbranch_scc1 SL_scan
    s_mul_i32 s66, s20, 5
    s_add_u32 s66, s66, s50
    s_lshl_b32 s67, s66, 4
    s_and_b32 s68, s67, 128
    s_and_b32 s67, s67, 0x70
    s_mul_i32 s69, s50, 1536
    s_add_u32 s69, s69, s21
    s_add_u32 s69, s69, s68
    s_mul_i32 s70, s66, 1536
    s_add_u32 s70, s70, 86016
    s_add_u32 s70, s70, s68
    v_mov_b32 v230, s69
    v_mov_b32 v231, s70
    v_cmp_gt_u32 vcc, 32, v240
    v_and_b32 v229, 31, v240
    v_lshlrev_b32 v229, 2, v229
    v_xor_b32 v229, s67, v229
    v_cndmask_b32 v244, v231, v230, vcc
    v_add_u32 v244, v244, v229
    v_cvt_pk_bf16_f32 v160, v160, v161
    ds_write_b32 v244, v160 offset:0
    v_cvt_pk_bf16_f32 v162, v162, v163
    ds_write_b32 v244, v162 offset:128
    v_cvt_pk_bf16_f32 v164, v164, v165
    ds_write_b32 v244, v164 offset:256
    v_cvt_pk_bf16_f32 v166, v166, v167
    ds_write_b32 v244, v166 offset:384
    v_cvt_pk_bf16_f32 v168, v168, v169
    ds_write_b32 v244, v168 offset:512
    v_cvt_pk_bf16_f32 v170, v170, v171
    ds_write_b32 v244, v170 offset:640
    v_cvt_pk_bf16_f32 v172, v172, v173
    ds_write_b32 v244, v172 offset:768
    v_cvt_pk_bf16_f32 v174, v174, v175
    ds_write_b32 v244, v174 offset:896
    v_cvt_pk_bf16_f32 v176, v176, v177
    ds_write_b32 v244, v176 offset:1024
    v_cvt_pk_bf16_f32 v178, v178, v179
    ds_write_b32 v244, v178 offset:1152
    v_cvt_pk_bf16_f32 v180, v180, v181
    ds_write_b32 v244, v180 offset:1280
    s_lshl_b32 s66, s66, 3
    s_add_u32 s66, s66, 163328
    v_mov_b32 v229, s66
    ds_write_b64 v229, v[230:231]
    s_add_u32 s50, s50, 1
    s_cmp_lt_u32 s50, 5
    s_cbranch_scc1 SL_node
    s_waitcnt lgkmcnt(0)
    s_barrier
    v_mov_b32 v176, v240
    s_load_dwordx4 s[84:87], s[0:1], 48
    s_mul_i32 s22, s20, 20
    s_waitcnt lgkmcnt(0)
    s_mul_i32 s24, s22, 3277
    s_lshr_b32 s24, s24, 16
    s_mul_i32 s68, s24, 20
    s_sub_u32 s68, s22, s68
    s_cmp_lt_u32 s68, 8
    s_cselect_b64 s[66:67], s[84:85], s[86:87]
    s_cselect_b32 s25, 0, 8
    s_sub_u32 s68, s68, s25
    s_and_b32 s25, s68, 1
    s_lshr_b32 s68, s68, 1
    s_lshl_b32 s68, s68, 14
    s_lshl_b32 s25, s25, 12
    s_add_u32 s68, s68, s25
    s_lshl_b32 s24, s24, 5
    s_add_u32 s68, s68, s24
    v_lshrrev_b32 v2, 4, v176
    v_lshlrev_b32 v2, 10, v2
    v_and_b32 v3, 15, v176
    v_lshl_add_u32 v2, v3, 1, v2
    v_add_u32 v2, s68, v2
    v_add_u32 v3, 8192, v2
    v_mov_b32 v4, 0
    v_mov_b32 v5, 0
    v_mov_b32 v6, 0
    v_mov_b32 v7, 0
    global_load_ushort v96, v2, s[66:67] offset:0
    global_load_short_d16_hi v4, v3, s[66:67] offset:0
    global_load_ushort v97, v2, s[66:67] offset:256
    global_load_short_d16_hi v5, v3, s[66:67] offset:256
    global_load_ushort v98, v2, s[66:67] offset:512
    global_load_short_d16_hi v6, v3, s[66:67] offset:512
    global_load_ushort v99, v2, s[66:67] offset:768
    global_load_short_d16_hi v7, v3, s[66:67] offset:768
    s_add_u32 s22, s22, 1
    s_waitcnt vmcnt(0)
    v_or_b32 v96, v96, v4
    v_or_b32 v97, v97, v5
    v_or_b32 v98, v98, v6
    v_or_b32 v99, v99, v7
    s_mul_i32 s24, s22, 3277
    s_lshr_b32 s24, s24, 16
    s_mul_i32 s68, s24, 20
    s_sub_u32 s68, s22, s68
    s_cmp_lt_u32 s68, 8
    s_cselect_b64 s[66:67], s[84:85], s[86:87]
    s_cselect_b32 s25, 0, 8
    s_sub_u32 s68, s68, s25
    s_and_b32 s25, s68, 1
    s_lshr_b32 s68, s68, 1
    s_lshl_b32 s68, s68, 14
    s_lshl_b32 s25, s25, 12
    s_add_u32 s68, s68, s25
    s_lshl_b32 s24, s24, 5
    s_add_u32 s68, s68, s24
    v_lshrrev_b32 v2, 4, v176
    v_lshlrev_b32 v2, 10, v2
    v_and_b32 v3, 15, v176
    v_lshl_add_u32 v2, v3, 1, v2
    v_add_u32 v2, s68, v2
    v_add_u32 v3, 8192, v2
    v_mov_b32 v4, 0
    v_mov_b32 v5, 0
    v_mov_b32 v6, 0
    v_mov_b32 v7, 0
    global_load_ushort v100, v2, s[66:67] offset:0
    global_load_short_d16_hi v4, v3, s[66:67] offset:0
    global_load_ushort v101, v2, s[66:67] offset:256
    global_load_short_d16_hi v5, v3, s[66:67] offset:256
    global_load_ushort v102, v2, s[66:67] offset:512
    global_load_short_d16_hi v6, v3, s[66:67] offset:512
    global_load_ushort v103, v2, s[66:67] offset:768
    global_load_short_d16_hi v7, v3, s[66:67] offset:768
    s_add_u32 s22, s22, 1
    s_waitcnt vmcnt(0)
    v_or_b32 v100, v100, v4
    v_or_b32 v101, v101, v5
    v_or_b32 v102, v102, v6
    v_or_b32 v103, v103, v7
    s_mul_i32 s24, s22, 3277
    s_lshr_b32 s24, s24, 16
    s_mul_i32 s68, s24, 20
    s_sub_u32 s68, s22, s68
    s_cmp_lt_u32 s68, 8
    s_cselect_b64 s[66:67], s[84:85], s[86:87]
    s_cselect_b32 s25, 0, 8
    s_sub_u32 s68, s68, s25
    s_and_b32 s25, s68, 1
    s_lshr_b32 s68, s68, 1
    s_lshl_b32 s68, s68, 14
    s_lshl_b32 s25, s25, 12
    s_add_u32 s68, s68, s25
    s_lshl_b32 s24, s24, 5
    s_add_u32 s68, s68, s24
    v_lshrrev_b32 v2, 4, v176
    v_lshlrev_b32 v2, 10, v2
    v_and_b32 v3, 15, v176
    v_lshl_add_u32 v2, v3, 1, v2
    v_add_u32 v2, s68, v2
    v_add_u32 v3, 8192, v2
    v_mov_b32 v4, 0
    v_mov_b32 v5, 0
    v_mov_b32 v6, 0
    v_mov_b32 v7, 0
    global_load_ushort v104, v2, s[66:67] offset:0
    global_load_short_d16_hi v4, v3, s[66:67] offset:0
    global_load_ushort v105, v2, s[66:67] offset:256
    global_load_short_d16_hi v5, v3, s[66:67] offset:256
    global_load_ushort v106, v2, s[66:67] offset:512
    global_load_short_d16_hi v6, v3, s[66:67] offset:512
    global_load_ushort v107, v2, s[66:67] offset:768
    global_load_short_d16_hi v7, v3, s[66:67] offset:768
    s_add_u32 s22, s22, 1
    s_waitcnt vmcnt(0)
    v_or_b32 v104, v104, v4
    v_or_b32 v105, v105, v5
    v_or_b32 v106, v106, v6
    v_or_b32 v107, v107, v7
    s_mul_i32 s24, s22, 3277
    s_lshr_b32 s24, s24, 16
    s_mul_i32 s68, s24, 20
    s_sub_u32 s68, s22, s68
    s_cmp_lt_u32 s68, 8
    s_cselect_b64 s[66:67], s[84:85], s[86:87]
    s_cselect_b32 s25, 0, 8
    s_sub_u32 s68, s68, s25
    s_and_b32 s25, s68, 1
    s_lshr_b32 s68, s68, 1
    s_lshl_b32 s68, s68, 14
    s_lshl_b32 s25, s25, 12
    s_add_u32 s68, s68, s25
    s_lshl_b32 s24, s24, 5
    s_add_u32 s68, s68, s24
    v_lshrrev_b32 v2, 4, v176
    v_lshlrev_b32 v2, 10, v2
    v_and_b32 v3, 15, v176
    v_lshl_add_u32 v2, v3, 1, v2
    v_add_u32 v2, s68, v2
    v_add_u32 v3, 8192, v2
    v_mov_b32 v4, 0
    v_mov_b32 v5, 0
    v_mov_b32 v6, 0
    v_mov_b32 v7, 0
    global_load_ushort v108, v2, s[66:67] offset:0
    global_load_short_d16_hi v4, v3, s[66:67] offset:0
    global_load_ushort v109, v2, s[66:67] offset:256
    global_load_short_d16_hi v5, v3, s[66:67] offset:256
    global_load_ushort v110, v2, s[66:67] offset:512
    global_load_short_d16_hi v6, v3, s[66:67] offset:512
    global_load_ushort v111, v2, s[66:67] offset:768
    global_load_short_d16_hi v7, v3, s[66:67] offset:768
    s_add_u32 s22, s22, 1
    s_waitcnt vmcnt(0)
    v_or_b32 v108, v108, v4
    v_or_b32 v109, v109, v5
    v_or_b32 v110, v110, v6
    v_or_b32 v111, v111, v7
    s_mul_i32 s24, s22, 3277
    s_lshr_b32 s24, s24, 16
    s_mul_i32 s68, s24, 20
    s_sub_u32 s68, s22, s68
    s_cmp_lt_u32 s68, 8
    s_cselect_b64 s[66:67], s[84:85], s[86:87]
    s_cselect_b32 s25, 0, 8
    s_sub_u32 s68, s68, s25
    s_and_b32 s25, s68, 1
    s_lshr_b32 s68, s68, 1
    s_lshl_b32 s68, s68, 14
    s_lshl_b32 s25, s25, 12
    s_add_u32 s68, s68, s25
    s_lshl_b32 s24, s24, 5
    s_add_u32 s68, s68, s24
    v_lshrrev_b32 v2, 4, v176
    v_lshlrev_b32 v2, 10, v2
    v_and_b32 v3, 15, v176
    v_lshl_add_u32 v2, v3, 1, v2
    v_add_u32 v2, s68, v2
    v_add_u32 v3, 8192, v2
    v_mov_b32 v4, 0
    v_mov_b32 v5, 0
    v_mov_b32 v6, 0
    v_mov_b32 v7, 0
    global_load_ushort v112, v2, s[66:67] offset:0
    global_load_short_d16_hi v4, v3, s[66:67] offset:0
    global_load_ushort v113, v2, s[66:67] offset:256
    global_load_short_d16_hi v5, v3, s[66:67] offset:256
    global_load_ushort v114, v2, s[66:67] offset:512
    global_load_short_d16_hi v6, v3, s[66:67] offset:512
    global_load_ushort v115, v2, s[66:67] offset:768
    global_load_short_d16_hi v7, v3, s[66:67] offset:768
    s_add_u32 s22, s22, 1
    s_waitcnt vmcnt(0)
    v_or_b32 v112, v112, v4
    v_or_b32 v113, v113, v5
    v_or_b32 v114, v114, v6
    v_or_b32 v115, v115, v7
    s_mul_i32 s24, s22, 3277
    s_lshr_b32 s24, s24, 16
    s_mul_i32 s68, s24, 20
    s_sub_u32 s68, s22, s68
    s_cmp_lt_u32 s68, 8
    s_cselect_b64 s[66:67], s[84:85], s[86:87]
    s_cselect_b32 s25, 0, 8
    s_sub_u32 s68, s68, s25
    s_and_b32 s25, s68, 1
    s_lshr_b32 s68, s68, 1
    s_lshl_b32 s68, s68, 14
    s_lshl_b32 s25, s25, 12
    s_add_u32 s68, s68, s25
    s_lshl_b32 s24, s24, 5
    s_add_u32 s68, s68, s24
    v_lshrrev_b32 v2, 4, v176
    v_lshlrev_b32 v2, 10, v2
    v_and_b32 v3, 15, v176
    v_lshl_add_u32 v2, v3, 1, v2
    v_add_u32 v2, s68, v2
    v_add_u32 v3, 8192, v2
    v_mov_b32 v4, 0
    v_mov_b32 v5, 0
    v_mov_b32 v6, 0
    v_mov_b32 v7, 0
    global_load_ushort v116, v2, s[66:67] offset:0
    global_load_short_d16_hi v4, v3, s[66:67] offset:0
    global_load_ushort v117, v2, s[66:67] offset:256
    global_load_short_d16_hi v5, v3, s[66:67] offset:256
    global_load_ushort v118, v2, s[66:67] offset:512
    global_load_short_d16_hi v6, v3, s[66:67] offset:512
    global_load_ushort v119, v2, s[66:67] offset:768
    global_load_short_d16_hi v7, v3, s[66:67] offset:768
    s_add_u32 s22, s22, 1
    s_waitcnt vmcnt(0)
    v_or_b32 v116, v116, v4
    v_or_b32 v117, v117, v5
    v_or_b32 v118, v118, v6
    v_or_b32 v119, v119, v7
    s_mul_i32 s24, s22, 3277
    s_lshr_b32 s24, s24, 16
    s_mul_i32 s68, s24, 20
    s_sub_u32 s68, s22, s68
    s_cmp_lt_u32 s68, 8
    s_cselect_b64 s[66:67], s[84:85], s[86:87]
    s_cselect_b32 s25, 0, 8
    s_sub_u32 s68, s68, s25
    s_and_b32 s25, s68, 1
    s_lshr_b32 s68, s68, 1
    s_lshl_b32 s68, s68, 14
    s_lshl_b32 s25, s25, 12
    s_add_u32 s68, s68, s25
    s_lshl_b32 s24, s24, 5
    s_add_u32 s68, s68, s24
    v_lshrrev_b32 v2, 4, v176
    v_lshlrev_b32 v2, 10, v2
    v_and_b32 v3, 15, v176
    v_lshl_add_u32 v2, v3, 1, v2
    v_add_u32 v2, s68, v2
    v_add_u32 v3, 8192, v2
    v_mov_b32 v4, 0
    v_mov_b32 v5, 0
    v_mov_b32 v6, 0
    v_mov_b32 v7, 0
    global_load_ushort v120, v2, s[66:67] offset:0
    global_load_short_d16_hi v4, v3, s[66:67] offset:0
    global_load_ushort v121, v2, s[66:67] offset:256
    global_load_short_d16_hi v5, v3, s[66:67] offset:256
    global_load_ushort v122, v2, s[66:67] offset:512
    global_load_short_d16_hi v6, v3, s[66:67] offset:512
    global_load_ushort v123, v2, s[66:67] offset:768
    global_load_short_d16_hi v7, v3, s[66:67] offset:768
    s_add_u32 s22, s22, 1
    s_waitcnt vmcnt(0)
    v_or_b32 v120, v120, v4
    v_or_b32 v121, v121, v5
    v_or_b32 v122, v122, v6
    v_or_b32 v123, v123, v7
    s_mul_i32 s24, s22, 3277
    s_lshr_b32 s24, s24, 16
    s_mul_i32 s68, s24, 20
    s_sub_u32 s68, s22, s68
    s_cmp_lt_u32 s68, 8
    s_cselect_b64 s[66:67], s[84:85], s[86:87]
    s_cselect_b32 s25, 0, 8
    s_sub_u32 s68, s68, s25
    s_and_b32 s25, s68, 1
    s_lshr_b32 s68, s68, 1
    s_lshl_b32 s68, s68, 14
    s_lshl_b32 s25, s25, 12
    s_add_u32 s68, s68, s25
    s_lshl_b32 s24, s24, 5
    s_add_u32 s68, s68, s24
    v_lshrrev_b32 v2, 4, v176
    v_lshlrev_b32 v2, 10, v2
    v_and_b32 v3, 15, v176
    v_lshl_add_u32 v2, v3, 1, v2
    v_add_u32 v2, s68, v2
    v_add_u32 v3, 8192, v2
    v_mov_b32 v4, 0
    v_mov_b32 v5, 0
    v_mov_b32 v6, 0
    v_mov_b32 v7, 0
    global_load_ushort v124, v2, s[66:67] offset:0
    global_load_short_d16_hi v4, v3, s[66:67] offset:0
    global_load_ushort v125, v2, s[66:67] offset:256
    global_load_short_d16_hi v5, v3, s[66:67] offset:256
    global_load_ushort v126, v2, s[66:67] offset:512
    global_load_short_d16_hi v6, v3, s[66:67] offset:512
    global_load_ushort v127, v2, s[66:67] offset:768
    global_load_short_d16_hi v7, v3, s[66:67] offset:768
    s_add_u32 s22, s22, 1
    s_waitcnt vmcnt(0)
    v_or_b32 v124, v124, v4
    v_or_b32 v125, v125, v5
    v_or_b32 v126, v126, v6
    v_or_b32 v127, v127, v7
    s_mul_i32 s24, s22, 3277
    s_lshr_b32 s24, s24, 16
    s_mul_i32 s68, s24, 20
    s_sub_u32 s68, s22, s68
    s_cmp_lt_u32 s68, 8
    s_cselect_b64 s[66:67], s[84:85], s[86:87]
    s_cselect_b32 s25, 0, 8
    s_sub_u32 s68, s68, s25
    s_and_b32 s25, s68, 1
    s_lshr_b32 s68, s68, 1
    s_lshl_b32 s68, s68, 14
    s_lshl_b32 s25, s25, 12
    s_add_u32 s68, s68, s25
    s_lshl_b32 s24, s24, 5
    s_add_u32 s68, s68, s24
    v_lshrrev_b32 v2, 4, v176
    v_lshlrev_b32 v2, 10, v2
    v_and_b32 v3, 15, v176
    v_lshl_add_u32 v2, v3, 1, v2
    v_add_u32 v2, s68, v2
    v_add_u32 v3, 8192, v2
    v_mov_b32 v4, 0
    v_mov_b32 v5, 0
    v_mov_b32 v6, 0
    v_mov_b32 v7, 0
    global_load_ushort v128, v2, s[66:67] offset:0
    global_load_short_d16_hi v4, v3, s[66:67] offset:0
    global_load_ushort v129, v2, s[66:67] offset:256
    global_load_short_d16_hi v5, v3, s[66:67] offset:256
    global_load_ushort v130, v2, s[66:67] offset:512
    global_load_short_d16_hi v6, v3, s[66:67] offset:512
    global_load_ushort v131, v2, s[66:67] offset:768
    global_load_short_d16_hi v7, v3, s[66:67] offset:768
    s_add_u32 s22, s22, 1
    s_waitcnt vmcnt(0)
    v_or_b32 v128, v128, v4
    v_or_b32 v129, v129, v5
    v_or_b32 v130, v130, v6
    v_or_b32 v131, v131, v7
    s_mul_i32 s24, s22, 3277
    s_lshr_b32 s24, s24, 16
    s_mul_i32 s68, s24, 20
    s_sub_u32 s68, s22, s68
    s_cmp_lt_u32 s68, 8
    s_cselect_b64 s[66:67], s[84:85], s[86:87]
    s_cselect_b32 s25, 0, 8
    s_sub_u32 s68, s68, s25
    s_and_b32 s25, s68, 1
    s_lshr_b32 s68, s68, 1
    s_lshl_b32 s68, s68, 14
    s_lshl_b32 s25, s25, 12
    s_add_u32 s68, s68, s25
    s_lshl_b32 s24, s24, 5
    s_add_u32 s68, s68, s24
    v_lshrrev_b32 v2, 4, v176
    v_lshlrev_b32 v2, 10, v2
    v_and_b32 v3, 15, v176
    v_lshl_add_u32 v2, v3, 1, v2
    v_add_u32 v2, s68, v2
    v_add_u32 v3, 8192, v2
    v_mov_b32 v4, 0
    v_mov_b32 v5, 0
    v_mov_b32 v6, 0
    v_mov_b32 v7, 0
    global_load_ushort v132, v2, s[66:67] offset:0
    global_load_short_d16_hi v4, v3, s[66:67] offset:0
    global_load_ushort v133, v2, s[66:67] offset:256
    global_load_short_d16_hi v5, v3, s[66:67] offset:256
    global_load_ushort v134, v2, s[66:67] offset:512
    global_load_short_d16_hi v6, v3, s[66:67] offset:512
    global_load_ushort v135, v2, s[66:67] offset:768
    global_load_short_d16_hi v7, v3, s[66:67] offset:768
    s_add_u32 s22, s22, 1
    s_waitcnt vmcnt(0)
    v_or_b32 v132, v132, v4
    v_or_b32 v133, v133, v5
    v_or_b32 v134, v134, v6
    v_or_b32 v135, v135, v7
    s_mul_i32 s24, s22, 3277
    s_lshr_b32 s24, s24, 16
    s_mul_i32 s68, s24, 20
    s_sub_u32 s68, s22, s68
    s_cmp_lt_u32 s68, 8
    s_cselect_b64 s[66:67], s[84:85], s[86:87]
    s_cselect_b32 s25, 0, 8
    s_sub_u32 s68, s68, s25
    s_and_b32 s25, s68, 1
    s_lshr_b32 s68, s68, 1
    s_lshl_b32 s68, s68, 14
    s_lshl_b32 s25, s25, 12
    s_add_u32 s68, s68, s25
    s_lshl_b32 s24, s24, 5
    s_add_u32 s68, s68, s24
    v_lshrrev_b32 v2, 4, v176
    v_lshlrev_b32 v2, 10, v2
    v_and_b32 v3, 15, v176
    v_lshl_add_u32 v2, v3, 1, v2
    v_add_u32 v2, s68, v2
    v_add_u32 v3, 8192, v2
    v_mov_b32 v4, 0
    v_mov_b32 v5, 0
    v_mov_b32 v6, 0
    v_mov_b32 v7, 0
    global_load_ushort v136, v2, s[66:67] offset:0
    global_load_short_d16_hi v4, v3, s[66:67] offset:0
    global_load_ushort v137, v2, s[66:67] offset:256
    global_load_short_d16_hi v5, v3, s[66:67] offset:256
    global_load_ushort v138, v2, s[66:67] offset:512
    global_load_short_d16_hi v6, v3, s[66:67] offset:512
    global_load_ushort v139, v2, s[66:67] offset:768
    global_load_short_d16_hi v7, v3, s[66:67] offset:768
    s_add_u32 s22, s22, 1
    s_waitcnt vmcnt(0)
    v_or_b32 v136, v136, v4
    v_or_b32 v137, v137, v5
    v_or_b32 v138, v138, v6
    v_or_b32 v139, v139, v7
    s_mul_i32 s24, s22, 3277
    s_lshr_b32 s24, s24, 16
    s_mul_i32 s68, s24, 20
    s_sub_u32 s68, s22, s68
    s_cmp_lt_u32 s68, 8
    s_cselect_b64 s[66:67], s[84:85], s[86:87]
    s_cselect_b32 s25, 0, 8
    s_sub_u32 s68, s68, s25
    s_and_b32 s25, s68, 1
    s_lshr_b32 s68, s68, 1
    s_lshl_b32 s68, s68, 14
    s_lshl_b32 s25, s25, 12
    s_add_u32 s68, s68, s25
    s_lshl_b32 s24, s24, 5
    s_add_u32 s68, s68, s24
    v_lshrrev_b32 v2, 4, v176
    v_lshlrev_b32 v2, 10, v2
    v_and_b32 v3, 15, v176
    v_lshl_add_u32 v2, v3, 1, v2
    v_add_u32 v2, s68, v2
    v_add_u32 v3, 8192, v2
    v_mov_b32 v4, 0
    v_mov_b32 v5, 0
    v_mov_b32 v6, 0
    v_mov_b32 v7, 0
    global_load_ushort v140, v2, s[66:67] offset:0
    global_load_short_d16_hi v4, v3, s[66:67] offset:0
    global_load_ushort v141, v2, s[66:67] offset:256
    global_load_short_d16_hi v5, v3, s[66:67] offset:256
    global_load_ushort v142, v2, s[66:67] offset:512
    global_load_short_d16_hi v6, v3, s[66:67] offset:512
    global_load_ushort v143, v2, s[66:67] offset:768
    global_load_short_d16_hi v7, v3, s[66:67] offset:768
    s_add_u32 s22, s22, 1
    s_waitcnt vmcnt(0)
    v_or_b32 v140, v140, v4
    v_or_b32 v141, v141, v5
    v_or_b32 v142, v142, v6
    v_or_b32 v143, v143, v7
    s_mul_i32 s24, s22, 3277
    s_lshr_b32 s24, s24, 16
    s_mul_i32 s68, s24, 20
    s_sub_u32 s68, s22, s68
    s_cmp_lt_u32 s68, 8
    s_cselect_b64 s[66:67], s[84:85], s[86:87]
    s_cselect_b32 s25, 0, 8
    s_sub_u32 s68, s68, s25
    s_and_b32 s25, s68, 1
    s_lshr_b32 s68, s68, 1
    s_lshl_b32 s68, s68, 14
    s_lshl_b32 s25, s25, 12
    s_add_u32 s68, s68, s25
    s_lshl_b32 s24, s24, 5
    s_add_u32 s68, s68, s24
    v_lshrrev_b32 v2, 4, v176
    v_lshlrev_b32 v2, 10, v2
    v_and_b32 v3, 15, v176
    v_lshl_add_u32 v2, v3, 1, v2
    v_add_u32 v2, s68, v2
    v_add_u32 v3, 8192, v2
    v_mov_b32 v4, 0
    v_mov_b32 v5, 0
    v_mov_b32 v6, 0
    v_mov_b32 v7, 0
    global_load_ushort v144, v2, s[66:67] offset:0
    global_load_short_d16_hi v4, v3, s[66:67] offset:0
    global_load_ushort v145, v2, s[66:67] offset:256
    global_load_short_d16_hi v5, v3, s[66:67] offset:256
    global_load_ushort v146, v2, s[66:67] offset:512
    global_load_short_d16_hi v6, v3, s[66:67] offset:512
    global_load_ushort v147, v2, s[66:67] offset:768
    global_load_short_d16_hi v7, v3, s[66:67] offset:768
    s_add_u32 s22, s22, 1
    s_waitcnt vmcnt(0)
    v_or_b32 v144, v144, v4
    v_or_b32 v145, v145, v5
    v_or_b32 v146, v146, v6
    v_or_b32 v147, v147, v7
    s_mul_i32 s24, s22, 3277
    s_lshr_b32 s24, s24, 16
    s_mul_i32 s68, s24, 20
    s_sub_u32 s68, s22, s68
    s_cmp_lt_u32 s68, 8
    s_cselect_b64 s[66:67], s[84:85], s[86:87]
    s_cselect_b32 s25, 0, 8
    s_sub_u32 s68, s68, s25
    s_and_b32 s25, s68, 1
    s_lshr_b32 s68, s68, 1
    s_lshl_b32 s68, s68, 14
    s_lshl_b32 s25, s25, 12
    s_add_u32 s68, s68, s25
    s_lshl_b32 s24, s24, 5
    s_add_u32 s68, s68, s24
    v_lshrrev_b32 v2, 4, v176
    v_lshlrev_b32 v2, 10, v2
    v_and_b32 v3, 15, v176
    v_lshl_add_u32 v2, v3, 1, v2
    v_add_u32 v2, s68, v2
    v_add_u32 v3, 8192, v2
    v_mov_b32 v4, 0
    v_mov_b32 v5, 0
    v_mov_b32 v6, 0
    v_mov_b32 v7, 0
    global_load_ushort v148, v2, s[66:67] offset:0
    global_load_short_d16_hi v4, v3, s[66:67] offset:0
    global_load_ushort v149, v2, s[66:67] offset:256
    global_load_short_d16_hi v5, v3, s[66:67] offset:256
    global_load_ushort v150, v2, s[66:67] offset:512
    global_load_short_d16_hi v6, v3, s[66:67] offset:512
    global_load_ushort v151, v2, s[66:67] offset:768
    global_load_short_d16_hi v7, v3, s[66:67] offset:768
    s_add_u32 s22, s22, 1
    s_waitcnt vmcnt(0)
    v_or_b32 v148, v148, v4
    v_or_b32 v149, v149, v5
    v_or_b32 v150, v150, v6
    v_or_b32 v151, v151, v7
    s_mul_i32 s24, s22, 3277
    s_lshr_b32 s24, s24, 16
    s_mul_i32 s68, s24, 20
    s_sub_u32 s68, s22, s68
    s_cmp_lt_u32 s68, 8
    s_cselect_b64 s[66:67], s[84:85], s[86:87]
    s_cselect_b32 s25, 0, 8
    s_sub_u32 s68, s68, s25
    s_and_b32 s25, s68, 1
    s_lshr_b32 s68, s68, 1
    s_lshl_b32 s68, s68, 14
    s_lshl_b32 s25, s25, 12
    s_add_u32 s68, s68, s25
    s_lshl_b32 s24, s24, 5
    s_add_u32 s68, s68, s24
    v_lshrrev_b32 v2, 4, v176
    v_lshlrev_b32 v2, 10, v2
    v_and_b32 v3, 15, v176
    v_lshl_add_u32 v2, v3, 1, v2
    v_add_u32 v2, s68, v2
    v_add_u32 v3, 8192, v2
    v_mov_b32 v4, 0
    v_mov_b32 v5, 0
    v_mov_b32 v6, 0
    v_mov_b32 v7, 0
    global_load_ushort v152, v2, s[66:67] offset:0
    global_load_short_d16_hi v4, v3, s[66:67] offset:0
    global_load_ushort v153, v2, s[66:67] offset:256
    global_load_short_d16_hi v5, v3, s[66:67] offset:256
    global_load_ushort v154, v2, s[66:67] offset:512
    global_load_short_d16_hi v6, v3, s[66:67] offset:512
    global_load_ushort v155, v2, s[66:67] offset:768
    global_load_short_d16_hi v7, v3, s[66:67] offset:768
    s_add_u32 s22, s22, 1
    s_waitcnt vmcnt(0)
    v_or_b32 v152, v152, v4
    v_or_b32 v153, v153, v5
    v_or_b32 v154, v154, v6
    v_or_b32 v155, v155, v7
    s_mul_i32 s24, s22, 3277
    s_lshr_b32 s24, s24, 16
    s_mul_i32 s68, s24, 20
    s_sub_u32 s68, s22, s68
    s_cmp_lt_u32 s68, 8
    s_cselect_b64 s[66:67], s[84:85], s[86:87]
    s_cselect_b32 s25, 0, 8
    s_sub_u32 s68, s68, s25
    s_and_b32 s25, s68, 1
    s_lshr_b32 s68, s68, 1
    s_lshl_b32 s68, s68, 14
    s_lshl_b32 s25, s25, 12
    s_add_u32 s68, s68, s25
    s_lshl_b32 s24, s24, 5
    s_add_u32 s68, s68, s24
    v_lshrrev_b32 v2, 4, v176
    v_lshlrev_b32 v2, 10, v2
    v_and_b32 v3, 15, v176
    v_lshl_add_u32 v2, v3, 1, v2
    v_add_u32 v2, s68, v2
    v_add_u32 v3, 8192, v2
    v_mov_b32 v4, 0
    v_mov_b32 v5, 0
    v_mov_b32 v6, 0
    v_mov_b32 v7, 0
    global_load_ushort v156, v2, s[66:67] offset:0
    global_load_short_d16_hi v4, v3, s[66:67] offset:0
    global_load_ushort v157, v2, s[66:67] offset:256
    global_load_short_d16_hi v5, v3, s[66:67] offset:256
    global_load_ushort v158, v2, s[66:67] offset:512
    global_load_short_d16_hi v6, v3, s[66:67] offset:512
    global_load_ushort v159, v2, s[66:67] offset:768
    global_load_short_d16_hi v7, v3, s[66:67] offset:768
    s_add_u32 s22, s22, 1
    s_waitcnt vmcnt(0)
    v_or_b32 v156, v156, v4
    v_or_b32 v157, v157, v5
    v_or_b32 v158, v158, v6
    v_or_b32 v159, v159, v7
    s_mul_i32 s24, s22, 3277
    s_lshr_b32 s24, s24, 16
    s_mul_i32 s68, s24, 20
    s_sub_u32 s68, s22, s68
    s_cmp_lt_u32 s68, 8
    s_cselect_b64 s[66:67], s[84:85], s[86:87]
    s_cselect_b32 s25, 0, 8
    s_sub_u32 s68, s68, s25
    s_and_b32 s25, s68, 1
    s_lshr_b32 s68, s68, 1
    s_lshl_b32 s68, s68, 14
    s_lshl_b32 s25, s25, 12
    s_add_u32 s68, s68, s25
    s_lshl_b32 s24, s24, 5
    s_add_u32 s68, s68, s24
    v_lshrrev_b32 v2, 4, v176
    v_lshlrev_b32 v2, 10, v2
    v_and_b32 v3, 15, v176
    v_lshl_add_u32 v2, v3, 1, v2
    v_add_u32 v2, s68, v2
    v_add_u32 v3, 8192, v2
    v_mov_b32 v4, 0
    v_mov_b32 v5, 0
    v_mov_b32 v6, 0
    v_mov_b32 v7, 0
    global_load_ushort v160, v2, s[66:67] offset:0
    global_load_short_d16_hi v4, v3, s[66:67] offset:0
    global_load_ushort v161, v2, s[66:67] offset:256
    global_load_short_d16_hi v5, v3, s[66:67] offset:256
    global_load_ushort v162, v2, s[66:67] offset:512
    global_load_short_d16_hi v6, v3, s[66:67] offset:512
    global_load_ushort v163, v2, s[66:67] offset:768
    global_load_short_d16_hi v7, v3, s[66:67] offset:768
    s_add_u32 s22, s22, 1
    s_waitcnt vmcnt(0)
    v_or_b32 v160, v160, v4
    v_or_b32 v161, v161, v5
    v_or_b32 v162, v162, v6
    v_or_b32 v163, v163, v7
    s_mul_i32 s24, s22, 3277
    s_lshr_b32 s24, s24, 16
    s_mul_i32 s68, s24, 20
    s_sub_u32 s68, s22, s68
    s_cmp_lt_u32 s68, 8
    s_cselect_b64 s[66:67], s[84:85], s[86:87]
    s_cselect_b32 s25, 0, 8
    s_sub_u32 s68, s68, s25
    s_and_b32 s25, s68, 1
    s_lshr_b32 s68, s68, 1
    s_lshl_b32 s68, s68, 14
    s_lshl_b32 s25, s25, 12
    s_add_u32 s68, s68, s25
    s_lshl_b32 s24, s24, 5
    s_add_u32 s68, s68, s24
    v_lshrrev_b32 v2, 4, v176
    v_lshlrev_b32 v2, 10, v2
    v_and_b32 v3, 15, v176
    v_lshl_add_u32 v2, v3, 1, v2
    v_add_u32 v2, s68, v2
    v_add_u32 v3, 8192, v2
    v_mov_b32 v4, 0
    v_mov_b32 v5, 0
    v_mov_b32 v6, 0
    v_mov_b32 v7, 0
    global_load_ushort v164, v2, s[66:67] offset:0
    global_load_short_d16_hi v4, v3, s[66:67] offset:0
    global_load_ushort v165, v2, s[66:67] offset:256
    global_load_short_d16_hi v5, v3, s[66:67] offset:256
    global_load_ushort v166, v2, s[66:67] offset:512
    global_load_short_d16_hi v6, v3, s[66:67] offset:512
    global_load_ushort v167, v2, s[66:67] offset:768
    global_load_short_d16_hi v7, v3, s[66:67] offset:768
    s_add_u32 s22, s22, 1
    s_waitcnt vmcnt(0)
    v_or_b32 v164, v164, v4
    v_or_b32 v165, v165, v5
    v_or_b32 v166, v166, v6
    v_or_b32 v167, v167, v7
    s_mul_i32 s24, s22, 3277
    s_lshr_b32 s24, s24, 16
    s_mul_i32 s68, s24, 20
    s_sub_u32 s68, s22, s68
    s_cmp_lt_u32 s68, 8
    s_cselect_b64 s[66:67], s[84:85], s[86:87]
    s_cselect_b32 s25, 0, 8
    s_sub_u32 s68, s68, s25
    s_and_b32 s25, s68, 1
    s_lshr_b32 s68, s68, 1
    s_lshl_b32 s68, s68, 14
    s_lshl_b32 s25, s25, 12
    s_add_u32 s68, s68, s25
    s_lshl_b32 s24, s24, 5
    s_add_u32 s68, s68, s24
    v_lshrrev_b32 v2, 4, v176
    v_lshlrev_b32 v2, 10, v2
    v_and_b32 v3, 15, v176
    v_lshl_add_u32 v2, v3, 1, v2
    v_add_u32 v2, s68, v2
    v_add_u32 v3, 8192, v2
    v_mov_b32 v4, 0
    v_mov_b32 v5, 0
    v_mov_b32 v6, 0
    v_mov_b32 v7, 0
    global_load_ushort v168, v2, s[66:67] offset:0
    global_load_short_d16_hi v4, v3, s[66:67] offset:0
    global_load_ushort v169, v2, s[66:67] offset:256
    global_load_short_d16_hi v5, v3, s[66:67] offset:256
    global_load_ushort v170, v2, s[66:67] offset:512
    global_load_short_d16_hi v6, v3, s[66:67] offset:512
    global_load_ushort v171, v2, s[66:67] offset:768
    global_load_short_d16_hi v7, v3, s[66:67] offset:768
    s_add_u32 s22, s22, 1
    s_waitcnt vmcnt(0)
    v_or_b32 v168, v168, v4
    v_or_b32 v169, v169, v5
    v_or_b32 v170, v170, v6
    v_or_b32 v171, v171, v7
    s_mul_i32 s24, s22, 3277
    s_lshr_b32 s24, s24, 16
    s_mul_i32 s68, s24, 20
    s_sub_u32 s68, s22, s68
    s_cmp_lt_u32 s68, 8
    s_cselect_b64 s[66:67], s[84:85], s[86:87]
    s_cselect_b32 s25, 0, 8
    s_sub_u32 s68, s68, s25
    s_and_b32 s25, s68, 1
    s_lshr_b32 s68, s68, 1
    s_lshl_b32 s68, s68, 14
    s_lshl_b32 s25, s25, 12
    s_add_u32 s68, s68, s25
    s_lshl_b32 s24, s24, 5
    s_add_u32 s68, s68, s24
    v_lshrrev_b32 v2, 4, v176
    v_lshlrev_b32 v2, 10, v2
    v_and_b32 v3, 15, v176
    v_lshl_add_u32 v2, v3, 1, v2
    v_add_u32 v2, s68, v2
    v_add_u32 v3, 8192, v2
    v_mov_b32 v4, 0
    v_mov_b32 v5, 0
    v_mov_b32 v6, 0
    v_mov_b32 v7, 0
    global_load_ushort v172, v2, s[66:67] offset:0
    global_load_short_d16_hi v4, v3, s[66:67] offset:0
    global_load_ushort v173, v2, s[66:67] offset:256
    global_load_short_d16_hi v5, v3, s[66:67] offset:256
    global_load_ushort v174, v2, s[66:67] offset:512
    global_load_short_d16_hi v6, v3, s[66:67] offset:512
    global_load_ushort v175, v2, s[66:67] offset:768
    global_load_short_d16_hi v7, v3, s[66:67] offset:768
    s_add_u32 s22, s22, 1
    s_waitcnt vmcnt(0)
    v_or_b32 v172, v172, v4
    v_or_b32 v173, v173, v5
    v_or_b32 v174, v174, v6
    v_or_b32 v175, v175, v7
    s_branch GEMM
.section .rodata,"a"
.p2align 6
.amdhsa_kernel standalone__tensor_product_equiv_equiformer__graph_kernel
  .amdhsa_next_free_vgpr 256
  .amdhsa_next_free_sgpr 90
  .amdhsa_accum_offset 256
  .amdhsa_group_segment_fixed_size 0
  .amdhsa_kernarg_size 96
  .amdhsa_user_sgpr_count 2
  .amdhsa_user_sgpr_kernarg_segment_ptr 1
  .amdhsa_system_sgpr_workgroup_id_x 1
.end_amdhsa_kernel
```

```asm
; @launch grid=(250,1,1) block=(512,1,1) lds=163840
.amdgcn_target "amdgcn-amd-amdhsa--gfx950"
.text
.globl standalone__tensor_product_equiv_equiformer__graph_kernel
.p2align 8
.type standalone__tensor_product_equiv_equiformer__graph_kernel,@function
standalone__tensor_product_equiv_equiformer__graph_kernel:
    s_cmp_ge_u32 s2, 250
    s_cbranch_scc1 K2_end
    s_load_dwordx16 s[72:87], s[0:1], 0
    s_load_dwordx2 s[70:71], s[0:1], 88
    v_lshrrev_b32 v2, 6, v0
    v_and_b32 v1, 63, v0
    v_readfirstlane_b32 s20, v2
    s_getpc_b64 s[66:67]
    v_lshlrev_b32 v95, 7, v1
    s_cmp_eq_u32 s20, 6
    s_cbranch_scc0 F_nopf0
    global_load_dword v95, v95, s[66:67]
F_nopf0:
    s_mul_i32 s66, s2, 5120
    s_mul_i32 s67, s2, 7680
    v_lshl_add_u32 v3, v0, 4, s66
    v_mul_u32_u24 v4, 24, v0
    v_add_u32 v4, s67, v4
    v_lshlrev_b32 v5, 2, v0
    v_mov_b32 v89, 0
    v_add_u32 v6, 98304, v5
    ds_write_b32 v6, v89
    s_cmp_ge_u32 s20, 5
    s_waitcnt lgkmcnt(0)
    s_cbranch_scc1 F_noload
    global_load_dwordx4 v[8:11], v3, s[80:81] nt
    global_load_dwordx4 v[12:15], v3, s[78:79] nt
    global_load_dwordx4 v[16:19], v4, s[74:75] nt
    global_load_dwordx2 v[20:21], v4, s[74:75] offset:16 nt
F_noload:
    s_load_dword s88, s[70:71], 0
    s_barrier
    v_lshlrev_b32 v248, 2, v1
    v_add_u32 v88, 162816, v248
    ds_write_b32 v88, v89
    ds_write_b32 v88, v89 offset:256
    v_lshlrev_b32 v86, 4, v1
    s_lshl_b32 s21, s20, 13
    v_lshrrev_b32 v6, 5, v1
    v_mul_u32_u24 v6, 5120, v6
    v_and_b32 v7, 31, v1
    v_lshl_add_u32 v6, v7, 1, v6
    s_lshr_b32 s66, s20, 2
    s_lshl_b32 s66, s66, 7
    s_and_b32 s67, s20, 3
    s_mul_i32 s67, s67, 5
    s_add_u32 s68, s67, 0
    s_lshr_b32 s24, s68, 2
    s_lshl_b32 s24, s24, 8
    s_bfe_u32 s69, s68, 0x10001
    s_lshl_b32 s69, s69, 6
    s_add_u32 s24, s24, s69
    s_and_b32 s69, s68, 1
    s_mul_i32 s69, s69, 10240
    s_add_u32 s24, s24, s69
    s_add_u32 s24, s24, s66
    s_add_u32 s68, s67, 1
    s_lshr_b32 s25, s68, 2
    s_lshl_b32 s25, s25, 8
    s_bfe_u32 s69, s68, 0x10001
    s_lshl_b32 s69, s69, 6
    s_add_u32 s25, s25, s69
    s_and_b32 s69, s68, 1
    s_mul_i32 s69, s69, 10240
    s_add_u32 s25, s25, s69
    s_add_u32 s25, s25, s66
    s_add_u32 s68, s67, 2
    s_lshr_b32 s26, s68, 2
    s_lshl_b32 s26, s26, 8
    s_bfe_u32 s69, s68, 0x10001
    s_lshl_b32 s69, s69, 6
    s_add_u32 s26, s26, s69
    s_and_b32 s69, s68, 1
    s_mul_i32 s69, s69, 10240
    s_add_u32 s26, s26, s69
    s_add_u32 s26, s26, s66
    s_add_u32 s68, s67, 3
    s_lshr_b32 s27, s68, 2
    s_lshl_b32 s27, s27, 8
    s_bfe_u32 s69, s68, 0x10001
    s_lshl_b32 s69, s69, 6
    s_add_u32 s27, s27, s69
    s_and_b32 s69, s68, 1
    s_mul_i32 s69, s69, 10240
    s_add_u32 s27, s27, s69
    s_add_u32 s27, s27, s66
    s_add_u32 s68, s67, 4
    s_lshr_b32 s28, s68, 2
    s_lshl_b32 s28, s28, 8
    s_bfe_u32 s69, s68, 0x10001
    s_lshl_b32 s69, s69, 6
    s_add_u32 s28, s28, s69
    s_and_b32 s69, s68, 1
    s_mul_i32 s69, s69, 10240
    s_add_u32 s28, s28, s69
    s_add_u32 s28, s28, s66
    v_mov_b32 v96, 0
    v_mov_b32 v97, 0
    v_mov_b32 v98, 0
    v_mov_b32 v99, 0
    v_mov_b32 v100, 0
    v_mov_b32 v101, 0
    v_mov_b32 v102, 0
    v_mov_b32 v103, 0
    v_mov_b32 v104, 0
    v_mov_b32 v105, 0
    v_mov_b32 v106, 0
    v_mov_b32 v107, 0
    v_mov_b32 v108, 0
    v_mov_b32 v109, 0
    v_mov_b32 v110, 0
    v_mov_b32 v111, 0
    v_mov_b32 v112, 0
    v_mov_b32 v113, 0
    v_mov_b32 v114, 0
    v_mov_b32 v115, 0
    v_mov_b32 v180, 0
    v_mov_b32 v181, 0
    v_mov_b32 v182, 0
    v_mov_b32 v183, 0
    s_mov_b32 s16, s70
    s_and_b32 s17, s71, 0xffff
    s_mov_b32 s18, 24165888
    s_mov_b32 s19, 0x20000
    v_lshrrev_b32 v2, 3, v1
    v_lshl_add_u32 v2, s20, 5, v2
    v_and_b32 v91, 7, v1
    v_mul_u32_u24 v94, 384, v2
    v_lshl_add_u32 v94, v91, 4, v94
    v_lshlrev_b32 v93, 2, v2
    v_add_u32 v93, 98304, v93
    v_mul_u32_u24 v92, 32000, v2
    v_lshl_add_u32 v92, v91, 4, v92
    v_mul_u32_u24 v90, 40960, v2
    s_mov_b32 s32, s82
    s_and_b32 s33, s83, 0xffff
    s_mov_b32 s34, 20480
    s_mov_b32 s35, 0x20000
    s_cmp_ge_u32 s20, 5
    s_cbranch_scc1 F_helper
    s_mov_b32 s22, 52429
    s_mov_b32 s23, 0x05040100
    s_mov_b32 s66, 98304
    s_movk_i32 s67, -40
    v_mov_b32 v7, 1
    v_add_u32 v31, 1, v5
    v_add_u32 v32, 2, v5
    v_add_u32 v33, 3, v5
    s_waitcnt vmcnt(3)
    v_mul_u32_u24 v22, s22, v8
    v_mul_u32_u24 v23, s22, v9
    v_mul_u32_u24 v24, s22, v10
    v_mul_u32_u24 v25, s22, v11
    v_lshrrev_b32 v22, 21, v22
    v_lshrrev_b32 v23, 21, v23
    v_lshrrev_b32 v24, 21, v24
    v_lshrrev_b32 v25, 21, v25
    v_lshl_add_u32 v34, v22, 2, s66
    ds_add_rtn_u32 v26, v34, v7
    v_lshl_add_u32 v35, v23, 2, s66
    ds_add_rtn_u32 v27, v35, v7
    v_lshl_add_u32 v36, v24, 2, s66
    ds_add_rtn_u32 v28, v36, v7
    v_lshl_add_u32 v37, v25, 2, s66
    ds_add_rtn_u32 v29, v37, v7
    buffer_load_short_d16_hi v96, v6, s[32:35], s24 offen offset:0
    buffer_load_short_d16_hi v97, v6, s[32:35], s24 offen offset:1280
    buffer_load_short_d16_hi v98, v6, s[32:35], s24 offen offset:2560
    buffer_load_short_d16_hi v99, v6, s[32:35], s24 offen offset:3840
    buffer_load_short_d16_hi v100, v6, s[32:35], s25 offen offset:0
    buffer_load_short_d16_hi v101, v6, s[32:35], s25 offen offset:1280
    buffer_load_short_d16_hi v102, v6, s[32:35], s25 offen offset:2560
    buffer_load_short_d16_hi v103, v6, s[32:35], s25 offen offset:3840
    buffer_load_short_d16_hi v104, v6, s[32:35], s26 offen offset:0
    buffer_load_short_d16_hi v105, v6, s[32:35], s26 offen offset:1280
    buffer_load_short_d16_hi v106, v6, s[32:35], s26 offen offset:2560
    buffer_load_short_d16_hi v107, v6, s[32:35], s26 offen offset:3840
    buffer_load_short_d16_hi v108, v6, s[32:35], s27 offen offset:0
    buffer_load_short_d16_hi v109, v6, s[32:35], s27 offen offset:1280
    buffer_load_short_d16_hi v110, v6, s[32:35], s27 offen offset:2560
    buffer_load_short_d16_hi v111, v6, s[32:35], s27 offen offset:3840
    buffer_load_short_d16_hi v112, v6, s[32:35], s28 offen offset:0
    buffer_load_short_d16_hi v113, v6, s[32:35], s28 offen offset:1280
    buffer_load_short_d16_hi v114, v6, s[32:35], s28 offen offset:2560
    buffer_load_short_d16_hi v115, v6, s[32:35], s28 offen offset:3840
    v_mad_i32_i24 v2, v22, s67, v8
    v_mul_u32_u24 v22, 384, v22
    v_lshl_or_b32 v42, v2, 11, v5
    v_mad_i32_i24 v2, v23, s67, v9
    v_mul_u32_u24 v23, 384, v23
    v_lshl_or_b32 v46, v2, 11, v31
    v_mad_i32_i24 v2, v24, s67, v10
    v_mul_u32_u24 v24, 384, v24
    v_lshl_or_b32 v50, v2, 11, v32
    v_mad_i32_i24 v2, v25, s67, v11
    v_mul_u32_u24 v25, 384, v25
    v_lshl_or_b32 v54, v2, 11, v33
    s_waitcnt vmcnt(20)
    v_mov_b32 v40, v16
    v_perm_b32 v41, v12, v17, s23
    v_alignbit_b32 v44, v18, v17, 16
    v_alignbit_b32 v45, v13, v18, 16
    v_mov_b32 v48, v19
    v_perm_b32 v49, v14, v20, s23
    v_alignbit_b32 v52, v21, v20, 16
    v_alignbit_b32 v53, v15, v21, 16
    v_xor_b32 v41, 0x8000, v41
    v_xor_b32 v45, 0x8000, v45
    v_xor_b32 v49, 0x8000, v49
    v_xor_b32 v53, 0x8000, v53
    s_waitcnt lgkmcnt(0)
    v_min_u32 v26, 23, v26
    v_lshl_add_u32 v34, v26, 4, v22
    ds_write_b128 v34, v[40:43]
    v_min_u32 v27, 23, v27
    v_lshl_add_u32 v35, v27, 4, v23
    ds_write_b128 v35, v[44:47]
    v_min_u32 v28, 23, v28
    v_lshl_add_u32 v36, v28, 4, v24
    ds_write_b128 v36, v[48:51]
    v_min_u32 v29, 23, v29
    v_lshl_add_u32 v37, v29, 4, v25
    ds_write_b128 v37, v[52:55]
    s_branch F_staged
F_helper:
    buffer_load_short_d16_hi v96, v6, s[32:35], s24 offen offset:0
    buffer_load_short_d16_hi v97, v6, s[32:35], s24 offen offset:1280
    buffer_load_short_d16_hi v98, v6, s[32:35], s24 offen offset:2560
    buffer_load_short_d16_hi v99, v6, s[32:35], s24 offen offset:3840
    buffer_load_short_d16_hi v100, v6, s[32:35], s25 offen offset:0
    buffer_load_short_d16_hi v101, v6, s[32:35], s25 offen offset:1280
    buffer_load_short_d16_hi v102, v6, s[32:35], s25 offen offset:2560
    buffer_load_short_d16_hi v103, v6, s[32:35], s25 offen offset:3840
    buffer_load_short_d16_hi v104, v6, s[32:35], s26 offen offset:0
    buffer_load_short_d16_hi v105, v6, s[32:35], s26 offen offset:1280
    buffer_load_short_d16_hi v106, v6, s[32:35], s26 offen offset:2560
    buffer_load_short_d16_hi v107, v6, s[32:35], s26 offen offset:3840
    buffer_load_short_d16_hi v108, v6, s[32:35], s27 offen offset:0
    buffer_load_short_d16_hi v109, v6, s[32:35], s27 offen offset:1280
    buffer_load_short_d16_hi v110, v6, s[32:35], s27 offen offset:2560
    buffer_load_short_d16_hi v111, v6, s[32:35], s27 offen offset:3840
    buffer_load_short_d16_hi v112, v6, s[32:35], s28 offen offset:0
    buffer_load_short_d16_hi v113, v6, s[32:35], s28 offen offset:1280
    buffer_load_short_d16_hi v114, v6, s[32:35], s28 offen offset:2560
    buffer_load_short_d16_hi v115, v6, s[32:35], s28 offen offset:3840
    s_cmp_eq_u32 s20, 6
    s_cbranch_scc0 F_nopf
    s_getpc_b64 s[66:67]
F_pc:
    s_lshr_b32 s68, s2, 3
    s_mul_i32 s68, s68, ((K2_last-F_pc)/128/31+1)*128
    v_lshl_add_u32 v2, v1, 7, s68
    v_min_u32 v2, K2_last-F_pc-4, v2
    v_cmp_gt_u32 vcc, (K2_last-F_pc)/128/31+1, v1
    s_mov_b64 exec, vcc
    global_load_dword v95, v2, s[66:67]
    s_mov_b64 exec, -1
F_nopf:
    s_cmp_eq_u32 s20, 7
    s_cbranch_scc0 F_staged
    s_cmp_lt_u32 s2, 160
    s_cbranch_scc0 F_staged
    s_mul_i32 s22, s2, 3277
    s_lshr_b32 s22, s22, 16
    s_mul_i32 s68, s22, 20
    s_sub_u32 s68, s2, s68
    s_cmp_lt_u32 s68, 8
    s_cselect_b64 s[66:67], s[84:85], s[86:87]
    s_cselect_b32 s23, 0, 8
    s_sub_u32 s68, s68, s23
    s_and_b32 s23, s68, 1
    s_lshr_b32 s68, s68, 1
    s_lshl_b32 s68, s68, 14
    s_lshl_b32 s23, s23, 12
    s_add_u32 s68, s68, s23
    s_lshl_b32 s22, s22, 5
    s_add_u32 s68, s68, s22
    v_lshrrev_b32 v2, 4, v1
    v_lshlrev_b32 v2, 10, v2
    v_and_b32 v3, 15, v1
    v_lshl_add_u32 v2, v3, 1, v2
    v_add_u32 v2, s68, v2
    v_add_u32 v3, 8192, v2
    global_load_ushort v176, v2, s[66:67] offset:0
    global_load_short_d16_hi v180, v3, s[66:67] offset:0
    global_load_ushort v177, v2, s[66:67] offset:256
    global_load_short_d16_hi v181, v3, s[66:67] offset:256
    global_load_ushort v178, v2, s[66:67] offset:512
    global_load_short_d16_hi v182, v3, s[66:67] offset:512
    global_load_ushort v179, v2, s[66:67] offset:768
    global_load_short_d16_hi v183, v3, s[66:67] offset:768
F_staged:
    s_lshl_b32 s66, s2, 7
    s_add_u32 s66, s66, 164864
    s_cmp_eq_u32 s20, 7
    s_cselect_b32 s22, 0xffff, -1
    s_cselect_b32 s23, 0, -1
    s_waitcnt lgkmcnt(0)
    s_add_u32 s88, s88, 1
    s_barrier
    ds_read_b32 v40, v93 offset:0
    ds_read_b128 v[8:11], v94 offset:0
    ds_read_b128 v[12:15], v94 offset:128
    ds_read_b32 v41, v93 offset:32
    ds_read_b128 v[16:19], v94 offset:3072
    ds_read_b128 v[20:23], v94 offset:3200
    ds_read_b32 v42, v93 offset:64
    ds_read_b128 v[24:27], v94 offset:6144
    ds_read_b128 v[28:31], v94 offset:6272
    ds_read_b32 v43, v93 offset:96
    ds_read_b128 v[32:35], v94 offset:9216
    ds_read_b128 v[36:39], v94 offset:9344
    s_waitcnt vmcnt(0)
    s_waitcnt lgkmcnt(9)
    v_min_u32 v5, 31, v40
    v_bfe_u32 v6, v14, 11, 6
    v_and_b32 v10, 0x1ffff, v10
    v_lshl_or_b32 v6, v5, 6, v6
    v_mov_b32 v11, s88
    v_lshl_or_b32 v10, v6, 17, v10
    v_mov_b32 v15, s88
    buffer_store_dwordx4 v[8:11], v92, s[16:19], s66 offen sc1
    v_cmp_lt_u32 vcc, 8, v40
    s_add_u32 s67, s66, 8000000
    s_mov_b64 exec, vcc
    s_cbranch_execz F_w0
    buffer_store_dwordx4 v[12:15], v92, s[16:19], s67 offen sc1
    v_cmp_lt_u32 vcc, 16, v40
    s_add_u32 s67, s67, 8000000
    s_mov_b64 exec, vcc
    s_cbranch_execz F_w0
    ds_read_b128 v[44:47], v94 offset:256
    s_waitcnt lgkmcnt(0)
    v_mov_b32 v47, s88
    buffer_store_dwordx4 v[44:47], v92, s[16:19], s67 offen sc1
    s_nop 1
F_w0:
    s_mov_b64 exec, -1
    s_add_u32 s66, s66, 256000
    s_waitcnt lgkmcnt(6)
    v_min_u32 v5, 31, v41
    v_bfe_u32 v6, v22, 11, 6
    v_and_b32 v18, 0x1ffff, v18
    v_lshl_or_b32 v6, v5, 6, v6
    v_mov_b32 v19, s88
    v_lshl_or_b32 v18, v6, 17, v18
    v_mov_b32 v23, s88
    buffer_store_dwordx4 v[16:19], v92, s[16:19], s66 offen sc1
    v_cmp_lt_u32 vcc, 8, v41
    s_add_u32 s67, s66, 8000000
    s_mov_b64 exec, vcc
    s_cbranch_execz F_w1
    buffer_store_dwordx4 v[20:23], v92, s[16:19], s67 offen sc1
    v_cmp_lt_u32 vcc, 16, v41
    s_add_u32 s67, s67, 8000000
    s_mov_b64 exec, vcc
    s_cbranch_execz F_w1
    ds_read_b128 v[44:47], v94 offset:3328
    s_waitcnt lgkmcnt(0)
    v_mov_b32 v47, s88
    buffer_store_dwordx4 v[44:47], v92, s[16:19], s67 offen sc1
    s_nop 1
F_w1:
    s_mov_b64 exec, -1
    s_add_u32 s66, s66, 256000
    s_waitcnt lgkmcnt(3)
    v_min_u32 v5, 31, v42
    v_bfe_u32 v6, v30, 11, 6
    v_and_b32 v26, 0x1ffff, v26
    v_lshl_or_b32 v6, v5, 6, v6
    v_mov_b32 v27, s88
    v_lshl_or_b32 v26, v6, 17, v26
    v_mov_b32 v31, s88
    buffer_store_dwordx4 v[24:27], v92, s[16:19], s66 offen sc1
    v_cmp_lt_u32 vcc, 8, v42
    s_add_u32 s67, s66, 8000000
    s_mov_b64 exec, vcc
    s_cbranch_execz F_w2
    buffer_store_dwordx4 v[28:31], v92, s[16:19], s67 offen sc1
    v_cmp_lt_u32 vcc, 16, v42
    s_add_u32 s67, s67, 8000000
    s_mov_b64 exec, vcc
    s_cbranch_execz F_w2
    ds_read_b128 v[44:47], v94 offset:6400
    s_waitcnt lgkmcnt(0)
    v_mov_b32 v47, s88
    buffer_store_dwordx4 v[44:47], v92, s[16:19], s67 offen sc1
    s_nop 1
F_w2:
    s_mov_b64 exec, -1
    s_add_u32 s66, s66, 256000
    s_waitcnt lgkmcnt(0)
    v_min_u32 v5, 31, v43
    v_bfe_u32 v6, v38, 11, 6
    v_and_b32 v34, 0x1ffff, v34
    v_lshl_or_b32 v6, v5, 6, v6
    v_mov_b32 v35, s88
    v_lshl_or_b32 v34, v6, 17, v34
    v_mov_b32 v39, s88
    s_mov_b64 exec, s[22:23]
    buffer_store_dwordx4 v[32:35], v92, s[16:19], s66 offen sc1
    v_cmp_lt_u32 vcc, 8, v43
    s_add_u32 s67, s66, 8000000
    s_mov_b64 exec, vcc
    s_cbranch_execz F_w3
    buffer_store_dwordx4 v[36:39], v92, s[16:19], s67 offen sc1
    v_cmp_lt_u32 vcc, 16, v43
    s_add_u32 s67, s67, 8000000
    s_mov_b64 exec, vcc
    s_cbranch_execz F_w3
    ds_read_b128 v[44:47], v94 offset:9472
    s_waitcnt lgkmcnt(0)
    v_mov_b32 v47, s88
    buffer_store_dwordx4 v[44:47], v92, s[16:19], s67 offen sc1
    s_nop 1
F_w3:
    s_mov_b64 exec, -1
    s_cmp_eq_u32 s20, 7
    s_cbranch_scc0 F_nofrag
    s_cmp_lt_u32 s2, 160
    s_cbranch_scc0 F_nofrag
    v_or_b32 v176, v176, v180
    v_or_b32 v177, v177, v181
    v_or_b32 v178, v178, v182
    v_or_b32 v179, v179, v183
    s_lshl_b32 s66, s2, 10
    s_add_u32 s66, s66, 1024
    buffer_store_dwordx4 v[176:179], v86, s[16:19], s66 offen sc1
F_nofrag:
    s_barrier
    s_mul_i32 s24, s2, 32000
    s_lshl_b32 s25, s20, 12
    s_add_u32 s24, s24, s25
    s_add_u32 s24, s24, 164864
    s_add_u32 s25, s24, 8000000
    s_add_u32 s26, s25, 8000000
    v_mov_b32 v22, 0
    v_mov_b32 v23, s88
    s_mul_i32 s68, s20, 5120
    s_cmp_ge_u32 s20, 4
    s_cselect_b32 s70, 45056, 0
    s_add_u32 s68, s68, s70
    v_add_u32 v2, s68, v86
    ds_write_b128 v2, v[96:99] offset:0
    ds_write_b128 v2, v[100:103] offset:1024
    ds_write_b128 v2, v[104:107] offset:2048
    ds_write_b128 v2, v[108:111] offset:3072
    ds_write_b128 v2, v[112:115] offset:4096
    v_mov_b32 v4, 2130738944
    v_mov_b32 v5, 2130738944
    v_mov_b32 v6, 2130738944
    v_mov_b32 v7, 2130738944
    v_lshlrev_b32 v2, 4, v0
    v_add_u32 v3, 86016, v2
    ds_write_b128 v3, v[4:7] offset:0
    ds_write_b128 v3, v[4:7] offset:8192
    ds_write_b128 v3, v[4:7] offset:16384
    ds_write_b128 v3, v[4:7] offset:24576
    ds_write_b128 v3, v[4:7] offset:32768
    ds_write_b128 v3, v[4:7] offset:40960
    ds_write_b128 v3, v[4:7] offset:49152
    ds_write_b128 v3, v[4:7] offset:57344
    v_add_u32 v3, 0x10000, v3
    ds_write_b128 v3, v[4:7] offset:0
    v_min_u32 v2, 3056, v2
    v_add_u32 v2, 159744, v2
    ds_write_b128 v2, v[4:7]
    s_sub_u32 s72, s72, 128
    s_subb_u32 s73, s73, 0
    s_mov_b32 s4, s72
    s_and_b32 s5, s73, 0xffff
    s_mov_b32 s6, 10240000
    s_mov_b32 s7, 0x20000
    s_sub_u32 s72, s72, 1024
    s_subb_u32 s73, s73, 0
    s_mov_b32 s8, s72
    s_and_b32 s9, s73, 0xffff
    s_mov_b32 s10, 10241024
    s_mov_b32 s11, 0x20000
    s_mov_b32 s12, s76
    s_and_b32 s13, s77, 0xffff
    s_mov_b32 s14, 10240000
    s_mov_b32 s15, 0x20000
    v_lshrrev_b32 v2, 5, v1
    v_bfe_u32 v3, v1, 2, 2
    v_and_b32 v4, 3, v1
    v_bfe_u32 v5, v1, 4, 1
    v_lshlrev_b32 v6, 9, v2
    v_lshl_add_u32 v6, v3, 7, v6
    v_lshl_add_u32 v6, v5, 5, v6
    v_lshl_add_u32 v6, v4, 3, v6
    v_lshrrev_b32 v7, 1, v3
    v_lshl_add_u32 v6, v7, 6, v6
    v_add_u32 v244, s21, v6
    v_xor_b32 v245, 64, v244
    v_lshlrev_b32 v6, 7, v2
    v_lshl_add_u32 v6, v3, 5, v6
    v_lshl_add_u32 v249, v4, 3, v6
    v_lshl_add_u32 v6, v2, 2, v4
    v_bfe_u32 v7, v1, 2, 1
    v_lshl_add_u32 v6, v7, 3, v6
    v_lshlrev_b32 v6, 3, v6
    v_bfe_u32 v7, v1, 3, 1
    v_add_u32 v5, 1, v5
    v_mul_u32_u24 v7, v7, v5
    v_lshl_add_u32 v250, v7, 1, v6
    v_and_b32 v6, 0x38, v1
    v_add_u32 v247, 6, v6
    v_lshrrev_b32 v6, 2, v1
    v_lshrrev_b32 v7, 4, v1
    v_xor_b32 v6, v6, v7
    v_and_b32 v6, 1, v6
    v_lshlrev_b32 v6, 6, v6
    v_lshl_add_u32 v246, v4, 4, v6
    v_mov_b32 v242, 1.0
    v_mov_b32 v243, 1.0
    s_mov_b32 s54, 0xffffff00
    s_mov_b32 s55, 0xffffff00
    s_mov_b32 s56, 0xffff
    s_mov_b32 s57, 0xffff
    s_mov_b32 s58, 0
    s_mov_b32 s59, 134217856
    s_mov_b32 s60, 262272
    s_mov_b32 s61, 402915456
    s_mov_b32 s62, 940179840
    s_mov_b32 s63, 403046528
    s_mov_b32 s64, 402784384
    s_mov_b32 s65, 134348928
    s_mov_b32 s38, 128
    s_mov_b32 s33, -1
    s_and_b32 s68, s20, 3
    s_lshl_b32 s68, s68, 2
    s_lshr_b32 s69, s20, 2
    s_add_u32 s68, s68, s69
    s_lshl_b32 s68, s68, 4
    s_add_u32 s68, s68, 163072
    v_mov_b32 v251, s68
    s_mov_b32 s53, 0
    s_mov_b32 s50, 0
    s_mov_b32 s51, 0
    s_mov_b32 s47, 0
    s_mov_b32 s42, 0
    s_mov_b32 s3, 0
    s_mov_b32 s89, 0
    s_mov_b32 s34, 128
    s_mov_b32 s35, 384
    s_mov_b32 s36, 640
    s_mov_b32 s37, 896
    s_waitcnt lgkmcnt(0)
    s_barrier
    buffer_load_dwordx4 v[8:11], v86, s[16:19], s24 offen offset:0 sc1
    buffer_load_dwordx4 v[12:15], v86, s[16:19], s24 offen offset:1024 sc1
    buffer_load_dwordx4 v[16:19], v86, s[16:19], s24 offen offset:2048 sc1
    s_mov_b64 exec, s[22:23]
    buffer_load_dwordx4 v[20:23], v86, s[16:19], s24 offen offset:3072 sc1
    s_mov_b64 exec, -1
    ds_read_b128 v[96:99], v86 offset:0
    ds_read_b128 v[100:103], v86 offset:1024
    ds_read_b128 v[104:107], v86 offset:2048
    ds_read_b128 v[108:111], v86 offset:3072
    ds_read_b128 v[112:115], v86 offset:4096
    ds_read_b128 v[116:119], v86 offset:5120
    ds_read_b128 v[120:123], v86 offset:6144
    ds_read_b128 v[124:127], v86 offset:7168
    ds_read_b128 v[128:131], v86 offset:8192
    ds_read_b128 v[132:135], v86 offset:9216
    ds_read_b128 v[136:139], v86 offset:10240
    ds_read_b128 v[140:143], v86 offset:11264
    ds_read_b128 v[144:147], v86 offset:12288
    ds_read_b128 v[148:151], v86 offset:13312
    ds_read_b128 v[152:155], v86 offset:14336
    ds_read_b128 v[156:159], v86 offset:15360
    ds_read_b128 v[160:163], v86 offset:16384
    ds_read_b128 v[164:167], v86 offset:17408
    ds_read_b128 v[168:171], v86 offset:18432
    ds_read_b128 v[172:175], v86 offset:19456
    s_mov_b32 s27, 32768
F_poll:
    s_waitcnt vmcnt(0)
    v_cmp_ne_u32 s[72:73], s88, v11
    v_cmp_ne_u32 s[74:75], s88, v15
    v_cmp_ne_u32 s[76:77], s88, v19
    v_cmp_ne_u32 s[78:79], s88, v23
    s_or_b64 s[80:81], s[72:73], s[74:75]
    s_or_b64 s[82:83], s[76:77], s[78:79]
    s_or_b64 s[80:81], s[80:81], s[82:83]
    s_cbranch_scc0 F_got
    s_sub_u32 s27, s27, 1
    s_cbranch_scc1 F_late
    s_cmp_eq_u64 s[72:73], 0
    s_cbranch_scc1 F_p0
    buffer_load_dwordx4 v[8:11], v86, s[16:19], s24 offen offset:0 sc1
F_p0:
    s_cmp_eq_u64 s[74:75], 0
    s_cbranch_scc1 F_p1
    buffer_load_dwordx4 v[12:15], v86, s[16:19], s24 offen offset:1024 sc1
F_p1:
    s_cmp_eq_u64 s[76:77], 0
    s_cbranch_scc1 F_p2
    buffer_load_dwordx4 v[16:19], v86, s[16:19], s24 offen offset:2048 sc1
F_p2:
    s_cmp_eq_u64 s[78:79], 0
    s_cbranch_scc1 F_p3
    s_mov_b64 exec, s[22:23]
    buffer_load_dwordx4 v[20:23], v86, s[16:19], s24 offen offset:3072 sc1
    s_mov_b64 exec, -1
F_p3:
    s_branch F_poll
F_late:
    v_mov_b32 v2, 163064
    v_mov_b32 v3, 1000
    ds_write_b32 v2, v3
    v_mov_b32 v10, 0
    v_mov_b32 v14, 0
    v_mov_b32 v18, 0
    v_mov_b32 v22, 0
F_got:
    s_cmp_eq_u32 s20, 7
    s_cbranch_scc0 F_noflag
    s_cmp_lt_u32 s2, 160
    s_cbranch_scc0 F_noflag
    s_lshl_b32 s66, s2, 2
    v_mov_b32 v2, 128
    v_mov_b32 v3, s88
    s_mov_b64 exec, 1
    buffer_store_dword v3, v2, s[16:19], s66 offen sc1
    s_mov_b64 exec, -1
F_noflag:
    s_mov_b32 s27, 262144
    s_mov_b32 s71, 162816
    v_mov_b32 v3, 1
    v_bfe_u32 v2, v10, 23, 5
    v_bfe_u32 v60, v10, 11, 6
    v_sub_u32 v56, v2, v91
    v_max_u32 v89, v89, v2
    v_lshl_add_u32 v60, v60, 2, s71
    v_bfe_u32 v64, v10, 17, 6
    v_cmp_lt_u32 s[72:73], 8, v2
    v_cmp_lt_i32 vcc, 0, v56
    v_cmp_lt_i32 s[80:81], 8, v56
    s_mov_b64 exec, vcc
    ds_add_rtn_u32 v72, v60, v3
    s_mov_b64 exec, s[80:81]
    s_cbranch_execz F_h0
    v_lshl_add_u32 v64, v64, 2, s71
    ds_add_rtn_u32 v76, v64, v3
    s_mov_b64 exec, s[72:73]
    buffer_load_dwordx4 v[24:27], v86, s[16:19], s25 offen offset:0 sc1
F_h0:
    s_mov_b64 exec, -1
    v_bfe_u32 v2, v14, 23, 5
    v_bfe_u32 v61, v14, 11, 6
    v_sub_u32 v57, v2, v91
    v_max_u32 v89, v89, v2
    v_lshl_add_u32 v61, v61, 2, s71
    v_bfe_u32 v65, v14, 17, 6
    v_cmp_lt_u32 s[74:75], 8, v2
    v_cmp_lt_i32 vcc, 0, v57
    v_cmp_lt_i32 s[80:81], 8, v57
    s_mov_b64 exec, vcc
    ds_add_rtn_u32 v73, v61, v3
    s_mov_b64 exec, s[80:81]
    s_cbranch_execz F_h1
    v_lshl_add_u32 v65, v65, 2, s71
    ds_add_rtn_u32 v77, v65, v3
    s_mov_b64 exec, s[74:75]
    buffer_load_dwordx4 v[28:31], v86, s[16:19], s25 offen offset:1024 sc1
F_h1:
    s_mov_b64 exec, -1
    v_bfe_u32 v2, v18, 23, 5
    v_bfe_u32 v62, v18, 11, 6
    v_sub_u32 v58, v2, v91
    v_max_u32 v89, v89, v2
    v_lshl_add_u32 v62, v62, 2, s71
    v_bfe_u32 v66, v18, 17, 6
    v_cmp_lt_u32 s[76:77], 8, v2
    v_cmp_lt_i32 vcc, 0, v58
    v_cmp_lt_i32 s[80:81], 8, v58
    s_mov_b64 exec, vcc
    ds_add_rtn_u32 v74, v62, v3
    s_mov_b64 exec, s[80:81]
    s_cbranch_execz F_h2
    v_lshl_add_u32 v66, v66, 2, s71
    ds_add_rtn_u32 v78, v66, v3
    s_mov_b64 exec, s[76:77]
    buffer_load_dwordx4 v[32:35], v86, s[16:19], s25 offen offset:2048 sc1
F_h2:
    s_mov_b64 exec, -1
    v_bfe_u32 v2, v22, 23, 5
    v_bfe_u32 v63, v22, 11, 6
    v_sub_u32 v59, v2, v91
    v_max_u32 v89, v89, v2
    v_lshl_add_u32 v63, v63, 2, s71
    v_bfe_u32 v67, v22, 17, 6
    v_cmp_lt_u32 s[78:79], 8, v2
    v_cmp_lt_i32 vcc, 0, v59
    v_cmp_lt_i32 s[80:81], 8, v59
    s_mov_b64 exec, vcc
    ds_add_rtn_u32 v75, v63, v3
    s_mov_b64 exec, s[80:81]
    s_cbranch_execz F_h3
    v_lshl_add_u32 v67, v67, 2, s71
    ds_add_rtn_u32 v79, v67, v3
    s_mov_b64 exec, s[78:79]
    buffer_load_dwordx4 v[36:39], v86, s[16:19], s25 offen offset:3072 sc1
F_h3:
    s_mov_b64 exec, -1
    v_cmp_lt_u32 vcc, 16, v89
    s_cmp_eq_u64 vcc, 0
    s_cbranch_scc1 F_no3
    v_add_u32 v2, v56, v91
    v_cmp_lt_u32 vcc, 16, v2
    s_mov_b64 exec, vcc
    s_cbranch_execz F_t0
F_tp0:
    buffer_load_dwordx4 v[40:43], v86, s[16:19], s26 offen offset:0 sc1
    s_waitcnt vmcnt(0)
    v_cmp_ne_u32 vcc, s88, v43
    s_sub_u32 s27, s27, 1
    s_cselect_b64 vcc, 0, vcc
    s_cmp_eq_u64 vcc, 0
    s_cbranch_scc0 F_tp0
    v_bfe_u32 v68, v42, 11, 6
    v_lshl_add_u32 v68, v68, 2, s71
    v_cmp_lt_i32 vcc, 16, v56
    s_mov_b64 exec, vcc
    ds_add_rtn_u32 v80, v68, v3
F_t0:
    s_mov_b64 exec, -1
    v_add_u32 v2, v57, v91
    v_cmp_lt_u32 vcc, 16, v2
    s_mov_b64 exec, vcc
    s_cbranch_execz F_t1
F_tp1:
    buffer_load_dwordx4 v[44:47], v86, s[16:19], s26 offen offset:1024 sc1
    s_waitcnt vmcnt(0)
    v_cmp_ne_u32 vcc, s88, v47
    s_sub_u32 s27, s27, 1
    s_cselect_b64 vcc, 0, vcc
    s_cmp_eq_u64 vcc, 0
    s_cbranch_scc0 F_tp1
    v_bfe_u32 v69, v46, 11, 6
    v_lshl_add_u32 v69, v69, 2, s71
    v_cmp_lt_i32 vcc, 16, v57
    s_mov_b64 exec, vcc
    ds_add_rtn_u32 v81, v69, v3
F_t1:
    s_mov_b64 exec, -1
    v_add_u32 v2, v58, v91
    v_cmp_lt_u32 vcc, 16, v2
    s_mov_b64 exec, vcc
    s_cbranch_execz F_t2
F_tp2:
    buffer_load_dwordx4 v[48:51], v86, s[16:19], s26 offen offset:2048 sc1
    s_waitcnt vmcnt(0)
    v_cmp_ne_u32 vcc, s88, v51
    s_sub_u32 s27, s27, 1
    s_cselect_b64 vcc, 0, vcc
    s_cmp_eq_u64 vcc, 0
    s_cbranch_scc0 F_tp2
    v_bfe_u32 v70, v50, 11, 6
    v_lshl_add_u32 v70, v70, 2, s71
    v_cmp_lt_i32 vcc, 16, v58
    s_mov_b64 exec, vcc
    ds_add_rtn_u32 v82, v70, v3
F_t2:
    s_mov_b64 exec, -1
    v_add_u32 v2, v59, v91
    v_cmp_lt_u32 vcc, 16, v2
    s_mov_b64 exec, vcc
    s_cbranch_execz F_t3
F_tp3:
    buffer_load_dwordx4 v[52:55], v86, s[16:19], s26 offen offset:3072 sc1
    s_waitcnt vmcnt(0)
    v_cmp_ne_u32 vcc, s88, v55
    s_sub_u32 s27, s27, 1
    s_cselect_b64 vcc, 0, vcc
    s_cmp_eq_u64 vcc, 0
    s_cbranch_scc0 F_tp3
    v_bfe_u32 v71, v54, 11, 6
    v_lshl_add_u32 v71, v71, 2, s71
    v_cmp_lt_i32 vcc, 16, v59
    s_mov_b64 exec, vcc
    ds_add_rtn_u32 v83, v71, v3
F_t3:
    s_mov_b64 exec, -1
    v_mov_b32 v2, 163068
    v_mov_b32 v4, 1000
    v_cmp_lt_u32 vcc, 24, v89
    s_mov_b64 exec, vcc
    ds_write_b32 v2, v4
    s_mov_b64 exec, -1
F_no3:
    s_waitcnt lgkmcnt(0)
    s_barrier
    ds_read_b32 v4, v88
    s_lshr_b32 s66, s2, 3
    s_mul_i32 s66, s66, 8
    s_add_u32 s66, s66, s20
    s_mul_i32 s66, s66, 40
    s_add_u32 s66, s66, 0
    v_min_u32 v93, 39, v1
    v_add_u32 v93, s66, v93
    v_lshlrev_b32 v93, 10, v93
    buffer_load_dword v95, v93, s[4:7], 0 offen offset:128
    v_cmp_gt_u32 s[68:69], 40, v1
    s_waitcnt lgkmcnt(0)
    v_cmp_lt_u32 vcc, 64, v4
    v_add_u32 v5, 15, v4
    v_lshrrev_b32 v5, 4, v5
    v_med3_u32 v5, v5, 1, 4
    v_mul_u32_u24 v6, 640, v5
    v_max_u32 v6, 1536, v6
    v_cndmask_b32 v6, 0, v6, s[68:69]
    s_cmp_lg_u64 vcc, 0
    s_cbranch_scc1 SLOW
    v_mov_b32 v7, v6
    v_add_u32 v2, 7, v4
    v_lshrrev_b32 v2, 3, v2
    v_add_u32_dpp v7, v7, v7 row_shr:1 row_mask:0xf bank_mask:0xf
    v_max_u32 v2, 2, v2
    v_cmp_eq_u32 vcc, 7, v2
    v_add_u32_dpp v7, v7, v7 row_shr:2 row_mask:0xf bank_mask:0xf
    v_lshlrev_b32 v5, 18, v5
    v_lshl_or_b32 v5, v1, 21, v5
    v_add_u32_dpp v7, v7, v7 row_shr:4 row_mask:0xf bank_mask:0xf
    v_addc_co_u32 v2, vcc, 0, v2, vcc
    v_lshl_or_b32 v5, v2, 28, v5
    v_add_u32_dpp v7, v7, v7 row_shr:8 row_mask:0xf bank_mask:0xf
    v_med3_u32 v2, v2, 3, 6
    v_cndmask_b32 v2, 0, v2, s[68:69]
    v_add_u32_dpp v7, v7, v7 row_bcast:15 row_mask:0xa bank_mask:0xf
    v_mov_b32 v84, 63
    s_mov_b32 s70, 0
    v_add_u32_dpp v7, v7, v7 row_bcast:31 row_mask:0xc bank_mask:0xf
    v_cmp_eq_u32 vcc, 6, v2
    v_readlane_b32 s66, v7, 63
    v_sub_u32 v7, v7, v6
    v_add_u32 v7, 86016, v7
    v_or_b32 v6, v5, v7
    s_cmp_gt_u32 s66, 76800
    s_cbranch_scc1 SLOW
    ds_bpermute_b32 v60, v60, v6
    ds_bpermute_b32 v61, v61, v6
    ds_bpermute_b32 v62, v62, v6
    ds_bpermute_b32 v63, v63, v6
    ds_bpermute_b32 v64, v64, v6
    ds_bpermute_b32 v65, v65, v6
    ds_bpermute_b32 v66, v66, v6
    ds_bpermute_b32 v67, v67, v6
    v_mbcnt_lo_u32_b32 v5, vcc_lo, 0
    v_mbcnt_hi_u32_b32 v5, vcc_hi, v5
    v_add_u32 v5, s70, v5
    v_cndmask_b32 v84, v84, v5, vcc
    s_bcnt1_i32_b64 s71, vcc
    v_cmp_eq_u32 vcc, 5, v2
    s_add_u32 s70, s70, s71
    s_nop 0
    v_mbcnt_lo_u32_b32 v5, vcc_lo, 0
    v_mbcnt_hi_u32_b32 v5, vcc_hi, v5
    v_add_u32 v5, s70, v5
    v_cndmask_b32 v84, v84, v5, vcc
    s_bcnt1_i32_b64 s71, vcc
    v_cmp_eq_u32 vcc, 4, v2
    s_add_u32 s70, s70, s71
    s_nop 0
    v_mbcnt_lo_u32_b32 v5, vcc_lo, 0
    v_mbcnt_hi_u32_b32 v5, vcc_hi, v5
    v_add_u32 v5, s70, v5
    v_cndmask_b32 v84, v84, v5, vcc
    s_bcnt1_i32_b64 s71, vcc
    v_cmp_eq_u32 vcc, 3, v2
    s_add_u32 s70, s70, s71
    s_nop 0
    v_mbcnt_lo_u32_b32 v5, vcc_lo, 0
    v_mbcnt_hi_u32_b32 v5, vcc_hi, v5
    v_add_u32 v5, s70, v5
    v_cndmask_b32 v84, v84, v5, vcc
    v_lshrrev_b32 v2, 3, v84
    v_and_b32 v3, 1, v2
    v_mul_u32_u24 v3, 7, v3
    v_xor_b32 v84, v84, v3
    s_add_u32 s66, s20, 0
    v_cmp_eq_u32 vcc, s66, v84
    s_ff1_i32_b64 s67, vcc
    v_readlane_b32 s80, v6, s67
    s_waitcnt lgkmcnt(0)
    v_cmpx_lt_i32 vcc, 0, v56
    v_and_b32 v2, 0x3ffff, v60
    v_bfe_u32 v3, v60, 18, 3
    v_and_b32 v4, 0x7ff, v10
    v_lshl_add_u32 v3, v3, 9, v2
    v_lshl_add_u32 v4, v4, 5, v90
    v_lshl_add_u32 v2, v72, 5, v2
    v_lshl_add_u32 v3, v72, 3, v3
    v_or_b32 v5, 16, v4
    ds_write2_b32 v2, v4, v5 offset0:0 offset1:4
    ds_write_b64 v3, v[8:9]
    s_mov_b64 exec, -1
    v_cmpx_lt_i32 vcc, 0, v57
    v_and_b32 v2, 0x3ffff, v61
    v_bfe_u32 v3, v61, 18, 3
    v_and_b32 v4, 0x7ff, v14
    v_lshl_add_u32 v3, v3, 9, v2
    v_lshl_add_u32 v4, v4, 5, v90
    v_lshl_add_u32 v2, v73, 5, v2
    v_add_u32 v4, 327680, v4
    v_lshl_add_u32 v3, v73, 3, v3
    v_or_b32 v5, 16, v4
    ds_write2_b32 v2, v4, v5 offset0:0 offset1:4
    ds_write_b64 v3, v[12:13]
    s_mov_b64 exec, -1
    v_cmpx_lt_i32 vcc, 0, v58
    v_and_b32 v2, 0x3ffff, v62
    v_bfe_u32 v3, v62, 18, 3
    v_and_b32 v4, 0x7ff, v18
    v_lshl_add_u32 v3, v3, 9, v2
    v_lshl_add_u32 v4, v4, 5, v90
    v_lshl_add_u32 v2, v74, 5, v2
    v_add_u32 v4, 655360, v4
    v_lshl_add_u32 v3, v74, 3, v3
    v_or_b32 v5, 16, v4
    ds_write2_b32 v2, v4, v5 offset0:0 offset1:4
    ds_write_b64 v3, v[16:17]
    s_mov_b64 exec, -1
    v_cmpx_lt_i32 vcc, 0, v59
    v_and_b32 v2, 0x3ffff, v63
    v_bfe_u32 v3, v63, 18, 3
    v_and_b32 v4, 0x7ff, v22
    v_lshl_add_u32 v3, v3, 9, v2
    v_lshl_add_u32 v4, v4, 5, v90
    v_lshl_add_u32 v2, v75, 5, v2
    v_add_u32 v4, 983040, v4
    v_lshl_add_u32 v3, v75, 3, v3
    v_or_b32 v5, 16, v4
    ds_write2_b32 v2, v4, v5 offset0:0 offset1:4
    ds_write_b64 v3, v[20:21]
    s_mov_b64 exec, -1
    s_mov_b64 exec, s[72:73]
    s_cbranch_execz F_s0
    s_waitcnt vmcnt(1)
F_sp0:
    v_cmp_ne_u32 vcc, s88, v27
    s_cmp_eq_u64 vcc, 0
    s_cbranch_scc1 F_sg0
    s_sub_u32 s27, s27, 1
    s_cbranch_scc1 F_sg0
    buffer_load_dwordx4 v[24:27], v86, s[16:19], s25 offen offset:0 sc1
    s_waitcnt vmcnt(0)
    s_branch F_sp0
F_sg0:
    v_cmpx_lt_i32 vcc, 8, v56
    v_and_b32 v2, 0x3ffff, v64
    v_bfe_u32 v3, v64, 18, 3
    v_and_b32 v4, 0x7ff, v26
    v_lshl_add_u32 v3, v3, 9, v2
    v_lshl_add_u32 v4, v4, 5, v90
    v_lshl_add_u32 v2, v76, 5, v2
    v_lshl_add_u32 v3, v76, 3, v3
    v_or_b32 v5, 16, v4
    ds_write2_b32 v2, v4, v5 offset0:0 offset1:4
    ds_write_b64 v3, v[24:25]
F_s0:
    s_mov_b64 exec, s[74:75]
    s_cbranch_execz F_s1
    s_waitcnt vmcnt(1)
F_sp1:
    v_cmp_ne_u32 vcc, s88, v31
    s_cmp_eq_u64 vcc, 0
    s_cbranch_scc1 F_sg1
    s_sub_u32 s27, s27, 1
    s_cbranch_scc1 F_sg1
    buffer_load_dwordx4 v[28:31], v86, s[16:19], s25 offen offset:1024 sc1
    s_waitcnt vmcnt(0)
    s_branch F_sp1
F_sg1:
    v_cmpx_lt_i32 vcc, 8, v57
    v_and_b32 v2, 0x3ffff, v65
    v_bfe_u32 v3, v65, 18, 3
    v_and_b32 v4, 0x7ff, v30
    v_lshl_add_u32 v3, v3, 9, v2
    v_lshl_add_u32 v4, v4, 5, v90
    v_lshl_add_u32 v2, v77, 5, v2
    v_add_u32 v4, 327680, v4
    v_lshl_add_u32 v3, v77, 3, v3
    v_or_b32 v5, 16, v4
    ds_write2_b32 v2, v4, v5 offset0:0 offset1:4
    ds_write_b64 v3, v[28:29]
F_s1:
    s_mov_b64 exec, s[76:77]
    s_cbranch_execz F_s2
    s_waitcnt vmcnt(1)
F_sp2:
    v_cmp_ne_u32 vcc, s88, v35
    s_cmp_eq_u64 vcc, 0
    s_cbranch_scc1 F_sg2
    s_sub_u32 s27, s27, 1
    s_cbranch_scc1 F_sg2
    buffer_load_dwordx4 v[32:35], v86, s[16:19], s25 offen offset:2048 sc1
    s_waitcnt vmcnt(0)
    s_branch F_sp2
F_sg2:
    v_cmpx_lt_i32 vcc, 8, v58
    v_and_b32 v2, 0x3ffff, v66
    v_bfe_u32 v3, v66, 18, 3
    v_and_b32 v4, 0x7ff, v34
    v_lshl_add_u32 v3, v3, 9, v2
    v_lshl_add_u32 v4, v4, 5, v90
    v_lshl_add_u32 v2, v78, 5, v2
    v_add_u32 v4, 655360, v4
    v_lshl_add_u32 v3, v78, 3, v3
    v_or_b32 v5, 16, v4
    ds_write2_b32 v2, v4, v5 offset0:0 offset1:4
    ds_write_b64 v3, v[32:33]
F_s2:
    s_mov_b64 exec, s[78:79]
    s_cbranch_execz F_s3
    s_waitcnt vmcnt(1)
F_sp3:
    v_cmp_ne_u32 vcc, s88, v39
    s_cmp_eq_u64 vcc, 0
    s_cbranch_scc1 F_sg3
    s_sub_u32 s27, s27, 1
    s_cbranch_scc1 F_sg3
    buffer_load_dwordx4 v[36:39], v86, s[16:19], s25 offen offset:3072 sc1
    s_waitcnt vmcnt(0)
    s_branch F_sp3
F_sg3:
    v_cmpx_lt_i32 vcc, 8, v59
    v_and_b32 v2, 0x3ffff, v67
    v_bfe_u32 v3, v67, 18, 3
    v_and_b32 v4, 0x7ff, v38
    v_lshl_add_u32 v3, v3, 9, v2
    v_lshl_add_u32 v4, v4, 5, v90
    v_lshl_add_u32 v2, v79, 5, v2
    v_add_u32 v4, 983040, v4
    v_lshl_add_u32 v3, v79, 3, v3
    v_or_b32 v5, 16, v4
    ds_write2_b32 v2, v4, v5 offset0:0 offset1:4
    ds_write_b64 v3, v[36:37]
F_s3:
    s_mov_b64 exec, -1
    v_cmp_lt_u32 vcc, 16, v89
    s_cmp_eq_u64 vcc, 0
    s_cbranch_scc1 F_no3b
    ds_bpermute_b32 v68, v68, v6
    ds_bpermute_b32 v69, v69, v6
    ds_bpermute_b32 v70, v70, v6
    ds_bpermute_b32 v71, v71, v6
    s_waitcnt lgkmcnt(0)
    v_cmp_lt_i32 vcc, 16, v56
    s_mov_b64 exec, vcc
    s_cbranch_execz F_u0
    v_and_b32 v2, 0x3ffff, v68
    v_bfe_u32 v3, v68, 18, 3
    v_and_b32 v4, 0x7ff, v42
    v_lshl_add_u32 v3, v3, 9, v2
    v_lshl_add_u32 v4, v4, 5, v90
    v_lshl_add_u32 v2, v80, 5, v2
    v_lshl_add_u32 v3, v80, 3, v3
    v_or_b32 v5, 16, v4
    ds_write2_b32 v2, v4, v5 offset0:0 offset1:4
    ds_write_b64 v3, v[40:41]
F_u0:
    s_mov_b64 exec, -1
    v_cmp_lt_i32 vcc, 16, v57
    s_mov_b64 exec, vcc
    s_cbranch_execz F_u1
    v_and_b32 v2, 0x3ffff, v69
    v_bfe_u32 v3, v69, 18, 3
    v_and_b32 v4, 0x7ff, v46
    v_lshl_add_u32 v3, v3, 9, v2
    v_lshl_add_u32 v4, v4, 5, v90
    v_lshl_add_u32 v2, v81, 5, v2
    v_add_u32 v4, 327680, v4
    v_lshl_add_u32 v3, v81, 3, v3
    v_or_b32 v5, 16, v4
    ds_write2_b32 v2, v4, v5 offset0:0 offset1:4
    ds_write_b64 v3, v[44:45]
F_u1:
    s_mov_b64 exec, -1
    v_cmp_lt_i32 vcc, 16, v58
    s_mov_b64 exec, vcc
    s_cbranch_execz F_u2
    v_and_b32 v2, 0x3ffff, v70
    v_bfe_u32 v3, v70, 18, 3
    v_and_b32 v4, 0x7ff, v50
    v_lshl_add_u32 v3, v3, 9, v2
    v_lshl_add_u32 v4, v4, 5, v90
    v_lshl_add_u32 v2, v82, 5, v2
    v_add_u32 v4, 655360, v4
    v_lshl_add_u32 v3, v82, 3, v3
    v_or_b32 v5, 16, v4
    ds_write2_b32 v2, v4, v5 offset0:0 offset1:4
    ds_write_b64 v3, v[48:49]
F_u2:
    s_mov_b64 exec, -1
    v_cmp_lt_i32 vcc, 16, v59
    s_mov_b64 exec, vcc
    s_cbranch_execz F_u3
    v_and_b32 v2, 0x3ffff, v71
    v_bfe_u32 v3, v71, 18, 3
    v_and_b32 v4, 0x7ff, v54
    v_lshl_add_u32 v3, v3, 9, v2
    v_lshl_add_u32 v4, v4, 5, v90
    v_lshl_add_u32 v2, v83, 5, v2
    v_add_u32 v4, 983040, v4
    v_lshl_add_u32 v3, v83, 3, v3
    v_or_b32 v5, 16, v4
    ds_write2_b32 v2, v4, v5 offset0:0 offset1:4
    ds_write_b64 v3, v[52:53]
F_u3:
    s_mov_b64 exec, -1
F_no3b:
    s_mov_b32 s22, s80
    s_mov_b32 s27, s80
    s_mov_b32 s71, s80
    s_bfe_u32 s46, s71, 0x30012
    s_mov_b32 m0, s46
    s_and_b32 s66, s71, 0x3ffff
    s_movrels_b32 s68, s57
    s_movrels_b32 s69, s61
    s_sub_u32 s48, s66, s47
    s_mov_b32 s47, s66
    s_lshr_b32 s52, s71, 28
    s_lshl_b32 s67, s46, 9
    s_add_u32 s66, s66, s67
    s_sub_u32 s49, s66, s42
    s_mov_b32 s42, s66
    s_bfe_u32 s66, s68, 655360
    s_add_u32 s43, s42, s66
    s_bfe_u32 s39, s69, 655360
    s_bfe_u32 s66, s68, 655370
    s_add_u32 s44, s42, s66
    s_bfe_u32 s40, s69, 655370
    s_bfe_u32 s66, s68, 655380
    s_add_u32 s45, s42, s66
    s_bfe_u32 s41, s69, 655380
    s_and_b32 s66, s46, s33
    s_cselect_b32 s72, -1, 1
    s_cselect_b32 s76, s47, 163712
    s_cmp_ge_u32 s66, 2
    s_cselect_b32 s73, -1, 0
    s_add_u32 s77, s47, 1024
    s_cmp_ge_u32 s66, 4
    s_cselect_b32 s75, -1, 0
    s_cmp_ge_u32 s66, 3
    s_cselect_b32 s74, -1, 1
    s_cselect_b32 s77, s77, 163712
    s_mul_i32 s66, s20, 80
    v_min_u32 v2, 76, v248
    s_waitcnt lgkmcnt(0)
    s_barrier
    v_lshl_add_u32 v253, v248, 2, s47
    ds_read_b32 v254, v253
    ds_read_b32 v255, v253 offset:1024
    v_add_u32 v252, s42, v247
    ds_read_u16 v234, v252
    ds_read_u16 v235, v252 offset:64
    v_add_u32 v252, s43, v247
    ds_read_u16 v236, v252
    ds_read_u16 v237, v252 offset:64
    v_add_u32 v252, s44, v247
    ds_read_u16 v238, v252
    ds_read_u16 v239, v252 offset:64
    v_add_u32 v252, s45, v247
    ds_read_u16 v240, v252
    ds_read_u16 v241, v252 offset:64
    buffer_load_dword v3, v2, s[16:19], s66 offen offset:128 sc1
    v_add_u32 v249, s48, v249
    v_add_u32 v250, s49, v250
    s_waitcnt lgkmcnt(8)
    s_mov_b32 m0, s76
    s_mov_b64 exec, s[72:73]
    buffer_load_dwordx4 v254, s[12:15], 0 offen  lds
    s_mov_b32 m0, s77
    s_mov_b64 exec, s[74:75]
    buffer_load_dwordx4 v255, s[12:15], 0 offen  lds
    s_mov_b64 exec, -1
    s_waitcnt lgkmcnt(0)
    s_add_u32 m0, s21, 0
    v_lshl_add_u32 v234, v234, 10, v246
    v_lshl_add_u32 v235, v235, 10, v246
    buffer_load_dwordx4 v234, s[4:7], s38 offen lds
    buffer_load_dwordx4 v235, s[8:11], s38 offen offset:1024 lds
    s_add_u32 m0, s21, 2048
    v_lshl_add_u32 v236, v236, 10, v246
    v_lshl_add_u32 v237, v237, 10, v246
    buffer_load_dwordx4 v236, s[4:7], s39 offen lds
    buffer_load_dwordx4 v237, s[8:11], s39 offen offset:1024 lds
    s_add_u32 m0, s21, 4096
    v_lshl_add_u32 v238, v238, 10, v246
    v_lshl_add_u32 v239, v239, 10, v246
    buffer_load_dwordx4 v238, s[4:7], s40 offen lds
    buffer_load_dwordx4 v239, s[8:11], s40 offen offset:1024 lds
    s_add_u32 m0, s21, 6144
    v_lshl_add_u32 v240, v240, 10, v246
    v_lshl_add_u32 v241, v241, 10, v246
    buffer_load_dwordx4 v240, s[4:7], s41 offen lds
    buffer_load_dwordx4 v241, s[8:11], s41 offen offset:1024 lds
    v_lshrrev_b32 v8, 3, v84
    v_and_b32 v9, 7, v84
    v_lshlrev_b32 v9, 13, v9
    v_mul_u32_u24 v8, 1536, v8
    v_and_b32 v5, 128, v86
    v_add3_u32 v8, v8, v9, v5
    v_xor_b32 v9, v86, v7
    v_and_b32 v9, 128, v9
    v_add_u32 v9, v9, v7
    v_and_b32 v4, 0x70, v86
    v_or_b32 v5, v9, v4
    s_add_u32 s66, s20, 0
    v_cmp_eq_u32 vcc, s66, v84
    s_ff1_i32_b64 s67, vcc
    v_readlane_b32 s28, v5, s67
    s_add_u32 s66, s20, 8
    v_cmp_eq_u32 vcc, s66, v84
    s_ff1_i32_b64 s67, vcc
    v_readlane_b32 s29, v5, s67
    v_readlane_b32 s23, v6, s67
    s_add_u32 s66, s20, 16
    v_cmp_eq_u32 vcc, s66, v84
    s_ff1_i32_b64 s67, vcc
    v_readlane_b32 s30, v5, s67
    v_readlane_b32 s24, v6, s67
    s_add_u32 s66, s20, 24
    v_cmp_eq_u32 vcc, s66, v84
    s_ff1_i32_b64 s67, vcc
    v_readlane_b32 s31, v5, s67
    v_readlane_b32 s25, v6, s67
    s_add_u32 s66, s20, 32
    v_cmp_eq_u32 vcc, s66, v84
    s_ff1_i32_b64 s67, vcc
    v_readlane_b32 s32, v5, s67
    v_readlane_b32 s26, v6, s67
    v_lshlrev_b32 v4, 3, v1
    v_add_u32 v4, 163328, v4
    s_mov_b32 exec_hi, 0xff
    ds_write_b64 v4, v[8:9]
    s_mov_b32 exec_hi, -1
    s_waitcnt lgkmcnt(0)
    v_mov_b32 v252, 0
    s_waitcnt vmcnt(6)
    v_cmp_ne_u32 vcc, s88, v3
    ds_read_b64_tr_b16 v[176:177], v244 offset:0
    ds_read_b64_tr_b16 v[178:179], v244 offset:1024
    ds_read_b64_tr_b16 v[180:181], v245 offset:0
    ds_read_b64_tr_b16 v[182:183], v245 offset:1024
    ds_read_b64_tr_b16 v[68:69], v249 offset:0
    ds_read_b64_tr_b16 v[70:71], v249 offset:256
    s_mov_b64 exec, s[54:55]
    ds_read_u16_d16_hi v242, v250 offset:0
    s_mov_b64 exec, -1
    s_or_b32 s89, vcc_lo, vcc_hi
    s_waitcnt lgkmcnt(3)
    v_readfirstlane_b32 s66, v252
    s_add_u32 s53, s53, 1
    v_mov_b32 v252, s53
    s_cmp_le_u32 s53, s66
    ds_write2_b32 v251, v252, v252 offset0:0 offset1:8
    s_setprio 1
    s_cbranch_scc1 PRIO_1
    s_setprio 0
PRIO_1:
    s_cmp_eq_u32 s52, 4
    s_cbranch_scc1 ITEM_0_4
    s_cmp_eq_u32 s52, 5
    s_cbranch_scc1 ITEM_0_5
    s_cmp_eq_u32 s52, 3
    s_cbranch_scc1 ITEM_0_3
    s_cmp_eq_u32 s52, 6
    s_cbranch_scc1 ITEM_0_6
    s_cmp_eq_u32 s52, 8
    s_cbranch_scc1 ITEM_0_8
    s_branch ITEM_0_2
LAST0:
    s_cmp_eq_u32 s50, 5
    s_cbranch_scc1 TO_PHASE1
    s_add_u32 s4, s4, 128
    s_addc_u32 s5, s5, 0
    s_add_u32 s8, s8, 128
    s_addc_u32 s9, s9, 0
    s_mov_b32 s34, 0
    s_mov_b32 s35, 256
    s_mov_b32 s36, 512
    s_mov_b32 s37, 768
    s_mov_b32 s33, 0
    s_waitcnt lgkmcnt(3)
    v_readfirstlane_b32 s66, v252
    s_add_u32 s53, s53, 1
    v_mov_b32 v252, s53
    s_cmp_le_u32 s53, s66
    ds_write2_b32 v251, v252, v252 offset0:0 offset1:8
    s_setprio 1
    s_cbranch_scc1 PRIO_2
    s_setprio 0
PRIO_2:
    s_cmp_eq_u32 s52, 4
    s_cbranch_scc1 ITEM_0_4
    s_cmp_eq_u32 s52, 5
    s_cbranch_scc1 ITEM_0_5
    s_cmp_eq_u32 s52, 3
    s_cbranch_scc1 ITEM_0_3
    s_cmp_eq_u32 s52, 6
    s_cbranch_scc1 ITEM_0_6
    s_cmp_eq_u32 s52, 8
    s_cbranch_scc1 ITEM_0_8
    s_branch ITEM_0_2
TO_PHASE1:
    v_lshlrev_b32 v253, 2, v248
    v_add_u32 v253, 65536, v253
    ds_read_b128 v[96:99], v253 offset:0
    ds_read_b128 v[100:103], v253 offset:1024
    ds_read_b128 v[104:107], v253 offset:2048
    ds_read_b128 v[108:111], v253 offset:3072
    ds_read_b128 v[112:115], v253 offset:4096
    ds_read_b128 v[116:119], v253 offset:5120
    ds_read_b128 v[120:123], v253 offset:6144
    ds_read_b128 v[124:127], v253 offset:7168
    ds_read_b128 v[128:131], v253 offset:8192
    ds_read_b128 v[132:135], v253 offset:9216
    ds_read_b128 v[136:139], v253 offset:10240
    ds_read_b128 v[140:143], v253 offset:11264
    ds_read_b128 v[144:147], v253 offset:12288
    ds_read_b128 v[148:151], v253 offset:13312
    ds_read_b128 v[152:155], v253 offset:14336
    ds_read_b128 v[156:159], v253 offset:15360
    ds_read_b128 v[160:163], v253 offset:16384
    ds_read_b128 v[164:167], v253 offset:17408
    ds_read_b128 v[168:171], v253 offset:18432
    ds_read_b128 v[172:175], v253 offset:19456
    s_mov_b32 s34, 128
    s_mov_b32 s35, 384
    s_mov_b32 s36, 640
    s_mov_b32 s37, 896
    s_mov_b32 s50, 0
    s_waitcnt lgkmcnt(0)
    s_waitcnt lgkmcnt(0)
    v_readfirstlane_b32 s66, v252
    s_add_u32 s53, s53, 1
    v_mov_b32 v252, s53
    s_cmp_le_u32 s53, s66
    ds_write2_b32 v251, v252, v252 offset0:0 offset1:8
    s_setprio 1
    s_cbranch_scc1 PRIO_3
    s_setprio 0
PRIO_3:
    s_cmp_eq_u32 s52, 4
    s_cbranch_scc1 ITEM_1_4
    s_cmp_eq_u32 s52, 5
    s_cbranch_scc1 ITEM_1_5
    s_cmp_eq_u32 s52, 3
    s_cbranch_scc1 ITEM_1_3
    s_cmp_eq_u32 s52, 6
    s_cbranch_scc1 ITEM_1_6
    s_cmp_eq_u32 s52, 8
    s_cbranch_scc1 ITEM_1_8
    s_branch ITEM_1_2
.p2align 6
ITEM_0_4:
    s_mov_b64 exec, s[54:55]
    ds_read_u16_d16_hi v243, v250 offset:128
    s_mov_b64 exec, -1
    ds_read_b64_tr_b16 v[76:77], v249 offset:512
    ds_read_b64_tr_b16 v[78:79], v249 offset:768
    s_waitcnt lgkmcnt(3)
    v_lshlrev_b32 v196, 16, v68
    v_and_b32 v197, 0xffff0000, v68
    v_lshlrev_b32 v198, 16, v69
    v_and_b32 v199, 0xffff0000, v69
    v_mul_f32_dpp v200, v242, v196 row_newbcast:0 row_mask:0xf bank_mask:0xf
    v_mul_f32_dpp v201, v242, v197 row_newbcast:1 row_mask:0xf bank_mask:0xf
    v_mul_f32_dpp v202, v242, v196 row_newbcast:8 row_mask:0xf bank_mask:0xf
    v_mul_f32_dpp v203, v242, v197 row_newbcast:9 row_mask:0xf bank_mask:0xf
    v_lshlrev_b32 v196, 16, v70
    v_and_b32 v197, 0xffff0000, v70
    v_cvt_pk_bf16_f32 v64, v200, v201
    v_cvt_pk_bf16_f32 v68, v202, v203
    v_mul_f32_dpp v200, v242, v198 row_newbcast:2 row_mask:0xf bank_mask:0xf
    v_mul_f32_dpp v201, v242, v199 row_newbcast:3 row_mask:0xf bank_mask:0xf
    v_mul_f32_dpp v202, v242, v198 row_newbcast:10 row_mask:0xf bank_mask:0xf
    v_mul_f32_dpp v203, v242, v199 row_newbcast:11 row_mask:0xf bank_mask:0xf
    v_lshlrev_b32 v198, 16, v71
    v_and_b32 v199, 0xffff0000, v71
    v_cvt_pk_bf16_f32 v65, v200, v201
    v_cvt_pk_bf16_f32 v69, v202, v203
    v_mul_f32_dpp v200, v242, v196 row_newbcast:4 row_mask:0xf bank_mask:0xf
    v_mul_f32_dpp v201, v242, v197 row_newbcast:5 row_mask:0xf bank_mask:0xf
    v_mul_f32_dpp v202, v242, v196 row_newbcast:12 row_mask:0xf bank_mask:0xf
    v_mul_f32_dpp v203, v242, v197 row_newbcast:13 row_mask:0xf bank_mask:0xf
    v_cvt_pk_bf16_f32 v66, v200, v201
    v_cvt_pk_bf16_f32 v70, v202, v203
    v_mul_f32_dpp v200, v242, v198 row_newbcast:6 row_mask:0xf bank_mask:0xf
    v_mul_f32_dpp v201, v242, v199 row_newbcast:7 row_mask:0xf bank_mask:0xf
    v_mul_f32_dpp v202, v242, v198 row_newbcast:14 row_mask:0xf bank_mask:0xf
    v_mul_f32_dpp v203, v242, v199 row_newbcast:15 row_mask:0xf bank_mask:0xf
    v_cvt_pk_bf16_f32 v67, v200, v201
    v_cvt_pk_bf16_f32 v71, v202, v203
    s_nop 0
    s_waitcnt vmcnt(4) lgkmcnt(0)
    v_mfma_f32_32x32x16_bf16 v[0:15], v[64:67], v[176:179], 0
    v_lshlrev_b32 v196, 16, v76
    v_and_b32 v197, 0xffff0000, v76
    v_lshlrev_b32 v198, 16, v77
    v_and_b32 v199, 0xffff0000, v77
    v_mul_f32_dpp v200, v243, v196 row_newbcast:0 row_mask:0xf bank_mask:0xf
    v_mul_f32_dpp v201, v243, v197 row_newbcast:1 row_mask:0xf bank_mask:0xf
    v_mul_f32_dpp v202, v243, v196 row_newbcast:8 row_mask:0xf bank_mask:0xf
    v_mul_f32_dpp v203, v243, v197 row_newbcast:9 row_mask:0xf bank_mask:0xf
    v_lshlrev_b32 v196, 16, v78
    v_and_b32 v197, 0xffff0000, v78
    v_cvt_pk_bf16_f32 v72, v200, v201
    v_cvt_pk_bf16_f32 v76, v202, v203
    v_mul_f32_dpp v200, v243, v198 row_newbcast:2 row_mask:0xf bank_mask:0xf
    v_mul_f32_dpp v201, v243, v199 row_newbcast:3 row_mask:0xf bank_mask:0xf
    v_mul_f32_dpp v202, v243, v198 row_newbcast:10 row_mask:0xf bank_mask:0xf
    v_mul_f32_dpp v203, v243, v199 row_newbcast:11 row_mask:0xf bank_mask:0xf
    s_add_u32 m0, s21, 0
    v_mfma_f32_32x32x16_bf16 v[16:31], v[68:71], v[176:179], 0
    buffer_load_dwordx4 v234, s[4:7], s36 offen lds
    buffer_load_dwordx4 v235, s[8:11], s36 offen offset:1024 lds
    ds_read_b64_tr_b16 v[176:177], v244 offset:2048
    ds_read_b64_tr_b16 v[178:179], v244 offset:3072
    ds_read_b64_tr_b16 v[184:185], v245 offset:2048
    ds_read_b64_tr_b16 v[186:187], v245 offset:3072
    v_lshlrev_b32 v198, 16, v79
    v_and_b32 v199, 0xffff0000, v79
    v_cvt_pk_bf16_f32 v73, v200, v201
    v_cvt_pk_bf16_f32 v77, v202, v203
    v_mul_f32_dpp v200, v243, v196 row_newbcast:4 row_mask:0xf bank_mask:0xf
    v_mul_f32_dpp v201, v243, v197 row_newbcast:5 row_mask:0xf bank_mask:0xf
    v_mul_f32_dpp v202, v243, v196 row_newbcast:12 row_mask:0xf bank_mask:0xf
    v_mul_f32_dpp v203, v243, v197 row_newbcast:13 row_mask:0xf bank_mask:0xf
    v_cvt_pk_bf16_f32 v74, v200, v201
    v_cvt_pk_bf16_f32 v78, v202, v203
    v_mul_f32_dpp v200, v243, v198 row_newbcast:6 row_mask:0xf bank_mask:0xf
    v_mul_f32_dpp v201, v243, v199 row_newbcast:7 row_mask:0xf bank_mask:0xf
    v_mul_f32_dpp v202, v243, v198 row_newbcast:14 row_mask:0xf bank_mask:0xf
    v_mul_f32_dpp v203, v243, v199 row_newbcast:15 row_mask:0xf bank_mask:0xf
    v_cvt_pk_bf16_f32 v75, v200, v201
    v_cvt_pk_bf16_f32 v79, v202, v203
    s_nop 0
    s_waitcnt lgkmcnt(0)
    v_mfma_f32_32x32x16_bf16 v[0:15], v[72:75], v[176:179], v[0:15]
    s_add_u32 m0, s21, 2048
    v_mfma_f32_32x32x16_bf16 v[16:31], v[76:79], v[176:179], v[16:31]
    buffer_load_dwordx4 v236, s[4:7], s36 offen lds
    buffer_load_dwordx4 v237, s[8:11], s36 offen offset:1024 lds
    s_mov_b32 m0, s50
    s_nop 0
    s_movrels_b32 s71, s23
    s_bfe_u32 s46, s71, 0x30012
    s_mov_b32 m0, s46
    s_and_b32 s66, s71, 0x3ffff
    s_movrels_b32 s68, s57
    s_movrels_b32 s69, s61
    s_sub_u32 s48, s66, s47
    s_mov_b32 s47, s66
    s_lshr_b32 s52, s71, 28
    s_lshl_b32 s67, s46, 9
    s_add_u32 s66, s66, s67
    s_sub_u32 s49, s66, s42
    s_mov_b32 s42, s66
    s_bfe_u32 s66, s68, 655360
    s_add_u32 s43, s42, s66
    s_bfe_u32 s39, s69, 655360
    s_bfe_u32 s66, s68, 655370
    s_add_u32 s44, s42, s66
    s_bfe_u32 s40, s69, 655370
    s_bfe_u32 s66, s68, 655380
    s_add_u32 s45, s42, s66
    s_bfe_u32 s41, s69, 655380
    s_and_b32 s66, s46, s33
    s_cselect_b32 s72, -1, 1
    s_cselect_b32 s76, s47, 163712
    s_cmp_ge_u32 s66, 2
    s_cselect_b32 s73, -1, 0
    s_add_u32 s77, s47, 1024
    s_cmp_ge_u32 s66, 4
    s_cselect_b32 s75, -1, 0
    s_cmp_ge_u32 s66, 3
    s_cselect_b32 s74, -1, 1
    s_cselect_b32 s77, s77, 163712
    v_add_u32 v252, s44, v247
    ds_read_u16 v238, v252
    ds_read_u16 v239, v252 offset:64
    v_add_u32 v252, s45, v247
    ds_read_u16 v240, v252
    ds_read_u16 v241, v252 offset:64
    v_mfma_f32_32x32x16_bf16 v[32:47], v[64:67], v[180:183], 0
    v_mul_f32 v196, v0, v96
    v_fmac_f32 v196, v1, v97
    v_fmac_f32 v196, v2, v98
    v_fmac_f32 v196, v3, v99
    v_fmac_f32 v196, v4, v100
    v_fmac_f32 v196, v5, v101
    v_fmac_f32 v196, v6, v102
    v_fmac_f32 v196, v7, v103
    v_mul_f32 v198, v8, v128
    v_fmac_f32 v198, v9, v129
    v_mfma_f32_32x32x16_bf16 v[48:63], v[68:71], v[180:183], 0
    v_lshl_add_u32 v253, v248, 2, s47
    ds_read_b32 v254, v253
    ds_read_b32 v255, v253 offset:1024
    s_waitcnt vmcnt(6)
    ds_read_b64_tr_b16 v[176:177], v244 offset:4096
    ds_read_b64_tr_b16 v[178:179], v244 offset:5120
    ds_read_b64_tr_b16 v[180:181], v245 offset:4096
    ds_read_b64_tr_b16 v[182:183], v245 offset:5120
    v_fmac_f32 v198, v10, v130
    v_fmac_f32 v198, v11, v131
    v_fmac_f32 v198, v12, v132
    v_fmac_f32 v198, v13, v133
    v_fmac_f32 v198, v14, v134
    v_fmac_f32 v198, v15, v135
    v_mul_f32 v200, v16, v128
    v_fmac_f32 v200, v17, v129
    v_permlane32_swap_b32 v196, v198
    v_mfma_f32_32x32x16_bf16 v[32:47], v[72:75], v[184:187], v[32:47]
    v_fmac_f32 v200, v18, v130
    v_fmac_f32 v200, v19, v131
    v_fmac_f32 v200, v20, v132
    v_fmac_f32 v200, v21, v133
    v_fmac_f32 v200, v22, v134
    v_fmac_f32 v200, v23, v135
    v_add_f32 v198, v196, v198
    v_mul_f32_e64 v202, v24, -v128
    v_fma_f32 v202, v25, -v129, v202
    v_mfma_f32_32x32x16_bf16 v[48:63], v[76:79], v[184:187], v[48:63]
    v_fma_f32 v202, v26, -v130, v202
    v_fma_f32 v202, v27, -v131, v202
    v_fma_f32 v202, v28, -v132, v202
    v_fma_f32 v202, v29, -v133, v202
    v_fma_f32 v202, v30, -v134, v202
    v_fma_f32 v202, v31, -v135, v202
    s_nop 1
    v_permlane32_swap_b32 v200, v202
    v_add_f32 v202, v200, v202
    s_waitcnt vmcnt(4) lgkmcnt(0)
    v_mfma_f32_32x32x16_bf16 v[0:15], v[64:67], v[176:179], 0
    v_mul_f32 v197, v32, v104
    v_fmac_f32 v197, v33, v105
    v_fmac_f32 v197, v34, v106
    v_fmac_f32 v197, v35, v107
    v_fmac_f32 v197, v36, v108
    v_fmac_f32 v197, v37, v109
    v_fmac_f32 v197, v38, v110
    v_fmac_f32 v197, v39, v111
    v_mul_f32 v199, v40, v136
    v_fmac_f32 v199, v41, v137
    v_fmac_f32 v199, v42, v138
    s_add_u32 m0, s21, 4096
    v_mfma_f32_32x32x16_bf16 v[16:31], v[68:71], v[176:179], 0
    buffer_load_dwordx4 v234, s[4:7], s37 offen lds
    buffer_load_dwordx4 v235, s[8:11], s37 offen offset:1024 lds
    ds_read_b64_tr_b16 v[176:177], v244 offset:6144
    ds_read_b64_tr_b16 v[178:179], v244 offset:7168
    ds_read_b64_tr_b16 v[184:185], v245 offset:6144
    ds_read_b64_tr_b16 v[186:187], v245 offset:7168
    v_add_u32 v252, s42, v247
    ds_read_u16 v234, v252
    ds_read_u16 v235, v252 offset:64
    s_mov_b32 m0, s76
    s_mov_b64 exec, s[72:73]
    buffer_load_dwordx4 v254, s[12:15], 0 offen  lds
    s_mov_b32 m0, s77
    s_mov_b64 exec, s[74:75]
    buffer_load_dwordx4 v255, s[12:15], 0 offen  lds
    s_mov_b64 exec, -1
    v_fmac_f32 v199, v43, v139
    v_fmac_f32 v199, v44, v140
    v_fmac_f32 v199, v45, v141
    v_fmac_f32 v199, v46, v142
    v_fmac_f32 v199, v47, v143
    v_mul_f32 v201, v48, v136
    v_fmac_f32 v201, v49, v137
    v_permlane32_swap_b32 v197, v199
    v_fmac_f32 v201, v50, v138
    v_fmac_f32 v201, v51, v139
    s_waitcnt lgkmcnt(2)
    v_mfma_f32_32x32x16_bf16 v[0:15], v[72:75], v[176:179], v[0:15]
    v_fmac_f32 v201, v52, v140
    v_fmac_f32 v201, v53, v141
    v_fmac_f32 v201, v54, v142
    v_fmac_f32 v201, v55, v143
    v_add_f32 v199, v197, v199
    v_mul_f32_e64 v203, v56, -v136
    v_fma_f32 v203, v57, -v137, v203
    v_fma_f32 v203, v58, -v138, v203
    v_fma_f32 v203, v59, -v139, v203
    v_fma_f32 v203, v60, -v140, v203
    v_fma_f32 v203, v61, -v141, v203
    s_add_u32 m0, s21, 6144
    v_mfma_f32_32x32x16_bf16 v[16:31], v[76:79], v[176:179], v[16:31]
    buffer_load_dwordx4 v236, s[4:7], s37 offen lds
    buffer_load_dwordx4 v237, s[8:11], s37 offen offset:1024 lds
    v_add_u32 v252, s43, v247
    ds_read_u16 v236, v252
    ds_read_u16 v237, v252 offset:64
    v_fma_f32 v203, v62, -v142, v203
    v_fma_f32 v203, v63, -v143, v203
    s_nop 1
    v_permlane32_swap_b32 v201, v203
    v_add_f32 v203, v201, v203
    s_set_gpr_idx_on s51, gpr_idx(DST)
    s_nop 0
    v_cvt_pk_bf16_f32 v204, v198, v199
    v_cvt_pk_bf16_f32 v205, v202, v203
    s_set_gpr_idx_off
    v_mfma_f32_32x32x16_bf16 v[32:47], v[64:67], v[180:183], 0
    v_mul_f32 v196, v0, v144
    v_fmac_f32 v196, v1, v145
    v_fmac_f32 v196, v2, v146
    v_fmac_f32 v196, v3, v147
    v_fmac_f32 v196, v4, v148
    v_fmac_f32 v196, v5, v149
    v_fmac_f32 v196, v6, v150
    v_fmac_f32 v196, v7, v151
    v_mfma_f32_32x32x16_bf16 v[48:63], v[68:71], v[180:183], 0
    s_waitcnt vmcnt(8)
    ds_read_b64_tr_b16 v[176:177], v244 offset:0
    ds_read_b64_tr_b16 v[178:179], v244 offset:1024
    ds_read_b64_tr_b16 v[180:181], v245 offset:0
    ds_read_b64_tr_b16 v[182:183], v245 offset:1024
    v_mul_f32 v198, v8, v112
    v_fmac_f32 v198, v9, v113
    v_fmac_f32 v198, v10, v114
    v_fmac_f32 v198, v11, v115
    v_fmac_f32 v198, v12, v116
    v_fmac_f32 v198, v13, v117
    v_fmac_f32 v198, v14, v118
    v_fmac_f32 v198, v15, v119
    v_mfma_f32_32x32x16_bf16 v[32:47], v[72:75], v[184:187], v[32:47]
    v_mul_f32_e64 v200, v16, -v160
    v_fma_f32 v200, v17, -v161, v200
    v_fma_f32 v200, v18, -v162, v200
    v_fma_f32 v200, v19, -v163, v200
    v_fma_f32 v200, v20, -v164, v200
    v_fma_f32 v200, v21, -v165, v200
    v_fma_f32 v200, v22, -v166, v200
    v_fma_f32 v200, v23, -v167, v200
    v_mfma_f32_32x32x16_bf16 v[48:63], v[76:79], v[184:187], v[48:63]
    v_mul_f32_e64 v202, v24, -v160
    v_fma_f32 v202, v25, -v161, v202
    v_fma_f32 v202, v26, -v162, v202
    v_fma_f32 v202, v27, -v163, v202
    v_fma_f32 v202, v28, -v164, v202
    v_fma_f32 v202, v29, -v165, v202
    v_fma_f32 v202, v30, -v166, v202
    v_fma_f32 v202, v31, -v167, v202
    s_waitcnt vmcnt(6) lgkmcnt(0)
    v_mfma_f32_32x32x16_bf16 v[0:15], v[64:67], v[176:179], 0
    v_mul_f32 v197, v32, v152
    v_fmac_f32 v197, v33, v153
    v_fmac_f32 v197, v34, v154
    v_fmac_f32 v197, v35, v155
    v_fmac_f32 v197, v36, v156
    v_fmac_f32 v197, v37, v157
    v_fmac_f32 v197, v38, v158
    v_fmac_f32 v197, v39, v159
    s_add_u32 m0, s21, 0
    v_mfma_f32_32x32x16_bf16 v[16:31], v[68:71], v[176:179], 0
    v_lshl_add_u32 v234, v234, 10, v246
    v_lshl_add_u32 v235, v235, 10, v246
    buffer_load_dwordx4 v234, s[4:7], s38 offen lds
    buffer_load_dwordx4 v235, s[8:11], s38 offen offset:1024 lds
    ds_read_b64_tr_b16 v[176:177], v244 offset:2048
    ds_read_b64_tr_b16 v[178:179], v244 offset:3072
    ds_read_b64_tr_b16 v[184:185], v245 offset:2048
    ds_read_b64_tr_b16 v[186:187], v245 offset:3072
    v_mul_f32 v199, v40, v120
    v_fmac_f32 v199, v41, v121
    v_fmac_f32 v199, v42, v122
    v_fmac_f32 v199, v43, v123
    v_fmac_f32 v199, v44, v124
    v_fmac_f32 v199, v45, v125
    v_fmac_f32 v199, v46, v126
    v_fmac_f32 v199, v47, v127
    s_waitcnt lgkmcnt(0)
    v_mfma_f32_32x32x16_bf16 v[0:15], v[72:75], v[176:179], v[0:15]
    v_mul_f32_e64 v201, v48, -v168
    v_fma_f32 v201, v49, -v169, v201
    v_fma_f32 v201, v50, -v170, v201
    v_fma_f32 v201, v51, -v171, v201
    v_fma_f32 v201, v52, -v172, v201
    v_fma_f32 v201, v53, -v173, v201
    v_fma_f32 v201, v54, -v174, v201
    v_fma_f32 v201, v55, -v175, v201
    s_add_u32 m0, s21, 2048
    v_mfma_f32_32x32x16_bf16 v[16:31], v[76:79], v[176:179], v[16:31]
    v_lshl_add_u32 v236, v236, 10, v246
    v_lshl_add_u32 v237, v237, 10, v246
    buffer_load_dwordx4 v236, s[4:7], s39 offen lds
    buffer_load_dwordx4 v237, s[8:11], s39 offen offset:1024 lds
    v_mul_f32_e64 v203, v56, -v168
    v_fma_f32 v203, v57, -v169, v203
    v_fma_f32 v203, v58, -v170, v203
    v_fma_f32 v203, v59, -v171, v203
    v_fma_f32 v203, v60, -v172, v203
    v_fma_f32 v203, v61, -v173, v203
    v_fma_f32 v203, v62, -v174, v203
    v_fma_f32 v203, v63, -v175, v203
    v_mfma_f32_32x32x16_bf16 v[32:47], v[64:67], v[180:183], 0
    v_mul_f32 v254, v0, v144
    v_fmac_f32 v254, v1, v145
    v_fmac_f32 v254, v2, v146
    v_fmac_f32 v254, v3, v147
    v_fmac_f32 v254, v4, v148
    v_mfma_f32_32x32x16_bf16 v[48:63], v[68:71], v[180:183], 0
    ds_swizzle_b32 v68, v68 offset:0x401F
    ds_swizzle_b32 v69, v69 offset:0x401F
    ds_swizzle_b32 v70, v70 offset:0x401F
    ds_swizzle_b32 v71, v71 offset:0x401F
    s_waitcnt vmcnt(8)
    ds_read_b64_tr_b16 v[176:177], v244 offset:4096
    ds_read_b64_tr_b16 v[178:179], v244 offset:5120
    ds_read_b64_tr_b16 v[180:181], v245 offset:4096
    ds_read_b64_tr_b16 v[182:183], v245 offset:5120
    v_fmac_f32 v254, v5, v149
    v_fmac_f32 v254, v6, v150
    v_fmac_f32 v254, v7, v151
    v_fmac_f32 v200, v8, v160
    v_mfma_f32_32x32x16_bf16 v[32:47], v[72:75], v[184:187], v[32:47]
    v_fmac_f32 v200, v9, v161
    v_permlane32_swap_b32 v196, v254
    v_fmac_f32 v200, v10, v162
    v_fmac_f32 v200, v11, v163
    v_fmac_f32 v200, v12, v164
    v_mfma_f32_32x32x16_bf16 v[48:63], v[76:79], v[184:187], v[48:63]
    ds_swizzle_b32 v76, v76 offset:0x401F
    ds_swizzle_b32 v77, v77 offset:0x401F
    ds_swizzle_b32 v78, v78 offset:0x401F
    ds_swizzle_b32 v79, v79 offset:0x401F
    v_fmac_f32 v200, v13, v165
    v_fmac_f32 v200, v14, v166
    v_fmac_f32 v200, v15, v167
    v_add_f32 v254, v196, v254
    s_waitcnt lgkmcnt(8)
    s_mov_b64 exec, s[56:57]
    v_xor_b32 v68, 0x80008000, v68
    v_xor_b32 v69, 0x80008000, v69
    v_xor_b32 v70, 0x80008000, v70
    v_xor_b32 v71, 0x80008000, v71
    s_mov_b64 exec, -1
    s_waitcnt vmcnt(4) lgkmcnt(4)
    v_mfma_f32_32x32x16_bf16 v[0:15], v[64:67], v[176:179], 0
    v_mul_f32 v255, v32, v152
    v_fmac_f32 v255, v33, v153
    v_fmac_f32 v255, v34, v154
    v_fmac_f32 v255, v35, v155
    v_fmac_f32 v255, v36, v156
    v_fmac_f32 v255, v37, v157
    s_add_u32 m0, s21, 4096
    v_mfma_f32_32x32x16_bf16 v[16:31], v[68:71], v[176:179], v[16:31]
    v_lshl_add_u32 v238, v238, 10, v246
    v_lshl_add_u32 v239, v239, 10, v246
    buffer_load_dwordx4 v238, s[4:7], s40 offen lds
    buffer_load_dwordx4 v239, s[8:11], s40 offen offset:1024 lds
    ds_read_b64_tr_b16 v[176:177], v244 offset:6144
    ds_read_b64_tr_b16 v[178:179], v244 offset:7168
    ds_read_b64_tr_b16 v[184:185], v245 offset:6144
    ds_read_b64_tr_b16 v[186:187], v245 offset:7168
    v_fmac_f32 v255, v38, v158
    v_fmac_f32 v255, v39, v159
    v_fmac_f32 v201, v40, v168
    v_fmac_f32 v201, v41, v169
    v_permlane32_swap_b32 v197, v255
    s_waitcnt lgkmcnt(0)
    s_mov_b64 exec, s[56:57]
    v_xor_b32 v76, 0x80008000, v76
    v_xor_b32 v77, 0x80008000, v77
    v_xor_b32 v78, 0x80008000, v78
    v_xor_b32 v79, 0x80008000, v79
    s_mov_b64 exec, -1
    v_mfma_f32_32x32x16_bf16 v[0:15], v[72:75], v[176:179], v[0:15]
    v_fmac_f32 v201, v42, v170
    v_fmac_f32 v201, v43, v171
    v_fmac_f32 v201, v44, v172
    v_fmac_f32 v201, v45, v173
    v_fmac_f32 v201, v46, v174
    v_fmac_f32 v201, v47, v175
    s_add_u32 m0, s21, 6144
    v_mfma_f32_32x32x16_bf16 v[16:31], v[76:79], v[176:179], v[16:31]
    v_lshl_add_u32 v240, v240, 10, v246
    v_lshl_add_u32 v241, v241, 10, v246
    buffer_load_dwordx4 v240, s[4:7], s41 offen lds
    buffer_load_dwordx4 v241, s[8:11], s41 offen offset:1024 lds
    v_add_f32 v255, v197, v255
    s_set_gpr_idx_on s51, gpr_idx(DST)
    s_nop 0
    v_cvt_pk_bf16_f32 v206, v254, v255
    s_set_gpr_idx_off
    v_mfma_f32_32x32x16_bf16 v[32:47], v[64:67], v[180:183], 0
    v_mul_f32 v254, v0, v144
    v_fmac_f32 v254, v1, v145
    v_fmac_f32 v254, v2, v146
    v_fmac_f32 v254, v3, v147
    v_fmac_f32 v254, v4, v148
    v_fmac_f32 v254, v5, v149
    v_fmac_f32 v254, v6, v150
    v_fmac_f32 v254, v7, v151
    v_fma_f32 v202, v8, -v160, v202
    v_fma_f32 v202, v9, -v161, v202
    v_mfma_f32_32x32x16_bf16 v[48:63], v[68:71], v[180:183], v[48:63]
    s_waitcnt vmcnt(6)
    ds_read_b64_tr_b16 v[176:177], v244 offset:0
    ds_read_b64_tr_b16 v[178:179], v244 offset:1024
    ds_read_b64_tr_b16 v[180:181], v245 offset:0
    ds_read_b64_tr_b16 v[182:183], v245 offset:1024
    v_permlane32_swap_b32 v254, v200
    v_fma_f32 v202, v10, -v162, v202
    v_fma_f32 v202, v11, -v163, v202
    v_fma_f32 v202, v12, -v164, v202
    v_fma_f32 v202, v13, -v165, v202
    v_fma_f32 v202, v14, -v166, v202
    v_fma_f32 v202, v15, -v167, v202
    v_add_f32 v200, v254, v200
    v_fmac_f32 v198, v16, v112
    v_permlane32_swap_b32 v202, v254
    v_mfma_f32_32x32x16_bf16 v[32:47], v[72:75], v[184:187], v[32:47]
    v_fmac_f32 v198, v17, v113
    v_fmac_f32 v198, v18, v114
    v_fmac_f32 v198, v19, v115
    v_fmac_f32 v198, v20, v116
    v_fmac_f32 v198, v21, v117
    v_fmac_f32 v198, v22, v118
    v_fmac_f32 v198, v23, v119
    v_add_f32 v254, v202, v254
    v_mul_f32 v196, v24, v160
    v_fmac_f32 v196, v25, v161
    v_mfma_f32_32x32x16_bf16 v[48:63], v[76:79], v[184:187], v[48:63]
    v_add_u32 v249, s48, v249
    v_add_u32 v250, s49, v250
    ds_read_b32 v252, v251 offset:16
    ds_read_b64_tr_b16 v[68:69], v249 offset:0
    ds_read_b64_tr_b16 v[70:71], v249 offset:256
    s_mov_b64 exec, s[54:55]
    ds_read_u16_d16_hi v242, v250 offset:0
    s_mov_b64 exec, -1
    v_fmac_f32 v196, v26, v162
    v_fmac_f32 v196, v27, v163
    v_fmac_f32 v196, v28, v164
    v_fmac_f32 v196, v29, v165
    v_fmac_f32 v196, v30, v166
    v_fmac_f32 v196, v31, v167
    s_nop 1
    v_permlane32_swap_b32 v198, v196
    v_add_f32 v196, v198, v196
    v_mul_f32 v255, v32, v152
    v_fmac_f32 v255, v33, v153
    v_fmac_f32 v255, v34, v154
    v_fmac_f32 v255, v35, v155
    v_fmac_f32 v255, v36, v156
    v_fmac_f32 v255, v37, v157
    v_fmac_f32 v255, v38, v158
    v_fmac_f32 v255, v39, v159
    v_fma_f32 v203, v40, -v168, v203
    v_fma_f32 v203, v41, -v169, v203
    v_permlane32_swap_b32 v255, v201
    v_fma_f32 v203, v42, -v170, v203
    v_fma_f32 v203, v43, -v171, v203
    v_fma_f32 v203, v44, -v172, v203
    v_fma_f32 v203, v45, -v173, v203
    v_fma_f32 v203, v46, -v174, v203
    v_fma_f32 v203, v47, -v175, v203
    v_add_f32 v201, v255, v201
    v_fmac_f32 v199, v48, v120
    v_permlane32_swap_b32 v203, v255
    v_fmac_f32 v199, v49, v121
    v_fmac_f32 v199, v50, v122
    v_fmac_f32 v199, v51, v123
    v_fmac_f32 v199, v52, v124
    v_fmac_f32 v199, v53, v125
    v_fmac_f32 v199, v54, v126
    v_fmac_f32 v199, v55, v127
    v_add_f32 v255, v203, v255
    v_mul_f32 v197, v56, v168
    v_fmac_f32 v197, v57, v169
    v_fmac_f32 v197, v58, v170
    v_fmac_f32 v197, v59, v171
    v_fmac_f32 v197, v60, v172
    v_fmac_f32 v197, v61, v173
    v_fmac_f32 v197, v62, v174
    v_fmac_f32 v197, v63, v175
    s_nop 1
    v_permlane32_swap_b32 v199, v197
    v_add_f32 v197, v199, v197
    s_set_gpr_idx_on s51, gpr_idx(DST)
    s_nop 0
    v_cvt_pk_bf16_f32 v207, v200, v201
    v_cvt_pk_bf16_f32 v209, v254, v255
    v_cvt_pk_bf16_f32 v208, v196, v197
    s_set_gpr_idx_off
    s_add_u32 s50, s50, 1
    s_add_u32 s51, s51, 6
    s_cmp_ge_u32 s50, 4
    s_cbranch_scc1 LAST0
    s_waitcnt lgkmcnt(3)
    v_readfirstlane_b32 s66, v252
    s_add_u32 s53, s53, 1
    v_mov_b32 v252, s53
    s_cmp_le_u32 s53, s66
    ds_write2_b32 v251, v252, v252 offset0:0 offset1:8
    s_setprio 1
    s_cbranch_scc1 PRIO_4
    s_setprio 0
PRIO_4:
    s_cmp_eq_u32 s52, 4
    s_cbranch_scc1 ITEM_0_4
    s_cmp_eq_u32 s52, 5
    s_cbranch_scc1 ITEM_0_5
    s_cmp_eq_u32 s52, 3
    s_cbranch_scc1 ITEM_0_3
    s_cmp_eq_u32 s52, 6
    s_cbranch_scc1 ITEM_0_6
    s_cmp_eq_u32 s52, 8
    s_cbranch_scc1 ITEM_0_8
    s_branch ITEM_0_2
.p2align 6
ITEM_0_5:
    s_mov_b64 exec, s[54:55]
    ds_read_u16_d16_hi v243, v250 offset:128
    s_mov_b64 exec, -1
    ds_read_b64_tr_b16 v[76:77], v249 offset:512
    ds_read_b64_tr_b16 v[78:79], v249 offset:768
    ds_read_b64_tr_b16 v[84:85], v249 offset:1024
    s_waitcnt lgkmcnt(4)
    v_lshlrev_b32 v196, 16, v68
    v_and_b32 v197, 0xffff0000, v68
    v_lshlrev_b32 v198, 16, v69
    v_and_b32 v199, 0xffff0000, v69
    v_mul_f32_dpp v200, v242, v196 row_newbcast:0 row_mask:0xf bank_mask:0xf
    v_mul_f32_dpp v201, v242, v197 row_newbcast:1 row_mask:0xf bank_mask:0xf
    v_mul_f32_dpp v202, v242, v196 row_newbcast:8 row_mask:0xf bank_mask:0xf
    v_mul_f32_dpp v203, v242, v197 row_newbcast:9 row_mask:0xf bank_mask:0xf
    v_lshlrev_b32 v196, 16, v70
    v_and_b32 v197, 0xffff0000, v70
    v_cvt_pk_bf16_f32 v64, v200, v201
    v_cvt_pk_bf16_f32 v68, v202, v203
    v_mul_f32_dpp v200, v242, v198 row_newbcast:2 row_mask:0xf bank_mask:0xf
    v_mul_f32_dpp v201, v242, v199 row_newbcast:3 row_mask:0xf bank_mask:0xf
    v_mul_f32_dpp v202, v242, v198 row_newbcast:10 row_mask:0xf bank_mask:0xf
    v_mul_f32_dpp v203, v242, v199 row_newbcast:11 row_mask:0xf bank_mask:0xf
    v_lshlrev_b32 v198, 16, v71
    v_and_b32 v199, 0xffff0000, v71
    v_cvt_pk_bf16_f32 v65, v200, v201
    v_cvt_pk_bf16_f32 v69, v202, v203
    v_mul_f32_dpp v200, v242, v196 row_newbcast:4 row_mask:0xf bank_mask:0xf
    v_mul_f32_dpp v201, v242, v197 row_newbcast:5 row_mask:0xf bank_mask:0xf
    v_mul_f32_dpp v202, v242, v196 row_newbcast:12 row_mask:0xf bank_mask:0xf
    v_mul_f32_dpp v203, v242, v197 row_newbcast:13 row_mask:0xf bank_mask:0xf
    v_cvt_pk_bf16_f32 v66, v200, v201
    v_cvt_pk_bf16_f32 v70, v202, v203
    v_mul_f32_dpp v200, v242, v198 row_newbcast:6 row_mask:0xf bank_mask:0xf
    v_mul_f32_dpp v201, v242, v199 row_newbcast:7 row_mask:0xf bank_mask:0xf
    v_mul_f32_dpp v202, v242, v198 row_newbcast:14 row_mask:0xf bank_mask:0xf
    v_mul_f32_dpp v203, v242, v199 row_newbcast:15 row_mask:0xf bank_mask:0xf
    v_cvt_pk_bf16_f32 v67, v200, v201
    v_cvt_pk_bf16_f32 v71, v202, v203
    s_mov_b64 exec, s[54:55]
    ds_read_u16_d16_hi v242, v250 offset:256
    s_mov_b64 exec, -1
    s_waitcnt vmcnt(4) lgkmcnt(2)
    v_mfma_f32_32x32x16_bf16 v[0:15], v[64:67], v[176:179], 0
    v_lshlrev_b32 v196, 16, v76
    v_and_b32 v197, 0xffff0000, v76
    v_lshlrev_b32 v198, 16, v77
    v_and_b32 v199, 0xffff0000, v77
    v_mul_f32_dpp v200, v243, v196 row_newbcast:0 row_mask:0xf bank_mask:0xf
    v_mul_f32_dpp v201, v243, v197 row_newbcast:1 row_mask:0xf bank_mask:0xf
    v_mul_f32_dpp v202, v243, v196 row_newbcast:8 row_mask:0xf bank_mask:0xf
    v_mul_f32_dpp v203, v243, v197 row_newbcast:9 row_mask:0xf bank_mask:0xf
    v_lshlrev_b32 v196, 16, v78
    v_and_b32 v197, 0xffff0000, v78
    v_cvt_pk_bf16_f32 v72, v200, v201
    v_cvt_pk_bf16_f32 v76, v202, v203
    v_mul_f32_dpp v200, v243, v198 row_newbcast:2 row_mask:0xf bank_mask:0xf
    v_mul_f32_dpp v201, v243, v199 row_newbcast:3 row_mask:0xf bank_mask:0xf
    v_mul_f32_dpp v202, v243, v198 row_newbcast:10 row_mask:0xf bank_mask:0xf
    v_mul_f32_dpp v203, v243, v199 row_newbcast:11 row_mask:0xf bank_mask:0xf
    s_add_u32 m0, s21, 0
    v_mfma_f32_32x32x16_bf16 v[16:31], v[68:71], v[176:179], 0
    buffer_load_dwordx4 v236, s[4:7], s35 offen lds
    buffer_load_dwordx4 v237, s[8:11], s35 offen offset:1024 lds
    ds_read_b64_tr_b16 v[176:177], v244 offset:2048
    ds_read_b64_tr_b16 v[178:179], v244 offset:3072
    ds_read_b64_tr_b16 v[184:185], v245 offset:2048
    ds_read_b64_tr_b16 v[186:187], v245 offset:3072
    v_lshlrev_b32 v198, 16, v79
    v_and_b32 v199, 0xffff0000, v79
    v_cvt_pk_bf16_f32 v73, v200, v201
    v_cvt_pk_bf16_f32 v77, v202, v203
    v_mul_f32_dpp v200, v243, v196 row_newbcast:4 row_mask:0xf bank_mask:0xf
    v_mul_f32_dpp v201, v243, v197 row_newbcast:5 row_mask:0xf bank_mask:0xf
    v_mul_f32_dpp v202, v243, v196 row_newbcast:12 row_mask:0xf bank_mask:0xf
    v_mul_f32_dpp v203, v243, v197 row_newbcast:13 row_mask:0xf bank_mask:0xf
    v_cvt_pk_bf16_f32 v74, v200, v201
    v_cvt_pk_bf16_f32 v78, v202, v203
    v_mul_f32_dpp v200, v243, v198 row_newbcast:6 row_mask:0xf bank_mask:0xf
    v_mul_f32_dpp v201, v243, v199 row_newbcast:7 row_mask:0xf bank_mask:0xf
    v_mul_f32_dpp v202, v243, v198 row_newbcast:14 row_mask:0xf bank_mask:0xf
    v_mul_f32_dpp v203, v243, v199 row_newbcast:15 row_mask:0xf bank_mask:0xf
    v_cvt_pk_bf16_f32 v75, v200, v201
    v_cvt_pk_bf16_f32 v79, v202, v203
    s_nop 0
    s_waitcnt vmcnt(4) lgkmcnt(0)
    v_mfma_f32_32x32x16_bf16 v[0:15], v[72:75], v[176:179], v[0:15]
    v_lshlrev_b32 v196, 16, v84
    v_and_b32 v197, 0xffff0000, v84
    v_lshlrev_b32 v198, 16, v85
    v_and_b32 v199, 0xffff0000, v85
    v_mul_f32_dpp v200, v242, v196 row_newbcast:0 row_mask:0xf bank_mask:0xf
    v_mul_f32_dpp v201, v242, v197 row_newbcast:1 row_mask:0xf bank_mask:0xf
    v_mul_f32_dpp v202, v242, v196 row_newbcast:8 row_mask:0xf bank_mask:0xf
    v_mul_f32_dpp v203, v242, v197 row_newbcast:9 row_mask:0xf bank_mask:0xf
    s_add_u32 m0, s21, 2048
    v_mfma_f32_32x32x16_bf16 v[16:31], v[76:79], v[176:179], v[16:31]
    buffer_load_dwordx4 v238, s[4:7], s35 offen lds
    ds_read_b64_tr_b16 v[176:177], v244 offset:4096
    ds_read_b64_tr_b16 v[188:189], v245 offset:4096
    v_cvt_pk_bf16_f32 v80, v200, v201
    v_cvt_pk_bf16_f32 v84, v202, v203
    v_mul_f32_dpp v200, v242, v198 row_newbcast:2 row_mask:0xf bank_mask:0xf
    v_mul_f32_dpp v201, v242, v199 row_newbcast:3 row_mask:0xf bank_mask:0xf
    v_mul_f32_dpp v202, v242, v198 row_newbcast:10 row_mask:0xf bank_mask:0xf
    v_mul_f32_dpp v203, v242, v199 row_newbcast:11 row_mask:0xf bank_mask:0xf
    v_cvt_pk_bf16_f32 v81, v200, v201
    v_cvt_pk_bf16_f32 v85, v202, v203
    s_nop 0
    s_waitcnt lgkmcnt(0)
    v_mfma_f32_32x32x8_bf16 v[0:15], v[80:81], v[176:177], v[0:15]
    s_add_u32 m0, s21, 4096
    v_mfma_f32_32x32x8_bf16 v[16:31], v[84:85], v[176:177], v[16:31]
    buffer_load_dwordx4 v234, s[4:7], s36 offen lds
    buffer_load_dwordx4 v235, s[8:11], s36 offen offset:1024 lds
    s_mov_b32 m0, s50
    s_nop 0
    s_movrels_b32 s71, s23
    s_bfe_u32 s46, s71, 0x30012
    s_mov_b32 m0, s46
    s_and_b32 s66, s71, 0x3ffff
    s_movrels_b32 s68, s57
    s_movrels_b32 s69, s61
    s_sub_u32 s48, s66, s47
    s_mov_b32 s47, s66
    s_lshr_b32 s52, s71, 28
    s_lshl_b32 s67, s46, 9
    s_add_u32 s66, s66, s67
    s_sub_u32 s49, s66, s42
    s_mov_b32 s42, s66
    s_bfe_u32 s66, s68, 655360
    s_add_u32 s43, s42, s66
    s_bfe_u32 s39, s69, 655360
    s_bfe_u32 s66, s68, 655370
    s_add_u32 s44, s42, s66
    s_bfe_u32 s40, s69, 655370
    s_bfe_u32 s66, s68, 655380
    s_add_u32 s45, s42, s66
    s_bfe_u32 s41, s69, 655380
    s_and_b32 s66, s46, s33
    s_cselect_b32 s72, -1, 1
    s_cselect_b32 s76, s47, 163712
    s_cmp_ge_u32 s66, 2
    s_cselect_b32 s73, -1, 0
    s_add_u32 s77, s47, 1024
    s_cmp_ge_u32 s66, 4
    s_cselect_b32 s75, -1, 0
    s_cmp_ge_u32 s66, 3
    s_cselect_b32 s74, -1, 1
    s_cselect_b32 s77, s77, 163712
    v_add_u32 v252, s45, v247
    ds_read_u16 v240, v252
    ds_read_u16 v241, v252 offset:64
    v_mfma_f32_32x32x16_bf16 v[32:47], v[64:67], v[180:183], 0
    v_mul_f32 v196, v0, v96
    v_fmac_f32 v196, v1, v97
    v_fmac_f32 v196, v2, v98
    v_fmac_f32 v196, v3, v99
    v_fmac_f32 v196, v4, v100
    v_fmac_f32 v196, v5, v101
    v_fmac_f32 v196, v6, v102
    v_mfma_f32_32x32x16_bf16 v[48:63], v[68:71], v[180:183], 0
    v_lshl_add_u32 v253, v248, 2, s47
    ds_read_b32 v254, v253
    ds_read_b32 v255, v253 offset:1024
    v_fmac_f32 v196, v7, v103
    v_mul_f32 v198, v8, v128
    v_fmac_f32 v198, v9, v129
    v_fmac_f32 v198, v10, v130
    v_fmac_f32 v198, v11, v131
    v_fmac_f32 v198, v12, v132
    v_mfma_f32_32x32x16_bf16 v[32:47], v[72:75], v[184:187], v[32:47]
    v_fmac_f32 v198, v13, v133
    v_fmac_f32 v198, v14, v134
    v_fmac_f32 v198, v15, v135
    v_mul_f32 v200, v16, v128
    v_fmac_f32 v200, v17, v129
    v_permlane32_swap_b32 v196, v198
    v_mfma_f32_32x32x16_bf16 v[48:63], v[76:79], v[184:187], v[48:63]
    s_waitcnt vmcnt(5)
    ds_read_b64_tr_b16 v[176:177], v244 offset:6144
    ds_read_b64_tr_b16 v[178:179], v244 offset:7168
    ds_read_b64_tr_b16 v[180:181], v245 offset:6144
    ds_read_b64_tr_b16 v[182:183], v245 offset:7168
    v_fmac_f32 v200, v18, v130
    v_fmac_f32 v200, v19, v131
    v_fmac_f32 v200, v20, v132
    v_fmac_f32 v200, v21, v133
    v_fmac_f32 v200, v22, v134
    v_fmac_f32 v200, v23, v135
    v_mfma_f32_32x32x8_bf16 v[32:47], v[80:81], v[188:189], v[32:47]
    v_add_f32 v198, v196, v198
    v_mul_f32_e64 v202, v24, -v128
    v_fma_f32 v202, v25, -v129, v202
    v_fma_f32 v202, v26, -v130, v202
    v_fma_f32 v202, v27, -v131, v202
    v_fma_f32 v202, v28, -v132, v202
    v_mfma_f32_32x32x8_bf16 v[48:63], v[84:85], v[188:189], v[48:63]
    v_fma_f32 v202, v29, -v133, v202
    v_fma_f32 v202, v30, -v134, v202
    v_fma_f32 v202, v31, -v135, v202
    s_nop 1
    v_permlane32_swap_b32 v200, v202
    v_add_f32 v202, v200, v202
    s_waitcnt vmcnt(3) lgkmcnt(0)
    v_mfma_f32_32x32x16_bf16 v[0:15], v[64:67], v[176:179], 0
    v_mul_f32 v197, v32, v104
    v_fmac_f32 v197, v33, v105
    v_fmac_f32 v197, v34, v106
    v_fmac_f32 v197, v35, v107
    v_fmac_f32 v197, v36, v108
    v_fmac_f32 v197, v37, v109
    v_fmac_f32 v197, v38, v110
    s_add_u32 m0, s21, 6144
    v_mfma_f32_32x32x16_bf16 v[16:31], v[68:71], v[176:179], 0
    buffer_load_dwordx4 v236, s[4:7], s36 offen lds
    buffer_load_dwordx4 v237, s[8:11], s36 offen offset:1024 lds
    ds_read_b64_tr_b16 v[176:177], v244 offset:0
    ds_read_b64_tr_b16 v[178:179], v244 offset:1024
    ds_read_b64_tr_b16 v[184:185], v245 offset:0
    ds_read_b64_tr_b16 v[186:187], v245 offset:1024
    s_mov_b32 m0, s76
    s_mov_b64 exec, s[72:73]
    buffer_load_dwordx4 v254, s[12:15], 0 offen  lds
    s_mov_b32 m0, s77
    s_mov_b64 exec, s[74:75]
    buffer_load_dwordx4 v255, s[12:15], 0 offen  lds
    s_mov_b64 exec, -1
    v_fmac_f32 v197, v39, v111
    v_mul_f32 v199, v40, v136
    v_fmac_f32 v199, v41, v137
    v_fmac_f32 v199, v42, v138
    v_fmac_f32 v199, v43, v139
    v_fmac_f32 v199, v44, v140
    v_fmac_f32 v199, v45, v141
    s_waitcnt vmcnt(6) lgkmcnt(0)
    v_mfma_f32_32x32x16_bf16 v[0:15], v[72:75], v[176:179], v[0:15]
    v_fmac_f32 v199, v46, v142
    v_fmac_f32 v199, v47, v143
    v_mul_f32 v201, v48, v136
    v_fmac_f32 v201, v49, v137
    v_permlane32_swap_b32 v197, v199
    v_fmac_f32 v201, v50, v138
    v_fmac_f32 v201, v51, v139
    s_add_u32 m0, s21, 0
    v_mfma_f32_32x32x16_bf16 v[16:31], v[76:79], v[176:179], v[16:31]
    buffer_load_dwordx4 v238, s[4:7], s36 offen lds
    ds_read_b64_tr_b16 v[176:177], v244 offset:2048
    ds_read_b64_tr_b16 v[188:189], v245 offset:2048
    v_fmac_f32 v201, v52, v140
    v_fmac_f32 v201, v53, v141
    v_fmac_f32 v201, v54, v142
    v_fmac_f32 v201, v55, v143
    v_add_f32 v199, v197, v199
    v_mul_f32_e64 v203, v56, -v136
    v_fma_f32 v203, v57, -v137, v203
    s_waitcnt lgkmcnt(0)
    v_mfma_f32_32x32x8_bf16 v[0:15], v[80:81], v[176:177], v[0:15]
    v_fma_f32 v203, v58, -v138, v203
    v_fma_f32 v203, v59, -v139, v203
    v_fma_f32 v203, v60, -v140, v203
    v_fma_f32 v203, v61, -v141, v203
    v_fma_f32 v203, v62, -v142, v203
    v_fma_f32 v203, v63, -v143, v203
    s_nop 1
    s_add_u32 m0, s21, 2048
    v_mfma_f32_32x32x8_bf16 v[16:31], v[84:85], v[176:177], v[16:31]
    buffer_load_dwordx4 v234, s[4:7], s37 offen lds
    buffer_load_dwordx4 v235, s[8:11], s37 offen offset:1024 lds
    v_add_u32 v252, s42, v247
    ds_read_u16 v234, v252
    ds_read_u16 v235, v252 offset:64
    v_permlane32_swap_b32 v201, v203
    v_add_f32 v203, v201, v203
    s_set_gpr_idx_on s51, gpr_idx(DST)
    s_nop 0
    v_cvt_pk_bf16_f32 v204, v198, v199
    v_cvt_pk_bf16_f32 v205, v202, v203
    s_set_gpr_idx_off
    v_mfma_f32_32x32x16_bf16 v[32:47], v[64:67], v[180:183], 0
    v_mul_f32 v196, v0, v144
    v_fmac_f32 v196, v1, v145
    v_fmac_f32 v196, v2, v146
    v_fmac_f32 v196, v3, v147
    v_fmac_f32 v196, v4, v148
    v_fmac_f32 v196, v5, v149
    v_mfma_f32_32x32x16_bf16 v[48:63], v[68:71], v[180:183], 0
    v_fmac_f32 v196, v6, v150
    v_fmac_f32 v196, v7, v151
    v_mul_f32 v198, v8, v112
    v_fmac_f32 v198, v9, v113
    v_fmac_f32 v198, v10, v114
    v_mfma_f32_32x32x16_bf16 v[32:47], v[72:75], v[184:187], v[32:47]
    v_fmac_f32 v198, v11, v115
    v_fmac_f32 v198, v12, v116
    v_fmac_f32 v198, v13, v117
    v_fmac_f32 v198, v14, v118
    v_fmac_f32 v198, v15, v119
    v_mfma_f32_32x32x16_bf16 v[48:63], v[76:79], v[184:187], v[48:63]
    s_waitcnt vmcnt(7)
    ds_read_b64_tr_b16 v[176:177], v244 offset:4096
    ds_read_b64_tr_b16 v[178:179], v244 offset:5120
    ds_read_b64_tr_b16 v[180:181], v245 offset:4096
    ds_read_b64_tr_b16 v[182:183], v245 offset:5120
    v_mul_f32_e64 v200, v16, -v160
    v_fma_f32 v200, v17, -v161, v200
    v_fma_f32 v200, v18, -v162, v200
    v_fma_f32 v200, v19, -v163, v200
    v_fma_f32 v200, v20, -v164, v200
    v_fma_f32 v200, v21, -v165, v200
    v_mfma_f32_32x32x8_bf16 v[32:47], v[80:81], v[188:189], v[32:47]
    v_fma_f32 v200, v22, -v166, v200
    v_fma_f32 v200, v23, -v167, v200
    v_mul_f32_e64 v202, v24, -v160
    v_fma_f32 v202, v25, -v161, v202
    v_fma_f32 v202, v26, -v162, v202
    v_mfma_f32_32x32x8_bf16 v[48:63], v[84:85], v[188:189], v[48:63]
    v_fma_f32 v202, v27, -v163, v202
    v_fma_f32 v202, v28, -v164, v202
    v_fma_f32 v202, v29, -v165, v202
    v_fma_f32 v202, v30, -v166, v202
    v_fma_f32 v202, v31, -v167, v202
    s_waitcnt vmcnt(5) lgkmcnt(0)
    v_mfma_f32_32x32x16_bf16 v[0:15], v[64:67], v[176:179], 0
    v_mul_f32 v197, v32, v152
    v_fmac_f32 v197, v33, v153
    v_fmac_f32 v197, v34, v154
    v_fmac_f32 v197, v35, v155
    v_fmac_f32 v197, v36, v156
    v_fmac_f32 v197, v37, v157
    s_add_u32 m0, s21, 4096
    v_mfma_f32_32x32x16_bf16 v[16:31], v[68:71], v[176:179], 0
    buffer_load_dwordx4 v236, s[4:7], s37 offen lds
    buffer_load_dwordx4 v237, s[8:11], s37 offen offset:1024 lds
    ds_read_b64_tr_b16 v[176:177], v244 offset:6144
    ds_read_b64_tr_b16 v[178:179], v244 offset:7168
    ds_read_b64_tr_b16 v[184:185], v245 offset:6144
    ds_read_b64_tr_b16 v[186:187], v245 offset:7168
    v_add_u32 v252, s43, v247
    ds_read_u16 v236, v252
    ds_read_u16 v237, v252 offset:64
    v_fmac_f32 v197, v38, v158
    v_fmac_f32 v197, v39, v159
    v_mul_f32 v199, v40, v120
    v_fmac_f32 v199, v41, v121
    v_fmac_f32 v199, v42, v122
    s_waitcnt vmcnt(4) lgkmcnt(2)
    v_mfma_f32_32x32x16_bf16 v[0:15], v[72:75], v[176:179], v[0:15]
    v_fmac_f32 v199, v43, v123
    v_fmac_f32 v199, v44, v124
    v_fmac_f32 v199, v45, v125
    v_fmac_f32 v199, v46, v126
    v_fmac_f32 v199, v47, v127
    s_add_u32 m0, s21, 6144
    v_mfma_f32_32x32x16_bf16 v[16:31], v[76:79], v[176:179], v[16:31]
    buffer_load_dwordx4 v238, s[4:7], s37 offen lds
    ds_read_b64_tr_b16 v[176:177], v244 offset:0
    ds_read_b64_tr_b16 v[188:189], v245 offset:0
    v_add_u32 v252, s44, v247
    ds_read_u16 v238, v252
    ds_read_u16 v239, v252 offset:64
    v_mul_f32_e64 v201, v48, -v168
    v_fma_f32 v201, v49, -v169, v201
    v_fma_f32 v201, v50, -v170, v201
    v_fma_f32 v201, v51, -v171, v201
    v_fma_f32 v201, v52, -v172, v201
    v_fma_f32 v201, v53, -v173, v201
    s_waitcnt lgkmcnt(2)
    v_mfma_f32_32x32x8_bf16 v[0:15], v[80:81], v[176:177], v[0:15]
    v_fma_f32 v201, v54, -v174, v201
    v_fma_f32 v201, v55, -v175, v201
    v_mul_f32_e64 v203, v56, -v168
    v_fma_f32 v203, v57, -v169, v203
    v_fma_f32 v203, v58, -v170, v203
    s_add_u32 m0, s21, 0
    v_mfma_f32_32x32x8_bf16 v[16:31], v[84:85], v[176:177], v[16:31]
    v_lshl_add_u32 v234, v234, 10, v246
    v_lshl_add_u32 v235, v235, 10, v246
    buffer_load_dwordx4 v234, s[4:7], s38 offen lds
    buffer_load_dwordx4 v235, s[8:11], s38 offen offset:1024 lds
    v_fma_f32 v203, v59, -v171, v203
    v_fma_f32 v203, v60, -v172, v203
    v_fma_f32 v203, v61, -v173, v203
    v_fma_f32 v203, v62, -v174, v203
    v_fma_f32 v203, v63, -v175, v203
    v_mfma_f32_32x32x16_bf16 v[32:47], v[64:67], v[180:183], 0
    v_mul_f32 v254, v0, v144
    v_fmac_f32 v254, v1, v145
    v_fmac_f32 v254, v2, v146
    v_mfma_f32_32x32x16_bf16 v[48:63], v[68:71], v[180:183], 0
    ds_swizzle_b32 v68, v68 offset:0x401F
    ds_swizzle_b32 v69, v69 offset:0x401F
    ds_swizzle_b32 v70, v70 offset:0x401F
    ds_swizzle_b32 v71, v71 offset:0x401F
    v_fmac_f32 v254, v3, v147
    v_fmac_f32 v254, v4, v148
    v_fmac_f32 v254, v5, v149
    v_mfma_f32_32x32x16_bf16 v[32:47], v[72:75], v[184:187], v[32:47]
    v_fmac_f32 v254, v6, v150
    v_fmac_f32 v254, v7, v151
    v_fmac_f32 v200, v8, v160
    v_mfma_f32_32x32x16_bf16 v[48:63], v[76:79], v[184:187], v[48:63]
    ds_swizzle_b32 v76, v76 offset:0x401F
    ds_swizzle_b32 v77, v77 offset:0x401F
    ds_swizzle_b32 v78, v78 offset:0x401F
    ds_swizzle_b32 v79, v79 offset:0x401F
    s_waitcnt vmcnt(5)
    ds_read_b64_tr_b16 v[176:177], v244 offset:2048
    ds_read_b64_tr_b16 v[178:179], v244 offset:3072
    ds_read_b64_tr_b16 v[180:181], v245 offset:2048
    ds_read_b64_tr_b16 v[182:183], v245 offset:3072
    v_fmac_f32 v200, v9, v161
    v_permlane32_swap_b32 v196, v254
    v_fmac_f32 v200, v10, v162
    v_mfma_f32_32x32x8_bf16 v[32:47], v[80:81], v[188:189], v[32:47]
    v_fmac_f32 v200, v11, v163
    v_fmac_f32 v200, v12, v164
    v_fmac_f32 v200, v13, v165
    v_mfma_f32_32x32x8_bf16 v[48:63], v[84:85], v[188:189], v[48:63]
    ds_swizzle_b32 v84, v84 offset:0x401F
    ds_swizzle_b32 v85, v85 offset:0x401F
    v_fmac_f32 v200, v14, v166
    v_fmac_f32 v200, v15, v167
    v_add_f32 v254, v196, v254
    s_waitcnt lgkmcnt(6)
    s_mov_b64 exec, s[56:57]
    v_xor_b32 v68, 0x80008000, v68
    v_xor_b32 v69, 0x80008000, v69
    v_xor_b32 v70, 0x80008000, v70
    v_xor_b32 v71, 0x80008000, v71
    v_xor_b32 v76, 0x80008000, v76
    v_xor_b32 v77, 0x80008000, v77
    v_xor_b32 v78, 0x80008000, v78
    v_xor_b32 v79, 0x80008000, v79
    s_mov_b64 exec, -1
    s_waitcnt vmcnt(3) lgkmcnt(2)
    v_mfma_f32_32x32x16_bf16 v[0:15], v[64:67], v[176:179], 0
    v_mul_f32 v255, v32, v152
    v_fmac_f32 v255, v33, v153
    v_fmac_f32 v255, v34, v154
    v_fmac_f32 v255, v35, v155
    s_add_u32 m0, s21, 2048
    v_mfma_f32_32x32x16_bf16 v[16:31], v[68:71], v[176:179], v[16:31]
    v_lshl_add_u32 v236, v236, 10, v246
    v_lshl_add_u32 v237, v237, 10, v246
    buffer_load_dwordx4 v236, s[4:7], s39 offen lds
    buffer_load_dwordx4 v237, s[8:11], s39 offen offset:1024 lds
    ds_read_b64_tr_b16 v[176:177], v244 offset:4096
    ds_read_b64_tr_b16 v[178:179], v244 offset:5120
    ds_read_b64_tr_b16 v[184:185], v245 offset:4096
    ds_read_b64_tr_b16 v[186:187], v245 offset:5120
    v_fmac_f32 v255, v36, v156
    v_fmac_f32 v255, v37, v157
    v_fmac_f32 v255, v38, v158
    v_fmac_f32 v255, v39, v159
    s_waitcnt vmcnt(4) lgkmcnt(0)
    v_mfma_f32_32x32x16_bf16 v[0:15], v[72:75], v[176:179], v[0:15]
    v_fmac_f32 v201, v40, v168
    v_fmac_f32 v201, v41, v169
    v_permlane32_swap_b32 v197, v255
    s_add_u32 m0, s21, 4096
    v_mfma_f32_32x32x16_bf16 v[16:31], v[76:79], v[176:179], v[16:31]
    v_lshl_add_u32 v238, v238, 10, v246
    v_lshl_add_u32 v239, v239, 10, v246
    buffer_load_dwordx4 v238, s[4:7], s40 offen lds
    buffer_load_dwordx4 v239, s[8:11], s40 offen offset:1024 lds
    ds_read_b64_tr_b16 v[176:177], v244 offset:6144
    ds_read_b64_tr_b16 v[188:189], v245 offset:6144
    v_fmac_f32 v201, v42, v170
    v_fmac_f32 v201, v43, v171
    v_fmac_f32 v201, v44, v172
    v_fmac_f32 v201, v45, v173
    s_waitcnt lgkmcnt(0)
    s_mov_b64 exec, s[56:57]
    v_xor_b32 v84, 0x80008000, v84
    v_xor_b32 v85, 0x80008000, v85
    s_mov_b64 exec, -1
    v_mfma_f32_32x32x8_bf16 v[0:15], v[80:81], v[176:177], v[0:15]
    v_fmac_f32 v201, v46, v174
    v_fmac_f32 v201, v47, v175
    v_add_f32 v255, v197, v255
    s_set_gpr_idx_on s51, gpr_idx(DST)
    s_nop 0
    v_cvt_pk_bf16_f32 v206, v254, v255
    s_set_gpr_idx_off
    s_add_u32 m0, s21, 6144
    v_mfma_f32_32x32x8_bf16 v[16:31], v[84:85], v[176:177], v[16:31]
    v_lshl_add_u32 v240, v240, 10, v246
    v_lshl_add_u32 v241, v241, 10, v246
    buffer_load_dwordx4 v240, s[4:7], s41 offen lds
    buffer_load_dwordx4 v241, s[8:11], s41 offen offset:1024 lds
    v_mfma_f32_32x32x16_bf16 v[32:47], v[64:67], v[180:183], 0
    v_mul_f32 v254, v0, v144
    v_fmac_f32 v254, v1, v145
    v_fmac_f32 v254, v2, v146
    v_fmac_f32 v254, v3, v147
    v_fmac_f32 v254, v4, v148
    v_fmac_f32 v254, v5, v149
    v_fmac_f32 v254, v6, v150
    v_mfma_f32_32x32x16_bf16 v[48:63], v[68:71], v[180:183], v[48:63]
    v_fmac_f32 v254, v7, v151
    v_fma_f32 v202, v8, -v160, v202
    v_fma_f32 v202, v9, -v161, v202
    v_permlane32_swap_b32 v254, v200
    v_fma_f32 v202, v10, -v162, v202
    v_fma_f32 v202, v11, -v163, v202
    v_mfma_f32_32x32x16_bf16 v[32:47], v[72:75], v[184:187], v[32:47]
    v_fma_f32 v202, v12, -v164, v202
    v_fma_f32 v202, v13, -v165, v202
    v_fma_f32 v202, v14, -v166, v202
    v_fma_f32 v202, v15, -v167, v202
    v_add_f32 v200, v254, v200
    v_fmac_f32 v198, v16, v112
    v_permlane32_swap_b32 v202, v254
    v_mfma_f32_32x32x16_bf16 v[48:63], v[76:79], v[184:187], v[48:63]
    s_waitcnt vmcnt(6)
    ds_read_b64_tr_b16 v[176:177], v244 offset:0
    ds_read_b64_tr_b16 v[178:179], v244 offset:1024
    ds_read_b64_tr_b16 v[180:181], v245 offset:0
    ds_read_b64_tr_b16 v[182:183], v245 offset:1024
    v_fmac_f32 v198, v17, v113
    v_fmac_f32 v198, v18, v114
    v_fmac_f32 v198, v19, v115
    v_fmac_f32 v198, v20, v116
    v_fmac_f32 v198, v21, v117
    v_fmac_f32 v198, v22, v118
    v_mfma_f32_32x32x8_bf16 v[32:47], v[80:81], v[188:189], v[32:47]
    v_fmac_f32 v198, v23, v119
    v_add_f32 v254, v202, v254
    v_mul_f32 v196, v24, v160
    v_fmac_f32 v196, v25, v161
    v_fmac_f32 v196, v26, v162
    v_fmac_f32 v196, v27, v163
    v_fmac_f32 v196, v28, v164
    v_mfma_f32_32x32x8_bf16 v[48:63], v[84:85], v[188:189], v[48:63]
    v_add_u32 v249, s48, v249
    v_add_u32 v250, s49, v250
    ds_read_b32 v252, v251 offset:16
    ds_read_b64_tr_b16 v[68:69], v249 offset:0
    ds_read_b64_tr_b16 v[70:71], v249 offset:256
    s_mov_b64 exec, s[54:55]
    ds_read_u16_d16_hi v242, v250 offset:0
    s_mov_b64 exec, -1
    v_fmac_f32 v196, v29, v165
    v_fmac_f32 v196, v30, v166
    v_fmac_f32 v196, v31, v167
    s_nop 1
    v_permlane32_swap_b32 v198, v196
    v_add_f32 v196, v198, v196
    v_mul_f32 v255, v32, v152
    v_fmac_f32 v255, v33, v153
    v_fmac_f32 v255, v34, v154
    v_fmac_f32 v255, v35, v155
    v_fmac_f32 v255, v36, v156
    v_fmac_f32 v255, v37, v157
    v_fmac_f32 v255, v38, v158
    v_fmac_f32 v255, v39, v159
    v_fma_f32 v203, v40, -v168, v203
    v_fma_f32 v203, v41, -v169, v203
    v_permlane32_swap_b32 v255, v201
    v_fma_f32 v203, v42, -v170, v203
    v_fma_f32 v203, v43, -v171, v203
    v_fma_f32 v203, v44, -v172, v203
    v_fma_f32 v203, v45, -v173, v203
    v_fma_f32 v203, v46, -v174, v203
    v_fma_f32 v203, v47, -v175, v203
    v_add_f32 v201, v255, v201
    v_fmac_f32 v199, v48, v120
    v_permlane32_swap_b32 v203, v255
    v_fmac_f32 v199, v49, v121
    v_fmac_f32 v199, v50, v122
    v_fmac_f32 v199, v51, v123
    v_fmac_f32 v199, v52, v124
    v_fmac_f32 v199, v53, v125
    v_fmac_f32 v199, v54, v126
    v_fmac_f32 v199, v55, v127
    v_add_f32 v255, v203, v255
    v_mul_f32 v197, v56, v168
    v_fmac_f32 v197, v57, v169
    v_fmac_f32 v197, v58, v170
    v_fmac_f32 v197, v59, v171
    v_fmac_f32 v197, v60, v172
    v_fmac_f32 v197, v61, v173
    v_fmac_f32 v197, v62, v174
    v_fmac_f32 v197, v63, v175
    s_nop 1
    v_permlane32_swap_b32 v199, v197
    v_add_f32 v197, v199, v197
    s_set_gpr_idx_on s51, gpr_idx(DST)
    s_nop 0
    v_cvt_pk_bf16_f32 v207, v200, v201
    v_cvt_pk_bf16_f32 v209, v254, v255
    v_cvt_pk_bf16_f32 v208, v196, v197
    s_set_gpr_idx_off
    s_add_u32 s50, s50, 1
    s_add_u32 s51, s51, 6
    s_cmp_ge_u32 s50, 4
    s_cbranch_scc1 LAST0
    s_waitcnt lgkmcnt(3)
    v_readfirstlane_b32 s66, v252
    s_add_u32 s53, s53, 1
    v_mov_b32 v252, s53
    s_cmp_le_u32 s53, s66
    ds_write2_b32 v251, v252, v252 offset0:0 offset1:8
    s_setprio 1
    s_cbranch_scc1 PRIO_5
    s_setprio 0
PRIO_5:
    s_cmp_eq_u32 s52, 4
    s_cbranch_scc1 ITEM_0_4
    s_cmp_eq_u32 s52, 5
    s_cbranch_scc1 ITEM_0_5
    s_cmp_eq_u32 s52, 3
    s_cbranch_scc1 ITEM_0_3
    s_cmp_eq_u32 s52, 6
    s_cbranch_scc1 ITEM_0_6
    s_cmp_eq_u32 s52, 8
    s_cbranch_scc1 ITEM_0_8
    s_branch ITEM_0_2
.p2align 6
ITEM_0_3:
    s_mov_b64 exec, s[54:55]
    ds_read_u16_d16_hi v243, v250 offset:128
    s_mov_b64 exec, -1
    ds_read_b64_tr_b16 v[76:77], v249 offset:512
    s_waitcnt lgkmcnt(2)
    v_lshlrev_b32 v196, 16, v68
    v_and_b32 v197, 0xffff0000, v68
    v_lshlrev_b32 v198, 16, v69
    v_and_b32 v199, 0xffff0000, v69
    v_mul_f32_dpp v200, v242, v196 row_newbcast:0 row_mask:0xf bank_mask:0xf
    v_mul_f32_dpp v201, v242, v197 row_newbcast:1 row_mask:0xf bank_mask:0xf
    v_mul_f32_dpp v202, v242, v196 row_newbcast:8 row_mask:0xf bank_mask:0xf
    v_mul_f32_dpp v203, v242, v197 row_newbcast:9 row_mask:0xf bank_mask:0xf
    v_lshlrev_b32 v196, 16, v70
    v_and_b32 v197, 0xffff0000, v70
    v_cvt_pk_bf16_f32 v64, v200, v201
    v_cvt_pk_bf16_f32 v68, v202, v203
    v_mul_f32_dpp v200, v242, v198 row_newbcast:2 row_mask:0xf bank_mask:0xf
    v_mul_f32_dpp v201, v242, v199 row_newbcast:3 row_mask:0xf bank_mask:0xf
    v_mul_f32_dpp v202, v242, v198 row_newbcast:10 row_mask:0xf bank_mask:0xf
    v_mul_f32_dpp v203, v242, v199 row_newbcast:11 row_mask:0xf bank_mask:0xf
    v_lshlrev_b32 v198, 16, v71
    v_and_b32 v199, 0xffff0000, v71
    v_cvt_pk_bf16_f32 v65, v200, v201
    v_cvt_pk_bf16_f32 v69, v202, v203
    v_mul_f32_dpp v200, v242, v196 row_newbcast:4 row_mask:0xf bank_mask:0xf
    v_mul_f32_dpp v201, v242, v197 row_newbcast:5 row_mask:0xf bank_mask:0xf
    v_mul_f32_dpp v202, v242, v196 row_newbcast:12 row_mask:0xf bank_mask:0xf
    v_mul_f32_dpp v203, v242, v197 row_newbcast:13 row_mask:0xf bank_mask:0xf
    v_cvt_pk_bf16_f32 v66, v200, v201
    v_cvt_pk_bf16_f32 v70, v202, v203
    v_mul_f32_dpp v200, v242, v198 row_newbcast:6 row_mask:0xf bank_mask:0xf
    v_mul_f32_dpp v201, v242, v199 row_newbcast:7 row_mask:0xf bank_mask:0xf
    v_mul_f32_dpp v202, v242, v198 row_newbcast:14 row_mask:0xf bank_mask:0xf
    v_mul_f32_dpp v203, v242, v199 row_newbcast:15 row_mask:0xf bank_mask:0xf
    v_cvt_pk_bf16_f32 v67, v200, v201
    v_cvt_pk_bf16_f32 v71, v202, v203
    s_nop 0
    s_waitcnt vmcnt(4) lgkmcnt(0)
    v_mfma_f32_32x32x16_bf16 v[0:15], v[64:67], v[176:179], 0
    v_lshlrev_b32 v196, 16, v76
    v_and_b32 v197, 0xffff0000, v76
    v_lshlrev_b32 v198, 16, v77
    v_and_b32 v199, 0xffff0000, v77
    v_mul_f32_dpp v200, v243, v196 row_newbcast:0 row_mask:0xf bank_mask:0xf
    v_mul_f32_dpp v201, v243, v197 row_newbcast:1 row_mask:0xf bank_mask:0xf
    v_mul_f32_dpp v202, v243, v196 row_newbcast:8 row_mask:0xf bank_mask:0xf
    v_mul_f32_dpp v203, v243, v197 row_newbcast:9 row_mask:0xf bank_mask:0xf
    s_add_u32 m0, s21, 0
    v_mfma_f32_32x32x16_bf16 v[16:31], v[68:71], v[176:179], 0
    buffer_load_dwordx4 v234, s[4:7], s36 offen lds
    buffer_load_dwordx4 v235, s[8:11], s36 offen offset:1024 lds
    ds_read_b64_tr_b16 v[176:177], v244 offset:2048
    ds_read_b64_tr_b16 v[184:185], v245 offset:2048
    v_cvt_pk_bf16_f32 v72, v200, v201
    v_cvt_pk_bf16_f32 v76, v202, v203
    v_mul_f32_dpp v200, v243, v198 row_newbcast:2 row_mask:0xf bank_mask:0xf
    v_mul_f32_dpp v201, v243, v199 row_newbcast:3 row_mask:0xf bank_mask:0xf
    v_mul_f32_dpp v202, v243, v198 row_newbcast:10 row_mask:0xf bank_mask:0xf
    v_mul_f32_dpp v203, v243, v199 row_newbcast:11 row_mask:0xf bank_mask:0xf
    v_cvt_pk_bf16_f32 v73, v200, v201
    v_cvt_pk_bf16_f32 v77, v202, v203
    s_nop 0
    s_waitcnt lgkmcnt(0)
    v_mfma_f32_32x32x8_bf16 v[0:15], v[72:73], v[176:177], v[0:15]
    s_add_u32 m0, s21, 2048
    v_mfma_f32_32x32x8_bf16 v[16:31], v[76:77], v[176:177], v[16:31]
    buffer_load_dwordx4 v236, s[4:7], s36 offen lds
    s_mov_b32 m0, s50
    s_nop 0
    s_movrels_b32 s71, s23
    s_bfe_u32 s46, s71, 0x30012
    s_mov_b32 m0, s46
    s_and_b32 s66, s71, 0x3ffff
    s_movrels_b32 s68, s57
    s_movrels_b32 s69, s61
    s_sub_u32 s48, s66, s47
    s_mov_b32 s47, s66
    s_lshr_b32 s52, s71, 28
    s_lshl_b32 s67, s46, 9
    s_add_u32 s66, s66, s67
    s_sub_u32 s49, s66, s42
    s_mov_b32 s42, s66
    s_bfe_u32 s66, s68, 655360
    s_add_u32 s43, s42, s66
    s_bfe_u32 s39, s69, 655360
    s_bfe_u32 s66, s68, 655370
    s_add_u32 s44, s42, s66
    s_bfe_u32 s40, s69, 655370
    s_bfe_u32 s66, s68, 655380
    s_add_u32 s45, s42, s66
    s_bfe_u32 s41, s69, 655380
    s_and_b32 s66, s46, s33
    s_cselect_b32 s72, -1, 1
    s_cselect_b32 s76, s47, 163712
    s_cmp_ge_u32 s66, 2
    s_cselect_b32 s73, -1, 0
    s_add_u32 s77, s47, 1024
    s_cmp_ge_u32 s66, 4
    s_cselect_b32 s75, -1, 0
    s_cmp_ge_u32 s66, 3
    s_cselect_b32 s74, -1, 1
    s_cselect_b32 s77, s77, 163712
    v_add_u32 v252, s44, v247
    ds_read_u16 v238, v252
    ds_read_u16 v239, v252 offset:64
    v_add_u32 v252, s45, v247
    ds_read_u16 v240, v252
    ds_read_u16 v241, v252 offset:64
    v_mfma_f32_32x32x16_bf16 v[32:47], v[64:67], v[180:183], 0
    v_mul_f32 v196, v0, v96
    v_fmac_f32 v196, v1, v97
    v_fmac_f32 v196, v2, v98
    v_fmac_f32 v196, v3, v99
    v_fmac_f32 v196, v4, v100
    v_fmac_f32 v196, v5, v101
    v_fmac_f32 v196, v6, v102
    v_fmac_f32 v196, v7, v103
    v_mul_f32 v198, v8, v128
    v_fmac_f32 v198, v9, v129
    v_mfma_f32_32x32x16_bf16 v[48:63], v[68:71], v[180:183], 0
    v_lshl_add_u32 v253, v248, 2, s47
    ds_read_b32 v254, v253
    ds_read_b32 v255, v253 offset:1024
    s_waitcnt vmcnt(5)
    ds_read_b64_tr_b16 v[176:177], v244 offset:4096
    ds_read_b64_tr_b16 v[178:179], v244 offset:5120
    ds_read_b64_tr_b16 v[180:181], v245 offset:4096
    ds_read_b64_tr_b16 v[182:183], v245 offset:5120
    v_fmac_f32 v198, v10, v130
    v_fmac_f32 v198, v11, v131
    v_fmac_f32 v198, v12, v132
    v_fmac_f32 v198, v13, v133
    v_fmac_f32 v198, v14, v134
    v_fmac_f32 v198, v15, v135
    v_mul_f32 v200, v16, v128
    v_fmac_f32 v200, v17, v129
    v_permlane32_swap_b32 v196, v198
    v_mfma_f32_32x32x8_bf16 v[32:47], v[72:73], v[184:185], v[32:47]
    v_fmac_f32 v200, v18, v130
    v_fmac_f32 v200, v19, v131
    v_fmac_f32 v200, v20, v132
    v_fmac_f32 v200, v21, v133
    v_fmac_f32 v200, v22, v134
    v_fmac_f32 v200, v23, v135
    v_add_f32 v198, v196, v198
    v_mul_f32_e64 v202, v24, -v128
    v_fma_f32 v202, v25, -v129, v202
    v_mfma_f32_32x32x8_bf16 v[48:63], v[76:77], v[184:185], v[48:63]
    v_fma_f32 v202, v26, -v130, v202
    v_fma_f32 v202, v27, -v131, v202
    v_fma_f32 v202, v28, -v132, v202
    v_fma_f32 v202, v29, -v133, v202
    v_fma_f32 v202, v30, -v134, v202
    v_fma_f32 v202, v31, -v135, v202
    s_nop 1
    v_permlane32_swap_b32 v200, v202
    v_add_f32 v202, v200, v202
    s_waitcnt vmcnt(3) lgkmcnt(0)
    v_mfma_f32_32x32x16_bf16 v[0:15], v[64:67], v[176:179], 0
    v_mul_f32 v197, v32, v104
    v_fmac_f32 v197, v33, v105
    v_fmac_f32 v197, v34, v106
    v_fmac_f32 v197, v35, v107
    v_fmac_f32 v197, v36, v108
    v_fmac_f32 v197, v37, v109
    v_fmac_f32 v197, v38, v110
    v_fmac_f32 v197, v39, v111
    v_mul_f32 v199, v40, v136
    v_fmac_f32 v199, v41, v137
    v_fmac_f32 v199, v42, v138
    s_add_u32 m0, s21, 4096
    v_mfma_f32_32x32x16_bf16 v[16:31], v[68:71], v[176:179], 0
    buffer_load_dwordx4 v234, s[4:7], s37 offen lds
    buffer_load_dwordx4 v235, s[8:11], s37 offen offset:1024 lds
    ds_read_b64_tr_b16 v[176:177], v244 offset:6144
    ds_read_b64_tr_b16 v[184:185], v245 offset:6144
    v_add_u32 v252, s42, v247
    ds_read_u16 v234, v252
    ds_read_u16 v235, v252 offset:64
    s_mov_b32 m0, s76
    s_mov_b64 exec, s[72:73]
    buffer_load_dwordx4 v254, s[12:15], 0 offen  lds
    s_mov_b32 m0, s77
    s_mov_b64 exec, s[74:75]
    buffer_load_dwordx4 v255, s[12:15], 0 offen  lds
    s_mov_b64 exec, -1
    v_fmac_f32 v199, v43, v139
    v_fmac_f32 v199, v44, v140
    v_fmac_f32 v199, v45, v141
    v_fmac_f32 v199, v46, v142
    v_fmac_f32 v199, v47, v143
    v_mul_f32 v201, v48, v136
    v_fmac_f32 v201, v49, v137
    v_permlane32_swap_b32 v197, v199
    v_fmac_f32 v201, v50, v138
    v_fmac_f32 v201, v51, v139
    s_waitcnt lgkmcnt(2)
    v_mfma_f32_32x32x8_bf16 v[0:15], v[72:73], v[176:177], v[0:15]
    v_fmac_f32 v201, v52, v140
    v_fmac_f32 v201, v53, v141
    v_fmac_f32 v201, v54, v142
    v_fmac_f32 v201, v55, v143
    v_add_f32 v199, v197, v199
    v_mul_f32_e64 v203, v56, -v136
    v_fma_f32 v203, v57, -v137, v203
    v_fma_f32 v203, v58, -v138, v203
    v_fma_f32 v203, v59, -v139, v203
    v_fma_f32 v203, v60, -v140, v203
    v_fma_f32 v203, v61, -v141, v203
    s_add_u32 m0, s21, 6144
    v_mfma_f32_32x32x8_bf16 v[16:31], v[76:77], v[176:177], v[16:31]
    buffer_load_dwordx4 v236, s[4:7], s37 offen lds
    v_add_u32 v252, s43, v247
    ds_read_u16 v236, v252
    ds_read_u16 v237, v252 offset:64
    v_fma_f32 v203, v62, -v142, v203
    v_fma_f32 v203, v63, -v143, v203
    s_nop 1
    v_permlane32_swap_b32 v201, v203
    v_add_f32 v203, v201, v203
    s_set_gpr_idx_on s51, gpr_idx(DST)
    s_nop 0
    v_cvt_pk_bf16_f32 v204, v198, v199
    v_cvt_pk_bf16_f32 v205, v202, v203
    s_set_gpr_idx_off
    v_mfma_f32_32x32x16_bf16 v[32:47], v[64:67], v[180:183], 0
    v_mul_f32 v196, v0, v144
    v_fmac_f32 v196, v1, v145
    v_fmac_f32 v196, v2, v146
    v_fmac_f32 v196, v3, v147
    v_fmac_f32 v196, v4, v148
    v_fmac_f32 v196, v5, v149
    v_fmac_f32 v196, v6, v150
    v_fmac_f32 v196, v7, v151
    v_mfma_f32_32x32x16_bf16 v[48:63], v[68:71], v[180:183], 0
    s_waitcnt vmcnt(6)
    ds_read_b64_tr_b16 v[176:177], v244 offset:0
    ds_read_b64_tr_b16 v[178:179], v244 offset:1024
    ds_read_b64_tr_b16 v[180:181], v245 offset:0
    ds_read_b64_tr_b16 v[182:183], v245 offset:1024
    v_mul_f32 v198, v8, v112
    v_fmac_f32 v198, v9, v113
    v_fmac_f32 v198, v10, v114
    v_fmac_f32 v198, v11, v115
    v_fmac_f32 v198, v12, v116
    v_fmac_f32 v198, v13, v117
    v_fmac_f32 v198, v14, v118
    v_fmac_f32 v198, v15, v119
    v_mfma_f32_32x32x8_bf16 v[32:47], v[72:73], v[184:185], v[32:47]
    v_mul_f32_e64 v200, v16, -v160
    v_fma_f32 v200, v17, -v161, v200
    v_fma_f32 v200, v18, -v162, v200
    v_fma_f32 v200, v19, -v163, v200
    v_fma_f32 v200, v20, -v164, v200
    v_fma_f32 v200, v21, -v165, v200
    v_fma_f32 v200, v22, -v166, v200
    v_fma_f32 v200, v23, -v167, v200
    v_mfma_f32_32x32x8_bf16 v[48:63], v[76:77], v[184:185], v[48:63]
    v_mul_f32_e64 v202, v24, -v160
    v_fma_f32 v202, v25, -v161, v202
    v_fma_f32 v202, v26, -v162, v202
    v_fma_f32 v202, v27, -v163, v202
    v_fma_f32 v202, v28, -v164, v202
    v_fma_f32 v202, v29, -v165, v202
    v_fma_f32 v202, v30, -v166, v202
    v_fma_f32 v202, v31, -v167, v202
    s_waitcnt vmcnt(5) lgkmcnt(0)
    v_mfma_f32_32x32x16_bf16 v[0:15], v[64:67], v[176:179], 0
    v_mul_f32 v197, v32, v152
    v_fmac_f32 v197, v33, v153
    v_fmac_f32 v197, v34, v154
    v_fmac_f32 v197, v35, v155
    v_fmac_f32 v197, v36, v156
    v_fmac_f32 v197, v37, v157
    v_fmac_f32 v197, v38, v158
    v_fmac_f32 v197, v39, v159
    s_add_u32 m0, s21, 0
    v_mfma_f32_32x32x16_bf16 v[16:31], v[68:71], v[176:179], 0
    v_lshl_add_u32 v234, v234, 10, v246
    v_lshl_add_u32 v235, v235, 10, v246
    buffer_load_dwordx4 v234, s[4:7], s38 offen lds
    buffer_load_dwordx4 v235, s[8:11], s38 offen offset:1024 lds
    ds_read_b64_tr_b16 v[176:177], v244 offset:2048
    ds_read_b64_tr_b16 v[184:185], v245 offset:2048
    v_mul_f32 v199, v40, v120
    v_fmac_f32 v199, v41, v121
    v_fmac_f32 v199, v42, v122
    v_fmac_f32 v199, v43, v123
    v_fmac_f32 v199, v44, v124
    v_fmac_f32 v199, v45, v125
    v_fmac_f32 v199, v46, v126
    v_fmac_f32 v199, v47, v127
    s_waitcnt lgkmcnt(0)
    v_mfma_f32_32x32x8_bf16 v[0:15], v[72:73], v[176:177], v[0:15]
    v_mul_f32_e64 v201, v48, -v168
    v_fma_f32 v201, v49, -v169, v201
    v_fma_f32 v201, v50, -v170, v201
    v_fma_f32 v201, v51, -v171, v201
    v_fma_f32 v201, v52, -v172, v201
    v_fma_f32 v201, v53, -v173, v201
    v_fma_f32 v201, v54, -v174, v201
    v_fma_f32 v201, v55, -v175, v201
    s_add_u32 m0, s21, 2048
    v_mfma_f32_32x32x8_bf16 v[16:31], v[76:77], v[176:177], v[16:31]
    v_lshl_add_u32 v236, v236, 10, v246
    v_lshl_add_u32 v237, v237, 10, v246
    buffer_load_dwordx4 v236, s[4:7], s39 offen lds
    buffer_load_dwordx4 v237, s[8:11], s39 offen offset:1024 lds
    v_mul_f32_e64 v203, v56, -v168
    v_fma_f32 v203, v57, -v169, v203
    v_fma_f32 v203, v58, -v170, v203
    v_fma_f32 v203, v59, -v171, v203
    v_fma_f32 v203, v60, -v172, v203
    v_fma_f32 v203, v61, -v173, v203
    v_fma_f32 v203, v62, -v174, v203
    v_fma_f32 v203, v63, -v175, v203
    v_mfma_f32_32x32x16_bf16 v[32:47], v[64:67], v[180:183], 0
    v_mul_f32 v254, v0, v144
    v_fmac_f32 v254, v1, v145
    v_fmac_f32 v254, v2, v146
    v_fmac_f32 v254, v3, v147
    v_fmac_f32 v254, v4, v148
    v_mfma_f32_32x32x16_bf16 v[48:63], v[68:71], v[180:183], 0
    ds_swizzle_b32 v68, v68 offset:0x401F
    ds_swizzle_b32 v69, v69 offset:0x401F
    ds_swizzle_b32 v70, v70 offset:0x401F
    ds_swizzle_b32 v71, v71 offset:0x401F
    s_waitcnt vmcnt(7)
    ds_read_b64_tr_b16 v[176:177], v244 offset:4096
    ds_read_b64_tr_b16 v[178:179], v244 offset:5120
    ds_read_b64_tr_b16 v[180:181], v245 offset:4096
    ds_read_b64_tr_b16 v[182:183], v245 offset:5120
    v_fmac_f32 v254, v5, v149
    v_fmac_f32 v254, v6, v150
    v_fmac_f32 v254, v7, v151
    v_fmac_f32 v200, v8, v160
    v_mfma_f32_32x32x8_bf16 v[32:47], v[72:73], v[184:185], v[32:47]
    v_fmac_f32 v200, v9, v161
    v_permlane32_swap_b32 v196, v254
    v_fmac_f32 v200, v10, v162
    v_fmac_f32 v200, v11, v163
    v_fmac_f32 v200, v12, v164
    v_mfma_f32_32x32x8_bf16 v[48:63], v[76:77], v[184:185], v[48:63]
    ds_swizzle_b32 v76, v76 offset:0x401F
    ds_swizzle_b32 v77, v77 offset:0x401F
    v_fmac_f32 v200, v13, v165
    v_fmac_f32 v200, v14, v166
    v_fmac_f32 v200, v15, v167
    v_add_f32 v254, v196, v254
    s_waitcnt lgkmcnt(6)
    s_mov_b64 exec, s[56:57]
    v_xor_b32 v68, 0x80008000, v68
    v_xor_b32 v69, 0x80008000, v69
    v_xor_b32 v70, 0x80008000, v70
    v_xor_b32 v71, 0x80008000, v71
    s_mov_b64 exec, -1
    s_waitcnt vmcnt(4) lgkmcnt(2)
    v_mfma_f32_32x32x16_bf16 v[0:15], v[64:67], v[176:179], 0
    v_mul_f32 v255, v32, v152
    v_fmac_f32 v255, v33, v153
    v_fmac_f32 v255, v34, v154
    v_fmac_f32 v255, v35, v155
    v_fmac_f32 v255, v36, v156
    v_fmac_f32 v255, v37, v157
    s_add_u32 m0, s21, 4096
    v_mfma_f32_32x32x16_bf16 v[16:31], v[68:71], v[176:179], v[16:31]
    v_lshl_add_u32 v238, v238, 10, v246
    v_lshl_add_u32 v239, v239, 10, v246
    buffer_load_dwordx4 v238, s[4:7], s40 offen lds
    buffer_load_dwordx4 v239, s[8:11], s40 offen offset:1024 lds
    ds_read_b64_tr_b16 v[176:177], v244 offset:6144
    ds_read_b64_tr_b16 v[184:185], v245 offset:6144
    v_fmac_f32 v255, v38, v158
    v_fmac_f32 v255, v39, v159
    v_fmac_f32 v201, v40, v168
    v_fmac_f32 v201, v41, v169
    v_permlane32_swap_b32 v197, v255
    s_waitcnt lgkmcnt(0)
    s_mov_b64 exec, s[56:57]
    v_xor_b32 v76, 0x80008000, v76
    v_xor_b32 v77, 0x80008000, v77
    s_mov_b64 exec, -1
    v_mfma_f32_32x32x8_bf16 v[0:15], v[72:73], v[176:177], v[0:15]
    v_fmac_f32 v201, v42, v170
    v_fmac_f32 v201, v43, v171
    v_fmac_f32 v201, v44, v172
    v_fmac_f32 v201, v45, v173
    v_fmac_f32 v201, v46, v174
    v_fmac_f32 v201, v47, v175
    s_add_u32 m0, s21, 6144
    v_mfma_f32_32x32x8_bf16 v[16:31], v[76:77], v[176:177], v[16:31]
    v_lshl_add_u32 v240, v240, 10, v246
    v_lshl_add_u32 v241, v241, 10, v246
    buffer_load_dwordx4 v240, s[4:7], s41 offen lds
    buffer_load_dwordx4 v241, s[8:11], s41 offen offset:1024 lds
    v_add_f32 v255, v197, v255
    s_set_gpr_idx_on s51, gpr_idx(DST)
    s_nop 0
    v_cvt_pk_bf16_f32 v206, v254, v255
    s_set_gpr_idx_off
    v_mfma_f32_32x32x16_bf16 v[32:47], v[64:67], v[180:183], 0
    v_mul_f32 v254, v0, v144
    v_fmac_f32 v254, v1, v145
    v_fmac_f32 v254, v2, v146
    v_fmac_f32 v254, v3, v147
    v_fmac_f32 v254, v4, v148
    v_fmac_f32 v254, v5, v149
    v_fmac_f32 v254, v6, v150
    v_fmac_f32 v254, v7, v151
    v_fma_f32 v202, v8, -v160, v202
    v_fma_f32 v202, v9, -v161, v202
    v_mfma_f32_32x32x16_bf16 v[48:63], v[68:71], v[180:183], v[48:63]
    s_waitcnt vmcnt(6)
    ds_read_b64_tr_b16 v[176:177], v244 offset:0
    ds_read_b64_tr_b16 v[178:179], v244 offset:1024
    ds_read_b64_tr_b16 v[180:181], v245 offset:0
    ds_read_b64_tr_b16 v[182:183], v245 offset:1024
    v_permlane32_swap_b32 v254, v200
    v_fma_f32 v202, v10, -v162, v202
    v_fma_f32 v202, v11, -v163, v202
    v_fma_f32 v202, v12, -v164, v202
    v_fma_f32 v202, v13, -v165, v202
    v_fma_f32 v202, v14, -v166, v202
    v_fma_f32 v202, v15, -v167, v202
    v_add_f32 v200, v254, v200
    v_fmac_f32 v198, v16, v112
    v_permlane32_swap_b32 v202, v254
    v_mfma_f32_32x32x8_bf16 v[32:47], v[72:73], v[184:185], v[32:47]
    v_fmac_f32 v198, v17, v113
    v_fmac_f32 v198, v18, v114
    v_fmac_f32 v198, v19, v115
    v_fmac_f32 v198, v20, v116
    v_fmac_f32 v198, v21, v117
    v_fmac_f32 v198, v22, v118
    v_fmac_f32 v198, v23, v119
    v_add_f32 v254, v202, v254
    v_mul_f32 v196, v24, v160
    v_fmac_f32 v196, v25, v161
    v_mfma_f32_32x32x8_bf16 v[48:63], v[76:77], v[184:185], v[48:63]
    v_add_u32 v249, s48, v249
    v_add_u32 v250, s49, v250
    ds_read_b32 v252, v251 offset:16
    ds_read_b64_tr_b16 v[68:69], v249 offset:0
    ds_read_b64_tr_b16 v[70:71], v249 offset:256
    s_mov_b64 exec, s[54:55]
    ds_read_u16_d16_hi v242, v250 offset:0
    s_mov_b64 exec, -1
    v_fmac_f32 v196, v26, v162
    v_fmac_f32 v196, v27, v163
    v_fmac_f32 v196, v28, v164
    v_fmac_f32 v196, v29, v165
    v_fmac_f32 v196, v30, v166
    v_fmac_f32 v196, v31, v167
    s_nop 1
    v_permlane32_swap_b32 v198, v196
    v_add_f32 v196, v198, v196
    v_mul_f32 v255, v32, v152
    v_fmac_f32 v255, v33, v153
    v_fmac_f32 v255, v34, v154
    v_fmac_f32 v255, v35, v155
    v_fmac_f32 v255, v36, v156
    v_fmac_f32 v255, v37, v157
    v_fmac_f32 v255, v38, v158
    v_fmac_f32 v255, v39, v159
    v_fma_f32 v203, v40, -v168, v203
    v_fma_f32 v203, v41, -v169, v203
    v_permlane32_swap_b32 v255, v201
    v_fma_f32 v203, v42, -v170, v203
    v_fma_f32 v203, v43, -v171, v203
    v_fma_f32 v203, v44, -v172, v203
    v_fma_f32 v203, v45, -v173, v203
    v_fma_f32 v203, v46, -v174, v203
    v_fma_f32 v203, v47, -v175, v203
    v_add_f32 v201, v255, v201
    v_fmac_f32 v199, v48, v120
    v_permlane32_swap_b32 v203, v255
    v_fmac_f32 v199, v49, v121
    v_fmac_f32 v199, v50, v122
    v_fmac_f32 v199, v51, v123
    v_fmac_f32 v199, v52, v124
    v_fmac_f32 v199, v53, v125
    v_fmac_f32 v199, v54, v126
    v_fmac_f32 v199, v55, v127
    v_add_f32 v255, v203, v255
    v_mul_f32 v197, v56, v168
    v_fmac_f32 v197, v57, v169
    v_fmac_f32 v197, v58, v170
    v_fmac_f32 v197, v59, v171
    v_fmac_f32 v197, v60, v172
    v_fmac_f32 v197, v61, v173
    v_fmac_f32 v197, v62, v174
    v_fmac_f32 v197, v63, v175
    s_nop 1
    v_permlane32_swap_b32 v199, v197
    v_add_f32 v197, v199, v197
    s_set_gpr_idx_on s51, gpr_idx(DST)
    s_nop 0
    v_cvt_pk_bf16_f32 v207, v200, v201
    v_cvt_pk_bf16_f32 v209, v254, v255
    v_cvt_pk_bf16_f32 v208, v196, v197
    s_set_gpr_idx_off
    s_add_u32 s50, s50, 1
    s_add_u32 s51, s51, 6
    s_cmp_ge_u32 s50, 4
    s_cbranch_scc1 LAST0
    s_waitcnt lgkmcnt(3)
    v_readfirstlane_b32 s66, v252
    s_add_u32 s53, s53, 1
    v_mov_b32 v252, s53
    s_cmp_le_u32 s53, s66
    ds_write2_b32 v251, v252, v252 offset0:0 offset1:8
    s_setprio 1
    s_cbranch_scc1 PRIO_6
    s_setprio 0
PRIO_6:
    s_cmp_eq_u32 s52, 4
    s_cbranch_scc1 ITEM_0_4
    s_cmp_eq_u32 s52, 5
    s_cbranch_scc1 ITEM_0_5
    s_cmp_eq_u32 s52, 3
    s_cbranch_scc1 ITEM_0_3
    s_cmp_eq_u32 s52, 6
    s_cbranch_scc1 ITEM_0_6
    s_cmp_eq_u32 s52, 8
    s_cbranch_scc1 ITEM_0_8
    s_branch ITEM_0_2
.p2align 6
ITEM_0_6:
    s_mov_b64 exec, s[54:55]
    ds_read_u16_d16_hi v243, v250 offset:128
    s_mov_b64 exec, -1
    ds_read_b64_tr_b16 v[76:77], v249 offset:512
    ds_read_b64_tr_b16 v[78:79], v249 offset:768
    ds_read_b64_tr_b16 v[84:85], v249 offset:1024
    ds_read_b64_tr_b16 v[86:87], v249 offset:1280
    s_waitcnt lgkmcnt(5)
    v_lshlrev_b32 v196, 16, v68
    v_and_b32 v197, 0xffff0000, v68
    v_lshlrev_b32 v198, 16, v69
    v_and_b32 v199, 0xffff0000, v69
    v_mul_f32_dpp v200, v242, v196 row_newbcast:0 row_mask:0xf bank_mask:0xf
    v_mul_f32_dpp v201, v242, v197 row_newbcast:1 row_mask:0xf bank_mask:0xf
    v_mul_f32_dpp v202, v242, v196 row_newbcast:8 row_mask:0xf bank_mask:0xf
    v_mul_f32_dpp v203, v242, v197 row_newbcast:9 row_mask:0xf bank_mask:0xf
    v_lshlrev_b32 v196, 16, v70
    v_and_b32 v197, 0xffff0000, v70
    v_cvt_pk_bf16_f32 v64, v200, v201
    v_cvt_pk_bf16_f32 v68, v202, v203
    v_mul_f32_dpp v200, v242, v198 row_newbcast:2 row_mask:0xf bank_mask:0xf
    v_mul_f32_dpp v201, v242, v199 row_newbcast:3 row_mask:0xf bank_mask:0xf
    v_mul_f32_dpp v202, v242, v198 row_newbcast:10 row_mask:0xf bank_mask:0xf
    v_mul_f32_dpp v203, v242, v199 row_newbcast:11 row_mask:0xf bank_mask:0xf
    v_lshlrev_b32 v198, 16, v71
    v_and_b32 v199, 0xffff0000, v71
    v_cvt_pk_bf16_f32 v65, v200, v201
    v_cvt_pk_bf16_f32 v69, v202, v203
    v_mul_f32_dpp v200, v242, v196 row_newbcast:4 row_mask:0xf bank_mask:0xf
    v_mul_f32_dpp v201, v242, v197 row_newbcast:5 row_mask:0xf bank_mask:0xf
    v_mul_f32_dpp v202, v242, v196 row_newbcast:12 row_mask:0xf bank_mask:0xf
    v_mul_f32_dpp v203, v242, v197 row_newbcast:13 row_mask:0xf bank_mask:0xf
    v_cvt_pk_bf16_f32 v66, v200, v201
    v_cvt_pk_bf16_f32 v70, v202, v203
    v_mul_f32_dpp v200, v242, v198 row_newbcast:6 row_mask:0xf bank_mask:0xf
    v_mul_f32_dpp v201, v242, v199 row_newbcast:7 row_mask:0xf bank_mask:0xf
    v_mul_f32_dpp v202, v242, v198 row_newbcast:14 row_mask:0xf bank_mask:0xf
    v_mul_f32_dpp v203, v242, v199 row_newbcast:15 row_mask:0xf bank_mask:0xf
    v_cvt_pk_bf16_f32 v67, v200, v201
    v_cvt_pk_bf16_f32 v71, v202, v203
    s_mov_b64 exec, s[54:55]
    ds_read_u16_d16_hi v242, v250 offset:256
    s_mov_b64 exec, -1
    s_waitcnt vmcnt(4) lgkmcnt(3)
    v_mfma_f32_32x32x16_bf16 v[0:15], v[64:67], v[176:179], 0
    v_lshlrev_b32 v196, 16, v76
    v_and_b32 v197, 0xffff0000, v76
    v_lshlrev_b32 v198, 16, v77
    v_and_b32 v199, 0xffff0000, v77
    v_mul_f32_dpp v200, v243, v196 row_newbcast:0 row_mask:0xf bank_mask:0xf
    v_mul_f32_dpp v201, v243, v197 row_newbcast:1 row_mask:0xf bank_mask:0xf
    v_mul_f32_dpp v202, v243, v196 row_newbcast:8 row_mask:0xf bank_mask:0xf
    v_mul_f32_dpp v203, v243, v197 row_newbcast:9 row_mask:0xf bank_mask:0xf
    v_lshlrev_b32 v196, 16, v78
    v_and_b32 v197, 0xffff0000, v78
    v_cvt_pk_bf16_f32 v72, v200, v201
    v_cvt_pk_bf16_f32 v76, v202, v203
    v_mul_f32_dpp v200, v243, v198 row_newbcast:2 row_mask:0xf bank_mask:0xf
    v_mul_f32_dpp v201, v243, v199 row_newbcast:3 row_mask:0xf bank_mask:0xf
    v_mul_f32_dpp v202, v243, v198 row_newbcast:10 row_mask:0xf bank_mask:0xf
    v_mul_f32_dpp v203, v243, v199 row_newbcast:11 row_mask:0xf bank_mask:0xf
    s_add_u32 m0, s21, 0
    v_mfma_f32_32x32x16_bf16 v[16:31], v[68:71], v[176:179], 0
    buffer_load_dwordx4 v236, s[4:7], s35 offen lds
    buffer_load_dwordx4 v237, s[8:11], s35 offen offset:1024 lds
    ds_read_b64_tr_b16 v[176:177], v244 offset:2048
    ds_read_b64_tr_b16 v[178:179], v244 offset:3072
    ds_read_b64_tr_b16 v[184:185], v245 offset:2048
    ds_read_b64_tr_b16 v[186:187], v245 offset:3072
    v_lshlrev_b32 v198, 16, v79
    v_and_b32 v199, 0xffff0000, v79
    v_cvt_pk_bf16_f32 v73, v200, v201
    v_cvt_pk_bf16_f32 v77, v202, v203
    v_mul_f32_dpp v200, v243, v196 row_newbcast:4 row_mask:0xf bank_mask:0xf
    v_mul_f32_dpp v201, v243, v197 row_newbcast:5 row_mask:0xf bank_mask:0xf
    v_mul_f32_dpp v202, v243, v196 row_newbcast:12 row_mask:0xf bank_mask:0xf
    v_mul_f32_dpp v203, v243, v197 row_newbcast:13 row_mask:0xf bank_mask:0xf
    v_cvt_pk_bf16_f32 v74, v200, v201
    v_cvt_pk_bf16_f32 v78, v202, v203
    v_mul_f32_dpp v200, v243, v198 row_newbcast:6 row_mask:0xf bank_mask:0xf
    v_mul_f32_dpp v201, v243, v199 row_newbcast:7 row_mask:0xf bank_mask:0xf
    v_mul_f32_dpp v202, v243, v198 row_newbcast:14 row_mask:0xf bank_mask:0xf
    v_mul_f32_dpp v203, v243, v199 row_newbcast:15 row_mask:0xf bank_mask:0xf
    v_cvt_pk_bf16_f32 v75, v200, v201
    v_cvt_pk_bf16_f32 v79, v202, v203
    s_nop 0
    s_waitcnt vmcnt(4) lgkmcnt(0)
    v_mfma_f32_32x32x16_bf16 v[0:15], v[72:75], v[176:179], v[0:15]
    v_lshlrev_b32 v196, 16, v84
    v_and_b32 v197, 0xffff0000, v84
    v_lshlrev_b32 v198, 16, v85
    v_and_b32 v199, 0xffff0000, v85
    v_mul_f32_dpp v200, v242, v196 row_newbcast:0 row_mask:0xf bank_mask:0xf
    v_mul_f32_dpp v201, v242, v197 row_newbcast:1 row_mask:0xf bank_mask:0xf
    v_mul_f32_dpp v202, v242, v196 row_newbcast:8 row_mask:0xf bank_mask:0xf
    v_mul_f32_dpp v203, v242, v197 row_newbcast:9 row_mask:0xf bank_mask:0xf
    v_lshlrev_b32 v196, 16, v86
    v_and_b32 v197, 0xffff0000, v86
    v_cvt_pk_bf16_f32 v80, v200, v201
    v_cvt_pk_bf16_f32 v84, v202, v203
    v_mul_f32_dpp v200, v242, v198 row_newbcast:2 row_mask:0xf bank_mask:0xf
    v_mul_f32_dpp v201, v242, v199 row_newbcast:3 row_mask:0xf bank_mask:0xf
    v_mul_f32_dpp v202, v242, v198 row_newbcast:10 row_mask:0xf bank_mask:0xf
    v_mul_f32_dpp v203, v242, v199 row_newbcast:11 row_mask:0xf bank_mask:0xf
    s_add_u32 m0, s21, 2048
    v_mfma_f32_32x32x16_bf16 v[16:31], v[76:79], v[176:179], v[16:31]
    buffer_load_dwordx4 v238, s[4:7], s35 offen lds
    buffer_load_dwordx4 v239, s[8:11], s35 offen offset:1024 lds
    ds_read_b64_tr_b16 v[176:177], v244 offset:4096
    ds_read_b64_tr_b16 v[178:179], v244 offset:5120
    ds_read_b64_tr_b16 v[188:189], v245 offset:4096
    ds_read_b64_tr_b16 v[190:191], v245 offset:5120
    v_lshlrev_b32 v198, 16, v87
    v_and_b32 v199, 0xffff0000, v87
    v_cvt_pk_bf16_f32 v81, v200, v201
    v_cvt_pk_bf16_f32 v85, v202, v203
    v_mul_f32_dpp v200, v242, v196 row_newbcast:4 row_mask:0xf bank_mask:0xf
    v_mul_f32_dpp v201, v242, v197 row_newbcast:5 row_mask:0xf bank_mask:0xf
    v_mul_f32_dpp v202, v242, v196 row_newbcast:12 row_mask:0xf bank_mask:0xf
    v_mul_f32_dpp v203, v242, v197 row_newbcast:13 row_mask:0xf bank_mask:0xf
    v_cvt_pk_bf16_f32 v82, v200, v201
    v_cvt_pk_bf16_f32 v86, v202, v203
    v_mul_f32_dpp v200, v242, v198 row_newbcast:6 row_mask:0xf bank_mask:0xf
    v_mul_f32_dpp v201, v242, v199 row_newbcast:7 row_mask:0xf bank_mask:0xf
    v_mul_f32_dpp v202, v242, v198 row_newbcast:14 row_mask:0xf bank_mask:0xf
    v_mul_f32_dpp v203, v242, v199 row_newbcast:15 row_mask:0xf bank_mask:0xf
    v_cvt_pk_bf16_f32 v83, v200, v201
    v_cvt_pk_bf16_f32 v87, v202, v203
    s_nop 0
    s_waitcnt lgkmcnt(0)
    v_mfma_f32_32x32x16_bf16 v[0:15], v[80:83], v[176:179], v[0:15]
    s_add_u32 m0, s21, 4096
    v_mfma_f32_32x32x16_bf16 v[16:31], v[84:87], v[176:179], v[16:31]
    buffer_load_dwordx4 v234, s[4:7], s36 offen lds
    buffer_load_dwordx4 v235, s[8:11], s36 offen offset:1024 lds
    s_mov_b32 m0, s50
    s_nop 0
    s_movrels_b32 s71, s23
    s_bfe_u32 s46, s71, 0x30012
    s_mov_b32 m0, s46
    s_and_b32 s66, s71, 0x3ffff
    s_movrels_b32 s68, s57
    s_movrels_b32 s69, s61
    s_sub_u32 s48, s66, s47
    s_mov_b32 s47, s66
    s_lshr_b32 s52, s71, 28
    s_lshl_b32 s67, s46, 9
    s_add_u32 s66, s66, s67
    s_sub_u32 s49, s66, s42
    s_mov_b32 s42, s66
    s_bfe_u32 s66, s68, 655360
    s_add_u32 s43, s42, s66
    s_bfe_u32 s39, s69, 655360
    s_bfe_u32 s66, s68, 655370
    s_add_u32 s44, s42, s66
    s_bfe_u32 s40, s69, 655370
    s_bfe_u32 s66, s68, 655380
    s_add_u32 s45, s42, s66
    s_bfe_u32 s41, s69, 655380
    s_and_b32 s66, s46, s33
    s_cselect_b32 s72, -1, 1
    s_cselect_b32 s76, s47, 163712
    s_cmp_ge_u32 s66, 2
    s_cselect_b32 s73, -1, 0
    s_add_u32 s77, s47, 1024
    s_cmp_ge_u32 s66, 4
    s_cselect_b32 s75, -1, 0
    s_cmp_ge_u32 s66, 3
    s_cselect_b32 s74, -1, 1
    s_cselect_b32 s77, s77, 163712
    v_add_u32 v252, s45, v247
    ds_read_u16 v240, v252
    ds_read_u16 v241, v252 offset:64
    v_mfma_f32_32x32x16_bf16 v[32:47], v[64:67], v[180:183], 0
    v_mul_f32 v196, v0, v96
    v_fmac_f32 v196, v1, v97
    v_fmac_f32 v196, v2, v98
    v_fmac_f32 v196, v3, v99
    v_fmac_f32 v196, v4, v100
    v_fmac_f32 v196, v5, v101
    v_fmac_f32 v196, v6, v102
    v_mfma_f32_32x32x16_bf16 v[48:63], v[68:71], v[180:183], 0
    v_lshl_add_u32 v253, v248, 2, s47
    ds_read_b32 v254, v253
    ds_read_b32 v255, v253 offset:1024
    v_fmac_f32 v196, v7, v103
    v_mul_f32 v198, v8, v128
    v_fmac_f32 v198, v9, v129
    v_fmac_f32 v198, v10, v130
    v_fmac_f32 v198, v11, v131
    v_fmac_f32 v198, v12, v132
    v_mfma_f32_32x32x16_bf16 v[32:47], v[72:75], v[184:187], v[32:47]
    v_fmac_f32 v198, v13, v133
    v_fmac_f32 v198, v14, v134
    v_fmac_f32 v198, v15, v135
    v_mul_f32 v200, v16, v128
    v_fmac_f32 v200, v17, v129
    v_permlane32_swap_b32 v196, v198
    v_mfma_f32_32x32x16_bf16 v[48:63], v[76:79], v[184:187], v[48:63]
    s_waitcnt vmcnt(6)
    ds_read_b64_tr_b16 v[176:177], v244 offset:6144
    ds_read_b64_tr_b16 v[178:179], v244 offset:7168
    ds_read_b64_tr_b16 v[180:181], v245 offset:6144
    ds_read_b64_tr_b16 v[182:183], v245 offset:7168
    v_fmac_f32 v200, v18, v130
    v_fmac_f32 v200, v19, v131
    v_fmac_f32 v200, v20, v132
    v_fmac_f32 v200, v21, v133
    v_fmac_f32 v200, v22, v134
    v_fmac_f32 v200, v23, v135
    v_mfma_f32_32x32x16_bf16 v[32:47], v[80:83], v[188:191], v[32:47]
    v_add_f32 v198, v196, v198
    v_mul_f32_e64 v202, v24, -v128
    v_fma_f32 v202, v25, -v129, v202
    v_fma_f32 v202, v26, -v130, v202
    v_fma_f32 v202, v27, -v131, v202
    v_fma_f32 v202, v28, -v132, v202
    v_mfma_f32_32x32x16_bf16 v[48:63], v[84:87], v[188:191], v[48:63]
    v_fma_f32 v202, v29, -v133, v202
    v_fma_f32 v202, v30, -v134, v202
    v_fma_f32 v202, v31, -v135, v202
    s_nop 1
    v_permlane32_swap_b32 v200, v202
    v_add_f32 v202, v200, v202
    s_waitcnt vmcnt(4) lgkmcnt(0)
    v_mfma_f32_32x32x16_bf16 v[0:15], v[64:67], v[176:179], 0
    v_mul_f32 v197, v32, v104
    v_fmac_f32 v197, v33, v105
    v_fmac_f32 v197, v34, v106
    v_fmac_f32 v197, v35, v107
    v_fmac_f32 v197, v36, v108
    v_fmac_f32 v197, v37, v109
    v_fmac_f32 v197, v38, v110
    s_add_u32 m0, s21, 6144
    v_mfma_f32_32x32x16_bf16 v[16:31], v[68:71], v[176:179], 0
    buffer_load_dwordx4 v236, s[4:7], s36 offen lds
    buffer_load_dwordx4 v237, s[8:11], s36 offen offset:1024 lds
    ds_read_b64_tr_b16 v[176:177], v244 offset:0
    ds_read_b64_tr_b16 v[178:179], v244 offset:1024
    ds_read_b64_tr_b16 v[184:185], v245 offset:0
    ds_read_b64_tr_b16 v[186:187], v245 offset:1024
    s_mov_b32 m0, s76
    s_mov_b64 exec, s[72:73]
    buffer_load_dwordx4 v254, s[12:15], 0 offen  lds
    s_mov_b32 m0, s77
    s_mov_b64 exec, s[74:75]
    buffer_load_dwordx4 v255, s[12:15], 0 offen  lds
    s_mov_b64 exec, -1
    v_fmac_f32 v197, v39, v111
    v_mul_f32 v199, v40, v136
    v_fmac_f32 v199, v41, v137
    v_fmac_f32 v199, v42, v138
    v_fmac_f32 v199, v43, v139
    v_fmac_f32 v199, v44, v140
    v_fmac_f32 v199, v45, v141
    s_waitcnt vmcnt(6) lgkmcnt(0)
    v_mfma_f32_32x32x16_bf16 v[0:15], v[72:75], v[176:179], v[0:15]
    v_fmac_f32 v199, v46, v142
    v_fmac_f32 v199, v47, v143
    v_mul_f32 v201, v48, v136
    v_fmac_f32 v201, v49, v137
    v_permlane32_swap_b32 v197, v199
    v_fmac_f32 v201, v50, v138
    v_fmac_f32 v201, v51, v139
    s_add_u32 m0, s21, 0
    v_mfma_f32_32x32x16_bf16 v[16:31], v[76:79], v[176:179], v[16:31]
    buffer_load_dwordx4 v238, s[4:7], s36 offen lds
    buffer_load_dwordx4 v239, s[8:11], s36 offen offset:1024 lds
    ds_read_b64_tr_b16 v[176:177], v244 offset:2048
    ds_read_b64_tr_b16 v[178:179], v244 offset:3072
    ds_read_b64_tr_b16 v[188:189], v245 offset:2048
    ds_read_b64_tr_b16 v[190:191], v245 offset:3072
    v_fmac_f32 v201, v52, v140
    v_fmac_f32 v201, v53, v141
    v_fmac_f32 v201, v54, v142
    v_fmac_f32 v201, v55, v143
    v_add_f32 v199, v197, v199
    v_mul_f32_e64 v203, v56, -v136
    v_fma_f32 v203, v57, -v137, v203
    s_waitcnt lgkmcnt(0)
    v_mfma_f32_32x32x16_bf16 v[0:15], v[80:83], v[176:179], v[0:15]
    v_fma_f32 v203, v58, -v138, v203
    v_fma_f32 v203, v59, -v139, v203
    v_fma_f32 v203, v60, -v140, v203
    v_fma_f32 v203, v61, -v141, v203
    v_fma_f32 v203, v62, -v142, v203
    v_fma_f32 v203, v63, -v143, v203
    s_nop 1
    s_add_u32 m0, s21, 2048
    v_mfma_f32_32x32x16_bf16 v[16:31], v[84:87], v[176:179], v[16:31]
    buffer_load_dwordx4 v234, s[4:7], s37 offen lds
    buffer_load_dwordx4 v235, s[8:11], s37 offen offset:1024 lds
    v_add_u32 v252, s42, v247
    ds_read_u16 v234, v252
    ds_read_u16 v235, v252 offset:64
    v_permlane32_swap_b32 v201, v203
    v_add_f32 v203, v201, v203
    s_set_gpr_idx_on s51, gpr_idx(DST)
    s_nop 0
    v_cvt_pk_bf16_f32 v204, v198, v199
    v_cvt_pk_bf16_f32 v205, v202, v203
    s_set_gpr_idx_off
    v_mfma_f32_32x32x16_bf16 v[32:47], v[64:67], v[180:183], 0
    v_mul_f32 v196, v0, v144
    v_fmac_f32 v196, v1, v145
    v_fmac_f32 v196, v2, v146
    v_fmac_f32 v196, v3, v147
    v_fmac_f32 v196, v4, v148
    v_fmac_f32 v196, v5, v149
    v_mfma_f32_32x32x16_bf16 v[48:63], v[68:71], v[180:183], 0
    v_fmac_f32 v196, v6, v150
    v_fmac_f32 v196, v7, v151
    v_mul_f32 v198, v8, v112
    v_fmac_f32 v198, v9, v113
    v_fmac_f32 v198, v10, v114
    v_mfma_f32_32x32x16_bf16 v[32:47], v[72:75], v[184:187], v[32:47]
    v_fmac_f32 v198, v11, v115
    v_fmac_f32 v198, v12, v116
    v_fmac_f32 v198, v13, v117
    v_fmac_f32 v198, v14, v118
    v_fmac_f32 v198, v15, v119
    v_mfma_f32_32x32x16_bf16 v[48:63], v[76:79], v[184:187], v[48:63]
    s_waitcnt vmcnt(8)
    ds_read_b64_tr_b16 v[176:177], v244 offset:4096
    ds_read_b64_tr_b16 v[178:179], v244 offset:5120
    ds_read_b64_tr_b16 v[180:181], v245 offset:4096
    ds_read_b64_tr_b16 v[182:183], v245 offset:5120
    v_mul_f32_e64 v200, v16, -v160
    v_fma_f32 v200, v17, -v161, v200
    v_fma_f32 v200, v18, -v162, v200
    v_fma_f32 v200, v19, -v163, v200
    v_fma_f32 v200, v20, -v164, v200
    v_fma_f32 v200, v21, -v165, v200
    v_mfma_f32_32x32x16_bf16 v[32:47], v[80:83], v[188:191], v[32:47]
    v_fma_f32 v200, v22, -v166, v200
    v_fma_f32 v200, v23, -v167, v200
    v_mul_f32_e64 v202, v24, -v160
    v_fma_f32 v202, v25, -v161, v202
    v_fma_f32 v202, v26, -v162, v202
    v_mfma_f32_32x32x16_bf16 v[48:63], v[84:87], v[188:191], v[48:63]
    v_fma_f32 v202, v27, -v163, v202
    v_fma_f32 v202, v28, -v164, v202
    v_fma_f32 v202, v29, -v165, v202
    v_fma_f32 v202, v30, -v166, v202
    v_fma_f32 v202, v31, -v167, v202
    s_waitcnt vmcnt(6) lgkmcnt(0)
    v_mfma_f32_32x32x16_bf16 v[0:15], v[64:67], v[176:179], 0
    v_mul_f32 v197, v32, v152
    v_fmac_f32 v197, v33, v153
    v_fmac_f32 v197, v34, v154
    v_fmac_f32 v197, v35, v155
    v_fmac_f32 v197, v36, v156
    v_fmac_f32 v197, v37, v157
    s_add_u32 m0, s21, 4096
    v_mfma_f32_32x32x16_bf16 v[16:31], v[68:71], v[176:179], 0
    buffer_load_dwordx4 v236, s[4:7], s37 offen lds
    buffer_load_dwordx4 v237, s[8:11], s37 offen offset:1024 lds
    ds_read_b64_tr_b16 v[176:177], v244 offset:6144
    ds_read_b64_tr_b16 v[178:179], v244 offset:7168
    ds_read_b64_tr_b16 v[184:185], v245 offset:6144
    ds_read_b64_tr_b16 v[186:187], v245 offset:7168
    v_add_u32 v252, s43, v247
    ds_read_u16 v236, v252
    ds_read_u16 v237, v252 offset:64
    v_fmac_f32 v197, v38, v158
    v_fmac_f32 v197, v39, v159
    v_mul_f32 v199, v40, v120
    v_fmac_f32 v199, v41, v121
    v_fmac_f32 v199, v42, v122
    s_waitcnt vmcnt(4) lgkmcnt(2)
    v_mfma_f32_32x32x16_bf16 v[0:15], v[72:75], v[176:179], v[0:15]
    v_fmac_f32 v199, v43, v123
    v_fmac_f32 v199, v44, v124
    v_fmac_f32 v199, v45, v125
    v_fmac_f32 v199, v46, v126
    v_fmac_f32 v199, v47, v127
    s_add_u32 m0, s21, 6144
    v_mfma_f32_32x32x16_bf16 v[16:31], v[76:79], v[176:179], v[16:31]
    buffer_load_dwordx4 v238, s[4:7], s37 offen lds
    buffer_load_dwordx4 v239, s[8:11], s37 offen offset:1024 lds
    ds_read_b64_tr_b16 v[176:177], v244 offset:0
    ds_read_b64_tr_b16 v[178:179], v244 offset:1024
    ds_read_b64_tr_b16 v[188:189], v245 offset:0
    ds_read_b64_tr_b16 v[190:191], v245 offset:1024
    v_add_u32 v252, s44, v247
    ds_read_u16 v238, v252
    ds_read_u16 v239, v252 offset:64
    v_mul_f32_e64 v201, v48, -v168
    v_fma_f32 v201, v49, -v169, v201
    v_fma_f32 v201, v50, -v170, v201
    v_fma_f32 v201, v51, -v171, v201
    v_fma_f32 v201, v52, -v172, v201
    v_fma_f32 v201, v53, -v173, v201
    s_waitcnt lgkmcnt(2)
    v_mfma_f32_32x32x16_bf16 v[0:15], v[80:83], v[176:179], v[0:15]
    v_fma_f32 v201, v54, -v174, v201
    v_fma_f32 v201, v55, -v175, v201
    v_mul_f32_e64 v203, v56, -v168
    v_fma_f32 v203, v57, -v169, v203
    v_fma_f32 v203, v58, -v170, v203
    s_add_u32 m0, s21, 0
    v_mfma_f32_32x32x16_bf16 v[16:31], v[84:87], v[176:179], v[16:31]
    v_lshl_add_u32 v234, v234, 10, v246
    v_lshl_add_u32 v235, v235, 10, v246
    buffer_load_dwordx4 v234, s[4:7], s38 offen lds
    buffer_load_dwordx4 v235, s[8:11], s38 offen offset:1024 lds
    v_fma_f32 v203, v59, -v171, v203
    v_fma_f32 v203, v60, -v172, v203
    v_fma_f32 v203, v61, -v173, v203
    v_fma_f32 v203, v62, -v174, v203
    v_fma_f32 v203, v63, -v175, v203
    v_mfma_f32_32x32x16_bf16 v[32:47], v[64:67], v[180:183], 0
    v_mul_f32 v254, v0, v144
    v_fmac_f32 v254, v1, v145
    v_fmac_f32 v254, v2, v146
    v_mfma_f32_32x32x16_bf16 v[48:63], v[68:71], v[180:183], 0
    ds_swizzle_b32 v68, v68 offset:0x401F
    ds_swizzle_b32 v69, v69 offset:0x401F
    ds_swizzle_b32 v70, v70 offset:0x401F
    ds_swizzle_b32 v71, v71 offset:0x401F
    v_fmac_f32 v254, v3, v147
    v_fmac_f32 v254, v4, v148
    v_fmac_f32 v254, v5, v149
    v_mfma_f32_32x32x16_bf16 v[32:47], v[72:75], v[184:187], v[32:47]
    v_fmac_f32 v254, v6, v150
    v_fmac_f32 v254, v7, v151
    v_fmac_f32 v200, v8, v160
    v_mfma_f32_32x32x16_bf16 v[48:63], v[76:79], v[184:187], v[48:63]
    ds_swizzle_b32 v76, v76 offset:0x401F
    ds_swizzle_b32 v77, v77 offset:0x401F
    ds_swizzle_b32 v78, v78 offset:0x401F
    ds_swizzle_b32 v79, v79 offset:0x401F
    s_waitcnt vmcnt(6)
    ds_read_b64_tr_b16 v[176:177], v244 offset:2048
    ds_read_b64_tr_b16 v[178:179], v244 offset:3072
    ds_read_b64_tr_b16 v[180:181], v245 offset:2048
    ds_read_b64_tr_b16 v[182:183], v245 offset:3072
    v_fmac_f32 v200, v9, v161
    v_permlane32_swap_b32 v196, v254
    v_fmac_f32 v200, v10, v162
    v_mfma_f32_32x32x16_bf16 v[32:47], v[80:83], v[188:191], v[32:47]
    v_fmac_f32 v200, v11, v163
    v_fmac_f32 v200, v12, v164
    v_fmac_f32 v200, v13, v165
    v_mfma_f32_32x32x16_bf16 v[48:63], v[84:87], v[188:191], v[48:63]
    ds_swizzle_b32 v84, v84 offset:0x401F
    ds_swizzle_b32 v85, v85 offset:0x401F
    ds_swizzle_b32 v86, v86 offset:0x401F
    ds_swizzle_b32 v87, v87 offset:0x401F
    v_fmac_f32 v200, v14, v166
    v_fmac_f32 v200, v15, v167
    v_add_f32 v254, v196, v254
    s_waitcnt lgkmcnt(8)
    s_mov_b64 exec, s[56:57]
    v_xor_b32 v68, 0x80008000, v68
    v_xor_b32 v69, 0x80008000, v69
    v_xor_b32 v70, 0x80008000, v70
    v_xor_b32 v71, 0x80008000, v71
    v_xor_b32 v76, 0x80008000, v76
    v_xor_b32 v77, 0x80008000, v77
    v_xor_b32 v78, 0x80008000, v78
    v_xor_b32 v79, 0x80008000, v79
    s_mov_b64 exec, -1
    s_waitcnt vmcnt(4) lgkmcnt(4)
    v_mfma_f32_32x32x16_bf16 v[0:15], v[64:67], v[176:179], 0
    v_mul_f32 v255, v32, v152
    v_fmac_f32 v255, v33, v153
    v_fmac_f32 v255, v34, v154
    v_fmac_f32 v255, v35, v155
    s_add_u32 m0, s21, 2048
    v_mfma_f32_32x32x16_bf16 v[16:31], v[68:71], v[176:179], v[16:31]
    v_lshl_add_u32 v236, v236, 10, v246
    v_lshl_add_u32 v237, v237, 10, v246
    buffer_load_dwordx4 v236, s[4:7], s39 offen lds
    buffer_load_dwordx4 v237, s[8:11], s39 offen offset:1024 lds
    ds_read_b64_tr_b16 v[176:177], v244 offset:4096
    ds_read_b64_tr_b16 v[178:179], v244 offset:5120
    ds_read_b64_tr_b16 v[184:185], v245 offset:4096
    ds_read_b64_tr_b16 v[186:187], v245 offset:5120
    v_fmac_f32 v255, v36, v156
    v_fmac_f32 v255, v37, v157
    v_fmac_f32 v255, v38, v158
    v_fmac_f32 v255, v39, v159
    s_waitcnt vmcnt(4) lgkmcnt(0)
    v_mfma_f32_32x32x16_bf16 v[0:15], v[72:75], v[176:179], v[0:15]
    v_fmac_f32 v201, v40, v168
    v_fmac_f32 v201, v41, v169
    v_permlane32_swap_b32 v197, v255
    s_add_u32 m0, s21, 4096
    v_mfma_f32_32x32x16_bf16 v[16:31], v[76:79], v[176:179], v[16:31]
    v_lshl_add_u32 v238, v238, 10, v246
    v_lshl_add_u32 v239, v239, 10, v246
    buffer_load_dwordx4 v238, s[4:7], s40 offen lds
    buffer_load_dwordx4 v239, s[8:11], s40 offen offset:1024 lds
    ds_read_b64_tr_b16 v[176:177], v244 offset:6144
    ds_read_b64_tr_b16 v[178:179], v244 offset:7168
    ds_read_b64_tr_b16 v[188:189], v245 offset:6144
    ds_read_b64_tr_b16 v[190:191], v245 offset:7168
    v_fmac_f32 v201, v42, v170
    v_fmac_f32 v201, v43, v171
    v_fmac_f32 v201, v44, v172
    v_fmac_f32 v201, v45, v173
    s_waitcnt lgkmcnt(0)
    s_mov_b64 exec, s[56:57]
    v_xor_b32 v84, 0x80008000, v84
    v_xor_b32 v85, 0x80008000, v85
    v_xor_b32 v86, 0x80008000, v86
    v_xor_b32 v87, 0x80008000, v87
    s_mov_b64 exec, -1
    v_mfma_f32_32x32x16_bf16 v[0:15], v[80:83], v[176:179], v[0:15]
    v_fmac_f32 v201, v46, v174
    v_fmac_f32 v201, v47, v175
    v_add_f32 v255, v197, v255
    s_set_gpr_idx_on s51, gpr_idx(DST)
    s_nop 0
    v_cvt_pk_bf16_f32 v206, v254, v255
    s_set_gpr_idx_off
    s_add_u32 m0, s21, 6144
    v_mfma_f32_32x32x16_bf16 v[16:31], v[84:87], v[176:179], v[16:31]
    v_lshl_add_u32 v240, v240, 10, v246
    v_lshl_add_u32 v241, v241, 10, v246
    buffer_load_dwordx4 v240, s[4:7], s41 offen lds
    buffer_load_dwordx4 v241, s[8:11], s41 offen offset:1024 lds
    v_mfma_f32_32x32x16_bf16 v[32:47], v[64:67], v[180:183], 0
    v_mul_f32 v254, v0, v144
    v_fmac_f32 v254, v1, v145
    v_fmac_f32 v254, v2, v146
    v_fmac_f32 v254, v3, v147
    v_fmac_f32 v254, v4, v148
    v_fmac_f32 v254, v5, v149
    v_fmac_f32 v254, v6, v150
    v_mfma_f32_32x32x16_bf16 v[48:63], v[68:71], v[180:183], v[48:63]
    v_fmac_f32 v254, v7, v151
    v_fma_f32 v202, v8, -v160, v202
    v_fma_f32 v202, v9, -v161, v202
    v_permlane32_swap_b32 v254, v200
    v_fma_f32 v202, v10, -v162, v202
    v_fma_f32 v202, v11, -v163, v202
    v_mfma_f32_32x32x16_bf16 v[32:47], v[72:75], v[184:187], v[32:47]
    v_fma_f32 v202, v12, -v164, v202
    v_fma_f32 v202, v13, -v165, v202
    v_fma_f32 v202, v14, -v166, v202
    v_fma_f32 v202, v15, -v167, v202
    v_add_f32 v200, v254, v200
    v_fmac_f32 v198, v16, v112
    v_permlane32_swap_b32 v202, v254
    v_mfma_f32_32x32x16_bf16 v[48:63], v[76:79], v[184:187], v[48:63]
    s_waitcnt vmcnt(6)
    ds_read_b64_tr_b16 v[176:177], v244 offset:0
    ds_read_b64_tr_b16 v[178:179], v244 offset:1024
    ds_read_b64_tr_b16 v[180:181], v245 offset:0
    ds_read_b64_tr_b16 v[182:183], v245 offset:1024
    v_fmac_f32 v198, v17, v113
    v_fmac_f32 v198, v18, v114
    v_fmac_f32 v198, v19, v115
    v_fmac_f32 v198, v20, v116
    v_fmac_f32 v198, v21, v117
    v_fmac_f32 v198, v22, v118
    v_mfma_f32_32x32x16_bf16 v[32:47], v[80:83], v[188:191], v[32:47]
    v_fmac_f32 v198, v23, v119
    v_add_f32 v254, v202, v254
    v_mul_f32 v196, v24, v160
    v_fmac_f32 v196, v25, v161
    v_fmac_f32 v196, v26, v162
    v_fmac_f32 v196, v27, v163
    v_fmac_f32 v196, v28, v164
    v_mfma_f32_32x32x16_bf16 v[48:63], v[84:87], v[188:191], v[48:63]
    v_add_u32 v249, s48, v249
    v_add_u32 v250, s49, v250
    ds_read_b32 v252, v251 offset:16
    ds_read_b64_tr_b16 v[68:69], v249 offset:0
    ds_read_b64_tr_b16 v[70:71], v249 offset:256
    s_mov_b64 exec, s[54:55]
    ds_read_u16_d16_hi v242, v250 offset:0
    s_mov_b64 exec, -1
    v_fmac_f32 v196, v29, v165
    v_fmac_f32 v196, v30, v166
    v_fmac_f32 v196, v31, v167
    s_nop 1
    v_permlane32_swap_b32 v198, v196
    v_add_f32 v196, v198, v196
    v_mul_f32 v255, v32, v152
    v_fmac_f32 v255, v33, v153
    v_fmac_f32 v255, v34, v154
    v_fmac_f32 v255, v35, v155
    v_fmac_f32 v255, v36, v156
    v_fmac_f32 v255, v37, v157
    v_fmac_f32 v255, v38, v158
    v_fmac_f32 v255, v39, v159
    v_fma_f32 v203, v40, -v168, v203
    v_fma_f32 v203, v41, -v169, v203
    v_permlane32_swap_b32 v255, v201
    v_fma_f32 v203, v42, -v170, v203
    v_fma_f32 v203, v43, -v171, v203
    v_fma_f32 v203, v44, -v172, v203
    v_fma_f32 v203, v45, -v173, v203
    v_fma_f32 v203, v46, -v174, v203
    v_fma_f32 v203, v47, -v175, v203
    v_add_f32 v201, v255, v201
    v_fmac_f32 v199, v48, v120
    v_permlane32_swap_b32 v203, v255
    v_fmac_f32 v199, v49, v121
    v_fmac_f32 v199, v50, v122
    v_fmac_f32 v199, v51, v123
    v_fmac_f32 v199, v52, v124
    v_fmac_f32 v199, v53, v125
    v_fmac_f32 v199, v54, v126
    v_fmac_f32 v199, v55, v127
    v_add_f32 v255, v203, v255
    v_mul_f32 v197, v56, v168
    v_fmac_f32 v197, v57, v169
    v_fmac_f32 v197, v58, v170
    v_fmac_f32 v197, v59, v171
    v_fmac_f32 v197, v60, v172
    v_fmac_f32 v197, v61, v173
    v_fmac_f32 v197, v62, v174
    v_fmac_f32 v197, v63, v175
    s_nop 1
    v_permlane32_swap_b32 v199, v197
    v_add_f32 v197, v199, v197
    s_set_gpr_idx_on s51, gpr_idx(DST)
    s_nop 0
    v_cvt_pk_bf16_f32 v207, v200, v201
    v_cvt_pk_bf16_f32 v209, v254, v255
    v_cvt_pk_bf16_f32 v208, v196, v197
    s_set_gpr_idx_off
    s_add_u32 s50, s50, 1
    s_add_u32 s51, s51, 6
    s_cmp_ge_u32 s50, 4
    s_cbranch_scc1 LAST0
    s_waitcnt lgkmcnt(3)
    v_readfirstlane_b32 s66, v252
    s_add_u32 s53, s53, 1
    v_mov_b32 v252, s53
    s_cmp_le_u32 s53, s66
    ds_write2_b32 v251, v252, v252 offset0:0 offset1:8
    s_setprio 1
    s_cbranch_scc1 PRIO_7
    s_setprio 0
PRIO_7:
    s_cmp_eq_u32 s52, 4
    s_cbranch_scc1 ITEM_0_4
    s_cmp_eq_u32 s52, 5
    s_cbranch_scc1 ITEM_0_5
    s_cmp_eq_u32 s52, 3
    s_cbranch_scc1 ITEM_0_3
    s_cmp_eq_u32 s52, 6
    s_cbranch_scc1 ITEM_0_6
    s_cmp_eq_u32 s52, 8
    s_cbranch_scc1 ITEM_0_8
    s_branch ITEM_0_2
.p2align 6
ITEM_0_8:
    s_mov_b64 exec, s[54:55]
    ds_read_u16_d16_hi v243, v250 offset:128
    s_mov_b64 exec, -1
    ds_read_b64_tr_b16 v[76:77], v249 offset:512
    ds_read_b64_tr_b16 v[78:79], v249 offset:768
    ds_read_b64_tr_b16 v[84:85], v249 offset:1024
    ds_read_b64_tr_b16 v[86:87], v249 offset:1280
    ds_read_b64_tr_b16 v[92:93], v249 offset:1536
    ds_read_b64_tr_b16 v[94:95], v249 offset:1792
    s_waitcnt lgkmcnt(7)
    v_lshlrev_b32 v196, 16, v68
    v_and_b32 v197, 0xffff0000, v68
    v_lshlrev_b32 v198, 16, v69
    v_and_b32 v199, 0xffff0000, v69
    v_mul_f32_dpp v200, v242, v196 row_newbcast:0 row_mask:0xf bank_mask:0xf
    v_mul_f32_dpp v201, v242, v197 row_newbcast:1 row_mask:0xf bank_mask:0xf
    v_mul_f32_dpp v202, v242, v196 row_newbcast:8 row_mask:0xf bank_mask:0xf
    v_mul_f32_dpp v203, v242, v197 row_newbcast:9 row_mask:0xf bank_mask:0xf
    v_lshlrev_b32 v196, 16, v70
    v_and_b32 v197, 0xffff0000, v70
    v_cvt_pk_bf16_f32 v64, v200, v201
    v_cvt_pk_bf16_f32 v68, v202, v203
    v_mul_f32_dpp v200, v242, v198 row_newbcast:2 row_mask:0xf bank_mask:0xf
    v_mul_f32_dpp v201, v242, v199 row_newbcast:3 row_mask:0xf bank_mask:0xf
    v_mul_f32_dpp v202, v242, v198 row_newbcast:10 row_mask:0xf bank_mask:0xf
    v_mul_f32_dpp v203, v242, v199 row_newbcast:11 row_mask:0xf bank_mask:0xf
    v_lshlrev_b32 v198, 16, v71
    v_and_b32 v199, 0xffff0000, v71
    v_cvt_pk_bf16_f32 v65, v200, v201
    v_cvt_pk_bf16_f32 v69, v202, v203
    v_mul_f32_dpp v200, v242, v196 row_newbcast:4 row_mask:0xf bank_mask:0xf
    v_mul_f32_dpp v201, v242, v197 row_newbcast:5 row_mask:0xf bank_mask:0xf
    v_mul_f32_dpp v202, v242, v196 row_newbcast:12 row_mask:0xf bank_mask:0xf
    v_mul_f32_dpp v203, v242, v197 row_newbcast:13 row_mask:0xf bank_mask:0xf
    v_cvt_pk_bf16_f32 v66, v200, v201
    v_cvt_pk_bf16_f32 v70, v202, v203
    v_mul_f32_dpp v200, v242, v198 row_newbcast:6 row_mask:0xf bank_mask:0xf
    v_mul_f32_dpp v201, v242, v199 row_newbcast:7 row_mask:0xf bank_mask:0xf
    v_mul_f32_dpp v202, v242, v198 row_newbcast:14 row_mask:0xf bank_mask:0xf
    v_mul_f32_dpp v203, v242, v199 row_newbcast:15 row_mask:0xf bank_mask:0xf
    v_cvt_pk_bf16_f32 v67, v200, v201
    v_cvt_pk_bf16_f32 v71, v202, v203
    s_mov_b64 exec, s[54:55]
    ds_read_u16_d16_hi v242, v250 offset:256
    s_mov_b64 exec, -1
    s_waitcnt vmcnt(4) lgkmcnt(5)
    v_mfma_f32_32x32x16_bf16 v[0:15], v[64:67], v[176:179], 0
    v_lshlrev_b32 v196, 16, v76
    v_and_b32 v197, 0xffff0000, v76
    v_lshlrev_b32 v198, 16, v77
    v_and_b32 v199, 0xffff0000, v77
    v_mul_f32_dpp v200, v243, v196 row_newbcast:0 row_mask:0xf bank_mask:0xf
    v_mul_f32_dpp v201, v243, v197 row_newbcast:1 row_mask:0xf bank_mask:0xf
    v_mul_f32_dpp v202, v243, v196 row_newbcast:8 row_mask:0xf bank_mask:0xf
    v_mul_f32_dpp v203, v243, v197 row_newbcast:9 row_mask:0xf bank_mask:0xf
    v_lshlrev_b32 v196, 16, v78
    v_and_b32 v197, 0xffff0000, v78
    v_cvt_pk_bf16_f32 v72, v200, v201
    v_cvt_pk_bf16_f32 v76, v202, v203
    v_mul_f32_dpp v200, v243, v198 row_newbcast:2 row_mask:0xf bank_mask:0xf
    v_mul_f32_dpp v201, v243, v199 row_newbcast:3 row_mask:0xf bank_mask:0xf
    v_mul_f32_dpp v202, v243, v198 row_newbcast:10 row_mask:0xf bank_mask:0xf
    v_mul_f32_dpp v203, v243, v199 row_newbcast:11 row_mask:0xf bank_mask:0xf
    s_add_u32 m0, s21, 0
    v_mfma_f32_32x32x16_bf16 v[16:31], v[68:71], v[176:179], 0
    buffer_load_dwordx4 v234, s[4:7], s35 offen lds
    buffer_load_dwordx4 v235, s[8:11], s35 offen offset:1024 lds
    ds_read_b64_tr_b16 v[176:177], v244 offset:2048
    ds_read_b64_tr_b16 v[178:179], v244 offset:3072
    ds_read_b64_tr_b16 v[184:185], v245 offset:2048
    ds_read_b64_tr_b16 v[186:187], v245 offset:3072
    v_lshlrev_b32 v198, 16, v79
    v_and_b32 v199, 0xffff0000, v79
    v_cvt_pk_bf16_f32 v73, v200, v201
    v_cvt_pk_bf16_f32 v77, v202, v203
    v_mul_f32_dpp v200, v243, v196 row_newbcast:4 row_mask:0xf bank_mask:0xf
    v_mul_f32_dpp v201, v243, v197 row_newbcast:5 row_mask:0xf bank_mask:0xf
    v_mul_f32_dpp v202, v243, v196 row_newbcast:12 row_mask:0xf bank_mask:0xf
    v_mul_f32_dpp v203, v243, v197 row_newbcast:13 row_mask:0xf bank_mask:0xf
    v_cvt_pk_bf16_f32 v74, v200, v201
    v_cvt_pk_bf16_f32 v78, v202, v203
    v_mul_f32_dpp v200, v243, v198 row_newbcast:6 row_mask:0xf bank_mask:0xf
    v_mul_f32_dpp v201, v243, v199 row_newbcast:7 row_mask:0xf bank_mask:0xf
    v_mul_f32_dpp v202, v243, v198 row_newbcast:14 row_mask:0xf bank_mask:0xf
    v_mul_f32_dpp v203, v243, v199 row_newbcast:15 row_mask:0xf bank_mask:0xf
    v_cvt_pk_bf16_f32 v75, v200, v201
    v_cvt_pk_bf16_f32 v79, v202, v203
    s_mov_b64 exec, s[54:55]
    ds_read_u16_d16_hi v243, v250 offset:384
    s_mov_b64 exec, -1
    s_waitcnt vmcnt(4) lgkmcnt(1)
    v_mfma_f32_32x32x16_bf16 v[0:15], v[72:75], v[176:179], v[0:15]
    v_lshlrev_b32 v196, 16, v84
    v_and_b32 v197, 0xffff0000, v84
    v_lshlrev_b32 v198, 16, v85
    v_and_b32 v199, 0xffff0000, v85
    v_mul_f32_dpp v200, v242, v196 row_newbcast:0 row_mask:0xf bank_mask:0xf
    v_mul_f32_dpp v201, v242, v197 row_newbcast:1 row_mask:0xf bank_mask:0xf
    v_mul_f32_dpp v202, v242, v196 row_newbcast:8 row_mask:0xf bank_mask:0xf
    v_mul_f32_dpp v203, v242, v197 row_newbcast:9 row_mask:0xf bank_mask:0xf
    v_lshlrev_b32 v196, 16, v86
    v_and_b32 v197, 0xffff0000, v86
    v_cvt_pk_bf16_f32 v80, v200, v201
    v_cvt_pk_bf16_f32 v84, v202, v203
    v_mul_f32_dpp v200, v242, v198 row_newbcast:2 row_mask:0xf bank_mask:0xf
    v_mul_f32_dpp v201, v242, v199 row_newbcast:3 row_mask:0xf bank_mask:0xf
    v_mul_f32_dpp v202, v242, v198 row_newbcast:10 row_mask:0xf bank_mask:0xf
    v_mul_f32_dpp v203, v242, v199 row_newbcast:11 row_mask:0xf bank_mask:0xf
    s_add_u32 m0, s21, 2048
    v_mfma_f32_32x32x16_bf16 v[16:31], v[76:79], v[176:179], v[16:31]
    buffer_load_dwordx4 v236, s[4:7], s35 offen lds
    buffer_load_dwordx4 v237, s[8:11], s35 offen offset:1024 lds
    ds_read_b64_tr_b16 v[176:177], v244 offset:4096
    ds_read_b64_tr_b16 v[178:179], v244 offset:5120
    ds_read_b64_tr_b16 v[188:189], v245 offset:4096
    ds_read_b64_tr_b16 v[190:191], v245 offset:5120
    v_lshlrev_b32 v198, 16, v87
    v_and_b32 v199, 0xffff0000, v87
    v_cvt_pk_bf16_f32 v81, v200, v201
    v_cvt_pk_bf16_f32 v85, v202, v203
    v_mul_f32_dpp v200, v242, v196 row_newbcast:4 row_mask:0xf bank_mask:0xf
    v_mul_f32_dpp v201, v242, v197 row_newbcast:5 row_mask:0xf bank_mask:0xf
    v_mul_f32_dpp v202, v242, v196 row_newbcast:12 row_mask:0xf bank_mask:0xf
    v_mul_f32_dpp v203, v242, v197 row_newbcast:13 row_mask:0xf bank_mask:0xf
    v_cvt_pk_bf16_f32 v82, v200, v201
    v_cvt_pk_bf16_f32 v86, v202, v203
    v_mul_f32_dpp v200, v242, v198 row_newbcast:6 row_mask:0xf bank_mask:0xf
    v_mul_f32_dpp v201, v242, v199 row_newbcast:7 row_mask:0xf bank_mask:0xf
    v_mul_f32_dpp v202, v242, v198 row_newbcast:14 row_mask:0xf bank_mask:0xf
    v_mul_f32_dpp v203, v242, v199 row_newbcast:15 row_mask:0xf bank_mask:0xf
    v_cvt_pk_bf16_f32 v83, v200, v201
    v_cvt_pk_bf16_f32 v87, v202, v203
    s_nop 0
    s_waitcnt vmcnt(4) lgkmcnt(0)
    v_mfma_f32_32x32x16_bf16 v[0:15], v[80:83], v[176:179], v[0:15]
    v_lshlrev_b32 v196, 16, v92
    v_and_b32 v197, 0xffff0000, v92
    v_lshlrev_b32 v198, 16, v93
    v_and_b32 v199, 0xffff0000, v93
    v_mul_f32_dpp v200, v243, v196 row_newbcast:0 row_mask:0xf bank_mask:0xf
    v_mul_f32_dpp v201, v243, v197 row_newbcast:1 row_mask:0xf bank_mask:0xf
    v_mul_f32_dpp v202, v243, v196 row_newbcast:8 row_mask:0xf bank_mask:0xf
    v_mul_f32_dpp v203, v243, v197 row_newbcast:9 row_mask:0xf bank_mask:0xf
    v_lshlrev_b32 v196, 16, v94
    v_and_b32 v197, 0xffff0000, v94
    v_cvt_pk_bf16_f32 v88, v200, v201
    v_cvt_pk_bf16_f32 v92, v202, v203
    v_mul_f32_dpp v200, v243, v198 row_newbcast:2 row_mask:0xf bank_mask:0xf
    v_mul_f32_dpp v201, v243, v199 row_newbcast:3 row_mask:0xf bank_mask:0xf
    v_mul_f32_dpp v202, v243, v198 row_newbcast:10 row_mask:0xf bank_mask:0xf
    v_mul_f32_dpp v203, v243, v199 row_newbcast:11 row_mask:0xf bank_mask:0xf
    s_add_u32 m0, s21, 4096
    v_mfma_f32_32x32x16_bf16 v[16:31], v[84:87], v[176:179], v[16:31]
    buffer_load_dwordx4 v238, s[4:7], s35 offen lds
    buffer_load_dwordx4 v239, s[8:11], s35 offen offset:1024 lds
    ds_read_b64_tr_b16 v[176:177], v244 offset:6144
    ds_read_b64_tr_b16 v[178:179], v244 offset:7168
    ds_read_b64_tr_b16 v[192:193], v245 offset:6144
    ds_read_b64_tr_b16 v[194:195], v245 offset:7168
    v_lshlrev_b32 v198, 16, v95
    v_and_b32 v199, 0xffff0000, v95
    v_cvt_pk_bf16_f32 v89, v200, v201
    v_cvt_pk_bf16_f32 v93, v202, v203
    v_mul_f32_dpp v200, v243, v196 row_newbcast:4 row_mask:0xf bank_mask:0xf
    v_mul_f32_dpp v201, v243, v197 row_newbcast:5 row_mask:0xf bank_mask:0xf
    v_mul_f32_dpp v202, v243, v196 row_newbcast:12 row_mask:0xf bank_mask:0xf
    v_mul_f32_dpp v203, v243, v197 row_newbcast:13 row_mask:0xf bank_mask:0xf
    v_cvt_pk_bf16_f32 v90, v200, v201
    v_cvt_pk_bf16_f32 v94, v202, v203
    v_mul_f32_dpp v200, v243, v198 row_newbcast:6 row_mask:0xf bank_mask:0xf
    v_mul_f32_dpp v201, v243, v199 row_newbcast:7 row_mask:0xf bank_mask:0xf
    v_mul_f32_dpp v202, v243, v198 row_newbcast:14 row_mask:0xf bank_mask:0xf
    v_mul_f32_dpp v203, v243, v199 row_newbcast:15 row_mask:0xf bank_mask:0xf
    v_cvt_pk_bf16_f32 v91, v200, v201
    v_cvt_pk_bf16_f32 v95, v202, v203
    s_nop 0
    s_waitcnt lgkmcnt(0)
    v_mfma_f32_32x32x16_bf16 v[0:15], v[88:91], v[176:179], v[0:15]
    s_add_u32 m0, s21, 6144
    v_mfma_f32_32x32x16_bf16 v[16:31], v[92:95], v[176:179], v[16:31]
    buffer_load_dwordx4 v240, s[4:7], s35 offen lds
    buffer_load_dwordx4 v241, s[8:11], s35 offen offset:1024 lds
    s_mov_b32 m0, s50
    s_nop 0
    s_movrels_b32 s71, s23
    s_bfe_u32 s46, s71, 0x30012
    s_mov_b32 m0, s46
    s_and_b32 s66, s71, 0x3ffff
    s_movrels_b32 s68, s57
    s_movrels_b32 s69, s61
    s_sub_u32 s48, s66, s47
    s_mov_b32 s47, s66
    s_lshr_b32 s52, s71, 28
    s_lshl_b32 s67, s46, 9
    s_add_u32 s66, s66, s67
    s_sub_u32 s49, s66, s42
    s_mov_b32 s42, s66
    s_bfe_u32 s66, s68, 655360
    s_add_u32 s43, s42, s66
    s_bfe_u32 s39, s69, 655360
    s_bfe_u32 s66, s68, 655370
    s_add_u32 s44, s42, s66
    s_bfe_u32 s40, s69, 655370
    s_bfe_u32 s66, s68, 655380
    s_add_u32 s45, s42, s66
    s_bfe_u32 s41, s69, 655380
    s_and_b32 s66, s46, s33
    s_cselect_b32 s72, -1, 1
    s_cselect_b32 s76, s47, 163712
    s_cmp_ge_u32 s66, 2
    s_cselect_b32 s73, -1, 0
    s_add_u32 s77, s47, 1024
    s_cmp_ge_u32 s66, 4
    s_cselect_b32 s75, -1, 0
    s_cmp_ge_u32 s66, 3
    s_cselect_b32 s74, -1, 1
    s_cselect_b32 s77, s77, 163712
    v_mfma_f32_32x32x16_bf16 v[32:47], v[64:67], v[180:183], 0
    v_mul_f32 v196, v0, v96
    v_fmac_f32 v196, v1, v97
    v_fmac_f32 v196, v2, v98
    v_fmac_f32 v196, v3, v99
    v_fmac_f32 v196, v4, v100
    v_mfma_f32_32x32x16_bf16 v[48:63], v[68:71], v[180:183], 0
    v_lshl_add_u32 v253, v248, 2, s47
    ds_read_b32 v254, v253
    ds_read_b32 v255, v253 offset:1024
    v_fmac_f32 v196, v5, v101
    v_fmac_f32 v196, v6, v102
    v_fmac_f32 v196, v7, v103
    v_mul_f32 v198, v8, v128
    v_fmac_f32 v198, v9, v129
    v_mfma_f32_32x32x16_bf16 v[32:47], v[72:75], v[184:187], v[32:47]
    v_fmac_f32 v198, v10, v130
    v_fmac_f32 v198, v11, v131
    v_fmac_f32 v198, v12, v132
    v_fmac_f32 v198, v13, v133
    v_mfma_f32_32x32x16_bf16 v[48:63], v[76:79], v[184:187], v[48:63]
    v_fmac_f32 v198, v14, v134
    v_fmac_f32 v198, v15, v135
    v_mul_f32 v200, v16, v128
    v_fmac_f32 v200, v17, v129
    v_permlane32_swap_b32 v196, v198
    v_mfma_f32_32x32x16_bf16 v[32:47], v[80:83], v[188:191], v[32:47]
    v_fmac_f32 v200, v18, v130
    v_fmac_f32 v200, v19, v131
    v_fmac_f32 v200, v20, v132
    v_fmac_f32 v200, v21, v133
    v_fmac_f32 v200, v22, v134
    v_mfma_f32_32x32x16_bf16 v[48:63], v[84:87], v[188:191], v[48:63]
    s_waitcnt vmcnt(6)
    ds_read_b64_tr_b16 v[176:177], v244 offset:0
    ds_read_b64_tr_b16 v[178:179], v244 offset:1024
    ds_read_b64_tr_b16 v[180:181], v245 offset:0
    ds_read_b64_tr_b16 v[182:183], v245 offset:1024
    v_fmac_f32 v200, v23, v135
    v_add_f32 v198, v196, v198
    v_mul_f32_e64 v202, v24, -v128
    v_fma_f32 v202, v25, -v129, v202
    v_mfma_f32_32x32x16_bf16 v[32:47], v[88:91], v[192:195], v[32:47]
    v_fma_f32 v202, v26, -v130, v202
    v_fma_f32 v202, v27, -v131, v202
    v_fma_f32 v202, v28, -v132, v202
    v_fma_f32 v202, v29, -v133, v202
    v_fma_f32 v202, v30, -v134, v202
    v_mfma_f32_32x32x16_bf16 v[48:63], v[92:95], v[192:195], v[48:63]
    v_fma_f32 v202, v31, -v135, v202
    s_nop 1
    v_permlane32_swap_b32 v200, v202
    v_add_f32 v202, v200, v202
    s_waitcnt vmcnt(4) lgkmcnt(0)
    v_mfma_f32_32x32x16_bf16 v[0:15], v[64:67], v[176:179], 0
    v_mul_f32 v197, v32, v104
    v_fmac_f32 v197, v33, v105
    v_fmac_f32 v197, v34, v106
    v_fmac_f32 v197, v35, v107
    v_fmac_f32 v197, v36, v108
    v_fmac_f32 v197, v37, v109
    s_add_u32 m0, s21, 0
    v_mfma_f32_32x32x16_bf16 v[16:31], v[68:71], v[176:179], 0
    buffer_load_dwordx4 v234, s[4:7], s36 offen lds
    buffer_load_dwordx4 v235, s[8:11], s36 offen offset:1024 lds
    ds_read_b64_tr_b16 v[176:177], v244 offset:2048
    ds_read_b64_tr_b16 v[178:179], v244 offset:3072
    ds_read_b64_tr_b16 v[184:185], v245 offset:2048
    ds_read_b64_tr_b16 v[186:187], v245 offset:3072
    s_mov_b32 m0, s76
    s_mov_b64 exec, s[72:73]
    buffer_load_dwordx4 v254, s[12:15], 0 offen  lds
    s_mov_b32 m0, s77
    s_mov_b64 exec, s[74:75]
    buffer_load_dwordx4 v255, s[12:15], 0 offen  lds
    s_mov_b64 exec, -1
    v_fmac_f32 v197, v38, v110
    v_fmac_f32 v197, v39, v111
    v_mul_f32 v199, v40, v136
    v_fmac_f32 v199, v41, v137
    v_fmac_f32 v199, v42, v138
    s_waitcnt vmcnt(6) lgkmcnt(0)
    v_mfma_f32_32x32x16_bf16 v[0:15], v[72:75], v[176:179], v[0:15]
    v_fmac_f32 v199, v43, v139
    v_fmac_f32 v199, v44, v140
    v_fmac_f32 v199, v45, v141
    v_fmac_f32 v199, v46, v142
    v_fmac_f32 v199, v47, v143
    s_add_u32 m0, s21, 2048
    v_mfma_f32_32x32x16_bf16 v[16:31], v[76:79], v[176:179], v[16:31]
    buffer_load_dwordx4 v236, s[4:7], s36 offen lds
    buffer_load_dwordx4 v237, s[8:11], s36 offen offset:1024 lds
    ds_read_b64_tr_b16 v[176:177], v244 offset:4096
    ds_read_b64_tr_b16 v[178:179], v244 offset:5120
    ds_read_b64_tr_b16 v[188:189], v245 offset:4096
    ds_read_b64_tr_b16 v[190:191], v245 offset:5120
    v_mul_f32 v201, v48, v136
    v_fmac_f32 v201, v49, v137
    v_permlane32_swap_b32 v197, v199
    v_fmac_f32 v201, v50, v138
    v_fmac_f32 v201, v51, v139
    s_waitcnt vmcnt(6) lgkmcnt(0)
    v_mfma_f32_32x32x16_bf16 v[0:15], v[80:83], v[176:179], v[0:15]
    v_fmac_f32 v201, v52, v140
    v_fmac_f32 v201, v53, v141
    v_fmac_f32 v201, v54, v142
    v_fmac_f32 v201, v55, v143
    v_add_f32 v199, v197, v199
    v_mul_f32_e64 v203, v56, -v136
    s_add_u32 m0, s21, 4096
    v_mfma_f32_32x32x16_bf16 v[16:31], v[84:87], v[176:179], v[16:31]
    buffer_load_dwordx4 v238, s[4:7], s36 offen lds
    buffer_load_dwordx4 v239, s[8:11], s36 offen offset:1024 lds
    ds_read_b64_tr_b16 v[176:177], v244 offset:6144
    ds_read_b64_tr_b16 v[178:179], v244 offset:7168
    ds_read_b64_tr_b16 v[192:193], v245 offset:6144
    ds_read_b64_tr_b16 v[194:195], v245 offset:7168
    v_fma_f32 v203, v57, -v137, v203
    v_fma_f32 v203, v58, -v138, v203
    v_fma_f32 v203, v59, -v139, v203
    v_fma_f32 v203, v60, -v140, v203
    v_fma_f32 v203, v61, -v141, v203
    s_waitcnt lgkmcnt(0)
    v_mfma_f32_32x32x16_bf16 v[0:15], v[88:91], v[176:179], v[0:15]
    v_fma_f32 v203, v62, -v142, v203
    v_fma_f32 v203, v63, -v143, v203
    s_nop 1
    v_permlane32_swap_b32 v201, v203
    v_add_f32 v203, v201, v203
    s_add_u32 m0, s21, 6144
    v_mfma_f32_32x32x16_bf16 v[16:31], v[92:95], v[176:179], v[16:31]
    buffer_load_dwordx4 v240, s[4:7], s36 offen lds
    buffer_load_dwordx4 v241, s[8:11], s36 offen offset:1024 lds
    s_set_gpr_idx_on s51, gpr_idx(DST)
    s_nop 0
    v_cvt_pk_bf16_f32 v204, v198, v199
    v_cvt_pk_bf16_f32 v205, v202, v203
    s_set_gpr_idx_off
    v_mfma_f32_32x32x16_bf16 v[32:47], v[64:67], v[180:183], 0
    v_mul_f32 v196, v0, v144
    v_fmac_f32 v196, v1, v145
    v_fmac_f32 v196, v2, v146
    v_fmac_f32 v196, v3, v147
    v_mfma_f32_32x32x16_bf16 v[48:63], v[68:71], v[180:183], 0
    v_fmac_f32 v196, v4, v148
    v_fmac_f32 v196, v5, v149
    v_fmac_f32 v196, v6, v150
    v_fmac_f32 v196, v7, v151
    v_mfma_f32_32x32x16_bf16 v[32:47], v[72:75], v[184:187], v[32:47]
    v_mul_f32 v198, v8, v112
    v_fmac_f32 v198, v9, v113
    v_fmac_f32 v198, v10, v114
    v_fmac_f32 v198, v11, v115
    v_mfma_f32_32x32x16_bf16 v[48:63], v[76:79], v[184:187], v[48:63]
    v_fmac_f32 v198, v12, v116
    v_fmac_f32 v198, v13, v117
    v_fmac_f32 v198, v14, v118
    v_fmac_f32 v198, v15, v119
    v_mfma_f32_32x32x16_bf16 v[32:47], v[80:83], v[188:191], v[32:47]
    v_mul_f32_e64 v200, v16, -v160
    v_fma_f32 v200, v17, -v161, v200
    v_fma_f32 v200, v18, -v162, v200
    v_fma_f32 v200, v19, -v163, v200
    v_mfma_f32_32x32x16_bf16 v[48:63], v[84:87], v[188:191], v[48:63]
    s_waitcnt vmcnt(8)
    ds_read_b64_tr_b16 v[176:177], v244 offset:0
    ds_read_b64_tr_b16 v[178:179], v244 offset:1024
    ds_read_b64_tr_b16 v[180:181], v245 offset:0
    ds_read_b64_tr_b16 v[182:183], v245 offset:1024
    v_fma_f32 v200, v20, -v164, v200
    v_fma_f32 v200, v21, -v165, v200
    v_fma_f32 v200, v22, -v166, v200
    v_fma_f32 v200, v23, -v167, v200
    v_mfma_f32_32x32x16_bf16 v[32:47], v[88:91], v[192:195], v[32:47]
    v_mul_f32_e64 v202, v24, -v160
    v_fma_f32 v202, v25, -v161, v202
    v_fma_f32 v202, v26, -v162, v202
    v_fma_f32 v202, v27, -v163, v202
    v_mfma_f32_32x32x16_bf16 v[48:63], v[92:95], v[192:195], v[48:63]
    v_fma_f32 v202, v28, -v164, v202
    v_fma_f32 v202, v29, -v165, v202
    v_fma_f32 v202, v30, -v166, v202
    v_fma_f32 v202, v31, -v167, v202
    s_waitcnt vmcnt(4) lgkmcnt(0)
    v_mfma_f32_32x32x16_bf16 v[0:15], v[64:67], v[176:179], 0
    s_nop 0
    v_mul_f32 v197, v32, v152
    v_fmac_f32 v197, v33, v153
    v_fmac_f32 v197, v34, v154
    v_fmac_f32 v197, v35, v155
    s_add_u32 m0, s21, 0
    v_mfma_f32_32x32x16_bf16 v[16:31], v[68:71], v[176:179], 0
    buffer_load_dwordx4 v234, s[4:7], s37 offen lds
    buffer_load_dwordx4 v235, s[8:11], s37 offen offset:1024 lds
    ds_read_b64_tr_b16 v[176:177], v244 offset:2048
    ds_read_b64_tr_b16 v[178:179], v244 offset:3072
    ds_read_b64_tr_b16 v[184:185], v245 offset:2048
    ds_read_b64_tr_b16 v[186:187], v245 offset:3072
    v_add_u32 v252, s42, v247
    ds_read_u16 v234, v252
    ds_read_u16 v235, v252 offset:64
    v_fmac_f32 v197, v36, v156
    v_fmac_f32 v197, v37, v157
    v_fmac_f32 v197, v38, v158
    v_fmac_f32 v197, v39, v159
    s_waitcnt vmcnt(4) lgkmcnt(2)
    v_mfma_f32_32x32x16_bf16 v[0:15], v[72:75], v[176:179], v[0:15]
    v_mul_f32 v199, v40, v120
    v_fmac_f32 v199, v41, v121
    v_fmac_f32 v199, v42, v122
    v_fmac_f32 v199, v43, v123
    s_add_u32 m0, s21, 2048
    v_mfma_f32_32x32x16_bf16 v[16:31], v[76:79], v[176:179], v[16:31]
    buffer_load_dwordx4 v236, s[4:7], s37 offen lds
    buffer_load_dwordx4 v237, s[8:11], s37 offen offset:1024 lds
    ds_read_b64_tr_b16 v[176:177], v244 offset:4096
    ds_read_b64_tr_b16 v[178:179], v244 offset:5120
    ds_read_b64_tr_b16 v[188:189], v245 offset:4096
    ds_read_b64_tr_b16 v[190:191], v245 offset:5120
    v_add_u32 v252, s43, v247
    ds_read_u16 v236, v252
    ds_read_u16 v237, v252 offset:64
    v_fmac_f32 v199, v44, v124
    v_fmac_f32 v199, v45, v125
    v_fmac_f32 v199, v46, v126
    v_fmac_f32 v199, v47, v127
    s_waitcnt vmcnt(4) lgkmcnt(2)
    v_mfma_f32_32x32x16_bf16 v[0:15], v[80:83], v[176:179], v[0:15]
    v_mul_f32_e64 v201, v48, -v168
    v_fma_f32 v201, v49, -v169, v201
    v_fma_f32 v201, v50, -v170, v201
    v_fma_f32 v201, v51, -v171, v201
    s_add_u32 m0, s21, 4096
    v_mfma_f32_32x32x16_bf16 v[16:31], v[84:87], v[176:179], v[16:31]
    buffer_load_dwordx4 v238, s[4:7], s37 offen lds
    buffer_load_dwordx4 v239, s[8:11], s37 offen offset:1024 lds
    ds_read_b64_tr_b16 v[176:177], v244 offset:6144
    ds_read_b64_tr_b16 v[178:179], v244 offset:7168
    ds_read_b64_tr_b16 v[192:193], v245 offset:6144
    ds_read_b64_tr_b16 v[194:195], v245 offset:7168
    v_add_u32 v252, s44, v247
    ds_read_u16 v238, v252
    ds_read_u16 v239, v252 offset:64
    v_fma_f32 v201, v52, -v172, v201
    v_fma_f32 v201, v53, -v173, v201
    v_fma_f32 v201, v54, -v174, v201
    v_fma_f32 v201, v55, -v175, v201
    s_waitcnt lgkmcnt(2)
    v_mfma_f32_32x32x16_bf16 v[0:15], v[88:91], v[176:179], v[0:15]
    v_mul_f32_e64 v203, v56, -v168
    v_fma_f32 v203, v57, -v169, v203
    v_fma_f32 v203, v58, -v170, v203
    v_fma_f32 v203, v59, -v171, v203
    s_add_u32 m0, s21, 6144
    v_mfma_f32_32x32x16_bf16 v[16:31], v[92:95], v[176:179], v[16:31]
    buffer_load_dwordx4 v240, s[4:7], s37 offen lds
    buffer_load_dwordx4 v241, s[8:11], s37 offen offset:1024 lds
    v_add_u32 v252, s45, v247
    ds_read_u16 v240, v252
    ds_read_u16 v241, v252 offset:64
    v_fma_f32 v203, v60, -v172, v203
    v_fma_f32 v203, v61, -v173, v203
    v_fma_f32 v203, v62, -v174, v203
    v_fma_f32 v203, v63, -v175, v203
    v_mfma_f32_32x32x16_bf16 v[32:47], v[64:67], v[180:183], 0
    v_mul_f32 v254, v0, v144
    v_fmac_f32 v254, v1, v145
    v_fmac_f32 v254, v2, v146
    v_mfma_f32_32x32x16_bf16 v[48:63], v[68:71], v[180:183], 0
    ds_swizzle_b32 v68, v68 offset:0x401F
    ds_swizzle_b32 v69, v69 offset:0x401F
    ds_swizzle_b32 v70, v70 offset:0x401F
    ds_swizzle_b32 v71, v71 offset:0x401F
    v_fmac_f32 v254, v3, v147
    v_fmac_f32 v254, v4, v148
    v_mfma_f32_32x32x16_bf16 v[32:47], v[72:75], v[184:187], v[32:47]
    v_fmac_f32 v254, v5, v149
    v_fmac_f32 v254, v6, v150
    v_mfma_f32_32x32x16_bf16 v[48:63], v[76:79], v[184:187], v[48:63]
    ds_swizzle_b32 v76, v76 offset:0x401F
    ds_swizzle_b32 v77, v77 offset:0x401F
    ds_swizzle_b32 v78, v78 offset:0x401F
    ds_swizzle_b32 v79, v79 offset:0x401F
    v_fmac_f32 v254, v7, v151
    v_fmac_f32 v200, v8, v160
    v_mfma_f32_32x32x16_bf16 v[32:47], v[80:83], v[188:191], v[32:47]
    v_fmac_f32 v200, v9, v161
    v_permlane32_swap_b32 v196, v254
    v_fmac_f32 v200, v10, v162
    v_mfma_f32_32x32x16_bf16 v[48:63], v[84:87], v[188:191], v[48:63]
    ds_swizzle_b32 v84, v84 offset:0x401F
    ds_swizzle_b32 v85, v85 offset:0x401F
    ds_swizzle_b32 v86, v86 offset:0x401F
    ds_swizzle_b32 v87, v87 offset:0x401F
    s_waitcnt vmcnt(6)
    ds_read_b64_tr_b16 v[176:177], v244 offset:0
    ds_read_b64_tr_b16 v[178:179], v244 offset:1024
    ds_read_b64_tr_b16 v[180:181], v245 offset:0
    ds_read_b64_tr_b16 v[182:183], v245 offset:1024
    v_fmac_f32 v200, v11, v163
    v_fmac_f32 v200, v12, v164
    v_mfma_f32_32x32x16_bf16 v[32:47], v[88:91], v[192:195], v[32:47]
    v_fmac_f32 v200, v13, v165
    v_fmac_f32 v200, v14, v166
    v_mfma_f32_32x32x16_bf16 v[48:63], v[92:95], v[192:195], v[48:63]
    ds_swizzle_b32 v92, v92 offset:0x401F
    ds_swizzle_b32 v93, v93 offset:0x401F
    ds_swizzle_b32 v94, v94 offset:0x401F
    ds_swizzle_b32 v95, v95 offset:0x401F
    v_fmac_f32 v200, v15, v167
    v_add_f32 v254, v196, v254
    s_waitcnt lgkmcnt(8)
    s_mov_b64 exec, s[56:57]
    v_xor_b32 v68, 0x80008000, v68
    v_xor_b32 v69, 0x80008000, v69
    v_xor_b32 v70, 0x80008000, v70
    v_xor_b32 v71, 0x80008000, v71
    v_xor_b32 v76, 0x80008000, v76
    v_xor_b32 v77, 0x80008000, v77
    v_xor_b32 v78, 0x80008000, v78
    v_xor_b32 v79, 0x80008000, v79
    v_xor_b32 v84, 0x80008000, v84
    v_xor_b32 v85, 0x80008000, v85
    v_xor_b32 v86, 0x80008000, v86
    v_xor_b32 v87, 0x80008000, v87
    s_mov_b64 exec, -1
    s_waitcnt vmcnt(4) lgkmcnt(4)
    v_mfma_f32_32x32x16_bf16 v[0:15], v[64:67], v[176:179], 0
    v_mul_f32 v255, v32, v152
    v_fmac_f32 v255, v33, v153
    v_fmac_f32 v255, v34, v154
    s_add_u32 m0, s21, 0
    v_mfma_f32_32x32x16_bf16 v[16:31], v[68:71], v[176:179], v[16:31]
    v_lshl_add_u32 v234, v234, 10, v246
    v_lshl_add_u32 v235, v235, 10, v246
    buffer_load_dwordx4 v234, s[4:7], s38 offen lds
    buffer_load_dwordx4 v235, s[8:11], s38 offen offset:1024 lds
    ds_read_b64_tr_b16 v[176:177], v244 offset:2048
    ds_read_b64_tr_b16 v[178:179], v244 offset:3072
    ds_read_b64_tr_b16 v[184:185], v245 offset:2048
    ds_read_b64_tr_b16 v[186:187], v245 offset:3072
    v_fmac_f32 v255, v35, v155
    v_fmac_f32 v255, v36, v156
    v_fmac_f32 v255, v37, v157
    s_waitcnt vmcnt(4) lgkmcnt(0)
    v_mfma_f32_32x32x16_bf16 v[0:15], v[72:75], v[176:179], v[0:15]
    v_fmac_f32 v255, v38, v158
    v_fmac_f32 v255, v39, v159
    v_fmac_f32 v201, v40, v168
    s_add_u32 m0, s21, 2048
    v_mfma_f32_32x32x16_bf16 v[16:31], v[76:79], v[176:179], v[16:31]
    v_lshl_add_u32 v236, v236, 10, v246
    v_lshl_add_u32 v237, v237, 10, v246
    buffer_load_dwordx4 v236, s[4:7], s39 offen lds
    buffer_load_dwordx4 v237, s[8:11], s39 offen offset:1024 lds
    ds_read_b64_tr_b16 v[176:177], v244 offset:4096
    ds_read_b64_tr_b16 v[178:179], v244 offset:5120
    ds_read_b64_tr_b16 v[188:189], v245 offset:4096
    ds_read_b64_tr_b16 v[190:191], v245 offset:5120
    v_fmac_f32 v201, v41, v169
    v_permlane32_swap_b32 v197, v255
    s_waitcnt vmcnt(4) lgkmcnt(0)
    v_mfma_f32_32x32x16_bf16 v[0:15], v[80:83], v[176:179], v[0:15]
    v_fmac_f32 v201, v42, v170
    v_fmac_f32 v201, v43, v171
    v_fmac_f32 v201, v44, v172
    s_add_u32 m0, s21, 4096
    v_mfma_f32_32x32x16_bf16 v[16:31], v[84:87], v[176:179], v[16:31]
    v_lshl_add_u32 v238, v238, 10, v246
    v_lshl_add_u32 v239, v239, 10, v246
    buffer_load_dwordx4 v238, s[4:7], s40 offen lds
    buffer_load_dwordx4 v239, s[8:11], s40 offen offset:1024 lds
    ds_read_b64_tr_b16 v[176:177], v244 offset:6144
    ds_read_b64_tr_b16 v[178:179], v244 offset:7168
    ds_read_b64_tr_b16 v[192:193], v245 offset:6144
    ds_read_b64_tr_b16 v[194:195], v245 offset:7168
    v_fmac_f32 v201, v45, v173
    v_fmac_f32 v201, v46, v174
    v_fmac_f32 v201, v47, v175
    s_waitcnt lgkmcnt(0)
    s_mov_b64 exec, s[56:57]
    v_xor_b32 v92, 0x80008000, v92
    v_xor_b32 v93, 0x80008000, v93
    v_xor_b32 v94, 0x80008000, v94
    v_xor_b32 v95, 0x80008000, v95
    s_mov_b64 exec, -1
    v_mfma_f32_32x32x16_bf16 v[0:15], v[88:91], v[176:179], v[0:15]
    v_add_f32 v255, v197, v255
    s_set_gpr_idx_on s51, gpr_idx(DST)
    s_nop 0
    v_cvt_pk_bf16_f32 v206, v254, v255
    s_set_gpr_idx_off
    s_add_u32 m0, s21, 6144
    v_mfma_f32_32x32x16_bf16 v[16:31], v[92:95], v[176:179], v[16:31]
    v_lshl_add_u32 v240, v240, 10, v246
    v_lshl_add_u32 v241, v241, 10, v246
    buffer_load_dwordx4 v240, s[4:7], s41 offen lds
    buffer_load_dwordx4 v241, s[8:11], s41 offen offset:1024 lds
    v_mfma_f32_32x32x16_bf16 v[32:47], v[64:67], v[180:183], 0
    v_mul_f32 v254, v0, v144
    v_fmac_f32 v254, v1, v145
    v_fmac_f32 v254, v2, v146
    v_fmac_f32 v254, v3, v147
    v_fmac_f32 v254, v4, v148
    v_mfma_f32_32x32x16_bf16 v[48:63], v[68:71], v[180:183], v[48:63]
    v_fmac_f32 v254, v5, v149
    v_fmac_f32 v254, v6, v150
    v_fmac_f32 v254, v7, v151
    v_fma_f32 v202, v8, -v160, v202
    v_fma_f32 v202, v9, -v161, v202
    v_mfma_f32_32x32x16_bf16 v[32:47], v[72:75], v[184:187], v[32:47]
    v_permlane32_swap_b32 v254, v200
    v_fma_f32 v202, v10, -v162, v202
    v_fma_f32 v202, v11, -v163, v202
    v_fma_f32 v202, v12, -v164, v202
    v_fma_f32 v202, v13, -v165, v202
    v_mfma_f32_32x32x16_bf16 v[48:63], v[76:79], v[184:187], v[48:63]
    v_fma_f32 v202, v14, -v166, v202
    v_fma_f32 v202, v15, -v167, v202
    v_add_f32 v200, v254, v200
    v_fmac_f32 v198, v16, v112
    v_permlane32_swap_b32 v202, v254
    v_mfma_f32_32x32x16_bf16 v[32:47], v[80:83], v[188:191], v[32:47]
    v_fmac_f32 v198, v17, v113
    v_fmac_f32 v198, v18, v114
    v_fmac_f32 v198, v19, v115
    v_fmac_f32 v198, v20, v116
    v_fmac_f32 v198, v21, v117
    v_mfma_f32_32x32x16_bf16 v[48:63], v[84:87], v[188:191], v[48:63]
    s_waitcnt vmcnt(6)
    ds_read_b64_tr_b16 v[176:177], v244 offset:0
    ds_read_b64_tr_b16 v[178:179], v244 offset:1024
    ds_read_b64_tr_b16 v[180:181], v245 offset:0
    ds_read_b64_tr_b16 v[182:183], v245 offset:1024
    v_fmac_f32 v198, v22, v118
    v_fmac_f32 v198, v23, v119
    v_add_f32 v254, v202, v254
    v_mul_f32 v196, v24, v160
    v_fmac_f32 v196, v25, v161
    v_mfma_f32_32x32x16_bf16 v[32:47], v[88:91], v[192:195], v[32:47]
    v_fmac_f32 v196, v26, v162
    v_fmac_f32 v196, v27, v163
    v_fmac_f32 v196, v28, v164
    v_fmac_f32 v196, v29, v165
    v_fmac_f32 v196, v30, v166
    v_mfma_f32_32x32x16_bf16 v[48:63], v[92:95], v[192:195], v[48:63]
    v_add_u32 v249, s48, v249
    v_add_u32 v250, s49, v250
    ds_read_b32 v252, v251 offset:16
    ds_read_b64_tr_b16 v[68:69], v249 offset:0
    ds_read_b64_tr_b16 v[70:71], v249 offset:256
    s_mov_b64 exec, s[54:55]
    ds_read_u16_d16_hi v242, v250 offset:0
    s_mov_b64 exec, -1
    v_fmac_f32 v196, v31, v167
    s_nop 1
    v_permlane32_swap_b32 v198, v196
    v_add_f32 v196, v198, v196
    v_mul_f32 v255, v32, v152
    v_fmac_f32 v255, v33, v153
    v_fmac_f32 v255, v34, v154
    v_fmac_f32 v255, v35, v155
    v_fmac_f32 v255, v36, v156
    v_fmac_f32 v255, v37, v157
    v_fmac_f32 v255, v38, v158
    v_fmac_f32 v255, v39, v159
    v_fma_f32 v203, v40, -v168, v203
    v_fma_f32 v203, v41, -v169, v203
    v_permlane32_swap_b32 v255, v201
    v_fma_f32 v203, v42, -v170, v203
    v_fma_f32 v203, v43, -v171, v203
    v_fma_f32 v203, v44, -v172, v203
    v_fma_f32 v203, v45, -v173, v203
    v_fma_f32 v203, v46, -v174, v203
    v_fma_f32 v203, v47, -v175, v203
    v_add_f32 v201, v255, v201
    v_fmac_f32 v199, v48, v120
    v_permlane32_swap_b32 v203, v255
    v_fmac_f32 v199, v49, v121
    v_fmac_f32 v199, v50, v122
    v_fmac_f32 v199, v51, v123
    v_fmac_f32 v199, v52, v124
    v_fmac_f32 v199, v53, v125
    v_fmac_f32 v199, v54, v126
    v_fmac_f32 v199, v55, v127
    v_add_f32 v255, v203, v255
    v_mul_f32 v197, v56, v168
    v_fmac_f32 v197, v57, v169
    v_fmac_f32 v197, v58, v170
    v_fmac_f32 v197, v59, v171
    v_fmac_f32 v197, v60, v172
    v_fmac_f32 v197, v61, v173
    v_fmac_f32 v197, v62, v174
    v_fmac_f32 v197, v63, v175
    s_nop 1
    v_permlane32_swap_b32 v199, v197
    v_add_f32 v197, v199, v197
    s_set_gpr_idx_on s51, gpr_idx(DST)
    s_nop 0
    v_cvt_pk_bf16_f32 v207, v200, v201
    v_cvt_pk_bf16_f32 v209, v254, v255
    v_cvt_pk_bf16_f32 v208, v196, v197
    s_set_gpr_idx_off
    s_add_u32 s50, s50, 1
    s_add_u32 s51, s51, 6
    s_cmp_ge_u32 s50, 4
    s_cbranch_scc1 LAST0
    s_waitcnt lgkmcnt(3)
    v_readfirstlane_b32 s66, v252
    s_add_u32 s53, s53, 1
    v_mov_b32 v252, s53
    s_cmp_le_u32 s53, s66
    ds_write2_b32 v251, v252, v252 offset0:0 offset1:8
    s_setprio 1
    s_cbranch_scc1 PRIO_8
    s_setprio 0
PRIO_8:
    s_cmp_eq_u32 s52, 4
    s_cbranch_scc1 ITEM_0_4
    s_cmp_eq_u32 s52, 5
    s_cbranch_scc1 ITEM_0_5
    s_cmp_eq_u32 s52, 3
    s_cbranch_scc1 ITEM_0_3
    s_cmp_eq_u32 s52, 6
    s_cbranch_scc1 ITEM_0_6
    s_cmp_eq_u32 s52, 8
    s_cbranch_scc1 ITEM_0_8
    s_branch ITEM_0_2
.p2align 6
ITEM_0_2:
    s_mov_b32 m0, s50
    s_nop 0
    s_movrels_b32 s71, s23
    s_bfe_u32 s46, s71, 0x30012
    s_mov_b32 m0, s46
    s_and_b32 s66, s71, 0x3ffff
    s_movrels_b32 s68, s57
    s_movrels_b32 s69, s61
    s_sub_u32 s48, s66, s47
    s_mov_b32 s47, s66
    s_lshr_b32 s52, s71, 28
    s_lshl_b32 s67, s46, 9
    s_add_u32 s66, s66, s67
    s_sub_u32 s49, s66, s42
    s_mov_b32 s42, s66
    s_bfe_u32 s66, s68, 655360
    s_add_u32 s43, s42, s66
    s_bfe_u32 s39, s69, 655360
    s_bfe_u32 s66, s68, 655370
    s_add_u32 s44, s42, s66
    s_bfe_u32 s40, s69, 655370
    s_bfe_u32 s66, s68, 655380
    s_add_u32 s45, s42, s66
    s_bfe_u32 s41, s69, 655380
    s_and_b32 s66, s46, s33
    s_cselect_b32 s72, -1, 1
    s_cselect_b32 s76, s47, 163712
    s_cmp_ge_u32 s66, 2
    s_cselect_b32 s73, -1, 0
    s_add_u32 s77, s47, 1024
    s_cmp_ge_u32 s66, 4
    s_cselect_b32 s75, -1, 0
    s_cmp_ge_u32 s66, 3
    s_cselect_b32 s74, -1, 1
    s_cselect_b32 s77, s77, 163712
    v_add_u32 v252, s42, v247
    ds_read_u16 v234, v252
    ds_read_u16 v235, v252 offset:64
    v_add_u32 v252, s43, v247
    ds_read_u16 v236, v252
    ds_read_u16 v237, v252 offset:64
    v_add_u32 v252, s44, v247
    ds_read_u16 v238, v252
    ds_read_u16 v239, v252 offset:64
    v_add_u32 v252, s45, v247
    ds_read_u16 v240, v252
    ds_read_u16 v241, v252 offset:64
    s_waitcnt lgkmcnt(8)
    v_lshlrev_b32 v196, 16, v68
    v_and_b32 v197, 0xffff0000, v68
    v_lshlrev_b32 v198, 16, v69
    v_and_b32 v199, 0xffff0000, v69
    v_mul_f32_dpp v200, v242, v196 row_newbcast:0 row_mask:0xf bank_mask:0xf
    v_mul_f32_dpp v201, v242, v197 row_newbcast:1 row_mask:0xf bank_mask:0xf
    v_mul_f32_dpp v202, v242, v196 row_newbcast:8 row_mask:0xf bank_mask:0xf
    v_mul_f32_dpp v203, v242, v197 row_newbcast:9 row_mask:0xf bank_mask:0xf
    v_lshlrev_b32 v196, 16, v70
    v_and_b32 v197, 0xffff0000, v70
    v_cvt_pk_bf16_f32 v64, v200, v201
    v_cvt_pk_bf16_f32 v68, v202, v203
    v_mul_f32_dpp v200, v242, v198 row_newbcast:2 row_mask:0xf bank_mask:0xf
    v_mul_f32_dpp v201, v242, v199 row_newbcast:3 row_mask:0xf bank_mask:0xf
    v_mul_f32_dpp v202, v242, v198 row_newbcast:10 row_mask:0xf bank_mask:0xf
    v_mul_f32_dpp v203, v242, v199 row_newbcast:11 row_mask:0xf bank_mask:0xf
    v_lshlrev_b32 v198, 16, v71
    v_and_b32 v199, 0xffff0000, v71
    v_cvt_pk_bf16_f32 v65, v200, v201
    v_cvt_pk_bf16_f32 v69, v202, v203
    v_mul_f32_dpp v200, v242, v196 row_newbcast:4 row_mask:0xf bank_mask:0xf
    v_mul_f32_dpp v201, v242, v197 row_newbcast:5 row_mask:0xf bank_mask:0xf
    v_mul_f32_dpp v202, v242, v196 row_newbcast:12 row_mask:0xf bank_mask:0xf
    v_mul_f32_dpp v203, v242, v197 row_newbcast:13 row_mask:0xf bank_mask:0xf
    v_cvt_pk_bf16_f32 v66, v200, v201
    v_cvt_pk_bf16_f32 v70, v202, v203
    v_mul_f32_dpp v200, v242, v198 row_newbcast:6 row_mask:0xf bank_mask:0xf
    v_mul_f32_dpp v201, v242, v199 row_newbcast:7 row_mask:0xf bank_mask:0xf
    v_mul_f32_dpp v202, v242, v198 row_newbcast:14 row_mask:0xf bank_mask:0xf
    v_mul_f32_dpp v203, v242, v199 row_newbcast:15 row_mask:0xf bank_mask:0xf
    v_cvt_pk_bf16_f32 v67, v200, v201
    v_cvt_pk_bf16_f32 v71, v202, v203
    s_nop 0
    s_waitcnt lgkmcnt(6)
    v_mfma_f32_32x32x16_bf16 v[0:15], v[64:67], v[176:179], 0
    s_add_u32 m0, s21, 0
    v_mfma_f32_32x32x16_bf16 v[16:31], v[68:71], v[176:179], 0
    v_lshl_add_u32 v234, v234, 10, v246
    v_lshl_add_u32 v235, v235, 10, v246
    buffer_load_dwordx4 v234, s[4:7], s38 offen lds
    buffer_load_dwordx4 v235, s[8:11], s38 offen offset:1024 lds
    v_mfma_f32_32x32x16_bf16 v[32:47], v[64:67], v[180:183], 0
    s_nop 4
    v_mul_f32 v196, v0, v96
    v_fmac_f32 v196, v1, v97
    v_fmac_f32 v196, v2, v98
    v_fmac_f32 v196, v3, v99
    v_fmac_f32 v196, v4, v100
    v_fmac_f32 v196, v5, v101
    v_fmac_f32 v196, v6, v102
    v_fmac_f32 v196, v7, v103
    v_mul_f32 v198, v8, v128
    v_fmac_f32 v198, v9, v129
    v_fmac_f32 v198, v10, v130
    v_fmac_f32 v198, v11, v131
    v_fmac_f32 v198, v12, v132
    v_fmac_f32 v198, v13, v133
    v_fmac_f32 v198, v14, v134
    v_fmac_f32 v198, v15, v135
    v_mul_f32 v200, v16, v128
    v_fmac_f32 v200, v17, v129
    v_permlane32_swap_b32 v196, v198
    v_mfma_f32_32x32x16_bf16 v[48:63], v[68:71], v[180:183], 0
    v_lshl_add_u32 v253, v248, 2, s47
    ds_read_b32 v254, v253
    ds_read_b32 v255, v253 offset:1024
    s_waitcnt vmcnt(6)
    ds_read_b64_tr_b16 v[176:177], v244 offset:2048
    ds_read_b64_tr_b16 v[178:179], v244 offset:3072
    ds_read_b64_tr_b16 v[180:181], v245 offset:2048
    ds_read_b64_tr_b16 v[182:183], v245 offset:3072
    v_fmac_f32 v200, v18, v130
    v_fmac_f32 v200, v19, v131
    v_fmac_f32 v200, v20, v132
    v_fmac_f32 v200, v21, v133
    v_fmac_f32 v200, v22, v134
    v_fmac_f32 v200, v23, v135
    v_add_f32 v198, v196, v198
    v_mul_f32_e64 v202, v24, -v128
    v_fma_f32 v202, v25, -v129, v202
    v_fma_f32 v202, v26, -v130, v202
    v_fma_f32 v202, v27, -v131, v202
    v_fma_f32 v202, v28, -v132, v202
    v_fma_f32 v202, v29, -v133, v202
    v_fma_f32 v202, v30, -v134, v202
    v_fma_f32 v202, v31, -v135, v202
    s_nop 1
    v_permlane32_swap_b32 v200, v202
    v_add_f32 v202, v200, v202
    s_waitcnt lgkmcnt(0)
    v_mfma_f32_32x32x16_bf16 v[0:15], v[64:67], v[176:179], 0
    v_mul_f32 v197, v32, v104
    v_fmac_f32 v197, v33, v105
    v_fmac_f32 v197, v34, v106
    v_fmac_f32 v197, v35, v107
    v_fmac_f32 v197, v36, v108
    v_fmac_f32 v197, v37, v109
    v_fmac_f32 v197, v38, v110
    v_fmac_f32 v197, v39, v111
    v_mul_f32 v199, v40, v136
    v_fmac_f32 v199, v41, v137
    v_fmac_f32 v199, v42, v138
    v_fmac_f32 v199, v43, v139
    v_fmac_f32 v199, v44, v140
    v_fmac_f32 v199, v45, v141
    v_fmac_f32 v199, v46, v142
    v_fmac_f32 v199, v47, v143
    v_mul_f32 v201, v48, v136
    v_fmac_f32 v201, v49, v137
    v_permlane32_swap_b32 v197, v199
    v_fmac_f32 v201, v50, v138
    v_fmac_f32 v201, v51, v139
    s_add_u32 m0, s21, 2048
    v_mfma_f32_32x32x16_bf16 v[16:31], v[68:71], v[176:179], 0
    v_lshl_add_u32 v236, v236, 10, v246
    v_lshl_add_u32 v237, v237, 10, v246
    buffer_load_dwordx4 v236, s[4:7], s39 offen lds
    buffer_load_dwordx4 v237, s[8:11], s39 offen offset:1024 lds
    s_mov_b32 m0, s76
    s_mov_b64 exec, s[72:73]
    buffer_load_dwordx4 v254, s[12:15], 0 offen  lds
    s_mov_b32 m0, s77
    s_mov_b64 exec, s[74:75]
    buffer_load_dwordx4 v255, s[12:15], 0 offen  lds
    s_mov_b64 exec, -1
    v_fmac_f32 v201, v52, v140
    v_fmac_f32 v201, v53, v141
    v_fmac_f32 v201, v54, v142
    v_fmac_f32 v201, v55, v143
    v_add_f32 v199, v197, v199
    v_mul_f32_e64 v203, v56, -v136
    v_fma_f32 v203, v57, -v137, v203
    v_fma_f32 v203, v58, -v138, v203
    v_fma_f32 v203, v59, -v139, v203
    v_fma_f32 v203, v60, -v140, v203
    v_fma_f32 v203, v61, -v141, v203
    v_fma_f32 v203, v62, -v142, v203
    v_fma_f32 v203, v63, -v143, v203
    s_nop 1
    v_permlane32_swap_b32 v201, v203
    v_add_f32 v203, v201, v203
    s_set_gpr_idx_on s51, gpr_idx(DST)
    s_nop 0
    v_cvt_pk_bf16_f32 v204, v198, v199
    v_cvt_pk_bf16_f32 v205, v202, v203
    s_set_gpr_idx_off
    v_mfma_f32_32x32x16_bf16 v[32:47], v[64:67], v[180:183], 0
    v_mul_f32 v196, v0, v144
    v_fmac_f32 v196, v1, v145
    v_fmac_f32 v196, v2, v146
    v_fmac_f32 v196, v3, v147
    v_fmac_f32 v196, v4, v148
    v_fmac_f32 v196, v5, v149
    v_fmac_f32 v196, v6, v150
    v_fmac_f32 v196, v7, v151
    v_mul_f32 v198, v8, v112
    v_fmac_f32 v198, v9, v113
    v_fmac_f32 v198, v10, v114
    v_fmac_f32 v198, v11, v115
    v_fmac_f32 v198, v12, v116
    v_fmac_f32 v198, v13, v117
    v_fmac_f32 v198, v14, v118
    v_fmac_f32 v198, v15, v119
    v_mfma_f32_32x32x16_bf16 v[48:63], v[68:71], v[180:183], 0
    s_waitcnt vmcnt(8)
    ds_read_b64_tr_b16 v[176:177], v244 offset:4096
    ds_read_b64_tr_b16 v[178:179], v244 offset:5120
    ds_read_b64_tr_b16 v[180:181], v245 offset:4096
    ds_read_b64_tr_b16 v[182:183], v245 offset:5120
    v_mul_f32_e64 v200, v16, -v160
    v_fma_f32 v200, v17, -v161, v200
    v_fma_f32 v200, v18, -v162, v200
    v_fma_f32 v200, v19, -v163, v200
    v_fma_f32 v200, v20, -v164, v200
    v_fma_f32 v200, v21, -v165, v200
    v_fma_f32 v200, v22, -v166, v200
    v_fma_f32 v200, v23, -v167, v200
    v_mul_f32_e64 v202, v24, -v160
    v_fma_f32 v202, v25, -v161, v202
    v_fma_f32 v202, v26, -v162, v202
    v_fma_f32 v202, v27, -v163, v202
    v_fma_f32 v202, v28, -v164, v202
    v_fma_f32 v202, v29, -v165, v202
    v_fma_f32 v202, v30, -v166, v202
    v_fma_f32 v202, v31, -v167, v202
    s_waitcnt lgkmcnt(0)
    v_mfma_f32_32x32x16_bf16 v[0:15], v[64:67], v[176:179], 0
    v_mul_f32 v197, v32, v152
    v_fmac_f32 v197, v33, v153
    v_fmac_f32 v197, v34, v154
    v_fmac_f32 v197, v35, v155
    v_fmac_f32 v197, v36, v156
    v_fmac_f32 v197, v37, v157
    v_fmac_f32 v197, v38, v158
    v_fmac_f32 v197, v39, v159
    v_mul_f32 v199, v40, v120
    v_fmac_f32 v199, v41, v121
    v_fmac_f32 v199, v42, v122
    v_fmac_f32 v199, v43, v123
    v_fmac_f32 v199, v44, v124
    v_fmac_f32 v199, v45, v125
    v_fmac_f32 v199, v46, v126
    v_fmac_f32 v199, v47, v127
    s_add_u32 m0, s21, 4096
    v_mfma_f32_32x32x16_bf16 v[16:31], v[68:71], v[176:179], 0
    v_lshl_add_u32 v238, v238, 10, v246
    v_lshl_add_u32 v239, v239, 10, v246
    buffer_load_dwordx4 v238, s[4:7], s40 offen lds
    buffer_load_dwordx4 v239, s[8:11], s40 offen offset:1024 lds
    v_mul_f32_e64 v201, v48, -v168
    v_fma_f32 v201, v49, -v169, v201
    v_fma_f32 v201, v50, -v170, v201
    v_fma_f32 v201, v51, -v171, v201
    v_fma_f32 v201, v52, -v172, v201
    v_fma_f32 v201, v53, -v173, v201
    v_fma_f32 v201, v54, -v174, v201
    v_fma_f32 v201, v55, -v175, v201
    v_mul_f32_e64 v203, v56, -v168
    v_fma_f32 v203, v57, -v169, v203
    v_fma_f32 v203, v58, -v170, v203
    v_fma_f32 v203, v59, -v171, v203
    v_fma_f32 v203, v60, -v172, v203
    v_fma_f32 v203, v61, -v173, v203
    v_fma_f32 v203, v62, -v174, v203
    v_fma_f32 v203, v63, -v175, v203
    v_mfma_f32_32x32x16_bf16 v[32:47], v[64:67], v[180:183], 0
    v_mul_f32 v254, v0, v144
    v_fmac_f32 v254, v1, v145
    v_fmac_f32 v254, v2, v146
    v_fmac_f32 v254, v3, v147
    v_fmac_f32 v254, v4, v148
    v_fmac_f32 v254, v5, v149
    v_fmac_f32 v254, v6, v150
    v_fmac_f32 v254, v7, v151
    v_fmac_f32 v200, v8, v160
    v_mfma_f32_32x32x16_bf16 v[48:63], v[68:71], v[180:183], 0
    ds_swizzle_b32 v68, v68 offset:0x401F
    ds_swizzle_b32 v69, v69 offset:0x401F
    ds_swizzle_b32 v70, v70 offset:0x401F
    ds_swizzle_b32 v71, v71 offset:0x401F
    s_waitcnt vmcnt(8)
    ds_read_b64_tr_b16 v[176:177], v244 offset:6144
    ds_read_b64_tr_b16 v[178:179], v244 offset:7168
    ds_read_b64_tr_b16 v[180:181], v245 offset:6144
    ds_read_b64_tr_b16 v[182:183], v245 offset:7168
    v_fmac_f32 v200, v9, v161
    v_permlane32_swap_b32 v196, v254
    v_fmac_f32 v200, v10, v162
    v_fmac_f32 v200, v11, v163
    v_fmac_f32 v200, v12, v164
    v_fmac_f32 v200, v13, v165
    v_fmac_f32 v200, v14, v166
    v_fmac_f32 v200, v15, v167
    v_add_f32 v254, v196, v254
    s_waitcnt lgkmcnt(0)
    s_mov_b64 exec, s[56:57]
    v_xor_b32 v68, 0x80008000, v68
    v_xor_b32 v69, 0x80008000, v69
    v_xor_b32 v70, 0x80008000, v70
    v_xor_b32 v71, 0x80008000, v71
    s_mov_b64 exec, -1
    s_nop 0
    v_mfma_f32_32x32x16_bf16 v[0:15], v[64:67], v[176:179], 0
    v_mul_f32 v255, v32, v152
    v_fmac_f32 v255, v33, v153
    v_fmac_f32 v255, v34, v154
    v_fmac_f32 v255, v35, v155
    v_fmac_f32 v255, v36, v156
    v_fmac_f32 v255, v37, v157
    v_fmac_f32 v255, v38, v158
    v_fmac_f32 v255, v39, v159
    v_fmac_f32 v201, v40, v168
    v_fmac_f32 v201, v41, v169
    v_permlane32_swap_b32 v197, v255
    s_add_u32 m0, s21, 6144
    v_mfma_f32_32x32x16_bf16 v[16:31], v[68:71], v[176:179], v[16:31]
    v_lshl_add_u32 v240, v240, 10, v246
    v_lshl_add_u32 v241, v241, 10, v246
    buffer_load_dwordx4 v240, s[4:7], s41 offen lds
    buffer_load_dwordx4 v241, s[8:11], s41 offen offset:1024 lds
    v_fmac_f32 v201, v42, v170
    v_fmac_f32 v201, v43, v171
    v_fmac_f32 v201, v44, v172
    v_fmac_f32 v201, v45, v173
    v_fmac_f32 v201, v46, v174
    v_fmac_f32 v201, v47, v175
    v_add_f32 v255, v197, v255
    s_set_gpr_idx_on s51, gpr_idx(DST)
    s_nop 0
    v_cvt_pk_bf16_f32 v206, v254, v255
    s_set_gpr_idx_off
    v_mfma_f32_32x32x16_bf16 v[32:47], v[64:67], v[180:183], 0
    v_mul_f32 v254, v0, v144
    v_fmac_f32 v254, v1, v145
    v_fmac_f32 v254, v2, v146
    v_fmac_f32 v254, v3, v147
    v_fmac_f32 v254, v4, v148
    v_fmac_f32 v254, v5, v149
    v_fmac_f32 v254, v6, v150
    v_fmac_f32 v254, v7, v151
    v_fma_f32 v202, v8, -v160, v202
    v_fma_f32 v202, v9, -v161, v202
    v_permlane32_swap_b32 v254, v200
    v_fma_f32 v202, v10, -v162, v202
    v_fma_f32 v202, v11, -v163, v202
    v_fma_f32 v202, v12, -v164, v202
    v_fma_f32 v202, v13, -v165, v202
    v_fma_f32 v202, v14, -v166, v202
    v_fma_f32 v202, v15, -v167, v202
    v_add_f32 v200, v254, v200
    v_fmac_f32 v198, v16, v112
    v_permlane32_swap_b32 v202, v254
    v_mfma_f32_32x32x16_bf16 v[48:63], v[68:71], v[180:183], v[48:63]
    s_waitcnt vmcnt(4)
    ds_read_b64_tr_b16 v[176:177], v244 offset:0
    ds_read_b64_tr_b16 v[178:179], v244 offset:1024
    ds_read_b64_tr_b16 v[180:181], v245 offset:0
    ds_read_b64_tr_b16 v[182:183], v245 offset:1024
    v_add_u32 v249, s48, v249
    v_add_u32 v250, s49, v250
    ds_read_b32 v252, v251 offset:16
    ds_read_b64_tr_b16 v[68:69], v249 offset:0
    ds_read_b64_tr_b16 v[70:71], v249 offset:256
    s_mov_b64 exec, s[54:55]
    ds_read_u16_d16_hi v242, v250 offset:0
    s_mov_b64 exec, -1
    v_fmac_f32 v198, v17, v113
    v_fmac_f32 v198, v18, v114
    v_fmac_f32 v198, v19, v115
    v_fmac_f32 v198, v20, v116
    v_fmac_f32 v198, v21, v117
    v_fmac_f32 v198, v22, v118
    v_fmac_f32 v198, v23, v119
    v_add_f32 v254, v202, v254
    v_mul_f32 v196, v24, v160
    v_fmac_f32 v196, v25, v161
    v_fmac_f32 v196, v26, v162
    v_fmac_f32 v196, v27, v163
    v_fmac_f32 v196, v28, v164
    v_fmac_f32 v196, v29, v165
    v_fmac_f32 v196, v30, v166
    v_fmac_f32 v196, v31, v167
    s_nop 1
    v_permlane32_swap_b32 v198, v196
    v_add_f32 v196, v198, v196
    v_mul_f32 v255, v32, v152
    v_fmac_f32 v255, v33, v153
    v_fmac_f32 v255, v34, v154
    v_fmac_f32 v255, v35, v155
    v_fmac_f32 v255, v36, v156
    v_fmac_f32 v255, v37, v157
    v_fmac_f32 v255, v38, v158
    v_fmac_f32 v255, v39, v159
    v_fma_f32 v203, v40, -v168, v203
    v_fma_f32 v203, v41, -v169, v203
    v_permlane32_swap_b32 v255, v201
    v_fma_f32 v203, v42, -v170, v203
    v_fma_f32 v203, v43, -v171, v203
    v_fma_f32 v203, v44, -v172, v203
    v_fma_f32 v203, v45, -v173, v203
    v_fma_f32 v203, v46, -v174, v203
    v_fma_f32 v203, v47, -v175, v203
    v_add_f32 v201, v255, v201
    v_fmac_f32 v199, v48, v120
    v_permlane32_swap_b32 v203, v255
    v_fmac_f32 v199, v49, v121
    v_fmac_f32 v199, v50, v122
    v_fmac_f32 v199, v51, v123
    v_fmac_f32 v199, v52, v124
    v_fmac_f32 v199, v53, v125
    v_fmac_f32 v199, v54, v126
    v_fmac_f32 v199, v55, v127
    v_add_f32 v255, v203, v255
    v_mul_f32 v197, v56, v168
    v_fmac_f32 v197, v57, v169
    v_fmac_f32 v197, v58, v170
    v_fmac_f32 v197, v59, v171
    v_fmac_f32 v197, v60, v172
    v_fmac_f32 v197, v61, v173
    v_fmac_f32 v197, v62, v174
    v_fmac_f32 v197, v63, v175
    s_nop 1
    v_permlane32_swap_b32 v199, v197
    v_add_f32 v197, v199, v197
    s_set_gpr_idx_on s51, gpr_idx(DST)
    s_nop 0
    v_cvt_pk_bf16_f32 v207, v200, v201
    v_cvt_pk_bf16_f32 v209, v254, v255
    v_cvt_pk_bf16_f32 v208, v196, v197
    s_set_gpr_idx_off
    s_add_u32 s50, s50, 1
    s_add_u32 s51, s51, 6
    s_cmp_ge_u32 s50, 4
    s_cbranch_scc1 LAST0
    s_waitcnt lgkmcnt(3)
    v_readfirstlane_b32 s66, v252
    s_add_u32 s53, s53, 1
    v_mov_b32 v252, s53
    s_cmp_le_u32 s53, s66
    ds_write2_b32 v251, v252, v252 offset0:0 offset1:8
    s_setprio 1
    s_cbranch_scc1 PRIO_9
    s_setprio 0
PRIO_9:
    s_cmp_eq_u32 s52, 4
    s_cbranch_scc1 ITEM_0_4
    s_cmp_eq_u32 s52, 5
    s_cbranch_scc1 ITEM_0_5
    s_cmp_eq_u32 s52, 3
    s_cbranch_scc1 ITEM_0_3
    s_cmp_eq_u32 s52, 6
    s_cbranch_scc1 ITEM_0_6
    s_cmp_eq_u32 s52, 8
    s_cbranch_scc1 ITEM_0_8
    s_branch ITEM_0_2
.p2align 6
ITEM_1_4:
    s_mov_b64 exec, s[54:55]
    ds_read_u16_d16_hi v243, v250 offset:128
    s_mov_b64 exec, -1
    ds_read_b64_tr_b16 v[76:77], v249 offset:512
    ds_read_b64_tr_b16 v[78:79], v249 offset:768
    s_waitcnt lgkmcnt(3)
    v_lshlrev_b32 v196, 16, v68
    v_and_b32 v197, 0xffff0000, v68
    v_lshlrev_b32 v198, 16, v69
    v_and_b32 v199, 0xffff0000, v69
    v_mul_f32_dpp v200, v242, v196 row_newbcast:0 row_mask:0xf bank_mask:0xf
    v_mul_f32_dpp v201, v242, v197 row_newbcast:1 row_mask:0xf bank_mask:0xf
    v_mul_f32_dpp v202, v242, v196 row_newbcast:8 row_mask:0xf bank_mask:0xf
    v_mul_f32_dpp v203, v242, v197 row_newbcast:9 row_mask:0xf bank_mask:0xf
    v_lshlrev_b32 v196, 16, v70
    v_and_b32 v197, 0xffff0000, v70
    v_cvt_pk_bf16_f32 v64, v200, v201
    v_cvt_pk_bf16_f32 v68, v202, v203
    v_mul_f32_dpp v200, v242, v198 row_newbcast:2 row_mask:0xf bank_mask:0xf
    v_mul_f32_dpp v201, v242, v199 row_newbcast:3 row_mask:0xf bank_mask:0xf
    v_mul_f32_dpp v202, v242, v198 row_newbcast:10 row_mask:0xf bank_mask:0xf
    v_mul_f32_dpp v203, v242, v199 row_newbcast:11 row_mask:0xf bank_mask:0xf
    v_lshlrev_b32 v198, 16, v71
    v_and_b32 v199, 0xffff0000, v71
    v_cvt_pk_bf16_f32 v65, v200, v201
    v_cvt_pk_bf16_f32 v69, v202, v203
    v_mul_f32_dpp v200, v242, v196 row_newbcast:4 row_mask:0xf bank_mask:0xf
    v_mul_f32_dpp v201, v242, v197 row_newbcast:5 row_mask:0xf bank_mask:0xf
    v_mul_f32_dpp v202, v242, v196 row_newbcast:12 row_mask:0xf bank_mask:0xf
    v_mul_f32_dpp v203, v242, v197 row_newbcast:13 row_mask:0xf bank_mask:0xf
    v_cvt_pk_bf16_f32 v66, v200, v201
    v_cvt_pk_bf16_f32 v70, v202, v203
    v_mul_f32_dpp v200, v242, v198 row_newbcast:6 row_mask:0xf bank_mask:0xf
    v_mul_f32_dpp v201, v242, v199 row_newbcast:7 row_mask:0xf bank_mask:0xf
    v_mul_f32_dpp v202, v242, v198 row_newbcast:14 row_mask:0xf bank_mask:0xf
    v_mul_f32_dpp v203, v242, v199 row_newbcast:15 row_mask:0xf bank_mask:0xf
    v_cvt_pk_bf16_f32 v67, v200, v201
    v_cvt_pk_bf16_f32 v71, v202, v203
    s_nop 0
    s_waitcnt vmcnt(4) lgkmcnt(0)
    v_mfma_f32_32x32x16_bf16 v[0:15], v[64:67], v[176:179], 0
    v_lshlrev_b32 v196, 16, v76
    v_and_b32 v197, 0xffff0000, v76
    v_lshlrev_b32 v198, 16, v77
    v_and_b32 v199, 0xffff0000, v77
    v_mul_f32_dpp v200, v243, v196 row_newbcast:0 row_mask:0xf bank_mask:0xf
    v_mul_f32_dpp v201, v243, v197 row_newbcast:1 row_mask:0xf bank_mask:0xf
    v_mul_f32_dpp v202, v243, v196 row_newbcast:8 row_mask:0xf bank_mask:0xf
    v_mul_f32_dpp v203, v243, v197 row_newbcast:9 row_mask:0xf bank_mask:0xf
    v_lshlrev_b32 v196, 16, v78
    v_and_b32 v197, 0xffff0000, v78
    v_cvt_pk_bf16_f32 v72, v200, v201
    v_cvt_pk_bf16_f32 v76, v202, v203
    v_mul_f32_dpp v200, v243, v198 row_newbcast:2 row_mask:0xf bank_mask:0xf
    v_mul_f32_dpp v201, v243, v199 row_newbcast:3 row_mask:0xf bank_mask:0xf
    v_mul_f32_dpp v202, v243, v198 row_newbcast:10 row_mask:0xf bank_mask:0xf
    v_mul_f32_dpp v203, v243, v199 row_newbcast:11 row_mask:0xf bank_mask:0xf
    s_add_u32 m0, s21, 0
    v_mfma_f32_32x32x16_bf16 v[16:31], v[68:71], v[176:179], 0
    buffer_load_dwordx4 v234, s[4:7], s36 offen lds
    buffer_load_dwordx4 v235, s[8:11], s36 offen offset:1024 lds
    ds_read_b64_tr_b16 v[176:177], v244 offset:2048
    ds_read_b64_tr_b16 v[178:179], v244 offset:3072
    ds_read_b64_tr_b16 v[184:185], v245 offset:2048
    ds_read_b64_tr_b16 v[186:187], v245 offset:3072
    v_lshlrev_b32 v198, 16, v79
    v_and_b32 v199, 0xffff0000, v79
    v_cvt_pk_bf16_f32 v73, v200, v201
    v_cvt_pk_bf16_f32 v77, v202, v203
    v_mul_f32_dpp v200, v243, v196 row_newbcast:4 row_mask:0xf bank_mask:0xf
    v_mul_f32_dpp v201, v243, v197 row_newbcast:5 row_mask:0xf bank_mask:0xf
    v_mul_f32_dpp v202, v243, v196 row_newbcast:12 row_mask:0xf bank_mask:0xf
    v_mul_f32_dpp v203, v243, v197 row_newbcast:13 row_mask:0xf bank_mask:0xf
    v_cvt_pk_bf16_f32 v74, v200, v201
    v_cvt_pk_bf16_f32 v78, v202, v203
    v_mul_f32_dpp v200, v243, v198 row_newbcast:6 row_mask:0xf bank_mask:0xf
    v_mul_f32_dpp v201, v243, v199 row_newbcast:7 row_mask:0xf bank_mask:0xf
    v_mul_f32_dpp v202, v243, v198 row_newbcast:14 row_mask:0xf bank_mask:0xf
    v_mul_f32_dpp v203, v243, v199 row_newbcast:15 row_mask:0xf bank_mask:0xf
    v_cvt_pk_bf16_f32 v75, v200, v201
    v_cvt_pk_bf16_f32 v79, v202, v203
    s_nop 0
    s_waitcnt lgkmcnt(0)
    v_mfma_f32_32x32x16_bf16 v[0:15], v[72:75], v[176:179], v[0:15]
    s_add_u32 m0, s21, 2048
    v_mfma_f32_32x32x16_bf16 v[16:31], v[76:79], v[176:179], v[16:31]
    buffer_load_dwordx4 v236, s[4:7], s36 offen lds
    buffer_load_dwordx4 v237, s[8:11], s36 offen offset:1024 lds
    s_mov_b32 m0, s50
    s_nop 0
    s_movrels_b32 s71, s23
    s_movrels_b32 s33, s28
    s_and_b32 s70, s33, 0x70
    s_andn2_b32 s33, s33, 0x70
    v_xor_b32 v253, s70, v248
    v_add_u32 v253, s33, v253
    s_bfe_u32 s46, s71, 0x30012
    s_mov_b32 m0, s46
    s_and_b32 s66, s71, 0x3ffff
    s_movrels_b32 s68, s57
    s_movrels_b32 s69, s61
    s_sub_u32 s48, s66, s47
    s_mov_b32 s47, s66
    s_lshr_b32 s52, s71, 28
    s_lshl_b32 s67, s46, 9
    s_add_u32 s66, s66, s67
    s_sub_u32 s49, s66, s42
    s_mov_b32 s42, s66
    s_bfe_u32 s66, s68, 655360
    s_add_u32 s43, s42, s66
    s_bfe_u32 s39, s69, 655360
    s_bfe_u32 s66, s68, 655370
    s_add_u32 s44, s42, s66
    s_bfe_u32 s40, s69, 655370
    s_bfe_u32 s66, s68, 655380
    s_add_u32 s45, s42, s66
    s_bfe_u32 s41, s69, 655380
    v_add_u32 v252, s44, v247
    ds_read_u16 v238, v252
    ds_read_u16 v239, v252 offset:64
    v_add_u32 v252, s45, v247
    ds_read_u16 v240, v252
    ds_read_u16 v241, v252 offset:64
    v_mfma_f32_32x32x16_bf16 v[32:47], v[64:67], v[180:183], 0
    v_mul_f32 v196, v0, v96
    v_fmac_f32 v196, v1, v97
    v_fmac_f32 v196, v2, v98
    v_fmac_f32 v196, v3, v99
    v_fmac_f32 v196, v4, v100
    v_fmac_f32 v196, v5, v101
    v_fmac_f32 v196, v6, v102
    v_fmac_f32 v196, v7, v103
    v_mul_f32 v198, v8, v128
    v_fmac_f32 v198, v9, v129
    v_mfma_f32_32x32x16_bf16 v[48:63], v[68:71], v[180:183], 0
    s_waitcnt vmcnt(6)
    ds_read_b64_tr_b16 v[176:177], v244 offset:4096
    ds_read_b64_tr_b16 v[178:179], v244 offset:5120
    ds_read_b64_tr_b16 v[180:181], v245 offset:4096
    ds_read_b64_tr_b16 v[182:183], v245 offset:5120
    v_fmac_f32 v198, v10, v130
    v_fmac_f32 v198, v11, v131
    v_fmac_f32 v198, v12, v132
    v_fmac_f32 v198, v13, v133
    v_fmac_f32 v198, v14, v134
    v_fmac_f32 v198, v15, v135
    v_mul_f32 v200, v16, v128
    v_fmac_f32 v200, v17, v129
    v_permlane32_swap_b32 v196, v198
    v_mfma_f32_32x32x16_bf16 v[32:47], v[72:75], v[184:187], v[32:47]
    v_fmac_f32 v200, v18, v130
    v_fmac_f32 v200, v19, v131
    v_fmac_f32 v200, v20, v132
    v_fmac_f32 v200, v21, v133
    v_fmac_f32 v200, v22, v134
    v_fmac_f32 v200, v23, v135
    v_add_f32 v198, v196, v198
    v_mul_f32_e64 v202, v24, -v128
    v_fma_f32 v202, v25, -v129, v202
    v_mfma_f32_32x32x16_bf16 v[48:63], v[76:79], v[184:187], v[48:63]
    v_fma_f32 v202, v26, -v130, v202
    v_fma_f32 v202, v27, -v131, v202
    v_fma_f32 v202, v28, -v132, v202
    v_fma_f32 v202, v29, -v133, v202
    v_fma_f32 v202, v30, -v134, v202
    v_fma_f32 v202, v31, -v135, v202
    s_nop 1
    v_permlane32_swap_b32 v200, v202
    v_add_f32 v202, v200, v202
    s_waitcnt vmcnt(4) lgkmcnt(0)
    v_mfma_f32_32x32x16_bf16 v[0:15], v[64:67], v[176:179], 0
    v_mul_f32 v197, v32, v104
    v_fmac_f32 v197, v33, v105
    v_fmac_f32 v197, v34, v106
    v_fmac_f32 v197, v35, v107
    v_fmac_f32 v197, v36, v108
    v_fmac_f32 v197, v37, v109
    v_fmac_f32 v197, v38, v110
    v_fmac_f32 v197, v39, v111
    v_mul_f32 v199, v40, v136
    v_fmac_f32 v199, v41, v137
    v_fmac_f32 v199, v42, v138
    s_add_u32 m0, s21, 4096
    v_mfma_f32_32x32x16_bf16 v[16:31], v[68:71], v[176:179], 0
    buffer_load_dwordx4 v234, s[4:7], s37 offen lds
    buffer_load_dwordx4 v235, s[8:11], s37 offen offset:1024 lds
    ds_read_b64_tr_b16 v[176:177], v244 offset:6144
    ds_read_b64_tr_b16 v[178:179], v244 offset:7168
    ds_read_b64_tr_b16 v[184:185], v245 offset:6144
    ds_read_b64_tr_b16 v[186:187], v245 offset:7168
    v_add_u32 v252, s42, v247
    ds_read_u16 v234, v252
    ds_read_u16 v235, v252 offset:64
    v_fmac_f32 v199, v43, v139
    v_fmac_f32 v199, v44, v140
    v_fmac_f32 v199, v45, v141
    v_fmac_f32 v199, v46, v142
    v_fmac_f32 v199, v47, v143
    v_mul_f32 v201, v48, v136
    v_fmac_f32 v201, v49, v137
    v_permlane32_swap_b32 v197, v199
    v_fmac_f32 v201, v50, v138
    v_fmac_f32 v201, v51, v139
    s_waitcnt lgkmcnt(2)
    v_mfma_f32_32x32x16_bf16 v[0:15], v[72:75], v[176:179], v[0:15]
    v_fmac_f32 v201, v52, v140
    v_fmac_f32 v201, v53, v141
    v_fmac_f32 v201, v54, v142
    v_fmac_f32 v201, v55, v143
    v_add_f32 v199, v197, v199
    v_mul_f32_e64 v203, v56, -v136
    v_fma_f32 v203, v57, -v137, v203
    v_fma_f32 v203, v58, -v138, v203
    v_fma_f32 v203, v59, -v139, v203
    v_fma_f32 v203, v60, -v140, v203
    s_add_u32 m0, s21, 6144
    v_mfma_f32_32x32x16_bf16 v[16:31], v[76:79], v[176:179], v[16:31]
    buffer_load_dwordx4 v236, s[4:7], s37 offen lds
    buffer_load_dwordx4 v237, s[8:11], s37 offen offset:1024 lds
    v_add_u32 v252, s43, v247
    ds_read_u16 v236, v252
    ds_read_u16 v237, v252 offset:64
    v_fma_f32 v203, v61, -v141, v203
    v_fma_f32 v203, v62, -v142, v203
    v_fma_f32 v203, v63, -v143, v203
    s_nop 1
    v_permlane32_swap_b32 v201, v203
    v_add_f32 v203, v201, v203
    v_cvt_pk_bf16_f32 v198, v198, v199
    v_cvt_pk_bf16_f32 v202, v202, v203
    ds_write_b32 v253, v198 offset:0
    ds_write_b32 v253, v202 offset:256
    v_mfma_f32_32x32x16_bf16 v[32:47], v[64:67], v[180:183], 0
    v_mul_f32 v196, v0, v144
    v_fmac_f32 v196, v1, v145
    v_fmac_f32 v196, v2, v146
    v_fmac_f32 v196, v3, v147
    v_fmac_f32 v196, v4, v148
    v_fmac_f32 v196, v5, v149
    v_fmac_f32 v196, v6, v150
    v_fmac_f32 v196, v7, v151
    v_mfma_f32_32x32x16_bf16 v[48:63], v[68:71], v[180:183], 0
    s_waitcnt vmcnt(6)
    ds_read_b64_tr_b16 v[176:177], v244 offset:0
    ds_read_b64_tr_b16 v[178:179], v244 offset:1024
    ds_read_b64_tr_b16 v[180:181], v245 offset:0
    ds_read_b64_tr_b16 v[182:183], v245 offset:1024
    v_mul_f32 v198, v8, v112
    v_fmac_f32 v198, v9, v113
    v_fmac_f32 v198, v10, v114
    v_fmac_f32 v198, v11, v115
    v_fmac_f32 v198, v12, v116
    v_fmac_f32 v198, v13, v117
    v_fmac_f32 v198, v14, v118
    v_fmac_f32 v198, v15, v119
    v_mfma_f32_32x32x16_bf16 v[32:47], v[72:75], v[184:187], v[32:47]
    v_mul_f32_e64 v200, v16, -v160
    v_fma_f32 v200, v17, -v161, v200
    v_fma_f32 v200, v18, -v162, v200
    v_fma_f32 v200, v19, -v163, v200
    v_fma_f32 v200, v20, -v164, v200
    v_fma_f32 v200, v21, -v165, v200
    v_fma_f32 v200, v22, -v166, v200
    v_fma_f32 v200, v23, -v167, v200
    v_mfma_f32_32x32x16_bf16 v[48:63], v[76:79], v[184:187], v[48:63]
    v_mul_f32_e64 v202, v24, -v160
    v_fma_f32 v202, v25, -v161, v202
    v_fma_f32 v202, v26, -v162, v202
    v_fma_f32 v202, v27, -v163, v202
    v_fma_f32 v202, v28, -v164, v202
    v_fma_f32 v202, v29, -v165, v202
    v_fma_f32 v202, v30, -v166, v202
    v_fma_f32 v202, v31, -v167, v202
    s_waitcnt vmcnt(4) lgkmcnt(0)
    v_mfma_f32_32x32x16_bf16 v[0:15], v[64:67], v[176:179], 0
    v_mul_f32 v197, v32, v152
    v_fmac_f32 v197, v33, v153
    v_fmac_f32 v197, v34, v154
    v_fmac_f32 v197, v35, v155
    v_fmac_f32 v197, v36, v156
    v_fmac_f32 v197, v37, v157
    v_fmac_f32 v197, v38, v158
    v_fmac_f32 v197, v39, v159
    s_add_u32 m0, s21, 0
    v_mfma_f32_32x32x16_bf16 v[16:31], v[68:71], v[176:179], 0
    v_lshl_add_u32 v234, v234, 10, v246
    v_lshl_add_u32 v235, v235, 10, v246
    buffer_load_dwordx4 v234, s[4:7], s38 offen lds
    buffer_load_dwordx4 v235, s[8:11], s38 offen offset:1024 lds
    ds_read_b64_tr_b16 v[176:177], v244 offset:2048
    ds_read_b64_tr_b16 v[178:179], v244 offset:3072
    ds_read_b64_tr_b16 v[184:185], v245 offset:2048
    ds_read_b64_tr_b16 v[186:187], v245 offset:3072
    v_mul_f32 v199, v40, v120
    v_fmac_f32 v199, v41, v121
    v_fmac_f32 v199, v42, v122
    v_fmac_f32 v199, v43, v123
    v_fmac_f32 v199, v44, v124
    v_fmac_f32 v199, v45, v125
    v_fmac_f32 v199, v46, v126
    v_fmac_f32 v199, v47, v127
    s_waitcnt lgkmcnt(0)
    v_mfma_f32_32x32x16_bf16 v[0:15], v[72:75], v[176:179], v[0:15]
    v_mul_f32_e64 v201, v48, -v168
    v_fma_f32 v201, v49, -v169, v201
    v_fma_f32 v201, v50, -v170, v201
    v_fma_f32 v201, v51, -v171, v201
    v_fma_f32 v201, v52, -v172, v201
    v_fma_f32 v201, v53, -v173, v201
    v_fma_f32 v201, v54, -v174, v201
    v_fma_f32 v201, v55, -v175, v201
    s_add_u32 m0, s21, 2048
    v_mfma_f32_32x32x16_bf16 v[16:31], v[76:79], v[176:179], v[16:31]
    v_lshl_add_u32 v236, v236, 10, v246
    v_lshl_add_u32 v237, v237, 10, v246
    buffer_load_dwordx4 v236, s[4:7], s39 offen lds
    buffer_load_dwordx4 v237, s[8:11], s39 offen offset:1024 lds
    v_mul_f32_e64 v203, v56, -v168
    v_fma_f32 v203, v57, -v169, v203
    v_fma_f32 v203, v58, -v170, v203
    v_fma_f32 v203, v59, -v171, v203
    v_fma_f32 v203, v60, -v172, v203
    v_fma_f32 v203, v61, -v173, v203
    v_fma_f32 v203, v62, -v174, v203
    v_fma_f32 v203, v63, -v175, v203
    v_mfma_f32_32x32x16_bf16 v[32:47], v[64:67], v[180:183], 0
    v_mul_f32 v254, v0, v144
    v_fmac_f32 v254, v1, v145
    v_fmac_f32 v254, v2, v146
    v_fmac_f32 v254, v3, v147
    v_fmac_f32 v254, v4, v148
    v_mfma_f32_32x32x16_bf16 v[48:63], v[68:71], v[180:183], 0
    ds_swizzle_b32 v68, v68 offset:0x401F
    ds_swizzle_b32 v69, v69 offset:0x401F
    ds_swizzle_b32 v70, v70 offset:0x401F
    ds_swizzle_b32 v71, v71 offset:0x401F
    s_waitcnt vmcnt(6)
    ds_read_b64_tr_b16 v[176:177], v244 offset:4096
    ds_read_b64_tr_b16 v[178:179], v244 offset:5120
    ds_read_b64_tr_b16 v[180:181], v245 offset:4096
    ds_read_b64_tr_b16 v[182:183], v245 offset:5120
    v_fmac_f32 v254, v5, v149
    v_fmac_f32 v254, v6, v150
    v_fmac_f32 v254, v7, v151
    v_fmac_f32 v200, v8, v160
    v_mfma_f32_32x32x16_bf16 v[32:47], v[72:75], v[184:187], v[32:47]
    v_fmac_f32 v200, v9, v161
    v_permlane32_swap_b32 v196, v254
    v_fmac_f32 v200, v10, v162
    v_fmac_f32 v200, v11, v163
    v_fmac_f32 v200, v12, v164
    v_mfma_f32_32x32x16_bf16 v[48:63], v[76:79], v[184:187], v[48:63]
    ds_swizzle_b32 v76, v76 offset:0x401F
    ds_swizzle_b32 v77, v77 offset:0x401F
    ds_swizzle_b32 v78, v78 offset:0x401F
    ds_swizzle_b32 v79, v79 offset:0x401F
    v_fmac_f32 v200, v13, v165
    v_fmac_f32 v200, v14, v166
    v_fmac_f32 v200, v15, v167
    v_add_f32 v254, v196, v254
    s_waitcnt lgkmcnt(8)
    s_mov_b64 exec, s[56:57]
    v_xor_b32 v68, 0x80008000, v68
    v_xor_b32 v69, 0x80008000, v69
    v_xor_b32 v70, 0x80008000, v70
    v_xor_b32 v71, 0x80008000, v71
    s_mov_b64 exec, -1
    s_waitcnt vmcnt(4) lgkmcnt(4)
    v_mfma_f32_32x32x16_bf16 v[0:15], v[64:67], v[176:179], 0
    v_mul_f32 v255, v32, v152
    v_fmac_f32 v255, v33, v153
    v_fmac_f32 v255, v34, v154
    v_fmac_f32 v255, v35, v155
    v_fmac_f32 v255, v36, v156
    s_add_u32 m0, s21, 4096
    v_mfma_f32_32x32x16_bf16 v[16:31], v[68:71], v[176:179], v[16:31]
    v_lshl_add_u32 v238, v238, 10, v246
    v_lshl_add_u32 v239, v239, 10, v246
    buffer_load_dwordx4 v238, s[4:7], s40 offen lds
    buffer_load_dwordx4 v239, s[8:11], s40 offen offset:1024 lds
    ds_read_b64_tr_b16 v[176:177], v244 offset:6144
    ds_read_b64_tr_b16 v[178:179], v244 offset:7168
    ds_read_b64_tr_b16 v[184:185], v245 offset:6144
    ds_read_b64_tr_b16 v[186:187], v245 offset:7168
    v_fmac_f32 v255, v37, v157
    v_fmac_f32 v255, v38, v158
    v_fmac_f32 v255, v39, v159
    v_fmac_f32 v201, v40, v168
    v_fmac_f32 v201, v41, v169
    s_waitcnt lgkmcnt(0)
    s_mov_b64 exec, s[56:57]
    v_xor_b32 v76, 0x80008000, v76
    v_xor_b32 v77, 0x80008000, v77
    v_xor_b32 v78, 0x80008000, v78
    v_xor_b32 v79, 0x80008000, v79
    s_mov_b64 exec, -1
    v_mfma_f32_32x32x16_bf16 v[0:15], v[72:75], v[176:179], v[0:15]
    v_permlane32_swap_b32 v197, v255
    v_fmac_f32 v201, v42, v170
    v_fmac_f32 v201, v43, v171
    v_fmac_f32 v201, v44, v172
    v_fmac_f32 v201, v45, v173
    s_add_u32 m0, s21, 6144
    v_mfma_f32_32x32x16_bf16 v[16:31], v[76:79], v[176:179], v[16:31]
    v_lshl_add_u32 v240, v240, 10, v246
    v_lshl_add_u32 v241, v241, 10, v246
    buffer_load_dwordx4 v240, s[4:7], s41 offen lds
    buffer_load_dwordx4 v241, s[8:11], s41 offen offset:1024 lds
    v_fmac_f32 v201, v46, v174
    v_fmac_f32 v201, v47, v175
    v_add_f32 v255, v197, v255
    v_cvt_pk_bf16_f32 v254, v254, v255
    ds_write_b32 v253, v254 offset:512
    v_mfma_f32_32x32x16_bf16 v[32:47], v[64:67], v[180:183], 0
    v_mul_f32 v254, v0, v144
    v_fmac_f32 v254, v1, v145
    v_fmac_f32 v254, v2, v146
    v_fmac_f32 v254, v3, v147
    v_fmac_f32 v254, v4, v148
    v_fmac_f32 v254, v5, v149
    v_fmac_f32 v254, v6, v150
    v_fmac_f32 v254, v7, v151
    v_fma_f32 v202, v8, -v160, v202
    v_fma_f32 v202, v9, -v161, v202
    v_mfma_f32_32x32x16_bf16 v[48:63], v[68:71], v[180:183], v[48:63]
    s_waitcnt vmcnt(6)
    ds_read_b64_tr_b16 v[176:177], v244 offset:0
    ds_read_b64_tr_b16 v[178:179], v244 offset:1024
    ds_read_b64_tr_b16 v[180:181], v245 offset:0
    ds_read_b64_tr_b16 v[182:183], v245 offset:1024
    v_permlane32_swap_b32 v254, v200
    v_fma_f32 v202, v10, -v162, v202
    v_fma_f32 v202, v11, -v163, v202
    v_fma_f32 v202, v12, -v164, v202
    v_fma_f32 v202, v13, -v165, v202
    v_fma_f32 v202, v14, -v166, v202
    v_fma_f32 v202, v15, -v167, v202
    v_add_f32 v200, v254, v200
    v_fmac_f32 v198, v16, v112
    v_permlane32_swap_b32 v202, v254
    v_mfma_f32_32x32x16_bf16 v[32:47], v[72:75], v[184:187], v[32:47]
    v_fmac_f32 v198, v17, v113
    v_fmac_f32 v198, v18, v114
    v_fmac_f32 v198, v19, v115
    v_fmac_f32 v198, v20, v116
    v_fmac_f32 v198, v21, v117
    v_fmac_f32 v198, v22, v118
    v_fmac_f32 v198, v23, v119
    v_add_f32 v254, v202, v254
    v_mul_f32 v196, v24, v160
    v_fmac_f32 v196, v25, v161
    v_mfma_f32_32x32x16_bf16 v[48:63], v[76:79], v[184:187], v[48:63]
    v_add_u32 v249, s48, v249
    v_add_u32 v250, s49, v250
    ds_read_b32 v252, v251 offset:16
    ds_read_b64_tr_b16 v[68:69], v249 offset:0
    ds_read_b64_tr_b16 v[70:71], v249 offset:256
    s_mov_b64 exec, s[54:55]
    ds_read_u16_d16_hi v242, v250 offset:0
    s_mov_b64 exec, -1
    v_fmac_f32 v196, v26, v162
    v_fmac_f32 v196, v27, v163
    v_fmac_f32 v196, v28, v164
    v_fmac_f32 v196, v29, v165
    v_fmac_f32 v196, v30, v166
    v_fmac_f32 v196, v31, v167
    s_nop 1
    v_permlane32_swap_b32 v198, v196
    v_add_f32 v196, v198, v196
    v_mul_f32 v255, v32, v152
    v_fmac_f32 v255, v33, v153
    v_fmac_f32 v255, v34, v154
    v_fmac_f32 v255, v35, v155
    v_fmac_f32 v255, v36, v156
    v_fmac_f32 v255, v37, v157
    v_fmac_f32 v255, v38, v158
    v_fmac_f32 v255, v39, v159
    v_fma_f32 v203, v40, -v168, v203
    v_fma_f32 v203, v41, -v169, v203
    v_permlane32_swap_b32 v255, v201
    v_fma_f32 v203, v42, -v170, v203
    v_fma_f32 v203, v43, -v171, v203
    v_fma_f32 v203, v44, -v172, v203
    v_fma_f32 v203, v45, -v173, v203
    v_fma_f32 v203, v46, -v174, v203
    v_fma_f32 v203, v47, -v175, v203
    v_add_f32 v201, v255, v201
    v_fmac_f32 v199, v48, v120
    v_permlane32_swap_b32 v203, v255
    v_fmac_f32 v199, v49, v121
    v_fmac_f32 v199, v50, v122
    v_fmac_f32 v199, v51, v123
    v_fmac_f32 v199, v52, v124
    v_fmac_f32 v199, v53, v125
    v_fmac_f32 v199, v54, v126
    v_fmac_f32 v199, v55, v127
    v_add_f32 v255, v203, v255
    v_mul_f32 v197, v56, v168
    v_fmac_f32 v197, v57, v169
    v_fmac_f32 v197, v58, v170
    v_fmac_f32 v197, v59, v171
    v_fmac_f32 v197, v60, v172
    v_fmac_f32 v197, v61, v173
    v_fmac_f32 v197, v62, v174
    v_fmac_f32 v197, v63, v175
    s_nop 1
    v_permlane32_swap_b32 v199, v197
    v_add_f32 v197, v199, v197
    v_cvt_pk_bf16_f32 v200, v200, v201
    v_cvt_pk_bf16_f32 v254, v254, v255
    v_cvt_pk_bf16_f32 v196, v196, v197
    ds_write_b32 v253, v200 offset:768
    s_mov_b64 exec, 0xffffffff
    ds_write_b32 v253, v254 offset:1280
    s_mov_b64 exec, -1
    ds_write_b32 v253, v196 offset:1024
    s_add_u32 s50, s50, 1
    s_cmp_ge_u32 s50, 5
    s_cbranch_scc1 TAIL
    s_waitcnt lgkmcnt(6)
    v_readfirstlane_b32 s66, v252
    s_add_u32 s53, s53, 1
    v_mov_b32 v252, s53
    s_cmp_le_u32 s53, s66
    ds_write2_b32 v251, v252, v252 offset0:0 offset1:8
    s_setprio 1
    s_cbranch_scc1 PRIO_10
    s_setprio 0
PRIO_10:
    s_cmp_eq_u32 s52, 4
    s_cbranch_scc1 ITEM_1_4
    s_cmp_eq_u32 s52, 5
    s_cbranch_scc1 ITEM_1_5
    s_cmp_eq_u32 s52, 3
    s_cbranch_scc1 ITEM_1_3
    s_cmp_eq_u32 s52, 6
    s_cbranch_scc1 ITEM_1_6
    s_cmp_eq_u32 s52, 8
    s_cbranch_scc1 ITEM_1_8
    s_branch ITEM_1_2
.p2align 6
ITEM_1_5:
    s_mov_b64 exec, s[54:55]
    ds_read_u16_d16_hi v243, v250 offset:128
    s_mov_b64 exec, -1
    ds_read_b64_tr_b16 v[76:77], v249 offset:512
    ds_read_b64_tr_b16 v[78:79], v249 offset:768
    ds_read_b64_tr_b16 v[84:85], v249 offset:1024
    s_waitcnt lgkmcnt(4)
    v_lshlrev_b32 v196, 16, v68
    v_and_b32 v197, 0xffff0000, v68
    v_lshlrev_b32 v198, 16, v69
    v_and_b32 v199, 0xffff0000, v69
    v_mul_f32_dpp v200, v242, v196 row_newbcast:0 row_mask:0xf bank_mask:0xf
    v_mul_f32_dpp v201, v242, v197 row_newbcast:1 row_mask:0xf bank_mask:0xf
    v_mul_f32_dpp v202, v242, v196 row_newbcast:8 row_mask:0xf bank_mask:0xf
    v_mul_f32_dpp v203, v242, v197 row_newbcast:9 row_mask:0xf bank_mask:0xf
    v_lshlrev_b32 v196, 16, v70
    v_and_b32 v197, 0xffff0000, v70
    v_cvt_pk_bf16_f32 v64, v200, v201
    v_cvt_pk_bf16_f32 v68, v202, v203
    v_mul_f32_dpp v200, v242, v198 row_newbcast:2 row_mask:0xf bank_mask:0xf
    v_mul_f32_dpp v201, v242, v199 row_newbcast:3 row_mask:0xf bank_mask:0xf
    v_mul_f32_dpp v202, v242, v198 row_newbcast:10 row_mask:0xf bank_mask:0xf
    v_mul_f32_dpp v203, v242, v199 row_newbcast:11 row_mask:0xf bank_mask:0xf
    v_lshlrev_b32 v198, 16, v71
    v_and_b32 v199, 0xffff0000, v71
    v_cvt_pk_bf16_f32 v65, v200, v201
    v_cvt_pk_bf16_f32 v69, v202, v203
    v_mul_f32_dpp v200, v242, v196 row_newbcast:4 row_mask:0xf bank_mask:0xf
    v_mul_f32_dpp v201, v242, v197 row_newbcast:5 row_mask:0xf bank_mask:0xf
    v_mul_f32_dpp v202, v242, v196 row_newbcast:12 row_mask:0xf bank_mask:0xf
    v_mul_f32_dpp v203, v242, v197 row_newbcast:13 row_mask:0xf bank_mask:0xf
    v_cvt_pk_bf16_f32 v66, v200, v201
    v_cvt_pk_bf16_f32 v70, v202, v203
    v_mul_f32_dpp v200, v242, v198 row_newbcast:6 row_mask:0xf bank_mask:0xf
    v_mul_f32_dpp v201, v242, v199 row_newbcast:7 row_mask:0xf bank_mask:0xf
    v_mul_f32_dpp v202, v242, v198 row_newbcast:14 row_mask:0xf bank_mask:0xf
    v_mul_f32_dpp v203, v242, v199 row_newbcast:15 row_mask:0xf bank_mask:0xf
    v_cvt_pk_bf16_f32 v67, v200, v201
    v_cvt_pk_bf16_f32 v71, v202, v203
    s_mov_b64 exec, s[54:55]
    ds_read_u16_d16_hi v242, v250 offset:256
    s_mov_b64 exec, -1
    s_waitcnt vmcnt(4) lgkmcnt(2)
    v_mfma_f32_32x32x16_bf16 v[0:15], v[64:67], v[176:179], 0
    v_lshlrev_b32 v196, 16, v76
    v_and_b32 v197, 0xffff0000, v76
    v_lshlrev_b32 v198, 16, v77
    v_and_b32 v199, 0xffff0000, v77
    v_mul_f32_dpp v200, v243, v196 row_newbcast:0 row_mask:0xf bank_mask:0xf
    v_mul_f32_dpp v201, v243, v197 row_newbcast:1 row_mask:0xf bank_mask:0xf
    v_mul_f32_dpp v202, v243, v196 row_newbcast:8 row_mask:0xf bank_mask:0xf
    v_mul_f32_dpp v203, v243, v197 row_newbcast:9 row_mask:0xf bank_mask:0xf
    v_lshlrev_b32 v196, 16, v78
    v_and_b32 v197, 0xffff0000, v78
    v_cvt_pk_bf16_f32 v72, v200, v201
    v_cvt_pk_bf16_f32 v76, v202, v203
    v_mul_f32_dpp v200, v243, v198 row_newbcast:2 row_mask:0xf bank_mask:0xf
    v_mul_f32_dpp v201, v243, v199 row_newbcast:3 row_mask:0xf bank_mask:0xf
    v_mul_f32_dpp v202, v243, v198 row_newbcast:10 row_mask:0xf bank_mask:0xf
    v_mul_f32_dpp v203, v243, v199 row_newbcast:11 row_mask:0xf bank_mask:0xf
    s_add_u32 m0, s21, 0
    v_mfma_f32_32x32x16_bf16 v[16:31], v[68:71], v[176:179], 0
    buffer_load_dwordx4 v236, s[4:7], s35 offen lds
    buffer_load_dwordx4 v237, s[8:11], s35 offen offset:1024 lds
    ds_read_b64_tr_b16 v[176:177], v244 offset:2048
    ds_read_b64_tr_b16 v[178:179], v244 offset:3072
    ds_read_b64_tr_b16 v[184:185], v245 offset:2048
    ds_read_b64_tr_b16 v[186:187], v245 offset:3072
    v_lshlrev_b32 v198, 16, v79
    v_and_b32 v199, 0xffff0000, v79
    v_cvt_pk_bf16_f32 v73, v200, v201
    v_cvt_pk_bf16_f32 v77, v202, v203
    v_mul_f32_dpp v200, v243, v196 row_newbcast:4 row_mask:0xf bank_mask:0xf
    v_mul_f32_dpp v201, v243, v197 row_newbcast:5 row_mask:0xf bank_mask:0xf
    v_mul_f32_dpp v202, v243, v196 row_newbcast:12 row_mask:0xf bank_mask:0xf
    v_mul_f32_dpp v203, v243, v197 row_newbcast:13 row_mask:0xf bank_mask:0xf
    v_cvt_pk_bf16_f32 v74, v200, v201
    v_cvt_pk_bf16_f32 v78, v202, v203
    v_mul_f32_dpp v200, v243, v198 row_newbcast:6 row_mask:0xf bank_mask:0xf
    v_mul_f32_dpp v201, v243, v199 row_newbcast:7 row_mask:0xf bank_mask:0xf
    v_mul_f32_dpp v202, v243, v198 row_newbcast:14 row_mask:0xf bank_mask:0xf
    v_mul_f32_dpp v203, v243, v199 row_newbcast:15 row_mask:0xf bank_mask:0xf
    v_cvt_pk_bf16_f32 v75, v200, v201
    v_cvt_pk_bf16_f32 v79, v202, v203
    s_nop 0
    s_waitcnt vmcnt(4) lgkmcnt(0)
    v_mfma_f32_32x32x16_bf16 v[0:15], v[72:75], v[176:179], v[0:15]
    v_lshlrev_b32 v196, 16, v84
    v_and_b32 v197, 0xffff0000, v84
    v_lshlrev_b32 v198, 16, v85
    v_and_b32 v199, 0xffff0000, v85
    v_mul_f32_dpp v200, v242, v196 row_newbcast:0 row_mask:0xf bank_mask:0xf
    v_mul_f32_dpp v201, v242, v197 row_newbcast:1 row_mask:0xf bank_mask:0xf
    v_mul_f32_dpp v202, v242, v196 row_newbcast:8 row_mask:0xf bank_mask:0xf
    v_mul_f32_dpp v203, v242, v197 row_newbcast:9 row_mask:0xf bank_mask:0xf
    s_add_u32 m0, s21, 2048
    v_mfma_f32_32x32x16_bf16 v[16:31], v[76:79], v[176:179], v[16:31]
    buffer_load_dwordx4 v238, s[4:7], s35 offen lds
    ds_read_b64_tr_b16 v[176:177], v244 offset:4096
    ds_read_b64_tr_b16 v[188:189], v245 offset:4096
    v_cvt_pk_bf16_f32 v80, v200, v201
    v_cvt_pk_bf16_f32 v84, v202, v203
    v_mul_f32_dpp v200, v242, v198 row_newbcast:2 row_mask:0xf bank_mask:0xf
    v_mul_f32_dpp v201, v242, v199 row_newbcast:3 row_mask:0xf bank_mask:0xf
    v_mul_f32_dpp v202, v242, v198 row_newbcast:10 row_mask:0xf bank_mask:0xf
    v_mul_f32_dpp v203, v242, v199 row_newbcast:11 row_mask:0xf bank_mask:0xf
    v_cvt_pk_bf16_f32 v81, v200, v201
    v_cvt_pk_bf16_f32 v85, v202, v203
    s_nop 0
    s_waitcnt lgkmcnt(0)
    v_mfma_f32_32x32x8_bf16 v[0:15], v[80:81], v[176:177], v[0:15]
    s_add_u32 m0, s21, 4096
    v_mfma_f32_32x32x8_bf16 v[16:31], v[84:85], v[176:177], v[16:31]
    buffer_load_dwordx4 v234, s[4:7], s36 offen lds
    buffer_load_dwordx4 v235, s[8:11], s36 offen offset:1024 lds
    s_mov_b32 m0, s50
    s_nop 0
    s_movrels_b32 s71, s23
    s_movrels_b32 s33, s28
    s_and_b32 s70, s33, 0x70
    s_andn2_b32 s33, s33, 0x70
    v_xor_b32 v253, s70, v248
    v_add_u32 v253, s33, v253
    s_bfe_u32 s46, s71, 0x30012
    s_mov_b32 m0, s46
    s_and_b32 s66, s71, 0x3ffff
    s_movrels_b32 s68, s57
    s_movrels_b32 s69, s61
    s_sub_u32 s48, s66, s47
    s_mov_b32 s47, s66
    s_lshr_b32 s52, s71, 28
    s_lshl_b32 s67, s46, 9
    s_add_u32 s66, s66, s67
    s_sub_u32 s49, s66, s42
    s_mov_b32 s42, s66
    s_bfe_u32 s66, s68, 655360
    s_add_u32 s43, s42, s66
    s_bfe_u32 s39, s69, 655360
    s_bfe_u32 s66, s68, 655370
    s_add_u32 s44, s42, s66
    s_bfe_u32 s40, s69, 655370
    s_bfe_u32 s66, s68, 655380
    s_add_u32 s45, s42, s66
    s_bfe_u32 s41, s69, 655380
    v_add_u32 v252, s45, v247
    ds_read_u16 v240, v252
    ds_read_u16 v241, v252 offset:64
    v_mfma_f32_32x32x16_bf16 v[32:47], v[64:67], v[180:183], 0
    v_mul_f32 v196, v0, v96
    v_fmac_f32 v196, v1, v97
    v_fmac_f32 v196, v2, v98
    v_fmac_f32 v196, v3, v99
    v_fmac_f32 v196, v4, v100
    v_fmac_f32 v196, v5, v101
    v_fmac_f32 v196, v6, v102
    v_mfma_f32_32x32x16_bf16 v[48:63], v[68:71], v[180:183], 0
    v_fmac_f32 v196, v7, v103
    v_mul_f32 v198, v8, v128
    v_fmac_f32 v198, v9, v129
    v_fmac_f32 v198, v10, v130
    v_fmac_f32 v198, v11, v131
    v_fmac_f32 v198, v12, v132
    v_mfma_f32_32x32x16_bf16 v[32:47], v[72:75], v[184:187], v[32:47]
    v_fmac_f32 v198, v13, v133
    v_fmac_f32 v198, v14, v134
    v_fmac_f32 v198, v15, v135
    v_mul_f32 v200, v16, v128
    v_fmac_f32 v200, v17, v129
    v_permlane32_swap_b32 v196, v198
    v_mfma_f32_32x32x16_bf16 v[48:63], v[76:79], v[184:187], v[48:63]
    s_waitcnt vmcnt(5)
    ds_read_b64_tr_b16 v[176:177], v244 offset:6144
    ds_read_b64_tr_b16 v[178:179], v244 offset:7168
    ds_read_b64_tr_b16 v[180:181], v245 offset:6144
    ds_read_b64_tr_b16 v[182:183], v245 offset:7168
    v_fmac_f32 v200, v18, v130
    v_fmac_f32 v200, v19, v131
    v_fmac_f32 v200, v20, v132
    v_fmac_f32 v200, v21, v133
    v_fmac_f32 v200, v22, v134
    v_fmac_f32 v200, v23, v135
    v_mfma_f32_32x32x8_bf16 v[32:47], v[80:81], v[188:189], v[32:47]
    v_add_f32 v198, v196, v198
    v_mul_f32_e64 v202, v24, -v128
    v_fma_f32 v202, v25, -v129, v202
    v_fma_f32 v202, v26, -v130, v202
    v_fma_f32 v202, v27, -v131, v202
    v_fma_f32 v202, v28, -v132, v202
    v_mfma_f32_32x32x8_bf16 v[48:63], v[84:85], v[188:189], v[48:63]
    v_fma_f32 v202, v29, -v133, v202
    v_fma_f32 v202, v30, -v134, v202
    v_fma_f32 v202, v31, -v135, v202
    s_nop 1
    v_permlane32_swap_b32 v200, v202
    v_add_f32 v202, v200, v202
    s_waitcnt vmcnt(3) lgkmcnt(0)
    v_mfma_f32_32x32x16_bf16 v[0:15], v[64:67], v[176:179], 0
    v_mul_f32 v197, v32, v104
    v_fmac_f32 v197, v33, v105
    v_fmac_f32 v197, v34, v106
    v_fmac_f32 v197, v35, v107
    v_fmac_f32 v197, v36, v108
    v_fmac_f32 v197, v37, v109
    v_fmac_f32 v197, v38, v110
    s_add_u32 m0, s21, 6144
    v_mfma_f32_32x32x16_bf16 v[16:31], v[68:71], v[176:179], 0
    buffer_load_dwordx4 v236, s[4:7], s36 offen lds
    buffer_load_dwordx4 v237, s[8:11], s36 offen offset:1024 lds
    ds_read_b64_tr_b16 v[176:177], v244 offset:0
    ds_read_b64_tr_b16 v[178:179], v244 offset:1024
    ds_read_b64_tr_b16 v[184:185], v245 offset:0
    ds_read_b64_tr_b16 v[186:187], v245 offset:1024
    v_fmac_f32 v197, v39, v111
    v_mul_f32 v199, v40, v136
    v_fmac_f32 v199, v41, v137
    v_fmac_f32 v199, v42, v138
    v_fmac_f32 v199, v43, v139
    v_fmac_f32 v199, v44, v140
    v_fmac_f32 v199, v45, v141
    s_waitcnt vmcnt(4) lgkmcnt(0)
    v_mfma_f32_32x32x16_bf16 v[0:15], v[72:75], v[176:179], v[0:15]
    v_fmac_f32 v199, v46, v142
    v_fmac_f32 v199, v47, v143
    v_mul_f32 v201, v48, v136
    v_fmac_f32 v201, v49, v137
    v_permlane32_swap_b32 v197, v199
    v_fmac_f32 v201, v50, v138
    v_fmac_f32 v201, v51, v139
    s_add_u32 m0, s21, 0
    v_mfma_f32_32x32x16_bf16 v[16:31], v[76:79], v[176:179], v[16:31]
    buffer_load_dwordx4 v238, s[4:7], s36 offen lds
    ds_read_b64_tr_b16 v[176:177], v244 offset:2048
    ds_read_b64_tr_b16 v[188:189], v245 offset:2048
    v_fmac_f32 v201, v52, v140
    v_fmac_f32 v201, v53, v141
    v_fmac_f32 v201, v54, v142
    v_fmac_f32 v201, v55, v143
    v_add_f32 v199, v197, v199
    v_mul_f32_e64 v203, v56, -v136
    v_fma_f32 v203, v57, -v137, v203
    s_waitcnt lgkmcnt(0)
    v_mfma_f32_32x32x8_bf16 v[0:15], v[80:81], v[176:177], v[0:15]
    v_fma_f32 v203, v58, -v138, v203
    v_fma_f32 v203, v59, -v139, v203
    v_fma_f32 v203, v60, -v140, v203
    v_fma_f32 v203, v61, -v141, v203
    v_fma_f32 v203, v62, -v142, v203
    v_fma_f32 v203, v63, -v143, v203
    s_nop 1
    s_add_u32 m0, s21, 2048
    v_mfma_f32_32x32x8_bf16 v[16:31], v[84:85], v[176:177], v[16:31]
    buffer_load_dwordx4 v234, s[4:7], s37 offen lds
    buffer_load_dwordx4 v235, s[8:11], s37 offen offset:1024 lds
    v_add_u32 v252, s42, v247
    ds_read_u16 v234, v252
    ds_read_u16 v235, v252 offset:64
    v_permlane32_swap_b32 v201, v203
    v_add_f32 v203, v201, v203
    v_cvt_pk_bf16_f32 v198, v198, v199
    v_cvt_pk_bf16_f32 v202, v202, v203
    ds_write_b32 v253, v198 offset:0
    ds_write_b32 v253, v202 offset:256
    v_mfma_f32_32x32x16_bf16 v[32:47], v[64:67], v[180:183], 0
    v_mul_f32 v196, v0, v144
    v_fmac_f32 v196, v1, v145
    v_fmac_f32 v196, v2, v146
    v_fmac_f32 v196, v3, v147
    v_fmac_f32 v196, v4, v148
    v_fmac_f32 v196, v5, v149
    v_mfma_f32_32x32x16_bf16 v[48:63], v[68:71], v[180:183], 0
    v_fmac_f32 v196, v6, v150
    v_fmac_f32 v196, v7, v151
    v_mul_f32 v198, v8, v112
    v_fmac_f32 v198, v9, v113
    v_fmac_f32 v198, v10, v114
    v_mfma_f32_32x32x16_bf16 v[32:47], v[72:75], v[184:187], v[32:47]
    v_fmac_f32 v198, v11, v115
    v_fmac_f32 v198, v12, v116
    v_fmac_f32 v198, v13, v117
    v_fmac_f32 v198, v14, v118
    v_fmac_f32 v198, v15, v119
    v_mfma_f32_32x32x16_bf16 v[48:63], v[76:79], v[184:187], v[48:63]
    s_waitcnt vmcnt(5)
    ds_read_b64_tr_b16 v[176:177], v244 offset:4096
    ds_read_b64_tr_b16 v[178:179], v244 offset:5120
    ds_read_b64_tr_b16 v[180:181], v245 offset:4096
    ds_read_b64_tr_b16 v[182:183], v245 offset:5120
    v_mul_f32_e64 v200, v16, -v160
    v_fma_f32 v200, v17, -v161, v200
    v_fma_f32 v200, v18, -v162, v200
    v_fma_f32 v200, v19, -v163, v200
    v_fma_f32 v200, v20, -v164, v200
    v_fma_f32 v200, v21, -v165, v200
    v_mfma_f32_32x32x8_bf16 v[32:47], v[80:81], v[188:189], v[32:47]
    v_fma_f32 v200, v22, -v166, v200
    v_fma_f32 v200, v23, -v167, v200
    v_mul_f32_e64 v202, v24, -v160
    v_fma_f32 v202, v25, -v161, v202
    v_fma_f32 v202, v26, -v162, v202
    v_mfma_f32_32x32x8_bf16 v[48:63], v[84:85], v[188:189], v[48:63]
    v_fma_f32 v202, v27, -v163, v202
    v_fma_f32 v202, v28, -v164, v202
    v_fma_f32 v202, v29, -v165, v202
    v_fma_f32 v202, v30, -v166, v202
    v_fma_f32 v202, v31, -v167, v202
    s_waitcnt vmcnt(3) lgkmcnt(0)
    v_mfma_f32_32x32x16_bf16 v[0:15], v[64:67], v[176:179], 0
    v_mul_f32 v197, v32, v152
    v_fmac_f32 v197, v33, v153
    v_fmac_f32 v197, v34, v154
    v_fmac_f32 v197, v35, v155
    v_fmac_f32 v197, v36, v156
    v_fmac_f32 v197, v37, v157
    s_add_u32 m0, s21, 4096
    v_mfma_f32_32x32x16_bf16 v[16:31], v[68:71], v[176:179], 0
    buffer_load_dwordx4 v236, s[4:7], s37 offen lds
    buffer_load_dwordx4 v237, s[8:11], s37 offen offset:1024 lds
    ds_read_b64_tr_b16 v[176:177], v244 offset:6144
    ds_read_b64_tr_b16 v[178:179], v244 offset:7168
    ds_read_b64_tr_b16 v[184:185], v245 offset:6144
    ds_read_b64_tr_b16 v[186:187], v245 offset:7168
    v_add_u32 v252, s43, v247
    ds_read_u16 v236, v252
    ds_read_u16 v237, v252 offset:64
    v_fmac_f32 v197, v38, v158
    v_fmac_f32 v197, v39, v159
    v_mul_f32 v199, v40, v120
    v_fmac_f32 v199, v41, v121
    v_fmac_f32 v199, v42, v122
    s_waitcnt vmcnt(4) lgkmcnt(2)
    v_mfma_f32_32x32x16_bf16 v[0:15], v[72:75], v[176:179], v[0:15]
    v_fmac_f32 v199, v43, v123
    v_fmac_f32 v199, v44, v124
    v_fmac_f32 v199, v45, v125
    v_fmac_f32 v199, v46, v126
    v_fmac_f32 v199, v47, v127
    s_add_u32 m0, s21, 6144
    v_mfma_f32_32x32x16_bf16 v[16:31], v[76:79], v[176:179], v[16:31]
    buffer_load_dwordx4 v238, s[4:7], s37 offen lds
    ds_read_b64_tr_b16 v[176:177], v244 offset:0
    ds_read_b64_tr_b16 v[188:189], v245 offset:0
    v_add_u32 v252, s44, v247
    ds_read_u16 v238, v252
    ds_read_u16 v239, v252 offset:64
    v_mul_f32_e64 v201, v48, -v168
    v_fma_f32 v201, v49, -v169, v201
    v_fma_f32 v201, v50, -v170, v201
    v_fma_f32 v201, v51, -v171, v201
    v_fma_f32 v201, v52, -v172, v201
    v_fma_f32 v201, v53, -v173, v201
    s_waitcnt lgkmcnt(2)
    v_mfma_f32_32x32x8_bf16 v[0:15], v[80:81], v[176:177], v[0:15]
    v_fma_f32 v201, v54, -v174, v201
    v_fma_f32 v201, v55, -v175, v201
    v_mul_f32_e64 v203, v56, -v168
    v_fma_f32 v203, v57, -v169, v203
    v_fma_f32 v203, v58, -v170, v203
    s_add_u32 m0, s21, 0
    v_mfma_f32_32x32x8_bf16 v[16:31], v[84:85], v[176:177], v[16:31]
    v_lshl_add_u32 v234, v234, 10, v246
    v_lshl_add_u32 v235, v235, 10, v246
    buffer_load_dwordx4 v234, s[4:7], s38 offen lds
    buffer_load_dwordx4 v235, s[8:11], s38 offen offset:1024 lds
    v_fma_f32 v203, v59, -v171, v203
    v_fma_f32 v203, v60, -v172, v203
    v_fma_f32 v203, v61, -v173, v203
    v_fma_f32 v203, v62, -v174, v203
    v_fma_f32 v203, v63, -v175, v203
    v_mfma_f32_32x32x16_bf16 v[32:47], v[64:67], v[180:183], 0
    v_mul_f32 v254, v0, v144
    v_fmac_f32 v254, v1, v145
    v_fmac_f32 v254, v2, v146
    v_mfma_f32_32x32x16_bf16 v[48:63], v[68:71], v[180:183], 0
    ds_swizzle_b32 v68, v68 offset:0x401F
    ds_swizzle_b32 v69, v69 offset:0x401F
    ds_swizzle_b32 v70, v70 offset:0x401F
    ds_swizzle_b32 v71, v71 offset:0x401F
    v_fmac_f32 v254, v3, v147
    v_fmac_f32 v254, v4, v148
    v_fmac_f32 v254, v5, v149
    v_mfma_f32_32x32x16_bf16 v[32:47], v[72:75], v[184:187], v[32:47]
    v_fmac_f32 v254, v6, v150
    v_fmac_f32 v254, v7, v151
    v_fmac_f32 v200, v8, v160
    v_mfma_f32_32x32x16_bf16 v[48:63], v[76:79], v[184:187], v[48:63]
    ds_swizzle_b32 v76, v76 offset:0x401F
    ds_swizzle_b32 v77, v77 offset:0x401F
    ds_swizzle_b32 v78, v78 offset:0x401F
    ds_swizzle_b32 v79, v79 offset:0x401F
    s_waitcnt vmcnt(5)
    ds_read_b64_tr_b16 v[176:177], v244 offset:2048
    ds_read_b64_tr_b16 v[178:179], v244 offset:3072
    ds_read_b64_tr_b16 v[180:181], v245 offset:2048
    ds_read_b64_tr_b16 v[182:183], v245 offset:3072
    v_fmac_f32 v200, v9, v161
    v_permlane32_swap_b32 v196, v254
    v_fmac_f32 v200, v10, v162
    v_mfma_f32_32x32x8_bf16 v[32:47], v[80:81], v[188:189], v[32:47]
    v_fmac_f32 v200, v11, v163
    v_fmac_f32 v200, v12, v164
    v_fmac_f32 v200, v13, v165
    v_mfma_f32_32x32x8_bf16 v[48:63], v[84:85], v[188:189], v[48:63]
    ds_swizzle_b32 v84, v84 offset:0x401F
    ds_swizzle_b32 v85, v85 offset:0x401F
    v_fmac_f32 v200, v14, v166
    v_fmac_f32 v200, v15, v167
    v_add_f32 v254, v196, v254
    s_waitcnt lgkmcnt(6)
    s_mov_b64 exec, s[56:57]
    v_xor_b32 v68, 0x80008000, v68
    v_xor_b32 v69, 0x80008000, v69
    v_xor_b32 v70, 0x80008000, v70
    v_xor_b32 v71, 0x80008000, v71
    v_xor_b32 v76, 0x80008000, v76
    v_xor_b32 v77, 0x80008000, v77
    v_xor_b32 v78, 0x80008000, v78
    v_xor_b32 v79, 0x80008000, v79
    s_mov_b64 exec, -1
    s_waitcnt vmcnt(3) lgkmcnt(2)
    v_mfma_f32_32x32x16_bf16 v[0:15], v[64:67], v[176:179], 0
    v_mul_f32 v255, v32, v152
    v_fmac_f32 v255, v33, v153
    v_fmac_f32 v255, v34, v154
    v_fmac_f32 v255, v35, v155
    s_add_u32 m0, s21, 2048
    v_mfma_f32_32x32x16_bf16 v[16:31], v[68:71], v[176:179], v[16:31]
    v_lshl_add_u32 v236, v236, 10, v246
    v_lshl_add_u32 v237, v237, 10, v246
    buffer_load_dwordx4 v236, s[4:7], s39 offen lds
    buffer_load_dwordx4 v237, s[8:11], s39 offen offset:1024 lds
    ds_read_b64_tr_b16 v[176:177], v244 offset:4096
    ds_read_b64_tr_b16 v[178:179], v244 offset:5120
    ds_read_b64_tr_b16 v[184:185], v245 offset:4096
    ds_read_b64_tr_b16 v[186:187], v245 offset:5120
    v_fmac_f32 v255, v36, v156
    v_fmac_f32 v255, v37, v157
    v_fmac_f32 v255, v38, v158
    s_waitcnt vmcnt(4) lgkmcnt(0)
    v_mfma_f32_32x32x16_bf16 v[0:15], v[72:75], v[176:179], v[0:15]
    v_fmac_f32 v255, v39, v159
    v_fmac_f32 v201, v40, v168
    v_fmac_f32 v201, v41, v169
    s_add_u32 m0, s21, 4096
    v_mfma_f32_32x32x16_bf16 v[16:31], v[76:79], v[176:179], v[16:31]
    v_lshl_add_u32 v238, v238, 10, v246
    v_lshl_add_u32 v239, v239, 10, v246
    buffer_load_dwordx4 v238, s[4:7], s40 offen lds
    buffer_load_dwordx4 v239, s[8:11], s40 offen offset:1024 lds
    ds_read_b64_tr_b16 v[176:177], v244 offset:6144
    ds_read_b64_tr_b16 v[188:189], v245 offset:6144
    v_permlane32_swap_b32 v197, v255
    v_fmac_f32 v201, v42, v170
    v_fmac_f32 v201, v43, v171
    v_fmac_f32 v201, v44, v172
    s_waitcnt lgkmcnt(0)
    s_mov_b64 exec, s[56:57]
    v_xor_b32 v84, 0x80008000, v84
    v_xor_b32 v85, 0x80008000, v85
    s_mov_b64 exec, -1
    v_mfma_f32_32x32x8_bf16 v[0:15], v[80:81], v[176:177], v[0:15]
    v_fmac_f32 v201, v45, v173
    v_fmac_f32 v201, v46, v174
    v_fmac_f32 v201, v47, v175
    s_add_u32 m0, s21, 6144
    v_mfma_f32_32x32x8_bf16 v[16:31], v[84:85], v[176:177], v[16:31]
    v_lshl_add_u32 v240, v240, 10, v246
    v_lshl_add_u32 v241, v241, 10, v246
    buffer_load_dwordx4 v240, s[4:7], s41 offen lds
    buffer_load_dwordx4 v241, s[8:11], s41 offen offset:1024 lds
    v_add_f32 v255, v197, v255
    v_cvt_pk_bf16_f32 v254, v254, v255
    ds_write_b32 v253, v254 offset:512
    v_mfma_f32_32x32x16_bf16 v[32:47], v[64:67], v[180:183], 0
    v_mul_f32 v254, v0, v144
    v_fmac_f32 v254, v1, v145
    v_fmac_f32 v254, v2, v146
    v_fmac_f32 v254, v3, v147
    v_fmac_f32 v254, v4, v148
    v_fmac_f32 v254, v5, v149
    v_fmac_f32 v254, v6, v150
    v_mfma_f32_32x32x16_bf16 v[48:63], v[68:71], v[180:183], v[48:63]
    v_fmac_f32 v254, v7, v151
    v_fma_f32 v202, v8, -v160, v202
    v_fma_f32 v202, v9, -v161, v202
    v_permlane32_swap_b32 v254, v200
    v_fma_f32 v202, v10, -v162, v202
    v_fma_f32 v202, v11, -v163, v202
    v_mfma_f32_32x32x16_bf16 v[32:47], v[72:75], v[184:187], v[32:47]
    v_fma_f32 v202, v12, -v164, v202
    v_fma_f32 v202, v13, -v165, v202
    v_fma_f32 v202, v14, -v166, v202
    v_fma_f32 v202, v15, -v167, v202
    v_add_f32 v200, v254, v200
    v_fmac_f32 v198, v16, v112
    v_permlane32_swap_b32 v202, v254
    v_mfma_f32_32x32x16_bf16 v[48:63], v[76:79], v[184:187], v[48:63]
    s_waitcnt vmcnt(6)
    ds_read_b64_tr_b16 v[176:177], v244 offset:0
    ds_read_b64_tr_b16 v[178:179], v244 offset:1024
    ds_read_b64_tr_b16 v[180:181], v245 offset:0
    ds_read_b64_tr_b16 v[182:183], v245 offset:1024
    v_fmac_f32 v198, v17, v113
    v_fmac_f32 v198, v18, v114
    v_fmac_f32 v198, v19, v115
    v_fmac_f32 v198, v20, v116
    v_fmac_f32 v198, v21, v117
    v_fmac_f32 v198, v22, v118
    v_mfma_f32_32x32x8_bf16 v[32:47], v[80:81], v[188:189], v[32:47]
    v_fmac_f32 v198, v23, v119
    v_add_f32 v254, v202, v254
    v_mul_f32 v196, v24, v160
    v_fmac_f32 v196, v25, v161
    v_fmac_f32 v196, v26, v162
    v_fmac_f32 v196, v27, v163
    v_fmac_f32 v196, v28, v164
    v_mfma_f32_32x32x8_bf16 v[48:63], v[84:85], v[188:189], v[48:63]
    v_add_u32 v249, s48, v249
    v_add_u32 v250, s49, v250
    ds_read_b32 v252, v251 offset:16
    ds_read_b64_tr_b16 v[68:69], v249 offset:0
    ds_read_b64_tr_b16 v[70:71], v249 offset:256
    s_mov_b64 exec, s[54:55]
    ds_read_u16_d16_hi v242, v250 offset:0
    s_mov_b64 exec, -1
    v_fmac_f32 v196, v29, v165
    v_fmac_f32 v196, v30, v166
    v_fmac_f32 v196, v31, v167
    s_nop 1
    v_permlane32_swap_b32 v198, v196
    v_add_f32 v196, v198, v196
    v_mul_f32 v255, v32, v152
    v_fmac_f32 v255, v33, v153
    v_fmac_f32 v255, v34, v154
    v_fmac_f32 v255, v35, v155
    v_fmac_f32 v255, v36, v156
    v_fmac_f32 v255, v37, v157
    v_fmac_f32 v255, v38, v158
    v_fmac_f32 v255, v39, v159
    v_fma_f32 v203, v40, -v168, v203
    v_fma_f32 v203, v41, -v169, v203
    v_permlane32_swap_b32 v255, v201
    v_fma_f32 v203, v42, -v170, v203
    v_fma_f32 v203, v43, -v171, v203
    v_fma_f32 v203, v44, -v172, v203
    v_fma_f32 v203, v45, -v173, v203
    v_fma_f32 v203, v46, -v174, v203
    v_fma_f32 v203, v47, -v175, v203
    v_add_f32 v201, v255, v201
    v_fmac_f32 v199, v48, v120
    v_permlane32_swap_b32 v203, v255
    v_fmac_f32 v199, v49, v121
    v_fmac_f32 v199, v50, v122
    v_fmac_f32 v199, v51, v123
    v_fmac_f32 v199, v52, v124
    v_fmac_f32 v199, v53, v125
    v_fmac_f32 v199, v54, v126
    v_fmac_f32 v199, v55, v127
    v_add_f32 v255, v203, v255
    v_mul_f32 v197, v56, v168
    v_fmac_f32 v197, v57, v169
    v_fmac_f32 v197, v58, v170
    v_fmac_f32 v197, v59, v171
    v_fmac_f32 v197, v60, v172
    v_fmac_f32 v197, v61, v173
    v_fmac_f32 v197, v62, v174
    v_fmac_f32 v197, v63, v175
    s_nop 1
    v_permlane32_swap_b32 v199, v197
    v_add_f32 v197, v199, v197
    v_cvt_pk_bf16_f32 v200, v200, v201
    v_cvt_pk_bf16_f32 v254, v254, v255
    v_cvt_pk_bf16_f32 v196, v196, v197
    ds_write_b32 v253, v200 offset:768
    s_mov_b64 exec, 0xffffffff
    ds_write_b32 v253, v254 offset:1280
    s_mov_b64 exec, -1
    ds_write_b32 v253, v196 offset:1024
    s_add_u32 s50, s50, 1
    s_cmp_ge_u32 s50, 5
    s_cbranch_scc1 TAIL
    s_waitcnt lgkmcnt(6)
    v_readfirstlane_b32 s66, v252
    s_add_u32 s53, s53, 1
    v_mov_b32 v252, s53
    s_cmp_le_u32 s53, s66
    ds_write2_b32 v251, v252, v252 offset0:0 offset1:8
    s_setprio 1
    s_cbranch_scc1 PRIO_11
    s_setprio 0
PRIO_11:
    s_cmp_eq_u32 s52, 4
    s_cbranch_scc1 ITEM_1_4
    s_cmp_eq_u32 s52, 5
    s_cbranch_scc1 ITEM_1_5
    s_cmp_eq_u32 s52, 3
    s_cbranch_scc1 ITEM_1_3
    s_cmp_eq_u32 s52, 6
    s_cbranch_scc1 ITEM_1_6
    s_cmp_eq_u32 s52, 8
    s_cbranch_scc1 ITEM_1_8
    s_branch ITEM_1_2
.p2align 6
ITEM_1_3:
    s_mov_b64 exec, s[54:55]
    ds_read_u16_d16_hi v243, v250 offset:128
    s_mov_b64 exec, -1
    ds_read_b64_tr_b16 v[76:77], v249 offset:512
    s_waitcnt lgkmcnt(2)
    v_lshlrev_b32 v196, 16, v68
    v_and_b32 v197, 0xffff0000, v68
    v_lshlrev_b32 v198, 16, v69
    v_and_b32 v199, 0xffff0000, v69
    v_mul_f32_dpp v200, v242, v196 row_newbcast:0 row_mask:0xf bank_mask:0xf
    v_mul_f32_dpp v201, v242, v197 row_newbcast:1 row_mask:0xf bank_mask:0xf
    v_mul_f32_dpp v202, v242, v196 row_newbcast:8 row_mask:0xf bank_mask:0xf
    v_mul_f32_dpp v203, v242, v197 row_newbcast:9 row_mask:0xf bank_mask:0xf
    v_lshlrev_b32 v196, 16, v70
    v_and_b32 v197, 0xffff0000, v70
    v_cvt_pk_bf16_f32 v64, v200, v201
    v_cvt_pk_bf16_f32 v68, v202, v203
    v_mul_f32_dpp v200, v242, v198 row_newbcast:2 row_mask:0xf bank_mask:0xf
    v_mul_f32_dpp v201, v242, v199 row_newbcast:3 row_mask:0xf bank_mask:0xf
    v_mul_f32_dpp v202, v242, v198 row_newbcast:10 row_mask:0xf bank_mask:0xf
    v_mul_f32_dpp v203, v242, v199 row_newbcast:11 row_mask:0xf bank_mask:0xf
    v_lshlrev_b32 v198, 16, v71
    v_and_b32 v199, 0xffff0000, v71
    v_cvt_pk_bf16_f32 v65, v200, v201
    v_cvt_pk_bf16_f32 v69, v202, v203
    v_mul_f32_dpp v200, v242, v196 row_newbcast:4 row_mask:0xf bank_mask:0xf
    v_mul_f32_dpp v201, v242, v197 row_newbcast:5 row_mask:0xf bank_mask:0xf
    v_mul_f32_dpp v202, v242, v196 row_newbcast:12 row_mask:0xf bank_mask:0xf
    v_mul_f32_dpp v203, v242, v197 row_newbcast:13 row_mask:0xf bank_mask:0xf
    v_cvt_pk_bf16_f32 v66, v200, v201
    v_cvt_pk_bf16_f32 v70, v202, v203
    v_mul_f32_dpp v200, v242, v198 row_newbcast:6 row_mask:0xf bank_mask:0xf
    v_mul_f32_dpp v201, v242, v199 row_newbcast:7 row_mask:0xf bank_mask:0xf
    v_mul_f32_dpp v202, v242, v198 row_newbcast:14 row_mask:0xf bank_mask:0xf
    v_mul_f32_dpp v203, v242, v199 row_newbcast:15 row_mask:0xf bank_mask:0xf
    v_cvt_pk_bf16_f32 v67, v200, v201
    v_cvt_pk_bf16_f32 v71, v202, v203
    s_nop 0
    s_waitcnt vmcnt(4) lgkmcnt(0)
    v_mfma_f32_32x32x16_bf16 v[0:15], v[64:67], v[176:179], 0
    v_lshlrev_b32 v196, 16, v76
    v_and_b32 v197, 0xffff0000, v76
    v_lshlrev_b32 v198, 16, v77
    v_and_b32 v199, 0xffff0000, v77
    v_mul_f32_dpp v200, v243, v196 row_newbcast:0 row_mask:0xf bank_mask:0xf
    v_mul_f32_dpp v201, v243, v197 row_newbcast:1 row_mask:0xf bank_mask:0xf
    v_mul_f32_dpp v202, v243, v196 row_newbcast:8 row_mask:0xf bank_mask:0xf
    v_mul_f32_dpp v203, v243, v197 row_newbcast:9 row_mask:0xf bank_mask:0xf
    s_add_u32 m0, s21, 0
    v_mfma_f32_32x32x16_bf16 v[16:31], v[68:71], v[176:179], 0
    buffer_load_dwordx4 v234, s[4:7], s36 offen lds
    buffer_load_dwordx4 v235, s[8:11], s36 offen offset:1024 lds
    ds_read_b64_tr_b16 v[176:177], v244 offset:2048
    ds_read_b64_tr_b16 v[184:185], v245 offset:2048
    v_cvt_pk_bf16_f32 v72, v200, v201
    v_cvt_pk_bf16_f32 v76, v202, v203
    v_mul_f32_dpp v200, v243, v198 row_newbcast:2 row_mask:0xf bank_mask:0xf
    v_mul_f32_dpp v201, v243, v199 row_newbcast:3 row_mask:0xf bank_mask:0xf
    v_mul_f32_dpp v202, v243, v198 row_newbcast:10 row_mask:0xf bank_mask:0xf
    v_mul_f32_dpp v203, v243, v199 row_newbcast:11 row_mask:0xf bank_mask:0xf
    v_cvt_pk_bf16_f32 v73, v200, v201
    v_cvt_pk_bf16_f32 v77, v202, v203
    s_nop 0
    s_waitcnt lgkmcnt(0)
    v_mfma_f32_32x32x8_bf16 v[0:15], v[72:73], v[176:177], v[0:15]
    s_add_u32 m0, s21, 2048
    v_mfma_f32_32x32x8_bf16 v[16:31], v[76:77], v[176:177], v[16:31]
    buffer_load_dwordx4 v236, s[4:7], s36 offen lds
    s_mov_b32 m0, s50
    s_nop 0
    s_movrels_b32 s71, s23
    s_movrels_b32 s33, s28
    s_and_b32 s70, s33, 0x70
    s_andn2_b32 s33, s33, 0x70
    v_xor_b32 v253, s70, v248
    v_add_u32 v253, s33, v253
    s_bfe_u32 s46, s71, 0x30012
    s_mov_b32 m0, s46
    s_and_b32 s66, s71, 0x3ffff
    s_movrels_b32 s68, s57
    s_movrels_b32 s69, s61
    s_sub_u32 s48, s66, s47
    s_mov_b32 s47, s66
    s_lshr_b32 s52, s71, 28
    s_lshl_b32 s67, s46, 9
    s_add_u32 s66, s66, s67
    s_sub_u32 s49, s66, s42
    s_mov_b32 s42, s66
    s_bfe_u32 s66, s68, 655360
    s_add_u32 s43, s42, s66
    s_bfe_u32 s39, s69, 655360
    s_bfe_u32 s66, s68, 655370
    s_add_u32 s44, s42, s66
    s_bfe_u32 s40, s69, 655370
    s_bfe_u32 s66, s68, 655380
    s_add_u32 s45, s42, s66
    s_bfe_u32 s41, s69, 655380
    v_add_u32 v252, s44, v247
    ds_read_u16 v238, v252
    ds_read_u16 v239, v252 offset:64
    v_add_u32 v252, s45, v247
    ds_read_u16 v240, v252
    ds_read_u16 v241, v252 offset:64
    v_mfma_f32_32x32x16_bf16 v[32:47], v[64:67], v[180:183], 0
    v_mul_f32 v196, v0, v96
    v_fmac_f32 v196, v1, v97
    v_fmac_f32 v196, v2, v98
    v_fmac_f32 v196, v3, v99
    v_fmac_f32 v196, v4, v100
    v_fmac_f32 v196, v5, v101
    v_fmac_f32 v196, v6, v102
    v_fmac_f32 v196, v7, v103
    v_mul_f32 v198, v8, v128
    v_fmac_f32 v198, v9, v129
    v_mfma_f32_32x32x16_bf16 v[48:63], v[68:71], v[180:183], 0
    s_waitcnt vmcnt(5)
    ds_read_b64_tr_b16 v[176:177], v244 offset:4096
    ds_read_b64_tr_b16 v[178:179], v244 offset:5120
    ds_read_b64_tr_b16 v[180:181], v245 offset:4096
    ds_read_b64_tr_b16 v[182:183], v245 offset:5120
    v_fmac_f32 v198, v10, v130
    v_fmac_f32 v198, v11, v131
    v_fmac_f32 v198, v12, v132
    v_fmac_f32 v198, v13, v133
    v_fmac_f32 v198, v14, v134
    v_fmac_f32 v198, v15, v135
    v_mul_f32 v200, v16, v128
    v_fmac_f32 v200, v17, v129
    v_permlane32_swap_b32 v196, v198
    v_mfma_f32_32x32x8_bf16 v[32:47], v[72:73], v[184:185], v[32:47]
    v_fmac_f32 v200, v18, v130
    v_fmac_f32 v200, v19, v131
    v_fmac_f32 v200, v20, v132
    v_fmac_f32 v200, v21, v133
    v_fmac_f32 v200, v22, v134
    v_fmac_f32 v200, v23, v135
    v_add_f32 v198, v196, v198
    v_mul_f32_e64 v202, v24, -v128
    v_fma_f32 v202, v25, -v129, v202
    v_mfma_f32_32x32x8_bf16 v[48:63], v[76:77], v[184:185], v[48:63]
    v_fma_f32 v202, v26, -v130, v202
    v_fma_f32 v202, v27, -v131, v202
    v_fma_f32 v202, v28, -v132, v202
    v_fma_f32 v202, v29, -v133, v202
    v_fma_f32 v202, v30, -v134, v202
    v_fma_f32 v202, v31, -v135, v202
    s_nop 1
    v_permlane32_swap_b32 v200, v202
    v_add_f32 v202, v200, v202
    s_waitcnt vmcnt(3) lgkmcnt(0)
    v_mfma_f32_32x32x16_bf16 v[0:15], v[64:67], v[176:179], 0
    v_mul_f32 v197, v32, v104
    v_fmac_f32 v197, v33, v105
    v_fmac_f32 v197, v34, v106
    v_fmac_f32 v197, v35, v107
    v_fmac_f32 v197, v36, v108
    v_fmac_f32 v197, v37, v109
    v_fmac_f32 v197, v38, v110
    v_fmac_f32 v197, v39, v111
    v_mul_f32 v199, v40, v136
    v_fmac_f32 v199, v41, v137
    v_fmac_f32 v199, v42, v138
    s_add_u32 m0, s21, 4096
    v_mfma_f32_32x32x16_bf16 v[16:31], v[68:71], v[176:179], 0
    buffer_load_dwordx4 v234, s[4:7], s37 offen lds
    buffer_load_dwordx4 v235, s[8:11], s37 offen offset:1024 lds
    ds_read_b64_tr_b16 v[176:177], v244 offset:6144
    ds_read_b64_tr_b16 v[184:185], v245 offset:6144
    v_add_u32 v252, s42, v247
    ds_read_u16 v234, v252
    ds_read_u16 v235, v252 offset:64
    v_fmac_f32 v199, v43, v139
    v_fmac_f32 v199, v44, v140
    v_fmac_f32 v199, v45, v141
    v_fmac_f32 v199, v46, v142
    v_fmac_f32 v199, v47, v143
    v_mul_f32 v201, v48, v136
    v_fmac_f32 v201, v49, v137
    v_permlane32_swap_b32 v197, v199
    v_fmac_f32 v201, v50, v138
    v_fmac_f32 v201, v51, v139
    s_waitcnt lgkmcnt(2)
    v_mfma_f32_32x32x8_bf16 v[0:15], v[72:73], v[176:177], v[0:15]
    v_fmac_f32 v201, v52, v140
    v_fmac_f32 v201, v53, v141
    v_fmac_f32 v201, v54, v142
    v_fmac_f32 v201, v55, v143
    v_add_f32 v199, v197, v199
    v_mul_f32_e64 v203, v56, -v136
    v_fma_f32 v203, v57, -v137, v203
    v_fma_f32 v203, v58, -v138, v203
    v_fma_f32 v203, v59, -v139, v203
    v_fma_f32 v203, v60, -v140, v203
    s_add_u32 m0, s21, 6144
    v_mfma_f32_32x32x8_bf16 v[16:31], v[76:77], v[176:177], v[16:31]
    buffer_load_dwordx4 v236, s[4:7], s37 offen lds
    v_add_u32 v252, s43, v247
    ds_read_u16 v236, v252
    ds_read_u16 v237, v252 offset:64
    v_fma_f32 v203, v61, -v141, v203
    v_fma_f32 v203, v62, -v142, v203
    v_fma_f32 v203, v63, -v143, v203
    s_nop 1
    v_permlane32_swap_b32 v201, v203
    v_add_f32 v203, v201, v203
    v_cvt_pk_bf16_f32 v198, v198, v199
    v_cvt_pk_bf16_f32 v202, v202, v203
    ds_write_b32 v253, v198 offset:0
    ds_write_b32 v253, v202 offset:256
    v_mfma_f32_32x32x16_bf16 v[32:47], v[64:67], v[180:183], 0
    v_mul_f32 v196, v0, v144
    v_fmac_f32 v196, v1, v145
    v_fmac_f32 v196, v2, v146
    v_fmac_f32 v196, v3, v147
    v_fmac_f32 v196, v4, v148
    v_fmac_f32 v196, v5, v149
    v_fmac_f32 v196, v6, v150
    v_fmac_f32 v196, v7, v151
    v_mfma_f32_32x32x16_bf16 v[48:63], v[68:71], v[180:183], 0
    s_waitcnt vmcnt(4)
    ds_read_b64_tr_b16 v[176:177], v244 offset:0
    ds_read_b64_tr_b16 v[178:179], v244 offset:1024
    ds_read_b64_tr_b16 v[180:181], v245 offset:0
    ds_read_b64_tr_b16 v[182:183], v245 offset:1024
    v_mul_f32 v198, v8, v112
    v_fmac_f32 v198, v9, v113
    v_fmac_f32 v198, v10, v114
    v_fmac_f32 v198, v11, v115
    v_fmac_f32 v198, v12, v116
    v_fmac_f32 v198, v13, v117
    v_fmac_f32 v198, v14, v118
    v_fmac_f32 v198, v15, v119
    v_mfma_f32_32x32x8_bf16 v[32:47], v[72:73], v[184:185], v[32:47]
    v_mul_f32_e64 v200, v16, -v160
    v_fma_f32 v200, v17, -v161, v200
    v_fma_f32 v200, v18, -v162, v200
    v_fma_f32 v200, v19, -v163, v200
    v_fma_f32 v200, v20, -v164, v200
    v_fma_f32 v200, v21, -v165, v200
    v_fma_f32 v200, v22, -v166, v200
    v_fma_f32 v200, v23, -v167, v200
    v_mfma_f32_32x32x8_bf16 v[48:63], v[76:77], v[184:185], v[48:63]
    v_mul_f32_e64 v202, v24, -v160
    v_fma_f32 v202, v25, -v161, v202
    v_fma_f32 v202, v26, -v162, v202
    v_fma_f32 v202, v27, -v163, v202
    v_fma_f32 v202, v28, -v164, v202
    v_fma_f32 v202, v29, -v165, v202
    v_fma_f32 v202, v30, -v166, v202
    v_fma_f32 v202, v31, -v167, v202
    s_waitcnt vmcnt(3) lgkmcnt(0)
    v_mfma_f32_32x32x16_bf16 v[0:15], v[64:67], v[176:179], 0
    v_mul_f32 v197, v32, v152
    v_fmac_f32 v197, v33, v153
    v_fmac_f32 v197, v34, v154
    v_fmac_f32 v197, v35, v155
    v_fmac_f32 v197, v36, v156
    v_fmac_f32 v197, v37, v157
    v_fmac_f32 v197, v38, v158
    v_fmac_f32 v197, v39, v159
    s_add_u32 m0, s21, 0
    v_mfma_f32_32x32x16_bf16 v[16:31], v[68:71], v[176:179], 0
    v_lshl_add_u32 v234, v234, 10, v246
    v_lshl_add_u32 v235, v235, 10, v246
    buffer_load_dwordx4 v234, s[4:7], s38 offen lds
    buffer_load_dwordx4 v235, s[8:11], s38 offen offset:1024 lds
    ds_read_b64_tr_b16 v[176:177], v244 offset:2048
    ds_read_b64_tr_b16 v[184:185], v245 offset:2048
    v_mul_f32 v199, v40, v120
    v_fmac_f32 v199, v41, v121
    v_fmac_f32 v199, v42, v122
    v_fmac_f32 v199, v43, v123
    v_fmac_f32 v199, v44, v124
    v_fmac_f32 v199, v45, v125
    v_fmac_f32 v199, v46, v126
    v_fmac_f32 v199, v47, v127
    s_waitcnt lgkmcnt(0)
    v_mfma_f32_32x32x8_bf16 v[0:15], v[72:73], v[176:177], v[0:15]
    v_mul_f32_e64 v201, v48, -v168
    v_fma_f32 v201, v49, -v169, v201
    v_fma_f32 v201, v50, -v170, v201
    v_fma_f32 v201, v51, -v171, v201
    v_fma_f32 v201, v52, -v172, v201
    v_fma_f32 v201, v53, -v173, v201
    v_fma_f32 v201, v54, -v174, v201
    v_fma_f32 v201, v55, -v175, v201
    s_add_u32 m0, s21, 2048
    v_mfma_f32_32x32x8_bf16 v[16:31], v[76:77], v[176:177], v[16:31]
    v_lshl_add_u32 v236, v236, 10, v246
    v_lshl_add_u32 v237, v237, 10, v246
    buffer_load_dwordx4 v236, s[4:7], s39 offen lds
    buffer_load_dwordx4 v237, s[8:11], s39 offen offset:1024 lds
    v_mul_f32_e64 v203, v56, -v168
    v_fma_f32 v203, v57, -v169, v203
    v_fma_f32 v203, v58, -v170, v203
    v_fma_f32 v203, v59, -v171, v203
    v_fma_f32 v203, v60, -v172, v203
    v_fma_f32 v203, v61, -v173, v203
    v_fma_f32 v203, v62, -v174, v203
    v_fma_f32 v203, v63, -v175, v203
    v_mfma_f32_32x32x16_bf16 v[32:47], v[64:67], v[180:183], 0
    v_mul_f32 v254, v0, v144
    v_fmac_f32 v254, v1, v145
    v_fmac_f32 v254, v2, v146
    v_fmac_f32 v254, v3, v147
    v_fmac_f32 v254, v4, v148
    v_mfma_f32_32x32x16_bf16 v[48:63], v[68:71], v[180:183], 0
    ds_swizzle_b32 v68, v68 offset:0x401F
    ds_swizzle_b32 v69, v69 offset:0x401F
    ds_swizzle_b32 v70, v70 offset:0x401F
    ds_swizzle_b32 v71, v71 offset:0x401F
    s_waitcnt vmcnt(5)
    ds_read_b64_tr_b16 v[176:177], v244 offset:4096
    ds_read_b64_tr_b16 v[178:179], v244 offset:5120
    ds_read_b64_tr_b16 v[180:181], v245 offset:4096
    ds_read_b64_tr_b16 v[182:183], v245 offset:5120
    v_fmac_f32 v254, v5, v149
    v_fmac_f32 v254, v6, v150
    v_fmac_f32 v254, v7, v151
    v_fmac_f32 v200, v8, v160
    v_mfma_f32_32x32x8_bf16 v[32:47], v[72:73], v[184:185], v[32:47]
    v_fmac_f32 v200, v9, v161
    v_permlane32_swap_b32 v196, v254
    v_fmac_f32 v200, v10, v162
    v_fmac_f32 v200, v11, v163
    v_fmac_f32 v200, v12, v164
    v_mfma_f32_32x32x8_bf16 v[48:63], v[76:77], v[184:185], v[48:63]
    ds_swizzle_b32 v76, v76 offset:0x401F
    ds_swizzle_b32 v77, v77 offset:0x401F
    v_fmac_f32 v200, v13, v165
    v_fmac_f32 v200, v14, v166
    v_fmac_f32 v200, v15, v167
    v_add_f32 v254, v196, v254
    s_waitcnt lgkmcnt(6)
    s_mov_b64 exec, s[56:57]
    v_xor_b32 v68, 0x80008000, v68
    v_xor_b32 v69, 0x80008000, v69
    v_xor_b32 v70, 0x80008000, v70
    v_xor_b32 v71, 0x80008000, v71
    s_mov_b64 exec, -1
    s_waitcnt vmcnt(4) lgkmcnt(2)
    v_mfma_f32_32x32x16_bf16 v[0:15], v[64:67], v[176:179], 0
    v_mul_f32 v255, v32, v152
    v_fmac_f32 v255, v33, v153
    v_fmac_f32 v255, v34, v154
    v_fmac_f32 v255, v35, v155
    v_fmac_f32 v255, v36, v156
    s_add_u32 m0, s21, 4096
    v_mfma_f32_32x32x16_bf16 v[16:31], v[68:71], v[176:179], v[16:31]
    v_lshl_add_u32 v238, v238, 10, v246
    v_lshl_add_u32 v239, v239, 10, v246
    buffer_load_dwordx4 v238, s[4:7], s40 offen lds
    buffer_load_dwordx4 v239, s[8:11], s40 offen offset:1024 lds
    ds_read_b64_tr_b16 v[176:177], v244 offset:6144
    ds_read_b64_tr_b16 v[184:185], v245 offset:6144
    v_fmac_f32 v255, v37, v157
    v_fmac_f32 v255, v38, v158
    v_fmac_f32 v255, v39, v159
    v_fmac_f32 v201, v40, v168
    v_fmac_f32 v201, v41, v169
    s_waitcnt lgkmcnt(0)
    s_mov_b64 exec, s[56:57]
    v_xor_b32 v76, 0x80008000, v76
    v_xor_b32 v77, 0x80008000, v77
    s_mov_b64 exec, -1
    v_mfma_f32_32x32x8_bf16 v[0:15], v[72:73], v[176:177], v[0:15]
    v_permlane32_swap_b32 v197, v255
    v_fmac_f32 v201, v42, v170
    v_fmac_f32 v201, v43, v171
    v_fmac_f32 v201, v44, v172
    v_fmac_f32 v201, v45, v173
    s_add_u32 m0, s21, 6144
    v_mfma_f32_32x32x8_bf16 v[16:31], v[76:77], v[176:177], v[16:31]
    v_lshl_add_u32 v240, v240, 10, v246
    v_lshl_add_u32 v241, v241, 10, v246
    buffer_load_dwordx4 v240, s[4:7], s41 offen lds
    buffer_load_dwordx4 v241, s[8:11], s41 offen offset:1024 lds
    v_fmac_f32 v201, v46, v174
    v_fmac_f32 v201, v47, v175
    v_add_f32 v255, v197, v255
    v_cvt_pk_bf16_f32 v254, v254, v255
    ds_write_b32 v253, v254 offset:512
    v_mfma_f32_32x32x16_bf16 v[32:47], v[64:67], v[180:183], 0
    v_mul_f32 v254, v0, v144
    v_fmac_f32 v254, v1, v145
    v_fmac_f32 v254, v2, v146
    v_fmac_f32 v254, v3, v147
    v_fmac_f32 v254, v4, v148
    v_fmac_f32 v254, v5, v149
    v_fmac_f32 v254, v6, v150
    v_fmac_f32 v254, v7, v151
    v_fma_f32 v202, v8, -v160, v202
    v_fma_f32 v202, v9, -v161, v202
    v_mfma_f32_32x32x16_bf16 v[48:63], v[68:71], v[180:183], v[48:63]
    s_waitcnt vmcnt(6)
    ds_read_b64_tr_b16 v[176:177], v244 offset:0
    ds_read_b64_tr_b16 v[178:179], v244 offset:1024
    ds_read_b64_tr_b16 v[180:181], v245 offset:0
    ds_read_b64_tr_b16 v[182:183], v245 offset:1024
    v_permlane32_swap_b32 v254, v200
    v_fma_f32 v202, v10, -v162, v202
    v_fma_f32 v202, v11, -v163, v202
    v_fma_f32 v202, v12, -v164, v202
    v_fma_f32 v202, v13, -v165, v202
    v_fma_f32 v202, v14, -v166, v202
    v_fma_f32 v202, v15, -v167, v202
    v_add_f32 v200, v254, v200
    v_fmac_f32 v198, v16, v112
    v_permlane32_swap_b32 v202, v254
    v_mfma_f32_32x32x8_bf16 v[32:47], v[72:73], v[184:185], v[32:47]
    v_fmac_f32 v198, v17, v113
    v_fmac_f32 v198, v18, v114
    v_fmac_f32 v198, v19, v115
    v_fmac_f32 v198, v20, v116
    v_fmac_f32 v198, v21, v117
    v_fmac_f32 v198, v22, v118
    v_fmac_f32 v198, v23, v119
    v_add_f32 v254, v202, v254
    v_mul_f32 v196, v24, v160
    v_fmac_f32 v196, v25, v161
    v_mfma_f32_32x32x8_bf16 v[48:63], v[76:77], v[184:185], v[48:63]
    v_add_u32 v249, s48, v249
    v_add_u32 v250, s49, v250
    ds_read_b32 v252, v251 offset:16
    ds_read_b64_tr_b16 v[68:69], v249 offset:0
    ds_read_b64_tr_b16 v[70:71], v249 offset:256
    s_mov_b64 exec, s[54:55]
    ds_read_u16_d16_hi v242, v250 offset:0
    s_mov_b64 exec, -1
    v_fmac_f32 v196, v26, v162
    v_fmac_f32 v196, v27, v163
    v_fmac_f32 v196, v28, v164
    v_fmac_f32 v196, v29, v165
    v_fmac_f32 v196, v30, v166
    v_fmac_f32 v196, v31, v167
    s_nop 1
    v_permlane32_swap_b32 v198, v196
    v_add_f32 v196, v198, v196
    v_mul_f32 v255, v32, v152
    v_fmac_f32 v255, v33, v153
    v_fmac_f32 v255, v34, v154
    v_fmac_f32 v255, v35, v155
    v_fmac_f32 v255, v36, v156
    v_fmac_f32 v255, v37, v157
    v_fmac_f32 v255, v38, v158
    v_fmac_f32 v255, v39, v159
    v_fma_f32 v203, v40, -v168, v203
    v_fma_f32 v203, v41, -v169, v203
    v_permlane32_swap_b32 v255, v201
    v_fma_f32 v203, v42, -v170, v203
    v_fma_f32 v203, v43, -v171, v203
    v_fma_f32 v203, v44, -v172, v203
    v_fma_f32 v203, v45, -v173, v203
    v_fma_f32 v203, v46, -v174, v203
    v_fma_f32 v203, v47, -v175, v203
    v_add_f32 v201, v255, v201
    v_fmac_f32 v199, v48, v120
    v_permlane32_swap_b32 v203, v255
    v_fmac_f32 v199, v49, v121
    v_fmac_f32 v199, v50, v122
    v_fmac_f32 v199, v51, v123
    v_fmac_f32 v199, v52, v124
    v_fmac_f32 v199, v53, v125
    v_fmac_f32 v199, v54, v126
    v_fmac_f32 v199, v55, v127
    v_add_f32 v255, v203, v255
    v_mul_f32 v197, v56, v168
    v_fmac_f32 v197, v57, v169
    v_fmac_f32 v197, v58, v170
    v_fmac_f32 v197, v59, v171
    v_fmac_f32 v197, v60, v172
    v_fmac_f32 v197, v61, v173
    v_fmac_f32 v197, v62, v174
    v_fmac_f32 v197, v63, v175
    s_nop 1
    v_permlane32_swap_b32 v199, v197
    v_add_f32 v197, v199, v197
    v_cvt_pk_bf16_f32 v200, v200, v201
    v_cvt_pk_bf16_f32 v254, v254, v255
    v_cvt_pk_bf16_f32 v196, v196, v197
    ds_write_b32 v253, v200 offset:768
    s_mov_b64 exec, 0xffffffff
    ds_write_b32 v253, v254 offset:1280
    s_mov_b64 exec, -1
    ds_write_b32 v253, v196 offset:1024
    s_add_u32 s50, s50, 1
    s_cmp_ge_u32 s50, 5
    s_cbranch_scc1 TAIL
    s_waitcnt lgkmcnt(6)
    v_readfirstlane_b32 s66, v252
    s_add_u32 s53, s53, 1
    v_mov_b32 v252, s53
    s_cmp_le_u32 s53, s66
    ds_write2_b32 v251, v252, v252 offset0:0 offset1:8
    s_setprio 1
    s_cbranch_scc1 PRIO_12
    s_setprio 0
PRIO_12:
    s_cmp_eq_u32 s52, 4
    s_cbranch_scc1 ITEM_1_4
    s_cmp_eq_u32 s52, 5
    s_cbranch_scc1 ITEM_1_5
    s_cmp_eq_u32 s52, 3
    s_cbranch_scc1 ITEM_1_3
    s_cmp_eq_u32 s52, 6
    s_cbranch_scc1 ITEM_1_6
    s_cmp_eq_u32 s52, 8
    s_cbranch_scc1 ITEM_1_8
    s_branch ITEM_1_2
.p2align 6
ITEM_1_6:
    s_mov_b64 exec, s[54:55]
    ds_read_u16_d16_hi v243, v250 offset:128
    s_mov_b64 exec, -1
    ds_read_b64_tr_b16 v[76:77], v249 offset:512
    ds_read_b64_tr_b16 v[78:79], v249 offset:768
    ds_read_b64_tr_b16 v[84:85], v249 offset:1024
    ds_read_b64_tr_b16 v[86:87], v249 offset:1280
    s_waitcnt lgkmcnt(5)
    v_lshlrev_b32 v196, 16, v68
    v_and_b32 v197, 0xffff0000, v68
    v_lshlrev_b32 v198, 16, v69
    v_and_b32 v199, 0xffff0000, v69
    v_mul_f32_dpp v200, v242, v196 row_newbcast:0 row_mask:0xf bank_mask:0xf
    v_mul_f32_dpp v201, v242, v197 row_newbcast:1 row_mask:0xf bank_mask:0xf
    v_mul_f32_dpp v202, v242, v196 row_newbcast:8 row_mask:0xf bank_mask:0xf
    v_mul_f32_dpp v203, v242, v197 row_newbcast:9 row_mask:0xf bank_mask:0xf
    v_lshlrev_b32 v196, 16, v70
    v_and_b32 v197, 0xffff0000, v70
    v_cvt_pk_bf16_f32 v64, v200, v201
    v_cvt_pk_bf16_f32 v68, v202, v203
    v_mul_f32_dpp v200, v242, v198 row_newbcast:2 row_mask:0xf bank_mask:0xf
    v_mul_f32_dpp v201, v242, v199 row_newbcast:3 row_mask:0xf bank_mask:0xf
    v_mul_f32_dpp v202, v242, v198 row_newbcast:10 row_mask:0xf bank_mask:0xf
    v_mul_f32_dpp v203, v242, v199 row_newbcast:11 row_mask:0xf bank_mask:0xf
    v_lshlrev_b32 v198, 16, v71
    v_and_b32 v199, 0xffff0000, v71
    v_cvt_pk_bf16_f32 v65, v200, v201
    v_cvt_pk_bf16_f32 v69, v202, v203
    v_mul_f32_dpp v200, v242, v196 row_newbcast:4 row_mask:0xf bank_mask:0xf
    v_mul_f32_dpp v201, v242, v197 row_newbcast:5 row_mask:0xf bank_mask:0xf
    v_mul_f32_dpp v202, v242, v196 row_newbcast:12 row_mask:0xf bank_mask:0xf
    v_mul_f32_dpp v203, v242, v197 row_newbcast:13 row_mask:0xf bank_mask:0xf
    v_cvt_pk_bf16_f32 v66, v200, v201
    v_cvt_pk_bf16_f32 v70, v202, v203
    v_mul_f32_dpp v200, v242, v198 row_newbcast:6 row_mask:0xf bank_mask:0xf
    v_mul_f32_dpp v201, v242, v199 row_newbcast:7 row_mask:0xf bank_mask:0xf
    v_mul_f32_dpp v202, v242, v198 row_newbcast:14 row_mask:0xf bank_mask:0xf
    v_mul_f32_dpp v203, v242, v199 row_newbcast:15 row_mask:0xf bank_mask:0xf
    v_cvt_pk_bf16_f32 v67, v200, v201
    v_cvt_pk_bf16_f32 v71, v202, v203
    s_mov_b64 exec, s[54:55]
    ds_read_u16_d16_hi v242, v250 offset:256
    s_mov_b64 exec, -1
    s_waitcnt vmcnt(4) lgkmcnt(3)
    v_mfma_f32_32x32x16_bf16 v[0:15], v[64:67], v[176:179], 0
    v_lshlrev_b32 v196, 16, v76
    v_and_b32 v197, 0xffff0000, v76
    v_lshlrev_b32 v198, 16, v77
    v_and_b32 v199, 0xffff0000, v77
    v_mul_f32_dpp v200, v243, v196 row_newbcast:0 row_mask:0xf bank_mask:0xf
    v_mul_f32_dpp v201, v243, v197 row_newbcast:1 row_mask:0xf bank_mask:0xf
    v_mul_f32_dpp v202, v243, v196 row_newbcast:8 row_mask:0xf bank_mask:0xf
    v_mul_f32_dpp v203, v243, v197 row_newbcast:9 row_mask:0xf bank_mask:0xf
    v_lshlrev_b32 v196, 16, v78
    v_and_b32 v197, 0xffff0000, v78
    v_cvt_pk_bf16_f32 v72, v200, v201
    v_cvt_pk_bf16_f32 v76, v202, v203
    v_mul_f32_dpp v200, v243, v198 row_newbcast:2 row_mask:0xf bank_mask:0xf
    v_mul_f32_dpp v201, v243, v199 row_newbcast:3 row_mask:0xf bank_mask:0xf
    v_mul_f32_dpp v202, v243, v198 row_newbcast:10 row_mask:0xf bank_mask:0xf
    v_mul_f32_dpp v203, v243, v199 row_newbcast:11 row_mask:0xf bank_mask:0xf
    s_add_u32 m0, s21, 0
    v_mfma_f32_32x32x16_bf16 v[16:31], v[68:71], v[176:179], 0
    buffer_load_dwordx4 v236, s[4:7], s35 offen lds
    buffer_load_dwordx4 v237, s[8:11], s35 offen offset:1024 lds
    ds_read_b64_tr_b16 v[176:177], v244 offset:2048
    ds_read_b64_tr_b16 v[178:179], v244 offset:3072
    ds_read_b64_tr_b16 v[184:185], v245 offset:2048
    ds_read_b64_tr_b16 v[186:187], v245 offset:3072
    v_lshlrev_b32 v198, 16, v79
    v_and_b32 v199, 0xffff0000, v79
    v_cvt_pk_bf16_f32 v73, v200, v201
    v_cvt_pk_bf16_f32 v77, v202, v203
    v_mul_f32_dpp v200, v243, v196 row_newbcast:4 row_mask:0xf bank_mask:0xf
    v_mul_f32_dpp v201, v243, v197 row_newbcast:5 row_mask:0xf bank_mask:0xf
    v_mul_f32_dpp v202, v243, v196 row_newbcast:12 row_mask:0xf bank_mask:0xf
    v_mul_f32_dpp v203, v243, v197 row_newbcast:13 row_mask:0xf bank_mask:0xf
    v_cvt_pk_bf16_f32 v74, v200, v201
    v_cvt_pk_bf16_f32 v78, v202, v203
    v_mul_f32_dpp v200, v243, v198 row_newbcast:6 row_mask:0xf bank_mask:0xf
    v_mul_f32_dpp v201, v243, v199 row_newbcast:7 row_mask:0xf bank_mask:0xf
    v_mul_f32_dpp v202, v243, v198 row_newbcast:14 row_mask:0xf bank_mask:0xf
    v_mul_f32_dpp v203, v243, v199 row_newbcast:15 row_mask:0xf bank_mask:0xf
    v_cvt_pk_bf16_f32 v75, v200, v201
    v_cvt_pk_bf16_f32 v79, v202, v203
    s_nop 0
    s_waitcnt vmcnt(4) lgkmcnt(0)
    v_mfma_f32_32x32x16_bf16 v[0:15], v[72:75], v[176:179], v[0:15]
    v_lshlrev_b32 v196, 16, v84
    v_and_b32 v197, 0xffff0000, v84
    v_lshlrev_b32 v198, 16, v85
    v_and_b32 v199, 0xffff0000, v85
    v_mul_f32_dpp v200, v242, v196 row_newbcast:0 row_mask:0xf bank_mask:0xf
    v_mul_f32_dpp v201, v242, v197 row_newbcast:1 row_mask:0xf bank_mask:0xf
    v_mul_f32_dpp v202, v242, v196 row_newbcast:8 row_mask:0xf bank_mask:0xf
    v_mul_f32_dpp v203, v242, v197 row_newbcast:9 row_mask:0xf bank_mask:0xf
    v_lshlrev_b32 v196, 16, v86
    v_and_b32 v197, 0xffff0000, v86
    v_cvt_pk_bf16_f32 v80, v200, v201
    v_cvt_pk_bf16_f32 v84, v202, v203
    v_mul_f32_dpp v200, v242, v198 row_newbcast:2 row_mask:0xf bank_mask:0xf
    v_mul_f32_dpp v201, v242, v199 row_newbcast:3 row_mask:0xf bank_mask:0xf
    v_mul_f32_dpp v202, v242, v198 row_newbcast:10 row_mask:0xf bank_mask:0xf
    v_mul_f32_dpp v203, v242, v199 row_newbcast:11 row_mask:0xf bank_mask:0xf
    s_add_u32 m0, s21, 2048
    v_mfma_f32_32x32x16_bf16 v[16:31], v[76:79], v[176:179], v[16:31]
    buffer_load_dwordx4 v238, s[4:7], s35 offen lds
    buffer_load_dwordx4 v239, s[8:11], s35 offen offset:1024 lds
    ds_read_b64_tr_b16 v[176:177], v244 offset:4096
    ds_read_b64_tr_b16 v[178:179], v244 offset:5120
    ds_read_b64_tr_b16 v[188:189], v245 offset:4096
    ds_read_b64_tr_b16 v[190:191], v245 offset:5120
    v_lshlrev_b32 v198, 16, v87
    v_and_b32 v199, 0xffff0000, v87
    v_cvt_pk_bf16_f32 v81, v200, v201
    v_cvt_pk_bf16_f32 v85, v202, v203
    v_mul_f32_dpp v200, v242, v196 row_newbcast:4 row_mask:0xf bank_mask:0xf
    v_mul_f32_dpp v201, v242, v197 row_newbcast:5 row_mask:0xf bank_mask:0xf
    v_mul_f32_dpp v202, v242, v196 row_newbcast:12 row_mask:0xf bank_mask:0xf
    v_mul_f32_dpp v203, v242, v197 row_newbcast:13 row_mask:0xf bank_mask:0xf
    v_cvt_pk_bf16_f32 v82, v200, v201
    v_cvt_pk_bf16_f32 v86, v202, v203
    v_mul_f32_dpp v200, v242, v198 row_newbcast:6 row_mask:0xf bank_mask:0xf
    v_mul_f32_dpp v201, v242, v199 row_newbcast:7 row_mask:0xf bank_mask:0xf
    v_mul_f32_dpp v202, v242, v198 row_newbcast:14 row_mask:0xf bank_mask:0xf
    v_mul_f32_dpp v203, v242, v199 row_newbcast:15 row_mask:0xf bank_mask:0xf
    v_cvt_pk_bf16_f32 v83, v200, v201
    v_cvt_pk_bf16_f32 v87, v202, v203
    s_nop 0
    s_waitcnt lgkmcnt(0)
    v_mfma_f32_32x32x16_bf16 v[0:15], v[80:83], v[176:179], v[0:15]
    s_add_u32 m0, s21, 4096
    v_mfma_f32_32x32x16_bf16 v[16:31], v[84:87], v[176:179], v[16:31]
    buffer_load_dwordx4 v234, s[4:7], s36 offen lds
    buffer_load_dwordx4 v235, s[8:11], s36 offen offset:1024 lds
    s_mov_b32 m0, s50
    s_nop 0
    s_movrels_b32 s71, s23
    s_movrels_b32 s33, s28
    s_and_b32 s70, s33, 0x70
    s_andn2_b32 s33, s33, 0x70
    v_xor_b32 v253, s70, v248
    v_add_u32 v253, s33, v253
    s_bfe_u32 s46, s71, 0x30012
    s_mov_b32 m0, s46
    s_and_b32 s66, s71, 0x3ffff
    s_movrels_b32 s68, s57
    s_movrels_b32 s69, s61
    s_sub_u32 s48, s66, s47
    s_mov_b32 s47, s66
    s_lshr_b32 s52, s71, 28
    s_lshl_b32 s67, s46, 9
    s_add_u32 s66, s66, s67
    s_sub_u32 s49, s66, s42
    s_mov_b32 s42, s66
    s_bfe_u32 s66, s68, 655360
    s_add_u32 s43, s42, s66
    s_bfe_u32 s39, s69, 655360
    s_bfe_u32 s66, s68, 655370
    s_add_u32 s44, s42, s66
    s_bfe_u32 s40, s69, 655370
    s_bfe_u32 s66, s68, 655380
    s_add_u32 s45, s42, s66
    s_bfe_u32 s41, s69, 655380
    v_add_u32 v252, s45, v247
    ds_read_u16 v240, v252
    ds_read_u16 v241, v252 offset:64
    v_mfma_f32_32x32x16_bf16 v[32:47], v[64:67], v[180:183], 0
    v_mul_f32 v196, v0, v96
    v_fmac_f32 v196, v1, v97
    v_fmac_f32 v196, v2, v98
    v_fmac_f32 v196, v3, v99
    v_fmac_f32 v196, v4, v100
    v_fmac_f32 v196, v5, v101
    v_fmac_f32 v196, v6, v102
    v_mfma_f32_32x32x16_bf16 v[48:63], v[68:71], v[180:183], 0
    v_fmac_f32 v196, v7, v103
    v_mul_f32 v198, v8, v128
    v_fmac_f32 v198, v9, v129
    v_fmac_f32 v198, v10, v130
    v_fmac_f32 v198, v11, v131
    v_fmac_f32 v198, v12, v132
    v_mfma_f32_32x32x16_bf16 v[32:47], v[72:75], v[184:187], v[32:47]
    v_fmac_f32 v198, v13, v133
    v_fmac_f32 v198, v14, v134
    v_fmac_f32 v198, v15, v135
    v_mul_f32 v200, v16, v128
    v_fmac_f32 v200, v17, v129
    v_permlane32_swap_b32 v196, v198
    v_mfma_f32_32x32x16_bf16 v[48:63], v[76:79], v[184:187], v[48:63]
    s_waitcnt vmcnt(6)
    ds_read_b64_tr_b16 v[176:177], v244 offset:6144
    ds_read_b64_tr_b16 v[178:179], v244 offset:7168
    ds_read_b64_tr_b16 v[180:181], v245 offset:6144
    ds_read_b64_tr_b16 v[182:183], v245 offset:7168
    v_fmac_f32 v200, v18, v130
    v_fmac_f32 v200, v19, v131
    v_fmac_f32 v200, v20, v132
    v_fmac_f32 v200, v21, v133
    v_fmac_f32 v200, v22, v134
    v_fmac_f32 v200, v23, v135
    v_mfma_f32_32x32x16_bf16 v[32:47], v[80:83], v[188:191], v[32:47]
    v_add_f32 v198, v196, v198
    v_mul_f32_e64 v202, v24, -v128
    v_fma_f32 v202, v25, -v129, v202
    v_fma_f32 v202, v26, -v130, v202
    v_fma_f32 v202, v27, -v131, v202
    v_fma_f32 v202, v28, -v132, v202
    v_mfma_f32_32x32x16_bf16 v[48:63], v[84:87], v[188:191], v[48:63]
    v_fma_f32 v202, v29, -v133, v202
    v_fma_f32 v202, v30, -v134, v202
    v_fma_f32 v202, v31, -v135, v202
    s_nop 1
    v_permlane32_swap_b32 v200, v202
    v_add_f32 v202, v200, v202
    s_waitcnt vmcnt(4) lgkmcnt(0)
    v_mfma_f32_32x32x16_bf16 v[0:15], v[64:67], v[176:179], 0
    v_mul_f32 v197, v32, v104
    v_fmac_f32 v197, v33, v105
    v_fmac_f32 v197, v34, v106
    v_fmac_f32 v197, v35, v107
    v_fmac_f32 v197, v36, v108
    v_fmac_f32 v197, v37, v109
    v_fmac_f32 v197, v38, v110
    s_add_u32 m0, s21, 6144
    v_mfma_f32_32x32x16_bf16 v[16:31], v[68:71], v[176:179], 0
    buffer_load_dwordx4 v236, s[4:7], s36 offen lds
    buffer_load_dwordx4 v237, s[8:11], s36 offen offset:1024 lds
    ds_read_b64_tr_b16 v[176:177], v244 offset:0
    ds_read_b64_tr_b16 v[178:179], v244 offset:1024
    ds_read_b64_tr_b16 v[184:185], v245 offset:0
    ds_read_b64_tr_b16 v[186:187], v245 offset:1024
    v_fmac_f32 v197, v39, v111
    v_mul_f32 v199, v40, v136
    v_fmac_f32 v199, v41, v137
    v_fmac_f32 v199, v42, v138
    v_fmac_f32 v199, v43, v139
    v_fmac_f32 v199, v44, v140
    v_fmac_f32 v199, v45, v141
    s_waitcnt vmcnt(4) lgkmcnt(0)
    v_mfma_f32_32x32x16_bf16 v[0:15], v[72:75], v[176:179], v[0:15]
    v_fmac_f32 v199, v46, v142
    v_fmac_f32 v199, v47, v143
    v_mul_f32 v201, v48, v136
    v_fmac_f32 v201, v49, v137
    v_permlane32_swap_b32 v197, v199
    v_fmac_f32 v201, v50, v138
    v_fmac_f32 v201, v51, v139
    s_add_u32 m0, s21, 0
    v_mfma_f32_32x32x16_bf16 v[16:31], v[76:79], v[176:179], v[16:31]
    buffer_load_dwordx4 v238, s[4:7], s36 offen lds
    buffer_load_dwordx4 v239, s[8:11], s36 offen offset:1024 lds
    ds_read_b64_tr_b16 v[176:177], v244 offset:2048
    ds_read_b64_tr_b16 v[178:179], v244 offset:3072
    ds_read_b64_tr_b16 v[188:189], v245 offset:2048
    ds_read_b64_tr_b16 v[190:191], v245 offset:3072
    v_fmac_f32 v201, v52, v140
    v_fmac_f32 v201, v53, v141
    v_fmac_f32 v201, v54, v142
    v_fmac_f32 v201, v55, v143
    v_add_f32 v199, v197, v199
    v_mul_f32_e64 v203, v56, -v136
    v_fma_f32 v203, v57, -v137, v203
    s_waitcnt lgkmcnt(0)
    v_mfma_f32_32x32x16_bf16 v[0:15], v[80:83], v[176:179], v[0:15]
    v_fma_f32 v203, v58, -v138, v203
    v_fma_f32 v203, v59, -v139, v203
    v_fma_f32 v203, v60, -v140, v203
    v_fma_f32 v203, v61, -v141, v203
    v_fma_f32 v203, v62, -v142, v203
    v_fma_f32 v203, v63, -v143, v203
    s_nop 1
    s_add_u32 m0, s21, 2048
    v_mfma_f32_32x32x16_bf16 v[16:31], v[84:87], v[176:179], v[16:31]
    buffer_load_dwordx4 v234, s[4:7], s37 offen lds
    buffer_load_dwordx4 v235, s[8:11], s37 offen offset:1024 lds
    v_add_u32 v252, s42, v247
    ds_read_u16 v234, v252
    ds_read_u16 v235, v252 offset:64
    v_permlane32_swap_b32 v201, v203
    v_add_f32 v203, v201, v203
    v_cvt_pk_bf16_f32 v198, v198, v199
    v_cvt_pk_bf16_f32 v202, v202, v203
    ds_write_b32 v253, v198 offset:0
    ds_write_b32 v253, v202 offset:256
    v_mfma_f32_32x32x16_bf16 v[32:47], v[64:67], v[180:183], 0
    v_mul_f32 v196, v0, v144
    v_fmac_f32 v196, v1, v145
    v_fmac_f32 v196, v2, v146
    v_fmac_f32 v196, v3, v147
    v_fmac_f32 v196, v4, v148
    v_fmac_f32 v196, v5, v149
    v_mfma_f32_32x32x16_bf16 v[48:63], v[68:71], v[180:183], 0
    v_fmac_f32 v196, v6, v150
    v_fmac_f32 v196, v7, v151
    v_mul_f32 v198, v8, v112
    v_fmac_f32 v198, v9, v113
    v_fmac_f32 v198, v10, v114
    v_mfma_f32_32x32x16_bf16 v[32:47], v[72:75], v[184:187], v[32:47]
    v_fmac_f32 v198, v11, v115
    v_fmac_f32 v198, v12, v116
    v_fmac_f32 v198, v13, v117
    v_fmac_f32 v198, v14, v118
    v_fmac_f32 v198, v15, v119
    v_mfma_f32_32x32x16_bf16 v[48:63], v[76:79], v[184:187], v[48:63]
    s_waitcnt vmcnt(6)
    ds_read_b64_tr_b16 v[176:177], v244 offset:4096
    ds_read_b64_tr_b16 v[178:179], v244 offset:5120
    ds_read_b64_tr_b16 v[180:181], v245 offset:4096
    ds_read_b64_tr_b16 v[182:183], v245 offset:5120
    v_mul_f32_e64 v200, v16, -v160
    v_fma_f32 v200, v17, -v161, v200
    v_fma_f32 v200, v18, -v162, v200
    v_fma_f32 v200, v19, -v163, v200
    v_fma_f32 v200, v20, -v164, v200
    v_fma_f32 v200, v21, -v165, v200
    v_mfma_f32_32x32x16_bf16 v[32:47], v[80:83], v[188:191], v[32:47]
    v_fma_f32 v200, v22, -v166, v200
    v_fma_f32 v200, v23, -v167, v200
    v_mul_f32_e64 v202, v24, -v160
    v_fma_f32 v202, v25, -v161, v202
    v_fma_f32 v202, v26, -v162, v202
    v_mfma_f32_32x32x16_bf16 v[48:63], v[84:87], v[188:191], v[48:63]
    v_fma_f32 v202, v27, -v163, v202
    v_fma_f32 v202, v28, -v164, v202
    v_fma_f32 v202, v29, -v165, v202
    v_fma_f32 v202, v30, -v166, v202
    v_fma_f32 v202, v31, -v167, v202
    s_waitcnt vmcnt(4) lgkmcnt(0)
    v_mfma_f32_32x32x16_bf16 v[0:15], v[64:67], v[176:179], 0
    v_mul_f32 v197, v32, v152
    v_fmac_f32 v197, v33, v153
    v_fmac_f32 v197, v34, v154
    v_fmac_f32 v197, v35, v155
    v_fmac_f32 v197, v36, v156
    v_fmac_f32 v197, v37, v157
    s_add_u32 m0, s21, 4096
    v_mfma_f32_32x32x16_bf16 v[16:31], v[68:71], v[176:179], 0
    buffer_load_dwordx4 v236, s[4:7], s37 offen lds
    buffer_load_dwordx4 v237, s[8:11], s37 offen offset:1024 lds
    ds_read_b64_tr_b16 v[176:177], v244 offset:6144
    ds_read_b64_tr_b16 v[178:179], v244 offset:7168
    ds_read_b64_tr_b16 v[184:185], v245 offset:6144
    ds_read_b64_tr_b16 v[186:187], v245 offset:7168
    v_add_u32 v252, s43, v247
    ds_read_u16 v236, v252
    ds_read_u16 v237, v252 offset:64
    v_fmac_f32 v197, v38, v158
    v_fmac_f32 v197, v39, v159
    v_mul_f32 v199, v40, v120
    v_fmac_f32 v199, v41, v121
    v_fmac_f32 v199, v42, v122
    s_waitcnt vmcnt(4) lgkmcnt(2)
    v_mfma_f32_32x32x16_bf16 v[0:15], v[72:75], v[176:179], v[0:15]
    v_fmac_f32 v199, v43, v123
    v_fmac_f32 v199, v44, v124
    v_fmac_f32 v199, v45, v125
    v_fmac_f32 v199, v46, v126
    v_fmac_f32 v199, v47, v127
    s_add_u32 m0, s21, 6144
    v_mfma_f32_32x32x16_bf16 v[16:31], v[76:79], v[176:179], v[16:31]
    buffer_load_dwordx4 v238, s[4:7], s37 offen lds
    buffer_load_dwordx4 v239, s[8:11], s37 offen offset:1024 lds
    ds_read_b64_tr_b16 v[176:177], v244 offset:0
    ds_read_b64_tr_b16 v[178:179], v244 offset:1024
    ds_read_b64_tr_b16 v[188:189], v245 offset:0
    ds_read_b64_tr_b16 v[190:191], v245 offset:1024
    v_add_u32 v252, s44, v247
    ds_read_u16 v238, v252
    ds_read_u16 v239, v252 offset:64
    v_mul_f32_e64 v201, v48, -v168
    v_fma_f32 v201, v49, -v169, v201
    v_fma_f32 v201, v50, -v170, v201
    v_fma_f32 v201, v51, -v171, v201
    v_fma_f32 v201, v52, -v172, v201
    v_fma_f32 v201, v53, -v173, v201
    s_waitcnt lgkmcnt(2)
    v_mfma_f32_32x32x16_bf16 v[0:15], v[80:83], v[176:179], v[0:15]
    v_fma_f32 v201, v54, -v174, v201
    v_fma_f32 v201, v55, -v175, v201
    v_mul_f32_e64 v203, v56, -v168
    v_fma_f32 v203, v57, -v169, v203
    v_fma_f32 v203, v58, -v170, v203
    s_add_u32 m0, s21, 0
    v_mfma_f32_32x32x16_bf16 v[16:31], v[84:87], v[176:179], v[16:31]
    v_lshl_add_u32 v234, v234, 10, v246
    v_lshl_add_u32 v235, v235, 10, v246
    buffer_load_dwordx4 v234, s[4:7], s38 offen lds
    buffer_load_dwordx4 v235, s[8:11], s38 offen offset:1024 lds
    v_fma_f32 v203, v59, -v171, v203
    v_fma_f32 v203, v60, -v172, v203
    v_fma_f32 v203, v61, -v173, v203
    v_fma_f32 v203, v62, -v174, v203
    v_fma_f32 v203, v63, -v175, v203
    v_mfma_f32_32x32x16_bf16 v[32:47], v[64:67], v[180:183], 0
    v_mul_f32 v254, v0, v144
    v_fmac_f32 v254, v1, v145
    v_fmac_f32 v254, v2, v146
    v_mfma_f32_32x32x16_bf16 v[48:63], v[68:71], v[180:183], 0
    ds_swizzle_b32 v68, v68 offset:0x401F
    ds_swizzle_b32 v69, v69 offset:0x401F
    ds_swizzle_b32 v70, v70 offset:0x401F
    ds_swizzle_b32 v71, v71 offset:0x401F
    v_fmac_f32 v254, v3, v147
    v_fmac_f32 v254, v4, v148
    v_fmac_f32 v254, v5, v149
    v_mfma_f32_32x32x16_bf16 v[32:47], v[72:75], v[184:187], v[32:47]
    v_fmac_f32 v254, v6, v150
    v_fmac_f32 v254, v7, v151
    v_fmac_f32 v200, v8, v160
    v_mfma_f32_32x32x16_bf16 v[48:63], v[76:79], v[184:187], v[48:63]
    ds_swizzle_b32 v76, v76 offset:0x401F
    ds_swizzle_b32 v77, v77 offset:0x401F
    ds_swizzle_b32 v78, v78 offset:0x401F
    ds_swizzle_b32 v79, v79 offset:0x401F
    s_waitcnt vmcnt(6)
    ds_read_b64_tr_b16 v[176:177], v244 offset:2048
    ds_read_b64_tr_b16 v[178:179], v244 offset:3072
    ds_read_b64_tr_b16 v[180:181], v245 offset:2048
    ds_read_b64_tr_b16 v[182:183], v245 offset:3072
    v_fmac_f32 v200, v9, v161
    v_permlane32_swap_b32 v196, v254
    v_fmac_f32 v200, v10, v162
    v_mfma_f32_32x32x16_bf16 v[32:47], v[80:83], v[188:191], v[32:47]
    v_fmac_f32 v200, v11, v163
    v_fmac_f32 v200, v12, v164
    v_fmac_f32 v200, v13, v165
    v_mfma_f32_32x32x16_bf16 v[48:63], v[84:87], v[188:191], v[48:63]
    ds_swizzle_b32 v84, v84 offset:0x401F
    ds_swizzle_b32 v85, v85 offset:0x401F
    ds_swizzle_b32 v86, v86 offset:0x401F
    ds_swizzle_b32 v87, v87 offset:0x401F
    v_fmac_f32 v200, v14, v166
    v_fmac_f32 v200, v15, v167
    v_add_f32 v254, v196, v254
    s_waitcnt lgkmcnt(8)
    s_mov_b64 exec, s[56:57]
    v_xor_b32 v68, 0x80008000, v68
    v_xor_b32 v69, 0x80008000, v69
    v_xor_b32 v70, 0x80008000, v70
    v_xor_b32 v71, 0x80008000, v71
    v_xor_b32 v76, 0x80008000, v76
    v_xor_b32 v77, 0x80008000, v77
    v_xor_b32 v78, 0x80008000, v78
    v_xor_b32 v79, 0x80008000, v79
    s_mov_b64 exec, -1
    s_waitcnt vmcnt(4) lgkmcnt(4)
    v_mfma_f32_32x32x16_bf16 v[0:15], v[64:67], v[176:179], 0
    v_mul_f32 v255, v32, v152
    v_fmac_f32 v255, v33, v153
    v_fmac_f32 v255, v34, v154
    v_fmac_f32 v255, v35, v155
    s_add_u32 m0, s21, 2048
    v_mfma_f32_32x32x16_bf16 v[16:31], v[68:71], v[176:179], v[16:31]
    v_lshl_add_u32 v236, v236, 10, v246
    v_lshl_add_u32 v237, v237, 10, v246
    buffer_load_dwordx4 v236, s[4:7], s39 offen lds
    buffer_load_dwordx4 v237, s[8:11], s39 offen offset:1024 lds
    ds_read_b64_tr_b16 v[176:177], v244 offset:4096
    ds_read_b64_tr_b16 v[178:179], v244 offset:5120
    ds_read_b64_tr_b16 v[184:185], v245 offset:4096
    ds_read_b64_tr_b16 v[186:187], v245 offset:5120
    v_fmac_f32 v255, v36, v156
    v_fmac_f32 v255, v37, v157
    v_fmac_f32 v255, v38, v158
    s_waitcnt vmcnt(4) lgkmcnt(0)
    v_mfma_f32_32x32x16_bf16 v[0:15], v[72:75], v[176:179], v[0:15]
    v_fmac_f32 v255, v39, v159
    v_fmac_f32 v201, v40, v168
    v_fmac_f32 v201, v41, v169
    s_add_u32 m0, s21, 4096
    v_mfma_f32_32x32x16_bf16 v[16:31], v[76:79], v[176:179], v[16:31]
    v_lshl_add_u32 v238, v238, 10, v246
    v_lshl_add_u32 v239, v239, 10, v246
    buffer_load_dwordx4 v238, s[4:7], s40 offen lds
    buffer_load_dwordx4 v239, s[8:11], s40 offen offset:1024 lds
    ds_read_b64_tr_b16 v[176:177], v244 offset:6144
    ds_read_b64_tr_b16 v[178:179], v244 offset:7168
    ds_read_b64_tr_b16 v[188:189], v245 offset:6144
    ds_read_b64_tr_b16 v[190:191], v245 offset:7168
    v_permlane32_swap_b32 v197, v255
    v_fmac_f32 v201, v42, v170
    v_fmac_f32 v201, v43, v171
    v_fmac_f32 v201, v44, v172
    s_waitcnt lgkmcnt(0)
    s_mov_b64 exec, s[56:57]
    v_xor_b32 v84, 0x80008000, v84
    v_xor_b32 v85, 0x80008000, v85
    v_xor_b32 v86, 0x80008000, v86
    v_xor_b32 v87, 0x80008000, v87
    s_mov_b64 exec, -1
    v_mfma_f32_32x32x16_bf16 v[0:15], v[80:83], v[176:179], v[0:15]
    v_fmac_f32 v201, v45, v173
    v_fmac_f32 v201, v46, v174
    v_fmac_f32 v201, v47, v175
    s_add_u32 m0, s21, 6144
    v_mfma_f32_32x32x16_bf16 v[16:31], v[84:87], v[176:179], v[16:31]
    v_lshl_add_u32 v240, v240, 10, v246
    v_lshl_add_u32 v241, v241, 10, v246
    buffer_load_dwordx4 v240, s[4:7], s41 offen lds
    buffer_load_dwordx4 v241, s[8:11], s41 offen offset:1024 lds
    v_add_f32 v255, v197, v255
    v_cvt_pk_bf16_f32 v254, v254, v255
    ds_write_b32 v253, v254 offset:512
    v_mfma_f32_32x32x16_bf16 v[32:47], v[64:67], v[180:183], 0
    v_mul_f32 v254, v0, v144
    v_fmac_f32 v254, v1, v145
    v_fmac_f32 v254, v2, v146
    v_fmac_f32 v254, v3, v147
    v_fmac_f32 v254, v4, v148
    v_fmac_f32 v254, v5, v149
    v_fmac_f32 v254, v6, v150
    v_mfma_f32_32x32x16_bf16 v[48:63], v[68:71], v[180:183], v[48:63]
    v_fmac_f32 v254, v7, v151
    v_fma_f32 v202, v8, -v160, v202
    v_fma_f32 v202, v9, -v161, v202
    v_permlane32_swap_b32 v254, v200
    v_fma_f32 v202, v10, -v162, v202
    v_fma_f32 v202, v11, -v163, v202
    v_mfma_f32_32x32x16_bf16 v[32:47], v[72:75], v[184:187], v[32:47]
    v_fma_f32 v202, v12, -v164, v202
    v_fma_f32 v202, v13, -v165, v202
    v_fma_f32 v202, v14, -v166, v202
    v_fma_f32 v202, v15, -v167, v202
    v_add_f32 v200, v254, v200
    v_fmac_f32 v198, v16, v112
    v_permlane32_swap_b32 v202, v254
    v_mfma_f32_32x32x16_bf16 v[48:63], v[76:79], v[184:187], v[48:63]
    s_waitcnt vmcnt(6)
    ds_read_b64_tr_b16 v[176:177], v244 offset:0
    ds_read_b64_tr_b16 v[178:179], v244 offset:1024
    ds_read_b64_tr_b16 v[180:181], v245 offset:0
    ds_read_b64_tr_b16 v[182:183], v245 offset:1024
    v_fmac_f32 v198, v17, v113
    v_fmac_f32 v198, v18, v114
    v_fmac_f32 v198, v19, v115
    v_fmac_f32 v198, v20, v116
    v_fmac_f32 v198, v21, v117
    v_fmac_f32 v198, v22, v118
    v_mfma_f32_32x32x16_bf16 v[32:47], v[80:83], v[188:191], v[32:47]
    v_fmac_f32 v198, v23, v119
    v_add_f32 v254, v202, v254
    v_mul_f32 v196, v24, v160
    v_fmac_f32 v196, v25, v161
    v_fmac_f32 v196, v26, v162
    v_fmac_f32 v196, v27, v163
    v_fmac_f32 v196, v28, v164
    v_mfma_f32_32x32x16_bf16 v[48:63], v[84:87], v[188:191], v[48:63]
    v_add_u32 v249, s48, v249
    v_add_u32 v250, s49, v250
    ds_read_b32 v252, v251 offset:16
    ds_read_b64_tr_b16 v[68:69], v249 offset:0
    ds_read_b64_tr_b16 v[70:71], v249 offset:256
    s_mov_b64 exec, s[54:55]
    ds_read_u16_d16_hi v242, v250 offset:0
    s_mov_b64 exec, -1
    v_fmac_f32 v196, v29, v165
    v_fmac_f32 v196, v30, v166
    v_fmac_f32 v196, v31, v167
    s_nop 1
    v_permlane32_swap_b32 v198, v196
    v_add_f32 v196, v198, v196
    v_mul_f32 v255, v32, v152
    v_fmac_f32 v255, v33, v153
    v_fmac_f32 v255, v34, v154
    v_fmac_f32 v255, v35, v155
    v_fmac_f32 v255, v36, v156
    v_fmac_f32 v255, v37, v157
    v_fmac_f32 v255, v38, v158
    v_fmac_f32 v255, v39, v159
    v_fma_f32 v203, v40, -v168, v203
    v_fma_f32 v203, v41, -v169, v203
    v_permlane32_swap_b32 v255, v201
    v_fma_f32 v203, v42, -v170, v203
    v_fma_f32 v203, v43, -v171, v203
    v_fma_f32 v203, v44, -v172, v203
    v_fma_f32 v203, v45, -v173, v203
    v_fma_f32 v203, v46, -v174, v203
    v_fma_f32 v203, v47, -v175, v203
    v_add_f32 v201, v255, v201
    v_fmac_f32 v199, v48, v120
    v_permlane32_swap_b32 v203, v255
    v_fmac_f32 v199, v49, v121
    v_fmac_f32 v199, v50, v122
    v_fmac_f32 v199, v51, v123
    v_fmac_f32 v199, v52, v124
    v_fmac_f32 v199, v53, v125
    v_fmac_f32 v199, v54, v126
    v_fmac_f32 v199, v55, v127
    v_add_f32 v255, v203, v255
    v_mul_f32 v197, v56, v168
    v_fmac_f32 v197, v57, v169
    v_fmac_f32 v197, v58, v170
    v_fmac_f32 v197, v59, v171
    v_fmac_f32 v197, v60, v172
    v_fmac_f32 v197, v61, v173
    v_fmac_f32 v197, v62, v174
    v_fmac_f32 v197, v63, v175
    s_nop 1
    v_permlane32_swap_b32 v199, v197
    v_add_f32 v197, v199, v197
    v_cvt_pk_bf16_f32 v200, v200, v201
    v_cvt_pk_bf16_f32 v254, v254, v255
    v_cvt_pk_bf16_f32 v196, v196, v197
    ds_write_b32 v253, v200 offset:768
    s_mov_b64 exec, 0xffffffff
    ds_write_b32 v253, v254 offset:1280
    s_mov_b64 exec, -1
    ds_write_b32 v253, v196 offset:1024
    s_add_u32 s50, s50, 1
    s_cmp_ge_u32 s50, 5
    s_cbranch_scc1 TAIL
    s_waitcnt lgkmcnt(6)
    v_readfirstlane_b32 s66, v252
    s_add_u32 s53, s53, 1
    v_mov_b32 v252, s53
    s_cmp_le_u32 s53, s66
    ds_write2_b32 v251, v252, v252 offset0:0 offset1:8
    s_setprio 1
    s_cbranch_scc1 PRIO_13
    s_setprio 0
PRIO_13:
    s_cmp_eq_u32 s52, 4
    s_cbranch_scc1 ITEM_1_4
    s_cmp_eq_u32 s52, 5
    s_cbranch_scc1 ITEM_1_5
    s_cmp_eq_u32 s52, 3
    s_cbranch_scc1 ITEM_1_3
    s_cmp_eq_u32 s52, 6
    s_cbranch_scc1 ITEM_1_6
    s_cmp_eq_u32 s52, 8
    s_cbranch_scc1 ITEM_1_8
    s_branch ITEM_1_2
.p2align 6
ITEM_1_8:
    s_mov_b64 exec, s[54:55]
    ds_read_u16_d16_hi v243, v250 offset:128
    s_mov_b64 exec, -1
    ds_read_b64_tr_b16 v[76:77], v249 offset:512
    ds_read_b64_tr_b16 v[78:79], v249 offset:768
    ds_read_b64_tr_b16 v[84:85], v249 offset:1024
    ds_read_b64_tr_b16 v[86:87], v249 offset:1280
    ds_read_b64_tr_b16 v[92:93], v249 offset:1536
    ds_read_b64_tr_b16 v[94:95], v249 offset:1792
    s_waitcnt lgkmcnt(7)
    v_lshlrev_b32 v196, 16, v68
    v_and_b32 v197, 0xffff0000, v68
    v_lshlrev_b32 v198, 16, v69
    v_and_b32 v199, 0xffff0000, v69
    v_mul_f32_dpp v200, v242, v196 row_newbcast:0 row_mask:0xf bank_mask:0xf
    v_mul_f32_dpp v201, v242, v197 row_newbcast:1 row_mask:0xf bank_mask:0xf
    v_mul_f32_dpp v202, v242, v196 row_newbcast:8 row_mask:0xf bank_mask:0xf
    v_mul_f32_dpp v203, v242, v197 row_newbcast:9 row_mask:0xf bank_mask:0xf
    v_lshlrev_b32 v196, 16, v70
    v_and_b32 v197, 0xffff0000, v70
    v_cvt_pk_bf16_f32 v64, v200, v201
    v_cvt_pk_bf16_f32 v68, v202, v203
    v_mul_f32_dpp v200, v242, v198 row_newbcast:2 row_mask:0xf bank_mask:0xf
    v_mul_f32_dpp v201, v242, v199 row_newbcast:3 row_mask:0xf bank_mask:0xf
    v_mul_f32_dpp v202, v242, v198 row_newbcast:10 row_mask:0xf bank_mask:0xf
    v_mul_f32_dpp v203, v242, v199 row_newbcast:11 row_mask:0xf bank_mask:0xf
    v_lshlrev_b32 v198, 16, v71
    v_and_b32 v199, 0xffff0000, v71
    v_cvt_pk_bf16_f32 v65, v200, v201
    v_cvt_pk_bf16_f32 v69, v202, v203
    v_mul_f32_dpp v200, v242, v196 row_newbcast:4 row_mask:0xf bank_mask:0xf
    v_mul_f32_dpp v201, v242, v197 row_newbcast:5 row_mask:0xf bank_mask:0xf
    v_mul_f32_dpp v202, v242, v196 row_newbcast:12 row_mask:0xf bank_mask:0xf
    v_mul_f32_dpp v203, v242, v197 row_newbcast:13 row_mask:0xf bank_mask:0xf
    v_cvt_pk_bf16_f32 v66, v200, v201
    v_cvt_pk_bf16_f32 v70, v202, v203
    v_mul_f32_dpp v200, v242, v198 row_newbcast:6 row_mask:0xf bank_mask:0xf
    v_mul_f32_dpp v201, v242, v199 row_newbcast:7 row_mask:0xf bank_mask:0xf
    v_mul_f32_dpp v202, v242, v198 row_newbcast:14 row_mask:0xf bank_mask:0xf
    v_mul_f32_dpp v203, v242, v199 row_newbcast:15 row_mask:0xf bank_mask:0xf
    v_cvt_pk_bf16_f32 v67, v200, v201
    v_cvt_pk_bf16_f32 v71, v202, v203
    s_mov_b64 exec, s[54:55]
    ds_read_u16_d16_hi v242, v250 offset:256
    s_mov_b64 exec, -1
    s_waitcnt vmcnt(4) lgkmcnt(5)
    v_mfma_f32_32x32x16_bf16 v[0:15], v[64:67], v[176:179], 0
    v_lshlrev_b32 v196, 16, v76
    v_and_b32 v197, 0xffff0000, v76
    v_lshlrev_b32 v198, 16, v77
    v_and_b32 v199, 0xffff0000, v77
    v_mul_f32_dpp v200, v243, v196 row_newbcast:0 row_mask:0xf bank_mask:0xf
    v_mul_f32_dpp v201, v243, v197 row_newbcast:1 row_mask:0xf bank_mask:0xf
    v_mul_f32_dpp v202, v243, v196 row_newbcast:8 row_mask:0xf bank_mask:0xf
    v_mul_f32_dpp v203, v243, v197 row_newbcast:9 row_mask:0xf bank_mask:0xf
    v_lshlrev_b32 v196, 16, v78
    v_and_b32 v197, 0xffff0000, v78
    v_cvt_pk_bf16_f32 v72, v200, v201
    v_cvt_pk_bf16_f32 v76, v202, v203
    v_mul_f32_dpp v200, v243, v198 row_newbcast:2 row_mask:0xf bank_mask:0xf
    v_mul_f32_dpp v201, v243, v199 row_newbcast:3 row_mask:0xf bank_mask:0xf
    v_mul_f32_dpp v202, v243, v198 row_newbcast:10 row_mask:0xf bank_mask:0xf
    v_mul_f32_dpp v203, v243, v199 row_newbcast:11 row_mask:0xf bank_mask:0xf
    s_add_u32 m0, s21, 0
    v_mfma_f32_32x32x16_bf16 v[16:31], v[68:71], v[176:179], 0
    buffer_load_dwordx4 v234, s[4:7], s35 offen lds
    buffer_load_dwordx4 v235, s[8:11], s35 offen offset:1024 lds
    ds_read_b64_tr_b16 v[176:177], v244 offset:2048
    ds_read_b64_tr_b16 v[178:179], v244 offset:3072
    ds_read_b64_tr_b16 v[184:185], v245 offset:2048
    ds_read_b64_tr_b16 v[186:187], v245 offset:3072
    v_lshlrev_b32 v198, 16, v79
    v_and_b32 v199, 0xffff0000, v79
    v_cvt_pk_bf16_f32 v73, v200, v201
    v_cvt_pk_bf16_f32 v77, v202, v203
    v_mul_f32_dpp v200, v243, v196 row_newbcast:4 row_mask:0xf bank_mask:0xf
    v_mul_f32_dpp v201, v243, v197 row_newbcast:5 row_mask:0xf bank_mask:0xf
    v_mul_f32_dpp v202, v243, v196 row_newbcast:12 row_mask:0xf bank_mask:0xf
    v_mul_f32_dpp v203, v243, v197 row_newbcast:13 row_mask:0xf bank_mask:0xf
    v_cvt_pk_bf16_f32 v74, v200, v201
    v_cvt_pk_bf16_f32 v78, v202, v203
    v_mul_f32_dpp v200, v243, v198 row_newbcast:6 row_mask:0xf bank_mask:0xf
    v_mul_f32_dpp v201, v243, v199 row_newbcast:7 row_mask:0xf bank_mask:0xf
    v_mul_f32_dpp v202, v243, v198 row_newbcast:14 row_mask:0xf bank_mask:0xf
    v_mul_f32_dpp v203, v243, v199 row_newbcast:15 row_mask:0xf bank_mask:0xf
    v_cvt_pk_bf16_f32 v75, v200, v201
    v_cvt_pk_bf16_f32 v79, v202, v203
    s_mov_b64 exec, s[54:55]
    ds_read_u16_d16_hi v243, v250 offset:384
    s_mov_b64 exec, -1
    s_waitcnt vmcnt(4) lgkmcnt(1)
    v_mfma_f32_32x32x16_bf16 v[0:15], v[72:75], v[176:179], v[0:15]
    v_lshlrev_b32 v196, 16, v84
    v_and_b32 v197, 0xffff0000, v84
    v_lshlrev_b32 v198, 16, v85
    v_and_b32 v199, 0xffff0000, v85
    v_mul_f32_dpp v200, v242, v196 row_newbcast:0 row_mask:0xf bank_mask:0xf
    v_mul_f32_dpp v201, v242, v197 row_newbcast:1 row_mask:0xf bank_mask:0xf
    v_mul_f32_dpp v202, v242, v196 row_newbcast:8 row_mask:0xf bank_mask:0xf
    v_mul_f32_dpp v203, v242, v197 row_newbcast:9 row_mask:0xf bank_mask:0xf
    v_lshlrev_b32 v196, 16, v86
    v_and_b32 v197, 0xffff0000, v86
    v_cvt_pk_bf16_f32 v80, v200, v201
    v_cvt_pk_bf16_f32 v84, v202, v203
    v_mul_f32_dpp v200, v242, v198 row_newbcast:2 row_mask:0xf bank_mask:0xf
    v_mul_f32_dpp v201, v242, v199 row_newbcast:3 row_mask:0xf bank_mask:0xf
    v_mul_f32_dpp v202, v242, v198 row_newbcast:10 row_mask:0xf bank_mask:0xf
    v_mul_f32_dpp v203, v242, v199 row_newbcast:11 row_mask:0xf bank_mask:0xf
    s_add_u32 m0, s21, 2048
    v_mfma_f32_32x32x16_bf16 v[16:31], v[76:79], v[176:179], v[16:31]
    buffer_load_dwordx4 v236, s[4:7], s35 offen lds
    buffer_load_dwordx4 v237, s[8:11], s35 offen offset:1024 lds
    ds_read_b64_tr_b16 v[176:177], v244 offset:4096
    ds_read_b64_tr_b16 v[178:179], v244 offset:5120
    ds_read_b64_tr_b16 v[188:189], v245 offset:4096
    ds_read_b64_tr_b16 v[190:191], v245 offset:5120
    v_lshlrev_b32 v198, 16, v87
    v_and_b32 v199, 0xffff0000, v87
    v_cvt_pk_bf16_f32 v81, v200, v201
    v_cvt_pk_bf16_f32 v85, v202, v203
    v_mul_f32_dpp v200, v242, v196 row_newbcast:4 row_mask:0xf bank_mask:0xf
    v_mul_f32_dpp v201, v242, v197 row_newbcast:5 row_mask:0xf bank_mask:0xf
    v_mul_f32_dpp v202, v242, v196 row_newbcast:12 row_mask:0xf bank_mask:0xf
    v_mul_f32_dpp v203, v242, v197 row_newbcast:13 row_mask:0xf bank_mask:0xf
    v_cvt_pk_bf16_f32 v82, v200, v201
    v_cvt_pk_bf16_f32 v86, v202, v203
    v_mul_f32_dpp v200, v242, v198 row_newbcast:6 row_mask:0xf bank_mask:0xf
    v_mul_f32_dpp v201, v242, v199 row_newbcast:7 row_mask:0xf bank_mask:0xf
    v_mul_f32_dpp v202, v242, v198 row_newbcast:14 row_mask:0xf bank_mask:0xf
    v_mul_f32_dpp v203, v242, v199 row_newbcast:15 row_mask:0xf bank_mask:0xf
    v_cvt_pk_bf16_f32 v83, v200, v201
    v_cvt_pk_bf16_f32 v87, v202, v203
    s_nop 0
    s_waitcnt vmcnt(4) lgkmcnt(0)
    v_mfma_f32_32x32x16_bf16 v[0:15], v[80:83], v[176:179], v[0:15]
    v_lshlrev_b32 v196, 16, v92
    v_and_b32 v197, 0xffff0000, v92
    v_lshlrev_b32 v198, 16, v93
    v_and_b32 v199, 0xffff0000, v93
    v_mul_f32_dpp v200, v243, v196 row_newbcast:0 row_mask:0xf bank_mask:0xf
    v_mul_f32_dpp v201, v243, v197 row_newbcast:1 row_mask:0xf bank_mask:0xf
    v_mul_f32_dpp v202, v243, v196 row_newbcast:8 row_mask:0xf bank_mask:0xf
    v_mul_f32_dpp v203, v243, v197 row_newbcast:9 row_mask:0xf bank_mask:0xf
    v_lshlrev_b32 v196, 16, v94
    v_and_b32 v197, 0xffff0000, v94
    v_cvt_pk_bf16_f32 v88, v200, v201
    v_cvt_pk_bf16_f32 v92, v202, v203
    v_mul_f32_dpp v200, v243, v198 row_newbcast:2 row_mask:0xf bank_mask:0xf
    v_mul_f32_dpp v201, v243, v199 row_newbcast:3 row_mask:0xf bank_mask:0xf
    v_mul_f32_dpp v202, v243, v198 row_newbcast:10 row_mask:0xf bank_mask:0xf
    v_mul_f32_dpp v203, v243, v199 row_newbcast:11 row_mask:0xf bank_mask:0xf
    s_add_u32 m0, s21, 4096
    v_mfma_f32_32x32x16_bf16 v[16:31], v[84:87], v[176:179], v[16:31]
    buffer_load_dwordx4 v238, s[4:7], s35 offen lds
    buffer_load_dwordx4 v239, s[8:11], s35 offen offset:1024 lds
    ds_read_b64_tr_b16 v[176:177], v244 offset:6144
    ds_read_b64_tr_b16 v[178:179], v244 offset:7168
    ds_read_b64_tr_b16 v[192:193], v245 offset:6144
    ds_read_b64_tr_b16 v[194:195], v245 offset:7168
    v_lshlrev_b32 v198, 16, v95
    v_and_b32 v199, 0xffff0000, v95
    v_cvt_pk_bf16_f32 v89, v200, v201
    v_cvt_pk_bf16_f32 v93, v202, v203
    v_mul_f32_dpp v200, v243, v196 row_newbcast:4 row_mask:0xf bank_mask:0xf
    v_mul_f32_dpp v201, v243, v197 row_newbcast:5 row_mask:0xf bank_mask:0xf
    v_mul_f32_dpp v202, v243, v196 row_newbcast:12 row_mask:0xf bank_mask:0xf
    v_mul_f32_dpp v203, v243, v197 row_newbcast:13 row_mask:0xf bank_mask:0xf
    v_cvt_pk_bf16_f32 v90, v200, v201
    v_cvt_pk_bf16_f32 v94, v202, v203
    v_mul_f32_dpp v200, v243, v198 row_newbcast:6 row_mask:0xf bank_mask:0xf
    v_mul_f32_dpp v201, v243, v199 row_newbcast:7 row_mask:0xf bank_mask:0xf
    v_mul_f32_dpp v202, v243, v198 row_newbcast:14 row_mask:0xf bank_mask:0xf
    v_mul_f32_dpp v203, v243, v199 row_newbcast:15 row_mask:0xf bank_mask:0xf
    v_cvt_pk_bf16_f32 v91, v200, v201
    v_cvt_pk_bf16_f32 v95, v202, v203
    s_nop 0
    s_waitcnt lgkmcnt(0)
    v_mfma_f32_32x32x16_bf16 v[0:15], v[88:91], v[176:179], v[0:15]
    s_add_u32 m0, s21, 6144
    v_mfma_f32_32x32x16_bf16 v[16:31], v[92:95], v[176:179], v[16:31]
    buffer_load_dwordx4 v240, s[4:7], s35 offen lds
    buffer_load_dwordx4 v241, s[8:11], s35 offen offset:1024 lds
    s_mov_b32 m0, s50
    s_nop 0
    s_movrels_b32 s71, s23
    s_movrels_b32 s33, s28
    s_and_b32 s70, s33, 0x70
    s_andn2_b32 s33, s33, 0x70
    v_xor_b32 v253, s70, v248
    v_add_u32 v253, s33, v253
    s_bfe_u32 s46, s71, 0x30012
    s_mov_b32 m0, s46
    s_and_b32 s66, s71, 0x3ffff
    s_movrels_b32 s68, s57
    s_movrels_b32 s69, s61
    s_sub_u32 s48, s66, s47
    s_mov_b32 s47, s66
    s_lshr_b32 s52, s71, 28
    s_lshl_b32 s67, s46, 9
    s_add_u32 s66, s66, s67
    s_sub_u32 s49, s66, s42
    s_mov_b32 s42, s66
    s_bfe_u32 s66, s68, 655360
    s_add_u32 s43, s42, s66
    s_bfe_u32 s39, s69, 655360
    s_bfe_u32 s66, s68, 655370
    s_add_u32 s44, s42, s66
    s_bfe_u32 s40, s69, 655370
    s_bfe_u32 s66, s68, 655380
    s_add_u32 s45, s42, s66
    s_bfe_u32 s41, s69, 655380
    v_mfma_f32_32x32x16_bf16 v[32:47], v[64:67], v[180:183], 0
    v_mul_f32 v196, v0, v96
    v_fmac_f32 v196, v1, v97
    v_fmac_f32 v196, v2, v98
    v_fmac_f32 v196, v3, v99
    v_fmac_f32 v196, v4, v100
    v_mfma_f32_32x32x16_bf16 v[48:63], v[68:71], v[180:183], 0
    v_fmac_f32 v196, v5, v101
    v_fmac_f32 v196, v6, v102
    v_fmac_f32 v196, v7, v103
    v_mul_f32 v198, v8, v128
    v_fmac_f32 v198, v9, v129
    v_mfma_f32_32x32x16_bf16 v[32:47], v[72:75], v[184:187], v[32:47]
    v_fmac_f32 v198, v10, v130
    v_fmac_f32 v198, v11, v131
    v_fmac_f32 v198, v12, v132
    v_fmac_f32 v198, v13, v133
    v_mfma_f32_32x32x16_bf16 v[48:63], v[76:79], v[184:187], v[48:63]
    v_fmac_f32 v198, v14, v134
    v_fmac_f32 v198, v15, v135
    v_mul_f32 v200, v16, v128
    v_fmac_f32 v200, v17, v129
    v_permlane32_swap_b32 v196, v198
    v_mfma_f32_32x32x16_bf16 v[32:47], v[80:83], v[188:191], v[32:47]
    v_fmac_f32 v200, v18, v130
    v_fmac_f32 v200, v19, v131
    v_fmac_f32 v200, v20, v132
    v_fmac_f32 v200, v21, v133
    v_fmac_f32 v200, v22, v134
    v_mfma_f32_32x32x16_bf16 v[48:63], v[84:87], v[188:191], v[48:63]
    s_waitcnt vmcnt(6)
    ds_read_b64_tr_b16 v[176:177], v244 offset:0
    ds_read_b64_tr_b16 v[178:179], v244 offset:1024
    ds_read_b64_tr_b16 v[180:181], v245 offset:0
    ds_read_b64_tr_b16 v[182:183], v245 offset:1024
    v_fmac_f32 v200, v23, v135
    v_add_f32 v198, v196, v198
    v_mul_f32_e64 v202, v24, -v128
    v_fma_f32 v202, v25, -v129, v202
    v_mfma_f32_32x32x16_bf16 v[32:47], v[88:91], v[192:195], v[32:47]
    v_fma_f32 v202, v26, -v130, v202
    v_fma_f32 v202, v27, -v131, v202
    v_fma_f32 v202, v28, -v132, v202
    v_fma_f32 v202, v29, -v133, v202
    v_fma_f32 v202, v30, -v134, v202
    v_mfma_f32_32x32x16_bf16 v[48:63], v[92:95], v[192:195], v[48:63]
    v_fma_f32 v202, v31, -v135, v202
    s_nop 1
    v_permlane32_swap_b32 v200, v202
    v_add_f32 v202, v200, v202
    s_waitcnt vmcnt(4) lgkmcnt(0)
    v_mfma_f32_32x32x16_bf16 v[0:15], v[64:67], v[176:179], 0
    v_mul_f32 v197, v32, v104
    v_fmac_f32 v197, v33, v105
    v_fmac_f32 v197, v34, v106
    v_fmac_f32 v197, v35, v107
    v_fmac_f32 v197, v36, v108
    v_fmac_f32 v197, v37, v109
    s_add_u32 m0, s21, 0
    v_mfma_f32_32x32x16_bf16 v[16:31], v[68:71], v[176:179], 0
    buffer_load_dwordx4 v234, s[4:7], s36 offen lds
    buffer_load_dwordx4 v235, s[8:11], s36 offen offset:1024 lds
    ds_read_b64_tr_b16 v[176:177], v244 offset:2048
    ds_read_b64_tr_b16 v[178:179], v244 offset:3072
    ds_read_b64_tr_b16 v[184:185], v245 offset:2048
    ds_read_b64_tr_b16 v[186:187], v245 offset:3072
    v_fmac_f32 v197, v38, v110
    v_fmac_f32 v197, v39, v111
    v_mul_f32 v199, v40, v136
    v_fmac_f32 v199, v41, v137
    v_fmac_f32 v199, v42, v138
    s_waitcnt vmcnt(4) lgkmcnt(0)
    v_mfma_f32_32x32x16_bf16 v[0:15], v[72:75], v[176:179], v[0:15]
    v_fmac_f32 v199, v43, v139
    v_fmac_f32 v199, v44, v140
    v_fmac_f32 v199, v45, v141
    v_fmac_f32 v199, v46, v142
    v_fmac_f32 v199, v47, v143
    s_add_u32 m0, s21, 2048
    v_mfma_f32_32x32x16_bf16 v[16:31], v[76:79], v[176:179], v[16:31]
    buffer_load_dwordx4 v236, s[4:7], s36 offen lds
    buffer_load_dwordx4 v237, s[8:11], s36 offen offset:1024 lds
    ds_read_b64_tr_b16 v[176:177], v244 offset:4096
    ds_read_b64_tr_b16 v[178:179], v244 offset:5120
    ds_read_b64_tr_b16 v[188:189], v245 offset:4096
    ds_read_b64_tr_b16 v[190:191], v245 offset:5120
    v_mul_f32 v201, v48, v136
    v_fmac_f32 v201, v49, v137
    v_permlane32_swap_b32 v197, v199
    v_fmac_f32 v201, v50, v138
    v_fmac_f32 v201, v51, v139
    s_waitcnt vmcnt(4) lgkmcnt(0)
    v_mfma_f32_32x32x16_bf16 v[0:15], v[80:83], v[176:179], v[0:15]
    v_fmac_f32 v201, v52, v140
    v_fmac_f32 v201, v53, v141
    v_fmac_f32 v201, v54, v142
    v_fmac_f32 v201, v55, v143
    v_add_f32 v199, v197, v199
    s_add_u32 m0, s21, 4096
    v_mfma_f32_32x32x16_bf16 v[16:31], v[84:87], v[176:179], v[16:31]
    buffer_load_dwordx4 v238, s[4:7], s36 offen lds
    buffer_load_dwordx4 v239, s[8:11], s36 offen offset:1024 lds
    ds_read_b64_tr_b16 v[176:177], v244 offset:6144
    ds_read_b64_tr_b16 v[178:179], v244 offset:7168
    ds_read_b64_tr_b16 v[192:193], v245 offset:6144
    ds_read_b64_tr_b16 v[194:195], v245 offset:7168
    v_mul_f32_e64 v203, v56, -v136
    v_fma_f32 v203, v57, -v137, v203
    v_fma_f32 v203, v58, -v138, v203
    v_fma_f32 v203, v59, -v139, v203
    v_fma_f32 v203, v60, -v140, v203
    s_waitcnt lgkmcnt(0)
    v_mfma_f32_32x32x16_bf16 v[0:15], v[88:91], v[176:179], v[0:15]
    v_fma_f32 v203, v61, -v141, v203
    v_fma_f32 v203, v62, -v142, v203
    v_fma_f32 v203, v63, -v143, v203
    s_nop 1
    v_permlane32_swap_b32 v201, v203
    s_add_u32 m0, s21, 6144
    v_mfma_f32_32x32x16_bf16 v[16:31], v[92:95], v[176:179], v[16:31]
    buffer_load_dwordx4 v240, s[4:7], s36 offen lds
    buffer_load_dwordx4 v241, s[8:11], s36 offen offset:1024 lds
    v_add_f32 v203, v201, v203
    v_cvt_pk_bf16_f32 v198, v198, v199
    v_cvt_pk_bf16_f32 v202, v202, v203
    ds_write_b32 v253, v198 offset:0
    ds_write_b32 v253, v202 offset:256
    v_mfma_f32_32x32x16_bf16 v[32:47], v[64:67], v[180:183], 0
    v_mul_f32 v196, v0, v144
    v_fmac_f32 v196, v1, v145
    v_fmac_f32 v196, v2, v146
    v_fmac_f32 v196, v3, v147
    v_mfma_f32_32x32x16_bf16 v[48:63], v[68:71], v[180:183], 0
    v_fmac_f32 v196, v4, v148
    v_fmac_f32 v196, v5, v149
    v_fmac_f32 v196, v6, v150
    v_fmac_f32 v196, v7, v151
    v_mfma_f32_32x32x16_bf16 v[32:47], v[72:75], v[184:187], v[32:47]
    v_mul_f32 v198, v8, v112
    v_fmac_f32 v198, v9, v113
    v_fmac_f32 v198, v10, v114
    v_fmac_f32 v198, v11, v115
    v_mfma_f32_32x32x16_bf16 v[48:63], v[76:79], v[184:187], v[48:63]
    v_fmac_f32 v198, v12, v116
    v_fmac_f32 v198, v13, v117
    v_fmac_f32 v198, v14, v118
    v_fmac_f32 v198, v15, v119
    v_mfma_f32_32x32x16_bf16 v[32:47], v[80:83], v[188:191], v[32:47]
    v_mul_f32_e64 v200, v16, -v160
    v_fma_f32 v200, v17, -v161, v200
    v_fma_f32 v200, v18, -v162, v200
    v_fma_f32 v200, v19, -v163, v200
    v_mfma_f32_32x32x16_bf16 v[48:63], v[84:87], v[188:191], v[48:63]
    s_waitcnt vmcnt(6)
    ds_read_b64_tr_b16 v[176:177], v244 offset:0
    ds_read_b64_tr_b16 v[178:179], v244 offset:1024
    ds_read_b64_tr_b16 v[180:181], v245 offset:0
    ds_read_b64_tr_b16 v[182:183], v245 offset:1024
    v_fma_f32 v200, v20, -v164, v200
    v_fma_f32 v200, v21, -v165, v200
    v_fma_f32 v200, v22, -v166, v200
    v_fma_f32 v200, v23, -v167, v200
    v_mfma_f32_32x32x16_bf16 v[32:47], v[88:91], v[192:195], v[32:47]
    v_mul_f32_e64 v202, v24, -v160
    v_fma_f32 v202, v25, -v161, v202
    v_fma_f32 v202, v26, -v162, v202
    v_fma_f32 v202, v27, -v163, v202
    v_mfma_f32_32x32x16_bf16 v[48:63], v[92:95], v[192:195], v[48:63]
    v_fma_f32 v202, v28, -v164, v202
    v_fma_f32 v202, v29, -v165, v202
    v_fma_f32 v202, v30, -v166, v202
    v_fma_f32 v202, v31, -v167, v202
    s_waitcnt vmcnt(4) lgkmcnt(0)
    v_mfma_f32_32x32x16_bf16 v[0:15], v[64:67], v[176:179], 0
    s_nop 0
    v_mul_f32 v197, v32, v152
    v_fmac_f32 v197, v33, v153
    v_fmac_f32 v197, v34, v154
    v_fmac_f32 v197, v35, v155
    s_add_u32 m0, s21, 0
    v_mfma_f32_32x32x16_bf16 v[16:31], v[68:71], v[176:179], 0
    buffer_load_dwordx4 v234, s[4:7], s37 offen lds
    buffer_load_dwordx4 v235, s[8:11], s37 offen offset:1024 lds
    ds_read_b64_tr_b16 v[176:177], v244 offset:2048
    ds_read_b64_tr_b16 v[178:179], v244 offset:3072
    ds_read_b64_tr_b16 v[184:185], v245 offset:2048
    ds_read_b64_tr_b16 v[186:187], v245 offset:3072
    v_add_u32 v252, s42, v247
    ds_read_u16 v234, v252
    ds_read_u16 v235, v252 offset:64
    v_fmac_f32 v197, v36, v156
    v_fmac_f32 v197, v37, v157
    v_fmac_f32 v197, v38, v158
    v_fmac_f32 v197, v39, v159
    s_waitcnt vmcnt(4) lgkmcnt(2)
    v_mfma_f32_32x32x16_bf16 v[0:15], v[72:75], v[176:179], v[0:15]
    v_mul_f32 v199, v40, v120
    v_fmac_f32 v199, v41, v121
    v_fmac_f32 v199, v42, v122
    v_fmac_f32 v199, v43, v123
    s_add_u32 m0, s21, 2048
    v_mfma_f32_32x32x16_bf16 v[16:31], v[76:79], v[176:179], v[16:31]
    buffer_load_dwordx4 v236, s[4:7], s37 offen lds
    buffer_load_dwordx4 v237, s[8:11], s37 offen offset:1024 lds
    ds_read_b64_tr_b16 v[176:177], v244 offset:4096
    ds_read_b64_tr_b16 v[178:179], v244 offset:5120
    ds_read_b64_tr_b16 v[188:189], v245 offset:4096
    ds_read_b64_tr_b16 v[190:191], v245 offset:5120
    v_add_u32 v252, s43, v247
    ds_read_u16 v236, v252
    ds_read_u16 v237, v252 offset:64
    v_fmac_f32 v199, v44, v124
    v_fmac_f32 v199, v45, v125
    v_fmac_f32 v199, v46, v126
    v_fmac_f32 v199, v47, v127
    s_waitcnt vmcnt(4) lgkmcnt(2)
    v_mfma_f32_32x32x16_bf16 v[0:15], v[80:83], v[176:179], v[0:15]
    v_mul_f32_e64 v201, v48, -v168
    v_fma_f32 v201, v49, -v169, v201
    v_fma_f32 v201, v50, -v170, v201
    v_fma_f32 v201, v51, -v171, v201
    s_add_u32 m0, s21, 4096
    v_mfma_f32_32x32x16_bf16 v[16:31], v[84:87], v[176:179], v[16:31]
    buffer_load_dwordx4 v238, s[4:7], s37 offen lds
    buffer_load_dwordx4 v239, s[8:11], s37 offen offset:1024 lds
    ds_read_b64_tr_b16 v[176:177], v244 offset:6144
    ds_read_b64_tr_b16 v[178:179], v244 offset:7168
    ds_read_b64_tr_b16 v[192:193], v245 offset:6144
    ds_read_b64_tr_b16 v[194:195], v245 offset:7168
    v_add_u32 v252, s44, v247
    ds_read_u16 v238, v252
    ds_read_u16 v239, v252 offset:64
    v_fma_f32 v201, v52, -v172, v201
    v_fma_f32 v201, v53, -v173, v201
    v_fma_f32 v201, v54, -v174, v201
    v_fma_f32 v201, v55, -v175, v201
    s_waitcnt lgkmcnt(2)
    v_mfma_f32_32x32x16_bf16 v[0:15], v[88:91], v[176:179], v[0:15]
    v_mul_f32_e64 v203, v56, -v168
    v_fma_f32 v203, v57, -v169, v203
    v_fma_f32 v203, v58, -v170, v203
    v_fma_f32 v203, v59, -v171, v203
    s_add_u32 m0, s21, 6144
    v_mfma_f32_32x32x16_bf16 v[16:31], v[92:95], v[176:179], v[16:31]
    buffer_load_dwordx4 v240, s[4:7], s37 offen lds
    buffer_load_dwordx4 v241, s[8:11], s37 offen offset:1024 lds
    v_add_u32 v252, s45, v247
    ds_read_u16 v240, v252
    ds_read_u16 v241, v252 offset:64
    v_fma_f32 v203, v60, -v172, v203
    v_fma_f32 v203, v61, -v173, v203
    v_fma_f32 v203, v62, -v174, v203
    v_fma_f32 v203, v63, -v175, v203
    v_mfma_f32_32x32x16_bf16 v[32:47], v[64:67], v[180:183], 0
    v_mul_f32 v254, v0, v144
    v_fmac_f32 v254, v1, v145
    v_fmac_f32 v254, v2, v146
    v_mfma_f32_32x32x16_bf16 v[48:63], v[68:71], v[180:183], 0
    ds_swizzle_b32 v68, v68 offset:0x401F
    ds_swizzle_b32 v69, v69 offset:0x401F
    ds_swizzle_b32 v70, v70 offset:0x401F
    ds_swizzle_b32 v71, v71 offset:0x401F
    v_fmac_f32 v254, v3, v147
    v_fmac_f32 v254, v4, v148
    v_mfma_f32_32x32x16_bf16 v[32:47], v[72:75], v[184:187], v[32:47]
    v_fmac_f32 v254, v5, v149
    v_fmac_f32 v254, v6, v150
    v_mfma_f32_32x32x16_bf16 v[48:63], v[76:79], v[184:187], v[48:63]
    ds_swizzle_b32 v76, v76 offset:0x401F
    ds_swizzle_b32 v77, v77 offset:0x401F
    ds_swizzle_b32 v78, v78 offset:0x401F
    ds_swizzle_b32 v79, v79 offset:0x401F
    v_fmac_f32 v254, v7, v151
    v_fmac_f32 v200, v8, v160
    v_mfma_f32_32x32x16_bf16 v[32:47], v[80:83], v[188:191], v[32:47]
    v_fmac_f32 v200, v9, v161
    v_permlane32_swap_b32 v196, v254
    v_fmac_f32 v200, v10, v162
    v_mfma_f32_32x32x16_bf16 v[48:63], v[84:87], v[188:191], v[48:63]
    ds_swizzle_b32 v84, v84 offset:0x401F
    ds_swizzle_b32 v85, v85 offset:0x401F
    ds_swizzle_b32 v86, v86 offset:0x401F
    ds_swizzle_b32 v87, v87 offset:0x401F
    s_waitcnt vmcnt(6)
    ds_read_b64_tr_b16 v[176:177], v244 offset:0
    ds_read_b64_tr_b16 v[178:179], v244 offset:1024
    ds_read_b64_tr_b16 v[180:181], v245 offset:0
    ds_read_b64_tr_b16 v[182:183], v245 offset:1024
    v_fmac_f32 v200, v11, v163
    v_fmac_f32 v200, v12, v164
    v_mfma_f32_32x32x16_bf16 v[32:47], v[88:91], v[192:195], v[32:47]
    v_fmac_f32 v200, v13, v165
    v_fmac_f32 v200, v14, v166
    v_mfma_f32_32x32x16_bf16 v[48:63], v[92:95], v[192:195], v[48:63]
    ds_swizzle_b32 v92, v92 offset:0x401F
    ds_swizzle_b32 v93, v93 offset:0x401F
    ds_swizzle_b32 v94, v94 offset:0x401F
    ds_swizzle_b32 v95, v95 offset:0x401F
    v_fmac_f32 v200, v15, v167
    v_add_f32 v254, v196, v254
    s_waitcnt lgkmcnt(8)
    s_mov_b64 exec, s[56:57]
    v_xor_b32 v68, 0x80008000, v68
    v_xor_b32 v69, 0x80008000, v69
    v_xor_b32 v70, 0x80008000, v70
    v_xor_b32 v71, 0x80008000, v71
    v_xor_b32 v76, 0x80008000, v76
    v_xor_b32 v77, 0x80008000, v77
    v_xor_b32 v78, 0x80008000, v78
    v_xor_b32 v79, 0x80008000, v79
    v_xor_b32 v84, 0x80008000, v84
    v_xor_b32 v85, 0x80008000, v85
    v_xor_b32 v86, 0x80008000, v86
    v_xor_b32 v87, 0x80008000, v87
    s_mov_b64 exec, -1
    s_waitcnt vmcnt(4) lgkmcnt(4)
    v_mfma_f32_32x32x16_bf16 v[0:15], v[64:67], v[176:179], 0
    v_mul_f32 v255, v32, v152
    v_fmac_f32 v255, v33, v153
    v_fmac_f32 v255, v34, v154
    s_add_u32 m0, s21, 0
    v_mfma_f32_32x32x16_bf16 v[16:31], v[68:71], v[176:179], v[16:31]
    v_lshl_add_u32 v234, v234, 10, v246
    v_lshl_add_u32 v235, v235, 10, v246
    buffer_load_dwordx4 v234, s[4:7], s38 offen lds
    buffer_load_dwordx4 v235, s[8:11], s38 offen offset:1024 lds
    ds_read_b64_tr_b16 v[176:177], v244 offset:2048
    ds_read_b64_tr_b16 v[178:179], v244 offset:3072
    ds_read_b64_tr_b16 v[184:185], v245 offset:2048
    ds_read_b64_tr_b16 v[186:187], v245 offset:3072
    v_fmac_f32 v255, v35, v155
    v_fmac_f32 v255, v36, v156
    s_waitcnt vmcnt(4) lgkmcnt(0)
    v_mfma_f32_32x32x16_bf16 v[0:15], v[72:75], v[176:179], v[0:15]
    v_fmac_f32 v255, v37, v157
    v_fmac_f32 v255, v38, v158
    v_fmac_f32 v255, v39, v159
    s_add_u32 m0, s21, 2048
    v_mfma_f32_32x32x16_bf16 v[16:31], v[76:79], v[176:179], v[16:31]
    v_lshl_add_u32 v236, v236, 10, v246
    v_lshl_add_u32 v237, v237, 10, v246
    buffer_load_dwordx4 v236, s[4:7], s39 offen lds
    buffer_load_dwordx4 v237, s[8:11], s39 offen offset:1024 lds
    ds_read_b64_tr_b16 v[176:177], v244 offset:4096
    ds_read_b64_tr_b16 v[178:179], v244 offset:5120
    ds_read_b64_tr_b16 v[188:189], v245 offset:4096
    ds_read_b64_tr_b16 v[190:191], v245 offset:5120
    v_fmac_f32 v201, v40, v168
    v_fmac_f32 v201, v41, v169
    s_waitcnt vmcnt(4) lgkmcnt(0)
    v_mfma_f32_32x32x16_bf16 v[0:15], v[80:83], v[176:179], v[0:15]
    v_permlane32_swap_b32 v197, v255
    v_fmac_f32 v201, v42, v170
    v_fmac_f32 v201, v43, v171
    s_add_u32 m0, s21, 4096
    v_mfma_f32_32x32x16_bf16 v[16:31], v[84:87], v[176:179], v[16:31]
    v_lshl_add_u32 v238, v238, 10, v246
    v_lshl_add_u32 v239, v239, 10, v246
    buffer_load_dwordx4 v238, s[4:7], s40 offen lds
    buffer_load_dwordx4 v239, s[8:11], s40 offen offset:1024 lds
    ds_read_b64_tr_b16 v[176:177], v244 offset:6144
    ds_read_b64_tr_b16 v[178:179], v244 offset:7168
    ds_read_b64_tr_b16 v[192:193], v245 offset:6144
    ds_read_b64_tr_b16 v[194:195], v245 offset:7168
    v_fmac_f32 v201, v44, v172
    v_fmac_f32 v201, v45, v173
    s_waitcnt lgkmcnt(0)
    s_mov_b64 exec, s[56:57]
    v_xor_b32 v92, 0x80008000, v92
    v_xor_b32 v93, 0x80008000, v93
    v_xor_b32 v94, 0x80008000, v94
    v_xor_b32 v95, 0x80008000, v95
    s_mov_b64 exec, -1
    v_mfma_f32_32x32x16_bf16 v[0:15], v[88:91], v[176:179], v[0:15]
    v_fmac_f32 v201, v46, v174
    v_fmac_f32 v201, v47, v175
    v_add_f32 v255, v197, v255
    s_add_u32 m0, s21, 6144
    v_mfma_f32_32x32x16_bf16 v[16:31], v[92:95], v[176:179], v[16:31]
    v_lshl_add_u32 v240, v240, 10, v246
    v_lshl_add_u32 v241, v241, 10, v246
    buffer_load_dwordx4 v240, s[4:7], s41 offen lds
    buffer_load_dwordx4 v241, s[8:11], s41 offen offset:1024 lds
    v_cvt_pk_bf16_f32 v254, v254, v255
    ds_write_b32 v253, v254 offset:512
    v_mfma_f32_32x32x16_bf16 v[32:47], v[64:67], v[180:183], 0
    v_mul_f32 v254, v0, v144
    v_fmac_f32 v254, v1, v145
    v_fmac_f32 v254, v2, v146
    v_fmac_f32 v254, v3, v147
    v_fmac_f32 v254, v4, v148
    v_mfma_f32_32x32x16_bf16 v[48:63], v[68:71], v[180:183], v[48:63]
    v_fmac_f32 v254, v5, v149
    v_fmac_f32 v254, v6, v150
    v_fmac_f32 v254, v7, v151
    v_fma_f32 v202, v8, -v160, v202
    v_fma_f32 v202, v9, -v161, v202
    v_mfma_f32_32x32x16_bf16 v[32:47], v[72:75], v[184:187], v[32:47]
    v_permlane32_swap_b32 v254, v200
    v_fma_f32 v202, v10, -v162, v202
    v_fma_f32 v202, v11, -v163, v202
    v_fma_f32 v202, v12, -v164, v202
    v_fma_f32 v202, v13, -v165, v202
    v_mfma_f32_32x32x16_bf16 v[48:63], v[76:79], v[184:187], v[48:63]
    v_fma_f32 v202, v14, -v166, v202
    v_fma_f32 v202, v15, -v167, v202
    v_add_f32 v200, v254, v200
    v_fmac_f32 v198, v16, v112
    v_permlane32_swap_b32 v202, v254
    v_mfma_f32_32x32x16_bf16 v[32:47], v[80:83], v[188:191], v[32:47]
    v_fmac_f32 v198, v17, v113
    v_fmac_f32 v198, v18, v114
    v_fmac_f32 v198, v19, v115
    v_fmac_f32 v198, v20, v116
    v_fmac_f32 v198, v21, v117
    v_mfma_f32_32x32x16_bf16 v[48:63], v[84:87], v[188:191], v[48:63]
    s_waitcnt vmcnt(6)
    ds_read_b64_tr_b16 v[176:177], v244 offset:0
    ds_read_b64_tr_b16 v[178:179], v244 offset:1024
    ds_read_b64_tr_b16 v[180:181], v245 offset:0
    ds_read_b64_tr_b16 v[182:183], v245 offset:1024
    v_fmac_f32 v198, v22, v118
    v_fmac_f32 v198, v23, v119
    v_add_f32 v254, v202, v254
    v_mul_f32 v196, v24, v160
    v_fmac_f32 v196, v25, v161
    v_mfma_f32_32x32x16_bf16 v[32:47], v[88:91], v[192:195], v[32:47]
    v_fmac_f32 v196, v26, v162
    v_fmac_f32 v196, v27, v163
    v_fmac_f32 v196, v28, v164
    v_fmac_f32 v196, v29, v165
    v_fmac_f32 v196, v30, v166
    v_mfma_f32_32x32x16_bf16 v[48:63], v[92:95], v[192:195], v[48:63]
    v_add_u32 v249, s48, v249
    v_add_u32 v250, s49, v250
    ds_read_b32 v252, v251 offset:16
    ds_read_b64_tr_b16 v[68:69], v249 offset:0
    ds_read_b64_tr_b16 v[70:71], v249 offset:256
    s_mov_b64 exec, s[54:55]
    ds_read_u16_d16_hi v242, v250 offset:0
    s_mov_b64 exec, -1
    v_fmac_f32 v196, v31, v167
    s_nop 1
    v_permlane32_swap_b32 v198, v196
    v_add_f32 v196, v198, v196
    v_mul_f32 v255, v32, v152
    v_fmac_f32 v255, v33, v153
    v_fmac_f32 v255, v34, v154
    v_fmac_f32 v255, v35, v155
    v_fmac_f32 v255, v36, v156
    v_fmac_f32 v255, v37, v157
    v_fmac_f32 v255, v38, v158
    v_fmac_f32 v255, v39, v159
    v_fma_f32 v203, v40, -v168, v203
    v_fma_f32 v203, v41, -v169, v203
    v_permlane32_swap_b32 v255, v201
    v_fma_f32 v203, v42, -v170, v203
    v_fma_f32 v203, v43, -v171, v203
    v_fma_f32 v203, v44, -v172, v203
    v_fma_f32 v203, v45, -v173, v203
    v_fma_f32 v203, v46, -v174, v203
    v_fma_f32 v203, v47, -v175, v203
    v_add_f32 v201, v255, v201
    v_fmac_f32 v199, v48, v120
    v_permlane32_swap_b32 v203, v255
    v_fmac_f32 v199, v49, v121
    v_fmac_f32 v199, v50, v122
    v_fmac_f32 v199, v51, v123
    v_fmac_f32 v199, v52, v124
    v_fmac_f32 v199, v53, v125
    v_fmac_f32 v199, v54, v126
    v_fmac_f32 v199, v55, v127
    v_add_f32 v255, v203, v255
    v_mul_f32 v197, v56, v168
    v_fmac_f32 v197, v57, v169
    v_fmac_f32 v197, v58, v170
    v_fmac_f32 v197, v59, v171
    v_fmac_f32 v197, v60, v172
    v_fmac_f32 v197, v61, v173
    v_fmac_f32 v197, v62, v174
    v_fmac_f32 v197, v63, v175
    s_nop 1
    v_permlane32_swap_b32 v199, v197
    v_add_f32 v197, v199, v197
    v_cvt_pk_bf16_f32 v200, v200, v201
    v_cvt_pk_bf16_f32 v254, v254, v255
    v_cvt_pk_bf16_f32 v196, v196, v197
    ds_write_b32 v253, v200 offset:768
    s_mov_b64 exec, 0xffffffff
    ds_write_b32 v253, v254 offset:1280
    s_mov_b64 exec, -1
    ds_write_b32 v253, v196 offset:1024
    s_add_u32 s50, s50, 1
    s_cmp_ge_u32 s50, 5
    s_cbranch_scc1 TAIL
    s_waitcnt lgkmcnt(6)
    v_readfirstlane_b32 s66, v252
    s_add_u32 s53, s53, 1
    v_mov_b32 v252, s53
    s_cmp_le_u32 s53, s66
    ds_write2_b32 v251, v252, v252 offset0:0 offset1:8
    s_setprio 1
    s_cbranch_scc1 PRIO_14
    s_setprio 0
PRIO_14:
    s_cmp_eq_u32 s52, 4
    s_cbranch_scc1 ITEM_1_4
    s_cmp_eq_u32 s52, 5
    s_cbranch_scc1 ITEM_1_5
    s_cmp_eq_u32 s52, 3
    s_cbranch_scc1 ITEM_1_3
    s_cmp_eq_u32 s52, 6
    s_cbranch_scc1 ITEM_1_6
    s_cmp_eq_u32 s52, 8
    s_cbranch_scc1 ITEM_1_8
    s_branch ITEM_1_2
.p2align 6
ITEM_1_2:
    s_mov_b32 m0, s50
    s_nop 0
    s_movrels_b32 s71, s23
    s_movrels_b32 s33, s28
    s_and_b32 s70, s33, 0x70
    s_andn2_b32 s33, s33, 0x70
    v_xor_b32 v253, s70, v248
    v_add_u32 v253, s33, v253
    s_bfe_u32 s46, s71, 0x30012
    s_mov_b32 m0, s46
    s_and_b32 s66, s71, 0x3ffff
    s_movrels_b32 s68, s57
    s_movrels_b32 s69, s61
    s_sub_u32 s48, s66, s47
    s_mov_b32 s47, s66
    s_lshr_b32 s52, s71, 28
    s_lshl_b32 s67, s46, 9
    s_add_u32 s66, s66, s67
    s_sub_u32 s49, s66, s42
    s_mov_b32 s42, s66
    s_bfe_u32 s66, s68, 655360
    s_add_u32 s43, s42, s66
    s_bfe_u32 s39, s69, 655360
    s_bfe_u32 s66, s68, 655370
    s_add_u32 s44, s42, s66
    s_bfe_u32 s40, s69, 655370
    s_bfe_u32 s66, s68, 655380
    s_add_u32 s45, s42, s66
    s_bfe_u32 s41, s69, 655380
    v_add_u32 v252, s42, v247
    ds_read_u16 v234, v252
    ds_read_u16 v235, v252 offset:64
    v_add_u32 v252, s43, v247
    ds_read_u16 v236, v252
    ds_read_u16 v237, v252 offset:64
    v_add_u32 v252, s44, v247
    ds_read_u16 v238, v252
    ds_read_u16 v239, v252 offset:64
    v_add_u32 v252, s45, v247
    ds_read_u16 v240, v252
    ds_read_u16 v241, v252 offset:64
    s_waitcnt lgkmcnt(8)
    v_lshlrev_b32 v196, 16, v68
    v_and_b32 v197, 0xffff0000, v68
    v_lshlrev_b32 v198, 16, v69
    v_and_b32 v199, 0xffff0000, v69
    v_mul_f32_dpp v200, v242, v196 row_newbcast:0 row_mask:0xf bank_mask:0xf
    v_mul_f32_dpp v201, v242, v197 row_newbcast:1 row_mask:0xf bank_mask:0xf
    v_mul_f32_dpp v202, v242, v196 row_newbcast:8 row_mask:0xf bank_mask:0xf
    v_mul_f32_dpp v203, v242, v197 row_newbcast:9 row_mask:0xf bank_mask:0xf
    v_lshlrev_b32 v196, 16, v70
    v_and_b32 v197, 0xffff0000, v70
    v_cvt_pk_bf16_f32 v64, v200, v201
    v_cvt_pk_bf16_f32 v68, v202, v203
    v_mul_f32_dpp v200, v242, v198 row_newbcast:2 row_mask:0xf bank_mask:0xf
    v_mul_f32_dpp v201, v242, v199 row_newbcast:3 row_mask:0xf bank_mask:0xf
    v_mul_f32_dpp v202, v242, v198 row_newbcast:10 row_mask:0xf bank_mask:0xf
    v_mul_f32_dpp v203, v242, v199 row_newbcast:11 row_mask:0xf bank_mask:0xf
    v_lshlrev_b32 v198, 16, v71
    v_and_b32 v199, 0xffff0000, v71
    v_cvt_pk_bf16_f32 v65, v200, v201
    v_cvt_pk_bf16_f32 v69, v202, v203
    v_mul_f32_dpp v200, v242, v196 row_newbcast:4 row_mask:0xf bank_mask:0xf
    v_mul_f32_dpp v201, v242, v197 row_newbcast:5 row_mask:0xf bank_mask:0xf
    v_mul_f32_dpp v202, v242, v196 row_newbcast:12 row_mask:0xf bank_mask:0xf
    v_mul_f32_dpp v203, v242, v197 row_newbcast:13 row_mask:0xf bank_mask:0xf
    v_cvt_pk_bf16_f32 v66, v200, v201
    v_cvt_pk_bf16_f32 v70, v202, v203
    v_mul_f32_dpp v200, v242, v198 row_newbcast:6 row_mask:0xf bank_mask:0xf
    v_mul_f32_dpp v201, v242, v199 row_newbcast:7 row_mask:0xf bank_mask:0xf
    v_mul_f32_dpp v202, v242, v198 row_newbcast:14 row_mask:0xf bank_mask:0xf
    v_mul_f32_dpp v203, v242, v199 row_newbcast:15 row_mask:0xf bank_mask:0xf
    v_cvt_pk_bf16_f32 v67, v200, v201
    v_cvt_pk_bf16_f32 v71, v202, v203
    s_nop 0
    s_waitcnt lgkmcnt(6)
    v_mfma_f32_32x32x16_bf16 v[0:15], v[64:67], v[176:179], 0
    s_add_u32 m0, s21, 0
    v_mfma_f32_32x32x16_bf16 v[16:31], v[68:71], v[176:179], 0
    v_lshl_add_u32 v234, v234, 10, v246
    v_lshl_add_u32 v235, v235, 10, v246
    buffer_load_dwordx4 v234, s[4:7], s38 offen lds
    buffer_load_dwordx4 v235, s[8:11], s38 offen offset:1024 lds
    v_mfma_f32_32x32x16_bf16 v[32:47], v[64:67], v[180:183], 0
    s_nop 4
    v_mul_f32 v196, v0, v96
    v_fmac_f32 v196, v1, v97
    v_fmac_f32 v196, v2, v98
    v_fmac_f32 v196, v3, v99
    v_fmac_f32 v196, v4, v100
    v_fmac_f32 v196, v5, v101
    v_fmac_f32 v196, v6, v102
    v_fmac_f32 v196, v7, v103
    v_mul_f32 v198, v8, v128
    v_fmac_f32 v198, v9, v129
    v_fmac_f32 v198, v10, v130
    v_fmac_f32 v198, v11, v131
    v_fmac_f32 v198, v12, v132
    v_fmac_f32 v198, v13, v133
    v_fmac_f32 v198, v14, v134
    v_fmac_f32 v198, v15, v135
    v_mul_f32 v200, v16, v128
    v_fmac_f32 v200, v17, v129
    v_permlane32_swap_b32 v196, v198
    v_mfma_f32_32x32x16_bf16 v[48:63], v[68:71], v[180:183], 0
    s_waitcnt vmcnt(6)
    ds_read_b64_tr_b16 v[176:177], v244 offset:2048
    ds_read_b64_tr_b16 v[178:179], v244 offset:3072
    ds_read_b64_tr_b16 v[180:181], v245 offset:2048
    ds_read_b64_tr_b16 v[182:183], v245 offset:3072
    v_fmac_f32 v200, v18, v130
    v_fmac_f32 v200, v19, v131
    v_fmac_f32 v200, v20, v132
    v_fmac_f32 v200, v21, v133
    v_fmac_f32 v200, v22, v134
    v_fmac_f32 v200, v23, v135
    v_add_f32 v198, v196, v198
    v_mul_f32_e64 v202, v24, -v128
    v_fma_f32 v202, v25, -v129, v202
    v_fma_f32 v202, v26, -v130, v202
    v_fma_f32 v202, v27, -v131, v202
    v_fma_f32 v202, v28, -v132, v202
    v_fma_f32 v202, v29, -v133, v202
    v_fma_f32 v202, v30, -v134, v202
    v_fma_f32 v202, v31, -v135, v202
    s_nop 1
    v_permlane32_swap_b32 v200, v202
    v_add_f32 v202, v200, v202
    s_waitcnt lgkmcnt(0)
    v_mfma_f32_32x32x16_bf16 v[0:15], v[64:67], v[176:179], 0
    v_mul_f32 v197, v32, v104
    v_fmac_f32 v197, v33, v105
    v_fmac_f32 v197, v34, v106
    v_fmac_f32 v197, v35, v107
    v_fmac_f32 v197, v36, v108
    v_fmac_f32 v197, v37, v109
    v_fmac_f32 v197, v38, v110
    v_fmac_f32 v197, v39, v111
    v_mul_f32 v199, v40, v136
    v_fmac_f32 v199, v41, v137
    v_fmac_f32 v199, v42, v138
    v_fmac_f32 v199, v43, v139
    v_fmac_f32 v199, v44, v140
    v_fmac_f32 v199, v45, v141
    v_fmac_f32 v199, v46, v142
    v_fmac_f32 v199, v47, v143
    v_mul_f32 v201, v48, v136
    v_fmac_f32 v201, v49, v137
    v_permlane32_swap_b32 v197, v199
    v_fmac_f32 v201, v50, v138
    v_fmac_f32 v201, v51, v139
    s_add_u32 m0, s21, 2048
    v_mfma_f32_32x32x16_bf16 v[16:31], v[68:71], v[176:179], 0
    v_lshl_add_u32 v236, v236, 10, v246
    v_lshl_add_u32 v237, v237, 10, v246
    buffer_load_dwordx4 v236, s[4:7], s39 offen lds
    buffer_load_dwordx4 v237, s[8:11], s39 offen offset:1024 lds
    v_fmac_f32 v201, v52, v140
    v_fmac_f32 v201, v53, v141
    v_fmac_f32 v201, v54, v142
    v_fmac_f32 v201, v55, v143
    v_add_f32 v199, v197, v199
    v_mul_f32_e64 v203, v56, -v136
    v_fma_f32 v203, v57, -v137, v203
    v_fma_f32 v203, v58, -v138, v203
    v_fma_f32 v203, v59, -v139, v203
    v_fma_f32 v203, v60, -v140, v203
    v_fma_f32 v203, v61, -v141, v203
    v_fma_f32 v203, v62, -v142, v203
    v_fma_f32 v203, v63, -v143, v203
    s_nop 1
    v_permlane32_swap_b32 v201, v203
    v_add_f32 v203, v201, v203
    v_cvt_pk_bf16_f32 v198, v198, v199
    v_cvt_pk_bf16_f32 v202, v202, v203
    ds_write_b32 v253, v198 offset:0
    ds_write_b32 v253, v202 offset:256
    v_mfma_f32_32x32x16_bf16 v[32:47], v[64:67], v[180:183], 0
    v_mul_f32 v196, v0, v144
    v_fmac_f32 v196, v1, v145
    v_fmac_f32 v196, v2, v146
    v_fmac_f32 v196, v3, v147
    v_fmac_f32 v196, v4, v148
    v_fmac_f32 v196, v5, v149
    v_fmac_f32 v196, v6, v150
    v_fmac_f32 v196, v7, v151
    v_mul_f32 v198, v8, v112
    v_fmac_f32 v198, v9, v113
    v_fmac_f32 v198, v10, v114
    v_fmac_f32 v198, v11, v115
    v_fmac_f32 v198, v12, v116
    v_fmac_f32 v198, v13, v117
    v_fmac_f32 v198, v14, v118
    v_fmac_f32 v198, v15, v119
    v_mfma_f32_32x32x16_bf16 v[48:63], v[68:71], v[180:183], 0
    s_waitcnt vmcnt(6)
    ds_read_b64_tr_b16 v[176:177], v244 offset:4096
    ds_read_b64_tr_b16 v[178:179], v244 offset:5120
    ds_read_b64_tr_b16 v[180:181], v245 offset:4096
    ds_read_b64_tr_b16 v[182:183], v245 offset:5120
    v_mul_f32_e64 v200, v16, -v160
    v_fma_f32 v200, v17, -v161, v200
    v_fma_f32 v200, v18, -v162, v200
    v_fma_f32 v200, v19, -v163, v200
    v_fma_f32 v200, v20, -v164, v200
    v_fma_f32 v200, v21, -v165, v200
    v_fma_f32 v200, v22, -v166, v200
    v_fma_f32 v200, v23, -v167, v200
    v_mul_f32_e64 v202, v24, -v160
    v_fma_f32 v202, v25, -v161, v202
    v_fma_f32 v202, v26, -v162, v202
    v_fma_f32 v202, v27, -v163, v202
    v_fma_f32 v202, v28, -v164, v202
    v_fma_f32 v202, v29, -v165, v202
    v_fma_f32 v202, v30, -v166, v202
    v_fma_f32 v202, v31, -v167, v202
    s_waitcnt lgkmcnt(0)
    v_mfma_f32_32x32x16_bf16 v[0:15], v[64:67], v[176:179], 0
    v_mul_f32 v197, v32, v152
    v_fmac_f32 v197, v33, v153
    v_fmac_f32 v197, v34, v154
    v_fmac_f32 v197, v35, v155
    v_fmac_f32 v197, v36, v156
    v_fmac_f32 v197, v37, v157
    v_fmac_f32 v197, v38, v158
    v_fmac_f32 v197, v39, v159
    v_mul_f32 v199, v40, v120
    v_fmac_f32 v199, v41, v121
    v_fmac_f32 v199, v42, v122
    v_fmac_f32 v199, v43, v123
    v_fmac_f32 v199, v44, v124
    v_fmac_f32 v199, v45, v125
    v_fmac_f32 v199, v46, v126
    v_fmac_f32 v199, v47, v127
    s_add_u32 m0, s21, 4096
    v_mfma_f32_32x32x16_bf16 v[16:31], v[68:71], v[176:179], 0
    v_lshl_add_u32 v238, v238, 10, v246
    v_lshl_add_u32 v239, v239, 10, v246
    buffer_load_dwordx4 v238, s[4:7], s40 offen lds
    buffer_load_dwordx4 v239, s[8:11], s40 offen offset:1024 lds
    v_mul_f32_e64 v201, v48, -v168
    v_fma_f32 v201, v49, -v169, v201
    v_fma_f32 v201, v50, -v170, v201
    v_fma_f32 v201, v51, -v171, v201
    v_fma_f32 v201, v52, -v172, v201
    v_fma_f32 v201, v53, -v173, v201
    v_fma_f32 v201, v54, -v174, v201
    v_fma_f32 v201, v55, -v175, v201
    v_mul_f32_e64 v203, v56, -v168
    v_fma_f32 v203, v57, -v169, v203
    v_fma_f32 v203, v58, -v170, v203
    v_fma_f32 v203, v59, -v171, v203
    v_fma_f32 v203, v60, -v172, v203
    v_fma_f32 v203, v61, -v173, v203
    v_fma_f32 v203, v62, -v174, v203
    v_fma_f32 v203, v63, -v175, v203
    v_mfma_f32_32x32x16_bf16 v[32:47], v[64:67], v[180:183], 0
    v_mul_f32 v254, v0, v144
    v_fmac_f32 v254, v1, v145
    v_fmac_f32 v254, v2, v146
    v_fmac_f32 v254, v3, v147
    v_fmac_f32 v254, v4, v148
    v_fmac_f32 v254, v5, v149
    v_fmac_f32 v254, v6, v150
    v_fmac_f32 v254, v7, v151
    v_fmac_f32 v200, v8, v160
    v_mfma_f32_32x32x16_bf16 v[48:63], v[68:71], v[180:183], 0
    ds_swizzle_b32 v68, v68 offset:0x401F
    ds_swizzle_b32 v69, v69 offset:0x401F
    ds_swizzle_b32 v70, v70 offset:0x401F
    ds_swizzle_b32 v71, v71 offset:0x401F
    s_waitcnt vmcnt(6)
    ds_read_b64_tr_b16 v[176:177], v244 offset:6144
    ds_read_b64_tr_b16 v[178:179], v244 offset:7168
    ds_read_b64_tr_b16 v[180:181], v245 offset:6144
    ds_read_b64_tr_b16 v[182:183], v245 offset:7168
    v_fmac_f32 v200, v9, v161
    v_permlane32_swap_b32 v196, v254
    v_fmac_f32 v200, v10, v162
    v_fmac_f32 v200, v11, v163
    v_fmac_f32 v200, v12, v164
    v_fmac_f32 v200, v13, v165
    v_fmac_f32 v200, v14, v166
    v_fmac_f32 v200, v15, v167
    v_add_f32 v254, v196, v254
    s_waitcnt lgkmcnt(0)
    s_mov_b64 exec, s[56:57]
    v_xor_b32 v68, 0x80008000, v68
    v_xor_b32 v69, 0x80008000, v69
    v_xor_b32 v70, 0x80008000, v70
    v_xor_b32 v71, 0x80008000, v71
    s_mov_b64 exec, -1
    s_nop 0
    v_mfma_f32_32x32x16_bf16 v[0:15], v[64:67], v[176:179], 0
    v_mul_f32 v255, v32, v152
    v_fmac_f32 v255, v33, v153
    v_fmac_f32 v255, v34, v154
    v_fmac_f32 v255, v35, v155
    v_fmac_f32 v255, v36, v156
    v_fmac_f32 v255, v37, v157
    v_fmac_f32 v255, v38, v158
    v_fmac_f32 v255, v39, v159
    v_fmac_f32 v201, v40, v168
    v_fmac_f32 v201, v41, v169
    s_add_u32 m0, s21, 6144
    v_mfma_f32_32x32x16_bf16 v[16:31], v[68:71], v[176:179], v[16:31]
    v_lshl_add_u32 v240, v240, 10, v246
    v_lshl_add_u32 v241, v241, 10, v246
    buffer_load_dwordx4 v240, s[4:7], s41 offen lds
    buffer_load_dwordx4 v241, s[8:11], s41 offen offset:1024 lds
    v_permlane32_swap_b32 v197, v255
    v_fmac_f32 v201, v42, v170
    v_fmac_f32 v201, v43, v171
    v_fmac_f32 v201, v44, v172
    v_fmac_f32 v201, v45, v173
    v_fmac_f32 v201, v46, v174
    v_fmac_f32 v201, v47, v175
    v_add_f32 v255, v197, v255
    v_cvt_pk_bf16_f32 v254, v254, v255
    ds_write_b32 v253, v254 offset:512
    v_mfma_f32_32x32x16_bf16 v[32:47], v[64:67], v[180:183], 0
    v_mul_f32 v254, v0, v144
    v_fmac_f32 v254, v1, v145
    v_fmac_f32 v254, v2, v146
    v_fmac_f32 v254, v3, v147
    v_fmac_f32 v254, v4, v148
    v_fmac_f32 v254, v5, v149
    v_fmac_f32 v254, v6, v150
    v_fmac_f32 v254, v7, v151
    v_fma_f32 v202, v8, -v160, v202
    v_fma_f32 v202, v9, -v161, v202
    v_permlane32_swap_b32 v254, v200
    v_fma_f32 v202, v10, -v162, v202
    v_fma_f32 v202, v11, -v163, v202
    v_fma_f32 v202, v12, -v164, v202
    v_fma_f32 v202, v13, -v165, v202
    v_fma_f32 v202, v14, -v166, v202
    v_fma_f32 v202, v15, -v167, v202
    v_add_f32 v200, v254, v200
    v_fmac_f32 v198, v16, v112
    v_permlane32_swap_b32 v202, v254
    v_mfma_f32_32x32x16_bf16 v[48:63], v[68:71], v[180:183], v[48:63]
    s_waitcnt vmcnt(6)
    ds_read_b64_tr_b16 v[176:177], v244 offset:0
    ds_read_b64_tr_b16 v[178:179], v244 offset:1024
    ds_read_b64_tr_b16 v[180:181], v245 offset:0
    ds_read_b64_tr_b16 v[182:183], v245 offset:1024
    v_add_u32 v249, s48, v249
    v_add_u32 v250, s49, v250
    ds_read_b32 v252, v251 offset:16
    ds_read_b64_tr_b16 v[68:69], v249 offset:0
    ds_read_b64_tr_b16 v[70:71], v249 offset:256
    s_mov_b64 exec, s[54:55]
    ds_read_u16_d16_hi v242, v250 offset:0
    s_mov_b64 exec, -1
    v_fmac_f32 v198, v17, v113
    v_fmac_f32 v198, v18, v114
    v_fmac_f32 v198, v19, v115
    v_fmac_f32 v198, v20, v116
    v_fmac_f32 v198, v21, v117
    v_fmac_f32 v198, v22, v118
    v_fmac_f32 v198, v23, v119
    v_add_f32 v254, v202, v254
    v_mul_f32 v196, v24, v160
    v_fmac_f32 v196, v25, v161
    v_fmac_f32 v196, v26, v162
    v_fmac_f32 v196, v27, v163
    v_fmac_f32 v196, v28, v164
    v_fmac_f32 v196, v29, v165
    v_fmac_f32 v196, v30, v166
    v_fmac_f32 v196, v31, v167
    s_nop 1
    v_permlane32_swap_b32 v198, v196
    v_add_f32 v196, v198, v196
    v_mul_f32 v255, v32, v152
    v_fmac_f32 v255, v33, v153
    v_fmac_f32 v255, v34, v154
    v_fmac_f32 v255, v35, v155
    v_fmac_f32 v255, v36, v156
    v_fmac_f32 v255, v37, v157
    v_fmac_f32 v255, v38, v158
    v_fmac_f32 v255, v39, v159
    v_fma_f32 v203, v40, -v168, v203
    v_fma_f32 v203, v41, -v169, v203
    v_permlane32_swap_b32 v255, v201
    v_fma_f32 v203, v42, -v170, v203
    v_fma_f32 v203, v43, -v171, v203
    v_fma_f32 v203, v44, -v172, v203
    v_fma_f32 v203, v45, -v173, v203
    v_fma_f32 v203, v46, -v174, v203
    v_fma_f32 v203, v47, -v175, v203
    v_add_f32 v201, v255, v201
    v_fmac_f32 v199, v48, v120
    v_permlane32_swap_b32 v203, v255
    v_fmac_f32 v199, v49, v121
    v_fmac_f32 v199, v50, v122
    v_fmac_f32 v199, v51, v123
    v_fmac_f32 v199, v52, v124
    v_fmac_f32 v199, v53, v125
    v_fmac_f32 v199, v54, v126
    v_fmac_f32 v199, v55, v127
    v_add_f32 v255, v203, v255
    v_mul_f32 v197, v56, v168
    v_fmac_f32 v197, v57, v169
    v_fmac_f32 v197, v58, v170
    v_fmac_f32 v197, v59, v171
    v_fmac_f32 v197, v60, v172
    v_fmac_f32 v197, v61, v173
    v_fmac_f32 v197, v62, v174
    v_fmac_f32 v197, v63, v175
    s_nop 1
    v_permlane32_swap_b32 v199, v197
    v_add_f32 v197, v199, v197
    v_cvt_pk_bf16_f32 v200, v200, v201
    v_cvt_pk_bf16_f32 v254, v254, v255
    v_cvt_pk_bf16_f32 v196, v196, v197
    ds_write_b32 v253, v200 offset:768
    s_mov_b64 exec, 0xffffffff
    ds_write_b32 v253, v254 offset:1280
    s_mov_b64 exec, -1
    ds_write_b32 v253, v196 offset:1024
    s_add_u32 s50, s50, 1
    s_cmp_ge_u32 s50, 5
    s_cbranch_scc1 TAIL
    s_waitcnt lgkmcnt(6)
    v_readfirstlane_b32 s66, v252
    s_add_u32 s53, s53, 1
    v_mov_b32 v252, s53
    s_cmp_le_u32 s53, s66
    ds_write2_b32 v251, v252, v252 offset0:0 offset1:8
    s_setprio 1
    s_cbranch_scc1 PRIO_15
    s_setprio 0
PRIO_15:
    s_cmp_eq_u32 s52, 4
    s_cbranch_scc1 ITEM_1_4
    s_cmp_eq_u32 s52, 5
    s_cbranch_scc1 ITEM_1_5
    s_cmp_eq_u32 s52, 3
    s_cbranch_scc1 ITEM_1_3
    s_cmp_eq_u32 s52, 6
    s_cbranch_scc1 ITEM_1_6
    s_cmp_eq_u32 s52, 8
    s_cbranch_scc1 ITEM_1_8
    s_branch ITEM_1_2
.p2align 6
TAIL:
    s_setprio 0
    s_waitcnt vmcnt(0) lgkmcnt(0)
    v_mbcnt_lo_u32_b32 v176, -1, 0
    v_mbcnt_hi_u32_b32 v176, -1, v176
    v_lshlrev_b32 v180, 4, v176
    s_cmp_eq_u32 s89, 0
    s_cbranch_scc1 T_flags
    s_mul_i32 s66, s20, 80
    v_lshlrev_b32 v2, 2, v176
    v_min_u32 v2, 76, v2
    s_mov_b32 s67, 262144
T_poll:
    buffer_load_dword v3, v2, s[16:19], s66 offen offset:128 sc1
    s_waitcnt vmcnt(0)
    v_cmp_ne_u32 vcc, s88, v3
    s_sub_u32 s67, s67, 1
    s_cselect_b64 vcc, 0, vcc
    s_cmp_eq_u64 vcc, 0
    s_cbranch_scc0 T_poll
    s_mov_b32 s89, 0
T_flags:
    s_mul_i32 s66, s20, 20480
    s_add_u32 s66, s66, 1024
    buffer_load_dwordx4 v[96:99], v180, s[16:19], s66 offen offset:0 sc1
    buffer_load_dwordx4 v[100:103], v180, s[16:19], s66 offen offset:1024 sc1
    buffer_load_dwordx4 v[104:107], v180, s[16:19], s66 offen offset:2048 sc1
    buffer_load_dwordx4 v[108:111], v180, s[16:19], s66 offen offset:3072 sc1
    s_add_u32 s66, s66, 4096
    buffer_load_dwordx4 v[112:115], v180, s[16:19], s66 offen offset:0 sc1
    buffer_load_dwordx4 v[116:119], v180, s[16:19], s66 offen offset:1024 sc1
    buffer_load_dwordx4 v[120:123], v180, s[16:19], s66 offen offset:2048 sc1
    buffer_load_dwordx4 v[124:127], v180, s[16:19], s66 offen offset:3072 sc1
    s_add_u32 s66, s66, 4096
    buffer_load_dwordx4 v[128:131], v180, s[16:19], s66 offen offset:0 sc1
    buffer_load_dwordx4 v[132:135], v180, s[16:19], s66 offen offset:1024 sc1
    buffer_load_dwordx4 v[136:139], v180, s[16:19], s66 offen offset:2048 sc1
    buffer_load_dwordx4 v[140:143], v180, s[16:19], s66 offen offset:3072 sc1
    s_add_u32 s66, s66, 4096
    buffer_load_dwordx4 v[144:147], v180, s[16:19], s66 offen offset:0 sc1
    buffer_load_dwordx4 v[148:151], v180, s[16:19], s66 offen offset:1024 sc1
    buffer_load_dwordx4 v[152:155], v180, s[16:19], s66 offen offset:2048 sc1
    buffer_load_dwordx4 v[156:159], v180, s[16:19], s66 offen offset:3072 sc1
    s_add_u32 s66, s66, 4096
    buffer_load_dwordx4 v[160:163], v180, s[16:19], s66 offen offset:0 sc1
    buffer_load_dwordx4 v[164:167], v180, s[16:19], s66 offen offset:1024 sc1
    buffer_load_dwordx4 v[168:171], v180, s[16:19], s66 offen offset:2048 sc1
    buffer_load_dwordx4 v[172:175], v180, s[16:19], s66 offen offset:3072 sc1
    v_lshlrev_b32 v181, 2, v176
    s_bfe_u32 s67, s22, 0x40015
    s_lshl_b32 s67, s67, 4
    s_and_b32 s68, s67, 128
    s_and_b32 s67, s67, 0x70
    s_add_u32 s68, s68, s21
    v_xor_b32 v180, s67, v181
    v_add_u32 v180, s68, v180
    ds_write_b32 v180, v204 offset:0
    ds_write_b32 v180, v205 offset:256
    ds_write_b32 v180, v206 offset:512
    ds_write_b32 v180, v207 offset:768
    ds_write_b32 v180, v208 offset:1024
    s_mov_b64 exec, 0xffffffff
    ds_write_b32 v180, v209 offset:1280
    s_mov_b64 exec, -1
    s_bfe_u32 s67, s23, 0x40015
    s_lshl_b32 s67, s67, 4
    s_and_b32 s68, s67, 128
    s_and_b32 s67, s67, 0x70
    s_add_u32 s68, s68, s21
    v_xor_b32 v180, s67, v181
    v_add_u32 v180, s68, v180
    ds_write_b32 v180, v210 offset:1536
    ds_write_b32 v180, v211 offset:1792
    ds_write_b32 v180, v212 offset:2048
    ds_write_b32 v180, v213 offset:2304
    ds_write_b32 v180, v214 offset:2560
    s_mov_b64 exec, 0xffffffff
    ds_write_b32 v180, v215 offset:2816
    s_mov_b64 exec, -1
    s_bfe_u32 s67, s24, 0x40015
    s_lshl_b32 s67, s67, 4
    s_and_b32 s68, s67, 128
    s_and_b32 s67, s67, 0x70
    s_add_u32 s68, s68, s21
    v_xor_b32 v180, s67, v181
    v_add_u32 v180, s68, v180
    ds_write_b32 v180, v216 offset:3072
    ds_write_b32 v180, v217 offset:3328
    ds_write_b32 v180, v218 offset:3584
    ds_write_b32 v180, v219 offset:3840
    ds_write_b32 v180, v220 offset:4096
    s_mov_b64 exec, 0xffffffff
    ds_write_b32 v180, v221 offset:4352
    s_mov_b64 exec, -1
    s_bfe_u32 s67, s25, 0x40015
    s_lshl_b32 s67, s67, 4
    s_and_b32 s68, s67, 128
    s_and_b32 s67, s67, 0x70
    s_add_u32 s68, s68, s21
    v_xor_b32 v180, s67, v181
    v_add_u32 v180, s68, v180
    ds_write_b32 v180, v222 offset:4608
    ds_write_b32 v180, v223 offset:4864
    ds_write_b32 v180, v224 offset:5120
    ds_write_b32 v180, v225 offset:5376
    ds_write_b32 v180, v226 offset:5632
    s_mov_b64 exec, 0xffffffff
    ds_write_b32 v180, v227 offset:5888
    s_mov_b64 exec, -1
    s_bfe_u32 s67, s26, 0x40015
    s_lshl_b32 s67, s67, 4
    s_and_b32 s68, s67, 128
    s_and_b32 s67, s67, 0x70
    s_add_u32 s68, s68, s21
    v_xor_b32 v180, s67, v181
    v_add_u32 v180, s68, v180
    ds_write_b32 v180, v228 offset:6144
    ds_write_b32 v180, v229 offset:6400
    ds_write_b32 v180, v230 offset:6656
    ds_write_b32 v180, v231 offset:6912
    ds_write_b32 v180, v232 offset:7168
    s_mov_b64 exec, 0xffffffff
    ds_write_b32 v180, v233 offset:7424
    s_mov_b64 exec, -1
GEMM:
    s_load_dwordx2 s[72:73], s[0:1], 72
    v_and_b32 v177, 15, v176
    v_lshrrev_b32 v178, 4, v176
    v_and_b32 v179, 7, v177
    v_lshlrev_b32 v180, 3, v177
    v_lshlrev_b32 v181, 3, v179
    v_add_u32 v180, 163328, v180
    v_add_u32 v181, 163328, v181
    ds_read_b64 v[182:183], v180
    ds_read_b64 v[184:185], v180 offset:128
    ds_read_b64 v[186:187], v181 offset:256
    v_xor_b32 v180, v179, v178
    v_and_b32 v181, 8, v177
    v_xor_b32 v188, 4, v180
    v_add_u32 v189, v188, v181
    v_add_u32 v181, v180, v181
    s_waitcnt lgkmcnt(0)
    s_mov_b32 s4, s72
    s_and_b32 s5, s73, 0xffff
    s_mov_b32 s6, 10240000
    s_mov_b32 s7, 0x20000
    v_lshl_add_u32 v48, v180, 4, v182
    v_lshl_add_u32 v49, v188, 4, v182
    v_lshl_add_u32 v50, v180, 4, v183
    v_lshl_add_u32 v51, v188, 4, v183
    v_lshl_add_u32 v52, v180, 4, v184
    v_lshl_add_u32 v53, v188, 4, v184
    v_lshl_add_u32 v54, v180, 4, v185
    v_lshl_add_u32 v55, v188, 4, v185
    v_lshl_add_u32 v56, v181, 4, v186
    v_lshl_add_u32 v57, v189, 4, v186
    v_lshl_add_u32 v58, v181, 4, v187
    v_lshl_add_u32 v59, v189, 4, v187
    s_mov_b32 s67, 0xbfb8aa3b
    v_lshrrev_b32 v205, 1, v178
    v_lshl_add_u32 v205, s20, 1, v205
    v_and_b32 v204, 7, v177
    v_xor_b32 v205, v205, v204
    v_and_b32 v204, 1, v178
    v_lshlrev_b32 v204, 3, v204
    v_lshl_add_u32 v205, v205, 4, v204
    v_and_b32 v204, 8, v177
    v_lshl_add_u32 v204, v204, 4, v205
    v_lshl_add_u32 v204, v177, 10, v204
    v_add_u32 v204, 65536, v204
    v_add_u32 v205, v205, v182
    v_lshlrev_b32 v210, 4, v176
    s_lshl_b32 s68, s20, 1
    s_add_u32 s69, s68, 1
    v_readlane_b32 s24, v182, s68
    v_readlane_b32 s25, v182, s69
    s_and_b32 s70, s68, 7
    s_lshl_b32 s70, s70, 4
    v_xor_b32 v206, s70, v210
    v_xor_b32 v207, 16, v206
    v_add_u32 v208, s24, v206
    v_add_u32 v209, s25, v207
    s_lshl_b32 s70, s68, 10
    s_and_b32 s71, s68, 8
    s_lshl_b32 s71, s71, 4
    s_add_u32 s71, s71, s70
    s_add_u32 s71, s71, 65536
    v_add_u32 v206, s71, v206
    v_add_u32 v207, s71, v207
    s_mul_i32 s66, s2, 40960
    s_add_u32 s22, s66, s70
    s_add_u32 s23, s22, 0x4000
    s_lshl_b32 s70, s20, 10
    s_add_u32 s66, s66, s70
    s_add_u32 s66, s66, 0x8000
    s_add_u32 s70, s70, 65536
    s_lshl_b32 s71, s20, 4
    v_xor_b32 v211, s71, v210
    v_add_u32 v211, s70, v211
    s_barrier
    ds_read_b128 v[72:75], v48 offset:0
    ds_read_b128 v[76:79], v52 offset:0
    ds_read_b128 v[80:83], v56 offset:0
    ds_read_b128 v[84:87], v49 offset:0
    ds_read_b128 v[88:91], v53 offset:0
    ds_read_b128 v[92:95], v57 offset:0
    s_waitcnt vmcnt(19) lgkmcnt(5)
    v_mfma_f32_16x16x32_bf16 v[0:3], v[96:99], v[72:75], 0
    ds_read_b128 v[72:75], v50 offset:0
    s_waitcnt lgkmcnt(5)
    v_mfma_f32_16x16x32_bf16 v[4:7], v[96:99], v[76:79], 0
    ds_read_b128 v[76:79], v54 offset:0
    s_waitcnt lgkmcnt(5)
    v_mfma_f32_16x16x32_bf16 v[8:11], v[96:99], v[80:83], 0
    ds_read_b128 v[80:83], v58 offset:0
    s_waitcnt vmcnt(18) lgkmcnt(5)
    v_mfma_f32_16x16x32_bf16 v[0:3], v[100:103], v[84:87], v[0:3]
    ds_read_b128 v[84:87], v51 offset:0
    s_waitcnt lgkmcnt(5)
    v_mfma_f32_16x16x32_bf16 v[4:7], v[100:103], v[88:91], v[4:7]
    ds_read_b128 v[88:91], v55 offset:0
    s_waitcnt lgkmcnt(5)
    v_mfma_f32_16x16x32_bf16 v[8:11], v[100:103], v[92:95], v[8:11]
    ds_read_b128 v[92:95], v59 offset:0
    s_waitcnt vmcnt(17) lgkmcnt(5)
    v_mfma_f32_16x16x32_bf16 v[0:3], v[104:107], v[72:75], v[0:3]
    ds_read_b128 v[72:75], v48 offset:1024
    s_waitcnt lgkmcnt(5)
    v_mfma_f32_16x16x32_bf16 v[4:7], v[104:107], v[76:79], v[4:7]
    ds_read_b128 v[76:79], v52 offset:1024
    s_waitcnt lgkmcnt(5)
    v_mfma_f32_16x16x32_bf16 v[8:11], v[104:107], v[80:83], v[8:11]
    ds_read_b128 v[80:83], v56 offset:1024
    s_waitcnt vmcnt(16) lgkmcnt(5)
    v_mfma_f32_16x16x32_bf16 v[0:3], v[108:111], v[84:87], v[0:3]
    ds_read_b128 v[84:87], v49 offset:1024
    s_waitcnt lgkmcnt(5)
    v_mfma_f32_16x16x32_bf16 v[4:7], v[108:111], v[88:91], v[4:7]
    ds_read_b128 v[88:91], v53 offset:1024
    s_waitcnt lgkmcnt(5)
    v_mfma_f32_16x16x32_bf16 v[8:11], v[108:111], v[92:95], v[8:11]
    ds_read_b128 v[92:95], v57 offset:1024
    s_waitcnt vmcnt(15) lgkmcnt(5)
    v_mfma_f32_16x16x32_bf16 v[0:3], v[112:115], v[72:75], v[0:3]
    ds_read_b128 v[72:75], v50 offset:1024
    s_waitcnt lgkmcnt(5)
    v_mfma_f32_16x16x32_bf16 v[4:7], v[112:115], v[76:79], v[4:7]
    ds_read_b128 v[76:79], v54 offset:1024
    s_waitcnt lgkmcnt(5)
    v_mfma_f32_16x16x32_bf16 v[8:11], v[112:115], v[80:83], v[8:11]
    ds_read_b128 v[80:83], v58 offset:1024
    s_waitcnt vmcnt(14) lgkmcnt(5)
    v_mfma_f32_16x16x32_bf16 v[0:3], v[116:119], v[84:87], v[0:3]
    ds_read_b128 v[84:87], v51 offset:1024
    s_waitcnt lgkmcnt(5)
    v_mfma_f32_16x16x32_bf16 v[4:7], v[116:119], v[88:91], v[4:7]
    ds_read_b128 v[88:91], v55 offset:1024
    s_waitcnt lgkmcnt(5)
    v_mfma_f32_16x16x32_bf16 v[8:11], v[116:119], v[92:95], v[8:11]
    ds_read_b128 v[92:95], v59 offset:1024
    s_waitcnt vmcnt(13) lgkmcnt(5)
    v_mfma_f32_16x16x32_bf16 v[0:3], v[120:123], v[72:75], v[0:3]
    ds_read_b128 v[72:75], v48 offset:128
    s_waitcnt lgkmcnt(5)
    v_mfma_f32_16x16x32_bf16 v[4:7], v[120:123], v[76:79], v[4:7]
    ds_read_b128 v[76:79], v48 offset:256
    s_waitcnt lgkmcnt(5)
    v_mfma_f32_16x16x32_bf16 v[8:11], v[120:123], v[80:83], v[8:11]
    ds_read_b128 v[80:83], v48 offset:384
    s_waitcnt vmcnt(12) lgkmcnt(5)
    v_mfma_f32_16x16x32_bf16 v[0:3], v[124:127], v[84:87], v[0:3]
    ds_read_b128 v[84:87], v49 offset:128
    s_waitcnt lgkmcnt(5)
    v_mfma_f32_16x16x32_bf16 v[4:7], v[124:127], v[88:91], v[4:7]
    ds_read_b128 v[88:91], v49 offset:256
    s_waitcnt lgkmcnt(5)
    v_mfma_f32_16x16x32_bf16 v[8:11], v[124:127], v[92:95], v[8:11]
    ds_read_b128 v[92:95], v49 offset:384
    s_waitcnt vmcnt(11) lgkmcnt(5)
    v_mfma_f32_16x16x32_bf16 v[12:15], v[128:131], v[72:75], 0
    ds_read_b128 v[72:75], v50 offset:128
    s_waitcnt lgkmcnt(5)
    v_mfma_f32_16x16x32_bf16 v[24:27], v[128:131], v[76:79], 0
    ds_read_b128 v[76:79], v50 offset:256
    s_waitcnt lgkmcnt(5)
    v_mfma_f32_16x16x32_bf16 v[36:39], v[128:131], v[80:83], 0
    ds_read_b128 v[80:83], v50 offset:384
    s_waitcnt vmcnt(10) lgkmcnt(5)
    v_mfma_f32_16x16x32_bf16 v[12:15], v[132:135], v[84:87], v[12:15]
    v_mul_f32 v192, s67, v0
    v_mul_f32 v193, s67, v1
    ds_read_b128 v[84:87], v51 offset:128
    s_waitcnt lgkmcnt(5)
    v_mfma_f32_16x16x32_bf16 v[24:27], v[132:135], v[88:91], v[24:27]
    v_mul_f32 v194, s67, v2
    v_mul_f32 v195, s67, v3
    ds_read_b128 v[88:91], v51 offset:256
    s_waitcnt lgkmcnt(5)
    v_mfma_f32_16x16x32_bf16 v[36:39], v[132:135], v[92:95], v[36:39]
    v_exp_f32 v192, v192
    v_exp_f32 v193, v193
    ds_read_b128 v[92:95], v51 offset:384
    s_waitcnt vmcnt(9) lgkmcnt(5)
    v_mfma_f32_16x16x32_bf16 v[12:15], v[136:139], v[72:75], v[12:15]
    v_exp_f32 v194, v194
    v_exp_f32 v195, v195
    ds_read_b128 v[72:75], v48 offset:512
    s_waitcnt lgkmcnt(5)
    v_mfma_f32_16x16x32_bf16 v[24:27], v[136:139], v[76:79], v[24:27]
    v_add_f32 v192, 1.0, v192
    v_add_f32 v193, 1.0, v193
    ds_read_b128 v[76:79], v48 offset:640
    s_waitcnt lgkmcnt(5)
    v_mfma_f32_16x16x32_bf16 v[36:39], v[136:139], v[80:83], v[36:39]
    v_add_f32 v194, 1.0, v194
    v_add_f32 v195, 1.0, v195
    ds_read_b128 v[80:83], v48 offset:768
    s_waitcnt vmcnt(8) lgkmcnt(5)
    v_mfma_f32_16x16x32_bf16 v[12:15], v[140:143], v[84:87], v[12:15]
    v_rcp_f32 v192, v192
    v_rcp_f32 v193, v193
    ds_read_b128 v[84:87], v49 offset:512
    s_waitcnt lgkmcnt(5)
    v_mfma_f32_16x16x32_bf16 v[24:27], v[140:143], v[88:91], v[24:27]
    v_rcp_f32 v194, v194
    v_rcp_f32 v195, v195
    ds_read_b128 v[88:91], v49 offset:640
    s_waitcnt lgkmcnt(5)
    v_mfma_f32_16x16x32_bf16 v[36:39], v[140:143], v[92:95], v[36:39]
    v_mul_f32 v196, s67, v4
    v_mul_f32 v197, s67, v5
    ds_read_b128 v[92:95], v49 offset:768
    s_waitcnt vmcnt(7) lgkmcnt(5)
    v_mfma_f32_16x16x32_bf16 v[12:15], v[144:147], v[72:75], v[12:15]
    v_mul_f32 v198, s67, v6
    v_mul_f32 v199, s67, v7
    ds_read_b128 v[72:75], v50 offset:512
    s_waitcnt lgkmcnt(5)
    v_mfma_f32_16x16x32_bf16 v[24:27], v[144:147], v[76:79], v[24:27]
    v_exp_f32 v196, v196
    v_exp_f32 v197, v197
    ds_read_b128 v[76:79], v50 offset:640
    s_waitcnt lgkmcnt(5)
    v_mfma_f32_16x16x32_bf16 v[36:39], v[144:147], v[80:83], v[36:39]
    v_exp_f32 v198, v198
    v_exp_f32 v199, v199
    ds_read_b128 v[80:83], v50 offset:768
    s_waitcnt vmcnt(6) lgkmcnt(5)
    v_mfma_f32_16x16x32_bf16 v[12:15], v[148:151], v[84:87], v[12:15]
    v_add_f32 v196, 1.0, v196
    v_add_f32 v197, 1.0, v197
    ds_read_b128 v[84:87], v51 offset:512
    s_waitcnt lgkmcnt(5)
    v_mfma_f32_16x16x32_bf16 v[24:27], v[148:151], v[88:91], v[24:27]
    v_add_f32 v198, 1.0, v198
    v_add_f32 v199, 1.0, v199
    ds_read_b128 v[88:91], v51 offset:640
    s_waitcnt lgkmcnt(5)
    v_mfma_f32_16x16x32_bf16 v[36:39], v[148:151], v[92:95], v[36:39]
    v_rcp_f32 v196, v196
    v_rcp_f32 v197, v197
    ds_read_b128 v[92:95], v51 offset:768
    s_waitcnt vmcnt(5) lgkmcnt(5)
    v_mfma_f32_16x16x32_bf16 v[12:15], v[152:155], v[72:75], v[12:15]
    v_rcp_f32 v198, v198
    v_rcp_f32 v199, v199
    ds_read_b128 v[72:75], v48 offset:1152
    s_waitcnt lgkmcnt(5)
    v_mfma_f32_16x16x32_bf16 v[24:27], v[152:155], v[76:79], v[24:27]
    v_mul_f32 v200, s67, v8
    v_mul_f32 v201, s67, v9
    ds_read_b128 v[76:79], v48 offset:1280
    s_waitcnt lgkmcnt(5)
    v_mfma_f32_16x16x32_bf16 v[36:39], v[152:155], v[80:83], v[36:39]
    v_mul_f32 v202, s67, v10
    v_mul_f32 v203, s67, v11
    ds_read_b128 v[80:83], v48 offset:896
    s_waitcnt vmcnt(4) lgkmcnt(5)
    v_mfma_f32_16x16x32_bf16 v[12:15], v[156:159], v[84:87], v[12:15]
    v_exp_f32 v200, v200
    v_exp_f32 v201, v201
    ds_read_b128 v[84:87], v49 offset:1152
    s_waitcnt lgkmcnt(5)
    v_mfma_f32_16x16x32_bf16 v[24:27], v[156:159], v[88:91], v[24:27]
    v_exp_f32 v202, v202
    v_exp_f32 v203, v203
    ds_read_b128 v[88:91], v49 offset:1280
    s_waitcnt lgkmcnt(5)
    v_mfma_f32_16x16x32_bf16 v[36:39], v[156:159], v[92:95], v[36:39]
    v_add_f32 v200, 1.0, v200
    v_add_f32 v201, 1.0, v201
    ds_read_b128 v[92:95], v49 offset:896
    s_waitcnt vmcnt(3) lgkmcnt(5)
    v_mfma_f32_16x16x32_bf16 v[12:15], v[160:163], v[72:75], v[12:15]
    v_add_f32 v202, 1.0, v202
    v_add_f32 v203, 1.0, v203
    ds_read_b128 v[72:75], v50 offset:1152
    s_waitcnt lgkmcnt(5)
    v_mfma_f32_16x16x32_bf16 v[24:27], v[160:163], v[76:79], v[24:27]
    v_rcp_f32 v200, v200
    v_rcp_f32 v201, v201
    ds_read_b128 v[76:79], v50 offset:1280
    s_waitcnt lgkmcnt(5)
    v_mfma_f32_16x16x32_bf16 v[36:39], v[160:163], v[80:83], v[36:39]
    v_rcp_f32 v202, v202
    v_rcp_f32 v203, v203
    ds_read_b128 v[80:83], v50 offset:896
    s_waitcnt vmcnt(2) lgkmcnt(5)
    v_mfma_f32_16x16x32_bf16 v[12:15], v[164:167], v[84:87], v[12:15]
    v_cvt_pk_bf16_f32 v0, v0, v1
    v_cvt_pk_bf16_f32 v1, v2, v3
    ds_read_b128 v[84:87], v51 offset:1152
    s_waitcnt lgkmcnt(5)
    v_mfma_f32_16x16x32_bf16 v[24:27], v[164:167], v[88:91], v[24:27]
    ds_write_b64 v204, v[0:1] offset:0
    ds_read_b128 v[88:91], v51 offset:1280
    s_waitcnt lgkmcnt(6)
    v_mfma_f32_16x16x32_bf16 v[36:39], v[164:167], v[92:95], v[36:39]
    ds_read_b128 v[92:95], v51 offset:896
    s_waitcnt vmcnt(1) lgkmcnt(6)
    v_mfma_f32_16x16x32_bf16 v[12:15], v[168:171], v[72:75], v[12:15]
    ds_read_b128 v[72:75], v52 offset:128
    s_waitcnt lgkmcnt(6)
    v_mfma_f32_16x16x32_bf16 v[24:27], v[168:171], v[76:79], v[24:27]
    ds_read_b128 v[76:79], v53 offset:128
    s_waitcnt lgkmcnt(6)
    v_mfma_f32_16x16x32_bf16 v[36:39], v[168:171], v[80:83], v[36:39]
    ds_read_b128 v[80:83], v54 offset:128
    s_waitcnt vmcnt(0) lgkmcnt(6)
    v_mfma_f32_16x16x32_bf16 v[12:15], v[172:175], v[84:87], v[12:15]
    ds_read_b128 v[84:87], v55 offset:128
    s_waitcnt lgkmcnt(5)
    v_mfma_f32_16x16x32_bf16 v[24:27], v[172:175], v[88:91], v[24:27]
    ds_read_b128 v[88:91], v52 offset:512
    s_waitcnt lgkmcnt(5)
    v_mfma_f32_16x16x32_bf16 v[36:39], v[172:175], v[92:95], v[36:39]
    ds_read_b128 v[92:95], v53 offset:512
    s_waitcnt lgkmcnt(5)
    v_mfma_f32_16x16x32_bf16 v[16:19], v[128:131], v[72:75], 0
    ds_read_b128 v[72:75], v54 offset:512
    s_waitcnt lgkmcnt(5)
    v_mfma_f32_16x16x32_bf16 v[16:19], v[132:135], v[76:79], v[16:19]
    ds_read_b128 v[76:79], v55 offset:512
    s_waitcnt lgkmcnt(5)
    v_mfma_f32_16x16x32_bf16 v[16:19], v[136:139], v[80:83], v[16:19]
    v_mul_f32 v12, v12, v192
    v_mul_f32 v13, v13, v193
    ds_read_b128 v[80:83], v52 offset:1152
    s_waitcnt lgkmcnt(5)
    v_mfma_f32_16x16x32_bf16 v[16:19], v[140:143], v[84:87], v[16:19]
    v_mul_f32 v14, v14, v194
    v_mul_f32 v15, v15, v195
    ds_read_b128 v[84:87], v53 offset:1152
    s_waitcnt lgkmcnt(5)
    v_mfma_f32_16x16x32_bf16 v[16:19], v[144:147], v[88:91], v[16:19]
    v_cvt_pk_bf16_f32 v12, v12, v13
    v_cvt_pk_bf16_f32 v13, v14, v15
    ds_read_b128 v[88:91], v54 offset:1152
    s_waitcnt lgkmcnt(5)
    v_mfma_f32_16x16x32_bf16 v[16:19], v[148:151], v[92:95], v[16:19]
    ds_write_b64 v204, v[12:13] offset:256
    v_mul_f32 v24, v24, v192
    ds_read_b128 v[92:95], v55 offset:1152
    s_waitcnt lgkmcnt(6)
    v_mfma_f32_16x16x32_bf16 v[16:19], v[152:155], v[72:75], v[16:19]
    v_mul_f32 v25, v25, v193
    v_mul_f32 v26, v26, v194
    ds_read_b128 v[72:75], v52 offset:256
    s_waitcnt lgkmcnt(6)
    v_mfma_f32_16x16x32_bf16 v[16:19], v[156:159], v[76:79], v[16:19]
    v_mul_f32 v27, v27, v195
    v_cvt_pk_bf16_f32 v24, v24, v25
    ds_read_b128 v[76:79], v53 offset:256
    s_waitcnt lgkmcnt(6)
    v_mfma_f32_16x16x32_bf16 v[16:19], v[160:163], v[80:83], v[16:19]
    v_cvt_pk_bf16_f32 v25, v26, v27
    ds_write_b64 v204, v[24:25] offset:512
    ds_read_b128 v[80:83], v54 offset:256
    s_waitcnt lgkmcnt(7)
    v_mfma_f32_16x16x32_bf16 v[16:19], v[164:167], v[84:87], v[16:19]
    v_mul_f32 v36, v36, v192
    v_mul_f32 v37, v37, v193
    ds_read_b128 v[84:87], v55 offset:256
    s_waitcnt lgkmcnt(7)
    v_mfma_f32_16x16x32_bf16 v[16:19], v[168:171], v[88:91], v[16:19]
    v_mul_f32 v38, v38, v194
    v_mul_f32 v39, v39, v195
    ds_read_b128 v[88:91], v52 offset:640
    s_waitcnt lgkmcnt(6)
    v_mfma_f32_16x16x32_bf16 v[16:19], v[172:175], v[92:95], v[16:19]
    v_cvt_pk_bf16_f32 v36, v36, v37
    v_cvt_pk_bf16_f32 v37, v38, v39
    ds_read_b128 v[92:95], v53 offset:640
    s_waitcnt lgkmcnt(6)
    v_mfma_f32_16x16x32_bf16 v[28:31], v[128:131], v[72:75], 0
    ds_write_b64 v204, v[36:37] offset:768
    ds_read_b128 v[72:75], v54 offset:640
    s_waitcnt lgkmcnt(7)
    v_mfma_f32_16x16x32_bf16 v[28:31], v[132:135], v[76:79], v[28:31]
    ds_read_b128 v[76:79], v55 offset:640
    s_waitcnt lgkmcnt(6)
    v_mfma_f32_16x16x32_bf16 v[28:31], v[136:139], v[80:83], v[28:31]
    ds_read_b128 v[80:83], v52 offset:1280
    s_waitcnt lgkmcnt(6)
    v_mfma_f32_16x16x32_bf16 v[28:31], v[140:143], v[84:87], v[28:31]
    ds_read_b128 v[84:87], v53 offset:1280
    s_waitcnt lgkmcnt(6)
    v_mfma_f32_16x16x32_bf16 v[28:31], v[144:147], v[88:91], v[28:31]
    ds_read_b128 v[88:91], v54 offset:1280
    s_waitcnt lgkmcnt(6)
    v_mfma_f32_16x16x32_bf16 v[28:31], v[148:151], v[92:95], v[28:31]
    ds_read_b128 v[92:95], v55 offset:1280
    s_waitcnt lgkmcnt(5)
    v_mfma_f32_16x16x32_bf16 v[28:31], v[152:155], v[72:75], v[28:31]
    s_barrier
    ds_read_b128 v[72:75], v52 offset:384
    s_waitcnt lgkmcnt(5)
    v_mfma_f32_16x16x32_bf16 v[28:31], v[156:159], v[76:79], v[28:31]
    ds_read_b128 v[212:215], v206 offset:0
    ds_read_b128 v[216:219], v207 offset:1024
    ds_read_b128 v[76:79], v53 offset:384
    s_waitcnt lgkmcnt(7)
    v_mfma_f32_16x16x32_bf16 v[28:31], v[160:163], v[80:83], v[28:31]
    ds_read_b128 v[80:83], v54 offset:384
    s_waitcnt lgkmcnt(7)
    v_mfma_f32_16x16x32_bf16 v[28:31], v[164:167], v[84:87], v[28:31]
    ds_read_b128 v[84:87], v55 offset:384
    s_waitcnt lgkmcnt(7)
    v_mfma_f32_16x16x32_bf16 v[28:31], v[168:171], v[88:91], v[28:31]
    ds_read_b128 v[88:91], v52 offset:768
    s_waitcnt lgkmcnt(7)
    v_mfma_f32_16x16x32_bf16 v[28:31], v[172:175], v[92:95], v[28:31]
    ds_read_b128 v[92:95], v53 offset:768
    s_waitcnt lgkmcnt(7)
    v_mfma_f32_16x16x32_bf16 v[40:43], v[128:131], v[72:75], 0
    ds_read_b128 v[72:75], v54 offset:768
    s_waitcnt lgkmcnt(5)
    v_mfma_f32_16x16x32_bf16 v[40:43], v[132:135], v[76:79], v[40:43]
    buffer_store_dwordx4 v[212:215], v210, s[4:7], s22 offen offset:0 sc1
    ds_read_b128 v[76:79], v55 offset:768
    s_waitcnt lgkmcnt(5)
    v_mfma_f32_16x16x32_bf16 v[40:43], v[136:139], v[80:83], v[40:43]
    buffer_store_dwordx4 v[216:219], v210, s[4:7], s22 offen offset:1024 sc1
    ds_read_b128 v[80:83], v52 offset:896
    s_waitcnt lgkmcnt(5)
    v_mfma_f32_16x16x32_bf16 v[40:43], v[140:143], v[84:87], v[40:43]
    ds_read_b128 v[84:87], v53 offset:896
    s_waitcnt lgkmcnt(5)
    v_mfma_f32_16x16x32_bf16 v[40:43], v[144:147], v[88:91], v[40:43]
    ds_read_b128 v[88:91], v54 offset:896
    s_waitcnt lgkmcnt(5)
    v_mfma_f32_16x16x32_bf16 v[40:43], v[148:151], v[92:95], v[40:43]
    ds_read_b128 v[92:95], v55 offset:896
    s_waitcnt lgkmcnt(5)
    v_mfma_f32_16x16x32_bf16 v[40:43], v[152:155], v[72:75], v[40:43]
    v_cvt_pk_bf16_f32 v4, v4, v5
    v_cvt_pk_bf16_f32 v5, v6, v7
    ds_read_b128 v[72:75], v56 offset:128
    s_waitcnt lgkmcnt(5)
    v_mfma_f32_16x16x32_bf16 v[40:43], v[156:159], v[76:79], v[40:43]
    ds_write_b64 v205, v[4:5] offset:0
    v_mul_f32 v16, v16, v196
    ds_read_b128 v[76:79], v57 offset:128
    s_waitcnt lgkmcnt(6)
    v_mfma_f32_16x16x32_bf16 v[40:43], v[160:163], v[80:83], v[40:43]
    v_mul_f32 v17, v17, v197
    v_mul_f32 v18, v18, v198
    ds_read_b128 v[80:83], v58 offset:128
    s_waitcnt lgkmcnt(6)
    v_mfma_f32_16x16x32_bf16 v[40:43], v[164:167], v[84:87], v[40:43]
    v_mul_f32 v19, v19, v199
    v_cvt_pk_bf16_f32 v16, v16, v17
    ds_read_b128 v[84:87], v59 offset:128
    s_waitcnt lgkmcnt(6)
    v_mfma_f32_16x16x32_bf16 v[40:43], v[168:171], v[88:91], v[40:43]
    v_cvt_pk_bf16_f32 v17, v18, v19
    ds_write_b64 v205, v[16:17] offset:256
    ds_read_b128 v[88:91], v56 offset:512
    s_waitcnt lgkmcnt(7)
    v_mfma_f32_16x16x32_bf16 v[40:43], v[172:175], v[92:95], v[40:43]
    v_mul_f32 v28, v28, v196
    v_mul_f32 v29, v29, v197
    ds_read_b128 v[92:95], v57 offset:512
    s_waitcnt lgkmcnt(7)
    v_mfma_f32_16x16x32_bf16 v[20:23], v[128:131], v[72:75], 0
    v_mul_f32 v30, v30, v198
    v_mul_f32 v31, v31, v199
    ds_read_b128 v[72:75], v58 offset:512
    s_waitcnt lgkmcnt(6)
    v_mfma_f32_16x16x32_bf16 v[20:23], v[132:135], v[76:79], v[20:23]
    v_cvt_pk_bf16_f32 v28, v28, v29
    v_cvt_pk_bf16_f32 v29, v30, v31
    ds_read_b128 v[76:79], v59 offset:512
    s_waitcnt lgkmcnt(6)
    v_mfma_f32_16x16x32_bf16 v[20:23], v[136:139], v[80:83], v[20:23]
    ds_write_b64 v205, v[28:29] offset:512
    ds_read_b128 v[80:83], v56 offset:1152
    s_waitcnt lgkmcnt(7)
    v_mfma_f32_16x16x32_bf16 v[20:23], v[140:143], v[84:87], v[20:23]
    v_mul_f32 v40, v40, v196
    v_mul_f32 v41, v41, v197
    ds_read_b128 v[84:87], v57 offset:1152
    s_waitcnt lgkmcnt(6)
    v_mfma_f32_16x16x32_bf16 v[20:23], v[144:147], v[88:91], v[20:23]
    v_mul_f32 v42, v42, v198
    v_mul_f32 v43, v43, v199
    ds_read_b128 v[88:91], v58 offset:1152
    s_waitcnt lgkmcnt(6)
    v_mfma_f32_16x16x32_bf16 v[20:23], v[148:151], v[92:95], v[20:23]
    v_cvt_pk_bf16_f32 v40, v40, v41
    v_cvt_pk_bf16_f32 v41, v42, v43
    ds_read_b128 v[92:95], v59 offset:1152
    s_waitcnt lgkmcnt(6)
    v_mfma_f32_16x16x32_bf16 v[20:23], v[152:155], v[72:75], v[20:23]
    ds_write_b64 v205, v[40:41] offset:768
    ds_read_b128 v[72:75], v56 offset:256
    s_waitcnt lgkmcnt(7)
    v_mfma_f32_16x16x32_bf16 v[20:23], v[156:159], v[76:79], v[20:23]
    ds_read_b128 v[76:79], v57 offset:256
    s_waitcnt lgkmcnt(6)
    v_mfma_f32_16x16x32_bf16 v[20:23], v[160:163], v[80:83], v[20:23]
    ds_read_b128 v[80:83], v58 offset:256
    s_waitcnt lgkmcnt(6)
    v_mfma_f32_16x16x32_bf16 v[20:23], v[164:167], v[84:87], v[20:23]
    ds_read_b128 v[84:87], v59 offset:256
    s_waitcnt lgkmcnt(6)
    v_mfma_f32_16x16x32_bf16 v[20:23], v[168:171], v[88:91], v[20:23]
    ds_read_b128 v[88:91], v56 offset:640
    s_waitcnt lgkmcnt(6)
    v_mfma_f32_16x16x32_bf16 v[20:23], v[172:175], v[92:95], v[20:23]
    ds_read_b128 v[92:95], v57 offset:640
    s_waitcnt lgkmcnt(5)
    v_mfma_f32_16x16x32_bf16 v[32:35], v[128:131], v[72:75], 0
    s_barrier
    ds_read_b128 v[72:75], v58 offset:640
    s_waitcnt lgkmcnt(5)
    v_mfma_f32_16x16x32_bf16 v[32:35], v[132:135], v[76:79], v[32:35]
    ds_read_b128 v[212:215], v208 offset:0
    ds_read_b128 v[216:219], v209 offset:0
    ds_read_b128 v[76:79], v59 offset:640
    s_waitcnt lgkmcnt(7)
    v_mfma_f32_16x16x32_bf16 v[32:35], v[136:139], v[80:83], v[32:35]
    ds_read_b128 v[80:83], v56 offset:1280
    s_waitcnt lgkmcnt(7)
    v_mfma_f32_16x16x32_bf16 v[32:35], v[140:143], v[84:87], v[32:35]
    ds_read_b128 v[84:87], v57 offset:1280
    s_waitcnt lgkmcnt(7)
    v_mfma_f32_16x16x32_bf16 v[32:35], v[144:147], v[88:91], v[32:35]
    ds_read_b128 v[88:91], v58 offset:1280
    s_waitcnt lgkmcnt(7)
    v_mfma_f32_16x16x32_bf16 v[32:35], v[148:151], v[92:95], v[32:35]
    ds_read_b128 v[92:95], v59 offset:1280
    s_waitcnt lgkmcnt(7)
    v_mfma_f32_16x16x32_bf16 v[32:35], v[152:155], v[72:75], v[32:35]
    ds_read_b128 v[72:75], v56 offset:384
    s_waitcnt lgkmcnt(5)
    v_mfma_f32_16x16x32_bf16 v[32:35], v[156:159], v[76:79], v[32:35]
    buffer_store_dwordx4 v[212:215], v210, s[4:7], s23 offen offset:0 sc1
    ds_read_b128 v[76:79], v57 offset:384
    s_waitcnt lgkmcnt(5)
    v_mfma_f32_16x16x32_bf16 v[32:35], v[160:163], v[80:83], v[32:35]
    buffer_store_dwordx4 v[216:219], v210, s[4:7], s23 offen offset:1024 sc1
    ds_read_b128 v[80:83], v58 offset:384
    s_waitcnt lgkmcnt(5)
    v_mfma_f32_16x16x32_bf16 v[32:35], v[164:167], v[84:87], v[32:35]
    ds_read_b128 v[84:87], v59 offset:384
    s_waitcnt lgkmcnt(5)
    v_mfma_f32_16x16x32_bf16 v[32:35], v[168:171], v[88:91], v[32:35]
    ds_read_b128 v[88:91], v56 offset:768
    s_waitcnt lgkmcnt(5)
    v_mfma_f32_16x16x32_bf16 v[32:35], v[172:175], v[92:95], v[32:35]
    ds_read_b128 v[92:95], v57 offset:768
    s_waitcnt lgkmcnt(5)
    v_mfma_f32_16x16x32_bf16 v[44:47], v[128:131], v[72:75], 0
    ds_read_b128 v[72:75], v58 offset:768
    s_waitcnt lgkmcnt(5)
    v_mfma_f32_16x16x32_bf16 v[44:47], v[132:135], v[76:79], v[44:47]
    ds_read_b128 v[76:79], v59 offset:768
    s_waitcnt lgkmcnt(5)
    v_mfma_f32_16x16x32_bf16 v[44:47], v[136:139], v[80:83], v[44:47]
    ds_read_b128 v[80:83], v56 offset:896
    s_waitcnt lgkmcnt(5)
    v_mfma_f32_16x16x32_bf16 v[44:47], v[140:143], v[84:87], v[44:47]
    v_cvt_pk_bf16_f32 v8, v8, v9
    v_cvt_pk_bf16_f32 v9, v10, v11
    ds_read_b128 v[84:87], v57 offset:896
    s_waitcnt lgkmcnt(5)
    v_mfma_f32_16x16x32_bf16 v[44:47], v[144:147], v[88:91], v[44:47]
    ds_write_b64 v204, v[8:9] offset:0
    v_mul_f32 v20, v20, v200
    ds_read_b128 v[88:91], v58 offset:896
    s_waitcnt lgkmcnt(6)
    v_mfma_f32_16x16x32_bf16 v[44:47], v[148:151], v[92:95], v[44:47]
    v_mul_f32 v21, v21, v201
    v_mul_f32 v22, v22, v202
    ds_read_b128 v[92:95], v59 offset:896
    s_waitcnt lgkmcnt(6)
    v_mfma_f32_16x16x32_bf16 v[44:47], v[152:155], v[72:75], v[44:47]
    v_mul_f32 v23, v23, v203
    v_cvt_pk_bf16_f32 v20, v20, v21
    s_waitcnt lgkmcnt(5)
    v_mfma_f32_16x16x32_bf16 v[44:47], v[156:159], v[76:79], v[44:47]
    v_cvt_pk_bf16_f32 v21, v22, v23
    ds_write_b64 v204, v[20:21] offset:256
    s_waitcnt lgkmcnt(5)
    v_mfma_f32_16x16x32_bf16 v[44:47], v[160:163], v[80:83], v[44:47]
    v_mul_f32 v32, v32, v200
    v_mul_f32 v33, v33, v201
    s_waitcnt lgkmcnt(4)
    v_mfma_f32_16x16x32_bf16 v[44:47], v[164:167], v[84:87], v[44:47]
    v_mul_f32 v34, v34, v202
    v_mul_f32 v35, v35, v203
    s_waitcnt lgkmcnt(2)
    v_mfma_f32_16x16x32_bf16 v[44:47], v[168:171], v[88:91], v[44:47]
    v_cvt_pk_bf16_f32 v32, v32, v33
    v_cvt_pk_bf16_f32 v33, v34, v35
    s_waitcnt lgkmcnt(1)
    v_mfma_f32_16x16x32_bf16 v[44:47], v[172:175], v[92:95], v[44:47]
    ds_write_b64 v204, v[32:33] offset:512
    s_nop 6
    v_mul_f32 v44, v44, v200
    v_mul_f32 v45, v45, v201
    v_mul_f32 v46, v46, v202
    v_mul_f32 v47, v47, v203
    v_cvt_pk_bf16_f32 v44, v44, v45
    v_cvt_pk_bf16_f32 v45, v46, v47
    ds_write_b64 v204, v[44:45] offset:768
    s_waitcnt lgkmcnt(0)
    s_barrier
    ds_read_b128 v[212:215], v211 offset:0
    s_waitcnt lgkmcnt(0)
    buffer_store_dwordx4 v[212:215], v210, s[4:7], s66 offen offset:0 sc1
    s_or_b32 s89, s89, s20
    s_cbranch_scc1 K2_end
    v_mov_b32 v0, 0
    v_mov_b32 v1, s88
    s_mov_b64 exec, 1
    buffer_store_dword v1, v0, s[16:19], 0 offen
K2_end:
K2_last:
    s_endpgm
SLOW:
    v_readlane_b32 s89, v4, 62
    s_waitcnt vmcnt(0) lgkmcnt(0)
    s_barrier
    s_load_dwordx2 s[22:23], s[0:1], 8
    s_load_dwordx2 s[24:25], s[0:1], 24
    s_load_dwordx2 s[26:27], s[0:1], 32
    s_load_dwordx2 s[28:29], s[0:1], 40
    s_load_dwordx2 s[30:31], s[0:1], 0
    v_mbcnt_lo_u32_b32 v240, -1, 0
    v_mbcnt_hi_u32_b32 v240, -1, v240
    v_lshrrev_b32 v229, 5, v240
    v_and_b32 v230, 31, v240
    v_lshlrev_b32 v241, 7, v229
    v_lshl_add_u32 v241, v230, 1, v241
    v_lshlrev_b32 v245, 4, v240
    v_mov_b32 v242, 0
    s_waitcnt lgkmcnt(0)
    s_mov_b32 s80, s22
    s_and_b32 s81, s23, 0xffff
    s_mov_b32 s82, 1920000
    s_mov_b32 s83, 0x20000
    s_mov_b32 s76, s24
    s_and_b32 s77, s25, 0xffff
    s_mov_b32 s78, 1280000
    s_mov_b32 s79, 0x20000
    s_mov_b32 s72, s26
    s_and_b32 s73, s27, 0xffff
    s_mov_b32 s74, 1280000
    s_mov_b32 s75, 0x20000
    s_mov_b32 s84, s28
    s_and_b32 s85, s29, 0xffff
    s_mov_b32 s86, 20480
    s_mov_b32 s87, 0x20000
    s_mov_b32 s4, s30
    s_and_b32 s5, s31, 0xffff
    s_mov_b32 s6, 10240000
    s_mov_b32 s7, 0x20000
    s_mov_b32 s66, 0
    buffer_load_ushort v0, v241, s[84:87], s66 offen offset:0
    buffer_load_ushort v1, v241, s[84:87], s66 offen offset:64
    buffer_load_ushort v2, v241, s[84:87], s66 offen offset:256
    buffer_load_ushort v3, v241, s[84:87], s66 offen offset:320
    buffer_load_ushort v4, v241, s[84:87], s66 offen offset:512
    buffer_load_ushort v5, v241, s[84:87], s66 offen offset:576
    buffer_load_ushort v6, v241, s[84:87], s66 offen offset:768
    buffer_load_ushort v7, v241, s[84:87], s66 offen offset:832
    buffer_load_ushort v8, v241, s[84:87], s66 offen offset:1024
    buffer_load_ushort v9, v241, s[84:87], s66 offen offset:1088
    s_waitcnt vmcnt(0)
    s_mov_b32 s66, 1280
    buffer_load_ushort v10, v241, s[84:87], s66 offen offset:0
    buffer_load_ushort v11, v241, s[84:87], s66 offen offset:64
    buffer_load_ushort v12, v241, s[84:87], s66 offen offset:256
    buffer_load_ushort v13, v241, s[84:87], s66 offen offset:320
    buffer_load_ushort v14, v241, s[84:87], s66 offen offset:512
    buffer_load_ushort v15, v241, s[84:87], s66 offen offset:576
    buffer_load_ushort v16, v241, s[84:87], s66 offen offset:768
    buffer_load_ushort v17, v241, s[84:87], s66 offen offset:832
    buffer_load_ushort v18, v241, s[84:87], s66 offen offset:1024
    buffer_load_ushort v19, v241, s[84:87], s66 offen offset:1088
    s_waitcnt vmcnt(0)
    s_mov_b32 s66, 2560
    buffer_load_ushort v20, v241, s[84:87], s66 offen offset:0
    buffer_load_ushort v21, v241, s[84:87], s66 offen offset:64
    buffer_load_ushort v22, v241, s[84:87], s66 offen offset:256
    buffer_load_ushort v23, v241, s[84:87], s66 offen offset:320
    buffer_load_ushort v24, v241, s[84:87], s66 offen offset:512
    buffer_load_ushort v25, v241, s[84:87], s66 offen offset:576
    buffer_load_ushort v26, v241, s[84:87], s66 offen offset:768
    buffer_load_ushort v27, v241, s[84:87], s66 offen offset:832
    buffer_load_ushort v28, v241, s[84:87], s66 offen offset:1024
    buffer_load_ushort v29, v241, s[84:87], s66 offen offset:1088
    s_waitcnt vmcnt(0)
    s_mov_b32 s66, 3840
    buffer_load_ushort v30, v241, s[84:87], s66 offen offset:0
    buffer_load_ushort v31, v241, s[84:87], s66 offen offset:64
    buffer_load_ushort v32, v241, s[84:87], s66 offen offset:256
    buffer_load_ushort v33, v241, s[84:87], s66 offen offset:320
    buffer_load_ushort v34, v241, s[84:87], s66 offen offset:512
    buffer_load_ushort v35, v241, s[84:87], s66 offen offset:576
    buffer_load_ushort v36, v241, s[84:87], s66 offen offset:768
    buffer_load_ushort v37, v241, s[84:87], s66 offen offset:832
    buffer_load_ushort v38, v241, s[84:87], s66 offen offset:1024
    buffer_load_ushort v39, v241, s[84:87], s66 offen offset:1088
    s_waitcnt vmcnt(0)
    s_mov_b32 s66, 5120
    buffer_load_ushort v40, v241, s[84:87], s66 offen offset:0
    buffer_load_ushort v41, v241, s[84:87], s66 offen offset:64
    buffer_load_ushort v42, v241, s[84:87], s66 offen offset:256
    buffer_load_ushort v43, v241, s[84:87], s66 offen offset:320
    buffer_load_ushort v44, v241, s[84:87], s66 offen offset:512
    buffer_load_ushort v45, v241, s[84:87], s66 offen offset:576
    buffer_load_ushort v46, v241, s[84:87], s66 offen offset:768
    buffer_load_ushort v47, v241, s[84:87], s66 offen offset:832
    buffer_load_ushort v48, v241, s[84:87], s66 offen offset:1024
    buffer_load_ushort v49, v241, s[84:87], s66 offen offset:1088
    s_waitcnt vmcnt(0)
    s_mov_b32 s66, 6400
    buffer_load_ushort v50, v241, s[84:87], s66 offen offset:0
    buffer_load_ushort v51, v241, s[84:87], s66 offen offset:64
    buffer_load_ushort v52, v241, s[84:87], s66 offen offset:256
    buffer_load_ushort v53, v241, s[84:87], s66 offen offset:320
    buffer_load_ushort v54, v241, s[84:87], s66 offen offset:512
    buffer_load_ushort v55, v241, s[84:87], s66 offen offset:576
    buffer_load_ushort v56, v241, s[84:87], s66 offen offset:768
    buffer_load_ushort v57, v241, s[84:87], s66 offen offset:832
    buffer_load_ushort v58, v241, s[84:87], s66 offen offset:1024
    buffer_load_ushort v59, v241, s[84:87], s66 offen offset:1088
    s_waitcnt vmcnt(0)
    s_mov_b32 s66, 7680
    buffer_load_ushort v60, v241, s[84:87], s66 offen offset:0
    buffer_load_ushort v61, v241, s[84:87], s66 offen offset:64
    buffer_load_ushort v62, v241, s[84:87], s66 offen offset:256
    buffer_load_ushort v63, v241, s[84:87], s66 offen offset:320
    buffer_load_ushort v64, v241, s[84:87], s66 offen offset:512
    buffer_load_ushort v65, v241, s[84:87], s66 offen offset:576
    buffer_load_ushort v66, v241, s[84:87], s66 offen offset:768
    buffer_load_ushort v67, v241, s[84:87], s66 offen offset:832
    buffer_load_ushort v68, v241, s[84:87], s66 offen offset:1024
    buffer_load_ushort v69, v241, s[84:87], s66 offen offset:1088
    s_waitcnt vmcnt(0)
    s_mov_b32 s66, 8960
    buffer_load_ushort v70, v241, s[84:87], s66 offen offset:0
    buffer_load_ushort v71, v241, s[84:87], s66 offen offset:64
    buffer_load_ushort v72, v241, s[84:87], s66 offen offset:256
    buffer_load_ushort v73, v241, s[84:87], s66 offen offset:320
    buffer_load_ushort v74, v241, s[84:87], s66 offen offset:512
    buffer_load_ushort v75, v241, s[84:87], s66 offen offset:576
    buffer_load_ushort v76, v241, s[84:87], s66 offen offset:768
    buffer_load_ushort v77, v241, s[84:87], s66 offen offset:832
    buffer_load_ushort v78, v241, s[84:87], s66 offen offset:1024
    buffer_load_ushort v79, v241, s[84:87], s66 offen offset:1088
    s_waitcnt vmcnt(0)
    s_mov_b32 s66, 10240
    buffer_load_ushort v80, v241, s[84:87], s66 offen offset:0
    buffer_load_ushort v81, v241, s[84:87], s66 offen offset:64
    buffer_load_ushort v82, v241, s[84:87], s66 offen offset:256
    buffer_load_ushort v83, v241, s[84:87], s66 offen offset:320
    buffer_load_ushort v84, v241, s[84:87], s66 offen offset:512
    buffer_load_ushort v85, v241, s[84:87], s66 offen offset:576
    buffer_load_ushort v86, v241, s[84:87], s66 offen offset:768
    buffer_load_ushort v87, v241, s[84:87], s66 offen offset:832
    buffer_load_ushort v88, v241, s[84:87], s66 offen offset:1024
    buffer_load_ushort v89, v241, s[84:87], s66 offen offset:1088
    s_waitcnt vmcnt(0)
    s_mov_b32 s66, 11520
    buffer_load_ushort v90, v241, s[84:87], s66 offen offset:0
    buffer_load_ushort v91, v241, s[84:87], s66 offen offset:64
    buffer_load_ushort v92, v241, s[84:87], s66 offen offset:256
    buffer_load_ushort v93, v241, s[84:87], s66 offen offset:320
    buffer_load_ushort v94, v241, s[84:87], s66 offen offset:512
    buffer_load_ushort v95, v241, s[84:87], s66 offen offset:576
    buffer_load_ushort v96, v241, s[84:87], s66 offen offset:768
    buffer_load_ushort v97, v241, s[84:87], s66 offen offset:832
    buffer_load_ushort v98, v241, s[84:87], s66 offen offset:1024
    buffer_load_ushort v99, v241, s[84:87], s66 offen offset:1088
    s_waitcnt vmcnt(0)
    s_mov_b32 s66, 12800
    buffer_load_ushort v100, v241, s[84:87], s66 offen offset:0
    buffer_load_ushort v101, v241, s[84:87], s66 offen offset:64
    buffer_load_ushort v102, v241, s[84:87], s66 offen offset:256
    buffer_load_ushort v103, v241, s[84:87], s66 offen offset:320
    buffer_load_ushort v104, v241, s[84:87], s66 offen offset:512
    buffer_load_ushort v105, v241, s[84:87], s66 offen offset:576
    buffer_load_ushort v106, v241, s[84:87], s66 offen offset:768
    buffer_load_ushort v107, v241, s[84:87], s66 offen offset:832
    buffer_load_ushort v108, v241, s[84:87], s66 offen offset:1024
    buffer_load_ushort v109, v241, s[84:87], s66 offen offset:1088
    s_waitcnt vmcnt(0)
    s_mov_b32 s66, 14080
    buffer_load_ushort v110, v241, s[84:87], s66 offen offset:0
    buffer_load_ushort v111, v241, s[84:87], s66 offen offset:64
    buffer_load_ushort v112, v241, s[84:87], s66 offen offset:256
    buffer_load_ushort v113, v241, s[84:87], s66 offen offset:320
    buffer_load_ushort v114, v241, s[84:87], s66 offen offset:512
    buffer_load_ushort v115, v241, s[84:87], s66 offen offset:576
    buffer_load_ushort v116, v241, s[84:87], s66 offen offset:768
    buffer_load_ushort v117, v241, s[84:87], s66 offen offset:832
    buffer_load_ushort v118, v241, s[84:87], s66 offen offset:1024
    buffer_load_ushort v119, v241, s[84:87], s66 offen offset:1088
    s_waitcnt vmcnt(0)
    s_mov_b32 s66, 15360
    buffer_load_ushort v120, v241, s[84:87], s66 offen offset:0
    buffer_load_ushort v121, v241, s[84:87], s66 offen offset:64
    buffer_load_ushort v122, v241, s[84:87], s66 offen offset:256
    buffer_load_ushort v123, v241, s[84:87], s66 offen offset:320
    buffer_load_ushort v124, v241, s[84:87], s66 offen offset:512
    buffer_load_ushort v125, v241, s[84:87], s66 offen offset:576
    buffer_load_ushort v126, v241, s[84:87], s66 offen offset:768
    buffer_load_ushort v127, v241, s[84:87], s66 offen offset:832
    buffer_load_ushort v128, v241, s[84:87], s66 offen offset:1024
    buffer_load_ushort v129, v241, s[84:87], s66 offen offset:1088
    s_waitcnt vmcnt(0)
    s_mov_b32 s66, 16640
    buffer_load_ushort v130, v241, s[84:87], s66 offen offset:0
    buffer_load_ushort v131, v241, s[84:87], s66 offen offset:64
    buffer_load_ushort v132, v241, s[84:87], s66 offen offset:256
    buffer_load_ushort v133, v241, s[84:87], s66 offen offset:320
    buffer_load_ushort v134, v241, s[84:87], s66 offen offset:512
    buffer_load_ushort v135, v241, s[84:87], s66 offen offset:576
    buffer_load_ushort v136, v241, s[84:87], s66 offen offset:768
    buffer_load_ushort v137, v241, s[84:87], s66 offen offset:832
    buffer_load_ushort v138, v241, s[84:87], s66 offen offset:1024
    buffer_load_ushort v139, v241, s[84:87], s66 offen offset:1088
    s_waitcnt vmcnt(0)
    s_mov_b32 s66, 17920
    buffer_load_ushort v140, v241, s[84:87], s66 offen offset:0
    buffer_load_ushort v141, v241, s[84:87], s66 offen offset:64
    buffer_load_ushort v142, v241, s[84:87], s66 offen offset:256
    buffer_load_ushort v143, v241, s[84:87], s66 offen offset:320
    buffer_load_ushort v144, v241, s[84:87], s66 offen offset:512
    buffer_load_ushort v145, v241, s[84:87], s66 offen offset:576
    buffer_load_ushort v146, v241, s[84:87], s66 offen offset:768
    buffer_load_ushort v147, v241, s[84:87], s66 offen offset:832
    buffer_load_ushort v148, v241, s[84:87], s66 offen offset:1024
    buffer_load_ushort v149, v241, s[84:87], s66 offen offset:1088
    s_waitcnt vmcnt(0)
    s_mov_b32 s66, 19200
    buffer_load_ushort v150, v241, s[84:87], s66 offen offset:0
    buffer_load_ushort v151, v241, s[84:87], s66 offen offset:64
    buffer_load_ushort v152, v241, s[84:87], s66 offen offset:256
    buffer_load_ushort v153, v241, s[84:87], s66 offen offset:320
    buffer_load_ushort v154, v241, s[84:87], s66 offen offset:512
    buffer_load_ushort v155, v241, s[84:87], s66 offen offset:576
    buffer_load_ushort v156, v241, s[84:87], s66 offen offset:768
    buffer_load_ushort v157, v241, s[84:87], s66 offen offset:832
    buffer_load_ushort v158, v241, s[84:87], s66 offen offset:1024
    buffer_load_ushort v159, v241, s[84:87], s66 offen offset:1088
    s_waitcnt vmcnt(0)
    v_lshlrev_b32 v0, 16, v0
    v_lshlrev_b32 v1, 16, v1
    v_lshlrev_b32 v2, 16, v2
    v_lshlrev_b32 v3, 16, v3
    v_lshlrev_b32 v4, 16, v4
    v_lshlrev_b32 v5, 16, v5
    v_lshlrev_b32 v6, 16, v6
    v_lshlrev_b32 v7, 16, v7
    v_lshlrev_b32 v8, 16, v8
    v_lshlrev_b32 v9, 16, v9
    v_lshlrev_b32 v10, 16, v10
    v_lshlrev_b32 v11, 16, v11
    v_lshlrev_b32 v12, 16, v12
    v_lshlrev_b32 v13, 16, v13
    v_lshlrev_b32 v14, 16, v14
    v_lshlrev_b32 v15, 16, v15
    v_lshlrev_b32 v16, 16, v16
    v_lshlrev_b32 v17, 16, v17
    v_lshlrev_b32 v18, 16, v18
    v_lshlrev_b32 v19, 16, v19
    v_lshlrev_b32 v20, 16, v20
    v_lshlrev_b32 v21, 16, v21
    v_lshlrev_b32 v22, 16, v22
    v_lshlrev_b32 v23, 16, v23
    v_lshlrev_b32 v24, 16, v24
    v_lshlrev_b32 v25, 16, v25
    v_lshlrev_b32 v26, 16, v26
    v_lshlrev_b32 v27, 16, v27
    v_lshlrev_b32 v28, 16, v28
    v_lshlrev_b32 v29, 16, v29
    v_lshlrev_b32 v30, 16, v30
    v_lshlrev_b32 v31, 16, v31
    v_lshlrev_b32 v32, 16, v32
    v_lshlrev_b32 v33, 16, v33
    v_lshlrev_b32 v34, 16, v34
    v_lshlrev_b32 v35, 16, v35
    v_lshlrev_b32 v36, 16, v36
    v_lshlrev_b32 v37, 16, v37
    v_lshlrev_b32 v38, 16, v38
    v_lshlrev_b32 v39, 16, v39
    v_lshlrev_b32 v40, 16, v40
    v_lshlrev_b32 v41, 16, v41
    v_lshlrev_b32 v42, 16, v42
    v_lshlrev_b32 v43, 16, v43
    v_lshlrev_b32 v44, 16, v44
    v_lshlrev_b32 v45, 16, v45
    v_lshlrev_b32 v46, 16, v46
    v_lshlrev_b32 v47, 16, v47
    v_lshlrev_b32 v48, 16, v48
    v_lshlrev_b32 v49, 16, v49
    v_lshlrev_b32 v50, 16, v50
    v_lshlrev_b32 v51, 16, v51
    v_lshlrev_b32 v52, 16, v52
    v_lshlrev_b32 v53, 16, v53
    v_lshlrev_b32 v54, 16, v54
    v_lshlrev_b32 v55, 16, v55
    v_lshlrev_b32 v56, 16, v56
    v_lshlrev_b32 v57, 16, v57
    v_lshlrev_b32 v58, 16, v58
    v_lshlrev_b32 v59, 16, v59
    v_lshlrev_b32 v60, 16, v60
    v_lshlrev_b32 v61, 16, v61
    v_lshlrev_b32 v62, 16, v62
    v_lshlrev_b32 v63, 16, v63
    v_lshlrev_b32 v64, 16, v64
    v_lshlrev_b32 v65, 16, v65
    v_lshlrev_b32 v66, 16, v66
    v_lshlrev_b32 v67, 16, v67
    v_lshlrev_b32 v68, 16, v68
    v_lshlrev_b32 v69, 16, v69
    v_lshlrev_b32 v70, 16, v70
    v_lshlrev_b32 v71, 16, v71
    v_lshlrev_b32 v72, 16, v72
    v_lshlrev_b32 v73, 16, v73
    v_lshlrev_b32 v74, 16, v74
    v_lshlrev_b32 v75, 16, v75
    v_lshlrev_b32 v76, 16, v76
    v_lshlrev_b32 v77, 16, v77
    v_lshlrev_b32 v78, 16, v78
    v_lshlrev_b32 v79, 16, v79
    v_lshlrev_b32 v80, 16, v80
    v_lshlrev_b32 v81, 16, v81
    v_lshlrev_b32 v82, 16, v82
    v_lshlrev_b32 v83, 16, v83
    v_lshlrev_b32 v84, 16, v84
    v_lshlrev_b32 v85, 16, v85
    v_lshlrev_b32 v86, 16, v86
    v_lshlrev_b32 v87, 16, v87
    v_lshlrev_b32 v88, 16, v88
    v_lshlrev_b32 v89, 16, v89
    v_lshlrev_b32 v90, 16, v90
    v_lshlrev_b32 v91, 16, v91
    v_lshlrev_b32 v92, 16, v92
    v_lshlrev_b32 v93, 16, v93
    v_lshlrev_b32 v94, 16, v94
    v_lshlrev_b32 v95, 16, v95
    v_lshlrev_b32 v96, 16, v96
    v_lshlrev_b32 v97, 16, v97
    v_lshlrev_b32 v98, 16, v98
    v_lshlrev_b32 v99, 16, v99
    v_lshlrev_b32 v100, 16, v100
    v_lshlrev_b32 v101, 16, v101
    v_lshlrev_b32 v102, 16, v102
    v_lshlrev_b32 v103, 16, v103
    v_lshlrev_b32 v104, 16, v104
    v_lshlrev_b32 v105, 16, v105
    v_lshlrev_b32 v106, 16, v106
    v_lshlrev_b32 v107, 16, v107
    v_lshlrev_b32 v108, 16, v108
    v_lshlrev_b32 v109, 16, v109
    v_lshlrev_b32 v110, 16, v110
    v_lshlrev_b32 v111, 16, v111
    v_lshlrev_b32 v112, 16, v112
    v_lshlrev_b32 v113, 16, v113
    v_lshlrev_b32 v114, 16, v114
    v_lshlrev_b32 v115, 16, v115
    v_lshlrev_b32 v116, 16, v116
    v_lshlrev_b32 v117, 16, v117
    v_lshlrev_b32 v118, 16, v118
    v_lshlrev_b32 v119, 16, v119
    v_lshlrev_b32 v120, 16, v120
    v_lshlrev_b32 v121, 16, v121
    v_lshlrev_b32 v122, 16, v122
    v_lshlrev_b32 v123, 16, v123
    v_lshlrev_b32 v124, 16, v124
    v_lshlrev_b32 v125, 16, v125
    v_lshlrev_b32 v126, 16, v126
    v_lshlrev_b32 v127, 16, v127
    v_lshlrev_b32 v128, 16, v128
    v_lshlrev_b32 v129, 16, v129
    v_lshlrev_b32 v130, 16, v130
    v_lshlrev_b32 v131, 16, v131
    v_lshlrev_b32 v132, 16, v132
    v_lshlrev_b32 v133, 16, v133
    v_lshlrev_b32 v134, 16, v134
    v_lshlrev_b32 v135, 16, v135
    v_lshlrev_b32 v136, 16, v136
    v_lshlrev_b32 v137, 16, v137
    v_lshlrev_b32 v138, 16, v138
    v_lshlrev_b32 v139, 16, v139
    v_lshlrev_b32 v140, 16, v140
    v_lshlrev_b32 v141, 16, v141
    v_lshlrev_b32 v142, 16, v142
    v_lshlrev_b32 v143, 16, v143
    v_lshlrev_b32 v144, 16, v144
    v_lshlrev_b32 v145, 16, v145
    v_lshlrev_b32 v146, 16, v146
    v_lshlrev_b32 v147, 16, v147
    v_lshlrev_b32 v148, 16, v148
    v_lshlrev_b32 v149, 16, v149
    v_lshlrev_b32 v150, 16, v150
    v_lshlrev_b32 v151, 16, v151
    v_lshlrev_b32 v152, 16, v152
    v_lshlrev_b32 v153, 16, v153
    v_lshlrev_b32 v154, 16, v154
    v_lshlrev_b32 v155, 16, v155
    v_lshlrev_b32 v156, 16, v156
    v_lshlrev_b32 v157, 16, v157
    v_lshlrev_b32 v158, 16, v158
    v_lshlrev_b32 v159, 16, v159
    s_mov_b32 s50, 0
SL_node:
    s_mul_i32 s34, s2, 40
    s_mul_i32 s66, s20, 5
    s_add_u32 s66, s66, s50
    s_add_u32 s34, s34, s66
    v_mov_b32 v160, 0
    v_mov_b32 v161, 0
    v_mov_b32 v162, 0
    v_mov_b32 v163, 0
    v_mov_b32 v164, 0
    v_mov_b32 v165, 0
    v_mov_b32 v166, 0
    v_mov_b32 v167, 0
    v_mov_b32 v168, 0
    v_mov_b32 v169, 0
    v_mov_b32 v170, 0
    v_mov_b32 v171, 0
    v_mov_b32 v172, 0
    v_mov_b32 v173, 0
    v_mov_b32 v174, 0
    v_mov_b32 v175, 0
    v_mov_b32 v176, 0
    v_mov_b32 v177, 0
    v_mov_b32 v178, 0
    v_mov_b32 v179, 0
    v_mov_b32 v180, 0
    v_mov_b32 v181, 0
    s_mov_b32 s35, 0
SL_scan:
    s_lshl_b32 s66, s35, 2
    buffer_load_dwordx4 v[236:239], v245, s[72:75], s66 offen
    s_waitcnt vmcnt(0)
    v_cmp_eq_u32 s[38:39], s34, v236
    v_cmp_eq_u32 s[40:41], s34, v237
    v_cmp_eq_u32 s[42:43], s34, v238
    v_cmp_eq_u32 s[44:45], s34, v239
    s_mov_b32 s36, 0
SL_bits:
    s_cmp_eq_u64 s[38:39], 0
    s_cbranch_scc1 SL_nexti
    s_ff1_i32_b64 s66, s[38:39]
    s_bitset0_b64 s[38:39], s66
    s_lshl_b32 s66, s66, 2
    s_add_u32 s37, s66, s36
    s_add_u32 s37, s37, s35
    s_lshl_b32 s66, s37, 2
    s_lshl_b32 s67, s37, 5
    s_mul_i32 s68, s37, 6
    buffer_load_dword v243, v242, s[76:79], s66 offen
    buffer_load_dwordx4 v[184:187], v242, s[12:15], s67 offen
    buffer_load_dwordx4 v[188:191], v242, s[12:15], s67 offen offset:16
    buffer_load_ushort v226, v242, s[80:83], s68 offen offset:0
    buffer_load_ushort v227, v242, s[80:83], s68 offen offset:2
    buffer_load_ushort v228, v242, s[80:83], s68 offen offset:4
    s_waitcnt vmcnt(5)
    v_lshl_add_u32 v243, v243, 10, v241
    buffer_load_ushort v208, v243, s[4:7], 0 offen offset:0
    buffer_load_ushort v209, v243, s[4:7], 0 offen offset:64
    buffer_load_ushort v210, v243, s[4:7], 0 offen offset:256
    buffer_load_ushort v211, v243, s[4:7], 0 offen offset:320
    buffer_load_ushort v212, v243, s[4:7], 0 offen offset:512
    buffer_load_ushort v213, v243, s[4:7], 0 offen offset:576
    buffer_load_ushort v214, v243, s[4:7], 0 offen offset:768
    buffer_load_ushort v215, v243, s[4:7], 0 offen offset:832
    s_waitcnt vmcnt(8)
    v_lshlrev_b32 v192, 16, v184
    v_and_b32 v193, 0xffff0000, v184
    v_lshlrev_b32 v194, 16, v185
    v_and_b32 v195, 0xffff0000, v185
    v_lshlrev_b32 v196, 16, v186
    v_and_b32 v197, 0xffff0000, v186
    v_lshlrev_b32 v198, 16, v187
    v_and_b32 v199, 0xffff0000, v187
    v_lshlrev_b32 v200, 16, v188
    v_and_b32 v201, 0xffff0000, v188
    v_lshlrev_b32 v202, 16, v189
    v_and_b32 v203, 0xffff0000, v189
    v_lshlrev_b32 v204, 16, v190
    v_and_b32 v205, 0xffff0000, v190
    v_lshlrev_b32 v206, 16, v191
    v_and_b32 v207, 0xffff0000, v191
    v_lshlrev_b32 v226, 16, v226
    v_lshlrev_b32 v227, 16, v227
    v_lshlrev_b32 v228, 16, v228
    v_mul_f32 v216, v192, v0
    v_mul_f32 v217, v192, v1
    v_mul_f32 v218, v192, v2
    v_mul_f32 v219, v192, v3
    v_mul_f32 v220, v192, v4
    v_mul_f32 v221, v192, v5
    v_mul_f32 v222, v192, v6
    v_mul_f32 v223, v192, v7
    v_mul_f32 v224, v192, v8
    v_mul_f32 v225, v192, v9
    v_fmac_f32 v216, v193, v10
    v_fmac_f32 v217, v193, v11
    v_fmac_f32 v218, v193, v12
    v_fmac_f32 v219, v193, v13
    v_fmac_f32 v220, v193, v14
    v_fmac_f32 v221, v193, v15
    v_fmac_f32 v222, v193, v16
    v_fmac_f32 v223, v193, v17
    v_fmac_f32 v224, v193, v18
    v_fmac_f32 v225, v193, v19
    v_fmac_f32 v216, v194, v20
    v_fmac_f32 v217, v194, v21
    v_fmac_f32 v218, v194, v22
    v_fmac_f32 v219, v194, v23
    v_fmac_f32 v220, v194, v24
    v_fmac_f32 v221, v194, v25
    v_fmac_f32 v222, v194, v26
    v_fmac_f32 v223, v194, v27
    v_fmac_f32 v224, v194, v28
    v_fmac_f32 v225, v194, v29
    v_fmac_f32 v216, v195, v30
    v_fmac_f32 v217, v195, v31
    v_fmac_f32 v218, v195, v32
    v_fmac_f32 v219, v195, v33
    v_fmac_f32 v220, v195, v34
    v_fmac_f32 v221, v195, v35
    v_fmac_f32 v222, v195, v36
    v_fmac_f32 v223, v195, v37
    v_fmac_f32 v224, v195, v38
    v_fmac_f32 v225, v195, v39
    v_fmac_f32 v216, v196, v40
    v_fmac_f32 v217, v196, v41
    v_fmac_f32 v218, v196, v42
    v_fmac_f32 v219, v196, v43
    v_fmac_f32 v220, v196, v44
    v_fmac_f32 v221, v196, v45
    v_fmac_f32 v222, v196, v46
    v_fmac_f32 v223, v196, v47
    v_fmac_f32 v224, v196, v48
    v_fmac_f32 v225, v196, v49
    v_fmac_f32 v216, v197, v50
    v_fmac_f32 v217, v197, v51
    v_fmac_f32 v218, v197, v52
    v_fmac_f32 v219, v197, v53
    v_fmac_f32 v220, v197, v54
    v_fmac_f32 v221, v197, v55
    v_fmac_f32 v222, v197, v56
    v_fmac_f32 v223, v197, v57
    v_fmac_f32 v224, v197, v58
    v_fmac_f32 v225, v197, v59
    v_fmac_f32 v216, v198, v60
    v_fmac_f32 v217, v198, v61
    v_fmac_f32 v218, v198, v62
    v_fmac_f32 v219, v198, v63
    v_fmac_f32 v220, v198, v64
    v_fmac_f32 v221, v198, v65
    v_fmac_f32 v222, v198, v66
    v_fmac_f32 v223, v198, v67
    v_fmac_f32 v224, v198, v68
    v_fmac_f32 v225, v198, v69
    v_fmac_f32 v216, v199, v70
    v_fmac_f32 v217, v199, v71
    v_fmac_f32 v218, v199, v72
    v_fmac_f32 v219, v199, v73
    v_fmac_f32 v220, v199, v74
    v_fmac_f32 v221, v199, v75
    v_fmac_f32 v222, v199, v76
    v_fmac_f32 v223, v199, v77
    v_fmac_f32 v224, v199, v78
    v_fmac_f32 v225, v199, v79
    v_fmac_f32 v216, v200, v80
    v_fmac_f32 v217, v200, v81
    v_fmac_f32 v218, v200, v82
    v_fmac_f32 v219, v200, v83
    v_fmac_f32 v220, v200, v84
    v_fmac_f32 v221, v200, v85
    v_fmac_f32 v222, v200, v86
    v_fmac_f32 v223, v200, v87
    v_fmac_f32 v224, v200, v88
    v_fmac_f32 v225, v200, v89
    v_fmac_f32 v216, v201, v90
    v_fmac_f32 v217, v201, v91
    v_fmac_f32 v218, v201, v92
    v_fmac_f32 v219, v201, v93
    v_fmac_f32 v220, v201, v94
    v_fmac_f32 v221, v201, v95
    v_fmac_f32 v222, v201, v96
    v_fmac_f32 v223, v201, v97
    v_fmac_f32 v224, v201, v98
    v_fmac_f32 v225, v201, v99
    v_fmac_f32 v216, v202, v100
    v_fmac_f32 v217, v202, v101
    v_fmac_f32 v218, v202, v102
    v_fmac_f32 v219, v202, v103
    v_fmac_f32 v220, v202, v104
    v_fmac_f32 v221, v202, v105
    v_fmac_f32 v222, v202, v106
    v_fmac_f32 v223, v202, v107
    v_fmac_f32 v224, v202, v108
    v_fmac_f32 v225, v202, v109
    v_fmac_f32 v216, v203, v110
    v_fmac_f32 v217, v203, v111
    v_fmac_f32 v218, v203, v112
    v_fmac_f32 v219, v203, v113
    v_fmac_f32 v220, v203, v114
    v_fmac_f32 v221, v203, v115
    v_fmac_f32 v222, v203, v116
    v_fmac_f32 v223, v203, v117
    v_fmac_f32 v224, v203, v118
    v_fmac_f32 v225, v203, v119
    v_fmac_f32 v216, v204, v120
    v_fmac_f32 v217, v204, v121
    v_fmac_f32 v218, v204, v122
    v_fmac_f32 v219, v204, v123
    v_fmac_f32 v220, v204, v124
    v_fmac_f32 v221, v204, v125
    v_fmac_f32 v222, v204, v126
    v_fmac_f32 v223, v204, v127
    v_fmac_f32 v224, v204, v128
    v_fmac_f32 v225, v204, v129
    v_fmac_f32 v216, v205, v130
    v_fmac_f32 v217, v205, v131
    v_fmac_f32 v218, v205, v132
    v_fmac_f32 v219, v205, v133
    v_fmac_f32 v220, v205, v134
    v_fmac_f32 v221, v205, v135
    v_fmac_f32 v222, v205, v136
    v_fmac_f32 v223, v205, v137
    v_fmac_f32 v224, v205, v138
    v_fmac_f32 v225, v205, v139
    v_fmac_f32 v216, v206, v140
    v_fmac_f32 v217, v206, v141
    v_fmac_f32 v218, v206, v142
    v_fmac_f32 v219, v206, v143
    v_fmac_f32 v220, v206, v144
    v_fmac_f32 v221, v206, v145
    v_fmac_f32 v222, v206, v146
    v_fmac_f32 v223, v206, v147
    v_fmac_f32 v224, v206, v148
    v_fmac_f32 v225, v206, v149
    v_fmac_f32 v216, v207, v150
    v_fmac_f32 v217, v207, v151
    v_fmac_f32 v218, v207, v152
    v_fmac_f32 v219, v207, v153
    v_fmac_f32 v220, v207, v154
    v_fmac_f32 v221, v207, v155
    v_fmac_f32 v222, v207, v156
    v_fmac_f32 v223, v207, v157
    v_fmac_f32 v224, v207, v158
    v_fmac_f32 v225, v207, v159
    s_waitcnt vmcnt(0)
    v_lshlrev_b32 v208, 16, v208
    v_lshlrev_b32 v209, 16, v209
    v_lshlrev_b32 v210, 16, v210
    v_lshlrev_b32 v211, 16, v211
    v_lshlrev_b32 v212, 16, v212
    v_lshlrev_b32 v213, 16, v213
    v_lshlrev_b32 v214, 16, v214
    v_lshlrev_b32 v215, 16, v215
    v_fmac_f32 v160, v208, v216
    v_mul_f32 v229, v210, v226
    v_fmac_f32 v229, v212, v227
    v_fmac_f32 v229, v214, v228
    v_fmac_f32 v176, v229, v218
    v_mul_f32 v229, v208, v220
    v_fmac_f32 v162, v229, v226
    v_fmac_f32 v168, v210, v222
    v_mul_f32 v230, v227, v214
    v_fma_f32 v230, -v228, v212, v230
    v_fmac_f32 v178, v230, v224
    v_fmac_f32 v164, v229, v227
    v_fmac_f32 v170, v212, v222
    v_mul_f32 v230, v228, v210
    v_fma_f32 v230, -v226, v214, v230
    v_fmac_f32 v180, v230, v224
    v_fmac_f32 v166, v229, v228
    v_fmac_f32 v172, v214, v222
    v_mul_f32 v230, v226, v212
    v_fma_f32 v230, -v227, v210, v230
    v_fmac_f32 v174, v230, v224
    v_fmac_f32 v161, v209, v217
    v_mul_f32 v229, v211, v226
    v_fmac_f32 v229, v213, v227
    v_fmac_f32 v229, v215, v228
    v_fmac_f32 v177, v229, v219
    v_mul_f32 v229, v209, v221
    v_fmac_f32 v163, v229, v226
    v_fmac_f32 v169, v211, v223
    v_mul_f32 v230, v227, v215
    v_fma_f32 v230, -v228, v213, v230
    v_fmac_f32 v179, v230, v225
    v_fmac_f32 v165, v229, v227
    v_fmac_f32 v171, v213, v223
    v_mul_f32 v230, v228, v211
    v_fma_f32 v230, -v226, v215, v230
    v_fmac_f32 v181, v230, v225
    v_fmac_f32 v167, v229, v228
    v_fmac_f32 v173, v215, v223
    v_mul_f32 v230, v226, v213
    v_fma_f32 v230, -v227, v211, v230
    v_fmac_f32 v175, v230, v225
    s_branch SL_bits
SL_nexti:
    s_mov_b64 s[38:39], s[40:41]
    s_mov_b64 s[40:41], s[42:43]
    s_mov_b64 s[42:43], s[44:45]
    s_add_u32 s36, s36, 1
    s_cmp_lt_u32 s36, 4
    s_cbranch_scc1 SL_bits
    s_add_u32 s35, s35, 256
    s_cmp_lt_u32 s35, 320000
    s_cbranch_scc1 SL_scan
    s_mul_i32 s66, s20, 5
    s_add_u32 s66, s66, s50
    s_lshl_b32 s67, s66, 4
    s_and_b32 s68, s67, 128
    s_and_b32 s67, s67, 0x70
    s_mul_i32 s69, s50, 1536
    s_add_u32 s69, s69, s21
    s_add_u32 s69, s69, s68
    s_mul_i32 s70, s66, 1536
    s_add_u32 s70, s70, 86016
    s_add_u32 s70, s70, s68
    v_mov_b32 v230, s69
    v_mov_b32 v231, s70
    v_cmp_gt_u32 vcc, 32, v240
    v_and_b32 v229, 31, v240
    v_lshlrev_b32 v229, 2, v229
    v_xor_b32 v229, s67, v229
    v_cndmask_b32 v244, v231, v230, vcc
    v_add_u32 v244, v244, v229
    v_cvt_pk_bf16_f32 v160, v160, v161
    ds_write_b32 v244, v160 offset:0
    v_cvt_pk_bf16_f32 v162, v162, v163
    ds_write_b32 v244, v162 offset:128
    v_cvt_pk_bf16_f32 v164, v164, v165
    ds_write_b32 v244, v164 offset:256
    v_cvt_pk_bf16_f32 v166, v166, v167
    ds_write_b32 v244, v166 offset:384
    v_cvt_pk_bf16_f32 v168, v168, v169
    ds_write_b32 v244, v168 offset:512
    v_cvt_pk_bf16_f32 v170, v170, v171
    ds_write_b32 v244, v170 offset:640
    v_cvt_pk_bf16_f32 v172, v172, v173
    ds_write_b32 v244, v172 offset:768
    v_cvt_pk_bf16_f32 v174, v174, v175
    ds_write_b32 v244, v174 offset:896
    v_cvt_pk_bf16_f32 v176, v176, v177
    ds_write_b32 v244, v176 offset:1024
    v_cvt_pk_bf16_f32 v178, v178, v179
    ds_write_b32 v244, v178 offset:1152
    v_cvt_pk_bf16_f32 v180, v180, v181
    ds_write_b32 v244, v180 offset:1280
    s_lshl_b32 s66, s66, 3
    s_add_u32 s66, s66, 163328
    v_mov_b32 v229, s66
    ds_write_b64 v229, v[230:231]
    s_add_u32 s50, s50, 1
    s_cmp_lt_u32 s50, 5
    s_cbranch_scc1 SL_node
    s_waitcnt lgkmcnt(0)
    s_barrier
    v_mov_b32 v176, v240
    s_load_dwordx4 s[84:87], s[0:1], 48
    s_mul_i32 s22, s20, 20
    s_waitcnt lgkmcnt(0)
    s_mul_i32 s24, s22, 3277
    s_lshr_b32 s24, s24, 16
    s_mul_i32 s68, s24, 20
    s_sub_u32 s68, s22, s68
    s_cmp_lt_u32 s68, 8
    s_cselect_b64 s[66:67], s[84:85], s[86:87]
    s_cselect_b32 s25, 0, 8
    s_sub_u32 s68, s68, s25
    s_and_b32 s25, s68, 1
    s_lshr_b32 s68, s68, 1
    s_lshl_b32 s68, s68, 14
    s_lshl_b32 s25, s25, 12
    s_add_u32 s68, s68, s25
    s_lshl_b32 s24, s24, 5
    s_add_u32 s68, s68, s24
    v_lshrrev_b32 v2, 4, v176
    v_lshlrev_b32 v2, 10, v2
    v_and_b32 v3, 15, v176
    v_lshl_add_u32 v2, v3, 1, v2
    v_add_u32 v2, s68, v2
    v_add_u32 v3, 8192, v2
    v_mov_b32 v4, 0
    v_mov_b32 v5, 0
    v_mov_b32 v6, 0
    v_mov_b32 v7, 0
    global_load_ushort v96, v2, s[66:67] offset:0
    global_load_short_d16_hi v4, v3, s[66:67] offset:0
    global_load_ushort v97, v2, s[66:67] offset:256
    global_load_short_d16_hi v5, v3, s[66:67] offset:256
    global_load_ushort v98, v2, s[66:67] offset:512
    global_load_short_d16_hi v6, v3, s[66:67] offset:512
    global_load_ushort v99, v2, s[66:67] offset:768
    global_load_short_d16_hi v7, v3, s[66:67] offset:768
    s_add_u32 s22, s22, 1
    s_waitcnt vmcnt(0)
    v_or_b32 v96, v96, v4
    v_or_b32 v97, v97, v5
    v_or_b32 v98, v98, v6
    v_or_b32 v99, v99, v7
    s_mul_i32 s24, s22, 3277
    s_lshr_b32 s24, s24, 16
    s_mul_i32 s68, s24, 20
    s_sub_u32 s68, s22, s68
    s_cmp_lt_u32 s68, 8
    s_cselect_b64 s[66:67], s[84:85], s[86:87]
    s_cselect_b32 s25, 0, 8
    s_sub_u32 s68, s68, s25
    s_and_b32 s25, s68, 1
    s_lshr_b32 s68, s68, 1
    s_lshl_b32 s68, s68, 14
    s_lshl_b32 s25, s25, 12
    s_add_u32 s68, s68, s25
    s_lshl_b32 s24, s24, 5
    s_add_u32 s68, s68, s24
    v_lshrrev_b32 v2, 4, v176
    v_lshlrev_b32 v2, 10, v2
    v_and_b32 v3, 15, v176
    v_lshl_add_u32 v2, v3, 1, v2
    v_add_u32 v2, s68, v2
    v_add_u32 v3, 8192, v2
    v_mov_b32 v4, 0
    v_mov_b32 v5, 0
    v_mov_b32 v6, 0
    v_mov_b32 v7, 0
    global_load_ushort v100, v2, s[66:67] offset:0
    global_load_short_d16_hi v4, v3, s[66:67] offset:0
    global_load_ushort v101, v2, s[66:67] offset:256
    global_load_short_d16_hi v5, v3, s[66:67] offset:256
    global_load_ushort v102, v2, s[66:67] offset:512
    global_load_short_d16_hi v6, v3, s[66:67] offset:512
    global_load_ushort v103, v2, s[66:67] offset:768
    global_load_short_d16_hi v7, v3, s[66:67] offset:768
    s_add_u32 s22, s22, 1
    s_waitcnt vmcnt(0)
    v_or_b32 v100, v100, v4
    v_or_b32 v101, v101, v5
    v_or_b32 v102, v102, v6
    v_or_b32 v103, v103, v7
    s_mul_i32 s24, s22, 3277
    s_lshr_b32 s24, s24, 16
    s_mul_i32 s68, s24, 20
    s_sub_u32 s68, s22, s68
    s_cmp_lt_u32 s68, 8
    s_cselect_b64 s[66:67], s[84:85], s[86:87]
    s_cselect_b32 s25, 0, 8
    s_sub_u32 s68, s68, s25
    s_and_b32 s25, s68, 1
    s_lshr_b32 s68, s68, 1
    s_lshl_b32 s68, s68, 14
    s_lshl_b32 s25, s25, 12
    s_add_u32 s68, s68, s25
    s_lshl_b32 s24, s24, 5
    s_add_u32 s68, s68, s24
    v_lshrrev_b32 v2, 4, v176
    v_lshlrev_b32 v2, 10, v2
    v_and_b32 v3, 15, v176
    v_lshl_add_u32 v2, v3, 1, v2
    v_add_u32 v2, s68, v2
    v_add_u32 v3, 8192, v2
    v_mov_b32 v4, 0
    v_mov_b32 v5, 0
    v_mov_b32 v6, 0
    v_mov_b32 v7, 0
    global_load_ushort v104, v2, s[66:67] offset:0
    global_load_short_d16_hi v4, v3, s[66:67] offset:0
    global_load_ushort v105, v2, s[66:67] offset:256
    global_load_short_d16_hi v5, v3, s[66:67] offset:256
    global_load_ushort v106, v2, s[66:67] offset:512
    global_load_short_d16_hi v6, v3, s[66:67] offset:512
    global_load_ushort v107, v2, s[66:67] offset:768
    global_load_short_d16_hi v7, v3, s[66:67] offset:768
    s_add_u32 s22, s22, 1
    s_waitcnt vmcnt(0)
    v_or_b32 v104, v104, v4
    v_or_b32 v105, v105, v5
    v_or_b32 v106, v106, v6
    v_or_b32 v107, v107, v7
    s_mul_i32 s24, s22, 3277
    s_lshr_b32 s24, s24, 16
    s_mul_i32 s68, s24, 20
    s_sub_u32 s68, s22, s68
    s_cmp_lt_u32 s68, 8
    s_cselect_b64 s[66:67], s[84:85], s[86:87]
    s_cselect_b32 s25, 0, 8
    s_sub_u32 s68, s68, s25
    s_and_b32 s25, s68, 1
    s_lshr_b32 s68, s68, 1
    s_lshl_b32 s68, s68, 14
    s_lshl_b32 s25, s25, 12
    s_add_u32 s68, s68, s25
    s_lshl_b32 s24, s24, 5
    s_add_u32 s68, s68, s24
    v_lshrrev_b32 v2, 4, v176
    v_lshlrev_b32 v2, 10, v2
    v_and_b32 v3, 15, v176
    v_lshl_add_u32 v2, v3, 1, v2
    v_add_u32 v2, s68, v2
    v_add_u32 v3, 8192, v2
    v_mov_b32 v4, 0
    v_mov_b32 v5, 0
    v_mov_b32 v6, 0
    v_mov_b32 v7, 0
    global_load_ushort v108, v2, s[66:67] offset:0
    global_load_short_d16_hi v4, v3, s[66:67] offset:0
    global_load_ushort v109, v2, s[66:67] offset:256
    global_load_short_d16_hi v5, v3, s[66:67] offset:256
    global_load_ushort v110, v2, s[66:67] offset:512
    global_load_short_d16_hi v6, v3, s[66:67] offset:512
    global_load_ushort v111, v2, s[66:67] offset:768
    global_load_short_d16_hi v7, v3, s[66:67] offset:768
    s_add_u32 s22, s22, 1
    s_waitcnt vmcnt(0)
    v_or_b32 v108, v108, v4
    v_or_b32 v109, v109, v5
    v_or_b32 v110, v110, v6
    v_or_b32 v111, v111, v7
    s_mul_i32 s24, s22, 3277
    s_lshr_b32 s24, s24, 16
    s_mul_i32 s68, s24, 20
    s_sub_u32 s68, s22, s68
    s_cmp_lt_u32 s68, 8
    s_cselect_b64 s[66:67], s[84:85], s[86:87]
    s_cselect_b32 s25, 0, 8
    s_sub_u32 s68, s68, s25
    s_and_b32 s25, s68, 1
    s_lshr_b32 s68, s68, 1
    s_lshl_b32 s68, s68, 14
    s_lshl_b32 s25, s25, 12
    s_add_u32 s68, s68, s25
    s_lshl_b32 s24, s24, 5
    s_add_u32 s68, s68, s24
    v_lshrrev_b32 v2, 4, v176
    v_lshlrev_b32 v2, 10, v2
    v_and_b32 v3, 15, v176
    v_lshl_add_u32 v2, v3, 1, v2
    v_add_u32 v2, s68, v2
    v_add_u32 v3, 8192, v2
    v_mov_b32 v4, 0
    v_mov_b32 v5, 0
    v_mov_b32 v6, 0
    v_mov_b32 v7, 0
    global_load_ushort v112, v2, s[66:67] offset:0
    global_load_short_d16_hi v4, v3, s[66:67] offset:0
    global_load_ushort v113, v2, s[66:67] offset:256
    global_load_short_d16_hi v5, v3, s[66:67] offset:256
    global_load_ushort v114, v2, s[66:67] offset:512
    global_load_short_d16_hi v6, v3, s[66:67] offset:512
    global_load_ushort v115, v2, s[66:67] offset:768
    global_load_short_d16_hi v7, v3, s[66:67] offset:768
    s_add_u32 s22, s22, 1
    s_waitcnt vmcnt(0)
    v_or_b32 v112, v112, v4
    v_or_b32 v113, v113, v5
    v_or_b32 v114, v114, v6
    v_or_b32 v115, v115, v7
    s_mul_i32 s24, s22, 3277
    s_lshr_b32 s24, s24, 16
    s_mul_i32 s68, s24, 20
    s_sub_u32 s68, s22, s68
    s_cmp_lt_u32 s68, 8
    s_cselect_b64 s[66:67], s[84:85], s[86:87]
    s_cselect_b32 s25, 0, 8
    s_sub_u32 s68, s68, s25
    s_and_b32 s25, s68, 1
    s_lshr_b32 s68, s68, 1
    s_lshl_b32 s68, s68, 14
    s_lshl_b32 s25, s25, 12
    s_add_u32 s68, s68, s25
    s_lshl_b32 s24, s24, 5
    s_add_u32 s68, s68, s24
    v_lshrrev_b32 v2, 4, v176
    v_lshlrev_b32 v2, 10, v2
    v_and_b32 v3, 15, v176
    v_lshl_add_u32 v2, v3, 1, v2
    v_add_u32 v2, s68, v2
    v_add_u32 v3, 8192, v2
    v_mov_b32 v4, 0
    v_mov_b32 v5, 0
    v_mov_b32 v6, 0
    v_mov_b32 v7, 0
    global_load_ushort v116, v2, s[66:67] offset:0
    global_load_short_d16_hi v4, v3, s[66:67] offset:0
    global_load_ushort v117, v2, s[66:67] offset:256
    global_load_short_d16_hi v5, v3, s[66:67] offset:256
    global_load_ushort v118, v2, s[66:67] offset:512
    global_load_short_d16_hi v6, v3, s[66:67] offset:512
    global_load_ushort v119, v2, s[66:67] offset:768
    global_load_short_d16_hi v7, v3, s[66:67] offset:768
    s_add_u32 s22, s22, 1
    s_waitcnt vmcnt(0)
    v_or_b32 v116, v116, v4
    v_or_b32 v117, v117, v5
    v_or_b32 v118, v118, v6
    v_or_b32 v119, v119, v7
    s_mul_i32 s24, s22, 3277
    s_lshr_b32 s24, s24, 16
    s_mul_i32 s68, s24, 20
    s_sub_u32 s68, s22, s68
    s_cmp_lt_u32 s68, 8
    s_cselect_b64 s[66:67], s[84:85], s[86:87]
    s_cselect_b32 s25, 0, 8
    s_sub_u32 s68, s68, s25
    s_and_b32 s25, s68, 1
    s_lshr_b32 s68, s68, 1
    s_lshl_b32 s68, s68, 14
    s_lshl_b32 s25, s25, 12
    s_add_u32 s68, s68, s25
    s_lshl_b32 s24, s24, 5
    s_add_u32 s68, s68, s24
    v_lshrrev_b32 v2, 4, v176
    v_lshlrev_b32 v2, 10, v2
    v_and_b32 v3, 15, v176
    v_lshl_add_u32 v2, v3, 1, v2
    v_add_u32 v2, s68, v2
    v_add_u32 v3, 8192, v2
    v_mov_b32 v4, 0
    v_mov_b32 v5, 0
    v_mov_b32 v6, 0
    v_mov_b32 v7, 0
    global_load_ushort v120, v2, s[66:67] offset:0
    global_load_short_d16_hi v4, v3, s[66:67] offset:0
    global_load_ushort v121, v2, s[66:67] offset:256
    global_load_short_d16_hi v5, v3, s[66:67] offset:256
    global_load_ushort v122, v2, s[66:67] offset:512
    global_load_short_d16_hi v6, v3, s[66:67] offset:512
    global_load_ushort v123, v2, s[66:67] offset:768
    global_load_short_d16_hi v7, v3, s[66:67] offset:768
    s_add_u32 s22, s22, 1
    s_waitcnt vmcnt(0)
    v_or_b32 v120, v120, v4
    v_or_b32 v121, v121, v5
    v_or_b32 v122, v122, v6
    v_or_b32 v123, v123, v7
    s_mul_i32 s24, s22, 3277
    s_lshr_b32 s24, s24, 16
    s_mul_i32 s68, s24, 20
    s_sub_u32 s68, s22, s68
    s_cmp_lt_u32 s68, 8
    s_cselect_b64 s[66:67], s[84:85], s[86:87]
    s_cselect_b32 s25, 0, 8
    s_sub_u32 s68, s68, s25
    s_and_b32 s25, s68, 1
    s_lshr_b32 s68, s68, 1
    s_lshl_b32 s68, s68, 14
    s_lshl_b32 s25, s25, 12
    s_add_u32 s68, s68, s25
    s_lshl_b32 s24, s24, 5
    s_add_u32 s68, s68, s24
    v_lshrrev_b32 v2, 4, v176
    v_lshlrev_b32 v2, 10, v2
    v_and_b32 v3, 15, v176
    v_lshl_add_u32 v2, v3, 1, v2
    v_add_u32 v2, s68, v2
    v_add_u32 v3, 8192, v2
    v_mov_b32 v4, 0
    v_mov_b32 v5, 0
    v_mov_b32 v6, 0
    v_mov_b32 v7, 0
    global_load_ushort v124, v2, s[66:67] offset:0
    global_load_short_d16_hi v4, v3, s[66:67] offset:0
    global_load_ushort v125, v2, s[66:67] offset:256
    global_load_short_d16_hi v5, v3, s[66:67] offset:256
    global_load_ushort v126, v2, s[66:67] offset:512
    global_load_short_d16_hi v6, v3, s[66:67] offset:512
    global_load_ushort v127, v2, s[66:67] offset:768
    global_load_short_d16_hi v7, v3, s[66:67] offset:768
    s_add_u32 s22, s22, 1
    s_waitcnt vmcnt(0)
    v_or_b32 v124, v124, v4
    v_or_b32 v125, v125, v5
    v_or_b32 v126, v126, v6
    v_or_b32 v127, v127, v7
    s_mul_i32 s24, s22, 3277
    s_lshr_b32 s24, s24, 16
    s_mul_i32 s68, s24, 20
    s_sub_u32 s68, s22, s68
    s_cmp_lt_u32 s68, 8
    s_cselect_b64 s[66:67], s[84:85], s[86:87]
    s_cselect_b32 s25, 0, 8
    s_sub_u32 s68, s68, s25
    s_and_b32 s25, s68, 1
    s_lshr_b32 s68, s68, 1
    s_lshl_b32 s68, s68, 14
    s_lshl_b32 s25, s25, 12
    s_add_u32 s68, s68, s25
    s_lshl_b32 s24, s24, 5
    s_add_u32 s68, s68, s24
    v_lshrrev_b32 v2, 4, v176
    v_lshlrev_b32 v2, 10, v2
    v_and_b32 v3, 15, v176
    v_lshl_add_u32 v2, v3, 1, v2
    v_add_u32 v2, s68, v2
    v_add_u32 v3, 8192, v2
    v_mov_b32 v4, 0
    v_mov_b32 v5, 0
    v_mov_b32 v6, 0
    v_mov_b32 v7, 0
    global_load_ushort v128, v2, s[66:67] offset:0
    global_load_short_d16_hi v4, v3, s[66:67] offset:0
    global_load_ushort v129, v2, s[66:67] offset:256
    global_load_short_d16_hi v5, v3, s[66:67] offset:256
    global_load_ushort v130, v2, s[66:67] offset:512
    global_load_short_d16_hi v6, v3, s[66:67] offset:512
    global_load_ushort v131, v2, s[66:67] offset:768
    global_load_short_d16_hi v7, v3, s[66:67] offset:768
    s_add_u32 s22, s22, 1
    s_waitcnt vmcnt(0)
    v_or_b32 v128, v128, v4
    v_or_b32 v129, v129, v5
    v_or_b32 v130, v130, v6
    v_or_b32 v131, v131, v7
    s_mul_i32 s24, s22, 3277
    s_lshr_b32 s24, s24, 16
    s_mul_i32 s68, s24, 20
    s_sub_u32 s68, s22, s68
    s_cmp_lt_u32 s68, 8
    s_cselect_b64 s[66:67], s[84:85], s[86:87]
    s_cselect_b32 s25, 0, 8
    s_sub_u32 s68, s68, s25
    s_and_b32 s25, s68, 1
    s_lshr_b32 s68, s68, 1
    s_lshl_b32 s68, s68, 14
    s_lshl_b32 s25, s25, 12
    s_add_u32 s68, s68, s25
    s_lshl_b32 s24, s24, 5
    s_add_u32 s68, s68, s24
    v_lshrrev_b32 v2, 4, v176
    v_lshlrev_b32 v2, 10, v2
    v_and_b32 v3, 15, v176
    v_lshl_add_u32 v2, v3, 1, v2
    v_add_u32 v2, s68, v2
    v_add_u32 v3, 8192, v2
    v_mov_b32 v4, 0
    v_mov_b32 v5, 0
    v_mov_b32 v6, 0
    v_mov_b32 v7, 0
    global_load_ushort v132, v2, s[66:67] offset:0
    global_load_short_d16_hi v4, v3, s[66:67] offset:0
    global_load_ushort v133, v2, s[66:67] offset:256
    global_load_short_d16_hi v5, v3, s[66:67] offset:256
    global_load_ushort v134, v2, s[66:67] offset:512
    global_load_short_d16_hi v6, v3, s[66:67] offset:512
    global_load_ushort v135, v2, s[66:67] offset:768
    global_load_short_d16_hi v7, v3, s[66:67] offset:768
    s_add_u32 s22, s22, 1
    s_waitcnt vmcnt(0)
    v_or_b32 v132, v132, v4
    v_or_b32 v133, v133, v5
    v_or_b32 v134, v134, v6
    v_or_b32 v135, v135, v7
    s_mul_i32 s24, s22, 3277
    s_lshr_b32 s24, s24, 16
    s_mul_i32 s68, s24, 20
    s_sub_u32 s68, s22, s68
    s_cmp_lt_u32 s68, 8
    s_cselect_b64 s[66:67], s[84:85], s[86:87]
    s_cselect_b32 s25, 0, 8
    s_sub_u32 s68, s68, s25
    s_and_b32 s25, s68, 1
    s_lshr_b32 s68, s68, 1
    s_lshl_b32 s68, s68, 14
    s_lshl_b32 s25, s25, 12
    s_add_u32 s68, s68, s25
    s_lshl_b32 s24, s24, 5
    s_add_u32 s68, s68, s24
    v_lshrrev_b32 v2, 4, v176
    v_lshlrev_b32 v2, 10, v2
    v_and_b32 v3, 15, v176
    v_lshl_add_u32 v2, v3, 1, v2
    v_add_u32 v2, s68, v2
    v_add_u32 v3, 8192, v2
    v_mov_b32 v4, 0
    v_mov_b32 v5, 0
    v_mov_b32 v6, 0
    v_mov_b32 v7, 0
    global_load_ushort v136, v2, s[66:67] offset:0
    global_load_short_d16_hi v4, v3, s[66:67] offset:0
    global_load_ushort v137, v2, s[66:67] offset:256
    global_load_short_d16_hi v5, v3, s[66:67] offset:256
    global_load_ushort v138, v2, s[66:67] offset:512
    global_load_short_d16_hi v6, v3, s[66:67] offset:512
    global_load_ushort v139, v2, s[66:67] offset:768
    global_load_short_d16_hi v7, v3, s[66:67] offset:768
    s_add_u32 s22, s22, 1
    s_waitcnt vmcnt(0)
    v_or_b32 v136, v136, v4
    v_or_b32 v137, v137, v5
    v_or_b32 v138, v138, v6
    v_or_b32 v139, v139, v7
    s_mul_i32 s24, s22, 3277
    s_lshr_b32 s24, s24, 16
    s_mul_i32 s68, s24, 20
    s_sub_u32 s68, s22, s68
    s_cmp_lt_u32 s68, 8
    s_cselect_b64 s[66:67], s[84:85], s[86:87]
    s_cselect_b32 s25, 0, 8
    s_sub_u32 s68, s68, s25
    s_and_b32 s25, s68, 1
    s_lshr_b32 s68, s68, 1
    s_lshl_b32 s68, s68, 14
    s_lshl_b32 s25, s25, 12
    s_add_u32 s68, s68, s25
    s_lshl_b32 s24, s24, 5
    s_add_u32 s68, s68, s24
    v_lshrrev_b32 v2, 4, v176
    v_lshlrev_b32 v2, 10, v2
    v_and_b32 v3, 15, v176
    v_lshl_add_u32 v2, v3, 1, v2
    v_add_u32 v2, s68, v2
    v_add_u32 v3, 8192, v2
    v_mov_b32 v4, 0
    v_mov_b32 v5, 0
    v_mov_b32 v6, 0
    v_mov_b32 v7, 0
    global_load_ushort v140, v2, s[66:67] offset:0
    global_load_short_d16_hi v4, v3, s[66:67] offset:0
    global_load_ushort v141, v2, s[66:67] offset:256
    global_load_short_d16_hi v5, v3, s[66:67] offset:256
    global_load_ushort v142, v2, s[66:67] offset:512
    global_load_short_d16_hi v6, v3, s[66:67] offset:512
    global_load_ushort v143, v2, s[66:67] offset:768
    global_load_short_d16_hi v7, v3, s[66:67] offset:768
    s_add_u32 s22, s22, 1
    s_waitcnt vmcnt(0)
    v_or_b32 v140, v140, v4
    v_or_b32 v141, v141, v5
    v_or_b32 v142, v142, v6
    v_or_b32 v143, v143, v7
    s_mul_i32 s24, s22, 3277
    s_lshr_b32 s24, s24, 16
    s_mul_i32 s68, s24, 20
    s_sub_u32 s68, s22, s68
    s_cmp_lt_u32 s68, 8
    s_cselect_b64 s[66:67], s[84:85], s[86:87]
    s_cselect_b32 s25, 0, 8
    s_sub_u32 s68, s68, s25
    s_and_b32 s25, s68, 1
    s_lshr_b32 s68, s68, 1
    s_lshl_b32 s68, s68, 14
    s_lshl_b32 s25, s25, 12
    s_add_u32 s68, s68, s25
    s_lshl_b32 s24, s24, 5
    s_add_u32 s68, s68, s24
    v_lshrrev_b32 v2, 4, v176
    v_lshlrev_b32 v2, 10, v2
    v_and_b32 v3, 15, v176
    v_lshl_add_u32 v2, v3, 1, v2
    v_add_u32 v2, s68, v2
    v_add_u32 v3, 8192, v2
    v_mov_b32 v4, 0
    v_mov_b32 v5, 0
    v_mov_b32 v6, 0
    v_mov_b32 v7, 0
    global_load_ushort v144, v2, s[66:67] offset:0
    global_load_short_d16_hi v4, v3, s[66:67] offset:0
    global_load_ushort v145, v2, s[66:67] offset:256
    global_load_short_d16_hi v5, v3, s[66:67] offset:256
    global_load_ushort v146, v2, s[66:67] offset:512
    global_load_short_d16_hi v6, v3, s[66:67] offset:512
    global_load_ushort v147, v2, s[66:67] offset:768
    global_load_short_d16_hi v7, v3, s[66:67] offset:768
    s_add_u32 s22, s22, 1
    s_waitcnt vmcnt(0)
    v_or_b32 v144, v144, v4
    v_or_b32 v145, v145, v5
    v_or_b32 v146, v146, v6
    v_or_b32 v147, v147, v7
    s_mul_i32 s24, s22, 3277
    s_lshr_b32 s24, s24, 16
    s_mul_i32 s68, s24, 20
    s_sub_u32 s68, s22, s68
    s_cmp_lt_u32 s68, 8
    s_cselect_b64 s[66:67], s[84:85], s[86:87]
    s_cselect_b32 s25, 0, 8
    s_sub_u32 s68, s68, s25
    s_and_b32 s25, s68, 1
    s_lshr_b32 s68, s68, 1
    s_lshl_b32 s68, s68, 14
    s_lshl_b32 s25, s25, 12
    s_add_u32 s68, s68, s25
    s_lshl_b32 s24, s24, 5
    s_add_u32 s68, s68, s24
    v_lshrrev_b32 v2, 4, v176
    v_lshlrev_b32 v2, 10, v2
    v_and_b32 v3, 15, v176
    v_lshl_add_u32 v2, v3, 1, v2
    v_add_u32 v2, s68, v2
    v_add_u32 v3, 8192, v2
    v_mov_b32 v4, 0
    v_mov_b32 v5, 0
    v_mov_b32 v6, 0
    v_mov_b32 v7, 0
    global_load_ushort v148, v2, s[66:67] offset:0
    global_load_short_d16_hi v4, v3, s[66:67] offset:0
    global_load_ushort v149, v2, s[66:67] offset:256
    global_load_short_d16_hi v5, v3, s[66:67] offset:256
    global_load_ushort v150, v2, s[66:67] offset:512
    global_load_short_d16_hi v6, v3, s[66:67] offset:512
    global_load_ushort v151, v2, s[66:67] offset:768
    global_load_short_d16_hi v7, v3, s[66:67] offset:768
    s_add_u32 s22, s22, 1
    s_waitcnt vmcnt(0)
    v_or_b32 v148, v148, v4
    v_or_b32 v149, v149, v5
    v_or_b32 v150, v150, v6
    v_or_b32 v151, v151, v7
    s_mul_i32 s24, s22, 3277
    s_lshr_b32 s24, s24, 16
    s_mul_i32 s68, s24, 20
    s_sub_u32 s68, s22, s68
    s_cmp_lt_u32 s68, 8
    s_cselect_b64 s[66:67], s[84:85], s[86:87]
    s_cselect_b32 s25, 0, 8
    s_sub_u32 s68, s68, s25
    s_and_b32 s25, s68, 1
    s_lshr_b32 s68, s68, 1
    s_lshl_b32 s68, s68, 14
    s_lshl_b32 s25, s25, 12
    s_add_u32 s68, s68, s25
    s_lshl_b32 s24, s24, 5
    s_add_u32 s68, s68, s24
    v_lshrrev_b32 v2, 4, v176
    v_lshlrev_b32 v2, 10, v2
    v_and_b32 v3, 15, v176
    v_lshl_add_u32 v2, v3, 1, v2
    v_add_u32 v2, s68, v2
    v_add_u32 v3, 8192, v2
    v_mov_b32 v4, 0
    v_mov_b32 v5, 0
    v_mov_b32 v6, 0
    v_mov_b32 v7, 0
    global_load_ushort v152, v2, s[66:67] offset:0
    global_load_short_d16_hi v4, v3, s[66:67] offset:0
    global_load_ushort v153, v2, s[66:67] offset:256
    global_load_short_d16_hi v5, v3, s[66:67] offset:256
    global_load_ushort v154, v2, s[66:67] offset:512
    global_load_short_d16_hi v6, v3, s[66:67] offset:512
    global_load_ushort v155, v2, s[66:67] offset:768
    global_load_short_d16_hi v7, v3, s[66:67] offset:768
    s_add_u32 s22, s22, 1
    s_waitcnt vmcnt(0)
    v_or_b32 v152, v152, v4
    v_or_b32 v153, v153, v5
    v_or_b32 v154, v154, v6
    v_or_b32 v155, v155, v7
    s_mul_i32 s24, s22, 3277
    s_lshr_b32 s24, s24, 16
    s_mul_i32 s68, s24, 20
    s_sub_u32 s68, s22, s68
    s_cmp_lt_u32 s68, 8
    s_cselect_b64 s[66:67], s[84:85], s[86:87]
    s_cselect_b32 s25, 0, 8
    s_sub_u32 s68, s68, s25
    s_and_b32 s25, s68, 1
    s_lshr_b32 s68, s68, 1
    s_lshl_b32 s68, s68, 14
    s_lshl_b32 s25, s25, 12
    s_add_u32 s68, s68, s25
    s_lshl_b32 s24, s24, 5
    s_add_u32 s68, s68, s24
    v_lshrrev_b32 v2, 4, v176
    v_lshlrev_b32 v2, 10, v2
    v_and_b32 v3, 15, v176
    v_lshl_add_u32 v2, v3, 1, v2
    v_add_u32 v2, s68, v2
    v_add_u32 v3, 8192, v2
    v_mov_b32 v4, 0
    v_mov_b32 v5, 0
    v_mov_b32 v6, 0
    v_mov_b32 v7, 0
    global_load_ushort v156, v2, s[66:67] offset:0
    global_load_short_d16_hi v4, v3, s[66:67] offset:0
    global_load_ushort v157, v2, s[66:67] offset:256
    global_load_short_d16_hi v5, v3, s[66:67] offset:256
    global_load_ushort v158, v2, s[66:67] offset:512
    global_load_short_d16_hi v6, v3, s[66:67] offset:512
    global_load_ushort v159, v2, s[66:67] offset:768
    global_load_short_d16_hi v7, v3, s[66:67] offset:768
    s_add_u32 s22, s22, 1
    s_waitcnt vmcnt(0)
    v_or_b32 v156, v156, v4
    v_or_b32 v157, v157, v5
    v_or_b32 v158, v158, v6
    v_or_b32 v159, v159, v7
    s_mul_i32 s24, s22, 3277
    s_lshr_b32 s24, s24, 16
    s_mul_i32 s68, s24, 20
    s_sub_u32 s68, s22, s68
    s_cmp_lt_u32 s68, 8
    s_cselect_b64 s[66:67], s[84:85], s[86:87]
    s_cselect_b32 s25, 0, 8
    s_sub_u32 s68, s68, s25
    s_and_b32 s25, s68, 1
    s_lshr_b32 s68, s68, 1
    s_lshl_b32 s68, s68, 14
    s_lshl_b32 s25, s25, 12
    s_add_u32 s68, s68, s25
    s_lshl_b32 s24, s24, 5
    s_add_u32 s68, s68, s24
    v_lshrrev_b32 v2, 4, v176
    v_lshlrev_b32 v2, 10, v2
    v_and_b32 v3, 15, v176
    v_lshl_add_u32 v2, v3, 1, v2
    v_add_u32 v2, s68, v2
    v_add_u32 v3, 8192, v2
    v_mov_b32 v4, 0
    v_mov_b32 v5, 0
    v_mov_b32 v6, 0
    v_mov_b32 v7, 0
    global_load_ushort v160, v2, s[66:67] offset:0
    global_load_short_d16_hi v4, v3, s[66:67] offset:0
    global_load_ushort v161, v2, s[66:67] offset:256
    global_load_short_d16_hi v5, v3, s[66:67] offset:256
    global_load_ushort v162, v2, s[66:67] offset:512
    global_load_short_d16_hi v6, v3, s[66:67] offset:512
    global_load_ushort v163, v2, s[66:67] offset:768
    global_load_short_d16_hi v7, v3, s[66:67] offset:768
    s_add_u32 s22, s22, 1
    s_waitcnt vmcnt(0)
    v_or_b32 v160, v160, v4
    v_or_b32 v161, v161, v5
    v_or_b32 v162, v162, v6
    v_or_b32 v163, v163, v7
    s_mul_i32 s24, s22, 3277
    s_lshr_b32 s24, s24, 16
    s_mul_i32 s68, s24, 20
    s_sub_u32 s68, s22, s68
    s_cmp_lt_u32 s68, 8
    s_cselect_b64 s[66:67], s[84:85], s[86:87]
    s_cselect_b32 s25, 0, 8
    s_sub_u32 s68, s68, s25
    s_and_b32 s25, s68, 1
    s_lshr_b32 s68, s68, 1
    s_lshl_b32 s68, s68, 14
    s_lshl_b32 s25, s25, 12
    s_add_u32 s68, s68, s25
    s_lshl_b32 s24, s24, 5
    s_add_u32 s68, s68, s24
    v_lshrrev_b32 v2, 4, v176
    v_lshlrev_b32 v2, 10, v2
    v_and_b32 v3, 15, v176
    v_lshl_add_u32 v2, v3, 1, v2
    v_add_u32 v2, s68, v2
    v_add_u32 v3, 8192, v2
    v_mov_b32 v4, 0
    v_mov_b32 v5, 0
    v_mov_b32 v6, 0
    v_mov_b32 v7, 0
    global_load_ushort v164, v2, s[66:67] offset:0
    global_load_short_d16_hi v4, v3, s[66:67] offset:0
    global_load_ushort v165, v2, s[66:67] offset:256
    global_load_short_d16_hi v5, v3, s[66:67] offset:256
    global_load_ushort v166, v2, s[66:67] offset:512
    global_load_short_d16_hi v6, v3, s[66:67] offset:512
    global_load_ushort v167, v2, s[66:67] offset:768
    global_load_short_d16_hi v7, v3, s[66:67] offset:768
    s_add_u32 s22, s22, 1
    s_waitcnt vmcnt(0)
    v_or_b32 v164, v164, v4
    v_or_b32 v165, v165, v5
    v_or_b32 v166, v166, v6
    v_or_b32 v167, v167, v7
    s_mul_i32 s24, s22, 3277
    s_lshr_b32 s24, s24, 16
    s_mul_i32 s68, s24, 20
    s_sub_u32 s68, s22, s68
    s_cmp_lt_u32 s68, 8
    s_cselect_b64 s[66:67], s[84:85], s[86:87]
    s_cselect_b32 s25, 0, 8
    s_sub_u32 s68, s68, s25
    s_and_b32 s25, s68, 1
    s_lshr_b32 s68, s68, 1
    s_lshl_b32 s68, s68, 14
    s_lshl_b32 s25, s25, 12
    s_add_u32 s68, s68, s25
    s_lshl_b32 s24, s24, 5
    s_add_u32 s68, s68, s24
    v_lshrrev_b32 v2, 4, v176
    v_lshlrev_b32 v2, 10, v2
    v_and_b32 v3, 15, v176
    v_lshl_add_u32 v2, v3, 1, v2
    v_add_u32 v2, s68, v2
    v_add_u32 v3, 8192, v2
    v_mov_b32 v4, 0
    v_mov_b32 v5, 0
    v_mov_b32 v6, 0
    v_mov_b32 v7, 0
    global_load_ushort v168, v2, s[66:67] offset:0
    global_load_short_d16_hi v4, v3, s[66:67] offset:0
    global_load_ushort v169, v2, s[66:67] offset:256
    global_load_short_d16_hi v5, v3, s[66:67] offset:256
    global_load_ushort v170, v2, s[66:67] offset:512
    global_load_short_d16_hi v6, v3, s[66:67] offset:512
    global_load_ushort v171, v2, s[66:67] offset:768
    global_load_short_d16_hi v7, v3, s[66:67] offset:768
    s_add_u32 s22, s22, 1
    s_waitcnt vmcnt(0)
    v_or_b32 v168, v168, v4
    v_or_b32 v169, v169, v5
    v_or_b32 v170, v170, v6
    v_or_b32 v171, v171, v7
    s_mul_i32 s24, s22, 3277
    s_lshr_b32 s24, s24, 16
    s_mul_i32 s68, s24, 20
    s_sub_u32 s68, s22, s68
    s_cmp_lt_u32 s68, 8
    s_cselect_b64 s[66:67], s[84:85], s[86:87]
    s_cselect_b32 s25, 0, 8
    s_sub_u32 s68, s68, s25
    s_and_b32 s25, s68, 1
    s_lshr_b32 s68, s68, 1
    s_lshl_b32 s68, s68, 14
    s_lshl_b32 s25, s25, 12
    s_add_u32 s68, s68, s25
    s_lshl_b32 s24, s24, 5
    s_add_u32 s68, s68, s24
    v_lshrrev_b32 v2, 4, v176
    v_lshlrev_b32 v2, 10, v2
    v_and_b32 v3, 15, v176
    v_lshl_add_u32 v2, v3, 1, v2
    v_add_u32 v2, s68, v2
    v_add_u32 v3, 8192, v2
    v_mov_b32 v4, 0
    v_mov_b32 v5, 0
    v_mov_b32 v6, 0
    v_mov_b32 v7, 0
    global_load_ushort v172, v2, s[66:67] offset:0
    global_load_short_d16_hi v4, v3, s[66:67] offset:0
    global_load_ushort v173, v2, s[66:67] offset:256
    global_load_short_d16_hi v5, v3, s[66:67] offset:256
    global_load_ushort v174, v2, s[66:67] offset:512
    global_load_short_d16_hi v6, v3, s[66:67] offset:512
    global_load_ushort v175, v2, s[66:67] offset:768
    global_load_short_d16_hi v7, v3, s[66:67] offset:768
    s_add_u32 s22, s22, 1
    s_waitcnt vmcnt(0)
    v_or_b32 v172, v172, v4
    v_or_b32 v173, v173, v5
    v_or_b32 v174, v174, v6
    v_or_b32 v175, v175, v7
    s_branch GEMM
.section .rodata,"a"
.p2align 6
.amdhsa_kernel standalone__tensor_product_equiv_equiformer__graph_kernel
  .amdhsa_next_free_vgpr 256
  .amdhsa_next_free_sgpr 90
  .amdhsa_accum_offset 256
  .amdhsa_group_segment_fixed_size 0
  .amdhsa_kernarg_size 96
  .amdhsa_user_sgpr_count 2
  .amdhsa_user_sgpr_kernarg_segment_ptr 1
  .amdhsa_system_sgpr_workgroup_id_x 1
.end_amdhsa_kernel
```

```asm
; @launch grid=(250,1,1) block=(512,1,1) lds=163840
.amdgcn_target "amdgcn-amd-amdhsa--gfx950"
.text
.globl standalone__tensor_product_equiv_equiformer__graph_kernel
.p2align 8
.type standalone__tensor_product_equiv_equiformer__graph_kernel,@function
standalone__tensor_product_equiv_equiformer__graph_kernel:
    s_cmp_ge_u32 s2, 250
    s_cbranch_scc1 K2_end
    s_load_dwordx16 s[72:87], s[0:1], 0
    s_load_dwordx2 s[70:71], s[0:1], 88
    v_lshrrev_b32 v2, 6, v0
    v_and_b32 v1, 63, v0
    v_readfirstlane_b32 s20, v2
    s_getpc_b64 s[66:67]
    v_lshlrev_b32 v95, 7, v1
    s_cmp_eq_u32 s20, 6
    s_cbranch_scc0 F_nopf0
    global_load_dword v95, v95, s[66:67]
F_nopf0:
    s_mul_i32 s66, s2, 5120
    s_mul_i32 s67, s2, 7680
    v_lshl_add_u32 v3, v0, 4, s66
    v_mul_u32_u24 v4, 24, v0
    v_add_u32 v4, s67, v4
    v_lshlrev_b32 v5, 2, v0
    v_mov_b32 v89, 0
    v_add_u32 v6, 98304, v5
    ds_write_b32 v6, v89
    s_cmp_ge_u32 s20, 5
    s_waitcnt lgkmcnt(0)
    s_cbranch_scc1 F_noload
    global_load_dwordx4 v[8:11], v3, s[80:81] nt
    global_load_dwordx4 v[12:15], v3, s[78:79] nt
    global_load_dwordx4 v[16:19], v4, s[74:75] nt
    global_load_dwordx2 v[20:21], v4, s[74:75] offset:16 nt
F_noload:
    s_load_dword s88, s[70:71], 0
    s_barrier
    v_lshlrev_b32 v248, 2, v1
    v_add_u32 v88, 162816, v248
    ds_write_b32 v88, v89
    ds_write_b32 v88, v89 offset:256
    v_lshlrev_b32 v86, 4, v1
    s_lshl_b32 s21, s20, 13
    v_lshrrev_b32 v6, 5, v1
    v_mul_u32_u24 v6, 5120, v6
    v_and_b32 v7, 31, v1
    v_lshl_add_u32 v6, v7, 1, v6
    s_lshr_b32 s66, s20, 2
    s_lshl_b32 s66, s66, 7
    s_and_b32 s67, s20, 3
    s_mul_i32 s67, s67, 5
    s_add_u32 s68, s67, 0
    s_lshr_b32 s24, s68, 2
    s_lshl_b32 s24, s24, 8
    s_bfe_u32 s69, s68, 0x10001
    s_lshl_b32 s69, s69, 6
    s_add_u32 s24, s24, s69
    s_and_b32 s69, s68, 1
    s_mul_i32 s69, s69, 10240
    s_add_u32 s24, s24, s69
    s_add_u32 s24, s24, s66
    s_add_u32 s68, s67, 1
    s_lshr_b32 s25, s68, 2
    s_lshl_b32 s25, s25, 8
    s_bfe_u32 s69, s68, 0x10001
    s_lshl_b32 s69, s69, 6
    s_add_u32 s25, s25, s69
    s_and_b32 s69, s68, 1
    s_mul_i32 s69, s69, 10240
    s_add_u32 s25, s25, s69
    s_add_u32 s25, s25, s66
    s_add_u32 s68, s67, 2
    s_lshr_b32 s26, s68, 2
    s_lshl_b32 s26, s26, 8
    s_bfe_u32 s69, s68, 0x10001
    s_lshl_b32 s69, s69, 6
    s_add_u32 s26, s26, s69
    s_and_b32 s69, s68, 1
    s_mul_i32 s69, s69, 10240
    s_add_u32 s26, s26, s69
    s_add_u32 s26, s26, s66
    s_add_u32 s68, s67, 3
    s_lshr_b32 s27, s68, 2
    s_lshl_b32 s27, s27, 8
    s_bfe_u32 s69, s68, 0x10001
    s_lshl_b32 s69, s69, 6
    s_add_u32 s27, s27, s69
    s_and_b32 s69, s68, 1
    s_mul_i32 s69, s69, 10240
    s_add_u32 s27, s27, s69
    s_add_u32 s27, s27, s66
    s_add_u32 s68, s67, 4
    s_lshr_b32 s28, s68, 2
    s_lshl_b32 s28, s28, 8
    s_bfe_u32 s69, s68, 0x10001
    s_lshl_b32 s69, s69, 6
    s_add_u32 s28, s28, s69
    s_and_b32 s69, s68, 1
    s_mul_i32 s69, s69, 10240
    s_add_u32 s28, s28, s69
    s_add_u32 s28, s28, s66
    v_mov_b32 v96, 0
    v_mov_b32 v97, 0
    v_mov_b32 v98, 0
    v_mov_b32 v99, 0
    v_mov_b32 v100, 0
    v_mov_b32 v101, 0
    v_mov_b32 v102, 0
    v_mov_b32 v103, 0
    v_mov_b32 v104, 0
    v_mov_b32 v105, 0
    v_mov_b32 v106, 0
    v_mov_b32 v107, 0
    v_mov_b32 v108, 0
    v_mov_b32 v109, 0
    v_mov_b32 v110, 0
    v_mov_b32 v111, 0
    v_mov_b32 v112, 0
    v_mov_b32 v113, 0
    v_mov_b32 v114, 0
    v_mov_b32 v115, 0
    v_mov_b32 v180, 0
    v_mov_b32 v181, 0
    v_mov_b32 v182, 0
    v_mov_b32 v183, 0
    s_mov_b32 s16, s70
    s_and_b32 s17, s71, 0xffff
    s_mov_b32 s18, 24165888
    s_mov_b32 s19, 0x20000
    v_lshrrev_b32 v2, 3, v1
    v_lshl_add_u32 v2, s20, 5, v2
    v_and_b32 v91, 7, v1
    v_mul_u32_u24 v94, 384, v2
    v_lshl_add_u32 v94, v91, 4, v94
    v_lshlrev_b32 v93, 2, v2
    v_add_u32 v93, 98304, v93
    v_mul_u32_u24 v92, 32000, v2
    v_lshl_add_u32 v92, v91, 4, v92
    v_mul_u32_u24 v90, 40960, v2
    s_mov_b32 s32, s82
    s_and_b32 s33, s83, 0xffff
    s_mov_b32 s34, 20480
    s_mov_b32 s35, 0x20000
    s_cmp_ge_u32 s20, 5
    s_cbranch_scc1 F_helper
    s_mov_b32 s22, 52429
    s_mov_b32 s23, 0x05040100
    s_mov_b32 s66, 98304
    s_movk_i32 s67, -40
    v_mov_b32 v7, 1
    v_add_u32 v31, 1, v5
    v_add_u32 v32, 2, v5
    v_add_u32 v33, 3, v5
    s_waitcnt vmcnt(3)
    v_mul_u32_u24 v22, s22, v8
    v_mul_u32_u24 v23, s22, v9
    v_mul_u32_u24 v24, s22, v10
    v_mul_u32_u24 v25, s22, v11
    v_lshrrev_b32 v22, 21, v22
    v_lshrrev_b32 v23, 21, v23
    v_lshrrev_b32 v24, 21, v24
    v_lshrrev_b32 v25, 21, v25
    v_lshl_add_u32 v34, v22, 2, s66
    ds_add_rtn_u32 v26, v34, v7
    v_lshl_add_u32 v35, v23, 2, s66
    ds_add_rtn_u32 v27, v35, v7
    v_lshl_add_u32 v36, v24, 2, s66
    ds_add_rtn_u32 v28, v36, v7
    v_lshl_add_u32 v37, v25, 2, s66
    ds_add_rtn_u32 v29, v37, v7
    buffer_load_short_d16_hi v96, v6, s[32:35], s24 offen offset:0
    buffer_load_short_d16_hi v97, v6, s[32:35], s24 offen offset:1280
    buffer_load_short_d16_hi v98, v6, s[32:35], s24 offen offset:2560
    buffer_load_short_d16_hi v99, v6, s[32:35], s24 offen offset:3840
    buffer_load_short_d16_hi v100, v6, s[32:35], s25 offen offset:0
    buffer_load_short_d16_hi v101, v6, s[32:35], s25 offen offset:1280
    buffer_load_short_d16_hi v102, v6, s[32:35], s25 offen offset:2560
    buffer_load_short_d16_hi v103, v6, s[32:35], s25 offen offset:3840
    buffer_load_short_d16_hi v104, v6, s[32:35], s26 offen offset:0
    buffer_load_short_d16_hi v105, v6, s[32:35], s26 offen offset:1280
    buffer_load_short_d16_hi v106, v6, s[32:35], s26 offen offset:2560
    buffer_load_short_d16_hi v107, v6, s[32:35], s26 offen offset:3840
    buffer_load_short_d16_hi v108, v6, s[32:35], s27 offen offset:0
    buffer_load_short_d16_hi v109, v6, s[32:35], s27 offen offset:1280
    buffer_load_short_d16_hi v110, v6, s[32:35], s27 offen offset:2560
    buffer_load_short_d16_hi v111, v6, s[32:35], s27 offen offset:3840
    buffer_load_short_d16_hi v112, v6, s[32:35], s28 offen offset:0
    buffer_load_short_d16_hi v113, v6, s[32:35], s28 offen offset:1280
    buffer_load_short_d16_hi v114, v6, s[32:35], s28 offen offset:2560
    buffer_load_short_d16_hi v115, v6, s[32:35], s28 offen offset:3840
    v_mad_i32_i24 v2, v22, s67, v8
    v_mul_u32_u24 v22, 384, v22
    v_lshl_or_b32 v42, v2, 11, v5
    v_mad_i32_i24 v2, v23, s67, v9
    v_mul_u32_u24 v23, 384, v23
    v_lshl_or_b32 v46, v2, 11, v31
    v_mad_i32_i24 v2, v24, s67, v10
    v_mul_u32_u24 v24, 384, v24
    v_lshl_or_b32 v50, v2, 11, v32
    v_mad_i32_i24 v2, v25, s67, v11
    v_mul_u32_u24 v25, 384, v25
    v_lshl_or_b32 v54, v2, 11, v33
    s_waitcnt vmcnt(20)
    v_mov_b32 v40, v16
    v_perm_b32 v41, v12, v17, s23
    v_alignbit_b32 v44, v18, v17, 16
    v_alignbit_b32 v45, v13, v18, 16
    v_mov_b32 v48, v19
    v_perm_b32 v49, v14, v20, s23
    v_alignbit_b32 v52, v21, v20, 16
    v_alignbit_b32 v53, v15, v21, 16
    v_xor_b32 v41, 0x8000, v41
    v_xor_b32 v45, 0x8000, v45
    v_xor_b32 v49, 0x8000, v49
    v_xor_b32 v53, 0x8000, v53
    s_waitcnt lgkmcnt(0)
    v_min_u32 v26, 23, v26
    v_lshl_add_u32 v34, v26, 4, v22
    ds_write_b128 v34, v[40:43]
    v_min_u32 v27, 23, v27
    v_lshl_add_u32 v35, v27, 4, v23
    ds_write_b128 v35, v[44:47]
    v_min_u32 v28, 23, v28
    v_lshl_add_u32 v36, v28, 4, v24
    ds_write_b128 v36, v[48:51]
    v_min_u32 v29, 23, v29
    v_lshl_add_u32 v37, v29, 4, v25
    ds_write_b128 v37, v[52:55]
    s_branch F_staged
F_helper:
    buffer_load_short_d16_hi v96, v6, s[32:35], s24 offen offset:0
    buffer_load_short_d16_hi v97, v6, s[32:35], s24 offen offset:1280
    buffer_load_short_d16_hi v98, v6, s[32:35], s24 offen offset:2560
    buffer_load_short_d16_hi v99, v6, s[32:35], s24 offen offset:3840
    buffer_load_short_d16_hi v100, v6, s[32:35], s25 offen offset:0
    buffer_load_short_d16_hi v101, v6, s[32:35], s25 offen offset:1280
    buffer_load_short_d16_hi v102, v6, s[32:35], s25 offen offset:2560
    buffer_load_short_d16_hi v103, v6, s[32:35], s25 offen offset:3840
    buffer_load_short_d16_hi v104, v6, s[32:35], s26 offen offset:0
    buffer_load_short_d16_hi v105, v6, s[32:35], s26 offen offset:1280
    buffer_load_short_d16_hi v106, v6, s[32:35], s26 offen offset:2560
    buffer_load_short_d16_hi v107, v6, s[32:35], s26 offen offset:3840
    buffer_load_short_d16_hi v108, v6, s[32:35], s27 offen offset:0
    buffer_load_short_d16_hi v109, v6, s[32:35], s27 offen offset:1280
    buffer_load_short_d16_hi v110, v6, s[32:35], s27 offen offset:2560
    buffer_load_short_d16_hi v111, v6, s[32:35], s27 offen offset:3840
    buffer_load_short_d16_hi v112, v6, s[32:35], s28 offen offset:0
    buffer_load_short_d16_hi v113, v6, s[32:35], s28 offen offset:1280
    buffer_load_short_d16_hi v114, v6, s[32:35], s28 offen offset:2560
    buffer_load_short_d16_hi v115, v6, s[32:35], s28 offen offset:3840
    s_cmp_eq_u32 s20, 6
    s_cbranch_scc0 F_nopf
    s_getpc_b64 s[66:67]
F_pc:
    s_lshr_b32 s68, s2, 3
    s_mul_i32 s68, s68, ((K2_last-F_pc)/128/31+1)*128
    v_lshl_add_u32 v2, v1, 7, s68
    v_min_u32 v2, K2_last-F_pc-4, v2
    v_cmp_gt_u32 vcc, (K2_last-F_pc)/128/31+1, v1
    s_mov_b64 exec, vcc
    global_load_dword v95, v2, s[66:67]
    s_mov_b64 exec, -1
F_nopf:
    s_cmp_eq_u32 s20, 7
    s_cbranch_scc0 F_staged
    s_cmp_lt_u32 s2, 160
    s_cbranch_scc0 F_staged
    s_mul_i32 s22, s2, 3277
    s_lshr_b32 s22, s22, 16
    s_mul_i32 s68, s22, 20
    s_sub_u32 s68, s2, s68
    s_cmp_lt_u32 s68, 8
    s_cselect_b64 s[66:67], s[84:85], s[86:87]
    s_cselect_b32 s23, 0, 8
    s_sub_u32 s68, s68, s23
    s_and_b32 s23, s68, 1
    s_lshr_b32 s68, s68, 1
    s_lshl_b32 s68, s68, 14
    s_lshl_b32 s23, s23, 12
    s_add_u32 s68, s68, s23
    s_lshl_b32 s22, s22, 5
    s_add_u32 s68, s68, s22
    v_lshrrev_b32 v2, 4, v1
    v_lshlrev_b32 v2, 10, v2
    v_and_b32 v3, 15, v1
    v_lshl_add_u32 v2, v3, 1, v2
    v_add_u32 v2, s68, v2
    v_add_u32 v3, 8192, v2
    global_load_ushort v176, v2, s[66:67] offset:0
    global_load_short_d16_hi v180, v3, s[66:67] offset:0
    global_load_ushort v177, v2, s[66:67] offset:256
    global_load_short_d16_hi v181, v3, s[66:67] offset:256
    global_load_ushort v178, v2, s[66:67] offset:512
    global_load_short_d16_hi v182, v3, s[66:67] offset:512
    global_load_ushort v179, v2, s[66:67] offset:768
    global_load_short_d16_hi v183, v3, s[66:67] offset:768
F_staged:
    s_lshl_b32 s66, s2, 7
    s_add_u32 s66, s66, 164864
    s_cmp_eq_u32 s20, 7
    s_cselect_b32 s22, 0xffff, -1
    s_cselect_b32 s23, 0, -1
    s_waitcnt lgkmcnt(0)
    s_add_u32 s88, s88, 1
    s_barrier
    ds_read_b32 v40, v93 offset:0
    ds_read_b128 v[8:11], v94 offset:0
    ds_read_b128 v[12:15], v94 offset:128
    ds_read_b32 v41, v93 offset:32
    ds_read_b128 v[16:19], v94 offset:3072
    ds_read_b128 v[20:23], v94 offset:3200
    ds_read_b32 v42, v93 offset:64
    ds_read_b128 v[24:27], v94 offset:6144
    ds_read_b128 v[28:31], v94 offset:6272
    ds_read_b32 v43, v93 offset:96
    ds_read_b128 v[32:35], v94 offset:9216
    ds_read_b128 v[36:39], v94 offset:9344
    s_waitcnt vmcnt(0)
    s_waitcnt lgkmcnt(9)
    v_min_u32 v5, 31, v40
    v_bfe_u32 v6, v14, 11, 6
    v_and_b32 v10, 0x1ffff, v10
    v_lshl_or_b32 v6, v5, 6, v6
    v_mov_b32 v11, s88
    v_lshl_or_b32 v10, v6, 17, v10
    v_mov_b32 v15, s88
    buffer_store_dwordx4 v[8:11], v92, s[16:19], s66 offen sc1
    v_cmp_lt_u32 vcc, 8, v40
    s_add_u32 s67, s66, 8000000
    s_mov_b64 exec, vcc
    s_cbranch_execz F_w0
    buffer_store_dwordx4 v[12:15], v92, s[16:19], s67 offen sc1
    v_cmp_lt_u32 vcc, 16, v40
    s_add_u32 s67, s67, 8000000
    s_mov_b64 exec, vcc
    s_cbranch_execz F_w0
    ds_read_b128 v[44:47], v94 offset:256
    s_waitcnt lgkmcnt(0)
    v_mov_b32 v47, s88
    buffer_store_dwordx4 v[44:47], v92, s[16:19], s67 offen sc1
    s_nop 1
F_w0:
    s_mov_b64 exec, -1
    s_add_u32 s66, s66, 256000
    s_waitcnt lgkmcnt(6)
    v_min_u32 v5, 31, v41
    v_bfe_u32 v6, v22, 11, 6
    v_and_b32 v18, 0x1ffff, v18
    v_lshl_or_b32 v6, v5, 6, v6
    v_mov_b32 v19, s88
    v_lshl_or_b32 v18, v6, 17, v18
    v_mov_b32 v23, s88
    buffer_store_dwordx4 v[16:19], v92, s[16:19], s66 offen sc1
    v_cmp_lt_u32 vcc, 8, v41
    s_add_u32 s67, s66, 8000000
    s_mov_b64 exec, vcc
    s_cbranch_execz F_w1
    buffer_store_dwordx4 v[20:23], v92, s[16:19], s67 offen sc1
    v_cmp_lt_u32 vcc, 16, v41
    s_add_u32 s67, s67, 8000000
    s_mov_b64 exec, vcc
    s_cbranch_execz F_w1
    ds_read_b128 v[44:47], v94 offset:3328
    s_waitcnt lgkmcnt(0)
    v_mov_b32 v47, s88
    buffer_store_dwordx4 v[44:47], v92, s[16:19], s67 offen sc1
    s_nop 1
F_w1:
    s_mov_b64 exec, -1
    s_add_u32 s66, s66, 256000
    s_waitcnt lgkmcnt(3)
    v_min_u32 v5, 31, v42
    v_bfe_u32 v6, v30, 11, 6
    v_and_b32 v26, 0x1ffff, v26
    v_lshl_or_b32 v6, v5, 6, v6
    v_mov_b32 v27, s88
    v_lshl_or_b32 v26, v6, 17, v26
    v_mov_b32 v31, s88
    buffer_store_dwordx4 v[24:27], v92, s[16:19], s66 offen sc1
    v_cmp_lt_u32 vcc, 8, v42
    s_add_u32 s67, s66, 8000000
    s_mov_b64 exec, vcc
    s_cbranch_execz F_w2
    buffer_store_dwordx4 v[28:31], v92, s[16:19], s67 offen sc1
    v_cmp_lt_u32 vcc, 16, v42
    s_add_u32 s67, s67, 8000000
    s_mov_b64 exec, vcc
    s_cbranch_execz F_w2
    ds_read_b128 v[44:47], v94 offset:6400
    s_waitcnt lgkmcnt(0)
    v_mov_b32 v47, s88
    buffer_store_dwordx4 v[44:47], v92, s[16:19], s67 offen sc1
    s_nop 1
F_w2:
    s_mov_b64 exec, -1
    s_add_u32 s66, s66, 256000
    s_waitcnt lgkmcnt(0)
    v_min_u32 v5, 31, v43
    v_bfe_u32 v6, v38, 11, 6
    v_and_b32 v34, 0x1ffff, v34
    v_lshl_or_b32 v6, v5, 6, v6
    v_mov_b32 v35, s88
    v_lshl_or_b32 v34, v6, 17, v34
    v_mov_b32 v39, s88
    s_mov_b64 exec, s[22:23]
    buffer_store_dwordx4 v[32:35], v92, s[16:19], s66 offen sc1
    v_cmp_lt_u32 vcc, 8, v43
    s_add_u32 s67, s66, 8000000
    s_mov_b64 exec, vcc
    s_cbranch_execz F_w3
    buffer_store_dwordx4 v[36:39], v92, s[16:19], s67 offen sc1
    v_cmp_lt_u32 vcc, 16, v43
    s_add_u32 s67, s67, 8000000
    s_mov_b64 exec, vcc
    s_cbranch_execz F_w3
    ds_read_b128 v[44:47], v94 offset:9472
    s_waitcnt lgkmcnt(0)
    v_mov_b32 v47, s88
    buffer_store_dwordx4 v[44:47], v92, s[16:19], s67 offen sc1
    s_nop 1
F_w3:
    s_mov_b64 exec, -1
    s_cmp_eq_u32 s20, 7
    s_cbranch_scc0 F_nofrag
    s_cmp_lt_u32 s2, 160
    s_cbranch_scc0 F_nofrag
    v_or_b32 v176, v176, v180
    v_or_b32 v177, v177, v181
    v_or_b32 v178, v178, v182
    v_or_b32 v179, v179, v183
    s_lshl_b32 s66, s2, 10
    s_add_u32 s66, s66, 1024
    buffer_store_dwordx4 v[176:179], v86, s[16:19], s66 offen sc1
F_nofrag:
    s_barrier
    s_mul_i32 s24, s2, 32000
    s_lshl_b32 s25, s20, 12
    s_add_u32 s24, s24, s25
    s_add_u32 s24, s24, 164864
    s_add_u32 s25, s24, 8000000
    s_add_u32 s26, s25, 8000000
    v_mov_b32 v22, 0
    v_mov_b32 v23, s88
    s_mul_i32 s68, s20, 5120
    s_cmp_ge_u32 s20, 4
    s_cselect_b32 s70, 45056, 0
    s_add_u32 s68, s68, s70
    v_add_u32 v2, s68, v86
    ds_write_b128 v2, v[96:99] offset:0
    ds_write_b128 v2, v[100:103] offset:1024
    ds_write_b128 v2, v[104:107] offset:2048
    ds_write_b128 v2, v[108:111] offset:3072
    ds_write_b128 v2, v[112:115] offset:4096
    v_mov_b32 v4, 2130738944
    v_mov_b32 v5, 2130738944
    v_mov_b32 v6, 2130738944
    v_mov_b32 v7, 2130738944
    v_lshlrev_b32 v2, 4, v0
    v_add_u32 v3, 86016, v2
    ds_write_b128 v3, v[4:7] offset:0
    ds_write_b128 v3, v[4:7] offset:8192
    ds_write_b128 v3, v[4:7] offset:16384
    ds_write_b128 v3, v[4:7] offset:24576
    ds_write_b128 v3, v[4:7] offset:32768
    ds_write_b128 v3, v[4:7] offset:40960
    ds_write_b128 v3, v[4:7] offset:49152
    ds_write_b128 v3, v[4:7] offset:57344
    v_add_u32 v3, 0x10000, v3
    ds_write_b128 v3, v[4:7] offset:0
    v_min_u32 v2, 3056, v2
    v_add_u32 v2, 159744, v2
    ds_write_b128 v2, v[4:7]
    s_sub_u32 s72, s72, 128
    s_subb_u32 s73, s73, 0
    s_mov_b32 s4, s72
    s_and_b32 s5, s73, 0xffff
    s_mov_b32 s6, 10240000
    s_mov_b32 s7, 0x20000
    s_sub_u32 s72, s72, 1024
    s_subb_u32 s73, s73, 0
    s_mov_b32 s8, s72
    s_and_b32 s9, s73, 0xffff
    s_mov_b32 s10, 10241024
    s_mov_b32 s11, 0x20000
    s_mov_b32 s12, s76
    s_and_b32 s13, s77, 0xffff
    s_mov_b32 s14, 10240000
    s_mov_b32 s15, 0x20000
    v_lshrrev_b32 v2, 5, v1
    v_bfe_u32 v3, v1, 2, 2
    v_and_b32 v4, 3, v1
    v_bfe_u32 v5, v1, 4, 1
    v_lshlrev_b32 v6, 9, v2
    v_lshl_add_u32 v6, v3, 7, v6
    v_lshl_add_u32 v6, v5, 5, v6
    v_lshl_add_u32 v6, v4, 3, v6
    v_lshrrev_b32 v7, 1, v3
    v_lshl_add_u32 v6, v7, 6, v6
    v_add_u32 v244, s21, v6
    v_xor_b32 v245, 64, v244
    v_lshlrev_b32 v6, 7, v2
    v_lshl_add_u32 v6, v7, 5, v6
    v_and_b32 v7, 1, v3
    v_xor_b32 v7, 1, v7
    v_mul_u32_u24 v7, 90112, v7
    v_add_u32 v6, v6, v7
    v_lshl_add_u32 v249, v4, 3, v6
    v_lshl_add_u32 v6, v2, 2, v4
    v_bfe_u32 v7, v1, 2, 1
    v_lshl_add_u32 v6, v7, 3, v6
    v_lshlrev_b32 v6, 3, v6
    v_bfe_u32 v7, v1, 3, 1
    v_add_u32 v5, 1, v5
    v_mul_u32_u24 v7, v7, v5
    v_lshl_add_u32 v250, v7, 1, v6
    v_and_b32 v6, 0x38, v1
    v_add_u32 v247, 6, v6
    v_lshrrev_b32 v6, 2, v1
    v_lshrrev_b32 v7, 4, v1
    v_xor_b32 v6, v6, v7
    v_and_b32 v6, 1, v6
    v_lshlrev_b32 v6, 6, v6
    v_lshl_add_u32 v246, v4, 4, v6
    v_mov_b32 v242, 1.0
    v_mov_b32 v243, 1.0
    s_mov_b32 s54, 0xffffff00
    s_mov_b32 s55, 0xffffff00
    s_mov_b32 s56, 0xffff
    s_mov_b32 s57, 0xffff
    s_mov_b32 s58, 0
    s_mov_b32 s59, 134217856
    s_mov_b32 s60, 262272
    s_mov_b32 s61, 402915456
    s_mov_b32 s62, 940179840
    s_mov_b32 s63, 403046528
    s_mov_b32 s64, 402784384
    s_mov_b32 s65, 134348928
    s_mov_b32 s38, 128
    s_mov_b32 s33, -1
    s_and_b32 s68, s20, 3
    s_lshl_b32 s68, s68, 2
    s_lshr_b32 s69, s20, 2
    s_add_u32 s68, s68, s69
    s_lshl_b32 s68, s68, 4
    s_add_u32 s68, s68, 163072
    v_mov_b32 v251, s68
    s_mov_b32 s53, 0
    s_mov_b32 s50, 0
    s_mov_b32 s51, 0
    s_mov_b32 s47, 0
    s_mov_b32 s42, 0
    s_mov_b32 s3, 0
    s_mov_b32 s89, 0
    s_mov_b32 s34, 128
    s_mov_b32 s35, 384
    s_mov_b32 s36, 640
    s_mov_b32 s37, 896
    s_movk_i32 s3, 1024
    s_waitcnt lgkmcnt(0)
    s_barrier
    buffer_load_dwordx4 v[8:11], v86, s[16:19], s24 offen offset:0 sc1
    buffer_load_dwordx4 v[12:15], v86, s[16:19], s24 offen offset:1024 sc1
    buffer_load_dwordx4 v[16:19], v86, s[16:19], s24 offen offset:2048 sc1
    s_mov_b64 exec, s[22:23]
    buffer_load_dwordx4 v[20:23], v86, s[16:19], s24 offen offset:3072 sc1
    s_mov_b64 exec, -1
    ds_read_b128 v[96:99], v86 offset:0
    ds_read_b128 v[100:103], v86 offset:1024
    ds_read_b128 v[104:107], v86 offset:2048
    ds_read_b128 v[108:111], v86 offset:3072
    ds_read_b128 v[112:115], v86 offset:4096
    ds_read_b128 v[116:119], v86 offset:5120
    ds_read_b128 v[120:123], v86 offset:6144
    ds_read_b128 v[124:127], v86 offset:7168
    ds_read_b128 v[128:131], v86 offset:8192
    ds_read_b128 v[132:135], v86 offset:9216
    ds_read_b128 v[136:139], v86 offset:10240
    ds_read_b128 v[140:143], v86 offset:11264
    ds_read_b128 v[144:147], v86 offset:12288
    ds_read_b128 v[148:151], v86 offset:13312
    ds_read_b128 v[152:155], v86 offset:14336
    ds_read_b128 v[156:159], v86 offset:15360
    ds_read_b128 v[160:163], v86 offset:16384
    ds_read_b128 v[164:167], v86 offset:17408
    ds_read_b128 v[168:171], v86 offset:18432
    ds_read_b128 v[172:175], v86 offset:19456
    s_mov_b32 s27, 32768
    s_mov_b32 s71, 162816
    v_mov_b32 v3, 1
    s_cmp_eq_u32 s20, 7
    s_cselect_b32 s52, 160, 0
    v_cmp_gt_u32 s[68:69], 40, v1
    s_lshr_b32 s66, s2, 3
    s_lshl_b32 s66, s66, 3
    s_add_u32 s66, s66, s20
    s_mul_i32 s66, s66, 40
    v_min_u32 v93, 39, v1
    v_add_u32 v93, s66, v93
    v_lshlrev_b32 v93, 10, v93
F_poll:
    s_waitcnt vmcnt(0)
    v_cmp_ne_u32 s[72:73], s88, v11
    v_cmp_ne_u32 s[74:75], s88, v15
    v_cmp_ne_u32 s[76:77], s88, v19
    v_cmp_ne_u32 s[78:79], s88, v23
    s_or_b64 s[80:81], s[72:73], s[74:75]
    s_or_b64 s[82:83], s[76:77], s[78:79]
    s_or_b64 s[80:81], s[80:81], s[82:83]
    s_cbranch_scc1 F_again
F_got:
    v_bfe_u32 v2, v10, 23, 5
    v_bfe_u32 v60, v10, 11, 6
    v_cmp_gt_u32 s[80:81], v2, v91
    v_lshl_add_u32 v60, v60, 2, s71
    v_cmp_lt_u32 s[72:73], 8, v2
    v_max_u32 v89, v89, v2
    s_mov_b64 exec, s[80:81]
    ds_add_rtn_u32 v72, v60, v3
    s_mov_b64 exec, s[72:73]
    s_cbranch_execz F_h0
    buffer_load_dwordx4 v[24:27], v86, s[16:19], s25 offen offset:0 sc1
    v_sub_u32 v56, v2, v91
    v_bfe_u32 v64, v10, 17, 6
    v_cmp_lt_u32 vcc, 8, v56
    v_lshl_add_u32 v64, v64, 2, s71
    s_mov_b64 exec, vcc
    ds_add_rtn_u32 v76, v64, v3
F_h0:
    s_mov_b64 exec, -1
    v_bfe_u32 v2, v14, 23, 5
    v_bfe_u32 v61, v14, 11, 6
    v_cmp_gt_u32 s[82:83], v2, v91
    v_lshl_add_u32 v61, v61, 2, s71
    v_cmp_lt_u32 s[74:75], 8, v2
    v_max_u32 v89, v89, v2
    s_mov_b64 exec, s[82:83]
    ds_add_rtn_u32 v73, v61, v3
    s_mov_b64 exec, s[74:75]
    s_cbranch_execz F_h1
    buffer_load_dwordx4 v[28:31], v86, s[16:19], s25 offen offset:1024 sc1
    v_sub_u32 v57, v2, v91
    v_bfe_u32 v65, v14, 17, 6
    v_cmp_lt_u32 vcc, 8, v57
    v_lshl_add_u32 v65, v65, 2, s71
    s_mov_b64 exec, vcc
    ds_add_rtn_u32 v77, v65, v3
F_h1:
    s_mov_b64 exec, -1
    v_bfe_u32 v2, v18, 23, 5
    v_bfe_u32 v62, v18, 11, 6
    v_cmp_gt_u32 s[84:85], v2, v91
    v_lshl_add_u32 v62, v62, 2, s71
    v_cmp_lt_u32 s[76:77], 8, v2
    v_max_u32 v89, v89, v2
    s_mov_b64 exec, s[84:85]
    ds_add_rtn_u32 v74, v62, v3
    s_mov_b64 exec, s[76:77]
    s_cbranch_execz F_h2
    buffer_load_dwordx4 v[32:35], v86, s[16:19], s25 offen offset:2048 sc1
    v_sub_u32 v58, v2, v91
    v_bfe_u32 v66, v18, 17, 6
    v_cmp_lt_u32 vcc, 8, v58
    v_lshl_add_u32 v66, v66, 2, s71
    s_mov_b64 exec, vcc
    ds_add_rtn_u32 v78, v66, v3
F_h2:
    s_mov_b64 exec, -1
    v_bfe_u32 v2, v22, 23, 5
    v_bfe_u32 v63, v22, 11, 6
    v_cmp_gt_u32 s[86:87], v2, v91
    v_lshl_add_u32 v63, v63, 2, s71
    v_cmp_lt_u32 s[78:79], 8, v2
    v_max_u32 v89, v89, v2
    s_mov_b64 exec, s[86:87]
    ds_add_rtn_u32 v75, v63, v3
    s_mov_b64 exec, s[78:79]
    s_cbranch_execz F_h3
    buffer_load_dwordx4 v[36:39], v86, s[16:19], s25 offen offset:3072 sc1
    v_sub_u32 v59, v2, v91
    v_bfe_u32 v67, v22, 17, 6
    v_cmp_lt_u32 vcc, 8, v59
    v_lshl_add_u32 v67, v67, 2, s71
    s_mov_b64 exec, vcc
    ds_add_rtn_u32 v79, v67, v3
F_h3:
    s_mov_b64 exec, -1
    v_cmp_lt_u32 s[30:31], 16, v89
    s_mov_b32 s27, 262144
    s_cmp_lg_u64 s[30:31], 0
    s_cbranch_scc1 F_l3
F_l3r:
    v_and_b32 v10, 0x7ff, v10
    v_lshl_add_u32 v10, v10, 5, v90
    v_or_b32 v11, 16, v10
    v_and_b32 v14, 0x7ff, v14
    v_lshl_add_u32 v14, v14, 5, v90
    v_add_u32 v14, 327680, v14
    v_or_b32 v15, 16, v14
    v_and_b32 v18, 0x7ff, v18
    v_lshl_add_u32 v18, v18, 5, v90
    v_add_u32 v18, 655360, v18
    v_or_b32 v19, 16, v18
    v_and_b32 v22, 0x7ff, v22
    v_lshl_add_u32 v22, v22, 5, v90
    v_add_u32 v22, 983040, v22
    v_or_b32 v23, 16, v22
    s_cmp_lt_u32 s2, s52
    s_cbranch_scc1 F_flag
F_flagr:
    s_waitcnt lgkmcnt(0)
    s_barrier
    ds_read_b32 v4, v88
    buffer_load_dword v95, v93, s[4:7], 0 offen offset:128
    v_lshlrev_b32 v72, 3, v72
    v_lshlrev_b32 v73, 3, v73
    v_lshlrev_b32 v74, 3, v74
    v_lshlrev_b32 v75, 3, v75
    v_lshlrev_b32 v76, 3, v76
    v_lshlrev_b32 v77, 3, v77
    v_lshlrev_b32 v78, 3, v78
    v_lshlrev_b32 v79, 3, v79
    s_waitcnt lgkmcnt(0)
    v_add_u32 v5, 15, v4
    v_cmp_lt_u32 vcc, 64, v4
    v_lshrrev_b32 v5, 4, v5
    v_med3_u32 v5, v5, 1, 4
    v_mul_u32_u24 v6, 640, v5
    v_max_u32 v6, 1536, v6
    v_cndmask_b32 v6, 0, v6, s[68:69]
    s_cmp_lg_u64 vcc, 0
    s_cbranch_scc1 SLOW
    v_mov_b32 v7, v6
    v_add_u32 v2, 7, v4
    v_lshrrev_b32 v2, 3, v2
    v_add_u32_dpp v7, v7, v7 row_shr:1 row_mask:0xf bank_mask:0xf
    v_max_u32 v2, 2, v2
    v_cmp_eq_u32 vcc, 7, v2
    v_add_u32_dpp v7, v7, v7 row_shr:2 row_mask:0xf bank_mask:0xf
    v_lshlrev_b32 v92, 22, v5
    v_lshlrev_b32 v5, 18, v5
    v_add_u32_dpp v7, v7, v7 row_shr:4 row_mask:0xf bank_mask:0xf
    v_lshl_or_b32 v5, v1, 21, v5
    v_addc_co_u32 v2, vcc, 0, v2, vcc
    v_add_u32_dpp v7, v7, v7 row_shr:8 row_mask:0xf bank_mask:0xf
    v_lshl_or_b32 v5, v2, 28, v5
    v_med3_u32 v2, v2, 3, 6
    v_add_u32_dpp v7, v7, v7 row_bcast:15 row_mask:0xa bank_mask:0xf
    v_cndmask_b32 v2, 0, v2, s[68:69]
    v_mov_b32 v84, 63
    v_add_u32_dpp v7, v7, v7 row_bcast:31 row_mask:0xc bank_mask:0xf
    s_mov_b32 s71, 0x2000
    v_readlane_b32 s66, v7, 63
    v_sub_u32 v7, v7, v6
    v_add_u32 v7, 86016, v7
    v_lshrrev_b32 v6, 3, v7
    v_mad_u32_u24 v92, v7, s71, v92
    v_or_b32 v92, v92, v6
    ds_bpermute_b32 v60, v60, v92
    ds_bpermute_b32 v61, v61, v92
    ds_bpermute_b32 v62, v62, v92
    ds_bpermute_b32 v63, v63, v92
    ds_bpermute_b32 v64, v64, v92
    ds_bpermute_b32 v65, v65, v92
    ds_bpermute_b32 v66, v66, v92
    ds_bpermute_b32 v67, v67, v92
    v_cmp_eq_u32 vcc, 6, v2
    v_or_b32 v6, v5, v7
    s_cmp_gt_u32 s66, 76800
    s_cbranch_scc1 SLOW
    v_mbcnt_lo_u32_b32 v5, vcc_lo, 0
    v_mbcnt_hi_u32_b32 v5, vcc_hi, v5
    s_bcnt1_i32_b64 s71, vcc
    v_cndmask_b32 v84, v84, v5, vcc
    v_cmp_eq_u32 vcc, 5, v2
    v_mov_b32 v3, s71
    s_nop 0
    v_mbcnt_lo_u32_b32 v5, vcc_lo, v3
    v_mbcnt_hi_u32_b32 v5, vcc_hi, v5
    s_bcnt1_i32_b64 s71, vcc
    v_cndmask_b32 v84, v84, v5, vcc
    v_cmp_eq_u32 vcc, 4, v2
    v_add_u32 v3, s71, v3
    s_nop 0
    v_mbcnt_lo_u32_b32 v5, vcc_lo, v3
    v_mbcnt_hi_u32_b32 v5, vcc_hi, v5
    s_bcnt1_i32_b64 s71, vcc
    v_cndmask_b32 v84, v84, v5, vcc
    v_cmp_eq_u32 vcc, 3, v2
    v_add_u32 v3, s71, v3
    s_nop 0
    v_mbcnt_lo_u32_b32 v5, vcc_lo, v3
    v_mbcnt_hi_u32_b32 v5, vcc_hi, v5
    v_cndmask_b32 v84, v84, v5, vcc
    s_waitcnt lgkmcnt(7)
    v_mad_u32_u16 v2, v60, 8, v72
    v_mad_u32_u16 v3, v60, 8, v72 op_sel:[1,0,0,0]
    s_mov_b64 exec, s[80:81]
    ds_write_b64 v2, v[10:11]
    ds_write_b64 v3, v[8:9]
    s_mov_b64 exec, -1
    s_waitcnt lgkmcnt(8)
    v_mad_u32_u16 v2, v61, 8, v73
    v_mad_u32_u16 v3, v61, 8, v73 op_sel:[1,0,0,0]
    s_mov_b64 exec, s[82:83]
    ds_write_b64 v2, v[14:15]
    ds_write_b64 v3, v[12:13]
    s_mov_b64 exec, -1
    s_waitcnt lgkmcnt(9)
    v_mad_u32_u16 v2, v62, 8, v74
    v_mad_u32_u16 v3, v62, 8, v74 op_sel:[1,0,0,0]
    s_mov_b64 exec, s[84:85]
    ds_write_b64 v2, v[18:19]
    ds_write_b64 v3, v[16:17]
    s_mov_b64 exec, -1
    s_waitcnt lgkmcnt(10)
    v_mad_u32_u16 v2, v63, 8, v75
    v_mad_u32_u16 v3, v63, 8, v75 op_sel:[1,0,0,0]
    s_mov_b64 exec, s[86:87]
    ds_write_b64 v2, v[22:23]
    ds_write_b64 v3, v[20:21]
    s_mov_b64 exec, -1
    v_bfe_u32 v2, v84, 2, 1
    v_bfe_u32 v3, v84, 3, 1
    v_mul_u32_u24 v2, 3, v2
    v_lshl_or_b32 v3, v3, 2, v2
    v_xor_b32 v84, v84, v3
    v_cmp_eq_u32 vcc, s20, v84
    s_ff1_i32_b64 s67, vcc
    v_readlane_b32 s80, v6, s67
    s_waitcnt vmcnt(1) lgkmcnt(8)
    s_mov_b64 exec, s[72:73]
    s_cbranch_execz F_s0
F_sp0:
    v_cmp_ne_u32 vcc, s88, v27
    s_cbranch_vccnz F_sa0
F_sg0:
    v_cmpx_lt_u32 vcc, 8, v56
    v_and_b32 v26, 0x7ff, v26
    v_lshl_add_u32 v26, v26, 5, v90
    v_or_b32 v27, 16, v26
    v_mad_u32_u16 v2, v64, 8, v76
    v_mad_u32_u16 v3, v64, 8, v76 op_sel:[1,0,0,0]
    ds_write_b64 v2, v[26:27]
    ds_write_b64 v3, v[24:25]
F_s0:
    s_mov_b64 exec, s[74:75]
    s_cbranch_execz F_s1
F_sp1:
    v_cmp_ne_u32 vcc, s88, v31
    s_cbranch_vccnz F_sa1
F_sg1:
    v_cmpx_lt_u32 vcc, 8, v57
    v_and_b32 v30, 0x7ff, v30
    v_lshl_add_u32 v30, v30, 5, v90
    v_add_u32 v30, 327680, v30
    v_or_b32 v31, 16, v30
    v_mad_u32_u16 v2, v65, 8, v77
    v_mad_u32_u16 v3, v65, 8, v77 op_sel:[1,0,0,0]
    ds_write_b64 v2, v[30:31]
    ds_write_b64 v3, v[28:29]
F_s1:
    s_mov_b64 exec, s[76:77]
    s_cbranch_execz F_s2
F_sp2:
    v_cmp_ne_u32 vcc, s88, v35
    s_cbranch_vccnz F_sa2
F_sg2:
    v_cmpx_lt_u32 vcc, 8, v58
    v_and_b32 v34, 0x7ff, v34
    v_lshl_add_u32 v34, v34, 5, v90
    v_add_u32 v34, 655360, v34
    v_or_b32 v35, 16, v34
    v_mad_u32_u16 v2, v66, 8, v78
    v_mad_u32_u16 v3, v66, 8, v78 op_sel:[1,0,0,0]
    ds_write_b64 v2, v[34:35]
    ds_write_b64 v3, v[32:33]
F_s2:
    s_mov_b64 exec, s[78:79]
    s_cbranch_execz F_s3
F_sp3:
    v_cmp_ne_u32 vcc, s88, v39
    s_cbranch_vccnz F_sa3
F_sg3:
    v_cmpx_lt_u32 vcc, 8, v59
    v_and_b32 v38, 0x7ff, v38
    v_lshl_add_u32 v38, v38, 5, v90
    v_add_u32 v38, 983040, v38
    v_or_b32 v39, 16, v38
    v_mad_u32_u16 v2, v67, 8, v79
    v_mad_u32_u16 v3, v67, 8, v79 op_sel:[1,0,0,0]
    ds_write_b64 v2, v[38:39]
    ds_write_b64 v3, v[36:37]
F_s3:
    s_mov_b64 exec, -1
    s_cmp_lg_u64 s[30:31], 0
    s_cbranch_scc1 F_u
F_ur:
    s_mov_b32 s22, s80
    s_mov_b32 s27, s80
    s_mov_b32 s71, s80
    s_bfe_u32 s46, s71, 0x30012
    s_mov_b32 m0, s46
    s_and_b32 s66, s71, 0x3ffff
    s_movrels_b32 s68, s57
    s_movrels_b32 s69, s61
    s_sub_u32 s48, s66, s47
    s_mov_b32 s47, s66
    s_lshr_b32 s52, s71, 28
    s_lshl_b32 s67, s46, 9
    s_add_u32 s66, s66, s67
    s_sub_u32 s49, s66, s42
    s_mov_b32 s42, s66
    s_bfe_u32 s66, s68, 655360
    s_add_u32 s43, s42, s66
    s_bfe_u32 s39, s69, 655360
    s_bfe_u32 s66, s68, 655370
    s_add_u32 s44, s42, s66
    s_bfe_u32 s40, s69, 655370
    s_bfe_u32 s66, s68, 655380
    s_add_u32 s45, s42, s66
    s_bfe_u32 s41, s69, 655380
    s_and_b32 s66, s46, s33
    s_cselect_b32 s72, -1, 1
    s_cselect_b32 s76, s47, 163712
    s_cmp_ge_u32 s66, 2
    s_cselect_b32 s73, -1, 0
    s_add_u32 s77, s47, 1024
    s_cmp_ge_u32 s66, 4
    s_cselect_b32 s75, -1, 0
    s_cmp_ge_u32 s66, 3
    s_cselect_b32 s74, -1, 1
    s_cselect_b32 s77, s77, 163712
    s_mul_i32 s66, s20, 80
    v_min_u32 v2, 76, v248
    s_waitcnt lgkmcnt(0)
    s_barrier
    v_add_u32 v253, s47, v248
    ds_read_b32 v254, v253
    ds_read_b32 v255, v253 offset:256
    v_add_u32 v252, s42, v247
    ds_read_u16 v234, v252
    ds_read_u16 v235, v252 offset:64
    v_add_u32 v252, s43, v247
    ds_read_u16 v236, v252
    ds_read_u16 v237, v252 offset:64
    v_add_u32 v252, s44, v247
    ds_read_u16 v238, v252
    ds_read_u16 v239, v252 offset:64
    v_add_u32 v252, s45, v247
    ds_read_u16 v240, v252
    ds_read_u16 v241, v252 offset:64
    buffer_load_dword v3, v2, s[16:19], s66 offen offset:128 sc1
    v_add_u32 v249, s48, v249
    v_add_u32 v250, s49, v250
    s_waitcnt lgkmcnt(8)
    s_mov_b32 m0, s76
    s_mov_b64 exec, s[72:73]
    buffer_load_dwordx4 v254, s[12:15], 0 offen  lds
    s_mov_b32 m0, s77
    s_mov_b64 exec, s[74:75]
    buffer_load_dwordx4 v255, s[12:15], 0 offen  lds
    s_mov_b64 exec, -1
    s_waitcnt lgkmcnt(0)
    s_add_u32 m0, s21, 0
    v_lshl_add_u32 v234, v234, 10, v246
    v_lshl_add_u32 v235, v235, 10, v246
    buffer_load_dwordx4 v234, s[4:7], s38 offen lds
    buffer_load_dwordx4 v235, s[8:11], s38 offen offset:1024 lds
    s_add_u32 m0, s21, 2048
    v_lshl_add_u32 v236, v236, 10, v246
    v_lshl_add_u32 v237, v237, 10, v246
    buffer_load_dwordx4 v236, s[4:7], s39 offen lds
    buffer_load_dwordx4 v237, s[8:11], s39 offen offset:1024 lds
    s_add_u32 m0, s21, 4096
    v_lshl_add_u32 v238, v238, 10, v246
    v_lshl_add_u32 v239, v239, 10, v246
    buffer_load_dwordx4 v238, s[4:7], s40 offen lds
    buffer_load_dwordx4 v239, s[8:11], s40 offen offset:1024 lds
    s_add_u32 m0, s21, 6144
    v_lshl_add_u32 v240, v240, 10, v246
    v_lshl_add_u32 v241, v241, 10, v246
    buffer_load_dwordx4 v240, s[4:7], s41 offen lds
    buffer_load_dwordx4 v241, s[8:11], s41 offen offset:1024 lds
    v_lshrrev_b32 v8, 3, v84
    v_and_b32 v9, 7, v84
    v_lshlrev_b32 v9, 13, v9
    v_mul_u32_u24 v8, 1536, v8
    v_and_b32 v5, 128, v86
    v_add3_u32 v8, v8, v9, v5
    v_xor_b32 v9, v86, v7
    v_and_b32 v9, 128, v9
    v_add_u32 v9, v9, v7
    v_and_b32 v4, 0x70, v86
    v_or_b32 v5, v9, v4
    s_add_u32 s66, s20, 0
    v_cmp_eq_u32 vcc, s66, v84
    s_ff1_i32_b64 s67, vcc
    v_readlane_b32 s28, v5, s67
    s_add_u32 s66, s20, 8
    v_cmp_eq_u32 vcc, s66, v84
    s_ff1_i32_b64 s67, vcc
    v_readlane_b32 s29, v5, s67
    v_readlane_b32 s23, v6, s67
    s_add_u32 s66, s20, 16
    v_cmp_eq_u32 vcc, s66, v84
    s_ff1_i32_b64 s67, vcc
    v_readlane_b32 s30, v5, s67
    v_readlane_b32 s24, v6, s67
    s_add_u32 s66, s20, 24
    v_cmp_eq_u32 vcc, s66, v84
    s_ff1_i32_b64 s67, vcc
    v_readlane_b32 s31, v5, s67
    v_readlane_b32 s25, v6, s67
    s_add_u32 s66, s20, 32
    v_cmp_eq_u32 vcc, s66, v84
    s_ff1_i32_b64 s67, vcc
    v_readlane_b32 s32, v5, s67
    v_readlane_b32 s26, v6, s67
    v_lshlrev_b32 v4, 3, v1
    v_add_u32 v4, 163328, v4
    s_mov_b32 exec_hi, 0xff
    ds_write_b64 v4, v[8:9]
    s_mov_b32 exec_hi, -1
    s_waitcnt lgkmcnt(0)
    v_mov_b32 v252, 0
    s_waitcnt vmcnt(6)
    v_cmp_ne_u32 vcc, s88, v3
    ds_read_b64_tr_b16 v[176:177], v244 offset:0
    ds_read_b64_tr_b16 v[178:179], v244 offset:1024
    ds_read_b64_tr_b16 v[180:181], v245 offset:0
    ds_read_b64_tr_b16 v[182:183], v245 offset:1024
    ds_read_b64_tr_b16 v[64:65], v249 offset:0
    ds_read_b64_tr_b16 v[68:69], v249 offset:64
    ds_read_b64_tr_b16 v[66:67], v249 offset:256
    ds_read_b64_tr_b16 v[70:71], v249 offset:320
    s_mov_b64 exec, s[54:55]
    ds_read_u16_d16_hi v242, v250 offset:0
    s_mov_b64 exec, -1
    s_or_b32 s89, vcc_lo, vcc_hi
    s_waitcnt lgkmcnt(5)
    v_readfirstlane_b32 s66, v252
    s_add_u32 s53, s53, 1
    v_mov_b32 v252, s53
    s_cmp_le_u32 s53, s66
    ds_write2_b32 v251, v252, v252 offset0:0 offset1:8
    s_setprio 1
    s_cbranch_scc1 PRIO_1
    s_setprio 0
PRIO_1:
    s_cmp_eq_u32 s52, 4
    s_cbranch_scc1 ITEM_0_4
    s_cmp_eq_u32 s52, 5
    s_cbranch_scc1 ITEM_0_5
    s_cmp_eq_u32 s52, 3
    s_cbranch_scc1 ITEM_0_3
    s_cmp_eq_u32 s52, 6
    s_cbranch_scc1 ITEM_0_6
    s_cmp_eq_u32 s52, 8
    s_cbranch_scc1 ITEM_0_8
    s_branch ITEM_0_2
F_again:
    s_sub_u32 s27, s27, 1
    s_cbranch_scc1 F_late
    s_cmp_eq_u64 s[72:73], 0
    s_cbranch_scc1 F_p0
    buffer_load_dwordx4 v[8:11], v86, s[16:19], s24 offen offset:0 sc1
F_p0:
    s_cmp_eq_u64 s[74:75], 0
    s_cbranch_scc1 F_p1
    buffer_load_dwordx4 v[12:15], v86, s[16:19], s24 offen offset:1024 sc1
F_p1:
    s_cmp_eq_u64 s[76:77], 0
    s_cbranch_scc1 F_p2
    buffer_load_dwordx4 v[16:19], v86, s[16:19], s24 offen offset:2048 sc1
F_p2:
    s_cmp_eq_u64 s[78:79], 0
    s_cbranch_scc1 F_p3
    s_mov_b64 exec, s[22:23]
    buffer_load_dwordx4 v[20:23], v86, s[16:19], s24 offen offset:3072 sc1
    s_mov_b64 exec, -1
F_p3:
    s_branch F_poll
F_late:
    v_mov_b32 v2, 163064
    v_mov_b32 v4, 1000
    ds_write_b32 v2, v4
    v_mov_b32 v10, 0
    v_mov_b32 v14, 0
    v_mov_b32 v18, 0
    v_mov_b32 v22, 0
    s_branch F_got
F_l3:
    v_bfe_u32 v2, v10, 23, 5
    v_sub_u32 v56, v2, v91
    v_cmp_lt_u32 vcc, 16, v2
    s_mov_b64 exec, vcc
    s_cbranch_execz F_t0
F_tp0:
    buffer_load_dwordx4 v[40:43], v86, s[16:19], s26 offen offset:0 sc1
    s_waitcnt vmcnt(0)
    v_cmp_ne_u32 vcc, s88, v43
    s_sub_u32 s27, s27, 1
    s_cselect_b64 vcc, 0, vcc
    s_cmp_eq_u64 vcc, 0
    s_cbranch_scc0 F_tp0
    v_bfe_u32 v68, v42, 11, 6
    v_lshl_add_u32 v68, v68, 2, s71
    v_cmp_lt_i32 vcc, 16, v56
    s_mov_b64 exec, vcc
    ds_add_rtn_u32 v80, v68, v3
F_t0:
    s_mov_b64 exec, -1
    v_bfe_u32 v2, v14, 23, 5
    v_sub_u32 v57, v2, v91
    v_cmp_lt_u32 vcc, 16, v2
    s_mov_b64 exec, vcc
    s_cbranch_execz F_t1
F_tp1:
    buffer_load_dwordx4 v[44:47], v86, s[16:19], s26 offen offset:1024 sc1
    s_waitcnt vmcnt(0)
    v_cmp_ne_u32 vcc, s88, v47
    s_sub_u32 s27, s27, 1
    s_cselect_b64 vcc, 0, vcc
    s_cmp_eq_u64 vcc, 0
    s_cbranch_scc0 F_tp1
    v_bfe_u32 v69, v46, 11, 6
    v_lshl_add_u32 v69, v69, 2, s71
    v_cmp_lt_i32 vcc, 16, v57
    s_mov_b64 exec, vcc
    ds_add_rtn_u32 v81, v69, v3
F_t1:
    s_mov_b64 exec, -1
    v_bfe_u32 v2, v18, 23, 5
    v_sub_u32 v58, v2, v91
    v_cmp_lt_u32 vcc, 16, v2
    s_mov_b64 exec, vcc
    s_cbranch_execz F_t2
F_tp2:
    buffer_load_dwordx4 v[48:51], v86, s[16:19], s26 offen offset:2048 sc1
    s_waitcnt vmcnt(0)
    v_cmp_ne_u32 vcc, s88, v51
    s_sub_u32 s27, s27, 1
    s_cselect_b64 vcc, 0, vcc
    s_cmp_eq_u64 vcc, 0
    s_cbranch_scc0 F_tp2
    v_bfe_u32 v70, v50, 11, 6
    v_lshl_add_u32 v70, v70, 2, s71
    v_cmp_lt_i32 vcc, 16, v58
    s_mov_b64 exec, vcc
    ds_add_rtn_u32 v82, v70, v3
F_t2:
    s_mov_b64 exec, -1
    v_bfe_u32 v2, v22, 23, 5
    v_sub_u32 v59, v2, v91
    v_cmp_lt_u32 vcc, 16, v2
    s_mov_b64 exec, vcc
    s_cbranch_execz F_t3
F_tp3:
    buffer_load_dwordx4 v[52:55], v86, s[16:19], s26 offen offset:3072 sc1
    s_waitcnt vmcnt(0)
    v_cmp_ne_u32 vcc, s88, v55
    s_sub_u32 s27, s27, 1
    s_cselect_b64 vcc, 0, vcc
    s_cmp_eq_u64 vcc, 0
    s_cbranch_scc0 F_tp3
    v_bfe_u32 v71, v54, 11, 6
    v_lshl_add_u32 v71, v71, 2, s71
    v_cmp_lt_i32 vcc, 16, v59
    s_mov_b64 exec, vcc
    ds_add_rtn_u32 v83, v71, v3
F_t3:
    s_mov_b64 exec, -1
    v_mov_b32 v2, 163068
    v_mov_b32 v4, 1000
    v_cmp_lt_u32 vcc, 24, v89
    s_mov_b64 exec, vcc
    ds_write_b32 v2, v4
    s_mov_b64 exec, -1
    s_branch F_l3r
F_flag:
    s_lshl_b32 s66, s2, 2
    v_mov_b32 v2, 128
    v_mov_b32 v4, s88
    s_mov_b64 exec, 1
    buffer_store_dword v4, v2, s[16:19], s66 offen sc1
    s_mov_b64 exec, -1
    s_branch F_flagr
F_sa0:
    s_sub_u32 s27, s27, 1
    s_cbranch_scc1 F_sg0
    buffer_load_dwordx4 v[24:27], v86, s[16:19], s25 offen offset:0 sc1
    s_waitcnt vmcnt(0)
    s_branch F_sp0
F_sa1:
    s_sub_u32 s27, s27, 1
    s_cbranch_scc1 F_sg1
    buffer_load_dwordx4 v[28:31], v86, s[16:19], s25 offen offset:1024 sc1
    s_waitcnt vmcnt(0)
    s_branch F_sp1
F_sa2:
    s_sub_u32 s27, s27, 1
    s_cbranch_scc1 F_sg2
    buffer_load_dwordx4 v[32:35], v86, s[16:19], s25 offen offset:2048 sc1
    s_waitcnt vmcnt(0)
    s_branch F_sp2
F_sa3:
    s_sub_u32 s27, s27, 1
    s_cbranch_scc1 F_sg3
    buffer_load_dwordx4 v[36:39], v86, s[16:19], s25 offen offset:3072 sc1
    s_waitcnt vmcnt(0)
    s_branch F_sp3
F_u:
    ds_bpermute_b32 v68, v68, v92
    ds_bpermute_b32 v69, v69, v92
    ds_bpermute_b32 v70, v70, v92
    ds_bpermute_b32 v71, v71, v92
    s_waitcnt lgkmcnt(0)
    v_cmp_lt_i32 vcc, 16, v56
    s_mov_b64 exec, vcc
    s_cbranch_execz F_u0
    v_lshlrev_b32 v80, 3, v80
    v_and_b32 v42, 0x7ff, v42
    v_lshl_add_u32 v42, v42, 5, v90
    v_or_b32 v43, 16, v42
    v_mad_u32_u16 v2, v68, 8, v80
    v_mad_u32_u16 v3, v68, 8, v80 op_sel:[1,0,0,0]
    ds_write_b64 v2, v[42:43]
    ds_write_b64 v3, v[40:41]
F_u0:
    s_mov_b64 exec, -1
    v_cmp_lt_i32 vcc, 16, v57
    s_mov_b64 exec, vcc
    s_cbranch_execz F_u1
    v_lshlrev_b32 v81, 3, v81
    v_and_b32 v46, 0x7ff, v46
    v_lshl_add_u32 v46, v46, 5, v90
    v_add_u32 v46, 327680, v46
    v_or_b32 v47, 16, v46
    v_mad_u32_u16 v2, v69, 8, v81
    v_mad_u32_u16 v3, v69, 8, v81 op_sel:[1,0,0,0]
    ds_write_b64 v2, v[46:47]
    ds_write_b64 v3, v[44:45]
F_u1:
    s_mov_b64 exec, -1
    v_cmp_lt_i32 vcc, 16, v58
    s_mov_b64 exec, vcc
    s_cbranch_execz F_u2
    v_lshlrev_b32 v82, 3, v82
    v_and_b32 v50, 0x7ff, v50
    v_lshl_add_u32 v50, v50, 5, v90
    v_add_u32 v50, 655360, v50
    v_or_b32 v51, 16, v50
    v_mad_u32_u16 v2, v70, 8, v82
    v_mad_u32_u16 v3, v70, 8, v82 op_sel:[1,0,0,0]
    ds_write_b64 v2, v[50:51]
    ds_write_b64 v3, v[48:49]
F_u2:
    s_mov_b64 exec, -1
    v_cmp_lt_i32 vcc, 16, v59
    s_mov_b64 exec, vcc
    s_cbranch_execz F_u3
    v_lshlrev_b32 v83, 3, v83
    v_and_b32 v54, 0x7ff, v54
    v_lshl_add_u32 v54, v54, 5, v90
    v_add_u32 v54, 983040, v54
    v_or_b32 v55, 16, v54
    v_mad_u32_u16 v2, v71, 8, v83
    v_mad_u32_u16 v3, v71, 8, v83 op_sel:[1,0,0,0]
    ds_write_b64 v2, v[54:55]
    ds_write_b64 v3, v[52:53]
F_u3:
    s_mov_b64 exec, -1
    s_branch F_ur
LAST0:
    s_cmp_eq_u32 s50, 5
    s_cbranch_scc1 TO_PHASE1
    s_add_u32 s4, s4, 128
    s_addc_u32 s5, s5, 0
    s_add_u32 s8, s8, 128
    s_addc_u32 s9, s9, 0
    s_mov_b32 s34, 0
    s_mov_b32 s35, 256
    s_mov_b32 s36, 512
    s_mov_b32 s37, 768
    s_mov_b32 s33, 0
    s_waitcnt lgkmcnt(5)
    v_readfirstlane_b32 s66, v252
    s_add_u32 s53, s53, 1
    v_mov_b32 v252, s53
    s_cmp_le_u32 s53, s66
    ds_write2_b32 v251, v252, v252 offset0:0 offset1:8
    s_setprio 1
    s_cbranch_scc1 PRIO_2
    s_setprio 0
PRIO_2:
    s_cmp_eq_u32 s52, 4
    s_cbranch_scc1 ITEM_0_4
    s_cmp_eq_u32 s52, 5
    s_cbranch_scc1 ITEM_0_5
    s_cmp_eq_u32 s52, 3
    s_cbranch_scc1 ITEM_0_3
    s_cmp_eq_u32 s52, 6
    s_cbranch_scc1 ITEM_0_6
    s_cmp_eq_u32 s52, 8
    s_cbranch_scc1 ITEM_0_8
    s_branch ITEM_0_2
TO_PHASE1:
    v_lshlrev_b32 v253, 2, v248
    v_add_u32 v253, 65536, v253
    ds_read_b128 v[96:99], v253 offset:0
    ds_read_b128 v[100:103], v253 offset:1024
    ds_read_b128 v[104:107], v253 offset:2048
    ds_read_b128 v[108:111], v253 offset:3072
    ds_read_b128 v[112:115], v253 offset:4096
    ds_read_b128 v[116:119], v253 offset:5120
    ds_read_b128 v[120:123], v253 offset:6144
    ds_read_b128 v[124:127], v253 offset:7168
    ds_read_b128 v[128:131], v253 offset:8192
    ds_read_b128 v[132:135], v253 offset:9216
    ds_read_b128 v[136:139], v253 offset:10240
    ds_read_b128 v[140:143], v253 offset:11264
    ds_read_b128 v[144:147], v253 offset:12288
    ds_read_b128 v[148:151], v253 offset:13312
    ds_read_b128 v[152:155], v253 offset:14336
    ds_read_b128 v[156:159], v253 offset:15360
    ds_read_b128 v[160:163], v253 offset:16384
    ds_read_b128 v[164:167], v253 offset:17408
    ds_read_b128 v[168:171], v253 offset:18432
    ds_read_b128 v[172:175], v253 offset:19456
    s_mov_b32 s34, 128
    s_mov_b32 s35, 384
    s_mov_b32 s36, 640
    s_mov_b32 s37, 896
    s_mov_b32 s50, 0
    s_waitcnt lgkmcnt(0)
    s_waitcnt lgkmcnt(0)
    v_readfirstlane_b32 s66, v252
    s_add_u32 s53, s53, 1
    v_mov_b32 v252, s53
    s_cmp_le_u32 s53, s66
    ds_write2_b32 v251, v252, v252 offset0:0 offset1:8
    s_setprio 1
    s_cbranch_scc1 PRIO_3
    s_setprio 0
PRIO_3:
    s_cmp_eq_u32 s52, 4
    s_cbranch_scc1 ITEM_1_4
    s_cmp_eq_u32 s52, 5
    s_cbranch_scc1 ITEM_1_5
    s_cmp_eq_u32 s52, 3
    s_cbranch_scc1 ITEM_1_3
    s_cmp_eq_u32 s52, 6
    s_cbranch_scc1 ITEM_1_6
    s_cmp_eq_u32 s52, 8
    s_cbranch_scc1 ITEM_1_8
    s_branch ITEM_1_2
.p2align 6
ITEM_0_4:
    s_mov_b64 exec, s[54:55]
    ds_read_u16_d16_hi v243, v250 offset:128
    s_mov_b64 exec, -1
    ds_read_b64_tr_b16 v[72:73], v249 offset:512
    ds_read_b64_tr_b16 v[76:77], v249 offset:576
    ds_read_b64_tr_b16 v[74:75], v249 offset:768
    ds_read_b64_tr_b16 v[78:79], v249 offset:832
    s_waitcnt lgkmcnt(5)
    v_mul_f32_dpp v196, v242, v64 row_newbcast:0 row_mask:0xf bank_mask:0xf
    v_mul_f32_dpp v197, v242, v65 row_newbcast:1 row_mask:0xf bank_mask:0xf
    v_mul_f32_dpp v198, v242, v64 row_newbcast:8 row_mask:0xf bank_mask:0xf
    v_mul_f32_dpp v199, v242, v65 row_newbcast:9 row_mask:0xf bank_mask:0xf
    v_mul_f32_dpp v200, v242, v68 row_newbcast:2 row_mask:0xf bank_mask:0xf
    v_mul_f32_dpp v201, v242, v69 row_newbcast:3 row_mask:0xf bank_mask:0xf
    v_mul_f32_dpp v202, v242, v68 row_newbcast:10 row_mask:0xf bank_mask:0xf
    v_mul_f32_dpp v203, v242, v69 row_newbcast:11 row_mask:0xf bank_mask:0xf
    v_cvt_pk_bf16_f32 v64, v196, v197
    v_cvt_pk_bf16_f32 v68, v198, v199
    v_cvt_pk_bf16_f32 v65, v200, v201
    v_cvt_pk_bf16_f32 v69, v202, v203
    v_mul_f32_dpp v196, v242, v66 row_newbcast:4 row_mask:0xf bank_mask:0xf
    v_mul_f32_dpp v197, v242, v67 row_newbcast:5 row_mask:0xf bank_mask:0xf
    v_mul_f32_dpp v198, v242, v66 row_newbcast:12 row_mask:0xf bank_mask:0xf
    v_mul_f32_dpp v199, v242, v67 row_newbcast:13 row_mask:0xf bank_mask:0xf
    v_mul_f32_dpp v200, v242, v70 row_newbcast:6 row_mask:0xf bank_mask:0xf
    v_mul_f32_dpp v201, v242, v71 row_newbcast:7 row_mask:0xf bank_mask:0xf
    v_mul_f32_dpp v202, v242, v70 row_newbcast:14 row_mask:0xf bank_mask:0xf
    v_mul_f32_dpp v203, v242, v71 row_newbcast:15 row_mask:0xf bank_mask:0xf
    v_cvt_pk_bf16_f32 v66, v196, v197
    v_cvt_pk_bf16_f32 v70, v198, v199
    v_cvt_pk_bf16_f32 v67, v200, v201
    v_cvt_pk_bf16_f32 v71, v202, v203
    s_nop 0
    s_waitcnt vmcnt(4) lgkmcnt(0)
    v_mfma_f32_32x32x16_bf16 v[0:15], v[64:67], v[176:179], 0
    v_mul_f32_dpp v196, v243, v72 row_newbcast:0 row_mask:0xf bank_mask:0xf
    v_mul_f32_dpp v197, v243, v73 row_newbcast:1 row_mask:0xf bank_mask:0xf
    v_mul_f32_dpp v198, v243, v72 row_newbcast:8 row_mask:0xf bank_mask:0xf
    v_mul_f32_dpp v199, v243, v73 row_newbcast:9 row_mask:0xf bank_mask:0xf
    v_mul_f32_dpp v200, v243, v76 row_newbcast:2 row_mask:0xf bank_mask:0xf
    v_mul_f32_dpp v201, v243, v77 row_newbcast:3 row_mask:0xf bank_mask:0xf
    v_mul_f32_dpp v202, v243, v76 row_newbcast:10 row_mask:0xf bank_mask:0xf
    v_mul_f32_dpp v203, v243, v77 row_newbcast:11 row_mask:0xf bank_mask:0xf
    v_cvt_pk_bf16_f32 v72, v196, v197
    v_cvt_pk_bf16_f32 v76, v198, v199
    v_cvt_pk_bf16_f32 v73, v200, v201
    v_cvt_pk_bf16_f32 v77, v202, v203
    s_add_u32 m0, s21, 0
    v_mfma_f32_32x32x16_bf16 v[16:31], v[68:71], v[176:179], 0
    buffer_load_dwordx4 v234, s[4:7], s36 offen lds
    buffer_load_dwordx4 v235, s[8:11], s36 offen offset:1024 lds
    ds_read_b64_tr_b16 v[176:177], v244 offset:2048
    ds_read_b64_tr_b16 v[178:179], v244 offset:3072
    ds_read_b64_tr_b16 v[184:185], v245 offset:2048
    ds_read_b64_tr_b16 v[186:187], v245 offset:3072
    v_mul_f32_dpp v196, v243, v74 row_newbcast:4 row_mask:0xf bank_mask:0xf
    v_mul_f32_dpp v197, v243, v75 row_newbcast:5 row_mask:0xf bank_mask:0xf
    v_mul_f32_dpp v198, v243, v74 row_newbcast:12 row_mask:0xf bank_mask:0xf
    v_mul_f32_dpp v199, v243, v75 row_newbcast:13 row_mask:0xf bank_mask:0xf
    v_mul_f32_dpp v200, v243, v78 row_newbcast:6 row_mask:0xf bank_mask:0xf
    v_mul_f32_dpp v201, v243, v79 row_newbcast:7 row_mask:0xf bank_mask:0xf
    v_mul_f32_dpp v202, v243, v78 row_newbcast:14 row_mask:0xf bank_mask:0xf
    v_mul_f32_dpp v203, v243, v79 row_newbcast:15 row_mask:0xf bank_mask:0xf
    v_cvt_pk_bf16_f32 v74, v196, v197
    v_cvt_pk_bf16_f32 v78, v198, v199
    v_cvt_pk_bf16_f32 v75, v200, v201
    v_cvt_pk_bf16_f32 v79, v202, v203
    s_nop 0
    s_waitcnt lgkmcnt(0)
    v_mfma_f32_32x32x16_bf16 v[0:15], v[72:75], v[176:179], v[0:15]
    s_add_u32 m0, s21, 2048
    v_mfma_f32_32x32x16_bf16 v[16:31], v[76:79], v[176:179], v[16:31]
    buffer_load_dwordx4 v236, s[4:7], s36 offen lds
    buffer_load_dwordx4 v237, s[8:11], s36 offen offset:1024 lds
    s_mov_b32 m0, s50
    s_nop 0
    s_movrels_b32 s71, s23
    s_bfe_u32 s46, s71, 0x30012
    s_mov_b32 m0, s46
    s_and_b32 s66, s71, 0x3ffff
    s_movrels_b32 s68, s57
    s_movrels_b32 s69, s61
    s_sub_u32 s48, s66, s47
    s_mov_b32 s47, s66
    s_lshr_b32 s52, s71, 28
    s_lshl_b32 s67, s46, 9
    s_add_u32 s66, s66, s67
    s_sub_u32 s49, s66, s42
    s_mov_b32 s42, s66
    s_bfe_u32 s66, s68, 655360
    s_add_u32 s43, s42, s66
    s_bfe_u32 s39, s69, 655360
    s_bfe_u32 s66, s68, 655370
    s_add_u32 s44, s42, s66
    s_bfe_u32 s40, s69, 655370
    s_bfe_u32 s66, s68, 655380
    s_add_u32 s45, s42, s66
    s_bfe_u32 s41, s69, 655380
    s_and_b32 s66, s46, s33
    s_cselect_b32 s72, -1, 1
    s_cselect_b32 s76, s47, 163712
    s_cmp_ge_u32 s66, 2
    s_cselect_b32 s73, -1, 0
    s_add_u32 s77, s47, 1024
    s_cmp_ge_u32 s66, 4
    s_cselect_b32 s75, -1, 0
    s_cmp_ge_u32 s66, 3
    s_cselect_b32 s74, -1, 1
    s_cselect_b32 s77, s77, 163712
    v_add_u32 v252, s44, v247
    ds_read_u16 v238, v252
    ds_read_u16 v239, v252 offset:64
    v_add_u32 v252, s45, v247
    ds_read_u16 v240, v252
    ds_read_u16 v241, v252 offset:64
    v_mfma_f32_32x32x16_bf16 v[32:47], v[64:67], v[180:183], 0
    v_mul_f32 v196, v0, v96
    v_fmac_f32 v196, v1, v97
    v_fmac_f32 v196, v2, v98
    v_fmac_f32 v196, v3, v99
    v_fmac_f32 v196, v4, v100
    v_fmac_f32 v196, v5, v101
    v_fmac_f32 v196, v6, v102
    v_fmac_f32 v196, v7, v103
    v_mul_f32 v198, v8, v128
    v_fmac_f32 v198, v9, v129
    v_mfma_f32_32x32x16_bf16 v[48:63], v[68:71], v[180:183], 0
    v_add_u32 v253, s47, v248
    ds_read_b32 v254, v253
    ds_read_b32 v255, v253 offset:256
    s_waitcnt vmcnt(6)
    ds_read_b64_tr_b16 v[176:177], v244 offset:4096
    ds_read_b64_tr_b16 v[178:179], v244 offset:5120
    ds_read_b64_tr_b16 v[180:181], v245 offset:4096
    ds_read_b64_tr_b16 v[182:183], v245 offset:5120
    v_fmac_f32 v198, v10, v130
    v_fmac_f32 v198, v11, v131
    v_fmac_f32 v198, v12, v132
    v_fmac_f32 v198, v13, v133
    v_fmac_f32 v198, v14, v134
    v_fmac_f32 v198, v15, v135
    v_mul_f32 v200, v16, v128
    v_fmac_f32 v200, v17, v129
    v_permlane32_swap_b32 v196, v198
    v_mfma_f32_32x32x16_bf16 v[32:47], v[72:75], v[184:187], v[32:47]
    v_fmac_f32 v200, v18, v130
    v_fmac_f32 v200, v19, v131
    v_fmac_f32 v200, v20, v132
    v_fmac_f32 v200, v21, v133
    v_fmac_f32 v200, v22, v134
    v_fmac_f32 v200, v23, v135
    v_add_f32 v198, v196, v198
    v_mul_f32_e64 v202, v24, -v128
    v_fma_f32 v202, v25, -v129, v202
    v_mfma_f32_32x32x16_bf16 v[48:63], v[76:79], v[184:187], v[48:63]
    v_fma_f32 v202, v26, -v130, v202
    v_fma_f32 v202, v27, -v131, v202
    v_fma_f32 v202, v28, -v132, v202
    v_fma_f32 v202, v29, -v133, v202
    v_fma_f32 v202, v30, -v134, v202
    v_fma_f32 v202, v31, -v135, v202
    s_nop 1
    v_permlane32_swap_b32 v200, v202
    v_add_f32 v202, v200, v202
    s_waitcnt vmcnt(4) lgkmcnt(0)
    v_mfma_f32_32x32x16_bf16 v[0:15], v[64:67], v[176:179], 0
    v_mul_f32 v197, v32, v104
    v_fmac_f32 v197, v33, v105
    v_fmac_f32 v197, v34, v106
    v_fmac_f32 v197, v35, v107
    v_fmac_f32 v197, v36, v108
    v_fmac_f32 v197, v37, v109
    v_fmac_f32 v197, v38, v110
    v_fmac_f32 v197, v39, v111
    v_mul_f32 v199, v40, v136
    v_fmac_f32 v199, v41, v137
    v_fmac_f32 v199, v42, v138
    s_add_u32 m0, s21, 4096
    v_mfma_f32_32x32x16_bf16 v[16:31], v[68:71], v[176:179], 0
    buffer_load_dwordx4 v234, s[4:7], s37 offen lds
    buffer_load_dwordx4 v235, s[8:11], s37 offen offset:1024 lds
    ds_read_b64_tr_b16 v[176:177], v244 offset:6144
    ds_read_b64_tr_b16 v[178:179], v244 offset:7168
    ds_read_b64_tr_b16 v[184:185], v245 offset:6144
    ds_read_b64_tr_b16 v[186:187], v245 offset:7168
    v_add_u32 v252, s42, v247
    ds_read_u16 v234, v252
    ds_read_u16 v235, v252 offset:64
    s_mov_b32 m0, s76
    s_mov_b64 exec, s[72:73]
    buffer_load_dwordx4 v254, s[12:15], 0 offen  lds
    s_mov_b32 m0, s77
    s_mov_b64 exec, s[74:75]
    buffer_load_dwordx4 v255, s[12:15], 0 offen  lds
    s_mov_b64 exec, -1
    v_fmac_f32 v199, v43, v139
    v_fmac_f32 v199, v44, v140
    v_fmac_f32 v199, v45, v141
    v_fmac_f32 v199, v46, v142
    v_fmac_f32 v199, v47, v143
    v_mul_f32 v201, v48, v136
    v_fmac_f32 v201, v49, v137
    v_permlane32_swap_b32 v197, v199
    v_fmac_f32 v201, v50, v138
    v_fmac_f32 v201, v51, v139
    s_waitcnt lgkmcnt(2)
    v_mfma_f32_32x32x16_bf16 v[0:15], v[72:75], v[176:179], v[0:15]
    v_fmac_f32 v201, v52, v140
    v_fmac_f32 v201, v53, v141
    v_fmac_f32 v201, v54, v142
    v_fmac_f32 v201, v55, v143
    v_add_f32 v199, v197, v199
    v_mul_f32_e64 v203, v56, -v136
    v_fma_f32 v203, v57, -v137, v203
    v_fma_f32 v203, v58, -v138, v203
    v_fma_f32 v203, v59, -v139, v203
    v_fma_f32 v203, v60, -v140, v203
    v_fma_f32 v203, v61, -v141, v203
    s_add_u32 m0, s21, 6144
    v_mfma_f32_32x32x16_bf16 v[16:31], v[76:79], v[176:179], v[16:31]
    buffer_load_dwordx4 v236, s[4:7], s37 offen lds
    buffer_load_dwordx4 v237, s[8:11], s37 offen offset:1024 lds
    v_add_u32 v252, s43, v247
    ds_read_u16 v236, v252
    ds_read_u16 v237, v252 offset:64
    v_fma_f32 v203, v62, -v142, v203
    v_fma_f32 v203, v63, -v143, v203
    s_nop 1
    v_permlane32_swap_b32 v201, v203
    v_add_f32 v203, v201, v203
    s_set_gpr_idx_on s51, gpr_idx(DST)
    s_nop 0
    v_cvt_pk_bf16_f32 v204, v198, v199
    v_cvt_pk_bf16_f32 v205, v202, v203
    s_set_gpr_idx_off
    v_mfma_f32_32x32x16_bf16 v[32:47], v[64:67], v[180:183], 0
    v_mul_f32 v196, v0, v144
    v_fmac_f32 v196, v1, v145
    v_fmac_f32 v196, v2, v146
    v_fmac_f32 v196, v3, v147
    v_fmac_f32 v196, v4, v148
    v_fmac_f32 v196, v5, v149
    v_fmac_f32 v196, v6, v150
    v_fmac_f32 v196, v7, v151
    v_mfma_f32_32x32x16_bf16 v[48:63], v[68:71], v[180:183], 0
    s_waitcnt vmcnt(8)
    ds_read_b64_tr_b16 v[176:177], v244 offset:0
    ds_read_b64_tr_b16 v[178:179], v244 offset:1024
    ds_read_b64_tr_b16 v[180:181], v245 offset:0
    ds_read_b64_tr_b16 v[182:183], v245 offset:1024
    v_mul_f32 v198, v8, v112
    v_fmac_f32 v198, v9, v113
    v_fmac_f32 v198, v10, v114
    v_fmac_f32 v198, v11, v115
    v_fmac_f32 v198, v12, v116
    v_fmac_f32 v198, v13, v117
    v_fmac_f32 v198, v14, v118
    v_fmac_f32 v198, v15, v119
    v_mfma_f32_32x32x16_bf16 v[32:47], v[72:75], v[184:187], v[32:47]
    v_mul_f32_e64 v200, v16, -v160
    v_fma_f32 v200, v17, -v161, v200
    v_fma_f32 v200, v18, -v162, v200
    v_fma_f32 v200, v19, -v163, v200
    v_fma_f32 v200, v20, -v164, v200
    v_fma_f32 v200, v21, -v165, v200
    v_fma_f32 v200, v22, -v166, v200
    v_fma_f32 v200, v23, -v167, v200
    v_mfma_f32_32x32x16_bf16 v[48:63], v[76:79], v[184:187], v[48:63]
    v_mul_f32_e64 v202, v24, -v160
    v_fma_f32 v202, v25, -v161, v202
    v_fma_f32 v202, v26, -v162, v202
    v_fma_f32 v202, v27, -v163, v202
    v_fma_f32 v202, v28, -v164, v202
    v_fma_f32 v202, v29, -v165, v202
    v_fma_f32 v202, v30, -v166, v202
    v_fma_f32 v202, v31, -v167, v202
    s_waitcnt vmcnt(6) lgkmcnt(0)
    v_mfma_f32_32x32x16_bf16 v[0:15], v[64:67], v[176:179], 0
    v_mul_f32 v197, v32, v152
    v_fmac_f32 v197, v33, v153
    v_fmac_f32 v197, v34, v154
    v_fmac_f32 v197, v35, v155
    v_fmac_f32 v197, v36, v156
    v_fmac_f32 v197, v37, v157
    v_fmac_f32 v197, v38, v158
    v_fmac_f32 v197, v39, v159
    s_add_u32 m0, s21, 0
    v_mfma_f32_32x32x16_bf16 v[16:31], v[68:71], v[176:179], 0
    v_lshl_add_u32 v234, v234, 10, v246
    v_lshl_add_u32 v235, v235, 10, v246
    buffer_load_dwordx4 v234, s[4:7], s38 offen lds
    buffer_load_dwordx4 v235, s[8:11], s38 offen offset:1024 lds
    ds_read_b64_tr_b16 v[176:177], v244 offset:2048
    ds_read_b64_tr_b16 v[178:179], v244 offset:3072
    ds_read_b64_tr_b16 v[184:185], v245 offset:2048
    ds_read_b64_tr_b16 v[186:187], v245 offset:3072
    v_mul_f32 v199, v40, v120
    v_fmac_f32 v199, v41, v121
    v_fmac_f32 v199, v42, v122
    v_fmac_f32 v199, v43, v123
    v_fmac_f32 v199, v44, v124
    v_fmac_f32 v199, v45, v125
    v_fmac_f32 v199, v46, v126
    v_fmac_f32 v199, v47, v127
    s_waitcnt lgkmcnt(0)
    v_mfma_f32_32x32x16_bf16 v[0:15], v[72:75], v[176:179], v[0:15]
    v_mul_f32_e64 v201, v48, -v168
    v_fma_f32 v201, v49, -v169, v201
    v_fma_f32 v201, v50, -v170, v201
    v_fma_f32 v201, v51, -v171, v201
    v_fma_f32 v201, v52, -v172, v201
    v_fma_f32 v201, v53, -v173, v201
    v_fma_f32 v201, v54, -v174, v201
    v_fma_f32 v201, v55, -v175, v201
    s_add_u32 m0, s21, 2048
    v_mfma_f32_32x32x16_bf16 v[16:31], v[76:79], v[176:179], v[16:31]
    v_lshl_add_u32 v236, v236, 10, v246
    v_lshl_add_u32 v237, v237, 10, v246
    buffer_load_dwordx4 v236, s[4:7], s39 offen lds
    buffer_load_dwordx4 v237, s[8:11], s39 offen offset:1024 lds
    v_mul_f32_e64 v203, v56, -v168
    v_fma_f32 v203, v57, -v169, v203
    v_fma_f32 v203, v58, -v170, v203
    v_fma_f32 v203, v59, -v171, v203
    v_fma_f32 v203, v60, -v172, v203
    v_fma_f32 v203, v61, -v173, v203
    v_fma_f32 v203, v62, -v174, v203
    v_fma_f32 v203, v63, -v175, v203
    v_mfma_f32_32x32x16_bf16 v[32:47], v[64:67], v[180:183], 0
    v_mul_f32 v254, v0, v144
    v_fmac_f32 v254, v1, v145
    v_fmac_f32 v254, v2, v146
    v_fmac_f32 v254, v3, v147
    v_fmac_f32 v254, v4, v148
    v_mfma_f32_32x32x16_bf16 v[48:63], v[68:71], v[180:183], 0
    ds_swizzle_b32 v68, v68 offset:0x401F
    ds_swizzle_b32 v69, v69 offset:0x401F
    ds_swizzle_b32 v70, v70 offset:0x401F
    ds_swizzle_b32 v71, v71 offset:0x401F
    s_waitcnt vmcnt(8)
    ds_read_b64_tr_b16 v[176:177], v244 offset:4096
    ds_read_b64_tr_b16 v[178:179], v244 offset:5120
    ds_read_b64_tr_b16 v[180:181], v245 offset:4096
    ds_read_b64_tr_b16 v[182:183], v245 offset:5120
    v_fmac_f32 v254, v5, v149
    v_fmac_f32 v254, v6, v150
    v_fmac_f32 v254, v7, v151
    v_fmac_f32 v200, v8, v160
    v_mfma_f32_32x32x16_bf16 v[32:47], v[72:75], v[184:187], v[32:47]
    v_fmac_f32 v200, v9, v161
    v_permlane32_swap_b32 v196, v254
    v_fmac_f32 v200, v10, v162
    v_fmac_f32 v200, v11, v163
    v_fmac_f32 v200, v12, v164
    v_mfma_f32_32x32x16_bf16 v[48:63], v[76:79], v[184:187], v[48:63]
    ds_swizzle_b32 v76, v76 offset:0x401F
    ds_swizzle_b32 v77, v77 offset:0x401F
    ds_swizzle_b32 v78, v78 offset:0x401F
    ds_swizzle_b32 v79, v79 offset:0x401F
    v_fmac_f32 v200, v13, v165
    v_fmac_f32 v200, v14, v166
    v_fmac_f32 v200, v15, v167
    v_add_f32 v254, v196, v254
    s_waitcnt lgkmcnt(8)
    s_mov_b64 exec, s[56:57]
    v_xor_b32 v68, 0x80008000, v68
    v_xor_b32 v69, 0x80008000, v69
    v_xor_b32 v70, 0x80008000, v70
    v_xor_b32 v71, 0x80008000, v71
    s_mov_b64 exec, -1
    s_waitcnt vmcnt(4) lgkmcnt(4)
    v_mfma_f32_32x32x16_bf16 v[0:15], v[64:67], v[176:179], 0
    v_mul_f32 v255, v32, v152
    v_fmac_f32 v255, v33, v153
    v_fmac_f32 v255, v34, v154
    v_fmac_f32 v255, v35, v155
    v_fmac_f32 v255, v36, v156
    v_fmac_f32 v255, v37, v157
    s_add_u32 m0, s21, 4096
    v_mfma_f32_32x32x16_bf16 v[16:31], v[68:71], v[176:179], v[16:31]
    v_lshl_add_u32 v238, v238, 10, v246
    v_lshl_add_u32 v239, v239, 10, v246
    buffer_load_dwordx4 v238, s[4:7], s40 offen lds
    buffer_load_dwordx4 v239, s[8:11], s40 offen offset:1024 lds
    ds_read_b64_tr_b16 v[176:177], v244 offset:6144
    ds_read_b64_tr_b16 v[178:179], v244 offset:7168
    ds_read_b64_tr_b16 v[184:185], v245 offset:6144
    ds_read_b64_tr_b16 v[186:187], v245 offset:7168
    v_fmac_f32 v255, v38, v158
    v_fmac_f32 v255, v39, v159
    v_fmac_f32 v201, v40, v168
    v_fmac_f32 v201, v41, v169
    v_permlane32_swap_b32 v197, v255
    s_waitcnt lgkmcnt(0)
    s_mov_b64 exec, s[56:57]
    v_xor_b32 v76, 0x80008000, v76
    v_xor_b32 v77, 0x80008000, v77
    v_xor_b32 v78, 0x80008000, v78
    v_xor_b32 v79, 0x80008000, v79
    s_mov_b64 exec, -1
    v_mfma_f32_32x32x16_bf16 v[0:15], v[72:75], v[176:179], v[0:15]
    v_fmac_f32 v201, v42, v170
    v_fmac_f32 v201, v43, v171
    v_fmac_f32 v201, v44, v172
    v_fmac_f32 v201, v45, v173
    v_fmac_f32 v201, v46, v174
    v_fmac_f32 v201, v47, v175
    s_add_u32 m0, s21, 6144
    v_mfma_f32_32x32x16_bf16 v[16:31], v[76:79], v[176:179], v[16:31]
    v_lshl_add_u32 v240, v240, 10, v246
    v_lshl_add_u32 v241, v241, 10, v246
    buffer_load_dwordx4 v240, s[4:7], s41 offen lds
    buffer_load_dwordx4 v241, s[8:11], s41 offen offset:1024 lds
    v_add_f32 v255, v197, v255
    s_set_gpr_idx_on s51, gpr_idx(DST)
    s_nop 0
    v_cvt_pk_bf16_f32 v206, v254, v255
    s_set_gpr_idx_off
    v_mfma_f32_32x32x16_bf16 v[32:47], v[64:67], v[180:183], 0
    v_mul_f32 v254, v0, v144
    v_fmac_f32 v254, v1, v145
    v_fmac_f32 v254, v2, v146
    v_fmac_f32 v254, v3, v147
    v_fmac_f32 v254, v4, v148
    v_fmac_f32 v254, v5, v149
    v_fmac_f32 v254, v6, v150
    v_fmac_f32 v254, v7, v151
    v_fma_f32 v202, v8, -v160, v202
    v_fma_f32 v202, v9, -v161, v202
    v_mfma_f32_32x32x16_bf16 v[48:63], v[68:71], v[180:183], v[48:63]
    s_waitcnt vmcnt(6)
    ds_read_b64_tr_b16 v[176:177], v244 offset:0
    ds_read_b64_tr_b16 v[178:179], v244 offset:1024
    ds_read_b64_tr_b16 v[180:181], v245 offset:0
    ds_read_b64_tr_b16 v[182:183], v245 offset:1024
    v_permlane32_swap_b32 v254, v200
    v_fma_f32 v202, v10, -v162, v202
    v_fma_f32 v202, v11, -v163, v202
    v_fma_f32 v202, v12, -v164, v202
    v_fma_f32 v202, v13, -v165, v202
    v_fma_f32 v202, v14, -v166, v202
    v_fma_f32 v202, v15, -v167, v202
    v_add_f32 v200, v254, v200
    v_fmac_f32 v198, v16, v112
    v_permlane32_swap_b32 v202, v254
    v_mfma_f32_32x32x16_bf16 v[32:47], v[72:75], v[184:187], v[32:47]
    v_fmac_f32 v198, v17, v113
    v_fmac_f32 v198, v18, v114
    v_fmac_f32 v198, v19, v115
    v_fmac_f32 v198, v20, v116
    v_fmac_f32 v198, v21, v117
    v_fmac_f32 v198, v22, v118
    v_fmac_f32 v198, v23, v119
    v_add_f32 v254, v202, v254
    v_mul_f32 v196, v24, v160
    v_fmac_f32 v196, v25, v161
    v_mfma_f32_32x32x16_bf16 v[48:63], v[76:79], v[184:187], v[48:63]
    v_add_u32 v249, s48, v249
    v_add_u32 v250, s49, v250
    ds_read_b32 v252, v251 offset:16
    ds_read_b64_tr_b16 v[64:65], v249 offset:0
    ds_read_b64_tr_b16 v[68:69], v249 offset:64
    ds_read_b64_tr_b16 v[66:67], v249 offset:256
    ds_read_b64_tr_b16 v[70:71], v249 offset:320
    s_mov_b64 exec, s[54:55]
    ds_read_u16_d16_hi v242, v250 offset:0
    s_mov_b64 exec, -1
    v_fmac_f32 v196, v26, v162
    v_fmac_f32 v196, v27, v163
    v_fmac_f32 v196, v28, v164
    v_fmac_f32 v196, v29, v165
    v_fmac_f32 v196, v30, v166
    v_fmac_f32 v196, v31, v167
    s_nop 1
    v_permlane32_swap_b32 v198, v196
    v_add_f32 v196, v198, v196
    v_mul_f32 v255, v32, v152
    v_fmac_f32 v255, v33, v153
    v_fmac_f32 v255, v34, v154
    v_fmac_f32 v255, v35, v155
    v_fmac_f32 v255, v36, v156
    v_fmac_f32 v255, v37, v157
    v_fmac_f32 v255, v38, v158
    v_fmac_f32 v255, v39, v159
    v_fma_f32 v203, v40, -v168, v203
    v_fma_f32 v203, v41, -v169, v203
    v_permlane32_swap_b32 v255, v201
    v_fma_f32 v203, v42, -v170, v203
    v_fma_f32 v203, v43, -v171, v203
    v_fma_f32 v203, v44, -v172, v203
    v_fma_f32 v203, v45, -v173, v203
    v_fma_f32 v203, v46, -v174, v203
    v_fma_f32 v203, v47, -v175, v203
    v_add_f32 v201, v255, v201
    v_fmac_f32 v199, v48, v120
    v_permlane32_swap_b32 v203, v255
    v_fmac_f32 v199, v49, v121
    v_fmac_f32 v199, v50, v122
    v_fmac_f32 v199, v51, v123
    v_fmac_f32 v199, v52, v124
    v_fmac_f32 v199, v53, v125
    v_fmac_f32 v199, v54, v126
    v_fmac_f32 v199, v55, v127
    v_add_f32 v255, v203, v255
    v_mul_f32 v197, v56, v168
    v_fmac_f32 v197, v57, v169
    v_fmac_f32 v197, v58, v170
    v_fmac_f32 v197, v59, v171
    v_fmac_f32 v197, v60, v172
    v_fmac_f32 v197, v61, v173
    v_fmac_f32 v197, v62, v174
    v_fmac_f32 v197, v63, v175
    s_nop 1
    v_permlane32_swap_b32 v199, v197
    v_add_f32 v197, v199, v197
    s_set_gpr_idx_on s51, gpr_idx(DST)
    s_nop 0
    v_cvt_pk_bf16_f32 v207, v200, v201
    v_cvt_pk_bf16_f32 v209, v254, v255
    v_cvt_pk_bf16_f32 v208, v196, v197
    s_set_gpr_idx_off
    s_add_u32 s50, s50, 1
    s_add_u32 s51, s51, 6
    s_cmp_ge_u32 s50, 4
    s_cbranch_scc1 LAST0
    s_waitcnt lgkmcnt(5)
    v_readfirstlane_b32 s66, v252
    s_add_u32 s53, s53, 1
    v_mov_b32 v252, s53
    s_cmp_le_u32 s53, s66
    ds_write2_b32 v251, v252, v252 offset0:0 offset1:8
    s_setprio 1
    s_cbranch_scc1 PRIO_4
    s_setprio 0
PRIO_4:
    s_cmp_eq_u32 s52, 4
    s_cbranch_scc1 ITEM_0_4
    s_cmp_eq_u32 s52, 5
    s_cbranch_scc1 ITEM_0_5
    s_cmp_eq_u32 s52, 3
    s_cbranch_scc1 ITEM_0_3
    s_cmp_eq_u32 s52, 6
    s_cbranch_scc1 ITEM_0_6
    s_cmp_eq_u32 s52, 8
    s_cbranch_scc1 ITEM_0_8
    s_branch ITEM_0_2
.p2align 6
ITEM_0_5:
    s_mov_b64 exec, s[54:55]
    ds_read_u16_d16_hi v243, v250 offset:128
    s_mov_b64 exec, -1
    ds_read_b64_tr_b16 v[72:73], v249 offset:512
    ds_read_b64_tr_b16 v[76:77], v249 offset:576
    ds_read_b64_tr_b16 v[74:75], v249 offset:768
    ds_read_b64_tr_b16 v[78:79], v249 offset:832
    ds_read_b64_tr_b16 v[80:81], v249 offset:1024
    ds_read_b64_tr_b16 v[84:85], v249 offset:1088
    s_waitcnt lgkmcnt(7)
    v_mul_f32_dpp v196, v242, v64 row_newbcast:0 row_mask:0xf bank_mask:0xf
    v_mul_f32_dpp v197, v242, v65 row_newbcast:1 row_mask:0xf bank_mask:0xf
    v_mul_f32_dpp v198, v242, v64 row_newbcast:8 row_mask:0xf bank_mask:0xf
    v_mul_f32_dpp v199, v242, v65 row_newbcast:9 row_mask:0xf bank_mask:0xf
    v_mul_f32_dpp v200, v242, v68 row_newbcast:2 row_mask:0xf bank_mask:0xf
    v_mul_f32_dpp v201, v242, v69 row_newbcast:3 row_mask:0xf bank_mask:0xf
    v_mul_f32_dpp v202, v242, v68 row_newbcast:10 row_mask:0xf bank_mask:0xf
    v_mul_f32_dpp v203, v242, v69 row_newbcast:11 row_mask:0xf bank_mask:0xf
    v_cvt_pk_bf16_f32 v64, v196, v197
    v_cvt_pk_bf16_f32 v68, v198, v199
    v_cvt_pk_bf16_f32 v65, v200, v201
    v_cvt_pk_bf16_f32 v69, v202, v203
    v_mul_f32_dpp v196, v242, v66 row_newbcast:4 row_mask:0xf bank_mask:0xf
    v_mul_f32_dpp v197, v242, v67 row_newbcast:5 row_mask:0xf bank_mask:0xf
    v_mul_f32_dpp v198, v242, v66 row_newbcast:12 row_mask:0xf bank_mask:0xf
    v_mul_f32_dpp v199, v242, v67 row_newbcast:13 row_mask:0xf bank_mask:0xf
    v_mul_f32_dpp v200, v242, v70 row_newbcast:6 row_mask:0xf bank_mask:0xf
    v_mul_f32_dpp v201, v242, v71 row_newbcast:7 row_mask:0xf bank_mask:0xf
    v_mul_f32_dpp v202, v242, v70 row_newbcast:14 row_mask:0xf bank_mask:0xf
    v_mul_f32_dpp v203, v242, v71 row_newbcast:15 row_mask:0xf bank_mask:0xf
    v_cvt_pk_bf16_f32 v66, v196, v197
    v_cvt_pk_bf16_f32 v70, v198, v199
    v_cvt_pk_bf16_f32 v67, v200, v201
    v_cvt_pk_bf16_f32 v71, v202, v203
    s_mov_b64 exec, s[54:55]
    ds_read_u16_d16_hi v242, v250 offset:256
    s_mov_b64 exec, -1
    s_waitcnt vmcnt(4) lgkmcnt(3)
    v_mfma_f32_32x32x16_bf16 v[0:15], v[64:67], v[176:179], 0
    v_mul_f32_dpp v196, v243, v72 row_newbcast:0 row_mask:0xf bank_mask:0xf
    v_mul_f32_dpp v197, v243, v73 row_newbcast:1 row_mask:0xf bank_mask:0xf
    v_mul_f32_dpp v198, v243, v72 row_newbcast:8 row_mask:0xf bank_mask:0xf
    v_mul_f32_dpp v199, v243, v73 row_newbcast:9 row_mask:0xf bank_mask:0xf
    v_mul_f32_dpp v200, v243, v76 row_newbcast:2 row_mask:0xf bank_mask:0xf
    v_mul_f32_dpp v201, v243, v77 row_newbcast:3 row_mask:0xf bank_mask:0xf
    v_mul_f32_dpp v202, v243, v76 row_newbcast:10 row_mask:0xf bank_mask:0xf
    v_mul_f32_dpp v203, v243, v77 row_newbcast:11 row_mask:0xf bank_mask:0xf
    v_cvt_pk_bf16_f32 v72, v196, v197
    v_cvt_pk_bf16_f32 v76, v198, v199
    v_cvt_pk_bf16_f32 v73, v200, v201
    v_cvt_pk_bf16_f32 v77, v202, v203
    s_add_u32 m0, s21, 0
    v_mfma_f32_32x32x16_bf16 v[16:31], v[68:71], v[176:179], 0
    buffer_load_dwordx4 v236, s[4:7], s35 offen lds
    buffer_load_dwordx4 v237, s[8:11], s35 offen offset:1024 lds
    ds_read_b64_tr_b16 v[176:177], v244 offset:2048
    ds_read_b64_tr_b16 v[178:179], v244 offset:3072
    ds_read_b64_tr_b16 v[184:185], v245 offset:2048
    ds_read_b64_tr_b16 v[186:187], v245 offset:3072
    v_mul_f32_dpp v196, v243, v74 row_newbcast:4 row_mask:0xf bank_mask:0xf
    v_mul_f32_dpp v197, v243, v75 row_newbcast:5 row_mask:0xf bank_mask:0xf
    v_mul_f32_dpp v198, v243, v74 row_newbcast:12 row_mask:0xf bank_mask:0xf
    v_mul_f32_dpp v199, v243, v75 row_newbcast:13 row_mask:0xf bank_mask:0xf
    v_mul_f32_dpp v200, v243, v78 row_newbcast:6 row_mask:0xf bank_mask:0xf
    v_mul_f32_dpp v201, v243, v79 row_newbcast:7 row_mask:0xf bank_mask:0xf
    v_mul_f32_dpp v202, v243, v78 row_newbcast:14 row_mask:0xf bank_mask:0xf
    v_mul_f32_dpp v203, v243, v79 row_newbcast:15 row_mask:0xf bank_mask:0xf
    v_cvt_pk_bf16_f32 v74, v196, v197
    v_cvt_pk_bf16_f32 v78, v198, v199
    v_cvt_pk_bf16_f32 v75, v200, v201
    v_cvt_pk_bf16_f32 v79, v202, v203
    s_nop 0
    s_waitcnt vmcnt(4) lgkmcnt(0)
    v_mfma_f32_32x32x16_bf16 v[0:15], v[72:75], v[176:179], v[0:15]
    v_mul_f32_dpp v196, v242, v80 row_newbcast:0 row_mask:0xf bank_mask:0xf
    v_mul_f32_dpp v197, v242, v81 row_newbcast:1 row_mask:0xf bank_mask:0xf
    v_mul_f32_dpp v198, v242, v80 row_newbcast:8 row_mask:0xf bank_mask:0xf
    v_mul_f32_dpp v199, v242, v81 row_newbcast:9 row_mask:0xf bank_mask:0xf
    v_mul_f32_dpp v200, v242, v84 row_newbcast:2 row_mask:0xf bank_mask:0xf
    v_mul_f32_dpp v201, v242, v85 row_newbcast:3 row_mask:0xf bank_mask:0xf
    s_add_u32 m0, s21, 2048
    v_mfma_f32_32x32x16_bf16 v[16:31], v[76:79], v[176:179], v[16:31]
    buffer_load_dwordx4 v238, s[4:7], s35 offen lds
    ds_read_b64_tr_b16 v[176:177], v244 offset:4096
    ds_read_b64_tr_b16 v[188:189], v245 offset:4096
    v_mul_f32_dpp v202, v242, v84 row_newbcast:10 row_mask:0xf bank_mask:0xf
    v_mul_f32_dpp v203, v242, v85 row_newbcast:11 row_mask:0xf bank_mask:0xf
    v_cvt_pk_bf16_f32 v80, v196, v197
    v_cvt_pk_bf16_f32 v84, v198, v199
    v_cvt_pk_bf16_f32 v81, v200, v201
    v_cvt_pk_bf16_f32 v85, v202, v203
    s_nop 0
    s_waitcnt lgkmcnt(0)
    v_mfma_f32_32x32x8_bf16 v[0:15], v[80:81], v[176:177], v[0:15]
    s_add_u32 m0, s21, 4096
    v_mfma_f32_32x32x8_bf16 v[16:31], v[84:85], v[176:177], v[16:31]
    buffer_load_dwordx4 v234, s[4:7], s36 offen lds
    buffer_load_dwordx4 v235, s[8:11], s36 offen offset:1024 lds
    s_mov_b32 m0, s50
    s_nop 0
    s_movrels_b32 s71, s23
    s_bfe_u32 s46, s71, 0x30012
    s_mov_b32 m0, s46
    s_and_b32 s66, s71, 0x3ffff
    s_movrels_b32 s68, s57
    s_movrels_b32 s69, s61
    s_sub_u32 s48, s66, s47
    s_mov_b32 s47, s66
    s_lshr_b32 s52, s71, 28
    s_lshl_b32 s67, s46, 9
    s_add_u32 s66, s66, s67
    s_sub_u32 s49, s66, s42
    s_mov_b32 s42, s66
    s_bfe_u32 s66, s68, 655360
    s_add_u32 s43, s42, s66
    s_bfe_u32 s39, s69, 655360
    s_bfe_u32 s66, s68, 655370
    s_add_u32 s44, s42, s66
    s_bfe_u32 s40, s69, 655370
    s_bfe_u32 s66, s68, 655380
    s_add_u32 s45, s42, s66
    s_bfe_u32 s41, s69, 655380
    s_and_b32 s66, s46, s33
    s_cselect_b32 s72, -1, 1
    s_cselect_b32 s76, s47, 163712
    s_cmp_ge_u32 s66, 2
    s_cselect_b32 s73, -1, 0
    s_add_u32 s77, s47, 1024
    s_cmp_ge_u32 s66, 4
    s_cselect_b32 s75, -1, 0
    s_cmp_ge_u32 s66, 3
    s_cselect_b32 s74, -1, 1
    s_cselect_b32 s77, s77, 163712
    v_add_u32 v252, s45, v247
    ds_read_u16 v240, v252
    ds_read_u16 v241, v252 offset:64
    v_mfma_f32_32x32x16_bf16 v[32:47], v[64:67], v[180:183], 0
    v_mul_f32 v196, v0, v96
    v_fmac_f32 v196, v1, v97
    v_fmac_f32 v196, v2, v98
    v_fmac_f32 v196, v3, v99
    v_fmac_f32 v196, v4, v100
    v_fmac_f32 v196, v5, v101
    v_fmac_f32 v196, v6, v102
    v_mfma_f32_32x32x16_bf16 v[48:63], v[68:71], v[180:183], 0
    v_add_u32 v253, s47, v248
    ds_read_b32 v254, v253
    ds_read_b32 v255, v253 offset:256
    v_fmac_f32 v196, v7, v103
    v_mul_f32 v198, v8, v128
    v_fmac_f32 v198, v9, v129
    v_fmac_f32 v198, v10, v130
    v_fmac_f32 v198, v11, v131
    v_fmac_f32 v198, v12, v132
    v_mfma_f32_32x32x16_bf16 v[32:47], v[72:75], v[184:187], v[32:47]
    v_fmac_f32 v198, v13, v133
    v_fmac_f32 v198, v14, v134
    v_fmac_f32 v198, v15, v135
    v_mul_f32 v200, v16, v128
    v_fmac_f32 v200, v17, v129
    v_permlane32_swap_b32 v196, v198
    v_mfma_f32_32x32x16_bf16 v[48:63], v[76:79], v[184:187], v[48:63]
    s_waitcnt vmcnt(5)
    ds_read_b64_tr_b16 v[176:177], v244 offset:6144
    ds_read_b64_tr_b16 v[178:179], v244 offset:7168
    ds_read_b64_tr_b16 v[180:181], v245 offset:6144
    ds_read_b64_tr_b16 v[182:183], v245 offset:7168
    v_fmac_f32 v200, v18, v130
    v_fmac_f32 v200, v19, v131
    v_fmac_f32 v200, v20, v132
    v_fmac_f32 v200, v21, v133
    v_fmac_f32 v200, v22, v134
    v_fmac_f32 v200, v23, v135
    v_mfma_f32_32x32x8_bf16 v[32:47], v[80:81], v[188:189], v[32:47]
    v_add_f32 v198, v196, v198
    v_mul_f32_e64 v202, v24, -v128
    v_fma_f32 v202, v25, -v129, v202
    v_fma_f32 v202, v26, -v130, v202
    v_fma_f32 v202, v27, -v131, v202
    v_fma_f32 v202, v28, -v132, v202
    v_mfma_f32_32x32x8_bf16 v[48:63], v[84:85], v[188:189], v[48:63]
    v_fma_f32 v202, v29, -v133, v202
    v_fma_f32 v202, v30, -v134, v202
    v_fma_f32 v202, v31, -v135, v202
    s_nop 1
    v_permlane32_swap_b32 v200, v202
    v_add_f32 v202, v200, v202
    s_waitcnt vmcnt(3) lgkmcnt(0)
    v_mfma_f32_32x32x16_bf16 v[0:15], v[64:67], v[176:179], 0
    v_mul_f32 v197, v32, v104
    v_fmac_f32 v197, v33, v105
    v_fmac_f32 v197, v34, v106
    v_fmac_f32 v197, v35, v107
    v_fmac_f32 v197, v36, v108
    v_fmac_f32 v197, v37, v109
    v_fmac_f32 v197, v38, v110
    s_add_u32 m0, s21, 6144
    v_mfma_f32_32x32x16_bf16 v[16:31], v[68:71], v[176:179], 0
    buffer_load_dwordx4 v236, s[4:7], s36 offen lds
    buffer_load_dwordx4 v237, s[8:11], s36 offen offset:1024 lds
    ds_read_b64_tr_b16 v[176:177], v244 offset:0
    ds_read_b64_tr_b16 v[178:179], v244 offset:1024
    ds_read_b64_tr_b16 v[184:185], v245 offset:0
    ds_read_b64_tr_b16 v[186:187], v245 offset:1024
    s_mov_b32 m0, s76
    s_mov_b64 exec, s[72:73]
    buffer_load_dwordx4 v254, s[12:15], 0 offen  lds
    s_mov_b32 m0, s77
    s_mov_b64 exec, s[74:75]
    buffer_load_dwordx4 v255, s[12:15], 0 offen  lds
    s_mov_b64 exec, -1
    v_fmac_f32 v197, v39, v111
    v_mul_f32 v199, v40, v136
    v_fmac_f32 v199, v41, v137
    v_fmac_f32 v199, v42, v138
    v_fmac_f32 v199, v43, v139
    v_fmac_f32 v199, v44, v140
    v_fmac_f32 v199, v45, v141
    s_waitcnt vmcnt(6) lgkmcnt(0)
    v_mfma_f32_32x32x16_bf16 v[0:15], v[72:75], v[176:179], v[0:15]
    v_fmac_f32 v199, v46, v142
    v_fmac_f32 v199, v47, v143
    v_mul_f32 v201, v48, v136
    v_fmac_f32 v201, v49, v137
    v_permlane32_swap_b32 v197, v199
    v_fmac_f32 v201, v50, v138
    v_fmac_f32 v201, v51, v139
    s_add_u32 m0, s21, 0
    v_mfma_f32_32x32x16_bf16 v[16:31], v[76:79], v[176:179], v[16:31]
    buffer_load_dwordx4 v238, s[4:7], s36 offen lds
    ds_read_b64_tr_b16 v[176:177], v244 offset:2048
    ds_read_b64_tr_b16 v[188:189], v245 offset:2048
    v_fmac_f32 v201, v52, v140
    v_fmac_f32 v201, v53, v141
    v_fmac_f32 v201, v54, v142
    v_fmac_f32 v201, v55, v143
    v_add_f32 v199, v197, v199
    v_mul_f32_e64 v203, v56, -v136
    v_fma_f32 v203, v57, -v137, v203
    s_waitcnt lgkmcnt(0)
    v_mfma_f32_32x32x8_bf16 v[0:15], v[80:81], v[176:177], v[0:15]
    v_fma_f32 v203, v58, -v138, v203
    v_fma_f32 v203, v59, -v139, v203
    v_fma_f32 v203, v60, -v140, v203
    v_fma_f32 v203, v61, -v141, v203
    v_fma_f32 v203, v62, -v142, v203
    v_fma_f32 v203, v63, -v143, v203
    s_nop 1
    s_add_u32 m0, s21, 2048
    v_mfma_f32_32x32x8_bf16 v[16:31], v[84:85], v[176:177], v[16:31]
    buffer_load_dwordx4 v234, s[4:7], s37 offen lds
    buffer_load_dwordx4 v235, s[8:11], s37 offen offset:1024 lds
    v_add_u32 v252, s42, v247
    ds_read_u16 v234, v252
    ds_read_u16 v235, v252 offset:64
    v_permlane32_swap_b32 v201, v203
    v_add_f32 v203, v201, v203
    s_set_gpr_idx_on s51, gpr_idx(DST)
    s_nop 0
    v_cvt_pk_bf16_f32 v204, v198, v199
    v_cvt_pk_bf16_f32 v205, v202, v203
    s_set_gpr_idx_off
    v_mfma_f32_32x32x16_bf16 v[32:47], v[64:67], v[180:183], 0
    v_mul_f32 v196, v0, v144
    v_fmac_f32 v196, v1, v145
    v_fmac_f32 v196, v2, v146
    v_fmac_f32 v196, v3, v147
    v_fmac_f32 v196, v4, v148
    v_fmac_f32 v196, v5, v149
    v_mfma_f32_32x32x16_bf16 v[48:63], v[68:71], v[180:183], 0
    v_fmac_f32 v196, v6, v150
    v_fmac_f32 v196, v7, v151
    v_mul_f32 v198, v8, v112
    v_fmac_f32 v198, v9, v113
    v_fmac_f32 v198, v10, v114
    v_mfma_f32_32x32x16_bf16 v[32:47], v[72:75], v[184:187], v[32:47]
    v_fmac_f32 v198, v11, v115
    v_fmac_f32 v198, v12, v116
    v_fmac_f32 v198, v13, v117
    v_fmac_f32 v198, v14, v118
    v_fmac_f32 v198, v15, v119
    v_mfma_f32_32x32x16_bf16 v[48:63], v[76:79], v[184:187], v[48:63]
    s_waitcnt vmcnt(7)
    ds_read_b64_tr_b16 v[176:177], v244 offset:4096
    ds_read_b64_tr_b16 v[178:179], v244 offset:5120
    ds_read_b64_tr_b16 v[180:181], v245 offset:4096
    ds_read_b64_tr_b16 v[182:183], v245 offset:5120
    v_mul_f32_e64 v200, v16, -v160
    v_fma_f32 v200, v17, -v161, v200
    v_fma_f32 v200, v18, -v162, v200
    v_fma_f32 v200, v19, -v163, v200
    v_fma_f32 v200, v20, -v164, v200
    v_fma_f32 v200, v21, -v165, v200
    v_mfma_f32_32x32x8_bf16 v[32:47], v[80:81], v[188:189], v[32:47]
    v_fma_f32 v200, v22, -v166, v200
    v_fma_f32 v200, v23, -v167, v200
    v_mul_f32_e64 v202, v24, -v160
    v_fma_f32 v202, v25, -v161, v202
    v_fma_f32 v202, v26, -v162, v202
    v_mfma_f32_32x32x8_bf16 v[48:63], v[84:85], v[188:189], v[48:63]
    v_fma_f32 v202, v27, -v163, v202
    v_fma_f32 v202, v28, -v164, v202
    v_fma_f32 v202, v29, -v165, v202
    v_fma_f32 v202, v30, -v166, v202
    v_fma_f32 v202, v31, -v167, v202
    s_waitcnt vmcnt(5) lgkmcnt(0)
    v_mfma_f32_32x32x16_bf16 v[0:15], v[64:67], v[176:179], 0
    v_mul_f32 v197, v32, v152
    v_fmac_f32 v197, v33, v153
    v_fmac_f32 v197, v34, v154
    v_fmac_f32 v197, v35, v155
    v_fmac_f32 v197, v36, v156
    v_fmac_f32 v197, v37, v157
    s_add_u32 m0, s21, 4096
    v_mfma_f32_32x32x16_bf16 v[16:31], v[68:71], v[176:179], 0
    buffer_load_dwordx4 v236, s[4:7], s37 offen lds
    buffer_load_dwordx4 v237, s[8:11], s37 offen offset:1024 lds
    ds_read_b64_tr_b16 v[176:177], v244 offset:6144
    ds_read_b64_tr_b16 v[178:179], v244 offset:7168
    ds_read_b64_tr_b16 v[184:185], v245 offset:6144
    ds_read_b64_tr_b16 v[186:187], v245 offset:7168
    v_add_u32 v252, s43, v247
    ds_read_u16 v236, v252
    ds_read_u16 v237, v252 offset:64
    v_fmac_f32 v197, v38, v158
    v_fmac_f32 v197, v39, v159
    v_mul_f32 v199, v40, v120
    v_fmac_f32 v199, v41, v121
    v_fmac_f32 v199, v42, v122
    s_waitcnt vmcnt(4) lgkmcnt(2)
    v_mfma_f32_32x32x16_bf16 v[0:15], v[72:75], v[176:179], v[0:15]
    v_fmac_f32 v199, v43, v123
    v_fmac_f32 v199, v44, v124
    v_fmac_f32 v199, v45, v125
    v_fmac_f32 v199, v46, v126
    v_fmac_f32 v199, v47, v127
    s_add_u32 m0, s21, 6144
    v_mfma_f32_32x32x16_bf16 v[16:31], v[76:79], v[176:179], v[16:31]
    buffer_load_dwordx4 v238, s[4:7], s37 offen lds
    ds_read_b64_tr_b16 v[176:177], v244 offset:0
    ds_read_b64_tr_b16 v[188:189], v245 offset:0
    v_add_u32 v252, s44, v247
    ds_read_u16 v238, v252
    ds_read_u16 v239, v252 offset:64
    v_mul_f32_e64 v201, v48, -v168
    v_fma_f32 v201, v49, -v169, v201
    v_fma_f32 v201, v50, -v170, v201
    v_fma_f32 v201, v51, -v171, v201
    v_fma_f32 v201, v52, -v172, v201
    v_fma_f32 v201, v53, -v173, v201
    s_waitcnt lgkmcnt(2)
    v_mfma_f32_32x32x8_bf16 v[0:15], v[80:81], v[176:177], v[0:15]
    v_fma_f32 v201, v54, -v174, v201
    v_fma_f32 v201, v55, -v175, v201
    v_mul_f32_e64 v203, v56, -v168
    v_fma_f32 v203, v57, -v169, v203
    v_fma_f32 v203, v58, -v170, v203
    s_add_u32 m0, s21, 0
    v_mfma_f32_32x32x8_bf16 v[16:31], v[84:85], v[176:177], v[16:31]
    v_lshl_add_u32 v234, v234, 10, v246
    v_lshl_add_u32 v235, v235, 10, v246
    buffer_load_dwordx4 v234, s[4:7], s38 offen lds
    buffer_load_dwordx4 v235, s[8:11], s38 offen offset:1024 lds
    v_fma_f32 v203, v59, -v171, v203
    v_fma_f32 v203, v60, -v172, v203
    v_fma_f32 v203, v61, -v173, v203
    v_fma_f32 v203, v62, -v174, v203
    v_fma_f32 v203, v63, -v175, v203
    v_mfma_f32_32x32x16_bf16 v[32:47], v[64:67], v[180:183], 0
    v_mul_f32 v254, v0, v144
    v_fmac_f32 v254, v1, v145
    v_fmac_f32 v254, v2, v146
    v_mfma_f32_32x32x16_bf16 v[48:63], v[68:71], v[180:183], 0
    ds_swizzle_b32 v68, v68 offset:0x401F
    ds_swizzle_b32 v69, v69 offset:0x401F
    ds_swizzle_b32 v70, v70 offset:0x401F
    ds_swizzle_b32 v71, v71 offset:0x401F
    v_fmac_f32 v254, v3, v147
    v_fmac_f32 v254, v4, v148
    v_fmac_f32 v254, v5, v149
    v_mfma_f32_32x32x16_bf16 v[32:47], v[72:75], v[184:187], v[32:47]
    v_fmac_f32 v254, v6, v150
    v_fmac_f32 v254, v7, v151
    v_fmac_f32 v200, v8, v160
    v_mfma_f32_32x32x16_bf16 v[48:63], v[76:79], v[184:187], v[48:63]
    ds_swizzle_b32 v76, v76 offset:0x401F
    ds_swizzle_b32 v77, v77 offset:0x401F
    ds_swizzle_b32 v78, v78 offset:0x401F
    ds_swizzle_b32 v79, v79 offset:0x401F
    s_waitcnt vmcnt(5)
    ds_read_b64_tr_b16 v[176:177], v244 offset:2048
    ds_read_b64_tr_b16 v[178:179], v244 offset:3072
    ds_read_b64_tr_b16 v[180:181], v245 offset:2048
    ds_read_b64_tr_b16 v[182:183], v245 offset:3072
    v_fmac_f32 v200, v9, v161
    v_permlane32_swap_b32 v196, v254
    v_fmac_f32 v200, v10, v162
    v_mfma_f32_32x32x8_bf16 v[32:47], v[80:81], v[188:189], v[32:47]
    v_fmac_f32 v200, v11, v163
    v_fmac_f32 v200, v12, v164
    v_fmac_f32 v200, v13, v165
    v_mfma_f32_32x32x8_bf16 v[48:63], v[84:85], v[188:189], v[48:63]
    ds_swizzle_b32 v84, v84 offset:0x401F
    ds_swizzle_b32 v85, v85 offset:0x401F
    v_fmac_f32 v200, v14, v166
    v_fmac_f32 v200, v15, v167
    v_add_f32 v254, v196, v254
    s_waitcnt lgkmcnt(6)
    s_mov_b64 exec, s[56:57]
    v_xor_b32 v68, 0x80008000, v68
    v_xor_b32 v69, 0x80008000, v69
    v_xor_b32 v70, 0x80008000, v70
    v_xor_b32 v71, 0x80008000, v71
    v_xor_b32 v76, 0x80008000, v76
    v_xor_b32 v77, 0x80008000, v77
    v_xor_b32 v78, 0x80008000, v78
    v_xor_b32 v79, 0x80008000, v79
    s_mov_b64 exec, -1
    s_waitcnt vmcnt(3) lgkmcnt(2)
    v_mfma_f32_32x32x16_bf16 v[0:15], v[64:67], v[176:179], 0
    v_mul_f32 v255, v32, v152
    v_fmac_f32 v255, v33, v153
    v_fmac_f32 v255, v34, v154
    v_fmac_f32 v255, v35, v155
    s_add_u32 m0, s21, 2048
    v_mfma_f32_32x32x16_bf16 v[16:31], v[68:71], v[176:179], v[16:31]
    v_lshl_add_u32 v236, v236, 10, v246
    v_lshl_add_u32 v237, v237, 10, v246
    buffer_load_dwordx4 v236, s[4:7], s39 offen lds
    buffer_load_dwordx4 v237, s[8:11], s39 offen offset:1024 lds
    ds_read_b64_tr_b16 v[176:177], v244 offset:4096
    ds_read_b64_tr_b16 v[178:179], v244 offset:5120
    ds_read_b64_tr_b16 v[184:185], v245 offset:4096
    ds_read_b64_tr_b16 v[186:187], v245 offset:5120
    v_fmac_f32 v255, v36, v156
    v_fmac_f32 v255, v37, v157
    v_fmac_f32 v255, v38, v158
    v_fmac_f32 v255, v39, v159
    s_waitcnt vmcnt(4) lgkmcnt(0)
    v_mfma_f32_32x32x16_bf16 v[0:15], v[72:75], v[176:179], v[0:15]
    v_fmac_f32 v201, v40, v168
    v_fmac_f32 v201, v41, v169
    v_permlane32_swap_b32 v197, v255
    s_add_u32 m0, s21, 4096
    v_mfma_f32_32x32x16_bf16 v[16:31], v[76:79], v[176:179], v[16:31]
    v_lshl_add_u32 v238, v238, 10, v246
    v_lshl_add_u32 v239, v239, 10, v246
    buffer_load_dwordx4 v238, s[4:7], s40 offen lds
    buffer_load_dwordx4 v239, s[8:11], s40 offen offset:1024 lds
    ds_read_b64_tr_b16 v[176:177], v244 offset:6144
    ds_read_b64_tr_b16 v[188:189], v245 offset:6144
    v_fmac_f32 v201, v42, v170
    v_fmac_f32 v201, v43, v171
    v_fmac_f32 v201, v44, v172
    v_fmac_f32 v201, v45, v173
    s_waitcnt lgkmcnt(0)
    s_mov_b64 exec, s[56:57]
    v_xor_b32 v84, 0x80008000, v84
    v_xor_b32 v85, 0x80008000, v85
    s_mov_b64 exec, -1
    v_mfma_f32_32x32x8_bf16 v[0:15], v[80:81], v[176:177], v[0:15]
    v_fmac_f32 v201, v46, v174
    v_fmac_f32 v201, v47, v175
    v_add_f32 v255, v197, v255
    s_set_gpr_idx_on s51, gpr_idx(DST)
    s_nop 0
    v_cvt_pk_bf16_f32 v206, v254, v255
    s_set_gpr_idx_off
    s_add_u32 m0, s21, 6144
    v_mfma_f32_32x32x8_bf16 v[16:31], v[84:85], v[176:177], v[16:31]
    v_lshl_add_u32 v240, v240, 10, v246
    v_lshl_add_u32 v241, v241, 10, v246
    buffer_load_dwordx4 v240, s[4:7], s41 offen lds
    buffer_load_dwordx4 v241, s[8:11], s41 offen offset:1024 lds
    v_mfma_f32_32x32x16_bf16 v[32:47], v[64:67], v[180:183], 0
    v_mul_f32 v254, v0, v144
    v_fmac_f32 v254, v1, v145
    v_fmac_f32 v254, v2, v146
    v_fmac_f32 v254, v3, v147
    v_fmac_f32 v254, v4, v148
    v_fmac_f32 v254, v5, v149
    v_fmac_f32 v254, v6, v150
    v_mfma_f32_32x32x16_bf16 v[48:63], v[68:71], v[180:183], v[48:63]
    v_fmac_f32 v254, v7, v151
    v_fma_f32 v202, v8, -v160, v202
    v_fma_f32 v202, v9, -v161, v202
    v_permlane32_swap_b32 v254, v200
    v_fma_f32 v202, v10, -v162, v202
    v_fma_f32 v202, v11, -v163, v202
    v_mfma_f32_32x32x16_bf16 v[32:47], v[72:75], v[184:187], v[32:47]
    v_fma_f32 v202, v12, -v164, v202
    v_fma_f32 v202, v13, -v165, v202
    v_fma_f32 v202, v14, -v166, v202
    v_fma_f32 v202, v15, -v167, v202
    v_add_f32 v200, v254, v200
    v_fmac_f32 v198, v16, v112
    v_permlane32_swap_b32 v202, v254
    v_mfma_f32_32x32x16_bf16 v[48:63], v[76:79], v[184:187], v[48:63]
    s_waitcnt vmcnt(6)
    ds_read_b64_tr_b16 v[176:177], v244 offset:0
    ds_read_b64_tr_b16 v[178:179], v244 offset:1024
    ds_read_b64_tr_b16 v[180:181], v245 offset:0
    ds_read_b64_tr_b16 v[182:183], v245 offset:1024
    v_fmac_f32 v198, v17, v113
    v_fmac_f32 v198, v18, v114
    v_fmac_f32 v198, v19, v115
    v_fmac_f32 v198, v20, v116
    v_fmac_f32 v198, v21, v117
    v_fmac_f32 v198, v22, v118
    v_mfma_f32_32x32x8_bf16 v[32:47], v[80:81], v[188:189], v[32:47]
    v_fmac_f32 v198, v23, v119
    v_add_f32 v254, v202, v254
    v_mul_f32 v196, v24, v160
    v_fmac_f32 v196, v25, v161
    v_fmac_f32 v196, v26, v162
    v_fmac_f32 v196, v27, v163
    v_fmac_f32 v196, v28, v164
    v_mfma_f32_32x32x8_bf16 v[48:63], v[84:85], v[188:189], v[48:63]
    v_add_u32 v249, s48, v249
    v_add_u32 v250, s49, v250
    ds_read_b32 v252, v251 offset:16
    ds_read_b64_tr_b16 v[64:65], v249 offset:0
    ds_read_b64_tr_b16 v[68:69], v249 offset:64
    ds_read_b64_tr_b16 v[66:67], v249 offset:256
    ds_read_b64_tr_b16 v[70:71], v249 offset:320
    s_mov_b64 exec, s[54:55]
    ds_read_u16_d16_hi v242, v250 offset:0
    s_mov_b64 exec, -1
    v_fmac_f32 v196, v29, v165
    v_fmac_f32 v196, v30, v166
    v_fmac_f32 v196, v31, v167
    s_nop 1
    v_permlane32_swap_b32 v198, v196
    v_add_f32 v196, v198, v196
    v_mul_f32 v255, v32, v152
    v_fmac_f32 v255, v33, v153
    v_fmac_f32 v255, v34, v154
    v_fmac_f32 v255, v35, v155
    v_fmac_f32 v255, v36, v156
    v_fmac_f32 v255, v37, v157
    v_fmac_f32 v255, v38, v158
    v_fmac_f32 v255, v39, v159
    v_fma_f32 v203, v40, -v168, v203
    v_fma_f32 v203, v41, -v169, v203
    v_permlane32_swap_b32 v255, v201
    v_fma_f32 v203, v42, -v170, v203
    v_fma_f32 v203, v43, -v171, v203
    v_fma_f32 v203, v44, -v172, v203
    v_fma_f32 v203, v45, -v173, v203
    v_fma_f32 v203, v46, -v174, v203
    v_fma_f32 v203, v47, -v175, v203
    v_add_f32 v201, v255, v201
    v_fmac_f32 v199, v48, v120
    v_permlane32_swap_b32 v203, v255
    v_fmac_f32 v199, v49, v121
    v_fmac_f32 v199, v50, v122
    v_fmac_f32 v199, v51, v123
    v_fmac_f32 v199, v52, v124
    v_fmac_f32 v199, v53, v125
    v_fmac_f32 v199, v54, v126
    v_fmac_f32 v199, v55, v127
    v_add_f32 v255, v203, v255
    v_mul_f32 v197, v56, v168
    v_fmac_f32 v197, v57, v169
    v_fmac_f32 v197, v58, v170
    v_fmac_f32 v197, v59, v171
    v_fmac_f32 v197, v60, v172
    v_fmac_f32 v197, v61, v173
    v_fmac_f32 v197, v62, v174
    v_fmac_f32 v197, v63, v175
    s_nop 1
    v_permlane32_swap_b32 v199, v197
    v_add_f32 v197, v199, v197
    s_set_gpr_idx_on s51, gpr_idx(DST)
    s_nop 0
    v_cvt_pk_bf16_f32 v207, v200, v201
    v_cvt_pk_bf16_f32 v209, v254, v255
    v_cvt_pk_bf16_f32 v208, v196, v197
    s_set_gpr_idx_off
    s_add_u32 s50, s50, 1
    s_add_u32 s51, s51, 6
    s_cmp_ge_u32 s50, 4
    s_cbranch_scc1 LAST0
    s_waitcnt lgkmcnt(5)
    v_readfirstlane_b32 s66, v252
    s_add_u32 s53, s53, 1
    v_mov_b32 v252, s53
    s_cmp_le_u32 s53, s66
    ds_write2_b32 v251, v252, v252 offset0:0 offset1:8
    s_setprio 1
    s_cbranch_scc1 PRIO_5
    s_setprio 0
PRIO_5:
    s_cmp_eq_u32 s52, 4
    s_cbranch_scc1 ITEM_0_4
    s_cmp_eq_u32 s52, 5
    s_cbranch_scc1 ITEM_0_5
    s_cmp_eq_u32 s52, 3
    s_cbranch_scc1 ITEM_0_3
    s_cmp_eq_u32 s52, 6
    s_cbranch_scc1 ITEM_0_6
    s_cmp_eq_u32 s52, 8
    s_cbranch_scc1 ITEM_0_8
    s_branch ITEM_0_2
.p2align 6
ITEM_0_3:
    s_mov_b64 exec, s[54:55]
    ds_read_u16_d16_hi v243, v250 offset:128
    s_mov_b64 exec, -1
    ds_read_b64_tr_b16 v[72:73], v249 offset:512
    ds_read_b64_tr_b16 v[76:77], v249 offset:576
    s_waitcnt lgkmcnt(3)
    v_mul_f32_dpp v196, v242, v64 row_newbcast:0 row_mask:0xf bank_mask:0xf
    v_mul_f32_dpp v197, v242, v65 row_newbcast:1 row_mask:0xf bank_mask:0xf
    v_mul_f32_dpp v198, v242, v64 row_newbcast:8 row_mask:0xf bank_mask:0xf
    v_mul_f32_dpp v199, v242, v65 row_newbcast:9 row_mask:0xf bank_mask:0xf
    v_mul_f32_dpp v200, v242, v68 row_newbcast:2 row_mask:0xf bank_mask:0xf
    v_mul_f32_dpp v201, v242, v69 row_newbcast:3 row_mask:0xf bank_mask:0xf
    v_mul_f32_dpp v202, v242, v68 row_newbcast:10 row_mask:0xf bank_mask:0xf
    v_mul_f32_dpp v203, v242, v69 row_newbcast:11 row_mask:0xf bank_mask:0xf
    v_cvt_pk_bf16_f32 v64, v196, v197
    v_cvt_pk_bf16_f32 v68, v198, v199
    v_cvt_pk_bf16_f32 v65, v200, v201
    v_cvt_pk_bf16_f32 v69, v202, v203
    v_mul_f32_dpp v196, v242, v66 row_newbcast:4 row_mask:0xf bank_mask:0xf
    v_mul_f32_dpp v197, v242, v67 row_newbcast:5 row_mask:0xf bank_mask:0xf
    v_mul_f32_dpp v198, v242, v66 row_newbcast:12 row_mask:0xf bank_mask:0xf
    v_mul_f32_dpp v199, v242, v67 row_newbcast:13 row_mask:0xf bank_mask:0xf
    v_mul_f32_dpp v200, v242, v70 row_newbcast:6 row_mask:0xf bank_mask:0xf
    v_mul_f32_dpp v201, v242, v71 row_newbcast:7 row_mask:0xf bank_mask:0xf
    v_mul_f32_dpp v202, v242, v70 row_newbcast:14 row_mask:0xf bank_mask:0xf
    v_mul_f32_dpp v203, v242, v71 row_newbcast:15 row_mask:0xf bank_mask:0xf
    v_cvt_pk_bf16_f32 v66, v196, v197
    v_cvt_pk_bf16_f32 v70, v198, v199
    v_cvt_pk_bf16_f32 v67, v200, v201
    v_cvt_pk_bf16_f32 v71, v202, v203
    s_nop 0
    s_waitcnt vmcnt(4) lgkmcnt(0)
    v_mfma_f32_32x32x16_bf16 v[0:15], v[64:67], v[176:179], 0
    v_mul_f32_dpp v196, v243, v72 row_newbcast:0 row_mask:0xf bank_mask:0xf
    v_mul_f32_dpp v197, v243, v73 row_newbcast:1 row_mask:0xf bank_mask:0xf
    v_mul_f32_dpp v198, v243, v72 row_newbcast:8 row_mask:0xf bank_mask:0xf
    v_mul_f32_dpp v199, v243, v73 row_newbcast:9 row_mask:0xf bank_mask:0xf
    v_mul_f32_dpp v200, v243, v76 row_newbcast:2 row_mask:0xf bank_mask:0xf
    v_mul_f32_dpp v201, v243, v77 row_newbcast:3 row_mask:0xf bank_mask:0xf
    s_add_u32 m0, s21, 0
    v_mfma_f32_32x32x16_bf16 v[16:31], v[68:71], v[176:179], 0
    buffer_load_dwordx4 v234, s[4:7], s36 offen lds
    buffer_load_dwordx4 v235, s[8:11], s36 offen offset:1024 lds
    ds_read_b64_tr_b16 v[176:177], v244 offset:2048
    ds_read_b64_tr_b16 v[184:185], v245 offset:2048
    v_mul_f32_dpp v202, v243, v76 row_newbcast:10 row_mask:0xf bank_mask:0xf
    v_mul_f32_dpp v203, v243, v77 row_newbcast:11 row_mask:0xf bank_mask:0xf
    v_cvt_pk_bf16_f32 v72, v196, v197
    v_cvt_pk_bf16_f32 v76, v198, v199
    v_cvt_pk_bf16_f32 v73, v200, v201
    v_cvt_pk_bf16_f32 v77, v202, v203
    s_nop 0
    s_waitcnt lgkmcnt(0)
    v_mfma_f32_32x32x8_bf16 v[0:15], v[72:73], v[176:177], v[0:15]
    s_add_u32 m0, s21, 2048
    v_mfma_f32_32x32x8_bf16 v[16:31], v[76:77], v[176:177], v[16:31]
    buffer_load_dwordx4 v236, s[4:7], s36 offen lds
    s_mov_b32 m0, s50
    s_nop 0
    s_movrels_b32 s71, s23
    s_bfe_u32 s46, s71, 0x30012
    s_mov_b32 m0, s46
    s_and_b32 s66, s71, 0x3ffff
    s_movrels_b32 s68, s57
    s_movrels_b32 s69, s61
    s_sub_u32 s48, s66, s47
    s_mov_b32 s47, s66
    s_lshr_b32 s52, s71, 28
    s_lshl_b32 s67, s46, 9
    s_add_u32 s66, s66, s67
    s_sub_u32 s49, s66, s42
    s_mov_b32 s42, s66
    s_bfe_u32 s66, s68, 655360
    s_add_u32 s43, s42, s66
    s_bfe_u32 s39, s69, 655360
    s_bfe_u32 s66, s68, 655370
    s_add_u32 s44, s42, s66
    s_bfe_u32 s40, s69, 655370
    s_bfe_u32 s66, s68, 655380
    s_add_u32 s45, s42, s66
    s_bfe_u32 s41, s69, 655380
    s_and_b32 s66, s46, s33
    s_cselect_b32 s72, -1, 1
    s_cselect_b32 s76, s47, 163712
    s_cmp_ge_u32 s66, 2
    s_cselect_b32 s73, -1, 0
    s_add_u32 s77, s47, 1024
    s_cmp_ge_u32 s66, 4
    s_cselect_b32 s75, -1, 0
    s_cmp_ge_u32 s66, 3
    s_cselect_b32 s74, -1, 1
    s_cselect_b32 s77, s77, 163712
    v_add_u32 v252, s44, v247
    ds_read_u16 v238, v252
    ds_read_u16 v239, v252 offset:64
    v_add_u32 v252, s45, v247
    ds_read_u16 v240, v252
    ds_read_u16 v241, v252 offset:64
    v_mfma_f32_32x32x16_bf16 v[32:47], v[64:67], v[180:183], 0
    v_mul_f32 v196, v0, v96
    v_fmac_f32 v196, v1, v97
    v_fmac_f32 v196, v2, v98
    v_fmac_f32 v196, v3, v99
    v_fmac_f32 v196, v4, v100
    v_fmac_f32 v196, v5, v101
    v_fmac_f32 v196, v6, v102
    v_fmac_f32 v196, v7, v103
    v_mul_f32 v198, v8, v128
    v_fmac_f32 v198, v9, v129
    v_mfma_f32_32x32x16_bf16 v[48:63], v[68:71], v[180:183], 0
    v_add_u32 v253, s47, v248
    ds_read_b32 v254, v253
    ds_read_b32 v255, v253 offset:256
    s_waitcnt vmcnt(5)
    ds_read_b64_tr_b16 v[176:177], v244 offset:4096
    ds_read_b64_tr_b16 v[178:179], v244 offset:5120
    ds_read_b64_tr_b16 v[180:181], v245 offset:4096
    ds_read_b64_tr_b16 v[182:183], v245 offset:5120
    v_fmac_f32 v198, v10, v130
    v_fmac_f32 v198, v11, v131
    v_fmac_f32 v198, v12, v132
    v_fmac_f32 v198, v13, v133
    v_fmac_f32 v198, v14, v134
    v_fmac_f32 v198, v15, v135
    v_mul_f32 v200, v16, v128
    v_fmac_f32 v200, v17, v129
    v_permlane32_swap_b32 v196, v198
    v_mfma_f32_32x32x8_bf16 v[32:47], v[72:73], v[184:185], v[32:47]
    v_fmac_f32 v200, v18, v130
    v_fmac_f32 v200, v19, v131
    v_fmac_f32 v200, v20, v132
    v_fmac_f32 v200, v21, v133
    v_fmac_f32 v200, v22, v134
    v_fmac_f32 v200, v23, v135
    v_add_f32 v198, v196, v198
    v_mul_f32_e64 v202, v24, -v128
    v_fma_f32 v202, v25, -v129, v202
    v_mfma_f32_32x32x8_bf16 v[48:63], v[76:77], v[184:185], v[48:63]
    v_fma_f32 v202, v26, -v130, v202
    v_fma_f32 v202, v27, -v131, v202
    v_fma_f32 v202, v28, -v132, v202
    v_fma_f32 v202, v29, -v133, v202
    v_fma_f32 v202, v30, -v134, v202
    v_fma_f32 v202, v31, -v135, v202
    s_nop 1
    v_permlane32_swap_b32 v200, v202
    v_add_f32 v202, v200, v202
    s_waitcnt vmcnt(3) lgkmcnt(0)
    v_mfma_f32_32x32x16_bf16 v[0:15], v[64:67], v[176:179], 0
    v_mul_f32 v197, v32, v104
    v_fmac_f32 v197, v33, v105
    v_fmac_f32 v197, v34, v106
    v_fmac_f32 v197, v35, v107
    v_fmac_f32 v197, v36, v108
    v_fmac_f32 v197, v37, v109
    v_fmac_f32 v197, v38, v110
    v_fmac_f32 v197, v39, v111
    v_mul_f32 v199, v40, v136
    v_fmac_f32 v199, v41, v137
    v_fmac_f32 v199, v42, v138
    s_add_u32 m0, s21, 4096
    v_mfma_f32_32x32x16_bf16 v[16:31], v[68:71], v[176:179], 0
    buffer_load_dwordx4 v234, s[4:7], s37 offen lds
    buffer_load_dwordx4 v235, s[8:11], s37 offen offset:1024 lds
    ds_read_b64_tr_b16 v[176:177], v244 offset:6144
    ds_read_b64_tr_b16 v[184:185], v245 offset:6144
    v_add_u32 v252, s42, v247
    ds_read_u16 v234, v252
    ds_read_u16 v235, v252 offset:64
    s_mov_b32 m0, s76
    s_mov_b64 exec, s[72:73]
    buffer_load_dwordx4 v254, s[12:15], 0 offen  lds
    s_mov_b32 m0, s77
    s_mov_b64 exec, s[74:75]
    buffer_load_dwordx4 v255, s[12:15], 0 offen  lds
    s_mov_b64 exec, -1
    v_fmac_f32 v199, v43, v139
    v_fmac_f32 v199, v44, v140
    v_fmac_f32 v199, v45, v141
    v_fmac_f32 v199, v46, v142
    v_fmac_f32 v199, v47, v143
    v_mul_f32 v201, v48, v136
    v_fmac_f32 v201, v49, v137
    v_permlane32_swap_b32 v197, v199
    v_fmac_f32 v201, v50, v138
    v_fmac_f32 v201, v51, v139
    s_waitcnt lgkmcnt(2)
    v_mfma_f32_32x32x8_bf16 v[0:15], v[72:73], v[176:177], v[0:15]
    v_fmac_f32 v201, v52, v140
    v_fmac_f32 v201, v53, v141
    v_fmac_f32 v201, v54, v142
    v_fmac_f32 v201, v55, v143
    v_add_f32 v199, v197, v199
    v_mul_f32_e64 v203, v56, -v136
    v_fma_f32 v203, v57, -v137, v203
    v_fma_f32 v203, v58, -v138, v203
    v_fma_f32 v203, v59, -v139, v203
    v_fma_f32 v203, v60, -v140, v203
    v_fma_f32 v203, v61, -v141, v203
    s_add_u32 m0, s21, 6144
    v_mfma_f32_32x32x8_bf16 v[16:31], v[76:77], v[176:177], v[16:31]
    buffer_load_dwordx4 v236, s[4:7], s37 offen lds
    v_add_u32 v252, s43, v247
    ds_read_u16 v236, v252
    ds_read_u16 v237, v252 offset:64
    v_fma_f32 v203, v62, -v142, v203
    v_fma_f32 v203, v63, -v143, v203
    s_nop 1
    v_permlane32_swap_b32 v201, v203
    v_add_f32 v203, v201, v203
    s_set_gpr_idx_on s51, gpr_idx(DST)
    s_nop 0
    v_cvt_pk_bf16_f32 v204, v198, v199
    v_cvt_pk_bf16_f32 v205, v202, v203
    s_set_gpr_idx_off
    v_mfma_f32_32x32x16_bf16 v[32:47], v[64:67], v[180:183], 0
    v_mul_f32 v196, v0, v144
    v_fmac_f32 v196, v1, v145
    v_fmac_f32 v196, v2, v146
    v_fmac_f32 v196, v3, v147
    v_fmac_f32 v196, v4, v148
    v_fmac_f32 v196, v5, v149
    v_fmac_f32 v196, v6, v150
    v_fmac_f32 v196, v7, v151
    v_mfma_f32_32x32x16_bf16 v[48:63], v[68:71], v[180:183], 0
    s_waitcnt vmcnt(6)
    ds_read_b64_tr_b16 v[176:177], v244 offset:0
    ds_read_b64_tr_b16 v[178:179], v244 offset:1024
    ds_read_b64_tr_b16 v[180:181], v245 offset:0
    ds_read_b64_tr_b16 v[182:183], v245 offset:1024
    v_mul_f32 v198, v8, v112
    v_fmac_f32 v198, v9, v113
    v_fmac_f32 v198, v10, v114
    v_fmac_f32 v198, v11, v115
    v_fmac_f32 v198, v12, v116
    v_fmac_f32 v198, v13, v117
    v_fmac_f32 v198, v14, v118
    v_fmac_f32 v198, v15, v119
    v_mfma_f32_32x32x8_bf16 v[32:47], v[72:73], v[184:185], v[32:47]
    v_mul_f32_e64 v200, v16, -v160
    v_fma_f32 v200, v17, -v161, v200
    v_fma_f32 v200, v18, -v162, v200
    v_fma_f32 v200, v19, -v163, v200
    v_fma_f32 v200, v20, -v164, v200
    v_fma_f32 v200, v21, -v165, v200
    v_fma_f32 v200, v22, -v166, v200
    v_fma_f32 v200, v23, -v167, v200
    v_mfma_f32_32x32x8_bf16 v[48:63], v[76:77], v[184:185], v[48:63]
    v_mul_f32_e64 v202, v24, -v160
    v_fma_f32 v202, v25, -v161, v202
    v_fma_f32 v202, v26, -v162, v202
    v_fma_f32 v202, v27, -v163, v202
    v_fma_f32 v202, v28, -v164, v202
    v_fma_f32 v202, v29, -v165, v202
    v_fma_f32 v202, v30, -v166, v202
    v_fma_f32 v202, v31, -v167, v202
    s_waitcnt vmcnt(5) lgkmcnt(0)
    v_mfma_f32_32x32x16_bf16 v[0:15], v[64:67], v[176:179], 0
    v_mul_f32 v197, v32, v152
    v_fmac_f32 v197, v33, v153
    v_fmac_f32 v197, v34, v154
    v_fmac_f32 v197, v35, v155
    v_fmac_f32 v197, v36, v156
    v_fmac_f32 v197, v37, v157
    v_fmac_f32 v197, v38, v158
    v_fmac_f32 v197, v39, v159
    s_add_u32 m0, s21, 0
    v_mfma_f32_32x32x16_bf16 v[16:31], v[68:71], v[176:179], 0
    v_lshl_add_u32 v234, v234, 10, v246
    v_lshl_add_u32 v235, v235, 10, v246
    buffer_load_dwordx4 v234, s[4:7], s38 offen lds
    buffer_load_dwordx4 v235, s[8:11], s38 offen offset:1024 lds
    ds_read_b64_tr_b16 v[176:177], v244 offset:2048
    ds_read_b64_tr_b16 v[184:185], v245 offset:2048
    v_mul_f32 v199, v40, v120
    v_fmac_f32 v199, v41, v121
    v_fmac_f32 v199, v42, v122
    v_fmac_f32 v199, v43, v123
    v_fmac_f32 v199, v44, v124
    v_fmac_f32 v199, v45, v125
    v_fmac_f32 v199, v46, v126
    v_fmac_f32 v199, v47, v127
    s_waitcnt lgkmcnt(0)
    v_mfma_f32_32x32x8_bf16 v[0:15], v[72:73], v[176:177], v[0:15]
    v_mul_f32_e64 v201, v48, -v168
    v_fma_f32 v201, v49, -v169, v201
    v_fma_f32 v201, v50, -v170, v201
    v_fma_f32 v201, v51, -v171, v201
    v_fma_f32 v201, v52, -v172, v201
    v_fma_f32 v201, v53, -v173, v201
    v_fma_f32 v201, v54, -v174, v201
    v_fma_f32 v201, v55, -v175, v201
    s_add_u32 m0, s21, 2048
    v_mfma_f32_32x32x8_bf16 v[16:31], v[76:77], v[176:177], v[16:31]
    v_lshl_add_u32 v236, v236, 10, v246
    v_lshl_add_u32 v237, v237, 10, v246
    buffer_load_dwordx4 v236, s[4:7], s39 offen lds
    buffer_load_dwordx4 v237, s[8:11], s39 offen offset:1024 lds
    v_mul_f32_e64 v203, v56, -v168
    v_fma_f32 v203, v57, -v169, v203
    v_fma_f32 v203, v58, -v170, v203
    v_fma_f32 v203, v59, -v171, v203
    v_fma_f32 v203, v60, -v172, v203
    v_fma_f32 v203, v61, -v173, v203
    v_fma_f32 v203, v62, -v174, v203
    v_fma_f32 v203, v63, -v175, v203
    v_mfma_f32_32x32x16_bf16 v[32:47], v[64:67], v[180:183], 0
    v_mul_f32 v254, v0, v144
    v_fmac_f32 v254, v1, v145
    v_fmac_f32 v254, v2, v146
    v_fmac_f32 v254, v3, v147
    v_fmac_f32 v254, v4, v148
    v_mfma_f32_32x32x16_bf16 v[48:63], v[68:71], v[180:183], 0
    ds_swizzle_b32 v68, v68 offset:0x401F
    ds_swizzle_b32 v69, v69 offset:0x401F
    ds_swizzle_b32 v70, v70 offset:0x401F
    ds_swizzle_b32 v71, v71 offset:0x401F
    s_waitcnt vmcnt(7)
    ds_read_b64_tr_b16 v[176:177], v244 offset:4096
    ds_read_b64_tr_b16 v[178:179], v244 offset:5120
    ds_read_b64_tr_b16 v[180:181], v245 offset:4096
    ds_read_b64_tr_b16 v[182:183], v245 offset:5120
    v_fmac_f32 v254, v5, v149
    v_fmac_f32 v254, v6, v150
    v_fmac_f32 v254, v7, v151
    v_fmac_f32 v200, v8, v160
    v_mfma_f32_32x32x8_bf16 v[32:47], v[72:73], v[184:185], v[32:47]
    v_fmac_f32 v200, v9, v161
    v_permlane32_swap_b32 v196, v254
    v_fmac_f32 v200, v10, v162
    v_fmac_f32 v200, v11, v163
    v_fmac_f32 v200, v12, v164
    v_mfma_f32_32x32x8_bf16 v[48:63], v[76:77], v[184:185], v[48:63]
    ds_swizzle_b32 v76, v76 offset:0x401F
    ds_swizzle_b32 v77, v77 offset:0x401F
    v_fmac_f32 v200, v13, v165
    v_fmac_f32 v200, v14, v166
    v_fmac_f32 v200, v15, v167
    v_add_f32 v254, v196, v254
    s_waitcnt lgkmcnt(6)
    s_mov_b64 exec, s[56:57]
    v_xor_b32 v68, 0x80008000, v68
    v_xor_b32 v69, 0x80008000, v69
    v_xor_b32 v70, 0x80008000, v70
    v_xor_b32 v71, 0x80008000, v71
    s_mov_b64 exec, -1
    s_waitcnt vmcnt(4) lgkmcnt(2)
    v_mfma_f32_32x32x16_bf16 v[0:15], v[64:67], v[176:179], 0
    v_mul_f32 v255, v32, v152
    v_fmac_f32 v255, v33, v153
    v_fmac_f32 v255, v34, v154
    v_fmac_f32 v255, v35, v155
    v_fmac_f32 v255, v36, v156
    v_fmac_f32 v255, v37, v157
    s_add_u32 m0, s21, 4096
    v_mfma_f32_32x32x16_bf16 v[16:31], v[68:71], v[176:179], v[16:31]
    v_lshl_add_u32 v238, v238, 10, v246
    v_lshl_add_u32 v239, v239, 10, v246
    buffer_load_dwordx4 v238, s[4:7], s40 offen lds
    buffer_load_dwordx4 v239, s[8:11], s40 offen offset:1024 lds
    ds_read_b64_tr_b16 v[176:177], v244 offset:6144
    ds_read_b64_tr_b16 v[184:185], v245 offset:6144
    v_fmac_f32 v255, v38, v158
    v_fmac_f32 v255, v39, v159
    v_fmac_f32 v201, v40, v168
    v_fmac_f32 v201, v41, v169
    v_permlane32_swap_b32 v197, v255
    s_waitcnt lgkmcnt(0)
    s_mov_b64 exec, s[56:57]
    v_xor_b32 v76, 0x80008000, v76
    v_xor_b32 v77, 0x80008000, v77
    s_mov_b64 exec, -1
    v_mfma_f32_32x32x8_bf16 v[0:15], v[72:73], v[176:177], v[0:15]
    v_fmac_f32 v201, v42, v170
    v_fmac_f32 v201, v43, v171
    v_fmac_f32 v201, v44, v172
    v_fmac_f32 v201, v45, v173
    v_fmac_f32 v201, v46, v174
    v_fmac_f32 v201, v47, v175
    s_add_u32 m0, s21, 6144
    v_mfma_f32_32x32x8_bf16 v[16:31], v[76:77], v[176:177], v[16:31]
    v_lshl_add_u32 v240, v240, 10, v246
    v_lshl_add_u32 v241, v241, 10, v246
    buffer_load_dwordx4 v240, s[4:7], s41 offen lds
    buffer_load_dwordx4 v241, s[8:11], s41 offen offset:1024 lds
    v_add_f32 v255, v197, v255
    s_set_gpr_idx_on s51, gpr_idx(DST)
    s_nop 0
    v_cvt_pk_bf16_f32 v206, v254, v255
    s_set_gpr_idx_off
    v_mfma_f32_32x32x16_bf16 v[32:47], v[64:67], v[180:183], 0
    v_mul_f32 v254, v0, v144
    v_fmac_f32 v254, v1, v145
    v_fmac_f32 v254, v2, v146
    v_fmac_f32 v254, v3, v147
    v_fmac_f32 v254, v4, v148
    v_fmac_f32 v254, v5, v149
    v_fmac_f32 v254, v6, v150
    v_fmac_f32 v254, v7, v151
    v_fma_f32 v202, v8, -v160, v202
    v_fma_f32 v202, v9, -v161, v202
    v_mfma_f32_32x32x16_bf16 v[48:63], v[68:71], v[180:183], v[48:63]
    s_waitcnt vmcnt(6)
    ds_read_b64_tr_b16 v[176:177], v244 offset:0
    ds_read_b64_tr_b16 v[178:179], v244 offset:1024
    ds_read_b64_tr_b16 v[180:181], v245 offset:0
    ds_read_b64_tr_b16 v[182:183], v245 offset:1024
    v_permlane32_swap_b32 v254, v200
    v_fma_f32 v202, v10, -v162, v202
    v_fma_f32 v202, v11, -v163, v202
    v_fma_f32 v202, v12, -v164, v202
    v_fma_f32 v202, v13, -v165, v202
    v_fma_f32 v202, v14, -v166, v202
    v_fma_f32 v202, v15, -v167, v202
    v_add_f32 v200, v254, v200
    v_fmac_f32 v198, v16, v112
    v_permlane32_swap_b32 v202, v254
    v_mfma_f32_32x32x8_bf16 v[32:47], v[72:73], v[184:185], v[32:47]
    v_fmac_f32 v198, v17, v113
    v_fmac_f32 v198, v18, v114
    v_fmac_f32 v198, v19, v115
    v_fmac_f32 v198, v20, v116
    v_fmac_f32 v198, v21, v117
    v_fmac_f32 v198, v22, v118
    v_fmac_f32 v198, v23, v119
    v_add_f32 v254, v202, v254
    v_mul_f32 v196, v24, v160
    v_fmac_f32 v196, v25, v161
    v_mfma_f32_32x32x8_bf16 v[48:63], v[76:77], v[184:185], v[48:63]
    v_add_u32 v249, s48, v249
    v_add_u32 v250, s49, v250
    ds_read_b32 v252, v251 offset:16
    ds_read_b64_tr_b16 v[64:65], v249 offset:0
    ds_read_b64_tr_b16 v[68:69], v249 offset:64
    ds_read_b64_tr_b16 v[66:67], v249 offset:256
    ds_read_b64_tr_b16 v[70:71], v249 offset:320
    s_mov_b64 exec, s[54:55]
    ds_read_u16_d16_hi v242, v250 offset:0
    s_mov_b64 exec, -1
    v_fmac_f32 v196, v26, v162
    v_fmac_f32 v196, v27, v163
    v_fmac_f32 v196, v28, v164
    v_fmac_f32 v196, v29, v165
    v_fmac_f32 v196, v30, v166
    v_fmac_f32 v196, v31, v167
    s_nop 1
    v_permlane32_swap_b32 v198, v196
    v_add_f32 v196, v198, v196
    v_mul_f32 v255, v32, v152
    v_fmac_f32 v255, v33, v153
    v_fmac_f32 v255, v34, v154
    v_fmac_f32 v255, v35, v155
    v_fmac_f32 v255, v36, v156
    v_fmac_f32 v255, v37, v157
    v_fmac_f32 v255, v38, v158
    v_fmac_f32 v255, v39, v159
    v_fma_f32 v203, v40, -v168, v203
    v_fma_f32 v203, v41, -v169, v203
    v_permlane32_swap_b32 v255, v201
    v_fma_f32 v203, v42, -v170, v203
    v_fma_f32 v203, v43, -v171, v203
    v_fma_f32 v203, v44, -v172, v203
    v_fma_f32 v203, v45, -v173, v203
    v_fma_f32 v203, v46, -v174, v203
    v_fma_f32 v203, v47, -v175, v203
    v_add_f32 v201, v255, v201
    v_fmac_f32 v199, v48, v120
    v_permlane32_swap_b32 v203, v255
    v_fmac_f32 v199, v49, v121
    v_fmac_f32 v199, v50, v122
    v_fmac_f32 v199, v51, v123
    v_fmac_f32 v199, v52, v124
    v_fmac_f32 v199, v53, v125
    v_fmac_f32 v199, v54, v126
    v_fmac_f32 v199, v55, v127
    v_add_f32 v255, v203, v255
    v_mul_f32 v197, v56, v168
    v_fmac_f32 v197, v57, v169
    v_fmac_f32 v197, v58, v170
    v_fmac_f32 v197, v59, v171
    v_fmac_f32 v197, v60, v172
    v_fmac_f32 v197, v61, v173
    v_fmac_f32 v197, v62, v174
    v_fmac_f32 v197, v63, v175
    s_nop 1
    v_permlane32_swap_b32 v199, v197
    v_add_f32 v197, v199, v197
    s_set_gpr_idx_on s51, gpr_idx(DST)
    s_nop 0
    v_cvt_pk_bf16_f32 v207, v200, v201
    v_cvt_pk_bf16_f32 v209, v254, v255
    v_cvt_pk_bf16_f32 v208, v196, v197
    s_set_gpr_idx_off
    s_add_u32 s50, s50, 1
    s_add_u32 s51, s51, 6
    s_cmp_ge_u32 s50, 4
    s_cbranch_scc1 LAST0
    s_waitcnt lgkmcnt(5)
    v_readfirstlane_b32 s66, v252
    s_add_u32 s53, s53, 1
    v_mov_b32 v252, s53
    s_cmp_le_u32 s53, s66
    ds_write2_b32 v251, v252, v252 offset0:0 offset1:8
    s_setprio 1
    s_cbranch_scc1 PRIO_6
    s_setprio 0
PRIO_6:
    s_cmp_eq_u32 s52, 4
    s_cbranch_scc1 ITEM_0_4
    s_cmp_eq_u32 s52, 5
    s_cbranch_scc1 ITEM_0_5
    s_cmp_eq_u32 s52, 3
    s_cbranch_scc1 ITEM_0_3
    s_cmp_eq_u32 s52, 6
    s_cbranch_scc1 ITEM_0_6
    s_cmp_eq_u32 s52, 8
    s_cbranch_scc1 ITEM_0_8
    s_branch ITEM_0_2
.p2align 6
ITEM_0_6:
    s_mov_b64 exec, s[54:55]
    ds_read_u16_d16_hi v243, v250 offset:128
    s_mov_b64 exec, -1
    ds_read_b64_tr_b16 v[72:73], v249 offset:512
    ds_read_b64_tr_b16 v[76:77], v249 offset:576
    ds_read_b64_tr_b16 v[74:75], v249 offset:768
    ds_read_b64_tr_b16 v[78:79], v249 offset:832
    ds_read_b64_tr_b16 v[80:81], v249 offset:1024
    ds_read_b64_tr_b16 v[84:85], v249 offset:1088
    ds_read_b64_tr_b16 v[82:83], v249 offset:1280
    ds_read_b64_tr_b16 v[86:87], v249 offset:1344
    s_waitcnt lgkmcnt(9)
    v_mul_f32_dpp v196, v242, v64 row_newbcast:0 row_mask:0xf bank_mask:0xf
    v_mul_f32_dpp v197, v242, v65 row_newbcast:1 row_mask:0xf bank_mask:0xf
    v_mul_f32_dpp v198, v242, v64 row_newbcast:8 row_mask:0xf bank_mask:0xf
    v_mul_f32_dpp v199, v242, v65 row_newbcast:9 row_mask:0xf bank_mask:0xf
    v_mul_f32_dpp v200, v242, v68 row_newbcast:2 row_mask:0xf bank_mask:0xf
    v_mul_f32_dpp v201, v242, v69 row_newbcast:3 row_mask:0xf bank_mask:0xf
    v_mul_f32_dpp v202, v242, v68 row_newbcast:10 row_mask:0xf bank_mask:0xf
    v_mul_f32_dpp v203, v242, v69 row_newbcast:11 row_mask:0xf bank_mask:0xf
    v_cvt_pk_bf16_f32 v64, v196, v197
    v_cvt_pk_bf16_f32 v68, v198, v199
    v_cvt_pk_bf16_f32 v65, v200, v201
    v_cvt_pk_bf16_f32 v69, v202, v203
    v_mul_f32_dpp v196, v242, v66 row_newbcast:4 row_mask:0xf bank_mask:0xf
    v_mul_f32_dpp v197, v242, v67 row_newbcast:5 row_mask:0xf bank_mask:0xf
    v_mul_f32_dpp v198, v242, v66 row_newbcast:12 row_mask:0xf bank_mask:0xf
    v_mul_f32_dpp v199, v242, v67 row_newbcast:13 row_mask:0xf bank_mask:0xf
    v_mul_f32_dpp v200, v242, v70 row_newbcast:6 row_mask:0xf bank_mask:0xf
    v_mul_f32_dpp v201, v242, v71 row_newbcast:7 row_mask:0xf bank_mask:0xf
    v_mul_f32_dpp v202, v242, v70 row_newbcast:14 row_mask:0xf bank_mask:0xf
    v_mul_f32_dpp v203, v242, v71 row_newbcast:15 row_mask:0xf bank_mask:0xf
    v_cvt_pk_bf16_f32 v66, v196, v197
    v_cvt_pk_bf16_f32 v70, v198, v199
    v_cvt_pk_bf16_f32 v67, v200, v201
    v_cvt_pk_bf16_f32 v71, v202, v203
    s_mov_b64 exec, s[54:55]
    ds_read_u16_d16_hi v242, v250 offset:256
    s_mov_b64 exec, -1
    s_waitcnt vmcnt(4) lgkmcnt(5)
    v_mfma_f32_32x32x16_bf16 v[0:15], v[64:67], v[176:179], 0
    v_mul_f32_dpp v196, v243, v72 row_newbcast:0 row_mask:0xf bank_mask:0xf
    v_mul_f32_dpp v197, v243, v73 row_newbcast:1 row_mask:0xf bank_mask:0xf
    v_mul_f32_dpp v198, v243, v72 row_newbcast:8 row_mask:0xf bank_mask:0xf
    v_mul_f32_dpp v199, v243, v73 row_newbcast:9 row_mask:0xf bank_mask:0xf
    v_mul_f32_dpp v200, v243, v76 row_newbcast:2 row_mask:0xf bank_mask:0xf
    v_mul_f32_dpp v201, v243, v77 row_newbcast:3 row_mask:0xf bank_mask:0xf
    v_mul_f32_dpp v202, v243, v76 row_newbcast:10 row_mask:0xf bank_mask:0xf
    v_mul_f32_dpp v203, v243, v77 row_newbcast:11 row_mask:0xf bank_mask:0xf
    v_cvt_pk_bf16_f32 v72, v196, v197
    v_cvt_pk_bf16_f32 v76, v198, v199
    v_cvt_pk_bf16_f32 v73, v200, v201
    v_cvt_pk_bf16_f32 v77, v202, v203
    s_add_u32 m0, s21, 0
    v_mfma_f32_32x32x16_bf16 v[16:31], v[68:71], v[176:179], 0
    buffer_load_dwordx4 v236, s[4:7], s35 offen lds
    buffer_load_dwordx4 v237, s[8:11], s35 offen offset:1024 lds
    ds_read_b64_tr_b16 v[176:177], v244 offset:2048
    ds_read_b64_tr_b16 v[178:179], v244 offset:3072
    ds_read_b64_tr_b16 v[184:185], v245 offset:2048
    ds_read_b64_tr_b16 v[186:187], v245 offset:3072
    v_mul_f32_dpp v196, v243, v74 row_newbcast:4 row_mask:0xf bank_mask:0xf
    v_mul_f32_dpp v197, v243, v75 row_newbcast:5 row_mask:0xf bank_mask:0xf
    v_mul_f32_dpp v198, v243, v74 row_newbcast:12 row_mask:0xf bank_mask:0xf
    v_mul_f32_dpp v199, v243, v75 row_newbcast:13 row_mask:0xf bank_mask:0xf
    v_mul_f32_dpp v200, v243, v78 row_newbcast:6 row_mask:0xf bank_mask:0xf
    v_mul_f32_dpp v201, v243, v79 row_newbcast:7 row_mask:0xf bank_mask:0xf
    v_mul_f32_dpp v202, v243, v78 row_newbcast:14 row_mask:0xf bank_mask:0xf
    v_mul_f32_dpp v203, v243, v79 row_newbcast:15 row_mask:0xf bank_mask:0xf
    v_cvt_pk_bf16_f32 v74, v196, v197
    v_cvt_pk_bf16_f32 v78, v198, v199
    v_cvt_pk_bf16_f32 v75, v200, v201
    v_cvt_pk_bf16_f32 v79, v202, v203
    s_nop 0
    s_waitcnt vmcnt(4) lgkmcnt(0)
    v_mfma_f32_32x32x16_bf16 v[0:15], v[72:75], v[176:179], v[0:15]
    v_mul_f32_dpp v196, v242, v80 row_newbcast:0 row_mask:0xf bank_mask:0xf
    v_mul_f32_dpp v197, v242, v81 row_newbcast:1 row_mask:0xf bank_mask:0xf
    v_mul_f32_dpp v198, v242, v80 row_newbcast:8 row_mask:0xf bank_mask:0xf
    v_mul_f32_dpp v199, v242, v81 row_newbcast:9 row_mask:0xf bank_mask:0xf
    v_mul_f32_dpp v200, v242, v84 row_newbcast:2 row_mask:0xf bank_mask:0xf
    v_mul_f32_dpp v201, v242, v85 row_newbcast:3 row_mask:0xf bank_mask:0xf
    v_mul_f32_dpp v202, v242, v84 row_newbcast:10 row_mask:0xf bank_mask:0xf
    v_mul_f32_dpp v203, v242, v85 row_newbcast:11 row_mask:0xf bank_mask:0xf
    v_cvt_pk_bf16_f32 v80, v196, v197
    v_cvt_pk_bf16_f32 v84, v198, v199
    v_cvt_pk_bf16_f32 v81, v200, v201
    v_cvt_pk_bf16_f32 v85, v202, v203
    s_add_u32 m0, s21, 2048
    v_mfma_f32_32x32x16_bf16 v[16:31], v[76:79], v[176:179], v[16:31]
    buffer_load_dwordx4 v238, s[4:7], s35 offen lds
    buffer_load_dwordx4 v239, s[8:11], s35 offen offset:1024 lds
    ds_read_b64_tr_b16 v[176:177], v244 offset:4096
    ds_read_b64_tr_b16 v[178:179], v244 offset:5120
    ds_read_b64_tr_b16 v[188:189], v245 offset:4096
    ds_read_b64_tr_b16 v[190:191], v245 offset:5120
    v_mul_f32_dpp v196, v242, v82 row_newbcast:4 row_mask:0xf bank_mask:0xf
    v_mul_f32_dpp v197, v242, v83 row_newbcast:5 row_mask:0xf bank_mask:0xf
    v_mul_f32_dpp v198, v242, v82 row_newbcast:12 row_mask:0xf bank_mask:0xf
    v_mul_f32_dpp v199, v242, v83 row_newbcast:13 row_mask:0xf bank_mask:0xf
    v_mul_f32_dpp v200, v242, v86 row_newbcast:6 row_mask:0xf bank_mask:0xf
    v_mul_f32_dpp v201, v242, v87 row_newbcast:7 row_mask:0xf bank_mask:0xf
    v_mul_f32_dpp v202, v242, v86 row_newbcast:14 row_mask:0xf bank_mask:0xf
    v_mul_f32_dpp v203, v242, v87 row_newbcast:15 row_mask:0xf bank_mask:0xf
    v_cvt_pk_bf16_f32 v82, v196, v197
    v_cvt_pk_bf16_f32 v86, v198, v199
    v_cvt_pk_bf16_f32 v83, v200, v201
    v_cvt_pk_bf16_f32 v87, v202, v203
    s_nop 0
    s_waitcnt lgkmcnt(0)
    v_mfma_f32_32x32x16_bf16 v[0:15], v[80:83], v[176:179], v[0:15]
    s_add_u32 m0, s21, 4096
    v_mfma_f32_32x32x16_bf16 v[16:31], v[84:87], v[176:179], v[16:31]
    buffer_load_dwordx4 v234, s[4:7], s36 offen lds
    buffer_load_dwordx4 v235, s[8:11], s36 offen offset:1024 lds
    s_mov_b32 m0, s50
    s_nop 0
    s_movrels_b32 s71, s23
    s_bfe_u32 s46, s71, 0x30012
    s_mov_b32 m0, s46
    s_and_b32 s66, s71, 0x3ffff
    s_movrels_b32 s68, s57
    s_movrels_b32 s69, s61
    s_sub_u32 s48, s66, s47
    s_mov_b32 s47, s66
    s_lshr_b32 s52, s71, 28
    s_lshl_b32 s67, s46, 9
    s_add_u32 s66, s66, s67
    s_sub_u32 s49, s66, s42
    s_mov_b32 s42, s66
    s_bfe_u32 s66, s68, 655360
    s_add_u32 s43, s42, s66
    s_bfe_u32 s39, s69, 655360
    s_bfe_u32 s66, s68, 655370
    s_add_u32 s44, s42, s66
    s_bfe_u32 s40, s69, 655370
    s_bfe_u32 s66, s68, 655380
    s_add_u32 s45, s42, s66
    s_bfe_u32 s41, s69, 655380
    s_and_b32 s66, s46, s33
    s_cselect_b32 s72, -1, 1
    s_cselect_b32 s76, s47, 163712
    s_cmp_ge_u32 s66, 2
    s_cselect_b32 s73, -1, 0
    s_add_u32 s77, s47, 1024
    s_cmp_ge_u32 s66, 4
    s_cselect_b32 s75, -1, 0
    s_cmp_ge_u32 s66, 3
    s_cselect_b32 s74, -1, 1
    s_cselect_b32 s77, s77, 163712
    v_add_u32 v252, s45, v247
    ds_read_u16 v240, v252
    ds_read_u16 v241, v252 offset:64
    v_mfma_f32_32x32x16_bf16 v[32:47], v[64:67], v[180:183], 0
    v_mul_f32 v196, v0, v96
    v_fmac_f32 v196, v1, v97
    v_fmac_f32 v196, v2, v98
    v_fmac_f32 v196, v3, v99
    v_fmac_f32 v196, v4, v100
    v_fmac_f32 v196, v5, v101
    v_fmac_f32 v196, v6, v102
    v_mfma_f32_32x32x16_bf16 v[48:63], v[68:71], v[180:183], 0
    v_add_u32 v253, s47, v248
    ds_read_b32 v254, v253
    ds_read_b32 v255, v253 offset:256
    v_fmac_f32 v196, v7, v103
    v_mul_f32 v198, v8, v128
    v_fmac_f32 v198, v9, v129
    v_fmac_f32 v198, v10, v130
    v_fmac_f32 v198, v11, v131
    v_fmac_f32 v198, v12, v132
    v_mfma_f32_32x32x16_bf16 v[32:47], v[72:75], v[184:187], v[32:47]
    v_fmac_f32 v198, v13, v133
    v_fmac_f32 v198, v14, v134
    v_fmac_f32 v198, v15, v135
    v_mul_f32 v200, v16, v128
    v_fmac_f32 v200, v17, v129
    v_permlane32_swap_b32 v196, v198
    v_mfma_f32_32x32x16_bf16 v[48:63], v[76:79], v[184:187], v[48:63]
    s_waitcnt vmcnt(6)
    ds_read_b64_tr_b16 v[176:177], v244 offset:6144
    ds_read_b64_tr_b16 v[178:179], v244 offset:7168
    ds_read_b64_tr_b16 v[180:181], v245 offset:6144
    ds_read_b64_tr_b16 v[182:183], v245 offset:7168
    v_fmac_f32 v200, v18, v130
    v_fmac_f32 v200, v19, v131
    v_fmac_f32 v200, v20, v132
    v_fmac_f32 v200, v21, v133
    v_fmac_f32 v200, v22, v134
    v_fmac_f32 v200, v23, v135
    v_mfma_f32_32x32x16_bf16 v[32:47], v[80:83], v[188:191], v[32:47]
    v_add_f32 v198, v196, v198
    v_mul_f32_e64 v202, v24, -v128
    v_fma_f32 v202, v25, -v129, v202
    v_fma_f32 v202, v26, -v130, v202
    v_fma_f32 v202, v27, -v131, v202
    v_fma_f32 v202, v28, -v132, v202
    v_mfma_f32_32x32x16_bf16 v[48:63], v[84:87], v[188:191], v[48:63]
    v_fma_f32 v202, v29, -v133, v202
    v_fma_f32 v202, v30, -v134, v202
    v_fma_f32 v202, v31, -v135, v202
    s_nop 1
    v_permlane32_swap_b32 v200, v202
    v_add_f32 v202, v200, v202
    s_waitcnt vmcnt(4) lgkmcnt(0)
    v_mfma_f32_32x32x16_bf16 v[0:15], v[64:67], v[176:179], 0
    v_mul_f32 v197, v32, v104
    v_fmac_f32 v197, v33, v105
    v_fmac_f32 v197, v34, v106
    v_fmac_f32 v197, v35, v107
    v_fmac_f32 v197, v36, v108
    v_fmac_f32 v197, v37, v109
    v_fmac_f32 v197, v38, v110
    s_add_u32 m0, s21, 6144
    v_mfma_f32_32x32x16_bf16 v[16:31], v[68:71], v[176:179], 0
    buffer_load_dwordx4 v236, s[4:7], s36 offen lds
    buffer_load_dwordx4 v237, s[8:11], s36 offen offset:1024 lds
    ds_read_b64_tr_b16 v[176:177], v244 offset:0
    ds_read_b64_tr_b16 v[178:179], v244 offset:1024
    ds_read_b64_tr_b16 v[184:185], v245 offset:0
    ds_read_b64_tr_b16 v[186:187], v245 offset:1024
    s_mov_b32 m0, s76
    s_mov_b64 exec, s[72:73]
    buffer_load_dwordx4 v254, s[12:15], 0 offen  lds
    s_mov_b32 m0, s77
    s_mov_b64 exec, s[74:75]
    buffer_load_dwordx4 v255, s[12:15], 0 offen  lds
    s_mov_b64 exec, -1
    v_fmac_f32 v197, v39, v111
    v_mul_f32 v199, v40, v136
    v_fmac_f32 v199, v41, v137
    v_fmac_f32 v199, v42, v138
    v_fmac_f32 v199, v43, v139
    v_fmac_f32 v199, v44, v140
    v_fmac_f32 v199, v45, v141
    s_waitcnt vmcnt(6) lgkmcnt(0)
    v_mfma_f32_32x32x16_bf16 v[0:15], v[72:75], v[176:179], v[0:15]
    v_fmac_f32 v199, v46, v142
    v_fmac_f32 v199, v47, v143
    v_mul_f32 v201, v48, v136
    v_fmac_f32 v201, v49, v137
    v_permlane32_swap_b32 v197, v199
    v_fmac_f32 v201, v50, v138
    v_fmac_f32 v201, v51, v139
    s_add_u32 m0, s21, 0
    v_mfma_f32_32x32x16_bf16 v[16:31], v[76:79], v[176:179], v[16:31]
    buffer_load_dwordx4 v238, s[4:7], s36 offen lds
    buffer_load_dwordx4 v239, s[8:11], s36 offen offset:1024 lds
    ds_read_b64_tr_b16 v[176:177], v244 offset:2048
    ds_read_b64_tr_b16 v[178:179], v244 offset:3072
    ds_read_b64_tr_b16 v[188:189], v245 offset:2048
    ds_read_b64_tr_b16 v[190:191], v245 offset:3072
    v_fmac_f32 v201, v52, v140
    v_fmac_f32 v201, v53, v141
    v_fmac_f32 v201, v54, v142
    v_fmac_f32 v201, v55, v143
    v_add_f32 v199, v197, v199
    v_mul_f32_e64 v203, v56, -v136
    v_fma_f32 v203, v57, -v137, v203
    s_waitcnt lgkmcnt(0)
    v_mfma_f32_32x32x16_bf16 v[0:15], v[80:83], v[176:179], v[0:15]
    v_fma_f32 v203, v58, -v138, v203
    v_fma_f32 v203, v59, -v139, v203
    v_fma_f32 v203, v60, -v140, v203
    v_fma_f32 v203, v61, -v141, v203
    v_fma_f32 v203, v62, -v142, v203
    v_fma_f32 v203, v63, -v143, v203
    s_nop 1
    s_add_u32 m0, s21, 2048
    v_mfma_f32_32x32x16_bf16 v[16:31], v[84:87], v[176:179], v[16:31]
    buffer_load_dwordx4 v234, s[4:7], s37 offen lds
    buffer_load_dwordx4 v235, s[8:11], s37 offen offset:1024 lds
    v_add_u32 v252, s42, v247
    ds_read_u16 v234, v252
    ds_read_u16 v235, v252 offset:64
    v_permlane32_swap_b32 v201, v203
    v_add_f32 v203, v201, v203
    s_set_gpr_idx_on s51, gpr_idx(DST)
    s_nop 0
    v_cvt_pk_bf16_f32 v204, v198, v199
    v_cvt_pk_bf16_f32 v205, v202, v203
    s_set_gpr_idx_off
    v_mfma_f32_32x32x16_bf16 v[32:47], v[64:67], v[180:183], 0
    v_mul_f32 v196, v0, v144
    v_fmac_f32 v196, v1, v145
    v_fmac_f32 v196, v2, v146
    v_fmac_f32 v196, v3, v147
    v_fmac_f32 v196, v4, v148
    v_fmac_f32 v196, v5, v149
    v_mfma_f32_32x32x16_bf16 v[48:63], v[68:71], v[180:183], 0
    v_fmac_f32 v196, v6, v150
    v_fmac_f32 v196, v7, v151
    v_mul_f32 v198, v8, v112
    v_fmac_f32 v198, v9, v113
    v_fmac_f32 v198, v10, v114
    v_mfma_f32_32x32x16_bf16 v[32:47], v[72:75], v[184:187], v[32:47]
    v_fmac_f32 v198, v11, v115
    v_fmac_f32 v198, v12, v116
    v_fmac_f32 v198, v13, v117
    v_fmac_f32 v198, v14, v118
    v_fmac_f32 v198, v15, v119
    v_mfma_f32_32x32x16_bf16 v[48:63], v[76:79], v[184:187], v[48:63]
    s_waitcnt vmcnt(8)
    ds_read_b64_tr_b16 v[176:177], v244 offset:4096
    ds_read_b64_tr_b16 v[178:179], v244 offset:5120
    ds_read_b64_tr_b16 v[180:181], v245 offset:4096
    ds_read_b64_tr_b16 v[182:183], v245 offset:5120
    v_mul_f32_e64 v200, v16, -v160
    v_fma_f32 v200, v17, -v161, v200
    v_fma_f32 v200, v18, -v162, v200
    v_fma_f32 v200, v19, -v163, v200
    v_fma_f32 v200, v20, -v164, v200
    v_fma_f32 v200, v21, -v165, v200
    v_mfma_f32_32x32x16_bf16 v[32:47], v[80:83], v[188:191], v[32:47]
    v_fma_f32 v200, v22, -v166, v200
    v_fma_f32 v200, v23, -v167, v200
    v_mul_f32_e64 v202, v24, -v160
    v_fma_f32 v202, v25, -v161, v202
    v_fma_f32 v202, v26, -v162, v202
    v_mfma_f32_32x32x16_bf16 v[48:63], v[84:87], v[188:191], v[48:63]
    v_fma_f32 v202, v27, -v163, v202
    v_fma_f32 v202, v28, -v164, v202
    v_fma_f32 v202, v29, -v165, v202
    v_fma_f32 v202, v30, -v166, v202
    v_fma_f32 v202, v31, -v167, v202
    s_waitcnt vmcnt(6) lgkmcnt(0)
    v_mfma_f32_32x32x16_bf16 v[0:15], v[64:67], v[176:179], 0
    v_mul_f32 v197, v32, v152
    v_fmac_f32 v197, v33, v153
    v_fmac_f32 v197, v34, v154
    v_fmac_f32 v197, v35, v155
    v_fmac_f32 v197, v36, v156
    v_fmac_f32 v197, v37, v157
    s_add_u32 m0, s21, 4096
    v_mfma_f32_32x32x16_bf16 v[16:31], v[68:71], v[176:179], 0
    buffer_load_dwordx4 v236, s[4:7], s37 offen lds
    buffer_load_dwordx4 v237, s[8:11], s37 offen offset:1024 lds
    ds_read_b64_tr_b16 v[176:177], v244 offset:6144
    ds_read_b64_tr_b16 v[178:179], v244 offset:7168
    ds_read_b64_tr_b16 v[184:185], v245 offset:6144
    ds_read_b64_tr_b16 v[186:187], v245 offset:7168
    v_add_u32 v252, s43, v247
    ds_read_u16 v236, v252
    ds_read_u16 v237, v252 offset:64
    v_fmac_f32 v197, v38, v158
    v_fmac_f32 v197, v39, v159
    v_mul_f32 v199, v40, v120
    v_fmac_f32 v199, v41, v121
    v_fmac_f32 v199, v42, v122
    s_waitcnt vmcnt(4) lgkmcnt(2)
    v_mfma_f32_32x32x16_bf16 v[0:15], v[72:75], v[176:179], v[0:15]
    v_fmac_f32 v199, v43, v123
    v_fmac_f32 v199, v44, v124
    v_fmac_f32 v199, v45, v125
    v_fmac_f32 v199, v46, v126
    v_fmac_f32 v199, v47, v127
    s_add_u32 m0, s21, 6144
    v_mfma_f32_32x32x16_bf16 v[16:31], v[76:79], v[176:179], v[16:31]
    buffer_load_dwordx4 v238, s[4:7], s37 offen lds
    buffer_load_dwordx4 v239, s[8:11], s37 offen offset:1024 lds
    ds_read_b64_tr_b16 v[176:177], v244 offset:0
    ds_read_b64_tr_b16 v[178:179], v244 offset:1024
    ds_read_b64_tr_b16 v[188:189], v245 offset:0
    ds_read_b64_tr_b16 v[190:191], v245 offset:1024
    v_add_u32 v252, s44, v247
    ds_read_u16 v238, v252
    ds_read_u16 v239, v252 offset:64
    v_mul_f32_e64 v201, v48, -v168
    v_fma_f32 v201, v49, -v169, v201
    v_fma_f32 v201, v50, -v170, v201
    v_fma_f32 v201, v51, -v171, v201
    v_fma_f32 v201, v52, -v172, v201
    v_fma_f32 v201, v53, -v173, v201
    s_waitcnt lgkmcnt(2)
    v_mfma_f32_32x32x16_bf16 v[0:15], v[80:83], v[176:179], v[0:15]
    v_fma_f32 v201, v54, -v174, v201
    v_fma_f32 v201, v55, -v175, v201
    v_mul_f32_e64 v203, v56, -v168
    v_fma_f32 v203, v57, -v169, v203
    v_fma_f32 v203, v58, -v170, v203
    s_add_u32 m0, s21, 0
    v_mfma_f32_32x32x16_bf16 v[16:31], v[84:87], v[176:179], v[16:31]
    v_lshl_add_u32 v234, v234, 10, v246
    v_lshl_add_u32 v235, v235, 10, v246
    buffer_load_dwordx4 v234, s[4:7], s38 offen lds
    buffer_load_dwordx4 v235, s[8:11], s38 offen offset:1024 lds
    v_fma_f32 v203, v59, -v171, v203
    v_fma_f32 v203, v60, -v172, v203
    v_fma_f32 v203, v61, -v173, v203
    v_fma_f32 v203, v62, -v174, v203
    v_fma_f32 v203, v63, -v175, v203
    v_mfma_f32_32x32x16_bf16 v[32:47], v[64:67], v[180:183], 0
    v_mul_f32 v254, v0, v144
    v_fmac_f32 v254, v1, v145
    v_fmac_f32 v254, v2, v146
    v_mfma_f32_32x32x16_bf16 v[48:63], v[68:71], v[180:183], 0
    ds_swizzle_b32 v68, v68 offset:0x401F
    ds_swizzle_b32 v69, v69 offset:0x401F
    ds_swizzle_b32 v70, v70 offset:0x401F
    ds_swizzle_b32 v71, v71 offset:0x401F
    v_fmac_f32 v254, v3, v147
    v_fmac_f32 v254, v4, v148
    v_fmac_f32 v254, v5, v149
    v_mfma_f32_32x32x16_bf16 v[32:47], v[72:75], v[184:187], v[32:47]
    v_fmac_f32 v254, v6, v150
    v_fmac_f32 v254, v7, v151
    v_fmac_f32 v200, v8, v160
    v_mfma_f32_32x32x16_bf16 v[48:63], v[76:79], v[184:187], v[48:63]
    ds_swizzle_b32 v76, v76 offset:0x401F
    ds_swizzle_b32 v77, v77 offset:0x401F
    ds_swizzle_b32 v78, v78 offset:0x401F
    ds_swizzle_b32 v79, v79 offset:0x401F
    s_waitcnt vmcnt(6)
    ds_read_b64_tr_b16 v[176:177], v244 offset:2048
    ds_read_b64_tr_b16 v[178:179], v244 offset:3072
    ds_read_b64_tr_b16 v[180:181], v245 offset:2048
    ds_read_b64_tr_b16 v[182:183], v245 offset:3072
    v_fmac_f32 v200, v9, v161
    v_permlane32_swap_b32 v196, v254
    v_fmac_f32 v200, v10, v162
    v_mfma_f32_32x32x16_bf16 v[32:47], v[80:83], v[188:191], v[32:47]
    v_fmac_f32 v200, v11, v163
    v_fmac_f32 v200, v12, v164
    v_fmac_f32 v200, v13, v165
    v_mfma_f32_32x32x16_bf16 v[48:63], v[84:87], v[188:191], v[48:63]
    ds_swizzle_b32 v84, v84 offset:0x401F
    ds_swizzle_b32 v85, v85 offset:0x401F
    ds_swizzle_b32 v86, v86 offset:0x401F
    ds_swizzle_b32 v87, v87 offset:0x401F
    v_fmac_f32 v200, v14, v166
    v_fmac_f32 v200, v15, v167
    v_add_f32 v254, v196, v254
    s_waitcnt lgkmcnt(8)
    s_mov_b64 exec, s[56:57]
    v_xor_b32 v68, 0x80008000, v68
    v_xor_b32 v69, 0x80008000, v69
    v_xor_b32 v70, 0x80008000, v70
    v_xor_b32 v71, 0x80008000, v71
    v_xor_b32 v76, 0x80008000, v76
    v_xor_b32 v77, 0x80008000, v77
    v_xor_b32 v78, 0x80008000, v78
    v_xor_b32 v79, 0x80008000, v79
    s_mov_b64 exec, -1
    s_waitcnt vmcnt(4) lgkmcnt(4)
    v_mfma_f32_32x32x16_bf16 v[0:15], v[64:67], v[176:179], 0
    v_mul_f32 v255, v32, v152
    v_fmac_f32 v255, v33, v153
    v_fmac_f32 v255, v34, v154
    v_fmac_f32 v255, v35, v155
    s_add_u32 m0, s21, 2048
    v_mfma_f32_32x32x16_bf16 v[16:31], v[68:71], v[176:179], v[16:31]
    v_lshl_add_u32 v236, v236, 10, v246
    v_lshl_add_u32 v237, v237, 10, v246
    buffer_load_dwordx4 v236, s[4:7], s39 offen lds
    buffer_load_dwordx4 v237, s[8:11], s39 offen offset:1024 lds
    ds_read_b64_tr_b16 v[176:177], v244 offset:4096
    ds_read_b64_tr_b16 v[178:179], v244 offset:5120
    ds_read_b64_tr_b16 v[184:185], v245 offset:4096
    ds_read_b64_tr_b16 v[186:187], v245 offset:5120
    v_fmac_f32 v255, v36, v156
    v_fmac_f32 v255, v37, v157
    v_fmac_f32 v255, v38, v158
    v_fmac_f32 v255, v39, v159
    s_waitcnt vmcnt(4) lgkmcnt(0)
    v_mfma_f32_32x32x16_bf16 v[0:15], v[72:75], v[176:179], v[0:15]
    v_fmac_f32 v201, v40, v168
    v_fmac_f32 v201, v41, v169
    v_permlane32_swap_b32 v197, v255
    s_add_u32 m0, s21, 4096
    v_mfma_f32_32x32x16_bf16 v[16:31], v[76:79], v[176:179], v[16:31]
    v_lshl_add_u32 v238, v238, 10, v246
    v_lshl_add_u32 v239, v239, 10, v246
    buffer_load_dwordx4 v238, s[4:7], s40 offen lds
    buffer_load_dwordx4 v239, s[8:11], s40 offen offset:1024 lds
    ds_read_b64_tr_b16 v[176:177], v244 offset:6144
    ds_read_b64_tr_b16 v[178:179], v244 offset:7168
    ds_read_b64_tr_b16 v[188:189], v245 offset:6144
    ds_read_b64_tr_b16 v[190:191], v245 offset:7168
    v_fmac_f32 v201, v42, v170
    v_fmac_f32 v201, v43, v171
    v_fmac_f32 v201, v44, v172
    v_fmac_f32 v201, v45, v173
    s_waitcnt lgkmcnt(0)
    s_mov_b64 exec, s[56:57]
    v_xor_b32 v84, 0x80008000, v84
    v_xor_b32 v85, 0x80008000, v85
    v_xor_b32 v86, 0x80008000, v86
    v_xor_b32 v87, 0x80008000, v87
    s_mov_b64 exec, -1
    v_mfma_f32_32x32x16_bf16 v[0:15], v[80:83], v[176:179], v[0:15]
    v_fmac_f32 v201, v46, v174
    v_fmac_f32 v201, v47, v175
    v_add_f32 v255, v197, v255
    s_set_gpr_idx_on s51, gpr_idx(DST)
    s_nop 0
    v_cvt_pk_bf16_f32 v206, v254, v255
    s_set_gpr_idx_off
    s_add_u32 m0, s21, 6144
    v_mfma_f32_32x32x16_bf16 v[16:31], v[84:87], v[176:179], v[16:31]
    v_lshl_add_u32 v240, v240, 10, v246
    v_lshl_add_u32 v241, v241, 10, v246
    buffer_load_dwordx4 v240, s[4:7], s41 offen lds
    buffer_load_dwordx4 v241, s[8:11], s41 offen offset:1024 lds
    v_mfma_f32_32x32x16_bf16 v[32:47], v[64:67], v[180:183], 0
    v_mul_f32 v254, v0, v144
    v_fmac_f32 v254, v1, v145
    v_fmac_f32 v254, v2, v146
    v_fmac_f32 v254, v3, v147
    v_fmac_f32 v254, v4, v148
    v_fmac_f32 v254, v5, v149
    v_fmac_f32 v254, v6, v150
    v_mfma_f32_32x32x16_bf16 v[48:63], v[68:71], v[180:183], v[48:63]
    v_fmac_f32 v254, v7, v151
    v_fma_f32 v202, v8, -v160, v202
    v_fma_f32 v202, v9, -v161, v202
    v_permlane32_swap_b32 v254, v200
    v_fma_f32 v202, v10, -v162, v202
    v_fma_f32 v202, v11, -v163, v202
    v_mfma_f32_32x32x16_bf16 v[32:47], v[72:75], v[184:187], v[32:47]
    v_fma_f32 v202, v12, -v164, v202
    v_fma_f32 v202, v13, -v165, v202
    v_fma_f32 v202, v14, -v166, v202
    v_fma_f32 v202, v15, -v167, v202
    v_add_f32 v200, v254, v200
    v_fmac_f32 v198, v16, v112
    v_permlane32_swap_b32 v202, v254
    v_mfma_f32_32x32x16_bf16 v[48:63], v[76:79], v[184:187], v[48:63]
    s_waitcnt vmcnt(6)
    ds_read_b64_tr_b16 v[176:177], v244 offset:0
    ds_read_b64_tr_b16 v[178:179], v244 offset:1024
    ds_read_b64_tr_b16 v[180:181], v245 offset:0
    ds_read_b64_tr_b16 v[182:183], v245 offset:1024
    v_fmac_f32 v198, v17, v113
    v_fmac_f32 v198, v18, v114
    v_fmac_f32 v198, v19, v115
    v_fmac_f32 v198, v20, v116
    v_fmac_f32 v198, v21, v117
    v_fmac_f32 v198, v22, v118
    v_mfma_f32_32x32x16_bf16 v[32:47], v[80:83], v[188:191], v[32:47]
    v_fmac_f32 v198, v23, v119
    v_add_f32 v254, v202, v254
    v_mul_f32 v196, v24, v160
    v_fmac_f32 v196, v25, v161
    v_fmac_f32 v196, v26, v162
    v_fmac_f32 v196, v27, v163
    v_fmac_f32 v196, v28, v164
    v_mfma_f32_32x32x16_bf16 v[48:63], v[84:87], v[188:191], v[48:63]
    v_add_u32 v249, s48, v249
    v_add_u32 v250, s49, v250
    ds_read_b32 v252, v251 offset:16
    ds_read_b64_tr_b16 v[64:65], v249 offset:0
    ds_read_b64_tr_b16 v[68:69], v249 offset:64
    ds_read_b64_tr_b16 v[66:67], v249 offset:256
    ds_read_b64_tr_b16 v[70:71], v249 offset:320
    s_mov_b64 exec, s[54:55]
    ds_read_u16_d16_hi v242, v250 offset:0
    s_mov_b64 exec, -1
    v_fmac_f32 v196, v29, v165
    v_fmac_f32 v196, v30, v166
    v_fmac_f32 v196, v31, v167
    s_nop 1
    v_permlane32_swap_b32 v198, v196
    v_add_f32 v196, v198, v196
    v_mul_f32 v255, v32, v152
    v_fmac_f32 v255, v33, v153
    v_fmac_f32 v255, v34, v154
    v_fmac_f32 v255, v35, v155
    v_fmac_f32 v255, v36, v156
    v_fmac_f32 v255, v37, v157
    v_fmac_f32 v255, v38, v158
    v_fmac_f32 v255, v39, v159
    v_fma_f32 v203, v40, -v168, v203
    v_fma_f32 v203, v41, -v169, v203
    v_permlane32_swap_b32 v255, v201
    v_fma_f32 v203, v42, -v170, v203
    v_fma_f32 v203, v43, -v171, v203
    v_fma_f32 v203, v44, -v172, v203
    v_fma_f32 v203, v45, -v173, v203
    v_fma_f32 v203, v46, -v174, v203
    v_fma_f32 v203, v47, -v175, v203
    v_add_f32 v201, v255, v201
    v_fmac_f32 v199, v48, v120
    v_permlane32_swap_b32 v203, v255
    v_fmac_f32 v199, v49, v121
    v_fmac_f32 v199, v50, v122
    v_fmac_f32 v199, v51, v123
    v_fmac_f32 v199, v52, v124
    v_fmac_f32 v199, v53, v125
    v_fmac_f32 v199, v54, v126
    v_fmac_f32 v199, v55, v127
    v_add_f32 v255, v203, v255
    v_mul_f32 v197, v56, v168
    v_fmac_f32 v197, v57, v169
    v_fmac_f32 v197, v58, v170
    v_fmac_f32 v197, v59, v171
    v_fmac_f32 v197, v60, v172
    v_fmac_f32 v197, v61, v173
    v_fmac_f32 v197, v62, v174
    v_fmac_f32 v197, v63, v175
    s_nop 1
    v_permlane32_swap_b32 v199, v197
    v_add_f32 v197, v199, v197
    s_set_gpr_idx_on s51, gpr_idx(DST)
    s_nop 0
    v_cvt_pk_bf16_f32 v207, v200, v201
    v_cvt_pk_bf16_f32 v209, v254, v255
    v_cvt_pk_bf16_f32 v208, v196, v197
    s_set_gpr_idx_off
    s_add_u32 s50, s50, 1
    s_add_u32 s51, s51, 6
    s_cmp_ge_u32 s50, 4
    s_cbranch_scc1 LAST0
    s_waitcnt lgkmcnt(5)
    v_readfirstlane_b32 s66, v252
    s_add_u32 s53, s53, 1
    v_mov_b32 v252, s53
    s_cmp_le_u32 s53, s66
    ds_write2_b32 v251, v252, v252 offset0:0 offset1:8
    s_setprio 1
    s_cbranch_scc1 PRIO_7
    s_setprio 0
PRIO_7:
    s_cmp_eq_u32 s52, 4
    s_cbranch_scc1 ITEM_0_4
    s_cmp_eq_u32 s52, 5
    s_cbranch_scc1 ITEM_0_5
    s_cmp_eq_u32 s52, 3
    s_cbranch_scc1 ITEM_0_3
    s_cmp_eq_u32 s52, 6
    s_cbranch_scc1 ITEM_0_6
    s_cmp_eq_u32 s52, 8
    s_cbranch_scc1 ITEM_0_8
    s_branch ITEM_0_2
.p2align 6
ITEM_0_8:
    s_mov_b64 exec, s[54:55]
    ds_read_u16_d16_hi v243, v250 offset:128
    s_mov_b64 exec, -1
    ds_read_b64_tr_b16 v[72:73], v249 offset:512
    ds_read_b64_tr_b16 v[76:77], v249 offset:576
    ds_read_b64_tr_b16 v[74:75], v249 offset:768
    ds_read_b64_tr_b16 v[78:79], v249 offset:832
    ds_read_b64_tr_b16 v[80:81], v249 offset:1024
    ds_read_b64_tr_b16 v[84:85], v249 offset:1088
    ds_read_b64_tr_b16 v[82:83], v249 offset:1280
    ds_read_b64_tr_b16 v[86:87], v249 offset:1344
    ds_read_b64_tr_b16 v[88:89], v249 offset:1536
    ds_read_b64_tr_b16 v[92:93], v249 offset:1600
    ds_read_b64_tr_b16 v[90:91], v249 offset:1792
    ds_read_b64_tr_b16 v[94:95], v249 offset:1856
    s_waitcnt lgkmcnt(13)
    v_mul_f32_dpp v196, v242, v64 row_newbcast:0 row_mask:0xf bank_mask:0xf
    v_mul_f32_dpp v197, v242, v65 row_newbcast:1 row_mask:0xf bank_mask:0xf
    v_mul_f32_dpp v198, v242, v64 row_newbcast:8 row_mask:0xf bank_mask:0xf
    v_mul_f32_dpp v199, v242, v65 row_newbcast:9 row_mask:0xf bank_mask:0xf
    v_mul_f32_dpp v200, v242, v68 row_newbcast:2 row_mask:0xf bank_mask:0xf
    v_mul_f32_dpp v201, v242, v69 row_newbcast:3 row_mask:0xf bank_mask:0xf
    v_mul_f32_dpp v202, v242, v68 row_newbcast:10 row_mask:0xf bank_mask:0xf
    v_mul_f32_dpp v203, v242, v69 row_newbcast:11 row_mask:0xf bank_mask:0xf
    v_cvt_pk_bf16_f32 v64, v196, v197
    v_cvt_pk_bf16_f32 v68, v198, v199
    v_cvt_pk_bf16_f32 v65, v200, v201
    v_cvt_pk_bf16_f32 v69, v202, v203
    v_mul_f32_dpp v196, v242, v66 row_newbcast:4 row_mask:0xf bank_mask:0xf
    v_mul_f32_dpp v197, v242, v67 row_newbcast:5 row_mask:0xf bank_mask:0xf
    v_mul_f32_dpp v198, v242, v66 row_newbcast:12 row_mask:0xf bank_mask:0xf
    v_mul_f32_dpp v199, v242, v67 row_newbcast:13 row_mask:0xf bank_mask:0xf
    v_mul_f32_dpp v200, v242, v70 row_newbcast:6 row_mask:0xf bank_mask:0xf
    v_mul_f32_dpp v201, v242, v71 row_newbcast:7 row_mask:0xf bank_mask:0xf
    v_mul_f32_dpp v202, v242, v70 row_newbcast:14 row_mask:0xf bank_mask:0xf
    v_mul_f32_dpp v203, v242, v71 row_newbcast:15 row_mask:0xf bank_mask:0xf
    v_cvt_pk_bf16_f32 v66, v196, v197
    v_cvt_pk_bf16_f32 v70, v198, v199
    v_cvt_pk_bf16_f32 v67, v200, v201
    v_cvt_pk_bf16_f32 v71, v202, v203
    s_mov_b64 exec, s[54:55]
    ds_read_u16_d16_hi v242, v250 offset:256
    s_mov_b64 exec, -1
    s_waitcnt vmcnt(4) lgkmcnt(9)
    v_mfma_f32_32x32x16_bf16 v[0:15], v[64:67], v[176:179], 0
    v_mul_f32_dpp v196, v243, v72 row_newbcast:0 row_mask:0xf bank_mask:0xf
    v_mul_f32_dpp v197, v243, v73 row_newbcast:1 row_mask:0xf bank_mask:0xf
    v_mul_f32_dpp v198, v243, v72 row_newbcast:8 row_mask:0xf bank_mask:0xf
    v_mul_f32_dpp v199, v243, v73 row_newbcast:9 row_mask:0xf bank_mask:0xf
    v_mul_f32_dpp v200, v243, v76 row_newbcast:2 row_mask:0xf bank_mask:0xf
    v_mul_f32_dpp v201, v243, v77 row_newbcast:3 row_mask:0xf bank_mask:0xf
    v_mul_f32_dpp v202, v243, v76 row_newbcast:10 row_mask:0xf bank_mask:0xf
    v_mul_f32_dpp v203, v243, v77 row_newbcast:11 row_mask:0xf bank_mask:0xf
    v_cvt_pk_bf16_f32 v72, v196, v197
    v_cvt_pk_bf16_f32 v76, v198, v199
    v_cvt_pk_bf16_f32 v73, v200, v201
    v_cvt_pk_bf16_f32 v77, v202, v203
    s_add_u32 m0, s21, 0
    v_mfma_f32_32x32x16_bf16 v[16:31], v[68:71], v[176:179], 0
    buffer_load_dwordx4 v234, s[4:7], s35 offen lds
    buffer_load_dwordx4 v235, s[8:11], s35 offen offset:1024 lds
    ds_read_b64_tr_b16 v[176:177], v244 offset:2048
    ds_read_b64_tr_b16 v[178:179], v244 offset:3072
    ds_read_b64_tr_b16 v[184:185], v245 offset:2048
    ds_read_b64_tr_b16 v[186:187], v245 offset:3072
    v_mul_f32_dpp v196, v243, v74 row_newbcast:4 row_mask:0xf bank_mask:0xf
    v_mul_f32_dpp v197, v243, v75 row_newbcast:5 row_mask:0xf bank_mask:0xf
    v_mul_f32_dpp v198, v243, v74 row_newbcast:12 row_mask:0xf bank_mask:0xf
    v_mul_f32_dpp v199, v243, v75 row_newbcast:13 row_mask:0xf bank_mask:0xf
    v_mul_f32_dpp v200, v243, v78 row_newbcast:6 row_mask:0xf bank_mask:0xf
    v_mul_f32_dpp v201, v243, v79 row_newbcast:7 row_mask:0xf bank_mask:0xf
    v_mul_f32_dpp v202, v243, v78 row_newbcast:14 row_mask:0xf bank_mask:0xf
    v_mul_f32_dpp v203, v243, v79 row_newbcast:15 row_mask:0xf bank_mask:0xf
    v_cvt_pk_bf16_f32 v74, v196, v197
    v_cvt_pk_bf16_f32 v78, v198, v199
    v_cvt_pk_bf16_f32 v75, v200, v201
    v_cvt_pk_bf16_f32 v79, v202, v203
    s_mov_b64 exec, s[54:55]
    ds_read_u16_d16_hi v243, v250 offset:384
    s_mov_b64 exec, -1
    s_waitcnt vmcnt(4) lgkmcnt(1)
    v_mfma_f32_32x32x16_bf16 v[0:15], v[72:75], v[176:179], v[0:15]
    v_mul_f32_dpp v196, v242, v80 row_newbcast:0 row_mask:0xf bank_mask:0xf
    v_mul_f32_dpp v197, v242, v81 row_newbcast:1 row_mask:0xf bank_mask:0xf
    v_mul_f32_dpp v198, v242, v80 row_newbcast:8 row_mask:0xf bank_mask:0xf
    v_mul_f32_dpp v199, v242, v81 row_newbcast:9 row_mask:0xf bank_mask:0xf
    v_mul_f32_dpp v200, v242, v84 row_newbcast:2 row_mask:0xf bank_mask:0xf
    v_mul_f32_dpp v201, v242, v85 row_newbcast:3 row_mask:0xf bank_mask:0xf
    v_mul_f32_dpp v202, v242, v84 row_newbcast:10 row_mask:0xf bank_mask:0xf
    v_mul_f32_dpp v203, v242, v85 row_newbcast:11 row_mask:0xf bank_mask:0xf
    v_cvt_pk_bf16_f32 v80, v196, v197
    v_cvt_pk_bf16_f32 v84, v198, v199
    v_cvt_pk_bf16_f32 v81, v200, v201
    v_cvt_pk_bf16_f32 v85, v202, v203
    s_add_u32 m0, s21, 2048
    v_mfma_f32_32x32x16_bf16 v[16:31], v[76:79], v[176:179], v[16:31]
    buffer_load_dwordx4 v236, s[4:7], s35 offen lds
    buffer_load_dwordx4 v237, s[8:11], s35 offen offset:1024 lds
    ds_read_b64_tr_b16 v[176:177], v244 offset:4096
    ds_read_b64_tr_b16 v[178:179], v244 offset:5120
    ds_read_b64_tr_b16 v[188:189], v245 offset:4096
    ds_read_b64_tr_b16 v[190:191], v245 offset:5120
    v_mul_f32_dpp v196, v242, v82 row_newbcast:4 row_mask:0xf bank_mask:0xf
    v_mul_f32_dpp v197, v242, v83 row_newbcast:5 row_mask:0xf bank_mask:0xf
    v_mul_f32_dpp v198, v242, v82 row_newbcast:12 row_mask:0xf bank_mask:0xf
    v_mul_f32_dpp v199, v242, v83 row_newbcast:13 row_mask:0xf bank_mask:0xf
    v_mul_f32_dpp v200, v242, v86 row_newbcast:6 row_mask:0xf bank_mask:0xf
    v_mul_f32_dpp v201, v242, v87 row_newbcast:7 row_mask:0xf bank_mask:0xf
    v_mul_f32_dpp v202, v242, v86 row_newbcast:14 row_mask:0xf bank_mask:0xf
    v_mul_f32_dpp v203, v242, v87 row_newbcast:15 row_mask:0xf bank_mask:0xf
    v_cvt_pk_bf16_f32 v82, v196, v197
    v_cvt_pk_bf16_f32 v86, v198, v199
    v_cvt_pk_bf16_f32 v83, v200, v201
    v_cvt_pk_bf16_f32 v87, v202, v203
    s_nop 0
    s_waitcnt vmcnt(4) lgkmcnt(0)
    v_mfma_f32_32x32x16_bf16 v[0:15], v[80:83], v[176:179], v[0:15]
    v_mul_f32_dpp v196, v243, v88 row_newbcast:0 row_mask:0xf bank_mask:0xf
    v_mul_f32_dpp v197, v243, v89 row_newbcast:1 row_mask:0xf bank_mask:0xf
    v_mul_f32_dpp v198, v243, v88 row_newbcast:8 row_mask:0xf bank_mask:0xf
    v_mul_f32_dpp v199, v243, v89 row_newbcast:9 row_mask:0xf bank_mask:0xf
    v_mul_f32_dpp v200, v243, v92 row_newbcast:2 row_mask:0xf bank_mask:0xf
    v_mul_f32_dpp v201, v243, v93 row_newbcast:3 row_mask:0xf bank_mask:0xf
    v_mul_f32_dpp v202, v243, v92 row_newbcast:10 row_mask:0xf bank_mask:0xf
    v_mul_f32_dpp v203, v243, v93 row_newbcast:11 row_mask:0xf bank_mask:0xf
    v_cvt_pk_bf16_f32 v88, v196, v197
    v_cvt_pk_bf16_f32 v92, v198, v199
    v_cvt_pk_bf16_f32 v89, v200, v201
    v_cvt_pk_bf16_f32 v93, v202, v203
    s_add_u32 m0, s21, 4096
    v_mfma_f32_32x32x16_bf16 v[16:31], v[84:87], v[176:179], v[16:31]
    buffer_load_dwordx4 v238, s[4:7], s35 offen lds
    buffer_load_dwordx4 v239, s[8:11], s35 offen offset:1024 lds
    ds_read_b64_tr_b16 v[176:177], v244 offset:6144
    ds_read_b64_tr_b16 v[178:179], v244 offset:7168
    ds_read_b64_tr_b16 v[192:193], v245 offset:6144
    ds_read_b64_tr_b16 v[194:195], v245 offset:7168
    v_mul_f32_dpp v196, v243, v90 row_newbcast:4 row_mask:0xf bank_mask:0xf
    v_mul_f32_dpp v197, v243, v91 row_newbcast:5 row_mask:0xf bank_mask:0xf
    v_mul_f32_dpp v198, v243, v90 row_newbcast:12 row_mask:0xf bank_mask:0xf
    v_mul_f32_dpp v199, v243, v91 row_newbcast:13 row_mask:0xf bank_mask:0xf
    v_mul_f32_dpp v200, v243, v94 row_newbcast:6 row_mask:0xf bank_mask:0xf
    v_mul_f32_dpp v201, v243, v95 row_newbcast:7 row_mask:0xf bank_mask:0xf
    v_mul_f32_dpp v202, v243, v94 row_newbcast:14 row_mask:0xf bank_mask:0xf
    v_mul_f32_dpp v203, v243, v95 row_newbcast:15 row_mask:0xf bank_mask:0xf
    v_cvt_pk_bf16_f32 v90, v196, v197
    v_cvt_pk_bf16_f32 v94, v198, v199
    v_cvt_pk_bf16_f32 v91, v200, v201
    v_cvt_pk_bf16_f32 v95, v202, v203
    s_nop 0
    s_waitcnt lgkmcnt(0)
    v_mfma_f32_32x32x16_bf16 v[0:15], v[88:91], v[176:179], v[0:15]
    s_add_u32 m0, s21, 6144
    v_mfma_f32_32x32x16_bf16 v[16:31], v[92:95], v[176:179], v[16:31]
    buffer_load_dwordx4 v240, s[4:7], s35 offen lds
    buffer_load_dwordx4 v241, s[8:11], s35 offen offset:1024 lds
    s_mov_b32 m0, s50
    s_nop 0
    s_movrels_b32 s71, s23
    s_bfe_u32 s46, s71, 0x30012
    s_mov_b32 m0, s46
    s_and_b32 s66, s71, 0x3ffff
    s_movrels_b32 s68, s57
    s_movrels_b32 s69, s61
    s_sub_u32 s48, s66, s47
    s_mov_b32 s47, s66
    s_lshr_b32 s52, s71, 28
    s_lshl_b32 s67, s46, 9
    s_add_u32 s66, s66, s67
    s_sub_u32 s49, s66, s42
    s_mov_b32 s42, s66
    s_bfe_u32 s66, s68, 655360
    s_add_u32 s43, s42, s66
    s_bfe_u32 s39, s69, 655360
    s_bfe_u32 s66, s68, 655370
    s_add_u32 s44, s42, s66
    s_bfe_u32 s40, s69, 655370
    s_bfe_u32 s66, s68, 655380
    s_add_u32 s45, s42, s66
    s_bfe_u32 s41, s69, 655380
    s_and_b32 s66, s46, s33
    s_cselect_b32 s72, -1, 1
    s_cselect_b32 s76, s47, 163712
    s_cmp_ge_u32 s66, 2
    s_cselect_b32 s73, -1, 0
    s_add_u32 s77, s47, 1024
    s_cmp_ge_u32 s66, 4
    s_cselect_b32 s75, -1, 0
    s_cmp_ge_u32 s66, 3
    s_cselect_b32 s74, -1, 1
    s_cselect_b32 s77, s77, 163712
    v_mfma_f32_32x32x16_bf16 v[32:47], v[64:67], v[180:183], 0
    v_mul_f32 v196, v0, v96
    v_fmac_f32 v196, v1, v97
    v_fmac_f32 v196, v2, v98
    v_fmac_f32 v196, v3, v99
    v_fmac_f32 v196, v4, v100
    v_mfma_f32_32x32x16_bf16 v[48:63], v[68:71], v[180:183], 0
    v_add_u32 v253, s47, v248
    ds_read_b32 v254, v253
    ds_read_b32 v255, v253 offset:256
    v_fmac_f32 v196, v5, v101
    v_fmac_f32 v196, v6, v102
    v_fmac_f32 v196, v7, v103
    v_mul_f32 v198, v8, v128
    v_fmac_f32 v198, v9, v129
    v_mfma_f32_32x32x16_bf16 v[32:47], v[72:75], v[184:187], v[32:47]
    v_fmac_f32 v198, v10, v130
    v_fmac_f32 v198, v11, v131
    v_fmac_f32 v198, v12, v132
    v_fmac_f32 v198, v13, v133
    v_mfma_f32_32x32x16_bf16 v[48:63], v[76:79], v[184:187], v[48:63]
    v_fmac_f32 v198, v14, v134
    v_fmac_f32 v198, v15, v135
    v_mul_f32 v200, v16, v128
    v_fmac_f32 v200, v17, v129
    v_permlane32_swap_b32 v196, v198
    v_mfma_f32_32x32x16_bf16 v[32:47], v[80:83], v[188:191], v[32:47]
    v_fmac_f32 v200, v18, v130
    v_fmac_f32 v200, v19, v131
    v_fmac_f32 v200, v20, v132
    v_fmac_f32 v200, v21, v133
    v_fmac_f32 v200, v22, v134
    v_mfma_f32_32x32x16_bf16 v[48:63], v[84:87], v[188:191], v[48:63]
    s_waitcnt vmcnt(6)
    ds_read_b64_tr_b16 v[176:177], v244 offset:0
    ds_read_b64_tr_b16 v[178:179], v244 offset:1024
    ds_read_b64_tr_b16 v[180:181], v245 offset:0
    ds_read_b64_tr_b16 v[182:183], v245 offset:1024
    v_fmac_f32 v200, v23, v135
    v_add_f32 v198, v196, v198
    v_mul_f32_e64 v202, v24, -v128
    v_fma_f32 v202, v25, -v129, v202
    v_mfma_f32_32x32x16_bf16 v[32:47], v[88:91], v[192:195], v[32:47]
    v_fma_f32 v202, v26, -v130, v202
    v_fma_f32 v202, v27, -v131, v202
    v_fma_f32 v202, v28, -v132, v202
    v_fma_f32 v202, v29, -v133, v202
    v_fma_f32 v202, v30, -v134, v202
    v_mfma_f32_32x32x16_bf16 v[48:63], v[92:95], v[192:195], v[48:63]
    v_fma_f32 v202, v31, -v135, v202
    s_nop 1
    v_permlane32_swap_b32 v200, v202
    v_add_f32 v202, v200, v202
    s_waitcnt vmcnt(4) lgkmcnt(0)
    v_mfma_f32_32x32x16_bf16 v[0:15], v[64:67], v[176:179], 0
    v_mul_f32 v197, v32, v104
    v_fmac_f32 v197, v33, v105
    v_fmac_f32 v197, v34, v106
    v_fmac_f32 v197, v35, v107
    v_fmac_f32 v197, v36, v108
    v_fmac_f32 v197, v37, v109
    s_add_u32 m0, s21, 0
    v_mfma_f32_32x32x16_bf16 v[16:31], v[68:71], v[176:179], 0
    buffer_load_dwordx4 v234, s[4:7], s36 offen lds
    buffer_load_dwordx4 v235, s[8:11], s36 offen offset:1024 lds
    ds_read_b64_tr_b16 v[176:177], v244 offset:2048
    ds_read_b64_tr_b16 v[178:179], v244 offset:3072
    ds_read_b64_tr_b16 v[184:185], v245 offset:2048
    ds_read_b64_tr_b16 v[186:187], v245 offset:3072
    s_mov_b32 m0, s76
    s_mov_b64 exec, s[72:73]
    buffer_load_dwordx4 v254, s[12:15], 0 offen  lds
    s_mov_b32 m0, s77
    s_mov_b64 exec, s[74:75]
    buffer_load_dwordx4 v255, s[12:15], 0 offen  lds
    s_mov_b64 exec, -1
    v_fmac_f32 v197, v38, v110
    v_fmac_f32 v197, v39, v111
    v_mul_f32 v199, v40, v136
    v_fmac_f32 v199, v41, v137
    v_fmac_f32 v199, v42, v138
    s_waitcnt vmcnt(6) lgkmcnt(0)
    v_mfma_f32_32x32x16_bf16 v[0:15], v[72:75], v[176:179], v[0:15]
    v_fmac_f32 v199, v43, v139
    v_fmac_f32 v199, v44, v140
    v_fmac_f32 v199, v45, v141
    v_fmac_f32 v199, v46, v142
    v_fmac_f32 v199, v47, v143
    s_add_u32 m0, s21, 2048
    v_mfma_f32_32x32x16_bf16 v[16:31], v[76:79], v[176:179], v[16:31]
    buffer_load_dwordx4 v236, s[4:7], s36 offen lds
    buffer_load_dwordx4 v237, s[8:11], s36 offen offset:1024 lds
    ds_read_b64_tr_b16 v[176:177], v244 offset:4096
    ds_read_b64_tr_b16 v[178:179], v244 offset:5120
    ds_read_b64_tr_b16 v[188:189], v245 offset:4096
    ds_read_b64_tr_b16 v[190:191], v245 offset:5120
    v_mul_f32 v201, v48, v136
    v_fmac_f32 v201, v49, v137
    v_permlane32_swap_b32 v197, v199
    v_fmac_f32 v201, v50, v138
    v_fmac_f32 v201, v51, v139
    s_waitcnt vmcnt(6) lgkmcnt(0)
    v_mfma_f32_32x32x16_bf16 v[0:15], v[80:83], v[176:179], v[0:15]
    v_fmac_f32 v201, v52, v140
    v_fmac_f32 v201, v53, v141
    v_fmac_f32 v201, v54, v142
    v_fmac_f32 v201, v55, v143
    v_add_f32 v199, v197, v199
    v_mul_f32_e64 v203, v56, -v136
    s_add_u32 m0, s21, 4096
    v_mfma_f32_32x32x16_bf16 v[16:31], v[84:87], v[176:179], v[16:31]
    buffer_load_dwordx4 v238, s[4:7], s36 offen lds
    buffer_load_dwordx4 v239, s[8:11], s36 offen offset:1024 lds
    ds_read_b64_tr_b16 v[176:177], v244 offset:6144
    ds_read_b64_tr_b16 v[178:179], v244 offset:7168
    ds_read_b64_tr_b16 v[192:193], v245 offset:6144
    ds_read_b64_tr_b16 v[194:195], v245 offset:7168
    v_fma_f32 v203, v57, -v137, v203
    v_fma_f32 v203, v58, -v138, v203
    v_fma_f32 v203, v59, -v139, v203
    v_fma_f32 v203, v60, -v140, v203
    v_fma_f32 v203, v61, -v141, v203
    s_waitcnt lgkmcnt(0)
    v_mfma_f32_32x32x16_bf16 v[0:15], v[88:91], v[176:179], v[0:15]
    v_fma_f32 v203, v62, -v142, v203
    v_fma_f32 v203, v63, -v143, v203
    s_nop 1
    v_permlane32_swap_b32 v201, v203
    v_add_f32 v203, v201, v203
    s_add_u32 m0, s21, 6144
    v_mfma_f32_32x32x16_bf16 v[16:31], v[92:95], v[176:179], v[16:31]
    buffer_load_dwordx4 v240, s[4:7], s36 offen lds
    buffer_load_dwordx4 v241, s[8:11], s36 offen offset:1024 lds
    s_set_gpr_idx_on s51, gpr_idx(DST)
    s_nop 0
    v_cvt_pk_bf16_f32 v204, v198, v199
    v_cvt_pk_bf16_f32 v205, v202, v203
    s_set_gpr_idx_off
    v_mfma_f32_32x32x16_bf16 v[32:47], v[64:67], v[180:183], 0
    v_mul_f32 v196, v0, v144
    v_fmac_f32 v196, v1, v145
    v_fmac_f32 v196, v2, v146
    v_fmac_f32 v196, v3, v147
    v_mfma_f32_32x32x16_bf16 v[48:63], v[68:71], v[180:183], 0
    v_fmac_f32 v196, v4, v148
    v_fmac_f32 v196, v5, v149
    v_fmac_f32 v196, v6, v150
    v_fmac_f32 v196, v7, v151
    v_mfma_f32_32x32x16_bf16 v[32:47], v[72:75], v[184:187], v[32:47]
    v_mul_f32 v198, v8, v112
    v_fmac_f32 v198, v9, v113
    v_fmac_f32 v198, v10, v114
    v_fmac_f32 v198, v11, v115
    v_mfma_f32_32x32x16_bf16 v[48:63], v[76:79], v[184:187], v[48:63]
    v_fmac_f32 v198, v12, v116
    v_fmac_f32 v198, v13, v117
    v_fmac_f32 v198, v14, v118
    v_fmac_f32 v198, v15, v119
    v_mfma_f32_32x32x16_bf16 v[32:47], v[80:83], v[188:191], v[32:47]
    v_mul_f32_e64 v200, v16, -v160
    v_fma_f32 v200, v17, -v161, v200
    v_fma_f32 v200, v18, -v162, v200
    v_fma_f32 v200, v19, -v163, v200
    v_mfma_f32_32x32x16_bf16 v[48:63], v[84:87], v[188:191], v[48:63]
    s_waitcnt vmcnt(8)
    ds_read_b64_tr_b16 v[176:177], v244 offset:0
    ds_read_b64_tr_b16 v[178:179], v244 offset:1024
    ds_read_b64_tr_b16 v[180:181], v245 offset:0
    ds_read_b64_tr_b16 v[182:183], v245 offset:1024
    v_fma_f32 v200, v20, -v164, v200
    v_fma_f32 v200, v21, -v165, v200
    v_fma_f32 v200, v22, -v166, v200
    v_fma_f32 v200, v23, -v167, v200
    v_mfma_f32_32x32x16_bf16 v[32:47], v[88:91], v[192:195], v[32:47]
    v_mul_f32_e64 v202, v24, -v160
    v_fma_f32 v202, v25, -v161, v202
    v_fma_f32 v202, v26, -v162, v202
    v_fma_f32 v202, v27, -v163, v202
    v_mfma_f32_32x32x16_bf16 v[48:63], v[92:95], v[192:195], v[48:63]
    v_fma_f32 v202, v28, -v164, v202
    v_fma_f32 v202, v29, -v165, v202
    v_fma_f32 v202, v30, -v166, v202
    v_fma_f32 v202, v31, -v167, v202
    s_waitcnt vmcnt(4) lgkmcnt(0)
    v_mfma_f32_32x32x16_bf16 v[0:15], v[64:67], v[176:179], 0
    s_nop 0
    v_mul_f32 v197, v32, v152
    v_fmac_f32 v197, v33, v153
    v_fmac_f32 v197, v34, v154
    v_fmac_f32 v197, v35, v155
    s_add_u32 m0, s21, 0
    v_mfma_f32_32x32x16_bf16 v[16:31], v[68:71], v[176:179], 0
    buffer_load_dwordx4 v234, s[4:7], s37 offen lds
    buffer_load_dwordx4 v235, s[8:11], s37 offen offset:1024 lds
    ds_read_b64_tr_b16 v[176:177], v244 offset:2048
    ds_read_b64_tr_b16 v[178:179], v244 offset:3072
    ds_read_b64_tr_b16 v[184:185], v245 offset:2048
    ds_read_b64_tr_b16 v[186:187], v245 offset:3072
    v_add_u32 v252, s42, v247
    ds_read_u16 v234, v252
    ds_read_u16 v235, v252 offset:64
    v_fmac_f32 v197, v36, v156
    v_fmac_f32 v197, v37, v157
    v_fmac_f32 v197, v38, v158
    v_fmac_f32 v197, v39, v159
    s_waitcnt vmcnt(4) lgkmcnt(2)
    v_mfma_f32_32x32x16_bf16 v[0:15], v[72:75], v[176:179], v[0:15]
    v_mul_f32 v199, v40, v120
    v_fmac_f32 v199, v41, v121
    v_fmac_f32 v199, v42, v122
    v_fmac_f32 v199, v43, v123
    s_add_u32 m0, s21, 2048
    v_mfma_f32_32x32x16_bf16 v[16:31], v[76:79], v[176:179], v[16:31]
    buffer_load_dwordx4 v236, s[4:7], s37 offen lds
    buffer_load_dwordx4 v237, s[8:11], s37 offen offset:1024 lds
    ds_read_b64_tr_b16 v[176:177], v244 offset:4096
    ds_read_b64_tr_b16 v[178:179], v244 offset:5120
    ds_read_b64_tr_b16 v[188:189], v245 offset:4096
    ds_read_b64_tr_b16 v[190:191], v245 offset:5120
    v_add_u32 v252, s43, v247
    ds_read_u16 v236, v252
    ds_read_u16 v237, v252 offset:64
    v_fmac_f32 v199, v44, v124
    v_fmac_f32 v199, v45, v125
    v_fmac_f32 v199, v46, v126
    v_fmac_f32 v199, v47, v127
    s_waitcnt vmcnt(4) lgkmcnt(2)
    v_mfma_f32_32x32x16_bf16 v[0:15], v[80:83], v[176:179], v[0:15]
    v_mul_f32_e64 v201, v48, -v168
    v_fma_f32 v201, v49, -v169, v201
    v_fma_f32 v201, v50, -v170, v201
    v_fma_f32 v201, v51, -v171, v201
    s_add_u32 m0, s21, 4096
    v_mfma_f32_32x32x16_bf16 v[16:31], v[84:87], v[176:179], v[16:31]
    buffer_load_dwordx4 v238, s[4:7], s37 offen lds
    buffer_load_dwordx4 v239, s[8:11], s37 offen offset:1024 lds
    ds_read_b64_tr_b16 v[176:177], v244 offset:6144
    ds_read_b64_tr_b16 v[178:179], v244 offset:7168
    ds_read_b64_tr_b16 v[192:193], v245 offset:6144
    ds_read_b64_tr_b16 v[194:195], v245 offset:7168
    v_add_u32 v252, s44, v247
    ds_read_u16 v238, v252
    ds_read_u16 v239, v252 offset:64
    v_fma_f32 v201, v52, -v172, v201
    v_fma_f32 v201, v53, -v173, v201
    v_fma_f32 v201, v54, -v174, v201
    v_fma_f32 v201, v55, -v175, v201
    s_waitcnt lgkmcnt(2)
    v_mfma_f32_32x32x16_bf16 v[0:15], v[88:91], v[176:179], v[0:15]
    v_mul_f32_e64 v203, v56, -v168
    v_fma_f32 v203, v57, -v169, v203
    v_fma_f32 v203, v58, -v170, v203
    v_fma_f32 v203, v59, -v171, v203
    s_add_u32 m0, s21, 6144
    v_mfma_f32_32x32x16_bf16 v[16:31], v[92:95], v[176:179], v[16:31]
    buffer_load_dwordx4 v240, s[4:7], s37 offen lds
    buffer_load_dwordx4 v241, s[8:11], s37 offen offset:1024 lds
    v_add_u32 v252, s45, v247
    ds_read_u16 v240, v252
    ds_read_u16 v241, v252 offset:64
    v_fma_f32 v203, v60, -v172, v203
    v_fma_f32 v203, v61, -v173, v203
    v_fma_f32 v203, v62, -v174, v203
    v_fma_f32 v203, v63, -v175, v203
    v_mfma_f32_32x32x16_bf16 v[32:47], v[64:67], v[180:183], 0
    v_mul_f32 v254, v0, v144
    v_fmac_f32 v254, v1, v145
    v_fmac_f32 v254, v2, v146
    v_mfma_f32_32x32x16_bf16 v[48:63], v[68:71], v[180:183], 0
    ds_swizzle_b32 v68, v68 offset:0x401F
    ds_swizzle_b32 v69, v69 offset:0x401F
    ds_swizzle_b32 v70, v70 offset:0x401F
    ds_swizzle_b32 v71, v71 offset:0x401F
    v_fmac_f32 v254, v3, v147
    v_fmac_f32 v254, v4, v148
    v_mfma_f32_32x32x16_bf16 v[32:47], v[72:75], v[184:187], v[32:47]
    v_fmac_f32 v254, v5, v149
    v_fmac_f32 v254, v6, v150
    v_mfma_f32_32x32x16_bf16 v[48:63], v[76:79], v[184:187], v[48:63]
    ds_swizzle_b32 v76, v76 offset:0x401F
    ds_swizzle_b32 v77, v77 offset:0x401F
    ds_swizzle_b32 v78, v78 offset:0x401F
    ds_swizzle_b32 v79, v79 offset:0x401F
    v_fmac_f32 v254, v7, v151
    v_fmac_f32 v200, v8, v160
    v_mfma_f32_32x32x16_bf16 v[32:47], v[80:83], v[188:191], v[32:47]
    v_fmac_f32 v200, v9, v161
    v_permlane32_swap_b32 v196, v254
    v_fmac_f32 v200, v10, v162
    v_mfma_f32_32x32x16_bf16 v[48:63], v[84:87], v[188:191], v[48:63]
    ds_swizzle_b32 v84, v84 offset:0x401F
    ds_swizzle_b32 v85, v85 offset:0x401F
    ds_swizzle_b32 v86, v86 offset:0x401F
    ds_swizzle_b32 v87, v87 offset:0x401F
    s_waitcnt vmcnt(6)
    ds_read_b64_tr_b16 v[176:177], v244 offset:0
    ds_read_b64_tr_b16 v[178:179], v244 offset:1024
    ds_read_b64_tr_b16 v[180:181], v245 offset:0
    ds_read_b64_tr_b16 v[182:183], v245 offset:1024
    v_fmac_f32 v200, v11, v163
    v_fmac_f32 v200, v12, v164
    v_mfma_f32_32x32x16_bf16 v[32:47], v[88:91], v[192:195], v[32:47]
    v_fmac_f32 v200, v13, v165
    v_fmac_f32 v200, v14, v166
    v_mfma_f32_32x32x16_bf16 v[48:63], v[92:95], v[192:195], v[48:63]
    ds_swizzle_b32 v92, v92 offset:0x401F
    ds_swizzle_b32 v93, v93 offset:0x401F
    ds_swizzle_b32 v94, v94 offset:0x401F
    ds_swizzle_b32 v95, v95 offset:0x401F
    v_fmac_f32 v200, v15, v167
    v_add_f32 v254, v196, v254
    s_waitcnt lgkmcnt(8)
    s_mov_b64 exec, s[56:57]
    v_xor_b32 v68, 0x80008000, v68
    v_xor_b32 v69, 0x80008000, v69
    v_xor_b32 v70, 0x80008000, v70
    v_xor_b32 v71, 0x80008000, v71
    v_xor_b32 v76, 0x80008000, v76
    v_xor_b32 v77, 0x80008000, v77
    v_xor_b32 v78, 0x80008000, v78
    v_xor_b32 v79, 0x80008000, v79
    v_xor_b32 v84, 0x80008000, v84
    v_xor_b32 v85, 0x80008000, v85
    v_xor_b32 v86, 0x80008000, v86
    v_xor_b32 v87, 0x80008000, v87
    s_mov_b64 exec, -1
    s_waitcnt vmcnt(4) lgkmcnt(4)
    v_mfma_f32_32x32x16_bf16 v[0:15], v[64:67], v[176:179], 0
    v_mul_f32 v255, v32, v152
    v_fmac_f32 v255, v33, v153
    v_fmac_f32 v255, v34, v154
    s_add_u32 m0, s21, 0
    v_mfma_f32_32x32x16_bf16 v[16:31], v[68:71], v[176:179], v[16:31]
    v_lshl_add_u32 v234, v234, 10, v246
    v_lshl_add_u32 v235, v235, 10, v246
    buffer_load_dwordx4 v234, s[4:7], s38 offen lds
    buffer_load_dwordx4 v235, s[8:11], s38 offen offset:1024 lds
    ds_read_b64_tr_b16 v[176:177], v244 offset:2048
    ds_read_b64_tr_b16 v[178:179], v244 offset:3072
    ds_read_b64_tr_b16 v[184:185], v245 offset:2048
    ds_read_b64_tr_b16 v[186:187], v245 offset:3072
    v_fmac_f32 v255, v35, v155
    v_fmac_f32 v255, v36, v156
    v_fmac_f32 v255, v37, v157
    s_waitcnt vmcnt(4) lgkmcnt(0)
    v_mfma_f32_32x32x16_bf16 v[0:15], v[72:75], v[176:179], v[0:15]
    v_fmac_f32 v255, v38, v158
    v_fmac_f32 v255, v39, v159
    v_fmac_f32 v201, v40, v168
    s_add_u32 m0, s21, 2048
    v_mfma_f32_32x32x16_bf16 v[16:31], v[76:79], v[176:179], v[16:31]
    v_lshl_add_u32 v236, v236, 10, v246
    v_lshl_add_u32 v237, v237, 10, v246
    buffer_load_dwordx4 v236, s[4:7], s39 offen lds
    buffer_load_dwordx4 v237, s[8:11], s39 offen offset:1024 lds
    ds_read_b64_tr_b16 v[176:177], v244 offset:4096
    ds_read_b64_tr_b16 v[178:179], v244 offset:5120
    ds_read_b64_tr_b16 v[188:189], v245 offset:4096
    ds_read_b64_tr_b16 v[190:191], v245 offset:5120
    v_fmac_f32 v201, v41, v169
    v_permlane32_swap_b32 v197, v255
    s_waitcnt vmcnt(4) lgkmcnt(0)
    v_mfma_f32_32x32x16_bf16 v[0:15], v[80:83], v[176:179], v[0:15]
    v_fmac_f32 v201, v42, v170
    v_fmac_f32 v201, v43, v171
    v_fmac_f32 v201, v44, v172
    s_add_u32 m0, s21, 4096
    v_mfma_f32_32x32x16_bf16 v[16:31], v[84:87], v[176:179], v[16:31]
    v_lshl_add_u32 v238, v238, 10, v246
    v_lshl_add_u32 v239, v239, 10, v246
    buffer_load_dwordx4 v238, s[4:7], s40 offen lds
    buffer_load_dwordx4 v239, s[8:11], s40 offen offset:1024 lds
    ds_read_b64_tr_b16 v[176:177], v244 offset:6144
    ds_read_b64_tr_b16 v[178:179], v244 offset:7168
    ds_read_b64_tr_b16 v[192:193], v245 offset:6144
    ds_read_b64_tr_b16 v[194:195], v245 offset:7168
    v_fmac_f32 v201, v45, v173
    v_fmac_f32 v201, v46, v174
    v_fmac_f32 v201, v47, v175
    s_waitcnt lgkmcnt(0)
    s_mov_b64 exec, s[56:57]
    v_xor_b32 v92, 0x80008000, v92
    v_xor_b32 v93, 0x80008000, v93
    v_xor_b32 v94, 0x80008000, v94
    v_xor_b32 v95, 0x80008000, v95
    s_mov_b64 exec, -1
    v_mfma_f32_32x32x16_bf16 v[0:15], v[88:91], v[176:179], v[0:15]
    v_add_f32 v255, v197, v255
    s_set_gpr_idx_on s51, gpr_idx(DST)
    s_nop 0
    v_cvt_pk_bf16_f32 v206, v254, v255
    s_set_gpr_idx_off
    s_add_u32 m0, s21, 6144
    v_mfma_f32_32x32x16_bf16 v[16:31], v[92:95], v[176:179], v[16:31]
    v_lshl_add_u32 v240, v240, 10, v246
    v_lshl_add_u32 v241, v241, 10, v246
    buffer_load_dwordx4 v240, s[4:7], s41 offen lds
    buffer_load_dwordx4 v241, s[8:11], s41 offen offset:1024 lds
    v_mfma_f32_32x32x16_bf16 v[32:47], v[64:67], v[180:183], 0
    v_mul_f32 v254, v0, v144
    v_fmac_f32 v254, v1, v145
    v_fmac_f32 v254, v2, v146
    v_fmac_f32 v254, v3, v147
    v_fmac_f32 v254, v4, v148
    v_mfma_f32_32x32x16_bf16 v[48:63], v[68:71], v[180:183], v[48:63]
    v_fmac_f32 v254, v5, v149
    v_fmac_f32 v254, v6, v150
    v_fmac_f32 v254, v7, v151
    v_fma_f32 v202, v8, -v160, v202
    v_fma_f32 v202, v9, -v161, v202
    v_mfma_f32_32x32x16_bf16 v[32:47], v[72:75], v[184:187], v[32:47]
    v_permlane32_swap_b32 v254, v200
    v_fma_f32 v202, v10, -v162, v202
    v_fma_f32 v202, v11, -v163, v202
    v_fma_f32 v202, v12, -v164, v202
    v_fma_f32 v202, v13, -v165, v202
    v_mfma_f32_32x32x16_bf16 v[48:63], v[76:79], v[184:187], v[48:63]
    v_fma_f32 v202, v14, -v166, v202
    v_fma_f32 v202, v15, -v167, v202
    v_add_f32 v200, v254, v200
    v_fmac_f32 v198, v16, v112
    v_permlane32_swap_b32 v202, v254
    v_mfma_f32_32x32x16_bf16 v[32:47], v[80:83], v[188:191], v[32:47]
    v_fmac_f32 v198, v17, v113
    v_fmac_f32 v198, v18, v114
    v_fmac_f32 v198, v19, v115
    v_fmac_f32 v198, v20, v116
    v_fmac_f32 v198, v21, v117
    v_mfma_f32_32x32x16_bf16 v[48:63], v[84:87], v[188:191], v[48:63]
    s_waitcnt vmcnt(6)
    ds_read_b64_tr_b16 v[176:177], v244 offset:0
    ds_read_b64_tr_b16 v[178:179], v244 offset:1024
    ds_read_b64_tr_b16 v[180:181], v245 offset:0
    ds_read_b64_tr_b16 v[182:183], v245 offset:1024
    v_fmac_f32 v198, v22, v118
    v_fmac_f32 v198, v23, v119
    v_add_f32 v254, v202, v254
    v_mul_f32 v196, v24, v160
    v_fmac_f32 v196, v25, v161
    v_mfma_f32_32x32x16_bf16 v[32:47], v[88:91], v[192:195], v[32:47]
    v_fmac_f32 v196, v26, v162
    v_fmac_f32 v196, v27, v163
    v_fmac_f32 v196, v28, v164
    v_fmac_f32 v196, v29, v165
    v_fmac_f32 v196, v30, v166
    v_mfma_f32_32x32x16_bf16 v[48:63], v[92:95], v[192:195], v[48:63]
    v_add_u32 v249, s48, v249
    v_add_u32 v250, s49, v250
    ds_read_b32 v252, v251 offset:16
    ds_read_b64_tr_b16 v[64:65], v249 offset:0
    ds_read_b64_tr_b16 v[68:69], v249 offset:64
    ds_read_b64_tr_b16 v[66:67], v249 offset:256
    ds_read_b64_tr_b16 v[70:71], v249 offset:320
    s_mov_b64 exec, s[54:55]
    ds_read_u16_d16_hi v242, v250 offset:0
    s_mov_b64 exec, -1
    v_fmac_f32 v196, v31, v167
    s_nop 1
    v_permlane32_swap_b32 v198, v196
    v_add_f32 v196, v198, v196
    v_mul_f32 v255, v32, v152
    v_fmac_f32 v255, v33, v153
    v_fmac_f32 v255, v34, v154
    v_fmac_f32 v255, v35, v155
    v_fmac_f32 v255, v36, v156
    v_fmac_f32 v255, v37, v157
    v_fmac_f32 v255, v38, v158
    v_fmac_f32 v255, v39, v159
    v_fma_f32 v203, v40, -v168, v203
    v_fma_f32 v203, v41, -v169, v203
    v_permlane32_swap_b32 v255, v201
    v_fma_f32 v203, v42, -v170, v203
    v_fma_f32 v203, v43, -v171, v203
    v_fma_f32 v203, v44, -v172, v203
    v_fma_f32 v203, v45, -v173, v203
    v_fma_f32 v203, v46, -v174, v203
    v_fma_f32 v203, v47, -v175, v203
    v_add_f32 v201, v255, v201
    v_fmac_f32 v199, v48, v120
    v_permlane32_swap_b32 v203, v255
    v_fmac_f32 v199, v49, v121
    v_fmac_f32 v199, v50, v122
    v_fmac_f32 v199, v51, v123
    v_fmac_f32 v199, v52, v124
    v_fmac_f32 v199, v53, v125
    v_fmac_f32 v199, v54, v126
    v_fmac_f32 v199, v55, v127
    v_add_f32 v255, v203, v255
    v_mul_f32 v197, v56, v168
    v_fmac_f32 v197, v57, v169
    v_fmac_f32 v197, v58, v170
    v_fmac_f32 v197, v59, v171
    v_fmac_f32 v197, v60, v172
    v_fmac_f32 v197, v61, v173
    v_fmac_f32 v197, v62, v174
    v_fmac_f32 v197, v63, v175
    s_nop 1
    v_permlane32_swap_b32 v199, v197
    v_add_f32 v197, v199, v197
    s_set_gpr_idx_on s51, gpr_idx(DST)
    s_nop 0
    v_cvt_pk_bf16_f32 v207, v200, v201
    v_cvt_pk_bf16_f32 v209, v254, v255
    v_cvt_pk_bf16_f32 v208, v196, v197
    s_set_gpr_idx_off
    s_add_u32 s50, s50, 1
    s_add_u32 s51, s51, 6
    s_cmp_ge_u32 s50, 4
    s_cbranch_scc1 LAST0
    s_waitcnt lgkmcnt(5)
    v_readfirstlane_b32 s66, v252
    s_add_u32 s53, s53, 1
    v_mov_b32 v252, s53
    s_cmp_le_u32 s53, s66
    ds_write2_b32 v251, v252, v252 offset0:0 offset1:8
    s_setprio 1
    s_cbranch_scc1 PRIO_8
    s_setprio 0
PRIO_8:
    s_cmp_eq_u32 s52, 4
    s_cbranch_scc1 ITEM_0_4
    s_cmp_eq_u32 s52, 5
    s_cbranch_scc1 ITEM_0_5
    s_cmp_eq_u32 s52, 3
    s_cbranch_scc1 ITEM_0_3
    s_cmp_eq_u32 s52, 6
    s_cbranch_scc1 ITEM_0_6
    s_cmp_eq_u32 s52, 8
    s_cbranch_scc1 ITEM_0_8
    s_branch ITEM_0_2
.p2align 6
ITEM_0_2:
    s_mov_b32 m0, s50
    s_nop 0
    s_movrels_b32 s71, s23
    s_bfe_u32 s46, s71, 0x30012
    s_mov_b32 m0, s46
    s_and_b32 s66, s71, 0x3ffff
    s_movrels_b32 s68, s57
    s_movrels_b32 s69, s61
    s_sub_u32 s48, s66, s47
    s_mov_b32 s47, s66
    s_lshr_b32 s52, s71, 28
    s_lshl_b32 s67, s46, 9
    s_add_u32 s66, s66, s67
    s_sub_u32 s49, s66, s42
    s_mov_b32 s42, s66
    s_bfe_u32 s66, s68, 655360
    s_add_u32 s43, s42, s66
    s_bfe_u32 s39, s69, 655360
    s_bfe_u32 s66, s68, 655370
    s_add_u32 s44, s42, s66
    s_bfe_u32 s40, s69, 655370
    s_bfe_u32 s66, s68, 655380
    s_add_u32 s45, s42, s66
    s_bfe_u32 s41, s69, 655380
    s_and_b32 s66, s46, s33
    s_cselect_b32 s72, -1, 1
    s_cselect_b32 s76, s47, 163712
    s_cmp_ge_u32 s66, 2
    s_cselect_b32 s73, -1, 0
    s_add_u32 s77, s47, 1024
    s_cmp_ge_u32 s66, 4
    s_cselect_b32 s75, -1, 0
    s_cmp_ge_u32 s66, 3
    s_cselect_b32 s74, -1, 1
    s_cselect_b32 s77, s77, 163712
    v_add_u32 v252, s42, v247
    ds_read_u16 v234, v252
    ds_read_u16 v235, v252 offset:64
    v_add_u32 v252, s43, v247
    ds_read_u16 v236, v252
    ds_read_u16 v237, v252 offset:64
    v_add_u32 v252, s44, v247
    ds_read_u16 v238, v252
    ds_read_u16 v239, v252 offset:64
    v_add_u32 v252, s45, v247
    ds_read_u16 v240, v252
    ds_read_u16 v241, v252 offset:64
    s_waitcnt lgkmcnt(8)
    v_mul_f32_dpp v196, v242, v64 row_newbcast:0 row_mask:0xf bank_mask:0xf
    v_mul_f32_dpp v197, v242, v65 row_newbcast:1 row_mask:0xf bank_mask:0xf
    v_mul_f32_dpp v198, v242, v64 row_newbcast:8 row_mask:0xf bank_mask:0xf
    v_mul_f32_dpp v199, v242, v65 row_newbcast:9 row_mask:0xf bank_mask:0xf
    v_mul_f32_dpp v200, v242, v68 row_newbcast:2 row_mask:0xf bank_mask:0xf
    v_mul_f32_dpp v201, v242, v69 row_newbcast:3 row_mask:0xf bank_mask:0xf
    v_mul_f32_dpp v202, v242, v68 row_newbcast:10 row_mask:0xf bank_mask:0xf
    v_mul_f32_dpp v203, v242, v69 row_newbcast:11 row_mask:0xf bank_mask:0xf
    v_cvt_pk_bf16_f32 v64, v196, v197
    v_cvt_pk_bf16_f32 v68, v198, v199
    v_cvt_pk_bf16_f32 v65, v200, v201
    v_cvt_pk_bf16_f32 v69, v202, v203
    v_mul_f32_dpp v196, v242, v66 row_newbcast:4 row_mask:0xf bank_mask:0xf
    v_mul_f32_dpp v197, v242, v67 row_newbcast:5 row_mask:0xf bank_mask:0xf
    v_mul_f32_dpp v198, v242, v66 row_newbcast:12 row_mask:0xf bank_mask:0xf
    v_mul_f32_dpp v199, v242, v67 row_newbcast:13 row_mask:0xf bank_mask:0xf
    v_mul_f32_dpp v200, v242, v70 row_newbcast:6 row_mask:0xf bank_mask:0xf
    v_mul_f32_dpp v201, v242, v71 row_newbcast:7 row_mask:0xf bank_mask:0xf
    v_mul_f32_dpp v202, v242, v70 row_newbcast:14 row_mask:0xf bank_mask:0xf
    v_mul_f32_dpp v203, v242, v71 row_newbcast:15 row_mask:0xf bank_mask:0xf
    v_cvt_pk_bf16_f32 v66, v196, v197
    v_cvt_pk_bf16_f32 v70, v198, v199
    v_cvt_pk_bf16_f32 v67, v200, v201
    v_cvt_pk_bf16_f32 v71, v202, v203
    s_nop 0
    s_waitcnt lgkmcnt(6)
    v_mfma_f32_32x32x16_bf16 v[0:15], v[64:67], v[176:179], 0
    s_add_u32 m0, s21, 0
    v_mfma_f32_32x32x16_bf16 v[16:31], v[68:71], v[176:179], 0
    v_lshl_add_u32 v234, v234, 10, v246
    v_lshl_add_u32 v235, v235, 10, v246
    buffer_load_dwordx4 v234, s[4:7], s38 offen lds
    buffer_load_dwordx4 v235, s[8:11], s38 offen offset:1024 lds
    v_mfma_f32_32x32x16_bf16 v[32:47], v[64:67], v[180:183], 0
    s_nop 4
    v_mul_f32 v196, v0, v96
    v_fmac_f32 v196, v1, v97
    v_fmac_f32 v196, v2, v98
    v_fmac_f32 v196, v3, v99
    v_fmac_f32 v196, v4, v100
    v_fmac_f32 v196, v5, v101
    v_fmac_f32 v196, v6, v102
    v_fmac_f32 v196, v7, v103
    v_mul_f32 v198, v8, v128
    v_fmac_f32 v198, v9, v129
    v_fmac_f32 v198, v10, v130
    v_fmac_f32 v198, v11, v131
    v_fmac_f32 v198, v12, v132
    v_fmac_f32 v198, v13, v133
    v_fmac_f32 v198, v14, v134
    v_fmac_f32 v198, v15, v135
    v_mul_f32 v200, v16, v128
    v_fmac_f32 v200, v17, v129
    v_permlane32_swap_b32 v196, v198
    v_mfma_f32_32x32x16_bf16 v[48:63], v[68:71], v[180:183], 0
    v_add_u32 v253, s47, v248
    ds_read_b32 v254, v253
    ds_read_b32 v255, v253 offset:256
    s_waitcnt vmcnt(6)
    ds_read_b64_tr_b16 v[176:177], v244 offset:2048
    ds_read_b64_tr_b16 v[178:179], v244 offset:3072
    ds_read_b64_tr_b16 v[180:181], v245 offset:2048
    ds_read_b64_tr_b16 v[182:183], v245 offset:3072
    v_fmac_f32 v200, v18, v130
    v_fmac_f32 v200, v19, v131
    v_fmac_f32 v200, v20, v132
    v_fmac_f32 v200, v21, v133
    v_fmac_f32 v200, v22, v134
    v_fmac_f32 v200, v23, v135
    v_add_f32 v198, v196, v198
    v_mul_f32_e64 v202, v24, -v128
    v_fma_f32 v202, v25, -v129, v202
    v_fma_f32 v202, v26, -v130, v202
    v_fma_f32 v202, v27, -v131, v202
    v_fma_f32 v202, v28, -v132, v202
    v_fma_f32 v202, v29, -v133, v202
    v_fma_f32 v202, v30, -v134, v202
    v_fma_f32 v202, v31, -v135, v202
    s_nop 1
    v_permlane32_swap_b32 v200, v202
    v_add_f32 v202, v200, v202
    s_waitcnt lgkmcnt(0)
    v_mfma_f32_32x32x16_bf16 v[0:15], v[64:67], v[176:179], 0
    v_mul_f32 v197, v32, v104
    v_fmac_f32 v197, v33, v105
    v_fmac_f32 v197, v34, v106
    v_fmac_f32 v197, v35, v107
    v_fmac_f32 v197, v36, v108
    v_fmac_f32 v197, v37, v109
    v_fmac_f32 v197, v38, v110
    v_fmac_f32 v197, v39, v111
    v_mul_f32 v199, v40, v136
    v_fmac_f32 v199, v41, v137
    v_fmac_f32 v199, v42, v138
    v_fmac_f32 v199, v43, v139
    v_fmac_f32 v199, v44, v140
    v_fmac_f32 v199, v45, v141
    v_fmac_f32 v199, v46, v142
    v_fmac_f32 v199, v47, v143
    v_mul_f32 v201, v48, v136
    v_fmac_f32 v201, v49, v137
    v_permlane32_swap_b32 v197, v199
    v_fmac_f32 v201, v50, v138
    v_fmac_f32 v201, v51, v139
    s_add_u32 m0, s21, 2048
    v_mfma_f32_32x32x16_bf16 v[16:31], v[68:71], v[176:179], 0
    v_lshl_add_u32 v236, v236, 10, v246
    v_lshl_add_u32 v237, v237, 10, v246
    buffer_load_dwordx4 v236, s[4:7], s39 offen lds
    buffer_load_dwordx4 v237, s[8:11], s39 offen offset:1024 lds
    s_mov_b32 m0, s76
    s_mov_b64 exec, s[72:73]
    buffer_load_dwordx4 v254, s[12:15], 0 offen  lds
    s_mov_b32 m0, s77
    s_mov_b64 exec, s[74:75]
    buffer_load_dwordx4 v255, s[12:15], 0 offen  lds
    s_mov_b64 exec, -1
    v_fmac_f32 v201, v52, v140
    v_fmac_f32 v201, v53, v141
    v_fmac_f32 v201, v54, v142
    v_fmac_f32 v201, v55, v143
    v_add_f32 v199, v197, v199
    v_mul_f32_e64 v203, v56, -v136
    v_fma_f32 v203, v57, -v137, v203
    v_fma_f32 v203, v58, -v138, v203
    v_fma_f32 v203, v59, -v139, v203
    v_fma_f32 v203, v60, -v140, v203
    v_fma_f32 v203, v61, -v141, v203
    v_fma_f32 v203, v62, -v142, v203
    v_fma_f32 v203, v63, -v143, v203
    s_nop 1
    v_permlane32_swap_b32 v201, v203
    v_add_f32 v203, v201, v203
    s_set_gpr_idx_on s51, gpr_idx(DST)
    s_nop 0
    v_cvt_pk_bf16_f32 v204, v198, v199
    v_cvt_pk_bf16_f32 v205, v202, v203
    s_set_gpr_idx_off
    v_mfma_f32_32x32x16_bf16 v[32:47], v[64:67], v[180:183], 0
    v_mul_f32 v196, v0, v144
    v_fmac_f32 v196, v1, v145
    v_fmac_f32 v196, v2, v146
    v_fmac_f32 v196, v3, v147
    v_fmac_f32 v196, v4, v148
    v_fmac_f32 v196, v5, v149
    v_fmac_f32 v196, v6, v150
    v_fmac_f32 v196, v7, v151
    v_mul_f32 v198, v8, v112
    v_fmac_f32 v198, v9, v113
    v_fmac_f32 v198, v10, v114
    v_fmac_f32 v198, v11, v115
    v_fmac_f32 v198, v12, v116
    v_fmac_f32 v198, v13, v117
    v_fmac_f32 v198, v14, v118
    v_fmac_f32 v198, v15, v119
    v_mfma_f32_32x32x16_bf16 v[48:63], v[68:71], v[180:183], 0
    s_waitcnt vmcnt(8)
    ds_read_b64_tr_b16 v[176:177], v244 offset:4096
    ds_read_b64_tr_b16 v[178:179], v244 offset:5120
    ds_read_b64_tr_b16 v[180:181], v245 offset:4096
    ds_read_b64_tr_b16 v[182:183], v245 offset:5120
    v_mul_f32_e64 v200, v16, -v160
    v_fma_f32 v200, v17, -v161, v200
    v_fma_f32 v200, v18, -v162, v200
    v_fma_f32 v200, v19, -v163, v200
    v_fma_f32 v200, v20, -v164, v200
    v_fma_f32 v200, v21, -v165, v200
    v_fma_f32 v200, v22, -v166, v200
    v_fma_f32 v200, v23, -v167, v200
    v_mul_f32_e64 v202, v24, -v160
    v_fma_f32 v202, v25, -v161, v202
    v_fma_f32 v202, v26, -v162, v202
    v_fma_f32 v202, v27, -v163, v202
    v_fma_f32 v202, v28, -v164, v202
    v_fma_f32 v202, v29, -v165, v202
    v_fma_f32 v202, v30, -v166, v202
    v_fma_f32 v202, v31, -v167, v202
    s_waitcnt lgkmcnt(0)
    v_mfma_f32_32x32x16_bf16 v[0:15], v[64:67], v[176:179], 0
    v_mul_f32 v197, v32, v152
    v_fmac_f32 v197, v33, v153
    v_fmac_f32 v197, v34, v154
    v_fmac_f32 v197, v35, v155
    v_fmac_f32 v197, v36, v156
    v_fmac_f32 v197, v37, v157
    v_fmac_f32 v197, v38, v158
    v_fmac_f32 v197, v39, v159
    v_mul_f32 v199, v40, v120
    v_fmac_f32 v199, v41, v121
    v_fmac_f32 v199, v42, v122
    v_fmac_f32 v199, v43, v123
    v_fmac_f32 v199, v44, v124
    v_fmac_f32 v199, v45, v125
    v_fmac_f32 v199, v46, v126
    v_fmac_f32 v199, v47, v127
    s_add_u32 m0, s21, 4096
    v_mfma_f32_32x32x16_bf16 v[16:31], v[68:71], v[176:179], 0
    v_lshl_add_u32 v238, v238, 10, v246
    v_lshl_add_u32 v239, v239, 10, v246
    buffer_load_dwordx4 v238, s[4:7], s40 offen lds
    buffer_load_dwordx4 v239, s[8:11], s40 offen offset:1024 lds
    v_mul_f32_e64 v201, v48, -v168
    v_fma_f32 v201, v49, -v169, v201
    v_fma_f32 v201, v50, -v170, v201
    v_fma_f32 v201, v51, -v171, v201
    v_fma_f32 v201, v52, -v172, v201
    v_fma_f32 v201, v53, -v173, v201
    v_fma_f32 v201, v54, -v174, v201
    v_fma_f32 v201, v55, -v175, v201
    v_mul_f32_e64 v203, v56, -v168
    v_fma_f32 v203, v57, -v169, v203
    v_fma_f32 v203, v58, -v170, v203
    v_fma_f32 v203, v59, -v171, v203
    v_fma_f32 v203, v60, -v172, v203
    v_fma_f32 v203, v61, -v173, v203
    v_fma_f32 v203, v62, -v174, v203
    v_fma_f32 v203, v63, -v175, v203
    v_mfma_f32_32x32x16_bf16 v[32:47], v[64:67], v[180:183], 0
    v_mul_f32 v254, v0, v144
    v_fmac_f32 v254, v1, v145
    v_fmac_f32 v254, v2, v146
    v_fmac_f32 v254, v3, v147
    v_fmac_f32 v254, v4, v148
    v_fmac_f32 v254, v5, v149
    v_fmac_f32 v254, v6, v150
    v_fmac_f32 v254, v7, v151
    v_fmac_f32 v200, v8, v160
    v_mfma_f32_32x32x16_bf16 v[48:63], v[68:71], v[180:183], 0
    ds_swizzle_b32 v68, v68 offset:0x401F
    ds_swizzle_b32 v69, v69 offset:0x401F
    ds_swizzle_b32 v70, v70 offset:0x401F
    ds_swizzle_b32 v71, v71 offset:0x401F
    s_waitcnt vmcnt(8)
    ds_read_b64_tr_b16 v[176:177], v244 offset:6144
    ds_read_b64_tr_b16 v[178:179], v244 offset:7168
    ds_read_b64_tr_b16 v[180:181], v245 offset:6144
    ds_read_b64_tr_b16 v[182:183], v245 offset:7168
    v_fmac_f32 v200, v9, v161
    v_permlane32_swap_b32 v196, v254
    v_fmac_f32 v200, v10, v162
    v_fmac_f32 v200, v11, v163
    v_fmac_f32 v200, v12, v164
    v_fmac_f32 v200, v13, v165
    v_fmac_f32 v200, v14, v166
    v_fmac_f32 v200, v15, v167
    v_add_f32 v254, v196, v254
    s_waitcnt lgkmcnt(0)
    s_mov_b64 exec, s[56:57]
    v_xor_b32 v68, 0x80008000, v68
    v_xor_b32 v69, 0x80008000, v69
    v_xor_b32 v70, 0x80008000, v70
    v_xor_b32 v71, 0x80008000, v71
    s_mov_b64 exec, -1
    s_nop 0
    v_mfma_f32_32x32x16_bf16 v[0:15], v[64:67], v[176:179], 0
    v_mul_f32 v255, v32, v152
    v_fmac_f32 v255, v33, v153
    v_fmac_f32 v255, v34, v154
    v_fmac_f32 v255, v35, v155
    v_fmac_f32 v255, v36, v156
    v_fmac_f32 v255, v37, v157
    v_fmac_f32 v255, v38, v158
    v_fmac_f32 v255, v39, v159
    v_fmac_f32 v201, v40, v168
    v_fmac_f32 v201, v41, v169
    v_permlane32_swap_b32 v197, v255
    s_add_u32 m0, s21, 6144
    v_mfma_f32_32x32x16_bf16 v[16:31], v[68:71], v[176:179], v[16:31]
    v_lshl_add_u32 v240, v240, 10, v246
    v_lshl_add_u32 v241, v241, 10, v246
    buffer_load_dwordx4 v240, s[4:7], s41 offen lds
    buffer_load_dwordx4 v241, s[8:11], s41 offen offset:1024 lds
    v_fmac_f32 v201, v42, v170
    v_fmac_f32 v201, v43, v171
    v_fmac_f32 v201, v44, v172
    v_fmac_f32 v201, v45, v173
    v_fmac_f32 v201, v46, v174
    v_fmac_f32 v201, v47, v175
    v_add_f32 v255, v197, v255
    s_set_gpr_idx_on s51, gpr_idx(DST)
    s_nop 0
    v_cvt_pk_bf16_f32 v206, v254, v255
    s_set_gpr_idx_off
    v_mfma_f32_32x32x16_bf16 v[32:47], v[64:67], v[180:183], 0
    v_mul_f32 v254, v0, v144
    v_fmac_f32 v254, v1, v145
    v_fmac_f32 v254, v2, v146
    v_fmac_f32 v254, v3, v147
    v_fmac_f32 v254, v4, v148
    v_fmac_f32 v254, v5, v149
    v_fmac_f32 v254, v6, v150
    v_fmac_f32 v254, v7, v151
    v_fma_f32 v202, v8, -v160, v202
    v_fma_f32 v202, v9, -v161, v202
    v_permlane32_swap_b32 v254, v200
    v_fma_f32 v202, v10, -v162, v202
    v_fma_f32 v202, v11, -v163, v202
    v_fma_f32 v202, v12, -v164, v202
    v_fma_f32 v202, v13, -v165, v202
    v_fma_f32 v202, v14, -v166, v202
    v_fma_f32 v202, v15, -v167, v202
    v_add_f32 v200, v254, v200
    v_fmac_f32 v198, v16, v112
    v_permlane32_swap_b32 v202, v254
    v_mfma_f32_32x32x16_bf16 v[48:63], v[68:71], v[180:183], v[48:63]
    s_waitcnt vmcnt(4)
    ds_read_b64_tr_b16 v[176:177], v244 offset:0
    ds_read_b64_tr_b16 v[178:179], v244 offset:1024
    ds_read_b64_tr_b16 v[180:181], v245 offset:0
    ds_read_b64_tr_b16 v[182:183], v245 offset:1024
    v_add_u32 v249, s48, v249
    v_add_u32 v250, s49, v250
    ds_read_b32 v252, v251 offset:16
    ds_read_b64_tr_b16 v[64:65], v249 offset:0
    ds_read_b64_tr_b16 v[68:69], v249 offset:64
    ds_read_b64_tr_b16 v[66:67], v249 offset:256
    ds_read_b64_tr_b16 v[70:71], v249 offset:320
    s_mov_b64 exec, s[54:55]
    ds_read_u16_d16_hi v242, v250 offset:0
    s_mov_b64 exec, -1
    v_fmac_f32 v198, v17, v113
    v_fmac_f32 v198, v18, v114
    v_fmac_f32 v198, v19, v115
    v_fmac_f32 v198, v20, v116
    v_fmac_f32 v198, v21, v117
    v_fmac_f32 v198, v22, v118
    v_fmac_f32 v198, v23, v119
    v_add_f32 v254, v202, v254
    v_mul_f32 v196, v24, v160
    v_fmac_f32 v196, v25, v161
    v_fmac_f32 v196, v26, v162
    v_fmac_f32 v196, v27, v163
    v_fmac_f32 v196, v28, v164
    v_fmac_f32 v196, v29, v165
    v_fmac_f32 v196, v30, v166
    v_fmac_f32 v196, v31, v167
    s_nop 1
    v_permlane32_swap_b32 v198, v196
    v_add_f32 v196, v198, v196
    v_mul_f32 v255, v32, v152
    v_fmac_f32 v255, v33, v153
    v_fmac_f32 v255, v34, v154
    v_fmac_f32 v255, v35, v155
    v_fmac_f32 v255, v36, v156
    v_fmac_f32 v255, v37, v157
    v_fmac_f32 v255, v38, v158
    v_fmac_f32 v255, v39, v159
    v_fma_f32 v203, v40, -v168, v203
    v_fma_f32 v203, v41, -v169, v203
    v_permlane32_swap_b32 v255, v201
    v_fma_f32 v203, v42, -v170, v203
    v_fma_f32 v203, v43, -v171, v203
    v_fma_f32 v203, v44, -v172, v203
    v_fma_f32 v203, v45, -v173, v203
    v_fma_f32 v203, v46, -v174, v203
    v_fma_f32 v203, v47, -v175, v203
    v_add_f32 v201, v255, v201
    v_fmac_f32 v199, v48, v120
    v_permlane32_swap_b32 v203, v255
    v_fmac_f32 v199, v49, v121
    v_fmac_f32 v199, v50, v122
    v_fmac_f32 v199, v51, v123
    v_fmac_f32 v199, v52, v124
    v_fmac_f32 v199, v53, v125
    v_fmac_f32 v199, v54, v126
    v_fmac_f32 v199, v55, v127
    v_add_f32 v255, v203, v255
    v_mul_f32 v197, v56, v168
    v_fmac_f32 v197, v57, v169
    v_fmac_f32 v197, v58, v170
    v_fmac_f32 v197, v59, v171
    v_fmac_f32 v197, v60, v172
    v_fmac_f32 v197, v61, v173
    v_fmac_f32 v197, v62, v174
    v_fmac_f32 v197, v63, v175
    s_nop 1
    v_permlane32_swap_b32 v199, v197
    v_add_f32 v197, v199, v197
    s_set_gpr_idx_on s51, gpr_idx(DST)
    s_nop 0
    v_cvt_pk_bf16_f32 v207, v200, v201
    v_cvt_pk_bf16_f32 v209, v254, v255
    v_cvt_pk_bf16_f32 v208, v196, v197
    s_set_gpr_idx_off
    s_add_u32 s50, s50, 1
    s_add_u32 s51, s51, 6
    s_cmp_ge_u32 s50, 4
    s_cbranch_scc1 LAST0
    s_waitcnt lgkmcnt(5)
    v_readfirstlane_b32 s66, v252
    s_add_u32 s53, s53, 1
    v_mov_b32 v252, s53
    s_cmp_le_u32 s53, s66
    ds_write2_b32 v251, v252, v252 offset0:0 offset1:8
    s_setprio 1
    s_cbranch_scc1 PRIO_9
    s_setprio 0
PRIO_9:
    s_cmp_eq_u32 s52, 4
    s_cbranch_scc1 ITEM_0_4
    s_cmp_eq_u32 s52, 5
    s_cbranch_scc1 ITEM_0_5
    s_cmp_eq_u32 s52, 3
    s_cbranch_scc1 ITEM_0_3
    s_cmp_eq_u32 s52, 6
    s_cbranch_scc1 ITEM_0_6
    s_cmp_eq_u32 s52, 8
    s_cbranch_scc1 ITEM_0_8
    s_branch ITEM_0_2
.p2align 6
ITEM_1_4:
    s_mov_b64 exec, s[54:55]
    ds_read_u16_d16_hi v243, v250 offset:128
    s_mov_b64 exec, -1
    ds_read_b64_tr_b16 v[72:73], v249 offset:512
    ds_read_b64_tr_b16 v[76:77], v249 offset:576
    ds_read_b64_tr_b16 v[74:75], v249 offset:768
    ds_read_b64_tr_b16 v[78:79], v249 offset:832
    s_waitcnt lgkmcnt(5)
    v_mul_f32_dpp v196, v242, v64 row_newbcast:0 row_mask:0xf bank_mask:0xf
    v_mul_f32_dpp v197, v242, v65 row_newbcast:1 row_mask:0xf bank_mask:0xf
    v_mul_f32_dpp v198, v242, v64 row_newbcast:8 row_mask:0xf bank_mask:0xf
    v_mul_f32_dpp v199, v242, v65 row_newbcast:9 row_mask:0xf bank_mask:0xf
    v_mul_f32_dpp v200, v242, v68 row_newbcast:2 row_mask:0xf bank_mask:0xf
    v_mul_f32_dpp v201, v242, v69 row_newbcast:3 row_mask:0xf bank_mask:0xf
    v_mul_f32_dpp v202, v242, v68 row_newbcast:10 row_mask:0xf bank_mask:0xf
    v_mul_f32_dpp v203, v242, v69 row_newbcast:11 row_mask:0xf bank_mask:0xf
    v_cvt_pk_bf16_f32 v64, v196, v197
    v_cvt_pk_bf16_f32 v68, v198, v199
    v_cvt_pk_bf16_f32 v65, v200, v201
    v_cvt_pk_bf16_f32 v69, v202, v203
    v_mul_f32_dpp v196, v242, v66 row_newbcast:4 row_mask:0xf bank_mask:0xf
    v_mul_f32_dpp v197, v242, v67 row_newbcast:5 row_mask:0xf bank_mask:0xf
    v_mul_f32_dpp v198, v242, v66 row_newbcast:12 row_mask:0xf bank_mask:0xf
    v_mul_f32_dpp v199, v242, v67 row_newbcast:13 row_mask:0xf bank_mask:0xf
    v_mul_f32_dpp v200, v242, v70 row_newbcast:6 row_mask:0xf bank_mask:0xf
    v_mul_f32_dpp v201, v242, v71 row_newbcast:7 row_mask:0xf bank_mask:0xf
    v_mul_f32_dpp v202, v242, v70 row_newbcast:14 row_mask:0xf bank_mask:0xf
    v_mul_f32_dpp v203, v242, v71 row_newbcast:15 row_mask:0xf bank_mask:0xf
    v_cvt_pk_bf16_f32 v66, v196, v197
    v_cvt_pk_bf16_f32 v70, v198, v199
    v_cvt_pk_bf16_f32 v67, v200, v201
    v_cvt_pk_bf16_f32 v71, v202, v203
    s_nop 0
    s_waitcnt vmcnt(4) lgkmcnt(0)
    v_mfma_f32_32x32x16_bf16 v[0:15], v[64:67], v[176:179], 0
    v_mul_f32_dpp v196, v243, v72 row_newbcast:0 row_mask:0xf bank_mask:0xf
    v_mul_f32_dpp v197, v243, v73 row_newbcast:1 row_mask:0xf bank_mask:0xf
    v_mul_f32_dpp v198, v243, v72 row_newbcast:8 row_mask:0xf bank_mask:0xf
    v_mul_f32_dpp v199, v243, v73 row_newbcast:9 row_mask:0xf bank_mask:0xf
    v_mul_f32_dpp v200, v243, v76 row_newbcast:2 row_mask:0xf bank_mask:0xf
    v_mul_f32_dpp v201, v243, v77 row_newbcast:3 row_mask:0xf bank_mask:0xf
    v_mul_f32_dpp v202, v243, v76 row_newbcast:10 row_mask:0xf bank_mask:0xf
    v_mul_f32_dpp v203, v243, v77 row_newbcast:11 row_mask:0xf bank_mask:0xf
    v_cvt_pk_bf16_f32 v72, v196, v197
    v_cvt_pk_bf16_f32 v76, v198, v199
    v_cvt_pk_bf16_f32 v73, v200, v201
    v_cvt_pk_bf16_f32 v77, v202, v203
    s_add_u32 m0, s21, 0
    v_mfma_f32_32x32x16_bf16 v[16:31], v[68:71], v[176:179], 0
    buffer_load_dwordx4 v234, s[4:7], s36 offen lds
    buffer_load_dwordx4 v235, s[8:11], s36 offen offset:1024 lds
    ds_read_b64_tr_b16 v[176:177], v244 offset:2048
    ds_read_b64_tr_b16 v[178:179], v244 offset:3072
    ds_read_b64_tr_b16 v[184:185], v245 offset:2048
    ds_read_b64_tr_b16 v[186:187], v245 offset:3072
    v_mul_f32_dpp v196, v243, v74 row_newbcast:4 row_mask:0xf bank_mask:0xf
    v_mul_f32_dpp v197, v243, v75 row_newbcast:5 row_mask:0xf bank_mask:0xf
    v_mul_f32_dpp v198, v243, v74 row_newbcast:12 row_mask:0xf bank_mask:0xf
    v_mul_f32_dpp v199, v243, v75 row_newbcast:13 row_mask:0xf bank_mask:0xf
    v_mul_f32_dpp v200, v243, v78 row_newbcast:6 row_mask:0xf bank_mask:0xf
    v_mul_f32_dpp v201, v243, v79 row_newbcast:7 row_mask:0xf bank_mask:0xf
    v_mul_f32_dpp v202, v243, v78 row_newbcast:14 row_mask:0xf bank_mask:0xf
    v_mul_f32_dpp v203, v243, v79 row_newbcast:15 row_mask:0xf bank_mask:0xf
    v_cvt_pk_bf16_f32 v74, v196, v197
    v_cvt_pk_bf16_f32 v78, v198, v199
    v_cvt_pk_bf16_f32 v75, v200, v201
    v_cvt_pk_bf16_f32 v79, v202, v203
    s_nop 0
    s_waitcnt lgkmcnt(0)
    v_mfma_f32_32x32x16_bf16 v[0:15], v[72:75], v[176:179], v[0:15]
    s_add_u32 m0, s21, 2048
    v_mfma_f32_32x32x16_bf16 v[16:31], v[76:79], v[176:179], v[16:31]
    buffer_load_dwordx4 v236, s[4:7], s36 offen lds
    buffer_load_dwordx4 v237, s[8:11], s36 offen offset:1024 lds
    s_mov_b32 m0, s50
    s_nop 0
    s_movrels_b32 s71, s23
    s_movrels_b32 s33, s28
    s_and_b32 s70, s33, 0x70
    s_andn2_b32 s33, s33, 0x70
    v_xor_b32 v253, s70, v248
    v_add_u32 v253, s33, v253
    s_bfe_u32 s46, s71, 0x30012
    s_mov_b32 m0, s46
    s_and_b32 s66, s71, 0x3ffff
    s_movrels_b32 s68, s57
    s_movrels_b32 s69, s61
    s_sub_u32 s48, s66, s47
    s_mov_b32 s47, s66
    s_lshr_b32 s52, s71, 28
    s_lshl_b32 s67, s46, 9
    s_add_u32 s66, s66, s67
    s_sub_u32 s49, s66, s42
    s_mov_b32 s42, s66
    s_bfe_u32 s66, s68, 655360
    s_add_u32 s43, s42, s66
    s_bfe_u32 s39, s69, 655360
    s_bfe_u32 s66, s68, 655370
    s_add_u32 s44, s42, s66
    s_bfe_u32 s40, s69, 655370
    s_bfe_u32 s66, s68, 655380
    s_add_u32 s45, s42, s66
    s_bfe_u32 s41, s69, 655380
    v_add_u32 v252, s44, v247
    ds_read_u16 v238, v252
    ds_read_u16 v239, v252 offset:64
    v_add_u32 v252, s45, v247
    ds_read_u16 v240, v252
    ds_read_u16 v241, v252 offset:64
    v_mfma_f32_32x32x16_bf16 v[32:47], v[64:67], v[180:183], 0
    v_mul_f32 v196, v0, v96
    v_fmac_f32 v196, v1, v97
    v_fmac_f32 v196, v2, v98
    v_fmac_f32 v196, v3, v99
    v_fmac_f32 v196, v4, v100
    v_fmac_f32 v196, v5, v101
    v_fmac_f32 v196, v6, v102
    v_fmac_f32 v196, v7, v103
    v_mul_f32 v198, v8, v128
    v_fmac_f32 v198, v9, v129
    v_mfma_f32_32x32x16_bf16 v[48:63], v[68:71], v[180:183], 0
    s_waitcnt vmcnt(6)
    ds_read_b64_tr_b16 v[176:177], v244 offset:4096
    ds_read_b64_tr_b16 v[178:179], v244 offset:5120
    ds_read_b64_tr_b16 v[180:181], v245 offset:4096
    ds_read_b64_tr_b16 v[182:183], v245 offset:5120
    v_fmac_f32 v198, v10, v130
    v_fmac_f32 v198, v11, v131
    v_fmac_f32 v198, v12, v132
    v_fmac_f32 v198, v13, v133
    v_fmac_f32 v198, v14, v134
    v_fmac_f32 v198, v15, v135
    v_mul_f32 v200, v16, v128
    v_fmac_f32 v200, v17, v129
    v_permlane32_swap_b32 v196, v198
    v_mfma_f32_32x32x16_bf16 v[32:47], v[72:75], v[184:187], v[32:47]
    v_fmac_f32 v200, v18, v130
    v_fmac_f32 v200, v19, v131
    v_fmac_f32 v200, v20, v132
    v_fmac_f32 v200, v21, v133
    v_fmac_f32 v200, v22, v134
    v_fmac_f32 v200, v23, v135
    v_add_f32 v198, v196, v198
    v_mul_f32_e64 v202, v24, -v128
    v_fma_f32 v202, v25, -v129, v202
    v_mfma_f32_32x32x16_bf16 v[48:63], v[76:79], v[184:187], v[48:63]
    v_fma_f32 v202, v26, -v130, v202
    v_fma_f32 v202, v27, -v131, v202
    v_fma_f32 v202, v28, -v132, v202
    v_fma_f32 v202, v29, -v133, v202
    v_fma_f32 v202, v30, -v134, v202
    v_fma_f32 v202, v31, -v135, v202
    s_nop 1
    v_permlane32_swap_b32 v200, v202
    v_add_f32 v202, v200, v202
    s_waitcnt vmcnt(4) lgkmcnt(0)
    v_mfma_f32_32x32x16_bf16 v[0:15], v[64:67], v[176:179], 0
    v_mul_f32 v197, v32, v104
    v_fmac_f32 v197, v33, v105
    v_fmac_f32 v197, v34, v106
    v_fmac_f32 v197, v35, v107
    v_fmac_f32 v197, v36, v108
    v_fmac_f32 v197, v37, v109
    v_fmac_f32 v197, v38, v110
    v_fmac_f32 v197, v39, v111
    v_mul_f32 v199, v40, v136
    v_fmac_f32 v199, v41, v137
    v_fmac_f32 v199, v42, v138
    s_add_u32 m0, s21, 4096
    v_mfma_f32_32x32x16_bf16 v[16:31], v[68:71], v[176:179], 0
    buffer_load_dwordx4 v234, s[4:7], s37 offen lds
    buffer_load_dwordx4 v235, s[8:11], s37 offen offset:1024 lds
    ds_read_b64_tr_b16 v[176:177], v244 offset:6144
    ds_read_b64_tr_b16 v[178:179], v244 offset:7168
    ds_read_b64_tr_b16 v[184:185], v245 offset:6144
    ds_read_b64_tr_b16 v[186:187], v245 offset:7168
    v_add_u32 v252, s42, v247
    ds_read_u16 v234, v252
    ds_read_u16 v235, v252 offset:64
    v_fmac_f32 v199, v43, v139
    v_fmac_f32 v199, v44, v140
    v_fmac_f32 v199, v45, v141
    v_fmac_f32 v199, v46, v142
    v_fmac_f32 v199, v47, v143
    v_mul_f32 v201, v48, v136
    v_fmac_f32 v201, v49, v137
    v_permlane32_swap_b32 v197, v199
    v_fmac_f32 v201, v50, v138
    v_fmac_f32 v201, v51, v139
    s_waitcnt lgkmcnt(2)
    v_mfma_f32_32x32x16_bf16 v[0:15], v[72:75], v[176:179], v[0:15]
    v_fmac_f32 v201, v52, v140
    v_fmac_f32 v201, v53, v141
    v_fmac_f32 v201, v54, v142
    v_fmac_f32 v201, v55, v143
    v_add_f32 v199, v197, v199
    v_mul_f32_e64 v203, v56, -v136
    v_fma_f32 v203, v57, -v137, v203
    v_fma_f32 v203, v58, -v138, v203
    v_fma_f32 v203, v59, -v139, v203
    v_fma_f32 v203, v60, -v140, v203
    s_add_u32 m0, s21, 6144
    v_mfma_f32_32x32x16_bf16 v[16:31], v[76:79], v[176:179], v[16:31]
    buffer_load_dwordx4 v236, s[4:7], s37 offen lds
    buffer_load_dwordx4 v237, s[8:11], s37 offen offset:1024 lds
    v_add_u32 v252, s43, v247
    ds_read_u16 v236, v252
    ds_read_u16 v237, v252 offset:64
    v_fma_f32 v203, v61, -v141, v203
    v_fma_f32 v203, v62, -v142, v203
    v_fma_f32 v203, v63, -v143, v203
    s_nop 1
    v_permlane32_swap_b32 v201, v203
    v_add_f32 v203, v201, v203
    v_cvt_pk_bf16_f32 v198, v198, v199
    v_cvt_pk_bf16_f32 v202, v202, v203
    ds_write_b32 v253, v198 offset:0
    ds_write_b32 v253, v202 offset:256
    v_mfma_f32_32x32x16_bf16 v[32:47], v[64:67], v[180:183], 0
    v_mul_f32 v196, v0, v144
    v_fmac_f32 v196, v1, v145
    v_fmac_f32 v196, v2, v146
    v_fmac_f32 v196, v3, v147
    v_fmac_f32 v196, v4, v148
    v_fmac_f32 v196, v5, v149
    v_fmac_f32 v196, v6, v150
    v_fmac_f32 v196, v7, v151
    v_mfma_f32_32x32x16_bf16 v[48:63], v[68:71], v[180:183], 0
    s_waitcnt vmcnt(6)
    ds_read_b64_tr_b16 v[176:177], v244 offset:0
    ds_read_b64_tr_b16 v[178:179], v244 offset:1024
    ds_read_b64_tr_b16 v[180:181], v245 offset:0
    ds_read_b64_tr_b16 v[182:183], v245 offset:1024
    v_mul_f32 v198, v8, v112
    v_fmac_f32 v198, v9, v113
    v_fmac_f32 v198, v10, v114
    v_fmac_f32 v198, v11, v115
    v_fmac_f32 v198, v12, v116
    v_fmac_f32 v198, v13, v117
    v_fmac_f32 v198, v14, v118
    v_fmac_f32 v198, v15, v119
    v_mfma_f32_32x32x16_bf16 v[32:47], v[72:75], v[184:187], v[32:47]
    v_mul_f32_e64 v200, v16, -v160
    v_fma_f32 v200, v17, -v161, v200
    v_fma_f32 v200, v18, -v162, v200
    v_fma_f32 v200, v19, -v163, v200
    v_fma_f32 v200, v20, -v164, v200
    v_fma_f32 v200, v21, -v165, v200
    v_fma_f32 v200, v22, -v166, v200
    v_fma_f32 v200, v23, -v167, v200
    v_mfma_f32_32x32x16_bf16 v[48:63], v[76:79], v[184:187], v[48:63]
    v_mul_f32_e64 v202, v24, -v160
    v_fma_f32 v202, v25, -v161, v202
    v_fma_f32 v202, v26, -v162, v202
    v_fma_f32 v202, v27, -v163, v202
    v_fma_f32 v202, v28, -v164, v202
    v_fma_f32 v202, v29, -v165, v202
    v_fma_f32 v202, v30, -v166, v202
    v_fma_f32 v202, v31, -v167, v202
    s_waitcnt vmcnt(4) lgkmcnt(0)
    v_mfma_f32_32x32x16_bf16 v[0:15], v[64:67], v[176:179], 0
    v_mul_f32 v197, v32, v152
    v_fmac_f32 v197, v33, v153
    v_fmac_f32 v197, v34, v154
    v_fmac_f32 v197, v35, v155
    v_fmac_f32 v197, v36, v156
    v_fmac_f32 v197, v37, v157
    v_fmac_f32 v197, v38, v158
    v_fmac_f32 v197, v39, v159
    s_add_u32 m0, s21, 0
    v_mfma_f32_32x32x16_bf16 v[16:31], v[68:71], v[176:179], 0
    v_lshl_add_u32 v234, v234, 10, v246
    v_lshl_add_u32 v235, v235, 10, v246
    buffer_load_dwordx4 v234, s[4:7], s38 offen lds
    buffer_load_dwordx4 v235, s[8:11], s38 offen offset:1024 lds
    ds_read_b64_tr_b16 v[176:177], v244 offset:2048
    ds_read_b64_tr_b16 v[178:179], v244 offset:3072
    ds_read_b64_tr_b16 v[184:185], v245 offset:2048
    ds_read_b64_tr_b16 v[186:187], v245 offset:3072
    v_mul_f32 v199, v40, v120
    v_fmac_f32 v199, v41, v121
    v_fmac_f32 v199, v42, v122
    v_fmac_f32 v199, v43, v123
    v_fmac_f32 v199, v44, v124
    v_fmac_f32 v199, v45, v125
    v_fmac_f32 v199, v46, v126
    v_fmac_f32 v199, v47, v127
    s_waitcnt lgkmcnt(0)
    v_mfma_f32_32x32x16_bf16 v[0:15], v[72:75], v[176:179], v[0:15]
    v_mul_f32_e64 v201, v48, -v168
    v_fma_f32 v201, v49, -v169, v201
    v_fma_f32 v201, v50, -v170, v201
    v_fma_f32 v201, v51, -v171, v201
    v_fma_f32 v201, v52, -v172, v201
    v_fma_f32 v201, v53, -v173, v201
    v_fma_f32 v201, v54, -v174, v201
    v_fma_f32 v201, v55, -v175, v201
    s_add_u32 m0, s21, 2048
    v_mfma_f32_32x32x16_bf16 v[16:31], v[76:79], v[176:179], v[16:31]
    v_lshl_add_u32 v236, v236, 10, v246
    v_lshl_add_u32 v237, v237, 10, v246
    buffer_load_dwordx4 v236, s[4:7], s39 offen lds
    buffer_load_dwordx4 v237, s[8:11], s39 offen offset:1024 lds
    v_mul_f32_e64 v203, v56, -v168
    v_fma_f32 v203, v57, -v169, v203
    v_fma_f32 v203, v58, -v170, v203
    v_fma_f32 v203, v59, -v171, v203
    v_fma_f32 v203, v60, -v172, v203
    v_fma_f32 v203, v61, -v173, v203
    v_fma_f32 v203, v62, -v174, v203
    v_fma_f32 v203, v63, -v175, v203
    v_mfma_f32_32x32x16_bf16 v[32:47], v[64:67], v[180:183], 0
    v_mul_f32 v254, v0, v144
    v_fmac_f32 v254, v1, v145
    v_fmac_f32 v254, v2, v146
    v_fmac_f32 v254, v3, v147
    v_fmac_f32 v254, v4, v148
    v_mfma_f32_32x32x16_bf16 v[48:63], v[68:71], v[180:183], 0
    ds_swizzle_b32 v68, v68 offset:0x401F
    ds_swizzle_b32 v69, v69 offset:0x401F
    ds_swizzle_b32 v70, v70 offset:0x401F
    ds_swizzle_b32 v71, v71 offset:0x401F
    s_waitcnt vmcnt(6)
    ds_read_b64_tr_b16 v[176:177], v244 offset:4096
    ds_read_b64_tr_b16 v[178:179], v244 offset:5120
    ds_read_b64_tr_b16 v[180:181], v245 offset:4096
    ds_read_b64_tr_b16 v[182:183], v245 offset:5120
    v_fmac_f32 v254, v5, v149
    v_fmac_f32 v254, v6, v150
    v_fmac_f32 v254, v7, v151
    v_fmac_f32 v200, v8, v160
    v_mfma_f32_32x32x16_bf16 v[32:47], v[72:75], v[184:187], v[32:47]
    v_fmac_f32 v200, v9, v161
    v_permlane32_swap_b32 v196, v254
    v_fmac_f32 v200, v10, v162
    v_fmac_f32 v200, v11, v163
    v_fmac_f32 v200, v12, v164
    v_mfma_f32_32x32x16_bf16 v[48:63], v[76:79], v[184:187], v[48:63]
    ds_swizzle_b32 v76, v76 offset:0x401F
    ds_swizzle_b32 v77, v77 offset:0x401F
    ds_swizzle_b32 v78, v78 offset:0x401F
    ds_swizzle_b32 v79, v79 offset:0x401F
    v_fmac_f32 v200, v13, v165
    v_fmac_f32 v200, v14, v166
    v_fmac_f32 v200, v15, v167
    v_add_f32 v254, v196, v254
    s_waitcnt lgkmcnt(8)
    s_mov_b64 exec, s[56:57]
    v_xor_b32 v68, 0x80008000, v68
    v_xor_b32 v69, 0x80008000, v69
    v_xor_b32 v70, 0x80008000, v70
    v_xor_b32 v71, 0x80008000, v71
    s_mov_b64 exec, -1
    s_waitcnt vmcnt(4) lgkmcnt(4)
    v_mfma_f32_32x32x16_bf16 v[0:15], v[64:67], v[176:179], 0
    v_mul_f32 v255, v32, v152
    v_fmac_f32 v255, v33, v153
    v_fmac_f32 v255, v34, v154
    v_fmac_f32 v255, v35, v155
    v_fmac_f32 v255, v36, v156
    s_add_u32 m0, s21, 4096
    v_mfma_f32_32x32x16_bf16 v[16:31], v[68:71], v[176:179], v[16:31]
    v_lshl_add_u32 v238, v238, 10, v246
    v_lshl_add_u32 v239, v239, 10, v246
    buffer_load_dwordx4 v238, s[4:7], s40 offen lds
    buffer_load_dwordx4 v239, s[8:11], s40 offen offset:1024 lds
    ds_read_b64_tr_b16 v[176:177], v244 offset:6144
    ds_read_b64_tr_b16 v[178:179], v244 offset:7168
    ds_read_b64_tr_b16 v[184:185], v245 offset:6144
    ds_read_b64_tr_b16 v[186:187], v245 offset:7168
    v_fmac_f32 v255, v37, v157
    v_fmac_f32 v255, v38, v158
    v_fmac_f32 v255, v39, v159
    v_fmac_f32 v201, v40, v168
    v_fmac_f32 v201, v41, v169
    s_waitcnt lgkmcnt(0)
    s_mov_b64 exec, s[56:57]
    v_xor_b32 v76, 0x80008000, v76
    v_xor_b32 v77, 0x80008000, v77
    v_xor_b32 v78, 0x80008000, v78
    v_xor_b32 v79, 0x80008000, v79
    s_mov_b64 exec, -1
    v_mfma_f32_32x32x16_bf16 v[0:15], v[72:75], v[176:179], v[0:15]
    v_permlane32_swap_b32 v197, v255
    v_fmac_f32 v201, v42, v170
    v_fmac_f32 v201, v43, v171
    v_fmac_f32 v201, v44, v172
    v_fmac_f32 v201, v45, v173
    s_add_u32 m0, s21, 6144
    v_mfma_f32_32x32x16_bf16 v[16:31], v[76:79], v[176:179], v[16:31]
    v_lshl_add_u32 v240, v240, 10, v246
    v_lshl_add_u32 v241, v241, 10, v246
    buffer_load_dwordx4 v240, s[4:7], s41 offen lds
    buffer_load_dwordx4 v241, s[8:11], s41 offen offset:1024 lds
    v_fmac_f32 v201, v46, v174
    v_fmac_f32 v201, v47, v175
    v_add_f32 v255, v197, v255
    v_cvt_pk_bf16_f32 v254, v254, v255
    ds_write_b32 v253, v254 offset:512
    v_mfma_f32_32x32x16_bf16 v[32:47], v[64:67], v[180:183], 0
    v_mul_f32 v254, v0, v144
    v_fmac_f32 v254, v1, v145
    v_fmac_f32 v254, v2, v146
    v_fmac_f32 v254, v3, v147
    v_fmac_f32 v254, v4, v148
    v_fmac_f32 v254, v5, v149
    v_fmac_f32 v254, v6, v150
    v_fmac_f32 v254, v7, v151
    v_fma_f32 v202, v8, -v160, v202
    v_fma_f32 v202, v9, -v161, v202
    v_mfma_f32_32x32x16_bf16 v[48:63], v[68:71], v[180:183], v[48:63]
    s_waitcnt vmcnt(6)
    ds_read_b64_tr_b16 v[176:177], v244 offset:0
    ds_read_b64_tr_b16 v[178:179], v244 offset:1024
    ds_read_b64_tr_b16 v[180:181], v245 offset:0
    ds_read_b64_tr_b16 v[182:183], v245 offset:1024
    v_permlane32_swap_b32 v254, v200
    v_fma_f32 v202, v10, -v162, v202
    v_fma_f32 v202, v11, -v163, v202
    v_fma_f32 v202, v12, -v164, v202
    v_fma_f32 v202, v13, -v165, v202
    v_fma_f32 v202, v14, -v166, v202
    v_fma_f32 v202, v15, -v167, v202
    v_add_f32 v200, v254, v200
    v_fmac_f32 v198, v16, v112
    v_permlane32_swap_b32 v202, v254
    v_mfma_f32_32x32x16_bf16 v[32:47], v[72:75], v[184:187], v[32:47]
    v_fmac_f32 v198, v17, v113
    v_fmac_f32 v198, v18, v114
    v_fmac_f32 v198, v19, v115
    v_fmac_f32 v198, v20, v116
    v_fmac_f32 v198, v21, v117
    v_fmac_f32 v198, v22, v118
    v_fmac_f32 v198, v23, v119
    v_add_f32 v254, v202, v254
    v_mul_f32 v196, v24, v160
    v_fmac_f32 v196, v25, v161
    v_mfma_f32_32x32x16_bf16 v[48:63], v[76:79], v[184:187], v[48:63]
    v_add_u32 v249, s48, v249
    v_add_u32 v250, s49, v250
    ds_read_b32 v252, v251 offset:16
    ds_read_b64_tr_b16 v[64:65], v249 offset:0
    ds_read_b64_tr_b16 v[68:69], v249 offset:64
    ds_read_b64_tr_b16 v[66:67], v249 offset:256
    ds_read_b64_tr_b16 v[70:71], v249 offset:320
    s_mov_b64 exec, s[54:55]
    ds_read_u16_d16_hi v242, v250 offset:0
    s_mov_b64 exec, -1
    v_fmac_f32 v196, v26, v162
    v_fmac_f32 v196, v27, v163
    v_fmac_f32 v196, v28, v164
    v_fmac_f32 v196, v29, v165
    v_fmac_f32 v196, v30, v166
    v_fmac_f32 v196, v31, v167
    s_nop 1
    v_permlane32_swap_b32 v198, v196
    v_add_f32 v196, v198, v196
    v_mul_f32 v255, v32, v152
    v_fmac_f32 v255, v33, v153
    v_fmac_f32 v255, v34, v154
    v_fmac_f32 v255, v35, v155
    v_fmac_f32 v255, v36, v156
    v_fmac_f32 v255, v37, v157
    v_fmac_f32 v255, v38, v158
    v_fmac_f32 v255, v39, v159
    v_fma_f32 v203, v40, -v168, v203
    v_fma_f32 v203, v41, -v169, v203
    v_permlane32_swap_b32 v255, v201
    v_fma_f32 v203, v42, -v170, v203
    v_fma_f32 v203, v43, -v171, v203
    v_fma_f32 v203, v44, -v172, v203
    v_fma_f32 v203, v45, -v173, v203
    v_fma_f32 v203, v46, -v174, v203
    v_fma_f32 v203, v47, -v175, v203
    v_add_f32 v201, v255, v201
    v_fmac_f32 v199, v48, v120
    v_permlane32_swap_b32 v203, v255
    v_fmac_f32 v199, v49, v121
    v_fmac_f32 v199, v50, v122
    v_fmac_f32 v199, v51, v123
    v_fmac_f32 v199, v52, v124
    v_fmac_f32 v199, v53, v125
    v_fmac_f32 v199, v54, v126
    v_fmac_f32 v199, v55, v127
    v_add_f32 v255, v203, v255
    v_mul_f32 v197, v56, v168
    v_fmac_f32 v197, v57, v169
    v_fmac_f32 v197, v58, v170
    v_fmac_f32 v197, v59, v171
    v_fmac_f32 v197, v60, v172
    v_fmac_f32 v197, v61, v173
    v_fmac_f32 v197, v62, v174
    v_fmac_f32 v197, v63, v175
    s_nop 1
    v_permlane32_swap_b32 v199, v197
    v_add_f32 v197, v199, v197
    v_cvt_pk_bf16_f32 v200, v200, v201
    v_cvt_pk_bf16_f32 v254, v254, v255
    v_cvt_pk_bf16_f32 v196, v196, v197
    ds_write_b32 v253, v200 offset:768
    s_mov_b64 exec, 0xffffffff
    ds_write_b32 v253, v254 offset:1280
    s_mov_b64 exec, -1
    ds_write_b32 v253, v196 offset:1024
    s_add_u32 s50, s50, 1
    s_cmp_ge_u32 s50, 5
    s_cbranch_scc1 TAIL
    s_waitcnt lgkmcnt(8)
    v_readfirstlane_b32 s66, v252
    s_add_u32 s53, s53, 1
    v_mov_b32 v252, s53
    s_cmp_le_u32 s53, s66
    ds_write2_b32 v251, v252, v252 offset0:0 offset1:8
    s_setprio 1
    s_cbranch_scc1 PRIO_10
    s_setprio 0
PRIO_10:
    s_cmp_eq_u32 s52, 4
    s_cbranch_scc1 ITEM_1_4
    s_cmp_eq_u32 s52, 5
    s_cbranch_scc1 ITEM_1_5
    s_cmp_eq_u32 s52, 3
    s_cbranch_scc1 ITEM_1_3
    s_cmp_eq_u32 s52, 6
    s_cbranch_scc1 ITEM_1_6
    s_cmp_eq_u32 s52, 8
    s_cbranch_scc1 ITEM_1_8
    s_branch ITEM_1_2
.p2align 6
ITEM_1_5:
    s_mov_b64 exec, s[54:55]
    ds_read_u16_d16_hi v243, v250 offset:128
    s_mov_b64 exec, -1
    ds_read_b64_tr_b16 v[72:73], v249 offset:512
    ds_read_b64_tr_b16 v[76:77], v249 offset:576
    ds_read_b64_tr_b16 v[74:75], v249 offset:768
    ds_read_b64_tr_b16 v[78:79], v249 offset:832
    ds_read_b64_tr_b16 v[80:81], v249 offset:1024
    ds_read_b64_tr_b16 v[84:85], v249 offset:1088
    s_waitcnt lgkmcnt(7)
    v_mul_f32_dpp v196, v242, v64 row_newbcast:0 row_mask:0xf bank_mask:0xf
    v_mul_f32_dpp v197, v242, v65 row_newbcast:1 row_mask:0xf bank_mask:0xf
    v_mul_f32_dpp v198, v242, v64 row_newbcast:8 row_mask:0xf bank_mask:0xf
    v_mul_f32_dpp v199, v242, v65 row_newbcast:9 row_mask:0xf bank_mask:0xf
    v_mul_f32_dpp v200, v242, v68 row_newbcast:2 row_mask:0xf bank_mask:0xf
    v_mul_f32_dpp v201, v242, v69 row_newbcast:3 row_mask:0xf bank_mask:0xf
    v_mul_f32_dpp v202, v242, v68 row_newbcast:10 row_mask:0xf bank_mask:0xf
    v_mul_f32_dpp v203, v242, v69 row_newbcast:11 row_mask:0xf bank_mask:0xf
    v_cvt_pk_bf16_f32 v64, v196, v197
    v_cvt_pk_bf16_f32 v68, v198, v199
    v_cvt_pk_bf16_f32 v65, v200, v201
    v_cvt_pk_bf16_f32 v69, v202, v203
    v_mul_f32_dpp v196, v242, v66 row_newbcast:4 row_mask:0xf bank_mask:0xf
    v_mul_f32_dpp v197, v242, v67 row_newbcast:5 row_mask:0xf bank_mask:0xf
    v_mul_f32_dpp v198, v242, v66 row_newbcast:12 row_mask:0xf bank_mask:0xf
    v_mul_f32_dpp v199, v242, v67 row_newbcast:13 row_mask:0xf bank_mask:0xf
    v_mul_f32_dpp v200, v242, v70 row_newbcast:6 row_mask:0xf bank_mask:0xf
    v_mul_f32_dpp v201, v242, v71 row_newbcast:7 row_mask:0xf bank_mask:0xf
    v_mul_f32_dpp v202, v242, v70 row_newbcast:14 row_mask:0xf bank_mask:0xf
    v_mul_f32_dpp v203, v242, v71 row_newbcast:15 row_mask:0xf bank_mask:0xf
    v_cvt_pk_bf16_f32 v66, v196, v197
    v_cvt_pk_bf16_f32 v70, v198, v199
    v_cvt_pk_bf16_f32 v67, v200, v201
    v_cvt_pk_bf16_f32 v71, v202, v203
    s_mov_b64 exec, s[54:55]
    ds_read_u16_d16_hi v242, v250 offset:256
    s_mov_b64 exec, -1
    s_waitcnt vmcnt(4) lgkmcnt(3)
    v_mfma_f32_32x32x16_bf16 v[0:15], v[64:67], v[176:179], 0
    v_mul_f32_dpp v196, v243, v72 row_newbcast:0 row_mask:0xf bank_mask:0xf
    v_mul_f32_dpp v197, v243, v73 row_newbcast:1 row_mask:0xf bank_mask:0xf
    v_mul_f32_dpp v198, v243, v72 row_newbcast:8 row_mask:0xf bank_mask:0xf
    v_mul_f32_dpp v199, v243, v73 row_newbcast:9 row_mask:0xf bank_mask:0xf
    v_mul_f32_dpp v200, v243, v76 row_newbcast:2 row_mask:0xf bank_mask:0xf
    v_mul_f32_dpp v201, v243, v77 row_newbcast:3 row_mask:0xf bank_mask:0xf
    v_mul_f32_dpp v202, v243, v76 row_newbcast:10 row_mask:0xf bank_mask:0xf
    v_mul_f32_dpp v203, v243, v77 row_newbcast:11 row_mask:0xf bank_mask:0xf
    v_cvt_pk_bf16_f32 v72, v196, v197
    v_cvt_pk_bf16_f32 v76, v198, v199
    v_cvt_pk_bf16_f32 v73, v200, v201
    v_cvt_pk_bf16_f32 v77, v202, v203
    s_add_u32 m0, s21, 0
    v_mfma_f32_32x32x16_bf16 v[16:31], v[68:71], v[176:179], 0
    buffer_load_dwordx4 v236, s[4:7], s35 offen lds
    buffer_load_dwordx4 v237, s[8:11], s35 offen offset:1024 lds
    ds_read_b64_tr_b16 v[176:177], v244 offset:2048
    ds_read_b64_tr_b16 v[178:179], v244 offset:3072
    ds_read_b64_tr_b16 v[184:185], v245 offset:2048
    ds_read_b64_tr_b16 v[186:187], v245 offset:3072
    v_mul_f32_dpp v196, v243, v74 row_newbcast:4 row_mask:0xf bank_mask:0xf
    v_mul_f32_dpp v197, v243, v75 row_newbcast:5 row_mask:0xf bank_mask:0xf
    v_mul_f32_dpp v198, v243, v74 row_newbcast:12 row_mask:0xf bank_mask:0xf
    v_mul_f32_dpp v199, v243, v75 row_newbcast:13 row_mask:0xf bank_mask:0xf
    v_mul_f32_dpp v200, v243, v78 row_newbcast:6 row_mask:0xf bank_mask:0xf
    v_mul_f32_dpp v201, v243, v79 row_newbcast:7 row_mask:0xf bank_mask:0xf
    v_mul_f32_dpp v202, v243, v78 row_newbcast:14 row_mask:0xf bank_mask:0xf
    v_mul_f32_dpp v203, v243, v79 row_newbcast:15 row_mask:0xf bank_mask:0xf
    v_cvt_pk_bf16_f32 v74, v196, v197
    v_cvt_pk_bf16_f32 v78, v198, v199
    v_cvt_pk_bf16_f32 v75, v200, v201
    v_cvt_pk_bf16_f32 v79, v202, v203
    s_nop 0
    s_waitcnt vmcnt(4) lgkmcnt(0)
    v_mfma_f32_32x32x16_bf16 v[0:15], v[72:75], v[176:179], v[0:15]
    v_mul_f32_dpp v196, v242, v80 row_newbcast:0 row_mask:0xf bank_mask:0xf
    v_mul_f32_dpp v197, v242, v81 row_newbcast:1 row_mask:0xf bank_mask:0xf
    v_mul_f32_dpp v198, v242, v80 row_newbcast:8 row_mask:0xf bank_mask:0xf
    v_mul_f32_dpp v199, v242, v81 row_newbcast:9 row_mask:0xf bank_mask:0xf
    v_mul_f32_dpp v200, v242, v84 row_newbcast:2 row_mask:0xf bank_mask:0xf
    v_mul_f32_dpp v201, v242, v85 row_newbcast:3 row_mask:0xf bank_mask:0xf
    s_add_u32 m0, s21, 2048
    v_mfma_f32_32x32x16_bf16 v[16:31], v[76:79], v[176:179], v[16:31]
    buffer_load_dwordx4 v238, s[4:7], s35 offen lds
    ds_read_b64_tr_b16 v[176:177], v244 offset:4096
    ds_read_b64_tr_b16 v[188:189], v245 offset:4096
    v_mul_f32_dpp v202, v242, v84 row_newbcast:10 row_mask:0xf bank_mask:0xf
    v_mul_f32_dpp v203, v242, v85 row_newbcast:11 row_mask:0xf bank_mask:0xf
    v_cvt_pk_bf16_f32 v80, v196, v197
    v_cvt_pk_bf16_f32 v84, v198, v199
    v_cvt_pk_bf16_f32 v81, v200, v201
    v_cvt_pk_bf16_f32 v85, v202, v203
    s_nop 0
    s_waitcnt lgkmcnt(0)
    v_mfma_f32_32x32x8_bf16 v[0:15], v[80:81], v[176:177], v[0:15]
    s_add_u32 m0, s21, 4096
    v_mfma_f32_32x32x8_bf16 v[16:31], v[84:85], v[176:177], v[16:31]
    buffer_load_dwordx4 v234, s[4:7], s36 offen lds
    buffer_load_dwordx4 v235, s[8:11], s36 offen offset:1024 lds
    s_mov_b32 m0, s50
    s_nop 0
    s_movrels_b32 s71, s23
    s_movrels_b32 s33, s28
    s_and_b32 s70, s33, 0x70
    s_andn2_b32 s33, s33, 0x70
    v_xor_b32 v253, s70, v248
    v_add_u32 v253, s33, v253
    s_bfe_u32 s46, s71, 0x30012
    s_mov_b32 m0, s46
    s_and_b32 s66, s71, 0x3ffff
    s_movrels_b32 s68, s57
    s_movrels_b32 s69, s61
    s_sub_u32 s48, s66, s47
    s_mov_b32 s47, s66
    s_lshr_b32 s52, s71, 28
    s_lshl_b32 s67, s46, 9
    s_add_u32 s66, s66, s67
    s_sub_u32 s49, s66, s42
    s_mov_b32 s42, s66
    s_bfe_u32 s66, s68, 655360
    s_add_u32 s43, s42, s66
    s_bfe_u32 s39, s69, 655360
    s_bfe_u32 s66, s68, 655370
    s_add_u32 s44, s42, s66
    s_bfe_u32 s40, s69, 655370
    s_bfe_u32 s66, s68, 655380
    s_add_u32 s45, s42, s66
    s_bfe_u32 s41, s69, 655380
    v_add_u32 v252, s45, v247
    ds_read_u16 v240, v252
    ds_read_u16 v241, v252 offset:64
    v_mfma_f32_32x32x16_bf16 v[32:47], v[64:67], v[180:183], 0
    v_mul_f32 v196, v0, v96
    v_fmac_f32 v196, v1, v97
    v_fmac_f32 v196, v2, v98
    v_fmac_f32 v196, v3, v99
    v_fmac_f32 v196, v4, v100
    v_fmac_f32 v196, v5, v101
    v_fmac_f32 v196, v6, v102
    v_mfma_f32_32x32x16_bf16 v[48:63], v[68:71], v[180:183], 0
    v_fmac_f32 v196, v7, v103
    v_mul_f32 v198, v8, v128
    v_fmac_f32 v198, v9, v129
    v_fmac_f32 v198, v10, v130
    v_fmac_f32 v198, v11, v131
    v_fmac_f32 v198, v12, v132
    v_mfma_f32_32x32x16_bf16 v[32:47], v[72:75], v[184:187], v[32:47]
    v_fmac_f32 v198, v13, v133
    v_fmac_f32 v198, v14, v134
    v_fmac_f32 v198, v15, v135
    v_mul_f32 v200, v16, v128
    v_fmac_f32 v200, v17, v129
    v_permlane32_swap_b32 v196, v198
    v_mfma_f32_32x32x16_bf16 v[48:63], v[76:79], v[184:187], v[48:63]
    s_waitcnt vmcnt(5)
    ds_read_b64_tr_b16 v[176:177], v244 offset:6144
    ds_read_b64_tr_b16 v[178:179], v244 offset:7168
    ds_read_b64_tr_b16 v[180:181], v245 offset:6144
    ds_read_b64_tr_b16 v[182:183], v245 offset:7168
    v_fmac_f32 v200, v18, v130
    v_fmac_f32 v200, v19, v131
    v_fmac_f32 v200, v20, v132
    v_fmac_f32 v200, v21, v133
    v_fmac_f32 v200, v22, v134
    v_fmac_f32 v200, v23, v135
    v_mfma_f32_32x32x8_bf16 v[32:47], v[80:81], v[188:189], v[32:47]
    v_add_f32 v198, v196, v198
    v_mul_f32_e64 v202, v24, -v128
    v_fma_f32 v202, v25, -v129, v202
    v_fma_f32 v202, v26, -v130, v202
    v_fma_f32 v202, v27, -v131, v202
    v_fma_f32 v202, v28, -v132, v202
    v_mfma_f32_32x32x8_bf16 v[48:63], v[84:85], v[188:189], v[48:63]
    v_fma_f32 v202, v29, -v133, v202
    v_fma_f32 v202, v30, -v134, v202
    v_fma_f32 v202, v31, -v135, v202
    s_nop 1
    v_permlane32_swap_b32 v200, v202
    v_add_f32 v202, v200, v202
    s_waitcnt vmcnt(3) lgkmcnt(0)
    v_mfma_f32_32x32x16_bf16 v[0:15], v[64:67], v[176:179], 0
    v_mul_f32 v197, v32, v104
    v_fmac_f32 v197, v33, v105
    v_fmac_f32 v197, v34, v106
    v_fmac_f32 v197, v35, v107
    v_fmac_f32 v197, v36, v108
    v_fmac_f32 v197, v37, v109
    v_fmac_f32 v197, v38, v110
    s_add_u32 m0, s21, 6144
    v_mfma_f32_32x32x16_bf16 v[16:31], v[68:71], v[176:179], 0
    buffer_load_dwordx4 v236, s[4:7], s36 offen lds
    buffer_load_dwordx4 v237, s[8:11], s36 offen offset:1024 lds
    ds_read_b64_tr_b16 v[176:177], v244 offset:0
    ds_read_b64_tr_b16 v[178:179], v244 offset:1024
    ds_read_b64_tr_b16 v[184:185], v245 offset:0
    ds_read_b64_tr_b16 v[186:187], v245 offset:1024
    v_fmac_f32 v197, v39, v111
    v_mul_f32 v199, v40, v136
    v_fmac_f32 v199, v41, v137
    v_fmac_f32 v199, v42, v138
    v_fmac_f32 v199, v43, v139
    v_fmac_f32 v199, v44, v140
    v_fmac_f32 v199, v45, v141
    s_waitcnt vmcnt(4) lgkmcnt(0)
    v_mfma_f32_32x32x16_bf16 v[0:15], v[72:75], v[176:179], v[0:15]
    v_fmac_f32 v199, v46, v142
    v_fmac_f32 v199, v47, v143
    v_mul_f32 v201, v48, v136
    v_fmac_f32 v201, v49, v137
    v_permlane32_swap_b32 v197, v199
    v_fmac_f32 v201, v50, v138
    v_fmac_f32 v201, v51, v139
    s_add_u32 m0, s21, 0
    v_mfma_f32_32x32x16_bf16 v[16:31], v[76:79], v[176:179], v[16:31]
    buffer_load_dwordx4 v238, s[4:7], s36 offen lds
    ds_read_b64_tr_b16 v[176:177], v244 offset:2048
    ds_read_b64_tr_b16 v[188:189], v245 offset:2048
    v_fmac_f32 v201, v52, v140
    v_fmac_f32 v201, v53, v141
    v_fmac_f32 v201, v54, v142
    v_fmac_f32 v201, v55, v143
    v_add_f32 v199, v197, v199
    v_mul_f32_e64 v203, v56, -v136
    v_fma_f32 v203, v57, -v137, v203
    s_waitcnt lgkmcnt(0)
    v_mfma_f32_32x32x8_bf16 v[0:15], v[80:81], v[176:177], v[0:15]
    v_fma_f32 v203, v58, -v138, v203
    v_fma_f32 v203, v59, -v139, v203
    v_fma_f32 v203, v60, -v140, v203
    v_fma_f32 v203, v61, -v141, v203
    v_fma_f32 v203, v62, -v142, v203
    v_fma_f32 v203, v63, -v143, v203
    s_nop 1
    s_add_u32 m0, s21, 2048
    v_mfma_f32_32x32x8_bf16 v[16:31], v[84:85], v[176:177], v[16:31]
    buffer_load_dwordx4 v234, s[4:7], s37 offen lds
    buffer_load_dwordx4 v235, s[8:11], s37 offen offset:1024 lds
    v_add_u32 v252, s42, v247
    ds_read_u16 v234, v252
    ds_read_u16 v235, v252 offset:64
    v_permlane32_swap_b32 v201, v203
    v_add_f32 v203, v201, v203
    v_cvt_pk_bf16_f32 v198, v198, v199
    v_cvt_pk_bf16_f32 v202, v202, v203
    ds_write_b32 v253, v198 offset:0
    ds_write_b32 v253, v202 offset:256
    v_mfma_f32_32x32x16_bf16 v[32:47], v[64:67], v[180:183], 0
    v_mul_f32 v196, v0, v144
    v_fmac_f32 v196, v1, v145
    v_fmac_f32 v196, v2, v146
    v_fmac_f32 v196, v3, v147
    v_fmac_f32 v196, v4, v148
    v_fmac_f32 v196, v5, v149
    v_mfma_f32_32x32x16_bf16 v[48:63], v[68:71], v[180:183], 0
    v_fmac_f32 v196, v6, v150
    v_fmac_f32 v196, v7, v151
    v_mul_f32 v198, v8, v112
    v_fmac_f32 v198, v9, v113
    v_fmac_f32 v198, v10, v114
    v_mfma_f32_32x32x16_bf16 v[32:47], v[72:75], v[184:187], v[32:47]
    v_fmac_f32 v198, v11, v115
    v_fmac_f32 v198, v12, v116
    v_fmac_f32 v198, v13, v117
    v_fmac_f32 v198, v14, v118
    v_fmac_f32 v198, v15, v119
    v_mfma_f32_32x32x16_bf16 v[48:63], v[76:79], v[184:187], v[48:63]
    s_waitcnt vmcnt(5)
    ds_read_b64_tr_b16 v[176:177], v244 offset:4096
    ds_read_b64_tr_b16 v[178:179], v244 offset:5120
    ds_read_b64_tr_b16 v[180:181], v245 offset:4096
    ds_read_b64_tr_b16 v[182:183], v245 offset:5120
    v_mul_f32_e64 v200, v16, -v160
    v_fma_f32 v200, v17, -v161, v200
    v_fma_f32 v200, v18, -v162, v200
    v_fma_f32 v200, v19, -v163, v200
    v_fma_f32 v200, v20, -v164, v200
    v_fma_f32 v200, v21, -v165, v200
    v_mfma_f32_32x32x8_bf16 v[32:47], v[80:81], v[188:189], v[32:47]
    v_fma_f32 v200, v22, -v166, v200
    v_fma_f32 v200, v23, -v167, v200
    v_mul_f32_e64 v202, v24, -v160
    v_fma_f32 v202, v25, -v161, v202
    v_fma_f32 v202, v26, -v162, v202
    v_mfma_f32_32x32x8_bf16 v[48:63], v[84:85], v[188:189], v[48:63]
    v_fma_f32 v202, v27, -v163, v202
    v_fma_f32 v202, v28, -v164, v202
    v_fma_f32 v202, v29, -v165, v202
    v_fma_f32 v202, v30, -v166, v202
    v_fma_f32 v202, v31, -v167, v202
    s_waitcnt vmcnt(3) lgkmcnt(0)
    v_mfma_f32_32x32x16_bf16 v[0:15], v[64:67], v[176:179], 0
    v_mul_f32 v197, v32, v152
    v_fmac_f32 v197, v33, v153
    v_fmac_f32 v197, v34, v154
    v_fmac_f32 v197, v35, v155
    v_fmac_f32 v197, v36, v156
    v_fmac_f32 v197, v37, v157
    s_add_u32 m0, s21, 4096
    v_mfma_f32_32x32x16_bf16 v[16:31], v[68:71], v[176:179], 0
    buffer_load_dwordx4 v236, s[4:7], s37 offen lds
    buffer_load_dwordx4 v237, s[8:11], s37 offen offset:1024 lds
    ds_read_b64_tr_b16 v[176:177], v244 offset:6144
    ds_read_b64_tr_b16 v[178:179], v244 offset:7168
    ds_read_b64_tr_b16 v[184:185], v245 offset:6144
    ds_read_b64_tr_b16 v[186:187], v245 offset:7168
    v_add_u32 v252, s43, v247
    ds_read_u16 v236, v252
    ds_read_u16 v237, v252 offset:64
    v_fmac_f32 v197, v38, v158
    v_fmac_f32 v197, v39, v159
    v_mul_f32 v199, v40, v120
    v_fmac_f32 v199, v41, v121
    v_fmac_f32 v199, v42, v122
    s_waitcnt vmcnt(4) lgkmcnt(2)
    v_mfma_f32_32x32x16_bf16 v[0:15], v[72:75], v[176:179], v[0:15]
    v_fmac_f32 v199, v43, v123
    v_fmac_f32 v199, v44, v124
    v_fmac_f32 v199, v45, v125
    v_fmac_f32 v199, v46, v126
    v_fmac_f32 v199, v47, v127
    s_add_u32 m0, s21, 6144
    v_mfma_f32_32x32x16_bf16 v[16:31], v[76:79], v[176:179], v[16:31]
    buffer_load_dwordx4 v238, s[4:7], s37 offen lds
    ds_read_b64_tr_b16 v[176:177], v244 offset:0
    ds_read_b64_tr_b16 v[188:189], v245 offset:0
    v_add_u32 v252, s44, v247
    ds_read_u16 v238, v252
    ds_read_u16 v239, v252 offset:64
    v_mul_f32_e64 v201, v48, -v168
    v_fma_f32 v201, v49, -v169, v201
    v_fma_f32 v201, v50, -v170, v201
    v_fma_f32 v201, v51, -v171, v201
    v_fma_f32 v201, v52, -v172, v201
    v_fma_f32 v201, v53, -v173, v201
    s_waitcnt lgkmcnt(2)
    v_mfma_f32_32x32x8_bf16 v[0:15], v[80:81], v[176:177], v[0:15]
    v_fma_f32 v201, v54, -v174, v201
    v_fma_f32 v201, v55, -v175, v201
    v_mul_f32_e64 v203, v56, -v168
    v_fma_f32 v203, v57, -v169, v203
    v_fma_f32 v203, v58, -v170, v203
    s_add_u32 m0, s21, 0
    v_mfma_f32_32x32x8_bf16 v[16:31], v[84:85], v[176:177], v[16:31]
    v_lshl_add_u32 v234, v234, 10, v246
    v_lshl_add_u32 v235, v235, 10, v246
    buffer_load_dwordx4 v234, s[4:7], s38 offen lds
    buffer_load_dwordx4 v235, s[8:11], s38 offen offset:1024 lds
    v_fma_f32 v203, v59, -v171, v203
    v_fma_f32 v203, v60, -v172, v203
    v_fma_f32 v203, v61, -v173, v203
    v_fma_f32 v203, v62, -v174, v203
    v_fma_f32 v203, v63, -v175, v203
    v_mfma_f32_32x32x16_bf16 v[32:47], v[64:67], v[180:183], 0
    v_mul_f32 v254, v0, v144
    v_fmac_f32 v254, v1, v145
    v_fmac_f32 v254, v2, v146
    v_mfma_f32_32x32x16_bf16 v[48:63], v[68:71], v[180:183], 0
    ds_swizzle_b32 v68, v68 offset:0x401F
    ds_swizzle_b32 v69, v69 offset:0x401F
    ds_swizzle_b32 v70, v70 offset:0x401F
    ds_swizzle_b32 v71, v71 offset:0x401F
    v_fmac_f32 v254, v3, v147
    v_fmac_f32 v254, v4, v148
    v_fmac_f32 v254, v5, v149
    v_mfma_f32_32x32x16_bf16 v[32:47], v[72:75], v[184:187], v[32:47]
    v_fmac_f32 v254, v6, v150
    v_fmac_f32 v254, v7, v151
    v_fmac_f32 v200, v8, v160
    v_mfma_f32_32x32x16_bf16 v[48:63], v[76:79], v[184:187], v[48:63]
    ds_swizzle_b32 v76, v76 offset:0x401F
    ds_swizzle_b32 v77, v77 offset:0x401F
    ds_swizzle_b32 v78, v78 offset:0x401F
    ds_swizzle_b32 v79, v79 offset:0x401F
    s_waitcnt vmcnt(5)
    ds_read_b64_tr_b16 v[176:177], v244 offset:2048
    ds_read_b64_tr_b16 v[178:179], v244 offset:3072
    ds_read_b64_tr_b16 v[180:181], v245 offset:2048
    ds_read_b64_tr_b16 v[182:183], v245 offset:3072
    v_fmac_f32 v200, v9, v161
    v_permlane32_swap_b32 v196, v254
    v_fmac_f32 v200, v10, v162
    v_mfma_f32_32x32x8_bf16 v[32:47], v[80:81], v[188:189], v[32:47]
    v_fmac_f32 v200, v11, v163
    v_fmac_f32 v200, v12, v164
    v_fmac_f32 v200, v13, v165
    v_mfma_f32_32x32x8_bf16 v[48:63], v[84:85], v[188:189], v[48:63]
    ds_swizzle_b32 v84, v84 offset:0x401F
    ds_swizzle_b32 v85, v85 offset:0x401F
    v_fmac_f32 v200, v14, v166
    v_fmac_f32 v200, v15, v167
    v_add_f32 v254, v196, v254
    s_waitcnt lgkmcnt(6)
    s_mov_b64 exec, s[56:57]
    v_xor_b32 v68, 0x80008000, v68
    v_xor_b32 v69, 0x80008000, v69
    v_xor_b32 v70, 0x80008000, v70
    v_xor_b32 v71, 0x80008000, v71
    v_xor_b32 v76, 0x80008000, v76
    v_xor_b32 v77, 0x80008000, v77
    v_xor_b32 v78, 0x80008000, v78
    v_xor_b32 v79, 0x80008000, v79
    s_mov_b64 exec, -1
    s_waitcnt vmcnt(3) lgkmcnt(2)
    v_mfma_f32_32x32x16_bf16 v[0:15], v[64:67], v[176:179], 0
    v_mul_f32 v255, v32, v152
    v_fmac_f32 v255, v33, v153
    v_fmac_f32 v255, v34, v154
    v_fmac_f32 v255, v35, v155
    s_add_u32 m0, s21, 2048
    v_mfma_f32_32x32x16_bf16 v[16:31], v[68:71], v[176:179], v[16:31]
    v_lshl_add_u32 v236, v236, 10, v246
    v_lshl_add_u32 v237, v237, 10, v246
    buffer_load_dwordx4 v236, s[4:7], s39 offen lds
    buffer_load_dwordx4 v237, s[8:11], s39 offen offset:1024 lds
    ds_read_b64_tr_b16 v[176:177], v244 offset:4096
    ds_read_b64_tr_b16 v[178:179], v244 offset:5120
    ds_read_b64_tr_b16 v[184:185], v245 offset:4096
    ds_read_b64_tr_b16 v[186:187], v245 offset:5120
    v_fmac_f32 v255, v36, v156
    v_fmac_f32 v255, v37, v157
    v_fmac_f32 v255, v38, v158
    s_waitcnt vmcnt(4) lgkmcnt(0)
    v_mfma_f32_32x32x16_bf16 v[0:15], v[72:75], v[176:179], v[0:15]
    v_fmac_f32 v255, v39, v159
    v_fmac_f32 v201, v40, v168
    v_fmac_f32 v201, v41, v169
    s_add_u32 m0, s21, 4096
    v_mfma_f32_32x32x16_bf16 v[16:31], v[76:79], v[176:179], v[16:31]
    v_lshl_add_u32 v238, v238, 10, v246
    v_lshl_add_u32 v239, v239, 10, v246
    buffer_load_dwordx4 v238, s[4:7], s40 offen lds
    buffer_load_dwordx4 v239, s[8:11], s40 offen offset:1024 lds
    ds_read_b64_tr_b16 v[176:177], v244 offset:6144
    ds_read_b64_tr_b16 v[188:189], v245 offset:6144
    v_permlane32_swap_b32 v197, v255
    v_fmac_f32 v201, v42, v170
    v_fmac_f32 v201, v43, v171
    v_fmac_f32 v201, v44, v172
    s_waitcnt lgkmcnt(0)
    s_mov_b64 exec, s[56:57]
    v_xor_b32 v84, 0x80008000, v84
    v_xor_b32 v85, 0x80008000, v85
    s_mov_b64 exec, -1
    v_mfma_f32_32x32x8_bf16 v[0:15], v[80:81], v[176:177], v[0:15]
    v_fmac_f32 v201, v45, v173
    v_fmac_f32 v201, v46, v174
    v_fmac_f32 v201, v47, v175
    s_add_u32 m0, s21, 6144
    v_mfma_f32_32x32x8_bf16 v[16:31], v[84:85], v[176:177], v[16:31]
    v_lshl_add_u32 v240, v240, 10, v246
    v_lshl_add_u32 v241, v241, 10, v246
    buffer_load_dwordx4 v240, s[4:7], s41 offen lds
    buffer_load_dwordx4 v241, s[8:11], s41 offen offset:1024 lds
    v_add_f32 v255, v197, v255
    v_cvt_pk_bf16_f32 v254, v254, v255
    ds_write_b32 v253, v254 offset:512
    v_mfma_f32_32x32x16_bf16 v[32:47], v[64:67], v[180:183], 0
    v_mul_f32 v254, v0, v144
    v_fmac_f32 v254, v1, v145
    v_fmac_f32 v254, v2, v146
    v_fmac_f32 v254, v3, v147
    v_fmac_f32 v254, v4, v148
    v_fmac_f32 v254, v5, v149
    v_fmac_f32 v254, v6, v150
    v_mfma_f32_32x32x16_bf16 v[48:63], v[68:71], v[180:183], v[48:63]
    v_fmac_f32 v254, v7, v151
    v_fma_f32 v202, v8, -v160, v202
    v_fma_f32 v202, v9, -v161, v202
    v_permlane32_swap_b32 v254, v200
    v_fma_f32 v202, v10, -v162, v202
    v_fma_f32 v202, v11, -v163, v202
    v_mfma_f32_32x32x16_bf16 v[32:47], v[72:75], v[184:187], v[32:47]
    v_fma_f32 v202, v12, -v164, v202
    v_fma_f32 v202, v13, -v165, v202
    v_fma_f32 v202, v14, -v166, v202
    v_fma_f32 v202, v15, -v167, v202
    v_add_f32 v200, v254, v200
    v_fmac_f32 v198, v16, v112
    v_permlane32_swap_b32 v202, v254
    v_mfma_f32_32x32x16_bf16 v[48:63], v[76:79], v[184:187], v[48:63]
    s_waitcnt vmcnt(6)
    ds_read_b64_tr_b16 v[176:177], v244 offset:0
    ds_read_b64_tr_b16 v[178:179], v244 offset:1024
    ds_read_b64_tr_b16 v[180:181], v245 offset:0
    ds_read_b64_tr_b16 v[182:183], v245 offset:1024
    v_fmac_f32 v198, v17, v113
    v_fmac_f32 v198, v18, v114
    v_fmac_f32 v198, v19, v115
    v_fmac_f32 v198, v20, v116
    v_fmac_f32 v198, v21, v117
    v_fmac_f32 v198, v22, v118
    v_mfma_f32_32x32x8_bf16 v[32:47], v[80:81], v[188:189], v[32:47]
    v_fmac_f32 v198, v23, v119
    v_add_f32 v254, v202, v254
    v_mul_f32 v196, v24, v160
    v_fmac_f32 v196, v25, v161
    v_fmac_f32 v196, v26, v162
    v_fmac_f32 v196, v27, v163
    v_fmac_f32 v196, v28, v164
    v_mfma_f32_32x32x8_bf16 v[48:63], v[84:85], v[188:189], v[48:63]
    v_add_u32 v249, s48, v249
    v_add_u32 v250, s49, v250
    ds_read_b32 v252, v251 offset:16
    ds_read_b64_tr_b16 v[64:65], v249 offset:0
    ds_read_b64_tr_b16 v[68:69], v249 offset:64
    ds_read_b64_tr_b16 v[66:67], v249 offset:256
    ds_read_b64_tr_b16 v[70:71], v249 offset:320
    s_mov_b64 exec, s[54:55]
    ds_read_u16_d16_hi v242, v250 offset:0
    s_mov_b64 exec, -1
    v_fmac_f32 v196, v29, v165
    v_fmac_f32 v196, v30, v166
    v_fmac_f32 v196, v31, v167
    s_nop 1
    v_permlane32_swap_b32 v198, v196
    v_add_f32 v196, v198, v196
    v_mul_f32 v255, v32, v152
    v_fmac_f32 v255, v33, v153
    v_fmac_f32 v255, v34, v154
    v_fmac_f32 v255, v35, v155
    v_fmac_f32 v255, v36, v156
    v_fmac_f32 v255, v37, v157
    v_fmac_f32 v255, v38, v158
    v_fmac_f32 v255, v39, v159
    v_fma_f32 v203, v40, -v168, v203
    v_fma_f32 v203, v41, -v169, v203
    v_permlane32_swap_b32 v255, v201
    v_fma_f32 v203, v42, -v170, v203
    v_fma_f32 v203, v43, -v171, v203
    v_fma_f32 v203, v44, -v172, v203
    v_fma_f32 v203, v45, -v173, v203
    v_fma_f32 v203, v46, -v174, v203
    v_fma_f32 v203, v47, -v175, v203
    v_add_f32 v201, v255, v201
    v_fmac_f32 v199, v48, v120
    v_permlane32_swap_b32 v203, v255
    v_fmac_f32 v199, v49, v121
    v_fmac_f32 v199, v50, v122
    v_fmac_f32 v199, v51, v123
    v_fmac_f32 v199, v52, v124
    v_fmac_f32 v199, v53, v125
    v_fmac_f32 v199, v54, v126
    v_fmac_f32 v199, v55, v127
    v_add_f32 v255, v203, v255
    v_mul_f32 v197, v56, v168
    v_fmac_f32 v197, v57, v169
    v_fmac_f32 v197, v58, v170
    v_fmac_f32 v197, v59, v171
    v_fmac_f32 v197, v60, v172
    v_fmac_f32 v197, v61, v173
    v_fmac_f32 v197, v62, v174
    v_fmac_f32 v197, v63, v175
    s_nop 1
    v_permlane32_swap_b32 v199, v197
    v_add_f32 v197, v199, v197
    v_cvt_pk_bf16_f32 v200, v200, v201
    v_cvt_pk_bf16_f32 v254, v254, v255
    v_cvt_pk_bf16_f32 v196, v196, v197
    ds_write_b32 v253, v200 offset:768
    s_mov_b64 exec, 0xffffffff
    ds_write_b32 v253, v254 offset:1280
    s_mov_b64 exec, -1
    ds_write_b32 v253, v196 offset:1024
    s_add_u32 s50, s50, 1
    s_cmp_ge_u32 s50, 5
    s_cbranch_scc1 TAIL
    s_waitcnt lgkmcnt(8)
    v_readfirstlane_b32 s66, v252
    s_add_u32 s53, s53, 1
    v_mov_b32 v252, s53
    s_cmp_le_u32 s53, s66
    ds_write2_b32 v251, v252, v252 offset0:0 offset1:8
    s_setprio 1
    s_cbranch_scc1 PRIO_11
    s_setprio 0
PRIO_11:
    s_cmp_eq_u32 s52, 4
    s_cbranch_scc1 ITEM_1_4
    s_cmp_eq_u32 s52, 5
    s_cbranch_scc1 ITEM_1_5
    s_cmp_eq_u32 s52, 3
    s_cbranch_scc1 ITEM_1_3
    s_cmp_eq_u32 s52, 6
    s_cbranch_scc1 ITEM_1_6
    s_cmp_eq_u32 s52, 8
    s_cbranch_scc1 ITEM_1_8
    s_branch ITEM_1_2
.p2align 6
ITEM_1_3:
    s_mov_b64 exec, s[54:55]
    ds_read_u16_d16_hi v243, v250 offset:128
    s_mov_b64 exec, -1
    ds_read_b64_tr_b16 v[72:73], v249 offset:512
    ds_read_b64_tr_b16 v[76:77], v249 offset:576
    s_waitcnt lgkmcnt(3)
    v_mul_f32_dpp v196, v242, v64 row_newbcast:0 row_mask:0xf bank_mask:0xf
    v_mul_f32_dpp v197, v242, v65 row_newbcast:1 row_mask:0xf bank_mask:0xf
    v_mul_f32_dpp v198, v242, v64 row_newbcast:8 row_mask:0xf bank_mask:0xf
    v_mul_f32_dpp v199, v242, v65 row_newbcast:9 row_mask:0xf bank_mask:0xf
    v_mul_f32_dpp v200, v242, v68 row_newbcast:2 row_mask:0xf bank_mask:0xf
    v_mul_f32_dpp v201, v242, v69 row_newbcast:3 row_mask:0xf bank_mask:0xf
    v_mul_f32_dpp v202, v242, v68 row_newbcast:10 row_mask:0xf bank_mask:0xf
    v_mul_f32_dpp v203, v242, v69 row_newbcast:11 row_mask:0xf bank_mask:0xf
    v_cvt_pk_bf16_f32 v64, v196, v197
    v_cvt_pk_bf16_f32 v68, v198, v199
    v_cvt_pk_bf16_f32 v65, v200, v201
    v_cvt_pk_bf16_f32 v69, v202, v203
    v_mul_f32_dpp v196, v242, v66 row_newbcast:4 row_mask:0xf bank_mask:0xf
    v_mul_f32_dpp v197, v242, v67 row_newbcast:5 row_mask:0xf bank_mask:0xf
    v_mul_f32_dpp v198, v242, v66 row_newbcast:12 row_mask:0xf bank_mask:0xf
    v_mul_f32_dpp v199, v242, v67 row_newbcast:13 row_mask:0xf bank_mask:0xf
    v_mul_f32_dpp v200, v242, v70 row_newbcast:6 row_mask:0xf bank_mask:0xf
    v_mul_f32_dpp v201, v242, v71 row_newbcast:7 row_mask:0xf bank_mask:0xf
    v_mul_f32_dpp v202, v242, v70 row_newbcast:14 row_mask:0xf bank_mask:0xf
    v_mul_f32_dpp v203, v242, v71 row_newbcast:15 row_mask:0xf bank_mask:0xf
    v_cvt_pk_bf16_f32 v66, v196, v197
    v_cvt_pk_bf16_f32 v70, v198, v199
    v_cvt_pk_bf16_f32 v67, v200, v201
    v_cvt_pk_bf16_f32 v71, v202, v203
    s_nop 0
    s_waitcnt vmcnt(4) lgkmcnt(0)
    v_mfma_f32_32x32x16_bf16 v[0:15], v[64:67], v[176:179], 0
    v_mul_f32_dpp v196, v243, v72 row_newbcast:0 row_mask:0xf bank_mask:0xf
    v_mul_f32_dpp v197, v243, v73 row_newbcast:1 row_mask:0xf bank_mask:0xf
    v_mul_f32_dpp v198, v243, v72 row_newbcast:8 row_mask:0xf bank_mask:0xf
    v_mul_f32_dpp v199, v243, v73 row_newbcast:9 row_mask:0xf bank_mask:0xf
    v_mul_f32_dpp v200, v243, v76 row_newbcast:2 row_mask:0xf bank_mask:0xf
    v_mul_f32_dpp v201, v243, v77 row_newbcast:3 row_mask:0xf bank_mask:0xf
    s_add_u32 m0, s21, 0
    v_mfma_f32_32x32x16_bf16 v[16:31], v[68:71], v[176:179], 0
    buffer_load_dwordx4 v234, s[4:7], s36 offen lds
    buffer_load_dwordx4 v235, s[8:11], s36 offen offset:1024 lds
    ds_read_b64_tr_b16 v[176:177], v244 offset:2048
    ds_read_b64_tr_b16 v[184:185], v245 offset:2048
    v_mul_f32_dpp v202, v243, v76 row_newbcast:10 row_mask:0xf bank_mask:0xf
    v_mul_f32_dpp v203, v243, v77 row_newbcast:11 row_mask:0xf bank_mask:0xf
    v_cvt_pk_bf16_f32 v72, v196, v197
    v_cvt_pk_bf16_f32 v76, v198, v199
    v_cvt_pk_bf16_f32 v73, v200, v201
    v_cvt_pk_bf16_f32 v77, v202, v203
    s_nop 0
    s_waitcnt lgkmcnt(0)
    v_mfma_f32_32x32x8_bf16 v[0:15], v[72:73], v[176:177], v[0:15]
    s_add_u32 m0, s21, 2048
    v_mfma_f32_32x32x8_bf16 v[16:31], v[76:77], v[176:177], v[16:31]
    buffer_load_dwordx4 v236, s[4:7], s36 offen lds
    s_mov_b32 m0, s50
    s_nop 0
    s_movrels_b32 s71, s23
    s_movrels_b32 s33, s28
    s_and_b32 s70, s33, 0x70
    s_andn2_b32 s33, s33, 0x70
    v_xor_b32 v253, s70, v248
    v_add_u32 v253, s33, v253
    s_bfe_u32 s46, s71, 0x30012
    s_mov_b32 m0, s46
    s_and_b32 s66, s71, 0x3ffff
    s_movrels_b32 s68, s57
    s_movrels_b32 s69, s61
    s_sub_u32 s48, s66, s47
    s_mov_b32 s47, s66
    s_lshr_b32 s52, s71, 28
    s_lshl_b32 s67, s46, 9
    s_add_u32 s66, s66, s67
    s_sub_u32 s49, s66, s42
    s_mov_b32 s42, s66
    s_bfe_u32 s66, s68, 655360
    s_add_u32 s43, s42, s66
    s_bfe_u32 s39, s69, 655360
    s_bfe_u32 s66, s68, 655370
    s_add_u32 s44, s42, s66
    s_bfe_u32 s40, s69, 655370
    s_bfe_u32 s66, s68, 655380
    s_add_u32 s45, s42, s66
    s_bfe_u32 s41, s69, 655380
    v_add_u32 v252, s44, v247
    ds_read_u16 v238, v252
    ds_read_u16 v239, v252 offset:64
    v_add_u32 v252, s45, v247
    ds_read_u16 v240, v252
    ds_read_u16 v241, v252 offset:64
    v_mfma_f32_32x32x16_bf16 v[32:47], v[64:67], v[180:183], 0
    v_mul_f32 v196, v0, v96
    v_fmac_f32 v196, v1, v97
    v_fmac_f32 v196, v2, v98
    v_fmac_f32 v196, v3, v99
    v_fmac_f32 v196, v4, v100
    v_fmac_f32 v196, v5, v101
    v_fmac_f32 v196, v6, v102
    v_fmac_f32 v196, v7, v103
    v_mul_f32 v198, v8, v128
    v_fmac_f32 v198, v9, v129
    v_mfma_f32_32x32x16_bf16 v[48:63], v[68:71], v[180:183], 0
    s_waitcnt vmcnt(5)
    ds_read_b64_tr_b16 v[176:177], v244 offset:4096
    ds_read_b64_tr_b16 v[178:179], v244 offset:5120
    ds_read_b64_tr_b16 v[180:181], v245 offset:4096
    ds_read_b64_tr_b16 v[182:183], v245 offset:5120
    v_fmac_f32 v198, v10, v130
    v_fmac_f32 v198, v11, v131
    v_fmac_f32 v198, v12, v132
    v_fmac_f32 v198, v13, v133
    v_fmac_f32 v198, v14, v134
    v_fmac_f32 v198, v15, v135
    v_mul_f32 v200, v16, v128
    v_fmac_f32 v200, v17, v129
    v_permlane32_swap_b32 v196, v198
    v_mfma_f32_32x32x8_bf16 v[32:47], v[72:73], v[184:185], v[32:47]
    v_fmac_f32 v200, v18, v130
    v_fmac_f32 v200, v19, v131
    v_fmac_f32 v200, v20, v132
    v_fmac_f32 v200, v21, v133
    v_fmac_f32 v200, v22, v134
    v_fmac_f32 v200, v23, v135
    v_add_f32 v198, v196, v198
    v_mul_f32_e64 v202, v24, -v128
    v_fma_f32 v202, v25, -v129, v202
    v_mfma_f32_32x32x8_bf16 v[48:63], v[76:77], v[184:185], v[48:63]
    v_fma_f32 v202, v26, -v130, v202
    v_fma_f32 v202, v27, -v131, v202
    v_fma_f32 v202, v28, -v132, v202
    v_fma_f32 v202, v29, -v133, v202
    v_fma_f32 v202, v30, -v134, v202
    v_fma_f32 v202, v31, -v135, v202
    s_nop 1
    v_permlane32_swap_b32 v200, v202
    v_add_f32 v202, v200, v202
    s_waitcnt vmcnt(3) lgkmcnt(0)
    v_mfma_f32_32x32x16_bf16 v[0:15], v[64:67], v[176:179], 0
    v_mul_f32 v197, v32, v104
    v_fmac_f32 v197, v33, v105
    v_fmac_f32 v197, v34, v106
    v_fmac_f32 v197, v35, v107
    v_fmac_f32 v197, v36, v108
    v_fmac_f32 v197, v37, v109
    v_fmac_f32 v197, v38, v110
    v_fmac_f32 v197, v39, v111
    v_mul_f32 v199, v40, v136
    v_fmac_f32 v199, v41, v137
    v_fmac_f32 v199, v42, v138
    s_add_u32 m0, s21, 4096
    v_mfma_f32_32x32x16_bf16 v[16:31], v[68:71], v[176:179], 0
    buffer_load_dwordx4 v234, s[4:7], s37 offen lds
    buffer_load_dwordx4 v235, s[8:11], s37 offen offset:1024 lds
    ds_read_b64_tr_b16 v[176:177], v244 offset:6144
    ds_read_b64_tr_b16 v[184:185], v245 offset:6144
    v_add_u32 v252, s42, v247
    ds_read_u16 v234, v252
    ds_read_u16 v235, v252 offset:64
    v_fmac_f32 v199, v43, v139
    v_fmac_f32 v199, v44, v140
    v_fmac_f32 v199, v45, v141
    v_fmac_f32 v199, v46, v142
    v_fmac_f32 v199, v47, v143
    v_mul_f32 v201, v48, v136
    v_fmac_f32 v201, v49, v137
    v_permlane32_swap_b32 v197, v199
    v_fmac_f32 v201, v50, v138
    v_fmac_f32 v201, v51, v139
    s_waitcnt lgkmcnt(2)
    v_mfma_f32_32x32x8_bf16 v[0:15], v[72:73], v[176:177], v[0:15]
    v_fmac_f32 v201, v52, v140
    v_fmac_f32 v201, v53, v141
    v_fmac_f32 v201, v54, v142
    v_fmac_f32 v201, v55, v143
    v_add_f32 v199, v197, v199
    v_mul_f32_e64 v203, v56, -v136
    v_fma_f32 v203, v57, -v137, v203
    v_fma_f32 v203, v58, -v138, v203
    v_fma_f32 v203, v59, -v139, v203
    v_fma_f32 v203, v60, -v140, v203
    s_add_u32 m0, s21, 6144
    v_mfma_f32_32x32x8_bf16 v[16:31], v[76:77], v[176:177], v[16:31]
    buffer_load_dwordx4 v236, s[4:7], s37 offen lds
    v_add_u32 v252, s43, v247
    ds_read_u16 v236, v252
    ds_read_u16 v237, v252 offset:64
    v_fma_f32 v203, v61, -v141, v203
    v_fma_f32 v203, v62, -v142, v203
    v_fma_f32 v203, v63, -v143, v203
    s_nop 1
    v_permlane32_swap_b32 v201, v203
    v_add_f32 v203, v201, v203
    v_cvt_pk_bf16_f32 v198, v198, v199
    v_cvt_pk_bf16_f32 v202, v202, v203
    ds_write_b32 v253, v198 offset:0
    ds_write_b32 v253, v202 offset:256
    v_mfma_f32_32x32x16_bf16 v[32:47], v[64:67], v[180:183], 0
    v_mul_f32 v196, v0, v144
    v_fmac_f32 v196, v1, v145
    v_fmac_f32 v196, v2, v146
    v_fmac_f32 v196, v3, v147
    v_fmac_f32 v196, v4, v148
    v_fmac_f32 v196, v5, v149
    v_fmac_f32 v196, v6, v150
    v_fmac_f32 v196, v7, v151
    v_mfma_f32_32x32x16_bf16 v[48:63], v[68:71], v[180:183], 0
    s_waitcnt vmcnt(4)
    ds_read_b64_tr_b16 v[176:177], v244 offset:0
    ds_read_b64_tr_b16 v[178:179], v244 offset:1024
    ds_read_b64_tr_b16 v[180:181], v245 offset:0
    ds_read_b64_tr_b16 v[182:183], v245 offset:1024
    v_mul_f32 v198, v8, v112
    v_fmac_f32 v198, v9, v113
    v_fmac_f32 v198, v10, v114
    v_fmac_f32 v198, v11, v115
    v_fmac_f32 v198, v12, v116
    v_fmac_f32 v198, v13, v117
    v_fmac_f32 v198, v14, v118
    v_fmac_f32 v198, v15, v119
    v_mfma_f32_32x32x8_bf16 v[32:47], v[72:73], v[184:185], v[32:47]
    v_mul_f32_e64 v200, v16, -v160
    v_fma_f32 v200, v17, -v161, v200
    v_fma_f32 v200, v18, -v162, v200
    v_fma_f32 v200, v19, -v163, v200
    v_fma_f32 v200, v20, -v164, v200
    v_fma_f32 v200, v21, -v165, v200
    v_fma_f32 v200, v22, -v166, v200
    v_fma_f32 v200, v23, -v167, v200
    v_mfma_f32_32x32x8_bf16 v[48:63], v[76:77], v[184:185], v[48:63]
    v_mul_f32_e64 v202, v24, -v160
    v_fma_f32 v202, v25, -v161, v202
    v_fma_f32 v202, v26, -v162, v202
    v_fma_f32 v202, v27, -v163, v202
    v_fma_f32 v202, v28, -v164, v202
    v_fma_f32 v202, v29, -v165, v202
    v_fma_f32 v202, v30, -v166, v202
    v_fma_f32 v202, v31, -v167, v202
    s_waitcnt vmcnt(3) lgkmcnt(0)
    v_mfma_f32_32x32x16_bf16 v[0:15], v[64:67], v[176:179], 0
    v_mul_f32 v197, v32, v152
    v_fmac_f32 v197, v33, v153
    v_fmac_f32 v197, v34, v154
    v_fmac_f32 v197, v35, v155
    v_fmac_f32 v197, v36, v156
    v_fmac_f32 v197, v37, v157
    v_fmac_f32 v197, v38, v158
    v_fmac_f32 v197, v39, v159
    s_add_u32 m0, s21, 0
    v_mfma_f32_32x32x16_bf16 v[16:31], v[68:71], v[176:179], 0
    v_lshl_add_u32 v234, v234, 10, v246
    v_lshl_add_u32 v235, v235, 10, v246
    buffer_load_dwordx4 v234, s[4:7], s38 offen lds
    buffer_load_dwordx4 v235, s[8:11], s38 offen offset:1024 lds
    ds_read_b64_tr_b16 v[176:177], v244 offset:2048
    ds_read_b64_tr_b16 v[184:185], v245 offset:2048
    v_mul_f32 v199, v40, v120
    v_fmac_f32 v199, v41, v121
    v_fmac_f32 v199, v42, v122
    v_fmac_f32 v199, v43, v123
    v_fmac_f32 v199, v44, v124
    v_fmac_f32 v199, v45, v125
    v_fmac_f32 v199, v46, v126
    v_fmac_f32 v199, v47, v127
    s_waitcnt lgkmcnt(0)
    v_mfma_f32_32x32x8_bf16 v[0:15], v[72:73], v[176:177], v[0:15]
    v_mul_f32_e64 v201, v48, -v168
    v_fma_f32 v201, v49, -v169, v201
    v_fma_f32 v201, v50, -v170, v201
    v_fma_f32 v201, v51, -v171, v201
    v_fma_f32 v201, v52, -v172, v201
    v_fma_f32 v201, v53, -v173, v201
    v_fma_f32 v201, v54, -v174, v201
    v_fma_f32 v201, v55, -v175, v201
    s_add_u32 m0, s21, 2048
    v_mfma_f32_32x32x8_bf16 v[16:31], v[76:77], v[176:177], v[16:31]
    v_lshl_add_u32 v236, v236, 10, v246
    v_lshl_add_u32 v237, v237, 10, v246
    buffer_load_dwordx4 v236, s[4:7], s39 offen lds
    buffer_load_dwordx4 v237, s[8:11], s39 offen offset:1024 lds
    v_mul_f32_e64 v203, v56, -v168
    v_fma_f32 v203, v57, -v169, v203
    v_fma_f32 v203, v58, -v170, v203
    v_fma_f32 v203, v59, -v171, v203
    v_fma_f32 v203, v60, -v172, v203
    v_fma_f32 v203, v61, -v173, v203
    v_fma_f32 v203, v62, -v174, v203
    v_fma_f32 v203, v63, -v175, v203
    v_mfma_f32_32x32x16_bf16 v[32:47], v[64:67], v[180:183], 0
    v_mul_f32 v254, v0, v144
    v_fmac_f32 v254, v1, v145
    v_fmac_f32 v254, v2, v146
    v_fmac_f32 v254, v3, v147
    v_fmac_f32 v254, v4, v148
    v_mfma_f32_32x32x16_bf16 v[48:63], v[68:71], v[180:183], 0
    ds_swizzle_b32 v68, v68 offset:0x401F
    ds_swizzle_b32 v69, v69 offset:0x401F
    ds_swizzle_b32 v70, v70 offset:0x401F
    ds_swizzle_b32 v71, v71 offset:0x401F
    s_waitcnt vmcnt(5)
    ds_read_b64_tr_b16 v[176:177], v244 offset:4096
    ds_read_b64_tr_b16 v[178:179], v244 offset:5120
    ds_read_b64_tr_b16 v[180:181], v245 offset:4096
    ds_read_b64_tr_b16 v[182:183], v245 offset:5120
    v_fmac_f32 v254, v5, v149
    v_fmac_f32 v254, v6, v150
    v_fmac_f32 v254, v7, v151
    v_fmac_f32 v200, v8, v160
    v_mfma_f32_32x32x8_bf16 v[32:47], v[72:73], v[184:185], v[32:47]
    v_fmac_f32 v200, v9, v161
    v_permlane32_swap_b32 v196, v254
    v_fmac_f32 v200, v10, v162
    v_fmac_f32 v200, v11, v163
    v_fmac_f32 v200, v12, v164
    v_mfma_f32_32x32x8_bf16 v[48:63], v[76:77], v[184:185], v[48:63]
    ds_swizzle_b32 v76, v76 offset:0x401F
    ds_swizzle_b32 v77, v77 offset:0x401F
    v_fmac_f32 v200, v13, v165
    v_fmac_f32 v200, v14, v166
    v_fmac_f32 v200, v15, v167
    v_add_f32 v254, v196, v254
    s_waitcnt lgkmcnt(6)
    s_mov_b64 exec, s[56:57]
    v_xor_b32 v68, 0x80008000, v68
    v_xor_b32 v69, 0x80008000, v69
    v_xor_b32 v70, 0x80008000, v70
    v_xor_b32 v71, 0x80008000, v71
    s_mov_b64 exec, -1
    s_waitcnt vmcnt(4) lgkmcnt(2)
    v_mfma_f32_32x32x16_bf16 v[0:15], v[64:67], v[176:179], 0
    v_mul_f32 v255, v32, v152
    v_fmac_f32 v255, v33, v153
    v_fmac_f32 v255, v34, v154
    v_fmac_f32 v255, v35, v155
    v_fmac_f32 v255, v36, v156
    s_add_u32 m0, s21, 4096
    v_mfma_f32_32x32x16_bf16 v[16:31], v[68:71], v[176:179], v[16:31]
    v_lshl_add_u32 v238, v238, 10, v246
    v_lshl_add_u32 v239, v239, 10, v246
    buffer_load_dwordx4 v238, s[4:7], s40 offen lds
    buffer_load_dwordx4 v239, s[8:11], s40 offen offset:1024 lds
    ds_read_b64_tr_b16 v[176:177], v244 offset:6144
    ds_read_b64_tr_b16 v[184:185], v245 offset:6144
    v_fmac_f32 v255, v37, v157
    v_fmac_f32 v255, v38, v158
    v_fmac_f32 v255, v39, v159
    v_fmac_f32 v201, v40, v168
    v_fmac_f32 v201, v41, v169
    s_waitcnt lgkmcnt(0)
    s_mov_b64 exec, s[56:57]
    v_xor_b32 v76, 0x80008000, v76
    v_xor_b32 v77, 0x80008000, v77
    s_mov_b64 exec, -1
    v_mfma_f32_32x32x8_bf16 v[0:15], v[72:73], v[176:177], v[0:15]
    v_permlane32_swap_b32 v197, v255
    v_fmac_f32 v201, v42, v170
    v_fmac_f32 v201, v43, v171
    v_fmac_f32 v201, v44, v172
    v_fmac_f32 v201, v45, v173
    s_add_u32 m0, s21, 6144
    v_mfma_f32_32x32x8_bf16 v[16:31], v[76:77], v[176:177], v[16:31]
    v_lshl_add_u32 v240, v240, 10, v246
    v_lshl_add_u32 v241, v241, 10, v246
    buffer_load_dwordx4 v240, s[4:7], s41 offen lds
    buffer_load_dwordx4 v241, s[8:11], s41 offen offset:1024 lds
    v_fmac_f32 v201, v46, v174
    v_fmac_f32 v201, v47, v175
    v_add_f32 v255, v197, v255
    v_cvt_pk_bf16_f32 v254, v254, v255
    ds_write_b32 v253, v254 offset:512
    v_mfma_f32_32x32x16_bf16 v[32:47], v[64:67], v[180:183], 0
    v_mul_f32 v254, v0, v144
    v_fmac_f32 v254, v1, v145
    v_fmac_f32 v254, v2, v146
    v_fmac_f32 v254, v3, v147
    v_fmac_f32 v254, v4, v148
    v_fmac_f32 v254, v5, v149
    v_fmac_f32 v254, v6, v150
    v_fmac_f32 v254, v7, v151
    v_fma_f32 v202, v8, -v160, v202
    v_fma_f32 v202, v9, -v161, v202
    v_mfma_f32_32x32x16_bf16 v[48:63], v[68:71], v[180:183], v[48:63]
    s_waitcnt vmcnt(6)
    ds_read_b64_tr_b16 v[176:177], v244 offset:0
    ds_read_b64_tr_b16 v[178:179], v244 offset:1024
    ds_read_b64_tr_b16 v[180:181], v245 offset:0
    ds_read_b64_tr_b16 v[182:183], v245 offset:1024
    v_permlane32_swap_b32 v254, v200
    v_fma_f32 v202, v10, -v162, v202
    v_fma_f32 v202, v11, -v163, v202
    v_fma_f32 v202, v12, -v164, v202
    v_fma_f32 v202, v13, -v165, v202
    v_fma_f32 v202, v14, -v166, v202
    v_fma_f32 v202, v15, -v167, v202
    v_add_f32 v200, v254, v200
    v_fmac_f32 v198, v16, v112
    v_permlane32_swap_b32 v202, v254
    v_mfma_f32_32x32x8_bf16 v[32:47], v[72:73], v[184:185], v[32:47]
    v_fmac_f32 v198, v17, v113
    v_fmac_f32 v198, v18, v114
    v_fmac_f32 v198, v19, v115
    v_fmac_f32 v198, v20, v116
    v_fmac_f32 v198, v21, v117
    v_fmac_f32 v198, v22, v118
    v_fmac_f32 v198, v23, v119
    v_add_f32 v254, v202, v254
    v_mul_f32 v196, v24, v160
    v_fmac_f32 v196, v25, v161
    v_mfma_f32_32x32x8_bf16 v[48:63], v[76:77], v[184:185], v[48:63]
    v_add_u32 v249, s48, v249
    v_add_u32 v250, s49, v250
    ds_read_b32 v252, v251 offset:16
    ds_read_b64_tr_b16 v[64:65], v249 offset:0
    ds_read_b64_tr_b16 v[68:69], v249 offset:64
    ds_read_b64_tr_b16 v[66:67], v249 offset:256
    ds_read_b64_tr_b16 v[70:71], v249 offset:320
    s_mov_b64 exec, s[54:55]
    ds_read_u16_d16_hi v242, v250 offset:0
    s_mov_b64 exec, -1
    v_fmac_f32 v196, v26, v162
    v_fmac_f32 v196, v27, v163
    v_fmac_f32 v196, v28, v164
    v_fmac_f32 v196, v29, v165
    v_fmac_f32 v196, v30, v166
    v_fmac_f32 v196, v31, v167
    s_nop 1
    v_permlane32_swap_b32 v198, v196
    v_add_f32 v196, v198, v196
    v_mul_f32 v255, v32, v152
    v_fmac_f32 v255, v33, v153
    v_fmac_f32 v255, v34, v154
    v_fmac_f32 v255, v35, v155
    v_fmac_f32 v255, v36, v156
    v_fmac_f32 v255, v37, v157
    v_fmac_f32 v255, v38, v158
    v_fmac_f32 v255, v39, v159
    v_fma_f32 v203, v40, -v168, v203
    v_fma_f32 v203, v41, -v169, v203
    v_permlane32_swap_b32 v255, v201
    v_fma_f32 v203, v42, -v170, v203
    v_fma_f32 v203, v43, -v171, v203
    v_fma_f32 v203, v44, -v172, v203
    v_fma_f32 v203, v45, -v173, v203
    v_fma_f32 v203, v46, -v174, v203
    v_fma_f32 v203, v47, -v175, v203
    v_add_f32 v201, v255, v201
    v_fmac_f32 v199, v48, v120
    v_permlane32_swap_b32 v203, v255
    v_fmac_f32 v199, v49, v121
    v_fmac_f32 v199, v50, v122
    v_fmac_f32 v199, v51, v123
    v_fmac_f32 v199, v52, v124
    v_fmac_f32 v199, v53, v125
    v_fmac_f32 v199, v54, v126
    v_fmac_f32 v199, v55, v127
    v_add_f32 v255, v203, v255
    v_mul_f32 v197, v56, v168
    v_fmac_f32 v197, v57, v169
    v_fmac_f32 v197, v58, v170
    v_fmac_f32 v197, v59, v171
    v_fmac_f32 v197, v60, v172
    v_fmac_f32 v197, v61, v173
    v_fmac_f32 v197, v62, v174
    v_fmac_f32 v197, v63, v175
    s_nop 1
    v_permlane32_swap_b32 v199, v197
    v_add_f32 v197, v199, v197
    v_cvt_pk_bf16_f32 v200, v200, v201
    v_cvt_pk_bf16_f32 v254, v254, v255
    v_cvt_pk_bf16_f32 v196, v196, v197
    ds_write_b32 v253, v200 offset:768
    s_mov_b64 exec, 0xffffffff
    ds_write_b32 v253, v254 offset:1280
    s_mov_b64 exec, -1
    ds_write_b32 v253, v196 offset:1024
    s_add_u32 s50, s50, 1
    s_cmp_ge_u32 s50, 5
    s_cbranch_scc1 TAIL
    s_waitcnt lgkmcnt(8)
    v_readfirstlane_b32 s66, v252
    s_add_u32 s53, s53, 1
    v_mov_b32 v252, s53
    s_cmp_le_u32 s53, s66
    ds_write2_b32 v251, v252, v252 offset0:0 offset1:8
    s_setprio 1
    s_cbranch_scc1 PRIO_12
    s_setprio 0
PRIO_12:
    s_cmp_eq_u32 s52, 4
    s_cbranch_scc1 ITEM_1_4
    s_cmp_eq_u32 s52, 5
    s_cbranch_scc1 ITEM_1_5
    s_cmp_eq_u32 s52, 3
    s_cbranch_scc1 ITEM_1_3
    s_cmp_eq_u32 s52, 6
    s_cbranch_scc1 ITEM_1_6
    s_cmp_eq_u32 s52, 8
    s_cbranch_scc1 ITEM_1_8
    s_branch ITEM_1_2
.p2align 6
ITEM_1_6:
    s_mov_b64 exec, s[54:55]
    ds_read_u16_d16_hi v243, v250 offset:128
    s_mov_b64 exec, -1
    ds_read_b64_tr_b16 v[72:73], v249 offset:512
    ds_read_b64_tr_b16 v[76:77], v249 offset:576
    ds_read_b64_tr_b16 v[74:75], v249 offset:768
    ds_read_b64_tr_b16 v[78:79], v249 offset:832
    ds_read_b64_tr_b16 v[80:81], v249 offset:1024
    ds_read_b64_tr_b16 v[84:85], v249 offset:1088
    ds_read_b64_tr_b16 v[82:83], v249 offset:1280
    ds_read_b64_tr_b16 v[86:87], v249 offset:1344
    s_waitcnt lgkmcnt(9)
    v_mul_f32_dpp v196, v242, v64 row_newbcast:0 row_mask:0xf bank_mask:0xf
    v_mul_f32_dpp v197, v242, v65 row_newbcast:1 row_mask:0xf bank_mask:0xf
    v_mul_f32_dpp v198, v242, v64 row_newbcast:8 row_mask:0xf bank_mask:0xf
    v_mul_f32_dpp v199, v242, v65 row_newbcast:9 row_mask:0xf bank_mask:0xf
    v_mul_f32_dpp v200, v242, v68 row_newbcast:2 row_mask:0xf bank_mask:0xf
    v_mul_f32_dpp v201, v242, v69 row_newbcast:3 row_mask:0xf bank_mask:0xf
    v_mul_f32_dpp v202, v242, v68 row_newbcast:10 row_mask:0xf bank_mask:0xf
    v_mul_f32_dpp v203, v242, v69 row_newbcast:11 row_mask:0xf bank_mask:0xf
    v_cvt_pk_bf16_f32 v64, v196, v197
    v_cvt_pk_bf16_f32 v68, v198, v199
    v_cvt_pk_bf16_f32 v65, v200, v201
    v_cvt_pk_bf16_f32 v69, v202, v203
    v_mul_f32_dpp v196, v242, v66 row_newbcast:4 row_mask:0xf bank_mask:0xf
    v_mul_f32_dpp v197, v242, v67 row_newbcast:5 row_mask:0xf bank_mask:0xf
    v_mul_f32_dpp v198, v242, v66 row_newbcast:12 row_mask:0xf bank_mask:0xf
    v_mul_f32_dpp v199, v242, v67 row_newbcast:13 row_mask:0xf bank_mask:0xf
    v_mul_f32_dpp v200, v242, v70 row_newbcast:6 row_mask:0xf bank_mask:0xf
    v_mul_f32_dpp v201, v242, v71 row_newbcast:7 row_mask:0xf bank_mask:0xf
    v_mul_f32_dpp v202, v242, v70 row_newbcast:14 row_mask:0xf bank_mask:0xf
    v_mul_f32_dpp v203, v242, v71 row_newbcast:15 row_mask:0xf bank_mask:0xf
    v_cvt_pk_bf16_f32 v66, v196, v197
    v_cvt_pk_bf16_f32 v70, v198, v199
    v_cvt_pk_bf16_f32 v67, v200, v201
    v_cvt_pk_bf16_f32 v71, v202, v203
    s_mov_b64 exec, s[54:55]
    ds_read_u16_d16_hi v242, v250 offset:256
    s_mov_b64 exec, -1
    s_waitcnt vmcnt(4) lgkmcnt(5)
    v_mfma_f32_32x32x16_bf16 v[0:15], v[64:67], v[176:179], 0
    v_mul_f32_dpp v196, v243, v72 row_newbcast:0 row_mask:0xf bank_mask:0xf
    v_mul_f32_dpp v197, v243, v73 row_newbcast:1 row_mask:0xf bank_mask:0xf
    v_mul_f32_dpp v198, v243, v72 row_newbcast:8 row_mask:0xf bank_mask:0xf
    v_mul_f32_dpp v199, v243, v73 row_newbcast:9 row_mask:0xf bank_mask:0xf
    v_mul_f32_dpp v200, v243, v76 row_newbcast:2 row_mask:0xf bank_mask:0xf
    v_mul_f32_dpp v201, v243, v77 row_newbcast:3 row_mask:0xf bank_mask:0xf
    v_mul_f32_dpp v202, v243, v76 row_newbcast:10 row_mask:0xf bank_mask:0xf
    v_mul_f32_dpp v203, v243, v77 row_newbcast:11 row_mask:0xf bank_mask:0xf
    v_cvt_pk_bf16_f32 v72, v196, v197
    v_cvt_pk_bf16_f32 v76, v198, v199
    v_cvt_pk_bf16_f32 v73, v200, v201
    v_cvt_pk_bf16_f32 v77, v202, v203
    s_add_u32 m0, s21, 0
    v_mfma_f32_32x32x16_bf16 v[16:31], v[68:71], v[176:179], 0
    buffer_load_dwordx4 v236, s[4:7], s35 offen lds
    buffer_load_dwordx4 v237, s[8:11], s35 offen offset:1024 lds
    ds_read_b64_tr_b16 v[176:177], v244 offset:2048
    ds_read_b64_tr_b16 v[178:179], v244 offset:3072
    ds_read_b64_tr_b16 v[184:185], v245 offset:2048
    ds_read_b64_tr_b16 v[186:187], v245 offset:3072
    v_mul_f32_dpp v196, v243, v74 row_newbcast:4 row_mask:0xf bank_mask:0xf
    v_mul_f32_dpp v197, v243, v75 row_newbcast:5 row_mask:0xf bank_mask:0xf
    v_mul_f32_dpp v198, v243, v74 row_newbcast:12 row_mask:0xf bank_mask:0xf
    v_mul_f32_dpp v199, v243, v75 row_newbcast:13 row_mask:0xf bank_mask:0xf
    v_mul_f32_dpp v200, v243, v78 row_newbcast:6 row_mask:0xf bank_mask:0xf
    v_mul_f32_dpp v201, v243, v79 row_newbcast:7 row_mask:0xf bank_mask:0xf
    v_mul_f32_dpp v202, v243, v78 row_newbcast:14 row_mask:0xf bank_mask:0xf
    v_mul_f32_dpp v203, v243, v79 row_newbcast:15 row_mask:0xf bank_mask:0xf
    v_cvt_pk_bf16_f32 v74, v196, v197
    v_cvt_pk_bf16_f32 v78, v198, v199
    v_cvt_pk_bf16_f32 v75, v200, v201
    v_cvt_pk_bf16_f32 v79, v202, v203
    s_nop 0
    s_waitcnt vmcnt(4) lgkmcnt(0)
    v_mfma_f32_32x32x16_bf16 v[0:15], v[72:75], v[176:179], v[0:15]
    v_mul_f32_dpp v196, v242, v80 row_newbcast:0 row_mask:0xf bank_mask:0xf
    v_mul_f32_dpp v197, v242, v81 row_newbcast:1 row_mask:0xf bank_mask:0xf
    v_mul_f32_dpp v198, v242, v80 row_newbcast:8 row_mask:0xf bank_mask:0xf
    v_mul_f32_dpp v199, v242, v81 row_newbcast:9 row_mask:0xf bank_mask:0xf
    v_mul_f32_dpp v200, v242, v84 row_newbcast:2 row_mask:0xf bank_mask:0xf
    v_mul_f32_dpp v201, v242, v85 row_newbcast:3 row_mask:0xf bank_mask:0xf
    v_mul_f32_dpp v202, v242, v84 row_newbcast:10 row_mask:0xf bank_mask:0xf
    v_mul_f32_dpp v203, v242, v85 row_newbcast:11 row_mask:0xf bank_mask:0xf
    v_cvt_pk_bf16_f32 v80, v196, v197
    v_cvt_pk_bf16_f32 v84, v198, v199
    v_cvt_pk_bf16_f32 v81, v200, v201
    v_cvt_pk_bf16_f32 v85, v202, v203
    s_add_u32 m0, s21, 2048
    v_mfma_f32_32x32x16_bf16 v[16:31], v[76:79], v[176:179], v[16:31]
    buffer_load_dwordx4 v238, s[4:7], s35 offen lds
    buffer_load_dwordx4 v239, s[8:11], s35 offen offset:1024 lds
    ds_read_b64_tr_b16 v[176:177], v244 offset:4096
    ds_read_b64_tr_b16 v[178:179], v244 offset:5120
    ds_read_b64_tr_b16 v[188:189], v245 offset:4096
    ds_read_b64_tr_b16 v[190:191], v245 offset:5120
    v_mul_f32_dpp v196, v242, v82 row_newbcast:4 row_mask:0xf bank_mask:0xf
    v_mul_f32_dpp v197, v242, v83 row_newbcast:5 row_mask:0xf bank_mask:0xf
    v_mul_f32_dpp v198, v242, v82 row_newbcast:12 row_mask:0xf bank_mask:0xf
    v_mul_f32_dpp v199, v242, v83 row_newbcast:13 row_mask:0xf bank_mask:0xf
    v_mul_f32_dpp v200, v242, v86 row_newbcast:6 row_mask:0xf bank_mask:0xf
    v_mul_f32_dpp v201, v242, v87 row_newbcast:7 row_mask:0xf bank_mask:0xf
    v_mul_f32_dpp v202, v242, v86 row_newbcast:14 row_mask:0xf bank_mask:0xf
    v_mul_f32_dpp v203, v242, v87 row_newbcast:15 row_mask:0xf bank_mask:0xf
    v_cvt_pk_bf16_f32 v82, v196, v197
    v_cvt_pk_bf16_f32 v86, v198, v199
    v_cvt_pk_bf16_f32 v83, v200, v201
    v_cvt_pk_bf16_f32 v87, v202, v203
    s_nop 0
    s_waitcnt lgkmcnt(0)
    v_mfma_f32_32x32x16_bf16 v[0:15], v[80:83], v[176:179], v[0:15]
    s_add_u32 m0, s21, 4096
    v_mfma_f32_32x32x16_bf16 v[16:31], v[84:87], v[176:179], v[16:31]
    buffer_load_dwordx4 v234, s[4:7], s36 offen lds
    buffer_load_dwordx4 v235, s[8:11], s36 offen offset:1024 lds
    s_mov_b32 m0, s50
    s_nop 0
    s_movrels_b32 s71, s23
    s_movrels_b32 s33, s28
    s_and_b32 s70, s33, 0x70
    s_andn2_b32 s33, s33, 0x70
    v_xor_b32 v253, s70, v248
    v_add_u32 v253, s33, v253
    s_bfe_u32 s46, s71, 0x30012
    s_mov_b32 m0, s46
    s_and_b32 s66, s71, 0x3ffff
    s_movrels_b32 s68, s57
    s_movrels_b32 s69, s61
    s_sub_u32 s48, s66, s47
    s_mov_b32 s47, s66
    s_lshr_b32 s52, s71, 28
    s_lshl_b32 s67, s46, 9
    s_add_u32 s66, s66, s67
    s_sub_u32 s49, s66, s42
    s_mov_b32 s42, s66
    s_bfe_u32 s66, s68, 655360
    s_add_u32 s43, s42, s66
    s_bfe_u32 s39, s69, 655360
    s_bfe_u32 s66, s68, 655370
    s_add_u32 s44, s42, s66
    s_bfe_u32 s40, s69, 655370
    s_bfe_u32 s66, s68, 655380
    s_add_u32 s45, s42, s66
    s_bfe_u32 s41, s69, 655380
    v_add_u32 v252, s45, v247
    ds_read_u16 v240, v252
    ds_read_u16 v241, v252 offset:64
    v_mfma_f32_32x32x16_bf16 v[32:47], v[64:67], v[180:183], 0
    v_mul_f32 v196, v0, v96
    v_fmac_f32 v196, v1, v97
    v_fmac_f32 v196, v2, v98
    v_fmac_f32 v196, v3, v99
    v_fmac_f32 v196, v4, v100
    v_fmac_f32 v196, v5, v101
    v_fmac_f32 v196, v6, v102
    v_mfma_f32_32x32x16_bf16 v[48:63], v[68:71], v[180:183], 0
    v_fmac_f32 v196, v7, v103
    v_mul_f32 v198, v8, v128
    v_fmac_f32 v198, v9, v129
    v_fmac_f32 v198, v10, v130
    v_fmac_f32 v198, v11, v131
    v_fmac_f32 v198, v12, v132
    v_mfma_f32_32x32x16_bf16 v[32:47], v[72:75], v[184:187], v[32:47]
    v_fmac_f32 v198, v13, v133
    v_fmac_f32 v198, v14, v134
    v_fmac_f32 v198, v15, v135
    v_mul_f32 v200, v16, v128
    v_fmac_f32 v200, v17, v129
    v_permlane32_swap_b32 v196, v198
    v_mfma_f32_32x32x16_bf16 v[48:63], v[76:79], v[184:187], v[48:63]
    s_waitcnt vmcnt(6)
    ds_read_b64_tr_b16 v[176:177], v244 offset:6144
    ds_read_b64_tr_b16 v[178:179], v244 offset:7168
    ds_read_b64_tr_b16 v[180:181], v245 offset:6144
    ds_read_b64_tr_b16 v[182:183], v245 offset:7168
    v_fmac_f32 v200, v18, v130
    v_fmac_f32 v200, v19, v131
    v_fmac_f32 v200, v20, v132
    v_fmac_f32 v200, v21, v133
    v_fmac_f32 v200, v22, v134
    v_fmac_f32 v200, v23, v135
    v_mfma_f32_32x32x16_bf16 v[32:47], v[80:83], v[188:191], v[32:47]
    v_add_f32 v198, v196, v198
    v_mul_f32_e64 v202, v24, -v128
    v_fma_f32 v202, v25, -v129, v202
    v_fma_f32 v202, v26, -v130, v202
    v_fma_f32 v202, v27, -v131, v202
    v_fma_f32 v202, v28, -v132, v202
    v_mfma_f32_32x32x16_bf16 v[48:63], v[84:87], v[188:191], v[48:63]
    v_fma_f32 v202, v29, -v133, v202
    v_fma_f32 v202, v30, -v134, v202
    v_fma_f32 v202, v31, -v135, v202
    s_nop 1
    v_permlane32_swap_b32 v200, v202
    v_add_f32 v202, v200, v202
    s_waitcnt vmcnt(4) lgkmcnt(0)
    v_mfma_f32_32x32x16_bf16 v[0:15], v[64:67], v[176:179], 0
    v_mul_f32 v197, v32, v104
    v_fmac_f32 v197, v33, v105
    v_fmac_f32 v197, v34, v106
    v_fmac_f32 v197, v35, v107
    v_fmac_f32 v197, v36, v108
    v_fmac_f32 v197, v37, v109
    v_fmac_f32 v197, v38, v110
    s_add_u32 m0, s21, 6144
    v_mfma_f32_32x32x16_bf16 v[16:31], v[68:71], v[176:179], 0
    buffer_load_dwordx4 v236, s[4:7], s36 offen lds
    buffer_load_dwordx4 v237, s[8:11], s36 offen offset:1024 lds
    ds_read_b64_tr_b16 v[176:177], v244 offset:0
    ds_read_b64_tr_b16 v[178:179], v244 offset:1024
    ds_read_b64_tr_b16 v[184:185], v245 offset:0
    ds_read_b64_tr_b16 v[186:187], v245 offset:1024
    v_fmac_f32 v197, v39, v111
    v_mul_f32 v199, v40, v136
    v_fmac_f32 v199, v41, v137
    v_fmac_f32 v199, v42, v138
    v_fmac_f32 v199, v43, v139
    v_fmac_f32 v199, v44, v140
    v_fmac_f32 v199, v45, v141
    s_waitcnt vmcnt(4) lgkmcnt(0)
    v_mfma_f32_32x32x16_bf16 v[0:15], v[72:75], v[176:179], v[0:15]
    v_fmac_f32 v199, v46, v142
    v_fmac_f32 v199, v47, v143
    v_mul_f32 v201, v48, v136
    v_fmac_f32 v201, v49, v137
    v_permlane32_swap_b32 v197, v199
    v_fmac_f32 v201, v50, v138
    v_fmac_f32 v201, v51, v139
    s_add_u32 m0, s21, 0
    v_mfma_f32_32x32x16_bf16 v[16:31], v[76:79], v[176:179], v[16:31]
    buffer_load_dwordx4 v238, s[4:7], s36 offen lds
    buffer_load_dwordx4 v239, s[8:11], s36 offen offset:1024 lds
    ds_read_b64_tr_b16 v[176:177], v244 offset:2048
    ds_read_b64_tr_b16 v[178:179], v244 offset:3072
    ds_read_b64_tr_b16 v[188:189], v245 offset:2048
    ds_read_b64_tr_b16 v[190:191], v245 offset:3072
    v_fmac_f32 v201, v52, v140
    v_fmac_f32 v201, v53, v141
    v_fmac_f32 v201, v54, v142
    v_fmac_f32 v201, v55, v143
    v_add_f32 v199, v197, v199
    v_mul_f32_e64 v203, v56, -v136
    v_fma_f32 v203, v57, -v137, v203
    s_waitcnt lgkmcnt(0)
    v_mfma_f32_32x32x16_bf16 v[0:15], v[80:83], v[176:179], v[0:15]
    v_fma_f32 v203, v58, -v138, v203
    v_fma_f32 v203, v59, -v139, v203
    v_fma_f32 v203, v60, -v140, v203
    v_fma_f32 v203, v61, -v141, v203
    v_fma_f32 v203, v62, -v142, v203
    v_fma_f32 v203, v63, -v143, v203
    s_nop 1
    s_add_u32 m0, s21, 2048
    v_mfma_f32_32x32x16_bf16 v[16:31], v[84:87], v[176:179], v[16:31]
    buffer_load_dwordx4 v234, s[4:7], s37 offen lds
    buffer_load_dwordx4 v235, s[8:11], s37 offen offset:1024 lds
    v_add_u32 v252, s42, v247
    ds_read_u16 v234, v252
    ds_read_u16 v235, v252 offset:64
    v_permlane32_swap_b32 v201, v203
    v_add_f32 v203, v201, v203
    v_cvt_pk_bf16_f32 v198, v198, v199
    v_cvt_pk_bf16_f32 v202, v202, v203
    ds_write_b32 v253, v198 offset:0
    ds_write_b32 v253, v202 offset:256
    v_mfma_f32_32x32x16_bf16 v[32:47], v[64:67], v[180:183], 0
    v_mul_f32 v196, v0, v144
    v_fmac_f32 v196, v1, v145
    v_fmac_f32 v196, v2, v146
    v_fmac_f32 v196, v3, v147
    v_fmac_f32 v196, v4, v148
    v_fmac_f32 v196, v5, v149
    v_mfma_f32_32x32x16_bf16 v[48:63], v[68:71], v[180:183], 0
    v_fmac_f32 v196, v6, v150
    v_fmac_f32 v196, v7, v151
    v_mul_f32 v198, v8, v112
    v_fmac_f32 v198, v9, v113
    v_fmac_f32 v198, v10, v114
    v_mfma_f32_32x32x16_bf16 v[32:47], v[72:75], v[184:187], v[32:47]
    v_fmac_f32 v198, v11, v115
    v_fmac_f32 v198, v12, v116
    v_fmac_f32 v198, v13, v117
    v_fmac_f32 v198, v14, v118
    v_fmac_f32 v198, v15, v119
    v_mfma_f32_32x32x16_bf16 v[48:63], v[76:79], v[184:187], v[48:63]
    s_waitcnt vmcnt(6)
    ds_read_b64_tr_b16 v[176:177], v244 offset:4096
    ds_read_b64_tr_b16 v[178:179], v244 offset:5120
    ds_read_b64_tr_b16 v[180:181], v245 offset:4096
    ds_read_b64_tr_b16 v[182:183], v245 offset:5120
    v_mul_f32_e64 v200, v16, -v160
    v_fma_f32 v200, v17, -v161, v200
    v_fma_f32 v200, v18, -v162, v200
    v_fma_f32 v200, v19, -v163, v200
    v_fma_f32 v200, v20, -v164, v200
    v_fma_f32 v200, v21, -v165, v200
    v_mfma_f32_32x32x16_bf16 v[32:47], v[80:83], v[188:191], v[32:47]
    v_fma_f32 v200, v22, -v166, v200
    v_fma_f32 v200, v23, -v167, v200
    v_mul_f32_e64 v202, v24, -v160
    v_fma_f32 v202, v25, -v161, v202
    v_fma_f32 v202, v26, -v162, v202
    v_mfma_f32_32x32x16_bf16 v[48:63], v[84:87], v[188:191], v[48:63]
    v_fma_f32 v202, v27, -v163, v202
    v_fma_f32 v202, v28, -v164, v202
    v_fma_f32 v202, v29, -v165, v202
    v_fma_f32 v202, v30, -v166, v202
    v_fma_f32 v202, v31, -v167, v202
    s_waitcnt vmcnt(4) lgkmcnt(0)
    v_mfma_f32_32x32x16_bf16 v[0:15], v[64:67], v[176:179], 0
    v_mul_f32 v197, v32, v152
    v_fmac_f32 v197, v33, v153
    v_fmac_f32 v197, v34, v154
    v_fmac_f32 v197, v35, v155
    v_fmac_f32 v197, v36, v156
    v_fmac_f32 v197, v37, v157
    s_add_u32 m0, s21, 4096
    v_mfma_f32_32x32x16_bf16 v[16:31], v[68:71], v[176:179], 0
    buffer_load_dwordx4 v236, s[4:7], s37 offen lds
    buffer_load_dwordx4 v237, s[8:11], s37 offen offset:1024 lds
    ds_read_b64_tr_b16 v[176:177], v244 offset:6144
    ds_read_b64_tr_b16 v[178:179], v244 offset:7168
    ds_read_b64_tr_b16 v[184:185], v245 offset:6144
    ds_read_b64_tr_b16 v[186:187], v245 offset:7168
    v_add_u32 v252, s43, v247
    ds_read_u16 v236, v252
    ds_read_u16 v237, v252 offset:64
    v_fmac_f32 v197, v38, v158
    v_fmac_f32 v197, v39, v159
    v_mul_f32 v199, v40, v120
    v_fmac_f32 v199, v41, v121
    v_fmac_f32 v199, v42, v122
    s_waitcnt vmcnt(4) lgkmcnt(2)
    v_mfma_f32_32x32x16_bf16 v[0:15], v[72:75], v[176:179], v[0:15]
    v_fmac_f32 v199, v43, v123
    v_fmac_f32 v199, v44, v124
    v_fmac_f32 v199, v45, v125
    v_fmac_f32 v199, v46, v126
    v_fmac_f32 v199, v47, v127
    s_add_u32 m0, s21, 6144
    v_mfma_f32_32x32x16_bf16 v[16:31], v[76:79], v[176:179], v[16:31]
    buffer_load_dwordx4 v238, s[4:7], s37 offen lds
    buffer_load_dwordx4 v239, s[8:11], s37 offen offset:1024 lds
    ds_read_b64_tr_b16 v[176:177], v244 offset:0
    ds_read_b64_tr_b16 v[178:179], v244 offset:1024
    ds_read_b64_tr_b16 v[188:189], v245 offset:0
    ds_read_b64_tr_b16 v[190:191], v245 offset:1024
    v_add_u32 v252, s44, v247
    ds_read_u16 v238, v252
    ds_read_u16 v239, v252 offset:64
    v_mul_f32_e64 v201, v48, -v168
    v_fma_f32 v201, v49, -v169, v201
    v_fma_f32 v201, v50, -v170, v201
    v_fma_f32 v201, v51, -v171, v201
    v_fma_f32 v201, v52, -v172, v201
    v_fma_f32 v201, v53, -v173, v201
    s_waitcnt lgkmcnt(2)
    v_mfma_f32_32x32x16_bf16 v[0:15], v[80:83], v[176:179], v[0:15]
    v_fma_f32 v201, v54, -v174, v201
    v_fma_f32 v201, v55, -v175, v201
    v_mul_f32_e64 v203, v56, -v168
    v_fma_f32 v203, v57, -v169, v203
    v_fma_f32 v203, v58, -v170, v203
    s_add_u32 m0, s21, 0
    v_mfma_f32_32x32x16_bf16 v[16:31], v[84:87], v[176:179], v[16:31]
    v_lshl_add_u32 v234, v234, 10, v246
    v_lshl_add_u32 v235, v235, 10, v246
    buffer_load_dwordx4 v234, s[4:7], s38 offen lds
    buffer_load_dwordx4 v235, s[8:11], s38 offen offset:1024 lds
    v_fma_f32 v203, v59, -v171, v203
    v_fma_f32 v203, v60, -v172, v203
    v_fma_f32 v203, v61, -v173, v203
    v_fma_f32 v203, v62, -v174, v203
    v_fma_f32 v203, v63, -v175, v203
    v_mfma_f32_32x32x16_bf16 v[32:47], v[64:67], v[180:183], 0
    v_mul_f32 v254, v0, v144
    v_fmac_f32 v254, v1, v145
    v_fmac_f32 v254, v2, v146
    v_mfma_f32_32x32x16_bf16 v[48:63], v[68:71], v[180:183], 0
    ds_swizzle_b32 v68, v68 offset:0x401F
    ds_swizzle_b32 v69, v69 offset:0x401F
    ds_swizzle_b32 v70, v70 offset:0x401F
    ds_swizzle_b32 v71, v71 offset:0x401F
    v_fmac_f32 v254, v3, v147
    v_fmac_f32 v254, v4, v148
    v_fmac_f32 v254, v5, v149
    v_mfma_f32_32x32x16_bf16 v[32:47], v[72:75], v[184:187], v[32:47]
    v_fmac_f32 v254, v6, v150
    v_fmac_f32 v254, v7, v151
    v_fmac_f32 v200, v8, v160
    v_mfma_f32_32x32x16_bf16 v[48:63], v[76:79], v[184:187], v[48:63]
    ds_swizzle_b32 v76, v76 offset:0x401F
    ds_swizzle_b32 v77, v77 offset:0x401F
    ds_swizzle_b32 v78, v78 offset:0x401F
    ds_swizzle_b32 v79, v79 offset:0x401F
    s_waitcnt vmcnt(6)
    ds_read_b64_tr_b16 v[176:177], v244 offset:2048
    ds_read_b64_tr_b16 v[178:179], v244 offset:3072
    ds_read_b64_tr_b16 v[180:181], v245 offset:2048
    ds_read_b64_tr_b16 v[182:183], v245 offset:3072
    v_fmac_f32 v200, v9, v161
    v_permlane32_swap_b32 v196, v254
    v_fmac_f32 v200, v10, v162
    v_mfma_f32_32x32x16_bf16 v[32:47], v[80:83], v[188:191], v[32:47]
    v_fmac_f32 v200, v11, v163
    v_fmac_f32 v200, v12, v164
    v_fmac_f32 v200, v13, v165
    v_mfma_f32_32x32x16_bf16 v[48:63], v[84:87], v[188:191], v[48:63]
    ds_swizzle_b32 v84, v84 offset:0x401F
    ds_swizzle_b32 v85, v85 offset:0x401F
    ds_swizzle_b32 v86, v86 offset:0x401F
    ds_swizzle_b32 v87, v87 offset:0x401F
    v_fmac_f32 v200, v14, v166
    v_fmac_f32 v200, v15, v167
    v_add_f32 v254, v196, v254
    s_waitcnt lgkmcnt(8)
    s_mov_b64 exec, s[56:57]
    v_xor_b32 v68, 0x80008000, v68
    v_xor_b32 v69, 0x80008000, v69
    v_xor_b32 v70, 0x80008000, v70
    v_xor_b32 v71, 0x80008000, v71
    v_xor_b32 v76, 0x80008000, v76
    v_xor_b32 v77, 0x80008000, v77
    v_xor_b32 v78, 0x80008000, v78
    v_xor_b32 v79, 0x80008000, v79
    s_mov_b64 exec, -1
    s_waitcnt vmcnt(4) lgkmcnt(4)
    v_mfma_f32_32x32x16_bf16 v[0:15], v[64:67], v[176:179], 0
    v_mul_f32 v255, v32, v152
    v_fmac_f32 v255, v33, v153
    v_fmac_f32 v255, v34, v154
    v_fmac_f32 v255, v35, v155
    s_add_u32 m0, s21, 2048
    v_mfma_f32_32x32x16_bf16 v[16:31], v[68:71], v[176:179], v[16:31]
    v_lshl_add_u32 v236, v236, 10, v246
    v_lshl_add_u32 v237, v237, 10, v246
    buffer_load_dwordx4 v236, s[4:7], s39 offen lds
    buffer_load_dwordx4 v237, s[8:11], s39 offen offset:1024 lds
    ds_read_b64_tr_b16 v[176:177], v244 offset:4096
    ds_read_b64_tr_b16 v[178:179], v244 offset:5120
    ds_read_b64_tr_b16 v[184:185], v245 offset:4096
    ds_read_b64_tr_b16 v[186:187], v245 offset:5120
    v_fmac_f32 v255, v36, v156
    v_fmac_f32 v255, v37, v157
    v_fmac_f32 v255, v38, v158
    s_waitcnt vmcnt(4) lgkmcnt(0)
    v_mfma_f32_32x32x16_bf16 v[0:15], v[72:75], v[176:179], v[0:15]
    v_fmac_f32 v255, v39, v159
    v_fmac_f32 v201, v40, v168
    v_fmac_f32 v201, v41, v169
    s_add_u32 m0, s21, 4096
    v_mfma_f32_32x32x16_bf16 v[16:31], v[76:79], v[176:179], v[16:31]
    v_lshl_add_u32 v238, v238, 10, v246
    v_lshl_add_u32 v239, v239, 10, v246
    buffer_load_dwordx4 v238, s[4:7], s40 offen lds
    buffer_load_dwordx4 v239, s[8:11], s40 offen offset:1024 lds
    ds_read_b64_tr_b16 v[176:177], v244 offset:6144
    ds_read_b64_tr_b16 v[178:179], v244 offset:7168
    ds_read_b64_tr_b16 v[188:189], v245 offset:6144
    ds_read_b64_tr_b16 v[190:191], v245 offset:7168
    v_permlane32_swap_b32 v197, v255
    v_fmac_f32 v201, v42, v170
    v_fmac_f32 v201, v43, v171
    v_fmac_f32 v201, v44, v172
    s_waitcnt lgkmcnt(0)
    s_mov_b64 exec, s[56:57]
    v_xor_b32 v84, 0x80008000, v84
    v_xor_b32 v85, 0x80008000, v85
    v_xor_b32 v86, 0x80008000, v86
    v_xor_b32 v87, 0x80008000, v87
    s_mov_b64 exec, -1
    v_mfma_f32_32x32x16_bf16 v[0:15], v[80:83], v[176:179], v[0:15]
    v_fmac_f32 v201, v45, v173
    v_fmac_f32 v201, v46, v174
    v_fmac_f32 v201, v47, v175
    s_add_u32 m0, s21, 6144
    v_mfma_f32_32x32x16_bf16 v[16:31], v[84:87], v[176:179], v[16:31]
    v_lshl_add_u32 v240, v240, 10, v246
    v_lshl_add_u32 v241, v241, 10, v246
    buffer_load_dwordx4 v240, s[4:7], s41 offen lds
    buffer_load_dwordx4 v241, s[8:11], s41 offen offset:1024 lds
    v_add_f32 v255, v197, v255
    v_cvt_pk_bf16_f32 v254, v254, v255
    ds_write_b32 v253, v254 offset:512
    v_mfma_f32_32x32x16_bf16 v[32:47], v[64:67], v[180:183], 0
    v_mul_f32 v254, v0, v144
    v_fmac_f32 v254, v1, v145
    v_fmac_f32 v254, v2, v146
    v_fmac_f32 v254, v3, v147
    v_fmac_f32 v254, v4, v148
    v_fmac_f32 v254, v5, v149
    v_fmac_f32 v254, v6, v150
    v_mfma_f32_32x32x16_bf16 v[48:63], v[68:71], v[180:183], v[48:63]
    v_fmac_f32 v254, v7, v151
    v_fma_f32 v202, v8, -v160, v202
    v_fma_f32 v202, v9, -v161, v202
    v_permlane32_swap_b32 v254, v200
    v_fma_f32 v202, v10, -v162, v202
    v_fma_f32 v202, v11, -v163, v202
    v_mfma_f32_32x32x16_bf16 v[32:47], v[72:75], v[184:187], v[32:47]
    v_fma_f32 v202, v12, -v164, v202
    v_fma_f32 v202, v13, -v165, v202
    v_fma_f32 v202, v14, -v166, v202
    v_fma_f32 v202, v15, -v167, v202
    v_add_f32 v200, v254, v200
    v_fmac_f32 v198, v16, v112
    v_permlane32_swap_b32 v202, v254
    v_mfma_f32_32x32x16_bf16 v[48:63], v[76:79], v[184:187], v[48:63]
    s_waitcnt vmcnt(6)
    ds_read_b64_tr_b16 v[176:177], v244 offset:0
    ds_read_b64_tr_b16 v[178:179], v244 offset:1024
    ds_read_b64_tr_b16 v[180:181], v245 offset:0
    ds_read_b64_tr_b16 v[182:183], v245 offset:1024
    v_fmac_f32 v198, v17, v113
    v_fmac_f32 v198, v18, v114
    v_fmac_f32 v198, v19, v115
    v_fmac_f32 v198, v20, v116
    v_fmac_f32 v198, v21, v117
    v_fmac_f32 v198, v22, v118
    v_mfma_f32_32x32x16_bf16 v[32:47], v[80:83], v[188:191], v[32:47]
    v_fmac_f32 v198, v23, v119
    v_add_f32 v254, v202, v254
    v_mul_f32 v196, v24, v160
    v_fmac_f32 v196, v25, v161
    v_fmac_f32 v196, v26, v162
    v_fmac_f32 v196, v27, v163
    v_fmac_f32 v196, v28, v164
    v_mfma_f32_32x32x16_bf16 v[48:63], v[84:87], v[188:191], v[48:63]
    v_add_u32 v249, s48, v249
    v_add_u32 v250, s49, v250
    ds_read_b32 v252, v251 offset:16
    ds_read_b64_tr_b16 v[64:65], v249 offset:0
    ds_read_b64_tr_b16 v[68:69], v249 offset:64
    ds_read_b64_tr_b16 v[66:67], v249 offset:256
    ds_read_b64_tr_b16 v[70:71], v249 offset:320
    s_mov_b64 exec, s[54:55]
    ds_read_u16_d16_hi v242, v250 offset:0
    s_mov_b64 exec, -1
    v_fmac_f32 v196, v29, v165
    v_fmac_f32 v196, v30, v166
    v_fmac_f32 v196, v31, v167
    s_nop 1
    v_permlane32_swap_b32 v198, v196
    v_add_f32 v196, v198, v196
    v_mul_f32 v255, v32, v152
    v_fmac_f32 v255, v33, v153
    v_fmac_f32 v255, v34, v154
    v_fmac_f32 v255, v35, v155
    v_fmac_f32 v255, v36, v156
    v_fmac_f32 v255, v37, v157
    v_fmac_f32 v255, v38, v158
    v_fmac_f32 v255, v39, v159
    v_fma_f32 v203, v40, -v168, v203
    v_fma_f32 v203, v41, -v169, v203
    v_permlane32_swap_b32 v255, v201
    v_fma_f32 v203, v42, -v170, v203
    v_fma_f32 v203, v43, -v171, v203
    v_fma_f32 v203, v44, -v172, v203
    v_fma_f32 v203, v45, -v173, v203
    v_fma_f32 v203, v46, -v174, v203
    v_fma_f32 v203, v47, -v175, v203
    v_add_f32 v201, v255, v201
    v_fmac_f32 v199, v48, v120
    v_permlane32_swap_b32 v203, v255
    v_fmac_f32 v199, v49, v121
    v_fmac_f32 v199, v50, v122
    v_fmac_f32 v199, v51, v123
    v_fmac_f32 v199, v52, v124
    v_fmac_f32 v199, v53, v125
    v_fmac_f32 v199, v54, v126
    v_fmac_f32 v199, v55, v127
    v_add_f32 v255, v203, v255
    v_mul_f32 v197, v56, v168
    v_fmac_f32 v197, v57, v169
    v_fmac_f32 v197, v58, v170
    v_fmac_f32 v197, v59, v171
    v_fmac_f32 v197, v60, v172
    v_fmac_f32 v197, v61, v173
    v_fmac_f32 v197, v62, v174
    v_fmac_f32 v197, v63, v175
    s_nop 1
    v_permlane32_swap_b32 v199, v197
    v_add_f32 v197, v199, v197
    v_cvt_pk_bf16_f32 v200, v200, v201
    v_cvt_pk_bf16_f32 v254, v254, v255
    v_cvt_pk_bf16_f32 v196, v196, v197
    ds_write_b32 v253, v200 offset:768
    s_mov_b64 exec, 0xffffffff
    ds_write_b32 v253, v254 offset:1280
    s_mov_b64 exec, -1
    ds_write_b32 v253, v196 offset:1024
    s_add_u32 s50, s50, 1
    s_cmp_ge_u32 s50, 5
    s_cbranch_scc1 TAIL
    s_waitcnt lgkmcnt(8)
    v_readfirstlane_b32 s66, v252
    s_add_u32 s53, s53, 1
    v_mov_b32 v252, s53
    s_cmp_le_u32 s53, s66
    ds_write2_b32 v251, v252, v252 offset0:0 offset1:8
    s_setprio 1
    s_cbranch_scc1 PRIO_13
    s_setprio 0
PRIO_13:
    s_cmp_eq_u32 s52, 4
    s_cbranch_scc1 ITEM_1_4
    s_cmp_eq_u32 s52, 5
    s_cbranch_scc1 ITEM_1_5
    s_cmp_eq_u32 s52, 3
    s_cbranch_scc1 ITEM_1_3
    s_cmp_eq_u32 s52, 6
    s_cbranch_scc1 ITEM_1_6
    s_cmp_eq_u32 s52, 8
    s_cbranch_scc1 ITEM_1_8
    s_branch ITEM_1_2
.p2align 6
ITEM_1_8:
    s_mov_b64 exec, s[54:55]
    ds_read_u16_d16_hi v243, v250 offset:128
    s_mov_b64 exec, -1
    ds_read_b64_tr_b16 v[72:73], v249 offset:512
    ds_read_b64_tr_b16 v[76:77], v249 offset:576
    ds_read_b64_tr_b16 v[74:75], v249 offset:768
    ds_read_b64_tr_b16 v[78:79], v249 offset:832
    ds_read_b64_tr_b16 v[80:81], v249 offset:1024
    ds_read_b64_tr_b16 v[84:85], v249 offset:1088
    ds_read_b64_tr_b16 v[82:83], v249 offset:1280
    ds_read_b64_tr_b16 v[86:87], v249 offset:1344
    ds_read_b64_tr_b16 v[88:89], v249 offset:1536
    ds_read_b64_tr_b16 v[92:93], v249 offset:1600
    ds_read_b64_tr_b16 v[90:91], v249 offset:1792
    ds_read_b64_tr_b16 v[94:95], v249 offset:1856
    s_waitcnt lgkmcnt(13)
    v_mul_f32_dpp v196, v242, v64 row_newbcast:0 row_mask:0xf bank_mask:0xf
    v_mul_f32_dpp v197, v242, v65 row_newbcast:1 row_mask:0xf bank_mask:0xf
    v_mul_f32_dpp v198, v242, v64 row_newbcast:8 row_mask:0xf bank_mask:0xf
    v_mul_f32_dpp v199, v242, v65 row_newbcast:9 row_mask:0xf bank_mask:0xf
    v_mul_f32_dpp v200, v242, v68 row_newbcast:2 row_mask:0xf bank_mask:0xf
    v_mul_f32_dpp v201, v242, v69 row_newbcast:3 row_mask:0xf bank_mask:0xf
    v_mul_f32_dpp v202, v242, v68 row_newbcast:10 row_mask:0xf bank_mask:0xf
    v_mul_f32_dpp v203, v242, v69 row_newbcast:11 row_mask:0xf bank_mask:0xf
    v_cvt_pk_bf16_f32 v64, v196, v197
    v_cvt_pk_bf16_f32 v68, v198, v199
    v_cvt_pk_bf16_f32 v65, v200, v201
    v_cvt_pk_bf16_f32 v69, v202, v203
    v_mul_f32_dpp v196, v242, v66 row_newbcast:4 row_mask:0xf bank_mask:0xf
    v_mul_f32_dpp v197, v242, v67 row_newbcast:5 row_mask:0xf bank_mask:0xf
    v_mul_f32_dpp v198, v242, v66 row_newbcast:12 row_mask:0xf bank_mask:0xf
    v_mul_f32_dpp v199, v242, v67 row_newbcast:13 row_mask:0xf bank_mask:0xf
    v_mul_f32_dpp v200, v242, v70 row_newbcast:6 row_mask:0xf bank_mask:0xf
    v_mul_f32_dpp v201, v242, v71 row_newbcast:7 row_mask:0xf bank_mask:0xf
    v_mul_f32_dpp v202, v242, v70 row_newbcast:14 row_mask:0xf bank_mask:0xf
    v_mul_f32_dpp v203, v242, v71 row_newbcast:15 row_mask:0xf bank_mask:0xf
    v_cvt_pk_bf16_f32 v66, v196, v197
    v_cvt_pk_bf16_f32 v70, v198, v199
    v_cvt_pk_bf16_f32 v67, v200, v201
    v_cvt_pk_bf16_f32 v71, v202, v203
    s_mov_b64 exec, s[54:55]
    ds_read_u16_d16_hi v242, v250 offset:256
    s_mov_b64 exec, -1
    s_waitcnt vmcnt(4) lgkmcnt(9)
    v_mfma_f32_32x32x16_bf16 v[0:15], v[64:67], v[176:179], 0
    v_mul_f32_dpp v196, v243, v72 row_newbcast:0 row_mask:0xf bank_mask:0xf
    v_mul_f32_dpp v197, v243, v73 row_newbcast:1 row_mask:0xf bank_mask:0xf
    v_mul_f32_dpp v198, v243, v72 row_newbcast:8 row_mask:0xf bank_mask:0xf
    v_mul_f32_dpp v199, v243, v73 row_newbcast:9 row_mask:0xf bank_mask:0xf
    v_mul_f32_dpp v200, v243, v76 row_newbcast:2 row_mask:0xf bank_mask:0xf
    v_mul_f32_dpp v201, v243, v77 row_newbcast:3 row_mask:0xf bank_mask:0xf
    v_mul_f32_dpp v202, v243, v76 row_newbcast:10 row_mask:0xf bank_mask:0xf
    v_mul_f32_dpp v203, v243, v77 row_newbcast:11 row_mask:0xf bank_mask:0xf
    v_cvt_pk_bf16_f32 v72, v196, v197
    v_cvt_pk_bf16_f32 v76, v198, v199
    v_cvt_pk_bf16_f32 v73, v200, v201
    v_cvt_pk_bf16_f32 v77, v202, v203
    s_add_u32 m0, s21, 0
    v_mfma_f32_32x32x16_bf16 v[16:31], v[68:71], v[176:179], 0
    buffer_load_dwordx4 v234, s[4:7], s35 offen lds
    buffer_load_dwordx4 v235, s[8:11], s35 offen offset:1024 lds
    ds_read_b64_tr_b16 v[176:177], v244 offset:2048
    ds_read_b64_tr_b16 v[178:179], v244 offset:3072
    ds_read_b64_tr_b16 v[184:185], v245 offset:2048
    ds_read_b64_tr_b16 v[186:187], v245 offset:3072
    v_mul_f32_dpp v196, v243, v74 row_newbcast:4 row_mask:0xf bank_mask:0xf
    v_mul_f32_dpp v197, v243, v75 row_newbcast:5 row_mask:0xf bank_mask:0xf
    v_mul_f32_dpp v198, v243, v74 row_newbcast:12 row_mask:0xf bank_mask:0xf
    v_mul_f32_dpp v199, v243, v75 row_newbcast:13 row_mask:0xf bank_mask:0xf
    v_mul_f32_dpp v200, v243, v78 row_newbcast:6 row_mask:0xf bank_mask:0xf
    v_mul_f32_dpp v201, v243, v79 row_newbcast:7 row_mask:0xf bank_mask:0xf
    v_mul_f32_dpp v202, v243, v78 row_newbcast:14 row_mask:0xf bank_mask:0xf
    v_mul_f32_dpp v203, v243, v79 row_newbcast:15 row_mask:0xf bank_mask:0xf
    v_cvt_pk_bf16_f32 v74, v196, v197
    v_cvt_pk_bf16_f32 v78, v198, v199
    v_cvt_pk_bf16_f32 v75, v200, v201
    v_cvt_pk_bf16_f32 v79, v202, v203
    s_mov_b64 exec, s[54:55]
    ds_read_u16_d16_hi v243, v250 offset:384
    s_mov_b64 exec, -1
    s_waitcnt vmcnt(4) lgkmcnt(1)
    v_mfma_f32_32x32x16_bf16 v[0:15], v[72:75], v[176:179], v[0:15]
    v_mul_f32_dpp v196, v242, v80 row_newbcast:0 row_mask:0xf bank_mask:0xf
    v_mul_f32_dpp v197, v242, v81 row_newbcast:1 row_mask:0xf bank_mask:0xf
    v_mul_f32_dpp v198, v242, v80 row_newbcast:8 row_mask:0xf bank_mask:0xf
    v_mul_f32_dpp v199, v242, v81 row_newbcast:9 row_mask:0xf bank_mask:0xf
    v_mul_f32_dpp v200, v242, v84 row_newbcast:2 row_mask:0xf bank_mask:0xf
    v_mul_f32_dpp v201, v242, v85 row_newbcast:3 row_mask:0xf bank_mask:0xf
    v_mul_f32_dpp v202, v242, v84 row_newbcast:10 row_mask:0xf bank_mask:0xf
    v_mul_f32_dpp v203, v242, v85 row_newbcast:11 row_mask:0xf bank_mask:0xf
    v_cvt_pk_bf16_f32 v80, v196, v197
    v_cvt_pk_bf16_f32 v84, v198, v199
    v_cvt_pk_bf16_f32 v81, v200, v201
    v_cvt_pk_bf16_f32 v85, v202, v203
    s_add_u32 m0, s21, 2048
    v_mfma_f32_32x32x16_bf16 v[16:31], v[76:79], v[176:179], v[16:31]
    buffer_load_dwordx4 v236, s[4:7], s35 offen lds
    buffer_load_dwordx4 v237, s[8:11], s35 offen offset:1024 lds
    ds_read_b64_tr_b16 v[176:177], v244 offset:4096
    ds_read_b64_tr_b16 v[178:179], v244 offset:5120
    ds_read_b64_tr_b16 v[188:189], v245 offset:4096
    ds_read_b64_tr_b16 v[190:191], v245 offset:5120
    v_mul_f32_dpp v196, v242, v82 row_newbcast:4 row_mask:0xf bank_mask:0xf
    v_mul_f32_dpp v197, v242, v83 row_newbcast:5 row_mask:0xf bank_mask:0xf
    v_mul_f32_dpp v198, v242, v82 row_newbcast:12 row_mask:0xf bank_mask:0xf
    v_mul_f32_dpp v199, v242, v83 row_newbcast:13 row_mask:0xf bank_mask:0xf
    v_mul_f32_dpp v200, v242, v86 row_newbcast:6 row_mask:0xf bank_mask:0xf
    v_mul_f32_dpp v201, v242, v87 row_newbcast:7 row_mask:0xf bank_mask:0xf
    v_mul_f32_dpp v202, v242, v86 row_newbcast:14 row_mask:0xf bank_mask:0xf
    v_mul_f32_dpp v203, v242, v87 row_newbcast:15 row_mask:0xf bank_mask:0xf
    v_cvt_pk_bf16_f32 v82, v196, v197
    v_cvt_pk_bf16_f32 v86, v198, v199
    v_cvt_pk_bf16_f32 v83, v200, v201
    v_cvt_pk_bf16_f32 v87, v202, v203
    s_nop 0
    s_waitcnt vmcnt(4) lgkmcnt(0)
    v_mfma_f32_32x32x16_bf16 v[0:15], v[80:83], v[176:179], v[0:15]
    v_mul_f32_dpp v196, v243, v88 row_newbcast:0 row_mask:0xf bank_mask:0xf
    v_mul_f32_dpp v197, v243, v89 row_newbcast:1 row_mask:0xf bank_mask:0xf
    v_mul_f32_dpp v198, v243, v88 row_newbcast:8 row_mask:0xf bank_mask:0xf
    v_mul_f32_dpp v199, v243, v89 row_newbcast:9 row_mask:0xf bank_mask:0xf
    v_mul_f32_dpp v200, v243, v92 row_newbcast:2 row_mask:0xf bank_mask:0xf
    v_mul_f32_dpp v201, v243, v93 row_newbcast:3 row_mask:0xf bank_mask:0xf
    v_mul_f32_dpp v202, v243, v92 row_newbcast:10 row_mask:0xf bank_mask:0xf
    v_mul_f32_dpp v203, v243, v93 row_newbcast:11 row_mask:0xf bank_mask:0xf
    v_cvt_pk_bf16_f32 v88, v196, v197
    v_cvt_pk_bf16_f32 v92, v198, v199
    v_cvt_pk_bf16_f32 v89, v200, v201
    v_cvt_pk_bf16_f32 v93, v202, v203
    s_add_u32 m0, s21, 4096
    v_mfma_f32_32x32x16_bf16 v[16:31], v[84:87], v[176:179], v[16:31]
    buffer_load_dwordx4 v238, s[4:7], s35 offen lds
    buffer_load_dwordx4 v239, s[8:11], s35 offen offset:1024 lds
    ds_read_b64_tr_b16 v[176:177], v244 offset:6144
    ds_read_b64_tr_b16 v[178:179], v244 offset:7168
    ds_read_b64_tr_b16 v[192:193], v245 offset:6144
    ds_read_b64_tr_b16 v[194:195], v245 offset:7168
    v_mul_f32_dpp v196, v243, v90 row_newbcast:4 row_mask:0xf bank_mask:0xf
    v_mul_f32_dpp v197, v243, v91 row_newbcast:5 row_mask:0xf bank_mask:0xf
    v_mul_f32_dpp v198, v243, v90 row_newbcast:12 row_mask:0xf bank_mask:0xf
    v_mul_f32_dpp v199, v243, v91 row_newbcast:13 row_mask:0xf bank_mask:0xf
    v_mul_f32_dpp v200, v243, v94 row_newbcast:6 row_mask:0xf bank_mask:0xf
    v_mul_f32_dpp v201, v243, v95 row_newbcast:7 row_mask:0xf bank_mask:0xf
    v_mul_f32_dpp v202, v243, v94 row_newbcast:14 row_mask:0xf bank_mask:0xf
    v_mul_f32_dpp v203, v243, v95 row_newbcast:15 row_mask:0xf bank_mask:0xf
    v_cvt_pk_bf16_f32 v90, v196, v197
    v_cvt_pk_bf16_f32 v94, v198, v199
    v_cvt_pk_bf16_f32 v91, v200, v201
    v_cvt_pk_bf16_f32 v95, v202, v203
    s_nop 0
    s_waitcnt lgkmcnt(0)
    v_mfma_f32_32x32x16_bf16 v[0:15], v[88:91], v[176:179], v[0:15]
    s_add_u32 m0, s21, 6144
    v_mfma_f32_32x32x16_bf16 v[16:31], v[92:95], v[176:179], v[16:31]
    buffer_load_dwordx4 v240, s[4:7], s35 offen lds
    buffer_load_dwordx4 v241, s[8:11], s35 offen offset:1024 lds
    s_mov_b32 m0, s50
    s_nop 0
    s_movrels_b32 s71, s23
    s_movrels_b32 s33, s28
    s_and_b32 s70, s33, 0x70
    s_andn2_b32 s33, s33, 0x70
    v_xor_b32 v253, s70, v248
    v_add_u32 v253, s33, v253
    s_bfe_u32 s46, s71, 0x30012
    s_mov_b32 m0, s46
    s_and_b32 s66, s71, 0x3ffff
    s_movrels_b32 s68, s57
    s_movrels_b32 s69, s61
    s_sub_u32 s48, s66, s47
    s_mov_b32 s47, s66
    s_lshr_b32 s52, s71, 28
    s_lshl_b32 s67, s46, 9
    s_add_u32 s66, s66, s67
    s_sub_u32 s49, s66, s42
    s_mov_b32 s42, s66
    s_bfe_u32 s66, s68, 655360
    s_add_u32 s43, s42, s66
    s_bfe_u32 s39, s69, 655360
    s_bfe_u32 s66, s68, 655370
    s_add_u32 s44, s42, s66
    s_bfe_u32 s40, s69, 655370
    s_bfe_u32 s66, s68, 655380
    s_add_u32 s45, s42, s66
    s_bfe_u32 s41, s69, 655380
    v_mfma_f32_32x32x16_bf16 v[32:47], v[64:67], v[180:183], 0
    v_mul_f32 v196, v0, v96
    v_fmac_f32 v196, v1, v97
    v_fmac_f32 v196, v2, v98
    v_fmac_f32 v196, v3, v99
    v_fmac_f32 v196, v4, v100
    v_mfma_f32_32x32x16_bf16 v[48:63], v[68:71], v[180:183], 0
    v_fmac_f32 v196, v5, v101
    v_fmac_f32 v196, v6, v102
    v_fmac_f32 v196, v7, v103
    v_mul_f32 v198, v8, v128
    v_fmac_f32 v198, v9, v129
    v_mfma_f32_32x32x16_bf16 v[32:47], v[72:75], v[184:187], v[32:47]
    v_fmac_f32 v198, v10, v130
    v_fmac_f32 v198, v11, v131
    v_fmac_f32 v198, v12, v132
    v_fmac_f32 v198, v13, v133
    v_mfma_f32_32x32x16_bf16 v[48:63], v[76:79], v[184:187], v[48:63]
    v_fmac_f32 v198, v14, v134
    v_fmac_f32 v198, v15, v135
    v_mul_f32 v200, v16, v128
    v_fmac_f32 v200, v17, v129
    v_permlane32_swap_b32 v196, v198
    v_mfma_f32_32x32x16_bf16 v[32:47], v[80:83], v[188:191], v[32:47]
    v_fmac_f32 v200, v18, v130
    v_fmac_f32 v200, v19, v131
    v_fmac_f32 v200, v20, v132
    v_fmac_f32 v200, v21, v133
    v_fmac_f32 v200, v22, v134
    v_mfma_f32_32x32x16_bf16 v[48:63], v[84:87], v[188:191], v[48:63]
    s_waitcnt vmcnt(6)
    ds_read_b64_tr_b16 v[176:177], v244 offset:0
    ds_read_b64_tr_b16 v[178:179], v244 offset:1024
    ds_read_b64_tr_b16 v[180:181], v245 offset:0
    ds_read_b64_tr_b16 v[182:183], v245 offset:1024
    v_fmac_f32 v200, v23, v135
    v_add_f32 v198, v196, v198
    v_mul_f32_e64 v202, v24, -v128
    v_fma_f32 v202, v25, -v129, v202
    v_mfma_f32_32x32x16_bf16 v[32:47], v[88:91], v[192:195], v[32:47]
    v_fma_f32 v202, v26, -v130, v202
    v_fma_f32 v202, v27, -v131, v202
    v_fma_f32 v202, v28, -v132, v202
    v_fma_f32 v202, v29, -v133, v202
    v_fma_f32 v202, v30, -v134, v202
    v_mfma_f32_32x32x16_bf16 v[48:63], v[92:95], v[192:195], v[48:63]
    v_fma_f32 v202, v31, -v135, v202
    s_nop 1
    v_permlane32_swap_b32 v200, v202
    v_add_f32 v202, v200, v202
    s_waitcnt vmcnt(4) lgkmcnt(0)
    v_mfma_f32_32x32x16_bf16 v[0:15], v[64:67], v[176:179], 0
    v_mul_f32 v197, v32, v104
    v_fmac_f32 v197, v33, v105
    v_fmac_f32 v197, v34, v106
    v_fmac_f32 v197, v35, v107
    v_fmac_f32 v197, v36, v108
    v_fmac_f32 v197, v37, v109
    s_add_u32 m0, s21, 0
    v_mfma_f32_32x32x16_bf16 v[16:31], v[68:71], v[176:179], 0
    buffer_load_dwordx4 v234, s[4:7], s36 offen lds
    buffer_load_dwordx4 v235, s[8:11], s36 offen offset:1024 lds
    ds_read_b64_tr_b16 v[176:177], v244 offset:2048
    ds_read_b64_tr_b16 v[178:179], v244 offset:3072
    ds_read_b64_tr_b16 v[184:185], v245 offset:2048
    ds_read_b64_tr_b16 v[186:187], v245 offset:3072
    v_fmac_f32 v197, v38, v110
    v_fmac_f32 v197, v39, v111
    v_mul_f32 v199, v40, v136
    v_fmac_f32 v199, v41, v137
    v_fmac_f32 v199, v42, v138
    s_waitcnt vmcnt(4) lgkmcnt(0)
    v_mfma_f32_32x32x16_bf16 v[0:15], v[72:75], v[176:179], v[0:15]
    v_fmac_f32 v199, v43, v139
    v_fmac_f32 v199, v44, v140
    v_fmac_f32 v199, v45, v141
    v_fmac_f32 v199, v46, v142
    v_fmac_f32 v199, v47, v143
    s_add_u32 m0, s21, 2048
    v_mfma_f32_32x32x16_bf16 v[16:31], v[76:79], v[176:179], v[16:31]
    buffer_load_dwordx4 v236, s[4:7], s36 offen lds
    buffer_load_dwordx4 v237, s[8:11], s36 offen offset:1024 lds
    ds_read_b64_tr_b16 v[176:177], v244 offset:4096
    ds_read_b64_tr_b16 v[178:179], v244 offset:5120
    ds_read_b64_tr_b16 v[188:189], v245 offset:4096
    ds_read_b64_tr_b16 v[190:191], v245 offset:5120
    v_mul_f32 v201, v48, v136
    v_fmac_f32 v201, v49, v137
    v_permlane32_swap_b32 v197, v199
    v_fmac_f32 v201, v50, v138
    v_fmac_f32 v201, v51, v139
    s_waitcnt vmcnt(4) lgkmcnt(0)
    v_mfma_f32_32x32x16_bf16 v[0:15], v[80:83], v[176:179], v[0:15]
    v_fmac_f32 v201, v52, v140
    v_fmac_f32 v201, v53, v141
    v_fmac_f32 v201, v54, v142
    v_fmac_f32 v201, v55, v143
    v_add_f32 v199, v197, v199
    s_add_u32 m0, s21, 4096
    v_mfma_f32_32x32x16_bf16 v[16:31], v[84:87], v[176:179], v[16:31]
    buffer_load_dwordx4 v238, s[4:7], s36 offen lds
    buffer_load_dwordx4 v239, s[8:11], s36 offen offset:1024 lds
    ds_read_b64_tr_b16 v[176:177], v244 offset:6144
    ds_read_b64_tr_b16 v[178:179], v244 offset:7168
    ds_read_b64_tr_b16 v[192:193], v245 offset:6144
    ds_read_b64_tr_b16 v[194:195], v245 offset:7168
    v_mul_f32_e64 v203, v56, -v136
    v_fma_f32 v203, v57, -v137, v203
    v_fma_f32 v203, v58, -v138, v203
    v_fma_f32 v203, v59, -v139, v203
    v_fma_f32 v203, v60, -v140, v203
    s_waitcnt lgkmcnt(0)
    v_mfma_f32_32x32x16_bf16 v[0:15], v[88:91], v[176:179], v[0:15]
    v_fma_f32 v203, v61, -v141, v203
    v_fma_f32 v203, v62, -v142, v203
    v_fma_f32 v203, v63, -v143, v203
    s_nop 1
    v_permlane32_swap_b32 v201, v203
    s_add_u32 m0, s21, 6144
    v_mfma_f32_32x32x16_bf16 v[16:31], v[92:95], v[176:179], v[16:31]
    buffer_load_dwordx4 v240, s[4:7], s36 offen lds
    buffer_load_dwordx4 v241, s[8:11], s36 offen offset:1024 lds
    v_add_f32 v203, v201, v203
    v_cvt_pk_bf16_f32 v198, v198, v199
    v_cvt_pk_bf16_f32 v202, v202, v203
    ds_write_b32 v253, v198 offset:0
    ds_write_b32 v253, v202 offset:256
    v_mfma_f32_32x32x16_bf16 v[32:47], v[64:67], v[180:183], 0
    v_mul_f32 v196, v0, v144
    v_fmac_f32 v196, v1, v145
    v_fmac_f32 v196, v2, v146
    v_fmac_f32 v196, v3, v147
    v_mfma_f32_32x32x16_bf16 v[48:63], v[68:71], v[180:183], 0
    v_fmac_f32 v196, v4, v148
    v_fmac_f32 v196, v5, v149
    v_fmac_f32 v196, v6, v150
    v_fmac_f32 v196, v7, v151
    v_mfma_f32_32x32x16_bf16 v[32:47], v[72:75], v[184:187], v[32:47]
    v_mul_f32 v198, v8, v112
    v_fmac_f32 v198, v9, v113
    v_fmac_f32 v198, v10, v114
    v_fmac_f32 v198, v11, v115
    v_mfma_f32_32x32x16_bf16 v[48:63], v[76:79], v[184:187], v[48:63]
    v_fmac_f32 v198, v12, v116
    v_fmac_f32 v198, v13, v117
    v_fmac_f32 v198, v14, v118
    v_fmac_f32 v198, v15, v119
    v_mfma_f32_32x32x16_bf16 v[32:47], v[80:83], v[188:191], v[32:47]
    v_mul_f32_e64 v200, v16, -v160
    v_fma_f32 v200, v17, -v161, v200
    v_fma_f32 v200, v18, -v162, v200
    v_fma_f32 v200, v19, -v163, v200
    v_mfma_f32_32x32x16_bf16 v[48:63], v[84:87], v[188:191], v[48:63]
    s_waitcnt vmcnt(6)
    ds_read_b64_tr_b16 v[176:177], v244 offset:0
    ds_read_b64_tr_b16 v[178:179], v244 offset:1024
    ds_read_b64_tr_b16 v[180:181], v245 offset:0
    ds_read_b64_tr_b16 v[182:183], v245 offset:1024
    v_fma_f32 v200, v20, -v164, v200
    v_fma_f32 v200, v21, -v165, v200
    v_fma_f32 v200, v22, -v166, v200
    v_fma_f32 v200, v23, -v167, v200
    v_mfma_f32_32x32x16_bf16 v[32:47], v[88:91], v[192:195], v[32:47]
    v_mul_f32_e64 v202, v24, -v160
    v_fma_f32 v202, v25, -v161, v202
    v_fma_f32 v202, v26, -v162, v202
    v_fma_f32 v202, v27, -v163, v202
    v_mfma_f32_32x32x16_bf16 v[48:63], v[92:95], v[192:195], v[48:63]
    v_fma_f32 v202, v28, -v164, v202
    v_fma_f32 v202, v29, -v165, v202
    v_fma_f32 v202, v30, -v166, v202
    v_fma_f32 v202, v31, -v167, v202
    s_waitcnt vmcnt(4) lgkmcnt(0)
    v_mfma_f32_32x32x16_bf16 v[0:15], v[64:67], v[176:179], 0
    s_nop 0
    v_mul_f32 v197, v32, v152
    v_fmac_f32 v197, v33, v153
    v_fmac_f32 v197, v34, v154
    v_fmac_f32 v197, v35, v155
    s_add_u32 m0, s21, 0
    v_mfma_f32_32x32x16_bf16 v[16:31], v[68:71], v[176:179], 0
    buffer_load_dwordx4 v234, s[4:7], s37 offen lds
    buffer_load_dwordx4 v235, s[8:11], s37 offen offset:1024 lds
    ds_read_b64_tr_b16 v[176:177], v244 offset:2048
    ds_read_b64_tr_b16 v[178:179], v244 offset:3072
    ds_read_b64_tr_b16 v[184:185], v245 offset:2048
    ds_read_b64_tr_b16 v[186:187], v245 offset:3072
    v_add_u32 v252, s42, v247
    ds_read_u16 v234, v252
    ds_read_u16 v235, v252 offset:64
    v_fmac_f32 v197, v36, v156
    v_fmac_f32 v197, v37, v157
    v_fmac_f32 v197, v38, v158
    v_fmac_f32 v197, v39, v159
    s_waitcnt vmcnt(4) lgkmcnt(2)
    v_mfma_f32_32x32x16_bf16 v[0:15], v[72:75], v[176:179], v[0:15]
    v_mul_f32 v199, v40, v120
    v_fmac_f32 v199, v41, v121
    v_fmac_f32 v199, v42, v122
    v_fmac_f32 v199, v43, v123
    s_add_u32 m0, s21, 2048
    v_mfma_f32_32x32x16_bf16 v[16:31], v[76:79], v[176:179], v[16:31]
    buffer_load_dwordx4 v236, s[4:7], s37 offen lds
    buffer_load_dwordx4 v237, s[8:11], s37 offen offset:1024 lds
    ds_read_b64_tr_b16 v[176:177], v244 offset:4096
    ds_read_b64_tr_b16 v[178:179], v244 offset:5120
    ds_read_b64_tr_b16 v[188:189], v245 offset:4096
    ds_read_b64_tr_b16 v[190:191], v245 offset:5120
    v_add_u32 v252, s43, v247
    ds_read_u16 v236, v252
    ds_read_u16 v237, v252 offset:64
    v_fmac_f32 v199, v44, v124
    v_fmac_f32 v199, v45, v125
    v_fmac_f32 v199, v46, v126
    v_fmac_f32 v199, v47, v127
    s_waitcnt vmcnt(4) lgkmcnt(2)
    v_mfma_f32_32x32x16_bf16 v[0:15], v[80:83], v[176:179], v[0:15]
    v_mul_f32_e64 v201, v48, -v168
    v_fma_f32 v201, v49, -v169, v201
    v_fma_f32 v201, v50, -v170, v201
    v_fma_f32 v201, v51, -v171, v201
    s_add_u32 m0, s21, 4096
    v_mfma_f32_32x32x16_bf16 v[16:31], v[84:87], v[176:179], v[16:31]
    buffer_load_dwordx4 v238, s[4:7], s37 offen lds
    buffer_load_dwordx4 v239, s[8:11], s37 offen offset:1024 lds
    ds_read_b64_tr_b16 v[176:177], v244 offset:6144
    ds_read_b64_tr_b16 v[178:179], v244 offset:7168
    ds_read_b64_tr_b16 v[192:193], v245 offset:6144
    ds_read_b64_tr_b16 v[194:195], v245 offset:7168
    v_add_u32 v252, s44, v247
    ds_read_u16 v238, v252
    ds_read_u16 v239, v252 offset:64
    v_fma_f32 v201, v52, -v172, v201
    v_fma_f32 v201, v53, -v173, v201
    v_fma_f32 v201, v54, -v174, v201
    v_fma_f32 v201, v55, -v175, v201
    s_waitcnt lgkmcnt(2)
    v_mfma_f32_32x32x16_bf16 v[0:15], v[88:91], v[176:179], v[0:15]
    v_mul_f32_e64 v203, v56, -v168
    v_fma_f32 v203, v57, -v169, v203
    v_fma_f32 v203, v58, -v170, v203
    v_fma_f32 v203, v59, -v171, v203
    s_add_u32 m0, s21, 6144
    v_mfma_f32_32x32x16_bf16 v[16:31], v[92:95], v[176:179], v[16:31]
    buffer_load_dwordx4 v240, s[4:7], s37 offen lds
    buffer_load_dwordx4 v241, s[8:11], s37 offen offset:1024 lds
    v_add_u32 v252, s45, v247
    ds_read_u16 v240, v252
    ds_read_u16 v241, v252 offset:64
    v_fma_f32 v203, v60, -v172, v203
    v_fma_f32 v203, v61, -v173, v203
    v_fma_f32 v203, v62, -v174, v203
    v_fma_f32 v203, v63, -v175, v203
    v_mfma_f32_32x32x16_bf16 v[32:47], v[64:67], v[180:183], 0
    v_mul_f32 v254, v0, v144
    v_fmac_f32 v254, v1, v145
    v_fmac_f32 v254, v2, v146
    v_mfma_f32_32x32x16_bf16 v[48:63], v[68:71], v[180:183], 0
    ds_swizzle_b32 v68, v68 offset:0x401F
    ds_swizzle_b32 v69, v69 offset:0x401F
    ds_swizzle_b32 v70, v70 offset:0x401F
    ds_swizzle_b32 v71, v71 offset:0x401F
    v_fmac_f32 v254, v3, v147
    v_fmac_f32 v254, v4, v148
    v_mfma_f32_32x32x16_bf16 v[32:47], v[72:75], v[184:187], v[32:47]
    v_fmac_f32 v254, v5, v149
    v_fmac_f32 v254, v6, v150
    v_mfma_f32_32x32x16_bf16 v[48:63], v[76:79], v[184:187], v[48:63]
    ds_swizzle_b32 v76, v76 offset:0x401F
    ds_swizzle_b32 v77, v77 offset:0x401F
    ds_swizzle_b32 v78, v78 offset:0x401F
    ds_swizzle_b32 v79, v79 offset:0x401F
    v_fmac_f32 v254, v7, v151
    v_fmac_f32 v200, v8, v160
    v_mfma_f32_32x32x16_bf16 v[32:47], v[80:83], v[188:191], v[32:47]
    v_fmac_f32 v200, v9, v161
    v_permlane32_swap_b32 v196, v254
    v_fmac_f32 v200, v10, v162
    v_mfma_f32_32x32x16_bf16 v[48:63], v[84:87], v[188:191], v[48:63]
    ds_swizzle_b32 v84, v84 offset:0x401F
    ds_swizzle_b32 v85, v85 offset:0x401F
    ds_swizzle_b32 v86, v86 offset:0x401F
    ds_swizzle_b32 v87, v87 offset:0x401F
    s_waitcnt vmcnt(6)
    ds_read_b64_tr_b16 v[176:177], v244 offset:0
    ds_read_b64_tr_b16 v[178:179], v244 offset:1024
    ds_read_b64_tr_b16 v[180:181], v245 offset:0
    ds_read_b64_tr_b16 v[182:183], v245 offset:1024
    v_fmac_f32 v200, v11, v163
    v_fmac_f32 v200, v12, v164
    v_mfma_f32_32x32x16_bf16 v[32:47], v[88:91], v[192:195], v[32:47]
    v_fmac_f32 v200, v13, v165
    v_fmac_f32 v200, v14, v166
    v_mfma_f32_32x32x16_bf16 v[48:63], v[92:95], v[192:195], v[48:63]
    ds_swizzle_b32 v92, v92 offset:0x401F
    ds_swizzle_b32 v93, v93 offset:0x401F
    ds_swizzle_b32 v94, v94 offset:0x401F
    ds_swizzle_b32 v95, v95 offset:0x401F
    v_fmac_f32 v200, v15, v167
    v_add_f32 v254, v196, v254
    s_waitcnt lgkmcnt(8)
    s_mov_b64 exec, s[56:57]
    v_xor_b32 v68, 0x80008000, v68
    v_xor_b32 v69, 0x80008000, v69
    v_xor_b32 v70, 0x80008000, v70
    v_xor_b32 v71, 0x80008000, v71
    v_xor_b32 v76, 0x80008000, v76
    v_xor_b32 v77, 0x80008000, v77
    v_xor_b32 v78, 0x80008000, v78
    v_xor_b32 v79, 0x80008000, v79
    v_xor_b32 v84, 0x80008000, v84
    v_xor_b32 v85, 0x80008000, v85
    v_xor_b32 v86, 0x80008000, v86
    v_xor_b32 v87, 0x80008000, v87
    s_mov_b64 exec, -1
    s_waitcnt vmcnt(4) lgkmcnt(4)
    v_mfma_f32_32x32x16_bf16 v[0:15], v[64:67], v[176:179], 0
    v_mul_f32 v255, v32, v152
    v_fmac_f32 v255, v33, v153
    v_fmac_f32 v255, v34, v154
    s_add_u32 m0, s21, 0
    v_mfma_f32_32x32x16_bf16 v[16:31], v[68:71], v[176:179], v[16:31]
    v_lshl_add_u32 v234, v234, 10, v246
    v_lshl_add_u32 v235, v235, 10, v246
    buffer_load_dwordx4 v234, s[4:7], s38 offen lds
    buffer_load_dwordx4 v235, s[8:11], s38 offen offset:1024 lds
    ds_read_b64_tr_b16 v[176:177], v244 offset:2048
    ds_read_b64_tr_b16 v[178:179], v244 offset:3072
    ds_read_b64_tr_b16 v[184:185], v245 offset:2048
    ds_read_b64_tr_b16 v[186:187], v245 offset:3072
    v_fmac_f32 v255, v35, v155
    v_fmac_f32 v255, v36, v156
    s_waitcnt vmcnt(4) lgkmcnt(0)
    v_mfma_f32_32x32x16_bf16 v[0:15], v[72:75], v[176:179], v[0:15]
    v_fmac_f32 v255, v37, v157
    v_fmac_f32 v255, v38, v158
    v_fmac_f32 v255, v39, v159
    s_add_u32 m0, s21, 2048
    v_mfma_f32_32x32x16_bf16 v[16:31], v[76:79], v[176:179], v[16:31]
    v_lshl_add_u32 v236, v236, 10, v246
    v_lshl_add_u32 v237, v237, 10, v246
    buffer_load_dwordx4 v236, s[4:7], s39 offen lds
    buffer_load_dwordx4 v237, s[8:11], s39 offen offset:1024 lds
    ds_read_b64_tr_b16 v[176:177], v244 offset:4096
    ds_read_b64_tr_b16 v[178:179], v244 offset:5120
    ds_read_b64_tr_b16 v[188:189], v245 offset:4096
    ds_read_b64_tr_b16 v[190:191], v245 offset:5120
    v_fmac_f32 v201, v40, v168
    v_fmac_f32 v201, v41, v169
    s_waitcnt vmcnt(4) lgkmcnt(0)
    v_mfma_f32_32x32x16_bf16 v[0:15], v[80:83], v[176:179], v[0:15]
    v_permlane32_swap_b32 v197, v255
    v_fmac_f32 v201, v42, v170
    v_fmac_f32 v201, v43, v171
    s_add_u32 m0, s21, 4096
    v_mfma_f32_32x32x16_bf16 v[16:31], v[84:87], v[176:179], v[16:31]
    v_lshl_add_u32 v238, v238, 10, v246
    v_lshl_add_u32 v239, v239, 10, v246
    buffer_load_dwordx4 v238, s[4:7], s40 offen lds
    buffer_load_dwordx4 v239, s[8:11], s40 offen offset:1024 lds
    ds_read_b64_tr_b16 v[176:177], v244 offset:6144
    ds_read_b64_tr_b16 v[178:179], v244 offset:7168
    ds_read_b64_tr_b16 v[192:193], v245 offset:6144
    ds_read_b64_tr_b16 v[194:195], v245 offset:7168
    v_fmac_f32 v201, v44, v172
    v_fmac_f32 v201, v45, v173
    s_waitcnt lgkmcnt(0)
    s_mov_b64 exec, s[56:57]
    v_xor_b32 v92, 0x80008000, v92
    v_xor_b32 v93, 0x80008000, v93
    v_xor_b32 v94, 0x80008000, v94
    v_xor_b32 v95, 0x80008000, v95
    s_mov_b64 exec, -1
    v_mfma_f32_32x32x16_bf16 v[0:15], v[88:91], v[176:179], v[0:15]
    v_fmac_f32 v201, v46, v174
    v_fmac_f32 v201, v47, v175
    v_add_f32 v255, v197, v255
    s_add_u32 m0, s21, 6144
    v_mfma_f32_32x32x16_bf16 v[16:31], v[92:95], v[176:179], v[16:31]
    v_lshl_add_u32 v240, v240, 10, v246
    v_lshl_add_u32 v241, v241, 10, v246
    buffer_load_dwordx4 v240, s[4:7], s41 offen lds
    buffer_load_dwordx4 v241, s[8:11], s41 offen offset:1024 lds
    v_cvt_pk_bf16_f32 v254, v254, v255
    ds_write_b32 v253, v254 offset:512
    v_mfma_f32_32x32x16_bf16 v[32:47], v[64:67], v[180:183], 0
    v_mul_f32 v254, v0, v144
    v_fmac_f32 v254, v1, v145
    v_fmac_f32 v254, v2, v146
    v_fmac_f32 v254, v3, v147
    v_fmac_f32 v254, v4, v148
    v_mfma_f32_32x32x16_bf16 v[48:63], v[68:71], v[180:183], v[48:63]
    v_fmac_f32 v254, v5, v149
    v_fmac_f32 v254, v6, v150
    v_fmac_f32 v254, v7, v151
    v_fma_f32 v202, v8, -v160, v202
    v_fma_f32 v202, v9, -v161, v202
    v_mfma_f32_32x32x16_bf16 v[32:47], v[72:75], v[184:187], v[32:47]
    v_permlane32_swap_b32 v254, v200
    v_fma_f32 v202, v10, -v162, v202
    v_fma_f32 v202, v11, -v163, v202
    v_fma_f32 v202, v12, -v164, v202
    v_fma_f32 v202, v13, -v165, v202
    v_mfma_f32_32x32x16_bf16 v[48:63], v[76:79], v[184:187], v[48:63]
    v_fma_f32 v202, v14, -v166, v202
    v_fma_f32 v202, v15, -v167, v202
    v_add_f32 v200, v254, v200
    v_fmac_f32 v198, v16, v112
    v_permlane32_swap_b32 v202, v254
    v_mfma_f32_32x32x16_bf16 v[32:47], v[80:83], v[188:191], v[32:47]
    v_fmac_f32 v198, v17, v113
    v_fmac_f32 v198, v18, v114
    v_fmac_f32 v198, v19, v115
    v_fmac_f32 v198, v20, v116
    v_fmac_f32 v198, v21, v117
    v_mfma_f32_32x32x16_bf16 v[48:63], v[84:87], v[188:191], v[48:63]
    s_waitcnt vmcnt(6)
    ds_read_b64_tr_b16 v[176:177], v244 offset:0
    ds_read_b64_tr_b16 v[178:179], v244 offset:1024
    ds_read_b64_tr_b16 v[180:181], v245 offset:0
    ds_read_b64_tr_b16 v[182:183], v245 offset:1024
    v_fmac_f32 v198, v22, v118
    v_fmac_f32 v198, v23, v119
    v_add_f32 v254, v202, v254
    v_mul_f32 v196, v24, v160
    v_fmac_f32 v196, v25, v161
    v_mfma_f32_32x32x16_bf16 v[32:47], v[88:91], v[192:195], v[32:47]
    v_fmac_f32 v196, v26, v162
    v_fmac_f32 v196, v27, v163
    v_fmac_f32 v196, v28, v164
    v_fmac_f32 v196, v29, v165
    v_fmac_f32 v196, v30, v166
    v_mfma_f32_32x32x16_bf16 v[48:63], v[92:95], v[192:195], v[48:63]
    v_add_u32 v249, s48, v249
    v_add_u32 v250, s49, v250
    ds_read_b32 v252, v251 offset:16
    ds_read_b64_tr_b16 v[64:65], v249 offset:0
    ds_read_b64_tr_b16 v[68:69], v249 offset:64
    ds_read_b64_tr_b16 v[66:67], v249 offset:256
    ds_read_b64_tr_b16 v[70:71], v249 offset:320
    s_mov_b64 exec, s[54:55]
    ds_read_u16_d16_hi v242, v250 offset:0
    s_mov_b64 exec, -1
    v_fmac_f32 v196, v31, v167
    s_nop 1
    v_permlane32_swap_b32 v198, v196
    v_add_f32 v196, v198, v196
    v_mul_f32 v255, v32, v152
    v_fmac_f32 v255, v33, v153
    v_fmac_f32 v255, v34, v154
    v_fmac_f32 v255, v35, v155
    v_fmac_f32 v255, v36, v156
    v_fmac_f32 v255, v37, v157
    v_fmac_f32 v255, v38, v158
    v_fmac_f32 v255, v39, v159
    v_fma_f32 v203, v40, -v168, v203
    v_fma_f32 v203, v41, -v169, v203
    v_permlane32_swap_b32 v255, v201
    v_fma_f32 v203, v42, -v170, v203
    v_fma_f32 v203, v43, -v171, v203
    v_fma_f32 v203, v44, -v172, v203
    v_fma_f32 v203, v45, -v173, v203
    v_fma_f32 v203, v46, -v174, v203
    v_fma_f32 v203, v47, -v175, v203
    v_add_f32 v201, v255, v201
    v_fmac_f32 v199, v48, v120
    v_permlane32_swap_b32 v203, v255
    v_fmac_f32 v199, v49, v121
    v_fmac_f32 v199, v50, v122
    v_fmac_f32 v199, v51, v123
    v_fmac_f32 v199, v52, v124
    v_fmac_f32 v199, v53, v125
    v_fmac_f32 v199, v54, v126
    v_fmac_f32 v199, v55, v127
    v_add_f32 v255, v203, v255
    v_mul_f32 v197, v56, v168
    v_fmac_f32 v197, v57, v169
    v_fmac_f32 v197, v58, v170
    v_fmac_f32 v197, v59, v171
    v_fmac_f32 v197, v60, v172
    v_fmac_f32 v197, v61, v173
    v_fmac_f32 v197, v62, v174
    v_fmac_f32 v197, v63, v175
    s_nop 1
    v_permlane32_swap_b32 v199, v197
    v_add_f32 v197, v199, v197
    v_cvt_pk_bf16_f32 v200, v200, v201
    v_cvt_pk_bf16_f32 v254, v254, v255
    v_cvt_pk_bf16_f32 v196, v196, v197
    ds_write_b32 v253, v200 offset:768
    s_mov_b64 exec, 0xffffffff
    ds_write_b32 v253, v254 offset:1280
    s_mov_b64 exec, -1
    ds_write_b32 v253, v196 offset:1024
    s_add_u32 s50, s50, 1
    s_cmp_ge_u32 s50, 5
    s_cbranch_scc1 TAIL
    s_waitcnt lgkmcnt(8)
    v_readfirstlane_b32 s66, v252
    s_add_u32 s53, s53, 1
    v_mov_b32 v252, s53
    s_cmp_le_u32 s53, s66
    ds_write2_b32 v251, v252, v252 offset0:0 offset1:8
    s_setprio 1
    s_cbranch_scc1 PRIO_14
    s_setprio 0
PRIO_14:
    s_cmp_eq_u32 s52, 4
    s_cbranch_scc1 ITEM_1_4
    s_cmp_eq_u32 s52, 5
    s_cbranch_scc1 ITEM_1_5
    s_cmp_eq_u32 s52, 3
    s_cbranch_scc1 ITEM_1_3
    s_cmp_eq_u32 s52, 6
    s_cbranch_scc1 ITEM_1_6
    s_cmp_eq_u32 s52, 8
    s_cbranch_scc1 ITEM_1_8
    s_branch ITEM_1_2
.p2align 6
ITEM_1_2:
    s_mov_b32 m0, s50
    s_nop 0
    s_movrels_b32 s71, s23
    s_movrels_b32 s33, s28
    s_and_b32 s70, s33, 0x70
    s_andn2_b32 s33, s33, 0x70
    v_xor_b32 v253, s70, v248
    v_add_u32 v253, s33, v253
    s_bfe_u32 s46, s71, 0x30012
    s_mov_b32 m0, s46
    s_and_b32 s66, s71, 0x3ffff
    s_movrels_b32 s68, s57
    s_movrels_b32 s69, s61
    s_sub_u32 s48, s66, s47
    s_mov_b32 s47, s66
    s_lshr_b32 s52, s71, 28
    s_lshl_b32 s67, s46, 9
    s_add_u32 s66, s66, s67
    s_sub_u32 s49, s66, s42
    s_mov_b32 s42, s66
    s_bfe_u32 s66, s68, 655360
    s_add_u32 s43, s42, s66
    s_bfe_u32 s39, s69, 655360
    s_bfe_u32 s66, s68, 655370
    s_add_u32 s44, s42, s66
    s_bfe_u32 s40, s69, 655370
    s_bfe_u32 s66, s68, 655380
    s_add_u32 s45, s42, s66
    s_bfe_u32 s41, s69, 655380
    v_add_u32 v252, s42, v247
    ds_read_u16 v234, v252
    ds_read_u16 v235, v252 offset:64
    v_add_u32 v252, s43, v247
    ds_read_u16 v236, v252
    ds_read_u16 v237, v252 offset:64
    v_add_u32 v252, s44, v247
    ds_read_u16 v238, v252
    ds_read_u16 v239, v252 offset:64
    v_add_u32 v252, s45, v247
    ds_read_u16 v240, v252
    ds_read_u16 v241, v252 offset:64
    s_waitcnt lgkmcnt(8)
    v_mul_f32_dpp v196, v242, v64 row_newbcast:0 row_mask:0xf bank_mask:0xf
    v_mul_f32_dpp v197, v242, v65 row_newbcast:1 row_mask:0xf bank_mask:0xf
    v_mul_f32_dpp v198, v242, v64 row_newbcast:8 row_mask:0xf bank_mask:0xf
    v_mul_f32_dpp v199, v242, v65 row_newbcast:9 row_mask:0xf bank_mask:0xf
    v_mul_f32_dpp v200, v242, v68 row_newbcast:2 row_mask:0xf bank_mask:0xf
    v_mul_f32_dpp v201, v242, v69 row_newbcast:3 row_mask:0xf bank_mask:0xf
    v_mul_f32_dpp v202, v242, v68 row_newbcast:10 row_mask:0xf bank_mask:0xf
    v_mul_f32_dpp v203, v242, v69 row_newbcast:11 row_mask:0xf bank_mask:0xf
    v_cvt_pk_bf16_f32 v64, v196, v197
    v_cvt_pk_bf16_f32 v68, v198, v199
    v_cvt_pk_bf16_f32 v65, v200, v201
    v_cvt_pk_bf16_f32 v69, v202, v203
    v_mul_f32_dpp v196, v242, v66 row_newbcast:4 row_mask:0xf bank_mask:0xf
    v_mul_f32_dpp v197, v242, v67 row_newbcast:5 row_mask:0xf bank_mask:0xf
    v_mul_f32_dpp v198, v242, v66 row_newbcast:12 row_mask:0xf bank_mask:0xf
    v_mul_f32_dpp v199, v242, v67 row_newbcast:13 row_mask:0xf bank_mask:0xf
    v_mul_f32_dpp v200, v242, v70 row_newbcast:6 row_mask:0xf bank_mask:0xf
    v_mul_f32_dpp v201, v242, v71 row_newbcast:7 row_mask:0xf bank_mask:0xf
    v_mul_f32_dpp v202, v242, v70 row_newbcast:14 row_mask:0xf bank_mask:0xf
    v_mul_f32_dpp v203, v242, v71 row_newbcast:15 row_mask:0xf bank_mask:0xf
    v_cvt_pk_bf16_f32 v66, v196, v197
    v_cvt_pk_bf16_f32 v70, v198, v199
    v_cvt_pk_bf16_f32 v67, v200, v201
    v_cvt_pk_bf16_f32 v71, v202, v203
    s_nop 0
    s_waitcnt lgkmcnt(6)
    v_mfma_f32_32x32x16_bf16 v[0:15], v[64:67], v[176:179], 0
    s_add_u32 m0, s21, 0
    v_mfma_f32_32x32x16_bf16 v[16:31], v[68:71], v[176:179], 0
    v_lshl_add_u32 v234, v234, 10, v246
    v_lshl_add_u32 v235, v235, 10, v246
    buffer_load_dwordx4 v234, s[4:7], s38 offen lds
    buffer_load_dwordx4 v235, s[8:11], s38 offen offset:1024 lds
    v_mfma_f32_32x32x16_bf16 v[32:47], v[64:67], v[180:183], 0
    s_nop 4
    v_mul_f32 v196, v0, v96
    v_fmac_f32 v196, v1, v97
    v_fmac_f32 v196, v2, v98
    v_fmac_f32 v196, v3, v99
    v_fmac_f32 v196, v4, v100
    v_fmac_f32 v196, v5, v101
    v_fmac_f32 v196, v6, v102
    v_fmac_f32 v196, v7, v103
    v_mul_f32 v198, v8, v128
    v_fmac_f32 v198, v9, v129
    v_fmac_f32 v198, v10, v130
    v_fmac_f32 v198, v11, v131
    v_fmac_f32 v198, v12, v132
    v_fmac_f32 v198, v13, v133
    v_fmac_f32 v198, v14, v134
    v_fmac_f32 v198, v15, v135
    v_mul_f32 v200, v16, v128
    v_fmac_f32 v200, v17, v129
    v_permlane32_swap_b32 v196, v198
    v_mfma_f32_32x32x16_bf16 v[48:63], v[68:71], v[180:183], 0
    s_waitcnt vmcnt(6)
    ds_read_b64_tr_b16 v[176:177], v244 offset:2048
    ds_read_b64_tr_b16 v[178:179], v244 offset:3072
    ds_read_b64_tr_b16 v[180:181], v245 offset:2048
    ds_read_b64_tr_b16 v[182:183], v245 offset:3072
    v_fmac_f32 v200, v18, v130
    v_fmac_f32 v200, v19, v131
    v_fmac_f32 v200, v20, v132
    v_fmac_f32 v200, v21, v133
    v_fmac_f32 v200, v22, v134
    v_fmac_f32 v200, v23, v135
    v_add_f32 v198, v196, v198
    v_mul_f32_e64 v202, v24, -v128
    v_fma_f32 v202, v25, -v129, v202
    v_fma_f32 v202, v26, -v130, v202
    v_fma_f32 v202, v27, -v131, v202
    v_fma_f32 v202, v28, -v132, v202
    v_fma_f32 v202, v29, -v133, v202
    v_fma_f32 v202, v30, -v134, v202
    v_fma_f32 v202, v31, -v135, v202
    s_nop 1
    v_permlane32_swap_b32 v200, v202
    v_add_f32 v202, v200, v202
    s_waitcnt lgkmcnt(0)
    v_mfma_f32_32x32x16_bf16 v[0:15], v[64:67], v[176:179], 0
    v_mul_f32 v197, v32, v104
    v_fmac_f32 v197, v33, v105
    v_fmac_f32 v197, v34, v106
    v_fmac_f32 v197, v35, v107
    v_fmac_f32 v197, v36, v108
    v_fmac_f32 v197, v37, v109
    v_fmac_f32 v197, v38, v110
    v_fmac_f32 v197, v39, v111
    v_mul_f32 v199, v40, v136
    v_fmac_f32 v199, v41, v137
    v_fmac_f32 v199, v42, v138
    v_fmac_f32 v199, v43, v139
    v_fmac_f32 v199, v44, v140
    v_fmac_f32 v199, v45, v141
    v_fmac_f32 v199, v46, v142
    v_fmac_f32 v199, v47, v143
    v_mul_f32 v201, v48, v136
    v_fmac_f32 v201, v49, v137
    v_permlane32_swap_b32 v197, v199
    v_fmac_f32 v201, v50, v138
    v_fmac_f32 v201, v51, v139
    s_add_u32 m0, s21, 2048
    v_mfma_f32_32x32x16_bf16 v[16:31], v[68:71], v[176:179], 0
    v_lshl_add_u32 v236, v236, 10, v246
    v_lshl_add_u32 v237, v237, 10, v246
    buffer_load_dwordx4 v236, s[4:7], s39 offen lds
    buffer_load_dwordx4 v237, s[8:11], s39 offen offset:1024 lds
    v_fmac_f32 v201, v52, v140
    v_fmac_f32 v201, v53, v141
    v_fmac_f32 v201, v54, v142
    v_fmac_f32 v201, v55, v143
    v_add_f32 v199, v197, v199
    v_mul_f32_e64 v203, v56, -v136
    v_fma_f32 v203, v57, -v137, v203
    v_fma_f32 v203, v58, -v138, v203
    v_fma_f32 v203, v59, -v139, v203
    v_fma_f32 v203, v60, -v140, v203
    v_fma_f32 v203, v61, -v141, v203
    v_fma_f32 v203, v62, -v142, v203
    v_fma_f32 v203, v63, -v143, v203
    s_nop 1
    v_permlane32_swap_b32 v201, v203
    v_add_f32 v203, v201, v203
    v_cvt_pk_bf16_f32 v198, v198, v199
    v_cvt_pk_bf16_f32 v202, v202, v203
    ds_write_b32 v253, v198 offset:0
    ds_write_b32 v253, v202 offset:256
    v_mfma_f32_32x32x16_bf16 v[32:47], v[64:67], v[180:183], 0
    v_mul_f32 v196, v0, v144
    v_fmac_f32 v196, v1, v145
    v_fmac_f32 v196, v2, v146
    v_fmac_f32 v196, v3, v147
    v_fmac_f32 v196, v4, v148
    v_fmac_f32 v196, v5, v149
    v_fmac_f32 v196, v6, v150
    v_fmac_f32 v196, v7, v151
    v_mul_f32 v198, v8, v112
    v_fmac_f32 v198, v9, v113
    v_fmac_f32 v198, v10, v114
    v_fmac_f32 v198, v11, v115
    v_fmac_f32 v198, v12, v116
    v_fmac_f32 v198, v13, v117
    v_fmac_f32 v198, v14, v118
    v_fmac_f32 v198, v15, v119
    v_mfma_f32_32x32x16_bf16 v[48:63], v[68:71], v[180:183], 0
    s_waitcnt vmcnt(6)
    ds_read_b64_tr_b16 v[176:177], v244 offset:4096
    ds_read_b64_tr_b16 v[178:179], v244 offset:5120
    ds_read_b64_tr_b16 v[180:181], v245 offset:4096
    ds_read_b64_tr_b16 v[182:183], v245 offset:5120
    v_mul_f32_e64 v200, v16, -v160
    v_fma_f32 v200, v17, -v161, v200
    v_fma_f32 v200, v18, -v162, v200
    v_fma_f32 v200, v19, -v163, v200
    v_fma_f32 v200, v20, -v164, v200
    v_fma_f32 v200, v21, -v165, v200
    v_fma_f32 v200, v22, -v166, v200
    v_fma_f32 v200, v23, -v167, v200
    v_mul_f32_e64 v202, v24, -v160
    v_fma_f32 v202, v25, -v161, v202
    v_fma_f32 v202, v26, -v162, v202
    v_fma_f32 v202, v27, -v163, v202
    v_fma_f32 v202, v28, -v164, v202
    v_fma_f32 v202, v29, -v165, v202
    v_fma_f32 v202, v30, -v166, v202
    v_fma_f32 v202, v31, -v167, v202
    s_waitcnt lgkmcnt(0)
    v_mfma_f32_32x32x16_bf16 v[0:15], v[64:67], v[176:179], 0
    v_mul_f32 v197, v32, v152
    v_fmac_f32 v197, v33, v153
    v_fmac_f32 v197, v34, v154
    v_fmac_f32 v197, v35, v155
    v_fmac_f32 v197, v36, v156
    v_fmac_f32 v197, v37, v157
    v_fmac_f32 v197, v38, v158
    v_fmac_f32 v197, v39, v159
    v_mul_f32 v199, v40, v120
    v_fmac_f32 v199, v41, v121
    v_fmac_f32 v199, v42, v122
    v_fmac_f32 v199, v43, v123
    v_fmac_f32 v199, v44, v124
    v_fmac_f32 v199, v45, v125
    v_fmac_f32 v199, v46, v126
    v_fmac_f32 v199, v47, v127
    s_add_u32 m0, s21, 4096
    v_mfma_f32_32x32x16_bf16 v[16:31], v[68:71], v[176:179], 0
    v_lshl_add_u32 v238, v238, 10, v246
    v_lshl_add_u32 v239, v239, 10, v246
    buffer_load_dwordx4 v238, s[4:7], s40 offen lds
    buffer_load_dwordx4 v239, s[8:11], s40 offen offset:1024 lds
    v_mul_f32_e64 v201, v48, -v168
    v_fma_f32 v201, v49, -v169, v201
    v_fma_f32 v201, v50, -v170, v201
    v_fma_f32 v201, v51, -v171, v201
    v_fma_f32 v201, v52, -v172, v201
    v_fma_f32 v201, v53, -v173, v201
    v_fma_f32 v201, v54, -v174, v201
    v_fma_f32 v201, v55, -v175, v201
    v_mul_f32_e64 v203, v56, -v168
    v_fma_f32 v203, v57, -v169, v203
    v_fma_f32 v203, v58, -v170, v203
    v_fma_f32 v203, v59, -v171, v203
    v_fma_f32 v203, v60, -v172, v203
    v_fma_f32 v203, v61, -v173, v203
    v_fma_f32 v203, v62, -v174, v203
    v_fma_f32 v203, v63, -v175, v203
    v_mfma_f32_32x32x16_bf16 v[32:47], v[64:67], v[180:183], 0
    v_mul_f32 v254, v0, v144
    v_fmac_f32 v254, v1, v145
    v_fmac_f32 v254, v2, v146
    v_fmac_f32 v254, v3, v147
    v_fmac_f32 v254, v4, v148
    v_fmac_f32 v254, v5, v149
    v_fmac_f32 v254, v6, v150
    v_fmac_f32 v254, v7, v151
    v_fmac_f32 v200, v8, v160
    v_mfma_f32_32x32x16_bf16 v[48:63], v[68:71], v[180:183], 0
    ds_swizzle_b32 v68, v68 offset:0x401F
    ds_swizzle_b32 v69, v69 offset:0x401F
    ds_swizzle_b32 v70, v70 offset:0x401F
    ds_swizzle_b32 v71, v71 offset:0x401F
    s_waitcnt vmcnt(6)
    ds_read_b64_tr_b16 v[176:177], v244 offset:6144
    ds_read_b64_tr_b16 v[178:179], v244 offset:7168
    ds_read_b64_tr_b16 v[180:181], v245 offset:6144
    ds_read_b64_tr_b16 v[182:183], v245 offset:7168
    v_fmac_f32 v200, v9, v161
    v_permlane32_swap_b32 v196, v254
    v_fmac_f32 v200, v10, v162
    v_fmac_f32 v200, v11, v163
    v_fmac_f32 v200, v12, v164
    v_fmac_f32 v200, v13, v165
    v_fmac_f32 v200, v14, v166
    v_fmac_f32 v200, v15, v167
    v_add_f32 v254, v196, v254
    s_waitcnt lgkmcnt(0)
    s_mov_b64 exec, s[56:57]
    v_xor_b32 v68, 0x80008000, v68
    v_xor_b32 v69, 0x80008000, v69
    v_xor_b32 v70, 0x80008000, v70
    v_xor_b32 v71, 0x80008000, v71
    s_mov_b64 exec, -1
    s_nop 0
    v_mfma_f32_32x32x16_bf16 v[0:15], v[64:67], v[176:179], 0
    v_mul_f32 v255, v32, v152
    v_fmac_f32 v255, v33, v153
    v_fmac_f32 v255, v34, v154
    v_fmac_f32 v255, v35, v155
    v_fmac_f32 v255, v36, v156
    v_fmac_f32 v255, v37, v157
    v_fmac_f32 v255, v38, v158
    v_fmac_f32 v255, v39, v159
    v_fmac_f32 v201, v40, v168
    v_fmac_f32 v201, v41, v169
    s_add_u32 m0, s21, 6144
    v_mfma_f32_32x32x16_bf16 v[16:31], v[68:71], v[176:179], v[16:31]
    v_lshl_add_u32 v240, v240, 10, v246
    v_lshl_add_u32 v241, v241, 10, v246
    buffer_load_dwordx4 v240, s[4:7], s41 offen lds
    buffer_load_dwordx4 v241, s[8:11], s41 offen offset:1024 lds
    v_permlane32_swap_b32 v197, v255
    v_fmac_f32 v201, v42, v170
    v_fmac_f32 v201, v43, v171
    v_fmac_f32 v201, v44, v172
    v_fmac_f32 v201, v45, v173
    v_fmac_f32 v201, v46, v174
    v_fmac_f32 v201, v47, v175
    v_add_f32 v255, v197, v255
    v_cvt_pk_bf16_f32 v254, v254, v255
    ds_write_b32 v253, v254 offset:512
    v_mfma_f32_32x32x16_bf16 v[32:47], v[64:67], v[180:183], 0
    v_mul_f32 v254, v0, v144
    v_fmac_f32 v254, v1, v145
    v_fmac_f32 v254, v2, v146
    v_fmac_f32 v254, v3, v147
    v_fmac_f32 v254, v4, v148
    v_fmac_f32 v254, v5, v149
    v_fmac_f32 v254, v6, v150
    v_fmac_f32 v254, v7, v151
    v_fma_f32 v202, v8, -v160, v202
    v_fma_f32 v202, v9, -v161, v202
    v_permlane32_swap_b32 v254, v200
    v_fma_f32 v202, v10, -v162, v202
    v_fma_f32 v202, v11, -v163, v202
    v_fma_f32 v202, v12, -v164, v202
    v_fma_f32 v202, v13, -v165, v202
    v_fma_f32 v202, v14, -v166, v202
    v_fma_f32 v202, v15, -v167, v202
    v_add_f32 v200, v254, v200
    v_fmac_f32 v198, v16, v112
    v_permlane32_swap_b32 v202, v254
    v_mfma_f32_32x32x16_bf16 v[48:63], v[68:71], v[180:183], v[48:63]
    s_waitcnt vmcnt(6)
    ds_read_b64_tr_b16 v[176:177], v244 offset:0
    ds_read_b64_tr_b16 v[178:179], v244 offset:1024
    ds_read_b64_tr_b16 v[180:181], v245 offset:0
    ds_read_b64_tr_b16 v[182:183], v245 offset:1024
    v_add_u32 v249, s48, v249
    v_add_u32 v250, s49, v250
    ds_read_b32 v252, v251 offset:16
    ds_read_b64_tr_b16 v[64:65], v249 offset:0
    ds_read_b64_tr_b16 v[68:69], v249 offset:64
    ds_read_b64_tr_b16 v[66:67], v249 offset:256
    ds_read_b64_tr_b16 v[70:71], v249 offset:320
    s_mov_b64 exec, s[54:55]
    ds_read_u16_d16_hi v242, v250 offset:0
    s_mov_b64 exec, -1
    v_fmac_f32 v198, v17, v113
    v_fmac_f32 v198, v18, v114
    v_fmac_f32 v198, v19, v115
    v_fmac_f32 v198, v20, v116
    v_fmac_f32 v198, v21, v117
    v_fmac_f32 v198, v22, v118
    v_fmac_f32 v198, v23, v119
    v_add_f32 v254, v202, v254
    v_mul_f32 v196, v24, v160
    v_fmac_f32 v196, v25, v161
    v_fmac_f32 v196, v26, v162
    v_fmac_f32 v196, v27, v163
    v_fmac_f32 v196, v28, v164
    v_fmac_f32 v196, v29, v165
    v_fmac_f32 v196, v30, v166
    v_fmac_f32 v196, v31, v167
    s_nop 1
    v_permlane32_swap_b32 v198, v196
    v_add_f32 v196, v198, v196
    v_mul_f32 v255, v32, v152
    v_fmac_f32 v255, v33, v153
    v_fmac_f32 v255, v34, v154
    v_fmac_f32 v255, v35, v155
    v_fmac_f32 v255, v36, v156
    v_fmac_f32 v255, v37, v157
    v_fmac_f32 v255, v38, v158
    v_fmac_f32 v255, v39, v159
    v_fma_f32 v203, v40, -v168, v203
    v_fma_f32 v203, v41, -v169, v203
    v_permlane32_swap_b32 v255, v201
    v_fma_f32 v203, v42, -v170, v203
    v_fma_f32 v203, v43, -v171, v203
    v_fma_f32 v203, v44, -v172, v203
    v_fma_f32 v203, v45, -v173, v203
    v_fma_f32 v203, v46, -v174, v203
    v_fma_f32 v203, v47, -v175, v203
    v_add_f32 v201, v255, v201
    v_fmac_f32 v199, v48, v120
    v_permlane32_swap_b32 v203, v255
    v_fmac_f32 v199, v49, v121
    v_fmac_f32 v199, v50, v122
    v_fmac_f32 v199, v51, v123
    v_fmac_f32 v199, v52, v124
    v_fmac_f32 v199, v53, v125
    v_fmac_f32 v199, v54, v126
    v_fmac_f32 v199, v55, v127
    v_add_f32 v255, v203, v255
    v_mul_f32 v197, v56, v168
    v_fmac_f32 v197, v57, v169
    v_fmac_f32 v197, v58, v170
    v_fmac_f32 v197, v59, v171
    v_fmac_f32 v197, v60, v172
    v_fmac_f32 v197, v61, v173
    v_fmac_f32 v197, v62, v174
    v_fmac_f32 v197, v63, v175
    s_nop 1
    v_permlane32_swap_b32 v199, v197
    v_add_f32 v197, v199, v197
    v_cvt_pk_bf16_f32 v200, v200, v201
    v_cvt_pk_bf16_f32 v254, v254, v255
    v_cvt_pk_bf16_f32 v196, v196, v197
    ds_write_b32 v253, v200 offset:768
    s_mov_b64 exec, 0xffffffff
    ds_write_b32 v253, v254 offset:1280
    s_mov_b64 exec, -1
    ds_write_b32 v253, v196 offset:1024
    s_add_u32 s50, s50, 1
    s_cmp_ge_u32 s50, 5
    s_cbranch_scc1 TAIL
    s_waitcnt lgkmcnt(8)
    v_readfirstlane_b32 s66, v252
    s_add_u32 s53, s53, 1
    v_mov_b32 v252, s53
    s_cmp_le_u32 s53, s66
    ds_write2_b32 v251, v252, v252 offset0:0 offset1:8
    s_setprio 1
    s_cbranch_scc1 PRIO_15
    s_setprio 0
PRIO_15:
    s_cmp_eq_u32 s52, 4
    s_cbranch_scc1 ITEM_1_4
    s_cmp_eq_u32 s52, 5
    s_cbranch_scc1 ITEM_1_5
    s_cmp_eq_u32 s52, 3
    s_cbranch_scc1 ITEM_1_3
    s_cmp_eq_u32 s52, 6
    s_cbranch_scc1 ITEM_1_6
    s_cmp_eq_u32 s52, 8
    s_cbranch_scc1 ITEM_1_8
    s_branch ITEM_1_2
.p2align 6
TAIL:
    s_setprio 0
    s_waitcnt vmcnt(0) lgkmcnt(0)
    v_mbcnt_lo_u32_b32 v176, -1, 0
    v_mbcnt_hi_u32_b32 v176, -1, v176
    v_lshlrev_b32 v180, 4, v176
    s_cmp_eq_u32 s89, 0
    s_cbranch_scc1 T_flags
    s_mul_i32 s66, s20, 80
    v_lshlrev_b32 v2, 2, v176
    v_min_u32 v2, 76, v2
    s_mov_b32 s67, 262144
T_poll:
    buffer_load_dword v3, v2, s[16:19], s66 offen offset:128 sc1
    s_waitcnt vmcnt(0)
    v_cmp_ne_u32 vcc, s88, v3
    s_sub_u32 s67, s67, 1
    s_cselect_b64 vcc, 0, vcc
    s_cmp_eq_u64 vcc, 0
    s_cbranch_scc0 T_poll
    s_mov_b32 s89, 0
T_flags:
    s_mul_i32 s66, s20, 20480
    s_add_u32 s66, s66, 1024
    buffer_load_dwordx4 v[96:99], v180, s[16:19], s66 offen offset:0 sc1
    buffer_load_dwordx4 v[100:103], v180, s[16:19], s66 offen offset:1024 sc1
    buffer_load_dwordx4 v[104:107], v180, s[16:19], s66 offen offset:2048 sc1
    buffer_load_dwordx4 v[108:111], v180, s[16:19], s66 offen offset:3072 sc1
    s_add_u32 s66, s66, 4096
    buffer_load_dwordx4 v[112:115], v180, s[16:19], s66 offen offset:0 sc1
    buffer_load_dwordx4 v[116:119], v180, s[16:19], s66 offen offset:1024 sc1
    buffer_load_dwordx4 v[120:123], v180, s[16:19], s66 offen offset:2048 sc1
    buffer_load_dwordx4 v[124:127], v180, s[16:19], s66 offen offset:3072 sc1
    s_add_u32 s66, s66, 4096
    buffer_load_dwordx4 v[128:131], v180, s[16:19], s66 offen offset:0 sc1
    buffer_load_dwordx4 v[132:135], v180, s[16:19], s66 offen offset:1024 sc1
    buffer_load_dwordx4 v[136:139], v180, s[16:19], s66 offen offset:2048 sc1
    buffer_load_dwordx4 v[140:143], v180, s[16:19], s66 offen offset:3072 sc1
    s_add_u32 s66, s66, 4096
    buffer_load_dwordx4 v[144:147], v180, s[16:19], s66 offen offset:0 sc1
    buffer_load_dwordx4 v[148:151], v180, s[16:19], s66 offen offset:1024 sc1
    buffer_load_dwordx4 v[152:155], v180, s[16:19], s66 offen offset:2048 sc1
    buffer_load_dwordx4 v[156:159], v180, s[16:19], s66 offen offset:3072 sc1
    s_add_u32 s66, s66, 4096
    buffer_load_dwordx4 v[160:163], v180, s[16:19], s66 offen offset:0 sc1
    buffer_load_dwordx4 v[164:167], v180, s[16:19], s66 offen offset:1024 sc1
    buffer_load_dwordx4 v[168:171], v180, s[16:19], s66 offen offset:2048 sc1
    buffer_load_dwordx4 v[172:175], v180, s[16:19], s66 offen offset:3072 sc1
    v_lshlrev_b32 v181, 2, v176
    s_bfe_u32 s67, s22, 0x40015
    s_lshl_b32 s67, s67, 4
    s_and_b32 s68, s67, 128
    s_and_b32 s67, s67, 0x70
    s_add_u32 s68, s68, s21
    v_xor_b32 v180, s67, v181
    v_add_u32 v180, s68, v180
    ds_write_b32 v180, v204 offset:0
    ds_write_b32 v180, v205 offset:256
    ds_write_b32 v180, v206 offset:512
    ds_write_b32 v180, v207 offset:768
    ds_write_b32 v180, v208 offset:1024
    ds_write_b32 v180, v209 offset:1280
    s_bfe_u32 s67, s23, 0x40015
    s_lshl_b32 s67, s67, 4
    s_and_b32 s68, s67, 128
    s_and_b32 s67, s67, 0x70
    s_add_u32 s68, s68, s21
    v_xor_b32 v180, s67, v181
    v_add_u32 v180, s68, v180
    ds_write_b32 v180, v210 offset:1536
    ds_write_b32 v180, v211 offset:1792
    ds_write_b32 v180, v212 offset:2048
    ds_write_b32 v180, v213 offset:2304
    ds_write_b32 v180, v214 offset:2560
    ds_write_b32 v180, v215 offset:2816
    s_bfe_u32 s67, s24, 0x40015
    s_lshl_b32 s67, s67, 4
    s_and_b32 s68, s67, 128
    s_and_b32 s67, s67, 0x70
    s_add_u32 s68, s68, s21
    v_xor_b32 v180, s67, v181
    v_add_u32 v180, s68, v180
    ds_write_b32 v180, v216 offset:3072
    ds_write_b32 v180, v217 offset:3328
    ds_write_b32 v180, v218 offset:3584
    ds_write_b32 v180, v219 offset:3840
    ds_write_b32 v180, v220 offset:4096
    ds_write_b32 v180, v221 offset:4352
    s_bfe_u32 s67, s25, 0x40015
    s_lshl_b32 s67, s67, 4
    s_and_b32 s68, s67, 128
    s_and_b32 s67, s67, 0x70
    s_add_u32 s68, s68, s21
    v_xor_b32 v180, s67, v181
    v_add_u32 v180, s68, v180
    ds_write_b32 v180, v222 offset:4608
    ds_write_b32 v180, v223 offset:4864
    ds_write_b32 v180, v224 offset:5120
    ds_write_b32 v180, v225 offset:5376
    ds_write_b32 v180, v226 offset:5632
    ds_write_b32 v180, v227 offset:5888
    s_bfe_u32 s67, s26, 0x40015
    s_lshl_b32 s67, s67, 4
    s_and_b32 s68, s67, 128
    s_and_b32 s67, s67, 0x70
    s_add_u32 s68, s68, s21
    v_xor_b32 v180, s67, v181
    v_add_u32 v180, s68, v180
    ds_write_b32 v180, v228 offset:6144
    ds_write_b32 v180, v229 offset:6400
    ds_write_b32 v180, v230 offset:6656
    ds_write_b32 v180, v231 offset:6912
    ds_write_b32 v180, v232 offset:7168
    ds_write_b32 v180, v233 offset:7424
GEMM:
    s_load_dwordx2 s[72:73], s[0:1], 72
    v_and_b32 v177, 15, v176
    v_lshrrev_b32 v178, 4, v176
    v_and_b32 v179, 7, v177
    v_lshlrev_b32 v180, 3, v177
    v_lshlrev_b32 v181, 3, v179
    v_add_u32 v180, 163328, v180
    v_add_u32 v181, 163328, v181
    ds_read_b64 v[182:183], v180
    ds_read_b64 v[184:185], v180 offset:128
    ds_read_b64 v[186:187], v181 offset:256
    v_xor_b32 v180, v179, v178
    v_and_b32 v181, 8, v177
    v_xor_b32 v188, 4, v180
    v_add_u32 v189, v188, v181
    v_add_u32 v181, v180, v181
    s_waitcnt lgkmcnt(0)
    s_mov_b32 s4, s72
    s_and_b32 s5, s73, 0xffff
    s_mov_b32 s6, 10240000
    s_mov_b32 s7, 0x20000
    v_lshl_add_u32 v48, v180, 4, v182
    v_lshl_add_u32 v49, v188, 4, v182
    v_lshl_add_u32 v50, v180, 4, v183
    v_lshl_add_u32 v51, v188, 4, v183
    v_lshl_add_u32 v52, v180, 4, v184
    v_lshl_add_u32 v53, v188, 4, v184
    v_lshl_add_u32 v54, v180, 4, v185
    v_lshl_add_u32 v55, v188, 4, v185
    v_lshl_add_u32 v56, v181, 4, v186
    v_lshl_add_u32 v57, v189, 4, v186
    v_lshl_add_u32 v58, v181, 4, v187
    v_lshl_add_u32 v59, v189, 4, v187
    s_mov_b32 s67, 0xbfb8aa3b
    s_barrier
    ds_read_b128 v[76:79], v48 offset:0
    ds_read_b128 v[80:83], v52 offset:0
    ds_read_b128 v[84:87], v56 offset:0
    ds_read_b128 v[88:91], v49 offset:0
    ds_read_b128 v[92:95], v53 offset:0
    s_waitcnt vmcnt(19) lgkmcnt(4)
    v_mfma_f32_16x16x32_bf16 v[0:3], v[96:99], v[76:79], 0
    v_lshrrev_b32 v205, 1, v178
    v_lshl_add_u32 v205, s20, 1, v205
    ds_read_b128 v[76:79], v57 offset:0
    s_waitcnt lgkmcnt(4)
    v_mfma_f32_16x16x32_bf16 v[4:7], v[96:99], v[80:83], 0
    v_and_b32 v204, 7, v177
    v_xor_b32 v205, v205, v204
    ds_read_b128 v[80:83], v50 offset:0
    s_waitcnt lgkmcnt(4)
    v_mfma_f32_16x16x32_bf16 v[8:11], v[96:99], v[84:87], 0
    v_and_b32 v204, 1, v178
    v_lshlrev_b32 v204, 3, v204
    ds_read_b128 v[84:87], v54 offset:0
    s_waitcnt vmcnt(18) lgkmcnt(4)
    v_mfma_f32_16x16x32_bf16 v[0:3], v[100:103], v[88:91], v[0:3]
    v_lshl_add_u32 v205, v205, 4, v204
    v_and_b32 v204, 8, v177
    ds_read_b128 v[88:91], v58 offset:0
    s_waitcnt lgkmcnt(4)
    v_mfma_f32_16x16x32_bf16 v[4:7], v[100:103], v[92:95], v[4:7]
    v_lshl_add_u32 v204, v204, 4, v205
    v_lshl_add_u32 v204, v177, 10, v204
    ds_read_b128 v[92:95], v51 offset:0
    s_waitcnt lgkmcnt(4)
    v_mfma_f32_16x16x32_bf16 v[8:11], v[100:103], v[76:79], v[8:11]
    v_add_u32 v204, 65536, v204
    v_add_u32 v205, v205, v182
    ds_read_b128 v[76:79], v55 offset:0
    s_waitcnt vmcnt(17) lgkmcnt(4)
    v_mfma_f32_16x16x32_bf16 v[0:3], v[104:107], v[80:83], v[0:3]
    v_and_b32 v220, 8, v177
    v_mul_u32_u24 v220, 1008, v220
    ds_read_b128 v[80:83], v59 offset:0
    s_waitcnt lgkmcnt(4)
    v_mfma_f32_16x16x32_bf16 v[4:7], v[104:107], v[84:87], v[4:7]
    v_sub_u32 v220, v204, v220
    v_lshlrev_b32 v210, 4, v176
    ds_read_b128 v[84:87], v48 offset:1024
    s_waitcnt lgkmcnt(4)
    v_mfma_f32_16x16x32_bf16 v[8:11], v[104:107], v[88:91], v[8:11]
    s_lshl_b32 s68, s20, 1
    s_add_u32 s69, s68, 1
    ds_read_b128 v[88:91], v52 offset:1024
    s_waitcnt vmcnt(16) lgkmcnt(4)
    v_mfma_f32_16x16x32_bf16 v[0:3], v[108:111], v[92:95], v[0:3]
    v_readlane_b32 s24, v182, s68
    v_readlane_b32 s25, v182, s69
    ds_read_b128 v[92:95], v56 offset:1024
    s_waitcnt lgkmcnt(4)
    v_mfma_f32_16x16x32_bf16 v[4:7], v[108:111], v[76:79], v[4:7]
    s_and_b32 s70, s68, 7
    s_lshl_b32 s70, s70, 4
    ds_read_b128 v[76:79], v49 offset:1024
    s_waitcnt lgkmcnt(4)
    v_mfma_f32_16x16x32_bf16 v[8:11], v[108:111], v[80:83], v[8:11]
    v_xor_b32 v206, s70, v210
    v_xor_b32 v207, 16, v206
    ds_read_b128 v[80:83], v53 offset:1024
    s_waitcnt vmcnt(15) lgkmcnt(4)
    v_mfma_f32_16x16x32_bf16 v[0:3], v[112:115], v[84:87], v[0:3]
    v_add_u32 v208, s24, v206
    v_add_u32 v209, s25, v207
    ds_read_b128 v[84:87], v57 offset:1024
    s_waitcnt lgkmcnt(4)
    v_mfma_f32_16x16x32_bf16 v[4:7], v[112:115], v[88:91], v[4:7]
    s_lshl_b32 s70, s68, 10
    s_and_b32 s71, s68, 8
    ds_read_b128 v[88:91], v50 offset:1024
    s_waitcnt lgkmcnt(4)
    v_mfma_f32_16x16x32_bf16 v[8:11], v[112:115], v[92:95], v[8:11]
    s_lshl_b32 s71, s71, 4
    s_add_u32 s71, s71, s70
    ds_read_b128 v[92:95], v54 offset:1024
    s_waitcnt vmcnt(14) lgkmcnt(4)
    v_mfma_f32_16x16x32_bf16 v[0:3], v[116:119], v[76:79], v[0:3]
    s_add_u32 s71, s71, 65536
    v_add_u32 v206, s71, v206
    ds_read_b128 v[76:79], v58 offset:1024
    s_waitcnt lgkmcnt(4)
    v_mfma_f32_16x16x32_bf16 v[4:7], v[116:119], v[80:83], v[4:7]
    v_add_u32 v207, s71, v207
    s_mul_i32 s66, s2, 40960
    ds_read_b128 v[80:83], v51 offset:1024
    s_waitcnt lgkmcnt(4)
    v_mfma_f32_16x16x32_bf16 v[8:11], v[116:119], v[84:87], v[8:11]
    s_add_u32 s22, s66, s70
    s_add_u32 s23, s22, 0x4000
    ds_read_b128 v[84:87], v55 offset:1024
    s_waitcnt vmcnt(13) lgkmcnt(4)
    v_mfma_f32_16x16x32_bf16 v[0:3], v[120:123], v[88:91], v[0:3]
    s_lshl_b32 s70, s20, 10
    s_add_u32 s66, s66, s70
    ds_read_b128 v[88:91], v59 offset:1024
    s_waitcnt lgkmcnt(4)
    v_mfma_f32_16x16x32_bf16 v[4:7], v[120:123], v[92:95], v[4:7]
    s_add_u32 s66, s66, 0x8000
    s_add_u32 s70, s70, 65536
    ds_read_b128 v[92:95], v48 offset:128
    s_waitcnt lgkmcnt(4)
    v_mfma_f32_16x16x32_bf16 v[8:11], v[120:123], v[76:79], v[8:11]
    s_lshl_b32 s71, s20, 4
    v_xor_b32 v211, s71, v210
    ds_read_b128 v[76:79], v48 offset:256
    s_waitcnt vmcnt(12) lgkmcnt(4)
    v_mfma_f32_16x16x32_bf16 v[0:3], v[124:127], v[80:83], v[0:3]
    v_add_u32 v211, s70, v211
    ds_read_b128 v[80:83], v48 offset:384
    s_waitcnt lgkmcnt(4)
    v_mfma_f32_16x16x32_bf16 v[4:7], v[124:127], v[84:87], v[4:7]
    ds_read_b128 v[84:87], v49 offset:128
    s_waitcnt lgkmcnt(4)
    v_mfma_f32_16x16x32_bf16 v[8:11], v[124:127], v[88:91], v[8:11]
    ds_read_b128 v[88:91], v49 offset:256
    s_waitcnt vmcnt(11) lgkmcnt(4)
    v_mfma_f32_16x16x32_bf16 v[12:15], v[128:131], v[92:95], 0
    ds_read_b128 v[92:95], v49 offset:384
    s_waitcnt lgkmcnt(4)
    v_mfma_f32_16x16x32_bf16 v[24:27], v[128:131], v[76:79], 0
    ds_read_b128 v[76:79], v50 offset:128
    s_waitcnt lgkmcnt(4)
    v_mfma_f32_16x16x32_bf16 v[36:39], v[128:131], v[80:83], 0
    ds_read_b128 v[80:83], v50 offset:256
    s_waitcnt vmcnt(10) lgkmcnt(4)
    v_mfma_f32_16x16x32_bf16 v[12:15], v[132:135], v[84:87], v[12:15]
    v_mul_f32 v192, s67, v0
    v_mul_f32 v193, s67, v1
    ds_read_b128 v[84:87], v50 offset:384
    s_waitcnt lgkmcnt(4)
    v_mfma_f32_16x16x32_bf16 v[24:27], v[132:135], v[88:91], v[24:27]
    v_mul_f32 v194, s67, v2
    v_mul_f32 v195, s67, v3
    ds_read_b128 v[88:91], v51 offset:128
    s_waitcnt lgkmcnt(4)
    v_mfma_f32_16x16x32_bf16 v[36:39], v[132:135], v[92:95], v[36:39]
    v_exp_f32 v192, v192
    v_exp_f32 v193, v193
    ds_read_b128 v[92:95], v51 offset:256
    s_waitcnt vmcnt(9) lgkmcnt(4)
    v_mfma_f32_16x16x32_bf16 v[12:15], v[136:139], v[76:79], v[12:15]
    v_exp_f32 v194, v194
    v_exp_f32 v195, v195
    ds_read_b128 v[76:79], v51 offset:384
    s_waitcnt lgkmcnt(4)
    v_mfma_f32_16x16x32_bf16 v[24:27], v[136:139], v[80:83], v[24:27]
    v_add_f32 v192, 1.0, v192
    v_add_f32 v193, 1.0, v193
    ds_read_b128 v[80:83], v48 offset:512
    s_waitcnt lgkmcnt(4)
    v_mfma_f32_16x16x32_bf16 v[36:39], v[136:139], v[84:87], v[36:39]
    v_add_f32 v194, 1.0, v194
    v_add_f32 v195, 1.0, v195
    ds_read_b128 v[84:87], v48 offset:640
    s_waitcnt vmcnt(8) lgkmcnt(4)
    v_mfma_f32_16x16x32_bf16 v[12:15], v[140:143], v[88:91], v[12:15]
    v_rcp_f32 v192, v192
    v_rcp_f32 v193, v193
    ds_read_b128 v[88:91], v48 offset:768
    s_waitcnt lgkmcnt(4)
    v_mfma_f32_16x16x32_bf16 v[24:27], v[140:143], v[92:95], v[24:27]
    v_rcp_f32 v194, v194
    v_rcp_f32 v195, v195
    ds_read_b128 v[92:95], v49 offset:512
    s_waitcnt lgkmcnt(4)
    v_mfma_f32_16x16x32_bf16 v[36:39], v[140:143], v[76:79], v[36:39]
    v_mul_f32 v196, s67, v4
    v_mul_f32 v197, s67, v5
    ds_read_b128 v[76:79], v49 offset:640
    s_waitcnt vmcnt(7) lgkmcnt(4)
    v_mfma_f32_16x16x32_bf16 v[12:15], v[144:147], v[80:83], v[12:15]
    v_mul_f32 v198, s67, v6
    v_mul_f32 v199, s67, v7
    ds_read_b128 v[80:83], v49 offset:768
    s_waitcnt lgkmcnt(4)
    v_mfma_f32_16x16x32_bf16 v[24:27], v[144:147], v[84:87], v[24:27]
    v_exp_f32 v196, v196
    v_exp_f32 v197, v197
    ds_read_b128 v[84:87], v50 offset:512
    s_waitcnt lgkmcnt(4)
    v_mfma_f32_16x16x32_bf16 v[36:39], v[144:147], v[88:91], v[36:39]
    v_exp_f32 v198, v198
    v_exp_f32 v199, v199
    ds_read_b128 v[88:91], v50 offset:640
    s_waitcnt vmcnt(6) lgkmcnt(4)
    v_mfma_f32_16x16x32_bf16 v[12:15], v[148:151], v[92:95], v[12:15]
    v_add_f32 v196, 1.0, v196
    v_add_f32 v197, 1.0, v197
    ds_read_b128 v[92:95], v50 offset:768
    s_waitcnt lgkmcnt(4)
    v_mfma_f32_16x16x32_bf16 v[24:27], v[148:151], v[76:79], v[24:27]
    v_add_f32 v198, 1.0, v198
    v_add_f32 v199, 1.0, v199
    ds_read_b128 v[76:79], v51 offset:512
    s_waitcnt lgkmcnt(4)
    v_mfma_f32_16x16x32_bf16 v[36:39], v[148:151], v[80:83], v[36:39]
    v_rcp_f32 v196, v196
    v_rcp_f32 v197, v197
    ds_read_b128 v[80:83], v51 offset:640
    s_waitcnt vmcnt(5) lgkmcnt(4)
    v_mfma_f32_16x16x32_bf16 v[12:15], v[152:155], v[84:87], v[12:15]
    v_rcp_f32 v198, v198
    v_rcp_f32 v199, v199
    ds_read_b128 v[84:87], v51 offset:768
    s_waitcnt lgkmcnt(4)
    v_mfma_f32_16x16x32_bf16 v[24:27], v[152:155], v[88:91], v[24:27]
    v_mul_f32 v200, s67, v8
    v_mul_f32 v201, s67, v9
    ds_read_b128 v[88:91], v48 offset:1152
    s_waitcnt lgkmcnt(4)
    v_mfma_f32_16x16x32_bf16 v[36:39], v[152:155], v[92:95], v[36:39]
    v_mul_f32 v202, s67, v10
    v_mul_f32 v203, s67, v11
    ds_read_b128 v[92:95], v48 offset:1280
    s_waitcnt vmcnt(4) lgkmcnt(4)
    v_mfma_f32_16x16x32_bf16 v[12:15], v[156:159], v[76:79], v[12:15]
    v_exp_f32 v200, v200
    v_exp_f32 v201, v201
    ds_read_b128 v[76:79], v48 offset:896
    s_waitcnt lgkmcnt(4)
    v_mfma_f32_16x16x32_bf16 v[24:27], v[156:159], v[80:83], v[24:27]
    v_exp_f32 v202, v202
    v_exp_f32 v203, v203
    ds_read_b128 v[80:83], v49 offset:1152
    s_waitcnt lgkmcnt(4)
    v_mfma_f32_16x16x32_bf16 v[36:39], v[156:159], v[84:87], v[36:39]
    v_add_f32 v200, 1.0, v200
    v_add_f32 v201, 1.0, v201
    ds_read_b128 v[84:87], v49 offset:1280
    s_waitcnt vmcnt(3) lgkmcnt(4)
    v_mfma_f32_16x16x32_bf16 v[12:15], v[160:163], v[88:91], v[12:15]
    v_add_f32 v202, 1.0, v202
    v_add_f32 v203, 1.0, v203
    ds_read_b128 v[88:91], v49 offset:896
    s_waitcnt lgkmcnt(4)
    v_mfma_f32_16x16x32_bf16 v[24:27], v[160:163], v[92:95], v[24:27]
    v_rcp_f32 v200, v200
    v_rcp_f32 v201, v201
    ds_read_b128 v[92:95], v50 offset:1152
    s_waitcnt lgkmcnt(4)
    v_mfma_f32_16x16x32_bf16 v[36:39], v[160:163], v[76:79], v[36:39]
    v_rcp_f32 v202, v202
    v_rcp_f32 v203, v203
    ds_read_b128 v[76:79], v50 offset:1280
    s_waitcnt vmcnt(2) lgkmcnt(4)
    v_mfma_f32_16x16x32_bf16 v[12:15], v[164:167], v[80:83], v[12:15]
    v_cvt_pk_bf16_f32 v0, v0, v1
    v_cvt_pk_bf16_f32 v1, v2, v3
    ds_read_b128 v[80:83], v50 offset:896
    s_waitcnt lgkmcnt(4)
    v_mfma_f32_16x16x32_bf16 v[24:27], v[164:167], v[84:87], v[24:27]
    ds_write_b64 v204, v[0:1] offset:0
    ds_read_b128 v[84:87], v51 offset:1152
    s_waitcnt lgkmcnt(5)
    v_mfma_f32_16x16x32_bf16 v[36:39], v[164:167], v[88:91], v[36:39]
    v_mov_b32_dpp v200, v200 row_ror:8 row_mask:0xf bank_mask:0xc
    v_mov_b32_dpp v201, v201 row_ror:8 row_mask:0xf bank_mask:0xc
    ds_read_b128 v[88:91], v51 offset:1280
    s_waitcnt vmcnt(1) lgkmcnt(5)
    v_mfma_f32_16x16x32_bf16 v[12:15], v[168:171], v[92:95], v[12:15]
    v_mov_b32_dpp v202, v202 row_ror:8 row_mask:0xf bank_mask:0xc
    v_mov_b32_dpp v203, v203 row_ror:8 row_mask:0xf bank_mask:0xc
    ds_read_b128 v[92:95], v51 offset:896
    s_waitcnt lgkmcnt(5)
    v_mfma_f32_16x16x32_bf16 v[24:27], v[168:171], v[76:79], v[24:27]
    ds_read_b128 v[76:79], v52 offset:128
    s_waitcnt lgkmcnt(5)
    v_mfma_f32_16x16x32_bf16 v[36:39], v[168:171], v[80:83], v[36:39]
    ds_read_b128 v[80:83], v53 offset:128
    s_waitcnt vmcnt(0) lgkmcnt(4)
    v_mfma_f32_16x16x32_bf16 v[12:15], v[172:175], v[84:87], v[12:15]
    ds_read_b128 v[84:87], v54 offset:128
    s_waitcnt lgkmcnt(4)
    v_mfma_f32_16x16x32_bf16 v[24:27], v[172:175], v[88:91], v[24:27]
    ds_read_b128 v[88:91], v55 offset:128
    s_waitcnt lgkmcnt(4)
    v_mfma_f32_16x16x32_bf16 v[36:39], v[172:175], v[92:95], v[36:39]
    ds_read_b128 v[92:95], v52 offset:512
    s_waitcnt lgkmcnt(4)
    v_mfma_f32_16x16x32_bf16 v[16:19], v[128:131], v[76:79], 0
    ds_read_b128 v[76:79], v53 offset:512
    s_waitcnt lgkmcnt(4)
    v_mfma_f32_16x16x32_bf16 v[16:19], v[132:135], v[80:83], v[16:19]
    ds_read_b128 v[80:83], v54 offset:512
    s_waitcnt lgkmcnt(4)
    v_mfma_f32_16x16x32_bf16 v[16:19], v[136:139], v[84:87], v[16:19]
    v_mul_f32 v12, v12, v192
    v_mul_f32 v13, v13, v193
    ds_read_b128 v[84:87], v55 offset:512
    s_waitcnt lgkmcnt(4)
    v_mfma_f32_16x16x32_bf16 v[16:19], v[140:143], v[88:91], v[16:19]
    v_mul_f32 v14, v14, v194
    v_mul_f32 v15, v15, v195
    ds_read_b128 v[88:91], v52 offset:1152
    s_waitcnt lgkmcnt(4)
    v_mfma_f32_16x16x32_bf16 v[16:19], v[144:147], v[92:95], v[16:19]
    v_cvt_pk_bf16_f32 v12, v12, v13
    v_cvt_pk_bf16_f32 v13, v14, v15
    ds_read_b128 v[92:95], v53 offset:1152
    s_waitcnt lgkmcnt(4)
    v_mfma_f32_16x16x32_bf16 v[16:19], v[148:151], v[76:79], v[16:19]
    ds_write_b64 v204, v[12:13] offset:256
    v_mul_f32 v24, v24, v192
    ds_read_b128 v[76:79], v54 offset:1152
    s_waitcnt lgkmcnt(5)
    v_mfma_f32_16x16x32_bf16 v[16:19], v[152:155], v[80:83], v[16:19]
    v_mul_f32 v25, v25, v193
    v_mul_f32 v26, v26, v194
    ds_read_b128 v[80:83], v55 offset:1152
    s_waitcnt lgkmcnt(5)
    v_mfma_f32_16x16x32_bf16 v[16:19], v[156:159], v[84:87], v[16:19]
    v_mul_f32 v27, v27, v195
    v_cvt_pk_bf16_f32 v24, v24, v25
    ds_read_b128 v[84:87], v52 offset:256
    s_waitcnt lgkmcnt(5)
    v_mfma_f32_16x16x32_bf16 v[16:19], v[160:163], v[88:91], v[16:19]
    v_cvt_pk_bf16_f32 v25, v26, v27
    ds_write_b64 v204, v[24:25] offset:512
    ds_read_b128 v[88:91], v53 offset:256
    s_waitcnt lgkmcnt(6)
    v_mfma_f32_16x16x32_bf16 v[16:19], v[164:167], v[92:95], v[16:19]
    v_mul_f32 v36, v36, v192
    v_mul_f32 v37, v37, v193
    ds_read_b128 v[92:95], v54 offset:256
    s_waitcnt lgkmcnt(5)
    v_mfma_f32_16x16x32_bf16 v[16:19], v[168:171], v[76:79], v[16:19]
    v_mul_f32 v38, v38, v194
    v_mul_f32 v39, v39, v195
    ds_read_b128 v[76:79], v55 offset:256
    s_waitcnt lgkmcnt(5)
    v_mfma_f32_16x16x32_bf16 v[16:19], v[172:175], v[80:83], v[16:19]
    v_cvt_pk_bf16_f32 v36, v36, v37
    v_cvt_pk_bf16_f32 v37, v38, v39
    ds_read_b128 v[80:83], v52 offset:640
    s_waitcnt lgkmcnt(5)
    v_mfma_f32_16x16x32_bf16 v[28:31], v[128:131], v[84:87], 0
    ds_write_b64 v204, v[36:37] offset:768
    ds_read_b128 v[84:87], v53 offset:640
    s_waitcnt lgkmcnt(5)
    v_mfma_f32_16x16x32_bf16 v[28:31], v[132:135], v[88:91], v[28:31]
    ds_read_b128 v[88:91], v54 offset:640
    s_waitcnt lgkmcnt(5)
    v_mfma_f32_16x16x32_bf16 v[28:31], v[136:139], v[92:95], v[28:31]
    ds_read_b128 v[92:95], v55 offset:640
    s_waitcnt lgkmcnt(5)
    v_mfma_f32_16x16x32_bf16 v[28:31], v[140:143], v[76:79], v[28:31]
    ds_read_b128 v[76:79], v52 offset:1280
    s_waitcnt lgkmcnt(5)
    v_mfma_f32_16x16x32_bf16 v[28:31], v[144:147], v[80:83], v[28:31]
    ds_read_b128 v[80:83], v53 offset:1280
    s_waitcnt lgkmcnt(4)
    v_mfma_f32_16x16x32_bf16 v[28:31], v[148:151], v[84:87], v[28:31]
    s_barrier
    ds_read_b128 v[84:87], v54 offset:1280
    s_waitcnt lgkmcnt(4)
    v_mfma_f32_16x16x32_bf16 v[28:31], v[152:155], v[88:91], v[28:31]
    ds_read_b128 v[212:215], v206 offset:0
    ds_read_b128 v[216:219], v207 offset:1024
    ds_read_b128 v[88:91], v55 offset:1280
    s_waitcnt lgkmcnt(6)
    v_mfma_f32_16x16x32_bf16 v[28:31], v[156:159], v[92:95], v[28:31]
    ds_read_b128 v[92:95], v52 offset:384
    s_waitcnt lgkmcnt(6)
    v_mfma_f32_16x16x32_bf16 v[28:31], v[160:163], v[76:79], v[28:31]
    ds_read_b128 v[76:79], v53 offset:384
    s_waitcnt lgkmcnt(6)
    v_mfma_f32_16x16x32_bf16 v[28:31], v[164:167], v[80:83], v[28:31]
    ds_read_b128 v[80:83], v54 offset:384
    s_waitcnt lgkmcnt(6)
    v_mfma_f32_16x16x32_bf16 v[28:31], v[168:171], v[84:87], v[28:31]
    ds_read_b128 v[84:87], v55 offset:384
    s_waitcnt lgkmcnt(4)
    v_mfma_f32_16x16x32_bf16 v[28:31], v[172:175], v[88:91], v[28:31]
    buffer_store_dwordx4 v[212:215], v210, s[4:7], s22 offen offset:0 sc1
    ds_read_b128 v[88:91], v52 offset:768
    s_waitcnt lgkmcnt(4)
    v_mfma_f32_16x16x32_bf16 v[40:43], v[128:131], v[92:95], 0
    buffer_store_dwordx4 v[216:219], v210, s[4:7], s22 offen offset:1024 sc1
    ds_read_b128 v[92:95], v53 offset:768
    s_waitcnt lgkmcnt(4)
    v_mfma_f32_16x16x32_bf16 v[40:43], v[132:135], v[76:79], v[40:43]
    ds_read_b128 v[76:79], v54 offset:768
    s_waitcnt lgkmcnt(4)
    v_mfma_f32_16x16x32_bf16 v[40:43], v[136:139], v[80:83], v[40:43]
    ds_read_b128 v[80:83], v55 offset:768
    s_waitcnt lgkmcnt(4)
    v_mfma_f32_16x16x32_bf16 v[40:43], v[140:143], v[84:87], v[40:43]
    v_cvt_pk_bf16_f32 v4, v4, v5
    v_cvt_pk_bf16_f32 v5, v6, v7
    ds_read_b128 v[84:87], v52 offset:896
    s_waitcnt lgkmcnt(4)
    v_mfma_f32_16x16x32_bf16 v[40:43], v[144:147], v[88:91], v[40:43]
    ds_write_b64 v205, v[4:5] offset:0
    v_mul_f32 v16, v16, v196
    ds_read_b128 v[88:91], v53 offset:896
    s_waitcnt lgkmcnt(5)
    v_mfma_f32_16x16x32_bf16 v[40:43], v[148:151], v[92:95], v[40:43]
    v_mul_f32 v17, v17, v197
    v_mul_f32 v18, v18, v198
    ds_read_b128 v[92:95], v54 offset:896
    s_waitcnt lgkmcnt(5)
    v_mfma_f32_16x16x32_bf16 v[40:43], v[152:155], v[76:79], v[40:43]
    v_mul_f32 v19, v19, v199
    v_cvt_pk_bf16_f32 v16, v16, v17
    ds_read_b128 v[76:79], v55 offset:896
    s_waitcnt lgkmcnt(5)
    v_mfma_f32_16x16x32_bf16 v[40:43], v[156:159], v[80:83], v[40:43]
    v_cvt_pk_bf16_f32 v17, v18, v19
    ds_write_b64 v205, v[16:17] offset:256
    ds_read_b128 v[80:83], v56 offset:128
    s_waitcnt lgkmcnt(6)
    v_mfma_f32_16x16x32_bf16 v[40:43], v[160:163], v[84:87], v[40:43]
    v_mul_f32 v28, v28, v196
    v_mul_f32 v29, v29, v197
    ds_read_b128 v[84:87], v57 offset:128
    s_waitcnt lgkmcnt(5)
    v_mfma_f32_16x16x32_bf16 v[40:43], v[164:167], v[88:91], v[40:43]
    v_mul_f32 v30, v30, v198
    v_mul_f32 v31, v31, v199
    ds_read_b128 v[88:91], v58 offset:128
    s_waitcnt lgkmcnt(5)
    v_mfma_f32_16x16x32_bf16 v[40:43], v[168:171], v[92:95], v[40:43]
    v_cvt_pk_bf16_f32 v28, v28, v29
    v_cvt_pk_bf16_f32 v29, v30, v31
    ds_read_b128 v[92:95], v59 offset:128
    s_waitcnt lgkmcnt(5)
    v_mfma_f32_16x16x32_bf16 v[40:43], v[172:175], v[76:79], v[40:43]
    ds_write_b64 v205, v[28:29] offset:512
    ds_read_b128 v[76:79], v56 offset:512
    s_waitcnt lgkmcnt(5)
    v_mfma_f32_16x16x32_bf16 v[20:23], v[128:131], v[80:83], 0
    ds_read_b128 v[80:83], v57 offset:512
    s_waitcnt lgkmcnt(5)
    v_mfma_f32_16x16x32_bf16 v[20:23], v[132:135], v[84:87], v[20:23]
    ds_read_b128 v[84:87], v58 offset:512
    s_waitcnt lgkmcnt(5)
    v_mfma_f32_16x16x32_bf16 v[20:23], v[136:139], v[88:91], v[20:23]
    ds_read_b128 v[88:91], v59 offset:512
    s_waitcnt lgkmcnt(5)
    v_mfma_f32_16x16x32_bf16 v[20:23], v[140:143], v[92:95], v[20:23]
    v_mul_f32 v40, v40, v196
    v_mul_f32 v41, v41, v197
    ds_read_b128 v[92:95], v56 offset:1152
    s_waitcnt lgkmcnt(4)
    v_mfma_f32_16x16x32_bf16 v[20:23], v[144:147], v[76:79], v[20:23]
    v_mul_f32 v42, v42, v198
    v_mul_f32 v43, v43, v199
    ds_read_b128 v[76:79], v57 offset:1152
    s_waitcnt lgkmcnt(4)
    v_mfma_f32_16x16x32_bf16 v[20:23], v[148:151], v[80:83], v[20:23]
    v_cvt_pk_bf16_f32 v40, v40, v41
    v_cvt_pk_bf16_f32 v41, v42, v43
    ds_read_b128 v[80:83], v58 offset:1152
    s_waitcnt lgkmcnt(4)
    v_mfma_f32_16x16x32_bf16 v[20:23], v[152:155], v[84:87], v[20:23]
    ds_write_b64 v205, v[40:41] offset:768
    ds_read_b128 v[84:87], v59 offset:1152
    s_waitcnt lgkmcnt(5)
    v_mfma_f32_16x16x32_bf16 v[20:23], v[156:159], v[88:91], v[20:23]
    ds_read_b128 v[88:91], v56 offset:384
    s_waitcnt lgkmcnt(5)
    v_mfma_f32_16x16x32_bf16 v[20:23], v[160:163], v[92:95], v[20:23]
    ds_read_b128 v[92:95], v57 offset:384
    s_waitcnt lgkmcnt(5)
    v_mfma_f32_16x16x32_bf16 v[20:23], v[164:167], v[76:79], v[20:23]
    s_waitcnt lgkmcnt(3)
    s_barrier
    ds_read_b128 v[76:79], v58 offset:384
    v_mfma_f32_16x16x32_bf16 v[20:23], v[168:171], v[80:83], v[20:23]
    ds_read_b128 v[212:215], v208 offset:0
    ds_read_b128 v[216:219], v209 offset:0
    ds_read_b128 v[80:83], v59 offset:384
    s_waitcnt lgkmcnt(6)
    v_mfma_f32_16x16x32_bf16 v[20:23], v[172:175], v[84:87], v[20:23]
    ds_read_b128 v[84:87], v56 offset:768
    s_waitcnt lgkmcnt(6)
    v_mfma_f32_16x16x32_bf16 v[44:47], v[128:131], v[88:91], 0
    ds_read_b128 v[88:91], v57 offset:768
    s_waitcnt lgkmcnt(6)
    v_mfma_f32_16x16x32_bf16 v[44:47], v[132:135], v[92:95], v[44:47]
    ds_read_b128 v[92:95], v58 offset:768
    s_waitcnt lgkmcnt(6)
    v_mfma_f32_16x16x32_bf16 v[44:47], v[136:139], v[76:79], v[44:47]
    s_waitcnt lgkmcnt(5)
    buffer_store_dwordx4 v[212:215], v210, s[4:7], s23 offen offset:0 sc1
    ds_read_b128 v[76:79], v59 offset:768
    s_waitcnt lgkmcnt(4)
    v_mfma_f32_16x16x32_bf16 v[44:47], v[140:143], v[80:83], v[44:47]
    buffer_store_dwordx4 v[216:219], v210, s[4:7], s23 offen offset:1024 sc1
    ds_read_b128 v[80:83], v56 offset:896
    s_waitcnt lgkmcnt(4)
    v_mfma_f32_16x16x32_bf16 v[44:47], v[144:147], v[84:87], v[44:47]
    ds_read_b128 v[84:87], v57 offset:896
    s_waitcnt lgkmcnt(4)
    v_mfma_f32_16x16x32_bf16 v[44:47], v[148:151], v[88:91], v[44:47]
    ds_read_b128 v[88:91], v58 offset:896
    s_waitcnt lgkmcnt(4)
    v_mfma_f32_16x16x32_bf16 v[44:47], v[152:155], v[92:95], v[44:47]
    ds_read_b128 v[92:95], v59 offset:896
    s_waitcnt lgkmcnt(4)
    v_mfma_f32_16x16x32_bf16 v[44:47], v[156:159], v[76:79], v[44:47]
    v_cvt_pk_bf16_f32 v8, v8, v9
    v_cvt_pk_bf16_f32 v9, v10, v11
    s_waitcnt lgkmcnt(3)
    v_mfma_f32_16x16x32_bf16 v[44:47], v[160:163], v[80:83], v[44:47]
    ds_write_b64 v204, v[8:9] offset:0
    v_mul_f32 v20, v20, v200
    s_waitcnt lgkmcnt(3)
    v_mfma_f32_16x16x32_bf16 v[44:47], v[164:167], v[84:87], v[44:47]
    v_mul_f32 v21, v21, v201
    v_mul_f32 v22, v22, v202
    s_waitcnt lgkmcnt(2)
    v_mfma_f32_16x16x32_bf16 v[44:47], v[168:171], v[88:91], v[44:47]
    v_mul_f32 v23, v23, v203
    v_cvt_pk_bf16_f32 v20, v20, v21
    s_waitcnt lgkmcnt(1)
    v_mfma_f32_16x16x32_bf16 v[44:47], v[172:175], v[92:95], v[44:47]
    v_cvt_pk_bf16_f32 v21, v22, v23
    ds_write_b64 v220, v[20:21] offset:256
    s_nop 5
    v_mul_f32 v44, v44, v200
    v_mul_f32 v45, v45, v201
    v_mul_f32 v46, v46, v202
    v_mul_f32 v47, v47, v203
    v_cvt_pk_bf16_f32 v44, v44, v45
    v_cvt_pk_bf16_f32 v45, v46, v47
    ds_write_b64 v204, v[44:45] offset:768
    s_waitcnt lgkmcnt(0)
    s_barrier
    ds_read_b128 v[212:215], v211 offset:0
    s_waitcnt lgkmcnt(0)
    buffer_store_dwordx4 v[212:215], v210, s[4:7], s66 offen offset:0 sc1
    s_or_b32 s89, s89, s20
    s_cbranch_scc1 K2_end
    v_mov_b32 v0, 0
    v_mov_b32 v1, s88
    s_mov_b64 exec, 1
    buffer_store_dword v1, v0, s[16:19], 0 offen
K2_end:
K2_last:
    s_endpgm
SLOW:
    v_readlane_b32 s89, v4, 62
    s_waitcnt vmcnt(0) lgkmcnt(0)
    s_barrier
    s_load_dwordx2 s[22:23], s[0:1], 8
    s_load_dwordx2 s[24:25], s[0:1], 24
    s_load_dwordx2 s[26:27], s[0:1], 32
    s_load_dwordx2 s[28:29], s[0:1], 40
    s_load_dwordx2 s[30:31], s[0:1], 0
    v_mbcnt_lo_u32_b32 v240, -1, 0
    v_mbcnt_hi_u32_b32 v240, -1, v240
    v_lshrrev_b32 v229, 5, v240
    v_and_b32 v230, 31, v240
    v_lshlrev_b32 v241, 7, v229
    v_lshl_add_u32 v241, v230, 1, v241
    v_lshlrev_b32 v245, 4, v240
    v_mov_b32 v242, 0
    s_waitcnt lgkmcnt(0)
    s_mov_b32 s80, s22
    s_and_b32 s81, s23, 0xffff
    s_mov_b32 s82, 1920000
    s_mov_b32 s83, 0x20000
    s_mov_b32 s76, s24
    s_and_b32 s77, s25, 0xffff
    s_mov_b32 s78, 1280000
    s_mov_b32 s79, 0x20000
    s_mov_b32 s72, s26
    s_and_b32 s73, s27, 0xffff
    s_mov_b32 s74, 1280000
    s_mov_b32 s75, 0x20000
    s_mov_b32 s84, s28
    s_and_b32 s85, s29, 0xffff
    s_mov_b32 s86, 20480
    s_mov_b32 s87, 0x20000
    s_mov_b32 s4, s30
    s_and_b32 s5, s31, 0xffff
    s_mov_b32 s6, 10240000
    s_mov_b32 s7, 0x20000
    s_mov_b32 s66, 0
    buffer_load_ushort v0, v241, s[84:87], s66 offen offset:0
    buffer_load_ushort v1, v241, s[84:87], s66 offen offset:64
    buffer_load_ushort v2, v241, s[84:87], s66 offen offset:256
    buffer_load_ushort v3, v241, s[84:87], s66 offen offset:320
    buffer_load_ushort v4, v241, s[84:87], s66 offen offset:512
    buffer_load_ushort v5, v241, s[84:87], s66 offen offset:576
    buffer_load_ushort v6, v241, s[84:87], s66 offen offset:768
    buffer_load_ushort v7, v241, s[84:87], s66 offen offset:832
    buffer_load_ushort v8, v241, s[84:87], s66 offen offset:1024
    buffer_load_ushort v9, v241, s[84:87], s66 offen offset:1088
    s_waitcnt vmcnt(0)
    s_mov_b32 s66, 1280
    buffer_load_ushort v10, v241, s[84:87], s66 offen offset:0
    buffer_load_ushort v11, v241, s[84:87], s66 offen offset:64
    buffer_load_ushort v12, v241, s[84:87], s66 offen offset:256
    buffer_load_ushort v13, v241, s[84:87], s66 offen offset:320
    buffer_load_ushort v14, v241, s[84:87], s66 offen offset:512
    buffer_load_ushort v15, v241, s[84:87], s66 offen offset:576
    buffer_load_ushort v16, v241, s[84:87], s66 offen offset:768
    buffer_load_ushort v17, v241, s[84:87], s66 offen offset:832
    buffer_load_ushort v18, v241, s[84:87], s66 offen offset:1024
    buffer_load_ushort v19, v241, s[84:87], s66 offen offset:1088
    s_waitcnt vmcnt(0)
    s_mov_b32 s66, 2560
    buffer_load_ushort v20, v241, s[84:87], s66 offen offset:0
    buffer_load_ushort v21, v241, s[84:87], s66 offen offset:64
    buffer_load_ushort v22, v241, s[84:87], s66 offen offset:256
    buffer_load_ushort v23, v241, s[84:87], s66 offen offset:320
    buffer_load_ushort v24, v241, s[84:87], s66 offen offset:512
    buffer_load_ushort v25, v241, s[84:87], s66 offen offset:576
    buffer_load_ushort v26, v241, s[84:87], s66 offen offset:768
    buffer_load_ushort v27, v241, s[84:87], s66 offen offset:832
    buffer_load_ushort v28, v241, s[84:87], s66 offen offset:1024
    buffer_load_ushort v29, v241, s[84:87], s66 offen offset:1088
    s_waitcnt vmcnt(0)
    s_mov_b32 s66, 3840
    buffer_load_ushort v30, v241, s[84:87], s66 offen offset:0
    buffer_load_ushort v31, v241, s[84:87], s66 offen offset:64
    buffer_load_ushort v32, v241, s[84:87], s66 offen offset:256
    buffer_load_ushort v33, v241, s[84:87], s66 offen offset:320
    buffer_load_ushort v34, v241, s[84:87], s66 offen offset:512
    buffer_load_ushort v35, v241, s[84:87], s66 offen offset:576
    buffer_load_ushort v36, v241, s[84:87], s66 offen offset:768
    buffer_load_ushort v37, v241, s[84:87], s66 offen offset:832
    buffer_load_ushort v38, v241, s[84:87], s66 offen offset:1024
    buffer_load_ushort v39, v241, s[84:87], s66 offen offset:1088
    s_waitcnt vmcnt(0)
    s_mov_b32 s66, 5120
    buffer_load_ushort v40, v241, s[84:87], s66 offen offset:0
    buffer_load_ushort v41, v241, s[84:87], s66 offen offset:64
    buffer_load_ushort v42, v241, s[84:87], s66 offen offset:256
    buffer_load_ushort v43, v241, s[84:87], s66 offen offset:320
    buffer_load_ushort v44, v241, s[84:87], s66 offen offset:512
    buffer_load_ushort v45, v241, s[84:87], s66 offen offset:576
    buffer_load_ushort v46, v241, s[84:87], s66 offen offset:768
    buffer_load_ushort v47, v241, s[84:87], s66 offen offset:832
    buffer_load_ushort v48, v241, s[84:87], s66 offen offset:1024
    buffer_load_ushort v49, v241, s[84:87], s66 offen offset:1088
    s_waitcnt vmcnt(0)
    s_mov_b32 s66, 6400
    buffer_load_ushort v50, v241, s[84:87], s66 offen offset:0
    buffer_load_ushort v51, v241, s[84:87], s66 offen offset:64
    buffer_load_ushort v52, v241, s[84:87], s66 offen offset:256
    buffer_load_ushort v53, v241, s[84:87], s66 offen offset:320
    buffer_load_ushort v54, v241, s[84:87], s66 offen offset:512
    buffer_load_ushort v55, v241, s[84:87], s66 offen offset:576
    buffer_load_ushort v56, v241, s[84:87], s66 offen offset:768
    buffer_load_ushort v57, v241, s[84:87], s66 offen offset:832
    buffer_load_ushort v58, v241, s[84:87], s66 offen offset:1024
    buffer_load_ushort v59, v241, s[84:87], s66 offen offset:1088
    s_waitcnt vmcnt(0)
    s_mov_b32 s66, 7680
    buffer_load_ushort v60, v241, s[84:87], s66 offen offset:0
    buffer_load_ushort v61, v241, s[84:87], s66 offen offset:64
    buffer_load_ushort v62, v241, s[84:87], s66 offen offset:256
    buffer_load_ushort v63, v241, s[84:87], s66 offen offset:320
    buffer_load_ushort v64, v241, s[84:87], s66 offen offset:512
    buffer_load_ushort v65, v241, s[84:87], s66 offen offset:576
    buffer_load_ushort v66, v241, s[84:87], s66 offen offset:768
    buffer_load_ushort v67, v241, s[84:87], s66 offen offset:832
    buffer_load_ushort v68, v241, s[84:87], s66 offen offset:1024
    buffer_load_ushort v69, v241, s[84:87], s66 offen offset:1088
    s_waitcnt vmcnt(0)
    s_mov_b32 s66, 8960
    buffer_load_ushort v70, v241, s[84:87], s66 offen offset:0
    buffer_load_ushort v71, v241, s[84:87], s66 offen offset:64
    buffer_load_ushort v72, v241, s[84:87], s66 offen offset:256
    buffer_load_ushort v73, v241, s[84:87], s66 offen offset:320
    buffer_load_ushort v74, v241, s[84:87], s66 offen offset:512
    buffer_load_ushort v75, v241, s[84:87], s66 offen offset:576
    buffer_load_ushort v76, v241, s[84:87], s66 offen offset:768
    buffer_load_ushort v77, v241, s[84:87], s66 offen offset:832
    buffer_load_ushort v78, v241, s[84:87], s66 offen offset:1024
    buffer_load_ushort v79, v241, s[84:87], s66 offen offset:1088
    s_waitcnt vmcnt(0)
    s_mov_b32 s66, 10240
    buffer_load_ushort v80, v241, s[84:87], s66 offen offset:0
    buffer_load_ushort v81, v241, s[84:87], s66 offen offset:64
    buffer_load_ushort v82, v241, s[84:87], s66 offen offset:256
    buffer_load_ushort v83, v241, s[84:87], s66 offen offset:320
    buffer_load_ushort v84, v241, s[84:87], s66 offen offset:512
    buffer_load_ushort v85, v241, s[84:87], s66 offen offset:576
    buffer_load_ushort v86, v241, s[84:87], s66 offen offset:768
    buffer_load_ushort v87, v241, s[84:87], s66 offen offset:832
    buffer_load_ushort v88, v241, s[84:87], s66 offen offset:1024
    buffer_load_ushort v89, v241, s[84:87], s66 offen offset:1088
    s_waitcnt vmcnt(0)
    s_mov_b32 s66, 11520
    buffer_load_ushort v90, v241, s[84:87], s66 offen offset:0
    buffer_load_ushort v91, v241, s[84:87], s66 offen offset:64
    buffer_load_ushort v92, v241, s[84:87], s66 offen offset:256
    buffer_load_ushort v93, v241, s[84:87], s66 offen offset:320
    buffer_load_ushort v94, v241, s[84:87], s66 offen offset:512
    buffer_load_ushort v95, v241, s[84:87], s66 offen offset:576
    buffer_load_ushort v96, v241, s[84:87], s66 offen offset:768
    buffer_load_ushort v97, v241, s[84:87], s66 offen offset:832
    buffer_load_ushort v98, v241, s[84:87], s66 offen offset:1024
    buffer_load_ushort v99, v241, s[84:87], s66 offen offset:1088
    s_waitcnt vmcnt(0)
    s_mov_b32 s66, 12800
    buffer_load_ushort v100, v241, s[84:87], s66 offen offset:0
    buffer_load_ushort v101, v241, s[84:87], s66 offen offset:64
    buffer_load_ushort v102, v241, s[84:87], s66 offen offset:256
    buffer_load_ushort v103, v241, s[84:87], s66 offen offset:320
    buffer_load_ushort v104, v241, s[84:87], s66 offen offset:512
    buffer_load_ushort v105, v241, s[84:87], s66 offen offset:576
    buffer_load_ushort v106, v241, s[84:87], s66 offen offset:768
    buffer_load_ushort v107, v241, s[84:87], s66 offen offset:832
    buffer_load_ushort v108, v241, s[84:87], s66 offen offset:1024
    buffer_load_ushort v109, v241, s[84:87], s66 offen offset:1088
    s_waitcnt vmcnt(0)
    s_mov_b32 s66, 14080
    buffer_load_ushort v110, v241, s[84:87], s66 offen offset:0
    buffer_load_ushort v111, v241, s[84:87], s66 offen offset:64
    buffer_load_ushort v112, v241, s[84:87], s66 offen offset:256
    buffer_load_ushort v113, v241, s[84:87], s66 offen offset:320
    buffer_load_ushort v114, v241, s[84:87], s66 offen offset:512
    buffer_load_ushort v115, v241, s[84:87], s66 offen offset:576
    buffer_load_ushort v116, v241, s[84:87], s66 offen offset:768
    buffer_load_ushort v117, v241, s[84:87], s66 offen offset:832
    buffer_load_ushort v118, v241, s[84:87], s66 offen offset:1024
    buffer_load_ushort v119, v241, s[84:87], s66 offen offset:1088
    s_waitcnt vmcnt(0)
    s_mov_b32 s66, 15360
    buffer_load_ushort v120, v241, s[84:87], s66 offen offset:0
    buffer_load_ushort v121, v241, s[84:87], s66 offen offset:64
    buffer_load_ushort v122, v241, s[84:87], s66 offen offset:256
    buffer_load_ushort v123, v241, s[84:87], s66 offen offset:320
    buffer_load_ushort v124, v241, s[84:87], s66 offen offset:512
    buffer_load_ushort v125, v241, s[84:87], s66 offen offset:576
    buffer_load_ushort v126, v241, s[84:87], s66 offen offset:768
    buffer_load_ushort v127, v241, s[84:87], s66 offen offset:832
    buffer_load_ushort v128, v241, s[84:87], s66 offen offset:1024
    buffer_load_ushort v129, v241, s[84:87], s66 offen offset:1088
    s_waitcnt vmcnt(0)
    s_mov_b32 s66, 16640
    buffer_load_ushort v130, v241, s[84:87], s66 offen offset:0
    buffer_load_ushort v131, v241, s[84:87], s66 offen offset:64
    buffer_load_ushort v132, v241, s[84:87], s66 offen offset:256
    buffer_load_ushort v133, v241, s[84:87], s66 offen offset:320
    buffer_load_ushort v134, v241, s[84:87], s66 offen offset:512
    buffer_load_ushort v135, v241, s[84:87], s66 offen offset:576
    buffer_load_ushort v136, v241, s[84:87], s66 offen offset:768
    buffer_load_ushort v137, v241, s[84:87], s66 offen offset:832
    buffer_load_ushort v138, v241, s[84:87], s66 offen offset:1024
    buffer_load_ushort v139, v241, s[84:87], s66 offen offset:1088
    s_waitcnt vmcnt(0)
    s_mov_b32 s66, 17920
    buffer_load_ushort v140, v241, s[84:87], s66 offen offset:0
    buffer_load_ushort v141, v241, s[84:87], s66 offen offset:64
    buffer_load_ushort v142, v241, s[84:87], s66 offen offset:256
    buffer_load_ushort v143, v241, s[84:87], s66 offen offset:320
    buffer_load_ushort v144, v241, s[84:87], s66 offen offset:512
    buffer_load_ushort v145, v241, s[84:87], s66 offen offset:576
    buffer_load_ushort v146, v241, s[84:87], s66 offen offset:768
    buffer_load_ushort v147, v241, s[84:87], s66 offen offset:832
    buffer_load_ushort v148, v241, s[84:87], s66 offen offset:1024
    buffer_load_ushort v149, v241, s[84:87], s66 offen offset:1088
    s_waitcnt vmcnt(0)
    s_mov_b32 s66, 19200
    buffer_load_ushort v150, v241, s[84:87], s66 offen offset:0
    buffer_load_ushort v151, v241, s[84:87], s66 offen offset:64
    buffer_load_ushort v152, v241, s[84:87], s66 offen offset:256
    buffer_load_ushort v153, v241, s[84:87], s66 offen offset:320
    buffer_load_ushort v154, v241, s[84:87], s66 offen offset:512
    buffer_load_ushort v155, v241, s[84:87], s66 offen offset:576
    buffer_load_ushort v156, v241, s[84:87], s66 offen offset:768
    buffer_load_ushort v157, v241, s[84:87], s66 offen offset:832
    buffer_load_ushort v158, v241, s[84:87], s66 offen offset:1024
    buffer_load_ushort v159, v241, s[84:87], s66 offen offset:1088
    s_waitcnt vmcnt(0)
    v_lshlrev_b32 v0, 16, v0
    v_lshlrev_b32 v1, 16, v1
    v_lshlrev_b32 v2, 16, v2
    v_lshlrev_b32 v3, 16, v3
    v_lshlrev_b32 v4, 16, v4
    v_lshlrev_b32 v5, 16, v5
    v_lshlrev_b32 v6, 16, v6
    v_lshlrev_b32 v7, 16, v7
    v_lshlrev_b32 v8, 16, v8
    v_lshlrev_b32 v9, 16, v9
    v_lshlrev_b32 v10, 16, v10
    v_lshlrev_b32 v11, 16, v11
    v_lshlrev_b32 v12, 16, v12
    v_lshlrev_b32 v13, 16, v13
    v_lshlrev_b32 v14, 16, v14
    v_lshlrev_b32 v15, 16, v15
    v_lshlrev_b32 v16, 16, v16
    v_lshlrev_b32 v17, 16, v17
    v_lshlrev_b32 v18, 16, v18
    v_lshlrev_b32 v19, 16, v19
    v_lshlrev_b32 v20, 16, v20
    v_lshlrev_b32 v21, 16, v21
    v_lshlrev_b32 v22, 16, v22
    v_lshlrev_b32 v23, 16, v23
    v_lshlrev_b32 v24, 16, v24
    v_lshlrev_b32 v25, 16, v25
    v_lshlrev_b32 v26, 16, v26
    v_lshlrev_b32 v27, 16, v27
    v_lshlrev_b32 v28, 16, v28
    v_lshlrev_b32 v29, 16, v29
    v_lshlrev_b32 v30, 16, v30
    v_lshlrev_b32 v31, 16, v31
    v_lshlrev_b32 v32, 16, v32
    v_lshlrev_b32 v33, 16, v33
    v_lshlrev_b32 v34, 16, v34
    v_lshlrev_b32 v35, 16, v35
    v_lshlrev_b32 v36, 16, v36
    v_lshlrev_b32 v37, 16, v37
    v_lshlrev_b32 v38, 16, v38
    v_lshlrev_b32 v39, 16, v39
    v_lshlrev_b32 v40, 16, v40
    v_lshlrev_b32 v41, 16, v41
    v_lshlrev_b32 v42, 16, v42
    v_lshlrev_b32 v43, 16, v43
    v_lshlrev_b32 v44, 16, v44
    v_lshlrev_b32 v45, 16, v45
    v_lshlrev_b32 v46, 16, v46
    v_lshlrev_b32 v47, 16, v47
    v_lshlrev_b32 v48, 16, v48
    v_lshlrev_b32 v49, 16, v49
    v_lshlrev_b32 v50, 16, v50
    v_lshlrev_b32 v51, 16, v51
    v_lshlrev_b32 v52, 16, v52
    v_lshlrev_b32 v53, 16, v53
    v_lshlrev_b32 v54, 16, v54
    v_lshlrev_b32 v55, 16, v55
    v_lshlrev_b32 v56, 16, v56
    v_lshlrev_b32 v57, 16, v57
    v_lshlrev_b32 v58, 16, v58
    v_lshlrev_b32 v59, 16, v59
    v_lshlrev_b32 v60, 16, v60
    v_lshlrev_b32 v61, 16, v61
    v_lshlrev_b32 v62, 16, v62
    v_lshlrev_b32 v63, 16, v63
    v_lshlrev_b32 v64, 16, v64
    v_lshlrev_b32 v65, 16, v65
    v_lshlrev_b32 v66, 16, v66
    v_lshlrev_b32 v67, 16, v67
    v_lshlrev_b32 v68, 16, v68
    v_lshlrev_b32 v69, 16, v69
    v_lshlrev_b32 v70, 16, v70
    v_lshlrev_b32 v71, 16, v71
    v_lshlrev_b32 v72, 16, v72
    v_lshlrev_b32 v73, 16, v73
    v_lshlrev_b32 v74, 16, v74
    v_lshlrev_b32 v75, 16, v75
    v_lshlrev_b32 v76, 16, v76
    v_lshlrev_b32 v77, 16, v77
    v_lshlrev_b32 v78, 16, v78
    v_lshlrev_b32 v79, 16, v79
    v_lshlrev_b32 v80, 16, v80
    v_lshlrev_b32 v81, 16, v81
    v_lshlrev_b32 v82, 16, v82
    v_lshlrev_b32 v83, 16, v83
    v_lshlrev_b32 v84, 16, v84
    v_lshlrev_b32 v85, 16, v85
    v_lshlrev_b32 v86, 16, v86
    v_lshlrev_b32 v87, 16, v87
    v_lshlrev_b32 v88, 16, v88
    v_lshlrev_b32 v89, 16, v89
    v_lshlrev_b32 v90, 16, v90
    v_lshlrev_b32 v91, 16, v91
    v_lshlrev_b32 v92, 16, v92
    v_lshlrev_b32 v93, 16, v93
    v_lshlrev_b32 v94, 16, v94
    v_lshlrev_b32 v95, 16, v95
    v_lshlrev_b32 v96, 16, v96
    v_lshlrev_b32 v97, 16, v97
    v_lshlrev_b32 v98, 16, v98
    v_lshlrev_b32 v99, 16, v99
    v_lshlrev_b32 v100, 16, v100
    v_lshlrev_b32 v101, 16, v101
    v_lshlrev_b32 v102, 16, v102
    v_lshlrev_b32 v103, 16, v103
    v_lshlrev_b32 v104, 16, v104
    v_lshlrev_b32 v105, 16, v105
    v_lshlrev_b32 v106, 16, v106
    v_lshlrev_b32 v107, 16, v107
    v_lshlrev_b32 v108, 16, v108
    v_lshlrev_b32 v109, 16, v109
    v_lshlrev_b32 v110, 16, v110
    v_lshlrev_b32 v111, 16, v111
    v_lshlrev_b32 v112, 16, v112
    v_lshlrev_b32 v113, 16, v113
    v_lshlrev_b32 v114, 16, v114
    v_lshlrev_b32 v115, 16, v115
    v_lshlrev_b32 v116, 16, v116
    v_lshlrev_b32 v117, 16, v117
    v_lshlrev_b32 v118, 16, v118
    v_lshlrev_b32 v119, 16, v119
    v_lshlrev_b32 v120, 16, v120
    v_lshlrev_b32 v121, 16, v121
    v_lshlrev_b32 v122, 16, v122
    v_lshlrev_b32 v123, 16, v123
    v_lshlrev_b32 v124, 16, v124
    v_lshlrev_b32 v125, 16, v125
    v_lshlrev_b32 v126, 16, v126
    v_lshlrev_b32 v127, 16, v127
    v_lshlrev_b32 v128, 16, v128
    v_lshlrev_b32 v129, 16, v129
    v_lshlrev_b32 v130, 16, v130
    v_lshlrev_b32 v131, 16, v131
    v_lshlrev_b32 v132, 16, v132
    v_lshlrev_b32 v133, 16, v133
    v_lshlrev_b32 v134, 16, v134
    v_lshlrev_b32 v135, 16, v135
    v_lshlrev_b32 v136, 16, v136
    v_lshlrev_b32 v137, 16, v137
    v_lshlrev_b32 v138, 16, v138
    v_lshlrev_b32 v139, 16, v139
    v_lshlrev_b32 v140, 16, v140
    v_lshlrev_b32 v141, 16, v141
    v_lshlrev_b32 v142, 16, v142
    v_lshlrev_b32 v143, 16, v143
    v_lshlrev_b32 v144, 16, v144
    v_lshlrev_b32 v145, 16, v145
    v_lshlrev_b32 v146, 16, v146
    v_lshlrev_b32 v147, 16, v147
    v_lshlrev_b32 v148, 16, v148
    v_lshlrev_b32 v149, 16, v149
    v_lshlrev_b32 v150, 16, v150
    v_lshlrev_b32 v151, 16, v151
    v_lshlrev_b32 v152, 16, v152
    v_lshlrev_b32 v153, 16, v153
    v_lshlrev_b32 v154, 16, v154
    v_lshlrev_b32 v155, 16, v155
    v_lshlrev_b32 v156, 16, v156
    v_lshlrev_b32 v157, 16, v157
    v_lshlrev_b32 v158, 16, v158
    v_lshlrev_b32 v159, 16, v159
    s_mov_b32 s50, 0
SL_node:
    s_mul_i32 s34, s2, 40
    s_mul_i32 s66, s20, 5
    s_add_u32 s66, s66, s50
    s_add_u32 s34, s34, s66
    v_mov_b32 v160, 0
    v_mov_b32 v161, 0
    v_mov_b32 v162, 0
    v_mov_b32 v163, 0
    v_mov_b32 v164, 0
    v_mov_b32 v165, 0
    v_mov_b32 v166, 0
    v_mov_b32 v167, 0
    v_mov_b32 v168, 0
    v_mov_b32 v169, 0
    v_mov_b32 v170, 0
    v_mov_b32 v171, 0
    v_mov_b32 v172, 0
    v_mov_b32 v173, 0
    v_mov_b32 v174, 0
    v_mov_b32 v175, 0
    v_mov_b32 v176, 0
    v_mov_b32 v177, 0
    v_mov_b32 v178, 0
    v_mov_b32 v179, 0
    v_mov_b32 v180, 0
    v_mov_b32 v181, 0
    s_mov_b32 s35, 0
SL_scan:
    s_lshl_b32 s66, s35, 2
    buffer_load_dwordx4 v[236:239], v245, s[72:75], s66 offen
    s_waitcnt vmcnt(0)
    v_cmp_eq_u32 s[38:39], s34, v236
    v_cmp_eq_u32 s[40:41], s34, v237
    v_cmp_eq_u32 s[42:43], s34, v238
    v_cmp_eq_u32 s[44:45], s34, v239
    s_mov_b32 s36, 0
SL_bits:
    s_cmp_eq_u64 s[38:39], 0
    s_cbranch_scc1 SL_nexti
    s_ff1_i32_b64 s66, s[38:39]
    s_bitset0_b64 s[38:39], s66
    s_lshl_b32 s66, s66, 2
    s_add_u32 s37, s66, s36
    s_add_u32 s37, s37, s35
    s_lshl_b32 s66, s37, 2
    s_lshl_b32 s67, s37, 5
    s_mul_i32 s68, s37, 6
    buffer_load_dword v243, v242, s[76:79], s66 offen
    buffer_load_dwordx4 v[184:187], v242, s[12:15], s67 offen
    buffer_load_dwordx4 v[188:191], v242, s[12:15], s67 offen offset:16
    buffer_load_ushort v226, v242, s[80:83], s68 offen offset:0
    buffer_load_ushort v227, v242, s[80:83], s68 offen offset:2
    buffer_load_ushort v228, v242, s[80:83], s68 offen offset:4
    s_waitcnt vmcnt(5)
    v_lshl_add_u32 v243, v243, 10, v241
    buffer_load_ushort v208, v243, s[4:7], 0 offen offset:0
    buffer_load_ushort v209, v243, s[4:7], 0 offen offset:64
    buffer_load_ushort v210, v243, s[4:7], 0 offen offset:256
    buffer_load_ushort v211, v243, s[4:7], 0 offen offset:320
    buffer_load_ushort v212, v243, s[4:7], 0 offen offset:512
    buffer_load_ushort v213, v243, s[4:7], 0 offen offset:576
    buffer_load_ushort v214, v243, s[4:7], 0 offen offset:768
    buffer_load_ushort v215, v243, s[4:7], 0 offen offset:832
    s_waitcnt vmcnt(8)
    v_lshlrev_b32 v192, 16, v184
    v_and_b32 v193, 0xffff0000, v184
    v_lshlrev_b32 v194, 16, v185
    v_and_b32 v195, 0xffff0000, v185
    v_lshlrev_b32 v196, 16, v186
    v_and_b32 v197, 0xffff0000, v186
    v_lshlrev_b32 v198, 16, v187
    v_and_b32 v199, 0xffff0000, v187
    v_lshlrev_b32 v200, 16, v188
    v_and_b32 v201, 0xffff0000, v188
    v_lshlrev_b32 v202, 16, v189
    v_and_b32 v203, 0xffff0000, v189
    v_lshlrev_b32 v204, 16, v190
    v_and_b32 v205, 0xffff0000, v190
    v_lshlrev_b32 v206, 16, v191
    v_and_b32 v207, 0xffff0000, v191
    v_lshlrev_b32 v226, 16, v226
    v_lshlrev_b32 v227, 16, v227
    v_lshlrev_b32 v228, 16, v228
    v_mul_f32 v216, v192, v0
    v_mul_f32 v217, v192, v1
    v_mul_f32 v218, v192, v2
    v_mul_f32 v219, v192, v3
    v_mul_f32 v220, v192, v4
    v_mul_f32 v221, v192, v5
    v_mul_f32 v222, v192, v6
    v_mul_f32 v223, v192, v7
    v_mul_f32 v224, v192, v8
    v_mul_f32 v225, v192, v9
    v_fmac_f32 v216, v193, v10
    v_fmac_f32 v217, v193, v11
    v_fmac_f32 v218, v193, v12
    v_fmac_f32 v219, v193, v13
    v_fmac_f32 v220, v193, v14
    v_fmac_f32 v221, v193, v15
    v_fmac_f32 v222, v193, v16
    v_fmac_f32 v223, v193, v17
    v_fmac_f32 v224, v193, v18
    v_fmac_f32 v225, v193, v19
    v_fmac_f32 v216, v194, v20
    v_fmac_f32 v217, v194, v21
    v_fmac_f32 v218, v194, v22
    v_fmac_f32 v219, v194, v23
    v_fmac_f32 v220, v194, v24
    v_fmac_f32 v221, v194, v25
    v_fmac_f32 v222, v194, v26
    v_fmac_f32 v223, v194, v27
    v_fmac_f32 v224, v194, v28
    v_fmac_f32 v225, v194, v29
    v_fmac_f32 v216, v195, v30
    v_fmac_f32 v217, v195, v31
    v_fmac_f32 v218, v195, v32
    v_fmac_f32 v219, v195, v33
    v_fmac_f32 v220, v195, v34
    v_fmac_f32 v221, v195, v35
    v_fmac_f32 v222, v195, v36
    v_fmac_f32 v223, v195, v37
    v_fmac_f32 v224, v195, v38
    v_fmac_f32 v225, v195, v39
    v_fmac_f32 v216, v196, v40
    v_fmac_f32 v217, v196, v41
    v_fmac_f32 v218, v196, v42
    v_fmac_f32 v219, v196, v43
    v_fmac_f32 v220, v196, v44
    v_fmac_f32 v221, v196, v45
    v_fmac_f32 v222, v196, v46
    v_fmac_f32 v223, v196, v47
    v_fmac_f32 v224, v196, v48
    v_fmac_f32 v225, v196, v49
    v_fmac_f32 v216, v197, v50
    v_fmac_f32 v217, v197, v51
    v_fmac_f32 v218, v197, v52
    v_fmac_f32 v219, v197, v53
    v_fmac_f32 v220, v197, v54
    v_fmac_f32 v221, v197, v55
    v_fmac_f32 v222, v197, v56
    v_fmac_f32 v223, v197, v57
    v_fmac_f32 v224, v197, v58
    v_fmac_f32 v225, v197, v59
    v_fmac_f32 v216, v198, v60
    v_fmac_f32 v217, v198, v61
    v_fmac_f32 v218, v198, v62
    v_fmac_f32 v219, v198, v63
    v_fmac_f32 v220, v198, v64
    v_fmac_f32 v221, v198, v65
    v_fmac_f32 v222, v198, v66
    v_fmac_f32 v223, v198, v67
    v_fmac_f32 v224, v198, v68
    v_fmac_f32 v225, v198, v69
    v_fmac_f32 v216, v199, v70
    v_fmac_f32 v217, v199, v71
    v_fmac_f32 v218, v199, v72
    v_fmac_f32 v219, v199, v73
    v_fmac_f32 v220, v199, v74
    v_fmac_f32 v221, v199, v75
    v_fmac_f32 v222, v199, v76
    v_fmac_f32 v223, v199, v77
    v_fmac_f32 v224, v199, v78
    v_fmac_f32 v225, v199, v79
    v_fmac_f32 v216, v200, v80
    v_fmac_f32 v217, v200, v81
    v_fmac_f32 v218, v200, v82
    v_fmac_f32 v219, v200, v83
    v_fmac_f32 v220, v200, v84
    v_fmac_f32 v221, v200, v85
    v_fmac_f32 v222, v200, v86
    v_fmac_f32 v223, v200, v87
    v_fmac_f32 v224, v200, v88
    v_fmac_f32 v225, v200, v89
    v_fmac_f32 v216, v201, v90
    v_fmac_f32 v217, v201, v91
    v_fmac_f32 v218, v201, v92
    v_fmac_f32 v219, v201, v93
    v_fmac_f32 v220, v201, v94
    v_fmac_f32 v221, v201, v95
    v_fmac_f32 v222, v201, v96
    v_fmac_f32 v223, v201, v97
    v_fmac_f32 v224, v201, v98
    v_fmac_f32 v225, v201, v99
    v_fmac_f32 v216, v202, v100
    v_fmac_f32 v217, v202, v101
    v_fmac_f32 v218, v202, v102
    v_fmac_f32 v219, v202, v103
    v_fmac_f32 v220, v202, v104
    v_fmac_f32 v221, v202, v105
    v_fmac_f32 v222, v202, v106
    v_fmac_f32 v223, v202, v107
    v_fmac_f32 v224, v202, v108
    v_fmac_f32 v225, v202, v109
    v_fmac_f32 v216, v203, v110
    v_fmac_f32 v217, v203, v111
    v_fmac_f32 v218, v203, v112
    v_fmac_f32 v219, v203, v113
    v_fmac_f32 v220, v203, v114
    v_fmac_f32 v221, v203, v115
    v_fmac_f32 v222, v203, v116
    v_fmac_f32 v223, v203, v117
    v_fmac_f32 v224, v203, v118
    v_fmac_f32 v225, v203, v119
    v_fmac_f32 v216, v204, v120
    v_fmac_f32 v217, v204, v121
    v_fmac_f32 v218, v204, v122
    v_fmac_f32 v219, v204, v123
    v_fmac_f32 v220, v204, v124
    v_fmac_f32 v221, v204, v125
    v_fmac_f32 v222, v204, v126
    v_fmac_f32 v223, v204, v127
    v_fmac_f32 v224, v204, v128
    v_fmac_f32 v225, v204, v129
    v_fmac_f32 v216, v205, v130
    v_fmac_f32 v217, v205, v131
    v_fmac_f32 v218, v205, v132
    v_fmac_f32 v219, v205, v133
    v_fmac_f32 v220, v205, v134
    v_fmac_f32 v221, v205, v135
    v_fmac_f32 v222, v205, v136
    v_fmac_f32 v223, v205, v137
    v_fmac_f32 v224, v205, v138
    v_fmac_f32 v225, v205, v139
    v_fmac_f32 v216, v206, v140
    v_fmac_f32 v217, v206, v141
    v_fmac_f32 v218, v206, v142
    v_fmac_f32 v219, v206, v143
    v_fmac_f32 v220, v206, v144
    v_fmac_f32 v221, v206, v145
    v_fmac_f32 v222, v206, v146
    v_fmac_f32 v223, v206, v147
    v_fmac_f32 v224, v206, v148
    v_fmac_f32 v225, v206, v149
    v_fmac_f32 v216, v207, v150
    v_fmac_f32 v217, v207, v151
    v_fmac_f32 v218, v207, v152
    v_fmac_f32 v219, v207, v153
    v_fmac_f32 v220, v207, v154
    v_fmac_f32 v221, v207, v155
    v_fmac_f32 v222, v207, v156
    v_fmac_f32 v223, v207, v157
    v_fmac_f32 v224, v207, v158
    v_fmac_f32 v225, v207, v159
    s_waitcnt vmcnt(0)
    v_lshlrev_b32 v208, 16, v208
    v_lshlrev_b32 v209, 16, v209
    v_lshlrev_b32 v210, 16, v210
    v_lshlrev_b32 v211, 16, v211
    v_lshlrev_b32 v212, 16, v212
    v_lshlrev_b32 v213, 16, v213
    v_lshlrev_b32 v214, 16, v214
    v_lshlrev_b32 v215, 16, v215
    v_fmac_f32 v160, v208, v216
    v_mul_f32 v229, v210, v226
    v_fmac_f32 v229, v212, v227
    v_fmac_f32 v229, v214, v228
    v_fmac_f32 v176, v229, v218
    v_mul_f32 v229, v208, v220
    v_fmac_f32 v162, v229, v226
    v_fmac_f32 v168, v210, v222
    v_mul_f32 v230, v227, v214
    v_fma_f32 v230, -v228, v212, v230
    v_fmac_f32 v178, v230, v224
    v_fmac_f32 v164, v229, v227
    v_fmac_f32 v170, v212, v222
    v_mul_f32 v230, v228, v210
    v_fma_f32 v230, -v226, v214, v230
    v_fmac_f32 v180, v230, v224
    v_fmac_f32 v166, v229, v228
    v_fmac_f32 v172, v214, v222
    v_mul_f32 v230, v226, v212
    v_fma_f32 v230, -v227, v210, v230
    v_fmac_f32 v174, v230, v224
    v_fmac_f32 v161, v209, v217
    v_mul_f32 v229, v211, v226
    v_fmac_f32 v229, v213, v227
    v_fmac_f32 v229, v215, v228
    v_fmac_f32 v177, v229, v219
    v_mul_f32 v229, v209, v221
    v_fmac_f32 v163, v229, v226
    v_fmac_f32 v169, v211, v223
    v_mul_f32 v230, v227, v215
    v_fma_f32 v230, -v228, v213, v230
    v_fmac_f32 v179, v230, v225
    v_fmac_f32 v165, v229, v227
    v_fmac_f32 v171, v213, v223
    v_mul_f32 v230, v228, v211
    v_fma_f32 v230, -v226, v215, v230
    v_fmac_f32 v181, v230, v225
    v_fmac_f32 v167, v229, v228
    v_fmac_f32 v173, v215, v223
    v_mul_f32 v230, v226, v213
    v_fma_f32 v230, -v227, v211, v230
    v_fmac_f32 v175, v230, v225
    s_branch SL_bits
SL_nexti:
    s_mov_b64 s[38:39], s[40:41]
    s_mov_b64 s[40:41], s[42:43]
    s_mov_b64 s[42:43], s[44:45]
    s_add_u32 s36, s36, 1
    s_cmp_lt_u32 s36, 4
    s_cbranch_scc1 SL_bits
    s_add_u32 s35, s35, 256
    s_cmp_lt_u32 s35, 320000
    s_cbranch_scc1 SL_scan
    s_mul_i32 s66, s20, 5
    s_add_u32 s66, s66, s50
    s_lshl_b32 s67, s66, 4
    s_and_b32 s68, s67, 128
    s_and_b32 s67, s67, 0x70
    s_mul_i32 s69, s50, 1536
    s_add_u32 s69, s69, s21
    s_add_u32 s69, s69, s68
    s_mul_i32 s70, s66, 1536
    s_add_u32 s70, s70, 86016
    s_add_u32 s70, s70, s68
    v_mov_b32 v230, s69
    v_mov_b32 v231, s70
    v_cmp_gt_u32 vcc, 32, v240
    v_and_b32 v229, 31, v240
    v_lshlrev_b32 v229, 2, v229
    v_xor_b32 v229, s67, v229
    v_cndmask_b32 v244, v231, v230, vcc
    v_add_u32 v244, v244, v229
    v_cvt_pk_bf16_f32 v160, v160, v161
    ds_write_b32 v244, v160 offset:0
    v_cvt_pk_bf16_f32 v162, v162, v163
    ds_write_b32 v244, v162 offset:128
    v_cvt_pk_bf16_f32 v164, v164, v165
    ds_write_b32 v244, v164 offset:256
    v_cvt_pk_bf16_f32 v166, v166, v167
    ds_write_b32 v244, v166 offset:384
    v_cvt_pk_bf16_f32 v168, v168, v169
    ds_write_b32 v244, v168 offset:512
    v_cvt_pk_bf16_f32 v170, v170, v171
    ds_write_b32 v244, v170 offset:640
    v_cvt_pk_bf16_f32 v172, v172, v173
    ds_write_b32 v244, v172 offset:768
    v_cvt_pk_bf16_f32 v174, v174, v175
    ds_write_b32 v244, v174 offset:896
    v_cvt_pk_bf16_f32 v176, v176, v177
    ds_write_b32 v244, v176 offset:1024
    v_cvt_pk_bf16_f32 v178, v178, v179
    ds_write_b32 v244, v178 offset:1152
    v_cvt_pk_bf16_f32 v180, v180, v181
    ds_write_b32 v244, v180 offset:1280
    s_lshl_b32 s66, s66, 3
    s_add_u32 s66, s66, 163328
    v_mov_b32 v229, s66
    ds_write_b64 v229, v[230:231]
    s_add_u32 s50, s50, 1
    s_cmp_lt_u32 s50, 5
    s_cbranch_scc1 SL_node
    s_waitcnt lgkmcnt(0)
    s_barrier
    v_mov_b32 v176, v240
    s_load_dwordx4 s[84:87], s[0:1], 48
    s_mul_i32 s22, s20, 20
    s_waitcnt lgkmcnt(0)
    s_mul_i32 s24, s22, 3277
    s_lshr_b32 s24, s24, 16
    s_mul_i32 s68, s24, 20
    s_sub_u32 s68, s22, s68
    s_cmp_lt_u32 s68, 8
    s_cselect_b64 s[66:67], s[84:85], s[86:87]
    s_cselect_b32 s25, 0, 8
    s_sub_u32 s68, s68, s25
    s_and_b32 s25, s68, 1
    s_lshr_b32 s68, s68, 1
    s_lshl_b32 s68, s68, 14
    s_lshl_b32 s25, s25, 12
    s_add_u32 s68, s68, s25
    s_lshl_b32 s24, s24, 5
    s_add_u32 s68, s68, s24
    v_lshrrev_b32 v2, 4, v176
    v_lshlrev_b32 v2, 10, v2
    v_and_b32 v3, 15, v176
    v_lshl_add_u32 v2, v3, 1, v2
    v_add_u32 v2, s68, v2
    v_add_u32 v3, 8192, v2
    v_mov_b32 v4, 0
    v_mov_b32 v5, 0
    v_mov_b32 v6, 0
    v_mov_b32 v7, 0
    global_load_ushort v96, v2, s[66:67] offset:0
    global_load_short_d16_hi v4, v3, s[66:67] offset:0
    global_load_ushort v97, v2, s[66:67] offset:256
    global_load_short_d16_hi v5, v3, s[66:67] offset:256
    global_load_ushort v98, v2, s[66:67] offset:512
    global_load_short_d16_hi v6, v3, s[66:67] offset:512
    global_load_ushort v99, v2, s[66:67] offset:768
    global_load_short_d16_hi v7, v3, s[66:67] offset:768
    s_add_u32 s22, s22, 1
    s_waitcnt vmcnt(0)
    v_or_b32 v96, v96, v4
    v_or_b32 v97, v97, v5
    v_or_b32 v98, v98, v6
    v_or_b32 v99, v99, v7
    s_mul_i32 s24, s22, 3277
    s_lshr_b32 s24, s24, 16
    s_mul_i32 s68, s24, 20
    s_sub_u32 s68, s22, s68
    s_cmp_lt_u32 s68, 8
    s_cselect_b64 s[66:67], s[84:85], s[86:87]
    s_cselect_b32 s25, 0, 8
    s_sub_u32 s68, s68, s25
    s_and_b32 s25, s68, 1
    s_lshr_b32 s68, s68, 1
    s_lshl_b32 s68, s68, 14
    s_lshl_b32 s25, s25, 12
    s_add_u32 s68, s68, s25
    s_lshl_b32 s24, s24, 5
    s_add_u32 s68, s68, s24
    v_lshrrev_b32 v2, 4, v176
    v_lshlrev_b32 v2, 10, v2
    v_and_b32 v3, 15, v176
    v_lshl_add_u32 v2, v3, 1, v2
    v_add_u32 v2, s68, v2
    v_add_u32 v3, 8192, v2
    v_mov_b32 v4, 0
    v_mov_b32 v5, 0
    v_mov_b32 v6, 0
    v_mov_b32 v7, 0
    global_load_ushort v100, v2, s[66:67] offset:0
    global_load_short_d16_hi v4, v3, s[66:67] offset:0
    global_load_ushort v101, v2, s[66:67] offset:256
    global_load_short_d16_hi v5, v3, s[66:67] offset:256
    global_load_ushort v102, v2, s[66:67] offset:512
    global_load_short_d16_hi v6, v3, s[66:67] offset:512
    global_load_ushort v103, v2, s[66:67] offset:768
    global_load_short_d16_hi v7, v3, s[66:67] offset:768
    s_add_u32 s22, s22, 1
    s_waitcnt vmcnt(0)
    v_or_b32 v100, v100, v4
    v_or_b32 v101, v101, v5
    v_or_b32 v102, v102, v6
    v_or_b32 v103, v103, v7
    s_mul_i32 s24, s22, 3277
    s_lshr_b32 s24, s24, 16
    s_mul_i32 s68, s24, 20
    s_sub_u32 s68, s22, s68
    s_cmp_lt_u32 s68, 8
    s_cselect_b64 s[66:67], s[84:85], s[86:87]
    s_cselect_b32 s25, 0, 8
    s_sub_u32 s68, s68, s25
    s_and_b32 s25, s68, 1
    s_lshr_b32 s68, s68, 1
    s_lshl_b32 s68, s68, 14
    s_lshl_b32 s25, s25, 12
    s_add_u32 s68, s68, s25
    s_lshl_b32 s24, s24, 5
    s_add_u32 s68, s68, s24
    v_lshrrev_b32 v2, 4, v176
    v_lshlrev_b32 v2, 10, v2
    v_and_b32 v3, 15, v176
    v_lshl_add_u32 v2, v3, 1, v2
    v_add_u32 v2, s68, v2
    v_add_u32 v3, 8192, v2
    v_mov_b32 v4, 0
    v_mov_b32 v5, 0
    v_mov_b32 v6, 0
    v_mov_b32 v7, 0
    global_load_ushort v104, v2, s[66:67] offset:0
    global_load_short_d16_hi v4, v3, s[66:67] offset:0
    global_load_ushort v105, v2, s[66:67] offset:256
    global_load_short_d16_hi v5, v3, s[66:67] offset:256
    global_load_ushort v106, v2, s[66:67] offset:512
    global_load_short_d16_hi v6, v3, s[66:67] offset:512
    global_load_ushort v107, v2, s[66:67] offset:768
    global_load_short_d16_hi v7, v3, s[66:67] offset:768
    s_add_u32 s22, s22, 1
    s_waitcnt vmcnt(0)
    v_or_b32 v104, v104, v4
    v_or_b32 v105, v105, v5
    v_or_b32 v106, v106, v6
    v_or_b32 v107, v107, v7
    s_mul_i32 s24, s22, 3277
    s_lshr_b32 s24, s24, 16
    s_mul_i32 s68, s24, 20
    s_sub_u32 s68, s22, s68
    s_cmp_lt_u32 s68, 8
    s_cselect_b64 s[66:67], s[84:85], s[86:87]
    s_cselect_b32 s25, 0, 8
    s_sub_u32 s68, s68, s25
    s_and_b32 s25, s68, 1
    s_lshr_b32 s68, s68, 1
    s_lshl_b32 s68, s68, 14
    s_lshl_b32 s25, s25, 12
    s_add_u32 s68, s68, s25
    s_lshl_b32 s24, s24, 5
    s_add_u32 s68, s68, s24
    v_lshrrev_b32 v2, 4, v176
    v_lshlrev_b32 v2, 10, v2
    v_and_b32 v3, 15, v176
    v_lshl_add_u32 v2, v3, 1, v2
    v_add_u32 v2, s68, v2
    v_add_u32 v3, 8192, v2
    v_mov_b32 v4, 0
    v_mov_b32 v5, 0
    v_mov_b32 v6, 0
    v_mov_b32 v7, 0
    global_load_ushort v108, v2, s[66:67] offset:0
    global_load_short_d16_hi v4, v3, s[66:67] offset:0
    global_load_ushort v109, v2, s[66:67] offset:256
    global_load_short_d16_hi v5, v3, s[66:67] offset:256
    global_load_ushort v110, v2, s[66:67] offset:512
    global_load_short_d16_hi v6, v3, s[66:67] offset:512
    global_load_ushort v111, v2, s[66:67] offset:768
    global_load_short_d16_hi v7, v3, s[66:67] offset:768
    s_add_u32 s22, s22, 1
    s_waitcnt vmcnt(0)
    v_or_b32 v108, v108, v4
    v_or_b32 v109, v109, v5
    v_or_b32 v110, v110, v6
    v_or_b32 v111, v111, v7
    s_mul_i32 s24, s22, 3277
    s_lshr_b32 s24, s24, 16
    s_mul_i32 s68, s24, 20
    s_sub_u32 s68, s22, s68
    s_cmp_lt_u32 s68, 8
    s_cselect_b64 s[66:67], s[84:85], s[86:87]
    s_cselect_b32 s25, 0, 8
    s_sub_u32 s68, s68, s25
    s_and_b32 s25, s68, 1
    s_lshr_b32 s68, s68, 1
    s_lshl_b32 s68, s68, 14
    s_lshl_b32 s25, s25, 12
    s_add_u32 s68, s68, s25
    s_lshl_b32 s24, s24, 5
    s_add_u32 s68, s68, s24
    v_lshrrev_b32 v2, 4, v176
    v_lshlrev_b32 v2, 10, v2
    v_and_b32 v3, 15, v176
    v_lshl_add_u32 v2, v3, 1, v2
    v_add_u32 v2, s68, v2
    v_add_u32 v3, 8192, v2
    v_mov_b32 v4, 0
    v_mov_b32 v5, 0
    v_mov_b32 v6, 0
    v_mov_b32 v7, 0
    global_load_ushort v112, v2, s[66:67] offset:0
    global_load_short_d16_hi v4, v3, s[66:67] offset:0
    global_load_ushort v113, v2, s[66:67] offset:256
    global_load_short_d16_hi v5, v3, s[66:67] offset:256
    global_load_ushort v114, v2, s[66:67] offset:512
    global_load_short_d16_hi v6, v3, s[66:67] offset:512
    global_load_ushort v115, v2, s[66:67] offset:768
    global_load_short_d16_hi v7, v3, s[66:67] offset:768
    s_add_u32 s22, s22, 1
    s_waitcnt vmcnt(0)
    v_or_b32 v112, v112, v4
    v_or_b32 v113, v113, v5
    v_or_b32 v114, v114, v6
    v_or_b32 v115, v115, v7
    s_mul_i32 s24, s22, 3277
    s_lshr_b32 s24, s24, 16
    s_mul_i32 s68, s24, 20
    s_sub_u32 s68, s22, s68
    s_cmp_lt_u32 s68, 8
    s_cselect_b64 s[66:67], s[84:85], s[86:87]
    s_cselect_b32 s25, 0, 8
    s_sub_u32 s68, s68, s25
    s_and_b32 s25, s68, 1
    s_lshr_b32 s68, s68, 1
    s_lshl_b32 s68, s68, 14
    s_lshl_b32 s25, s25, 12
    s_add_u32 s68, s68, s25
    s_lshl_b32 s24, s24, 5
    s_add_u32 s68, s68, s24
    v_lshrrev_b32 v2, 4, v176
    v_lshlrev_b32 v2, 10, v2
    v_and_b32 v3, 15, v176
    v_lshl_add_u32 v2, v3, 1, v2
    v_add_u32 v2, s68, v2
    v_add_u32 v3, 8192, v2
    v_mov_b32 v4, 0
    v_mov_b32 v5, 0
    v_mov_b32 v6, 0
    v_mov_b32 v7, 0
    global_load_ushort v116, v2, s[66:67] offset:0
    global_load_short_d16_hi v4, v3, s[66:67] offset:0
    global_load_ushort v117, v2, s[66:67] offset:256
    global_load_short_d16_hi v5, v3, s[66:67] offset:256
    global_load_ushort v118, v2, s[66:67] offset:512
    global_load_short_d16_hi v6, v3, s[66:67] offset:512
    global_load_ushort v119, v2, s[66:67] offset:768
    global_load_short_d16_hi v7, v3, s[66:67] offset:768
    s_add_u32 s22, s22, 1
    s_waitcnt vmcnt(0)
    v_or_b32 v116, v116, v4
    v_or_b32 v117, v117, v5
    v_or_b32 v118, v118, v6
    v_or_b32 v119, v119, v7
    s_mul_i32 s24, s22, 3277
    s_lshr_b32 s24, s24, 16
    s_mul_i32 s68, s24, 20
    s_sub_u32 s68, s22, s68
    s_cmp_lt_u32 s68, 8
    s_cselect_b64 s[66:67], s[84:85], s[86:87]
    s_cselect_b32 s25, 0, 8
    s_sub_u32 s68, s68, s25
    s_and_b32 s25, s68, 1
    s_lshr_b32 s68, s68, 1
    s_lshl_b32 s68, s68, 14
    s_lshl_b32 s25, s25, 12
    s_add_u32 s68, s68, s25
    s_lshl_b32 s24, s24, 5
    s_add_u32 s68, s68, s24
    v_lshrrev_b32 v2, 4, v176
    v_lshlrev_b32 v2, 10, v2
    v_and_b32 v3, 15, v176
    v_lshl_add_u32 v2, v3, 1, v2
    v_add_u32 v2, s68, v2
    v_add_u32 v3, 8192, v2
    v_mov_b32 v4, 0
    v_mov_b32 v5, 0
    v_mov_b32 v6, 0
    v_mov_b32 v7, 0
    global_load_ushort v120, v2, s[66:67] offset:0
    global_load_short_d16_hi v4, v3, s[66:67] offset:0
    global_load_ushort v121, v2, s[66:67] offset:256
    global_load_short_d16_hi v5, v3, s[66:67] offset:256
    global_load_ushort v122, v2, s[66:67] offset:512
    global_load_short_d16_hi v6, v3, s[66:67] offset:512
    global_load_ushort v123, v2, s[66:67] offset:768
    global_load_short_d16_hi v7, v3, s[66:67] offset:768
    s_add_u32 s22, s22, 1
    s_waitcnt vmcnt(0)
    v_or_b32 v120, v120, v4
    v_or_b32 v121, v121, v5
    v_or_b32 v122, v122, v6
    v_or_b32 v123, v123, v7
    s_mul_i32 s24, s22, 3277
    s_lshr_b32 s24, s24, 16
    s_mul_i32 s68, s24, 20
    s_sub_u32 s68, s22, s68
    s_cmp_lt_u32 s68, 8
    s_cselect_b64 s[66:67], s[84:85], s[86:87]
    s_cselect_b32 s25, 0, 8
    s_sub_u32 s68, s68, s25
    s_and_b32 s25, s68, 1
    s_lshr_b32 s68, s68, 1
    s_lshl_b32 s68, s68, 14
    s_lshl_b32 s25, s25, 12
    s_add_u32 s68, s68, s25
    s_lshl_b32 s24, s24, 5
    s_add_u32 s68, s68, s24
    v_lshrrev_b32 v2, 4, v176
    v_lshlrev_b32 v2, 10, v2
    v_and_b32 v3, 15, v176
    v_lshl_add_u32 v2, v3, 1, v2
    v_add_u32 v2, s68, v2
    v_add_u32 v3, 8192, v2
    v_mov_b32 v4, 0
    v_mov_b32 v5, 0
    v_mov_b32 v6, 0
    v_mov_b32 v7, 0
    global_load_ushort v124, v2, s[66:67] offset:0
    global_load_short_d16_hi v4, v3, s[66:67] offset:0
    global_load_ushort v125, v2, s[66:67] offset:256
    global_load_short_d16_hi v5, v3, s[66:67] offset:256
    global_load_ushort v126, v2, s[66:67] offset:512
    global_load_short_d16_hi v6, v3, s[66:67] offset:512
    global_load_ushort v127, v2, s[66:67] offset:768
    global_load_short_d16_hi v7, v3, s[66:67] offset:768
    s_add_u32 s22, s22, 1
    s_waitcnt vmcnt(0)
    v_or_b32 v124, v124, v4
    v_or_b32 v125, v125, v5
    v_or_b32 v126, v126, v6
    v_or_b32 v127, v127, v7
    s_mul_i32 s24, s22, 3277
    s_lshr_b32 s24, s24, 16
    s_mul_i32 s68, s24, 20
    s_sub_u32 s68, s22, s68
    s_cmp_lt_u32 s68, 8
    s_cselect_b64 s[66:67], s[84:85], s[86:87]
    s_cselect_b32 s25, 0, 8
    s_sub_u32 s68, s68, s25
    s_and_b32 s25, s68, 1
    s_lshr_b32 s68, s68, 1
    s_lshl_b32 s68, s68, 14
    s_lshl_b32 s25, s25, 12
    s_add_u32 s68, s68, s25
    s_lshl_b32 s24, s24, 5
    s_add_u32 s68, s68, s24
    v_lshrrev_b32 v2, 4, v176
    v_lshlrev_b32 v2, 10, v2
    v_and_b32 v3, 15, v176
    v_lshl_add_u32 v2, v3, 1, v2
    v_add_u32 v2, s68, v2
    v_add_u32 v3, 8192, v2
    v_mov_b32 v4, 0
    v_mov_b32 v5, 0
    v_mov_b32 v6, 0
    v_mov_b32 v7, 0
    global_load_ushort v128, v2, s[66:67] offset:0
    global_load_short_d16_hi v4, v3, s[66:67] offset:0
    global_load_ushort v129, v2, s[66:67] offset:256
    global_load_short_d16_hi v5, v3, s[66:67] offset:256
    global_load_ushort v130, v2, s[66:67] offset:512
    global_load_short_d16_hi v6, v3, s[66:67] offset:512
    global_load_ushort v131, v2, s[66:67] offset:768
    global_load_short_d16_hi v7, v3, s[66:67] offset:768
    s_add_u32 s22, s22, 1
    s_waitcnt vmcnt(0)
    v_or_b32 v128, v128, v4
    v_or_b32 v129, v129, v5
    v_or_b32 v130, v130, v6
    v_or_b32 v131, v131, v7
    s_mul_i32 s24, s22, 3277
    s_lshr_b32 s24, s24, 16
    s_mul_i32 s68, s24, 20
    s_sub_u32 s68, s22, s68
    s_cmp_lt_u32 s68, 8
    s_cselect_b64 s[66:67], s[84:85], s[86:87]
    s_cselect_b32 s25, 0, 8
    s_sub_u32 s68, s68, s25
    s_and_b32 s25, s68, 1
    s_lshr_b32 s68, s68, 1
    s_lshl_b32 s68, s68, 14
    s_lshl_b32 s25, s25, 12
    s_add_u32 s68, s68, s25
    s_lshl_b32 s24, s24, 5
    s_add_u32 s68, s68, s24
    v_lshrrev_b32 v2, 4, v176
    v_lshlrev_b32 v2, 10, v2
    v_and_b32 v3, 15, v176
    v_lshl_add_u32 v2, v3, 1, v2
    v_add_u32 v2, s68, v2
    v_add_u32 v3, 8192, v2
    v_mov_b32 v4, 0
    v_mov_b32 v5, 0
    v_mov_b32 v6, 0
    v_mov_b32 v7, 0
    global_load_ushort v132, v2, s[66:67] offset:0
    global_load_short_d16_hi v4, v3, s[66:67] offset:0
    global_load_ushort v133, v2, s[66:67] offset:256
    global_load_short_d16_hi v5, v3, s[66:67] offset:256
    global_load_ushort v134, v2, s[66:67] offset:512
    global_load_short_d16_hi v6, v3, s[66:67] offset:512
    global_load_ushort v135, v2, s[66:67] offset:768
    global_load_short_d16_hi v7, v3, s[66:67] offset:768
    s_add_u32 s22, s22, 1
    s_waitcnt vmcnt(0)
    v_or_b32 v132, v132, v4
    v_or_b32 v133, v133, v5
    v_or_b32 v134, v134, v6
    v_or_b32 v135, v135, v7
    s_mul_i32 s24, s22, 3277
    s_lshr_b32 s24, s24, 16
    s_mul_i32 s68, s24, 20
    s_sub_u32 s68, s22, s68
    s_cmp_lt_u32 s68, 8
    s_cselect_b64 s[66:67], s[84:85], s[86:87]
    s_cselect_b32 s25, 0, 8
    s_sub_u32 s68, s68, s25
    s_and_b32 s25, s68, 1
    s_lshr_b32 s68, s68, 1
    s_lshl_b32 s68, s68, 14
    s_lshl_b32 s25, s25, 12
    s_add_u32 s68, s68, s25
    s_lshl_b32 s24, s24, 5
    s_add_u32 s68, s68, s24
    v_lshrrev_b32 v2, 4, v176
    v_lshlrev_b32 v2, 10, v2
    v_and_b32 v3, 15, v176
    v_lshl_add_u32 v2, v3, 1, v2
    v_add_u32 v2, s68, v2
    v_add_u32 v3, 8192, v2
    v_mov_b32 v4, 0
    v_mov_b32 v5, 0
    v_mov_b32 v6, 0
    v_mov_b32 v7, 0
    global_load_ushort v136, v2, s[66:67] offset:0
    global_load_short_d16_hi v4, v3, s[66:67] offset:0
    global_load_ushort v137, v2, s[66:67] offset:256
    global_load_short_d16_hi v5, v3, s[66:67] offset:256
    global_load_ushort v138, v2, s[66:67] offset:512
    global_load_short_d16_hi v6, v3, s[66:67] offset:512
    global_load_ushort v139, v2, s[66:67] offset:768
    global_load_short_d16_hi v7, v3, s[66:67] offset:768
    s_add_u32 s22, s22, 1
    s_waitcnt vmcnt(0)
    v_or_b32 v136, v136, v4
    v_or_b32 v137, v137, v5
    v_or_b32 v138, v138, v6
    v_or_b32 v139, v139, v7
    s_mul_i32 s24, s22, 3277
    s_lshr_b32 s24, s24, 16
    s_mul_i32 s68, s24, 20
    s_sub_u32 s68, s22, s68
    s_cmp_lt_u32 s68, 8
    s_cselect_b64 s[66:67], s[84:85], s[86:87]
    s_cselect_b32 s25, 0, 8
    s_sub_u32 s68, s68, s25
    s_and_b32 s25, s68, 1
    s_lshr_b32 s68, s68, 1
    s_lshl_b32 s68, s68, 14
    s_lshl_b32 s25, s25, 12
    s_add_u32 s68, s68, s25
    s_lshl_b32 s24, s24, 5
    s_add_u32 s68, s68, s24
    v_lshrrev_b32 v2, 4, v176
    v_lshlrev_b32 v2, 10, v2
    v_and_b32 v3, 15, v176
    v_lshl_add_u32 v2, v3, 1, v2
    v_add_u32 v2, s68, v2
    v_add_u32 v3, 8192, v2
    v_mov_b32 v4, 0
    v_mov_b32 v5, 0
    v_mov_b32 v6, 0
    v_mov_b32 v7, 0
    global_load_ushort v140, v2, s[66:67] offset:0
    global_load_short_d16_hi v4, v3, s[66:67] offset:0
    global_load_ushort v141, v2, s[66:67] offset:256
    global_load_short_d16_hi v5, v3, s[66:67] offset:256
    global_load_ushort v142, v2, s[66:67] offset:512
    global_load_short_d16_hi v6, v3, s[66:67] offset:512
    global_load_ushort v143, v2, s[66:67] offset:768
    global_load_short_d16_hi v7, v3, s[66:67] offset:768
    s_add_u32 s22, s22, 1
    s_waitcnt vmcnt(0)
    v_or_b32 v140, v140, v4
    v_or_b32 v141, v141, v5
    v_or_b32 v142, v142, v6
    v_or_b32 v143, v143, v7
    s_mul_i32 s24, s22, 3277
    s_lshr_b32 s24, s24, 16
    s_mul_i32 s68, s24, 20
    s_sub_u32 s68, s22, s68
    s_cmp_lt_u32 s68, 8
    s_cselect_b64 s[66:67], s[84:85], s[86:87]
    s_cselect_b32 s25, 0, 8
    s_sub_u32 s68, s68, s25
    s_and_b32 s25, s68, 1
    s_lshr_b32 s68, s68, 1
    s_lshl_b32 s68, s68, 14
    s_lshl_b32 s25, s25, 12
    s_add_u32 s68, s68, s25
    s_lshl_b32 s24, s24, 5
    s_add_u32 s68, s68, s24
    v_lshrrev_b32 v2, 4, v176
    v_lshlrev_b32 v2, 10, v2
    v_and_b32 v3, 15, v176
    v_lshl_add_u32 v2, v3, 1, v2
    v_add_u32 v2, s68, v2
    v_add_u32 v3, 8192, v2
    v_mov_b32 v4, 0
    v_mov_b32 v5, 0
    v_mov_b32 v6, 0
    v_mov_b32 v7, 0
    global_load_ushort v144, v2, s[66:67] offset:0
    global_load_short_d16_hi v4, v3, s[66:67] offset:0
    global_load_ushort v145, v2, s[66:67] offset:256
    global_load_short_d16_hi v5, v3, s[66:67] offset:256
    global_load_ushort v146, v2, s[66:67] offset:512
    global_load_short_d16_hi v6, v3, s[66:67] offset:512
    global_load_ushort v147, v2, s[66:67] offset:768
    global_load_short_d16_hi v7, v3, s[66:67] offset:768
    s_add_u32 s22, s22, 1
    s_waitcnt vmcnt(0)
    v_or_b32 v144, v144, v4
    v_or_b32 v145, v145, v5
    v_or_b32 v146, v146, v6
    v_or_b32 v147, v147, v7
    s_mul_i32 s24, s22, 3277
    s_lshr_b32 s24, s24, 16
    s_mul_i32 s68, s24, 20
    s_sub_u32 s68, s22, s68
    s_cmp_lt_u32 s68, 8
    s_cselect_b64 s[66:67], s[84:85], s[86:87]
    s_cselect_b32 s25, 0, 8
    s_sub_u32 s68, s68, s25
    s_and_b32 s25, s68, 1
    s_lshr_b32 s68, s68, 1
    s_lshl_b32 s68, s68, 14
    s_lshl_b32 s25, s25, 12
    s_add_u32 s68, s68, s25
    s_lshl_b32 s24, s24, 5
    s_add_u32 s68, s68, s24
    v_lshrrev_b32 v2, 4, v176
    v_lshlrev_b32 v2, 10, v2
    v_and_b32 v3, 15, v176
    v_lshl_add_u32 v2, v3, 1, v2
    v_add_u32 v2, s68, v2
    v_add_u32 v3, 8192, v2
    v_mov_b32 v4, 0
    v_mov_b32 v5, 0
    v_mov_b32 v6, 0
    v_mov_b32 v7, 0
    global_load_ushort v148, v2, s[66:67] offset:0
    global_load_short_d16_hi v4, v3, s[66:67] offset:0
    global_load_ushort v149, v2, s[66:67] offset:256
    global_load_short_d16_hi v5, v3, s[66:67] offset:256
    global_load_ushort v150, v2, s[66:67] offset:512
    global_load_short_d16_hi v6, v3, s[66:67] offset:512
    global_load_ushort v151, v2, s[66:67] offset:768
    global_load_short_d16_hi v7, v3, s[66:67] offset:768
    s_add_u32 s22, s22, 1
    s_waitcnt vmcnt(0)
    v_or_b32 v148, v148, v4
    v_or_b32 v149, v149, v5
    v_or_b32 v150, v150, v6
    v_or_b32 v151, v151, v7
    s_mul_i32 s24, s22, 3277
    s_lshr_b32 s24, s24, 16
    s_mul_i32 s68, s24, 20
    s_sub_u32 s68, s22, s68
    s_cmp_lt_u32 s68, 8
    s_cselect_b64 s[66:67], s[84:85], s[86:87]
    s_cselect_b32 s25, 0, 8
    s_sub_u32 s68, s68, s25
    s_and_b32 s25, s68, 1
    s_lshr_b32 s68, s68, 1
    s_lshl_b32 s68, s68, 14
    s_lshl_b32 s25, s25, 12
    s_add_u32 s68, s68, s25
    s_lshl_b32 s24, s24, 5
    s_add_u32 s68, s68, s24
    v_lshrrev_b32 v2, 4, v176
    v_lshlrev_b32 v2, 10, v2
    v_and_b32 v3, 15, v176
    v_lshl_add_u32 v2, v3, 1, v2
    v_add_u32 v2, s68, v2
    v_add_u32 v3, 8192, v2
    v_mov_b32 v4, 0
    v_mov_b32 v5, 0
    v_mov_b32 v6, 0
    v_mov_b32 v7, 0
    global_load_ushort v152, v2, s[66:67] offset:0
    global_load_short_d16_hi v4, v3, s[66:67] offset:0
    global_load_ushort v153, v2, s[66:67] offset:256
    global_load_short_d16_hi v5, v3, s[66:67] offset:256
    global_load_ushort v154, v2, s[66:67] offset:512
    global_load_short_d16_hi v6, v3, s[66:67] offset:512
    global_load_ushort v155, v2, s[66:67] offset:768
    global_load_short_d16_hi v7, v3, s[66:67] offset:768
    s_add_u32 s22, s22, 1
    s_waitcnt vmcnt(0)
    v_or_b32 v152, v152, v4
    v_or_b32 v153, v153, v5
    v_or_b32 v154, v154, v6
    v_or_b32 v155, v155, v7
    s_mul_i32 s24, s22, 3277
    s_lshr_b32 s24, s24, 16
    s_mul_i32 s68, s24, 20
    s_sub_u32 s68, s22, s68
    s_cmp_lt_u32 s68, 8
    s_cselect_b64 s[66:67], s[84:85], s[86:87]
    s_cselect_b32 s25, 0, 8
    s_sub_u32 s68, s68, s25
    s_and_b32 s25, s68, 1
    s_lshr_b32 s68, s68, 1
    s_lshl_b32 s68, s68, 14
    s_lshl_b32 s25, s25, 12
    s_add_u32 s68, s68, s25
    s_lshl_b32 s24, s24, 5
    s_add_u32 s68, s68, s24
    v_lshrrev_b32 v2, 4, v176
    v_lshlrev_b32 v2, 10, v2
    v_and_b32 v3, 15, v176
    v_lshl_add_u32 v2, v3, 1, v2
    v_add_u32 v2, s68, v2
    v_add_u32 v3, 8192, v2
    v_mov_b32 v4, 0
    v_mov_b32 v5, 0
    v_mov_b32 v6, 0
    v_mov_b32 v7, 0
    global_load_ushort v156, v2, s[66:67] offset:0
    global_load_short_d16_hi v4, v3, s[66:67] offset:0
    global_load_ushort v157, v2, s[66:67] offset:256
    global_load_short_d16_hi v5, v3, s[66:67] offset:256
    global_load_ushort v158, v2, s[66:67] offset:512
    global_load_short_d16_hi v6, v3, s[66:67] offset:512
    global_load_ushort v159, v2, s[66:67] offset:768
    global_load_short_d16_hi v7, v3, s[66:67] offset:768
    s_add_u32 s22, s22, 1
    s_waitcnt vmcnt(0)
    v_or_b32 v156, v156, v4
    v_or_b32 v157, v157, v5
    v_or_b32 v158, v158, v6
    v_or_b32 v159, v159, v7
    s_mul_i32 s24, s22, 3277
    s_lshr_b32 s24, s24, 16
    s_mul_i32 s68, s24, 20
    s_sub_u32 s68, s22, s68
    s_cmp_lt_u32 s68, 8
    s_cselect_b64 s[66:67], s[84:85], s[86:87]
    s_cselect_b32 s25, 0, 8
    s_sub_u32 s68, s68, s25
    s_and_b32 s25, s68, 1
    s_lshr_b32 s68, s68, 1
    s_lshl_b32 s68, s68, 14
    s_lshl_b32 s25, s25, 12
    s_add_u32 s68, s68, s25
    s_lshl_b32 s24, s24, 5
    s_add_u32 s68, s68, s24
    v_lshrrev_b32 v2, 4, v176
    v_lshlrev_b32 v2, 10, v2
    v_and_b32 v3, 15, v176
    v_lshl_add_u32 v2, v3, 1, v2
    v_add_u32 v2, s68, v2
    v_add_u32 v3, 8192, v2
    v_mov_b32 v4, 0
    v_mov_b32 v5, 0
    v_mov_b32 v6, 0
    v_mov_b32 v7, 0
    global_load_ushort v160, v2, s[66:67] offset:0
    global_load_short_d16_hi v4, v3, s[66:67] offset:0
    global_load_ushort v161, v2, s[66:67] offset:256
    global_load_short_d16_hi v5, v3, s[66:67] offset:256
    global_load_ushort v162, v2, s[66:67] offset:512
    global_load_short_d16_hi v6, v3, s[66:67] offset:512
    global_load_ushort v163, v2, s[66:67] offset:768
    global_load_short_d16_hi v7, v3, s[66:67] offset:768
    s_add_u32 s22, s22, 1
    s_waitcnt vmcnt(0)
    v_or_b32 v160, v160, v4
    v_or_b32 v161, v161, v5
    v_or_b32 v162, v162, v6
    v_or_b32 v163, v163, v7
    s_mul_i32 s24, s22, 3277
    s_lshr_b32 s24, s24, 16
    s_mul_i32 s68, s24, 20
    s_sub_u32 s68, s22, s68
    s_cmp_lt_u32 s68, 8
    s_cselect_b64 s[66:67], s[84:85], s[86:87]
    s_cselect_b32 s25, 0, 8
    s_sub_u32 s68, s68, s25
    s_and_b32 s25, s68, 1
    s_lshr_b32 s68, s68, 1
    s_lshl_b32 s68, s68, 14
    s_lshl_b32 s25, s25, 12
    s_add_u32 s68, s68, s25
    s_lshl_b32 s24, s24, 5
    s_add_u32 s68, s68, s24
    v_lshrrev_b32 v2, 4, v176
    v_lshlrev_b32 v2, 10, v2
    v_and_b32 v3, 15, v176
    v_lshl_add_u32 v2, v3, 1, v2
    v_add_u32 v2, s68, v2
    v_add_u32 v3, 8192, v2
    v_mov_b32 v4, 0
    v_mov_b32 v5, 0
    v_mov_b32 v6, 0
    v_mov_b32 v7, 0
    global_load_ushort v164, v2, s[66:67] offset:0
    global_load_short_d16_hi v4, v3, s[66:67] offset:0
    global_load_ushort v165, v2, s[66:67] offset:256
    global_load_short_d16_hi v5, v3, s[66:67] offset:256
    global_load_ushort v166, v2, s[66:67] offset:512
    global_load_short_d16_hi v6, v3, s[66:67] offset:512
    global_load_ushort v167, v2, s[66:67] offset:768
    global_load_short_d16_hi v7, v3, s[66:67] offset:768
    s_add_u32 s22, s22, 1
    s_waitcnt vmcnt(0)
    v_or_b32 v164, v164, v4
    v_or_b32 v165, v165, v5
    v_or_b32 v166, v166, v6
    v_or_b32 v167, v167, v7
    s_mul_i32 s24, s22, 3277
    s_lshr_b32 s24, s24, 16
    s_mul_i32 s68, s24, 20
    s_sub_u32 s68, s22, s68
    s_cmp_lt_u32 s68, 8
    s_cselect_b64 s[66:67], s[84:85], s[86:87]
    s_cselect_b32 s25, 0, 8
    s_sub_u32 s68, s68, s25
    s_and_b32 s25, s68, 1
    s_lshr_b32 s68, s68, 1
    s_lshl_b32 s68, s68, 14
    s_lshl_b32 s25, s25, 12
    s_add_u32 s68, s68, s25
    s_lshl_b32 s24, s24, 5
    s_add_u32 s68, s68, s24
    v_lshrrev_b32 v2, 4, v176
    v_lshlrev_b32 v2, 10, v2
    v_and_b32 v3, 15, v176
    v_lshl_add_u32 v2, v3, 1, v2
    v_add_u32 v2, s68, v2
    v_add_u32 v3, 8192, v2
    v_mov_b32 v4, 0
    v_mov_b32 v5, 0
    v_mov_b32 v6, 0
    v_mov_b32 v7, 0
    global_load_ushort v168, v2, s[66:67] offset:0
    global_load_short_d16_hi v4, v3, s[66:67] offset:0
    global_load_ushort v169, v2, s[66:67] offset:256
    global_load_short_d16_hi v5, v3, s[66:67] offset:256
    global_load_ushort v170, v2, s[66:67] offset:512
    global_load_short_d16_hi v6, v3, s[66:67] offset:512
    global_load_ushort v171, v2, s[66:67] offset:768
    global_load_short_d16_hi v7, v3, s[66:67] offset:768
    s_add_u32 s22, s22, 1
    s_waitcnt vmcnt(0)
    v_or_b32 v168, v168, v4
    v_or_b32 v169, v169, v5
    v_or_b32 v170, v170, v6
    v_or_b32 v171, v171, v7
    s_mul_i32 s24, s22, 3277
    s_lshr_b32 s24, s24, 16
    s_mul_i32 s68, s24, 20
    s_sub_u32 s68, s22, s68
    s_cmp_lt_u32 s68, 8
    s_cselect_b64 s[66:67], s[84:85], s[86:87]
    s_cselect_b32 s25, 0, 8
    s_sub_u32 s68, s68, s25
    s_and_b32 s25, s68, 1
    s_lshr_b32 s68, s68, 1
    s_lshl_b32 s68, s68, 14
    s_lshl_b32 s25, s25, 12
    s_add_u32 s68, s68, s25
    s_lshl_b32 s24, s24, 5
    s_add_u32 s68, s68, s24
    v_lshrrev_b32 v2, 4, v176
    v_lshlrev_b32 v2, 10, v2
    v_and_b32 v3, 15, v176
    v_lshl_add_u32 v2, v3, 1, v2
    v_add_u32 v2, s68, v2
    v_add_u32 v3, 8192, v2
    v_mov_b32 v4, 0
    v_mov_b32 v5, 0
    v_mov_b32 v6, 0
    v_mov_b32 v7, 0
    global_load_ushort v172, v2, s[66:67] offset:0
    global_load_short_d16_hi v4, v3, s[66:67] offset:0
    global_load_ushort v173, v2, s[66:67] offset:256
    global_load_short_d16_hi v5, v3, s[66:67] offset:256
    global_load_ushort v174, v2, s[66:67] offset:512
    global_load_short_d16_hi v6, v3, s[66:67] offset:512
    global_load_ushort v175, v2, s[66:67] offset:768
    global_load_short_d16_hi v7, v3, s[66:67] offset:768
    s_add_u32 s22, s22, 1
    s_waitcnt vmcnt(0)
    v_or_b32 v172, v172, v4
    v_or_b32 v173, v173, v5
    v_or_b32 v174, v174, v6
    v_or_b32 v175, v175, v7
    s_branch GEMM
.section .rodata,"a"
.p2align 6
.amdhsa_kernel standalone__tensor_product_equiv_equiformer__graph_kernel
  .amdhsa_next_free_vgpr 256
  .amdhsa_next_free_sgpr 90
  .amdhsa_accum_offset 256
  .amdhsa_group_segment_fixed_size 0
  .amdhsa_kernarg_size 96
  .amdhsa_user_sgpr_count 2
  .amdhsa_user_sgpr_kernarg_segment_ptr 1
  .amdhsa_system_sgpr_workgroup_id_x 1
.end_amdhsa_kernel
```

```asm
; @launch grid=(250,1,1) block=(512,1,1) lds=163840
.amdgcn_target "amdgcn-amd-amdhsa--gfx950"
.text
.globl standalone__tensor_product_equiv_equiformer__graph_kernel
.p2align 8
.type standalone__tensor_product_equiv_equiformer__graph_kernel,@function
standalone__tensor_product_equiv_equiformer__graph_kernel:
    s_cmp_ge_u32 s2, 250
    s_cbranch_scc1 K2_end
    s_load_dwordx16 s[72:87], s[0:1], 0
    s_load_dwordx2 s[70:71], s[0:1], 88
    v_lshrrev_b32 v2, 6, v0
    v_and_b32 v1, 63, v0
    v_readfirstlane_b32 s20, v2
    s_getpc_b64 s[66:67]
    v_lshlrev_b32 v95, 7, v1
    s_cmp_eq_u32 s20, 6
    s_cbranch_scc0 F_nopf0
    global_load_dword v95, v95, s[66:67]
F_nopf0:
    s_mul_i32 s66, s2, 5120
    s_mul_i32 s67, s2, 7680
    v_lshl_add_u32 v3, v0, 4, s66
    v_mul_u32_u24 v4, 24, v0
    v_add_u32 v4, s67, v4
    v_lshlrev_b32 v5, 2, v0
    v_mov_b32 v89, 0
    v_add_u32 v6, 98304, v5
    ds_write_b32 v6, v89
    s_cmp_ge_u32 s20, 5
    s_waitcnt lgkmcnt(0)
    s_cbranch_scc1 F_noload
    global_load_dwordx4 v[8:11], v3, s[80:81] nt
    global_load_dwordx4 v[12:15], v3, s[78:79] nt
    global_load_dwordx4 v[16:19], v4, s[74:75] nt
    global_load_dwordx2 v[20:21], v4, s[74:75] offset:16 nt
F_noload:
    s_load_dword s88, s[70:71], 0
    s_barrier
    v_lshlrev_b32 v248, 2, v1
    v_add_u32 v88, 162816, v248
    ds_write_b32 v88, v89
    ds_write_b32 v88, v89 offset:256
    v_lshlrev_b32 v86, 4, v1
    s_lshl_b32 s21, s20, 13
    v_lshrrev_b32 v6, 5, v1
    v_mul_u32_u24 v6, 5120, v6
    v_and_b32 v7, 31, v1
    v_lshl_add_u32 v6, v7, 1, v6
    s_lshr_b32 s66, s20, 2
    s_lshl_b32 s66, s66, 7
    s_and_b32 s67, s20, 3
    s_mul_i32 s67, s67, 5
    s_add_u32 s68, s67, 0
    s_lshr_b32 s24, s68, 2
    s_lshl_b32 s24, s24, 8
    s_bfe_u32 s69, s68, 0x10001
    s_lshl_b32 s69, s69, 6
    s_add_u32 s24, s24, s69
    s_and_b32 s69, s68, 1
    s_mul_i32 s69, s69, 10240
    s_add_u32 s24, s24, s69
    s_add_u32 s24, s24, s66
    s_add_u32 s68, s67, 1
    s_lshr_b32 s25, s68, 2
    s_lshl_b32 s25, s25, 8
    s_bfe_u32 s69, s68, 0x10001
    s_lshl_b32 s69, s69, 6
    s_add_u32 s25, s25, s69
    s_and_b32 s69, s68, 1
    s_mul_i32 s69, s69, 10240
    s_add_u32 s25, s25, s69
    s_add_u32 s25, s25, s66
    s_add_u32 s68, s67, 2
    s_lshr_b32 s26, s68, 2
    s_lshl_b32 s26, s26, 8
    s_bfe_u32 s69, s68, 0x10001
    s_lshl_b32 s69, s69, 6
    s_add_u32 s26, s26, s69
    s_and_b32 s69, s68, 1
    s_mul_i32 s69, s69, 10240
    s_add_u32 s26, s26, s69
    s_add_u32 s26, s26, s66
    s_add_u32 s68, s67, 3
    s_lshr_b32 s27, s68, 2
    s_lshl_b32 s27, s27, 8
    s_bfe_u32 s69, s68, 0x10001
    s_lshl_b32 s69, s69, 6
    s_add_u32 s27, s27, s69
    s_and_b32 s69, s68, 1
    s_mul_i32 s69, s69, 10240
    s_add_u32 s27, s27, s69
    s_add_u32 s27, s27, s66
    s_add_u32 s68, s67, 4
    s_lshr_b32 s28, s68, 2
    s_lshl_b32 s28, s28, 8
    s_bfe_u32 s69, s68, 0x10001
    s_lshl_b32 s69, s69, 6
    s_add_u32 s28, s28, s69
    s_and_b32 s69, s68, 1
    s_mul_i32 s69, s69, 10240
    s_add_u32 s28, s28, s69
    s_add_u32 s28, s28, s66
    v_mov_b32 v96, 0
    v_mov_b32 v97, 0
    v_mov_b32 v98, 0
    v_mov_b32 v99, 0
    v_mov_b32 v100, 0
    v_mov_b32 v101, 0
    v_mov_b32 v102, 0
    v_mov_b32 v103, 0
    v_mov_b32 v104, 0
    v_mov_b32 v105, 0
    v_mov_b32 v106, 0
    v_mov_b32 v107, 0
    v_mov_b32 v108, 0
    v_mov_b32 v109, 0
    v_mov_b32 v110, 0
    v_mov_b32 v111, 0
    v_mov_b32 v112, 0
    v_mov_b32 v113, 0
    v_mov_b32 v114, 0
    v_mov_b32 v115, 0
    v_mov_b32 v180, 0
    v_mov_b32 v181, 0
    v_mov_b32 v182, 0
    v_mov_b32 v183, 0
    s_mov_b32 s16, s70
    s_and_b32 s17, s71, 0xffff
    s_mov_b32 s18, 24165888
    s_mov_b32 s19, 0x20000
    v_lshrrev_b32 v2, 3, v1
    v_lshl_add_u32 v2, s20, 5, v2
    v_and_b32 v91, 7, v1
    v_mul_u32_u24 v94, 384, v2
    v_lshl_add_u32 v94, v91, 4, v94
    v_lshlrev_b32 v93, 2, v2
    v_add_u32 v93, 98304, v93
    v_mul_u32_u24 v92, 32000, v2
    v_lshl_add_u32 v92, v91, 4, v92
    v_mul_u32_u24 v90, 40960, v2
    s_mov_b32 s32, s82
    s_and_b32 s33, s83, 0xffff
    s_mov_b32 s34, 20480
    s_mov_b32 s35, 0x20000
    s_cmp_ge_u32 s20, 5
    s_cbranch_scc1 F_helper
    s_mov_b32 s22, 52429
    s_mov_b32 s23, 0x05040100
    s_mov_b32 s66, 98304
    s_movk_i32 s67, -40
    v_mov_b32 v7, 1
    v_add_u32 v31, 1, v5
    v_add_u32 v32, 2, v5
    v_add_u32 v33, 3, v5
    s_waitcnt vmcnt(3)
    v_mul_u32_u24 v22, s22, v8
    v_mul_u32_u24 v23, s22, v9
    v_mul_u32_u24 v24, s22, v10
    v_mul_u32_u24 v25, s22, v11
    v_lshrrev_b32 v22, 21, v22
    v_lshrrev_b32 v23, 21, v23
    v_lshrrev_b32 v24, 21, v24
    v_lshrrev_b32 v25, 21, v25
    v_lshl_add_u32 v34, v22, 2, s66
    ds_add_rtn_u32 v26, v34, v7
    v_lshl_add_u32 v35, v23, 2, s66
    ds_add_rtn_u32 v27, v35, v7
    v_lshl_add_u32 v36, v24, 2, s66
    ds_add_rtn_u32 v28, v36, v7
    v_lshl_add_u32 v37, v25, 2, s66
    ds_add_rtn_u32 v29, v37, v7
    buffer_load_short_d16_hi v96, v6, s[32:35], s24 offen offset:0
    buffer_load_short_d16_hi v97, v6, s[32:35], s24 offen offset:1280
    buffer_load_short_d16_hi v98, v6, s[32:35], s24 offen offset:2560
    buffer_load_short_d16_hi v99, v6, s[32:35], s24 offen offset:3840
    buffer_load_short_d16_hi v100, v6, s[32:35], s25 offen offset:0
    buffer_load_short_d16_hi v101, v6, s[32:35], s25 offen offset:1280
    buffer_load_short_d16_hi v102, v6, s[32:35], s25 offen offset:2560
    buffer_load_short_d16_hi v103, v6, s[32:35], s25 offen offset:3840
    buffer_load_short_d16_hi v104, v6, s[32:35], s26 offen offset:0
    buffer_load_short_d16_hi v105, v6, s[32:35], s26 offen offset:1280
    buffer_load_short_d16_hi v106, v6, s[32:35], s26 offen offset:2560
    buffer_load_short_d16_hi v107, v6, s[32:35], s26 offen offset:3840
    buffer_load_short_d16_hi v108, v6, s[32:35], s27 offen offset:0
    buffer_load_short_d16_hi v109, v6, s[32:35], s27 offen offset:1280
    buffer_load_short_d16_hi v110, v6, s[32:35], s27 offen offset:2560
    buffer_load_short_d16_hi v111, v6, s[32:35], s27 offen offset:3840
    buffer_load_short_d16_hi v112, v6, s[32:35], s28 offen offset:0
    buffer_load_short_d16_hi v113, v6, s[32:35], s28 offen offset:1280
    buffer_load_short_d16_hi v114, v6, s[32:35], s28 offen offset:2560
    buffer_load_short_d16_hi v115, v6, s[32:35], s28 offen offset:3840
    v_mad_i32_i24 v2, v22, s67, v8
    v_mul_u32_u24 v22, 384, v22
    v_lshl_or_b32 v42, v2, 11, v5
    v_mad_i32_i24 v2, v23, s67, v9
    v_mul_u32_u24 v23, 384, v23
    v_lshl_or_b32 v46, v2, 11, v31
    v_mad_i32_i24 v2, v24, s67, v10
    v_mul_u32_u24 v24, 384, v24
    v_lshl_or_b32 v50, v2, 11, v32
    v_mad_i32_i24 v2, v25, s67, v11
    v_mul_u32_u24 v25, 384, v25
    v_lshl_or_b32 v54, v2, 11, v33
    s_waitcnt vmcnt(20)
    v_mov_b32 v40, v16
    v_perm_b32 v41, v12, v17, s23
    v_alignbit_b32 v44, v18, v17, 16
    v_alignbit_b32 v45, v13, v18, 16
    v_mov_b32 v48, v19
    v_perm_b32 v49, v14, v20, s23
    v_alignbit_b32 v52, v21, v20, 16
    v_alignbit_b32 v53, v15, v21, 16
    v_xor_b32 v41, 0x8000, v41
    v_xor_b32 v45, 0x8000, v45
    v_xor_b32 v49, 0x8000, v49
    v_xor_b32 v53, 0x8000, v53
    s_waitcnt lgkmcnt(0)
    v_min_u32 v26, 23, v26
    v_lshl_add_u32 v34, v26, 4, v22
    ds_write_b128 v34, v[40:43]
    v_min_u32 v27, 23, v27
    v_lshl_add_u32 v35, v27, 4, v23
    ds_write_b128 v35, v[44:47]
    v_min_u32 v28, 23, v28
    v_lshl_add_u32 v36, v28, 4, v24
    ds_write_b128 v36, v[48:51]
    v_min_u32 v29, 23, v29
    v_lshl_add_u32 v37, v29, 4, v25
    ds_write_b128 v37, v[52:55]
    s_branch F_staged
F_helper:
    buffer_load_short_d16_hi v96, v6, s[32:35], s24 offen offset:0
    buffer_load_short_d16_hi v97, v6, s[32:35], s24 offen offset:1280
    buffer_load_short_d16_hi v98, v6, s[32:35], s24 offen offset:2560
    buffer_load_short_d16_hi v99, v6, s[32:35], s24 offen offset:3840
    buffer_load_short_d16_hi v100, v6, s[32:35], s25 offen offset:0
    buffer_load_short_d16_hi v101, v6, s[32:35], s25 offen offset:1280
    buffer_load_short_d16_hi v102, v6, s[32:35], s25 offen offset:2560
    buffer_load_short_d16_hi v103, v6, s[32:35], s25 offen offset:3840
    buffer_load_short_d16_hi v104, v6, s[32:35], s26 offen offset:0
    buffer_load_short_d16_hi v105, v6, s[32:35], s26 offen offset:1280
    buffer_load_short_d16_hi v106, v6, s[32:35], s26 offen offset:2560
    buffer_load_short_d16_hi v107, v6, s[32:35], s26 offen offset:3840
    buffer_load_short_d16_hi v108, v6, s[32:35], s27 offen offset:0
    buffer_load_short_d16_hi v109, v6, s[32:35], s27 offen offset:1280
    buffer_load_short_d16_hi v110, v6, s[32:35], s27 offen offset:2560
    buffer_load_short_d16_hi v111, v6, s[32:35], s27 offen offset:3840
    buffer_load_short_d16_hi v112, v6, s[32:35], s28 offen offset:0
    buffer_load_short_d16_hi v113, v6, s[32:35], s28 offen offset:1280
    buffer_load_short_d16_hi v114, v6, s[32:35], s28 offen offset:2560
    buffer_load_short_d16_hi v115, v6, s[32:35], s28 offen offset:3840
    s_cmp_eq_u32 s20, 6
    s_cbranch_scc0 F_nopf
    s_getpc_b64 s[66:67]
F_pc:
    s_lshr_b32 s68, s2, 3
    s_mul_i32 s68, s68, ((K2_last-F_pc)/128/31+1)*128
    v_lshl_add_u32 v2, v1, 7, s68
    v_min_u32 v2, K2_last-F_pc-4, v2
    v_cmp_gt_u32 vcc, (K2_last-F_pc)/128/31+1, v1
    s_mov_b64 exec, vcc
    global_load_dword v95, v2, s[66:67]
    s_mov_b64 exec, -1
F_nopf:
    s_cmp_eq_u32 s20, 7
    s_cbranch_scc0 F_staged
    s_cmp_lt_u32 s2, 160
    s_cbranch_scc0 F_staged
    s_mul_i32 s22, s2, 3277
    s_lshr_b32 s22, s22, 16
    s_mul_i32 s68, s22, 20
    s_sub_u32 s68, s2, s68
    s_cmp_lt_u32 s68, 8
    s_cselect_b64 s[66:67], s[84:85], s[86:87]
    s_cselect_b32 s23, 0, 8
    s_sub_u32 s68, s68, s23
    s_and_b32 s23, s68, 1
    s_lshr_b32 s68, s68, 1
    s_lshl_b32 s68, s68, 14
    s_lshl_b32 s23, s23, 12
    s_add_u32 s68, s68, s23
    s_lshl_b32 s22, s22, 5
    s_add_u32 s68, s68, s22
    v_lshrrev_b32 v2, 4, v1
    v_lshlrev_b32 v2, 10, v2
    v_and_b32 v3, 15, v1
    v_lshl_add_u32 v2, v3, 1, v2
    v_add_u32 v2, s68, v2
    v_add_u32 v3, 8192, v2
    global_load_ushort v176, v2, s[66:67] offset:0
    global_load_short_d16_hi v180, v3, s[66:67] offset:0
    global_load_ushort v177, v2, s[66:67] offset:256
    global_load_short_d16_hi v181, v3, s[66:67] offset:256
    global_load_ushort v178, v2, s[66:67] offset:512
    global_load_short_d16_hi v182, v3, s[66:67] offset:512
    global_load_ushort v179, v2, s[66:67] offset:768
    global_load_short_d16_hi v183, v3, s[66:67] offset:768
F_staged:
    s_lshl_b32 s66, s2, 7
    s_add_u32 s66, s66, 164864
    s_cmp_eq_u32 s20, 7
    s_cselect_b32 s22, 0xffff, -1
    s_cselect_b32 s23, 0, -1
    s_waitcnt lgkmcnt(0)
    s_add_u32 s88, s88, 1
    s_barrier
    ds_read_b32 v40, v93 offset:0
    ds_read_b128 v[8:11], v94 offset:0
    ds_read_b128 v[12:15], v94 offset:128
    ds_read_b32 v41, v93 offset:32
    ds_read_b128 v[16:19], v94 offset:3072
    ds_read_b128 v[20:23], v94 offset:3200
    ds_read_b32 v42, v93 offset:64
    ds_read_b128 v[24:27], v94 offset:6144
    ds_read_b128 v[28:31], v94 offset:6272
    ds_read_b32 v43, v93 offset:96
    ds_read_b128 v[32:35], v94 offset:9216
    ds_read_b128 v[36:39], v94 offset:9344
    s_waitcnt vmcnt(0)
    s_waitcnt lgkmcnt(9)
    v_min_u32 v5, 31, v40
    v_bfe_u32 v6, v14, 11, 6
    v_and_b32 v10, 0x1ffff, v10
    v_lshl_or_b32 v6, v5, 6, v6
    v_mov_b32 v11, s88
    v_lshl_or_b32 v10, v6, 17, v10
    v_mov_b32 v15, s88
    buffer_store_dwordx4 v[8:11], v92, s[16:19], s66 offen sc1
    v_cmp_lt_u32 vcc, 8, v40
    s_add_u32 s67, s66, 8000000
    s_mov_b64 exec, vcc
    s_cbranch_execz F_w0
    buffer_store_dwordx4 v[12:15], v92, s[16:19], s67 offen sc1
    v_cmp_lt_u32 vcc, 16, v40
    s_add_u32 s67, s67, 8000000
    s_mov_b64 exec, vcc
    s_cbranch_execz F_w0
    ds_read_b128 v[44:47], v94 offset:256
    s_waitcnt lgkmcnt(0)
    v_mov_b32 v47, s88
    buffer_store_dwordx4 v[44:47], v92, s[16:19], s67 offen sc1
    s_nop 1
F_w0:
    s_mov_b64 exec, -1
    s_add_u32 s66, s66, 256000
    s_waitcnt lgkmcnt(6)
    v_min_u32 v5, 31, v41
    v_bfe_u32 v6, v22, 11, 6
    v_and_b32 v18, 0x1ffff, v18
    v_lshl_or_b32 v6, v5, 6, v6
    v_mov_b32 v19, s88
    v_lshl_or_b32 v18, v6, 17, v18
    v_mov_b32 v23, s88
    buffer_store_dwordx4 v[16:19], v92, s[16:19], s66 offen sc1
    v_cmp_lt_u32 vcc, 8, v41
    s_add_u32 s67, s66, 8000000
    s_mov_b64 exec, vcc
    s_cbranch_execz F_w1
    buffer_store_dwordx4 v[20:23], v92, s[16:19], s67 offen sc1
    v_cmp_lt_u32 vcc, 16, v41
    s_add_u32 s67, s67, 8000000
    s_mov_b64 exec, vcc
    s_cbranch_execz F_w1
    ds_read_b128 v[44:47], v94 offset:3328
    s_waitcnt lgkmcnt(0)
    v_mov_b32 v47, s88
    buffer_store_dwordx4 v[44:47], v92, s[16:19], s67 offen sc1
    s_nop 1
F_w1:
    s_mov_b64 exec, -1
    s_add_u32 s66, s66, 256000
    s_waitcnt lgkmcnt(3)
    v_min_u32 v5, 31, v42
    v_bfe_u32 v6, v30, 11, 6
    v_and_b32 v26, 0x1ffff, v26
    v_lshl_or_b32 v6, v5, 6, v6
    v_mov_b32 v27, s88
    v_lshl_or_b32 v26, v6, 17, v26
    v_mov_b32 v31, s88
    buffer_store_dwordx4 v[24:27], v92, s[16:19], s66 offen sc1
    v_cmp_lt_u32 vcc, 8, v42
    s_add_u32 s67, s66, 8000000
    s_mov_b64 exec, vcc
    s_cbranch_execz F_w2
    buffer_store_dwordx4 v[28:31], v92, s[16:19], s67 offen sc1
    v_cmp_lt_u32 vcc, 16, v42
    s_add_u32 s67, s67, 8000000
    s_mov_b64 exec, vcc
    s_cbranch_execz F_w2
    ds_read_b128 v[44:47], v94 offset:6400
    s_waitcnt lgkmcnt(0)
    v_mov_b32 v47, s88
    buffer_store_dwordx4 v[44:47], v92, s[16:19], s67 offen sc1
    s_nop 1
F_w2:
    s_mov_b64 exec, -1
    s_add_u32 s66, s66, 256000
    s_waitcnt lgkmcnt(0)
    v_min_u32 v5, 31, v43
    v_bfe_u32 v6, v38, 11, 6
    v_and_b32 v34, 0x1ffff, v34
    v_lshl_or_b32 v6, v5, 6, v6
    v_mov_b32 v35, s88
    v_lshl_or_b32 v34, v6, 17, v34
    v_mov_b32 v39, s88
    s_mov_b64 exec, s[22:23]
    buffer_store_dwordx4 v[32:35], v92, s[16:19], s66 offen sc1
    v_cmp_lt_u32 vcc, 8, v43
    s_add_u32 s67, s66, 8000000
    s_mov_b64 exec, vcc
    s_cbranch_execz F_w3
    buffer_store_dwordx4 v[36:39], v92, s[16:19], s67 offen sc1
    v_cmp_lt_u32 vcc, 16, v43
    s_add_u32 s67, s67, 8000000
    s_mov_b64 exec, vcc
    s_cbranch_execz F_w3
    ds_read_b128 v[44:47], v94 offset:9472
    s_waitcnt lgkmcnt(0)
    v_mov_b32 v47, s88
    buffer_store_dwordx4 v[44:47], v92, s[16:19], s67 offen sc1
    s_nop 1
F_w3:
    s_mov_b64 exec, -1
    s_cmp_eq_u32 s20, 7
    s_cbranch_scc0 F_nofrag
    s_cmp_lt_u32 s2, 160
    s_cbranch_scc0 F_nofrag
    v_or_b32 v176, v176, v180
    v_or_b32 v177, v177, v181
    v_or_b32 v178, v178, v182
    v_or_b32 v179, v179, v183
    s_lshl_b32 s66, s2, 10
    s_add_u32 s66, s66, 1024
    buffer_store_dwordx4 v[176:179], v86, s[16:19], s66 offen sc1
F_nofrag:
    s_barrier
    s_mul_i32 s24, s2, 32000
    s_lshl_b32 s25, s20, 12
    s_add_u32 s24, s24, s25
    s_add_u32 s24, s24, 164864
    s_add_u32 s25, s24, 8000000
    s_add_u32 s26, s25, 8000000
    v_mov_b32 v22, 0
    v_mov_b32 v23, s88
    s_mul_i32 s68, s20, 5120
    s_cmp_ge_u32 s20, 4
    s_cselect_b32 s70, 45056, 0
    s_add_u32 s68, s68, s70
    v_add_u32 v2, s68, v86
    ds_write_b128 v2, v[96:99] offset:0
    ds_write_b128 v2, v[100:103] offset:1024
    ds_write_b128 v2, v[104:107] offset:2048
    ds_write_b128 v2, v[108:111] offset:3072
    ds_write_b128 v2, v[112:115] offset:4096
    v_mov_b32 v4, 2130738944
    v_mov_b32 v5, 2130738944
    v_mov_b32 v6, 2130738944
    v_mov_b32 v7, 2130738944
    v_lshlrev_b32 v2, 4, v0
    v_add_u32 v3, 86016, v2
    ds_write_b128 v3, v[4:7] offset:0
    ds_write_b128 v3, v[4:7] offset:8192
    ds_write_b128 v3, v[4:7] offset:16384
    ds_write_b128 v3, v[4:7] offset:24576
    ds_write_b128 v3, v[4:7] offset:32768
    ds_write_b128 v3, v[4:7] offset:40960
    ds_write_b128 v3, v[4:7] offset:49152
    ds_write_b128 v3, v[4:7] offset:57344
    v_add_u32 v3, 0x10000, v3
    ds_write_b128 v3, v[4:7] offset:0
    v_min_u32 v2, 3056, v2
    v_add_u32 v2, 159744, v2
    ds_write_b128 v2, v[4:7]
    s_sub_u32 s72, s72, 128
    s_subb_u32 s73, s73, 0
    s_mov_b32 s4, s72
    s_and_b32 s5, s73, 0xffff
    s_mov_b32 s6, 10240000
    s_mov_b32 s7, 0x20000
    s_sub_u32 s72, s72, 1024
    s_subb_u32 s73, s73, 0
    s_mov_b32 s8, s72
    s_and_b32 s9, s73, 0xffff
    s_mov_b32 s10, 10241024
    s_mov_b32 s11, 0x20000
    s_mov_b32 s12, s76
    s_and_b32 s13, s77, 0xffff
    s_mov_b32 s14, 10240000
    s_mov_b32 s15, 0x20000
    v_lshrrev_b32 v2, 5, v1
    v_bfe_u32 v3, v1, 2, 2
    v_and_b32 v4, 3, v1
    v_bfe_u32 v5, v1, 4, 1
    v_lshlrev_b32 v6, 9, v2
    v_lshl_add_u32 v6, v3, 7, v6
    v_lshl_add_u32 v6, v5, 5, v6
    v_lshl_add_u32 v6, v4, 3, v6
    v_lshrrev_b32 v7, 1, v3
    v_lshl_add_u32 v6, v7, 6, v6
    v_add_u32 v244, s21, v6
    v_xor_b32 v245, 64, v244
    v_lshlrev_b32 v6, 7, v2
    v_lshl_add_u32 v6, v7, 5, v6
    v_and_b32 v7, 1, v3
    v_xor_b32 v7, 1, v7
    v_mul_u32_u24 v7, 90112, v7
    v_add_u32 v6, v6, v7
    v_lshl_add_u32 v249, v4, 3, v6
    v_lshl_add_u32 v6, v2, 2, v4
    v_bfe_u32 v7, v1, 2, 1
    v_lshl_add_u32 v6, v7, 3, v6
    v_lshlrev_b32 v6, 3, v6
    v_bfe_u32 v7, v1, 3, 1
    v_add_u32 v5, 1, v5
    v_mul_u32_u24 v7, v7, v5
    v_lshl_add_u32 v250, v7, 1, v6
    v_and_b32 v6, 0x38, v1
    v_add_u32 v247, 6, v6
    v_lshrrev_b32 v6, 2, v1
    v_lshrrev_b32 v7, 4, v1
    v_xor_b32 v6, v6, v7
    v_and_b32 v6, 1, v6
    v_lshlrev_b32 v6, 6, v6
    v_lshl_add_u32 v246, v4, 4, v6
    v_mov_b32 v242, 1.0
    v_mov_b32 v243, 1.0
    s_mov_b32 s54, 0xffffff00
    s_mov_b32 s55, 0xffffff00
    s_mov_b32 s56, 0xffff
    s_mov_b32 s57, 0xffff
    s_mov_b32 s58, 0
    s_mov_b32 s59, 134217856
    s_mov_b32 s60, 262272
    s_mov_b32 s61, 402915456
    s_mov_b32 s62, 940179840
    s_mov_b32 s63, 403046528
    s_mov_b32 s64, 402784384
    s_mov_b32 s65, 134348928
    s_mov_b32 s38, 128
    s_mov_b32 s33, -1
    s_and_b32 s68, s20, 3
    s_lshl_b32 s68, s68, 2
    s_lshr_b32 s69, s20, 2
    s_add_u32 s68, s68, s69
    s_lshl_b32 s68, s68, 4
    s_add_u32 s68, s68, 163072
    v_mov_b32 v251, s68
    s_mov_b32 s53, 0
    s_mov_b32 s50, 0
    s_mov_b32 s51, 0
    s_mov_b32 s47, 0
    s_mov_b32 s42, 0
    s_mov_b32 s3, 0
    s_mov_b32 s89, 0
    s_mov_b32 s34, 128
    s_mov_b32 s35, 384
    s_mov_b32 s36, 640
    s_mov_b32 s37, 896
    s_waitcnt lgkmcnt(0)
    s_barrier
    buffer_load_dwordx4 v[8:11], v86, s[16:19], s24 offen offset:0 sc1
    buffer_load_dwordx4 v[12:15], v86, s[16:19], s24 offen offset:1024 sc1
    buffer_load_dwordx4 v[16:19], v86, s[16:19], s24 offen offset:2048 sc1
    s_mov_b64 exec, s[22:23]
    buffer_load_dwordx4 v[20:23], v86, s[16:19], s24 offen offset:3072 sc1
    s_mov_b64 exec, -1
    ds_read_b128 v[96:99], v86 offset:0
    ds_read_b128 v[100:103], v86 offset:1024
    ds_read_b128 v[104:107], v86 offset:2048
    ds_read_b128 v[108:111], v86 offset:3072
    ds_read_b128 v[112:115], v86 offset:4096
    ds_read_b128 v[116:119], v86 offset:5120
    ds_read_b128 v[120:123], v86 offset:6144
    ds_read_b128 v[124:127], v86 offset:7168
    ds_read_b128 v[128:131], v86 offset:8192
    ds_read_b128 v[132:135], v86 offset:9216
    ds_read_b128 v[136:139], v86 offset:10240
    ds_read_b128 v[140:143], v86 offset:11264
    ds_read_b128 v[144:147], v86 offset:12288
    ds_read_b128 v[148:151], v86 offset:13312
    ds_read_b128 v[152:155], v86 offset:14336
    ds_read_b128 v[156:159], v86 offset:15360
    ds_read_b128 v[160:163], v86 offset:16384
    ds_read_b128 v[164:167], v86 offset:17408
    ds_read_b128 v[168:171], v86 offset:18432
    ds_read_b128 v[172:175], v86 offset:19456
    s_mov_b32 s27, 32768
    s_mov_b32 s71, 162816
    v_mov_b32 v3, 1
    s_cmp_eq_u32 s20, 7
    s_cselect_b32 s52, 160, 0
    v_cmp_gt_u32 s[68:69], 40, v1
    s_lshr_b32 s66, s2, 3
    s_lshl_b32 s66, s66, 3
    s_add_u32 s66, s66, s20
    s_mul_i32 s66, s66, 40
    v_min_u32 v93, 39, v1
    v_add_u32 v93, s66, v93
    v_lshlrev_b32 v93, 10, v93
F_poll:
    s_waitcnt vmcnt(0)
    v_cmp_ne_u32 s[72:73], s88, v11
    v_cmp_ne_u32 s[74:75], s88, v15
    v_cmp_ne_u32 s[76:77], s88, v19
    v_cmp_ne_u32 s[78:79], s88, v23
    s_or_b64 s[80:81], s[72:73], s[74:75]
    s_or_b64 s[82:83], s[76:77], s[78:79]
    s_or_b64 s[80:81], s[80:81], s[82:83]
    s_cbranch_scc1 F_again
F_got:
    v_bfe_u32 v2, v10, 23, 5
    v_bfe_u32 v60, v10, 11, 6
    v_cmp_gt_u32 s[80:81], v2, v91
    v_lshl_add_u32 v60, v60, 2, s71
    v_cmp_lt_u32 s[72:73], 8, v2
    v_max_u32 v89, v89, v2
    s_mov_b64 exec, s[80:81]
    ds_add_rtn_u32 v72, v60, v3
    s_mov_b64 exec, s[72:73]
    s_cbranch_execz F_h0
    buffer_load_dwordx4 v[24:27], v86, s[16:19], s25 offen offset:0 sc1
    v_sub_u32 v56, v2, v91
    v_bfe_u32 v64, v10, 17, 6
    v_cmp_lt_u32 vcc, 8, v56
    v_lshl_add_u32 v64, v64, 2, s71
    s_mov_b64 exec, vcc
    ds_add_rtn_u32 v76, v64, v3
F_h0:
    s_mov_b64 exec, -1
    v_bfe_u32 v2, v14, 23, 5
    v_bfe_u32 v61, v14, 11, 6
    v_cmp_gt_u32 s[82:83], v2, v91
    v_lshl_add_u32 v61, v61, 2, s71
    v_cmp_lt_u32 s[74:75], 8, v2
    v_max_u32 v89, v89, v2
    s_mov_b64 exec, s[82:83]
    ds_add_rtn_u32 v73, v61, v3
    s_mov_b64 exec, s[74:75]
    s_cbranch_execz F_h1
    buffer_load_dwordx4 v[28:31], v86, s[16:19], s25 offen offset:1024 sc1
    v_sub_u32 v57, v2, v91
    v_bfe_u32 v65, v14, 17, 6
    v_cmp_lt_u32 vcc, 8, v57
    v_lshl_add_u32 v65, v65, 2, s71
    s_mov_b64 exec, vcc
    ds_add_rtn_u32 v77, v65, v3
F_h1:
    s_mov_b64 exec, -1
    v_bfe_u32 v2, v18, 23, 5
    v_bfe_u32 v62, v18, 11, 6
    v_cmp_gt_u32 s[84:85], v2, v91
    v_lshl_add_u32 v62, v62, 2, s71
    v_cmp_lt_u32 s[76:77], 8, v2
    v_max_u32 v89, v89, v2
    s_mov_b64 exec, s[84:85]
    ds_add_rtn_u32 v74, v62, v3
    s_mov_b64 exec, s[76:77]
    s_cbranch_execz F_h2
    buffer_load_dwordx4 v[32:35], v86, s[16:19], s25 offen offset:2048 sc1
    v_sub_u32 v58, v2, v91
    v_bfe_u32 v66, v18, 17, 6
    v_cmp_lt_u32 vcc, 8, v58
    v_lshl_add_u32 v66, v66, 2, s71
    s_mov_b64 exec, vcc
    ds_add_rtn_u32 v78, v66, v3
F_h2:
    s_mov_b64 exec, -1
    v_bfe_u32 v2, v22, 23, 5
    v_bfe_u32 v63, v22, 11, 6
    v_cmp_gt_u32 s[86:87], v2, v91
    v_lshl_add_u32 v63, v63, 2, s71
    v_cmp_lt_u32 s[78:79], 8, v2
    v_max_u32 v89, v89, v2
    s_mov_b64 exec, s[86:87]
    ds_add_rtn_u32 v75, v63, v3
    s_mov_b64 exec, s[78:79]
    s_cbranch_execz F_h3
    buffer_load_dwordx4 v[36:39], v86, s[16:19], s25 offen offset:3072 sc1
    v_sub_u32 v59, v2, v91
    v_bfe_u32 v67, v22, 17, 6
    v_cmp_lt_u32 vcc, 8, v59
    v_lshl_add_u32 v67, v67, 2, s71
    s_mov_b64 exec, vcc
    ds_add_rtn_u32 v79, v67, v3
F_h3:
    s_mov_b64 exec, -1
    v_cmp_lt_u32 s[30:31], 16, v89
    s_mov_b32 s27, 262144
    s_cmp_lg_u64 s[30:31], 0
    s_cbranch_scc1 F_l3
F_l3r:
    v_and_b32 v10, 0x7ff, v10
    v_lshl_add_u32 v10, v10, 5, v90
    v_or_b32 v11, 16, v10
    v_and_b32 v14, 0x7ff, v14
    v_lshl_add_u32 v14, v14, 5, v90
    v_add_u32 v14, 327680, v14
    v_or_b32 v15, 16, v14
    v_and_b32 v18, 0x7ff, v18
    v_lshl_add_u32 v18, v18, 5, v90
    v_add_u32 v18, 655360, v18
    v_or_b32 v19, 16, v18
    v_and_b32 v22, 0x7ff, v22
    v_lshl_add_u32 v22, v22, 5, v90
    v_add_u32 v22, 983040, v22
    v_or_b32 v23, 16, v22
    s_cmp_lt_u32 s2, s52
    s_cbranch_scc1 F_flag
F_flagr:
    s_waitcnt lgkmcnt(0)
    s_barrier
    ds_read_b32 v4, v88
    buffer_load_dword v95, v93, s[4:7], 0 offen offset:128
    v_lshlrev_b32 v72, 3, v72
    v_lshlrev_b32 v73, 3, v73
    v_lshlrev_b32 v74, 3, v74
    v_lshlrev_b32 v75, 3, v75
    v_lshlrev_b32 v76, 3, v76
    v_lshlrev_b32 v77, 3, v77
    v_lshlrev_b32 v78, 3, v78
    v_lshlrev_b32 v79, 3, v79
    s_waitcnt lgkmcnt(0)
    v_add_u32 v5, 15, v4
    v_cmp_lt_u32 vcc, 64, v4
    v_lshrrev_b32 v5, 4, v5
    v_med3_u32 v5, v5, 1, 4
    v_mul_u32_u24 v6, 640, v5
    v_max_u32 v6, 1536, v6
    v_cndmask_b32 v6, 0, v6, s[68:69]
    s_cmp_lg_u64 vcc, 0
    s_cbranch_scc1 SLOW
    v_mov_b32 v7, v6
    v_add_u32 v2, 7, v4
    v_lshrrev_b32 v2, 3, v2
    v_add_u32_dpp v7, v7, v7 row_shr:1 row_mask:0xf bank_mask:0xf
    v_max_u32 v2, 2, v2
    v_cmp_eq_u32 vcc, 7, v2
    v_add_u32_dpp v7, v7, v7 row_shr:2 row_mask:0xf bank_mask:0xf
    v_lshlrev_b32 v92, 22, v5
    v_lshlrev_b32 v5, 18, v5
    v_add_u32_dpp v7, v7, v7 row_shr:4 row_mask:0xf bank_mask:0xf
    v_lshl_or_b32 v5, v1, 21, v5
    v_addc_co_u32 v2, vcc, 0, v2, vcc
    v_add_u32_dpp v7, v7, v7 row_shr:8 row_mask:0xf bank_mask:0xf
    v_lshl_or_b32 v5, v2, 28, v5
    v_med3_u32 v2, v2, 3, 6
    v_add_u32_dpp v7, v7, v7 row_bcast:15 row_mask:0xa bank_mask:0xf
    v_cndmask_b32 v2, 0, v2, s[68:69]
    v_mov_b32 v84, 63
    v_add_u32_dpp v7, v7, v7 row_bcast:31 row_mask:0xc bank_mask:0xf
    s_mov_b32 s71, 0x2000
    v_readlane_b32 s66, v7, 63
    v_sub_u32 v7, v7, v6
    v_add_u32 v7, 86016, v7
    v_lshrrev_b32 v6, 3, v7
    v_mad_u32_u24 v92, v7, s71, v92
    v_or_b32 v92, v92, v6
    ds_bpermute_b32 v60, v60, v92
    ds_bpermute_b32 v61, v61, v92
    ds_bpermute_b32 v62, v62, v92
    ds_bpermute_b32 v63, v63, v92
    ds_bpermute_b32 v64, v64, v92
    ds_bpermute_b32 v65, v65, v92
    ds_bpermute_b32 v66, v66, v92
    ds_bpermute_b32 v67, v67, v92
    v_cmp_eq_u32 vcc, 6, v2
    v_or_b32 v6, v5, v7
    s_cmp_gt_u32 s66, 76800
    s_cbranch_scc1 SLOW
    v_mbcnt_lo_u32_b32 v5, vcc_lo, 0
    v_mbcnt_hi_u32_b32 v5, vcc_hi, v5
    s_bcnt1_i32_b64 s71, vcc
    v_cndmask_b32 v84, v84, v5, vcc
    v_cmp_eq_u32 vcc, 5, v2
    v_mov_b32 v3, s71
    s_nop 0
    v_mbcnt_lo_u32_b32 v5, vcc_lo, v3
    v_mbcnt_hi_u32_b32 v5, vcc_hi, v5
    s_bcnt1_i32_b64 s71, vcc
    v_cndmask_b32 v84, v84, v5, vcc
    v_cmp_eq_u32 vcc, 4, v2
    v_add_u32 v3, s71, v3
    s_nop 0
    v_mbcnt_lo_u32_b32 v5, vcc_lo, v3
    v_mbcnt_hi_u32_b32 v5, vcc_hi, v5
    s_bcnt1_i32_b64 s71, vcc
    v_cndmask_b32 v84, v84, v5, vcc
    v_cmp_eq_u32 vcc, 3, v2
    v_add_u32 v3, s71, v3
    s_nop 0
    v_mbcnt_lo_u32_b32 v5, vcc_lo, v3
    v_mbcnt_hi_u32_b32 v5, vcc_hi, v5
    v_cndmask_b32 v84, v84, v5, vcc
    s_waitcnt lgkmcnt(7)
    v_mad_u32_u16 v2, v60, 8, v72
    v_mad_u32_u16 v3, v60, 8, v72 op_sel:[1,0,0,0]
    s_mov_b64 exec, s[80:81]
    ds_write_b64 v2, v[10:11]
    ds_write_b64 v3, v[8:9]
    s_mov_b64 exec, -1
    s_waitcnt lgkmcnt(8)
    v_mad_u32_u16 v2, v61, 8, v73
    v_mad_u32_u16 v3, v61, 8, v73 op_sel:[1,0,0,0]
    s_mov_b64 exec, s[82:83]
    ds_write_b64 v2, v[14:15]
    ds_write_b64 v3, v[12:13]
    s_mov_b64 exec, -1
    s_waitcnt lgkmcnt(9)
    v_mad_u32_u16 v2, v62, 8, v74
    v_mad_u32_u16 v3, v62, 8, v74 op_sel:[1,0,0,0]
    s_mov_b64 exec, s[84:85]
    ds_write_b64 v2, v[18:19]
    ds_write_b64 v3, v[16:17]
    s_mov_b64 exec, -1
    s_waitcnt lgkmcnt(10)
    v_mad_u32_u16 v2, v63, 8, v75
    v_mad_u32_u16 v3, v63, 8, v75 op_sel:[1,0,0,0]
    s_mov_b64 exec, s[86:87]
    ds_write_b64 v2, v[22:23]
    ds_write_b64 v3, v[20:21]
    s_mov_b64 exec, -1
    v_bfe_u32 v2, v84, 2, 1
    v_bfe_u32 v3, v84, 3, 1
    v_mul_u32_u24 v2, 3, v2
    v_lshl_or_b32 v3, v3, 2, v2
    v_xor_b32 v84, v84, v3
    v_cmp_eq_u32 vcc, s20, v84
    s_ff1_i32_b64 s67, vcc
    v_readlane_b32 s80, v6, s67
    s_waitcnt vmcnt(1) lgkmcnt(8)
    s_mov_b64 exec, s[72:73]
    s_cbranch_execz F_s0
F_sp0:
    v_cmp_ne_u32 vcc, s88, v27
    s_cbranch_vccnz F_sa0
F_sg0:
    v_cmpx_lt_u32 vcc, 8, v56
    v_and_b32 v26, 0x7ff, v26
    v_lshl_add_u32 v26, v26, 5, v90
    v_or_b32 v27, 16, v26
    v_mad_u32_u16 v2, v64, 8, v76
    v_mad_u32_u16 v3, v64, 8, v76 op_sel:[1,0,0,0]
    ds_write_b64 v2, v[26:27]
    ds_write_b64 v3, v[24:25]
F_s0:
    s_mov_b64 exec, s[74:75]
    s_cbranch_execz F_s1
F_sp1:
    v_cmp_ne_u32 vcc, s88, v31
    s_cbranch_vccnz F_sa1
F_sg1:
    v_cmpx_lt_u32 vcc, 8, v57
    v_and_b32 v30, 0x7ff, v30
    v_lshl_add_u32 v30, v30, 5, v90
    v_add_u32 v30, 327680, v30
    v_or_b32 v31, 16, v30
    v_mad_u32_u16 v2, v65, 8, v77
    v_mad_u32_u16 v3, v65, 8, v77 op_sel:[1,0,0,0]
    ds_write_b64 v2, v[30:31]
    ds_write_b64 v3, v[28:29]
F_s1:
    s_mov_b64 exec, s[76:77]
    s_cbranch_execz F_s2
F_sp2:
    v_cmp_ne_u32 vcc, s88, v35
    s_cbranch_vccnz F_sa2
F_sg2:
    v_cmpx_lt_u32 vcc, 8, v58
    v_and_b32 v34, 0x7ff, v34
    v_lshl_add_u32 v34, v34, 5, v90
    v_add_u32 v34, 655360, v34
    v_or_b32 v35, 16, v34
    v_mad_u32_u16 v2, v66, 8, v78
    v_mad_u32_u16 v3, v66, 8, v78 op_sel:[1,0,0,0]
    ds_write_b64 v2, v[34:35]
    ds_write_b64 v3, v[32:33]
F_s2:
    s_mov_b64 exec, s[78:79]
    s_cbranch_execz F_s3
F_sp3:
    v_cmp_ne_u32 vcc, s88, v39
    s_cbranch_vccnz F_sa3
F_sg3:
    v_cmpx_lt_u32 vcc, 8, v59
    v_and_b32 v38, 0x7ff, v38
    v_lshl_add_u32 v38, v38, 5, v90
    v_add_u32 v38, 983040, v38
    v_or_b32 v39, 16, v38
    v_mad_u32_u16 v2, v67, 8, v79
    v_mad_u32_u16 v3, v67, 8, v79 op_sel:[1,0,0,0]
    ds_write_b64 v2, v[38:39]
    ds_write_b64 v3, v[36:37]
F_s3:
    s_mov_b64 exec, -1
    s_cmp_lg_u64 s[30:31], 0
    s_cbranch_scc1 F_u
F_ur:
    s_mov_b32 s22, s80
    s_mov_b32 s27, s80
    s_mov_b32 s71, s80
    s_bfe_u32 s46, s71, 0x30012
    s_mov_b32 m0, s46
    s_and_b32 s66, s71, 0x3ffff
    s_movrels_b32 s68, s57
    s_movrels_b32 s69, s61
    s_sub_u32 s48, s66, s47
    s_mov_b32 s47, s66
    s_lshr_b32 s52, s71, 28
    s_lshl_b32 s67, s46, 9
    s_add_u32 s66, s66, s67
    s_sub_u32 s49, s66, s42
    s_mov_b32 s42, s66
    s_bfe_u32 s66, s68, 655360
    s_add_u32 s43, s42, s66
    s_bfe_u32 s39, s69, 655360
    s_bfe_u32 s66, s68, 655370
    s_add_u32 s44, s42, s66
    s_bfe_u32 s40, s69, 655370
    s_bfe_u32 s66, s68, 655380
    s_add_u32 s45, s42, s66
    s_bfe_u32 s41, s69, 655380
    s_and_b32 s66, s46, s33
    s_cselect_b32 s72, -1, 1
    s_cselect_b32 s76, s47, 163712
    s_cmp_ge_u32 s66, 2
    s_cselect_b32 s73, -1, 0
    s_add_u32 s77, s47, 1024
    s_cmp_ge_u32 s66, 4
    s_cselect_b32 s75, -1, 0
    s_cmp_ge_u32 s66, 3
    s_cselect_b32 s74, -1, 1
    s_cselect_b32 s77, s77, 163712
    s_mul_i32 s66, s20, 80
    v_min_u32 v2, 76, v248
    s_waitcnt lgkmcnt(0)
    s_barrier
    v_add_u32 v253, s47, v248
    ds_read_b32 v254, v253
    ds_read_b32 v255, v253 offset:256
    v_add_u32 v252, s42, v247
    ds_read_u16 v234, v252
    ds_read_u16 v235, v252 offset:64
    v_add_u32 v252, s43, v247
    ds_read_u16 v236, v252
    ds_read_u16 v237, v252 offset:64
    v_add_u32 v252, s44, v247
    ds_read_u16 v238, v252
    ds_read_u16 v239, v252 offset:64
    v_add_u32 v252, s45, v247
    ds_read_u16 v240, v252
    ds_read_u16 v241, v252 offset:64
    buffer_load_dword v3, v2, s[16:19], s66 offen offset:128 sc1
    v_add_u32 v249, s48, v249
    v_add_u32 v250, s49, v250
    s_waitcnt lgkmcnt(8)
    s_mov_b32 m0, s76
    s_mov_b64 exec, s[72:73]
    buffer_load_dwordx4 v254, s[12:15], 0 offen  lds
    s_mov_b32 m0, s77
    s_mov_b64 exec, s[74:75]
    buffer_load_dwordx4 v255, s[12:15], 0 offen  lds
    s_mov_b64 exec, -1
    s_waitcnt lgkmcnt(0)
    s_add_u32 m0, s21, 0
    v_lshl_add_u32 v234, v234, 10, v246
    v_lshl_add_u32 v235, v235, 10, v246
    buffer_load_dwordx4 v234, s[4:7], s38 offen lds
    buffer_load_dwordx4 v235, s[8:11], s38 offen offset:1024 lds
    s_add_u32 m0, s21, 2048
    v_lshl_add_u32 v236, v236, 10, v246
    v_lshl_add_u32 v237, v237, 10, v246
    buffer_load_dwordx4 v236, s[4:7], s39 offen lds
    buffer_load_dwordx4 v237, s[8:11], s39 offen offset:1024 lds
    s_add_u32 m0, s21, 4096
    v_lshl_add_u32 v238, v238, 10, v246
    v_lshl_add_u32 v239, v239, 10, v246
    buffer_load_dwordx4 v238, s[4:7], s40 offen lds
    buffer_load_dwordx4 v239, s[8:11], s40 offen offset:1024 lds
    s_add_u32 m0, s21, 6144
    v_lshl_add_u32 v240, v240, 10, v246
    v_lshl_add_u32 v241, v241, 10, v246
    buffer_load_dwordx4 v240, s[4:7], s41 offen lds
    buffer_load_dwordx4 v241, s[8:11], s41 offen offset:1024 lds
    v_lshrrev_b32 v8, 3, v84
    v_and_b32 v9, 7, v84
    v_lshlrev_b32 v9, 13, v9
    v_mul_u32_u24 v8, 1536, v8
    v_and_b32 v5, 128, v86
    v_add3_u32 v8, v8, v9, v5
    v_xor_b32 v9, v86, v7
    v_and_b32 v9, 128, v9
    v_add_u32 v9, v9, v7
    v_and_b32 v4, 0x70, v86
    v_or_b32 v5, v9, v4
    s_add_u32 s66, s20, 0
    v_cmp_eq_u32 vcc, s66, v84
    s_ff1_i32_b64 s67, vcc
    v_readlane_b32 s28, v5, s67
    s_add_u32 s66, s20, 8
    v_cmp_eq_u32 vcc, s66, v84
    s_ff1_i32_b64 s67, vcc
    v_readlane_b32 s29, v5, s67
    v_readlane_b32 s23, v6, s67
    s_add_u32 s66, s20, 16
    v_cmp_eq_u32 vcc, s66, v84
    s_ff1_i32_b64 s67, vcc
    v_readlane_b32 s30, v5, s67
    v_readlane_b32 s24, v6, s67
    s_add_u32 s66, s20, 24
    v_cmp_eq_u32 vcc, s66, v84
    s_ff1_i32_b64 s67, vcc
    v_readlane_b32 s31, v5, s67
    v_readlane_b32 s25, v6, s67
    s_add_u32 s66, s20, 32
    v_cmp_eq_u32 vcc, s66, v84
    s_ff1_i32_b64 s67, vcc
    v_readlane_b32 s32, v5, s67
    v_readlane_b32 s26, v6, s67
    v_lshlrev_b32 v4, 3, v1
    v_add_u32 v4, 163328, v4
    s_mov_b32 exec_hi, 0xff
    ds_write_b64 v4, v[8:9]
    s_mov_b32 exec_hi, -1
    s_waitcnt lgkmcnt(0)
    v_mov_b32 v252, 0
    s_waitcnt vmcnt(6)
    v_cmp_ne_u32 vcc, s88, v3
    ds_read_b64_tr_b16 v[176:177], v244 offset:0
    ds_read_b64_tr_b16 v[178:179], v244 offset:1024
    ds_read_b64_tr_b16 v[180:181], v245 offset:0
    ds_read_b64_tr_b16 v[182:183], v245 offset:1024
    ds_read_b64_tr_b16 v[64:65], v249 offset:0
    ds_read_b64_tr_b16 v[68:69], v249 offset:64
    ds_read_b64_tr_b16 v[66:67], v249 offset:256
    ds_read_b64_tr_b16 v[70:71], v249 offset:320
    s_mov_b64 exec, s[54:55]
    ds_read_u16_d16_hi v242, v250 offset:0
    s_mov_b64 exec, -1
    s_or_b32 s89, vcc_lo, vcc_hi
    s_waitcnt lgkmcnt(5)
    v_readfirstlane_b32 s66, v252
    s_add_u32 s53, s53, 1
    v_mov_b32 v252, s53
    s_cmp_le_u32 s53, s66
    ds_write2_b32 v251, v252, v252 offset0:0 offset1:8
    s_setprio 1
    s_cbranch_scc1 PRIO_1
    s_setprio 0
PRIO_1:
    s_cmp_eq_u32 s52, 4
    s_cbranch_scc1 ITEM_0_4
    s_cmp_eq_u32 s52, 5
    s_cbranch_scc1 ITEM_0_5
    s_cmp_eq_u32 s52, 3
    s_cbranch_scc1 ITEM_0_3
    s_cmp_eq_u32 s52, 6
    s_cbranch_scc1 ITEM_0_6
    s_cmp_eq_u32 s52, 8
    s_cbranch_scc1 ITEM_0_8
    s_branch ITEM_0_2
F_again:
    s_sub_u32 s27, s27, 1
    s_cbranch_scc1 F_late
    s_cmp_eq_u64 s[72:73], 0
    s_cbranch_scc1 F_p0
    buffer_load_dwordx4 v[8:11], v86, s[16:19], s24 offen offset:0 sc1
F_p0:
    s_cmp_eq_u64 s[74:75], 0
    s_cbranch_scc1 F_p1
    buffer_load_dwordx4 v[12:15], v86, s[16:19], s24 offen offset:1024 sc1
F_p1:
    s_cmp_eq_u64 s[76:77], 0
    s_cbranch_scc1 F_p2
    buffer_load_dwordx4 v[16:19], v86, s[16:19], s24 offen offset:2048 sc1
F_p2:
    s_cmp_eq_u64 s[78:79], 0
    s_cbranch_scc1 F_p3
    s_mov_b64 exec, s[22:23]
    buffer_load_dwordx4 v[20:23], v86, s[16:19], s24 offen offset:3072 sc1
    s_mov_b64 exec, -1
F_p3:
    s_branch F_poll
F_late:
    v_mov_b32 v2, 163064
    v_mov_b32 v4, 1000
    ds_write_b32 v2, v4
    v_mov_b32 v10, 0
    v_mov_b32 v14, 0
    v_mov_b32 v18, 0
    v_mov_b32 v22, 0
    s_branch F_got
F_l3:
    v_bfe_u32 v2, v10, 23, 5
    v_sub_u32 v56, v2, v91
    v_cmp_lt_u32 vcc, 16, v2
    s_mov_b64 exec, vcc
    s_cbranch_execz F_t0
F_tp0:
    buffer_load_dwordx4 v[40:43], v86, s[16:19], s26 offen offset:0 sc1
    s_waitcnt vmcnt(0)
    v_cmp_ne_u32 vcc, s88, v43
    s_sub_u32 s27, s27, 1
    s_cselect_b64 vcc, 0, vcc
    s_cmp_eq_u64 vcc, 0
    s_cbranch_scc0 F_tp0
    v_bfe_u32 v68, v42, 11, 6
    v_lshl_add_u32 v68, v68, 2, s71
    v_cmp_lt_i32 vcc, 16, v56
    s_mov_b64 exec, vcc
    ds_add_rtn_u32 v80, v68, v3
F_t0:
    s_mov_b64 exec, -1
    v_bfe_u32 v2, v14, 23, 5
    v_sub_u32 v57, v2, v91
    v_cmp_lt_u32 vcc, 16, v2
    s_mov_b64 exec, vcc
    s_cbranch_execz F_t1
F_tp1:
    buffer_load_dwordx4 v[44:47], v86, s[16:19], s26 offen offset:1024 sc1
    s_waitcnt vmcnt(0)
    v_cmp_ne_u32 vcc, s88, v47
    s_sub_u32 s27, s27, 1
    s_cselect_b64 vcc, 0, vcc
    s_cmp_eq_u64 vcc, 0
    s_cbranch_scc0 F_tp1
    v_bfe_u32 v69, v46, 11, 6
    v_lshl_add_u32 v69, v69, 2, s71
    v_cmp_lt_i32 vcc, 16, v57
    s_mov_b64 exec, vcc
    ds_add_rtn_u32 v81, v69, v3
F_t1:
    s_mov_b64 exec, -1
    v_bfe_u32 v2, v18, 23, 5
    v_sub_u32 v58, v2, v91
    v_cmp_lt_u32 vcc, 16, v2
    s_mov_b64 exec, vcc
    s_cbranch_execz F_t2
F_tp2:
    buffer_load_dwordx4 v[48:51], v86, s[16:19], s26 offen offset:2048 sc1
    s_waitcnt vmcnt(0)
    v_cmp_ne_u32 vcc, s88, v51
    s_sub_u32 s27, s27, 1
    s_cselect_b64 vcc, 0, vcc
    s_cmp_eq_u64 vcc, 0
    s_cbranch_scc0 F_tp2
    v_bfe_u32 v70, v50, 11, 6
    v_lshl_add_u32 v70, v70, 2, s71
    v_cmp_lt_i32 vcc, 16, v58
    s_mov_b64 exec, vcc
    ds_add_rtn_u32 v82, v70, v3
F_t2:
    s_mov_b64 exec, -1
    v_bfe_u32 v2, v22, 23, 5
    v_sub_u32 v59, v2, v91
    v_cmp_lt_u32 vcc, 16, v2
    s_mov_b64 exec, vcc
    s_cbranch_execz F_t3
F_tp3:
    buffer_load_dwordx4 v[52:55], v86, s[16:19], s26 offen offset:3072 sc1
    s_waitcnt vmcnt(0)
    v_cmp_ne_u32 vcc, s88, v55
    s_sub_u32 s27, s27, 1
    s_cselect_b64 vcc, 0, vcc
    s_cmp_eq_u64 vcc, 0
    s_cbranch_scc0 F_tp3
    v_bfe_u32 v71, v54, 11, 6
    v_lshl_add_u32 v71, v71, 2, s71
    v_cmp_lt_i32 vcc, 16, v59
    s_mov_b64 exec, vcc
    ds_add_rtn_u32 v83, v71, v3
F_t3:
    s_mov_b64 exec, -1
    v_mov_b32 v2, 163068
    v_mov_b32 v4, 1000
    v_cmp_lt_u32 vcc, 24, v89
    s_mov_b64 exec, vcc
    ds_write_b32 v2, v4
    s_mov_b64 exec, -1
    s_branch F_l3r
F_flag:
    s_lshl_b32 s66, s2, 2
    v_mov_b32 v2, 128
    v_mov_b32 v4, s88
    s_mov_b64 exec, 1
    buffer_store_dword v4, v2, s[16:19], s66 offen sc1
    s_mov_b64 exec, -1
    s_branch F_flagr
F_sa0:
    s_sub_u32 s27, s27, 1
    s_cbranch_scc1 F_sg0
    buffer_load_dwordx4 v[24:27], v86, s[16:19], s25 offen offset:0 sc1
    s_waitcnt vmcnt(0)
    s_branch F_sp0
F_sa1:
    s_sub_u32 s27, s27, 1
    s_cbranch_scc1 F_sg1
    buffer_load_dwordx4 v[28:31], v86, s[16:19], s25 offen offset:1024 sc1
    s_waitcnt vmcnt(0)
    s_branch F_sp1
F_sa2:
    s_sub_u32 s27, s27, 1
    s_cbranch_scc1 F_sg2
    buffer_load_dwordx4 v[32:35], v86, s[16:19], s25 offen offset:2048 sc1
    s_waitcnt vmcnt(0)
    s_branch F_sp2
F_sa3:
    s_sub_u32 s27, s27, 1
    s_cbranch_scc1 F_sg3
    buffer_load_dwordx4 v[36:39], v86, s[16:19], s25 offen offset:3072 sc1
    s_waitcnt vmcnt(0)
    s_branch F_sp3
F_u:
    ds_bpermute_b32 v68, v68, v92
    ds_bpermute_b32 v69, v69, v92
    ds_bpermute_b32 v70, v70, v92
    ds_bpermute_b32 v71, v71, v92
    s_waitcnt lgkmcnt(0)
    v_cmp_lt_i32 vcc, 16, v56
    s_mov_b64 exec, vcc
    s_cbranch_execz F_u0
    v_lshlrev_b32 v80, 3, v80
    v_and_b32 v42, 0x7ff, v42
    v_lshl_add_u32 v42, v42, 5, v90
    v_or_b32 v43, 16, v42
    v_mad_u32_u16 v2, v68, 8, v80
    v_mad_u32_u16 v3, v68, 8, v80 op_sel:[1,0,0,0]
    ds_write_b64 v2, v[42:43]
    ds_write_b64 v3, v[40:41]
F_u0:
    s_mov_b64 exec, -1
    v_cmp_lt_i32 vcc, 16, v57
    s_mov_b64 exec, vcc
    s_cbranch_execz F_u1
    v_lshlrev_b32 v81, 3, v81
    v_and_b32 v46, 0x7ff, v46
    v_lshl_add_u32 v46, v46, 5, v90
    v_add_u32 v46, 327680, v46
    v_or_b32 v47, 16, v46
    v_mad_u32_u16 v2, v69, 8, v81
    v_mad_u32_u16 v3, v69, 8, v81 op_sel:[1,0,0,0]
    ds_write_b64 v2, v[46:47]
    ds_write_b64 v3, v[44:45]
F_u1:
    s_mov_b64 exec, -1
    v_cmp_lt_i32 vcc, 16, v58
    s_mov_b64 exec, vcc
    s_cbranch_execz F_u2
    v_lshlrev_b32 v82, 3, v82
    v_and_b32 v50, 0x7ff, v50
    v_lshl_add_u32 v50, v50, 5, v90
    v_add_u32 v50, 655360, v50
    v_or_b32 v51, 16, v50
    v_mad_u32_u16 v2, v70, 8, v82
    v_mad_u32_u16 v3, v70, 8, v82 op_sel:[1,0,0,0]
    ds_write_b64 v2, v[50:51]
    ds_write_b64 v3, v[48:49]
F_u2:
    s_mov_b64 exec, -1
    v_cmp_lt_i32 vcc, 16, v59
    s_mov_b64 exec, vcc
    s_cbranch_execz F_u3
    v_lshlrev_b32 v83, 3, v83
    v_and_b32 v54, 0x7ff, v54
    v_lshl_add_u32 v54, v54, 5, v90
    v_add_u32 v54, 983040, v54
    v_or_b32 v55, 16, v54
    v_mad_u32_u16 v2, v71, 8, v83
    v_mad_u32_u16 v3, v71, 8, v83 op_sel:[1,0,0,0]
    ds_write_b64 v2, v[54:55]
    ds_write_b64 v3, v[52:53]
F_u3:
    s_mov_b64 exec, -1
    s_branch F_ur
LAST0:
    s_cmp_eq_u32 s50, 5
    s_cbranch_scc1 TO_PHASE1
    s_add_u32 s4, s4, 128
    s_addc_u32 s5, s5, 0
    s_add_u32 s8, s8, 128
    s_addc_u32 s9, s9, 0
    s_mov_b32 s34, 0
    s_mov_b32 s35, 256
    s_mov_b32 s36, 512
    s_mov_b32 s37, 768
    s_mov_b32 s33, 0
    s_waitcnt lgkmcnt(5)
    v_readfirstlane_b32 s66, v252
    s_add_u32 s53, s53, 1
    v_mov_b32 v252, s53
    s_cmp_le_u32 s53, s66
    ds_write2_b32 v251, v252, v252 offset0:0 offset1:8
    s_setprio 1
    s_cbranch_scc1 PRIO_2
    s_setprio 0
PRIO_2:
    s_cmp_eq_u32 s52, 4
    s_cbranch_scc1 ITEM_0_4
    s_cmp_eq_u32 s52, 5
    s_cbranch_scc1 ITEM_0_5
    s_cmp_eq_u32 s52, 3
    s_cbranch_scc1 ITEM_0_3
    s_cmp_eq_u32 s52, 6
    s_cbranch_scc1 ITEM_0_6
    s_cmp_eq_u32 s52, 8
    s_cbranch_scc1 ITEM_0_8
    s_branch ITEM_0_2
TO_PHASE1:
    v_lshlrev_b32 v253, 2, v248
    v_add_u32 v253, 65536, v253
    ds_read_b128 v[96:99], v253 offset:0
    ds_read_b128 v[100:103], v253 offset:1024
    ds_read_b128 v[104:107], v253 offset:2048
    ds_read_b128 v[108:111], v253 offset:3072
    ds_read_b128 v[112:115], v253 offset:4096
    ds_read_b128 v[116:119], v253 offset:5120
    ds_read_b128 v[120:123], v253 offset:6144
    ds_read_b128 v[124:127], v253 offset:7168
    ds_read_b128 v[128:131], v253 offset:8192
    ds_read_b128 v[132:135], v253 offset:9216
    ds_read_b128 v[136:139], v253 offset:10240
    ds_read_b128 v[140:143], v253 offset:11264
    ds_read_b128 v[144:147], v253 offset:12288
    ds_read_b128 v[148:151], v253 offset:13312
    ds_read_b128 v[152:155], v253 offset:14336
    ds_read_b128 v[156:159], v253 offset:15360
    ds_read_b128 v[160:163], v253 offset:16384
    ds_read_b128 v[164:167], v253 offset:17408
    ds_read_b128 v[168:171], v253 offset:18432
    ds_read_b128 v[172:175], v253 offset:19456
    s_mov_b32 s34, 128
    s_mov_b32 s35, 384
    s_mov_b32 s36, 640
    s_mov_b32 s37, 896
    s_mov_b32 s50, 0
    s_waitcnt lgkmcnt(0)
    s_waitcnt lgkmcnt(0)
    v_readfirstlane_b32 s66, v252
    s_add_u32 s53, s53, 1
    v_mov_b32 v252, s53
    s_cmp_le_u32 s53, s66
    ds_write2_b32 v251, v252, v252 offset0:0 offset1:8
    s_setprio 1
    s_cbranch_scc1 PRIO_3
    s_setprio 0
PRIO_3:
    s_cmp_eq_u32 s52, 4
    s_cbranch_scc1 ITEM_1_4
    s_cmp_eq_u32 s52, 5
    s_cbranch_scc1 ITEM_1_5
    s_cmp_eq_u32 s52, 3
    s_cbranch_scc1 ITEM_1_3
    s_cmp_eq_u32 s52, 6
    s_cbranch_scc1 ITEM_1_6
    s_cmp_eq_u32 s52, 8
    s_cbranch_scc1 ITEM_1_8
    s_branch ITEM_1_2
LAST1:
    s_cmp_eq_u32 s50, 5
    s_cbranch_scc1 TAIL
    v_mov_b32 v246, 0x7f000000
    s_load_dwordx2 s[72:73], s[0:1], 72
    s_waitcnt lgkmcnt(7)
    v_readfirstlane_b32 s66, v252
    s_add_u32 s53, s53, 1
    v_mov_b32 v252, s53
    s_cmp_le_u32 s53, s66
    ds_write2_b32 v251, v252, v252 offset0:0 offset1:8
    s_setprio 1
    s_cbranch_scc1 PRIO_4
    s_setprio 0
PRIO_4:
    s_cmp_eq_u32 s52, 4
    s_cbranch_scc1 ITEM_1_4
    s_cmp_eq_u32 s52, 5
    s_cbranch_scc1 ITEM_1_5
    s_cmp_eq_u32 s52, 3
    s_cbranch_scc1 ITEM_1_3
    s_cmp_eq_u32 s52, 6
    s_cbranch_scc1 ITEM_1_6
    s_cmp_eq_u32 s52, 8
    s_cbranch_scc1 ITEM_1_8
    s_branch ITEM_1_2
.p2align 6
ITEM_0_4:
    s_mov_b64 exec, s[54:55]
    ds_read_u16_d16_hi v243, v250 offset:128
    s_mov_b64 exec, -1
    ds_read_b64_tr_b16 v[72:73], v249 offset:512
    ds_read_b64_tr_b16 v[76:77], v249 offset:576
    ds_read_b64_tr_b16 v[74:75], v249 offset:768
    ds_read_b64_tr_b16 v[78:79], v249 offset:832
    s_waitcnt lgkmcnt(5)
    v_mul_f32_dpp v196, v242, v64 row_newbcast:0 row_mask:0xf bank_mask:0xf
    v_mul_f32_dpp v197, v242, v65 row_newbcast:1 row_mask:0xf bank_mask:0xf
    v_mul_f32_dpp v198, v242, v64 row_newbcast:8 row_mask:0xf bank_mask:0xf
    v_mul_f32_dpp v199, v242, v65 row_newbcast:9 row_mask:0xf bank_mask:0xf
    v_mul_f32_dpp v200, v242, v68 row_newbcast:2 row_mask:0xf bank_mask:0xf
    v_mul_f32_dpp v201, v242, v69 row_newbcast:3 row_mask:0xf bank_mask:0xf
    v_mul_f32_dpp v202, v242, v68 row_newbcast:10 row_mask:0xf bank_mask:0xf
    v_mul_f32_dpp v203, v242, v69 row_newbcast:11 row_mask:0xf bank_mask:0xf
    v_cvt_pk_bf16_f32 v64, v196, v197
    v_cvt_pk_bf16_f32 v68, v198, v199
    v_cvt_pk_bf16_f32 v65, v200, v201
    v_cvt_pk_bf16_f32 v69, v202, v203
    v_mul_f32_dpp v196, v242, v66 row_newbcast:4 row_mask:0xf bank_mask:0xf
    v_mul_f32_dpp v197, v242, v67 row_newbcast:5 row_mask:0xf bank_mask:0xf
    v_mul_f32_dpp v198, v242, v66 row_newbcast:12 row_mask:0xf bank_mask:0xf
    v_mul_f32_dpp v199, v242, v67 row_newbcast:13 row_mask:0xf bank_mask:0xf
    v_mul_f32_dpp v200, v242, v70 row_newbcast:6 row_mask:0xf bank_mask:0xf
    v_mul_f32_dpp v201, v242, v71 row_newbcast:7 row_mask:0xf bank_mask:0xf
    v_mul_f32_dpp v202, v242, v70 row_newbcast:14 row_mask:0xf bank_mask:0xf
    v_mul_f32_dpp v203, v242, v71 row_newbcast:15 row_mask:0xf bank_mask:0xf
    v_cvt_pk_bf16_f32 v66, v196, v197
    v_cvt_pk_bf16_f32 v70, v198, v199
    v_cvt_pk_bf16_f32 v67, v200, v201
    v_cvt_pk_bf16_f32 v71, v202, v203
    s_nop 0
    s_waitcnt vmcnt(4) lgkmcnt(0)
    v_mfma_f32_32x32x16_bf16 v[0:15], v[64:67], v[176:179], 0
    v_mul_f32_dpp v196, v243, v72 row_newbcast:0 row_mask:0xf bank_mask:0xf
    v_mul_f32_dpp v197, v243, v73 row_newbcast:1 row_mask:0xf bank_mask:0xf
    v_mul_f32_dpp v198, v243, v72 row_newbcast:8 row_mask:0xf bank_mask:0xf
    v_mul_f32_dpp v199, v243, v73 row_newbcast:9 row_mask:0xf bank_mask:0xf
    v_mul_f32_dpp v200, v243, v76 row_newbcast:2 row_mask:0xf bank_mask:0xf
    v_mul_f32_dpp v201, v243, v77 row_newbcast:3 row_mask:0xf bank_mask:0xf
    v_mul_f32_dpp v202, v243, v76 row_newbcast:10 row_mask:0xf bank_mask:0xf
    v_mul_f32_dpp v203, v243, v77 row_newbcast:11 row_mask:0xf bank_mask:0xf
    v_cvt_pk_bf16_f32 v72, v196, v197
    v_cvt_pk_bf16_f32 v76, v198, v199
    v_cvt_pk_bf16_f32 v73, v200, v201
    v_cvt_pk_bf16_f32 v77, v202, v203
    s_add_u32 m0, s21, 0
    v_mfma_f32_32x32x16_bf16 v[16:31], v[68:71], v[176:179], 0
    buffer_load_dwordx4 v234, s[4:7], s36 offen lds
    buffer_load_dwordx4 v235, s[8:11], s36 offen offset:1024 lds
    ds_read_b64_tr_b16 v[176:177], v244 offset:2048
    ds_read_b64_tr_b16 v[178:179], v244 offset:3072
    ds_read_b64_tr_b16 v[184:185], v245 offset:2048
    ds_read_b64_tr_b16 v[186:187], v245 offset:3072
    v_mul_f32_dpp v196, v243, v74 row_newbcast:4 row_mask:0xf bank_mask:0xf
    v_mul_f32_dpp v197, v243, v75 row_newbcast:5 row_mask:0xf bank_mask:0xf
    v_mul_f32_dpp v198, v243, v74 row_newbcast:12 row_mask:0xf bank_mask:0xf
    v_mul_f32_dpp v199, v243, v75 row_newbcast:13 row_mask:0xf bank_mask:0xf
    v_mul_f32_dpp v200, v243, v78 row_newbcast:6 row_mask:0xf bank_mask:0xf
    v_mul_f32_dpp v201, v243, v79 row_newbcast:7 row_mask:0xf bank_mask:0xf
    v_mul_f32_dpp v202, v243, v78 row_newbcast:14 row_mask:0xf bank_mask:0xf
    v_mul_f32_dpp v203, v243, v79 row_newbcast:15 row_mask:0xf bank_mask:0xf
    v_cvt_pk_bf16_f32 v74, v196, v197
    v_cvt_pk_bf16_f32 v78, v198, v199
    v_cvt_pk_bf16_f32 v75, v200, v201
    v_cvt_pk_bf16_f32 v79, v202, v203
    s_nop 0
    s_waitcnt lgkmcnt(0)
    v_mfma_f32_32x32x16_bf16 v[0:15], v[72:75], v[176:179], v[0:15]
    s_add_u32 m0, s21, 2048
    v_mfma_f32_32x32x16_bf16 v[16:31], v[76:79], v[176:179], v[16:31]
    buffer_load_dwordx4 v236, s[4:7], s36 offen lds
    buffer_load_dwordx4 v237, s[8:11], s36 offen offset:1024 lds
    s_mov_b32 m0, s50
    s_nop 0
    s_movrels_b32 s71, s23
    s_bfe_u32 s46, s71, 0x30012
    s_mov_b32 m0, s46
    s_and_b32 s66, s71, 0x3ffff
    s_movrels_b32 s68, s57
    s_movrels_b32 s69, s61
    s_sub_u32 s48, s66, s47
    s_mov_b32 s47, s66
    s_lshr_b32 s52, s71, 28
    s_lshl_b32 s67, s46, 9
    s_add_u32 s66, s66, s67
    s_sub_u32 s49, s66, s42
    s_mov_b32 s42, s66
    s_bfe_u32 s66, s68, 655360
    s_add_u32 s43, s42, s66
    s_bfe_u32 s39, s69, 655360
    s_bfe_u32 s66, s68, 655370
    s_add_u32 s44, s42, s66
    s_bfe_u32 s40, s69, 655370
    s_bfe_u32 s66, s68, 655380
    s_add_u32 s45, s42, s66
    s_bfe_u32 s41, s69, 655380
    s_and_b32 s66, s46, s33
    s_cselect_b32 s72, -1, 1
    s_cselect_b32 s76, s47, 163712
    s_cmp_ge_u32 s66, 2
    s_cselect_b32 s73, -1, 0
    s_add_u32 s77, s47, 1024
    s_cmp_ge_u32 s66, 4
    s_cselect_b32 s75, -1, 0
    s_cmp_ge_u32 s66, 3
    s_cselect_b32 s74, -1, 1
    s_cselect_b32 s77, s77, 163712
    v_add_u32 v252, s44, v247
    ds_read_u16 v238, v252
    ds_read_u16 v239, v252 offset:64
    v_add_u32 v252, s45, v247
    ds_read_u16 v240, v252
    ds_read_u16 v241, v252 offset:64
    v_mfma_f32_32x32x16_bf16 v[32:47], v[64:67], v[180:183], 0
    v_mul_f32 v196, v0, v96
    v_fmac_f32 v196, v1, v97
    v_fmac_f32 v196, v2, v98
    v_fmac_f32 v196, v3, v99
    v_fmac_f32 v196, v4, v100
    v_fmac_f32 v196, v5, v101
    v_fmac_f32 v196, v6, v102
    v_fmac_f32 v196, v7, v103
    v_mul_f32 v198, v8, v128
    v_fmac_f32 v198, v9, v129
    v_mfma_f32_32x32x16_bf16 v[48:63], v[68:71], v[180:183], 0
    v_add_u32 v253, s47, v248
    ds_read_b32 v254, v253
    ds_read_b32 v255, v253 offset:256
    s_waitcnt vmcnt(6)
    ds_read_b64_tr_b16 v[176:177], v244 offset:4096
    ds_read_b64_tr_b16 v[178:179], v244 offset:5120
    ds_read_b64_tr_b16 v[180:181], v245 offset:4096
    ds_read_b64_tr_b16 v[182:183], v245 offset:5120
    v_fmac_f32 v198, v10, v130
    v_fmac_f32 v198, v11, v131
    v_fmac_f32 v198, v12, v132
    v_fmac_f32 v198, v13, v133
    v_fmac_f32 v198, v14, v134
    v_fmac_f32 v198, v15, v135
    v_mul_f32 v200, v16, v128
    v_fmac_f32 v200, v17, v129
    v_permlane32_swap_b32 v196, v198
    v_mfma_f32_32x32x16_bf16 v[32:47], v[72:75], v[184:187], v[32:47]
    v_fmac_f32 v200, v18, v130
    v_fmac_f32 v200, v19, v131
    v_fmac_f32 v200, v20, v132
    v_fmac_f32 v200, v21, v133
    v_fmac_f32 v200, v22, v134
    v_fmac_f32 v200, v23, v135
    v_add_f32 v198, v196, v198
    v_mul_f32_e64 v202, v24, -v128
    v_fma_f32 v202, v25, -v129, v202
    v_mfma_f32_32x32x16_bf16 v[48:63], v[76:79], v[184:187], v[48:63]
    v_fma_f32 v202, v26, -v130, v202
    v_fma_f32 v202, v27, -v131, v202
    v_fma_f32 v202, v28, -v132, v202
    v_fma_f32 v202, v29, -v133, v202
    v_fma_f32 v202, v30, -v134, v202
    v_fma_f32 v202, v31, -v135, v202
    s_nop 1
    v_permlane32_swap_b32 v200, v202
    v_add_f32 v202, v200, v202
    s_waitcnt vmcnt(4) lgkmcnt(0)
    v_mfma_f32_32x32x16_bf16 v[0:15], v[64:67], v[176:179], 0
    v_mul_f32 v197, v32, v104
    v_fmac_f32 v197, v33, v105
    v_fmac_f32 v197, v34, v106
    v_fmac_f32 v197, v35, v107
    v_fmac_f32 v197, v36, v108
    v_fmac_f32 v197, v37, v109
    v_fmac_f32 v197, v38, v110
    v_fmac_f32 v197, v39, v111
    v_mul_f32 v199, v40, v136
    v_fmac_f32 v199, v41, v137
    v_fmac_f32 v199, v42, v138
    s_add_u32 m0, s21, 4096
    v_mfma_f32_32x32x16_bf16 v[16:31], v[68:71], v[176:179], 0
    buffer_load_dwordx4 v234, s[4:7], s37 offen lds
    buffer_load_dwordx4 v235, s[8:11], s37 offen offset:1024 lds
    ds_read_b64_tr_b16 v[176:177], v244 offset:6144
    ds_read_b64_tr_b16 v[178:179], v244 offset:7168
    ds_read_b64_tr_b16 v[184:185], v245 offset:6144
    ds_read_b64_tr_b16 v[186:187], v245 offset:7168
    v_add_u32 v252, s42, v247
    ds_read_u16 v234, v252
    ds_read_u16 v235, v252 offset:64
    s_mov_b32 m0, s76
    s_mov_b64 exec, s[72:73]
    buffer_load_dwordx4 v254, s[12:15], 0 offen  lds
    s_mov_b32 m0, s77
    s_mov_b64 exec, s[74:75]
    buffer_load_dwordx4 v255, s[12:15], 0 offen  lds
    s_mov_b64 exec, -1
    v_fmac_f32 v199, v43, v139
    v_fmac_f32 v199, v44, v140
    v_fmac_f32 v199, v45, v141
    v_fmac_f32 v199, v46, v142
    v_fmac_f32 v199, v47, v143
    v_mul_f32 v201, v48, v136
    v_fmac_f32 v201, v49, v137
    v_permlane32_swap_b32 v197, v199
    v_fmac_f32 v201, v50, v138
    v_fmac_f32 v201, v51, v139
    s_waitcnt lgkmcnt(2)
    v_mfma_f32_32x32x16_bf16 v[0:15], v[72:75], v[176:179], v[0:15]
    v_fmac_f32 v201, v52, v140
    v_fmac_f32 v201, v53, v141
    v_fmac_f32 v201, v54, v142
    v_fmac_f32 v201, v55, v143
    v_add_f32 v199, v197, v199
    v_mul_f32_e64 v203, v56, -v136
    v_fma_f32 v203, v57, -v137, v203
    v_fma_f32 v203, v58, -v138, v203
    v_fma_f32 v203, v59, -v139, v203
    v_fma_f32 v203, v60, -v140, v203
    v_fma_f32 v203, v61, -v141, v203
    s_add_u32 m0, s21, 6144
    v_mfma_f32_32x32x16_bf16 v[16:31], v[76:79], v[176:179], v[16:31]
    buffer_load_dwordx4 v236, s[4:7], s37 offen lds
    buffer_load_dwordx4 v237, s[8:11], s37 offen offset:1024 lds
    v_add_u32 v252, s43, v247
    ds_read_u16 v236, v252
    ds_read_u16 v237, v252 offset:64
    v_fma_f32 v203, v62, -v142, v203
    v_fma_f32 v203, v63, -v143, v203
    s_nop 1
    v_permlane32_swap_b32 v201, v203
    v_add_f32 v203, v201, v203
    s_set_gpr_idx_on s51, gpr_idx(DST)
    s_nop 0
    v_cvt_pk_bf16_f32 v204, v198, v199
    v_cvt_pk_bf16_f32 v205, v202, v203
    s_set_gpr_idx_off
    v_mfma_f32_32x32x16_bf16 v[32:47], v[64:67], v[180:183], 0
    v_mul_f32 v196, v0, v144
    v_fmac_f32 v196, v1, v145
    v_fmac_f32 v196, v2, v146
    v_fmac_f32 v196, v3, v147
    v_fmac_f32 v196, v4, v148
    v_fmac_f32 v196, v5, v149
    v_fmac_f32 v196, v6, v150
    v_fmac_f32 v196, v7, v151
    v_mfma_f32_32x32x16_bf16 v[48:63], v[68:71], v[180:183], 0
    s_waitcnt vmcnt(8)
    ds_read_b64_tr_b16 v[176:177], v244 offset:0
    ds_read_b64_tr_b16 v[178:179], v244 offset:1024
    ds_read_b64_tr_b16 v[180:181], v245 offset:0
    ds_read_b64_tr_b16 v[182:183], v245 offset:1024
    v_mul_f32 v198, v8, v112
    v_fmac_f32 v198, v9, v113
    v_fmac_f32 v198, v10, v114
    v_fmac_f32 v198, v11, v115
    v_fmac_f32 v198, v12, v116
    v_fmac_f32 v198, v13, v117
    v_fmac_f32 v198, v14, v118
    v_fmac_f32 v198, v15, v119
    v_mfma_f32_32x32x16_bf16 v[32:47], v[72:75], v[184:187], v[32:47]
    v_mul_f32_e64 v200, v16, -v160
    v_fma_f32 v200, v17, -v161, v200
    v_fma_f32 v200, v18, -v162, v200
    v_fma_f32 v200, v19, -v163, v200
    v_fma_f32 v200, v20, -v164, v200
    v_fma_f32 v200, v21, -v165, v200
    v_fma_f32 v200, v22, -v166, v200
    v_fma_f32 v200, v23, -v167, v200
    v_mfma_f32_32x32x16_bf16 v[48:63], v[76:79], v[184:187], v[48:63]
    v_mul_f32_e64 v202, v24, -v160
    v_fma_f32 v202, v25, -v161, v202
    v_fma_f32 v202, v26, -v162, v202
    v_fma_f32 v202, v27, -v163, v202
    v_fma_f32 v202, v28, -v164, v202
    v_fma_f32 v202, v29, -v165, v202
    v_fma_f32 v202, v30, -v166, v202
    v_fma_f32 v202, v31, -v167, v202
    s_waitcnt vmcnt(6) lgkmcnt(0)
    v_mfma_f32_32x32x16_bf16 v[0:15], v[64:67], v[176:179], 0
    v_mul_f32 v197, v32, v152
    v_fmac_f32 v197, v33, v153
    v_fmac_f32 v197, v34, v154
    v_fmac_f32 v197, v35, v155
    v_fmac_f32 v197, v36, v156
    v_fmac_f32 v197, v37, v157
    v_fmac_f32 v197, v38, v158
    v_fmac_f32 v197, v39, v159
    s_add_u32 m0, s21, 0
    v_mfma_f32_32x32x16_bf16 v[16:31], v[68:71], v[176:179], 0
    v_lshl_add_u32 v234, v234, 10, v246
    v_lshl_add_u32 v235, v235, 10, v246
    buffer_load_dwordx4 v234, s[4:7], s38 offen lds
    buffer_load_dwordx4 v235, s[8:11], s38 offen offset:1024 lds
    ds_read_b64_tr_b16 v[176:177], v244 offset:2048
    ds_read_b64_tr_b16 v[178:179], v244 offset:3072
    ds_read_b64_tr_b16 v[184:185], v245 offset:2048
    ds_read_b64_tr_b16 v[186:187], v245 offset:3072
    v_mul_f32 v199, v40, v120
    v_fmac_f32 v199, v41, v121
    v_fmac_f32 v199, v42, v122
    v_fmac_f32 v199, v43, v123
    v_fmac_f32 v199, v44, v124
    v_fmac_f32 v199, v45, v125
    v_fmac_f32 v199, v46, v126
    v_fmac_f32 v199, v47, v127
    s_waitcnt lgkmcnt(0)
    v_mfma_f32_32x32x16_bf16 v[0:15], v[72:75], v[176:179], v[0:15]
    v_mul_f32_e64 v201, v48, -v168
    v_fma_f32 v201, v49, -v169, v201
    v_fma_f32 v201, v50, -v170, v201
    v_fma_f32 v201, v51, -v171, v201
    v_fma_f32 v201, v52, -v172, v201
    v_fma_f32 v201, v53, -v173, v201
    v_fma_f32 v201, v54, -v174, v201
    v_fma_f32 v201, v55, -v175, v201
    s_add_u32 m0, s21, 2048
    v_mfma_f32_32x32x16_bf16 v[16:31], v[76:79], v[176:179], v[16:31]
    v_lshl_add_u32 v236, v236, 10, v246
    v_lshl_add_u32 v237, v237, 10, v246
    buffer_load_dwordx4 v236, s[4:7], s39 offen lds
    buffer_load_dwordx4 v237, s[8:11], s39 offen offset:1024 lds
    v_mul_f32_e64 v203, v56, -v168
    v_fma_f32 v203, v57, -v169, v203
    v_fma_f32 v203, v58, -v170, v203
    v_fma_f32 v203, v59, -v171, v203
    v_fma_f32 v203, v60, -v172, v203
    v_fma_f32 v203, v61, -v173, v203
    v_fma_f32 v203, v62, -v174, v203
    v_fma_f32 v203, v63, -v175, v203
    v_mfma_f32_32x32x16_bf16 v[32:47], v[64:67], v[180:183], 0
    v_mul_f32 v254, v0, v144
    v_fmac_f32 v254, v1, v145
    v_fmac_f32 v254, v2, v146
    v_fmac_f32 v254, v3, v147
    v_fmac_f32 v254, v4, v148
    v_mfma_f32_32x32x16_bf16 v[48:63], v[68:71], v[180:183], 0
    ds_swizzle_b32 v68, v68 offset:0x401F
    ds_swizzle_b32 v69, v69 offset:0x401F
    ds_swizzle_b32 v70, v70 offset:0x401F
    ds_swizzle_b32 v71, v71 offset:0x401F
    s_waitcnt vmcnt(8)
    ds_read_b64_tr_b16 v[176:177], v244 offset:4096
    ds_read_b64_tr_b16 v[178:179], v244 offset:5120
    ds_read_b64_tr_b16 v[180:181], v245 offset:4096
    ds_read_b64_tr_b16 v[182:183], v245 offset:5120
    v_fmac_f32 v254, v5, v149
    v_fmac_f32 v254, v6, v150
    v_fmac_f32 v254, v7, v151
    v_fmac_f32 v200, v8, v160
    v_mfma_f32_32x32x16_bf16 v[32:47], v[72:75], v[184:187], v[32:47]
    v_fmac_f32 v200, v9, v161
    v_permlane32_swap_b32 v196, v254
    v_fmac_f32 v200, v10, v162
    v_fmac_f32 v200, v11, v163
    v_fmac_f32 v200, v12, v164
    v_mfma_f32_32x32x16_bf16 v[48:63], v[76:79], v[184:187], v[48:63]
    ds_swizzle_b32 v76, v76 offset:0x401F
    ds_swizzle_b32 v77, v77 offset:0x401F
    ds_swizzle_b32 v78, v78 offset:0x401F
    ds_swizzle_b32 v79, v79 offset:0x401F
    v_fmac_f32 v200, v13, v165
    v_fmac_f32 v200, v14, v166
    v_fmac_f32 v200, v15, v167
    v_add_f32 v254, v196, v254
    s_waitcnt lgkmcnt(8)
    s_mov_b64 exec, s[56:57]
    v_xor_b32 v68, 0x80008000, v68
    v_xor_b32 v69, 0x80008000, v69
    v_xor_b32 v70, 0x80008000, v70
    v_xor_b32 v71, 0x80008000, v71
    s_mov_b64 exec, -1
    s_waitcnt vmcnt(4) lgkmcnt(4)
    v_mfma_f32_32x32x16_bf16 v[0:15], v[64:67], v[176:179], 0
    v_mul_f32 v255, v32, v152
    v_fmac_f32 v255, v33, v153
    v_fmac_f32 v255, v34, v154
    v_fmac_f32 v255, v35, v155
    v_fmac_f32 v255, v36, v156
    v_fmac_f32 v255, v37, v157
    s_add_u32 m0, s21, 4096
    v_mfma_f32_32x32x16_bf16 v[16:31], v[68:71], v[176:179], v[16:31]
    v_lshl_add_u32 v238, v238, 10, v246
    v_lshl_add_u32 v239, v239, 10, v246
    buffer_load_dwordx4 v238, s[4:7], s40 offen lds
    buffer_load_dwordx4 v239, s[8:11], s40 offen offset:1024 lds
    ds_read_b64_tr_b16 v[176:177], v244 offset:6144
    ds_read_b64_tr_b16 v[178:179], v244 offset:7168
    ds_read_b64_tr_b16 v[184:185], v245 offset:6144
    ds_read_b64_tr_b16 v[186:187], v245 offset:7168
    v_fmac_f32 v255, v38, v158
    v_fmac_f32 v255, v39, v159
    v_fmac_f32 v201, v40, v168
    v_fmac_f32 v201, v41, v169
    v_permlane32_swap_b32 v197, v255
    s_waitcnt lgkmcnt(0)
    s_mov_b64 exec, s[56:57]
    v_xor_b32 v76, 0x80008000, v76
    v_xor_b32 v77, 0x80008000, v77
    v_xor_b32 v78, 0x80008000, v78
    v_xor_b32 v79, 0x80008000, v79
    s_mov_b64 exec, -1
    v_mfma_f32_32x32x16_bf16 v[0:15], v[72:75], v[176:179], v[0:15]
    v_fmac_f32 v201, v42, v170
    v_fmac_f32 v201, v43, v171
    v_fmac_f32 v201, v44, v172
    v_fmac_f32 v201, v45, v173
    v_fmac_f32 v201, v46, v174
    v_fmac_f32 v201, v47, v175
    s_add_u32 m0, s21, 6144
    v_mfma_f32_32x32x16_bf16 v[16:31], v[76:79], v[176:179], v[16:31]
    v_lshl_add_u32 v240, v240, 10, v246
    v_lshl_add_u32 v241, v241, 10, v246
    buffer_load_dwordx4 v240, s[4:7], s41 offen lds
    buffer_load_dwordx4 v241, s[8:11], s41 offen offset:1024 lds
    v_add_f32 v255, v197, v255
    s_set_gpr_idx_on s51, gpr_idx(DST)
    s_nop 0
    v_cvt_pk_bf16_f32 v206, v254, v255
    s_set_gpr_idx_off
    v_mfma_f32_32x32x16_bf16 v[32:47], v[64:67], v[180:183], 0
    v_mul_f32 v254, v0, v144
    v_fmac_f32 v254, v1, v145
    v_fmac_f32 v254, v2, v146
    v_fmac_f32 v254, v3, v147
    v_fmac_f32 v254, v4, v148
    v_fmac_f32 v254, v5, v149
    v_fmac_f32 v254, v6, v150
    v_fmac_f32 v254, v7, v151
    v_fma_f32 v202, v8, -v160, v202
    v_fma_f32 v202, v9, -v161, v202
    v_mfma_f32_32x32x16_bf16 v[48:63], v[68:71], v[180:183], v[48:63]
    s_waitcnt vmcnt(6)
    ds_read_b64_tr_b16 v[176:177], v244 offset:0
    ds_read_b64_tr_b16 v[178:179], v244 offset:1024
    ds_read_b64_tr_b16 v[180:181], v245 offset:0
    ds_read_b64_tr_b16 v[182:183], v245 offset:1024
    v_permlane32_swap_b32 v254, v200
    v_fma_f32 v202, v10, -v162, v202
    v_fma_f32 v202, v11, -v163, v202
    v_fma_f32 v202, v12, -v164, v202
    v_fma_f32 v202, v13, -v165, v202
    v_fma_f32 v202, v14, -v166, v202
    v_fma_f32 v202, v15, -v167, v202
    v_add_f32 v200, v254, v200
    v_fmac_f32 v198, v16, v112
    v_permlane32_swap_b32 v202, v254
    v_mfma_f32_32x32x16_bf16 v[32:47], v[72:75], v[184:187], v[32:47]
    v_fmac_f32 v198, v17, v113
    v_fmac_f32 v198, v18, v114
    v_fmac_f32 v198, v19, v115
    v_fmac_f32 v198, v20, v116
    v_fmac_f32 v198, v21, v117
    v_fmac_f32 v198, v22, v118
    v_fmac_f32 v198, v23, v119
    v_add_f32 v254, v202, v254
    v_mul_f32 v196, v24, v160
    v_fmac_f32 v196, v25, v161
    v_mfma_f32_32x32x16_bf16 v[48:63], v[76:79], v[184:187], v[48:63]
    v_add_u32 v249, s48, v249
    v_add_u32 v250, s49, v250
    ds_read_b32 v252, v251 offset:16
    ds_read_b64_tr_b16 v[64:65], v249 offset:0
    ds_read_b64_tr_b16 v[68:69], v249 offset:64
    ds_read_b64_tr_b16 v[66:67], v249 offset:256
    ds_read_b64_tr_b16 v[70:71], v249 offset:320
    s_mov_b64 exec, s[54:55]
    ds_read_u16_d16_hi v242, v250 offset:0
    s_mov_b64 exec, -1
    v_fmac_f32 v196, v26, v162
    v_fmac_f32 v196, v27, v163
    v_fmac_f32 v196, v28, v164
    v_fmac_f32 v196, v29, v165
    v_fmac_f32 v196, v30, v166
    v_fmac_f32 v196, v31, v167
    s_nop 1
    v_permlane32_swap_b32 v198, v196
    v_add_f32 v196, v198, v196
    v_mul_f32 v255, v32, v152
    v_fmac_f32 v255, v33, v153
    v_fmac_f32 v255, v34, v154
    v_fmac_f32 v255, v35, v155
    v_fmac_f32 v255, v36, v156
    v_fmac_f32 v255, v37, v157
    v_fmac_f32 v255, v38, v158
    v_fmac_f32 v255, v39, v159
    v_fma_f32 v203, v40, -v168, v203
    v_fma_f32 v203, v41, -v169, v203
    v_permlane32_swap_b32 v255, v201
    v_fma_f32 v203, v42, -v170, v203
    v_fma_f32 v203, v43, -v171, v203
    v_fma_f32 v203, v44, -v172, v203
    v_fma_f32 v203, v45, -v173, v203
    v_fma_f32 v203, v46, -v174, v203
    v_fma_f32 v203, v47, -v175, v203
    v_add_f32 v201, v255, v201
    v_fmac_f32 v199, v48, v120
    v_permlane32_swap_b32 v203, v255
    v_fmac_f32 v199, v49, v121
    v_fmac_f32 v199, v50, v122
    v_fmac_f32 v199, v51, v123
    v_fmac_f32 v199, v52, v124
    v_fmac_f32 v199, v53, v125
    v_fmac_f32 v199, v54, v126
    v_fmac_f32 v199, v55, v127
    v_add_f32 v255, v203, v255
    v_mul_f32 v197, v56, v168
    v_fmac_f32 v197, v57, v169
    v_fmac_f32 v197, v58, v170
    v_fmac_f32 v197, v59, v171
    v_fmac_f32 v197, v60, v172
    v_fmac_f32 v197, v61, v173
    v_fmac_f32 v197, v62, v174
    v_fmac_f32 v197, v63, v175
    s_nop 1
    v_permlane32_swap_b32 v199, v197
    v_add_f32 v197, v199, v197
    s_set_gpr_idx_on s51, gpr_idx(DST)
    s_nop 0
    v_cvt_pk_bf16_f32 v207, v200, v201
    v_cvt_pk_bf16_f32 v209, v254, v255
    v_cvt_pk_bf16_f32 v208, v196, v197
    s_set_gpr_idx_off
    s_add_u32 s50, s50, 1
    s_add_u32 s51, s51, 6
    s_cmp_ge_u32 s50, 4
    s_cbranch_scc1 LAST0
    s_waitcnt lgkmcnt(5)
    v_readfirstlane_b32 s66, v252
    s_add_u32 s53, s53, 1
    v_mov_b32 v252, s53
    s_cmp_le_u32 s53, s66
    ds_write2_b32 v251, v252, v252 offset0:0 offset1:8
    s_setprio 1
    s_cbranch_scc1 PRIO_5
    s_setprio 0
PRIO_5:
    s_cmp_eq_u32 s52, 4
    s_cbranch_scc1 ITEM_0_4
    s_cmp_eq_u32 s52, 5
    s_cbranch_scc1 ITEM_0_5
    s_cmp_eq_u32 s52, 3
    s_cbranch_scc1 ITEM_0_3
    s_cmp_eq_u32 s52, 6
    s_cbranch_scc1 ITEM_0_6
    s_cmp_eq_u32 s52, 8
    s_cbranch_scc1 ITEM_0_8
    s_branch ITEM_0_2
.p2align 6
ITEM_0_5:
    s_mov_b64 exec, s[54:55]
    ds_read_u16_d16_hi v243, v250 offset:128
    s_mov_b64 exec, -1
    ds_read_b64_tr_b16 v[72:73], v249 offset:512
    ds_read_b64_tr_b16 v[76:77], v249 offset:576
    ds_read_b64_tr_b16 v[74:75], v249 offset:768
    ds_read_b64_tr_b16 v[78:79], v249 offset:832
    ds_read_b64_tr_b16 v[80:81], v249 offset:1024
    ds_read_b64_tr_b16 v[84:85], v249 offset:1088
    s_waitcnt lgkmcnt(7)
    v_mul_f32_dpp v196, v242, v64 row_newbcast:0 row_mask:0xf bank_mask:0xf
    v_mul_f32_dpp v197, v242, v65 row_newbcast:1 row_mask:0xf bank_mask:0xf
    v_mul_f32_dpp v198, v242, v64 row_newbcast:8 row_mask:0xf bank_mask:0xf
    v_mul_f32_dpp v199, v242, v65 row_newbcast:9 row_mask:0xf bank_mask:0xf
    v_mul_f32_dpp v200, v242, v68 row_newbcast:2 row_mask:0xf bank_mask:0xf
    v_mul_f32_dpp v201, v242, v69 row_newbcast:3 row_mask:0xf bank_mask:0xf
    v_mul_f32_dpp v202, v242, v68 row_newbcast:10 row_mask:0xf bank_mask:0xf
    v_mul_f32_dpp v203, v242, v69 row_newbcast:11 row_mask:0xf bank_mask:0xf
    v_cvt_pk_bf16_f32 v64, v196, v197
    v_cvt_pk_bf16_f32 v68, v198, v199
    v_cvt_pk_bf16_f32 v65, v200, v201
    v_cvt_pk_bf16_f32 v69, v202, v203
    v_mul_f32_dpp v196, v242, v66 row_newbcast:4 row_mask:0xf bank_mask:0xf
    v_mul_f32_dpp v197, v242, v67 row_newbcast:5 row_mask:0xf bank_mask:0xf
    v_mul_f32_dpp v198, v242, v66 row_newbcast:12 row_mask:0xf bank_mask:0xf
    v_mul_f32_dpp v199, v242, v67 row_newbcast:13 row_mask:0xf bank_mask:0xf
    v_mul_f32_dpp v200, v242, v70 row_newbcast:6 row_mask:0xf bank_mask:0xf
    v_mul_f32_dpp v201, v242, v71 row_newbcast:7 row_mask:0xf bank_mask:0xf
    v_mul_f32_dpp v202, v242, v70 row_newbcast:14 row_mask:0xf bank_mask:0xf
    v_mul_f32_dpp v203, v242, v71 row_newbcast:15 row_mask:0xf bank_mask:0xf
    v_cvt_pk_bf16_f32 v66, v196, v197
    v_cvt_pk_bf16_f32 v70, v198, v199
    v_cvt_pk_bf16_f32 v67, v200, v201
    v_cvt_pk_bf16_f32 v71, v202, v203
    s_mov_b64 exec, s[54:55]
    ds_read_u16_d16_hi v242, v250 offset:256
    s_mov_b64 exec, -1
    s_waitcnt vmcnt(4) lgkmcnt(3)
    v_mfma_f32_32x32x16_bf16 v[0:15], v[64:67], v[176:179], 0
    v_mul_f32_dpp v196, v243, v72 row_newbcast:0 row_mask:0xf bank_mask:0xf
    v_mul_f32_dpp v197, v243, v73 row_newbcast:1 row_mask:0xf bank_mask:0xf
    v_mul_f32_dpp v198, v243, v72 row_newbcast:8 row_mask:0xf bank_mask:0xf
    v_mul_f32_dpp v199, v243, v73 row_newbcast:9 row_mask:0xf bank_mask:0xf
    v_mul_f32_dpp v200, v243, v76 row_newbcast:2 row_mask:0xf bank_mask:0xf
    v_mul_f32_dpp v201, v243, v77 row_newbcast:3 row_mask:0xf bank_mask:0xf
    v_mul_f32_dpp v202, v243, v76 row_newbcast:10 row_mask:0xf bank_mask:0xf
    v_mul_f32_dpp v203, v243, v77 row_newbcast:11 row_mask:0xf bank_mask:0xf
    v_cvt_pk_bf16_f32 v72, v196, v197
    v_cvt_pk_bf16_f32 v76, v198, v199
    v_cvt_pk_bf16_f32 v73, v200, v201
    v_cvt_pk_bf16_f32 v77, v202, v203
    s_add_u32 m0, s21, 0
    v_mfma_f32_32x32x16_bf16 v[16:31], v[68:71], v[176:179], 0
    buffer_load_dwordx4 v236, s[4:7], s35 offen lds
    buffer_load_dwordx4 v237, s[8:11], s35 offen offset:1024 lds
    ds_read_b64_tr_b16 v[176:177], v244 offset:2048
    ds_read_b64_tr_b16 v[178:179], v244 offset:3072
    ds_read_b64_tr_b16 v[184:185], v245 offset:2048
    ds_read_b64_tr_b16 v[186:187], v245 offset:3072
    v_mul_f32_dpp v196, v243, v74 row_newbcast:4 row_mask:0xf bank_mask:0xf
    v_mul_f32_dpp v197, v243, v75 row_newbcast:5 row_mask:0xf bank_mask:0xf
    v_mul_f32_dpp v198, v243, v74 row_newbcast:12 row_mask:0xf bank_mask:0xf
    v_mul_f32_dpp v199, v243, v75 row_newbcast:13 row_mask:0xf bank_mask:0xf
    v_mul_f32_dpp v200, v243, v78 row_newbcast:6 row_mask:0xf bank_mask:0xf
    v_mul_f32_dpp v201, v243, v79 row_newbcast:7 row_mask:0xf bank_mask:0xf
    v_mul_f32_dpp v202, v243, v78 row_newbcast:14 row_mask:0xf bank_mask:0xf
    v_mul_f32_dpp v203, v243, v79 row_newbcast:15 row_mask:0xf bank_mask:0xf
    v_cvt_pk_bf16_f32 v74, v196, v197
    v_cvt_pk_bf16_f32 v78, v198, v199
    v_cvt_pk_bf16_f32 v75, v200, v201
    v_cvt_pk_bf16_f32 v79, v202, v203
    s_nop 0
    s_waitcnt vmcnt(4) lgkmcnt(0)
    v_mfma_f32_32x32x16_bf16 v[0:15], v[72:75], v[176:179], v[0:15]
    v_mul_f32_dpp v196, v242, v80 row_newbcast:0 row_mask:0xf bank_mask:0xf
    v_mul_f32_dpp v197, v242, v81 row_newbcast:1 row_mask:0xf bank_mask:0xf
    v_mul_f32_dpp v198, v242, v80 row_newbcast:8 row_mask:0xf bank_mask:0xf
    v_mul_f32_dpp v199, v242, v81 row_newbcast:9 row_mask:0xf bank_mask:0xf
    v_mul_f32_dpp v200, v242, v84 row_newbcast:2 row_mask:0xf bank_mask:0xf
    v_mul_f32_dpp v201, v242, v85 row_newbcast:3 row_mask:0xf bank_mask:0xf
    s_add_u32 m0, s21, 2048
    v_mfma_f32_32x32x16_bf16 v[16:31], v[76:79], v[176:179], v[16:31]
    buffer_load_dwordx4 v238, s[4:7], s35 offen lds
    ds_read_b64_tr_b16 v[176:177], v244 offset:4096
    ds_read_b64_tr_b16 v[188:189], v245 offset:4096
    v_mul_f32_dpp v202, v242, v84 row_newbcast:10 row_mask:0xf bank_mask:0xf
    v_mul_f32_dpp v203, v242, v85 row_newbcast:11 row_mask:0xf bank_mask:0xf
    v_cvt_pk_bf16_f32 v80, v196, v197
    v_cvt_pk_bf16_f32 v84, v198, v199
    v_cvt_pk_bf16_f32 v81, v200, v201
    v_cvt_pk_bf16_f32 v85, v202, v203
    s_nop 0
    s_waitcnt lgkmcnt(0)
    v_mfma_f32_32x32x8_bf16 v[0:15], v[80:81], v[176:177], v[0:15]
    s_add_u32 m0, s21, 4096
    v_mfma_f32_32x32x8_bf16 v[16:31], v[84:85], v[176:177], v[16:31]
    buffer_load_dwordx4 v234, s[4:7], s36 offen lds
    buffer_load_dwordx4 v235, s[8:11], s36 offen offset:1024 lds
    s_mov_b32 m0, s50
    s_nop 0
    s_movrels_b32 s71, s23
    s_bfe_u32 s46, s71, 0x30012
    s_mov_b32 m0, s46
    s_and_b32 s66, s71, 0x3ffff
    s_movrels_b32 s68, s57
    s_movrels_b32 s69, s61
    s_sub_u32 s48, s66, s47
    s_mov_b32 s47, s66
    s_lshr_b32 s52, s71, 28
    s_lshl_b32 s67, s46, 9
    s_add_u32 s66, s66, s67
    s_sub_u32 s49, s66, s42
    s_mov_b32 s42, s66
    s_bfe_u32 s66, s68, 655360
    s_add_u32 s43, s42, s66
    s_bfe_u32 s39, s69, 655360
    s_bfe_u32 s66, s68, 655370
    s_add_u32 s44, s42, s66
    s_bfe_u32 s40, s69, 655370
    s_bfe_u32 s66, s68, 655380
    s_add_u32 s45, s42, s66
    s_bfe_u32 s41, s69, 655380
    s_and_b32 s66, s46, s33
    s_cselect_b32 s72, -1, 1
    s_cselect_b32 s76, s47, 163712
    s_cmp_ge_u32 s66, 2
    s_cselect_b32 s73, -1, 0
    s_add_u32 s77, s47, 1024
    s_cmp_ge_u32 s66, 4
    s_cselect_b32 s75, -1, 0
    s_cmp_ge_u32 s66, 3
    s_cselect_b32 s74, -1, 1
    s_cselect_b32 s77, s77, 163712
    v_add_u32 v252, s45, v247
    ds_read_u16 v240, v252
    ds_read_u16 v241, v252 offset:64
    v_mfma_f32_32x32x16_bf16 v[32:47], v[64:67], v[180:183], 0
    v_mul_f32 v196, v0, v96
    v_fmac_f32 v196, v1, v97
    v_fmac_f32 v196, v2, v98
    v_fmac_f32 v196, v3, v99
    v_fmac_f32 v196, v4, v100
    v_fmac_f32 v196, v5, v101
    v_fmac_f32 v196, v6, v102
    v_mfma_f32_32x32x16_bf16 v[48:63], v[68:71], v[180:183], 0
    v_add_u32 v253, s47, v248
    ds_read_b32 v254, v253
    ds_read_b32 v255, v253 offset:256
    v_fmac_f32 v196, v7, v103
    v_mul_f32 v198, v8, v128
    v_fmac_f32 v198, v9, v129
    v_fmac_f32 v198, v10, v130
    v_fmac_f32 v198, v11, v131
    v_fmac_f32 v198, v12, v132
    v_mfma_f32_32x32x16_bf16 v[32:47], v[72:75], v[184:187], v[32:47]
    v_fmac_f32 v198, v13, v133
    v_fmac_f32 v198, v14, v134
    v_fmac_f32 v198, v15, v135
    v_mul_f32 v200, v16, v128
    v_fmac_f32 v200, v17, v129
    v_permlane32_swap_b32 v196, v198
    v_mfma_f32_32x32x16_bf16 v[48:63], v[76:79], v[184:187], v[48:63]
    s_waitcnt vmcnt(5)
    ds_read_b64_tr_b16 v[176:177], v244 offset:6144
    ds_read_b64_tr_b16 v[178:179], v244 offset:7168
    ds_read_b64_tr_b16 v[180:181], v245 offset:6144
    ds_read_b64_tr_b16 v[182:183], v245 offset:7168
    v_fmac_f32 v200, v18, v130
    v_fmac_f32 v200, v19, v131
    v_fmac_f32 v200, v20, v132
    v_fmac_f32 v200, v21, v133
    v_fmac_f32 v200, v22, v134
    v_fmac_f32 v200, v23, v135
    v_mfma_f32_32x32x8_bf16 v[32:47], v[80:81], v[188:189], v[32:47]
    v_add_f32 v198, v196, v198
    v_mul_f32_e64 v202, v24, -v128
    v_fma_f32 v202, v25, -v129, v202
    v_fma_f32 v202, v26, -v130, v202
    v_fma_f32 v202, v27, -v131, v202
    v_fma_f32 v202, v28, -v132, v202
    v_mfma_f32_32x32x8_bf16 v[48:63], v[84:85], v[188:189], v[48:63]
    v_fma_f32 v202, v29, -v133, v202
    v_fma_f32 v202, v30, -v134, v202
    v_fma_f32 v202, v31, -v135, v202
    s_nop 1
    v_permlane32_swap_b32 v200, v202
    v_add_f32 v202, v200, v202
    s_waitcnt vmcnt(3) lgkmcnt(0)
    v_mfma_f32_32x32x16_bf16 v[0:15], v[64:67], v[176:179], 0
    v_mul_f32 v197, v32, v104
    v_fmac_f32 v197, v33, v105
    v_fmac_f32 v197, v34, v106
    v_fmac_f32 v197, v35, v107
    v_fmac_f32 v197, v36, v108
    v_fmac_f32 v197, v37, v109
    v_fmac_f32 v197, v38, v110
    s_add_u32 m0, s21, 6144
    v_mfma_f32_32x32x16_bf16 v[16:31], v[68:71], v[176:179], 0
    buffer_load_dwordx4 v236, s[4:7], s36 offen lds
    buffer_load_dwordx4 v237, s[8:11], s36 offen offset:1024 lds
    ds_read_b64_tr_b16 v[176:177], v244 offset:0
    ds_read_b64_tr_b16 v[178:179], v244 offset:1024
    ds_read_b64_tr_b16 v[184:185], v245 offset:0
    ds_read_b64_tr_b16 v[186:187], v245 offset:1024
    s_mov_b32 m0, s76
    s_mov_b64 exec, s[72:73]
    buffer_load_dwordx4 v254, s[12:15], 0 offen  lds
    s_mov_b32 m0, s77
    s_mov_b64 exec, s[74:75]
    buffer_load_dwordx4 v255, s[12:15], 0 offen  lds
    s_mov_b64 exec, -1
    v_fmac_f32 v197, v39, v111
    v_mul_f32 v199, v40, v136
    v_fmac_f32 v199, v41, v137
    v_fmac_f32 v199, v42, v138
    v_fmac_f32 v199, v43, v139
    v_fmac_f32 v199, v44, v140
    v_fmac_f32 v199, v45, v141
    s_waitcnt vmcnt(6) lgkmcnt(0)
    v_mfma_f32_32x32x16_bf16 v[0:15], v[72:75], v[176:179], v[0:15]
    v_fmac_f32 v199, v46, v142
    v_fmac_f32 v199, v47, v143
    v_mul_f32 v201, v48, v136
    v_fmac_f32 v201, v49, v137
    v_permlane32_swap_b32 v197, v199
    v_fmac_f32 v201, v50, v138
    v_fmac_f32 v201, v51, v139
    s_add_u32 m0, s21, 0
    v_mfma_f32_32x32x16_bf16 v[16:31], v[76:79], v[176:179], v[16:31]
    buffer_load_dwordx4 v238, s[4:7], s36 offen lds
    ds_read_b64_tr_b16 v[176:177], v244 offset:2048
    ds_read_b64_tr_b16 v[188:189], v245 offset:2048
    v_fmac_f32 v201, v52, v140
    v_fmac_f32 v201, v53, v141
    v_fmac_f32 v201, v54, v142
    v_fmac_f32 v201, v55, v143
    v_add_f32 v199, v197, v199
    v_mul_f32_e64 v203, v56, -v136
    v_fma_f32 v203, v57, -v137, v203
    s_waitcnt lgkmcnt(0)
    v_mfma_f32_32x32x8_bf16 v[0:15], v[80:81], v[176:177], v[0:15]
    v_fma_f32 v203, v58, -v138, v203
    v_fma_f32 v203, v59, -v139, v203
    v_fma_f32 v203, v60, -v140, v203
    v_fma_f32 v203, v61, -v141, v203
    v_fma_f32 v203, v62, -v142, v203
    v_fma_f32 v203, v63, -v143, v203
    s_nop 1
    s_add_u32 m0, s21, 2048
    v_mfma_f32_32x32x8_bf16 v[16:31], v[84:85], v[176:177], v[16:31]
    buffer_load_dwordx4 v234, s[4:7], s37 offen lds
    buffer_load_dwordx4 v235, s[8:11], s37 offen offset:1024 lds
    v_add_u32 v252, s42, v247
    ds_read_u16 v234, v252
    ds_read_u16 v235, v252 offset:64
    v_permlane32_swap_b32 v201, v203
    v_add_f32 v203, v201, v203
    s_set_gpr_idx_on s51, gpr_idx(DST)
    s_nop 0
    v_cvt_pk_bf16_f32 v204, v198, v199
    v_cvt_pk_bf16_f32 v205, v202, v203
    s_set_gpr_idx_off
    v_mfma_f32_32x32x16_bf16 v[32:47], v[64:67], v[180:183], 0
    v_mul_f32 v196, v0, v144
    v_fmac_f32 v196, v1, v145
    v_fmac_f32 v196, v2, v146
    v_fmac_f32 v196, v3, v147
    v_fmac_f32 v196, v4, v148
    v_fmac_f32 v196, v5, v149
    v_mfma_f32_32x32x16_bf16 v[48:63], v[68:71], v[180:183], 0
    v_fmac_f32 v196, v6, v150
    v_fmac_f32 v196, v7, v151
    v_mul_f32 v198, v8, v112
    v_fmac_f32 v198, v9, v113
    v_fmac_f32 v198, v10, v114
    v_mfma_f32_32x32x16_bf16 v[32:47], v[72:75], v[184:187], v[32:47]
    v_fmac_f32 v198, v11, v115
    v_fmac_f32 v198, v12, v116
    v_fmac_f32 v198, v13, v117
    v_fmac_f32 v198, v14, v118
    v_fmac_f32 v198, v15, v119
    v_mfma_f32_32x32x16_bf16 v[48:63], v[76:79], v[184:187], v[48:63]
    s_waitcnt vmcnt(7)
    ds_read_b64_tr_b16 v[176:177], v244 offset:4096
    ds_read_b64_tr_b16 v[178:179], v244 offset:5120
    ds_read_b64_tr_b16 v[180:181], v245 offset:4096
    ds_read_b64_tr_b16 v[182:183], v245 offset:5120
    v_mul_f32_e64 v200, v16, -v160
    v_fma_f32 v200, v17, -v161, v200
    v_fma_f32 v200, v18, -v162, v200
    v_fma_f32 v200, v19, -v163, v200
    v_fma_f32 v200, v20, -v164, v200
    v_fma_f32 v200, v21, -v165, v200
    v_mfma_f32_32x32x8_bf16 v[32:47], v[80:81], v[188:189], v[32:47]
    v_fma_f32 v200, v22, -v166, v200
    v_fma_f32 v200, v23, -v167, v200
    v_mul_f32_e64 v202, v24, -v160
    v_fma_f32 v202, v25, -v161, v202
    v_fma_f32 v202, v26, -v162, v202
    v_mfma_f32_32x32x8_bf16 v[48:63], v[84:85], v[188:189], v[48:63]
    v_fma_f32 v202, v27, -v163, v202
    v_fma_f32 v202, v28, -v164, v202
    v_fma_f32 v202, v29, -v165, v202
    v_fma_f32 v202, v30, -v166, v202
    v_fma_f32 v202, v31, -v167, v202
    s_waitcnt vmcnt(5) lgkmcnt(0)
    v_mfma_f32_32x32x16_bf16 v[0:15], v[64:67], v[176:179], 0
    v_mul_f32 v197, v32, v152
    v_fmac_f32 v197, v33, v153
    v_fmac_f32 v197, v34, v154
    v_fmac_f32 v197, v35, v155
    v_fmac_f32 v197, v36, v156
    v_fmac_f32 v197, v37, v157
    s_add_u32 m0, s21, 4096
    v_mfma_f32_32x32x16_bf16 v[16:31], v[68:71], v[176:179], 0
    buffer_load_dwordx4 v236, s[4:7], s37 offen lds
    buffer_load_dwordx4 v237, s[8:11], s37 offen offset:1024 lds
    ds_read_b64_tr_b16 v[176:177], v244 offset:6144
    ds_read_b64_tr_b16 v[178:179], v244 offset:7168
    ds_read_b64_tr_b16 v[184:185], v245 offset:6144
    ds_read_b64_tr_b16 v[186:187], v245 offset:7168
    v_add_u32 v252, s43, v247
    ds_read_u16 v236, v252
    ds_read_u16 v237, v252 offset:64
    v_fmac_f32 v197, v38, v158
    v_fmac_f32 v197, v39, v159
    v_mul_f32 v199, v40, v120
    v_fmac_f32 v199, v41, v121
    v_fmac_f32 v199, v42, v122
    s_waitcnt vmcnt(4) lgkmcnt(2)
    v_mfma_f32_32x32x16_bf16 v[0:15], v[72:75], v[176:179], v[0:15]
    v_fmac_f32 v199, v43, v123
    v_fmac_f32 v199, v44, v124
    v_fmac_f32 v199, v45, v125
    v_fmac_f32 v199, v46, v126
    v_fmac_f32 v199, v47, v127
    s_add_u32 m0, s21, 6144
    v_mfma_f32_32x32x16_bf16 v[16:31], v[76:79], v[176:179], v[16:31]
    buffer_load_dwordx4 v238, s[4:7], s37 offen lds
    ds_read_b64_tr_b16 v[176:177], v244 offset:0
    ds_read_b64_tr_b16 v[188:189], v245 offset:0
    v_add_u32 v252, s44, v247
    ds_read_u16 v238, v252
    ds_read_u16 v239, v252 offset:64
    v_mul_f32_e64 v201, v48, -v168
    v_fma_f32 v201, v49, -v169, v201
    v_fma_f32 v201, v50, -v170, v201
    v_fma_f32 v201, v51, -v171, v201
    v_fma_f32 v201, v52, -v172, v201
    v_fma_f32 v201, v53, -v173, v201
    s_waitcnt lgkmcnt(2)
    v_mfma_f32_32x32x8_bf16 v[0:15], v[80:81], v[176:177], v[0:15]
    v_fma_f32 v201, v54, -v174, v201
    v_fma_f32 v201, v55, -v175, v201
    v_mul_f32_e64 v203, v56, -v168
    v_fma_f32 v203, v57, -v169, v203
    v_fma_f32 v203, v58, -v170, v203
    s_add_u32 m0, s21, 0
    v_mfma_f32_32x32x8_bf16 v[16:31], v[84:85], v[176:177], v[16:31]
    v_lshl_add_u32 v234, v234, 10, v246
    v_lshl_add_u32 v235, v235, 10, v246
    buffer_load_dwordx4 v234, s[4:7], s38 offen lds
    buffer_load_dwordx4 v235, s[8:11], s38 offen offset:1024 lds
    v_fma_f32 v203, v59, -v171, v203
    v_fma_f32 v203, v60, -v172, v203
    v_fma_f32 v203, v61, -v173, v203
    v_fma_f32 v203, v62, -v174, v203
    v_fma_f32 v203, v63, -v175, v203
    v_mfma_f32_32x32x16_bf16 v[32:47], v[64:67], v[180:183], 0
    v_mul_f32 v254, v0, v144
    v_fmac_f32 v254, v1, v145
    v_fmac_f32 v254, v2, v146
    v_mfma_f32_32x32x16_bf16 v[48:63], v[68:71], v[180:183], 0
    ds_swizzle_b32 v68, v68 offset:0x401F
    ds_swizzle_b32 v69, v69 offset:0x401F
    ds_swizzle_b32 v70, v70 offset:0x401F
    ds_swizzle_b32 v71, v71 offset:0x401F
    v_fmac_f32 v254, v3, v147
    v_fmac_f32 v254, v4, v148
    v_fmac_f32 v254, v5, v149
    v_mfma_f32_32x32x16_bf16 v[32:47], v[72:75], v[184:187], v[32:47]
    v_fmac_f32 v254, v6, v150
    v_fmac_f32 v254, v7, v151
    v_fmac_f32 v200, v8, v160
    v_mfma_f32_32x32x16_bf16 v[48:63], v[76:79], v[184:187], v[48:63]
    ds_swizzle_b32 v76, v76 offset:0x401F
    ds_swizzle_b32 v77, v77 offset:0x401F
    ds_swizzle_b32 v78, v78 offset:0x401F
    ds_swizzle_b32 v79, v79 offset:0x401F
    s_waitcnt vmcnt(5)
    ds_read_b64_tr_b16 v[176:177], v244 offset:2048
    ds_read_b64_tr_b16 v[178:179], v244 offset:3072
    ds_read_b64_tr_b16 v[180:181], v245 offset:2048
    ds_read_b64_tr_b16 v[182:183], v245 offset:3072
    v_fmac_f32 v200, v9, v161
    v_permlane32_swap_b32 v196, v254
    v_fmac_f32 v200, v10, v162
    v_mfma_f32_32x32x8_bf16 v[32:47], v[80:81], v[188:189], v[32:47]
    v_fmac_f32 v200, v11, v163
    v_fmac_f32 v200, v12, v164
    v_fmac_f32 v200, v13, v165
    v_mfma_f32_32x32x8_bf16 v[48:63], v[84:85], v[188:189], v[48:63]
    ds_swizzle_b32 v84, v84 offset:0x401F
    ds_swizzle_b32 v85, v85 offset:0x401F
    v_fmac_f32 v200, v14, v166
    v_fmac_f32 v200, v15, v167
    v_add_f32 v254, v196, v254
    s_waitcnt lgkmcnt(6)
    s_mov_b64 exec, s[56:57]
    v_xor_b32 v68, 0x80008000, v68
    v_xor_b32 v69, 0x80008000, v69
    v_xor_b32 v70, 0x80008000, v70
    v_xor_b32 v71, 0x80008000, v71
    v_xor_b32 v76, 0x80008000, v76
    v_xor_b32 v77, 0x80008000, v77
    v_xor_b32 v78, 0x80008000, v78
    v_xor_b32 v79, 0x80008000, v79
    s_mov_b64 exec, -1
    s_waitcnt vmcnt(3) lgkmcnt(2)
    v_mfma_f32_32x32x16_bf16 v[0:15], v[64:67], v[176:179], 0
    v_mul_f32 v255, v32, v152
    v_fmac_f32 v255, v33, v153
    v_fmac_f32 v255, v34, v154
    v_fmac_f32 v255, v35, v155
    s_add_u32 m0, s21, 2048
    v_mfma_f32_32x32x16_bf16 v[16:31], v[68:71], v[176:179], v[16:31]
    v_lshl_add_u32 v236, v236, 10, v246
    v_lshl_add_u32 v237, v237, 10, v246
    buffer_load_dwordx4 v236, s[4:7], s39 offen lds
    buffer_load_dwordx4 v237, s[8:11], s39 offen offset:1024 lds
    ds_read_b64_tr_b16 v[176:177], v244 offset:4096
    ds_read_b64_tr_b16 v[178:179], v244 offset:5120
    ds_read_b64_tr_b16 v[184:185], v245 offset:4096
    ds_read_b64_tr_b16 v[186:187], v245 offset:5120
    v_fmac_f32 v255, v36, v156
    v_fmac_f32 v255, v37, v157
    v_fmac_f32 v255, v38, v158
    v_fmac_f32 v255, v39, v159
    s_waitcnt vmcnt(4) lgkmcnt(0)
    v_mfma_f32_32x32x16_bf16 v[0:15], v[72:75], v[176:179], v[0:15]
    v_fmac_f32 v201, v40, v168
    v_fmac_f32 v201, v41, v169
    v_permlane32_swap_b32 v197, v255
    s_add_u32 m0, s21, 4096
    v_mfma_f32_32x32x16_bf16 v[16:31], v[76:79], v[176:179], v[16:31]
    v_lshl_add_u32 v238, v238, 10, v246
    v_lshl_add_u32 v239, v239, 10, v246
    buffer_load_dwordx4 v238, s[4:7], s40 offen lds
    buffer_load_dwordx4 v239, s[8:11], s40 offen offset:1024 lds
    ds_read_b64_tr_b16 v[176:177], v244 offset:6144
    ds_read_b64_tr_b16 v[188:189], v245 offset:6144
    v_fmac_f32 v201, v42, v170
    v_fmac_f32 v201, v43, v171
    v_fmac_f32 v201, v44, v172
    v_fmac_f32 v201, v45, v173
    s_waitcnt lgkmcnt(0)
    s_mov_b64 exec, s[56:57]
    v_xor_b32 v84, 0x80008000, v84
    v_xor_b32 v85, 0x80008000, v85
    s_mov_b64 exec, -1
    v_mfma_f32_32x32x8_bf16 v[0:15], v[80:81], v[176:177], v[0:15]
    v_fmac_f32 v201, v46, v174
    v_fmac_f32 v201, v47, v175
    v_add_f32 v255, v197, v255
    s_set_gpr_idx_on s51, gpr_idx(DST)
    s_nop 0
    v_cvt_pk_bf16_f32 v206, v254, v255
    s_set_gpr_idx_off
    s_add_u32 m0, s21, 6144
    v_mfma_f32_32x32x8_bf16 v[16:31], v[84:85], v[176:177], v[16:31]
    v_lshl_add_u32 v240, v240, 10, v246
    v_lshl_add_u32 v241, v241, 10, v246
    buffer_load_dwordx4 v240, s[4:7], s41 offen lds
    buffer_load_dwordx4 v241, s[8:11], s41 offen offset:1024 lds
    v_mfma_f32_32x32x16_bf16 v[32:47], v[64:67], v[180:183], 0
    v_mul_f32 v254, v0, v144
    v_fmac_f32 v254, v1, v145
    v_fmac_f32 v254, v2, v146
    v_fmac_f32 v254, v3, v147
    v_fmac_f32 v254, v4, v148
    v_fmac_f32 v254, v5, v149
    v_fmac_f32 v254, v6, v150
    v_mfma_f32_32x32x16_bf16 v[48:63], v[68:71], v[180:183], v[48:63]
    v_fmac_f32 v254, v7, v151
    v_fma_f32 v202, v8, -v160, v202
    v_fma_f32 v202, v9, -v161, v202
    v_permlane32_swap_b32 v254, v200
    v_fma_f32 v202, v10, -v162, v202
    v_fma_f32 v202, v11, -v163, v202
    v_mfma_f32_32x32x16_bf16 v[32:47], v[72:75], v[184:187], v[32:47]
    v_fma_f32 v202, v12, -v164, v202
    v_fma_f32 v202, v13, -v165, v202
    v_fma_f32 v202, v14, -v166, v202
    v_fma_f32 v202, v15, -v167, v202
    v_add_f32 v200, v254, v200
    v_fmac_f32 v198, v16, v112
    v_permlane32_swap_b32 v202, v254
    v_mfma_f32_32x32x16_bf16 v[48:63], v[76:79], v[184:187], v[48:63]
    s_waitcnt vmcnt(6)
    ds_read_b64_tr_b16 v[176:177], v244 offset:0
    ds_read_b64_tr_b16 v[178:179], v244 offset:1024
    ds_read_b64_tr_b16 v[180:181], v245 offset:0
    ds_read_b64_tr_b16 v[182:183], v245 offset:1024
    v_fmac_f32 v198, v17, v113
    v_fmac_f32 v198, v18, v114
    v_fmac_f32 v198, v19, v115
    v_fmac_f32 v198, v20, v116
    v_fmac_f32 v198, v21, v117
    v_fmac_f32 v198, v22, v118
    v_mfma_f32_32x32x8_bf16 v[32:47], v[80:81], v[188:189], v[32:47]
    v_fmac_f32 v198, v23, v119
    v_add_f32 v254, v202, v254
    v_mul_f32 v196, v24, v160
    v_fmac_f32 v196, v25, v161
    v_fmac_f32 v196, v26, v162
    v_fmac_f32 v196, v27, v163
    v_fmac_f32 v196, v28, v164
    v_mfma_f32_32x32x8_bf16 v[48:63], v[84:85], v[188:189], v[48:63]
    v_add_u32 v249, s48, v249
    v_add_u32 v250, s49, v250
    ds_read_b32 v252, v251 offset:16
    ds_read_b64_tr_b16 v[64:65], v249 offset:0
    ds_read_b64_tr_b16 v[68:69], v249 offset:64
    ds_read_b64_tr_b16 v[66:67], v249 offset:256
    ds_read_b64_tr_b16 v[70:71], v249 offset:320
    s_mov_b64 exec, s[54:55]
    ds_read_u16_d16_hi v242, v250 offset:0
    s_mov_b64 exec, -1
    v_fmac_f32 v196, v29, v165
    v_fmac_f32 v196, v30, v166
    v_fmac_f32 v196, v31, v167
    s_nop 1
    v_permlane32_swap_b32 v198, v196
    v_add_f32 v196, v198, v196
    v_mul_f32 v255, v32, v152
    v_fmac_f32 v255, v33, v153
    v_fmac_f32 v255, v34, v154
    v_fmac_f32 v255, v35, v155
    v_fmac_f32 v255, v36, v156
    v_fmac_f32 v255, v37, v157
    v_fmac_f32 v255, v38, v158
    v_fmac_f32 v255, v39, v159
    v_fma_f32 v203, v40, -v168, v203
    v_fma_f32 v203, v41, -v169, v203
    v_permlane32_swap_b32 v255, v201
    v_fma_f32 v203, v42, -v170, v203
    v_fma_f32 v203, v43, -v171, v203
    v_fma_f32 v203, v44, -v172, v203
    v_fma_f32 v203, v45, -v173, v203
    v_fma_f32 v203, v46, -v174, v203
    v_fma_f32 v203, v47, -v175, v203
    v_add_f32 v201, v255, v201
    v_fmac_f32 v199, v48, v120
    v_permlane32_swap_b32 v203, v255
    v_fmac_f32 v199, v49, v121
    v_fmac_f32 v199, v50, v122
    v_fmac_f32 v199, v51, v123
    v_fmac_f32 v199, v52, v124
    v_fmac_f32 v199, v53, v125
    v_fmac_f32 v199, v54, v126
    v_fmac_f32 v199, v55, v127
    v_add_f32 v255, v203, v255
    v_mul_f32 v197, v56, v168
    v_fmac_f32 v197, v57, v169
    v_fmac_f32 v197, v58, v170
    v_fmac_f32 v197, v59, v171
    v_fmac_f32 v197, v60, v172
    v_fmac_f32 v197, v61, v173
    v_fmac_f32 v197, v62, v174
    v_fmac_f32 v197, v63, v175
    s_nop 1
    v_permlane32_swap_b32 v199, v197
    v_add_f32 v197, v199, v197
    s_set_gpr_idx_on s51, gpr_idx(DST)
    s_nop 0
    v_cvt_pk_bf16_f32 v207, v200, v201
    v_cvt_pk_bf16_f32 v209, v254, v255
    v_cvt_pk_bf16_f32 v208, v196, v197
    s_set_gpr_idx_off
    s_add_u32 s50, s50, 1
    s_add_u32 s51, s51, 6
    s_cmp_ge_u32 s50, 4
    s_cbranch_scc1 LAST0
    s_waitcnt lgkmcnt(5)
    v_readfirstlane_b32 s66, v252
    s_add_u32 s53, s53, 1
    v_mov_b32 v252, s53
    s_cmp_le_u32 s53, s66
    ds_write2_b32 v251, v252, v252 offset0:0 offset1:8
    s_setprio 1
    s_cbranch_scc1 PRIO_6
    s_setprio 0
PRIO_6:
    s_cmp_eq_u32 s52, 4
    s_cbranch_scc1 ITEM_0_4
    s_cmp_eq_u32 s52, 5
    s_cbranch_scc1 ITEM_0_5
    s_cmp_eq_u32 s52, 3
    s_cbranch_scc1 ITEM_0_3
    s_cmp_eq_u32 s52, 6
    s_cbranch_scc1 ITEM_0_6
    s_cmp_eq_u32 s52, 8
    s_cbranch_scc1 ITEM_0_8
    s_branch ITEM_0_2
.p2align 6
ITEM_0_3:
    s_mov_b64 exec, s[54:55]
    ds_read_u16_d16_hi v243, v250 offset:128
    s_mov_b64 exec, -1
    ds_read_b64_tr_b16 v[72:73], v249 offset:512
    ds_read_b64_tr_b16 v[76:77], v249 offset:576
    s_waitcnt lgkmcnt(3)
    v_mul_f32_dpp v196, v242, v64 row_newbcast:0 row_mask:0xf bank_mask:0xf
    v_mul_f32_dpp v197, v242, v65 row_newbcast:1 row_mask:0xf bank_mask:0xf
    v_mul_f32_dpp v198, v242, v64 row_newbcast:8 row_mask:0xf bank_mask:0xf
    v_mul_f32_dpp v199, v242, v65 row_newbcast:9 row_mask:0xf bank_mask:0xf
    v_mul_f32_dpp v200, v242, v68 row_newbcast:2 row_mask:0xf bank_mask:0xf
    v_mul_f32_dpp v201, v242, v69 row_newbcast:3 row_mask:0xf bank_mask:0xf
    v_mul_f32_dpp v202, v242, v68 row_newbcast:10 row_mask:0xf bank_mask:0xf
    v_mul_f32_dpp v203, v242, v69 row_newbcast:11 row_mask:0xf bank_mask:0xf
    v_cvt_pk_bf16_f32 v64, v196, v197
    v_cvt_pk_bf16_f32 v68, v198, v199
    v_cvt_pk_bf16_f32 v65, v200, v201
    v_cvt_pk_bf16_f32 v69, v202, v203
    v_mul_f32_dpp v196, v242, v66 row_newbcast:4 row_mask:0xf bank_mask:0xf
    v_mul_f32_dpp v197, v242, v67 row_newbcast:5 row_mask:0xf bank_mask:0xf
    v_mul_f32_dpp v198, v242, v66 row_newbcast:12 row_mask:0xf bank_mask:0xf
    v_mul_f32_dpp v199, v242, v67 row_newbcast:13 row_mask:0xf bank_mask:0xf
    v_mul_f32_dpp v200, v242, v70 row_newbcast:6 row_mask:0xf bank_mask:0xf
    v_mul_f32_dpp v201, v242, v71 row_newbcast:7 row_mask:0xf bank_mask:0xf
    v_mul_f32_dpp v202, v242, v70 row_newbcast:14 row_mask:0xf bank_mask:0xf
    v_mul_f32_dpp v203, v242, v71 row_newbcast:15 row_mask:0xf bank_mask:0xf
    v_cvt_pk_bf16_f32 v66, v196, v197
    v_cvt_pk_bf16_f32 v70, v198, v199
    v_cvt_pk_bf16_f32 v67, v200, v201
    v_cvt_pk_bf16_f32 v71, v202, v203
    s_nop 0
    s_waitcnt vmcnt(4) lgkmcnt(0)
    v_mfma_f32_32x32x16_bf16 v[0:15], v[64:67], v[176:179], 0
    v_mul_f32_dpp v196, v243, v72 row_newbcast:0 row_mask:0xf bank_mask:0xf
    v_mul_f32_dpp v197, v243, v73 row_newbcast:1 row_mask:0xf bank_mask:0xf
    v_mul_f32_dpp v198, v243, v72 row_newbcast:8 row_mask:0xf bank_mask:0xf
    v_mul_f32_dpp v199, v243, v73 row_newbcast:9 row_mask:0xf bank_mask:0xf
    v_mul_f32_dpp v200, v243, v76 row_newbcast:2 row_mask:0xf bank_mask:0xf
    v_mul_f32_dpp v201, v243, v77 row_newbcast:3 row_mask:0xf bank_mask:0xf
    s_add_u32 m0, s21, 0
    v_mfma_f32_32x32x16_bf16 v[16:31], v[68:71], v[176:179], 0
    buffer_load_dwordx4 v234, s[4:7], s36 offen lds
    buffer_load_dwordx4 v235, s[8:11], s36 offen offset:1024 lds
    ds_read_b64_tr_b16 v[176:177], v244 offset:2048
    ds_read_b64_tr_b16 v[184:185], v245 offset:2048
    v_mul_f32_dpp v202, v243, v76 row_newbcast:10 row_mask:0xf bank_mask:0xf
    v_mul_f32_dpp v203, v243, v77 row_newbcast:11 row_mask:0xf bank_mask:0xf
    v_cvt_pk_bf16_f32 v72, v196, v197
    v_cvt_pk_bf16_f32 v76, v198, v199
    v_cvt_pk_bf16_f32 v73, v200, v201
    v_cvt_pk_bf16_f32 v77, v202, v203
    s_nop 0
    s_waitcnt lgkmcnt(0)
    v_mfma_f32_32x32x8_bf16 v[0:15], v[72:73], v[176:177], v[0:15]
    s_add_u32 m0, s21, 2048
    v_mfma_f32_32x32x8_bf16 v[16:31], v[76:77], v[176:177], v[16:31]
    buffer_load_dwordx4 v236, s[4:7], s36 offen lds
    s_mov_b32 m0, s50
    s_nop 0
    s_movrels_b32 s71, s23
    s_bfe_u32 s46, s71, 0x30012
    s_mov_b32 m0, s46
    s_and_b32 s66, s71, 0x3ffff
    s_movrels_b32 s68, s57
    s_movrels_b32 s69, s61
    s_sub_u32 s48, s66, s47
    s_mov_b32 s47, s66
    s_lshr_b32 s52, s71, 28
    s_lshl_b32 s67, s46, 9
    s_add_u32 s66, s66, s67
    s_sub_u32 s49, s66, s42
    s_mov_b32 s42, s66
    s_bfe_u32 s66, s68, 655360
    s_add_u32 s43, s42, s66
    s_bfe_u32 s39, s69, 655360
    s_bfe_u32 s66, s68, 655370
    s_add_u32 s44, s42, s66
    s_bfe_u32 s40, s69, 655370
    s_bfe_u32 s66, s68, 655380
    s_add_u32 s45, s42, s66
    s_bfe_u32 s41, s69, 655380
    s_and_b32 s66, s46, s33
    s_cselect_b32 s72, -1, 1
    s_cselect_b32 s76, s47, 163712
    s_cmp_ge_u32 s66, 2
    s_cselect_b32 s73, -1, 0
    s_add_u32 s77, s47, 1024
    s_cmp_ge_u32 s66, 4
    s_cselect_b32 s75, -1, 0
    s_cmp_ge_u32 s66, 3
    s_cselect_b32 s74, -1, 1
    s_cselect_b32 s77, s77, 163712
    v_add_u32 v252, s44, v247
    ds_read_u16 v238, v252
    ds_read_u16 v239, v252 offset:64
    v_add_u32 v252, s45, v247
    ds_read_u16 v240, v252
    ds_read_u16 v241, v252 offset:64
    v_mfma_f32_32x32x16_bf16 v[32:47], v[64:67], v[180:183], 0
    v_mul_f32 v196, v0, v96
    v_fmac_f32 v196, v1, v97
    v_fmac_f32 v196, v2, v98
    v_fmac_f32 v196, v3, v99
    v_fmac_f32 v196, v4, v100
    v_fmac_f32 v196, v5, v101
    v_fmac_f32 v196, v6, v102
    v_fmac_f32 v196, v7, v103
    v_mul_f32 v198, v8, v128
    v_fmac_f32 v198, v9, v129
    v_mfma_f32_32x32x16_bf16 v[48:63], v[68:71], v[180:183], 0
    v_add_u32 v253, s47, v248
    ds_read_b32 v254, v253
    ds_read_b32 v255, v253 offset:256
    s_waitcnt vmcnt(5)
    ds_read_b64_tr_b16 v[176:177], v244 offset:4096
    ds_read_b64_tr_b16 v[178:179], v244 offset:5120
    ds_read_b64_tr_b16 v[180:181], v245 offset:4096
    ds_read_b64_tr_b16 v[182:183], v245 offset:5120
    v_fmac_f32 v198, v10, v130
    v_fmac_f32 v198, v11, v131
    v_fmac_f32 v198, v12, v132
    v_fmac_f32 v198, v13, v133
    v_fmac_f32 v198, v14, v134
    v_fmac_f32 v198, v15, v135
    v_mul_f32 v200, v16, v128
    v_fmac_f32 v200, v17, v129
    v_permlane32_swap_b32 v196, v198
    v_mfma_f32_32x32x8_bf16 v[32:47], v[72:73], v[184:185], v[32:47]
    v_fmac_f32 v200, v18, v130
    v_fmac_f32 v200, v19, v131
    v_fmac_f32 v200, v20, v132
    v_fmac_f32 v200, v21, v133
    v_fmac_f32 v200, v22, v134
    v_fmac_f32 v200, v23, v135
    v_add_f32 v198, v196, v198
    v_mul_f32_e64 v202, v24, -v128
    v_fma_f32 v202, v25, -v129, v202
    v_mfma_f32_32x32x8_bf16 v[48:63], v[76:77], v[184:185], v[48:63]
    v_fma_f32 v202, v26, -v130, v202
    v_fma_f32 v202, v27, -v131, v202
    v_fma_f32 v202, v28, -v132, v202
    v_fma_f32 v202, v29, -v133, v202
    v_fma_f32 v202, v30, -v134, v202
    v_fma_f32 v202, v31, -v135, v202
    s_nop 1
    v_permlane32_swap_b32 v200, v202
    v_add_f32 v202, v200, v202
    s_waitcnt vmcnt(3) lgkmcnt(0)
    v_mfma_f32_32x32x16_bf16 v[0:15], v[64:67], v[176:179], 0
    v_mul_f32 v197, v32, v104
    v_fmac_f32 v197, v33, v105
    v_fmac_f32 v197, v34, v106
    v_fmac_f32 v197, v35, v107
    v_fmac_f32 v197, v36, v108
    v_fmac_f32 v197, v37, v109
    v_fmac_f32 v197, v38, v110
    v_fmac_f32 v197, v39, v111
    v_mul_f32 v199, v40, v136
    v_fmac_f32 v199, v41, v137
    v_fmac_f32 v199, v42, v138
    s_add_u32 m0, s21, 4096
    v_mfma_f32_32x32x16_bf16 v[16:31], v[68:71], v[176:179], 0
    buffer_load_dwordx4 v234, s[4:7], s37 offen lds
    buffer_load_dwordx4 v235, s[8:11], s37 offen offset:1024 lds
    ds_read_b64_tr_b16 v[176:177], v244 offset:6144
    ds_read_b64_tr_b16 v[184:185], v245 offset:6144
    v_add_u32 v252, s42, v247
    ds_read_u16 v234, v252
    ds_read_u16 v235, v252 offset:64
    s_mov_b32 m0, s76
    s_mov_b64 exec, s[72:73]
    buffer_load_dwordx4 v254, s[12:15], 0 offen  lds
    s_mov_b32 m0, s77
    s_mov_b64 exec, s[74:75]
    buffer_load_dwordx4 v255, s[12:15], 0 offen  lds
    s_mov_b64 exec, -1
    v_fmac_f32 v199, v43, v139
    v_fmac_f32 v199, v44, v140
    v_fmac_f32 v199, v45, v141
    v_fmac_f32 v199, v46, v142
    v_fmac_f32 v199, v47, v143
    v_mul_f32 v201, v48, v136
    v_fmac_f32 v201, v49, v137
    v_permlane32_swap_b32 v197, v199
    v_fmac_f32 v201, v50, v138
    v_fmac_f32 v201, v51, v139
    s_waitcnt lgkmcnt(2)
    v_mfma_f32_32x32x8_bf16 v[0:15], v[72:73], v[176:177], v[0:15]
    v_fmac_f32 v201, v52, v140
    v_fmac_f32 v201, v53, v141
    v_fmac_f32 v201, v54, v142
    v_fmac_f32 v201, v55, v143
    v_add_f32 v199, v197, v199
    v_mul_f32_e64 v203, v56, -v136
    v_fma_f32 v203, v57, -v137, v203
    v_fma_f32 v203, v58, -v138, v203
    v_fma_f32 v203, v59, -v139, v203
    v_fma_f32 v203, v60, -v140, v203
    v_fma_f32 v203, v61, -v141, v203
    s_add_u32 m0, s21, 6144
    v_mfma_f32_32x32x8_bf16 v[16:31], v[76:77], v[176:177], v[16:31]
    buffer_load_dwordx4 v236, s[4:7], s37 offen lds
    v_add_u32 v252, s43, v247
    ds_read_u16 v236, v252
    ds_read_u16 v237, v252 offset:64
    v_fma_f32 v203, v62, -v142, v203
    v_fma_f32 v203, v63, -v143, v203
    s_nop 1
    v_permlane32_swap_b32 v201, v203
    v_add_f32 v203, v201, v203
    s_set_gpr_idx_on s51, gpr_idx(DST)
    s_nop 0
    v_cvt_pk_bf16_f32 v204, v198, v199
    v_cvt_pk_bf16_f32 v205, v202, v203
    s_set_gpr_idx_off
    v_mfma_f32_32x32x16_bf16 v[32:47], v[64:67], v[180:183], 0
    v_mul_f32 v196, v0, v144
    v_fmac_f32 v196, v1, v145
    v_fmac_f32 v196, v2, v146
    v_fmac_f32 v196, v3, v147
    v_fmac_f32 v196, v4, v148
    v_fmac_f32 v196, v5, v149
    v_fmac_f32 v196, v6, v150
    v_fmac_f32 v196, v7, v151
    v_mfma_f32_32x32x16_bf16 v[48:63], v[68:71], v[180:183], 0
    s_waitcnt vmcnt(6)
    ds_read_b64_tr_b16 v[176:177], v244 offset:0
    ds_read_b64_tr_b16 v[178:179], v244 offset:1024
    ds_read_b64_tr_b16 v[180:181], v245 offset:0
    ds_read_b64_tr_b16 v[182:183], v245 offset:1024
    v_mul_f32 v198, v8, v112
    v_fmac_f32 v198, v9, v113
    v_fmac_f32 v198, v10, v114
    v_fmac_f32 v198, v11, v115
    v_fmac_f32 v198, v12, v116
    v_fmac_f32 v198, v13, v117
    v_fmac_f32 v198, v14, v118
    v_fmac_f32 v198, v15, v119
    v_mfma_f32_32x32x8_bf16 v[32:47], v[72:73], v[184:185], v[32:47]
    v_mul_f32_e64 v200, v16, -v160
    v_fma_f32 v200, v17, -v161, v200
    v_fma_f32 v200, v18, -v162, v200
    v_fma_f32 v200, v19, -v163, v200
    v_fma_f32 v200, v20, -v164, v200
    v_fma_f32 v200, v21, -v165, v200
    v_fma_f32 v200, v22, -v166, v200
    v_fma_f32 v200, v23, -v167, v200
    v_mfma_f32_32x32x8_bf16 v[48:63], v[76:77], v[184:185], v[48:63]
    v_mul_f32_e64 v202, v24, -v160
    v_fma_f32 v202, v25, -v161, v202
    v_fma_f32 v202, v26, -v162, v202
    v_fma_f32 v202, v27, -v163, v202
    v_fma_f32 v202, v28, -v164, v202
    v_fma_f32 v202, v29, -v165, v202
    v_fma_f32 v202, v30, -v166, v202
    v_fma_f32 v202, v31, -v167, v202
    s_waitcnt vmcnt(5) lgkmcnt(0)
    v_mfma_f32_32x32x16_bf16 v[0:15], v[64:67], v[176:179], 0
    v_mul_f32 v197, v32, v152
    v_fmac_f32 v197, v33, v153
    v_fmac_f32 v197, v34, v154
    v_fmac_f32 v197, v35, v155
    v_fmac_f32 v197, v36, v156
    v_fmac_f32 v197, v37, v157
    v_fmac_f32 v197, v38, v158
    v_fmac_f32 v197, v39, v159
    s_add_u32 m0, s21, 0
    v_mfma_f32_32x32x16_bf16 v[16:31], v[68:71], v[176:179], 0
    v_lshl_add_u32 v234, v234, 10, v246
    v_lshl_add_u32 v235, v235, 10, v246
    buffer_load_dwordx4 v234, s[4:7], s38 offen lds
    buffer_load_dwordx4 v235, s[8:11], s38 offen offset:1024 lds
    ds_read_b64_tr_b16 v[176:177], v244 offset:2048
    ds_read_b64_tr_b16 v[184:185], v245 offset:2048
    v_mul_f32 v199, v40, v120
    v_fmac_f32 v199, v41, v121
    v_fmac_f32 v199, v42, v122
    v_fmac_f32 v199, v43, v123
    v_fmac_f32 v199, v44, v124
    v_fmac_f32 v199, v45, v125
    v_fmac_f32 v199, v46, v126
    v_fmac_f32 v199, v47, v127
    s_waitcnt lgkmcnt(0)
    v_mfma_f32_32x32x8_bf16 v[0:15], v[72:73], v[176:177], v[0:15]
    v_mul_f32_e64 v201, v48, -v168
    v_fma_f32 v201, v49, -v169, v201
    v_fma_f32 v201, v50, -v170, v201
    v_fma_f32 v201, v51, -v171, v201
    v_fma_f32 v201, v52, -v172, v201
    v_fma_f32 v201, v53, -v173, v201
    v_fma_f32 v201, v54, -v174, v201
    v_fma_f32 v201, v55, -v175, v201
    s_add_u32 m0, s21, 2048
    v_mfma_f32_32x32x8_bf16 v[16:31], v[76:77], v[176:177], v[16:31]
    v_lshl_add_u32 v236, v236, 10, v246
    v_lshl_add_u32 v237, v237, 10, v246
    buffer_load_dwordx4 v236, s[4:7], s39 offen lds
    buffer_load_dwordx4 v237, s[8:11], s39 offen offset:1024 lds
    v_mul_f32_e64 v203, v56, -v168
    v_fma_f32 v203, v57, -v169, v203
    v_fma_f32 v203, v58, -v170, v203
    v_fma_f32 v203, v59, -v171, v203
    v_fma_f32 v203, v60, -v172, v203
    v_fma_f32 v203, v61, -v173, v203
    v_fma_f32 v203, v62, -v174, v203
    v_fma_f32 v203, v63, -v175, v203
    v_mfma_f32_32x32x16_bf16 v[32:47], v[64:67], v[180:183], 0
    v_mul_f32 v254, v0, v144
    v_fmac_f32 v254, v1, v145
    v_fmac_f32 v254, v2, v146
    v_fmac_f32 v254, v3, v147
    v_fmac_f32 v254, v4, v148
    v_mfma_f32_32x32x16_bf16 v[48:63], v[68:71], v[180:183], 0
    ds_swizzle_b32 v68, v68 offset:0x401F
    ds_swizzle_b32 v69, v69 offset:0x401F
    ds_swizzle_b32 v70, v70 offset:0x401F
    ds_swizzle_b32 v71, v71 offset:0x401F
    s_waitcnt vmcnt(7)
    ds_read_b64_tr_b16 v[176:177], v244 offset:4096
    ds_read_b64_tr_b16 v[178:179], v244 offset:5120
    ds_read_b64_tr_b16 v[180:181], v245 offset:4096
    ds_read_b64_tr_b16 v[182:183], v245 offset:5120
    v_fmac_f32 v254, v5, v149
    v_fmac_f32 v254, v6, v150
    v_fmac_f32 v254, v7, v151
    v_fmac_f32 v200, v8, v160
    v_mfma_f32_32x32x8_bf16 v[32:47], v[72:73], v[184:185], v[32:47]
    v_fmac_f32 v200, v9, v161
    v_permlane32_swap_b32 v196, v254
    v_fmac_f32 v200, v10, v162
    v_fmac_f32 v200, v11, v163
    v_fmac_f32 v200, v12, v164
    v_mfma_f32_32x32x8_bf16 v[48:63], v[76:77], v[184:185], v[48:63]
    ds_swizzle_b32 v76, v76 offset:0x401F
    ds_swizzle_b32 v77, v77 offset:0x401F
    v_fmac_f32 v200, v13, v165
    v_fmac_f32 v200, v14, v166
    v_fmac_f32 v200, v15, v167
    v_add_f32 v254, v196, v254
    s_waitcnt lgkmcnt(6)
    s_mov_b64 exec, s[56:57]
    v_xor_b32 v68, 0x80008000, v68
    v_xor_b32 v69, 0x80008000, v69
    v_xor_b32 v70, 0x80008000, v70
    v_xor_b32 v71, 0x80008000, v71
    s_mov_b64 exec, -1
    s_waitcnt vmcnt(4) lgkmcnt(2)
    v_mfma_f32_32x32x16_bf16 v[0:15], v[64:67], v[176:179], 0
    v_mul_f32 v255, v32, v152
    v_fmac_f32 v255, v33, v153
    v_fmac_f32 v255, v34, v154
    v_fmac_f32 v255, v35, v155
    v_fmac_f32 v255, v36, v156
    v_fmac_f32 v255, v37, v157
    s_add_u32 m0, s21, 4096
    v_mfma_f32_32x32x16_bf16 v[16:31], v[68:71], v[176:179], v[16:31]
    v_lshl_add_u32 v238, v238, 10, v246
    v_lshl_add_u32 v239, v239, 10, v246
    buffer_load_dwordx4 v238, s[4:7], s40 offen lds
    buffer_load_dwordx4 v239, s[8:11], s40 offen offset:1024 lds
    ds_read_b64_tr_b16 v[176:177], v244 offset:6144
    ds_read_b64_tr_b16 v[184:185], v245 offset:6144
    v_fmac_f32 v255, v38, v158
    v_fmac_f32 v255, v39, v159
    v_fmac_f32 v201, v40, v168
    v_fmac_f32 v201, v41, v169
    v_permlane32_swap_b32 v197, v255
    s_waitcnt lgkmcnt(0)
    s_mov_b64 exec, s[56:57]
    v_xor_b32 v76, 0x80008000, v76
    v_xor_b32 v77, 0x80008000, v77
    s_mov_b64 exec, -1
    v_mfma_f32_32x32x8_bf16 v[0:15], v[72:73], v[176:177], v[0:15]
    v_fmac_f32 v201, v42, v170
    v_fmac_f32 v201, v43, v171
    v_fmac_f32 v201, v44, v172
    v_fmac_f32 v201, v45, v173
    v_fmac_f32 v201, v46, v174
    v_fmac_f32 v201, v47, v175
    s_add_u32 m0, s21, 6144
    v_mfma_f32_32x32x8_bf16 v[16:31], v[76:77], v[176:177], v[16:31]
    v_lshl_add_u32 v240, v240, 10, v246
    v_lshl_add_u32 v241, v241, 10, v246
    buffer_load_dwordx4 v240, s[4:7], s41 offen lds
    buffer_load_dwordx4 v241, s[8:11], s41 offen offset:1024 lds
    v_add_f32 v255, v197, v255
    s_set_gpr_idx_on s51, gpr_idx(DST)
    s_nop 0
    v_cvt_pk_bf16_f32 v206, v254, v255
    s_set_gpr_idx_off
    v_mfma_f32_32x32x16_bf16 v[32:47], v[64:67], v[180:183], 0
    v_mul_f32 v254, v0, v144
    v_fmac_f32 v254, v1, v145
    v_fmac_f32 v254, v2, v146
    v_fmac_f32 v254, v3, v147
    v_fmac_f32 v254, v4, v148
    v_fmac_f32 v254, v5, v149
    v_fmac_f32 v254, v6, v150
    v_fmac_f32 v254, v7, v151
    v_fma_f32 v202, v8, -v160, v202
    v_fma_f32 v202, v9, -v161, v202
    v_mfma_f32_32x32x16_bf16 v[48:63], v[68:71], v[180:183], v[48:63]
    s_waitcnt vmcnt(6)
    ds_read_b64_tr_b16 v[176:177], v244 offset:0
    ds_read_b64_tr_b16 v[178:179], v244 offset:1024
    ds_read_b64_tr_b16 v[180:181], v245 offset:0
    ds_read_b64_tr_b16 v[182:183], v245 offset:1024
    v_permlane32_swap_b32 v254, v200
    v_fma_f32 v202, v10, -v162, v202
    v_fma_f32 v202, v11, -v163, v202
    v_fma_f32 v202, v12, -v164, v202
    v_fma_f32 v202, v13, -v165, v202
    v_fma_f32 v202, v14, -v166, v202
    v_fma_f32 v202, v15, -v167, v202
    v_add_f32 v200, v254, v200
    v_fmac_f32 v198, v16, v112
    v_permlane32_swap_b32 v202, v254
    v_mfma_f32_32x32x8_bf16 v[32:47], v[72:73], v[184:185], v[32:47]
    v_fmac_f32 v198, v17, v113
    v_fmac_f32 v198, v18, v114
    v_fmac_f32 v198, v19, v115
    v_fmac_f32 v198, v20, v116
    v_fmac_f32 v198, v21, v117
    v_fmac_f32 v198, v22, v118
    v_fmac_f32 v198, v23, v119
    v_add_f32 v254, v202, v254
    v_mul_f32 v196, v24, v160
    v_fmac_f32 v196, v25, v161
    v_mfma_f32_32x32x8_bf16 v[48:63], v[76:77], v[184:185], v[48:63]
    v_add_u32 v249, s48, v249
    v_add_u32 v250, s49, v250
    ds_read_b32 v252, v251 offset:16
    ds_read_b64_tr_b16 v[64:65], v249 offset:0
    ds_read_b64_tr_b16 v[68:69], v249 offset:64
    ds_read_b64_tr_b16 v[66:67], v249 offset:256
    ds_read_b64_tr_b16 v[70:71], v249 offset:320
    s_mov_b64 exec, s[54:55]
    ds_read_u16_d16_hi v242, v250 offset:0
    s_mov_b64 exec, -1
    v_fmac_f32 v196, v26, v162
    v_fmac_f32 v196, v27, v163
    v_fmac_f32 v196, v28, v164
    v_fmac_f32 v196, v29, v165
    v_fmac_f32 v196, v30, v166
    v_fmac_f32 v196, v31, v167
    s_nop 1
    v_permlane32_swap_b32 v198, v196
    v_add_f32 v196, v198, v196
    v_mul_f32 v255, v32, v152
    v_fmac_f32 v255, v33, v153
    v_fmac_f32 v255, v34, v154
    v_fmac_f32 v255, v35, v155
    v_fmac_f32 v255, v36, v156
    v_fmac_f32 v255, v37, v157
    v_fmac_f32 v255, v38, v158
    v_fmac_f32 v255, v39, v159
    v_fma_f32 v203, v40, -v168, v203
    v_fma_f32 v203, v41, -v169, v203
    v_permlane32_swap_b32 v255, v201
    v_fma_f32 v203, v42, -v170, v203
    v_fma_f32 v203, v43, -v171, v203
    v_fma_f32 v203, v44, -v172, v203
    v_fma_f32 v203, v45, -v173, v203
    v_fma_f32 v203, v46, -v174, v203
    v_fma_f32 v203, v47, -v175, v203
    v_add_f32 v201, v255, v201
    v_fmac_f32 v199, v48, v120
    v_permlane32_swap_b32 v203, v255
    v_fmac_f32 v199, v49, v121
    v_fmac_f32 v199, v50, v122
    v_fmac_f32 v199, v51, v123
    v_fmac_f32 v199, v52, v124
    v_fmac_f32 v199, v53, v125
    v_fmac_f32 v199, v54, v126
    v_fmac_f32 v199, v55, v127
    v_add_f32 v255, v203, v255
    v_mul_f32 v197, v56, v168
    v_fmac_f32 v197, v57, v169
    v_fmac_f32 v197, v58, v170
    v_fmac_f32 v197, v59, v171
    v_fmac_f32 v197, v60, v172
    v_fmac_f32 v197, v61, v173
    v_fmac_f32 v197, v62, v174
    v_fmac_f32 v197, v63, v175
    s_nop 1
    v_permlane32_swap_b32 v199, v197
    v_add_f32 v197, v199, v197
    s_set_gpr_idx_on s51, gpr_idx(DST)
    s_nop 0
    v_cvt_pk_bf16_f32 v207, v200, v201
    v_cvt_pk_bf16_f32 v209, v254, v255
    v_cvt_pk_bf16_f32 v208, v196, v197
    s_set_gpr_idx_off
    s_add_u32 s50, s50, 1
    s_add_u32 s51, s51, 6
    s_cmp_ge_u32 s50, 4
    s_cbranch_scc1 LAST0
    s_waitcnt lgkmcnt(5)
    v_readfirstlane_b32 s66, v252
    s_add_u32 s53, s53, 1
    v_mov_b32 v252, s53
    s_cmp_le_u32 s53, s66
    ds_write2_b32 v251, v252, v252 offset0:0 offset1:8
    s_setprio 1
    s_cbranch_scc1 PRIO_7
    s_setprio 0
PRIO_7:
    s_cmp_eq_u32 s52, 4
    s_cbranch_scc1 ITEM_0_4
    s_cmp_eq_u32 s52, 5
    s_cbranch_scc1 ITEM_0_5
    s_cmp_eq_u32 s52, 3
    s_cbranch_scc1 ITEM_0_3
    s_cmp_eq_u32 s52, 6
    s_cbranch_scc1 ITEM_0_6
    s_cmp_eq_u32 s52, 8
    s_cbranch_scc1 ITEM_0_8
    s_branch ITEM_0_2
.p2align 6
ITEM_0_6:
    s_mov_b64 exec, s[54:55]
    ds_read_u16_d16_hi v243, v250 offset:128
    s_mov_b64 exec, -1
    ds_read_b64_tr_b16 v[72:73], v249 offset:512
    ds_read_b64_tr_b16 v[76:77], v249 offset:576
    ds_read_b64_tr_b16 v[74:75], v249 offset:768
    ds_read_b64_tr_b16 v[78:79], v249 offset:832
    ds_read_b64_tr_b16 v[80:81], v249 offset:1024
    ds_read_b64_tr_b16 v[84:85], v249 offset:1088
    ds_read_b64_tr_b16 v[82:83], v249 offset:1280
    ds_read_b64_tr_b16 v[86:87], v249 offset:1344
    s_waitcnt lgkmcnt(9)
    v_mul_f32_dpp v196, v242, v64 row_newbcast:0 row_mask:0xf bank_mask:0xf
    v_mul_f32_dpp v197, v242, v65 row_newbcast:1 row_mask:0xf bank_mask:0xf
    v_mul_f32_dpp v198, v242, v64 row_newbcast:8 row_mask:0xf bank_mask:0xf
    v_mul_f32_dpp v199, v242, v65 row_newbcast:9 row_mask:0xf bank_mask:0xf
    v_mul_f32_dpp v200, v242, v68 row_newbcast:2 row_mask:0xf bank_mask:0xf
    v_mul_f32_dpp v201, v242, v69 row_newbcast:3 row_mask:0xf bank_mask:0xf
    v_mul_f32_dpp v202, v242, v68 row_newbcast:10 row_mask:0xf bank_mask:0xf
    v_mul_f32_dpp v203, v242, v69 row_newbcast:11 row_mask:0xf bank_mask:0xf
    v_cvt_pk_bf16_f32 v64, v196, v197
    v_cvt_pk_bf16_f32 v68, v198, v199
    v_cvt_pk_bf16_f32 v65, v200, v201
    v_cvt_pk_bf16_f32 v69, v202, v203
    v_mul_f32_dpp v196, v242, v66 row_newbcast:4 row_mask:0xf bank_mask:0xf
    v_mul_f32_dpp v197, v242, v67 row_newbcast:5 row_mask:0xf bank_mask:0xf
    v_mul_f32_dpp v198, v242, v66 row_newbcast:12 row_mask:0xf bank_mask:0xf
    v_mul_f32_dpp v199, v242, v67 row_newbcast:13 row_mask:0xf bank_mask:0xf
    v_mul_f32_dpp v200, v242, v70 row_newbcast:6 row_mask:0xf bank_mask:0xf
    v_mul_f32_dpp v201, v242, v71 row_newbcast:7 row_mask:0xf bank_mask:0xf
    v_mul_f32_dpp v202, v242, v70 row_newbcast:14 row_mask:0xf bank_mask:0xf
    v_mul_f32_dpp v203, v242, v71 row_newbcast:15 row_mask:0xf bank_mask:0xf
    v_cvt_pk_bf16_f32 v66, v196, v197
    v_cvt_pk_bf16_f32 v70, v198, v199
    v_cvt_pk_bf16_f32 v67, v200, v201
    v_cvt_pk_bf16_f32 v71, v202, v203
    s_mov_b64 exec, s[54:55]
    ds_read_u16_d16_hi v242, v250 offset:256
    s_mov_b64 exec, -1
    s_waitcnt vmcnt(4) lgkmcnt(5)
    v_mfma_f32_32x32x16_bf16 v[0:15], v[64:67], v[176:179], 0
    v_mul_f32_dpp v196, v243, v72 row_newbcast:0 row_mask:0xf bank_mask:0xf
    v_mul_f32_dpp v197, v243, v73 row_newbcast:1 row_mask:0xf bank_mask:0xf
    v_mul_f32_dpp v198, v243, v72 row_newbcast:8 row_mask:0xf bank_mask:0xf
    v_mul_f32_dpp v199, v243, v73 row_newbcast:9 row_mask:0xf bank_mask:0xf
    v_mul_f32_dpp v200, v243, v76 row_newbcast:2 row_mask:0xf bank_mask:0xf
    v_mul_f32_dpp v201, v243, v77 row_newbcast:3 row_mask:0xf bank_mask:0xf
    v_mul_f32_dpp v202, v243, v76 row_newbcast:10 row_mask:0xf bank_mask:0xf
    v_mul_f32_dpp v203, v243, v77 row_newbcast:11 row_mask:0xf bank_mask:0xf
    v_cvt_pk_bf16_f32 v72, v196, v197
    v_cvt_pk_bf16_f32 v76, v198, v199
    v_cvt_pk_bf16_f32 v73, v200, v201
    v_cvt_pk_bf16_f32 v77, v202, v203
    s_add_u32 m0, s21, 0
    v_mfma_f32_32x32x16_bf16 v[16:31], v[68:71], v[176:179], 0
    buffer_load_dwordx4 v236, s[4:7], s35 offen lds
    buffer_load_dwordx4 v237, s[8:11], s35 offen offset:1024 lds
    ds_read_b64_tr_b16 v[176:177], v244 offset:2048
    ds_read_b64_tr_b16 v[178:179], v244 offset:3072
    ds_read_b64_tr_b16 v[184:185], v245 offset:2048
    ds_read_b64_tr_b16 v[186:187], v245 offset:3072
    v_mul_f32_dpp v196, v243, v74 row_newbcast:4 row_mask:0xf bank_mask:0xf
    v_mul_f32_dpp v197, v243, v75 row_newbcast:5 row_mask:0xf bank_mask:0xf
    v_mul_f32_dpp v198, v243, v74 row_newbcast:12 row_mask:0xf bank_mask:0xf
    v_mul_f32_dpp v199, v243, v75 row_newbcast:13 row_mask:0xf bank_mask:0xf
    v_mul_f32_dpp v200, v243, v78 row_newbcast:6 row_mask:0xf bank_mask:0xf
    v_mul_f32_dpp v201, v243, v79 row_newbcast:7 row_mask:0xf bank_mask:0xf
    v_mul_f32_dpp v202, v243, v78 row_newbcast:14 row_mask:0xf bank_mask:0xf
    v_mul_f32_dpp v203, v243, v79 row_newbcast:15 row_mask:0xf bank_mask:0xf
    v_cvt_pk_bf16_f32 v74, v196, v197
    v_cvt_pk_bf16_f32 v78, v198, v199
    v_cvt_pk_bf16_f32 v75, v200, v201
    v_cvt_pk_bf16_f32 v79, v202, v203
    s_nop 0
    s_waitcnt vmcnt(4) lgkmcnt(0)
    v_mfma_f32_32x32x16_bf16 v[0:15], v[72:75], v[176:179], v[0:15]
    v_mul_f32_dpp v196, v242, v80 row_newbcast:0 row_mask:0xf bank_mask:0xf
    v_mul_f32_dpp v197, v242, v81 row_newbcast:1 row_mask:0xf bank_mask:0xf
    v_mul_f32_dpp v198, v242, v80 row_newbcast:8 row_mask:0xf bank_mask:0xf
    v_mul_f32_dpp v199, v242, v81 row_newbcast:9 row_mask:0xf bank_mask:0xf
    v_mul_f32_dpp v200, v242, v84 row_newbcast:2 row_mask:0xf bank_mask:0xf
    v_mul_f32_dpp v201, v242, v85 row_newbcast:3 row_mask:0xf bank_mask:0xf
    v_mul_f32_dpp v202, v242, v84 row_newbcast:10 row_mask:0xf bank_mask:0xf
    v_mul_f32_dpp v203, v242, v85 row_newbcast:11 row_mask:0xf bank_mask:0xf
    v_cvt_pk_bf16_f32 v80, v196, v197
    v_cvt_pk_bf16_f32 v84, v198, v199
    v_cvt_pk_bf16_f32 v81, v200, v201
    v_cvt_pk_bf16_f32 v85, v202, v203
    s_add_u32 m0, s21, 2048
    v_mfma_f32_32x32x16_bf16 v[16:31], v[76:79], v[176:179], v[16:31]
    buffer_load_dwordx4 v238, s[4:7], s35 offen lds
    buffer_load_dwordx4 v239, s[8:11], s35 offen offset:1024 lds
    ds_read_b64_tr_b16 v[176:177], v244 offset:4096
    ds_read_b64_tr_b16 v[178:179], v244 offset:5120
    ds_read_b64_tr_b16 v[188:189], v245 offset:4096
    ds_read_b64_tr_b16 v[190:191], v245 offset:5120
    v_mul_f32_dpp v196, v242, v82 row_newbcast:4 row_mask:0xf bank_mask:0xf
    v_mul_f32_dpp v197, v242, v83 row_newbcast:5 row_mask:0xf bank_mask:0xf
    v_mul_f32_dpp v198, v242, v82 row_newbcast:12 row_mask:0xf bank_mask:0xf
    v_mul_f32_dpp v199, v242, v83 row_newbcast:13 row_mask:0xf bank_mask:0xf
    v_mul_f32_dpp v200, v242, v86 row_newbcast:6 row_mask:0xf bank_mask:0xf
    v_mul_f32_dpp v201, v242, v87 row_newbcast:7 row_mask:0xf bank_mask:0xf
    v_mul_f32_dpp v202, v242, v86 row_newbcast:14 row_mask:0xf bank_mask:0xf
    v_mul_f32_dpp v203, v242, v87 row_newbcast:15 row_mask:0xf bank_mask:0xf
    v_cvt_pk_bf16_f32 v82, v196, v197
    v_cvt_pk_bf16_f32 v86, v198, v199
    v_cvt_pk_bf16_f32 v83, v200, v201
    v_cvt_pk_bf16_f32 v87, v202, v203
    s_nop 0
    s_waitcnt lgkmcnt(0)
    v_mfma_f32_32x32x16_bf16 v[0:15], v[80:83], v[176:179], v[0:15]
    s_add_u32 m0, s21, 4096
    v_mfma_f32_32x32x16_bf16 v[16:31], v[84:87], v[176:179], v[16:31]
    buffer_load_dwordx4 v234, s[4:7], s36 offen lds
    buffer_load_dwordx4 v235, s[8:11], s36 offen offset:1024 lds
    s_mov_b32 m0, s50
    s_nop 0
    s_movrels_b32 s71, s23
    s_bfe_u32 s46, s71, 0x30012
    s_mov_b32 m0, s46
    s_and_b32 s66, s71, 0x3ffff
    s_movrels_b32 s68, s57
    s_movrels_b32 s69, s61
    s_sub_u32 s48, s66, s47
    s_mov_b32 s47, s66
    s_lshr_b32 s52, s71, 28
    s_lshl_b32 s67, s46, 9
    s_add_u32 s66, s66, s67
    s_sub_u32 s49, s66, s42
    s_mov_b32 s42, s66
    s_bfe_u32 s66, s68, 655360
    s_add_u32 s43, s42, s66
    s_bfe_u32 s39, s69, 655360
    s_bfe_u32 s66, s68, 655370
    s_add_u32 s44, s42, s66
    s_bfe_u32 s40, s69, 655370
    s_bfe_u32 s66, s68, 655380
    s_add_u32 s45, s42, s66
    s_bfe_u32 s41, s69, 655380
    s_and_b32 s66, s46, s33
    s_cselect_b32 s72, -1, 1
    s_cselect_b32 s76, s47, 163712
    s_cmp_ge_u32 s66, 2
    s_cselect_b32 s73, -1, 0
    s_add_u32 s77, s47, 1024
    s_cmp_ge_u32 s66, 4
    s_cselect_b32 s75, -1, 0
    s_cmp_ge_u32 s66, 3
    s_cselect_b32 s74, -1, 1
    s_cselect_b32 s77, s77, 163712
    v_add_u32 v252, s45, v247
    ds_read_u16 v240, v252
    ds_read_u16 v241, v252 offset:64
    v_mfma_f32_32x32x16_bf16 v[32:47], v[64:67], v[180:183], 0
    v_mul_f32 v196, v0, v96
    v_fmac_f32 v196, v1, v97
    v_fmac_f32 v196, v2, v98
    v_fmac_f32 v196, v3, v99
    v_fmac_f32 v196, v4, v100
    v_fmac_f32 v196, v5, v101
    v_fmac_f32 v196, v6, v102
    v_mfma_f32_32x32x16_bf16 v[48:63], v[68:71], v[180:183], 0
    v_add_u32 v253, s47, v248
    ds_read_b32 v254, v253
    ds_read_b32 v255, v253 offset:256
    v_fmac_f32 v196, v7, v103
    v_mul_f32 v198, v8, v128
    v_fmac_f32 v198, v9, v129
    v_fmac_f32 v198, v10, v130
    v_fmac_f32 v198, v11, v131
    v_fmac_f32 v198, v12, v132
    v_mfma_f32_32x32x16_bf16 v[32:47], v[72:75], v[184:187], v[32:47]
    v_fmac_f32 v198, v13, v133
    v_fmac_f32 v198, v14, v134
    v_fmac_f32 v198, v15, v135
    v_mul_f32 v200, v16, v128
    v_fmac_f32 v200, v17, v129
    v_permlane32_swap_b32 v196, v198
    v_mfma_f32_32x32x16_bf16 v[48:63], v[76:79], v[184:187], v[48:63]
    s_waitcnt vmcnt(6)
    ds_read_b64_tr_b16 v[176:177], v244 offset:6144
    ds_read_b64_tr_b16 v[178:179], v244 offset:7168
    ds_read_b64_tr_b16 v[180:181], v245 offset:6144
    ds_read_b64_tr_b16 v[182:183], v245 offset:7168
    v_fmac_f32 v200, v18, v130
    v_fmac_f32 v200, v19, v131
    v_fmac_f32 v200, v20, v132
    v_fmac_f32 v200, v21, v133
    v_fmac_f32 v200, v22, v134
    v_fmac_f32 v200, v23, v135
    v_mfma_f32_32x32x16_bf16 v[32:47], v[80:83], v[188:191], v[32:47]
    v_add_f32 v198, v196, v198
    v_mul_f32_e64 v202, v24, -v128
    v_fma_f32 v202, v25, -v129, v202
    v_fma_f32 v202, v26, -v130, v202
    v_fma_f32 v202, v27, -v131, v202
    v_fma_f32 v202, v28, -v132, v202
    v_mfma_f32_32x32x16_bf16 v[48:63], v[84:87], v[188:191], v[48:63]
    v_fma_f32 v202, v29, -v133, v202
    v_fma_f32 v202, v30, -v134, v202
    v_fma_f32 v202, v31, -v135, v202
    s_nop 1
    v_permlane32_swap_b32 v200, v202
    v_add_f32 v202, v200, v202
    s_waitcnt vmcnt(4) lgkmcnt(0)
    v_mfma_f32_32x32x16_bf16 v[0:15], v[64:67], v[176:179], 0
    v_mul_f32 v197, v32, v104
    v_fmac_f32 v197, v33, v105
    v_fmac_f32 v197, v34, v106
    v_fmac_f32 v197, v35, v107
    v_fmac_f32 v197, v36, v108
    v_fmac_f32 v197, v37, v109
    v_fmac_f32 v197, v38, v110
    s_add_u32 m0, s21, 6144
    v_mfma_f32_32x32x16_bf16 v[16:31], v[68:71], v[176:179], 0
    buffer_load_dwordx4 v236, s[4:7], s36 offen lds
    buffer_load_dwordx4 v237, s[8:11], s36 offen offset:1024 lds
    ds_read_b64_tr_b16 v[176:177], v244 offset:0
    ds_read_b64_tr_b16 v[178:179], v244 offset:1024
    ds_read_b64_tr_b16 v[184:185], v245 offset:0
    ds_read_b64_tr_b16 v[186:187], v245 offset:1024
    s_mov_b32 m0, s76
    s_mov_b64 exec, s[72:73]
    buffer_load_dwordx4 v254, s[12:15], 0 offen  lds
    s_mov_b32 m0, s77
    s_mov_b64 exec, s[74:75]
    buffer_load_dwordx4 v255, s[12:15], 0 offen  lds
    s_mov_b64 exec, -1
    v_fmac_f32 v197, v39, v111
    v_mul_f32 v199, v40, v136
    v_fmac_f32 v199, v41, v137
    v_fmac_f32 v199, v42, v138
    v_fmac_f32 v199, v43, v139
    v_fmac_f32 v199, v44, v140
    v_fmac_f32 v199, v45, v141
    s_waitcnt vmcnt(6) lgkmcnt(0)
    v_mfma_f32_32x32x16_bf16 v[0:15], v[72:75], v[176:179], v[0:15]
    v_fmac_f32 v199, v46, v142
    v_fmac_f32 v199, v47, v143
    v_mul_f32 v201, v48, v136
    v_fmac_f32 v201, v49, v137
    v_permlane32_swap_b32 v197, v199
    v_fmac_f32 v201, v50, v138
    v_fmac_f32 v201, v51, v139
    s_add_u32 m0, s21, 0
    v_mfma_f32_32x32x16_bf16 v[16:31], v[76:79], v[176:179], v[16:31]
    buffer_load_dwordx4 v238, s[4:7], s36 offen lds
    buffer_load_dwordx4 v239, s[8:11], s36 offen offset:1024 lds
    ds_read_b64_tr_b16 v[176:177], v244 offset:2048
    ds_read_b64_tr_b16 v[178:179], v244 offset:3072
    ds_read_b64_tr_b16 v[188:189], v245 offset:2048
    ds_read_b64_tr_b16 v[190:191], v245 offset:3072
    v_fmac_f32 v201, v52, v140
    v_fmac_f32 v201, v53, v141
    v_fmac_f32 v201, v54, v142
    v_fmac_f32 v201, v55, v143
    v_add_f32 v199, v197, v199
    v_mul_f32_e64 v203, v56, -v136
    v_fma_f32 v203, v57, -v137, v203
    s_waitcnt lgkmcnt(0)
    v_mfma_f32_32x32x16_bf16 v[0:15], v[80:83], v[176:179], v[0:15]
    v_fma_f32 v203, v58, -v138, v203
    v_fma_f32 v203, v59, -v139, v203
    v_fma_f32 v203, v60, -v140, v203
    v_fma_f32 v203, v61, -v141, v203
    v_fma_f32 v203, v62, -v142, v203
    v_fma_f32 v203, v63, -v143, v203
    s_nop 1
    s_add_u32 m0, s21, 2048
    v_mfma_f32_32x32x16_bf16 v[16:31], v[84:87], v[176:179], v[16:31]
    buffer_load_dwordx4 v234, s[4:7], s37 offen lds
    buffer_load_dwordx4 v235, s[8:11], s37 offen offset:1024 lds
    v_add_u32 v252, s42, v247
    ds_read_u16 v234, v252
    ds_read_u16 v235, v252 offset:64
    v_permlane32_swap_b32 v201, v203
    v_add_f32 v203, v201, v203
    s_set_gpr_idx_on s51, gpr_idx(DST)
    s_nop 0
    v_cvt_pk_bf16_f32 v204, v198, v199
    v_cvt_pk_bf16_f32 v205, v202, v203
    s_set_gpr_idx_off
    v_mfma_f32_32x32x16_bf16 v[32:47], v[64:67], v[180:183], 0
    v_mul_f32 v196, v0, v144
    v_fmac_f32 v196, v1, v145
    v_fmac_f32 v196, v2, v146
    v_fmac_f32 v196, v3, v147
    v_fmac_f32 v196, v4, v148
    v_fmac_f32 v196, v5, v149
    v_mfma_f32_32x32x16_bf16 v[48:63], v[68:71], v[180:183], 0
    v_fmac_f32 v196, v6, v150
    v_fmac_f32 v196, v7, v151
    v_mul_f32 v198, v8, v112
    v_fmac_f32 v198, v9, v113
    v_fmac_f32 v198, v10, v114
    v_mfma_f32_32x32x16_bf16 v[32:47], v[72:75], v[184:187], v[32:47]
    v_fmac_f32 v198, v11, v115
    v_fmac_f32 v198, v12, v116
    v_fmac_f32 v198, v13, v117
    v_fmac_f32 v198, v14, v118
    v_fmac_f32 v198, v15, v119
    v_mfma_f32_32x32x16_bf16 v[48:63], v[76:79], v[184:187], v[48:63]
    s_waitcnt vmcnt(8)
    ds_read_b64_tr_b16 v[176:177], v244 offset:4096
    ds_read_b64_tr_b16 v[178:179], v244 offset:5120
    ds_read_b64_tr_b16 v[180:181], v245 offset:4096
    ds_read_b64_tr_b16 v[182:183], v245 offset:5120
    v_mul_f32_e64 v200, v16, -v160
    v_fma_f32 v200, v17, -v161, v200
    v_fma_f32 v200, v18, -v162, v200
    v_fma_f32 v200, v19, -v163, v200
    v_fma_f32 v200, v20, -v164, v200
    v_fma_f32 v200, v21, -v165, v200
    v_mfma_f32_32x32x16_bf16 v[32:47], v[80:83], v[188:191], v[32:47]
    v_fma_f32 v200, v22, -v166, v200
    v_fma_f32 v200, v23, -v167, v200
    v_mul_f32_e64 v202, v24, -v160
    v_fma_f32 v202, v25, -v161, v202
    v_fma_f32 v202, v26, -v162, v202
    v_mfma_f32_32x32x16_bf16 v[48:63], v[84:87], v[188:191], v[48:63]
    v_fma_f32 v202, v27, -v163, v202
    v_fma_f32 v202, v28, -v164, v202
    v_fma_f32 v202, v29, -v165, v202
    v_fma_f32 v202, v30, -v166, v202
    v_fma_f32 v202, v31, -v167, v202
    s_waitcnt vmcnt(6) lgkmcnt(0)
    v_mfma_f32_32x32x16_bf16 v[0:15], v[64:67], v[176:179], 0
    v_mul_f32 v197, v32, v152
    v_fmac_f32 v197, v33, v153
    v_fmac_f32 v197, v34, v154
    v_fmac_f32 v197, v35, v155
    v_fmac_f32 v197, v36, v156
    v_fmac_f32 v197, v37, v157
    s_add_u32 m0, s21, 4096
    v_mfma_f32_32x32x16_bf16 v[16:31], v[68:71], v[176:179], 0
    buffer_load_dwordx4 v236, s[4:7], s37 offen lds
    buffer_load_dwordx4 v237, s[8:11], s37 offen offset:1024 lds
    ds_read_b64_tr_b16 v[176:177], v244 offset:6144
    ds_read_b64_tr_b16 v[178:179], v244 offset:7168
    ds_read_b64_tr_b16 v[184:185], v245 offset:6144
    ds_read_b64_tr_b16 v[186:187], v245 offset:7168
    v_add_u32 v252, s43, v247
    ds_read_u16 v236, v252
    ds_read_u16 v237, v252 offset:64
    v_fmac_f32 v197, v38, v158
    v_fmac_f32 v197, v39, v159
    v_mul_f32 v199, v40, v120
    v_fmac_f32 v199, v41, v121
    v_fmac_f32 v199, v42, v122
    s_waitcnt vmcnt(4) lgkmcnt(2)
    v_mfma_f32_32x32x16_bf16 v[0:15], v[72:75], v[176:179], v[0:15]
    v_fmac_f32 v199, v43, v123
    v_fmac_f32 v199, v44, v124
    v_fmac_f32 v199, v45, v125
    v_fmac_f32 v199, v46, v126
    v_fmac_f32 v199, v47, v127
    s_add_u32 m0, s21, 6144
    v_mfma_f32_32x32x16_bf16 v[16:31], v[76:79], v[176:179], v[16:31]
    buffer_load_dwordx4 v238, s[4:7], s37 offen lds
    buffer_load_dwordx4 v239, s[8:11], s37 offen offset:1024 lds
    ds_read_b64_tr_b16 v[176:177], v244 offset:0
    ds_read_b64_tr_b16 v[178:179], v244 offset:1024
    ds_read_b64_tr_b16 v[188:189], v245 offset:0
    ds_read_b64_tr_b16 v[190:191], v245 offset:1024
    v_add_u32 v252, s44, v247
    ds_read_u16 v238, v252
    ds_read_u16 v239, v252 offset:64
    v_mul_f32_e64 v201, v48, -v168
    v_fma_f32 v201, v49, -v169, v201
    v_fma_f32 v201, v50, -v170, v201
    v_fma_f32 v201, v51, -v171, v201
    v_fma_f32 v201, v52, -v172, v201
    v_fma_f32 v201, v53, -v173, v201
    s_waitcnt lgkmcnt(2)
    v_mfma_f32_32x32x16_bf16 v[0:15], v[80:83], v[176:179], v[0:15]
    v_fma_f32 v201, v54, -v174, v201
    v_fma_f32 v201, v55, -v175, v201
    v_mul_f32_e64 v203, v56, -v168
    v_fma_f32 v203, v57, -v169, v203
    v_fma_f32 v203, v58, -v170, v203
    s_add_u32 m0, s21, 0
    v_mfma_f32_32x32x16_bf16 v[16:31], v[84:87], v[176:179], v[16:31]
    v_lshl_add_u32 v234, v234, 10, v246
    v_lshl_add_u32 v235, v235, 10, v246
    buffer_load_dwordx4 v234, s[4:7], s38 offen lds
    buffer_load_dwordx4 v235, s[8:11], s38 offen offset:1024 lds
    v_fma_f32 v203, v59, -v171, v203
    v_fma_f32 v203, v60, -v172, v203
    v_fma_f32 v203, v61, -v173, v203
    v_fma_f32 v203, v62, -v174, v203
    v_fma_f32 v203, v63, -v175, v203
    v_mfma_f32_32x32x16_bf16 v[32:47], v[64:67], v[180:183], 0
    v_mul_f32 v254, v0, v144
    v_fmac_f32 v254, v1, v145
    v_fmac_f32 v254, v2, v146
    v_mfma_f32_32x32x16_bf16 v[48:63], v[68:71], v[180:183], 0
    ds_swizzle_b32 v68, v68 offset:0x401F
    ds_swizzle_b32 v69, v69 offset:0x401F
    ds_swizzle_b32 v70, v70 offset:0x401F
    ds_swizzle_b32 v71, v71 offset:0x401F
    v_fmac_f32 v254, v3, v147
    v_fmac_f32 v254, v4, v148
    v_fmac_f32 v254, v5, v149
    v_mfma_f32_32x32x16_bf16 v[32:47], v[72:75], v[184:187], v[32:47]
    v_fmac_f32 v254, v6, v150
    v_fmac_f32 v254, v7, v151
    v_fmac_f32 v200, v8, v160
    v_mfma_f32_32x32x16_bf16 v[48:63], v[76:79], v[184:187], v[48:63]
    ds_swizzle_b32 v76, v76 offset:0x401F
    ds_swizzle_b32 v77, v77 offset:0x401F
    ds_swizzle_b32 v78, v78 offset:0x401F
    ds_swizzle_b32 v79, v79 offset:0x401F
    s_waitcnt vmcnt(6)
    ds_read_b64_tr_b16 v[176:177], v244 offset:2048
    ds_read_b64_tr_b16 v[178:179], v244 offset:3072
    ds_read_b64_tr_b16 v[180:181], v245 offset:2048
    ds_read_b64_tr_b16 v[182:183], v245 offset:3072
    v_fmac_f32 v200, v9, v161
    v_permlane32_swap_b32 v196, v254
    v_fmac_f32 v200, v10, v162
    v_mfma_f32_32x32x16_bf16 v[32:47], v[80:83], v[188:191], v[32:47]
    v_fmac_f32 v200, v11, v163
    v_fmac_f32 v200, v12, v164
    v_fmac_f32 v200, v13, v165
    v_mfma_f32_32x32x16_bf16 v[48:63], v[84:87], v[188:191], v[48:63]
    ds_swizzle_b32 v84, v84 offset:0x401F
    ds_swizzle_b32 v85, v85 offset:0x401F
    ds_swizzle_b32 v86, v86 offset:0x401F
    ds_swizzle_b32 v87, v87 offset:0x401F
    v_fmac_f32 v200, v14, v166
    v_fmac_f32 v200, v15, v167
    v_add_f32 v254, v196, v254
    s_waitcnt lgkmcnt(8)
    s_mov_b64 exec, s[56:57]
    v_xor_b32 v68, 0x80008000, v68
    v_xor_b32 v69, 0x80008000, v69
    v_xor_b32 v70, 0x80008000, v70
    v_xor_b32 v71, 0x80008000, v71
    v_xor_b32 v76, 0x80008000, v76
    v_xor_b32 v77, 0x80008000, v77
    v_xor_b32 v78, 0x80008000, v78
    v_xor_b32 v79, 0x80008000, v79
    s_mov_b64 exec, -1
    s_waitcnt vmcnt(4) lgkmcnt(4)
    v_mfma_f32_32x32x16_bf16 v[0:15], v[64:67], v[176:179], 0
    v_mul_f32 v255, v32, v152
    v_fmac_f32 v255, v33, v153
    v_fmac_f32 v255, v34, v154
    v_fmac_f32 v255, v35, v155
    s_add_u32 m0, s21, 2048
    v_mfma_f32_32x32x16_bf16 v[16:31], v[68:71], v[176:179], v[16:31]
    v_lshl_add_u32 v236, v236, 10, v246
    v_lshl_add_u32 v237, v237, 10, v246
    buffer_load_dwordx4 v236, s[4:7], s39 offen lds
    buffer_load_dwordx4 v237, s[8:11], s39 offen offset:1024 lds
    ds_read_b64_tr_b16 v[176:177], v244 offset:4096
    ds_read_b64_tr_b16 v[178:179], v244 offset:5120
    ds_read_b64_tr_b16 v[184:185], v245 offset:4096
    ds_read_b64_tr_b16 v[186:187], v245 offset:5120
    v_fmac_f32 v255, v36, v156
    v_fmac_f32 v255, v37, v157
    v_fmac_f32 v255, v38, v158
    v_fmac_f32 v255, v39, v159
    s_waitcnt vmcnt(4) lgkmcnt(0)
    v_mfma_f32_32x32x16_bf16 v[0:15], v[72:75], v[176:179], v[0:15]
    v_fmac_f32 v201, v40, v168
    v_fmac_f32 v201, v41, v169
    v_permlane32_swap_b32 v197, v255
    s_add_u32 m0, s21, 4096
    v_mfma_f32_32x32x16_bf16 v[16:31], v[76:79], v[176:179], v[16:31]
    v_lshl_add_u32 v238, v238, 10, v246
    v_lshl_add_u32 v239, v239, 10, v246
    buffer_load_dwordx4 v238, s[4:7], s40 offen lds
    buffer_load_dwordx4 v239, s[8:11], s40 offen offset:1024 lds
    ds_read_b64_tr_b16 v[176:177], v244 offset:6144
    ds_read_b64_tr_b16 v[178:179], v244 offset:7168
    ds_read_b64_tr_b16 v[188:189], v245 offset:6144
    ds_read_b64_tr_b16 v[190:191], v245 offset:7168
    v_fmac_f32 v201, v42, v170
    v_fmac_f32 v201, v43, v171
    v_fmac_f32 v201, v44, v172
    v_fmac_f32 v201, v45, v173
    s_waitcnt lgkmcnt(0)
    s_mov_b64 exec, s[56:57]
    v_xor_b32 v84, 0x80008000, v84
    v_xor_b32 v85, 0x80008000, v85
    v_xor_b32 v86, 0x80008000, v86
    v_xor_b32 v87, 0x80008000, v87
    s_mov_b64 exec, -1
    v_mfma_f32_32x32x16_bf16 v[0:15], v[80:83], v[176:179], v[0:15]
    v_fmac_f32 v201, v46, v174
    v_fmac_f32 v201, v47, v175
    v_add_f32 v255, v197, v255
    s_set_gpr_idx_on s51, gpr_idx(DST)
    s_nop 0
    v_cvt_pk_bf16_f32 v206, v254, v255
    s_set_gpr_idx_off
    s_add_u32 m0, s21, 6144
    v_mfma_f32_32x32x16_bf16 v[16:31], v[84:87], v[176:179], v[16:31]
    v_lshl_add_u32 v240, v240, 10, v246
    v_lshl_add_u32 v241, v241, 10, v246
    buffer_load_dwordx4 v240, s[4:7], s41 offen lds
    buffer_load_dwordx4 v241, s[8:11], s41 offen offset:1024 lds
    v_mfma_f32_32x32x16_bf16 v[32:47], v[64:67], v[180:183], 0
    v_mul_f32 v254, v0, v144
    v_fmac_f32 v254, v1, v145
    v_fmac_f32 v254, v2, v146
    v_fmac_f32 v254, v3, v147
    v_fmac_f32 v254, v4, v148
    v_fmac_f32 v254, v5, v149
    v_fmac_f32 v254, v6, v150
    v_mfma_f32_32x32x16_bf16 v[48:63], v[68:71], v[180:183], v[48:63]
    v_fmac_f32 v254, v7, v151
    v_fma_f32 v202, v8, -v160, v202
    v_fma_f32 v202, v9, -v161, v202
    v_permlane32_swap_b32 v254, v200
    v_fma_f32 v202, v10, -v162, v202
    v_fma_f32 v202, v11, -v163, v202
    v_mfma_f32_32x32x16_bf16 v[32:47], v[72:75], v[184:187], v[32:47]
    v_fma_f32 v202, v12, -v164, v202
    v_fma_f32 v202, v13, -v165, v202
    v_fma_f32 v202, v14, -v166, v202
    v_fma_f32 v202, v15, -v167, v202
    v_add_f32 v200, v254, v200
    v_fmac_f32 v198, v16, v112
    v_permlane32_swap_b32 v202, v254
    v_mfma_f32_32x32x16_bf16 v[48:63], v[76:79], v[184:187], v[48:63]
    s_waitcnt vmcnt(6)
    ds_read_b64_tr_b16 v[176:177], v244 offset:0
    ds_read_b64_tr_b16 v[178:179], v244 offset:1024
    ds_read_b64_tr_b16 v[180:181], v245 offset:0
    ds_read_b64_tr_b16 v[182:183], v245 offset:1024
    v_fmac_f32 v198, v17, v113
    v_fmac_f32 v198, v18, v114
    v_fmac_f32 v198, v19, v115
    v_fmac_f32 v198, v20, v116
    v_fmac_f32 v198, v21, v117
    v_fmac_f32 v198, v22, v118
    v_mfma_f32_32x32x16_bf16 v[32:47], v[80:83], v[188:191], v[32:47]
    v_fmac_f32 v198, v23, v119
    v_add_f32 v254, v202, v254
    v_mul_f32 v196, v24, v160
    v_fmac_f32 v196, v25, v161
    v_fmac_f32 v196, v26, v162
    v_fmac_f32 v196, v27, v163
    v_fmac_f32 v196, v28, v164
    v_mfma_f32_32x32x16_bf16 v[48:63], v[84:87], v[188:191], v[48:63]
    v_add_u32 v249, s48, v249
    v_add_u32 v250, s49, v250
    ds_read_b32 v252, v251 offset:16
    ds_read_b64_tr_b16 v[64:65], v249 offset:0
    ds_read_b64_tr_b16 v[68:69], v249 offset:64
    ds_read_b64_tr_b16 v[66:67], v249 offset:256
    ds_read_b64_tr_b16 v[70:71], v249 offset:320
    s_mov_b64 exec, s[54:55]
    ds_read_u16_d16_hi v242, v250 offset:0
    s_mov_b64 exec, -1
    v_fmac_f32 v196, v29, v165
    v_fmac_f32 v196, v30, v166
    v_fmac_f32 v196, v31, v167
    s_nop 1
    v_permlane32_swap_b32 v198, v196
    v_add_f32 v196, v198, v196
    v_mul_f32 v255, v32, v152
    v_fmac_f32 v255, v33, v153
    v_fmac_f32 v255, v34, v154
    v_fmac_f32 v255, v35, v155
    v_fmac_f32 v255, v36, v156
    v_fmac_f32 v255, v37, v157
    v_fmac_f32 v255, v38, v158
    v_fmac_f32 v255, v39, v159
    v_fma_f32 v203, v40, -v168, v203
    v_fma_f32 v203, v41, -v169, v203
    v_permlane32_swap_b32 v255, v201
    v_fma_f32 v203, v42, -v170, v203
    v_fma_f32 v203, v43, -v171, v203
    v_fma_f32 v203, v44, -v172, v203
    v_fma_f32 v203, v45, -v173, v203
    v_fma_f32 v203, v46, -v174, v203
    v_fma_f32 v203, v47, -v175, v203
    v_add_f32 v201, v255, v201
    v_fmac_f32 v199, v48, v120
    v_permlane32_swap_b32 v203, v255
    v_fmac_f32 v199, v49, v121
    v_fmac_f32 v199, v50, v122
    v_fmac_f32 v199, v51, v123
    v_fmac_f32 v199, v52, v124
    v_fmac_f32 v199, v53, v125
    v_fmac_f32 v199, v54, v126
    v_fmac_f32 v199, v55, v127
    v_add_f32 v255, v203, v255
    v_mul_f32 v197, v56, v168
    v_fmac_f32 v197, v57, v169
    v_fmac_f32 v197, v58, v170
    v_fmac_f32 v197, v59, v171
    v_fmac_f32 v197, v60, v172
    v_fmac_f32 v197, v61, v173
    v_fmac_f32 v197, v62, v174
    v_fmac_f32 v197, v63, v175
    s_nop 1
    v_permlane32_swap_b32 v199, v197
    v_add_f32 v197, v199, v197
    s_set_gpr_idx_on s51, gpr_idx(DST)
    s_nop 0
    v_cvt_pk_bf16_f32 v207, v200, v201
    v_cvt_pk_bf16_f32 v209, v254, v255
    v_cvt_pk_bf16_f32 v208, v196, v197
    s_set_gpr_idx_off
    s_add_u32 s50, s50, 1
    s_add_u32 s51, s51, 6
    s_cmp_ge_u32 s50, 4
    s_cbranch_scc1 LAST0
    s_waitcnt lgkmcnt(5)
    v_readfirstlane_b32 s66, v252
    s_add_u32 s53, s53, 1
    v_mov_b32 v252, s53
    s_cmp_le_u32 s53, s66
    ds_write2_b32 v251, v252, v252 offset0:0 offset1:8
    s_setprio 1
    s_cbranch_scc1 PRIO_8
    s_setprio 0
PRIO_8:
    s_cmp_eq_u32 s52, 4
    s_cbranch_scc1 ITEM_0_4
    s_cmp_eq_u32 s52, 5
    s_cbranch_scc1 ITEM_0_5
    s_cmp_eq_u32 s52, 3
    s_cbranch_scc1 ITEM_0_3
    s_cmp_eq_u32 s52, 6
    s_cbranch_scc1 ITEM_0_6
    s_cmp_eq_u32 s52, 8
    s_cbranch_scc1 ITEM_0_8
    s_branch ITEM_0_2
.p2align 6
ITEM_0_8:
    s_mov_b64 exec, s[54:55]
    ds_read_u16_d16_hi v243, v250 offset:128
    s_mov_b64 exec, -1
    ds_read_b64_tr_b16 v[72:73], v249 offset:512
    ds_read_b64_tr_b16 v[76:77], v249 offset:576
    ds_read_b64_tr_b16 v[74:75], v249 offset:768
    ds_read_b64_tr_b16 v[78:79], v249 offset:832
    ds_read_b64_tr_b16 v[80:81], v249 offset:1024
    ds_read_b64_tr_b16 v[84:85], v249 offset:1088
    ds_read_b64_tr_b16 v[82:83], v249 offset:1280
    ds_read_b64_tr_b16 v[86:87], v249 offset:1344
    ds_read_b64_tr_b16 v[88:89], v249 offset:1536
    ds_read_b64_tr_b16 v[92:93], v249 offset:1600
    ds_read_b64_tr_b16 v[90:91], v249 offset:1792
    ds_read_b64_tr_b16 v[94:95], v249 offset:1856
    s_waitcnt lgkmcnt(13)
    v_mul_f32_dpp v196, v242, v64 row_newbcast:0 row_mask:0xf bank_mask:0xf
    v_mul_f32_dpp v197, v242, v65 row_newbcast:1 row_mask:0xf bank_mask:0xf
    v_mul_f32_dpp v198, v242, v64 row_newbcast:8 row_mask:0xf bank_mask:0xf
    v_mul_f32_dpp v199, v242, v65 row_newbcast:9 row_mask:0xf bank_mask:0xf
    v_mul_f32_dpp v200, v242, v68 row_newbcast:2 row_mask:0xf bank_mask:0xf
    v_mul_f32_dpp v201, v242, v69 row_newbcast:3 row_mask:0xf bank_mask:0xf
    v_mul_f32_dpp v202, v242, v68 row_newbcast:10 row_mask:0xf bank_mask:0xf
    v_mul_f32_dpp v203, v242, v69 row_newbcast:11 row_mask:0xf bank_mask:0xf
    v_cvt_pk_bf16_f32 v64, v196, v197
    v_cvt_pk_bf16_f32 v68, v198, v199
    v_cvt_pk_bf16_f32 v65, v200, v201
    v_cvt_pk_bf16_f32 v69, v202, v203
    v_mul_f32_dpp v196, v242, v66 row_newbcast:4 row_mask:0xf bank_mask:0xf
    v_mul_f32_dpp v197, v242, v67 row_newbcast:5 row_mask:0xf bank_mask:0xf
    v_mul_f32_dpp v198, v242, v66 row_newbcast:12 row_mask:0xf bank_mask:0xf
    v_mul_f32_dpp v199, v242, v67 row_newbcast:13 row_mask:0xf bank_mask:0xf
    v_mul_f32_dpp v200, v242, v70 row_newbcast:6 row_mask:0xf bank_mask:0xf
    v_mul_f32_dpp v201, v242, v71 row_newbcast:7 row_mask:0xf bank_mask:0xf
    v_mul_f32_dpp v202, v242, v70 row_newbcast:14 row_mask:0xf bank_mask:0xf
    v_mul_f32_dpp v203, v242, v71 row_newbcast:15 row_mask:0xf bank_mask:0xf
    v_cvt_pk_bf16_f32 v66, v196, v197
    v_cvt_pk_bf16_f32 v70, v198, v199
    v_cvt_pk_bf16_f32 v67, v200, v201
    v_cvt_pk_bf16_f32 v71, v202, v203
    s_mov_b64 exec, s[54:55]
    ds_read_u16_d16_hi v242, v250 offset:256
    s_mov_b64 exec, -1
    s_waitcnt vmcnt(4) lgkmcnt(9)
    v_mfma_f32_32x32x16_bf16 v[0:15], v[64:67], v[176:179], 0
    v_mul_f32_dpp v196, v243, v72 row_newbcast:0 row_mask:0xf bank_mask:0xf
    v_mul_f32_dpp v197, v243, v73 row_newbcast:1 row_mask:0xf bank_mask:0xf
    v_mul_f32_dpp v198, v243, v72 row_newbcast:8 row_mask:0xf bank_mask:0xf
    v_mul_f32_dpp v199, v243, v73 row_newbcast:9 row_mask:0xf bank_mask:0xf
    v_mul_f32_dpp v200, v243, v76 row_newbcast:2 row_mask:0xf bank_mask:0xf
    v_mul_f32_dpp v201, v243, v77 row_newbcast:3 row_mask:0xf bank_mask:0xf
    v_mul_f32_dpp v202, v243, v76 row_newbcast:10 row_mask:0xf bank_mask:0xf
    v_mul_f32_dpp v203, v243, v77 row_newbcast:11 row_mask:0xf bank_mask:0xf
    v_cvt_pk_bf16_f32 v72, v196, v197
    v_cvt_pk_bf16_f32 v76, v198, v199
    v_cvt_pk_bf16_f32 v73, v200, v201
    v_cvt_pk_bf16_f32 v77, v202, v203
    s_add_u32 m0, s21, 0
    v_mfma_f32_32x32x16_bf16 v[16:31], v[68:71], v[176:179], 0
    buffer_load_dwordx4 v234, s[4:7], s35 offen lds
    buffer_load_dwordx4 v235, s[8:11], s35 offen offset:1024 lds
    ds_read_b64_tr_b16 v[176:177], v244 offset:2048
    ds_read_b64_tr_b16 v[178:179], v244 offset:3072
    ds_read_b64_tr_b16 v[184:185], v245 offset:2048
    ds_read_b64_tr_b16 v[186:187], v245 offset:3072
    v_mul_f32_dpp v196, v243, v74 row_newbcast:4 row_mask:0xf bank_mask:0xf
    v_mul_f32_dpp v197, v243, v75 row_newbcast:5 row_mask:0xf bank_mask:0xf
    v_mul_f32_dpp v198, v243, v74 row_newbcast:12 row_mask:0xf bank_mask:0xf
    v_mul_f32_dpp v199, v243, v75 row_newbcast:13 row_mask:0xf bank_mask:0xf
    v_mul_f32_dpp v200, v243, v78 row_newbcast:6 row_mask:0xf bank_mask:0xf
    v_mul_f32_dpp v201, v243, v79 row_newbcast:7 row_mask:0xf bank_mask:0xf
    v_mul_f32_dpp v202, v243, v78 row_newbcast:14 row_mask:0xf bank_mask:0xf
    v_mul_f32_dpp v203, v243, v79 row_newbcast:15 row_mask:0xf bank_mask:0xf
    v_cvt_pk_bf16_f32 v74, v196, v197
    v_cvt_pk_bf16_f32 v78, v198, v199
    v_cvt_pk_bf16_f32 v75, v200, v201
    v_cvt_pk_bf16_f32 v79, v202, v203
    s_mov_b64 exec, s[54:55]
    ds_read_u16_d16_hi v243, v250 offset:384
    s_mov_b64 exec, -1
    s_waitcnt vmcnt(4) lgkmcnt(1)
    v_mfma_f32_32x32x16_bf16 v[0:15], v[72:75], v[176:179], v[0:15]
    v_mul_f32_dpp v196, v242, v80 row_newbcast:0 row_mask:0xf bank_mask:0xf
    v_mul_f32_dpp v197, v242, v81 row_newbcast:1 row_mask:0xf bank_mask:0xf
    v_mul_f32_dpp v198, v242, v80 row_newbcast:8 row_mask:0xf bank_mask:0xf
    v_mul_f32_dpp v199, v242, v81 row_newbcast:9 row_mask:0xf bank_mask:0xf
    v_mul_f32_dpp v200, v242, v84 row_newbcast:2 row_mask:0xf bank_mask:0xf
    v_mul_f32_dpp v201, v242, v85 row_newbcast:3 row_mask:0xf bank_mask:0xf
    v_mul_f32_dpp v202, v242, v84 row_newbcast:10 row_mask:0xf bank_mask:0xf
    v_mul_f32_dpp v203, v242, v85 row_newbcast:11 row_mask:0xf bank_mask:0xf
    v_cvt_pk_bf16_f32 v80, v196, v197
    v_cvt_pk_bf16_f32 v84, v198, v199
    v_cvt_pk_bf16_f32 v81, v200, v201
    v_cvt_pk_bf16_f32 v85, v202, v203
    s_add_u32 m0, s21, 2048
    v_mfma_f32_32x32x16_bf16 v[16:31], v[76:79], v[176:179], v[16:31]
    buffer_load_dwordx4 v236, s[4:7], s35 offen lds
    buffer_load_dwordx4 v237, s[8:11], s35 offen offset:1024 lds
    ds_read_b64_tr_b16 v[176:177], v244 offset:4096
    ds_read_b64_tr_b16 v[178:179], v244 offset:5120
    ds_read_b64_tr_b16 v[188:189], v245 offset:4096
    ds_read_b64_tr_b16 v[190:191], v245 offset:5120
    v_mul_f32_dpp v196, v242, v82 row_newbcast:4 row_mask:0xf bank_mask:0xf
    v_mul_f32_dpp v197, v242, v83 row_newbcast:5 row_mask:0xf bank_mask:0xf
    v_mul_f32_dpp v198, v242, v82 row_newbcast:12 row_mask:0xf bank_mask:0xf
    v_mul_f32_dpp v199, v242, v83 row_newbcast:13 row_mask:0xf bank_mask:0xf
    v_mul_f32_dpp v200, v242, v86 row_newbcast:6 row_mask:0xf bank_mask:0xf
    v_mul_f32_dpp v201, v242, v87 row_newbcast:7 row_mask:0xf bank_mask:0xf
    v_mul_f32_dpp v202, v242, v86 row_newbcast:14 row_mask:0xf bank_mask:0xf
    v_mul_f32_dpp v203, v242, v87 row_newbcast:15 row_mask:0xf bank_mask:0xf
    v_cvt_pk_bf16_f32 v82, v196, v197
    v_cvt_pk_bf16_f32 v86, v198, v199
    v_cvt_pk_bf16_f32 v83, v200, v201
    v_cvt_pk_bf16_f32 v87, v202, v203
    s_nop 0
    s_waitcnt vmcnt(4) lgkmcnt(0)
    v_mfma_f32_32x32x16_bf16 v[0:15], v[80:83], v[176:179], v[0:15]
    v_mul_f32_dpp v196, v243, v88 row_newbcast:0 row_mask:0xf bank_mask:0xf
    v_mul_f32_dpp v197, v243, v89 row_newbcast:1 row_mask:0xf bank_mask:0xf
    v_mul_f32_dpp v198, v243, v88 row_newbcast:8 row_mask:0xf bank_mask:0xf
    v_mul_f32_dpp v199, v243, v89 row_newbcast:9 row_mask:0xf bank_mask:0xf
    v_mul_f32_dpp v200, v243, v92 row_newbcast:2 row_mask:0xf bank_mask:0xf
    v_mul_f32_dpp v201, v243, v93 row_newbcast:3 row_mask:0xf bank_mask:0xf
    v_mul_f32_dpp v202, v243, v92 row_newbcast:10 row_mask:0xf bank_mask:0xf
    v_mul_f32_dpp v203, v243, v93 row_newbcast:11 row_mask:0xf bank_mask:0xf
    v_cvt_pk_bf16_f32 v88, v196, v197
    v_cvt_pk_bf16_f32 v92, v198, v199
    v_cvt_pk_bf16_f32 v89, v200, v201
    v_cvt_pk_bf16_f32 v93, v202, v203
    s_add_u32 m0, s21, 4096
    v_mfma_f32_32x32x16_bf16 v[16:31], v[84:87], v[176:179], v[16:31]
    buffer_load_dwordx4 v238, s[4:7], s35 offen lds
    buffer_load_dwordx4 v239, s[8:11], s35 offen offset:1024 lds
    ds_read_b64_tr_b16 v[176:177], v244 offset:6144
    ds_read_b64_tr_b16 v[178:179], v244 offset:7168
    ds_read_b64_tr_b16 v[192:193], v245 offset:6144
    ds_read_b64_tr_b16 v[194:195], v245 offset:7168
    v_mul_f32_dpp v196, v243, v90 row_newbcast:4 row_mask:0xf bank_mask:0xf
    v_mul_f32_dpp v197, v243, v91 row_newbcast:5 row_mask:0xf bank_mask:0xf
    v_mul_f32_dpp v198, v243, v90 row_newbcast:12 row_mask:0xf bank_mask:0xf
    v_mul_f32_dpp v199, v243, v91 row_newbcast:13 row_mask:0xf bank_mask:0xf
    v_mul_f32_dpp v200, v243, v94 row_newbcast:6 row_mask:0xf bank_mask:0xf
    v_mul_f32_dpp v201, v243, v95 row_newbcast:7 row_mask:0xf bank_mask:0xf
    v_mul_f32_dpp v202, v243, v94 row_newbcast:14 row_mask:0xf bank_mask:0xf
    v_mul_f32_dpp v203, v243, v95 row_newbcast:15 row_mask:0xf bank_mask:0xf
    v_cvt_pk_bf16_f32 v90, v196, v197
    v_cvt_pk_bf16_f32 v94, v198, v199
    v_cvt_pk_bf16_f32 v91, v200, v201
    v_cvt_pk_bf16_f32 v95, v202, v203
    s_nop 0
    s_waitcnt lgkmcnt(0)
    v_mfma_f32_32x32x16_bf16 v[0:15], v[88:91], v[176:179], v[0:15]
    s_add_u32 m0, s21, 6144
    v_mfma_f32_32x32x16_bf16 v[16:31], v[92:95], v[176:179], v[16:31]
    buffer_load_dwordx4 v240, s[4:7], s35 offen lds
    buffer_load_dwordx4 v241, s[8:11], s35 offen offset:1024 lds
    s_mov_b32 m0, s50
    s_nop 0
    s_movrels_b32 s71, s23
    s_bfe_u32 s46, s71, 0x30012
    s_mov_b32 m0, s46
    s_and_b32 s66, s71, 0x3ffff
    s_movrels_b32 s68, s57
    s_movrels_b32 s69, s61
    s_sub_u32 s48, s66, s47
    s_mov_b32 s47, s66
    s_lshr_b32 s52, s71, 28
    s_lshl_b32 s67, s46, 9
    s_add_u32 s66, s66, s67
    s_sub_u32 s49, s66, s42
    s_mov_b32 s42, s66
    s_bfe_u32 s66, s68, 655360
    s_add_u32 s43, s42, s66
    s_bfe_u32 s39, s69, 655360
    s_bfe_u32 s66, s68, 655370
    s_add_u32 s44, s42, s66
    s_bfe_u32 s40, s69, 655370
    s_bfe_u32 s66, s68, 655380
    s_add_u32 s45, s42, s66
    s_bfe_u32 s41, s69, 655380
    s_and_b32 s66, s46, s33
    s_cselect_b32 s72, -1, 1
    s_cselect_b32 s76, s47, 163712
    s_cmp_ge_u32 s66, 2
    s_cselect_b32 s73, -1, 0
    s_add_u32 s77, s47, 1024
    s_cmp_ge_u32 s66, 4
    s_cselect_b32 s75, -1, 0
    s_cmp_ge_u32 s66, 3
    s_cselect_b32 s74, -1, 1
    s_cselect_b32 s77, s77, 163712
    v_mfma_f32_32x32x16_bf16 v[32:47], v[64:67], v[180:183], 0
    v_mul_f32 v196, v0, v96
    v_fmac_f32 v196, v1, v97
    v_fmac_f32 v196, v2, v98
    v_fmac_f32 v196, v3, v99
    v_fmac_f32 v196, v4, v100
    v_mfma_f32_32x32x16_bf16 v[48:63], v[68:71], v[180:183], 0
    v_add_u32 v253, s47, v248
    ds_read_b32 v254, v253
    ds_read_b32 v255, v253 offset:256
    v_fmac_f32 v196, v5, v101
    v_fmac_f32 v196, v6, v102
    v_fmac_f32 v196, v7, v103
    v_mul_f32 v198, v8, v128
    v_fmac_f32 v198, v9, v129
    v_mfma_f32_32x32x16_bf16 v[32:47], v[72:75], v[184:187], v[32:47]
    v_fmac_f32 v198, v10, v130
    v_fmac_f32 v198, v11, v131
    v_fmac_f32 v198, v12, v132
    v_fmac_f32 v198, v13, v133
    v_mfma_f32_32x32x16_bf16 v[48:63], v[76:79], v[184:187], v[48:63]
    v_fmac_f32 v198, v14, v134
    v_fmac_f32 v198, v15, v135
    v_mul_f32 v200, v16, v128
    v_fmac_f32 v200, v17, v129
    v_permlane32_swap_b32 v196, v198
    v_mfma_f32_32x32x16_bf16 v[32:47], v[80:83], v[188:191], v[32:47]
    v_fmac_f32 v200, v18, v130
    v_fmac_f32 v200, v19, v131
    v_fmac_f32 v200, v20, v132
    v_fmac_f32 v200, v21, v133
    v_fmac_f32 v200, v22, v134
    v_mfma_f32_32x32x16_bf16 v[48:63], v[84:87], v[188:191], v[48:63]
    s_waitcnt vmcnt(6)
    ds_read_b64_tr_b16 v[176:177], v244 offset:0
    ds_read_b64_tr_b16 v[178:179], v244 offset:1024
    ds_read_b64_tr_b16 v[180:181], v245 offset:0
    ds_read_b64_tr_b16 v[182:183], v245 offset:1024
    v_fmac_f32 v200, v23, v135
    v_add_f32 v198, v196, v198
    v_mul_f32_e64 v202, v24, -v128
    v_fma_f32 v202, v25, -v129, v202
    v_mfma_f32_32x32x16_bf16 v[32:47], v[88:91], v[192:195], v[32:47]
    v_fma_f32 v202, v26, -v130, v202
    v_fma_f32 v202, v27, -v131, v202
    v_fma_f32 v202, v28, -v132, v202
    v_fma_f32 v202, v29, -v133, v202
    v_fma_f32 v202, v30, -v134, v202
    v_mfma_f32_32x32x16_bf16 v[48:63], v[92:95], v[192:195], v[48:63]
    v_fma_f32 v202, v31, -v135, v202
    s_nop 1
    v_permlane32_swap_b32 v200, v202
    v_add_f32 v202, v200, v202
    s_waitcnt vmcnt(4) lgkmcnt(0)
    v_mfma_f32_32x32x16_bf16 v[0:15], v[64:67], v[176:179], 0
    v_mul_f32 v197, v32, v104
    v_fmac_f32 v197, v33, v105
    v_fmac_f32 v197, v34, v106
    v_fmac_f32 v197, v35, v107
    v_fmac_f32 v197, v36, v108
    v_fmac_f32 v197, v37, v109
    s_add_u32 m0, s21, 0
    v_mfma_f32_32x32x16_bf16 v[16:31], v[68:71], v[176:179], 0
    buffer_load_dwordx4 v234, s[4:7], s36 offen lds
    buffer_load_dwordx4 v235, s[8:11], s36 offen offset:1024 lds
    ds_read_b64_tr_b16 v[176:177], v244 offset:2048
    ds_read_b64_tr_b16 v[178:179], v244 offset:3072
    ds_read_b64_tr_b16 v[184:185], v245 offset:2048
    ds_read_b64_tr_b16 v[186:187], v245 offset:3072
    s_mov_b32 m0, s76
    s_mov_b64 exec, s[72:73]
    buffer_load_dwordx4 v254, s[12:15], 0 offen  lds
    s_mov_b32 m0, s77
    s_mov_b64 exec, s[74:75]
    buffer_load_dwordx4 v255, s[12:15], 0 offen  lds
    s_mov_b64 exec, -1
    v_fmac_f32 v197, v38, v110
    v_fmac_f32 v197, v39, v111
    v_mul_f32 v199, v40, v136
    v_fmac_f32 v199, v41, v137
    v_fmac_f32 v199, v42, v138
    s_waitcnt vmcnt(6) lgkmcnt(0)
    v_mfma_f32_32x32x16_bf16 v[0:15], v[72:75], v[176:179], v[0:15]
    v_fmac_f32 v199, v43, v139
    v_fmac_f32 v199, v44, v140
    v_fmac_f32 v199, v45, v141
    v_fmac_f32 v199, v46, v142
    v_fmac_f32 v199, v47, v143
    s_add_u32 m0, s21, 2048
    v_mfma_f32_32x32x16_bf16 v[16:31], v[76:79], v[176:179], v[16:31]
    buffer_load_dwordx4 v236, s[4:7], s36 offen lds
    buffer_load_dwordx4 v237, s[8:11], s36 offen offset:1024 lds
    ds_read_b64_tr_b16 v[176:177], v244 offset:4096
    ds_read_b64_tr_b16 v[178:179], v244 offset:5120
    ds_read_b64_tr_b16 v[188:189], v245 offset:4096
    ds_read_b64_tr_b16 v[190:191], v245 offset:5120
    v_mul_f32 v201, v48, v136
    v_fmac_f32 v201, v49, v137
    v_permlane32_swap_b32 v197, v199
    v_fmac_f32 v201, v50, v138
    v_fmac_f32 v201, v51, v139
    s_waitcnt vmcnt(6) lgkmcnt(0)
    v_mfma_f32_32x32x16_bf16 v[0:15], v[80:83], v[176:179], v[0:15]
    v_fmac_f32 v201, v52, v140
    v_fmac_f32 v201, v53, v141
    v_fmac_f32 v201, v54, v142
    v_fmac_f32 v201, v55, v143
    v_add_f32 v199, v197, v199
    v_mul_f32_e64 v203, v56, -v136
    s_add_u32 m0, s21, 4096
    v_mfma_f32_32x32x16_bf16 v[16:31], v[84:87], v[176:179], v[16:31]
    buffer_load_dwordx4 v238, s[4:7], s36 offen lds
    buffer_load_dwordx4 v239, s[8:11], s36 offen offset:1024 lds
    ds_read_b64_tr_b16 v[176:177], v244 offset:6144
    ds_read_b64_tr_b16 v[178:179], v244 offset:7168
    ds_read_b64_tr_b16 v[192:193], v245 offset:6144
    ds_read_b64_tr_b16 v[194:195], v245 offset:7168
    v_fma_f32 v203, v57, -v137, v203
    v_fma_f32 v203, v58, -v138, v203
    v_fma_f32 v203, v59, -v139, v203
    v_fma_f32 v203, v60, -v140, v203
    v_fma_f32 v203, v61, -v141, v203
    s_waitcnt lgkmcnt(0)
    v_mfma_f32_32x32x16_bf16 v[0:15], v[88:91], v[176:179], v[0:15]
    v_fma_f32 v203, v62, -v142, v203
    v_fma_f32 v203, v63, -v143, v203
    s_nop 1
    v_permlane32_swap_b32 v201, v203
    v_add_f32 v203, v201, v203
    s_add_u32 m0, s21, 6144
    v_mfma_f32_32x32x16_bf16 v[16:31], v[92:95], v[176:179], v[16:31]
    buffer_load_dwordx4 v240, s[4:7], s36 offen lds
    buffer_load_dwordx4 v241, s[8:11], s36 offen offset:1024 lds
    s_set_gpr_idx_on s51, gpr_idx(DST)
    s_nop 0
    v_cvt_pk_bf16_f32 v204, v198, v199
    v_cvt_pk_bf16_f32 v205, v202, v203
    s_set_gpr_idx_off
    v_mfma_f32_32x32x16_bf16 v[32:47], v[64:67], v[180:183], 0
    v_mul_f32 v196, v0, v144
    v_fmac_f32 v196, v1, v145
    v_fmac_f32 v196, v2, v146
    v_fmac_f32 v196, v3, v147
    v_mfma_f32_32x32x16_bf16 v[48:63], v[68:71], v[180:183], 0
    v_fmac_f32 v196, v4, v148
    v_fmac_f32 v196, v5, v149
    v_fmac_f32 v196, v6, v150
    v_fmac_f32 v196, v7, v151
    v_mfma_f32_32x32x16_bf16 v[32:47], v[72:75], v[184:187], v[32:47]
    v_mul_f32 v198, v8, v112
    v_fmac_f32 v198, v9, v113
    v_fmac_f32 v198, v10, v114
    v_fmac_f32 v198, v11, v115
    v_mfma_f32_32x32x16_bf16 v[48:63], v[76:79], v[184:187], v[48:63]
    v_fmac_f32 v198, v12, v116
    v_fmac_f32 v198, v13, v117
    v_fmac_f32 v198, v14, v118
    v_fmac_f32 v198, v15, v119
    v_mfma_f32_32x32x16_bf16 v[32:47], v[80:83], v[188:191], v[32:47]
    v_mul_f32_e64 v200, v16, -v160
    v_fma_f32 v200, v17, -v161, v200
    v_fma_f32 v200, v18, -v162, v200
    v_fma_f32 v200, v19, -v163, v200
    v_mfma_f32_32x32x16_bf16 v[48:63], v[84:87], v[188:191], v[48:63]
    s_waitcnt vmcnt(8)
    ds_read_b64_tr_b16 v[176:177], v244 offset:0
    ds_read_b64_tr_b16 v[178:179], v244 offset:1024
    ds_read_b64_tr_b16 v[180:181], v245 offset:0
    ds_read_b64_tr_b16 v[182:183], v245 offset:1024
    v_fma_f32 v200, v20, -v164, v200
    v_fma_f32 v200, v21, -v165, v200
    v_fma_f32 v200, v22, -v166, v200
    v_fma_f32 v200, v23, -v167, v200
    v_mfma_f32_32x32x16_bf16 v[32:47], v[88:91], v[192:195], v[32:47]
    v_mul_f32_e64 v202, v24, -v160
    v_fma_f32 v202, v25, -v161, v202
    v_fma_f32 v202, v26, -v162, v202
    v_fma_f32 v202, v27, -v163, v202
    v_mfma_f32_32x32x16_bf16 v[48:63], v[92:95], v[192:195], v[48:63]
    v_fma_f32 v202, v28, -v164, v202
    v_fma_f32 v202, v29, -v165, v202
    v_fma_f32 v202, v30, -v166, v202
    v_fma_f32 v202, v31, -v167, v202
    s_waitcnt vmcnt(4) lgkmcnt(0)
    v_mfma_f32_32x32x16_bf16 v[0:15], v[64:67], v[176:179], 0
    s_nop 0
    v_mul_f32 v197, v32, v152
    v_fmac_f32 v197, v33, v153
    v_fmac_f32 v197, v34, v154
    v_fmac_f32 v197, v35, v155
    s_add_u32 m0, s21, 0
    v_mfma_f32_32x32x16_bf16 v[16:31], v[68:71], v[176:179], 0
    buffer_load_dwordx4 v234, s[4:7], s37 offen lds
    buffer_load_dwordx4 v235, s[8:11], s37 offen offset:1024 lds
    ds_read_b64_tr_b16 v[176:177], v244 offset:2048
    ds_read_b64_tr_b16 v[178:179], v244 offset:3072
    ds_read_b64_tr_b16 v[184:185], v245 offset:2048
    ds_read_b64_tr_b16 v[186:187], v245 offset:3072
    v_add_u32 v252, s42, v247
    ds_read_u16 v234, v252
    ds_read_u16 v235, v252 offset:64
    v_fmac_f32 v197, v36, v156
    v_fmac_f32 v197, v37, v157
    v_fmac_f32 v197, v38, v158
    v_fmac_f32 v197, v39, v159
    s_waitcnt vmcnt(4) lgkmcnt(2)
    v_mfma_f32_32x32x16_bf16 v[0:15], v[72:75], v[176:179], v[0:15]
    v_mul_f32 v199, v40, v120
    v_fmac_f32 v199, v41, v121
    v_fmac_f32 v199, v42, v122
    v_fmac_f32 v199, v43, v123
    s_add_u32 m0, s21, 2048
    v_mfma_f32_32x32x16_bf16 v[16:31], v[76:79], v[176:179], v[16:31]
    buffer_load_dwordx4 v236, s[4:7], s37 offen lds
    buffer_load_dwordx4 v237, s[8:11], s37 offen offset:1024 lds
    ds_read_b64_tr_b16 v[176:177], v244 offset:4096
    ds_read_b64_tr_b16 v[178:179], v244 offset:5120
    ds_read_b64_tr_b16 v[188:189], v245 offset:4096
    ds_read_b64_tr_b16 v[190:191], v245 offset:5120
    v_add_u32 v252, s43, v247
    ds_read_u16 v236, v252
    ds_read_u16 v237, v252 offset:64
    v_fmac_f32 v199, v44, v124
    v_fmac_f32 v199, v45, v125
    v_fmac_f32 v199, v46, v126
    v_fmac_f32 v199, v47, v127
    s_waitcnt vmcnt(4) lgkmcnt(2)
    v_mfma_f32_32x32x16_bf16 v[0:15], v[80:83], v[176:179], v[0:15]
    v_mul_f32_e64 v201, v48, -v168
    v_fma_f32 v201, v49, -v169, v201
    v_fma_f32 v201, v50, -v170, v201
    v_fma_f32 v201, v51, -v171, v201
    s_add_u32 m0, s21, 4096
    v_mfma_f32_32x32x16_bf16 v[16:31], v[84:87], v[176:179], v[16:31]
    buffer_load_dwordx4 v238, s[4:7], s37 offen lds
    buffer_load_dwordx4 v239, s[8:11], s37 offen offset:1024 lds
    ds_read_b64_tr_b16 v[176:177], v244 offset:6144
    ds_read_b64_tr_b16 v[178:179], v244 offset:7168
    ds_read_b64_tr_b16 v[192:193], v245 offset:6144
    ds_read_b64_tr_b16 v[194:195], v245 offset:7168
    v_add_u32 v252, s44, v247
    ds_read_u16 v238, v252
    ds_read_u16 v239, v252 offset:64
    v_fma_f32 v201, v52, -v172, v201
    v_fma_f32 v201, v53, -v173, v201
    v_fma_f32 v201, v54, -v174, v201
    v_fma_f32 v201, v55, -v175, v201
    s_waitcnt lgkmcnt(2)
    v_mfma_f32_32x32x16_bf16 v[0:15], v[88:91], v[176:179], v[0:15]
    v_mul_f32_e64 v203, v56, -v168
    v_fma_f32 v203, v57, -v169, v203
    v_fma_f32 v203, v58, -v170, v203
    v_fma_f32 v203, v59, -v171, v203
    s_add_u32 m0, s21, 6144
    v_mfma_f32_32x32x16_bf16 v[16:31], v[92:95], v[176:179], v[16:31]
    buffer_load_dwordx4 v240, s[4:7], s37 offen lds
    buffer_load_dwordx4 v241, s[8:11], s37 offen offset:1024 lds
    v_add_u32 v252, s45, v247
    ds_read_u16 v240, v252
    ds_read_u16 v241, v252 offset:64
    v_fma_f32 v203, v60, -v172, v203
    v_fma_f32 v203, v61, -v173, v203
    v_fma_f32 v203, v62, -v174, v203
    v_fma_f32 v203, v63, -v175, v203
    v_mfma_f32_32x32x16_bf16 v[32:47], v[64:67], v[180:183], 0
    v_mul_f32 v254, v0, v144
    v_fmac_f32 v254, v1, v145
    v_fmac_f32 v254, v2, v146
    v_mfma_f32_32x32x16_bf16 v[48:63], v[68:71], v[180:183], 0
    ds_swizzle_b32 v68, v68 offset:0x401F
    ds_swizzle_b32 v69, v69 offset:0x401F
    ds_swizzle_b32 v70, v70 offset:0x401F
    ds_swizzle_b32 v71, v71 offset:0x401F
    v_fmac_f32 v254, v3, v147
    v_fmac_f32 v254, v4, v148
    v_mfma_f32_32x32x16_bf16 v[32:47], v[72:75], v[184:187], v[32:47]
    v_fmac_f32 v254, v5, v149
    v_fmac_f32 v254, v6, v150
    v_mfma_f32_32x32x16_bf16 v[48:63], v[76:79], v[184:187], v[48:63]
    ds_swizzle_b32 v76, v76 offset:0x401F
    ds_swizzle_b32 v77, v77 offset:0x401F
    ds_swizzle_b32 v78, v78 offset:0x401F
    ds_swizzle_b32 v79, v79 offset:0x401F
    v_fmac_f32 v254, v7, v151
    v_fmac_f32 v200, v8, v160
    v_mfma_f32_32x32x16_bf16 v[32:47], v[80:83], v[188:191], v[32:47]
    v_fmac_f32 v200, v9, v161
    v_permlane32_swap_b32 v196, v254
    v_fmac_f32 v200, v10, v162
    v_mfma_f32_32x32x16_bf16 v[48:63], v[84:87], v[188:191], v[48:63]
    ds_swizzle_b32 v84, v84 offset:0x401F
    ds_swizzle_b32 v85, v85 offset:0x401F
    ds_swizzle_b32 v86, v86 offset:0x401F
    ds_swizzle_b32 v87, v87 offset:0x401F
    s_waitcnt vmcnt(6)
    ds_read_b64_tr_b16 v[176:177], v244 offset:0
    ds_read_b64_tr_b16 v[178:179], v244 offset:1024
    ds_read_b64_tr_b16 v[180:181], v245 offset:0
    ds_read_b64_tr_b16 v[182:183], v245 offset:1024
    v_fmac_f32 v200, v11, v163
    v_fmac_f32 v200, v12, v164
    v_mfma_f32_32x32x16_bf16 v[32:47], v[88:91], v[192:195], v[32:47]
    v_fmac_f32 v200, v13, v165
    v_fmac_f32 v200, v14, v166
    v_mfma_f32_32x32x16_bf16 v[48:63], v[92:95], v[192:195], v[48:63]
    ds_swizzle_b32 v92, v92 offset:0x401F
    ds_swizzle_b32 v93, v93 offset:0x401F
    ds_swizzle_b32 v94, v94 offset:0x401F
    ds_swizzle_b32 v95, v95 offset:0x401F
    v_fmac_f32 v200, v15, v167
    v_add_f32 v254, v196, v254
    s_waitcnt lgkmcnt(8)
    s_mov_b64 exec, s[56:57]
    v_xor_b32 v68, 0x80008000, v68
    v_xor_b32 v69, 0x80008000, v69
    v_xor_b32 v70, 0x80008000, v70
    v_xor_b32 v71, 0x80008000, v71
    v_xor_b32 v76, 0x80008000, v76
    v_xor_b32 v77, 0x80008000, v77
    v_xor_b32 v78, 0x80008000, v78
    v_xor_b32 v79, 0x80008000, v79
    v_xor_b32 v84, 0x80008000, v84
    v_xor_b32 v85, 0x80008000, v85
    v_xor_b32 v86, 0x80008000, v86
    v_xor_b32 v87, 0x80008000, v87
    s_mov_b64 exec, -1
    s_waitcnt vmcnt(4) lgkmcnt(4)
    v_mfma_f32_32x32x16_bf16 v[0:15], v[64:67], v[176:179], 0
    v_mul_f32 v255, v32, v152
    v_fmac_f32 v255, v33, v153
    v_fmac_f32 v255, v34, v154
    s_add_u32 m0, s21, 0
    v_mfma_f32_32x32x16_bf16 v[16:31], v[68:71], v[176:179], v[16:31]
    v_lshl_add_u32 v234, v234, 10, v246
    v_lshl_add_u32 v235, v235, 10, v246
    buffer_load_dwordx4 v234, s[4:7], s38 offen lds
    buffer_load_dwordx4 v235, s[8:11], s38 offen offset:1024 lds
    ds_read_b64_tr_b16 v[176:177], v244 offset:2048
    ds_read_b64_tr_b16 v[178:179], v244 offset:3072
    ds_read_b64_tr_b16 v[184:185], v245 offset:2048
    ds_read_b64_tr_b16 v[186:187], v245 offset:3072
    v_fmac_f32 v255, v35, v155
    v_fmac_f32 v255, v36, v156
    v_fmac_f32 v255, v37, v157
    s_waitcnt vmcnt(4) lgkmcnt(0)
    v_mfma_f32_32x32x16_bf16 v[0:15], v[72:75], v[176:179], v[0:15]
    v_fmac_f32 v255, v38, v158
    v_fmac_f32 v255, v39, v159
    v_fmac_f32 v201, v40, v168
    s_add_u32 m0, s21, 2048
    v_mfma_f32_32x32x16_bf16 v[16:31], v[76:79], v[176:179], v[16:31]
    v_lshl_add_u32 v236, v236, 10, v246
    v_lshl_add_u32 v237, v237, 10, v246
    buffer_load_dwordx4 v236, s[4:7], s39 offen lds
    buffer_load_dwordx4 v237, s[8:11], s39 offen offset:1024 lds
    ds_read_b64_tr_b16 v[176:177], v244 offset:4096
    ds_read_b64_tr_b16 v[178:179], v244 offset:5120
    ds_read_b64_tr_b16 v[188:189], v245 offset:4096
    ds_read_b64_tr_b16 v[190:191], v245 offset:5120
    v_fmac_f32 v201, v41, v169
    v_permlane32_swap_b32 v197, v255
    s_waitcnt vmcnt(4) lgkmcnt(0)
    v_mfma_f32_32x32x16_bf16 v[0:15], v[80:83], v[176:179], v[0:15]
    v_fmac_f32 v201, v42, v170
    v_fmac_f32 v201, v43, v171
    v_fmac_f32 v201, v44, v172
    s_add_u32 m0, s21, 4096
    v_mfma_f32_32x32x16_bf16 v[16:31], v[84:87], v[176:179], v[16:31]
    v_lshl_add_u32 v238, v238, 10, v246
    v_lshl_add_u32 v239, v239, 10, v246
    buffer_load_dwordx4 v238, s[4:7], s40 offen lds
    buffer_load_dwordx4 v239, s[8:11], s40 offen offset:1024 lds
    ds_read_b64_tr_b16 v[176:177], v244 offset:6144
    ds_read_b64_tr_b16 v[178:179], v244 offset:7168
    ds_read_b64_tr_b16 v[192:193], v245 offset:6144
    ds_read_b64_tr_b16 v[194:195], v245 offset:7168
    v_fmac_f32 v201, v45, v173
    v_fmac_f32 v201, v46, v174
    v_fmac_f32 v201, v47, v175
    s_waitcnt lgkmcnt(0)
    s_mov_b64 exec, s[56:57]
    v_xor_b32 v92, 0x80008000, v92
    v_xor_b32 v93, 0x80008000, v93
    v_xor_b32 v94, 0x80008000, v94
    v_xor_b32 v95, 0x80008000, v95
    s_mov_b64 exec, -1
    v_mfma_f32_32x32x16_bf16 v[0:15], v[88:91], v[176:179], v[0:15]
    v_add_f32 v255, v197, v255
    s_set_gpr_idx_on s51, gpr_idx(DST)
    s_nop 0
    v_cvt_pk_bf16_f32 v206, v254, v255
    s_set_gpr_idx_off
    s_add_u32 m0, s21, 6144
    v_mfma_f32_32x32x16_bf16 v[16:31], v[92:95], v[176:179], v[16:31]
    v_lshl_add_u32 v240, v240, 10, v246
    v_lshl_add_u32 v241, v241, 10, v246
    buffer_load_dwordx4 v240, s[4:7], s41 offen lds
    buffer_load_dwordx4 v241, s[8:11], s41 offen offset:1024 lds
    v_mfma_f32_32x32x16_bf16 v[32:47], v[64:67], v[180:183], 0
    v_mul_f32 v254, v0, v144
    v_fmac_f32 v254, v1, v145
    v_fmac_f32 v254, v2, v146
    v_fmac_f32 v254, v3, v147
    v_fmac_f32 v254, v4, v148
    v_mfma_f32_32x32x16_bf16 v[48:63], v[68:71], v[180:183], v[48:63]
    v_fmac_f32 v254, v5, v149
    v_fmac_f32 v254, v6, v150
    v_fmac_f32 v254, v7, v151
    v_fma_f32 v202, v8, -v160, v202
    v_fma_f32 v202, v9, -v161, v202
    v_mfma_f32_32x32x16_bf16 v[32:47], v[72:75], v[184:187], v[32:47]
    v_permlane32_swap_b32 v254, v200
    v_fma_f32 v202, v10, -v162, v202
    v_fma_f32 v202, v11, -v163, v202
    v_fma_f32 v202, v12, -v164, v202
    v_fma_f32 v202, v13, -v165, v202
    v_mfma_f32_32x32x16_bf16 v[48:63], v[76:79], v[184:187], v[48:63]
    v_fma_f32 v202, v14, -v166, v202
    v_fma_f32 v202, v15, -v167, v202
    v_add_f32 v200, v254, v200
    v_fmac_f32 v198, v16, v112
    v_permlane32_swap_b32 v202, v254
    v_mfma_f32_32x32x16_bf16 v[32:47], v[80:83], v[188:191], v[32:47]
    v_fmac_f32 v198, v17, v113
    v_fmac_f32 v198, v18, v114
    v_fmac_f32 v198, v19, v115
    v_fmac_f32 v198, v20, v116
    v_fmac_f32 v198, v21, v117
    v_mfma_f32_32x32x16_bf16 v[48:63], v[84:87], v[188:191], v[48:63]
    s_waitcnt vmcnt(6)
    ds_read_b64_tr_b16 v[176:177], v244 offset:0
    ds_read_b64_tr_b16 v[178:179], v244 offset:1024
    ds_read_b64_tr_b16 v[180:181], v245 offset:0
    ds_read_b64_tr_b16 v[182:183], v245 offset:1024
    v_fmac_f32 v198, v22, v118
    v_fmac_f32 v198, v23, v119
    v_add_f32 v254, v202, v254
    v_mul_f32 v196, v24, v160
    v_fmac_f32 v196, v25, v161
    v_mfma_f32_32x32x16_bf16 v[32:47], v[88:91], v[192:195], v[32:47]
    v_fmac_f32 v196, v26, v162
    v_fmac_f32 v196, v27, v163
    v_fmac_f32 v196, v28, v164
    v_fmac_f32 v196, v29, v165
    v_fmac_f32 v196, v30, v166
    v_mfma_f32_32x32x16_bf16 v[48:63], v[92:95], v[192:195], v[48:63]
    v_add_u32 v249, s48, v249
    v_add_u32 v250, s49, v250
    ds_read_b32 v252, v251 offset:16
    ds_read_b64_tr_b16 v[64:65], v249 offset:0
    ds_read_b64_tr_b16 v[68:69], v249 offset:64
    ds_read_b64_tr_b16 v[66:67], v249 offset:256
    ds_read_b64_tr_b16 v[70:71], v249 offset:320
    s_mov_b64 exec, s[54:55]
    ds_read_u16_d16_hi v242, v250 offset:0
    s_mov_b64 exec, -1
    v_fmac_f32 v196, v31, v167
    s_nop 1
    v_permlane32_swap_b32 v198, v196
    v_add_f32 v196, v198, v196
    v_mul_f32 v255, v32, v152
    v_fmac_f32 v255, v33, v153
    v_fmac_f32 v255, v34, v154
    v_fmac_f32 v255, v35, v155
    v_fmac_f32 v255, v36, v156
    v_fmac_f32 v255, v37, v157
    v_fmac_f32 v255, v38, v158
    v_fmac_f32 v255, v39, v159
    v_fma_f32 v203, v40, -v168, v203
    v_fma_f32 v203, v41, -v169, v203
    v_permlane32_swap_b32 v255, v201
    v_fma_f32 v203, v42, -v170, v203
    v_fma_f32 v203, v43, -v171, v203
    v_fma_f32 v203, v44, -v172, v203
    v_fma_f32 v203, v45, -v173, v203
    v_fma_f32 v203, v46, -v174, v203
    v_fma_f32 v203, v47, -v175, v203
    v_add_f32 v201, v255, v201
    v_fmac_f32 v199, v48, v120
    v_permlane32_swap_b32 v203, v255
    v_fmac_f32 v199, v49, v121
    v_fmac_f32 v199, v50, v122
    v_fmac_f32 v199, v51, v123
    v_fmac_f32 v199, v52, v124
    v_fmac_f32 v199, v53, v125
    v_fmac_f32 v199, v54, v126
    v_fmac_f32 v199, v55, v127
    v_add_f32 v255, v203, v255
    v_mul_f32 v197, v56, v168
    v_fmac_f32 v197, v57, v169
    v_fmac_f32 v197, v58, v170
    v_fmac_f32 v197, v59, v171
    v_fmac_f32 v197, v60, v172
    v_fmac_f32 v197, v61, v173
    v_fmac_f32 v197, v62, v174
    v_fmac_f32 v197, v63, v175
    s_nop 1
    v_permlane32_swap_b32 v199, v197
    v_add_f32 v197, v199, v197
    s_set_gpr_idx_on s51, gpr_idx(DST)
    s_nop 0
    v_cvt_pk_bf16_f32 v207, v200, v201
    v_cvt_pk_bf16_f32 v209, v254, v255
    v_cvt_pk_bf16_f32 v208, v196, v197
    s_set_gpr_idx_off
    s_add_u32 s50, s50, 1
    s_add_u32 s51, s51, 6
    s_cmp_ge_u32 s50, 4
    s_cbranch_scc1 LAST0
    s_waitcnt lgkmcnt(5)
    v_readfirstlane_b32 s66, v252
    s_add_u32 s53, s53, 1
    v_mov_b32 v252, s53
    s_cmp_le_u32 s53, s66
    ds_write2_b32 v251, v252, v252 offset0:0 offset1:8
    s_setprio 1
    s_cbranch_scc1 PRIO_9
    s_setprio 0
PRIO_9:
    s_cmp_eq_u32 s52, 4
    s_cbranch_scc1 ITEM_0_4
    s_cmp_eq_u32 s52, 5
    s_cbranch_scc1 ITEM_0_5
    s_cmp_eq_u32 s52, 3
    s_cbranch_scc1 ITEM_0_3
    s_cmp_eq_u32 s52, 6
    s_cbranch_scc1 ITEM_0_6
    s_cmp_eq_u32 s52, 8
    s_cbranch_scc1 ITEM_0_8
    s_branch ITEM_0_2
.p2align 6
ITEM_0_2:
    s_mov_b32 m0, s50
    s_nop 0
    s_movrels_b32 s71, s23
    s_bfe_u32 s46, s71, 0x30012
    s_mov_b32 m0, s46
    s_and_b32 s66, s71, 0x3ffff
    s_movrels_b32 s68, s57
    s_movrels_b32 s69, s61
    s_sub_u32 s48, s66, s47
    s_mov_b32 s47, s66
    s_lshr_b32 s52, s71, 28
    s_lshl_b32 s67, s46, 9
    s_add_u32 s66, s66, s67
    s_sub_u32 s49, s66, s42
    s_mov_b32 s42, s66
    s_bfe_u32 s66, s68, 655360
    s_add_u32 s43, s42, s66
    s_bfe_u32 s39, s69, 655360
    s_bfe_u32 s66, s68, 655370
    s_add_u32 s44, s42, s66
    s_bfe_u32 s40, s69, 655370
    s_bfe_u32 s66, s68, 655380
    s_add_u32 s45, s42, s66
    s_bfe_u32 s41, s69, 655380
    s_and_b32 s66, s46, s33
    s_cselect_b32 s72, -1, 1
    s_cselect_b32 s76, s47, 163712
    s_cmp_ge_u32 s66, 2
    s_cselect_b32 s73, -1, 0
    s_add_u32 s77, s47, 1024
    s_cmp_ge_u32 s66, 4
    s_cselect_b32 s75, -1, 0
    s_cmp_ge_u32 s66, 3
    s_cselect_b32 s74, -1, 1
    s_cselect_b32 s77, s77, 163712
    v_add_u32 v252, s42, v247
    ds_read_u16 v234, v252
    ds_read_u16 v235, v252 offset:64
    v_add_u32 v252, s43, v247
    ds_read_u16 v236, v252
    ds_read_u16 v237, v252 offset:64
    v_add_u32 v252, s44, v247
    ds_read_u16 v238, v252
    ds_read_u16 v239, v252 offset:64
    v_add_u32 v252, s45, v247
    ds_read_u16 v240, v252
    ds_read_u16 v241, v252 offset:64
    s_waitcnt lgkmcnt(8)
    v_mul_f32_dpp v196, v242, v64 row_newbcast:0 row_mask:0xf bank_mask:0xf
    v_mul_f32_dpp v197, v242, v65 row_newbcast:1 row_mask:0xf bank_mask:0xf
    v_mul_f32_dpp v198, v242, v64 row_newbcast:8 row_mask:0xf bank_mask:0xf
    v_mul_f32_dpp v199, v242, v65 row_newbcast:9 row_mask:0xf bank_mask:0xf
    v_mul_f32_dpp v200, v242, v68 row_newbcast:2 row_mask:0xf bank_mask:0xf
    v_mul_f32_dpp v201, v242, v69 row_newbcast:3 row_mask:0xf bank_mask:0xf
    v_mul_f32_dpp v202, v242, v68 row_newbcast:10 row_mask:0xf bank_mask:0xf
    v_mul_f32_dpp v203, v242, v69 row_newbcast:11 row_mask:0xf bank_mask:0xf
    v_cvt_pk_bf16_f32 v64, v196, v197
    v_cvt_pk_bf16_f32 v68, v198, v199
    v_cvt_pk_bf16_f32 v65, v200, v201
    v_cvt_pk_bf16_f32 v69, v202, v203
    v_mul_f32_dpp v196, v242, v66 row_newbcast:4 row_mask:0xf bank_mask:0xf
    v_mul_f32_dpp v197, v242, v67 row_newbcast:5 row_mask:0xf bank_mask:0xf
    v_mul_f32_dpp v198, v242, v66 row_newbcast:12 row_mask:0xf bank_mask:0xf
    v_mul_f32_dpp v199, v242, v67 row_newbcast:13 row_mask:0xf bank_mask:0xf
    v_mul_f32_dpp v200, v242, v70 row_newbcast:6 row_mask:0xf bank_mask:0xf
    v_mul_f32_dpp v201, v242, v71 row_newbcast:7 row_mask:0xf bank_mask:0xf
    v_mul_f32_dpp v202, v242, v70 row_newbcast:14 row_mask:0xf bank_mask:0xf
    v_mul_f32_dpp v203, v242, v71 row_newbcast:15 row_mask:0xf bank_mask:0xf
    v_cvt_pk_bf16_f32 v66, v196, v197
    v_cvt_pk_bf16_f32 v70, v198, v199
    v_cvt_pk_bf16_f32 v67, v200, v201
    v_cvt_pk_bf16_f32 v71, v202, v203
    s_nop 0
    s_waitcnt lgkmcnt(6)
    v_mfma_f32_32x32x16_bf16 v[0:15], v[64:67], v[176:179], 0
    s_add_u32 m0, s21, 0
    v_mfma_f32_32x32x16_bf16 v[16:31], v[68:71], v[176:179], 0
    v_lshl_add_u32 v234, v234, 10, v246
    v_lshl_add_u32 v235, v235, 10, v246
    buffer_load_dwordx4 v234, s[4:7], s38 offen lds
    buffer_load_dwordx4 v235, s[8:11], s38 offen offset:1024 lds
    v_mfma_f32_32x32x16_bf16 v[32:47], v[64:67], v[180:183], 0
    s_nop 4
    v_mul_f32 v196, v0, v96
    v_fmac_f32 v196, v1, v97
    v_fmac_f32 v196, v2, v98
    v_fmac_f32 v196, v3, v99
    v_fmac_f32 v196, v4, v100
    v_fmac_f32 v196, v5, v101
    v_fmac_f32 v196, v6, v102
    v_fmac_f32 v196, v7, v103
    v_mul_f32 v198, v8, v128
    v_fmac_f32 v198, v9, v129
    v_fmac_f32 v198, v10, v130
    v_fmac_f32 v198, v11, v131
    v_fmac_f32 v198, v12, v132
    v_fmac_f32 v198, v13, v133
    v_fmac_f32 v198, v14, v134
    v_fmac_f32 v198, v15, v135
    v_mul_f32 v200, v16, v128
    v_fmac_f32 v200, v17, v129
    v_permlane32_swap_b32 v196, v198
    v_mfma_f32_32x32x16_bf16 v[48:63], v[68:71], v[180:183], 0
    v_add_u32 v253, s47, v248
    ds_read_b32 v254, v253
    ds_read_b32 v255, v253 offset:256
    s_waitcnt vmcnt(6)
    ds_read_b64_tr_b16 v[176:177], v244 offset:2048
    ds_read_b64_tr_b16 v[178:179], v244 offset:3072
    ds_read_b64_tr_b16 v[180:181], v245 offset:2048
    ds_read_b64_tr_b16 v[182:183], v245 offset:3072
    v_fmac_f32 v200, v18, v130
    v_fmac_f32 v200, v19, v131
    v_fmac_f32 v200, v20, v132
    v_fmac_f32 v200, v21, v133
    v_fmac_f32 v200, v22, v134
    v_fmac_f32 v200, v23, v135
    v_add_f32 v198, v196, v198
    v_mul_f32_e64 v202, v24, -v128
    v_fma_f32 v202, v25, -v129, v202
    v_fma_f32 v202, v26, -v130, v202
    v_fma_f32 v202, v27, -v131, v202
    v_fma_f32 v202, v28, -v132, v202
    v_fma_f32 v202, v29, -v133, v202
    v_fma_f32 v202, v30, -v134, v202
    v_fma_f32 v202, v31, -v135, v202
    s_nop 1
    v_permlane32_swap_b32 v200, v202
    v_add_f32 v202, v200, v202
    s_waitcnt lgkmcnt(0)
    v_mfma_f32_32x32x16_bf16 v[0:15], v[64:67], v[176:179], 0
    v_mul_f32 v197, v32, v104
    v_fmac_f32 v197, v33, v105
    v_fmac_f32 v197, v34, v106
    v_fmac_f32 v197, v35, v107
    v_fmac_f32 v197, v36, v108
    v_fmac_f32 v197, v37, v109
    v_fmac_f32 v197, v38, v110
    v_fmac_f32 v197, v39, v111
    v_mul_f32 v199, v40, v136
    v_fmac_f32 v199, v41, v137
    v_fmac_f32 v199, v42, v138
    v_fmac_f32 v199, v43, v139
    v_fmac_f32 v199, v44, v140
    v_fmac_f32 v199, v45, v141
    v_fmac_f32 v199, v46, v142
    v_fmac_f32 v199, v47, v143
    v_mul_f32 v201, v48, v136
    v_fmac_f32 v201, v49, v137
    v_permlane32_swap_b32 v197, v199
    v_fmac_f32 v201, v50, v138
    v_fmac_f32 v201, v51, v139
    s_add_u32 m0, s21, 2048
    v_mfma_f32_32x32x16_bf16 v[16:31], v[68:71], v[176:179], 0
    v_lshl_add_u32 v236, v236, 10, v246
    v_lshl_add_u32 v237, v237, 10, v246
    buffer_load_dwordx4 v236, s[4:7], s39 offen lds
    buffer_load_dwordx4 v237, s[8:11], s39 offen offset:1024 lds
    s_mov_b32 m0, s76
    s_mov_b64 exec, s[72:73]
    buffer_load_dwordx4 v254, s[12:15], 0 offen  lds
    s_mov_b32 m0, s77
    s_mov_b64 exec, s[74:75]
    buffer_load_dwordx4 v255, s[12:15], 0 offen  lds
    s_mov_b64 exec, -1
    v_fmac_f32 v201, v52, v140
    v_fmac_f32 v201, v53, v141
    v_fmac_f32 v201, v54, v142
    v_fmac_f32 v201, v55, v143
    v_add_f32 v199, v197, v199
    v_mul_f32_e64 v203, v56, -v136
    v_fma_f32 v203, v57, -v137, v203
    v_fma_f32 v203, v58, -v138, v203
    v_fma_f32 v203, v59, -v139, v203
    v_fma_f32 v203, v60, -v140, v203
    v_fma_f32 v203, v61, -v141, v203
    v_fma_f32 v203, v62, -v142, v203
    v_fma_f32 v203, v63, -v143, v203
    s_nop 1
    v_permlane32_swap_b32 v201, v203
    v_add_f32 v203, v201, v203
    s_set_gpr_idx_on s51, gpr_idx(DST)
    s_nop 0
    v_cvt_pk_bf16_f32 v204, v198, v199
    v_cvt_pk_bf16_f32 v205, v202, v203
    s_set_gpr_idx_off
    v_mfma_f32_32x32x16_bf16 v[32:47], v[64:67], v[180:183], 0
    v_mul_f32 v196, v0, v144
    v_fmac_f32 v196, v1, v145
    v_fmac_f32 v196, v2, v146
    v_fmac_f32 v196, v3, v147
    v_fmac_f32 v196, v4, v148
    v_fmac_f32 v196, v5, v149
    v_fmac_f32 v196, v6, v150
    v_fmac_f32 v196, v7, v151
    v_mul_f32 v198, v8, v112
    v_fmac_f32 v198, v9, v113
    v_fmac_f32 v198, v10, v114
    v_fmac_f32 v198, v11, v115
    v_fmac_f32 v198, v12, v116
    v_fmac_f32 v198, v13, v117
    v_fmac_f32 v198, v14, v118
    v_fmac_f32 v198, v15, v119
    v_mfma_f32_32x32x16_bf16 v[48:63], v[68:71], v[180:183], 0
    s_waitcnt vmcnt(8)
    ds_read_b64_tr_b16 v[176:177], v244 offset:4096
    ds_read_b64_tr_b16 v[178:179], v244 offset:5120
    ds_read_b64_tr_b16 v[180:181], v245 offset:4096
    ds_read_b64_tr_b16 v[182:183], v245 offset:5120
    v_mul_f32_e64 v200, v16, -v160
    v_fma_f32 v200, v17, -v161, v200
    v_fma_f32 v200, v18, -v162, v200
    v_fma_f32 v200, v19, -v163, v200
    v_fma_f32 v200, v20, -v164, v200
    v_fma_f32 v200, v21, -v165, v200
    v_fma_f32 v200, v22, -v166, v200
    v_fma_f32 v200, v23, -v167, v200
    v_mul_f32_e64 v202, v24, -v160
    v_fma_f32 v202, v25, -v161, v202
    v_fma_f32 v202, v26, -v162, v202
    v_fma_f32 v202, v27, -v163, v202
    v_fma_f32 v202, v28, -v164, v202
    v_fma_f32 v202, v29, -v165, v202
    v_fma_f32 v202, v30, -v166, v202
    v_fma_f32 v202, v31, -v167, v202
    s_waitcnt lgkmcnt(0)
    v_mfma_f32_32x32x16_bf16 v[0:15], v[64:67], v[176:179], 0
    v_mul_f32 v197, v32, v152
    v_fmac_f32 v197, v33, v153
    v_fmac_f32 v197, v34, v154
    v_fmac_f32 v197, v35, v155
    v_fmac_f32 v197, v36, v156
    v_fmac_f32 v197, v37, v157
    v_fmac_f32 v197, v38, v158
    v_fmac_f32 v197, v39, v159
    v_mul_f32 v199, v40, v120
    v_fmac_f32 v199, v41, v121
    v_fmac_f32 v199, v42, v122
    v_fmac_f32 v199, v43, v123
    v_fmac_f32 v199, v44, v124
    v_fmac_f32 v199, v45, v125
    v_fmac_f32 v199, v46, v126
    v_fmac_f32 v199, v47, v127
    s_add_u32 m0, s21, 4096
    v_mfma_f32_32x32x16_bf16 v[16:31], v[68:71], v[176:179], 0
    v_lshl_add_u32 v238, v238, 10, v246
    v_lshl_add_u32 v239, v239, 10, v246
    buffer_load_dwordx4 v238, s[4:7], s40 offen lds
    buffer_load_dwordx4 v239, s[8:11], s40 offen offset:1024 lds
    v_mul_f32_e64 v201, v48, -v168
    v_fma_f32 v201, v49, -v169, v201
    v_fma_f32 v201, v50, -v170, v201
    v_fma_f32 v201, v51, -v171, v201
    v_fma_f32 v201, v52, -v172, v201
    v_fma_f32 v201, v53, -v173, v201
    v_fma_f32 v201, v54, -v174, v201
    v_fma_f32 v201, v55, -v175, v201
    v_mul_f32_e64 v203, v56, -v168
    v_fma_f32 v203, v57, -v169, v203
    v_fma_f32 v203, v58, -v170, v203
    v_fma_f32 v203, v59, -v171, v203
    v_fma_f32 v203, v60, -v172, v203
    v_fma_f32 v203, v61, -v173, v203
    v_fma_f32 v203, v62, -v174, v203
    v_fma_f32 v203, v63, -v175, v203
    v_mfma_f32_32x32x16_bf16 v[32:47], v[64:67], v[180:183], 0
    v_mul_f32 v254, v0, v144
    v_fmac_f32 v254, v1, v145
    v_fmac_f32 v254, v2, v146
    v_fmac_f32 v254, v3, v147
    v_fmac_f32 v254, v4, v148
    v_fmac_f32 v254, v5, v149
    v_fmac_f32 v254, v6, v150
    v_fmac_f32 v254, v7, v151
    v_fmac_f32 v200, v8, v160
    v_mfma_f32_32x32x16_bf16 v[48:63], v[68:71], v[180:183], 0
    ds_swizzle_b32 v68, v68 offset:0x401F
    ds_swizzle_b32 v69, v69 offset:0x401F
    ds_swizzle_b32 v70, v70 offset:0x401F
    ds_swizzle_b32 v71, v71 offset:0x401F
    s_waitcnt vmcnt(8)
    ds_read_b64_tr_b16 v[176:177], v244 offset:6144
    ds_read_b64_tr_b16 v[178:179], v244 offset:7168
    ds_read_b64_tr_b16 v[180:181], v245 offset:6144
    ds_read_b64_tr_b16 v[182:183], v245 offset:7168
    v_fmac_f32 v200, v9, v161
    v_permlane32_swap_b32 v196, v254
    v_fmac_f32 v200, v10, v162
    v_fmac_f32 v200, v11, v163
    v_fmac_f32 v200, v12, v164
    v_fmac_f32 v200, v13, v165
    v_fmac_f32 v200, v14, v166
    v_fmac_f32 v200, v15, v167
    v_add_f32 v254, v196, v254
    s_waitcnt lgkmcnt(0)
    s_mov_b64 exec, s[56:57]
    v_xor_b32 v68, 0x80008000, v68
    v_xor_b32 v69, 0x80008000, v69
    v_xor_b32 v70, 0x80008000, v70
    v_xor_b32 v71, 0x80008000, v71
    s_mov_b64 exec, -1
    s_nop 0
    v_mfma_f32_32x32x16_bf16 v[0:15], v[64:67], v[176:179], 0
    v_mul_f32 v255, v32, v152
    v_fmac_f32 v255, v33, v153
    v_fmac_f32 v255, v34, v154
    v_fmac_f32 v255, v35, v155
    v_fmac_f32 v255, v36, v156
    v_fmac_f32 v255, v37, v157
    v_fmac_f32 v255, v38, v158
    v_fmac_f32 v255, v39, v159
    v_fmac_f32 v201, v40, v168
    v_fmac_f32 v201, v41, v169
    v_permlane32_swap_b32 v197, v255
    s_add_u32 m0, s21, 6144
    v_mfma_f32_32x32x16_bf16 v[16:31], v[68:71], v[176:179], v[16:31]
    v_lshl_add_u32 v240, v240, 10, v246
    v_lshl_add_u32 v241, v241, 10, v246
    buffer_load_dwordx4 v240, s[4:7], s41 offen lds
    buffer_load_dwordx4 v241, s[8:11], s41 offen offset:1024 lds
    v_fmac_f32 v201, v42, v170
    v_fmac_f32 v201, v43, v171
    v_fmac_f32 v201, v44, v172
    v_fmac_f32 v201, v45, v173
    v_fmac_f32 v201, v46, v174
    v_fmac_f32 v201, v47, v175
    v_add_f32 v255, v197, v255
    s_set_gpr_idx_on s51, gpr_idx(DST)
    s_nop 0
    v_cvt_pk_bf16_f32 v206, v254, v255
    s_set_gpr_idx_off
    v_mfma_f32_32x32x16_bf16 v[32:47], v[64:67], v[180:183], 0
    v_mul_f32 v254, v0, v144
    v_fmac_f32 v254, v1, v145
    v_fmac_f32 v254, v2, v146
    v_fmac_f32 v254, v3, v147
    v_fmac_f32 v254, v4, v148
    v_fmac_f32 v254, v5, v149
    v_fmac_f32 v254, v6, v150
    v_fmac_f32 v254, v7, v151
    v_fma_f32 v202, v8, -v160, v202
    v_fma_f32 v202, v9, -v161, v202
    v_permlane32_swap_b32 v254, v200
    v_fma_f32 v202, v10, -v162, v202
    v_fma_f32 v202, v11, -v163, v202
    v_fma_f32 v202, v12, -v164, v202
    v_fma_f32 v202, v13, -v165, v202
    v_fma_f32 v202, v14, -v166, v202
    v_fma_f32 v202, v15, -v167, v202
    v_add_f32 v200, v254, v200
    v_fmac_f32 v198, v16, v112
    v_permlane32_swap_b32 v202, v254
    v_mfma_f32_32x32x16_bf16 v[48:63], v[68:71], v[180:183], v[48:63]
    s_waitcnt vmcnt(4)
    ds_read_b64_tr_b16 v[176:177], v244 offset:0
    ds_read_b64_tr_b16 v[178:179], v244 offset:1024
    ds_read_b64_tr_b16 v[180:181], v245 offset:0
    ds_read_b64_tr_b16 v[182:183], v245 offset:1024
    v_add_u32 v249, s48, v249
    v_add_u32 v250, s49, v250
    ds_read_b32 v252, v251 offset:16
    ds_read_b64_tr_b16 v[64:65], v249 offset:0
    ds_read_b64_tr_b16 v[68:69], v249 offset:64
    ds_read_b64_tr_b16 v[66:67], v249 offset:256
    ds_read_b64_tr_b16 v[70:71], v249 offset:320
    s_mov_b64 exec, s[54:55]
    ds_read_u16_d16_hi v242, v250 offset:0
    s_mov_b64 exec, -1
    v_fmac_f32 v198, v17, v113
    v_fmac_f32 v198, v18, v114
    v_fmac_f32 v198, v19, v115
    v_fmac_f32 v198, v20, v116
    v_fmac_f32 v198, v21, v117
    v_fmac_f32 v198, v22, v118
    v_fmac_f32 v198, v23, v119
    v_add_f32 v254, v202, v254
    v_mul_f32 v196, v24, v160
    v_fmac_f32 v196, v25, v161
    v_fmac_f32 v196, v26, v162
    v_fmac_f32 v196, v27, v163
    v_fmac_f32 v196, v28, v164
    v_fmac_f32 v196, v29, v165
    v_fmac_f32 v196, v30, v166
    v_fmac_f32 v196, v31, v167
    s_nop 1
    v_permlane32_swap_b32 v198, v196
    v_add_f32 v196, v198, v196
    v_mul_f32 v255, v32, v152
    v_fmac_f32 v255, v33, v153
    v_fmac_f32 v255, v34, v154
    v_fmac_f32 v255, v35, v155
    v_fmac_f32 v255, v36, v156
    v_fmac_f32 v255, v37, v157
    v_fmac_f32 v255, v38, v158
    v_fmac_f32 v255, v39, v159
    v_fma_f32 v203, v40, -v168, v203
    v_fma_f32 v203, v41, -v169, v203
    v_permlane32_swap_b32 v255, v201
    v_fma_f32 v203, v42, -v170, v203
    v_fma_f32 v203, v43, -v171, v203
    v_fma_f32 v203, v44, -v172, v203
    v_fma_f32 v203, v45, -v173, v203
    v_fma_f32 v203, v46, -v174, v203
    v_fma_f32 v203, v47, -v175, v203
    v_add_f32 v201, v255, v201
    v_fmac_f32 v199, v48, v120
    v_permlane32_swap_b32 v203, v255
    v_fmac_f32 v199, v49, v121
    v_fmac_f32 v199, v50, v122
    v_fmac_f32 v199, v51, v123
    v_fmac_f32 v199, v52, v124
    v_fmac_f32 v199, v53, v125
    v_fmac_f32 v199, v54, v126
    v_fmac_f32 v199, v55, v127
    v_add_f32 v255, v203, v255
    v_mul_f32 v197, v56, v168
    v_fmac_f32 v197, v57, v169
    v_fmac_f32 v197, v58, v170
    v_fmac_f32 v197, v59, v171
    v_fmac_f32 v197, v60, v172
    v_fmac_f32 v197, v61, v173
    v_fmac_f32 v197, v62, v174
    v_fmac_f32 v197, v63, v175
    s_nop 1
    v_permlane32_swap_b32 v199, v197
    v_add_f32 v197, v199, v197
    s_set_gpr_idx_on s51, gpr_idx(DST)
    s_nop 0
    v_cvt_pk_bf16_f32 v207, v200, v201
    v_cvt_pk_bf16_f32 v209, v254, v255
    v_cvt_pk_bf16_f32 v208, v196, v197
    s_set_gpr_idx_off
    s_add_u32 s50, s50, 1
    s_add_u32 s51, s51, 6
    s_cmp_ge_u32 s50, 4
    s_cbranch_scc1 LAST0
    s_waitcnt lgkmcnt(5)
    v_readfirstlane_b32 s66, v252
    s_add_u32 s53, s53, 1
    v_mov_b32 v252, s53
    s_cmp_le_u32 s53, s66
    ds_write2_b32 v251, v252, v252 offset0:0 offset1:8
    s_setprio 1
    s_cbranch_scc1 PRIO_10
    s_setprio 0
PRIO_10:
    s_cmp_eq_u32 s52, 4
    s_cbranch_scc1 ITEM_0_4
    s_cmp_eq_u32 s52, 5
    s_cbranch_scc1 ITEM_0_5
    s_cmp_eq_u32 s52, 3
    s_cbranch_scc1 ITEM_0_3
    s_cmp_eq_u32 s52, 6
    s_cbranch_scc1 ITEM_0_6
    s_cmp_eq_u32 s52, 8
    s_cbranch_scc1 ITEM_0_8
    s_branch ITEM_0_2
.p2align 6
ITEM_1_4:
    s_mov_b64 exec, s[54:55]
    ds_read_u16_d16_hi v243, v250 offset:128
    s_mov_b64 exec, -1
    ds_read_b64_tr_b16 v[72:73], v249 offset:512
    ds_read_b64_tr_b16 v[76:77], v249 offset:576
    ds_read_b64_tr_b16 v[74:75], v249 offset:768
    ds_read_b64_tr_b16 v[78:79], v249 offset:832
    s_waitcnt lgkmcnt(5)
    v_mul_f32_dpp v196, v242, v64 row_newbcast:0 row_mask:0xf bank_mask:0xf
    v_mul_f32_dpp v197, v242, v65 row_newbcast:1 row_mask:0xf bank_mask:0xf
    v_mul_f32_dpp v198, v242, v64 row_newbcast:8 row_mask:0xf bank_mask:0xf
    v_mul_f32_dpp v199, v242, v65 row_newbcast:9 row_mask:0xf bank_mask:0xf
    v_mul_f32_dpp v200, v242, v68 row_newbcast:2 row_mask:0xf bank_mask:0xf
    v_mul_f32_dpp v201, v242, v69 row_newbcast:3 row_mask:0xf bank_mask:0xf
    v_mul_f32_dpp v202, v242, v68 row_newbcast:10 row_mask:0xf bank_mask:0xf
    v_mul_f32_dpp v203, v242, v69 row_newbcast:11 row_mask:0xf bank_mask:0xf
    v_cvt_pk_bf16_f32 v64, v196, v197
    v_cvt_pk_bf16_f32 v68, v198, v199
    v_cvt_pk_bf16_f32 v65, v200, v201
    v_cvt_pk_bf16_f32 v69, v202, v203
    v_mul_f32_dpp v196, v242, v66 row_newbcast:4 row_mask:0xf bank_mask:0xf
    v_mul_f32_dpp v197, v242, v67 row_newbcast:5 row_mask:0xf bank_mask:0xf
    v_mul_f32_dpp v198, v242, v66 row_newbcast:12 row_mask:0xf bank_mask:0xf
    v_mul_f32_dpp v199, v242, v67 row_newbcast:13 row_mask:0xf bank_mask:0xf
    v_mul_f32_dpp v200, v242, v70 row_newbcast:6 row_mask:0xf bank_mask:0xf
    v_mul_f32_dpp v201, v242, v71 row_newbcast:7 row_mask:0xf bank_mask:0xf
    v_mul_f32_dpp v202, v242, v70 row_newbcast:14 row_mask:0xf bank_mask:0xf
    v_mul_f32_dpp v203, v242, v71 row_newbcast:15 row_mask:0xf bank_mask:0xf
    v_cvt_pk_bf16_f32 v66, v196, v197
    v_cvt_pk_bf16_f32 v70, v198, v199
    v_cvt_pk_bf16_f32 v67, v200, v201
    v_cvt_pk_bf16_f32 v71, v202, v203
    s_nop 0
    s_waitcnt vmcnt(4) lgkmcnt(0)
    v_mfma_f32_32x32x16_bf16 v[0:15], v[64:67], v[176:179], 0
    v_mul_f32_dpp v196, v243, v72 row_newbcast:0 row_mask:0xf bank_mask:0xf
    v_mul_f32_dpp v197, v243, v73 row_newbcast:1 row_mask:0xf bank_mask:0xf
    v_mul_f32_dpp v198, v243, v72 row_newbcast:8 row_mask:0xf bank_mask:0xf
    v_mul_f32_dpp v199, v243, v73 row_newbcast:9 row_mask:0xf bank_mask:0xf
    v_mul_f32_dpp v200, v243, v76 row_newbcast:2 row_mask:0xf bank_mask:0xf
    v_mul_f32_dpp v201, v243, v77 row_newbcast:3 row_mask:0xf bank_mask:0xf
    v_mul_f32_dpp v202, v243, v76 row_newbcast:10 row_mask:0xf bank_mask:0xf
    v_mul_f32_dpp v203, v243, v77 row_newbcast:11 row_mask:0xf bank_mask:0xf
    v_cvt_pk_bf16_f32 v72, v196, v197
    v_cvt_pk_bf16_f32 v76, v198, v199
    v_cvt_pk_bf16_f32 v73, v200, v201
    v_cvt_pk_bf16_f32 v77, v202, v203
    s_add_u32 m0, s21, 0
    v_mfma_f32_32x32x16_bf16 v[16:31], v[68:71], v[176:179], 0
    buffer_load_dwordx4 v234, s[4:7], s36 offen lds
    buffer_load_dwordx4 v235, s[8:11], s36 offen offset:1024 lds
    ds_read_b64_tr_b16 v[176:177], v244 offset:2048
    ds_read_b64_tr_b16 v[178:179], v244 offset:3072
    ds_read_b64_tr_b16 v[184:185], v245 offset:2048
    ds_read_b64_tr_b16 v[186:187], v245 offset:3072
    v_mul_f32_dpp v196, v243, v74 row_newbcast:4 row_mask:0xf bank_mask:0xf
    v_mul_f32_dpp v197, v243, v75 row_newbcast:5 row_mask:0xf bank_mask:0xf
    v_mul_f32_dpp v198, v243, v74 row_newbcast:12 row_mask:0xf bank_mask:0xf
    v_mul_f32_dpp v199, v243, v75 row_newbcast:13 row_mask:0xf bank_mask:0xf
    v_mul_f32_dpp v200, v243, v78 row_newbcast:6 row_mask:0xf bank_mask:0xf
    v_mul_f32_dpp v201, v243, v79 row_newbcast:7 row_mask:0xf bank_mask:0xf
    v_mul_f32_dpp v202, v243, v78 row_newbcast:14 row_mask:0xf bank_mask:0xf
    v_mul_f32_dpp v203, v243, v79 row_newbcast:15 row_mask:0xf bank_mask:0xf
    v_cvt_pk_bf16_f32 v74, v196, v197
    v_cvt_pk_bf16_f32 v78, v198, v199
    v_cvt_pk_bf16_f32 v75, v200, v201
    v_cvt_pk_bf16_f32 v79, v202, v203
    s_nop 0
    s_waitcnt lgkmcnt(0)
    v_mfma_f32_32x32x16_bf16 v[0:15], v[72:75], v[176:179], v[0:15]
    s_add_u32 m0, s21, 2048
    v_mfma_f32_32x32x16_bf16 v[16:31], v[76:79], v[176:179], v[16:31]
    buffer_load_dwordx4 v236, s[4:7], s36 offen lds
    buffer_load_dwordx4 v237, s[8:11], s36 offen offset:1024 lds
    s_mov_b32 m0, s50
    s_nop 0
    s_movrels_b32 s71, s23
    s_movrels_b32 s33, s28
    s_and_b32 s70, s33, 0x70
    s_andn2_b32 s33, s33, 0x70
    v_xor_b32 v253, s70, v248
    v_add_u32 v253, s33, v253
    s_bfe_u32 s46, s71, 0x30012
    s_mov_b32 m0, s46
    s_and_b32 s66, s71, 0x3ffff
    s_movrels_b32 s68, s57
    s_movrels_b32 s69, s61
    s_sub_u32 s48, s66, s47
    s_mov_b32 s47, s66
    s_lshr_b32 s52, s71, 28
    s_lshl_b32 s67, s46, 9
    s_add_u32 s66, s66, s67
    s_sub_u32 s49, s66, s42
    s_mov_b32 s42, s66
    s_bfe_u32 s66, s68, 655360
    s_add_u32 s43, s42, s66
    s_bfe_u32 s39, s69, 655360
    s_bfe_u32 s66, s68, 655370
    s_add_u32 s44, s42, s66
    s_bfe_u32 s40, s69, 655370
    s_bfe_u32 s66, s68, 655380
    s_add_u32 s45, s42, s66
    s_bfe_u32 s41, s69, 655380
    v_add_u32 v252, s44, v247
    ds_read_u16 v238, v252
    ds_read_u16 v239, v252 offset:64
    v_add_u32 v252, s45, v247
    ds_read_u16 v240, v252
    ds_read_u16 v241, v252 offset:64
    v_mfma_f32_32x32x16_bf16 v[32:47], v[64:67], v[180:183], 0
    v_mul_f32 v196, v0, v96
    v_fmac_f32 v196, v1, v97
    v_fmac_f32 v196, v2, v98
    v_fmac_f32 v196, v3, v99
    v_fmac_f32 v196, v4, v100
    v_fmac_f32 v196, v5, v101
    v_fmac_f32 v196, v6, v102
    v_fmac_f32 v196, v7, v103
    v_mul_f32 v198, v8, v128
    v_fmac_f32 v198, v9, v129
    v_mfma_f32_32x32x16_bf16 v[48:63], v[68:71], v[180:183], 0
    s_waitcnt vmcnt(6)
    ds_read_b64_tr_b16 v[176:177], v244 offset:4096
    ds_read_b64_tr_b16 v[178:179], v244 offset:5120
    ds_read_b64_tr_b16 v[180:181], v245 offset:4096
    ds_read_b64_tr_b16 v[182:183], v245 offset:5120
    v_fmac_f32 v198, v10, v130
    v_fmac_f32 v198, v11, v131
    v_fmac_f32 v198, v12, v132
    v_fmac_f32 v198, v13, v133
    v_fmac_f32 v198, v14, v134
    v_fmac_f32 v198, v15, v135
    v_mul_f32 v200, v16, v128
    v_fmac_f32 v200, v17, v129
    v_permlane32_swap_b32 v196, v198
    v_mfma_f32_32x32x16_bf16 v[32:47], v[72:75], v[184:187], v[32:47]
    v_fmac_f32 v200, v18, v130
    v_fmac_f32 v200, v19, v131
    v_fmac_f32 v200, v20, v132
    v_fmac_f32 v200, v21, v133
    v_fmac_f32 v200, v22, v134
    v_fmac_f32 v200, v23, v135
    v_add_f32 v198, v196, v198
    v_mul_f32_e64 v202, v24, -v128
    v_fma_f32 v202, v25, -v129, v202
    v_mfma_f32_32x32x16_bf16 v[48:63], v[76:79], v[184:187], v[48:63]
    v_fma_f32 v202, v26, -v130, v202
    v_fma_f32 v202, v27, -v131, v202
    v_fma_f32 v202, v28, -v132, v202
    v_fma_f32 v202, v29, -v133, v202
    v_fma_f32 v202, v30, -v134, v202
    v_fma_f32 v202, v31, -v135, v202
    s_nop 1
    v_permlane32_swap_b32 v200, v202
    v_add_f32 v202, v200, v202
    s_waitcnt vmcnt(4) lgkmcnt(0)
    v_mfma_f32_32x32x16_bf16 v[0:15], v[64:67], v[176:179], 0
    v_mul_f32 v197, v32, v104
    v_fmac_f32 v197, v33, v105
    v_fmac_f32 v197, v34, v106
    v_fmac_f32 v197, v35, v107
    v_fmac_f32 v197, v36, v108
    v_fmac_f32 v197, v37, v109
    v_fmac_f32 v197, v38, v110
    v_fmac_f32 v197, v39, v111
    v_mul_f32 v199, v40, v136
    v_fmac_f32 v199, v41, v137
    s_add_u32 m0, s21, 4096
    v_mfma_f32_32x32x16_bf16 v[16:31], v[68:71], v[176:179], 0
    buffer_load_dwordx4 v234, s[4:7], s37 offen lds
    buffer_load_dwordx4 v235, s[8:11], s37 offen offset:1024 lds
    ds_read_b64_tr_b16 v[176:177], v244 offset:6144
    ds_read_b64_tr_b16 v[178:179], v244 offset:7168
    ds_read_b64_tr_b16 v[184:185], v245 offset:6144
    ds_read_b64_tr_b16 v[186:187], v245 offset:7168
    v_add_u32 v252, s42, v247
    ds_read_u16 v234, v252
    ds_read_u16 v235, v252 offset:64
    v_fmac_f32 v199, v42, v138
    v_fmac_f32 v199, v43, v139
    v_fmac_f32 v199, v44, v140
    v_fmac_f32 v199, v45, v141
    v_fmac_f32 v199, v46, v142
    v_fmac_f32 v199, v47, v143
    v_mul_f32 v201, v48, v136
    v_fmac_f32 v201, v49, v137
    v_permlane32_swap_b32 v197, v199
    v_fmac_f32 v201, v50, v138
    s_waitcnt lgkmcnt(2)
    v_mfma_f32_32x32x16_bf16 v[0:15], v[72:75], v[176:179], v[0:15]
    v_fmac_f32 v201, v51, v139
    v_fmac_f32 v201, v52, v140
    v_fmac_f32 v201, v53, v141
    v_fmac_f32 v201, v54, v142
    v_fmac_f32 v201, v55, v143
    v_add_f32 v199, v197, v199
    v_mul_f32_e64 v203, v56, -v136
    v_fma_f32 v203, v57, -v137, v203
    v_fma_f32 v203, v58, -v138, v203
    v_fma_f32 v203, v59, -v139, v203
    s_add_u32 m0, s21, 6144
    v_mfma_f32_32x32x16_bf16 v[16:31], v[76:79], v[176:179], v[16:31]
    buffer_load_dwordx4 v236, s[4:7], s37 offen lds
    buffer_load_dwordx4 v237, s[8:11], s37 offen offset:1024 lds
    v_add_u32 v252, s43, v247
    ds_read_u16 v236, v252
    ds_read_u16 v237, v252 offset:64
    v_fma_f32 v203, v60, -v140, v203
    v_fma_f32 v203, v61, -v141, v203
    v_fma_f32 v203, v62, -v142, v203
    v_fma_f32 v203, v63, -v143, v203
    s_nop 1
    v_permlane32_swap_b32 v201, v203
    v_add_f32 v203, v201, v203
    v_cvt_pk_bf16_f32 v198, v198, v199
    v_cvt_pk_bf16_f32 v202, v202, v203
    ds_write2st64_b32 v253, v198, v202 offset0:0 offset1:1
    v_mfma_f32_32x32x16_bf16 v[32:47], v[64:67], v[180:183], 0
    v_mul_f32 v196, v0, v144
    v_fmac_f32 v196, v1, v145
    v_fmac_f32 v196, v2, v146
    v_fmac_f32 v196, v3, v147
    v_fmac_f32 v196, v4, v148
    v_fmac_f32 v196, v5, v149
    v_fmac_f32 v196, v6, v150
    v_fmac_f32 v196, v7, v151
    v_mfma_f32_32x32x16_bf16 v[48:63], v[68:71], v[180:183], 0
    s_waitcnt vmcnt(6)
    ds_read_b64_tr_b16 v[176:177], v244 offset:0
    ds_read_b64_tr_b16 v[178:179], v244 offset:1024
    ds_read_b64_tr_b16 v[180:181], v245 offset:0
    ds_read_b64_tr_b16 v[182:183], v245 offset:1024
    v_mul_f32 v198, v8, v112
    v_fmac_f32 v198, v9, v113
    v_fmac_f32 v198, v10, v114
    v_fmac_f32 v198, v11, v115
    v_fmac_f32 v198, v12, v116
    v_fmac_f32 v198, v13, v117
    v_fmac_f32 v198, v14, v118
    v_fmac_f32 v198, v15, v119
    v_mfma_f32_32x32x16_bf16 v[32:47], v[72:75], v[184:187], v[32:47]
    v_mul_f32_e64 v200, v16, -v160
    v_fma_f32 v200, v17, -v161, v200
    v_fma_f32 v200, v18, -v162, v200
    v_fma_f32 v200, v19, -v163, v200
    v_fma_f32 v200, v20, -v164, v200
    v_fma_f32 v200, v21, -v165, v200
    v_fma_f32 v200, v22, -v166, v200
    v_fma_f32 v200, v23, -v167, v200
    v_mfma_f32_32x32x16_bf16 v[48:63], v[76:79], v[184:187], v[48:63]
    v_mul_f32_e64 v202, v24, -v160
    v_fma_f32 v202, v25, -v161, v202
    v_fma_f32 v202, v26, -v162, v202
    v_fma_f32 v202, v27, -v163, v202
    v_fma_f32 v202, v28, -v164, v202
    v_fma_f32 v202, v29, -v165, v202
    v_fma_f32 v202, v30, -v166, v202
    v_fma_f32 v202, v31, -v167, v202
    s_waitcnt vmcnt(4) lgkmcnt(0)
    v_mfma_f32_32x32x16_bf16 v[0:15], v[64:67], v[176:179], 0
    v_mul_f32 v197, v32, v152
    v_fmac_f32 v197, v33, v153
    v_fmac_f32 v197, v34, v154
    v_fmac_f32 v197, v35, v155
    v_fmac_f32 v197, v36, v156
    v_fmac_f32 v197, v37, v157
    v_fmac_f32 v197, v38, v158
    v_fmac_f32 v197, v39, v159
    s_add_u32 m0, s21, 0
    v_mfma_f32_32x32x16_bf16 v[16:31], v[68:71], v[176:179], 0
    v_lshl_add_u32 v234, v234, 10, v246
    v_lshl_add_u32 v235, v235, 10, v246
    buffer_load_dwordx4 v234, s[4:7], s38 offen lds
    buffer_load_dwordx4 v235, s[8:11], s38 offen offset:1024 lds
    ds_read_b64_tr_b16 v[176:177], v244 offset:2048
    ds_read_b64_tr_b16 v[178:179], v244 offset:3072
    ds_read_b64_tr_b16 v[184:185], v245 offset:2048
    ds_read_b64_tr_b16 v[186:187], v245 offset:3072
    v_mul_f32 v199, v40, v120
    v_fmac_f32 v199, v41, v121
    v_fmac_f32 v199, v42, v122
    v_fmac_f32 v199, v43, v123
    v_fmac_f32 v199, v44, v124
    v_fmac_f32 v199, v45, v125
    v_fmac_f32 v199, v46, v126
    v_fmac_f32 v199, v47, v127
    s_waitcnt lgkmcnt(0)
    v_mfma_f32_32x32x16_bf16 v[0:15], v[72:75], v[176:179], v[0:15]
    v_mul_f32_e64 v201, v48, -v168
    v_fma_f32 v201, v49, -v169, v201
    v_fma_f32 v201, v50, -v170, v201
    v_fma_f32 v201, v51, -v171, v201
    v_fma_f32 v201, v52, -v172, v201
    v_fma_f32 v201, v53, -v173, v201
    v_fma_f32 v201, v54, -v174, v201
    v_fma_f32 v201, v55, -v175, v201
    s_add_u32 m0, s21, 2048
    v_mfma_f32_32x32x16_bf16 v[16:31], v[76:79], v[176:179], v[16:31]
    v_lshl_add_u32 v236, v236, 10, v246
    v_lshl_add_u32 v237, v237, 10, v246
    buffer_load_dwordx4 v236, s[4:7], s39 offen lds
    buffer_load_dwordx4 v237, s[8:11], s39 offen offset:1024 lds
    v_mul_f32_e64 v203, v56, -v168
    v_fma_f32 v203, v57, -v169, v203
    v_fma_f32 v203, v58, -v170, v203
    v_fma_f32 v203, v59, -v171, v203
    v_fma_f32 v203, v60, -v172, v203
    v_fma_f32 v203, v61, -v173, v203
    v_fma_f32 v203, v62, -v174, v203
    v_fma_f32 v203, v63, -v175, v203
    v_mfma_f32_32x32x16_bf16 v[32:47], v[64:67], v[180:183], 0
    v_mul_f32 v254, v0, v144
    v_fmac_f32 v254, v1, v145
    v_fmac_f32 v254, v2, v146
    v_fmac_f32 v254, v3, v147
    v_fmac_f32 v254, v4, v148
    v_mfma_f32_32x32x16_bf16 v[48:63], v[68:71], v[180:183], 0
    ds_swizzle_b32 v68, v68 offset:0x401F
    ds_swizzle_b32 v69, v69 offset:0x401F
    ds_swizzle_b32 v70, v70 offset:0x401F
    ds_swizzle_b32 v71, v71 offset:0x401F
    s_waitcnt vmcnt(6)
    ds_read_b64_tr_b16 v[176:177], v244 offset:4096
    ds_read_b64_tr_b16 v[178:179], v244 offset:5120
    ds_read_b64_tr_b16 v[180:181], v245 offset:4096
    ds_read_b64_tr_b16 v[182:183], v245 offset:5120
    v_fmac_f32 v254, v5, v149
    v_fmac_f32 v254, v6, v150
    v_fmac_f32 v254, v7, v151
    v_fmac_f32 v200, v8, v160
    v_mfma_f32_32x32x16_bf16 v[32:47], v[72:75], v[184:187], v[32:47]
    v_fmac_f32 v200, v9, v161
    v_permlane32_swap_b32 v196, v254
    v_fmac_f32 v200, v10, v162
    v_fmac_f32 v200, v11, v163
    v_fmac_f32 v200, v12, v164
    v_mfma_f32_32x32x16_bf16 v[48:63], v[76:79], v[184:187], v[48:63]
    ds_swizzle_b32 v76, v76 offset:0x401F
    ds_swizzle_b32 v77, v77 offset:0x401F
    ds_swizzle_b32 v78, v78 offset:0x401F
    ds_swizzle_b32 v79, v79 offset:0x401F
    v_fmac_f32 v200, v13, v165
    v_fmac_f32 v200, v14, v166
    v_fmac_f32 v200, v15, v167
    v_add_f32 v254, v196, v254
    s_waitcnt lgkmcnt(8)
    s_mov_b64 exec, s[56:57]
    v_xor_b32 v68, 0x80008000, v68
    v_xor_b32 v69, 0x80008000, v69
    v_xor_b32 v70, 0x80008000, v70
    v_xor_b32 v71, 0x80008000, v71
    s_mov_b64 exec, -1
    s_waitcnt vmcnt(4) lgkmcnt(4)
    v_mfma_f32_32x32x16_bf16 v[0:15], v[64:67], v[176:179], 0
    v_mul_f32 v255, v32, v152
    v_fmac_f32 v255, v33, v153
    v_fmac_f32 v255, v34, v154
    v_fmac_f32 v255, v35, v155
    v_fmac_f32 v255, v36, v156
    s_add_u32 m0, s21, 4096
    v_mfma_f32_32x32x16_bf16 v[16:31], v[68:71], v[176:179], v[16:31]
    v_lshl_add_u32 v238, v238, 10, v246
    v_lshl_add_u32 v239, v239, 10, v246
    buffer_load_dwordx4 v238, s[4:7], s40 offen lds
    buffer_load_dwordx4 v239, s[8:11], s40 offen offset:1024 lds
    ds_read_b64_tr_b16 v[176:177], v244 offset:6144
    ds_read_b64_tr_b16 v[178:179], v244 offset:7168
    ds_read_b64_tr_b16 v[184:185], v245 offset:6144
    ds_read_b64_tr_b16 v[186:187], v245 offset:7168
    v_fmac_f32 v255, v37, v157
    v_fmac_f32 v255, v38, v158
    v_fmac_f32 v255, v39, v159
    v_fmac_f32 v201, v40, v168
    v_fmac_f32 v201, v41, v169
    s_waitcnt lgkmcnt(0)
    s_mov_b64 exec, s[56:57]
    v_xor_b32 v76, 0x80008000, v76
    v_xor_b32 v77, 0x80008000, v77
    v_xor_b32 v78, 0x80008000, v78
    v_xor_b32 v79, 0x80008000, v79
    s_mov_b64 exec, -1
    v_mfma_f32_32x32x16_bf16 v[0:15], v[72:75], v[176:179], v[0:15]
    v_permlane32_swap_b32 v197, v255
    v_fmac_f32 v201, v42, v170
    v_fmac_f32 v201, v43, v171
    v_fmac_f32 v201, v44, v172
    v_fmac_f32 v201, v45, v173
    s_add_u32 m0, s21, 6144
    v_mfma_f32_32x32x16_bf16 v[16:31], v[76:79], v[176:179], v[16:31]
    v_lshl_add_u32 v240, v240, 10, v246
    v_lshl_add_u32 v241, v241, 10, v246
    buffer_load_dwordx4 v240, s[4:7], s41 offen lds
    buffer_load_dwordx4 v241, s[8:11], s41 offen offset:1024 lds
    v_fmac_f32 v201, v46, v174
    v_fmac_f32 v201, v47, v175
    v_add_f32 v255, v197, v255
    v_cvt_pk_bf16_f32 v254, v254, v255
    ds_write_b32 v253, v254 offset:512
    v_mfma_f32_32x32x16_bf16 v[32:47], v[64:67], v[180:183], 0
    v_mul_f32 v254, v0, v144
    v_fmac_f32 v254, v1, v145
    v_fmac_f32 v254, v2, v146
    v_fmac_f32 v254, v3, v147
    v_fmac_f32 v254, v4, v148
    v_fmac_f32 v254, v5, v149
    v_fmac_f32 v254, v6, v150
    v_fmac_f32 v254, v7, v151
    v_fma_f32 v202, v8, -v160, v202
    v_fma_f32 v202, v9, -v161, v202
    v_mfma_f32_32x32x16_bf16 v[48:63], v[68:71], v[180:183], v[48:63]
    s_waitcnt vmcnt(6)
    ds_read_b64_tr_b16 v[176:177], v244 offset:0
    ds_read_b64_tr_b16 v[178:179], v244 offset:1024
    ds_read_b64_tr_b16 v[180:181], v245 offset:0
    ds_read_b64_tr_b16 v[182:183], v245 offset:1024
    v_permlane32_swap_b32 v254, v200
    v_fma_f32 v202, v10, -v162, v202
    v_fma_f32 v202, v11, -v163, v202
    v_fma_f32 v202, v12, -v164, v202
    v_fma_f32 v202, v13, -v165, v202
    v_fma_f32 v202, v14, -v166, v202
    v_fma_f32 v202, v15, -v167, v202
    v_add_f32 v200, v254, v200
    v_fmac_f32 v198, v16, v112
    v_permlane32_swap_b32 v202, v254
    v_mfma_f32_32x32x16_bf16 v[32:47], v[72:75], v[184:187], v[32:47]
    v_fmac_f32 v198, v17, v113
    v_fmac_f32 v198, v18, v114
    v_fmac_f32 v198, v19, v115
    v_fmac_f32 v198, v20, v116
    v_fmac_f32 v198, v21, v117
    v_fmac_f32 v198, v22, v118
    v_fmac_f32 v198, v23, v119
    v_add_f32 v254, v202, v254
    v_mul_f32 v196, v24, v160
    v_fmac_f32 v196, v25, v161
    v_mfma_f32_32x32x16_bf16 v[48:63], v[76:79], v[184:187], v[48:63]
    v_add_u32 v249, s48, v249
    v_add_u32 v250, s49, v250
    ds_read_b32 v252, v251 offset:16
    ds_read_b64_tr_b16 v[64:65], v249 offset:0
    ds_read_b64_tr_b16 v[68:69], v249 offset:64
    ds_read_b64_tr_b16 v[66:67], v249 offset:256
    ds_read_b64_tr_b16 v[70:71], v249 offset:320
    s_mov_b64 exec, s[54:55]
    ds_read_u16_d16_hi v242, v250 offset:0
    s_mov_b64 exec, -1
    v_fmac_f32 v196, v26, v162
    v_fmac_f32 v196, v27, v163
    v_fmac_f32 v196, v28, v164
    v_fmac_f32 v196, v29, v165
    v_fmac_f32 v196, v30, v166
    v_fmac_f32 v196, v31, v167
    s_nop 1
    v_permlane32_swap_b32 v198, v196
    v_add_f32 v196, v198, v196
    v_mul_f32 v255, v32, v152
    v_fmac_f32 v255, v33, v153
    v_fmac_f32 v255, v34, v154
    v_fmac_f32 v255, v35, v155
    v_fmac_f32 v255, v36, v156
    v_fmac_f32 v255, v37, v157
    v_fmac_f32 v255, v38, v158
    v_fmac_f32 v255, v39, v159
    v_fma_f32 v203, v40, -v168, v203
    v_fma_f32 v203, v41, -v169, v203
    v_permlane32_swap_b32 v255, v201
    v_fma_f32 v203, v42, -v170, v203
    v_fma_f32 v203, v43, -v171, v203
    v_fma_f32 v203, v44, -v172, v203
    v_fma_f32 v203, v45, -v173, v203
    v_fma_f32 v203, v46, -v174, v203
    v_fma_f32 v203, v47, -v175, v203
    v_add_f32 v201, v255, v201
    v_fmac_f32 v199, v48, v120
    v_permlane32_swap_b32 v203, v255
    v_fmac_f32 v199, v49, v121
    v_fmac_f32 v199, v50, v122
    v_fmac_f32 v199, v51, v123
    v_fmac_f32 v199, v52, v124
    v_fmac_f32 v199, v53, v125
    v_fmac_f32 v199, v54, v126
    v_fmac_f32 v199, v55, v127
    v_add_f32 v255, v203, v255
    v_mul_f32 v197, v56, v168
    v_fmac_f32 v197, v57, v169
    v_fmac_f32 v197, v58, v170
    v_fmac_f32 v197, v59, v171
    v_fmac_f32 v197, v60, v172
    v_fmac_f32 v197, v61, v173
    v_fmac_f32 v197, v62, v174
    v_fmac_f32 v197, v63, v175
    s_nop 1
    v_permlane32_swap_b32 v199, v197
    v_add_f32 v197, v199, v197
    v_cvt_pk_bf16_f32 v200, v200, v201
    v_cvt_pk_bf16_f32 v254, v254, v255
    v_cvt_pk_bf16_f32 v196, v196, v197
    ds_write2st64_b32 v253, v200, v196 offset0:3 offset1:4
    s_mov_b64 exec, 0xffffffff
    ds_write_b32 v253, v254 offset:1280
    s_mov_b64 exec, -1
    s_add_u32 s50, s50, 1
    s_cmp_ge_u32 s50, 4
    s_cbranch_scc1 LAST1
    s_waitcnt lgkmcnt(7)
    v_readfirstlane_b32 s66, v252
    s_add_u32 s53, s53, 1
    v_mov_b32 v252, s53
    s_cmp_le_u32 s53, s66
    ds_write2_b32 v251, v252, v252 offset0:0 offset1:8
    s_setprio 1
    s_cbranch_scc1 PRIO_11
    s_setprio 0
PRIO_11:
    s_cmp_eq_u32 s52, 4
    s_cbranch_scc1 ITEM_1_4
    s_cmp_eq_u32 s52, 5
    s_cbranch_scc1 ITEM_1_5
    s_cmp_eq_u32 s52, 3
    s_cbranch_scc1 ITEM_1_3
    s_cmp_eq_u32 s52, 6
    s_cbranch_scc1 ITEM_1_6
    s_cmp_eq_u32 s52, 8
    s_cbranch_scc1 ITEM_1_8
    s_branch ITEM_1_2
.p2align 6
ITEM_1_5:
    s_mov_b64 exec, s[54:55]
    ds_read_u16_d16_hi v243, v250 offset:128
    s_mov_b64 exec, -1
    ds_read_b64_tr_b16 v[72:73], v249 offset:512
    ds_read_b64_tr_b16 v[76:77], v249 offset:576
    ds_read_b64_tr_b16 v[74:75], v249 offset:768
    ds_read_b64_tr_b16 v[78:79], v249 offset:832
    ds_read_b64_tr_b16 v[80:81], v249 offset:1024
    ds_read_b64_tr_b16 v[84:85], v249 offset:1088
    s_waitcnt lgkmcnt(7)
    v_mul_f32_dpp v196, v242, v64 row_newbcast:0 row_mask:0xf bank_mask:0xf
    v_mul_f32_dpp v197, v242, v65 row_newbcast:1 row_mask:0xf bank_mask:0xf
    v_mul_f32_dpp v198, v242, v64 row_newbcast:8 row_mask:0xf bank_mask:0xf
    v_mul_f32_dpp v199, v242, v65 row_newbcast:9 row_mask:0xf bank_mask:0xf
    v_mul_f32_dpp v200, v242, v68 row_newbcast:2 row_mask:0xf bank_mask:0xf
    v_mul_f32_dpp v201, v242, v69 row_newbcast:3 row_mask:0xf bank_mask:0xf
    v_mul_f32_dpp v202, v242, v68 row_newbcast:10 row_mask:0xf bank_mask:0xf
    v_mul_f32_dpp v203, v242, v69 row_newbcast:11 row_mask:0xf bank_mask:0xf
    v_cvt_pk_bf16_f32 v64, v196, v197
    v_cvt_pk_bf16_f32 v68, v198, v199
    v_cvt_pk_bf16_f32 v65, v200, v201
    v_cvt_pk_bf16_f32 v69, v202, v203
    v_mul_f32_dpp v196, v242, v66 row_newbcast:4 row_mask:0xf bank_mask:0xf
    v_mul_f32_dpp v197, v242, v67 row_newbcast:5 row_mask:0xf bank_mask:0xf
    v_mul_f32_dpp v198, v242, v66 row_newbcast:12 row_mask:0xf bank_mask:0xf
    v_mul_f32_dpp v199, v242, v67 row_newbcast:13 row_mask:0xf bank_mask:0xf
    v_mul_f32_dpp v200, v242, v70 row_newbcast:6 row_mask:0xf bank_mask:0xf
    v_mul_f32_dpp v201, v242, v71 row_newbcast:7 row_mask:0xf bank_mask:0xf
    v_mul_f32_dpp v202, v242, v70 row_newbcast:14 row_mask:0xf bank_mask:0xf
    v_mul_f32_dpp v203, v242, v71 row_newbcast:15 row_mask:0xf bank_mask:0xf
    v_cvt_pk_bf16_f32 v66, v196, v197
    v_cvt_pk_bf16_f32 v70, v198, v199
    v_cvt_pk_bf16_f32 v67, v200, v201
    v_cvt_pk_bf16_f32 v71, v202, v203
    s_mov_b64 exec, s[54:55]
    ds_read_u16_d16_hi v242, v250 offset:256
    s_mov_b64 exec, -1
    s_waitcnt vmcnt(4) lgkmcnt(3)
    v_mfma_f32_32x32x16_bf16 v[0:15], v[64:67], v[176:179], 0
    v_mul_f32_dpp v196, v243, v72 row_newbcast:0 row_mask:0xf bank_mask:0xf
    v_mul_f32_dpp v197, v243, v73 row_newbcast:1 row_mask:0xf bank_mask:0xf
    v_mul_f32_dpp v198, v243, v72 row_newbcast:8 row_mask:0xf bank_mask:0xf
    v_mul_f32_dpp v199, v243, v73 row_newbcast:9 row_mask:0xf bank_mask:0xf
    v_mul_f32_dpp v200, v243, v76 row_newbcast:2 row_mask:0xf bank_mask:0xf
    v_mul_f32_dpp v201, v243, v77 row_newbcast:3 row_mask:0xf bank_mask:0xf
    v_mul_f32_dpp v202, v243, v76 row_newbcast:10 row_mask:0xf bank_mask:0xf
    v_mul_f32_dpp v203, v243, v77 row_newbcast:11 row_mask:0xf bank_mask:0xf
    v_cvt_pk_bf16_f32 v72, v196, v197
    v_cvt_pk_bf16_f32 v76, v198, v199
    v_cvt_pk_bf16_f32 v73, v200, v201
    v_cvt_pk_bf16_f32 v77, v202, v203
    s_add_u32 m0, s21, 0
    v_mfma_f32_32x32x16_bf16 v[16:31], v[68:71], v[176:179], 0
    buffer_load_dwordx4 v236, s[4:7], s35 offen lds
    buffer_load_dwordx4 v237, s[8:11], s35 offen offset:1024 lds
    ds_read_b64_tr_b16 v[176:177], v244 offset:2048
    ds_read_b64_tr_b16 v[178:179], v244 offset:3072
    ds_read_b64_tr_b16 v[184:185], v245 offset:2048
    ds_read_b64_tr_b16 v[186:187], v245 offset:3072
    v_mul_f32_dpp v196, v243, v74 row_newbcast:4 row_mask:0xf bank_mask:0xf
    v_mul_f32_dpp v197, v243, v75 row_newbcast:5 row_mask:0xf bank_mask:0xf
    v_mul_f32_dpp v198, v243, v74 row_newbcast:12 row_mask:0xf bank_mask:0xf
    v_mul_f32_dpp v199, v243, v75 row_newbcast:13 row_mask:0xf bank_mask:0xf
    v_mul_f32_dpp v200, v243, v78 row_newbcast:6 row_mask:0xf bank_mask:0xf
    v_mul_f32_dpp v201, v243, v79 row_newbcast:7 row_mask:0xf bank_mask:0xf
    v_mul_f32_dpp v202, v243, v78 row_newbcast:14 row_mask:0xf bank_mask:0xf
    v_mul_f32_dpp v203, v243, v79 row_newbcast:15 row_mask:0xf bank_mask:0xf
    v_cvt_pk_bf16_f32 v74, v196, v197
    v_cvt_pk_bf16_f32 v78, v198, v199
    v_cvt_pk_bf16_f32 v75, v200, v201
    v_cvt_pk_bf16_f32 v79, v202, v203
    s_nop 0
    s_waitcnt vmcnt(4) lgkmcnt(0)
    v_mfma_f32_32x32x16_bf16 v[0:15], v[72:75], v[176:179], v[0:15]
    v_mul_f32_dpp v196, v242, v80 row_newbcast:0 row_mask:0xf bank_mask:0xf
    v_mul_f32_dpp v197, v242, v81 row_newbcast:1 row_mask:0xf bank_mask:0xf
    v_mul_f32_dpp v198, v242, v80 row_newbcast:8 row_mask:0xf bank_mask:0xf
    v_mul_f32_dpp v199, v242, v81 row_newbcast:9 row_mask:0xf bank_mask:0xf
    v_mul_f32_dpp v200, v242, v84 row_newbcast:2 row_mask:0xf bank_mask:0xf
    v_mul_f32_dpp v201, v242, v85 row_newbcast:3 row_mask:0xf bank_mask:0xf
    s_add_u32 m0, s21, 2048
    v_mfma_f32_32x32x16_bf16 v[16:31], v[76:79], v[176:179], v[16:31]
    buffer_load_dwordx4 v238, s[4:7], s35 offen lds
    ds_read_b64_tr_b16 v[176:177], v244 offset:4096
    ds_read_b64_tr_b16 v[188:189], v245 offset:4096
    v_mul_f32_dpp v202, v242, v84 row_newbcast:10 row_mask:0xf bank_mask:0xf
    v_mul_f32_dpp v203, v242, v85 row_newbcast:11 row_mask:0xf bank_mask:0xf
    v_cvt_pk_bf16_f32 v80, v196, v197
    v_cvt_pk_bf16_f32 v84, v198, v199
    v_cvt_pk_bf16_f32 v81, v200, v201
    v_cvt_pk_bf16_f32 v85, v202, v203
    s_nop 0
    s_waitcnt lgkmcnt(0)
    v_mfma_f32_32x32x8_bf16 v[0:15], v[80:81], v[176:177], v[0:15]
    s_add_u32 m0, s21, 4096
    v_mfma_f32_32x32x8_bf16 v[16:31], v[84:85], v[176:177], v[16:31]
    buffer_load_dwordx4 v234, s[4:7], s36 offen lds
    buffer_load_dwordx4 v235, s[8:11], s36 offen offset:1024 lds
    s_mov_b32 m0, s50
    s_nop 0
    s_movrels_b32 s71, s23
    s_movrels_b32 s33, s28
    s_and_b32 s70, s33, 0x70
    s_andn2_b32 s33, s33, 0x70
    v_xor_b32 v253, s70, v248
    v_add_u32 v253, s33, v253
    s_bfe_u32 s46, s71, 0x30012
    s_mov_b32 m0, s46
    s_and_b32 s66, s71, 0x3ffff
    s_movrels_b32 s68, s57
    s_movrels_b32 s69, s61
    s_sub_u32 s48, s66, s47
    s_mov_b32 s47, s66
    s_lshr_b32 s52, s71, 28
    s_lshl_b32 s67, s46, 9
    s_add_u32 s66, s66, s67
    s_sub_u32 s49, s66, s42
    s_mov_b32 s42, s66
    s_bfe_u32 s66, s68, 655360
    s_add_u32 s43, s42, s66
    s_bfe_u32 s39, s69, 655360
    s_bfe_u32 s66, s68, 655370
    s_add_u32 s44, s42, s66
    s_bfe_u32 s40, s69, 655370
    s_bfe_u32 s66, s68, 655380
    s_add_u32 s45, s42, s66
    s_bfe_u32 s41, s69, 655380
    v_add_u32 v252, s45, v247
    ds_read_u16 v240, v252
    ds_read_u16 v241, v252 offset:64
    v_mfma_f32_32x32x16_bf16 v[32:47], v[64:67], v[180:183], 0
    v_mul_f32 v196, v0, v96
    v_fmac_f32 v196, v1, v97
    v_fmac_f32 v196, v2, v98
    v_fmac_f32 v196, v3, v99
    v_fmac_f32 v196, v4, v100
    v_fmac_f32 v196, v5, v101
    v_fmac_f32 v196, v6, v102
    v_mfma_f32_32x32x16_bf16 v[48:63], v[68:71], v[180:183], 0
    v_fmac_f32 v196, v7, v103
    v_mul_f32 v198, v8, v128
    v_fmac_f32 v198, v9, v129
    v_fmac_f32 v198, v10, v130
    v_fmac_f32 v198, v11, v131
    v_fmac_f32 v198, v12, v132
    v_mfma_f32_32x32x16_bf16 v[32:47], v[72:75], v[184:187], v[32:47]
    v_fmac_f32 v198, v13, v133
    v_fmac_f32 v198, v14, v134
    v_fmac_f32 v198, v15, v135
    v_mul_f32 v200, v16, v128
    v_fmac_f32 v200, v17, v129
    v_permlane32_swap_b32 v196, v198
    v_mfma_f32_32x32x16_bf16 v[48:63], v[76:79], v[184:187], v[48:63]
    s_waitcnt vmcnt(5)
    ds_read_b64_tr_b16 v[176:177], v244 offset:6144
    ds_read_b64_tr_b16 v[178:179], v244 offset:7168
    ds_read_b64_tr_b16 v[180:181], v245 offset:6144
    ds_read_b64_tr_b16 v[182:183], v245 offset:7168
    v_fmac_f32 v200, v18, v130
    v_fmac_f32 v200, v19, v131
    v_fmac_f32 v200, v20, v132
    v_fmac_f32 v200, v21, v133
    v_fmac_f32 v200, v22, v134
    v_fmac_f32 v200, v23, v135
    v_mfma_f32_32x32x8_bf16 v[32:47], v[80:81], v[188:189], v[32:47]
    v_add_f32 v198, v196, v198
    v_mul_f32_e64 v202, v24, -v128
    v_fma_f32 v202, v25, -v129, v202
    v_fma_f32 v202, v26, -v130, v202
    v_fma_f32 v202, v27, -v131, v202
    v_fma_f32 v202, v28, -v132, v202
    v_mfma_f32_32x32x8_bf16 v[48:63], v[84:85], v[188:189], v[48:63]
    v_fma_f32 v202, v29, -v133, v202
    v_fma_f32 v202, v30, -v134, v202
    v_fma_f32 v202, v31, -v135, v202
    s_nop 1
    v_permlane32_swap_b32 v200, v202
    v_add_f32 v202, v200, v202
    s_waitcnt vmcnt(3) lgkmcnt(0)
    v_mfma_f32_32x32x16_bf16 v[0:15], v[64:67], v[176:179], 0
    v_mul_f32 v197, v32, v104
    v_fmac_f32 v197, v33, v105
    v_fmac_f32 v197, v34, v106
    v_fmac_f32 v197, v35, v107
    v_fmac_f32 v197, v36, v108
    v_fmac_f32 v197, v37, v109
    v_fmac_f32 v197, v38, v110
    s_add_u32 m0, s21, 6144
    v_mfma_f32_32x32x16_bf16 v[16:31], v[68:71], v[176:179], 0
    buffer_load_dwordx4 v236, s[4:7], s36 offen lds
    buffer_load_dwordx4 v237, s[8:11], s36 offen offset:1024 lds
    ds_read_b64_tr_b16 v[176:177], v244 offset:0
    ds_read_b64_tr_b16 v[178:179], v244 offset:1024
    ds_read_b64_tr_b16 v[184:185], v245 offset:0
    ds_read_b64_tr_b16 v[186:187], v245 offset:1024
    v_fmac_f32 v197, v39, v111
    v_mul_f32 v199, v40, v136
    v_fmac_f32 v199, v41, v137
    v_fmac_f32 v199, v42, v138
    v_fmac_f32 v199, v43, v139
    v_fmac_f32 v199, v44, v140
    v_fmac_f32 v199, v45, v141
    s_waitcnt vmcnt(4) lgkmcnt(0)
    v_mfma_f32_32x32x16_bf16 v[0:15], v[72:75], v[176:179], v[0:15]
    v_fmac_f32 v199, v46, v142
    v_fmac_f32 v199, v47, v143
    v_mul_f32 v201, v48, v136
    v_fmac_f32 v201, v49, v137
    v_permlane32_swap_b32 v197, v199
    v_fmac_f32 v201, v50, v138
    s_add_u32 m0, s21, 0
    v_mfma_f32_32x32x16_bf16 v[16:31], v[76:79], v[176:179], v[16:31]
    buffer_load_dwordx4 v238, s[4:7], s36 offen lds
    ds_read_b64_tr_b16 v[176:177], v244 offset:2048
    ds_read_b64_tr_b16 v[188:189], v245 offset:2048
    v_fmac_f32 v201, v51, v139
    v_fmac_f32 v201, v52, v140
    v_fmac_f32 v201, v53, v141
    v_fmac_f32 v201, v54, v142
    v_fmac_f32 v201, v55, v143
    v_add_f32 v199, v197, v199
    v_mul_f32_e64 v203, v56, -v136
    s_waitcnt lgkmcnt(0)
    v_mfma_f32_32x32x8_bf16 v[0:15], v[80:81], v[176:177], v[0:15]
    v_fma_f32 v203, v57, -v137, v203
    v_fma_f32 v203, v58, -v138, v203
    v_fma_f32 v203, v59, -v139, v203
    v_fma_f32 v203, v60, -v140, v203
    v_fma_f32 v203, v61, -v141, v203
    v_fma_f32 v203, v62, -v142, v203
    v_fma_f32 v203, v63, -v143, v203
    s_add_u32 m0, s21, 2048
    v_mfma_f32_32x32x8_bf16 v[16:31], v[84:85], v[176:177], v[16:31]
    buffer_load_dwordx4 v234, s[4:7], s37 offen lds
    buffer_load_dwordx4 v235, s[8:11], s37 offen offset:1024 lds
    v_add_u32 v252, s42, v247
    ds_read_u16 v234, v252
    ds_read_u16 v235, v252 offset:64
    s_nop 1
    v_permlane32_swap_b32 v201, v203
    v_add_f32 v203, v201, v203
    v_cvt_pk_bf16_f32 v198, v198, v199
    v_cvt_pk_bf16_f32 v202, v202, v203
    ds_write2st64_b32 v253, v198, v202 offset0:0 offset1:1
    v_mfma_f32_32x32x16_bf16 v[32:47], v[64:67], v[180:183], 0
    v_mul_f32 v196, v0, v144
    v_fmac_f32 v196, v1, v145
    v_fmac_f32 v196, v2, v146
    v_fmac_f32 v196, v3, v147
    v_fmac_f32 v196, v4, v148
    v_fmac_f32 v196, v5, v149
    v_mfma_f32_32x32x16_bf16 v[48:63], v[68:71], v[180:183], 0
    v_fmac_f32 v196, v6, v150
    v_fmac_f32 v196, v7, v151
    v_mul_f32 v198, v8, v112
    v_fmac_f32 v198, v9, v113
    v_fmac_f32 v198, v10, v114
    v_mfma_f32_32x32x16_bf16 v[32:47], v[72:75], v[184:187], v[32:47]
    v_fmac_f32 v198, v11, v115
    v_fmac_f32 v198, v12, v116
    v_fmac_f32 v198, v13, v117
    v_fmac_f32 v198, v14, v118
    v_fmac_f32 v198, v15, v119
    v_mfma_f32_32x32x16_bf16 v[48:63], v[76:79], v[184:187], v[48:63]
    s_waitcnt vmcnt(5)
    ds_read_b64_tr_b16 v[176:177], v244 offset:4096
    ds_read_b64_tr_b16 v[178:179], v244 offset:5120
    ds_read_b64_tr_b16 v[180:181], v245 offset:4096
    ds_read_b64_tr_b16 v[182:183], v245 offset:5120
    v_mul_f32_e64 v200, v16, -v160
    v_fma_f32 v200, v17, -v161, v200
    v_fma_f32 v200, v18, -v162, v200
    v_fma_f32 v200, v19, -v163, v200
    v_fma_f32 v200, v20, -v164, v200
    v_fma_f32 v200, v21, -v165, v200
    v_mfma_f32_32x32x8_bf16 v[32:47], v[80:81], v[188:189], v[32:47]
    v_fma_f32 v200, v22, -v166, v200
    v_fma_f32 v200, v23, -v167, v200
    v_mul_f32_e64 v202, v24, -v160
    v_fma_f32 v202, v25, -v161, v202
    v_fma_f32 v202, v26, -v162, v202
    v_mfma_f32_32x32x8_bf16 v[48:63], v[84:85], v[188:189], v[48:63]
    v_fma_f32 v202, v27, -v163, v202
    v_fma_f32 v202, v28, -v164, v202
    v_fma_f32 v202, v29, -v165, v202
    v_fma_f32 v202, v30, -v166, v202
    v_fma_f32 v202, v31, -v167, v202
    s_waitcnt vmcnt(3) lgkmcnt(0)
    v_mfma_f32_32x32x16_bf16 v[0:15], v[64:67], v[176:179], 0
    v_mul_f32 v197, v32, v152
    v_fmac_f32 v197, v33, v153
    v_fmac_f32 v197, v34, v154
    v_fmac_f32 v197, v35, v155
    v_fmac_f32 v197, v36, v156
    v_fmac_f32 v197, v37, v157
    s_add_u32 m0, s21, 4096
    v_mfma_f32_32x32x16_bf16 v[16:31], v[68:71], v[176:179], 0
    buffer_load_dwordx4 v236, s[4:7], s37 offen lds
    buffer_load_dwordx4 v237, s[8:11], s37 offen offset:1024 lds
    ds_read_b64_tr_b16 v[176:177], v244 offset:6144
    ds_read_b64_tr_b16 v[178:179], v244 offset:7168
    ds_read_b64_tr_b16 v[184:185], v245 offset:6144
    ds_read_b64_tr_b16 v[186:187], v245 offset:7168
    v_add_u32 v252, s43, v247
    ds_read_u16 v236, v252
    ds_read_u16 v237, v252 offset:64
    v_fmac_f32 v197, v38, v158
    v_fmac_f32 v197, v39, v159
    v_mul_f32 v199, v40, v120
    v_fmac_f32 v199, v41, v121
    v_fmac_f32 v199, v42, v122
    s_waitcnt vmcnt(4) lgkmcnt(2)
    v_mfma_f32_32x32x16_bf16 v[0:15], v[72:75], v[176:179], v[0:15]
    v_fmac_f32 v199, v43, v123
    v_fmac_f32 v199, v44, v124
    v_fmac_f32 v199, v45, v125
    v_fmac_f32 v199, v46, v126
    v_fmac_f32 v199, v47, v127
    s_add_u32 m0, s21, 6144
    v_mfma_f32_32x32x16_bf16 v[16:31], v[76:79], v[176:179], v[16:31]
    buffer_load_dwordx4 v238, s[4:7], s37 offen lds
    ds_read_b64_tr_b16 v[176:177], v244 offset:0
    ds_read_b64_tr_b16 v[188:189], v245 offset:0
    v_add_u32 v252, s44, v247
    ds_read_u16 v238, v252
    ds_read_u16 v239, v252 offset:64
    v_mul_f32_e64 v201, v48, -v168
    v_fma_f32 v201, v49, -v169, v201
    v_fma_f32 v201, v50, -v170, v201
    v_fma_f32 v201, v51, -v171, v201
    v_fma_f32 v201, v52, -v172, v201
    v_fma_f32 v201, v53, -v173, v201
    s_waitcnt lgkmcnt(2)
    v_mfma_f32_32x32x8_bf16 v[0:15], v[80:81], v[176:177], v[0:15]
    v_fma_f32 v201, v54, -v174, v201
    v_fma_f32 v201, v55, -v175, v201
    v_mul_f32_e64 v203, v56, -v168
    v_fma_f32 v203, v57, -v169, v203
    v_fma_f32 v203, v58, -v170, v203
    s_add_u32 m0, s21, 0
    v_mfma_f32_32x32x8_bf16 v[16:31], v[84:85], v[176:177], v[16:31]
    v_lshl_add_u32 v234, v234, 10, v246
    v_lshl_add_u32 v235, v235, 10, v246
    buffer_load_dwordx4 v234, s[4:7], s38 offen lds
    buffer_load_dwordx4 v235, s[8:11], s38 offen offset:1024 lds
    v_fma_f32 v203, v59, -v171, v203
    v_fma_f32 v203, v60, -v172, v203
    v_fma_f32 v203, v61, -v173, v203
    v_fma_f32 v203, v62, -v174, v203
    v_fma_f32 v203, v63, -v175, v203
    v_mfma_f32_32x32x16_bf16 v[32:47], v[64:67], v[180:183], 0
    v_mul_f32 v254, v0, v144
    v_fmac_f32 v254, v1, v145
    v_fmac_f32 v254, v2, v146
    v_mfma_f32_32x32x16_bf16 v[48:63], v[68:71], v[180:183], 0
    ds_swizzle_b32 v68, v68 offset:0x401F
    ds_swizzle_b32 v69, v69 offset:0x401F
    ds_swizzle_b32 v70, v70 offset:0x401F
    ds_swizzle_b32 v71, v71 offset:0x401F
    v_fmac_f32 v254, v3, v147
    v_fmac_f32 v254, v4, v148
    v_fmac_f32 v254, v5, v149
    v_mfma_f32_32x32x16_bf16 v[32:47], v[72:75], v[184:187], v[32:47]
    v_fmac_f32 v254, v6, v150
    v_fmac_f32 v254, v7, v151
    v_fmac_f32 v200, v8, v160
    v_mfma_f32_32x32x16_bf16 v[48:63], v[76:79], v[184:187], v[48:63]
    ds_swizzle_b32 v76, v76 offset:0x401F
    ds_swizzle_b32 v77, v77 offset:0x401F
    ds_swizzle_b32 v78, v78 offset:0x401F
    ds_swizzle_b32 v79, v79 offset:0x401F
    s_waitcnt vmcnt(5)
    ds_read_b64_tr_b16 v[176:177], v244 offset:2048
    ds_read_b64_tr_b16 v[178:179], v244 offset:3072
    ds_read_b64_tr_b16 v[180:181], v245 offset:2048
    ds_read_b64_tr_b16 v[182:183], v245 offset:3072
    v_fmac_f32 v200, v9, v161
    v_permlane32_swap_b32 v196, v254
    v_fmac_f32 v200, v10, v162
    v_mfma_f32_32x32x8_bf16 v[32:47], v[80:81], v[188:189], v[32:47]
    v_fmac_f32 v200, v11, v163
    v_fmac_f32 v200, v12, v164
    v_fmac_f32 v200, v13, v165
    v_mfma_f32_32x32x8_bf16 v[48:63], v[84:85], v[188:189], v[48:63]
    ds_swizzle_b32 v84, v84 offset:0x401F
    ds_swizzle_b32 v85, v85 offset:0x401F
    v_fmac_f32 v200, v14, v166
    v_fmac_f32 v200, v15, v167
    v_add_f32 v254, v196, v254
    s_waitcnt lgkmcnt(6)
    s_mov_b64 exec, s[56:57]
    v_xor_b32 v68, 0x80008000, v68
    v_xor_b32 v69, 0x80008000, v69
    v_xor_b32 v70, 0x80008000, v70
    v_xor_b32 v71, 0x80008000, v71
    v_xor_b32 v76, 0x80008000, v76
    v_xor_b32 v77, 0x80008000, v77
    v_xor_b32 v78, 0x80008000, v78
    v_xor_b32 v79, 0x80008000, v79
    s_mov_b64 exec, -1
    s_waitcnt vmcnt(3) lgkmcnt(2)
    v_mfma_f32_32x32x16_bf16 v[0:15], v[64:67], v[176:179], 0
    v_mul_f32 v255, v32, v152
    v_fmac_f32 v255, v33, v153
    v_fmac_f32 v255, v34, v154
    v_fmac_f32 v255, v35, v155
    s_add_u32 m0, s21, 2048
    v_mfma_f32_32x32x16_bf16 v[16:31], v[68:71], v[176:179], v[16:31]
    v_lshl_add_u32 v236, v236, 10, v246
    v_lshl_add_u32 v237, v237, 10, v246
    buffer_load_dwordx4 v236, s[4:7], s39 offen lds
    buffer_load_dwordx4 v237, s[8:11], s39 offen offset:1024 lds
    ds_read_b64_tr_b16 v[176:177], v244 offset:4096
    ds_read_b64_tr_b16 v[178:179], v244 offset:5120
    ds_read_b64_tr_b16 v[184:185], v245 offset:4096
    ds_read_b64_tr_b16 v[186:187], v245 offset:5120
    v_fmac_f32 v255, v36, v156
    v_fmac_f32 v255, v37, v157
    v_fmac_f32 v255, v38, v158
    s_waitcnt vmcnt(4) lgkmcnt(0)
    v_mfma_f32_32x32x16_bf16 v[0:15], v[72:75], v[176:179], v[0:15]
    v_fmac_f32 v255, v39, v159
    v_fmac_f32 v201, v40, v168
    v_fmac_f32 v201, v41, v169
    s_add_u32 m0, s21, 4096
    v_mfma_f32_32x32x16_bf16 v[16:31], v[76:79], v[176:179], v[16:31]
    v_lshl_add_u32 v238, v238, 10, v246
    v_lshl_add_u32 v239, v239, 10, v246
    buffer_load_dwordx4 v238, s[4:7], s40 offen lds
    buffer_load_dwordx4 v239, s[8:11], s40 offen offset:1024 lds
    ds_read_b64_tr_b16 v[176:177], v244 offset:6144
    ds_read_b64_tr_b16 v[188:189], v245 offset:6144
    v_permlane32_swap_b32 v197, v255
    v_fmac_f32 v201, v42, v170
    v_fmac_f32 v201, v43, v171
    v_fmac_f32 v201, v44, v172
    s_waitcnt lgkmcnt(0)
    s_mov_b64 exec, s[56:57]
    v_xor_b32 v84, 0x80008000, v84
    v_xor_b32 v85, 0x80008000, v85
    s_mov_b64 exec, -1
    v_mfma_f32_32x32x8_bf16 v[0:15], v[80:81], v[176:177], v[0:15]
    v_fmac_f32 v201, v45, v173
    v_fmac_f32 v201, v46, v174
    v_fmac_f32 v201, v47, v175
    s_add_u32 m0, s21, 6144
    v_mfma_f32_32x32x8_bf16 v[16:31], v[84:85], v[176:177], v[16:31]
    v_lshl_add_u32 v240, v240, 10, v246
    v_lshl_add_u32 v241, v241, 10, v246
    buffer_load_dwordx4 v240, s[4:7], s41 offen lds
    buffer_load_dwordx4 v241, s[8:11], s41 offen offset:1024 lds
    v_add_f32 v255, v197, v255
    v_cvt_pk_bf16_f32 v254, v254, v255
    ds_write_b32 v253, v254 offset:512
    v_mfma_f32_32x32x16_bf16 v[32:47], v[64:67], v[180:183], 0
    v_mul_f32 v254, v0, v144
    v_fmac_f32 v254, v1, v145
    v_fmac_f32 v254, v2, v146
    v_fmac_f32 v254, v3, v147
    v_fmac_f32 v254, v4, v148
    v_fmac_f32 v254, v5, v149
    v_fmac_f32 v254, v6, v150
    v_mfma_f32_32x32x16_bf16 v[48:63], v[68:71], v[180:183], v[48:63]
    v_fmac_f32 v254, v7, v151
    v_fma_f32 v202, v8, -v160, v202
    v_fma_f32 v202, v9, -v161, v202
    v_permlane32_swap_b32 v254, v200
    v_fma_f32 v202, v10, -v162, v202
    v_fma_f32 v202, v11, -v163, v202
    v_mfma_f32_32x32x16_bf16 v[32:47], v[72:75], v[184:187], v[32:47]
    v_fma_f32 v202, v12, -v164, v202
    v_fma_f32 v202, v13, -v165, v202
    v_fma_f32 v202, v14, -v166, v202
    v_fma_f32 v202, v15, -v167, v202
    v_add_f32 v200, v254, v200
    v_fmac_f32 v198, v16, v112
    v_permlane32_swap_b32 v202, v254
    v_mfma_f32_32x32x16_bf16 v[48:63], v[76:79], v[184:187], v[48:63]
    s_waitcnt vmcnt(6)
    ds_read_b64_tr_b16 v[176:177], v244 offset:0
    ds_read_b64_tr_b16 v[178:179], v244 offset:1024
    ds_read_b64_tr_b16 v[180:181], v245 offset:0
    ds_read_b64_tr_b16 v[182:183], v245 offset:1024
    v_fmac_f32 v198, v17, v113
    v_fmac_f32 v198, v18, v114
    v_fmac_f32 v198, v19, v115
    v_fmac_f32 v198, v20, v116
    v_fmac_f32 v198, v21, v117
    v_fmac_f32 v198, v22, v118
    v_mfma_f32_32x32x8_bf16 v[32:47], v[80:81], v[188:189], v[32:47]
    v_fmac_f32 v198, v23, v119
    v_add_f32 v254, v202, v254
    v_mul_f32 v196, v24, v160
    v_fmac_f32 v196, v25, v161
    v_fmac_f32 v196, v26, v162
    v_fmac_f32 v196, v27, v163
    v_fmac_f32 v196, v28, v164
    v_mfma_f32_32x32x8_bf16 v[48:63], v[84:85], v[188:189], v[48:63]
    v_add_u32 v249, s48, v249
    v_add_u32 v250, s49, v250
    ds_read_b32 v252, v251 offset:16
    ds_read_b64_tr_b16 v[64:65], v249 offset:0
    ds_read_b64_tr_b16 v[68:69], v249 offset:64
    ds_read_b64_tr_b16 v[66:67], v249 offset:256
    ds_read_b64_tr_b16 v[70:71], v249 offset:320
    s_mov_b64 exec, s[54:55]
    ds_read_u16_d16_hi v242, v250 offset:0
    s_mov_b64 exec, -1
    v_fmac_f32 v196, v29, v165
    v_fmac_f32 v196, v30, v166
    v_fmac_f32 v196, v31, v167
    s_nop 1
    v_permlane32_swap_b32 v198, v196
    v_add_f32 v196, v198, v196
    v_mul_f32 v255, v32, v152
    v_fmac_f32 v255, v33, v153
    v_fmac_f32 v255, v34, v154
    v_fmac_f32 v255, v35, v155
    v_fmac_f32 v255, v36, v156
    v_fmac_f32 v255, v37, v157
    v_fmac_f32 v255, v38, v158
    v_fmac_f32 v255, v39, v159
    v_fma_f32 v203, v40, -v168, v203
    v_fma_f32 v203, v41, -v169, v203
    v_permlane32_swap_b32 v255, v201
    v_fma_f32 v203, v42, -v170, v203
    v_fma_f32 v203, v43, -v171, v203
    v_fma_f32 v203, v44, -v172, v203
    v_fma_f32 v203, v45, -v173, v203
    v_fma_f32 v203, v46, -v174, v203
    v_fma_f32 v203, v47, -v175, v203
    v_add_f32 v201, v255, v201
    v_fmac_f32 v199, v48, v120
    v_permlane32_swap_b32 v203, v255
    v_fmac_f32 v199, v49, v121
    v_fmac_f32 v199, v50, v122
    v_fmac_f32 v199, v51, v123
    v_fmac_f32 v199, v52, v124
    v_fmac_f32 v199, v53, v125
    v_fmac_f32 v199, v54, v126
    v_fmac_f32 v199, v55, v127
    v_add_f32 v255, v203, v255
    v_mul_f32 v197, v56, v168
    v_fmac_f32 v197, v57, v169
    v_fmac_f32 v197, v58, v170
    v_fmac_f32 v197, v59, v171
    v_fmac_f32 v197, v60, v172
    v_fmac_f32 v197, v61, v173
    v_fmac_f32 v197, v62, v174
    v_fmac_f32 v197, v63, v175
    s_nop 1
    v_permlane32_swap_b32 v199, v197
    v_add_f32 v197, v199, v197
    v_cvt_pk_bf16_f32 v200, v200, v201
    v_cvt_pk_bf16_f32 v254, v254, v255
    v_cvt_pk_bf16_f32 v196, v196, v197
    ds_write2st64_b32 v253, v200, v196 offset0:3 offset1:4
    s_mov_b64 exec, 0xffffffff
    ds_write_b32 v253, v254 offset:1280
    s_mov_b64 exec, -1
    s_add_u32 s50, s50, 1
    s_cmp_ge_u32 s50, 4
    s_cbranch_scc1 LAST1
    s_waitcnt lgkmcnt(7)
    v_readfirstlane_b32 s66, v252
    s_add_u32 s53, s53, 1
    v_mov_b32 v252, s53
    s_cmp_le_u32 s53, s66
    ds_write2_b32 v251, v252, v252 offset0:0 offset1:8
    s_setprio 1
    s_cbranch_scc1 PRIO_12
    s_setprio 0
PRIO_12:
    s_cmp_eq_u32 s52, 4
    s_cbranch_scc1 ITEM_1_4
    s_cmp_eq_u32 s52, 5
    s_cbranch_scc1 ITEM_1_5
    s_cmp_eq_u32 s52, 3
    s_cbranch_scc1 ITEM_1_3
    s_cmp_eq_u32 s52, 6
    s_cbranch_scc1 ITEM_1_6
    s_cmp_eq_u32 s52, 8
    s_cbranch_scc1 ITEM_1_8
    s_branch ITEM_1_2
.p2align 6
ITEM_1_3:
    s_mov_b64 exec, s[54:55]
    ds_read_u16_d16_hi v243, v250 offset:128
    s_mov_b64 exec, -1
    ds_read_b64_tr_b16 v[72:73], v249 offset:512
    ds_read_b64_tr_b16 v[76:77], v249 offset:576
    s_waitcnt lgkmcnt(3)
    v_mul_f32_dpp v196, v242, v64 row_newbcast:0 row_mask:0xf bank_mask:0xf
    v_mul_f32_dpp v197, v242, v65 row_newbcast:1 row_mask:0xf bank_mask:0xf
    v_mul_f32_dpp v198, v242, v64 row_newbcast:8 row_mask:0xf bank_mask:0xf
    v_mul_f32_dpp v199, v242, v65 row_newbcast:9 row_mask:0xf bank_mask:0xf
    v_mul_f32_dpp v200, v242, v68 row_newbcast:2 row_mask:0xf bank_mask:0xf
    v_mul_f32_dpp v201, v242, v69 row_newbcast:3 row_mask:0xf bank_mask:0xf
    v_mul_f32_dpp v202, v242, v68 row_newbcast:10 row_mask:0xf bank_mask:0xf
    v_mul_f32_dpp v203, v242, v69 row_newbcast:11 row_mask:0xf bank_mask:0xf
    v_cvt_pk_bf16_f32 v64, v196, v197
    v_cvt_pk_bf16_f32 v68, v198, v199
    v_cvt_pk_bf16_f32 v65, v200, v201
    v_cvt_pk_bf16_f32 v69, v202, v203
    v_mul_f32_dpp v196, v242, v66 row_newbcast:4 row_mask:0xf bank_mask:0xf
    v_mul_f32_dpp v197, v242, v67 row_newbcast:5 row_mask:0xf bank_mask:0xf
    v_mul_f32_dpp v198, v242, v66 row_newbcast:12 row_mask:0xf bank_mask:0xf
    v_mul_f32_dpp v199, v242, v67 row_newbcast:13 row_mask:0xf bank_mask:0xf
    v_mul_f32_dpp v200, v242, v70 row_newbcast:6 row_mask:0xf bank_mask:0xf
    v_mul_f32_dpp v201, v242, v71 row_newbcast:7 row_mask:0xf bank_mask:0xf
    v_mul_f32_dpp v202, v242, v70 row_newbcast:14 row_mask:0xf bank_mask:0xf
    v_mul_f32_dpp v203, v242, v71 row_newbcast:15 row_mask:0xf bank_mask:0xf
    v_cvt_pk_bf16_f32 v66, v196, v197
    v_cvt_pk_bf16_f32 v70, v198, v199
    v_cvt_pk_bf16_f32 v67, v200, v201
    v_cvt_pk_bf16_f32 v71, v202, v203
    s_nop 0
    s_waitcnt vmcnt(4) lgkmcnt(0)
    v_mfma_f32_32x32x16_bf16 v[0:15], v[64:67], v[176:179], 0
    v_mul_f32_dpp v196, v243, v72 row_newbcast:0 row_mask:0xf bank_mask:0xf
    v_mul_f32_dpp v197, v243, v73 row_newbcast:1 row_mask:0xf bank_mask:0xf
    v_mul_f32_dpp v198, v243, v72 row_newbcast:8 row_mask:0xf bank_mask:0xf
    v_mul_f32_dpp v199, v243, v73 row_newbcast:9 row_mask:0xf bank_mask:0xf
    v_mul_f32_dpp v200, v243, v76 row_newbcast:2 row_mask:0xf bank_mask:0xf
    v_mul_f32_dpp v201, v243, v77 row_newbcast:3 row_mask:0xf bank_mask:0xf
    s_add_u32 m0, s21, 0
    v_mfma_f32_32x32x16_bf16 v[16:31], v[68:71], v[176:179], 0
    buffer_load_dwordx4 v234, s[4:7], s36 offen lds
    buffer_load_dwordx4 v235, s[8:11], s36 offen offset:1024 lds
    ds_read_b64_tr_b16 v[176:177], v244 offset:2048
    ds_read_b64_tr_b16 v[184:185], v245 offset:2048
    v_mul_f32_dpp v202, v243, v76 row_newbcast:10 row_mask:0xf bank_mask:0xf
    v_mul_f32_dpp v203, v243, v77 row_newbcast:11 row_mask:0xf bank_mask:0xf
    v_cvt_pk_bf16_f32 v72, v196, v197
    v_cvt_pk_bf16_f32 v76, v198, v199
    v_cvt_pk_bf16_f32 v73, v200, v201
    v_cvt_pk_bf16_f32 v77, v202, v203
    s_nop 0
    s_waitcnt lgkmcnt(0)
    v_mfma_f32_32x32x8_bf16 v[0:15], v[72:73], v[176:177], v[0:15]
    s_add_u32 m0, s21, 2048
    v_mfma_f32_32x32x8_bf16 v[16:31], v[76:77], v[176:177], v[16:31]
    buffer_load_dwordx4 v236, s[4:7], s36 offen lds
    s_mov_b32 m0, s50
    s_nop 0
    s_movrels_b32 s71, s23
    s_movrels_b32 s33, s28
    s_and_b32 s70, s33, 0x70
    s_andn2_b32 s33, s33, 0x70
    v_xor_b32 v253, s70, v248
    v_add_u32 v253, s33, v253
    s_bfe_u32 s46, s71, 0x30012
    s_mov_b32 m0, s46
    s_and_b32 s66, s71, 0x3ffff
    s_movrels_b32 s68, s57
    s_movrels_b32 s69, s61
    s_sub_u32 s48, s66, s47
    s_mov_b32 s47, s66
    s_lshr_b32 s52, s71, 28
    s_lshl_b32 s67, s46, 9
    s_add_u32 s66, s66, s67
    s_sub_u32 s49, s66, s42
    s_mov_b32 s42, s66
    s_bfe_u32 s66, s68, 655360
    s_add_u32 s43, s42, s66
    s_bfe_u32 s39, s69, 655360
    s_bfe_u32 s66, s68, 655370
    s_add_u32 s44, s42, s66
    s_bfe_u32 s40, s69, 655370
    s_bfe_u32 s66, s68, 655380
    s_add_u32 s45, s42, s66
    s_bfe_u32 s41, s69, 655380
    v_add_u32 v252, s44, v247
    ds_read_u16 v238, v252
    ds_read_u16 v239, v252 offset:64
    v_add_u32 v252, s45, v247
    ds_read_u16 v240, v252
    ds_read_u16 v241, v252 offset:64
    v_mfma_f32_32x32x16_bf16 v[32:47], v[64:67], v[180:183], 0
    v_mul_f32 v196, v0, v96
    v_fmac_f32 v196, v1, v97
    v_fmac_f32 v196, v2, v98
    v_fmac_f32 v196, v3, v99
    v_fmac_f32 v196, v4, v100
    v_fmac_f32 v196, v5, v101
    v_fmac_f32 v196, v6, v102
    v_fmac_f32 v196, v7, v103
    v_mul_f32 v198, v8, v128
    v_fmac_f32 v198, v9, v129
    v_mfma_f32_32x32x16_bf16 v[48:63], v[68:71], v[180:183], 0
    s_waitcnt vmcnt(5)
    ds_read_b64_tr_b16 v[176:177], v244 offset:4096
    ds_read_b64_tr_b16 v[178:179], v244 offset:5120
    ds_read_b64_tr_b16 v[180:181], v245 offset:4096
    ds_read_b64_tr_b16 v[182:183], v245 offset:5120
    v_fmac_f32 v198, v10, v130
    v_fmac_f32 v198, v11, v131
    v_fmac_f32 v198, v12, v132
    v_fmac_f32 v198, v13, v133
    v_fmac_f32 v198, v14, v134
    v_fmac_f32 v198, v15, v135
    v_mul_f32 v200, v16, v128
    v_fmac_f32 v200, v17, v129
    v_permlane32_swap_b32 v196, v198
    v_mfma_f32_32x32x8_bf16 v[32:47], v[72:73], v[184:185], v[32:47]
    v_fmac_f32 v200, v18, v130
    v_fmac_f32 v200, v19, v131
    v_fmac_f32 v200, v20, v132
    v_fmac_f32 v200, v21, v133
    v_fmac_f32 v200, v22, v134
    v_fmac_f32 v200, v23, v135
    v_add_f32 v198, v196, v198
    v_mul_f32_e64 v202, v24, -v128
    v_fma_f32 v202, v25, -v129, v202
    v_mfma_f32_32x32x8_bf16 v[48:63], v[76:77], v[184:185], v[48:63]
    v_fma_f32 v202, v26, -v130, v202
    v_fma_f32 v202, v27, -v131, v202
    v_fma_f32 v202, v28, -v132, v202
    v_fma_f32 v202, v29, -v133, v202
    v_fma_f32 v202, v30, -v134, v202
    v_fma_f32 v202, v31, -v135, v202
    s_nop 1
    v_permlane32_swap_b32 v200, v202
    v_add_f32 v202, v200, v202
    s_waitcnt vmcnt(3) lgkmcnt(0)
    v_mfma_f32_32x32x16_bf16 v[0:15], v[64:67], v[176:179], 0
    v_mul_f32 v197, v32, v104
    v_fmac_f32 v197, v33, v105
    v_fmac_f32 v197, v34, v106
    v_fmac_f32 v197, v35, v107
    v_fmac_f32 v197, v36, v108
    v_fmac_f32 v197, v37, v109
    v_fmac_f32 v197, v38, v110
    v_fmac_f32 v197, v39, v111
    v_mul_f32 v199, v40, v136
    v_fmac_f32 v199, v41, v137
    s_add_u32 m0, s21, 4096
    v_mfma_f32_32x32x16_bf16 v[16:31], v[68:71], v[176:179], 0
    buffer_load_dwordx4 v234, s[4:7], s37 offen lds
    buffer_load_dwordx4 v235, s[8:11], s37 offen offset:1024 lds
    ds_read_b64_tr_b16 v[176:177], v244 offset:6144
    ds_read_b64_tr_b16 v[184:185], v245 offset:6144
    v_add_u32 v252, s42, v247
    ds_read_u16 v234, v252
    ds_read_u16 v235, v252 offset:64
    v_fmac_f32 v199, v42, v138
    v_fmac_f32 v199, v43, v139
    v_fmac_f32 v199, v44, v140
    v_fmac_f32 v199, v45, v141
    v_fmac_f32 v199, v46, v142
    v_fmac_f32 v199, v47, v143
    v_mul_f32 v201, v48, v136
    v_fmac_f32 v201, v49, v137
    v_permlane32_swap_b32 v197, v199
    v_fmac_f32 v201, v50, v138
    s_waitcnt lgkmcnt(2)
    v_mfma_f32_32x32x8_bf16 v[0:15], v[72:73], v[176:177], v[0:15]
    v_fmac_f32 v201, v51, v139
    v_fmac_f32 v201, v52, v140
    v_fmac_f32 v201, v53, v141
    v_fmac_f32 v201, v54, v142
    v_fmac_f32 v201, v55, v143
    v_add_f32 v199, v197, v199
    v_mul_f32_e64 v203, v56, -v136
    v_fma_f32 v203, v57, -v137, v203
    v_fma_f32 v203, v58, -v138, v203
    v_fma_f32 v203, v59, -v139, v203
    s_add_u32 m0, s21, 6144
    v_mfma_f32_32x32x8_bf16 v[16:31], v[76:77], v[176:177], v[16:31]
    buffer_load_dwordx4 v236, s[4:7], s37 offen lds
    v_add_u32 v252, s43, v247
    ds_read_u16 v236, v252
    ds_read_u16 v237, v252 offset:64
    v_fma_f32 v203, v60, -v140, v203
    v_fma_f32 v203, v61, -v141, v203
    v_fma_f32 v203, v62, -v142, v203
    v_fma_f32 v203, v63, -v143, v203
    s_nop 1
    v_permlane32_swap_b32 v201, v203
    v_add_f32 v203, v201, v203
    v_cvt_pk_bf16_f32 v198, v198, v199
    v_cvt_pk_bf16_f32 v202, v202, v203
    ds_write2st64_b32 v253, v198, v202 offset0:0 offset1:1
    v_mfma_f32_32x32x16_bf16 v[32:47], v[64:67], v[180:183], 0
    v_mul_f32 v196, v0, v144
    v_fmac_f32 v196, v1, v145
    v_fmac_f32 v196, v2, v146
    v_fmac_f32 v196, v3, v147
    v_fmac_f32 v196, v4, v148
    v_fmac_f32 v196, v5, v149
    v_fmac_f32 v196, v6, v150
    v_fmac_f32 v196, v7, v151
    v_mfma_f32_32x32x16_bf16 v[48:63], v[68:71], v[180:183], 0
    s_waitcnt vmcnt(4)
    ds_read_b64_tr_b16 v[176:177], v244 offset:0
    ds_read_b64_tr_b16 v[178:179], v244 offset:1024
    ds_read_b64_tr_b16 v[180:181], v245 offset:0
    ds_read_b64_tr_b16 v[182:183], v245 offset:1024
    v_mul_f32 v198, v8, v112
    v_fmac_f32 v198, v9, v113
    v_fmac_f32 v198, v10, v114
    v_fmac_f32 v198, v11, v115
    v_fmac_f32 v198, v12, v116
    v_fmac_f32 v198, v13, v117
    v_fmac_f32 v198, v14, v118
    v_fmac_f32 v198, v15, v119
    v_mfma_f32_32x32x8_bf16 v[32:47], v[72:73], v[184:185], v[32:47]
    v_mul_f32_e64 v200, v16, -v160
    v_fma_f32 v200, v17, -v161, v200
    v_fma_f32 v200, v18, -v162, v200
    v_fma_f32 v200, v19, -v163, v200
    v_fma_f32 v200, v20, -v164, v200
    v_fma_f32 v200, v21, -v165, v200
    v_fma_f32 v200, v22, -v166, v200
    v_fma_f32 v200, v23, -v167, v200
    v_mfma_f32_32x32x8_bf16 v[48:63], v[76:77], v[184:185], v[48:63]
    v_mul_f32_e64 v202, v24, -v160
    v_fma_f32 v202, v25, -v161, v202
    v_fma_f32 v202, v26, -v162, v202
    v_fma_f32 v202, v27, -v163, v202
    v_fma_f32 v202, v28, -v164, v202
    v_fma_f32 v202, v29, -v165, v202
    v_fma_f32 v202, v30, -v166, v202
    v_fma_f32 v202, v31, -v167, v202
    s_waitcnt vmcnt(3) lgkmcnt(0)
    v_mfma_f32_32x32x16_bf16 v[0:15], v[64:67], v[176:179], 0
    v_mul_f32 v197, v32, v152
    v_fmac_f32 v197, v33, v153
    v_fmac_f32 v197, v34, v154
    v_fmac_f32 v197, v35, v155
    v_fmac_f32 v197, v36, v156
    v_fmac_f32 v197, v37, v157
    v_fmac_f32 v197, v38, v158
    v_fmac_f32 v197, v39, v159
    s_add_u32 m0, s21, 0
    v_mfma_f32_32x32x16_bf16 v[16:31], v[68:71], v[176:179], 0
    v_lshl_add_u32 v234, v234, 10, v246
    v_lshl_add_u32 v235, v235, 10, v246
    buffer_load_dwordx4 v234, s[4:7], s38 offen lds
    buffer_load_dwordx4 v235, s[8:11], s38 offen offset:1024 lds
    ds_read_b64_tr_b16 v[176:177], v244 offset:2048
    ds_read_b64_tr_b16 v[184:185], v245 offset:2048
    v_mul_f32 v199, v40, v120
    v_fmac_f32 v199, v41, v121
    v_fmac_f32 v199, v42, v122
    v_fmac_f32 v199, v43, v123
    v_fmac_f32 v199, v44, v124
    v_fmac_f32 v199, v45, v125
    v_fmac_f32 v199, v46, v126
    v_fmac_f32 v199, v47, v127
    s_waitcnt lgkmcnt(0)
    v_mfma_f32_32x32x8_bf16 v[0:15], v[72:73], v[176:177], v[0:15]
    v_mul_f32_e64 v201, v48, -v168
    v_fma_f32 v201, v49, -v169, v201
    v_fma_f32 v201, v50, -v170, v201
    v_fma_f32 v201, v51, -v171, v201
    v_fma_f32 v201, v52, -v172, v201
    v_fma_f32 v201, v53, -v173, v201
    v_fma_f32 v201, v54, -v174, v201
    v_fma_f32 v201, v55, -v175, v201
    s_add_u32 m0, s21, 2048
    v_mfma_f32_32x32x8_bf16 v[16:31], v[76:77], v[176:177], v[16:31]
    v_lshl_add_u32 v236, v236, 10, v246
    v_lshl_add_u32 v237, v237, 10, v246
    buffer_load_dwordx4 v236, s[4:7], s39 offen lds
    buffer_load_dwordx4 v237, s[8:11], s39 offen offset:1024 lds
    v_mul_f32_e64 v203, v56, -v168
    v_fma_f32 v203, v57, -v169, v203
    v_fma_f32 v203, v58, -v170, v203
    v_fma_f32 v203, v59, -v171, v203
    v_fma_f32 v203, v60, -v172, v203
    v_fma_f32 v203, v61, -v173, v203
    v_fma_f32 v203, v62, -v174, v203
    v_fma_f32 v203, v63, -v175, v203
    v_mfma_f32_32x32x16_bf16 v[32:47], v[64:67], v[180:183], 0
    v_mul_f32 v254, v0, v144
    v_fmac_f32 v254, v1, v145
    v_fmac_f32 v254, v2, v146
    v_fmac_f32 v254, v3, v147
    v_fmac_f32 v254, v4, v148
    v_mfma_f32_32x32x16_bf16 v[48:63], v[68:71], v[180:183], 0
    ds_swizzle_b32 v68, v68 offset:0x401F
    ds_swizzle_b32 v69, v69 offset:0x401F
    ds_swizzle_b32 v70, v70 offset:0x401F
    ds_swizzle_b32 v71, v71 offset:0x401F
    s_waitcnt vmcnt(5)
    ds_read_b64_tr_b16 v[176:177], v244 offset:4096
    ds_read_b64_tr_b16 v[178:179], v244 offset:5120
    ds_read_b64_tr_b16 v[180:181], v245 offset:4096
    ds_read_b64_tr_b16 v[182:183], v245 offset:5120
    v_fmac_f32 v254, v5, v149
    v_fmac_f32 v254, v6, v150
    v_fmac_f32 v254, v7, v151
    v_fmac_f32 v200, v8, v160
    v_mfma_f32_32x32x8_bf16 v[32:47], v[72:73], v[184:185], v[32:47]
    v_fmac_f32 v200, v9, v161
    v_permlane32_swap_b32 v196, v254
    v_fmac_f32 v200, v10, v162
    v_fmac_f32 v200, v11, v163
    v_fmac_f32 v200, v12, v164
    v_mfma_f32_32x32x8_bf16 v[48:63], v[76:77], v[184:185], v[48:63]
    ds_swizzle_b32 v76, v76 offset:0x401F
    ds_swizzle_b32 v77, v77 offset:0x401F
    v_fmac_f32 v200, v13, v165
    v_fmac_f32 v200, v14, v166
    v_fmac_f32 v200, v15, v167
    v_add_f32 v254, v196, v254
    s_waitcnt lgkmcnt(6)
    s_mov_b64 exec, s[56:57]
    v_xor_b32 v68, 0x80008000, v68
    v_xor_b32 v69, 0x80008000, v69
    v_xor_b32 v70, 0x80008000, v70
    v_xor_b32 v71, 0x80008000, v71
    s_mov_b64 exec, -1
    s_waitcnt vmcnt(4) lgkmcnt(2)
    v_mfma_f32_32x32x16_bf16 v[0:15], v[64:67], v[176:179], 0
    v_mul_f32 v255, v32, v152
    v_fmac_f32 v255, v33, v153
    v_fmac_f32 v255, v34, v154
    v_fmac_f32 v255, v35, v155
    v_fmac_f32 v255, v36, v156
    s_add_u32 m0, s21, 4096
    v_mfma_f32_32x32x16_bf16 v[16:31], v[68:71], v[176:179], v[16:31]
    v_lshl_add_u32 v238, v238, 10, v246
    v_lshl_add_u32 v239, v239, 10, v246
    buffer_load_dwordx4 v238, s[4:7], s40 offen lds
    buffer_load_dwordx4 v239, s[8:11], s40 offen offset:1024 lds
    ds_read_b64_tr_b16 v[176:177], v244 offset:6144
    ds_read_b64_tr_b16 v[184:185], v245 offset:6144
    v_fmac_f32 v255, v37, v157
    v_fmac_f32 v255, v38, v158
    v_fmac_f32 v255, v39, v159
    v_fmac_f32 v201, v40, v168
    v_fmac_f32 v201, v41, v169
    s_waitcnt lgkmcnt(0)
    s_mov_b64 exec, s[56:57]
    v_xor_b32 v76, 0x80008000, v76
    v_xor_b32 v77, 0x80008000, v77
    s_mov_b64 exec, -1
    v_mfma_f32_32x32x8_bf16 v[0:15], v[72:73], v[176:177], v[0:15]
    v_permlane32_swap_b32 v197, v255
    v_fmac_f32 v201, v42, v170
    v_fmac_f32 v201, v43, v171
    v_fmac_f32 v201, v44, v172
    v_fmac_f32 v201, v45, v173
    s_add_u32 m0, s21, 6144
    v_mfma_f32_32x32x8_bf16 v[16:31], v[76:77], v[176:177], v[16:31]
    v_lshl_add_u32 v240, v240, 10, v246
    v_lshl_add_u32 v241, v241, 10, v246
    buffer_load_dwordx4 v240, s[4:7], s41 offen lds
    buffer_load_dwordx4 v241, s[8:11], s41 offen offset:1024 lds
    v_fmac_f32 v201, v46, v174
    v_fmac_f32 v201, v47, v175
    v_add_f32 v255, v197, v255
    v_cvt_pk_bf16_f32 v254, v254, v255
    ds_write_b32 v253, v254 offset:512
    v_mfma_f32_32x32x16_bf16 v[32:47], v[64:67], v[180:183], 0
    v_mul_f32 v254, v0, v144
    v_fmac_f32 v254, v1, v145
    v_fmac_f32 v254, v2, v146
    v_fmac_f32 v254, v3, v147
    v_fmac_f32 v254, v4, v148
    v_fmac_f32 v254, v5, v149
    v_fmac_f32 v254, v6, v150
    v_fmac_f32 v254, v7, v151
    v_fma_f32 v202, v8, -v160, v202
    v_fma_f32 v202, v9, -v161, v202
    v_mfma_f32_32x32x16_bf16 v[48:63], v[68:71], v[180:183], v[48:63]
    s_waitcnt vmcnt(6)
    ds_read_b64_tr_b16 v[176:177], v244 offset:0
    ds_read_b64_tr_b16 v[178:179], v244 offset:1024
    ds_read_b64_tr_b16 v[180:181], v245 offset:0
    ds_read_b64_tr_b16 v[182:183], v245 offset:1024
    v_permlane32_swap_b32 v254, v200
    v_fma_f32 v202, v10, -v162, v202
    v_fma_f32 v202, v11, -v163, v202
    v_fma_f32 v202, v12, -v164, v202
    v_fma_f32 v202, v13, -v165, v202
    v_fma_f32 v202, v14, -v166, v202
    v_fma_f32 v202, v15, -v167, v202
    v_add_f32 v200, v254, v200
    v_fmac_f32 v198, v16, v112
    v_permlane32_swap_b32 v202, v254
    v_mfma_f32_32x32x8_bf16 v[32:47], v[72:73], v[184:185], v[32:47]
    v_fmac_f32 v198, v17, v113
    v_fmac_f32 v198, v18, v114
    v_fmac_f32 v198, v19, v115
    v_fmac_f32 v198, v20, v116
    v_fmac_f32 v198, v21, v117
    v_fmac_f32 v198, v22, v118
    v_fmac_f32 v198, v23, v119
    v_add_f32 v254, v202, v254
    v_mul_f32 v196, v24, v160
    v_fmac_f32 v196, v25, v161
    v_mfma_f32_32x32x8_bf16 v[48:63], v[76:77], v[184:185], v[48:63]
    v_add_u32 v249, s48, v249
    v_add_u32 v250, s49, v250
    ds_read_b32 v252, v251 offset:16
    ds_read_b64_tr_b16 v[64:65], v249 offset:0
    ds_read_b64_tr_b16 v[68:69], v249 offset:64
    ds_read_b64_tr_b16 v[66:67], v249 offset:256
    ds_read_b64_tr_b16 v[70:71], v249 offset:320
    s_mov_b64 exec, s[54:55]
    ds_read_u16_d16_hi v242, v250 offset:0
    s_mov_b64 exec, -1
    v_fmac_f32 v196, v26, v162
    v_fmac_f32 v196, v27, v163
    v_fmac_f32 v196, v28, v164
    v_fmac_f32 v196, v29, v165
    v_fmac_f32 v196, v30, v166
    v_fmac_f32 v196, v31, v167
    s_nop 1
    v_permlane32_swap_b32 v198, v196
    v_add_f32 v196, v198, v196
    v_mul_f32 v255, v32, v152
    v_fmac_f32 v255, v33, v153
    v_fmac_f32 v255, v34, v154
    v_fmac_f32 v255, v35, v155
    v_fmac_f32 v255, v36, v156
    v_fmac_f32 v255, v37, v157
    v_fmac_f32 v255, v38, v158
    v_fmac_f32 v255, v39, v159
    v_fma_f32 v203, v40, -v168, v203
    v_fma_f32 v203, v41, -v169, v203
    v_permlane32_swap_b32 v255, v201
    v_fma_f32 v203, v42, -v170, v203
    v_fma_f32 v203, v43, -v171, v203
    v_fma_f32 v203, v44, -v172, v203
    v_fma_f32 v203, v45, -v173, v203
    v_fma_f32 v203, v46, -v174, v203
    v_fma_f32 v203, v47, -v175, v203
    v_add_f32 v201, v255, v201
    v_fmac_f32 v199, v48, v120
    v_permlane32_swap_b32 v203, v255
    v_fmac_f32 v199, v49, v121
    v_fmac_f32 v199, v50, v122
    v_fmac_f32 v199, v51, v123
    v_fmac_f32 v199, v52, v124
    v_fmac_f32 v199, v53, v125
    v_fmac_f32 v199, v54, v126
    v_fmac_f32 v199, v55, v127
    v_add_f32 v255, v203, v255
    v_mul_f32 v197, v56, v168
    v_fmac_f32 v197, v57, v169
    v_fmac_f32 v197, v58, v170
    v_fmac_f32 v197, v59, v171
    v_fmac_f32 v197, v60, v172
    v_fmac_f32 v197, v61, v173
    v_fmac_f32 v197, v62, v174
    v_fmac_f32 v197, v63, v175
    s_nop 1
    v_permlane32_swap_b32 v199, v197
    v_add_f32 v197, v199, v197
    v_cvt_pk_bf16_f32 v200, v200, v201
    v_cvt_pk_bf16_f32 v254, v254, v255
    v_cvt_pk_bf16_f32 v196, v196, v197
    ds_write2st64_b32 v253, v200, v196 offset0:3 offset1:4
    s_mov_b64 exec, 0xffffffff
    ds_write_b32 v253, v254 offset:1280
    s_mov_b64 exec, -1
    s_add_u32 s50, s50, 1
    s_cmp_ge_u32 s50, 4
    s_cbranch_scc1 LAST1
    s_waitcnt lgkmcnt(7)
    v_readfirstlane_b32 s66, v252
    s_add_u32 s53, s53, 1
    v_mov_b32 v252, s53
    s_cmp_le_u32 s53, s66
    ds_write2_b32 v251, v252, v252 offset0:0 offset1:8
    s_setprio 1
    s_cbranch_scc1 PRIO_13
    s_setprio 0
PRIO_13:
    s_cmp_eq_u32 s52, 4
    s_cbranch_scc1 ITEM_1_4
    s_cmp_eq_u32 s52, 5
    s_cbranch_scc1 ITEM_1_5
    s_cmp_eq_u32 s52, 3
    s_cbranch_scc1 ITEM_1_3
    s_cmp_eq_u32 s52, 6
    s_cbranch_scc1 ITEM_1_6
    s_cmp_eq_u32 s52, 8
    s_cbranch_scc1 ITEM_1_8
    s_branch ITEM_1_2
.p2align 6
ITEM_1_6:
    s_mov_b64 exec, s[54:55]
    ds_read_u16_d16_hi v243, v250 offset:128
    s_mov_b64 exec, -1
    ds_read_b64_tr_b16 v[72:73], v249 offset:512
    ds_read_b64_tr_b16 v[76:77], v249 offset:576
    ds_read_b64_tr_b16 v[74:75], v249 offset:768
    ds_read_b64_tr_b16 v[78:79], v249 offset:832
    ds_read_b64_tr_b16 v[80:81], v249 offset:1024
    ds_read_b64_tr_b16 v[84:85], v249 offset:1088
    ds_read_b64_tr_b16 v[82:83], v249 offset:1280
    ds_read_b64_tr_b16 v[86:87], v249 offset:1344
    s_waitcnt lgkmcnt(9)
    v_mul_f32_dpp v196, v242, v64 row_newbcast:0 row_mask:0xf bank_mask:0xf
    v_mul_f32_dpp v197, v242, v65 row_newbcast:1 row_mask:0xf bank_mask:0xf
    v_mul_f32_dpp v198, v242, v64 row_newbcast:8 row_mask:0xf bank_mask:0xf
    v_mul_f32_dpp v199, v242, v65 row_newbcast:9 row_mask:0xf bank_mask:0xf
    v_mul_f32_dpp v200, v242, v68 row_newbcast:2 row_mask:0xf bank_mask:0xf
    v_mul_f32_dpp v201, v242, v69 row_newbcast:3 row_mask:0xf bank_mask:0xf
    v_mul_f32_dpp v202, v242, v68 row_newbcast:10 row_mask:0xf bank_mask:0xf
    v_mul_f32_dpp v203, v242, v69 row_newbcast:11 row_mask:0xf bank_mask:0xf
    v_cvt_pk_bf16_f32 v64, v196, v197
    v_cvt_pk_bf16_f32 v68, v198, v199
    v_cvt_pk_bf16_f32 v65, v200, v201
    v_cvt_pk_bf16_f32 v69, v202, v203
    v_mul_f32_dpp v196, v242, v66 row_newbcast:4 row_mask:0xf bank_mask:0xf
    v_mul_f32_dpp v197, v242, v67 row_newbcast:5 row_mask:0xf bank_mask:0xf
    v_mul_f32_dpp v198, v242, v66 row_newbcast:12 row_mask:0xf bank_mask:0xf
    v_mul_f32_dpp v199, v242, v67 row_newbcast:13 row_mask:0xf bank_mask:0xf
    v_mul_f32_dpp v200, v242, v70 row_newbcast:6 row_mask:0xf bank_mask:0xf
    v_mul_f32_dpp v201, v242, v71 row_newbcast:7 row_mask:0xf bank_mask:0xf
    v_mul_f32_dpp v202, v242, v70 row_newbcast:14 row_mask:0xf bank_mask:0xf
    v_mul_f32_dpp v203, v242, v71 row_newbcast:15 row_mask:0xf bank_mask:0xf
    v_cvt_pk_bf16_f32 v66, v196, v197
    v_cvt_pk_bf16_f32 v70, v198, v199
    v_cvt_pk_bf16_f32 v67, v200, v201
    v_cvt_pk_bf16_f32 v71, v202, v203
    s_mov_b64 exec, s[54:55]
    ds_read_u16_d16_hi v242, v250 offset:256
    s_mov_b64 exec, -1
    s_waitcnt vmcnt(4) lgkmcnt(5)
    v_mfma_f32_32x32x16_bf16 v[0:15], v[64:67], v[176:179], 0
    v_mul_f32_dpp v196, v243, v72 row_newbcast:0 row_mask:0xf bank_mask:0xf
    v_mul_f32_dpp v197, v243, v73 row_newbcast:1 row_mask:0xf bank_mask:0xf
    v_mul_f32_dpp v198, v243, v72 row_newbcast:8 row_mask:0xf bank_mask:0xf
    v_mul_f32_dpp v199, v243, v73 row_newbcast:9 row_mask:0xf bank_mask:0xf
    v_mul_f32_dpp v200, v243, v76 row_newbcast:2 row_mask:0xf bank_mask:0xf
    v_mul_f32_dpp v201, v243, v77 row_newbcast:3 row_mask:0xf bank_mask:0xf
    v_mul_f32_dpp v202, v243, v76 row_newbcast:10 row_mask:0xf bank_mask:0xf
    v_mul_f32_dpp v203, v243, v77 row_newbcast:11 row_mask:0xf bank_mask:0xf
    v_cvt_pk_bf16_f32 v72, v196, v197
    v_cvt_pk_bf16_f32 v76, v198, v199
    v_cvt_pk_bf16_f32 v73, v200, v201
    v_cvt_pk_bf16_f32 v77, v202, v203
    s_add_u32 m0, s21, 0
    v_mfma_f32_32x32x16_bf16 v[16:31], v[68:71], v[176:179], 0
    buffer_load_dwordx4 v236, s[4:7], s35 offen lds
    buffer_load_dwordx4 v237, s[8:11], s35 offen offset:1024 lds
    ds_read_b64_tr_b16 v[176:177], v244 offset:2048
    ds_read_b64_tr_b16 v[178:179], v244 offset:3072
    ds_read_b64_tr_b16 v[184:185], v245 offset:2048
    ds_read_b64_tr_b16 v[186:187], v245 offset:3072
    v_mul_f32_dpp v196, v243, v74 row_newbcast:4 row_mask:0xf bank_mask:0xf
    v_mul_f32_dpp v197, v243, v75 row_newbcast:5 row_mask:0xf bank_mask:0xf
    v_mul_f32_dpp v198, v243, v74 row_newbcast:12 row_mask:0xf bank_mask:0xf
    v_mul_f32_dpp v199, v243, v75 row_newbcast:13 row_mask:0xf bank_mask:0xf
    v_mul_f32_dpp v200, v243, v78 row_newbcast:6 row_mask:0xf bank_mask:0xf
    v_mul_f32_dpp v201, v243, v79 row_newbcast:7 row_mask:0xf bank_mask:0xf
    v_mul_f32_dpp v202, v243, v78 row_newbcast:14 row_mask:0xf bank_mask:0xf
    v_mul_f32_dpp v203, v243, v79 row_newbcast:15 row_mask:0xf bank_mask:0xf
    v_cvt_pk_bf16_f32 v74, v196, v197
    v_cvt_pk_bf16_f32 v78, v198, v199
    v_cvt_pk_bf16_f32 v75, v200, v201
    v_cvt_pk_bf16_f32 v79, v202, v203
    s_nop 0
    s_waitcnt vmcnt(4) lgkmcnt(0)
    v_mfma_f32_32x32x16_bf16 v[0:15], v[72:75], v[176:179], v[0:15]
    v_mul_f32_dpp v196, v242, v80 row_newbcast:0 row_mask:0xf bank_mask:0xf
    v_mul_f32_dpp v197, v242, v81 row_newbcast:1 row_mask:0xf bank_mask:0xf
    v_mul_f32_dpp v198, v242, v80 row_newbcast:8 row_mask:0xf bank_mask:0xf
    v_mul_f32_dpp v199, v242, v81 row_newbcast:9 row_mask:0xf bank_mask:0xf
    v_mul_f32_dpp v200, v242, v84 row_newbcast:2 row_mask:0xf bank_mask:0xf
    v_mul_f32_dpp v201, v242, v85 row_newbcast:3 row_mask:0xf bank_mask:0xf
    v_mul_f32_dpp v202, v242, v84 row_newbcast:10 row_mask:0xf bank_mask:0xf
    v_mul_f32_dpp v203, v242, v85 row_newbcast:11 row_mask:0xf bank_mask:0xf
    v_cvt_pk_bf16_f32 v80, v196, v197
    v_cvt_pk_bf16_f32 v84, v198, v199
    v_cvt_pk_bf16_f32 v81, v200, v201
    v_cvt_pk_bf16_f32 v85, v202, v203
    s_add_u32 m0, s21, 2048
    v_mfma_f32_32x32x16_bf16 v[16:31], v[76:79], v[176:179], v[16:31]
    buffer_load_dwordx4 v238, s[4:7], s35 offen lds
    buffer_load_dwordx4 v239, s[8:11], s35 offen offset:1024 lds
    ds_read_b64_tr_b16 v[176:177], v244 offset:4096
    ds_read_b64_tr_b16 v[178:179], v244 offset:5120
    ds_read_b64_tr_b16 v[188:189], v245 offset:4096
    ds_read_b64_tr_b16 v[190:191], v245 offset:5120
    v_mul_f32_dpp v196, v242, v82 row_newbcast:4 row_mask:0xf bank_mask:0xf
    v_mul_f32_dpp v197, v242, v83 row_newbcast:5 row_mask:0xf bank_mask:0xf
    v_mul_f32_dpp v198, v242, v82 row_newbcast:12 row_mask:0xf bank_mask:0xf
    v_mul_f32_dpp v199, v242, v83 row_newbcast:13 row_mask:0xf bank_mask:0xf
    v_mul_f32_dpp v200, v242, v86 row_newbcast:6 row_mask:0xf bank_mask:0xf
    v_mul_f32_dpp v201, v242, v87 row_newbcast:7 row_mask:0xf bank_mask:0xf
    v_mul_f32_dpp v202, v242, v86 row_newbcast:14 row_mask:0xf bank_mask:0xf
    v_mul_f32_dpp v203, v242, v87 row_newbcast:15 row_mask:0xf bank_mask:0xf
    v_cvt_pk_bf16_f32 v82, v196, v197
    v_cvt_pk_bf16_f32 v86, v198, v199
    v_cvt_pk_bf16_f32 v83, v200, v201
    v_cvt_pk_bf16_f32 v87, v202, v203
    s_nop 0
    s_waitcnt lgkmcnt(0)
    v_mfma_f32_32x32x16_bf16 v[0:15], v[80:83], v[176:179], v[0:15]
    s_add_u32 m0, s21, 4096
    v_mfma_f32_32x32x16_bf16 v[16:31], v[84:87], v[176:179], v[16:31]
    buffer_load_dwordx4 v234, s[4:7], s36 offen lds
    buffer_load_dwordx4 v235, s[8:11], s36 offen offset:1024 lds
    s_mov_b32 m0, s50
    s_nop 0
    s_movrels_b32 s71, s23
    s_movrels_b32 s33, s28
    s_and_b32 s70, s33, 0x70
    s_andn2_b32 s33, s33, 0x70
    v_xor_b32 v253, s70, v248
    v_add_u32 v253, s33, v253
    s_bfe_u32 s46, s71, 0x30012
    s_mov_b32 m0, s46
    s_and_b32 s66, s71, 0x3ffff
    s_movrels_b32 s68, s57
    s_movrels_b32 s69, s61
    s_sub_u32 s48, s66, s47
    s_mov_b32 s47, s66
    s_lshr_b32 s52, s71, 28
    s_lshl_b32 s67, s46, 9
    s_add_u32 s66, s66, s67
    s_sub_u32 s49, s66, s42
    s_mov_b32 s42, s66
    s_bfe_u32 s66, s68, 655360
    s_add_u32 s43, s42, s66
    s_bfe_u32 s39, s69, 655360
    s_bfe_u32 s66, s68, 655370
    s_add_u32 s44, s42, s66
    s_bfe_u32 s40, s69, 655370
    s_bfe_u32 s66, s68, 655380
    s_add_u32 s45, s42, s66
    s_bfe_u32 s41, s69, 655380
    v_add_u32 v252, s45, v247
    ds_read_u16 v240, v252
    ds_read_u16 v241, v252 offset:64
    v_mfma_f32_32x32x16_bf16 v[32:47], v[64:67], v[180:183], 0
    v_mul_f32 v196, v0, v96
    v_fmac_f32 v196, v1, v97
    v_fmac_f32 v196, v2, v98
    v_fmac_f32 v196, v3, v99
    v_fmac_f32 v196, v4, v100
    v_fmac_f32 v196, v5, v101
    v_fmac_f32 v196, v6, v102
    v_mfma_f32_32x32x16_bf16 v[48:63], v[68:71], v[180:183], 0
    v_fmac_f32 v196, v7, v103
    v_mul_f32 v198, v8, v128
    v_fmac_f32 v198, v9, v129
    v_fmac_f32 v198, v10, v130
    v_fmac_f32 v198, v11, v131
    v_fmac_f32 v198, v12, v132
    v_mfma_f32_32x32x16_bf16 v[32:47], v[72:75], v[184:187], v[32:47]
    v_fmac_f32 v198, v13, v133
    v_fmac_f32 v198, v14, v134
    v_fmac_f32 v198, v15, v135
    v_mul_f32 v200, v16, v128
    v_fmac_f32 v200, v17, v129
    v_permlane32_swap_b32 v196, v198
    v_mfma_f32_32x32x16_bf16 v[48:63], v[76:79], v[184:187], v[48:63]
    s_waitcnt vmcnt(6)
    ds_read_b64_tr_b16 v[176:177], v244 offset:6144
    ds_read_b64_tr_b16 v[178:179], v244 offset:7168
    ds_read_b64_tr_b16 v[180:181], v245 offset:6144
    ds_read_b64_tr_b16 v[182:183], v245 offset:7168
    v_fmac_f32 v200, v18, v130
    v_fmac_f32 v200, v19, v131
    v_fmac_f32 v200, v20, v132
    v_fmac_f32 v200, v21, v133
    v_fmac_f32 v200, v22, v134
    v_fmac_f32 v200, v23, v135
    v_mfma_f32_32x32x16_bf16 v[32:47], v[80:83], v[188:191], v[32:47]
    v_add_f32 v198, v196, v198
    v_mul_f32_e64 v202, v24, -v128
    v_fma_f32 v202, v25, -v129, v202
    v_fma_f32 v202, v26, -v130, v202
    v_fma_f32 v202, v27, -v131, v202
    v_fma_f32 v202, v28, -v132, v202
    v_mfma_f32_32x32x16_bf16 v[48:63], v[84:87], v[188:191], v[48:63]
    v_fma_f32 v202, v29, -v133, v202
    v_fma_f32 v202, v30, -v134, v202
    v_fma_f32 v202, v31, -v135, v202
    s_nop 1
    v_permlane32_swap_b32 v200, v202
    v_add_f32 v202, v200, v202
    s_waitcnt vmcnt(4) lgkmcnt(0)
    v_mfma_f32_32x32x16_bf16 v[0:15], v[64:67], v[176:179], 0
    v_mul_f32 v197, v32, v104
    v_fmac_f32 v197, v33, v105
    v_fmac_f32 v197, v34, v106
    v_fmac_f32 v197, v35, v107
    v_fmac_f32 v197, v36, v108
    v_fmac_f32 v197, v37, v109
    v_fmac_f32 v197, v38, v110
    s_add_u32 m0, s21, 6144
    v_mfma_f32_32x32x16_bf16 v[16:31], v[68:71], v[176:179], 0
    buffer_load_dwordx4 v236, s[4:7], s36 offen lds
    buffer_load_dwordx4 v237, s[8:11], s36 offen offset:1024 lds
    ds_read_b64_tr_b16 v[176:177], v244 offset:0
    ds_read_b64_tr_b16 v[178:179], v244 offset:1024
    ds_read_b64_tr_b16 v[184:185], v245 offset:0
    ds_read_b64_tr_b16 v[186:187], v245 offset:1024
    v_fmac_f32 v197, v39, v111
    v_mul_f32 v199, v40, v136
    v_fmac_f32 v199, v41, v137
    v_fmac_f32 v199, v42, v138
    v_fmac_f32 v199, v43, v139
    v_fmac_f32 v199, v44, v140
    v_fmac_f32 v199, v45, v141
    s_waitcnt vmcnt(4) lgkmcnt(0)
    v_mfma_f32_32x32x16_bf16 v[0:15], v[72:75], v[176:179], v[0:15]
    v_fmac_f32 v199, v46, v142
    v_fmac_f32 v199, v47, v143
    v_mul_f32 v201, v48, v136
    v_fmac_f32 v201, v49, v137
    v_permlane32_swap_b32 v197, v199
    v_fmac_f32 v201, v50, v138
    s_add_u32 m0, s21, 0
    v_mfma_f32_32x32x16_bf16 v[16:31], v[76:79], v[176:179], v[16:31]
    buffer_load_dwordx4 v238, s[4:7], s36 offen lds
    buffer_load_dwordx4 v239, s[8:11], s36 offen offset:1024 lds
    ds_read_b64_tr_b16 v[176:177], v244 offset:2048
    ds_read_b64_tr_b16 v[178:179], v244 offset:3072
    ds_read_b64_tr_b16 v[188:189], v245 offset:2048
    ds_read_b64_tr_b16 v[190:191], v245 offset:3072
    v_fmac_f32 v201, v51, v139
    v_fmac_f32 v201, v52, v140
    v_fmac_f32 v201, v53, v141
    v_fmac_f32 v201, v54, v142
    v_fmac_f32 v201, v55, v143
    v_add_f32 v199, v197, v199
    v_mul_f32_e64 v203, v56, -v136
    s_waitcnt lgkmcnt(0)
    v_mfma_f32_32x32x16_bf16 v[0:15], v[80:83], v[176:179], v[0:15]
    v_fma_f32 v203, v57, -v137, v203
    v_fma_f32 v203, v58, -v138, v203
    v_fma_f32 v203, v59, -v139, v203
    v_fma_f32 v203, v60, -v140, v203
    v_fma_f32 v203, v61, -v141, v203
    v_fma_f32 v203, v62, -v142, v203
    v_fma_f32 v203, v63, -v143, v203
    s_add_u32 m0, s21, 2048
    v_mfma_f32_32x32x16_bf16 v[16:31], v[84:87], v[176:179], v[16:31]
    buffer_load_dwordx4 v234, s[4:7], s37 offen lds
    buffer_load_dwordx4 v235, s[8:11], s37 offen offset:1024 lds
    v_add_u32 v252, s42, v247
    ds_read_u16 v234, v252
    ds_read_u16 v235, v252 offset:64
    s_nop 1
    v_permlane32_swap_b32 v201, v203
    v_add_f32 v203, v201, v203
    v_cvt_pk_bf16_f32 v198, v198, v199
    v_cvt_pk_bf16_f32 v202, v202, v203
    ds_write2st64_b32 v253, v198, v202 offset0:0 offset1:1
    v_mfma_f32_32x32x16_bf16 v[32:47], v[64:67], v[180:183], 0
    v_mul_f32 v196, v0, v144
    v_fmac_f32 v196, v1, v145
    v_fmac_f32 v196, v2, v146
    v_fmac_f32 v196, v3, v147
    v_fmac_f32 v196, v4, v148
    v_fmac_f32 v196, v5, v149
    v_mfma_f32_32x32x16_bf16 v[48:63], v[68:71], v[180:183], 0
    v_fmac_f32 v196, v6, v150
    v_fmac_f32 v196, v7, v151
    v_mul_f32 v198, v8, v112
    v_fmac_f32 v198, v9, v113
    v_fmac_f32 v198, v10, v114
    v_mfma_f32_32x32x16_bf16 v[32:47], v[72:75], v[184:187], v[32:47]
    v_fmac_f32 v198, v11, v115
    v_fmac_f32 v198, v12, v116
    v_fmac_f32 v198, v13, v117
    v_fmac_f32 v198, v14, v118
    v_fmac_f32 v198, v15, v119
    v_mfma_f32_32x32x16_bf16 v[48:63], v[76:79], v[184:187], v[48:63]
    s_waitcnt vmcnt(6)
    ds_read_b64_tr_b16 v[176:177], v244 offset:4096
    ds_read_b64_tr_b16 v[178:179], v244 offset:5120
    ds_read_b64_tr_b16 v[180:181], v245 offset:4096
    ds_read_b64_tr_b16 v[182:183], v245 offset:5120
    v_mul_f32_e64 v200, v16, -v160
    v_fma_f32 v200, v17, -v161, v200
    v_fma_f32 v200, v18, -v162, v200
    v_fma_f32 v200, v19, -v163, v200
    v_fma_f32 v200, v20, -v164, v200
    v_fma_f32 v200, v21, -v165, v200
    v_mfma_f32_32x32x16_bf16 v[32:47], v[80:83], v[188:191], v[32:47]
    v_fma_f32 v200, v22, -v166, v200
    v_fma_f32 v200, v23, -v167, v200
    v_mul_f32_e64 v202, v24, -v160
    v_fma_f32 v202, v25, -v161, v202
    v_fma_f32 v202, v26, -v162, v202
    v_mfma_f32_32x32x16_bf16 v[48:63], v[84:87], v[188:191], v[48:63]
    v_fma_f32 v202, v27, -v163, v202
    v_fma_f32 v202, v28, -v164, v202
    v_fma_f32 v202, v29, -v165, v202
    v_fma_f32 v202, v30, -v166, v202
    v_fma_f32 v202, v31, -v167, v202
    s_waitcnt vmcnt(4) lgkmcnt(0)
    v_mfma_f32_32x32x16_bf16 v[0:15], v[64:67], v[176:179], 0
    v_mul_f32 v197, v32, v152
    v_fmac_f32 v197, v33, v153
    v_fmac_f32 v197, v34, v154
    v_fmac_f32 v197, v35, v155
    v_fmac_f32 v197, v36, v156
    v_fmac_f32 v197, v37, v157
    s_add_u32 m0, s21, 4096
    v_mfma_f32_32x32x16_bf16 v[16:31], v[68:71], v[176:179], 0
    buffer_load_dwordx4 v236, s[4:7], s37 offen lds
    buffer_load_dwordx4 v237, s[8:11], s37 offen offset:1024 lds
    ds_read_b64_tr_b16 v[176:177], v244 offset:6144
    ds_read_b64_tr_b16 v[178:179], v244 offset:7168
    ds_read_b64_tr_b16 v[184:185], v245 offset:6144
    ds_read_b64_tr_b16 v[186:187], v245 offset:7168
    v_add_u32 v252, s43, v247
    ds_read_u16 v236, v252
    ds_read_u16 v237, v252 offset:64
    v_fmac_f32 v197, v38, v158
    v_fmac_f32 v197, v39, v159
    v_mul_f32 v199, v40, v120
    v_fmac_f32 v199, v41, v121
    v_fmac_f32 v199, v42, v122
    s_waitcnt vmcnt(4) lgkmcnt(2)
    v_mfma_f32_32x32x16_bf16 v[0:15], v[72:75], v[176:179], v[0:15]
    v_fmac_f32 v199, v43, v123
    v_fmac_f32 v199, v44, v124
    v_fmac_f32 v199, v45, v125
    v_fmac_f32 v199, v46, v126
    v_fmac_f32 v199, v47, v127
    s_add_u32 m0, s21, 6144
    v_mfma_f32_32x32x16_bf16 v[16:31], v[76:79], v[176:179], v[16:31]
    buffer_load_dwordx4 v238, s[4:7], s37 offen lds
    buffer_load_dwordx4 v239, s[8:11], s37 offen offset:1024 lds
    ds_read_b64_tr_b16 v[176:177], v244 offset:0
    ds_read_b64_tr_b16 v[178:179], v244 offset:1024
    ds_read_b64_tr_b16 v[188:189], v245 offset:0
    ds_read_b64_tr_b16 v[190:191], v245 offset:1024
    v_add_u32 v252, s44, v247
    ds_read_u16 v238, v252
    ds_read_u16 v239, v252 offset:64
    v_mul_f32_e64 v201, v48, -v168
    v_fma_f32 v201, v49, -v169, v201
    v_fma_f32 v201, v50, -v170, v201
    v_fma_f32 v201, v51, -v171, v201
    v_fma_f32 v201, v52, -v172, v201
    v_fma_f32 v201, v53, -v173, v201
    s_waitcnt lgkmcnt(2)
    v_mfma_f32_32x32x16_bf16 v[0:15], v[80:83], v[176:179], v[0:15]
    v_fma_f32 v201, v54, -v174, v201
    v_fma_f32 v201, v55, -v175, v201
    v_mul_f32_e64 v203, v56, -v168
    v_fma_f32 v203, v57, -v169, v203
    v_fma_f32 v203, v58, -v170, v203
    s_add_u32 m0, s21, 0
    v_mfma_f32_32x32x16_bf16 v[16:31], v[84:87], v[176:179], v[16:31]
    v_lshl_add_u32 v234, v234, 10, v246
    v_lshl_add_u32 v235, v235, 10, v246
    buffer_load_dwordx4 v234, s[4:7], s38 offen lds
    buffer_load_dwordx4 v235, s[8:11], s38 offen offset:1024 lds
    v_fma_f32 v203, v59, -v171, v203
    v_fma_f32 v203, v60, -v172, v203
    v_fma_f32 v203, v61, -v173, v203
    v_fma_f32 v203, v62, -v174, v203
    v_fma_f32 v203, v63, -v175, v203
    v_mfma_f32_32x32x16_bf16 v[32:47], v[64:67], v[180:183], 0
    v_mul_f32 v254, v0, v144
    v_fmac_f32 v254, v1, v145
    v_fmac_f32 v254, v2, v146
    v_mfma_f32_32x32x16_bf16 v[48:63], v[68:71], v[180:183], 0
    ds_swizzle_b32 v68, v68 offset:0x401F
    ds_swizzle_b32 v69, v69 offset:0x401F
    ds_swizzle_b32 v70, v70 offset:0x401F
    ds_swizzle_b32 v71, v71 offset:0x401F
    v_fmac_f32 v254, v3, v147
    v_fmac_f32 v254, v4, v148
    v_fmac_f32 v254, v5, v149
    v_mfma_f32_32x32x16_bf16 v[32:47], v[72:75], v[184:187], v[32:47]
    v_fmac_f32 v254, v6, v150
    v_fmac_f32 v254, v7, v151
    v_fmac_f32 v200, v8, v160
    v_mfma_f32_32x32x16_bf16 v[48:63], v[76:79], v[184:187], v[48:63]
    ds_swizzle_b32 v76, v76 offset:0x401F
    ds_swizzle_b32 v77, v77 offset:0x401F
    ds_swizzle_b32 v78, v78 offset:0x401F
    ds_swizzle_b32 v79, v79 offset:0x401F
    s_waitcnt vmcnt(6)
    ds_read_b64_tr_b16 v[176:177], v244 offset:2048
    ds_read_b64_tr_b16 v[178:179], v244 offset:3072
    ds_read_b64_tr_b16 v[180:181], v245 offset:2048
    ds_read_b64_tr_b16 v[182:183], v245 offset:3072
    v_fmac_f32 v200, v9, v161
    v_permlane32_swap_b32 v196, v254
    v_fmac_f32 v200, v10, v162
    v_mfma_f32_32x32x16_bf16 v[32:47], v[80:83], v[188:191], v[32:47]
    v_fmac_f32 v200, v11, v163
    v_fmac_f32 v200, v12, v164
    v_fmac_f32 v200, v13, v165
    v_mfma_f32_32x32x16_bf16 v[48:63], v[84:87], v[188:191], v[48:63]
    ds_swizzle_b32 v84, v84 offset:0x401F
    ds_swizzle_b32 v85, v85 offset:0x401F
    ds_swizzle_b32 v86, v86 offset:0x401F
    ds_swizzle_b32 v87, v87 offset:0x401F
    v_fmac_f32 v200, v14, v166
    v_fmac_f32 v200, v15, v167
    v_add_f32 v254, v196, v254
    s_waitcnt lgkmcnt(8)
    s_mov_b64 exec, s[56:57]
    v_xor_b32 v68, 0x80008000, v68
    v_xor_b32 v69, 0x80008000, v69
    v_xor_b32 v70, 0x80008000, v70
    v_xor_b32 v71, 0x80008000, v71
    v_xor_b32 v76, 0x80008000, v76
    v_xor_b32 v77, 0x80008000, v77
    v_xor_b32 v78, 0x80008000, v78
    v_xor_b32 v79, 0x80008000, v79
    s_mov_b64 exec, -1
    s_waitcnt vmcnt(4) lgkmcnt(4)
    v_mfma_f32_32x32x16_bf16 v[0:15], v[64:67], v[176:179], 0
    v_mul_f32 v255, v32, v152
    v_fmac_f32 v255, v33, v153
    v_fmac_f32 v255, v34, v154
    v_fmac_f32 v255, v35, v155
    s_add_u32 m0, s21, 2048
    v_mfma_f32_32x32x16_bf16 v[16:31], v[68:71], v[176:179], v[16:31]
    v_lshl_add_u32 v236, v236, 10, v246
    v_lshl_add_u32 v237, v237, 10, v246
    buffer_load_dwordx4 v236, s[4:7], s39 offen lds
    buffer_load_dwordx4 v237, s[8:11], s39 offen offset:1024 lds
    ds_read_b64_tr_b16 v[176:177], v244 offset:4096
    ds_read_b64_tr_b16 v[178:179], v244 offset:5120
    ds_read_b64_tr_b16 v[184:185], v245 offset:4096
    ds_read_b64_tr_b16 v[186:187], v245 offset:5120
    v_fmac_f32 v255, v36, v156
    v_fmac_f32 v255, v37, v157
    v_fmac_f32 v255, v38, v158
    s_waitcnt vmcnt(4) lgkmcnt(0)
    v_mfma_f32_32x32x16_bf16 v[0:15], v[72:75], v[176:179], v[0:15]
    v_fmac_f32 v255, v39, v159
    v_fmac_f32 v201, v40, v168
    v_fmac_f32 v201, v41, v169
    s_add_u32 m0, s21, 4096
    v_mfma_f32_32x32x16_bf16 v[16:31], v[76:79], v[176:179], v[16:31]
    v_lshl_add_u32 v238, v238, 10, v246
    v_lshl_add_u32 v239, v239, 10, v246
    buffer_load_dwordx4 v238, s[4:7], s40 offen lds
    buffer_load_dwordx4 v239, s[8:11], s40 offen offset:1024 lds
    ds_read_b64_tr_b16 v[176:177], v244 offset:6144
    ds_read_b64_tr_b16 v[178:179], v244 offset:7168
    ds_read_b64_tr_b16 v[188:189], v245 offset:6144
    ds_read_b64_tr_b16 v[190:191], v245 offset:7168
    v_permlane32_swap_b32 v197, v255
    v_fmac_f32 v201, v42, v170
    v_fmac_f32 v201, v43, v171
    v_fmac_f32 v201, v44, v172
    s_waitcnt lgkmcnt(0)
    s_mov_b64 exec, s[56:57]
    v_xor_b32 v84, 0x80008000, v84
    v_xor_b32 v85, 0x80008000, v85
    v_xor_b32 v86, 0x80008000, v86
    v_xor_b32 v87, 0x80008000, v87
    s_mov_b64 exec, -1
    v_mfma_f32_32x32x16_bf16 v[0:15], v[80:83], v[176:179], v[0:15]
    v_fmac_f32 v201, v45, v173
    v_fmac_f32 v201, v46, v174
    v_fmac_f32 v201, v47, v175
    s_add_u32 m0, s21, 6144
    v_mfma_f32_32x32x16_bf16 v[16:31], v[84:87], v[176:179], v[16:31]
    v_lshl_add_u32 v240, v240, 10, v246
    v_lshl_add_u32 v241, v241, 10, v246
    buffer_load_dwordx4 v240, s[4:7], s41 offen lds
    buffer_load_dwordx4 v241, s[8:11], s41 offen offset:1024 lds
    v_add_f32 v255, v197, v255
    v_cvt_pk_bf16_f32 v254, v254, v255
    ds_write_b32 v253, v254 offset:512
    v_mfma_f32_32x32x16_bf16 v[32:47], v[64:67], v[180:183], 0
    v_mul_f32 v254, v0, v144
    v_fmac_f32 v254, v1, v145
    v_fmac_f32 v254, v2, v146
    v_fmac_f32 v254, v3, v147
    v_fmac_f32 v254, v4, v148
    v_fmac_f32 v254, v5, v149
    v_fmac_f32 v254, v6, v150
    v_mfma_f32_32x32x16_bf16 v[48:63], v[68:71], v[180:183], v[48:63]
    v_fmac_f32 v254, v7, v151
    v_fma_f32 v202, v8, -v160, v202
    v_fma_f32 v202, v9, -v161, v202
    v_permlane32_swap_b32 v254, v200
    v_fma_f32 v202, v10, -v162, v202
    v_fma_f32 v202, v11, -v163, v202
    v_mfma_f32_32x32x16_bf16 v[32:47], v[72:75], v[184:187], v[32:47]
    v_fma_f32 v202, v12, -v164, v202
    v_fma_f32 v202, v13, -v165, v202
    v_fma_f32 v202, v14, -v166, v202
    v_fma_f32 v202, v15, -v167, v202
    v_add_f32 v200, v254, v200
    v_fmac_f32 v198, v16, v112
    v_permlane32_swap_b32 v202, v254
    v_mfma_f32_32x32x16_bf16 v[48:63], v[76:79], v[184:187], v[48:63]
    s_waitcnt vmcnt(6)
    ds_read_b64_tr_b16 v[176:177], v244 offset:0
    ds_read_b64_tr_b16 v[178:179], v244 offset:1024
    ds_read_b64_tr_b16 v[180:181], v245 offset:0
    ds_read_b64_tr_b16 v[182:183], v245 offset:1024
    v_fmac_f32 v198, v17, v113
    v_fmac_f32 v198, v18, v114
    v_fmac_f32 v198, v19, v115
    v_fmac_f32 v198, v20, v116
    v_fmac_f32 v198, v21, v117
    v_fmac_f32 v198, v22, v118
    v_mfma_f32_32x32x16_bf16 v[32:47], v[80:83], v[188:191], v[32:47]
    v_fmac_f32 v198, v23, v119
    v_add_f32 v254, v202, v254
    v_mul_f32 v196, v24, v160
    v_fmac_f32 v196, v25, v161
    v_fmac_f32 v196, v26, v162
    v_fmac_f32 v196, v27, v163
    v_fmac_f32 v196, v28, v164
    v_mfma_f32_32x32x16_bf16 v[48:63], v[84:87], v[188:191], v[48:63]
    v_add_u32 v249, s48, v249
    v_add_u32 v250, s49, v250
    ds_read_b32 v252, v251 offset:16
    ds_read_b64_tr_b16 v[64:65], v249 offset:0
    ds_read_b64_tr_b16 v[68:69], v249 offset:64
    ds_read_b64_tr_b16 v[66:67], v249 offset:256
    ds_read_b64_tr_b16 v[70:71], v249 offset:320
    s_mov_b64 exec, s[54:55]
    ds_read_u16_d16_hi v242, v250 offset:0
    s_mov_b64 exec, -1
    v_fmac_f32 v196, v29, v165
    v_fmac_f32 v196, v30, v166
    v_fmac_f32 v196, v31, v167
    s_nop 1
    v_permlane32_swap_b32 v198, v196
    v_add_f32 v196, v198, v196
    v_mul_f32 v255, v32, v152
    v_fmac_f32 v255, v33, v153
    v_fmac_f32 v255, v34, v154
    v_fmac_f32 v255, v35, v155
    v_fmac_f32 v255, v36, v156
    v_fmac_f32 v255, v37, v157
    v_fmac_f32 v255, v38, v158
    v_fmac_f32 v255, v39, v159
    v_fma_f32 v203, v40, -v168, v203
    v_fma_f32 v203, v41, -v169, v203
    v_permlane32_swap_b32 v255, v201
    v_fma_f32 v203, v42, -v170, v203
    v_fma_f32 v203, v43, -v171, v203
    v_fma_f32 v203, v44, -v172, v203
    v_fma_f32 v203, v45, -v173, v203
    v_fma_f32 v203, v46, -v174, v203
    v_fma_f32 v203, v47, -v175, v203
    v_add_f32 v201, v255, v201
    v_fmac_f32 v199, v48, v120
    v_permlane32_swap_b32 v203, v255
    v_fmac_f32 v199, v49, v121
    v_fmac_f32 v199, v50, v122
    v_fmac_f32 v199, v51, v123
    v_fmac_f32 v199, v52, v124
    v_fmac_f32 v199, v53, v125
    v_fmac_f32 v199, v54, v126
    v_fmac_f32 v199, v55, v127
    v_add_f32 v255, v203, v255
    v_mul_f32 v197, v56, v168
    v_fmac_f32 v197, v57, v169
    v_fmac_f32 v197, v58, v170
    v_fmac_f32 v197, v59, v171
    v_fmac_f32 v197, v60, v172
    v_fmac_f32 v197, v61, v173
    v_fmac_f32 v197, v62, v174
    v_fmac_f32 v197, v63, v175
    s_nop 1
    v_permlane32_swap_b32 v199, v197
    v_add_f32 v197, v199, v197
    v_cvt_pk_bf16_f32 v200, v200, v201
    v_cvt_pk_bf16_f32 v254, v254, v255
    v_cvt_pk_bf16_f32 v196, v196, v197
    ds_write2st64_b32 v253, v200, v196 offset0:3 offset1:4
    s_mov_b64 exec, 0xffffffff
    ds_write_b32 v253, v254 offset:1280
    s_mov_b64 exec, -1
    s_add_u32 s50, s50, 1
    s_cmp_ge_u32 s50, 4
    s_cbranch_scc1 LAST1
    s_waitcnt lgkmcnt(7)
    v_readfirstlane_b32 s66, v252
    s_add_u32 s53, s53, 1
    v_mov_b32 v252, s53
    s_cmp_le_u32 s53, s66
    ds_write2_b32 v251, v252, v252 offset0:0 offset1:8
    s_setprio 1
    s_cbranch_scc1 PRIO_14
    s_setprio 0
PRIO_14:
    s_cmp_eq_u32 s52, 4
    s_cbranch_scc1 ITEM_1_4
    s_cmp_eq_u32 s52, 5
    s_cbranch_scc1 ITEM_1_5
    s_cmp_eq_u32 s52, 3
    s_cbranch_scc1 ITEM_1_3
    s_cmp_eq_u32 s52, 6
    s_cbranch_scc1 ITEM_1_6
    s_cmp_eq_u32 s52, 8
    s_cbranch_scc1 ITEM_1_8
    s_branch ITEM_1_2
.p2align 6
ITEM_1_8:
    s_mov_b64 exec, s[54:55]
    ds_read_u16_d16_hi v243, v250 offset:128
    s_mov_b64 exec, -1
    ds_read_b64_tr_b16 v[72:73], v249 offset:512
    ds_read_b64_tr_b16 v[76:77], v249 offset:576
    ds_read_b64_tr_b16 v[74:75], v249 offset:768
    ds_read_b64_tr_b16 v[78:79], v249 offset:832
    ds_read_b64_tr_b16 v[80:81], v249 offset:1024
    ds_read_b64_tr_b16 v[84:85], v249 offset:1088
    ds_read_b64_tr_b16 v[82:83], v249 offset:1280
    ds_read_b64_tr_b16 v[86:87], v249 offset:1344
    ds_read_b64_tr_b16 v[88:89], v249 offset:1536
    ds_read_b64_tr_b16 v[92:93], v249 offset:1600
    ds_read_b64_tr_b16 v[90:91], v249 offset:1792
    ds_read_b64_tr_b16 v[94:95], v249 offset:1856
    s_waitcnt lgkmcnt(13)
    v_mul_f32_dpp v196, v242, v64 row_newbcast:0 row_mask:0xf bank_mask:0xf
    v_mul_f32_dpp v197, v242, v65 row_newbcast:1 row_mask:0xf bank_mask:0xf
    v_mul_f32_dpp v198, v242, v64 row_newbcast:8 row_mask:0xf bank_mask:0xf
    v_mul_f32_dpp v199, v242, v65 row_newbcast:9 row_mask:0xf bank_mask:0xf
    v_mul_f32_dpp v200, v242, v68 row_newbcast:2 row_mask:0xf bank_mask:0xf
    v_mul_f32_dpp v201, v242, v69 row_newbcast:3 row_mask:0xf bank_mask:0xf
    v_mul_f32_dpp v202, v242, v68 row_newbcast:10 row_mask:0xf bank_mask:0xf
    v_mul_f32_dpp v203, v242, v69 row_newbcast:11 row_mask:0xf bank_mask:0xf
    v_cvt_pk_bf16_f32 v64, v196, v197
    v_cvt_pk_bf16_f32 v68, v198, v199
    v_cvt_pk_bf16_f32 v65, v200, v201
    v_cvt_pk_bf16_f32 v69, v202, v203
    v_mul_f32_dpp v196, v242, v66 row_newbcast:4 row_mask:0xf bank_mask:0xf
    v_mul_f32_dpp v197, v242, v67 row_newbcast:5 row_mask:0xf bank_mask:0xf
    v_mul_f32_dpp v198, v242, v66 row_newbcast:12 row_mask:0xf bank_mask:0xf
    v_mul_f32_dpp v199, v242, v67 row_newbcast:13 row_mask:0xf bank_mask:0xf
    v_mul_f32_dpp v200, v242, v70 row_newbcast:6 row_mask:0xf bank_mask:0xf
    v_mul_f32_dpp v201, v242, v71 row_newbcast:7 row_mask:0xf bank_mask:0xf
    v_mul_f32_dpp v202, v242, v70 row_newbcast:14 row_mask:0xf bank_mask:0xf
    v_mul_f32_dpp v203, v242, v71 row_newbcast:15 row_mask:0xf bank_mask:0xf
    v_cvt_pk_bf16_f32 v66, v196, v197
    v_cvt_pk_bf16_f32 v70, v198, v199
    v_cvt_pk_bf16_f32 v67, v200, v201
    v_cvt_pk_bf16_f32 v71, v202, v203
    s_mov_b64 exec, s[54:55]
    ds_read_u16_d16_hi v242, v250 offset:256
    s_mov_b64 exec, -1
    s_waitcnt vmcnt(4) lgkmcnt(9)
    v_mfma_f32_32x32x16_bf16 v[0:15], v[64:67], v[176:179], 0
    v_mul_f32_dpp v196, v243, v72 row_newbcast:0 row_mask:0xf bank_mask:0xf
    v_mul_f32_dpp v197, v243, v73 row_newbcast:1 row_mask:0xf bank_mask:0xf
    v_mul_f32_dpp v198, v243, v72 row_newbcast:8 row_mask:0xf bank_mask:0xf
    v_mul_f32_dpp v199, v243, v73 row_newbcast:9 row_mask:0xf bank_mask:0xf
    v_mul_f32_dpp v200, v243, v76 row_newbcast:2 row_mask:0xf bank_mask:0xf
    v_mul_f32_dpp v201, v243, v77 row_newbcast:3 row_mask:0xf bank_mask:0xf
    v_mul_f32_dpp v202, v243, v76 row_newbcast:10 row_mask:0xf bank_mask:0xf
    v_mul_f32_dpp v203, v243, v77 row_newbcast:11 row_mask:0xf bank_mask:0xf
    v_cvt_pk_bf16_f32 v72, v196, v197
    v_cvt_pk_bf16_f32 v76, v198, v199
    v_cvt_pk_bf16_f32 v73, v200, v201
    v_cvt_pk_bf16_f32 v77, v202, v203
    s_add_u32 m0, s21, 0
    v_mfma_f32_32x32x16_bf16 v[16:31], v[68:71], v[176:179], 0
    buffer_load_dwordx4 v234, s[4:7], s35 offen lds
    buffer_load_dwordx4 v235, s[8:11], s35 offen offset:1024 lds
    ds_read_b64_tr_b16 v[176:177], v244 offset:2048
    ds_read_b64_tr_b16 v[178:179], v244 offset:3072
    ds_read_b64_tr_b16 v[184:185], v245 offset:2048
    ds_read_b64_tr_b16 v[186:187], v245 offset:3072
    v_mul_f32_dpp v196, v243, v74 row_newbcast:4 row_mask:0xf bank_mask:0xf
    v_mul_f32_dpp v197, v243, v75 row_newbcast:5 row_mask:0xf bank_mask:0xf
    v_mul_f32_dpp v198, v243, v74 row_newbcast:12 row_mask:0xf bank_mask:0xf
    v_mul_f32_dpp v199, v243, v75 row_newbcast:13 row_mask:0xf bank_mask:0xf
    v_mul_f32_dpp v200, v243, v78 row_newbcast:6 row_mask:0xf bank_mask:0xf
    v_mul_f32_dpp v201, v243, v79 row_newbcast:7 row_mask:0xf bank_mask:0xf
    v_mul_f32_dpp v202, v243, v78 row_newbcast:14 row_mask:0xf bank_mask:0xf
    v_mul_f32_dpp v203, v243, v79 row_newbcast:15 row_mask:0xf bank_mask:0xf
    v_cvt_pk_bf16_f32 v74, v196, v197
    v_cvt_pk_bf16_f32 v78, v198, v199
    v_cvt_pk_bf16_f32 v75, v200, v201
    v_cvt_pk_bf16_f32 v79, v202, v203
    s_mov_b64 exec, s[54:55]
    ds_read_u16_d16_hi v243, v250 offset:384
    s_mov_b64 exec, -1
    s_waitcnt vmcnt(4) lgkmcnt(1)
    v_mfma_f32_32x32x16_bf16 v[0:15], v[72:75], v[176:179], v[0:15]
    v_mul_f32_dpp v196, v242, v80 row_newbcast:0 row_mask:0xf bank_mask:0xf
    v_mul_f32_dpp v197, v242, v81 row_newbcast:1 row_mask:0xf bank_mask:0xf
    v_mul_f32_dpp v198, v242, v80 row_newbcast:8 row_mask:0xf bank_mask:0xf
    v_mul_f32_dpp v199, v242, v81 row_newbcast:9 row_mask:0xf bank_mask:0xf
    v_mul_f32_dpp v200, v242, v84 row_newbcast:2 row_mask:0xf bank_mask:0xf
    v_mul_f32_dpp v201, v242, v85 row_newbcast:3 row_mask:0xf bank_mask:0xf
    v_mul_f32_dpp v202, v242, v84 row_newbcast:10 row_mask:0xf bank_mask:0xf
    v_mul_f32_dpp v203, v242, v85 row_newbcast:11 row_mask:0xf bank_mask:0xf
    v_cvt_pk_bf16_f32 v80, v196, v197
    v_cvt_pk_bf16_f32 v84, v198, v199
    v_cvt_pk_bf16_f32 v81, v200, v201
    v_cvt_pk_bf16_f32 v85, v202, v203
    s_add_u32 m0, s21, 2048
    v_mfma_f32_32x32x16_bf16 v[16:31], v[76:79], v[176:179], v[16:31]
    buffer_load_dwordx4 v236, s[4:7], s35 offen lds
    buffer_load_dwordx4 v237, s[8:11], s35 offen offset:1024 lds
    ds_read_b64_tr_b16 v[176:177], v244 offset:4096
    ds_read_b64_tr_b16 v[178:179], v244 offset:5120
    ds_read_b64_tr_b16 v[188:189], v245 offset:4096
    ds_read_b64_tr_b16 v[190:191], v245 offset:5120
    v_mul_f32_dpp v196, v242, v82 row_newbcast:4 row_mask:0xf bank_mask:0xf
    v_mul_f32_dpp v197, v242, v83 row_newbcast:5 row_mask:0xf bank_mask:0xf
    v_mul_f32_dpp v198, v242, v82 row_newbcast:12 row_mask:0xf bank_mask:0xf
    v_mul_f32_dpp v199, v242, v83 row_newbcast:13 row_mask:0xf bank_mask:0xf
    v_mul_f32_dpp v200, v242, v86 row_newbcast:6 row_mask:0xf bank_mask:0xf
    v_mul_f32_dpp v201, v242, v87 row_newbcast:7 row_mask:0xf bank_mask:0xf
    v_mul_f32_dpp v202, v242, v86 row_newbcast:14 row_mask:0xf bank_mask:0xf
    v_mul_f32_dpp v203, v242, v87 row_newbcast:15 row_mask:0xf bank_mask:0xf
    v_cvt_pk_bf16_f32 v82, v196, v197
    v_cvt_pk_bf16_f32 v86, v198, v199
    v_cvt_pk_bf16_f32 v83, v200, v201
    v_cvt_pk_bf16_f32 v87, v202, v203
    s_nop 0
    s_waitcnt vmcnt(4) lgkmcnt(0)
    v_mfma_f32_32x32x16_bf16 v[0:15], v[80:83], v[176:179], v[0:15]
    v_mul_f32_dpp v196, v243, v88 row_newbcast:0 row_mask:0xf bank_mask:0xf
    v_mul_f32_dpp v197, v243, v89 row_newbcast:1 row_mask:0xf bank_mask:0xf
    v_mul_f32_dpp v198, v243, v88 row_newbcast:8 row_mask:0xf bank_mask:0xf
    v_mul_f32_dpp v199, v243, v89 row_newbcast:9 row_mask:0xf bank_mask:0xf
    v_mul_f32_dpp v200, v243, v92 row_newbcast:2 row_mask:0xf bank_mask:0xf
    v_mul_f32_dpp v201, v243, v93 row_newbcast:3 row_mask:0xf bank_mask:0xf
    v_mul_f32_dpp v202, v243, v92 row_newbcast:10 row_mask:0xf bank_mask:0xf
    v_mul_f32_dpp v203, v243, v93 row_newbcast:11 row_mask:0xf bank_mask:0xf
    v_cvt_pk_bf16_f32 v88, v196, v197
    v_cvt_pk_bf16_f32 v92, v198, v199
    v_cvt_pk_bf16_f32 v89, v200, v201
    v_cvt_pk_bf16_f32 v93, v202, v203
    s_add_u32 m0, s21, 4096
    v_mfma_f32_32x32x16_bf16 v[16:31], v[84:87], v[176:179], v[16:31]
    buffer_load_dwordx4 v238, s[4:7], s35 offen lds
    buffer_load_dwordx4 v239, s[8:11], s35 offen offset:1024 lds
    ds_read_b64_tr_b16 v[176:177], v244 offset:6144
    ds_read_b64_tr_b16 v[178:179], v244 offset:7168
    ds_read_b64_tr_b16 v[192:193], v245 offset:6144
    ds_read_b64_tr_b16 v[194:195], v245 offset:7168
    v_mul_f32_dpp v196, v243, v90 row_newbcast:4 row_mask:0xf bank_mask:0xf
    v_mul_f32_dpp v197, v243, v91 row_newbcast:5 row_mask:0xf bank_mask:0xf
    v_mul_f32_dpp v198, v243, v90 row_newbcast:12 row_mask:0xf bank_mask:0xf
    v_mul_f32_dpp v199, v243, v91 row_newbcast:13 row_mask:0xf bank_mask:0xf
    v_mul_f32_dpp v200, v243, v94 row_newbcast:6 row_mask:0xf bank_mask:0xf
    v_mul_f32_dpp v201, v243, v95 row_newbcast:7 row_mask:0xf bank_mask:0xf
    v_mul_f32_dpp v202, v243, v94 row_newbcast:14 row_mask:0xf bank_mask:0xf
    v_mul_f32_dpp v203, v243, v95 row_newbcast:15 row_mask:0xf bank_mask:0xf
    v_cvt_pk_bf16_f32 v90, v196, v197
    v_cvt_pk_bf16_f32 v94, v198, v199
    v_cvt_pk_bf16_f32 v91, v200, v201
    v_cvt_pk_bf16_f32 v95, v202, v203
    s_nop 0
    s_waitcnt lgkmcnt(0)
    v_mfma_f32_32x32x16_bf16 v[0:15], v[88:91], v[176:179], v[0:15]
    s_add_u32 m0, s21, 6144
    v_mfma_f32_32x32x16_bf16 v[16:31], v[92:95], v[176:179], v[16:31]
    buffer_load_dwordx4 v240, s[4:7], s35 offen lds
    buffer_load_dwordx4 v241, s[8:11], s35 offen offset:1024 lds
    s_mov_b32 m0, s50
    s_nop 0
    s_movrels_b32 s71, s23
    s_movrels_b32 s33, s28
    s_and_b32 s70, s33, 0x70
    s_andn2_b32 s33, s33, 0x70
    v_xor_b32 v253, s70, v248
    v_add_u32 v253, s33, v253
    s_bfe_u32 s46, s71, 0x30012
    s_mov_b32 m0, s46
    s_and_b32 s66, s71, 0x3ffff
    s_movrels_b32 s68, s57
    s_movrels_b32 s69, s61
    s_sub_u32 s48, s66, s47
    s_mov_b32 s47, s66
    s_lshr_b32 s52, s71, 28
    s_lshl_b32 s67, s46, 9
    s_add_u32 s66, s66, s67
    s_sub_u32 s49, s66, s42
    s_mov_b32 s42, s66
    s_bfe_u32 s66, s68, 655360
    s_add_u32 s43, s42, s66
    s_bfe_u32 s39, s69, 655360
    s_bfe_u32 s66, s68, 655370
    s_add_u32 s44, s42, s66
    s_bfe_u32 s40, s69, 655370
    s_bfe_u32 s66, s68, 655380
    s_add_u32 s45, s42, s66
    s_bfe_u32 s41, s69, 655380
    v_mfma_f32_32x32x16_bf16 v[32:47], v[64:67], v[180:183], 0
    v_mul_f32 v196, v0, v96
    v_fmac_f32 v196, v1, v97
    v_fmac_f32 v196, v2, v98
    v_fmac_f32 v196, v3, v99
    v_fmac_f32 v196, v4, v100
    v_mfma_f32_32x32x16_bf16 v[48:63], v[68:71], v[180:183], 0
    v_fmac_f32 v196, v5, v101
    v_fmac_f32 v196, v6, v102
    v_fmac_f32 v196, v7, v103
    v_mul_f32 v198, v8, v128
    v_fmac_f32 v198, v9, v129
    v_mfma_f32_32x32x16_bf16 v[32:47], v[72:75], v[184:187], v[32:47]
    v_fmac_f32 v198, v10, v130
    v_fmac_f32 v198, v11, v131
    v_fmac_f32 v198, v12, v132
    v_fmac_f32 v198, v13, v133
    v_mfma_f32_32x32x16_bf16 v[48:63], v[76:79], v[184:187], v[48:63]
    v_fmac_f32 v198, v14, v134
    v_fmac_f32 v198, v15, v135
    v_mul_f32 v200, v16, v128
    v_fmac_f32 v200, v17, v129
    v_permlane32_swap_b32 v196, v198
    v_mfma_f32_32x32x16_bf16 v[32:47], v[80:83], v[188:191], v[32:47]
    v_fmac_f32 v200, v18, v130
    v_fmac_f32 v200, v19, v131
    v_fmac_f32 v200, v20, v132
    v_fmac_f32 v200, v21, v133
    v_fmac_f32 v200, v22, v134
    v_mfma_f32_32x32x16_bf16 v[48:63], v[84:87], v[188:191], v[48:63]
    s_waitcnt vmcnt(6)
    ds_read_b64_tr_b16 v[176:177], v244 offset:0
    ds_read_b64_tr_b16 v[178:179], v244 offset:1024
    ds_read_b64_tr_b16 v[180:181], v245 offset:0
    ds_read_b64_tr_b16 v[182:183], v245 offset:1024
    v_fmac_f32 v200, v23, v135
    v_add_f32 v198, v196, v198
    v_mul_f32_e64 v202, v24, -v128
    v_fma_f32 v202, v25, -v129, v202
    v_mfma_f32_32x32x16_bf16 v[32:47], v[88:91], v[192:195], v[32:47]
    v_fma_f32 v202, v26, -v130, v202
    v_fma_f32 v202, v27, -v131, v202
    v_fma_f32 v202, v28, -v132, v202
    v_fma_f32 v202, v29, -v133, v202
    v_fma_f32 v202, v30, -v134, v202
    v_mfma_f32_32x32x16_bf16 v[48:63], v[92:95], v[192:195], v[48:63]
    v_fma_f32 v202, v31, -v135, v202
    s_nop 1
    v_permlane32_swap_b32 v200, v202
    v_add_f32 v202, v200, v202
    s_waitcnt vmcnt(4) lgkmcnt(0)
    v_mfma_f32_32x32x16_bf16 v[0:15], v[64:67], v[176:179], 0
    v_mul_f32 v197, v32, v104
    v_fmac_f32 v197, v33, v105
    v_fmac_f32 v197, v34, v106
    v_fmac_f32 v197, v35, v107
    v_fmac_f32 v197, v36, v108
    s_add_u32 m0, s21, 0
    v_mfma_f32_32x32x16_bf16 v[16:31], v[68:71], v[176:179], 0
    buffer_load_dwordx4 v234, s[4:7], s36 offen lds
    buffer_load_dwordx4 v235, s[8:11], s36 offen offset:1024 lds
    ds_read_b64_tr_b16 v[176:177], v244 offset:2048
    ds_read_b64_tr_b16 v[178:179], v244 offset:3072
    ds_read_b64_tr_b16 v[184:185], v245 offset:2048
    ds_read_b64_tr_b16 v[186:187], v245 offset:3072
    v_fmac_f32 v197, v37, v109
    v_fmac_f32 v197, v38, v110
    v_fmac_f32 v197, v39, v111
    v_mul_f32 v199, v40, v136
    v_fmac_f32 v199, v41, v137
    s_waitcnt vmcnt(4) lgkmcnt(0)
    v_mfma_f32_32x32x16_bf16 v[0:15], v[72:75], v[176:179], v[0:15]
    v_fmac_f32 v199, v42, v138
    v_fmac_f32 v199, v43, v139
    v_fmac_f32 v199, v44, v140
    v_fmac_f32 v199, v45, v141
    v_fmac_f32 v199, v46, v142
    s_add_u32 m0, s21, 2048
    v_mfma_f32_32x32x16_bf16 v[16:31], v[76:79], v[176:179], v[16:31]
    buffer_load_dwordx4 v236, s[4:7], s36 offen lds
    buffer_load_dwordx4 v237, s[8:11], s36 offen offset:1024 lds
    ds_read_b64_tr_b16 v[176:177], v244 offset:4096
    ds_read_b64_tr_b16 v[178:179], v244 offset:5120
    ds_read_b64_tr_b16 v[188:189], v245 offset:4096
    ds_read_b64_tr_b16 v[190:191], v245 offset:5120
    v_fmac_f32 v199, v47, v143
    v_mul_f32 v201, v48, v136
    v_fmac_f32 v201, v49, v137
    v_permlane32_swap_b32 v197, v199
    v_fmac_f32 v201, v50, v138
    s_waitcnt vmcnt(4) lgkmcnt(0)
    v_mfma_f32_32x32x16_bf16 v[0:15], v[80:83], v[176:179], v[0:15]
    v_fmac_f32 v201, v51, v139
    v_fmac_f32 v201, v52, v140
    v_fmac_f32 v201, v53, v141
    v_fmac_f32 v201, v54, v142
    v_fmac_f32 v201, v55, v143
    s_add_u32 m0, s21, 4096
    v_mfma_f32_32x32x16_bf16 v[16:31], v[84:87], v[176:179], v[16:31]
    buffer_load_dwordx4 v238, s[4:7], s36 offen lds
    buffer_load_dwordx4 v239, s[8:11], s36 offen offset:1024 lds
    ds_read_b64_tr_b16 v[176:177], v244 offset:6144
    ds_read_b64_tr_b16 v[178:179], v244 offset:7168
    ds_read_b64_tr_b16 v[192:193], v245 offset:6144
    ds_read_b64_tr_b16 v[194:195], v245 offset:7168
    v_add_f32 v199, v197, v199
    v_mul_f32_e64 v203, v56, -v136
    v_fma_f32 v203, v57, -v137, v203
    v_fma_f32 v203, v58, -v138, v203
    v_fma_f32 v203, v59, -v139, v203
    s_waitcnt lgkmcnt(0)
    v_mfma_f32_32x32x16_bf16 v[0:15], v[88:91], v[176:179], v[0:15]
    v_fma_f32 v203, v60, -v140, v203
    v_fma_f32 v203, v61, -v141, v203
    v_fma_f32 v203, v62, -v142, v203
    v_fma_f32 v203, v63, -v143, v203
    s_nop 1
    s_add_u32 m0, s21, 6144
    v_mfma_f32_32x32x16_bf16 v[16:31], v[92:95], v[176:179], v[16:31]
    buffer_load_dwordx4 v240, s[4:7], s36 offen lds
    buffer_load_dwordx4 v241, s[8:11], s36 offen offset:1024 lds
    v_permlane32_swap_b32 v201, v203
    v_add_f32 v203, v201, v203
    v_cvt_pk_bf16_f32 v198, v198, v199
    v_cvt_pk_bf16_f32 v202, v202, v203
    ds_write2st64_b32 v253, v198, v202 offset0:0 offset1:1
    v_mfma_f32_32x32x16_bf16 v[32:47], v[64:67], v[180:183], 0
    v_mul_f32 v196, v0, v144
    v_fmac_f32 v196, v1, v145
    v_fmac_f32 v196, v2, v146
    v_fmac_f32 v196, v3, v147
    v_mfma_f32_32x32x16_bf16 v[48:63], v[68:71], v[180:183], 0
    v_fmac_f32 v196, v4, v148
    v_fmac_f32 v196, v5, v149
    v_fmac_f32 v196, v6, v150
    v_fmac_f32 v196, v7, v151
    v_mfma_f32_32x32x16_bf16 v[32:47], v[72:75], v[184:187], v[32:47]
    v_mul_f32 v198, v8, v112
    v_fmac_f32 v198, v9, v113
    v_fmac_f32 v198, v10, v114
    v_fmac_f32 v198, v11, v115
    v_mfma_f32_32x32x16_bf16 v[48:63], v[76:79], v[184:187], v[48:63]
    v_fmac_f32 v198, v12, v116
    v_fmac_f32 v198, v13, v117
    v_fmac_f32 v198, v14, v118
    v_fmac_f32 v198, v15, v119
    v_mfma_f32_32x32x16_bf16 v[32:47], v[80:83], v[188:191], v[32:47]
    v_mul_f32_e64 v200, v16, -v160
    v_fma_f32 v200, v17, -v161, v200
    v_fma_f32 v200, v18, -v162, v200
    v_fma_f32 v200, v19, -v163, v200
    v_mfma_f32_32x32x16_bf16 v[48:63], v[84:87], v[188:191], v[48:63]
    s_waitcnt vmcnt(6)
    ds_read_b64_tr_b16 v[176:177], v244 offset:0
    ds_read_b64_tr_b16 v[178:179], v244 offset:1024
    ds_read_b64_tr_b16 v[180:181], v245 offset:0
    ds_read_b64_tr_b16 v[182:183], v245 offset:1024
    v_fma_f32 v200, v20, -v164, v200
    v_fma_f32 v200, v21, -v165, v200
    v_fma_f32 v200, v22, -v166, v200
    v_fma_f32 v200, v23, -v167, v200
    v_mfma_f32_32x32x16_bf16 v[32:47], v[88:91], v[192:195], v[32:47]
    v_mul_f32_e64 v202, v24, -v160
    v_fma_f32 v202, v25, -v161, v202
    v_fma_f32 v202, v26, -v162, v202
    v_fma_f32 v202, v27, -v163, v202
    v_mfma_f32_32x32x16_bf16 v[48:63], v[92:95], v[192:195], v[48:63]
    v_fma_f32 v202, v28, -v164, v202
    v_fma_f32 v202, v29, -v165, v202
    v_fma_f32 v202, v30, -v166, v202
    v_fma_f32 v202, v31, -v167, v202
    s_waitcnt vmcnt(4) lgkmcnt(0)
    v_mfma_f32_32x32x16_bf16 v[0:15], v[64:67], v[176:179], 0
    s_nop 0
    v_mul_f32 v197, v32, v152
    v_fmac_f32 v197, v33, v153
    v_fmac_f32 v197, v34, v154
    v_fmac_f32 v197, v35, v155
    s_add_u32 m0, s21, 0
    v_mfma_f32_32x32x16_bf16 v[16:31], v[68:71], v[176:179], 0
    buffer_load_dwordx4 v234, s[4:7], s37 offen lds
    buffer_load_dwordx4 v235, s[8:11], s37 offen offset:1024 lds
    ds_read_b64_tr_b16 v[176:177], v244 offset:2048
    ds_read_b64_tr_b16 v[178:179], v244 offset:3072
    ds_read_b64_tr_b16 v[184:185], v245 offset:2048
    ds_read_b64_tr_b16 v[186:187], v245 offset:3072
    v_add_u32 v252, s42, v247
    ds_read_u16 v234, v252
    ds_read_u16 v235, v252 offset:64
    v_fmac_f32 v197, v36, v156
    v_fmac_f32 v197, v37, v157
    v_fmac_f32 v197, v38, v158
    v_fmac_f32 v197, v39, v159
    s_waitcnt vmcnt(4) lgkmcnt(2)
    v_mfma_f32_32x32x16_bf16 v[0:15], v[72:75], v[176:179], v[0:15]
    v_mul_f32 v199, v40, v120
    v_fmac_f32 v199, v41, v121
    v_fmac_f32 v199, v42, v122
    v_fmac_f32 v199, v43, v123
    s_add_u32 m0, s21, 2048
    v_mfma_f32_32x32x16_bf16 v[16:31], v[76:79], v[176:179], v[16:31]
    buffer_load_dwordx4 v236, s[4:7], s37 offen lds
    buffer_load_dwordx4 v237, s[8:11], s37 offen offset:1024 lds
    ds_read_b64_tr_b16 v[176:177], v244 offset:4096
    ds_read_b64_tr_b16 v[178:179], v244 offset:5120
    ds_read_b64_tr_b16 v[188:189], v245 offset:4096
    ds_read_b64_tr_b16 v[190:191], v245 offset:5120
    v_add_u32 v252, s43, v247
    ds_read_u16 v236, v252
    ds_read_u16 v237, v252 offset:64
    v_fmac_f32 v199, v44, v124
    v_fmac_f32 v199, v45, v125
    v_fmac_f32 v199, v46, v126
    v_fmac_f32 v199, v47, v127
    s_waitcnt vmcnt(4) lgkmcnt(2)
    v_mfma_f32_32x32x16_bf16 v[0:15], v[80:83], v[176:179], v[0:15]
    v_mul_f32_e64 v201, v48, -v168
    v_fma_f32 v201, v49, -v169, v201
    v_fma_f32 v201, v50, -v170, v201
    v_fma_f32 v201, v51, -v171, v201
    s_add_u32 m0, s21, 4096
    v_mfma_f32_32x32x16_bf16 v[16:31], v[84:87], v[176:179], v[16:31]
    buffer_load_dwordx4 v238, s[4:7], s37 offen lds
    buffer_load_dwordx4 v239, s[8:11], s37 offen offset:1024 lds
    ds_read_b64_tr_b16 v[176:177], v244 offset:6144
    ds_read_b64_tr_b16 v[178:179], v244 offset:7168
    ds_read_b64_tr_b16 v[192:193], v245 offset:6144
    ds_read_b64_tr_b16 v[194:195], v245 offset:7168
    v_add_u32 v252, s44, v247
    ds_read_u16 v238, v252
    ds_read_u16 v239, v252 offset:64
    v_fma_f32 v201, v52, -v172, v201
    v_fma_f32 v201, v53, -v173, v201
    v_fma_f32 v201, v54, -v174, v201
    v_fma_f32 v201, v55, -v175, v201
    s_waitcnt lgkmcnt(2)
    v_mfma_f32_32x32x16_bf16 v[0:15], v[88:91], v[176:179], v[0:15]
    v_mul_f32_e64 v203, v56, -v168
    v_fma_f32 v203, v57, -v169, v203
    v_fma_f32 v203, v58, -v170, v203
    v_fma_f32 v203, v59, -v171, v203
    s_add_u32 m0, s21, 6144
    v_mfma_f32_32x32x16_bf16 v[16:31], v[92:95], v[176:179], v[16:31]
    buffer_load_dwordx4 v240, s[4:7], s37 offen lds
    buffer_load_dwordx4 v241, s[8:11], s37 offen offset:1024 lds
    v_add_u32 v252, s45, v247
    ds_read_u16 v240, v252
    ds_read_u16 v241, v252 offset:64
    v_fma_f32 v203, v60, -v172, v203
    v_fma_f32 v203, v61, -v173, v203
    v_fma_f32 v203, v62, -v174, v203
    v_fma_f32 v203, v63, -v175, v203
    v_mfma_f32_32x32x16_bf16 v[32:47], v[64:67], v[180:183], 0
    v_mul_f32 v254, v0, v144
    v_fmac_f32 v254, v1, v145
    v_fmac_f32 v254, v2, v146
    v_mfma_f32_32x32x16_bf16 v[48:63], v[68:71], v[180:183], 0
    ds_swizzle_b32 v68, v68 offset:0x401F
    ds_swizzle_b32 v69, v69 offset:0x401F
    ds_swizzle_b32 v70, v70 offset:0x401F
    ds_swizzle_b32 v71, v71 offset:0x401F
    v_fmac_f32 v254, v3, v147
    v_fmac_f32 v254, v4, v148
    v_mfma_f32_32x32x16_bf16 v[32:47], v[72:75], v[184:187], v[32:47]
    v_fmac_f32 v254, v5, v149
    v_fmac_f32 v254, v6, v150
    v_mfma_f32_32x32x16_bf16 v[48:63], v[76:79], v[184:187], v[48:63]
    ds_swizzle_b32 v76, v76 offset:0x401F
    ds_swizzle_b32 v77, v77 offset:0x401F
    ds_swizzle_b32 v78, v78 offset:0x401F
    ds_swizzle_b32 v79, v79 offset:0x401F
    v_fmac_f32 v254, v7, v151
    v_fmac_f32 v200, v8, v160
    v_mfma_f32_32x32x16_bf16 v[32:47], v[80:83], v[188:191], v[32:47]
    v_fmac_f32 v200, v9, v161
    v_permlane32_swap_b32 v196, v254
    v_fmac_f32 v200, v10, v162
    v_mfma_f32_32x32x16_bf16 v[48:63], v[84:87], v[188:191], v[48:63]
    ds_swizzle_b32 v84, v84 offset:0x401F
    ds_swizzle_b32 v85, v85 offset:0x401F
    ds_swizzle_b32 v86, v86 offset:0x401F
    ds_swizzle_b32 v87, v87 offset:0x401F
    s_waitcnt vmcnt(6)
    ds_read_b64_tr_b16 v[176:177], v244 offset:0
    ds_read_b64_tr_b16 v[178:179], v244 offset:1024
    ds_read_b64_tr_b16 v[180:181], v245 offset:0
    ds_read_b64_tr_b16 v[182:183], v245 offset:1024
    v_fmac_f32 v200, v11, v163
    v_fmac_f32 v200, v12, v164
    v_mfma_f32_32x32x16_bf16 v[32:47], v[88:91], v[192:195], v[32:47]
    v_fmac_f32 v200, v13, v165
    v_fmac_f32 v200, v14, v166
    v_mfma_f32_32x32x16_bf16 v[48:63], v[92:95], v[192:195], v[48:63]
    ds_swizzle_b32 v92, v92 offset:0x401F
    ds_swizzle_b32 v93, v93 offset:0x401F
    ds_swizzle_b32 v94, v94 offset:0x401F
    ds_swizzle_b32 v95, v95 offset:0x401F
    v_fmac_f32 v200, v15, v167
    v_add_f32 v254, v196, v254
    s_waitcnt lgkmcnt(8)
    s_mov_b64 exec, s[56:57]
    v_xor_b32 v68, 0x80008000, v68
    v_xor_b32 v69, 0x80008000, v69
    v_xor_b32 v70, 0x80008000, v70
    v_xor_b32 v71, 0x80008000, v71
    v_xor_b32 v76, 0x80008000, v76
    v_xor_b32 v77, 0x80008000, v77
    v_xor_b32 v78, 0x80008000, v78
    v_xor_b32 v79, 0x80008000, v79
    v_xor_b32 v84, 0x80008000, v84
    v_xor_b32 v85, 0x80008000, v85
    v_xor_b32 v86, 0x80008000, v86
    v_xor_b32 v87, 0x80008000, v87
    s_mov_b64 exec, -1
    s_waitcnt vmcnt(4) lgkmcnt(4)
    v_mfma_f32_32x32x16_bf16 v[0:15], v[64:67], v[176:179], 0
    v_mul_f32 v255, v32, v152
    v_fmac_f32 v255, v33, v153
    v_fmac_f32 v255, v34, v154
    s_add_u32 m0, s21, 0
    v_mfma_f32_32x32x16_bf16 v[16:31], v[68:71], v[176:179], v[16:31]
    v_lshl_add_u32 v234, v234, 10, v246
    v_lshl_add_u32 v235, v235, 10, v246
    buffer_load_dwordx4 v234, s[4:7], s38 offen lds
    buffer_load_dwordx4 v235, s[8:11], s38 offen offset:1024 lds
    ds_read_b64_tr_b16 v[176:177], v244 offset:2048
    ds_read_b64_tr_b16 v[178:179], v244 offset:3072
    ds_read_b64_tr_b16 v[184:185], v245 offset:2048
    ds_read_b64_tr_b16 v[186:187], v245 offset:3072
    v_fmac_f32 v255, v35, v155
    v_fmac_f32 v255, v36, v156
    s_waitcnt vmcnt(4) lgkmcnt(0)
    v_mfma_f32_32x32x16_bf16 v[0:15], v[72:75], v[176:179], v[0:15]
    v_fmac_f32 v255, v37, v157
    v_fmac_f32 v255, v38, v158
    v_fmac_f32 v255, v39, v159
    s_add_u32 m0, s21, 2048
    v_mfma_f32_32x32x16_bf16 v[16:31], v[76:79], v[176:179], v[16:31]
    v_lshl_add_u32 v236, v236, 10, v246
    v_lshl_add_u32 v237, v237, 10, v246
    buffer_load_dwordx4 v236, s[4:7], s39 offen lds
    buffer_load_dwordx4 v237, s[8:11], s39 offen offset:1024 lds
    ds_read_b64_tr_b16 v[176:177], v244 offset:4096
    ds_read_b64_tr_b16 v[178:179], v244 offset:5120
    ds_read_b64_tr_b16 v[188:189], v245 offset:4096
    ds_read_b64_tr_b16 v[190:191], v245 offset:5120
    v_fmac_f32 v201, v40, v168
    v_fmac_f32 v201, v41, v169
    s_waitcnt vmcnt(4) lgkmcnt(0)
    v_mfma_f32_32x32x16_bf16 v[0:15], v[80:83], v[176:179], v[0:15]
    v_permlane32_swap_b32 v197, v255
    v_fmac_f32 v201, v42, v170
    v_fmac_f32 v201, v43, v171
    s_add_u32 m0, s21, 4096
    v_mfma_f32_32x32x16_bf16 v[16:31], v[84:87], v[176:179], v[16:31]
    v_lshl_add_u32 v238, v238, 10, v246
    v_lshl_add_u32 v239, v239, 10, v246
    buffer_load_dwordx4 v238, s[4:7], s40 offen lds
    buffer_load_dwordx4 v239, s[8:11], s40 offen offset:1024 lds
    ds_read_b64_tr_b16 v[176:177], v244 offset:6144
    ds_read_b64_tr_b16 v[178:179], v244 offset:7168
    ds_read_b64_tr_b16 v[192:193], v245 offset:6144
    ds_read_b64_tr_b16 v[194:195], v245 offset:7168
    v_fmac_f32 v201, v44, v172
    v_fmac_f32 v201, v45, v173
    s_waitcnt lgkmcnt(0)
    s_mov_b64 exec, s[56:57]
    v_xor_b32 v92, 0x80008000, v92
    v_xor_b32 v93, 0x80008000, v93
    v_xor_b32 v94, 0x80008000, v94
    v_xor_b32 v95, 0x80008000, v95
    s_mov_b64 exec, -1
    v_mfma_f32_32x32x16_bf16 v[0:15], v[88:91], v[176:179], v[0:15]
    v_fmac_f32 v201, v46, v174
    v_fmac_f32 v201, v47, v175
    v_add_f32 v255, v197, v255
    s_add_u32 m0, s21, 6144
    v_mfma_f32_32x32x16_bf16 v[16:31], v[92:95], v[176:179], v[16:31]
    v_lshl_add_u32 v240, v240, 10, v246
    v_lshl_add_u32 v241, v241, 10, v246
    buffer_load_dwordx4 v240, s[4:7], s41 offen lds
    buffer_load_dwordx4 v241, s[8:11], s41 offen offset:1024 lds
    v_cvt_pk_bf16_f32 v254, v254, v255
    ds_write_b32 v253, v254 offset:512
    v_mfma_f32_32x32x16_bf16 v[32:47], v[64:67], v[180:183], 0
    v_mul_f32 v254, v0, v144
    v_fmac_f32 v254, v1, v145
    v_fmac_f32 v254, v2, v146
    v_fmac_f32 v254, v3, v147
    v_fmac_f32 v254, v4, v148
    v_mfma_f32_32x32x16_bf16 v[48:63], v[68:71], v[180:183], v[48:63]
    v_fmac_f32 v254, v5, v149
    v_fmac_f32 v254, v6, v150
    v_fmac_f32 v254, v7, v151
    v_fma_f32 v202, v8, -v160, v202
    v_fma_f32 v202, v9, -v161, v202
    v_mfma_f32_32x32x16_bf16 v[32:47], v[72:75], v[184:187], v[32:47]
    v_permlane32_swap_b32 v254, v200
    v_fma_f32 v202, v10, -v162, v202
    v_fma_f32 v202, v11, -v163, v202
    v_fma_f32 v202, v12, -v164, v202
    v_fma_f32 v202, v13, -v165, v202
    v_mfma_f32_32x32x16_bf16 v[48:63], v[76:79], v[184:187], v[48:63]
    v_fma_f32 v202, v14, -v166, v202
    v_fma_f32 v202, v15, -v167, v202
    v_add_f32 v200, v254, v200
    v_fmac_f32 v198, v16, v112
    v_permlane32_swap_b32 v202, v254
    v_mfma_f32_32x32x16_bf16 v[32:47], v[80:83], v[188:191], v[32:47]
    v_fmac_f32 v198, v17, v113
    v_fmac_f32 v198, v18, v114
    v_fmac_f32 v198, v19, v115
    v_fmac_f32 v198, v20, v116
    v_fmac_f32 v198, v21, v117
    v_mfma_f32_32x32x16_bf16 v[48:63], v[84:87], v[188:191], v[48:63]
    s_waitcnt vmcnt(6)
    ds_read_b64_tr_b16 v[176:177], v244 offset:0
    ds_read_b64_tr_b16 v[178:179], v244 offset:1024
    ds_read_b64_tr_b16 v[180:181], v245 offset:0
    ds_read_b64_tr_b16 v[182:183], v245 offset:1024
    v_fmac_f32 v198, v22, v118
    v_fmac_f32 v198, v23, v119
    v_add_f32 v254, v202, v254
    v_mul_f32 v196, v24, v160
    v_fmac_f32 v196, v25, v161
    v_mfma_f32_32x32x16_bf16 v[32:47], v[88:91], v[192:195], v[32:47]
    v_fmac_f32 v196, v26, v162
    v_fmac_f32 v196, v27, v163
    v_fmac_f32 v196, v28, v164
    v_fmac_f32 v196, v29, v165
    v_fmac_f32 v196, v30, v166
    v_mfma_f32_32x32x16_bf16 v[48:63], v[92:95], v[192:195], v[48:63]
    v_add_u32 v249, s48, v249
    v_add_u32 v250, s49, v250
    ds_read_b32 v252, v251 offset:16
    ds_read_b64_tr_b16 v[64:65], v249 offset:0
    ds_read_b64_tr_b16 v[68:69], v249 offset:64
    ds_read_b64_tr_b16 v[66:67], v249 offset:256
    ds_read_b64_tr_b16 v[70:71], v249 offset:320
    s_mov_b64 exec, s[54:55]
    ds_read_u16_d16_hi v242, v250 offset:0
    s_mov_b64 exec, -1
    v_fmac_f32 v196, v31, v167
    s_nop 1
    v_permlane32_swap_b32 v198, v196
    v_add_f32 v196, v198, v196
    v_mul_f32 v255, v32, v152
    v_fmac_f32 v255, v33, v153
    v_fmac_f32 v255, v34, v154
    v_fmac_f32 v255, v35, v155
    v_fmac_f32 v255, v36, v156
    v_fmac_f32 v255, v37, v157
    v_fmac_f32 v255, v38, v158
    v_fmac_f32 v255, v39, v159
    v_fma_f32 v203, v40, -v168, v203
    v_fma_f32 v203, v41, -v169, v203
    v_permlane32_swap_b32 v255, v201
    v_fma_f32 v203, v42, -v170, v203
    v_fma_f32 v203, v43, -v171, v203
    v_fma_f32 v203, v44, -v172, v203
    v_fma_f32 v203, v45, -v173, v203
    v_fma_f32 v203, v46, -v174, v203
    v_fma_f32 v203, v47, -v175, v203
    v_add_f32 v201, v255, v201
    v_fmac_f32 v199, v48, v120
    v_permlane32_swap_b32 v203, v255
    v_fmac_f32 v199, v49, v121
    v_fmac_f32 v199, v50, v122
    v_fmac_f32 v199, v51, v123
    v_fmac_f32 v199, v52, v124
    v_fmac_f32 v199, v53, v125
    v_fmac_f32 v199, v54, v126
    v_fmac_f32 v199, v55, v127
    v_add_f32 v255, v203, v255
    v_mul_f32 v197, v56, v168
    v_fmac_f32 v197, v57, v169
    v_fmac_f32 v197, v58, v170
    v_fmac_f32 v197, v59, v171
    v_fmac_f32 v197, v60, v172
    v_fmac_f32 v197, v61, v173
    v_fmac_f32 v197, v62, v174
    v_fmac_f32 v197, v63, v175
    s_nop 1
    v_permlane32_swap_b32 v199, v197
    v_add_f32 v197, v199, v197
    v_cvt_pk_bf16_f32 v200, v200, v201
    v_cvt_pk_bf16_f32 v254, v254, v255
    v_cvt_pk_bf16_f32 v196, v196, v197
    ds_write2st64_b32 v253, v200, v196 offset0:3 offset1:4
    s_mov_b64 exec, 0xffffffff
    ds_write_b32 v253, v254 offset:1280
    s_mov_b64 exec, -1
    s_add_u32 s50, s50, 1
    s_cmp_ge_u32 s50, 4
    s_cbranch_scc1 LAST1
    s_waitcnt lgkmcnt(7)
    v_readfirstlane_b32 s66, v252
    s_add_u32 s53, s53, 1
    v_mov_b32 v252, s53
    s_cmp_le_u32 s53, s66
    ds_write2_b32 v251, v252, v252 offset0:0 offset1:8
    s_setprio 1
    s_cbranch_scc1 PRIO_15
    s_setprio 0
PRIO_15:
    s_cmp_eq_u32 s52, 4
    s_cbranch_scc1 ITEM_1_4
    s_cmp_eq_u32 s52, 5
    s_cbranch_scc1 ITEM_1_5
    s_cmp_eq_u32 s52, 3
    s_cbranch_scc1 ITEM_1_3
    s_cmp_eq_u32 s52, 6
    s_cbranch_scc1 ITEM_1_6
    s_cmp_eq_u32 s52, 8
    s_cbranch_scc1 ITEM_1_8
    s_branch ITEM_1_2
.p2align 6
ITEM_1_2:
    s_mov_b32 m0, s50
    s_nop 0
    s_movrels_b32 s71, s23
    s_movrels_b32 s33, s28
    s_and_b32 s70, s33, 0x70
    s_andn2_b32 s33, s33, 0x70
    v_xor_b32 v253, s70, v248
    v_add_u32 v253, s33, v253
    s_bfe_u32 s46, s71, 0x30012
    s_mov_b32 m0, s46
    s_and_b32 s66, s71, 0x3ffff
    s_movrels_b32 s68, s57
    s_movrels_b32 s69, s61
    s_sub_u32 s48, s66, s47
    s_mov_b32 s47, s66
    s_lshr_b32 s52, s71, 28
    s_lshl_b32 s67, s46, 9
    s_add_u32 s66, s66, s67
    s_sub_u32 s49, s66, s42
    s_mov_b32 s42, s66
    s_bfe_u32 s66, s68, 655360
    s_add_u32 s43, s42, s66
    s_bfe_u32 s39, s69, 655360
    s_bfe_u32 s66, s68, 655370
    s_add_u32 s44, s42, s66
    s_bfe_u32 s40, s69, 655370
    s_bfe_u32 s66, s68, 655380
    s_add_u32 s45, s42, s66
    s_bfe_u32 s41, s69, 655380
    v_add_u32 v252, s42, v247
    ds_read_u16 v234, v252
    ds_read_u16 v235, v252 offset:64
    v_add_u32 v252, s43, v247
    ds_read_u16 v236, v252
    ds_read_u16 v237, v252 offset:64
    v_add_u32 v252, s44, v247
    ds_read_u16 v238, v252
    ds_read_u16 v239, v252 offset:64
    v_add_u32 v252, s45, v247
    ds_read_u16 v240, v252
    ds_read_u16 v241, v252 offset:64
    s_waitcnt lgkmcnt(8)
    v_mul_f32_dpp v196, v242, v64 row_newbcast:0 row_mask:0xf bank_mask:0xf
    v_mul_f32_dpp v197, v242, v65 row_newbcast:1 row_mask:0xf bank_mask:0xf
    v_mul_f32_dpp v198, v242, v64 row_newbcast:8 row_mask:0xf bank_mask:0xf
    v_mul_f32_dpp v199, v242, v65 row_newbcast:9 row_mask:0xf bank_mask:0xf
    v_mul_f32_dpp v200, v242, v68 row_newbcast:2 row_mask:0xf bank_mask:0xf
    v_mul_f32_dpp v201, v242, v69 row_newbcast:3 row_mask:0xf bank_mask:0xf
    v_mul_f32_dpp v202, v242, v68 row_newbcast:10 row_mask:0xf bank_mask:0xf
    v_mul_f32_dpp v203, v242, v69 row_newbcast:11 row_mask:0xf bank_mask:0xf
    v_cvt_pk_bf16_f32 v64, v196, v197
    v_cvt_pk_bf16_f32 v68, v198, v199
    v_cvt_pk_bf16_f32 v65, v200, v201
    v_cvt_pk_bf16_f32 v69, v202, v203
    v_mul_f32_dpp v196, v242, v66 row_newbcast:4 row_mask:0xf bank_mask:0xf
    v_mul_f32_dpp v197, v242, v67 row_newbcast:5 row_mask:0xf bank_mask:0xf
    v_mul_f32_dpp v198, v242, v66 row_newbcast:12 row_mask:0xf bank_mask:0xf
    v_mul_f32_dpp v199, v242, v67 row_newbcast:13 row_mask:0xf bank_mask:0xf
    v_mul_f32_dpp v200, v242, v70 row_newbcast:6 row_mask:0xf bank_mask:0xf
    v_mul_f32_dpp v201, v242, v71 row_newbcast:7 row_mask:0xf bank_mask:0xf
    v_mul_f32_dpp v202, v242, v70 row_newbcast:14 row_mask:0xf bank_mask:0xf
    v_mul_f32_dpp v203, v242, v71 row_newbcast:15 row_mask:0xf bank_mask:0xf
    v_cvt_pk_bf16_f32 v66, v196, v197
    v_cvt_pk_bf16_f32 v70, v198, v199
    v_cvt_pk_bf16_f32 v67, v200, v201
    v_cvt_pk_bf16_f32 v71, v202, v203
    s_nop 0
    s_waitcnt lgkmcnt(6)
    v_mfma_f32_32x32x16_bf16 v[0:15], v[64:67], v[176:179], 0
    s_add_u32 m0, s21, 0
    v_mfma_f32_32x32x16_bf16 v[16:31], v[68:71], v[176:179], 0
    v_lshl_add_u32 v234, v234, 10, v246
    v_lshl_add_u32 v235, v235, 10, v246
    buffer_load_dwordx4 v234, s[4:7], s38 offen lds
    buffer_load_dwordx4 v235, s[8:11], s38 offen offset:1024 lds
    v_mfma_f32_32x32x16_bf16 v[32:47], v[64:67], v[180:183], 0
    s_nop 4
    v_mul_f32 v196, v0, v96
    v_fmac_f32 v196, v1, v97
    v_fmac_f32 v196, v2, v98
    v_fmac_f32 v196, v3, v99
    v_fmac_f32 v196, v4, v100
    v_fmac_f32 v196, v5, v101
    v_fmac_f32 v196, v6, v102
    v_fmac_f32 v196, v7, v103
    v_mul_f32 v198, v8, v128
    v_fmac_f32 v198, v9, v129
    v_fmac_f32 v198, v10, v130
    v_fmac_f32 v198, v11, v131
    v_fmac_f32 v198, v12, v132
    v_fmac_f32 v198, v13, v133
    v_fmac_f32 v198, v14, v134
    v_fmac_f32 v198, v15, v135
    v_mul_f32 v200, v16, v128
    v_fmac_f32 v200, v17, v129
    v_permlane32_swap_b32 v196, v198
    v_mfma_f32_32x32x16_bf16 v[48:63], v[68:71], v[180:183], 0
    s_waitcnt vmcnt(6)
    ds_read_b64_tr_b16 v[176:177], v244 offset:2048
    ds_read_b64_tr_b16 v[178:179], v244 offset:3072
    ds_read_b64_tr_b16 v[180:181], v245 offset:2048
    ds_read_b64_tr_b16 v[182:183], v245 offset:3072
    v_fmac_f32 v200, v18, v130
    v_fmac_f32 v200, v19, v131
    v_fmac_f32 v200, v20, v132
    v_fmac_f32 v200, v21, v133
    v_fmac_f32 v200, v22, v134
    v_fmac_f32 v200, v23, v135
    v_add_f32 v198, v196, v198
    v_mul_f32_e64 v202, v24, -v128
    v_fma_f32 v202, v25, -v129, v202
    v_fma_f32 v202, v26, -v130, v202
    v_fma_f32 v202, v27, -v131, v202
    v_fma_f32 v202, v28, -v132, v202
    v_fma_f32 v202, v29, -v133, v202
    v_fma_f32 v202, v30, -v134, v202
    v_fma_f32 v202, v31, -v135, v202
    s_nop 1
    v_permlane32_swap_b32 v200, v202
    v_add_f32 v202, v200, v202
    s_waitcnt lgkmcnt(0)
    v_mfma_f32_32x32x16_bf16 v[0:15], v[64:67], v[176:179], 0
    v_mul_f32 v197, v32, v104
    v_fmac_f32 v197, v33, v105
    v_fmac_f32 v197, v34, v106
    v_fmac_f32 v197, v35, v107
    v_fmac_f32 v197, v36, v108
    v_fmac_f32 v197, v37, v109
    v_fmac_f32 v197, v38, v110
    v_fmac_f32 v197, v39, v111
    v_mul_f32 v199, v40, v136
    v_fmac_f32 v199, v41, v137
    v_fmac_f32 v199, v42, v138
    v_fmac_f32 v199, v43, v139
    v_fmac_f32 v199, v44, v140
    v_fmac_f32 v199, v45, v141
    v_fmac_f32 v199, v46, v142
    v_fmac_f32 v199, v47, v143
    v_mul_f32 v201, v48, v136
    v_fmac_f32 v201, v49, v137
    v_permlane32_swap_b32 v197, v199
    v_fmac_f32 v201, v50, v138
    s_add_u32 m0, s21, 2048
    v_mfma_f32_32x32x16_bf16 v[16:31], v[68:71], v[176:179], 0
    v_lshl_add_u32 v236, v236, 10, v246
    v_lshl_add_u32 v237, v237, 10, v246
    buffer_load_dwordx4 v236, s[4:7], s39 offen lds
    buffer_load_dwordx4 v237, s[8:11], s39 offen offset:1024 lds
    v_fmac_f32 v201, v51, v139
    v_fmac_f32 v201, v52, v140
    v_fmac_f32 v201, v53, v141
    v_fmac_f32 v201, v54, v142
    v_fmac_f32 v201, v55, v143
    v_add_f32 v199, v197, v199
    v_mul_f32_e64 v203, v56, -v136
    v_fma_f32 v203, v57, -v137, v203
    v_fma_f32 v203, v58, -v138, v203
    v_fma_f32 v203, v59, -v139, v203
    v_fma_f32 v203, v60, -v140, v203
    v_fma_f32 v203, v61, -v141, v203
    v_fma_f32 v203, v62, -v142, v203
    v_fma_f32 v203, v63, -v143, v203
    s_nop 1
    v_permlane32_swap_b32 v201, v203
    v_add_f32 v203, v201, v203
    v_cvt_pk_bf16_f32 v198, v198, v199
    v_cvt_pk_bf16_f32 v202, v202, v203
    ds_write2st64_b32 v253, v198, v202 offset0:0 offset1:1
    v_mfma_f32_32x32x16_bf16 v[32:47], v[64:67], v[180:183], 0
    v_mul_f32 v196, v0, v144
    v_fmac_f32 v196, v1, v145
    v_fmac_f32 v196, v2, v146
    v_fmac_f32 v196, v3, v147
    v_fmac_f32 v196, v4, v148
    v_fmac_f32 v196, v5, v149
    v_fmac_f32 v196, v6, v150
    v_fmac_f32 v196, v7, v151
    v_mul_f32 v198, v8, v112
    v_fmac_f32 v198, v9, v113
    v_fmac_f32 v198, v10, v114
    v_fmac_f32 v198, v11, v115
    v_fmac_f32 v198, v12, v116
    v_fmac_f32 v198, v13, v117
    v_fmac_f32 v198, v14, v118
    v_fmac_f32 v198, v15, v119
    v_mfma_f32_32x32x16_bf16 v[48:63], v[68:71], v[180:183], 0
    s_waitcnt vmcnt(6)
    ds_read_b64_tr_b16 v[176:177], v244 offset:4096
    ds_read_b64_tr_b16 v[178:179], v244 offset:5120
    ds_read_b64_tr_b16 v[180:181], v245 offset:4096
    ds_read_b64_tr_b16 v[182:183], v245 offset:5120
    v_mul_f32_e64 v200, v16, -v160
    v_fma_f32 v200, v17, -v161, v200
    v_fma_f32 v200, v18, -v162, v200
    v_fma_f32 v200, v19, -v163, v200
    v_fma_f32 v200, v20, -v164, v200
    v_fma_f32 v200, v21, -v165, v200
    v_fma_f32 v200, v22, -v166, v200
    v_fma_f32 v200, v23, -v167, v200
    v_mul_f32_e64 v202, v24, -v160
    v_fma_f32 v202, v25, -v161, v202
    v_fma_f32 v202, v26, -v162, v202
    v_fma_f32 v202, v27, -v163, v202
    v_fma_f32 v202, v28, -v164, v202
    v_fma_f32 v202, v29, -v165, v202
    v_fma_f32 v202, v30, -v166, v202
    v_fma_f32 v202, v31, -v167, v202
    s_waitcnt lgkmcnt(0)
    v_mfma_f32_32x32x16_bf16 v[0:15], v[64:67], v[176:179], 0
    v_mul_f32 v197, v32, v152
    v_fmac_f32 v197, v33, v153
    v_fmac_f32 v197, v34, v154
    v_fmac_f32 v197, v35, v155
    v_fmac_f32 v197, v36, v156
    v_fmac_f32 v197, v37, v157
    v_fmac_f32 v197, v38, v158
    v_fmac_f32 v197, v39, v159
    v_mul_f32 v199, v40, v120
    v_fmac_f32 v199, v41, v121
    v_fmac_f32 v199, v42, v122
    v_fmac_f32 v199, v43, v123
    v_fmac_f32 v199, v44, v124
    v_fmac_f32 v199, v45, v125
    v_fmac_f32 v199, v46, v126
    v_fmac_f32 v199, v47, v127
    s_add_u32 m0, s21, 4096
    v_mfma_f32_32x32x16_bf16 v[16:31], v[68:71], v[176:179], 0
    v_lshl_add_u32 v238, v238, 10, v246
    v_lshl_add_u32 v239, v239, 10, v246
    buffer_load_dwordx4 v238, s[4:7], s40 offen lds
    buffer_load_dwordx4 v239, s[8:11], s40 offen offset:1024 lds
    v_mul_f32_e64 v201, v48, -v168
    v_fma_f32 v201, v49, -v169, v201
    v_fma_f32 v201, v50, -v170, v201
    v_fma_f32 v201, v51, -v171, v201
    v_fma_f32 v201, v52, -v172, v201
    v_fma_f32 v201, v53, -v173, v201
    v_fma_f32 v201, v54, -v174, v201
    v_fma_f32 v201, v55, -v175, v201
    v_mul_f32_e64 v203, v56, -v168
    v_fma_f32 v203, v57, -v169, v203
    v_fma_f32 v203, v58, -v170, v203
    v_fma_f32 v203, v59, -v171, v203
    v_fma_f32 v203, v60, -v172, v203
    v_fma_f32 v203, v61, -v173, v203
    v_fma_f32 v203, v62, -v174, v203
    v_fma_f32 v203, v63, -v175, v203
    v_mfma_f32_32x32x16_bf16 v[32:47], v[64:67], v[180:183], 0
    v_mul_f32 v254, v0, v144
    v_fmac_f32 v254, v1, v145
    v_fmac_f32 v254, v2, v146
    v_fmac_f32 v254, v3, v147
    v_fmac_f32 v254, v4, v148
    v_fmac_f32 v254, v5, v149
    v_fmac_f32 v254, v6, v150
    v_fmac_f32 v254, v7, v151
    v_fmac_f32 v200, v8, v160
    v_mfma_f32_32x32x16_bf16 v[48:63], v[68:71], v[180:183], 0
    ds_swizzle_b32 v68, v68 offset:0x401F
    ds_swizzle_b32 v69, v69 offset:0x401F
    ds_swizzle_b32 v70, v70 offset:0x401F
    ds_swizzle_b32 v71, v71 offset:0x401F
    s_waitcnt vmcnt(6)
    ds_read_b64_tr_b16 v[176:177], v244 offset:6144
    ds_read_b64_tr_b16 v[178:179], v244 offset:7168
    ds_read_b64_tr_b16 v[180:181], v245 offset:6144
    ds_read_b64_tr_b16 v[182:183], v245 offset:7168
    v_fmac_f32 v200, v9, v161
    v_permlane32_swap_b32 v196, v254
    v_fmac_f32 v200, v10, v162
    v_fmac_f32 v200, v11, v163
    v_fmac_f32 v200, v12, v164
    v_fmac_f32 v200, v13, v165
    v_fmac_f32 v200, v14, v166
    v_fmac_f32 v200, v15, v167
    v_add_f32 v254, v196, v254
    s_waitcnt lgkmcnt(0)
    s_mov_b64 exec, s[56:57]
    v_xor_b32 v68, 0x80008000, v68
    v_xor_b32 v69, 0x80008000, v69
    v_xor_b32 v70, 0x80008000, v70
    v_xor_b32 v71, 0x80008000, v71
    s_mov_b64 exec, -1
    s_nop 0
    v_mfma_f32_32x32x16_bf16 v[0:15], v[64:67], v[176:179], 0
    v_mul_f32 v255, v32, v152
    v_fmac_f32 v255, v33, v153
    v_fmac_f32 v255, v34, v154
    v_fmac_f32 v255, v35, v155
    v_fmac_f32 v255, v36, v156
    v_fmac_f32 v255, v37, v157
    v_fmac_f32 v255, v38, v158
    v_fmac_f32 v255, v39, v159
    v_fmac_f32 v201, v40, v168
    v_fmac_f32 v201, v41, v169
    s_add_u32 m0, s21, 6144
    v_mfma_f32_32x32x16_bf16 v[16:31], v[68:71], v[176:179], v[16:31]
    v_lshl_add_u32 v240, v240, 10, v246
    v_lshl_add_u32 v241, v241, 10, v246
    buffer_load_dwordx4 v240, s[4:7], s41 offen lds
    buffer_load_dwordx4 v241, s[8:11], s41 offen offset:1024 lds
    v_permlane32_swap_b32 v197, v255
    v_fmac_f32 v201, v42, v170
    v_fmac_f32 v201, v43, v171
    v_fmac_f32 v201, v44, v172
    v_fmac_f32 v201, v45, v173
    v_fmac_f32 v201, v46, v174
    v_fmac_f32 v201, v47, v175
    v_add_f32 v255, v197, v255
    v_cvt_pk_bf16_f32 v254, v254, v255
    ds_write_b32 v253, v254 offset:512
    v_mfma_f32_32x32x16_bf16 v[32:47], v[64:67], v[180:183], 0
    v_mul_f32 v254, v0, v144
    v_fmac_f32 v254, v1, v145
    v_fmac_f32 v254, v2, v146
    v_fmac_f32 v254, v3, v147
    v_fmac_f32 v254, v4, v148
    v_fmac_f32 v254, v5, v149
    v_fmac_f32 v254, v6, v150
    v_fmac_f32 v254, v7, v151
    v_fma_f32 v202, v8, -v160, v202
    v_fma_f32 v202, v9, -v161, v202
    v_permlane32_swap_b32 v254, v200
    v_fma_f32 v202, v10, -v162, v202
    v_fma_f32 v202, v11, -v163, v202
    v_fma_f32 v202, v12, -v164, v202
    v_fma_f32 v202, v13, -v165, v202
    v_fma_f32 v202, v14, -v166, v202
    v_fma_f32 v202, v15, -v167, v202
    v_add_f32 v200, v254, v200
    v_fmac_f32 v198, v16, v112
    v_permlane32_swap_b32 v202, v254
    v_mfma_f32_32x32x16_bf16 v[48:63], v[68:71], v[180:183], v[48:63]
    s_waitcnt vmcnt(6)
    ds_read_b64_tr_b16 v[176:177], v244 offset:0
    ds_read_b64_tr_b16 v[178:179], v244 offset:1024
    ds_read_b64_tr_b16 v[180:181], v245 offset:0
    ds_read_b64_tr_b16 v[182:183], v245 offset:1024
    v_add_u32 v249, s48, v249
    v_add_u32 v250, s49, v250
    ds_read_b32 v252, v251 offset:16
    ds_read_b64_tr_b16 v[64:65], v249 offset:0
    ds_read_b64_tr_b16 v[68:69], v249 offset:64
    ds_read_b64_tr_b16 v[66:67], v249 offset:256
    ds_read_b64_tr_b16 v[70:71], v249 offset:320
    s_mov_b64 exec, s[54:55]
    ds_read_u16_d16_hi v242, v250 offset:0
    s_mov_b64 exec, -1
    v_fmac_f32 v198, v17, v113
    v_fmac_f32 v198, v18, v114
    v_fmac_f32 v198, v19, v115
    v_fmac_f32 v198, v20, v116
    v_fmac_f32 v198, v21, v117
    v_fmac_f32 v198, v22, v118
    v_fmac_f32 v198, v23, v119
    v_add_f32 v254, v202, v254
    v_mul_f32 v196, v24, v160
    v_fmac_f32 v196, v25, v161
    v_fmac_f32 v196, v26, v162
    v_fmac_f32 v196, v27, v163
    v_fmac_f32 v196, v28, v164
    v_fmac_f32 v196, v29, v165
    v_fmac_f32 v196, v30, v166
    v_fmac_f32 v196, v31, v167
    s_nop 1
    v_permlane32_swap_b32 v198, v196
    v_add_f32 v196, v198, v196
    v_mul_f32 v255, v32, v152
    v_fmac_f32 v255, v33, v153
    v_fmac_f32 v255, v34, v154
    v_fmac_f32 v255, v35, v155
    v_fmac_f32 v255, v36, v156
    v_fmac_f32 v255, v37, v157
    v_fmac_f32 v255, v38, v158
    v_fmac_f32 v255, v39, v159
    v_fma_f32 v203, v40, -v168, v203
    v_fma_f32 v203, v41, -v169, v203
    v_permlane32_swap_b32 v255, v201
    v_fma_f32 v203, v42, -v170, v203
    v_fma_f32 v203, v43, -v171, v203
    v_fma_f32 v203, v44, -v172, v203
    v_fma_f32 v203, v45, -v173, v203
    v_fma_f32 v203, v46, -v174, v203
    v_fma_f32 v203, v47, -v175, v203
    v_add_f32 v201, v255, v201
    v_fmac_f32 v199, v48, v120
    v_permlane32_swap_b32 v203, v255
    v_fmac_f32 v199, v49, v121
    v_fmac_f32 v199, v50, v122
    v_fmac_f32 v199, v51, v123
    v_fmac_f32 v199, v52, v124
    v_fmac_f32 v199, v53, v125
    v_fmac_f32 v199, v54, v126
    v_fmac_f32 v199, v55, v127
    v_add_f32 v255, v203, v255
    v_mul_f32 v197, v56, v168
    v_fmac_f32 v197, v57, v169
    v_fmac_f32 v197, v58, v170
    v_fmac_f32 v197, v59, v171
    v_fmac_f32 v197, v60, v172
    v_fmac_f32 v197, v61, v173
    v_fmac_f32 v197, v62, v174
    v_fmac_f32 v197, v63, v175
    s_nop 1
    v_permlane32_swap_b32 v199, v197
    v_add_f32 v197, v199, v197
    v_cvt_pk_bf16_f32 v200, v200, v201
    v_cvt_pk_bf16_f32 v254, v254, v255
    v_cvt_pk_bf16_f32 v196, v196, v197
    ds_write2st64_b32 v253, v200, v196 offset0:3 offset1:4
    s_mov_b64 exec, 0xffffffff
    ds_write_b32 v253, v254 offset:1280
    s_mov_b64 exec, -1
    s_add_u32 s50, s50, 1
    s_cmp_ge_u32 s50, 4
    s_cbranch_scc1 LAST1
    s_waitcnt lgkmcnt(7)
    v_readfirstlane_b32 s66, v252
    s_add_u32 s53, s53, 1
    v_mov_b32 v252, s53
    s_cmp_le_u32 s53, s66
    ds_write2_b32 v251, v252, v252 offset0:0 offset1:8
    s_setprio 1
    s_cbranch_scc1 PRIO_16
    s_setprio 0
PRIO_16:
    s_cmp_eq_u32 s52, 4
    s_cbranch_scc1 ITEM_1_4
    s_cmp_eq_u32 s52, 5
    s_cbranch_scc1 ITEM_1_5
    s_cmp_eq_u32 s52, 3
    s_cbranch_scc1 ITEM_1_3
    s_cmp_eq_u32 s52, 6
    s_cbranch_scc1 ITEM_1_6
    s_cmp_eq_u32 s52, 8
    s_cbranch_scc1 ITEM_1_8
    s_branch ITEM_1_2
.p2align 6
TAIL:
    s_setprio 0
    s_waitcnt vmcnt(0) lgkmcnt(0)
    v_mbcnt_lo_u32_b32 v176, -1, 0
    v_mbcnt_hi_u32_b32 v176, -1, v176
    v_lshlrev_b32 v180, 4, v176
    s_cmp_eq_u32 s89, 0
    s_cbranch_scc1 T_flags
    s_mul_i32 s66, s20, 80
    v_lshlrev_b32 v2, 2, v176
    v_min_u32 v2, 76, v2
    s_mov_b32 s67, 262144
T_poll:
    buffer_load_dword v3, v2, s[16:19], s66 offen offset:128 sc1
    s_waitcnt vmcnt(0)
    v_cmp_ne_u32 vcc, s88, v3
    s_sub_u32 s67, s67, 1
    s_cselect_b64 vcc, 0, vcc
    s_cmp_eq_u64 vcc, 0
    s_cbranch_scc0 T_poll
    s_mov_b32 s89, 0
T_flags:
    s_mul_i32 s66, s20, 20480
    s_add_u32 s66, s66, 1024
    buffer_load_dwordx4 v[96:99], v180, s[16:19], s66 offen offset:0 sc1
    buffer_load_dwordx4 v[100:103], v180, s[16:19], s66 offen offset:1024 sc1
    buffer_load_dwordx4 v[104:107], v180, s[16:19], s66 offen offset:2048 sc1
    buffer_load_dwordx4 v[108:111], v180, s[16:19], s66 offen offset:3072 sc1
    s_add_u32 s66, s66, 4096
    buffer_load_dwordx4 v[112:115], v180, s[16:19], s66 offen offset:0 sc1
    buffer_load_dwordx4 v[116:119], v180, s[16:19], s66 offen offset:1024 sc1
    buffer_load_dwordx4 v[120:123], v180, s[16:19], s66 offen offset:2048 sc1
    buffer_load_dwordx4 v[124:127], v180, s[16:19], s66 offen offset:3072 sc1
    s_add_u32 s66, s66, 4096
    buffer_load_dwordx4 v[128:131], v180, s[16:19], s66 offen offset:0 sc1
    buffer_load_dwordx4 v[132:135], v180, s[16:19], s66 offen offset:1024 sc1
    buffer_load_dwordx4 v[136:139], v180, s[16:19], s66 offen offset:2048 sc1
    buffer_load_dwordx4 v[140:143], v180, s[16:19], s66 offen offset:3072 sc1
    s_add_u32 s66, s66, 4096
    buffer_load_dwordx4 v[144:147], v180, s[16:19], s66 offen offset:0 sc1
    buffer_load_dwordx4 v[148:151], v180, s[16:19], s66 offen offset:1024 sc1
    buffer_load_dwordx4 v[152:155], v180, s[16:19], s66 offen offset:2048 sc1
    buffer_load_dwordx4 v[156:159], v180, s[16:19], s66 offen offset:3072 sc1
    s_add_u32 s66, s66, 4096
    buffer_load_dwordx4 v[160:163], v180, s[16:19], s66 offen offset:0 sc1
    buffer_load_dwordx4 v[164:167], v180, s[16:19], s66 offen offset:1024 sc1
    buffer_load_dwordx4 v[168:171], v180, s[16:19], s66 offen offset:2048 sc1
    buffer_load_dwordx4 v[172:175], v180, s[16:19], s66 offen offset:3072 sc1
    v_lshlrev_b32 v181, 2, v176
    s_bfe_u32 s67, s22, 0x40015
    s_lshl_b32 s67, s67, 4
    s_and_b32 s68, s67, 128
    s_and_b32 s67, s67, 0x70
    s_add_u32 s68, s68, s21
    v_xor_b32 v180, s67, v181
    v_add_u32 v180, s68, v180
    ds_write2st64_b32 v180, v204, v205 offset0:0 offset1:1
    ds_write2st64_b32 v180, v206, v207 offset0:2 offset1:3
    ds_write2st64_b32 v180, v208, v209 offset0:4 offset1:5
    s_bfe_u32 s67, s23, 0x40015
    s_lshl_b32 s67, s67, 4
    s_and_b32 s68, s67, 128
    s_and_b32 s67, s67, 0x70
    s_add_u32 s68, s68, s21
    v_xor_b32 v180, s67, v181
    v_add_u32 v180, s68, v180
    ds_write2st64_b32 v180, v210, v211 offset0:6 offset1:7
    ds_write2st64_b32 v180, v212, v213 offset0:8 offset1:9
    ds_write2st64_b32 v180, v214, v215 offset0:10 offset1:11
    s_bfe_u32 s67, s24, 0x40015
    s_lshl_b32 s67, s67, 4
    s_and_b32 s68, s67, 128
    s_and_b32 s67, s67, 0x70
    s_add_u32 s68, s68, s21
    v_xor_b32 v180, s67, v181
    v_add_u32 v180, s68, v180
    ds_write2st64_b32 v180, v216, v217 offset0:12 offset1:13
    ds_write2st64_b32 v180, v218, v219 offset0:14 offset1:15
    ds_write2st64_b32 v180, v220, v221 offset0:16 offset1:17
    s_bfe_u32 s67, s25, 0x40015
    s_lshl_b32 s67, s67, 4
    s_and_b32 s68, s67, 128
    s_and_b32 s67, s67, 0x70
    s_add_u32 s68, s68, s21
    v_xor_b32 v180, s67, v181
    v_add_u32 v180, s68, v180
    ds_write2st64_b32 v180, v222, v223 offset0:18 offset1:19
    ds_write2st64_b32 v180, v224, v225 offset0:20 offset1:21
    ds_write2st64_b32 v180, v226, v227 offset0:22 offset1:23
    s_bfe_u32 s67, s26, 0x40015
    s_lshl_b32 s67, s67, 4
    s_and_b32 s68, s67, 128
    s_and_b32 s67, s67, 0x70
    s_add_u32 s68, s68, s21
    v_xor_b32 v180, s67, v181
    v_add_u32 v180, s68, v180
    ds_write2st64_b32 v180, v228, v229 offset0:24 offset1:25
    ds_write2st64_b32 v180, v230, v231 offset0:26 offset1:27
    ds_write2st64_b32 v180, v232, v233 offset0:28 offset1:29
GEMM:
    v_and_b32 v177, 15, v176
    v_lshrrev_b32 v178, 4, v176
    v_and_b32 v179, 7, v177
    v_lshlrev_b32 v180, 3, v177
    v_lshlrev_b32 v181, 3, v179
    v_add_u32 v180, 163328, v180
    v_add_u32 v181, 163328, v181
    ds_read_b64 v[182:183], v180
    ds_read_b64 v[184:185], v180 offset:128
    ds_read_b64 v[186:187], v181 offset:256
    v_xor_b32 v180, v179, v178
    v_and_b32 v181, 8, v177
    v_xor_b32 v188, 4, v180
    v_add_u32 v189, v188, v181
    v_add_u32 v181, v180, v181
    s_waitcnt lgkmcnt(0)
    s_mov_b32 s4, s72
    s_and_b32 s5, s73, 0xffff
    s_mov_b32 s6, 10240000
    s_mov_b32 s7, 0x20000
    v_lshl_add_u32 v48, v180, 4, v182
    v_lshl_add_u32 v49, v188, 4, v182
    v_lshl_add_u32 v50, v180, 4, v183
    v_lshl_add_u32 v51, v188, 4, v183
    v_lshl_add_u32 v52, v180, 4, v184
    v_lshl_add_u32 v53, v188, 4, v184
    v_lshl_add_u32 v54, v180, 4, v185
    v_lshl_add_u32 v55, v188, 4, v185
    v_lshl_add_u32 v56, v181, 4, v186
    v_lshl_add_u32 v57, v189, 4, v186
    v_lshl_add_u32 v58, v181, 4, v187
    v_lshl_add_u32 v59, v189, 4, v187
    s_mov_b32 s67, 0xbfb8aa3b
    s_barrier
    ds_read_b128 v[76:79], v48 offset:0
    ds_read_b128 v[80:83], v52 offset:0
    ds_read_b128 v[84:87], v56 offset:0
    ds_read_b128 v[88:91], v49 offset:0
    ds_read_b128 v[92:95], v53 offset:0
    s_waitcnt vmcnt(19) lgkmcnt(4)
    v_mfma_f32_16x16x32_bf16 v[0:3], v[96:99], v[76:79], 0
    v_lshrrev_b32 v205, 1, v178
    v_lshl_add_u32 v205, s20, 1, v205
    ds_read_b128 v[76:79], v57 offset:0
    s_waitcnt lgkmcnt(4)
    v_mfma_f32_16x16x32_bf16 v[4:7], v[96:99], v[80:83], 0
    v_and_b32 v204, 7, v177
    v_xor_b32 v205, v205, v204
    ds_read_b128 v[80:83], v50 offset:0
    s_waitcnt lgkmcnt(4)
    v_mfma_f32_16x16x32_bf16 v[8:11], v[96:99], v[84:87], 0
    v_and_b32 v204, 1, v178
    v_lshlrev_b32 v204, 3, v204
    ds_read_b128 v[84:87], v54 offset:0
    s_waitcnt vmcnt(18) lgkmcnt(4)
    v_mfma_f32_16x16x32_bf16 v[0:3], v[100:103], v[88:91], v[0:3]
    v_lshl_add_u32 v205, v205, 4, v204
    v_and_b32 v204, 8, v177
    ds_read_b128 v[88:91], v58 offset:0
    s_waitcnt lgkmcnt(4)
    v_mfma_f32_16x16x32_bf16 v[4:7], v[100:103], v[92:95], v[4:7]
    v_lshl_add_u32 v204, v204, 4, v205
    v_lshl_add_u32 v204, v177, 10, v204
    ds_read_b128 v[92:95], v51 offset:0
    s_waitcnt lgkmcnt(4)
    v_mfma_f32_16x16x32_bf16 v[8:11], v[100:103], v[76:79], v[8:11]
    v_add_u32 v204, 65536, v204
    v_add_u32 v205, v205, v182
    ds_read_b128 v[76:79], v55 offset:0
    s_waitcnt vmcnt(17) lgkmcnt(4)
    v_mfma_f32_16x16x32_bf16 v[0:3], v[104:107], v[80:83], v[0:3]
    v_and_b32 v220, 8, v177
    v_mul_u32_u24 v220, 1008, v220
    ds_read_b128 v[80:83], v59 offset:0
    s_waitcnt lgkmcnt(4)
    v_mfma_f32_16x16x32_bf16 v[4:7], v[104:107], v[84:87], v[4:7]
    v_sub_u32 v220, v204, v220
    v_lshlrev_b32 v210, 4, v176
    ds_read_b128 v[84:87], v48 offset:1024
    s_waitcnt lgkmcnt(4)
    v_mfma_f32_16x16x32_bf16 v[8:11], v[104:107], v[88:91], v[8:11]
    s_lshl_b32 s68, s20, 1
    s_add_u32 s69, s68, 1
    ds_read_b128 v[88:91], v52 offset:1024
    s_waitcnt vmcnt(16) lgkmcnt(4)
    v_mfma_f32_16x16x32_bf16 v[0:3], v[108:111], v[92:95], v[0:3]
    v_readlane_b32 s24, v182, s68
    v_readlane_b32 s25, v182, s69
    ds_read_b128 v[92:95], v56 offset:1024
    s_waitcnt lgkmcnt(4)
    v_mfma_f32_16x16x32_bf16 v[4:7], v[108:111], v[76:79], v[4:7]
    s_and_b32 s70, s68, 7
    s_lshl_b32 s70, s70, 4
    ds_read_b128 v[76:79], v49 offset:1024
    s_waitcnt lgkmcnt(4)
    v_mfma_f32_16x16x32_bf16 v[8:11], v[108:111], v[80:83], v[8:11]
    v_xor_b32 v206, s70, v210
    v_xor_b32 v207, 16, v206
    ds_read_b128 v[80:83], v53 offset:1024
    s_waitcnt vmcnt(15) lgkmcnt(4)
    v_mfma_f32_16x16x32_bf16 v[0:3], v[112:115], v[84:87], v[0:3]
    v_add_u32 v208, s24, v206
    v_add_u32 v209, s25, v207
    ds_read_b128 v[84:87], v57 offset:1024
    s_waitcnt lgkmcnt(4)
    v_mfma_f32_16x16x32_bf16 v[4:7], v[112:115], v[88:91], v[4:7]
    s_lshl_b32 s70, s68, 10
    s_and_b32 s71, s68, 8
    ds_read_b128 v[88:91], v50 offset:1024
    s_waitcnt lgkmcnt(4)
    v_mfma_f32_16x16x32_bf16 v[8:11], v[112:115], v[92:95], v[8:11]
    s_lshl_b32 s71, s71, 4
    s_add_u32 s71, s71, s70
    ds_read_b128 v[92:95], v54 offset:1024
    s_waitcnt vmcnt(14) lgkmcnt(4)
    v_mfma_f32_16x16x32_bf16 v[0:3], v[116:119], v[76:79], v[0:3]
    s_add_u32 s71, s71, 65536
    v_add_u32 v206, s71, v206
    ds_read_b128 v[76:79], v58 offset:1024
    s_waitcnt lgkmcnt(4)
    v_mfma_f32_16x16x32_bf16 v[4:7], v[116:119], v[80:83], v[4:7]
    v_add_u32 v207, s71, v207
    s_mul_i32 s66, s2, 40960
    ds_read_b128 v[80:83], v51 offset:1024
    s_waitcnt lgkmcnt(4)
    v_mfma_f32_16x16x32_bf16 v[8:11], v[116:119], v[84:87], v[8:11]
    s_add_u32 s22, s66, s70
    s_add_u32 s23, s22, 0x4000
    ds_read_b128 v[84:87], v55 offset:1024
    s_waitcnt vmcnt(13) lgkmcnt(4)
    v_mfma_f32_16x16x32_bf16 v[0:3], v[120:123], v[88:91], v[0:3]
    s_lshl_b32 s70, s20, 10
    s_add_u32 s66, s66, s70
    ds_read_b128 v[88:91], v59 offset:1024
    s_waitcnt lgkmcnt(4)
    v_mfma_f32_16x16x32_bf16 v[4:7], v[120:123], v[92:95], v[4:7]
    s_add_u32 s66, s66, 0x8000
    s_add_u32 s70, s70, 65536
    ds_read_b128 v[92:95], v48 offset:128
    s_waitcnt lgkmcnt(4)
    v_mfma_f32_16x16x32_bf16 v[8:11], v[120:123], v[76:79], v[8:11]
    s_lshl_b32 s71, s20, 4
    v_xor_b32 v211, s71, v210
    ds_read_b128 v[76:79], v48 offset:256
    s_waitcnt vmcnt(12) lgkmcnt(4)
    v_mfma_f32_16x16x32_bf16 v[0:3], v[124:127], v[80:83], v[0:3]
    v_add_u32 v211, s70, v211
    ds_read_b128 v[80:83], v48 offset:384
    s_waitcnt lgkmcnt(4)
    v_mfma_f32_16x16x32_bf16 v[4:7], v[124:127], v[84:87], v[4:7]
    ds_read_b128 v[84:87], v49 offset:128
    s_waitcnt lgkmcnt(4)
    v_mfma_f32_16x16x32_bf16 v[8:11], v[124:127], v[88:91], v[8:11]
    ds_read_b128 v[88:91], v49 offset:256
    s_waitcnt vmcnt(11) lgkmcnt(4)
    v_mfma_f32_16x16x32_bf16 v[12:15], v[128:131], v[92:95], 0
    ds_read_b128 v[92:95], v49 offset:384
    s_waitcnt lgkmcnt(4)
    v_mfma_f32_16x16x32_bf16 v[24:27], v[128:131], v[76:79], 0
    ds_read_b128 v[76:79], v50 offset:128
    s_waitcnt lgkmcnt(4)
    v_mfma_f32_16x16x32_bf16 v[36:39], v[128:131], v[80:83], 0
    ds_read_b128 v[80:83], v50 offset:256
    s_waitcnt vmcnt(10) lgkmcnt(4)
    v_mfma_f32_16x16x32_bf16 v[12:15], v[132:135], v[84:87], v[12:15]
    v_mul_f32 v192, s67, v0
    v_mul_f32 v193, s67, v1
    ds_read_b128 v[84:87], v50 offset:384
    s_waitcnt lgkmcnt(4)
    v_mfma_f32_16x16x32_bf16 v[24:27], v[132:135], v[88:91], v[24:27]
    v_mul_f32 v194, s67, v2
    v_mul_f32 v195, s67, v3
    ds_read_b128 v[88:91], v51 offset:128
    s_waitcnt lgkmcnt(4)
    v_mfma_f32_16x16x32_bf16 v[36:39], v[132:135], v[92:95], v[36:39]
    v_exp_f32 v192, v192
    v_exp_f32 v193, v193
    ds_read_b128 v[92:95], v51 offset:256
    s_waitcnt vmcnt(9) lgkmcnt(4)
    v_mfma_f32_16x16x32_bf16 v[12:15], v[136:139], v[76:79], v[12:15]
    v_exp_f32 v194, v194
    v_exp_f32 v195, v195
    ds_read_b128 v[76:79], v51 offset:384
    s_waitcnt lgkmcnt(4)
    v_mfma_f32_16x16x32_bf16 v[24:27], v[136:139], v[80:83], v[24:27]
    v_add_f32 v192, 1.0, v192
    v_add_f32 v193, 1.0, v193
    ds_read_b128 v[80:83], v48 offset:512
    s_waitcnt lgkmcnt(4)
    v_mfma_f32_16x16x32_bf16 v[36:39], v[136:139], v[84:87], v[36:39]
    v_add_f32 v194, 1.0, v194
    v_add_f32 v195, 1.0, v195
    ds_read_b128 v[84:87], v48 offset:640
    s_waitcnt vmcnt(8) lgkmcnt(4)
    v_mfma_f32_16x16x32_bf16 v[12:15], v[140:143], v[88:91], v[12:15]
    v_rcp_f32 v192, v192
    v_rcp_f32 v193, v193
    ds_read_b128 v[88:91], v48 offset:768
    s_waitcnt lgkmcnt(4)
    v_mfma_f32_16x16x32_bf16 v[24:27], v[140:143], v[92:95], v[24:27]
    v_rcp_f32 v194, v194
    v_rcp_f32 v195, v195
    ds_read_b128 v[92:95], v49 offset:512
    s_waitcnt lgkmcnt(4)
    v_mfma_f32_16x16x32_bf16 v[36:39], v[140:143], v[76:79], v[36:39]
    v_mul_f32 v196, s67, v4
    v_mul_f32 v197, s67, v5
    ds_read_b128 v[76:79], v49 offset:640
    s_waitcnt vmcnt(7) lgkmcnt(4)
    v_mfma_f32_16x16x32_bf16 v[12:15], v[144:147], v[80:83], v[12:15]
    v_mul_f32 v198, s67, v6
    v_mul_f32 v199, s67, v7
    ds_read_b128 v[80:83], v49 offset:768
    s_waitcnt lgkmcnt(4)
    v_mfma_f32_16x16x32_bf16 v[24:27], v[144:147], v[84:87], v[24:27]
    v_exp_f32 v196, v196
    v_exp_f32 v197, v197
    ds_read_b128 v[84:87], v50 offset:512
    s_waitcnt lgkmcnt(4)
    v_mfma_f32_16x16x32_bf16 v[36:39], v[144:147], v[88:91], v[36:39]
    v_exp_f32 v198, v198
    v_exp_f32 v199, v199
    ds_read_b128 v[88:91], v50 offset:640
    s_waitcnt vmcnt(6) lgkmcnt(4)
    v_mfma_f32_16x16x32_bf16 v[12:15], v[148:151], v[92:95], v[12:15]
    v_add_f32 v196, 1.0, v196
    v_add_f32 v197, 1.0, v197
    ds_read_b128 v[92:95], v50 offset:768
    s_waitcnt lgkmcnt(4)
    v_mfma_f32_16x16x32_bf16 v[24:27], v[148:151], v[76:79], v[24:27]
    v_add_f32 v198, 1.0, v198
    v_add_f32 v199, 1.0, v199
    ds_read_b128 v[76:79], v51 offset:512
    s_waitcnt lgkmcnt(4)
    v_mfma_f32_16x16x32_bf16 v[36:39], v[148:151], v[80:83], v[36:39]
    v_rcp_f32 v196, v196
    v_rcp_f32 v197, v197
    ds_read_b128 v[80:83], v51 offset:640
    s_waitcnt vmcnt(5) lgkmcnt(4)
    v_mfma_f32_16x16x32_bf16 v[12:15], v[152:155], v[84:87], v[12:15]
    v_rcp_f32 v198, v198
    v_rcp_f32 v199, v199
    ds_read_b128 v[84:87], v51 offset:768
    s_waitcnt lgkmcnt(4)
    v_mfma_f32_16x16x32_bf16 v[24:27], v[152:155], v[88:91], v[24:27]
    v_mul_f32 v200, s67, v8
    v_mul_f32 v201, s67, v9
    ds_read_b128 v[88:91], v48 offset:1152
    s_waitcnt lgkmcnt(4)
    v_mfma_f32_16x16x32_bf16 v[36:39], v[152:155], v[92:95], v[36:39]
    v_mul_f32 v202, s67, v10
    v_mul_f32 v203, s67, v11
    ds_read_b128 v[92:95], v48 offset:1280
    s_waitcnt vmcnt(4) lgkmcnt(4)
    v_mfma_f32_16x16x32_bf16 v[12:15], v[156:159], v[76:79], v[12:15]
    v_exp_f32 v200, v200
    v_exp_f32 v201, v201
    ds_read_b128 v[76:79], v48 offset:896
    s_waitcnt lgkmcnt(4)
    v_mfma_f32_16x16x32_bf16 v[24:27], v[156:159], v[80:83], v[24:27]
    v_exp_f32 v202, v202
    v_exp_f32 v203, v203
    ds_read_b128 v[80:83], v49 offset:1152
    s_waitcnt lgkmcnt(4)
    v_mfma_f32_16x16x32_bf16 v[36:39], v[156:159], v[84:87], v[36:39]
    v_add_f32 v200, 1.0, v200
    v_add_f32 v201, 1.0, v201
    ds_read_b128 v[84:87], v49 offset:1280
    s_waitcnt vmcnt(3) lgkmcnt(4)
    v_mfma_f32_16x16x32_bf16 v[12:15], v[160:163], v[88:91], v[12:15]
    v_add_f32 v202, 1.0, v202
    v_add_f32 v203, 1.0, v203
    ds_read_b128 v[88:91], v49 offset:896
    s_waitcnt lgkmcnt(4)
    v_mfma_f32_16x16x32_bf16 v[24:27], v[160:163], v[92:95], v[24:27]
    v_rcp_f32 v200, v200
    v_rcp_f32 v201, v201
    ds_read_b128 v[92:95], v50 offset:1152
    s_waitcnt lgkmcnt(4)
    v_mfma_f32_16x16x32_bf16 v[36:39], v[160:163], v[76:79], v[36:39]
    v_rcp_f32 v202, v202
    v_rcp_f32 v203, v203
    ds_read_b128 v[76:79], v50 offset:1280
    s_waitcnt vmcnt(2) lgkmcnt(4)
    v_mfma_f32_16x16x32_bf16 v[12:15], v[164:167], v[80:83], v[12:15]
    v_cvt_pk_bf16_f32 v0, v0, v1
    v_cvt_pk_bf16_f32 v1, v2, v3
    ds_read_b128 v[80:83], v50 offset:896
    s_waitcnt lgkmcnt(4)
    v_mfma_f32_16x16x32_bf16 v[24:27], v[164:167], v[84:87], v[24:27]
    ds_write_b64 v204, v[0:1] offset:0
    ds_read_b128 v[84:87], v51 offset:1152
    s_waitcnt lgkmcnt(5)
    v_mfma_f32_16x16x32_bf16 v[36:39], v[164:167], v[88:91], v[36:39]
    v_mov_b32_dpp v200, v200 row_ror:8 row_mask:0xf bank_mask:0xc
    v_mov_b32_dpp v201, v201 row_ror:8 row_mask:0xf bank_mask:0xc
    ds_read_b128 v[88:91], v51 offset:1280
    s_waitcnt vmcnt(1) lgkmcnt(5)
    v_mfma_f32_16x16x32_bf16 v[12:15], v[168:171], v[92:95], v[12:15]
    v_mov_b32_dpp v202, v202 row_ror:8 row_mask:0xf bank_mask:0xc
    v_mov_b32_dpp v203, v203 row_ror:8 row_mask:0xf bank_mask:0xc
    ds_read_b128 v[92:95], v51 offset:896
    s_waitcnt lgkmcnt(5)
    v_mfma_f32_16x16x32_bf16 v[24:27], v[168:171], v[76:79], v[24:27]
    ds_read_b128 v[76:79], v52 offset:128
    s_waitcnt lgkmcnt(5)
    v_mfma_f32_16x16x32_bf16 v[36:39], v[168:171], v[80:83], v[36:39]
    ds_read_b128 v[80:83], v53 offset:128
    s_waitcnt vmcnt(0) lgkmcnt(4)
    v_mfma_f32_16x16x32_bf16 v[12:15], v[172:175], v[84:87], v[12:15]
    ds_read_b128 v[84:87], v54 offset:128
    s_waitcnt lgkmcnt(4)
    v_mfma_f32_16x16x32_bf16 v[24:27], v[172:175], v[88:91], v[24:27]
    ds_read_b128 v[88:91], v55 offset:128
    s_waitcnt lgkmcnt(4)
    v_mfma_f32_16x16x32_bf16 v[36:39], v[172:175], v[92:95], v[36:39]
    ds_read_b128 v[92:95], v52 offset:512
    s_waitcnt lgkmcnt(4)
    v_mfma_f32_16x16x32_bf16 v[16:19], v[128:131], v[76:79], 0
    ds_read_b128 v[76:79], v53 offset:512
    s_waitcnt lgkmcnt(4)
    v_mfma_f32_16x16x32_bf16 v[16:19], v[132:135], v[80:83], v[16:19]
    ds_read_b128 v[80:83], v54 offset:512
    s_waitcnt lgkmcnt(4)
    v_mfma_f32_16x16x32_bf16 v[16:19], v[136:139], v[84:87], v[16:19]
    v_mul_f32 v12, v12, v192
    v_mul_f32 v13, v13, v193
    ds_read_b128 v[84:87], v55 offset:512
    s_waitcnt lgkmcnt(4)
    v_mfma_f32_16x16x32_bf16 v[16:19], v[140:143], v[88:91], v[16:19]
    v_mul_f32 v14, v14, v194
    v_mul_f32 v15, v15, v195
    ds_read_b128 v[88:91], v52 offset:1152
    s_waitcnt lgkmcnt(4)
    v_mfma_f32_16x16x32_bf16 v[16:19], v[144:147], v[92:95], v[16:19]
    v_cvt_pk_bf16_f32 v12, v12, v13
    v_cvt_pk_bf16_f32 v13, v14, v15
    ds_read_b128 v[92:95], v53 offset:1152
    s_waitcnt lgkmcnt(4)
    v_mfma_f32_16x16x32_bf16 v[16:19], v[148:151], v[76:79], v[16:19]
    ds_write_b64 v204, v[12:13] offset:256
    v_mul_f32 v24, v24, v192
    ds_read_b128 v[76:79], v54 offset:1152
    s_waitcnt lgkmcnt(5)
    v_mfma_f32_16x16x32_bf16 v[16:19], v[152:155], v[80:83], v[16:19]
    v_mul_f32 v25, v25, v193
    v_mul_f32 v26, v26, v194
    ds_read_b128 v[80:83], v55 offset:1152
    s_waitcnt lgkmcnt(5)
    v_mfma_f32_16x16x32_bf16 v[16:19], v[156:159], v[84:87], v[16:19]
    v_mul_f32 v27, v27, v195
    v_cvt_pk_bf16_f32 v24, v24, v25
    ds_read_b128 v[84:87], v52 offset:256
    s_waitcnt lgkmcnt(5)
    v_mfma_f32_16x16x32_bf16 v[16:19], v[160:163], v[88:91], v[16:19]
    v_cvt_pk_bf16_f32 v25, v26, v27
    ds_write_b64 v204, v[24:25] offset:512
    ds_read_b128 v[88:91], v53 offset:256
    s_waitcnt lgkmcnt(6)
    v_mfma_f32_16x16x32_bf16 v[16:19], v[164:167], v[92:95], v[16:19]
    v_mul_f32 v36, v36, v192
    v_mul_f32 v37, v37, v193
    ds_read_b128 v[92:95], v54 offset:256
    s_waitcnt lgkmcnt(5)
    v_mfma_f32_16x16x32_bf16 v[16:19], v[168:171], v[76:79], v[16:19]
    v_mul_f32 v38, v38, v194
    v_mul_f32 v39, v39, v195
    ds_read_b128 v[76:79], v55 offset:256
    s_waitcnt lgkmcnt(5)
    v_mfma_f32_16x16x32_bf16 v[16:19], v[172:175], v[80:83], v[16:19]
    v_cvt_pk_bf16_f32 v36, v36, v37
    v_cvt_pk_bf16_f32 v37, v38, v39
    ds_read_b128 v[80:83], v52 offset:640
    s_waitcnt lgkmcnt(5)
    v_mfma_f32_16x16x32_bf16 v[28:31], v[128:131], v[84:87], 0
    ds_write_b64 v204, v[36:37] offset:768
    ds_read_b128 v[84:87], v53 offset:640
    s_waitcnt lgkmcnt(5)
    v_mfma_f32_16x16x32_bf16 v[28:31], v[132:135], v[88:91], v[28:31]
    ds_read_b128 v[88:91], v54 offset:640
    s_waitcnt lgkmcnt(5)
    v_mfma_f32_16x16x32_bf16 v[28:31], v[136:139], v[92:95], v[28:31]
    ds_read_b128 v[92:95], v55 offset:640
    s_waitcnt lgkmcnt(5)
    v_mfma_f32_16x16x32_bf16 v[28:31], v[140:143], v[76:79], v[28:31]
    ds_read_b128 v[76:79], v52 offset:1280
    s_waitcnt lgkmcnt(5)
    v_mfma_f32_16x16x32_bf16 v[28:31], v[144:147], v[80:83], v[28:31]
    ds_read_b128 v[80:83], v53 offset:1280
    s_waitcnt lgkmcnt(4)
    v_mfma_f32_16x16x32_bf16 v[28:31], v[148:151], v[84:87], v[28:31]
    s_barrier
    ds_read_b128 v[84:87], v54 offset:1280
    s_waitcnt lgkmcnt(4)
    v_mfma_f32_16x16x32_bf16 v[28:31], v[152:155], v[88:91], v[28:31]
    ds_read_b128 v[212:215], v206 offset:0
    ds_read_b128 v[216:219], v207 offset:1024
    ds_read_b128 v[88:91], v55 offset:1280
    s_waitcnt lgkmcnt(6)
    v_mfma_f32_16x16x32_bf16 v[28:31], v[156:159], v[92:95], v[28:31]
    ds_read_b128 v[92:95], v52 offset:384
    s_waitcnt lgkmcnt(6)
    v_mfma_f32_16x16x32_bf16 v[28:31], v[160:163], v[76:79], v[28:31]
    ds_read_b128 v[76:79], v53 offset:384
    s_waitcnt lgkmcnt(6)
    v_mfma_f32_16x16x32_bf16 v[28:31], v[164:167], v[80:83], v[28:31]
    ds_read_b128 v[80:83], v54 offset:384
    s_waitcnt lgkmcnt(6)
    v_mfma_f32_16x16x32_bf16 v[28:31], v[168:171], v[84:87], v[28:31]
    ds_read_b128 v[84:87], v55 offset:384
    s_waitcnt lgkmcnt(4)
    v_mfma_f32_16x16x32_bf16 v[28:31], v[172:175], v[88:91], v[28:31]
    buffer_store_dwordx4 v[212:215], v210, s[4:7], s22 offen offset:0 sc1
    ds_read_b128 v[88:91], v52 offset:768
    s_waitcnt lgkmcnt(4)
    v_mfma_f32_16x16x32_bf16 v[40:43], v[128:131], v[92:95], 0
    buffer_store_dwordx4 v[216:219], v210, s[4:7], s22 offen offset:1024 sc1
    ds_read_b128 v[92:95], v53 offset:768
    s_waitcnt lgkmcnt(4)
    v_mfma_f32_16x16x32_bf16 v[40:43], v[132:135], v[76:79], v[40:43]
    ds_read_b128 v[76:79], v54 offset:768
    s_waitcnt lgkmcnt(4)
    v_mfma_f32_16x16x32_bf16 v[40:43], v[136:139], v[80:83], v[40:43]
    ds_read_b128 v[80:83], v55 offset:768
    s_waitcnt lgkmcnt(4)
    v_mfma_f32_16x16x32_bf16 v[40:43], v[140:143], v[84:87], v[40:43]
    v_cvt_pk_bf16_f32 v4, v4, v5
    v_cvt_pk_bf16_f32 v5, v6, v7
    ds_read_b128 v[84:87], v52 offset:896
    s_waitcnt lgkmcnt(4)
    v_mfma_f32_16x16x32_bf16 v[40:43], v[144:147], v[88:91], v[40:43]
    ds_write_b64 v205, v[4:5] offset:0
    v_mul_f32 v16, v16, v196
    ds_read_b128 v[88:91], v53 offset:896
    s_waitcnt lgkmcnt(5)
    v_mfma_f32_16x16x32_bf16 v[40:43], v[148:151], v[92:95], v[40:43]
    v_mul_f32 v17, v17, v197
    v_mul_f32 v18, v18, v198
    ds_read_b128 v[92:95], v54 offset:896
    s_waitcnt lgkmcnt(5)
    v_mfma_f32_16x16x32_bf16 v[40:43], v[152:155], v[76:79], v[40:43]
    v_mul_f32 v19, v19, v199
    v_cvt_pk_bf16_f32 v16, v16, v17
    ds_read_b128 v[76:79], v55 offset:896
    s_waitcnt lgkmcnt(5)
    v_mfma_f32_16x16x32_bf16 v[40:43], v[156:159], v[80:83], v[40:43]
    v_cvt_pk_bf16_f32 v17, v18, v19
    ds_write_b64 v205, v[16:17] offset:256
    ds_read_b128 v[80:83], v56 offset:128
    s_waitcnt lgkmcnt(6)
    v_mfma_f32_16x16x32_bf16 v[40:43], v[160:163], v[84:87], v[40:43]
    v_mul_f32 v28, v28, v196
    v_mul_f32 v29, v29, v197
    ds_read_b128 v[84:87], v57 offset:128
    s_waitcnt lgkmcnt(5)
    v_mfma_f32_16x16x32_bf16 v[40:43], v[164:167], v[88:91], v[40:43]
    v_mul_f32 v30, v30, v198
    v_mul_f32 v31, v31, v199
    ds_read_b128 v[88:91], v58 offset:128
    s_waitcnt lgkmcnt(5)
    v_mfma_f32_16x16x32_bf16 v[40:43], v[168:171], v[92:95], v[40:43]
    v_cvt_pk_bf16_f32 v28, v28, v29
    v_cvt_pk_bf16_f32 v29, v30, v31
    ds_read_b128 v[92:95], v59 offset:128
    s_waitcnt lgkmcnt(5)
    v_mfma_f32_16x16x32_bf16 v[40:43], v[172:175], v[76:79], v[40:43]
    ds_write_b64 v205, v[28:29] offset:512
    ds_read_b128 v[76:79], v56 offset:512
    s_waitcnt lgkmcnt(5)
    v_mfma_f32_16x16x32_bf16 v[20:23], v[128:131], v[80:83], 0
    ds_read_b128 v[80:83], v57 offset:512
    s_waitcnt lgkmcnt(5)
    v_mfma_f32_16x16x32_bf16 v[20:23], v[132:135], v[84:87], v[20:23]
    ds_read_b128 v[84:87], v58 offset:512
    s_waitcnt lgkmcnt(5)
    v_mfma_f32_16x16x32_bf16 v[20:23], v[136:139], v[88:91], v[20:23]
    ds_read_b128 v[88:91], v59 offset:512
    s_waitcnt lgkmcnt(5)
    v_mfma_f32_16x16x32_bf16 v[20:23], v[140:143], v[92:95], v[20:23]
    v_mul_f32 v40, v40, v196
    v_mul_f32 v41, v41, v197
    ds_read_b128 v[92:95], v56 offset:1152
    s_waitcnt lgkmcnt(4)
    v_mfma_f32_16x16x32_bf16 v[20:23], v[144:147], v[76:79], v[20:23]
    v_mul_f32 v42, v42, v198
    v_mul_f32 v43, v43, v199
    ds_read_b128 v[76:79], v57 offset:1152
    s_waitcnt lgkmcnt(4)
    v_mfma_f32_16x16x32_bf16 v[20:23], v[148:151], v[80:83], v[20:23]
    v_cvt_pk_bf16_f32 v40, v40, v41
    v_cvt_pk_bf16_f32 v41, v42, v43
    ds_read_b128 v[80:83], v58 offset:1152
    s_waitcnt lgkmcnt(4)
    v_mfma_f32_16x16x32_bf16 v[20:23], v[152:155], v[84:87], v[20:23]
    ds_write_b64 v205, v[40:41] offset:768
    ds_read_b128 v[84:87], v59 offset:1152
    s_waitcnt lgkmcnt(5)
    v_mfma_f32_16x16x32_bf16 v[20:23], v[156:159], v[88:91], v[20:23]
    ds_read_b128 v[88:91], v56 offset:384
    s_waitcnt lgkmcnt(5)
    v_mfma_f32_16x16x32_bf16 v[20:23], v[160:163], v[92:95], v[20:23]
    ds_read_b128 v[92:95], v57 offset:384
    s_waitcnt lgkmcnt(5)
    v_mfma_f32_16x16x32_bf16 v[20:23], v[164:167], v[76:79], v[20:23]
    s_waitcnt lgkmcnt(3)
    s_barrier
    ds_read_b128 v[76:79], v58 offset:384
    v_mfma_f32_16x16x32_bf16 v[20:23], v[168:171], v[80:83], v[20:23]
    ds_read_b128 v[212:215], v208 offset:0
    ds_read_b128 v[216:219], v209 offset:0
    ds_read_b128 v[80:83], v59 offset:384
    s_waitcnt lgkmcnt(6)
    v_mfma_f32_16x16x32_bf16 v[20:23], v[172:175], v[84:87], v[20:23]
    ds_read_b128 v[84:87], v56 offset:768
    s_waitcnt lgkmcnt(6)
    v_mfma_f32_16x16x32_bf16 v[44:47], v[128:131], v[88:91], 0
    ds_read_b128 v[88:91], v57 offset:768
    s_waitcnt lgkmcnt(6)
    v_mfma_f32_16x16x32_bf16 v[44:47], v[132:135], v[92:95], v[44:47]
    ds_read_b128 v[92:95], v58 offset:768
    s_waitcnt lgkmcnt(6)
    v_mfma_f32_16x16x32_bf16 v[44:47], v[136:139], v[76:79], v[44:47]
    s_waitcnt lgkmcnt(5)
    buffer_store_dwordx4 v[212:215], v210, s[4:7], s23 offen offset:0 sc1
    ds_read_b128 v[76:79], v59 offset:768
    s_waitcnt lgkmcnt(4)
    v_mfma_f32_16x16x32_bf16 v[44:47], v[140:143], v[80:83], v[44:47]
    buffer_store_dwordx4 v[216:219], v210, s[4:7], s23 offen offset:1024 sc1
    ds_read_b128 v[80:83], v56 offset:896
    s_waitcnt lgkmcnt(4)
    v_mfma_f32_16x16x32_bf16 v[44:47], v[144:147], v[84:87], v[44:47]
    ds_read_b128 v[84:87], v57 offset:896
    s_waitcnt lgkmcnt(4)
    v_mfma_f32_16x16x32_bf16 v[44:47], v[148:151], v[88:91], v[44:47]
    ds_read_b128 v[88:91], v58 offset:896
    s_waitcnt lgkmcnt(4)
    v_mfma_f32_16x16x32_bf16 v[44:47], v[152:155], v[92:95], v[44:47]
    ds_read_b128 v[92:95], v59 offset:896
    s_waitcnt lgkmcnt(4)
    v_mfma_f32_16x16x32_bf16 v[44:47], v[156:159], v[76:79], v[44:47]
    v_cvt_pk_bf16_f32 v8, v8, v9
    v_cvt_pk_bf16_f32 v9, v10, v11
    s_waitcnt lgkmcnt(3)
    v_mfma_f32_16x16x32_bf16 v[44:47], v[160:163], v[80:83], v[44:47]
    ds_write_b64 v204, v[8:9] offset:0
    v_mul_f32 v20, v20, v200
    s_waitcnt lgkmcnt(3)
    v_mfma_f32_16x16x32_bf16 v[44:47], v[164:167], v[84:87], v[44:47]
    v_mul_f32 v21, v21, v201
    v_mul_f32 v22, v22, v202
    s_waitcnt lgkmcnt(2)
    v_mfma_f32_16x16x32_bf16 v[44:47], v[168:171], v[88:91], v[44:47]
    v_mul_f32 v23, v23, v203
    v_cvt_pk_bf16_f32 v20, v20, v21
    s_waitcnt lgkmcnt(1)
    v_mfma_f32_16x16x32_bf16 v[44:47], v[172:175], v[92:95], v[44:47]
    v_cvt_pk_bf16_f32 v21, v22, v23
    ds_write_b64 v220, v[20:21] offset:256
    s_nop 5
    v_mul_f32 v44, v44, v200
    v_mul_f32 v45, v45, v201
    v_mul_f32 v46, v46, v202
    v_mul_f32 v47, v47, v203
    v_cvt_pk_bf16_f32 v44, v44, v45
    v_cvt_pk_bf16_f32 v45, v46, v47
    ds_write_b64 v204, v[44:45] offset:768
    s_waitcnt lgkmcnt(0)
    s_barrier
    ds_read_b128 v[212:215], v211 offset:0
    s_waitcnt lgkmcnt(0)
    buffer_store_dwordx4 v[212:215], v210, s[4:7], s66 offen offset:0 sc1
    s_or_b32 s89, s89, s20
    s_cbranch_scc1 K2_end
    v_mov_b32 v0, 0
    v_mov_b32 v1, s88
    s_mov_b64 exec, 1
    buffer_store_dword v1, v0, s[16:19], 0 offen
K2_end:
K2_last:
    s_endpgm
SLOW:
    v_readlane_b32 s89, v4, 62
    s_waitcnt vmcnt(0) lgkmcnt(0)
    s_barrier
    s_load_dwordx2 s[22:23], s[0:1], 8
    s_load_dwordx2 s[24:25], s[0:1], 24
    s_load_dwordx2 s[26:27], s[0:1], 32
    s_load_dwordx2 s[28:29], s[0:1], 40
    s_load_dwordx2 s[30:31], s[0:1], 0
    v_mbcnt_lo_u32_b32 v240, -1, 0
    v_mbcnt_hi_u32_b32 v240, -1, v240
    v_lshrrev_b32 v229, 5, v240
    v_and_b32 v230, 31, v240
    v_lshlrev_b32 v241, 7, v229
    v_lshl_add_u32 v241, v230, 1, v241
    v_lshlrev_b32 v245, 4, v240
    v_mov_b32 v242, 0
    s_waitcnt lgkmcnt(0)
    s_mov_b32 s80, s22
    s_and_b32 s81, s23, 0xffff
    s_mov_b32 s82, 1920000
    s_mov_b32 s83, 0x20000
    s_mov_b32 s76, s24
    s_and_b32 s77, s25, 0xffff
    s_mov_b32 s78, 1280000
    s_mov_b32 s79, 0x20000
    s_mov_b32 s72, s26
    s_and_b32 s73, s27, 0xffff
    s_mov_b32 s74, 1280000
    s_mov_b32 s75, 0x20000
    s_mov_b32 s84, s28
    s_and_b32 s85, s29, 0xffff
    s_mov_b32 s86, 20480
    s_mov_b32 s87, 0x20000
    s_mov_b32 s4, s30
    s_and_b32 s5, s31, 0xffff
    s_mov_b32 s6, 10240000
    s_mov_b32 s7, 0x20000
    s_mov_b32 s66, 0
    buffer_load_ushort v0, v241, s[84:87], s66 offen offset:0
    buffer_load_ushort v1, v241, s[84:87], s66 offen offset:64
    buffer_load_ushort v2, v241, s[84:87], s66 offen offset:256
    buffer_load_ushort v3, v241, s[84:87], s66 offen offset:320
    buffer_load_ushort v4, v241, s[84:87], s66 offen offset:512
    buffer_load_ushort v5, v241, s[84:87], s66 offen offset:576
    buffer_load_ushort v6, v241, s[84:87], s66 offen offset:768
    buffer_load_ushort v7, v241, s[84:87], s66 offen offset:832
    buffer_load_ushort v8, v241, s[84:87], s66 offen offset:1024
    buffer_load_ushort v9, v241, s[84:87], s66 offen offset:1088
    s_waitcnt vmcnt(0)
    s_mov_b32 s66, 1280
    buffer_load_ushort v10, v241, s[84:87], s66 offen offset:0
    buffer_load_ushort v11, v241, s[84:87], s66 offen offset:64
    buffer_load_ushort v12, v241, s[84:87], s66 offen offset:256
    buffer_load_ushort v13, v241, s[84:87], s66 offen offset:320
    buffer_load_ushort v14, v241, s[84:87], s66 offen offset:512
    buffer_load_ushort v15, v241, s[84:87], s66 offen offset:576
    buffer_load_ushort v16, v241, s[84:87], s66 offen offset:768
    buffer_load_ushort v17, v241, s[84:87], s66 offen offset:832
    buffer_load_ushort v18, v241, s[84:87], s66 offen offset:1024
    buffer_load_ushort v19, v241, s[84:87], s66 offen offset:1088
    s_waitcnt vmcnt(0)
    s_mov_b32 s66, 2560
    buffer_load_ushort v20, v241, s[84:87], s66 offen offset:0
    buffer_load_ushort v21, v241, s[84:87], s66 offen offset:64
    buffer_load_ushort v22, v241, s[84:87], s66 offen offset:256
    buffer_load_ushort v23, v241, s[84:87], s66 offen offset:320
    buffer_load_ushort v24, v241, s[84:87], s66 offen offset:512
    buffer_load_ushort v25, v241, s[84:87], s66 offen offset:576
    buffer_load_ushort v26, v241, s[84:87], s66 offen offset:768
    buffer_load_ushort v27, v241, s[84:87], s66 offen offset:832
    buffer_load_ushort v28, v241, s[84:87], s66 offen offset:1024
    buffer_load_ushort v29, v241, s[84:87], s66 offen offset:1088
    s_waitcnt vmcnt(0)
    s_mov_b32 s66, 3840
    buffer_load_ushort v30, v241, s[84:87], s66 offen offset:0
    buffer_load_ushort v31, v241, s[84:87], s66 offen offset:64
    buffer_load_ushort v32, v241, s[84:87], s66 offen offset:256
    buffer_load_ushort v33, v241, s[84:87], s66 offen offset:320
    buffer_load_ushort v34, v241, s[84:87], s66 offen offset:512
    buffer_load_ushort v35, v241, s[84:87], s66 offen offset:576
    buffer_load_ushort v36, v241, s[84:87], s66 offen offset:768
    buffer_load_ushort v37, v241, s[84:87], s66 offen offset:832
    buffer_load_ushort v38, v241, s[84:87], s66 offen offset:1024
    buffer_load_ushort v39, v241, s[84:87], s66 offen offset:1088
    s_waitcnt vmcnt(0)
    s_mov_b32 s66, 5120
    buffer_load_ushort v40, v241, s[84:87], s66 offen offset:0
    buffer_load_ushort v41, v241, s[84:87], s66 offen offset:64
    buffer_load_ushort v42, v241, s[84:87], s66 offen offset:256
    buffer_load_ushort v43, v241, s[84:87], s66 offen offset:320
    buffer_load_ushort v44, v241, s[84:87], s66 offen offset:512
    buffer_load_ushort v45, v241, s[84:87], s66 offen offset:576
    buffer_load_ushort v46, v241, s[84:87], s66 offen offset:768
    buffer_load_ushort v47, v241, s[84:87], s66 offen offset:832
    buffer_load_ushort v48, v241, s[84:87], s66 offen offset:1024
    buffer_load_ushort v49, v241, s[84:87], s66 offen offset:1088
    s_waitcnt vmcnt(0)
    s_mov_b32 s66, 6400
    buffer_load_ushort v50, v241, s[84:87], s66 offen offset:0
    buffer_load_ushort v51, v241, s[84:87], s66 offen offset:64
    buffer_load_ushort v52, v241, s[84:87], s66 offen offset:256
    buffer_load_ushort v53, v241, s[84:87], s66 offen offset:320
    buffer_load_ushort v54, v241, s[84:87], s66 offen offset:512
    buffer_load_ushort v55, v241, s[84:87], s66 offen offset:576
    buffer_load_ushort v56, v241, s[84:87], s66 offen offset:768
    buffer_load_ushort v57, v241, s[84:87], s66 offen offset:832
    buffer_load_ushort v58, v241, s[84:87], s66 offen offset:1024
    buffer_load_ushort v59, v241, s[84:87], s66 offen offset:1088
    s_waitcnt vmcnt(0)
    s_mov_b32 s66, 7680
    buffer_load_ushort v60, v241, s[84:87], s66 offen offset:0
    buffer_load_ushort v61, v241, s[84:87], s66 offen offset:64
    buffer_load_ushort v62, v241, s[84:87], s66 offen offset:256
    buffer_load_ushort v63, v241, s[84:87], s66 offen offset:320
    buffer_load_ushort v64, v241, s[84:87], s66 offen offset:512
    buffer_load_ushort v65, v241, s[84:87], s66 offen offset:576
    buffer_load_ushort v66, v241, s[84:87], s66 offen offset:768
    buffer_load_ushort v67, v241, s[84:87], s66 offen offset:832
    buffer_load_ushort v68, v241, s[84:87], s66 offen offset:1024
    buffer_load_ushort v69, v241, s[84:87], s66 offen offset:1088
    s_waitcnt vmcnt(0)
    s_mov_b32 s66, 8960
    buffer_load_ushort v70, v241, s[84:87], s66 offen offset:0
    buffer_load_ushort v71, v241, s[84:87], s66 offen offset:64
    buffer_load_ushort v72, v241, s[84:87], s66 offen offset:256
    buffer_load_ushort v73, v241, s[84:87], s66 offen offset:320
    buffer_load_ushort v74, v241, s[84:87], s66 offen offset:512
    buffer_load_ushort v75, v241, s[84:87], s66 offen offset:576
    buffer_load_ushort v76, v241, s[84:87], s66 offen offset:768
    buffer_load_ushort v77, v241, s[84:87], s66 offen offset:832
    buffer_load_ushort v78, v241, s[84:87], s66 offen offset:1024
    buffer_load_ushort v79, v241, s[84:87], s66 offen offset:1088
    s_waitcnt vmcnt(0)
    s_mov_b32 s66, 10240
    buffer_load_ushort v80, v241, s[84:87], s66 offen offset:0
    buffer_load_ushort v81, v241, s[84:87], s66 offen offset:64
    buffer_load_ushort v82, v241, s[84:87], s66 offen offset:256
    buffer_load_ushort v83, v241, s[84:87], s66 offen offset:320
    buffer_load_ushort v84, v241, s[84:87], s66 offen offset:512
    buffer_load_ushort v85, v241, s[84:87], s66 offen offset:576
    buffer_load_ushort v86, v241, s[84:87], s66 offen offset:768
    buffer_load_ushort v87, v241, s[84:87], s66 offen offset:832
    buffer_load_ushort v88, v241, s[84:87], s66 offen offset:1024
    buffer_load_ushort v89, v241, s[84:87], s66 offen offset:1088
    s_waitcnt vmcnt(0)
    s_mov_b32 s66, 11520
    buffer_load_ushort v90, v241, s[84:87], s66 offen offset:0
    buffer_load_ushort v91, v241, s[84:87], s66 offen offset:64
    buffer_load_ushort v92, v241, s[84:87], s66 offen offset:256
    buffer_load_ushort v93, v241, s[84:87], s66 offen offset:320
    buffer_load_ushort v94, v241, s[84:87], s66 offen offset:512
    buffer_load_ushort v95, v241, s[84:87], s66 offen offset:576
    buffer_load_ushort v96, v241, s[84:87], s66 offen offset:768
    buffer_load_ushort v97, v241, s[84:87], s66 offen offset:832
    buffer_load_ushort v98, v241, s[84:87], s66 offen offset:1024
    buffer_load_ushort v99, v241, s[84:87], s66 offen offset:1088
    s_waitcnt vmcnt(0)
    s_mov_b32 s66, 12800
    buffer_load_ushort v100, v241, s[84:87], s66 offen offset:0
    buffer_load_ushort v101, v241, s[84:87], s66 offen offset:64
    buffer_load_ushort v102, v241, s[84:87], s66 offen offset:256
    buffer_load_ushort v103, v241, s[84:87], s66 offen offset:320
    buffer_load_ushort v104, v241, s[84:87], s66 offen offset:512
    buffer_load_ushort v105, v241, s[84:87], s66 offen offset:576
    buffer_load_ushort v106, v241, s[84:87], s66 offen offset:768
    buffer_load_ushort v107, v241, s[84:87], s66 offen offset:832
    buffer_load_ushort v108, v241, s[84:87], s66 offen offset:1024
    buffer_load_ushort v109, v241, s[84:87], s66 offen offset:1088
    s_waitcnt vmcnt(0)
    s_mov_b32 s66, 14080
    buffer_load_ushort v110, v241, s[84:87], s66 offen offset:0
    buffer_load_ushort v111, v241, s[84:87], s66 offen offset:64
    buffer_load_ushort v112, v241, s[84:87], s66 offen offset:256
    buffer_load_ushort v113, v241, s[84:87], s66 offen offset:320
    buffer_load_ushort v114, v241, s[84:87], s66 offen offset:512
    buffer_load_ushort v115, v241, s[84:87], s66 offen offset:576
    buffer_load_ushort v116, v241, s[84:87], s66 offen offset:768
    buffer_load_ushort v117, v241, s[84:87], s66 offen offset:832
    buffer_load_ushort v118, v241, s[84:87], s66 offen offset:1024
    buffer_load_ushort v119, v241, s[84:87], s66 offen offset:1088
    s_waitcnt vmcnt(0)
    s_mov_b32 s66, 15360
    buffer_load_ushort v120, v241, s[84:87], s66 offen offset:0
    buffer_load_ushort v121, v241, s[84:87], s66 offen offset:64
    buffer_load_ushort v122, v241, s[84:87], s66 offen offset:256
    buffer_load_ushort v123, v241, s[84:87], s66 offen offset:320
    buffer_load_ushort v124, v241, s[84:87], s66 offen offset:512
    buffer_load_ushort v125, v241, s[84:87], s66 offen offset:576
    buffer_load_ushort v126, v241, s[84:87], s66 offen offset:768
    buffer_load_ushort v127, v241, s[84:87], s66 offen offset:832
    buffer_load_ushort v128, v241, s[84:87], s66 offen offset:1024
    buffer_load_ushort v129, v241, s[84:87], s66 offen offset:1088
    s_waitcnt vmcnt(0)
    s_mov_b32 s66, 16640
    buffer_load_ushort v130, v241, s[84:87], s66 offen offset:0
    buffer_load_ushort v131, v241, s[84:87], s66 offen offset:64
    buffer_load_ushort v132, v241, s[84:87], s66 offen offset:256
    buffer_load_ushort v133, v241, s[84:87], s66 offen offset:320
    buffer_load_ushort v134, v241, s[84:87], s66 offen offset:512
    buffer_load_ushort v135, v241, s[84:87], s66 offen offset:576
    buffer_load_ushort v136, v241, s[84:87], s66 offen offset:768
    buffer_load_ushort v137, v241, s[84:87], s66 offen offset:832
    buffer_load_ushort v138, v241, s[84:87], s66 offen offset:1024
    buffer_load_ushort v139, v241, s[84:87], s66 offen offset:1088
    s_waitcnt vmcnt(0)
    s_mov_b32 s66, 17920
    buffer_load_ushort v140, v241, s[84:87], s66 offen offset:0
    buffer_load_ushort v141, v241, s[84:87], s66 offen offset:64
    buffer_load_ushort v142, v241, s[84:87], s66 offen offset:256
    buffer_load_ushort v143, v241, s[84:87], s66 offen offset:320
    buffer_load_ushort v144, v241, s[84:87], s66 offen offset:512
    buffer_load_ushort v145, v241, s[84:87], s66 offen offset:576
    buffer_load_ushort v146, v241, s[84:87], s66 offen offset:768
    buffer_load_ushort v147, v241, s[84:87], s66 offen offset:832
    buffer_load_ushort v148, v241, s[84:87], s66 offen offset:1024
    buffer_load_ushort v149, v241, s[84:87], s66 offen offset:1088
    s_waitcnt vmcnt(0)
    s_mov_b32 s66, 19200
    buffer_load_ushort v150, v241, s[84:87], s66 offen offset:0
    buffer_load_ushort v151, v241, s[84:87], s66 offen offset:64
    buffer_load_ushort v152, v241, s[84:87], s66 offen offset:256
    buffer_load_ushort v153, v241, s[84:87], s66 offen offset:320
    buffer_load_ushort v154, v241, s[84:87], s66 offen offset:512
    buffer_load_ushort v155, v241, s[84:87], s66 offen offset:576
    buffer_load_ushort v156, v241, s[84:87], s66 offen offset:768
    buffer_load_ushort v157, v241, s[84:87], s66 offen offset:832
    buffer_load_ushort v158, v241, s[84:87], s66 offen offset:1024
    buffer_load_ushort v159, v241, s[84:87], s66 offen offset:1088
    s_waitcnt vmcnt(0)
    v_lshlrev_b32 v0, 16, v0
    v_lshlrev_b32 v1, 16, v1
    v_lshlrev_b32 v2, 16, v2
    v_lshlrev_b32 v3, 16, v3
    v_lshlrev_b32 v4, 16, v4
    v_lshlrev_b32 v5, 16, v5
    v_lshlrev_b32 v6, 16, v6
    v_lshlrev_b32 v7, 16, v7
    v_lshlrev_b32 v8, 16, v8
    v_lshlrev_b32 v9, 16, v9
    v_lshlrev_b32 v10, 16, v10
    v_lshlrev_b32 v11, 16, v11
    v_lshlrev_b32 v12, 16, v12
    v_lshlrev_b32 v13, 16, v13
    v_lshlrev_b32 v14, 16, v14
    v_lshlrev_b32 v15, 16, v15
    v_lshlrev_b32 v16, 16, v16
    v_lshlrev_b32 v17, 16, v17
    v_lshlrev_b32 v18, 16, v18
    v_lshlrev_b32 v19, 16, v19
    v_lshlrev_b32 v20, 16, v20
    v_lshlrev_b32 v21, 16, v21
    v_lshlrev_b32 v22, 16, v22
    v_lshlrev_b32 v23, 16, v23
    v_lshlrev_b32 v24, 16, v24
    v_lshlrev_b32 v25, 16, v25
    v_lshlrev_b32 v26, 16, v26
    v_lshlrev_b32 v27, 16, v27
    v_lshlrev_b32 v28, 16, v28
    v_lshlrev_b32 v29, 16, v29
    v_lshlrev_b32 v30, 16, v30
    v_lshlrev_b32 v31, 16, v31
    v_lshlrev_b32 v32, 16, v32
    v_lshlrev_b32 v33, 16, v33
    v_lshlrev_b32 v34, 16, v34
    v_lshlrev_b32 v35, 16, v35
    v_lshlrev_b32 v36, 16, v36
    v_lshlrev_b32 v37, 16, v37
    v_lshlrev_b32 v38, 16, v38
    v_lshlrev_b32 v39, 16, v39
    v_lshlrev_b32 v40, 16, v40
    v_lshlrev_b32 v41, 16, v41
    v_lshlrev_b32 v42, 16, v42
    v_lshlrev_b32 v43, 16, v43
    v_lshlrev_b32 v44, 16, v44
    v_lshlrev_b32 v45, 16, v45
    v_lshlrev_b32 v46, 16, v46
    v_lshlrev_b32 v47, 16, v47
    v_lshlrev_b32 v48, 16, v48
    v_lshlrev_b32 v49, 16, v49
    v_lshlrev_b32 v50, 16, v50
    v_lshlrev_b32 v51, 16, v51
    v_lshlrev_b32 v52, 16, v52
    v_lshlrev_b32 v53, 16, v53
    v_lshlrev_b32 v54, 16, v54
    v_lshlrev_b32 v55, 16, v55
    v_lshlrev_b32 v56, 16, v56
    v_lshlrev_b32 v57, 16, v57
    v_lshlrev_b32 v58, 16, v58
    v_lshlrev_b32 v59, 16, v59
    v_lshlrev_b32 v60, 16, v60
    v_lshlrev_b32 v61, 16, v61
    v_lshlrev_b32 v62, 16, v62
    v_lshlrev_b32 v63, 16, v63
    v_lshlrev_b32 v64, 16, v64
    v_lshlrev_b32 v65, 16, v65
    v_lshlrev_b32 v66, 16, v66
    v_lshlrev_b32 v67, 16, v67
    v_lshlrev_b32 v68, 16, v68
    v_lshlrev_b32 v69, 16, v69
    v_lshlrev_b32 v70, 16, v70
    v_lshlrev_b32 v71, 16, v71
    v_lshlrev_b32 v72, 16, v72
    v_lshlrev_b32 v73, 16, v73
    v_lshlrev_b32 v74, 16, v74
    v_lshlrev_b32 v75, 16, v75
    v_lshlrev_b32 v76, 16, v76
    v_lshlrev_b32 v77, 16, v77
    v_lshlrev_b32 v78, 16, v78
    v_lshlrev_b32 v79, 16, v79
    v_lshlrev_b32 v80, 16, v80
    v_lshlrev_b32 v81, 16, v81
    v_lshlrev_b32 v82, 16, v82
    v_lshlrev_b32 v83, 16, v83
    v_lshlrev_b32 v84, 16, v84
    v_lshlrev_b32 v85, 16, v85
    v_lshlrev_b32 v86, 16, v86
    v_lshlrev_b32 v87, 16, v87
    v_lshlrev_b32 v88, 16, v88
    v_lshlrev_b32 v89, 16, v89
    v_lshlrev_b32 v90, 16, v90
    v_lshlrev_b32 v91, 16, v91
    v_lshlrev_b32 v92, 16, v92
    v_lshlrev_b32 v93, 16, v93
    v_lshlrev_b32 v94, 16, v94
    v_lshlrev_b32 v95, 16, v95
    v_lshlrev_b32 v96, 16, v96
    v_lshlrev_b32 v97, 16, v97
    v_lshlrev_b32 v98, 16, v98
    v_lshlrev_b32 v99, 16, v99
    v_lshlrev_b32 v100, 16, v100
    v_lshlrev_b32 v101, 16, v101
    v_lshlrev_b32 v102, 16, v102
    v_lshlrev_b32 v103, 16, v103
    v_lshlrev_b32 v104, 16, v104
    v_lshlrev_b32 v105, 16, v105
    v_lshlrev_b32 v106, 16, v106
    v_lshlrev_b32 v107, 16, v107
    v_lshlrev_b32 v108, 16, v108
    v_lshlrev_b32 v109, 16, v109
    v_lshlrev_b32 v110, 16, v110
    v_lshlrev_b32 v111, 16, v111
    v_lshlrev_b32 v112, 16, v112
    v_lshlrev_b32 v113, 16, v113
    v_lshlrev_b32 v114, 16, v114
    v_lshlrev_b32 v115, 16, v115
    v_lshlrev_b32 v116, 16, v116
    v_lshlrev_b32 v117, 16, v117
    v_lshlrev_b32 v118, 16, v118
    v_lshlrev_b32 v119, 16, v119
    v_lshlrev_b32 v120, 16, v120
    v_lshlrev_b32 v121, 16, v121
    v_lshlrev_b32 v122, 16, v122
    v_lshlrev_b32 v123, 16, v123
    v_lshlrev_b32 v124, 16, v124
    v_lshlrev_b32 v125, 16, v125
    v_lshlrev_b32 v126, 16, v126
    v_lshlrev_b32 v127, 16, v127
    v_lshlrev_b32 v128, 16, v128
    v_lshlrev_b32 v129, 16, v129
    v_lshlrev_b32 v130, 16, v130
    v_lshlrev_b32 v131, 16, v131
    v_lshlrev_b32 v132, 16, v132
    v_lshlrev_b32 v133, 16, v133
    v_lshlrev_b32 v134, 16, v134
    v_lshlrev_b32 v135, 16, v135
    v_lshlrev_b32 v136, 16, v136
    v_lshlrev_b32 v137, 16, v137
    v_lshlrev_b32 v138, 16, v138
    v_lshlrev_b32 v139, 16, v139
    v_lshlrev_b32 v140, 16, v140
    v_lshlrev_b32 v141, 16, v141
    v_lshlrev_b32 v142, 16, v142
    v_lshlrev_b32 v143, 16, v143
    v_lshlrev_b32 v144, 16, v144
    v_lshlrev_b32 v145, 16, v145
    v_lshlrev_b32 v146, 16, v146
    v_lshlrev_b32 v147, 16, v147
    v_lshlrev_b32 v148, 16, v148
    v_lshlrev_b32 v149, 16, v149
    v_lshlrev_b32 v150, 16, v150
    v_lshlrev_b32 v151, 16, v151
    v_lshlrev_b32 v152, 16, v152
    v_lshlrev_b32 v153, 16, v153
    v_lshlrev_b32 v154, 16, v154
    v_lshlrev_b32 v155, 16, v155
    v_lshlrev_b32 v156, 16, v156
    v_lshlrev_b32 v157, 16, v157
    v_lshlrev_b32 v158, 16, v158
    v_lshlrev_b32 v159, 16, v159
    s_mov_b32 s50, 0
SL_node:
    s_mul_i32 s34, s2, 40
    s_mul_i32 s66, s20, 5
    s_add_u32 s66, s66, s50
    s_add_u32 s34, s34, s66
    v_mov_b32 v160, 0
    v_mov_b32 v161, 0
    v_mov_b32 v162, 0
    v_mov_b32 v163, 0
    v_mov_b32 v164, 0
    v_mov_b32 v165, 0
    v_mov_b32 v166, 0
    v_mov_b32 v167, 0
    v_mov_b32 v168, 0
    v_mov_b32 v169, 0
    v_mov_b32 v170, 0
    v_mov_b32 v171, 0
    v_mov_b32 v172, 0
    v_mov_b32 v173, 0
    v_mov_b32 v174, 0
    v_mov_b32 v175, 0
    v_mov_b32 v176, 0
    v_mov_b32 v177, 0
    v_mov_b32 v178, 0
    v_mov_b32 v179, 0
    v_mov_b32 v180, 0
    v_mov_b32 v181, 0
    s_mov_b32 s35, 0
SL_scan:
    s_lshl_b32 s66, s35, 2
    buffer_load_dwordx4 v[236:239], v245, s[72:75], s66 offen
    s_waitcnt vmcnt(0)
    v_cmp_eq_u32 s[38:39], s34, v236
    v_cmp_eq_u32 s[40:41], s34, v237
    v_cmp_eq_u32 s[42:43], s34, v238
    v_cmp_eq_u32 s[44:45], s34, v239
    s_mov_b32 s36, 0
SL_bits:
    s_cmp_eq_u64 s[38:39], 0
    s_cbranch_scc1 SL_nexti
    s_ff1_i32_b64 s66, s[38:39]
    s_bitset0_b64 s[38:39], s66
    s_lshl_b32 s66, s66, 2
    s_add_u32 s37, s66, s36
    s_add_u32 s37, s37, s35
    s_lshl_b32 s66, s37, 2
    s_lshl_b32 s67, s37, 5
    s_mul_i32 s68, s37, 6
    buffer_load_dword v243, v242, s[76:79], s66 offen
    buffer_load_dwordx4 v[184:187], v242, s[12:15], s67 offen
    buffer_load_dwordx4 v[188:191], v242, s[12:15], s67 offen offset:16
    buffer_load_ushort v226, v242, s[80:83], s68 offen offset:0
    buffer_load_ushort v227, v242, s[80:83], s68 offen offset:2
    buffer_load_ushort v228, v242, s[80:83], s68 offen offset:4
    s_waitcnt vmcnt(5)
    v_lshl_add_u32 v243, v243, 10, v241
    buffer_load_ushort v208, v243, s[4:7], 0 offen offset:0
    buffer_load_ushort v209, v243, s[4:7], 0 offen offset:64
    buffer_load_ushort v210, v243, s[4:7], 0 offen offset:256
    buffer_load_ushort v211, v243, s[4:7], 0 offen offset:320
    buffer_load_ushort v212, v243, s[4:7], 0 offen offset:512
    buffer_load_ushort v213, v243, s[4:7], 0 offen offset:576
    buffer_load_ushort v214, v243, s[4:7], 0 offen offset:768
    buffer_load_ushort v215, v243, s[4:7], 0 offen offset:832
    s_waitcnt vmcnt(8)
    v_lshlrev_b32 v192, 16, v184
    v_and_b32 v193, 0xffff0000, v184
    v_lshlrev_b32 v194, 16, v185
    v_and_b32 v195, 0xffff0000, v185
    v_lshlrev_b32 v196, 16, v186
    v_and_b32 v197, 0xffff0000, v186
    v_lshlrev_b32 v198, 16, v187
    v_and_b32 v199, 0xffff0000, v187
    v_lshlrev_b32 v200, 16, v188
    v_and_b32 v201, 0xffff0000, v188
    v_lshlrev_b32 v202, 16, v189
    v_and_b32 v203, 0xffff0000, v189
    v_lshlrev_b32 v204, 16, v190
    v_and_b32 v205, 0xffff0000, v190
    v_lshlrev_b32 v206, 16, v191
    v_and_b32 v207, 0xffff0000, v191
    v_lshlrev_b32 v226, 16, v226
    v_lshlrev_b32 v227, 16, v227
    v_lshlrev_b32 v228, 16, v228
    v_mul_f32 v216, v192, v0
    v_mul_f32 v217, v192, v1
    v_mul_f32 v218, v192, v2
    v_mul_f32 v219, v192, v3
    v_mul_f32 v220, v192, v4
    v_mul_f32 v221, v192, v5
    v_mul_f32 v222, v192, v6
    v_mul_f32 v223, v192, v7
    v_mul_f32 v224, v192, v8
    v_mul_f32 v225, v192, v9
    v_fmac_f32 v216, v193, v10
    v_fmac_f32 v217, v193, v11
    v_fmac_f32 v218, v193, v12
    v_fmac_f32 v219, v193, v13
    v_fmac_f32 v220, v193, v14
    v_fmac_f32 v221, v193, v15
    v_fmac_f32 v222, v193, v16
    v_fmac_f32 v223, v193, v17
    v_fmac_f32 v224, v193, v18
    v_fmac_f32 v225, v193, v19
    v_fmac_f32 v216, v194, v20
    v_fmac_f32 v217, v194, v21
    v_fmac_f32 v218, v194, v22
    v_fmac_f32 v219, v194, v23
    v_fmac_f32 v220, v194, v24
    v_fmac_f32 v221, v194, v25
    v_fmac_f32 v222, v194, v26
    v_fmac_f32 v223, v194, v27
    v_fmac_f32 v224, v194, v28
    v_fmac_f32 v225, v194, v29
    v_fmac_f32 v216, v195, v30
    v_fmac_f32 v217, v195, v31
    v_fmac_f32 v218, v195, v32
    v_fmac_f32 v219, v195, v33
    v_fmac_f32 v220, v195, v34
    v_fmac_f32 v221, v195, v35
    v_fmac_f32 v222, v195, v36
    v_fmac_f32 v223, v195, v37
    v_fmac_f32 v224, v195, v38
    v_fmac_f32 v225, v195, v39
    v_fmac_f32 v216, v196, v40
    v_fmac_f32 v217, v196, v41
    v_fmac_f32 v218, v196, v42
    v_fmac_f32 v219, v196, v43
    v_fmac_f32 v220, v196, v44
    v_fmac_f32 v221, v196, v45
    v_fmac_f32 v222, v196, v46
    v_fmac_f32 v223, v196, v47
    v_fmac_f32 v224, v196, v48
    v_fmac_f32 v225, v196, v49
    v_fmac_f32 v216, v197, v50
    v_fmac_f32 v217, v197, v51
    v_fmac_f32 v218, v197, v52
    v_fmac_f32 v219, v197, v53
    v_fmac_f32 v220, v197, v54
    v_fmac_f32 v221, v197, v55
    v_fmac_f32 v222, v197, v56
    v_fmac_f32 v223, v197, v57
    v_fmac_f32 v224, v197, v58
    v_fmac_f32 v225, v197, v59
    v_fmac_f32 v216, v198, v60
    v_fmac_f32 v217, v198, v61
    v_fmac_f32 v218, v198, v62
    v_fmac_f32 v219, v198, v63
    v_fmac_f32 v220, v198, v64
    v_fmac_f32 v221, v198, v65
    v_fmac_f32 v222, v198, v66
    v_fmac_f32 v223, v198, v67
    v_fmac_f32 v224, v198, v68
    v_fmac_f32 v225, v198, v69
    v_fmac_f32 v216, v199, v70
    v_fmac_f32 v217, v199, v71
    v_fmac_f32 v218, v199, v72
    v_fmac_f32 v219, v199, v73
    v_fmac_f32 v220, v199, v74
    v_fmac_f32 v221, v199, v75
    v_fmac_f32 v222, v199, v76
    v_fmac_f32 v223, v199, v77
    v_fmac_f32 v224, v199, v78
    v_fmac_f32 v225, v199, v79
    v_fmac_f32 v216, v200, v80
    v_fmac_f32 v217, v200, v81
    v_fmac_f32 v218, v200, v82
    v_fmac_f32 v219, v200, v83
    v_fmac_f32 v220, v200, v84
    v_fmac_f32 v221, v200, v85
    v_fmac_f32 v222, v200, v86
    v_fmac_f32 v223, v200, v87
    v_fmac_f32 v224, v200, v88
    v_fmac_f32 v225, v200, v89
    v_fmac_f32 v216, v201, v90
    v_fmac_f32 v217, v201, v91
    v_fmac_f32 v218, v201, v92
    v_fmac_f32 v219, v201, v93
    v_fmac_f32 v220, v201, v94
    v_fmac_f32 v221, v201, v95
    v_fmac_f32 v222, v201, v96
    v_fmac_f32 v223, v201, v97
    v_fmac_f32 v224, v201, v98
    v_fmac_f32 v225, v201, v99
    v_fmac_f32 v216, v202, v100
    v_fmac_f32 v217, v202, v101
    v_fmac_f32 v218, v202, v102
    v_fmac_f32 v219, v202, v103
    v_fmac_f32 v220, v202, v104
    v_fmac_f32 v221, v202, v105
    v_fmac_f32 v222, v202, v106
    v_fmac_f32 v223, v202, v107
    v_fmac_f32 v224, v202, v108
    v_fmac_f32 v225, v202, v109
    v_fmac_f32 v216, v203, v110
    v_fmac_f32 v217, v203, v111
    v_fmac_f32 v218, v203, v112
    v_fmac_f32 v219, v203, v113
    v_fmac_f32 v220, v203, v114
    v_fmac_f32 v221, v203, v115
    v_fmac_f32 v222, v203, v116
    v_fmac_f32 v223, v203, v117
    v_fmac_f32 v224, v203, v118
    v_fmac_f32 v225, v203, v119
    v_fmac_f32 v216, v204, v120
    v_fmac_f32 v217, v204, v121
    v_fmac_f32 v218, v204, v122
    v_fmac_f32 v219, v204, v123
    v_fmac_f32 v220, v204, v124
    v_fmac_f32 v221, v204, v125
    v_fmac_f32 v222, v204, v126
    v_fmac_f32 v223, v204, v127
    v_fmac_f32 v224, v204, v128
    v_fmac_f32 v225, v204, v129
    v_fmac_f32 v216, v205, v130
    v_fmac_f32 v217, v205, v131
    v_fmac_f32 v218, v205, v132
    v_fmac_f32 v219, v205, v133
    v_fmac_f32 v220, v205, v134
    v_fmac_f32 v221, v205, v135
    v_fmac_f32 v222, v205, v136
    v_fmac_f32 v223, v205, v137
    v_fmac_f32 v224, v205, v138
    v_fmac_f32 v225, v205, v139
    v_fmac_f32 v216, v206, v140
    v_fmac_f32 v217, v206, v141
    v_fmac_f32 v218, v206, v142
    v_fmac_f32 v219, v206, v143
    v_fmac_f32 v220, v206, v144
    v_fmac_f32 v221, v206, v145
    v_fmac_f32 v222, v206, v146
    v_fmac_f32 v223, v206, v147
    v_fmac_f32 v224, v206, v148
    v_fmac_f32 v225, v206, v149
    v_fmac_f32 v216, v207, v150
    v_fmac_f32 v217, v207, v151
    v_fmac_f32 v218, v207, v152
    v_fmac_f32 v219, v207, v153
    v_fmac_f32 v220, v207, v154
    v_fmac_f32 v221, v207, v155
    v_fmac_f32 v222, v207, v156
    v_fmac_f32 v223, v207, v157
    v_fmac_f32 v224, v207, v158
    v_fmac_f32 v225, v207, v159
    s_waitcnt vmcnt(0)
    v_lshlrev_b32 v208, 16, v208
    v_lshlrev_b32 v209, 16, v209
    v_lshlrev_b32 v210, 16, v210
    v_lshlrev_b32 v211, 16, v211
    v_lshlrev_b32 v212, 16, v212
    v_lshlrev_b32 v213, 16, v213
    v_lshlrev_b32 v214, 16, v214
    v_lshlrev_b32 v215, 16, v215
    v_fmac_f32 v160, v208, v216
    v_mul_f32 v229, v210, v226
    v_fmac_f32 v229, v212, v227
    v_fmac_f32 v229, v214, v228
    v_fmac_f32 v176, v229, v218
    v_mul_f32 v229, v208, v220
    v_fmac_f32 v162, v229, v226
    v_fmac_f32 v168, v210, v222
    v_mul_f32 v230, v227, v214
    v_fma_f32 v230, -v228, v212, v230
    v_fmac_f32 v178, v230, v224
    v_fmac_f32 v164, v229, v227
    v_fmac_f32 v170, v212, v222
    v_mul_f32 v230, v228, v210
    v_fma_f32 v230, -v226, v214, v230
    v_fmac_f32 v180, v230, v224
    v_fmac_f32 v166, v229, v228
    v_fmac_f32 v172, v214, v222
    v_mul_f32 v230, v226, v212
    v_fma_f32 v230, -v227, v210, v230
    v_fmac_f32 v174, v230, v224
    v_fmac_f32 v161, v209, v217
    v_mul_f32 v229, v211, v226
    v_fmac_f32 v229, v213, v227
    v_fmac_f32 v229, v215, v228
    v_fmac_f32 v177, v229, v219
    v_mul_f32 v229, v209, v221
    v_fmac_f32 v163, v229, v226
    v_fmac_f32 v169, v211, v223
    v_mul_f32 v230, v227, v215
    v_fma_f32 v230, -v228, v213, v230
    v_fmac_f32 v179, v230, v225
    v_fmac_f32 v165, v229, v227
    v_fmac_f32 v171, v213, v223
    v_mul_f32 v230, v228, v211
    v_fma_f32 v230, -v226, v215, v230
    v_fmac_f32 v181, v230, v225
    v_fmac_f32 v167, v229, v228
    v_fmac_f32 v173, v215, v223
    v_mul_f32 v230, v226, v213
    v_fma_f32 v230, -v227, v211, v230
    v_fmac_f32 v175, v230, v225
    s_branch SL_bits
SL_nexti:
    s_mov_b64 s[38:39], s[40:41]
    s_mov_b64 s[40:41], s[42:43]
    s_mov_b64 s[42:43], s[44:45]
    s_add_u32 s36, s36, 1
    s_cmp_lt_u32 s36, 4
    s_cbranch_scc1 SL_bits
    s_add_u32 s35, s35, 256
    s_cmp_lt_u32 s35, 320000
    s_cbranch_scc1 SL_scan
    s_mul_i32 s66, s20, 5
    s_add_u32 s66, s66, s50
    s_lshl_b32 s67, s66, 4
    s_and_b32 s68, s67, 128
    s_and_b32 s67, s67, 0x70
    s_mul_i32 s69, s50, 1536
    s_add_u32 s69, s69, s21
    s_add_u32 s69, s69, s68
    s_mul_i32 s70, s66, 1536
    s_add_u32 s70, s70, 86016
    s_add_u32 s70, s70, s68
    v_mov_b32 v230, s69
    v_mov_b32 v231, s70
    v_cmp_gt_u32 vcc, 32, v240
    v_and_b32 v229, 31, v240
    v_lshlrev_b32 v229, 2, v229
    v_xor_b32 v229, s67, v229
    v_cndmask_b32 v244, v231, v230, vcc
    v_add_u32 v244, v244, v229
    v_cvt_pk_bf16_f32 v160, v160, v161
    ds_write_b32 v244, v160 offset:0
    v_cvt_pk_bf16_f32 v162, v162, v163
    ds_write_b32 v244, v162 offset:128
    v_cvt_pk_bf16_f32 v164, v164, v165
    ds_write_b32 v244, v164 offset:256
    v_cvt_pk_bf16_f32 v166, v166, v167
    ds_write_b32 v244, v166 offset:384
    v_cvt_pk_bf16_f32 v168, v168, v169
    ds_write_b32 v244, v168 offset:512
    v_cvt_pk_bf16_f32 v170, v170, v171
    ds_write_b32 v244, v170 offset:640
    v_cvt_pk_bf16_f32 v172, v172, v173
    ds_write_b32 v244, v172 offset:768
    v_cvt_pk_bf16_f32 v174, v174, v175
    ds_write_b32 v244, v174 offset:896
    v_cvt_pk_bf16_f32 v176, v176, v177
    ds_write_b32 v244, v176 offset:1024
    v_cvt_pk_bf16_f32 v178, v178, v179
    ds_write_b32 v244, v178 offset:1152
    v_cvt_pk_bf16_f32 v180, v180, v181
    ds_write_b32 v244, v180 offset:1280
    s_lshl_b32 s66, s66, 3
    s_add_u32 s66, s66, 163328
    v_mov_b32 v229, s66
    ds_write_b64 v229, v[230:231]
    s_add_u32 s50, s50, 1
    s_cmp_lt_u32 s50, 5
    s_cbranch_scc1 SL_node
    s_waitcnt lgkmcnt(0)
    s_barrier
    v_mov_b32 v176, v240
    s_load_dwordx4 s[84:87], s[0:1], 48
    s_mul_i32 s22, s20, 20
    s_waitcnt lgkmcnt(0)
    s_mul_i32 s24, s22, 3277
    s_lshr_b32 s24, s24, 16
    s_mul_i32 s68, s24, 20
    s_sub_u32 s68, s22, s68
    s_cmp_lt_u32 s68, 8
    s_cselect_b64 s[66:67], s[84:85], s[86:87]
    s_cselect_b32 s25, 0, 8
    s_sub_u32 s68, s68, s25
    s_and_b32 s25, s68, 1
    s_lshr_b32 s68, s68, 1
    s_lshl_b32 s68, s68, 14
    s_lshl_b32 s25, s25, 12
    s_add_u32 s68, s68, s25
    s_lshl_b32 s24, s24, 5
    s_add_u32 s68, s68, s24
    v_lshrrev_b32 v2, 4, v176
    v_lshlrev_b32 v2, 10, v2
    v_and_b32 v3, 15, v176
    v_lshl_add_u32 v2, v3, 1, v2
    v_add_u32 v2, s68, v2
    v_add_u32 v3, 8192, v2
    v_mov_b32 v4, 0
    v_mov_b32 v5, 0
    v_mov_b32 v6, 0
    v_mov_b32 v7, 0
    global_load_ushort v96, v2, s[66:67] offset:0
    global_load_short_d16_hi v4, v3, s[66:67] offset:0
    global_load_ushort v97, v2, s[66:67] offset:256
    global_load_short_d16_hi v5, v3, s[66:67] offset:256
    global_load_ushort v98, v2, s[66:67] offset:512
    global_load_short_d16_hi v6, v3, s[66:67] offset:512
    global_load_ushort v99, v2, s[66:67] offset:768
    global_load_short_d16_hi v7, v3, s[66:67] offset:768
    s_add_u32 s22, s22, 1
    s_waitcnt vmcnt(0)
    v_or_b32 v96, v96, v4
    v_or_b32 v97, v97, v5
    v_or_b32 v98, v98, v6
    v_or_b32 v99, v99, v7
    s_mul_i32 s24, s22, 3277
    s_lshr_b32 s24, s24, 16
    s_mul_i32 s68, s24, 20
    s_sub_u32 s68, s22, s68
    s_cmp_lt_u32 s68, 8
    s_cselect_b64 s[66:67], s[84:85], s[86:87]
    s_cselect_b32 s25, 0, 8
    s_sub_u32 s68, s68, s25
    s_and_b32 s25, s68, 1
    s_lshr_b32 s68, s68, 1
    s_lshl_b32 s68, s68, 14
    s_lshl_b32 s25, s25, 12
    s_add_u32 s68, s68, s25
    s_lshl_b32 s24, s24, 5
    s_add_u32 s68, s68, s24
    v_lshrrev_b32 v2, 4, v176
    v_lshlrev_b32 v2, 10, v2
    v_and_b32 v3, 15, v176
    v_lshl_add_u32 v2, v3, 1, v2
    v_add_u32 v2, s68, v2
    v_add_u32 v3, 8192, v2
    v_mov_b32 v4, 0
    v_mov_b32 v5, 0
    v_mov_b32 v6, 0
    v_mov_b32 v7, 0
    global_load_ushort v100, v2, s[66:67] offset:0
    global_load_short_d16_hi v4, v3, s[66:67] offset:0
    global_load_ushort v101, v2, s[66:67] offset:256
    global_load_short_d16_hi v5, v3, s[66:67] offset:256
    global_load_ushort v102, v2, s[66:67] offset:512
    global_load_short_d16_hi v6, v3, s[66:67] offset:512
    global_load_ushort v103, v2, s[66:67] offset:768
    global_load_short_d16_hi v7, v3, s[66:67] offset:768
    s_add_u32 s22, s22, 1
    s_waitcnt vmcnt(0)
    v_or_b32 v100, v100, v4
    v_or_b32 v101, v101, v5
    v_or_b32 v102, v102, v6
    v_or_b32 v103, v103, v7
    s_mul_i32 s24, s22, 3277
    s_lshr_b32 s24, s24, 16
    s_mul_i32 s68, s24, 20
    s_sub_u32 s68, s22, s68
    s_cmp_lt_u32 s68, 8
    s_cselect_b64 s[66:67], s[84:85], s[86:87]
    s_cselect_b32 s25, 0, 8
    s_sub_u32 s68, s68, s25
    s_and_b32 s25, s68, 1
    s_lshr_b32 s68, s68, 1
    s_lshl_b32 s68, s68, 14
    s_lshl_b32 s25, s25, 12
    s_add_u32 s68, s68, s25
    s_lshl_b32 s24, s24, 5
    s_add_u32 s68, s68, s24
    v_lshrrev_b32 v2, 4, v176
    v_lshlrev_b32 v2, 10, v2
    v_and_b32 v3, 15, v176
    v_lshl_add_u32 v2, v3, 1, v2
    v_add_u32 v2, s68, v2
    v_add_u32 v3, 8192, v2
    v_mov_b32 v4, 0
    v_mov_b32 v5, 0
    v_mov_b32 v6, 0
    v_mov_b32 v7, 0
    global_load_ushort v104, v2, s[66:67] offset:0
    global_load_short_d16_hi v4, v3, s[66:67] offset:0
    global_load_ushort v105, v2, s[66:67] offset:256
    global_load_short_d16_hi v5, v3, s[66:67] offset:256
    global_load_ushort v106, v2, s[66:67] offset:512
    global_load_short_d16_hi v6, v3, s[66:67] offset:512
    global_load_ushort v107, v2, s[66:67] offset:768
    global_load_short_d16_hi v7, v3, s[66:67] offset:768
    s_add_u32 s22, s22, 1
    s_waitcnt vmcnt(0)
    v_or_b32 v104, v104, v4
    v_or_b32 v105, v105, v5
    v_or_b32 v106, v106, v6
    v_or_b32 v107, v107, v7
    s_mul_i32 s24, s22, 3277
    s_lshr_b32 s24, s24, 16
    s_mul_i32 s68, s24, 20
    s_sub_u32 s68, s22, s68
    s_cmp_lt_u32 s68, 8
    s_cselect_b64 s[66:67], s[84:85], s[86:87]
    s_cselect_b32 s25, 0, 8
    s_sub_u32 s68, s68, s25
    s_and_b32 s25, s68, 1
    s_lshr_b32 s68, s68, 1
    s_lshl_b32 s68, s68, 14
    s_lshl_b32 s25, s25, 12
    s_add_u32 s68, s68, s25
    s_lshl_b32 s24, s24, 5
    s_add_u32 s68, s68, s24
    v_lshrrev_b32 v2, 4, v176
    v_lshlrev_b32 v2, 10, v2
    v_and_b32 v3, 15, v176
    v_lshl_add_u32 v2, v3, 1, v2
    v_add_u32 v2, s68, v2
    v_add_u32 v3, 8192, v2
    v_mov_b32 v4, 0
    v_mov_b32 v5, 0
    v_mov_b32 v6, 0
    v_mov_b32 v7, 0
    global_load_ushort v108, v2, s[66:67] offset:0
    global_load_short_d16_hi v4, v3, s[66:67] offset:0
    global_load_ushort v109, v2, s[66:67] offset:256
    global_load_short_d16_hi v5, v3, s[66:67] offset:256
    global_load_ushort v110, v2, s[66:67] offset:512
    global_load_short_d16_hi v6, v3, s[66:67] offset:512
    global_load_ushort v111, v2, s[66:67] offset:768
    global_load_short_d16_hi v7, v3, s[66:67] offset:768
    s_add_u32 s22, s22, 1
    s_waitcnt vmcnt(0)
    v_or_b32 v108, v108, v4
    v_or_b32 v109, v109, v5
    v_or_b32 v110, v110, v6
    v_or_b32 v111, v111, v7
    s_mul_i32 s24, s22, 3277
    s_lshr_b32 s24, s24, 16
    s_mul_i32 s68, s24, 20
    s_sub_u32 s68, s22, s68
    s_cmp_lt_u32 s68, 8
    s_cselect_b64 s[66:67], s[84:85], s[86:87]
    s_cselect_b32 s25, 0, 8
    s_sub_u32 s68, s68, s25
    s_and_b32 s25, s68, 1
    s_lshr_b32 s68, s68, 1
    s_lshl_b32 s68, s68, 14
    s_lshl_b32 s25, s25, 12
    s_add_u32 s68, s68, s25
    s_lshl_b32 s24, s24, 5
    s_add_u32 s68, s68, s24
    v_lshrrev_b32 v2, 4, v176
    v_lshlrev_b32 v2, 10, v2
    v_and_b32 v3, 15, v176
    v_lshl_add_u32 v2, v3, 1, v2
    v_add_u32 v2, s68, v2
    v_add_u32 v3, 8192, v2
    v_mov_b32 v4, 0
    v_mov_b32 v5, 0
    v_mov_b32 v6, 0
    v_mov_b32 v7, 0
    global_load_ushort v112, v2, s[66:67] offset:0
    global_load_short_d16_hi v4, v3, s[66:67] offset:0
    global_load_ushort v113, v2, s[66:67] offset:256
    global_load_short_d16_hi v5, v3, s[66:67] offset:256
    global_load_ushort v114, v2, s[66:67] offset:512
    global_load_short_d16_hi v6, v3, s[66:67] offset:512
    global_load_ushort v115, v2, s[66:67] offset:768
    global_load_short_d16_hi v7, v3, s[66:67] offset:768
    s_add_u32 s22, s22, 1
    s_waitcnt vmcnt(0)
    v_or_b32 v112, v112, v4
    v_or_b32 v113, v113, v5
    v_or_b32 v114, v114, v6
    v_or_b32 v115, v115, v7
    s_mul_i32 s24, s22, 3277
    s_lshr_b32 s24, s24, 16
    s_mul_i32 s68, s24, 20
    s_sub_u32 s68, s22, s68
    s_cmp_lt_u32 s68, 8
    s_cselect_b64 s[66:67], s[84:85], s[86:87]
    s_cselect_b32 s25, 0, 8
    s_sub_u32 s68, s68, s25
    s_and_b32 s25, s68, 1
    s_lshr_b32 s68, s68, 1
    s_lshl_b32 s68, s68, 14
    s_lshl_b32 s25, s25, 12
    s_add_u32 s68, s68, s25
    s_lshl_b32 s24, s24, 5
    s_add_u32 s68, s68, s24
    v_lshrrev_b32 v2, 4, v176
    v_lshlrev_b32 v2, 10, v2
    v_and_b32 v3, 15, v176
    v_lshl_add_u32 v2, v3, 1, v2
    v_add_u32 v2, s68, v2
    v_add_u32 v3, 8192, v2
    v_mov_b32 v4, 0
    v_mov_b32 v5, 0
    v_mov_b32 v6, 0
    v_mov_b32 v7, 0
    global_load_ushort v116, v2, s[66:67] offset:0
    global_load_short_d16_hi v4, v3, s[66:67] offset:0
    global_load_ushort v117, v2, s[66:67] offset:256
    global_load_short_d16_hi v5, v3, s[66:67] offset:256
    global_load_ushort v118, v2, s[66:67] offset:512
    global_load_short_d16_hi v6, v3, s[66:67] offset:512
    global_load_ushort v119, v2, s[66:67] offset:768
    global_load_short_d16_hi v7, v3, s[66:67] offset:768
    s_add_u32 s22, s22, 1
    s_waitcnt vmcnt(0)
    v_or_b32 v116, v116, v4
    v_or_b32 v117, v117, v5
    v_or_b32 v118, v118, v6
    v_or_b32 v119, v119, v7
    s_mul_i32 s24, s22, 3277
    s_lshr_b32 s24, s24, 16
    s_mul_i32 s68, s24, 20
    s_sub_u32 s68, s22, s68
    s_cmp_lt_u32 s68, 8
    s_cselect_b64 s[66:67], s[84:85], s[86:87]
    s_cselect_b32 s25, 0, 8
    s_sub_u32 s68, s68, s25
    s_and_b32 s25, s68, 1
    s_lshr_b32 s68, s68, 1
    s_lshl_b32 s68, s68, 14
    s_lshl_b32 s25, s25, 12
    s_add_u32 s68, s68, s25
    s_lshl_b32 s24, s24, 5
    s_add_u32 s68, s68, s24
    v_lshrrev_b32 v2, 4, v176
    v_lshlrev_b32 v2, 10, v2
    v_and_b32 v3, 15, v176
    v_lshl_add_u32 v2, v3, 1, v2
    v_add_u32 v2, s68, v2
    v_add_u32 v3, 8192, v2
    v_mov_b32 v4, 0
    v_mov_b32 v5, 0
    v_mov_b32 v6, 0
    v_mov_b32 v7, 0
    global_load_ushort v120, v2, s[66:67] offset:0
    global_load_short_d16_hi v4, v3, s[66:67] offset:0
    global_load_ushort v121, v2, s[66:67] offset:256
    global_load_short_d16_hi v5, v3, s[66:67] offset:256
    global_load_ushort v122, v2, s[66:67] offset:512
    global_load_short_d16_hi v6, v3, s[66:67] offset:512
    global_load_ushort v123, v2, s[66:67] offset:768
    global_load_short_d16_hi v7, v3, s[66:67] offset:768
    s_add_u32 s22, s22, 1
    s_waitcnt vmcnt(0)
    v_or_b32 v120, v120, v4
    v_or_b32 v121, v121, v5
    v_or_b32 v122, v122, v6
    v_or_b32 v123, v123, v7
    s_mul_i32 s24, s22, 3277
    s_lshr_b32 s24, s24, 16
    s_mul_i32 s68, s24, 20
    s_sub_u32 s68, s22, s68
    s_cmp_lt_u32 s68, 8
    s_cselect_b64 s[66:67], s[84:85], s[86:87]
    s_cselect_b32 s25, 0, 8
    s_sub_u32 s68, s68, s25
    s_and_b32 s25, s68, 1
    s_lshr_b32 s68, s68, 1
    s_lshl_b32 s68, s68, 14
    s_lshl_b32 s25, s25, 12
    s_add_u32 s68, s68, s25
    s_lshl_b32 s24, s24, 5
    s_add_u32 s68, s68, s24
    v_lshrrev_b32 v2, 4, v176
    v_lshlrev_b32 v2, 10, v2
    v_and_b32 v3, 15, v176
    v_lshl_add_u32 v2, v3, 1, v2
    v_add_u32 v2, s68, v2
    v_add_u32 v3, 8192, v2
    v_mov_b32 v4, 0
    v_mov_b32 v5, 0
    v_mov_b32 v6, 0
    v_mov_b32 v7, 0
    global_load_ushort v124, v2, s[66:67] offset:0
    global_load_short_d16_hi v4, v3, s[66:67] offset:0
    global_load_ushort v125, v2, s[66:67] offset:256
    global_load_short_d16_hi v5, v3, s[66:67] offset:256
    global_load_ushort v126, v2, s[66:67] offset:512
    global_load_short_d16_hi v6, v3, s[66:67] offset:512
    global_load_ushort v127, v2, s[66:67] offset:768
    global_load_short_d16_hi v7, v3, s[66:67] offset:768
    s_add_u32 s22, s22, 1
    s_waitcnt vmcnt(0)
    v_or_b32 v124, v124, v4
    v_or_b32 v125, v125, v5
    v_or_b32 v126, v126, v6
    v_or_b32 v127, v127, v7
    s_mul_i32 s24, s22, 3277
    s_lshr_b32 s24, s24, 16
    s_mul_i32 s68, s24, 20
    s_sub_u32 s68, s22, s68
    s_cmp_lt_u32 s68, 8
    s_cselect_b64 s[66:67], s[84:85], s[86:87]
    s_cselect_b32 s25, 0, 8
    s_sub_u32 s68, s68, s25
    s_and_b32 s25, s68, 1
    s_lshr_b32 s68, s68, 1
    s_lshl_b32 s68, s68, 14
    s_lshl_b32 s25, s25, 12
    s_add_u32 s68, s68, s25
    s_lshl_b32 s24, s24, 5
    s_add_u32 s68, s68, s24
    v_lshrrev_b32 v2, 4, v176
    v_lshlrev_b32 v2, 10, v2
    v_and_b32 v3, 15, v176
    v_lshl_add_u32 v2, v3, 1, v2
    v_add_u32 v2, s68, v2
    v_add_u32 v3, 8192, v2
    v_mov_b32 v4, 0
    v_mov_b32 v5, 0
    v_mov_b32 v6, 0
    v_mov_b32 v7, 0
    global_load_ushort v128, v2, s[66:67] offset:0
    global_load_short_d16_hi v4, v3, s[66:67] offset:0
    global_load_ushort v129, v2, s[66:67] offset:256
    global_load_short_d16_hi v5, v3, s[66:67] offset:256
    global_load_ushort v130, v2, s[66:67] offset:512
    global_load_short_d16_hi v6, v3, s[66:67] offset:512
    global_load_ushort v131, v2, s[66:67] offset:768
    global_load_short_d16_hi v7, v3, s[66:67] offset:768
    s_add_u32 s22, s22, 1
    s_waitcnt vmcnt(0)
    v_or_b32 v128, v128, v4
    v_or_b32 v129, v129, v5
    v_or_b32 v130, v130, v6
    v_or_b32 v131, v131, v7
    s_mul_i32 s24, s22, 3277
    s_lshr_b32 s24, s24, 16
    s_mul_i32 s68, s24, 20
    s_sub_u32 s68, s22, s68
    s_cmp_lt_u32 s68, 8
    s_cselect_b64 s[66:67], s[84:85], s[86:87]
    s_cselect_b32 s25, 0, 8
    s_sub_u32 s68, s68, s25
    s_and_b32 s25, s68, 1
    s_lshr_b32 s68, s68, 1
    s_lshl_b32 s68, s68, 14
    s_lshl_b32 s25, s25, 12
    s_add_u32 s68, s68, s25
    s_lshl_b32 s24, s24, 5
    s_add_u32 s68, s68, s24
    v_lshrrev_b32 v2, 4, v176
    v_lshlrev_b32 v2, 10, v2
    v_and_b32 v3, 15, v176
    v_lshl_add_u32 v2, v3, 1, v2
    v_add_u32 v2, s68, v2
    v_add_u32 v3, 8192, v2
    v_mov_b32 v4, 0
    v_mov_b32 v5, 0
    v_mov_b32 v6, 0
    v_mov_b32 v7, 0
    global_load_ushort v132, v2, s[66:67] offset:0
    global_load_short_d16_hi v4, v3, s[66:67] offset:0
    global_load_ushort v133, v2, s[66:67] offset:256
    global_load_short_d16_hi v5, v3, s[66:67] offset:256
    global_load_ushort v134, v2, s[66:67] offset:512
    global_load_short_d16_hi v6, v3, s[66:67] offset:512
    global_load_ushort v135, v2, s[66:67] offset:768
    global_load_short_d16_hi v7, v3, s[66:67] offset:768
    s_add_u32 s22, s22, 1
    s_waitcnt vmcnt(0)
    v_or_b32 v132, v132, v4
    v_or_b32 v133, v133, v5
    v_or_b32 v134, v134, v6
    v_or_b32 v135, v135, v7
    s_mul_i32 s24, s22, 3277
    s_lshr_b32 s24, s24, 16
    s_mul_i32 s68, s24, 20
    s_sub_u32 s68, s22, s68
    s_cmp_lt_u32 s68, 8
    s_cselect_b64 s[66:67], s[84:85], s[86:87]
    s_cselect_b32 s25, 0, 8
    s_sub_u32 s68, s68, s25
    s_and_b32 s25, s68, 1
    s_lshr_b32 s68, s68, 1
    s_lshl_b32 s68, s68, 14
    s_lshl_b32 s25, s25, 12
    s_add_u32 s68, s68, s25
    s_lshl_b32 s24, s24, 5
    s_add_u32 s68, s68, s24
    v_lshrrev_b32 v2, 4, v176
    v_lshlrev_b32 v2, 10, v2
    v_and_b32 v3, 15, v176
    v_lshl_add_u32 v2, v3, 1, v2
    v_add_u32 v2, s68, v2
    v_add_u32 v3, 8192, v2
    v_mov_b32 v4, 0
    v_mov_b32 v5, 0
    v_mov_b32 v6, 0
    v_mov_b32 v7, 0
    global_load_ushort v136, v2, s[66:67] offset:0
    global_load_short_d16_hi v4, v3, s[66:67] offset:0
    global_load_ushort v137, v2, s[66:67] offset:256
    global_load_short_d16_hi v5, v3, s[66:67] offset:256
    global_load_ushort v138, v2, s[66:67] offset:512
    global_load_short_d16_hi v6, v3, s[66:67] offset:512
    global_load_ushort v139, v2, s[66:67] offset:768
    global_load_short_d16_hi v7, v3, s[66:67] offset:768
    s_add_u32 s22, s22, 1
    s_waitcnt vmcnt(0)
    v_or_b32 v136, v136, v4
    v_or_b32 v137, v137, v5
    v_or_b32 v138, v138, v6
    v_or_b32 v139, v139, v7
    s_mul_i32 s24, s22, 3277
    s_lshr_b32 s24, s24, 16
    s_mul_i32 s68, s24, 20
    s_sub_u32 s68, s22, s68
    s_cmp_lt_u32 s68, 8
    s_cselect_b64 s[66:67], s[84:85], s[86:87]
    s_cselect_b32 s25, 0, 8
    s_sub_u32 s68, s68, s25
    s_and_b32 s25, s68, 1
    s_lshr_b32 s68, s68, 1
    s_lshl_b32 s68, s68, 14
    s_lshl_b32 s25, s25, 12
    s_add_u32 s68, s68, s25
    s_lshl_b32 s24, s24, 5
    s_add_u32 s68, s68, s24
    v_lshrrev_b32 v2, 4, v176
    v_lshlrev_b32 v2, 10, v2
    v_and_b32 v3, 15, v176
    v_lshl_add_u32 v2, v3, 1, v2
    v_add_u32 v2, s68, v2
    v_add_u32 v3, 8192, v2
    v_mov_b32 v4, 0
    v_mov_b32 v5, 0
    v_mov_b32 v6, 0
    v_mov_b32 v7, 0
    global_load_ushort v140, v2, s[66:67] offset:0
    global_load_short_d16_hi v4, v3, s[66:67] offset:0
    global_load_ushort v141, v2, s[66:67] offset:256
    global_load_short_d16_hi v5, v3, s[66:67] offset:256
    global_load_ushort v142, v2, s[66:67] offset:512
    global_load_short_d16_hi v6, v3, s[66:67] offset:512
    global_load_ushort v143, v2, s[66:67] offset:768
    global_load_short_d16_hi v7, v3, s[66:67] offset:768
    s_add_u32 s22, s22, 1
    s_waitcnt vmcnt(0)
    v_or_b32 v140, v140, v4
    v_or_b32 v141, v141, v5
    v_or_b32 v142, v142, v6
    v_or_b32 v143, v143, v7
    s_mul_i32 s24, s22, 3277
    s_lshr_b32 s24, s24, 16
    s_mul_i32 s68, s24, 20
    s_sub_u32 s68, s22, s68
    s_cmp_lt_u32 s68, 8
    s_cselect_b64 s[66:67], s[84:85], s[86:87]
    s_cselect_b32 s25, 0, 8
    s_sub_u32 s68, s68, s25
    s_and_b32 s25, s68, 1
    s_lshr_b32 s68, s68, 1
    s_lshl_b32 s68, s68, 14
    s_lshl_b32 s25, s25, 12
    s_add_u32 s68, s68, s25
    s_lshl_b32 s24, s24, 5
    s_add_u32 s68, s68, s24
    v_lshrrev_b32 v2, 4, v176
    v_lshlrev_b32 v2, 10, v2
    v_and_b32 v3, 15, v176
    v_lshl_add_u32 v2, v3, 1, v2
    v_add_u32 v2, s68, v2
    v_add_u32 v3, 8192, v2
    v_mov_b32 v4, 0
    v_mov_b32 v5, 0
    v_mov_b32 v6, 0
    v_mov_b32 v7, 0
    global_load_ushort v144, v2, s[66:67] offset:0
    global_load_short_d16_hi v4, v3, s[66:67] offset:0
    global_load_ushort v145, v2, s[66:67] offset:256
    global_load_short_d16_hi v5, v3, s[66:67] offset:256
    global_load_ushort v146, v2, s[66:67] offset:512
    global_load_short_d16_hi v6, v3, s[66:67] offset:512
    global_load_ushort v147, v2, s[66:67] offset:768
    global_load_short_d16_hi v7, v3, s[66:67] offset:768
    s_add_u32 s22, s22, 1
    s_waitcnt vmcnt(0)
    v_or_b32 v144, v144, v4
    v_or_b32 v145, v145, v5
    v_or_b32 v146, v146, v6
    v_or_b32 v147, v147, v7
    s_mul_i32 s24, s22, 3277
    s_lshr_b32 s24, s24, 16
    s_mul_i32 s68, s24, 20
    s_sub_u32 s68, s22, s68
    s_cmp_lt_u32 s68, 8
    s_cselect_b64 s[66:67], s[84:85], s[86:87]
    s_cselect_b32 s25, 0, 8
    s_sub_u32 s68, s68, s25
    s_and_b32 s25, s68, 1
    s_lshr_b32 s68, s68, 1
    s_lshl_b32 s68, s68, 14
    s_lshl_b32 s25, s25, 12
    s_add_u32 s68, s68, s25
    s_lshl_b32 s24, s24, 5
    s_add_u32 s68, s68, s24
    v_lshrrev_b32 v2, 4, v176
    v_lshlrev_b32 v2, 10, v2
    v_and_b32 v3, 15, v176
    v_lshl_add_u32 v2, v3, 1, v2
    v_add_u32 v2, s68, v2
    v_add_u32 v3, 8192, v2
    v_mov_b32 v4, 0
    v_mov_b32 v5, 0
    v_mov_b32 v6, 0
    v_mov_b32 v7, 0
    global_load_ushort v148, v2, s[66:67] offset:0
    global_load_short_d16_hi v4, v3, s[66:67] offset:0
    global_load_ushort v149, v2, s[66:67] offset:256
    global_load_short_d16_hi v5, v3, s[66:67] offset:256
    global_load_ushort v150, v2, s[66:67] offset:512
    global_load_short_d16_hi v6, v3, s[66:67] offset:512
    global_load_ushort v151, v2, s[66:67] offset:768
    global_load_short_d16_hi v7, v3, s[66:67] offset:768
    s_add_u32 s22, s22, 1
    s_waitcnt vmcnt(0)
    v_or_b32 v148, v148, v4
    v_or_b32 v149, v149, v5
    v_or_b32 v150, v150, v6
    v_or_b32 v151, v151, v7
    s_mul_i32 s24, s22, 3277
    s_lshr_b32 s24, s24, 16
    s_mul_i32 s68, s24, 20
    s_sub_u32 s68, s22, s68
    s_cmp_lt_u32 s68, 8
    s_cselect_b64 s[66:67], s[84:85], s[86:87]
    s_cselect_b32 s25, 0, 8
    s_sub_u32 s68, s68, s25
    s_and_b32 s25, s68, 1
    s_lshr_b32 s68, s68, 1
    s_lshl_b32 s68, s68, 14
    s_lshl_b32 s25, s25, 12
    s_add_u32 s68, s68, s25
    s_lshl_b32 s24, s24, 5
    s_add_u32 s68, s68, s24
    v_lshrrev_b32 v2, 4, v176
    v_lshlrev_b32 v2, 10, v2
    v_and_b32 v3, 15, v176
    v_lshl_add_u32 v2, v3, 1, v2
    v_add_u32 v2, s68, v2
    v_add_u32 v3, 8192, v2
    v_mov_b32 v4, 0
    v_mov_b32 v5, 0
    v_mov_b32 v6, 0
    v_mov_b32 v7, 0
    global_load_ushort v152, v2, s[66:67] offset:0
    global_load_short_d16_hi v4, v3, s[66:67] offset:0
    global_load_ushort v153, v2, s[66:67] offset:256
    global_load_short_d16_hi v5, v3, s[66:67] offset:256
    global_load_ushort v154, v2, s[66:67] offset:512
    global_load_short_d16_hi v6, v3, s[66:67] offset:512
    global_load_ushort v155, v2, s[66:67] offset:768
    global_load_short_d16_hi v7, v3, s[66:67] offset:768
    s_add_u32 s22, s22, 1
    s_waitcnt vmcnt(0)
    v_or_b32 v152, v152, v4
    v_or_b32 v153, v153, v5
    v_or_b32 v154, v154, v6
    v_or_b32 v155, v155, v7
    s_mul_i32 s24, s22, 3277
    s_lshr_b32 s24, s24, 16
    s_mul_i32 s68, s24, 20
    s_sub_u32 s68, s22, s68
    s_cmp_lt_u32 s68, 8
    s_cselect_b64 s[66:67], s[84:85], s[86:87]
    s_cselect_b32 s25, 0, 8
    s_sub_u32 s68, s68, s25
    s_and_b32 s25, s68, 1
    s_lshr_b32 s68, s68, 1
    s_lshl_b32 s68, s68, 14
    s_lshl_b32 s25, s25, 12
    s_add_u32 s68, s68, s25
    s_lshl_b32 s24, s24, 5
    s_add_u32 s68, s68, s24
    v_lshrrev_b32 v2, 4, v176
    v_lshlrev_b32 v2, 10, v2
    v_and_b32 v3, 15, v176
    v_lshl_add_u32 v2, v3, 1, v2
    v_add_u32 v2, s68, v2
    v_add_u32 v3, 8192, v2
    v_mov_b32 v4, 0
    v_mov_b32 v5, 0
    v_mov_b32 v6, 0
    v_mov_b32 v7, 0
    global_load_ushort v156, v2, s[66:67] offset:0
    global_load_short_d16_hi v4, v3, s[66:67] offset:0
    global_load_ushort v157, v2, s[66:67] offset:256
    global_load_short_d16_hi v5, v3, s[66:67] offset:256
    global_load_ushort v158, v2, s[66:67] offset:512
    global_load_short_d16_hi v6, v3, s[66:67] offset:512
    global_load_ushort v159, v2, s[66:67] offset:768
    global_load_short_d16_hi v7, v3, s[66:67] offset:768
    s_add_u32 s22, s22, 1
    s_waitcnt vmcnt(0)
    v_or_b32 v156, v156, v4
    v_or_b32 v157, v157, v5
    v_or_b32 v158, v158, v6
    v_or_b32 v159, v159, v7
    s_mul_i32 s24, s22, 3277
    s_lshr_b32 s24, s24, 16
    s_mul_i32 s68, s24, 20
    s_sub_u32 s68, s22, s68
    s_cmp_lt_u32 s68, 8
    s_cselect_b64 s[66:67], s[84:85], s[86:87]
    s_cselect_b32 s25, 0, 8
    s_sub_u32 s68, s68, s25
    s_and_b32 s25, s68, 1
    s_lshr_b32 s68, s68, 1
    s_lshl_b32 s68, s68, 14
    s_lshl_b32 s25, s25, 12
    s_add_u32 s68, s68, s25
    s_lshl_b32 s24, s24, 5
    s_add_u32 s68, s68, s24
    v_lshrrev_b32 v2, 4, v176
    v_lshlrev_b32 v2, 10, v2
    v_and_b32 v3, 15, v176
    v_lshl_add_u32 v2, v3, 1, v2
    v_add_u32 v2, s68, v2
    v_add_u32 v3, 8192, v2
    v_mov_b32 v4, 0
    v_mov_b32 v5, 0
    v_mov_b32 v6, 0
    v_mov_b32 v7, 0
    global_load_ushort v160, v2, s[66:67] offset:0
    global_load_short_d16_hi v4, v3, s[66:67] offset:0
    global_load_ushort v161, v2, s[66:67] offset:256
    global_load_short_d16_hi v5, v3, s[66:67] offset:256
    global_load_ushort v162, v2, s[66:67] offset:512
    global_load_short_d16_hi v6, v3, s[66:67] offset:512
    global_load_ushort v163, v2, s[66:67] offset:768
    global_load_short_d16_hi v7, v3, s[66:67] offset:768
    s_add_u32 s22, s22, 1
    s_waitcnt vmcnt(0)
    v_or_b32 v160, v160, v4
    v_or_b32 v161, v161, v5
    v_or_b32 v162, v162, v6
    v_or_b32 v163, v163, v7
    s_mul_i32 s24, s22, 3277
    s_lshr_b32 s24, s24, 16
    s_mul_i32 s68, s24, 20
    s_sub_u32 s68, s22, s68
    s_cmp_lt_u32 s68, 8
    s_cselect_b64 s[66:67], s[84:85], s[86:87]
    s_cselect_b32 s25, 0, 8
    s_sub_u32 s68, s68, s25
    s_and_b32 s25, s68, 1
    s_lshr_b32 s68, s68, 1
    s_lshl_b32 s68, s68, 14
    s_lshl_b32 s25, s25, 12
    s_add_u32 s68, s68, s25
    s_lshl_b32 s24, s24, 5
    s_add_u32 s68, s68, s24
    v_lshrrev_b32 v2, 4, v176
    v_lshlrev_b32 v2, 10, v2
    v_and_b32 v3, 15, v176
    v_lshl_add_u32 v2, v3, 1, v2
    v_add_u32 v2, s68, v2
    v_add_u32 v3, 8192, v2
    v_mov_b32 v4, 0
    v_mov_b32 v5, 0
    v_mov_b32 v6, 0
    v_mov_b32 v7, 0
    global_load_ushort v164, v2, s[66:67] offset:0
    global_load_short_d16_hi v4, v3, s[66:67] offset:0
    global_load_ushort v165, v2, s[66:67] offset:256
    global_load_short_d16_hi v5, v3, s[66:67] offset:256
    global_load_ushort v166, v2, s[66:67] offset:512
    global_load_short_d16_hi v6, v3, s[66:67] offset:512
    global_load_ushort v167, v2, s[66:67] offset:768
    global_load_short_d16_hi v7, v3, s[66:67] offset:768
    s_add_u32 s22, s22, 1
    s_waitcnt vmcnt(0)
    v_or_b32 v164, v164, v4
    v_or_b32 v165, v165, v5
    v_or_b32 v166, v166, v6
    v_or_b32 v167, v167, v7
    s_mul_i32 s24, s22, 3277
    s_lshr_b32 s24, s24, 16
    s_mul_i32 s68, s24, 20
    s_sub_u32 s68, s22, s68
    s_cmp_lt_u32 s68, 8
    s_cselect_b64 s[66:67], s[84:85], s[86:87]
    s_cselect_b32 s25, 0, 8
    s_sub_u32 s68, s68, s25
    s_and_b32 s25, s68, 1
    s_lshr_b32 s68, s68, 1
    s_lshl_b32 s68, s68, 14
    s_lshl_b32 s25, s25, 12
    s_add_u32 s68, s68, s25
    s_lshl_b32 s24, s24, 5
    s_add_u32 s68, s68, s24
    v_lshrrev_b32 v2, 4, v176
    v_lshlrev_b32 v2, 10, v2
    v_and_b32 v3, 15, v176
    v_lshl_add_u32 v2, v3, 1, v2
    v_add_u32 v2, s68, v2
    v_add_u32 v3, 8192, v2
    v_mov_b32 v4, 0
    v_mov_b32 v5, 0
    v_mov_b32 v6, 0
    v_mov_b32 v7, 0
    global_load_ushort v168, v2, s[66:67] offset:0
    global_load_short_d16_hi v4, v3, s[66:67] offset:0
    global_load_ushort v169, v2, s[66:67] offset:256
    global_load_short_d16_hi v5, v3, s[66:67] offset:256
    global_load_ushort v170, v2, s[66:67] offset:512
    global_load_short_d16_hi v6, v3, s[66:67] offset:512
    global_load_ushort v171, v2, s[66:67] offset:768
    global_load_short_d16_hi v7, v3, s[66:67] offset:768
    s_add_u32 s22, s22, 1
    s_waitcnt vmcnt(0)
    v_or_b32 v168, v168, v4
    v_or_b32 v169, v169, v5
    v_or_b32 v170, v170, v6
    v_or_b32 v171, v171, v7
    s_mul_i32 s24, s22, 3277
    s_lshr_b32 s24, s24, 16
    s_mul_i32 s68, s24, 20
    s_sub_u32 s68, s22, s68
    s_cmp_lt_u32 s68, 8
    s_cselect_b64 s[66:67], s[84:85], s[86:87]
    s_cselect_b32 s25, 0, 8
    s_sub_u32 s68, s68, s25
    s_and_b32 s25, s68, 1
    s_lshr_b32 s68, s68, 1
    s_lshl_b32 s68, s68, 14
    s_lshl_b32 s25, s25, 12
    s_add_u32 s68, s68, s25
    s_lshl_b32 s24, s24, 5
    s_add_u32 s68, s68, s24
    v_lshrrev_b32 v2, 4, v176
    v_lshlrev_b32 v2, 10, v2
    v_and_b32 v3, 15, v176
    v_lshl_add_u32 v2, v3, 1, v2
    v_add_u32 v2, s68, v2
    v_add_u32 v3, 8192, v2
    v_mov_b32 v4, 0
    v_mov_b32 v5, 0
    v_mov_b32 v6, 0
    v_mov_b32 v7, 0
    global_load_ushort v172, v2, s[66:67] offset:0
    global_load_short_d16_hi v4, v3, s[66:67] offset:0
    global_load_ushort v173, v2, s[66:67] offset:256
    global_load_short_d16_hi v5, v3, s[66:67] offset:256
    global_load_ushort v174, v2, s[66:67] offset:512
    global_load_short_d16_hi v6, v3, s[66:67] offset:512
    global_load_ushort v175, v2, s[66:67] offset:768
    global_load_short_d16_hi v7, v3, s[66:67] offset:768
    s_add_u32 s22, s22, 1
    s_waitcnt vmcnt(0)
    v_or_b32 v172, v172, v4
    v_or_b32 v173, v173, v5
    v_or_b32 v174, v174, v6
    v_or_b32 v175, v175, v7
    s_load_dwordx2 s[72:73], s[0:1], 72
    s_branch GEMM
.section .rodata,"a"
.p2align 6
.amdhsa_kernel standalone__tensor_product_equiv_equiformer__graph_kernel
  .amdhsa_next_free_vgpr 256
  .amdhsa_next_free_sgpr 90
  .amdhsa_accum_offset 256
  .amdhsa_group_segment_fixed_size 0
  .amdhsa_kernarg_size 96
  .amdhsa_user_sgpr_count 2
  .amdhsa_user_sgpr_kernarg_segment_ptr 1
  .amdhsa_system_sgpr_workgroup_id_x 1
.end_amdhsa_kernel
```

```asm
; @launch grid=(250,1,1) block=(512,1,1) lds=163840
.amdgcn_target "amdgcn-amd-amdhsa--gfx950"
.text
.globl standalone__tensor_product_equiv_equiformer__graph_kernel
.p2align 8
.type standalone__tensor_product_equiv_equiformer__graph_kernel,@function
standalone__tensor_product_equiv_equiformer__graph_kernel:
    s_cmp_ge_u32 s2, 250
    s_cbranch_scc1 K2_end
    s_load_dwordx16 s[72:87], s[0:1], 0
    s_load_dwordx2 s[70:71], s[0:1], 88
    v_lshrrev_b32 v2, 6, v0
    v_and_b32 v1, 63, v0
    v_readfirstlane_b32 s20, v2
    s_getpc_b64 s[66:67]
    v_lshlrev_b32 v95, 7, v1
    s_cmp_eq_u32 s20, 6
    s_cbranch_scc0 F_nopf0
    global_load_dword v95, v95, s[66:67]
F_nopf0:
    s_mul_i32 s66, s2, 5120
    s_mul_i32 s67, s2, 7680
    v_lshl_add_u32 v3, v0, 4, s66
    v_mul_u32_u24 v4, 24, v0
    v_add_u32 v4, s67, v4
    v_lshlrev_b32 v5, 2, v0
    v_mov_b32 v89, 0
    v_add_u32 v6, 98304, v5
    ds_write_b32 v6, v89
    s_cmp_ge_u32 s20, 5
    s_waitcnt lgkmcnt(0)
    s_cbranch_scc1 F_noload
    global_load_dwordx4 v[8:11], v3, s[80:81] nt
    global_load_dwordx4 v[12:15], v3, s[78:79] nt
    global_load_dwordx4 v[16:19], v4, s[74:75] nt
    global_load_dwordx2 v[20:21], v4, s[74:75] offset:16 nt
F_noload:
    s_load_dword s88, s[70:71], 0
    s_barrier
    v_lshlrev_b32 v248, 2, v1
    v_add_u32 v88, 162816, v248
    ds_write_b32 v88, v89
    ds_write_b32 v88, v89 offset:256
    v_lshlrev_b32 v86, 4, v1
    s_lshl_b32 s21, s20, 13
    v_lshrrev_b32 v6, 5, v1
    v_mul_u32_u24 v6, 5120, v6
    v_and_b32 v7, 31, v1
    v_lshl_add_u32 v6, v7, 1, v6
    s_lshr_b32 s66, s20, 2
    s_lshl_b32 s66, s66, 7
    s_and_b32 s67, s20, 3
    s_mul_i32 s67, s67, 5
    s_add_u32 s68, s67, 0
    s_lshr_b32 s24, s68, 2
    s_lshl_b32 s24, s24, 8
    s_bfe_u32 s69, s68, 0x10001
    s_lshl_b32 s69, s69, 6
    s_add_u32 s24, s24, s69
    s_and_b32 s69, s68, 1
    s_mul_i32 s69, s69, 10240
    s_add_u32 s24, s24, s69
    s_add_u32 s24, s24, s66
    s_add_u32 s68, s67, 1
    s_lshr_b32 s25, s68, 2
    s_lshl_b32 s25, s25, 8
    s_bfe_u32 s69, s68, 0x10001
    s_lshl_b32 s69, s69, 6
    s_add_u32 s25, s25, s69
    s_and_b32 s69, s68, 1
    s_mul_i32 s69, s69, 10240
    s_add_u32 s25, s25, s69
    s_add_u32 s25, s25, s66
    s_add_u32 s68, s67, 2
    s_lshr_b32 s26, s68, 2
    s_lshl_b32 s26, s26, 8
    s_bfe_u32 s69, s68, 0x10001
    s_lshl_b32 s69, s69, 6
    s_add_u32 s26, s26, s69
    s_and_b32 s69, s68, 1
    s_mul_i32 s69, s69, 10240
    s_add_u32 s26, s26, s69
    s_add_u32 s26, s26, s66
    s_add_u32 s68, s67, 3
    s_lshr_b32 s27, s68, 2
    s_lshl_b32 s27, s27, 8
    s_bfe_u32 s69, s68, 0x10001
    s_lshl_b32 s69, s69, 6
    s_add_u32 s27, s27, s69
    s_and_b32 s69, s68, 1
    s_mul_i32 s69, s69, 10240
    s_add_u32 s27, s27, s69
    s_add_u32 s27, s27, s66
    s_add_u32 s68, s67, 4
    s_lshr_b32 s28, s68, 2
    s_lshl_b32 s28, s28, 8
    s_bfe_u32 s69, s68, 0x10001
    s_lshl_b32 s69, s69, 6
    s_add_u32 s28, s28, s69
    s_and_b32 s69, s68, 1
    s_mul_i32 s69, s69, 10240
    s_add_u32 s28, s28, s69
    s_add_u32 s28, s28, s66
    v_mov_b32 v96, 0
    v_mov_b32 v97, 0
    v_mov_b32 v98, 0
    v_mov_b32 v99, 0
    v_mov_b32 v100, 0
    v_mov_b32 v101, 0
    v_mov_b32 v102, 0
    v_mov_b32 v103, 0
    v_mov_b32 v104, 0
    v_mov_b32 v105, 0
    v_mov_b32 v106, 0
    v_mov_b32 v107, 0
    v_mov_b32 v108, 0
    v_mov_b32 v109, 0
    v_mov_b32 v110, 0
    v_mov_b32 v111, 0
    v_mov_b32 v112, 0
    v_mov_b32 v113, 0
    v_mov_b32 v114, 0
    v_mov_b32 v115, 0
    v_mov_b32 v180, 0
    v_mov_b32 v181, 0
    v_mov_b32 v182, 0
    v_mov_b32 v183, 0
    s_mov_b32 s16, s70
    s_and_b32 s17, s71, 0xffff
    s_mov_b32 s18, 24165888
    s_mov_b32 s19, 0x20000
    v_lshrrev_b32 v2, 3, v1
    v_lshl_add_u32 v2, s20, 5, v2
    v_and_b32 v91, 7, v1
    v_mul_u32_u24 v94, 384, v2
    v_lshl_add_u32 v94, v91, 4, v94
    v_lshlrev_b32 v93, 2, v2
    v_add_u32 v93, 98304, v93
    v_mul_u32_u24 v92, 32000, v2
    v_lshl_add_u32 v92, v91, 4, v92
    v_mul_u32_u24 v90, 40960, v2
    s_mov_b32 s32, s82
    s_and_b32 s33, s83, 0xffff
    s_mov_b32 s34, 20480
    s_mov_b32 s35, 0x20000
    s_cmp_ge_u32 s20, 5
    s_cbranch_scc1 F_helper
    s_mov_b32 s22, 52429
    s_mov_b32 s23, 0x05040100
    s_mov_b32 s66, 98304
    s_movk_i32 s67, -40
    v_mov_b32 v7, 1
    v_add_u32 v31, 1, v5
    v_add_u32 v32, 2, v5
    v_add_u32 v33, 3, v5
    s_waitcnt vmcnt(3)
    v_mul_u32_u24 v22, s22, v8
    v_mul_u32_u24 v23, s22, v9
    v_mul_u32_u24 v24, s22, v10
    v_mul_u32_u24 v25, s22, v11
    v_lshrrev_b32 v22, 21, v22
    v_lshrrev_b32 v23, 21, v23
    v_lshrrev_b32 v24, 21, v24
    v_lshrrev_b32 v25, 21, v25
    v_lshl_add_u32 v34, v22, 2, s66
    ds_add_rtn_u32 v26, v34, v7
    v_lshl_add_u32 v35, v23, 2, s66
    ds_add_rtn_u32 v27, v35, v7
    v_lshl_add_u32 v36, v24, 2, s66
    ds_add_rtn_u32 v28, v36, v7
    v_lshl_add_u32 v37, v25, 2, s66
    ds_add_rtn_u32 v29, v37, v7
    buffer_load_short_d16_hi v96, v6, s[32:35], s24 offen offset:0
    buffer_load_short_d16_hi v97, v6, s[32:35], s24 offen offset:1280
    buffer_load_short_d16_hi v98, v6, s[32:35], s24 offen offset:2560
    buffer_load_short_d16_hi v99, v6, s[32:35], s24 offen offset:3840
    buffer_load_short_d16_hi v100, v6, s[32:35], s25 offen offset:0
    buffer_load_short_d16_hi v101, v6, s[32:35], s25 offen offset:1280
    buffer_load_short_d16_hi v102, v6, s[32:35], s25 offen offset:2560
    buffer_load_short_d16_hi v103, v6, s[32:35], s25 offen offset:3840
    buffer_load_short_d16_hi v104, v6, s[32:35], s26 offen offset:0
    buffer_load_short_d16_hi v105, v6, s[32:35], s26 offen offset:1280
    buffer_load_short_d16_hi v106, v6, s[32:35], s26 offen offset:2560
    buffer_load_short_d16_hi v107, v6, s[32:35], s26 offen offset:3840
    buffer_load_short_d16_hi v108, v6, s[32:35], s27 offen offset:0
    buffer_load_short_d16_hi v109, v6, s[32:35], s27 offen offset:1280
    buffer_load_short_d16_hi v110, v6, s[32:35], s27 offen offset:2560
    buffer_load_short_d16_hi v111, v6, s[32:35], s27 offen offset:3840
    buffer_load_short_d16_hi v112, v6, s[32:35], s28 offen offset:0
    buffer_load_short_d16_hi v113, v6, s[32:35], s28 offen offset:1280
    buffer_load_short_d16_hi v114, v6, s[32:35], s28 offen offset:2560
    buffer_load_short_d16_hi v115, v6, s[32:35], s28 offen offset:3840
    v_mad_i32_i24 v2, v22, s67, v8
    v_mul_u32_u24 v22, 384, v22
    v_lshl_or_b32 v42, v2, 11, v5
    v_mad_i32_i24 v2, v23, s67, v9
    v_mul_u32_u24 v23, 384, v23
    v_lshl_or_b32 v46, v2, 11, v31
    v_mad_i32_i24 v2, v24, s67, v10
    v_mul_u32_u24 v24, 384, v24
    v_lshl_or_b32 v50, v2, 11, v32
    v_mad_i32_i24 v2, v25, s67, v11
    v_mul_u32_u24 v25, 384, v25
    v_lshl_or_b32 v54, v2, 11, v33
    s_waitcnt vmcnt(20)
    v_mov_b32 v40, v16
    v_perm_b32 v41, v12, v17, s23
    v_alignbit_b32 v44, v18, v17, 16
    v_alignbit_b32 v45, v13, v18, 16
    v_mov_b32 v48, v19
    v_perm_b32 v49, v14, v20, s23
    v_alignbit_b32 v52, v21, v20, 16
    v_alignbit_b32 v53, v15, v21, 16
    v_xor_b32 v41, 0x8000, v41
    v_xor_b32 v45, 0x8000, v45
    v_xor_b32 v49, 0x8000, v49
    v_xor_b32 v53, 0x8000, v53
    s_waitcnt lgkmcnt(0)
    v_min_u32 v26, 23, v26
    v_lshl_add_u32 v34, v26, 4, v22
    ds_write_b128 v34, v[40:43]
    v_min_u32 v27, 23, v27
    v_lshl_add_u32 v35, v27, 4, v23
    ds_write_b128 v35, v[44:47]
    v_min_u32 v28, 23, v28
    v_lshl_add_u32 v36, v28, 4, v24
    ds_write_b128 v36, v[48:51]
    v_min_u32 v29, 23, v29
    v_lshl_add_u32 v37, v29, 4, v25
    ds_write_b128 v37, v[52:55]
    s_branch F_staged
F_helper:
    buffer_load_short_d16_hi v96, v6, s[32:35], s24 offen offset:0
    buffer_load_short_d16_hi v97, v6, s[32:35], s24 offen offset:1280
    buffer_load_short_d16_hi v98, v6, s[32:35], s24 offen offset:2560
    buffer_load_short_d16_hi v99, v6, s[32:35], s24 offen offset:3840
    buffer_load_short_d16_hi v100, v6, s[32:35], s25 offen offset:0
    buffer_load_short_d16_hi v101, v6, s[32:35], s25 offen offset:1280
    buffer_load_short_d16_hi v102, v6, s[32:35], s25 offen offset:2560
    buffer_load_short_d16_hi v103, v6, s[32:35], s25 offen offset:3840
    buffer_load_short_d16_hi v104, v6, s[32:35], s26 offen offset:0
    buffer_load_short_d16_hi v105, v6, s[32:35], s26 offen offset:1280
    buffer_load_short_d16_hi v106, v6, s[32:35], s26 offen offset:2560
    buffer_load_short_d16_hi v107, v6, s[32:35], s26 offen offset:3840
    buffer_load_short_d16_hi v108, v6, s[32:35], s27 offen offset:0
    buffer_load_short_d16_hi v109, v6, s[32:35], s27 offen offset:1280
    buffer_load_short_d16_hi v110, v6, s[32:35], s27 offen offset:2560
    buffer_load_short_d16_hi v111, v6, s[32:35], s27 offen offset:3840
    buffer_load_short_d16_hi v112, v6, s[32:35], s28 offen offset:0
    buffer_load_short_d16_hi v113, v6, s[32:35], s28 offen offset:1280
    buffer_load_short_d16_hi v114, v6, s[32:35], s28 offen offset:2560
    buffer_load_short_d16_hi v115, v6, s[32:35], s28 offen offset:3840
    s_cmp_eq_u32 s20, 6
    s_cbranch_scc0 F_nopf
    s_getpc_b64 s[66:67]
F_pc:
    s_lshr_b32 s68, s2, 3
    s_mul_i32 s68, s68, ((K2_last-F_pc)/128/31+1)*128
    v_lshl_add_u32 v2, v1, 7, s68
    v_min_u32 v2, K2_last-F_pc-4, v2
    v_cmp_gt_u32 vcc, (K2_last-F_pc)/128/31+1, v1
    s_mov_b64 exec, vcc
    global_load_dword v95, v2, s[66:67]
    s_mov_b64 exec, -1
F_nopf:
    s_cmp_eq_u32 s20, 7
    s_cbranch_scc0 F_staged
    s_cmp_lt_u32 s2, 160
    s_cbranch_scc0 F_staged
    s_mul_i32 s22, s2, 3277
    s_lshr_b32 s22, s22, 16
    s_mul_i32 s68, s22, 20
    s_sub_u32 s68, s2, s68
    s_cmp_lt_u32 s68, 8
    s_cselect_b64 s[66:67], s[84:85], s[86:87]
    s_cselect_b32 s23, 0, 8
    s_sub_u32 s68, s68, s23
    s_and_b32 s23, s68, 1
    s_lshr_b32 s68, s68, 1
    s_lshl_b32 s68, s68, 14
    s_lshl_b32 s23, s23, 12
    s_add_u32 s68, s68, s23
    s_lshl_b32 s22, s22, 5
    s_add_u32 s68, s68, s22
    v_lshrrev_b32 v2, 4, v1
    v_lshlrev_b32 v2, 10, v2
    v_and_b32 v3, 15, v1
    v_lshl_add_u32 v2, v3, 1, v2
    v_add_u32 v2, s68, v2
    v_add_u32 v3, 8192, v2
    global_load_ushort v176, v2, s[66:67] offset:0
    global_load_short_d16_hi v180, v3, s[66:67] offset:0
    global_load_ushort v177, v2, s[66:67] offset:256
    global_load_short_d16_hi v181, v3, s[66:67] offset:256
    global_load_ushort v178, v2, s[66:67] offset:512
    global_load_short_d16_hi v182, v3, s[66:67] offset:512
    global_load_ushort v179, v2, s[66:67] offset:768
    global_load_short_d16_hi v183, v3, s[66:67] offset:768
F_staged:
    s_lshl_b32 s66, s2, 7
    s_add_u32 s66, s66, 164864
    s_cmp_eq_u32 s20, 7
    s_cselect_b32 s22, 0xffff, -1
    s_cselect_b32 s23, 0, -1
    s_waitcnt lgkmcnt(0)
    s_add_u32 s88, s88, 1
    s_barrier
    ds_read_b32 v40, v93 offset:0
    ds_read_b128 v[8:11], v94 offset:0
    ds_read_b128 v[12:15], v94 offset:128
    ds_read_b32 v41, v93 offset:32
    ds_read_b128 v[16:19], v94 offset:3072
    ds_read_b128 v[20:23], v94 offset:3200
    ds_read_b32 v42, v93 offset:64
    ds_read_b128 v[24:27], v94 offset:6144
    ds_read_b128 v[28:31], v94 offset:6272
    ds_read_b32 v43, v93 offset:96
    ds_read_b128 v[32:35], v94 offset:9216
    ds_read_b128 v[36:39], v94 offset:9344
    s_waitcnt vmcnt(0)
    s_waitcnt lgkmcnt(9)
    v_min_u32 v5, 31, v40
    v_bfe_u32 v6, v14, 11, 6
    v_and_b32 v10, 0x1ffff, v10
    v_lshl_or_b32 v6, v5, 6, v6
    v_mov_b32 v11, s88
    v_lshl_or_b32 v10, v6, 17, v10
    v_mov_b32 v15, s88
    buffer_store_dwordx4 v[8:11], v92, s[16:19], s66 offen sc1
    v_cmp_lt_u32 vcc, 8, v40
    s_add_u32 s67, s66, 8000000
    s_mov_b64 exec, vcc
    s_cbranch_execz F_w0
    buffer_store_dwordx4 v[12:15], v92, s[16:19], s67 offen sc1
    v_cmp_lt_u32 vcc, 16, v40
    s_add_u32 s67, s67, 8000000
    s_mov_b64 exec, vcc
    s_cbranch_execz F_w0
    ds_read_b128 v[44:47], v94 offset:256
    s_waitcnt lgkmcnt(0)
    v_mov_b32 v47, s88
    buffer_store_dwordx4 v[44:47], v92, s[16:19], s67 offen sc1
    s_nop 1
F_w0:
    s_mov_b64 exec, -1
    s_add_u32 s66, s66, 256000
    s_waitcnt lgkmcnt(6)
    v_min_u32 v5, 31, v41
    v_bfe_u32 v6, v22, 11, 6
    v_and_b32 v18, 0x1ffff, v18
    v_lshl_or_b32 v6, v5, 6, v6
    v_mov_b32 v19, s88
    v_lshl_or_b32 v18, v6, 17, v18
    v_mov_b32 v23, s88
    buffer_store_dwordx4 v[16:19], v92, s[16:19], s66 offen sc1
    v_cmp_lt_u32 vcc, 8, v41
    s_add_u32 s67, s66, 8000000
    s_mov_b64 exec, vcc
    s_cbranch_execz F_w1
    buffer_store_dwordx4 v[20:23], v92, s[16:19], s67 offen sc1
    v_cmp_lt_u32 vcc, 16, v41
    s_add_u32 s67, s67, 8000000
    s_mov_b64 exec, vcc
    s_cbranch_execz F_w1
    ds_read_b128 v[44:47], v94 offset:3328
    s_waitcnt lgkmcnt(0)
    v_mov_b32 v47, s88
    buffer_store_dwordx4 v[44:47], v92, s[16:19], s67 offen sc1
    s_nop 1
F_w1:
    s_mov_b64 exec, -1
    s_add_u32 s66, s66, 256000
    s_waitcnt lgkmcnt(3)
    v_min_u32 v5, 31, v42
    v_bfe_u32 v6, v30, 11, 6
    v_and_b32 v26, 0x1ffff, v26
    v_lshl_or_b32 v6, v5, 6, v6
    v_mov_b32 v27, s88
    v_lshl_or_b32 v26, v6, 17, v26
    v_mov_b32 v31, s88
    buffer_store_dwordx4 v[24:27], v92, s[16:19], s66 offen sc1
    v_cmp_lt_u32 vcc, 8, v42
    s_add_u32 s67, s66, 8000000
    s_mov_b64 exec, vcc
    s_cbranch_execz F_w2
    buffer_store_dwordx4 v[28:31], v92, s[16:19], s67 offen sc1
    v_cmp_lt_u32 vcc, 16, v42
    s_add_u32 s67, s67, 8000000
    s_mov_b64 exec, vcc
    s_cbranch_execz F_w2
    ds_read_b128 v[44:47], v94 offset:6400
    s_waitcnt lgkmcnt(0)
    v_mov_b32 v47, s88
    buffer_store_dwordx4 v[44:47], v92, s[16:19], s67 offen sc1
    s_nop 1
F_w2:
    s_mov_b64 exec, -1
    s_add_u32 s66, s66, 256000
    s_waitcnt lgkmcnt(0)
    v_min_u32 v5, 31, v43
    v_bfe_u32 v6, v38, 11, 6
    v_and_b32 v34, 0x1ffff, v34
    v_lshl_or_b32 v6, v5, 6, v6
    v_mov_b32 v35, s88
    v_lshl_or_b32 v34, v6, 17, v34
    v_mov_b32 v39, s88
    s_mov_b64 exec, s[22:23]
    buffer_store_dwordx4 v[32:35], v92, s[16:19], s66 offen sc1
    v_cmp_lt_u32 vcc, 8, v43
    s_add_u32 s67, s66, 8000000
    s_mov_b64 exec, vcc
    s_cbranch_execz F_w3
    buffer_store_dwordx4 v[36:39], v92, s[16:19], s67 offen sc1
    v_cmp_lt_u32 vcc, 16, v43
    s_add_u32 s67, s67, 8000000
    s_mov_b64 exec, vcc
    s_cbranch_execz F_w3
    ds_read_b128 v[44:47], v94 offset:9472
    s_waitcnt lgkmcnt(0)
    v_mov_b32 v47, s88
    buffer_store_dwordx4 v[44:47], v92, s[16:19], s67 offen sc1
    s_nop 1
F_w3:
    s_mov_b64 exec, -1
    s_cmp_eq_u32 s20, 7
    s_cbranch_scc0 F_nofrag
    s_cmp_lt_u32 s2, 160
    s_cbranch_scc0 F_nofrag
    v_or_b32 v176, v176, v180
    v_or_b32 v177, v177, v181
    v_or_b32 v178, v178, v182
    v_or_b32 v179, v179, v183
    s_lshl_b32 s66, s2, 10
    s_add_u32 s66, s66, 1024
    buffer_store_dwordx4 v[176:179], v86, s[16:19], s66 offen sc1
F_nofrag:
    s_barrier
    s_mul_i32 s24, s2, 32000
    s_lshl_b32 s25, s20, 12
    s_add_u32 s24, s24, s25
    s_add_u32 s24, s24, 164864
    s_add_u32 s25, s24, 8000000
    s_add_u32 s26, s25, 8000000
    v_mov_b32 v22, 0
    v_mov_b32 v23, s88
    s_mul_i32 s68, s20, 5120
    s_cmp_ge_u32 s20, 4
    s_cselect_b32 s70, 45056, 0
    s_add_u32 s68, s68, s70
    v_add_u32 v2, s68, v86
    ds_write_b128 v2, v[96:99] offset:0
    ds_write_b128 v2, v[100:103] offset:1024
    ds_write_b128 v2, v[104:107] offset:2048
    ds_write_b128 v2, v[108:111] offset:3072
    ds_write_b128 v2, v[112:115] offset:4096
    v_mov_b32 v4, 2130738944
    v_mov_b32 v5, 2130738944
    v_mov_b32 v6, 2130738944
    v_mov_b32 v7, 2130738944
    v_lshlrev_b32 v2, 4, v0
    v_add_u32 v3, 86016, v2
    ds_write_b128 v3, v[4:7] offset:0
    ds_write_b128 v3, v[4:7] offset:8192
    ds_write_b128 v3, v[4:7] offset:16384
    ds_write_b128 v3, v[4:7] offset:24576
    ds_write_b128 v3, v[4:7] offset:32768
    ds_write_b128 v3, v[4:7] offset:40960
    ds_write_b128 v3, v[4:7] offset:49152
    ds_write_b128 v3, v[4:7] offset:57344
    v_add_u32 v3, 0x10000, v3
    ds_write_b128 v3, v[4:7] offset:0
    v_min_u32 v2, 3056, v2
    v_add_u32 v2, 159744, v2
    ds_write_b128 v2, v[4:7]
    s_sub_u32 s72, s72, 128
    s_subb_u32 s73, s73, 0
    s_mov_b32 s4, s72
    s_and_b32 s5, s73, 0xffff
    s_mov_b32 s6, 10240000
    s_mov_b32 s7, 0x20000
    s_sub_u32 s72, s72, 1024
    s_subb_u32 s73, s73, 0
    s_mov_b32 s8, s72
    s_and_b32 s9, s73, 0xffff
    s_mov_b32 s10, 10241024
    s_mov_b32 s11, 0x20000
    s_mov_b32 s12, s76
    s_and_b32 s13, s77, 0xffff
    s_mov_b32 s14, 10240000
    s_mov_b32 s15, 0x20000
    v_lshrrev_b32 v2, 5, v1
    v_bfe_u32 v3, v1, 2, 2
    v_and_b32 v4, 3, v1
    v_bfe_u32 v5, v1, 4, 1
    v_lshlrev_b32 v6, 9, v2
    v_lshl_add_u32 v6, v3, 7, v6
    v_lshl_add_u32 v6, v5, 5, v6
    v_lshl_add_u32 v6, v4, 3, v6
    v_lshrrev_b32 v7, 1, v3
    v_lshl_add_u32 v6, v7, 6, v6
    v_add_u32 v244, s21, v6
    v_xor_b32 v245, 64, v244
    v_lshlrev_b32 v6, 7, v2
    v_lshl_add_u32 v6, v7, 5, v6
    v_and_b32 v7, 1, v3
    v_xor_b32 v7, 1, v7
    v_mul_u32_u24 v7, 90112, v7
    v_add_u32 v6, v6, v7
    v_lshl_add_u32 v249, v4, 3, v6
    v_lshl_add_u32 v6, v2, 2, v4
    v_bfe_u32 v7, v1, 2, 1
    v_lshl_add_u32 v6, v7, 3, v6
    v_lshlrev_b32 v6, 3, v6
    v_bfe_u32 v7, v1, 3, 1
    v_add_u32 v5, 1, v5
    v_mul_u32_u24 v7, v7, v5
    v_lshl_add_u32 v250, v7, 1, v6
    v_and_b32 v6, 0x38, v1
    v_add_u32 v247, 6, v6
    v_lshrrev_b32 v6, 2, v1
    v_lshrrev_b32 v7, 4, v1
    v_xor_b32 v6, v6, v7
    v_and_b32 v6, 1, v6
    v_lshlrev_b32 v6, 6, v6
    v_lshl_add_u32 v246, v4, 4, v6
    v_mov_b32 v242, 1.0
    v_mov_b32 v243, 1.0
    s_mov_b32 s54, 0xffffff00
    s_mov_b32 s55, 0xffffff00
    s_mov_b32 s56, 0xffff
    s_mov_b32 s57, 0xffff
    s_mov_b32 s58, 0
    s_mov_b32 s59, 134217856
    s_mov_b32 s60, 262272
    s_mov_b32 s61, 402915456
    s_mov_b32 s62, 940179840
    s_mov_b32 s63, 403046528
    s_mov_b32 s64, 402784384
    s_mov_b32 s65, 134348928
    s_mov_b32 s38, 128
    s_mov_b32 s33, -1
    s_and_b32 s68, s20, 3
    s_lshl_b32 s68, s68, 2
    s_lshr_b32 s69, s20, 2
    s_add_u32 s68, s68, s69
    s_lshl_b32 s68, s68, 4
    s_add_u32 s68, s68, 163072
    v_mov_b32 v251, s68
    s_mov_b32 s53, 0
    s_mov_b32 s50, 0
    s_mov_b32 s51, 0
    s_mov_b32 s47, 0
    s_mov_b32 s42, 0
    s_mov_b32 s3, 0
    s_mov_b32 s89, 0
    s_mov_b32 s34, 128
    s_mov_b32 s35, 384
    s_mov_b32 s36, 640
    s_mov_b32 s37, 896
    s_waitcnt lgkmcnt(0)
    s_barrier
    buffer_load_dwordx4 v[8:11], v86, s[16:19], s24 offen offset:0 sc1
    buffer_load_dwordx4 v[12:15], v86, s[16:19], s24 offen offset:1024 sc1
    buffer_load_dwordx4 v[16:19], v86, s[16:19], s24 offen offset:2048 sc1
    s_mov_b64 exec, s[22:23]
    buffer_load_dwordx4 v[20:23], v86, s[16:19], s24 offen offset:3072 sc1
    s_mov_b64 exec, -1
    ds_read_b128 v[96:99], v86 offset:0
    ds_read_b128 v[100:103], v86 offset:1024
    ds_read_b128 v[104:107], v86 offset:2048
    ds_read_b128 v[108:111], v86 offset:3072
    ds_read_b128 v[112:115], v86 offset:4096
    ds_read_b128 v[116:119], v86 offset:5120
    ds_read_b128 v[120:123], v86 offset:6144
    ds_read_b128 v[124:127], v86 offset:7168
    ds_read_b128 v[128:131], v86 offset:8192
    ds_read_b128 v[132:135], v86 offset:9216
    ds_read_b128 v[136:139], v86 offset:10240
    ds_read_b128 v[140:143], v86 offset:11264
    ds_read_b128 v[144:147], v86 offset:12288
    ds_read_b128 v[148:151], v86 offset:13312
    ds_read_b128 v[152:155], v86 offset:14336
    ds_read_b128 v[156:159], v86 offset:15360
    ds_read_b128 v[160:163], v86 offset:16384
    ds_read_b128 v[164:167], v86 offset:17408
    ds_read_b128 v[168:171], v86 offset:18432
    ds_read_b128 v[172:175], v86 offset:19456
    s_mov_b32 s27, 32768
    s_mov_b32 s71, 162816
    v_mov_b32 v3, 1
    s_cmp_eq_u32 s20, 7
    s_cselect_b32 s52, 160, 0
    v_cmp_gt_u32 s[68:69], 40, v1
    s_mov_b64 s[28:29], 0xff
    s_lshr_b32 s66, s2, 3
    s_lshl_b32 s66, s66, 3
    s_add_u32 s66, s66, s20
    s_mul_i32 s66, s66, 40
    v_min_u32 v93, 39, v1
    v_add_u32 v93, s66, v93
    v_lshlrev_b32 v93, 10, v93
    v_mov_b32 v94, 0x7f000000
F_poll:
    s_waitcnt vmcnt(0)
    v_cmp_ne_u32 s[72:73], s88, v11
    v_cmp_ne_u32 s[74:75], s88, v15
    v_cmp_ne_u32 s[76:77], s88, v19
    v_cmp_ne_u32 s[78:79], s88, v23
    s_or_b64 s[80:81], s[72:73], s[74:75]
    s_or_b64 s[82:83], s[76:77], s[78:79]
    s_or_b64 s[80:81], s[80:81], s[82:83]
    s_cbranch_scc1 F_again
F_got:
    v_bfe_u32 v2, v10, 23, 5
    v_bfe_u32 v60, v10, 11, 6
    v_cmp_gt_u32 s[80:81], v2, v91
    v_lshl_add_u32 v60, v60, 2, s71
    v_cmp_lt_u32 s[72:73], 8, v2
    v_max_u32 v89, v89, v2
    s_mov_b64 exec, s[80:81]
    ds_add_rtn_u32 v72, v60, v3
    s_mov_b64 exec, s[72:73]
    s_cbranch_execz F_h0
    buffer_load_dwordx4 v[24:27], v86, s[16:19], s25 offen offset:0 sc1
    v_sub_u32 v56, v2, v91
    v_bfe_u32 v64, v10, 17, 6
    v_cmp_lt_u32 vcc, 8, v56
    v_lshl_add_u32 v64, v64, 2, s71
    s_mov_b64 exec, vcc
    ds_add_rtn_u32 v76, v64, v3
F_h0:
    s_mov_b64 exec, -1
    v_bfe_u32 v2, v14, 23, 5
    v_bfe_u32 v61, v14, 11, 6
    v_cmp_gt_u32 s[82:83], v2, v91
    v_lshl_add_u32 v61, v61, 2, s71
    v_cmp_lt_u32 s[74:75], 8, v2
    v_max_u32 v89, v89, v2
    s_mov_b64 exec, s[82:83]
    ds_add_rtn_u32 v73, v61, v3
    s_mov_b64 exec, s[74:75]
    s_cbranch_execz F_h1
    buffer_load_dwordx4 v[28:31], v86, s[16:19], s25 offen offset:1024 sc1
    v_sub_u32 v57, v2, v91
    v_bfe_u32 v65, v14, 17, 6
    v_cmp_lt_u32 vcc, 8, v57
    v_lshl_add_u32 v65, v65, 2, s71
    s_mov_b64 exec, vcc
    ds_add_rtn_u32 v77, v65, v3
F_h1:
    s_mov_b64 exec, -1
    v_bfe_u32 v2, v18, 23, 5
    v_bfe_u32 v62, v18, 11, 6
    v_cmp_gt_u32 s[84:85], v2, v91
    v_lshl_add_u32 v62, v62, 2, s71
    v_cmp_lt_u32 s[76:77], 8, v2
    v_max_u32 v89, v89, v2
    s_mov_b64 exec, s[84:85]
    ds_add_rtn_u32 v74, v62, v3
    s_mov_b64 exec, s[76:77]
    s_cbranch_execz F_h2
    buffer_load_dwordx4 v[32:35], v86, s[16:19], s25 offen offset:2048 sc1
    v_sub_u32 v58, v2, v91
    v_bfe_u32 v66, v18, 17, 6
    v_cmp_lt_u32 vcc, 8, v58
    v_lshl_add_u32 v66, v66, 2, s71
    s_mov_b64 exec, vcc
    ds_add_rtn_u32 v78, v66, v3
F_h2:
    s_mov_b64 exec, -1
    v_bfe_u32 v2, v22, 23, 5
    v_bfe_u32 v63, v22, 11, 6
    v_cmp_gt_u32 s[86:87], v2, v91
    v_lshl_add_u32 v63, v63, 2, s71
    v_cmp_lt_u32 s[78:79], 8, v2
    v_max_u32 v89, v89, v2
    s_mov_b64 exec, s[86:87]
    ds_add_rtn_u32 v75, v63, v3
    s_mov_b64 exec, s[78:79]
    s_cbranch_execz F_h3
    buffer_load_dwordx4 v[36:39], v86, s[16:19], s25 offen offset:3072 sc1
    v_sub_u32 v59, v2, v91
    v_bfe_u32 v67, v22, 17, 6
    v_cmp_lt_u32 vcc, 8, v59
    v_lshl_add_u32 v67, v67, 2, s71
    s_mov_b64 exec, vcc
    ds_add_rtn_u32 v79, v67, v3
F_h3:
    s_mov_b64 exec, -1
    v_cmp_lt_u32 s[30:31], 16, v89
    s_mov_b32 s27, 262144
    s_cmp_lg_u64 s[30:31], 0
    s_cbranch_scc1 F_l3
F_l3r:
    v_and_b32 v10, 0x7ff, v10
    v_lshl_add_u32 v10, v10, 5, v90
    v_or_b32 v11, 16, v10
    v_and_b32 v14, 0x7ff, v14
    v_lshl_add_u32 v14, v14, 5, v90
    v_add_u32 v14, 327680, v14
    v_or_b32 v15, 16, v14
    v_and_b32 v18, 0x7ff, v18
    v_lshl_add_u32 v18, v18, 5, v90
    v_add_u32 v18, 655360, v18
    v_or_b32 v19, 16, v18
    v_and_b32 v22, 0x7ff, v22
    v_lshl_add_u32 v22, v22, 5, v90
    v_add_u32 v22, 983040, v22
    v_or_b32 v23, 16, v22
    s_cmp_lt_u32 s2, s52
    s_cbranch_scc1 F_flag
F_flagr:
    s_waitcnt lgkmcnt(0)
    s_barrier
    ds_read_b32 v4, v88
    buffer_load_dword v95, v93, s[4:7], 0 offen offset:128
    v_lshlrev_b32 v72, 3, v72
    v_lshlrev_b32 v73, 3, v73
    v_lshlrev_b32 v74, 3, v74
    v_lshlrev_b32 v75, 3, v75
    v_lshlrev_b32 v76, 3, v76
    v_lshlrev_b32 v77, 3, v77
    v_lshlrev_b32 v78, 3, v78
    v_lshlrev_b32 v79, 3, v79
    s_waitcnt lgkmcnt(0)
    v_add_u32 v5, 15, v4
    v_cmp_lt_u32 vcc, 64, v4
    v_lshrrev_b32 v5, 4, v5
    v_med3_u32 v5, v5, 1, 4
    v_mul_u32_u24 v6, 640, v5
    v_max_u32 v6, 1536, v6
    v_cndmask_b32 v6, 0, v6, s[68:69]
    s_cmp_lg_u64 vcc, 0
    s_cbranch_scc1 SLOW
    v_mov_b32 v7, v6
    v_add_u32 v2, 7, v4
    v_lshrrev_b32 v2, 3, v2
    v_add_u32_dpp v7, v7, v7 row_shr:1 row_mask:0xf bank_mask:0xf
    v_max_u32 v2, 2, v2
    v_cmp_eq_u32 vcc, 7, v2
    v_add_u32_dpp v7, v7, v7 row_shr:2 row_mask:0xf bank_mask:0xf
    v_lshlrev_b32 v92, 22, v5
    v_lshlrev_b32 v5, 18, v5
    v_add_u32_dpp v7, v7, v7 row_shr:4 row_mask:0xf bank_mask:0xf
    v_lshl_or_b32 v5, v1, 21, v5
    v_addc_co_u32 v2, vcc, 0, v2, vcc
    v_add_u32_dpp v7, v7, v7 row_shr:8 row_mask:0xf bank_mask:0xf
    v_lshl_or_b32 v5, v2, 28, v5
    v_med3_u32 v2, v2, 3, 6
    v_add_u32_dpp v7, v7, v7 row_bcast:15 row_mask:0xa bank_mask:0xf
    v_cndmask_b32 v2, 0, v2, s[68:69]
    v_mov_b32 v84, 63
    v_add_u32_dpp v7, v7, v7 row_bcast:31 row_mask:0xc bank_mask:0xf
    s_mov_b32 s71, 0x2000
    v_readlane_b32 s66, v7, 63
    v_sub_u32 v7, v7, v6
    v_add_u32 v7, 86016, v7
    v_lshrrev_b32 v6, 3, v7
    v_mad_u32_u24 v92, v7, s71, v92
    v_or_b32 v92, v92, v6
    ds_bpermute_b32 v60, v60, v92
    ds_bpermute_b32 v61, v61, v92
    ds_bpermute_b32 v62, v62, v92
    ds_bpermute_b32 v63, v63, v92
    ds_bpermute_b32 v64, v64, v92
    ds_bpermute_b32 v65, v65, v92
    ds_bpermute_b32 v66, v66, v92
    ds_bpermute_b32 v67, v67, v92
    v_cmp_eq_u32 vcc, 6, v2
    v_or_b32 v6, v5, v7
    s_cmp_gt_u32 s66, 76800
    s_cbranch_scc1 SLOW
    v_mbcnt_lo_u32_b32 v5, vcc_lo, 0
    v_mbcnt_hi_u32_b32 v5, vcc_hi, v5
    s_bcnt1_i32_b64 s71, vcc
    v_cndmask_b32 v84, v84, v5, vcc
    v_cmp_eq_u32 vcc, 5, v2
    v_mov_b32 v3, s71
    s_nop 0
    v_mbcnt_lo_u32_b32 v5, vcc_lo, v3
    v_mbcnt_hi_u32_b32 v5, vcc_hi, v5
    s_bcnt1_i32_b64 s71, vcc
    v_cndmask_b32 v84, v84, v5, vcc
    v_cmp_eq_u32 vcc, 4, v2
    v_add_u32 v3, s71, v3
    s_nop 0
    v_mbcnt_lo_u32_b32 v5, vcc_lo, v3
    v_mbcnt_hi_u32_b32 v5, vcc_hi, v5
    s_bcnt1_i32_b64 s71, vcc
    v_cndmask_b32 v84, v84, v5, vcc
    v_cmp_eq_u32 vcc, 3, v2
    v_add_u32 v3, s71, v3
    s_nop 0
    v_mbcnt_lo_u32_b32 v5, vcc_lo, v3
    v_mbcnt_hi_u32_b32 v5, vcc_hi, v5
    v_cndmask_b32 v84, v84, v5, vcc
    s_waitcnt lgkmcnt(7)
    v_mad_u32_u16 v2, v60, 8, v72
    v_mad_u32_u16 v3, v60, 8, v72 op_sel:[1,0,0,0]
    s_mov_b64 exec, s[80:81]
    ds_write_b64 v2, v[10:11]
    ds_write_b64 v3, v[8:9]
    s_mov_b64 exec, -1
    s_waitcnt lgkmcnt(8)
    v_mad_u32_u16 v2, v61, 8, v73
    v_mad_u32_u16 v3, v61, 8, v73 op_sel:[1,0,0,0]
    s_mov_b64 exec, s[82:83]
    ds_write_b64 v2, v[14:15]
    ds_write_b64 v3, v[12:13]
    s_mov_b64 exec, -1
    s_waitcnt lgkmcnt(9)
    v_mad_u32_u16 v2, v62, 8, v74
    v_mad_u32_u16 v3, v62, 8, v74 op_sel:[1,0,0,0]
    s_mov_b64 exec, s[84:85]
    ds_write_b64 v2, v[18:19]
    ds_write_b64 v3, v[16:17]
    s_mov_b64 exec, -1
    s_waitcnt lgkmcnt(10)
    v_mad_u32_u16 v2, v63, 8, v75
    v_mad_u32_u16 v3, v63, 8, v75 op_sel:[1,0,0,0]
    s_mov_b64 exec, s[86:87]
    ds_write_b64 v2, v[22:23]
    ds_write_b64 v3, v[20:21]
    s_mov_b64 exec, -1
    v_bfe_u32 v2, v84, 2, 1
    v_bfe_u32 v3, v84, 3, 1
    v_mul_u32_u24 v2, 3, v2
    v_lshl_or_b32 v3, v3, 2, v2
    v_xor_b32 v84, v84, v3
    s_lshr_b32 s66, s2, 3
    v_add_u32 v2, s66, v84
    v_lshlrev_b32 v2, 3, v2
    v_add_u32 v2, v2, v84
    v_cmp_gt_u32 vcc, 32, v84
    v_and_b32 v2, 24, v2
    v_and_or_b32 v2, v84, 7, v2
    v_cndmask_b32 v84, v84, v2, vcc
    v_cmp_eq_u32 vcc, s20, v84
    s_ff1_i32_b64 s67, vcc
    v_readlane_b32 s80, v6, s67
    s_waitcnt vmcnt(1) lgkmcnt(8)
    s_mov_b64 exec, s[72:73]
    s_cbranch_execz F_s0
F_sp0:
    v_cmp_ne_u32 vcc, s88, v27
    s_cbranch_vccnz F_sa0
F_sg0:
    v_cmpx_lt_u32 vcc, 8, v56
    v_and_b32 v26, 0x7ff, v26
    v_lshl_add_u32 v26, v26, 5, v90
    v_or_b32 v27, 16, v26
    v_mad_u32_u16 v2, v64, 8, v76
    v_mad_u32_u16 v3, v64, 8, v76 op_sel:[1,0,0,0]
    ds_write_b64 v2, v[26:27]
    ds_write_b64 v3, v[24:25]
F_s0:
    s_mov_b64 exec, s[74:75]
    s_cbranch_execz F_s1
F_sp1:
    v_cmp_ne_u32 vcc, s88, v31
    s_cbranch_vccnz F_sa1
F_sg1:
    v_cmpx_lt_u32 vcc, 8, v57
    v_and_b32 v30, 0x7ff, v30
    v_lshl_add_u32 v30, v30, 5, v90
    v_add_u32 v30, 327680, v30
    v_or_b32 v31, 16, v30
    v_mad_u32_u16 v2, v65, 8, v77
    v_mad_u32_u16 v3, v65, 8, v77 op_sel:[1,0,0,0]
    ds_write_b64 v2, v[30:31]
    ds_write_b64 v3, v[28:29]
F_s1:
    s_mov_b64 exec, s[76:77]
    s_cbranch_execz F_s2
F_sp2:
    v_cmp_ne_u32 vcc, s88, v35
    s_cbranch_vccnz F_sa2
F_sg2:
    v_cmpx_lt_u32 vcc, 8, v58
    v_and_b32 v34, 0x7ff, v34
    v_lshl_add_u32 v34, v34, 5, v90
    v_add_u32 v34, 655360, v34
    v_or_b32 v35, 16, v34
    v_mad_u32_u16 v2, v66, 8, v78
    v_mad_u32_u16 v3, v66, 8, v78 op_sel:[1,0,0,0]
    ds_write_b64 v2, v[34:35]
    ds_write_b64 v3, v[32:33]
F_s2:
    s_mov_b64 exec, s[78:79]
    s_cbranch_execz F_s3
F_sp3:
    v_cmp_ne_u32 vcc, s88, v39
    s_cbranch_vccnz F_sa3
F_sg3:
    v_cmpx_lt_u32 vcc, 8, v59
    v_and_b32 v38, 0x7ff, v38
    v_lshl_add_u32 v38, v38, 5, v90
    v_add_u32 v38, 983040, v38
    v_or_b32 v39, 16, v38
    v_mad_u32_u16 v2, v67, 8, v79
    v_mad_u32_u16 v3, v67, 8, v79 op_sel:[1,0,0,0]
    ds_write_b64 v2, v[38:39]
    ds_write_b64 v3, v[36:37]
F_s3:
    s_mov_b64 exec, -1
    s_cmp_lg_u64 s[30:31], 0
    s_cbranch_scc1 F_u
F_ur:
    s_mov_b32 s22, s80
    s_mov_b32 s27, s80
    s_mov_b32 s71, s80
    s_bfe_u32 s46, s71, 0x30012
    s_mov_b32 m0, s46
    s_and_b32 s66, s71, 0x3ffff
    s_movrels_b32 s68, s57
    s_movrels_b32 s69, s61
    s_sub_u32 s48, s66, s47
    s_mov_b32 s47, s66
    s_lshr_b32 s52, s71, 28
    s_lshl_b32 s67, s46, 9
    s_add_u32 s66, s66, s67
    s_sub_u32 s49, s66, s42
    s_mov_b32 s42, s66
    s_bfe_u32 s66, s68, 655360
    s_add_u32 s43, s42, s66
    s_bfe_u32 s39, s69, 655360
    s_bfe_u32 s66, s68, 655370
    s_add_u32 s44, s42, s66
    s_bfe_u32 s40, s69, 655370
    s_bfe_u32 s66, s68, 655380
    s_add_u32 s45, s42, s66
    s_bfe_u32 s41, s69, 655380
    s_and_b32 s66, s46, s33
    s_cselect_b32 s72, -1, 1
    s_cselect_b32 s76, s47, 163712
    s_cmp_ge_u32 s66, 2
    s_cselect_b32 s73, -1, 0
    s_add_u32 s77, s47, 1024
    s_cmp_ge_u32 s66, 4
    s_cselect_b32 s75, -1, 0
    s_cmp_ge_u32 s66, 3
    s_cselect_b32 s74, -1, 1
    s_cselect_b32 s77, s77, 163712
    s_mul_i32 s66, s20, 80
    v_min_u32 v2, 76, v248
    s_waitcnt lgkmcnt(0)
    s_barrier
    v_add_u32 v253, s47, v248
    ds_read_b32 v254, v253
    ds_read_b32 v255, v253 offset:256
    v_add_u32 v252, s42, v247
    ds_read_u16 v234, v252
    ds_read_u16 v235, v252 offset:64
    v_add_u32 v252, s43, v247
    ds_read_u16 v236, v252
    ds_read_u16 v237, v252 offset:64
    v_add_u32 v252, s44, v247
    ds_read_u16 v238, v252
    ds_read_u16 v239, v252 offset:64
    v_add_u32 v252, s45, v247
    ds_read_u16 v240, v252
    ds_read_u16 v241, v252 offset:64
    buffer_load_dword v3, v2, s[16:19], s66 offen offset:128 sc1
    v_add_u32 v249, s48, v249
    v_add_u32 v250, s49, v250
    s_waitcnt lgkmcnt(8)
    s_mov_b32 m0, s76
    s_mov_b64 exec, s[72:73]
    buffer_load_dwordx4 v254, s[12:15], 0 offen  lds
    s_mov_b32 m0, s77
    s_mov_b64 exec, s[74:75]
    buffer_load_dwordx4 v255, s[12:15], 0 offen  lds
    s_mov_b64 exec, -1
    s_waitcnt lgkmcnt(0)
    s_add_u32 m0, s21, 0
    v_lshl_add_u32 v234, v234, 10, v246
    v_lshl_add_u32 v235, v235, 10, v246
    buffer_load_dwordx4 v234, s[4:7], s38 offen lds
    buffer_load_dwordx4 v235, s[8:11], s38 offen offset:1024 lds
    s_add_u32 m0, s21, 2048
    v_lshl_add_u32 v236, v236, 10, v246
    v_lshl_add_u32 v237, v237, 10, v246
    buffer_load_dwordx4 v236, s[4:7], s39 offen lds
    buffer_load_dwordx4 v237, s[8:11], s39 offen offset:1024 lds
    s_add_u32 m0, s21, 4096
    v_lshl_add_u32 v238, v238, 10, v246
    v_lshl_add_u32 v239, v239, 10, v246
    buffer_load_dwordx4 v238, s[4:7], s40 offen lds
    buffer_load_dwordx4 v239, s[8:11], s40 offen offset:1024 lds
    s_add_u32 m0, s21, 6144
    v_lshl_add_u32 v240, v240, 10, v246
    v_lshl_add_u32 v241, v241, 10, v246
    buffer_load_dwordx4 v240, s[4:7], s41 offen lds
    buffer_load_dwordx4 v241, s[8:11], s41 offen offset:1024 lds
    v_lshrrev_b32 v8, 3, v84
    v_and_b32 v9, 7, v84
    v_lshlrev_b32 v9, 13, v9
    v_mul_u32_u24 v8, 1536, v8
    v_and_b32 v5, 128, v86
    v_add3_u32 v8, v8, v9, v5
    v_xor_b32 v9, v86, v7
    v_and_b32 v9, 128, v9
    v_add_u32 v9, v9, v7
    v_and_b32 v4, 0x70, v86
    v_or_b32 v5, v9, v4
    s_add_u32 s66, s20, 0
    v_cmp_eq_u32 vcc, s66, v84
    s_ff1_i32_b64 s67, vcc
    v_readlane_b32 s28, v5, s67
    s_add_u32 s66, s20, 8
    v_cmp_eq_u32 vcc, s66, v84
    s_ff1_i32_b64 s67, vcc
    v_readlane_b32 s29, v5, s67
    v_readlane_b32 s23, v6, s67
    s_add_u32 s66, s20, 16
    v_cmp_eq_u32 vcc, s66, v84
    s_ff1_i32_b64 s67, vcc
    v_readlane_b32 s30, v5, s67
    v_readlane_b32 s24, v6, s67
    s_add_u32 s66, s20, 24
    v_cmp_eq_u32 vcc, s66, v84
    s_ff1_i32_b64 s67, vcc
    v_readlane_b32 s31, v5, s67
    v_readlane_b32 s25, v6, s67
    s_add_u32 s66, s20, 32
    v_cmp_eq_u32 vcc, s66, v84
    s_ff1_i32_b64 s67, vcc
    v_readlane_b32 s32, v5, s67
    v_readlane_b32 s26, v6, s67
    v_lshlrev_b32 v4, 3, v1
    v_add_u32 v4, 163328, v4
    s_mov_b32 exec_hi, 0xff
    ds_write_b64 v4, v[8:9]
    s_mov_b32 exec_hi, -1
    s_waitcnt lgkmcnt(0)
    v_mov_b32 v252, 0
    s_waitcnt vmcnt(6)
    v_cmp_ne_u32 vcc, s88, v3
    ds_read_b64_tr_b16 v[176:177], v244 offset:0
    ds_read_b64_tr_b16 v[178:179], v244 offset:1024
    ds_read_b64_tr_b16 v[180:181], v245 offset:0
    ds_read_b64_tr_b16 v[182:183], v245 offset:1024
    ds_read_b64_tr_b16 v[64:65], v249 offset:0
    ds_read_b64_tr_b16 v[68:69], v249 offset:64
    ds_read_b64_tr_b16 v[66:67], v249 offset:256
    ds_read_b64_tr_b16 v[70:71], v249 offset:320
    s_mov_b64 exec, s[54:55]
    ds_read_u16_d16_hi v242, v250 offset:0
    s_mov_b64 exec, -1
    s_or_b32 s89, vcc_lo, vcc_hi
    s_waitcnt lgkmcnt(5)
    v_readfirstlane_b32 s66, v252
    s_add_u32 s53, s53, 1
    v_mov_b32 v252, s53
    s_cmp_le_u32 s53, s66
    ds_write2_b32 v251, v252, v252 offset0:0 offset1:8
    s_setprio 1
    s_cbranch_scc1 PRIO_1
    s_setprio 0
PRIO_1:
    s_cmp_eq_u32 s52, 4
    s_cbranch_scc1 ITEM_0_4
    s_cmp_eq_u32 s52, 5
    s_cbranch_scc1 ITEM_0_5
    s_cmp_eq_u32 s52, 3
    s_cbranch_scc1 ITEM_0_3
    s_cmp_eq_u32 s52, 6
    s_cbranch_scc1 ITEM_0_6
    s_cmp_eq_u32 s52, 8
    s_cbranch_scc1 ITEM_0_8
    s_branch ITEM_0_2
F_again:
    s_sub_u32 s27, s27, 1
    s_cbranch_scc1 F_late
    s_cmp_eq_u64 s[72:73], 0
    s_cbranch_scc1 F_p0
    buffer_load_dwordx4 v[8:11], v86, s[16:19], s24 offen offset:0 sc1
F_p0:
    s_cmp_eq_u64 s[74:75], 0
    s_cbranch_scc1 F_p1
    buffer_load_dwordx4 v[12:15], v86, s[16:19], s24 offen offset:1024 sc1
F_p1:
    s_cmp_eq_u64 s[76:77], 0
    s_cbranch_scc1 F_p2
    buffer_load_dwordx4 v[16:19], v86, s[16:19], s24 offen offset:2048 sc1
F_p2:
    s_cmp_eq_u64 s[78:79], 0
    s_cbranch_scc1 F_p3
    s_mov_b64 exec, s[22:23]
    buffer_load_dwordx4 v[20:23], v86, s[16:19], s24 offen offset:3072 sc1
    s_mov_b64 exec, -1
F_p3:
    s_branch F_poll
F_late:
    v_mov_b32 v2, 163064
    v_mov_b32 v4, 1000
    ds_write_b32 v2, v4
    v_mov_b32 v10, 0
    v_mov_b32 v14, 0
    v_mov_b32 v18, 0
    v_mov_b32 v22, 0
    s_branch F_got
F_l3:
    v_bfe_u32 v2, v10, 23, 5
    v_sub_u32 v56, v2, v91
    v_cmp_lt_u32 vcc, 16, v2
    s_mov_b64 exec, vcc
    s_cbranch_execz F_t0
F_tp0:
    buffer_load_dwordx4 v[40:43], v86, s[16:19], s26 offen offset:0 sc1
    s_waitcnt vmcnt(0)
    v_cmp_ne_u32 vcc, s88, v43
    s_sub_u32 s27, s27, 1
    s_cselect_b64 vcc, 0, vcc
    s_cmp_eq_u64 vcc, 0
    s_cbranch_scc0 F_tp0
    v_bfe_u32 v68, v42, 11, 6
    v_lshl_add_u32 v68, v68, 2, s71
    v_cmp_lt_i32 vcc, 16, v56
    s_mov_b64 exec, vcc
    ds_add_rtn_u32 v80, v68, v3
F_t0:
    s_mov_b64 exec, -1
    v_bfe_u32 v2, v14, 23, 5
    v_sub_u32 v57, v2, v91
    v_cmp_lt_u32 vcc, 16, v2
    s_mov_b64 exec, vcc
    s_cbranch_execz F_t1
F_tp1:
    buffer_load_dwordx4 v[44:47], v86, s[16:19], s26 offen offset:1024 sc1
    s_waitcnt vmcnt(0)
    v_cmp_ne_u32 vcc, s88, v47
    s_sub_u32 s27, s27, 1
    s_cselect_b64 vcc, 0, vcc
    s_cmp_eq_u64 vcc, 0
    s_cbranch_scc0 F_tp1
    v_bfe_u32 v69, v46, 11, 6
    v_lshl_add_u32 v69, v69, 2, s71
    v_cmp_lt_i32 vcc, 16, v57
    s_mov_b64 exec, vcc
    ds_add_rtn_u32 v81, v69, v3
F_t1:
    s_mov_b64 exec, -1
    v_bfe_u32 v2, v18, 23, 5
    v_sub_u32 v58, v2, v91
    v_cmp_lt_u32 vcc, 16, v2
    s_mov_b64 exec, vcc
    s_cbranch_execz F_t2
F_tp2:
    buffer_load_dwordx4 v[48:51], v86, s[16:19], s26 offen offset:2048 sc1
    s_waitcnt vmcnt(0)
    v_cmp_ne_u32 vcc, s88, v51
    s_sub_u32 s27, s27, 1
    s_cselect_b64 vcc, 0, vcc
    s_cmp_eq_u64 vcc, 0
    s_cbranch_scc0 F_tp2
    v_bfe_u32 v70, v50, 11, 6
    v_lshl_add_u32 v70, v70, 2, s71
    v_cmp_lt_i32 vcc, 16, v58
    s_mov_b64 exec, vcc
    ds_add_rtn_u32 v82, v70, v3
F_t2:
    s_mov_b64 exec, -1
    v_bfe_u32 v2, v22, 23, 5
    v_sub_u32 v59, v2, v91
    v_cmp_lt_u32 vcc, 16, v2
    s_mov_b64 exec, vcc
    s_cbranch_execz F_t3
F_tp3:
    buffer_load_dwordx4 v[52:55], v86, s[16:19], s26 offen offset:3072 sc1
    s_waitcnt vmcnt(0)
    v_cmp_ne_u32 vcc, s88, v55
    s_sub_u32 s27, s27, 1
    s_cselect_b64 vcc, 0, vcc
    s_cmp_eq_u64 vcc, 0
    s_cbranch_scc0 F_tp3
    v_bfe_u32 v71, v54, 11, 6
    v_lshl_add_u32 v71, v71, 2, s71
    v_cmp_lt_i32 vcc, 16, v59
    s_mov_b64 exec, vcc
    ds_add_rtn_u32 v83, v71, v3
F_t3:
    s_mov_b64 exec, -1
    v_mov_b32 v2, 163068
    v_mov_b32 v4, 1000
    v_cmp_lt_u32 vcc, 24, v89
    s_mov_b64 exec, vcc
    ds_write_b32 v2, v4
    s_mov_b64 exec, -1
    s_branch F_l3r
F_flag:
    s_lshl_b32 s66, s2, 2
    v_mov_b32 v2, 128
    v_mov_b32 v4, s88
    s_mov_b64 exec, 1
    buffer_store_dword v4, v2, s[16:19], s66 offen sc1
    s_mov_b64 exec, -1
    s_branch F_flagr
F_sa0:
    s_sub_u32 s27, s27, 1
    s_cbranch_scc1 F_sg0
    buffer_load_dwordx4 v[24:27], v86, s[16:19], s25 offen offset:0 sc1
    s_waitcnt vmcnt(0)
    s_branch F_sp0
F_sa1:
    s_sub_u32 s27, s27, 1
    s_cbranch_scc1 F_sg1
    buffer_load_dwordx4 v[28:31], v86, s[16:19], s25 offen offset:1024 sc1
    s_waitcnt vmcnt(0)
    s_branch F_sp1
F_sa2:
    s_sub_u32 s27, s27, 1
    s_cbranch_scc1 F_sg2
    buffer_load_dwordx4 v[32:35], v86, s[16:19], s25 offen offset:2048 sc1
    s_waitcnt vmcnt(0)
    s_branch F_sp2
F_sa3:
    s_sub_u32 s27, s27, 1
    s_cbranch_scc1 F_sg3
    buffer_load_dwordx4 v[36:39], v86, s[16:19], s25 offen offset:3072 sc1
    s_waitcnt vmcnt(0)
    s_branch F_sp3
F_u:
    ds_bpermute_b32 v68, v68, v92
    ds_bpermute_b32 v69, v69, v92
    ds_bpermute_b32 v70, v70, v92
    ds_bpermute_b32 v71, v71, v92
    s_waitcnt lgkmcnt(0)
    v_cmp_lt_i32 vcc, 16, v56
    s_mov_b64 exec, vcc
    s_cbranch_execz F_u0
    v_lshlrev_b32 v80, 3, v80
    v_and_b32 v42, 0x7ff, v42
    v_lshl_add_u32 v42, v42, 5, v90
    v_or_b32 v43, 16, v42
    v_mad_u32_u16 v2, v68, 8, v80
    v_mad_u32_u16 v3, v68, 8, v80 op_sel:[1,0,0,0]
    ds_write_b64 v2, v[42:43]
    ds_write_b64 v3, v[40:41]
F_u0:
    s_mov_b64 exec, -1
    v_cmp_lt_i32 vcc, 16, v57
    s_mov_b64 exec, vcc
    s_cbranch_execz F_u1
    v_lshlrev_b32 v81, 3, v81
    v_and_b32 v46, 0x7ff, v46
    v_lshl_add_u32 v46, v46, 5, v90
    v_add_u32 v46, 327680, v46
    v_or_b32 v47, 16, v46
    v_mad_u32_u16 v2, v69, 8, v81
    v_mad_u32_u16 v3, v69, 8, v81 op_sel:[1,0,0,0]
    ds_write_b64 v2, v[46:47]
    ds_write_b64 v3, v[44:45]
F_u1:
    s_mov_b64 exec, -1
    v_cmp_lt_i32 vcc, 16, v58
    s_mov_b64 exec, vcc
    s_cbranch_execz F_u2
    v_lshlrev_b32 v82, 3, v82
    v_and_b32 v50, 0x7ff, v50
    v_lshl_add_u32 v50, v50, 5, v90
    v_add_u32 v50, 655360, v50
    v_or_b32 v51, 16, v50
    v_mad_u32_u16 v2, v70, 8, v82
    v_mad_u32_u16 v3, v70, 8, v82 op_sel:[1,0,0,0]
    ds_write_b64 v2, v[50:51]
    ds_write_b64 v3, v[48:49]
F_u2:
    s_mov_b64 exec, -1
    v_cmp_lt_i32 vcc, 16, v59
    s_mov_b64 exec, vcc
    s_cbranch_execz F_u3
    v_lshlrev_b32 v83, 3, v83
    v_and_b32 v54, 0x7ff, v54
    v_lshl_add_u32 v54, v54, 5, v90
    v_add_u32 v54, 983040, v54
    v_or_b32 v55, 16, v54
    v_mad_u32_u16 v2, v71, 8, v83
    v_mad_u32_u16 v3, v71, 8, v83 op_sel:[1,0,0,0]
    ds_write_b64 v2, v[54:55]
    ds_write_b64 v3, v[52:53]
F_u3:
    s_mov_b64 exec, -1
    s_branch F_ur
LAST0:
    s_cmp_eq_u32 s50, 5
    s_cbranch_scc1 TO_PHASE1
    s_add_u32 s4, s4, 128
    s_addc_u32 s5, s5, 0
    s_add_u32 s8, s8, 128
    s_addc_u32 s9, s9, 0
    s_mov_b32 s34, 0
    s_mov_b32 s35, 256
    s_mov_b32 s36, 512
    s_mov_b32 s37, 768
    s_mov_b32 s33, 0
    s_waitcnt lgkmcnt(5)
    v_readfirstlane_b32 s66, v252
    s_add_u32 s53, s53, 1
    v_mov_b32 v252, s53
    s_cmp_le_u32 s53, s66
    ds_write2_b32 v251, v252, v252 offset0:0 offset1:8
    s_setprio 1
    s_cbranch_scc1 PRIO_2
    s_setprio 0
PRIO_2:
    s_cmp_eq_u32 s52, 4
    s_cbranch_scc1 ITEM_0_4
    s_cmp_eq_u32 s52, 5
    s_cbranch_scc1 ITEM_0_5
    s_cmp_eq_u32 s52, 3
    s_cbranch_scc1 ITEM_0_3
    s_cmp_eq_u32 s52, 6
    s_cbranch_scc1 ITEM_0_6
    s_cmp_eq_u32 s52, 8
    s_cbranch_scc1 ITEM_0_8
    s_branch ITEM_0_2
TO_PHASE1:
    v_lshlrev_b32 v253, 2, v248
    v_add_u32 v253, 65536, v253
    ds_read_b128 v[96:99], v253 offset:0
    ds_read_b128 v[100:103], v253 offset:1024
    ds_read_b128 v[104:107], v253 offset:2048
    ds_read_b128 v[108:111], v253 offset:3072
    ds_read_b128 v[112:115], v253 offset:4096
    ds_read_b128 v[116:119], v253 offset:5120
    ds_read_b128 v[120:123], v253 offset:6144
    ds_read_b128 v[124:127], v253 offset:7168
    ds_read_b128 v[128:131], v253 offset:8192
    ds_read_b128 v[132:135], v253 offset:9216
    ds_read_b128 v[136:139], v253 offset:10240
    ds_read_b128 v[140:143], v253 offset:11264
    ds_read_b128 v[144:147], v253 offset:12288
    ds_read_b128 v[148:151], v253 offset:13312
    ds_read_b128 v[152:155], v253 offset:14336
    ds_read_b128 v[156:159], v253 offset:15360
    ds_read_b128 v[160:163], v253 offset:16384
    ds_read_b128 v[164:167], v253 offset:17408
    ds_read_b128 v[168:171], v253 offset:18432
    ds_read_b128 v[172:175], v253 offset:19456
    s_mov_b32 s34, 128
    s_mov_b32 s35, 384
    s_mov_b32 s36, 640
    s_mov_b32 s37, 896
    s_mov_b32 s50, 0
    s_waitcnt lgkmcnt(0)
    s_waitcnt lgkmcnt(0)
    v_readfirstlane_b32 s66, v252
    s_add_u32 s53, s53, 1
    v_mov_b32 v252, s53
    s_cmp_le_u32 s53, s66
    ds_write2_b32 v251, v252, v252 offset0:0 offset1:8
    s_setprio 1
    s_cbranch_scc1 PRIO_3
    s_setprio 0
PRIO_3:
    s_cmp_eq_u32 s52, 4
    s_cbranch_scc1 ITEM_1_4
    s_cmp_eq_u32 s52, 5
    s_cbranch_scc1 ITEM_1_5
    s_cmp_eq_u32 s52, 3
    s_cbranch_scc1 ITEM_1_3
    s_cmp_eq_u32 s52, 6
    s_cbranch_scc1 ITEM_1_6
    s_cmp_eq_u32 s52, 8
    s_cbranch_scc1 ITEM_1_8
    s_branch ITEM_1_2
LAST1:
    s_cmp_eq_u32 s50, 5
    s_cbranch_scc1 TAIL
    v_mov_b32 v246, 0x7f000000
    s_load_dwordx2 s[72:73], s[0:1], 72
    s_waitcnt lgkmcnt(7)
    v_readfirstlane_b32 s66, v252
    s_add_u32 s53, s53, 1
    v_mov_b32 v252, s53
    s_cmp_le_u32 s53, s66
    ds_write2_b32 v251, v252, v252 offset0:0 offset1:8
    s_setprio 1
    s_cbranch_scc1 PRIO_4
    s_setprio 0
PRIO_4:
    s_cmp_eq_u32 s52, 4
    s_cbranch_scc1 ITEM_1_4
    s_cmp_eq_u32 s52, 5
    s_cbranch_scc1 ITEM_1_5
    s_cmp_eq_u32 s52, 3
    s_cbranch_scc1 ITEM_1_3
    s_cmp_eq_u32 s52, 6
    s_cbranch_scc1 ITEM_1_6
    s_cmp_eq_u32 s52, 8
    s_cbranch_scc1 ITEM_1_8
    s_branch ITEM_1_2
.p2align 6
ITEM_0_4:
    s_mov_b64 exec, s[54:55]
    ds_read_u16_d16_hi v243, v250 offset:128
    s_mov_b64 exec, -1
    ds_read_b64_tr_b16 v[72:73], v249 offset:512
    ds_read_b64_tr_b16 v[76:77], v249 offset:576
    ds_read_b64_tr_b16 v[74:75], v249 offset:768
    ds_read_b64_tr_b16 v[78:79], v249 offset:832
    s_waitcnt lgkmcnt(5)
    v_mul_f32_dpp v196, v242, v64 row_newbcast:0 row_mask:0xf bank_mask:0xf
    v_mul_f32_dpp v197, v242, v65 row_newbcast:1 row_mask:0xf bank_mask:0xf
    v_mul_f32_dpp v198, v242, v64 row_newbcast:8 row_mask:0xf bank_mask:0xf
    v_mul_f32_dpp v199, v242, v65 row_newbcast:9 row_mask:0xf bank_mask:0xf
    v_mul_f32_dpp v200, v242, v68 row_newbcast:2 row_mask:0xf bank_mask:0xf
    v_mul_f32_dpp v201, v242, v69 row_newbcast:3 row_mask:0xf bank_mask:0xf
    v_mul_f32_dpp v202, v242, v68 row_newbcast:10 row_mask:0xf bank_mask:0xf
    v_mul_f32_dpp v203, v242, v69 row_newbcast:11 row_mask:0xf bank_mask:0xf
    v_cvt_pk_bf16_f32 v64, v196, v197
    v_cvt_pk_bf16_f32 v68, v198, v199
    v_cvt_pk_bf16_f32 v65, v200, v201
    v_cvt_pk_bf16_f32 v69, v202, v203
    v_mul_f32_dpp v196, v242, v66 row_newbcast:4 row_mask:0xf bank_mask:0xf
    v_mul_f32_dpp v197, v242, v67 row_newbcast:5 row_mask:0xf bank_mask:0xf
    v_mul_f32_dpp v198, v242, v66 row_newbcast:12 row_mask:0xf bank_mask:0xf
    v_mul_f32_dpp v199, v242, v67 row_newbcast:13 row_mask:0xf bank_mask:0xf
    v_mul_f32_dpp v200, v242, v70 row_newbcast:6 row_mask:0xf bank_mask:0xf
    v_mul_f32_dpp v201, v242, v71 row_newbcast:7 row_mask:0xf bank_mask:0xf
    v_mul_f32_dpp v202, v242, v70 row_newbcast:14 row_mask:0xf bank_mask:0xf
    v_mul_f32_dpp v203, v242, v71 row_newbcast:15 row_mask:0xf bank_mask:0xf
    v_cvt_pk_bf16_f32 v66, v196, v197
    v_cvt_pk_bf16_f32 v70, v198, v199
    v_cvt_pk_bf16_f32 v67, v200, v201
    v_cvt_pk_bf16_f32 v71, v202, v203
    s_nop 0
    s_waitcnt vmcnt(4) lgkmcnt(0)
    v_mfma_f32_32x32x16_bf16 v[0:15], v[64:67], v[176:179], 0
    v_mul_f32_dpp v196, v243, v72 row_newbcast:0 row_mask:0xf bank_mask:0xf
    v_mul_f32_dpp v197, v243, v73 row_newbcast:1 row_mask:0xf bank_mask:0xf
    v_mul_f32_dpp v198, v243, v72 row_newbcast:8 row_mask:0xf bank_mask:0xf
    v_mul_f32_dpp v199, v243, v73 row_newbcast:9 row_mask:0xf bank_mask:0xf
    v_mul_f32_dpp v200, v243, v76 row_newbcast:2 row_mask:0xf bank_mask:0xf
    v_mul_f32_dpp v201, v243, v77 row_newbcast:3 row_mask:0xf bank_mask:0xf
    v_mul_f32_dpp v202, v243, v76 row_newbcast:10 row_mask:0xf bank_mask:0xf
    v_mul_f32_dpp v203, v243, v77 row_newbcast:11 row_mask:0xf bank_mask:0xf
    v_cvt_pk_bf16_f32 v72, v196, v197
    v_cvt_pk_bf16_f32 v76, v198, v199
    v_cvt_pk_bf16_f32 v73, v200, v201
    v_cvt_pk_bf16_f32 v77, v202, v203
    s_add_u32 m0, s21, 0
    v_mfma_f32_32x32x16_bf16 v[16:31], v[68:71], v[176:179], 0
    buffer_load_dwordx4 v234, s[4:7], s36 offen lds
    buffer_load_dwordx4 v235, s[8:11], s36 offen offset:1024 lds
    ds_read_b64_tr_b16 v[176:177], v244 offset:2048
    ds_read_b64_tr_b16 v[178:179], v244 offset:3072
    ds_read_b64_tr_b16 v[184:185], v245 offset:2048
    ds_read_b64_tr_b16 v[186:187], v245 offset:3072
    v_mul_f32_dpp v196, v243, v74 row_newbcast:4 row_mask:0xf bank_mask:0xf
    v_mul_f32_dpp v197, v243, v75 row_newbcast:5 row_mask:0xf bank_mask:0xf
    v_mul_f32_dpp v198, v243, v74 row_newbcast:12 row_mask:0xf bank_mask:0xf
    v_mul_f32_dpp v199, v243, v75 row_newbcast:13 row_mask:0xf bank_mask:0xf
    v_mul_f32_dpp v200, v243, v78 row_newbcast:6 row_mask:0xf bank_mask:0xf
    v_mul_f32_dpp v201, v243, v79 row_newbcast:7 row_mask:0xf bank_mask:0xf
    v_mul_f32_dpp v202, v243, v78 row_newbcast:14 row_mask:0xf bank_mask:0xf
    v_mul_f32_dpp v203, v243, v79 row_newbcast:15 row_mask:0xf bank_mask:0xf
    v_cvt_pk_bf16_f32 v74, v196, v197
    v_cvt_pk_bf16_f32 v78, v198, v199
    v_cvt_pk_bf16_f32 v75, v200, v201
    v_cvt_pk_bf16_f32 v79, v202, v203
    s_nop 0
    s_waitcnt lgkmcnt(0)
    v_mfma_f32_32x32x16_bf16 v[0:15], v[72:75], v[176:179], v[0:15]
    s_add_u32 m0, s21, 2048
    v_mfma_f32_32x32x16_bf16 v[16:31], v[76:79], v[176:179], v[16:31]
    buffer_load_dwordx4 v236, s[4:7], s36 offen lds
    buffer_load_dwordx4 v237, s[8:11], s36 offen offset:1024 lds
    s_mov_b32 m0, s50
    s_nop 0
    s_movrels_b32 s71, s23
    s_bfe_u32 s46, s71, 0x30012
    s_mov_b32 m0, s46
    s_and_b32 s66, s71, 0x3ffff
    s_movrels_b32 s68, s57
    s_movrels_b32 s69, s61
    s_sub_u32 s48, s66, s47
    s_mov_b32 s47, s66
    s_lshr_b32 s52, s71, 28
    s_lshl_b32 s67, s46, 9
    s_add_u32 s66, s66, s67
    s_sub_u32 s49, s66, s42
    s_mov_b32 s42, s66
    s_bfe_u32 s66, s68, 655360
    s_add_u32 s43, s42, s66
    s_bfe_u32 s39, s69, 655360
    s_bfe_u32 s66, s68, 655370
    s_add_u32 s44, s42, s66
    s_bfe_u32 s40, s69, 655370
    s_bfe_u32 s66, s68, 655380
    s_add_u32 s45, s42, s66
    s_bfe_u32 s41, s69, 655380
    s_and_b32 s66, s46, s33
    s_cselect_b32 s72, -1, 1
    s_cselect_b32 s76, s47, 163712
    s_cmp_ge_u32 s66, 2
    s_cselect_b32 s73, -1, 0
    s_add_u32 s77, s47, 1024
    s_cmp_ge_u32 s66, 4
    s_cselect_b32 s75, -1, 0
    s_cmp_ge_u32 s66, 3
    s_cselect_b32 s74, -1, 1
    s_cselect_b32 s77, s77, 163712
    v_add_u32 v252, s44, v247
    ds_read_u16 v238, v252
    ds_read_u16 v239, v252 offset:64
    v_add_u32 v252, s45, v247
    ds_read_u16 v240, v252
    ds_read_u16 v241, v252 offset:64
    v_mfma_f32_32x32x16_bf16 v[32:47], v[64:67], v[180:183], 0
    v_mul_f32 v196, v0, v96
    v_fmac_f32 v196, v1, v97
    v_fmac_f32 v196, v2, v98
    v_fmac_f32 v196, v3, v99
    v_fmac_f32 v196, v4, v100
    v_fmac_f32 v196, v5, v101
    v_fmac_f32 v196, v6, v102
    v_fmac_f32 v196, v7, v103
    v_mul_f32 v198, v8, v128
    v_fmac_f32 v198, v9, v129
    v_mfma_f32_32x32x16_bf16 v[48:63], v[68:71], v[180:183], 0
    v_add_u32 v253, s47, v248
    ds_read_b32 v254, v253
    ds_read_b32 v255, v253 offset:256
    s_waitcnt vmcnt(6)
    ds_read_b64_tr_b16 v[176:177], v244 offset:4096
    ds_read_b64_tr_b16 v[178:179], v244 offset:5120
    ds_read_b64_tr_b16 v[180:181], v245 offset:4096
    ds_read_b64_tr_b16 v[182:183], v245 offset:5120
    v_fmac_f32 v198, v10, v130
    v_fmac_f32 v198, v11, v131
    v_fmac_f32 v198, v12, v132
    v_fmac_f32 v198, v13, v133
    v_fmac_f32 v198, v14, v134
    v_fmac_f32 v198, v15, v135
    v_mul_f32 v200, v16, v128
    v_fmac_f32 v200, v17, v129
    v_permlane32_swap_b32 v196, v198
    v_mfma_f32_32x32x16_bf16 v[32:47], v[72:75], v[184:187], v[32:47]
    v_fmac_f32 v200, v18, v130
    v_fmac_f32 v200, v19, v131
    v_fmac_f32 v200, v20, v132
    v_fmac_f32 v200, v21, v133
    v_fmac_f32 v200, v22, v134
    v_fmac_f32 v200, v23, v135
    v_add_f32 v198, v196, v198
    v_mul_f32_e64 v202, v24, -v128
    v_fma_f32 v202, v25, -v129, v202
    v_mfma_f32_32x32x16_bf16 v[48:63], v[76:79], v[184:187], v[48:63]
    v_fma_f32 v202, v26, -v130, v202
    v_fma_f32 v202, v27, -v131, v202
    v_fma_f32 v202, v28, -v132, v202
    v_fma_f32 v202, v29, -v133, v202
    v_fma_f32 v202, v30, -v134, v202
    v_fma_f32 v202, v31, -v135, v202
    s_nop 1
    v_permlane32_swap_b32 v200, v202
    v_add_f32 v202, v200, v202
    s_waitcnt vmcnt(4) lgkmcnt(0)
    v_mfma_f32_32x32x16_bf16 v[0:15], v[64:67], v[176:179], 0
    v_mul_f32 v197, v32, v104
    v_fmac_f32 v197, v33, v105
    v_fmac_f32 v197, v34, v106
    v_fmac_f32 v197, v35, v107
    v_fmac_f32 v197, v36, v108
    v_fmac_f32 v197, v37, v109
    v_fmac_f32 v197, v38, v110
    v_fmac_f32 v197, v39, v111
    v_mul_f32 v199, v40, v136
    v_fmac_f32 v199, v41, v137
    v_fmac_f32 v199, v42, v138
    s_add_u32 m0, s21, 4096
    v_mfma_f32_32x32x16_bf16 v[16:31], v[68:71], v[176:179], 0
    buffer_load_dwordx4 v234, s[4:7], s37 offen lds
    buffer_load_dwordx4 v235, s[8:11], s37 offen offset:1024 lds
    ds_read_b64_tr_b16 v[176:177], v244 offset:6144
    ds_read_b64_tr_b16 v[178:179], v244 offset:7168
    ds_read_b64_tr_b16 v[184:185], v245 offset:6144
    ds_read_b64_tr_b16 v[186:187], v245 offset:7168
    v_add_u32 v252, s42, v247
    ds_read_u16 v234, v252
    ds_read_u16 v235, v252 offset:64
    s_mov_b32 m0, s76
    s_mov_b64 exec, s[72:73]
    buffer_load_dwordx4 v254, s[12:15], 0 offen  lds
    s_mov_b32 m0, s77
    s_mov_b64 exec, s[74:75]
    buffer_load_dwordx4 v255, s[12:15], 0 offen  lds
    s_mov_b64 exec, -1
    v_fmac_f32 v199, v43, v139
    v_fmac_f32 v199, v44, v140
    v_fmac_f32 v199, v45, v141
    v_fmac_f32 v199, v46, v142
    v_fmac_f32 v199, v47, v143
    v_mul_f32 v201, v48, v136
    v_fmac_f32 v201, v49, v137
    v_permlane32_swap_b32 v197, v199
    v_fmac_f32 v201, v50, v138
    v_fmac_f32 v201, v51, v139
    s_waitcnt lgkmcnt(2)
    v_mfma_f32_32x32x16_bf16 v[0:15], v[72:75], v[176:179], v[0:15]
    v_fmac_f32 v201, v52, v140
    v_fmac_f32 v201, v53, v141
    v_fmac_f32 v201, v54, v142
    v_fmac_f32 v201, v55, v143
    v_add_f32 v199, v197, v199
    v_mul_f32_e64 v203, v56, -v136
    v_fma_f32 v203, v57, -v137, v203
    v_fma_f32 v203, v58, -v138, v203
    v_fma_f32 v203, v59, -v139, v203
    v_fma_f32 v203, v60, -v140, v203
    v_fma_f32 v203, v61, -v141, v203
    s_add_u32 m0, s21, 6144
    v_mfma_f32_32x32x16_bf16 v[16:31], v[76:79], v[176:179], v[16:31]
    buffer_load_dwordx4 v236, s[4:7], s37 offen lds
    buffer_load_dwordx4 v237, s[8:11], s37 offen offset:1024 lds
    v_add_u32 v252, s43, v247
    ds_read_u16 v236, v252
    ds_read_u16 v237, v252 offset:64
    v_fma_f32 v203, v62, -v142, v203
    v_fma_f32 v203, v63, -v143, v203
    s_nop 1
    v_permlane32_swap_b32 v201, v203
    v_add_f32 v203, v201, v203
    s_set_gpr_idx_on s51, gpr_idx(DST)
    s_nop 0
    v_cvt_pk_bf16_f32 v204, v198, v199
    v_cvt_pk_bf16_f32 v205, v202, v203
    s_set_gpr_idx_off
    v_mfma_f32_32x32x16_bf16 v[32:47], v[64:67], v[180:183], 0
    v_mul_f32 v196, v0, v144
    v_fmac_f32 v196, v1, v145
    v_fmac_f32 v196, v2, v146
    v_fmac_f32 v196, v3, v147
    v_fmac_f32 v196, v4, v148
    v_fmac_f32 v196, v5, v149
    v_fmac_f32 v196, v6, v150
    v_fmac_f32 v196, v7, v151
    v_mfma_f32_32x32x16_bf16 v[48:63], v[68:71], v[180:183], 0
    s_waitcnt vmcnt(8)
    ds_read_b64_tr_b16 v[176:177], v244 offset:0
    ds_read_b64_tr_b16 v[178:179], v244 offset:1024
    ds_read_b64_tr_b16 v[180:181], v245 offset:0
    ds_read_b64_tr_b16 v[182:183], v245 offset:1024
    v_mul_f32 v198, v8, v112
    v_fmac_f32 v198, v9, v113
    v_fmac_f32 v198, v10, v114
    v_fmac_f32 v198, v11, v115
    v_fmac_f32 v198, v12, v116
    v_fmac_f32 v198, v13, v117
    v_fmac_f32 v198, v14, v118
    v_fmac_f32 v198, v15, v119
    v_mfma_f32_32x32x16_bf16 v[32:47], v[72:75], v[184:187], v[32:47]
    v_mul_f32_e64 v200, v16, -v160
    v_fma_f32 v200, v17, -v161, v200
    v_fma_f32 v200, v18, -v162, v200
    v_fma_f32 v200, v19, -v163, v200
    v_fma_f32 v200, v20, -v164, v200
    v_fma_f32 v200, v21, -v165, v200
    v_fma_f32 v200, v22, -v166, v200
    v_fma_f32 v200, v23, -v167, v200
    v_mfma_f32_32x32x16_bf16 v[48:63], v[76:79], v[184:187], v[48:63]
    v_mul_f32_e64 v202, v24, -v160
    v_fma_f32 v202, v25, -v161, v202
    v_fma_f32 v202, v26, -v162, v202
    v_fma_f32 v202, v27, -v163, v202
    v_fma_f32 v202, v28, -v164, v202
    v_fma_f32 v202, v29, -v165, v202
    v_fma_f32 v202, v30, -v166, v202
    v_fma_f32 v202, v31, -v167, v202
    s_waitcnt vmcnt(6) lgkmcnt(0)
    v_mfma_f32_32x32x16_bf16 v[0:15], v[64:67], v[176:179], 0
    v_mul_f32 v197, v32, v152
    v_fmac_f32 v197, v33, v153
    v_fmac_f32 v197, v34, v154
    v_fmac_f32 v197, v35, v155
    v_fmac_f32 v197, v36, v156
    v_fmac_f32 v197, v37, v157
    v_fmac_f32 v197, v38, v158
    v_fmac_f32 v197, v39, v159
    s_add_u32 m0, s21, 0
    v_mfma_f32_32x32x16_bf16 v[16:31], v[68:71], v[176:179], 0
    v_lshl_add_u32 v234, v234, 10, v246
    v_lshl_add_u32 v235, v235, 10, v246
    buffer_load_dwordx4 v234, s[4:7], s38 offen lds
    buffer_load_dwordx4 v235, s[8:11], s38 offen offset:1024 lds
    ds_read_b64_tr_b16 v[176:177], v244 offset:2048
    ds_read_b64_tr_b16 v[178:179], v244 offset:3072
    ds_read_b64_tr_b16 v[184:185], v245 offset:2048
    ds_read_b64_tr_b16 v[186:187], v245 offset:3072
    v_mul_f32 v199, v40, v120
    v_fmac_f32 v199, v41, v121
    v_fmac_f32 v199, v42, v122
    v_fmac_f32 v199, v43, v123
    v_fmac_f32 v199, v44, v124
    v_fmac_f32 v199, v45, v125
    v_fmac_f32 v199, v46, v126
    v_fmac_f32 v199, v47, v127
    s_waitcnt lgkmcnt(0)
    v_mfma_f32_32x32x16_bf16 v[0:15], v[72:75], v[176:179], v[0:15]
    v_mul_f32_e64 v201, v48, -v168
    v_fma_f32 v201, v49, -v169, v201
    v_fma_f32 v201, v50, -v170, v201
    v_fma_f32 v201, v51, -v171, v201
    v_fma_f32 v201, v52, -v172, v201
    v_fma_f32 v201, v53, -v173, v201
    v_fma_f32 v201, v54, -v174, v201
    v_fma_f32 v201, v55, -v175, v201
    s_add_u32 m0, s21, 2048
    v_mfma_f32_32x32x16_bf16 v[16:31], v[76:79], v[176:179], v[16:31]
    v_lshl_add_u32 v236, v236, 10, v246
    v_lshl_add_u32 v237, v237, 10, v246
    buffer_load_dwordx4 v236, s[4:7], s39 offen lds
    buffer_load_dwordx4 v237, s[8:11], s39 offen offset:1024 lds
    v_mul_f32_e64 v203, v56, -v168
    v_fma_f32 v203, v57, -v169, v203
    v_fma_f32 v203, v58, -v170, v203
    v_fma_f32 v203, v59, -v171, v203
    v_fma_f32 v203, v60, -v172, v203
    v_fma_f32 v203, v61, -v173, v203
    v_fma_f32 v203, v62, -v174, v203
    v_fma_f32 v203, v63, -v175, v203
    v_mfma_f32_32x32x16_bf16 v[32:47], v[64:67], v[180:183], 0
    v_mul_f32 v254, v0, v144
    v_fmac_f32 v254, v1, v145
    v_fmac_f32 v254, v2, v146
    v_fmac_f32 v254, v3, v147
    v_fmac_f32 v254, v4, v148
    v_mfma_f32_32x32x16_bf16 v[48:63], v[68:71], v[180:183], 0
    ds_swizzle_b32 v68, v68 offset:0x401F
    ds_swizzle_b32 v69, v69 offset:0x401F
    ds_swizzle_b32 v70, v70 offset:0x401F
    ds_swizzle_b32 v71, v71 offset:0x401F
    s_waitcnt vmcnt(8)
    ds_read_b64_tr_b16 v[176:177], v244 offset:4096
    ds_read_b64_tr_b16 v[178:179], v244 offset:5120
    ds_read_b64_tr_b16 v[180:181], v245 offset:4096
    ds_read_b64_tr_b16 v[182:183], v245 offset:5120
    v_fmac_f32 v254, v5, v149
    v_fmac_f32 v254, v6, v150
    v_fmac_f32 v254, v7, v151
    v_fmac_f32 v200, v8, v160
    v_mfma_f32_32x32x16_bf16 v[32:47], v[72:75], v[184:187], v[32:47]
    v_fmac_f32 v200, v9, v161
    v_permlane32_swap_b32 v196, v254
    v_fmac_f32 v200, v10, v162
    v_fmac_f32 v200, v11, v163
    v_fmac_f32 v200, v12, v164
    v_mfma_f32_32x32x16_bf16 v[48:63], v[76:79], v[184:187], v[48:63]
    ds_swizzle_b32 v76, v76 offset:0x401F
    ds_swizzle_b32 v77, v77 offset:0x401F
    ds_swizzle_b32 v78, v78 offset:0x401F
    ds_swizzle_b32 v79, v79 offset:0x401F
    v_fmac_f32 v200, v13, v165
    v_fmac_f32 v200, v14, v166
    v_fmac_f32 v200, v15, v167
    v_add_f32 v254, v196, v254
    s_waitcnt lgkmcnt(8)
    s_mov_b64 exec, s[56:57]
    v_xor_b32 v68, 0x80008000, v68
    v_xor_b32 v69, 0x80008000, v69
    v_xor_b32 v70, 0x80008000, v70
    v_xor_b32 v71, 0x80008000, v71
    s_mov_b64 exec, -1
    s_waitcnt vmcnt(4) lgkmcnt(4)
    v_mfma_f32_32x32x16_bf16 v[0:15], v[64:67], v[176:179], 0
    v_mul_f32 v255, v32, v152
    v_fmac_f32 v255, v33, v153
    v_fmac_f32 v255, v34, v154
    v_fmac_f32 v255, v35, v155
    v_fmac_f32 v255, v36, v156
    v_fmac_f32 v255, v37, v157
    s_add_u32 m0, s21, 4096
    v_mfma_f32_32x32x16_bf16 v[16:31], v[68:71], v[176:179], v[16:31]
    v_lshl_add_u32 v238, v238, 10, v246
    v_lshl_add_u32 v239, v239, 10, v246
    buffer_load_dwordx4 v238, s[4:7], s40 offen lds
    buffer_load_dwordx4 v239, s[8:11], s40 offen offset:1024 lds
    ds_read_b64_tr_b16 v[176:177], v244 offset:6144
    ds_read_b64_tr_b16 v[178:179], v244 offset:7168
    ds_read_b64_tr_b16 v[184:185], v245 offset:6144
    ds_read_b64_tr_b16 v[186:187], v245 offset:7168
    v_fmac_f32 v255, v38, v158
    v_fmac_f32 v255, v39, v159
    v_fmac_f32 v201, v40, v168
    v_fmac_f32 v201, v41, v169
    v_permlane32_swap_b32 v197, v255
    s_waitcnt lgkmcnt(0)
    s_mov_b64 exec, s[56:57]
    v_xor_b32 v76, 0x80008000, v76
    v_xor_b32 v77, 0x80008000, v77
    v_xor_b32 v78, 0x80008000, v78
    v_xor_b32 v79, 0x80008000, v79
    s_mov_b64 exec, -1
    v_mfma_f32_32x32x16_bf16 v[0:15], v[72:75], v[176:179], v[0:15]
    v_fmac_f32 v201, v42, v170
    v_fmac_f32 v201, v43, v171
    v_fmac_f32 v201, v44, v172
    v_fmac_f32 v201, v45, v173
    v_fmac_f32 v201, v46, v174
    v_fmac_f32 v201, v47, v175
    s_add_u32 m0, s21, 6144
    v_mfma_f32_32x32x16_bf16 v[16:31], v[76:79], v[176:179], v[16:31]
    v_lshl_add_u32 v240, v240, 10, v246
    v_lshl_add_u32 v241, v241, 10, v246
    buffer_load_dwordx4 v240, s[4:7], s41 offen lds
    buffer_load_dwordx4 v241, s[8:11], s41 offen offset:1024 lds
    v_add_f32 v255, v197, v255
    s_set_gpr_idx_on s51, gpr_idx(DST)
    s_nop 0
    v_cvt_pk_bf16_f32 v206, v254, v255
    s_set_gpr_idx_off
    v_mfma_f32_32x32x16_bf16 v[32:47], v[64:67], v[180:183], 0
    v_mul_f32 v254, v0, v144
    v_fmac_f32 v254, v1, v145
    v_fmac_f32 v254, v2, v146
    v_fmac_f32 v254, v3, v147
    v_fmac_f32 v254, v4, v148
    v_fmac_f32 v254, v5, v149
    v_fmac_f32 v254, v6, v150
    v_fmac_f32 v254, v7, v151
    v_fma_f32 v202, v8, -v160, v202
    v_fma_f32 v202, v9, -v161, v202
    v_mfma_f32_32x32x16_bf16 v[48:63], v[68:71], v[180:183], v[48:63]
    s_waitcnt vmcnt(6)
    ds_read_b64_tr_b16 v[176:177], v244 offset:0
    ds_read_b64_tr_b16 v[178:179], v244 offset:1024
    ds_read_b64_tr_b16 v[180:181], v245 offset:0
    ds_read_b64_tr_b16 v[182:183], v245 offset:1024
    v_permlane32_swap_b32 v254, v200
    v_fma_f32 v202, v10, -v162, v202
    v_fma_f32 v202, v11, -v163, v202
    v_fma_f32 v202, v12, -v164, v202
    v_fma_f32 v202, v13, -v165, v202
    v_fma_f32 v202, v14, -v166, v202
    v_fma_f32 v202, v15, -v167, v202
    v_add_f32 v200, v254, v200
    v_fmac_f32 v198, v16, v112
    v_permlane32_swap_b32 v202, v254
    v_mfma_f32_32x32x16_bf16 v[32:47], v[72:75], v[184:187], v[32:47]
    v_fmac_f32 v198, v17, v113
    v_fmac_f32 v198, v18, v114
    v_fmac_f32 v198, v19, v115
    v_fmac_f32 v198, v20, v116
    v_fmac_f32 v198, v21, v117
    v_fmac_f32 v198, v22, v118
    v_fmac_f32 v198, v23, v119
    v_add_f32 v254, v202, v254
    v_mul_f32 v196, v24, v160
    v_fmac_f32 v196, v25, v161
    v_mfma_f32_32x32x16_bf16 v[48:63], v[76:79], v[184:187], v[48:63]
    v_add_u32 v249, s48, v249
    v_add_u32 v250, s49, v250
    ds_read_b32 v252, v251 offset:16
    ds_read_b64_tr_b16 v[64:65], v249 offset:0
    ds_read_b64_tr_b16 v[68:69], v249 offset:64
    ds_read_b64_tr_b16 v[66:67], v249 offset:256
    ds_read_b64_tr_b16 v[70:71], v249 offset:320
    s_mov_b64 exec, s[54:55]
    ds_read_u16_d16_hi v242, v250 offset:0
    s_mov_b64 exec, -1
    v_fmac_f32 v196, v26, v162
    v_fmac_f32 v196, v27, v163
    v_fmac_f32 v196, v28, v164
    v_fmac_f32 v196, v29, v165
    v_fmac_f32 v196, v30, v166
    v_fmac_f32 v196, v31, v167
    s_nop 1
    v_permlane32_swap_b32 v198, v196
    v_add_f32 v196, v198, v196
    v_mul_f32 v255, v32, v152
    v_fmac_f32 v255, v33, v153
    v_fmac_f32 v255, v34, v154
    v_fmac_f32 v255, v35, v155
    v_fmac_f32 v255, v36, v156
    v_fmac_f32 v255, v37, v157
    v_fmac_f32 v255, v38, v158
    v_fmac_f32 v255, v39, v159
    v_fma_f32 v203, v40, -v168, v203
    v_fma_f32 v203, v41, -v169, v203
    v_permlane32_swap_b32 v255, v201
    v_fma_f32 v203, v42, -v170, v203
    v_fma_f32 v203, v43, -v171, v203
    v_fma_f32 v203, v44, -v172, v203
    v_fma_f32 v203, v45, -v173, v203
    v_fma_f32 v203, v46, -v174, v203
    v_fma_f32 v203, v47, -v175, v203
    v_add_f32 v201, v255, v201
    v_fmac_f32 v199, v48, v120
    v_permlane32_swap_b32 v203, v255
    v_fmac_f32 v199, v49, v121
    v_fmac_f32 v199, v50, v122
    v_fmac_f32 v199, v51, v123
    v_fmac_f32 v199, v52, v124
    v_fmac_f32 v199, v53, v125
    v_fmac_f32 v199, v54, v126
    v_fmac_f32 v199, v55, v127
    v_add_f32 v255, v203, v255
    v_mul_f32 v197, v56, v168
    v_fmac_f32 v197, v57, v169
    v_fmac_f32 v197, v58, v170
    v_fmac_f32 v197, v59, v171
    v_fmac_f32 v197, v60, v172
    v_fmac_f32 v197, v61, v173
    v_fmac_f32 v197, v62, v174
    v_fmac_f32 v197, v63, v175
    s_nop 1
    v_permlane32_swap_b32 v199, v197
    v_add_f32 v197, v199, v197
    s_set_gpr_idx_on s51, gpr_idx(DST)
    s_nop 0
    v_cvt_pk_bf16_f32 v207, v200, v201
    v_cvt_pk_bf16_f32 v209, v254, v255
    v_cvt_pk_bf16_f32 v208, v196, v197
    s_set_gpr_idx_off
    s_add_u32 s50, s50, 1
    s_add_u32 s51, s51, 6
    s_cmp_ge_u32 s50, 4
    s_cbranch_scc1 LAST0
    s_waitcnt lgkmcnt(5)
    v_readfirstlane_b32 s66, v252
    s_add_u32 s53, s53, 1
    v_mov_b32 v252, s53
    s_cmp_le_u32 s53, s66
    ds_write2_b32 v251, v252, v252 offset0:0 offset1:8
    s_setprio 1
    s_cbranch_scc1 PRIO_5
    s_setprio 0
PRIO_5:
    s_cmp_eq_u32 s52, 4
    s_cbranch_scc1 ITEM_0_4
    s_cmp_eq_u32 s52, 5
    s_cbranch_scc1 ITEM_0_5
    s_cmp_eq_u32 s52, 3
    s_cbranch_scc1 ITEM_0_3
    s_cmp_eq_u32 s52, 6
    s_cbranch_scc1 ITEM_0_6
    s_cmp_eq_u32 s52, 8
    s_cbranch_scc1 ITEM_0_8
    s_branch ITEM_0_2
.p2align 6
ITEM_0_5:
    s_mov_b64 exec, s[54:55]
    ds_read_u16_d16_hi v243, v250 offset:128
    s_mov_b64 exec, -1
    ds_read_b64_tr_b16 v[72:73], v249 offset:512
    ds_read_b64_tr_b16 v[76:77], v249 offset:576
    ds_read_b64_tr_b16 v[74:75], v249 offset:768
    ds_read_b64_tr_b16 v[78:79], v249 offset:832
    ds_read_b64_tr_b16 v[80:81], v249 offset:1024
    ds_read_b64_tr_b16 v[84:85], v249 offset:1088
    s_waitcnt lgkmcnt(7)
    v_mul_f32_dpp v196, v242, v64 row_newbcast:0 row_mask:0xf bank_mask:0xf
    v_mul_f32_dpp v197, v242, v65 row_newbcast:1 row_mask:0xf bank_mask:0xf
    v_mul_f32_dpp v198, v242, v64 row_newbcast:8 row_mask:0xf bank_mask:0xf
    v_mul_f32_dpp v199, v242, v65 row_newbcast:9 row_mask:0xf bank_mask:0xf
    v_mul_f32_dpp v200, v242, v68 row_newbcast:2 row_mask:0xf bank_mask:0xf
    v_mul_f32_dpp v201, v242, v69 row_newbcast:3 row_mask:0xf bank_mask:0xf
    v_mul_f32_dpp v202, v242, v68 row_newbcast:10 row_mask:0xf bank_mask:0xf
    v_mul_f32_dpp v203, v242, v69 row_newbcast:11 row_mask:0xf bank_mask:0xf
    v_cvt_pk_bf16_f32 v64, v196, v197
    v_cvt_pk_bf16_f32 v68, v198, v199
    v_cvt_pk_bf16_f32 v65, v200, v201
    v_cvt_pk_bf16_f32 v69, v202, v203
    v_mul_f32_dpp v196, v242, v66 row_newbcast:4 row_mask:0xf bank_mask:0xf
    v_mul_f32_dpp v197, v242, v67 row_newbcast:5 row_mask:0xf bank_mask:0xf
    v_mul_f32_dpp v198, v242, v66 row_newbcast:12 row_mask:0xf bank_mask:0xf
    v_mul_f32_dpp v199, v242, v67 row_newbcast:13 row_mask:0xf bank_mask:0xf
    v_mul_f32_dpp v200, v242, v70 row_newbcast:6 row_mask:0xf bank_mask:0xf
    v_mul_f32_dpp v201, v242, v71 row_newbcast:7 row_mask:0xf bank_mask:0xf
    v_mul_f32_dpp v202, v242, v70 row_newbcast:14 row_mask:0xf bank_mask:0xf
    v_mul_f32_dpp v203, v242, v71 row_newbcast:15 row_mask:0xf bank_mask:0xf
    v_cvt_pk_bf16_f32 v66, v196, v197
    v_cvt_pk_bf16_f32 v70, v198, v199
    v_cvt_pk_bf16_f32 v67, v200, v201
    v_cvt_pk_bf16_f32 v71, v202, v203
    s_mov_b64 exec, s[54:55]
    ds_read_u16_d16_hi v242, v250 offset:256
    s_mov_b64 exec, -1
    s_waitcnt vmcnt(4) lgkmcnt(3)
    v_mfma_f32_32x32x16_bf16 v[0:15], v[64:67], v[176:179], 0
    v_mul_f32_dpp v196, v243, v72 row_newbcast:0 row_mask:0xf bank_mask:0xf
    v_mul_f32_dpp v197, v243, v73 row_newbcast:1 row_mask:0xf bank_mask:0xf
    v_mul_f32_dpp v198, v243, v72 row_newbcast:8 row_mask:0xf bank_mask:0xf
    v_mul_f32_dpp v199, v243, v73 row_newbcast:9 row_mask:0xf bank_mask:0xf
    v_mul_f32_dpp v200, v243, v76 row_newbcast:2 row_mask:0xf bank_mask:0xf
    v_mul_f32_dpp v201, v243, v77 row_newbcast:3 row_mask:0xf bank_mask:0xf
    v_mul_f32_dpp v202, v243, v76 row_newbcast:10 row_mask:0xf bank_mask:0xf
    v_mul_f32_dpp v203, v243, v77 row_newbcast:11 row_mask:0xf bank_mask:0xf
    v_cvt_pk_bf16_f32 v72, v196, v197
    v_cvt_pk_bf16_f32 v76, v198, v199
    v_cvt_pk_bf16_f32 v73, v200, v201
    v_cvt_pk_bf16_f32 v77, v202, v203
    s_add_u32 m0, s21, 0
    v_mfma_f32_32x32x16_bf16 v[16:31], v[68:71], v[176:179], 0
    buffer_load_dwordx4 v236, s[4:7], s35 offen lds
    buffer_load_dwordx4 v237, s[8:11], s35 offen offset:1024 lds
    ds_read_b64_tr_b16 v[176:177], v244 offset:2048
    ds_read_b64_tr_b16 v[178:179], v244 offset:3072
    ds_read_b64_tr_b16 v[184:185], v245 offset:2048
    ds_read_b64_tr_b16 v[186:187], v245 offset:3072
    v_mul_f32_dpp v196, v243, v74 row_newbcast:4 row_mask:0xf bank_mask:0xf
    v_mul_f32_dpp v197, v243, v75 row_newbcast:5 row_mask:0xf bank_mask:0xf
    v_mul_f32_dpp v198, v243, v74 row_newbcast:12 row_mask:0xf bank_mask:0xf
    v_mul_f32_dpp v199, v243, v75 row_newbcast:13 row_mask:0xf bank_mask:0xf
    v_mul_f32_dpp v200, v243, v78 row_newbcast:6 row_mask:0xf bank_mask:0xf
    v_mul_f32_dpp v201, v243, v79 row_newbcast:7 row_mask:0xf bank_mask:0xf
    v_mul_f32_dpp v202, v243, v78 row_newbcast:14 row_mask:0xf bank_mask:0xf
    v_mul_f32_dpp v203, v243, v79 row_newbcast:15 row_mask:0xf bank_mask:0xf
    v_cvt_pk_bf16_f32 v74, v196, v197
    v_cvt_pk_bf16_f32 v78, v198, v199
    v_cvt_pk_bf16_f32 v75, v200, v201
    v_cvt_pk_bf16_f32 v79, v202, v203
    s_nop 0
    s_waitcnt vmcnt(4) lgkmcnt(0)
    v_mfma_f32_32x32x16_bf16 v[0:15], v[72:75], v[176:179], v[0:15]
    v_mul_f32_dpp v196, v242, v80 row_newbcast:0 row_mask:0xf bank_mask:0xf
    v_mul_f32_dpp v197, v242, v81 row_newbcast:1 row_mask:0xf bank_mask:0xf
    v_mul_f32_dpp v198, v242, v80 row_newbcast:8 row_mask:0xf bank_mask:0xf
    v_mul_f32_dpp v199, v242, v81 row_newbcast:9 row_mask:0xf bank_mask:0xf
    v_mul_f32_dpp v200, v242, v84 row_newbcast:2 row_mask:0xf bank_mask:0xf
    v_mul_f32_dpp v201, v242, v85 row_newbcast:3 row_mask:0xf bank_mask:0xf
    s_add_u32 m0, s21, 2048
    v_mfma_f32_32x32x16_bf16 v[16:31], v[76:79], v[176:179], v[16:31]
    buffer_load_dwordx4 v238, s[4:7], s35 offen lds
    ds_read_b64_tr_b16 v[176:177], v244 offset:4096
    ds_read_b64_tr_b16 v[188:189], v245 offset:4096
    v_mul_f32_dpp v202, v242, v84 row_newbcast:10 row_mask:0xf bank_mask:0xf
    v_mul_f32_dpp v203, v242, v85 row_newbcast:11 row_mask:0xf bank_mask:0xf
    v_cvt_pk_bf16_f32 v80, v196, v197
    v_cvt_pk_bf16_f32 v84, v198, v199
    v_cvt_pk_bf16_f32 v81, v200, v201
    v_cvt_pk_bf16_f32 v85, v202, v203
    s_nop 0
    s_waitcnt lgkmcnt(0)
    v_mfma_f32_32x32x8_bf16 v[0:15], v[80:81], v[176:177], v[0:15]
    s_add_u32 m0, s21, 4096
    v_mfma_f32_32x32x8_bf16 v[16:31], v[84:85], v[176:177], v[16:31]
    buffer_load_dwordx4 v234, s[4:7], s36 offen lds
    buffer_load_dwordx4 v235, s[8:11], s36 offen offset:1024 lds
    s_mov_b32 m0, s50
    s_nop 0
    s_movrels_b32 s71, s23
    s_bfe_u32 s46, s71, 0x30012
    s_mov_b32 m0, s46
    s_and_b32 s66, s71, 0x3ffff
    s_movrels_b32 s68, s57
    s_movrels_b32 s69, s61
    s_sub_u32 s48, s66, s47
    s_mov_b32 s47, s66
    s_lshr_b32 s52, s71, 28
    s_lshl_b32 s67, s46, 9
    s_add_u32 s66, s66, s67
    s_sub_u32 s49, s66, s42
    s_mov_b32 s42, s66
    s_bfe_u32 s66, s68, 655360
    s_add_u32 s43, s42, s66
    s_bfe_u32 s39, s69, 655360
    s_bfe_u32 s66, s68, 655370
    s_add_u32 s44, s42, s66
    s_bfe_u32 s40, s69, 655370
    s_bfe_u32 s66, s68, 655380
    s_add_u32 s45, s42, s66
    s_bfe_u32 s41, s69, 655380
    s_and_b32 s66, s46, s33
    s_cselect_b32 s72, -1, 1
    s_cselect_b32 s76, s47, 163712
    s_cmp_ge_u32 s66, 2
    s_cselect_b32 s73, -1, 0
    s_add_u32 s77, s47, 1024
    s_cmp_ge_u32 s66, 4
    s_cselect_b32 s75, -1, 0
    s_cmp_ge_u32 s66, 3
    s_cselect_b32 s74, -1, 1
    s_cselect_b32 s77, s77, 163712
    v_add_u32 v252, s45, v247
    ds_read_u16 v240, v252
    ds_read_u16 v241, v252 offset:64
    v_mfma_f32_32x32x16_bf16 v[32:47], v[64:67], v[180:183], 0
    v_mul_f32 v196, v0, v96
    v_fmac_f32 v196, v1, v97
    v_fmac_f32 v196, v2, v98
    v_fmac_f32 v196, v3, v99
    v_fmac_f32 v196, v4, v100
    v_fmac_f32 v196, v5, v101
    v_fmac_f32 v196, v6, v102
    v_mfma_f32_32x32x16_bf16 v[48:63], v[68:71], v[180:183], 0
    v_add_u32 v253, s47, v248
    ds_read_b32 v254, v253
    ds_read_b32 v255, v253 offset:256
    v_fmac_f32 v196, v7, v103
    v_mul_f32 v198, v8, v128
    v_fmac_f32 v198, v9, v129
    v_fmac_f32 v198, v10, v130
    v_fmac_f32 v198, v11, v131
    v_fmac_f32 v198, v12, v132
    v_mfma_f32_32x32x16_bf16 v[32:47], v[72:75], v[184:187], v[32:47]
    v_fmac_f32 v198, v13, v133
    v_fmac_f32 v198, v14, v134
    v_fmac_f32 v198, v15, v135
    v_mul_f32 v200, v16, v128
    v_fmac_f32 v200, v17, v129
    v_permlane32_swap_b32 v196, v198
    v_mfma_f32_32x32x16_bf16 v[48:63], v[76:79], v[184:187], v[48:63]
    s_waitcnt vmcnt(5)
    ds_read_b64_tr_b16 v[176:177], v244 offset:6144
    ds_read_b64_tr_b16 v[178:179], v244 offset:7168
    ds_read_b64_tr_b16 v[180:181], v245 offset:6144
    ds_read_b64_tr_b16 v[182:183], v245 offset:7168
    v_fmac_f32 v200, v18, v130
    v_fmac_f32 v200, v19, v131
    v_fmac_f32 v200, v20, v132
    v_fmac_f32 v200, v21, v133
    v_fmac_f32 v200, v22, v134
    v_fmac_f32 v200, v23, v135
    v_mfma_f32_32x32x8_bf16 v[32:47], v[80:81], v[188:189], v[32:47]
    v_add_f32 v198, v196, v198
    v_mul_f32_e64 v202, v24, -v128
    v_fma_f32 v202, v25, -v129, v202
    v_fma_f32 v202, v26, -v130, v202
    v_fma_f32 v202, v27, -v131, v202
    v_fma_f32 v202, v28, -v132, v202
    v_mfma_f32_32x32x8_bf16 v[48:63], v[84:85], v[188:189], v[48:63]
    v_fma_f32 v202, v29, -v133, v202
    v_fma_f32 v202, v30, -v134, v202
    v_fma_f32 v202, v31, -v135, v202
    s_nop 1
    v_permlane32_swap_b32 v200, v202
    v_add_f32 v202, v200, v202
    s_waitcnt vmcnt(3) lgkmcnt(0)
    v_mfma_f32_32x32x16_bf16 v[0:15], v[64:67], v[176:179], 0
    v_mul_f32 v197, v32, v104
    v_fmac_f32 v197, v33, v105
    v_fmac_f32 v197, v34, v106
    v_fmac_f32 v197, v35, v107
    v_fmac_f32 v197, v36, v108
    v_fmac_f32 v197, v37, v109
    v_fmac_f32 v197, v38, v110
    s_add_u32 m0, s21, 6144
    v_mfma_f32_32x32x16_bf16 v[16:31], v[68:71], v[176:179], 0
    buffer_load_dwordx4 v236, s[4:7], s36 offen lds
    buffer_load_dwordx4 v237, s[8:11], s36 offen offset:1024 lds
    ds_read_b64_tr_b16 v[176:177], v244 offset:0
    ds_read_b64_tr_b16 v[178:179], v244 offset:1024
    ds_read_b64_tr_b16 v[184:185], v245 offset:0
    ds_read_b64_tr_b16 v[186:187], v245 offset:1024
    s_mov_b32 m0, s76
    s_mov_b64 exec, s[72:73]
    buffer_load_dwordx4 v254, s[12:15], 0 offen  lds
    s_mov_b32 m0, s77
    s_mov_b64 exec, s[74:75]
    buffer_load_dwordx4 v255, s[12:15], 0 offen  lds
    s_mov_b64 exec, -1
    v_fmac_f32 v197, v39, v111
    v_mul_f32 v199, v40, v136
    v_fmac_f32 v199, v41, v137
    v_fmac_f32 v199, v42, v138
    v_fmac_f32 v199, v43, v139
    v_fmac_f32 v199, v44, v140
    v_fmac_f32 v199, v45, v141
    s_waitcnt vmcnt(6) lgkmcnt(0)
    v_mfma_f32_32x32x16_bf16 v[0:15], v[72:75], v[176:179], v[0:15]
    v_fmac_f32 v199, v46, v142
    v_fmac_f32 v199, v47, v143
    v_mul_f32 v201, v48, v136
    v_fmac_f32 v201, v49, v137
    v_permlane32_swap_b32 v197, v199
    v_fmac_f32 v201, v50, v138
    v_fmac_f32 v201, v51, v139
    s_add_u32 m0, s21, 0
    v_mfma_f32_32x32x16_bf16 v[16:31], v[76:79], v[176:179], v[16:31]
    buffer_load_dwordx4 v238, s[4:7], s36 offen lds
    ds_read_b64_tr_b16 v[176:177], v244 offset:2048
    ds_read_b64_tr_b16 v[188:189], v245 offset:2048
    v_fmac_f32 v201, v52, v140
    v_fmac_f32 v201, v53, v141
    v_fmac_f32 v201, v54, v142
    v_fmac_f32 v201, v55, v143
    v_add_f32 v199, v197, v199
    v_mul_f32_e64 v203, v56, -v136
    v_fma_f32 v203, v57, -v137, v203
    s_waitcnt lgkmcnt(0)
    v_mfma_f32_32x32x8_bf16 v[0:15], v[80:81], v[176:177], v[0:15]
    v_fma_f32 v203, v58, -v138, v203
    v_fma_f32 v203, v59, -v139, v203
    v_fma_f32 v203, v60, -v140, v203
    v_fma_f32 v203, v61, -v141, v203
    v_fma_f32 v203, v62, -v142, v203
    v_fma_f32 v203, v63, -v143, v203
    s_nop 1
    s_add_u32 m0, s21, 2048
    v_mfma_f32_32x32x8_bf16 v[16:31], v[84:85], v[176:177], v[16:31]
    buffer_load_dwordx4 v234, s[4:7], s37 offen lds
    buffer_load_dwordx4 v235, s[8:11], s37 offen offset:1024 lds
    v_add_u32 v252, s42, v247
    ds_read_u16 v234, v252
    ds_read_u16 v235, v252 offset:64
    v_permlane32_swap_b32 v201, v203
    v_add_f32 v203, v201, v203
    s_set_gpr_idx_on s51, gpr_idx(DST)
    s_nop 0
    v_cvt_pk_bf16_f32 v204, v198, v199
    v_cvt_pk_bf16_f32 v205, v202, v203
    s_set_gpr_idx_off
    v_mfma_f32_32x32x16_bf16 v[32:47], v[64:67], v[180:183], 0
    v_mul_f32 v196, v0, v144
    v_fmac_f32 v196, v1, v145
    v_fmac_f32 v196, v2, v146
    v_fmac_f32 v196, v3, v147
    v_fmac_f32 v196, v4, v148
    v_fmac_f32 v196, v5, v149
    v_mfma_f32_32x32x16_bf16 v[48:63], v[68:71], v[180:183], 0
    v_fmac_f32 v196, v6, v150
    v_fmac_f32 v196, v7, v151
    v_mul_f32 v198, v8, v112
    v_fmac_f32 v198, v9, v113
    v_fmac_f32 v198, v10, v114
    v_mfma_f32_32x32x16_bf16 v[32:47], v[72:75], v[184:187], v[32:47]
    v_fmac_f32 v198, v11, v115
    v_fmac_f32 v198, v12, v116
    v_fmac_f32 v198, v13, v117
    v_fmac_f32 v198, v14, v118
    v_fmac_f32 v198, v15, v119
    v_mfma_f32_32x32x16_bf16 v[48:63], v[76:79], v[184:187], v[48:63]
    s_waitcnt vmcnt(7)
    ds_read_b64_tr_b16 v[176:177], v244 offset:4096
    ds_read_b64_tr_b16 v[178:179], v244 offset:5120
    ds_read_b64_tr_b16 v[180:181], v245 offset:4096
    ds_read_b64_tr_b16 v[182:183], v245 offset:5120
    v_mul_f32_e64 v200, v16, -v160
    v_fma_f32 v200, v17, -v161, v200
    v_fma_f32 v200, v18, -v162, v200
    v_fma_f32 v200, v19, -v163, v200
    v_fma_f32 v200, v20, -v164, v200
    v_fma_f32 v200, v21, -v165, v200
    v_mfma_f32_32x32x8_bf16 v[32:47], v[80:81], v[188:189], v[32:47]
    v_fma_f32 v200, v22, -v166, v200
    v_fma_f32 v200, v23, -v167, v200
    v_mul_f32_e64 v202, v24, -v160
    v_fma_f32 v202, v25, -v161, v202
    v_fma_f32 v202, v26, -v162, v202
    v_mfma_f32_32x32x8_bf16 v[48:63], v[84:85], v[188:189], v[48:63]
    v_fma_f32 v202, v27, -v163, v202
    v_fma_f32 v202, v28, -v164, v202
    v_fma_f32 v202, v29, -v165, v202
    v_fma_f32 v202, v30, -v166, v202
    v_fma_f32 v202, v31, -v167, v202
    s_waitcnt vmcnt(5) lgkmcnt(0)
    v_mfma_f32_32x32x16_bf16 v[0:15], v[64:67], v[176:179], 0
    v_mul_f32 v197, v32, v152
    v_fmac_f32 v197, v33, v153
    v_fmac_f32 v197, v34, v154
    v_fmac_f32 v197, v35, v155
    v_fmac_f32 v197, v36, v156
    v_fmac_f32 v197, v37, v157
    s_add_u32 m0, s21, 4096
    v_mfma_f32_32x32x16_bf16 v[16:31], v[68:71], v[176:179], 0
    buffer_load_dwordx4 v236, s[4:7], s37 offen lds
    buffer_load_dwordx4 v237, s[8:11], s37 offen offset:1024 lds
    ds_read_b64_tr_b16 v[176:177], v244 offset:6144
    ds_read_b64_tr_b16 v[178:179], v244 offset:7168
    ds_read_b64_tr_b16 v[184:185], v245 offset:6144
    ds_read_b64_tr_b16 v[186:187], v245 offset:7168
    v_add_u32 v252, s43, v247
    ds_read_u16 v236, v252
    ds_read_u16 v237, v252 offset:64
    v_fmac_f32 v197, v38, v158
    v_fmac_f32 v197, v39, v159
    v_mul_f32 v199, v40, v120
    v_fmac_f32 v199, v41, v121
    v_fmac_f32 v199, v42, v122
    s_waitcnt vmcnt(4) lgkmcnt(2)
    v_mfma_f32_32x32x16_bf16 v[0:15], v[72:75], v[176:179], v[0:15]
    v_fmac_f32 v199, v43, v123
    v_fmac_f32 v199, v44, v124
    v_fmac_f32 v199, v45, v125
    v_fmac_f32 v199, v46, v126
    v_fmac_f32 v199, v47, v127
    s_add_u32 m0, s21, 6144
    v_mfma_f32_32x32x16_bf16 v[16:31], v[76:79], v[176:179], v[16:31]
    buffer_load_dwordx4 v238, s[4:7], s37 offen lds
    ds_read_b64_tr_b16 v[176:177], v244 offset:0
    ds_read_b64_tr_b16 v[188:189], v245 offset:0
    v_add_u32 v252, s44, v247
    ds_read_u16 v238, v252
    ds_read_u16 v239, v252 offset:64
    v_mul_f32_e64 v201, v48, -v168
    v_fma_f32 v201, v49, -v169, v201
    v_fma_f32 v201, v50, -v170, v201
    v_fma_f32 v201, v51, -v171, v201
    v_fma_f32 v201, v52, -v172, v201
    v_fma_f32 v201, v53, -v173, v201
    s_waitcnt lgkmcnt(2)
    v_mfma_f32_32x32x8_bf16 v[0:15], v[80:81], v[176:177], v[0:15]
    v_fma_f32 v201, v54, -v174, v201
    v_fma_f32 v201, v55, -v175, v201
    v_mul_f32_e64 v203, v56, -v168
    v_fma_f32 v203, v57, -v169, v203
    v_fma_f32 v203, v58, -v170, v203
    s_add_u32 m0, s21, 0
    v_mfma_f32_32x32x8_bf16 v[16:31], v[84:85], v[176:177], v[16:31]
    v_lshl_add_u32 v234, v234, 10, v246
    v_lshl_add_u32 v235, v235, 10, v246
    buffer_load_dwordx4 v234, s[4:7], s38 offen lds
    buffer_load_dwordx4 v235, s[8:11], s38 offen offset:1024 lds
    v_fma_f32 v203, v59, -v171, v203
    v_fma_f32 v203, v60, -v172, v203
    v_fma_f32 v203, v61, -v173, v203
    v_fma_f32 v203, v62, -v174, v203
    v_fma_f32 v203, v63, -v175, v203
    v_mfma_f32_32x32x16_bf16 v[32:47], v[64:67], v[180:183], 0
    v_mul_f32 v254, v0, v144
    v_fmac_f32 v254, v1, v145
    v_fmac_f32 v254, v2, v146
    v_mfma_f32_32x32x16_bf16 v[48:63], v[68:71], v[180:183], 0
    ds_swizzle_b32 v68, v68 offset:0x401F
    ds_swizzle_b32 v69, v69 offset:0x401F
    ds_swizzle_b32 v70, v70 offset:0x401F
    ds_swizzle_b32 v71, v71 offset:0x401F
    v_fmac_f32 v254, v3, v147
    v_fmac_f32 v254, v4, v148
    v_fmac_f32 v254, v5, v149
    v_mfma_f32_32x32x16_bf16 v[32:47], v[72:75], v[184:187], v[32:47]
    v_fmac_f32 v254, v6, v150
    v_fmac_f32 v254, v7, v151
    v_fmac_f32 v200, v8, v160
    v_mfma_f32_32x32x16_bf16 v[48:63], v[76:79], v[184:187], v[48:63]
    ds_swizzle_b32 v76, v76 offset:0x401F
    ds_swizzle_b32 v77, v77 offset:0x401F
    ds_swizzle_b32 v78, v78 offset:0x401F
    ds_swizzle_b32 v79, v79 offset:0x401F
    s_waitcnt vmcnt(5)
    ds_read_b64_tr_b16 v[176:177], v244 offset:2048
    ds_read_b64_tr_b16 v[178:179], v244 offset:3072
    ds_read_b64_tr_b16 v[180:181], v245 offset:2048
    ds_read_b64_tr_b16 v[182:183], v245 offset:3072
    v_fmac_f32 v200, v9, v161
    v_permlane32_swap_b32 v196, v254
    v_fmac_f32 v200, v10, v162
    v_mfma_f32_32x32x8_bf16 v[32:47], v[80:81], v[188:189], v[32:47]
    v_fmac_f32 v200, v11, v163
    v_fmac_f32 v200, v12, v164
    v_fmac_f32 v200, v13, v165
    v_mfma_f32_32x32x8_bf16 v[48:63], v[84:85], v[188:189], v[48:63]
    ds_swizzle_b32 v84, v84 offset:0x401F
    ds_swizzle_b32 v85, v85 offset:0x401F
    v_fmac_f32 v200, v14, v166
    v_fmac_f32 v200, v15, v167
    v_add_f32 v254, v196, v254
    s_waitcnt lgkmcnt(6)
    s_mov_b64 exec, s[56:57]
    v_xor_b32 v68, 0x80008000, v68
    v_xor_b32 v69, 0x80008000, v69
    v_xor_b32 v70, 0x80008000, v70
    v_xor_b32 v71, 0x80008000, v71
    v_xor_b32 v76, 0x80008000, v76
    v_xor_b32 v77, 0x80008000, v77
    v_xor_b32 v78, 0x80008000, v78
    v_xor_b32 v79, 0x80008000, v79
    s_mov_b64 exec, -1
    s_waitcnt vmcnt(3) lgkmcnt(2)
    v_mfma_f32_32x32x16_bf16 v[0:15], v[64:67], v[176:179], 0
    v_mul_f32 v255, v32, v152
    v_fmac_f32 v255, v33, v153
    v_fmac_f32 v255, v34, v154
    v_fmac_f32 v255, v35, v155
    s_add_u32 m0, s21, 2048
    v_mfma_f32_32x32x16_bf16 v[16:31], v[68:71], v[176:179], v[16:31]
    v_lshl_add_u32 v236, v236, 10, v246
    v_lshl_add_u32 v237, v237, 10, v246
    buffer_load_dwordx4 v236, s[4:7], s39 offen lds
    buffer_load_dwordx4 v237, s[8:11], s39 offen offset:1024 lds
    ds_read_b64_tr_b16 v[176:177], v244 offset:4096
    ds_read_b64_tr_b16 v[178:179], v244 offset:5120
    ds_read_b64_tr_b16 v[184:185], v245 offset:4096
    ds_read_b64_tr_b16 v[186:187], v245 offset:5120
    v_fmac_f32 v255, v36, v156
    v_fmac_f32 v255, v37, v157
    v_fmac_f32 v255, v38, v158
    v_fmac_f32 v255, v39, v159
    s_waitcnt vmcnt(4) lgkmcnt(0)
    v_mfma_f32_32x32x16_bf16 v[0:15], v[72:75], v[176:179], v[0:15]
    v_fmac_f32 v201, v40, v168
    v_fmac_f32 v201, v41, v169
    v_permlane32_swap_b32 v197, v255
    s_add_u32 m0, s21, 4096
    v_mfma_f32_32x32x16_bf16 v[16:31], v[76:79], v[176:179], v[16:31]
    v_lshl_add_u32 v238, v238, 10, v246
    v_lshl_add_u32 v239, v239, 10, v246
    buffer_load_dwordx4 v238, s[4:7], s40 offen lds
    buffer_load_dwordx4 v239, s[8:11], s40 offen offset:1024 lds
    ds_read_b64_tr_b16 v[176:177], v244 offset:6144
    ds_read_b64_tr_b16 v[188:189], v245 offset:6144
    v_fmac_f32 v201, v42, v170
    v_fmac_f32 v201, v43, v171
    v_fmac_f32 v201, v44, v172
    v_fmac_f32 v201, v45, v173
    s_waitcnt lgkmcnt(0)
    s_mov_b64 exec, s[56:57]
    v_xor_b32 v84, 0x80008000, v84
    v_xor_b32 v85, 0x80008000, v85
    s_mov_b64 exec, -1
    v_mfma_f32_32x32x8_bf16 v[0:15], v[80:81], v[176:177], v[0:15]
    v_fmac_f32 v201, v46, v174
    v_fmac_f32 v201, v47, v175
    v_add_f32 v255, v197, v255
    s_set_gpr_idx_on s51, gpr_idx(DST)
    s_nop 0
    v_cvt_pk_bf16_f32 v206, v254, v255
    s_set_gpr_idx_off
    s_add_u32 m0, s21, 6144
    v_mfma_f32_32x32x8_bf16 v[16:31], v[84:85], v[176:177], v[16:31]
    v_lshl_add_u32 v240, v240, 10, v246
    v_lshl_add_u32 v241, v241, 10, v246
    buffer_load_dwordx4 v240, s[4:7], s41 offen lds
    buffer_load_dwordx4 v241, s[8:11], s41 offen offset:1024 lds
    v_mfma_f32_32x32x16_bf16 v[32:47], v[64:67], v[180:183], 0
    v_mul_f32 v254, v0, v144
    v_fmac_f32 v254, v1, v145
    v_fmac_f32 v254, v2, v146
    v_fmac_f32 v254, v3, v147
    v_fmac_f32 v254, v4, v148
    v_fmac_f32 v254, v5, v149
    v_fmac_f32 v254, v6, v150
    v_mfma_f32_32x32x16_bf16 v[48:63], v[68:71], v[180:183], v[48:63]
    v_fmac_f32 v254, v7, v151
    v_fma_f32 v202, v8, -v160, v202
    v_fma_f32 v202, v9, -v161, v202
    v_permlane32_swap_b32 v254, v200
    v_fma_f32 v202, v10, -v162, v202
    v_fma_f32 v202, v11, -v163, v202
    v_mfma_f32_32x32x16_bf16 v[32:47], v[72:75], v[184:187], v[32:47]
    v_fma_f32 v202, v12, -v164, v202
    v_fma_f32 v202, v13, -v165, v202
    v_fma_f32 v202, v14, -v166, v202
    v_fma_f32 v202, v15, -v167, v202
    v_add_f32 v200, v254, v200
    v_fmac_f32 v198, v16, v112
    v_permlane32_swap_b32 v202, v254
    v_mfma_f32_32x32x16_bf16 v[48:63], v[76:79], v[184:187], v[48:63]
    s_waitcnt vmcnt(6)
    ds_read_b64_tr_b16 v[176:177], v244 offset:0
    ds_read_b64_tr_b16 v[178:179], v244 offset:1024
    ds_read_b64_tr_b16 v[180:181], v245 offset:0
    ds_read_b64_tr_b16 v[182:183], v245 offset:1024
    v_fmac_f32 v198, v17, v113
    v_fmac_f32 v198, v18, v114
    v_fmac_f32 v198, v19, v115
    v_fmac_f32 v198, v20, v116
    v_fmac_f32 v198, v21, v117
    v_fmac_f32 v198, v22, v118
    v_mfma_f32_32x32x8_bf16 v[32:47], v[80:81], v[188:189], v[32:47]
    v_fmac_f32 v198, v23, v119
    v_add_f32 v254, v202, v254
    v_mul_f32 v196, v24, v160
    v_fmac_f32 v196, v25, v161
    v_fmac_f32 v196, v26, v162
    v_fmac_f32 v196, v27, v163
    v_fmac_f32 v196, v28, v164
    v_mfma_f32_32x32x8_bf16 v[48:63], v[84:85], v[188:189], v[48:63]
    v_add_u32 v249, s48, v249
    v_add_u32 v250, s49, v250
    ds_read_b32 v252, v251 offset:16
    ds_read_b64_tr_b16 v[64:65], v249 offset:0
    ds_read_b64_tr_b16 v[68:69], v249 offset:64
    ds_read_b64_tr_b16 v[66:67], v249 offset:256
    ds_read_b64_tr_b16 v[70:71], v249 offset:320
    s_mov_b64 exec, s[54:55]
    ds_read_u16_d16_hi v242, v250 offset:0
    s_mov_b64 exec, -1
    v_fmac_f32 v196, v29, v165
    v_fmac_f32 v196, v30, v166
    v_fmac_f32 v196, v31, v167
    s_nop 1
    v_permlane32_swap_b32 v198, v196
    v_add_f32 v196, v198, v196
    v_mul_f32 v255, v32, v152
    v_fmac_f32 v255, v33, v153
    v_fmac_f32 v255, v34, v154
    v_fmac_f32 v255, v35, v155
    v_fmac_f32 v255, v36, v156
    v_fmac_f32 v255, v37, v157
    v_fmac_f32 v255, v38, v158
    v_fmac_f32 v255, v39, v159
    v_fma_f32 v203, v40, -v168, v203
    v_fma_f32 v203, v41, -v169, v203
    v_permlane32_swap_b32 v255, v201
    v_fma_f32 v203, v42, -v170, v203
    v_fma_f32 v203, v43, -v171, v203
    v_fma_f32 v203, v44, -v172, v203
    v_fma_f32 v203, v45, -v173, v203
    v_fma_f32 v203, v46, -v174, v203
    v_fma_f32 v203, v47, -v175, v203
    v_add_f32 v201, v255, v201
    v_fmac_f32 v199, v48, v120
    v_permlane32_swap_b32 v203, v255
    v_fmac_f32 v199, v49, v121
    v_fmac_f32 v199, v50, v122
    v_fmac_f32 v199, v51, v123
    v_fmac_f32 v199, v52, v124
    v_fmac_f32 v199, v53, v125
    v_fmac_f32 v199, v54, v126
    v_fmac_f32 v199, v55, v127
    v_add_f32 v255, v203, v255
    v_mul_f32 v197, v56, v168
    v_fmac_f32 v197, v57, v169
    v_fmac_f32 v197, v58, v170
    v_fmac_f32 v197, v59, v171
    v_fmac_f32 v197, v60, v172
    v_fmac_f32 v197, v61, v173
    v_fmac_f32 v197, v62, v174
    v_fmac_f32 v197, v63, v175
    s_nop 1
    v_permlane32_swap_b32 v199, v197
    v_add_f32 v197, v199, v197
    s_set_gpr_idx_on s51, gpr_idx(DST)
    s_nop 0
    v_cvt_pk_bf16_f32 v207, v200, v201
    v_cvt_pk_bf16_f32 v209, v254, v255
    v_cvt_pk_bf16_f32 v208, v196, v197
    s_set_gpr_idx_off
    s_add_u32 s50, s50, 1
    s_add_u32 s51, s51, 6
    s_cmp_ge_u32 s50, 4
    s_cbranch_scc1 LAST0
    s_waitcnt lgkmcnt(5)
    v_readfirstlane_b32 s66, v252
    s_add_u32 s53, s53, 1
    v_mov_b32 v252, s53
    s_cmp_le_u32 s53, s66
    ds_write2_b32 v251, v252, v252 offset0:0 offset1:8
    s_setprio 1
    s_cbranch_scc1 PRIO_6
    s_setprio 0
PRIO_6:
    s_cmp_eq_u32 s52, 4
    s_cbranch_scc1 ITEM_0_4
    s_cmp_eq_u32 s52, 5
    s_cbranch_scc1 ITEM_0_5
    s_cmp_eq_u32 s52, 3
    s_cbranch_scc1 ITEM_0_3
    s_cmp_eq_u32 s52, 6
    s_cbranch_scc1 ITEM_0_6
    s_cmp_eq_u32 s52, 8
    s_cbranch_scc1 ITEM_0_8
    s_branch ITEM_0_2
.p2align 6
ITEM_0_3:
    s_mov_b64 exec, s[54:55]
    ds_read_u16_d16_hi v243, v250 offset:128
    s_mov_b64 exec, -1
    ds_read_b64_tr_b16 v[72:73], v249 offset:512
    ds_read_b64_tr_b16 v[76:77], v249 offset:576
    s_waitcnt lgkmcnt(3)
    v_mul_f32_dpp v196, v242, v64 row_newbcast:0 row_mask:0xf bank_mask:0xf
    v_mul_f32_dpp v197, v242, v65 row_newbcast:1 row_mask:0xf bank_mask:0xf
    v_mul_f32_dpp v198, v242, v64 row_newbcast:8 row_mask:0xf bank_mask:0xf
    v_mul_f32_dpp v199, v242, v65 row_newbcast:9 row_mask:0xf bank_mask:0xf
    v_mul_f32_dpp v200, v242, v68 row_newbcast:2 row_mask:0xf bank_mask:0xf
    v_mul_f32_dpp v201, v242, v69 row_newbcast:3 row_mask:0xf bank_mask:0xf
    v_mul_f32_dpp v202, v242, v68 row_newbcast:10 row_mask:0xf bank_mask:0xf
    v_mul_f32_dpp v203, v242, v69 row_newbcast:11 row_mask:0xf bank_mask:0xf
    v_cvt_pk_bf16_f32 v64, v196, v197
    v_cvt_pk_bf16_f32 v68, v198, v199
    v_cvt_pk_bf16_f32 v65, v200, v201
    v_cvt_pk_bf16_f32 v69, v202, v203
    v_mul_f32_dpp v196, v242, v66 row_newbcast:4 row_mask:0xf bank_mask:0xf
    v_mul_f32_dpp v197, v242, v67 row_newbcast:5 row_mask:0xf bank_mask:0xf
    v_mul_f32_dpp v198, v242, v66 row_newbcast:12 row_mask:0xf bank_mask:0xf
    v_mul_f32_dpp v199, v242, v67 row_newbcast:13 row_mask:0xf bank_mask:0xf
    v_mul_f32_dpp v200, v242, v70 row_newbcast:6 row_mask:0xf bank_mask:0xf
    v_mul_f32_dpp v201, v242, v71 row_newbcast:7 row_mask:0xf bank_mask:0xf
    v_mul_f32_dpp v202, v242, v70 row_newbcast:14 row_mask:0xf bank_mask:0xf
    v_mul_f32_dpp v203, v242, v71 row_newbcast:15 row_mask:0xf bank_mask:0xf
    v_cvt_pk_bf16_f32 v66, v196, v197
    v_cvt_pk_bf16_f32 v70, v198, v199
    v_cvt_pk_bf16_f32 v67, v200, v201
    v_cvt_pk_bf16_f32 v71, v202, v203
    s_nop 0
    s_waitcnt vmcnt(4) lgkmcnt(0)
    v_mfma_f32_32x32x16_bf16 v[0:15], v[64:67], v[176:179], 0
    v_mul_f32_dpp v196, v243, v72 row_newbcast:0 row_mask:0xf bank_mask:0xf
    v_mul_f32_dpp v197, v243, v73 row_newbcast:1 row_mask:0xf bank_mask:0xf
    v_mul_f32_dpp v198, v243, v72 row_newbcast:8 row_mask:0xf bank_mask:0xf
    v_mul_f32_dpp v199, v243, v73 row_newbcast:9 row_mask:0xf bank_mask:0xf
    v_mul_f32_dpp v200, v243, v76 row_newbcast:2 row_mask:0xf bank_mask:0xf
    v_mul_f32_dpp v201, v243, v77 row_newbcast:3 row_mask:0xf bank_mask:0xf
    s_add_u32 m0, s21, 0
    v_mfma_f32_32x32x16_bf16 v[16:31], v[68:71], v[176:179], 0
    buffer_load_dwordx4 v234, s[4:7], s36 offen lds
    buffer_load_dwordx4 v235, s[8:11], s36 offen offset:1024 lds
    ds_read_b64_tr_b16 v[176:177], v244 offset:2048
    ds_read_b64_tr_b16 v[184:185], v245 offset:2048
    v_mul_f32_dpp v202, v243, v76 row_newbcast:10 row_mask:0xf bank_mask:0xf
    v_mul_f32_dpp v203, v243, v77 row_newbcast:11 row_mask:0xf bank_mask:0xf
    v_cvt_pk_bf16_f32 v72, v196, v197
    v_cvt_pk_bf16_f32 v76, v198, v199
    v_cvt_pk_bf16_f32 v73, v200, v201
    v_cvt_pk_bf16_f32 v77, v202, v203
    s_nop 0
    s_waitcnt lgkmcnt(0)
    v_mfma_f32_32x32x8_bf16 v[0:15], v[72:73], v[176:177], v[0:15]
    s_add_u32 m0, s21, 2048
    v_mfma_f32_32x32x8_bf16 v[16:31], v[76:77], v[176:177], v[16:31]
    buffer_load_dwordx4 v236, s[4:7], s36 offen lds
    s_mov_b32 m0, s50
    s_nop 0
    s_movrels_b32 s71, s23
    s_bfe_u32 s46, s71, 0x30012
    s_mov_b32 m0, s46
    s_and_b32 s66, s71, 0x3ffff
    s_movrels_b32 s68, s57
    s_movrels_b32 s69, s61
    s_sub_u32 s48, s66, s47
    s_mov_b32 s47, s66
    s_lshr_b32 s52, s71, 28
    s_lshl_b32 s67, s46, 9
    s_add_u32 s66, s66, s67
    s_sub_u32 s49, s66, s42
    s_mov_b32 s42, s66
    s_bfe_u32 s66, s68, 655360
    s_add_u32 s43, s42, s66
    s_bfe_u32 s39, s69, 655360
    s_bfe_u32 s66, s68, 655370
    s_add_u32 s44, s42, s66
    s_bfe_u32 s40, s69, 655370
    s_bfe_u32 s66, s68, 655380
    s_add_u32 s45, s42, s66
    s_bfe_u32 s41, s69, 655380
    s_and_b32 s66, s46, s33
    s_cselect_b32 s72, -1, 1
    s_cselect_b32 s76, s47, 163712
    s_cmp_ge_u32 s66, 2
    s_cselect_b32 s73, -1, 0
    s_add_u32 s77, s47, 1024
    s_cmp_ge_u32 s66, 4
    s_cselect_b32 s75, -1, 0
    s_cmp_ge_u32 s66, 3
    s_cselect_b32 s74, -1, 1
    s_cselect_b32 s77, s77, 163712
    v_add_u32 v252, s44, v247
    ds_read_u16 v238, v252
    ds_read_u16 v239, v252 offset:64
    v_add_u32 v252, s45, v247
    ds_read_u16 v240, v252
    ds_read_u16 v241, v252 offset:64
    v_mfma_f32_32x32x16_bf16 v[32:47], v[64:67], v[180:183], 0
    v_mul_f32 v196, v0, v96
    v_fmac_f32 v196, v1, v97
    v_fmac_f32 v196, v2, v98
    v_fmac_f32 v196, v3, v99
    v_fmac_f32 v196, v4, v100
    v_fmac_f32 v196, v5, v101
    v_fmac_f32 v196, v6, v102
    v_fmac_f32 v196, v7, v103
    v_mul_f32 v198, v8, v128
    v_fmac_f32 v198, v9, v129
    v_mfma_f32_32x32x16_bf16 v[48:63], v[68:71], v[180:183], 0
    v_add_u32 v253, s47, v248
    ds_read_b32 v254, v253
    ds_read_b32 v255, v253 offset:256
    s_waitcnt vmcnt(5)
    ds_read_b64_tr_b16 v[176:177], v244 offset:4096
    ds_read_b64_tr_b16 v[178:179], v244 offset:5120
    ds_read_b64_tr_b16 v[180:181], v245 offset:4096
    ds_read_b64_tr_b16 v[182:183], v245 offset:5120
    v_fmac_f32 v198, v10, v130
    v_fmac_f32 v198, v11, v131
    v_fmac_f32 v198, v12, v132
    v_fmac_f32 v198, v13, v133
    v_fmac_f32 v198, v14, v134
    v_fmac_f32 v198, v15, v135
    v_mul_f32 v200, v16, v128
    v_fmac_f32 v200, v17, v129
    v_permlane32_swap_b32 v196, v198
    v_mfma_f32_32x32x8_bf16 v[32:47], v[72:73], v[184:185], v[32:47]
    v_fmac_f32 v200, v18, v130
    v_fmac_f32 v200, v19, v131
    v_fmac_f32 v200, v20, v132
    v_fmac_f32 v200, v21, v133
    v_fmac_f32 v200, v22, v134
    v_fmac_f32 v200, v23, v135
    v_add_f32 v198, v196, v198
    v_mul_f32_e64 v202, v24, -v128
    v_fma_f32 v202, v25, -v129, v202
    v_mfma_f32_32x32x8_bf16 v[48:63], v[76:77], v[184:185], v[48:63]
    v_fma_f32 v202, v26, -v130, v202
    v_fma_f32 v202, v27, -v131, v202
    v_fma_f32 v202, v28, -v132, v202
    v_fma_f32 v202, v29, -v133, v202
    v_fma_f32 v202, v30, -v134, v202
    v_fma_f32 v202, v31, -v135, v202
    s_nop 1
    v_permlane32_swap_b32 v200, v202
    v_add_f32 v202, v200, v202
    s_waitcnt vmcnt(3) lgkmcnt(0)
    v_mfma_f32_32x32x16_bf16 v[0:15], v[64:67], v[176:179], 0
    v_mul_f32 v197, v32, v104
    v_fmac_f32 v197, v33, v105
    v_fmac_f32 v197, v34, v106
    v_fmac_f32 v197, v35, v107
    v_fmac_f32 v197, v36, v108
    v_fmac_f32 v197, v37, v109
    v_fmac_f32 v197, v38, v110
    v_fmac_f32 v197, v39, v111
    v_mul_f32 v199, v40, v136
    v_fmac_f32 v199, v41, v137
    v_fmac_f32 v199, v42, v138
    s_add_u32 m0, s21, 4096
    v_mfma_f32_32x32x16_bf16 v[16:31], v[68:71], v[176:179], 0
    buffer_load_dwordx4 v234, s[4:7], s37 offen lds
    buffer_load_dwordx4 v235, s[8:11], s37 offen offset:1024 lds
    ds_read_b64_tr_b16 v[176:177], v244 offset:6144
    ds_read_b64_tr_b16 v[184:185], v245 offset:6144
    v_add_u32 v252, s42, v247
    ds_read_u16 v234, v252
    ds_read_u16 v235, v252 offset:64
    s_mov_b32 m0, s76
    s_mov_b64 exec, s[72:73]
    buffer_load_dwordx4 v254, s[12:15], 0 offen  lds
    s_mov_b32 m0, s77
    s_mov_b64 exec, s[74:75]
    buffer_load_dwordx4 v255, s[12:15], 0 offen  lds
    s_mov_b64 exec, -1
    v_fmac_f32 v199, v43, v139
    v_fmac_f32 v199, v44, v140
    v_fmac_f32 v199, v45, v141
    v_fmac_f32 v199, v46, v142
    v_fmac_f32 v199, v47, v143
    v_mul_f32 v201, v48, v136
    v_fmac_f32 v201, v49, v137
    v_permlane32_swap_b32 v197, v199
    v_fmac_f32 v201, v50, v138
    v_fmac_f32 v201, v51, v139
    s_waitcnt lgkmcnt(2)
    v_mfma_f32_32x32x8_bf16 v[0:15], v[72:73], v[176:177], v[0:15]
    v_fmac_f32 v201, v52, v140
    v_fmac_f32 v201, v53, v141
    v_fmac_f32 v201, v54, v142
    v_fmac_f32 v201, v55, v143
    v_add_f32 v199, v197, v199
    v_mul_f32_e64 v203, v56, -v136
    v_fma_f32 v203, v57, -v137, v203
    v_fma_f32 v203, v58, -v138, v203
    v_fma_f32 v203, v59, -v139, v203
    v_fma_f32 v203, v60, -v140, v203
    v_fma_f32 v203, v61, -v141, v203
    s_add_u32 m0, s21, 6144
    v_mfma_f32_32x32x8_bf16 v[16:31], v[76:77], v[176:177], v[16:31]
    buffer_load_dwordx4 v236, s[4:7], s37 offen lds
    v_add_u32 v252, s43, v247
    ds_read_u16 v236, v252
    ds_read_u16 v237, v252 offset:64
    v_fma_f32 v203, v62, -v142, v203
    v_fma_f32 v203, v63, -v143, v203
    s_nop 1
    v_permlane32_swap_b32 v201, v203
    v_add_f32 v203, v201, v203
    s_set_gpr_idx_on s51, gpr_idx(DST)
    s_nop 0
    v_cvt_pk_bf16_f32 v204, v198, v199
    v_cvt_pk_bf16_f32 v205, v202, v203
    s_set_gpr_idx_off
    v_mfma_f32_32x32x16_bf16 v[32:47], v[64:67], v[180:183], 0
    v_mul_f32 v196, v0, v144
    v_fmac_f32 v196, v1, v145
    v_fmac_f32 v196, v2, v146
    v_fmac_f32 v196, v3, v147
    v_fmac_f32 v196, v4, v148
    v_fmac_f32 v196, v5, v149
    v_fmac_f32 v196, v6, v150
    v_fmac_f32 v196, v7, v151
    v_mfma_f32_32x32x16_bf16 v[48:63], v[68:71], v[180:183], 0
    s_waitcnt vmcnt(6)
    ds_read_b64_tr_b16 v[176:177], v244 offset:0
    ds_read_b64_tr_b16 v[178:179], v244 offset:1024
    ds_read_b64_tr_b16 v[180:181], v245 offset:0
    ds_read_b64_tr_b16 v[182:183], v245 offset:1024
    v_mul_f32 v198, v8, v112
    v_fmac_f32 v198, v9, v113
    v_fmac_f32 v198, v10, v114
    v_fmac_f32 v198, v11, v115
    v_fmac_f32 v198, v12, v116
    v_fmac_f32 v198, v13, v117
    v_fmac_f32 v198, v14, v118
    v_fmac_f32 v198, v15, v119
    v_mfma_f32_32x32x8_bf16 v[32:47], v[72:73], v[184:185], v[32:47]
    v_mul_f32_e64 v200, v16, -v160
    v_fma_f32 v200, v17, -v161, v200
    v_fma_f32 v200, v18, -v162, v200
    v_fma_f32 v200, v19, -v163, v200
    v_fma_f32 v200, v20, -v164, v200
    v_fma_f32 v200, v21, -v165, v200
    v_fma_f32 v200, v22, -v166, v200
    v_fma_f32 v200, v23, -v167, v200
    v_mfma_f32_32x32x8_bf16 v[48:63], v[76:77], v[184:185], v[48:63]
    v_mul_f32_e64 v202, v24, -v160
    v_fma_f32 v202, v25, -v161, v202
    v_fma_f32 v202, v26, -v162, v202
    v_fma_f32 v202, v27, -v163, v202
    v_fma_f32 v202, v28, -v164, v202
    v_fma_f32 v202, v29, -v165, v202
    v_fma_f32 v202, v30, -v166, v202
    v_fma_f32 v202, v31, -v167, v202
    s_waitcnt vmcnt(5) lgkmcnt(0)
    v_mfma_f32_32x32x16_bf16 v[0:15], v[64:67], v[176:179], 0
    v_mul_f32 v197, v32, v152
    v_fmac_f32 v197, v33, v153
    v_fmac_f32 v197, v34, v154
    v_fmac_f32 v197, v35, v155
    v_fmac_f32 v197, v36, v156
    v_fmac_f32 v197, v37, v157
    v_fmac_f32 v197, v38, v158
    v_fmac_f32 v197, v39, v159
    s_add_u32 m0, s21, 0
    v_mfma_f32_32x32x16_bf16 v[16:31], v[68:71], v[176:179], 0
    v_lshl_add_u32 v234, v234, 10, v246
    v_lshl_add_u32 v235, v235, 10, v246
    buffer_load_dwordx4 v234, s[4:7], s38 offen lds
    buffer_load_dwordx4 v235, s[8:11], s38 offen offset:1024 lds
    ds_read_b64_tr_b16 v[176:177], v244 offset:2048
    ds_read_b64_tr_b16 v[184:185], v245 offset:2048
    v_mul_f32 v199, v40, v120
    v_fmac_f32 v199, v41, v121
    v_fmac_f32 v199, v42, v122
    v_fmac_f32 v199, v43, v123
    v_fmac_f32 v199, v44, v124
    v_fmac_f32 v199, v45, v125
    v_fmac_f32 v199, v46, v126
    v_fmac_f32 v199, v47, v127
    s_waitcnt lgkmcnt(0)
    v_mfma_f32_32x32x8_bf16 v[0:15], v[72:73], v[176:177], v[0:15]
    v_mul_f32_e64 v201, v48, -v168
    v_fma_f32 v201, v49, -v169, v201
    v_fma_f32 v201, v50, -v170, v201
    v_fma_f32 v201, v51, -v171, v201
    v_fma_f32 v201, v52, -v172, v201
    v_fma_f32 v201, v53, -v173, v201
    v_fma_f32 v201, v54, -v174, v201
    v_fma_f32 v201, v55, -v175, v201
    s_add_u32 m0, s21, 2048
    v_mfma_f32_32x32x8_bf16 v[16:31], v[76:77], v[176:177], v[16:31]
    v_lshl_add_u32 v236, v236, 10, v246
    v_lshl_add_u32 v237, v237, 10, v246
    buffer_load_dwordx4 v236, s[4:7], s39 offen lds
    buffer_load_dwordx4 v237, s[8:11], s39 offen offset:1024 lds
    v_mul_f32_e64 v203, v56, -v168
    v_fma_f32 v203, v57, -v169, v203
    v_fma_f32 v203, v58, -v170, v203
    v_fma_f32 v203, v59, -v171, v203
    v_fma_f32 v203, v60, -v172, v203
    v_fma_f32 v203, v61, -v173, v203
    v_fma_f32 v203, v62, -v174, v203
    v_fma_f32 v203, v63, -v175, v203
    v_mfma_f32_32x32x16_bf16 v[32:47], v[64:67], v[180:183], 0
    v_mul_f32 v254, v0, v144
    v_fmac_f32 v254, v1, v145
    v_fmac_f32 v254, v2, v146
    v_fmac_f32 v254, v3, v147
    v_fmac_f32 v254, v4, v148
    v_mfma_f32_32x32x16_bf16 v[48:63], v[68:71], v[180:183], 0
    ds_swizzle_b32 v68, v68 offset:0x401F
    ds_swizzle_b32 v69, v69 offset:0x401F
    ds_swizzle_b32 v70, v70 offset:0x401F
    ds_swizzle_b32 v71, v71 offset:0x401F
    s_waitcnt vmcnt(7)
    ds_read_b64_tr_b16 v[176:177], v244 offset:4096
    ds_read_b64_tr_b16 v[178:179], v244 offset:5120
    ds_read_b64_tr_b16 v[180:181], v245 offset:4096
    ds_read_b64_tr_b16 v[182:183], v245 offset:5120
    v_fmac_f32 v254, v5, v149
    v_fmac_f32 v254, v6, v150
    v_fmac_f32 v254, v7, v151
    v_fmac_f32 v200, v8, v160
    v_mfma_f32_32x32x8_bf16 v[32:47], v[72:73], v[184:185], v[32:47]
    v_fmac_f32 v200, v9, v161
    v_permlane32_swap_b32 v196, v254
    v_fmac_f32 v200, v10, v162
    v_fmac_f32 v200, v11, v163
    v_fmac_f32 v200, v12, v164
    v_mfma_f32_32x32x8_bf16 v[48:63], v[76:77], v[184:185], v[48:63]
    ds_swizzle_b32 v76, v76 offset:0x401F
    ds_swizzle_b32 v77, v77 offset:0x401F
    v_fmac_f32 v200, v13, v165
    v_fmac_f32 v200, v14, v166
    v_fmac_f32 v200, v15, v167
    v_add_f32 v254, v196, v254
    s_waitcnt lgkmcnt(6)
    s_mov_b64 exec, s[56:57]
    v_xor_b32 v68, 0x80008000, v68
    v_xor_b32 v69, 0x80008000, v69
    v_xor_b32 v70, 0x80008000, v70
    v_xor_b32 v71, 0x80008000, v71
    s_mov_b64 exec, -1
    s_waitcnt vmcnt(4) lgkmcnt(2)
    v_mfma_f32_32x32x16_bf16 v[0:15], v[64:67], v[176:179], 0
    v_mul_f32 v255, v32, v152
    v_fmac_f32 v255, v33, v153
    v_fmac_f32 v255, v34, v154
    v_fmac_f32 v255, v35, v155
    v_fmac_f32 v255, v36, v156
    v_fmac_f32 v255, v37, v157
    s_add_u32 m0, s21, 4096
    v_mfma_f32_32x32x16_bf16 v[16:31], v[68:71], v[176:179], v[16:31]
    v_lshl_add_u32 v238, v238, 10, v246
    v_lshl_add_u32 v239, v239, 10, v246
    buffer_load_dwordx4 v238, s[4:7], s40 offen lds
    buffer_load_dwordx4 v239, s[8:11], s40 offen offset:1024 lds
    ds_read_b64_tr_b16 v[176:177], v244 offset:6144
    ds_read_b64_tr_b16 v[184:185], v245 offset:6144
    v_fmac_f32 v255, v38, v158
    v_fmac_f32 v255, v39, v159
    v_fmac_f32 v201, v40, v168
    v_fmac_f32 v201, v41, v169
    v_permlane32_swap_b32 v197, v255
    s_waitcnt lgkmcnt(0)
    s_mov_b64 exec, s[56:57]
    v_xor_b32 v76, 0x80008000, v76
    v_xor_b32 v77, 0x80008000, v77
    s_mov_b64 exec, -1
    v_mfma_f32_32x32x8_bf16 v[0:15], v[72:73], v[176:177], v[0:15]
    v_fmac_f32 v201, v42, v170
    v_fmac_f32 v201, v43, v171
    v_fmac_f32 v201, v44, v172
    v_fmac_f32 v201, v45, v173
    v_fmac_f32 v201, v46, v174
    v_fmac_f32 v201, v47, v175
    s_add_u32 m0, s21, 6144
    v_mfma_f32_32x32x8_bf16 v[16:31], v[76:77], v[176:177], v[16:31]
    v_lshl_add_u32 v240, v240, 10, v246
    v_lshl_add_u32 v241, v241, 10, v246
    buffer_load_dwordx4 v240, s[4:7], s41 offen lds
    buffer_load_dwordx4 v241, s[8:11], s41 offen offset:1024 lds
    v_add_f32 v255, v197, v255
    s_set_gpr_idx_on s51, gpr_idx(DST)
    s_nop 0
    v_cvt_pk_bf16_f32 v206, v254, v255
    s_set_gpr_idx_off
    v_mfma_f32_32x32x16_bf16 v[32:47], v[64:67], v[180:183], 0
    v_mul_f32 v254, v0, v144
    v_fmac_f32 v254, v1, v145
    v_fmac_f32 v254, v2, v146
    v_fmac_f32 v254, v3, v147
    v_fmac_f32 v254, v4, v148
    v_fmac_f32 v254, v5, v149
    v_fmac_f32 v254, v6, v150
    v_fmac_f32 v254, v7, v151
    v_fma_f32 v202, v8, -v160, v202
    v_fma_f32 v202, v9, -v161, v202
    v_mfma_f32_32x32x16_bf16 v[48:63], v[68:71], v[180:183], v[48:63]
    s_waitcnt vmcnt(6)
    ds_read_b64_tr_b16 v[176:177], v244 offset:0
    ds_read_b64_tr_b16 v[178:179], v244 offset:1024
    ds_read_b64_tr_b16 v[180:181], v245 offset:0
    ds_read_b64_tr_b16 v[182:183], v245 offset:1024
    v_permlane32_swap_b32 v254, v200
    v_fma_f32 v202, v10, -v162, v202
    v_fma_f32 v202, v11, -v163, v202
    v_fma_f32 v202, v12, -v164, v202
    v_fma_f32 v202, v13, -v165, v202
    v_fma_f32 v202, v14, -v166, v202
    v_fma_f32 v202, v15, -v167, v202
    v_add_f32 v200, v254, v200
    v_fmac_f32 v198, v16, v112
    v_permlane32_swap_b32 v202, v254
    v_mfma_f32_32x32x8_bf16 v[32:47], v[72:73], v[184:185], v[32:47]
    v_fmac_f32 v198, v17, v113
    v_fmac_f32 v198, v18, v114
    v_fmac_f32 v198, v19, v115
    v_fmac_f32 v198, v20, v116
    v_fmac_f32 v198, v21, v117
    v_fmac_f32 v198, v22, v118
    v_fmac_f32 v198, v23, v119
    v_add_f32 v254, v202, v254
    v_mul_f32 v196, v24, v160
    v_fmac_f32 v196, v25, v161
    v_mfma_f32_32x32x8_bf16 v[48:63], v[76:77], v[184:185], v[48:63]
    v_add_u32 v249, s48, v249
    v_add_u32 v250, s49, v250
    ds_read_b32 v252, v251 offset:16
    ds_read_b64_tr_b16 v[64:65], v249 offset:0
    ds_read_b64_tr_b16 v[68:69], v249 offset:64
    ds_read_b64_tr_b16 v[66:67], v249 offset:256
    ds_read_b64_tr_b16 v[70:71], v249 offset:320
    s_mov_b64 exec, s[54:55]
    ds_read_u16_d16_hi v242, v250 offset:0
    s_mov_b64 exec, -1
    v_fmac_f32 v196, v26, v162
    v_fmac_f32 v196, v27, v163
    v_fmac_f32 v196, v28, v164
    v_fmac_f32 v196, v29, v165
    v_fmac_f32 v196, v30, v166
    v_fmac_f32 v196, v31, v167
    s_nop 1
    v_permlane32_swap_b32 v198, v196
    v_add_f32 v196, v198, v196
    v_mul_f32 v255, v32, v152
    v_fmac_f32 v255, v33, v153
    v_fmac_f32 v255, v34, v154
    v_fmac_f32 v255, v35, v155
    v_fmac_f32 v255, v36, v156
    v_fmac_f32 v255, v37, v157
    v_fmac_f32 v255, v38, v158
    v_fmac_f32 v255, v39, v159
    v_fma_f32 v203, v40, -v168, v203
    v_fma_f32 v203, v41, -v169, v203
    v_permlane32_swap_b32 v255, v201
    v_fma_f32 v203, v42, -v170, v203
    v_fma_f32 v203, v43, -v171, v203
    v_fma_f32 v203, v44, -v172, v203
    v_fma_f32 v203, v45, -v173, v203
    v_fma_f32 v203, v46, -v174, v203
    v_fma_f32 v203, v47, -v175, v203
    v_add_f32 v201, v255, v201
    v_fmac_f32 v199, v48, v120
    v_permlane32_swap_b32 v203, v255
    v_fmac_f32 v199, v49, v121
    v_fmac_f32 v199, v50, v122
    v_fmac_f32 v199, v51, v123
    v_fmac_f32 v199, v52, v124
    v_fmac_f32 v199, v53, v125
    v_fmac_f32 v199, v54, v126
    v_fmac_f32 v199, v55, v127
    v_add_f32 v255, v203, v255
    v_mul_f32 v197, v56, v168
    v_fmac_f32 v197, v57, v169
    v_fmac_f32 v197, v58, v170
    v_fmac_f32 v197, v59, v171
    v_fmac_f32 v197, v60, v172
    v_fmac_f32 v197, v61, v173
    v_fmac_f32 v197, v62, v174
    v_fmac_f32 v197, v63, v175
    s_nop 1
    v_permlane32_swap_b32 v199, v197
    v_add_f32 v197, v199, v197
    s_set_gpr_idx_on s51, gpr_idx(DST)
    s_nop 0
    v_cvt_pk_bf16_f32 v207, v200, v201
    v_cvt_pk_bf16_f32 v209, v254, v255
    v_cvt_pk_bf16_f32 v208, v196, v197
    s_set_gpr_idx_off
    s_add_u32 s50, s50, 1
    s_add_u32 s51, s51, 6
    s_cmp_ge_u32 s50, 4
    s_cbranch_scc1 LAST0
    s_waitcnt lgkmcnt(5)
    v_readfirstlane_b32 s66, v252
    s_add_u32 s53, s53, 1
    v_mov_b32 v252, s53
    s_cmp_le_u32 s53, s66
    ds_write2_b32 v251, v252, v252 offset0:0 offset1:8
    s_setprio 1
    s_cbranch_scc1 PRIO_7
    s_setprio 0
PRIO_7:
    s_cmp_eq_u32 s52, 4
    s_cbranch_scc1 ITEM_0_4
    s_cmp_eq_u32 s52, 5
    s_cbranch_scc1 ITEM_0_5
    s_cmp_eq_u32 s52, 3
    s_cbranch_scc1 ITEM_0_3
    s_cmp_eq_u32 s52, 6
    s_cbranch_scc1 ITEM_0_6
    s_cmp_eq_u32 s52, 8
    s_cbranch_scc1 ITEM_0_8
    s_branch ITEM_0_2
.p2align 6
ITEM_0_6:
    s_mov_b64 exec, s[54:55]
    ds_read_u16_d16_hi v243, v250 offset:128
    s_mov_b64 exec, -1
    ds_read_b64_tr_b16 v[72:73], v249 offset:512
    ds_read_b64_tr_b16 v[76:77], v249 offset:576
    ds_read_b64_tr_b16 v[74:75], v249 offset:768
    ds_read_b64_tr_b16 v[78:79], v249 offset:832
    ds_read_b64_tr_b16 v[80:81], v249 offset:1024
    ds_read_b64_tr_b16 v[84:85], v249 offset:1088
    ds_read_b64_tr_b16 v[82:83], v249 offset:1280
    ds_read_b64_tr_b16 v[86:87], v249 offset:1344
    s_waitcnt lgkmcnt(9)
    v_mul_f32_dpp v196, v242, v64 row_newbcast:0 row_mask:0xf bank_mask:0xf
    v_mul_f32_dpp v197, v242, v65 row_newbcast:1 row_mask:0xf bank_mask:0xf
    v_mul_f32_dpp v198, v242, v64 row_newbcast:8 row_mask:0xf bank_mask:0xf
    v_mul_f32_dpp v199, v242, v65 row_newbcast:9 row_mask:0xf bank_mask:0xf
    v_mul_f32_dpp v200, v242, v68 row_newbcast:2 row_mask:0xf bank_mask:0xf
    v_mul_f32_dpp v201, v242, v69 row_newbcast:3 row_mask:0xf bank_mask:0xf
    v_mul_f32_dpp v202, v242, v68 row_newbcast:10 row_mask:0xf bank_mask:0xf
    v_mul_f32_dpp v203, v242, v69 row_newbcast:11 row_mask:0xf bank_mask:0xf
    v_cvt_pk_bf16_f32 v64, v196, v197
    v_cvt_pk_bf16_f32 v68, v198, v199
    v_cvt_pk_bf16_f32 v65, v200, v201
    v_cvt_pk_bf16_f32 v69, v202, v203
    v_mul_f32_dpp v196, v242, v66 row_newbcast:4 row_mask:0xf bank_mask:0xf
    v_mul_f32_dpp v197, v242, v67 row_newbcast:5 row_mask:0xf bank_mask:0xf
    v_mul_f32_dpp v198, v242, v66 row_newbcast:12 row_mask:0xf bank_mask:0xf
    v_mul_f32_dpp v199, v242, v67 row_newbcast:13 row_mask:0xf bank_mask:0xf
    v_mul_f32_dpp v200, v242, v70 row_newbcast:6 row_mask:0xf bank_mask:0xf
    v_mul_f32_dpp v201, v242, v71 row_newbcast:7 row_mask:0xf bank_mask:0xf
    v_mul_f32_dpp v202, v242, v70 row_newbcast:14 row_mask:0xf bank_mask:0xf
    v_mul_f32_dpp v203, v242, v71 row_newbcast:15 row_mask:0xf bank_mask:0xf
    v_cvt_pk_bf16_f32 v66, v196, v197
    v_cvt_pk_bf16_f32 v70, v198, v199
    v_cvt_pk_bf16_f32 v67, v200, v201
    v_cvt_pk_bf16_f32 v71, v202, v203
    s_mov_b64 exec, s[54:55]
    ds_read_u16_d16_hi v242, v250 offset:256
    s_mov_b64 exec, -1
    s_waitcnt vmcnt(4) lgkmcnt(5)
    v_mfma_f32_32x32x16_bf16 v[0:15], v[64:67], v[176:179], 0
    v_mul_f32_dpp v196, v243, v72 row_newbcast:0 row_mask:0xf bank_mask:0xf
    v_mul_f32_dpp v197, v243, v73 row_newbcast:1 row_mask:0xf bank_mask:0xf
    v_mul_f32_dpp v198, v243, v72 row_newbcast:8 row_mask:0xf bank_mask:0xf
    v_mul_f32_dpp v199, v243, v73 row_newbcast:9 row_mask:0xf bank_mask:0xf
    v_mul_f32_dpp v200, v243, v76 row_newbcast:2 row_mask:0xf bank_mask:0xf
    v_mul_f32_dpp v201, v243, v77 row_newbcast:3 row_mask:0xf bank_mask:0xf
    v_mul_f32_dpp v202, v243, v76 row_newbcast:10 row_mask:0xf bank_mask:0xf
    v_mul_f32_dpp v203, v243, v77 row_newbcast:11 row_mask:0xf bank_mask:0xf
    v_cvt_pk_bf16_f32 v72, v196, v197
    v_cvt_pk_bf16_f32 v76, v198, v199
    v_cvt_pk_bf16_f32 v73, v200, v201
    v_cvt_pk_bf16_f32 v77, v202, v203
    s_add_u32 m0, s21, 0
    v_mfma_f32_32x32x16_bf16 v[16:31], v[68:71], v[176:179], 0
    buffer_load_dwordx4 v236, s[4:7], s35 offen lds
    buffer_load_dwordx4 v237, s[8:11], s35 offen offset:1024 lds
    ds_read_b64_tr_b16 v[176:177], v244 offset:2048
    ds_read_b64_tr_b16 v[178:179], v244 offset:3072
    ds_read_b64_tr_b16 v[184:185], v245 offset:2048
    ds_read_b64_tr_b16 v[186:187], v245 offset:3072
    v_mul_f32_dpp v196, v243, v74 row_newbcast:4 row_mask:0xf bank_mask:0xf
    v_mul_f32_dpp v197, v243, v75 row_newbcast:5 row_mask:0xf bank_mask:0xf
    v_mul_f32_dpp v198, v243, v74 row_newbcast:12 row_mask:0xf bank_mask:0xf
    v_mul_f32_dpp v199, v243, v75 row_newbcast:13 row_mask:0xf bank_mask:0xf
    v_mul_f32_dpp v200, v243, v78 row_newbcast:6 row_mask:0xf bank_mask:0xf
    v_mul_f32_dpp v201, v243, v79 row_newbcast:7 row_mask:0xf bank_mask:0xf
    v_mul_f32_dpp v202, v243, v78 row_newbcast:14 row_mask:0xf bank_mask:0xf
    v_mul_f32_dpp v203, v243, v79 row_newbcast:15 row_mask:0xf bank_mask:0xf
    v_cvt_pk_bf16_f32 v74, v196, v197
    v_cvt_pk_bf16_f32 v78, v198, v199
    v_cvt_pk_bf16_f32 v75, v200, v201
    v_cvt_pk_bf16_f32 v79, v202, v203
    s_nop 0
    s_waitcnt vmcnt(4) lgkmcnt(0)
    v_mfma_f32_32x32x16_bf16 v[0:15], v[72:75], v[176:179], v[0:15]
    v_mul_f32_dpp v196, v242, v80 row_newbcast:0 row_mask:0xf bank_mask:0xf
    v_mul_f32_dpp v197, v242, v81 row_newbcast:1 row_mask:0xf bank_mask:0xf
    v_mul_f32_dpp v198, v242, v80 row_newbcast:8 row_mask:0xf bank_mask:0xf
    v_mul_f32_dpp v199, v242, v81 row_newbcast:9 row_mask:0xf bank_mask:0xf
    v_mul_f32_dpp v200, v242, v84 row_newbcast:2 row_mask:0xf bank_mask:0xf
    v_mul_f32_dpp v201, v242, v85 row_newbcast:3 row_mask:0xf bank_mask:0xf
    v_mul_f32_dpp v202, v242, v84 row_newbcast:10 row_mask:0xf bank_mask:0xf
    v_mul_f32_dpp v203, v242, v85 row_newbcast:11 row_mask:0xf bank_mask:0xf
    v_cvt_pk_bf16_f32 v80, v196, v197
    v_cvt_pk_bf16_f32 v84, v198, v199
    v_cvt_pk_bf16_f32 v81, v200, v201
    v_cvt_pk_bf16_f32 v85, v202, v203
    s_add_u32 m0, s21, 2048
    v_mfma_f32_32x32x16_bf16 v[16:31], v[76:79], v[176:179], v[16:31]
    buffer_load_dwordx4 v238, s[4:7], s35 offen lds
    buffer_load_dwordx4 v239, s[8:11], s35 offen offset:1024 lds
    ds_read_b64_tr_b16 v[176:177], v244 offset:4096
    ds_read_b64_tr_b16 v[178:179], v244 offset:5120
    ds_read_b64_tr_b16 v[188:189], v245 offset:4096
    ds_read_b64_tr_b16 v[190:191], v245 offset:5120
    v_mul_f32_dpp v196, v242, v82 row_newbcast:4 row_mask:0xf bank_mask:0xf
    v_mul_f32_dpp v197, v242, v83 row_newbcast:5 row_mask:0xf bank_mask:0xf
    v_mul_f32_dpp v198, v242, v82 row_newbcast:12 row_mask:0xf bank_mask:0xf
    v_mul_f32_dpp v199, v242, v83 row_newbcast:13 row_mask:0xf bank_mask:0xf
    v_mul_f32_dpp v200, v242, v86 row_newbcast:6 row_mask:0xf bank_mask:0xf
    v_mul_f32_dpp v201, v242, v87 row_newbcast:7 row_mask:0xf bank_mask:0xf
    v_mul_f32_dpp v202, v242, v86 row_newbcast:14 row_mask:0xf bank_mask:0xf
    v_mul_f32_dpp v203, v242, v87 row_newbcast:15 row_mask:0xf bank_mask:0xf
    v_cvt_pk_bf16_f32 v82, v196, v197
    v_cvt_pk_bf16_f32 v86, v198, v199
    v_cvt_pk_bf16_f32 v83, v200, v201
    v_cvt_pk_bf16_f32 v87, v202, v203
    s_nop 0
    s_waitcnt lgkmcnt(0)
    v_mfma_f32_32x32x16_bf16 v[0:15], v[80:83], v[176:179], v[0:15]
    s_add_u32 m0, s21, 4096
    v_mfma_f32_32x32x16_bf16 v[16:31], v[84:87], v[176:179], v[16:31]
    buffer_load_dwordx4 v234, s[4:7], s36 offen lds
    buffer_load_dwordx4 v235, s[8:11], s36 offen offset:1024 lds
    s_mov_b32 m0, s50
    s_nop 0
    s_movrels_b32 s71, s23
    s_bfe_u32 s46, s71, 0x30012
    s_mov_b32 m0, s46
    s_and_b32 s66, s71, 0x3ffff
    s_movrels_b32 s68, s57
    s_movrels_b32 s69, s61
    s_sub_u32 s48, s66, s47
    s_mov_b32 s47, s66
    s_lshr_b32 s52, s71, 28
    s_lshl_b32 s67, s46, 9
    s_add_u32 s66, s66, s67
    s_sub_u32 s49, s66, s42
    s_mov_b32 s42, s66
    s_bfe_u32 s66, s68, 655360
    s_add_u32 s43, s42, s66
    s_bfe_u32 s39, s69, 655360
    s_bfe_u32 s66, s68, 655370
    s_add_u32 s44, s42, s66
    s_bfe_u32 s40, s69, 655370
    s_bfe_u32 s66, s68, 655380
    s_add_u32 s45, s42, s66
    s_bfe_u32 s41, s69, 655380
    s_and_b32 s66, s46, s33
    s_cselect_b32 s72, -1, 1
    s_cselect_b32 s76, s47, 163712
    s_cmp_ge_u32 s66, 2
    s_cselect_b32 s73, -1, 0
    s_add_u32 s77, s47, 1024
    s_cmp_ge_u32 s66, 4
    s_cselect_b32 s75, -1, 0
    s_cmp_ge_u32 s66, 3
    s_cselect_b32 s74, -1, 1
    s_cselect_b32 s77, s77, 163712
    v_add_u32 v252, s45, v247
    ds_read_u16 v240, v252
    ds_read_u16 v241, v252 offset:64
    v_mfma_f32_32x32x16_bf16 v[32:47], v[64:67], v[180:183], 0
    v_mul_f32 v196, v0, v96
    v_fmac_f32 v196, v1, v97
    v_fmac_f32 v196, v2, v98
    v_fmac_f32 v196, v3, v99
    v_fmac_f32 v196, v4, v100
    v_fmac_f32 v196, v5, v101
    v_fmac_f32 v196, v6, v102
    v_mfma_f32_32x32x16_bf16 v[48:63], v[68:71], v[180:183], 0
    v_add_u32 v253, s47, v248
    ds_read_b32 v254, v253
    ds_read_b32 v255, v253 offset:256
    v_fmac_f32 v196, v7, v103
    v_mul_f32 v198, v8, v128
    v_fmac_f32 v198, v9, v129
    v_fmac_f32 v198, v10, v130
    v_fmac_f32 v198, v11, v131
    v_fmac_f32 v198, v12, v132
    v_mfma_f32_32x32x16_bf16 v[32:47], v[72:75], v[184:187], v[32:47]
    v_fmac_f32 v198, v13, v133
    v_fmac_f32 v198, v14, v134
    v_fmac_f32 v198, v15, v135
    v_mul_f32 v200, v16, v128
    v_fmac_f32 v200, v17, v129
    v_permlane32_swap_b32 v196, v198
    v_mfma_f32_32x32x16_bf16 v[48:63], v[76:79], v[184:187], v[48:63]
    s_waitcnt vmcnt(6)
    ds_read_b64_tr_b16 v[176:177], v244 offset:6144
    ds_read_b64_tr_b16 v[178:179], v244 offset:7168
    ds_read_b64_tr_b16 v[180:181], v245 offset:6144
    ds_read_b64_tr_b16 v[182:183], v245 offset:7168
    v_fmac_f32 v200, v18, v130
    v_fmac_f32 v200, v19, v131
    v_fmac_f32 v200, v20, v132
    v_fmac_f32 v200, v21, v133
    v_fmac_f32 v200, v22, v134
    v_fmac_f32 v200, v23, v135
    v_mfma_f32_32x32x16_bf16 v[32:47], v[80:83], v[188:191], v[32:47]
    v_add_f32 v198, v196, v198
    v_mul_f32_e64 v202, v24, -v128
    v_fma_f32 v202, v25, -v129, v202
    v_fma_f32 v202, v26, -v130, v202
    v_fma_f32 v202, v27, -v131, v202
    v_fma_f32 v202, v28, -v132, v202
    v_mfma_f32_32x32x16_bf16 v[48:63], v[84:87], v[188:191], v[48:63]
    v_fma_f32 v202, v29, -v133, v202
    v_fma_f32 v202, v30, -v134, v202
    v_fma_f32 v202, v31, -v135, v202
    s_nop 1
    v_permlane32_swap_b32 v200, v202
    v_add_f32 v202, v200, v202
    s_waitcnt vmcnt(4) lgkmcnt(0)
    v_mfma_f32_32x32x16_bf16 v[0:15], v[64:67], v[176:179], 0
    v_mul_f32 v197, v32, v104
    v_fmac_f32 v197, v33, v105
    v_fmac_f32 v197, v34, v106
    v_fmac_f32 v197, v35, v107
    v_fmac_f32 v197, v36, v108
    v_fmac_f32 v197, v37, v109
    v_fmac_f32 v197, v38, v110
    s_add_u32 m0, s21, 6144
    v_mfma_f32_32x32x16_bf16 v[16:31], v[68:71], v[176:179], 0
    buffer_load_dwordx4 v236, s[4:7], s36 offen lds
    buffer_load_dwordx4 v237, s[8:11], s36 offen offset:1024 lds
    ds_read_b64_tr_b16 v[176:177], v244 offset:0
    ds_read_b64_tr_b16 v[178:179], v244 offset:1024
    ds_read_b64_tr_b16 v[184:185], v245 offset:0
    ds_read_b64_tr_b16 v[186:187], v245 offset:1024
    s_mov_b32 m0, s76
    s_mov_b64 exec, s[72:73]
    buffer_load_dwordx4 v254, s[12:15], 0 offen  lds
    s_mov_b32 m0, s77
    s_mov_b64 exec, s[74:75]
    buffer_load_dwordx4 v255, s[12:15], 0 offen  lds
    s_mov_b64 exec, -1
    v_fmac_f32 v197, v39, v111
    v_mul_f32 v199, v40, v136
    v_fmac_f32 v199, v41, v137
    v_fmac_f32 v199, v42, v138
    v_fmac_f32 v199, v43, v139
    v_fmac_f32 v199, v44, v140
    v_fmac_f32 v199, v45, v141
    s_waitcnt vmcnt(6) lgkmcnt(0)
    v_mfma_f32_32x32x16_bf16 v[0:15], v[72:75], v[176:179], v[0:15]
    v_fmac_f32 v199, v46, v142
    v_fmac_f32 v199, v47, v143
    v_mul_f32 v201, v48, v136
    v_fmac_f32 v201, v49, v137
    v_permlane32_swap_b32 v197, v199
    v_fmac_f32 v201, v50, v138
    v_fmac_f32 v201, v51, v139
    s_add_u32 m0, s21, 0
    v_mfma_f32_32x32x16_bf16 v[16:31], v[76:79], v[176:179], v[16:31]
    buffer_load_dwordx4 v238, s[4:7], s36 offen lds
    buffer_load_dwordx4 v239, s[8:11], s36 offen offset:1024 lds
    ds_read_b64_tr_b16 v[176:177], v244 offset:2048
    ds_read_b64_tr_b16 v[178:179], v244 offset:3072
    ds_read_b64_tr_b16 v[188:189], v245 offset:2048
    ds_read_b64_tr_b16 v[190:191], v245 offset:3072
    v_fmac_f32 v201, v52, v140
    v_fmac_f32 v201, v53, v141
    v_fmac_f32 v201, v54, v142
    v_fmac_f32 v201, v55, v143
    v_add_f32 v199, v197, v199
    v_mul_f32_e64 v203, v56, -v136
    v_fma_f32 v203, v57, -v137, v203
    s_waitcnt lgkmcnt(0)
    v_mfma_f32_32x32x16_bf16 v[0:15], v[80:83], v[176:179], v[0:15]
    v_fma_f32 v203, v58, -v138, v203
    v_fma_f32 v203, v59, -v139, v203
    v_fma_f32 v203, v60, -v140, v203
    v_fma_f32 v203, v61, -v141, v203
    v_fma_f32 v203, v62, -v142, v203
    v_fma_f32 v203, v63, -v143, v203
    s_nop 1
    s_add_u32 m0, s21, 2048
    v_mfma_f32_32x32x16_bf16 v[16:31], v[84:87], v[176:179], v[16:31]
    buffer_load_dwordx4 v234, s[4:7], s37 offen lds
    buffer_load_dwordx4 v235, s[8:11], s37 offen offset:1024 lds
    v_add_u32 v252, s42, v247
    ds_read_u16 v234, v252
    ds_read_u16 v235, v252 offset:64
    v_permlane32_swap_b32 v201, v203
    v_add_f32 v203, v201, v203
    s_set_gpr_idx_on s51, gpr_idx(DST)
    s_nop 0
    v_cvt_pk_bf16_f32 v204, v198, v199
    v_cvt_pk_bf16_f32 v205, v202, v203
    s_set_gpr_idx_off
    v_mfma_f32_32x32x16_bf16 v[32:47], v[64:67], v[180:183], 0
    v_mul_f32 v196, v0, v144
    v_fmac_f32 v196, v1, v145
    v_fmac_f32 v196, v2, v146
    v_fmac_f32 v196, v3, v147
    v_fmac_f32 v196, v4, v148
    v_fmac_f32 v196, v5, v149
    v_mfma_f32_32x32x16_bf16 v[48:63], v[68:71], v[180:183], 0
    v_fmac_f32 v196, v6, v150
    v_fmac_f32 v196, v7, v151
    v_mul_f32 v198, v8, v112
    v_fmac_f32 v198, v9, v113
    v_fmac_f32 v198, v10, v114
    v_mfma_f32_32x32x16_bf16 v[32:47], v[72:75], v[184:187], v[32:47]
    v_fmac_f32 v198, v11, v115
    v_fmac_f32 v198, v12, v116
    v_fmac_f32 v198, v13, v117
    v_fmac_f32 v198, v14, v118
    v_fmac_f32 v198, v15, v119
    v_mfma_f32_32x32x16_bf16 v[48:63], v[76:79], v[184:187], v[48:63]
    s_waitcnt vmcnt(8)
    ds_read_b64_tr_b16 v[176:177], v244 offset:4096
    ds_read_b64_tr_b16 v[178:179], v244 offset:5120
    ds_read_b64_tr_b16 v[180:181], v245 offset:4096
    ds_read_b64_tr_b16 v[182:183], v245 offset:5120
    v_mul_f32_e64 v200, v16, -v160
    v_fma_f32 v200, v17, -v161, v200
    v_fma_f32 v200, v18, -v162, v200
    v_fma_f32 v200, v19, -v163, v200
    v_fma_f32 v200, v20, -v164, v200
    v_fma_f32 v200, v21, -v165, v200
    v_mfma_f32_32x32x16_bf16 v[32:47], v[80:83], v[188:191], v[32:47]
    v_fma_f32 v200, v22, -v166, v200
    v_fma_f32 v200, v23, -v167, v200
    v_mul_f32_e64 v202, v24, -v160
    v_fma_f32 v202, v25, -v161, v202
    v_fma_f32 v202, v26, -v162, v202
    v_mfma_f32_32x32x16_bf16 v[48:63], v[84:87], v[188:191], v[48:63]
    v_fma_f32 v202, v27, -v163, v202
    v_fma_f32 v202, v28, -v164, v202
    v_fma_f32 v202, v29, -v165, v202
    v_fma_f32 v202, v30, -v166, v202
    v_fma_f32 v202, v31, -v167, v202
    s_waitcnt vmcnt(6) lgkmcnt(0)
    v_mfma_f32_32x32x16_bf16 v[0:15], v[64:67], v[176:179], 0
    v_mul_f32 v197, v32, v152
    v_fmac_f32 v197, v33, v153
    v_fmac_f32 v197, v34, v154
    v_fmac_f32 v197, v35, v155
    v_fmac_f32 v197, v36, v156
    v_fmac_f32 v197, v37, v157
    s_add_u32 m0, s21, 4096
    v_mfma_f32_32x32x16_bf16 v[16:31], v[68:71], v[176:179], 0
    buffer_load_dwordx4 v236, s[4:7], s37 offen lds
    buffer_load_dwordx4 v237, s[8:11], s37 offen offset:1024 lds
    ds_read_b64_tr_b16 v[176:177], v244 offset:6144
    ds_read_b64_tr_b16 v[178:179], v244 offset:7168
    ds_read_b64_tr_b16 v[184:185], v245 offset:6144
    ds_read_b64_tr_b16 v[186:187], v245 offset:7168
    v_add_u32 v252, s43, v247
    ds_read_u16 v236, v252
    ds_read_u16 v237, v252 offset:64
    v_fmac_f32 v197, v38, v158
    v_fmac_f32 v197, v39, v159
    v_mul_f32 v199, v40, v120
    v_fmac_f32 v199, v41, v121
    v_fmac_f32 v199, v42, v122
    s_waitcnt vmcnt(4) lgkmcnt(2)
    v_mfma_f32_32x32x16_bf16 v[0:15], v[72:75], v[176:179], v[0:15]
    v_fmac_f32 v199, v43, v123
    v_fmac_f32 v199, v44, v124
    v_fmac_f32 v199, v45, v125
    v_fmac_f32 v199, v46, v126
    v_fmac_f32 v199, v47, v127
    s_add_u32 m0, s21, 6144
    v_mfma_f32_32x32x16_bf16 v[16:31], v[76:79], v[176:179], v[16:31]
    buffer_load_dwordx4 v238, s[4:7], s37 offen lds
    buffer_load_dwordx4 v239, s[8:11], s37 offen offset:1024 lds
    ds_read_b64_tr_b16 v[176:177], v244 offset:0
    ds_read_b64_tr_b16 v[178:179], v244 offset:1024
    ds_read_b64_tr_b16 v[188:189], v245 offset:0
    ds_read_b64_tr_b16 v[190:191], v245 offset:1024
    v_add_u32 v252, s44, v247
    ds_read_u16 v238, v252
    ds_read_u16 v239, v252 offset:64
    v_mul_f32_e64 v201, v48, -v168
    v_fma_f32 v201, v49, -v169, v201
    v_fma_f32 v201, v50, -v170, v201
    v_fma_f32 v201, v51, -v171, v201
    v_fma_f32 v201, v52, -v172, v201
    v_fma_f32 v201, v53, -v173, v201
    s_waitcnt lgkmcnt(2)
    v_mfma_f32_32x32x16_bf16 v[0:15], v[80:83], v[176:179], v[0:15]
    v_fma_f32 v201, v54, -v174, v201
    v_fma_f32 v201, v55, -v175, v201
    v_mul_f32_e64 v203, v56, -v168
    v_fma_f32 v203, v57, -v169, v203
    v_fma_f32 v203, v58, -v170, v203
    s_add_u32 m0, s21, 0
    v_mfma_f32_32x32x16_bf16 v[16:31], v[84:87], v[176:179], v[16:31]
    v_lshl_add_u32 v234, v234, 10, v246
    v_lshl_add_u32 v235, v235, 10, v246
    buffer_load_dwordx4 v234, s[4:7], s38 offen lds
    buffer_load_dwordx4 v235, s[8:11], s38 offen offset:1024 lds
    v_fma_f32 v203, v59, -v171, v203
    v_fma_f32 v203, v60, -v172, v203
    v_fma_f32 v203, v61, -v173, v203
    v_fma_f32 v203, v62, -v174, v203
    v_fma_f32 v203, v63, -v175, v203
    v_mfma_f32_32x32x16_bf16 v[32:47], v[64:67], v[180:183], 0
    v_mul_f32 v254, v0, v144
    v_fmac_f32 v254, v1, v145
    v_fmac_f32 v254, v2, v146
    v_mfma_f32_32x32x16_bf16 v[48:63], v[68:71], v[180:183], 0
    ds_swizzle_b32 v68, v68 offset:0x401F
    ds_swizzle_b32 v69, v69 offset:0x401F
    ds_swizzle_b32 v70, v70 offset:0x401F
    ds_swizzle_b32 v71, v71 offset:0x401F
    v_fmac_f32 v254, v3, v147
    v_fmac_f32 v254, v4, v148
    v_fmac_f32 v254, v5, v149
    v_mfma_f32_32x32x16_bf16 v[32:47], v[72:75], v[184:187], v[32:47]
    v_fmac_f32 v254, v6, v150
    v_fmac_f32 v254, v7, v151
    v_fmac_f32 v200, v8, v160
    v_mfma_f32_32x32x16_bf16 v[48:63], v[76:79], v[184:187], v[48:63]
    ds_swizzle_b32 v76, v76 offset:0x401F
    ds_swizzle_b32 v77, v77 offset:0x401F
    ds_swizzle_b32 v78, v78 offset:0x401F
    ds_swizzle_b32 v79, v79 offset:0x401F
    s_waitcnt vmcnt(6)
    ds_read_b64_tr_b16 v[176:177], v244 offset:2048
    ds_read_b64_tr_b16 v[178:179], v244 offset:3072
    ds_read_b64_tr_b16 v[180:181], v245 offset:2048
    ds_read_b64_tr_b16 v[182:183], v245 offset:3072
    v_fmac_f32 v200, v9, v161
    v_permlane32_swap_b32 v196, v254
    v_fmac_f32 v200, v10, v162
    v_mfma_f32_32x32x16_bf16 v[32:47], v[80:83], v[188:191], v[32:47]
    v_fmac_f32 v200, v11, v163
    v_fmac_f32 v200, v12, v164
    v_fmac_f32 v200, v13, v165
    v_mfma_f32_32x32x16_bf16 v[48:63], v[84:87], v[188:191], v[48:63]
    ds_swizzle_b32 v84, v84 offset:0x401F
    ds_swizzle_b32 v85, v85 offset:0x401F
    ds_swizzle_b32 v86, v86 offset:0x401F
    ds_swizzle_b32 v87, v87 offset:0x401F
    v_fmac_f32 v200, v14, v166
    v_fmac_f32 v200, v15, v167
    v_add_f32 v254, v196, v254
    s_waitcnt lgkmcnt(8)
    s_mov_b64 exec, s[56:57]
    v_xor_b32 v68, 0x80008000, v68
    v_xor_b32 v69, 0x80008000, v69
    v_xor_b32 v70, 0x80008000, v70
    v_xor_b32 v71, 0x80008000, v71
    v_xor_b32 v76, 0x80008000, v76
    v_xor_b32 v77, 0x80008000, v77
    v_xor_b32 v78, 0x80008000, v78
    v_xor_b32 v79, 0x80008000, v79
    s_mov_b64 exec, -1
    s_waitcnt vmcnt(4) lgkmcnt(4)
    v_mfma_f32_32x32x16_bf16 v[0:15], v[64:67], v[176:179], 0
    v_mul_f32 v255, v32, v152
    v_fmac_f32 v255, v33, v153
    v_fmac_f32 v255, v34, v154
    v_fmac_f32 v255, v35, v155
    s_add_u32 m0, s21, 2048
    v_mfma_f32_32x32x16_bf16 v[16:31], v[68:71], v[176:179], v[16:31]
    v_lshl_add_u32 v236, v236, 10, v246
    v_lshl_add_u32 v237, v237, 10, v246
    buffer_load_dwordx4 v236, s[4:7], s39 offen lds
    buffer_load_dwordx4 v237, s[8:11], s39 offen offset:1024 lds
    ds_read_b64_tr_b16 v[176:177], v244 offset:4096
    ds_read_b64_tr_b16 v[178:179], v244 offset:5120
    ds_read_b64_tr_b16 v[184:185], v245 offset:4096
    ds_read_b64_tr_b16 v[186:187], v245 offset:5120
    v_fmac_f32 v255, v36, v156
    v_fmac_f32 v255, v37, v157
    v_fmac_f32 v255, v38, v158
    v_fmac_f32 v255, v39, v159
    s_waitcnt vmcnt(4) lgkmcnt(0)
    v_mfma_f32_32x32x16_bf16 v[0:15], v[72:75], v[176:179], v[0:15]
    v_fmac_f32 v201, v40, v168
    v_fmac_f32 v201, v41, v169
    v_permlane32_swap_b32 v197, v255
    s_add_u32 m0, s21, 4096
    v_mfma_f32_32x32x16_bf16 v[16:31], v[76:79], v[176:179], v[16:31]
    v_lshl_add_u32 v238, v238, 10, v246
    v_lshl_add_u32 v239, v239, 10, v246
    buffer_load_dwordx4 v238, s[4:7], s40 offen lds
    buffer_load_dwordx4 v239, s[8:11], s40 offen offset:1024 lds
    ds_read_b64_tr_b16 v[176:177], v244 offset:6144
    ds_read_b64_tr_b16 v[178:179], v244 offset:7168
    ds_read_b64_tr_b16 v[188:189], v245 offset:6144
    ds_read_b64_tr_b16 v[190:191], v245 offset:7168
    v_fmac_f32 v201, v42, v170
    v_fmac_f32 v201, v43, v171
    v_fmac_f32 v201, v44, v172
    v_fmac_f32 v201, v45, v173
    s_waitcnt lgkmcnt(0)
    s_mov_b64 exec, s[56:57]
    v_xor_b32 v84, 0x80008000, v84
    v_xor_b32 v85, 0x80008000, v85
    v_xor_b32 v86, 0x80008000, v86
    v_xor_b32 v87, 0x80008000, v87
    s_mov_b64 exec, -1
    v_mfma_f32_32x32x16_bf16 v[0:15], v[80:83], v[176:179], v[0:15]
    v_fmac_f32 v201, v46, v174
    v_fmac_f32 v201, v47, v175
    v_add_f32 v255, v197, v255
    s_set_gpr_idx_on s51, gpr_idx(DST)
    s_nop 0
    v_cvt_pk_bf16_f32 v206, v254, v255
    s_set_gpr_idx_off
    s_add_u32 m0, s21, 6144
    v_mfma_f32_32x32x16_bf16 v[16:31], v[84:87], v[176:179], v[16:31]
    v_lshl_add_u32 v240, v240, 10, v246
    v_lshl_add_u32 v241, v241, 10, v246
    buffer_load_dwordx4 v240, s[4:7], s41 offen lds
    buffer_load_dwordx4 v241, s[8:11], s41 offen offset:1024 lds
    v_mfma_f32_32x32x16_bf16 v[32:47], v[64:67], v[180:183], 0
    v_mul_f32 v254, v0, v144
    v_fmac_f32 v254, v1, v145
    v_fmac_f32 v254, v2, v146
    v_fmac_f32 v254, v3, v147
    v_fmac_f32 v254, v4, v148
    v_fmac_f32 v254, v5, v149
    v_fmac_f32 v254, v6, v150
    v_mfma_f32_32x32x16_bf16 v[48:63], v[68:71], v[180:183], v[48:63]
    v_fmac_f32 v254, v7, v151
    v_fma_f32 v202, v8, -v160, v202
    v_fma_f32 v202, v9, -v161, v202
    v_permlane32_swap_b32 v254, v200
    v_fma_f32 v202, v10, -v162, v202
    v_fma_f32 v202, v11, -v163, v202
    v_mfma_f32_32x32x16_bf16 v[32:47], v[72:75], v[184:187], v[32:47]
    v_fma_f32 v202, v12, -v164, v202
    v_fma_f32 v202, v13, -v165, v202
    v_fma_f32 v202, v14, -v166, v202
    v_fma_f32 v202, v15, -v167, v202
    v_add_f32 v200, v254, v200
    v_fmac_f32 v198, v16, v112
    v_permlane32_swap_b32 v202, v254
    v_mfma_f32_32x32x16_bf16 v[48:63], v[76:79], v[184:187], v[48:63]
    s_waitcnt vmcnt(6)
    ds_read_b64_tr_b16 v[176:177], v244 offset:0
    ds_read_b64_tr_b16 v[178:179], v244 offset:1024
    ds_read_b64_tr_b16 v[180:181], v245 offset:0
    ds_read_b64_tr_b16 v[182:183], v245 offset:1024
    v_fmac_f32 v198, v17, v113
    v_fmac_f32 v198, v18, v114
    v_fmac_f32 v198, v19, v115
    v_fmac_f32 v198, v20, v116
    v_fmac_f32 v198, v21, v117
    v_fmac_f32 v198, v22, v118
    v_mfma_f32_32x32x16_bf16 v[32:47], v[80:83], v[188:191], v[32:47]
    v_fmac_f32 v198, v23, v119
    v_add_f32 v254, v202, v254
    v_mul_f32 v196, v24, v160
    v_fmac_f32 v196, v25, v161
    v_fmac_f32 v196, v26, v162
    v_fmac_f32 v196, v27, v163
    v_fmac_f32 v196, v28, v164
    v_mfma_f32_32x32x16_bf16 v[48:63], v[84:87], v[188:191], v[48:63]
    v_add_u32 v249, s48, v249
    v_add_u32 v250, s49, v250
    ds_read_b32 v252, v251 offset:16
    ds_read_b64_tr_b16 v[64:65], v249 offset:0
    ds_read_b64_tr_b16 v[68:69], v249 offset:64
    ds_read_b64_tr_b16 v[66:67], v249 offset:256
    ds_read_b64_tr_b16 v[70:71], v249 offset:320
    s_mov_b64 exec, s[54:55]
    ds_read_u16_d16_hi v242, v250 offset:0
    s_mov_b64 exec, -1
    v_fmac_f32 v196, v29, v165
    v_fmac_f32 v196, v30, v166
    v_fmac_f32 v196, v31, v167
    s_nop 1
    v_permlane32_swap_b32 v198, v196
    v_add_f32 v196, v198, v196
    v_mul_f32 v255, v32, v152
    v_fmac_f32 v255, v33, v153
    v_fmac_f32 v255, v34, v154
    v_fmac_f32 v255, v35, v155
    v_fmac_f32 v255, v36, v156
    v_fmac_f32 v255, v37, v157
    v_fmac_f32 v255, v38, v158
    v_fmac_f32 v255, v39, v159
    v_fma_f32 v203, v40, -v168, v203
    v_fma_f32 v203, v41, -v169, v203
    v_permlane32_swap_b32 v255, v201
    v_fma_f32 v203, v42, -v170, v203
    v_fma_f32 v203, v43, -v171, v203
    v_fma_f32 v203, v44, -v172, v203
    v_fma_f32 v203, v45, -v173, v203
    v_fma_f32 v203, v46, -v174, v203
    v_fma_f32 v203, v47, -v175, v203
    v_add_f32 v201, v255, v201
    v_fmac_f32 v199, v48, v120
    v_permlane32_swap_b32 v203, v255
    v_fmac_f32 v199, v49, v121
    v_fmac_f32 v199, v50, v122
    v_fmac_f32 v199, v51, v123
    v_fmac_f32 v199, v52, v124
    v_fmac_f32 v199, v53, v125
    v_fmac_f32 v199, v54, v126
    v_fmac_f32 v199, v55, v127
    v_add_f32 v255, v203, v255
    v_mul_f32 v197, v56, v168
    v_fmac_f32 v197, v57, v169
    v_fmac_f32 v197, v58, v170
    v_fmac_f32 v197, v59, v171
    v_fmac_f32 v197, v60, v172
    v_fmac_f32 v197, v61, v173
    v_fmac_f32 v197, v62, v174
    v_fmac_f32 v197, v63, v175
    s_nop 1
    v_permlane32_swap_b32 v199, v197
    v_add_f32 v197, v199, v197
    s_set_gpr_idx_on s51, gpr_idx(DST)
    s_nop 0
    v_cvt_pk_bf16_f32 v207, v200, v201
    v_cvt_pk_bf16_f32 v209, v254, v255
    v_cvt_pk_bf16_f32 v208, v196, v197
    s_set_gpr_idx_off
    s_add_u32 s50, s50, 1
    s_add_u32 s51, s51, 6
    s_cmp_ge_u32 s50, 4
    s_cbranch_scc1 LAST0
    s_waitcnt lgkmcnt(5)
    v_readfirstlane_b32 s66, v252
    s_add_u32 s53, s53, 1
    v_mov_b32 v252, s53
    s_cmp_le_u32 s53, s66
    ds_write2_b32 v251, v252, v252 offset0:0 offset1:8
    s_setprio 1
    s_cbranch_scc1 PRIO_8
    s_setprio 0
PRIO_8:
    s_cmp_eq_u32 s52, 4
    s_cbranch_scc1 ITEM_0_4
    s_cmp_eq_u32 s52, 5
    s_cbranch_scc1 ITEM_0_5
    s_cmp_eq_u32 s52, 3
    s_cbranch_scc1 ITEM_0_3
    s_cmp_eq_u32 s52, 6
    s_cbranch_scc1 ITEM_0_6
    s_cmp_eq_u32 s52, 8
    s_cbranch_scc1 ITEM_0_8
    s_branch ITEM_0_2
.p2align 6
ITEM_0_8:
    s_mov_b64 exec, s[54:55]
    ds_read_u16_d16_hi v243, v250 offset:128
    s_mov_b64 exec, -1
    ds_read_b64_tr_b16 v[72:73], v249 offset:512
    ds_read_b64_tr_b16 v[76:77], v249 offset:576
    ds_read_b64_tr_b16 v[74:75], v249 offset:768
    ds_read_b64_tr_b16 v[78:79], v249 offset:832
    ds_read_b64_tr_b16 v[80:81], v249 offset:1024
    ds_read_b64_tr_b16 v[84:85], v249 offset:1088
    ds_read_b64_tr_b16 v[82:83], v249 offset:1280
    ds_read_b64_tr_b16 v[86:87], v249 offset:1344
    ds_read_b64_tr_b16 v[88:89], v249 offset:1536
    ds_read_b64_tr_b16 v[92:93], v249 offset:1600
    ds_read_b64_tr_b16 v[90:91], v249 offset:1792
    ds_read_b64_tr_b16 v[94:95], v249 offset:1856
    s_waitcnt lgkmcnt(13)
    v_mul_f32_dpp v196, v242, v64 row_newbcast:0 row_mask:0xf bank_mask:0xf
    v_mul_f32_dpp v197, v242, v65 row_newbcast:1 row_mask:0xf bank_mask:0xf
    v_mul_f32_dpp v198, v242, v64 row_newbcast:8 row_mask:0xf bank_mask:0xf
    v_mul_f32_dpp v199, v242, v65 row_newbcast:9 row_mask:0xf bank_mask:0xf
    v_mul_f32_dpp v200, v242, v68 row_newbcast:2 row_mask:0xf bank_mask:0xf
    v_mul_f32_dpp v201, v242, v69 row_newbcast:3 row_mask:0xf bank_mask:0xf
    v_mul_f32_dpp v202, v242, v68 row_newbcast:10 row_mask:0xf bank_mask:0xf
    v_mul_f32_dpp v203, v242, v69 row_newbcast:11 row_mask:0xf bank_mask:0xf
    v_cvt_pk_bf16_f32 v64, v196, v197
    v_cvt_pk_bf16_f32 v68, v198, v199
    v_cvt_pk_bf16_f32 v65, v200, v201
    v_cvt_pk_bf16_f32 v69, v202, v203
    v_mul_f32_dpp v196, v242, v66 row_newbcast:4 row_mask:0xf bank_mask:0xf
    v_mul_f32_dpp v197, v242, v67 row_newbcast:5 row_mask:0xf bank_mask:0xf
    v_mul_f32_dpp v198, v242, v66 row_newbcast:12 row_mask:0xf bank_mask:0xf
    v_mul_f32_dpp v199, v242, v67 row_newbcast:13 row_mask:0xf bank_mask:0xf
    v_mul_f32_dpp v200, v242, v70 row_newbcast:6 row_mask:0xf bank_mask:0xf
    v_mul_f32_dpp v201, v242, v71 row_newbcast:7 row_mask:0xf bank_mask:0xf
    v_mul_f32_dpp v202, v242, v70 row_newbcast:14 row_mask:0xf bank_mask:0xf
    v_mul_f32_dpp v203, v242, v71 row_newbcast:15 row_mask:0xf bank_mask:0xf
    v_cvt_pk_bf16_f32 v66, v196, v197
    v_cvt_pk_bf16_f32 v70, v198, v199
    v_cvt_pk_bf16_f32 v67, v200, v201
    v_cvt_pk_bf16_f32 v71, v202, v203
    s_mov_b64 exec, s[54:55]
    ds_read_u16_d16_hi v242, v250 offset:256
    s_mov_b64 exec, -1
    s_waitcnt vmcnt(4) lgkmcnt(9)
    v_mfma_f32_32x32x16_bf16 v[0:15], v[64:67], v[176:179], 0
    v_mul_f32_dpp v196, v243, v72 row_newbcast:0 row_mask:0xf bank_mask:0xf
    v_mul_f32_dpp v197, v243, v73 row_newbcast:1 row_mask:0xf bank_mask:0xf
    v_mul_f32_dpp v198, v243, v72 row_newbcast:8 row_mask:0xf bank_mask:0xf
    v_mul_f32_dpp v199, v243, v73 row_newbcast:9 row_mask:0xf bank_mask:0xf
    v_mul_f32_dpp v200, v243, v76 row_newbcast:2 row_mask:0xf bank_mask:0xf
    v_mul_f32_dpp v201, v243, v77 row_newbcast:3 row_mask:0xf bank_mask:0xf
    v_mul_f32_dpp v202, v243, v76 row_newbcast:10 row_mask:0xf bank_mask:0xf
    v_mul_f32_dpp v203, v243, v77 row_newbcast:11 row_mask:0xf bank_mask:0xf
    v_cvt_pk_bf16_f32 v72, v196, v197
    v_cvt_pk_bf16_f32 v76, v198, v199
    v_cvt_pk_bf16_f32 v73, v200, v201
    v_cvt_pk_bf16_f32 v77, v202, v203
    s_add_u32 m0, s21, 0
    v_mfma_f32_32x32x16_bf16 v[16:31], v[68:71], v[176:179], 0
    buffer_load_dwordx4 v234, s[4:7], s35 offen lds
    buffer_load_dwordx4 v235, s[8:11], s35 offen offset:1024 lds
    ds_read_b64_tr_b16 v[176:177], v244 offset:2048
    ds_read_b64_tr_b16 v[178:179], v244 offset:3072
    ds_read_b64_tr_b16 v[184:185], v245 offset:2048
    ds_read_b64_tr_b16 v[186:187], v245 offset:3072
    v_mul_f32_dpp v196, v243, v74 row_newbcast:4 row_mask:0xf bank_mask:0xf
    v_mul_f32_dpp v197, v243, v75 row_newbcast:5 row_mask:0xf bank_mask:0xf
    v_mul_f32_dpp v198, v243, v74 row_newbcast:12 row_mask:0xf bank_mask:0xf
    v_mul_f32_dpp v199, v243, v75 row_newbcast:13 row_mask:0xf bank_mask:0xf
    v_mul_f32_dpp v200, v243, v78 row_newbcast:6 row_mask:0xf bank_mask:0xf
    v_mul_f32_dpp v201, v243, v79 row_newbcast:7 row_mask:0xf bank_mask:0xf
    v_mul_f32_dpp v202, v243, v78 row_newbcast:14 row_mask:0xf bank_mask:0xf
    v_mul_f32_dpp v203, v243, v79 row_newbcast:15 row_mask:0xf bank_mask:0xf
    v_cvt_pk_bf16_f32 v74, v196, v197
    v_cvt_pk_bf16_f32 v78, v198, v199
    v_cvt_pk_bf16_f32 v75, v200, v201
    v_cvt_pk_bf16_f32 v79, v202, v203
    s_mov_b64 exec, s[54:55]
    ds_read_u16_d16_hi v243, v250 offset:384
    s_mov_b64 exec, -1
    s_waitcnt vmcnt(4) lgkmcnt(1)
    v_mfma_f32_32x32x16_bf16 v[0:15], v[72:75], v[176:179], v[0:15]
    v_mul_f32_dpp v196, v242, v80 row_newbcast:0 row_mask:0xf bank_mask:0xf
    v_mul_f32_dpp v197, v242, v81 row_newbcast:1 row_mask:0xf bank_mask:0xf
    v_mul_f32_dpp v198, v242, v80 row_newbcast:8 row_mask:0xf bank_mask:0xf
    v_mul_f32_dpp v199, v242, v81 row_newbcast:9 row_mask:0xf bank_mask:0xf
    v_mul_f32_dpp v200, v242, v84 row_newbcast:2 row_mask:0xf bank_mask:0xf
    v_mul_f32_dpp v201, v242, v85 row_newbcast:3 row_mask:0xf bank_mask:0xf
    v_mul_f32_dpp v202, v242, v84 row_newbcast:10 row_mask:0xf bank_mask:0xf
    v_mul_f32_dpp v203, v242, v85 row_newbcast:11 row_mask:0xf bank_mask:0xf
    v_cvt_pk_bf16_f32 v80, v196, v197
    v_cvt_pk_bf16_f32 v84, v198, v199
    v_cvt_pk_bf16_f32 v81, v200, v201
    v_cvt_pk_bf16_f32 v85, v202, v203
    s_add_u32 m0, s21, 2048
    v_mfma_f32_32x32x16_bf16 v[16:31], v[76:79], v[176:179], v[16:31]
    buffer_load_dwordx4 v236, s[4:7], s35 offen lds
    buffer_load_dwordx4 v237, s[8:11], s35 offen offset:1024 lds
    ds_read_b64_tr_b16 v[176:177], v244 offset:4096
    ds_read_b64_tr_b16 v[178:179], v244 offset:5120
    ds_read_b64_tr_b16 v[188:189], v245 offset:4096
    ds_read_b64_tr_b16 v[190:191], v245 offset:5120
    v_mul_f32_dpp v196, v242, v82 row_newbcast:4 row_mask:0xf bank_mask:0xf
    v_mul_f32_dpp v197, v242, v83 row_newbcast:5 row_mask:0xf bank_mask:0xf
    v_mul_f32_dpp v198, v242, v82 row_newbcast:12 row_mask:0xf bank_mask:0xf
    v_mul_f32_dpp v199, v242, v83 row_newbcast:13 row_mask:0xf bank_mask:0xf
    v_mul_f32_dpp v200, v242, v86 row_newbcast:6 row_mask:0xf bank_mask:0xf
    v_mul_f32_dpp v201, v242, v87 row_newbcast:7 row_mask:0xf bank_mask:0xf
    v_mul_f32_dpp v202, v242, v86 row_newbcast:14 row_mask:0xf bank_mask:0xf
    v_mul_f32_dpp v203, v242, v87 row_newbcast:15 row_mask:0xf bank_mask:0xf
    v_cvt_pk_bf16_f32 v82, v196, v197
    v_cvt_pk_bf16_f32 v86, v198, v199
    v_cvt_pk_bf16_f32 v83, v200, v201
    v_cvt_pk_bf16_f32 v87, v202, v203
    s_nop 0
    s_waitcnt vmcnt(4) lgkmcnt(0)
    v_mfma_f32_32x32x16_bf16 v[0:15], v[80:83], v[176:179], v[0:15]
    v_mul_f32_dpp v196, v243, v88 row_newbcast:0 row_mask:0xf bank_mask:0xf
    v_mul_f32_dpp v197, v243, v89 row_newbcast:1 row_mask:0xf bank_mask:0xf
    v_mul_f32_dpp v198, v243, v88 row_newbcast:8 row_mask:0xf bank_mask:0xf
    v_mul_f32_dpp v199, v243, v89 row_newbcast:9 row_mask:0xf bank_mask:0xf
    v_mul_f32_dpp v200, v243, v92 row_newbcast:2 row_mask:0xf bank_mask:0xf
    v_mul_f32_dpp v201, v243, v93 row_newbcast:3 row_mask:0xf bank_mask:0xf
    v_mul_f32_dpp v202, v243, v92 row_newbcast:10 row_mask:0xf bank_mask:0xf
    v_mul_f32_dpp v203, v243, v93 row_newbcast:11 row_mask:0xf bank_mask:0xf
    v_cvt_pk_bf16_f32 v88, v196, v197
    v_cvt_pk_bf16_f32 v92, v198, v199
    v_cvt_pk_bf16_f32 v89, v200, v201
    v_cvt_pk_bf16_f32 v93, v202, v203
    s_add_u32 m0, s21, 4096
    v_mfma_f32_32x32x16_bf16 v[16:31], v[84:87], v[176:179], v[16:31]
    buffer_load_dwordx4 v238, s[4:7], s35 offen lds
    buffer_load_dwordx4 v239, s[8:11], s35 offen offset:1024 lds
    ds_read_b64_tr_b16 v[176:177], v244 offset:6144
    ds_read_b64_tr_b16 v[178:179], v244 offset:7168
    ds_read_b64_tr_b16 v[192:193], v245 offset:6144
    ds_read_b64_tr_b16 v[194:195], v245 offset:7168
    v_mul_f32_dpp v196, v243, v90 row_newbcast:4 row_mask:0xf bank_mask:0xf
    v_mul_f32_dpp v197, v243, v91 row_newbcast:5 row_mask:0xf bank_mask:0xf
    v_mul_f32_dpp v198, v243, v90 row_newbcast:12 row_mask:0xf bank_mask:0xf
    v_mul_f32_dpp v199, v243, v91 row_newbcast:13 row_mask:0xf bank_mask:0xf
    v_mul_f32_dpp v200, v243, v94 row_newbcast:6 row_mask:0xf bank_mask:0xf
    v_mul_f32_dpp v201, v243, v95 row_newbcast:7 row_mask:0xf bank_mask:0xf
    v_mul_f32_dpp v202, v243, v94 row_newbcast:14 row_mask:0xf bank_mask:0xf
    v_mul_f32_dpp v203, v243, v95 row_newbcast:15 row_mask:0xf bank_mask:0xf
    v_cvt_pk_bf16_f32 v90, v196, v197
    v_cvt_pk_bf16_f32 v94, v198, v199
    v_cvt_pk_bf16_f32 v91, v200, v201
    v_cvt_pk_bf16_f32 v95, v202, v203
    s_nop 0
    s_waitcnt lgkmcnt(0)
    v_mfma_f32_32x32x16_bf16 v[0:15], v[88:91], v[176:179], v[0:15]
    s_add_u32 m0, s21, 6144
    v_mfma_f32_32x32x16_bf16 v[16:31], v[92:95], v[176:179], v[16:31]
    buffer_load_dwordx4 v240, s[4:7], s35 offen lds
    buffer_load_dwordx4 v241, s[8:11], s35 offen offset:1024 lds
    s_mov_b32 m0, s50
    s_nop 0
    s_movrels_b32 s71, s23
    s_bfe_u32 s46, s71, 0x30012
    s_mov_b32 m0, s46
    s_and_b32 s66, s71, 0x3ffff
    s_movrels_b32 s68, s57
    s_movrels_b32 s69, s61
    s_sub_u32 s48, s66, s47
    s_mov_b32 s47, s66
    s_lshr_b32 s52, s71, 28
    s_lshl_b32 s67, s46, 9
    s_add_u32 s66, s66, s67
    s_sub_u32 s49, s66, s42
    s_mov_b32 s42, s66
    s_bfe_u32 s66, s68, 655360
    s_add_u32 s43, s42, s66
    s_bfe_u32 s39, s69, 655360
    s_bfe_u32 s66, s68, 655370
    s_add_u32 s44, s42, s66
    s_bfe_u32 s40, s69, 655370
    s_bfe_u32 s66, s68, 655380
    s_add_u32 s45, s42, s66
    s_bfe_u32 s41, s69, 655380
    s_and_b32 s66, s46, s33
    s_cselect_b32 s72, -1, 1
    s_cselect_b32 s76, s47, 163712
    s_cmp_ge_u32 s66, 2
    s_cselect_b32 s73, -1, 0
    s_add_u32 s77, s47, 1024
    s_cmp_ge_u32 s66, 4
    s_cselect_b32 s75, -1, 0
    s_cmp_ge_u32 s66, 3
    s_cselect_b32 s74, -1, 1
    s_cselect_b32 s77, s77, 163712
    v_mfma_f32_32x32x16_bf16 v[32:47], v[64:67], v[180:183], 0
    v_mul_f32 v196, v0, v96
    v_fmac_f32 v196, v1, v97
    v_fmac_f32 v196, v2, v98
    v_fmac_f32 v196, v3, v99
    v_fmac_f32 v196, v4, v100
    v_mfma_f32_32x32x16_bf16 v[48:63], v[68:71], v[180:183], 0
    v_add_u32 v253, s47, v248
    ds_read_b32 v254, v253
    ds_read_b32 v255, v253 offset:256
    v_fmac_f32 v196, v5, v101
    v_fmac_f32 v196, v6, v102
    v_fmac_f32 v196, v7, v103
    v_mul_f32 v198, v8, v128
    v_fmac_f32 v198, v9, v129
    v_mfma_f32_32x32x16_bf16 v[32:47], v[72:75], v[184:187], v[32:47]
    v_fmac_f32 v198, v10, v130
    v_fmac_f32 v198, v11, v131
    v_fmac_f32 v198, v12, v132
    v_fmac_f32 v198, v13, v133
    v_mfma_f32_32x32x16_bf16 v[48:63], v[76:79], v[184:187], v[48:63]
    v_fmac_f32 v198, v14, v134
    v_fmac_f32 v198, v15, v135
    v_mul_f32 v200, v16, v128
    v_fmac_f32 v200, v17, v129
    v_permlane32_swap_b32 v196, v198
    v_mfma_f32_32x32x16_bf16 v[32:47], v[80:83], v[188:191], v[32:47]
    v_fmac_f32 v200, v18, v130
    v_fmac_f32 v200, v19, v131
    v_fmac_f32 v200, v20, v132
    v_fmac_f32 v200, v21, v133
    v_fmac_f32 v200, v22, v134
    v_mfma_f32_32x32x16_bf16 v[48:63], v[84:87], v[188:191], v[48:63]
    s_waitcnt vmcnt(6)
    ds_read_b64_tr_b16 v[176:177], v244 offset:0
    ds_read_b64_tr_b16 v[178:179], v244 offset:1024
    ds_read_b64_tr_b16 v[180:181], v245 offset:0
    ds_read_b64_tr_b16 v[182:183], v245 offset:1024
    v_fmac_f32 v200, v23, v135
    v_add_f32 v198, v196, v198
    v_mul_f32_e64 v202, v24, -v128
    v_fma_f32 v202, v25, -v129, v202
    v_mfma_f32_32x32x16_bf16 v[32:47], v[88:91], v[192:195], v[32:47]
    v_fma_f32 v202, v26, -v130, v202
    v_fma_f32 v202, v27, -v131, v202
    v_fma_f32 v202, v28, -v132, v202
    v_fma_f32 v202, v29, -v133, v202
    v_fma_f32 v202, v30, -v134, v202
    v_mfma_f32_32x32x16_bf16 v[48:63], v[92:95], v[192:195], v[48:63]
    v_fma_f32 v202, v31, -v135, v202
    s_nop 1
    v_permlane32_swap_b32 v200, v202
    v_add_f32 v202, v200, v202
    s_waitcnt vmcnt(4) lgkmcnt(0)
    v_mfma_f32_32x32x16_bf16 v[0:15], v[64:67], v[176:179], 0
    v_mul_f32 v197, v32, v104
    v_fmac_f32 v197, v33, v105
    v_fmac_f32 v197, v34, v106
    v_fmac_f32 v197, v35, v107
    v_fmac_f32 v197, v36, v108
    v_fmac_f32 v197, v37, v109
    s_add_u32 m0, s21, 0
    v_mfma_f32_32x32x16_bf16 v[16:31], v[68:71], v[176:179], 0
    buffer_load_dwordx4 v234, s[4:7], s36 offen lds
    buffer_load_dwordx4 v235, s[8:11], s36 offen offset:1024 lds
    ds_read_b64_tr_b16 v[176:177], v244 offset:2048
    ds_read_b64_tr_b16 v[178:179], v244 offset:3072
    ds_read_b64_tr_b16 v[184:185], v245 offset:2048
    ds_read_b64_tr_b16 v[186:187], v245 offset:3072
    s_mov_b32 m0, s76
    s_mov_b64 exec, s[72:73]
    buffer_load_dwordx4 v254, s[12:15], 0 offen  lds
    s_mov_b32 m0, s77
    s_mov_b64 exec, s[74:75]
    buffer_load_dwordx4 v255, s[12:15], 0 offen  lds
    s_mov_b64 exec, -1
    v_fmac_f32 v197, v38, v110
    v_fmac_f32 v197, v39, v111
    v_mul_f32 v199, v40, v136
    v_fmac_f32 v199, v41, v137
    v_fmac_f32 v199, v42, v138
    s_waitcnt vmcnt(6) lgkmcnt(0)
    v_mfma_f32_32x32x16_bf16 v[0:15], v[72:75], v[176:179], v[0:15]
    v_fmac_f32 v199, v43, v139
    v_fmac_f32 v199, v44, v140
    v_fmac_f32 v199, v45, v141
    v_fmac_f32 v199, v46, v142
    v_fmac_f32 v199, v47, v143
    s_add_u32 m0, s21, 2048
    v_mfma_f32_32x32x16_bf16 v[16:31], v[76:79], v[176:179], v[16:31]
    buffer_load_dwordx4 v236, s[4:7], s36 offen lds
    buffer_load_dwordx4 v237, s[8:11], s36 offen offset:1024 lds
    ds_read_b64_tr_b16 v[176:177], v244 offset:4096
    ds_read_b64_tr_b16 v[178:179], v244 offset:5120
    ds_read_b64_tr_b16 v[188:189], v245 offset:4096
    ds_read_b64_tr_b16 v[190:191], v245 offset:5120
    v_mul_f32 v201, v48, v136
    v_fmac_f32 v201, v49, v137
    v_permlane32_swap_b32 v197, v199
    v_fmac_f32 v201, v50, v138
    v_fmac_f32 v201, v51, v139
    s_waitcnt vmcnt(6) lgkmcnt(0)
    v_mfma_f32_32x32x16_bf16 v[0:15], v[80:83], v[176:179], v[0:15]
    v_fmac_f32 v201, v52, v140
    v_fmac_f32 v201, v53, v141
    v_fmac_f32 v201, v54, v142
    v_fmac_f32 v201, v55, v143
    v_add_f32 v199, v197, v199
    v_mul_f32_e64 v203, v56, -v136
    s_add_u32 m0, s21, 4096
    v_mfma_f32_32x32x16_bf16 v[16:31], v[84:87], v[176:179], v[16:31]
    buffer_load_dwordx4 v238, s[4:7], s36 offen lds
    buffer_load_dwordx4 v239, s[8:11], s36 offen offset:1024 lds
    ds_read_b64_tr_b16 v[176:177], v244 offset:6144
    ds_read_b64_tr_b16 v[178:179], v244 offset:7168
    ds_read_b64_tr_b16 v[192:193], v245 offset:6144
    ds_read_b64_tr_b16 v[194:195], v245 offset:7168
    v_fma_f32 v203, v57, -v137, v203
    v_fma_f32 v203, v58, -v138, v203
    v_fma_f32 v203, v59, -v139, v203
    v_fma_f32 v203, v60, -v140, v203
    v_fma_f32 v203, v61, -v141, v203
    s_waitcnt lgkmcnt(0)
    v_mfma_f32_32x32x16_bf16 v[0:15], v[88:91], v[176:179], v[0:15]
    v_fma_f32 v203, v62, -v142, v203
    v_fma_f32 v203, v63, -v143, v203
    s_nop 1
    v_permlane32_swap_b32 v201, v203
    v_add_f32 v203, v201, v203
    s_add_u32 m0, s21, 6144
    v_mfma_f32_32x32x16_bf16 v[16:31], v[92:95], v[176:179], v[16:31]
    buffer_load_dwordx4 v240, s[4:7], s36 offen lds
    buffer_load_dwordx4 v241, s[8:11], s36 offen offset:1024 lds
    s_set_gpr_idx_on s51, gpr_idx(DST)
    s_nop 0
    v_cvt_pk_bf16_f32 v204, v198, v199
    v_cvt_pk_bf16_f32 v205, v202, v203
    s_set_gpr_idx_off
    v_mfma_f32_32x32x16_bf16 v[32:47], v[64:67], v[180:183], 0
    v_mul_f32 v196, v0, v144
    v_fmac_f32 v196, v1, v145
    v_fmac_f32 v196, v2, v146
    v_fmac_f32 v196, v3, v147
    v_mfma_f32_32x32x16_bf16 v[48:63], v[68:71], v[180:183], 0
    v_fmac_f32 v196, v4, v148
    v_fmac_f32 v196, v5, v149
    v_fmac_f32 v196, v6, v150
    v_fmac_f32 v196, v7, v151
    v_mfma_f32_32x32x16_bf16 v[32:47], v[72:75], v[184:187], v[32:47]
    v_mul_f32 v198, v8, v112
    v_fmac_f32 v198, v9, v113
    v_fmac_f32 v198, v10, v114
    v_fmac_f32 v198, v11, v115
    v_mfma_f32_32x32x16_bf16 v[48:63], v[76:79], v[184:187], v[48:63]
    v_fmac_f32 v198, v12, v116
    v_fmac_f32 v198, v13, v117
    v_fmac_f32 v198, v14, v118
    v_fmac_f32 v198, v15, v119
    v_mfma_f32_32x32x16_bf16 v[32:47], v[80:83], v[188:191], v[32:47]
    v_mul_f32_e64 v200, v16, -v160
    v_fma_f32 v200, v17, -v161, v200
    v_fma_f32 v200, v18, -v162, v200
    v_fma_f32 v200, v19, -v163, v200
    v_mfma_f32_32x32x16_bf16 v[48:63], v[84:87], v[188:191], v[48:63]
    s_waitcnt vmcnt(8)
    ds_read_b64_tr_b16 v[176:177], v244 offset:0
    ds_read_b64_tr_b16 v[178:179], v244 offset:1024
    ds_read_b64_tr_b16 v[180:181], v245 offset:0
    ds_read_b64_tr_b16 v[182:183], v245 offset:1024
    v_fma_f32 v200, v20, -v164, v200
    v_fma_f32 v200, v21, -v165, v200
    v_fma_f32 v200, v22, -v166, v200
    v_fma_f32 v200, v23, -v167, v200
    v_mfma_f32_32x32x16_bf16 v[32:47], v[88:91], v[192:195], v[32:47]
    v_mul_f32_e64 v202, v24, -v160
    v_fma_f32 v202, v25, -v161, v202
    v_fma_f32 v202, v26, -v162, v202
    v_fma_f32 v202, v27, -v163, v202
    v_mfma_f32_32x32x16_bf16 v[48:63], v[92:95], v[192:195], v[48:63]
    v_fma_f32 v202, v28, -v164, v202
    v_fma_f32 v202, v29, -v165, v202
    v_fma_f32 v202, v30, -v166, v202
    v_fma_f32 v202, v31, -v167, v202
    s_waitcnt vmcnt(4) lgkmcnt(0)
    v_mfma_f32_32x32x16_bf16 v[0:15], v[64:67], v[176:179], 0
    s_nop 0
    v_mul_f32 v197, v32, v152
    v_fmac_f32 v197, v33, v153
    v_fmac_f32 v197, v34, v154
    v_fmac_f32 v197, v35, v155
    s_add_u32 m0, s21, 0
    v_mfma_f32_32x32x16_bf16 v[16:31], v[68:71], v[176:179], 0
    buffer_load_dwordx4 v234, s[4:7], s37 offen lds
    buffer_load_dwordx4 v235, s[8:11], s37 offen offset:1024 lds
    ds_read_b64_tr_b16 v[176:177], v244 offset:2048
    ds_read_b64_tr_b16 v[178:179], v244 offset:3072
    ds_read_b64_tr_b16 v[184:185], v245 offset:2048
    ds_read_b64_tr_b16 v[186:187], v245 offset:3072
    v_add_u32 v252, s42, v247
    ds_read_u16 v234, v252
    ds_read_u16 v235, v252 offset:64
    v_fmac_f32 v197, v36, v156
    v_fmac_f32 v197, v37, v157
    v_fmac_f32 v197, v38, v158
    v_fmac_f32 v197, v39, v159
    s_waitcnt vmcnt(4) lgkmcnt(2)
    v_mfma_f32_32x32x16_bf16 v[0:15], v[72:75], v[176:179], v[0:15]
    v_mul_f32 v199, v40, v120
    v_fmac_f32 v199, v41, v121
    v_fmac_f32 v199, v42, v122
    v_fmac_f32 v199, v43, v123
    s_add_u32 m0, s21, 2048
    v_mfma_f32_32x32x16_bf16 v[16:31], v[76:79], v[176:179], v[16:31]
    buffer_load_dwordx4 v236, s[4:7], s37 offen lds
    buffer_load_dwordx4 v237, s[8:11], s37 offen offset:1024 lds
    ds_read_b64_tr_b16 v[176:177], v244 offset:4096
    ds_read_b64_tr_b16 v[178:179], v244 offset:5120
    ds_read_b64_tr_b16 v[188:189], v245 offset:4096
    ds_read_b64_tr_b16 v[190:191], v245 offset:5120
    v_add_u32 v252, s43, v247
    ds_read_u16 v236, v252
    ds_read_u16 v237, v252 offset:64
    v_fmac_f32 v199, v44, v124
    v_fmac_f32 v199, v45, v125
    v_fmac_f32 v199, v46, v126
    v_fmac_f32 v199, v47, v127
    s_waitcnt vmcnt(4) lgkmcnt(2)
    v_mfma_f32_32x32x16_bf16 v[0:15], v[80:83], v[176:179], v[0:15]
    v_mul_f32_e64 v201, v48, -v168
    v_fma_f32 v201, v49, -v169, v201
    v_fma_f32 v201, v50, -v170, v201
    v_fma_f32 v201, v51, -v171, v201
    s_add_u32 m0, s21, 4096
    v_mfma_f32_32x32x16_bf16 v[16:31], v[84:87], v[176:179], v[16:31]
    buffer_load_dwordx4 v238, s[4:7], s37 offen lds
    buffer_load_dwordx4 v239, s[8:11], s37 offen offset:1024 lds
    ds_read_b64_tr_b16 v[176:177], v244 offset:6144
    ds_read_b64_tr_b16 v[178:179], v244 offset:7168
    ds_read_b64_tr_b16 v[192:193], v245 offset:6144
    ds_read_b64_tr_b16 v[194:195], v245 offset:7168
    v_add_u32 v252, s44, v247
    ds_read_u16 v238, v252
    ds_read_u16 v239, v252 offset:64
    v_fma_f32 v201, v52, -v172, v201
    v_fma_f32 v201, v53, -v173, v201
    v_fma_f32 v201, v54, -v174, v201
    v_fma_f32 v201, v55, -v175, v201
    s_waitcnt lgkmcnt(2)
    v_mfma_f32_32x32x16_bf16 v[0:15], v[88:91], v[176:179], v[0:15]
    v_mul_f32_e64 v203, v56, -v168
    v_fma_f32 v203, v57, -v169, v203
    v_fma_f32 v203, v58, -v170, v203
    v_fma_f32 v203, v59, -v171, v203
    s_add_u32 m0, s21, 6144
    v_mfma_f32_32x32x16_bf16 v[16:31], v[92:95], v[176:179], v[16:31]
    buffer_load_dwordx4 v240, s[4:7], s37 offen lds
    buffer_load_dwordx4 v241, s[8:11], s37 offen offset:1024 lds
    v_add_u32 v252, s45, v247
    ds_read_u16 v240, v252
    ds_read_u16 v241, v252 offset:64
    v_fma_f32 v203, v60, -v172, v203
    v_fma_f32 v203, v61, -v173, v203
    v_fma_f32 v203, v62, -v174, v203
    v_fma_f32 v203, v63, -v175, v203
    v_mfma_f32_32x32x16_bf16 v[32:47], v[64:67], v[180:183], 0
    v_mul_f32 v254, v0, v144
    v_fmac_f32 v254, v1, v145
    v_fmac_f32 v254, v2, v146
    v_mfma_f32_32x32x16_bf16 v[48:63], v[68:71], v[180:183], 0
    ds_swizzle_b32 v68, v68 offset:0x401F
    ds_swizzle_b32 v69, v69 offset:0x401F
    ds_swizzle_b32 v70, v70 offset:0x401F
    ds_swizzle_b32 v71, v71 offset:0x401F
    v_fmac_f32 v254, v3, v147
    v_fmac_f32 v254, v4, v148
    v_mfma_f32_32x32x16_bf16 v[32:47], v[72:75], v[184:187], v[32:47]
    v_fmac_f32 v254, v5, v149
    v_fmac_f32 v254, v6, v150
    v_mfma_f32_32x32x16_bf16 v[48:63], v[76:79], v[184:187], v[48:63]
    ds_swizzle_b32 v76, v76 offset:0x401F
    ds_swizzle_b32 v77, v77 offset:0x401F
    ds_swizzle_b32 v78, v78 offset:0x401F
    ds_swizzle_b32 v79, v79 offset:0x401F
    v_fmac_f32 v254, v7, v151
    v_fmac_f32 v200, v8, v160
    v_mfma_f32_32x32x16_bf16 v[32:47], v[80:83], v[188:191], v[32:47]
    v_fmac_f32 v200, v9, v161
    v_permlane32_swap_b32 v196, v254
    v_fmac_f32 v200, v10, v162
    v_mfma_f32_32x32x16_bf16 v[48:63], v[84:87], v[188:191], v[48:63]
    ds_swizzle_b32 v84, v84 offset:0x401F
    ds_swizzle_b32 v85, v85 offset:0x401F
    ds_swizzle_b32 v86, v86 offset:0x401F
    ds_swizzle_b32 v87, v87 offset:0x401F
    s_waitcnt vmcnt(6)
    ds_read_b64_tr_b16 v[176:177], v244 offset:0
    ds_read_b64_tr_b16 v[178:179], v244 offset:1024
    ds_read_b64_tr_b16 v[180:181], v245 offset:0
    ds_read_b64_tr_b16 v[182:183], v245 offset:1024
    v_fmac_f32 v200, v11, v163
    v_fmac_f32 v200, v12, v164
    v_mfma_f32_32x32x16_bf16 v[32:47], v[88:91], v[192:195], v[32:47]
    v_fmac_f32 v200, v13, v165
    v_fmac_f32 v200, v14, v166
    v_mfma_f32_32x32x16_bf16 v[48:63], v[92:95], v[192:195], v[48:63]
    ds_swizzle_b32 v92, v92 offset:0x401F
    ds_swizzle_b32 v93, v93 offset:0x401F
    ds_swizzle_b32 v94, v94 offset:0x401F
    ds_swizzle_b32 v95, v95 offset:0x401F
    v_fmac_f32 v200, v15, v167
    v_add_f32 v254, v196, v254
    s_waitcnt lgkmcnt(8)
    s_mov_b64 exec, s[56:57]
    v_xor_b32 v68, 0x80008000, v68
    v_xor_b32 v69, 0x80008000, v69
    v_xor_b32 v70, 0x80008000, v70
    v_xor_b32 v71, 0x80008000, v71
    v_xor_b32 v76, 0x80008000, v76
    v_xor_b32 v77, 0x80008000, v77
    v_xor_b32 v78, 0x80008000, v78
    v_xor_b32 v79, 0x80008000, v79
    v_xor_b32 v84, 0x80008000, v84
    v_xor_b32 v85, 0x80008000, v85
    v_xor_b32 v86, 0x80008000, v86
    v_xor_b32 v87, 0x80008000, v87
    s_mov_b64 exec, -1
    s_waitcnt vmcnt(4) lgkmcnt(4)
    v_mfma_f32_32x32x16_bf16 v[0:15], v[64:67], v[176:179], 0
    v_mul_f32 v255, v32, v152
    v_fmac_f32 v255, v33, v153
    v_fmac_f32 v255, v34, v154
    s_add_u32 m0, s21, 0
    v_mfma_f32_32x32x16_bf16 v[16:31], v[68:71], v[176:179], v[16:31]
    v_lshl_add_u32 v234, v234, 10, v246
    v_lshl_add_u32 v235, v235, 10, v246
    buffer_load_dwordx4 v234, s[4:7], s38 offen lds
    buffer_load_dwordx4 v235, s[8:11], s38 offen offset:1024 lds
    ds_read_b64_tr_b16 v[176:177], v244 offset:2048
    ds_read_b64_tr_b16 v[178:179], v244 offset:3072
    ds_read_b64_tr_b16 v[184:185], v245 offset:2048
    ds_read_b64_tr_b16 v[186:187], v245 offset:3072
    v_fmac_f32 v255, v35, v155
    v_fmac_f32 v255, v36, v156
    v_fmac_f32 v255, v37, v157
    s_waitcnt vmcnt(4) lgkmcnt(0)
    v_mfma_f32_32x32x16_bf16 v[0:15], v[72:75], v[176:179], v[0:15]
    v_fmac_f32 v255, v38, v158
    v_fmac_f32 v255, v39, v159
    v_fmac_f32 v201, v40, v168
    s_add_u32 m0, s21, 2048
    v_mfma_f32_32x32x16_bf16 v[16:31], v[76:79], v[176:179], v[16:31]
    v_lshl_add_u32 v236, v236, 10, v246
    v_lshl_add_u32 v237, v237, 10, v246
    buffer_load_dwordx4 v236, s[4:7], s39 offen lds
    buffer_load_dwordx4 v237, s[8:11], s39 offen offset:1024 lds
    ds_read_b64_tr_b16 v[176:177], v244 offset:4096
    ds_read_b64_tr_b16 v[178:179], v244 offset:5120
    ds_read_b64_tr_b16 v[188:189], v245 offset:4096
    ds_read_b64_tr_b16 v[190:191], v245 offset:5120
    v_fmac_f32 v201, v41, v169
    v_permlane32_swap_b32 v197, v255
    s_waitcnt vmcnt(4) lgkmcnt(0)
    v_mfma_f32_32x32x16_bf16 v[0:15], v[80:83], v[176:179], v[0:15]
    v_fmac_f32 v201, v42, v170
    v_fmac_f32 v201, v43, v171
    v_fmac_f32 v201, v44, v172
    s_add_u32 m0, s21, 4096
    v_mfma_f32_32x32x16_bf16 v[16:31], v[84:87], v[176:179], v[16:31]
    v_lshl_add_u32 v238, v238, 10, v246
    v_lshl_add_u32 v239, v239, 10, v246
    buffer_load_dwordx4 v238, s[4:7], s40 offen lds
    buffer_load_dwordx4 v239, s[8:11], s40 offen offset:1024 lds
    ds_read_b64_tr_b16 v[176:177], v244 offset:6144
    ds_read_b64_tr_b16 v[178:179], v244 offset:7168
    ds_read_b64_tr_b16 v[192:193], v245 offset:6144
    ds_read_b64_tr_b16 v[194:195], v245 offset:7168
    v_fmac_f32 v201, v45, v173
    v_fmac_f32 v201, v46, v174
    v_fmac_f32 v201, v47, v175
    s_waitcnt lgkmcnt(0)
    s_mov_b64 exec, s[56:57]
    v_xor_b32 v92, 0x80008000, v92
    v_xor_b32 v93, 0x80008000, v93
    v_xor_b32 v94, 0x80008000, v94
    v_xor_b32 v95, 0x80008000, v95
    s_mov_b64 exec, -1
    v_mfma_f32_32x32x16_bf16 v[0:15], v[88:91], v[176:179], v[0:15]
    v_add_f32 v255, v197, v255
    s_set_gpr_idx_on s51, gpr_idx(DST)
    s_nop 0
    v_cvt_pk_bf16_f32 v206, v254, v255
    s_set_gpr_idx_off
    s_add_u32 m0, s21, 6144
    v_mfma_f32_32x32x16_bf16 v[16:31], v[92:95], v[176:179], v[16:31]
    v_lshl_add_u32 v240, v240, 10, v246
    v_lshl_add_u32 v241, v241, 10, v246
    buffer_load_dwordx4 v240, s[4:7], s41 offen lds
    buffer_load_dwordx4 v241, s[8:11], s41 offen offset:1024 lds
    v_mfma_f32_32x32x16_bf16 v[32:47], v[64:67], v[180:183], 0
    v_mul_f32 v254, v0, v144
    v_fmac_f32 v254, v1, v145
    v_fmac_f32 v254, v2, v146
    v_fmac_f32 v254, v3, v147
    v_fmac_f32 v254, v4, v148
    v_mfma_f32_32x32x16_bf16 v[48:63], v[68:71], v[180:183], v[48:63]
    v_fmac_f32 v254, v5, v149
    v_fmac_f32 v254, v6, v150
    v_fmac_f32 v254, v7, v151
    v_fma_f32 v202, v8, -v160, v202
    v_fma_f32 v202, v9, -v161, v202
    v_mfma_f32_32x32x16_bf16 v[32:47], v[72:75], v[184:187], v[32:47]
    v_permlane32_swap_b32 v254, v200
    v_fma_f32 v202, v10, -v162, v202
    v_fma_f32 v202, v11, -v163, v202
    v_fma_f32 v202, v12, -v164, v202
    v_fma_f32 v202, v13, -v165, v202
    v_mfma_f32_32x32x16_bf16 v[48:63], v[76:79], v[184:187], v[48:63]
    v_fma_f32 v202, v14, -v166, v202
    v_fma_f32 v202, v15, -v167, v202
    v_add_f32 v200, v254, v200
    v_fmac_f32 v198, v16, v112
    v_permlane32_swap_b32 v202, v254
    v_mfma_f32_32x32x16_bf16 v[32:47], v[80:83], v[188:191], v[32:47]
    v_fmac_f32 v198, v17, v113
    v_fmac_f32 v198, v18, v114
    v_fmac_f32 v198, v19, v115
    v_fmac_f32 v198, v20, v116
    v_fmac_f32 v198, v21, v117
    v_mfma_f32_32x32x16_bf16 v[48:63], v[84:87], v[188:191], v[48:63]
    s_waitcnt vmcnt(6)
    ds_read_b64_tr_b16 v[176:177], v244 offset:0
    ds_read_b64_tr_b16 v[178:179], v244 offset:1024
    ds_read_b64_tr_b16 v[180:181], v245 offset:0
    ds_read_b64_tr_b16 v[182:183], v245 offset:1024
    v_fmac_f32 v198, v22, v118
    v_fmac_f32 v198, v23, v119
    v_add_f32 v254, v202, v254
    v_mul_f32 v196, v24, v160
    v_fmac_f32 v196, v25, v161
    v_mfma_f32_32x32x16_bf16 v[32:47], v[88:91], v[192:195], v[32:47]
    v_fmac_f32 v196, v26, v162
    v_fmac_f32 v196, v27, v163
    v_fmac_f32 v196, v28, v164
    v_fmac_f32 v196, v29, v165
    v_fmac_f32 v196, v30, v166
    v_mfma_f32_32x32x16_bf16 v[48:63], v[92:95], v[192:195], v[48:63]
    v_add_u32 v249, s48, v249
    v_add_u32 v250, s49, v250
    ds_read_b32 v252, v251 offset:16
    ds_read_b64_tr_b16 v[64:65], v249 offset:0
    ds_read_b64_tr_b16 v[68:69], v249 offset:64
    ds_read_b64_tr_b16 v[66:67], v249 offset:256
    ds_read_b64_tr_b16 v[70:71], v249 offset:320
    s_mov_b64 exec, s[54:55]
    ds_read_u16_d16_hi v242, v250 offset:0
    s_mov_b64 exec, -1
    v_fmac_f32 v196, v31, v167
    s_nop 1
    v_permlane32_swap_b32 v198, v196
    v_add_f32 v196, v198, v196
    v_mul_f32 v255, v32, v152
    v_fmac_f32 v255, v33, v153
    v_fmac_f32 v255, v34, v154
    v_fmac_f32 v255, v35, v155
    v_fmac_f32 v255, v36, v156
    v_fmac_f32 v255, v37, v157
    v_fmac_f32 v255, v38, v158
    v_fmac_f32 v255, v39, v159
    v_fma_f32 v203, v40, -v168, v203
    v_fma_f32 v203, v41, -v169, v203
    v_permlane32_swap_b32 v255, v201
    v_fma_f32 v203, v42, -v170, v203
    v_fma_f32 v203, v43, -v171, v203
    v_fma_f32 v203, v44, -v172, v203
    v_fma_f32 v203, v45, -v173, v203
    v_fma_f32 v203, v46, -v174, v203
    v_fma_f32 v203, v47, -v175, v203
    v_add_f32 v201, v255, v201
    v_fmac_f32 v199, v48, v120
    v_permlane32_swap_b32 v203, v255
    v_fmac_f32 v199, v49, v121
    v_fmac_f32 v199, v50, v122
    v_fmac_f32 v199, v51, v123
    v_fmac_f32 v199, v52, v124
    v_fmac_f32 v199, v53, v125
    v_fmac_f32 v199, v54, v126
    v_fmac_f32 v199, v55, v127
    v_add_f32 v255, v203, v255
    v_mul_f32 v197, v56, v168
    v_fmac_f32 v197, v57, v169
    v_fmac_f32 v197, v58, v170
    v_fmac_f32 v197, v59, v171
    v_fmac_f32 v197, v60, v172
    v_fmac_f32 v197, v61, v173
    v_fmac_f32 v197, v62, v174
    v_fmac_f32 v197, v63, v175
    s_nop 1
    v_permlane32_swap_b32 v199, v197
    v_add_f32 v197, v199, v197
    s_set_gpr_idx_on s51, gpr_idx(DST)
    s_nop 0
    v_cvt_pk_bf16_f32 v207, v200, v201
    v_cvt_pk_bf16_f32 v209, v254, v255
    v_cvt_pk_bf16_f32 v208, v196, v197
    s_set_gpr_idx_off
    s_add_u32 s50, s50, 1
    s_add_u32 s51, s51, 6
    s_cmp_ge_u32 s50, 4
    s_cbranch_scc1 LAST0
    s_waitcnt lgkmcnt(5)
    v_readfirstlane_b32 s66, v252
    s_add_u32 s53, s53, 1
    v_mov_b32 v252, s53
    s_cmp_le_u32 s53, s66
    ds_write2_b32 v251, v252, v252 offset0:0 offset1:8
    s_setprio 1
    s_cbranch_scc1 PRIO_9
    s_setprio 0
PRIO_9:
    s_cmp_eq_u32 s52, 4
    s_cbranch_scc1 ITEM_0_4
    s_cmp_eq_u32 s52, 5
    s_cbranch_scc1 ITEM_0_5
    s_cmp_eq_u32 s52, 3
    s_cbranch_scc1 ITEM_0_3
    s_cmp_eq_u32 s52, 6
    s_cbranch_scc1 ITEM_0_6
    s_cmp_eq_u32 s52, 8
    s_cbranch_scc1 ITEM_0_8
    s_branch ITEM_0_2
.p2align 6
ITEM_0_2:
    s_mov_b32 m0, s50
    s_nop 0
    s_movrels_b32 s71, s23
    s_bfe_u32 s46, s71, 0x30012
    s_mov_b32 m0, s46
    s_and_b32 s66, s71, 0x3ffff
    s_movrels_b32 s68, s57
    s_movrels_b32 s69, s61
    s_sub_u32 s48, s66, s47
    s_mov_b32 s47, s66
    s_lshr_b32 s52, s71, 28
    s_lshl_b32 s67, s46, 9
    s_add_u32 s66, s66, s67
    s_sub_u32 s49, s66, s42
    s_mov_b32 s42, s66
    s_bfe_u32 s66, s68, 655360
    s_add_u32 s43, s42, s66
    s_bfe_u32 s39, s69, 655360
    s_bfe_u32 s66, s68, 655370
    s_add_u32 s44, s42, s66
    s_bfe_u32 s40, s69, 655370
    s_bfe_u32 s66, s68, 655380
    s_add_u32 s45, s42, s66
    s_bfe_u32 s41, s69, 655380
    s_and_b32 s66, s46, s33
    s_cselect_b32 s72, -1, 1
    s_cselect_b32 s76, s47, 163712
    s_cmp_ge_u32 s66, 2
    s_cselect_b32 s73, -1, 0
    s_add_u32 s77, s47, 1024
    s_cmp_ge_u32 s66, 4
    s_cselect_b32 s75, -1, 0
    s_cmp_ge_u32 s66, 3
    s_cselect_b32 s74, -1, 1
    s_cselect_b32 s77, s77, 163712
    v_add_u32 v252, s42, v247
    ds_read_u16 v234, v252
    ds_read_u16 v235, v252 offset:64
    v_add_u32 v252, s43, v247
    ds_read_u16 v236, v252
    ds_read_u16 v237, v252 offset:64
    v_add_u32 v252, s44, v247
    ds_read_u16 v238, v252
    ds_read_u16 v239, v252 offset:64
    v_add_u32 v252, s45, v247
    ds_read_u16 v240, v252
    ds_read_u16 v241, v252 offset:64
    s_waitcnt lgkmcnt(8)
    v_mul_f32_dpp v196, v242, v64 row_newbcast:0 row_mask:0xf bank_mask:0xf
    v_mul_f32_dpp v197, v242, v65 row_newbcast:1 row_mask:0xf bank_mask:0xf
    v_mul_f32_dpp v198, v242, v64 row_newbcast:8 row_mask:0xf bank_mask:0xf
    v_mul_f32_dpp v199, v242, v65 row_newbcast:9 row_mask:0xf bank_mask:0xf
    v_mul_f32_dpp v200, v242, v68 row_newbcast:2 row_mask:0xf bank_mask:0xf
    v_mul_f32_dpp v201, v242, v69 row_newbcast:3 row_mask:0xf bank_mask:0xf
    v_mul_f32_dpp v202, v242, v68 row_newbcast:10 row_mask:0xf bank_mask:0xf
    v_mul_f32_dpp v203, v242, v69 row_newbcast:11 row_mask:0xf bank_mask:0xf
    v_cvt_pk_bf16_f32 v64, v196, v197
    v_cvt_pk_bf16_f32 v68, v198, v199
    v_cvt_pk_bf16_f32 v65, v200, v201
    v_cvt_pk_bf16_f32 v69, v202, v203
    v_mul_f32_dpp v196, v242, v66 row_newbcast:4 row_mask:0xf bank_mask:0xf
    v_mul_f32_dpp v197, v242, v67 row_newbcast:5 row_mask:0xf bank_mask:0xf
    v_mul_f32_dpp v198, v242, v66 row_newbcast:12 row_mask:0xf bank_mask:0xf
    v_mul_f32_dpp v199, v242, v67 row_newbcast:13 row_mask:0xf bank_mask:0xf
    v_mul_f32_dpp v200, v242, v70 row_newbcast:6 row_mask:0xf bank_mask:0xf
    v_mul_f32_dpp v201, v242, v71 row_newbcast:7 row_mask:0xf bank_mask:0xf
    v_mul_f32_dpp v202, v242, v70 row_newbcast:14 row_mask:0xf bank_mask:0xf
    v_mul_f32_dpp v203, v242, v71 row_newbcast:15 row_mask:0xf bank_mask:0xf
    v_cvt_pk_bf16_f32 v66, v196, v197
    v_cvt_pk_bf16_f32 v70, v198, v199
    v_cvt_pk_bf16_f32 v67, v200, v201
    v_cvt_pk_bf16_f32 v71, v202, v203
    s_nop 0
    s_waitcnt lgkmcnt(6)
    v_mfma_f32_32x32x16_bf16 v[0:15], v[64:67], v[176:179], 0
    s_add_u32 m0, s21, 0
    v_mfma_f32_32x32x16_bf16 v[16:31], v[68:71], v[176:179], 0
    v_lshl_add_u32 v234, v234, 10, v246
    v_lshl_add_u32 v235, v235, 10, v246
    buffer_load_dwordx4 v234, s[4:7], s38 offen lds
    buffer_load_dwordx4 v235, s[8:11], s38 offen offset:1024 lds
    v_mfma_f32_32x32x16_bf16 v[32:47], v[64:67], v[180:183], 0
    s_nop 4
    v_mul_f32 v196, v0, v96
    v_fmac_f32 v196, v1, v97
    v_fmac_f32 v196, v2, v98
    v_fmac_f32 v196, v3, v99
    v_fmac_f32 v196, v4, v100
    v_fmac_f32 v196, v5, v101
    v_fmac_f32 v196, v6, v102
    v_fmac_f32 v196, v7, v103
    v_mul_f32 v198, v8, v128
    v_fmac_f32 v198, v9, v129
    v_fmac_f32 v198, v10, v130
    v_fmac_f32 v198, v11, v131
    v_fmac_f32 v198, v12, v132
    v_fmac_f32 v198, v13, v133
    v_fmac_f32 v198, v14, v134
    v_fmac_f32 v198, v15, v135
    v_mul_f32 v200, v16, v128
    v_fmac_f32 v200, v17, v129
    v_permlane32_swap_b32 v196, v198
    v_mfma_f32_32x32x16_bf16 v[48:63], v[68:71], v[180:183], 0
    v_add_u32 v253, s47, v248
    ds_read_b32 v254, v253
    ds_read_b32 v255, v253 offset:256
    s_waitcnt vmcnt(6)
    ds_read_b64_tr_b16 v[176:177], v244 offset:2048
    ds_read_b64_tr_b16 v[178:179], v244 offset:3072
    ds_read_b64_tr_b16 v[180:181], v245 offset:2048
    ds_read_b64_tr_b16 v[182:183], v245 offset:3072
    v_fmac_f32 v200, v18, v130
    v_fmac_f32 v200, v19, v131
    v_fmac_f32 v200, v20, v132
    v_fmac_f32 v200, v21, v133
    v_fmac_f32 v200, v22, v134
    v_fmac_f32 v200, v23, v135
    v_add_f32 v198, v196, v198
    v_mul_f32_e64 v202, v24, -v128
    v_fma_f32 v202, v25, -v129, v202
    v_fma_f32 v202, v26, -v130, v202
    v_fma_f32 v202, v27, -v131, v202
    v_fma_f32 v202, v28, -v132, v202
    v_fma_f32 v202, v29, -v133, v202
    v_fma_f32 v202, v30, -v134, v202
    v_fma_f32 v202, v31, -v135, v202
    s_nop 1
    v_permlane32_swap_b32 v200, v202
    v_add_f32 v202, v200, v202
    s_waitcnt lgkmcnt(0)
    v_mfma_f32_32x32x16_bf16 v[0:15], v[64:67], v[176:179], 0
    v_mul_f32 v197, v32, v104
    v_fmac_f32 v197, v33, v105
    v_fmac_f32 v197, v34, v106
    v_fmac_f32 v197, v35, v107
    v_fmac_f32 v197, v36, v108
    v_fmac_f32 v197, v37, v109
    v_fmac_f32 v197, v38, v110
    v_fmac_f32 v197, v39, v111
    v_mul_f32 v199, v40, v136
    v_fmac_f32 v199, v41, v137
    v_fmac_f32 v199, v42, v138
    v_fmac_f32 v199, v43, v139
    v_fmac_f32 v199, v44, v140
    v_fmac_f32 v199, v45, v141
    v_fmac_f32 v199, v46, v142
    v_fmac_f32 v199, v47, v143
    v_mul_f32 v201, v48, v136
    v_fmac_f32 v201, v49, v137
    v_permlane32_swap_b32 v197, v199
    v_fmac_f32 v201, v50, v138
    v_fmac_f32 v201, v51, v139
    s_add_u32 m0, s21, 2048
    v_mfma_f32_32x32x16_bf16 v[16:31], v[68:71], v[176:179], 0
    v_lshl_add_u32 v236, v236, 10, v246
    v_lshl_add_u32 v237, v237, 10, v246
    buffer_load_dwordx4 v236, s[4:7], s39 offen lds
    buffer_load_dwordx4 v237, s[8:11], s39 offen offset:1024 lds
    s_mov_b32 m0, s76
    s_mov_b64 exec, s[72:73]
    buffer_load_dwordx4 v254, s[12:15], 0 offen  lds
    s_mov_b32 m0, s77
    s_mov_b64 exec, s[74:75]
    buffer_load_dwordx4 v255, s[12:15], 0 offen  lds
    s_mov_b64 exec, -1
    v_fmac_f32 v201, v52, v140
    v_fmac_f32 v201, v53, v141
    v_fmac_f32 v201, v54, v142
    v_fmac_f32 v201, v55, v143
    v_add_f32 v199, v197, v199
    v_mul_f32_e64 v203, v56, -v136
    v_fma_f32 v203, v57, -v137, v203
    v_fma_f32 v203, v58, -v138, v203
    v_fma_f32 v203, v59, -v139, v203
    v_fma_f32 v203, v60, -v140, v203
    v_fma_f32 v203, v61, -v141, v203
    v_fma_f32 v203, v62, -v142, v203
    v_fma_f32 v203, v63, -v143, v203
    s_nop 1
    v_permlane32_swap_b32 v201, v203
    v_add_f32 v203, v201, v203
    s_set_gpr_idx_on s51, gpr_idx(DST)
    s_nop 0
    v_cvt_pk_bf16_f32 v204, v198, v199
    v_cvt_pk_bf16_f32 v205, v202, v203
    s_set_gpr_idx_off
    v_mfma_f32_32x32x16_bf16 v[32:47], v[64:67], v[180:183], 0
    v_mul_f32 v196, v0, v144
    v_fmac_f32 v196, v1, v145
    v_fmac_f32 v196, v2, v146
    v_fmac_f32 v196, v3, v147
    v_fmac_f32 v196, v4, v148
    v_fmac_f32 v196, v5, v149
    v_fmac_f32 v196, v6, v150
    v_fmac_f32 v196, v7, v151
    v_mul_f32 v198, v8, v112
    v_fmac_f32 v198, v9, v113
    v_fmac_f32 v198, v10, v114
    v_fmac_f32 v198, v11, v115
    v_fmac_f32 v198, v12, v116
    v_fmac_f32 v198, v13, v117
    v_fmac_f32 v198, v14, v118
    v_fmac_f32 v198, v15, v119
    v_mfma_f32_32x32x16_bf16 v[48:63], v[68:71], v[180:183], 0
    s_waitcnt vmcnt(8)
    ds_read_b64_tr_b16 v[176:177], v244 offset:4096
    ds_read_b64_tr_b16 v[178:179], v244 offset:5120
    ds_read_b64_tr_b16 v[180:181], v245 offset:4096
    ds_read_b64_tr_b16 v[182:183], v245 offset:5120
    v_mul_f32_e64 v200, v16, -v160
    v_fma_f32 v200, v17, -v161, v200
    v_fma_f32 v200, v18, -v162, v200
    v_fma_f32 v200, v19, -v163, v200
    v_fma_f32 v200, v20, -v164, v200
    v_fma_f32 v200, v21, -v165, v200
    v_fma_f32 v200, v22, -v166, v200
    v_fma_f32 v200, v23, -v167, v200
    v_mul_f32_e64 v202, v24, -v160
    v_fma_f32 v202, v25, -v161, v202
    v_fma_f32 v202, v26, -v162, v202
    v_fma_f32 v202, v27, -v163, v202
    v_fma_f32 v202, v28, -v164, v202
    v_fma_f32 v202, v29, -v165, v202
    v_fma_f32 v202, v30, -v166, v202
    v_fma_f32 v202, v31, -v167, v202
    s_waitcnt lgkmcnt(0)
    v_mfma_f32_32x32x16_bf16 v[0:15], v[64:67], v[176:179], 0
    v_mul_f32 v197, v32, v152
    v_fmac_f32 v197, v33, v153
    v_fmac_f32 v197, v34, v154
    v_fmac_f32 v197, v35, v155
    v_fmac_f32 v197, v36, v156
    v_fmac_f32 v197, v37, v157
    v_fmac_f32 v197, v38, v158
    v_fmac_f32 v197, v39, v159
    v_mul_f32 v199, v40, v120
    v_fmac_f32 v199, v41, v121
    v_fmac_f32 v199, v42, v122
    v_fmac_f32 v199, v43, v123
    v_fmac_f32 v199, v44, v124
    v_fmac_f32 v199, v45, v125
    v_fmac_f32 v199, v46, v126
    v_fmac_f32 v199, v47, v127
    s_add_u32 m0, s21, 4096
    v_mfma_f32_32x32x16_bf16 v[16:31], v[68:71], v[176:179], 0
    v_lshl_add_u32 v238, v238, 10, v246
    v_lshl_add_u32 v239, v239, 10, v246
    buffer_load_dwordx4 v238, s[4:7], s40 offen lds
    buffer_load_dwordx4 v239, s[8:11], s40 offen offset:1024 lds
    v_mul_f32_e64 v201, v48, -v168
    v_fma_f32 v201, v49, -v169, v201
    v_fma_f32 v201, v50, -v170, v201
    v_fma_f32 v201, v51, -v171, v201
    v_fma_f32 v201, v52, -v172, v201
    v_fma_f32 v201, v53, -v173, v201
    v_fma_f32 v201, v54, -v174, v201
    v_fma_f32 v201, v55, -v175, v201
    v_mul_f32_e64 v203, v56, -v168
    v_fma_f32 v203, v57, -v169, v203
    v_fma_f32 v203, v58, -v170, v203
    v_fma_f32 v203, v59, -v171, v203
    v_fma_f32 v203, v60, -v172, v203
    v_fma_f32 v203, v61, -v173, v203
    v_fma_f32 v203, v62, -v174, v203
    v_fma_f32 v203, v63, -v175, v203
    v_mfma_f32_32x32x16_bf16 v[32:47], v[64:67], v[180:183], 0
    v_mul_f32 v254, v0, v144
    v_fmac_f32 v254, v1, v145
    v_fmac_f32 v254, v2, v146
    v_fmac_f32 v254, v3, v147
    v_fmac_f32 v254, v4, v148
    v_fmac_f32 v254, v5, v149
    v_fmac_f32 v254, v6, v150
    v_fmac_f32 v254, v7, v151
    v_fmac_f32 v200, v8, v160
    v_mfma_f32_32x32x16_bf16 v[48:63], v[68:71], v[180:183], 0
    ds_swizzle_b32 v68, v68 offset:0x401F
    ds_swizzle_b32 v69, v69 offset:0x401F
    ds_swizzle_b32 v70, v70 offset:0x401F
    ds_swizzle_b32 v71, v71 offset:0x401F
    s_waitcnt vmcnt(8)
    ds_read_b64_tr_b16 v[176:177], v244 offset:6144
    ds_read_b64_tr_b16 v[178:179], v244 offset:7168
    ds_read_b64_tr_b16 v[180:181], v245 offset:6144
    ds_read_b64_tr_b16 v[182:183], v245 offset:7168
    v_fmac_f32 v200, v9, v161
    v_permlane32_swap_b32 v196, v254
    v_fmac_f32 v200, v10, v162
    v_fmac_f32 v200, v11, v163
    v_fmac_f32 v200, v12, v164
    v_fmac_f32 v200, v13, v165
    v_fmac_f32 v200, v14, v166
    v_fmac_f32 v200, v15, v167
    v_add_f32 v254, v196, v254
    s_waitcnt lgkmcnt(0)
    s_mov_b64 exec, s[56:57]
    v_xor_b32 v68, 0x80008000, v68
    v_xor_b32 v69, 0x80008000, v69
    v_xor_b32 v70, 0x80008000, v70
    v_xor_b32 v71, 0x80008000, v71
    s_mov_b64 exec, -1
    s_nop 0
    v_mfma_f32_32x32x16_bf16 v[0:15], v[64:67], v[176:179], 0
    v_mul_f32 v255, v32, v152
    v_fmac_f32 v255, v33, v153
    v_fmac_f32 v255, v34, v154
    v_fmac_f32 v255, v35, v155
    v_fmac_f32 v255, v36, v156
    v_fmac_f32 v255, v37, v157
    v_fmac_f32 v255, v38, v158
    v_fmac_f32 v255, v39, v159
    v_fmac_f32 v201, v40, v168
    v_fmac_f32 v201, v41, v169
    v_permlane32_swap_b32 v197, v255
    s_add_u32 m0, s21, 6144
    v_mfma_f32_32x32x16_bf16 v[16:31], v[68:71], v[176:179], v[16:31]
    v_lshl_add_u32 v240, v240, 10, v246
    v_lshl_add_u32 v241, v241, 10, v246
    buffer_load_dwordx4 v240, s[4:7], s41 offen lds
    buffer_load_dwordx4 v241, s[8:11], s41 offen offset:1024 lds
    v_fmac_f32 v201, v42, v170
    v_fmac_f32 v201, v43, v171
    v_fmac_f32 v201, v44, v172
    v_fmac_f32 v201, v45, v173
    v_fmac_f32 v201, v46, v174
    v_fmac_f32 v201, v47, v175
    v_add_f32 v255, v197, v255
    s_set_gpr_idx_on s51, gpr_idx(DST)
    s_nop 0
    v_cvt_pk_bf16_f32 v206, v254, v255
    s_set_gpr_idx_off
    v_mfma_f32_32x32x16_bf16 v[32:47], v[64:67], v[180:183], 0
    v_mul_f32 v254, v0, v144
    v_fmac_f32 v254, v1, v145
    v_fmac_f32 v254, v2, v146
    v_fmac_f32 v254, v3, v147
    v_fmac_f32 v254, v4, v148
    v_fmac_f32 v254, v5, v149
    v_fmac_f32 v254, v6, v150
    v_fmac_f32 v254, v7, v151
    v_fma_f32 v202, v8, -v160, v202
    v_fma_f32 v202, v9, -v161, v202
    v_permlane32_swap_b32 v254, v200
    v_fma_f32 v202, v10, -v162, v202
    v_fma_f32 v202, v11, -v163, v202
    v_fma_f32 v202, v12, -v164, v202
    v_fma_f32 v202, v13, -v165, v202
    v_fma_f32 v202, v14, -v166, v202
    v_fma_f32 v202, v15, -v167, v202
    v_add_f32 v200, v254, v200
    v_fmac_f32 v198, v16, v112
    v_permlane32_swap_b32 v202, v254
    v_mfma_f32_32x32x16_bf16 v[48:63], v[68:71], v[180:183], v[48:63]
    s_waitcnt vmcnt(4)
    ds_read_b64_tr_b16 v[176:177], v244 offset:0
    ds_read_b64_tr_b16 v[178:179], v244 offset:1024
    ds_read_b64_tr_b16 v[180:181], v245 offset:0
    ds_read_b64_tr_b16 v[182:183], v245 offset:1024
    v_add_u32 v249, s48, v249
    v_add_u32 v250, s49, v250
    ds_read_b32 v252, v251 offset:16
    ds_read_b64_tr_b16 v[64:65], v249 offset:0
    ds_read_b64_tr_b16 v[68:69], v249 offset:64
    ds_read_b64_tr_b16 v[66:67], v249 offset:256
    ds_read_b64_tr_b16 v[70:71], v249 offset:320
    s_mov_b64 exec, s[54:55]
    ds_read_u16_d16_hi v242, v250 offset:0
    s_mov_b64 exec, -1
    v_fmac_f32 v198, v17, v113
    v_fmac_f32 v198, v18, v114
    v_fmac_f32 v198, v19, v115
    v_fmac_f32 v198, v20, v116
    v_fmac_f32 v198, v21, v117
    v_fmac_f32 v198, v22, v118
    v_fmac_f32 v198, v23, v119
    v_add_f32 v254, v202, v254
    v_mul_f32 v196, v24, v160
    v_fmac_f32 v196, v25, v161
    v_fmac_f32 v196, v26, v162
    v_fmac_f32 v196, v27, v163
    v_fmac_f32 v196, v28, v164
    v_fmac_f32 v196, v29, v165
    v_fmac_f32 v196, v30, v166
    v_fmac_f32 v196, v31, v167
    s_nop 1
    v_permlane32_swap_b32 v198, v196
    v_add_f32 v196, v198, v196
    v_mul_f32 v255, v32, v152
    v_fmac_f32 v255, v33, v153
    v_fmac_f32 v255, v34, v154
    v_fmac_f32 v255, v35, v155
    v_fmac_f32 v255, v36, v156
    v_fmac_f32 v255, v37, v157
    v_fmac_f32 v255, v38, v158
    v_fmac_f32 v255, v39, v159
    v_fma_f32 v203, v40, -v168, v203
    v_fma_f32 v203, v41, -v169, v203
    v_permlane32_swap_b32 v255, v201
    v_fma_f32 v203, v42, -v170, v203
    v_fma_f32 v203, v43, -v171, v203
    v_fma_f32 v203, v44, -v172, v203
    v_fma_f32 v203, v45, -v173, v203
    v_fma_f32 v203, v46, -v174, v203
    v_fma_f32 v203, v47, -v175, v203
    v_add_f32 v201, v255, v201
    v_fmac_f32 v199, v48, v120
    v_permlane32_swap_b32 v203, v255
    v_fmac_f32 v199, v49, v121
    v_fmac_f32 v199, v50, v122
    v_fmac_f32 v199, v51, v123
    v_fmac_f32 v199, v52, v124
    v_fmac_f32 v199, v53, v125
    v_fmac_f32 v199, v54, v126
    v_fmac_f32 v199, v55, v127
    v_add_f32 v255, v203, v255
    v_mul_f32 v197, v56, v168
    v_fmac_f32 v197, v57, v169
    v_fmac_f32 v197, v58, v170
    v_fmac_f32 v197, v59, v171
    v_fmac_f32 v197, v60, v172
    v_fmac_f32 v197, v61, v173
    v_fmac_f32 v197, v62, v174
    v_fmac_f32 v197, v63, v175
    s_nop 1
    v_permlane32_swap_b32 v199, v197
    v_add_f32 v197, v199, v197
    s_set_gpr_idx_on s51, gpr_idx(DST)
    s_nop 0
    v_cvt_pk_bf16_f32 v207, v200, v201
    v_cvt_pk_bf16_f32 v209, v254, v255
    v_cvt_pk_bf16_f32 v208, v196, v197
    s_set_gpr_idx_off
    s_add_u32 s50, s50, 1
    s_add_u32 s51, s51, 6
    s_cmp_ge_u32 s50, 4
    s_cbranch_scc1 LAST0
    s_waitcnt lgkmcnt(5)
    v_readfirstlane_b32 s66, v252
    s_add_u32 s53, s53, 1
    v_mov_b32 v252, s53
    s_cmp_le_u32 s53, s66
    ds_write2_b32 v251, v252, v252 offset0:0 offset1:8
    s_setprio 1
    s_cbranch_scc1 PRIO_10
    s_setprio 0
PRIO_10:
    s_cmp_eq_u32 s52, 4
    s_cbranch_scc1 ITEM_0_4
    s_cmp_eq_u32 s52, 5
    s_cbranch_scc1 ITEM_0_5
    s_cmp_eq_u32 s52, 3
    s_cbranch_scc1 ITEM_0_3
    s_cmp_eq_u32 s52, 6
    s_cbranch_scc1 ITEM_0_6
    s_cmp_eq_u32 s52, 8
    s_cbranch_scc1 ITEM_0_8
    s_branch ITEM_0_2
.p2align 6
ITEM_1_4:
    s_mov_b64 exec, s[54:55]
    ds_read_u16_d16_hi v243, v250 offset:128
    s_mov_b64 exec, -1
    ds_read_b64_tr_b16 v[72:73], v249 offset:512
    ds_read_b64_tr_b16 v[76:77], v249 offset:576
    ds_read_b64_tr_b16 v[74:75], v249 offset:768
    ds_read_b64_tr_b16 v[78:79], v249 offset:832
    s_waitcnt lgkmcnt(5)
    v_mul_f32_dpp v196, v242, v64 row_newbcast:0 row_mask:0xf bank_mask:0xf
    v_mul_f32_dpp v197, v242, v65 row_newbcast:1 row_mask:0xf bank_mask:0xf
    v_mul_f32_dpp v198, v242, v64 row_newbcast:8 row_mask:0xf bank_mask:0xf
    v_mul_f32_dpp v199, v242, v65 row_newbcast:9 row_mask:0xf bank_mask:0xf
    v_mul_f32_dpp v200, v242, v68 row_newbcast:2 row_mask:0xf bank_mask:0xf
    v_mul_f32_dpp v201, v242, v69 row_newbcast:3 row_mask:0xf bank_mask:0xf
    v_mul_f32_dpp v202, v242, v68 row_newbcast:10 row_mask:0xf bank_mask:0xf
    v_mul_f32_dpp v203, v242, v69 row_newbcast:11 row_mask:0xf bank_mask:0xf
    v_cvt_pk_bf16_f32 v64, v196, v197
    v_cvt_pk_bf16_f32 v68, v198, v199
    v_cvt_pk_bf16_f32 v65, v200, v201
    v_cvt_pk_bf16_f32 v69, v202, v203
    v_mul_f32_dpp v196, v242, v66 row_newbcast:4 row_mask:0xf bank_mask:0xf
    v_mul_f32_dpp v197, v242, v67 row_newbcast:5 row_mask:0xf bank_mask:0xf
    v_mul_f32_dpp v198, v242, v66 row_newbcast:12 row_mask:0xf bank_mask:0xf
    v_mul_f32_dpp v199, v242, v67 row_newbcast:13 row_mask:0xf bank_mask:0xf
    v_mul_f32_dpp v200, v242, v70 row_newbcast:6 row_mask:0xf bank_mask:0xf
    v_mul_f32_dpp v201, v242, v71 row_newbcast:7 row_mask:0xf bank_mask:0xf
    v_mul_f32_dpp v202, v242, v70 row_newbcast:14 row_mask:0xf bank_mask:0xf
    v_mul_f32_dpp v203, v242, v71 row_newbcast:15 row_mask:0xf bank_mask:0xf
    v_cvt_pk_bf16_f32 v66, v196, v197
    v_cvt_pk_bf16_f32 v70, v198, v199
    v_cvt_pk_bf16_f32 v67, v200, v201
    v_cvt_pk_bf16_f32 v71, v202, v203
    s_nop 0
    s_waitcnt vmcnt(4) lgkmcnt(0)
    v_mfma_f32_32x32x16_bf16 v[0:15], v[64:67], v[176:179], 0
    v_mul_f32_dpp v196, v243, v72 row_newbcast:0 row_mask:0xf bank_mask:0xf
    v_mul_f32_dpp v197, v243, v73 row_newbcast:1 row_mask:0xf bank_mask:0xf
    v_mul_f32_dpp v198, v243, v72 row_newbcast:8 row_mask:0xf bank_mask:0xf
    v_mul_f32_dpp v199, v243, v73 row_newbcast:9 row_mask:0xf bank_mask:0xf
    v_mul_f32_dpp v200, v243, v76 row_newbcast:2 row_mask:0xf bank_mask:0xf
    v_mul_f32_dpp v201, v243, v77 row_newbcast:3 row_mask:0xf bank_mask:0xf
    v_mul_f32_dpp v202, v243, v76 row_newbcast:10 row_mask:0xf bank_mask:0xf
    v_mul_f32_dpp v203, v243, v77 row_newbcast:11 row_mask:0xf bank_mask:0xf
    v_cvt_pk_bf16_f32 v72, v196, v197
    v_cvt_pk_bf16_f32 v76, v198, v199
    v_cvt_pk_bf16_f32 v73, v200, v201
    v_cvt_pk_bf16_f32 v77, v202, v203
    s_add_u32 m0, s21, 0
    v_mfma_f32_32x32x16_bf16 v[16:31], v[68:71], v[176:179], 0
    buffer_load_dwordx4 v234, s[4:7], s36 offen lds
    buffer_load_dwordx4 v235, s[8:11], s36 offen offset:1024 lds
    ds_read_b64_tr_b16 v[176:177], v244 offset:2048
    ds_read_b64_tr_b16 v[178:179], v244 offset:3072
    ds_read_b64_tr_b16 v[184:185], v245 offset:2048
    ds_read_b64_tr_b16 v[186:187], v245 offset:3072
    v_mul_f32_dpp v196, v243, v74 row_newbcast:4 row_mask:0xf bank_mask:0xf
    v_mul_f32_dpp v197, v243, v75 row_newbcast:5 row_mask:0xf bank_mask:0xf
    v_mul_f32_dpp v198, v243, v74 row_newbcast:12 row_mask:0xf bank_mask:0xf
    v_mul_f32_dpp v199, v243, v75 row_newbcast:13 row_mask:0xf bank_mask:0xf
    v_mul_f32_dpp v200, v243, v78 row_newbcast:6 row_mask:0xf bank_mask:0xf
    v_mul_f32_dpp v201, v243, v79 row_newbcast:7 row_mask:0xf bank_mask:0xf
    v_mul_f32_dpp v202, v243, v78 row_newbcast:14 row_mask:0xf bank_mask:0xf
    v_mul_f32_dpp v203, v243, v79 row_newbcast:15 row_mask:0xf bank_mask:0xf
    v_cvt_pk_bf16_f32 v74, v196, v197
    v_cvt_pk_bf16_f32 v78, v198, v199
    v_cvt_pk_bf16_f32 v75, v200, v201
    v_cvt_pk_bf16_f32 v79, v202, v203
    s_nop 0
    s_waitcnt lgkmcnt(0)
    v_mfma_f32_32x32x16_bf16 v[0:15], v[72:75], v[176:179], v[0:15]
    s_add_u32 m0, s21, 2048
    v_mfma_f32_32x32x16_bf16 v[16:31], v[76:79], v[176:179], v[16:31]
    buffer_load_dwordx4 v236, s[4:7], s36 offen lds
    buffer_load_dwordx4 v237, s[8:11], s36 offen offset:1024 lds
    s_mov_b32 m0, s50
    s_nop 0
    s_movrels_b32 s71, s23
    s_movrels_b32 s33, s28
    s_and_b32 s70, s33, 0x70
    s_andn2_b32 s33, s33, 0x70
    v_xor_b32 v253, s70, v248
    v_add_u32 v253, s33, v253
    s_bfe_u32 s46, s71, 0x30012
    s_mov_b32 m0, s46
    s_and_b32 s66, s71, 0x3ffff
    s_movrels_b32 s68, s57
    s_movrels_b32 s69, s61
    s_sub_u32 s48, s66, s47
    s_mov_b32 s47, s66
    s_lshr_b32 s52, s71, 28
    s_lshl_b32 s67, s46, 9
    s_add_u32 s66, s66, s67
    s_sub_u32 s49, s66, s42
    s_mov_b32 s42, s66
    s_bfe_u32 s66, s68, 655360
    s_add_u32 s43, s42, s66
    s_bfe_u32 s39, s69, 655360
    s_bfe_u32 s66, s68, 655370
    s_add_u32 s44, s42, s66
    s_bfe_u32 s40, s69, 655370
    s_bfe_u32 s66, s68, 655380
    s_add_u32 s45, s42, s66
    s_bfe_u32 s41, s69, 655380
    v_add_u32 v252, s44, v247
    ds_read_u16 v238, v252
    ds_read_u16 v239, v252 offset:64
    v_add_u32 v252, s45, v247
    ds_read_u16 v240, v252
    ds_read_u16 v241, v252 offset:64
    v_mfma_f32_32x32x16_bf16 v[32:47], v[64:67], v[180:183], 0
    v_mul_f32 v196, v0, v96
    v_fmac_f32 v196, v1, v97
    v_fmac_f32 v196, v2, v98
    v_fmac_f32 v196, v3, v99
    v_fmac_f32 v196, v4, v100
    v_fmac_f32 v196, v5, v101
    v_fmac_f32 v196, v6, v102
    v_fmac_f32 v196, v7, v103
    v_mul_f32 v198, v8, v128
    v_fmac_f32 v198, v9, v129
    v_mfma_f32_32x32x16_bf16 v[48:63], v[68:71], v[180:183], 0
    s_waitcnt vmcnt(6)
    ds_read_b64_tr_b16 v[176:177], v244 offset:4096
    ds_read_b64_tr_b16 v[178:179], v244 offset:5120
    ds_read_b64_tr_b16 v[180:181], v245 offset:4096
    ds_read_b64_tr_b16 v[182:183], v245 offset:5120
    v_fmac_f32 v198, v10, v130
    v_fmac_f32 v198, v11, v131
    v_fmac_f32 v198, v12, v132
    v_fmac_f32 v198, v13, v133
    v_fmac_f32 v198, v14, v134
    v_fmac_f32 v198, v15, v135
    v_mul_f32 v200, v16, v128
    v_fmac_f32 v200, v17, v129
    v_permlane32_swap_b32 v196, v198
    v_mfma_f32_32x32x16_bf16 v[32:47], v[72:75], v[184:187], v[32:47]
    v_fmac_f32 v200, v18, v130
    v_fmac_f32 v200, v19, v131
    v_fmac_f32 v200, v20, v132
    v_fmac_f32 v200, v21, v133
    v_fmac_f32 v200, v22, v134
    v_fmac_f32 v200, v23, v135
    v_add_f32 v198, v196, v198
    v_mul_f32_e64 v202, v24, -v128
    v_fma_f32 v202, v25, -v129, v202
    v_mfma_f32_32x32x16_bf16 v[48:63], v[76:79], v[184:187], v[48:63]
    v_fma_f32 v202, v26, -v130, v202
    v_fma_f32 v202, v27, -v131, v202
    v_fma_f32 v202, v28, -v132, v202
    v_fma_f32 v202, v29, -v133, v202
    v_fma_f32 v202, v30, -v134, v202
    v_fma_f32 v202, v31, -v135, v202
    s_nop 1
    v_permlane32_swap_b32 v200, v202
    v_add_f32 v202, v200, v202
    s_waitcnt vmcnt(4) lgkmcnt(0)
    v_mfma_f32_32x32x16_bf16 v[0:15], v[64:67], v[176:179], 0
    v_mul_f32 v197, v32, v104
    v_fmac_f32 v197, v33, v105
    v_fmac_f32 v197, v34, v106
    v_fmac_f32 v197, v35, v107
    v_fmac_f32 v197, v36, v108
    v_fmac_f32 v197, v37, v109
    v_fmac_f32 v197, v38, v110
    v_fmac_f32 v197, v39, v111
    v_mul_f32 v199, v40, v136
    v_fmac_f32 v199, v41, v137
    s_add_u32 m0, s21, 4096
    v_mfma_f32_32x32x16_bf16 v[16:31], v[68:71], v[176:179], 0
    buffer_load_dwordx4 v234, s[4:7], s37 offen lds
    buffer_load_dwordx4 v235, s[8:11], s37 offen offset:1024 lds
    ds_read_b64_tr_b16 v[176:177], v244 offset:6144
    ds_read_b64_tr_b16 v[178:179], v244 offset:7168
    ds_read_b64_tr_b16 v[184:185], v245 offset:6144
    ds_read_b64_tr_b16 v[186:187], v245 offset:7168
    v_add_u32 v252, s42, v247
    ds_read_u16 v234, v252
    ds_read_u16 v235, v252 offset:64
    v_fmac_f32 v199, v42, v138
    v_fmac_f32 v199, v43, v139
    v_fmac_f32 v199, v44, v140
    v_fmac_f32 v199, v45, v141
    v_fmac_f32 v199, v46, v142
    v_fmac_f32 v199, v47, v143
    v_mul_f32 v201, v48, v136
    v_fmac_f32 v201, v49, v137
    v_permlane32_swap_b32 v197, v199
    v_fmac_f32 v201, v50, v138
    s_waitcnt lgkmcnt(2)
    v_mfma_f32_32x32x16_bf16 v[0:15], v[72:75], v[176:179], v[0:15]
    v_fmac_f32 v201, v51, v139
    v_fmac_f32 v201, v52, v140
    v_fmac_f32 v201, v53, v141
    v_fmac_f32 v201, v54, v142
    v_fmac_f32 v201, v55, v143
    v_add_f32 v199, v197, v199
    v_mul_f32_e64 v203, v56, -v136
    v_fma_f32 v203, v57, -v137, v203
    v_fma_f32 v203, v58, -v138, v203
    v_fma_f32 v203, v59, -v139, v203
    s_add_u32 m0, s21, 6144
    v_mfma_f32_32x32x16_bf16 v[16:31], v[76:79], v[176:179], v[16:31]
    buffer_load_dwordx4 v236, s[4:7], s37 offen lds
    buffer_load_dwordx4 v237, s[8:11], s37 offen offset:1024 lds
    v_add_u32 v252, s43, v247
    ds_read_u16 v236, v252
    ds_read_u16 v237, v252 offset:64
    v_fma_f32 v203, v60, -v140, v203
    v_fma_f32 v203, v61, -v141, v203
    v_fma_f32 v203, v62, -v142, v203
    v_fma_f32 v203, v63, -v143, v203
    s_nop 1
    v_permlane32_swap_b32 v201, v203
    v_add_f32 v203, v201, v203
    v_cvt_pk_bf16_f32 v198, v198, v199
    v_cvt_pk_bf16_f32 v202, v202, v203
    ds_write2st64_b32 v253, v198, v202 offset0:0 offset1:1
    v_mfma_f32_32x32x16_bf16 v[32:47], v[64:67], v[180:183], 0
    v_mul_f32 v196, v0, v144
    v_fmac_f32 v196, v1, v145
    v_fmac_f32 v196, v2, v146
    v_fmac_f32 v196, v3, v147
    v_fmac_f32 v196, v4, v148
    v_fmac_f32 v196, v5, v149
    v_fmac_f32 v196, v6, v150
    v_fmac_f32 v196, v7, v151
    v_mfma_f32_32x32x16_bf16 v[48:63], v[68:71], v[180:183], 0
    s_waitcnt vmcnt(6)
    ds_read_b64_tr_b16 v[176:177], v244 offset:0
    ds_read_b64_tr_b16 v[178:179], v244 offset:1024
    ds_read_b64_tr_b16 v[180:181], v245 offset:0
    ds_read_b64_tr_b16 v[182:183], v245 offset:1024
    v_mul_f32 v198, v8, v112
    v_fmac_f32 v198, v9, v113
    v_fmac_f32 v198, v10, v114
    v_fmac_f32 v198, v11, v115
    v_fmac_f32 v198, v12, v116
    v_fmac_f32 v198, v13, v117
    v_fmac_f32 v198, v14, v118
    v_fmac_f32 v198, v15, v119
    v_mfma_f32_32x32x16_bf16 v[32:47], v[72:75], v[184:187], v[32:47]
    v_mul_f32_e64 v200, v16, -v160
    v_fma_f32 v200, v17, -v161, v200
    v_fma_f32 v200, v18, -v162, v200
    v_fma_f32 v200, v19, -v163, v200
    v_fma_f32 v200, v20, -v164, v200
    v_fma_f32 v200, v21, -v165, v200
    v_fma_f32 v200, v22, -v166, v200
    v_fma_f32 v200, v23, -v167, v200
    v_mfma_f32_32x32x16_bf16 v[48:63], v[76:79], v[184:187], v[48:63]
    v_mul_f32_e64 v202, v24, -v160
    v_fma_f32 v202, v25, -v161, v202
    v_fma_f32 v202, v26, -v162, v202
    v_fma_f32 v202, v27, -v163, v202
    v_fma_f32 v202, v28, -v164, v202
    v_fma_f32 v202, v29, -v165, v202
    v_fma_f32 v202, v30, -v166, v202
    v_fma_f32 v202, v31, -v167, v202
    s_waitcnt vmcnt(4) lgkmcnt(0)
    v_mfma_f32_32x32x16_bf16 v[0:15], v[64:67], v[176:179], 0
    v_mul_f32 v197, v32, v152
    v_fmac_f32 v197, v33, v153
    v_fmac_f32 v197, v34, v154
    v_fmac_f32 v197, v35, v155
    v_fmac_f32 v197, v36, v156
    v_fmac_f32 v197, v37, v157
    v_fmac_f32 v197, v38, v158
    v_fmac_f32 v197, v39, v159
    s_add_u32 m0, s21, 0
    v_mfma_f32_32x32x16_bf16 v[16:31], v[68:71], v[176:179], 0
    v_lshl_add_u32 v234, v234, 10, v246
    v_lshl_add_u32 v235, v235, 10, v246
    buffer_load_dwordx4 v234, s[4:7], s38 offen lds
    buffer_load_dwordx4 v235, s[8:11], s38 offen offset:1024 lds
    ds_read_b64_tr_b16 v[176:177], v244 offset:2048
    ds_read_b64_tr_b16 v[178:179], v244 offset:3072
    ds_read_b64_tr_b16 v[184:185], v245 offset:2048
    ds_read_b64_tr_b16 v[186:187], v245 offset:3072
    v_mul_f32 v199, v40, v120
    v_fmac_f32 v199, v41, v121
    v_fmac_f32 v199, v42, v122
    v_fmac_f32 v199, v43, v123
    v_fmac_f32 v199, v44, v124
    v_fmac_f32 v199, v45, v125
    v_fmac_f32 v199, v46, v126
    v_fmac_f32 v199, v47, v127
    s_waitcnt lgkmcnt(0)
    v_mfma_f32_32x32x16_bf16 v[0:15], v[72:75], v[176:179], v[0:15]
    v_mul_f32_e64 v201, v48, -v168
    v_fma_f32 v201, v49, -v169, v201
    v_fma_f32 v201, v50, -v170, v201
    v_fma_f32 v201, v51, -v171, v201
    v_fma_f32 v201, v52, -v172, v201
    v_fma_f32 v201, v53, -v173, v201
    v_fma_f32 v201, v54, -v174, v201
    v_fma_f32 v201, v55, -v175, v201
    s_add_u32 m0, s21, 2048
    v_mfma_f32_32x32x16_bf16 v[16:31], v[76:79], v[176:179], v[16:31]
    v_lshl_add_u32 v236, v236, 10, v246
    v_lshl_add_u32 v237, v237, 10, v246
    buffer_load_dwordx4 v236, s[4:7], s39 offen lds
    buffer_load_dwordx4 v237, s[8:11], s39 offen offset:1024 lds
    v_mul_f32_e64 v203, v56, -v168
    v_fma_f32 v203, v57, -v169, v203
    v_fma_f32 v203, v58, -v170, v203
    v_fma_f32 v203, v59, -v171, v203
    v_fma_f32 v203, v60, -v172, v203
    v_fma_f32 v203, v61, -v173, v203
    v_fma_f32 v203, v62, -v174, v203
    v_fma_f32 v203, v63, -v175, v203
    v_mfma_f32_32x32x16_bf16 v[32:47], v[64:67], v[180:183], 0
    v_mul_f32 v254, v0, v144
    v_fmac_f32 v254, v1, v145
    v_fmac_f32 v254, v2, v146
    v_fmac_f32 v254, v3, v147
    v_fmac_f32 v254, v4, v148
    v_mfma_f32_32x32x16_bf16 v[48:63], v[68:71], v[180:183], 0
    ds_swizzle_b32 v68, v68 offset:0x401F
    ds_swizzle_b32 v69, v69 offset:0x401F
    ds_swizzle_b32 v70, v70 offset:0x401F
    ds_swizzle_b32 v71, v71 offset:0x401F
    s_waitcnt vmcnt(6)
    ds_read_b64_tr_b16 v[176:177], v244 offset:4096
    ds_read_b64_tr_b16 v[178:179], v244 offset:5120
    ds_read_b64_tr_b16 v[180:181], v245 offset:4096
    ds_read_b64_tr_b16 v[182:183], v245 offset:5120
    v_fmac_f32 v254, v5, v149
    v_fmac_f32 v254, v6, v150
    v_fmac_f32 v254, v7, v151
    v_fmac_f32 v200, v8, v160
    v_mfma_f32_32x32x16_bf16 v[32:47], v[72:75], v[184:187], v[32:47]
    v_fmac_f32 v200, v9, v161
    v_permlane32_swap_b32 v196, v254
    v_fmac_f32 v200, v10, v162
    v_fmac_f32 v200, v11, v163
    v_fmac_f32 v200, v12, v164
    v_mfma_f32_32x32x16_bf16 v[48:63], v[76:79], v[184:187], v[48:63]
    ds_swizzle_b32 v76, v76 offset:0x401F
    ds_swizzle_b32 v77, v77 offset:0x401F
    ds_swizzle_b32 v78, v78 offset:0x401F
    ds_swizzle_b32 v79, v79 offset:0x401F
    v_fmac_f32 v200, v13, v165
    v_fmac_f32 v200, v14, v166
    v_fmac_f32 v200, v15, v167
    v_add_f32 v254, v196, v254
    s_waitcnt lgkmcnt(8)
    s_mov_b64 exec, s[56:57]
    v_xor_b32 v68, 0x80008000, v68
    v_xor_b32 v69, 0x80008000, v69
    v_xor_b32 v70, 0x80008000, v70
    v_xor_b32 v71, 0x80008000, v71
    s_mov_b64 exec, -1
    s_waitcnt vmcnt(4) lgkmcnt(4)
    v_mfma_f32_32x32x16_bf16 v[0:15], v[64:67], v[176:179], 0
    v_mul_f32 v255, v32, v152
    v_fmac_f32 v255, v33, v153
    v_fmac_f32 v255, v34, v154
    v_fmac_f32 v255, v35, v155
    v_fmac_f32 v255, v36, v156
    s_add_u32 m0, s21, 4096
    v_mfma_f32_32x32x16_bf16 v[16:31], v[68:71], v[176:179], v[16:31]
    v_lshl_add_u32 v238, v238, 10, v246
    v_lshl_add_u32 v239, v239, 10, v246
    buffer_load_dwordx4 v238, s[4:7], s40 offen lds
    buffer_load_dwordx4 v239, s[8:11], s40 offen offset:1024 lds
    ds_read_b64_tr_b16 v[176:177], v244 offset:6144
    ds_read_b64_tr_b16 v[178:179], v244 offset:7168
    ds_read_b64_tr_b16 v[184:185], v245 offset:6144
    ds_read_b64_tr_b16 v[186:187], v245 offset:7168
    v_fmac_f32 v255, v37, v157
    v_fmac_f32 v255, v38, v158
    v_fmac_f32 v255, v39, v159
    v_fmac_f32 v201, v40, v168
    v_fmac_f32 v201, v41, v169
    s_waitcnt lgkmcnt(0)
    s_mov_b64 exec, s[56:57]
    v_xor_b32 v76, 0x80008000, v76
    v_xor_b32 v77, 0x80008000, v77
    v_xor_b32 v78, 0x80008000, v78
    v_xor_b32 v79, 0x80008000, v79
    s_mov_b64 exec, -1
    v_mfma_f32_32x32x16_bf16 v[0:15], v[72:75], v[176:179], v[0:15]
    v_permlane32_swap_b32 v197, v255
    v_fmac_f32 v201, v42, v170
    v_fmac_f32 v201, v43, v171
    v_fmac_f32 v201, v44, v172
    v_fmac_f32 v201, v45, v173
    s_add_u32 m0, s21, 6144
    v_mfma_f32_32x32x16_bf16 v[16:31], v[76:79], v[176:179], v[16:31]
    v_lshl_add_u32 v240, v240, 10, v246
    v_lshl_add_u32 v241, v241, 10, v246
    buffer_load_dwordx4 v240, s[4:7], s41 offen lds
    buffer_load_dwordx4 v241, s[8:11], s41 offen offset:1024 lds
    v_fmac_f32 v201, v46, v174
    v_fmac_f32 v201, v47, v175
    v_add_f32 v255, v197, v255
    v_cvt_pk_bf16_f32 v254, v254, v255
    ds_write_b32 v253, v254 offset:512
    v_mfma_f32_32x32x16_bf16 v[32:47], v[64:67], v[180:183], 0
    v_mul_f32 v254, v0, v144
    v_fmac_f32 v254, v1, v145
    v_fmac_f32 v254, v2, v146
    v_fmac_f32 v254, v3, v147
    v_fmac_f32 v254, v4, v148
    v_fmac_f32 v254, v5, v149
    v_fmac_f32 v254, v6, v150
    v_fmac_f32 v254, v7, v151
    v_fma_f32 v202, v8, -v160, v202
    v_fma_f32 v202, v9, -v161, v202
    v_mfma_f32_32x32x16_bf16 v[48:63], v[68:71], v[180:183], v[48:63]
    s_waitcnt vmcnt(6)
    ds_read_b64_tr_b16 v[176:177], v244 offset:0
    ds_read_b64_tr_b16 v[178:179], v244 offset:1024
    ds_read_b64_tr_b16 v[180:181], v245 offset:0
    ds_read_b64_tr_b16 v[182:183], v245 offset:1024
    v_permlane32_swap_b32 v254, v200
    v_fma_f32 v202, v10, -v162, v202
    v_fma_f32 v202, v11, -v163, v202
    v_fma_f32 v202, v12, -v164, v202
    v_fma_f32 v202, v13, -v165, v202
    v_fma_f32 v202, v14, -v166, v202
    v_fma_f32 v202, v15, -v167, v202
    v_add_f32 v200, v254, v200
    v_fmac_f32 v198, v16, v112
    v_permlane32_swap_b32 v202, v254
    v_mfma_f32_32x32x16_bf16 v[32:47], v[72:75], v[184:187], v[32:47]
    v_fmac_f32 v198, v17, v113
    v_fmac_f32 v198, v18, v114
    v_fmac_f32 v198, v19, v115
    v_fmac_f32 v198, v20, v116
    v_fmac_f32 v198, v21, v117
    v_fmac_f32 v198, v22, v118
    v_fmac_f32 v198, v23, v119
    v_add_f32 v254, v202, v254
    v_mul_f32 v196, v24, v160
    v_fmac_f32 v196, v25, v161
    v_mfma_f32_32x32x16_bf16 v[48:63], v[76:79], v[184:187], v[48:63]
    v_add_u32 v249, s48, v249
    v_add_u32 v250, s49, v250
    ds_read_b32 v252, v251 offset:16
    ds_read_b64_tr_b16 v[64:65], v249 offset:0
    ds_read_b64_tr_b16 v[68:69], v249 offset:64
    ds_read_b64_tr_b16 v[66:67], v249 offset:256
    ds_read_b64_tr_b16 v[70:71], v249 offset:320
    s_mov_b64 exec, s[54:55]
    ds_read_u16_d16_hi v242, v250 offset:0
    s_mov_b64 exec, -1
    v_fmac_f32 v196, v26, v162
    v_fmac_f32 v196, v27, v163
    v_fmac_f32 v196, v28, v164
    v_fmac_f32 v196, v29, v165
    v_fmac_f32 v196, v30, v166
    v_fmac_f32 v196, v31, v167
    s_nop 1
    v_permlane32_swap_b32 v198, v196
    v_add_f32 v196, v198, v196
    v_mul_f32 v255, v32, v152
    v_fmac_f32 v255, v33, v153
    v_fmac_f32 v255, v34, v154
    v_fmac_f32 v255, v35, v155
    v_fmac_f32 v255, v36, v156
    v_fmac_f32 v255, v37, v157
    v_fmac_f32 v255, v38, v158
    v_fmac_f32 v255, v39, v159
    v_fma_f32 v203, v40, -v168, v203
    v_fma_f32 v203, v41, -v169, v203
    v_permlane32_swap_b32 v255, v201
    v_fma_f32 v203, v42, -v170, v203
    v_fma_f32 v203, v43, -v171, v203
    v_fma_f32 v203, v44, -v172, v203
    v_fma_f32 v203, v45, -v173, v203
    v_fma_f32 v203, v46, -v174, v203
    v_fma_f32 v203, v47, -v175, v203
    v_add_f32 v201, v255, v201
    v_fmac_f32 v199, v48, v120
    v_permlane32_swap_b32 v203, v255
    v_fmac_f32 v199, v49, v121
    v_fmac_f32 v199, v50, v122
    v_fmac_f32 v199, v51, v123
    v_fmac_f32 v199, v52, v124
    v_fmac_f32 v199, v53, v125
    v_fmac_f32 v199, v54, v126
    v_fmac_f32 v199, v55, v127
    v_add_f32 v255, v203, v255
    v_mul_f32 v197, v56, v168
    v_fmac_f32 v197, v57, v169
    v_fmac_f32 v197, v58, v170
    v_fmac_f32 v197, v59, v171
    v_fmac_f32 v197, v60, v172
    v_fmac_f32 v197, v61, v173
    v_fmac_f32 v197, v62, v174
    v_fmac_f32 v197, v63, v175
    s_nop 1
    v_permlane32_swap_b32 v199, v197
    v_add_f32 v197, v199, v197
    v_cvt_pk_bf16_f32 v200, v200, v201
    v_cvt_pk_bf16_f32 v254, v254, v255
    v_cvt_pk_bf16_f32 v196, v196, v197
    ds_write2st64_b32 v253, v200, v196 offset0:3 offset1:4
    s_mov_b64 exec, 0xffffffff
    ds_write_b32 v253, v254 offset:1280
    s_mov_b64 exec, -1
    s_add_u32 s50, s50, 1
    s_cmp_ge_u32 s50, 4
    s_cbranch_scc1 LAST1
    s_waitcnt lgkmcnt(7)
    v_readfirstlane_b32 s66, v252
    s_add_u32 s53, s53, 1
    v_mov_b32 v252, s53
    s_cmp_le_u32 s53, s66
    ds_write2_b32 v251, v252, v252 offset0:0 offset1:8
    s_setprio 1
    s_cbranch_scc1 PRIO_11
    s_setprio 0
PRIO_11:
    s_cmp_eq_u32 s52, 4
    s_cbranch_scc1 ITEM_1_4
    s_cmp_eq_u32 s52, 5
    s_cbranch_scc1 ITEM_1_5
    s_cmp_eq_u32 s52, 3
    s_cbranch_scc1 ITEM_1_3
    s_cmp_eq_u32 s52, 6
    s_cbranch_scc1 ITEM_1_6
    s_cmp_eq_u32 s52, 8
    s_cbranch_scc1 ITEM_1_8
    s_branch ITEM_1_2
.p2align 6
ITEM_1_5:
    s_mov_b64 exec, s[54:55]
    ds_read_u16_d16_hi v243, v250 offset:128
    s_mov_b64 exec, -1
    ds_read_b64_tr_b16 v[72:73], v249 offset:512
    ds_read_b64_tr_b16 v[76:77], v249 offset:576
    ds_read_b64_tr_b16 v[74:75], v249 offset:768
    ds_read_b64_tr_b16 v[78:79], v249 offset:832
    ds_read_b64_tr_b16 v[80:81], v249 offset:1024
    ds_read_b64_tr_b16 v[84:85], v249 offset:1088
    s_waitcnt lgkmcnt(7)
    v_mul_f32_dpp v196, v242, v64 row_newbcast:0 row_mask:0xf bank_mask:0xf
    v_mul_f32_dpp v197, v242, v65 row_newbcast:1 row_mask:0xf bank_mask:0xf
    v_mul_f32_dpp v198, v242, v64 row_newbcast:8 row_mask:0xf bank_mask:0xf
    v_mul_f32_dpp v199, v242, v65 row_newbcast:9 row_mask:0xf bank_mask:0xf
    v_mul_f32_dpp v200, v242, v68 row_newbcast:2 row_mask:0xf bank_mask:0xf
    v_mul_f32_dpp v201, v242, v69 row_newbcast:3 row_mask:0xf bank_mask:0xf
    v_mul_f32_dpp v202, v242, v68 row_newbcast:10 row_mask:0xf bank_mask:0xf
    v_mul_f32_dpp v203, v242, v69 row_newbcast:11 row_mask:0xf bank_mask:0xf
    v_cvt_pk_bf16_f32 v64, v196, v197
    v_cvt_pk_bf16_f32 v68, v198, v199
    v_cvt_pk_bf16_f32 v65, v200, v201
    v_cvt_pk_bf16_f32 v69, v202, v203
    v_mul_f32_dpp v196, v242, v66 row_newbcast:4 row_mask:0xf bank_mask:0xf
    v_mul_f32_dpp v197, v242, v67 row_newbcast:5 row_mask:0xf bank_mask:0xf
    v_mul_f32_dpp v198, v242, v66 row_newbcast:12 row_mask:0xf bank_mask:0xf
    v_mul_f32_dpp v199, v242, v67 row_newbcast:13 row_mask:0xf bank_mask:0xf
    v_mul_f32_dpp v200, v242, v70 row_newbcast:6 row_mask:0xf bank_mask:0xf
    v_mul_f32_dpp v201, v242, v71 row_newbcast:7 row_mask:0xf bank_mask:0xf
    v_mul_f32_dpp v202, v242, v70 row_newbcast:14 row_mask:0xf bank_mask:0xf
    v_mul_f32_dpp v203, v242, v71 row_newbcast:15 row_mask:0xf bank_mask:0xf
    v_cvt_pk_bf16_f32 v66, v196, v197
    v_cvt_pk_bf16_f32 v70, v198, v199
    v_cvt_pk_bf16_f32 v67, v200, v201
    v_cvt_pk_bf16_f32 v71, v202, v203
    s_mov_b64 exec, s[54:55]
    ds_read_u16_d16_hi v242, v250 offset:256
    s_mov_b64 exec, -1
    s_waitcnt vmcnt(4) lgkmcnt(3)
    v_mfma_f32_32x32x16_bf16 v[0:15], v[64:67], v[176:179], 0
    v_mul_f32_dpp v196, v243, v72 row_newbcast:0 row_mask:0xf bank_mask:0xf
    v_mul_f32_dpp v197, v243, v73 row_newbcast:1 row_mask:0xf bank_mask:0xf
    v_mul_f32_dpp v198, v243, v72 row_newbcast:8 row_mask:0xf bank_mask:0xf
    v_mul_f32_dpp v199, v243, v73 row_newbcast:9 row_mask:0xf bank_mask:0xf
    v_mul_f32_dpp v200, v243, v76 row_newbcast:2 row_mask:0xf bank_mask:0xf
    v_mul_f32_dpp v201, v243, v77 row_newbcast:3 row_mask:0xf bank_mask:0xf
    v_mul_f32_dpp v202, v243, v76 row_newbcast:10 row_mask:0xf bank_mask:0xf
    v_mul_f32_dpp v203, v243, v77 row_newbcast:11 row_mask:0xf bank_mask:0xf
    v_cvt_pk_bf16_f32 v72, v196, v197
    v_cvt_pk_bf16_f32 v76, v198, v199
    v_cvt_pk_bf16_f32 v73, v200, v201
    v_cvt_pk_bf16_f32 v77, v202, v203
    s_add_u32 m0, s21, 0
    v_mfma_f32_32x32x16_bf16 v[16:31], v[68:71], v[176:179], 0
    buffer_load_dwordx4 v236, s[4:7], s35 offen lds
    buffer_load_dwordx4 v237, s[8:11], s35 offen offset:1024 lds
    ds_read_b64_tr_b16 v[176:177], v244 offset:2048
    ds_read_b64_tr_b16 v[178:179], v244 offset:3072
    ds_read_b64_tr_b16 v[184:185], v245 offset:2048
    ds_read_b64_tr_b16 v[186:187], v245 offset:3072
    v_mul_f32_dpp v196, v243, v74 row_newbcast:4 row_mask:0xf bank_mask:0xf
    v_mul_f32_dpp v197, v243, v75 row_newbcast:5 row_mask:0xf bank_mask:0xf
    v_mul_f32_dpp v198, v243, v74 row_newbcast:12 row_mask:0xf bank_mask:0xf
    v_mul_f32_dpp v199, v243, v75 row_newbcast:13 row_mask:0xf bank_mask:0xf
    v_mul_f32_dpp v200, v243, v78 row_newbcast:6 row_mask:0xf bank_mask:0xf
    v_mul_f32_dpp v201, v243, v79 row_newbcast:7 row_mask:0xf bank_mask:0xf
    v_mul_f32_dpp v202, v243, v78 row_newbcast:14 row_mask:0xf bank_mask:0xf
    v_mul_f32_dpp v203, v243, v79 row_newbcast:15 row_mask:0xf bank_mask:0xf
    v_cvt_pk_bf16_f32 v74, v196, v197
    v_cvt_pk_bf16_f32 v78, v198, v199
    v_cvt_pk_bf16_f32 v75, v200, v201
    v_cvt_pk_bf16_f32 v79, v202, v203
    s_nop 0
    s_waitcnt vmcnt(4) lgkmcnt(0)
    v_mfma_f32_32x32x16_bf16 v[0:15], v[72:75], v[176:179], v[0:15]
    v_mul_f32_dpp v196, v242, v80 row_newbcast:0 row_mask:0xf bank_mask:0xf
    v_mul_f32_dpp v197, v242, v81 row_newbcast:1 row_mask:0xf bank_mask:0xf
    v_mul_f32_dpp v198, v242, v80 row_newbcast:8 row_mask:0xf bank_mask:0xf
    v_mul_f32_dpp v199, v242, v81 row_newbcast:9 row_mask:0xf bank_mask:0xf
    v_mul_f32_dpp v200, v242, v84 row_newbcast:2 row_mask:0xf bank_mask:0xf
    v_mul_f32_dpp v201, v242, v85 row_newbcast:3 row_mask:0xf bank_mask:0xf
    s_add_u32 m0, s21, 2048
    v_mfma_f32_32x32x16_bf16 v[16:31], v[76:79], v[176:179], v[16:31]
    buffer_load_dwordx4 v238, s[4:7], s35 offen lds
    ds_read_b64_tr_b16 v[176:177], v244 offset:4096
    ds_read_b64_tr_b16 v[188:189], v245 offset:4096
    v_mul_f32_dpp v202, v242, v84 row_newbcast:10 row_mask:0xf bank_mask:0xf
    v_mul_f32_dpp v203, v242, v85 row_newbcast:11 row_mask:0xf bank_mask:0xf
    v_cvt_pk_bf16_f32 v80, v196, v197
    v_cvt_pk_bf16_f32 v84, v198, v199
    v_cvt_pk_bf16_f32 v81, v200, v201
    v_cvt_pk_bf16_f32 v85, v202, v203
    s_nop 0
    s_waitcnt lgkmcnt(0)
    v_mfma_f32_32x32x8_bf16 v[0:15], v[80:81], v[176:177], v[0:15]
    s_add_u32 m0, s21, 4096
    v_mfma_f32_32x32x8_bf16 v[16:31], v[84:85], v[176:177], v[16:31]
    buffer_load_dwordx4 v234, s[4:7], s36 offen lds
    buffer_load_dwordx4 v235, s[8:11], s36 offen offset:1024 lds
    s_mov_b32 m0, s50
    s_nop 0
    s_movrels_b32 s71, s23
    s_movrels_b32 s33, s28
    s_and_b32 s70, s33, 0x70
    s_andn2_b32 s33, s33, 0x70
    v_xor_b32 v253, s70, v248
    v_add_u32 v253, s33, v253
    s_bfe_u32 s46, s71, 0x30012
    s_mov_b32 m0, s46
    s_and_b32 s66, s71, 0x3ffff
    s_movrels_b32 s68, s57
    s_movrels_b32 s69, s61
    s_sub_u32 s48, s66, s47
    s_mov_b32 s47, s66
    s_lshr_b32 s52, s71, 28
    s_lshl_b32 s67, s46, 9
    s_add_u32 s66, s66, s67
    s_sub_u32 s49, s66, s42
    s_mov_b32 s42, s66
    s_bfe_u32 s66, s68, 655360
    s_add_u32 s43, s42, s66
    s_bfe_u32 s39, s69, 655360
    s_bfe_u32 s66, s68, 655370
    s_add_u32 s44, s42, s66
    s_bfe_u32 s40, s69, 655370
    s_bfe_u32 s66, s68, 655380
    s_add_u32 s45, s42, s66
    s_bfe_u32 s41, s69, 655380
    v_add_u32 v252, s45, v247
    ds_read_u16 v240, v252
    ds_read_u16 v241, v252 offset:64
    v_mfma_f32_32x32x16_bf16 v[32:47], v[64:67], v[180:183], 0
    v_mul_f32 v196, v0, v96
    v_fmac_f32 v196, v1, v97
    v_fmac_f32 v196, v2, v98
    v_fmac_f32 v196, v3, v99
    v_fmac_f32 v196, v4, v100
    v_fmac_f32 v196, v5, v101
    v_fmac_f32 v196, v6, v102
    v_mfma_f32_32x32x16_bf16 v[48:63], v[68:71], v[180:183], 0
    v_fmac_f32 v196, v7, v103
    v_mul_f32 v198, v8, v128
    v_fmac_f32 v198, v9, v129
    v_fmac_f32 v198, v10, v130
    v_fmac_f32 v198, v11, v131
    v_fmac_f32 v198, v12, v132
    v_mfma_f32_32x32x16_bf16 v[32:47], v[72:75], v[184:187], v[32:47]
    v_fmac_f32 v198, v13, v133
    v_fmac_f32 v198, v14, v134
    v_fmac_f32 v198, v15, v135
    v_mul_f32 v200, v16, v128
    v_fmac_f32 v200, v17, v129
    v_permlane32_swap_b32 v196, v198
    v_mfma_f32_32x32x16_bf16 v[48:63], v[76:79], v[184:187], v[48:63]
    s_waitcnt vmcnt(5)
    ds_read_b64_tr_b16 v[176:177], v244 offset:6144
    ds_read_b64_tr_b16 v[178:179], v244 offset:7168
    ds_read_b64_tr_b16 v[180:181], v245 offset:6144
    ds_read_b64_tr_b16 v[182:183], v245 offset:7168
    v_fmac_f32 v200, v18, v130
    v_fmac_f32 v200, v19, v131
    v_fmac_f32 v200, v20, v132
    v_fmac_f32 v200, v21, v133
    v_fmac_f32 v200, v22, v134
    v_fmac_f32 v200, v23, v135
    v_mfma_f32_32x32x8_bf16 v[32:47], v[80:81], v[188:189], v[32:47]
    v_add_f32 v198, v196, v198
    v_mul_f32_e64 v202, v24, -v128
    v_fma_f32 v202, v25, -v129, v202
    v_fma_f32 v202, v26, -v130, v202
    v_fma_f32 v202, v27, -v131, v202
    v_fma_f32 v202, v28, -v132, v202
    v_mfma_f32_32x32x8_bf16 v[48:63], v[84:85], v[188:189], v[48:63]
    v_fma_f32 v202, v29, -v133, v202
    v_fma_f32 v202, v30, -v134, v202
    v_fma_f32 v202, v31, -v135, v202
    s_nop 1
    v_permlane32_swap_b32 v200, v202
    v_add_f32 v202, v200, v202
    s_waitcnt vmcnt(3) lgkmcnt(0)
    v_mfma_f32_32x32x16_bf16 v[0:15], v[64:67], v[176:179], 0
    v_mul_f32 v197, v32, v104
    v_fmac_f32 v197, v33, v105
    v_fmac_f32 v197, v34, v106
    v_fmac_f32 v197, v35, v107
    v_fmac_f32 v197, v36, v108
    v_fmac_f32 v197, v37, v109
    v_fmac_f32 v197, v38, v110
    s_add_u32 m0, s21, 6144
    v_mfma_f32_32x32x16_bf16 v[16:31], v[68:71], v[176:179], 0
    buffer_load_dwordx4 v236, s[4:7], s36 offen lds
    buffer_load_dwordx4 v237, s[8:11], s36 offen offset:1024 lds
    ds_read_b64_tr_b16 v[176:177], v244 offset:0
    ds_read_b64_tr_b16 v[178:179], v244 offset:1024
    ds_read_b64_tr_b16 v[184:185], v245 offset:0
    ds_read_b64_tr_b16 v[186:187], v245 offset:1024
    v_fmac_f32 v197, v39, v111
    v_mul_f32 v199, v40, v136
    v_fmac_f32 v199, v41, v137
    v_fmac_f32 v199, v42, v138
    v_fmac_f32 v199, v43, v139
    v_fmac_f32 v199, v44, v140
    v_fmac_f32 v199, v45, v141
    s_waitcnt vmcnt(4) lgkmcnt(0)
    v_mfma_f32_32x32x16_bf16 v[0:15], v[72:75], v[176:179], v[0:15]
    v_fmac_f32 v199, v46, v142
    v_fmac_f32 v199, v47, v143
    v_mul_f32 v201, v48, v136
    v_fmac_f32 v201, v49, v137
    v_permlane32_swap_b32 v197, v199
    v_fmac_f32 v201, v50, v138
    s_add_u32 m0, s21, 0
    v_mfma_f32_32x32x16_bf16 v[16:31], v[76:79], v[176:179], v[16:31]
    buffer_load_dwordx4 v238, s[4:7], s36 offen lds
    ds_read_b64_tr_b16 v[176:177], v244 offset:2048
    ds_read_b64_tr_b16 v[188:189], v245 offset:2048
    v_fmac_f32 v201, v51, v139
    v_fmac_f32 v201, v52, v140
    v_fmac_f32 v201, v53, v141
    v_fmac_f32 v201, v54, v142
    v_fmac_f32 v201, v55, v143
    v_add_f32 v199, v197, v199
    v_mul_f32_e64 v203, v56, -v136
    s_waitcnt lgkmcnt(0)
    v_mfma_f32_32x32x8_bf16 v[0:15], v[80:81], v[176:177], v[0:15]
    v_fma_f32 v203, v57, -v137, v203
    v_fma_f32 v203, v58, -v138, v203
    v_fma_f32 v203, v59, -v139, v203
    v_fma_f32 v203, v60, -v140, v203
    v_fma_f32 v203, v61, -v141, v203
    v_fma_f32 v203, v62, -v142, v203
    v_fma_f32 v203, v63, -v143, v203
    s_add_u32 m0, s21, 2048
    v_mfma_f32_32x32x8_bf16 v[16:31], v[84:85], v[176:177], v[16:31]
    buffer_load_dwordx4 v234, s[4:7], s37 offen lds
    buffer_load_dwordx4 v235, s[8:11], s37 offen offset:1024 lds
    v_add_u32 v252, s42, v247
    ds_read_u16 v234, v252
    ds_read_u16 v235, v252 offset:64
    s_nop 1
    v_permlane32_swap_b32 v201, v203
    v_add_f32 v203, v201, v203
    v_cvt_pk_bf16_f32 v198, v198, v199
    v_cvt_pk_bf16_f32 v202, v202, v203
    ds_write2st64_b32 v253, v198, v202 offset0:0 offset1:1
    v_mfma_f32_32x32x16_bf16 v[32:47], v[64:67], v[180:183], 0
    v_mul_f32 v196, v0, v144
    v_fmac_f32 v196, v1, v145
    v_fmac_f32 v196, v2, v146
    v_fmac_f32 v196, v3, v147
    v_fmac_f32 v196, v4, v148
    v_fmac_f32 v196, v5, v149
    v_mfma_f32_32x32x16_bf16 v[48:63], v[68:71], v[180:183], 0
    v_fmac_f32 v196, v6, v150
    v_fmac_f32 v196, v7, v151
    v_mul_f32 v198, v8, v112
    v_fmac_f32 v198, v9, v113
    v_fmac_f32 v198, v10, v114
    v_mfma_f32_32x32x16_bf16 v[32:47], v[72:75], v[184:187], v[32:47]
    v_fmac_f32 v198, v11, v115
    v_fmac_f32 v198, v12, v116
    v_fmac_f32 v198, v13, v117
    v_fmac_f32 v198, v14, v118
    v_fmac_f32 v198, v15, v119
    v_mfma_f32_32x32x16_bf16 v[48:63], v[76:79], v[184:187], v[48:63]
    s_waitcnt vmcnt(5)
    ds_read_b64_tr_b16 v[176:177], v244 offset:4096
    ds_read_b64_tr_b16 v[178:179], v244 offset:5120
    ds_read_b64_tr_b16 v[180:181], v245 offset:4096
    ds_read_b64_tr_b16 v[182:183], v245 offset:5120
    v_mul_f32_e64 v200, v16, -v160
    v_fma_f32 v200, v17, -v161, v200
    v_fma_f32 v200, v18, -v162, v200
    v_fma_f32 v200, v19, -v163, v200
    v_fma_f32 v200, v20, -v164, v200
    v_fma_f32 v200, v21, -v165, v200
    v_mfma_f32_32x32x8_bf16 v[32:47], v[80:81], v[188:189], v[32:47]
    v_fma_f32 v200, v22, -v166, v200
    v_fma_f32 v200, v23, -v167, v200
    v_mul_f32_e64 v202, v24, -v160
    v_fma_f32 v202, v25, -v161, v202
    v_fma_f32 v202, v26, -v162, v202
    v_mfma_f32_32x32x8_bf16 v[48:63], v[84:85], v[188:189], v[48:63]
    v_fma_f32 v202, v27, -v163, v202
    v_fma_f32 v202, v28, -v164, v202
    v_fma_f32 v202, v29, -v165, v202
    v_fma_f32 v202, v30, -v166, v202
    v_fma_f32 v202, v31, -v167, v202
    s_waitcnt vmcnt(3) lgkmcnt(0)
    v_mfma_f32_32x32x16_bf16 v[0:15], v[64:67], v[176:179], 0
    v_mul_f32 v197, v32, v152
    v_fmac_f32 v197, v33, v153
    v_fmac_f32 v197, v34, v154
    v_fmac_f32 v197, v35, v155
    v_fmac_f32 v197, v36, v156
    v_fmac_f32 v197, v37, v157
    s_add_u32 m0, s21, 4096
    v_mfma_f32_32x32x16_bf16 v[16:31], v[68:71], v[176:179], 0
    buffer_load_dwordx4 v236, s[4:7], s37 offen lds
    buffer_load_dwordx4 v237, s[8:11], s37 offen offset:1024 lds
    ds_read_b64_tr_b16 v[176:177], v244 offset:6144
    ds_read_b64_tr_b16 v[178:179], v244 offset:7168
    ds_read_b64_tr_b16 v[184:185], v245 offset:6144
    ds_read_b64_tr_b16 v[186:187], v245 offset:7168
    v_add_u32 v252, s43, v247
    ds_read_u16 v236, v252
    ds_read_u16 v237, v252 offset:64
    v_fmac_f32 v197, v38, v158
    v_fmac_f32 v197, v39, v159
    v_mul_f32 v199, v40, v120
    v_fmac_f32 v199, v41, v121
    v_fmac_f32 v199, v42, v122
    s_waitcnt vmcnt(4) lgkmcnt(2)
    v_mfma_f32_32x32x16_bf16 v[0:15], v[72:75], v[176:179], v[0:15]
    v_fmac_f32 v199, v43, v123
    v_fmac_f32 v199, v44, v124
    v_fmac_f32 v199, v45, v125
    v_fmac_f32 v199, v46, v126
    v_fmac_f32 v199, v47, v127
    s_add_u32 m0, s21, 6144
    v_mfma_f32_32x32x16_bf16 v[16:31], v[76:79], v[176:179], v[16:31]
    buffer_load_dwordx4 v238, s[4:7], s37 offen lds
    ds_read_b64_tr_b16 v[176:177], v244 offset:0
    ds_read_b64_tr_b16 v[188:189], v245 offset:0
    v_add_u32 v252, s44, v247
    ds_read_u16 v238, v252
    ds_read_u16 v239, v252 offset:64
    v_mul_f32_e64 v201, v48, -v168
    v_fma_f32 v201, v49, -v169, v201
    v_fma_f32 v201, v50, -v170, v201
    v_fma_f32 v201, v51, -v171, v201
    v_fma_f32 v201, v52, -v172, v201
    v_fma_f32 v201, v53, -v173, v201
    s_waitcnt lgkmcnt(2)
    v_mfma_f32_32x32x8_bf16 v[0:15], v[80:81], v[176:177], v[0:15]
    v_fma_f32 v201, v54, -v174, v201
    v_fma_f32 v201, v55, -v175, v201
    v_mul_f32_e64 v203, v56, -v168
    v_fma_f32 v203, v57, -v169, v203
    v_fma_f32 v203, v58, -v170, v203
    s_add_u32 m0, s21, 0
    v_mfma_f32_32x32x8_bf16 v[16:31], v[84:85], v[176:177], v[16:31]
    v_lshl_add_u32 v234, v234, 10, v246
    v_lshl_add_u32 v235, v235, 10, v246
    buffer_load_dwordx4 v234, s[4:7], s38 offen lds
    buffer_load_dwordx4 v235, s[8:11], s38 offen offset:1024 lds
    v_fma_f32 v203, v59, -v171, v203
    v_fma_f32 v203, v60, -v172, v203
    v_fma_f32 v203, v61, -v173, v203
    v_fma_f32 v203, v62, -v174, v203
    v_fma_f32 v203, v63, -v175, v203
    v_mfma_f32_32x32x16_bf16 v[32:47], v[64:67], v[180:183], 0
    v_mul_f32 v254, v0, v144
    v_fmac_f32 v254, v1, v145
    v_fmac_f32 v254, v2, v146
    v_mfma_f32_32x32x16_bf16 v[48:63], v[68:71], v[180:183], 0
    ds_swizzle_b32 v68, v68 offset:0x401F
    ds_swizzle_b32 v69, v69 offset:0x401F
    ds_swizzle_b32 v70, v70 offset:0x401F
    ds_swizzle_b32 v71, v71 offset:0x401F
    v_fmac_f32 v254, v3, v147
    v_fmac_f32 v254, v4, v148
    v_fmac_f32 v254, v5, v149
    v_mfma_f32_32x32x16_bf16 v[32:47], v[72:75], v[184:187], v[32:47]
    v_fmac_f32 v254, v6, v150
    v_fmac_f32 v254, v7, v151
    v_fmac_f32 v200, v8, v160
    v_mfma_f32_32x32x16_bf16 v[48:63], v[76:79], v[184:187], v[48:63]
    ds_swizzle_b32 v76, v76 offset:0x401F
    ds_swizzle_b32 v77, v77 offset:0x401F
    ds_swizzle_b32 v78, v78 offset:0x401F
    ds_swizzle_b32 v79, v79 offset:0x401F
    s_waitcnt vmcnt(5)
    ds_read_b64_tr_b16 v[176:177], v244 offset:2048
    ds_read_b64_tr_b16 v[178:179], v244 offset:3072
    ds_read_b64_tr_b16 v[180:181], v245 offset:2048
    ds_read_b64_tr_b16 v[182:183], v245 offset:3072
    v_fmac_f32 v200, v9, v161
    v_permlane32_swap_b32 v196, v254
    v_fmac_f32 v200, v10, v162
    v_mfma_f32_32x32x8_bf16 v[32:47], v[80:81], v[188:189], v[32:47]
    v_fmac_f32 v200, v11, v163
    v_fmac_f32 v200, v12, v164
    v_fmac_f32 v200, v13, v165
    v_mfma_f32_32x32x8_bf16 v[48:63], v[84:85], v[188:189], v[48:63]
    ds_swizzle_b32 v84, v84 offset:0x401F
    ds_swizzle_b32 v85, v85 offset:0x401F
    v_fmac_f32 v200, v14, v166
    v_fmac_f32 v200, v15, v167
    v_add_f32 v254, v196, v254
    s_waitcnt lgkmcnt(6)
    s_mov_b64 exec, s[56:57]
    v_xor_b32 v68, 0x80008000, v68
    v_xor_b32 v69, 0x80008000, v69
    v_xor_b32 v70, 0x80008000, v70
    v_xor_b32 v71, 0x80008000, v71
    v_xor_b32 v76, 0x80008000, v76
    v_xor_b32 v77, 0x80008000, v77
    v_xor_b32 v78, 0x80008000, v78
    v_xor_b32 v79, 0x80008000, v79
    s_mov_b64 exec, -1
    s_waitcnt vmcnt(3) lgkmcnt(2)
    v_mfma_f32_32x32x16_bf16 v[0:15], v[64:67], v[176:179], 0
    v_mul_f32 v255, v32, v152
    v_fmac_f32 v255, v33, v153
    v_fmac_f32 v255, v34, v154
    v_fmac_f32 v255, v35, v155
    s_add_u32 m0, s21, 2048
    v_mfma_f32_32x32x16_bf16 v[16:31], v[68:71], v[176:179], v[16:31]
    v_lshl_add_u32 v236, v236, 10, v246
    v_lshl_add_u32 v237, v237, 10, v246
    buffer_load_dwordx4 v236, s[4:7], s39 offen lds
    buffer_load_dwordx4 v237, s[8:11], s39 offen offset:1024 lds
    ds_read_b64_tr_b16 v[176:177], v244 offset:4096
    ds_read_b64_tr_b16 v[178:179], v244 offset:5120
    ds_read_b64_tr_b16 v[184:185], v245 offset:4096
    ds_read_b64_tr_b16 v[186:187], v245 offset:5120
    v_fmac_f32 v255, v36, v156
    v_fmac_f32 v255, v37, v157
    v_fmac_f32 v255, v38, v158
    s_waitcnt vmcnt(4) lgkmcnt(0)
    v_mfma_f32_32x32x16_bf16 v[0:15], v[72:75], v[176:179], v[0:15]
    v_fmac_f32 v255, v39, v159
    v_fmac_f32 v201, v40, v168
    v_fmac_f32 v201, v41, v169
    s_add_u32 m0, s21, 4096
    v_mfma_f32_32x32x16_bf16 v[16:31], v[76:79], v[176:179], v[16:31]
    v_lshl_add_u32 v238, v238, 10, v246
    v_lshl_add_u32 v239, v239, 10, v246
    buffer_load_dwordx4 v238, s[4:7], s40 offen lds
    buffer_load_dwordx4 v239, s[8:11], s40 offen offset:1024 lds
    ds_read_b64_tr_b16 v[176:177], v244 offset:6144
    ds_read_b64_tr_b16 v[188:189], v245 offset:6144
    v_permlane32_swap_b32 v197, v255
    v_fmac_f32 v201, v42, v170
    v_fmac_f32 v201, v43, v171
    v_fmac_f32 v201, v44, v172
    s_waitcnt lgkmcnt(0)
    s_mov_b64 exec, s[56:57]
    v_xor_b32 v84, 0x80008000, v84
    v_xor_b32 v85, 0x80008000, v85
    s_mov_b64 exec, -1
    v_mfma_f32_32x32x8_bf16 v[0:15], v[80:81], v[176:177], v[0:15]
    v_fmac_f32 v201, v45, v173
    v_fmac_f32 v201, v46, v174
    v_fmac_f32 v201, v47, v175
    s_add_u32 m0, s21, 6144
    v_mfma_f32_32x32x8_bf16 v[16:31], v[84:85], v[176:177], v[16:31]
    v_lshl_add_u32 v240, v240, 10, v246
    v_lshl_add_u32 v241, v241, 10, v246
    buffer_load_dwordx4 v240, s[4:7], s41 offen lds
    buffer_load_dwordx4 v241, s[8:11], s41 offen offset:1024 lds
    v_add_f32 v255, v197, v255
    v_cvt_pk_bf16_f32 v254, v254, v255
    ds_write_b32 v253, v254 offset:512
    v_mfma_f32_32x32x16_bf16 v[32:47], v[64:67], v[180:183], 0
    v_mul_f32 v254, v0, v144
    v_fmac_f32 v254, v1, v145
    v_fmac_f32 v254, v2, v146
    v_fmac_f32 v254, v3, v147
    v_fmac_f32 v254, v4, v148
    v_fmac_f32 v254, v5, v149
    v_fmac_f32 v254, v6, v150
    v_mfma_f32_32x32x16_bf16 v[48:63], v[68:71], v[180:183], v[48:63]
    v_fmac_f32 v254, v7, v151
    v_fma_f32 v202, v8, -v160, v202
    v_fma_f32 v202, v9, -v161, v202
    v_permlane32_swap_b32 v254, v200
    v_fma_f32 v202, v10, -v162, v202
    v_fma_f32 v202, v11, -v163, v202
    v_mfma_f32_32x32x16_bf16 v[32:47], v[72:75], v[184:187], v[32:47]
    v_fma_f32 v202, v12, -v164, v202
    v_fma_f32 v202, v13, -v165, v202
    v_fma_f32 v202, v14, -v166, v202
    v_fma_f32 v202, v15, -v167, v202
    v_add_f32 v200, v254, v200
    v_fmac_f32 v198, v16, v112
    v_permlane32_swap_b32 v202, v254
    v_mfma_f32_32x32x16_bf16 v[48:63], v[76:79], v[184:187], v[48:63]
    s_waitcnt vmcnt(6)
    ds_read_b64_tr_b16 v[176:177], v244 offset:0
    ds_read_b64_tr_b16 v[178:179], v244 offset:1024
    ds_read_b64_tr_b16 v[180:181], v245 offset:0
    ds_read_b64_tr_b16 v[182:183], v245 offset:1024
    v_fmac_f32 v198, v17, v113
    v_fmac_f32 v198, v18, v114
    v_fmac_f32 v198, v19, v115
    v_fmac_f32 v198, v20, v116
    v_fmac_f32 v198, v21, v117
    v_fmac_f32 v198, v22, v118
    v_mfma_f32_32x32x8_bf16 v[32:47], v[80:81], v[188:189], v[32:47]
    v_fmac_f32 v198, v23, v119
    v_add_f32 v254, v202, v254
    v_mul_f32 v196, v24, v160
    v_fmac_f32 v196, v25, v161
    v_fmac_f32 v196, v26, v162
    v_fmac_f32 v196, v27, v163
    v_fmac_f32 v196, v28, v164
    v_mfma_f32_32x32x8_bf16 v[48:63], v[84:85], v[188:189], v[48:63]
    v_add_u32 v249, s48, v249
    v_add_u32 v250, s49, v250
    ds_read_b32 v252, v251 offset:16
    ds_read_b64_tr_b16 v[64:65], v249 offset:0
    ds_read_b64_tr_b16 v[68:69], v249 offset:64
    ds_read_b64_tr_b16 v[66:67], v249 offset:256
    ds_read_b64_tr_b16 v[70:71], v249 offset:320
    s_mov_b64 exec, s[54:55]
    ds_read_u16_d16_hi v242, v250 offset:0
    s_mov_b64 exec, -1
    v_fmac_f32 v196, v29, v165
    v_fmac_f32 v196, v30, v166
    v_fmac_f32 v196, v31, v167
    s_nop 1
    v_permlane32_swap_b32 v198, v196
    v_add_f32 v196, v198, v196
    v_mul_f32 v255, v32, v152
    v_fmac_f32 v255, v33, v153
    v_fmac_f32 v255, v34, v154
    v_fmac_f32 v255, v35, v155
    v_fmac_f32 v255, v36, v156
    v_fmac_f32 v255, v37, v157
    v_fmac_f32 v255, v38, v158
    v_fmac_f32 v255, v39, v159
    v_fma_f32 v203, v40, -v168, v203
    v_fma_f32 v203, v41, -v169, v203
    v_permlane32_swap_b32 v255, v201
    v_fma_f32 v203, v42, -v170, v203
    v_fma_f32 v203, v43, -v171, v203
    v_fma_f32 v203, v44, -v172, v203
    v_fma_f32 v203, v45, -v173, v203
    v_fma_f32 v203, v46, -v174, v203
    v_fma_f32 v203, v47, -v175, v203
    v_add_f32 v201, v255, v201
    v_fmac_f32 v199, v48, v120
    v_permlane32_swap_b32 v203, v255
    v_fmac_f32 v199, v49, v121
    v_fmac_f32 v199, v50, v122
    v_fmac_f32 v199, v51, v123
    v_fmac_f32 v199, v52, v124
    v_fmac_f32 v199, v53, v125
    v_fmac_f32 v199, v54, v126
    v_fmac_f32 v199, v55, v127
    v_add_f32 v255, v203, v255
    v_mul_f32 v197, v56, v168
    v_fmac_f32 v197, v57, v169
    v_fmac_f32 v197, v58, v170
    v_fmac_f32 v197, v59, v171
    v_fmac_f32 v197, v60, v172
    v_fmac_f32 v197, v61, v173
    v_fmac_f32 v197, v62, v174
    v_fmac_f32 v197, v63, v175
    s_nop 1
    v_permlane32_swap_b32 v199, v197
    v_add_f32 v197, v199, v197
    v_cvt_pk_bf16_f32 v200, v200, v201
    v_cvt_pk_bf16_f32 v254, v254, v255
    v_cvt_pk_bf16_f32 v196, v196, v197
    ds_write2st64_b32 v253, v200, v196 offset0:3 offset1:4
    s_mov_b64 exec, 0xffffffff
    ds_write_b32 v253, v254 offset:1280
    s_mov_b64 exec, -1
    s_add_u32 s50, s50, 1
    s_cmp_ge_u32 s50, 4
    s_cbranch_scc1 LAST1
    s_waitcnt lgkmcnt(7)
    v_readfirstlane_b32 s66, v252
    s_add_u32 s53, s53, 1
    v_mov_b32 v252, s53
    s_cmp_le_u32 s53, s66
    ds_write2_b32 v251, v252, v252 offset0:0 offset1:8
    s_setprio 1
    s_cbranch_scc1 PRIO_12
    s_setprio 0
PRIO_12:
    s_cmp_eq_u32 s52, 4
    s_cbranch_scc1 ITEM_1_4
    s_cmp_eq_u32 s52, 5
    s_cbranch_scc1 ITEM_1_5
    s_cmp_eq_u32 s52, 3
    s_cbranch_scc1 ITEM_1_3
    s_cmp_eq_u32 s52, 6
    s_cbranch_scc1 ITEM_1_6
    s_cmp_eq_u32 s52, 8
    s_cbranch_scc1 ITEM_1_8
    s_branch ITEM_1_2
.p2align 6
ITEM_1_3:
    s_mov_b64 exec, s[54:55]
    ds_read_u16_d16_hi v243, v250 offset:128
    s_mov_b64 exec, -1
    ds_read_b64_tr_b16 v[72:73], v249 offset:512
    ds_read_b64_tr_b16 v[76:77], v249 offset:576
    s_waitcnt lgkmcnt(3)
    v_mul_f32_dpp v196, v242, v64 row_newbcast:0 row_mask:0xf bank_mask:0xf
    v_mul_f32_dpp v197, v242, v65 row_newbcast:1 row_mask:0xf bank_mask:0xf
    v_mul_f32_dpp v198, v242, v64 row_newbcast:8 row_mask:0xf bank_mask:0xf
    v_mul_f32_dpp v199, v242, v65 row_newbcast:9 row_mask:0xf bank_mask:0xf
    v_mul_f32_dpp v200, v242, v68 row_newbcast:2 row_mask:0xf bank_mask:0xf
    v_mul_f32_dpp v201, v242, v69 row_newbcast:3 row_mask:0xf bank_mask:0xf
    v_mul_f32_dpp v202, v242, v68 row_newbcast:10 row_mask:0xf bank_mask:0xf
    v_mul_f32_dpp v203, v242, v69 row_newbcast:11 row_mask:0xf bank_mask:0xf
    v_cvt_pk_bf16_f32 v64, v196, v197
    v_cvt_pk_bf16_f32 v68, v198, v199
    v_cvt_pk_bf16_f32 v65, v200, v201
    v_cvt_pk_bf16_f32 v69, v202, v203
    v_mul_f32_dpp v196, v242, v66 row_newbcast:4 row_mask:0xf bank_mask:0xf
    v_mul_f32_dpp v197, v242, v67 row_newbcast:5 row_mask:0xf bank_mask:0xf
    v_mul_f32_dpp v198, v242, v66 row_newbcast:12 row_mask:0xf bank_mask:0xf
    v_mul_f32_dpp v199, v242, v67 row_newbcast:13 row_mask:0xf bank_mask:0xf
    v_mul_f32_dpp v200, v242, v70 row_newbcast:6 row_mask:0xf bank_mask:0xf
    v_mul_f32_dpp v201, v242, v71 row_newbcast:7 row_mask:0xf bank_mask:0xf
    v_mul_f32_dpp v202, v242, v70 row_newbcast:14 row_mask:0xf bank_mask:0xf
    v_mul_f32_dpp v203, v242, v71 row_newbcast:15 row_mask:0xf bank_mask:0xf
    v_cvt_pk_bf16_f32 v66, v196, v197
    v_cvt_pk_bf16_f32 v70, v198, v199
    v_cvt_pk_bf16_f32 v67, v200, v201
    v_cvt_pk_bf16_f32 v71, v202, v203
    s_nop 0
    s_waitcnt vmcnt(4) lgkmcnt(0)
    v_mfma_f32_32x32x16_bf16 v[0:15], v[64:67], v[176:179], 0
    v_mul_f32_dpp v196, v243, v72 row_newbcast:0 row_mask:0xf bank_mask:0xf
    v_mul_f32_dpp v197, v243, v73 row_newbcast:1 row_mask:0xf bank_mask:0xf
    v_mul_f32_dpp v198, v243, v72 row_newbcast:8 row_mask:0xf bank_mask:0xf
    v_mul_f32_dpp v199, v243, v73 row_newbcast:9 row_mask:0xf bank_mask:0xf
    v_mul_f32_dpp v200, v243, v76 row_newbcast:2 row_mask:0xf bank_mask:0xf
    v_mul_f32_dpp v201, v243, v77 row_newbcast:3 row_mask:0xf bank_mask:0xf
    s_add_u32 m0, s21, 0
    v_mfma_f32_32x32x16_bf16 v[16:31], v[68:71], v[176:179], 0
    buffer_load_dwordx4 v234, s[4:7], s36 offen lds
    buffer_load_dwordx4 v235, s[8:11], s36 offen offset:1024 lds
    ds_read_b64_tr_b16 v[176:177], v244 offset:2048
    ds_read_b64_tr_b16 v[184:185], v245 offset:2048
    v_mul_f32_dpp v202, v243, v76 row_newbcast:10 row_mask:0xf bank_mask:0xf
    v_mul_f32_dpp v203, v243, v77 row_newbcast:11 row_mask:0xf bank_mask:0xf
    v_cvt_pk_bf16_f32 v72, v196, v197
    v_cvt_pk_bf16_f32 v76, v198, v199
    v_cvt_pk_bf16_f32 v73, v200, v201
    v_cvt_pk_bf16_f32 v77, v202, v203
    s_nop 0
    s_waitcnt lgkmcnt(0)
    v_mfma_f32_32x32x8_bf16 v[0:15], v[72:73], v[176:177], v[0:15]
    s_add_u32 m0, s21, 2048
    v_mfma_f32_32x32x8_bf16 v[16:31], v[76:77], v[176:177], v[16:31]
    buffer_load_dwordx4 v236, s[4:7], s36 offen lds
    s_mov_b32 m0, s50
    s_nop 0
    s_movrels_b32 s71, s23
    s_movrels_b32 s33, s28
    s_and_b32 s70, s33, 0x70
    s_andn2_b32 s33, s33, 0x70
    v_xor_b32 v253, s70, v248
    v_add_u32 v253, s33, v253
    s_bfe_u32 s46, s71, 0x30012
    s_mov_b32 m0, s46
    s_and_b32 s66, s71, 0x3ffff
    s_movrels_b32 s68, s57
    s_movrels_b32 s69, s61
    s_sub_u32 s48, s66, s47
    s_mov_b32 s47, s66
    s_lshr_b32 s52, s71, 28
    s_lshl_b32 s67, s46, 9
    s_add_u32 s66, s66, s67
    s_sub_u32 s49, s66, s42
    s_mov_b32 s42, s66
    s_bfe_u32 s66, s68, 655360
    s_add_u32 s43, s42, s66
    s_bfe_u32 s39, s69, 655360
    s_bfe_u32 s66, s68, 655370
    s_add_u32 s44, s42, s66
    s_bfe_u32 s40, s69, 655370
    s_bfe_u32 s66, s68, 655380
    s_add_u32 s45, s42, s66
    s_bfe_u32 s41, s69, 655380
    v_add_u32 v252, s44, v247
    ds_read_u16 v238, v252
    ds_read_u16 v239, v252 offset:64
    v_add_u32 v252, s45, v247
    ds_read_u16 v240, v252
    ds_read_u16 v241, v252 offset:64
    v_mfma_f32_32x32x16_bf16 v[32:47], v[64:67], v[180:183], 0
    v_mul_f32 v196, v0, v96
    v_fmac_f32 v196, v1, v97
    v_fmac_f32 v196, v2, v98
    v_fmac_f32 v196, v3, v99
    v_fmac_f32 v196, v4, v100
    v_fmac_f32 v196, v5, v101
    v_fmac_f32 v196, v6, v102
    v_fmac_f32 v196, v7, v103
    v_mul_f32 v198, v8, v128
    v_fmac_f32 v198, v9, v129
    v_mfma_f32_32x32x16_bf16 v[48:63], v[68:71], v[180:183], 0
    s_waitcnt vmcnt(5)
    ds_read_b64_tr_b16 v[176:177], v244 offset:4096
    ds_read_b64_tr_b16 v[178:179], v244 offset:5120
    ds_read_b64_tr_b16 v[180:181], v245 offset:4096
    ds_read_b64_tr_b16 v[182:183], v245 offset:5120
    v_fmac_f32 v198, v10, v130
    v_fmac_f32 v198, v11, v131
    v_fmac_f32 v198, v12, v132
    v_fmac_f32 v198, v13, v133
    v_fmac_f32 v198, v14, v134
    v_fmac_f32 v198, v15, v135
    v_mul_f32 v200, v16, v128
    v_fmac_f32 v200, v17, v129
    v_permlane32_swap_b32 v196, v198
    v_mfma_f32_32x32x8_bf16 v[32:47], v[72:73], v[184:185], v[32:47]
    v_fmac_f32 v200, v18, v130
    v_fmac_f32 v200, v19, v131
    v_fmac_f32 v200, v20, v132
    v_fmac_f32 v200, v21, v133
    v_fmac_f32 v200, v22, v134
    v_fmac_f32 v200, v23, v135
    v_add_f32 v198, v196, v198
    v_mul_f32_e64 v202, v24, -v128
    v_fma_f32 v202, v25, -v129, v202
    v_mfma_f32_32x32x8_bf16 v[48:63], v[76:77], v[184:185], v[48:63]
    v_fma_f32 v202, v26, -v130, v202
    v_fma_f32 v202, v27, -v131, v202
    v_fma_f32 v202, v28, -v132, v202
    v_fma_f32 v202, v29, -v133, v202
    v_fma_f32 v202, v30, -v134, v202
    v_fma_f32 v202, v31, -v135, v202
    s_nop 1
    v_permlane32_swap_b32 v200, v202
    v_add_f32 v202, v200, v202
    s_waitcnt vmcnt(3) lgkmcnt(0)
    v_mfma_f32_32x32x16_bf16 v[0:15], v[64:67], v[176:179], 0
    v_mul_f32 v197, v32, v104
    v_fmac_f32 v197, v33, v105
    v_fmac_f32 v197, v34, v106
    v_fmac_f32 v197, v35, v107
    v_fmac_f32 v197, v36, v108
    v_fmac_f32 v197, v37, v109
    v_fmac_f32 v197, v38, v110
    v_fmac_f32 v197, v39, v111
    v_mul_f32 v199, v40, v136
    v_fmac_f32 v199, v41, v137
    s_add_u32 m0, s21, 4096
    v_mfma_f32_32x32x16_bf16 v[16:31], v[68:71], v[176:179], 0
    buffer_load_dwordx4 v234, s[4:7], s37 offen lds
    buffer_load_dwordx4 v235, s[8:11], s37 offen offset:1024 lds
    ds_read_b64_tr_b16 v[176:177], v244 offset:6144
    ds_read_b64_tr_b16 v[184:185], v245 offset:6144
    v_add_u32 v252, s42, v247
    ds_read_u16 v234, v252
    ds_read_u16 v235, v252 offset:64
    v_fmac_f32 v199, v42, v138
    v_fmac_f32 v199, v43, v139
    v_fmac_f32 v199, v44, v140
    v_fmac_f32 v199, v45, v141
    v_fmac_f32 v199, v46, v142
    v_fmac_f32 v199, v47, v143
    v_mul_f32 v201, v48, v136
    v_fmac_f32 v201, v49, v137
    v_permlane32_swap_b32 v197, v199
    v_fmac_f32 v201, v50, v138
    s_waitcnt lgkmcnt(2)
    v_mfma_f32_32x32x8_bf16 v[0:15], v[72:73], v[176:177], v[0:15]
    v_fmac_f32 v201, v51, v139
    v_fmac_f32 v201, v52, v140
    v_fmac_f32 v201, v53, v141
    v_fmac_f32 v201, v54, v142
    v_fmac_f32 v201, v55, v143
    v_add_f32 v199, v197, v199
    v_mul_f32_e64 v203, v56, -v136
    v_fma_f32 v203, v57, -v137, v203
    v_fma_f32 v203, v58, -v138, v203
    v_fma_f32 v203, v59, -v139, v203
    s_add_u32 m0, s21, 6144
    v_mfma_f32_32x32x8_bf16 v[16:31], v[76:77], v[176:177], v[16:31]
    buffer_load_dwordx4 v236, s[4:7], s37 offen lds
    v_add_u32 v252, s43, v247
    ds_read_u16 v236, v252
    ds_read_u16 v237, v252 offset:64
    v_fma_f32 v203, v60, -v140, v203
    v_fma_f32 v203, v61, -v141, v203
    v_fma_f32 v203, v62, -v142, v203
    v_fma_f32 v203, v63, -v143, v203
    s_nop 1
    v_permlane32_swap_b32 v201, v203
    v_add_f32 v203, v201, v203
    v_cvt_pk_bf16_f32 v198, v198, v199
    v_cvt_pk_bf16_f32 v202, v202, v203
    ds_write2st64_b32 v253, v198, v202 offset0:0 offset1:1
    v_mfma_f32_32x32x16_bf16 v[32:47], v[64:67], v[180:183], 0
    v_mul_f32 v196, v0, v144
    v_fmac_f32 v196, v1, v145
    v_fmac_f32 v196, v2, v146
    v_fmac_f32 v196, v3, v147
    v_fmac_f32 v196, v4, v148
    v_fmac_f32 v196, v5, v149
    v_fmac_f32 v196, v6, v150
    v_fmac_f32 v196, v7, v151
    v_mfma_f32_32x32x16_bf16 v[48:63], v[68:71], v[180:183], 0
    s_waitcnt vmcnt(4)
    ds_read_b64_tr_b16 v[176:177], v244 offset:0
    ds_read_b64_tr_b16 v[178:179], v244 offset:1024
    ds_read_b64_tr_b16 v[180:181], v245 offset:0
    ds_read_b64_tr_b16 v[182:183], v245 offset:1024
    v_mul_f32 v198, v8, v112
    v_fmac_f32 v198, v9, v113
    v_fmac_f32 v198, v10, v114
    v_fmac_f32 v198, v11, v115
    v_fmac_f32 v198, v12, v116
    v_fmac_f32 v198, v13, v117
    v_fmac_f32 v198, v14, v118
    v_fmac_f32 v198, v15, v119
    v_mfma_f32_32x32x8_bf16 v[32:47], v[72:73], v[184:185], v[32:47]
    v_mul_f32_e64 v200, v16, -v160
    v_fma_f32 v200, v17, -v161, v200
    v_fma_f32 v200, v18, -v162, v200
    v_fma_f32 v200, v19, -v163, v200
    v_fma_f32 v200, v20, -v164, v200
    v_fma_f32 v200, v21, -v165, v200
    v_fma_f32 v200, v22, -v166, v200
    v_fma_f32 v200, v23, -v167, v200
    v_mfma_f32_32x32x8_bf16 v[48:63], v[76:77], v[184:185], v[48:63]
    v_mul_f32_e64 v202, v24, -v160
    v_fma_f32 v202, v25, -v161, v202
    v_fma_f32 v202, v26, -v162, v202
    v_fma_f32 v202, v27, -v163, v202
    v_fma_f32 v202, v28, -v164, v202
    v_fma_f32 v202, v29, -v165, v202
    v_fma_f32 v202, v30, -v166, v202
    v_fma_f32 v202, v31, -v167, v202
    s_waitcnt vmcnt(3) lgkmcnt(0)
    v_mfma_f32_32x32x16_bf16 v[0:15], v[64:67], v[176:179], 0
    v_mul_f32 v197, v32, v152
    v_fmac_f32 v197, v33, v153
    v_fmac_f32 v197, v34, v154
    v_fmac_f32 v197, v35, v155
    v_fmac_f32 v197, v36, v156
    v_fmac_f32 v197, v37, v157
    v_fmac_f32 v197, v38, v158
    v_fmac_f32 v197, v39, v159
    s_add_u32 m0, s21, 0
    v_mfma_f32_32x32x16_bf16 v[16:31], v[68:71], v[176:179], 0
    v_lshl_add_u32 v234, v234, 10, v246
    v_lshl_add_u32 v235, v235, 10, v246
    buffer_load_dwordx4 v234, s[4:7], s38 offen lds
    buffer_load_dwordx4 v235, s[8:11], s38 offen offset:1024 lds
    ds_read_b64_tr_b16 v[176:177], v244 offset:2048
    ds_read_b64_tr_b16 v[184:185], v245 offset:2048
    v_mul_f32 v199, v40, v120
    v_fmac_f32 v199, v41, v121
    v_fmac_f32 v199, v42, v122
    v_fmac_f32 v199, v43, v123
    v_fmac_f32 v199, v44, v124
    v_fmac_f32 v199, v45, v125
    v_fmac_f32 v199, v46, v126
    v_fmac_f32 v199, v47, v127
    s_waitcnt lgkmcnt(0)
    v_mfma_f32_32x32x8_bf16 v[0:15], v[72:73], v[176:177], v[0:15]
    v_mul_f32_e64 v201, v48, -v168
    v_fma_f32 v201, v49, -v169, v201
    v_fma_f32 v201, v50, -v170, v201
    v_fma_f32 v201, v51, -v171, v201
    v_fma_f32 v201, v52, -v172, v201
    v_fma_f32 v201, v53, -v173, v201
    v_fma_f32 v201, v54, -v174, v201
    v_fma_f32 v201, v55, -v175, v201
    s_add_u32 m0, s21, 2048
    v_mfma_f32_32x32x8_bf16 v[16:31], v[76:77], v[176:177], v[16:31]
    v_lshl_add_u32 v236, v236, 10, v246
    v_lshl_add_u32 v237, v237, 10, v246
    buffer_load_dwordx4 v236, s[4:7], s39 offen lds
    buffer_load_dwordx4 v237, s[8:11], s39 offen offset:1024 lds
    v_mul_f32_e64 v203, v56, -v168
    v_fma_f32 v203, v57, -v169, v203
    v_fma_f32 v203, v58, -v170, v203
    v_fma_f32 v203, v59, -v171, v203
    v_fma_f32 v203, v60, -v172, v203
    v_fma_f32 v203, v61, -v173, v203
    v_fma_f32 v203, v62, -v174, v203
    v_fma_f32 v203, v63, -v175, v203
    v_mfma_f32_32x32x16_bf16 v[32:47], v[64:67], v[180:183], 0
    v_mul_f32 v254, v0, v144
    v_fmac_f32 v254, v1, v145
    v_fmac_f32 v254, v2, v146
    v_fmac_f32 v254, v3, v147
    v_fmac_f32 v254, v4, v148
    v_mfma_f32_32x32x16_bf16 v[48:63], v[68:71], v[180:183], 0
    ds_swizzle_b32 v68, v68 offset:0x401F
    ds_swizzle_b32 v69, v69 offset:0x401F
    ds_swizzle_b32 v70, v70 offset:0x401F
    ds_swizzle_b32 v71, v71 offset:0x401F
    s_waitcnt vmcnt(5)
    ds_read_b64_tr_b16 v[176:177], v244 offset:4096
    ds_read_b64_tr_b16 v[178:179], v244 offset:5120
    ds_read_b64_tr_b16 v[180:181], v245 offset:4096
    ds_read_b64_tr_b16 v[182:183], v245 offset:5120
    v_fmac_f32 v254, v5, v149
    v_fmac_f32 v254, v6, v150
    v_fmac_f32 v254, v7, v151
    v_fmac_f32 v200, v8, v160
    v_mfma_f32_32x32x8_bf16 v[32:47], v[72:73], v[184:185], v[32:47]
    v_fmac_f32 v200, v9, v161
    v_permlane32_swap_b32 v196, v254
    v_fmac_f32 v200, v10, v162
    v_fmac_f32 v200, v11, v163
    v_fmac_f32 v200, v12, v164
    v_mfma_f32_32x32x8_bf16 v[48:63], v[76:77], v[184:185], v[48:63]
    ds_swizzle_b32 v76, v76 offset:0x401F
    ds_swizzle_b32 v77, v77 offset:0x401F
    v_fmac_f32 v200, v13, v165
    v_fmac_f32 v200, v14, v166
    v_fmac_f32 v200, v15, v167
    v_add_f32 v254, v196, v254
    s_waitcnt lgkmcnt(6)
    s_mov_b64 exec, s[56:57]
    v_xor_b32 v68, 0x80008000, v68
    v_xor_b32 v69, 0x80008000, v69
    v_xor_b32 v70, 0x80008000, v70
    v_xor_b32 v71, 0x80008000, v71
    s_mov_b64 exec, -1
    s_waitcnt vmcnt(4) lgkmcnt(2)
    v_mfma_f32_32x32x16_bf16 v[0:15], v[64:67], v[176:179], 0
    v_mul_f32 v255, v32, v152
    v_fmac_f32 v255, v33, v153
    v_fmac_f32 v255, v34, v154
    v_fmac_f32 v255, v35, v155
    v_fmac_f32 v255, v36, v156
    s_add_u32 m0, s21, 4096
    v_mfma_f32_32x32x16_bf16 v[16:31], v[68:71], v[176:179], v[16:31]
    v_lshl_add_u32 v238, v238, 10, v246
    v_lshl_add_u32 v239, v239, 10, v246
    buffer_load_dwordx4 v238, s[4:7], s40 offen lds
    buffer_load_dwordx4 v239, s[8:11], s40 offen offset:1024 lds
    ds_read_b64_tr_b16 v[176:177], v244 offset:6144
    ds_read_b64_tr_b16 v[184:185], v245 offset:6144
    v_fmac_f32 v255, v37, v157
    v_fmac_f32 v255, v38, v158
    v_fmac_f32 v255, v39, v159
    v_fmac_f32 v201, v40, v168
    v_fmac_f32 v201, v41, v169
    s_waitcnt lgkmcnt(0)
    s_mov_b64 exec, s[56:57]
    v_xor_b32 v76, 0x80008000, v76
    v_xor_b32 v77, 0x80008000, v77
    s_mov_b64 exec, -1
    v_mfma_f32_32x32x8_bf16 v[0:15], v[72:73], v[176:177], v[0:15]
    v_permlane32_swap_b32 v197, v255
    v_fmac_f32 v201, v42, v170
    v_fmac_f32 v201, v43, v171
    v_fmac_f32 v201, v44, v172
    v_fmac_f32 v201, v45, v173
    s_add_u32 m0, s21, 6144
    v_mfma_f32_32x32x8_bf16 v[16:31], v[76:77], v[176:177], v[16:31]
    v_lshl_add_u32 v240, v240, 10, v246
    v_lshl_add_u32 v241, v241, 10, v246
    buffer_load_dwordx4 v240, s[4:7], s41 offen lds
    buffer_load_dwordx4 v241, s[8:11], s41 offen offset:1024 lds
    v_fmac_f32 v201, v46, v174
    v_fmac_f32 v201, v47, v175
    v_add_f32 v255, v197, v255
    v_cvt_pk_bf16_f32 v254, v254, v255
    ds_write_b32 v253, v254 offset:512
    v_mfma_f32_32x32x16_bf16 v[32:47], v[64:67], v[180:183], 0
    v_mul_f32 v254, v0, v144
    v_fmac_f32 v254, v1, v145
    v_fmac_f32 v254, v2, v146
    v_fmac_f32 v254, v3, v147
    v_fmac_f32 v254, v4, v148
    v_fmac_f32 v254, v5, v149
    v_fmac_f32 v254, v6, v150
    v_fmac_f32 v254, v7, v151
    v_fma_f32 v202, v8, -v160, v202
    v_fma_f32 v202, v9, -v161, v202
    v_mfma_f32_32x32x16_bf16 v[48:63], v[68:71], v[180:183], v[48:63]
    s_waitcnt vmcnt(6)
    ds_read_b64_tr_b16 v[176:177], v244 offset:0
    ds_read_b64_tr_b16 v[178:179], v244 offset:1024
    ds_read_b64_tr_b16 v[180:181], v245 offset:0
    ds_read_b64_tr_b16 v[182:183], v245 offset:1024
    v_permlane32_swap_b32 v254, v200
    v_fma_f32 v202, v10, -v162, v202
    v_fma_f32 v202, v11, -v163, v202
    v_fma_f32 v202, v12, -v164, v202
    v_fma_f32 v202, v13, -v165, v202
    v_fma_f32 v202, v14, -v166, v202
    v_fma_f32 v202, v15, -v167, v202
    v_add_f32 v200, v254, v200
    v_fmac_f32 v198, v16, v112
    v_permlane32_swap_b32 v202, v254
    v_mfma_f32_32x32x8_bf16 v[32:47], v[72:73], v[184:185], v[32:47]
    v_fmac_f32 v198, v17, v113
    v_fmac_f32 v198, v18, v114
    v_fmac_f32 v198, v19, v115
    v_fmac_f32 v198, v20, v116
    v_fmac_f32 v198, v21, v117
    v_fmac_f32 v198, v22, v118
    v_fmac_f32 v198, v23, v119
    v_add_f32 v254, v202, v254
    v_mul_f32 v196, v24, v160
    v_fmac_f32 v196, v25, v161
    v_mfma_f32_32x32x8_bf16 v[48:63], v[76:77], v[184:185], v[48:63]
    v_add_u32 v249, s48, v249
    v_add_u32 v250, s49, v250
    ds_read_b32 v252, v251 offset:16
    ds_read_b64_tr_b16 v[64:65], v249 offset:0
    ds_read_b64_tr_b16 v[68:69], v249 offset:64
    ds_read_b64_tr_b16 v[66:67], v249 offset:256
    ds_read_b64_tr_b16 v[70:71], v249 offset:320
    s_mov_b64 exec, s[54:55]
    ds_read_u16_d16_hi v242, v250 offset:0
    s_mov_b64 exec, -1
    v_fmac_f32 v196, v26, v162
    v_fmac_f32 v196, v27, v163
    v_fmac_f32 v196, v28, v164
    v_fmac_f32 v196, v29, v165
    v_fmac_f32 v196, v30, v166
    v_fmac_f32 v196, v31, v167
    s_nop 1
    v_permlane32_swap_b32 v198, v196
    v_add_f32 v196, v198, v196
    v_mul_f32 v255, v32, v152
    v_fmac_f32 v255, v33, v153
    v_fmac_f32 v255, v34, v154
    v_fmac_f32 v255, v35, v155
    v_fmac_f32 v255, v36, v156
    v_fmac_f32 v255, v37, v157
    v_fmac_f32 v255, v38, v158
    v_fmac_f32 v255, v39, v159
    v_fma_f32 v203, v40, -v168, v203
    v_fma_f32 v203, v41, -v169, v203
    v_permlane32_swap_b32 v255, v201
    v_fma_f32 v203, v42, -v170, v203
    v_fma_f32 v203, v43, -v171, v203
    v_fma_f32 v203, v44, -v172, v203
    v_fma_f32 v203, v45, -v173, v203
    v_fma_f32 v203, v46, -v174, v203
    v_fma_f32 v203, v47, -v175, v203
    v_add_f32 v201, v255, v201
    v_fmac_f32 v199, v48, v120
    v_permlane32_swap_b32 v203, v255
    v_fmac_f32 v199, v49, v121
    v_fmac_f32 v199, v50, v122
    v_fmac_f32 v199, v51, v123
    v_fmac_f32 v199, v52, v124
    v_fmac_f32 v199, v53, v125
    v_fmac_f32 v199, v54, v126
    v_fmac_f32 v199, v55, v127
    v_add_f32 v255, v203, v255
    v_mul_f32 v197, v56, v168
    v_fmac_f32 v197, v57, v169
    v_fmac_f32 v197, v58, v170
    v_fmac_f32 v197, v59, v171
    v_fmac_f32 v197, v60, v172
    v_fmac_f32 v197, v61, v173
    v_fmac_f32 v197, v62, v174
    v_fmac_f32 v197, v63, v175
    s_nop 1
    v_permlane32_swap_b32 v199, v197
    v_add_f32 v197, v199, v197
    v_cvt_pk_bf16_f32 v200, v200, v201
    v_cvt_pk_bf16_f32 v254, v254, v255
    v_cvt_pk_bf16_f32 v196, v196, v197
    ds_write2st64_b32 v253, v200, v196 offset0:3 offset1:4
    s_mov_b64 exec, 0xffffffff
    ds_write_b32 v253, v254 offset:1280
    s_mov_b64 exec, -1
    s_add_u32 s50, s50, 1
    s_cmp_ge_u32 s50, 4
    s_cbranch_scc1 LAST1
    s_waitcnt lgkmcnt(7)
    v_readfirstlane_b32 s66, v252
    s_add_u32 s53, s53, 1
    v_mov_b32 v252, s53
    s_cmp_le_u32 s53, s66
    ds_write2_b32 v251, v252, v252 offset0:0 offset1:8
    s_setprio 1
    s_cbranch_scc1 PRIO_13
    s_setprio 0
PRIO_13:
    s_cmp_eq_u32 s52, 4
    s_cbranch_scc1 ITEM_1_4
    s_cmp_eq_u32 s52, 5
    s_cbranch_scc1 ITEM_1_5
    s_cmp_eq_u32 s52, 3
    s_cbranch_scc1 ITEM_1_3
    s_cmp_eq_u32 s52, 6
    s_cbranch_scc1 ITEM_1_6
    s_cmp_eq_u32 s52, 8
    s_cbranch_scc1 ITEM_1_8
    s_branch ITEM_1_2
.p2align 6
ITEM_1_6:
    s_mov_b64 exec, s[54:55]
    ds_read_u16_d16_hi v243, v250 offset:128
    s_mov_b64 exec, -1
    ds_read_b64_tr_b16 v[72:73], v249 offset:512
    ds_read_b64_tr_b16 v[76:77], v249 offset:576
    ds_read_b64_tr_b16 v[74:75], v249 offset:768
    ds_read_b64_tr_b16 v[78:79], v249 offset:832
    ds_read_b64_tr_b16 v[80:81], v249 offset:1024
    ds_read_b64_tr_b16 v[84:85], v249 offset:1088
    ds_read_b64_tr_b16 v[82:83], v249 offset:1280
    ds_read_b64_tr_b16 v[86:87], v249 offset:1344
    s_waitcnt lgkmcnt(9)
    v_mul_f32_dpp v196, v242, v64 row_newbcast:0 row_mask:0xf bank_mask:0xf
    v_mul_f32_dpp v197, v242, v65 row_newbcast:1 row_mask:0xf bank_mask:0xf
    v_mul_f32_dpp v198, v242, v64 row_newbcast:8 row_mask:0xf bank_mask:0xf
    v_mul_f32_dpp v199, v242, v65 row_newbcast:9 row_mask:0xf bank_mask:0xf
    v_mul_f32_dpp v200, v242, v68 row_newbcast:2 row_mask:0xf bank_mask:0xf
    v_mul_f32_dpp v201, v242, v69 row_newbcast:3 row_mask:0xf bank_mask:0xf
    v_mul_f32_dpp v202, v242, v68 row_newbcast:10 row_mask:0xf bank_mask:0xf
    v_mul_f32_dpp v203, v242, v69 row_newbcast:11 row_mask:0xf bank_mask:0xf
    v_cvt_pk_bf16_f32 v64, v196, v197
    v_cvt_pk_bf16_f32 v68, v198, v199
    v_cvt_pk_bf16_f32 v65, v200, v201
    v_cvt_pk_bf16_f32 v69, v202, v203
    v_mul_f32_dpp v196, v242, v66 row_newbcast:4 row_mask:0xf bank_mask:0xf
    v_mul_f32_dpp v197, v242, v67 row_newbcast:5 row_mask:0xf bank_mask:0xf
    v_mul_f32_dpp v198, v242, v66 row_newbcast:12 row_mask:0xf bank_mask:0xf
    v_mul_f32_dpp v199, v242, v67 row_newbcast:13 row_mask:0xf bank_mask:0xf
    v_mul_f32_dpp v200, v242, v70 row_newbcast:6 row_mask:0xf bank_mask:0xf
    v_mul_f32_dpp v201, v242, v71 row_newbcast:7 row_mask:0xf bank_mask:0xf
    v_mul_f32_dpp v202, v242, v70 row_newbcast:14 row_mask:0xf bank_mask:0xf
    v_mul_f32_dpp v203, v242, v71 row_newbcast:15 row_mask:0xf bank_mask:0xf
    v_cvt_pk_bf16_f32 v66, v196, v197
    v_cvt_pk_bf16_f32 v70, v198, v199
    v_cvt_pk_bf16_f32 v67, v200, v201
    v_cvt_pk_bf16_f32 v71, v202, v203
    s_mov_b64 exec, s[54:55]
    ds_read_u16_d16_hi v242, v250 offset:256
    s_mov_b64 exec, -1
    s_waitcnt vmcnt(4) lgkmcnt(5)
    v_mfma_f32_32x32x16_bf16 v[0:15], v[64:67], v[176:179], 0
    v_mul_f32_dpp v196, v243, v72 row_newbcast:0 row_mask:0xf bank_mask:0xf
    v_mul_f32_dpp v197, v243, v73 row_newbcast:1 row_mask:0xf bank_mask:0xf
    v_mul_f32_dpp v198, v243, v72 row_newbcast:8 row_mask:0xf bank_mask:0xf
    v_mul_f32_dpp v199, v243, v73 row_newbcast:9 row_mask:0xf bank_mask:0xf
    v_mul_f32_dpp v200, v243, v76 row_newbcast:2 row_mask:0xf bank_mask:0xf
    v_mul_f32_dpp v201, v243, v77 row_newbcast:3 row_mask:0xf bank_mask:0xf
    v_mul_f32_dpp v202, v243, v76 row_newbcast:10 row_mask:0xf bank_mask:0xf
    v_mul_f32_dpp v203, v243, v77 row_newbcast:11 row_mask:0xf bank_mask:0xf
    v_cvt_pk_bf16_f32 v72, v196, v197
    v_cvt_pk_bf16_f32 v76, v198, v199
    v_cvt_pk_bf16_f32 v73, v200, v201
    v_cvt_pk_bf16_f32 v77, v202, v203
    s_add_u32 m0, s21, 0
    v_mfma_f32_32x32x16_bf16 v[16:31], v[68:71], v[176:179], 0
    buffer_load_dwordx4 v236, s[4:7], s35 offen lds
    buffer_load_dwordx4 v237, s[8:11], s35 offen offset:1024 lds
    ds_read_b64_tr_b16 v[176:177], v244 offset:2048
    ds_read_b64_tr_b16 v[178:179], v244 offset:3072
    ds_read_b64_tr_b16 v[184:185], v245 offset:2048
    ds_read_b64_tr_b16 v[186:187], v245 offset:3072
    v_mul_f32_dpp v196, v243, v74 row_newbcast:4 row_mask:0xf bank_mask:0xf
    v_mul_f32_dpp v197, v243, v75 row_newbcast:5 row_mask:0xf bank_mask:0xf
    v_mul_f32_dpp v198, v243, v74 row_newbcast:12 row_mask:0xf bank_mask:0xf
    v_mul_f32_dpp v199, v243, v75 row_newbcast:13 row_mask:0xf bank_mask:0xf
    v_mul_f32_dpp v200, v243, v78 row_newbcast:6 row_mask:0xf bank_mask:0xf
    v_mul_f32_dpp v201, v243, v79 row_newbcast:7 row_mask:0xf bank_mask:0xf
    v_mul_f32_dpp v202, v243, v78 row_newbcast:14 row_mask:0xf bank_mask:0xf
    v_mul_f32_dpp v203, v243, v79 row_newbcast:15 row_mask:0xf bank_mask:0xf
    v_cvt_pk_bf16_f32 v74, v196, v197
    v_cvt_pk_bf16_f32 v78, v198, v199
    v_cvt_pk_bf16_f32 v75, v200, v201
    v_cvt_pk_bf16_f32 v79, v202, v203
    s_nop 0
    s_waitcnt vmcnt(4) lgkmcnt(0)
    v_mfma_f32_32x32x16_bf16 v[0:15], v[72:75], v[176:179], v[0:15]
    v_mul_f32_dpp v196, v242, v80 row_newbcast:0 row_mask:0xf bank_mask:0xf
    v_mul_f32_dpp v197, v242, v81 row_newbcast:1 row_mask:0xf bank_mask:0xf
    v_mul_f32_dpp v198, v242, v80 row_newbcast:8 row_mask:0xf bank_mask:0xf
    v_mul_f32_dpp v199, v242, v81 row_newbcast:9 row_mask:0xf bank_mask:0xf
    v_mul_f32_dpp v200, v242, v84 row_newbcast:2 row_mask:0xf bank_mask:0xf
    v_mul_f32_dpp v201, v242, v85 row_newbcast:3 row_mask:0xf bank_mask:0xf
    v_mul_f32_dpp v202, v242, v84 row_newbcast:10 row_mask:0xf bank_mask:0xf
    v_mul_f32_dpp v203, v242, v85 row_newbcast:11 row_mask:0xf bank_mask:0xf
    v_cvt_pk_bf16_f32 v80, v196, v197
    v_cvt_pk_bf16_f32 v84, v198, v199
    v_cvt_pk_bf16_f32 v81, v200, v201
    v_cvt_pk_bf16_f32 v85, v202, v203
    s_add_u32 m0, s21, 2048
    v_mfma_f32_32x32x16_bf16 v[16:31], v[76:79], v[176:179], v[16:31]
    buffer_load_dwordx4 v238, s[4:7], s35 offen lds
    buffer_load_dwordx4 v239, s[8:11], s35 offen offset:1024 lds
    ds_read_b64_tr_b16 v[176:177], v244 offset:4096
    ds_read_b64_tr_b16 v[178:179], v244 offset:5120
    ds_read_b64_tr_b16 v[188:189], v245 offset:4096
    ds_read_b64_tr_b16 v[190:191], v245 offset:5120
    v_mul_f32_dpp v196, v242, v82 row_newbcast:4 row_mask:0xf bank_mask:0xf
    v_mul_f32_dpp v197, v242, v83 row_newbcast:5 row_mask:0xf bank_mask:0xf
    v_mul_f32_dpp v198, v242, v82 row_newbcast:12 row_mask:0xf bank_mask:0xf
    v_mul_f32_dpp v199, v242, v83 row_newbcast:13 row_mask:0xf bank_mask:0xf
    v_mul_f32_dpp v200, v242, v86 row_newbcast:6 row_mask:0xf bank_mask:0xf
    v_mul_f32_dpp v201, v242, v87 row_newbcast:7 row_mask:0xf bank_mask:0xf
    v_mul_f32_dpp v202, v242, v86 row_newbcast:14 row_mask:0xf bank_mask:0xf
    v_mul_f32_dpp v203, v242, v87 row_newbcast:15 row_mask:0xf bank_mask:0xf
    v_cvt_pk_bf16_f32 v82, v196, v197
    v_cvt_pk_bf16_f32 v86, v198, v199
    v_cvt_pk_bf16_f32 v83, v200, v201
    v_cvt_pk_bf16_f32 v87, v202, v203
    s_nop 0
    s_waitcnt lgkmcnt(0)
    v_mfma_f32_32x32x16_bf16 v[0:15], v[80:83], v[176:179], v[0:15]
    s_add_u32 m0, s21, 4096
    v_mfma_f32_32x32x16_bf16 v[16:31], v[84:87], v[176:179], v[16:31]
    buffer_load_dwordx4 v234, s[4:7], s36 offen lds
    buffer_load_dwordx4 v235, s[8:11], s36 offen offset:1024 lds
    s_mov_b32 m0, s50
    s_nop 0
    s_movrels_b32 s71, s23
    s_movrels_b32 s33, s28
    s_and_b32 s70, s33, 0x70
    s_andn2_b32 s33, s33, 0x70
    v_xor_b32 v253, s70, v248
    v_add_u32 v253, s33, v253
    s_bfe_u32 s46, s71, 0x30012
    s_mov_b32 m0, s46
    s_and_b32 s66, s71, 0x3ffff
    s_movrels_b32 s68, s57
    s_movrels_b32 s69, s61
    s_sub_u32 s48, s66, s47
    s_mov_b32 s47, s66
    s_lshr_b32 s52, s71, 28
    s_lshl_b32 s67, s46, 9
    s_add_u32 s66, s66, s67
    s_sub_u32 s49, s66, s42
    s_mov_b32 s42, s66
    s_bfe_u32 s66, s68, 655360
    s_add_u32 s43, s42, s66
    s_bfe_u32 s39, s69, 655360
    s_bfe_u32 s66, s68, 655370
    s_add_u32 s44, s42, s66
    s_bfe_u32 s40, s69, 655370
    s_bfe_u32 s66, s68, 655380
    s_add_u32 s45, s42, s66
    s_bfe_u32 s41, s69, 655380
    v_add_u32 v252, s45, v247
    ds_read_u16 v240, v252
    ds_read_u16 v241, v252 offset:64
    v_mfma_f32_32x32x16_bf16 v[32:47], v[64:67], v[180:183], 0
    v_mul_f32 v196, v0, v96
    v_fmac_f32 v196, v1, v97
    v_fmac_f32 v196, v2, v98
    v_fmac_f32 v196, v3, v99
    v_fmac_f32 v196, v4, v100
    v_fmac_f32 v196, v5, v101
    v_fmac_f32 v196, v6, v102
    v_mfma_f32_32x32x16_bf16 v[48:63], v[68:71], v[180:183], 0
    v_fmac_f32 v196, v7, v103
    v_mul_f32 v198, v8, v128
    v_fmac_f32 v198, v9, v129
    v_fmac_f32 v198, v10, v130
    v_fmac_f32 v198, v11, v131
    v_fmac_f32 v198, v12, v132
    v_mfma_f32_32x32x16_bf16 v[32:47], v[72:75], v[184:187], v[32:47]
    v_fmac_f32 v198, v13, v133
    v_fmac_f32 v198, v14, v134
    v_fmac_f32 v198, v15, v135
    v_mul_f32 v200, v16, v128
    v_fmac_f32 v200, v17, v129
    v_permlane32_swap_b32 v196, v198
    v_mfma_f32_32x32x16_bf16 v[48:63], v[76:79], v[184:187], v[48:63]
    s_waitcnt vmcnt(6)
    ds_read_b64_tr_b16 v[176:177], v244 offset:6144
    ds_read_b64_tr_b16 v[178:179], v244 offset:7168
    ds_read_b64_tr_b16 v[180:181], v245 offset:6144
    ds_read_b64_tr_b16 v[182:183], v245 offset:7168
    v_fmac_f32 v200, v18, v130
    v_fmac_f32 v200, v19, v131
    v_fmac_f32 v200, v20, v132
    v_fmac_f32 v200, v21, v133
    v_fmac_f32 v200, v22, v134
    v_fmac_f32 v200, v23, v135
    v_mfma_f32_32x32x16_bf16 v[32:47], v[80:83], v[188:191], v[32:47]
    v_add_f32 v198, v196, v198
    v_mul_f32_e64 v202, v24, -v128
    v_fma_f32 v202, v25, -v129, v202
    v_fma_f32 v202, v26, -v130, v202
    v_fma_f32 v202, v27, -v131, v202
    v_fma_f32 v202, v28, -v132, v202
    v_mfma_f32_32x32x16_bf16 v[48:63], v[84:87], v[188:191], v[48:63]
    v_fma_f32 v202, v29, -v133, v202
    v_fma_f32 v202, v30, -v134, v202
    v_fma_f32 v202, v31, -v135, v202
    s_nop 1
    v_permlane32_swap_b32 v200, v202
    v_add_f32 v202, v200, v202
    s_waitcnt vmcnt(4) lgkmcnt(0)
    v_mfma_f32_32x32x16_bf16 v[0:15], v[64:67], v[176:179], 0
    v_mul_f32 v197, v32, v104
    v_fmac_f32 v197, v33, v105
    v_fmac_f32 v197, v34, v106
    v_fmac_f32 v197, v35, v107
    v_fmac_f32 v197, v36, v108
    v_fmac_f32 v197, v37, v109
    v_fmac_f32 v197, v38, v110
    s_add_u32 m0, s21, 6144
    v_mfma_f32_32x32x16_bf16 v[16:31], v[68:71], v[176:179], 0
    buffer_load_dwordx4 v236, s[4:7], s36 offen lds
    buffer_load_dwordx4 v237, s[8:11], s36 offen offset:1024 lds
    ds_read_b64_tr_b16 v[176:177], v244 offset:0
    ds_read_b64_tr_b16 v[178:179], v244 offset:1024
    ds_read_b64_tr_b16 v[184:185], v245 offset:0
    ds_read_b64_tr_b16 v[186:187], v245 offset:1024
    v_fmac_f32 v197, v39, v111
    v_mul_f32 v199, v40, v136
    v_fmac_f32 v199, v41, v137
    v_fmac_f32 v199, v42, v138
    v_fmac_f32 v199, v43, v139
    v_fmac_f32 v199, v44, v140
    v_fmac_f32 v199, v45, v141
    s_waitcnt vmcnt(4) lgkmcnt(0)
    v_mfma_f32_32x32x16_bf16 v[0:15], v[72:75], v[176:179], v[0:15]
    v_fmac_f32 v199, v46, v142
    v_fmac_f32 v199, v47, v143
    v_mul_f32 v201, v48, v136
    v_fmac_f32 v201, v49, v137
    v_permlane32_swap_b32 v197, v199
    v_fmac_f32 v201, v50, v138
    s_add_u32 m0, s21, 0
    v_mfma_f32_32x32x16_bf16 v[16:31], v[76:79], v[176:179], v[16:31]
    buffer_load_dwordx4 v238, s[4:7], s36 offen lds
    buffer_load_dwordx4 v239, s[8:11], s36 offen offset:1024 lds
    ds_read_b64_tr_b16 v[176:177], v244 offset:2048
    ds_read_b64_tr_b16 v[178:179], v244 offset:3072
    ds_read_b64_tr_b16 v[188:189], v245 offset:2048
    ds_read_b64_tr_b16 v[190:191], v245 offset:3072
    v_fmac_f32 v201, v51, v139
    v_fmac_f32 v201, v52, v140
    v_fmac_f32 v201, v53, v141
    v_fmac_f32 v201, v54, v142
    v_fmac_f32 v201, v55, v143
    v_add_f32 v199, v197, v199
    v_mul_f32_e64 v203, v56, -v136
    s_waitcnt lgkmcnt(0)
    v_mfma_f32_32x32x16_bf16 v[0:15], v[80:83], v[176:179], v[0:15]
    v_fma_f32 v203, v57, -v137, v203
    v_fma_f32 v203, v58, -v138, v203
    v_fma_f32 v203, v59, -v139, v203
    v_fma_f32 v203, v60, -v140, v203
    v_fma_f32 v203, v61, -v141, v203
    v_fma_f32 v203, v62, -v142, v203
    v_fma_f32 v203, v63, -v143, v203
    s_add_u32 m0, s21, 2048
    v_mfma_f32_32x32x16_bf16 v[16:31], v[84:87], v[176:179], v[16:31]
    buffer_load_dwordx4 v234, s[4:7], s37 offen lds
    buffer_load_dwordx4 v235, s[8:11], s37 offen offset:1024 lds
    v_add_u32 v252, s42, v247
    ds_read_u16 v234, v252
    ds_read_u16 v235, v252 offset:64
    s_nop 1
    v_permlane32_swap_b32 v201, v203
    v_add_f32 v203, v201, v203
    v_cvt_pk_bf16_f32 v198, v198, v199
    v_cvt_pk_bf16_f32 v202, v202, v203
    ds_write2st64_b32 v253, v198, v202 offset0:0 offset1:1
    v_mfma_f32_32x32x16_bf16 v[32:47], v[64:67], v[180:183], 0
    v_mul_f32 v196, v0, v144
    v_fmac_f32 v196, v1, v145
    v_fmac_f32 v196, v2, v146
    v_fmac_f32 v196, v3, v147
    v_fmac_f32 v196, v4, v148
    v_fmac_f32 v196, v5, v149
    v_mfma_f32_32x32x16_bf16 v[48:63], v[68:71], v[180:183], 0
    v_fmac_f32 v196, v6, v150
    v_fmac_f32 v196, v7, v151
    v_mul_f32 v198, v8, v112
    v_fmac_f32 v198, v9, v113
    v_fmac_f32 v198, v10, v114
    v_mfma_f32_32x32x16_bf16 v[32:47], v[72:75], v[184:187], v[32:47]
    v_fmac_f32 v198, v11, v115
    v_fmac_f32 v198, v12, v116
    v_fmac_f32 v198, v13, v117
    v_fmac_f32 v198, v14, v118
    v_fmac_f32 v198, v15, v119
    v_mfma_f32_32x32x16_bf16 v[48:63], v[76:79], v[184:187], v[48:63]
    s_waitcnt vmcnt(6)
    ds_read_b64_tr_b16 v[176:177], v244 offset:4096
    ds_read_b64_tr_b16 v[178:179], v244 offset:5120
    ds_read_b64_tr_b16 v[180:181], v245 offset:4096
    ds_read_b64_tr_b16 v[182:183], v245 offset:5120
    v_mul_f32_e64 v200, v16, -v160
    v_fma_f32 v200, v17, -v161, v200
    v_fma_f32 v200, v18, -v162, v200
    v_fma_f32 v200, v19, -v163, v200
    v_fma_f32 v200, v20, -v164, v200
    v_fma_f32 v200, v21, -v165, v200
    v_mfma_f32_32x32x16_bf16 v[32:47], v[80:83], v[188:191], v[32:47]
    v_fma_f32 v200, v22, -v166, v200
    v_fma_f32 v200, v23, -v167, v200
    v_mul_f32_e64 v202, v24, -v160
    v_fma_f32 v202, v25, -v161, v202
    v_fma_f32 v202, v26, -v162, v202
    v_mfma_f32_32x32x16_bf16 v[48:63], v[84:87], v[188:191], v[48:63]
    v_fma_f32 v202, v27, -v163, v202
    v_fma_f32 v202, v28, -v164, v202
    v_fma_f32 v202, v29, -v165, v202
    v_fma_f32 v202, v30, -v166, v202
    v_fma_f32 v202, v31, -v167, v202
    s_waitcnt vmcnt(4) lgkmcnt(0)
    v_mfma_f32_32x32x16_bf16 v[0:15], v[64:67], v[176:179], 0
    v_mul_f32 v197, v32, v152
    v_fmac_f32 v197, v33, v153
    v_fmac_f32 v197, v34, v154
    v_fmac_f32 v197, v35, v155
    v_fmac_f32 v197, v36, v156
    v_fmac_f32 v197, v37, v157
    s_add_u32 m0, s21, 4096
    v_mfma_f32_32x32x16_bf16 v[16:31], v[68:71], v[176:179], 0
    buffer_load_dwordx4 v236, s[4:7], s37 offen lds
    buffer_load_dwordx4 v237, s[8:11], s37 offen offset:1024 lds
    ds_read_b64_tr_b16 v[176:177], v244 offset:6144
    ds_read_b64_tr_b16 v[178:179], v244 offset:7168
    ds_read_b64_tr_b16 v[184:185], v245 offset:6144
    ds_read_b64_tr_b16 v[186:187], v245 offset:7168
    v_add_u32 v252, s43, v247
    ds_read_u16 v236, v252
    ds_read_u16 v237, v252 offset:64
    v_fmac_f32 v197, v38, v158
    v_fmac_f32 v197, v39, v159
    v_mul_f32 v199, v40, v120
    v_fmac_f32 v199, v41, v121
    v_fmac_f32 v199, v42, v122
    s_waitcnt vmcnt(4) lgkmcnt(2)
    v_mfma_f32_32x32x16_bf16 v[0:15], v[72:75], v[176:179], v[0:15]
    v_fmac_f32 v199, v43, v123
    v_fmac_f32 v199, v44, v124
    v_fmac_f32 v199, v45, v125
    v_fmac_f32 v199, v46, v126
    v_fmac_f32 v199, v47, v127
    s_add_u32 m0, s21, 6144
    v_mfma_f32_32x32x16_bf16 v[16:31], v[76:79], v[176:179], v[16:31]
    buffer_load_dwordx4 v238, s[4:7], s37 offen lds
    buffer_load_dwordx4 v239, s[8:11], s37 offen offset:1024 lds
    ds_read_b64_tr_b16 v[176:177], v244 offset:0
    ds_read_b64_tr_b16 v[178:179], v244 offset:1024
    ds_read_b64_tr_b16 v[188:189], v245 offset:0
    ds_read_b64_tr_b16 v[190:191], v245 offset:1024
    v_add_u32 v252, s44, v247
    ds_read_u16 v238, v252
    ds_read_u16 v239, v252 offset:64
    v_mul_f32_e64 v201, v48, -v168
    v_fma_f32 v201, v49, -v169, v201
    v_fma_f32 v201, v50, -v170, v201
    v_fma_f32 v201, v51, -v171, v201
    v_fma_f32 v201, v52, -v172, v201
    v_fma_f32 v201, v53, -v173, v201
    s_waitcnt lgkmcnt(2)
    v_mfma_f32_32x32x16_bf16 v[0:15], v[80:83], v[176:179], v[0:15]
    v_fma_f32 v201, v54, -v174, v201
    v_fma_f32 v201, v55, -v175, v201
    v_mul_f32_e64 v203, v56, -v168
    v_fma_f32 v203, v57, -v169, v203
    v_fma_f32 v203, v58, -v170, v203
    s_add_u32 m0, s21, 0
    v_mfma_f32_32x32x16_bf16 v[16:31], v[84:87], v[176:179], v[16:31]
    v_lshl_add_u32 v234, v234, 10, v246
    v_lshl_add_u32 v235, v235, 10, v246
    buffer_load_dwordx4 v234, s[4:7], s38 offen lds
    buffer_load_dwordx4 v235, s[8:11], s38 offen offset:1024 lds
    v_fma_f32 v203, v59, -v171, v203
    v_fma_f32 v203, v60, -v172, v203
    v_fma_f32 v203, v61, -v173, v203
    v_fma_f32 v203, v62, -v174, v203
    v_fma_f32 v203, v63, -v175, v203
    v_mfma_f32_32x32x16_bf16 v[32:47], v[64:67], v[180:183], 0
    v_mul_f32 v254, v0, v144
    v_fmac_f32 v254, v1, v145
    v_fmac_f32 v254, v2, v146
    v_mfma_f32_32x32x16_bf16 v[48:63], v[68:71], v[180:183], 0
    ds_swizzle_b32 v68, v68 offset:0x401F
    ds_swizzle_b32 v69, v69 offset:0x401F
    ds_swizzle_b32 v70, v70 offset:0x401F
    ds_swizzle_b32 v71, v71 offset:0x401F
    v_fmac_f32 v254, v3, v147
    v_fmac_f32 v254, v4, v148
    v_fmac_f32 v254, v5, v149
    v_mfma_f32_32x32x16_bf16 v[32:47], v[72:75], v[184:187], v[32:47]
    v_fmac_f32 v254, v6, v150
    v_fmac_f32 v254, v7, v151
    v_fmac_f32 v200, v8, v160
    v_mfma_f32_32x32x16_bf16 v[48:63], v[76:79], v[184:187], v[48:63]
    ds_swizzle_b32 v76, v76 offset:0x401F
    ds_swizzle_b32 v77, v77 offset:0x401F
    ds_swizzle_b32 v78, v78 offset:0x401F
    ds_swizzle_b32 v79, v79 offset:0x401F
    s_waitcnt vmcnt(6)
    ds_read_b64_tr_b16 v[176:177], v244 offset:2048
    ds_read_b64_tr_b16 v[178:179], v244 offset:3072
    ds_read_b64_tr_b16 v[180:181], v245 offset:2048
    ds_read_b64_tr_b16 v[182:183], v245 offset:3072
    v_fmac_f32 v200, v9, v161
    v_permlane32_swap_b32 v196, v254
    v_fmac_f32 v200, v10, v162
    v_mfma_f32_32x32x16_bf16 v[32:47], v[80:83], v[188:191], v[32:47]
    v_fmac_f32 v200, v11, v163
    v_fmac_f32 v200, v12, v164
    v_fmac_f32 v200, v13, v165
    v_mfma_f32_32x32x16_bf16 v[48:63], v[84:87], v[188:191], v[48:63]
    ds_swizzle_b32 v84, v84 offset:0x401F
    ds_swizzle_b32 v85, v85 offset:0x401F
    ds_swizzle_b32 v86, v86 offset:0x401F
    ds_swizzle_b32 v87, v87 offset:0x401F
    v_fmac_f32 v200, v14, v166
    v_fmac_f32 v200, v15, v167
    v_add_f32 v254, v196, v254
    s_waitcnt lgkmcnt(8)
    s_mov_b64 exec, s[56:57]
    v_xor_b32 v68, 0x80008000, v68
    v_xor_b32 v69, 0x80008000, v69
    v_xor_b32 v70, 0x80008000, v70
    v_xor_b32 v71, 0x80008000, v71
    v_xor_b32 v76, 0x80008000, v76
    v_xor_b32 v77, 0x80008000, v77
    v_xor_b32 v78, 0x80008000, v78
    v_xor_b32 v79, 0x80008000, v79
    s_mov_b64 exec, -1
    s_waitcnt vmcnt(4) lgkmcnt(4)
    v_mfma_f32_32x32x16_bf16 v[0:15], v[64:67], v[176:179], 0
    v_mul_f32 v255, v32, v152
    v_fmac_f32 v255, v33, v153
    v_fmac_f32 v255, v34, v154
    v_fmac_f32 v255, v35, v155
    s_add_u32 m0, s21, 2048
    v_mfma_f32_32x32x16_bf16 v[16:31], v[68:71], v[176:179], v[16:31]
    v_lshl_add_u32 v236, v236, 10, v246
    v_lshl_add_u32 v237, v237, 10, v246
    buffer_load_dwordx4 v236, s[4:7], s39 offen lds
    buffer_load_dwordx4 v237, s[8:11], s39 offen offset:1024 lds
    ds_read_b64_tr_b16 v[176:177], v244 offset:4096
    ds_read_b64_tr_b16 v[178:179], v244 offset:5120
    ds_read_b64_tr_b16 v[184:185], v245 offset:4096
    ds_read_b64_tr_b16 v[186:187], v245 offset:5120
    v_fmac_f32 v255, v36, v156
    v_fmac_f32 v255, v37, v157
    v_fmac_f32 v255, v38, v158
    s_waitcnt vmcnt(4) lgkmcnt(0)
    v_mfma_f32_32x32x16_bf16 v[0:15], v[72:75], v[176:179], v[0:15]
    v_fmac_f32 v255, v39, v159
    v_fmac_f32 v201, v40, v168
    v_fmac_f32 v201, v41, v169
    s_add_u32 m0, s21, 4096
    v_mfma_f32_32x32x16_bf16 v[16:31], v[76:79], v[176:179], v[16:31]
    v_lshl_add_u32 v238, v238, 10, v246
    v_lshl_add_u32 v239, v239, 10, v246
    buffer_load_dwordx4 v238, s[4:7], s40 offen lds
    buffer_load_dwordx4 v239, s[8:11], s40 offen offset:1024 lds
    ds_read_b64_tr_b16 v[176:177], v244 offset:6144
    ds_read_b64_tr_b16 v[178:179], v244 offset:7168
    ds_read_b64_tr_b16 v[188:189], v245 offset:6144
    ds_read_b64_tr_b16 v[190:191], v245 offset:7168
    v_permlane32_swap_b32 v197, v255
    v_fmac_f32 v201, v42, v170
    v_fmac_f32 v201, v43, v171
    v_fmac_f32 v201, v44, v172
    s_waitcnt lgkmcnt(0)
    s_mov_b64 exec, s[56:57]
    v_xor_b32 v84, 0x80008000, v84
    v_xor_b32 v85, 0x80008000, v85
    v_xor_b32 v86, 0x80008000, v86
    v_xor_b32 v87, 0x80008000, v87
    s_mov_b64 exec, -1
    v_mfma_f32_32x32x16_bf16 v[0:15], v[80:83], v[176:179], v[0:15]
    v_fmac_f32 v201, v45, v173
    v_fmac_f32 v201, v46, v174
    v_fmac_f32 v201, v47, v175
    s_add_u32 m0, s21, 6144
    v_mfma_f32_32x32x16_bf16 v[16:31], v[84:87], v[176:179], v[16:31]
    v_lshl_add_u32 v240, v240, 10, v246
    v_lshl_add_u32 v241, v241, 10, v246
    buffer_load_dwordx4 v240, s[4:7], s41 offen lds
    buffer_load_dwordx4 v241, s[8:11], s41 offen offset:1024 lds
    v_add_f32 v255, v197, v255
    v_cvt_pk_bf16_f32 v254, v254, v255
    ds_write_b32 v253, v254 offset:512
    v_mfma_f32_32x32x16_bf16 v[32:47], v[64:67], v[180:183], 0
    v_mul_f32 v254, v0, v144
    v_fmac_f32 v254, v1, v145
    v_fmac_f32 v254, v2, v146
    v_fmac_f32 v254, v3, v147
    v_fmac_f32 v254, v4, v148
    v_fmac_f32 v254, v5, v149
    v_fmac_f32 v254, v6, v150
    v_mfma_f32_32x32x16_bf16 v[48:63], v[68:71], v[180:183], v[48:63]
    v_fmac_f32 v254, v7, v151
    v_fma_f32 v202, v8, -v160, v202
    v_fma_f32 v202, v9, -v161, v202
    v_permlane32_swap_b32 v254, v200
    v_fma_f32 v202, v10, -v162, v202
    v_fma_f32 v202, v11, -v163, v202
    v_mfma_f32_32x32x16_bf16 v[32:47], v[72:75], v[184:187], v[32:47]
    v_fma_f32 v202, v12, -v164, v202
    v_fma_f32 v202, v13, -v165, v202
    v_fma_f32 v202, v14, -v166, v202
    v_fma_f32 v202, v15, -v167, v202
    v_add_f32 v200, v254, v200
    v_fmac_f32 v198, v16, v112
    v_permlane32_swap_b32 v202, v254
    v_mfma_f32_32x32x16_bf16 v[48:63], v[76:79], v[184:187], v[48:63]
    s_waitcnt vmcnt(6)
    ds_read_b64_tr_b16 v[176:177], v244 offset:0
    ds_read_b64_tr_b16 v[178:179], v244 offset:1024
    ds_read_b64_tr_b16 v[180:181], v245 offset:0
    ds_read_b64_tr_b16 v[182:183], v245 offset:1024
    v_fmac_f32 v198, v17, v113
    v_fmac_f32 v198, v18, v114
    v_fmac_f32 v198, v19, v115
    v_fmac_f32 v198, v20, v116
    v_fmac_f32 v198, v21, v117
    v_fmac_f32 v198, v22, v118
    v_mfma_f32_32x32x16_bf16 v[32:47], v[80:83], v[188:191], v[32:47]
    v_fmac_f32 v198, v23, v119
    v_add_f32 v254, v202, v254
    v_mul_f32 v196, v24, v160
    v_fmac_f32 v196, v25, v161
    v_fmac_f32 v196, v26, v162
    v_fmac_f32 v196, v27, v163
    v_fmac_f32 v196, v28, v164
    v_mfma_f32_32x32x16_bf16 v[48:63], v[84:87], v[188:191], v[48:63]
    v_add_u32 v249, s48, v249
    v_add_u32 v250, s49, v250
    ds_read_b32 v252, v251 offset:16
    ds_read_b64_tr_b16 v[64:65], v249 offset:0
    ds_read_b64_tr_b16 v[68:69], v249 offset:64
    ds_read_b64_tr_b16 v[66:67], v249 offset:256
    ds_read_b64_tr_b16 v[70:71], v249 offset:320
    s_mov_b64 exec, s[54:55]
    ds_read_u16_d16_hi v242, v250 offset:0
    s_mov_b64 exec, -1
    v_fmac_f32 v196, v29, v165
    v_fmac_f32 v196, v30, v166
    v_fmac_f32 v196, v31, v167
    s_nop 1
    v_permlane32_swap_b32 v198, v196
    v_add_f32 v196, v198, v196
    v_mul_f32 v255, v32, v152
    v_fmac_f32 v255, v33, v153
    v_fmac_f32 v255, v34, v154
    v_fmac_f32 v255, v35, v155
    v_fmac_f32 v255, v36, v156
    v_fmac_f32 v255, v37, v157
    v_fmac_f32 v255, v38, v158
    v_fmac_f32 v255, v39, v159
    v_fma_f32 v203, v40, -v168, v203
    v_fma_f32 v203, v41, -v169, v203
    v_permlane32_swap_b32 v255, v201
    v_fma_f32 v203, v42, -v170, v203
    v_fma_f32 v203, v43, -v171, v203
    v_fma_f32 v203, v44, -v172, v203
    v_fma_f32 v203, v45, -v173, v203
    v_fma_f32 v203, v46, -v174, v203
    v_fma_f32 v203, v47, -v175, v203
    v_add_f32 v201, v255, v201
    v_fmac_f32 v199, v48, v120
    v_permlane32_swap_b32 v203, v255
    v_fmac_f32 v199, v49, v121
    v_fmac_f32 v199, v50, v122
    v_fmac_f32 v199, v51, v123
    v_fmac_f32 v199, v52, v124
    v_fmac_f32 v199, v53, v125
    v_fmac_f32 v199, v54, v126
    v_fmac_f32 v199, v55, v127
    v_add_f32 v255, v203, v255
    v_mul_f32 v197, v56, v168
    v_fmac_f32 v197, v57, v169
    v_fmac_f32 v197, v58, v170
    v_fmac_f32 v197, v59, v171
    v_fmac_f32 v197, v60, v172
    v_fmac_f32 v197, v61, v173
    v_fmac_f32 v197, v62, v174
    v_fmac_f32 v197, v63, v175
    s_nop 1
    v_permlane32_swap_b32 v199, v197
    v_add_f32 v197, v199, v197
    v_cvt_pk_bf16_f32 v200, v200, v201
    v_cvt_pk_bf16_f32 v254, v254, v255
    v_cvt_pk_bf16_f32 v196, v196, v197
    ds_write2st64_b32 v253, v200, v196 offset0:3 offset1:4
    s_mov_b64 exec, 0xffffffff
    ds_write_b32 v253, v254 offset:1280
    s_mov_b64 exec, -1
    s_add_u32 s50, s50, 1
    s_cmp_ge_u32 s50, 4
    s_cbranch_scc1 LAST1
    s_waitcnt lgkmcnt(7)
    v_readfirstlane_b32 s66, v252
    s_add_u32 s53, s53, 1
    v_mov_b32 v252, s53
    s_cmp_le_u32 s53, s66
    ds_write2_b32 v251, v252, v252 offset0:0 offset1:8
    s_setprio 1
    s_cbranch_scc1 PRIO_14
    s_setprio 0
PRIO_14:
    s_cmp_eq_u32 s52, 4
    s_cbranch_scc1 ITEM_1_4
    s_cmp_eq_u32 s52, 5
    s_cbranch_scc1 ITEM_1_5
    s_cmp_eq_u32 s52, 3
    s_cbranch_scc1 ITEM_1_3
    s_cmp_eq_u32 s52, 6
    s_cbranch_scc1 ITEM_1_6
    s_cmp_eq_u32 s52, 8
    s_cbranch_scc1 ITEM_1_8
    s_branch ITEM_1_2
.p2align 6
ITEM_1_8:
    s_mov_b64 exec, s[54:55]
    ds_read_u16_d16_hi v243, v250 offset:128
    s_mov_b64 exec, -1
    ds_read_b64_tr_b16 v[72:73], v249 offset:512
    ds_read_b64_tr_b16 v[76:77], v249 offset:576
    ds_read_b64_tr_b16 v[74:75], v249 offset:768
    ds_read_b64_tr_b16 v[78:79], v249 offset:832
    ds_read_b64_tr_b16 v[80:81], v249 offset:1024
    ds_read_b64_tr_b16 v[84:85], v249 offset:1088
    ds_read_b64_tr_b16 v[82:83], v249 offset:1280
    ds_read_b64_tr_b16 v[86:87], v249 offset:1344
    ds_read_b64_tr_b16 v[88:89], v249 offset:1536
    ds_read_b64_tr_b16 v[92:93], v249 offset:1600
    ds_read_b64_tr_b16 v[90:91], v249 offset:1792
    ds_read_b64_tr_b16 v[94:95], v249 offset:1856
    s_waitcnt lgkmcnt(13)
    v_mul_f32_dpp v196, v242, v64 row_newbcast:0 row_mask:0xf bank_mask:0xf
    v_mul_f32_dpp v197, v242, v65 row_newbcast:1 row_mask:0xf bank_mask:0xf
    v_mul_f32_dpp v198, v242, v64 row_newbcast:8 row_mask:0xf bank_mask:0xf
    v_mul_f32_dpp v199, v242, v65 row_newbcast:9 row_mask:0xf bank_mask:0xf
    v_mul_f32_dpp v200, v242, v68 row_newbcast:2 row_mask:0xf bank_mask:0xf
    v_mul_f32_dpp v201, v242, v69 row_newbcast:3 row_mask:0xf bank_mask:0xf
    v_mul_f32_dpp v202, v242, v68 row_newbcast:10 row_mask:0xf bank_mask:0xf
    v_mul_f32_dpp v203, v242, v69 row_newbcast:11 row_mask:0xf bank_mask:0xf
    v_cvt_pk_bf16_f32 v64, v196, v197
    v_cvt_pk_bf16_f32 v68, v198, v199
    v_cvt_pk_bf16_f32 v65, v200, v201
    v_cvt_pk_bf16_f32 v69, v202, v203
    v_mul_f32_dpp v196, v242, v66 row_newbcast:4 row_mask:0xf bank_mask:0xf
    v_mul_f32_dpp v197, v242, v67 row_newbcast:5 row_mask:0xf bank_mask:0xf
    v_mul_f32_dpp v198, v242, v66 row_newbcast:12 row_mask:0xf bank_mask:0xf
    v_mul_f32_dpp v199, v242, v67 row_newbcast:13 row_mask:0xf bank_mask:0xf
    v_mul_f32_dpp v200, v242, v70 row_newbcast:6 row_mask:0xf bank_mask:0xf
    v_mul_f32_dpp v201, v242, v71 row_newbcast:7 row_mask:0xf bank_mask:0xf
    v_mul_f32_dpp v202, v242, v70 row_newbcast:14 row_mask:0xf bank_mask:0xf
    v_mul_f32_dpp v203, v242, v71 row_newbcast:15 row_mask:0xf bank_mask:0xf
    v_cvt_pk_bf16_f32 v66, v196, v197
    v_cvt_pk_bf16_f32 v70, v198, v199
    v_cvt_pk_bf16_f32 v67, v200, v201
    v_cvt_pk_bf16_f32 v71, v202, v203
    s_mov_b64 exec, s[54:55]
    ds_read_u16_d16_hi v242, v250 offset:256
    s_mov_b64 exec, -1
    s_waitcnt vmcnt(4) lgkmcnt(9)
    v_mfma_f32_32x32x16_bf16 v[0:15], v[64:67], v[176:179], 0
    v_mul_f32_dpp v196, v243, v72 row_newbcast:0 row_mask:0xf bank_mask:0xf
    v_mul_f32_dpp v197, v243, v73 row_newbcast:1 row_mask:0xf bank_mask:0xf
    v_mul_f32_dpp v198, v243, v72 row_newbcast:8 row_mask:0xf bank_mask:0xf
    v_mul_f32_dpp v199, v243, v73 row_newbcast:9 row_mask:0xf bank_mask:0xf
    v_mul_f32_dpp v200, v243, v76 row_newbcast:2 row_mask:0xf bank_mask:0xf
    v_mul_f32_dpp v201, v243, v77 row_newbcast:3 row_mask:0xf bank_mask:0xf
    v_mul_f32_dpp v202, v243, v76 row_newbcast:10 row_mask:0xf bank_mask:0xf
    v_mul_f32_dpp v203, v243, v77 row_newbcast:11 row_mask:0xf bank_mask:0xf
    v_cvt_pk_bf16_f32 v72, v196, v197
    v_cvt_pk_bf16_f32 v76, v198, v199
    v_cvt_pk_bf16_f32 v73, v200, v201
    v_cvt_pk_bf16_f32 v77, v202, v203
    s_add_u32 m0, s21, 0
    v_mfma_f32_32x32x16_bf16 v[16:31], v[68:71], v[176:179], 0
    buffer_load_dwordx4 v234, s[4:7], s35 offen lds
    buffer_load_dwordx4 v235, s[8:11], s35 offen offset:1024 lds
    ds_read_b64_tr_b16 v[176:177], v244 offset:2048
    ds_read_b64_tr_b16 v[178:179], v244 offset:3072
    ds_read_b64_tr_b16 v[184:185], v245 offset:2048
    ds_read_b64_tr_b16 v[186:187], v245 offset:3072
    v_mul_f32_dpp v196, v243, v74 row_newbcast:4 row_mask:0xf bank_mask:0xf
    v_mul_f32_dpp v197, v243, v75 row_newbcast:5 row_mask:0xf bank_mask:0xf
    v_mul_f32_dpp v198, v243, v74 row_newbcast:12 row_mask:0xf bank_mask:0xf
    v_mul_f32_dpp v199, v243, v75 row_newbcast:13 row_mask:0xf bank_mask:0xf
    v_mul_f32_dpp v200, v243, v78 row_newbcast:6 row_mask:0xf bank_mask:0xf
    v_mul_f32_dpp v201, v243, v79 row_newbcast:7 row_mask:0xf bank_mask:0xf
    v_mul_f32_dpp v202, v243, v78 row_newbcast:14 row_mask:0xf bank_mask:0xf
    v_mul_f32_dpp v203, v243, v79 row_newbcast:15 row_mask:0xf bank_mask:0xf
    v_cvt_pk_bf16_f32 v74, v196, v197
    v_cvt_pk_bf16_f32 v78, v198, v199
    v_cvt_pk_bf16_f32 v75, v200, v201
    v_cvt_pk_bf16_f32 v79, v202, v203
    s_mov_b64 exec, s[54:55]
    ds_read_u16_d16_hi v243, v250 offset:384
    s_mov_b64 exec, -1
    s_waitcnt vmcnt(4) lgkmcnt(1)
    v_mfma_f32_32x32x16_bf16 v[0:15], v[72:75], v[176:179], v[0:15]
    v_mul_f32_dpp v196, v242, v80 row_newbcast:0 row_mask:0xf bank_mask:0xf
    v_mul_f32_dpp v197, v242, v81 row_newbcast:1 row_mask:0xf bank_mask:0xf
    v_mul_f32_dpp v198, v242, v80 row_newbcast:8 row_mask:0xf bank_mask:0xf
    v_mul_f32_dpp v199, v242, v81 row_newbcast:9 row_mask:0xf bank_mask:0xf
    v_mul_f32_dpp v200, v242, v84 row_newbcast:2 row_mask:0xf bank_mask:0xf
    v_mul_f32_dpp v201, v242, v85 row_newbcast:3 row_mask:0xf bank_mask:0xf
    v_mul_f32_dpp v202, v242, v84 row_newbcast:10 row_mask:0xf bank_mask:0xf
    v_mul_f32_dpp v203, v242, v85 row_newbcast:11 row_mask:0xf bank_mask:0xf
    v_cvt_pk_bf16_f32 v80, v196, v197
    v_cvt_pk_bf16_f32 v84, v198, v199
    v_cvt_pk_bf16_f32 v81, v200, v201
    v_cvt_pk_bf16_f32 v85, v202, v203
    s_add_u32 m0, s21, 2048
    v_mfma_f32_32x32x16_bf16 v[16:31], v[76:79], v[176:179], v[16:31]
    buffer_load_dwordx4 v236, s[4:7], s35 offen lds
    buffer_load_dwordx4 v237, s[8:11], s35 offen offset:1024 lds
    ds_read_b64_tr_b16 v[176:177], v244 offset:4096
    ds_read_b64_tr_b16 v[178:179], v244 offset:5120
    ds_read_b64_tr_b16 v[188:189], v245 offset:4096
    ds_read_b64_tr_b16 v[190:191], v245 offset:5120
    v_mul_f32_dpp v196, v242, v82 row_newbcast:4 row_mask:0xf bank_mask:0xf
    v_mul_f32_dpp v197, v242, v83 row_newbcast:5 row_mask:0xf bank_mask:0xf
    v_mul_f32_dpp v198, v242, v82 row_newbcast:12 row_mask:0xf bank_mask:0xf
    v_mul_f32_dpp v199, v242, v83 row_newbcast:13 row_mask:0xf bank_mask:0xf
    v_mul_f32_dpp v200, v242, v86 row_newbcast:6 row_mask:0xf bank_mask:0xf
    v_mul_f32_dpp v201, v242, v87 row_newbcast:7 row_mask:0xf bank_mask:0xf
    v_mul_f32_dpp v202, v242, v86 row_newbcast:14 row_mask:0xf bank_mask:0xf
    v_mul_f32_dpp v203, v242, v87 row_newbcast:15 row_mask:0xf bank_mask:0xf
    v_cvt_pk_bf16_f32 v82, v196, v197
    v_cvt_pk_bf16_f32 v86, v198, v199
    v_cvt_pk_bf16_f32 v83, v200, v201
    v_cvt_pk_bf16_f32 v87, v202, v203
    s_nop 0
    s_waitcnt vmcnt(4) lgkmcnt(0)
    v_mfma_f32_32x32x16_bf16 v[0:15], v[80:83], v[176:179], v[0:15]
    v_mul_f32_dpp v196, v243, v88 row_newbcast:0 row_mask:0xf bank_mask:0xf
    v_mul_f32_dpp v197, v243, v89 row_newbcast:1 row_mask:0xf bank_mask:0xf
    v_mul_f32_dpp v198, v243, v88 row_newbcast:8 row_mask:0xf bank_mask:0xf
    v_mul_f32_dpp v199, v243, v89 row_newbcast:9 row_mask:0xf bank_mask:0xf
    v_mul_f32_dpp v200, v243, v92 row_newbcast:2 row_mask:0xf bank_mask:0xf
    v_mul_f32_dpp v201, v243, v93 row_newbcast:3 row_mask:0xf bank_mask:0xf
    v_mul_f32_dpp v202, v243, v92 row_newbcast:10 row_mask:0xf bank_mask:0xf
    v_mul_f32_dpp v203, v243, v93 row_newbcast:11 row_mask:0xf bank_mask:0xf
    v_cvt_pk_bf16_f32 v88, v196, v197
    v_cvt_pk_bf16_f32 v92, v198, v199
    v_cvt_pk_bf16_f32 v89, v200, v201
    v_cvt_pk_bf16_f32 v93, v202, v203
    s_add_u32 m0, s21, 4096
    v_mfma_f32_32x32x16_bf16 v[16:31], v[84:87], v[176:179], v[16:31]
    buffer_load_dwordx4 v238, s[4:7], s35 offen lds
    buffer_load_dwordx4 v239, s[8:11], s35 offen offset:1024 lds
    ds_read_b64_tr_b16 v[176:177], v244 offset:6144
    ds_read_b64_tr_b16 v[178:179], v244 offset:7168
    ds_read_b64_tr_b16 v[192:193], v245 offset:6144
    ds_read_b64_tr_b16 v[194:195], v245 offset:7168
    v_mul_f32_dpp v196, v243, v90 row_newbcast:4 row_mask:0xf bank_mask:0xf
    v_mul_f32_dpp v197, v243, v91 row_newbcast:5 row_mask:0xf bank_mask:0xf
    v_mul_f32_dpp v198, v243, v90 row_newbcast:12 row_mask:0xf bank_mask:0xf
    v_mul_f32_dpp v199, v243, v91 row_newbcast:13 row_mask:0xf bank_mask:0xf
    v_mul_f32_dpp v200, v243, v94 row_newbcast:6 row_mask:0xf bank_mask:0xf
    v_mul_f32_dpp v201, v243, v95 row_newbcast:7 row_mask:0xf bank_mask:0xf
    v_mul_f32_dpp v202, v243, v94 row_newbcast:14 row_mask:0xf bank_mask:0xf
    v_mul_f32_dpp v203, v243, v95 row_newbcast:15 row_mask:0xf bank_mask:0xf
    v_cvt_pk_bf16_f32 v90, v196, v197
    v_cvt_pk_bf16_f32 v94, v198, v199
    v_cvt_pk_bf16_f32 v91, v200, v201
    v_cvt_pk_bf16_f32 v95, v202, v203
    s_nop 0
    s_waitcnt lgkmcnt(0)
    v_mfma_f32_32x32x16_bf16 v[0:15], v[88:91], v[176:179], v[0:15]
    s_add_u32 m0, s21, 6144
    v_mfma_f32_32x32x16_bf16 v[16:31], v[92:95], v[176:179], v[16:31]
    buffer_load_dwordx4 v240, s[4:7], s35 offen lds
    buffer_load_dwordx4 v241, s[8:11], s35 offen offset:1024 lds
    s_mov_b32 m0, s50
    s_nop 0
    s_movrels_b32 s71, s23
    s_movrels_b32 s33, s28
    s_and_b32 s70, s33, 0x70
    s_andn2_b32 s33, s33, 0x70
    v_xor_b32 v253, s70, v248
    v_add_u32 v253, s33, v253
    s_bfe_u32 s46, s71, 0x30012
    s_mov_b32 m0, s46
    s_and_b32 s66, s71, 0x3ffff
    s_movrels_b32 s68, s57
    s_movrels_b32 s69, s61
    s_sub_u32 s48, s66, s47
    s_mov_b32 s47, s66
    s_lshr_b32 s52, s71, 28
    s_lshl_b32 s67, s46, 9
    s_add_u32 s66, s66, s67
    s_sub_u32 s49, s66, s42
    s_mov_b32 s42, s66
    s_bfe_u32 s66, s68, 655360
    s_add_u32 s43, s42, s66
    s_bfe_u32 s39, s69, 655360
    s_bfe_u32 s66, s68, 655370
    s_add_u32 s44, s42, s66
    s_bfe_u32 s40, s69, 655370
    s_bfe_u32 s66, s68, 655380
    s_add_u32 s45, s42, s66
    s_bfe_u32 s41, s69, 655380
    v_mfma_f32_32x32x16_bf16 v[32:47], v[64:67], v[180:183], 0
    v_mul_f32 v196, v0, v96
    v_fmac_f32 v196, v1, v97
    v_fmac_f32 v196, v2, v98
    v_fmac_f32 v196, v3, v99
    v_fmac_f32 v196, v4, v100
    v_mfma_f32_32x32x16_bf16 v[48:63], v[68:71], v[180:183], 0
    v_fmac_f32 v196, v5, v101
    v_fmac_f32 v196, v6, v102
    v_fmac_f32 v196, v7, v103
    v_mul_f32 v198, v8, v128
    v_fmac_f32 v198, v9, v129
    v_mfma_f32_32x32x16_bf16 v[32:47], v[72:75], v[184:187], v[32:47]
    v_fmac_f32 v198, v10, v130
    v_fmac_f32 v198, v11, v131
    v_fmac_f32 v198, v12, v132
    v_fmac_f32 v198, v13, v133
    v_mfma_f32_32x32x16_bf16 v[48:63], v[76:79], v[184:187], v[48:63]
    v_fmac_f32 v198, v14, v134
    v_fmac_f32 v198, v15, v135
    v_mul_f32 v200, v16, v128
    v_fmac_f32 v200, v17, v129
    v_permlane32_swap_b32 v196, v198
    v_mfma_f32_32x32x16_bf16 v[32:47], v[80:83], v[188:191], v[32:47]
    v_fmac_f32 v200, v18, v130
    v_fmac_f32 v200, v19, v131
    v_fmac_f32 v200, v20, v132
    v_fmac_f32 v200, v21, v133
    v_fmac_f32 v200, v22, v134
    v_mfma_f32_32x32x16_bf16 v[48:63], v[84:87], v[188:191], v[48:63]
    s_waitcnt vmcnt(6)
    ds_read_b64_tr_b16 v[176:177], v244 offset:0
    ds_read_b64_tr_b16 v[178:179], v244 offset:1024
    ds_read_b64_tr_b16 v[180:181], v245 offset:0
    ds_read_b64_tr_b16 v[182:183], v245 offset:1024
    v_fmac_f32 v200, v23, v135
    v_add_f32 v198, v196, v198
    v_mul_f32_e64 v202, v24, -v128
    v_fma_f32 v202, v25, -v129, v202
    v_mfma_f32_32x32x16_bf16 v[32:47], v[88:91], v[192:195], v[32:47]
    v_fma_f32 v202, v26, -v130, v202
    v_fma_f32 v202, v27, -v131, v202
    v_fma_f32 v202, v28, -v132, v202
    v_fma_f32 v202, v29, -v133, v202
    v_fma_f32 v202, v30, -v134, v202
    v_mfma_f32_32x32x16_bf16 v[48:63], v[92:95], v[192:195], v[48:63]
    v_fma_f32 v202, v31, -v135, v202
    s_nop 1
    v_permlane32_swap_b32 v200, v202
    v_add_f32 v202, v200, v202
    s_waitcnt vmcnt(4) lgkmcnt(0)
    v_mfma_f32_32x32x16_bf16 v[0:15], v[64:67], v[176:179], 0
    v_mul_f32 v197, v32, v104
    v_fmac_f32 v197, v33, v105
    v_fmac_f32 v197, v34, v106
    v_fmac_f32 v197, v35, v107
    v_fmac_f32 v197, v36, v108
    s_add_u32 m0, s21, 0
    v_mfma_f32_32x32x16_bf16 v[16:31], v[68:71], v[176:179], 0
    buffer_load_dwordx4 v234, s[4:7], s36 offen lds
    buffer_load_dwordx4 v235, s[8:11], s36 offen offset:1024 lds
    ds_read_b64_tr_b16 v[176:177], v244 offset:2048
    ds_read_b64_tr_b16 v[178:179], v244 offset:3072
    ds_read_b64_tr_b16 v[184:185], v245 offset:2048
    ds_read_b64_tr_b16 v[186:187], v245 offset:3072
    v_fmac_f32 v197, v37, v109
    v_fmac_f32 v197, v38, v110
    v_fmac_f32 v197, v39, v111
    v_mul_f32 v199, v40, v136
    v_fmac_f32 v199, v41, v137
    s_waitcnt vmcnt(4) lgkmcnt(0)
    v_mfma_f32_32x32x16_bf16 v[0:15], v[72:75], v[176:179], v[0:15]
    v_fmac_f32 v199, v42, v138
    v_fmac_f32 v199, v43, v139
    v_fmac_f32 v199, v44, v140
    v_fmac_f32 v199, v45, v141
    v_fmac_f32 v199, v46, v142
    s_add_u32 m0, s21, 2048
    v_mfma_f32_32x32x16_bf16 v[16:31], v[76:79], v[176:179], v[16:31]
    buffer_load_dwordx4 v236, s[4:7], s36 offen lds
    buffer_load_dwordx4 v237, s[8:11], s36 offen offset:1024 lds
    ds_read_b64_tr_b16 v[176:177], v244 offset:4096
    ds_read_b64_tr_b16 v[178:179], v244 offset:5120
    ds_read_b64_tr_b16 v[188:189], v245 offset:4096
    ds_read_b64_tr_b16 v[190:191], v245 offset:5120
    v_fmac_f32 v199, v47, v143
    v_mul_f32 v201, v48, v136
    v_fmac_f32 v201, v49, v137
    v_permlane32_swap_b32 v197, v199
    v_fmac_f32 v201, v50, v138
    s_waitcnt vmcnt(4) lgkmcnt(0)
    v_mfma_f32_32x32x16_bf16 v[0:15], v[80:83], v[176:179], v[0:15]
    v_fmac_f32 v201, v51, v139
    v_fmac_f32 v201, v52, v140
    v_fmac_f32 v201, v53, v141
    v_fmac_f32 v201, v54, v142
    v_fmac_f32 v201, v55, v143
    s_add_u32 m0, s21, 4096
    v_mfma_f32_32x32x16_bf16 v[16:31], v[84:87], v[176:179], v[16:31]
    buffer_load_dwordx4 v238, s[4:7], s36 offen lds
    buffer_load_dwordx4 v239, s[8:11], s36 offen offset:1024 lds
    ds_read_b64_tr_b16 v[176:177], v244 offset:6144
    ds_read_b64_tr_b16 v[178:179], v244 offset:7168
    ds_read_b64_tr_b16 v[192:193], v245 offset:6144
    ds_read_b64_tr_b16 v[194:195], v245 offset:7168
    v_add_f32 v199, v197, v199
    v_mul_f32_e64 v203, v56, -v136
    v_fma_f32 v203, v57, -v137, v203
    v_fma_f32 v203, v58, -v138, v203
    v_fma_f32 v203, v59, -v139, v203
    s_waitcnt lgkmcnt(0)
    v_mfma_f32_32x32x16_bf16 v[0:15], v[88:91], v[176:179], v[0:15]
    v_fma_f32 v203, v60, -v140, v203
    v_fma_f32 v203, v61, -v141, v203
    v_fma_f32 v203, v62, -v142, v203
    v_fma_f32 v203, v63, -v143, v203
    s_nop 1
    s_add_u32 m0, s21, 6144
    v_mfma_f32_32x32x16_bf16 v[16:31], v[92:95], v[176:179], v[16:31]
    buffer_load_dwordx4 v240, s[4:7], s36 offen lds
    buffer_load_dwordx4 v241, s[8:11], s36 offen offset:1024 lds
    v_permlane32_swap_b32 v201, v203
    v_add_f32 v203, v201, v203
    v_cvt_pk_bf16_f32 v198, v198, v199
    v_cvt_pk_bf16_f32 v202, v202, v203
    ds_write2st64_b32 v253, v198, v202 offset0:0 offset1:1
    v_mfma_f32_32x32x16_bf16 v[32:47], v[64:67], v[180:183], 0
    v_mul_f32 v196, v0, v144
    v_fmac_f32 v196, v1, v145
    v_fmac_f32 v196, v2, v146
    v_fmac_f32 v196, v3, v147
    v_mfma_f32_32x32x16_bf16 v[48:63], v[68:71], v[180:183], 0
    v_fmac_f32 v196, v4, v148
    v_fmac_f32 v196, v5, v149
    v_fmac_f32 v196, v6, v150
    v_fmac_f32 v196, v7, v151
    v_mfma_f32_32x32x16_bf16 v[32:47], v[72:75], v[184:187], v[32:47]
    v_mul_f32 v198, v8, v112
    v_fmac_f32 v198, v9, v113
    v_fmac_f32 v198, v10, v114
    v_fmac_f32 v198, v11, v115
    v_mfma_f32_32x32x16_bf16 v[48:63], v[76:79], v[184:187], v[48:63]
    v_fmac_f32 v198, v12, v116
    v_fmac_f32 v198, v13, v117
    v_fmac_f32 v198, v14, v118
    v_fmac_f32 v198, v15, v119
    v_mfma_f32_32x32x16_bf16 v[32:47], v[80:83], v[188:191], v[32:47]
    v_mul_f32_e64 v200, v16, -v160
    v_fma_f32 v200, v17, -v161, v200
    v_fma_f32 v200, v18, -v162, v200
    v_fma_f32 v200, v19, -v163, v200
    v_mfma_f32_32x32x16_bf16 v[48:63], v[84:87], v[188:191], v[48:63]
    s_waitcnt vmcnt(6)
    ds_read_b64_tr_b16 v[176:177], v244 offset:0
    ds_read_b64_tr_b16 v[178:179], v244 offset:1024
    ds_read_b64_tr_b16 v[180:181], v245 offset:0
    ds_read_b64_tr_b16 v[182:183], v245 offset:1024
    v_fma_f32 v200, v20, -v164, v200
    v_fma_f32 v200, v21, -v165, v200
    v_fma_f32 v200, v22, -v166, v200
    v_fma_f32 v200, v23, -v167, v200
    v_mfma_f32_32x32x16_bf16 v[32:47], v[88:91], v[192:195], v[32:47]
    v_mul_f32_e64 v202, v24, -v160
    v_fma_f32 v202, v25, -v161, v202
    v_fma_f32 v202, v26, -v162, v202
    v_fma_f32 v202, v27, -v163, v202
    v_mfma_f32_32x32x16_bf16 v[48:63], v[92:95], v[192:195], v[48:63]
    v_fma_f32 v202, v28, -v164, v202
    v_fma_f32 v202, v29, -v165, v202
    v_fma_f32 v202, v30, -v166, v202
    v_fma_f32 v202, v31, -v167, v202
    s_waitcnt vmcnt(4) lgkmcnt(0)
    v_mfma_f32_32x32x16_bf16 v[0:15], v[64:67], v[176:179], 0
    s_nop 0
    v_mul_f32 v197, v32, v152
    v_fmac_f32 v197, v33, v153
    v_fmac_f32 v197, v34, v154
    v_fmac_f32 v197, v35, v155
    s_add_u32 m0, s21, 0
    v_mfma_f32_32x32x16_bf16 v[16:31], v[68:71], v[176:179], 0
    buffer_load_dwordx4 v234, s[4:7], s37 offen lds
    buffer_load_dwordx4 v235, s[8:11], s37 offen offset:1024 lds
    ds_read_b64_tr_b16 v[176:177], v244 offset:2048
    ds_read_b64_tr_b16 v[178:179], v244 offset:3072
    ds_read_b64_tr_b16 v[184:185], v245 offset:2048
    ds_read_b64_tr_b16 v[186:187], v245 offset:3072
    v_add_u32 v252, s42, v247
    ds_read_u16 v234, v252
    ds_read_u16 v235, v252 offset:64
    v_fmac_f32 v197, v36, v156
    v_fmac_f32 v197, v37, v157
    v_fmac_f32 v197, v38, v158
    v_fmac_f32 v197, v39, v159
    s_waitcnt vmcnt(4) lgkmcnt(2)
    v_mfma_f32_32x32x16_bf16 v[0:15], v[72:75], v[176:179], v[0:15]
    v_mul_f32 v199, v40, v120
    v_fmac_f32 v199, v41, v121
    v_fmac_f32 v199, v42, v122
    v_fmac_f32 v199, v43, v123
    s_add_u32 m0, s21, 2048
    v_mfma_f32_32x32x16_bf16 v[16:31], v[76:79], v[176:179], v[16:31]
    buffer_load_dwordx4 v236, s[4:7], s37 offen lds
    buffer_load_dwordx4 v237, s[8:11], s37 offen offset:1024 lds
    ds_read_b64_tr_b16 v[176:177], v244 offset:4096
    ds_read_b64_tr_b16 v[178:179], v244 offset:5120
    ds_read_b64_tr_b16 v[188:189], v245 offset:4096
    ds_read_b64_tr_b16 v[190:191], v245 offset:5120
    v_add_u32 v252, s43, v247
    ds_read_u16 v236, v252
    ds_read_u16 v237, v252 offset:64
    v_fmac_f32 v199, v44, v124
    v_fmac_f32 v199, v45, v125
    v_fmac_f32 v199, v46, v126
    v_fmac_f32 v199, v47, v127
    s_waitcnt vmcnt(4) lgkmcnt(2)
    v_mfma_f32_32x32x16_bf16 v[0:15], v[80:83], v[176:179], v[0:15]
    v_mul_f32_e64 v201, v48, -v168
    v_fma_f32 v201, v49, -v169, v201
    v_fma_f32 v201, v50, -v170, v201
    v_fma_f32 v201, v51, -v171, v201
    s_add_u32 m0, s21, 4096
    v_mfma_f32_32x32x16_bf16 v[16:31], v[84:87], v[176:179], v[16:31]
    buffer_load_dwordx4 v238, s[4:7], s37 offen lds
    buffer_load_dwordx4 v239, s[8:11], s37 offen offset:1024 lds
    ds_read_b64_tr_b16 v[176:177], v244 offset:6144
    ds_read_b64_tr_b16 v[178:179], v244 offset:7168
    ds_read_b64_tr_b16 v[192:193], v245 offset:6144
    ds_read_b64_tr_b16 v[194:195], v245 offset:7168
    v_add_u32 v252, s44, v247
    ds_read_u16 v238, v252
    ds_read_u16 v239, v252 offset:64
    v_fma_f32 v201, v52, -v172, v201
    v_fma_f32 v201, v53, -v173, v201
    v_fma_f32 v201, v54, -v174, v201
    v_fma_f32 v201, v55, -v175, v201
    s_waitcnt lgkmcnt(2)
    v_mfma_f32_32x32x16_bf16 v[0:15], v[88:91], v[176:179], v[0:15]
    v_mul_f32_e64 v203, v56, -v168
    v_fma_f32 v203, v57, -v169, v203
    v_fma_f32 v203, v58, -v170, v203
    v_fma_f32 v203, v59, -v171, v203
    s_add_u32 m0, s21, 6144
    v_mfma_f32_32x32x16_bf16 v[16:31], v[92:95], v[176:179], v[16:31]
    buffer_load_dwordx4 v240, s[4:7], s37 offen lds
    buffer_load_dwordx4 v241, s[8:11], s37 offen offset:1024 lds
    v_add_u32 v252, s45, v247
    ds_read_u16 v240, v252
    ds_read_u16 v241, v252 offset:64
    v_fma_f32 v203, v60, -v172, v203
    v_fma_f32 v203, v61, -v173, v203
    v_fma_f32 v203, v62, -v174, v203
    v_fma_f32 v203, v63, -v175, v203
    v_mfma_f32_32x32x16_bf16 v[32:47], v[64:67], v[180:183], 0
    v_mul_f32 v254, v0, v144
    v_fmac_f32 v254, v1, v145
    v_fmac_f32 v254, v2, v146
    v_mfma_f32_32x32x16_bf16 v[48:63], v[68:71], v[180:183], 0
    ds_swizzle_b32 v68, v68 offset:0x401F
    ds_swizzle_b32 v69, v69 offset:0x401F
    ds_swizzle_b32 v70, v70 offset:0x401F
    ds_swizzle_b32 v71, v71 offset:0x401F
    v_fmac_f32 v254, v3, v147
    v_fmac_f32 v254, v4, v148
    v_mfma_f32_32x32x16_bf16 v[32:47], v[72:75], v[184:187], v[32:47]
    v_fmac_f32 v254, v5, v149
    v_fmac_f32 v254, v6, v150
    v_mfma_f32_32x32x16_bf16 v[48:63], v[76:79], v[184:187], v[48:63]
    ds_swizzle_b32 v76, v76 offset:0x401F
    ds_swizzle_b32 v77, v77 offset:0x401F
    ds_swizzle_b32 v78, v78 offset:0x401F
    ds_swizzle_b32 v79, v79 offset:0x401F
    v_fmac_f32 v254, v7, v151
    v_fmac_f32 v200, v8, v160
    v_mfma_f32_32x32x16_bf16 v[32:47], v[80:83], v[188:191], v[32:47]
    v_fmac_f32 v200, v9, v161
    v_permlane32_swap_b32 v196, v254
    v_fmac_f32 v200, v10, v162
    v_mfma_f32_32x32x16_bf16 v[48:63], v[84:87], v[188:191], v[48:63]
    ds_swizzle_b32 v84, v84 offset:0x401F
    ds_swizzle_b32 v85, v85 offset:0x401F
    ds_swizzle_b32 v86, v86 offset:0x401F
    ds_swizzle_b32 v87, v87 offset:0x401F
    s_waitcnt vmcnt(6)
    ds_read_b64_tr_b16 v[176:177], v244 offset:0
    ds_read_b64_tr_b16 v[178:179], v244 offset:1024
    ds_read_b64_tr_b16 v[180:181], v245 offset:0
    ds_read_b64_tr_b16 v[182:183], v245 offset:1024
    v_fmac_f32 v200, v11, v163
    v_fmac_f32 v200, v12, v164
    v_mfma_f32_32x32x16_bf16 v[32:47], v[88:91], v[192:195], v[32:47]
    v_fmac_f32 v200, v13, v165
    v_fmac_f32 v200, v14, v166
    v_mfma_f32_32x32x16_bf16 v[48:63], v[92:95], v[192:195], v[48:63]
    ds_swizzle_b32 v92, v92 offset:0x401F
    ds_swizzle_b32 v93, v93 offset:0x401F
    ds_swizzle_b32 v94, v94 offset:0x401F
    ds_swizzle_b32 v95, v95 offset:0x401F
    v_fmac_f32 v200, v15, v167
    v_add_f32 v254, v196, v254
    s_waitcnt lgkmcnt(8)
    s_mov_b64 exec, s[56:57]
    v_xor_b32 v68, 0x80008000, v68
    v_xor_b32 v69, 0x80008000, v69
    v_xor_b32 v70, 0x80008000, v70
    v_xor_b32 v71, 0x80008000, v71
    v_xor_b32 v76, 0x80008000, v76
    v_xor_b32 v77, 0x80008000, v77
    v_xor_b32 v78, 0x80008000, v78
    v_xor_b32 v79, 0x80008000, v79
    v_xor_b32 v84, 0x80008000, v84
    v_xor_b32 v85, 0x80008000, v85
    v_xor_b32 v86, 0x80008000, v86
    v_xor_b32 v87, 0x80008000, v87
    s_mov_b64 exec, -1
    s_waitcnt vmcnt(4) lgkmcnt(4)
    v_mfma_f32_32x32x16_bf16 v[0:15], v[64:67], v[176:179], 0
    v_mul_f32 v255, v32, v152
    v_fmac_f32 v255, v33, v153
    v_fmac_f32 v255, v34, v154
    s_add_u32 m0, s21, 0
    v_mfma_f32_32x32x16_bf16 v[16:31], v[68:71], v[176:179], v[16:31]
    v_lshl_add_u32 v234, v234, 10, v246
    v_lshl_add_u32 v235, v235, 10, v246
    buffer_load_dwordx4 v234, s[4:7], s38 offen lds
    buffer_load_dwordx4 v235, s[8:11], s38 offen offset:1024 lds
    ds_read_b64_tr_b16 v[176:177], v244 offset:2048
    ds_read_b64_tr_b16 v[178:179], v244 offset:3072
    ds_read_b64_tr_b16 v[184:185], v245 offset:2048
    ds_read_b64_tr_b16 v[186:187], v245 offset:3072
    v_fmac_f32 v255, v35, v155
    v_fmac_f32 v255, v36, v156
    s_waitcnt vmcnt(4) lgkmcnt(0)
    v_mfma_f32_32x32x16_bf16 v[0:15], v[72:75], v[176:179], v[0:15]
    v_fmac_f32 v255, v37, v157
    v_fmac_f32 v255, v38, v158
    v_fmac_f32 v255, v39, v159
    s_add_u32 m0, s21, 2048
    v_mfma_f32_32x32x16_bf16 v[16:31], v[76:79], v[176:179], v[16:31]
    v_lshl_add_u32 v236, v236, 10, v246
    v_lshl_add_u32 v237, v237, 10, v246
    buffer_load_dwordx4 v236, s[4:7], s39 offen lds
    buffer_load_dwordx4 v237, s[8:11], s39 offen offset:1024 lds
    ds_read_b64_tr_b16 v[176:177], v244 offset:4096
    ds_read_b64_tr_b16 v[178:179], v244 offset:5120
    ds_read_b64_tr_b16 v[188:189], v245 offset:4096
    ds_read_b64_tr_b16 v[190:191], v245 offset:5120
    v_fmac_f32 v201, v40, v168
    v_fmac_f32 v201, v41, v169
    s_waitcnt vmcnt(4) lgkmcnt(0)
    v_mfma_f32_32x32x16_bf16 v[0:15], v[80:83], v[176:179], v[0:15]
    v_permlane32_swap_b32 v197, v255
    v_fmac_f32 v201, v42, v170
    v_fmac_f32 v201, v43, v171
    s_add_u32 m0, s21, 4096
    v_mfma_f32_32x32x16_bf16 v[16:31], v[84:87], v[176:179], v[16:31]
    v_lshl_add_u32 v238, v238, 10, v246
    v_lshl_add_u32 v239, v239, 10, v246
    buffer_load_dwordx4 v238, s[4:7], s40 offen lds
    buffer_load_dwordx4 v239, s[8:11], s40 offen offset:1024 lds
    ds_read_b64_tr_b16 v[176:177], v244 offset:6144
    ds_read_b64_tr_b16 v[178:179], v244 offset:7168
    ds_read_b64_tr_b16 v[192:193], v245 offset:6144
    ds_read_b64_tr_b16 v[194:195], v245 offset:7168
    v_fmac_f32 v201, v44, v172
    v_fmac_f32 v201, v45, v173
    s_waitcnt lgkmcnt(0)
    s_mov_b64 exec, s[56:57]
    v_xor_b32 v92, 0x80008000, v92
    v_xor_b32 v93, 0x80008000, v93
    v_xor_b32 v94, 0x80008000, v94
    v_xor_b32 v95, 0x80008000, v95
    s_mov_b64 exec, -1
    v_mfma_f32_32x32x16_bf16 v[0:15], v[88:91], v[176:179], v[0:15]
    v_fmac_f32 v201, v46, v174
    v_fmac_f32 v201, v47, v175
    v_add_f32 v255, v197, v255
    s_add_u32 m0, s21, 6144
    v_mfma_f32_32x32x16_bf16 v[16:31], v[92:95], v[176:179], v[16:31]
    v_lshl_add_u32 v240, v240, 10, v246
    v_lshl_add_u32 v241, v241, 10, v246
    buffer_load_dwordx4 v240, s[4:7], s41 offen lds
    buffer_load_dwordx4 v241, s[8:11], s41 offen offset:1024 lds
    v_cvt_pk_bf16_f32 v254, v254, v255
    ds_write_b32 v253, v254 offset:512
    v_mfma_f32_32x32x16_bf16 v[32:47], v[64:67], v[180:183], 0
    v_mul_f32 v254, v0, v144
    v_fmac_f32 v254, v1, v145
    v_fmac_f32 v254, v2, v146
    v_fmac_f32 v254, v3, v147
    v_fmac_f32 v254, v4, v148
    v_mfma_f32_32x32x16_bf16 v[48:63], v[68:71], v[180:183], v[48:63]
    v_fmac_f32 v254, v5, v149
    v_fmac_f32 v254, v6, v150
    v_fmac_f32 v254, v7, v151
    v_fma_f32 v202, v8, -v160, v202
    v_fma_f32 v202, v9, -v161, v202
    v_mfma_f32_32x32x16_bf16 v[32:47], v[72:75], v[184:187], v[32:47]
    v_permlane32_swap_b32 v254, v200
    v_fma_f32 v202, v10, -v162, v202
    v_fma_f32 v202, v11, -v163, v202
    v_fma_f32 v202, v12, -v164, v202
    v_fma_f32 v202, v13, -v165, v202
    v_mfma_f32_32x32x16_bf16 v[48:63], v[76:79], v[184:187], v[48:63]
    v_fma_f32 v202, v14, -v166, v202
    v_fma_f32 v202, v15, -v167, v202
    v_add_f32 v200, v254, v200
    v_fmac_f32 v198, v16, v112
    v_permlane32_swap_b32 v202, v254
    v_mfma_f32_32x32x16_bf16 v[32:47], v[80:83], v[188:191], v[32:47]
    v_fmac_f32 v198, v17, v113
    v_fmac_f32 v198, v18, v114
    v_fmac_f32 v198, v19, v115
    v_fmac_f32 v198, v20, v116
    v_fmac_f32 v198, v21, v117
    v_mfma_f32_32x32x16_bf16 v[48:63], v[84:87], v[188:191], v[48:63]
    s_waitcnt vmcnt(6)
    ds_read_b64_tr_b16 v[176:177], v244 offset:0
    ds_read_b64_tr_b16 v[178:179], v244 offset:1024
    ds_read_b64_tr_b16 v[180:181], v245 offset:0
    ds_read_b64_tr_b16 v[182:183], v245 offset:1024
    v_fmac_f32 v198, v22, v118
    v_fmac_f32 v198, v23, v119
    v_add_f32 v254, v202, v254
    v_mul_f32 v196, v24, v160
    v_fmac_f32 v196, v25, v161
    v_mfma_f32_32x32x16_bf16 v[32:47], v[88:91], v[192:195], v[32:47]
    v_fmac_f32 v196, v26, v162
    v_fmac_f32 v196, v27, v163
    v_fmac_f32 v196, v28, v164
    v_fmac_f32 v196, v29, v165
    v_fmac_f32 v196, v30, v166
    v_mfma_f32_32x32x16_bf16 v[48:63], v[92:95], v[192:195], v[48:63]
    v_add_u32 v249, s48, v249
    v_add_u32 v250, s49, v250
    ds_read_b32 v252, v251 offset:16
    ds_read_b64_tr_b16 v[64:65], v249 offset:0
    ds_read_b64_tr_b16 v[68:69], v249 offset:64
    ds_read_b64_tr_b16 v[66:67], v249 offset:256
    ds_read_b64_tr_b16 v[70:71], v249 offset:320
    s_mov_b64 exec, s[54:55]
    ds_read_u16_d16_hi v242, v250 offset:0
    s_mov_b64 exec, -1
    v_fmac_f32 v196, v31, v167
    s_nop 1
    v_permlane32_swap_b32 v198, v196
    v_add_f32 v196, v198, v196
    v_mul_f32 v255, v32, v152
    v_fmac_f32 v255, v33, v153
    v_fmac_f32 v255, v34, v154
    v_fmac_f32 v255, v35, v155
    v_fmac_f32 v255, v36, v156
    v_fmac_f32 v255, v37, v157
    v_fmac_f32 v255, v38, v158
    v_fmac_f32 v255, v39, v159
    v_fma_f32 v203, v40, -v168, v203
    v_fma_f32 v203, v41, -v169, v203
    v_permlane32_swap_b32 v255, v201
    v_fma_f32 v203, v42, -v170, v203
    v_fma_f32 v203, v43, -v171, v203
    v_fma_f32 v203, v44, -v172, v203
    v_fma_f32 v203, v45, -v173, v203
    v_fma_f32 v203, v46, -v174, v203
    v_fma_f32 v203, v47, -v175, v203
    v_add_f32 v201, v255, v201
    v_fmac_f32 v199, v48, v120
    v_permlane32_swap_b32 v203, v255
    v_fmac_f32 v199, v49, v121
    v_fmac_f32 v199, v50, v122
    v_fmac_f32 v199, v51, v123
    v_fmac_f32 v199, v52, v124
    v_fmac_f32 v199, v53, v125
    v_fmac_f32 v199, v54, v126
    v_fmac_f32 v199, v55, v127
    v_add_f32 v255, v203, v255
    v_mul_f32 v197, v56, v168
    v_fmac_f32 v197, v57, v169
    v_fmac_f32 v197, v58, v170
    v_fmac_f32 v197, v59, v171
    v_fmac_f32 v197, v60, v172
    v_fmac_f32 v197, v61, v173
    v_fmac_f32 v197, v62, v174
    v_fmac_f32 v197, v63, v175
    s_nop 1
    v_permlane32_swap_b32 v199, v197
    v_add_f32 v197, v199, v197
    v_cvt_pk_bf16_f32 v200, v200, v201
    v_cvt_pk_bf16_f32 v254, v254, v255
    v_cvt_pk_bf16_f32 v196, v196, v197
    ds_write2st64_b32 v253, v200, v196 offset0:3 offset1:4
    s_mov_b64 exec, 0xffffffff
    ds_write_b32 v253, v254 offset:1280
    s_mov_b64 exec, -1
    s_add_u32 s50, s50, 1
    s_cmp_ge_u32 s50, 4
    s_cbranch_scc1 LAST1
    s_waitcnt lgkmcnt(7)
    v_readfirstlane_b32 s66, v252
    s_add_u32 s53, s53, 1
    v_mov_b32 v252, s53
    s_cmp_le_u32 s53, s66
    ds_write2_b32 v251, v252, v252 offset0:0 offset1:8
    s_setprio 1
    s_cbranch_scc1 PRIO_15
    s_setprio 0
PRIO_15:
    s_cmp_eq_u32 s52, 4
    s_cbranch_scc1 ITEM_1_4
    s_cmp_eq_u32 s52, 5
    s_cbranch_scc1 ITEM_1_5
    s_cmp_eq_u32 s52, 3
    s_cbranch_scc1 ITEM_1_3
    s_cmp_eq_u32 s52, 6
    s_cbranch_scc1 ITEM_1_6
    s_cmp_eq_u32 s52, 8
    s_cbranch_scc1 ITEM_1_8
    s_branch ITEM_1_2
.p2align 6
ITEM_1_2:
    s_mov_b32 m0, s50
    s_nop 0
    s_movrels_b32 s71, s23
    s_movrels_b32 s33, s28
    s_and_b32 s70, s33, 0x70
    s_andn2_b32 s33, s33, 0x70
    v_xor_b32 v253, s70, v248
    v_add_u32 v253, s33, v253
    s_bfe_u32 s46, s71, 0x30012
    s_mov_b32 m0, s46
    s_and_b32 s66, s71, 0x3ffff
    s_movrels_b32 s68, s57
    s_movrels_b32 s69, s61
    s_sub_u32 s48, s66, s47
    s_mov_b32 s47, s66
    s_lshr_b32 s52, s71, 28
    s_lshl_b32 s67, s46, 9
    s_add_u32 s66, s66, s67
    s_sub_u32 s49, s66, s42
    s_mov_b32 s42, s66
    s_bfe_u32 s66, s68, 655360
    s_add_u32 s43, s42, s66
    s_bfe_u32 s39, s69, 655360
    s_bfe_u32 s66, s68, 655370
    s_add_u32 s44, s42, s66
    s_bfe_u32 s40, s69, 655370
    s_bfe_u32 s66, s68, 655380
    s_add_u32 s45, s42, s66
    s_bfe_u32 s41, s69, 655380
    v_add_u32 v252, s42, v247
    ds_read_u16 v234, v252
    ds_read_u16 v235, v252 offset:64
    v_add_u32 v252, s43, v247
    ds_read_u16 v236, v252
    ds_read_u16 v237, v252 offset:64
    v_add_u32 v252, s44, v247
    ds_read_u16 v238, v252
    ds_read_u16 v239, v252 offset:64
    v_add_u32 v252, s45, v247
    ds_read_u16 v240, v252
    ds_read_u16 v241, v252 offset:64
    s_waitcnt lgkmcnt(8)
    v_mul_f32_dpp v196, v242, v64 row_newbcast:0 row_mask:0xf bank_mask:0xf
    v_mul_f32_dpp v197, v242, v65 row_newbcast:1 row_mask:0xf bank_mask:0xf
    v_mul_f32_dpp v198, v242, v64 row_newbcast:8 row_mask:0xf bank_mask:0xf
    v_mul_f32_dpp v199, v242, v65 row_newbcast:9 row_mask:0xf bank_mask:0xf
    v_mul_f32_dpp v200, v242, v68 row_newbcast:2 row_mask:0xf bank_mask:0xf
    v_mul_f32_dpp v201, v242, v69 row_newbcast:3 row_mask:0xf bank_mask:0xf
    v_mul_f32_dpp v202, v242, v68 row_newbcast:10 row_mask:0xf bank_mask:0xf
    v_mul_f32_dpp v203, v242, v69 row_newbcast:11 row_mask:0xf bank_mask:0xf
    v_cvt_pk_bf16_f32 v64, v196, v197
    v_cvt_pk_bf16_f32 v68, v198, v199
    v_cvt_pk_bf16_f32 v65, v200, v201
    v_cvt_pk_bf16_f32 v69, v202, v203
    v_mul_f32_dpp v196, v242, v66 row_newbcast:4 row_mask:0xf bank_mask:0xf
    v_mul_f32_dpp v197, v242, v67 row_newbcast:5 row_mask:0xf bank_mask:0xf
    v_mul_f32_dpp v198, v242, v66 row_newbcast:12 row_mask:0xf bank_mask:0xf
    v_mul_f32_dpp v199, v242, v67 row_newbcast:13 row_mask:0xf bank_mask:0xf
    v_mul_f32_dpp v200, v242, v70 row_newbcast:6 row_mask:0xf bank_mask:0xf
    v_mul_f32_dpp v201, v242, v71 row_newbcast:7 row_mask:0xf bank_mask:0xf
    v_mul_f32_dpp v202, v242, v70 row_newbcast:14 row_mask:0xf bank_mask:0xf
    v_mul_f32_dpp v203, v242, v71 row_newbcast:15 row_mask:0xf bank_mask:0xf
    v_cvt_pk_bf16_f32 v66, v196, v197
    v_cvt_pk_bf16_f32 v70, v198, v199
    v_cvt_pk_bf16_f32 v67, v200, v201
    v_cvt_pk_bf16_f32 v71, v202, v203
    s_nop 0
    s_waitcnt lgkmcnt(6)
    v_mfma_f32_32x32x16_bf16 v[0:15], v[64:67], v[176:179], 0
    s_add_u32 m0, s21, 0
    v_mfma_f32_32x32x16_bf16 v[16:31], v[68:71], v[176:179], 0
    v_lshl_add_u32 v234, v234, 10, v246
    v_lshl_add_u32 v235, v235, 10, v246
    buffer_load_dwordx4 v234, s[4:7], s38 offen lds
    buffer_load_dwordx4 v235, s[8:11], s38 offen offset:1024 lds
    v_mfma_f32_32x32x16_bf16 v[32:47], v[64:67], v[180:183], 0
    s_nop 4
    v_mul_f32 v196, v0, v96
    v_fmac_f32 v196, v1, v97
    v_fmac_f32 v196, v2, v98
    v_fmac_f32 v196, v3, v99
    v_fmac_f32 v196, v4, v100
    v_fmac_f32 v196, v5, v101
    v_fmac_f32 v196, v6, v102
    v_fmac_f32 v196, v7, v103
    v_mul_f32 v198, v8, v128
    v_fmac_f32 v198, v9, v129
    v_fmac_f32 v198, v10, v130
    v_fmac_f32 v198, v11, v131
    v_fmac_f32 v198, v12, v132
    v_fmac_f32 v198, v13, v133
    v_fmac_f32 v198, v14, v134
    v_fmac_f32 v198, v15, v135
    v_mul_f32 v200, v16, v128
    v_fmac_f32 v200, v17, v129
    v_permlane32_swap_b32 v196, v198
    v_mfma_f32_32x32x16_bf16 v[48:63], v[68:71], v[180:183], 0
    s_waitcnt vmcnt(6)
    ds_read_b64_tr_b16 v[176:177], v244 offset:2048
    ds_read_b64_tr_b16 v[178:179], v244 offset:3072
    ds_read_b64_tr_b16 v[180:181], v245 offset:2048
    ds_read_b64_tr_b16 v[182:183], v245 offset:3072
    v_fmac_f32 v200, v18, v130
    v_fmac_f32 v200, v19, v131
    v_fmac_f32 v200, v20, v132
    v_fmac_f32 v200, v21, v133
    v_fmac_f32 v200, v22, v134
    v_fmac_f32 v200, v23, v135
    v_add_f32 v198, v196, v198
    v_mul_f32_e64 v202, v24, -v128
    v_fma_f32 v202, v25, -v129, v202
    v_fma_f32 v202, v26, -v130, v202
    v_fma_f32 v202, v27, -v131, v202
    v_fma_f32 v202, v28, -v132, v202
    v_fma_f32 v202, v29, -v133, v202
    v_fma_f32 v202, v30, -v134, v202
    v_fma_f32 v202, v31, -v135, v202
    s_nop 1
    v_permlane32_swap_b32 v200, v202
    v_add_f32 v202, v200, v202
    s_waitcnt lgkmcnt(0)
    v_mfma_f32_32x32x16_bf16 v[0:15], v[64:67], v[176:179], 0
    v_mul_f32 v197, v32, v104
    v_fmac_f32 v197, v33, v105
    v_fmac_f32 v197, v34, v106
    v_fmac_f32 v197, v35, v107
    v_fmac_f32 v197, v36, v108
    v_fmac_f32 v197, v37, v109
    v_fmac_f32 v197, v38, v110
    v_fmac_f32 v197, v39, v111
    v_mul_f32 v199, v40, v136
    v_fmac_f32 v199, v41, v137
    v_fmac_f32 v199, v42, v138
    v_fmac_f32 v199, v43, v139
    v_fmac_f32 v199, v44, v140
    v_fmac_f32 v199, v45, v141
    v_fmac_f32 v199, v46, v142
    v_fmac_f32 v199, v47, v143
    v_mul_f32 v201, v48, v136
    v_fmac_f32 v201, v49, v137
    v_permlane32_swap_b32 v197, v199
    v_fmac_f32 v201, v50, v138
    s_add_u32 m0, s21, 2048
    v_mfma_f32_32x32x16_bf16 v[16:31], v[68:71], v[176:179], 0
    v_lshl_add_u32 v236, v236, 10, v246
    v_lshl_add_u32 v237, v237, 10, v246
    buffer_load_dwordx4 v236, s[4:7], s39 offen lds
    buffer_load_dwordx4 v237, s[8:11], s39 offen offset:1024 lds
    v_fmac_f32 v201, v51, v139
    v_fmac_f32 v201, v52, v140
    v_fmac_f32 v201, v53, v141
    v_fmac_f32 v201, v54, v142
    v_fmac_f32 v201, v55, v143
    v_add_f32 v199, v197, v199
    v_mul_f32_e64 v203, v56, -v136
    v_fma_f32 v203, v57, -v137, v203
    v_fma_f32 v203, v58, -v138, v203
    v_fma_f32 v203, v59, -v139, v203
    v_fma_f32 v203, v60, -v140, v203
    v_fma_f32 v203, v61, -v141, v203
    v_fma_f32 v203, v62, -v142, v203
    v_fma_f32 v203, v63, -v143, v203
    s_nop 1
    v_permlane32_swap_b32 v201, v203
    v_add_f32 v203, v201, v203
    v_cvt_pk_bf16_f32 v198, v198, v199
    v_cvt_pk_bf16_f32 v202, v202, v203
    ds_write2st64_b32 v253, v198, v202 offset0:0 offset1:1
    v_mfma_f32_32x32x16_bf16 v[32:47], v[64:67], v[180:183], 0
    v_mul_f32 v196, v0, v144
    v_fmac_f32 v196, v1, v145
    v_fmac_f32 v196, v2, v146
    v_fmac_f32 v196, v3, v147
    v_fmac_f32 v196, v4, v148
    v_fmac_f32 v196, v5, v149
    v_fmac_f32 v196, v6, v150
    v_fmac_f32 v196, v7, v151
    v_mul_f32 v198, v8, v112
    v_fmac_f32 v198, v9, v113
    v_fmac_f32 v198, v10, v114
    v_fmac_f32 v198, v11, v115
    v_fmac_f32 v198, v12, v116
    v_fmac_f32 v198, v13, v117
    v_fmac_f32 v198, v14, v118
    v_fmac_f32 v198, v15, v119
    v_mfma_f32_32x32x16_bf16 v[48:63], v[68:71], v[180:183], 0
    s_waitcnt vmcnt(6)
    ds_read_b64_tr_b16 v[176:177], v244 offset:4096
    ds_read_b64_tr_b16 v[178:179], v244 offset:5120
    ds_read_b64_tr_b16 v[180:181], v245 offset:4096
    ds_read_b64_tr_b16 v[182:183], v245 offset:5120
    v_mul_f32_e64 v200, v16, -v160
    v_fma_f32 v200, v17, -v161, v200
    v_fma_f32 v200, v18, -v162, v200
    v_fma_f32 v200, v19, -v163, v200
    v_fma_f32 v200, v20, -v164, v200
    v_fma_f32 v200, v21, -v165, v200
    v_fma_f32 v200, v22, -v166, v200
    v_fma_f32 v200, v23, -v167, v200
    v_mul_f32_e64 v202, v24, -v160
    v_fma_f32 v202, v25, -v161, v202
    v_fma_f32 v202, v26, -v162, v202
    v_fma_f32 v202, v27, -v163, v202
    v_fma_f32 v202, v28, -v164, v202
    v_fma_f32 v202, v29, -v165, v202
    v_fma_f32 v202, v30, -v166, v202
    v_fma_f32 v202, v31, -v167, v202
    s_waitcnt lgkmcnt(0)
    v_mfma_f32_32x32x16_bf16 v[0:15], v[64:67], v[176:179], 0
    v_mul_f32 v197, v32, v152
    v_fmac_f32 v197, v33, v153
    v_fmac_f32 v197, v34, v154
    v_fmac_f32 v197, v35, v155
    v_fmac_f32 v197, v36, v156
    v_fmac_f32 v197, v37, v157
    v_fmac_f32 v197, v38, v158
    v_fmac_f32 v197, v39, v159
    v_mul_f32 v199, v40, v120
    v_fmac_f32 v199, v41, v121
    v_fmac_f32 v199, v42, v122
    v_fmac_f32 v199, v43, v123
    v_fmac_f32 v199, v44, v124
    v_fmac_f32 v199, v45, v125
    v_fmac_f32 v199, v46, v126
    v_fmac_f32 v199, v47, v127
    s_add_u32 m0, s21, 4096
    v_mfma_f32_32x32x16_bf16 v[16:31], v[68:71], v[176:179], 0
    v_lshl_add_u32 v238, v238, 10, v246
    v_lshl_add_u32 v239, v239, 10, v246
    buffer_load_dwordx4 v238, s[4:7], s40 offen lds
    buffer_load_dwordx4 v239, s[8:11], s40 offen offset:1024 lds
    v_mul_f32_e64 v201, v48, -v168
    v_fma_f32 v201, v49, -v169, v201
    v_fma_f32 v201, v50, -v170, v201
    v_fma_f32 v201, v51, -v171, v201
    v_fma_f32 v201, v52, -v172, v201
    v_fma_f32 v201, v53, -v173, v201
    v_fma_f32 v201, v54, -v174, v201
    v_fma_f32 v201, v55, -v175, v201
    v_mul_f32_e64 v203, v56, -v168
    v_fma_f32 v203, v57, -v169, v203
    v_fma_f32 v203, v58, -v170, v203
    v_fma_f32 v203, v59, -v171, v203
    v_fma_f32 v203, v60, -v172, v203
    v_fma_f32 v203, v61, -v173, v203
    v_fma_f32 v203, v62, -v174, v203
    v_fma_f32 v203, v63, -v175, v203
    v_mfma_f32_32x32x16_bf16 v[32:47], v[64:67], v[180:183], 0
    v_mul_f32 v254, v0, v144
    v_fmac_f32 v254, v1, v145
    v_fmac_f32 v254, v2, v146
    v_fmac_f32 v254, v3, v147
    v_fmac_f32 v254, v4, v148
    v_fmac_f32 v254, v5, v149
    v_fmac_f32 v254, v6, v150
    v_fmac_f32 v254, v7, v151
    v_fmac_f32 v200, v8, v160
    v_mfma_f32_32x32x16_bf16 v[48:63], v[68:71], v[180:183], 0
    ds_swizzle_b32 v68, v68 offset:0x401F
    ds_swizzle_b32 v69, v69 offset:0x401F
    ds_swizzle_b32 v70, v70 offset:0x401F
    ds_swizzle_b32 v71, v71 offset:0x401F
    s_waitcnt vmcnt(6)
    ds_read_b64_tr_b16 v[176:177], v244 offset:6144
    ds_read_b64_tr_b16 v[178:179], v244 offset:7168
    ds_read_b64_tr_b16 v[180:181], v245 offset:6144
    ds_read_b64_tr_b16 v[182:183], v245 offset:7168
    v_fmac_f32 v200, v9, v161
    v_permlane32_swap_b32 v196, v254
    v_fmac_f32 v200, v10, v162
    v_fmac_f32 v200, v11, v163
    v_fmac_f32 v200, v12, v164
    v_fmac_f32 v200, v13, v165
    v_fmac_f32 v200, v14, v166
    v_fmac_f32 v200, v15, v167
    v_add_f32 v254, v196, v254
    s_waitcnt lgkmcnt(0)
    s_mov_b64 exec, s[56:57]
    v_xor_b32 v68, 0x80008000, v68
    v_xor_b32 v69, 0x80008000, v69
    v_xor_b32 v70, 0x80008000, v70
    v_xor_b32 v71, 0x80008000, v71
    s_mov_b64 exec, -1
    s_nop 0
    v_mfma_f32_32x32x16_bf16 v[0:15], v[64:67], v[176:179], 0
    v_mul_f32 v255, v32, v152
    v_fmac_f32 v255, v33, v153
    v_fmac_f32 v255, v34, v154
    v_fmac_f32 v255, v35, v155
    v_fmac_f32 v255, v36, v156
    v_fmac_f32 v255, v37, v157
    v_fmac_f32 v255, v38, v158
    v_fmac_f32 v255, v39, v159
    v_fmac_f32 v201, v40, v168
    v_fmac_f32 v201, v41, v169
    s_add_u32 m0, s21, 6144
    v_mfma_f32_32x32x16_bf16 v[16:31], v[68:71], v[176:179], v[16:31]
    v_lshl_add_u32 v240, v240, 10, v246
    v_lshl_add_u32 v241, v241, 10, v246
    buffer_load_dwordx4 v240, s[4:7], s41 offen lds
    buffer_load_dwordx4 v241, s[8:11], s41 offen offset:1024 lds
    v_permlane32_swap_b32 v197, v255
    v_fmac_f32 v201, v42, v170
    v_fmac_f32 v201, v43, v171
    v_fmac_f32 v201, v44, v172
    v_fmac_f32 v201, v45, v173
    v_fmac_f32 v201, v46, v174
    v_fmac_f32 v201, v47, v175
    v_add_f32 v255, v197, v255
    v_cvt_pk_bf16_f32 v254, v254, v255
    ds_write_b32 v253, v254 offset:512
    v_mfma_f32_32x32x16_bf16 v[32:47], v[64:67], v[180:183], 0
    v_mul_f32 v254, v0, v144
    v_fmac_f32 v254, v1, v145
    v_fmac_f32 v254, v2, v146
    v_fmac_f32 v254, v3, v147
    v_fmac_f32 v254, v4, v148
    v_fmac_f32 v254, v5, v149
    v_fmac_f32 v254, v6, v150
    v_fmac_f32 v254, v7, v151
    v_fma_f32 v202, v8, -v160, v202
    v_fma_f32 v202, v9, -v161, v202
    v_permlane32_swap_b32 v254, v200
    v_fma_f32 v202, v10, -v162, v202
    v_fma_f32 v202, v11, -v163, v202
    v_fma_f32 v202, v12, -v164, v202
    v_fma_f32 v202, v13, -v165, v202
    v_fma_f32 v202, v14, -v166, v202
    v_fma_f32 v202, v15, -v167, v202
    v_add_f32 v200, v254, v200
    v_fmac_f32 v198, v16, v112
    v_permlane32_swap_b32 v202, v254
    v_mfma_f32_32x32x16_bf16 v[48:63], v[68:71], v[180:183], v[48:63]
    s_waitcnt vmcnt(6)
    ds_read_b64_tr_b16 v[176:177], v244 offset:0
    ds_read_b64_tr_b16 v[178:179], v244 offset:1024
    ds_read_b64_tr_b16 v[180:181], v245 offset:0
    ds_read_b64_tr_b16 v[182:183], v245 offset:1024
    v_add_u32 v249, s48, v249
    v_add_u32 v250, s49, v250
    ds_read_b32 v252, v251 offset:16
    ds_read_b64_tr_b16 v[64:65], v249 offset:0
    ds_read_b64_tr_b16 v[68:69], v249 offset:64
    ds_read_b64_tr_b16 v[66:67], v249 offset:256
    ds_read_b64_tr_b16 v[70:71], v249 offset:320
    s_mov_b64 exec, s[54:55]
    ds_read_u16_d16_hi v242, v250 offset:0
    s_mov_b64 exec, -1
    v_fmac_f32 v198, v17, v113
    v_fmac_f32 v198, v18, v114
    v_fmac_f32 v198, v19, v115
    v_fmac_f32 v198, v20, v116
    v_fmac_f32 v198, v21, v117
    v_fmac_f32 v198, v22, v118
    v_fmac_f32 v198, v23, v119
    v_add_f32 v254, v202, v254
    v_mul_f32 v196, v24, v160
    v_fmac_f32 v196, v25, v161
    v_fmac_f32 v196, v26, v162
    v_fmac_f32 v196, v27, v163
    v_fmac_f32 v196, v28, v164
    v_fmac_f32 v196, v29, v165
    v_fmac_f32 v196, v30, v166
    v_fmac_f32 v196, v31, v167
    s_nop 1
    v_permlane32_swap_b32 v198, v196
    v_add_f32 v196, v198, v196
    v_mul_f32 v255, v32, v152
    v_fmac_f32 v255, v33, v153
    v_fmac_f32 v255, v34, v154
    v_fmac_f32 v255, v35, v155
    v_fmac_f32 v255, v36, v156
    v_fmac_f32 v255, v37, v157
    v_fmac_f32 v255, v38, v158
    v_fmac_f32 v255, v39, v159
    v_fma_f32 v203, v40, -v168, v203
    v_fma_f32 v203, v41, -v169, v203
    v_permlane32_swap_b32 v255, v201
    v_fma_f32 v203, v42, -v170, v203
    v_fma_f32 v203, v43, -v171, v203
    v_fma_f32 v203, v44, -v172, v203
    v_fma_f32 v203, v45, -v173, v203
    v_fma_f32 v203, v46, -v174, v203
    v_fma_f32 v203, v47, -v175, v203
    v_add_f32 v201, v255, v201
    v_fmac_f32 v199, v48, v120
    v_permlane32_swap_b32 v203, v255
    v_fmac_f32 v199, v49, v121
    v_fmac_f32 v199, v50, v122
    v_fmac_f32 v199, v51, v123
    v_fmac_f32 v199, v52, v124
    v_fmac_f32 v199, v53, v125
    v_fmac_f32 v199, v54, v126
    v_fmac_f32 v199, v55, v127
    v_add_f32 v255, v203, v255
    v_mul_f32 v197, v56, v168
    v_fmac_f32 v197, v57, v169
    v_fmac_f32 v197, v58, v170
    v_fmac_f32 v197, v59, v171
    v_fmac_f32 v197, v60, v172
    v_fmac_f32 v197, v61, v173
    v_fmac_f32 v197, v62, v174
    v_fmac_f32 v197, v63, v175
    s_nop 1
    v_permlane32_swap_b32 v199, v197
    v_add_f32 v197, v199, v197
    v_cvt_pk_bf16_f32 v200, v200, v201
    v_cvt_pk_bf16_f32 v254, v254, v255
    v_cvt_pk_bf16_f32 v196, v196, v197
    ds_write2st64_b32 v253, v200, v196 offset0:3 offset1:4
    s_mov_b64 exec, 0xffffffff
    ds_write_b32 v253, v254 offset:1280
    s_mov_b64 exec, -1
    s_add_u32 s50, s50, 1
    s_cmp_ge_u32 s50, 4
    s_cbranch_scc1 LAST1
    s_waitcnt lgkmcnt(7)
    v_readfirstlane_b32 s66, v252
    s_add_u32 s53, s53, 1
    v_mov_b32 v252, s53
    s_cmp_le_u32 s53, s66
    ds_write2_b32 v251, v252, v252 offset0:0 offset1:8
    s_setprio 1
    s_cbranch_scc1 PRIO_16
    s_setprio 0
PRIO_16:
    s_cmp_eq_u32 s52, 4
    s_cbranch_scc1 ITEM_1_4
    s_cmp_eq_u32 s52, 5
    s_cbranch_scc1 ITEM_1_5
    s_cmp_eq_u32 s52, 3
    s_cbranch_scc1 ITEM_1_3
    s_cmp_eq_u32 s52, 6
    s_cbranch_scc1 ITEM_1_6
    s_cmp_eq_u32 s52, 8
    s_cbranch_scc1 ITEM_1_8
    s_branch ITEM_1_2
.p2align 6
TAIL:
    s_setprio 0
    s_waitcnt vmcnt(0) lgkmcnt(0)
    v_mbcnt_lo_u32_b32 v176, -1, 0
    v_mbcnt_hi_u32_b32 v176, -1, v176
    v_lshlrev_b32 v180, 4, v176
    s_cmp_eq_u32 s89, 0
    s_cbranch_scc1 T_flags
    s_mul_i32 s66, s20, 80
    v_lshlrev_b32 v2, 2, v176
    v_min_u32 v2, 76, v2
    s_mov_b32 s67, 262144
T_poll:
    buffer_load_dword v3, v2, s[16:19], s66 offen offset:128 sc1
    s_waitcnt vmcnt(0)
    v_cmp_ne_u32 vcc, s88, v3
    s_sub_u32 s67, s67, 1
    s_cselect_b64 vcc, 0, vcc
    s_cmp_eq_u64 vcc, 0
    s_cbranch_scc0 T_poll
    s_mov_b32 s89, 0
T_flags:
    s_mul_i32 s66, s20, 20480
    s_add_u32 s66, s66, 1024
    buffer_load_dwordx4 v[96:99], v180, s[16:19], s66 offen offset:0 sc1
    buffer_load_dwordx4 v[100:103], v180, s[16:19], s66 offen offset:1024 sc1
    buffer_load_dwordx4 v[104:107], v180, s[16:19], s66 offen offset:2048 sc1
    buffer_load_dwordx4 v[108:111], v180, s[16:19], s66 offen offset:3072 sc1
    s_add_u32 s66, s66, 4096
    buffer_load_dwordx4 v[112:115], v180, s[16:19], s66 offen offset:0 sc1
    buffer_load_dwordx4 v[116:119], v180, s[16:19], s66 offen offset:1024 sc1
    buffer_load_dwordx4 v[120:123], v180, s[16:19], s66 offen offset:2048 sc1
    buffer_load_dwordx4 v[124:127], v180, s[16:19], s66 offen offset:3072 sc1
    s_add_u32 s66, s66, 4096
    buffer_load_dwordx4 v[128:131], v180, s[16:19], s66 offen offset:0 sc1
    buffer_load_dwordx4 v[132:135], v180, s[16:19], s66 offen offset:1024 sc1
    buffer_load_dwordx4 v[136:139], v180, s[16:19], s66 offen offset:2048 sc1
    buffer_load_dwordx4 v[140:143], v180, s[16:19], s66 offen offset:3072 sc1
    s_add_u32 s66, s66, 4096
    buffer_load_dwordx4 v[144:147], v180, s[16:19], s66 offen offset:0 sc1
    buffer_load_dwordx4 v[148:151], v180, s[16:19], s66 offen offset:1024 sc1
    buffer_load_dwordx4 v[152:155], v180, s[16:19], s66 offen offset:2048 sc1
    buffer_load_dwordx4 v[156:159], v180, s[16:19], s66 offen offset:3072 sc1
    s_add_u32 s66, s66, 4096
    buffer_load_dwordx4 v[160:163], v180, s[16:19], s66 offen offset:0 sc1
    buffer_load_dwordx4 v[164:167], v180, s[16:19], s66 offen offset:1024 sc1
    buffer_load_dwordx4 v[168:171], v180, s[16:19], s66 offen offset:2048 sc1
    buffer_load_dwordx4 v[172:175], v180, s[16:19], s66 offen offset:3072 sc1
    v_lshlrev_b32 v181, 2, v176
    s_bfe_u32 s67, s22, 0x40015
    s_lshl_b32 s67, s67, 4
    s_and_b32 s68, s67, 128
    s_and_b32 s67, s67, 0x70
    s_add_u32 s68, s68, s21
    v_xor_b32 v180, s67, v181
    v_add_u32 v180, s68, v180
    ds_write2st64_b32 v180, v204, v205 offset0:0 offset1:1
    ds_write2st64_b32 v180, v206, v207 offset0:2 offset1:3
    ds_write2st64_b32 v180, v208, v209 offset0:4 offset1:5
    s_bfe_u32 s67, s23, 0x40015
    s_lshl_b32 s67, s67, 4
    s_and_b32 s68, s67, 128
    s_and_b32 s67, s67, 0x70
    s_add_u32 s68, s68, s21
    v_xor_b32 v180, s67, v181
    v_add_u32 v180, s68, v180
    ds_write2st64_b32 v180, v210, v211 offset0:6 offset1:7
    ds_write2st64_b32 v180, v212, v213 offset0:8 offset1:9
    ds_write2st64_b32 v180, v214, v215 offset0:10 offset1:11
    s_bfe_u32 s67, s24, 0x40015
    s_lshl_b32 s67, s67, 4
    s_and_b32 s68, s67, 128
    s_and_b32 s67, s67, 0x70
    s_add_u32 s68, s68, s21
    v_xor_b32 v180, s67, v181
    v_add_u32 v180, s68, v180
    ds_write2st64_b32 v180, v216, v217 offset0:12 offset1:13
    ds_write2st64_b32 v180, v218, v219 offset0:14 offset1:15
    ds_write2st64_b32 v180, v220, v221 offset0:16 offset1:17
    s_bfe_u32 s67, s25, 0x40015
    s_lshl_b32 s67, s67, 4
    s_and_b32 s68, s67, 128
    s_and_b32 s67, s67, 0x70
    s_add_u32 s68, s68, s21
    v_xor_b32 v180, s67, v181
    v_add_u32 v180, s68, v180
    ds_write2st64_b32 v180, v222, v223 offset0:18 offset1:19
    ds_write2st64_b32 v180, v224, v225 offset0:20 offset1:21
    ds_write2st64_b32 v180, v226, v227 offset0:22 offset1:23
    s_bfe_u32 s67, s26, 0x40015
    s_lshl_b32 s67, s67, 4
    s_and_b32 s68, s67, 128
    s_and_b32 s67, s67, 0x70
    s_add_u32 s68, s68, s21
    v_xor_b32 v180, s67, v181
    v_add_u32 v180, s68, v180
    ds_write2st64_b32 v180, v228, v229 offset0:24 offset1:25
    ds_write2st64_b32 v180, v230, v231 offset0:26 offset1:27
    ds_write2st64_b32 v180, v232, v233 offset0:28 offset1:29
GEMM:
    v_and_b32 v177, 15, v176
    v_lshrrev_b32 v178, 4, v176
    v_and_b32 v179, 7, v177
    v_lshlrev_b32 v180, 3, v177
    v_lshlrev_b32 v181, 3, v179
    v_add_u32 v180, 163328, v180
    v_add_u32 v181, 163328, v181
    ds_read_b64 v[182:183], v180
    ds_read_b64 v[184:185], v180 offset:128
    ds_read_b64 v[186:187], v181 offset:256
    v_xor_b32 v180, v179, v178
    v_and_b32 v181, 8, v177
    v_xor_b32 v188, 4, v180
    v_add_u32 v189, v188, v181
    v_add_u32 v181, v180, v181
    s_waitcnt lgkmcnt(0)
    s_mov_b32 s4, s72
    s_and_b32 s5, s73, 0xffff
    s_mov_b32 s6, 10240000
    s_mov_b32 s7, 0x20000
    v_lshl_add_u32 v48, v180, 4, v182
    v_lshl_add_u32 v49, v188, 4, v182
    v_lshl_add_u32 v50, v180, 4, v183
    v_lshl_add_u32 v51, v188, 4, v183
    v_lshl_add_u32 v52, v180, 4, v184
    v_lshl_add_u32 v53, v188, 4, v184
    v_lshl_add_u32 v54, v180, 4, v185
    v_lshl_add_u32 v55, v188, 4, v185
    v_lshl_add_u32 v56, v181, 4, v186
    v_lshl_add_u32 v57, v189, 4, v186
    v_lshl_add_u32 v58, v181, 4, v187
    v_lshl_add_u32 v59, v189, 4, v187
    s_mov_b32 s67, 0xbfb8aa3b
    s_barrier
    ds_read_b128 v[76:79], v48 offset:0
    ds_read_b128 v[80:83], v52 offset:0
    ds_read_b128 v[84:87], v56 offset:0
    ds_read_b128 v[88:91], v49 offset:0
    ds_read_b128 v[92:95], v53 offset:0
    s_waitcnt vmcnt(19) lgkmcnt(4)
    v_mfma_f32_16x16x32_bf16 v[0:3], v[96:99], v[76:79], 0
    v_lshrrev_b32 v205, 1, v178
    v_lshl_add_u32 v205, s20, 1, v205
    ds_read_b128 v[76:79], v57 offset:0
    s_waitcnt lgkmcnt(4)
    v_mfma_f32_16x16x32_bf16 v[4:7], v[96:99], v[80:83], 0
    v_and_b32 v204, 7, v177
    v_xor_b32 v205, v205, v204
    ds_read_b128 v[80:83], v50 offset:0
    s_waitcnt lgkmcnt(4)
    v_mfma_f32_16x16x32_bf16 v[8:11], v[96:99], v[84:87], 0
    v_and_b32 v204, 1, v178
    v_lshlrev_b32 v204, 3, v204
    ds_read_b128 v[84:87], v54 offset:0
    s_waitcnt vmcnt(18) lgkmcnt(4)
    v_mfma_f32_16x16x32_bf16 v[0:3], v[100:103], v[88:91], v[0:3]
    v_lshl_add_u32 v205, v205, 4, v204
    v_and_b32 v204, 8, v177
    ds_read_b128 v[88:91], v58 offset:0
    s_waitcnt lgkmcnt(4)
    v_mfma_f32_16x16x32_bf16 v[4:7], v[100:103], v[92:95], v[4:7]
    v_lshl_add_u32 v204, v204, 4, v205
    v_lshl_add_u32 v204, v177, 10, v204
    ds_read_b128 v[92:95], v51 offset:0
    s_waitcnt lgkmcnt(4)
    v_mfma_f32_16x16x32_bf16 v[8:11], v[100:103], v[76:79], v[8:11]
    v_add_u32 v204, 65536, v204
    v_add_u32 v205, v205, v182
    ds_read_b128 v[76:79], v55 offset:0
    s_waitcnt vmcnt(17) lgkmcnt(4)
    v_mfma_f32_16x16x32_bf16 v[0:3], v[104:107], v[80:83], v[0:3]
    v_and_b32 v220, 8, v177
    v_mul_u32_u24 v220, 1008, v220
    ds_read_b128 v[80:83], v59 offset:0
    s_waitcnt lgkmcnt(4)
    v_mfma_f32_16x16x32_bf16 v[4:7], v[104:107], v[84:87], v[4:7]
    v_sub_u32 v220, v204, v220
    v_lshlrev_b32 v210, 4, v176
    ds_read_b128 v[84:87], v48 offset:1024
    s_waitcnt lgkmcnt(4)
    v_mfma_f32_16x16x32_bf16 v[8:11], v[104:107], v[88:91], v[8:11]
    s_lshl_b32 s68, s20, 1
    s_add_u32 s69, s68, 1
    ds_read_b128 v[88:91], v52 offset:1024
    s_waitcnt vmcnt(16) lgkmcnt(4)
    v_mfma_f32_16x16x32_bf16 v[0:3], v[108:111], v[92:95], v[0:3]
    v_readlane_b32 s24, v182, s68
    v_readlane_b32 s25, v182, s69
    ds_read_b128 v[92:95], v56 offset:1024
    s_waitcnt lgkmcnt(4)
    v_mfma_f32_16x16x32_bf16 v[4:7], v[108:111], v[76:79], v[4:7]
    s_and_b32 s70, s68, 7
    s_lshl_b32 s70, s70, 4
    ds_read_b128 v[76:79], v49 offset:1024
    s_waitcnt lgkmcnt(4)
    v_mfma_f32_16x16x32_bf16 v[8:11], v[108:111], v[80:83], v[8:11]
    v_xor_b32 v206, s70, v210
    v_xor_b32 v207, 16, v206
    ds_read_b128 v[80:83], v53 offset:1024
    s_waitcnt vmcnt(15) lgkmcnt(4)
    v_mfma_f32_16x16x32_bf16 v[0:3], v[112:115], v[84:87], v[0:3]
    v_add_u32 v208, s24, v206
    v_add_u32 v209, s25, v207
    ds_read_b128 v[84:87], v57 offset:1024
    s_waitcnt lgkmcnt(4)
    v_mfma_f32_16x16x32_bf16 v[4:7], v[112:115], v[88:91], v[4:7]
    s_lshl_b32 s70, s68, 10
    s_and_b32 s71, s68, 8
    ds_read_b128 v[88:91], v50 offset:1024
    s_waitcnt lgkmcnt(4)
    v_mfma_f32_16x16x32_bf16 v[8:11], v[112:115], v[92:95], v[8:11]
    s_lshl_b32 s71, s71, 4
    s_add_u32 s71, s71, s70
    ds_read_b128 v[92:95], v54 offset:1024
    s_waitcnt vmcnt(14) lgkmcnt(4)
    v_mfma_f32_16x16x32_bf16 v[0:3], v[116:119], v[76:79], v[0:3]
    s_add_u32 s71, s71, 65536
    v_add_u32 v206, s71, v206
    ds_read_b128 v[76:79], v58 offset:1024
    s_waitcnt lgkmcnt(4)
    v_mfma_f32_16x16x32_bf16 v[4:7], v[116:119], v[80:83], v[4:7]
    v_add_u32 v207, s71, v207
    s_mul_i32 s66, s2, 40960
    ds_read_b128 v[80:83], v51 offset:1024
    s_waitcnt lgkmcnt(4)
    v_mfma_f32_16x16x32_bf16 v[8:11], v[116:119], v[84:87], v[8:11]
    s_add_u32 s22, s66, s70
    s_add_u32 s23, s22, 0x4000
    ds_read_b128 v[84:87], v55 offset:1024
    s_waitcnt vmcnt(13) lgkmcnt(4)
    v_mfma_f32_16x16x32_bf16 v[0:3], v[120:123], v[88:91], v[0:3]
    s_lshl_b32 s70, s20, 10
    s_add_u32 s66, s66, s70
    ds_read_b128 v[88:91], v59 offset:1024
    s_waitcnt lgkmcnt(4)
    v_mfma_f32_16x16x32_bf16 v[4:7], v[120:123], v[92:95], v[4:7]
    s_add_u32 s66, s66, 0x8000
    s_add_u32 s70, s70, 65536
    ds_read_b128 v[92:95], v48 offset:128
    s_waitcnt lgkmcnt(4)
    v_mfma_f32_16x16x32_bf16 v[8:11], v[120:123], v[76:79], v[8:11]
    s_lshl_b32 s71, s20, 4
    v_xor_b32 v211, s71, v210
    ds_read_b128 v[76:79], v48 offset:256
    s_waitcnt vmcnt(12) lgkmcnt(4)
    v_mfma_f32_16x16x32_bf16 v[0:3], v[124:127], v[80:83], v[0:3]
    v_add_u32 v211, s70, v211
    ds_read_b128 v[80:83], v48 offset:384
    s_waitcnt lgkmcnt(4)
    v_mfma_f32_16x16x32_bf16 v[4:7], v[124:127], v[84:87], v[4:7]
    ds_read_b128 v[84:87], v49 offset:128
    s_waitcnt lgkmcnt(4)
    v_mfma_f32_16x16x32_bf16 v[8:11], v[124:127], v[88:91], v[8:11]
    ds_read_b128 v[88:91], v49 offset:256
    s_waitcnt vmcnt(11) lgkmcnt(4)
    v_mfma_f32_16x16x32_bf16 v[12:15], v[128:131], v[92:95], 0
    ds_read_b128 v[92:95], v49 offset:384
    s_waitcnt lgkmcnt(4)
    v_mfma_f32_16x16x32_bf16 v[24:27], v[128:131], v[76:79], 0
    ds_read_b128 v[76:79], v50 offset:128
    s_waitcnt lgkmcnt(4)
    v_mfma_f32_16x16x32_bf16 v[36:39], v[128:131], v[80:83], 0
    ds_read_b128 v[80:83], v50 offset:256
    s_waitcnt vmcnt(10) lgkmcnt(4)
    v_mfma_f32_16x16x32_bf16 v[12:15], v[132:135], v[84:87], v[12:15]
    v_mul_f32 v192, s67, v0
    v_mul_f32 v193, s67, v1
    ds_read_b128 v[84:87], v50 offset:384
    s_waitcnt lgkmcnt(4)
    v_mfma_f32_16x16x32_bf16 v[24:27], v[132:135], v[88:91], v[24:27]
    v_mul_f32 v194, s67, v2
    v_mul_f32 v195, s67, v3
    ds_read_b128 v[88:91], v51 offset:128
    s_waitcnt lgkmcnt(4)
    v_mfma_f32_16x16x32_bf16 v[36:39], v[132:135], v[92:95], v[36:39]
    v_exp_f32 v192, v192
    v_exp_f32 v193, v193
    ds_read_b128 v[92:95], v51 offset:256
    s_waitcnt vmcnt(9) lgkmcnt(4)
    v_mfma_f32_16x16x32_bf16 v[12:15], v[136:139], v[76:79], v[12:15]
    v_exp_f32 v194, v194
    v_exp_f32 v195, v195
    ds_read_b128 v[76:79], v51 offset:384
    s_waitcnt lgkmcnt(4)
    v_mfma_f32_16x16x32_bf16 v[24:27], v[136:139], v[80:83], v[24:27]
    v_add_f32 v192, 1.0, v192
    v_add_f32 v193, 1.0, v193
    ds_read_b128 v[80:83], v48 offset:512
    s_waitcnt lgkmcnt(4)
    v_mfma_f32_16x16x32_bf16 v[36:39], v[136:139], v[84:87], v[36:39]
    v_add_f32 v194, 1.0, v194
    v_add_f32 v195, 1.0, v195
    ds_read_b128 v[84:87], v48 offset:640
    s_waitcnt vmcnt(8) lgkmcnt(4)
    v_mfma_f32_16x16x32_bf16 v[12:15], v[140:143], v[88:91], v[12:15]
    v_rcp_f32 v192, v192
    v_rcp_f32 v193, v193
    ds_read_b128 v[88:91], v48 offset:768
    s_waitcnt lgkmcnt(4)
    v_mfma_f32_16x16x32_bf16 v[24:27], v[140:143], v[92:95], v[24:27]
    v_rcp_f32 v194, v194
    v_rcp_f32 v195, v195
    ds_read_b128 v[92:95], v49 offset:512
    s_waitcnt lgkmcnt(4)
    v_mfma_f32_16x16x32_bf16 v[36:39], v[140:143], v[76:79], v[36:39]
    v_mul_f32 v196, s67, v4
    v_mul_f32 v197, s67, v5
    ds_read_b128 v[76:79], v49 offset:640
    s_waitcnt vmcnt(7) lgkmcnt(4)
    v_mfma_f32_16x16x32_bf16 v[12:15], v[144:147], v[80:83], v[12:15]
    v_mul_f32 v198, s67, v6
    v_mul_f32 v199, s67, v7
    ds_read_b128 v[80:83], v49 offset:768
    s_waitcnt lgkmcnt(4)
    v_mfma_f32_16x16x32_bf16 v[24:27], v[144:147], v[84:87], v[24:27]
    v_exp_f32 v196, v196
    v_exp_f32 v197, v197
    ds_read_b128 v[84:87], v50 offset:512
    s_waitcnt lgkmcnt(4)
    v_mfma_f32_16x16x32_bf16 v[36:39], v[144:147], v[88:91], v[36:39]
    v_exp_f32 v198, v198
    v_exp_f32 v199, v199
    ds_read_b128 v[88:91], v50 offset:640
    s_waitcnt vmcnt(6) lgkmcnt(4)
    v_mfma_f32_16x16x32_bf16 v[12:15], v[148:151], v[92:95], v[12:15]
    v_add_f32 v196, 1.0, v196
    v_add_f32 v197, 1.0, v197
    ds_read_b128 v[92:95], v50 offset:768
    s_waitcnt lgkmcnt(4)
    v_mfma_f32_16x16x32_bf16 v[24:27], v[148:151], v[76:79], v[24:27]
    v_add_f32 v198, 1.0, v198
    v_add_f32 v199, 1.0, v199
    ds_read_b128 v[76:79], v51 offset:512
    s_waitcnt lgkmcnt(4)
    v_mfma_f32_16x16x32_bf16 v[36:39], v[148:151], v[80:83], v[36:39]
    v_rcp_f32 v196, v196
    v_rcp_f32 v197, v197
    ds_read_b128 v[80:83], v51 offset:640
    s_waitcnt vmcnt(5) lgkmcnt(4)
    v_mfma_f32_16x16x32_bf16 v[12:15], v[152:155], v[84:87], v[12:15]
    v_rcp_f32 v198, v198
    v_rcp_f32 v199, v199
    ds_read_b128 v[84:87], v51 offset:768
    s_waitcnt lgkmcnt(4)
    v_mfma_f32_16x16x32_bf16 v[24:27], v[152:155], v[88:91], v[24:27]
    v_mul_f32 v200, s67, v8
    v_mul_f32 v201, s67, v9
    ds_read_b128 v[88:91], v48 offset:1152
    s_waitcnt lgkmcnt(4)
    v_mfma_f32_16x16x32_bf16 v[36:39], v[152:155], v[92:95], v[36:39]
    v_mul_f32 v202, s67, v10
    v_mul_f32 v203, s67, v11
    ds_read_b128 v[92:95], v48 offset:1280
    s_waitcnt vmcnt(4) lgkmcnt(4)
    v_mfma_f32_16x16x32_bf16 v[12:15], v[156:159], v[76:79], v[12:15]
    v_exp_f32 v200, v200
    v_exp_f32 v201, v201
    ds_read_b128 v[76:79], v48 offset:896
    s_waitcnt lgkmcnt(4)
    v_mfma_f32_16x16x32_bf16 v[24:27], v[156:159], v[80:83], v[24:27]
    v_exp_f32 v202, v202
    v_exp_f32 v203, v203
    ds_read_b128 v[80:83], v49 offset:1152
    s_waitcnt lgkmcnt(4)
    v_mfma_f32_16x16x32_bf16 v[36:39], v[156:159], v[84:87], v[36:39]
    v_add_f32 v200, 1.0, v200
    v_add_f32 v201, 1.0, v201
    ds_read_b128 v[84:87], v49 offset:1280
    s_waitcnt vmcnt(3) lgkmcnt(4)
    v_mfma_f32_16x16x32_bf16 v[12:15], v[160:163], v[88:91], v[12:15]
    v_add_f32 v202, 1.0, v202
    v_add_f32 v203, 1.0, v203
    ds_read_b128 v[88:91], v49 offset:896
    s_waitcnt lgkmcnt(4)
    v_mfma_f32_16x16x32_bf16 v[24:27], v[160:163], v[92:95], v[24:27]
    v_rcp_f32 v200, v200
    v_rcp_f32 v201, v201
    ds_read_b128 v[92:95], v50 offset:1152
    s_waitcnt lgkmcnt(4)
    v_mfma_f32_16x16x32_bf16 v[36:39], v[160:163], v[76:79], v[36:39]
    v_rcp_f32 v202, v202
    v_rcp_f32 v203, v203
    ds_read_b128 v[76:79], v50 offset:1280
    s_waitcnt vmcnt(2) lgkmcnt(4)
    v_mfma_f32_16x16x32_bf16 v[12:15], v[164:167], v[80:83], v[12:15]
    v_cvt_pk_bf16_f32 v0, v0, v1
    v_cvt_pk_bf16_f32 v1, v2, v3
    ds_read_b128 v[80:83], v50 offset:896
    s_waitcnt lgkmcnt(4)
    v_mfma_f32_16x16x32_bf16 v[24:27], v[164:167], v[84:87], v[24:27]
    ds_write_b64 v204, v[0:1] offset:0
    ds_read_b128 v[84:87], v51 offset:1152
    s_waitcnt lgkmcnt(5)
    v_mfma_f32_16x16x32_bf16 v[36:39], v[164:167], v[88:91], v[36:39]
    v_mov_b32_dpp v200, v200 row_ror:8 row_mask:0xf bank_mask:0xc
    v_mov_b32_dpp v201, v201 row_ror:8 row_mask:0xf bank_mask:0xc
    ds_read_b128 v[88:91], v51 offset:1280
    s_waitcnt vmcnt(1) lgkmcnt(5)
    v_mfma_f32_16x16x32_bf16 v[12:15], v[168:171], v[92:95], v[12:15]
    v_mov_b32_dpp v202, v202 row_ror:8 row_mask:0xf bank_mask:0xc
    v_mov_b32_dpp v203, v203 row_ror:8 row_mask:0xf bank_mask:0xc
    ds_read_b128 v[92:95], v51 offset:896
    s_waitcnt lgkmcnt(5)
    v_mfma_f32_16x16x32_bf16 v[24:27], v[168:171], v[76:79], v[24:27]
    ds_read_b128 v[76:79], v52 offset:128
    s_waitcnt lgkmcnt(5)
    v_mfma_f32_16x16x32_bf16 v[36:39], v[168:171], v[80:83], v[36:39]
    ds_read_b128 v[80:83], v53 offset:128
    s_waitcnt vmcnt(0) lgkmcnt(4)
    v_mfma_f32_16x16x32_bf16 v[12:15], v[172:175], v[84:87], v[12:15]
    ds_read_b128 v[84:87], v54 offset:128
    s_waitcnt lgkmcnt(4)
    v_mfma_f32_16x16x32_bf16 v[24:27], v[172:175], v[88:91], v[24:27]
    ds_read_b128 v[88:91], v55 offset:128
    s_waitcnt lgkmcnt(4)
    v_mfma_f32_16x16x32_bf16 v[36:39], v[172:175], v[92:95], v[36:39]
    ds_read_b128 v[92:95], v52 offset:512
    s_waitcnt lgkmcnt(4)
    v_mfma_f32_16x16x32_bf16 v[16:19], v[128:131], v[76:79], 0
    ds_read_b128 v[76:79], v53 offset:512
    s_waitcnt lgkmcnt(4)
    v_mfma_f32_16x16x32_bf16 v[16:19], v[132:135], v[80:83], v[16:19]
    ds_read_b128 v[80:83], v54 offset:512
    s_waitcnt lgkmcnt(4)
    v_mfma_f32_16x16x32_bf16 v[16:19], v[136:139], v[84:87], v[16:19]
    v_mul_f32 v12, v12, v192
    v_mul_f32 v13, v13, v193
    ds_read_b128 v[84:87], v55 offset:512
    s_waitcnt lgkmcnt(4)
    v_mfma_f32_16x16x32_bf16 v[16:19], v[140:143], v[88:91], v[16:19]
    v_mul_f32 v14, v14, v194
    v_mul_f32 v15, v15, v195
    ds_read_b128 v[88:91], v52 offset:1152
    s_waitcnt lgkmcnt(4)
    v_mfma_f32_16x16x32_bf16 v[16:19], v[144:147], v[92:95], v[16:19]
    v_cvt_pk_bf16_f32 v12, v12, v13
    v_cvt_pk_bf16_f32 v13, v14, v15
    ds_read_b128 v[92:95], v53 offset:1152
    s_waitcnt lgkmcnt(4)
    v_mfma_f32_16x16x32_bf16 v[16:19], v[148:151], v[76:79], v[16:19]
    ds_write_b64 v204, v[12:13] offset:256
    v_mul_f32 v24, v24, v192
    ds_read_b128 v[76:79], v54 offset:1152
    s_waitcnt lgkmcnt(5)
    v_mfma_f32_16x16x32_bf16 v[16:19], v[152:155], v[80:83], v[16:19]
    v_mul_f32 v25, v25, v193
    v_mul_f32 v26, v26, v194
    ds_read_b128 v[80:83], v55 offset:1152
    s_waitcnt lgkmcnt(5)
    v_mfma_f32_16x16x32_bf16 v[16:19], v[156:159], v[84:87], v[16:19]
    v_mul_f32 v27, v27, v195
    v_cvt_pk_bf16_f32 v24, v24, v25
    ds_read_b128 v[84:87], v52 offset:256
    s_waitcnt lgkmcnt(5)
    v_mfma_f32_16x16x32_bf16 v[16:19], v[160:163], v[88:91], v[16:19]
    v_cvt_pk_bf16_f32 v25, v26, v27
    ds_write_b64 v204, v[24:25] offset:512
    ds_read_b128 v[88:91], v53 offset:256
    s_waitcnt lgkmcnt(6)
    v_mfma_f32_16x16x32_bf16 v[16:19], v[164:167], v[92:95], v[16:19]
    v_mul_f32 v36, v36, v192
    v_mul_f32 v37, v37, v193
    ds_read_b128 v[92:95], v54 offset:256
    s_waitcnt lgkmcnt(5)
    v_mfma_f32_16x16x32_bf16 v[16:19], v[168:171], v[76:79], v[16:19]
    v_mul_f32 v38, v38, v194
    v_mul_f32 v39, v39, v195
    ds_read_b128 v[76:79], v55 offset:256
    s_waitcnt lgkmcnt(5)
    v_mfma_f32_16x16x32_bf16 v[16:19], v[172:175], v[80:83], v[16:19]
    v_cvt_pk_bf16_f32 v36, v36, v37
    v_cvt_pk_bf16_f32 v37, v38, v39
    ds_read_b128 v[80:83], v52 offset:640
    s_waitcnt lgkmcnt(5)
    v_mfma_f32_16x16x32_bf16 v[28:31], v[128:131], v[84:87], 0
    ds_write_b64 v204, v[36:37] offset:768
    ds_read_b128 v[84:87], v53 offset:640
    s_waitcnt lgkmcnt(5)
    v_mfma_f32_16x16x32_bf16 v[28:31], v[132:135], v[88:91], v[28:31]
    ds_read_b128 v[88:91], v54 offset:640
    s_waitcnt lgkmcnt(5)
    v_mfma_f32_16x16x32_bf16 v[28:31], v[136:139], v[92:95], v[28:31]
    ds_read_b128 v[92:95], v55 offset:640
    s_waitcnt lgkmcnt(5)
    v_mfma_f32_16x16x32_bf16 v[28:31], v[140:143], v[76:79], v[28:31]
    ds_read_b128 v[76:79], v52 offset:1280
    s_waitcnt lgkmcnt(5)
    v_mfma_f32_16x16x32_bf16 v[28:31], v[144:147], v[80:83], v[28:31]
    ds_read_b128 v[80:83], v53 offset:1280
    s_waitcnt lgkmcnt(4)
    v_mfma_f32_16x16x32_bf16 v[28:31], v[148:151], v[84:87], v[28:31]
    s_barrier
    ds_read_b128 v[84:87], v54 offset:1280
    s_waitcnt lgkmcnt(4)
    v_mfma_f32_16x16x32_bf16 v[28:31], v[152:155], v[88:91], v[28:31]
    ds_read_b128 v[212:215], v206 offset:0
    ds_read_b128 v[216:219], v207 offset:1024
    ds_read_b128 v[88:91], v55 offset:1280
    s_waitcnt lgkmcnt(6)
    v_mfma_f32_16x16x32_bf16 v[28:31], v[156:159], v[92:95], v[28:31]
    ds_read_b128 v[92:95], v52 offset:384
    s_waitcnt lgkmcnt(6)
    v_mfma_f32_16x16x32_bf16 v[28:31], v[160:163], v[76:79], v[28:31]
    ds_read_b128 v[76:79], v53 offset:384
    s_waitcnt lgkmcnt(6)
    v_mfma_f32_16x16x32_bf16 v[28:31], v[164:167], v[80:83], v[28:31]
    ds_read_b128 v[80:83], v54 offset:384
    s_waitcnt lgkmcnt(6)
    v_mfma_f32_16x16x32_bf16 v[28:31], v[168:171], v[84:87], v[28:31]
    ds_read_b128 v[84:87], v55 offset:384
    s_waitcnt lgkmcnt(4)
    v_mfma_f32_16x16x32_bf16 v[28:31], v[172:175], v[88:91], v[28:31]
    buffer_store_dwordx4 v[212:215], v210, s[4:7], s22 offen offset:0 sc1
    ds_read_b128 v[88:91], v52 offset:768
    s_waitcnt lgkmcnt(4)
    v_mfma_f32_16x16x32_bf16 v[40:43], v[128:131], v[92:95], 0
    buffer_store_dwordx4 v[216:219], v210, s[4:7], s22 offen offset:1024 sc1
    ds_read_b128 v[92:95], v53 offset:768
    s_waitcnt lgkmcnt(4)
    v_mfma_f32_16x16x32_bf16 v[40:43], v[132:135], v[76:79], v[40:43]
    ds_read_b128 v[76:79], v54 offset:768
    s_waitcnt lgkmcnt(4)
    v_mfma_f32_16x16x32_bf16 v[40:43], v[136:139], v[80:83], v[40:43]
    ds_read_b128 v[80:83], v55 offset:768
    s_waitcnt lgkmcnt(4)
    v_mfma_f32_16x16x32_bf16 v[40:43], v[140:143], v[84:87], v[40:43]
    v_cvt_pk_bf16_f32 v4, v4, v5
    v_cvt_pk_bf16_f32 v5, v6, v7
    ds_read_b128 v[84:87], v52 offset:896
    s_waitcnt lgkmcnt(4)
    v_mfma_f32_16x16x32_bf16 v[40:43], v[144:147], v[88:91], v[40:43]
    ds_write_b64 v205, v[4:5] offset:0
    v_mul_f32 v16, v16, v196
    ds_read_b128 v[88:91], v53 offset:896
    s_waitcnt lgkmcnt(5)
    v_mfma_f32_16x16x32_bf16 v[40:43], v[148:151], v[92:95], v[40:43]
    v_mul_f32 v17, v17, v197
    v_mul_f32 v18, v18, v198
    ds_read_b128 v[92:95], v54 offset:896
    s_waitcnt lgkmcnt(5)
    v_mfma_f32_16x16x32_bf16 v[40:43], v[152:155], v[76:79], v[40:43]
    v_mul_f32 v19, v19, v199
    v_cvt_pk_bf16_f32 v16, v16, v17
    ds_read_b128 v[76:79], v55 offset:896
    s_waitcnt lgkmcnt(5)
    v_mfma_f32_16x16x32_bf16 v[40:43], v[156:159], v[80:83], v[40:43]
    v_cvt_pk_bf16_f32 v17, v18, v19
    ds_write_b64 v205, v[16:17] offset:256
    ds_read_b128 v[80:83], v56 offset:128
    s_waitcnt lgkmcnt(6)
    v_mfma_f32_16x16x32_bf16 v[40:43], v[160:163], v[84:87], v[40:43]
    v_mul_f32 v28, v28, v196
    v_mul_f32 v29, v29, v197
    ds_read_b128 v[84:87], v57 offset:128
    s_waitcnt lgkmcnt(5)
    v_mfma_f32_16x16x32_bf16 v[40:43], v[164:167], v[88:91], v[40:43]
    v_mul_f32 v30, v30, v198
    v_mul_f32 v31, v31, v199
    ds_read_b128 v[88:91], v58 offset:128
    s_waitcnt lgkmcnt(5)
    v_mfma_f32_16x16x32_bf16 v[40:43], v[168:171], v[92:95], v[40:43]
    v_cvt_pk_bf16_f32 v28, v28, v29
    v_cvt_pk_bf16_f32 v29, v30, v31
    ds_read_b128 v[92:95], v59 offset:128
    s_waitcnt lgkmcnt(5)
    v_mfma_f32_16x16x32_bf16 v[40:43], v[172:175], v[76:79], v[40:43]
    ds_write_b64 v205, v[28:29] offset:512
    ds_read_b128 v[76:79], v56 offset:512
    s_waitcnt lgkmcnt(5)
    v_mfma_f32_16x16x32_bf16 v[20:23], v[128:131], v[80:83], 0
    ds_read_b128 v[80:83], v57 offset:512
    s_waitcnt lgkmcnt(5)
    v_mfma_f32_16x16x32_bf16 v[20:23], v[132:135], v[84:87], v[20:23]
    ds_read_b128 v[84:87], v58 offset:512
    s_waitcnt lgkmcnt(5)
    v_mfma_f32_16x16x32_bf16 v[20:23], v[136:139], v[88:91], v[20:23]
    ds_read_b128 v[88:91], v59 offset:512
    s_waitcnt lgkmcnt(5)
    v_mfma_f32_16x16x32_bf16 v[20:23], v[140:143], v[92:95], v[20:23]
    v_mul_f32 v40, v40, v196
    v_mul_f32 v41, v41, v197
    ds_read_b128 v[92:95], v56 offset:1152
    s_waitcnt lgkmcnt(4)
    v_mfma_f32_16x16x32_bf16 v[20:23], v[144:147], v[76:79], v[20:23]
    v_mul_f32 v42, v42, v198
    v_mul_f32 v43, v43, v199
    ds_read_b128 v[76:79], v57 offset:1152
    s_waitcnt lgkmcnt(4)
    v_mfma_f32_16x16x32_bf16 v[20:23], v[148:151], v[80:83], v[20:23]
    v_cvt_pk_bf16_f32 v40, v40, v41
    v_cvt_pk_bf16_f32 v41, v42, v43
    ds_read_b128 v[80:83], v58 offset:1152
    s_waitcnt lgkmcnt(4)
    v_mfma_f32_16x16x32_bf16 v[20:23], v[152:155], v[84:87], v[20:23]
    ds_write_b64 v205, v[40:41] offset:768
    ds_read_b128 v[84:87], v59 offset:1152
    s_waitcnt lgkmcnt(5)
    v_mfma_f32_16x16x32_bf16 v[20:23], v[156:159], v[88:91], v[20:23]
    ds_read_b128 v[88:91], v56 offset:384
    s_waitcnt lgkmcnt(5)
    v_mfma_f32_16x16x32_bf16 v[20:23], v[160:163], v[92:95], v[20:23]
    ds_read_b128 v[92:95], v57 offset:384
    s_waitcnt lgkmcnt(5)
    v_mfma_f32_16x16x32_bf16 v[20:23], v[164:167], v[76:79], v[20:23]
    s_waitcnt lgkmcnt(3)
    s_barrier
    ds_read_b128 v[76:79], v58 offset:384
    v_mfma_f32_16x16x32_bf16 v[20:23], v[168:171], v[80:83], v[20:23]
    ds_read_b128 v[212:215], v208 offset:0
    ds_read_b128 v[216:219], v209 offset:0
    ds_read_b128 v[80:83], v59 offset:384
    s_waitcnt lgkmcnt(6)
    v_mfma_f32_16x16x32_bf16 v[20:23], v[172:175], v[84:87], v[20:23]
    ds_read_b128 v[84:87], v56 offset:768
    s_waitcnt lgkmcnt(6)
    v_mfma_f32_16x16x32_bf16 v[44:47], v[128:131], v[88:91], 0
    ds_read_b128 v[88:91], v57 offset:768
    s_waitcnt lgkmcnt(6)
    v_mfma_f32_16x16x32_bf16 v[44:47], v[132:135], v[92:95], v[44:47]
    ds_read_b128 v[92:95], v58 offset:768
    s_waitcnt lgkmcnt(6)
    v_mfma_f32_16x16x32_bf16 v[44:47], v[136:139], v[76:79], v[44:47]
    s_waitcnt lgkmcnt(5)
    buffer_store_dwordx4 v[212:215], v210, s[4:7], s23 offen offset:0 sc1
    ds_read_b128 v[76:79], v59 offset:768
    s_waitcnt lgkmcnt(4)
    v_mfma_f32_16x16x32_bf16 v[44:47], v[140:143], v[80:83], v[44:47]
    buffer_store_dwordx4 v[216:219], v210, s[4:7], s23 offen offset:1024 sc1
    ds_read_b128 v[80:83], v56 offset:896
    s_waitcnt lgkmcnt(4)
    v_mfma_f32_16x16x32_bf16 v[44:47], v[144:147], v[84:87], v[44:47]
    ds_read_b128 v[84:87], v57 offset:896
    s_waitcnt lgkmcnt(4)
    v_mfma_f32_16x16x32_bf16 v[44:47], v[148:151], v[88:91], v[44:47]
    ds_read_b128 v[88:91], v58 offset:896
    s_waitcnt lgkmcnt(4)
    v_mfma_f32_16x16x32_bf16 v[44:47], v[152:155], v[92:95], v[44:47]
    ds_read_b128 v[92:95], v59 offset:896
    s_waitcnt lgkmcnt(4)
    v_mfma_f32_16x16x32_bf16 v[44:47], v[156:159], v[76:79], v[44:47]
    v_cvt_pk_bf16_f32 v8, v8, v9
    v_cvt_pk_bf16_f32 v9, v10, v11
    s_waitcnt lgkmcnt(3)
    v_mfma_f32_16x16x32_bf16 v[44:47], v[160:163], v[80:83], v[44:47]
    ds_write_b64 v204, v[8:9] offset:0
    v_mul_f32 v20, v20, v200
    s_waitcnt lgkmcnt(3)
    v_mfma_f32_16x16x32_bf16 v[44:47], v[164:167], v[84:87], v[44:47]
    v_mul_f32 v21, v21, v201
    v_mul_f32 v22, v22, v202
    s_waitcnt lgkmcnt(2)
    v_mfma_f32_16x16x32_bf16 v[44:47], v[168:171], v[88:91], v[44:47]
    v_mul_f32 v23, v23, v203
    v_cvt_pk_bf16_f32 v20, v20, v21
    s_waitcnt lgkmcnt(1)
    v_mfma_f32_16x16x32_bf16 v[44:47], v[172:175], v[92:95], v[44:47]
    v_cvt_pk_bf16_f32 v21, v22, v23
    ds_write_b64 v220, v[20:21] offset:256
    s_nop 5
    v_mul_f32 v44, v44, v200
    v_mul_f32 v45, v45, v201
    v_mul_f32 v46, v46, v202
    v_mul_f32 v47, v47, v203
    v_cvt_pk_bf16_f32 v44, v44, v45
    v_cvt_pk_bf16_f32 v45, v46, v47
    ds_write_b64 v204, v[44:45] offset:768
    s_waitcnt lgkmcnt(0)
    s_barrier
    ds_read_b128 v[212:215], v211 offset:0
    s_waitcnt lgkmcnt(0)
    buffer_store_dwordx4 v[212:215], v210, s[4:7], s66 offen offset:0 sc1
    s_or_b32 s89, s89, s20
    s_cbranch_scc1 K2_end
    v_mov_b32 v0, 0
    v_mov_b32 v1, s88
    s_mov_b64 exec, 1
    buffer_store_dword v1, v0, s[16:19], 0 offen
K2_end:
K2_last:
    s_endpgm
SLOW:
    v_readlane_b32 s89, v4, 62
    s_waitcnt vmcnt(0) lgkmcnt(0)
    s_barrier
    s_load_dwordx2 s[22:23], s[0:1], 8
    s_load_dwordx2 s[24:25], s[0:1], 24
    s_load_dwordx2 s[26:27], s[0:1], 32
    s_load_dwordx2 s[28:29], s[0:1], 40
    s_load_dwordx2 s[30:31], s[0:1], 0
    v_mbcnt_lo_u32_b32 v240, -1, 0
    v_mbcnt_hi_u32_b32 v240, -1, v240
    v_lshrrev_b32 v229, 5, v240
    v_and_b32 v230, 31, v240
    v_lshlrev_b32 v241, 7, v229
    v_lshl_add_u32 v241, v230, 1, v241
    v_lshlrev_b32 v245, 4, v240
    v_mov_b32 v242, 0
    s_waitcnt lgkmcnt(0)
    s_mov_b32 s80, s22
    s_and_b32 s81, s23, 0xffff
    s_mov_b32 s82, 1920000
    s_mov_b32 s83, 0x20000
    s_mov_b32 s76, s24
    s_and_b32 s77, s25, 0xffff
    s_mov_b32 s78, 1280000
    s_mov_b32 s79, 0x20000
    s_mov_b32 s72, s26
    s_and_b32 s73, s27, 0xffff
    s_mov_b32 s74, 1280000
    s_mov_b32 s75, 0x20000
    s_mov_b32 s84, s28
    s_and_b32 s85, s29, 0xffff
    s_mov_b32 s86, 20480
    s_mov_b32 s87, 0x20000
    s_mov_b32 s4, s30
    s_and_b32 s5, s31, 0xffff
    s_mov_b32 s6, 10240000
    s_mov_b32 s7, 0x20000
    s_mov_b32 s66, 0
    buffer_load_ushort v0, v241, s[84:87], s66 offen offset:0
    buffer_load_ushort v1, v241, s[84:87], s66 offen offset:64
    buffer_load_ushort v2, v241, s[84:87], s66 offen offset:256
    buffer_load_ushort v3, v241, s[84:87], s66 offen offset:320
    buffer_load_ushort v4, v241, s[84:87], s66 offen offset:512
    buffer_load_ushort v5, v241, s[84:87], s66 offen offset:576
    buffer_load_ushort v6, v241, s[84:87], s66 offen offset:768
    buffer_load_ushort v7, v241, s[84:87], s66 offen offset:832
    buffer_load_ushort v8, v241, s[84:87], s66 offen offset:1024
    buffer_load_ushort v9, v241, s[84:87], s66 offen offset:1088
    s_waitcnt vmcnt(0)
    s_mov_b32 s66, 1280
    buffer_load_ushort v10, v241, s[84:87], s66 offen offset:0
    buffer_load_ushort v11, v241, s[84:87], s66 offen offset:64
    buffer_load_ushort v12, v241, s[84:87], s66 offen offset:256
    buffer_load_ushort v13, v241, s[84:87], s66 offen offset:320
    buffer_load_ushort v14, v241, s[84:87], s66 offen offset:512
    buffer_load_ushort v15, v241, s[84:87], s66 offen offset:576
    buffer_load_ushort v16, v241, s[84:87], s66 offen offset:768
    buffer_load_ushort v17, v241, s[84:87], s66 offen offset:832
    buffer_load_ushort v18, v241, s[84:87], s66 offen offset:1024
    buffer_load_ushort v19, v241, s[84:87], s66 offen offset:1088
    s_waitcnt vmcnt(0)
    s_mov_b32 s66, 2560
    buffer_load_ushort v20, v241, s[84:87], s66 offen offset:0
    buffer_load_ushort v21, v241, s[84:87], s66 offen offset:64
    buffer_load_ushort v22, v241, s[84:87], s66 offen offset:256
    buffer_load_ushort v23, v241, s[84:87], s66 offen offset:320
    buffer_load_ushort v24, v241, s[84:87], s66 offen offset:512
    buffer_load_ushort v25, v241, s[84:87], s66 offen offset:576
    buffer_load_ushort v26, v241, s[84:87], s66 offen offset:768
    buffer_load_ushort v27, v241, s[84:87], s66 offen offset:832
    buffer_load_ushort v28, v241, s[84:87], s66 offen offset:1024
    buffer_load_ushort v29, v241, s[84:87], s66 offen offset:1088
    s_waitcnt vmcnt(0)
    s_mov_b32 s66, 3840
    buffer_load_ushort v30, v241, s[84:87], s66 offen offset:0
    buffer_load_ushort v31, v241, s[84:87], s66 offen offset:64
    buffer_load_ushort v32, v241, s[84:87], s66 offen offset:256
    buffer_load_ushort v33, v241, s[84:87], s66 offen offset:320
    buffer_load_ushort v34, v241, s[84:87], s66 offen offset:512
    buffer_load_ushort v35, v241, s[84:87], s66 offen offset:576
    buffer_load_ushort v36, v241, s[84:87], s66 offen offset:768
    buffer_load_ushort v37, v241, s[84:87], s66 offen offset:832
    buffer_load_ushort v38, v241, s[84:87], s66 offen offset:1024
    buffer_load_ushort v39, v241, s[84:87], s66 offen offset:1088
    s_waitcnt vmcnt(0)
    s_mov_b32 s66, 5120
    buffer_load_ushort v40, v241, s[84:87], s66 offen offset:0
    buffer_load_ushort v41, v241, s[84:87], s66 offen offset:64
    buffer_load_ushort v42, v241, s[84:87], s66 offen offset:256
    buffer_load_ushort v43, v241, s[84:87], s66 offen offset:320
    buffer_load_ushort v44, v241, s[84:87], s66 offen offset:512
    buffer_load_ushort v45, v241, s[84:87], s66 offen offset:576
    buffer_load_ushort v46, v241, s[84:87], s66 offen offset:768
    buffer_load_ushort v47, v241, s[84:87], s66 offen offset:832
    buffer_load_ushort v48, v241, s[84:87], s66 offen offset:1024
    buffer_load_ushort v49, v241, s[84:87], s66 offen offset:1088
    s_waitcnt vmcnt(0)
    s_mov_b32 s66, 6400
    buffer_load_ushort v50, v241, s[84:87], s66 offen offset:0
    buffer_load_ushort v51, v241, s[84:87], s66 offen offset:64
    buffer_load_ushort v52, v241, s[84:87], s66 offen offset:256
    buffer_load_ushort v53, v241, s[84:87], s66 offen offset:320
    buffer_load_ushort v54, v241, s[84:87], s66 offen offset:512
    buffer_load_ushort v55, v241, s[84:87], s66 offen offset:576
    buffer_load_ushort v56, v241, s[84:87], s66 offen offset:768
    buffer_load_ushort v57, v241, s[84:87], s66 offen offset:832
    buffer_load_ushort v58, v241, s[84:87], s66 offen offset:1024
    buffer_load_ushort v59, v241, s[84:87], s66 offen offset:1088
    s_waitcnt vmcnt(0)
    s_mov_b32 s66, 7680
    buffer_load_ushort v60, v241, s[84:87], s66 offen offset:0
    buffer_load_ushort v61, v241, s[84:87], s66 offen offset:64
    buffer_load_ushort v62, v241, s[84:87], s66 offen offset:256
    buffer_load_ushort v63, v241, s[84:87], s66 offen offset:320
    buffer_load_ushort v64, v241, s[84:87], s66 offen offset:512
    buffer_load_ushort v65, v241, s[84:87], s66 offen offset:576
    buffer_load_ushort v66, v241, s[84:87], s66 offen offset:768
    buffer_load_ushort v67, v241, s[84:87], s66 offen offset:832
    buffer_load_ushort v68, v241, s[84:87], s66 offen offset:1024
    buffer_load_ushort v69, v241, s[84:87], s66 offen offset:1088
    s_waitcnt vmcnt(0)
    s_mov_b32 s66, 8960
    buffer_load_ushort v70, v241, s[84:87], s66 offen offset:0
    buffer_load_ushort v71, v241, s[84:87], s66 offen offset:64
    buffer_load_ushort v72, v241, s[84:87], s66 offen offset:256
    buffer_load_ushort v73, v241, s[84:87], s66 offen offset:320
    buffer_load_ushort v74, v241, s[84:87], s66 offen offset:512
    buffer_load_ushort v75, v241, s[84:87], s66 offen offset:576
    buffer_load_ushort v76, v241, s[84:87], s66 offen offset:768
    buffer_load_ushort v77, v241, s[84:87], s66 offen offset:832
    buffer_load_ushort v78, v241, s[84:87], s66 offen offset:1024
    buffer_load_ushort v79, v241, s[84:87], s66 offen offset:1088
    s_waitcnt vmcnt(0)
    s_mov_b32 s66, 10240
    buffer_load_ushort v80, v241, s[84:87], s66 offen offset:0
    buffer_load_ushort v81, v241, s[84:87], s66 offen offset:64
    buffer_load_ushort v82, v241, s[84:87], s66 offen offset:256
    buffer_load_ushort v83, v241, s[84:87], s66 offen offset:320
    buffer_load_ushort v84, v241, s[84:87], s66 offen offset:512
    buffer_load_ushort v85, v241, s[84:87], s66 offen offset:576
    buffer_load_ushort v86, v241, s[84:87], s66 offen offset:768
    buffer_load_ushort v87, v241, s[84:87], s66 offen offset:832
    buffer_load_ushort v88, v241, s[84:87], s66 offen offset:1024
    buffer_load_ushort v89, v241, s[84:87], s66 offen offset:1088
    s_waitcnt vmcnt(0)
    s_mov_b32 s66, 11520
    buffer_load_ushort v90, v241, s[84:87], s66 offen offset:0
    buffer_load_ushort v91, v241, s[84:87], s66 offen offset:64
    buffer_load_ushort v92, v241, s[84:87], s66 offen offset:256
    buffer_load_ushort v93, v241, s[84:87], s66 offen offset:320
    buffer_load_ushort v94, v241, s[84:87], s66 offen offset:512
    buffer_load_ushort v95, v241, s[84:87], s66 offen offset:576
    buffer_load_ushort v96, v241, s[84:87], s66 offen offset:768
    buffer_load_ushort v97, v241, s[84:87], s66 offen offset:832
    buffer_load_ushort v98, v241, s[84:87], s66 offen offset:1024
    buffer_load_ushort v99, v241, s[84:87], s66 offen offset:1088
    s_waitcnt vmcnt(0)
    s_mov_b32 s66, 12800
    buffer_load_ushort v100, v241, s[84:87], s66 offen offset:0
    buffer_load_ushort v101, v241, s[84:87], s66 offen offset:64
    buffer_load_ushort v102, v241, s[84:87], s66 offen offset:256
    buffer_load_ushort v103, v241, s[84:87], s66 offen offset:320
    buffer_load_ushort v104, v241, s[84:87], s66 offen offset:512
    buffer_load_ushort v105, v241, s[84:87], s66 offen offset:576
    buffer_load_ushort v106, v241, s[84:87], s66 offen offset:768
    buffer_load_ushort v107, v241, s[84:87], s66 offen offset:832
    buffer_load_ushort v108, v241, s[84:87], s66 offen offset:1024
    buffer_load_ushort v109, v241, s[84:87], s66 offen offset:1088
    s_waitcnt vmcnt(0)
    s_mov_b32 s66, 14080
    buffer_load_ushort v110, v241, s[84:87], s66 offen offset:0
    buffer_load_ushort v111, v241, s[84:87], s66 offen offset:64
    buffer_load_ushort v112, v241, s[84:87], s66 offen offset:256
    buffer_load_ushort v113, v241, s[84:87], s66 offen offset:320
    buffer_load_ushort v114, v241, s[84:87], s66 offen offset:512
    buffer_load_ushort v115, v241, s[84:87], s66 offen offset:576
    buffer_load_ushort v116, v241, s[84:87], s66 offen offset:768
    buffer_load_ushort v117, v241, s[84:87], s66 offen offset:832
    buffer_load_ushort v118, v241, s[84:87], s66 offen offset:1024
    buffer_load_ushort v119, v241, s[84:87], s66 offen offset:1088
    s_waitcnt vmcnt(0)
    s_mov_b32 s66, 15360
    buffer_load_ushort v120, v241, s[84:87], s66 offen offset:0
    buffer_load_ushort v121, v241, s[84:87], s66 offen offset:64
    buffer_load_ushort v122, v241, s[84:87], s66 offen offset:256
    buffer_load_ushort v123, v241, s[84:87], s66 offen offset:320
    buffer_load_ushort v124, v241, s[84:87], s66 offen offset:512
    buffer_load_ushort v125, v241, s[84:87], s66 offen offset:576
    buffer_load_ushort v126, v241, s[84:87], s66 offen offset:768
    buffer_load_ushort v127, v241, s[84:87], s66 offen offset:832
    buffer_load_ushort v128, v241, s[84:87], s66 offen offset:1024
    buffer_load_ushort v129, v241, s[84:87], s66 offen offset:1088
    s_waitcnt vmcnt(0)
    s_mov_b32 s66, 16640
    buffer_load_ushort v130, v241, s[84:87], s66 offen offset:0
    buffer_load_ushort v131, v241, s[84:87], s66 offen offset:64
    buffer_load_ushort v132, v241, s[84:87], s66 offen offset:256
    buffer_load_ushort v133, v241, s[84:87], s66 offen offset:320
    buffer_load_ushort v134, v241, s[84:87], s66 offen offset:512
    buffer_load_ushort v135, v241, s[84:87], s66 offen offset:576
    buffer_load_ushort v136, v241, s[84:87], s66 offen offset:768
    buffer_load_ushort v137, v241, s[84:87], s66 offen offset:832
    buffer_load_ushort v138, v241, s[84:87], s66 offen offset:1024
    buffer_load_ushort v139, v241, s[84:87], s66 offen offset:1088
    s_waitcnt vmcnt(0)
    s_mov_b32 s66, 17920
    buffer_load_ushort v140, v241, s[84:87], s66 offen offset:0
    buffer_load_ushort v141, v241, s[84:87], s66 offen offset:64
    buffer_load_ushort v142, v241, s[84:87], s66 offen offset:256
    buffer_load_ushort v143, v241, s[84:87], s66 offen offset:320
    buffer_load_ushort v144, v241, s[84:87], s66 offen offset:512
    buffer_load_ushort v145, v241, s[84:87], s66 offen offset:576
    buffer_load_ushort v146, v241, s[84:87], s66 offen offset:768
    buffer_load_ushort v147, v241, s[84:87], s66 offen offset:832
    buffer_load_ushort v148, v241, s[84:87], s66 offen offset:1024
    buffer_load_ushort v149, v241, s[84:87], s66 offen offset:1088
    s_waitcnt vmcnt(0)
    s_mov_b32 s66, 19200
    buffer_load_ushort v150, v241, s[84:87], s66 offen offset:0
    buffer_load_ushort v151, v241, s[84:87], s66 offen offset:64
    buffer_load_ushort v152, v241, s[84:87], s66 offen offset:256
    buffer_load_ushort v153, v241, s[84:87], s66 offen offset:320
    buffer_load_ushort v154, v241, s[84:87], s66 offen offset:512
    buffer_load_ushort v155, v241, s[84:87], s66 offen offset:576
    buffer_load_ushort v156, v241, s[84:87], s66 offen offset:768
    buffer_load_ushort v157, v241, s[84:87], s66 offen offset:832
    buffer_load_ushort v158, v241, s[84:87], s66 offen offset:1024
    buffer_load_ushort v159, v241, s[84:87], s66 offen offset:1088
    s_waitcnt vmcnt(0)
    v_lshlrev_b32 v0, 16, v0
    v_lshlrev_b32 v1, 16, v1
    v_lshlrev_b32 v2, 16, v2
    v_lshlrev_b32 v3, 16, v3
    v_lshlrev_b32 v4, 16, v4
    v_lshlrev_b32 v5, 16, v5
    v_lshlrev_b32 v6, 16, v6
    v_lshlrev_b32 v7, 16, v7
    v_lshlrev_b32 v8, 16, v8
    v_lshlrev_b32 v9, 16, v9
    v_lshlrev_b32 v10, 16, v10
    v_lshlrev_b32 v11, 16, v11
    v_lshlrev_b32 v12, 16, v12
    v_lshlrev_b32 v13, 16, v13
    v_lshlrev_b32 v14, 16, v14
    v_lshlrev_b32 v15, 16, v15
    v_lshlrev_b32 v16, 16, v16
    v_lshlrev_b32 v17, 16, v17
    v_lshlrev_b32 v18, 16, v18
    v_lshlrev_b32 v19, 16, v19
    v_lshlrev_b32 v20, 16, v20
    v_lshlrev_b32 v21, 16, v21
    v_lshlrev_b32 v22, 16, v22
    v_lshlrev_b32 v23, 16, v23
    v_lshlrev_b32 v24, 16, v24
    v_lshlrev_b32 v25, 16, v25
    v_lshlrev_b32 v26, 16, v26
    v_lshlrev_b32 v27, 16, v27
    v_lshlrev_b32 v28, 16, v28
    v_lshlrev_b32 v29, 16, v29
    v_lshlrev_b32 v30, 16, v30
    v_lshlrev_b32 v31, 16, v31
    v_lshlrev_b32 v32, 16, v32
    v_lshlrev_b32 v33, 16, v33
    v_lshlrev_b32 v34, 16, v34
    v_lshlrev_b32 v35, 16, v35
    v_lshlrev_b32 v36, 16, v36
    v_lshlrev_b32 v37, 16, v37
    v_lshlrev_b32 v38, 16, v38
    v_lshlrev_b32 v39, 16, v39
    v_lshlrev_b32 v40, 16, v40
    v_lshlrev_b32 v41, 16, v41
    v_lshlrev_b32 v42, 16, v42
    v_lshlrev_b32 v43, 16, v43
    v_lshlrev_b32 v44, 16, v44
    v_lshlrev_b32 v45, 16, v45
    v_lshlrev_b32 v46, 16, v46
    v_lshlrev_b32 v47, 16, v47
    v_lshlrev_b32 v48, 16, v48
    v_lshlrev_b32 v49, 16, v49
    v_lshlrev_b32 v50, 16, v50
    v_lshlrev_b32 v51, 16, v51
    v_lshlrev_b32 v52, 16, v52
    v_lshlrev_b32 v53, 16, v53
    v_lshlrev_b32 v54, 16, v54
    v_lshlrev_b32 v55, 16, v55
    v_lshlrev_b32 v56, 16, v56
    v_lshlrev_b32 v57, 16, v57
    v_lshlrev_b32 v58, 16, v58
    v_lshlrev_b32 v59, 16, v59
    v_lshlrev_b32 v60, 16, v60
    v_lshlrev_b32 v61, 16, v61
    v_lshlrev_b32 v62, 16, v62
    v_lshlrev_b32 v63, 16, v63
    v_lshlrev_b32 v64, 16, v64
    v_lshlrev_b32 v65, 16, v65
    v_lshlrev_b32 v66, 16, v66
    v_lshlrev_b32 v67, 16, v67
    v_lshlrev_b32 v68, 16, v68
    v_lshlrev_b32 v69, 16, v69
    v_lshlrev_b32 v70, 16, v70
    v_lshlrev_b32 v71, 16, v71
    v_lshlrev_b32 v72, 16, v72
    v_lshlrev_b32 v73, 16, v73
    v_lshlrev_b32 v74, 16, v74
    v_lshlrev_b32 v75, 16, v75
    v_lshlrev_b32 v76, 16, v76
    v_lshlrev_b32 v77, 16, v77
    v_lshlrev_b32 v78, 16, v78
    v_lshlrev_b32 v79, 16, v79
    v_lshlrev_b32 v80, 16, v80
    v_lshlrev_b32 v81, 16, v81
    v_lshlrev_b32 v82, 16, v82
    v_lshlrev_b32 v83, 16, v83
    v_lshlrev_b32 v84, 16, v84
    v_lshlrev_b32 v85, 16, v85
    v_lshlrev_b32 v86, 16, v86
    v_lshlrev_b32 v87, 16, v87
    v_lshlrev_b32 v88, 16, v88
    v_lshlrev_b32 v89, 16, v89
    v_lshlrev_b32 v90, 16, v90
    v_lshlrev_b32 v91, 16, v91
    v_lshlrev_b32 v92, 16, v92
    v_lshlrev_b32 v93, 16, v93
    v_lshlrev_b32 v94, 16, v94
    v_lshlrev_b32 v95, 16, v95
    v_lshlrev_b32 v96, 16, v96
    v_lshlrev_b32 v97, 16, v97
    v_lshlrev_b32 v98, 16, v98
    v_lshlrev_b32 v99, 16, v99
    v_lshlrev_b32 v100, 16, v100
    v_lshlrev_b32 v101, 16, v101
    v_lshlrev_b32 v102, 16, v102
    v_lshlrev_b32 v103, 16, v103
    v_lshlrev_b32 v104, 16, v104
    v_lshlrev_b32 v105, 16, v105
    v_lshlrev_b32 v106, 16, v106
    v_lshlrev_b32 v107, 16, v107
    v_lshlrev_b32 v108, 16, v108
    v_lshlrev_b32 v109, 16, v109
    v_lshlrev_b32 v110, 16, v110
    v_lshlrev_b32 v111, 16, v111
    v_lshlrev_b32 v112, 16, v112
    v_lshlrev_b32 v113, 16, v113
    v_lshlrev_b32 v114, 16, v114
    v_lshlrev_b32 v115, 16, v115
    v_lshlrev_b32 v116, 16, v116
    v_lshlrev_b32 v117, 16, v117
    v_lshlrev_b32 v118, 16, v118
    v_lshlrev_b32 v119, 16, v119
    v_lshlrev_b32 v120, 16, v120
    v_lshlrev_b32 v121, 16, v121
    v_lshlrev_b32 v122, 16, v122
    v_lshlrev_b32 v123, 16, v123
    v_lshlrev_b32 v124, 16, v124
    v_lshlrev_b32 v125, 16, v125
    v_lshlrev_b32 v126, 16, v126
    v_lshlrev_b32 v127, 16, v127
    v_lshlrev_b32 v128, 16, v128
    v_lshlrev_b32 v129, 16, v129
    v_lshlrev_b32 v130, 16, v130
    v_lshlrev_b32 v131, 16, v131
    v_lshlrev_b32 v132, 16, v132
    v_lshlrev_b32 v133, 16, v133
    v_lshlrev_b32 v134, 16, v134
    v_lshlrev_b32 v135, 16, v135
    v_lshlrev_b32 v136, 16, v136
    v_lshlrev_b32 v137, 16, v137
    v_lshlrev_b32 v138, 16, v138
    v_lshlrev_b32 v139, 16, v139
    v_lshlrev_b32 v140, 16, v140
    v_lshlrev_b32 v141, 16, v141
    v_lshlrev_b32 v142, 16, v142
    v_lshlrev_b32 v143, 16, v143
    v_lshlrev_b32 v144, 16, v144
    v_lshlrev_b32 v145, 16, v145
    v_lshlrev_b32 v146, 16, v146
    v_lshlrev_b32 v147, 16, v147
    v_lshlrev_b32 v148, 16, v148
    v_lshlrev_b32 v149, 16, v149
    v_lshlrev_b32 v150, 16, v150
    v_lshlrev_b32 v151, 16, v151
    v_lshlrev_b32 v152, 16, v152
    v_lshlrev_b32 v153, 16, v153
    v_lshlrev_b32 v154, 16, v154
    v_lshlrev_b32 v155, 16, v155
    v_lshlrev_b32 v156, 16, v156
    v_lshlrev_b32 v157, 16, v157
    v_lshlrev_b32 v158, 16, v158
    v_lshlrev_b32 v159, 16, v159
    s_mov_b32 s50, 0
SL_node:
    s_mul_i32 s34, s2, 40
    s_mul_i32 s66, s20, 5
    s_add_u32 s66, s66, s50
    s_add_u32 s34, s34, s66
    v_mov_b32 v160, 0
    v_mov_b32 v161, 0
    v_mov_b32 v162, 0
    v_mov_b32 v163, 0
    v_mov_b32 v164, 0
    v_mov_b32 v165, 0
    v_mov_b32 v166, 0
    v_mov_b32 v167, 0
    v_mov_b32 v168, 0
    v_mov_b32 v169, 0
    v_mov_b32 v170, 0
    v_mov_b32 v171, 0
    v_mov_b32 v172, 0
    v_mov_b32 v173, 0
    v_mov_b32 v174, 0
    v_mov_b32 v175, 0
    v_mov_b32 v176, 0
    v_mov_b32 v177, 0
    v_mov_b32 v178, 0
    v_mov_b32 v179, 0
    v_mov_b32 v180, 0
    v_mov_b32 v181, 0
    s_mov_b32 s35, 0
SL_scan:
    s_lshl_b32 s66, s35, 2
    buffer_load_dwordx4 v[236:239], v245, s[72:75], s66 offen
    s_waitcnt vmcnt(0)
    v_cmp_eq_u32 s[38:39], s34, v236
    v_cmp_eq_u32 s[40:41], s34, v237
    v_cmp_eq_u32 s[42:43], s34, v238
    v_cmp_eq_u32 s[44:45], s34, v239
    s_mov_b32 s36, 0
SL_bits:
    s_cmp_eq_u64 s[38:39], 0
    s_cbranch_scc1 SL_nexti
    s_ff1_i32_b64 s66, s[38:39]
    s_bitset0_b64 s[38:39], s66
    s_lshl_b32 s66, s66, 2
    s_add_u32 s37, s66, s36
    s_add_u32 s37, s37, s35
    s_lshl_b32 s66, s37, 2
    s_lshl_b32 s67, s37, 5
    s_mul_i32 s68, s37, 6
    buffer_load_dword v243, v242, s[76:79], s66 offen
    buffer_load_dwordx4 v[184:187], v242, s[12:15], s67 offen
    buffer_load_dwordx4 v[188:191], v242, s[12:15], s67 offen offset:16
    buffer_load_ushort v226, v242, s[80:83], s68 offen offset:0
    buffer_load_ushort v227, v242, s[80:83], s68 offen offset:2
    buffer_load_ushort v228, v242, s[80:83], s68 offen offset:4
    s_waitcnt vmcnt(5)
    v_lshl_add_u32 v243, v243, 10, v241
    buffer_load_ushort v208, v243, s[4:7], 0 offen offset:0
    buffer_load_ushort v209, v243, s[4:7], 0 offen offset:64
    buffer_load_ushort v210, v243, s[4:7], 0 offen offset:256
    buffer_load_ushort v211, v243, s[4:7], 0 offen offset:320
    buffer_load_ushort v212, v243, s[4:7], 0 offen offset:512
    buffer_load_ushort v213, v243, s[4:7], 0 offen offset:576
    buffer_load_ushort v214, v243, s[4:7], 0 offen offset:768
    buffer_load_ushort v215, v243, s[4:7], 0 offen offset:832
    s_waitcnt vmcnt(8)
    v_lshlrev_b32 v192, 16, v184
    v_and_b32 v193, 0xffff0000, v184
    v_lshlrev_b32 v194, 16, v185
    v_and_b32 v195, 0xffff0000, v185
    v_lshlrev_b32 v196, 16, v186
    v_and_b32 v197, 0xffff0000, v186
    v_lshlrev_b32 v198, 16, v187
    v_and_b32 v199, 0xffff0000, v187
    v_lshlrev_b32 v200, 16, v188
    v_and_b32 v201, 0xffff0000, v188
    v_lshlrev_b32 v202, 16, v189
    v_and_b32 v203, 0xffff0000, v189
    v_lshlrev_b32 v204, 16, v190
    v_and_b32 v205, 0xffff0000, v190
    v_lshlrev_b32 v206, 16, v191
    v_and_b32 v207, 0xffff0000, v191
    v_lshlrev_b32 v226, 16, v226
    v_lshlrev_b32 v227, 16, v227
    v_lshlrev_b32 v228, 16, v228
    v_mul_f32 v216, v192, v0
    v_mul_f32 v217, v192, v1
    v_mul_f32 v218, v192, v2
    v_mul_f32 v219, v192, v3
    v_mul_f32 v220, v192, v4
    v_mul_f32 v221, v192, v5
    v_mul_f32 v222, v192, v6
    v_mul_f32 v223, v192, v7
    v_mul_f32 v224, v192, v8
    v_mul_f32 v225, v192, v9
    v_fmac_f32 v216, v193, v10
    v_fmac_f32 v217, v193, v11
    v_fmac_f32 v218, v193, v12
    v_fmac_f32 v219, v193, v13
    v_fmac_f32 v220, v193, v14
    v_fmac_f32 v221, v193, v15
    v_fmac_f32 v222, v193, v16
    v_fmac_f32 v223, v193, v17
    v_fmac_f32 v224, v193, v18
    v_fmac_f32 v225, v193, v19
    v_fmac_f32 v216, v194, v20
    v_fmac_f32 v217, v194, v21
    v_fmac_f32 v218, v194, v22
    v_fmac_f32 v219, v194, v23
    v_fmac_f32 v220, v194, v24
    v_fmac_f32 v221, v194, v25
    v_fmac_f32 v222, v194, v26
    v_fmac_f32 v223, v194, v27
    v_fmac_f32 v224, v194, v28
    v_fmac_f32 v225, v194, v29
    v_fmac_f32 v216, v195, v30
    v_fmac_f32 v217, v195, v31
    v_fmac_f32 v218, v195, v32
    v_fmac_f32 v219, v195, v33
    v_fmac_f32 v220, v195, v34
    v_fmac_f32 v221, v195, v35
    v_fmac_f32 v222, v195, v36
    v_fmac_f32 v223, v195, v37
    v_fmac_f32 v224, v195, v38
    v_fmac_f32 v225, v195, v39
    v_fmac_f32 v216, v196, v40
    v_fmac_f32 v217, v196, v41
    v_fmac_f32 v218, v196, v42
    v_fmac_f32 v219, v196, v43
    v_fmac_f32 v220, v196, v44
    v_fmac_f32 v221, v196, v45
    v_fmac_f32 v222, v196, v46
    v_fmac_f32 v223, v196, v47
    v_fmac_f32 v224, v196, v48
    v_fmac_f32 v225, v196, v49
    v_fmac_f32 v216, v197, v50
    v_fmac_f32 v217, v197, v51
    v_fmac_f32 v218, v197, v52
    v_fmac_f32 v219, v197, v53
    v_fmac_f32 v220, v197, v54
    v_fmac_f32 v221, v197, v55
    v_fmac_f32 v222, v197, v56
    v_fmac_f32 v223, v197, v57
    v_fmac_f32 v224, v197, v58
    v_fmac_f32 v225, v197, v59
    v_fmac_f32 v216, v198, v60
    v_fmac_f32 v217, v198, v61
    v_fmac_f32 v218, v198, v62
    v_fmac_f32 v219, v198, v63
    v_fmac_f32 v220, v198, v64
    v_fmac_f32 v221, v198, v65
    v_fmac_f32 v222, v198, v66
    v_fmac_f32 v223, v198, v67
    v_fmac_f32 v224, v198, v68
    v_fmac_f32 v225, v198, v69
    v_fmac_f32 v216, v199, v70
    v_fmac_f32 v217, v199, v71
    v_fmac_f32 v218, v199, v72
    v_fmac_f32 v219, v199, v73
    v_fmac_f32 v220, v199, v74
    v_fmac_f32 v221, v199, v75
    v_fmac_f32 v222, v199, v76
    v_fmac_f32 v223, v199, v77
    v_fmac_f32 v224, v199, v78
    v_fmac_f32 v225, v199, v79
    v_fmac_f32 v216, v200, v80
    v_fmac_f32 v217, v200, v81
    v_fmac_f32 v218, v200, v82
    v_fmac_f32 v219, v200, v83
    v_fmac_f32 v220, v200, v84
    v_fmac_f32 v221, v200, v85
    v_fmac_f32 v222, v200, v86
    v_fmac_f32 v223, v200, v87
    v_fmac_f32 v224, v200, v88
    v_fmac_f32 v225, v200, v89
    v_fmac_f32 v216, v201, v90
    v_fmac_f32 v217, v201, v91
    v_fmac_f32 v218, v201, v92
    v_fmac_f32 v219, v201, v93
    v_fmac_f32 v220, v201, v94
    v_fmac_f32 v221, v201, v95
    v_fmac_f32 v222, v201, v96
    v_fmac_f32 v223, v201, v97
    v_fmac_f32 v224, v201, v98
    v_fmac_f32 v225, v201, v99
    v_fmac_f32 v216, v202, v100
    v_fmac_f32 v217, v202, v101
    v_fmac_f32 v218, v202, v102
    v_fmac_f32 v219, v202, v103
    v_fmac_f32 v220, v202, v104
    v_fmac_f32 v221, v202, v105
    v_fmac_f32 v222, v202, v106
    v_fmac_f32 v223, v202, v107
    v_fmac_f32 v224, v202, v108
    v_fmac_f32 v225, v202, v109
    v_fmac_f32 v216, v203, v110
    v_fmac_f32 v217, v203, v111
    v_fmac_f32 v218, v203, v112
    v_fmac_f32 v219, v203, v113
    v_fmac_f32 v220, v203, v114
    v_fmac_f32 v221, v203, v115
    v_fmac_f32 v222, v203, v116
    v_fmac_f32 v223, v203, v117
    v_fmac_f32 v224, v203, v118
    v_fmac_f32 v225, v203, v119
    v_fmac_f32 v216, v204, v120
    v_fmac_f32 v217, v204, v121
    v_fmac_f32 v218, v204, v122
    v_fmac_f32 v219, v204, v123
    v_fmac_f32 v220, v204, v124
    v_fmac_f32 v221, v204, v125
    v_fmac_f32 v222, v204, v126
    v_fmac_f32 v223, v204, v127
    v_fmac_f32 v224, v204, v128
    v_fmac_f32 v225, v204, v129
    v_fmac_f32 v216, v205, v130
    v_fmac_f32 v217, v205, v131
    v_fmac_f32 v218, v205, v132
    v_fmac_f32 v219, v205, v133
    v_fmac_f32 v220, v205, v134
    v_fmac_f32 v221, v205, v135
    v_fmac_f32 v222, v205, v136
    v_fmac_f32 v223, v205, v137
    v_fmac_f32 v224, v205, v138
    v_fmac_f32 v225, v205, v139
    v_fmac_f32 v216, v206, v140
    v_fmac_f32 v217, v206, v141
    v_fmac_f32 v218, v206, v142
    v_fmac_f32 v219, v206, v143
    v_fmac_f32 v220, v206, v144
    v_fmac_f32 v221, v206, v145
    v_fmac_f32 v222, v206, v146
    v_fmac_f32 v223, v206, v147
    v_fmac_f32 v224, v206, v148
    v_fmac_f32 v225, v206, v149
    v_fmac_f32 v216, v207, v150
    v_fmac_f32 v217, v207, v151
    v_fmac_f32 v218, v207, v152
    v_fmac_f32 v219, v207, v153
    v_fmac_f32 v220, v207, v154
    v_fmac_f32 v221, v207, v155
    v_fmac_f32 v222, v207, v156
    v_fmac_f32 v223, v207, v157
    v_fmac_f32 v224, v207, v158
    v_fmac_f32 v225, v207, v159
    s_waitcnt vmcnt(0)
    v_lshlrev_b32 v208, 16, v208
    v_lshlrev_b32 v209, 16, v209
    v_lshlrev_b32 v210, 16, v210
    v_lshlrev_b32 v211, 16, v211
    v_lshlrev_b32 v212, 16, v212
    v_lshlrev_b32 v213, 16, v213
    v_lshlrev_b32 v214, 16, v214
    v_lshlrev_b32 v215, 16, v215
    v_fmac_f32 v160, v208, v216
    v_mul_f32 v229, v210, v226
    v_fmac_f32 v229, v212, v227
    v_fmac_f32 v229, v214, v228
    v_fmac_f32 v176, v229, v218
    v_mul_f32 v229, v208, v220
    v_fmac_f32 v162, v229, v226
    v_fmac_f32 v168, v210, v222
    v_mul_f32 v230, v227, v214
    v_fma_f32 v230, -v228, v212, v230
    v_fmac_f32 v178, v230, v224
    v_fmac_f32 v164, v229, v227
    v_fmac_f32 v170, v212, v222
    v_mul_f32 v230, v228, v210
    v_fma_f32 v230, -v226, v214, v230
    v_fmac_f32 v180, v230, v224
    v_fmac_f32 v166, v229, v228
    v_fmac_f32 v172, v214, v222
    v_mul_f32 v230, v226, v212
    v_fma_f32 v230, -v227, v210, v230
    v_fmac_f32 v174, v230, v224
    v_fmac_f32 v161, v209, v217
    v_mul_f32 v229, v211, v226
    v_fmac_f32 v229, v213, v227
    v_fmac_f32 v229, v215, v228
    v_fmac_f32 v177, v229, v219
    v_mul_f32 v229, v209, v221
    v_fmac_f32 v163, v229, v226
    v_fmac_f32 v169, v211, v223
    v_mul_f32 v230, v227, v215
    v_fma_f32 v230, -v228, v213, v230
    v_fmac_f32 v179, v230, v225
    v_fmac_f32 v165, v229, v227
    v_fmac_f32 v171, v213, v223
    v_mul_f32 v230, v228, v211
    v_fma_f32 v230, -v226, v215, v230
    v_fmac_f32 v181, v230, v225
    v_fmac_f32 v167, v229, v228
    v_fmac_f32 v173, v215, v223
    v_mul_f32 v230, v226, v213
    v_fma_f32 v230, -v227, v211, v230
    v_fmac_f32 v175, v230, v225
    s_branch SL_bits
SL_nexti:
    s_mov_b64 s[38:39], s[40:41]
    s_mov_b64 s[40:41], s[42:43]
    s_mov_b64 s[42:43], s[44:45]
    s_add_u32 s36, s36, 1
    s_cmp_lt_u32 s36, 4
    s_cbranch_scc1 SL_bits
    s_add_u32 s35, s35, 256
    s_cmp_lt_u32 s35, 320000
    s_cbranch_scc1 SL_scan
    s_mul_i32 s66, s20, 5
    s_add_u32 s66, s66, s50
    s_lshl_b32 s67, s66, 4
    s_and_b32 s68, s67, 128
    s_and_b32 s67, s67, 0x70
    s_mul_i32 s69, s50, 1536
    s_add_u32 s69, s69, s21
    s_add_u32 s69, s69, s68
    s_mul_i32 s70, s66, 1536
    s_add_u32 s70, s70, 86016
    s_add_u32 s70, s70, s68
    v_mov_b32 v230, s69
    v_mov_b32 v231, s70
    v_cmp_gt_u32 vcc, 32, v240
    v_and_b32 v229, 31, v240
    v_lshlrev_b32 v229, 2, v229
    v_xor_b32 v229, s67, v229
    v_cndmask_b32 v244, v231, v230, vcc
    v_add_u32 v244, v244, v229
    v_cvt_pk_bf16_f32 v160, v160, v161
    ds_write_b32 v244, v160 offset:0
    v_cvt_pk_bf16_f32 v162, v162, v163
    ds_write_b32 v244, v162 offset:128
    v_cvt_pk_bf16_f32 v164, v164, v165
    ds_write_b32 v244, v164 offset:256
    v_cvt_pk_bf16_f32 v166, v166, v167
    ds_write_b32 v244, v166 offset:384
    v_cvt_pk_bf16_f32 v168, v168, v169
    ds_write_b32 v244, v168 offset:512
    v_cvt_pk_bf16_f32 v170, v170, v171
    ds_write_b32 v244, v170 offset:640
    v_cvt_pk_bf16_f32 v172, v172, v173
    ds_write_b32 v244, v172 offset:768
    v_cvt_pk_bf16_f32 v174, v174, v175
    ds_write_b32 v244, v174 offset:896
    v_cvt_pk_bf16_f32 v176, v176, v177
    ds_write_b32 v244, v176 offset:1024
    v_cvt_pk_bf16_f32 v178, v178, v179
    ds_write_b32 v244, v178 offset:1152
    v_cvt_pk_bf16_f32 v180, v180, v181
    ds_write_b32 v244, v180 offset:1280
    s_lshl_b32 s66, s66, 3
    s_add_u32 s66, s66, 163328
    v_mov_b32 v229, s66
    ds_write_b64 v229, v[230:231]
    s_add_u32 s50, s50, 1
    s_cmp_lt_u32 s50, 5
    s_cbranch_scc1 SL_node
    s_waitcnt lgkmcnt(0)
    s_barrier
    v_mov_b32 v176, v240
    s_load_dwordx4 s[84:87], s[0:1], 48
    s_mul_i32 s22, s20, 20
    s_waitcnt lgkmcnt(0)
    s_mul_i32 s24, s22, 3277
    s_lshr_b32 s24, s24, 16
    s_mul_i32 s68, s24, 20
    s_sub_u32 s68, s22, s68
    s_cmp_lt_u32 s68, 8
    s_cselect_b64 s[66:67], s[84:85], s[86:87]
    s_cselect_b32 s25, 0, 8
    s_sub_u32 s68, s68, s25
    s_and_b32 s25, s68, 1
    s_lshr_b32 s68, s68, 1
    s_lshl_b32 s68, s68, 14
    s_lshl_b32 s25, s25, 12
    s_add_u32 s68, s68, s25
    s_lshl_b32 s24, s24, 5
    s_add_u32 s68, s68, s24
    v_lshrrev_b32 v2, 4, v176
    v_lshlrev_b32 v2, 10, v2
    v_and_b32 v3, 15, v176
    v_lshl_add_u32 v2, v3, 1, v2
    v_add_u32 v2, s68, v2
    v_add_u32 v3, 8192, v2
    v_mov_b32 v4, 0
    v_mov_b32 v5, 0
    v_mov_b32 v6, 0
    v_mov_b32 v7, 0
    global_load_ushort v96, v2, s[66:67] offset:0
    global_load_short_d16_hi v4, v3, s[66:67] offset:0
    global_load_ushort v97, v2, s[66:67] offset:256
    global_load_short_d16_hi v5, v3, s[66:67] offset:256
    global_load_ushort v98, v2, s[66:67] offset:512
    global_load_short_d16_hi v6, v3, s[66:67] offset:512
    global_load_ushort v99, v2, s[66:67] offset:768
    global_load_short_d16_hi v7, v3, s[66:67] offset:768
    s_add_u32 s22, s22, 1
    s_waitcnt vmcnt(0)
    v_or_b32 v96, v96, v4
    v_or_b32 v97, v97, v5
    v_or_b32 v98, v98, v6
    v_or_b32 v99, v99, v7
    s_mul_i32 s24, s22, 3277
    s_lshr_b32 s24, s24, 16
    s_mul_i32 s68, s24, 20
    s_sub_u32 s68, s22, s68
    s_cmp_lt_u32 s68, 8
    s_cselect_b64 s[66:67], s[84:85], s[86:87]
    s_cselect_b32 s25, 0, 8
    s_sub_u32 s68, s68, s25
    s_and_b32 s25, s68, 1
    s_lshr_b32 s68, s68, 1
    s_lshl_b32 s68, s68, 14
    s_lshl_b32 s25, s25, 12
    s_add_u32 s68, s68, s25
    s_lshl_b32 s24, s24, 5
    s_add_u32 s68, s68, s24
    v_lshrrev_b32 v2, 4, v176
    v_lshlrev_b32 v2, 10, v2
    v_and_b32 v3, 15, v176
    v_lshl_add_u32 v2, v3, 1, v2
    v_add_u32 v2, s68, v2
    v_add_u32 v3, 8192, v2
    v_mov_b32 v4, 0
    v_mov_b32 v5, 0
    v_mov_b32 v6, 0
    v_mov_b32 v7, 0
    global_load_ushort v100, v2, s[66:67] offset:0
    global_load_short_d16_hi v4, v3, s[66:67] offset:0
    global_load_ushort v101, v2, s[66:67] offset:256
    global_load_short_d16_hi v5, v3, s[66:67] offset:256
    global_load_ushort v102, v2, s[66:67] offset:512
    global_load_short_d16_hi v6, v3, s[66:67] offset:512
    global_load_ushort v103, v2, s[66:67] offset:768
    global_load_short_d16_hi v7, v3, s[66:67] offset:768
    s_add_u32 s22, s22, 1
    s_waitcnt vmcnt(0)
    v_or_b32 v100, v100, v4
    v_or_b32 v101, v101, v5
    v_or_b32 v102, v102, v6
    v_or_b32 v103, v103, v7
    s_mul_i32 s24, s22, 3277
    s_lshr_b32 s24, s24, 16
    s_mul_i32 s68, s24, 20
    s_sub_u32 s68, s22, s68
    s_cmp_lt_u32 s68, 8
    s_cselect_b64 s[66:67], s[84:85], s[86:87]
    s_cselect_b32 s25, 0, 8
    s_sub_u32 s68, s68, s25
    s_and_b32 s25, s68, 1
    s_lshr_b32 s68, s68, 1
    s_lshl_b32 s68, s68, 14
    s_lshl_b32 s25, s25, 12
    s_add_u32 s68, s68, s25
    s_lshl_b32 s24, s24, 5
    s_add_u32 s68, s68, s24
    v_lshrrev_b32 v2, 4, v176
    v_lshlrev_b32 v2, 10, v2
    v_and_b32 v3, 15, v176
    v_lshl_add_u32 v2, v3, 1, v2
    v_add_u32 v2, s68, v2
    v_add_u32 v3, 8192, v2
    v_mov_b32 v4, 0
    v_mov_b32 v5, 0
    v_mov_b32 v6, 0
    v_mov_b32 v7, 0
    global_load_ushort v104, v2, s[66:67] offset:0
    global_load_short_d16_hi v4, v3, s[66:67] offset:0
    global_load_ushort v105, v2, s[66:67] offset:256
    global_load_short_d16_hi v5, v3, s[66:67] offset:256
    global_load_ushort v106, v2, s[66:67] offset:512
    global_load_short_d16_hi v6, v3, s[66:67] offset:512
    global_load_ushort v107, v2, s[66:67] offset:768
    global_load_short_d16_hi v7, v3, s[66:67] offset:768
    s_add_u32 s22, s22, 1
    s_waitcnt vmcnt(0)
    v_or_b32 v104, v104, v4
    v_or_b32 v105, v105, v5
    v_or_b32 v106, v106, v6
    v_or_b32 v107, v107, v7
    s_mul_i32 s24, s22, 3277
    s_lshr_b32 s24, s24, 16
    s_mul_i32 s68, s24, 20
    s_sub_u32 s68, s22, s68
    s_cmp_lt_u32 s68, 8
    s_cselect_b64 s[66:67], s[84:85], s[86:87]
    s_cselect_b32 s25, 0, 8
    s_sub_u32 s68, s68, s25
    s_and_b32 s25, s68, 1
    s_lshr_b32 s68, s68, 1
    s_lshl_b32 s68, s68, 14
    s_lshl_b32 s25, s25, 12
    s_add_u32 s68, s68, s25
    s_lshl_b32 s24, s24, 5
    s_add_u32 s68, s68, s24
    v_lshrrev_b32 v2, 4, v176
    v_lshlrev_b32 v2, 10, v2
    v_and_b32 v3, 15, v176
    v_lshl_add_u32 v2, v3, 1, v2
    v_add_u32 v2, s68, v2
    v_add_u32 v3, 8192, v2
    v_mov_b32 v4, 0
    v_mov_b32 v5, 0
    v_mov_b32 v6, 0
    v_mov_b32 v7, 0
    global_load_ushort v108, v2, s[66:67] offset:0
    global_load_short_d16_hi v4, v3, s[66:67] offset:0
    global_load_ushort v109, v2, s[66:67] offset:256
    global_load_short_d16_hi v5, v3, s[66:67] offset:256
    global_load_ushort v110, v2, s[66:67] offset:512
    global_load_short_d16_hi v6, v3, s[66:67] offset:512
    global_load_ushort v111, v2, s[66:67] offset:768
    global_load_short_d16_hi v7, v3, s[66:67] offset:768
    s_add_u32 s22, s22, 1
    s_waitcnt vmcnt(0)
    v_or_b32 v108, v108, v4
    v_or_b32 v109, v109, v5
    v_or_b32 v110, v110, v6
    v_or_b32 v111, v111, v7
    s_mul_i32 s24, s22, 3277
    s_lshr_b32 s24, s24, 16
    s_mul_i32 s68, s24, 20
    s_sub_u32 s68, s22, s68
    s_cmp_lt_u32 s68, 8
    s_cselect_b64 s[66:67], s[84:85], s[86:87]
    s_cselect_b32 s25, 0, 8
    s_sub_u32 s68, s68, s25
    s_and_b32 s25, s68, 1
    s_lshr_b32 s68, s68, 1
    s_lshl_b32 s68, s68, 14
    s_lshl_b32 s25, s25, 12
    s_add_u32 s68, s68, s25
    s_lshl_b32 s24, s24, 5
    s_add_u32 s68, s68, s24
    v_lshrrev_b32 v2, 4, v176
    v_lshlrev_b32 v2, 10, v2
    v_and_b32 v3, 15, v176
    v_lshl_add_u32 v2, v3, 1, v2
    v_add_u32 v2, s68, v2
    v_add_u32 v3, 8192, v2
    v_mov_b32 v4, 0
    v_mov_b32 v5, 0
    v_mov_b32 v6, 0
    v_mov_b32 v7, 0
    global_load_ushort v112, v2, s[66:67] offset:0
    global_load_short_d16_hi v4, v3, s[66:67] offset:0
    global_load_ushort v113, v2, s[66:67] offset:256
    global_load_short_d16_hi v5, v3, s[66:67] offset:256
    global_load_ushort v114, v2, s[66:67] offset:512
    global_load_short_d16_hi v6, v3, s[66:67] offset:512
    global_load_ushort v115, v2, s[66:67] offset:768
    global_load_short_d16_hi v7, v3, s[66:67] offset:768
    s_add_u32 s22, s22, 1
    s_waitcnt vmcnt(0)
    v_or_b32 v112, v112, v4
    v_or_b32 v113, v113, v5
    v_or_b32 v114, v114, v6
    v_or_b32 v115, v115, v7
    s_mul_i32 s24, s22, 3277
    s_lshr_b32 s24, s24, 16
    s_mul_i32 s68, s24, 20
    s_sub_u32 s68, s22, s68
    s_cmp_lt_u32 s68, 8
    s_cselect_b64 s[66:67], s[84:85], s[86:87]
    s_cselect_b32 s25, 0, 8
    s_sub_u32 s68, s68, s25
    s_and_b32 s25, s68, 1
    s_lshr_b32 s68, s68, 1
    s_lshl_b32 s68, s68, 14
    s_lshl_b32 s25, s25, 12
    s_add_u32 s68, s68, s25
    s_lshl_b32 s24, s24, 5
    s_add_u32 s68, s68, s24
    v_lshrrev_b32 v2, 4, v176
    v_lshlrev_b32 v2, 10, v2
    v_and_b32 v3, 15, v176
    v_lshl_add_u32 v2, v3, 1, v2
    v_add_u32 v2, s68, v2
    v_add_u32 v3, 8192, v2
    v_mov_b32 v4, 0
    v_mov_b32 v5, 0
    v_mov_b32 v6, 0
    v_mov_b32 v7, 0
    global_load_ushort v116, v2, s[66:67] offset:0
    global_load_short_d16_hi v4, v3, s[66:67] offset:0
    global_load_ushort v117, v2, s[66:67] offset:256
    global_load_short_d16_hi v5, v3, s[66:67] offset:256
    global_load_ushort v118, v2, s[66:67] offset:512
    global_load_short_d16_hi v6, v3, s[66:67] offset:512
    global_load_ushort v119, v2, s[66:67] offset:768
    global_load_short_d16_hi v7, v3, s[66:67] offset:768
    s_add_u32 s22, s22, 1
    s_waitcnt vmcnt(0)
    v_or_b32 v116, v116, v4
    v_or_b32 v117, v117, v5
    v_or_b32 v118, v118, v6
    v_or_b32 v119, v119, v7
    s_mul_i32 s24, s22, 3277
    s_lshr_b32 s24, s24, 16
    s_mul_i32 s68, s24, 20
    s_sub_u32 s68, s22, s68
    s_cmp_lt_u32 s68, 8
    s_cselect_b64 s[66:67], s[84:85], s[86:87]
    s_cselect_b32 s25, 0, 8
    s_sub_u32 s68, s68, s25
    s_and_b32 s25, s68, 1
    s_lshr_b32 s68, s68, 1
    s_lshl_b32 s68, s68, 14
    s_lshl_b32 s25, s25, 12
    s_add_u32 s68, s68, s25
    s_lshl_b32 s24, s24, 5
    s_add_u32 s68, s68, s24
    v_lshrrev_b32 v2, 4, v176
    v_lshlrev_b32 v2, 10, v2
    v_and_b32 v3, 15, v176
    v_lshl_add_u32 v2, v3, 1, v2
    v_add_u32 v2, s68, v2
    v_add_u32 v3, 8192, v2
    v_mov_b32 v4, 0
    v_mov_b32 v5, 0
    v_mov_b32 v6, 0
    v_mov_b32 v7, 0
    global_load_ushort v120, v2, s[66:67] offset:0
    global_load_short_d16_hi v4, v3, s[66:67] offset:0
    global_load_ushort v121, v2, s[66:67] offset:256
    global_load_short_d16_hi v5, v3, s[66:67] offset:256
    global_load_ushort v122, v2, s[66:67] offset:512
    global_load_short_d16_hi v6, v3, s[66:67] offset:512
    global_load_ushort v123, v2, s[66:67] offset:768
    global_load_short_d16_hi v7, v3, s[66:67] offset:768
    s_add_u32 s22, s22, 1
    s_waitcnt vmcnt(0)
    v_or_b32 v120, v120, v4
    v_or_b32 v121, v121, v5
    v_or_b32 v122, v122, v6
    v_or_b32 v123, v123, v7
    s_mul_i32 s24, s22, 3277
    s_lshr_b32 s24, s24, 16
    s_mul_i32 s68, s24, 20
    s_sub_u32 s68, s22, s68
    s_cmp_lt_u32 s68, 8
    s_cselect_b64 s[66:67], s[84:85], s[86:87]
    s_cselect_b32 s25, 0, 8
    s_sub_u32 s68, s68, s25
    s_and_b32 s25, s68, 1
    s_lshr_b32 s68, s68, 1
    s_lshl_b32 s68, s68, 14
    s_lshl_b32 s25, s25, 12
    s_add_u32 s68, s68, s25
    s_lshl_b32 s24, s24, 5
    s_add_u32 s68, s68, s24
    v_lshrrev_b32 v2, 4, v176
    v_lshlrev_b32 v2, 10, v2
    v_and_b32 v3, 15, v176
    v_lshl_add_u32 v2, v3, 1, v2
    v_add_u32 v2, s68, v2
    v_add_u32 v3, 8192, v2
    v_mov_b32 v4, 0
    v_mov_b32 v5, 0
    v_mov_b32 v6, 0
    v_mov_b32 v7, 0
    global_load_ushort v124, v2, s[66:67] offset:0
    global_load_short_d16_hi v4, v3, s[66:67] offset:0
    global_load_ushort v125, v2, s[66:67] offset:256
    global_load_short_d16_hi v5, v3, s[66:67] offset:256
    global_load_ushort v126, v2, s[66:67] offset:512
    global_load_short_d16_hi v6, v3, s[66:67] offset:512
    global_load_ushort v127, v2, s[66:67] offset:768
    global_load_short_d16_hi v7, v3, s[66:67] offset:768
    s_add_u32 s22, s22, 1
    s_waitcnt vmcnt(0)
    v_or_b32 v124, v124, v4
    v_or_b32 v125, v125, v5
    v_or_b32 v126, v126, v6
    v_or_b32 v127, v127, v7
    s_mul_i32 s24, s22, 3277
    s_lshr_b32 s24, s24, 16
    s_mul_i32 s68, s24, 20
    s_sub_u32 s68, s22, s68
    s_cmp_lt_u32 s68, 8
    s_cselect_b64 s[66:67], s[84:85], s[86:87]
    s_cselect_b32 s25, 0, 8
    s_sub_u32 s68, s68, s25
    s_and_b32 s25, s68, 1
    s_lshr_b32 s68, s68, 1
    s_lshl_b32 s68, s68, 14
    s_lshl_b32 s25, s25, 12
    s_add_u32 s68, s68, s25
    s_lshl_b32 s24, s24, 5
    s_add_u32 s68, s68, s24
    v_lshrrev_b32 v2, 4, v176
    v_lshlrev_b32 v2, 10, v2
    v_and_b32 v3, 15, v176
    v_lshl_add_u32 v2, v3, 1, v2
    v_add_u32 v2, s68, v2
    v_add_u32 v3, 8192, v2
    v_mov_b32 v4, 0
    v_mov_b32 v5, 0
    v_mov_b32 v6, 0
    v_mov_b32 v7, 0
    global_load_ushort v128, v2, s[66:67] offset:0
    global_load_short_d16_hi v4, v3, s[66:67] offset:0
    global_load_ushort v129, v2, s[66:67] offset:256
    global_load_short_d16_hi v5, v3, s[66:67] offset:256
    global_load_ushort v130, v2, s[66:67] offset:512
    global_load_short_d16_hi v6, v3, s[66:67] offset:512
    global_load_ushort v131, v2, s[66:67] offset:768
    global_load_short_d16_hi v7, v3, s[66:67] offset:768
    s_add_u32 s22, s22, 1
    s_waitcnt vmcnt(0)
    v_or_b32 v128, v128, v4
    v_or_b32 v129, v129, v5
    v_or_b32 v130, v130, v6
    v_or_b32 v131, v131, v7
    s_mul_i32 s24, s22, 3277
    s_lshr_b32 s24, s24, 16
    s_mul_i32 s68, s24, 20
    s_sub_u32 s68, s22, s68
    s_cmp_lt_u32 s68, 8
    s_cselect_b64 s[66:67], s[84:85], s[86:87]
    s_cselect_b32 s25, 0, 8
    s_sub_u32 s68, s68, s25
    s_and_b32 s25, s68, 1
    s_lshr_b32 s68, s68, 1
    s_lshl_b32 s68, s68, 14
    s_lshl_b32 s25, s25, 12
    s_add_u32 s68, s68, s25
    s_lshl_b32 s24, s24, 5
    s_add_u32 s68, s68, s24
    v_lshrrev_b32 v2, 4, v176
    v_lshlrev_b32 v2, 10, v2
    v_and_b32 v3, 15, v176
    v_lshl_add_u32 v2, v3, 1, v2
    v_add_u32 v2, s68, v2
    v_add_u32 v3, 8192, v2
    v_mov_b32 v4, 0
    v_mov_b32 v5, 0
    v_mov_b32 v6, 0
    v_mov_b32 v7, 0
    global_load_ushort v132, v2, s[66:67] offset:0
    global_load_short_d16_hi v4, v3, s[66:67] offset:0
    global_load_ushort v133, v2, s[66:67] offset:256
    global_load_short_d16_hi v5, v3, s[66:67] offset:256
    global_load_ushort v134, v2, s[66:67] offset:512
    global_load_short_d16_hi v6, v3, s[66:67] offset:512
    global_load_ushort v135, v2, s[66:67] offset:768
    global_load_short_d16_hi v7, v3, s[66:67] offset:768
    s_add_u32 s22, s22, 1
    s_waitcnt vmcnt(0)
    v_or_b32 v132, v132, v4
    v_or_b32 v133, v133, v5
    v_or_b32 v134, v134, v6
    v_or_b32 v135, v135, v7
    s_mul_i32 s24, s22, 3277
    s_lshr_b32 s24, s24, 16
    s_mul_i32 s68, s24, 20
    s_sub_u32 s68, s22, s68
    s_cmp_lt_u32 s68, 8
    s_cselect_b64 s[66:67], s[84:85], s[86:87]
    s_cselect_b32 s25, 0, 8
    s_sub_u32 s68, s68, s25
    s_and_b32 s25, s68, 1
    s_lshr_b32 s68, s68, 1
    s_lshl_b32 s68, s68, 14
    s_lshl_b32 s25, s25, 12
    s_add_u32 s68, s68, s25
    s_lshl_b32 s24, s24, 5
    s_add_u32 s68, s68, s24
    v_lshrrev_b32 v2, 4, v176
    v_lshlrev_b32 v2, 10, v2
    v_and_b32 v3, 15, v176
    v_lshl_add_u32 v2, v3, 1, v2
    v_add_u32 v2, s68, v2
    v_add_u32 v3, 8192, v2
    v_mov_b32 v4, 0
    v_mov_b32 v5, 0
    v_mov_b32 v6, 0
    v_mov_b32 v7, 0
    global_load_ushort v136, v2, s[66:67] offset:0
    global_load_short_d16_hi v4, v3, s[66:67] offset:0
    global_load_ushort v137, v2, s[66:67] offset:256
    global_load_short_d16_hi v5, v3, s[66:67] offset:256
    global_load_ushort v138, v2, s[66:67] offset:512
    global_load_short_d16_hi v6, v3, s[66:67] offset:512
    global_load_ushort v139, v2, s[66:67] offset:768
    global_load_short_d16_hi v7, v3, s[66:67] offset:768
    s_add_u32 s22, s22, 1
    s_waitcnt vmcnt(0)
    v_or_b32 v136, v136, v4
    v_or_b32 v137, v137, v5
    v_or_b32 v138, v138, v6
    v_or_b32 v139, v139, v7
    s_mul_i32 s24, s22, 3277
    s_lshr_b32 s24, s24, 16
    s_mul_i32 s68, s24, 20
    s_sub_u32 s68, s22, s68
    s_cmp_lt_u32 s68, 8
    s_cselect_b64 s[66:67], s[84:85], s[86:87]
    s_cselect_b32 s25, 0, 8
    s_sub_u32 s68, s68, s25
    s_and_b32 s25, s68, 1
    s_lshr_b32 s68, s68, 1
    s_lshl_b32 s68, s68, 14
    s_lshl_b32 s25, s25, 12
    s_add_u32 s68, s68, s25
    s_lshl_b32 s24, s24, 5
    s_add_u32 s68, s68, s24
    v_lshrrev_b32 v2, 4, v176
    v_lshlrev_b32 v2, 10, v2
    v_and_b32 v3, 15, v176
    v_lshl_add_u32 v2, v3, 1, v2
    v_add_u32 v2, s68, v2
    v_add_u32 v3, 8192, v2
    v_mov_b32 v4, 0
    v_mov_b32 v5, 0
    v_mov_b32 v6, 0
    v_mov_b32 v7, 0
    global_load_ushort v140, v2, s[66:67] offset:0
    global_load_short_d16_hi v4, v3, s[66:67] offset:0
    global_load_ushort v141, v2, s[66:67] offset:256
    global_load_short_d16_hi v5, v3, s[66:67] offset:256
    global_load_ushort v142, v2, s[66:67] offset:512
    global_load_short_d16_hi v6, v3, s[66:67] offset:512
    global_load_ushort v143, v2, s[66:67] offset:768
    global_load_short_d16_hi v7, v3, s[66:67] offset:768
    s_add_u32 s22, s22, 1
    s_waitcnt vmcnt(0)
    v_or_b32 v140, v140, v4
    v_or_b32 v141, v141, v5
    v_or_b32 v142, v142, v6
    v_or_b32 v143, v143, v7
    s_mul_i32 s24, s22, 3277
    s_lshr_b32 s24, s24, 16
    s_mul_i32 s68, s24, 20
    s_sub_u32 s68, s22, s68
    s_cmp_lt_u32 s68, 8
    s_cselect_b64 s[66:67], s[84:85], s[86:87]
    s_cselect_b32 s25, 0, 8
    s_sub_u32 s68, s68, s25
    s_and_b32 s25, s68, 1
    s_lshr_b32 s68, s68, 1
    s_lshl_b32 s68, s68, 14
    s_lshl_b32 s25, s25, 12
    s_add_u32 s68, s68, s25
    s_lshl_b32 s24, s24, 5
    s_add_u32 s68, s68, s24
    v_lshrrev_b32 v2, 4, v176
    v_lshlrev_b32 v2, 10, v2
    v_and_b32 v3, 15, v176
    v_lshl_add_u32 v2, v3, 1, v2
    v_add_u32 v2, s68, v2
    v_add_u32 v3, 8192, v2
    v_mov_b32 v4, 0
    v_mov_b32 v5, 0
    v_mov_b32 v6, 0
    v_mov_b32 v7, 0
    global_load_ushort v144, v2, s[66:67] offset:0
    global_load_short_d16_hi v4, v3, s[66:67] offset:0
    global_load_ushort v145, v2, s[66:67] offset:256
    global_load_short_d16_hi v5, v3, s[66:67] offset:256
    global_load_ushort v146, v2, s[66:67] offset:512
    global_load_short_d16_hi v6, v3, s[66:67] offset:512
    global_load_ushort v147, v2, s[66:67] offset:768
    global_load_short_d16_hi v7, v3, s[66:67] offset:768
    s_add_u32 s22, s22, 1
    s_waitcnt vmcnt(0)
    v_or_b32 v144, v144, v4
    v_or_b32 v145, v145, v5
    v_or_b32 v146, v146, v6
    v_or_b32 v147, v147, v7
    s_mul_i32 s24, s22, 3277
    s_lshr_b32 s24, s24, 16
    s_mul_i32 s68, s24, 20
    s_sub_u32 s68, s22, s68
    s_cmp_lt_u32 s68, 8
    s_cselect_b64 s[66:67], s[84:85], s[86:87]
    s_cselect_b32 s25, 0, 8
    s_sub_u32 s68, s68, s25
    s_and_b32 s25, s68, 1
    s_lshr_b32 s68, s68, 1
    s_lshl_b32 s68, s68, 14
    s_lshl_b32 s25, s25, 12
    s_add_u32 s68, s68, s25
    s_lshl_b32 s24, s24, 5
    s_add_u32 s68, s68, s24
    v_lshrrev_b32 v2, 4, v176
    v_lshlrev_b32 v2, 10, v2
    v_and_b32 v3, 15, v176
    v_lshl_add_u32 v2, v3, 1, v2
    v_add_u32 v2, s68, v2
    v_add_u32 v3, 8192, v2
    v_mov_b32 v4, 0
    v_mov_b32 v5, 0
    v_mov_b32 v6, 0
    v_mov_b32 v7, 0
    global_load_ushort v148, v2, s[66:67] offset:0
    global_load_short_d16_hi v4, v3, s[66:67] offset:0
    global_load_ushort v149, v2, s[66:67] offset:256
    global_load_short_d16_hi v5, v3, s[66:67] offset:256
    global_load_ushort v150, v2, s[66:67] offset:512
    global_load_short_d16_hi v6, v3, s[66:67] offset:512
    global_load_ushort v151, v2, s[66:67] offset:768
    global_load_short_d16_hi v7, v3, s[66:67] offset:768
    s_add_u32 s22, s22, 1
    s_waitcnt vmcnt(0)
    v_or_b32 v148, v148, v4
    v_or_b32 v149, v149, v5
    v_or_b32 v150, v150, v6
    v_or_b32 v151, v151, v7
    s_mul_i32 s24, s22, 3277
    s_lshr_b32 s24, s24, 16
    s_mul_i32 s68, s24, 20
    s_sub_u32 s68, s22, s68
    s_cmp_lt_u32 s68, 8
    s_cselect_b64 s[66:67], s[84:85], s[86:87]
    s_cselect_b32 s25, 0, 8
    s_sub_u32 s68, s68, s25
    s_and_b32 s25, s68, 1
    s_lshr_b32 s68, s68, 1
    s_lshl_b32 s68, s68, 14
    s_lshl_b32 s25, s25, 12
    s_add_u32 s68, s68, s25
    s_lshl_b32 s24, s24, 5
    s_add_u32 s68, s68, s24
    v_lshrrev_b32 v2, 4, v176
    v_lshlrev_b32 v2, 10, v2
    v_and_b32 v3, 15, v176
    v_lshl_add_u32 v2, v3, 1, v2
    v_add_u32 v2, s68, v2
    v_add_u32 v3, 8192, v2
    v_mov_b32 v4, 0
    v_mov_b32 v5, 0
    v_mov_b32 v6, 0
    v_mov_b32 v7, 0
    global_load_ushort v152, v2, s[66:67] offset:0
    global_load_short_d16_hi v4, v3, s[66:67] offset:0
    global_load_ushort v153, v2, s[66:67] offset:256
    global_load_short_d16_hi v5, v3, s[66:67] offset:256
    global_load_ushort v154, v2, s[66:67] offset:512
    global_load_short_d16_hi v6, v3, s[66:67] offset:512
    global_load_ushort v155, v2, s[66:67] offset:768
    global_load_short_d16_hi v7, v3, s[66:67] offset:768
    s_add_u32 s22, s22, 1
    s_waitcnt vmcnt(0)
    v_or_b32 v152, v152, v4
    v_or_b32 v153, v153, v5
    v_or_b32 v154, v154, v6
    v_or_b32 v155, v155, v7
    s_mul_i32 s24, s22, 3277
    s_lshr_b32 s24, s24, 16
    s_mul_i32 s68, s24, 20
    s_sub_u32 s68, s22, s68
    s_cmp_lt_u32 s68, 8
    s_cselect_b64 s[66:67], s[84:85], s[86:87]
    s_cselect_b32 s25, 0, 8
    s_sub_u32 s68, s68, s25
    s_and_b32 s25, s68, 1
    s_lshr_b32 s68, s68, 1
    s_lshl_b32 s68, s68, 14
    s_lshl_b32 s25, s25, 12
    s_add_u32 s68, s68, s25
    s_lshl_b32 s24, s24, 5
    s_add_u32 s68, s68, s24
    v_lshrrev_b32 v2, 4, v176
    v_lshlrev_b32 v2, 10, v2
    v_and_b32 v3, 15, v176
    v_lshl_add_u32 v2, v3, 1, v2
    v_add_u32 v2, s68, v2
    v_add_u32 v3, 8192, v2
    v_mov_b32 v4, 0
    v_mov_b32 v5, 0
    v_mov_b32 v6, 0
    v_mov_b32 v7, 0
    global_load_ushort v156, v2, s[66:67] offset:0
    global_load_short_d16_hi v4, v3, s[66:67] offset:0
    global_load_ushort v157, v2, s[66:67] offset:256
    global_load_short_d16_hi v5, v3, s[66:67] offset:256
    global_load_ushort v158, v2, s[66:67] offset:512
    global_load_short_d16_hi v6, v3, s[66:67] offset:512
    global_load_ushort v159, v2, s[66:67] offset:768
    global_load_short_d16_hi v7, v3, s[66:67] offset:768
    s_add_u32 s22, s22, 1
    s_waitcnt vmcnt(0)
    v_or_b32 v156, v156, v4
    v_or_b32 v157, v157, v5
    v_or_b32 v158, v158, v6
    v_or_b32 v159, v159, v7
    s_mul_i32 s24, s22, 3277
    s_lshr_b32 s24, s24, 16
    s_mul_i32 s68, s24, 20
    s_sub_u32 s68, s22, s68
    s_cmp_lt_u32 s68, 8
    s_cselect_b64 s[66:67], s[84:85], s[86:87]
    s_cselect_b32 s25, 0, 8
    s_sub_u32 s68, s68, s25
    s_and_b32 s25, s68, 1
    s_lshr_b32 s68, s68, 1
    s_lshl_b32 s68, s68, 14
    s_lshl_b32 s25, s25, 12
    s_add_u32 s68, s68, s25
    s_lshl_b32 s24, s24, 5
    s_add_u32 s68, s68, s24
    v_lshrrev_b32 v2, 4, v176
    v_lshlrev_b32 v2, 10, v2
    v_and_b32 v3, 15, v176
    v_lshl_add_u32 v2, v3, 1, v2
    v_add_u32 v2, s68, v2
    v_add_u32 v3, 8192, v2
    v_mov_b32 v4, 0
    v_mov_b32 v5, 0
    v_mov_b32 v6, 0
    v_mov_b32 v7, 0
    global_load_ushort v160, v2, s[66:67] offset:0
    global_load_short_d16_hi v4, v3, s[66:67] offset:0
    global_load_ushort v161, v2, s[66:67] offset:256
    global_load_short_d16_hi v5, v3, s[66:67] offset:256
    global_load_ushort v162, v2, s[66:67] offset:512
    global_load_short_d16_hi v6, v3, s[66:67] offset:512
    global_load_ushort v163, v2, s[66:67] offset:768
    global_load_short_d16_hi v7, v3, s[66:67] offset:768
    s_add_u32 s22, s22, 1
    s_waitcnt vmcnt(0)
    v_or_b32 v160, v160, v4
    v_or_b32 v161, v161, v5
    v_or_b32 v162, v162, v6
    v_or_b32 v163, v163, v7
    s_mul_i32 s24, s22, 3277
    s_lshr_b32 s24, s24, 16
    s_mul_i32 s68, s24, 20
    s_sub_u32 s68, s22, s68
    s_cmp_lt_u32 s68, 8
    s_cselect_b64 s[66:67], s[84:85], s[86:87]
    s_cselect_b32 s25, 0, 8
    s_sub_u32 s68, s68, s25
    s_and_b32 s25, s68, 1
    s_lshr_b32 s68, s68, 1
    s_lshl_b32 s68, s68, 14
    s_lshl_b32 s25, s25, 12
    s_add_u32 s68, s68, s25
    s_lshl_b32 s24, s24, 5
    s_add_u32 s68, s68, s24
    v_lshrrev_b32 v2, 4, v176
    v_lshlrev_b32 v2, 10, v2
    v_and_b32 v3, 15, v176
    v_lshl_add_u32 v2, v3, 1, v2
    v_add_u32 v2, s68, v2
    v_add_u32 v3, 8192, v2
    v_mov_b32 v4, 0
    v_mov_b32 v5, 0
    v_mov_b32 v6, 0
    v_mov_b32 v7, 0
    global_load_ushort v164, v2, s[66:67] offset:0
    global_load_short_d16_hi v4, v3, s[66:67] offset:0
    global_load_ushort v165, v2, s[66:67] offset:256
    global_load_short_d16_hi v5, v3, s[66:67] offset:256
    global_load_ushort v166, v2, s[66:67] offset:512
    global_load_short_d16_hi v6, v3, s[66:67] offset:512
    global_load_ushort v167, v2, s[66:67] offset:768
    global_load_short_d16_hi v7, v3, s[66:67] offset:768
    s_add_u32 s22, s22, 1
    s_waitcnt vmcnt(0)
    v_or_b32 v164, v164, v4
    v_or_b32 v165, v165, v5
    v_or_b32 v166, v166, v6
    v_or_b32 v167, v167, v7
    s_mul_i32 s24, s22, 3277
    s_lshr_b32 s24, s24, 16
    s_mul_i32 s68, s24, 20
    s_sub_u32 s68, s22, s68
    s_cmp_lt_u32 s68, 8
    s_cselect_b64 s[66:67], s[84:85], s[86:87]
    s_cselect_b32 s25, 0, 8
    s_sub_u32 s68, s68, s25
    s_and_b32 s25, s68, 1
    s_lshr_b32 s68, s68, 1
    s_lshl_b32 s68, s68, 14
    s_lshl_b32 s25, s25, 12
    s_add_u32 s68, s68, s25
    s_lshl_b32 s24, s24, 5
    s_add_u32 s68, s68, s24
    v_lshrrev_b32 v2, 4, v176
    v_lshlrev_b32 v2, 10, v2
    v_and_b32 v3, 15, v176
    v_lshl_add_u32 v2, v3, 1, v2
    v_add_u32 v2, s68, v2
    v_add_u32 v3, 8192, v2
    v_mov_b32 v4, 0
    v_mov_b32 v5, 0
    v_mov_b32 v6, 0
    v_mov_b32 v7, 0
    global_load_ushort v168, v2, s[66:67] offset:0
    global_load_short_d16_hi v4, v3, s[66:67] offset:0
    global_load_ushort v169, v2, s[66:67] offset:256
    global_load_short_d16_hi v5, v3, s[66:67] offset:256
    global_load_ushort v170, v2, s[66:67] offset:512
    global_load_short_d16_hi v6, v3, s[66:67] offset:512
    global_load_ushort v171, v2, s[66:67] offset:768
    global_load_short_d16_hi v7, v3, s[66:67] offset:768
    s_add_u32 s22, s22, 1
    s_waitcnt vmcnt(0)
    v_or_b32 v168, v168, v4
    v_or_b32 v169, v169, v5
    v_or_b32 v170, v170, v6
    v_or_b32 v171, v171, v7
    s_mul_i32 s24, s22, 3277
    s_lshr_b32 s24, s24, 16
    s_mul_i32 s68, s24, 20
    s_sub_u32 s68, s22, s68
    s_cmp_lt_u32 s68, 8
    s_cselect_b64 s[66:67], s[84:85], s[86:87]
    s_cselect_b32 s25, 0, 8
    s_sub_u32 s68, s68, s25
    s_and_b32 s25, s68, 1
    s_lshr_b32 s68, s68, 1
    s_lshl_b32 s68, s68, 14
    s_lshl_b32 s25, s25, 12
    s_add_u32 s68, s68, s25
    s_lshl_b32 s24, s24, 5
    s_add_u32 s68, s68, s24
    v_lshrrev_b32 v2, 4, v176
    v_lshlrev_b32 v2, 10, v2
    v_and_b32 v3, 15, v176
    v_lshl_add_u32 v2, v3, 1, v2
    v_add_u32 v2, s68, v2
    v_add_u32 v3, 8192, v2
    v_mov_b32 v4, 0
    v_mov_b32 v5, 0
    v_mov_b32 v6, 0
    v_mov_b32 v7, 0
    global_load_ushort v172, v2, s[66:67] offset:0
    global_load_short_d16_hi v4, v3, s[66:67] offset:0
    global_load_ushort v173, v2, s[66:67] offset:256
    global_load_short_d16_hi v5, v3, s[66:67] offset:256
    global_load_ushort v174, v2, s[66:67] offset:512
    global_load_short_d16_hi v6, v3, s[66:67] offset:512
    global_load_ushort v175, v2, s[66:67] offset:768
    global_load_short_d16_hi v7, v3, s[66:67] offset:768
    s_add_u32 s22, s22, 1
    s_waitcnt vmcnt(0)
    v_or_b32 v172, v172, v4
    v_or_b32 v173, v173, v5
    v_or_b32 v174, v174, v6
    v_or_b32 v175, v175, v7
    s_load_dwordx2 s[72:73], s[0:1], 72
    s_branch GEMM
.section .rodata,"a"
.p2align 6
.amdhsa_kernel standalone__tensor_product_equiv_equiformer__graph_kernel
  .amdhsa_next_free_vgpr 256
  .amdhsa_next_free_sgpr 90
  .amdhsa_accum_offset 256
  .amdhsa_group_segment_fixed_size 0
  .amdhsa_kernarg_size 96
  .amdhsa_user_sgpr_count 2
  .amdhsa_user_sgpr_kernarg_segment_ptr 1
  .amdhsa_system_sgpr_workgroup_id_x 1
.end_amdhsa_kernel
```

```asm
; @launch grid=(250,1,1) block=(512,1,1) lds=163840
.amdgcn_target "amdgcn-amd-amdhsa--gfx950"
.text
.globl standalone__tensor_product_equiv_equiformer__graph_kernel
.p2align 8
.type standalone__tensor_product_equiv_equiformer__graph_kernel,@function
standalone__tensor_product_equiv_equiformer__graph_kernel:
    s_cmp_ge_u32 s2, 250
    s_cbranch_scc1 K2_end
    s_load_dwordx16 s[72:87], s[0:1], 0
    s_load_dwordx2 s[70:71], s[0:1], 88
    v_lshrrev_b32 v2, 6, v0
    v_and_b32 v1, 63, v0
    v_readfirstlane_b32 s20, v2
    s_getpc_b64 s[66:67]
    v_lshlrev_b32 v95, 7, v1
    s_cmp_eq_u32 s20, 6
    s_cbranch_scc0 F_nopf0
    global_load_dword v95, v95, s[66:67]
F_nopf0:
    s_mul_i32 s66, s2, 5120
    s_mul_i32 s67, s2, 7680
    v_lshl_add_u32 v3, v0, 4, s66
    v_mul_u32_u24 v4, 24, v0
    v_add_u32 v4, s67, v4
    v_lshlrev_b32 v5, 2, v0
    v_mov_b32 v89, 0
    v_add_u32 v6, 98304, v5
    ds_write_b32 v6, v89
    s_cmp_ge_u32 s20, 5
    s_waitcnt lgkmcnt(0)
    s_cbranch_scc1 F_noload
    global_load_dwordx4 v[8:11], v3, s[80:81] nt
    global_load_dwordx4 v[12:15], v3, s[78:79] nt
    global_load_dwordx4 v[16:19], v4, s[74:75] nt
    global_load_dwordx2 v[20:21], v4, s[74:75] offset:16 nt
F_noload:
    s_load_dword s88, s[70:71], 0
    s_barrier
    v_lshlrev_b32 v248, 2, v1
    v_add_u32 v88, 162816, v248
    ds_write_b32 v88, v89
    ds_write_b32 v88, v89 offset:256
    v_lshlrev_b32 v86, 4, v1
    s_lshl_b32 s21, s20, 13
    v_lshrrev_b32 v6, 5, v1
    v_mul_u32_u24 v6, 5120, v6
    v_and_b32 v7, 31, v1
    v_lshl_add_u32 v6, v7, 1, v6
    s_lshr_b32 s66, s20, 2
    s_lshl_b32 s66, s66, 7
    s_and_b32 s67, s20, 3
    s_mul_i32 s67, s67, 5
    s_add_u32 s68, s67, 0
    s_lshr_b32 s24, s68, 2
    s_lshl_b32 s24, s24, 8
    s_bfe_u32 s69, s68, 0x10001
    s_lshl_b32 s69, s69, 6
    s_add_u32 s24, s24, s69
    s_and_b32 s69, s68, 1
    s_mul_i32 s69, s69, 10240
    s_add_u32 s24, s24, s69
    s_add_u32 s24, s24, s66
    s_add_u32 s68, s67, 1
    s_lshr_b32 s25, s68, 2
    s_lshl_b32 s25, s25, 8
    s_bfe_u32 s69, s68, 0x10001
    s_lshl_b32 s69, s69, 6
    s_add_u32 s25, s25, s69
    s_and_b32 s69, s68, 1
    s_mul_i32 s69, s69, 10240
    s_add_u32 s25, s25, s69
    s_add_u32 s25, s25, s66
    s_add_u32 s68, s67, 2
    s_lshr_b32 s26, s68, 2
    s_lshl_b32 s26, s26, 8
    s_bfe_u32 s69, s68, 0x10001
    s_lshl_b32 s69, s69, 6
    s_add_u32 s26, s26, s69
    s_and_b32 s69, s68, 1
    s_mul_i32 s69, s69, 10240
    s_add_u32 s26, s26, s69
    s_add_u32 s26, s26, s66
    s_add_u32 s68, s67, 3
    s_lshr_b32 s27, s68, 2
    s_lshl_b32 s27, s27, 8
    s_bfe_u32 s69, s68, 0x10001
    s_lshl_b32 s69, s69, 6
    s_add_u32 s27, s27, s69
    s_and_b32 s69, s68, 1
    s_mul_i32 s69, s69, 10240
    s_add_u32 s27, s27, s69
    s_add_u32 s27, s27, s66
    s_add_u32 s68, s67, 4
    s_lshr_b32 s28, s68, 2
    s_lshl_b32 s28, s28, 8
    s_bfe_u32 s69, s68, 0x10001
    s_lshl_b32 s69, s69, 6
    s_add_u32 s28, s28, s69
    s_and_b32 s69, s68, 1
    s_mul_i32 s69, s69, 10240
    s_add_u32 s28, s28, s69
    s_add_u32 s28, s28, s66
    v_mov_b32 v96, 0
    v_mov_b32 v97, 0
    v_mov_b32 v98, 0
    v_mov_b32 v99, 0
    v_mov_b32 v100, 0
    v_mov_b32 v101, 0
    v_mov_b32 v102, 0
    v_mov_b32 v103, 0
    v_mov_b32 v104, 0
    v_mov_b32 v105, 0
    v_mov_b32 v106, 0
    v_mov_b32 v107, 0
    v_mov_b32 v108, 0
    v_mov_b32 v109, 0
    v_mov_b32 v110, 0
    v_mov_b32 v111, 0
    v_mov_b32 v112, 0
    v_mov_b32 v113, 0
    v_mov_b32 v114, 0
    v_mov_b32 v115, 0
    v_mov_b32 v180, 0
    v_mov_b32 v181, 0
    v_mov_b32 v182, 0
    v_mov_b32 v183, 0
    s_mov_b32 s16, s70
    s_and_b32 s17, s71, 0xffff
    s_mov_b32 s18, 24165888
    s_mov_b32 s19, 0x20000
    v_lshrrev_b32 v2, 3, v1
    v_lshl_add_u32 v2, s20, 5, v2
    v_and_b32 v91, 7, v1
    v_mul_u32_u24 v94, 384, v2
    v_lshl_add_u32 v94, v91, 4, v94
    v_lshlrev_b32 v93, 2, v2
    v_add_u32 v93, 98304, v93
    v_mul_u32_u24 v92, 32000, v2
    v_lshl_add_u32 v92, v91, 4, v92
    v_mul_u32_u24 v90, 40960, v2
    s_mov_b32 s32, s82
    s_and_b32 s33, s83, 0xffff
    s_mov_b32 s34, 20480
    s_mov_b32 s35, 0x20000
    s_cmp_ge_u32 s20, 5
    s_cbranch_scc1 F_helper
    s_mov_b32 s22, 52429
    s_mov_b32 s23, 0x05040100
    s_mov_b32 s66, 98304
    s_movk_i32 s67, -40
    v_mov_b32 v7, 1
    v_add_u32 v31, 1, v5
    v_add_u32 v32, 2, v5
    v_add_u32 v33, 3, v5
    s_waitcnt vmcnt(3)
    v_mul_u32_u24 v22, s22, v8
    v_mul_u32_u24 v23, s22, v9
    v_mul_u32_u24 v24, s22, v10
    v_mul_u32_u24 v25, s22, v11
    v_lshrrev_b32 v22, 21, v22
    v_lshrrev_b32 v23, 21, v23
    v_lshrrev_b32 v24, 21, v24
    v_lshrrev_b32 v25, 21, v25
    v_lshl_add_u32 v34, v22, 2, s66
    ds_add_rtn_u32 v26, v34, v7
    v_lshl_add_u32 v35, v23, 2, s66
    ds_add_rtn_u32 v27, v35, v7
    v_lshl_add_u32 v36, v24, 2, s66
    ds_add_rtn_u32 v28, v36, v7
    v_lshl_add_u32 v37, v25, 2, s66
    ds_add_rtn_u32 v29, v37, v7
    buffer_load_short_d16_hi v96, v6, s[32:35], s24 offen offset:0
    buffer_load_short_d16_hi v97, v6, s[32:35], s24 offen offset:1280
    buffer_load_short_d16_hi v98, v6, s[32:35], s24 offen offset:2560
    buffer_load_short_d16_hi v99, v6, s[32:35], s24 offen offset:3840
    buffer_load_short_d16_hi v100, v6, s[32:35], s25 offen offset:0
    buffer_load_short_d16_hi v101, v6, s[32:35], s25 offen offset:1280
    buffer_load_short_d16_hi v102, v6, s[32:35], s25 offen offset:2560
    buffer_load_short_d16_hi v103, v6, s[32:35], s25 offen offset:3840
    buffer_load_short_d16_hi v104, v6, s[32:35], s26 offen offset:0
    buffer_load_short_d16_hi v105, v6, s[32:35], s26 offen offset:1280
    buffer_load_short_d16_hi v106, v6, s[32:35], s26 offen offset:2560
    buffer_load_short_d16_hi v107, v6, s[32:35], s26 offen offset:3840
    buffer_load_short_d16_hi v108, v6, s[32:35], s27 offen offset:0
    buffer_load_short_d16_hi v109, v6, s[32:35], s27 offen offset:1280
    buffer_load_short_d16_hi v110, v6, s[32:35], s27 offen offset:2560
    buffer_load_short_d16_hi v111, v6, s[32:35], s27 offen offset:3840
    buffer_load_short_d16_hi v112, v6, s[32:35], s28 offen offset:0
    buffer_load_short_d16_hi v113, v6, s[32:35], s28 offen offset:1280
    buffer_load_short_d16_hi v114, v6, s[32:35], s28 offen offset:2560
    buffer_load_short_d16_hi v115, v6, s[32:35], s28 offen offset:3840
    v_mad_i32_i24 v2, v22, s67, v8
    v_mul_u32_u24 v22, 384, v22
    v_lshl_or_b32 v42, v2, 11, v5
    v_mad_i32_i24 v2, v23, s67, v9
    v_mul_u32_u24 v23, 384, v23
    v_lshl_or_b32 v46, v2, 11, v31
    v_mad_i32_i24 v2, v24, s67, v10
    v_mul_u32_u24 v24, 384, v24
    v_lshl_or_b32 v50, v2, 11, v32
    v_mad_i32_i24 v2, v25, s67, v11
    v_mul_u32_u24 v25, 384, v25
    v_lshl_or_b32 v54, v2, 11, v33
    s_waitcnt vmcnt(20)
    v_mov_b32 v40, v16
    v_perm_b32 v41, v12, v17, s23
    v_alignbit_b32 v44, v18, v17, 16
    v_alignbit_b32 v45, v13, v18, 16
    v_mov_b32 v48, v19
    v_perm_b32 v49, v14, v20, s23
    v_alignbit_b32 v52, v21, v20, 16
    v_alignbit_b32 v53, v15, v21, 16
    v_xor_b32 v41, 0x8000, v41
    v_xor_b32 v45, 0x8000, v45
    v_xor_b32 v49, 0x8000, v49
    v_xor_b32 v53, 0x8000, v53
    s_waitcnt lgkmcnt(0)
    v_min_u32 v26, 23, v26
    v_lshl_add_u32 v34, v26, 4, v22
    ds_write_b128 v34, v[40:43]
    v_min_u32 v27, 23, v27
    v_lshl_add_u32 v35, v27, 4, v23
    ds_write_b128 v35, v[44:47]
    v_min_u32 v28, 23, v28
    v_lshl_add_u32 v36, v28, 4, v24
    ds_write_b128 v36, v[48:51]
    v_min_u32 v29, 23, v29
    v_lshl_add_u32 v37, v29, 4, v25
    ds_write_b128 v37, v[52:55]
    s_branch F_staged
F_helper:
    buffer_load_short_d16_hi v96, v6, s[32:35], s24 offen offset:0
    buffer_load_short_d16_hi v97, v6, s[32:35], s24 offen offset:1280
    buffer_load_short_d16_hi v98, v6, s[32:35], s24 offen offset:2560
    buffer_load_short_d16_hi v99, v6, s[32:35], s24 offen offset:3840
    buffer_load_short_d16_hi v100, v6, s[32:35], s25 offen offset:0
    buffer_load_short_d16_hi v101, v6, s[32:35], s25 offen offset:1280
    buffer_load_short_d16_hi v102, v6, s[32:35], s25 offen offset:2560
    buffer_load_short_d16_hi v103, v6, s[32:35], s25 offen offset:3840
    buffer_load_short_d16_hi v104, v6, s[32:35], s26 offen offset:0
    buffer_load_short_d16_hi v105, v6, s[32:35], s26 offen offset:1280
    buffer_load_short_d16_hi v106, v6, s[32:35], s26 offen offset:2560
    buffer_load_short_d16_hi v107, v6, s[32:35], s26 offen offset:3840
    buffer_load_short_d16_hi v108, v6, s[32:35], s27 offen offset:0
    buffer_load_short_d16_hi v109, v6, s[32:35], s27 offen offset:1280
    buffer_load_short_d16_hi v110, v6, s[32:35], s27 offen offset:2560
    buffer_load_short_d16_hi v111, v6, s[32:35], s27 offen offset:3840
    buffer_load_short_d16_hi v112, v6, s[32:35], s28 offen offset:0
    buffer_load_short_d16_hi v113, v6, s[32:35], s28 offen offset:1280
    buffer_load_short_d16_hi v114, v6, s[32:35], s28 offen offset:2560
    buffer_load_short_d16_hi v115, v6, s[32:35], s28 offen offset:3840
    s_cmp_eq_u32 s20, 6
    s_cbranch_scc0 F_nopf
    s_getpc_b64 s[66:67]
F_pc:
    s_lshr_b32 s68, s2, 3
    s_mul_i32 s68, s68, ((K2_last-F_pc)/128/31+1)*128
    v_lshl_add_u32 v2, v1, 7, s68
    v_min_u32 v2, K2_last-F_pc-4, v2
    v_cmp_gt_u32 vcc, (K2_last-F_pc)/128/31+1, v1
    s_mov_b64 exec, vcc
    global_load_dword v95, v2, s[66:67]
    s_mov_b64 exec, -1
F_nopf:
    s_cmp_eq_u32 s20, 7
    s_cbranch_scc0 F_staged
    s_cmp_lt_u32 s2, 160
    s_cbranch_scc0 F_staged
    s_mul_i32 s22, s2, 3277
    s_lshr_b32 s22, s22, 16
    s_mul_i32 s68, s22, 20
    s_sub_u32 s68, s2, s68
    s_cmp_lt_u32 s68, 8
    s_cselect_b64 s[66:67], s[84:85], s[86:87]
    s_cselect_b32 s23, 0, 8
    s_sub_u32 s68, s68, s23
    s_and_b32 s23, s68, 1
    s_lshr_b32 s68, s68, 1
    s_lshl_b32 s68, s68, 14
    s_lshl_b32 s23, s23, 12
    s_add_u32 s68, s68, s23
    s_lshl_b32 s22, s22, 5
    s_add_u32 s68, s68, s22
    v_lshrrev_b32 v2, 4, v1
    v_lshlrev_b32 v2, 10, v2
    v_and_b32 v3, 15, v1
    v_lshl_add_u32 v2, v3, 1, v2
    v_add_u32 v2, s68, v2
    v_add_u32 v3, 8192, v2
    global_load_ushort v176, v2, s[66:67] offset:0
    global_load_short_d16_hi v180, v3, s[66:67] offset:0
    global_load_ushort v177, v2, s[66:67] offset:256
    global_load_short_d16_hi v181, v3, s[66:67] offset:256
    global_load_ushort v178, v2, s[66:67] offset:512
    global_load_short_d16_hi v182, v3, s[66:67] offset:512
    global_load_ushort v179, v2, s[66:67] offset:768
    global_load_short_d16_hi v183, v3, s[66:67] offset:768
F_staged:
    s_lshl_b32 s66, s2, 7
    s_add_u32 s66, s66, 164864
    s_cmp_eq_u32 s20, 7
    s_cselect_b32 s22, 0xffff, -1
    s_cselect_b32 s23, 0, -1
    s_waitcnt lgkmcnt(0)
    s_add_u32 s88, s88, 1
    s_barrier
    ds_read_b32 v40, v93 offset:0
    ds_read_b128 v[8:11], v94 offset:0
    ds_read_b128 v[12:15], v94 offset:128
    ds_read_b32 v41, v93 offset:32
    ds_read_b128 v[16:19], v94 offset:3072
    ds_read_b128 v[20:23], v94 offset:3200
    ds_read_b32 v42, v93 offset:64
    ds_read_b128 v[24:27], v94 offset:6144
    ds_read_b128 v[28:31], v94 offset:6272
    ds_read_b32 v43, v93 offset:96
    ds_read_b128 v[32:35], v94 offset:9216
    ds_read_b128 v[36:39], v94 offset:9344
    s_waitcnt vmcnt(0)
    s_waitcnt lgkmcnt(9)
    v_min_u32 v5, 31, v40
    v_bfe_u32 v6, v14, 11, 6
    v_and_b32 v10, 0x1ffff, v10
    v_lshl_or_b32 v6, v5, 6, v6
    v_mov_b32 v11, s88
    v_lshl_or_b32 v10, v6, 17, v10
    v_mov_b32 v15, s88
    buffer_store_dwordx4 v[8:11], v92, s[16:19], s66 offen sc1
    v_cmp_lt_u32 vcc, 8, v40
    s_add_u32 s67, s66, 8000000
    s_mov_b64 exec, vcc
    s_cbranch_execz F_w0
    buffer_store_dwordx4 v[12:15], v92, s[16:19], s67 offen sc1
    v_cmp_lt_u32 vcc, 16, v40
    s_add_u32 s67, s67, 8000000
    s_mov_b64 exec, vcc
    s_cbranch_execz F_w0
    ds_read_b128 v[44:47], v94 offset:256
    s_waitcnt lgkmcnt(0)
    v_mov_b32 v47, s88
    buffer_store_dwordx4 v[44:47], v92, s[16:19], s67 offen sc1
    s_nop 1
F_w0:
    s_mov_b64 exec, -1
    s_add_u32 s66, s66, 256000
    s_waitcnt lgkmcnt(6)
    v_min_u32 v5, 31, v41
    v_bfe_u32 v6, v22, 11, 6
    v_and_b32 v18, 0x1ffff, v18
    v_lshl_or_b32 v6, v5, 6, v6
    v_mov_b32 v19, s88
    v_lshl_or_b32 v18, v6, 17, v18
    v_mov_b32 v23, s88
    buffer_store_dwordx4 v[16:19], v92, s[16:19], s66 offen sc1
    v_cmp_lt_u32 vcc, 8, v41
    s_add_u32 s67, s66, 8000000
    s_mov_b64 exec, vcc
    s_cbranch_execz F_w1
    buffer_store_dwordx4 v[20:23], v92, s[16:19], s67 offen sc1
    v_cmp_lt_u32 vcc, 16, v41
    s_add_u32 s67, s67, 8000000
    s_mov_b64 exec, vcc
    s_cbranch_execz F_w1
    ds_read_b128 v[44:47], v94 offset:3328
    s_waitcnt lgkmcnt(0)
    v_mov_b32 v47, s88
    buffer_store_dwordx4 v[44:47], v92, s[16:19], s67 offen sc1
    s_nop 1
F_w1:
    s_mov_b64 exec, -1
    s_add_u32 s66, s66, 256000
    s_waitcnt lgkmcnt(3)
    v_min_u32 v5, 31, v42
    v_bfe_u32 v6, v30, 11, 6
    v_and_b32 v26, 0x1ffff, v26
    v_lshl_or_b32 v6, v5, 6, v6
    v_mov_b32 v27, s88
    v_lshl_or_b32 v26, v6, 17, v26
    v_mov_b32 v31, s88
    buffer_store_dwordx4 v[24:27], v92, s[16:19], s66 offen sc1
    v_cmp_lt_u32 vcc, 8, v42
    s_add_u32 s67, s66, 8000000
    s_mov_b64 exec, vcc
    s_cbranch_execz F_w2
    buffer_store_dwordx4 v[28:31], v92, s[16:19], s67 offen sc1
    v_cmp_lt_u32 vcc, 16, v42
    s_add_u32 s67, s67, 8000000
    s_mov_b64 exec, vcc
    s_cbranch_execz F_w2
    ds_read_b128 v[44:47], v94 offset:6400
    s_waitcnt lgkmcnt(0)
    v_mov_b32 v47, s88
    buffer_store_dwordx4 v[44:47], v92, s[16:19], s67 offen sc1
    s_nop 1
F_w2:
    s_mov_b64 exec, -1
    s_add_u32 s66, s66, 256000
    s_waitcnt lgkmcnt(0)
    v_min_u32 v5, 31, v43
    v_bfe_u32 v6, v38, 11, 6
    v_and_b32 v34, 0x1ffff, v34
    v_lshl_or_b32 v6, v5, 6, v6
    v_mov_b32 v35, s88
    v_lshl_or_b32 v34, v6, 17, v34
    v_mov_b32 v39, s88
    s_mov_b64 exec, s[22:23]
    buffer_store_dwordx4 v[32:35], v92, s[16:19], s66 offen sc1
    v_cmp_lt_u32 vcc, 8, v43
    s_add_u32 s67, s66, 8000000
    s_mov_b64 exec, vcc
    s_cbranch_execz F_w3
    buffer_store_dwordx4 v[36:39], v92, s[16:19], s67 offen sc1
    v_cmp_lt_u32 vcc, 16, v43
    s_add_u32 s67, s67, 8000000
    s_mov_b64 exec, vcc
    s_cbranch_execz F_w3
    ds_read_b128 v[44:47], v94 offset:9472
    s_waitcnt lgkmcnt(0)
    v_mov_b32 v47, s88
    buffer_store_dwordx4 v[44:47], v92, s[16:19], s67 offen sc1
    s_nop 1
F_w3:
    s_mov_b64 exec, -1
    s_cmp_eq_u32 s20, 7
    s_cbranch_scc0 F_nofrag
    s_cmp_lt_u32 s2, 160
    s_cbranch_scc0 F_nofrag
    v_or_b32 v176, v176, v180
    v_or_b32 v177, v177, v181
    v_or_b32 v178, v178, v182
    v_or_b32 v179, v179, v183
    s_lshl_b32 s66, s2, 10
    s_add_u32 s66, s66, 1024
    buffer_store_dwordx4 v[176:179], v86, s[16:19], s66 offen sc1
F_nofrag:
    s_barrier
    s_mul_i32 s24, s2, 32000
    s_lshl_b32 s25, s20, 12
    s_add_u32 s24, s24, s25
    s_add_u32 s24, s24, 164864
    s_add_u32 s25, s24, 8000000
    s_add_u32 s26, s25, 8000000
    v_mov_b32 v22, 0
    v_mov_b32 v23, s88
    s_mul_i32 s68, s20, 5120
    s_cmp_ge_u32 s20, 4
    s_cselect_b32 s70, 45056, 0
    s_add_u32 s68, s68, s70
    v_add_u32 v2, s68, v86
    ds_write_b128 v2, v[96:99] offset:0
    ds_write_b128 v2, v[100:103] offset:1024
    ds_write_b128 v2, v[104:107] offset:2048
    ds_write_b128 v2, v[108:111] offset:3072
    ds_write_b128 v2, v[112:115] offset:4096
    v_mov_b32 v4, 2130738944
    v_mov_b32 v5, 2130738944
    v_mov_b32 v6, 2130738944
    v_mov_b32 v7, 2130738944
    v_lshlrev_b32 v2, 4, v0
    v_add_u32 v3, 86016, v2
    ds_write_b128 v3, v[4:7] offset:0
    ds_write_b128 v3, v[4:7] offset:8192
    ds_write_b128 v3, v[4:7] offset:16384
    ds_write_b128 v3, v[4:7] offset:24576
    ds_write_b128 v3, v[4:7] offset:32768
    ds_write_b128 v3, v[4:7] offset:40960
    ds_write_b128 v3, v[4:7] offset:49152
    ds_write_b128 v3, v[4:7] offset:57344
    v_add_u32 v3, 0x10000, v3
    ds_write_b128 v3, v[4:7] offset:0
    v_min_u32 v2, 3056, v2
    v_add_u32 v2, 159744, v2
    ds_write_b128 v2, v[4:7]
    s_sub_u32 s72, s72, 128
    s_subb_u32 s73, s73, 0
    s_mov_b32 s4, s72
    s_and_b32 s5, s73, 0xffff
    s_mov_b32 s6, 10240000
    s_mov_b32 s7, 0x20000
    s_sub_u32 s72, s72, 1024
    s_subb_u32 s73, s73, 0
    s_mov_b32 s8, s72
    s_and_b32 s9, s73, 0xffff
    s_mov_b32 s10, 10241024
    s_mov_b32 s11, 0x20000
    s_mov_b32 s12, s76
    s_and_b32 s13, s77, 0xffff
    s_mov_b32 s14, 10240000
    s_mov_b32 s15, 0x20000
    v_lshrrev_b32 v2, 5, v1
    v_bfe_u32 v3, v1, 2, 2
    v_and_b32 v4, 3, v1
    v_bfe_u32 v5, v1, 4, 1
    v_lshlrev_b32 v6, 9, v2
    v_lshl_add_u32 v6, v3, 7, v6
    v_lshl_add_u32 v6, v5, 5, v6
    v_lshl_add_u32 v6, v4, 3, v6
    v_lshrrev_b32 v7, 1, v3
    v_lshl_add_u32 v6, v7, 6, v6
    v_add_u32 v244, s21, v6
    v_xor_b32 v245, 64, v244
    v_lshlrev_b32 v6, 7, v2
    v_lshl_add_u32 v6, v7, 5, v6
    v_and_b32 v7, 1, v3
    v_xor_b32 v7, 1, v7
    v_mul_u32_u24 v7, 90112, v7
    v_add_u32 v6, v6, v7
    v_lshl_add_u32 v249, v4, 3, v6
    v_lshl_add_u32 v6, v2, 2, v4
    v_bfe_u32 v7, v1, 2, 1
    v_lshl_add_u32 v6, v7, 3, v6
    v_lshlrev_b32 v6, 3, v6
    v_bfe_u32 v7, v1, 3, 1
    v_add_u32 v5, 1, v5
    v_mul_u32_u24 v7, v7, v5
    v_lshl_add_u32 v250, v7, 1, v6
    v_and_b32 v6, 0x38, v1
    v_add_u32 v247, 6, v6
    v_lshrrev_b32 v6, 2, v1
    v_lshrrev_b32 v7, 4, v1
    v_xor_b32 v6, v6, v7
    v_and_b32 v6, 1, v6
    v_lshlrev_b32 v6, 6, v6
    v_lshl_add_u32 v246, v4, 4, v6
    v_mov_b32 v242, 1.0
    v_mov_b32 v243, 1.0
    s_mov_b32 s54, 0xffffff00
    s_mov_b32 s55, 0xffffff00
    s_mov_b32 s56, 0xffff
    s_mov_b32 s57, 0xffff
    s_mov_b32 s58, 0
    s_mov_b32 s59, 134217856
    s_mov_b32 s60, 262272
    s_mov_b32 s61, 402915456
    s_mov_b32 s62, 940179840
    s_mov_b32 s63, 403046528
    s_mov_b32 s64, 402784384
    s_mov_b32 s65, 134348928
    s_mov_b32 s38, 128
    s_mov_b32 s33, -1
    s_and_b32 s68, s20, 3
    s_lshl_b32 s68, s68, 2
    s_lshr_b32 s69, s20, 2
    s_add_u32 s68, s68, s69
    s_lshl_b32 s68, s68, 4
    s_add_u32 s68, s68, 163072
    v_mov_b32 v251, s68
    s_mov_b32 s53, 0
    s_mov_b32 s50, 0
    s_mov_b32 s51, 0
    s_mov_b32 s47, 0
    s_mov_b32 s42, 0
    s_mov_b32 s3, 0
    s_mov_b32 s89, 0
    s_mov_b32 s34, 128
    s_mov_b32 s35, 384
    s_mov_b32 s36, 640
    s_mov_b32 s37, 896
    s_waitcnt lgkmcnt(0)
    s_barrier
    buffer_load_dwordx4 v[8:11], v86, s[16:19], s24 offen offset:0 sc1
    buffer_load_dwordx4 v[12:15], v86, s[16:19], s24 offen offset:1024 sc1
    buffer_load_dwordx4 v[16:19], v86, s[16:19], s24 offen offset:2048 sc1
    s_mov_b64 exec, s[22:23]
    buffer_load_dwordx4 v[20:23], v86, s[16:19], s24 offen offset:3072 sc1
    s_mov_b64 exec, -1
    ds_read_b128 v[96:99], v86 offset:0
    ds_read_b128 v[100:103], v86 offset:1024
    ds_read_b128 v[104:107], v86 offset:2048
    ds_read_b128 v[108:111], v86 offset:3072
    ds_read_b128 v[112:115], v86 offset:4096
    ds_read_b128 v[116:119], v86 offset:5120
    ds_read_b128 v[120:123], v86 offset:6144
    ds_read_b128 v[124:127], v86 offset:7168
    ds_read_b128 v[128:131], v86 offset:8192
    ds_read_b128 v[132:135], v86 offset:9216
    ds_read_b128 v[136:139], v86 offset:10240
    ds_read_b128 v[140:143], v86 offset:11264
    ds_read_b128 v[144:147], v86 offset:12288
    ds_read_b128 v[148:151], v86 offset:13312
    ds_read_b128 v[152:155], v86 offset:14336
    ds_read_b128 v[156:159], v86 offset:15360
    ds_read_b128 v[160:163], v86 offset:16384
    ds_read_b128 v[164:167], v86 offset:17408
    ds_read_b128 v[168:171], v86 offset:18432
    ds_read_b128 v[172:175], v86 offset:19456
    s_mov_b32 s27, 32768
    s_mov_b32 s71, 162816
    v_mov_b32 v3, 1
    s_cmp_eq_u32 s20, 7
    s_cselect_b32 s52, 160, 0
    v_cmp_gt_u32 s[68:69], 40, v1
    s_mov_b64 s[28:29], 0xff
    s_lshr_b32 s66, s2, 3
    s_lshl_b32 s66, s66, 3
    s_add_u32 s66, s66, s20
    s_mul_i32 s66, s66, 40
    v_min_u32 v93, 39, v1
    v_add_u32 v93, s66, v93
    v_lshlrev_b32 v93, 10, v93
    v_mov_b32 v94, 0x7f000000
F_poll:
    s_waitcnt vmcnt(0)
    v_cmp_ne_u32 s[72:73], s88, v11
    v_cmp_ne_u32 s[74:75], s88, v15
    v_cmp_ne_u32 s[76:77], s88, v19
    v_cmp_ne_u32 s[78:79], s88, v23
    s_or_b64 s[80:81], s[72:73], s[74:75]
    s_or_b64 s[82:83], s[76:77], s[78:79]
    s_or_b64 s[80:81], s[80:81], s[82:83]
    s_cbranch_scc1 F_again
F_got:
    v_bfe_u32 v2, v10, 23, 5
    v_bfe_u32 v60, v10, 11, 6
    v_cmp_gt_u32 s[80:81], v2, v91
    v_lshl_add_u32 v60, v60, 2, s71
    v_cmp_lt_u32 s[72:73], 8, v2
    v_max_u32 v89, v89, v2
    s_mov_b64 exec, s[80:81]
    ds_add_rtn_u32 v72, v60, v3
    s_mov_b64 exec, s[72:73]
    s_cbranch_execz F_h0
    buffer_load_dwordx4 v[24:27], v86, s[16:19], s25 offen offset:0 sc1
    v_sub_u32 v56, v2, v91
    v_bfe_u32 v64, v10, 17, 6
    v_cmp_lt_u32 vcc, 8, v56
    v_lshl_add_u32 v64, v64, 2, s71
    s_mov_b64 exec, vcc
    ds_add_rtn_u32 v76, v64, v3
F_h0:
    s_mov_b64 exec, -1
    v_bfe_u32 v2, v14, 23, 5
    v_bfe_u32 v61, v14, 11, 6
    v_cmp_gt_u32 s[82:83], v2, v91
    v_lshl_add_u32 v61, v61, 2, s71
    v_cmp_lt_u32 s[74:75], 8, v2
    v_max_u32 v89, v89, v2
    s_mov_b64 exec, s[82:83]
    ds_add_rtn_u32 v73, v61, v3
    s_mov_b64 exec, s[74:75]
    s_cbranch_execz F_h1
    buffer_load_dwordx4 v[28:31], v86, s[16:19], s25 offen offset:1024 sc1
    v_sub_u32 v57, v2, v91
    v_bfe_u32 v65, v14, 17, 6
    v_cmp_lt_u32 vcc, 8, v57
    v_lshl_add_u32 v65, v65, 2, s71
    s_mov_b64 exec, vcc
    ds_add_rtn_u32 v77, v65, v3
F_h1:
    s_mov_b64 exec, -1
    v_bfe_u32 v2, v18, 23, 5
    v_bfe_u32 v62, v18, 11, 6
    v_cmp_gt_u32 s[84:85], v2, v91
    v_lshl_add_u32 v62, v62, 2, s71
    v_cmp_lt_u32 s[76:77], 8, v2
    v_max_u32 v89, v89, v2
    s_mov_b64 exec, s[84:85]
    ds_add_rtn_u32 v74, v62, v3
    s_mov_b64 exec, s[76:77]
    s_cbranch_execz F_h2
    buffer_load_dwordx4 v[32:35], v86, s[16:19], s25 offen offset:2048 sc1
    v_sub_u32 v58, v2, v91
    v_bfe_u32 v66, v18, 17, 6
    v_cmp_lt_u32 vcc, 8, v58
    v_lshl_add_u32 v66, v66, 2, s71
    s_mov_b64 exec, vcc
    ds_add_rtn_u32 v78, v66, v3
F_h2:
    s_mov_b64 exec, -1
    v_bfe_u32 v2, v22, 23, 5
    v_bfe_u32 v63, v22, 11, 6
    v_cmp_gt_u32 s[86:87], v2, v91
    v_lshl_add_u32 v63, v63, 2, s71
    v_cmp_lt_u32 s[78:79], 8, v2
    v_max_u32 v89, v89, v2
    s_mov_b64 exec, s[86:87]
    ds_add_rtn_u32 v75, v63, v3
    s_mov_b64 exec, s[78:79]
    s_cbranch_execz F_h3
    buffer_load_dwordx4 v[36:39], v86, s[16:19], s25 offen offset:3072 sc1
    v_sub_u32 v59, v2, v91
    v_bfe_u32 v67, v22, 17, 6
    v_cmp_lt_u32 vcc, 8, v59
    v_lshl_add_u32 v67, v67, 2, s71
    s_mov_b64 exec, vcc
    ds_add_rtn_u32 v79, v67, v3
F_h3:
    s_mov_b64 exec, -1
    v_cmp_lt_u32 s[30:31], 16, v89
    s_mov_b32 s27, 262144
    s_cmp_lg_u64 s[30:31], 0
    s_cbranch_scc1 F_l3
F_l3r:
    v_and_b32 v10, 0x7ff, v10
    v_lshl_add_u32 v10, v10, 5, v90
    v_or_b32 v11, 16, v10
    v_and_b32 v14, 0x7ff, v14
    v_lshl_add_u32 v14, v14, 5, v90
    v_add_u32 v14, 327680, v14
    v_or_b32 v15, 16, v14
    v_and_b32 v18, 0x7ff, v18
    v_lshl_add_u32 v18, v18, 5, v90
    v_add_u32 v18, 655360, v18
    v_or_b32 v19, 16, v18
    v_and_b32 v22, 0x7ff, v22
    v_lshl_add_u32 v22, v22, 5, v90
    v_add_u32 v22, 983040, v22
    v_or_b32 v23, 16, v22
    s_cmp_lt_u32 s2, s52
    s_cbranch_scc1 F_flag
F_flagr:
    s_waitcnt lgkmcnt(0)
    s_barrier
    ds_read_b32 v4, v88
    buffer_load_dword v95, v93, s[4:7], 0 offen offset:128
    v_lshlrev_b32 v72, 3, v72
    v_lshlrev_b32 v73, 3, v73
    v_lshlrev_b32 v74, 3, v74
    v_lshlrev_b32 v75, 3, v75
    v_lshlrev_b32 v76, 3, v76
    v_lshlrev_b32 v77, 3, v77
    v_lshlrev_b32 v78, 3, v78
    v_lshlrev_b32 v79, 3, v79
    s_waitcnt lgkmcnt(0)
    v_add_u32 v5, 15, v4
    v_cmp_lt_u32 vcc, 64, v4
    v_lshrrev_b32 v5, 4, v5
    v_med3_u32 v5, v5, 1, 4
    v_mul_u32_u24 v6, 640, v5
    v_max_u32 v6, 1536, v6
    v_cndmask_b32 v6, 0, v6, s[68:69]
    s_cmp_lg_u64 vcc, 0
    s_cbranch_scc1 SLOW
    v_mov_b32 v7, v6
    v_add_u32 v2, 7, v4
    v_lshrrev_b32 v2, 3, v2
    v_add_u32_dpp v7, v7, v7 row_shr:1 row_mask:0xf bank_mask:0xf
    v_max_u32 v2, 2, v2
    v_cmp_eq_u32 vcc, 7, v2
    v_add_u32_dpp v7, v7, v7 row_shr:2 row_mask:0xf bank_mask:0xf
    v_lshlrev_b32 v92, 22, v5
    v_lshlrev_b32 v5, 18, v5
    v_add_u32_dpp v7, v7, v7 row_shr:4 row_mask:0xf bank_mask:0xf
    v_lshl_or_b32 v5, v1, 21, v5
    v_addc_co_u32 v2, vcc, 0, v2, vcc
    v_add_u32_dpp v7, v7, v7 row_shr:8 row_mask:0xf bank_mask:0xf
    v_lshl_or_b32 v5, v2, 28, v5
    v_med3_u32 v2, v2, 3, 6
    v_add_u32_dpp v7, v7, v7 row_bcast:15 row_mask:0xa bank_mask:0xf
    v_cndmask_b32 v2, 0, v2, s[68:69]
    v_mov_b32 v84, 63
    v_add_u32_dpp v7, v7, v7 row_bcast:31 row_mask:0xc bank_mask:0xf
    s_mov_b32 s71, 0x2000
    v_readlane_b32 s66, v7, 63
    v_sub_u32 v7, v7, v6
    v_add_u32 v7, 86016, v7
    v_lshrrev_b32 v6, 3, v7
    v_mad_u32_u24 v92, v7, s71, v92
    v_or_b32 v92, v92, v6
    ds_bpermute_b32 v60, v60, v92
    ds_bpermute_b32 v61, v61, v92
    ds_bpermute_b32 v62, v62, v92
    ds_bpermute_b32 v63, v63, v92
    ds_bpermute_b32 v64, v64, v92
    ds_bpermute_b32 v65, v65, v92
    ds_bpermute_b32 v66, v66, v92
    ds_bpermute_b32 v67, v67, v92
    v_cmp_eq_u32 vcc, 6, v2
    v_or_b32 v6, v5, v7
    s_cmp_gt_u32 s66, 76800
    s_cbranch_scc1 SLOW
    v_mbcnt_lo_u32_b32 v5, vcc_lo, 0
    v_mbcnt_hi_u32_b32 v5, vcc_hi, v5
    s_bcnt1_i32_b64 s71, vcc
    v_cndmask_b32 v84, v84, v5, vcc
    v_cmp_eq_u32 vcc, 5, v2
    v_mov_b32 v3, s71
    s_nop 0
    v_mbcnt_lo_u32_b32 v5, vcc_lo, v3
    v_mbcnt_hi_u32_b32 v5, vcc_hi, v5
    s_bcnt1_i32_b64 s71, vcc
    v_cndmask_b32 v84, v84, v5, vcc
    v_cmp_eq_u32 vcc, 4, v2
    v_add_u32 v3, s71, v3
    s_nop 0
    v_mbcnt_lo_u32_b32 v5, vcc_lo, v3
    v_mbcnt_hi_u32_b32 v5, vcc_hi, v5
    s_bcnt1_i32_b64 s71, vcc
    v_cndmask_b32 v84, v84, v5, vcc
    v_cmp_eq_u32 vcc, 3, v2
    v_add_u32 v3, s71, v3
    s_nop 0
    v_mbcnt_lo_u32_b32 v5, vcc_lo, v3
    v_mbcnt_hi_u32_b32 v5, vcc_hi, v5
    v_cndmask_b32 v84, v84, v5, vcc
    s_waitcnt lgkmcnt(7)
    v_mad_u32_u16 v2, v60, 8, v72
    v_mad_u32_u16 v3, v60, 8, v72 op_sel:[1,0,0,0]
    s_mov_b64 exec, s[80:81]
    ds_write_b64 v2, v[10:11]
    ds_write_b64 v3, v[8:9]
    s_mov_b64 exec, -1
    s_waitcnt lgkmcnt(8)
    v_mad_u32_u16 v2, v61, 8, v73
    v_mad_u32_u16 v3, v61, 8, v73 op_sel:[1,0,0,0]
    s_mov_b64 exec, s[82:83]
    ds_write_b64 v2, v[14:15]
    ds_write_b64 v3, v[12:13]
    s_mov_b64 exec, -1
    s_waitcnt lgkmcnt(9)
    v_mad_u32_u16 v2, v62, 8, v74
    v_mad_u32_u16 v3, v62, 8, v74 op_sel:[1,0,0,0]
    s_mov_b64 exec, s[84:85]
    ds_write_b64 v2, v[18:19]
    ds_write_b64 v3, v[16:17]
    s_mov_b64 exec, -1
    s_waitcnt lgkmcnt(10)
    v_mad_u32_u16 v2, v63, 8, v75
    v_mad_u32_u16 v3, v63, 8, v75 op_sel:[1,0,0,0]
    s_mov_b64 exec, s[86:87]
    ds_write_b64 v2, v[22:23]
    ds_write_b64 v3, v[20:21]
    s_mov_b64 exec, -1
    v_bfe_u32 v2, v84, 2, 1
    v_bfe_u32 v3, v84, 3, 1
    v_mul_u32_u24 v2, 3, v2
    v_lshl_or_b32 v3, v3, 2, v2
    v_xor_b32 v84, v84, v3
    s_lshr_b32 s66, s2, 3
    v_add_u32 v2, s66, v84
    v_lshlrev_b32 v2, 3, v2
    v_add_u32 v2, v2, v84
    v_cmp_gt_u32 vcc, 32, v84
    v_and_b32 v2, 24, v2
    v_and_or_b32 v2, v84, 7, v2
    v_cndmask_b32 v84, v84, v2, vcc
    v_cmp_eq_u32 vcc, s20, v84
    s_ff1_i32_b64 s67, vcc
    v_readlane_b32 s80, v6, s67
    s_waitcnt vmcnt(1) lgkmcnt(8)
    s_mov_b64 exec, s[72:73]
    s_cbranch_execz F_s0
F_sp0:
    v_cmp_ne_u32 vcc, s88, v27
    s_cbranch_vccnz F_sa0
F_sg0:
    v_cmpx_lt_u32 vcc, 8, v56
    v_and_b32 v26, 0x7ff, v26
    v_lshl_add_u32 v26, v26, 5, v90
    v_or_b32 v27, 16, v26
    v_mad_u32_u16 v2, v64, 8, v76
    v_mad_u32_u16 v3, v64, 8, v76 op_sel:[1,0,0,0]
    ds_write_b64 v2, v[26:27]
    ds_write_b64 v3, v[24:25]
F_s0:
    s_mov_b64 exec, s[74:75]
    s_cbranch_execz F_s1
F_sp1:
    v_cmp_ne_u32 vcc, s88, v31
    s_cbranch_vccnz F_sa1
F_sg1:
    v_cmpx_lt_u32 vcc, 8, v57
    v_and_b32 v30, 0x7ff, v30
    v_lshl_add_u32 v30, v30, 5, v90
    v_add_u32 v30, 327680, v30
    v_or_b32 v31, 16, v30
    v_mad_u32_u16 v2, v65, 8, v77
    v_mad_u32_u16 v3, v65, 8, v77 op_sel:[1,0,0,0]
    ds_write_b64 v2, v[30:31]
    ds_write_b64 v3, v[28:29]
F_s1:
    s_mov_b64 exec, s[76:77]
    s_cbranch_execz F_s2
F_sp2:
    v_cmp_ne_u32 vcc, s88, v35
    s_cbranch_vccnz F_sa2
F_sg2:
    v_cmpx_lt_u32 vcc, 8, v58
    v_and_b32 v34, 0x7ff, v34
    v_lshl_add_u32 v34, v34, 5, v90
    v_add_u32 v34, 655360, v34
    v_or_b32 v35, 16, v34
    v_mad_u32_u16 v2, v66, 8, v78
    v_mad_u32_u16 v3, v66, 8, v78 op_sel:[1,0,0,0]
    ds_write_b64 v2, v[34:35]
    ds_write_b64 v3, v[32:33]
F_s2:
    s_mov_b64 exec, s[78:79]
    s_cbranch_execz F_s3
F_sp3:
    v_cmp_ne_u32 vcc, s88, v39
    s_cbranch_vccnz F_sa3
F_sg3:
    v_cmpx_lt_u32 vcc, 8, v59
    v_and_b32 v38, 0x7ff, v38
    v_lshl_add_u32 v38, v38, 5, v90
    v_add_u32 v38, 983040, v38
    v_or_b32 v39, 16, v38
    v_mad_u32_u16 v2, v67, 8, v79
    v_mad_u32_u16 v3, v67, 8, v79 op_sel:[1,0,0,0]
    ds_write_b64 v2, v[38:39]
    ds_write_b64 v3, v[36:37]
F_s3:
    s_mov_b64 exec, -1
    s_cmp_lg_u64 s[30:31], 0
    s_cbranch_scc1 F_u
F_ur:
    s_mov_b32 s22, s80
    s_mov_b32 s27, s80
    s_mov_b32 s71, s80
    s_bfe_u32 s46, s71, 0x30012
    s_mov_b32 m0, s46
    s_and_b32 s66, s71, 0x3ffff
    s_movrels_b32 s68, s57
    s_movrels_b32 s69, s61
    s_sub_u32 s48, s66, s47
    s_mov_b32 s47, s66
    s_lshr_b32 s52, s71, 28
    s_lshl_b32 s67, s46, 9
    s_add_u32 s66, s66, s67
    s_sub_u32 s49, s66, s42
    s_mov_b32 s42, s66
    s_bfe_u32 s66, s68, 655360
    s_add_u32 s43, s42, s66
    s_bfe_u32 s39, s69, 655360
    s_bfe_u32 s66, s68, 655370
    s_add_u32 s44, s42, s66
    s_bfe_u32 s40, s69, 655370
    s_bfe_u32 s66, s68, 655380
    s_add_u32 s45, s42, s66
    s_bfe_u32 s41, s69, 655380
    s_and_b32 s66, s46, s33
    s_cselect_b32 s72, -1, 1
    s_cselect_b32 s76, s47, 163712
    s_cmp_ge_u32 s66, 2
    s_cselect_b32 s73, -1, 0
    s_add_u32 s77, s47, 1024
    s_cmp_ge_u32 s66, 4
    s_cselect_b32 s75, -1, 0
    s_cmp_ge_u32 s66, 3
    s_cselect_b32 s74, -1, 1
    s_cselect_b32 s77, s77, 163712
    s_mul_i32 s66, s20, 80
    v_min_u32 v2, 76, v248
    s_waitcnt lgkmcnt(0)
    s_barrier
    v_add_u32 v253, s47, v248
    ds_read_b32 v254, v253
    ds_read_b32 v255, v253 offset:256
    v_add_u32 v252, s42, v247
    ds_read_u16 v234, v252
    ds_read_u16 v235, v252 offset:64
    v_add_u32 v252, s43, v247
    ds_read_u16 v236, v252
    ds_read_u16 v237, v252 offset:64
    v_add_u32 v252, s44, v247
    ds_read_u16 v238, v252
    ds_read_u16 v239, v252 offset:64
    v_add_u32 v252, s45, v247
    ds_read_u16 v240, v252
    ds_read_u16 v241, v252 offset:64
    buffer_load_dword v3, v2, s[16:19], s66 offen offset:128 sc1
    v_add_u32 v249, s48, v249
    v_add_u32 v250, s49, v250
    s_waitcnt lgkmcnt(8)
    s_mov_b32 m0, s76
    s_mov_b64 exec, s[72:73]
    buffer_load_dwordx4 v254, s[12:15], 0 offen  lds
    s_mov_b32 m0, s77
    s_mov_b64 exec, s[74:75]
    buffer_load_dwordx4 v255, s[12:15], 0 offen  lds
    s_mov_b64 exec, -1
    s_waitcnt lgkmcnt(0)
    s_add_u32 m0, s21, 0
    v_lshl_add_u32 v234, v234, 10, v246
    v_lshl_add_u32 v235, v235, 10, v246
    buffer_load_dwordx4 v234, s[4:7], s38 offen lds
    buffer_load_dwordx4 v235, s[8:11], s38 offen offset:1024 lds
    s_add_u32 m0, s21, 2048
    v_lshl_add_u32 v236, v236, 10, v246
    v_lshl_add_u32 v237, v237, 10, v246
    buffer_load_dwordx4 v236, s[4:7], s39 offen lds
    buffer_load_dwordx4 v237, s[8:11], s39 offen offset:1024 lds
    s_add_u32 m0, s21, 4096
    v_lshl_add_u32 v238, v238, 10, v246
    v_lshl_add_u32 v239, v239, 10, v246
    buffer_load_dwordx4 v238, s[4:7], s40 offen lds
    buffer_load_dwordx4 v239, s[8:11], s40 offen offset:1024 lds
    s_add_u32 m0, s21, 6144
    v_lshl_add_u32 v240, v240, 10, v246
    v_lshl_add_u32 v241, v241, 10, v246
    buffer_load_dwordx4 v240, s[4:7], s41 offen lds
    buffer_load_dwordx4 v241, s[8:11], s41 offen offset:1024 lds
    v_lshrrev_b32 v8, 3, v84
    v_and_b32 v9, 7, v84
    v_lshlrev_b32 v9, 13, v9
    v_mul_u32_u24 v8, 1536, v8
    v_and_b32 v5, 128, v86
    v_add3_u32 v8, v8, v9, v5
    v_xor_b32 v9, v86, v7
    v_and_b32 v9, 128, v9
    v_add_u32 v9, v9, v7
    v_and_b32 v4, 0x70, v86
    v_or_b32 v5, v9, v4
    s_add_u32 s66, s20, 0
    v_cmp_eq_u32 vcc, s66, v84
    s_ff1_i32_b64 s67, vcc
    v_readlane_b32 s28, v5, s67
    s_add_u32 s66, s20, 8
    v_cmp_eq_u32 vcc, s66, v84
    s_ff1_i32_b64 s67, vcc
    v_readlane_b32 s29, v5, s67
    v_readlane_b32 s23, v6, s67
    s_add_u32 s66, s20, 16
    v_cmp_eq_u32 vcc, s66, v84
    s_ff1_i32_b64 s67, vcc
    v_readlane_b32 s30, v5, s67
    v_readlane_b32 s24, v6, s67
    s_add_u32 s66, s20, 24
    v_cmp_eq_u32 vcc, s66, v84
    s_ff1_i32_b64 s67, vcc
    v_readlane_b32 s31, v5, s67
    v_readlane_b32 s25, v6, s67
    s_add_u32 s66, s20, 32
    v_cmp_eq_u32 vcc, s66, v84
    s_ff1_i32_b64 s67, vcc
    v_readlane_b32 s32, v5, s67
    v_readlane_b32 s26, v6, s67
    v_lshlrev_b32 v4, 3, v1
    v_add_u32 v4, 163328, v4
    s_mov_b32 exec_hi, 0xff
    ds_write_b64 v4, v[8:9]
    s_mov_b32 exec_hi, -1
    s_waitcnt lgkmcnt(0)
    v_mov_b32 v252, 0
    s_waitcnt vmcnt(6)
    v_cmp_ne_u32 vcc, s88, v3
    ds_read_b64_tr_b16 v[176:177], v244 offset:0
    ds_read_b64_tr_b16 v[178:179], v244 offset:1024
    ds_read_b64_tr_b16 v[180:181], v245 offset:0
    ds_read_b64_tr_b16 v[182:183], v245 offset:1024
    ds_read_b64_tr_b16 v[64:65], v249 offset:0
    ds_read_b64_tr_b16 v[68:69], v249 offset:64
    ds_read_b64_tr_b16 v[66:67], v249 offset:256
    ds_read_b64_tr_b16 v[70:71], v249 offset:320
    s_mov_b64 exec, s[54:55]
    ds_read_u16_d16_hi v242, v250 offset:0
    s_mov_b64 exec, -1
    s_or_b32 s89, vcc_lo, vcc_hi
    s_waitcnt lgkmcnt(5)
    v_readfirstlane_b32 s66, v252
    s_add_u32 s53, s53, 1
    v_mov_b32 v252, s53
    s_cmp_le_u32 s53, s66
    ds_write2_b32 v251, v252, v252 offset0:0 offset1:8
    s_setprio 1
    s_cbranch_scc1 PRIO_1
    s_setprio 0
PRIO_1:
    s_cmp_eq_u32 s52, 4
    s_cbranch_scc1 ITEM_0_4
    s_cmp_eq_u32 s52, 5
    s_cbranch_scc1 ITEM_0_5
    s_cmp_eq_u32 s52, 3
    s_cbranch_scc1 ITEM_0_3
    s_cmp_eq_u32 s52, 6
    s_cbranch_scc1 ITEM_0_6
    s_cmp_eq_u32 s52, 8
    s_cbranch_scc1 ITEM_0_8
    s_branch ITEM_0_2
F_again:
    s_sub_u32 s27, s27, 1
    s_cbranch_scc1 F_late
    s_cmp_eq_u64 s[72:73], 0
    s_cbranch_scc1 F_p0
    buffer_load_dwordx4 v[8:11], v86, s[16:19], s24 offen offset:0 sc1
F_p0:
    s_cmp_eq_u64 s[74:75], 0
    s_cbranch_scc1 F_p1
    buffer_load_dwordx4 v[12:15], v86, s[16:19], s24 offen offset:1024 sc1
F_p1:
    s_cmp_eq_u64 s[76:77], 0
    s_cbranch_scc1 F_p2
    buffer_load_dwordx4 v[16:19], v86, s[16:19], s24 offen offset:2048 sc1
F_p2:
    s_cmp_eq_u64 s[78:79], 0
    s_cbranch_scc1 F_p3
    s_mov_b64 exec, s[22:23]
    buffer_load_dwordx4 v[20:23], v86, s[16:19], s24 offen offset:3072 sc1
    s_mov_b64 exec, -1
F_p3:
    s_branch F_poll
F_late:
    v_mov_b32 v2, 163064
    v_mov_b32 v4, 1000
    ds_write_b32 v2, v4
    v_mov_b32 v10, 0
    v_mov_b32 v14, 0
    v_mov_b32 v18, 0
    v_mov_b32 v22, 0
    s_branch F_got
F_l3:
    v_bfe_u32 v2, v10, 23, 5
    v_sub_u32 v56, v2, v91
    v_cmp_lt_u32 vcc, 16, v2
    s_mov_b64 exec, vcc
    s_cbranch_execz F_t0
F_tp0:
    buffer_load_dwordx4 v[40:43], v86, s[16:19], s26 offen offset:0 sc1
    s_waitcnt vmcnt(0)
    v_cmp_ne_u32 vcc, s88, v43
    s_sub_u32 s27, s27, 1
    s_cselect_b64 vcc, 0, vcc
    s_cmp_eq_u64 vcc, 0
    s_cbranch_scc0 F_tp0
    v_bfe_u32 v68, v42, 11, 6
    v_lshl_add_u32 v68, v68, 2, s71
    v_cmp_lt_i32 vcc, 16, v56
    s_mov_b64 exec, vcc
    ds_add_rtn_u32 v80, v68, v3
F_t0:
    s_mov_b64 exec, -1
    v_bfe_u32 v2, v14, 23, 5
    v_sub_u32 v57, v2, v91
    v_cmp_lt_u32 vcc, 16, v2
    s_mov_b64 exec, vcc
    s_cbranch_execz F_t1
F_tp1:
    buffer_load_dwordx4 v[44:47], v86, s[16:19], s26 offen offset:1024 sc1
    s_waitcnt vmcnt(0)
    v_cmp_ne_u32 vcc, s88, v47
    s_sub_u32 s27, s27, 1
    s_cselect_b64 vcc, 0, vcc
    s_cmp_eq_u64 vcc, 0
    s_cbranch_scc0 F_tp1
    v_bfe_u32 v69, v46, 11, 6
    v_lshl_add_u32 v69, v69, 2, s71
    v_cmp_lt_i32 vcc, 16, v57
    s_mov_b64 exec, vcc
    ds_add_rtn_u32 v81, v69, v3
F_t1:
    s_mov_b64 exec, -1
    v_bfe_u32 v2, v18, 23, 5
    v_sub_u32 v58, v2, v91
    v_cmp_lt_u32 vcc, 16, v2
    s_mov_b64 exec, vcc
    s_cbranch_execz F_t2
F_tp2:
    buffer_load_dwordx4 v[48:51], v86, s[16:19], s26 offen offset:2048 sc1
    s_waitcnt vmcnt(0)
    v_cmp_ne_u32 vcc, s88, v51
    s_sub_u32 s27, s27, 1
    s_cselect_b64 vcc, 0, vcc
    s_cmp_eq_u64 vcc, 0
    s_cbranch_scc0 F_tp2
    v_bfe_u32 v70, v50, 11, 6
    v_lshl_add_u32 v70, v70, 2, s71
    v_cmp_lt_i32 vcc, 16, v58
    s_mov_b64 exec, vcc
    ds_add_rtn_u32 v82, v70, v3
F_t2:
    s_mov_b64 exec, -1
    v_bfe_u32 v2, v22, 23, 5
    v_sub_u32 v59, v2, v91
    v_cmp_lt_u32 vcc, 16, v2
    s_mov_b64 exec, vcc
    s_cbranch_execz F_t3
F_tp3:
    buffer_load_dwordx4 v[52:55], v86, s[16:19], s26 offen offset:3072 sc1
    s_waitcnt vmcnt(0)
    v_cmp_ne_u32 vcc, s88, v55
    s_sub_u32 s27, s27, 1
    s_cselect_b64 vcc, 0, vcc
    s_cmp_eq_u64 vcc, 0
    s_cbranch_scc0 F_tp3
    v_bfe_u32 v71, v54, 11, 6
    v_lshl_add_u32 v71, v71, 2, s71
    v_cmp_lt_i32 vcc, 16, v59
    s_mov_b64 exec, vcc
    ds_add_rtn_u32 v83, v71, v3
F_t3:
    s_mov_b64 exec, -1
    v_mov_b32 v2, 163068
    v_mov_b32 v4, 1000
    v_cmp_lt_u32 vcc, 24, v89
    s_mov_b64 exec, vcc
    ds_write_b32 v2, v4
    s_mov_b64 exec, -1
    s_branch F_l3r
F_flag:
    s_lshl_b32 s66, s2, 2
    v_mov_b32 v2, 128
    v_mov_b32 v4, s88
    s_mov_b64 exec, 1
    buffer_store_dword v4, v2, s[16:19], s66 offen sc1
    s_mov_b64 exec, -1
    s_branch F_flagr
F_sa0:
    s_sub_u32 s27, s27, 1
    s_cbranch_scc1 F_sg0
    buffer_load_dwordx4 v[24:27], v86, s[16:19], s25 offen offset:0 sc1
    s_waitcnt vmcnt(0)
    s_branch F_sp0
F_sa1:
    s_sub_u32 s27, s27, 1
    s_cbranch_scc1 F_sg1
    buffer_load_dwordx4 v[28:31], v86, s[16:19], s25 offen offset:1024 sc1
    s_waitcnt vmcnt(0)
    s_branch F_sp1
F_sa2:
    s_sub_u32 s27, s27, 1
    s_cbranch_scc1 F_sg2
    buffer_load_dwordx4 v[32:35], v86, s[16:19], s25 offen offset:2048 sc1
    s_waitcnt vmcnt(0)
    s_branch F_sp2
F_sa3:
    s_sub_u32 s27, s27, 1
    s_cbranch_scc1 F_sg3
    buffer_load_dwordx4 v[36:39], v86, s[16:19], s25 offen offset:3072 sc1
    s_waitcnt vmcnt(0)
    s_branch F_sp3
F_u:
    ds_bpermute_b32 v68, v68, v92
    ds_bpermute_b32 v69, v69, v92
    ds_bpermute_b32 v70, v70, v92
    ds_bpermute_b32 v71, v71, v92
    s_waitcnt lgkmcnt(0)
    v_cmp_lt_i32 vcc, 16, v56
    s_mov_b64 exec, vcc
    s_cbranch_execz F_u0
    v_lshlrev_b32 v80, 3, v80
    v_and_b32 v42, 0x7ff, v42
    v_lshl_add_u32 v42, v42, 5, v90
    v_or_b32 v43, 16, v42
    v_mad_u32_u16 v2, v68, 8, v80
    v_mad_u32_u16 v3, v68, 8, v80 op_sel:[1,0,0,0]
    ds_write_b64 v2, v[42:43]
    ds_write_b64 v3, v[40:41]
F_u0:
    s_mov_b64 exec, -1
    v_cmp_lt_i32 vcc, 16, v57
    s_mov_b64 exec, vcc
    s_cbranch_execz F_u1
    v_lshlrev_b32 v81, 3, v81
    v_and_b32 v46, 0x7ff, v46
    v_lshl_add_u32 v46, v46, 5, v90
    v_add_u32 v46, 327680, v46
    v_or_b32 v47, 16, v46
    v_mad_u32_u16 v2, v69, 8, v81
    v_mad_u32_u16 v3, v69, 8, v81 op_sel:[1,0,0,0]
    ds_write_b64 v2, v[46:47]
    ds_write_b64 v3, v[44:45]
F_u1:
    s_mov_b64 exec, -1
    v_cmp_lt_i32 vcc, 16, v58
    s_mov_b64 exec, vcc
    s_cbranch_execz F_u2
    v_lshlrev_b32 v82, 3, v82
    v_and_b32 v50, 0x7ff, v50
    v_lshl_add_u32 v50, v50, 5, v90
    v_add_u32 v50, 655360, v50
    v_or_b32 v51, 16, v50
    v_mad_u32_u16 v2, v70, 8, v82
    v_mad_u32_u16 v3, v70, 8, v82 op_sel:[1,0,0,0]
    ds_write_b64 v2, v[50:51]
    ds_write_b64 v3, v[48:49]
F_u2:
    s_mov_b64 exec, -1
    v_cmp_lt_i32 vcc, 16, v59
    s_mov_b64 exec, vcc
    s_cbranch_execz F_u3
    v_lshlrev_b32 v83, 3, v83
    v_and_b32 v54, 0x7ff, v54
    v_lshl_add_u32 v54, v54, 5, v90
    v_add_u32 v54, 983040, v54
    v_or_b32 v55, 16, v54
    v_mad_u32_u16 v2, v71, 8, v83
    v_mad_u32_u16 v3, v71, 8, v83 op_sel:[1,0,0,0]
    ds_write_b64 v2, v[54:55]
    ds_write_b64 v3, v[52:53]
F_u3:
    s_mov_b64 exec, -1
    s_branch F_ur
LAST0:
    s_cmp_eq_u32 s50, 5
    s_cbranch_scc1 TO_PHASE1
    s_add_u32 s4, s4, 128
    s_addc_u32 s5, s5, 0
    s_add_u32 s8, s8, 128
    s_addc_u32 s9, s9, 0
    s_mov_b32 s34, 0
    s_mov_b32 s35, 256
    s_mov_b32 s36, 512
    s_mov_b32 s37, 768
    s_mov_b32 s33, 0
    s_waitcnt lgkmcnt(5)
    v_readfirstlane_b32 s66, v252
    s_add_u32 s53, s53, 1
    v_mov_b32 v252, s53
    s_cmp_le_u32 s53, s66
    ds_write2_b32 v251, v252, v252 offset0:0 offset1:8
    s_setprio 1
    s_cbranch_scc1 PRIO_2
    s_setprio 0
PRIO_2:
    s_cmp_eq_u32 s52, 4
    s_cbranch_scc1 ITEM_0_4
    s_cmp_eq_u32 s52, 5
    s_cbranch_scc1 ITEM_0_5
    s_cmp_eq_u32 s52, 3
    s_cbranch_scc1 ITEM_0_3
    s_cmp_eq_u32 s52, 6
    s_cbranch_scc1 ITEM_0_6
    s_cmp_eq_u32 s52, 8
    s_cbranch_scc1 ITEM_0_8
    s_branch ITEM_0_2
TO_PHASE1:
    v_lshlrev_b32 v253, 2, v248
    v_add_u32 v253, 65536, v253
    ds_read_b128 v[96:99], v253 offset:0
    ds_read_b128 v[100:103], v253 offset:1024
    ds_read_b128 v[104:107], v253 offset:2048
    ds_read_b128 v[108:111], v253 offset:3072
    ds_read_b128 v[112:115], v253 offset:4096
    ds_read_b128 v[116:119], v253 offset:5120
    ds_read_b128 v[120:123], v253 offset:6144
    ds_read_b128 v[124:127], v253 offset:7168
    ds_read_b128 v[128:131], v253 offset:8192
    ds_read_b128 v[132:135], v253 offset:9216
    ds_read_b128 v[136:139], v253 offset:10240
    ds_read_b128 v[140:143], v253 offset:11264
    ds_read_b128 v[144:147], v253 offset:12288
    ds_read_b128 v[148:151], v253 offset:13312
    ds_read_b128 v[152:155], v253 offset:14336
    ds_read_b128 v[156:159], v253 offset:15360
    ds_read_b128 v[160:163], v253 offset:16384
    ds_read_b128 v[164:167], v253 offset:17408
    ds_read_b128 v[168:171], v253 offset:18432
    ds_read_b128 v[172:175], v253 offset:19456
    s_mov_b32 s34, 128
    s_mov_b32 s35, 384
    s_mov_b32 s36, 640
    s_mov_b32 s37, 896
    s_mov_b32 s50, 0
    s_waitcnt lgkmcnt(0)
    s_waitcnt lgkmcnt(0)
    v_readfirstlane_b32 s66, v252
    s_add_u32 s53, s53, 1
    v_mov_b32 v252, s53
    s_cmp_le_u32 s53, s66
    ds_write2_b32 v251, v252, v252 offset0:0 offset1:8
    s_setprio 1
    s_cbranch_scc1 PRIO_3
    s_setprio 0
PRIO_3:
    s_cmp_eq_u32 s52, 4
    s_cbranch_scc1 ITEM_1_4
    s_cmp_eq_u32 s52, 5
    s_cbranch_scc1 ITEM_1_5
    s_cmp_eq_u32 s52, 3
    s_cbranch_scc1 ITEM_1_3
    s_cmp_eq_u32 s52, 6
    s_cbranch_scc1 ITEM_1_6
    s_cmp_eq_u32 s52, 8
    s_cbranch_scc1 ITEM_1_8
    s_branch ITEM_1_2
LAST1:
    s_cmp_eq_u32 s50, 5
    s_cbranch_scc1 TAIL
    v_mov_b32 v246, 0x7f000000
    s_load_dwordx2 s[72:73], s[0:1], 72
    s_waitcnt lgkmcnt(7)
    v_readfirstlane_b32 s66, v252
    s_add_u32 s53, s53, 1
    v_mov_b32 v252, s53
    s_cmp_le_u32 s53, s66
    ds_write2_b32 v251, v252, v252 offset0:0 offset1:8
    s_setprio 1
    s_cbranch_scc1 PRIO_4
    s_setprio 0
PRIO_4:
    s_cmp_eq_u32 s52, 4
    s_cbranch_scc1 ITEM_1_4
    s_cmp_eq_u32 s52, 5
    s_cbranch_scc1 ITEM_1_5
    s_cmp_eq_u32 s52, 3
    s_cbranch_scc1 ITEM_1_3
    s_cmp_eq_u32 s52, 6
    s_cbranch_scc1 ITEM_1_6
    s_cmp_eq_u32 s52, 8
    s_cbranch_scc1 ITEM_1_8
    s_branch ITEM_1_2
.p2align 6
ITEM_0_4:
    s_mov_b64 exec, s[54:55]
    ds_read_u16_d16_hi v243, v250 offset:128
    s_mov_b64 exec, -1
    ds_read_b64_tr_b16 v[72:73], v249 offset:512
    ds_read_b64_tr_b16 v[76:77], v249 offset:576
    ds_read_b64_tr_b16 v[74:75], v249 offset:768
    ds_read_b64_tr_b16 v[78:79], v249 offset:832
    s_waitcnt lgkmcnt(5)
    v_mul_f32_dpp v196, v242, v64 row_newbcast:0 row_mask:0xf bank_mask:0xf
    v_mul_f32_dpp v197, v242, v65 row_newbcast:1 row_mask:0xf bank_mask:0xf
    v_mul_f32_dpp v198, v242, v64 row_newbcast:8 row_mask:0xf bank_mask:0xf
    v_mul_f32_dpp v199, v242, v65 row_newbcast:9 row_mask:0xf bank_mask:0xf
    v_mul_f32_dpp v200, v242, v68 row_newbcast:2 row_mask:0xf bank_mask:0xf
    v_mul_f32_dpp v201, v242, v69 row_newbcast:3 row_mask:0xf bank_mask:0xf
    v_mul_f32_dpp v202, v242, v68 row_newbcast:10 row_mask:0xf bank_mask:0xf
    v_mul_f32_dpp v203, v242, v69 row_newbcast:11 row_mask:0xf bank_mask:0xf
    v_cvt_pk_bf16_f32 v64, v196, v197
    v_cvt_pk_bf16_f32 v68, v198, v199
    v_cvt_pk_bf16_f32 v65, v200, v201
    v_cvt_pk_bf16_f32 v69, v202, v203
    v_mul_f32_dpp v196, v242, v66 row_newbcast:4 row_mask:0xf bank_mask:0xf
    v_mul_f32_dpp v197, v242, v67 row_newbcast:5 row_mask:0xf bank_mask:0xf
    v_mul_f32_dpp v198, v242, v66 row_newbcast:12 row_mask:0xf bank_mask:0xf
    v_mul_f32_dpp v199, v242, v67 row_newbcast:13 row_mask:0xf bank_mask:0xf
    v_mul_f32_dpp v200, v242, v70 row_newbcast:6 row_mask:0xf bank_mask:0xf
    v_mul_f32_dpp v201, v242, v71 row_newbcast:7 row_mask:0xf bank_mask:0xf
    v_mul_f32_dpp v202, v242, v70 row_newbcast:14 row_mask:0xf bank_mask:0xf
    v_mul_f32_dpp v203, v242, v71 row_newbcast:15 row_mask:0xf bank_mask:0xf
    v_cvt_pk_bf16_f32 v66, v196, v197
    v_cvt_pk_bf16_f32 v70, v198, v199
    v_cvt_pk_bf16_f32 v67, v200, v201
    v_cvt_pk_bf16_f32 v71, v202, v203
    s_nop 0
    s_waitcnt vmcnt(4) lgkmcnt(0)
    v_mfma_f32_32x32x16_bf16 v[0:15], v[64:67], v[176:179], 0
    v_mul_f32_dpp v196, v243, v72 row_newbcast:0 row_mask:0xf bank_mask:0xf
    v_mul_f32_dpp v197, v243, v73 row_newbcast:1 row_mask:0xf bank_mask:0xf
    v_mul_f32_dpp v198, v243, v72 row_newbcast:8 row_mask:0xf bank_mask:0xf
    v_mul_f32_dpp v199, v243, v73 row_newbcast:9 row_mask:0xf bank_mask:0xf
    v_mul_f32_dpp v200, v243, v76 row_newbcast:2 row_mask:0xf bank_mask:0xf
    v_mul_f32_dpp v201, v243, v77 row_newbcast:3 row_mask:0xf bank_mask:0xf
    v_mul_f32_dpp v202, v243, v76 row_newbcast:10 row_mask:0xf bank_mask:0xf
    v_mul_f32_dpp v203, v243, v77 row_newbcast:11 row_mask:0xf bank_mask:0xf
    v_cvt_pk_bf16_f32 v72, v196, v197
    v_cvt_pk_bf16_f32 v76, v198, v199
    v_cvt_pk_bf16_f32 v73, v200, v201
    v_cvt_pk_bf16_f32 v77, v202, v203
    s_add_u32 m0, s21, 0
    v_mfma_f32_32x32x16_bf16 v[16:31], v[68:71], v[176:179], 0
    buffer_load_dwordx4 v234, s[4:7], s36 offen lds
    buffer_load_dwordx4 v235, s[8:11], s36 offen offset:1024 lds
    ds_read_b64_tr_b16 v[176:177], v244 offset:2048
    ds_read_b64_tr_b16 v[178:179], v244 offset:3072
    ds_read_b64_tr_b16 v[184:185], v245 offset:2048
    ds_read_b64_tr_b16 v[186:187], v245 offset:3072
    v_mul_f32_dpp v196, v243, v74 row_newbcast:4 row_mask:0xf bank_mask:0xf
    v_mul_f32_dpp v197, v243, v75 row_newbcast:5 row_mask:0xf bank_mask:0xf
    v_mul_f32_dpp v198, v243, v74 row_newbcast:12 row_mask:0xf bank_mask:0xf
    v_mul_f32_dpp v199, v243, v75 row_newbcast:13 row_mask:0xf bank_mask:0xf
    v_mul_f32_dpp v200, v243, v78 row_newbcast:6 row_mask:0xf bank_mask:0xf
    v_mul_f32_dpp v201, v243, v79 row_newbcast:7 row_mask:0xf bank_mask:0xf
    v_mul_f32_dpp v202, v243, v78 row_newbcast:14 row_mask:0xf bank_mask:0xf
    v_mul_f32_dpp v203, v243, v79 row_newbcast:15 row_mask:0xf bank_mask:0xf
    v_cvt_pk_bf16_f32 v74, v196, v197
    v_cvt_pk_bf16_f32 v78, v198, v199
    v_cvt_pk_bf16_f32 v75, v200, v201
    v_cvt_pk_bf16_f32 v79, v202, v203
    s_nop 0
    s_waitcnt lgkmcnt(0)
    v_mfma_f32_32x32x16_bf16 v[0:15], v[72:75], v[176:179], v[0:15]
    s_add_u32 m0, s21, 2048
    v_mfma_f32_32x32x16_bf16 v[16:31], v[76:79], v[176:179], v[16:31]
    buffer_load_dwordx4 v236, s[4:7], s36 offen lds
    buffer_load_dwordx4 v237, s[8:11], s36 offen offset:1024 lds
    s_mov_b32 m0, s50
    s_nop 0
    s_movrels_b32 s71, s23
    s_bfe_u32 s46, s71, 0x30012
    s_mov_b32 m0, s46
    s_and_b32 s66, s71, 0x3ffff
    s_movrels_b32 s68, s57
    s_movrels_b32 s69, s61
    s_sub_u32 s48, s66, s47
    s_mov_b32 s47, s66
    s_lshr_b32 s52, s71, 28
    s_lshl_b32 s67, s46, 9
    s_add_u32 s66, s66, s67
    s_sub_u32 s49, s66, s42
    s_mov_b32 s42, s66
    s_bfe_u32 s66, s68, 655360
    s_add_u32 s43, s42, s66
    s_bfe_u32 s39, s69, 655360
    s_bfe_u32 s66, s68, 655370
    s_add_u32 s44, s42, s66
    s_bfe_u32 s40, s69, 655370
    s_bfe_u32 s66, s68, 655380
    s_add_u32 s45, s42, s66
    s_bfe_u32 s41, s69, 655380
    s_and_b32 s66, s46, s33
    s_cselect_b32 s72, -1, 1
    s_cselect_b32 s76, s47, 163712
    s_cmp_ge_u32 s66, 2
    s_cselect_b32 s73, -1, 0
    s_add_u32 s77, s47, 1024
    s_cmp_ge_u32 s66, 4
    s_cselect_b32 s75, -1, 0
    s_cmp_ge_u32 s66, 3
    s_cselect_b32 s74, -1, 1
    s_cselect_b32 s77, s77, 163712
    v_add_u32 v252, s44, v247
    ds_read_u16 v238, v252
    ds_read_u16 v239, v252 offset:64
    v_add_u32 v252, s45, v247
    ds_read_u16 v240, v252
    ds_read_u16 v241, v252 offset:64
    v_mfma_f32_32x32x16_bf16 v[32:47], v[64:67], v[180:183], 0
    v_mul_f32 v196, v0, v96
    v_fmac_f32 v196, v1, v97
    v_fmac_f32 v196, v2, v98
    v_fmac_f32 v196, v3, v99
    v_fmac_f32 v196, v4, v100
    v_fmac_f32 v196, v5, v101
    v_fmac_f32 v196, v6, v102
    v_fmac_f32 v196, v7, v103
    v_mul_f32 v198, v8, v128
    v_fmac_f32 v198, v9, v129
    v_mfma_f32_32x32x16_bf16 v[48:63], v[68:71], v[180:183], 0
    v_add_u32 v253, s47, v248
    ds_read_b32 v254, v253
    ds_read_b32 v255, v253 offset:256
    s_waitcnt vmcnt(6)
    ds_read_b64_tr_b16 v[176:177], v244 offset:4096
    ds_read_b64_tr_b16 v[178:179], v244 offset:5120
    ds_read_b64_tr_b16 v[180:181], v245 offset:4096
    ds_read_b64_tr_b16 v[182:183], v245 offset:5120
    v_fmac_f32 v198, v10, v130
    v_fmac_f32 v198, v11, v131
    v_fmac_f32 v198, v12, v132
    v_fmac_f32 v198, v13, v133
    v_fmac_f32 v198, v14, v134
    v_fmac_f32 v198, v15, v135
    v_mul_f32 v200, v16, v128
    v_fmac_f32 v200, v17, v129
    v_permlane32_swap_b32 v196, v198
    v_mfma_f32_32x32x16_bf16 v[32:47], v[72:75], v[184:187], v[32:47]
    v_fmac_f32 v200, v18, v130
    v_fmac_f32 v200, v19, v131
    v_fmac_f32 v200, v20, v132
    v_fmac_f32 v200, v21, v133
    v_fmac_f32 v200, v22, v134
    v_fmac_f32 v200, v23, v135
    v_add_f32 v198, v196, v198
    v_mul_f32_e64 v202, v24, -v128
    v_fma_f32 v202, v25, -v129, v202
    v_mfma_f32_32x32x16_bf16 v[48:63], v[76:79], v[184:187], v[48:63]
    v_fma_f32 v202, v26, -v130, v202
    v_fma_f32 v202, v27, -v131, v202
    v_fma_f32 v202, v28, -v132, v202
    v_fma_f32 v202, v29, -v133, v202
    v_fma_f32 v202, v30, -v134, v202
    v_fma_f32 v202, v31, -v135, v202
    s_nop 1
    v_permlane32_swap_b32 v200, v202
    v_add_f32 v202, v200, v202
    s_waitcnt vmcnt(4) lgkmcnt(0)
    v_mfma_f32_32x32x16_bf16 v[0:15], v[64:67], v[176:179], 0
    v_mul_f32 v197, v32, v104
    v_fmac_f32 v197, v33, v105
    v_fmac_f32 v197, v34, v106
    v_fmac_f32 v197, v35, v107
    v_fmac_f32 v197, v36, v108
    v_fmac_f32 v197, v37, v109
    v_fmac_f32 v197, v38, v110
    v_fmac_f32 v197, v39, v111
    v_mul_f32 v199, v40, v136
    v_fmac_f32 v199, v41, v137
    v_fmac_f32 v199, v42, v138
    s_add_u32 m0, s21, 4096
    v_mfma_f32_32x32x16_bf16 v[16:31], v[68:71], v[176:179], 0
    buffer_load_dwordx4 v234, s[4:7], s37 offen lds
    buffer_load_dwordx4 v235, s[8:11], s37 offen offset:1024 lds
    ds_read_b64_tr_b16 v[176:177], v244 offset:6144
    ds_read_b64_tr_b16 v[178:179], v244 offset:7168
    ds_read_b64_tr_b16 v[184:185], v245 offset:6144
    ds_read_b64_tr_b16 v[186:187], v245 offset:7168
    v_add_u32 v252, s42, v247
    ds_read_u16 v234, v252
    ds_read_u16 v235, v252 offset:64
    s_mov_b32 m0, s76
    s_mov_b64 exec, s[72:73]
    buffer_load_dwordx4 v254, s[12:15], 0 offen  lds
    s_mov_b32 m0, s77
    s_mov_b64 exec, s[74:75]
    buffer_load_dwordx4 v255, s[12:15], 0 offen  lds
    s_mov_b64 exec, -1
    v_fmac_f32 v199, v43, v139
    v_fmac_f32 v199, v44, v140
    v_fmac_f32 v199, v45, v141
    v_fmac_f32 v199, v46, v142
    v_fmac_f32 v199, v47, v143
    v_mul_f32 v201, v48, v136
    v_fmac_f32 v201, v49, v137
    v_permlane32_swap_b32 v197, v199
    v_fmac_f32 v201, v50, v138
    v_fmac_f32 v201, v51, v139
    s_waitcnt lgkmcnt(2)
    v_mfma_f32_32x32x16_bf16 v[0:15], v[72:75], v[176:179], v[0:15]
    v_fmac_f32 v201, v52, v140
    v_fmac_f32 v201, v53, v141
    v_fmac_f32 v201, v54, v142
    v_fmac_f32 v201, v55, v143
    v_add_f32 v199, v197, v199
    v_mul_f32_e64 v203, v56, -v136
    v_fma_f32 v203, v57, -v137, v203
    v_fma_f32 v203, v58, -v138, v203
    v_fma_f32 v203, v59, -v139, v203
    v_fma_f32 v203, v60, -v140, v203
    v_fma_f32 v203, v61, -v141, v203
    s_add_u32 m0, s21, 6144
    v_mfma_f32_32x32x16_bf16 v[16:31], v[76:79], v[176:179], v[16:31]
    buffer_load_dwordx4 v236, s[4:7], s37 offen lds
    buffer_load_dwordx4 v237, s[8:11], s37 offen offset:1024 lds
    v_add_u32 v252, s43, v247
    ds_read_u16 v236, v252
    ds_read_u16 v237, v252 offset:64
    v_fma_f32 v203, v62, -v142, v203
    v_fma_f32 v203, v63, -v143, v203
    s_nop 1
    v_permlane32_swap_b32 v201, v203
    v_add_f32 v203, v201, v203
    s_set_gpr_idx_on s51, gpr_idx(DST)
    s_nop 0
    v_cvt_pk_bf16_f32 v204, v198, v199
    v_cvt_pk_bf16_f32 v205, v202, v203
    s_set_gpr_idx_off
    v_mfma_f32_32x32x16_bf16 v[32:47], v[64:67], v[180:183], 0
    v_mul_f32 v196, v0, v144
    v_fmac_f32 v196, v1, v145
    v_fmac_f32 v196, v2, v146
    v_fmac_f32 v196, v3, v147
    v_fmac_f32 v196, v4, v148
    v_fmac_f32 v196, v5, v149
    v_fmac_f32 v196, v6, v150
    v_fmac_f32 v196, v7, v151
    v_mfma_f32_32x32x16_bf16 v[48:63], v[68:71], v[180:183], 0
    s_waitcnt vmcnt(8)
    ds_read_b64_tr_b16 v[176:177], v244 offset:0
    ds_read_b64_tr_b16 v[178:179], v244 offset:1024
    ds_read_b64_tr_b16 v[180:181], v245 offset:0
    ds_read_b64_tr_b16 v[182:183], v245 offset:1024
    v_mul_f32 v198, v8, v112
    v_fmac_f32 v198, v9, v113
    v_fmac_f32 v198, v10, v114
    v_fmac_f32 v198, v11, v115
    v_fmac_f32 v198, v12, v116
    v_fmac_f32 v198, v13, v117
    v_fmac_f32 v198, v14, v118
    v_fmac_f32 v198, v15, v119
    v_mfma_f32_32x32x16_bf16 v[32:47], v[72:75], v[184:187], v[32:47]
    v_mul_f32_e64 v200, v16, -v160
    v_fma_f32 v200, v17, -v161, v200
    v_fma_f32 v200, v18, -v162, v200
    v_fma_f32 v200, v19, -v163, v200
    v_fma_f32 v200, v20, -v164, v200
    v_fma_f32 v200, v21, -v165, v200
    v_fma_f32 v200, v22, -v166, v200
    v_fma_f32 v200, v23, -v167, v200
    v_mfma_f32_32x32x16_bf16 v[48:63], v[76:79], v[184:187], v[48:63]
    v_mul_f32_e64 v202, v24, -v160
    v_fma_f32 v202, v25, -v161, v202
    v_fma_f32 v202, v26, -v162, v202
    v_fma_f32 v202, v27, -v163, v202
    v_fma_f32 v202, v28, -v164, v202
    v_fma_f32 v202, v29, -v165, v202
    v_fma_f32 v202, v30, -v166, v202
    v_fma_f32 v202, v31, -v167, v202
    s_waitcnt vmcnt(6) lgkmcnt(0)
    v_mfma_f32_32x32x16_bf16 v[0:15], v[64:67], v[176:179], 0
    v_mul_f32 v197, v32, v152
    v_fmac_f32 v197, v33, v153
    v_fmac_f32 v197, v34, v154
    v_fmac_f32 v197, v35, v155
    v_fmac_f32 v197, v36, v156
    v_fmac_f32 v197, v37, v157
    v_fmac_f32 v197, v38, v158
    v_fmac_f32 v197, v39, v159
    s_add_u32 m0, s21, 0
    v_mfma_f32_32x32x16_bf16 v[16:31], v[68:71], v[176:179], 0
    v_lshl_add_u32 v234, v234, 10, v246
    v_lshl_add_u32 v235, v235, 10, v246
    buffer_load_dwordx4 v234, s[4:7], s38 offen lds
    buffer_load_dwordx4 v235, s[8:11], s38 offen offset:1024 lds
    ds_read_b64_tr_b16 v[176:177], v244 offset:2048
    ds_read_b64_tr_b16 v[178:179], v244 offset:3072
    ds_read_b64_tr_b16 v[184:185], v245 offset:2048
    ds_read_b64_tr_b16 v[186:187], v245 offset:3072
    v_mul_f32 v199, v40, v120
    v_fmac_f32 v199, v41, v121
    v_fmac_f32 v199, v42, v122
    v_fmac_f32 v199, v43, v123
    v_fmac_f32 v199, v44, v124
    v_fmac_f32 v199, v45, v125
    v_fmac_f32 v199, v46, v126
    v_fmac_f32 v199, v47, v127
    s_waitcnt lgkmcnt(0)
    v_mfma_f32_32x32x16_bf16 v[0:15], v[72:75], v[176:179], v[0:15]
    v_mul_f32_e64 v201, v48, -v168
    v_fma_f32 v201, v49, -v169, v201
    v_fma_f32 v201, v50, -v170, v201
    v_fma_f32 v201, v51, -v171, v201
    v_fma_f32 v201, v52, -v172, v201
    v_fma_f32 v201, v53, -v173, v201
    v_fma_f32 v201, v54, -v174, v201
    v_fma_f32 v201, v55, -v175, v201
    s_add_u32 m0, s21, 2048
    v_mfma_f32_32x32x16_bf16 v[16:31], v[76:79], v[176:179], v[16:31]
    v_lshl_add_u32 v236, v236, 10, v246
    v_lshl_add_u32 v237, v237, 10, v246
    buffer_load_dwordx4 v236, s[4:7], s39 offen lds
    buffer_load_dwordx4 v237, s[8:11], s39 offen offset:1024 lds
    v_mul_f32_e64 v203, v56, -v168
    v_fma_f32 v203, v57, -v169, v203
    v_fma_f32 v203, v58, -v170, v203
    v_fma_f32 v203, v59, -v171, v203
    v_fma_f32 v203, v60, -v172, v203
    v_fma_f32 v203, v61, -v173, v203
    v_fma_f32 v203, v62, -v174, v203
    v_fma_f32 v203, v63, -v175, v203
    v_mfma_f32_32x32x16_bf16 v[32:47], v[64:67], v[180:183], 0
    v_mul_f32 v254, v0, v144
    v_fmac_f32 v254, v1, v145
    v_fmac_f32 v254, v2, v146
    v_fmac_f32 v254, v3, v147
    v_fmac_f32 v254, v4, v148
    v_mfma_f32_32x32x16_bf16 v[48:63], v[68:71], v[180:183], 0
    ds_swizzle_b32 v68, v68 offset:0x401F
    ds_swizzle_b32 v69, v69 offset:0x401F
    ds_swizzle_b32 v70, v70 offset:0x401F
    ds_swizzle_b32 v71, v71 offset:0x401F
    s_waitcnt vmcnt(8)
    ds_read_b64_tr_b16 v[176:177], v244 offset:4096
    ds_read_b64_tr_b16 v[178:179], v244 offset:5120
    ds_read_b64_tr_b16 v[180:181], v245 offset:4096
    ds_read_b64_tr_b16 v[182:183], v245 offset:5120
    v_fmac_f32 v254, v5, v149
    v_fmac_f32 v254, v6, v150
    v_fmac_f32 v254, v7, v151
    v_fmac_f32 v200, v8, v160
    v_mfma_f32_32x32x16_bf16 v[32:47], v[72:75], v[184:187], v[32:47]
    v_fmac_f32 v200, v9, v161
    v_permlane32_swap_b32 v196, v254
    v_fmac_f32 v200, v10, v162
    v_fmac_f32 v200, v11, v163
    v_fmac_f32 v200, v12, v164
    v_mfma_f32_32x32x16_bf16 v[48:63], v[76:79], v[184:187], v[48:63]
    ds_swizzle_b32 v76, v76 offset:0x401F
    ds_swizzle_b32 v77, v77 offset:0x401F
    ds_swizzle_b32 v78, v78 offset:0x401F
    ds_swizzle_b32 v79, v79 offset:0x401F
    v_fmac_f32 v200, v13, v165
    v_fmac_f32 v200, v14, v166
    v_fmac_f32 v200, v15, v167
    v_add_f32 v254, v196, v254
    s_waitcnt lgkmcnt(8)
    s_mov_b64 exec, s[56:57]
    v_xor_b32 v68, 0x80008000, v68
    v_xor_b32 v69, 0x80008000, v69
    v_xor_b32 v70, 0x80008000, v70
    v_xor_b32 v71, 0x80008000, v71
    s_mov_b64 exec, -1
    s_waitcnt vmcnt(4) lgkmcnt(4)
    v_mfma_f32_32x32x16_bf16 v[0:15], v[64:67], v[176:179], 0
    v_mul_f32 v255, v32, v152
    v_fmac_f32 v255, v33, v153
    v_fmac_f32 v255, v34, v154
    v_fmac_f32 v255, v35, v155
    v_fmac_f32 v255, v36, v156
    v_fmac_f32 v255, v37, v157
    s_add_u32 m0, s21, 4096
    v_mfma_f32_32x32x16_bf16 v[16:31], v[68:71], v[176:179], v[16:31]
    v_lshl_add_u32 v238, v238, 10, v246
    v_lshl_add_u32 v239, v239, 10, v246
    buffer_load_dwordx4 v238, s[4:7], s40 offen lds
    buffer_load_dwordx4 v239, s[8:11], s40 offen offset:1024 lds
    ds_read_b64_tr_b16 v[176:177], v244 offset:6144
    ds_read_b64_tr_b16 v[178:179], v244 offset:7168
    ds_read_b64_tr_b16 v[184:185], v245 offset:6144
    ds_read_b64_tr_b16 v[186:187], v245 offset:7168
    v_fmac_f32 v255, v38, v158
    v_fmac_f32 v255, v39, v159
    v_fmac_f32 v201, v40, v168
    v_fmac_f32 v201, v41, v169
    v_permlane32_swap_b32 v197, v255
    s_waitcnt lgkmcnt(0)
    s_mov_b64 exec, s[56:57]
    v_xor_b32 v76, 0x80008000, v76
    v_xor_b32 v77, 0x80008000, v77
    v_xor_b32 v78, 0x80008000, v78
    v_xor_b32 v79, 0x80008000, v79
    s_mov_b64 exec, -1
    v_mfma_f32_32x32x16_bf16 v[0:15], v[72:75], v[176:179], v[0:15]
    v_fmac_f32 v201, v42, v170
    v_fmac_f32 v201, v43, v171
    v_fmac_f32 v201, v44, v172
    v_fmac_f32 v201, v45, v173
    v_fmac_f32 v201, v46, v174
    v_fmac_f32 v201, v47, v175
    s_add_u32 m0, s21, 6144
    v_mfma_f32_32x32x16_bf16 v[16:31], v[76:79], v[176:179], v[16:31]
    v_lshl_add_u32 v240, v240, 10, v246
    v_lshl_add_u32 v241, v241, 10, v246
    buffer_load_dwordx4 v240, s[4:7], s41 offen lds
    buffer_load_dwordx4 v241, s[8:11], s41 offen offset:1024 lds
    v_add_f32 v255, v197, v255
    s_set_gpr_idx_on s51, gpr_idx(DST)
    s_nop 0
    v_cvt_pk_bf16_f32 v206, v254, v255
    s_set_gpr_idx_off
    v_mfma_f32_32x32x16_bf16 v[32:47], v[64:67], v[180:183], 0
    v_mul_f32 v254, v0, v144
    v_fmac_f32 v254, v1, v145
    v_fmac_f32 v254, v2, v146
    v_fmac_f32 v254, v3, v147
    v_fmac_f32 v254, v4, v148
    v_fmac_f32 v254, v5, v149
    v_fmac_f32 v254, v6, v150
    v_fmac_f32 v254, v7, v151
    v_fma_f32 v202, v8, -v160, v202
    v_fma_f32 v202, v9, -v161, v202
    v_mfma_f32_32x32x16_bf16 v[48:63], v[68:71], v[180:183], v[48:63]
    s_waitcnt vmcnt(6)
    ds_read_b64_tr_b16 v[176:177], v244 offset:0
    ds_read_b64_tr_b16 v[178:179], v244 offset:1024
    ds_read_b64_tr_b16 v[180:181], v245 offset:0
    ds_read_b64_tr_b16 v[182:183], v245 offset:1024
    v_permlane32_swap_b32 v254, v200
    v_fma_f32 v202, v10, -v162, v202
    v_fma_f32 v202, v11, -v163, v202
    v_fma_f32 v202, v12, -v164, v202
    v_fma_f32 v202, v13, -v165, v202
    v_fma_f32 v202, v14, -v166, v202
    v_fma_f32 v202, v15, -v167, v202
    v_add_f32 v200, v254, v200
    v_fmac_f32 v198, v16, v112
    v_permlane32_swap_b32 v202, v254
    v_mfma_f32_32x32x16_bf16 v[32:47], v[72:75], v[184:187], v[32:47]
    v_fmac_f32 v198, v17, v113
    v_fmac_f32 v198, v18, v114
    v_fmac_f32 v198, v19, v115
    v_fmac_f32 v198, v20, v116
    v_fmac_f32 v198, v21, v117
    v_fmac_f32 v198, v22, v118
    v_fmac_f32 v198, v23, v119
    v_add_f32 v254, v202, v254
    v_mul_f32 v196, v24, v160
    v_fmac_f32 v196, v25, v161
    v_mfma_f32_32x32x16_bf16 v[48:63], v[76:79], v[184:187], v[48:63]
    v_add_u32 v249, s48, v249
    v_add_u32 v250, s49, v250
    ds_read_b32 v252, v251 offset:16
    ds_read_b64_tr_b16 v[64:65], v249 offset:0
    ds_read_b64_tr_b16 v[68:69], v249 offset:64
    ds_read_b64_tr_b16 v[66:67], v249 offset:256
    ds_read_b64_tr_b16 v[70:71], v249 offset:320
    s_mov_b64 exec, s[54:55]
    ds_read_u16_d16_hi v242, v250 offset:0
    s_mov_b64 exec, -1
    v_fmac_f32 v196, v26, v162
    v_fmac_f32 v196, v27, v163
    v_fmac_f32 v196, v28, v164
    v_fmac_f32 v196, v29, v165
    v_fmac_f32 v196, v30, v166
    v_fmac_f32 v196, v31, v167
    s_nop 1
    v_permlane32_swap_b32 v198, v196
    v_add_f32 v196, v198, v196
    v_mul_f32 v255, v32, v152
    v_fmac_f32 v255, v33, v153
    v_fmac_f32 v255, v34, v154
    v_fmac_f32 v255, v35, v155
    v_fmac_f32 v255, v36, v156
    v_fmac_f32 v255, v37, v157
    v_fmac_f32 v255, v38, v158
    v_fmac_f32 v255, v39, v159
    v_fma_f32 v203, v40, -v168, v203
    v_fma_f32 v203, v41, -v169, v203
    v_permlane32_swap_b32 v255, v201
    v_fma_f32 v203, v42, -v170, v203
    v_fma_f32 v203, v43, -v171, v203
    v_fma_f32 v203, v44, -v172, v203
    v_fma_f32 v203, v45, -v173, v203
    v_fma_f32 v203, v46, -v174, v203
    v_fma_f32 v203, v47, -v175, v203
    v_add_f32 v201, v255, v201
    v_fmac_f32 v199, v48, v120
    v_permlane32_swap_b32 v203, v255
    v_fmac_f32 v199, v49, v121
    v_fmac_f32 v199, v50, v122
    v_fmac_f32 v199, v51, v123
    v_fmac_f32 v199, v52, v124
    v_fmac_f32 v199, v53, v125
    v_fmac_f32 v199, v54, v126
    v_fmac_f32 v199, v55, v127
    v_add_f32 v255, v203, v255
    v_mul_f32 v197, v56, v168
    v_fmac_f32 v197, v57, v169
    v_fmac_f32 v197, v58, v170
    v_fmac_f32 v197, v59, v171
    v_fmac_f32 v197, v60, v172
    v_fmac_f32 v197, v61, v173
    v_fmac_f32 v197, v62, v174
    v_fmac_f32 v197, v63, v175
    s_nop 1
    v_permlane32_swap_b32 v199, v197
    v_add_f32 v197, v199, v197
    s_set_gpr_idx_on s51, gpr_idx(DST)
    s_nop 0
    v_cvt_pk_bf16_f32 v207, v200, v201
    v_cvt_pk_bf16_f32 v209, v254, v255
    v_cvt_pk_bf16_f32 v208, v196, v197
    s_set_gpr_idx_off
    s_add_u32 s50, s50, 1
    s_add_u32 s51, s51, 6
    s_cmp_ge_u32 s50, 4
    s_cbranch_scc1 LAST0
    s_waitcnt lgkmcnt(5)
    v_readfirstlane_b32 s66, v252
    s_add_u32 s53, s53, 1
    v_mov_b32 v252, s53
    s_cmp_le_u32 s53, s66
    ds_write2_b32 v251, v252, v252 offset0:0 offset1:8
    s_setprio 1
    s_cbranch_scc1 PRIO_5
    s_setprio 0
PRIO_5:
    s_cmp_eq_u32 s52, 4
    s_cbranch_scc1 ITEM_0_4
    s_cmp_eq_u32 s52, 5
    s_cbranch_scc1 ITEM_0_5
    s_cmp_eq_u32 s52, 3
    s_cbranch_scc1 ITEM_0_3
    s_cmp_eq_u32 s52, 6
    s_cbranch_scc1 ITEM_0_6
    s_cmp_eq_u32 s52, 8
    s_cbranch_scc1 ITEM_0_8
    s_branch ITEM_0_2
.p2align 6
ITEM_0_5:
    s_mov_b64 exec, s[54:55]
    ds_read_u16_d16_hi v243, v250 offset:128
    s_mov_b64 exec, -1
    ds_read_b64_tr_b16 v[72:73], v249 offset:512
    ds_read_b64_tr_b16 v[76:77], v249 offset:576
    ds_read_b64_tr_b16 v[74:75], v249 offset:768
    ds_read_b64_tr_b16 v[78:79], v249 offset:832
    ds_read_b64_tr_b16 v[80:81], v249 offset:1024
    ds_read_b64_tr_b16 v[84:85], v249 offset:1088
    s_waitcnt lgkmcnt(7)
    v_mul_f32_dpp v196, v242, v64 row_newbcast:0 row_mask:0xf bank_mask:0xf
    v_mul_f32_dpp v197, v242, v65 row_newbcast:1 row_mask:0xf bank_mask:0xf
    v_mul_f32_dpp v198, v242, v64 row_newbcast:8 row_mask:0xf bank_mask:0xf
    v_mul_f32_dpp v199, v242, v65 row_newbcast:9 row_mask:0xf bank_mask:0xf
    v_mul_f32_dpp v200, v242, v68 row_newbcast:2 row_mask:0xf bank_mask:0xf
    v_mul_f32_dpp v201, v242, v69 row_newbcast:3 row_mask:0xf bank_mask:0xf
    v_mul_f32_dpp v202, v242, v68 row_newbcast:10 row_mask:0xf bank_mask:0xf
    v_mul_f32_dpp v203, v242, v69 row_newbcast:11 row_mask:0xf bank_mask:0xf
    v_cvt_pk_bf16_f32 v64, v196, v197
    v_cvt_pk_bf16_f32 v68, v198, v199
    v_cvt_pk_bf16_f32 v65, v200, v201
    v_cvt_pk_bf16_f32 v69, v202, v203
    v_mul_f32_dpp v196, v242, v66 row_newbcast:4 row_mask:0xf bank_mask:0xf
    v_mul_f32_dpp v197, v242, v67 row_newbcast:5 row_mask:0xf bank_mask:0xf
    v_mul_f32_dpp v198, v242, v66 row_newbcast:12 row_mask:0xf bank_mask:0xf
    v_mul_f32_dpp v199, v242, v67 row_newbcast:13 row_mask:0xf bank_mask:0xf
    v_mul_f32_dpp v200, v242, v70 row_newbcast:6 row_mask:0xf bank_mask:0xf
    v_mul_f32_dpp v201, v242, v71 row_newbcast:7 row_mask:0xf bank_mask:0xf
    v_mul_f32_dpp v202, v242, v70 row_newbcast:14 row_mask:0xf bank_mask:0xf
    v_mul_f32_dpp v203, v242, v71 row_newbcast:15 row_mask:0xf bank_mask:0xf
    v_cvt_pk_bf16_f32 v66, v196, v197
    v_cvt_pk_bf16_f32 v70, v198, v199
    v_cvt_pk_bf16_f32 v67, v200, v201
    v_cvt_pk_bf16_f32 v71, v202, v203
    s_mov_b64 exec, s[54:55]
    ds_read_u16_d16_hi v242, v250 offset:256
    s_mov_b64 exec, -1
    s_waitcnt vmcnt(4) lgkmcnt(3)
    v_mfma_f32_32x32x16_bf16 v[0:15], v[64:67], v[176:179], 0
    v_mul_f32_dpp v196, v243, v72 row_newbcast:0 row_mask:0xf bank_mask:0xf
    v_mul_f32_dpp v197, v243, v73 row_newbcast:1 row_mask:0xf bank_mask:0xf
    v_mul_f32_dpp v198, v243, v72 row_newbcast:8 row_mask:0xf bank_mask:0xf
    v_mul_f32_dpp v199, v243, v73 row_newbcast:9 row_mask:0xf bank_mask:0xf
    v_mul_f32_dpp v200, v243, v76 row_newbcast:2 row_mask:0xf bank_mask:0xf
    v_mul_f32_dpp v201, v243, v77 row_newbcast:3 row_mask:0xf bank_mask:0xf
    v_mul_f32_dpp v202, v243, v76 row_newbcast:10 row_mask:0xf bank_mask:0xf
    v_mul_f32_dpp v203, v243, v77 row_newbcast:11 row_mask:0xf bank_mask:0xf
    v_cvt_pk_bf16_f32 v72, v196, v197
    v_cvt_pk_bf16_f32 v76, v198, v199
    v_cvt_pk_bf16_f32 v73, v200, v201
    v_cvt_pk_bf16_f32 v77, v202, v203
    s_add_u32 m0, s21, 0
    v_mfma_f32_32x32x16_bf16 v[16:31], v[68:71], v[176:179], 0
    buffer_load_dwordx4 v236, s[4:7], s35 offen lds
    buffer_load_dwordx4 v237, s[8:11], s35 offen offset:1024 lds
    ds_read_b64_tr_b16 v[176:177], v244 offset:2048
    ds_read_b64_tr_b16 v[178:179], v244 offset:3072
    ds_read_b64_tr_b16 v[184:185], v245 offset:2048
    ds_read_b64_tr_b16 v[186:187], v245 offset:3072
    v_mul_f32_dpp v196, v243, v74 row_newbcast:4 row_mask:0xf bank_mask:0xf
    v_mul_f32_dpp v197, v243, v75 row_newbcast:5 row_mask:0xf bank_mask:0xf
    v_mul_f32_dpp v198, v243, v74 row_newbcast:12 row_mask:0xf bank_mask:0xf
    v_mul_f32_dpp v199, v243, v75 row_newbcast:13 row_mask:0xf bank_mask:0xf
    v_mul_f32_dpp v200, v243, v78 row_newbcast:6 row_mask:0xf bank_mask:0xf
    v_mul_f32_dpp v201, v243, v79 row_newbcast:7 row_mask:0xf bank_mask:0xf
    v_mul_f32_dpp v202, v243, v78 row_newbcast:14 row_mask:0xf bank_mask:0xf
    v_mul_f32_dpp v203, v243, v79 row_newbcast:15 row_mask:0xf bank_mask:0xf
    v_cvt_pk_bf16_f32 v74, v196, v197
    v_cvt_pk_bf16_f32 v78, v198, v199
    v_cvt_pk_bf16_f32 v75, v200, v201
    v_cvt_pk_bf16_f32 v79, v202, v203
    s_nop 0
    s_waitcnt vmcnt(4) lgkmcnt(0)
    v_mfma_f32_32x32x16_bf16 v[0:15], v[72:75], v[176:179], v[0:15]
    v_mul_f32_dpp v196, v242, v80 row_newbcast:0 row_mask:0xf bank_mask:0xf
    v_mul_f32_dpp v197, v242, v81 row_newbcast:1 row_mask:0xf bank_mask:0xf
    v_mul_f32_dpp v198, v242, v80 row_newbcast:8 row_mask:0xf bank_mask:0xf
    v_mul_f32_dpp v199, v242, v81 row_newbcast:9 row_mask:0xf bank_mask:0xf
    v_mul_f32_dpp v200, v242, v84 row_newbcast:2 row_mask:0xf bank_mask:0xf
    v_mul_f32_dpp v201, v242, v85 row_newbcast:3 row_mask:0xf bank_mask:0xf
    s_add_u32 m0, s21, 2048
    v_mfma_f32_32x32x16_bf16 v[16:31], v[76:79], v[176:179], v[16:31]
    buffer_load_dwordx4 v238, s[4:7], s35 offen lds
    ds_read_b64_tr_b16 v[176:177], v244 offset:4096
    ds_read_b64_tr_b16 v[188:189], v245 offset:4096
    v_mul_f32_dpp v202, v242, v84 row_newbcast:10 row_mask:0xf bank_mask:0xf
    v_mul_f32_dpp v203, v242, v85 row_newbcast:11 row_mask:0xf bank_mask:0xf
    v_cvt_pk_bf16_f32 v80, v196, v197
    v_cvt_pk_bf16_f32 v84, v198, v199
    v_cvt_pk_bf16_f32 v81, v200, v201
    v_cvt_pk_bf16_f32 v85, v202, v203
    s_nop 0
    s_waitcnt lgkmcnt(0)
    v_mfma_f32_32x32x8_bf16 v[0:15], v[80:81], v[176:177], v[0:15]
    s_add_u32 m0, s21, 4096
    v_mfma_f32_32x32x8_bf16 v[16:31], v[84:85], v[176:177], v[16:31]
    buffer_load_dwordx4 v234, s[4:7], s36 offen lds
    buffer_load_dwordx4 v235, s[8:11], s36 offen offset:1024 lds
    s_mov_b32 m0, s50
    s_nop 0
    s_movrels_b32 s71, s23
    s_bfe_u32 s46, s71, 0x30012
    s_mov_b32 m0, s46
    s_and_b32 s66, s71, 0x3ffff
    s_movrels_b32 s68, s57
    s_movrels_b32 s69, s61
    s_sub_u32 s48, s66, s47
    s_mov_b32 s47, s66
    s_lshr_b32 s52, s71, 28
    s_lshl_b32 s67, s46, 9
    s_add_u32 s66, s66, s67
    s_sub_u32 s49, s66, s42
    s_mov_b32 s42, s66
    s_bfe_u32 s66, s68, 655360
    s_add_u32 s43, s42, s66
    s_bfe_u32 s39, s69, 655360
    s_bfe_u32 s66, s68, 655370
    s_add_u32 s44, s42, s66
    s_bfe_u32 s40, s69, 655370
    s_bfe_u32 s66, s68, 655380
    s_add_u32 s45, s42, s66
    s_bfe_u32 s41, s69, 655380
    s_and_b32 s66, s46, s33
    s_cselect_b32 s72, -1, 1
    s_cselect_b32 s76, s47, 163712
    s_cmp_ge_u32 s66, 2
    s_cselect_b32 s73, -1, 0
    s_add_u32 s77, s47, 1024
    s_cmp_ge_u32 s66, 4
    s_cselect_b32 s75, -1, 0
    s_cmp_ge_u32 s66, 3
    s_cselect_b32 s74, -1, 1
    s_cselect_b32 s77, s77, 163712
    v_add_u32 v252, s45, v247
    ds_read_u16 v240, v252
    ds_read_u16 v241, v252 offset:64
    v_mfma_f32_32x32x16_bf16 v[32:47], v[64:67], v[180:183], 0
    v_mul_f32 v196, v0, v96
    v_fmac_f32 v196, v1, v97
    v_fmac_f32 v196, v2, v98
    v_fmac_f32 v196, v3, v99
    v_fmac_f32 v196, v4, v100
    v_fmac_f32 v196, v5, v101
    v_fmac_f32 v196, v6, v102
    v_mfma_f32_32x32x16_bf16 v[48:63], v[68:71], v[180:183], 0
    v_add_u32 v253, s47, v248
    ds_read_b32 v254, v253
    ds_read_b32 v255, v253 offset:256
    v_fmac_f32 v196, v7, v103
    v_mul_f32 v198, v8, v128
    v_fmac_f32 v198, v9, v129
    v_fmac_f32 v198, v10, v130
    v_fmac_f32 v198, v11, v131
    v_fmac_f32 v198, v12, v132
    v_mfma_f32_32x32x16_bf16 v[32:47], v[72:75], v[184:187], v[32:47]
    v_fmac_f32 v198, v13, v133
    v_fmac_f32 v198, v14, v134
    v_fmac_f32 v198, v15, v135
    v_mul_f32 v200, v16, v128
    v_fmac_f32 v200, v17, v129
    v_permlane32_swap_b32 v196, v198
    v_mfma_f32_32x32x16_bf16 v[48:63], v[76:79], v[184:187], v[48:63]
    s_waitcnt vmcnt(5)
    ds_read_b64_tr_b16 v[176:177], v244 offset:6144
    ds_read_b64_tr_b16 v[178:179], v244 offset:7168
    ds_read_b64_tr_b16 v[180:181], v245 offset:6144
    ds_read_b64_tr_b16 v[182:183], v245 offset:7168
    v_fmac_f32 v200, v18, v130
    v_fmac_f32 v200, v19, v131
    v_fmac_f32 v200, v20, v132
    v_fmac_f32 v200, v21, v133
    v_fmac_f32 v200, v22, v134
    v_fmac_f32 v200, v23, v135
    v_mfma_f32_32x32x8_bf16 v[32:47], v[80:81], v[188:189], v[32:47]
    v_add_f32 v198, v196, v198
    v_mul_f32_e64 v202, v24, -v128
    v_fma_f32 v202, v25, -v129, v202
    v_fma_f32 v202, v26, -v130, v202
    v_fma_f32 v202, v27, -v131, v202
    v_fma_f32 v202, v28, -v132, v202
    v_mfma_f32_32x32x8_bf16 v[48:63], v[84:85], v[188:189], v[48:63]
    v_fma_f32 v202, v29, -v133, v202
    v_fma_f32 v202, v30, -v134, v202
    v_fma_f32 v202, v31, -v135, v202
    s_nop 1
    v_permlane32_swap_b32 v200, v202
    v_add_f32 v202, v200, v202
    s_waitcnt vmcnt(3) lgkmcnt(0)
    v_mfma_f32_32x32x16_bf16 v[0:15], v[64:67], v[176:179], 0
    v_mul_f32 v197, v32, v104
    v_fmac_f32 v197, v33, v105
    v_fmac_f32 v197, v34, v106
    v_fmac_f32 v197, v35, v107
    v_fmac_f32 v197, v36, v108
    v_fmac_f32 v197, v37, v109
    v_fmac_f32 v197, v38, v110
    s_add_u32 m0, s21, 6144
    v_mfma_f32_32x32x16_bf16 v[16:31], v[68:71], v[176:179], 0
    buffer_load_dwordx4 v236, s[4:7], s36 offen lds
    buffer_load_dwordx4 v237, s[8:11], s36 offen offset:1024 lds
    ds_read_b64_tr_b16 v[176:177], v244 offset:0
    ds_read_b64_tr_b16 v[178:179], v244 offset:1024
    ds_read_b64_tr_b16 v[184:185], v245 offset:0
    ds_read_b64_tr_b16 v[186:187], v245 offset:1024
    s_mov_b32 m0, s76
    s_mov_b64 exec, s[72:73]
    buffer_load_dwordx4 v254, s[12:15], 0 offen  lds
    s_mov_b32 m0, s77
    s_mov_b64 exec, s[74:75]
    buffer_load_dwordx4 v255, s[12:15], 0 offen  lds
    s_mov_b64 exec, -1
    v_fmac_f32 v197, v39, v111
    v_mul_f32 v199, v40, v136
    v_fmac_f32 v199, v41, v137
    v_fmac_f32 v199, v42, v138
    v_fmac_f32 v199, v43, v139
    v_fmac_f32 v199, v44, v140
    v_fmac_f32 v199, v45, v141
    s_waitcnt vmcnt(6) lgkmcnt(0)
    v_mfma_f32_32x32x16_bf16 v[0:15], v[72:75], v[176:179], v[0:15]
    v_fmac_f32 v199, v46, v142
    v_fmac_f32 v199, v47, v143
    v_mul_f32 v201, v48, v136
    v_fmac_f32 v201, v49, v137
    v_permlane32_swap_b32 v197, v199
    v_fmac_f32 v201, v50, v138
    v_fmac_f32 v201, v51, v139
    s_add_u32 m0, s21, 0
    v_mfma_f32_32x32x16_bf16 v[16:31], v[76:79], v[176:179], v[16:31]
    buffer_load_dwordx4 v238, s[4:7], s36 offen lds
    ds_read_b64_tr_b16 v[176:177], v244 offset:2048
    ds_read_b64_tr_b16 v[188:189], v245 offset:2048
    v_fmac_f32 v201, v52, v140
    v_fmac_f32 v201, v53, v141
    v_fmac_f32 v201, v54, v142
    v_fmac_f32 v201, v55, v143
    v_add_f32 v199, v197, v199
    v_mul_f32_e64 v203, v56, -v136
    v_fma_f32 v203, v57, -v137, v203
    s_waitcnt lgkmcnt(0)
    v_mfma_f32_32x32x8_bf16 v[0:15], v[80:81], v[176:177], v[0:15]
    v_fma_f32 v203, v58, -v138, v203
    v_fma_f32 v203, v59, -v139, v203
    v_fma_f32 v203, v60, -v140, v203
    v_fma_f32 v203, v61, -v141, v203
    v_fma_f32 v203, v62, -v142, v203
    v_fma_f32 v203, v63, -v143, v203
    s_nop 1
    s_add_u32 m0, s21, 2048
    v_mfma_f32_32x32x8_bf16 v[16:31], v[84:85], v[176:177], v[16:31]
    buffer_load_dwordx4 v234, s[4:7], s37 offen lds
    buffer_load_dwordx4 v235, s[8:11], s37 offen offset:1024 lds
    v_add_u32 v252, s42, v247
    ds_read_u16 v234, v252
    ds_read_u16 v235, v252 offset:64
    v_permlane32_swap_b32 v201, v203
    v_add_f32 v203, v201, v203
    s_set_gpr_idx_on s51, gpr_idx(DST)
    s_nop 0
    v_cvt_pk_bf16_f32 v204, v198, v199
    v_cvt_pk_bf16_f32 v205, v202, v203
    s_set_gpr_idx_off
    v_mfma_f32_32x32x16_bf16 v[32:47], v[64:67], v[180:183], 0
    v_mul_f32 v196, v0, v144
    v_fmac_f32 v196, v1, v145
    v_fmac_f32 v196, v2, v146
    v_fmac_f32 v196, v3, v147
    v_fmac_f32 v196, v4, v148
    v_fmac_f32 v196, v5, v149
    v_mfma_f32_32x32x16_bf16 v[48:63], v[68:71], v[180:183], 0
    v_fmac_f32 v196, v6, v150
    v_fmac_f32 v196, v7, v151
    v_mul_f32 v198, v8, v112
    v_fmac_f32 v198, v9, v113
    v_fmac_f32 v198, v10, v114
    v_mfma_f32_32x32x16_bf16 v[32:47], v[72:75], v[184:187], v[32:47]
    v_fmac_f32 v198, v11, v115
    v_fmac_f32 v198, v12, v116
    v_fmac_f32 v198, v13, v117
    v_fmac_f32 v198, v14, v118
    v_fmac_f32 v198, v15, v119
    v_mfma_f32_32x32x16_bf16 v[48:63], v[76:79], v[184:187], v[48:63]
    s_waitcnt vmcnt(7)
    ds_read_b64_tr_b16 v[176:177], v244 offset:4096
    ds_read_b64_tr_b16 v[178:179], v244 offset:5120
    ds_read_b64_tr_b16 v[180:181], v245 offset:4096
    ds_read_b64_tr_b16 v[182:183], v245 offset:5120
    v_mul_f32_e64 v200, v16, -v160
    v_fma_f32 v200, v17, -v161, v200
    v_fma_f32 v200, v18, -v162, v200
    v_fma_f32 v200, v19, -v163, v200
    v_fma_f32 v200, v20, -v164, v200
    v_fma_f32 v200, v21, -v165, v200
    v_mfma_f32_32x32x8_bf16 v[32:47], v[80:81], v[188:189], v[32:47]
    v_fma_f32 v200, v22, -v166, v200
    v_fma_f32 v200, v23, -v167, v200
    v_mul_f32_e64 v202, v24, -v160
    v_fma_f32 v202, v25, -v161, v202
    v_fma_f32 v202, v26, -v162, v202
    v_mfma_f32_32x32x8_bf16 v[48:63], v[84:85], v[188:189], v[48:63]
    v_fma_f32 v202, v27, -v163, v202
    v_fma_f32 v202, v28, -v164, v202
    v_fma_f32 v202, v29, -v165, v202
    v_fma_f32 v202, v30, -v166, v202
    v_fma_f32 v202, v31, -v167, v202
    s_waitcnt vmcnt(5) lgkmcnt(0)
    v_mfma_f32_32x32x16_bf16 v[0:15], v[64:67], v[176:179], 0
    v_mul_f32 v197, v32, v152
    v_fmac_f32 v197, v33, v153
    v_fmac_f32 v197, v34, v154
    v_fmac_f32 v197, v35, v155
    v_fmac_f32 v197, v36, v156
    v_fmac_f32 v197, v37, v157
    s_add_u32 m0, s21, 4096
    v_mfma_f32_32x32x16_bf16 v[16:31], v[68:71], v[176:179], 0
    buffer_load_dwordx4 v236, s[4:7], s37 offen lds
    buffer_load_dwordx4 v237, s[8:11], s37 offen offset:1024 lds
    ds_read_b64_tr_b16 v[176:177], v244 offset:6144
    ds_read_b64_tr_b16 v[178:179], v244 offset:7168
    ds_read_b64_tr_b16 v[184:185], v245 offset:6144
    ds_read_b64_tr_b16 v[186:187], v245 offset:7168
    v_add_u32 v252, s43, v247
    ds_read_u16 v236, v252
    ds_read_u16 v237, v252 offset:64
    v_fmac_f32 v197, v38, v158
    v_fmac_f32 v197, v39, v159
    v_mul_f32 v199, v40, v120
    v_fmac_f32 v199, v41, v121
    v_fmac_f32 v199, v42, v122
    s_waitcnt vmcnt(4) lgkmcnt(2)
    v_mfma_f32_32x32x16_bf16 v[0:15], v[72:75], v[176:179], v[0:15]
    v_fmac_f32 v199, v43, v123
    v_fmac_f32 v199, v44, v124
    v_fmac_f32 v199, v45, v125
    v_fmac_f32 v199, v46, v126
    v_fmac_f32 v199, v47, v127
    s_add_u32 m0, s21, 6144
    v_mfma_f32_32x32x16_bf16 v[16:31], v[76:79], v[176:179], v[16:31]
    buffer_load_dwordx4 v238, s[4:7], s37 offen lds
    ds_read_b64_tr_b16 v[176:177], v244 offset:0
    ds_read_b64_tr_b16 v[188:189], v245 offset:0
    v_add_u32 v252, s44, v247
    ds_read_u16 v238, v252
    ds_read_u16 v239, v252 offset:64
    v_mul_f32_e64 v201, v48, -v168
    v_fma_f32 v201, v49, -v169, v201
    v_fma_f32 v201, v50, -v170, v201
    v_fma_f32 v201, v51, -v171, v201
    v_fma_f32 v201, v52, -v172, v201
    v_fma_f32 v201, v53, -v173, v201
    s_waitcnt lgkmcnt(2)
    v_mfma_f32_32x32x8_bf16 v[0:15], v[80:81], v[176:177], v[0:15]
    v_fma_f32 v201, v54, -v174, v201
    v_fma_f32 v201, v55, -v175, v201
    v_mul_f32_e64 v203, v56, -v168
    v_fma_f32 v203, v57, -v169, v203
    v_fma_f32 v203, v58, -v170, v203
    s_add_u32 m0, s21, 0
    v_mfma_f32_32x32x8_bf16 v[16:31], v[84:85], v[176:177], v[16:31]
    v_lshl_add_u32 v234, v234, 10, v246
    v_lshl_add_u32 v235, v235, 10, v246
    buffer_load_dwordx4 v234, s[4:7], s38 offen lds
    buffer_load_dwordx4 v235, s[8:11], s38 offen offset:1024 lds
    v_fma_f32 v203, v59, -v171, v203
    v_fma_f32 v203, v60, -v172, v203
    v_fma_f32 v203, v61, -v173, v203
    v_fma_f32 v203, v62, -v174, v203
    v_fma_f32 v203, v63, -v175, v203
    v_mfma_f32_32x32x16_bf16 v[32:47], v[64:67], v[180:183], 0
    v_mul_f32 v254, v0, v144
    v_fmac_f32 v254, v1, v145
    v_fmac_f32 v254, v2, v146
    v_mfma_f32_32x32x16_bf16 v[48:63], v[68:71], v[180:183], 0
    ds_swizzle_b32 v68, v68 offset:0x401F
    ds_swizzle_b32 v69, v69 offset:0x401F
    ds_swizzle_b32 v70, v70 offset:0x401F
    ds_swizzle_b32 v71, v71 offset:0x401F
    v_fmac_f32 v254, v3, v147
    v_fmac_f32 v254, v4, v148
    v_fmac_f32 v254, v5, v149
    v_mfma_f32_32x32x16_bf16 v[32:47], v[72:75], v[184:187], v[32:47]
    v_fmac_f32 v254, v6, v150
    v_fmac_f32 v254, v7, v151
    v_fmac_f32 v200, v8, v160
    v_mfma_f32_32x32x16_bf16 v[48:63], v[76:79], v[184:187], v[48:63]
    ds_swizzle_b32 v76, v76 offset:0x401F
    ds_swizzle_b32 v77, v77 offset:0x401F
    ds_swizzle_b32 v78, v78 offset:0x401F
    ds_swizzle_b32 v79, v79 offset:0x401F
    s_waitcnt vmcnt(5)
    ds_read_b64_tr_b16 v[176:177], v244 offset:2048
    ds_read_b64_tr_b16 v[178:179], v244 offset:3072
    ds_read_b64_tr_b16 v[180:181], v245 offset:2048
    ds_read_b64_tr_b16 v[182:183], v245 offset:3072
    v_fmac_f32 v200, v9, v161
    v_permlane32_swap_b32 v196, v254
    v_fmac_f32 v200, v10, v162
    v_mfma_f32_32x32x8_bf16 v[32:47], v[80:81], v[188:189], v[32:47]
    v_fmac_f32 v200, v11, v163
    v_fmac_f32 v200, v12, v164
    v_fmac_f32 v200, v13, v165
    v_mfma_f32_32x32x8_bf16 v[48:63], v[84:85], v[188:189], v[48:63]
    ds_swizzle_b32 v84, v84 offset:0x401F
    ds_swizzle_b32 v85, v85 offset:0x401F
    v_fmac_f32 v200, v14, v166
    v_fmac_f32 v200, v15, v167
    v_add_f32 v254, v196, v254
    s_waitcnt lgkmcnt(6)
    s_mov_b64 exec, s[56:57]
    v_xor_b32 v68, 0x80008000, v68
    v_xor_b32 v69, 0x80008000, v69
    v_xor_b32 v70, 0x80008000, v70
    v_xor_b32 v71, 0x80008000, v71
    v_xor_b32 v76, 0x80008000, v76
    v_xor_b32 v77, 0x80008000, v77
    v_xor_b32 v78, 0x80008000, v78
    v_xor_b32 v79, 0x80008000, v79
    s_mov_b64 exec, -1
    s_waitcnt vmcnt(3) lgkmcnt(2)
    v_mfma_f32_32x32x16_bf16 v[0:15], v[64:67], v[176:179], 0
    v_mul_f32 v255, v32, v152
    v_fmac_f32 v255, v33, v153
    v_fmac_f32 v255, v34, v154
    v_fmac_f32 v255, v35, v155
    s_add_u32 m0, s21, 2048
    v_mfma_f32_32x32x16_bf16 v[16:31], v[68:71], v[176:179], v[16:31]
    v_lshl_add_u32 v236, v236, 10, v246
    v_lshl_add_u32 v237, v237, 10, v246
    buffer_load_dwordx4 v236, s[4:7], s39 offen lds
    buffer_load_dwordx4 v237, s[8:11], s39 offen offset:1024 lds
    ds_read_b64_tr_b16 v[176:177], v244 offset:4096
    ds_read_b64_tr_b16 v[178:179], v244 offset:5120
    ds_read_b64_tr_b16 v[184:185], v245 offset:4096
    ds_read_b64_tr_b16 v[186:187], v245 offset:5120
    v_fmac_f32 v255, v36, v156
    v_fmac_f32 v255, v37, v157
    v_fmac_f32 v255, v38, v158
    v_fmac_f32 v255, v39, v159
    s_waitcnt vmcnt(4) lgkmcnt(0)
    v_mfma_f32_32x32x16_bf16 v[0:15], v[72:75], v[176:179], v[0:15]
    v_fmac_f32 v201, v40, v168
    v_fmac_f32 v201, v41, v169
    v_permlane32_swap_b32 v197, v255
    s_add_u32 m0, s21, 4096
    v_mfma_f32_32x32x16_bf16 v[16:31], v[76:79], v[176:179], v[16:31]
    v_lshl_add_u32 v238, v238, 10, v246
    v_lshl_add_u32 v239, v239, 10, v246
    buffer_load_dwordx4 v238, s[4:7], s40 offen lds
    buffer_load_dwordx4 v239, s[8:11], s40 offen offset:1024 lds
    ds_read_b64_tr_b16 v[176:177], v244 offset:6144
    ds_read_b64_tr_b16 v[188:189], v245 offset:6144
    v_fmac_f32 v201, v42, v170
    v_fmac_f32 v201, v43, v171
    v_fmac_f32 v201, v44, v172
    v_fmac_f32 v201, v45, v173
    s_waitcnt lgkmcnt(0)
    s_mov_b64 exec, s[56:57]
    v_xor_b32 v84, 0x80008000, v84
    v_xor_b32 v85, 0x80008000, v85
    s_mov_b64 exec, -1
    v_mfma_f32_32x32x8_bf16 v[0:15], v[80:81], v[176:177], v[0:15]
    v_fmac_f32 v201, v46, v174
    v_fmac_f32 v201, v47, v175
    v_add_f32 v255, v197, v255
    s_set_gpr_idx_on s51, gpr_idx(DST)
    s_nop 0
    v_cvt_pk_bf16_f32 v206, v254, v255
    s_set_gpr_idx_off
    s_add_u32 m0, s21, 6144
    v_mfma_f32_32x32x8_bf16 v[16:31], v[84:85], v[176:177], v[16:31]
    v_lshl_add_u32 v240, v240, 10, v246
    v_lshl_add_u32 v241, v241, 10, v246
    buffer_load_dwordx4 v240, s[4:7], s41 offen lds
    buffer_load_dwordx4 v241, s[8:11], s41 offen offset:1024 lds
    v_mfma_f32_32x32x16_bf16 v[32:47], v[64:67], v[180:183], 0
    v_mul_f32 v254, v0, v144
    v_fmac_f32 v254, v1, v145
    v_fmac_f32 v254, v2, v146
    v_fmac_f32 v254, v3, v147
    v_fmac_f32 v254, v4, v148
    v_fmac_f32 v254, v5, v149
    v_fmac_f32 v254, v6, v150
    v_mfma_f32_32x32x16_bf16 v[48:63], v[68:71], v[180:183], v[48:63]
    v_fmac_f32 v254, v7, v151
    v_fma_f32 v202, v8, -v160, v202
    v_fma_f32 v202, v9, -v161, v202
    v_permlane32_swap_b32 v254, v200
    v_fma_f32 v202, v10, -v162, v202
    v_fma_f32 v202, v11, -v163, v202
    v_mfma_f32_32x32x16_bf16 v[32:47], v[72:75], v[184:187], v[32:47]
    v_fma_f32 v202, v12, -v164, v202
    v_fma_f32 v202, v13, -v165, v202
    v_fma_f32 v202, v14, -v166, v202
    v_fma_f32 v202, v15, -v167, v202
    v_add_f32 v200, v254, v200
    v_fmac_f32 v198, v16, v112
    v_permlane32_swap_b32 v202, v254
    v_mfma_f32_32x32x16_bf16 v[48:63], v[76:79], v[184:187], v[48:63]
    s_waitcnt vmcnt(6)
    ds_read_b64_tr_b16 v[176:177], v244 offset:0
    ds_read_b64_tr_b16 v[178:179], v244 offset:1024
    ds_read_b64_tr_b16 v[180:181], v245 offset:0
    ds_read_b64_tr_b16 v[182:183], v245 offset:1024
    v_fmac_f32 v198, v17, v113
    v_fmac_f32 v198, v18, v114
    v_fmac_f32 v198, v19, v115
    v_fmac_f32 v198, v20, v116
    v_fmac_f32 v198, v21, v117
    v_fmac_f32 v198, v22, v118
    v_mfma_f32_32x32x8_bf16 v[32:47], v[80:81], v[188:189], v[32:47]
    v_fmac_f32 v198, v23, v119
    v_add_f32 v254, v202, v254
    v_mul_f32 v196, v24, v160
    v_fmac_f32 v196, v25, v161
    v_fmac_f32 v196, v26, v162
    v_fmac_f32 v196, v27, v163
    v_fmac_f32 v196, v28, v164
    v_mfma_f32_32x32x8_bf16 v[48:63], v[84:85], v[188:189], v[48:63]
    v_add_u32 v249, s48, v249
    v_add_u32 v250, s49, v250
    ds_read_b32 v252, v251 offset:16
    ds_read_b64_tr_b16 v[64:65], v249 offset:0
    ds_read_b64_tr_b16 v[68:69], v249 offset:64
    ds_read_b64_tr_b16 v[66:67], v249 offset:256
    ds_read_b64_tr_b16 v[70:71], v249 offset:320
    s_mov_b64 exec, s[54:55]
    ds_read_u16_d16_hi v242, v250 offset:0
    s_mov_b64 exec, -1
    v_fmac_f32 v196, v29, v165
    v_fmac_f32 v196, v30, v166
    v_fmac_f32 v196, v31, v167
    s_nop 1
    v_permlane32_swap_b32 v198, v196
    v_add_f32 v196, v198, v196
    v_mul_f32 v255, v32, v152
    v_fmac_f32 v255, v33, v153
    v_fmac_f32 v255, v34, v154
    v_fmac_f32 v255, v35, v155
    v_fmac_f32 v255, v36, v156
    v_fmac_f32 v255, v37, v157
    v_fmac_f32 v255, v38, v158
    v_fmac_f32 v255, v39, v159
    v_fma_f32 v203, v40, -v168, v203
    v_fma_f32 v203, v41, -v169, v203
    v_permlane32_swap_b32 v255, v201
    v_fma_f32 v203, v42, -v170, v203
    v_fma_f32 v203, v43, -v171, v203
    v_fma_f32 v203, v44, -v172, v203
    v_fma_f32 v203, v45, -v173, v203
    v_fma_f32 v203, v46, -v174, v203
    v_fma_f32 v203, v47, -v175, v203
    v_add_f32 v201, v255, v201
    v_fmac_f32 v199, v48, v120
    v_permlane32_swap_b32 v203, v255
    v_fmac_f32 v199, v49, v121
    v_fmac_f32 v199, v50, v122
    v_fmac_f32 v199, v51, v123
    v_fmac_f32 v199, v52, v124
    v_fmac_f32 v199, v53, v125
    v_fmac_f32 v199, v54, v126
    v_fmac_f32 v199, v55, v127
    v_add_f32 v255, v203, v255
    v_mul_f32 v197, v56, v168
    v_fmac_f32 v197, v57, v169
    v_fmac_f32 v197, v58, v170
    v_fmac_f32 v197, v59, v171
    v_fmac_f32 v197, v60, v172
    v_fmac_f32 v197, v61, v173
    v_fmac_f32 v197, v62, v174
    v_fmac_f32 v197, v63, v175
    s_nop 1
    v_permlane32_swap_b32 v199, v197
    v_add_f32 v197, v199, v197
    s_set_gpr_idx_on s51, gpr_idx(DST)
    s_nop 0
    v_cvt_pk_bf16_f32 v207, v200, v201
    v_cvt_pk_bf16_f32 v209, v254, v255
    v_cvt_pk_bf16_f32 v208, v196, v197
    s_set_gpr_idx_off
    s_add_u32 s50, s50, 1
    s_add_u32 s51, s51, 6
    s_cmp_ge_u32 s50, 4
    s_cbranch_scc1 LAST0
    s_waitcnt lgkmcnt(5)
    v_readfirstlane_b32 s66, v252
    s_add_u32 s53, s53, 1
    v_mov_b32 v252, s53
    s_cmp_le_u32 s53, s66
    ds_write2_b32 v251, v252, v252 offset0:0 offset1:8
    s_setprio 1
    s_cbranch_scc1 PRIO_6
    s_setprio 0
PRIO_6:
    s_cmp_eq_u32 s52, 4
    s_cbranch_scc1 ITEM_0_4
    s_cmp_eq_u32 s52, 5
    s_cbranch_scc1 ITEM_0_5
    s_cmp_eq_u32 s52, 3
    s_cbranch_scc1 ITEM_0_3
    s_cmp_eq_u32 s52, 6
    s_cbranch_scc1 ITEM_0_6
    s_cmp_eq_u32 s52, 8
    s_cbranch_scc1 ITEM_0_8
    s_branch ITEM_0_2
.p2align 6
ITEM_0_3:
    s_mov_b64 exec, s[54:55]
    ds_read_u16_d16_hi v243, v250 offset:128
    s_mov_b64 exec, -1
    ds_read_b64_tr_b16 v[72:73], v249 offset:512
    ds_read_b64_tr_b16 v[76:77], v249 offset:576
    s_waitcnt lgkmcnt(3)
    v_mul_f32_dpp v196, v242, v64 row_newbcast:0 row_mask:0xf bank_mask:0xf
    v_mul_f32_dpp v197, v242, v65 row_newbcast:1 row_mask:0xf bank_mask:0xf
    v_mul_f32_dpp v198, v242, v64 row_newbcast:8 row_mask:0xf bank_mask:0xf
    v_mul_f32_dpp v199, v242, v65 row_newbcast:9 row_mask:0xf bank_mask:0xf
    v_mul_f32_dpp v200, v242, v68 row_newbcast:2 row_mask:0xf bank_mask:0xf
    v_mul_f32_dpp v201, v242, v69 row_newbcast:3 row_mask:0xf bank_mask:0xf
    v_mul_f32_dpp v202, v242, v68 row_newbcast:10 row_mask:0xf bank_mask:0xf
    v_mul_f32_dpp v203, v242, v69 row_newbcast:11 row_mask:0xf bank_mask:0xf
    v_cvt_pk_bf16_f32 v64, v196, v197
    v_cvt_pk_bf16_f32 v68, v198, v199
    v_cvt_pk_bf16_f32 v65, v200, v201
    v_cvt_pk_bf16_f32 v69, v202, v203
    v_mul_f32_dpp v196, v242, v66 row_newbcast:4 row_mask:0xf bank_mask:0xf
    v_mul_f32_dpp v197, v242, v67 row_newbcast:5 row_mask:0xf bank_mask:0xf
    v_mul_f32_dpp v198, v242, v66 row_newbcast:12 row_mask:0xf bank_mask:0xf
    v_mul_f32_dpp v199, v242, v67 row_newbcast:13 row_mask:0xf bank_mask:0xf
    v_mul_f32_dpp v200, v242, v70 row_newbcast:6 row_mask:0xf bank_mask:0xf
    v_mul_f32_dpp v201, v242, v71 row_newbcast:7 row_mask:0xf bank_mask:0xf
    v_mul_f32_dpp v202, v242, v70 row_newbcast:14 row_mask:0xf bank_mask:0xf
    v_mul_f32_dpp v203, v242, v71 row_newbcast:15 row_mask:0xf bank_mask:0xf
    v_cvt_pk_bf16_f32 v66, v196, v197
    v_cvt_pk_bf16_f32 v70, v198, v199
    v_cvt_pk_bf16_f32 v67, v200, v201
    v_cvt_pk_bf16_f32 v71, v202, v203
    s_nop 0
    s_waitcnt vmcnt(4) lgkmcnt(0)
    v_mfma_f32_32x32x16_bf16 v[0:15], v[64:67], v[176:179], 0
    v_mul_f32_dpp v196, v243, v72 row_newbcast:0 row_mask:0xf bank_mask:0xf
    v_mul_f32_dpp v197, v243, v73 row_newbcast:1 row_mask:0xf bank_mask:0xf
    v_mul_f32_dpp v198, v243, v72 row_newbcast:8 row_mask:0xf bank_mask:0xf
    v_mul_f32_dpp v199, v243, v73 row_newbcast:9 row_mask:0xf bank_mask:0xf
    v_mul_f32_dpp v200, v243, v76 row_newbcast:2 row_mask:0xf bank_mask:0xf
    v_mul_f32_dpp v201, v243, v77 row_newbcast:3 row_mask:0xf bank_mask:0xf
    s_add_u32 m0, s21, 0
    v_mfma_f32_32x32x16_bf16 v[16:31], v[68:71], v[176:179], 0
    buffer_load_dwordx4 v234, s[4:7], s36 offen lds
    buffer_load_dwordx4 v235, s[8:11], s36 offen offset:1024 lds
    ds_read_b64_tr_b16 v[176:177], v244 offset:2048
    ds_read_b64_tr_b16 v[184:185], v245 offset:2048
    v_mul_f32_dpp v202, v243, v76 row_newbcast:10 row_mask:0xf bank_mask:0xf
    v_mul_f32_dpp v203, v243, v77 row_newbcast:11 row_mask:0xf bank_mask:0xf
    v_cvt_pk_bf16_f32 v72, v196, v197
    v_cvt_pk_bf16_f32 v76, v198, v199
    v_cvt_pk_bf16_f32 v73, v200, v201
    v_cvt_pk_bf16_f32 v77, v202, v203
    s_nop 0
    s_waitcnt lgkmcnt(0)
    v_mfma_f32_32x32x8_bf16 v[0:15], v[72:73], v[176:177], v[0:15]
    s_add_u32 m0, s21, 2048
    v_mfma_f32_32x32x8_bf16 v[16:31], v[76:77], v[176:177], v[16:31]
    buffer_load_dwordx4 v236, s[4:7], s36 offen lds
    s_mov_b32 m0, s50
    s_nop 0
    s_movrels_b32 s71, s23
    s_bfe_u32 s46, s71, 0x30012
    s_mov_b32 m0, s46
    s_and_b32 s66, s71, 0x3ffff
    s_movrels_b32 s68, s57
    s_movrels_b32 s69, s61
    s_sub_u32 s48, s66, s47
    s_mov_b32 s47, s66
    s_lshr_b32 s52, s71, 28
    s_lshl_b32 s67, s46, 9
    s_add_u32 s66, s66, s67
    s_sub_u32 s49, s66, s42
    s_mov_b32 s42, s66
    s_bfe_u32 s66, s68, 655360
    s_add_u32 s43, s42, s66
    s_bfe_u32 s39, s69, 655360
    s_bfe_u32 s66, s68, 655370
    s_add_u32 s44, s42, s66
    s_bfe_u32 s40, s69, 655370
    s_bfe_u32 s66, s68, 655380
    s_add_u32 s45, s42, s66
    s_bfe_u32 s41, s69, 655380
    s_and_b32 s66, s46, s33
    s_cselect_b32 s72, -1, 1
    s_cselect_b32 s76, s47, 163712
    s_cmp_ge_u32 s66, 2
    s_cselect_b32 s73, -1, 0
    s_add_u32 s77, s47, 1024
    s_cmp_ge_u32 s66, 4
    s_cselect_b32 s75, -1, 0
    s_cmp_ge_u32 s66, 3
    s_cselect_b32 s74, -1, 1
    s_cselect_b32 s77, s77, 163712
    v_add_u32 v252, s44, v247
    ds_read_u16 v238, v252
    ds_read_u16 v239, v252 offset:64
    v_add_u32 v252, s45, v247
    ds_read_u16 v240, v252
    ds_read_u16 v241, v252 offset:64
    v_mfma_f32_32x32x16_bf16 v[32:47], v[64:67], v[180:183], 0
    v_mul_f32 v196, v0, v96
    v_fmac_f32 v196, v1, v97
    v_fmac_f32 v196, v2, v98
    v_fmac_f32 v196, v3, v99
    v_fmac_f32 v196, v4, v100
    v_fmac_f32 v196, v5, v101
    v_fmac_f32 v196, v6, v102
    v_fmac_f32 v196, v7, v103
    v_mul_f32 v198, v8, v128
    v_fmac_f32 v198, v9, v129
    v_mfma_f32_32x32x16_bf16 v[48:63], v[68:71], v[180:183], 0
    v_add_u32 v253, s47, v248
    ds_read_b32 v254, v253
    ds_read_b32 v255, v253 offset:256
    s_waitcnt vmcnt(5)
    ds_read_b64_tr_b16 v[176:177], v244 offset:4096
    ds_read_b64_tr_b16 v[178:179], v244 offset:5120
    ds_read_b64_tr_b16 v[180:181], v245 offset:4096
    ds_read_b64_tr_b16 v[182:183], v245 offset:5120
    v_fmac_f32 v198, v10, v130
    v_fmac_f32 v198, v11, v131
    v_fmac_f32 v198, v12, v132
    v_fmac_f32 v198, v13, v133
    v_fmac_f32 v198, v14, v134
    v_fmac_f32 v198, v15, v135
    v_mul_f32 v200, v16, v128
    v_fmac_f32 v200, v17, v129
    v_permlane32_swap_b32 v196, v198
    v_mfma_f32_32x32x8_bf16 v[32:47], v[72:73], v[184:185], v[32:47]
    v_fmac_f32 v200, v18, v130
    v_fmac_f32 v200, v19, v131
    v_fmac_f32 v200, v20, v132
    v_fmac_f32 v200, v21, v133
    v_fmac_f32 v200, v22, v134
    v_fmac_f32 v200, v23, v135
    v_add_f32 v198, v196, v198
    v_mul_f32_e64 v202, v24, -v128
    v_fma_f32 v202, v25, -v129, v202
    v_mfma_f32_32x32x8_bf16 v[48:63], v[76:77], v[184:185], v[48:63]
    v_fma_f32 v202, v26, -v130, v202
    v_fma_f32 v202, v27, -v131, v202
    v_fma_f32 v202, v28, -v132, v202
    v_fma_f32 v202, v29, -v133, v202
    v_fma_f32 v202, v30, -v134, v202
    v_fma_f32 v202, v31, -v135, v202
    s_nop 1
    v_permlane32_swap_b32 v200, v202
    v_add_f32 v202, v200, v202
    s_waitcnt vmcnt(3) lgkmcnt(0)
    v_mfma_f32_32x32x16_bf16 v[0:15], v[64:67], v[176:179], 0
    v_mul_f32 v197, v32, v104
    v_fmac_f32 v197, v33, v105
    v_fmac_f32 v197, v34, v106
    v_fmac_f32 v197, v35, v107
    v_fmac_f32 v197, v36, v108
    v_fmac_f32 v197, v37, v109
    v_fmac_f32 v197, v38, v110
    v_fmac_f32 v197, v39, v111
    v_mul_f32 v199, v40, v136
    v_fmac_f32 v199, v41, v137
    v_fmac_f32 v199, v42, v138
    s_add_u32 m0, s21, 4096
    v_mfma_f32_32x32x16_bf16 v[16:31], v[68:71], v[176:179], 0
    buffer_load_dwordx4 v234, s[4:7], s37 offen lds
    buffer_load_dwordx4 v235, s[8:11], s37 offen offset:1024 lds
    ds_read_b64_tr_b16 v[176:177], v244 offset:6144
    ds_read_b64_tr_b16 v[184:185], v245 offset:6144
    v_add_u32 v252, s42, v247
    ds_read_u16 v234, v252
    ds_read_u16 v235, v252 offset:64
    s_mov_b32 m0, s76
    s_mov_b64 exec, s[72:73]
    buffer_load_dwordx4 v254, s[12:15], 0 offen  lds
    s_mov_b32 m0, s77
    s_mov_b64 exec, s[74:75]
    buffer_load_dwordx4 v255, s[12:15], 0 offen  lds
    s_mov_b64 exec, -1
    v_fmac_f32 v199, v43, v139
    v_fmac_f32 v199, v44, v140
    v_fmac_f32 v199, v45, v141
    v_fmac_f32 v199, v46, v142
    v_fmac_f32 v199, v47, v143
    v_mul_f32 v201, v48, v136
    v_fmac_f32 v201, v49, v137
    v_permlane32_swap_b32 v197, v199
    v_fmac_f32 v201, v50, v138
    v_fmac_f32 v201, v51, v139
    s_waitcnt lgkmcnt(2)
    v_mfma_f32_32x32x8_bf16 v[0:15], v[72:73], v[176:177], v[0:15]
    v_fmac_f32 v201, v52, v140
    v_fmac_f32 v201, v53, v141
    v_fmac_f32 v201, v54, v142
    v_fmac_f32 v201, v55, v143
    v_add_f32 v199, v197, v199
    v_mul_f32_e64 v203, v56, -v136
    v_fma_f32 v203, v57, -v137, v203
    v_fma_f32 v203, v58, -v138, v203
    v_fma_f32 v203, v59, -v139, v203
    v_fma_f32 v203, v60, -v140, v203
    v_fma_f32 v203, v61, -v141, v203
    s_add_u32 m0, s21, 6144
    v_mfma_f32_32x32x8_bf16 v[16:31], v[76:77], v[176:177], v[16:31]
    buffer_load_dwordx4 v236, s[4:7], s37 offen lds
    v_add_u32 v252, s43, v247
    ds_read_u16 v236, v252
    ds_read_u16 v237, v252 offset:64
    v_fma_f32 v203, v62, -v142, v203
    v_fma_f32 v203, v63, -v143, v203
    s_nop 1
    v_permlane32_swap_b32 v201, v203
    v_add_f32 v203, v201, v203
    s_set_gpr_idx_on s51, gpr_idx(DST)
    s_nop 0
    v_cvt_pk_bf16_f32 v204, v198, v199
    v_cvt_pk_bf16_f32 v205, v202, v203
    s_set_gpr_idx_off
    v_mfma_f32_32x32x16_bf16 v[32:47], v[64:67], v[180:183], 0
    v_mul_f32 v196, v0, v144
    v_fmac_f32 v196, v1, v145
    v_fmac_f32 v196, v2, v146
    v_fmac_f32 v196, v3, v147
    v_fmac_f32 v196, v4, v148
    v_fmac_f32 v196, v5, v149
    v_fmac_f32 v196, v6, v150
    v_fmac_f32 v196, v7, v151
    v_mfma_f32_32x32x16_bf16 v[48:63], v[68:71], v[180:183], 0
    s_waitcnt vmcnt(6)
    ds_read_b64_tr_b16 v[176:177], v244 offset:0
    ds_read_b64_tr_b16 v[178:179], v244 offset:1024
    ds_read_b64_tr_b16 v[180:181], v245 offset:0
    ds_read_b64_tr_b16 v[182:183], v245 offset:1024
    v_mul_f32 v198, v8, v112
    v_fmac_f32 v198, v9, v113
    v_fmac_f32 v198, v10, v114
    v_fmac_f32 v198, v11, v115
    v_fmac_f32 v198, v12, v116
    v_fmac_f32 v198, v13, v117
    v_fmac_f32 v198, v14, v118
    v_fmac_f32 v198, v15, v119
    v_mfma_f32_32x32x8_bf16 v[32:47], v[72:73], v[184:185], v[32:47]
    v_mul_f32_e64 v200, v16, -v160
    v_fma_f32 v200, v17, -v161, v200
    v_fma_f32 v200, v18, -v162, v200
    v_fma_f32 v200, v19, -v163, v200
    v_fma_f32 v200, v20, -v164, v200
    v_fma_f32 v200, v21, -v165, v200
    v_fma_f32 v200, v22, -v166, v200
    v_fma_f32 v200, v23, -v167, v200
    v_mfma_f32_32x32x8_bf16 v[48:63], v[76:77], v[184:185], v[48:63]
    v_mul_f32_e64 v202, v24, -v160
    v_fma_f32 v202, v25, -v161, v202
    v_fma_f32 v202, v26, -v162, v202
    v_fma_f32 v202, v27, -v163, v202
    v_fma_f32 v202, v28, -v164, v202
    v_fma_f32 v202, v29, -v165, v202
    v_fma_f32 v202, v30, -v166, v202
    v_fma_f32 v202, v31, -v167, v202
    s_waitcnt vmcnt(5) lgkmcnt(0)
    v_mfma_f32_32x32x16_bf16 v[0:15], v[64:67], v[176:179], 0
    v_mul_f32 v197, v32, v152
    v_fmac_f32 v197, v33, v153
    v_fmac_f32 v197, v34, v154
    v_fmac_f32 v197, v35, v155
    v_fmac_f32 v197, v36, v156
    v_fmac_f32 v197, v37, v157
    v_fmac_f32 v197, v38, v158
    v_fmac_f32 v197, v39, v159
    s_add_u32 m0, s21, 0
    v_mfma_f32_32x32x16_bf16 v[16:31], v[68:71], v[176:179], 0
    v_lshl_add_u32 v234, v234, 10, v246
    v_lshl_add_u32 v235, v235, 10, v246
    buffer_load_dwordx4 v234, s[4:7], s38 offen lds
    buffer_load_dwordx4 v235, s[8:11], s38 offen offset:1024 lds
    ds_read_b64_tr_b16 v[176:177], v244 offset:2048
    ds_read_b64_tr_b16 v[184:185], v245 offset:2048
    v_mul_f32 v199, v40, v120
    v_fmac_f32 v199, v41, v121
    v_fmac_f32 v199, v42, v122
    v_fmac_f32 v199, v43, v123
    v_fmac_f32 v199, v44, v124
    v_fmac_f32 v199, v45, v125
    v_fmac_f32 v199, v46, v126
    v_fmac_f32 v199, v47, v127
    s_waitcnt lgkmcnt(0)
    v_mfma_f32_32x32x8_bf16 v[0:15], v[72:73], v[176:177], v[0:15]
    v_mul_f32_e64 v201, v48, -v168
    v_fma_f32 v201, v49, -v169, v201
    v_fma_f32 v201, v50, -v170, v201
    v_fma_f32 v201, v51, -v171, v201
    v_fma_f32 v201, v52, -v172, v201
    v_fma_f32 v201, v53, -v173, v201
    v_fma_f32 v201, v54, -v174, v201
    v_fma_f32 v201, v55, -v175, v201
    s_add_u32 m0, s21, 2048
    v_mfma_f32_32x32x8_bf16 v[16:31], v[76:77], v[176:177], v[16:31]
    v_lshl_add_u32 v236, v236, 10, v246
    v_lshl_add_u32 v237, v237, 10, v246
    buffer_load_dwordx4 v236, s[4:7], s39 offen lds
    buffer_load_dwordx4 v237, s[8:11], s39 offen offset:1024 lds
    v_mul_f32_e64 v203, v56, -v168
    v_fma_f32 v203, v57, -v169, v203
    v_fma_f32 v203, v58, -v170, v203
    v_fma_f32 v203, v59, -v171, v203
    v_fma_f32 v203, v60, -v172, v203
    v_fma_f32 v203, v61, -v173, v203
    v_fma_f32 v203, v62, -v174, v203
    v_fma_f32 v203, v63, -v175, v203
    v_mfma_f32_32x32x16_bf16 v[32:47], v[64:67], v[180:183], 0
    v_mul_f32 v254, v0, v144
    v_fmac_f32 v254, v1, v145
    v_fmac_f32 v254, v2, v146
    v_fmac_f32 v254, v3, v147
    v_fmac_f32 v254, v4, v148
    v_mfma_f32_32x32x16_bf16 v[48:63], v[68:71], v[180:183], 0
    ds_swizzle_b32 v68, v68 offset:0x401F
    ds_swizzle_b32 v69, v69 offset:0x401F
    ds_swizzle_b32 v70, v70 offset:0x401F
    ds_swizzle_b32 v71, v71 offset:0x401F
    s_waitcnt vmcnt(7)
    ds_read_b64_tr_b16 v[176:177], v244 offset:4096
    ds_read_b64_tr_b16 v[178:179], v244 offset:5120
    ds_read_b64_tr_b16 v[180:181], v245 offset:4096
    ds_read_b64_tr_b16 v[182:183], v245 offset:5120
    v_fmac_f32 v254, v5, v149
    v_fmac_f32 v254, v6, v150
    v_fmac_f32 v254, v7, v151
    v_fmac_f32 v200, v8, v160
    v_mfma_f32_32x32x8_bf16 v[32:47], v[72:73], v[184:185], v[32:47]
    v_fmac_f32 v200, v9, v161
    v_permlane32_swap_b32 v196, v254
    v_fmac_f32 v200, v10, v162
    v_fmac_f32 v200, v11, v163
    v_fmac_f32 v200, v12, v164
    v_mfma_f32_32x32x8_bf16 v[48:63], v[76:77], v[184:185], v[48:63]
    ds_swizzle_b32 v76, v76 offset:0x401F
    ds_swizzle_b32 v77, v77 offset:0x401F
    v_fmac_f32 v200, v13, v165
    v_fmac_f32 v200, v14, v166
    v_fmac_f32 v200, v15, v167
    v_add_f32 v254, v196, v254
    s_waitcnt lgkmcnt(6)
    s_mov_b64 exec, s[56:57]
    v_xor_b32 v68, 0x80008000, v68
    v_xor_b32 v69, 0x80008000, v69
    v_xor_b32 v70, 0x80008000, v70
    v_xor_b32 v71, 0x80008000, v71
    s_mov_b64 exec, -1
    s_waitcnt vmcnt(4) lgkmcnt(2)
    v_mfma_f32_32x32x16_bf16 v[0:15], v[64:67], v[176:179], 0
    v_mul_f32 v255, v32, v152
    v_fmac_f32 v255, v33, v153
    v_fmac_f32 v255, v34, v154
    v_fmac_f32 v255, v35, v155
    v_fmac_f32 v255, v36, v156
    v_fmac_f32 v255, v37, v157
    s_add_u32 m0, s21, 4096
    v_mfma_f32_32x32x16_bf16 v[16:31], v[68:71], v[176:179], v[16:31]
    v_lshl_add_u32 v238, v238, 10, v246
    v_lshl_add_u32 v239, v239, 10, v246
    buffer_load_dwordx4 v238, s[4:7], s40 offen lds
    buffer_load_dwordx4 v239, s[8:11], s40 offen offset:1024 lds
    ds_read_b64_tr_b16 v[176:177], v244 offset:6144
    ds_read_b64_tr_b16 v[184:185], v245 offset:6144
    v_fmac_f32 v255, v38, v158
    v_fmac_f32 v255, v39, v159
    v_fmac_f32 v201, v40, v168
    v_fmac_f32 v201, v41, v169
    v_permlane32_swap_b32 v197, v255
    s_waitcnt lgkmcnt(0)
    s_mov_b64 exec, s[56:57]
    v_xor_b32 v76, 0x80008000, v76
    v_xor_b32 v77, 0x80008000, v77
    s_mov_b64 exec, -1
    v_mfma_f32_32x32x8_bf16 v[0:15], v[72:73], v[176:177], v[0:15]
    v_fmac_f32 v201, v42, v170
    v_fmac_f32 v201, v43, v171
    v_fmac_f32 v201, v44, v172
    v_fmac_f32 v201, v45, v173
    v_fmac_f32 v201, v46, v174
    v_fmac_f32 v201, v47, v175
    s_add_u32 m0, s21, 6144
    v_mfma_f32_32x32x8_bf16 v[16:31], v[76:77], v[176:177], v[16:31]
    v_lshl_add_u32 v240, v240, 10, v246
    v_lshl_add_u32 v241, v241, 10, v246
    buffer_load_dwordx4 v240, s[4:7], s41 offen lds
    buffer_load_dwordx4 v241, s[8:11], s41 offen offset:1024 lds
    v_add_f32 v255, v197, v255
    s_set_gpr_idx_on s51, gpr_idx(DST)
    s_nop 0
    v_cvt_pk_bf16_f32 v206, v254, v255
    s_set_gpr_idx_off
    v_mfma_f32_32x32x16_bf16 v[32:47], v[64:67], v[180:183], 0
    v_mul_f32 v254, v0, v144
    v_fmac_f32 v254, v1, v145
    v_fmac_f32 v254, v2, v146
    v_fmac_f32 v254, v3, v147
    v_fmac_f32 v254, v4, v148
    v_fmac_f32 v254, v5, v149
    v_fmac_f32 v254, v6, v150
    v_fmac_f32 v254, v7, v151
    v_fma_f32 v202, v8, -v160, v202
    v_fma_f32 v202, v9, -v161, v202
    v_mfma_f32_32x32x16_bf16 v[48:63], v[68:71], v[180:183], v[48:63]
    s_waitcnt vmcnt(6)
    ds_read_b64_tr_b16 v[176:177], v244 offset:0
    ds_read_b64_tr_b16 v[178:179], v244 offset:1024
    ds_read_b64_tr_b16 v[180:181], v245 offset:0
    ds_read_b64_tr_b16 v[182:183], v245 offset:1024
    v_permlane32_swap_b32 v254, v200
    v_fma_f32 v202, v10, -v162, v202
    v_fma_f32 v202, v11, -v163, v202
    v_fma_f32 v202, v12, -v164, v202
    v_fma_f32 v202, v13, -v165, v202
    v_fma_f32 v202, v14, -v166, v202
    v_fma_f32 v202, v15, -v167, v202
    v_add_f32 v200, v254, v200
    v_fmac_f32 v198, v16, v112
    v_permlane32_swap_b32 v202, v254
    v_mfma_f32_32x32x8_bf16 v[32:47], v[72:73], v[184:185], v[32:47]
    v_fmac_f32 v198, v17, v113
    v_fmac_f32 v198, v18, v114
    v_fmac_f32 v198, v19, v115
    v_fmac_f32 v198, v20, v116
    v_fmac_f32 v198, v21, v117
    v_fmac_f32 v198, v22, v118
    v_fmac_f32 v198, v23, v119
    v_add_f32 v254, v202, v254
    v_mul_f32 v196, v24, v160
    v_fmac_f32 v196, v25, v161
    v_mfma_f32_32x32x8_bf16 v[48:63], v[76:77], v[184:185], v[48:63]
    v_add_u32 v249, s48, v249
    v_add_u32 v250, s49, v250
    ds_read_b32 v252, v251 offset:16
    ds_read_b64_tr_b16 v[64:65], v249 offset:0
    ds_read_b64_tr_b16 v[68:69], v249 offset:64
    ds_read_b64_tr_b16 v[66:67], v249 offset:256
    ds_read_b64_tr_b16 v[70:71], v249 offset:320
    s_mov_b64 exec, s[54:55]
    ds_read_u16_d16_hi v242, v250 offset:0
    s_mov_b64 exec, -1
    v_fmac_f32 v196, v26, v162
    v_fmac_f32 v196, v27, v163
    v_fmac_f32 v196, v28, v164
    v_fmac_f32 v196, v29, v165
    v_fmac_f32 v196, v30, v166
    v_fmac_f32 v196, v31, v167
    s_nop 1
    v_permlane32_swap_b32 v198, v196
    v_add_f32 v196, v198, v196
    v_mul_f32 v255, v32, v152
    v_fmac_f32 v255, v33, v153
    v_fmac_f32 v255, v34, v154
    v_fmac_f32 v255, v35, v155
    v_fmac_f32 v255, v36, v156
    v_fmac_f32 v255, v37, v157
    v_fmac_f32 v255, v38, v158
    v_fmac_f32 v255, v39, v159
    v_fma_f32 v203, v40, -v168, v203
    v_fma_f32 v203, v41, -v169, v203
    v_permlane32_swap_b32 v255, v201
    v_fma_f32 v203, v42, -v170, v203
    v_fma_f32 v203, v43, -v171, v203
    v_fma_f32 v203, v44, -v172, v203
    v_fma_f32 v203, v45, -v173, v203
    v_fma_f32 v203, v46, -v174, v203
    v_fma_f32 v203, v47, -v175, v203
    v_add_f32 v201, v255, v201
    v_fmac_f32 v199, v48, v120
    v_permlane32_swap_b32 v203, v255
    v_fmac_f32 v199, v49, v121
    v_fmac_f32 v199, v50, v122
    v_fmac_f32 v199, v51, v123
    v_fmac_f32 v199, v52, v124
    v_fmac_f32 v199, v53, v125
    v_fmac_f32 v199, v54, v126
    v_fmac_f32 v199, v55, v127
    v_add_f32 v255, v203, v255
    v_mul_f32 v197, v56, v168
    v_fmac_f32 v197, v57, v169
    v_fmac_f32 v197, v58, v170
    v_fmac_f32 v197, v59, v171
    v_fmac_f32 v197, v60, v172
    v_fmac_f32 v197, v61, v173
    v_fmac_f32 v197, v62, v174
    v_fmac_f32 v197, v63, v175
    s_nop 1
    v_permlane32_swap_b32 v199, v197
    v_add_f32 v197, v199, v197
    s_set_gpr_idx_on s51, gpr_idx(DST)
    s_nop 0
    v_cvt_pk_bf16_f32 v207, v200, v201
    v_cvt_pk_bf16_f32 v209, v254, v255
    v_cvt_pk_bf16_f32 v208, v196, v197
    s_set_gpr_idx_off
    s_add_u32 s50, s50, 1
    s_add_u32 s51, s51, 6
    s_cmp_ge_u32 s50, 4
    s_cbranch_scc1 LAST0
    s_waitcnt lgkmcnt(5)
    v_readfirstlane_b32 s66, v252
    s_add_u32 s53, s53, 1
    v_mov_b32 v252, s53
    s_cmp_le_u32 s53, s66
    ds_write2_b32 v251, v252, v252 offset0:0 offset1:8
    s_setprio 1
    s_cbranch_scc1 PRIO_7
    s_setprio 0
PRIO_7:
    s_cmp_eq_u32 s52, 4
    s_cbranch_scc1 ITEM_0_4
    s_cmp_eq_u32 s52, 5
    s_cbranch_scc1 ITEM_0_5
    s_cmp_eq_u32 s52, 3
    s_cbranch_scc1 ITEM_0_3
    s_cmp_eq_u32 s52, 6
    s_cbranch_scc1 ITEM_0_6
    s_cmp_eq_u32 s52, 8
    s_cbranch_scc1 ITEM_0_8
    s_branch ITEM_0_2
.p2align 6
ITEM_0_6:
    s_mov_b64 exec, s[54:55]
    ds_read_u16_d16_hi v243, v250 offset:128
    s_mov_b64 exec, -1
    ds_read_b64_tr_b16 v[72:73], v249 offset:512
    ds_read_b64_tr_b16 v[76:77], v249 offset:576
    ds_read_b64_tr_b16 v[74:75], v249 offset:768
    ds_read_b64_tr_b16 v[78:79], v249 offset:832
    ds_read_b64_tr_b16 v[80:81], v249 offset:1024
    ds_read_b64_tr_b16 v[84:85], v249 offset:1088
    ds_read_b64_tr_b16 v[82:83], v249 offset:1280
    ds_read_b64_tr_b16 v[86:87], v249 offset:1344
    s_waitcnt lgkmcnt(9)
    v_mul_f32_dpp v196, v242, v64 row_newbcast:0 row_mask:0xf bank_mask:0xf
    v_mul_f32_dpp v197, v242, v65 row_newbcast:1 row_mask:0xf bank_mask:0xf
    v_mul_f32_dpp v198, v242, v64 row_newbcast:8 row_mask:0xf bank_mask:0xf
    v_mul_f32_dpp v199, v242, v65 row_newbcast:9 row_mask:0xf bank_mask:0xf
    v_mul_f32_dpp v200, v242, v68 row_newbcast:2 row_mask:0xf bank_mask:0xf
    v_mul_f32_dpp v201, v242, v69 row_newbcast:3 row_mask:0xf bank_mask:0xf
    v_mul_f32_dpp v202, v242, v68 row_newbcast:10 row_mask:0xf bank_mask:0xf
    v_mul_f32_dpp v203, v242, v69 row_newbcast:11 row_mask:0xf bank_mask:0xf
    v_cvt_pk_bf16_f32 v64, v196, v197
    v_cvt_pk_bf16_f32 v68, v198, v199
    v_cvt_pk_bf16_f32 v65, v200, v201
    v_cvt_pk_bf16_f32 v69, v202, v203
    v_mul_f32_dpp v196, v242, v66 row_newbcast:4 row_mask:0xf bank_mask:0xf
    v_mul_f32_dpp v197, v242, v67 row_newbcast:5 row_mask:0xf bank_mask:0xf
    v_mul_f32_dpp v198, v242, v66 row_newbcast:12 row_mask:0xf bank_mask:0xf
    v_mul_f32_dpp v199, v242, v67 row_newbcast:13 row_mask:0xf bank_mask:0xf
    v_mul_f32_dpp v200, v242, v70 row_newbcast:6 row_mask:0xf bank_mask:0xf
    v_mul_f32_dpp v201, v242, v71 row_newbcast:7 row_mask:0xf bank_mask:0xf
    v_mul_f32_dpp v202, v242, v70 row_newbcast:14 row_mask:0xf bank_mask:0xf
    v_mul_f32_dpp v203, v242, v71 row_newbcast:15 row_mask:0xf bank_mask:0xf
    v_cvt_pk_bf16_f32 v66, v196, v197
    v_cvt_pk_bf16_f32 v70, v198, v199
    v_cvt_pk_bf16_f32 v67, v200, v201
    v_cvt_pk_bf16_f32 v71, v202, v203
    s_mov_b64 exec, s[54:55]
    ds_read_u16_d16_hi v242, v250 offset:256
    s_mov_b64 exec, -1
    s_waitcnt vmcnt(4) lgkmcnt(5)
    v_mfma_f32_32x32x16_bf16 v[0:15], v[64:67], v[176:179], 0
    v_mul_f32_dpp v196, v243, v72 row_newbcast:0 row_mask:0xf bank_mask:0xf
    v_mul_f32_dpp v197, v243, v73 row_newbcast:1 row_mask:0xf bank_mask:0xf
    v_mul_f32_dpp v198, v243, v72 row_newbcast:8 row_mask:0xf bank_mask:0xf
    v_mul_f32_dpp v199, v243, v73 row_newbcast:9 row_mask:0xf bank_mask:0xf
    v_mul_f32_dpp v200, v243, v76 row_newbcast:2 row_mask:0xf bank_mask:0xf
    v_mul_f32_dpp v201, v243, v77 row_newbcast:3 row_mask:0xf bank_mask:0xf
    v_mul_f32_dpp v202, v243, v76 row_newbcast:10 row_mask:0xf bank_mask:0xf
    v_mul_f32_dpp v203, v243, v77 row_newbcast:11 row_mask:0xf bank_mask:0xf
    v_cvt_pk_bf16_f32 v72, v196, v197
    v_cvt_pk_bf16_f32 v76, v198, v199
    v_cvt_pk_bf16_f32 v73, v200, v201
    v_cvt_pk_bf16_f32 v77, v202, v203
    s_add_u32 m0, s21, 0
    v_mfma_f32_32x32x16_bf16 v[16:31], v[68:71], v[176:179], 0
    buffer_load_dwordx4 v236, s[4:7], s35 offen lds
    buffer_load_dwordx4 v237, s[8:11], s35 offen offset:1024 lds
    ds_read_b64_tr_b16 v[176:177], v244 offset:2048
    ds_read_b64_tr_b16 v[178:179], v244 offset:3072
    ds_read_b64_tr_b16 v[184:185], v245 offset:2048
    ds_read_b64_tr_b16 v[186:187], v245 offset:3072
    v_mul_f32_dpp v196, v243, v74 row_newbcast:4 row_mask:0xf bank_mask:0xf
    v_mul_f32_dpp v197, v243, v75 row_newbcast:5 row_mask:0xf bank_mask:0xf
    v_mul_f32_dpp v198, v243, v74 row_newbcast:12 row_mask:0xf bank_mask:0xf
    v_mul_f32_dpp v199, v243, v75 row_newbcast:13 row_mask:0xf bank_mask:0xf
    v_mul_f32_dpp v200, v243, v78 row_newbcast:6 row_mask:0xf bank_mask:0xf
    v_mul_f32_dpp v201, v243, v79 row_newbcast:7 row_mask:0xf bank_mask:0xf
    v_mul_f32_dpp v202, v243, v78 row_newbcast:14 row_mask:0xf bank_mask:0xf
    v_mul_f32_dpp v203, v243, v79 row_newbcast:15 row_mask:0xf bank_mask:0xf
    v_cvt_pk_bf16_f32 v74, v196, v197
    v_cvt_pk_bf16_f32 v78, v198, v199
    v_cvt_pk_bf16_f32 v75, v200, v201
    v_cvt_pk_bf16_f32 v79, v202, v203
    s_nop 0
    s_waitcnt vmcnt(4) lgkmcnt(0)
    v_mfma_f32_32x32x16_bf16 v[0:15], v[72:75], v[176:179], v[0:15]
    v_mul_f32_dpp v196, v242, v80 row_newbcast:0 row_mask:0xf bank_mask:0xf
    v_mul_f32_dpp v197, v242, v81 row_newbcast:1 row_mask:0xf bank_mask:0xf
    v_mul_f32_dpp v198, v242, v80 row_newbcast:8 row_mask:0xf bank_mask:0xf
    v_mul_f32_dpp v199, v242, v81 row_newbcast:9 row_mask:0xf bank_mask:0xf
    v_mul_f32_dpp v200, v242, v84 row_newbcast:2 row_mask:0xf bank_mask:0xf
    v_mul_f32_dpp v201, v242, v85 row_newbcast:3 row_mask:0xf bank_mask:0xf
    v_mul_f32_dpp v202, v242, v84 row_newbcast:10 row_mask:0xf bank_mask:0xf
    v_mul_f32_dpp v203, v242, v85 row_newbcast:11 row_mask:0xf bank_mask:0xf
    v_cvt_pk_bf16_f32 v80, v196, v197
    v_cvt_pk_bf16_f32 v84, v198, v199
    v_cvt_pk_bf16_f32 v81, v200, v201
    v_cvt_pk_bf16_f32 v85, v202, v203
    s_add_u32 m0, s21, 2048
    v_mfma_f32_32x32x16_bf16 v[16:31], v[76:79], v[176:179], v[16:31]
    buffer_load_dwordx4 v238, s[4:7], s35 offen lds
    buffer_load_dwordx4 v239, s[8:11], s35 offen offset:1024 lds
    ds_read_b64_tr_b16 v[176:177], v244 offset:4096
    ds_read_b64_tr_b16 v[178:179], v244 offset:5120
    ds_read_b64_tr_b16 v[188:189], v245 offset:4096
    ds_read_b64_tr_b16 v[190:191], v245 offset:5120
    v_mul_f32_dpp v196, v242, v82 row_newbcast:4 row_mask:0xf bank_mask:0xf
    v_mul_f32_dpp v197, v242, v83 row_newbcast:5 row_mask:0xf bank_mask:0xf
    v_mul_f32_dpp v198, v242, v82 row_newbcast:12 row_mask:0xf bank_mask:0xf
    v_mul_f32_dpp v199, v242, v83 row_newbcast:13 row_mask:0xf bank_mask:0xf
    v_mul_f32_dpp v200, v242, v86 row_newbcast:6 row_mask:0xf bank_mask:0xf
    v_mul_f32_dpp v201, v242, v87 row_newbcast:7 row_mask:0xf bank_mask:0xf
    v_mul_f32_dpp v202, v242, v86 row_newbcast:14 row_mask:0xf bank_mask:0xf
    v_mul_f32_dpp v203, v242, v87 row_newbcast:15 row_mask:0xf bank_mask:0xf
    v_cvt_pk_bf16_f32 v82, v196, v197
    v_cvt_pk_bf16_f32 v86, v198, v199
    v_cvt_pk_bf16_f32 v83, v200, v201
    v_cvt_pk_bf16_f32 v87, v202, v203
    s_nop 0
    s_waitcnt lgkmcnt(0)
    v_mfma_f32_32x32x16_bf16 v[0:15], v[80:83], v[176:179], v[0:15]
    s_add_u32 m0, s21, 4096
    v_mfma_f32_32x32x16_bf16 v[16:31], v[84:87], v[176:179], v[16:31]
    buffer_load_dwordx4 v234, s[4:7], s36 offen lds
    buffer_load_dwordx4 v235, s[8:11], s36 offen offset:1024 lds
    s_mov_b32 m0, s50
    s_nop 0
    s_movrels_b32 s71, s23
    s_bfe_u32 s46, s71, 0x30012
    s_mov_b32 m0, s46
    s_and_b32 s66, s71, 0x3ffff
    s_movrels_b32 s68, s57
    s_movrels_b32 s69, s61
    s_sub_u32 s48, s66, s47
    s_mov_b32 s47, s66
    s_lshr_b32 s52, s71, 28
    s_lshl_b32 s67, s46, 9
    s_add_u32 s66, s66, s67
    s_sub_u32 s49, s66, s42
    s_mov_b32 s42, s66
    s_bfe_u32 s66, s68, 655360
    s_add_u32 s43, s42, s66
    s_bfe_u32 s39, s69, 655360
    s_bfe_u32 s66, s68, 655370
    s_add_u32 s44, s42, s66
    s_bfe_u32 s40, s69, 655370
    s_bfe_u32 s66, s68, 655380
    s_add_u32 s45, s42, s66
    s_bfe_u32 s41, s69, 655380
    s_and_b32 s66, s46, s33
    s_cselect_b32 s72, -1, 1
    s_cselect_b32 s76, s47, 163712
    s_cmp_ge_u32 s66, 2
    s_cselect_b32 s73, -1, 0
    s_add_u32 s77, s47, 1024
    s_cmp_ge_u32 s66, 4
    s_cselect_b32 s75, -1, 0
    s_cmp_ge_u32 s66, 3
    s_cselect_b32 s74, -1, 1
    s_cselect_b32 s77, s77, 163712
    v_add_u32 v252, s45, v247
    ds_read_u16 v240, v252
    ds_read_u16 v241, v252 offset:64
    v_mfma_f32_32x32x16_bf16 v[32:47], v[64:67], v[180:183], 0
    v_mul_f32 v196, v0, v96
    v_fmac_f32 v196, v1, v97
    v_fmac_f32 v196, v2, v98
    v_fmac_f32 v196, v3, v99
    v_fmac_f32 v196, v4, v100
    v_fmac_f32 v196, v5, v101
    v_fmac_f32 v196, v6, v102
    v_mfma_f32_32x32x16_bf16 v[48:63], v[68:71], v[180:183], 0
    v_add_u32 v253, s47, v248
    ds_read_b32 v254, v253
    ds_read_b32 v255, v253 offset:256
    v_fmac_f32 v196, v7, v103
    v_mul_f32 v198, v8, v128
    v_fmac_f32 v198, v9, v129
    v_fmac_f32 v198, v10, v130
    v_fmac_f32 v198, v11, v131
    v_fmac_f32 v198, v12, v132
    v_mfma_f32_32x32x16_bf16 v[32:47], v[72:75], v[184:187], v[32:47]
    v_fmac_f32 v198, v13, v133
    v_fmac_f32 v198, v14, v134
    v_fmac_f32 v198, v15, v135
    v_mul_f32 v200, v16, v128
    v_fmac_f32 v200, v17, v129
    v_permlane32_swap_b32 v196, v198
    v_mfma_f32_32x32x16_bf16 v[48:63], v[76:79], v[184:187], v[48:63]
    s_waitcnt vmcnt(6)
    ds_read_b64_tr_b16 v[176:177], v244 offset:6144
    ds_read_b64_tr_b16 v[178:179], v244 offset:7168
    ds_read_b64_tr_b16 v[180:181], v245 offset:6144
    ds_read_b64_tr_b16 v[182:183], v245 offset:7168
    v_fmac_f32 v200, v18, v130
    v_fmac_f32 v200, v19, v131
    v_fmac_f32 v200, v20, v132
    v_fmac_f32 v200, v21, v133
    v_fmac_f32 v200, v22, v134
    v_fmac_f32 v200, v23, v135
    v_mfma_f32_32x32x16_bf16 v[32:47], v[80:83], v[188:191], v[32:47]
    v_add_f32 v198, v196, v198
    v_mul_f32_e64 v202, v24, -v128
    v_fma_f32 v202, v25, -v129, v202
    v_fma_f32 v202, v26, -v130, v202
    v_fma_f32 v202, v27, -v131, v202
    v_fma_f32 v202, v28, -v132, v202
    v_mfma_f32_32x32x16_bf16 v[48:63], v[84:87], v[188:191], v[48:63]
    v_fma_f32 v202, v29, -v133, v202
    v_fma_f32 v202, v30, -v134, v202
    v_fma_f32 v202, v31, -v135, v202
    s_nop 1
    v_permlane32_swap_b32 v200, v202
    v_add_f32 v202, v200, v202
    s_waitcnt vmcnt(4) lgkmcnt(0)
    v_mfma_f32_32x32x16_bf16 v[0:15], v[64:67], v[176:179], 0
    v_mul_f32 v197, v32, v104
    v_fmac_f32 v197, v33, v105
    v_fmac_f32 v197, v34, v106
    v_fmac_f32 v197, v35, v107
    v_fmac_f32 v197, v36, v108
    v_fmac_f32 v197, v37, v109
    v_fmac_f32 v197, v38, v110
    s_add_u32 m0, s21, 6144
    v_mfma_f32_32x32x16_bf16 v[16:31], v[68:71], v[176:179], 0
    buffer_load_dwordx4 v236, s[4:7], s36 offen lds
    buffer_load_dwordx4 v237, s[8:11], s36 offen offset:1024 lds
    ds_read_b64_tr_b16 v[176:177], v244 offset:0
    ds_read_b64_tr_b16 v[178:179], v244 offset:1024
    ds_read_b64_tr_b16 v[184:185], v245 offset:0
    ds_read_b64_tr_b16 v[186:187], v245 offset:1024
    s_mov_b32 m0, s76
    s_mov_b64 exec, s[72:73]
    buffer_load_dwordx4 v254, s[12:15], 0 offen  lds
    s_mov_b32 m0, s77
    s_mov_b64 exec, s[74:75]
    buffer_load_dwordx4 v255, s[12:15], 0 offen  lds
    s_mov_b64 exec, -1
    v_fmac_f32 v197, v39, v111
    v_mul_f32 v199, v40, v136
    v_fmac_f32 v199, v41, v137
    v_fmac_f32 v199, v42, v138
    v_fmac_f32 v199, v43, v139
    v_fmac_f32 v199, v44, v140
    v_fmac_f32 v199, v45, v141
    s_waitcnt vmcnt(6) lgkmcnt(0)
    v_mfma_f32_32x32x16_bf16 v[0:15], v[72:75], v[176:179], v[0:15]
    v_fmac_f32 v199, v46, v142
    v_fmac_f32 v199, v47, v143
    v_mul_f32 v201, v48, v136
    v_fmac_f32 v201, v49, v137
    v_permlane32_swap_b32 v197, v199
    v_fmac_f32 v201, v50, v138
    v_fmac_f32 v201, v51, v139
    s_add_u32 m0, s21, 0
    v_mfma_f32_32x32x16_bf16 v[16:31], v[76:79], v[176:179], v[16:31]
    buffer_load_dwordx4 v238, s[4:7], s36 offen lds
    buffer_load_dwordx4 v239, s[8:11], s36 offen offset:1024 lds
    ds_read_b64_tr_b16 v[176:177], v244 offset:2048
    ds_read_b64_tr_b16 v[178:179], v244 offset:3072
    ds_read_b64_tr_b16 v[188:189], v245 offset:2048
    ds_read_b64_tr_b16 v[190:191], v245 offset:3072
    v_fmac_f32 v201, v52, v140
    v_fmac_f32 v201, v53, v141
    v_fmac_f32 v201, v54, v142
    v_fmac_f32 v201, v55, v143
    v_add_f32 v199, v197, v199
    v_mul_f32_e64 v203, v56, -v136
    v_fma_f32 v203, v57, -v137, v203
    s_waitcnt lgkmcnt(0)
    v_mfma_f32_32x32x16_bf16 v[0:15], v[80:83], v[176:179], v[0:15]
    v_fma_f32 v203, v58, -v138, v203
    v_fma_f32 v203, v59, -v139, v203
    v_fma_f32 v203, v60, -v140, v203
    v_fma_f32 v203, v61, -v141, v203
    v_fma_f32 v203, v62, -v142, v203
    v_fma_f32 v203, v63, -v143, v203
    s_nop 1
    s_add_u32 m0, s21, 2048
    v_mfma_f32_32x32x16_bf16 v[16:31], v[84:87], v[176:179], v[16:31]
    buffer_load_dwordx4 v234, s[4:7], s37 offen lds
    buffer_load_dwordx4 v235, s[8:11], s37 offen offset:1024 lds
    v_add_u32 v252, s42, v247
    ds_read_u16 v234, v252
    ds_read_u16 v235, v252 offset:64
    v_permlane32_swap_b32 v201, v203
    v_add_f32 v203, v201, v203
    s_set_gpr_idx_on s51, gpr_idx(DST)
    s_nop 0
    v_cvt_pk_bf16_f32 v204, v198, v199
    v_cvt_pk_bf16_f32 v205, v202, v203
    s_set_gpr_idx_off
    v_mfma_f32_32x32x16_bf16 v[32:47], v[64:67], v[180:183], 0
    v_mul_f32 v196, v0, v144
    v_fmac_f32 v196, v1, v145
    v_fmac_f32 v196, v2, v146
    v_fmac_f32 v196, v3, v147
    v_fmac_f32 v196, v4, v148
    v_fmac_f32 v196, v5, v149
    v_mfma_f32_32x32x16_bf16 v[48:63], v[68:71], v[180:183], 0
    v_fmac_f32 v196, v6, v150
    v_fmac_f32 v196, v7, v151
    v_mul_f32 v198, v8, v112
    v_fmac_f32 v198, v9, v113
    v_fmac_f32 v198, v10, v114
    v_mfma_f32_32x32x16_bf16 v[32:47], v[72:75], v[184:187], v[32:47]
    v_fmac_f32 v198, v11, v115
    v_fmac_f32 v198, v12, v116
    v_fmac_f32 v198, v13, v117
    v_fmac_f32 v198, v14, v118
    v_fmac_f32 v198, v15, v119
    v_mfma_f32_32x32x16_bf16 v[48:63], v[76:79], v[184:187], v[48:63]
    s_waitcnt vmcnt(8)
    ds_read_b64_tr_b16 v[176:177], v244 offset:4096
    ds_read_b64_tr_b16 v[178:179], v244 offset:5120
    ds_read_b64_tr_b16 v[180:181], v245 offset:4096
    ds_read_b64_tr_b16 v[182:183], v245 offset:5120
    v_mul_f32_e64 v200, v16, -v160
    v_fma_f32 v200, v17, -v161, v200
    v_fma_f32 v200, v18, -v162, v200
    v_fma_f32 v200, v19, -v163, v200
    v_fma_f32 v200, v20, -v164, v200
    v_fma_f32 v200, v21, -v165, v200
    v_mfma_f32_32x32x16_bf16 v[32:47], v[80:83], v[188:191], v[32:47]
    v_fma_f32 v200, v22, -v166, v200
    v_fma_f32 v200, v23, -v167, v200
    v_mul_f32_e64 v202, v24, -v160
    v_fma_f32 v202, v25, -v161, v202
    v_fma_f32 v202, v26, -v162, v202
    v_mfma_f32_32x32x16_bf16 v[48:63], v[84:87], v[188:191], v[48:63]
    v_fma_f32 v202, v27, -v163, v202
    v_fma_f32 v202, v28, -v164, v202
    v_fma_f32 v202, v29, -v165, v202
    v_fma_f32 v202, v30, -v166, v202
    v_fma_f32 v202, v31, -v167, v202
    s_waitcnt vmcnt(6) lgkmcnt(0)
    v_mfma_f32_32x32x16_bf16 v[0:15], v[64:67], v[176:179], 0
    v_mul_f32 v197, v32, v152
    v_fmac_f32 v197, v33, v153
    v_fmac_f32 v197, v34, v154
    v_fmac_f32 v197, v35, v155
    v_fmac_f32 v197, v36, v156
    v_fmac_f32 v197, v37, v157
    s_add_u32 m0, s21, 4096
    v_mfma_f32_32x32x16_bf16 v[16:31], v[68:71], v[176:179], 0
    buffer_load_dwordx4 v236, s[4:7], s37 offen lds
    buffer_load_dwordx4 v237, s[8:11], s37 offen offset:1024 lds
    ds_read_b64_tr_b16 v[176:177], v244 offset:6144
    ds_read_b64_tr_b16 v[178:179], v244 offset:7168
    ds_read_b64_tr_b16 v[184:185], v245 offset:6144
    ds_read_b64_tr_b16 v[186:187], v245 offset:7168
    v_add_u32 v252, s43, v247
    ds_read_u16 v236, v252
    ds_read_u16 v237, v252 offset:64
    v_fmac_f32 v197, v38, v158
    v_fmac_f32 v197, v39, v159
    v_mul_f32 v199, v40, v120
    v_fmac_f32 v199, v41, v121
    v_fmac_f32 v199, v42, v122
    s_waitcnt vmcnt(4) lgkmcnt(2)
    v_mfma_f32_32x32x16_bf16 v[0:15], v[72:75], v[176:179], v[0:15]
    v_fmac_f32 v199, v43, v123
    v_fmac_f32 v199, v44, v124
    v_fmac_f32 v199, v45, v125
    v_fmac_f32 v199, v46, v126
    v_fmac_f32 v199, v47, v127
    s_add_u32 m0, s21, 6144
    v_mfma_f32_32x32x16_bf16 v[16:31], v[76:79], v[176:179], v[16:31]
    buffer_load_dwordx4 v238, s[4:7], s37 offen lds
    buffer_load_dwordx4 v239, s[8:11], s37 offen offset:1024 lds
    ds_read_b64_tr_b16 v[176:177], v244 offset:0
    ds_read_b64_tr_b16 v[178:179], v244 offset:1024
    ds_read_b64_tr_b16 v[188:189], v245 offset:0
    ds_read_b64_tr_b16 v[190:191], v245 offset:1024
    v_add_u32 v252, s44, v247
    ds_read_u16 v238, v252
    ds_read_u16 v239, v252 offset:64
    v_mul_f32_e64 v201, v48, -v168
    v_fma_f32 v201, v49, -v169, v201
    v_fma_f32 v201, v50, -v170, v201
    v_fma_f32 v201, v51, -v171, v201
    v_fma_f32 v201, v52, -v172, v201
    v_fma_f32 v201, v53, -v173, v201
    s_waitcnt lgkmcnt(2)
    v_mfma_f32_32x32x16_bf16 v[0:15], v[80:83], v[176:179], v[0:15]
    v_fma_f32 v201, v54, -v174, v201
    v_fma_f32 v201, v55, -v175, v201
    v_mul_f32_e64 v203, v56, -v168
    v_fma_f32 v203, v57, -v169, v203
    v_fma_f32 v203, v58, -v170, v203
    s_add_u32 m0, s21, 0
    v_mfma_f32_32x32x16_bf16 v[16:31], v[84:87], v[176:179], v[16:31]
    v_lshl_add_u32 v234, v234, 10, v246
    v_lshl_add_u32 v235, v235, 10, v246
    buffer_load_dwordx4 v234, s[4:7], s38 offen lds
    buffer_load_dwordx4 v235, s[8:11], s38 offen offset:1024 lds
    v_fma_f32 v203, v59, -v171, v203
    v_fma_f32 v203, v60, -v172, v203
    v_fma_f32 v203, v61, -v173, v203
    v_fma_f32 v203, v62, -v174, v203
    v_fma_f32 v203, v63, -v175, v203
    v_mfma_f32_32x32x16_bf16 v[32:47], v[64:67], v[180:183], 0
    v_mul_f32 v254, v0, v144
    v_fmac_f32 v254, v1, v145
    v_fmac_f32 v254, v2, v146
    v_mfma_f32_32x32x16_bf16 v[48:63], v[68:71], v[180:183], 0
    ds_swizzle_b32 v68, v68 offset:0x401F
    ds_swizzle_b32 v69, v69 offset:0x401F
    ds_swizzle_b32 v70, v70 offset:0x401F
    ds_swizzle_b32 v71, v71 offset:0x401F
    v_fmac_f32 v254, v3, v147
    v_fmac_f32 v254, v4, v148
    v_fmac_f32 v254, v5, v149
    v_mfma_f32_32x32x16_bf16 v[32:47], v[72:75], v[184:187], v[32:47]
    v_fmac_f32 v254, v6, v150
    v_fmac_f32 v254, v7, v151
    v_fmac_f32 v200, v8, v160
    v_mfma_f32_32x32x16_bf16 v[48:63], v[76:79], v[184:187], v[48:63]
    ds_swizzle_b32 v76, v76 offset:0x401F
    ds_swizzle_b32 v77, v77 offset:0x401F
    ds_swizzle_b32 v78, v78 offset:0x401F
    ds_swizzle_b32 v79, v79 offset:0x401F
    s_waitcnt vmcnt(6)
    ds_read_b64_tr_b16 v[176:177], v244 offset:2048
    ds_read_b64_tr_b16 v[178:179], v244 offset:3072
    ds_read_b64_tr_b16 v[180:181], v245 offset:2048
    ds_read_b64_tr_b16 v[182:183], v245 offset:3072
    v_fmac_f32 v200, v9, v161
    v_permlane32_swap_b32 v196, v254
    v_fmac_f32 v200, v10, v162
    v_mfma_f32_32x32x16_bf16 v[32:47], v[80:83], v[188:191], v[32:47]
    v_fmac_f32 v200, v11, v163
    v_fmac_f32 v200, v12, v164
    v_fmac_f32 v200, v13, v165
    v_mfma_f32_32x32x16_bf16 v[48:63], v[84:87], v[188:191], v[48:63]
    ds_swizzle_b32 v84, v84 offset:0x401F
    ds_swizzle_b32 v85, v85 offset:0x401F
    ds_swizzle_b32 v86, v86 offset:0x401F
    ds_swizzle_b32 v87, v87 offset:0x401F
    v_fmac_f32 v200, v14, v166
    v_fmac_f32 v200, v15, v167
    v_add_f32 v254, v196, v254
    s_waitcnt lgkmcnt(8)
    s_mov_b64 exec, s[56:57]
    v_xor_b32 v68, 0x80008000, v68
    v_xor_b32 v69, 0x80008000, v69
    v_xor_b32 v70, 0x80008000, v70
    v_xor_b32 v71, 0x80008000, v71
    v_xor_b32 v76, 0x80008000, v76
    v_xor_b32 v77, 0x80008000, v77
    v_xor_b32 v78, 0x80008000, v78
    v_xor_b32 v79, 0x80008000, v79
    s_mov_b64 exec, -1
    s_waitcnt vmcnt(4) lgkmcnt(4)
    v_mfma_f32_32x32x16_bf16 v[0:15], v[64:67], v[176:179], 0
    v_mul_f32 v255, v32, v152
    v_fmac_f32 v255, v33, v153
    v_fmac_f32 v255, v34, v154
    v_fmac_f32 v255, v35, v155
    s_add_u32 m0, s21, 2048
    v_mfma_f32_32x32x16_bf16 v[16:31], v[68:71], v[176:179], v[16:31]
    v_lshl_add_u32 v236, v236, 10, v246
    v_lshl_add_u32 v237, v237, 10, v246
    buffer_load_dwordx4 v236, s[4:7], s39 offen lds
    buffer_load_dwordx4 v237, s[8:11], s39 offen offset:1024 lds
    ds_read_b64_tr_b16 v[176:177], v244 offset:4096
    ds_read_b64_tr_b16 v[178:179], v244 offset:5120
    ds_read_b64_tr_b16 v[184:185], v245 offset:4096
    ds_read_b64_tr_b16 v[186:187], v245 offset:5120
    v_fmac_f32 v255, v36, v156
    v_fmac_f32 v255, v37, v157
    v_fmac_f32 v255, v38, v158
    v_fmac_f32 v255, v39, v159
    s_waitcnt vmcnt(4) lgkmcnt(0)
    v_mfma_f32_32x32x16_bf16 v[0:15], v[72:75], v[176:179], v[0:15]
    v_fmac_f32 v201, v40, v168
    v_fmac_f32 v201, v41, v169
    v_permlane32_swap_b32 v197, v255
    s_add_u32 m0, s21, 4096
    v_mfma_f32_32x32x16_bf16 v[16:31], v[76:79], v[176:179], v[16:31]
    v_lshl_add_u32 v238, v238, 10, v246
    v_lshl_add_u32 v239, v239, 10, v246
    buffer_load_dwordx4 v238, s[4:7], s40 offen lds
    buffer_load_dwordx4 v239, s[8:11], s40 offen offset:1024 lds
    ds_read_b64_tr_b16 v[176:177], v244 offset:6144
    ds_read_b64_tr_b16 v[178:179], v244 offset:7168
    ds_read_b64_tr_b16 v[188:189], v245 offset:6144
    ds_read_b64_tr_b16 v[190:191], v245 offset:7168
    v_fmac_f32 v201, v42, v170
    v_fmac_f32 v201, v43, v171
    v_fmac_f32 v201, v44, v172
    v_fmac_f32 v201, v45, v173
    s_waitcnt lgkmcnt(0)
    s_mov_b64 exec, s[56:57]
    v_xor_b32 v84, 0x80008000, v84
    v_xor_b32 v85, 0x80008000, v85
    v_xor_b32 v86, 0x80008000, v86
    v_xor_b32 v87, 0x80008000, v87
    s_mov_b64 exec, -1
    v_mfma_f32_32x32x16_bf16 v[0:15], v[80:83], v[176:179], v[0:15]
    v_fmac_f32 v201, v46, v174
    v_fmac_f32 v201, v47, v175
    v_add_f32 v255, v197, v255
    s_set_gpr_idx_on s51, gpr_idx(DST)
    s_nop 0
    v_cvt_pk_bf16_f32 v206, v254, v255
    s_set_gpr_idx_off
    s_add_u32 m0, s21, 6144
    v_mfma_f32_32x32x16_bf16 v[16:31], v[84:87], v[176:179], v[16:31]
    v_lshl_add_u32 v240, v240, 10, v246
    v_lshl_add_u32 v241, v241, 10, v246
    buffer_load_dwordx4 v240, s[4:7], s41 offen lds
    buffer_load_dwordx4 v241, s[8:11], s41 offen offset:1024 lds
    v_mfma_f32_32x32x16_bf16 v[32:47], v[64:67], v[180:183], 0
    v_mul_f32 v254, v0, v144
    v_fmac_f32 v254, v1, v145
    v_fmac_f32 v254, v2, v146
    v_fmac_f32 v254, v3, v147
    v_fmac_f32 v254, v4, v148
    v_fmac_f32 v254, v5, v149
    v_fmac_f32 v254, v6, v150
    v_mfma_f32_32x32x16_bf16 v[48:63], v[68:71], v[180:183], v[48:63]
    v_fmac_f32 v254, v7, v151
    v_fma_f32 v202, v8, -v160, v202
    v_fma_f32 v202, v9, -v161, v202
    v_permlane32_swap_b32 v254, v200
    v_fma_f32 v202, v10, -v162, v202
    v_fma_f32 v202, v11, -v163, v202
    v_mfma_f32_32x32x16_bf16 v[32:47], v[72:75], v[184:187], v[32:47]
    v_fma_f32 v202, v12, -v164, v202
    v_fma_f32 v202, v13, -v165, v202
    v_fma_f32 v202, v14, -v166, v202
    v_fma_f32 v202, v15, -v167, v202
    v_add_f32 v200, v254, v200
    v_fmac_f32 v198, v16, v112
    v_permlane32_swap_b32 v202, v254
    v_mfma_f32_32x32x16_bf16 v[48:63], v[76:79], v[184:187], v[48:63]
    s_waitcnt vmcnt(6)
    ds_read_b64_tr_b16 v[176:177], v244 offset:0
    ds_read_b64_tr_b16 v[178:179], v244 offset:1024
    ds_read_b64_tr_b16 v[180:181], v245 offset:0
    ds_read_b64_tr_b16 v[182:183], v245 offset:1024
    v_fmac_f32 v198, v17, v113
    v_fmac_f32 v198, v18, v114
    v_fmac_f32 v198, v19, v115
    v_fmac_f32 v198, v20, v116
    v_fmac_f32 v198, v21, v117
    v_fmac_f32 v198, v22, v118
    v_mfma_f32_32x32x16_bf16 v[32:47], v[80:83], v[188:191], v[32:47]
    v_fmac_f32 v198, v23, v119
    v_add_f32 v254, v202, v254
    v_mul_f32 v196, v24, v160
    v_fmac_f32 v196, v25, v161
    v_fmac_f32 v196, v26, v162
    v_fmac_f32 v196, v27, v163
    v_fmac_f32 v196, v28, v164
    v_mfma_f32_32x32x16_bf16 v[48:63], v[84:87], v[188:191], v[48:63]
    v_add_u32 v249, s48, v249
    v_add_u32 v250, s49, v250
    ds_read_b32 v252, v251 offset:16
    ds_read_b64_tr_b16 v[64:65], v249 offset:0
    ds_read_b64_tr_b16 v[68:69], v249 offset:64
    ds_read_b64_tr_b16 v[66:67], v249 offset:256
    ds_read_b64_tr_b16 v[70:71], v249 offset:320
    s_mov_b64 exec, s[54:55]
    ds_read_u16_d16_hi v242, v250 offset:0
    s_mov_b64 exec, -1
    v_fmac_f32 v196, v29, v165
    v_fmac_f32 v196, v30, v166
    v_fmac_f32 v196, v31, v167
    s_nop 1
    v_permlane32_swap_b32 v198, v196
    v_add_f32 v196, v198, v196
    v_mul_f32 v255, v32, v152
    v_fmac_f32 v255, v33, v153
    v_fmac_f32 v255, v34, v154
    v_fmac_f32 v255, v35, v155
    v_fmac_f32 v255, v36, v156
    v_fmac_f32 v255, v37, v157
    v_fmac_f32 v255, v38, v158
    v_fmac_f32 v255, v39, v159
    v_fma_f32 v203, v40, -v168, v203
    v_fma_f32 v203, v41, -v169, v203
    v_permlane32_swap_b32 v255, v201
    v_fma_f32 v203, v42, -v170, v203
    v_fma_f32 v203, v43, -v171, v203
    v_fma_f32 v203, v44, -v172, v203
    v_fma_f32 v203, v45, -v173, v203
    v_fma_f32 v203, v46, -v174, v203
    v_fma_f32 v203, v47, -v175, v203
    v_add_f32 v201, v255, v201
    v_fmac_f32 v199, v48, v120
    v_permlane32_swap_b32 v203, v255
    v_fmac_f32 v199, v49, v121
    v_fmac_f32 v199, v50, v122
    v_fmac_f32 v199, v51, v123
    v_fmac_f32 v199, v52, v124
    v_fmac_f32 v199, v53, v125
    v_fmac_f32 v199, v54, v126
    v_fmac_f32 v199, v55, v127
    v_add_f32 v255, v203, v255
    v_mul_f32 v197, v56, v168
    v_fmac_f32 v197, v57, v169
    v_fmac_f32 v197, v58, v170
    v_fmac_f32 v197, v59, v171
    v_fmac_f32 v197, v60, v172
    v_fmac_f32 v197, v61, v173
    v_fmac_f32 v197, v62, v174
    v_fmac_f32 v197, v63, v175
    s_nop 1
    v_permlane32_swap_b32 v199, v197
    v_add_f32 v197, v199, v197
    s_set_gpr_idx_on s51, gpr_idx(DST)
    s_nop 0
    v_cvt_pk_bf16_f32 v207, v200, v201
    v_cvt_pk_bf16_f32 v209, v254, v255
    v_cvt_pk_bf16_f32 v208, v196, v197
    s_set_gpr_idx_off
    s_add_u32 s50, s50, 1
    s_add_u32 s51, s51, 6
    s_cmp_ge_u32 s50, 4
    s_cbranch_scc1 LAST0
    s_waitcnt lgkmcnt(5)
    v_readfirstlane_b32 s66, v252
    s_add_u32 s53, s53, 1
    v_mov_b32 v252, s53
    s_cmp_le_u32 s53, s66
    ds_write2_b32 v251, v252, v252 offset0:0 offset1:8
    s_setprio 1
    s_cbranch_scc1 PRIO_8
    s_setprio 0
PRIO_8:
    s_cmp_eq_u32 s52, 4
    s_cbranch_scc1 ITEM_0_4
    s_cmp_eq_u32 s52, 5
    s_cbranch_scc1 ITEM_0_5
    s_cmp_eq_u32 s52, 3
    s_cbranch_scc1 ITEM_0_3
    s_cmp_eq_u32 s52, 6
    s_cbranch_scc1 ITEM_0_6
    s_cmp_eq_u32 s52, 8
    s_cbranch_scc1 ITEM_0_8
    s_branch ITEM_0_2
.p2align 6
ITEM_0_8:
    s_mov_b64 exec, s[54:55]
    ds_read_u16_d16_hi v243, v250 offset:128
    s_mov_b64 exec, -1
    ds_read_b64_tr_b16 v[72:73], v249 offset:512
    ds_read_b64_tr_b16 v[76:77], v249 offset:576
    ds_read_b64_tr_b16 v[74:75], v249 offset:768
    ds_read_b64_tr_b16 v[78:79], v249 offset:832
    ds_read_b64_tr_b16 v[80:81], v249 offset:1024
    ds_read_b64_tr_b16 v[84:85], v249 offset:1088
    ds_read_b64_tr_b16 v[82:83], v249 offset:1280
    ds_read_b64_tr_b16 v[86:87], v249 offset:1344
    ds_read_b64_tr_b16 v[88:89], v249 offset:1536
    ds_read_b64_tr_b16 v[92:93], v249 offset:1600
    ds_read_b64_tr_b16 v[90:91], v249 offset:1792
    ds_read_b64_tr_b16 v[94:95], v249 offset:1856
    s_waitcnt lgkmcnt(13)
    v_mul_f32_dpp v196, v242, v64 row_newbcast:0 row_mask:0xf bank_mask:0xf
    v_mul_f32_dpp v197, v242, v65 row_newbcast:1 row_mask:0xf bank_mask:0xf
    v_mul_f32_dpp v198, v242, v64 row_newbcast:8 row_mask:0xf bank_mask:0xf
    v_mul_f32_dpp v199, v242, v65 row_newbcast:9 row_mask:0xf bank_mask:0xf
    v_mul_f32_dpp v200, v242, v68 row_newbcast:2 row_mask:0xf bank_mask:0xf
    v_mul_f32_dpp v201, v242, v69 row_newbcast:3 row_mask:0xf bank_mask:0xf
    v_mul_f32_dpp v202, v242, v68 row_newbcast:10 row_mask:0xf bank_mask:0xf
    v_mul_f32_dpp v203, v242, v69 row_newbcast:11 row_mask:0xf bank_mask:0xf
    v_cvt_pk_bf16_f32 v64, v196, v197
    v_cvt_pk_bf16_f32 v68, v198, v199
    v_cvt_pk_bf16_f32 v65, v200, v201
    v_cvt_pk_bf16_f32 v69, v202, v203
    v_mul_f32_dpp v196, v242, v66 row_newbcast:4 row_mask:0xf bank_mask:0xf
    v_mul_f32_dpp v197, v242, v67 row_newbcast:5 row_mask:0xf bank_mask:0xf
    v_mul_f32_dpp v198, v242, v66 row_newbcast:12 row_mask:0xf bank_mask:0xf
    v_mul_f32_dpp v199, v242, v67 row_newbcast:13 row_mask:0xf bank_mask:0xf
    v_mul_f32_dpp v200, v242, v70 row_newbcast:6 row_mask:0xf bank_mask:0xf
    v_mul_f32_dpp v201, v242, v71 row_newbcast:7 row_mask:0xf bank_mask:0xf
    v_mul_f32_dpp v202, v242, v70 row_newbcast:14 row_mask:0xf bank_mask:0xf
    v_mul_f32_dpp v203, v242, v71 row_newbcast:15 row_mask:0xf bank_mask:0xf
    v_cvt_pk_bf16_f32 v66, v196, v197
    v_cvt_pk_bf16_f32 v70, v198, v199
    v_cvt_pk_bf16_f32 v67, v200, v201
    v_cvt_pk_bf16_f32 v71, v202, v203
    s_mov_b64 exec, s[54:55]
    ds_read_u16_d16_hi v242, v250 offset:256
    s_mov_b64 exec, -1
    s_waitcnt vmcnt(4) lgkmcnt(9)
    v_mfma_f32_32x32x16_bf16 v[0:15], v[64:67], v[176:179], 0
    v_mul_f32_dpp v196, v243, v72 row_newbcast:0 row_mask:0xf bank_mask:0xf
    v_mul_f32_dpp v197, v243, v73 row_newbcast:1 row_mask:0xf bank_mask:0xf
    v_mul_f32_dpp v198, v243, v72 row_newbcast:8 row_mask:0xf bank_mask:0xf
    v_mul_f32_dpp v199, v243, v73 row_newbcast:9 row_mask:0xf bank_mask:0xf
    v_mul_f32_dpp v200, v243, v76 row_newbcast:2 row_mask:0xf bank_mask:0xf
    v_mul_f32_dpp v201, v243, v77 row_newbcast:3 row_mask:0xf bank_mask:0xf
    v_mul_f32_dpp v202, v243, v76 row_newbcast:10 row_mask:0xf bank_mask:0xf
    v_mul_f32_dpp v203, v243, v77 row_newbcast:11 row_mask:0xf bank_mask:0xf
    v_cvt_pk_bf16_f32 v72, v196, v197
    v_cvt_pk_bf16_f32 v76, v198, v199
    v_cvt_pk_bf16_f32 v73, v200, v201
    v_cvt_pk_bf16_f32 v77, v202, v203
    s_add_u32 m0, s21, 0
    v_mfma_f32_32x32x16_bf16 v[16:31], v[68:71], v[176:179], 0
    buffer_load_dwordx4 v234, s[4:7], s35 offen lds
    buffer_load_dwordx4 v235, s[8:11], s35 offen offset:1024 lds
    ds_read_b64_tr_b16 v[176:177], v244 offset:2048
    ds_read_b64_tr_b16 v[178:179], v244 offset:3072
    ds_read_b64_tr_b16 v[184:185], v245 offset:2048
    ds_read_b64_tr_b16 v[186:187], v245 offset:3072
    v_mul_f32_dpp v196, v243, v74 row_newbcast:4 row_mask:0xf bank_mask:0xf
    v_mul_f32_dpp v197, v243, v75 row_newbcast:5 row_mask:0xf bank_mask:0xf
    v_mul_f32_dpp v198, v243, v74 row_newbcast:12 row_mask:0xf bank_mask:0xf
    v_mul_f32_dpp v199, v243, v75 row_newbcast:13 row_mask:0xf bank_mask:0xf
    v_mul_f32_dpp v200, v243, v78 row_newbcast:6 row_mask:0xf bank_mask:0xf
    v_mul_f32_dpp v201, v243, v79 row_newbcast:7 row_mask:0xf bank_mask:0xf
    v_mul_f32_dpp v202, v243, v78 row_newbcast:14 row_mask:0xf bank_mask:0xf
    v_mul_f32_dpp v203, v243, v79 row_newbcast:15 row_mask:0xf bank_mask:0xf
    v_cvt_pk_bf16_f32 v74, v196, v197
    v_cvt_pk_bf16_f32 v78, v198, v199
    v_cvt_pk_bf16_f32 v75, v200, v201
    v_cvt_pk_bf16_f32 v79, v202, v203
    s_mov_b64 exec, s[54:55]
    ds_read_u16_d16_hi v243, v250 offset:384
    s_mov_b64 exec, -1
    s_waitcnt vmcnt(4) lgkmcnt(1)
    v_mfma_f32_32x32x16_bf16 v[0:15], v[72:75], v[176:179], v[0:15]
    v_mul_f32_dpp v196, v242, v80 row_newbcast:0 row_mask:0xf bank_mask:0xf
    v_mul_f32_dpp v197, v242, v81 row_newbcast:1 row_mask:0xf bank_mask:0xf
    v_mul_f32_dpp v198, v242, v80 row_newbcast:8 row_mask:0xf bank_mask:0xf
    v_mul_f32_dpp v199, v242, v81 row_newbcast:9 row_mask:0xf bank_mask:0xf
    v_mul_f32_dpp v200, v242, v84 row_newbcast:2 row_mask:0xf bank_mask:0xf
    v_mul_f32_dpp v201, v242, v85 row_newbcast:3 row_mask:0xf bank_mask:0xf
    v_mul_f32_dpp v202, v242, v84 row_newbcast:10 row_mask:0xf bank_mask:0xf
    v_mul_f32_dpp v203, v242, v85 row_newbcast:11 row_mask:0xf bank_mask:0xf
    v_cvt_pk_bf16_f32 v80, v196, v197
    v_cvt_pk_bf16_f32 v84, v198, v199
    v_cvt_pk_bf16_f32 v81, v200, v201
    v_cvt_pk_bf16_f32 v85, v202, v203
    s_add_u32 m0, s21, 2048
    v_mfma_f32_32x32x16_bf16 v[16:31], v[76:79], v[176:179], v[16:31]
    buffer_load_dwordx4 v236, s[4:7], s35 offen lds
    buffer_load_dwordx4 v237, s[8:11], s35 offen offset:1024 lds
    ds_read_b64_tr_b16 v[176:177], v244 offset:4096
    ds_read_b64_tr_b16 v[178:179], v244 offset:5120
    ds_read_b64_tr_b16 v[188:189], v245 offset:4096
    ds_read_b64_tr_b16 v[190:191], v245 offset:5120
    v_mul_f32_dpp v196, v242, v82 row_newbcast:4 row_mask:0xf bank_mask:0xf
    v_mul_f32_dpp v197, v242, v83 row_newbcast:5 row_mask:0xf bank_mask:0xf
    v_mul_f32_dpp v198, v242, v82 row_newbcast:12 row_mask:0xf bank_mask:0xf
    v_mul_f32_dpp v199, v242, v83 row_newbcast:13 row_mask:0xf bank_mask:0xf
    v_mul_f32_dpp v200, v242, v86 row_newbcast:6 row_mask:0xf bank_mask:0xf
    v_mul_f32_dpp v201, v242, v87 row_newbcast:7 row_mask:0xf bank_mask:0xf
    v_mul_f32_dpp v202, v242, v86 row_newbcast:14 row_mask:0xf bank_mask:0xf
    v_mul_f32_dpp v203, v242, v87 row_newbcast:15 row_mask:0xf bank_mask:0xf
    v_cvt_pk_bf16_f32 v82, v196, v197
    v_cvt_pk_bf16_f32 v86, v198, v199
    v_cvt_pk_bf16_f32 v83, v200, v201
    v_cvt_pk_bf16_f32 v87, v202, v203
    s_nop 0
    s_waitcnt vmcnt(4) lgkmcnt(0)
    v_mfma_f32_32x32x16_bf16 v[0:15], v[80:83], v[176:179], v[0:15]
    v_mul_f32_dpp v196, v243, v88 row_newbcast:0 row_mask:0xf bank_mask:0xf
    v_mul_f32_dpp v197, v243, v89 row_newbcast:1 row_mask:0xf bank_mask:0xf
    v_mul_f32_dpp v198, v243, v88 row_newbcast:8 row_mask:0xf bank_mask:0xf
    v_mul_f32_dpp v199, v243, v89 row_newbcast:9 row_mask:0xf bank_mask:0xf
    v_mul_f32_dpp v200, v243, v92 row_newbcast:2 row_mask:0xf bank_mask:0xf
    v_mul_f32_dpp v201, v243, v93 row_newbcast:3 row_mask:0xf bank_mask:0xf
    v_mul_f32_dpp v202, v243, v92 row_newbcast:10 row_mask:0xf bank_mask:0xf
    v_mul_f32_dpp v203, v243, v93 row_newbcast:11 row_mask:0xf bank_mask:0xf
    v_cvt_pk_bf16_f32 v88, v196, v197
    v_cvt_pk_bf16_f32 v92, v198, v199
    v_cvt_pk_bf16_f32 v89, v200, v201
    v_cvt_pk_bf16_f32 v93, v202, v203
    s_add_u32 m0, s21, 4096
    v_mfma_f32_32x32x16_bf16 v[16:31], v[84:87], v[176:179], v[16:31]
    buffer_load_dwordx4 v238, s[4:7], s35 offen lds
    buffer_load_dwordx4 v239, s[8:11], s35 offen offset:1024 lds
    ds_read_b64_tr_b16 v[176:177], v244 offset:6144
    ds_read_b64_tr_b16 v[178:179], v244 offset:7168
    ds_read_b64_tr_b16 v[192:193], v245 offset:6144
    ds_read_b64_tr_b16 v[194:195], v245 offset:7168
    v_mul_f32_dpp v196, v243, v90 row_newbcast:4 row_mask:0xf bank_mask:0xf
    v_mul_f32_dpp v197, v243, v91 row_newbcast:5 row_mask:0xf bank_mask:0xf
    v_mul_f32_dpp v198, v243, v90 row_newbcast:12 row_mask:0xf bank_mask:0xf
    v_mul_f32_dpp v199, v243, v91 row_newbcast:13 row_mask:0xf bank_mask:0xf
    v_mul_f32_dpp v200, v243, v94 row_newbcast:6 row_mask:0xf bank_mask:0xf
    v_mul_f32_dpp v201, v243, v95 row_newbcast:7 row_mask:0xf bank_mask:0xf
    v_mul_f32_dpp v202, v243, v94 row_newbcast:14 row_mask:0xf bank_mask:0xf
    v_mul_f32_dpp v203, v243, v95 row_newbcast:15 row_mask:0xf bank_mask:0xf
    v_cvt_pk_bf16_f32 v90, v196, v197
    v_cvt_pk_bf16_f32 v94, v198, v199
    v_cvt_pk_bf16_f32 v91, v200, v201
    v_cvt_pk_bf16_f32 v95, v202, v203
    s_nop 0
    s_waitcnt lgkmcnt(0)
    v_mfma_f32_32x32x16_bf16 v[0:15], v[88:91], v[176:179], v[0:15]
    s_add_u32 m0, s21, 6144
    v_mfma_f32_32x32x16_bf16 v[16:31], v[92:95], v[176:179], v[16:31]
    buffer_load_dwordx4 v240, s[4:7], s35 offen lds
    buffer_load_dwordx4 v241, s[8:11], s35 offen offset:1024 lds
    s_mov_b32 m0, s50
    s_nop 0
    s_movrels_b32 s71, s23
    s_bfe_u32 s46, s71, 0x30012
    s_mov_b32 m0, s46
    s_and_b32 s66, s71, 0x3ffff
    s_movrels_b32 s68, s57
    s_movrels_b32 s69, s61
    s_sub_u32 s48, s66, s47
    s_mov_b32 s47, s66
    s_lshr_b32 s52, s71, 28
    s_lshl_b32 s67, s46, 9
    s_add_u32 s66, s66, s67
    s_sub_u32 s49, s66, s42
    s_mov_b32 s42, s66
    s_bfe_u32 s66, s68, 655360
    s_add_u32 s43, s42, s66
    s_bfe_u32 s39, s69, 655360
    s_bfe_u32 s66, s68, 655370
    s_add_u32 s44, s42, s66
    s_bfe_u32 s40, s69, 655370
    s_bfe_u32 s66, s68, 655380
    s_add_u32 s45, s42, s66
    s_bfe_u32 s41, s69, 655380
    s_and_b32 s66, s46, s33
    s_cselect_b32 s72, -1, 1
    s_cselect_b32 s76, s47, 163712
    s_cmp_ge_u32 s66, 2
    s_cselect_b32 s73, -1, 0
    s_add_u32 s77, s47, 1024
    s_cmp_ge_u32 s66, 4
    s_cselect_b32 s75, -1, 0
    s_cmp_ge_u32 s66, 3
    s_cselect_b32 s74, -1, 1
    s_cselect_b32 s77, s77, 163712
    v_mfma_f32_32x32x16_bf16 v[32:47], v[64:67], v[180:183], 0
    v_mul_f32 v196, v0, v96
    v_fmac_f32 v196, v1, v97
    v_fmac_f32 v196, v2, v98
    v_fmac_f32 v196, v3, v99
    v_fmac_f32 v196, v4, v100
    v_mfma_f32_32x32x16_bf16 v[48:63], v[68:71], v[180:183], 0
    v_add_u32 v253, s47, v248
    ds_read_b32 v254, v253
    ds_read_b32 v255, v253 offset:256
    v_fmac_f32 v196, v5, v101
    v_fmac_f32 v196, v6, v102
    v_fmac_f32 v196, v7, v103
    v_mul_f32 v198, v8, v128
    v_fmac_f32 v198, v9, v129
    v_mfma_f32_32x32x16_bf16 v[32:47], v[72:75], v[184:187], v[32:47]
    v_fmac_f32 v198, v10, v130
    v_fmac_f32 v198, v11, v131
    v_fmac_f32 v198, v12, v132
    v_fmac_f32 v198, v13, v133
    v_mfma_f32_32x32x16_bf16 v[48:63], v[76:79], v[184:187], v[48:63]
    v_fmac_f32 v198, v14, v134
    v_fmac_f32 v198, v15, v135
    v_mul_f32 v200, v16, v128
    v_fmac_f32 v200, v17, v129
    v_permlane32_swap_b32 v196, v198
    v_mfma_f32_32x32x16_bf16 v[32:47], v[80:83], v[188:191], v[32:47]
    v_fmac_f32 v200, v18, v130
    v_fmac_f32 v200, v19, v131
    v_fmac_f32 v200, v20, v132
    v_fmac_f32 v200, v21, v133
    v_fmac_f32 v200, v22, v134
    v_mfma_f32_32x32x16_bf16 v[48:63], v[84:87], v[188:191], v[48:63]
    s_waitcnt vmcnt(6)
    ds_read_b64_tr_b16 v[176:177], v244 offset:0
    ds_read_b64_tr_b16 v[178:179], v244 offset:1024
    ds_read_b64_tr_b16 v[180:181], v245 offset:0
    ds_read_b64_tr_b16 v[182:183], v245 offset:1024
    v_fmac_f32 v200, v23, v135
    v_add_f32 v198, v196, v198
    v_mul_f32_e64 v202, v24, -v128
    v_fma_f32 v202, v25, -v129, v202
    v_mfma_f32_32x32x16_bf16 v[32:47], v[88:91], v[192:195], v[32:47]
    v_fma_f32 v202, v26, -v130, v202
    v_fma_f32 v202, v27, -v131, v202
    v_fma_f32 v202, v28, -v132, v202
    v_fma_f32 v202, v29, -v133, v202
    v_fma_f32 v202, v30, -v134, v202
    v_mfma_f32_32x32x16_bf16 v[48:63], v[92:95], v[192:195], v[48:63]
    v_fma_f32 v202, v31, -v135, v202
    s_nop 1
    v_permlane32_swap_b32 v200, v202
    v_add_f32 v202, v200, v202
    s_waitcnt vmcnt(4) lgkmcnt(0)
    v_mfma_f32_32x32x16_bf16 v[0:15], v[64:67], v[176:179], 0
    v_mul_f32 v197, v32, v104
    v_fmac_f32 v197, v33, v105
    v_fmac_f32 v197, v34, v106
    v_fmac_f32 v197, v35, v107
    v_fmac_f32 v197, v36, v108
    v_fmac_f32 v197, v37, v109
    s_add_u32 m0, s21, 0
    v_mfma_f32_32x32x16_bf16 v[16:31], v[68:71], v[176:179], 0
    buffer_load_dwordx4 v234, s[4:7], s36 offen lds
    buffer_load_dwordx4 v235, s[8:11], s36 offen offset:1024 lds
    ds_read_b64_tr_b16 v[176:177], v244 offset:2048
    ds_read_b64_tr_b16 v[178:179], v244 offset:3072
    ds_read_b64_tr_b16 v[184:185], v245 offset:2048
    ds_read_b64_tr_b16 v[186:187], v245 offset:3072
    s_mov_b32 m0, s76
    s_mov_b64 exec, s[72:73]
    buffer_load_dwordx4 v254, s[12:15], 0 offen  lds
    s_mov_b32 m0, s77
    s_mov_b64 exec, s[74:75]
    buffer_load_dwordx4 v255, s[12:15], 0 offen  lds
    s_mov_b64 exec, -1
    v_fmac_f32 v197, v38, v110
    v_fmac_f32 v197, v39, v111
    v_mul_f32 v199, v40, v136
    v_fmac_f32 v199, v41, v137
    v_fmac_f32 v199, v42, v138
    s_waitcnt vmcnt(6) lgkmcnt(0)
    v_mfma_f32_32x32x16_bf16 v[0:15], v[72:75], v[176:179], v[0:15]
    v_fmac_f32 v199, v43, v139
    v_fmac_f32 v199, v44, v140
    v_fmac_f32 v199, v45, v141
    v_fmac_f32 v199, v46, v142
    v_fmac_f32 v199, v47, v143
    s_add_u32 m0, s21, 2048
    v_mfma_f32_32x32x16_bf16 v[16:31], v[76:79], v[176:179], v[16:31]
    buffer_load_dwordx4 v236, s[4:7], s36 offen lds
    buffer_load_dwordx4 v237, s[8:11], s36 offen offset:1024 lds
    ds_read_b64_tr_b16 v[176:177], v244 offset:4096
    ds_read_b64_tr_b16 v[178:179], v244 offset:5120
    ds_read_b64_tr_b16 v[188:189], v245 offset:4096
    ds_read_b64_tr_b16 v[190:191], v245 offset:5120
    v_mul_f32 v201, v48, v136
    v_fmac_f32 v201, v49, v137
    v_permlane32_swap_b32 v197, v199
    v_fmac_f32 v201, v50, v138
    v_fmac_f32 v201, v51, v139
    s_waitcnt vmcnt(6) lgkmcnt(0)
    v_mfma_f32_32x32x16_bf16 v[0:15], v[80:83], v[176:179], v[0:15]
    v_fmac_f32 v201, v52, v140
    v_fmac_f32 v201, v53, v141
    v_fmac_f32 v201, v54, v142
    v_fmac_f32 v201, v55, v143
    v_add_f32 v199, v197, v199
    v_mul_f32_e64 v203, v56, -v136
    s_add_u32 m0, s21, 4096
    v_mfma_f32_32x32x16_bf16 v[16:31], v[84:87], v[176:179], v[16:31]
    buffer_load_dwordx4 v238, s[4:7], s36 offen lds
    buffer_load_dwordx4 v239, s[8:11], s36 offen offset:1024 lds
    ds_read_b64_tr_b16 v[176:177], v244 offset:6144
    ds_read_b64_tr_b16 v[178:179], v244 offset:7168
    ds_read_b64_tr_b16 v[192:193], v245 offset:6144
    ds_read_b64_tr_b16 v[194:195], v245 offset:7168
    v_fma_f32 v203, v57, -v137, v203
    v_fma_f32 v203, v58, -v138, v203
    v_fma_f32 v203, v59, -v139, v203
    v_fma_f32 v203, v60, -v140, v203
    v_fma_f32 v203, v61, -v141, v203
    s_waitcnt lgkmcnt(0)
    v_mfma_f32_32x32x16_bf16 v[0:15], v[88:91], v[176:179], v[0:15]
    v_fma_f32 v203, v62, -v142, v203
    v_fma_f32 v203, v63, -v143, v203
    s_nop 1
    v_permlane32_swap_b32 v201, v203
    v_add_f32 v203, v201, v203
    s_add_u32 m0, s21, 6144
    v_mfma_f32_32x32x16_bf16 v[16:31], v[92:95], v[176:179], v[16:31]
    buffer_load_dwordx4 v240, s[4:7], s36 offen lds
    buffer_load_dwordx4 v241, s[8:11], s36 offen offset:1024 lds
    s_set_gpr_idx_on s51, gpr_idx(DST)
    s_nop 0
    v_cvt_pk_bf16_f32 v204, v198, v199
    v_cvt_pk_bf16_f32 v205, v202, v203
    s_set_gpr_idx_off
    v_mfma_f32_32x32x16_bf16 v[32:47], v[64:67], v[180:183], 0
    v_mul_f32 v196, v0, v144
    v_fmac_f32 v196, v1, v145
    v_fmac_f32 v196, v2, v146
    v_fmac_f32 v196, v3, v147
    v_mfma_f32_32x32x16_bf16 v[48:63], v[68:71], v[180:183], 0
    v_fmac_f32 v196, v4, v148
    v_fmac_f32 v196, v5, v149
    v_fmac_f32 v196, v6, v150
    v_fmac_f32 v196, v7, v151
    v_mfma_f32_32x32x16_bf16 v[32:47], v[72:75], v[184:187], v[32:47]
    v_mul_f32 v198, v8, v112
    v_fmac_f32 v198, v9, v113
    v_fmac_f32 v198, v10, v114
    v_fmac_f32 v198, v11, v115
    v_mfma_f32_32x32x16_bf16 v[48:63], v[76:79], v[184:187], v[48:63]
    v_fmac_f32 v198, v12, v116
    v_fmac_f32 v198, v13, v117
    v_fmac_f32 v198, v14, v118
    v_fmac_f32 v198, v15, v119
    v_mfma_f32_32x32x16_bf16 v[32:47], v[80:83], v[188:191], v[32:47]
    v_mul_f32_e64 v200, v16, -v160
    v_fma_f32 v200, v17, -v161, v200
    v_fma_f32 v200, v18, -v162, v200
    v_fma_f32 v200, v19, -v163, v200
    v_mfma_f32_32x32x16_bf16 v[48:63], v[84:87], v[188:191], v[48:63]
    s_waitcnt vmcnt(8)
    ds_read_b64_tr_b16 v[176:177], v244 offset:0
    ds_read_b64_tr_b16 v[178:179], v244 offset:1024
    ds_read_b64_tr_b16 v[180:181], v245 offset:0
    ds_read_b64_tr_b16 v[182:183], v245 offset:1024
    v_fma_f32 v200, v20, -v164, v200
    v_fma_f32 v200, v21, -v165, v200
    v_fma_f32 v200, v22, -v166, v200
    v_fma_f32 v200, v23, -v167, v200
    v_mfma_f32_32x32x16_bf16 v[32:47], v[88:91], v[192:195], v[32:47]
    v_mul_f32_e64 v202, v24, -v160
    v_fma_f32 v202, v25, -v161, v202
    v_fma_f32 v202, v26, -v162, v202
    v_fma_f32 v202, v27, -v163, v202
    v_mfma_f32_32x32x16_bf16 v[48:63], v[92:95], v[192:195], v[48:63]
    v_fma_f32 v202, v28, -v164, v202
    v_fma_f32 v202, v29, -v165, v202
    v_fma_f32 v202, v30, -v166, v202
    v_fma_f32 v202, v31, -v167, v202
    s_waitcnt vmcnt(4) lgkmcnt(0)
    v_mfma_f32_32x32x16_bf16 v[0:15], v[64:67], v[176:179], 0
    s_nop 0
    v_mul_f32 v197, v32, v152
    v_fmac_f32 v197, v33, v153
    v_fmac_f32 v197, v34, v154
    v_fmac_f32 v197, v35, v155
    s_add_u32 m0, s21, 0
    v_mfma_f32_32x32x16_bf16 v[16:31], v[68:71], v[176:179], 0
    buffer_load_dwordx4 v234, s[4:7], s37 offen lds
    buffer_load_dwordx4 v235, s[8:11], s37 offen offset:1024 lds
    ds_read_b64_tr_b16 v[176:177], v244 offset:2048
    ds_read_b64_tr_b16 v[178:179], v244 offset:3072
    ds_read_b64_tr_b16 v[184:185], v245 offset:2048
    ds_read_b64_tr_b16 v[186:187], v245 offset:3072
    v_add_u32 v252, s42, v247
    ds_read_u16 v234, v252
    ds_read_u16 v235, v252 offset:64
    v_fmac_f32 v197, v36, v156
    v_fmac_f32 v197, v37, v157
    v_fmac_f32 v197, v38, v158
    v_fmac_f32 v197, v39, v159
    s_waitcnt vmcnt(4) lgkmcnt(2)
    v_mfma_f32_32x32x16_bf16 v[0:15], v[72:75], v[176:179], v[0:15]
    v_mul_f32 v199, v40, v120
    v_fmac_f32 v199, v41, v121
    v_fmac_f32 v199, v42, v122
    v_fmac_f32 v199, v43, v123
    s_add_u32 m0, s21, 2048
    v_mfma_f32_32x32x16_bf16 v[16:31], v[76:79], v[176:179], v[16:31]
    buffer_load_dwordx4 v236, s[4:7], s37 offen lds
    buffer_load_dwordx4 v237, s[8:11], s37 offen offset:1024 lds
    ds_read_b64_tr_b16 v[176:177], v244 offset:4096
    ds_read_b64_tr_b16 v[178:179], v244 offset:5120
    ds_read_b64_tr_b16 v[188:189], v245 offset:4096
    ds_read_b64_tr_b16 v[190:191], v245 offset:5120
    v_add_u32 v252, s43, v247
    ds_read_u16 v236, v252
    ds_read_u16 v237, v252 offset:64
    v_fmac_f32 v199, v44, v124
    v_fmac_f32 v199, v45, v125
    v_fmac_f32 v199, v46, v126
    v_fmac_f32 v199, v47, v127
    s_waitcnt vmcnt(4) lgkmcnt(2)
    v_mfma_f32_32x32x16_bf16 v[0:15], v[80:83], v[176:179], v[0:15]
    v_mul_f32_e64 v201, v48, -v168
    v_fma_f32 v201, v49, -v169, v201
    v_fma_f32 v201, v50, -v170, v201
    v_fma_f32 v201, v51, -v171, v201
    s_add_u32 m0, s21, 4096
    v_mfma_f32_32x32x16_bf16 v[16:31], v[84:87], v[176:179], v[16:31]
    buffer_load_dwordx4 v238, s[4:7], s37 offen lds
    buffer_load_dwordx4 v239, s[8:11], s37 offen offset:1024 lds
    ds_read_b64_tr_b16 v[176:177], v244 offset:6144
    ds_read_b64_tr_b16 v[178:179], v244 offset:7168
    ds_read_b64_tr_b16 v[192:193], v245 offset:6144
    ds_read_b64_tr_b16 v[194:195], v245 offset:7168
    v_add_u32 v252, s44, v247
    ds_read_u16 v238, v252
    ds_read_u16 v239, v252 offset:64
    v_fma_f32 v201, v52, -v172, v201
    v_fma_f32 v201, v53, -v173, v201
    v_fma_f32 v201, v54, -v174, v201
    v_fma_f32 v201, v55, -v175, v201
    s_waitcnt lgkmcnt(2)
    v_mfma_f32_32x32x16_bf16 v[0:15], v[88:91], v[176:179], v[0:15]
    v_mul_f32_e64 v203, v56, -v168
    v_fma_f32 v203, v57, -v169, v203
    v_fma_f32 v203, v58, -v170, v203
    v_fma_f32 v203, v59, -v171, v203
    s_add_u32 m0, s21, 6144
    v_mfma_f32_32x32x16_bf16 v[16:31], v[92:95], v[176:179], v[16:31]
    buffer_load_dwordx4 v240, s[4:7], s37 offen lds
    buffer_load_dwordx4 v241, s[8:11], s37 offen offset:1024 lds
    v_add_u32 v252, s45, v247
    ds_read_u16 v240, v252
    ds_read_u16 v241, v252 offset:64
    v_fma_f32 v203, v60, -v172, v203
    v_fma_f32 v203, v61, -v173, v203
    v_fma_f32 v203, v62, -v174, v203
    v_fma_f32 v203, v63, -v175, v203
    v_mfma_f32_32x32x16_bf16 v[32:47], v[64:67], v[180:183], 0
    v_mul_f32 v254, v0, v144
    v_fmac_f32 v254, v1, v145
    v_fmac_f32 v254, v2, v146
    v_mfma_f32_32x32x16_bf16 v[48:63], v[68:71], v[180:183], 0
    ds_swizzle_b32 v68, v68 offset:0x401F
    ds_swizzle_b32 v69, v69 offset:0x401F
    ds_swizzle_b32 v70, v70 offset:0x401F
    ds_swizzle_b32 v71, v71 offset:0x401F
    v_fmac_f32 v254, v3, v147
    v_fmac_f32 v254, v4, v148
    v_mfma_f32_32x32x16_bf16 v[32:47], v[72:75], v[184:187], v[32:47]
    v_fmac_f32 v254, v5, v149
    v_fmac_f32 v254, v6, v150
    v_mfma_f32_32x32x16_bf16 v[48:63], v[76:79], v[184:187], v[48:63]
    ds_swizzle_b32 v76, v76 offset:0x401F
    ds_swizzle_b32 v77, v77 offset:0x401F
    ds_swizzle_b32 v78, v78 offset:0x401F
    ds_swizzle_b32 v79, v79 offset:0x401F
    v_fmac_f32 v254, v7, v151
    v_fmac_f32 v200, v8, v160
    v_mfma_f32_32x32x16_bf16 v[32:47], v[80:83], v[188:191], v[32:47]
    v_fmac_f32 v200, v9, v161
    v_permlane32_swap_b32 v196, v254
    v_fmac_f32 v200, v10, v162
    v_mfma_f32_32x32x16_bf16 v[48:63], v[84:87], v[188:191], v[48:63]
    ds_swizzle_b32 v84, v84 offset:0x401F
    ds_swizzle_b32 v85, v85 offset:0x401F
    ds_swizzle_b32 v86, v86 offset:0x401F
    ds_swizzle_b32 v87, v87 offset:0x401F
    s_waitcnt vmcnt(6)
    ds_read_b64_tr_b16 v[176:177], v244 offset:0
    ds_read_b64_tr_b16 v[178:179], v244 offset:1024
    ds_read_b64_tr_b16 v[180:181], v245 offset:0
    ds_read_b64_tr_b16 v[182:183], v245 offset:1024
    v_fmac_f32 v200, v11, v163
    v_fmac_f32 v200, v12, v164
    v_mfma_f32_32x32x16_bf16 v[32:47], v[88:91], v[192:195], v[32:47]
    v_fmac_f32 v200, v13, v165
    v_fmac_f32 v200, v14, v166
    v_mfma_f32_32x32x16_bf16 v[48:63], v[92:95], v[192:195], v[48:63]
    ds_swizzle_b32 v92, v92 offset:0x401F
    ds_swizzle_b32 v93, v93 offset:0x401F
    ds_swizzle_b32 v94, v94 offset:0x401F
    ds_swizzle_b32 v95, v95 offset:0x401F
    v_fmac_f32 v200, v15, v167
    v_add_f32 v254, v196, v254
    s_waitcnt lgkmcnt(8)
    s_mov_b64 exec, s[56:57]
    v_xor_b32 v68, 0x80008000, v68
    v_xor_b32 v69, 0x80008000, v69
    v_xor_b32 v70, 0x80008000, v70
    v_xor_b32 v71, 0x80008000, v71
    v_xor_b32 v76, 0x80008000, v76
    v_xor_b32 v77, 0x80008000, v77
    v_xor_b32 v78, 0x80008000, v78
    v_xor_b32 v79, 0x80008000, v79
    v_xor_b32 v84, 0x80008000, v84
    v_xor_b32 v85, 0x80008000, v85
    v_xor_b32 v86, 0x80008000, v86
    v_xor_b32 v87, 0x80008000, v87
    s_mov_b64 exec, -1
    s_waitcnt vmcnt(4) lgkmcnt(4)
    v_mfma_f32_32x32x16_bf16 v[0:15], v[64:67], v[176:179], 0
    v_mul_f32 v255, v32, v152
    v_fmac_f32 v255, v33, v153
    v_fmac_f32 v255, v34, v154
    s_add_u32 m0, s21, 0
    v_mfma_f32_32x32x16_bf16 v[16:31], v[68:71], v[176:179], v[16:31]
    v_lshl_add_u32 v234, v234, 10, v246
    v_lshl_add_u32 v235, v235, 10, v246
    buffer_load_dwordx4 v234, s[4:7], s38 offen lds
    buffer_load_dwordx4 v235, s[8:11], s38 offen offset:1024 lds
    ds_read_b64_tr_b16 v[176:177], v244 offset:2048
    ds_read_b64_tr_b16 v[178:179], v244 offset:3072
    ds_read_b64_tr_b16 v[184:185], v245 offset:2048
    ds_read_b64_tr_b16 v[186:187], v245 offset:3072
    v_fmac_f32 v255, v35, v155
    v_fmac_f32 v255, v36, v156
    v_fmac_f32 v255, v37, v157
    s_waitcnt vmcnt(4) lgkmcnt(0)
    v_mfma_f32_32x32x16_bf16 v[0:15], v[72:75], v[176:179], v[0:15]
    v_fmac_f32 v255, v38, v158
    v_fmac_f32 v255, v39, v159
    v_fmac_f32 v201, v40, v168
    s_add_u32 m0, s21, 2048
    v_mfma_f32_32x32x16_bf16 v[16:31], v[76:79], v[176:179], v[16:31]
    v_lshl_add_u32 v236, v236, 10, v246
    v_lshl_add_u32 v237, v237, 10, v246
    buffer_load_dwordx4 v236, s[4:7], s39 offen lds
    buffer_load_dwordx4 v237, s[8:11], s39 offen offset:1024 lds
    ds_read_b64_tr_b16 v[176:177], v244 offset:4096
    ds_read_b64_tr_b16 v[178:179], v244 offset:5120
    ds_read_b64_tr_b16 v[188:189], v245 offset:4096
    ds_read_b64_tr_b16 v[190:191], v245 offset:5120
    v_fmac_f32 v201, v41, v169
    v_permlane32_swap_b32 v197, v255
    s_waitcnt vmcnt(4) lgkmcnt(0)
    v_mfma_f32_32x32x16_bf16 v[0:15], v[80:83], v[176:179], v[0:15]
    v_fmac_f32 v201, v42, v170
    v_fmac_f32 v201, v43, v171
    v_fmac_f32 v201, v44, v172
    s_add_u32 m0, s21, 4096
    v_mfma_f32_32x32x16_bf16 v[16:31], v[84:87], v[176:179], v[16:31]
    v_lshl_add_u32 v238, v238, 10, v246
    v_lshl_add_u32 v239, v239, 10, v246
    buffer_load_dwordx4 v238, s[4:7], s40 offen lds
    buffer_load_dwordx4 v239, s[8:11], s40 offen offset:1024 lds
    ds_read_b64_tr_b16 v[176:177], v244 offset:6144
    ds_read_b64_tr_b16 v[178:179], v244 offset:7168
    ds_read_b64_tr_b16 v[192:193], v245 offset:6144
    ds_read_b64_tr_b16 v[194:195], v245 offset:7168
    v_fmac_f32 v201, v45, v173
    v_fmac_f32 v201, v46, v174
    v_fmac_f32 v201, v47, v175
    s_waitcnt lgkmcnt(0)
    s_mov_b64 exec, s[56:57]
    v_xor_b32 v92, 0x80008000, v92
    v_xor_b32 v93, 0x80008000, v93
    v_xor_b32 v94, 0x80008000, v94
    v_xor_b32 v95, 0x80008000, v95
    s_mov_b64 exec, -1
    v_mfma_f32_32x32x16_bf16 v[0:15], v[88:91], v[176:179], v[0:15]
    v_add_f32 v255, v197, v255
    s_set_gpr_idx_on s51, gpr_idx(DST)
    s_nop 0
    v_cvt_pk_bf16_f32 v206, v254, v255
    s_set_gpr_idx_off
    s_add_u32 m0, s21, 6144
    v_mfma_f32_32x32x16_bf16 v[16:31], v[92:95], v[176:179], v[16:31]
    v_lshl_add_u32 v240, v240, 10, v246
    v_lshl_add_u32 v241, v241, 10, v246
    buffer_load_dwordx4 v240, s[4:7], s41 offen lds
    buffer_load_dwordx4 v241, s[8:11], s41 offen offset:1024 lds
    v_mfma_f32_32x32x16_bf16 v[32:47], v[64:67], v[180:183], 0
    v_mul_f32 v254, v0, v144
    v_fmac_f32 v254, v1, v145
    v_fmac_f32 v254, v2, v146
    v_fmac_f32 v254, v3, v147
    v_fmac_f32 v254, v4, v148
    v_mfma_f32_32x32x16_bf16 v[48:63], v[68:71], v[180:183], v[48:63]
    v_fmac_f32 v254, v5, v149
    v_fmac_f32 v254, v6, v150
    v_fmac_f32 v254, v7, v151
    v_fma_f32 v202, v8, -v160, v202
    v_fma_f32 v202, v9, -v161, v202
    v_mfma_f32_32x32x16_bf16 v[32:47], v[72:75], v[184:187], v[32:47]
    v_permlane32_swap_b32 v254, v200
    v_fma_f32 v202, v10, -v162, v202
    v_fma_f32 v202, v11, -v163, v202
    v_fma_f32 v202, v12, -v164, v202
    v_fma_f32 v202, v13, -v165, v202
    v_mfma_f32_32x32x16_bf16 v[48:63], v[76:79], v[184:187], v[48:63]
    v_fma_f32 v202, v14, -v166, v202
    v_fma_f32 v202, v15, -v167, v202
    v_add_f32 v200, v254, v200
    v_fmac_f32 v198, v16, v112
    v_permlane32_swap_b32 v202, v254
    v_mfma_f32_32x32x16_bf16 v[32:47], v[80:83], v[188:191], v[32:47]
    v_fmac_f32 v198, v17, v113
    v_fmac_f32 v198, v18, v114
    v_fmac_f32 v198, v19, v115
    v_fmac_f32 v198, v20, v116
    v_fmac_f32 v198, v21, v117
    v_mfma_f32_32x32x16_bf16 v[48:63], v[84:87], v[188:191], v[48:63]
    s_waitcnt vmcnt(6)
    ds_read_b64_tr_b16 v[176:177], v244 offset:0
    ds_read_b64_tr_b16 v[178:179], v244 offset:1024
    ds_read_b64_tr_b16 v[180:181], v245 offset:0
    ds_read_b64_tr_b16 v[182:183], v245 offset:1024
    v_fmac_f32 v198, v22, v118
    v_fmac_f32 v198, v23, v119
    v_add_f32 v254, v202, v254
    v_mul_f32 v196, v24, v160
    v_fmac_f32 v196, v25, v161
    v_mfma_f32_32x32x16_bf16 v[32:47], v[88:91], v[192:195], v[32:47]
    v_fmac_f32 v196, v26, v162
    v_fmac_f32 v196, v27, v163
    v_fmac_f32 v196, v28, v164
    v_fmac_f32 v196, v29, v165
    v_fmac_f32 v196, v30, v166
    v_mfma_f32_32x32x16_bf16 v[48:63], v[92:95], v[192:195], v[48:63]
    v_add_u32 v249, s48, v249
    v_add_u32 v250, s49, v250
    ds_read_b32 v252, v251 offset:16
    ds_read_b64_tr_b16 v[64:65], v249 offset:0
    ds_read_b64_tr_b16 v[68:69], v249 offset:64
    ds_read_b64_tr_b16 v[66:67], v249 offset:256
    ds_read_b64_tr_b16 v[70:71], v249 offset:320
    s_mov_b64 exec, s[54:55]
    ds_read_u16_d16_hi v242, v250 offset:0
    s_mov_b64 exec, -1
    v_fmac_f32 v196, v31, v167
    s_nop 1
    v_permlane32_swap_b32 v198, v196
    v_add_f32 v196, v198, v196
    v_mul_f32 v255, v32, v152
    v_fmac_f32 v255, v33, v153
    v_fmac_f32 v255, v34, v154
    v_fmac_f32 v255, v35, v155
    v_fmac_f32 v255, v36, v156
    v_fmac_f32 v255, v37, v157
    v_fmac_f32 v255, v38, v158
    v_fmac_f32 v255, v39, v159
    v_fma_f32 v203, v40, -v168, v203
    v_fma_f32 v203, v41, -v169, v203
    v_permlane32_swap_b32 v255, v201
    v_fma_f32 v203, v42, -v170, v203
    v_fma_f32 v203, v43, -v171, v203
    v_fma_f32 v203, v44, -v172, v203
    v_fma_f32 v203, v45, -v173, v203
    v_fma_f32 v203, v46, -v174, v203
    v_fma_f32 v203, v47, -v175, v203
    v_add_f32 v201, v255, v201
    v_fmac_f32 v199, v48, v120
    v_permlane32_swap_b32 v203, v255
    v_fmac_f32 v199, v49, v121
    v_fmac_f32 v199, v50, v122
    v_fmac_f32 v199, v51, v123
    v_fmac_f32 v199, v52, v124
    v_fmac_f32 v199, v53, v125
    v_fmac_f32 v199, v54, v126
    v_fmac_f32 v199, v55, v127
    v_add_f32 v255, v203, v255
    v_mul_f32 v197, v56, v168
    v_fmac_f32 v197, v57, v169
    v_fmac_f32 v197, v58, v170
    v_fmac_f32 v197, v59, v171
    v_fmac_f32 v197, v60, v172
    v_fmac_f32 v197, v61, v173
    v_fmac_f32 v197, v62, v174
    v_fmac_f32 v197, v63, v175
    s_nop 1
    v_permlane32_swap_b32 v199, v197
    v_add_f32 v197, v199, v197
    s_set_gpr_idx_on s51, gpr_idx(DST)
    s_nop 0
    v_cvt_pk_bf16_f32 v207, v200, v201
    v_cvt_pk_bf16_f32 v209, v254, v255
    v_cvt_pk_bf16_f32 v208, v196, v197
    s_set_gpr_idx_off
    s_add_u32 s50, s50, 1
    s_add_u32 s51, s51, 6
    s_cmp_ge_u32 s50, 4
    s_cbranch_scc1 LAST0
    s_waitcnt lgkmcnt(5)
    v_readfirstlane_b32 s66, v252
    s_add_u32 s53, s53, 1
    v_mov_b32 v252, s53
    s_cmp_le_u32 s53, s66
    ds_write2_b32 v251, v252, v252 offset0:0 offset1:8
    s_setprio 1
    s_cbranch_scc1 PRIO_9
    s_setprio 0
PRIO_9:
    s_cmp_eq_u32 s52, 4
    s_cbranch_scc1 ITEM_0_4
    s_cmp_eq_u32 s52, 5
    s_cbranch_scc1 ITEM_0_5
    s_cmp_eq_u32 s52, 3
    s_cbranch_scc1 ITEM_0_3
    s_cmp_eq_u32 s52, 6
    s_cbranch_scc1 ITEM_0_6
    s_cmp_eq_u32 s52, 8
    s_cbranch_scc1 ITEM_0_8
    s_branch ITEM_0_2
.p2align 6
ITEM_0_2:
    s_mov_b32 m0, s50
    s_nop 0
    s_movrels_b32 s71, s23
    s_bfe_u32 s46, s71, 0x30012
    s_mov_b32 m0, s46
    s_and_b32 s66, s71, 0x3ffff
    s_movrels_b32 s68, s57
    s_movrels_b32 s69, s61
    s_sub_u32 s48, s66, s47
    s_mov_b32 s47, s66
    s_lshr_b32 s52, s71, 28
    s_lshl_b32 s67, s46, 9
    s_add_u32 s66, s66, s67
    s_sub_u32 s49, s66, s42
    s_mov_b32 s42, s66
    s_bfe_u32 s66, s68, 655360
    s_add_u32 s43, s42, s66
    s_bfe_u32 s39, s69, 655360
    s_bfe_u32 s66, s68, 655370
    s_add_u32 s44, s42, s66
    s_bfe_u32 s40, s69, 655370
    s_bfe_u32 s66, s68, 655380
    s_add_u32 s45, s42, s66
    s_bfe_u32 s41, s69, 655380
    s_and_b32 s66, s46, s33
    s_cselect_b32 s72, -1, 1
    s_cselect_b32 s76, s47, 163712
    s_cmp_ge_u32 s66, 2
    s_cselect_b32 s73, -1, 0
    s_add_u32 s77, s47, 1024
    s_cmp_ge_u32 s66, 4
    s_cselect_b32 s75, -1, 0
    s_cmp_ge_u32 s66, 3
    s_cselect_b32 s74, -1, 1
    s_cselect_b32 s77, s77, 163712
    v_add_u32 v252, s42, v247
    ds_read_u16 v234, v252
    ds_read_u16 v235, v252 offset:64
    v_add_u32 v252, s43, v247
    ds_read_u16 v236, v252
    ds_read_u16 v237, v252 offset:64
    v_add_u32 v252, s44, v247
    ds_read_u16 v238, v252
    ds_read_u16 v239, v252 offset:64
    v_add_u32 v252, s45, v247
    ds_read_u16 v240, v252
    ds_read_u16 v241, v252 offset:64
    s_waitcnt lgkmcnt(8)
    v_mul_f32_dpp v196, v242, v64 row_newbcast:0 row_mask:0xf bank_mask:0xf
    v_mul_f32_dpp v197, v242, v65 row_newbcast:1 row_mask:0xf bank_mask:0xf
    v_mul_f32_dpp v198, v242, v64 row_newbcast:8 row_mask:0xf bank_mask:0xf
    v_mul_f32_dpp v199, v242, v65 row_newbcast:9 row_mask:0xf bank_mask:0xf
    v_mul_f32_dpp v200, v242, v68 row_newbcast:2 row_mask:0xf bank_mask:0xf
    v_mul_f32_dpp v201, v242, v69 row_newbcast:3 row_mask:0xf bank_mask:0xf
    v_mul_f32_dpp v202, v242, v68 row_newbcast:10 row_mask:0xf bank_mask:0xf
    v_mul_f32_dpp v203, v242, v69 row_newbcast:11 row_mask:0xf bank_mask:0xf
    v_cvt_pk_bf16_f32 v64, v196, v197
    v_cvt_pk_bf16_f32 v68, v198, v199
    v_cvt_pk_bf16_f32 v65, v200, v201
    v_cvt_pk_bf16_f32 v69, v202, v203
    v_mul_f32_dpp v196, v242, v66 row_newbcast:4 row_mask:0xf bank_mask:0xf
    v_mul_f32_dpp v197, v242, v67 row_newbcast:5 row_mask:0xf bank_mask:0xf
    v_mul_f32_dpp v198, v242, v66 row_newbcast:12 row_mask:0xf bank_mask:0xf
    v_mul_f32_dpp v199, v242, v67 row_newbcast:13 row_mask:0xf bank_mask:0xf
    v_mul_f32_dpp v200, v242, v70 row_newbcast:6 row_mask:0xf bank_mask:0xf
    v_mul_f32_dpp v201, v242, v71 row_newbcast:7 row_mask:0xf bank_mask:0xf
    v_mul_f32_dpp v202, v242, v70 row_newbcast:14 row_mask:0xf bank_mask:0xf
    v_mul_f32_dpp v203, v242, v71 row_newbcast:15 row_mask:0xf bank_mask:0xf
    v_cvt_pk_bf16_f32 v66, v196, v197
    v_cvt_pk_bf16_f32 v70, v198, v199
    v_cvt_pk_bf16_f32 v67, v200, v201
    v_cvt_pk_bf16_f32 v71, v202, v203
    s_nop 0
    s_waitcnt lgkmcnt(6)
    v_mfma_f32_32x32x16_bf16 v[0:15], v[64:67], v[176:179], 0
    s_add_u32 m0, s21, 0
    v_mfma_f32_32x32x16_bf16 v[16:31], v[68:71], v[176:179], 0
    v_lshl_add_u32 v234, v234, 10, v246
    v_lshl_add_u32 v235, v235, 10, v246
    buffer_load_dwordx4 v234, s[4:7], s38 offen lds
    buffer_load_dwordx4 v235, s[8:11], s38 offen offset:1024 lds
    v_mfma_f32_32x32x16_bf16 v[32:47], v[64:67], v[180:183], 0
    s_nop 4
    v_mul_f32 v196, v0, v96
    v_fmac_f32 v196, v1, v97
    v_fmac_f32 v196, v2, v98
    v_fmac_f32 v196, v3, v99
    v_fmac_f32 v196, v4, v100
    v_fmac_f32 v196, v5, v101
    v_fmac_f32 v196, v6, v102
    v_fmac_f32 v196, v7, v103
    v_mul_f32 v198, v8, v128
    v_fmac_f32 v198, v9, v129
    v_fmac_f32 v198, v10, v130
    v_fmac_f32 v198, v11, v131
    v_fmac_f32 v198, v12, v132
    v_fmac_f32 v198, v13, v133
    v_fmac_f32 v198, v14, v134
    v_fmac_f32 v198, v15, v135
    v_mul_f32 v200, v16, v128
    v_fmac_f32 v200, v17, v129
    v_permlane32_swap_b32 v196, v198
    v_mfma_f32_32x32x16_bf16 v[48:63], v[68:71], v[180:183], 0
    v_add_u32 v253, s47, v248
    ds_read_b32 v254, v253
    ds_read_b32 v255, v253 offset:256
    s_waitcnt vmcnt(6)
    ds_read_b64_tr_b16 v[176:177], v244 offset:2048
    ds_read_b64_tr_b16 v[178:179], v244 offset:3072
    ds_read_b64_tr_b16 v[180:181], v245 offset:2048
    ds_read_b64_tr_b16 v[182:183], v245 offset:3072
    v_fmac_f32 v200, v18, v130
    v_fmac_f32 v200, v19, v131
    v_fmac_f32 v200, v20, v132
    v_fmac_f32 v200, v21, v133
    v_fmac_f32 v200, v22, v134
    v_fmac_f32 v200, v23, v135
    v_add_f32 v198, v196, v198
    v_mul_f32_e64 v202, v24, -v128
    v_fma_f32 v202, v25, -v129, v202
    v_fma_f32 v202, v26, -v130, v202
    v_fma_f32 v202, v27, -v131, v202
    v_fma_f32 v202, v28, -v132, v202
    v_fma_f32 v202, v29, -v133, v202
    v_fma_f32 v202, v30, -v134, v202
    v_fma_f32 v202, v31, -v135, v202
    s_nop 1
    v_permlane32_swap_b32 v200, v202
    v_add_f32 v202, v200, v202
    s_waitcnt lgkmcnt(0)
    v_mfma_f32_32x32x16_bf16 v[0:15], v[64:67], v[176:179], 0
    v_mul_f32 v197, v32, v104
    v_fmac_f32 v197, v33, v105
    v_fmac_f32 v197, v34, v106
    v_fmac_f32 v197, v35, v107
    v_fmac_f32 v197, v36, v108
    v_fmac_f32 v197, v37, v109
    v_fmac_f32 v197, v38, v110
    v_fmac_f32 v197, v39, v111
    v_mul_f32 v199, v40, v136
    v_fmac_f32 v199, v41, v137
    v_fmac_f32 v199, v42, v138
    v_fmac_f32 v199, v43, v139
    v_fmac_f32 v199, v44, v140
    v_fmac_f32 v199, v45, v141
    v_fmac_f32 v199, v46, v142
    v_fmac_f32 v199, v47, v143
    v_mul_f32 v201, v48, v136
    v_fmac_f32 v201, v49, v137
    v_permlane32_swap_b32 v197, v199
    v_fmac_f32 v201, v50, v138
    v_fmac_f32 v201, v51, v139
    s_add_u32 m0, s21, 2048
    v_mfma_f32_32x32x16_bf16 v[16:31], v[68:71], v[176:179], 0
    v_lshl_add_u32 v236, v236, 10, v246
    v_lshl_add_u32 v237, v237, 10, v246
    buffer_load_dwordx4 v236, s[4:7], s39 offen lds
    buffer_load_dwordx4 v237, s[8:11], s39 offen offset:1024 lds
    s_mov_b32 m0, s76
    s_mov_b64 exec, s[72:73]
    buffer_load_dwordx4 v254, s[12:15], 0 offen  lds
    s_mov_b32 m0, s77
    s_mov_b64 exec, s[74:75]
    buffer_load_dwordx4 v255, s[12:15], 0 offen  lds
    s_mov_b64 exec, -1
    v_fmac_f32 v201, v52, v140
    v_fmac_f32 v201, v53, v141
    v_fmac_f32 v201, v54, v142
    v_fmac_f32 v201, v55, v143
    v_add_f32 v199, v197, v199
    v_mul_f32_e64 v203, v56, -v136
    v_fma_f32 v203, v57, -v137, v203
    v_fma_f32 v203, v58, -v138, v203
    v_fma_f32 v203, v59, -v139, v203
    v_fma_f32 v203, v60, -v140, v203
    v_fma_f32 v203, v61, -v141, v203
    v_fma_f32 v203, v62, -v142, v203
    v_fma_f32 v203, v63, -v143, v203
    s_nop 1
    v_permlane32_swap_b32 v201, v203
    v_add_f32 v203, v201, v203
    s_set_gpr_idx_on s51, gpr_idx(DST)
    s_nop 0
    v_cvt_pk_bf16_f32 v204, v198, v199
    v_cvt_pk_bf16_f32 v205, v202, v203
    s_set_gpr_idx_off
    v_mfma_f32_32x32x16_bf16 v[32:47], v[64:67], v[180:183], 0
    v_mul_f32 v196, v0, v144
    v_fmac_f32 v196, v1, v145
    v_fmac_f32 v196, v2, v146
    v_fmac_f32 v196, v3, v147
    v_fmac_f32 v196, v4, v148
    v_fmac_f32 v196, v5, v149
    v_fmac_f32 v196, v6, v150
    v_fmac_f32 v196, v7, v151
    v_mul_f32 v198, v8, v112
    v_fmac_f32 v198, v9, v113
    v_fmac_f32 v198, v10, v114
    v_fmac_f32 v198, v11, v115
    v_fmac_f32 v198, v12, v116
    v_fmac_f32 v198, v13, v117
    v_fmac_f32 v198, v14, v118
    v_fmac_f32 v198, v15, v119
    v_mfma_f32_32x32x16_bf16 v[48:63], v[68:71], v[180:183], 0
    s_waitcnt vmcnt(8)
    ds_read_b64_tr_b16 v[176:177], v244 offset:4096
    ds_read_b64_tr_b16 v[178:179], v244 offset:5120
    ds_read_b64_tr_b16 v[180:181], v245 offset:4096
    ds_read_b64_tr_b16 v[182:183], v245 offset:5120
    v_mul_f32_e64 v200, v16, -v160
    v_fma_f32 v200, v17, -v161, v200
    v_fma_f32 v200, v18, -v162, v200
    v_fma_f32 v200, v19, -v163, v200
    v_fma_f32 v200, v20, -v164, v200
    v_fma_f32 v200, v21, -v165, v200
    v_fma_f32 v200, v22, -v166, v200
    v_fma_f32 v200, v23, -v167, v200
    v_mul_f32_e64 v202, v24, -v160
    v_fma_f32 v202, v25, -v161, v202
    v_fma_f32 v202, v26, -v162, v202
    v_fma_f32 v202, v27, -v163, v202
    v_fma_f32 v202, v28, -v164, v202
    v_fma_f32 v202, v29, -v165, v202
    v_fma_f32 v202, v30, -v166, v202
    v_fma_f32 v202, v31, -v167, v202
    s_waitcnt lgkmcnt(0)
    v_mfma_f32_32x32x16_bf16 v[0:15], v[64:67], v[176:179], 0
    v_mul_f32 v197, v32, v152
    v_fmac_f32 v197, v33, v153
    v_fmac_f32 v197, v34, v154
    v_fmac_f32 v197, v35, v155
    v_fmac_f32 v197, v36, v156
    v_fmac_f32 v197, v37, v157
    v_fmac_f32 v197, v38, v158
    v_fmac_f32 v197, v39, v159
    v_mul_f32 v199, v40, v120
    v_fmac_f32 v199, v41, v121
    v_fmac_f32 v199, v42, v122
    v_fmac_f32 v199, v43, v123
    v_fmac_f32 v199, v44, v124
    v_fmac_f32 v199, v45, v125
    v_fmac_f32 v199, v46, v126
    v_fmac_f32 v199, v47, v127
    s_add_u32 m0, s21, 4096
    v_mfma_f32_32x32x16_bf16 v[16:31], v[68:71], v[176:179], 0
    v_lshl_add_u32 v238, v238, 10, v246
    v_lshl_add_u32 v239, v239, 10, v246
    buffer_load_dwordx4 v238, s[4:7], s40 offen lds
    buffer_load_dwordx4 v239, s[8:11], s40 offen offset:1024 lds
    v_mul_f32_e64 v201, v48, -v168
    v_fma_f32 v201, v49, -v169, v201
    v_fma_f32 v201, v50, -v170, v201
    v_fma_f32 v201, v51, -v171, v201
    v_fma_f32 v201, v52, -v172, v201
    v_fma_f32 v201, v53, -v173, v201
    v_fma_f32 v201, v54, -v174, v201
    v_fma_f32 v201, v55, -v175, v201
    v_mul_f32_e64 v203, v56, -v168
    v_fma_f32 v203, v57, -v169, v203
    v_fma_f32 v203, v58, -v170, v203
    v_fma_f32 v203, v59, -v171, v203
    v_fma_f32 v203, v60, -v172, v203
    v_fma_f32 v203, v61, -v173, v203
    v_fma_f32 v203, v62, -v174, v203
    v_fma_f32 v203, v63, -v175, v203
    v_mfma_f32_32x32x16_bf16 v[32:47], v[64:67], v[180:183], 0
    v_mul_f32 v254, v0, v144
    v_fmac_f32 v254, v1, v145
    v_fmac_f32 v254, v2, v146
    v_fmac_f32 v254, v3, v147
    v_fmac_f32 v254, v4, v148
    v_fmac_f32 v254, v5, v149
    v_fmac_f32 v254, v6, v150
    v_fmac_f32 v254, v7, v151
    v_fmac_f32 v200, v8, v160
    v_mfma_f32_32x32x16_bf16 v[48:63], v[68:71], v[180:183], 0
    ds_swizzle_b32 v68, v68 offset:0x401F
    ds_swizzle_b32 v69, v69 offset:0x401F
    ds_swizzle_b32 v70, v70 offset:0x401F
    ds_swizzle_b32 v71, v71 offset:0x401F
    s_waitcnt vmcnt(8)
    ds_read_b64_tr_b16 v[176:177], v244 offset:6144
    ds_read_b64_tr_b16 v[178:179], v244 offset:7168
    ds_read_b64_tr_b16 v[180:181], v245 offset:6144
    ds_read_b64_tr_b16 v[182:183], v245 offset:7168
    v_fmac_f32 v200, v9, v161
    v_permlane32_swap_b32 v196, v254
    v_fmac_f32 v200, v10, v162
    v_fmac_f32 v200, v11, v163
    v_fmac_f32 v200, v12, v164
    v_fmac_f32 v200, v13, v165
    v_fmac_f32 v200, v14, v166
    v_fmac_f32 v200, v15, v167
    v_add_f32 v254, v196, v254
    s_waitcnt lgkmcnt(0)
    s_mov_b64 exec, s[56:57]
    v_xor_b32 v68, 0x80008000, v68
    v_xor_b32 v69, 0x80008000, v69
    v_xor_b32 v70, 0x80008000, v70
    v_xor_b32 v71, 0x80008000, v71
    s_mov_b64 exec, -1
    s_nop 0
    v_mfma_f32_32x32x16_bf16 v[0:15], v[64:67], v[176:179], 0
    v_mul_f32 v255, v32, v152
    v_fmac_f32 v255, v33, v153
    v_fmac_f32 v255, v34, v154
    v_fmac_f32 v255, v35, v155
    v_fmac_f32 v255, v36, v156
    v_fmac_f32 v255, v37, v157
    v_fmac_f32 v255, v38, v158
    v_fmac_f32 v255, v39, v159
    v_fmac_f32 v201, v40, v168
    v_fmac_f32 v201, v41, v169
    v_permlane32_swap_b32 v197, v255
    s_add_u32 m0, s21, 6144
    v_mfma_f32_32x32x16_bf16 v[16:31], v[68:71], v[176:179], v[16:31]
    v_lshl_add_u32 v240, v240, 10, v246
    v_lshl_add_u32 v241, v241, 10, v246
    buffer_load_dwordx4 v240, s[4:7], s41 offen lds
    buffer_load_dwordx4 v241, s[8:11], s41 offen offset:1024 lds
    v_fmac_f32 v201, v42, v170
    v_fmac_f32 v201, v43, v171
    v_fmac_f32 v201, v44, v172
    v_fmac_f32 v201, v45, v173
    v_fmac_f32 v201, v46, v174
    v_fmac_f32 v201, v47, v175
    v_add_f32 v255, v197, v255
    s_set_gpr_idx_on s51, gpr_idx(DST)
    s_nop 0
    v_cvt_pk_bf16_f32 v206, v254, v255
    s_set_gpr_idx_off
    v_mfma_f32_32x32x16_bf16 v[32:47], v[64:67], v[180:183], 0
    v_mul_f32 v254, v0, v144
    v_fmac_f32 v254, v1, v145
    v_fmac_f32 v254, v2, v146
    v_fmac_f32 v254, v3, v147
    v_fmac_f32 v254, v4, v148
    v_fmac_f32 v254, v5, v149
    v_fmac_f32 v254, v6, v150
    v_fmac_f32 v254, v7, v151
    v_fma_f32 v202, v8, -v160, v202
    v_fma_f32 v202, v9, -v161, v202
    v_permlane32_swap_b32 v254, v200
    v_fma_f32 v202, v10, -v162, v202
    v_fma_f32 v202, v11, -v163, v202
    v_fma_f32 v202, v12, -v164, v202
    v_fma_f32 v202, v13, -v165, v202
    v_fma_f32 v202, v14, -v166, v202
    v_fma_f32 v202, v15, -v167, v202
    v_add_f32 v200, v254, v200
    v_fmac_f32 v198, v16, v112
    v_permlane32_swap_b32 v202, v254
    v_mfma_f32_32x32x16_bf16 v[48:63], v[68:71], v[180:183], v[48:63]
    s_waitcnt vmcnt(4)
    ds_read_b64_tr_b16 v[176:177], v244 offset:0
    ds_read_b64_tr_b16 v[178:179], v244 offset:1024
    ds_read_b64_tr_b16 v[180:181], v245 offset:0
    ds_read_b64_tr_b16 v[182:183], v245 offset:1024
    v_add_u32 v249, s48, v249
    v_add_u32 v250, s49, v250
    ds_read_b32 v252, v251 offset:16
    ds_read_b64_tr_b16 v[64:65], v249 offset:0
    ds_read_b64_tr_b16 v[68:69], v249 offset:64
    ds_read_b64_tr_b16 v[66:67], v249 offset:256
    ds_read_b64_tr_b16 v[70:71], v249 offset:320
    s_mov_b64 exec, s[54:55]
    ds_read_u16_d16_hi v242, v250 offset:0
    s_mov_b64 exec, -1
    v_fmac_f32 v198, v17, v113
    v_fmac_f32 v198, v18, v114
    v_fmac_f32 v198, v19, v115
    v_fmac_f32 v198, v20, v116
    v_fmac_f32 v198, v21, v117
    v_fmac_f32 v198, v22, v118
    v_fmac_f32 v198, v23, v119
    v_add_f32 v254, v202, v254
    v_mul_f32 v196, v24, v160
    v_fmac_f32 v196, v25, v161
    v_fmac_f32 v196, v26, v162
    v_fmac_f32 v196, v27, v163
    v_fmac_f32 v196, v28, v164
    v_fmac_f32 v196, v29, v165
    v_fmac_f32 v196, v30, v166
    v_fmac_f32 v196, v31, v167
    s_nop 1
    v_permlane32_swap_b32 v198, v196
    v_add_f32 v196, v198, v196
    v_mul_f32 v255, v32, v152
    v_fmac_f32 v255, v33, v153
    v_fmac_f32 v255, v34, v154
    v_fmac_f32 v255, v35, v155
    v_fmac_f32 v255, v36, v156
    v_fmac_f32 v255, v37, v157
    v_fmac_f32 v255, v38, v158
    v_fmac_f32 v255, v39, v159
    v_fma_f32 v203, v40, -v168, v203
    v_fma_f32 v203, v41, -v169, v203
    v_permlane32_swap_b32 v255, v201
    v_fma_f32 v203, v42, -v170, v203
    v_fma_f32 v203, v43, -v171, v203
    v_fma_f32 v203, v44, -v172, v203
    v_fma_f32 v203, v45, -v173, v203
    v_fma_f32 v203, v46, -v174, v203
    v_fma_f32 v203, v47, -v175, v203
    v_add_f32 v201, v255, v201
    v_fmac_f32 v199, v48, v120
    v_permlane32_swap_b32 v203, v255
    v_fmac_f32 v199, v49, v121
    v_fmac_f32 v199, v50, v122
    v_fmac_f32 v199, v51, v123
    v_fmac_f32 v199, v52, v124
    v_fmac_f32 v199, v53, v125
    v_fmac_f32 v199, v54, v126
    v_fmac_f32 v199, v55, v127
    v_add_f32 v255, v203, v255
    v_mul_f32 v197, v56, v168
    v_fmac_f32 v197, v57, v169
    v_fmac_f32 v197, v58, v170
    v_fmac_f32 v197, v59, v171
    v_fmac_f32 v197, v60, v172
    v_fmac_f32 v197, v61, v173
    v_fmac_f32 v197, v62, v174
    v_fmac_f32 v197, v63, v175
    s_nop 1
    v_permlane32_swap_b32 v199, v197
    v_add_f32 v197, v199, v197
    s_set_gpr_idx_on s51, gpr_idx(DST)
    s_nop 0
    v_cvt_pk_bf16_f32 v207, v200, v201
    v_cvt_pk_bf16_f32 v209, v254, v255
    v_cvt_pk_bf16_f32 v208, v196, v197
    s_set_gpr_idx_off
    s_add_u32 s50, s50, 1
    s_add_u32 s51, s51, 6
    s_cmp_ge_u32 s50, 4
    s_cbranch_scc1 LAST0
    s_waitcnt lgkmcnt(5)
    v_readfirstlane_b32 s66, v252
    s_add_u32 s53, s53, 1
    v_mov_b32 v252, s53
    s_cmp_le_u32 s53, s66
    ds_write2_b32 v251, v252, v252 offset0:0 offset1:8
    s_setprio 1
    s_cbranch_scc1 PRIO_10
    s_setprio 0
PRIO_10:
    s_cmp_eq_u32 s52, 4
    s_cbranch_scc1 ITEM_0_4
    s_cmp_eq_u32 s52, 5
    s_cbranch_scc1 ITEM_0_5
    s_cmp_eq_u32 s52, 3
    s_cbranch_scc1 ITEM_0_3
    s_cmp_eq_u32 s52, 6
    s_cbranch_scc1 ITEM_0_6
    s_cmp_eq_u32 s52, 8
    s_cbranch_scc1 ITEM_0_8
    s_branch ITEM_0_2
.p2align 6
ITEM_1_4:
    s_mov_b64 exec, s[54:55]
    ds_read_u16_d16_hi v243, v250 offset:128
    s_mov_b64 exec, -1
    ds_read_b64_tr_b16 v[72:73], v249 offset:512
    ds_read_b64_tr_b16 v[76:77], v249 offset:576
    ds_read_b64_tr_b16 v[74:75], v249 offset:768
    ds_read_b64_tr_b16 v[78:79], v249 offset:832
    s_waitcnt lgkmcnt(5)
    v_mul_f32_dpp v196, v242, v64 row_newbcast:0 row_mask:0xf bank_mask:0xf
    v_mul_f32_dpp v197, v242, v65 row_newbcast:1 row_mask:0xf bank_mask:0xf
    v_mul_f32_dpp v198, v242, v64 row_newbcast:8 row_mask:0xf bank_mask:0xf
    v_mul_f32_dpp v199, v242, v65 row_newbcast:9 row_mask:0xf bank_mask:0xf
    v_mul_f32_dpp v200, v242, v68 row_newbcast:2 row_mask:0xf bank_mask:0xf
    v_mul_f32_dpp v201, v242, v69 row_newbcast:3 row_mask:0xf bank_mask:0xf
    v_mul_f32_dpp v202, v242, v68 row_newbcast:10 row_mask:0xf bank_mask:0xf
    v_mul_f32_dpp v203, v242, v69 row_newbcast:11 row_mask:0xf bank_mask:0xf
    v_cvt_pk_bf16_f32 v64, v196, v197
    v_cvt_pk_bf16_f32 v68, v198, v199
    v_cvt_pk_bf16_f32 v65, v200, v201
    v_cvt_pk_bf16_f32 v69, v202, v203
    v_mul_f32_dpp v196, v242, v66 row_newbcast:4 row_mask:0xf bank_mask:0xf
    v_mul_f32_dpp v197, v242, v67 row_newbcast:5 row_mask:0xf bank_mask:0xf
    v_mul_f32_dpp v198, v242, v66 row_newbcast:12 row_mask:0xf bank_mask:0xf
    v_mul_f32_dpp v199, v242, v67 row_newbcast:13 row_mask:0xf bank_mask:0xf
    v_mul_f32_dpp v200, v242, v70 row_newbcast:6 row_mask:0xf bank_mask:0xf
    v_mul_f32_dpp v201, v242, v71 row_newbcast:7 row_mask:0xf bank_mask:0xf
    v_mul_f32_dpp v202, v242, v70 row_newbcast:14 row_mask:0xf bank_mask:0xf
    v_mul_f32_dpp v203, v242, v71 row_newbcast:15 row_mask:0xf bank_mask:0xf
    v_cvt_pk_bf16_f32 v66, v196, v197
    v_cvt_pk_bf16_f32 v70, v198, v199
    v_cvt_pk_bf16_f32 v67, v200, v201
    v_cvt_pk_bf16_f32 v71, v202, v203
    s_nop 0
    s_waitcnt vmcnt(4) lgkmcnt(0)
    v_mfma_f32_32x32x16_bf16 v[0:15], v[64:67], v[176:179], 0
    v_mul_f32_dpp v196, v243, v72 row_newbcast:0 row_mask:0xf bank_mask:0xf
    v_mul_f32_dpp v197, v243, v73 row_newbcast:1 row_mask:0xf bank_mask:0xf
    v_mul_f32_dpp v198, v243, v72 row_newbcast:8 row_mask:0xf bank_mask:0xf
    v_mul_f32_dpp v199, v243, v73 row_newbcast:9 row_mask:0xf bank_mask:0xf
    v_mul_f32_dpp v200, v243, v76 row_newbcast:2 row_mask:0xf bank_mask:0xf
    v_mul_f32_dpp v201, v243, v77 row_newbcast:3 row_mask:0xf bank_mask:0xf
    v_mul_f32_dpp v202, v243, v76 row_newbcast:10 row_mask:0xf bank_mask:0xf
    v_mul_f32_dpp v203, v243, v77 row_newbcast:11 row_mask:0xf bank_mask:0xf
    v_cvt_pk_bf16_f32 v72, v196, v197
    v_cvt_pk_bf16_f32 v76, v198, v199
    v_cvt_pk_bf16_f32 v73, v200, v201
    v_cvt_pk_bf16_f32 v77, v202, v203
    s_add_u32 m0, s21, 0
    v_mfma_f32_32x32x16_bf16 v[16:31], v[68:71], v[176:179], 0
    buffer_load_dwordx4 v234, s[4:7], s36 offen lds
    buffer_load_dwordx4 v235, s[8:11], s36 offen offset:1024 lds
    ds_read_b64_tr_b16 v[176:177], v244 offset:2048
    ds_read_b64_tr_b16 v[178:179], v244 offset:3072
    ds_read_b64_tr_b16 v[184:185], v245 offset:2048
    ds_read_b64_tr_b16 v[186:187], v245 offset:3072
    v_mul_f32_dpp v196, v243, v74 row_newbcast:4 row_mask:0xf bank_mask:0xf
    v_mul_f32_dpp v197, v243, v75 row_newbcast:5 row_mask:0xf bank_mask:0xf
    v_mul_f32_dpp v198, v243, v74 row_newbcast:12 row_mask:0xf bank_mask:0xf
    v_mul_f32_dpp v199, v243, v75 row_newbcast:13 row_mask:0xf bank_mask:0xf
    v_mul_f32_dpp v200, v243, v78 row_newbcast:6 row_mask:0xf bank_mask:0xf
    v_mul_f32_dpp v201, v243, v79 row_newbcast:7 row_mask:0xf bank_mask:0xf
    v_mul_f32_dpp v202, v243, v78 row_newbcast:14 row_mask:0xf bank_mask:0xf
    v_mul_f32_dpp v203, v243, v79 row_newbcast:15 row_mask:0xf bank_mask:0xf
    v_cvt_pk_bf16_f32 v74, v196, v197
    v_cvt_pk_bf16_f32 v78, v198, v199
    v_cvt_pk_bf16_f32 v75, v200, v201
    v_cvt_pk_bf16_f32 v79, v202, v203
    s_nop 0
    s_waitcnt lgkmcnt(0)
    v_mfma_f32_32x32x16_bf16 v[0:15], v[72:75], v[176:179], v[0:15]
    s_add_u32 m0, s21, 2048
    v_mfma_f32_32x32x16_bf16 v[16:31], v[76:79], v[176:179], v[16:31]
    buffer_load_dwordx4 v236, s[4:7], s36 offen lds
    buffer_load_dwordx4 v237, s[8:11], s36 offen offset:1024 lds
    s_mov_b32 m0, s50
    s_nop 0
    s_movrels_b32 s71, s23
    s_movrels_b32 s33, s28
    s_and_b32 s70, s33, 0x70
    s_andn2_b32 s33, s33, 0x70
    v_xor_b32 v253, s70, v248
    v_add_u32 v253, s33, v253
    s_bfe_u32 s46, s71, 0x30012
    s_mov_b32 m0, s46
    s_and_b32 s66, s71, 0x3ffff
    s_movrels_b32 s68, s57
    s_movrels_b32 s69, s61
    s_sub_u32 s48, s66, s47
    s_mov_b32 s47, s66
    s_lshr_b32 s52, s71, 28
    s_lshl_b32 s67, s46, 9
    s_add_u32 s66, s66, s67
    s_sub_u32 s49, s66, s42
    s_mov_b32 s42, s66
    s_bfe_u32 s66, s68, 655360
    s_add_u32 s43, s42, s66
    s_bfe_u32 s39, s69, 655360
    s_bfe_u32 s66, s68, 655370
    s_add_u32 s44, s42, s66
    s_bfe_u32 s40, s69, 655370
    s_bfe_u32 s66, s68, 655380
    s_add_u32 s45, s42, s66
    s_bfe_u32 s41, s69, 655380
    v_add_u32 v252, s44, v247
    ds_read_u16 v238, v252
    ds_read_u16 v239, v252 offset:64
    v_add_u32 v252, s45, v247
    ds_read_u16 v240, v252
    ds_read_u16 v241, v252 offset:64
    v_mfma_f32_32x32x16_bf16 v[32:47], v[64:67], v[180:183], 0
    v_mul_f32 v196, v0, v96
    v_fmac_f32 v196, v1, v97
    v_fmac_f32 v196, v2, v98
    v_fmac_f32 v196, v3, v99
    v_fmac_f32 v196, v4, v100
    v_fmac_f32 v196, v5, v101
    v_fmac_f32 v196, v6, v102
    v_fmac_f32 v196, v7, v103
    v_mul_f32 v198, v8, v128
    v_fmac_f32 v198, v9, v129
    v_mfma_f32_32x32x16_bf16 v[48:63], v[68:71], v[180:183], 0
    s_waitcnt vmcnt(6)
    ds_read_b64_tr_b16 v[176:177], v244 offset:4096
    ds_read_b64_tr_b16 v[178:179], v244 offset:5120
    ds_read_b64_tr_b16 v[180:181], v245 offset:4096
    ds_read_b64_tr_b16 v[182:183], v245 offset:5120
    v_fmac_f32 v198, v10, v130
    v_fmac_f32 v198, v11, v131
    v_fmac_f32 v198, v12, v132
    v_fmac_f32 v198, v13, v133
    v_fmac_f32 v198, v14, v134
    v_fmac_f32 v198, v15, v135
    v_mul_f32 v200, v16, v128
    v_fmac_f32 v200, v17, v129
    v_permlane32_swap_b32 v196, v198
    v_mfma_f32_32x32x16_bf16 v[32:47], v[72:75], v[184:187], v[32:47]
    v_fmac_f32 v200, v18, v130
    v_fmac_f32 v200, v19, v131
    v_fmac_f32 v200, v20, v132
    v_fmac_f32 v200, v21, v133
    v_fmac_f32 v200, v22, v134
    v_fmac_f32 v200, v23, v135
    v_add_f32 v198, v196, v198
    v_mul_f32_e64 v202, v24, -v128
    v_fma_f32 v202, v25, -v129, v202
    v_mfma_f32_32x32x16_bf16 v[48:63], v[76:79], v[184:187], v[48:63]
    v_fma_f32 v202, v26, -v130, v202
    v_fma_f32 v202, v27, -v131, v202
    v_fma_f32 v202, v28, -v132, v202
    v_fma_f32 v202, v29, -v133, v202
    v_fma_f32 v202, v30, -v134, v202
    v_fma_f32 v202, v31, -v135, v202
    s_nop 1
    v_permlane32_swap_b32 v200, v202
    v_add_f32 v202, v200, v202
    s_waitcnt vmcnt(4) lgkmcnt(0)
    v_mfma_f32_32x32x16_bf16 v[0:15], v[64:67], v[176:179], 0
    v_mul_f32 v197, v32, v104
    v_fmac_f32 v197, v33, v105
    v_fmac_f32 v197, v34, v106
    v_fmac_f32 v197, v35, v107
    v_fmac_f32 v197, v36, v108
    v_fmac_f32 v197, v37, v109
    v_fmac_f32 v197, v38, v110
    v_fmac_f32 v197, v39, v111
    v_mul_f32 v199, v40, v136
    v_fmac_f32 v199, v41, v137
    s_add_u32 m0, s21, 4096
    v_mfma_f32_32x32x16_bf16 v[16:31], v[68:71], v[176:179], 0
    buffer_load_dwordx4 v234, s[4:7], s37 offen lds
    buffer_load_dwordx4 v235, s[8:11], s37 offen offset:1024 lds
    ds_read_b64_tr_b16 v[176:177], v244 offset:6144
    ds_read_b64_tr_b16 v[178:179], v244 offset:7168
    ds_read_b64_tr_b16 v[184:185], v245 offset:6144
    ds_read_b64_tr_b16 v[186:187], v245 offset:7168
    v_add_u32 v252, s42, v247
    ds_read_u16 v234, v252
    ds_read_u16 v235, v252 offset:64
    v_fmac_f32 v199, v42, v138
    v_fmac_f32 v199, v43, v139
    v_fmac_f32 v199, v44, v140
    v_fmac_f32 v199, v45, v141
    v_fmac_f32 v199, v46, v142
    v_fmac_f32 v199, v47, v143
    v_mul_f32 v201, v48, v136
    v_fmac_f32 v201, v49, v137
    v_permlane32_swap_b32 v197, v199
    v_fmac_f32 v201, v50, v138
    s_waitcnt lgkmcnt(2)
    v_mfma_f32_32x32x16_bf16 v[0:15], v[72:75], v[176:179], v[0:15]
    v_fmac_f32 v201, v51, v139
    v_fmac_f32 v201, v52, v140
    v_fmac_f32 v201, v53, v141
    v_fmac_f32 v201, v54, v142
    v_fmac_f32 v201, v55, v143
    v_add_f32 v199, v197, v199
    v_mul_f32_e64 v203, v56, -v136
    v_fma_f32 v203, v57, -v137, v203
    v_fma_f32 v203, v58, -v138, v203
    v_fma_f32 v203, v59, -v139, v203
    s_add_u32 m0, s21, 6144
    v_mfma_f32_32x32x16_bf16 v[16:31], v[76:79], v[176:179], v[16:31]
    buffer_load_dwordx4 v236, s[4:7], s37 offen lds
    buffer_load_dwordx4 v237, s[8:11], s37 offen offset:1024 lds
    v_add_u32 v252, s43, v247
    ds_read_u16 v236, v252
    ds_read_u16 v237, v252 offset:64
    v_fma_f32 v203, v60, -v140, v203
    v_fma_f32 v203, v61, -v141, v203
    v_fma_f32 v203, v62, -v142, v203
    v_fma_f32 v203, v63, -v143, v203
    s_nop 1
    v_permlane32_swap_b32 v201, v203
    v_add_f32 v203, v201, v203
    v_cvt_pk_bf16_f32 v198, v198, v199
    v_cvt_pk_bf16_f32 v202, v202, v203
    ds_write2st64_b32 v253, v198, v202 offset0:0 offset1:1
    v_mfma_f32_32x32x16_bf16 v[32:47], v[64:67], v[180:183], 0
    v_mul_f32 v196, v0, v144
    v_fmac_f32 v196, v1, v145
    v_fmac_f32 v196, v2, v146
    v_fmac_f32 v196, v3, v147
    v_fmac_f32 v196, v4, v148
    v_fmac_f32 v196, v5, v149
    v_fmac_f32 v196, v6, v150
    v_fmac_f32 v196, v7, v151
    v_mfma_f32_32x32x16_bf16 v[48:63], v[68:71], v[180:183], 0
    s_waitcnt vmcnt(6)
    ds_read_b64_tr_b16 v[176:177], v244 offset:0
    ds_read_b64_tr_b16 v[178:179], v244 offset:1024
    ds_read_b64_tr_b16 v[180:181], v245 offset:0
    ds_read_b64_tr_b16 v[182:183], v245 offset:1024
    v_mul_f32 v198, v8, v112
    v_fmac_f32 v198, v9, v113
    v_fmac_f32 v198, v10, v114
    v_fmac_f32 v198, v11, v115
    v_fmac_f32 v198, v12, v116
    v_fmac_f32 v198, v13, v117
    v_fmac_f32 v198, v14, v118
    v_fmac_f32 v198, v15, v119
    v_mfma_f32_32x32x16_bf16 v[32:47], v[72:75], v[184:187], v[32:47]
    v_mul_f32_e64 v200, v16, -v160
    v_fma_f32 v200, v17, -v161, v200
    v_fma_f32 v200, v18, -v162, v200
    v_fma_f32 v200, v19, -v163, v200
    v_fma_f32 v200, v20, -v164, v200
    v_fma_f32 v200, v21, -v165, v200
    v_fma_f32 v200, v22, -v166, v200
    v_fma_f32 v200, v23, -v167, v200
    v_mfma_f32_32x32x16_bf16 v[48:63], v[76:79], v[184:187], v[48:63]
    v_mul_f32_e64 v202, v24, -v160
    v_fma_f32 v202, v25, -v161, v202
    v_fma_f32 v202, v26, -v162, v202
    v_fma_f32 v202, v27, -v163, v202
    v_fma_f32 v202, v28, -v164, v202
    v_fma_f32 v202, v29, -v165, v202
    v_fma_f32 v202, v30, -v166, v202
    v_fma_f32 v202, v31, -v167, v202
    s_waitcnt vmcnt(4) lgkmcnt(0)
    v_mfma_f32_32x32x16_bf16 v[0:15], v[64:67], v[176:179], 0
    v_mul_f32 v197, v32, v152
    v_fmac_f32 v197, v33, v153
    v_fmac_f32 v197, v34, v154
    v_fmac_f32 v197, v35, v155
    v_fmac_f32 v197, v36, v156
    v_fmac_f32 v197, v37, v157
    v_fmac_f32 v197, v38, v158
    v_fmac_f32 v197, v39, v159
    s_add_u32 m0, s21, 0
    v_mfma_f32_32x32x16_bf16 v[16:31], v[68:71], v[176:179], 0
    v_lshl_add_u32 v234, v234, 10, v246
    v_lshl_add_u32 v235, v235, 10, v246
    buffer_load_dwordx4 v234, s[4:7], s38 offen lds
    buffer_load_dwordx4 v235, s[8:11], s38 offen offset:1024 lds
    ds_read_b64_tr_b16 v[176:177], v244 offset:2048
    ds_read_b64_tr_b16 v[178:179], v244 offset:3072
    ds_read_b64_tr_b16 v[184:185], v245 offset:2048
    ds_read_b64_tr_b16 v[186:187], v245 offset:3072
    v_mul_f32 v199, v40, v120
    v_fmac_f32 v199, v41, v121
    v_fmac_f32 v199, v42, v122
    v_fmac_f32 v199, v43, v123
    v_fmac_f32 v199, v44, v124
    v_fmac_f32 v199, v45, v125
    v_fmac_f32 v199, v46, v126
    v_fmac_f32 v199, v47, v127
    s_waitcnt lgkmcnt(0)
    v_mfma_f32_32x32x16_bf16 v[0:15], v[72:75], v[176:179], v[0:15]
    v_mul_f32_e64 v201, v48, -v168
    v_fma_f32 v201, v49, -v169, v201
    v_fma_f32 v201, v50, -v170, v201
    v_fma_f32 v201, v51, -v171, v201
    v_fma_f32 v201, v52, -v172, v201
    v_fma_f32 v201, v53, -v173, v201
    v_fma_f32 v201, v54, -v174, v201
    v_fma_f32 v201, v55, -v175, v201
    s_add_u32 m0, s21, 2048
    v_mfma_f32_32x32x16_bf16 v[16:31], v[76:79], v[176:179], v[16:31]
    v_lshl_add_u32 v236, v236, 10, v246
    v_lshl_add_u32 v237, v237, 10, v246
    buffer_load_dwordx4 v236, s[4:7], s39 offen lds
    buffer_load_dwordx4 v237, s[8:11], s39 offen offset:1024 lds
    v_mul_f32_e64 v203, v56, -v168
    v_fma_f32 v203, v57, -v169, v203
    v_fma_f32 v203, v58, -v170, v203
    v_fma_f32 v203, v59, -v171, v203
    v_fma_f32 v203, v60, -v172, v203
    v_fma_f32 v203, v61, -v173, v203
    v_fma_f32 v203, v62, -v174, v203
    v_fma_f32 v203, v63, -v175, v203
    v_mfma_f32_32x32x16_bf16 v[32:47], v[64:67], v[180:183], 0
    v_mul_f32 v254, v0, v144
    v_fmac_f32 v254, v1, v145
    v_fmac_f32 v254, v2, v146
    v_fmac_f32 v254, v3, v147
    v_fmac_f32 v254, v4, v148
    v_mfma_f32_32x32x16_bf16 v[48:63], v[68:71], v[180:183], 0
    ds_swizzle_b32 v68, v68 offset:0x401F
    ds_swizzle_b32 v69, v69 offset:0x401F
    ds_swizzle_b32 v70, v70 offset:0x401F
    ds_swizzle_b32 v71, v71 offset:0x401F
    s_waitcnt vmcnt(6)
    ds_read_b64_tr_b16 v[176:177], v244 offset:4096
    ds_read_b64_tr_b16 v[178:179], v244 offset:5120
    ds_read_b64_tr_b16 v[180:181], v245 offset:4096
    ds_read_b64_tr_b16 v[182:183], v245 offset:5120
    v_fmac_f32 v254, v5, v149
    v_fmac_f32 v254, v6, v150
    v_fmac_f32 v254, v7, v151
    v_fmac_f32 v200, v8, v160
    v_mfma_f32_32x32x16_bf16 v[32:47], v[72:75], v[184:187], v[32:47]
    v_fmac_f32 v200, v9, v161
    v_permlane32_swap_b32 v196, v254
    v_fmac_f32 v200, v10, v162
    v_fmac_f32 v200, v11, v163
    v_fmac_f32 v200, v12, v164
    v_mfma_f32_32x32x16_bf16 v[48:63], v[76:79], v[184:187], v[48:63]
    ds_swizzle_b32 v76, v76 offset:0x401F
    ds_swizzle_b32 v77, v77 offset:0x401F
    ds_swizzle_b32 v78, v78 offset:0x401F
    ds_swizzle_b32 v79, v79 offset:0x401F
    v_fmac_f32 v200, v13, v165
    v_fmac_f32 v200, v14, v166
    v_fmac_f32 v200, v15, v167
    v_add_f32 v254, v196, v254
    s_waitcnt lgkmcnt(8)
    s_mov_b64 exec, s[56:57]
    v_xor_b32 v68, 0x80008000, v68
    v_xor_b32 v69, 0x80008000, v69
    v_xor_b32 v70, 0x80008000, v70
    v_xor_b32 v71, 0x80008000, v71
    s_mov_b64 exec, -1
    s_waitcnt vmcnt(4) lgkmcnt(4)
    v_mfma_f32_32x32x16_bf16 v[0:15], v[64:67], v[176:179], 0
    v_mul_f32 v255, v32, v152
    v_fmac_f32 v255, v33, v153
    v_fmac_f32 v255, v34, v154
    v_fmac_f32 v255, v35, v155
    v_fmac_f32 v255, v36, v156
    s_add_u32 m0, s21, 4096
    v_mfma_f32_32x32x16_bf16 v[16:31], v[68:71], v[176:179], v[16:31]
    v_lshl_add_u32 v238, v238, 10, v246
    v_lshl_add_u32 v239, v239, 10, v246
    buffer_load_dwordx4 v238, s[4:7], s40 offen lds
    buffer_load_dwordx4 v239, s[8:11], s40 offen offset:1024 lds
    ds_read_b64_tr_b16 v[176:177], v244 offset:6144
    ds_read_b64_tr_b16 v[178:179], v244 offset:7168
    ds_read_b64_tr_b16 v[184:185], v245 offset:6144
    ds_read_b64_tr_b16 v[186:187], v245 offset:7168
    v_fmac_f32 v255, v37, v157
    v_fmac_f32 v255, v38, v158
    v_fmac_f32 v255, v39, v159
    v_fmac_f32 v201, v40, v168
    v_fmac_f32 v201, v41, v169
    s_waitcnt lgkmcnt(0)
    s_mov_b64 exec, s[56:57]
    v_xor_b32 v76, 0x80008000, v76
    v_xor_b32 v77, 0x80008000, v77
    v_xor_b32 v78, 0x80008000, v78
    v_xor_b32 v79, 0x80008000, v79
    s_mov_b64 exec, -1
    v_mfma_f32_32x32x16_bf16 v[0:15], v[72:75], v[176:179], v[0:15]
    v_permlane32_swap_b32 v197, v255
    v_fmac_f32 v201, v42, v170
    v_fmac_f32 v201, v43, v171
    v_fmac_f32 v201, v44, v172
    v_fmac_f32 v201, v45, v173
    s_add_u32 m0, s21, 6144
    v_mfma_f32_32x32x16_bf16 v[16:31], v[76:79], v[176:179], v[16:31]
    v_lshl_add_u32 v240, v240, 10, v246
    v_lshl_add_u32 v241, v241, 10, v246
    buffer_load_dwordx4 v240, s[4:7], s41 offen lds
    buffer_load_dwordx4 v241, s[8:11], s41 offen offset:1024 lds
    v_fmac_f32 v201, v46, v174
    v_fmac_f32 v201, v47, v175
    v_add_f32 v255, v197, v255
    v_cvt_pk_bf16_f32 v254, v254, v255
    ds_write_b32 v253, v254 offset:512
    v_mfma_f32_32x32x16_bf16 v[32:47], v[64:67], v[180:183], 0
    v_mul_f32 v254, v0, v144
    v_fmac_f32 v254, v1, v145
    v_fmac_f32 v254, v2, v146
    v_fmac_f32 v254, v3, v147
    v_fmac_f32 v254, v4, v148
    v_fmac_f32 v254, v5, v149
    v_fmac_f32 v254, v6, v150
    v_fmac_f32 v254, v7, v151
    v_fma_f32 v202, v8, -v160, v202
    v_fma_f32 v202, v9, -v161, v202
    v_mfma_f32_32x32x16_bf16 v[48:63], v[68:71], v[180:183], v[48:63]
    s_waitcnt vmcnt(6)
    ds_read_b64_tr_b16 v[176:177], v244 offset:0
    ds_read_b64_tr_b16 v[178:179], v244 offset:1024
    ds_read_b64_tr_b16 v[180:181], v245 offset:0
    ds_read_b64_tr_b16 v[182:183], v245 offset:1024
    v_permlane32_swap_b32 v254, v200
    v_fma_f32 v202, v10, -v162, v202
    v_fma_f32 v202, v11, -v163, v202
    v_fma_f32 v202, v12, -v164, v202
    v_fma_f32 v202, v13, -v165, v202
    v_fma_f32 v202, v14, -v166, v202
    v_fma_f32 v202, v15, -v167, v202
    v_add_f32 v200, v254, v200
    v_fmac_f32 v198, v16, v112
    v_permlane32_swap_b32 v202, v254
    v_mfma_f32_32x32x16_bf16 v[32:47], v[72:75], v[184:187], v[32:47]
    v_fmac_f32 v198, v17, v113
    v_fmac_f32 v198, v18, v114
    v_fmac_f32 v198, v19, v115
    v_fmac_f32 v198, v20, v116
    v_fmac_f32 v198, v21, v117
    v_fmac_f32 v198, v22, v118
    v_fmac_f32 v198, v23, v119
    v_add_f32 v254, v202, v254
    v_mul_f32 v196, v24, v160
    v_fmac_f32 v196, v25, v161
    v_mfma_f32_32x32x16_bf16 v[48:63], v[76:79], v[184:187], v[48:63]
    v_add_u32 v249, s48, v249
    v_add_u32 v250, s49, v250
    ds_read_b32 v252, v251 offset:16
    ds_read_b64_tr_b16 v[64:65], v249 offset:0
    ds_read_b64_tr_b16 v[68:69], v249 offset:64
    ds_read_b64_tr_b16 v[66:67], v249 offset:256
    ds_read_b64_tr_b16 v[70:71], v249 offset:320
    s_mov_b64 exec, s[54:55]
    ds_read_u16_d16_hi v242, v250 offset:0
    s_mov_b64 exec, -1
    v_fmac_f32 v196, v26, v162
    v_fmac_f32 v196, v27, v163
    v_fmac_f32 v196, v28, v164
    v_fmac_f32 v196, v29, v165
    v_fmac_f32 v196, v30, v166
    v_fmac_f32 v196, v31, v167
    s_nop 1
    v_permlane32_swap_b32 v198, v196
    v_add_f32 v196, v198, v196
    v_mul_f32 v255, v32, v152
    v_fmac_f32 v255, v33, v153
    v_fmac_f32 v255, v34, v154
    v_fmac_f32 v255, v35, v155
    v_fmac_f32 v255, v36, v156
    v_fmac_f32 v255, v37, v157
    v_fmac_f32 v255, v38, v158
    v_fmac_f32 v255, v39, v159
    v_fma_f32 v203, v40, -v168, v203
    v_fma_f32 v203, v41, -v169, v203
    v_permlane32_swap_b32 v255, v201
    v_fma_f32 v203, v42, -v170, v203
    v_fma_f32 v203, v43, -v171, v203
    v_fma_f32 v203, v44, -v172, v203
    v_fma_f32 v203, v45, -v173, v203
    v_fma_f32 v203, v46, -v174, v203
    v_fma_f32 v203, v47, -v175, v203
    v_add_f32 v201, v255, v201
    v_fmac_f32 v199, v48, v120
    v_permlane32_swap_b32 v203, v255
    v_fmac_f32 v199, v49, v121
    v_fmac_f32 v199, v50, v122
    v_fmac_f32 v199, v51, v123
    v_fmac_f32 v199, v52, v124
    v_fmac_f32 v199, v53, v125
    v_fmac_f32 v199, v54, v126
    v_fmac_f32 v199, v55, v127
    v_add_f32 v255, v203, v255
    v_mul_f32 v197, v56, v168
    v_fmac_f32 v197, v57, v169
    v_fmac_f32 v197, v58, v170
    v_fmac_f32 v197, v59, v171
    v_fmac_f32 v197, v60, v172
    v_fmac_f32 v197, v61, v173
    v_fmac_f32 v197, v62, v174
    v_fmac_f32 v197, v63, v175
    s_nop 1
    v_permlane32_swap_b32 v199, v197
    v_add_f32 v197, v199, v197
    v_cvt_pk_bf16_f32 v200, v200, v201
    v_cvt_pk_bf16_f32 v254, v254, v255
    v_cvt_pk_bf16_f32 v196, v196, v197
    ds_write2st64_b32 v253, v200, v196 offset0:3 offset1:4
    s_mov_b64 exec, 0xffffffff
    ds_write_b32 v253, v254 offset:1280
    s_mov_b64 exec, -1
    s_add_u32 s50, s50, 1
    s_cmp_ge_u32 s50, 4
    s_cbranch_scc1 LAST1
    s_waitcnt lgkmcnt(7)
    v_readfirstlane_b32 s66, v252
    s_add_u32 s53, s53, 1
    v_mov_b32 v252, s53
    s_cmp_le_u32 s53, s66
    ds_write2_b32 v251, v252, v252 offset0:0 offset1:8
    s_setprio 1
    s_cbranch_scc1 PRIO_11
    s_setprio 0
PRIO_11:
    s_cmp_eq_u32 s52, 4
    s_cbranch_scc1 ITEM_1_4
    s_cmp_eq_u32 s52, 5
    s_cbranch_scc1 ITEM_1_5
    s_cmp_eq_u32 s52, 3
    s_cbranch_scc1 ITEM_1_3
    s_cmp_eq_u32 s52, 6
    s_cbranch_scc1 ITEM_1_6
    s_cmp_eq_u32 s52, 8
    s_cbranch_scc1 ITEM_1_8
    s_branch ITEM_1_2
.p2align 6
ITEM_1_5:
    s_mov_b64 exec, s[54:55]
    ds_read_u16_d16_hi v243, v250 offset:128
    s_mov_b64 exec, -1
    ds_read_b64_tr_b16 v[72:73], v249 offset:512
    ds_read_b64_tr_b16 v[76:77], v249 offset:576
    ds_read_b64_tr_b16 v[74:75], v249 offset:768
    ds_read_b64_tr_b16 v[78:79], v249 offset:832
    ds_read_b64_tr_b16 v[80:81], v249 offset:1024
    ds_read_b64_tr_b16 v[84:85], v249 offset:1088
    s_waitcnt lgkmcnt(7)
    v_mul_f32_dpp v196, v242, v64 row_newbcast:0 row_mask:0xf bank_mask:0xf
    v_mul_f32_dpp v197, v242, v65 row_newbcast:1 row_mask:0xf bank_mask:0xf
    v_mul_f32_dpp v198, v242, v64 row_newbcast:8 row_mask:0xf bank_mask:0xf
    v_mul_f32_dpp v199, v242, v65 row_newbcast:9 row_mask:0xf bank_mask:0xf
    v_mul_f32_dpp v200, v242, v68 row_newbcast:2 row_mask:0xf bank_mask:0xf
    v_mul_f32_dpp v201, v242, v69 row_newbcast:3 row_mask:0xf bank_mask:0xf
    v_mul_f32_dpp v202, v242, v68 row_newbcast:10 row_mask:0xf bank_mask:0xf
    v_mul_f32_dpp v203, v242, v69 row_newbcast:11 row_mask:0xf bank_mask:0xf
    v_cvt_pk_bf16_f32 v64, v196, v197
    v_cvt_pk_bf16_f32 v68, v198, v199
    v_cvt_pk_bf16_f32 v65, v200, v201
    v_cvt_pk_bf16_f32 v69, v202, v203
    v_mul_f32_dpp v196, v242, v66 row_newbcast:4 row_mask:0xf bank_mask:0xf
    v_mul_f32_dpp v197, v242, v67 row_newbcast:5 row_mask:0xf bank_mask:0xf
    v_mul_f32_dpp v198, v242, v66 row_newbcast:12 row_mask:0xf bank_mask:0xf
    v_mul_f32_dpp v199, v242, v67 row_newbcast:13 row_mask:0xf bank_mask:0xf
    v_mul_f32_dpp v200, v242, v70 row_newbcast:6 row_mask:0xf bank_mask:0xf
    v_mul_f32_dpp v201, v242, v71 row_newbcast:7 row_mask:0xf bank_mask:0xf
    v_mul_f32_dpp v202, v242, v70 row_newbcast:14 row_mask:0xf bank_mask:0xf
    v_mul_f32_dpp v203, v242, v71 row_newbcast:15 row_mask:0xf bank_mask:0xf
    v_cvt_pk_bf16_f32 v66, v196, v197
    v_cvt_pk_bf16_f32 v70, v198, v199
    v_cvt_pk_bf16_f32 v67, v200, v201
    v_cvt_pk_bf16_f32 v71, v202, v203
    s_mov_b64 exec, s[54:55]
    ds_read_u16_d16_hi v242, v250 offset:256
    s_mov_b64 exec, -1
    s_waitcnt vmcnt(4) lgkmcnt(3)
    v_mfma_f32_32x32x16_bf16 v[0:15], v[64:67], v[176:179], 0
    v_mul_f32_dpp v196, v243, v72 row_newbcast:0 row_mask:0xf bank_mask:0xf
    v_mul_f32_dpp v197, v243, v73 row_newbcast:1 row_mask:0xf bank_mask:0xf
    v_mul_f32_dpp v198, v243, v72 row_newbcast:8 row_mask:0xf bank_mask:0xf
    v_mul_f32_dpp v199, v243, v73 row_newbcast:9 row_mask:0xf bank_mask:0xf
    v_mul_f32_dpp v200, v243, v76 row_newbcast:2 row_mask:0xf bank_mask:0xf
    v_mul_f32_dpp v201, v243, v77 row_newbcast:3 row_mask:0xf bank_mask:0xf
    v_mul_f32_dpp v202, v243, v76 row_newbcast:10 row_mask:0xf bank_mask:0xf
    v_mul_f32_dpp v203, v243, v77 row_newbcast:11 row_mask:0xf bank_mask:0xf
    v_cvt_pk_bf16_f32 v72, v196, v197
    v_cvt_pk_bf16_f32 v76, v198, v199
    v_cvt_pk_bf16_f32 v73, v200, v201
    v_cvt_pk_bf16_f32 v77, v202, v203
    s_add_u32 m0, s21, 0
    v_mfma_f32_32x32x16_bf16 v[16:31], v[68:71], v[176:179], 0
    buffer_load_dwordx4 v236, s[4:7], s35 offen lds
    buffer_load_dwordx4 v237, s[8:11], s35 offen offset:1024 lds
    ds_read_b64_tr_b16 v[176:177], v244 offset:2048
    ds_read_b64_tr_b16 v[178:179], v244 offset:3072
    ds_read_b64_tr_b16 v[184:185], v245 offset:2048
    ds_read_b64_tr_b16 v[186:187], v245 offset:3072
    v_mul_f32_dpp v196, v243, v74 row_newbcast:4 row_mask:0xf bank_mask:0xf
    v_mul_f32_dpp v197, v243, v75 row_newbcast:5 row_mask:0xf bank_mask:0xf
    v_mul_f32_dpp v198, v243, v74 row_newbcast:12 row_mask:0xf bank_mask:0xf
    v_mul_f32_dpp v199, v243, v75 row_newbcast:13 row_mask:0xf bank_mask:0xf
    v_mul_f32_dpp v200, v243, v78 row_newbcast:6 row_mask:0xf bank_mask:0xf
    v_mul_f32_dpp v201, v243, v79 row_newbcast:7 row_mask:0xf bank_mask:0xf
    v_mul_f32_dpp v202, v243, v78 row_newbcast:14 row_mask:0xf bank_mask:0xf
    v_mul_f32_dpp v203, v243, v79 row_newbcast:15 row_mask:0xf bank_mask:0xf
    v_cvt_pk_bf16_f32 v74, v196, v197
    v_cvt_pk_bf16_f32 v78, v198, v199
    v_cvt_pk_bf16_f32 v75, v200, v201
    v_cvt_pk_bf16_f32 v79, v202, v203
    s_nop 0
    s_waitcnt vmcnt(4) lgkmcnt(0)
    v_mfma_f32_32x32x16_bf16 v[0:15], v[72:75], v[176:179], v[0:15]
    v_mul_f32_dpp v196, v242, v80 row_newbcast:0 row_mask:0xf bank_mask:0xf
    v_mul_f32_dpp v197, v242, v81 row_newbcast:1 row_mask:0xf bank_mask:0xf
    v_mul_f32_dpp v198, v242, v80 row_newbcast:8 row_mask:0xf bank_mask:0xf
    v_mul_f32_dpp v199, v242, v81 row_newbcast:9 row_mask:0xf bank_mask:0xf
    v_mul_f32_dpp v200, v242, v84 row_newbcast:2 row_mask:0xf bank_mask:0xf
    v_mul_f32_dpp v201, v242, v85 row_newbcast:3 row_mask:0xf bank_mask:0xf
    s_add_u32 m0, s21, 2048
    v_mfma_f32_32x32x16_bf16 v[16:31], v[76:79], v[176:179], v[16:31]
    buffer_load_dwordx4 v238, s[4:7], s35 offen lds
    ds_read_b64_tr_b16 v[176:177], v244 offset:4096
    ds_read_b64_tr_b16 v[188:189], v245 offset:4096
    v_mul_f32_dpp v202, v242, v84 row_newbcast:10 row_mask:0xf bank_mask:0xf
    v_mul_f32_dpp v203, v242, v85 row_newbcast:11 row_mask:0xf bank_mask:0xf
    v_cvt_pk_bf16_f32 v80, v196, v197
    v_cvt_pk_bf16_f32 v84, v198, v199
    v_cvt_pk_bf16_f32 v81, v200, v201
    v_cvt_pk_bf16_f32 v85, v202, v203
    s_nop 0
    s_waitcnt lgkmcnt(0)
    v_mfma_f32_32x32x8_bf16 v[0:15], v[80:81], v[176:177], v[0:15]
    s_add_u32 m0, s21, 4096
    v_mfma_f32_32x32x8_bf16 v[16:31], v[84:85], v[176:177], v[16:31]
    buffer_load_dwordx4 v234, s[4:7], s36 offen lds
    buffer_load_dwordx4 v235, s[8:11], s36 offen offset:1024 lds
    s_mov_b32 m0, s50
    s_nop 0
    s_movrels_b32 s71, s23
    s_movrels_b32 s33, s28
    s_and_b32 s70, s33, 0x70
    s_andn2_b32 s33, s33, 0x70
    v_xor_b32 v253, s70, v248
    v_add_u32 v253, s33, v253
    s_bfe_u32 s46, s71, 0x30012
    s_mov_b32 m0, s46
    s_and_b32 s66, s71, 0x3ffff
    s_movrels_b32 s68, s57
    s_movrels_b32 s69, s61
    s_sub_u32 s48, s66, s47
    s_mov_b32 s47, s66
    s_lshr_b32 s52, s71, 28
    s_lshl_b32 s67, s46, 9
    s_add_u32 s66, s66, s67
    s_sub_u32 s49, s66, s42
    s_mov_b32 s42, s66
    s_bfe_u32 s66, s68, 655360
    s_add_u32 s43, s42, s66
    s_bfe_u32 s39, s69, 655360
    s_bfe_u32 s66, s68, 655370
    s_add_u32 s44, s42, s66
    s_bfe_u32 s40, s69, 655370
    s_bfe_u32 s66, s68, 655380
    s_add_u32 s45, s42, s66
    s_bfe_u32 s41, s69, 655380
    v_add_u32 v252, s45, v247
    ds_read_u16 v240, v252
    ds_read_u16 v241, v252 offset:64
    v_mfma_f32_32x32x16_bf16 v[32:47], v[64:67], v[180:183], 0
    v_mul_f32 v196, v0, v96
    v_fmac_f32 v196, v1, v97
    v_fmac_f32 v196, v2, v98
    v_fmac_f32 v196, v3, v99
    v_fmac_f32 v196, v4, v100
    v_fmac_f32 v196, v5, v101
    v_fmac_f32 v196, v6, v102
    v_mfma_f32_32x32x16_bf16 v[48:63], v[68:71], v[180:183], 0
    v_fmac_f32 v196, v7, v103
    v_mul_f32 v198, v8, v128
    v_fmac_f32 v198, v9, v129
    v_fmac_f32 v198, v10, v130
    v_fmac_f32 v198, v11, v131
    v_fmac_f32 v198, v12, v132
    v_mfma_f32_32x32x16_bf16 v[32:47], v[72:75], v[184:187], v[32:47]
    v_fmac_f32 v198, v13, v133
    v_fmac_f32 v198, v14, v134
    v_fmac_f32 v198, v15, v135
    v_mul_f32 v200, v16, v128
    v_fmac_f32 v200, v17, v129
    v_permlane32_swap_b32 v196, v198
    v_mfma_f32_32x32x16_bf16 v[48:63], v[76:79], v[184:187], v[48:63]
    s_waitcnt vmcnt(5)
    ds_read_b64_tr_b16 v[176:177], v244 offset:6144
    ds_read_b64_tr_b16 v[178:179], v244 offset:7168
    ds_read_b64_tr_b16 v[180:181], v245 offset:6144
    ds_read_b64_tr_b16 v[182:183], v245 offset:7168
    v_fmac_f32 v200, v18, v130
    v_fmac_f32 v200, v19, v131
    v_fmac_f32 v200, v20, v132
    v_fmac_f32 v200, v21, v133
    v_fmac_f32 v200, v22, v134
    v_fmac_f32 v200, v23, v135
    v_mfma_f32_32x32x8_bf16 v[32:47], v[80:81], v[188:189], v[32:47]
    v_add_f32 v198, v196, v198
    v_mul_f32_e64 v202, v24, -v128
    v_fma_f32 v202, v25, -v129, v202
    v_fma_f32 v202, v26, -v130, v202
    v_fma_f32 v202, v27, -v131, v202
    v_fma_f32 v202, v28, -v132, v202
    v_mfma_f32_32x32x8_bf16 v[48:63], v[84:85], v[188:189], v[48:63]
    v_fma_f32 v202, v29, -v133, v202
    v_fma_f32 v202, v30, -v134, v202
    v_fma_f32 v202, v31, -v135, v202
    s_nop 1
    v_permlane32_swap_b32 v200, v202
    v_add_f32 v202, v200, v202
    s_waitcnt vmcnt(3) lgkmcnt(0)
    v_mfma_f32_32x32x16_bf16 v[0:15], v[64:67], v[176:179], 0
    v_mul_f32 v197, v32, v104
    v_fmac_f32 v197, v33, v105
    v_fmac_f32 v197, v34, v106
    v_fmac_f32 v197, v35, v107
    v_fmac_f32 v197, v36, v108
    v_fmac_f32 v197, v37, v109
    v_fmac_f32 v197, v38, v110
    s_add_u32 m0, s21, 6144
    v_mfma_f32_32x32x16_bf16 v[16:31], v[68:71], v[176:179], 0
    buffer_load_dwordx4 v236, s[4:7], s36 offen lds
    buffer_load_dwordx4 v237, s[8:11], s36 offen offset:1024 lds
    ds_read_b64_tr_b16 v[176:177], v244 offset:0
    ds_read_b64_tr_b16 v[178:179], v244 offset:1024
    ds_read_b64_tr_b16 v[184:185], v245 offset:0
    ds_read_b64_tr_b16 v[186:187], v245 offset:1024
    v_fmac_f32 v197, v39, v111
    v_mul_f32 v199, v40, v136
    v_fmac_f32 v199, v41, v137
    v_fmac_f32 v199, v42, v138
    v_fmac_f32 v199, v43, v139
    v_fmac_f32 v199, v44, v140
    v_fmac_f32 v199, v45, v141
    s_waitcnt vmcnt(4) lgkmcnt(0)
    v_mfma_f32_32x32x16_bf16 v[0:15], v[72:75], v[176:179], v[0:15]
    v_fmac_f32 v199, v46, v142
    v_fmac_f32 v199, v47, v143
    v_mul_f32 v201, v48, v136
    v_fmac_f32 v201, v49, v137
    v_permlane32_swap_b32 v197, v199
    v_fmac_f32 v201, v50, v138
    s_add_u32 m0, s21, 0
    v_mfma_f32_32x32x16_bf16 v[16:31], v[76:79], v[176:179], v[16:31]
    buffer_load_dwordx4 v238, s[4:7], s36 offen lds
    ds_read_b64_tr_b16 v[176:177], v244 offset:2048
    ds_read_b64_tr_b16 v[188:189], v245 offset:2048
    v_fmac_f32 v201, v51, v139
    v_fmac_f32 v201, v52, v140
    v_fmac_f32 v201, v53, v141
    v_fmac_f32 v201, v54, v142
    v_fmac_f32 v201, v55, v143
    v_add_f32 v199, v197, v199
    v_mul_f32_e64 v203, v56, -v136
    s_waitcnt lgkmcnt(0)
    v_mfma_f32_32x32x8_bf16 v[0:15], v[80:81], v[176:177], v[0:15]
    v_fma_f32 v203, v57, -v137, v203
    v_fma_f32 v203, v58, -v138, v203
    v_fma_f32 v203, v59, -v139, v203
    v_fma_f32 v203, v60, -v140, v203
    v_fma_f32 v203, v61, -v141, v203
    v_fma_f32 v203, v62, -v142, v203
    v_fma_f32 v203, v63, -v143, v203
    s_add_u32 m0, s21, 2048
    v_mfma_f32_32x32x8_bf16 v[16:31], v[84:85], v[176:177], v[16:31]
    buffer_load_dwordx4 v234, s[4:7], s37 offen lds
    buffer_load_dwordx4 v235, s[8:11], s37 offen offset:1024 lds
    v_add_u32 v252, s42, v247
    ds_read_u16 v234, v252
    ds_read_u16 v235, v252 offset:64
    s_nop 1
    v_permlane32_swap_b32 v201, v203
    v_add_f32 v203, v201, v203
    v_cvt_pk_bf16_f32 v198, v198, v199
    v_cvt_pk_bf16_f32 v202, v202, v203
    ds_write2st64_b32 v253, v198, v202 offset0:0 offset1:1
    v_mfma_f32_32x32x16_bf16 v[32:47], v[64:67], v[180:183], 0
    v_mul_f32 v196, v0, v144
    v_fmac_f32 v196, v1, v145
    v_fmac_f32 v196, v2, v146
    v_fmac_f32 v196, v3, v147
    v_fmac_f32 v196, v4, v148
    v_fmac_f32 v196, v5, v149
    v_mfma_f32_32x32x16_bf16 v[48:63], v[68:71], v[180:183], 0
    v_fmac_f32 v196, v6, v150
    v_fmac_f32 v196, v7, v151
    v_mul_f32 v198, v8, v112
    v_fmac_f32 v198, v9, v113
    v_fmac_f32 v198, v10, v114
    v_mfma_f32_32x32x16_bf16 v[32:47], v[72:75], v[184:187], v[32:47]
    v_fmac_f32 v198, v11, v115
    v_fmac_f32 v198, v12, v116
    v_fmac_f32 v198, v13, v117
    v_fmac_f32 v198, v14, v118
    v_fmac_f32 v198, v15, v119
    v_mfma_f32_32x32x16_bf16 v[48:63], v[76:79], v[184:187], v[48:63]
    s_waitcnt vmcnt(5)
    ds_read_b64_tr_b16 v[176:177], v244 offset:4096
    ds_read_b64_tr_b16 v[178:179], v244 offset:5120
    ds_read_b64_tr_b16 v[180:181], v245 offset:4096
    ds_read_b64_tr_b16 v[182:183], v245 offset:5120
    v_mul_f32_e64 v200, v16, -v160
    v_fma_f32 v200, v17, -v161, v200
    v_fma_f32 v200, v18, -v162, v200
    v_fma_f32 v200, v19, -v163, v200
    v_fma_f32 v200, v20, -v164, v200
    v_fma_f32 v200, v21, -v165, v200
    v_mfma_f32_32x32x8_bf16 v[32:47], v[80:81], v[188:189], v[32:47]
    v_fma_f32 v200, v22, -v166, v200
    v_fma_f32 v200, v23, -v167, v200
    v_mul_f32_e64 v202, v24, -v160
    v_fma_f32 v202, v25, -v161, v202
    v_fma_f32 v202, v26, -v162, v202
    v_mfma_f32_32x32x8_bf16 v[48:63], v[84:85], v[188:189], v[48:63]
    v_fma_f32 v202, v27, -v163, v202
    v_fma_f32 v202, v28, -v164, v202
    v_fma_f32 v202, v29, -v165, v202
    v_fma_f32 v202, v30, -v166, v202
    v_fma_f32 v202, v31, -v167, v202
    s_waitcnt vmcnt(3) lgkmcnt(0)
    v_mfma_f32_32x32x16_bf16 v[0:15], v[64:67], v[176:179], 0
    v_mul_f32 v197, v32, v152
    v_fmac_f32 v197, v33, v153
    v_fmac_f32 v197, v34, v154
    v_fmac_f32 v197, v35, v155
    v_fmac_f32 v197, v36, v156
    v_fmac_f32 v197, v37, v157
    s_add_u32 m0, s21, 4096
    v_mfma_f32_32x32x16_bf16 v[16:31], v[68:71], v[176:179], 0
    buffer_load_dwordx4 v236, s[4:7], s37 offen lds
    buffer_load_dwordx4 v237, s[8:11], s37 offen offset:1024 lds
    ds_read_b64_tr_b16 v[176:177], v244 offset:6144
    ds_read_b64_tr_b16 v[178:179], v244 offset:7168
    ds_read_b64_tr_b16 v[184:185], v245 offset:6144
    ds_read_b64_tr_b16 v[186:187], v245 offset:7168
    v_add_u32 v252, s43, v247
    ds_read_u16 v236, v252
    ds_read_u16 v237, v252 offset:64
    v_fmac_f32 v197, v38, v158
    v_fmac_f32 v197, v39, v159
    v_mul_f32 v199, v40, v120
    v_fmac_f32 v199, v41, v121
    v_fmac_f32 v199, v42, v122
    s_waitcnt vmcnt(4) lgkmcnt(2)
    v_mfma_f32_32x32x16_bf16 v[0:15], v[72:75], v[176:179], v[0:15]
    v_fmac_f32 v199, v43, v123
    v_fmac_f32 v199, v44, v124
    v_fmac_f32 v199, v45, v125
    v_fmac_f32 v199, v46, v126
    v_fmac_f32 v199, v47, v127
    s_add_u32 m0, s21, 6144
    v_mfma_f32_32x32x16_bf16 v[16:31], v[76:79], v[176:179], v[16:31]
    buffer_load_dwordx4 v238, s[4:7], s37 offen lds
    ds_read_b64_tr_b16 v[176:177], v244 offset:0
    ds_read_b64_tr_b16 v[188:189], v245 offset:0
    v_add_u32 v252, s44, v247
    ds_read_u16 v238, v252
    ds_read_u16 v239, v252 offset:64
    v_mul_f32_e64 v201, v48, -v168
    v_fma_f32 v201, v49, -v169, v201
    v_fma_f32 v201, v50, -v170, v201
    v_fma_f32 v201, v51, -v171, v201
    v_fma_f32 v201, v52, -v172, v201
    v_fma_f32 v201, v53, -v173, v201
    s_waitcnt lgkmcnt(2)
    v_mfma_f32_32x32x8_bf16 v[0:15], v[80:81], v[176:177], v[0:15]
    v_fma_f32 v201, v54, -v174, v201
    v_fma_f32 v201, v55, -v175, v201
    v_mul_f32_e64 v203, v56, -v168
    v_fma_f32 v203, v57, -v169, v203
    v_fma_f32 v203, v58, -v170, v203
    s_add_u32 m0, s21, 0
    v_mfma_f32_32x32x8_bf16 v[16:31], v[84:85], v[176:177], v[16:31]
    v_lshl_add_u32 v234, v234, 10, v246
    v_lshl_add_u32 v235, v235, 10, v246
    buffer_load_dwordx4 v234, s[4:7], s38 offen lds
    buffer_load_dwordx4 v235, s[8:11], s38 offen offset:1024 lds
    v_fma_f32 v203, v59, -v171, v203
    v_fma_f32 v203, v60, -v172, v203
    v_fma_f32 v203, v61, -v173, v203
    v_fma_f32 v203, v62, -v174, v203
    v_fma_f32 v203, v63, -v175, v203
    v_mfma_f32_32x32x16_bf16 v[32:47], v[64:67], v[180:183], 0
    v_mul_f32 v254, v0, v144
    v_fmac_f32 v254, v1, v145
    v_fmac_f32 v254, v2, v146
    v_mfma_f32_32x32x16_bf16 v[48:63], v[68:71], v[180:183], 0
    ds_swizzle_b32 v68, v68 offset:0x401F
    ds_swizzle_b32 v69, v69 offset:0x401F
    ds_swizzle_b32 v70, v70 offset:0x401F
    ds_swizzle_b32 v71, v71 offset:0x401F
    v_fmac_f32 v254, v3, v147
    v_fmac_f32 v254, v4, v148
    v_fmac_f32 v254, v5, v149
    v_mfma_f32_32x32x16_bf16 v[32:47], v[72:75], v[184:187], v[32:47]
    v_fmac_f32 v254, v6, v150
    v_fmac_f32 v254, v7, v151
    v_fmac_f32 v200, v8, v160
    v_mfma_f32_32x32x16_bf16 v[48:63], v[76:79], v[184:187], v[48:63]
    ds_swizzle_b32 v76, v76 offset:0x401F
    ds_swizzle_b32 v77, v77 offset:0x401F
    ds_swizzle_b32 v78, v78 offset:0x401F
    ds_swizzle_b32 v79, v79 offset:0x401F
    s_waitcnt vmcnt(5)
    ds_read_b64_tr_b16 v[176:177], v244 offset:2048
    ds_read_b64_tr_b16 v[178:179], v244 offset:3072
    ds_read_b64_tr_b16 v[180:181], v245 offset:2048
    ds_read_b64_tr_b16 v[182:183], v245 offset:3072
    v_fmac_f32 v200, v9, v161
    v_permlane32_swap_b32 v196, v254
    v_fmac_f32 v200, v10, v162
    v_mfma_f32_32x32x8_bf16 v[32:47], v[80:81], v[188:189], v[32:47]
    v_fmac_f32 v200, v11, v163
    v_fmac_f32 v200, v12, v164
    v_fmac_f32 v200, v13, v165
    v_mfma_f32_32x32x8_bf16 v[48:63], v[84:85], v[188:189], v[48:63]
    ds_swizzle_b32 v84, v84 offset:0x401F
    ds_swizzle_b32 v85, v85 offset:0x401F
    v_fmac_f32 v200, v14, v166
    v_fmac_f32 v200, v15, v167
    v_add_f32 v254, v196, v254
    s_waitcnt lgkmcnt(6)
    s_mov_b64 exec, s[56:57]
    v_xor_b32 v68, 0x80008000, v68
    v_xor_b32 v69, 0x80008000, v69
    v_xor_b32 v70, 0x80008000, v70
    v_xor_b32 v71, 0x80008000, v71
    v_xor_b32 v76, 0x80008000, v76
    v_xor_b32 v77, 0x80008000, v77
    v_xor_b32 v78, 0x80008000, v78
    v_xor_b32 v79, 0x80008000, v79
    s_mov_b64 exec, -1
    s_waitcnt vmcnt(3) lgkmcnt(2)
    v_mfma_f32_32x32x16_bf16 v[0:15], v[64:67], v[176:179], 0
    v_mul_f32 v255, v32, v152
    v_fmac_f32 v255, v33, v153
    v_fmac_f32 v255, v34, v154
    v_fmac_f32 v255, v35, v155
    s_add_u32 m0, s21, 2048
    v_mfma_f32_32x32x16_bf16 v[16:31], v[68:71], v[176:179], v[16:31]
    v_lshl_add_u32 v236, v236, 10, v246
    v_lshl_add_u32 v237, v237, 10, v246
    buffer_load_dwordx4 v236, s[4:7], s39 offen lds
    buffer_load_dwordx4 v237, s[8:11], s39 offen offset:1024 lds
    ds_read_b64_tr_b16 v[176:177], v244 offset:4096
    ds_read_b64_tr_b16 v[178:179], v244 offset:5120
    ds_read_b64_tr_b16 v[184:185], v245 offset:4096
    ds_read_b64_tr_b16 v[186:187], v245 offset:5120
    v_fmac_f32 v255, v36, v156
    v_fmac_f32 v255, v37, v157
    v_fmac_f32 v255, v38, v158
    s_waitcnt vmcnt(4) lgkmcnt(0)
    v_mfma_f32_32x32x16_bf16 v[0:15], v[72:75], v[176:179], v[0:15]
    v_fmac_f32 v255, v39, v159
    v_fmac_f32 v201, v40, v168
    v_fmac_f32 v201, v41, v169
    s_add_u32 m0, s21, 4096
    v_mfma_f32_32x32x16_bf16 v[16:31], v[76:79], v[176:179], v[16:31]
    v_lshl_add_u32 v238, v238, 10, v246
    v_lshl_add_u32 v239, v239, 10, v246
    buffer_load_dwordx4 v238, s[4:7], s40 offen lds
    buffer_load_dwordx4 v239, s[8:11], s40 offen offset:1024 lds
    ds_read_b64_tr_b16 v[176:177], v244 offset:6144
    ds_read_b64_tr_b16 v[188:189], v245 offset:6144
    v_permlane32_swap_b32 v197, v255
    v_fmac_f32 v201, v42, v170
    v_fmac_f32 v201, v43, v171
    v_fmac_f32 v201, v44, v172
    s_waitcnt lgkmcnt(0)
    s_mov_b64 exec, s[56:57]
    v_xor_b32 v84, 0x80008000, v84
    v_xor_b32 v85, 0x80008000, v85
    s_mov_b64 exec, -1
    v_mfma_f32_32x32x8_bf16 v[0:15], v[80:81], v[176:177], v[0:15]
    v_fmac_f32 v201, v45, v173
    v_fmac_f32 v201, v46, v174
    v_fmac_f32 v201, v47, v175
    s_add_u32 m0, s21, 6144
    v_mfma_f32_32x32x8_bf16 v[16:31], v[84:85], v[176:177], v[16:31]
    v_lshl_add_u32 v240, v240, 10, v246
    v_lshl_add_u32 v241, v241, 10, v246
    buffer_load_dwordx4 v240, s[4:7], s41 offen lds
    buffer_load_dwordx4 v241, s[8:11], s41 offen offset:1024 lds
    v_add_f32 v255, v197, v255
    v_cvt_pk_bf16_f32 v254, v254, v255
    ds_write_b32 v253, v254 offset:512
    v_mfma_f32_32x32x16_bf16 v[32:47], v[64:67], v[180:183], 0
    v_mul_f32 v254, v0, v144
    v_fmac_f32 v254, v1, v145
    v_fmac_f32 v254, v2, v146
    v_fmac_f32 v254, v3, v147
    v_fmac_f32 v254, v4, v148
    v_fmac_f32 v254, v5, v149
    v_fmac_f32 v254, v6, v150
    v_mfma_f32_32x32x16_bf16 v[48:63], v[68:71], v[180:183], v[48:63]
    v_fmac_f32 v254, v7, v151
    v_fma_f32 v202, v8, -v160, v202
    v_fma_f32 v202, v9, -v161, v202
    v_permlane32_swap_b32 v254, v200
    v_fma_f32 v202, v10, -v162, v202
    v_fma_f32 v202, v11, -v163, v202
    v_mfma_f32_32x32x16_bf16 v[32:47], v[72:75], v[184:187], v[32:47]
    v_fma_f32 v202, v12, -v164, v202
    v_fma_f32 v202, v13, -v165, v202
    v_fma_f32 v202, v14, -v166, v202
    v_fma_f32 v202, v15, -v167, v202
    v_add_f32 v200, v254, v200
    v_fmac_f32 v198, v16, v112
    v_permlane32_swap_b32 v202, v254
    v_mfma_f32_32x32x16_bf16 v[48:63], v[76:79], v[184:187], v[48:63]
    s_waitcnt vmcnt(6)
    ds_read_b64_tr_b16 v[176:177], v244 offset:0
    ds_read_b64_tr_b16 v[178:179], v244 offset:1024
    ds_read_b64_tr_b16 v[180:181], v245 offset:0
    ds_read_b64_tr_b16 v[182:183], v245 offset:1024
    v_fmac_f32 v198, v17, v113
    v_fmac_f32 v198, v18, v114
    v_fmac_f32 v198, v19, v115
    v_fmac_f32 v198, v20, v116
    v_fmac_f32 v198, v21, v117
    v_fmac_f32 v198, v22, v118
    v_mfma_f32_32x32x8_bf16 v[32:47], v[80:81], v[188:189], v[32:47]
    v_fmac_f32 v198, v23, v119
    v_add_f32 v254, v202, v254
    v_mul_f32 v196, v24, v160
    v_fmac_f32 v196, v25, v161
    v_fmac_f32 v196, v26, v162
    v_fmac_f32 v196, v27, v163
    v_fmac_f32 v196, v28, v164
    v_mfma_f32_32x32x8_bf16 v[48:63], v[84:85], v[188:189], v[48:63]
    v_add_u32 v249, s48, v249
    v_add_u32 v250, s49, v250
    ds_read_b32 v252, v251 offset:16
    ds_read_b64_tr_b16 v[64:65], v249 offset:0
    ds_read_b64_tr_b16 v[68:69], v249 offset:64
    ds_read_b64_tr_b16 v[66:67], v249 offset:256
    ds_read_b64_tr_b16 v[70:71], v249 offset:320
    s_mov_b64 exec, s[54:55]
    ds_read_u16_d16_hi v242, v250 offset:0
    s_mov_b64 exec, -1
    v_fmac_f32 v196, v29, v165
    v_fmac_f32 v196, v30, v166
    v_fmac_f32 v196, v31, v167
    s_nop 1
    v_permlane32_swap_b32 v198, v196
    v_add_f32 v196, v198, v196
    v_mul_f32 v255, v32, v152
    v_fmac_f32 v255, v33, v153
    v_fmac_f32 v255, v34, v154
    v_fmac_f32 v255, v35, v155
    v_fmac_f32 v255, v36, v156
    v_fmac_f32 v255, v37, v157
    v_fmac_f32 v255, v38, v158
    v_fmac_f32 v255, v39, v159
    v_fma_f32 v203, v40, -v168, v203
    v_fma_f32 v203, v41, -v169, v203
    v_permlane32_swap_b32 v255, v201
    v_fma_f32 v203, v42, -v170, v203
    v_fma_f32 v203, v43, -v171, v203
    v_fma_f32 v203, v44, -v172, v203
    v_fma_f32 v203, v45, -v173, v203
    v_fma_f32 v203, v46, -v174, v203
    v_fma_f32 v203, v47, -v175, v203
    v_add_f32 v201, v255, v201
    v_fmac_f32 v199, v48, v120
    v_permlane32_swap_b32 v203, v255
    v_fmac_f32 v199, v49, v121
    v_fmac_f32 v199, v50, v122
    v_fmac_f32 v199, v51, v123
    v_fmac_f32 v199, v52, v124
    v_fmac_f32 v199, v53, v125
    v_fmac_f32 v199, v54, v126
    v_fmac_f32 v199, v55, v127
    v_add_f32 v255, v203, v255
    v_mul_f32 v197, v56, v168
    v_fmac_f32 v197, v57, v169
    v_fmac_f32 v197, v58, v170
    v_fmac_f32 v197, v59, v171
    v_fmac_f32 v197, v60, v172
    v_fmac_f32 v197, v61, v173
    v_fmac_f32 v197, v62, v174
    v_fmac_f32 v197, v63, v175
    s_nop 1
    v_permlane32_swap_b32 v199, v197
    v_add_f32 v197, v199, v197
    v_cvt_pk_bf16_f32 v200, v200, v201
    v_cvt_pk_bf16_f32 v254, v254, v255
    v_cvt_pk_bf16_f32 v196, v196, v197
    ds_write2st64_b32 v253, v200, v196 offset0:3 offset1:4
    s_mov_b64 exec, 0xffffffff
    ds_write_b32 v253, v254 offset:1280
    s_mov_b64 exec, -1
    s_add_u32 s50, s50, 1
    s_cmp_ge_u32 s50, 4
    s_cbranch_scc1 LAST1
    s_waitcnt lgkmcnt(7)
    v_readfirstlane_b32 s66, v252
    s_add_u32 s53, s53, 1
    v_mov_b32 v252, s53
    s_cmp_le_u32 s53, s66
    ds_write2_b32 v251, v252, v252 offset0:0 offset1:8
    s_setprio 1
    s_cbranch_scc1 PRIO_12
    s_setprio 0
PRIO_12:
    s_cmp_eq_u32 s52, 4
    s_cbranch_scc1 ITEM_1_4
    s_cmp_eq_u32 s52, 5
    s_cbranch_scc1 ITEM_1_5
    s_cmp_eq_u32 s52, 3
    s_cbranch_scc1 ITEM_1_3
    s_cmp_eq_u32 s52, 6
    s_cbranch_scc1 ITEM_1_6
    s_cmp_eq_u32 s52, 8
    s_cbranch_scc1 ITEM_1_8
    s_branch ITEM_1_2
.p2align 6
ITEM_1_3:
    s_mov_b64 exec, s[54:55]
    ds_read_u16_d16_hi v243, v250 offset:128
    s_mov_b64 exec, -1
    ds_read_b64_tr_b16 v[72:73], v249 offset:512
    ds_read_b64_tr_b16 v[76:77], v249 offset:576
    s_waitcnt lgkmcnt(3)
    v_mul_f32_dpp v196, v242, v64 row_newbcast:0 row_mask:0xf bank_mask:0xf
    v_mul_f32_dpp v197, v242, v65 row_newbcast:1 row_mask:0xf bank_mask:0xf
    v_mul_f32_dpp v198, v242, v64 row_newbcast:8 row_mask:0xf bank_mask:0xf
    v_mul_f32_dpp v199, v242, v65 row_newbcast:9 row_mask:0xf bank_mask:0xf
    v_mul_f32_dpp v200, v242, v68 row_newbcast:2 row_mask:0xf bank_mask:0xf
    v_mul_f32_dpp v201, v242, v69 row_newbcast:3 row_mask:0xf bank_mask:0xf
    v_mul_f32_dpp v202, v242, v68 row_newbcast:10 row_mask:0xf bank_mask:0xf
    v_mul_f32_dpp v203, v242, v69 row_newbcast:11 row_mask:0xf bank_mask:0xf
    v_cvt_pk_bf16_f32 v64, v196, v197
    v_cvt_pk_bf16_f32 v68, v198, v199
    v_cvt_pk_bf16_f32 v65, v200, v201
    v_cvt_pk_bf16_f32 v69, v202, v203
    v_mul_f32_dpp v196, v242, v66 row_newbcast:4 row_mask:0xf bank_mask:0xf
    v_mul_f32_dpp v197, v242, v67 row_newbcast:5 row_mask:0xf bank_mask:0xf
    v_mul_f32_dpp v198, v242, v66 row_newbcast:12 row_mask:0xf bank_mask:0xf
    v_mul_f32_dpp v199, v242, v67 row_newbcast:13 row_mask:0xf bank_mask:0xf
    v_mul_f32_dpp v200, v242, v70 row_newbcast:6 row_mask:0xf bank_mask:0xf
    v_mul_f32_dpp v201, v242, v71 row_newbcast:7 row_mask:0xf bank_mask:0xf
    v_mul_f32_dpp v202, v242, v70 row_newbcast:14 row_mask:0xf bank_mask:0xf
    v_mul_f32_dpp v203, v242, v71 row_newbcast:15 row_mask:0xf bank_mask:0xf
    v_cvt_pk_bf16_f32 v66, v196, v197
    v_cvt_pk_bf16_f32 v70, v198, v199
    v_cvt_pk_bf16_f32 v67, v200, v201
    v_cvt_pk_bf16_f32 v71, v202, v203
    s_nop 0
    s_waitcnt vmcnt(4) lgkmcnt(0)
    v_mfma_f32_32x32x16_bf16 v[0:15], v[64:67], v[176:179], 0
    v_mul_f32_dpp v196, v243, v72 row_newbcast:0 row_mask:0xf bank_mask:0xf
    v_mul_f32_dpp v197, v243, v73 row_newbcast:1 row_mask:0xf bank_mask:0xf
    v_mul_f32_dpp v198, v243, v72 row_newbcast:8 row_mask:0xf bank_mask:0xf
    v_mul_f32_dpp v199, v243, v73 row_newbcast:9 row_mask:0xf bank_mask:0xf
    v_mul_f32_dpp v200, v243, v76 row_newbcast:2 row_mask:0xf bank_mask:0xf
    v_mul_f32_dpp v201, v243, v77 row_newbcast:3 row_mask:0xf bank_mask:0xf
    s_add_u32 m0, s21, 0
    v_mfma_f32_32x32x16_bf16 v[16:31], v[68:71], v[176:179], 0
    buffer_load_dwordx4 v234, s[4:7], s36 offen lds
    buffer_load_dwordx4 v235, s[8:11], s36 offen offset:1024 lds
    ds_read_b64_tr_b16 v[176:177], v244 offset:2048
    ds_read_b64_tr_b16 v[184:185], v245 offset:2048
    v_mul_f32_dpp v202, v243, v76 row_newbcast:10 row_mask:0xf bank_mask:0xf
    v_mul_f32_dpp v203, v243, v77 row_newbcast:11 row_mask:0xf bank_mask:0xf
    v_cvt_pk_bf16_f32 v72, v196, v197
    v_cvt_pk_bf16_f32 v76, v198, v199
    v_cvt_pk_bf16_f32 v73, v200, v201
    v_cvt_pk_bf16_f32 v77, v202, v203
    s_nop 0
    s_waitcnt lgkmcnt(0)
    v_mfma_f32_32x32x8_bf16 v[0:15], v[72:73], v[176:177], v[0:15]
    s_add_u32 m0, s21, 2048
    v_mfma_f32_32x32x8_bf16 v[16:31], v[76:77], v[176:177], v[16:31]
    buffer_load_dwordx4 v236, s[4:7], s36 offen lds
    s_mov_b32 m0, s50
    s_nop 0
    s_movrels_b32 s71, s23
    s_movrels_b32 s33, s28
    s_and_b32 s70, s33, 0x70
    s_andn2_b32 s33, s33, 0x70
    v_xor_b32 v253, s70, v248
    v_add_u32 v253, s33, v253
    s_bfe_u32 s46, s71, 0x30012
    s_mov_b32 m0, s46
    s_and_b32 s66, s71, 0x3ffff
    s_movrels_b32 s68, s57
    s_movrels_b32 s69, s61
    s_sub_u32 s48, s66, s47
    s_mov_b32 s47, s66
    s_lshr_b32 s52, s71, 28
    s_lshl_b32 s67, s46, 9
    s_add_u32 s66, s66, s67
    s_sub_u32 s49, s66, s42
    s_mov_b32 s42, s66
    s_bfe_u32 s66, s68, 655360
    s_add_u32 s43, s42, s66
    s_bfe_u32 s39, s69, 655360
    s_bfe_u32 s66, s68, 655370
    s_add_u32 s44, s42, s66
    s_bfe_u32 s40, s69, 655370
    s_bfe_u32 s66, s68, 655380
    s_add_u32 s45, s42, s66
    s_bfe_u32 s41, s69, 655380
    v_add_u32 v252, s44, v247
    ds_read_u16 v238, v252
    ds_read_u16 v239, v252 offset:64
    v_add_u32 v252, s45, v247
    ds_read_u16 v240, v252
    ds_read_u16 v241, v252 offset:64
    v_mfma_f32_32x32x16_bf16 v[32:47], v[64:67], v[180:183], 0
    v_mul_f32 v196, v0, v96
    v_fmac_f32 v196, v1, v97
    v_fmac_f32 v196, v2, v98
    v_fmac_f32 v196, v3, v99
    v_fmac_f32 v196, v4, v100
    v_fmac_f32 v196, v5, v101
    v_fmac_f32 v196, v6, v102
    v_fmac_f32 v196, v7, v103
    v_mul_f32 v198, v8, v128
    v_fmac_f32 v198, v9, v129
    v_mfma_f32_32x32x16_bf16 v[48:63], v[68:71], v[180:183], 0
    s_waitcnt vmcnt(5)
    ds_read_b64_tr_b16 v[176:177], v244 offset:4096
    ds_read_b64_tr_b16 v[178:179], v244 offset:5120
    ds_read_b64_tr_b16 v[180:181], v245 offset:4096
    ds_read_b64_tr_b16 v[182:183], v245 offset:5120
    v_fmac_f32 v198, v10, v130
    v_fmac_f32 v198, v11, v131
    v_fmac_f32 v198, v12, v132
    v_fmac_f32 v198, v13, v133
    v_fmac_f32 v198, v14, v134
    v_fmac_f32 v198, v15, v135
    v_mul_f32 v200, v16, v128
    v_fmac_f32 v200, v17, v129
    v_permlane32_swap_b32 v196, v198
    v_mfma_f32_32x32x8_bf16 v[32:47], v[72:73], v[184:185], v[32:47]
    v_fmac_f32 v200, v18, v130
    v_fmac_f32 v200, v19, v131
    v_fmac_f32 v200, v20, v132
    v_fmac_f32 v200, v21, v133
    v_fmac_f32 v200, v22, v134
    v_fmac_f32 v200, v23, v135
    v_add_f32 v198, v196, v198
    v_mul_f32_e64 v202, v24, -v128
    v_fma_f32 v202, v25, -v129, v202
    v_mfma_f32_32x32x8_bf16 v[48:63], v[76:77], v[184:185], v[48:63]
    v_fma_f32 v202, v26, -v130, v202
    v_fma_f32 v202, v27, -v131, v202
    v_fma_f32 v202, v28, -v132, v202
    v_fma_f32 v202, v29, -v133, v202
    v_fma_f32 v202, v30, -v134, v202
    v_fma_f32 v202, v31, -v135, v202
    s_nop 1
    v_permlane32_swap_b32 v200, v202
    v_add_f32 v202, v200, v202
    s_waitcnt vmcnt(3) lgkmcnt(0)
    v_mfma_f32_32x32x16_bf16 v[0:15], v[64:67], v[176:179], 0
    v_mul_f32 v197, v32, v104
    v_fmac_f32 v197, v33, v105
    v_fmac_f32 v197, v34, v106
    v_fmac_f32 v197, v35, v107
    v_fmac_f32 v197, v36, v108
    v_fmac_f32 v197, v37, v109
    v_fmac_f32 v197, v38, v110
    v_fmac_f32 v197, v39, v111
    v_mul_f32 v199, v40, v136
    v_fmac_f32 v199, v41, v137
    s_add_u32 m0, s21, 4096
    v_mfma_f32_32x32x16_bf16 v[16:31], v[68:71], v[176:179], 0
    buffer_load_dwordx4 v234, s[4:7], s37 offen lds
    buffer_load_dwordx4 v235, s[8:11], s37 offen offset:1024 lds
    ds_read_b64_tr_b16 v[176:177], v244 offset:6144
    ds_read_b64_tr_b16 v[184:185], v245 offset:6144
    v_add_u32 v252, s42, v247
    ds_read_u16 v234, v252
    ds_read_u16 v235, v252 offset:64
    v_fmac_f32 v199, v42, v138
    v_fmac_f32 v199, v43, v139
    v_fmac_f32 v199, v44, v140
    v_fmac_f32 v199, v45, v141
    v_fmac_f32 v199, v46, v142
    v_fmac_f32 v199, v47, v143
    v_mul_f32 v201, v48, v136
    v_fmac_f32 v201, v49, v137
    v_permlane32_swap_b32 v197, v199
    v_fmac_f32 v201, v50, v138
    s_waitcnt lgkmcnt(2)
    v_mfma_f32_32x32x8_bf16 v[0:15], v[72:73], v[176:177], v[0:15]
    v_fmac_f32 v201, v51, v139
    v_fmac_f32 v201, v52, v140
    v_fmac_f32 v201, v53, v141
    v_fmac_f32 v201, v54, v142
    v_fmac_f32 v201, v55, v143
    v_add_f32 v199, v197, v199
    v_mul_f32_e64 v203, v56, -v136
    v_fma_f32 v203, v57, -v137, v203
    v_fma_f32 v203, v58, -v138, v203
    v_fma_f32 v203, v59, -v139, v203
    s_add_u32 m0, s21, 6144
    v_mfma_f32_32x32x8_bf16 v[16:31], v[76:77], v[176:177], v[16:31]
    buffer_load_dwordx4 v236, s[4:7], s37 offen lds
    v_add_u32 v252, s43, v247
    ds_read_u16 v236, v252
    ds_read_u16 v237, v252 offset:64
    v_fma_f32 v203, v60, -v140, v203
    v_fma_f32 v203, v61, -v141, v203
    v_fma_f32 v203, v62, -v142, v203
    v_fma_f32 v203, v63, -v143, v203
    s_nop 1
    v_permlane32_swap_b32 v201, v203
    v_add_f32 v203, v201, v203
    v_cvt_pk_bf16_f32 v198, v198, v199
    v_cvt_pk_bf16_f32 v202, v202, v203
    ds_write2st64_b32 v253, v198, v202 offset0:0 offset1:1
    v_mfma_f32_32x32x16_bf16 v[32:47], v[64:67], v[180:183], 0
    v_mul_f32 v196, v0, v144
    v_fmac_f32 v196, v1, v145
    v_fmac_f32 v196, v2, v146
    v_fmac_f32 v196, v3, v147
    v_fmac_f32 v196, v4, v148
    v_fmac_f32 v196, v5, v149
    v_fmac_f32 v196, v6, v150
    v_fmac_f32 v196, v7, v151
    v_mfma_f32_32x32x16_bf16 v[48:63], v[68:71], v[180:183], 0
    s_waitcnt vmcnt(4)
    ds_read_b64_tr_b16 v[176:177], v244 offset:0
    ds_read_b64_tr_b16 v[178:179], v244 offset:1024
    ds_read_b64_tr_b16 v[180:181], v245 offset:0
    ds_read_b64_tr_b16 v[182:183], v245 offset:1024
    v_mul_f32 v198, v8, v112
    v_fmac_f32 v198, v9, v113
    v_fmac_f32 v198, v10, v114
    v_fmac_f32 v198, v11, v115
    v_fmac_f32 v198, v12, v116
    v_fmac_f32 v198, v13, v117
    v_fmac_f32 v198, v14, v118
    v_fmac_f32 v198, v15, v119
    v_mfma_f32_32x32x8_bf16 v[32:47], v[72:73], v[184:185], v[32:47]
    v_mul_f32_e64 v200, v16, -v160
    v_fma_f32 v200, v17, -v161, v200
    v_fma_f32 v200, v18, -v162, v200
    v_fma_f32 v200, v19, -v163, v200
    v_fma_f32 v200, v20, -v164, v200
    v_fma_f32 v200, v21, -v165, v200
    v_fma_f32 v200, v22, -v166, v200
    v_fma_f32 v200, v23, -v167, v200
    v_mfma_f32_32x32x8_bf16 v[48:63], v[76:77], v[184:185], v[48:63]
    v_mul_f32_e64 v202, v24, -v160
    v_fma_f32 v202, v25, -v161, v202
    v_fma_f32 v202, v26, -v162, v202
    v_fma_f32 v202, v27, -v163, v202
    v_fma_f32 v202, v28, -v164, v202
    v_fma_f32 v202, v29, -v165, v202
    v_fma_f32 v202, v30, -v166, v202
    v_fma_f32 v202, v31, -v167, v202
    s_waitcnt vmcnt(3) lgkmcnt(0)
    v_mfma_f32_32x32x16_bf16 v[0:15], v[64:67], v[176:179], 0
    v_mul_f32 v197, v32, v152
    v_fmac_f32 v197, v33, v153
    v_fmac_f32 v197, v34, v154
    v_fmac_f32 v197, v35, v155
    v_fmac_f32 v197, v36, v156
    v_fmac_f32 v197, v37, v157
    v_fmac_f32 v197, v38, v158
    v_fmac_f32 v197, v39, v159
    s_add_u32 m0, s21, 0
    v_mfma_f32_32x32x16_bf16 v[16:31], v[68:71], v[176:179], 0
    v_lshl_add_u32 v234, v234, 10, v246
    v_lshl_add_u32 v235, v235, 10, v246
    buffer_load_dwordx4 v234, s[4:7], s38 offen lds
    buffer_load_dwordx4 v235, s[8:11], s38 offen offset:1024 lds
    ds_read_b64_tr_b16 v[176:177], v244 offset:2048
    ds_read_b64_tr_b16 v[184:185], v245 offset:2048
    v_mul_f32 v199, v40, v120
    v_fmac_f32 v199, v41, v121
    v_fmac_f32 v199, v42, v122
    v_fmac_f32 v199, v43, v123
    v_fmac_f32 v199, v44, v124
    v_fmac_f32 v199, v45, v125
    v_fmac_f32 v199, v46, v126
    v_fmac_f32 v199, v47, v127
    s_waitcnt lgkmcnt(0)
    v_mfma_f32_32x32x8_bf16 v[0:15], v[72:73], v[176:177], v[0:15]
    v_mul_f32_e64 v201, v48, -v168
    v_fma_f32 v201, v49, -v169, v201
    v_fma_f32 v201, v50, -v170, v201
    v_fma_f32 v201, v51, -v171, v201
    v_fma_f32 v201, v52, -v172, v201
    v_fma_f32 v201, v53, -v173, v201
    v_fma_f32 v201, v54, -v174, v201
    v_fma_f32 v201, v55, -v175, v201
    s_add_u32 m0, s21, 2048
    v_mfma_f32_32x32x8_bf16 v[16:31], v[76:77], v[176:177], v[16:31]
    v_lshl_add_u32 v236, v236, 10, v246
    v_lshl_add_u32 v237, v237, 10, v246
    buffer_load_dwordx4 v236, s[4:7], s39 offen lds
    buffer_load_dwordx4 v237, s[8:11], s39 offen offset:1024 lds
    v_mul_f32_e64 v203, v56, -v168
    v_fma_f32 v203, v57, -v169, v203
    v_fma_f32 v203, v58, -v170, v203
    v_fma_f32 v203, v59, -v171, v203
    v_fma_f32 v203, v60, -v172, v203
    v_fma_f32 v203, v61, -v173, v203
    v_fma_f32 v203, v62, -v174, v203
    v_fma_f32 v203, v63, -v175, v203
    v_mfma_f32_32x32x16_bf16 v[32:47], v[64:67], v[180:183], 0
    v_mul_f32 v254, v0, v144
    v_fmac_f32 v254, v1, v145
    v_fmac_f32 v254, v2, v146
    v_fmac_f32 v254, v3, v147
    v_fmac_f32 v254, v4, v148
    v_mfma_f32_32x32x16_bf16 v[48:63], v[68:71], v[180:183], 0
    ds_swizzle_b32 v68, v68 offset:0x401F
    ds_swizzle_b32 v69, v69 offset:0x401F
    ds_swizzle_b32 v70, v70 offset:0x401F
    ds_swizzle_b32 v71, v71 offset:0x401F
    s_waitcnt vmcnt(5)
    ds_read_b64_tr_b16 v[176:177], v244 offset:4096
    ds_read_b64_tr_b16 v[178:179], v244 offset:5120
    ds_read_b64_tr_b16 v[180:181], v245 offset:4096
    ds_read_b64_tr_b16 v[182:183], v245 offset:5120
    v_fmac_f32 v254, v5, v149
    v_fmac_f32 v254, v6, v150
    v_fmac_f32 v254, v7, v151
    v_fmac_f32 v200, v8, v160
    v_mfma_f32_32x32x8_bf16 v[32:47], v[72:73], v[184:185], v[32:47]
    v_fmac_f32 v200, v9, v161
    v_permlane32_swap_b32 v196, v254
    v_fmac_f32 v200, v10, v162
    v_fmac_f32 v200, v11, v163
    v_fmac_f32 v200, v12, v164
    v_mfma_f32_32x32x8_bf16 v[48:63], v[76:77], v[184:185], v[48:63]
    ds_swizzle_b32 v76, v76 offset:0x401F
    ds_swizzle_b32 v77, v77 offset:0x401F
    v_fmac_f32 v200, v13, v165
    v_fmac_f32 v200, v14, v166
    v_fmac_f32 v200, v15, v167
    v_add_f32 v254, v196, v254
    s_waitcnt lgkmcnt(6)
    s_mov_b64 exec, s[56:57]
    v_xor_b32 v68, 0x80008000, v68
    v_xor_b32 v69, 0x80008000, v69
    v_xor_b32 v70, 0x80008000, v70
    v_xor_b32 v71, 0x80008000, v71
    s_mov_b64 exec, -1
    s_waitcnt vmcnt(4) lgkmcnt(2)
    v_mfma_f32_32x32x16_bf16 v[0:15], v[64:67], v[176:179], 0
    v_mul_f32 v255, v32, v152
    v_fmac_f32 v255, v33, v153
    v_fmac_f32 v255, v34, v154
    v_fmac_f32 v255, v35, v155
    v_fmac_f32 v255, v36, v156
    s_add_u32 m0, s21, 4096
    v_mfma_f32_32x32x16_bf16 v[16:31], v[68:71], v[176:179], v[16:31]
    v_lshl_add_u32 v238, v238, 10, v246
    v_lshl_add_u32 v239, v239, 10, v246
    buffer_load_dwordx4 v238, s[4:7], s40 offen lds
    buffer_load_dwordx4 v239, s[8:11], s40 offen offset:1024 lds
    ds_read_b64_tr_b16 v[176:177], v244 offset:6144
    ds_read_b64_tr_b16 v[184:185], v245 offset:6144
    v_fmac_f32 v255, v37, v157
    v_fmac_f32 v255, v38, v158
    v_fmac_f32 v255, v39, v159
    v_fmac_f32 v201, v40, v168
    v_fmac_f32 v201, v41, v169
    s_waitcnt lgkmcnt(0)
    s_mov_b64 exec, s[56:57]
    v_xor_b32 v76, 0x80008000, v76
    v_xor_b32 v77, 0x80008000, v77
    s_mov_b64 exec, -1
    v_mfma_f32_32x32x8_bf16 v[0:15], v[72:73], v[176:177], v[0:15]
    v_permlane32_swap_b32 v197, v255
    v_fmac_f32 v201, v42, v170
    v_fmac_f32 v201, v43, v171
    v_fmac_f32 v201, v44, v172
    v_fmac_f32 v201, v45, v173
    s_add_u32 m0, s21, 6144
    v_mfma_f32_32x32x8_bf16 v[16:31], v[76:77], v[176:177], v[16:31]
    v_lshl_add_u32 v240, v240, 10, v246
    v_lshl_add_u32 v241, v241, 10, v246
    buffer_load_dwordx4 v240, s[4:7], s41 offen lds
    buffer_load_dwordx4 v241, s[8:11], s41 offen offset:1024 lds
    v_fmac_f32 v201, v46, v174
    v_fmac_f32 v201, v47, v175
    v_add_f32 v255, v197, v255
    v_cvt_pk_bf16_f32 v254, v254, v255
    ds_write_b32 v253, v254 offset:512
    v_mfma_f32_32x32x16_bf16 v[32:47], v[64:67], v[180:183], 0
    v_mul_f32 v254, v0, v144
    v_fmac_f32 v254, v1, v145
    v_fmac_f32 v254, v2, v146
    v_fmac_f32 v254, v3, v147
    v_fmac_f32 v254, v4, v148
    v_fmac_f32 v254, v5, v149
    v_fmac_f32 v254, v6, v150
    v_fmac_f32 v254, v7, v151
    v_fma_f32 v202, v8, -v160, v202
    v_fma_f32 v202, v9, -v161, v202
    v_mfma_f32_32x32x16_bf16 v[48:63], v[68:71], v[180:183], v[48:63]
    s_waitcnt vmcnt(6)
    ds_read_b64_tr_b16 v[176:177], v244 offset:0
    ds_read_b64_tr_b16 v[178:179], v244 offset:1024
    ds_read_b64_tr_b16 v[180:181], v245 offset:0
    ds_read_b64_tr_b16 v[182:183], v245 offset:1024
    v_permlane32_swap_b32 v254, v200
    v_fma_f32 v202, v10, -v162, v202
    v_fma_f32 v202, v11, -v163, v202
    v_fma_f32 v202, v12, -v164, v202
    v_fma_f32 v202, v13, -v165, v202
    v_fma_f32 v202, v14, -v166, v202
    v_fma_f32 v202, v15, -v167, v202
    v_add_f32 v200, v254, v200
    v_fmac_f32 v198, v16, v112
    v_permlane32_swap_b32 v202, v254
    v_mfma_f32_32x32x8_bf16 v[32:47], v[72:73], v[184:185], v[32:47]
    v_fmac_f32 v198, v17, v113
    v_fmac_f32 v198, v18, v114
    v_fmac_f32 v198, v19, v115
    v_fmac_f32 v198, v20, v116
    v_fmac_f32 v198, v21, v117
    v_fmac_f32 v198, v22, v118
    v_fmac_f32 v198, v23, v119
    v_add_f32 v254, v202, v254
    v_mul_f32 v196, v24, v160
    v_fmac_f32 v196, v25, v161
    v_mfma_f32_32x32x8_bf16 v[48:63], v[76:77], v[184:185], v[48:63]
    v_add_u32 v249, s48, v249
    v_add_u32 v250, s49, v250
    ds_read_b32 v252, v251 offset:16
    ds_read_b64_tr_b16 v[64:65], v249 offset:0
    ds_read_b64_tr_b16 v[68:69], v249 offset:64
    ds_read_b64_tr_b16 v[66:67], v249 offset:256
    ds_read_b64_tr_b16 v[70:71], v249 offset:320
    s_mov_b64 exec, s[54:55]
    ds_read_u16_d16_hi v242, v250 offset:0
    s_mov_b64 exec, -1
    v_fmac_f32 v196, v26, v162
    v_fmac_f32 v196, v27, v163
    v_fmac_f32 v196, v28, v164
    v_fmac_f32 v196, v29, v165
    v_fmac_f32 v196, v30, v166
    v_fmac_f32 v196, v31, v167
    s_nop 1
    v_permlane32_swap_b32 v198, v196
    v_add_f32 v196, v198, v196
    v_mul_f32 v255, v32, v152
    v_fmac_f32 v255, v33, v153
    v_fmac_f32 v255, v34, v154
    v_fmac_f32 v255, v35, v155
    v_fmac_f32 v255, v36, v156
    v_fmac_f32 v255, v37, v157
    v_fmac_f32 v255, v38, v158
    v_fmac_f32 v255, v39, v159
    v_fma_f32 v203, v40, -v168, v203
    v_fma_f32 v203, v41, -v169, v203
    v_permlane32_swap_b32 v255, v201
    v_fma_f32 v203, v42, -v170, v203
    v_fma_f32 v203, v43, -v171, v203
    v_fma_f32 v203, v44, -v172, v203
    v_fma_f32 v203, v45, -v173, v203
    v_fma_f32 v203, v46, -v174, v203
    v_fma_f32 v203, v47, -v175, v203
    v_add_f32 v201, v255, v201
    v_fmac_f32 v199, v48, v120
    v_permlane32_swap_b32 v203, v255
    v_fmac_f32 v199, v49, v121
    v_fmac_f32 v199, v50, v122
    v_fmac_f32 v199, v51, v123
    v_fmac_f32 v199, v52, v124
    v_fmac_f32 v199, v53, v125
    v_fmac_f32 v199, v54, v126
    v_fmac_f32 v199, v55, v127
    v_add_f32 v255, v203, v255
    v_mul_f32 v197, v56, v168
    v_fmac_f32 v197, v57, v169
    v_fmac_f32 v197, v58, v170
    v_fmac_f32 v197, v59, v171
    v_fmac_f32 v197, v60, v172
    v_fmac_f32 v197, v61, v173
    v_fmac_f32 v197, v62, v174
    v_fmac_f32 v197, v63, v175
    s_nop 1
    v_permlane32_swap_b32 v199, v197
    v_add_f32 v197, v199, v197
    v_cvt_pk_bf16_f32 v200, v200, v201
    v_cvt_pk_bf16_f32 v254, v254, v255
    v_cvt_pk_bf16_f32 v196, v196, v197
    ds_write2st64_b32 v253, v200, v196 offset0:3 offset1:4
    s_mov_b64 exec, 0xffffffff
    ds_write_b32 v253, v254 offset:1280
    s_mov_b64 exec, -1
    s_add_u32 s50, s50, 1
    s_cmp_ge_u32 s50, 4
    s_cbranch_scc1 LAST1
    s_waitcnt lgkmcnt(7)
    v_readfirstlane_b32 s66, v252
    s_add_u32 s53, s53, 1
    v_mov_b32 v252, s53
    s_cmp_le_u32 s53, s66
    ds_write2_b32 v251, v252, v252 offset0:0 offset1:8
    s_setprio 1
    s_cbranch_scc1 PRIO_13
    s_setprio 0
PRIO_13:
    s_cmp_eq_u32 s52, 4
    s_cbranch_scc1 ITEM_1_4
    s_cmp_eq_u32 s52, 5
    s_cbranch_scc1 ITEM_1_5
    s_cmp_eq_u32 s52, 3
    s_cbranch_scc1 ITEM_1_3
    s_cmp_eq_u32 s52, 6
    s_cbranch_scc1 ITEM_1_6
    s_cmp_eq_u32 s52, 8
    s_cbranch_scc1 ITEM_1_8
    s_branch ITEM_1_2
.p2align 6
ITEM_1_6:
    s_mov_b64 exec, s[54:55]
    ds_read_u16_d16_hi v243, v250 offset:128
    s_mov_b64 exec, -1
    ds_read_b64_tr_b16 v[72:73], v249 offset:512
    ds_read_b64_tr_b16 v[76:77], v249 offset:576
    ds_read_b64_tr_b16 v[74:75], v249 offset:768
    ds_read_b64_tr_b16 v[78:79], v249 offset:832
    ds_read_b64_tr_b16 v[80:81], v249 offset:1024
    ds_read_b64_tr_b16 v[84:85], v249 offset:1088
    ds_read_b64_tr_b16 v[82:83], v249 offset:1280
    ds_read_b64_tr_b16 v[86:87], v249 offset:1344
    s_waitcnt lgkmcnt(9)
    v_mul_f32_dpp v196, v242, v64 row_newbcast:0 row_mask:0xf bank_mask:0xf
    v_mul_f32_dpp v197, v242, v65 row_newbcast:1 row_mask:0xf bank_mask:0xf
    v_mul_f32_dpp v198, v242, v64 row_newbcast:8 row_mask:0xf bank_mask:0xf
    v_mul_f32_dpp v199, v242, v65 row_newbcast:9 row_mask:0xf bank_mask:0xf
    v_mul_f32_dpp v200, v242, v68 row_newbcast:2 row_mask:0xf bank_mask:0xf
    v_mul_f32_dpp v201, v242, v69 row_newbcast:3 row_mask:0xf bank_mask:0xf
    v_mul_f32_dpp v202, v242, v68 row_newbcast:10 row_mask:0xf bank_mask:0xf
    v_mul_f32_dpp v203, v242, v69 row_newbcast:11 row_mask:0xf bank_mask:0xf
    v_cvt_pk_bf16_f32 v64, v196, v197
    v_cvt_pk_bf16_f32 v68, v198, v199
    v_cvt_pk_bf16_f32 v65, v200, v201
    v_cvt_pk_bf16_f32 v69, v202, v203
    v_mul_f32_dpp v196, v242, v66 row_newbcast:4 row_mask:0xf bank_mask:0xf
    v_mul_f32_dpp v197, v242, v67 row_newbcast:5 row_mask:0xf bank_mask:0xf
    v_mul_f32_dpp v198, v242, v66 row_newbcast:12 row_mask:0xf bank_mask:0xf
    v_mul_f32_dpp v199, v242, v67 row_newbcast:13 row_mask:0xf bank_mask:0xf
    v_mul_f32_dpp v200, v242, v70 row_newbcast:6 row_mask:0xf bank_mask:0xf
    v_mul_f32_dpp v201, v242, v71 row_newbcast:7 row_mask:0xf bank_mask:0xf
    v_mul_f32_dpp v202, v242, v70 row_newbcast:14 row_mask:0xf bank_mask:0xf
    v_mul_f32_dpp v203, v242, v71 row_newbcast:15 row_mask:0xf bank_mask:0xf
    v_cvt_pk_bf16_f32 v66, v196, v197
    v_cvt_pk_bf16_f32 v70, v198, v199
    v_cvt_pk_bf16_f32 v67, v200, v201
    v_cvt_pk_bf16_f32 v71, v202, v203
    s_mov_b64 exec, s[54:55]
    ds_read_u16_d16_hi v242, v250 offset:256
    s_mov_b64 exec, -1
    s_waitcnt vmcnt(4) lgkmcnt(5)
    v_mfma_f32_32x32x16_bf16 v[0:15], v[64:67], v[176:179], 0
    v_mul_f32_dpp v196, v243, v72 row_newbcast:0 row_mask:0xf bank_mask:0xf
    v_mul_f32_dpp v197, v243, v73 row_newbcast:1 row_mask:0xf bank_mask:0xf
    v_mul_f32_dpp v198, v243, v72 row_newbcast:8 row_mask:0xf bank_mask:0xf
    v_mul_f32_dpp v199, v243, v73 row_newbcast:9 row_mask:0xf bank_mask:0xf
    v_mul_f32_dpp v200, v243, v76 row_newbcast:2 row_mask:0xf bank_mask:0xf
    v_mul_f32_dpp v201, v243, v77 row_newbcast:3 row_mask:0xf bank_mask:0xf
    v_mul_f32_dpp v202, v243, v76 row_newbcast:10 row_mask:0xf bank_mask:0xf
    v_mul_f32_dpp v203, v243, v77 row_newbcast:11 row_mask:0xf bank_mask:0xf
    v_cvt_pk_bf16_f32 v72, v196, v197
    v_cvt_pk_bf16_f32 v76, v198, v199
    v_cvt_pk_bf16_f32 v73, v200, v201
    v_cvt_pk_bf16_f32 v77, v202, v203
    s_add_u32 m0, s21, 0
    v_mfma_f32_32x32x16_bf16 v[16:31], v[68:71], v[176:179], 0
    buffer_load_dwordx4 v236, s[4:7], s35 offen lds
    buffer_load_dwordx4 v237, s[8:11], s35 offen offset:1024 lds
    ds_read_b64_tr_b16 v[176:177], v244 offset:2048
    ds_read_b64_tr_b16 v[178:179], v244 offset:3072
    ds_read_b64_tr_b16 v[184:185], v245 offset:2048
    ds_read_b64_tr_b16 v[186:187], v245 offset:3072
    v_mul_f32_dpp v196, v243, v74 row_newbcast:4 row_mask:0xf bank_mask:0xf
    v_mul_f32_dpp v197, v243, v75 row_newbcast:5 row_mask:0xf bank_mask:0xf
    v_mul_f32_dpp v198, v243, v74 row_newbcast:12 row_mask:0xf bank_mask:0xf
    v_mul_f32_dpp v199, v243, v75 row_newbcast:13 row_mask:0xf bank_mask:0xf
    v_mul_f32_dpp v200, v243, v78 row_newbcast:6 row_mask:0xf bank_mask:0xf
    v_mul_f32_dpp v201, v243, v79 row_newbcast:7 row_mask:0xf bank_mask:0xf
    v_mul_f32_dpp v202, v243, v78 row_newbcast:14 row_mask:0xf bank_mask:0xf
    v_mul_f32_dpp v203, v243, v79 row_newbcast:15 row_mask:0xf bank_mask:0xf
    v_cvt_pk_bf16_f32 v74, v196, v197
    v_cvt_pk_bf16_f32 v78, v198, v199
    v_cvt_pk_bf16_f32 v75, v200, v201
    v_cvt_pk_bf16_f32 v79, v202, v203
    s_nop 0
    s_waitcnt vmcnt(4) lgkmcnt(0)
    v_mfma_f32_32x32x16_bf16 v[0:15], v[72:75], v[176:179], v[0:15]
    v_mul_f32_dpp v196, v242, v80 row_newbcast:0 row_mask:0xf bank_mask:0xf
    v_mul_f32_dpp v197, v242, v81 row_newbcast:1 row_mask:0xf bank_mask:0xf
    v_mul_f32_dpp v198, v242, v80 row_newbcast:8 row_mask:0xf bank_mask:0xf
    v_mul_f32_dpp v199, v242, v81 row_newbcast:9 row_mask:0xf bank_mask:0xf
    v_mul_f32_dpp v200, v242, v84 row_newbcast:2 row_mask:0xf bank_mask:0xf
    v_mul_f32_dpp v201, v242, v85 row_newbcast:3 row_mask:0xf bank_mask:0xf
    v_mul_f32_dpp v202, v242, v84 row_newbcast:10 row_mask:0xf bank_mask:0xf
    v_mul_f32_dpp v203, v242, v85 row_newbcast:11 row_mask:0xf bank_mask:0xf
    v_cvt_pk_bf16_f32 v80, v196, v197
    v_cvt_pk_bf16_f32 v84, v198, v199
    v_cvt_pk_bf16_f32 v81, v200, v201
    v_cvt_pk_bf16_f32 v85, v202, v203
    s_add_u32 m0, s21, 2048
    v_mfma_f32_32x32x16_bf16 v[16:31], v[76:79], v[176:179], v[16:31]
    buffer_load_dwordx4 v238, s[4:7], s35 offen lds
    buffer_load_dwordx4 v239, s[8:11], s35 offen offset:1024 lds
    ds_read_b64_tr_b16 v[176:177], v244 offset:4096
    ds_read_b64_tr_b16 v[178:179], v244 offset:5120
    ds_read_b64_tr_b16 v[188:189], v245 offset:4096
    ds_read_b64_tr_b16 v[190:191], v245 offset:5120
    v_mul_f32_dpp v196, v242, v82 row_newbcast:4 row_mask:0xf bank_mask:0xf
    v_mul_f32_dpp v197, v242, v83 row_newbcast:5 row_mask:0xf bank_mask:0xf
    v_mul_f32_dpp v198, v242, v82 row_newbcast:12 row_mask:0xf bank_mask:0xf
    v_mul_f32_dpp v199, v242, v83 row_newbcast:13 row_mask:0xf bank_mask:0xf
    v_mul_f32_dpp v200, v242, v86 row_newbcast:6 row_mask:0xf bank_mask:0xf
    v_mul_f32_dpp v201, v242, v87 row_newbcast:7 row_mask:0xf bank_mask:0xf
    v_mul_f32_dpp v202, v242, v86 row_newbcast:14 row_mask:0xf bank_mask:0xf
    v_mul_f32_dpp v203, v242, v87 row_newbcast:15 row_mask:0xf bank_mask:0xf
    v_cvt_pk_bf16_f32 v82, v196, v197
    v_cvt_pk_bf16_f32 v86, v198, v199
    v_cvt_pk_bf16_f32 v83, v200, v201
    v_cvt_pk_bf16_f32 v87, v202, v203
    s_nop 0
    s_waitcnt lgkmcnt(0)
    v_mfma_f32_32x32x16_bf16 v[0:15], v[80:83], v[176:179], v[0:15]
    s_add_u32 m0, s21, 4096
    v_mfma_f32_32x32x16_bf16 v[16:31], v[84:87], v[176:179], v[16:31]
    buffer_load_dwordx4 v234, s[4:7], s36 offen lds
    buffer_load_dwordx4 v235, s[8:11], s36 offen offset:1024 lds
    s_mov_b32 m0, s50
    s_nop 0
    s_movrels_b32 s71, s23
    s_movrels_b32 s33, s28
    s_and_b32 s70, s33, 0x70
    s_andn2_b32 s33, s33, 0x70
    v_xor_b32 v253, s70, v248
    v_add_u32 v253, s33, v253
    s_bfe_u32 s46, s71, 0x30012
    s_mov_b32 m0, s46
    s_and_b32 s66, s71, 0x3ffff
    s_movrels_b32 s68, s57
    s_movrels_b32 s69, s61
    s_sub_u32 s48, s66, s47
    s_mov_b32 s47, s66
    s_lshr_b32 s52, s71, 28
    s_lshl_b32 s67, s46, 9
    s_add_u32 s66, s66, s67
    s_sub_u32 s49, s66, s42
    s_mov_b32 s42, s66
    s_bfe_u32 s66, s68, 655360
    s_add_u32 s43, s42, s66
    s_bfe_u32 s39, s69, 655360
    s_bfe_u32 s66, s68, 655370
    s_add_u32 s44, s42, s66
    s_bfe_u32 s40, s69, 655370
    s_bfe_u32 s66, s68, 655380
    s_add_u32 s45, s42, s66
    s_bfe_u32 s41, s69, 655380
    v_add_u32 v252, s45, v247
    ds_read_u16 v240, v252
    ds_read_u16 v241, v252 offset:64
    v_mfma_f32_32x32x16_bf16 v[32:47], v[64:67], v[180:183], 0
    v_mul_f32 v196, v0, v96
    v_fmac_f32 v196, v1, v97
    v_fmac_f32 v196, v2, v98
    v_fmac_f32 v196, v3, v99
    v_fmac_f32 v196, v4, v100
    v_fmac_f32 v196, v5, v101
    v_fmac_f32 v196, v6, v102
    v_mfma_f32_32x32x16_bf16 v[48:63], v[68:71], v[180:183], 0
    v_fmac_f32 v196, v7, v103
    v_mul_f32 v198, v8, v128
    v_fmac_f32 v198, v9, v129
    v_fmac_f32 v198, v10, v130
    v_fmac_f32 v198, v11, v131
    v_fmac_f32 v198, v12, v132
    v_mfma_f32_32x32x16_bf16 v[32:47], v[72:75], v[184:187], v[32:47]
    v_fmac_f32 v198, v13, v133
    v_fmac_f32 v198, v14, v134
    v_fmac_f32 v198, v15, v135
    v_mul_f32 v200, v16, v128
    v_fmac_f32 v200, v17, v129
    v_permlane32_swap_b32 v196, v198
    v_mfma_f32_32x32x16_bf16 v[48:63], v[76:79], v[184:187], v[48:63]
    s_waitcnt vmcnt(6)
    ds_read_b64_tr_b16 v[176:177], v244 offset:6144
    ds_read_b64_tr_b16 v[178:179], v244 offset:7168
    ds_read_b64_tr_b16 v[180:181], v245 offset:6144
    ds_read_b64_tr_b16 v[182:183], v245 offset:7168
    v_fmac_f32 v200, v18, v130
    v_fmac_f32 v200, v19, v131
    v_fmac_f32 v200, v20, v132
    v_fmac_f32 v200, v21, v133
    v_fmac_f32 v200, v22, v134
    v_fmac_f32 v200, v23, v135
    v_mfma_f32_32x32x16_bf16 v[32:47], v[80:83], v[188:191], v[32:47]
    v_add_f32 v198, v196, v198
    v_mul_f32_e64 v202, v24, -v128
    v_fma_f32 v202, v25, -v129, v202
    v_fma_f32 v202, v26, -v130, v202
    v_fma_f32 v202, v27, -v131, v202
    v_fma_f32 v202, v28, -v132, v202
    v_mfma_f32_32x32x16_bf16 v[48:63], v[84:87], v[188:191], v[48:63]
    v_fma_f32 v202, v29, -v133, v202
    v_fma_f32 v202, v30, -v134, v202
    v_fma_f32 v202, v31, -v135, v202
    s_nop 1
    v_permlane32_swap_b32 v200, v202
    v_add_f32 v202, v200, v202
    s_waitcnt vmcnt(4) lgkmcnt(0)
    v_mfma_f32_32x32x16_bf16 v[0:15], v[64:67], v[176:179], 0
    v_mul_f32 v197, v32, v104
    v_fmac_f32 v197, v33, v105
    v_fmac_f32 v197, v34, v106
    v_fmac_f32 v197, v35, v107
    v_fmac_f32 v197, v36, v108
    v_fmac_f32 v197, v37, v109
    v_fmac_f32 v197, v38, v110
    s_add_u32 m0, s21, 6144
    v_mfma_f32_32x32x16_bf16 v[16:31], v[68:71], v[176:179], 0
    buffer_load_dwordx4 v236, s[4:7], s36 offen lds
    buffer_load_dwordx4 v237, s[8:11], s36 offen offset:1024 lds
    ds_read_b64_tr_b16 v[176:177], v244 offset:0
    ds_read_b64_tr_b16 v[178:179], v244 offset:1024
    ds_read_b64_tr_b16 v[184:185], v245 offset:0
    ds_read_b64_tr_b16 v[186:187], v245 offset:1024
    v_fmac_f32 v197, v39, v111
    v_mul_f32 v199, v40, v136
    v_fmac_f32 v199, v41, v137
    v_fmac_f32 v199, v42, v138
    v_fmac_f32 v199, v43, v139
    v_fmac_f32 v199, v44, v140
    v_fmac_f32 v199, v45, v141
    s_waitcnt vmcnt(4) lgkmcnt(0)
    v_mfma_f32_32x32x16_bf16 v[0:15], v[72:75], v[176:179], v[0:15]
    v_fmac_f32 v199, v46, v142
    v_fmac_f32 v199, v47, v143
    v_mul_f32 v201, v48, v136
    v_fmac_f32 v201, v49, v137
    v_permlane32_swap_b32 v197, v199
    v_fmac_f32 v201, v50, v138
    s_add_u32 m0, s21, 0
    v_mfma_f32_32x32x16_bf16 v[16:31], v[76:79], v[176:179], v[16:31]
    buffer_load_dwordx4 v238, s[4:7], s36 offen lds
    buffer_load_dwordx4 v239, s[8:11], s36 offen offset:1024 lds
    ds_read_b64_tr_b16 v[176:177], v244 offset:2048
    ds_read_b64_tr_b16 v[178:179], v244 offset:3072
    ds_read_b64_tr_b16 v[188:189], v245 offset:2048
    ds_read_b64_tr_b16 v[190:191], v245 offset:3072
    v_fmac_f32 v201, v51, v139
    v_fmac_f32 v201, v52, v140
    v_fmac_f32 v201, v53, v141
    v_fmac_f32 v201, v54, v142
    v_fmac_f32 v201, v55, v143
    v_add_f32 v199, v197, v199
    v_mul_f32_e64 v203, v56, -v136
    s_waitcnt lgkmcnt(0)
    v_mfma_f32_32x32x16_bf16 v[0:15], v[80:83], v[176:179], v[0:15]
    v_fma_f32 v203, v57, -v137, v203
    v_fma_f32 v203, v58, -v138, v203
    v_fma_f32 v203, v59, -v139, v203
    v_fma_f32 v203, v60, -v140, v203
    v_fma_f32 v203, v61, -v141, v203
    v_fma_f32 v203, v62, -v142, v203
    v_fma_f32 v203, v63, -v143, v203
    s_add_u32 m0, s21, 2048
    v_mfma_f32_32x32x16_bf16 v[16:31], v[84:87], v[176:179], v[16:31]
    buffer_load_dwordx4 v234, s[4:7], s37 offen lds
    buffer_load_dwordx4 v235, s[8:11], s37 offen offset:1024 lds
    v_add_u32 v252, s42, v247
    ds_read_u16 v234, v252
    ds_read_u16 v235, v252 offset:64
    s_nop 1
    v_permlane32_swap_b32 v201, v203
    v_add_f32 v203, v201, v203
    v_cvt_pk_bf16_f32 v198, v198, v199
    v_cvt_pk_bf16_f32 v202, v202, v203
    ds_write2st64_b32 v253, v198, v202 offset0:0 offset1:1
    v_mfma_f32_32x32x16_bf16 v[32:47], v[64:67], v[180:183], 0
    v_mul_f32 v196, v0, v144
    v_fmac_f32 v196, v1, v145
    v_fmac_f32 v196, v2, v146
    v_fmac_f32 v196, v3, v147
    v_fmac_f32 v196, v4, v148
    v_fmac_f32 v196, v5, v149
    v_mfma_f32_32x32x16_bf16 v[48:63], v[68:71], v[180:183], 0
    v_fmac_f32 v196, v6, v150
    v_fmac_f32 v196, v7, v151
    v_mul_f32 v198, v8, v112
    v_fmac_f32 v198, v9, v113
    v_fmac_f32 v198, v10, v114
    v_mfma_f32_32x32x16_bf16 v[32:47], v[72:75], v[184:187], v[32:47]
    v_fmac_f32 v198, v11, v115
    v_fmac_f32 v198, v12, v116
    v_fmac_f32 v198, v13, v117
    v_fmac_f32 v198, v14, v118
    v_fmac_f32 v198, v15, v119
    v_mfma_f32_32x32x16_bf16 v[48:63], v[76:79], v[184:187], v[48:63]
    s_waitcnt vmcnt(6)
    ds_read_b64_tr_b16 v[176:177], v244 offset:4096
    ds_read_b64_tr_b16 v[178:179], v244 offset:5120
    ds_read_b64_tr_b16 v[180:181], v245 offset:4096
    ds_read_b64_tr_b16 v[182:183], v245 offset:5120
    v_mul_f32_e64 v200, v16, -v160
    v_fma_f32 v200, v17, -v161, v200
    v_fma_f32 v200, v18, -v162, v200
    v_fma_f32 v200, v19, -v163, v200
    v_fma_f32 v200, v20, -v164, v200
    v_fma_f32 v200, v21, -v165, v200
    v_mfma_f32_32x32x16_bf16 v[32:47], v[80:83], v[188:191], v[32:47]
    v_fma_f32 v200, v22, -v166, v200
    v_fma_f32 v200, v23, -v167, v200
    v_mul_f32_e64 v202, v24, -v160
    v_fma_f32 v202, v25, -v161, v202
    v_fma_f32 v202, v26, -v162, v202
    v_mfma_f32_32x32x16_bf16 v[48:63], v[84:87], v[188:191], v[48:63]
    v_fma_f32 v202, v27, -v163, v202
    v_fma_f32 v202, v28, -v164, v202
    v_fma_f32 v202, v29, -v165, v202
    v_fma_f32 v202, v30, -v166, v202
    v_fma_f32 v202, v31, -v167, v202
    s_waitcnt vmcnt(4) lgkmcnt(0)
    v_mfma_f32_32x32x16_bf16 v[0:15], v[64:67], v[176:179], 0
    v_mul_f32 v197, v32, v152
    v_fmac_f32 v197, v33, v153
    v_fmac_f32 v197, v34, v154
    v_fmac_f32 v197, v35, v155
    v_fmac_f32 v197, v36, v156
    v_fmac_f32 v197, v37, v157
    s_add_u32 m0, s21, 4096
    v_mfma_f32_32x32x16_bf16 v[16:31], v[68:71], v[176:179], 0
    buffer_load_dwordx4 v236, s[4:7], s37 offen lds
    buffer_load_dwordx4 v237, s[8:11], s37 offen offset:1024 lds
    ds_read_b64_tr_b16 v[176:177], v244 offset:6144
    ds_read_b64_tr_b16 v[178:179], v244 offset:7168
    ds_read_b64_tr_b16 v[184:185], v245 offset:6144
    ds_read_b64_tr_b16 v[186:187], v245 offset:7168
    v_add_u32 v252, s43, v247
    ds_read_u16 v236, v252
    ds_read_u16 v237, v252 offset:64
    v_fmac_f32 v197, v38, v158
    v_fmac_f32 v197, v39, v159
    v_mul_f32 v199, v40, v120
    v_fmac_f32 v199, v41, v121
    v_fmac_f32 v199, v42, v122
    s_waitcnt vmcnt(4) lgkmcnt(2)
    v_mfma_f32_32x32x16_bf16 v[0:15], v[72:75], v[176:179], v[0:15]
    v_fmac_f32 v199, v43, v123
    v_fmac_f32 v199, v44, v124
    v_fmac_f32 v199, v45, v125
    v_fmac_f32 v199, v46, v126
    v_fmac_f32 v199, v47, v127
    s_add_u32 m0, s21, 6144
    v_mfma_f32_32x32x16_bf16 v[16:31], v[76:79], v[176:179], v[16:31]
    buffer_load_dwordx4 v238, s[4:7], s37 offen lds
    buffer_load_dwordx4 v239, s[8:11], s37 offen offset:1024 lds
    ds_read_b64_tr_b16 v[176:177], v244 offset:0
    ds_read_b64_tr_b16 v[178:179], v244 offset:1024
    ds_read_b64_tr_b16 v[188:189], v245 offset:0
    ds_read_b64_tr_b16 v[190:191], v245 offset:1024
    v_add_u32 v252, s44, v247
    ds_read_u16 v238, v252
    ds_read_u16 v239, v252 offset:64
    v_mul_f32_e64 v201, v48, -v168
    v_fma_f32 v201, v49, -v169, v201
    v_fma_f32 v201, v50, -v170, v201
    v_fma_f32 v201, v51, -v171, v201
    v_fma_f32 v201, v52, -v172, v201
    v_fma_f32 v201, v53, -v173, v201
    s_waitcnt lgkmcnt(2)
    v_mfma_f32_32x32x16_bf16 v[0:15], v[80:83], v[176:179], v[0:15]
    v_fma_f32 v201, v54, -v174, v201
    v_fma_f32 v201, v55, -v175, v201
    v_mul_f32_e64 v203, v56, -v168
    v_fma_f32 v203, v57, -v169, v203
    v_fma_f32 v203, v58, -v170, v203
    s_add_u32 m0, s21, 0
    v_mfma_f32_32x32x16_bf16 v[16:31], v[84:87], v[176:179], v[16:31]
    v_lshl_add_u32 v234, v234, 10, v246
    v_lshl_add_u32 v235, v235, 10, v246
    buffer_load_dwordx4 v234, s[4:7], s38 offen lds
    buffer_load_dwordx4 v235, s[8:11], s38 offen offset:1024 lds
    v_fma_f32 v203, v59, -v171, v203
    v_fma_f32 v203, v60, -v172, v203
    v_fma_f32 v203, v61, -v173, v203
    v_fma_f32 v203, v62, -v174, v203
    v_fma_f32 v203, v63, -v175, v203
    v_mfma_f32_32x32x16_bf16 v[32:47], v[64:67], v[180:183], 0
    v_mul_f32 v254, v0, v144
    v_fmac_f32 v254, v1, v145
    v_fmac_f32 v254, v2, v146
    v_mfma_f32_32x32x16_bf16 v[48:63], v[68:71], v[180:183], 0
    ds_swizzle_b32 v68, v68 offset:0x401F
    ds_swizzle_b32 v69, v69 offset:0x401F
    ds_swizzle_b32 v70, v70 offset:0x401F
    ds_swizzle_b32 v71, v71 offset:0x401F
    v_fmac_f32 v254, v3, v147
    v_fmac_f32 v254, v4, v148
    v_fmac_f32 v254, v5, v149
    v_mfma_f32_32x32x16_bf16 v[32:47], v[72:75], v[184:187], v[32:47]
    v_fmac_f32 v254, v6, v150
    v_fmac_f32 v254, v7, v151
    v_fmac_f32 v200, v8, v160
    v_mfma_f32_32x32x16_bf16 v[48:63], v[76:79], v[184:187], v[48:63]
    ds_swizzle_b32 v76, v76 offset:0x401F
    ds_swizzle_b32 v77, v77 offset:0x401F
    ds_swizzle_b32 v78, v78 offset:0x401F
    ds_swizzle_b32 v79, v79 offset:0x401F
    s_waitcnt vmcnt(6)
    ds_read_b64_tr_b16 v[176:177], v244 offset:2048
    ds_read_b64_tr_b16 v[178:179], v244 offset:3072
    ds_read_b64_tr_b16 v[180:181], v245 offset:2048
    ds_read_b64_tr_b16 v[182:183], v245 offset:3072
    v_fmac_f32 v200, v9, v161
    v_permlane32_swap_b32 v196, v254
    v_fmac_f32 v200, v10, v162
    v_mfma_f32_32x32x16_bf16 v[32:47], v[80:83], v[188:191], v[32:47]
    v_fmac_f32 v200, v11, v163
    v_fmac_f32 v200, v12, v164
    v_fmac_f32 v200, v13, v165
    v_mfma_f32_32x32x16_bf16 v[48:63], v[84:87], v[188:191], v[48:63]
    ds_swizzle_b32 v84, v84 offset:0x401F
    ds_swizzle_b32 v85, v85 offset:0x401F
    ds_swizzle_b32 v86, v86 offset:0x401F
    ds_swizzle_b32 v87, v87 offset:0x401F
    v_fmac_f32 v200, v14, v166
    v_fmac_f32 v200, v15, v167
    v_add_f32 v254, v196, v254
    s_waitcnt lgkmcnt(8)
    s_mov_b64 exec, s[56:57]
    v_xor_b32 v68, 0x80008000, v68
    v_xor_b32 v69, 0x80008000, v69
    v_xor_b32 v70, 0x80008000, v70
    v_xor_b32 v71, 0x80008000, v71
    v_xor_b32 v76, 0x80008000, v76
    v_xor_b32 v77, 0x80008000, v77
    v_xor_b32 v78, 0x80008000, v78
    v_xor_b32 v79, 0x80008000, v79
    s_mov_b64 exec, -1
    s_waitcnt vmcnt(4) lgkmcnt(4)
    v_mfma_f32_32x32x16_bf16 v[0:15], v[64:67], v[176:179], 0
    v_mul_f32 v255, v32, v152
    v_fmac_f32 v255, v33, v153
    v_fmac_f32 v255, v34, v154
    v_fmac_f32 v255, v35, v155
    s_add_u32 m0, s21, 2048
    v_mfma_f32_32x32x16_bf16 v[16:31], v[68:71], v[176:179], v[16:31]
    v_lshl_add_u32 v236, v236, 10, v246
    v_lshl_add_u32 v237, v237, 10, v246
    buffer_load_dwordx4 v236, s[4:7], s39 offen lds
    buffer_load_dwordx4 v237, s[8:11], s39 offen offset:1024 lds
    ds_read_b64_tr_b16 v[176:177], v244 offset:4096
    ds_read_b64_tr_b16 v[178:179], v244 offset:5120
    ds_read_b64_tr_b16 v[184:185], v245 offset:4096
    ds_read_b64_tr_b16 v[186:187], v245 offset:5120
    v_fmac_f32 v255, v36, v156
    v_fmac_f32 v255, v37, v157
    v_fmac_f32 v255, v38, v158
    s_waitcnt vmcnt(4) lgkmcnt(0)
    v_mfma_f32_32x32x16_bf16 v[0:15], v[72:75], v[176:179], v[0:15]
    v_fmac_f32 v255, v39, v159
    v_fmac_f32 v201, v40, v168
    v_fmac_f32 v201, v41, v169
    s_add_u32 m0, s21, 4096
    v_mfma_f32_32x32x16_bf16 v[16:31], v[76:79], v[176:179], v[16:31]
    v_lshl_add_u32 v238, v238, 10, v246
    v_lshl_add_u32 v239, v239, 10, v246
    buffer_load_dwordx4 v238, s[4:7], s40 offen lds
    buffer_load_dwordx4 v239, s[8:11], s40 offen offset:1024 lds
    ds_read_b64_tr_b16 v[176:177], v244 offset:6144
    ds_read_b64_tr_b16 v[178:179], v244 offset:7168
    ds_read_b64_tr_b16 v[188:189], v245 offset:6144
    ds_read_b64_tr_b16 v[190:191], v245 offset:7168
    v_permlane32_swap_b32 v197, v255
    v_fmac_f32 v201, v42, v170
    v_fmac_f32 v201, v43, v171
    v_fmac_f32 v201, v44, v172
    s_waitcnt lgkmcnt(0)
    s_mov_b64 exec, s[56:57]
    v_xor_b32 v84, 0x80008000, v84
    v_xor_b32 v85, 0x80008000, v85
    v_xor_b32 v86, 0x80008000, v86
    v_xor_b32 v87, 0x80008000, v87
    s_mov_b64 exec, -1
    v_mfma_f32_32x32x16_bf16 v[0:15], v[80:83], v[176:179], v[0:15]
    v_fmac_f32 v201, v45, v173
    v_fmac_f32 v201, v46, v174
    v_fmac_f32 v201, v47, v175
    s_add_u32 m0, s21, 6144
    v_mfma_f32_32x32x16_bf16 v[16:31], v[84:87], v[176:179], v[16:31]
    v_lshl_add_u32 v240, v240, 10, v246
    v_lshl_add_u32 v241, v241, 10, v246
    buffer_load_dwordx4 v240, s[4:7], s41 offen lds
    buffer_load_dwordx4 v241, s[8:11], s41 offen offset:1024 lds
    v_add_f32 v255, v197, v255
    v_cvt_pk_bf16_f32 v254, v254, v255
    ds_write_b32 v253, v254 offset:512
    v_mfma_f32_32x32x16_bf16 v[32:47], v[64:67], v[180:183], 0
    v_mul_f32 v254, v0, v144
    v_fmac_f32 v254, v1, v145
    v_fmac_f32 v254, v2, v146
    v_fmac_f32 v254, v3, v147
    v_fmac_f32 v254, v4, v148
    v_fmac_f32 v254, v5, v149
    v_fmac_f32 v254, v6, v150
    v_mfma_f32_32x32x16_bf16 v[48:63], v[68:71], v[180:183], v[48:63]
    v_fmac_f32 v254, v7, v151
    v_fma_f32 v202, v8, -v160, v202
    v_fma_f32 v202, v9, -v161, v202
    v_permlane32_swap_b32 v254, v200
    v_fma_f32 v202, v10, -v162, v202
    v_fma_f32 v202, v11, -v163, v202
    v_mfma_f32_32x32x16_bf16 v[32:47], v[72:75], v[184:187], v[32:47]
    v_fma_f32 v202, v12, -v164, v202
    v_fma_f32 v202, v13, -v165, v202
    v_fma_f32 v202, v14, -v166, v202
    v_fma_f32 v202, v15, -v167, v202
    v_add_f32 v200, v254, v200
    v_fmac_f32 v198, v16, v112
    v_permlane32_swap_b32 v202, v254
    v_mfma_f32_32x32x16_bf16 v[48:63], v[76:79], v[184:187], v[48:63]
    s_waitcnt vmcnt(6)
    ds_read_b64_tr_b16 v[176:177], v244 offset:0
    ds_read_b64_tr_b16 v[178:179], v244 offset:1024
    ds_read_b64_tr_b16 v[180:181], v245 offset:0
    ds_read_b64_tr_b16 v[182:183], v245 offset:1024
    v_fmac_f32 v198, v17, v113
    v_fmac_f32 v198, v18, v114
    v_fmac_f32 v198, v19, v115
    v_fmac_f32 v198, v20, v116
    v_fmac_f32 v198, v21, v117
    v_fmac_f32 v198, v22, v118
    v_mfma_f32_32x32x16_bf16 v[32:47], v[80:83], v[188:191], v[32:47]
    v_fmac_f32 v198, v23, v119
    v_add_f32 v254, v202, v254
    v_mul_f32 v196, v24, v160
    v_fmac_f32 v196, v25, v161
    v_fmac_f32 v196, v26, v162
    v_fmac_f32 v196, v27, v163
    v_fmac_f32 v196, v28, v164
    v_mfma_f32_32x32x16_bf16 v[48:63], v[84:87], v[188:191], v[48:63]
    v_add_u32 v249, s48, v249
    v_add_u32 v250, s49, v250
    ds_read_b32 v252, v251 offset:16
    ds_read_b64_tr_b16 v[64:65], v249 offset:0
    ds_read_b64_tr_b16 v[68:69], v249 offset:64
    ds_read_b64_tr_b16 v[66:67], v249 offset:256
    ds_read_b64_tr_b16 v[70:71], v249 offset:320
    s_mov_b64 exec, s[54:55]
    ds_read_u16_d16_hi v242, v250 offset:0
    s_mov_b64 exec, -1
    v_fmac_f32 v196, v29, v165
    v_fmac_f32 v196, v30, v166
    v_fmac_f32 v196, v31, v167
    s_nop 1
    v_permlane32_swap_b32 v198, v196
    v_add_f32 v196, v198, v196
    v_mul_f32 v255, v32, v152
    v_fmac_f32 v255, v33, v153
    v_fmac_f32 v255, v34, v154
    v_fmac_f32 v255, v35, v155
    v_fmac_f32 v255, v36, v156
    v_fmac_f32 v255, v37, v157
    v_fmac_f32 v255, v38, v158
    v_fmac_f32 v255, v39, v159
    v_fma_f32 v203, v40, -v168, v203
    v_fma_f32 v203, v41, -v169, v203
    v_permlane32_swap_b32 v255, v201
    v_fma_f32 v203, v42, -v170, v203
    v_fma_f32 v203, v43, -v171, v203
    v_fma_f32 v203, v44, -v172, v203
    v_fma_f32 v203, v45, -v173, v203
    v_fma_f32 v203, v46, -v174, v203
    v_fma_f32 v203, v47, -v175, v203
    v_add_f32 v201, v255, v201
    v_fmac_f32 v199, v48, v120
    v_permlane32_swap_b32 v203, v255
    v_fmac_f32 v199, v49, v121
    v_fmac_f32 v199, v50, v122
    v_fmac_f32 v199, v51, v123
    v_fmac_f32 v199, v52, v124
    v_fmac_f32 v199, v53, v125
    v_fmac_f32 v199, v54, v126
    v_fmac_f32 v199, v55, v127
    v_add_f32 v255, v203, v255
    v_mul_f32 v197, v56, v168
    v_fmac_f32 v197, v57, v169
    v_fmac_f32 v197, v58, v170
    v_fmac_f32 v197, v59, v171
    v_fmac_f32 v197, v60, v172
    v_fmac_f32 v197, v61, v173
    v_fmac_f32 v197, v62, v174
    v_fmac_f32 v197, v63, v175
    s_nop 1
    v_permlane32_swap_b32 v199, v197
    v_add_f32 v197, v199, v197
    v_cvt_pk_bf16_f32 v200, v200, v201
    v_cvt_pk_bf16_f32 v254, v254, v255
    v_cvt_pk_bf16_f32 v196, v196, v197
    ds_write2st64_b32 v253, v200, v196 offset0:3 offset1:4
    s_mov_b64 exec, 0xffffffff
    ds_write_b32 v253, v254 offset:1280
    s_mov_b64 exec, -1
    s_add_u32 s50, s50, 1
    s_cmp_ge_u32 s50, 4
    s_cbranch_scc1 LAST1
    s_waitcnt lgkmcnt(7)
    v_readfirstlane_b32 s66, v252
    s_add_u32 s53, s53, 1
    v_mov_b32 v252, s53
    s_cmp_le_u32 s53, s66
    ds_write2_b32 v251, v252, v252 offset0:0 offset1:8
    s_setprio 1
    s_cbranch_scc1 PRIO_14
    s_setprio 0
PRIO_14:
    s_cmp_eq_u32 s52, 4
    s_cbranch_scc1 ITEM_1_4
    s_cmp_eq_u32 s52, 5
    s_cbranch_scc1 ITEM_1_5
    s_cmp_eq_u32 s52, 3
    s_cbranch_scc1 ITEM_1_3
    s_cmp_eq_u32 s52, 6
    s_cbranch_scc1 ITEM_1_6
    s_cmp_eq_u32 s52, 8
    s_cbranch_scc1 ITEM_1_8
    s_branch ITEM_1_2
.p2align 6
ITEM_1_8:
    s_mov_b64 exec, s[54:55]
    ds_read_u16_d16_hi v243, v250 offset:128
    s_mov_b64 exec, -1
    ds_read_b64_tr_b16 v[72:73], v249 offset:512
    ds_read_b64_tr_b16 v[76:77], v249 offset:576
    ds_read_b64_tr_b16 v[74:75], v249 offset:768
    ds_read_b64_tr_b16 v[78:79], v249 offset:832
    ds_read_b64_tr_b16 v[80:81], v249 offset:1024
    ds_read_b64_tr_b16 v[84:85], v249 offset:1088
    ds_read_b64_tr_b16 v[82:83], v249 offset:1280
    ds_read_b64_tr_b16 v[86:87], v249 offset:1344
    ds_read_b64_tr_b16 v[88:89], v249 offset:1536
    ds_read_b64_tr_b16 v[92:93], v249 offset:1600
    ds_read_b64_tr_b16 v[90:91], v249 offset:1792
    ds_read_b64_tr_b16 v[94:95], v249 offset:1856
    s_waitcnt lgkmcnt(13)
    v_mul_f32_dpp v196, v242, v64 row_newbcast:0 row_mask:0xf bank_mask:0xf
    v_mul_f32_dpp v197, v242, v65 row_newbcast:1 row_mask:0xf bank_mask:0xf
    v_mul_f32_dpp v198, v242, v64 row_newbcast:8 row_mask:0xf bank_mask:0xf
    v_mul_f32_dpp v199, v242, v65 row_newbcast:9 row_mask:0xf bank_mask:0xf
    v_mul_f32_dpp v200, v242, v68 row_newbcast:2 row_mask:0xf bank_mask:0xf
    v_mul_f32_dpp v201, v242, v69 row_newbcast:3 row_mask:0xf bank_mask:0xf
    v_mul_f32_dpp v202, v242, v68 row_newbcast:10 row_mask:0xf bank_mask:0xf
    v_mul_f32_dpp v203, v242, v69 row_newbcast:11 row_mask:0xf bank_mask:0xf
    v_cvt_pk_bf16_f32 v64, v196, v197
    v_cvt_pk_bf16_f32 v68, v198, v199
    v_cvt_pk_bf16_f32 v65, v200, v201
    v_cvt_pk_bf16_f32 v69, v202, v203
    v_mul_f32_dpp v196, v242, v66 row_newbcast:4 row_mask:0xf bank_mask:0xf
    v_mul_f32_dpp v197, v242, v67 row_newbcast:5 row_mask:0xf bank_mask:0xf
    v_mul_f32_dpp v198, v242, v66 row_newbcast:12 row_mask:0xf bank_mask:0xf
    v_mul_f32_dpp v199, v242, v67 row_newbcast:13 row_mask:0xf bank_mask:0xf
    v_mul_f32_dpp v200, v242, v70 row_newbcast:6 row_mask:0xf bank_mask:0xf
    v_mul_f32_dpp v201, v242, v71 row_newbcast:7 row_mask:0xf bank_mask:0xf
    v_mul_f32_dpp v202, v242, v70 row_newbcast:14 row_mask:0xf bank_mask:0xf
    v_mul_f32_dpp v203, v242, v71 row_newbcast:15 row_mask:0xf bank_mask:0xf
    v_cvt_pk_bf16_f32 v66, v196, v197
    v_cvt_pk_bf16_f32 v70, v198, v199
    v_cvt_pk_bf16_f32 v67, v200, v201
    v_cvt_pk_bf16_f32 v71, v202, v203
    s_mov_b64 exec, s[54:55]
    ds_read_u16_d16_hi v242, v250 offset:256
    s_mov_b64 exec, -1
    s_waitcnt vmcnt(4) lgkmcnt(9)
    v_mfma_f32_32x32x16_bf16 v[0:15], v[64:67], v[176:179], 0
    v_mul_f32_dpp v196, v243, v72 row_newbcast:0 row_mask:0xf bank_mask:0xf
    v_mul_f32_dpp v197, v243, v73 row_newbcast:1 row_mask:0xf bank_mask:0xf
    v_mul_f32_dpp v198, v243, v72 row_newbcast:8 row_mask:0xf bank_mask:0xf
    v_mul_f32_dpp v199, v243, v73 row_newbcast:9 row_mask:0xf bank_mask:0xf
    v_mul_f32_dpp v200, v243, v76 row_newbcast:2 row_mask:0xf bank_mask:0xf
    v_mul_f32_dpp v201, v243, v77 row_newbcast:3 row_mask:0xf bank_mask:0xf
    v_mul_f32_dpp v202, v243, v76 row_newbcast:10 row_mask:0xf bank_mask:0xf
    v_mul_f32_dpp v203, v243, v77 row_newbcast:11 row_mask:0xf bank_mask:0xf
    v_cvt_pk_bf16_f32 v72, v196, v197
    v_cvt_pk_bf16_f32 v76, v198, v199
    v_cvt_pk_bf16_f32 v73, v200, v201
    v_cvt_pk_bf16_f32 v77, v202, v203
    s_add_u32 m0, s21, 0
    v_mfma_f32_32x32x16_bf16 v[16:31], v[68:71], v[176:179], 0
    buffer_load_dwordx4 v234, s[4:7], s35 offen lds
    buffer_load_dwordx4 v235, s[8:11], s35 offen offset:1024 lds
    ds_read_b64_tr_b16 v[176:177], v244 offset:2048
    ds_read_b64_tr_b16 v[178:179], v244 offset:3072
    ds_read_b64_tr_b16 v[184:185], v245 offset:2048
    ds_read_b64_tr_b16 v[186:187], v245 offset:3072
    v_mul_f32_dpp v196, v243, v74 row_newbcast:4 row_mask:0xf bank_mask:0xf
    v_mul_f32_dpp v197, v243, v75 row_newbcast:5 row_mask:0xf bank_mask:0xf
    v_mul_f32_dpp v198, v243, v74 row_newbcast:12 row_mask:0xf bank_mask:0xf
    v_mul_f32_dpp v199, v243, v75 row_newbcast:13 row_mask:0xf bank_mask:0xf
    v_mul_f32_dpp v200, v243, v78 row_newbcast:6 row_mask:0xf bank_mask:0xf
    v_mul_f32_dpp v201, v243, v79 row_newbcast:7 row_mask:0xf bank_mask:0xf
    v_mul_f32_dpp v202, v243, v78 row_newbcast:14 row_mask:0xf bank_mask:0xf
    v_mul_f32_dpp v203, v243, v79 row_newbcast:15 row_mask:0xf bank_mask:0xf
    v_cvt_pk_bf16_f32 v74, v196, v197
    v_cvt_pk_bf16_f32 v78, v198, v199
    v_cvt_pk_bf16_f32 v75, v200, v201
    v_cvt_pk_bf16_f32 v79, v202, v203
    s_mov_b64 exec, s[54:55]
    ds_read_u16_d16_hi v243, v250 offset:384
    s_mov_b64 exec, -1
    s_waitcnt vmcnt(4) lgkmcnt(1)
    v_mfma_f32_32x32x16_bf16 v[0:15], v[72:75], v[176:179], v[0:15]
    v_mul_f32_dpp v196, v242, v80 row_newbcast:0 row_mask:0xf bank_mask:0xf
    v_mul_f32_dpp v197, v242, v81 row_newbcast:1 row_mask:0xf bank_mask:0xf
    v_mul_f32_dpp v198, v242, v80 row_newbcast:8 row_mask:0xf bank_mask:0xf
    v_mul_f32_dpp v199, v242, v81 row_newbcast:9 row_mask:0xf bank_mask:0xf
    v_mul_f32_dpp v200, v242, v84 row_newbcast:2 row_mask:0xf bank_mask:0xf
    v_mul_f32_dpp v201, v242, v85 row_newbcast:3 row_mask:0xf bank_mask:0xf
    v_mul_f32_dpp v202, v242, v84 row_newbcast:10 row_mask:0xf bank_mask:0xf
    v_mul_f32_dpp v203, v242, v85 row_newbcast:11 row_mask:0xf bank_mask:0xf
    v_cvt_pk_bf16_f32 v80, v196, v197
    v_cvt_pk_bf16_f32 v84, v198, v199
    v_cvt_pk_bf16_f32 v81, v200, v201
    v_cvt_pk_bf16_f32 v85, v202, v203
    s_add_u32 m0, s21, 2048
    v_mfma_f32_32x32x16_bf16 v[16:31], v[76:79], v[176:179], v[16:31]
    buffer_load_dwordx4 v236, s[4:7], s35 offen lds
    buffer_load_dwordx4 v237, s[8:11], s35 offen offset:1024 lds
    ds_read_b64_tr_b16 v[176:177], v244 offset:4096
    ds_read_b64_tr_b16 v[178:179], v244 offset:5120
    ds_read_b64_tr_b16 v[188:189], v245 offset:4096
    ds_read_b64_tr_b16 v[190:191], v245 offset:5120
    v_mul_f32_dpp v196, v242, v82 row_newbcast:4 row_mask:0xf bank_mask:0xf
    v_mul_f32_dpp v197, v242, v83 row_newbcast:5 row_mask:0xf bank_mask:0xf
    v_mul_f32_dpp v198, v242, v82 row_newbcast:12 row_mask:0xf bank_mask:0xf
    v_mul_f32_dpp v199, v242, v83 row_newbcast:13 row_mask:0xf bank_mask:0xf
    v_mul_f32_dpp v200, v242, v86 row_newbcast:6 row_mask:0xf bank_mask:0xf
    v_mul_f32_dpp v201, v242, v87 row_newbcast:7 row_mask:0xf bank_mask:0xf
    v_mul_f32_dpp v202, v242, v86 row_newbcast:14 row_mask:0xf bank_mask:0xf
    v_mul_f32_dpp v203, v242, v87 row_newbcast:15 row_mask:0xf bank_mask:0xf
    v_cvt_pk_bf16_f32 v82, v196, v197
    v_cvt_pk_bf16_f32 v86, v198, v199
    v_cvt_pk_bf16_f32 v83, v200, v201
    v_cvt_pk_bf16_f32 v87, v202, v203
    s_nop 0
    s_waitcnt vmcnt(4) lgkmcnt(0)
    v_mfma_f32_32x32x16_bf16 v[0:15], v[80:83], v[176:179], v[0:15]
    v_mul_f32_dpp v196, v243, v88 row_newbcast:0 row_mask:0xf bank_mask:0xf
    v_mul_f32_dpp v197, v243, v89 row_newbcast:1 row_mask:0xf bank_mask:0xf
    v_mul_f32_dpp v198, v243, v88 row_newbcast:8 row_mask:0xf bank_mask:0xf
    v_mul_f32_dpp v199, v243, v89 row_newbcast:9 row_mask:0xf bank_mask:0xf
    v_mul_f32_dpp v200, v243, v92 row_newbcast:2 row_mask:0xf bank_mask:0xf
    v_mul_f32_dpp v201, v243, v93 row_newbcast:3 row_mask:0xf bank_mask:0xf
    v_mul_f32_dpp v202, v243, v92 row_newbcast:10 row_mask:0xf bank_mask:0xf
    v_mul_f32_dpp v203, v243, v93 row_newbcast:11 row_mask:0xf bank_mask:0xf
    v_cvt_pk_bf16_f32 v88, v196, v197
    v_cvt_pk_bf16_f32 v92, v198, v199
    v_cvt_pk_bf16_f32 v89, v200, v201
    v_cvt_pk_bf16_f32 v93, v202, v203
    s_add_u32 m0, s21, 4096
    v_mfma_f32_32x32x16_bf16 v[16:31], v[84:87], v[176:179], v[16:31]
    buffer_load_dwordx4 v238, s[4:7], s35 offen lds
    buffer_load_dwordx4 v239, s[8:11], s35 offen offset:1024 lds
    ds_read_b64_tr_b16 v[176:177], v244 offset:6144
    ds_read_b64_tr_b16 v[178:179], v244 offset:7168
    ds_read_b64_tr_b16 v[192:193], v245 offset:6144
    ds_read_b64_tr_b16 v[194:195], v245 offset:7168
    v_mul_f32_dpp v196, v243, v90 row_newbcast:4 row_mask:0xf bank_mask:0xf
    v_mul_f32_dpp v197, v243, v91 row_newbcast:5 row_mask:0xf bank_mask:0xf
    v_mul_f32_dpp v198, v243, v90 row_newbcast:12 row_mask:0xf bank_mask:0xf
    v_mul_f32_dpp v199, v243, v91 row_newbcast:13 row_mask:0xf bank_mask:0xf
    v_mul_f32_dpp v200, v243, v94 row_newbcast:6 row_mask:0xf bank_mask:0xf
    v_mul_f32_dpp v201, v243, v95 row_newbcast:7 row_mask:0xf bank_mask:0xf
    v_mul_f32_dpp v202, v243, v94 row_newbcast:14 row_mask:0xf bank_mask:0xf
    v_mul_f32_dpp v203, v243, v95 row_newbcast:15 row_mask:0xf bank_mask:0xf
    v_cvt_pk_bf16_f32 v90, v196, v197
    v_cvt_pk_bf16_f32 v94, v198, v199
    v_cvt_pk_bf16_f32 v91, v200, v201
    v_cvt_pk_bf16_f32 v95, v202, v203
    s_nop 0
    s_waitcnt lgkmcnt(0)
    v_mfma_f32_32x32x16_bf16 v[0:15], v[88:91], v[176:179], v[0:15]
    s_add_u32 m0, s21, 6144
    v_mfma_f32_32x32x16_bf16 v[16:31], v[92:95], v[176:179], v[16:31]
    buffer_load_dwordx4 v240, s[4:7], s35 offen lds
    buffer_load_dwordx4 v241, s[8:11], s35 offen offset:1024 lds
    s_mov_b32 m0, s50
    s_nop 0
    s_movrels_b32 s71, s23
    s_movrels_b32 s33, s28
    s_and_b32 s70, s33, 0x70
    s_andn2_b32 s33, s33, 0x70
    v_xor_b32 v253, s70, v248
    v_add_u32 v253, s33, v253
    s_bfe_u32 s46, s71, 0x30012
    s_mov_b32 m0, s46
    s_and_b32 s66, s71, 0x3ffff
    s_movrels_b32 s68, s57
    s_movrels_b32 s69, s61
    s_sub_u32 s48, s66, s47
    s_mov_b32 s47, s66
    s_lshr_b32 s52, s71, 28
    s_lshl_b32 s67, s46, 9
    s_add_u32 s66, s66, s67
    s_sub_u32 s49, s66, s42
    s_mov_b32 s42, s66
    s_bfe_u32 s66, s68, 655360
    s_add_u32 s43, s42, s66
    s_bfe_u32 s39, s69, 655360
    s_bfe_u32 s66, s68, 655370
    s_add_u32 s44, s42, s66
    s_bfe_u32 s40, s69, 655370
    s_bfe_u32 s66, s68, 655380
    s_add_u32 s45, s42, s66
    s_bfe_u32 s41, s69, 655380
    v_mfma_f32_32x32x16_bf16 v[32:47], v[64:67], v[180:183], 0
    v_mul_f32 v196, v0, v96
    v_fmac_f32 v196, v1, v97
    v_fmac_f32 v196, v2, v98
    v_fmac_f32 v196, v3, v99
    v_fmac_f32 v196, v4, v100
    v_mfma_f32_32x32x16_bf16 v[48:63], v[68:71], v[180:183], 0
    v_fmac_f32 v196, v5, v101
    v_fmac_f32 v196, v6, v102
    v_fmac_f32 v196, v7, v103
    v_mul_f32 v198, v8, v128
    v_fmac_f32 v198, v9, v129
    v_mfma_f32_32x32x16_bf16 v[32:47], v[72:75], v[184:187], v[32:47]
    v_fmac_f32 v198, v10, v130
    v_fmac_f32 v198, v11, v131
    v_fmac_f32 v198, v12, v132
    v_fmac_f32 v198, v13, v133
    v_mfma_f32_32x32x16_bf16 v[48:63], v[76:79], v[184:187], v[48:63]
    v_fmac_f32 v198, v14, v134
    v_fmac_f32 v198, v15, v135
    v_mul_f32 v200, v16, v128
    v_fmac_f32 v200, v17, v129
    v_permlane32_swap_b32 v196, v198
    v_mfma_f32_32x32x16_bf16 v[32:47], v[80:83], v[188:191], v[32:47]
    v_fmac_f32 v200, v18, v130
    v_fmac_f32 v200, v19, v131
    v_fmac_f32 v200, v20, v132
    v_fmac_f32 v200, v21, v133
    v_fmac_f32 v200, v22, v134
    v_mfma_f32_32x32x16_bf16 v[48:63], v[84:87], v[188:191], v[48:63]
    s_waitcnt vmcnt(6)
    ds_read_b64_tr_b16 v[176:177], v244 offset:0
    ds_read_b64_tr_b16 v[178:179], v244 offset:1024
    ds_read_b64_tr_b16 v[180:181], v245 offset:0
    ds_read_b64_tr_b16 v[182:183], v245 offset:1024
    v_fmac_f32 v200, v23, v135
    v_add_f32 v198, v196, v198
    v_mul_f32_e64 v202, v24, -v128
    v_fma_f32 v202, v25, -v129, v202
    v_mfma_f32_32x32x16_bf16 v[32:47], v[88:91], v[192:195], v[32:47]
    v_fma_f32 v202, v26, -v130, v202
    v_fma_f32 v202, v27, -v131, v202
    v_fma_f32 v202, v28, -v132, v202
    v_fma_f32 v202, v29, -v133, v202
    v_fma_f32 v202, v30, -v134, v202
    v_mfma_f32_32x32x16_bf16 v[48:63], v[92:95], v[192:195], v[48:63]
    v_fma_f32 v202, v31, -v135, v202
    s_nop 1
    v_permlane32_swap_b32 v200, v202
    v_add_f32 v202, v200, v202
    s_waitcnt vmcnt(4) lgkmcnt(0)
    v_mfma_f32_32x32x16_bf16 v[0:15], v[64:67], v[176:179], 0
    v_mul_f32 v197, v32, v104
    v_fmac_f32 v197, v33, v105
    v_fmac_f32 v197, v34, v106
    v_fmac_f32 v197, v35, v107
    v_fmac_f32 v197, v36, v108
    s_add_u32 m0, s21, 0
    v_mfma_f32_32x32x16_bf16 v[16:31], v[68:71], v[176:179], 0
    buffer_load_dwordx4 v234, s[4:7], s36 offen lds
    buffer_load_dwordx4 v235, s[8:11], s36 offen offset:1024 lds
    ds_read_b64_tr_b16 v[176:177], v244 offset:2048
    ds_read_b64_tr_b16 v[178:179], v244 offset:3072
    ds_read_b64_tr_b16 v[184:185], v245 offset:2048
    ds_read_b64_tr_b16 v[186:187], v245 offset:3072
    v_fmac_f32 v197, v37, v109
    v_fmac_f32 v197, v38, v110
    v_fmac_f32 v197, v39, v111
    v_mul_f32 v199, v40, v136
    v_fmac_f32 v199, v41, v137
    s_waitcnt vmcnt(4) lgkmcnt(0)
    v_mfma_f32_32x32x16_bf16 v[0:15], v[72:75], v[176:179], v[0:15]
    v_fmac_f32 v199, v42, v138
    v_fmac_f32 v199, v43, v139
    v_fmac_f32 v199, v44, v140
    v_fmac_f32 v199, v45, v141
    v_fmac_f32 v199, v46, v142
    s_add_u32 m0, s21, 2048
    v_mfma_f32_32x32x16_bf16 v[16:31], v[76:79], v[176:179], v[16:31]
    buffer_load_dwordx4 v236, s[4:7], s36 offen lds
    buffer_load_dwordx4 v237, s[8:11], s36 offen offset:1024 lds
    ds_read_b64_tr_b16 v[176:177], v244 offset:4096
    ds_read_b64_tr_b16 v[178:179], v244 offset:5120
    ds_read_b64_tr_b16 v[188:189], v245 offset:4096
    ds_read_b64_tr_b16 v[190:191], v245 offset:5120
    v_fmac_f32 v199, v47, v143
    v_mul_f32 v201, v48, v136
    v_fmac_f32 v201, v49, v137
    v_permlane32_swap_b32 v197, v199
    v_fmac_f32 v201, v50, v138
    s_waitcnt vmcnt(4) lgkmcnt(0)
    v_mfma_f32_32x32x16_bf16 v[0:15], v[80:83], v[176:179], v[0:15]
    v_fmac_f32 v201, v51, v139
    v_fmac_f32 v201, v52, v140
    v_fmac_f32 v201, v53, v141
    v_fmac_f32 v201, v54, v142
    v_fmac_f32 v201, v55, v143
    s_add_u32 m0, s21, 4096
    v_mfma_f32_32x32x16_bf16 v[16:31], v[84:87], v[176:179], v[16:31]
    buffer_load_dwordx4 v238, s[4:7], s36 offen lds
    buffer_load_dwordx4 v239, s[8:11], s36 offen offset:1024 lds
    ds_read_b64_tr_b16 v[176:177], v244 offset:6144
    ds_read_b64_tr_b16 v[178:179], v244 offset:7168
    ds_read_b64_tr_b16 v[192:193], v245 offset:6144
    ds_read_b64_tr_b16 v[194:195], v245 offset:7168
    v_add_f32 v199, v197, v199
    v_mul_f32_e64 v203, v56, -v136
    v_fma_f32 v203, v57, -v137, v203
    v_fma_f32 v203, v58, -v138, v203
    v_fma_f32 v203, v59, -v139, v203
    s_waitcnt lgkmcnt(0)
    v_mfma_f32_32x32x16_bf16 v[0:15], v[88:91], v[176:179], v[0:15]
    v_fma_f32 v203, v60, -v140, v203
    v_fma_f32 v203, v61, -v141, v203
    v_fma_f32 v203, v62, -v142, v203
    v_fma_f32 v203, v63, -v143, v203
    s_nop 1
    s_add_u32 m0, s21, 6144
    v_mfma_f32_32x32x16_bf16 v[16:31], v[92:95], v[176:179], v[16:31]
    buffer_load_dwordx4 v240, s[4:7], s36 offen lds
    buffer_load_dwordx4 v241, s[8:11], s36 offen offset:1024 lds
    v_permlane32_swap_b32 v201, v203
    v_add_f32 v203, v201, v203
    v_cvt_pk_bf16_f32 v198, v198, v199
    v_cvt_pk_bf16_f32 v202, v202, v203
    ds_write2st64_b32 v253, v198, v202 offset0:0 offset1:1
    v_mfma_f32_32x32x16_bf16 v[32:47], v[64:67], v[180:183], 0
    v_mul_f32 v196, v0, v144
    v_fmac_f32 v196, v1, v145
    v_fmac_f32 v196, v2, v146
    v_fmac_f32 v196, v3, v147
    v_mfma_f32_32x32x16_bf16 v[48:63], v[68:71], v[180:183], 0
    v_fmac_f32 v196, v4, v148
    v_fmac_f32 v196, v5, v149
    v_fmac_f32 v196, v6, v150
    v_fmac_f32 v196, v7, v151
    v_mfma_f32_32x32x16_bf16 v[32:47], v[72:75], v[184:187], v[32:47]
    v_mul_f32 v198, v8, v112
    v_fmac_f32 v198, v9, v113
    v_fmac_f32 v198, v10, v114
    v_fmac_f32 v198, v11, v115
    v_mfma_f32_32x32x16_bf16 v[48:63], v[76:79], v[184:187], v[48:63]
    v_fmac_f32 v198, v12, v116
    v_fmac_f32 v198, v13, v117
    v_fmac_f32 v198, v14, v118
    v_fmac_f32 v198, v15, v119
    v_mfma_f32_32x32x16_bf16 v[32:47], v[80:83], v[188:191], v[32:47]
    v_mul_f32_e64 v200, v16, -v160
    v_fma_f32 v200, v17, -v161, v200
    v_fma_f32 v200, v18, -v162, v200
    v_fma_f32 v200, v19, -v163, v200
    v_mfma_f32_32x32x16_bf16 v[48:63], v[84:87], v[188:191], v[48:63]
    s_waitcnt vmcnt(6)
    ds_read_b64_tr_b16 v[176:177], v244 offset:0
    ds_read_b64_tr_b16 v[178:179], v244 offset:1024
    ds_read_b64_tr_b16 v[180:181], v245 offset:0
    ds_read_b64_tr_b16 v[182:183], v245 offset:1024
    v_fma_f32 v200, v20, -v164, v200
    v_fma_f32 v200, v21, -v165, v200
    v_fma_f32 v200, v22, -v166, v200
    v_fma_f32 v200, v23, -v167, v200
    v_mfma_f32_32x32x16_bf16 v[32:47], v[88:91], v[192:195], v[32:47]
    v_mul_f32_e64 v202, v24, -v160
    v_fma_f32 v202, v25, -v161, v202
    v_fma_f32 v202, v26, -v162, v202
    v_fma_f32 v202, v27, -v163, v202
    v_mfma_f32_32x32x16_bf16 v[48:63], v[92:95], v[192:195], v[48:63]
    v_fma_f32 v202, v28, -v164, v202
    v_fma_f32 v202, v29, -v165, v202
    v_fma_f32 v202, v30, -v166, v202
    v_fma_f32 v202, v31, -v167, v202
    s_waitcnt vmcnt(4) lgkmcnt(0)
    v_mfma_f32_32x32x16_bf16 v[0:15], v[64:67], v[176:179], 0
    s_nop 0
    v_mul_f32 v197, v32, v152
    v_fmac_f32 v197, v33, v153
    v_fmac_f32 v197, v34, v154
    v_fmac_f32 v197, v35, v155
    s_add_u32 m0, s21, 0
    v_mfma_f32_32x32x16_bf16 v[16:31], v[68:71], v[176:179], 0
    buffer_load_dwordx4 v234, s[4:7], s37 offen lds
    buffer_load_dwordx4 v235, s[8:11], s37 offen offset:1024 lds
    ds_read_b64_tr_b16 v[176:177], v244 offset:2048
    ds_read_b64_tr_b16 v[178:179], v244 offset:3072
    ds_read_b64_tr_b16 v[184:185], v245 offset:2048
    ds_read_b64_tr_b16 v[186:187], v245 offset:3072
    v_add_u32 v252, s42, v247
    ds_read_u16 v234, v252
    ds_read_u16 v235, v252 offset:64
    v_fmac_f32 v197, v36, v156
    v_fmac_f32 v197, v37, v157
    v_fmac_f32 v197, v38, v158
    v_fmac_f32 v197, v39, v159
    s_waitcnt vmcnt(4) lgkmcnt(2)
    v_mfma_f32_32x32x16_bf16 v[0:15], v[72:75], v[176:179], v[0:15]
    v_mul_f32 v199, v40, v120
    v_fmac_f32 v199, v41, v121
    v_fmac_f32 v199, v42, v122
    v_fmac_f32 v199, v43, v123
    s_add_u32 m0, s21, 2048
    v_mfma_f32_32x32x16_bf16 v[16:31], v[76:79], v[176:179], v[16:31]
    buffer_load_dwordx4 v236, s[4:7], s37 offen lds
    buffer_load_dwordx4 v237, s[8:11], s37 offen offset:1024 lds
    ds_read_b64_tr_b16 v[176:177], v244 offset:4096
    ds_read_b64_tr_b16 v[178:179], v244 offset:5120
    ds_read_b64_tr_b16 v[188:189], v245 offset:4096
    ds_read_b64_tr_b16 v[190:191], v245 offset:5120
    v_add_u32 v252, s43, v247
    ds_read_u16 v236, v252
    ds_read_u16 v237, v252 offset:64
    v_fmac_f32 v199, v44, v124
    v_fmac_f32 v199, v45, v125
    v_fmac_f32 v199, v46, v126
    v_fmac_f32 v199, v47, v127
    s_waitcnt vmcnt(4) lgkmcnt(2)
    v_mfma_f32_32x32x16_bf16 v[0:15], v[80:83], v[176:179], v[0:15]
    v_mul_f32_e64 v201, v48, -v168
    v_fma_f32 v201, v49, -v169, v201
    v_fma_f32 v201, v50, -v170, v201
    v_fma_f32 v201, v51, -v171, v201
    s_add_u32 m0, s21, 4096
    v_mfma_f32_32x32x16_bf16 v[16:31], v[84:87], v[176:179], v[16:31]
    buffer_load_dwordx4 v238, s[4:7], s37 offen lds
    buffer_load_dwordx4 v239, s[8:11], s37 offen offset:1024 lds
    ds_read_b64_tr_b16 v[176:177], v244 offset:6144
    ds_read_b64_tr_b16 v[178:179], v244 offset:7168
    ds_read_b64_tr_b16 v[192:193], v245 offset:6144
    ds_read_b64_tr_b16 v[194:195], v245 offset:7168
    v_add_u32 v252, s44, v247
    ds_read_u16 v238, v252
    ds_read_u16 v239, v252 offset:64
    v_fma_f32 v201, v52, -v172, v201
    v_fma_f32 v201, v53, -v173, v201
    v_fma_f32 v201, v54, -v174, v201
    v_fma_f32 v201, v55, -v175, v201
    s_waitcnt lgkmcnt(2)
    v_mfma_f32_32x32x16_bf16 v[0:15], v[88:91], v[176:179], v[0:15]
    v_mul_f32_e64 v203, v56, -v168
    v_fma_f32 v203, v57, -v169, v203
    v_fma_f32 v203, v58, -v170, v203
    v_fma_f32 v203, v59, -v171, v203
    s_add_u32 m0, s21, 6144
    v_mfma_f32_32x32x16_bf16 v[16:31], v[92:95], v[176:179], v[16:31]
    buffer_load_dwordx4 v240, s[4:7], s37 offen lds
    buffer_load_dwordx4 v241, s[8:11], s37 offen offset:1024 lds
    v_add_u32 v252, s45, v247
    ds_read_u16 v240, v252
    ds_read_u16 v241, v252 offset:64
    v_fma_f32 v203, v60, -v172, v203
    v_fma_f32 v203, v61, -v173, v203
    v_fma_f32 v203, v62, -v174, v203
    v_fma_f32 v203, v63, -v175, v203
    v_mfma_f32_32x32x16_bf16 v[32:47], v[64:67], v[180:183], 0
    v_mul_f32 v254, v0, v144
    v_fmac_f32 v254, v1, v145
    v_fmac_f32 v254, v2, v146
    v_mfma_f32_32x32x16_bf16 v[48:63], v[68:71], v[180:183], 0
    ds_swizzle_b32 v68, v68 offset:0x401F
    ds_swizzle_b32 v69, v69 offset:0x401F
    ds_swizzle_b32 v70, v70 offset:0x401F
    ds_swizzle_b32 v71, v71 offset:0x401F
    v_fmac_f32 v254, v3, v147
    v_fmac_f32 v254, v4, v148
    v_mfma_f32_32x32x16_bf16 v[32:47], v[72:75], v[184:187], v[32:47]
    v_fmac_f32 v254, v5, v149
    v_fmac_f32 v254, v6, v150
    v_mfma_f32_32x32x16_bf16 v[48:63], v[76:79], v[184:187], v[48:63]
    ds_swizzle_b32 v76, v76 offset:0x401F
    ds_swizzle_b32 v77, v77 offset:0x401F
    ds_swizzle_b32 v78, v78 offset:0x401F
    ds_swizzle_b32 v79, v79 offset:0x401F
    v_fmac_f32 v254, v7, v151
    v_fmac_f32 v200, v8, v160
    v_mfma_f32_32x32x16_bf16 v[32:47], v[80:83], v[188:191], v[32:47]
    v_fmac_f32 v200, v9, v161
    v_permlane32_swap_b32 v196, v254
    v_fmac_f32 v200, v10, v162
    v_mfma_f32_32x32x16_bf16 v[48:63], v[84:87], v[188:191], v[48:63]
    ds_swizzle_b32 v84, v84 offset:0x401F
    ds_swizzle_b32 v85, v85 offset:0x401F
    ds_swizzle_b32 v86, v86 offset:0x401F
    ds_swizzle_b32 v87, v87 offset:0x401F
    s_waitcnt vmcnt(6)
    ds_read_b64_tr_b16 v[176:177], v244 offset:0
    ds_read_b64_tr_b16 v[178:179], v244 offset:1024
    ds_read_b64_tr_b16 v[180:181], v245 offset:0
    ds_read_b64_tr_b16 v[182:183], v245 offset:1024
    v_fmac_f32 v200, v11, v163
    v_fmac_f32 v200, v12, v164
    v_mfma_f32_32x32x16_bf16 v[32:47], v[88:91], v[192:195], v[32:47]
    v_fmac_f32 v200, v13, v165
    v_fmac_f32 v200, v14, v166
    v_mfma_f32_32x32x16_bf16 v[48:63], v[92:95], v[192:195], v[48:63]
    ds_swizzle_b32 v92, v92 offset:0x401F
    ds_swizzle_b32 v93, v93 offset:0x401F
    ds_swizzle_b32 v94, v94 offset:0x401F
    ds_swizzle_b32 v95, v95 offset:0x401F
    v_fmac_f32 v200, v15, v167
    v_add_f32 v254, v196, v254
    s_waitcnt lgkmcnt(8)
    s_mov_b64 exec, s[56:57]
    v_xor_b32 v68, 0x80008000, v68
    v_xor_b32 v69, 0x80008000, v69
    v_xor_b32 v70, 0x80008000, v70
    v_xor_b32 v71, 0x80008000, v71
    v_xor_b32 v76, 0x80008000, v76
    v_xor_b32 v77, 0x80008000, v77
    v_xor_b32 v78, 0x80008000, v78
    v_xor_b32 v79, 0x80008000, v79
    v_xor_b32 v84, 0x80008000, v84
    v_xor_b32 v85, 0x80008000, v85
    v_xor_b32 v86, 0x80008000, v86
    v_xor_b32 v87, 0x80008000, v87
    s_mov_b64 exec, -1
    s_waitcnt vmcnt(4) lgkmcnt(4)
    v_mfma_f32_32x32x16_bf16 v[0:15], v[64:67], v[176:179], 0
    v_mul_f32 v255, v32, v152
    v_fmac_f32 v255, v33, v153
    v_fmac_f32 v255, v34, v154
    s_add_u32 m0, s21, 0
    v_mfma_f32_32x32x16_bf16 v[16:31], v[68:71], v[176:179], v[16:31]
    v_lshl_add_u32 v234, v234, 10, v246
    v_lshl_add_u32 v235, v235, 10, v246
    buffer_load_dwordx4 v234, s[4:7], s38 offen lds
    buffer_load_dwordx4 v235, s[8:11], s38 offen offset:1024 lds
    ds_read_b64_tr_b16 v[176:177], v244 offset:2048
    ds_read_b64_tr_b16 v[178:179], v244 offset:3072
    ds_read_b64_tr_b16 v[184:185], v245 offset:2048
    ds_read_b64_tr_b16 v[186:187], v245 offset:3072
    v_fmac_f32 v255, v35, v155
    v_fmac_f32 v255, v36, v156
    s_waitcnt vmcnt(4) lgkmcnt(0)
    v_mfma_f32_32x32x16_bf16 v[0:15], v[72:75], v[176:179], v[0:15]
    v_fmac_f32 v255, v37, v157
    v_fmac_f32 v255, v38, v158
    v_fmac_f32 v255, v39, v159
    s_add_u32 m0, s21, 2048
    v_mfma_f32_32x32x16_bf16 v[16:31], v[76:79], v[176:179], v[16:31]
    v_lshl_add_u32 v236, v236, 10, v246
    v_lshl_add_u32 v237, v237, 10, v246
    buffer_load_dwordx4 v236, s[4:7], s39 offen lds
    buffer_load_dwordx4 v237, s[8:11], s39 offen offset:1024 lds
    ds_read_b64_tr_b16 v[176:177], v244 offset:4096
    ds_read_b64_tr_b16 v[178:179], v244 offset:5120
    ds_read_b64_tr_b16 v[188:189], v245 offset:4096
    ds_read_b64_tr_b16 v[190:191], v245 offset:5120
    v_fmac_f32 v201, v40, v168
    v_fmac_f32 v201, v41, v169
    s_waitcnt vmcnt(4) lgkmcnt(0)
    v_mfma_f32_32x32x16_bf16 v[0:15], v[80:83], v[176:179], v[0:15]
    v_permlane32_swap_b32 v197, v255
    v_fmac_f32 v201, v42, v170
    v_fmac_f32 v201, v43, v171
    s_add_u32 m0, s21, 4096
    v_mfma_f32_32x32x16_bf16 v[16:31], v[84:87], v[176:179], v[16:31]
    v_lshl_add_u32 v238, v238, 10, v246
    v_lshl_add_u32 v239, v239, 10, v246
    buffer_load_dwordx4 v238, s[4:7], s40 offen lds
    buffer_load_dwordx4 v239, s[8:11], s40 offen offset:1024 lds
    ds_read_b64_tr_b16 v[176:177], v244 offset:6144
    ds_read_b64_tr_b16 v[178:179], v244 offset:7168
    ds_read_b64_tr_b16 v[192:193], v245 offset:6144
    ds_read_b64_tr_b16 v[194:195], v245 offset:7168
    v_fmac_f32 v201, v44, v172
    v_fmac_f32 v201, v45, v173
    s_waitcnt lgkmcnt(0)
    s_mov_b64 exec, s[56:57]
    v_xor_b32 v92, 0x80008000, v92
    v_xor_b32 v93, 0x80008000, v93
    v_xor_b32 v94, 0x80008000, v94
    v_xor_b32 v95, 0x80008000, v95
    s_mov_b64 exec, -1
    v_mfma_f32_32x32x16_bf16 v[0:15], v[88:91], v[176:179], v[0:15]
    v_fmac_f32 v201, v46, v174
    v_fmac_f32 v201, v47, v175
    v_add_f32 v255, v197, v255
    s_add_u32 m0, s21, 6144
    v_mfma_f32_32x32x16_bf16 v[16:31], v[92:95], v[176:179], v[16:31]
    v_lshl_add_u32 v240, v240, 10, v246
    v_lshl_add_u32 v241, v241, 10, v246
    buffer_load_dwordx4 v240, s[4:7], s41 offen lds
    buffer_load_dwordx4 v241, s[8:11], s41 offen offset:1024 lds
    v_cvt_pk_bf16_f32 v254, v254, v255
    ds_write_b32 v253, v254 offset:512
    v_mfma_f32_32x32x16_bf16 v[32:47], v[64:67], v[180:183], 0
    v_mul_f32 v254, v0, v144
    v_fmac_f32 v254, v1, v145
    v_fmac_f32 v254, v2, v146
    v_fmac_f32 v254, v3, v147
    v_fmac_f32 v254, v4, v148
    v_mfma_f32_32x32x16_bf16 v[48:63], v[68:71], v[180:183], v[48:63]
    v_fmac_f32 v254, v5, v149
    v_fmac_f32 v254, v6, v150
    v_fmac_f32 v254, v7, v151
    v_fma_f32 v202, v8, -v160, v202
    v_fma_f32 v202, v9, -v161, v202
    v_mfma_f32_32x32x16_bf16 v[32:47], v[72:75], v[184:187], v[32:47]
    v_permlane32_swap_b32 v254, v200
    v_fma_f32 v202, v10, -v162, v202
    v_fma_f32 v202, v11, -v163, v202
    v_fma_f32 v202, v12, -v164, v202
    v_fma_f32 v202, v13, -v165, v202
    v_mfma_f32_32x32x16_bf16 v[48:63], v[76:79], v[184:187], v[48:63]
    v_fma_f32 v202, v14, -v166, v202
    v_fma_f32 v202, v15, -v167, v202
    v_add_f32 v200, v254, v200
    v_fmac_f32 v198, v16, v112
    v_permlane32_swap_b32 v202, v254
    v_mfma_f32_32x32x16_bf16 v[32:47], v[80:83], v[188:191], v[32:47]
    v_fmac_f32 v198, v17, v113
    v_fmac_f32 v198, v18, v114
    v_fmac_f32 v198, v19, v115
    v_fmac_f32 v198, v20, v116
    v_fmac_f32 v198, v21, v117
    v_mfma_f32_32x32x16_bf16 v[48:63], v[84:87], v[188:191], v[48:63]
    s_waitcnt vmcnt(6)
    ds_read_b64_tr_b16 v[176:177], v244 offset:0
    ds_read_b64_tr_b16 v[178:179], v244 offset:1024
    ds_read_b64_tr_b16 v[180:181], v245 offset:0
    ds_read_b64_tr_b16 v[182:183], v245 offset:1024
    v_fmac_f32 v198, v22, v118
    v_fmac_f32 v198, v23, v119
    v_add_f32 v254, v202, v254
    v_mul_f32 v196, v24, v160
    v_fmac_f32 v196, v25, v161
    v_mfma_f32_32x32x16_bf16 v[32:47], v[88:91], v[192:195], v[32:47]
    v_fmac_f32 v196, v26, v162
    v_fmac_f32 v196, v27, v163
    v_fmac_f32 v196, v28, v164
    v_fmac_f32 v196, v29, v165
    v_fmac_f32 v196, v30, v166
    v_mfma_f32_32x32x16_bf16 v[48:63], v[92:95], v[192:195], v[48:63]
    v_add_u32 v249, s48, v249
    v_add_u32 v250, s49, v250
    ds_read_b32 v252, v251 offset:16
    ds_read_b64_tr_b16 v[64:65], v249 offset:0
    ds_read_b64_tr_b16 v[68:69], v249 offset:64
    ds_read_b64_tr_b16 v[66:67], v249 offset:256
    ds_read_b64_tr_b16 v[70:71], v249 offset:320
    s_mov_b64 exec, s[54:55]
    ds_read_u16_d16_hi v242, v250 offset:0
    s_mov_b64 exec, -1
    v_fmac_f32 v196, v31, v167
    s_nop 1
    v_permlane32_swap_b32 v198, v196
    v_add_f32 v196, v198, v196
    v_mul_f32 v255, v32, v152
    v_fmac_f32 v255, v33, v153
    v_fmac_f32 v255, v34, v154
    v_fmac_f32 v255, v35, v155
    v_fmac_f32 v255, v36, v156
    v_fmac_f32 v255, v37, v157
    v_fmac_f32 v255, v38, v158
    v_fmac_f32 v255, v39, v159
    v_fma_f32 v203, v40, -v168, v203
    v_fma_f32 v203, v41, -v169, v203
    v_permlane32_swap_b32 v255, v201
    v_fma_f32 v203, v42, -v170, v203
    v_fma_f32 v203, v43, -v171, v203
    v_fma_f32 v203, v44, -v172, v203
    v_fma_f32 v203, v45, -v173, v203
    v_fma_f32 v203, v46, -v174, v203
    v_fma_f32 v203, v47, -v175, v203
    v_add_f32 v201, v255, v201
    v_fmac_f32 v199, v48, v120
    v_permlane32_swap_b32 v203, v255
    v_fmac_f32 v199, v49, v121
    v_fmac_f32 v199, v50, v122
    v_fmac_f32 v199, v51, v123
    v_fmac_f32 v199, v52, v124
    v_fmac_f32 v199, v53, v125
    v_fmac_f32 v199, v54, v126
    v_fmac_f32 v199, v55, v127
    v_add_f32 v255, v203, v255
    v_mul_f32 v197, v56, v168
    v_fmac_f32 v197, v57, v169
    v_fmac_f32 v197, v58, v170
    v_fmac_f32 v197, v59, v171
    v_fmac_f32 v197, v60, v172
    v_fmac_f32 v197, v61, v173
    v_fmac_f32 v197, v62, v174
    v_fmac_f32 v197, v63, v175
    s_nop 1
    v_permlane32_swap_b32 v199, v197
    v_add_f32 v197, v199, v197
    v_cvt_pk_bf16_f32 v200, v200, v201
    v_cvt_pk_bf16_f32 v254, v254, v255
    v_cvt_pk_bf16_f32 v196, v196, v197
    ds_write2st64_b32 v253, v200, v196 offset0:3 offset1:4
    s_mov_b64 exec, 0xffffffff
    ds_write_b32 v253, v254 offset:1280
    s_mov_b64 exec, -1
    s_add_u32 s50, s50, 1
    s_cmp_ge_u32 s50, 4
    s_cbranch_scc1 LAST1
    s_waitcnt lgkmcnt(7)
    v_readfirstlane_b32 s66, v252
    s_add_u32 s53, s53, 1
    v_mov_b32 v252, s53
    s_cmp_le_u32 s53, s66
    ds_write2_b32 v251, v252, v252 offset0:0 offset1:8
    s_setprio 1
    s_cbranch_scc1 PRIO_15
    s_setprio 0
PRIO_15:
    s_cmp_eq_u32 s52, 4
    s_cbranch_scc1 ITEM_1_4
    s_cmp_eq_u32 s52, 5
    s_cbranch_scc1 ITEM_1_5
    s_cmp_eq_u32 s52, 3
    s_cbranch_scc1 ITEM_1_3
    s_cmp_eq_u32 s52, 6
    s_cbranch_scc1 ITEM_1_6
    s_cmp_eq_u32 s52, 8
    s_cbranch_scc1 ITEM_1_8
    s_branch ITEM_1_2
.p2align 6
ITEM_1_2:
    s_mov_b32 m0, s50
    s_nop 0
    s_movrels_b32 s71, s23
    s_movrels_b32 s33, s28
    s_and_b32 s70, s33, 0x70
    s_andn2_b32 s33, s33, 0x70
    v_xor_b32 v253, s70, v248
    v_add_u32 v253, s33, v253
    s_bfe_u32 s46, s71, 0x30012
    s_mov_b32 m0, s46
    s_and_b32 s66, s71, 0x3ffff
    s_movrels_b32 s68, s57
    s_movrels_b32 s69, s61
    s_sub_u32 s48, s66, s47
    s_mov_b32 s47, s66
    s_lshr_b32 s52, s71, 28
    s_lshl_b32 s67, s46, 9
    s_add_u32 s66, s66, s67
    s_sub_u32 s49, s66, s42
    s_mov_b32 s42, s66
    s_bfe_u32 s66, s68, 655360
    s_add_u32 s43, s42, s66
    s_bfe_u32 s39, s69, 655360
    s_bfe_u32 s66, s68, 655370
    s_add_u32 s44, s42, s66
    s_bfe_u32 s40, s69, 655370
    s_bfe_u32 s66, s68, 655380
    s_add_u32 s45, s42, s66
    s_bfe_u32 s41, s69, 655380
    v_add_u32 v252, s42, v247
    ds_read_u16 v234, v252
    ds_read_u16 v235, v252 offset:64
    v_add_u32 v252, s43, v247
    ds_read_u16 v236, v252
    ds_read_u16 v237, v252 offset:64
    v_add_u32 v252, s44, v247
    ds_read_u16 v238, v252
    ds_read_u16 v239, v252 offset:64
    v_add_u32 v252, s45, v247
    ds_read_u16 v240, v252
    ds_read_u16 v241, v252 offset:64
    s_waitcnt lgkmcnt(8)
    v_mul_f32_dpp v196, v242, v64 row_newbcast:0 row_mask:0xf bank_mask:0xf
    v_mul_f32_dpp v197, v242, v65 row_newbcast:1 row_mask:0xf bank_mask:0xf
    v_mul_f32_dpp v198, v242, v64 row_newbcast:8 row_mask:0xf bank_mask:0xf
    v_mul_f32_dpp v199, v242, v65 row_newbcast:9 row_mask:0xf bank_mask:0xf
    v_mul_f32_dpp v200, v242, v68 row_newbcast:2 row_mask:0xf bank_mask:0xf
    v_mul_f32_dpp v201, v242, v69 row_newbcast:3 row_mask:0xf bank_mask:0xf
    v_mul_f32_dpp v202, v242, v68 row_newbcast:10 row_mask:0xf bank_mask:0xf
    v_mul_f32_dpp v203, v242, v69 row_newbcast:11 row_mask:0xf bank_mask:0xf
    v_cvt_pk_bf16_f32 v64, v196, v197
    v_cvt_pk_bf16_f32 v68, v198, v199
    v_cvt_pk_bf16_f32 v65, v200, v201
    v_cvt_pk_bf16_f32 v69, v202, v203
    v_mul_f32_dpp v196, v242, v66 row_newbcast:4 row_mask:0xf bank_mask:0xf
    v_mul_f32_dpp v197, v242, v67 row_newbcast:5 row_mask:0xf bank_mask:0xf
    v_mul_f32_dpp v198, v242, v66 row_newbcast:12 row_mask:0xf bank_mask:0xf
    v_mul_f32_dpp v199, v242, v67 row_newbcast:13 row_mask:0xf bank_mask:0xf
    v_mul_f32_dpp v200, v242, v70 row_newbcast:6 row_mask:0xf bank_mask:0xf
    v_mul_f32_dpp v201, v242, v71 row_newbcast:7 row_mask:0xf bank_mask:0xf
    v_mul_f32_dpp v202, v242, v70 row_newbcast:14 row_mask:0xf bank_mask:0xf
    v_mul_f32_dpp v203, v242, v71 row_newbcast:15 row_mask:0xf bank_mask:0xf
    v_cvt_pk_bf16_f32 v66, v196, v197
    v_cvt_pk_bf16_f32 v70, v198, v199
    v_cvt_pk_bf16_f32 v67, v200, v201
    v_cvt_pk_bf16_f32 v71, v202, v203
    s_nop 0
    s_waitcnt lgkmcnt(6)
    v_mfma_f32_32x32x16_bf16 v[0:15], v[64:67], v[176:179], 0
    s_add_u32 m0, s21, 0
    v_mfma_f32_32x32x16_bf16 v[16:31], v[68:71], v[176:179], 0
    v_lshl_add_u32 v234, v234, 10, v246
    v_lshl_add_u32 v235, v235, 10, v246
    buffer_load_dwordx4 v234, s[4:7], s38 offen lds
    buffer_load_dwordx4 v235, s[8:11], s38 offen offset:1024 lds
    v_mfma_f32_32x32x16_bf16 v[32:47], v[64:67], v[180:183], 0
    s_nop 4
    v_mul_f32 v196, v0, v96
    v_fmac_f32 v196, v1, v97
    v_fmac_f32 v196, v2, v98
    v_fmac_f32 v196, v3, v99
    v_fmac_f32 v196, v4, v100
    v_fmac_f32 v196, v5, v101
    v_fmac_f32 v196, v6, v102
    v_fmac_f32 v196, v7, v103
    v_mul_f32 v198, v8, v128
    v_fmac_f32 v198, v9, v129
    v_fmac_f32 v198, v10, v130
    v_fmac_f32 v198, v11, v131
    v_fmac_f32 v198, v12, v132
    v_fmac_f32 v198, v13, v133
    v_fmac_f32 v198, v14, v134
    v_fmac_f32 v198, v15, v135
    v_mul_f32 v200, v16, v128
    v_fmac_f32 v200, v17, v129
    v_permlane32_swap_b32 v196, v198
    v_mfma_f32_32x32x16_bf16 v[48:63], v[68:71], v[180:183], 0
    s_waitcnt vmcnt(6)
    ds_read_b64_tr_b16 v[176:177], v244 offset:2048
    ds_read_b64_tr_b16 v[178:179], v244 offset:3072
    ds_read_b64_tr_b16 v[180:181], v245 offset:2048
    ds_read_b64_tr_b16 v[182:183], v245 offset:3072
    v_fmac_f32 v200, v18, v130
    v_fmac_f32 v200, v19, v131
    v_fmac_f32 v200, v20, v132
    v_fmac_f32 v200, v21, v133
    v_fmac_f32 v200, v22, v134
    v_fmac_f32 v200, v23, v135
    v_add_f32 v198, v196, v198
    v_mul_f32_e64 v202, v24, -v128
    v_fma_f32 v202, v25, -v129, v202
    v_fma_f32 v202, v26, -v130, v202
    v_fma_f32 v202, v27, -v131, v202
    v_fma_f32 v202, v28, -v132, v202
    v_fma_f32 v202, v29, -v133, v202
    v_fma_f32 v202, v30, -v134, v202
    v_fma_f32 v202, v31, -v135, v202
    s_nop 1
    v_permlane32_swap_b32 v200, v202
    v_add_f32 v202, v200, v202
    s_waitcnt lgkmcnt(0)
    v_mfma_f32_32x32x16_bf16 v[0:15], v[64:67], v[176:179], 0
    v_mul_f32 v197, v32, v104
    v_fmac_f32 v197, v33, v105
    v_fmac_f32 v197, v34, v106
    v_fmac_f32 v197, v35, v107
    v_fmac_f32 v197, v36, v108
    v_fmac_f32 v197, v37, v109
    v_fmac_f32 v197, v38, v110
    v_fmac_f32 v197, v39, v111
    v_mul_f32 v199, v40, v136
    v_fmac_f32 v199, v41, v137
    v_fmac_f32 v199, v42, v138
    v_fmac_f32 v199, v43, v139
    v_fmac_f32 v199, v44, v140
    v_fmac_f32 v199, v45, v141
    v_fmac_f32 v199, v46, v142
    v_fmac_f32 v199, v47, v143
    v_mul_f32 v201, v48, v136
    v_fmac_f32 v201, v49, v137
    v_permlane32_swap_b32 v197, v199
    v_fmac_f32 v201, v50, v138
    s_add_u32 m0, s21, 2048
    v_mfma_f32_32x32x16_bf16 v[16:31], v[68:71], v[176:179], 0
    v_lshl_add_u32 v236, v236, 10, v246
    v_lshl_add_u32 v237, v237, 10, v246
    buffer_load_dwordx4 v236, s[4:7], s39 offen lds
    buffer_load_dwordx4 v237, s[8:11], s39 offen offset:1024 lds
    v_fmac_f32 v201, v51, v139
    v_fmac_f32 v201, v52, v140
    v_fmac_f32 v201, v53, v141
    v_fmac_f32 v201, v54, v142
    v_fmac_f32 v201, v55, v143
    v_add_f32 v199, v197, v199
    v_mul_f32_e64 v203, v56, -v136
    v_fma_f32 v203, v57, -v137, v203
    v_fma_f32 v203, v58, -v138, v203
    v_fma_f32 v203, v59, -v139, v203
    v_fma_f32 v203, v60, -v140, v203
    v_fma_f32 v203, v61, -v141, v203
    v_fma_f32 v203, v62, -v142, v203
    v_fma_f32 v203, v63, -v143, v203
    s_nop 1
    v_permlane32_swap_b32 v201, v203
    v_add_f32 v203, v201, v203
    v_cvt_pk_bf16_f32 v198, v198, v199
    v_cvt_pk_bf16_f32 v202, v202, v203
    ds_write2st64_b32 v253, v198, v202 offset0:0 offset1:1
    v_mfma_f32_32x32x16_bf16 v[32:47], v[64:67], v[180:183], 0
    v_mul_f32 v196, v0, v144
    v_fmac_f32 v196, v1, v145
    v_fmac_f32 v196, v2, v146
    v_fmac_f32 v196, v3, v147
    v_fmac_f32 v196, v4, v148
    v_fmac_f32 v196, v5, v149
    v_fmac_f32 v196, v6, v150
    v_fmac_f32 v196, v7, v151
    v_mul_f32 v198, v8, v112
    v_fmac_f32 v198, v9, v113
    v_fmac_f32 v198, v10, v114
    v_fmac_f32 v198, v11, v115
    v_fmac_f32 v198, v12, v116
    v_fmac_f32 v198, v13, v117
    v_fmac_f32 v198, v14, v118
    v_fmac_f32 v198, v15, v119
    v_mfma_f32_32x32x16_bf16 v[48:63], v[68:71], v[180:183], 0
    s_waitcnt vmcnt(6)
    ds_read_b64_tr_b16 v[176:177], v244 offset:4096
    ds_read_b64_tr_b16 v[178:179], v244 offset:5120
    ds_read_b64_tr_b16 v[180:181], v245 offset:4096
    ds_read_b64_tr_b16 v[182:183], v245 offset:5120
    v_mul_f32_e64 v200, v16, -v160
    v_fma_f32 v200, v17, -v161, v200
    v_fma_f32 v200, v18, -v162, v200
    v_fma_f32 v200, v19, -v163, v200
    v_fma_f32 v200, v20, -v164, v200
    v_fma_f32 v200, v21, -v165, v200
    v_fma_f32 v200, v22, -v166, v200
    v_fma_f32 v200, v23, -v167, v200
    v_mul_f32_e64 v202, v24, -v160
    v_fma_f32 v202, v25, -v161, v202
    v_fma_f32 v202, v26, -v162, v202
    v_fma_f32 v202, v27, -v163, v202
    v_fma_f32 v202, v28, -v164, v202
    v_fma_f32 v202, v29, -v165, v202
    v_fma_f32 v202, v30, -v166, v202
    v_fma_f32 v202, v31, -v167, v202
    s_waitcnt lgkmcnt(0)
    v_mfma_f32_32x32x16_bf16 v[0:15], v[64:67], v[176:179], 0
    v_mul_f32 v197, v32, v152
    v_fmac_f32 v197, v33, v153
    v_fmac_f32 v197, v34, v154
    v_fmac_f32 v197, v35, v155
    v_fmac_f32 v197, v36, v156
    v_fmac_f32 v197, v37, v157
    v_fmac_f32 v197, v38, v158
    v_fmac_f32 v197, v39, v159
    v_mul_f32 v199, v40, v120
    v_fmac_f32 v199, v41, v121
    v_fmac_f32 v199, v42, v122
    v_fmac_f32 v199, v43, v123
    v_fmac_f32 v199, v44, v124
    v_fmac_f32 v199, v45, v125
    v_fmac_f32 v199, v46, v126
    v_fmac_f32 v199, v47, v127
    s_add_u32 m0, s21, 4096
    v_mfma_f32_32x32x16_bf16 v[16:31], v[68:71], v[176:179], 0
    v_lshl_add_u32 v238, v238, 10, v246
    v_lshl_add_u32 v239, v239, 10, v246
    buffer_load_dwordx4 v238, s[4:7], s40 offen lds
    buffer_load_dwordx4 v239, s[8:11], s40 offen offset:1024 lds
    v_mul_f32_e64 v201, v48, -v168
    v_fma_f32 v201, v49, -v169, v201
    v_fma_f32 v201, v50, -v170, v201
    v_fma_f32 v201, v51, -v171, v201
    v_fma_f32 v201, v52, -v172, v201
    v_fma_f32 v201, v53, -v173, v201
    v_fma_f32 v201, v54, -v174, v201
    v_fma_f32 v201, v55, -v175, v201
    v_mul_f32_e64 v203, v56, -v168
    v_fma_f32 v203, v57, -v169, v203
    v_fma_f32 v203, v58, -v170, v203
    v_fma_f32 v203, v59, -v171, v203
    v_fma_f32 v203, v60, -v172, v203
    v_fma_f32 v203, v61, -v173, v203
    v_fma_f32 v203, v62, -v174, v203
    v_fma_f32 v203, v63, -v175, v203
    v_mfma_f32_32x32x16_bf16 v[32:47], v[64:67], v[180:183], 0
    v_mul_f32 v254, v0, v144
    v_fmac_f32 v254, v1, v145
    v_fmac_f32 v254, v2, v146
    v_fmac_f32 v254, v3, v147
    v_fmac_f32 v254, v4, v148
    v_fmac_f32 v254, v5, v149
    v_fmac_f32 v254, v6, v150
    v_fmac_f32 v254, v7, v151
    v_fmac_f32 v200, v8, v160
    v_mfma_f32_32x32x16_bf16 v[48:63], v[68:71], v[180:183], 0
    ds_swizzle_b32 v68, v68 offset:0x401F
    ds_swizzle_b32 v69, v69 offset:0x401F
    ds_swizzle_b32 v70, v70 offset:0x401F
    ds_swizzle_b32 v71, v71 offset:0x401F
    s_waitcnt vmcnt(6)
    ds_read_b64_tr_b16 v[176:177], v244 offset:6144
    ds_read_b64_tr_b16 v[178:179], v244 offset:7168
    ds_read_b64_tr_b16 v[180:181], v245 offset:6144
    ds_read_b64_tr_b16 v[182:183], v245 offset:7168
    v_fmac_f32 v200, v9, v161
    v_permlane32_swap_b32 v196, v254
    v_fmac_f32 v200, v10, v162
    v_fmac_f32 v200, v11, v163
    v_fmac_f32 v200, v12, v164
    v_fmac_f32 v200, v13, v165
    v_fmac_f32 v200, v14, v166
    v_fmac_f32 v200, v15, v167
    v_add_f32 v254, v196, v254
    s_waitcnt lgkmcnt(0)
    s_mov_b64 exec, s[56:57]
    v_xor_b32 v68, 0x80008000, v68
    v_xor_b32 v69, 0x80008000, v69
    v_xor_b32 v70, 0x80008000, v70
    v_xor_b32 v71, 0x80008000, v71
    s_mov_b64 exec, -1
    s_nop 0
    v_mfma_f32_32x32x16_bf16 v[0:15], v[64:67], v[176:179], 0
    v_mul_f32 v255, v32, v152
    v_fmac_f32 v255, v33, v153
    v_fmac_f32 v255, v34, v154
    v_fmac_f32 v255, v35, v155
    v_fmac_f32 v255, v36, v156
    v_fmac_f32 v255, v37, v157
    v_fmac_f32 v255, v38, v158
    v_fmac_f32 v255, v39, v159
    v_fmac_f32 v201, v40, v168
    v_fmac_f32 v201, v41, v169
    s_add_u32 m0, s21, 6144
    v_mfma_f32_32x32x16_bf16 v[16:31], v[68:71], v[176:179], v[16:31]
    v_lshl_add_u32 v240, v240, 10, v246
    v_lshl_add_u32 v241, v241, 10, v246
    buffer_load_dwordx4 v240, s[4:7], s41 offen lds
    buffer_load_dwordx4 v241, s[8:11], s41 offen offset:1024 lds
    v_permlane32_swap_b32 v197, v255
    v_fmac_f32 v201, v42, v170
    v_fmac_f32 v201, v43, v171
    v_fmac_f32 v201, v44, v172
    v_fmac_f32 v201, v45, v173
    v_fmac_f32 v201, v46, v174
    v_fmac_f32 v201, v47, v175
    v_add_f32 v255, v197, v255
    v_cvt_pk_bf16_f32 v254, v254, v255
    ds_write_b32 v253, v254 offset:512
    v_mfma_f32_32x32x16_bf16 v[32:47], v[64:67], v[180:183], 0
    v_mul_f32 v254, v0, v144
    v_fmac_f32 v254, v1, v145
    v_fmac_f32 v254, v2, v146
    v_fmac_f32 v254, v3, v147
    v_fmac_f32 v254, v4, v148
    v_fmac_f32 v254, v5, v149
    v_fmac_f32 v254, v6, v150
    v_fmac_f32 v254, v7, v151
    v_fma_f32 v202, v8, -v160, v202
    v_fma_f32 v202, v9, -v161, v202
    v_permlane32_swap_b32 v254, v200
    v_fma_f32 v202, v10, -v162, v202
    v_fma_f32 v202, v11, -v163, v202
    v_fma_f32 v202, v12, -v164, v202
    v_fma_f32 v202, v13, -v165, v202
    v_fma_f32 v202, v14, -v166, v202
    v_fma_f32 v202, v15, -v167, v202
    v_add_f32 v200, v254, v200
    v_fmac_f32 v198, v16, v112
    v_permlane32_swap_b32 v202, v254
    v_mfma_f32_32x32x16_bf16 v[48:63], v[68:71], v[180:183], v[48:63]
    s_waitcnt vmcnt(6)
    ds_read_b64_tr_b16 v[176:177], v244 offset:0
    ds_read_b64_tr_b16 v[178:179], v244 offset:1024
    ds_read_b64_tr_b16 v[180:181], v245 offset:0
    ds_read_b64_tr_b16 v[182:183], v245 offset:1024
    v_add_u32 v249, s48, v249
    v_add_u32 v250, s49, v250
    ds_read_b32 v252, v251 offset:16
    ds_read_b64_tr_b16 v[64:65], v249 offset:0
    ds_read_b64_tr_b16 v[68:69], v249 offset:64
    ds_read_b64_tr_b16 v[66:67], v249 offset:256
    ds_read_b64_tr_b16 v[70:71], v249 offset:320
    s_mov_b64 exec, s[54:55]
    ds_read_u16_d16_hi v242, v250 offset:0
    s_mov_b64 exec, -1
    v_fmac_f32 v198, v17, v113
    v_fmac_f32 v198, v18, v114
    v_fmac_f32 v198, v19, v115
    v_fmac_f32 v198, v20, v116
    v_fmac_f32 v198, v21, v117
    v_fmac_f32 v198, v22, v118
    v_fmac_f32 v198, v23, v119
    v_add_f32 v254, v202, v254
    v_mul_f32 v196, v24, v160
    v_fmac_f32 v196, v25, v161
    v_fmac_f32 v196, v26, v162
    v_fmac_f32 v196, v27, v163
    v_fmac_f32 v196, v28, v164
    v_fmac_f32 v196, v29, v165
    v_fmac_f32 v196, v30, v166
    v_fmac_f32 v196, v31, v167
    s_nop 1
    v_permlane32_swap_b32 v198, v196
    v_add_f32 v196, v198, v196
    v_mul_f32 v255, v32, v152
    v_fmac_f32 v255, v33, v153
    v_fmac_f32 v255, v34, v154
    v_fmac_f32 v255, v35, v155
    v_fmac_f32 v255, v36, v156
    v_fmac_f32 v255, v37, v157
    v_fmac_f32 v255, v38, v158
    v_fmac_f32 v255, v39, v159
    v_fma_f32 v203, v40, -v168, v203
    v_fma_f32 v203, v41, -v169, v203
    v_permlane32_swap_b32 v255, v201
    v_fma_f32 v203, v42, -v170, v203
    v_fma_f32 v203, v43, -v171, v203
    v_fma_f32 v203, v44, -v172, v203
    v_fma_f32 v203, v45, -v173, v203
    v_fma_f32 v203, v46, -v174, v203
    v_fma_f32 v203, v47, -v175, v203
    v_add_f32 v201, v255, v201
    v_fmac_f32 v199, v48, v120
    v_permlane32_swap_b32 v203, v255
    v_fmac_f32 v199, v49, v121
    v_fmac_f32 v199, v50, v122
    v_fmac_f32 v199, v51, v123
    v_fmac_f32 v199, v52, v124
    v_fmac_f32 v199, v53, v125
    v_fmac_f32 v199, v54, v126
    v_fmac_f32 v199, v55, v127
    v_add_f32 v255, v203, v255
    v_mul_f32 v197, v56, v168
    v_fmac_f32 v197, v57, v169
    v_fmac_f32 v197, v58, v170
    v_fmac_f32 v197, v59, v171
    v_fmac_f32 v197, v60, v172
    v_fmac_f32 v197, v61, v173
    v_fmac_f32 v197, v62, v174
    v_fmac_f32 v197, v63, v175
    s_nop 1
    v_permlane32_swap_b32 v199, v197
    v_add_f32 v197, v199, v197
    v_cvt_pk_bf16_f32 v200, v200, v201
    v_cvt_pk_bf16_f32 v254, v254, v255
    v_cvt_pk_bf16_f32 v196, v196, v197
    ds_write2st64_b32 v253, v200, v196 offset0:3 offset1:4
    s_mov_b64 exec, 0xffffffff
    ds_write_b32 v253, v254 offset:1280
    s_mov_b64 exec, -1
    s_add_u32 s50, s50, 1
    s_cmp_ge_u32 s50, 4
    s_cbranch_scc1 LAST1
    s_waitcnt lgkmcnt(7)
    v_readfirstlane_b32 s66, v252
    s_add_u32 s53, s53, 1
    v_mov_b32 v252, s53
    s_cmp_le_u32 s53, s66
    ds_write2_b32 v251, v252, v252 offset0:0 offset1:8
    s_setprio 1
    s_cbranch_scc1 PRIO_16
    s_setprio 0
PRIO_16:
    s_cmp_eq_u32 s52, 4
    s_cbranch_scc1 ITEM_1_4
    s_cmp_eq_u32 s52, 5
    s_cbranch_scc1 ITEM_1_5
    s_cmp_eq_u32 s52, 3
    s_cbranch_scc1 ITEM_1_3
    s_cmp_eq_u32 s52, 6
    s_cbranch_scc1 ITEM_1_6
    s_cmp_eq_u32 s52, 8
    s_cbranch_scc1 ITEM_1_8
    s_branch ITEM_1_2
.p2align 6
TAIL:
    s_setprio 0
    s_waitcnt vmcnt(0) lgkmcnt(0)
    v_lshrrev_b32 v176, 2, v248
    v_lshlrev_b32 v180, 2, v248
    s_cmp_eq_u32 s89, 0
    s_cbranch_scc1 T_flags
    s_mul_i32 s66, s20, 80
    v_lshlrev_b32 v2, 2, v176
    v_min_u32 v2, 76, v2
    s_mov_b32 s67, 262144
T_poll:
    buffer_load_dword v3, v2, s[16:19], s66 offen offset:128 sc1
    s_waitcnt vmcnt(0)
    v_cmp_ne_u32 vcc, s88, v3
    s_sub_u32 s67, s67, 1
    s_cselect_b64 vcc, 0, vcc
    s_cmp_eq_u64 vcc, 0
    s_cbranch_scc0 T_poll
    s_mov_b32 s89, 0
T_flags:
    s_mul_i32 s66, s20, 20480
    s_add_u32 s66, s66, 1024
    buffer_load_dwordx4 v[96:99], v180, s[16:19], s66 offen offset:0 sc1
    buffer_load_dwordx4 v[100:103], v180, s[16:19], s66 offen offset:1024 sc1
    buffer_load_dwordx4 v[104:107], v180, s[16:19], s66 offen offset:2048 sc1
    buffer_load_dwordx4 v[108:111], v180, s[16:19], s66 offen offset:3072 sc1
    s_add_u32 s66, s66, 4096
    buffer_load_dwordx4 v[112:115], v180, s[16:19], s66 offen offset:0 sc1
    buffer_load_dwordx4 v[116:119], v180, s[16:19], s66 offen offset:1024 sc1
    buffer_load_dwordx4 v[120:123], v180, s[16:19], s66 offen offset:2048 sc1
    buffer_load_dwordx4 v[124:127], v180, s[16:19], s66 offen offset:3072 sc1
    s_add_u32 s66, s66, 4096
    buffer_load_dwordx4 v[128:131], v180, s[16:19], s66 offen offset:0 sc1
    buffer_load_dwordx4 v[132:135], v180, s[16:19], s66 offen offset:1024 sc1
    buffer_load_dwordx4 v[136:139], v180, s[16:19], s66 offen offset:2048 sc1
    buffer_load_dwordx4 v[140:143], v180, s[16:19], s66 offen offset:3072 sc1
    s_add_u32 s66, s66, 4096
    buffer_load_dwordx4 v[144:147], v180, s[16:19], s66 offen offset:0 sc1
    buffer_load_dwordx4 v[148:151], v180, s[16:19], s66 offen offset:1024 sc1
    buffer_load_dwordx4 v[152:155], v180, s[16:19], s66 offen offset:2048 sc1
    buffer_load_dwordx4 v[156:159], v180, s[16:19], s66 offen offset:3072 sc1
    s_add_u32 s66, s66, 4096
    buffer_load_dwordx4 v[160:163], v180, s[16:19], s66 offen offset:0 sc1
    buffer_load_dwordx4 v[164:167], v180, s[16:19], s66 offen offset:1024 sc1
    buffer_load_dwordx4 v[168:171], v180, s[16:19], s66 offen offset:2048 sc1
    buffer_load_dwordx4 v[172:175], v180, s[16:19], s66 offen offset:3072 sc1
    s_lshr_b32 s67, s22, 17
    s_and_b32 s68, s67, 128
    s_and_b32 s67, s67, 0x70
    s_add_u32 s68, s68, s21
    v_xor_b32 v181, s67, v248
    v_add_u32 v181, s68, v181
    ds_write2st64_b32 v181, v204, v205 offset0:0 offset1:1
    ds_write2st64_b32 v181, v206, v207 offset0:2 offset1:3
    ds_write2st64_b32 v181, v208, v209 offset0:4 offset1:5
    s_lshr_b32 s67, s23, 17
    s_and_b32 s68, s67, 128
    s_and_b32 s67, s67, 0x70
    s_add_u32 s68, s68, s21
    v_xor_b32 v181, s67, v248
    v_add_u32 v181, s68, v181
    ds_write2st64_b32 v181, v210, v211 offset0:6 offset1:7
    ds_write2st64_b32 v181, v212, v213 offset0:8 offset1:9
    ds_write2st64_b32 v181, v214, v215 offset0:10 offset1:11
    s_lshr_b32 s67, s24, 17
    s_and_b32 s68, s67, 128
    s_and_b32 s67, s67, 0x70
    s_add_u32 s68, s68, s21
    v_xor_b32 v181, s67, v248
    v_add_u32 v181, s68, v181
    ds_write2st64_b32 v181, v216, v217 offset0:12 offset1:13
    ds_write2st64_b32 v181, v218, v219 offset0:14 offset1:15
    ds_write2st64_b32 v181, v220, v221 offset0:16 offset1:17
    s_lshr_b32 s67, s25, 17
    s_and_b32 s68, s67, 128
    s_and_b32 s67, s67, 0x70
    s_add_u32 s68, s68, s21
    v_xor_b32 v181, s67, v248
    v_add_u32 v181, s68, v181
    ds_write2st64_b32 v181, v222, v223 offset0:18 offset1:19
    ds_write2st64_b32 v181, v224, v225 offset0:20 offset1:21
    ds_write2st64_b32 v181, v226, v227 offset0:22 offset1:23
    s_lshr_b32 s67, s26, 17
    s_and_b32 s68, s67, 128
    s_and_b32 s67, s67, 0x70
    s_add_u32 s68, s68, s21
    v_xor_b32 v181, s67, v248
    v_add_u32 v181, s68, v181
    ds_write2st64_b32 v181, v228, v229 offset0:24 offset1:25
    ds_write2st64_b32 v181, v230, v231 offset0:26 offset1:27
    ds_write2st64_b32 v181, v232, v233 offset0:28 offset1:29
GEMM:
    v_and_b32 v177, 15, v176
    v_lshrrev_b32 v178, 4, v176
    v_and_b32 v179, 7, v177
    v_lshlrev_b32 v180, 3, v177
    v_lshlrev_b32 v181, 3, v179
    v_add_u32 v180, 163328, v180
    v_add_u32 v181, 163328, v181
    ds_read_b64 v[182:183], v180
    ds_read_b64 v[184:185], v180 offset:128
    ds_read_b64 v[186:187], v181 offset:256
    v_xor_b32 v180, v179, v178
    v_and_b32 v181, 8, v177
    v_xor_b32 v188, 4, v180
    v_add_u32 v189, v188, v181
    v_add_u32 v181, v180, v181
    s_waitcnt lgkmcnt(0)
    s_mov_b32 s4, s72
    s_and_b32 s5, s73, 0xffff
    s_mov_b32 s6, 10240000
    s_mov_b32 s7, 0x20000
    v_lshl_add_u32 v48, v180, 4, v182
    v_lshl_add_u32 v49, v188, 4, v182
    v_lshl_add_u32 v50, v180, 4, v183
    v_lshl_add_u32 v51, v188, 4, v183
    v_lshl_add_u32 v52, v180, 4, v184
    v_lshl_add_u32 v53, v188, 4, v184
    v_lshl_add_u32 v54, v180, 4, v185
    v_lshl_add_u32 v55, v188, 4, v185
    v_lshl_add_u32 v56, v181, 4, v186
    v_lshl_add_u32 v57, v189, 4, v186
    v_lshl_add_u32 v58, v181, 4, v187
    v_lshl_add_u32 v59, v189, 4, v187
    s_mov_b32 s67, 0xbfb8aa3b
    s_barrier
    ds_read_b128 v[76:79], v48 offset:0
    ds_read_b128 v[80:83], v52 offset:0
    ds_read_b128 v[84:87], v56 offset:0
    ds_read_b128 v[88:91], v49 offset:0
    ds_read_b128 v[92:95], v53 offset:0
    s_waitcnt vmcnt(19) lgkmcnt(4)
    v_mfma_f32_16x16x32_bf16 v[0:3], v[96:99], v[76:79], 0
    v_lshrrev_b32 v205, 1, v178
    v_lshl_add_u32 v205, s20, 1, v205
    ds_read_b128 v[76:79], v57 offset:0
    s_waitcnt lgkmcnt(4)
    v_mfma_f32_16x16x32_bf16 v[4:7], v[96:99], v[80:83], 0
    v_and_b32 v204, 7, v177
    v_xor_b32 v205, v205, v204
    ds_read_b128 v[80:83], v50 offset:0
    s_waitcnt lgkmcnt(4)
    v_mfma_f32_16x16x32_bf16 v[8:11], v[96:99], v[84:87], 0
    v_and_b32 v204, 1, v178
    v_lshlrev_b32 v204, 3, v204
    ds_read_b128 v[84:87], v54 offset:0
    s_waitcnt vmcnt(18) lgkmcnt(4)
    v_mfma_f32_16x16x32_bf16 v[0:3], v[100:103], v[88:91], v[0:3]
    v_lshl_add_u32 v205, v205, 4, v204
    v_and_b32 v204, 8, v177
    ds_read_b128 v[88:91], v58 offset:0
    s_waitcnt lgkmcnt(4)
    v_mfma_f32_16x16x32_bf16 v[4:7], v[100:103], v[92:95], v[4:7]
    v_lshl_add_u32 v204, v204, 4, v205
    v_lshl_add_u32 v204, v177, 10, v204
    ds_read_b128 v[92:95], v51 offset:0
    s_waitcnt lgkmcnt(4)
    v_mfma_f32_16x16x32_bf16 v[8:11], v[100:103], v[76:79], v[8:11]
    v_add_u32 v204, 65536, v204
    v_add_u32 v205, v205, v182
    ds_read_b128 v[76:79], v55 offset:0
    s_waitcnt vmcnt(17) lgkmcnt(4)
    v_mfma_f32_16x16x32_bf16 v[0:3], v[104:107], v[80:83], v[0:3]
    v_and_b32 v220, 8, v177
    v_mul_u32_u24 v220, 1008, v220
    ds_read_b128 v[80:83], v59 offset:0
    s_waitcnt lgkmcnt(4)
    v_mfma_f32_16x16x32_bf16 v[4:7], v[104:107], v[84:87], v[4:7]
    v_sub_u32 v220, v204, v220
    v_lshlrev_b32 v210, 4, v176
    ds_read_b128 v[84:87], v48 offset:1024
    s_waitcnt lgkmcnt(4)
    v_mfma_f32_16x16x32_bf16 v[8:11], v[104:107], v[88:91], v[8:11]
    s_lshl_b32 s68, s20, 1
    s_add_u32 s69, s68, 1
    ds_read_b128 v[88:91], v52 offset:1024
    s_waitcnt vmcnt(16) lgkmcnt(4)
    v_mfma_f32_16x16x32_bf16 v[0:3], v[108:111], v[92:95], v[0:3]
    v_readlane_b32 s24, v182, s68
    v_readlane_b32 s25, v182, s69
    ds_read_b128 v[92:95], v56 offset:1024
    s_waitcnt lgkmcnt(4)
    v_mfma_f32_16x16x32_bf16 v[4:7], v[108:111], v[76:79], v[4:7]
    s_and_b32 s70, s68, 7
    s_lshl_b32 s70, s70, 4
    ds_read_b128 v[76:79], v49 offset:1024
    s_waitcnt lgkmcnt(4)
    v_mfma_f32_16x16x32_bf16 v[8:11], v[108:111], v[80:83], v[8:11]
    v_xor_b32 v206, s70, v210
    v_xor_b32 v207, 16, v206
    ds_read_b128 v[80:83], v53 offset:1024
    s_waitcnt vmcnt(15) lgkmcnt(4)
    v_mfma_f32_16x16x32_bf16 v[0:3], v[112:115], v[84:87], v[0:3]
    v_add_u32 v208, s24, v206
    v_add_u32 v209, s25, v207
    ds_read_b128 v[84:87], v57 offset:1024
    s_waitcnt lgkmcnt(4)
    v_mfma_f32_16x16x32_bf16 v[4:7], v[112:115], v[88:91], v[4:7]
    s_lshl_b32 s70, s68, 10
    s_and_b32 s71, s68, 8
    ds_read_b128 v[88:91], v50 offset:1024
    s_waitcnt lgkmcnt(4)
    v_mfma_f32_16x16x32_bf16 v[8:11], v[112:115], v[92:95], v[8:11]
    s_lshl_b32 s71, s71, 4
    s_add_u32 s71, s71, s70
    ds_read_b128 v[92:95], v54 offset:1024
    s_waitcnt vmcnt(14) lgkmcnt(4)
    v_mfma_f32_16x16x32_bf16 v[0:3], v[116:119], v[76:79], v[0:3]
    s_add_u32 s71, s71, 65536
    v_add_u32 v206, s71, v206
    ds_read_b128 v[76:79], v58 offset:1024
    s_waitcnt lgkmcnt(4)
    v_mfma_f32_16x16x32_bf16 v[4:7], v[116:119], v[80:83], v[4:7]
    v_add_u32 v207, s71, v207
    s_mul_i32 s66, s2, 40960
    ds_read_b128 v[80:83], v51 offset:1024
    s_waitcnt lgkmcnt(4)
    v_mfma_f32_16x16x32_bf16 v[8:11], v[116:119], v[84:87], v[8:11]
    s_add_u32 s22, s66, s70
    s_add_u32 s23, s22, 0x4000
    ds_read_b128 v[84:87], v55 offset:1024
    s_waitcnt vmcnt(13) lgkmcnt(4)
    v_mfma_f32_16x16x32_bf16 v[0:3], v[120:123], v[88:91], v[0:3]
    s_lshl_b32 s70, s20, 10
    s_add_u32 s66, s66, s70
    ds_read_b128 v[88:91], v59 offset:1024
    s_waitcnt lgkmcnt(4)
    v_mfma_f32_16x16x32_bf16 v[4:7], v[120:123], v[92:95], v[4:7]
    s_add_u32 s66, s66, 0x8000
    s_add_u32 s70, s70, 65536
    ds_read_b128 v[92:95], v48 offset:128
    s_waitcnt lgkmcnt(4)
    v_mfma_f32_16x16x32_bf16 v[8:11], v[120:123], v[76:79], v[8:11]
    s_lshl_b32 s71, s20, 4
    v_xor_b32 v211, s71, v210
    ds_read_b128 v[76:79], v48 offset:256
    s_waitcnt vmcnt(12) lgkmcnt(4)
    v_mfma_f32_16x16x32_bf16 v[0:3], v[124:127], v[80:83], v[0:3]
    v_add_u32 v211, s70, v211
    ds_read_b128 v[80:83], v48 offset:384
    s_waitcnt lgkmcnt(4)
    v_mfma_f32_16x16x32_bf16 v[4:7], v[124:127], v[84:87], v[4:7]
    ds_read_b128 v[84:87], v49 offset:128
    s_waitcnt lgkmcnt(4)
    v_mfma_f32_16x16x32_bf16 v[8:11], v[124:127], v[88:91], v[8:11]
    ds_read_b128 v[88:91], v49 offset:256
    s_waitcnt vmcnt(11) lgkmcnt(4)
    v_mfma_f32_16x16x32_bf16 v[12:15], v[128:131], v[92:95], 0
    ds_read_b128 v[92:95], v49 offset:384
    s_waitcnt lgkmcnt(4)
    v_mfma_f32_16x16x32_bf16 v[24:27], v[128:131], v[76:79], 0
    ds_read_b128 v[76:79], v50 offset:128
    s_waitcnt lgkmcnt(4)
    v_mfma_f32_16x16x32_bf16 v[36:39], v[128:131], v[80:83], 0
    ds_read_b128 v[80:83], v50 offset:256
    s_waitcnt vmcnt(10) lgkmcnt(4)
    v_mfma_f32_16x16x32_bf16 v[12:15], v[132:135], v[84:87], v[12:15]
    v_mul_f32 v192, s67, v0
    v_mul_f32 v193, s67, v1
    ds_read_b128 v[84:87], v50 offset:384
    s_waitcnt lgkmcnt(4)
    v_mfma_f32_16x16x32_bf16 v[24:27], v[132:135], v[88:91], v[24:27]
    v_mul_f32 v194, s67, v2
    v_mul_f32 v195, s67, v3
    ds_read_b128 v[88:91], v51 offset:128
    s_waitcnt lgkmcnt(4)
    v_mfma_f32_16x16x32_bf16 v[36:39], v[132:135], v[92:95], v[36:39]
    v_exp_f32 v192, v192
    v_exp_f32 v193, v193
    ds_read_b128 v[92:95], v51 offset:256
    s_waitcnt vmcnt(9) lgkmcnt(4)
    v_mfma_f32_16x16x32_bf16 v[12:15], v[136:139], v[76:79], v[12:15]
    v_exp_f32 v194, v194
    v_exp_f32 v195, v195
    ds_read_b128 v[76:79], v51 offset:384
    s_waitcnt lgkmcnt(4)
    v_mfma_f32_16x16x32_bf16 v[24:27], v[136:139], v[80:83], v[24:27]
    v_add_f32 v192, 1.0, v192
    v_add_f32 v193, 1.0, v193
    ds_read_b128 v[80:83], v48 offset:512
    s_waitcnt lgkmcnt(4)
    v_mfma_f32_16x16x32_bf16 v[36:39], v[136:139], v[84:87], v[36:39]
    v_add_f32 v194, 1.0, v194
    v_add_f32 v195, 1.0, v195
    ds_read_b128 v[84:87], v48 offset:640
    s_waitcnt vmcnt(8) lgkmcnt(4)
    v_mfma_f32_16x16x32_bf16 v[12:15], v[140:143], v[88:91], v[12:15]
    v_rcp_f32 v192, v192
    v_rcp_f32 v193, v193
    ds_read_b128 v[88:91], v48 offset:768
    s_waitcnt lgkmcnt(4)
    v_mfma_f32_16x16x32_bf16 v[24:27], v[140:143], v[92:95], v[24:27]
    v_rcp_f32 v194, v194
    v_rcp_f32 v195, v195
    ds_read_b128 v[92:95], v49 offset:512
    s_waitcnt lgkmcnt(4)
    v_mfma_f32_16x16x32_bf16 v[36:39], v[140:143], v[76:79], v[36:39]
    v_mul_f32 v196, s67, v4
    v_mul_f32 v197, s67, v5
    ds_read_b128 v[76:79], v49 offset:640
    s_waitcnt vmcnt(7) lgkmcnt(4)
    v_mfma_f32_16x16x32_bf16 v[12:15], v[144:147], v[80:83], v[12:15]
    v_mul_f32 v198, s67, v6
    v_mul_f32 v199, s67, v7
    ds_read_b128 v[80:83], v49 offset:768
    s_waitcnt lgkmcnt(4)
    v_mfma_f32_16x16x32_bf16 v[24:27], v[144:147], v[84:87], v[24:27]
    v_exp_f32 v196, v196
    v_exp_f32 v197, v197
    ds_read_b128 v[84:87], v50 offset:512
    s_waitcnt lgkmcnt(4)
    v_mfma_f32_16x16x32_bf16 v[36:39], v[144:147], v[88:91], v[36:39]
    v_exp_f32 v198, v198
    v_exp_f32 v199, v199
    ds_read_b128 v[88:91], v50 offset:640
    s_waitcnt vmcnt(6) lgkmcnt(4)
    v_mfma_f32_16x16x32_bf16 v[12:15], v[148:151], v[92:95], v[12:15]
    v_add_f32 v196, 1.0, v196
    v_add_f32 v197, 1.0, v197
    ds_read_b128 v[92:95], v50 offset:768
    s_waitcnt lgkmcnt(4)
    v_mfma_f32_16x16x32_bf16 v[24:27], v[148:151], v[76:79], v[24:27]
    v_add_f32 v198, 1.0, v198
    v_add_f32 v199, 1.0, v199
    ds_read_b128 v[76:79], v51 offset:512
    s_waitcnt lgkmcnt(4)
    v_mfma_f32_16x16x32_bf16 v[36:39], v[148:151], v[80:83], v[36:39]
    v_rcp_f32 v196, v196
    v_rcp_f32 v197, v197
    ds_read_b128 v[80:83], v51 offset:640
    s_waitcnt vmcnt(5) lgkmcnt(4)
    v_mfma_f32_16x16x32_bf16 v[12:15], v[152:155], v[84:87], v[12:15]
    v_rcp_f32 v198, v198
    v_rcp_f32 v199, v199
    ds_read_b128 v[84:87], v51 offset:768
    s_waitcnt lgkmcnt(4)
    v_mfma_f32_16x16x32_bf16 v[24:27], v[152:155], v[88:91], v[24:27]
    v_mul_f32 v200, s67, v8
    v_mul_f32 v201, s67, v9
    ds_read_b128 v[88:91], v48 offset:1152
    s_waitcnt lgkmcnt(4)
    v_mfma_f32_16x16x32_bf16 v[36:39], v[152:155], v[92:95], v[36:39]
    v_mul_f32 v202, s67, v10
    v_mul_f32 v203, s67, v11
    ds_read_b128 v[92:95], v48 offset:1280
    s_waitcnt vmcnt(4) lgkmcnt(4)
    v_mfma_f32_16x16x32_bf16 v[12:15], v[156:159], v[76:79], v[12:15]
    v_exp_f32 v200, v200
    v_exp_f32 v201, v201
    ds_read_b128 v[76:79], v48 offset:896
    s_waitcnt lgkmcnt(4)
    v_mfma_f32_16x16x32_bf16 v[24:27], v[156:159], v[80:83], v[24:27]
    v_exp_f32 v202, v202
    v_exp_f32 v203, v203
    ds_read_b128 v[80:83], v49 offset:1152
    s_waitcnt lgkmcnt(4)
    v_mfma_f32_16x16x32_bf16 v[36:39], v[156:159], v[84:87], v[36:39]
    v_add_f32 v200, 1.0, v200
    v_add_f32 v201, 1.0, v201
    ds_read_b128 v[84:87], v49 offset:1280
    s_waitcnt vmcnt(3) lgkmcnt(4)
    v_mfma_f32_16x16x32_bf16 v[12:15], v[160:163], v[88:91], v[12:15]
    v_add_f32 v202, 1.0, v202
    v_add_f32 v203, 1.0, v203
    ds_read_b128 v[88:91], v49 offset:896
    s_waitcnt lgkmcnt(4)
    v_mfma_f32_16x16x32_bf16 v[24:27], v[160:163], v[92:95], v[24:27]
    v_rcp_f32 v200, v200
    v_rcp_f32 v201, v201
    ds_read_b128 v[92:95], v50 offset:1152
    s_waitcnt lgkmcnt(4)
    v_mfma_f32_16x16x32_bf16 v[36:39], v[160:163], v[76:79], v[36:39]
    v_rcp_f32 v202, v202
    v_rcp_f32 v203, v203
    ds_read_b128 v[76:79], v50 offset:1280
    s_waitcnt vmcnt(2) lgkmcnt(4)
    v_mfma_f32_16x16x32_bf16 v[12:15], v[164:167], v[80:83], v[12:15]
    v_cvt_pk_bf16_f32 v0, v0, v1
    v_cvt_pk_bf16_f32 v1, v2, v3
    ds_read_b128 v[80:83], v50 offset:896
    s_waitcnt lgkmcnt(4)
    v_mfma_f32_16x16x32_bf16 v[24:27], v[164:167], v[84:87], v[24:27]
    ds_write_b64 v204, v[0:1] offset:0
    ds_read_b128 v[84:87], v51 offset:1152
    s_waitcnt lgkmcnt(5)
    v_mfma_f32_16x16x32_bf16 v[36:39], v[164:167], v[88:91], v[36:39]
    v_mov_b32_dpp v200, v200 row_ror:8 row_mask:0xf bank_mask:0xc
    v_mov_b32_dpp v201, v201 row_ror:8 row_mask:0xf bank_mask:0xc
    ds_read_b128 v[88:91], v51 offset:1280
    s_waitcnt vmcnt(1) lgkmcnt(5)
    v_mfma_f32_16x16x32_bf16 v[12:15], v[168:171], v[92:95], v[12:15]
    v_mov_b32_dpp v202, v202 row_ror:8 row_mask:0xf bank_mask:0xc
    v_mov_b32_dpp v203, v203 row_ror:8 row_mask:0xf bank_mask:0xc
    ds_read_b128 v[92:95], v51 offset:896
    s_waitcnt lgkmcnt(5)
    v_mfma_f32_16x16x32_bf16 v[24:27], v[168:171], v[76:79], v[24:27]
    ds_read_b128 v[76:79], v52 offset:128
    s_waitcnt lgkmcnt(5)
    v_mfma_f32_16x16x32_bf16 v[36:39], v[168:171], v[80:83], v[36:39]
    ds_read_b128 v[80:83], v53 offset:128
    s_waitcnt vmcnt(0) lgkmcnt(4)
    v_mfma_f32_16x16x32_bf16 v[12:15], v[172:175], v[84:87], v[12:15]
    ds_read_b128 v[84:87], v54 offset:128
    s_waitcnt lgkmcnt(4)
    v_mfma_f32_16x16x32_bf16 v[24:27], v[172:175], v[88:91], v[24:27]
    ds_read_b128 v[88:91], v55 offset:128
    s_waitcnt lgkmcnt(4)
    v_mfma_f32_16x16x32_bf16 v[36:39], v[172:175], v[92:95], v[36:39]
    ds_read_b128 v[92:95], v52 offset:512
    s_waitcnt lgkmcnt(4)
    v_mfma_f32_16x16x32_bf16 v[16:19], v[128:131], v[76:79], 0
    ds_read_b128 v[76:79], v53 offset:512
    s_waitcnt lgkmcnt(4)
    v_mfma_f32_16x16x32_bf16 v[16:19], v[132:135], v[80:83], v[16:19]
    ds_read_b128 v[80:83], v54 offset:512
    s_waitcnt lgkmcnt(4)
    v_mfma_f32_16x16x32_bf16 v[16:19], v[136:139], v[84:87], v[16:19]
    v_mul_f32 v12, v12, v192
    v_mul_f32 v13, v13, v193
    ds_read_b128 v[84:87], v55 offset:512
    s_waitcnt lgkmcnt(4)
    v_mfma_f32_16x16x32_bf16 v[16:19], v[140:143], v[88:91], v[16:19]
    v_mul_f32 v14, v14, v194
    v_mul_f32 v15, v15, v195
    ds_read_b128 v[88:91], v52 offset:1152
    s_waitcnt lgkmcnt(4)
    v_mfma_f32_16x16x32_bf16 v[16:19], v[144:147], v[92:95], v[16:19]
    v_cvt_pk_bf16_f32 v12, v12, v13
    v_cvt_pk_bf16_f32 v13, v14, v15
    ds_read_b128 v[92:95], v53 offset:1152
    s_waitcnt lgkmcnt(4)
    v_mfma_f32_16x16x32_bf16 v[16:19], v[148:151], v[76:79], v[16:19]
    ds_write_b64 v204, v[12:13] offset:256
    v_mul_f32 v24, v24, v192
    ds_read_b128 v[76:79], v54 offset:1152
    s_waitcnt lgkmcnt(5)
    v_mfma_f32_16x16x32_bf16 v[16:19], v[152:155], v[80:83], v[16:19]
    v_mul_f32 v25, v25, v193
    v_mul_f32 v26, v26, v194
    ds_read_b128 v[80:83], v55 offset:1152
    s_waitcnt lgkmcnt(5)
    v_mfma_f32_16x16x32_bf16 v[16:19], v[156:159], v[84:87], v[16:19]
    v_mul_f32 v27, v27, v195
    v_cvt_pk_bf16_f32 v24, v24, v25
    ds_read_b128 v[84:87], v52 offset:256
    s_waitcnt lgkmcnt(5)
    v_mfma_f32_16x16x32_bf16 v[16:19], v[160:163], v[88:91], v[16:19]
    v_cvt_pk_bf16_f32 v25, v26, v27
    ds_write_b64 v204, v[24:25] offset:512
    ds_read_b128 v[88:91], v53 offset:256
    s_waitcnt lgkmcnt(6)
    v_mfma_f32_16x16x32_bf16 v[16:19], v[164:167], v[92:95], v[16:19]
    v_mul_f32 v36, v36, v192
    v_mul_f32 v37, v37, v193
    ds_read_b128 v[92:95], v54 offset:256
    s_waitcnt lgkmcnt(5)
    v_mfma_f32_16x16x32_bf16 v[16:19], v[168:171], v[76:79], v[16:19]
    v_mul_f32 v38, v38, v194
    v_mul_f32 v39, v39, v195
    ds_read_b128 v[76:79], v55 offset:256
    s_waitcnt lgkmcnt(5)
    v_mfma_f32_16x16x32_bf16 v[16:19], v[172:175], v[80:83], v[16:19]
    v_cvt_pk_bf16_f32 v36, v36, v37
    v_cvt_pk_bf16_f32 v37, v38, v39
    ds_read_b128 v[80:83], v52 offset:640
    s_waitcnt lgkmcnt(5)
    v_mfma_f32_16x16x32_bf16 v[28:31], v[128:131], v[84:87], 0
    ds_write_b64 v204, v[36:37] offset:768
    ds_read_b128 v[84:87], v53 offset:640
    s_waitcnt lgkmcnt(5)
    v_mfma_f32_16x16x32_bf16 v[28:31], v[132:135], v[88:91], v[28:31]
    ds_read_b128 v[88:91], v54 offset:640
    s_waitcnt lgkmcnt(5)
    v_mfma_f32_16x16x32_bf16 v[28:31], v[136:139], v[92:95], v[28:31]
    ds_read_b128 v[92:95], v55 offset:640
    s_waitcnt lgkmcnt(5)
    v_mfma_f32_16x16x32_bf16 v[28:31], v[140:143], v[76:79], v[28:31]
    ds_read_b128 v[76:79], v52 offset:1280
    s_waitcnt lgkmcnt(5)
    v_mfma_f32_16x16x32_bf16 v[28:31], v[144:147], v[80:83], v[28:31]
    ds_read_b128 v[80:83], v53 offset:1280
    s_waitcnt lgkmcnt(4)
    v_mfma_f32_16x16x32_bf16 v[28:31], v[148:151], v[84:87], v[28:31]
    s_barrier
    ds_read_b128 v[84:87], v54 offset:1280
    s_waitcnt lgkmcnt(4)
    v_mfma_f32_16x16x32_bf16 v[28:31], v[152:155], v[88:91], v[28:31]
    ds_read_b128 v[212:215], v206 offset:0
    ds_read_b128 v[216:219], v207 offset:1024
    ds_read_b128 v[88:91], v55 offset:1280
    s_waitcnt lgkmcnt(6)
    v_mfma_f32_16x16x32_bf16 v[28:31], v[156:159], v[92:95], v[28:31]
    ds_read_b128 v[92:95], v52 offset:384
    s_waitcnt lgkmcnt(6)
    v_mfma_f32_16x16x32_bf16 v[28:31], v[160:163], v[76:79], v[28:31]
    ds_read_b128 v[76:79], v53 offset:384
    s_waitcnt lgkmcnt(6)
    v_mfma_f32_16x16x32_bf16 v[28:31], v[164:167], v[80:83], v[28:31]
    ds_read_b128 v[80:83], v54 offset:384
    s_waitcnt lgkmcnt(6)
    v_mfma_f32_16x16x32_bf16 v[28:31], v[168:171], v[84:87], v[28:31]
    ds_read_b128 v[84:87], v55 offset:384
    s_waitcnt lgkmcnt(4)
    v_mfma_f32_16x16x32_bf16 v[28:31], v[172:175], v[88:91], v[28:31]
    buffer_store_dwordx4 v[212:215], v210, s[4:7], s22 offen offset:0 sc1
    ds_read_b128 v[88:91], v52 offset:768
    s_waitcnt lgkmcnt(4)
    v_mfma_f32_16x16x32_bf16 v[40:43], v[128:131], v[92:95], 0
    buffer_store_dwordx4 v[216:219], v210, s[4:7], s22 offen offset:1024 sc1
    ds_read_b128 v[92:95], v53 offset:768
    s_waitcnt lgkmcnt(4)
    v_mfma_f32_16x16x32_bf16 v[40:43], v[132:135], v[76:79], v[40:43]
    ds_read_b128 v[76:79], v54 offset:768
    s_waitcnt lgkmcnt(4)
    v_mfma_f32_16x16x32_bf16 v[40:43], v[136:139], v[80:83], v[40:43]
    ds_read_b128 v[80:83], v55 offset:768
    s_waitcnt lgkmcnt(4)
    v_mfma_f32_16x16x32_bf16 v[40:43], v[140:143], v[84:87], v[40:43]
    v_cvt_pk_bf16_f32 v4, v4, v5
    v_cvt_pk_bf16_f32 v5, v6, v7
    ds_read_b128 v[84:87], v52 offset:896
    s_waitcnt lgkmcnt(4)
    v_mfma_f32_16x16x32_bf16 v[40:43], v[144:147], v[88:91], v[40:43]
    ds_write_b64 v205, v[4:5] offset:0
    v_mul_f32 v16, v16, v196
    ds_read_b128 v[88:91], v53 offset:896
    s_waitcnt lgkmcnt(5)
    v_mfma_f32_16x16x32_bf16 v[40:43], v[148:151], v[92:95], v[40:43]
    v_mul_f32 v17, v17, v197
    v_mul_f32 v18, v18, v198
    ds_read_b128 v[92:95], v54 offset:896
    s_waitcnt lgkmcnt(5)
    v_mfma_f32_16x16x32_bf16 v[40:43], v[152:155], v[76:79], v[40:43]
    v_mul_f32 v19, v19, v199
    v_cvt_pk_bf16_f32 v16, v16, v17
    ds_read_b128 v[76:79], v55 offset:896
    s_waitcnt lgkmcnt(5)
    v_mfma_f32_16x16x32_bf16 v[40:43], v[156:159], v[80:83], v[40:43]
    v_cvt_pk_bf16_f32 v17, v18, v19
    ds_write_b64 v205, v[16:17] offset:256
    ds_read_b128 v[80:83], v56 offset:128
    s_waitcnt lgkmcnt(6)
    v_mfma_f32_16x16x32_bf16 v[40:43], v[160:163], v[84:87], v[40:43]
    v_mul_f32 v28, v28, v196
    v_mul_f32 v29, v29, v197
    ds_read_b128 v[84:87], v57 offset:128
    s_waitcnt lgkmcnt(5)
    v_mfma_f32_16x16x32_bf16 v[40:43], v[164:167], v[88:91], v[40:43]
    v_mul_f32 v30, v30, v198
    v_mul_f32 v31, v31, v199
    ds_read_b128 v[88:91], v58 offset:128
    s_waitcnt lgkmcnt(5)
    v_mfma_f32_16x16x32_bf16 v[40:43], v[168:171], v[92:95], v[40:43]
    v_cvt_pk_bf16_f32 v28, v28, v29
    v_cvt_pk_bf16_f32 v29, v30, v31
    ds_read_b128 v[92:95], v59 offset:128
    s_waitcnt lgkmcnt(5)
    v_mfma_f32_16x16x32_bf16 v[40:43], v[172:175], v[76:79], v[40:43]
    ds_write_b64 v205, v[28:29] offset:512
    ds_read_b128 v[76:79], v56 offset:512
    s_waitcnt lgkmcnt(5)
    v_mfma_f32_16x16x32_bf16 v[20:23], v[128:131], v[80:83], 0
    ds_read_b128 v[80:83], v57 offset:512
    s_waitcnt lgkmcnt(5)
    v_mfma_f32_16x16x32_bf16 v[20:23], v[132:135], v[84:87], v[20:23]
    ds_read_b128 v[84:87], v58 offset:512
    s_waitcnt lgkmcnt(5)
    v_mfma_f32_16x16x32_bf16 v[20:23], v[136:139], v[88:91], v[20:23]
    ds_read_b128 v[88:91], v59 offset:512
    s_waitcnt lgkmcnt(5)
    v_mfma_f32_16x16x32_bf16 v[20:23], v[140:143], v[92:95], v[20:23]
    v_mul_f32 v40, v40, v196
    v_mul_f32 v41, v41, v197
    ds_read_b128 v[92:95], v56 offset:1152
    s_waitcnt lgkmcnt(4)
    v_mfma_f32_16x16x32_bf16 v[20:23], v[144:147], v[76:79], v[20:23]
    v_mul_f32 v42, v42, v198
    v_mul_f32 v43, v43, v199
    ds_read_b128 v[76:79], v57 offset:1152
    s_waitcnt lgkmcnt(4)
    v_mfma_f32_16x16x32_bf16 v[20:23], v[148:151], v[80:83], v[20:23]
    v_cvt_pk_bf16_f32 v40, v40, v41
    v_cvt_pk_bf16_f32 v41, v42, v43
    ds_read_b128 v[80:83], v58 offset:1152
    s_waitcnt lgkmcnt(4)
    v_mfma_f32_16x16x32_bf16 v[20:23], v[152:155], v[84:87], v[20:23]
    ds_write_b64 v205, v[40:41] offset:768
    ds_read_b128 v[84:87], v59 offset:1152
    s_waitcnt lgkmcnt(5)
    v_mfma_f32_16x16x32_bf16 v[20:23], v[156:159], v[88:91], v[20:23]
    ds_read_b128 v[88:91], v56 offset:384
    s_waitcnt lgkmcnt(5)
    v_mfma_f32_16x16x32_bf16 v[20:23], v[160:163], v[92:95], v[20:23]
    ds_read_b128 v[92:95], v57 offset:384
    s_waitcnt lgkmcnt(5)
    v_mfma_f32_16x16x32_bf16 v[20:23], v[164:167], v[76:79], v[20:23]
    s_waitcnt lgkmcnt(3)
    s_barrier
    ds_read_b128 v[76:79], v58 offset:384
    v_mfma_f32_16x16x32_bf16 v[20:23], v[168:171], v[80:83], v[20:23]
    ds_read_b128 v[212:215], v208 offset:0
    ds_read_b128 v[216:219], v209 offset:0
    ds_read_b128 v[80:83], v59 offset:384
    s_waitcnt lgkmcnt(6)
    v_mfma_f32_16x16x32_bf16 v[20:23], v[172:175], v[84:87], v[20:23]
    ds_read_b128 v[84:87], v56 offset:768
    s_waitcnt lgkmcnt(6)
    v_mfma_f32_16x16x32_bf16 v[44:47], v[128:131], v[88:91], 0
    ds_read_b128 v[88:91], v57 offset:768
    s_waitcnt lgkmcnt(6)
    v_mfma_f32_16x16x32_bf16 v[44:47], v[132:135], v[92:95], v[44:47]
    ds_read_b128 v[92:95], v58 offset:768
    s_waitcnt lgkmcnt(6)
    v_mfma_f32_16x16x32_bf16 v[44:47], v[136:139], v[76:79], v[44:47]
    s_waitcnt lgkmcnt(5)
    buffer_store_dwordx4 v[212:215], v210, s[4:7], s23 offen offset:0 sc1
    ds_read_b128 v[76:79], v59 offset:768
    s_waitcnt lgkmcnt(4)
    v_mfma_f32_16x16x32_bf16 v[44:47], v[140:143], v[80:83], v[44:47]
    buffer_store_dwordx4 v[216:219], v210, s[4:7], s23 offen offset:1024 sc1
    ds_read_b128 v[80:83], v56 offset:896
    s_waitcnt lgkmcnt(4)
    v_mfma_f32_16x16x32_bf16 v[44:47], v[144:147], v[84:87], v[44:47]
    ds_read_b128 v[84:87], v57 offset:896
    s_waitcnt lgkmcnt(4)
    v_mfma_f32_16x16x32_bf16 v[44:47], v[148:151], v[88:91], v[44:47]
    ds_read_b128 v[88:91], v58 offset:896
    s_waitcnt lgkmcnt(4)
    v_mfma_f32_16x16x32_bf16 v[44:47], v[152:155], v[92:95], v[44:47]
    ds_read_b128 v[92:95], v59 offset:896
    s_waitcnt lgkmcnt(4)
    v_mfma_f32_16x16x32_bf16 v[44:47], v[156:159], v[76:79], v[44:47]
    v_cvt_pk_bf16_f32 v8, v8, v9
    v_cvt_pk_bf16_f32 v9, v10, v11
    s_waitcnt lgkmcnt(3)
    v_mfma_f32_16x16x32_bf16 v[44:47], v[160:163], v[80:83], v[44:47]
    ds_write_b64 v204, v[8:9] offset:0
    v_mul_f32 v20, v20, v200
    s_waitcnt lgkmcnt(3)
    v_mfma_f32_16x16x32_bf16 v[44:47], v[164:167], v[84:87], v[44:47]
    v_mul_f32 v21, v21, v201
    v_mul_f32 v22, v22, v202
    s_waitcnt lgkmcnt(2)
    v_mfma_f32_16x16x32_bf16 v[44:47], v[168:171], v[88:91], v[44:47]
    v_mul_f32 v23, v23, v203
    v_cvt_pk_bf16_f32 v20, v20, v21
    s_waitcnt lgkmcnt(1)
    v_mfma_f32_16x16x32_bf16 v[44:47], v[172:175], v[92:95], v[44:47]
    v_cvt_pk_bf16_f32 v21, v22, v23
    ds_write_b64 v220, v[20:21] offset:256
    s_nop 5
    v_mul_f32 v44, v44, v200
    v_mul_f32 v45, v45, v201
    v_mul_f32 v46, v46, v202
    v_mul_f32 v47, v47, v203
    v_cvt_pk_bf16_f32 v44, v44, v45
    v_cvt_pk_bf16_f32 v45, v46, v47
    ds_write_b64 v204, v[44:45] offset:768
    s_waitcnt lgkmcnt(0)
    s_barrier
    ds_read_b128 v[212:215], v211 offset:0
    s_waitcnt lgkmcnt(0)
    buffer_store_dwordx4 v[212:215], v210, s[4:7], s66 offen offset:0 sc1
    s_or_b32 s89, s89, s20
    s_cbranch_scc1 K2_end
    v_mov_b32 v0, 0
    v_mov_b32 v1, s88
    s_mov_b64 exec, 1
    buffer_store_dword v1, v0, s[16:19], 0 offen
K2_end:
K2_last:
    s_endpgm
SLOW:
    v_readlane_b32 s89, v4, 62
    s_waitcnt vmcnt(0) lgkmcnt(0)
    s_barrier
    s_load_dwordx2 s[22:23], s[0:1], 8
    s_load_dwordx2 s[24:25], s[0:1], 24
    s_load_dwordx2 s[26:27], s[0:1], 32
    s_load_dwordx2 s[28:29], s[0:1], 40
    s_load_dwordx2 s[30:31], s[0:1], 0
    v_mbcnt_lo_u32_b32 v240, -1, 0
    v_mbcnt_hi_u32_b32 v240, -1, v240
    v_lshrrev_b32 v229, 5, v240
    v_and_b32 v230, 31, v240
    v_lshlrev_b32 v241, 7, v229
    v_lshl_add_u32 v241, v230, 1, v241
    v_lshlrev_b32 v245, 4, v240
    v_mov_b32 v242, 0
    s_waitcnt lgkmcnt(0)
    s_mov_b32 s80, s22
    s_and_b32 s81, s23, 0xffff
    s_mov_b32 s82, 1920000
    s_mov_b32 s83, 0x20000
    s_mov_b32 s76, s24
    s_and_b32 s77, s25, 0xffff
    s_mov_b32 s78, 1280000
    s_mov_b32 s79, 0x20000
    s_mov_b32 s72, s26
    s_and_b32 s73, s27, 0xffff
    s_mov_b32 s74, 1280000
    s_mov_b32 s75, 0x20000
    s_mov_b32 s84, s28
    s_and_b32 s85, s29, 0xffff
    s_mov_b32 s86, 20480
    s_mov_b32 s87, 0x20000
    s_mov_b32 s4, s30
    s_and_b32 s5, s31, 0xffff
    s_mov_b32 s6, 10240000
    s_mov_b32 s7, 0x20000
    s_mov_b32 s66, 0
    buffer_load_ushort v0, v241, s[84:87], s66 offen offset:0
    buffer_load_ushort v1, v241, s[84:87], s66 offen offset:64
    buffer_load_ushort v2, v241, s[84:87], s66 offen offset:256
    buffer_load_ushort v3, v241, s[84:87], s66 offen offset:320
    buffer_load_ushort v4, v241, s[84:87], s66 offen offset:512
    buffer_load_ushort v5, v241, s[84:87], s66 offen offset:576
    buffer_load_ushort v6, v241, s[84:87], s66 offen offset:768
    buffer_load_ushort v7, v241, s[84:87], s66 offen offset:832
    buffer_load_ushort v8, v241, s[84:87], s66 offen offset:1024
    buffer_load_ushort v9, v241, s[84:87], s66 offen offset:1088
    s_waitcnt vmcnt(0)
    s_mov_b32 s66, 1280
    buffer_load_ushort v10, v241, s[84:87], s66 offen offset:0
    buffer_load_ushort v11, v241, s[84:87], s66 offen offset:64
    buffer_load_ushort v12, v241, s[84:87], s66 offen offset:256
    buffer_load_ushort v13, v241, s[84:87], s66 offen offset:320
    buffer_load_ushort v14, v241, s[84:87], s66 offen offset:512
    buffer_load_ushort v15, v241, s[84:87], s66 offen offset:576
    buffer_load_ushort v16, v241, s[84:87], s66 offen offset:768
    buffer_load_ushort v17, v241, s[84:87], s66 offen offset:832
    buffer_load_ushort v18, v241, s[84:87], s66 offen offset:1024
    buffer_load_ushort v19, v241, s[84:87], s66 offen offset:1088
    s_waitcnt vmcnt(0)
    s_mov_b32 s66, 2560
    buffer_load_ushort v20, v241, s[84:87], s66 offen offset:0
    buffer_load_ushort v21, v241, s[84:87], s66 offen offset:64
    buffer_load_ushort v22, v241, s[84:87], s66 offen offset:256
    buffer_load_ushort v23, v241, s[84:87], s66 offen offset:320
    buffer_load_ushort v24, v241, s[84:87], s66 offen offset:512
    buffer_load_ushort v25, v241, s[84:87], s66 offen offset:576
    buffer_load_ushort v26, v241, s[84:87], s66 offen offset:768
    buffer_load_ushort v27, v241, s[84:87], s66 offen offset:832
    buffer_load_ushort v28, v241, s[84:87], s66 offen offset:1024
    buffer_load_ushort v29, v241, s[84:87], s66 offen offset:1088
    s_waitcnt vmcnt(0)
    s_mov_b32 s66, 3840
    buffer_load_ushort v30, v241, s[84:87], s66 offen offset:0
    buffer_load_ushort v31, v241, s[84:87], s66 offen offset:64
    buffer_load_ushort v32, v241, s[84:87], s66 offen offset:256
    buffer_load_ushort v33, v241, s[84:87], s66 offen offset:320
    buffer_load_ushort v34, v241, s[84:87], s66 offen offset:512
    buffer_load_ushort v35, v241, s[84:87], s66 offen offset:576
    buffer_load_ushort v36, v241, s[84:87], s66 offen offset:768
    buffer_load_ushort v37, v241, s[84:87], s66 offen offset:832
    buffer_load_ushort v38, v241, s[84:87], s66 offen offset:1024
    buffer_load_ushort v39, v241, s[84:87], s66 offen offset:1088
    s_waitcnt vmcnt(0)
    s_mov_b32 s66, 5120
    buffer_load_ushort v40, v241, s[84:87], s66 offen offset:0
    buffer_load_ushort v41, v241, s[84:87], s66 offen offset:64
    buffer_load_ushort v42, v241, s[84:87], s66 offen offset:256
    buffer_load_ushort v43, v241, s[84:87], s66 offen offset:320
    buffer_load_ushort v44, v241, s[84:87], s66 offen offset:512
    buffer_load_ushort v45, v241, s[84:87], s66 offen offset:576
    buffer_load_ushort v46, v241, s[84:87], s66 offen offset:768
    buffer_load_ushort v47, v241, s[84:87], s66 offen offset:832
    buffer_load_ushort v48, v241, s[84:87], s66 offen offset:1024
    buffer_load_ushort v49, v241, s[84:87], s66 offen offset:1088
    s_waitcnt vmcnt(0)
    s_mov_b32 s66, 6400
    buffer_load_ushort v50, v241, s[84:87], s66 offen offset:0
    buffer_load_ushort v51, v241, s[84:87], s66 offen offset:64
    buffer_load_ushort v52, v241, s[84:87], s66 offen offset:256
    buffer_load_ushort v53, v241, s[84:87], s66 offen offset:320
    buffer_load_ushort v54, v241, s[84:87], s66 offen offset:512
    buffer_load_ushort v55, v241, s[84:87], s66 offen offset:576
    buffer_load_ushort v56, v241, s[84:87], s66 offen offset:768
    buffer_load_ushort v57, v241, s[84:87], s66 offen offset:832
    buffer_load_ushort v58, v241, s[84:87], s66 offen offset:1024
    buffer_load_ushort v59, v241, s[84:87], s66 offen offset:1088
    s_waitcnt vmcnt(0)
    s_mov_b32 s66, 7680
    buffer_load_ushort v60, v241, s[84:87], s66 offen offset:0
    buffer_load_ushort v61, v241, s[84:87], s66 offen offset:64
    buffer_load_ushort v62, v241, s[84:87], s66 offen offset:256
    buffer_load_ushort v63, v241, s[84:87], s66 offen offset:320
    buffer_load_ushort v64, v241, s[84:87], s66 offen offset:512
    buffer_load_ushort v65, v241, s[84:87], s66 offen offset:576
    buffer_load_ushort v66, v241, s[84:87], s66 offen offset:768
    buffer_load_ushort v67, v241, s[84:87], s66 offen offset:832
    buffer_load_ushort v68, v241, s[84:87], s66 offen offset:1024
    buffer_load_ushort v69, v241, s[84:87], s66 offen offset:1088
    s_waitcnt vmcnt(0)
    s_mov_b32 s66, 8960
    buffer_load_ushort v70, v241, s[84:87], s66 offen offset:0
    buffer_load_ushort v71, v241, s[84:87], s66 offen offset:64
    buffer_load_ushort v72, v241, s[84:87], s66 offen offset:256
    buffer_load_ushort v73, v241, s[84:87], s66 offen offset:320
    buffer_load_ushort v74, v241, s[84:87], s66 offen offset:512
    buffer_load_ushort v75, v241, s[84:87], s66 offen offset:576
    buffer_load_ushort v76, v241, s[84:87], s66 offen offset:768
    buffer_load_ushort v77, v241, s[84:87], s66 offen offset:832
    buffer_load_ushort v78, v241, s[84:87], s66 offen offset:1024
    buffer_load_ushort v79, v241, s[84:87], s66 offen offset:1088
    s_waitcnt vmcnt(0)
    s_mov_b32 s66, 10240
    buffer_load_ushort v80, v241, s[84:87], s66 offen offset:0
    buffer_load_ushort v81, v241, s[84:87], s66 offen offset:64
    buffer_load_ushort v82, v241, s[84:87], s66 offen offset:256
    buffer_load_ushort v83, v241, s[84:87], s66 offen offset:320
    buffer_load_ushort v84, v241, s[84:87], s66 offen offset:512
    buffer_load_ushort v85, v241, s[84:87], s66 offen offset:576
    buffer_load_ushort v86, v241, s[84:87], s66 offen offset:768
    buffer_load_ushort v87, v241, s[84:87], s66 offen offset:832
    buffer_load_ushort v88, v241, s[84:87], s66 offen offset:1024
    buffer_load_ushort v89, v241, s[84:87], s66 offen offset:1088
    s_waitcnt vmcnt(0)
    s_mov_b32 s66, 11520
    buffer_load_ushort v90, v241, s[84:87], s66 offen offset:0
    buffer_load_ushort v91, v241, s[84:87], s66 offen offset:64
    buffer_load_ushort v92, v241, s[84:87], s66 offen offset:256
    buffer_load_ushort v93, v241, s[84:87], s66 offen offset:320
    buffer_load_ushort v94, v241, s[84:87], s66 offen offset:512
    buffer_load_ushort v95, v241, s[84:87], s66 offen offset:576
    buffer_load_ushort v96, v241, s[84:87], s66 offen offset:768
    buffer_load_ushort v97, v241, s[84:87], s66 offen offset:832
    buffer_load_ushort v98, v241, s[84:87], s66 offen offset:1024
    buffer_load_ushort v99, v241, s[84:87], s66 offen offset:1088
    s_waitcnt vmcnt(0)
    s_mov_b32 s66, 12800
    buffer_load_ushort v100, v241, s[84:87], s66 offen offset:0
    buffer_load_ushort v101, v241, s[84:87], s66 offen offset:64
    buffer_load_ushort v102, v241, s[84:87], s66 offen offset:256
    buffer_load_ushort v103, v241, s[84:87], s66 offen offset:320
    buffer_load_ushort v104, v241, s[84:87], s66 offen offset:512
    buffer_load_ushort v105, v241, s[84:87], s66 offen offset:576
    buffer_load_ushort v106, v241, s[84:87], s66 offen offset:768
    buffer_load_ushort v107, v241, s[84:87], s66 offen offset:832
    buffer_load_ushort v108, v241, s[84:87], s66 offen offset:1024
    buffer_load_ushort v109, v241, s[84:87], s66 offen offset:1088
    s_waitcnt vmcnt(0)
    s_mov_b32 s66, 14080
    buffer_load_ushort v110, v241, s[84:87], s66 offen offset:0
    buffer_load_ushort v111, v241, s[84:87], s66 offen offset:64
    buffer_load_ushort v112, v241, s[84:87], s66 offen offset:256
    buffer_load_ushort v113, v241, s[84:87], s66 offen offset:320
    buffer_load_ushort v114, v241, s[84:87], s66 offen offset:512
    buffer_load_ushort v115, v241, s[84:87], s66 offen offset:576
    buffer_load_ushort v116, v241, s[84:87], s66 offen offset:768
    buffer_load_ushort v117, v241, s[84:87], s66 offen offset:832
    buffer_load_ushort v118, v241, s[84:87], s66 offen offset:1024
    buffer_load_ushort v119, v241, s[84:87], s66 offen offset:1088
    s_waitcnt vmcnt(0)
    s_mov_b32 s66, 15360
    buffer_load_ushort v120, v241, s[84:87], s66 offen offset:0
    buffer_load_ushort v121, v241, s[84:87], s66 offen offset:64
    buffer_load_ushort v122, v241, s[84:87], s66 offen offset:256
    buffer_load_ushort v123, v241, s[84:87], s66 offen offset:320
    buffer_load_ushort v124, v241, s[84:87], s66 offen offset:512
    buffer_load_ushort v125, v241, s[84:87], s66 offen offset:576
    buffer_load_ushort v126, v241, s[84:87], s66 offen offset:768
    buffer_load_ushort v127, v241, s[84:87], s66 offen offset:832
    buffer_load_ushort v128, v241, s[84:87], s66 offen offset:1024
    buffer_load_ushort v129, v241, s[84:87], s66 offen offset:1088
    s_waitcnt vmcnt(0)
    s_mov_b32 s66, 16640
    buffer_load_ushort v130, v241, s[84:87], s66 offen offset:0
    buffer_load_ushort v131, v241, s[84:87], s66 offen offset:64
    buffer_load_ushort v132, v241, s[84:87], s66 offen offset:256
    buffer_load_ushort v133, v241, s[84:87], s66 offen offset:320
    buffer_load_ushort v134, v241, s[84:87], s66 offen offset:512
    buffer_load_ushort v135, v241, s[84:87], s66 offen offset:576
    buffer_load_ushort v136, v241, s[84:87], s66 offen offset:768
    buffer_load_ushort v137, v241, s[84:87], s66 offen offset:832
    buffer_load_ushort v138, v241, s[84:87], s66 offen offset:1024
    buffer_load_ushort v139, v241, s[84:87], s66 offen offset:1088
    s_waitcnt vmcnt(0)
    s_mov_b32 s66, 17920
    buffer_load_ushort v140, v241, s[84:87], s66 offen offset:0
    buffer_load_ushort v141, v241, s[84:87], s66 offen offset:64
    buffer_load_ushort v142, v241, s[84:87], s66 offen offset:256
    buffer_load_ushort v143, v241, s[84:87], s66 offen offset:320
    buffer_load_ushort v144, v241, s[84:87], s66 offen offset:512
    buffer_load_ushort v145, v241, s[84:87], s66 offen offset:576
    buffer_load_ushort v146, v241, s[84:87], s66 offen offset:768
    buffer_load_ushort v147, v241, s[84:87], s66 offen offset:832
    buffer_load_ushort v148, v241, s[84:87], s66 offen offset:1024
    buffer_load_ushort v149, v241, s[84:87], s66 offen offset:1088
    s_waitcnt vmcnt(0)
    s_mov_b32 s66, 19200
    buffer_load_ushort v150, v241, s[84:87], s66 offen offset:0
    buffer_load_ushort v151, v241, s[84:87], s66 offen offset:64
    buffer_load_ushort v152, v241, s[84:87], s66 offen offset:256
    buffer_load_ushort v153, v241, s[84:87], s66 offen offset:320
    buffer_load_ushort v154, v241, s[84:87], s66 offen offset:512
    buffer_load_ushort v155, v241, s[84:87], s66 offen offset:576
    buffer_load_ushort v156, v241, s[84:87], s66 offen offset:768
    buffer_load_ushort v157, v241, s[84:87], s66 offen offset:832
    buffer_load_ushort v158, v241, s[84:87], s66 offen offset:1024
    buffer_load_ushort v159, v241, s[84:87], s66 offen offset:1088
    s_waitcnt vmcnt(0)
    v_lshlrev_b32 v0, 16, v0
    v_lshlrev_b32 v1, 16, v1
    v_lshlrev_b32 v2, 16, v2
    v_lshlrev_b32 v3, 16, v3
    v_lshlrev_b32 v4, 16, v4
    v_lshlrev_b32 v5, 16, v5
    v_lshlrev_b32 v6, 16, v6
    v_lshlrev_b32 v7, 16, v7
    v_lshlrev_b32 v8, 16, v8
    v_lshlrev_b32 v9, 16, v9
    v_lshlrev_b32 v10, 16, v10
    v_lshlrev_b32 v11, 16, v11
    v_lshlrev_b32 v12, 16, v12
    v_lshlrev_b32 v13, 16, v13
    v_lshlrev_b32 v14, 16, v14
    v_lshlrev_b32 v15, 16, v15
    v_lshlrev_b32 v16, 16, v16
    v_lshlrev_b32 v17, 16, v17
    v_lshlrev_b32 v18, 16, v18
    v_lshlrev_b32 v19, 16, v19
    v_lshlrev_b32 v20, 16, v20
    v_lshlrev_b32 v21, 16, v21
    v_lshlrev_b32 v22, 16, v22
    v_lshlrev_b32 v23, 16, v23
    v_lshlrev_b32 v24, 16, v24
    v_lshlrev_b32 v25, 16, v25
    v_lshlrev_b32 v26, 16, v26
    v_lshlrev_b32 v27, 16, v27
    v_lshlrev_b32 v28, 16, v28
    v_lshlrev_b32 v29, 16, v29
    v_lshlrev_b32 v30, 16, v30
    v_lshlrev_b32 v31, 16, v31
    v_lshlrev_b32 v32, 16, v32
    v_lshlrev_b32 v33, 16, v33
    v_lshlrev_b32 v34, 16, v34
    v_lshlrev_b32 v35, 16, v35
    v_lshlrev_b32 v36, 16, v36
    v_lshlrev_b32 v37, 16, v37
    v_lshlrev_b32 v38, 16, v38
    v_lshlrev_b32 v39, 16, v39
    v_lshlrev_b32 v40, 16, v40
    v_lshlrev_b32 v41, 16, v41
    v_lshlrev_b32 v42, 16, v42
    v_lshlrev_b32 v43, 16, v43
    v_lshlrev_b32 v44, 16, v44
    v_lshlrev_b32 v45, 16, v45
    v_lshlrev_b32 v46, 16, v46
    v_lshlrev_b32 v47, 16, v47
    v_lshlrev_b32 v48, 16, v48
    v_lshlrev_b32 v49, 16, v49
    v_lshlrev_b32 v50, 16, v50
    v_lshlrev_b32 v51, 16, v51
    v_lshlrev_b32 v52, 16, v52
    v_lshlrev_b32 v53, 16, v53
    v_lshlrev_b32 v54, 16, v54
    v_lshlrev_b32 v55, 16, v55
    v_lshlrev_b32 v56, 16, v56
    v_lshlrev_b32 v57, 16, v57
    v_lshlrev_b32 v58, 16, v58
    v_lshlrev_b32 v59, 16, v59
    v_lshlrev_b32 v60, 16, v60
    v_lshlrev_b32 v61, 16, v61
    v_lshlrev_b32 v62, 16, v62
    v_lshlrev_b32 v63, 16, v63
    v_lshlrev_b32 v64, 16, v64
    v_lshlrev_b32 v65, 16, v65
    v_lshlrev_b32 v66, 16, v66
    v_lshlrev_b32 v67, 16, v67
    v_lshlrev_b32 v68, 16, v68
    v_lshlrev_b32 v69, 16, v69
    v_lshlrev_b32 v70, 16, v70
    v_lshlrev_b32 v71, 16, v71
    v_lshlrev_b32 v72, 16, v72
    v_lshlrev_b32 v73, 16, v73
    v_lshlrev_b32 v74, 16, v74
    v_lshlrev_b32 v75, 16, v75
    v_lshlrev_b32 v76, 16, v76
    v_lshlrev_b32 v77, 16, v77
    v_lshlrev_b32 v78, 16, v78
    v_lshlrev_b32 v79, 16, v79
    v_lshlrev_b32 v80, 16, v80
    v_lshlrev_b32 v81, 16, v81
    v_lshlrev_b32 v82, 16, v82
    v_lshlrev_b32 v83, 16, v83
    v_lshlrev_b32 v84, 16, v84
    v_lshlrev_b32 v85, 16, v85
    v_lshlrev_b32 v86, 16, v86
    v_lshlrev_b32 v87, 16, v87
    v_lshlrev_b32 v88, 16, v88
    v_lshlrev_b32 v89, 16, v89
    v_lshlrev_b32 v90, 16, v90
    v_lshlrev_b32 v91, 16, v91
    v_lshlrev_b32 v92, 16, v92
    v_lshlrev_b32 v93, 16, v93
    v_lshlrev_b32 v94, 16, v94
    v_lshlrev_b32 v95, 16, v95
    v_lshlrev_b32 v96, 16, v96
    v_lshlrev_b32 v97, 16, v97
    v_lshlrev_b32 v98, 16, v98
    v_lshlrev_b32 v99, 16, v99
    v_lshlrev_b32 v100, 16, v100
    v_lshlrev_b32 v101, 16, v101
    v_lshlrev_b32 v102, 16, v102
    v_lshlrev_b32 v103, 16, v103
    v_lshlrev_b32 v104, 16, v104
    v_lshlrev_b32 v105, 16, v105
    v_lshlrev_b32 v106, 16, v106
    v_lshlrev_b32 v107, 16, v107
    v_lshlrev_b32 v108, 16, v108
    v_lshlrev_b32 v109, 16, v109
    v_lshlrev_b32 v110, 16, v110
    v_lshlrev_b32 v111, 16, v111
    v_lshlrev_b32 v112, 16, v112
    v_lshlrev_b32 v113, 16, v113
    v_lshlrev_b32 v114, 16, v114
    v_lshlrev_b32 v115, 16, v115
    v_lshlrev_b32 v116, 16, v116
    v_lshlrev_b32 v117, 16, v117
    v_lshlrev_b32 v118, 16, v118
    v_lshlrev_b32 v119, 16, v119
    v_lshlrev_b32 v120, 16, v120
    v_lshlrev_b32 v121, 16, v121
    v_lshlrev_b32 v122, 16, v122
    v_lshlrev_b32 v123, 16, v123
    v_lshlrev_b32 v124, 16, v124
    v_lshlrev_b32 v125, 16, v125
    v_lshlrev_b32 v126, 16, v126
    v_lshlrev_b32 v127, 16, v127
    v_lshlrev_b32 v128, 16, v128
    v_lshlrev_b32 v129, 16, v129
    v_lshlrev_b32 v130, 16, v130
    v_lshlrev_b32 v131, 16, v131
    v_lshlrev_b32 v132, 16, v132
    v_lshlrev_b32 v133, 16, v133
    v_lshlrev_b32 v134, 16, v134
    v_lshlrev_b32 v135, 16, v135
    v_lshlrev_b32 v136, 16, v136
    v_lshlrev_b32 v137, 16, v137
    v_lshlrev_b32 v138, 16, v138
    v_lshlrev_b32 v139, 16, v139
    v_lshlrev_b32 v140, 16, v140
    v_lshlrev_b32 v141, 16, v141
    v_lshlrev_b32 v142, 16, v142
    v_lshlrev_b32 v143, 16, v143
    v_lshlrev_b32 v144, 16, v144
    v_lshlrev_b32 v145, 16, v145
    v_lshlrev_b32 v146, 16, v146
    v_lshlrev_b32 v147, 16, v147
    v_lshlrev_b32 v148, 16, v148
    v_lshlrev_b32 v149, 16, v149
    v_lshlrev_b32 v150, 16, v150
    v_lshlrev_b32 v151, 16, v151
    v_lshlrev_b32 v152, 16, v152
    v_lshlrev_b32 v153, 16, v153
    v_lshlrev_b32 v154, 16, v154
    v_lshlrev_b32 v155, 16, v155
    v_lshlrev_b32 v156, 16, v156
    v_lshlrev_b32 v157, 16, v157
    v_lshlrev_b32 v158, 16, v158
    v_lshlrev_b32 v159, 16, v159
    s_mov_b32 s50, 0
SL_node:
    s_mul_i32 s34, s2, 40
    s_mul_i32 s66, s20, 5
    s_add_u32 s66, s66, s50
    s_add_u32 s34, s34, s66
    v_mov_b32 v160, 0
    v_mov_b32 v161, 0
    v_mov_b32 v162, 0
    v_mov_b32 v163, 0
    v_mov_b32 v164, 0
    v_mov_b32 v165, 0
    v_mov_b32 v166, 0
    v_mov_b32 v167, 0
    v_mov_b32 v168, 0
    v_mov_b32 v169, 0
    v_mov_b32 v170, 0
    v_mov_b32 v171, 0
    v_mov_b32 v172, 0
    v_mov_b32 v173, 0
    v_mov_b32 v174, 0
    v_mov_b32 v175, 0
    v_mov_b32 v176, 0
    v_mov_b32 v177, 0
    v_mov_b32 v178, 0
    v_mov_b32 v179, 0
    v_mov_b32 v180, 0
    v_mov_b32 v181, 0
    s_mov_b32 s35, 0
SL_scan:
    s_lshl_b32 s66, s35, 2
    buffer_load_dwordx4 v[236:239], v245, s[72:75], s66 offen
    s_waitcnt vmcnt(0)
    v_cmp_eq_u32 s[38:39], s34, v236
    v_cmp_eq_u32 s[40:41], s34, v237
    v_cmp_eq_u32 s[42:43], s34, v238
    v_cmp_eq_u32 s[44:45], s34, v239
    s_mov_b32 s36, 0
SL_bits:
    s_cmp_eq_u64 s[38:39], 0
    s_cbranch_scc1 SL_nexti
    s_ff1_i32_b64 s66, s[38:39]
    s_bitset0_b64 s[38:39], s66
    s_lshl_b32 s66, s66, 2
    s_add_u32 s37, s66, s36
    s_add_u32 s37, s37, s35
    s_lshl_b32 s66, s37, 2
    s_lshl_b32 s67, s37, 5
    s_mul_i32 s68, s37, 6
    buffer_load_dword v243, v242, s[76:79], s66 offen
    buffer_load_dwordx4 v[184:187], v242, s[12:15], s67 offen
    buffer_load_dwordx4 v[188:191], v242, s[12:15], s67 offen offset:16
    buffer_load_ushort v226, v242, s[80:83], s68 offen offset:0
    buffer_load_ushort v227, v242, s[80:83], s68 offen offset:2
    buffer_load_ushort v228, v242, s[80:83], s68 offen offset:4
    s_waitcnt vmcnt(5)
    v_lshl_add_u32 v243, v243, 10, v241
    buffer_load_ushort v208, v243, s[4:7], 0 offen offset:0
    buffer_load_ushort v209, v243, s[4:7], 0 offen offset:64
    buffer_load_ushort v210, v243, s[4:7], 0 offen offset:256
    buffer_load_ushort v211, v243, s[4:7], 0 offen offset:320
    buffer_load_ushort v212, v243, s[4:7], 0 offen offset:512
    buffer_load_ushort v213, v243, s[4:7], 0 offen offset:576
    buffer_load_ushort v214, v243, s[4:7], 0 offen offset:768
    buffer_load_ushort v215, v243, s[4:7], 0 offen offset:832
    s_waitcnt vmcnt(8)
    v_lshlrev_b32 v192, 16, v184
    v_and_b32 v193, 0xffff0000, v184
    v_lshlrev_b32 v194, 16, v185
    v_and_b32 v195, 0xffff0000, v185
    v_lshlrev_b32 v196, 16, v186
    v_and_b32 v197, 0xffff0000, v186
    v_lshlrev_b32 v198, 16, v187
    v_and_b32 v199, 0xffff0000, v187
    v_lshlrev_b32 v200, 16, v188
    v_and_b32 v201, 0xffff0000, v188
    v_lshlrev_b32 v202, 16, v189
    v_and_b32 v203, 0xffff0000, v189
    v_lshlrev_b32 v204, 16, v190
    v_and_b32 v205, 0xffff0000, v190
    v_lshlrev_b32 v206, 16, v191
    v_and_b32 v207, 0xffff0000, v191
    v_lshlrev_b32 v226, 16, v226
    v_lshlrev_b32 v227, 16, v227
    v_lshlrev_b32 v228, 16, v228
    v_mul_f32 v216, v192, v0
    v_mul_f32 v217, v192, v1
    v_mul_f32 v218, v192, v2
    v_mul_f32 v219, v192, v3
    v_mul_f32 v220, v192, v4
    v_mul_f32 v221, v192, v5
    v_mul_f32 v222, v192, v6
    v_mul_f32 v223, v192, v7
    v_mul_f32 v224, v192, v8
    v_mul_f32 v225, v192, v9
    v_fmac_f32 v216, v193, v10
    v_fmac_f32 v217, v193, v11
    v_fmac_f32 v218, v193, v12
    v_fmac_f32 v219, v193, v13
    v_fmac_f32 v220, v193, v14
    v_fmac_f32 v221, v193, v15
    v_fmac_f32 v222, v193, v16
    v_fmac_f32 v223, v193, v17
    v_fmac_f32 v224, v193, v18
    v_fmac_f32 v225, v193, v19
    v_fmac_f32 v216, v194, v20
    v_fmac_f32 v217, v194, v21
    v_fmac_f32 v218, v194, v22
    v_fmac_f32 v219, v194, v23
    v_fmac_f32 v220, v194, v24
    v_fmac_f32 v221, v194, v25
    v_fmac_f32 v222, v194, v26
    v_fmac_f32 v223, v194, v27
    v_fmac_f32 v224, v194, v28
    v_fmac_f32 v225, v194, v29
    v_fmac_f32 v216, v195, v30
    v_fmac_f32 v217, v195, v31
    v_fmac_f32 v218, v195, v32
    v_fmac_f32 v219, v195, v33
    v_fmac_f32 v220, v195, v34
    v_fmac_f32 v221, v195, v35
    v_fmac_f32 v222, v195, v36
    v_fmac_f32 v223, v195, v37
    v_fmac_f32 v224, v195, v38
    v_fmac_f32 v225, v195, v39
    v_fmac_f32 v216, v196, v40
    v_fmac_f32 v217, v196, v41
    v_fmac_f32 v218, v196, v42
    v_fmac_f32 v219, v196, v43
    v_fmac_f32 v220, v196, v44
    v_fmac_f32 v221, v196, v45
    v_fmac_f32 v222, v196, v46
    v_fmac_f32 v223, v196, v47
    v_fmac_f32 v224, v196, v48
    v_fmac_f32 v225, v196, v49
    v_fmac_f32 v216, v197, v50
    v_fmac_f32 v217, v197, v51
    v_fmac_f32 v218, v197, v52
    v_fmac_f32 v219, v197, v53
    v_fmac_f32 v220, v197, v54
    v_fmac_f32 v221, v197, v55
    v_fmac_f32 v222, v197, v56
    v_fmac_f32 v223, v197, v57
    v_fmac_f32 v224, v197, v58
    v_fmac_f32 v225, v197, v59
    v_fmac_f32 v216, v198, v60
    v_fmac_f32 v217, v198, v61
    v_fmac_f32 v218, v198, v62
    v_fmac_f32 v219, v198, v63
    v_fmac_f32 v220, v198, v64
    v_fmac_f32 v221, v198, v65
    v_fmac_f32 v222, v198, v66
    v_fmac_f32 v223, v198, v67
    v_fmac_f32 v224, v198, v68
    v_fmac_f32 v225, v198, v69
    v_fmac_f32 v216, v199, v70
    v_fmac_f32 v217, v199, v71
    v_fmac_f32 v218, v199, v72
    v_fmac_f32 v219, v199, v73
    v_fmac_f32 v220, v199, v74
    v_fmac_f32 v221, v199, v75
    v_fmac_f32 v222, v199, v76
    v_fmac_f32 v223, v199, v77
    v_fmac_f32 v224, v199, v78
    v_fmac_f32 v225, v199, v79
    v_fmac_f32 v216, v200, v80
    v_fmac_f32 v217, v200, v81
    v_fmac_f32 v218, v200, v82
    v_fmac_f32 v219, v200, v83
    v_fmac_f32 v220, v200, v84
    v_fmac_f32 v221, v200, v85
    v_fmac_f32 v222, v200, v86
    v_fmac_f32 v223, v200, v87
    v_fmac_f32 v224, v200, v88
    v_fmac_f32 v225, v200, v89
    v_fmac_f32 v216, v201, v90
    v_fmac_f32 v217, v201, v91
    v_fmac_f32 v218, v201, v92
    v_fmac_f32 v219, v201, v93
    v_fmac_f32 v220, v201, v94
    v_fmac_f32 v221, v201, v95
    v_fmac_f32 v222, v201, v96
    v_fmac_f32 v223, v201, v97
    v_fmac_f32 v224, v201, v98
    v_fmac_f32 v225, v201, v99
    v_fmac_f32 v216, v202, v100
    v_fmac_f32 v217, v202, v101
    v_fmac_f32 v218, v202, v102
    v_fmac_f32 v219, v202, v103
    v_fmac_f32 v220, v202, v104
    v_fmac_f32 v221, v202, v105
    v_fmac_f32 v222, v202, v106
    v_fmac_f32 v223, v202, v107
    v_fmac_f32 v224, v202, v108
    v_fmac_f32 v225, v202, v109
    v_fmac_f32 v216, v203, v110
    v_fmac_f32 v217, v203, v111
    v_fmac_f32 v218, v203, v112
    v_fmac_f32 v219, v203, v113
    v_fmac_f32 v220, v203, v114
    v_fmac_f32 v221, v203, v115
    v_fmac_f32 v222, v203, v116
    v_fmac_f32 v223, v203, v117
    v_fmac_f32 v224, v203, v118
    v_fmac_f32 v225, v203, v119
    v_fmac_f32 v216, v204, v120
    v_fmac_f32 v217, v204, v121
    v_fmac_f32 v218, v204, v122
    v_fmac_f32 v219, v204, v123
    v_fmac_f32 v220, v204, v124
    v_fmac_f32 v221, v204, v125
    v_fmac_f32 v222, v204, v126
    v_fmac_f32 v223, v204, v127
    v_fmac_f32 v224, v204, v128
    v_fmac_f32 v225, v204, v129
    v_fmac_f32 v216, v205, v130
    v_fmac_f32 v217, v205, v131
    v_fmac_f32 v218, v205, v132
    v_fmac_f32 v219, v205, v133
    v_fmac_f32 v220, v205, v134
    v_fmac_f32 v221, v205, v135
    v_fmac_f32 v222, v205, v136
    v_fmac_f32 v223, v205, v137
    v_fmac_f32 v224, v205, v138
    v_fmac_f32 v225, v205, v139
    v_fmac_f32 v216, v206, v140
    v_fmac_f32 v217, v206, v141
    v_fmac_f32 v218, v206, v142
    v_fmac_f32 v219, v206, v143
    v_fmac_f32 v220, v206, v144
    v_fmac_f32 v221, v206, v145
    v_fmac_f32 v222, v206, v146
    v_fmac_f32 v223, v206, v147
    v_fmac_f32 v224, v206, v148
    v_fmac_f32 v225, v206, v149
    v_fmac_f32 v216, v207, v150
    v_fmac_f32 v217, v207, v151
    v_fmac_f32 v218, v207, v152
    v_fmac_f32 v219, v207, v153
    v_fmac_f32 v220, v207, v154
    v_fmac_f32 v221, v207, v155
    v_fmac_f32 v222, v207, v156
    v_fmac_f32 v223, v207, v157
    v_fmac_f32 v224, v207, v158
    v_fmac_f32 v225, v207, v159
    s_waitcnt vmcnt(0)
    v_lshlrev_b32 v208, 16, v208
    v_lshlrev_b32 v209, 16, v209
    v_lshlrev_b32 v210, 16, v210
    v_lshlrev_b32 v211, 16, v211
    v_lshlrev_b32 v212, 16, v212
    v_lshlrev_b32 v213, 16, v213
    v_lshlrev_b32 v214, 16, v214
    v_lshlrev_b32 v215, 16, v215
    v_fmac_f32 v160, v208, v216
    v_mul_f32 v229, v210, v226
    v_fmac_f32 v229, v212, v227
    v_fmac_f32 v229, v214, v228
    v_fmac_f32 v176, v229, v218
    v_mul_f32 v229, v208, v220
    v_fmac_f32 v162, v229, v226
    v_fmac_f32 v168, v210, v222
    v_mul_f32 v230, v227, v214
    v_fma_f32 v230, -v228, v212, v230
    v_fmac_f32 v178, v230, v224
    v_fmac_f32 v164, v229, v227
    v_fmac_f32 v170, v212, v222
    v_mul_f32 v230, v228, v210
    v_fma_f32 v230, -v226, v214, v230
    v_fmac_f32 v180, v230, v224
    v_fmac_f32 v166, v229, v228
    v_fmac_f32 v172, v214, v222
    v_mul_f32 v230, v226, v212
    v_fma_f32 v230, -v227, v210, v230
    v_fmac_f32 v174, v230, v224
    v_fmac_f32 v161, v209, v217
    v_mul_f32 v229, v211, v226
    v_fmac_f32 v229, v213, v227
    v_fmac_f32 v229, v215, v228
    v_fmac_f32 v177, v229, v219
    v_mul_f32 v229, v209, v221
    v_fmac_f32 v163, v229, v226
    v_fmac_f32 v169, v211, v223
    v_mul_f32 v230, v227, v215
    v_fma_f32 v230, -v228, v213, v230
    v_fmac_f32 v179, v230, v225
    v_fmac_f32 v165, v229, v227
    v_fmac_f32 v171, v213, v223
    v_mul_f32 v230, v228, v211
    v_fma_f32 v230, -v226, v215, v230
    v_fmac_f32 v181, v230, v225
    v_fmac_f32 v167, v229, v228
    v_fmac_f32 v173, v215, v223
    v_mul_f32 v230, v226, v213
    v_fma_f32 v230, -v227, v211, v230
    v_fmac_f32 v175, v230, v225
    s_branch SL_bits
SL_nexti:
    s_mov_b64 s[38:39], s[40:41]
    s_mov_b64 s[40:41], s[42:43]
    s_mov_b64 s[42:43], s[44:45]
    s_add_u32 s36, s36, 1
    s_cmp_lt_u32 s36, 4
    s_cbranch_scc1 SL_bits
    s_add_u32 s35, s35, 256
    s_cmp_lt_u32 s35, 320000
    s_cbranch_scc1 SL_scan
    s_mul_i32 s66, s20, 5
    s_add_u32 s66, s66, s50
    s_lshl_b32 s67, s66, 4
    s_and_b32 s68, s67, 128
    s_and_b32 s67, s67, 0x70
    s_mul_i32 s69, s50, 1536
    s_add_u32 s69, s69, s21
    s_add_u32 s69, s69, s68
    s_mul_i32 s70, s66, 1536
    s_add_u32 s70, s70, 86016
    s_add_u32 s70, s70, s68
    v_mov_b32 v230, s69
    v_mov_b32 v231, s70
    v_cmp_gt_u32 vcc, 32, v240
    v_and_b32 v229, 31, v240
    v_lshlrev_b32 v229, 2, v229
    v_xor_b32 v229, s67, v229
    v_cndmask_b32 v244, v231, v230, vcc
    v_add_u32 v244, v244, v229
    v_cvt_pk_bf16_f32 v160, v160, v161
    ds_write_b32 v244, v160 offset:0
    v_cvt_pk_bf16_f32 v162, v162, v163
    ds_write_b32 v244, v162 offset:128
    v_cvt_pk_bf16_f32 v164, v164, v165
    ds_write_b32 v244, v164 offset:256
    v_cvt_pk_bf16_f32 v166, v166, v167
    ds_write_b32 v244, v166 offset:384
    v_cvt_pk_bf16_f32 v168, v168, v169
    ds_write_b32 v244, v168 offset:512
    v_cvt_pk_bf16_f32 v170, v170, v171
    ds_write_b32 v244, v170 offset:640
    v_cvt_pk_bf16_f32 v172, v172, v173
    ds_write_b32 v244, v172 offset:768
    v_cvt_pk_bf16_f32 v174, v174, v175
    ds_write_b32 v244, v174 offset:896
    v_cvt_pk_bf16_f32 v176, v176, v177
    ds_write_b32 v244, v176 offset:1024
    v_cvt_pk_bf16_f32 v178, v178, v179
    ds_write_b32 v244, v178 offset:1152
    v_cvt_pk_bf16_f32 v180, v180, v181
    ds_write_b32 v244, v180 offset:1280
    s_lshl_b32 s66, s66, 3
    s_add_u32 s66, s66, 163328
    v_mov_b32 v229, s66
    ds_write_b64 v229, v[230:231]
    s_add_u32 s50, s50, 1
    s_cmp_lt_u32 s50, 5
    s_cbranch_scc1 SL_node
    s_waitcnt lgkmcnt(0)
    s_barrier
    v_mov_b32 v176, v240
    s_load_dwordx4 s[84:87], s[0:1], 48
    s_mul_i32 s22, s20, 20
    s_waitcnt lgkmcnt(0)
    s_mul_i32 s24, s22, 3277
    s_lshr_b32 s24, s24, 16
    s_mul_i32 s68, s24, 20
    s_sub_u32 s68, s22, s68
    s_cmp_lt_u32 s68, 8
    s_cselect_b64 s[66:67], s[84:85], s[86:87]
    s_cselect_b32 s25, 0, 8
    s_sub_u32 s68, s68, s25
    s_and_b32 s25, s68, 1
    s_lshr_b32 s68, s68, 1
    s_lshl_b32 s68, s68, 14
    s_lshl_b32 s25, s25, 12
    s_add_u32 s68, s68, s25
    s_lshl_b32 s24, s24, 5
    s_add_u32 s68, s68, s24
    v_lshrrev_b32 v2, 4, v176
    v_lshlrev_b32 v2, 10, v2
    v_and_b32 v3, 15, v176
    v_lshl_add_u32 v2, v3, 1, v2
    v_add_u32 v2, s68, v2
    v_add_u32 v3, 8192, v2
    v_mov_b32 v4, 0
    v_mov_b32 v5, 0
    v_mov_b32 v6, 0
    v_mov_b32 v7, 0
    global_load_ushort v96, v2, s[66:67] offset:0
    global_load_short_d16_hi v4, v3, s[66:67] offset:0
    global_load_ushort v97, v2, s[66:67] offset:256
    global_load_short_d16_hi v5, v3, s[66:67] offset:256
    global_load_ushort v98, v2, s[66:67] offset:512
    global_load_short_d16_hi v6, v3, s[66:67] offset:512
    global_load_ushort v99, v2, s[66:67] offset:768
    global_load_short_d16_hi v7, v3, s[66:67] offset:768
    s_add_u32 s22, s22, 1
    s_waitcnt vmcnt(0)
    v_or_b32 v96, v96, v4
    v_or_b32 v97, v97, v5
    v_or_b32 v98, v98, v6
    v_or_b32 v99, v99, v7
    s_mul_i32 s24, s22, 3277
    s_lshr_b32 s24, s24, 16
    s_mul_i32 s68, s24, 20
    s_sub_u32 s68, s22, s68
    s_cmp_lt_u32 s68, 8
    s_cselect_b64 s[66:67], s[84:85], s[86:87]
    s_cselect_b32 s25, 0, 8
    s_sub_u32 s68, s68, s25
    s_and_b32 s25, s68, 1
    s_lshr_b32 s68, s68, 1
    s_lshl_b32 s68, s68, 14
    s_lshl_b32 s25, s25, 12
    s_add_u32 s68, s68, s25
    s_lshl_b32 s24, s24, 5
    s_add_u32 s68, s68, s24
    v_lshrrev_b32 v2, 4, v176
    v_lshlrev_b32 v2, 10, v2
    v_and_b32 v3, 15, v176
    v_lshl_add_u32 v2, v3, 1, v2
    v_add_u32 v2, s68, v2
    v_add_u32 v3, 8192, v2
    v_mov_b32 v4, 0
    v_mov_b32 v5, 0
    v_mov_b32 v6, 0
    v_mov_b32 v7, 0
    global_load_ushort v100, v2, s[66:67] offset:0
    global_load_short_d16_hi v4, v3, s[66:67] offset:0
    global_load_ushort v101, v2, s[66:67] offset:256
    global_load_short_d16_hi v5, v3, s[66:67] offset:256
    global_load_ushort v102, v2, s[66:67] offset:512
    global_load_short_d16_hi v6, v3, s[66:67] offset:512
    global_load_ushort v103, v2, s[66:67] offset:768
    global_load_short_d16_hi v7, v3, s[66:67] offset:768
    s_add_u32 s22, s22, 1
    s_waitcnt vmcnt(0)
    v_or_b32 v100, v100, v4
    v_or_b32 v101, v101, v5
    v_or_b32 v102, v102, v6
    v_or_b32 v103, v103, v7
    s_mul_i32 s24, s22, 3277
    s_lshr_b32 s24, s24, 16
    s_mul_i32 s68, s24, 20
    s_sub_u32 s68, s22, s68
    s_cmp_lt_u32 s68, 8
    s_cselect_b64 s[66:67], s[84:85], s[86:87]
    s_cselect_b32 s25, 0, 8
    s_sub_u32 s68, s68, s25
    s_and_b32 s25, s68, 1
    s_lshr_b32 s68, s68, 1
    s_lshl_b32 s68, s68, 14
    s_lshl_b32 s25, s25, 12
    s_add_u32 s68, s68, s25
    s_lshl_b32 s24, s24, 5
    s_add_u32 s68, s68, s24
    v_lshrrev_b32 v2, 4, v176
    v_lshlrev_b32 v2, 10, v2
    v_and_b32 v3, 15, v176
    v_lshl_add_u32 v2, v3, 1, v2
    v_add_u32 v2, s68, v2
    v_add_u32 v3, 8192, v2
    v_mov_b32 v4, 0
    v_mov_b32 v5, 0
    v_mov_b32 v6, 0
    v_mov_b32 v7, 0
    global_load_ushort v104, v2, s[66:67] offset:0
    global_load_short_d16_hi v4, v3, s[66:67] offset:0
    global_load_ushort v105, v2, s[66:67] offset:256
    global_load_short_d16_hi v5, v3, s[66:67] offset:256
    global_load_ushort v106, v2, s[66:67] offset:512
    global_load_short_d16_hi v6, v3, s[66:67] offset:512
    global_load_ushort v107, v2, s[66:67] offset:768
    global_load_short_d16_hi v7, v3, s[66:67] offset:768
    s_add_u32 s22, s22, 1
    s_waitcnt vmcnt(0)
    v_or_b32 v104, v104, v4
    v_or_b32 v105, v105, v5
    v_or_b32 v106, v106, v6
    v_or_b32 v107, v107, v7
    s_mul_i32 s24, s22, 3277
    s_lshr_b32 s24, s24, 16
    s_mul_i32 s68, s24, 20
    s_sub_u32 s68, s22, s68
    s_cmp_lt_u32 s68, 8
    s_cselect_b64 s[66:67], s[84:85], s[86:87]
    s_cselect_b32 s25, 0, 8
    s_sub_u32 s68, s68, s25
    s_and_b32 s25, s68, 1
    s_lshr_b32 s68, s68, 1
    s_lshl_b32 s68, s68, 14
    s_lshl_b32 s25, s25, 12
    s_add_u32 s68, s68, s25
    s_lshl_b32 s24, s24, 5
    s_add_u32 s68, s68, s24
    v_lshrrev_b32 v2, 4, v176
    v_lshlrev_b32 v2, 10, v2
    v_and_b32 v3, 15, v176
    v_lshl_add_u32 v2, v3, 1, v2
    v_add_u32 v2, s68, v2
    v_add_u32 v3, 8192, v2
    v_mov_b32 v4, 0
    v_mov_b32 v5, 0
    v_mov_b32 v6, 0
    v_mov_b32 v7, 0
    global_load_ushort v108, v2, s[66:67] offset:0
    global_load_short_d16_hi v4, v3, s[66:67] offset:0
    global_load_ushort v109, v2, s[66:67] offset:256
    global_load_short_d16_hi v5, v3, s[66:67] offset:256
    global_load_ushort v110, v2, s[66:67] offset:512
    global_load_short_d16_hi v6, v3, s[66:67] offset:512
    global_load_ushort v111, v2, s[66:67] offset:768
    global_load_short_d16_hi v7, v3, s[66:67] offset:768
    s_add_u32 s22, s22, 1
    s_waitcnt vmcnt(0)
    v_or_b32 v108, v108, v4
    v_or_b32 v109, v109, v5
    v_or_b32 v110, v110, v6
    v_or_b32 v111, v111, v7
    s_mul_i32 s24, s22, 3277
    s_lshr_b32 s24, s24, 16
    s_mul_i32 s68, s24, 20
    s_sub_u32 s68, s22, s68
    s_cmp_lt_u32 s68, 8
    s_cselect_b64 s[66:67], s[84:85], s[86:87]
    s_cselect_b32 s25, 0, 8
    s_sub_u32 s68, s68, s25
    s_and_b32 s25, s68, 1
    s_lshr_b32 s68, s68, 1
    s_lshl_b32 s68, s68, 14
    s_lshl_b32 s25, s25, 12
    s_add_u32 s68, s68, s25
    s_lshl_b32 s24, s24, 5
    s_add_u32 s68, s68, s24
    v_lshrrev_b32 v2, 4, v176
    v_lshlrev_b32 v2, 10, v2
    v_and_b32 v3, 15, v176
    v_lshl_add_u32 v2, v3, 1, v2
    v_add_u32 v2, s68, v2
    v_add_u32 v3, 8192, v2
    v_mov_b32 v4, 0
    v_mov_b32 v5, 0
    v_mov_b32 v6, 0
    v_mov_b32 v7, 0
    global_load_ushort v112, v2, s[66:67] offset:0
    global_load_short_d16_hi v4, v3, s[66:67] offset:0
    global_load_ushort v113, v2, s[66:67] offset:256
    global_load_short_d16_hi v5, v3, s[66:67] offset:256
    global_load_ushort v114, v2, s[66:67] offset:512
    global_load_short_d16_hi v6, v3, s[66:67] offset:512
    global_load_ushort v115, v2, s[66:67] offset:768
    global_load_short_d16_hi v7, v3, s[66:67] offset:768
    s_add_u32 s22, s22, 1
    s_waitcnt vmcnt(0)
    v_or_b32 v112, v112, v4
    v_or_b32 v113, v113, v5
    v_or_b32 v114, v114, v6
    v_or_b32 v115, v115, v7
    s_mul_i32 s24, s22, 3277
    s_lshr_b32 s24, s24, 16
    s_mul_i32 s68, s24, 20
    s_sub_u32 s68, s22, s68
    s_cmp_lt_u32 s68, 8
    s_cselect_b64 s[66:67], s[84:85], s[86:87]
    s_cselect_b32 s25, 0, 8
    s_sub_u32 s68, s68, s25
    s_and_b32 s25, s68, 1
    s_lshr_b32 s68, s68, 1
    s_lshl_b32 s68, s68, 14
    s_lshl_b32 s25, s25, 12
    s_add_u32 s68, s68, s25
    s_lshl_b32 s24, s24, 5
    s_add_u32 s68, s68, s24
    v_lshrrev_b32 v2, 4, v176
    v_lshlrev_b32 v2, 10, v2
    v_and_b32 v3, 15, v176
    v_lshl_add_u32 v2, v3, 1, v2
    v_add_u32 v2, s68, v2
    v_add_u32 v3, 8192, v2
    v_mov_b32 v4, 0
    v_mov_b32 v5, 0
    v_mov_b32 v6, 0
    v_mov_b32 v7, 0
    global_load_ushort v116, v2, s[66:67] offset:0
    global_load_short_d16_hi v4, v3, s[66:67] offset:0
    global_load_ushort v117, v2, s[66:67] offset:256
    global_load_short_d16_hi v5, v3, s[66:67] offset:256
    global_load_ushort v118, v2, s[66:67] offset:512
    global_load_short_d16_hi v6, v3, s[66:67] offset:512
    global_load_ushort v119, v2, s[66:67] offset:768
    global_load_short_d16_hi v7, v3, s[66:67] offset:768
    s_add_u32 s22, s22, 1
    s_waitcnt vmcnt(0)
    v_or_b32 v116, v116, v4
    v_or_b32 v117, v117, v5
    v_or_b32 v118, v118, v6
    v_or_b32 v119, v119, v7
    s_mul_i32 s24, s22, 3277
    s_lshr_b32 s24, s24, 16
    s_mul_i32 s68, s24, 20
    s_sub_u32 s68, s22, s68
    s_cmp_lt_u32 s68, 8
    s_cselect_b64 s[66:67], s[84:85], s[86:87]
    s_cselect_b32 s25, 0, 8
    s_sub_u32 s68, s68, s25
    s_and_b32 s25, s68, 1
    s_lshr_b32 s68, s68, 1
    s_lshl_b32 s68, s68, 14
    s_lshl_b32 s25, s25, 12
    s_add_u32 s68, s68, s25
    s_lshl_b32 s24, s24, 5
    s_add_u32 s68, s68, s24
    v_lshrrev_b32 v2, 4, v176
    v_lshlrev_b32 v2, 10, v2
    v_and_b32 v3, 15, v176
    v_lshl_add_u32 v2, v3, 1, v2
    v_add_u32 v2, s68, v2
    v_add_u32 v3, 8192, v2
    v_mov_b32 v4, 0
    v_mov_b32 v5, 0
    v_mov_b32 v6, 0
    v_mov_b32 v7, 0
    global_load_ushort v120, v2, s[66:67] offset:0
    global_load_short_d16_hi v4, v3, s[66:67] offset:0
    global_load_ushort v121, v2, s[66:67] offset:256
    global_load_short_d16_hi v5, v3, s[66:67] offset:256
    global_load_ushort v122, v2, s[66:67] offset:512
    global_load_short_d16_hi v6, v3, s[66:67] offset:512
    global_load_ushort v123, v2, s[66:67] offset:768
    global_load_short_d16_hi v7, v3, s[66:67] offset:768
    s_add_u32 s22, s22, 1
    s_waitcnt vmcnt(0)
    v_or_b32 v120, v120, v4
    v_or_b32 v121, v121, v5
    v_or_b32 v122, v122, v6
    v_or_b32 v123, v123, v7
    s_mul_i32 s24, s22, 3277
    s_lshr_b32 s24, s24, 16
    s_mul_i32 s68, s24, 20
    s_sub_u32 s68, s22, s68
    s_cmp_lt_u32 s68, 8
    s_cselect_b64 s[66:67], s[84:85], s[86:87]
    s_cselect_b32 s25, 0, 8
    s_sub_u32 s68, s68, s25
    s_and_b32 s25, s68, 1
    s_lshr_b32 s68, s68, 1
    s_lshl_b32 s68, s68, 14
    s_lshl_b32 s25, s25, 12
    s_add_u32 s68, s68, s25
    s_lshl_b32 s24, s24, 5
    s_add_u32 s68, s68, s24
    v_lshrrev_b32 v2, 4, v176
    v_lshlrev_b32 v2, 10, v2
    v_and_b32 v3, 15, v176
    v_lshl_add_u32 v2, v3, 1, v2
    v_add_u32 v2, s68, v2
    v_add_u32 v3, 8192, v2
    v_mov_b32 v4, 0
    v_mov_b32 v5, 0
    v_mov_b32 v6, 0
    v_mov_b32 v7, 0
    global_load_ushort v124, v2, s[66:67] offset:0
    global_load_short_d16_hi v4, v3, s[66:67] offset:0
    global_load_ushort v125, v2, s[66:67] offset:256
    global_load_short_d16_hi v5, v3, s[66:67] offset:256
    global_load_ushort v126, v2, s[66:67] offset:512
    global_load_short_d16_hi v6, v3, s[66:67] offset:512
    global_load_ushort v127, v2, s[66:67] offset:768
    global_load_short_d16_hi v7, v3, s[66:67] offset:768
    s_add_u32 s22, s22, 1
    s_waitcnt vmcnt(0)
    v_or_b32 v124, v124, v4
    v_or_b32 v125, v125, v5
    v_or_b32 v126, v126, v6
    v_or_b32 v127, v127, v7
    s_mul_i32 s24, s22, 3277
    s_lshr_b32 s24, s24, 16
    s_mul_i32 s68, s24, 20
    s_sub_u32 s68, s22, s68
    s_cmp_lt_u32 s68, 8
    s_cselect_b64 s[66:67], s[84:85], s[86:87]
    s_cselect_b32 s25, 0, 8
    s_sub_u32 s68, s68, s25
    s_and_b32 s25, s68, 1
    s_lshr_b32 s68, s68, 1
    s_lshl_b32 s68, s68, 14
    s_lshl_b32 s25, s25, 12
    s_add_u32 s68, s68, s25
    s_lshl_b32 s24, s24, 5
    s_add_u32 s68, s68, s24
    v_lshrrev_b32 v2, 4, v176
    v_lshlrev_b32 v2, 10, v2
    v_and_b32 v3, 15, v176
    v_lshl_add_u32 v2, v3, 1, v2
    v_add_u32 v2, s68, v2
    v_add_u32 v3, 8192, v2
    v_mov_b32 v4, 0
    v_mov_b32 v5, 0
    v_mov_b32 v6, 0
    v_mov_b32 v7, 0
    global_load_ushort v128, v2, s[66:67] offset:0
    global_load_short_d16_hi v4, v3, s[66:67] offset:0
    global_load_ushort v129, v2, s[66:67] offset:256
    global_load_short_d16_hi v5, v3, s[66:67] offset:256
    global_load_ushort v130, v2, s[66:67] offset:512
    global_load_short_d16_hi v6, v3, s[66:67] offset:512
    global_load_ushort v131, v2, s[66:67] offset:768
    global_load_short_d16_hi v7, v3, s[66:67] offset:768
    s_add_u32 s22, s22, 1
    s_waitcnt vmcnt(0)
    v_or_b32 v128, v128, v4
    v_or_b32 v129, v129, v5
    v_or_b32 v130, v130, v6
    v_or_b32 v131, v131, v7
    s_mul_i32 s24, s22, 3277
    s_lshr_b32 s24, s24, 16
    s_mul_i32 s68, s24, 20
    s_sub_u32 s68, s22, s68
    s_cmp_lt_u32 s68, 8
    s_cselect_b64 s[66:67], s[84:85], s[86:87]
    s_cselect_b32 s25, 0, 8
    s_sub_u32 s68, s68, s25
    s_and_b32 s25, s68, 1
    s_lshr_b32 s68, s68, 1
    s_lshl_b32 s68, s68, 14
    s_lshl_b32 s25, s25, 12
    s_add_u32 s68, s68, s25
    s_lshl_b32 s24, s24, 5
    s_add_u32 s68, s68, s24
    v_lshrrev_b32 v2, 4, v176
    v_lshlrev_b32 v2, 10, v2
    v_and_b32 v3, 15, v176
    v_lshl_add_u32 v2, v3, 1, v2
    v_add_u32 v2, s68, v2
    v_add_u32 v3, 8192, v2
    v_mov_b32 v4, 0
    v_mov_b32 v5, 0
    v_mov_b32 v6, 0
    v_mov_b32 v7, 0
    global_load_ushort v132, v2, s[66:67] offset:0
    global_load_short_d16_hi v4, v3, s[66:67] offset:0
    global_load_ushort v133, v2, s[66:67] offset:256
    global_load_short_d16_hi v5, v3, s[66:67] offset:256
    global_load_ushort v134, v2, s[66:67] offset:512
    global_load_short_d16_hi v6, v3, s[66:67] offset:512
    global_load_ushort v135, v2, s[66:67] offset:768
    global_load_short_d16_hi v7, v3, s[66:67] offset:768
    s_add_u32 s22, s22, 1
    s_waitcnt vmcnt(0)
    v_or_b32 v132, v132, v4
    v_or_b32 v133, v133, v5
    v_or_b32 v134, v134, v6
    v_or_b32 v135, v135, v7
    s_mul_i32 s24, s22, 3277
    s_lshr_b32 s24, s24, 16
    s_mul_i32 s68, s24, 20
    s_sub_u32 s68, s22, s68
    s_cmp_lt_u32 s68, 8
    s_cselect_b64 s[66:67], s[84:85], s[86:87]
    s_cselect_b32 s25, 0, 8
    s_sub_u32 s68, s68, s25
    s_and_b32 s25, s68, 1
    s_lshr_b32 s68, s68, 1
    s_lshl_b32 s68, s68, 14
    s_lshl_b32 s25, s25, 12
    s_add_u32 s68, s68, s25
    s_lshl_b32 s24, s24, 5
    s_add_u32 s68, s68, s24
    v_lshrrev_b32 v2, 4, v176
    v_lshlrev_b32 v2, 10, v2
    v_and_b32 v3, 15, v176
    v_lshl_add_u32 v2, v3, 1, v2
    v_add_u32 v2, s68, v2
    v_add_u32 v3, 8192, v2
    v_mov_b32 v4, 0
    v_mov_b32 v5, 0
    v_mov_b32 v6, 0
    v_mov_b32 v7, 0
    global_load_ushort v136, v2, s[66:67] offset:0
    global_load_short_d16_hi v4, v3, s[66:67] offset:0
    global_load_ushort v137, v2, s[66:67] offset:256
    global_load_short_d16_hi v5, v3, s[66:67] offset:256
    global_load_ushort v138, v2, s[66:67] offset:512
    global_load_short_d16_hi v6, v3, s[66:67] offset:512
    global_load_ushort v139, v2, s[66:67] offset:768
    global_load_short_d16_hi v7, v3, s[66:67] offset:768
    s_add_u32 s22, s22, 1
    s_waitcnt vmcnt(0)
    v_or_b32 v136, v136, v4
    v_or_b32 v137, v137, v5
    v_or_b32 v138, v138, v6
    v_or_b32 v139, v139, v7
    s_mul_i32 s24, s22, 3277
    s_lshr_b32 s24, s24, 16
    s_mul_i32 s68, s24, 20
    s_sub_u32 s68, s22, s68
    s_cmp_lt_u32 s68, 8
    s_cselect_b64 s[66:67], s[84:85], s[86:87]
    s_cselect_b32 s25, 0, 8
    s_sub_u32 s68, s68, s25
    s_and_b32 s25, s68, 1
    s_lshr_b32 s68, s68, 1
    s_lshl_b32 s68, s68, 14
    s_lshl_b32 s25, s25, 12
    s_add_u32 s68, s68, s25
    s_lshl_b32 s24, s24, 5
    s_add_u32 s68, s68, s24
    v_lshrrev_b32 v2, 4, v176
    v_lshlrev_b32 v2, 10, v2
    v_and_b32 v3, 15, v176
    v_lshl_add_u32 v2, v3, 1, v2
    v_add_u32 v2, s68, v2
    v_add_u32 v3, 8192, v2
    v_mov_b32 v4, 0
    v_mov_b32 v5, 0
    v_mov_b32 v6, 0
    v_mov_b32 v7, 0
    global_load_ushort v140, v2, s[66:67] offset:0
    global_load_short_d16_hi v4, v3, s[66:67] offset:0
    global_load_ushort v141, v2, s[66:67] offset:256
    global_load_short_d16_hi v5, v3, s[66:67] offset:256
    global_load_ushort v142, v2, s[66:67] offset:512
    global_load_short_d16_hi v6, v3, s[66:67] offset:512
    global_load_ushort v143, v2, s[66:67] offset:768
    global_load_short_d16_hi v7, v3, s[66:67] offset:768
    s_add_u32 s22, s22, 1
    s_waitcnt vmcnt(0)
    v_or_b32 v140, v140, v4
    v_or_b32 v141, v141, v5
    v_or_b32 v142, v142, v6
    v_or_b32 v143, v143, v7
    s_mul_i32 s24, s22, 3277
    s_lshr_b32 s24, s24, 16
    s_mul_i32 s68, s24, 20
    s_sub_u32 s68, s22, s68
    s_cmp_lt_u32 s68, 8
    s_cselect_b64 s[66:67], s[84:85], s[86:87]
    s_cselect_b32 s25, 0, 8
    s_sub_u32 s68, s68, s25
    s_and_b32 s25, s68, 1
    s_lshr_b32 s68, s68, 1
    s_lshl_b32 s68, s68, 14
    s_lshl_b32 s25, s25, 12
    s_add_u32 s68, s68, s25
    s_lshl_b32 s24, s24, 5
    s_add_u32 s68, s68, s24
    v_lshrrev_b32 v2, 4, v176
    v_lshlrev_b32 v2, 10, v2
    v_and_b32 v3, 15, v176
    v_lshl_add_u32 v2, v3, 1, v2
    v_add_u32 v2, s68, v2
    v_add_u32 v3, 8192, v2
    v_mov_b32 v4, 0
    v_mov_b32 v5, 0
    v_mov_b32 v6, 0
    v_mov_b32 v7, 0
    global_load_ushort v144, v2, s[66:67] offset:0
    global_load_short_d16_hi v4, v3, s[66:67] offset:0
    global_load_ushort v145, v2, s[66:67] offset:256
    global_load_short_d16_hi v5, v3, s[66:67] offset:256
    global_load_ushort v146, v2, s[66:67] offset:512
    global_load_short_d16_hi v6, v3, s[66:67] offset:512
    global_load_ushort v147, v2, s[66:67] offset:768
    global_load_short_d16_hi v7, v3, s[66:67] offset:768
    s_add_u32 s22, s22, 1
    s_waitcnt vmcnt(0)
    v_or_b32 v144, v144, v4
    v_or_b32 v145, v145, v5
    v_or_b32 v146, v146, v6
    v_or_b32 v147, v147, v7
    s_mul_i32 s24, s22, 3277
    s_lshr_b32 s24, s24, 16
    s_mul_i32 s68, s24, 20
    s_sub_u32 s68, s22, s68
    s_cmp_lt_u32 s68, 8
    s_cselect_b64 s[66:67], s[84:85], s[86:87]
    s_cselect_b32 s25, 0, 8
    s_sub_u32 s68, s68, s25
    s_and_b32 s25, s68, 1
    s_lshr_b32 s68, s68, 1
    s_lshl_b32 s68, s68, 14
    s_lshl_b32 s25, s25, 12
    s_add_u32 s68, s68, s25
    s_lshl_b32 s24, s24, 5
    s_add_u32 s68, s68, s24
    v_lshrrev_b32 v2, 4, v176
    v_lshlrev_b32 v2, 10, v2
    v_and_b32 v3, 15, v176
    v_lshl_add_u32 v2, v3, 1, v2
    v_add_u32 v2, s68, v2
    v_add_u32 v3, 8192, v2
    v_mov_b32 v4, 0
    v_mov_b32 v5, 0
    v_mov_b32 v6, 0
    v_mov_b32 v7, 0
    global_load_ushort v148, v2, s[66:67] offset:0
    global_load_short_d16_hi v4, v3, s[66:67] offset:0
    global_load_ushort v149, v2, s[66:67] offset:256
    global_load_short_d16_hi v5, v3, s[66:67] offset:256
    global_load_ushort v150, v2, s[66:67] offset:512
    global_load_short_d16_hi v6, v3, s[66:67] offset:512
    global_load_ushort v151, v2, s[66:67] offset:768
    global_load_short_d16_hi v7, v3, s[66:67] offset:768
    s_add_u32 s22, s22, 1
    s_waitcnt vmcnt(0)
    v_or_b32 v148, v148, v4
    v_or_b32 v149, v149, v5
    v_or_b32 v150, v150, v6
    v_or_b32 v151, v151, v7
    s_mul_i32 s24, s22, 3277
    s_lshr_b32 s24, s24, 16
    s_mul_i32 s68, s24, 20
    s_sub_u32 s68, s22, s68
    s_cmp_lt_u32 s68, 8
    s_cselect_b64 s[66:67], s[84:85], s[86:87]
    s_cselect_b32 s25, 0, 8
    s_sub_u32 s68, s68, s25
    s_and_b32 s25, s68, 1
    s_lshr_b32 s68, s68, 1
    s_lshl_b32 s68, s68, 14
    s_lshl_b32 s25, s25, 12
    s_add_u32 s68, s68, s25
    s_lshl_b32 s24, s24, 5
    s_add_u32 s68, s68, s24
    v_lshrrev_b32 v2, 4, v176
    v_lshlrev_b32 v2, 10, v2
    v_and_b32 v3, 15, v176
    v_lshl_add_u32 v2, v3, 1, v2
    v_add_u32 v2, s68, v2
    v_add_u32 v3, 8192, v2
    v_mov_b32 v4, 0
    v_mov_b32 v5, 0
    v_mov_b32 v6, 0
    v_mov_b32 v7, 0
    global_load_ushort v152, v2, s[66:67] offset:0
    global_load_short_d16_hi v4, v3, s[66:67] offset:0
    global_load_ushort v153, v2, s[66:67] offset:256
    global_load_short_d16_hi v5, v3, s[66:67] offset:256
    global_load_ushort v154, v2, s[66:67] offset:512
    global_load_short_d16_hi v6, v3, s[66:67] offset:512
    global_load_ushort v155, v2, s[66:67] offset:768
    global_load_short_d16_hi v7, v3, s[66:67] offset:768
    s_add_u32 s22, s22, 1
    s_waitcnt vmcnt(0)
    v_or_b32 v152, v152, v4
    v_or_b32 v153, v153, v5
    v_or_b32 v154, v154, v6
    v_or_b32 v155, v155, v7
    s_mul_i32 s24, s22, 3277
    s_lshr_b32 s24, s24, 16
    s_mul_i32 s68, s24, 20
    s_sub_u32 s68, s22, s68
    s_cmp_lt_u32 s68, 8
    s_cselect_b64 s[66:67], s[84:85], s[86:87]
    s_cselect_b32 s25, 0, 8
    s_sub_u32 s68, s68, s25
    s_and_b32 s25, s68, 1
    s_lshr_b32 s68, s68, 1
    s_lshl_b32 s68, s68, 14
    s_lshl_b32 s25, s25, 12
    s_add_u32 s68, s68, s25
    s_lshl_b32 s24, s24, 5
    s_add_u32 s68, s68, s24
    v_lshrrev_b32 v2, 4, v176
    v_lshlrev_b32 v2, 10, v2
    v_and_b32 v3, 15, v176
    v_lshl_add_u32 v2, v3, 1, v2
    v_add_u32 v2, s68, v2
    v_add_u32 v3, 8192, v2
    v_mov_b32 v4, 0
    v_mov_b32 v5, 0
    v_mov_b32 v6, 0
    v_mov_b32 v7, 0
    global_load_ushort v156, v2, s[66:67] offset:0
    global_load_short_d16_hi v4, v3, s[66:67] offset:0
    global_load_ushort v157, v2, s[66:67] offset:256
    global_load_short_d16_hi v5, v3, s[66:67] offset:256
    global_load_ushort v158, v2, s[66:67] offset:512
    global_load_short_d16_hi v6, v3, s[66:67] offset:512
    global_load_ushort v159, v2, s[66:67] offset:768
    global_load_short_d16_hi v7, v3, s[66:67] offset:768
    s_add_u32 s22, s22, 1
    s_waitcnt vmcnt(0)
    v_or_b32 v156, v156, v4
    v_or_b32 v157, v157, v5
    v_or_b32 v158, v158, v6
    v_or_b32 v159, v159, v7
    s_mul_i32 s24, s22, 3277
    s_lshr_b32 s24, s24, 16
    s_mul_i32 s68, s24, 20
    s_sub_u32 s68, s22, s68
    s_cmp_lt_u32 s68, 8
    s_cselect_b64 s[66:67], s[84:85], s[86:87]
    s_cselect_b32 s25, 0, 8
    s_sub_u32 s68, s68, s25
    s_and_b32 s25, s68, 1
    s_lshr_b32 s68, s68, 1
    s_lshl_b32 s68, s68, 14
    s_lshl_b32 s25, s25, 12
    s_add_u32 s68, s68, s25
    s_lshl_b32 s24, s24, 5
    s_add_u32 s68, s68, s24
    v_lshrrev_b32 v2, 4, v176
    v_lshlrev_b32 v2, 10, v2
    v_and_b32 v3, 15, v176
    v_lshl_add_u32 v2, v3, 1, v2
    v_add_u32 v2, s68, v2
    v_add_u32 v3, 8192, v2
    v_mov_b32 v4, 0
    v_mov_b32 v5, 0
    v_mov_b32 v6, 0
    v_mov_b32 v7, 0
    global_load_ushort v160, v2, s[66:67] offset:0
    global_load_short_d16_hi v4, v3, s[66:67] offset:0
    global_load_ushort v161, v2, s[66:67] offset:256
    global_load_short_d16_hi v5, v3, s[66:67] offset:256
    global_load_ushort v162, v2, s[66:67] offset:512
    global_load_short_d16_hi v6, v3, s[66:67] offset:512
    global_load_ushort v163, v2, s[66:67] offset:768
    global_load_short_d16_hi v7, v3, s[66:67] offset:768
    s_add_u32 s22, s22, 1
    s_waitcnt vmcnt(0)
    v_or_b32 v160, v160, v4
    v_or_b32 v161, v161, v5
    v_or_b32 v162, v162, v6
    v_or_b32 v163, v163, v7
    s_mul_i32 s24, s22, 3277
    s_lshr_b32 s24, s24, 16
    s_mul_i32 s68, s24, 20
    s_sub_u32 s68, s22, s68
    s_cmp_lt_u32 s68, 8
    s_cselect_b64 s[66:67], s[84:85], s[86:87]
    s_cselect_b32 s25, 0, 8
    s_sub_u32 s68, s68, s25
    s_and_b32 s25, s68, 1
    s_lshr_b32 s68, s68, 1
    s_lshl_b32 s68, s68, 14
    s_lshl_b32 s25, s25, 12
    s_add_u32 s68, s68, s25
    s_lshl_b32 s24, s24, 5
    s_add_u32 s68, s68, s24
    v_lshrrev_b32 v2, 4, v176
    v_lshlrev_b32 v2, 10, v2
    v_and_b32 v3, 15, v176
    v_lshl_add_u32 v2, v3, 1, v2
    v_add_u32 v2, s68, v2
    v_add_u32 v3, 8192, v2
    v_mov_b32 v4, 0
    v_mov_b32 v5, 0
    v_mov_b32 v6, 0
    v_mov_b32 v7, 0
    global_load_ushort v164, v2, s[66:67] offset:0
    global_load_short_d16_hi v4, v3, s[66:67] offset:0
    global_load_ushort v165, v2, s[66:67] offset:256
    global_load_short_d16_hi v5, v3, s[66:67] offset:256
    global_load_ushort v166, v2, s[66:67] offset:512
    global_load_short_d16_hi v6, v3, s[66:67] offset:512
    global_load_ushort v167, v2, s[66:67] offset:768
    global_load_short_d16_hi v7, v3, s[66:67] offset:768
    s_add_u32 s22, s22, 1
    s_waitcnt vmcnt(0)
    v_or_b32 v164, v164, v4
    v_or_b32 v165, v165, v5
    v_or_b32 v166, v166, v6
    v_or_b32 v167, v167, v7
    s_mul_i32 s24, s22, 3277
    s_lshr_b32 s24, s24, 16
    s_mul_i32 s68, s24, 20
    s_sub_u32 s68, s22, s68
    s_cmp_lt_u32 s68, 8
    s_cselect_b64 s[66:67], s[84:85], s[86:87]
    s_cselect_b32 s25, 0, 8
    s_sub_u32 s68, s68, s25
    s_and_b32 s25, s68, 1
    s_lshr_b32 s68, s68, 1
    s_lshl_b32 s68, s68, 14
    s_lshl_b32 s25, s25, 12
    s_add_u32 s68, s68, s25
    s_lshl_b32 s24, s24, 5
    s_add_u32 s68, s68, s24
    v_lshrrev_b32 v2, 4, v176
    v_lshlrev_b32 v2, 10, v2
    v_and_b32 v3, 15, v176
    v_lshl_add_u32 v2, v3, 1, v2
    v_add_u32 v2, s68, v2
    v_add_u32 v3, 8192, v2
    v_mov_b32 v4, 0
    v_mov_b32 v5, 0
    v_mov_b32 v6, 0
    v_mov_b32 v7, 0
    global_load_ushort v168, v2, s[66:67] offset:0
    global_load_short_d16_hi v4, v3, s[66:67] offset:0
    global_load_ushort v169, v2, s[66:67] offset:256
    global_load_short_d16_hi v5, v3, s[66:67] offset:256
    global_load_ushort v170, v2, s[66:67] offset:512
    global_load_short_d16_hi v6, v3, s[66:67] offset:512
    global_load_ushort v171, v2, s[66:67] offset:768
    global_load_short_d16_hi v7, v3, s[66:67] offset:768
    s_add_u32 s22, s22, 1
    s_waitcnt vmcnt(0)
    v_or_b32 v168, v168, v4
    v_or_b32 v169, v169, v5
    v_or_b32 v170, v170, v6
    v_or_b32 v171, v171, v7
    s_mul_i32 s24, s22, 3277
    s_lshr_b32 s24, s24, 16
    s_mul_i32 s68, s24, 20
    s_sub_u32 s68, s22, s68
    s_cmp_lt_u32 s68, 8
    s_cselect_b64 s[66:67], s[84:85], s[86:87]
    s_cselect_b32 s25, 0, 8
    s_sub_u32 s68, s68, s25
    s_and_b32 s25, s68, 1
    s_lshr_b32 s68, s68, 1
    s_lshl_b32 s68, s68, 14
    s_lshl_b32 s25, s25, 12
    s_add_u32 s68, s68, s25
    s_lshl_b32 s24, s24, 5
    s_add_u32 s68, s68, s24
    v_lshrrev_b32 v2, 4, v176
    v_lshlrev_b32 v2, 10, v2
    v_and_b32 v3, 15, v176
    v_lshl_add_u32 v2, v3, 1, v2
    v_add_u32 v2, s68, v2
    v_add_u32 v3, 8192, v2
    v_mov_b32 v4, 0
    v_mov_b32 v5, 0
    v_mov_b32 v6, 0
    v_mov_b32 v7, 0
    global_load_ushort v172, v2, s[66:67] offset:0
    global_load_short_d16_hi v4, v3, s[66:67] offset:0
    global_load_ushort v173, v2, s[66:67] offset:256
    global_load_short_d16_hi v5, v3, s[66:67] offset:256
    global_load_ushort v174, v2, s[66:67] offset:512
    global_load_short_d16_hi v6, v3, s[66:67] offset:512
    global_load_ushort v175, v2, s[66:67] offset:768
    global_load_short_d16_hi v7, v3, s[66:67] offset:768
    s_add_u32 s22, s22, 1
    s_waitcnt vmcnt(0)
    v_or_b32 v172, v172, v4
    v_or_b32 v173, v173, v5
    v_or_b32 v174, v174, v6
    v_or_b32 v175, v175, v7
    s_load_dwordx2 s[72:73], s[0:1], 72
    s_branch GEMM
.section .rodata,"a"
.p2align 6
.amdhsa_kernel standalone__tensor_product_equiv_equiformer__graph_kernel
  .amdhsa_next_free_vgpr 256
  .amdhsa_next_free_sgpr 90
  .amdhsa_accum_offset 256
  .amdhsa_group_segment_fixed_size 0
  .amdhsa_kernarg_size 96
  .amdhsa_user_sgpr_count 2
  .amdhsa_user_sgpr_kernarg_segment_ptr 1
  .amdhsa_system_sgpr_workgroup_id_x 1
.end_amdhsa_kernel
```

```asm
; @launch grid=(250,1,1) block=(512,1,1) lds=163840
.amdgcn_target "amdgcn-amd-amdhsa--gfx950"
.text
.globl standalone__tensor_product_equiv_equiformer__graph_kernel
.p2align 8
.type standalone__tensor_product_equiv_equiformer__graph_kernel,@function
standalone__tensor_product_equiv_equiformer__graph_kernel:
    s_cmp_ge_u32 s2, 250
    s_cbranch_scc1 K2_end
    s_load_dwordx16 s[72:87], s[0:1], 0
    s_load_dwordx2 s[70:71], s[0:1], 88
    v_lshrrev_b32 v2, 6, v0
    v_and_b32 v1, 63, v0
    v_readfirstlane_b32 s20, v2
    s_getpc_b64 s[66:67]
    v_lshlrev_b32 v95, 7, v1
    s_cmp_eq_u32 s20, 6
    s_cbranch_scc0 F_nopf0
    global_load_dword v95, v95, s[66:67]
F_nopf0:
    s_mul_i32 s66, s2, 5120
    s_mul_i32 s67, s2, 7680
    v_lshl_add_u32 v3, v0, 4, s66
    v_mul_u32_u24 v4, 24, v0
    v_add_u32 v4, s67, v4
    v_lshlrev_b32 v5, 2, v0
    v_mov_b32 v89, 0
    v_add_u32 v6, 98304, v5
    ds_write_b32 v6, v89
    s_cmp_ge_u32 s20, 5
    s_waitcnt lgkmcnt(0)
    s_cbranch_scc1 F_noload
    global_load_dwordx4 v[8:11], v3, s[80:81] nt
    global_load_dwordx4 v[12:15], v3, s[78:79] nt
    global_load_dwordx4 v[16:19], v4, s[74:75] nt
    global_load_dwordx2 v[20:21], v4, s[74:75] offset:16 nt
F_noload:
    s_load_dword s88, s[70:71], 0
    s_barrier
    v_lshlrev_b32 v248, 2, v1
    v_add_u32 v88, 162816, v248
    ds_write_b32 v88, v89
    ds_write_b32 v88, v89 offset:256
    v_lshlrev_b32 v86, 4, v1
    s_lshl_b32 s21, s20, 13
    v_lshrrev_b32 v6, 5, v1
    v_mul_u32_u24 v6, 5120, v6
    v_and_b32 v7, 31, v1
    v_lshl_add_u32 v6, v7, 1, v6
    s_lshr_b32 s66, s20, 2
    s_lshl_b32 s66, s66, 7
    s_and_b32 s67, s20, 3
    s_mul_i32 s67, s67, 5
    s_add_u32 s68, s67, 0
    s_lshr_b32 s24, s68, 2
    s_lshl_b32 s24, s24, 8
    s_bfe_u32 s69, s68, 0x10001
    s_lshl_b32 s69, s69, 6
    s_add_u32 s24, s24, s69
    s_and_b32 s69, s68, 1
    s_mul_i32 s69, s69, 10240
    s_add_u32 s24, s24, s69
    s_add_u32 s24, s24, s66
    s_add_u32 s68, s67, 1
    s_lshr_b32 s25, s68, 2
    s_lshl_b32 s25, s25, 8
    s_bfe_u32 s69, s68, 0x10001
    s_lshl_b32 s69, s69, 6
    s_add_u32 s25, s25, s69
    s_and_b32 s69, s68, 1
    s_mul_i32 s69, s69, 10240
    s_add_u32 s25, s25, s69
    s_add_u32 s25, s25, s66
    s_add_u32 s68, s67, 2
    s_lshr_b32 s26, s68, 2
    s_lshl_b32 s26, s26, 8
    s_bfe_u32 s69, s68, 0x10001
    s_lshl_b32 s69, s69, 6
    s_add_u32 s26, s26, s69
    s_and_b32 s69, s68, 1
    s_mul_i32 s69, s69, 10240
    s_add_u32 s26, s26, s69
    s_add_u32 s26, s26, s66
    s_add_u32 s68, s67, 3
    s_lshr_b32 s27, s68, 2
    s_lshl_b32 s27, s27, 8
    s_bfe_u32 s69, s68, 0x10001
    s_lshl_b32 s69, s69, 6
    s_add_u32 s27, s27, s69
    s_and_b32 s69, s68, 1
    s_mul_i32 s69, s69, 10240
    s_add_u32 s27, s27, s69
    s_add_u32 s27, s27, s66
    s_add_u32 s68, s67, 4
    s_lshr_b32 s28, s68, 2
    s_lshl_b32 s28, s28, 8
    s_bfe_u32 s69, s68, 0x10001
    s_lshl_b32 s69, s69, 6
    s_add_u32 s28, s28, s69
    s_and_b32 s69, s68, 1
    s_mul_i32 s69, s69, 10240
    s_add_u32 s28, s28, s69
    s_add_u32 s28, s28, s66
    v_mov_b32 v96, 0
    v_mov_b32 v97, 0
    v_mov_b32 v98, 0
    v_mov_b32 v99, 0
    v_mov_b32 v100, 0
    v_mov_b32 v101, 0
    v_mov_b32 v102, 0
    v_mov_b32 v103, 0
    v_mov_b32 v104, 0
    v_mov_b32 v105, 0
    v_mov_b32 v106, 0
    v_mov_b32 v107, 0
    v_mov_b32 v108, 0
    v_mov_b32 v109, 0
    v_mov_b32 v110, 0
    v_mov_b32 v111, 0
    v_mov_b32 v112, 0
    v_mov_b32 v113, 0
    v_mov_b32 v114, 0
    v_mov_b32 v115, 0
    v_mov_b32 v180, 0
    v_mov_b32 v181, 0
    v_mov_b32 v182, 0
    v_mov_b32 v183, 0
    s_mov_b32 s16, s70
    s_and_b32 s17, s71, 0xffff
    s_mov_b32 s18, 24165888
    s_mov_b32 s19, 0x20000
    v_lshrrev_b32 v2, 3, v1
    v_lshl_add_u32 v2, s20, 5, v2
    v_and_b32 v91, 7, v1
    v_mul_u32_u24 v94, 384, v2
    v_lshl_add_u32 v94, v91, 4, v94
    v_lshlrev_b32 v93, 2, v2
    v_add_u32 v93, 98304, v93
    v_mul_u32_u24 v92, 32000, v2
    v_lshl_add_u32 v92, v91, 4, v92
    v_mul_u32_u24 v90, 40960, v2
    s_mov_b32 s32, s82
    s_and_b32 s33, s83, 0xffff
    s_mov_b32 s34, 20480
    s_mov_b32 s35, 0x20000
    s_cmp_ge_u32 s20, 5
    s_cbranch_scc1 F_helper
    s_mov_b32 s22, 52429
    s_mov_b32 s23, 0x05040100
    s_mov_b32 s66, 98304
    s_movk_i32 s67, -40
    v_mov_b32 v7, 1
    v_add_u32 v31, 1, v5
    v_add_u32 v32, 2, v5
    v_add_u32 v33, 3, v5
    s_waitcnt vmcnt(3)
    v_mul_u32_u24 v22, s22, v8
    v_mul_u32_u24 v23, s22, v9
    v_mul_u32_u24 v24, s22, v10
    v_mul_u32_u24 v25, s22, v11
    v_lshrrev_b32 v22, 21, v22
    v_lshrrev_b32 v23, 21, v23
    v_lshrrev_b32 v24, 21, v24
    v_lshrrev_b32 v25, 21, v25
    v_lshl_add_u32 v34, v22, 2, s66
    ds_add_rtn_u32 v26, v34, v7
    v_lshl_add_u32 v35, v23, 2, s66
    ds_add_rtn_u32 v27, v35, v7
    v_lshl_add_u32 v36, v24, 2, s66
    ds_add_rtn_u32 v28, v36, v7
    v_lshl_add_u32 v37, v25, 2, s66
    ds_add_rtn_u32 v29, v37, v7
    buffer_load_short_d16_hi v96, v6, s[32:35], s24 offen offset:0
    buffer_load_short_d16_hi v97, v6, s[32:35], s24 offen offset:1280
    buffer_load_short_d16_hi v98, v6, s[32:35], s24 offen offset:2560
    buffer_load_short_d16_hi v99, v6, s[32:35], s24 offen offset:3840
    buffer_load_short_d16_hi v100, v6, s[32:35], s25 offen offset:0
    buffer_load_short_d16_hi v101, v6, s[32:35], s25 offen offset:1280
    buffer_load_short_d16_hi v102, v6, s[32:35], s25 offen offset:2560
    buffer_load_short_d16_hi v103, v6, s[32:35], s25 offen offset:3840
    buffer_load_short_d16_hi v104, v6, s[32:35], s26 offen offset:0
    buffer_load_short_d16_hi v105, v6, s[32:35], s26 offen offset:1280
    buffer_load_short_d16_hi v106, v6, s[32:35], s26 offen offset:2560
    buffer_load_short_d16_hi v107, v6, s[32:35], s26 offen offset:3840
    buffer_load_short_d16_hi v108, v6, s[32:35], s27 offen offset:0
    buffer_load_short_d16_hi v109, v6, s[32:35], s27 offen offset:1280
    buffer_load_short_d16_hi v110, v6, s[32:35], s27 offen offset:2560
    buffer_load_short_d16_hi v111, v6, s[32:35], s27 offen offset:3840
    buffer_load_short_d16_hi v112, v6, s[32:35], s28 offen offset:0
    buffer_load_short_d16_hi v113, v6, s[32:35], s28 offen offset:1280
    buffer_load_short_d16_hi v114, v6, s[32:35], s28 offen offset:2560
    buffer_load_short_d16_hi v115, v6, s[32:35], s28 offen offset:3840
    v_mad_i32_i24 v2, v22, s67, v8
    v_mul_u32_u24 v22, 384, v22
    v_lshl_or_b32 v42, v2, 11, v5
    v_mad_i32_i24 v2, v23, s67, v9
    v_mul_u32_u24 v23, 384, v23
    v_lshl_or_b32 v46, v2, 11, v31
    v_mad_i32_i24 v2, v24, s67, v10
    v_mul_u32_u24 v24, 384, v24
    v_lshl_or_b32 v50, v2, 11, v32
    v_mad_i32_i24 v2, v25, s67, v11
    v_mul_u32_u24 v25, 384, v25
    v_lshl_or_b32 v54, v2, 11, v33
    s_waitcnt vmcnt(20)
    v_mov_b32 v40, v16
    v_perm_b32 v41, v12, v17, s23
    v_alignbit_b32 v44, v18, v17, 16
    v_alignbit_b32 v45, v13, v18, 16
    v_mov_b32 v48, v19
    v_perm_b32 v49, v14, v20, s23
    v_alignbit_b32 v52, v21, v20, 16
    v_alignbit_b32 v53, v15, v21, 16
    v_xor_b32 v41, 0x8000, v41
    v_xor_b32 v45, 0x8000, v45
    v_xor_b32 v49, 0x8000, v49
    v_xor_b32 v53, 0x8000, v53
    s_waitcnt lgkmcnt(0)
    v_min_u32 v26, 23, v26
    v_lshl_add_u32 v34, v26, 4, v22
    ds_write_b128 v34, v[40:43]
    v_min_u32 v27, 23, v27
    v_lshl_add_u32 v35, v27, 4, v23
    ds_write_b128 v35, v[44:47]
    v_min_u32 v28, 23, v28
    v_lshl_add_u32 v36, v28, 4, v24
    ds_write_b128 v36, v[48:51]
    v_min_u32 v29, 23, v29
    v_lshl_add_u32 v37, v29, 4, v25
    ds_write_b128 v37, v[52:55]
    s_branch F_staged
F_helper:
    buffer_load_short_d16_hi v96, v6, s[32:35], s24 offen offset:0
    buffer_load_short_d16_hi v97, v6, s[32:35], s24 offen offset:1280
    buffer_load_short_d16_hi v98, v6, s[32:35], s24 offen offset:2560
    buffer_load_short_d16_hi v99, v6, s[32:35], s24 offen offset:3840
    buffer_load_short_d16_hi v100, v6, s[32:35], s25 offen offset:0
    buffer_load_short_d16_hi v101, v6, s[32:35], s25 offen offset:1280
    buffer_load_short_d16_hi v102, v6, s[32:35], s25 offen offset:2560
    buffer_load_short_d16_hi v103, v6, s[32:35], s25 offen offset:3840
    buffer_load_short_d16_hi v104, v6, s[32:35], s26 offen offset:0
    buffer_load_short_d16_hi v105, v6, s[32:35], s26 offen offset:1280
    buffer_load_short_d16_hi v106, v6, s[32:35], s26 offen offset:2560
    buffer_load_short_d16_hi v107, v6, s[32:35], s26 offen offset:3840
    buffer_load_short_d16_hi v108, v6, s[32:35], s27 offen offset:0
    buffer_load_short_d16_hi v109, v6, s[32:35], s27 offen offset:1280
    buffer_load_short_d16_hi v110, v6, s[32:35], s27 offen offset:2560
    buffer_load_short_d16_hi v111, v6, s[32:35], s27 offen offset:3840
    buffer_load_short_d16_hi v112, v6, s[32:35], s28 offen offset:0
    buffer_load_short_d16_hi v113, v6, s[32:35], s28 offen offset:1280
    buffer_load_short_d16_hi v114, v6, s[32:35], s28 offen offset:2560
    buffer_load_short_d16_hi v115, v6, s[32:35], s28 offen offset:3840
    s_cmp_eq_u32 s20, 6
    s_cbranch_scc0 F_nopf
    s_getpc_b64 s[66:67]
F_pc:
    s_lshr_b32 s68, s2, 3
    s_mul_i32 s68, s68, ((K2_last-F_pc)/128/31+1)*128
    v_lshl_add_u32 v2, v1, 7, s68
    v_min_u32 v2, K2_last-F_pc-4, v2
    v_cmp_gt_u32 vcc, (K2_last-F_pc)/128/31+1, v1
    s_mov_b64 exec, vcc
    global_load_dword v95, v2, s[66:67]
    s_mov_b64 exec, -1
F_nopf:
    s_cmp_eq_u32 s20, 7
    s_cbranch_scc0 F_staged
    s_cmp_lt_u32 s2, 160
    s_cbranch_scc0 F_staged
    s_mul_i32 s22, s2, 3277
    s_lshr_b32 s22, s22, 16
    s_mul_i32 s68, s22, 20
    s_sub_u32 s68, s2, s68
    s_cmp_lt_u32 s68, 8
    s_cselect_b64 s[66:67], s[84:85], s[86:87]
    s_cselect_b32 s23, 0, 8
    s_sub_u32 s68, s68, s23
    s_and_b32 s23, s68, 1
    s_lshr_b32 s68, s68, 1
    s_lshl_b32 s68, s68, 14
    s_lshl_b32 s23, s23, 12
    s_add_u32 s68, s68, s23
    s_lshl_b32 s22, s22, 5
    s_add_u32 s68, s68, s22
    v_lshrrev_b32 v2, 4, v1
    v_lshlrev_b32 v2, 10, v2
    v_and_b32 v3, 15, v1
    v_lshl_add_u32 v2, v3, 1, v2
    v_add_u32 v2, s68, v2
    v_add_u32 v3, 8192, v2
    global_load_ushort v176, v2, s[66:67] offset:0
    global_load_short_d16_hi v180, v3, s[66:67] offset:0
    global_load_ushort v177, v2, s[66:67] offset:256
    global_load_short_d16_hi v181, v3, s[66:67] offset:256
    global_load_ushort v178, v2, s[66:67] offset:512
    global_load_short_d16_hi v182, v3, s[66:67] offset:512
    global_load_ushort v179, v2, s[66:67] offset:768
    global_load_short_d16_hi v183, v3, s[66:67] offset:768
F_staged:
    s_lshl_b32 s66, s2, 7
    s_add_u32 s66, s66, 164864
    s_cmp_eq_u32 s20, 7
    s_cselect_b32 s22, 0xffff, -1
    s_cselect_b32 s23, 0, -1
    s_waitcnt lgkmcnt(0)
    s_add_u32 s88, s88, 1
    s_barrier
    ds_read_b32 v40, v93 offset:0
    ds_read_b128 v[8:11], v94 offset:0
    ds_read_b128 v[12:15], v94 offset:128
    ds_read_b32 v41, v93 offset:32
    ds_read_b128 v[16:19], v94 offset:3072
    ds_read_b128 v[20:23], v94 offset:3200
    ds_read_b32 v42, v93 offset:64
    ds_read_b128 v[24:27], v94 offset:6144
    ds_read_b128 v[28:31], v94 offset:6272
    ds_read_b32 v43, v93 offset:96
    ds_read_b128 v[32:35], v94 offset:9216
    ds_read_b128 v[36:39], v94 offset:9344
    s_waitcnt vmcnt(0)
    s_waitcnt lgkmcnt(9)
    v_min_u32 v5, 31, v40
    v_bfe_u32 v6, v14, 11, 6
    v_and_b32 v10, 0x1ffff, v10
    v_lshl_or_b32 v6, v5, 6, v6
    v_mov_b32 v11, s88
    v_lshl_or_b32 v10, v6, 17, v10
    v_mov_b32 v15, s88
    buffer_store_dwordx4 v[8:11], v92, s[16:19], s66 offen sc1
    v_cmp_lt_u32 vcc, 8, v40
    s_add_u32 s67, s66, 8000000
    s_mov_b64 exec, vcc
    s_cbranch_execz F_w0
    buffer_store_dwordx4 v[12:15], v92, s[16:19], s67 offen sc1
    v_cmp_lt_u32 vcc, 16, v40
    s_add_u32 s67, s67, 8000000
    s_mov_b64 exec, vcc
    s_cbranch_execz F_w0
    ds_read_b128 v[44:47], v94 offset:256
    s_waitcnt lgkmcnt(0)
    v_mov_b32 v47, s88
    buffer_store_dwordx4 v[44:47], v92, s[16:19], s67 offen sc1
    s_nop 1
F_w0:
    s_mov_b64 exec, -1
    s_add_u32 s66, s66, 256000
    s_waitcnt lgkmcnt(6)
    v_min_u32 v5, 31, v41
    v_bfe_u32 v6, v22, 11, 6
    v_and_b32 v18, 0x1ffff, v18
    v_lshl_or_b32 v6, v5, 6, v6
    v_mov_b32 v19, s88
    v_lshl_or_b32 v18, v6, 17, v18
    v_mov_b32 v23, s88
    buffer_store_dwordx4 v[16:19], v92, s[16:19], s66 offen sc1
    v_cmp_lt_u32 vcc, 8, v41
    s_add_u32 s67, s66, 8000000
    s_mov_b64 exec, vcc
    s_cbranch_execz F_w1
    buffer_store_dwordx4 v[20:23], v92, s[16:19], s67 offen sc1
    v_cmp_lt_u32 vcc, 16, v41
    s_add_u32 s67, s67, 8000000
    s_mov_b64 exec, vcc
    s_cbranch_execz F_w1
    ds_read_b128 v[44:47], v94 offset:3328
    s_waitcnt lgkmcnt(0)
    v_mov_b32 v47, s88
    buffer_store_dwordx4 v[44:47], v92, s[16:19], s67 offen sc1
    s_nop 1
F_w1:
    s_mov_b64 exec, -1
    s_add_u32 s66, s66, 256000
    s_waitcnt lgkmcnt(3)
    v_min_u32 v5, 31, v42
    v_bfe_u32 v6, v30, 11, 6
    v_and_b32 v26, 0x1ffff, v26
    v_lshl_or_b32 v6, v5, 6, v6
    v_mov_b32 v27, s88
    v_lshl_or_b32 v26, v6, 17, v26
    v_mov_b32 v31, s88
    buffer_store_dwordx4 v[24:27], v92, s[16:19], s66 offen sc1
    v_cmp_lt_u32 vcc, 8, v42
    s_add_u32 s67, s66, 8000000
    s_mov_b64 exec, vcc
    s_cbranch_execz F_w2
    buffer_store_dwordx4 v[28:31], v92, s[16:19], s67 offen sc1
    v_cmp_lt_u32 vcc, 16, v42
    s_add_u32 s67, s67, 8000000
    s_mov_b64 exec, vcc
    s_cbranch_execz F_w2
    ds_read_b128 v[44:47], v94 offset:6400
    s_waitcnt lgkmcnt(0)
    v_mov_b32 v47, s88
    buffer_store_dwordx4 v[44:47], v92, s[16:19], s67 offen sc1
    s_nop 1
F_w2:
    s_mov_b64 exec, -1
    s_add_u32 s66, s66, 256000
    s_waitcnt lgkmcnt(0)
    v_min_u32 v5, 31, v43
    v_bfe_u32 v6, v38, 11, 6
    v_and_b32 v34, 0x1ffff, v34
    v_lshl_or_b32 v6, v5, 6, v6
    v_mov_b32 v35, s88
    v_lshl_or_b32 v34, v6, 17, v34
    v_mov_b32 v39, s88
    s_mov_b64 exec, s[22:23]
    buffer_store_dwordx4 v[32:35], v92, s[16:19], s66 offen sc1
    v_cmp_lt_u32 vcc, 8, v43
    s_add_u32 s67, s66, 8000000
    s_mov_b64 exec, vcc
    s_cbranch_execz F_w3
    buffer_store_dwordx4 v[36:39], v92, s[16:19], s67 offen sc1
    v_cmp_lt_u32 vcc, 16, v43
    s_add_u32 s67, s67, 8000000
    s_mov_b64 exec, vcc
    s_cbranch_execz F_w3
    ds_read_b128 v[44:47], v94 offset:9472
    s_waitcnt lgkmcnt(0)
    v_mov_b32 v47, s88
    buffer_store_dwordx4 v[44:47], v92, s[16:19], s67 offen sc1
    s_nop 1
F_w3:
    s_mov_b64 exec, -1
    s_cmp_eq_u32 s20, 7
    s_cbranch_scc0 F_nofrag
    s_cmp_lt_u32 s2, 160
    s_cbranch_scc0 F_nofrag
    v_or_b32 v176, v176, v180
    v_or_b32 v177, v177, v181
    v_or_b32 v178, v178, v182
    v_or_b32 v179, v179, v183
    s_lshl_b32 s66, s2, 10
    s_add_u32 s66, s66, 1024
    buffer_store_dwordx4 v[176:179], v86, s[16:19], s66 offen sc1
F_nofrag:
    s_barrier
    s_mul_i32 s24, s2, 32000
    s_lshl_b32 s25, s20, 12
    s_add_u32 s24, s24, s25
    s_add_u32 s24, s24, 164864
    s_add_u32 s25, s24, 8000000
    s_add_u32 s26, s25, 8000000
    v_mov_b32 v22, 0
    v_mov_b32 v23, s88
    s_mul_i32 s68, s20, 5120
    s_cmp_ge_u32 s20, 4
    s_cselect_b32 s70, 45056, 0
    s_add_u32 s68, s68, s70
    v_add_u32 v2, s68, v86
    ds_write_b128 v2, v[96:99] offset:0
    ds_write_b128 v2, v[100:103] offset:1024
    ds_write_b128 v2, v[104:107] offset:2048
    ds_write_b128 v2, v[108:111] offset:3072
    ds_write_b128 v2, v[112:115] offset:4096
    v_mov_b32 v4, 2130738944
    v_mov_b32 v5, 2130738944
    v_mov_b32 v6, 2130738944
    v_mov_b32 v7, 2130738944
    v_lshlrev_b32 v2, 4, v0
    v_add_u32 v3, 86016, v2
    ds_write_b128 v3, v[4:7] offset:0
    ds_write_b128 v3, v[4:7] offset:8192
    ds_write_b128 v3, v[4:7] offset:16384
    ds_write_b128 v3, v[4:7] offset:24576
    ds_write_b128 v3, v[4:7] offset:32768
    ds_write_b128 v3, v[4:7] offset:40960
    ds_write_b128 v3, v[4:7] offset:49152
    ds_write_b128 v3, v[4:7] offset:57344
    v_add_u32 v3, 0x10000, v3
    ds_write_b128 v3, v[4:7] offset:0
    v_min_u32 v2, 3056, v2
    v_add_u32 v2, 159744, v2
    ds_write_b128 v2, v[4:7]
    s_sub_u32 s72, s72, 128
    s_subb_u32 s73, s73, 0
    s_mov_b32 s4, s72
    s_and_b32 s5, s73, 0xffff
    s_mov_b32 s6, 10240000
    s_mov_b32 s7, 0x20000
    s_sub_u32 s72, s72, 1024
    s_subb_u32 s73, s73, 0
    s_mov_b32 s8, s72
    s_and_b32 s9, s73, 0xffff
    s_mov_b32 s10, 10241024
    s_mov_b32 s11, 0x20000
    s_mov_b32 s12, s76
    s_and_b32 s13, s77, 0xffff
    s_mov_b32 s14, 10240000
    s_mov_b32 s15, 0x20000
    v_lshrrev_b32 v2, 5, v1
    v_bfe_u32 v3, v1, 2, 2
    v_and_b32 v4, 3, v1
    v_bfe_u32 v5, v1, 4, 1
    v_lshlrev_b32 v6, 9, v2
    v_lshl_add_u32 v6, v3, 7, v6
    v_lshl_add_u32 v6, v5, 5, v6
    v_lshl_add_u32 v6, v4, 3, v6
    v_lshrrev_b32 v7, 1, v3
    v_lshl_add_u32 v6, v7, 6, v6
    v_add_u32 v244, s21, v6
    v_xor_b32 v245, 64, v244
    v_lshlrev_b32 v6, 7, v2
    v_lshl_add_u32 v6, v7, 5, v6
    v_and_b32 v7, 1, v3
    v_xor_b32 v7, 1, v7
    v_mul_u32_u24 v7, 90112, v7
    v_add_u32 v6, v6, v7
    v_lshl_add_u32 v249, v4, 3, v6
    v_lshl_add_u32 v6, v2, 2, v4
    v_bfe_u32 v7, v1, 2, 1
    v_lshl_add_u32 v6, v7, 3, v6
    v_lshlrev_b32 v6, 3, v6
    v_bfe_u32 v7, v1, 3, 1
    v_add_u32 v5, 1, v5
    v_mul_u32_u24 v7, v7, v5
    v_lshl_add_u32 v250, v7, 1, v6
    v_and_b32 v6, 0x38, v1
    v_add_u32 v247, 6, v6
    v_lshrrev_b32 v6, 2, v1
    v_lshrrev_b32 v7, 4, v1
    v_xor_b32 v6, v6, v7
    v_and_b32 v6, 1, v6
    v_lshlrev_b32 v6, 6, v6
    v_lshl_add_u32 v246, v4, 4, v6
    v_mov_b32 v242, 1.0
    v_mov_b32 v243, 1.0
    s_mov_b32 s54, 0xffffff00
    s_mov_b32 s55, 0xffffff00
    s_mov_b32 s56, 0xffff
    s_mov_b32 s57, 0xffff
    s_mov_b32 s58, 0
    s_mov_b32 s59, 134217856
    s_mov_b32 s60, 262272
    s_mov_b32 s61, 402915456
    s_mov_b32 s62, 940179840
    s_mov_b32 s63, 403046528
    s_mov_b32 s64, 402784384
    s_mov_b32 s65, 134348928
    s_mov_b32 s38, 128
    s_mov_b32 s33, -1
    s_and_b32 s68, s20, 3
    s_lshl_b32 s68, s68, 2
    s_lshr_b32 s69, s20, 2
    s_add_u32 s68, s68, s69
    s_lshl_b32 s68, s68, 4
    s_add_u32 s68, s68, 163072
    v_mov_b32 v251, s68
    s_mov_b32 s53, 0
    s_mov_b32 s50, 0
    s_mov_b32 s51, 0
    s_mov_b32 s47, 0
    s_mov_b32 s42, 0
    s_mov_b32 s3, 0
    s_mov_b32 s89, 0
    s_mov_b32 s34, 128
    s_mov_b32 s35, 384
    s_mov_b32 s36, 640
    s_mov_b32 s37, 896
    s_waitcnt lgkmcnt(0)
    s_barrier
    buffer_load_dwordx4 v[8:11], v86, s[16:19], s24 offen offset:0 sc1
    buffer_load_dwordx4 v[12:15], v86, s[16:19], s24 offen offset:1024 sc1
    buffer_load_dwordx4 v[16:19], v86, s[16:19], s24 offen offset:2048 sc1
    s_mov_b64 exec, s[22:23]
    buffer_load_dwordx4 v[20:23], v86, s[16:19], s24 offen offset:3072 sc1
    s_mov_b64 exec, -1
    ds_read_b128 v[96:99], v86 offset:0
    ds_read_b128 v[100:103], v86 offset:1024
    ds_read_b128 v[104:107], v86 offset:2048
    ds_read_b128 v[108:111], v86 offset:3072
    ds_read_b128 v[112:115], v86 offset:4096
    ds_read_b128 v[116:119], v86 offset:5120
    ds_read_b128 v[120:123], v86 offset:6144
    ds_read_b128 v[124:127], v86 offset:7168
    ds_read_b128 v[128:131], v86 offset:8192
    ds_read_b128 v[132:135], v86 offset:9216
    ds_read_b128 v[136:139], v86 offset:10240
    ds_read_b128 v[140:143], v86 offset:11264
    ds_read_b128 v[144:147], v86 offset:12288
    ds_read_b128 v[148:151], v86 offset:13312
    ds_read_b128 v[152:155], v86 offset:14336
    ds_read_b128 v[156:159], v86 offset:15360
    ds_read_b128 v[160:163], v86 offset:16384
    ds_read_b128 v[164:167], v86 offset:17408
    ds_read_b128 v[168:171], v86 offset:18432
    ds_read_b128 v[172:175], v86 offset:19456
    s_mov_b32 s27, 32768
    s_mov_b32 s71, 162816
    v_mov_b32 v3, 1
    s_cmp_eq_u32 s20, 7
    s_cselect_b32 s52, 160, 0
    v_cmp_gt_u32 s[68:69], 40, v1
    s_mov_b64 s[28:29], 0xff
    s_lshr_b32 s66, s2, 3
    s_lshl_b32 s66, s66, 3
    s_add_u32 s66, s66, s20
    s_mul_i32 s66, s66, 40
    v_min_u32 v93, 39, v1
    v_add_u32 v93, s66, v93
    v_lshlrev_b32 v93, 10, v93
    v_mov_b32 v94, 0x7f000000
F_poll:
    s_waitcnt vmcnt(0)
    v_cmp_ne_u32 s[72:73], s88, v11
    v_cmp_ne_u32 s[74:75], s88, v15
    v_cmp_ne_u32 s[76:77], s88, v19
    v_cmp_ne_u32 s[78:79], s88, v23
    s_or_b64 s[80:81], s[72:73], s[74:75]
    s_or_b64 s[82:83], s[76:77], s[78:79]
    s_or_b64 s[80:81], s[80:81], s[82:83]
    s_cbranch_scc1 F_again
F_got:
    v_bfe_u32 v2, v10, 23, 5
    v_bfe_u32 v60, v10, 11, 6
    v_cmp_gt_u32 s[80:81], v2, v91
    v_lshl_add_u32 v60, v60, 2, s71
    v_cmp_lt_u32 s[72:73], 8, v2
    v_max_u32 v89, v89, v2
    s_mov_b64 exec, s[80:81]
    ds_add_rtn_u32 v72, v60, v3
    s_mov_b64 exec, s[72:73]
    s_cbranch_execz F_h0
    buffer_load_dwordx4 v[24:27], v86, s[16:19], s25 offen offset:0 sc1
    v_sub_u32 v56, v2, v91
    v_bfe_u32 v64, v10, 17, 6
    v_cmp_lt_u32 vcc, 8, v56
    v_lshl_add_u32 v64, v64, 2, s71
    s_mov_b64 exec, vcc
    ds_add_rtn_u32 v76, v64, v3
F_h0:
    s_mov_b64 exec, -1
    v_bfe_u32 v2, v14, 23, 5
    v_bfe_u32 v61, v14, 11, 6
    v_cmp_gt_u32 s[82:83], v2, v91
    v_lshl_add_u32 v61, v61, 2, s71
    v_cmp_lt_u32 s[74:75], 8, v2
    v_max_u32 v89, v89, v2
    s_mov_b64 exec, s[82:83]
    ds_add_rtn_u32 v73, v61, v3
    s_mov_b64 exec, s[74:75]
    s_cbranch_execz F_h1
    buffer_load_dwordx4 v[28:31], v86, s[16:19], s25 offen offset:1024 sc1
    v_sub_u32 v57, v2, v91
    v_bfe_u32 v65, v14, 17, 6
    v_cmp_lt_u32 vcc, 8, v57
    v_lshl_add_u32 v65, v65, 2, s71
    s_mov_b64 exec, vcc
    ds_add_rtn_u32 v77, v65, v3
F_h1:
    s_mov_b64 exec, -1
    v_bfe_u32 v2, v18, 23, 5
    v_bfe_u32 v62, v18, 11, 6
    v_cmp_gt_u32 s[84:85], v2, v91
    v_lshl_add_u32 v62, v62, 2, s71
    v_cmp_lt_u32 s[76:77], 8, v2
    v_max_u32 v89, v89, v2
    s_mov_b64 exec, s[84:85]
    ds_add_rtn_u32 v74, v62, v3
    s_mov_b64 exec, s[76:77]
    s_cbranch_execz F_h2
    buffer_load_dwordx4 v[32:35], v86, s[16:19], s25 offen offset:2048 sc1
    v_sub_u32 v58, v2, v91
    v_bfe_u32 v66, v18, 17, 6
    v_cmp_lt_u32 vcc, 8, v58
    v_lshl_add_u32 v66, v66, 2, s71
    s_mov_b64 exec, vcc
    ds_add_rtn_u32 v78, v66, v3
F_h2:
    s_mov_b64 exec, -1
    v_bfe_u32 v2, v22, 23, 5
    v_bfe_u32 v63, v22, 11, 6
    v_cmp_gt_u32 s[86:87], v2, v91
    v_lshl_add_u32 v63, v63, 2, s71
    v_cmp_lt_u32 s[78:79], 8, v2
    v_max_u32 v89, v89, v2
    s_mov_b64 exec, s[86:87]
    ds_add_rtn_u32 v75, v63, v3
    s_mov_b64 exec, s[78:79]
    s_cbranch_execz F_h3
    buffer_load_dwordx4 v[36:39], v86, s[16:19], s25 offen offset:3072 sc1
    v_sub_u32 v59, v2, v91
    v_bfe_u32 v67, v22, 17, 6
    v_cmp_lt_u32 vcc, 8, v59
    v_lshl_add_u32 v67, v67, 2, s71
    s_mov_b64 exec, vcc
    ds_add_rtn_u32 v79, v67, v3
F_h3:
    s_mov_b64 exec, -1
    v_cmp_lt_u32 s[30:31], 16, v89
    s_mov_b32 s27, 262144
    s_cmp_lg_u64 s[30:31], 0
    s_cbranch_scc1 F_l3
F_l3r:
    v_and_b32 v10, 0x7ff, v10
    v_lshl_add_u32 v10, v10, 5, v90
    v_or_b32 v11, 16, v10
    v_and_b32 v14, 0x7ff, v14
    v_lshl_add_u32 v14, v14, 5, v90
    v_add_u32 v14, 327680, v14
    v_or_b32 v15, 16, v14
    v_and_b32 v18, 0x7ff, v18
    v_lshl_add_u32 v18, v18, 5, v90
    v_add_u32 v18, 655360, v18
    v_or_b32 v19, 16, v18
    v_and_b32 v22, 0x7ff, v22
    v_lshl_add_u32 v22, v22, 5, v90
    v_add_u32 v22, 983040, v22
    v_or_b32 v23, 16, v22
    s_cmp_lt_u32 s2, s52
    s_cbranch_scc1 F_flag
F_flagr:
    s_waitcnt lgkmcnt(0)
    s_barrier
    ds_read_b32 v4, v88
    buffer_load_dword v95, v93, s[4:7], 0 offen offset:128
    v_lshlrev_b32 v72, 3, v72
    v_lshlrev_b32 v73, 3, v73
    v_lshlrev_b32 v74, 3, v74
    v_lshlrev_b32 v75, 3, v75
    v_lshlrev_b32 v76, 3, v76
    v_lshlrev_b32 v77, 3, v77
    v_lshlrev_b32 v78, 3, v78
    v_lshlrev_b32 v79, 3, v79
    s_waitcnt lgkmcnt(0)
    v_add_u32 v5, 15, v4
    v_cmp_lt_u32 vcc, 64, v4
    v_lshrrev_b32 v5, 4, v5
    v_med3_u32 v5, v5, 1, 4
    v_mul_u32_u24 v6, 640, v5
    v_max_u32 v6, 1536, v6
    v_cndmask_b32 v6, 0, v6, s[68:69]
    s_cmp_lg_u64 vcc, 0
    s_cbranch_scc1 SLOW
    v_mov_b32 v7, v6
    v_add_u32 v2, 7, v4
    v_lshrrev_b32 v2, 3, v2
    v_add_u32_dpp v7, v7, v7 row_shr:1 row_mask:0xf bank_mask:0xf
    v_max_u32 v2, 2, v2
    v_cmp_eq_u32 vcc, 7, v2
    v_add_u32_dpp v7, v7, v7 row_shr:2 row_mask:0xf bank_mask:0xf
    v_lshlrev_b32 v92, 22, v5
    v_lshlrev_b32 v5, 18, v5
    v_add_u32_dpp v7, v7, v7 row_shr:4 row_mask:0xf bank_mask:0xf
    v_lshl_or_b32 v5, v1, 21, v5
    v_addc_co_u32 v2, vcc, 0, v2, vcc
    v_add_u32_dpp v7, v7, v7 row_shr:8 row_mask:0xf bank_mask:0xf
    v_lshl_or_b32 v5, v2, 28, v5
    v_med3_u32 v2, v2, 3, 6
    v_add_u32_dpp v7, v7, v7 row_bcast:15 row_mask:0xa bank_mask:0xf
    v_cndmask_b32 v2, 0, v2, s[68:69]
    v_mov_b32 v84, 63
    v_add_u32_dpp v7, v7, v7 row_bcast:31 row_mask:0xc bank_mask:0xf
    s_mov_b32 s71, 0x2000
    v_readlane_b32 s66, v7, 63
    v_sub_u32 v7, v7, v6
    v_add_u32 v7, 86016, v7
    v_lshrrev_b32 v6, 3, v7
    v_mad_u32_u24 v92, v7, s71, v92
    v_or_b32 v92, v92, v6
    ds_bpermute_b32 v60, v60, v92
    ds_bpermute_b32 v61, v61, v92
    ds_bpermute_b32 v62, v62, v92
    ds_bpermute_b32 v63, v63, v92
    ds_bpermute_b32 v64, v64, v92
    ds_bpermute_b32 v65, v65, v92
    ds_bpermute_b32 v66, v66, v92
    ds_bpermute_b32 v67, v67, v92
    v_cmp_eq_u32 vcc, 6, v2
    v_or_b32 v6, v5, v7
    s_cmp_gt_u32 s66, 76800
    s_cbranch_scc1 SLOW
    v_mbcnt_lo_u32_b32 v5, vcc_lo, 0
    v_mbcnt_hi_u32_b32 v5, vcc_hi, v5
    s_bcnt1_i32_b64 s71, vcc
    v_cndmask_b32 v84, v84, v5, vcc
    v_cmp_eq_u32 vcc, 5, v2
    v_mov_b32 v3, s71
    s_nop 0
    v_mbcnt_lo_u32_b32 v5, vcc_lo, v3
    v_mbcnt_hi_u32_b32 v5, vcc_hi, v5
    s_bcnt1_i32_b64 s71, vcc
    v_cndmask_b32 v84, v84, v5, vcc
    v_cmp_eq_u32 vcc, 4, v2
    v_add_u32 v3, s71, v3
    s_nop 0
    v_mbcnt_lo_u32_b32 v5, vcc_lo, v3
    v_mbcnt_hi_u32_b32 v5, vcc_hi, v5
    s_bcnt1_i32_b64 s71, vcc
    v_cndmask_b32 v84, v84, v5, vcc
    v_cmp_eq_u32 vcc, 3, v2
    v_add_u32 v3, s71, v3
    s_nop 0
    v_mbcnt_lo_u32_b32 v5, vcc_lo, v3
    v_mbcnt_hi_u32_b32 v5, vcc_hi, v5
    v_cndmask_b32 v84, v84, v5, vcc
    s_waitcnt lgkmcnt(7)
    v_mad_u32_u16 v2, v60, 8, v72
    v_mad_u32_u16 v3, v60, 8, v72 op_sel:[1,0,0,0]
    s_mov_b64 exec, s[80:81]
    ds_write_b64 v2, v[10:11]
    ds_write_b64 v3, v[8:9]
    s_mov_b64 exec, -1
    s_waitcnt lgkmcnt(8)
    v_mad_u32_u16 v2, v61, 8, v73
    v_mad_u32_u16 v3, v61, 8, v73 op_sel:[1,0,0,0]
    s_mov_b64 exec, s[82:83]
    ds_write_b64 v2, v[14:15]
    ds_write_b64 v3, v[12:13]
    s_mov_b64 exec, -1
    s_waitcnt lgkmcnt(9)
    v_mad_u32_u16 v2, v62, 8, v74
    v_mad_u32_u16 v3, v62, 8, v74 op_sel:[1,0,0,0]
    s_mov_b64 exec, s[84:85]
    ds_write_b64 v2, v[18:19]
    ds_write_b64 v3, v[16:17]
    s_mov_b64 exec, -1
    s_waitcnt lgkmcnt(10)
    v_mad_u32_u16 v2, v63, 8, v75
    v_mad_u32_u16 v3, v63, 8, v75 op_sel:[1,0,0,0]
    s_mov_b64 exec, s[86:87]
    ds_write_b64 v2, v[22:23]
    ds_write_b64 v3, v[20:21]
    s_mov_b64 exec, -1
    v_bfe_u32 v2, v84, 2, 1
    v_bfe_u32 v3, v84, 3, 1
    v_mul_u32_u24 v2, 3, v2
    v_lshl_or_b32 v3, v3, 2, v2
    v_xor_b32 v84, v84, v3
    s_lshr_b32 s66, s2, 3
    v_add_u32 v2, s66, v84
    v_lshlrev_b32 v2, 3, v2
    v_add_u32 v2, v2, v84
    v_cmp_gt_u32 vcc, 32, v84
    v_and_b32 v2, 24, v2
    v_and_or_b32 v2, v84, 7, v2
    v_cndmask_b32 v84, v84, v2, vcc
    v_cmp_eq_u32 vcc, s20, v84
    s_ff1_i32_b64 s67, vcc
    v_readlane_b32 s80, v6, s67
    s_waitcnt vmcnt(1) lgkmcnt(8)
    s_mov_b64 exec, s[72:73]
    s_cbranch_execz F_s0
F_sp0:
    v_cmp_ne_u32 vcc, s88, v27
    s_cbranch_vccnz F_sa0
F_sg0:
    v_cmpx_lt_u32 vcc, 8, v56
    v_and_b32 v26, 0x7ff, v26
    v_lshl_add_u32 v26, v26, 5, v90
    v_or_b32 v27, 16, v26
    v_mad_u32_u16 v2, v64, 8, v76
    v_mad_u32_u16 v3, v64, 8, v76 op_sel:[1,0,0,0]
    ds_write_b64 v2, v[26:27]
    ds_write_b64 v3, v[24:25]
F_s0:
    s_mov_b64 exec, s[74:75]
    s_cbranch_execz F_s1
F_sp1:
    v_cmp_ne_u32 vcc, s88, v31
    s_cbranch_vccnz F_sa1
F_sg1:
    v_cmpx_lt_u32 vcc, 8, v57
    v_and_b32 v30, 0x7ff, v30
    v_lshl_add_u32 v30, v30, 5, v90
    v_add_u32 v30, 327680, v30
    v_or_b32 v31, 16, v30
    v_mad_u32_u16 v2, v65, 8, v77
    v_mad_u32_u16 v3, v65, 8, v77 op_sel:[1,0,0,0]
    ds_write_b64 v2, v[30:31]
    ds_write_b64 v3, v[28:29]
F_s1:
    s_mov_b64 exec, s[76:77]
    s_cbranch_execz F_s2
F_sp2:
    v_cmp_ne_u32 vcc, s88, v35
    s_cbranch_vccnz F_sa2
F_sg2:
    v_cmpx_lt_u32 vcc, 8, v58
    v_and_b32 v34, 0x7ff, v34
    v_lshl_add_u32 v34, v34, 5, v90
    v_add_u32 v34, 655360, v34
    v_or_b32 v35, 16, v34
    v_mad_u32_u16 v2, v66, 8, v78
    v_mad_u32_u16 v3, v66, 8, v78 op_sel:[1,0,0,0]
    ds_write_b64 v2, v[34:35]
    ds_write_b64 v3, v[32:33]
F_s2:
    s_mov_b64 exec, s[78:79]
    s_cbranch_execz F_s3
F_sp3:
    v_cmp_ne_u32 vcc, s88, v39
    s_cbranch_vccnz F_sa3
F_sg3:
    v_cmpx_lt_u32 vcc, 8, v59
    v_and_b32 v38, 0x7ff, v38
    v_lshl_add_u32 v38, v38, 5, v90
    v_add_u32 v38, 983040, v38
    v_or_b32 v39, 16, v38
    v_mad_u32_u16 v2, v67, 8, v79
    v_mad_u32_u16 v3, v67, 8, v79 op_sel:[1,0,0,0]
    ds_write_b64 v2, v[38:39]
    ds_write_b64 v3, v[36:37]
F_s3:
    s_mov_b64 exec, -1
    s_cmp_lg_u64 s[30:31], 0
    s_cbranch_scc1 F_u
F_ur:
    s_mov_b32 s22, s80
    s_mov_b32 s27, s80
    s_mov_b32 s71, s80
    s_bfe_u32 s46, s71, 0x30012
    s_mov_b32 m0, s46
    s_and_b32 s66, s71, 0x3ffff
    s_movrels_b32 s68, s57
    s_movrels_b32 s69, s61
    s_sub_u32 s48, s66, s47
    s_mov_b32 s47, s66
    s_lshr_b32 s52, s71, 28
    s_lshl_b32 s67, s46, 9
    s_add_u32 s66, s66, s67
    s_sub_u32 s49, s66, s42
    s_mov_b32 s42, s66
    s_bfe_u32 s66, s68, 655360
    s_add_u32 s43, s42, s66
    s_bfe_u32 s39, s69, 655360
    s_bfe_u32 s66, s68, 655370
    s_add_u32 s44, s42, s66
    s_bfe_u32 s40, s69, 655370
    s_bfe_u32 s66, s68, 655380
    s_add_u32 s45, s42, s66
    s_bfe_u32 s41, s69, 655380
    s_and_b32 s66, s46, s33
    s_cselect_b32 s72, -1, 1
    s_cselect_b32 s76, s47, 163712
    s_cmp_ge_u32 s66, 2
    s_cselect_b32 s73, -1, 0
    s_add_u32 s77, s47, 1024
    s_cmp_ge_u32 s66, 4
    s_cselect_b32 s75, -1, 0
    s_cmp_ge_u32 s66, 3
    s_cselect_b32 s74, -1, 1
    s_cselect_b32 s77, s77, 163712
    s_mul_i32 s66, s20, 80
    v_min_u32 v2, 76, v248
    s_waitcnt lgkmcnt(0)
    s_barrier
    v_add_u32 v253, s47, v248
    ds_read_b32 v254, v253
    ds_read_b32 v255, v253 offset:256
    v_add_u32 v252, s42, v247
    ds_read_u16 v234, v252
    ds_read_u16 v235, v252 offset:64
    v_add_u32 v252, s43, v247
    ds_read_u16 v236, v252
    ds_read_u16 v237, v252 offset:64
    v_add_u32 v252, s44, v247
    ds_read_u16 v238, v252
    ds_read_u16 v239, v252 offset:64
    v_add_u32 v252, s45, v247
    ds_read_u16 v240, v252
    ds_read_u16 v241, v252 offset:64
    buffer_load_dword v3, v2, s[16:19], s66 offen offset:128 sc1
    v_add_u32 v249, s48, v249
    v_add_u32 v250, s49, v250
    s_waitcnt lgkmcnt(8)
    s_mov_b32 m0, s76
    s_mov_b64 exec, s[72:73]
    buffer_load_dwordx4 v254, s[12:15], 0 offen  lds
    s_mov_b32 m0, s77
    s_mov_b64 exec, s[74:75]
    buffer_load_dwordx4 v255, s[12:15], 0 offen  lds
    s_mov_b64 exec, -1
    s_waitcnt lgkmcnt(0)
    s_add_u32 m0, s21, 0
    v_lshl_add_u32 v234, v234, 10, v246
    v_lshl_add_u32 v235, v235, 10, v246
    buffer_load_dwordx4 v234, s[4:7], s38 offen  lds
    buffer_load_dwordx4 v235, s[8:11], s38 offen offset:1024  lds
    s_add_u32 m0, s21, 2048
    v_lshl_add_u32 v236, v236, 10, v246
    v_lshl_add_u32 v237, v237, 10, v246
    buffer_load_dwordx4 v236, s[4:7], s39 offen  lds
    buffer_load_dwordx4 v237, s[8:11], s39 offen offset:1024  lds
    s_add_u32 m0, s21, 4096
    v_lshl_add_u32 v238, v238, 10, v246
    v_lshl_add_u32 v239, v239, 10, v246
    buffer_load_dwordx4 v238, s[4:7], s40 offen  lds
    buffer_load_dwordx4 v239, s[8:11], s40 offen offset:1024  lds
    s_add_u32 m0, s21, 6144
    v_lshl_add_u32 v240, v240, 10, v246
    v_lshl_add_u32 v241, v241, 10, v246
    buffer_load_dwordx4 v240, s[4:7], s41 offen  lds
    buffer_load_dwordx4 v241, s[8:11], s41 offen offset:1024  lds
    v_lshrrev_b32 v8, 3, v84
    v_and_b32 v9, 7, v84
    v_lshlrev_b32 v9, 13, v9
    v_mul_u32_u24 v8, 1536, v8
    v_and_b32 v5, 128, v86
    v_add3_u32 v8, v8, v9, v5
    v_xor_b32 v9, v86, v7
    v_and_b32 v9, 128, v9
    v_add_u32 v9, v9, v7
    v_and_b32 v4, 0x70, v86
    v_or_b32 v5, v9, v4
    s_add_u32 s66, s20, 0
    v_cmp_eq_u32 vcc, s66, v84
    s_ff1_i32_b64 s67, vcc
    v_readlane_b32 s28, v5, s67
    s_add_u32 s66, s20, 8
    v_cmp_eq_u32 vcc, s66, v84
    s_ff1_i32_b64 s67, vcc
    v_readlane_b32 s29, v5, s67
    v_readlane_b32 s23, v6, s67
    s_add_u32 s66, s20, 16
    v_cmp_eq_u32 vcc, s66, v84
    s_ff1_i32_b64 s67, vcc
    v_readlane_b32 s30, v5, s67
    v_readlane_b32 s24, v6, s67
    s_add_u32 s66, s20, 24
    v_cmp_eq_u32 vcc, s66, v84
    s_ff1_i32_b64 s67, vcc
    v_readlane_b32 s31, v5, s67
    v_readlane_b32 s25, v6, s67
    s_add_u32 s66, s20, 32
    v_cmp_eq_u32 vcc, s66, v84
    s_ff1_i32_b64 s67, vcc
    v_readlane_b32 s32, v5, s67
    v_readlane_b32 s26, v6, s67
    v_lshlrev_b32 v4, 3, v1
    v_add_u32 v4, 163328, v4
    s_mov_b32 exec_hi, 0xff
    ds_write_b64 v4, v[8:9]
    s_mov_b32 exec_hi, -1
    s_waitcnt lgkmcnt(0)
    v_mov_b32 v252, 0
    s_waitcnt vmcnt(6)
    v_cmp_ne_u32 vcc, s88, v3
    ds_read_b64_tr_b16 v[176:177], v244 offset:0
    ds_read_b64_tr_b16 v[178:179], v244 offset:1024
    ds_read_b64_tr_b16 v[180:181], v245 offset:0
    ds_read_b64_tr_b16 v[182:183], v245 offset:1024
    ds_read_b64_tr_b16 v[64:65], v249 offset:0
    ds_read_b64_tr_b16 v[68:69], v249 offset:64
    ds_read_b64_tr_b16 v[66:67], v249 offset:256
    ds_read_b64_tr_b16 v[70:71], v249 offset:320
    s_mov_b64 exec, s[54:55]
    ds_read_u16_d16_hi v242, v250 offset:0
    s_mov_b64 exec, -1
    s_or_b32 s89, vcc_lo, vcc_hi
    s_add_u32 s53, s53, 4
    s_xor_b32 s66, s53, s20
    s_bitcmp1_b32 s66, 2
    s_setprio 1
    s_cbranch_scc1 PRIO_1
    s_setprio 0
PRIO_1:
    s_cmp_eq_u32 s52, 4
    s_cbranch_scc1 ITEM_0_4
    s_cmp_eq_u32 s52, 5
    s_cbranch_scc1 ITEM_0_5
    s_cmp_eq_u32 s52, 3
    s_cbranch_scc1 ITEM_0_3
    s_cmp_eq_u32 s52, 6
    s_cbranch_scc1 ITEM_0_6
    s_cmp_eq_u32 s52, 8
    s_cbranch_scc1 ITEM_0_8
    s_branch ITEM_0_2
F_again:
    s_sub_u32 s27, s27, 1
    s_cbranch_scc1 F_late
    s_cmp_eq_u64 s[72:73], 0
    s_cbranch_scc1 F_p0
    buffer_load_dwordx4 v[8:11], v86, s[16:19], s24 offen offset:0 sc1
F_p0:
    s_cmp_eq_u64 s[74:75], 0
    s_cbranch_scc1 F_p1
    buffer_load_dwordx4 v[12:15], v86, s[16:19], s24 offen offset:1024 sc1
F_p1:
    s_cmp_eq_u64 s[76:77], 0
    s_cbranch_scc1 F_p2
    buffer_load_dwordx4 v[16:19], v86, s[16:19], s24 offen offset:2048 sc1
F_p2:
    s_cmp_eq_u64 s[78:79], 0
    s_cbranch_scc1 F_p3
    s_mov_b64 exec, s[22:23]
    buffer_load_dwordx4 v[20:23], v86, s[16:19], s24 offen offset:3072 sc1
    s_mov_b64 exec, -1
F_p3:
    s_branch F_poll
F_late:
    v_mov_b32 v2, 163064
    v_mov_b32 v4, 1000
    ds_write_b32 v2, v4
    v_mov_b32 v10, 0
    v_mov_b32 v14, 0
    v_mov_b32 v18, 0
    v_mov_b32 v22, 0
    s_branch F_got
F_l3:
    v_bfe_u32 v2, v10, 23, 5
    v_sub_u32 v56, v2, v91
    v_cmp_lt_u32 vcc, 16, v2
    s_mov_b64 exec, vcc
    s_cbranch_execz F_t0
F_tp0:
    buffer_load_dwordx4 v[40:43], v86, s[16:19], s26 offen offset:0 sc1
    s_waitcnt vmcnt(0)
    v_cmp_ne_u32 vcc, s88, v43
    s_sub_u32 s27, s27, 1
    s_cselect_b64 vcc, 0, vcc
    s_cmp_eq_u64 vcc, 0
    s_cbranch_scc0 F_tp0
    v_bfe_u32 v68, v42, 11, 6
    v_lshl_add_u32 v68, v68, 2, s71
    v_cmp_lt_i32 vcc, 16, v56
    s_mov_b64 exec, vcc
    ds_add_rtn_u32 v80, v68, v3
F_t0:
    s_mov_b64 exec, -1
    v_bfe_u32 v2, v14, 23, 5
    v_sub_u32 v57, v2, v91
    v_cmp_lt_u32 vcc, 16, v2
    s_mov_b64 exec, vcc
    s_cbranch_execz F_t1
F_tp1:
    buffer_load_dwordx4 v[44:47], v86, s[16:19], s26 offen offset:1024 sc1
    s_waitcnt vmcnt(0)
    v_cmp_ne_u32 vcc, s88, v47
    s_sub_u32 s27, s27, 1
    s_cselect_b64 vcc, 0, vcc
    s_cmp_eq_u64 vcc, 0
    s_cbranch_scc0 F_tp1
    v_bfe_u32 v69, v46, 11, 6
    v_lshl_add_u32 v69, v69, 2, s71
    v_cmp_lt_i32 vcc, 16, v57
    s_mov_b64 exec, vcc
    ds_add_rtn_u32 v81, v69, v3
F_t1:
    s_mov_b64 exec, -1
    v_bfe_u32 v2, v18, 23, 5
    v_sub_u32 v58, v2, v91
    v_cmp_lt_u32 vcc, 16, v2
    s_mov_b64 exec, vcc
    s_cbranch_execz F_t2
F_tp2:
    buffer_load_dwordx4 v[48:51], v86, s[16:19], s26 offen offset:2048 sc1
    s_waitcnt vmcnt(0)
    v_cmp_ne_u32 vcc, s88, v51
    s_sub_u32 s27, s27, 1
    s_cselect_b64 vcc, 0, vcc
    s_cmp_eq_u64 vcc, 0
    s_cbranch_scc0 F_tp2
    v_bfe_u32 v70, v50, 11, 6
    v_lshl_add_u32 v70, v70, 2, s71
    v_cmp_lt_i32 vcc, 16, v58
    s_mov_b64 exec, vcc
    ds_add_rtn_u32 v82, v70, v3
F_t2:
    s_mov_b64 exec, -1
    v_bfe_u32 v2, v22, 23, 5
    v_sub_u32 v59, v2, v91
    v_cmp_lt_u32 vcc, 16, v2
    s_mov_b64 exec, vcc
    s_cbranch_execz F_t3
F_tp3:
    buffer_load_dwordx4 v[52:55], v86, s[16:19], s26 offen offset:3072 sc1
    s_waitcnt vmcnt(0)
    v_cmp_ne_u32 vcc, s88, v55
    s_sub_u32 s27, s27, 1
    s_cselect_b64 vcc, 0, vcc
    s_cmp_eq_u64 vcc, 0
    s_cbranch_scc0 F_tp3
    v_bfe_u32 v71, v54, 11, 6
    v_lshl_add_u32 v71, v71, 2, s71
    v_cmp_lt_i32 vcc, 16, v59
    s_mov_b64 exec, vcc
    ds_add_rtn_u32 v83, v71, v3
F_t3:
    s_mov_b64 exec, -1
    v_mov_b32 v2, 163068
    v_mov_b32 v4, 1000
    v_cmp_lt_u32 vcc, 24, v89
    s_mov_b64 exec, vcc
    ds_write_b32 v2, v4
    s_mov_b64 exec, -1
    s_branch F_l3r
F_flag:
    s_lshl_b32 s66, s2, 2
    v_mov_b32 v2, 128
    v_mov_b32 v4, s88
    s_mov_b64 exec, 1
    buffer_store_dword v4, v2, s[16:19], s66 offen sc1
    s_mov_b64 exec, -1
    s_branch F_flagr
F_sa0:
    s_sub_u32 s27, s27, 1
    s_cbranch_scc1 F_sg0
    buffer_load_dwordx4 v[24:27], v86, s[16:19], s25 offen offset:0 sc1
    s_waitcnt vmcnt(0)
    s_branch F_sp0
F_sa1:
    s_sub_u32 s27, s27, 1
    s_cbranch_scc1 F_sg1
    buffer_load_dwordx4 v[28:31], v86, s[16:19], s25 offen offset:1024 sc1
    s_waitcnt vmcnt(0)
    s_branch F_sp1
F_sa2:
    s_sub_u32 s27, s27, 1
    s_cbranch_scc1 F_sg2
    buffer_load_dwordx4 v[32:35], v86, s[16:19], s25 offen offset:2048 sc1
    s_waitcnt vmcnt(0)
    s_branch F_sp2
F_sa3:
    s_sub_u32 s27, s27, 1
    s_cbranch_scc1 F_sg3
    buffer_load_dwordx4 v[36:39], v86, s[16:19], s25 offen offset:3072 sc1
    s_waitcnt vmcnt(0)
    s_branch F_sp3
F_u:
    ds_bpermute_b32 v68, v68, v92
    ds_bpermute_b32 v69, v69, v92
    ds_bpermute_b32 v70, v70, v92
    ds_bpermute_b32 v71, v71, v92
    s_waitcnt lgkmcnt(0)
    v_cmp_lt_i32 vcc, 16, v56
    s_mov_b64 exec, vcc
    s_cbranch_execz F_u0
    v_lshlrev_b32 v80, 3, v80
    v_and_b32 v42, 0x7ff, v42
    v_lshl_add_u32 v42, v42, 5, v90
    v_or_b32 v43, 16, v42
    v_mad_u32_u16 v2, v68, 8, v80
    v_mad_u32_u16 v3, v68, 8, v80 op_sel:[1,0,0,0]
    ds_write_b64 v2, v[42:43]
    ds_write_b64 v3, v[40:41]
F_u0:
    s_mov_b64 exec, -1
    v_cmp_lt_i32 vcc, 16, v57
    s_mov_b64 exec, vcc
    s_cbranch_execz F_u1
    v_lshlrev_b32 v81, 3, v81
    v_and_b32 v46, 0x7ff, v46
    v_lshl_add_u32 v46, v46, 5, v90
    v_add_u32 v46, 327680, v46
    v_or_b32 v47, 16, v46
    v_mad_u32_u16 v2, v69, 8, v81
    v_mad_u32_u16 v3, v69, 8, v81 op_sel:[1,0,0,0]
    ds_write_b64 v2, v[46:47]
    ds_write_b64 v3, v[44:45]
F_u1:
    s_mov_b64 exec, -1
    v_cmp_lt_i32 vcc, 16, v58
    s_mov_b64 exec, vcc
    s_cbranch_execz F_u2
    v_lshlrev_b32 v82, 3, v82
    v_and_b32 v50, 0x7ff, v50
    v_lshl_add_u32 v50, v50, 5, v90
    v_add_u32 v50, 655360, v50
    v_or_b32 v51, 16, v50
    v_mad_u32_u16 v2, v70, 8, v82
    v_mad_u32_u16 v3, v70, 8, v82 op_sel:[1,0,0,0]
    ds_write_b64 v2, v[50:51]
    ds_write_b64 v3, v[48:49]
F_u2:
    s_mov_b64 exec, -1
    v_cmp_lt_i32 vcc, 16, v59
    s_mov_b64 exec, vcc
    s_cbranch_execz F_u3
    v_lshlrev_b32 v83, 3, v83
    v_and_b32 v54, 0x7ff, v54
    v_lshl_add_u32 v54, v54, 5, v90
    v_add_u32 v54, 983040, v54
    v_or_b32 v55, 16, v54
    v_mad_u32_u16 v2, v71, 8, v83
    v_mad_u32_u16 v3, v71, 8, v83 op_sel:[1,0,0,0]
    ds_write_b64 v2, v[54:55]
    ds_write_b64 v3, v[52:53]
F_u3:
    s_mov_b64 exec, -1
    s_branch F_ur
LAST0:
    s_cmp_eq_u32 s50, 5
    s_cbranch_scc1 TO_PHASE1
    s_add_u32 s4, s4, 128
    s_addc_u32 s5, s5, 0
    s_add_u32 s8, s8, 128
    s_addc_u32 s9, s9, 0
    s_mov_b32 s34, 0
    s_mov_b32 s35, 256
    s_mov_b32 s36, 512
    s_mov_b32 s37, 768
    s_mov_b32 s33, 0
    s_add_u32 s53, s53, 4
    s_xor_b32 s66, s53, s20
    s_bitcmp1_b32 s66, 2
    s_setprio 1
    s_cbranch_scc1 PRIO_2
    s_setprio 0
PRIO_2:
    s_cmp_eq_u32 s52, 4
    s_cbranch_scc1 ITEM_0_4
    s_cmp_eq_u32 s52, 5
    s_cbranch_scc1 ITEM_0_5
    s_cmp_eq_u32 s52, 3
    s_cbranch_scc1 ITEM_0_3
    s_cmp_eq_u32 s52, 6
    s_cbranch_scc1 ITEM_0_6
    s_cmp_eq_u32 s52, 8
    s_cbranch_scc1 ITEM_0_8
    s_branch ITEM_0_2
TO_PHASE1:
    ds_read_b32 v252, v251 offset:16
    v_lshlrev_b32 v253, 2, v248
    v_add_u32 v253, 65536, v253
    ds_read_b128 v[96:99], v253 offset:0
    ds_read_b128 v[100:103], v253 offset:1024
    ds_read_b128 v[104:107], v253 offset:2048
    ds_read_b128 v[108:111], v253 offset:3072
    ds_read_b128 v[112:115], v253 offset:4096
    ds_read_b128 v[116:119], v253 offset:5120
    ds_read_b128 v[120:123], v253 offset:6144
    ds_read_b128 v[124:127], v253 offset:7168
    ds_read_b128 v[128:131], v253 offset:8192
    ds_read_b128 v[132:135], v253 offset:9216
    ds_read_b128 v[136:139], v253 offset:10240
    ds_read_b128 v[140:143], v253 offset:11264
    ds_read_b128 v[144:147], v253 offset:12288
    ds_read_b128 v[148:151], v253 offset:13312
    ds_read_b128 v[152:155], v253 offset:14336
    ds_read_b128 v[156:159], v253 offset:15360
    ds_read_b128 v[160:163], v253 offset:16384
    ds_read_b128 v[164:167], v253 offset:17408
    ds_read_b128 v[168:171], v253 offset:18432
    ds_read_b128 v[172:175], v253 offset:19456
    s_mov_b32 s34, 128
    s_mov_b32 s35, 384
    s_mov_b32 s36, 640
    s_mov_b32 s37, 896
    s_mov_b32 s50, 0
    s_waitcnt lgkmcnt(0)
    s_waitcnt lgkmcnt(0)
    v_readfirstlane_b32 s66, v252
    s_add_u32 s53, s53, 1
    v_mov_b32 v252, s53
    s_cmp_le_u32 s53, s66
    ds_write2_b32 v251, v252, v252 offset0:0 offset1:8
    s_setprio 1
    s_cbranch_scc1 PRIO_3
    s_setprio 0
PRIO_3:
    s_cmp_eq_u32 s52, 4
    s_cbranch_scc1 ITEM_1_4
    s_cmp_eq_u32 s52, 5
    s_cbranch_scc1 ITEM_1_5
    s_cmp_eq_u32 s52, 3
    s_cbranch_scc1 ITEM_1_3
    s_cmp_eq_u32 s52, 6
    s_cbranch_scc1 ITEM_1_6
    s_cmp_eq_u32 s52, 8
    s_cbranch_scc1 ITEM_1_8
    s_branch ITEM_1_2
LAST1:
    s_cmp_eq_u32 s50, 5
    s_cbranch_scc1 TAIL
    v_mov_b32 v246, 0x7f000000
    s_load_dwordx2 s[72:73], s[0:1], 72
    s_waitcnt lgkmcnt(7)
    v_readfirstlane_b32 s66, v252
    s_add_u32 s53, s53, 1
    v_mov_b32 v252, s53
    s_cmp_le_u32 s53, s66
    ds_write2_b32 v251, v252, v252 offset0:0 offset1:8
    s_setprio 1
    s_cbranch_scc1 PRIO_4
    s_setprio 0
PRIO_4:
    s_cmp_eq_u32 s52, 4
    s_cbranch_scc1 ITEM_1_4
    s_cmp_eq_u32 s52, 5
    s_cbranch_scc1 ITEM_1_5
    s_cmp_eq_u32 s52, 3
    s_cbranch_scc1 ITEM_1_3
    s_cmp_eq_u32 s52, 6
    s_cbranch_scc1 ITEM_1_6
    s_cmp_eq_u32 s52, 8
    s_cbranch_scc1 ITEM_1_8
    s_branch ITEM_1_2
.p2align 6
ITEM_0_4:
    s_mov_b64 exec, s[54:55]
    ds_read_u16_d16_hi v243, v250 offset:128
    s_mov_b64 exec, -1
    ds_read_b64_tr_b16 v[72:73], v249 offset:512
    ds_read_b64_tr_b16 v[76:77], v249 offset:576
    ds_read_b64_tr_b16 v[74:75], v249 offset:768
    ds_read_b64_tr_b16 v[78:79], v249 offset:832
    s_waitcnt lgkmcnt(5)
    v_mul_f32_dpp v196, v242, v64 row_newbcast:0 row_mask:0xf bank_mask:0xf
    v_mul_f32_dpp v197, v242, v65 row_newbcast:1 row_mask:0xf bank_mask:0xf
    v_mul_f32_dpp v198, v242, v64 row_newbcast:8 row_mask:0xf bank_mask:0xf
    v_mul_f32_dpp v199, v242, v65 row_newbcast:9 row_mask:0xf bank_mask:0xf
    v_mul_f32_dpp v200, v242, v68 row_newbcast:2 row_mask:0xf bank_mask:0xf
    v_mul_f32_dpp v201, v242, v69 row_newbcast:3 row_mask:0xf bank_mask:0xf
    v_mul_f32_dpp v202, v242, v68 row_newbcast:10 row_mask:0xf bank_mask:0xf
    v_mul_f32_dpp v203, v242, v69 row_newbcast:11 row_mask:0xf bank_mask:0xf
    v_cvt_pk_bf16_f32 v64, v196, v197
    v_cvt_pk_bf16_f32 v68, v198, v199
    v_cvt_pk_bf16_f32 v65, v200, v201
    v_cvt_pk_bf16_f32 v69, v202, v203
    v_mul_f32_dpp v196, v242, v66 row_newbcast:4 row_mask:0xf bank_mask:0xf
    v_mul_f32_dpp v197, v242, v67 row_newbcast:5 row_mask:0xf bank_mask:0xf
    v_mul_f32_dpp v198, v242, v66 row_newbcast:12 row_mask:0xf bank_mask:0xf
    v_mul_f32_dpp v199, v242, v67 row_newbcast:13 row_mask:0xf bank_mask:0xf
    v_mul_f32_dpp v200, v242, v70 row_newbcast:6 row_mask:0xf bank_mask:0xf
    v_mul_f32_dpp v201, v242, v71 row_newbcast:7 row_mask:0xf bank_mask:0xf
    v_mul_f32_dpp v202, v242, v70 row_newbcast:14 row_mask:0xf bank_mask:0xf
    v_mul_f32_dpp v203, v242, v71 row_newbcast:15 row_mask:0xf bank_mask:0xf
    v_cvt_pk_bf16_f32 v66, v196, v197
    v_cvt_pk_bf16_f32 v70, v198, v199
    v_cvt_pk_bf16_f32 v67, v200, v201
    v_cvt_pk_bf16_f32 v71, v202, v203
    s_nop 0
    s_waitcnt vmcnt(4) lgkmcnt(0)
    v_mfma_f32_32x32x16_bf16 v[0:15], v[64:67], v[176:179], 0
    v_mul_f32_dpp v196, v243, v72 row_newbcast:0 row_mask:0xf bank_mask:0xf
    v_mul_f32_dpp v197, v243, v73 row_newbcast:1 row_mask:0xf bank_mask:0xf
    v_mul_f32_dpp v198, v243, v72 row_newbcast:8 row_mask:0xf bank_mask:0xf
    v_mul_f32_dpp v199, v243, v73 row_newbcast:9 row_mask:0xf bank_mask:0xf
    v_mul_f32_dpp v200, v243, v76 row_newbcast:2 row_mask:0xf bank_mask:0xf
    v_mul_f32_dpp v201, v243, v77 row_newbcast:3 row_mask:0xf bank_mask:0xf
    v_mul_f32_dpp v202, v243, v76 row_newbcast:10 row_mask:0xf bank_mask:0xf
    v_mul_f32_dpp v203, v243, v77 row_newbcast:11 row_mask:0xf bank_mask:0xf
    v_cvt_pk_bf16_f32 v72, v196, v197
    v_cvt_pk_bf16_f32 v76, v198, v199
    v_cvt_pk_bf16_f32 v73, v200, v201
    v_cvt_pk_bf16_f32 v77, v202, v203
    s_add_u32 m0, s21, 0
    v_mfma_f32_32x32x16_bf16 v[16:31], v[68:71], v[176:179], 0
    buffer_load_dwordx4 v234, s[4:7], s36 offen  lds
    buffer_load_dwordx4 v235, s[8:11], s36 offen offset:1024  lds
    ds_read_b64_tr_b16 v[176:177], v244 offset:2048
    ds_read_b64_tr_b16 v[178:179], v244 offset:3072
    ds_read_b64_tr_b16 v[184:185], v245 offset:2048
    ds_read_b64_tr_b16 v[186:187], v245 offset:3072
    v_mul_f32_dpp v196, v243, v74 row_newbcast:4 row_mask:0xf bank_mask:0xf
    v_mul_f32_dpp v197, v243, v75 row_newbcast:5 row_mask:0xf bank_mask:0xf
    v_mul_f32_dpp v198, v243, v74 row_newbcast:12 row_mask:0xf bank_mask:0xf
    v_mul_f32_dpp v199, v243, v75 row_newbcast:13 row_mask:0xf bank_mask:0xf
    v_mul_f32_dpp v200, v243, v78 row_newbcast:6 row_mask:0xf bank_mask:0xf
    v_mul_f32_dpp v201, v243, v79 row_newbcast:7 row_mask:0xf bank_mask:0xf
    v_mul_f32_dpp v202, v243, v78 row_newbcast:14 row_mask:0xf bank_mask:0xf
    v_mul_f32_dpp v203, v243, v79 row_newbcast:15 row_mask:0xf bank_mask:0xf
    v_cvt_pk_bf16_f32 v74, v196, v197
    v_cvt_pk_bf16_f32 v78, v198, v199
    v_cvt_pk_bf16_f32 v75, v200, v201
    v_cvt_pk_bf16_f32 v79, v202, v203
    s_nop 0
    s_waitcnt lgkmcnt(0)
    v_mfma_f32_32x32x16_bf16 v[0:15], v[72:75], v[176:179], v[0:15]
    s_add_u32 m0, s21, 2048
    v_mfma_f32_32x32x16_bf16 v[16:31], v[76:79], v[176:179], v[16:31]
    buffer_load_dwordx4 v236, s[4:7], s36 offen  lds
    buffer_load_dwordx4 v237, s[8:11], s36 offen offset:1024  lds
    s_mov_b32 m0, s50
    s_nop 0
    s_movrels_b32 s71, s23
    s_bfe_u32 s46, s71, 0x30012
    s_mov_b32 m0, s46
    s_and_b32 s66, s71, 0x3ffff
    s_movrels_b32 s68, s57
    s_movrels_b32 s69, s61
    s_sub_u32 s48, s66, s47
    s_mov_b32 s47, s66
    s_lshr_b32 s52, s71, 28
    s_lshl_b32 s67, s46, 9
    s_add_u32 s66, s66, s67
    s_sub_u32 s49, s66, s42
    s_mov_b32 s42, s66
    s_bfe_u32 s66, s68, 655360
    s_add_u32 s43, s42, s66
    s_bfe_u32 s39, s69, 655360
    s_bfe_u32 s66, s68, 655370
    s_add_u32 s44, s42, s66
    s_bfe_u32 s40, s69, 655370
    s_bfe_u32 s66, s68, 655380
    s_add_u32 s45, s42, s66
    s_bfe_u32 s41, s69, 655380
    s_and_b32 s66, s46, s33
    s_cselect_b32 s72, -1, 1
    s_cselect_b32 s76, s47, 163712
    s_cmp_ge_u32 s66, 2
    s_cselect_b32 s73, -1, 0
    s_add_u32 s77, s47, 1024
    s_cmp_ge_u32 s66, 4
    s_cselect_b32 s75, -1, 0
    s_cmp_ge_u32 s66, 3
    s_cselect_b32 s74, -1, 1
    s_cselect_b32 s77, s77, 163712
    v_add_u32 v252, s44, v247
    ds_read_u16 v238, v252
    ds_read_u16 v239, v252 offset:64
    v_add_u32 v252, s45, v247
    ds_read_u16 v240, v252
    ds_read_u16 v241, v252 offset:64
    v_mfma_f32_32x32x16_bf16 v[32:47], v[64:67], v[180:183], 0
    v_mul_f32 v196, v0, v96
    v_fmac_f32 v196, v1, v97
    v_fmac_f32 v196, v2, v98
    v_fmac_f32 v196, v3, v99
    v_fmac_f32 v196, v4, v100
    v_fmac_f32 v196, v5, v101
    v_fmac_f32 v196, v6, v102
    v_fmac_f32 v196, v7, v103
    v_mul_f32 v198, v8, v128
    v_fmac_f32 v198, v9, v129
    v_mfma_f32_32x32x16_bf16 v[48:63], v[68:71], v[180:183], 0
    v_add_u32 v253, s47, v248
    ds_read_b32 v254, v253
    ds_read_b32 v255, v253 offset:256
    s_waitcnt vmcnt(6)
    ds_read_b64_tr_b16 v[176:177], v244 offset:4096
    ds_read_b64_tr_b16 v[178:179], v244 offset:5120
    ds_read_b64_tr_b16 v[180:181], v245 offset:4096
    ds_read_b64_tr_b16 v[182:183], v245 offset:5120
    v_fmac_f32 v198, v10, v130
    v_fmac_f32 v198, v11, v131
    v_fmac_f32 v198, v12, v132
    v_fmac_f32 v198, v13, v133
    v_fmac_f32 v198, v14, v134
    v_fmac_f32 v198, v15, v135
    v_mul_f32 v200, v16, v128
    v_fmac_f32 v200, v17, v129
    v_permlane32_swap_b32 v196, v198
    v_mfma_f32_32x32x16_bf16 v[32:47], v[72:75], v[184:187], v[32:47]
    v_fmac_f32 v200, v18, v130
    v_fmac_f32 v200, v19, v131
    v_fmac_f32 v200, v20, v132
    v_fmac_f32 v200, v21, v133
    v_fmac_f32 v200, v22, v134
    v_fmac_f32 v200, v23, v135
    v_add_f32 v198, v196, v198
    v_mul_f32_e64 v202, v24, -v128
    v_fma_f32 v202, v25, -v129, v202
    v_mfma_f32_32x32x16_bf16 v[48:63], v[76:79], v[184:187], v[48:63]
    v_fma_f32 v202, v26, -v130, v202
    v_fma_f32 v202, v27, -v131, v202
    v_fma_f32 v202, v28, -v132, v202
    v_fma_f32 v202, v29, -v133, v202
    v_fma_f32 v202, v30, -v134, v202
    v_fma_f32 v202, v31, -v135, v202
    s_nop 1
    v_permlane32_swap_b32 v200, v202
    v_add_f32 v202, v200, v202
    s_waitcnt vmcnt(4) lgkmcnt(0)
    v_mfma_f32_32x32x16_bf16 v[0:15], v[64:67], v[176:179], 0
    v_mul_f32 v197, v32, v104
    v_fmac_f32 v197, v33, v105
    v_fmac_f32 v197, v34, v106
    v_fmac_f32 v197, v35, v107
    v_fmac_f32 v197, v36, v108
    v_fmac_f32 v197, v37, v109
    v_fmac_f32 v197, v38, v110
    v_fmac_f32 v197, v39, v111
    v_mul_f32 v199, v40, v136
    v_fmac_f32 v199, v41, v137
    v_fmac_f32 v199, v42, v138
    s_add_u32 m0, s21, 4096
    v_mfma_f32_32x32x16_bf16 v[16:31], v[68:71], v[176:179], 0
    buffer_load_dwordx4 v234, s[4:7], s37 offen  lds
    buffer_load_dwordx4 v235, s[8:11], s37 offen offset:1024  lds
    ds_read_b64_tr_b16 v[176:177], v244 offset:6144
    ds_read_b64_tr_b16 v[178:179], v244 offset:7168
    ds_read_b64_tr_b16 v[184:185], v245 offset:6144
    ds_read_b64_tr_b16 v[186:187], v245 offset:7168
    v_add_u32 v252, s42, v247
    ds_read_u16 v234, v252
    ds_read_u16 v235, v252 offset:64
    s_mov_b32 m0, s76
    s_mov_b64 exec, s[72:73]
    buffer_load_dwordx4 v254, s[12:15], 0 offen  lds
    s_mov_b32 m0, s77
    s_mov_b64 exec, s[74:75]
    buffer_load_dwordx4 v255, s[12:15], 0 offen  lds
    s_mov_b64 exec, -1
    v_fmac_f32 v199, v43, v139
    v_fmac_f32 v199, v44, v140
    v_fmac_f32 v199, v45, v141
    v_fmac_f32 v199, v46, v142
    v_fmac_f32 v199, v47, v143
    v_mul_f32 v201, v48, v136
    v_fmac_f32 v201, v49, v137
    v_permlane32_swap_b32 v197, v199
    v_fmac_f32 v201, v50, v138
    v_fmac_f32 v201, v51, v139
    s_waitcnt lgkmcnt(2)
    v_mfma_f32_32x32x16_bf16 v[0:15], v[72:75], v[176:179], v[0:15]
    v_fmac_f32 v201, v52, v140
    v_fmac_f32 v201, v53, v141
    v_fmac_f32 v201, v54, v142
    v_fmac_f32 v201, v55, v143
    v_add_f32 v199, v197, v199
    v_mul_f32_e64 v203, v56, -v136
    v_fma_f32 v203, v57, -v137, v203
    v_fma_f32 v203, v58, -v138, v203
    v_fma_f32 v203, v59, -v139, v203
    v_fma_f32 v203, v60, -v140, v203
    v_fma_f32 v203, v61, -v141, v203
    s_add_u32 m0, s21, 6144
    v_mfma_f32_32x32x16_bf16 v[16:31], v[76:79], v[176:179], v[16:31]
    buffer_load_dwordx4 v236, s[4:7], s37 offen  lds
    buffer_load_dwordx4 v237, s[8:11], s37 offen offset:1024  lds
    v_add_u32 v252, s43, v247
    ds_read_u16 v236, v252
    ds_read_u16 v237, v252 offset:64
    v_fma_f32 v203, v62, -v142, v203
    v_fma_f32 v203, v63, -v143, v203
    s_nop 1
    v_permlane32_swap_b32 v201, v203
    v_add_f32 v203, v201, v203
    s_set_gpr_idx_on s51, gpr_idx(DST)
    s_nop 0
    v_cvt_pk_bf16_f32 v204, v198, v199
    v_cvt_pk_bf16_f32 v205, v202, v203
    s_set_gpr_idx_off
    v_mfma_f32_32x32x16_bf16 v[32:47], v[64:67], v[180:183], 0
    v_mul_f32 v196, v0, v144
    v_fmac_f32 v196, v1, v145
    v_fmac_f32 v196, v2, v146
    v_fmac_f32 v196, v3, v147
    v_fmac_f32 v196, v4, v148
    v_fmac_f32 v196, v5, v149
    v_fmac_f32 v196, v6, v150
    v_fmac_f32 v196, v7, v151
    v_mfma_f32_32x32x16_bf16 v[48:63], v[68:71], v[180:183], 0
    s_waitcnt vmcnt(8)
    ds_read_b64_tr_b16 v[176:177], v244 offset:0
    ds_read_b64_tr_b16 v[178:179], v244 offset:1024
    ds_read_b64_tr_b16 v[180:181], v245 offset:0
    ds_read_b64_tr_b16 v[182:183], v245 offset:1024
    v_mul_f32 v198, v8, v112
    v_fmac_f32 v198, v9, v113
    v_fmac_f32 v198, v10, v114
    v_fmac_f32 v198, v11, v115
    v_fmac_f32 v198, v12, v116
    v_fmac_f32 v198, v13, v117
    v_fmac_f32 v198, v14, v118
    v_fmac_f32 v198, v15, v119
    v_mfma_f32_32x32x16_bf16 v[32:47], v[72:75], v[184:187], v[32:47]
    v_mul_f32_e64 v200, v16, -v160
    v_fma_f32 v200, v17, -v161, v200
    v_fma_f32 v200, v18, -v162, v200
    v_fma_f32 v200, v19, -v163, v200
    v_fma_f32 v200, v20, -v164, v200
    v_fma_f32 v200, v21, -v165, v200
    v_fma_f32 v200, v22, -v166, v200
    v_fma_f32 v200, v23, -v167, v200
    v_mfma_f32_32x32x16_bf16 v[48:63], v[76:79], v[184:187], v[48:63]
    v_mul_f32_e64 v202, v24, -v160
    v_fma_f32 v202, v25, -v161, v202
    v_fma_f32 v202, v26, -v162, v202
    v_fma_f32 v202, v27, -v163, v202
    v_fma_f32 v202, v28, -v164, v202
    v_fma_f32 v202, v29, -v165, v202
    v_fma_f32 v202, v30, -v166, v202
    v_fma_f32 v202, v31, -v167, v202
    s_waitcnt vmcnt(6) lgkmcnt(0)
    v_mfma_f32_32x32x16_bf16 v[0:15], v[64:67], v[176:179], 0
    v_mul_f32 v197, v32, v152
    v_fmac_f32 v197, v33, v153
    v_fmac_f32 v197, v34, v154
    v_fmac_f32 v197, v35, v155
    v_fmac_f32 v197, v36, v156
    v_fmac_f32 v197, v37, v157
    v_fmac_f32 v197, v38, v158
    v_fmac_f32 v197, v39, v159
    s_add_u32 m0, s21, 0
    v_mfma_f32_32x32x16_bf16 v[16:31], v[68:71], v[176:179], 0
    v_lshl_add_u32 v234, v234, 10, v246
    v_lshl_add_u32 v235, v235, 10, v246
    buffer_load_dwordx4 v234, s[4:7], s38 offen  lds
    buffer_load_dwordx4 v235, s[8:11], s38 offen offset:1024  lds
    ds_read_b64_tr_b16 v[176:177], v244 offset:2048
    ds_read_b64_tr_b16 v[178:179], v244 offset:3072
    ds_read_b64_tr_b16 v[184:185], v245 offset:2048
    ds_read_b64_tr_b16 v[186:187], v245 offset:3072
    v_mul_f32 v199, v40, v120
    v_fmac_f32 v199, v41, v121
    v_fmac_f32 v199, v42, v122
    v_fmac_f32 v199, v43, v123
    v_fmac_f32 v199, v44, v124
    v_fmac_f32 v199, v45, v125
    v_fmac_f32 v199, v46, v126
    v_fmac_f32 v199, v47, v127
    s_waitcnt lgkmcnt(0)
    v_mfma_f32_32x32x16_bf16 v[0:15], v[72:75], v[176:179], v[0:15]
    v_mul_f32_e64 v201, v48, -v168
    v_fma_f32 v201, v49, -v169, v201
    v_fma_f32 v201, v50, -v170, v201
    v_fma_f32 v201, v51, -v171, v201
    v_fma_f32 v201, v52, -v172, v201
    v_fma_f32 v201, v53, -v173, v201
    v_fma_f32 v201, v54, -v174, v201
    v_fma_f32 v201, v55, -v175, v201
    s_add_u32 m0, s21, 2048
    v_mfma_f32_32x32x16_bf16 v[16:31], v[76:79], v[176:179], v[16:31]
    v_lshl_add_u32 v236, v236, 10, v246
    v_lshl_add_u32 v237, v237, 10, v246
    buffer_load_dwordx4 v236, s[4:7], s39 offen  lds
    buffer_load_dwordx4 v237, s[8:11], s39 offen offset:1024  lds
    v_mul_f32_e64 v203, v56, -v168
    v_fma_f32 v203, v57, -v169, v203
    v_fma_f32 v203, v58, -v170, v203
    v_fma_f32 v203, v59, -v171, v203
    v_fma_f32 v203, v60, -v172, v203
    v_fma_f32 v203, v61, -v173, v203
    v_fma_f32 v203, v62, -v174, v203
    v_fma_f32 v203, v63, -v175, v203
    v_mfma_f32_32x32x16_bf16 v[32:47], v[64:67], v[180:183], 0
    v_mul_f32 v254, v0, v144
    v_fmac_f32 v254, v1, v145
    v_fmac_f32 v254, v2, v146
    v_fmac_f32 v254, v3, v147
    v_fmac_f32 v254, v4, v148
    v_mfma_f32_32x32x16_bf16 v[48:63], v[68:71], v[180:183], 0
    ds_swizzle_b32 v68, v68 offset:0x401F
    ds_swizzle_b32 v69, v69 offset:0x401F
    ds_swizzle_b32 v70, v70 offset:0x401F
    ds_swizzle_b32 v71, v71 offset:0x401F
    s_waitcnt vmcnt(8)
    ds_read_b64_tr_b16 v[176:177], v244 offset:4096
    ds_read_b64_tr_b16 v[178:179], v244 offset:5120
    ds_read_b64_tr_b16 v[180:181], v245 offset:4096
    ds_read_b64_tr_b16 v[182:183], v245 offset:5120
    v_fmac_f32 v254, v5, v149
    v_fmac_f32 v254, v6, v150
    v_fmac_f32 v254, v7, v151
    v_fmac_f32 v200, v8, v160
    v_mfma_f32_32x32x16_bf16 v[32:47], v[72:75], v[184:187], v[32:47]
    v_fmac_f32 v200, v9, v161
    v_permlane32_swap_b32 v196, v254
    v_fmac_f32 v200, v10, v162
    v_fmac_f32 v200, v11, v163
    v_fmac_f32 v200, v12, v164
    v_mfma_f32_32x32x16_bf16 v[48:63], v[76:79], v[184:187], v[48:63]
    ds_swizzle_b32 v76, v76 offset:0x401F
    ds_swizzle_b32 v77, v77 offset:0x401F
    ds_swizzle_b32 v78, v78 offset:0x401F
    ds_swizzle_b32 v79, v79 offset:0x401F
    v_fmac_f32 v200, v13, v165
    v_fmac_f32 v200, v14, v166
    v_fmac_f32 v200, v15, v167
    v_add_f32 v254, v196, v254
    s_waitcnt lgkmcnt(8)
    s_mov_b64 exec, s[56:57]
    v_xor_b32 v68, 0x80008000, v68
    v_xor_b32 v69, 0x80008000, v69
    v_xor_b32 v70, 0x80008000, v70
    v_xor_b32 v71, 0x80008000, v71
    s_mov_b64 exec, -1
    s_waitcnt vmcnt(4) lgkmcnt(4)
    v_mfma_f32_32x32x16_bf16 v[0:15], v[64:67], v[176:179], 0
    v_mul_f32 v255, v32, v152
    v_fmac_f32 v255, v33, v153
    v_fmac_f32 v255, v34, v154
    v_fmac_f32 v255, v35, v155
    v_fmac_f32 v255, v36, v156
    v_fmac_f32 v255, v37, v157
    s_add_u32 m0, s21, 4096
    v_mfma_f32_32x32x16_bf16 v[16:31], v[68:71], v[176:179], v[16:31]
    v_lshl_add_u32 v238, v238, 10, v246
    v_lshl_add_u32 v239, v239, 10, v246
    buffer_load_dwordx4 v238, s[4:7], s40 offen  lds
    buffer_load_dwordx4 v239, s[8:11], s40 offen offset:1024  lds
    ds_read_b64_tr_b16 v[176:177], v244 offset:6144
    ds_read_b64_tr_b16 v[178:179], v244 offset:7168
    ds_read_b64_tr_b16 v[184:185], v245 offset:6144
    ds_read_b64_tr_b16 v[186:187], v245 offset:7168
    v_fmac_f32 v255, v38, v158
    v_fmac_f32 v255, v39, v159
    v_fmac_f32 v201, v40, v168
    v_fmac_f32 v201, v41, v169
    v_permlane32_swap_b32 v197, v255
    s_waitcnt lgkmcnt(0)
    s_mov_b64 exec, s[56:57]
    v_xor_b32 v76, 0x80008000, v76
    v_xor_b32 v77, 0x80008000, v77
    v_xor_b32 v78, 0x80008000, v78
    v_xor_b32 v79, 0x80008000, v79
    s_mov_b64 exec, -1
    v_mfma_f32_32x32x16_bf16 v[0:15], v[72:75], v[176:179], v[0:15]
    v_fmac_f32 v201, v42, v170
    v_fmac_f32 v201, v43, v171
    v_fmac_f32 v201, v44, v172
    v_fmac_f32 v201, v45, v173
    v_fmac_f32 v201, v46, v174
    v_fmac_f32 v201, v47, v175
    s_add_u32 m0, s21, 6144
    v_mfma_f32_32x32x16_bf16 v[16:31], v[76:79], v[176:179], v[16:31]
    v_lshl_add_u32 v240, v240, 10, v246
    v_lshl_add_u32 v241, v241, 10, v246
    buffer_load_dwordx4 v240, s[4:7], s41 offen  lds
    buffer_load_dwordx4 v241, s[8:11], s41 offen offset:1024  lds
    v_add_f32 v255, v197, v255
    s_set_gpr_idx_on s51, gpr_idx(DST)
    s_nop 0
    v_cvt_pk_bf16_f32 v206, v254, v255
    s_set_gpr_idx_off
    v_mfma_f32_32x32x16_bf16 v[32:47], v[64:67], v[180:183], 0
    v_mul_f32 v254, v0, v144
    v_fmac_f32 v254, v1, v145
    v_fmac_f32 v254, v2, v146
    v_fmac_f32 v254, v3, v147
    v_fmac_f32 v254, v4, v148
    v_fmac_f32 v254, v5, v149
    v_fmac_f32 v254, v6, v150
    v_fmac_f32 v254, v7, v151
    v_fma_f32 v202, v8, -v160, v202
    v_fma_f32 v202, v9, -v161, v202
    v_mfma_f32_32x32x16_bf16 v[48:63], v[68:71], v[180:183], v[48:63]
    s_waitcnt vmcnt(6)
    ds_read_b64_tr_b16 v[176:177], v244 offset:0
    ds_read_b64_tr_b16 v[178:179], v244 offset:1024
    ds_read_b64_tr_b16 v[180:181], v245 offset:0
    ds_read_b64_tr_b16 v[182:183], v245 offset:1024
    v_permlane32_swap_b32 v254, v200
    v_fma_f32 v202, v10, -v162, v202
    v_fma_f32 v202, v11, -v163, v202
    v_fma_f32 v202, v12, -v164, v202
    v_fma_f32 v202, v13, -v165, v202
    v_fma_f32 v202, v14, -v166, v202
    v_fma_f32 v202, v15, -v167, v202
    v_add_f32 v200, v254, v200
    v_fmac_f32 v198, v16, v112
    v_permlane32_swap_b32 v202, v254
    v_mfma_f32_32x32x16_bf16 v[32:47], v[72:75], v[184:187], v[32:47]
    v_fmac_f32 v198, v17, v113
    v_fmac_f32 v198, v18, v114
    v_fmac_f32 v198, v19, v115
    v_fmac_f32 v198, v20, v116
    v_fmac_f32 v198, v21, v117
    v_fmac_f32 v198, v22, v118
    v_fmac_f32 v198, v23, v119
    v_add_f32 v254, v202, v254
    v_mul_f32 v196, v24, v160
    v_fmac_f32 v196, v25, v161
    v_mfma_f32_32x32x16_bf16 v[48:63], v[76:79], v[184:187], v[48:63]
    v_add_u32 v249, s48, v249
    v_add_u32 v250, s49, v250
    ds_read_b64_tr_b16 v[64:65], v249 offset:0
    ds_read_b64_tr_b16 v[68:69], v249 offset:64
    ds_read_b64_tr_b16 v[66:67], v249 offset:256
    ds_read_b64_tr_b16 v[70:71], v249 offset:320
    s_mov_b64 exec, s[54:55]
    ds_read_u16_d16_hi v242, v250 offset:0
    s_mov_b64 exec, -1
    v_fmac_f32 v196, v26, v162
    v_fmac_f32 v196, v27, v163
    v_fmac_f32 v196, v28, v164
    v_fmac_f32 v196, v29, v165
    v_fmac_f32 v196, v30, v166
    v_fmac_f32 v196, v31, v167
    s_nop 1
    v_permlane32_swap_b32 v198, v196
    v_add_f32 v196, v198, v196
    v_mul_f32 v255, v32, v152
    v_fmac_f32 v255, v33, v153
    v_fmac_f32 v255, v34, v154
    v_fmac_f32 v255, v35, v155
    v_fmac_f32 v255, v36, v156
    v_fmac_f32 v255, v37, v157
    v_fmac_f32 v255, v38, v158
    v_fmac_f32 v255, v39, v159
    v_fma_f32 v203, v40, -v168, v203
    v_fma_f32 v203, v41, -v169, v203
    v_permlane32_swap_b32 v255, v201
    v_fma_f32 v203, v42, -v170, v203
    v_fma_f32 v203, v43, -v171, v203
    v_fma_f32 v203, v44, -v172, v203
    v_fma_f32 v203, v45, -v173, v203
    v_fma_f32 v203, v46, -v174, v203
    v_fma_f32 v203, v47, -v175, v203
    v_add_f32 v201, v255, v201
    v_fmac_f32 v199, v48, v120
    v_permlane32_swap_b32 v203, v255
    v_fmac_f32 v199, v49, v121
    v_fmac_f32 v199, v50, v122
    v_fmac_f32 v199, v51, v123
    v_fmac_f32 v199, v52, v124
    v_fmac_f32 v199, v53, v125
    v_fmac_f32 v199, v54, v126
    v_fmac_f32 v199, v55, v127
    v_add_f32 v255, v203, v255
    v_mul_f32 v197, v56, v168
    v_fmac_f32 v197, v57, v169
    v_fmac_f32 v197, v58, v170
    v_fmac_f32 v197, v59, v171
    v_fmac_f32 v197, v60, v172
    v_fmac_f32 v197, v61, v173
    v_fmac_f32 v197, v62, v174
    v_fmac_f32 v197, v63, v175
    s_nop 1
    v_permlane32_swap_b32 v199, v197
    v_add_f32 v197, v199, v197
    s_set_gpr_idx_on s51, gpr_idx(DST)
    s_nop 0
    v_cvt_pk_bf16_f32 v207, v200, v201
    v_cvt_pk_bf16_f32 v209, v254, v255
    v_cvt_pk_bf16_f32 v208, v196, v197
    s_set_gpr_idx_off
    s_add_u32 s50, s50, 1
    s_add_u32 s51, s51, 6
    s_cmp_ge_u32 s50, 4
    s_cbranch_scc1 LAST0
    s_add_u32 s53, s53, 4
    s_xor_b32 s66, s53, s20
    s_bitcmp1_b32 s66, 2
    s_setprio 1
    s_cbranch_scc1 PRIO_5
    s_setprio 0
PRIO_5:
    s_cmp_eq_u32 s52, 4
    s_cbranch_scc1 ITEM_0_4
    s_cmp_eq_u32 s52, 5
    s_cbranch_scc1 ITEM_0_5
    s_cmp_eq_u32 s52, 3
    s_cbranch_scc1 ITEM_0_3
    s_cmp_eq_u32 s52, 6
    s_cbranch_scc1 ITEM_0_6
    s_cmp_eq_u32 s52, 8
    s_cbranch_scc1 ITEM_0_8
    s_branch ITEM_0_2
.p2align 6
ITEM_0_5:
    s_mov_b64 exec, s[54:55]
    ds_read_u16_d16_hi v243, v250 offset:128
    s_mov_b64 exec, -1
    ds_read_b64_tr_b16 v[72:73], v249 offset:512
    ds_read_b64_tr_b16 v[76:77], v249 offset:576
    ds_read_b64_tr_b16 v[74:75], v249 offset:768
    ds_read_b64_tr_b16 v[78:79], v249 offset:832
    ds_read_b64_tr_b16 v[80:81], v249 offset:1024
    ds_read_b64_tr_b16 v[84:85], v249 offset:1088
    s_waitcnt lgkmcnt(7)
    v_mul_f32_dpp v196, v242, v64 row_newbcast:0 row_mask:0xf bank_mask:0xf
    v_mul_f32_dpp v197, v242, v65 row_newbcast:1 row_mask:0xf bank_mask:0xf
    v_mul_f32_dpp v198, v242, v64 row_newbcast:8 row_mask:0xf bank_mask:0xf
    v_mul_f32_dpp v199, v242, v65 row_newbcast:9 row_mask:0xf bank_mask:0xf
    v_mul_f32_dpp v200, v242, v68 row_newbcast:2 row_mask:0xf bank_mask:0xf
    v_mul_f32_dpp v201, v242, v69 row_newbcast:3 row_mask:0xf bank_mask:0xf
    v_mul_f32_dpp v202, v242, v68 row_newbcast:10 row_mask:0xf bank_mask:0xf
    v_mul_f32_dpp v203, v242, v69 row_newbcast:11 row_mask:0xf bank_mask:0xf
    v_cvt_pk_bf16_f32 v64, v196, v197
    v_cvt_pk_bf16_f32 v68, v198, v199
    v_cvt_pk_bf16_f32 v65, v200, v201
    v_cvt_pk_bf16_f32 v69, v202, v203
    v_mul_f32_dpp v196, v242, v66 row_newbcast:4 row_mask:0xf bank_mask:0xf
    v_mul_f32_dpp v197, v242, v67 row_newbcast:5 row_mask:0xf bank_mask:0xf
    v_mul_f32_dpp v198, v242, v66 row_newbcast:12 row_mask:0xf bank_mask:0xf
    v_mul_f32_dpp v199, v242, v67 row_newbcast:13 row_mask:0xf bank_mask:0xf
    v_mul_f32_dpp v200, v242, v70 row_newbcast:6 row_mask:0xf bank_mask:0xf
    v_mul_f32_dpp v201, v242, v71 row_newbcast:7 row_mask:0xf bank_mask:0xf
    v_mul_f32_dpp v202, v242, v70 row_newbcast:14 row_mask:0xf bank_mask:0xf
    v_mul_f32_dpp v203, v242, v71 row_newbcast:15 row_mask:0xf bank_mask:0xf
    v_cvt_pk_bf16_f32 v66, v196, v197
    v_cvt_pk_bf16_f32 v70, v198, v199
    v_cvt_pk_bf16_f32 v67, v200, v201
    v_cvt_pk_bf16_f32 v71, v202, v203
    s_mov_b64 exec, s[54:55]
    ds_read_u16_d16_hi v242, v250 offset:256
    s_mov_b64 exec, -1
    s_waitcnt vmcnt(4) lgkmcnt(3)
    v_mfma_f32_32x32x16_bf16 v[0:15], v[64:67], v[176:179], 0
    v_mul_f32_dpp v196, v243, v72 row_newbcast:0 row_mask:0xf bank_mask:0xf
    v_mul_f32_dpp v197, v243, v73 row_newbcast:1 row_mask:0xf bank_mask:0xf
    v_mul_f32_dpp v198, v243, v72 row_newbcast:8 row_mask:0xf bank_mask:0xf
    v_mul_f32_dpp v199, v243, v73 row_newbcast:9 row_mask:0xf bank_mask:0xf
    v_mul_f32_dpp v200, v243, v76 row_newbcast:2 row_mask:0xf bank_mask:0xf
    v_mul_f32_dpp v201, v243, v77 row_newbcast:3 row_mask:0xf bank_mask:0xf
    v_mul_f32_dpp v202, v243, v76 row_newbcast:10 row_mask:0xf bank_mask:0xf
    v_mul_f32_dpp v203, v243, v77 row_newbcast:11 row_mask:0xf bank_mask:0xf
    v_cvt_pk_bf16_f32 v72, v196, v197
    v_cvt_pk_bf16_f32 v76, v198, v199
    v_cvt_pk_bf16_f32 v73, v200, v201
    v_cvt_pk_bf16_f32 v77, v202, v203
    s_add_u32 m0, s21, 0
    v_mfma_f32_32x32x16_bf16 v[16:31], v[68:71], v[176:179], 0
    buffer_load_dwordx4 v236, s[4:7], s35 offen  lds
    buffer_load_dwordx4 v237, s[8:11], s35 offen offset:1024  lds
    ds_read_b64_tr_b16 v[176:177], v244 offset:2048
    ds_read_b64_tr_b16 v[178:179], v244 offset:3072
    ds_read_b64_tr_b16 v[184:185], v245 offset:2048
    ds_read_b64_tr_b16 v[186:187], v245 offset:3072
    v_mul_f32_dpp v196, v243, v74 row_newbcast:4 row_mask:0xf bank_mask:0xf
    v_mul_f32_dpp v197, v243, v75 row_newbcast:5 row_mask:0xf bank_mask:0xf
    v_mul_f32_dpp v198, v243, v74 row_newbcast:12 row_mask:0xf bank_mask:0xf
    v_mul_f32_dpp v199, v243, v75 row_newbcast:13 row_mask:0xf bank_mask:0xf
    v_mul_f32_dpp v200, v243, v78 row_newbcast:6 row_mask:0xf bank_mask:0xf
    v_mul_f32_dpp v201, v243, v79 row_newbcast:7 row_mask:0xf bank_mask:0xf
    v_mul_f32_dpp v202, v243, v78 row_newbcast:14 row_mask:0xf bank_mask:0xf
    v_mul_f32_dpp v203, v243, v79 row_newbcast:15 row_mask:0xf bank_mask:0xf
    v_cvt_pk_bf16_f32 v74, v196, v197
    v_cvt_pk_bf16_f32 v78, v198, v199
    v_cvt_pk_bf16_f32 v75, v200, v201
    v_cvt_pk_bf16_f32 v79, v202, v203
    s_nop 0
    s_waitcnt vmcnt(4) lgkmcnt(0)
    v_mfma_f32_32x32x16_bf16 v[0:15], v[72:75], v[176:179], v[0:15]
    v_mul_f32_dpp v196, v242, v80 row_newbcast:0 row_mask:0xf bank_mask:0xf
    v_mul_f32_dpp v197, v242, v81 row_newbcast:1 row_mask:0xf bank_mask:0xf
    v_mul_f32_dpp v198, v242, v80 row_newbcast:8 row_mask:0xf bank_mask:0xf
    v_mul_f32_dpp v199, v242, v81 row_newbcast:9 row_mask:0xf bank_mask:0xf
    v_mul_f32_dpp v200, v242, v84 row_newbcast:2 row_mask:0xf bank_mask:0xf
    v_mul_f32_dpp v201, v242, v85 row_newbcast:3 row_mask:0xf bank_mask:0xf
    s_add_u32 m0, s21, 2048
    v_mfma_f32_32x32x16_bf16 v[16:31], v[76:79], v[176:179], v[16:31]
    buffer_load_dwordx4 v238, s[4:7], s35 offen  lds
    ds_read_b64_tr_b16 v[176:177], v244 offset:4096
    ds_read_b64_tr_b16 v[188:189], v245 offset:4096
    v_mul_f32_dpp v202, v242, v84 row_newbcast:10 row_mask:0xf bank_mask:0xf
    v_mul_f32_dpp v203, v242, v85 row_newbcast:11 row_mask:0xf bank_mask:0xf
    v_cvt_pk_bf16_f32 v80, v196, v197
    v_cvt_pk_bf16_f32 v84, v198, v199
    v_cvt_pk_bf16_f32 v81, v200, v201
    v_cvt_pk_bf16_f32 v85, v202, v203
    s_nop 0
    s_waitcnt lgkmcnt(0)
    v_mfma_f32_32x32x8_bf16 v[0:15], v[80:81], v[176:177], v[0:15]
    s_add_u32 m0, s21, 4096
    v_mfma_f32_32x32x8_bf16 v[16:31], v[84:85], v[176:177], v[16:31]
    buffer_load_dwordx4 v234, s[4:7], s36 offen  lds
    buffer_load_dwordx4 v235, s[8:11], s36 offen offset:1024  lds
    s_mov_b32 m0, s50
    s_nop 0
    s_movrels_b32 s71, s23
    s_bfe_u32 s46, s71, 0x30012
    s_mov_b32 m0, s46
    s_and_b32 s66, s71, 0x3ffff
    s_movrels_b32 s68, s57
    s_movrels_b32 s69, s61
    s_sub_u32 s48, s66, s47
    s_mov_b32 s47, s66
    s_lshr_b32 s52, s71, 28
    s_lshl_b32 s67, s46, 9
    s_add_u32 s66, s66, s67
    s_sub_u32 s49, s66, s42
    s_mov_b32 s42, s66
    s_bfe_u32 s66, s68, 655360
    s_add_u32 s43, s42, s66
    s_bfe_u32 s39, s69, 655360
    s_bfe_u32 s66, s68, 655370
    s_add_u32 s44, s42, s66
    s_bfe_u32 s40, s69, 655370
    s_bfe_u32 s66, s68, 655380
    s_add_u32 s45, s42, s66
    s_bfe_u32 s41, s69, 655380
    s_and_b32 s66, s46, s33
    s_cselect_b32 s72, -1, 1
    s_cselect_b32 s76, s47, 163712
    s_cmp_ge_u32 s66, 2
    s_cselect_b32 s73, -1, 0
    s_add_u32 s77, s47, 1024
    s_cmp_ge_u32 s66, 4
    s_cselect_b32 s75, -1, 0
    s_cmp_ge_u32 s66, 3
    s_cselect_b32 s74, -1, 1
    s_cselect_b32 s77, s77, 163712
    v_add_u32 v252, s45, v247
    ds_read_u16 v240, v252
    ds_read_u16 v241, v252 offset:64
    v_mfma_f32_32x32x16_bf16 v[32:47], v[64:67], v[180:183], 0
    v_mul_f32 v196, v0, v96
    v_fmac_f32 v196, v1, v97
    v_fmac_f32 v196, v2, v98
    v_fmac_f32 v196, v3, v99
    v_fmac_f32 v196, v4, v100
    v_fmac_f32 v196, v5, v101
    v_fmac_f32 v196, v6, v102
    v_mfma_f32_32x32x16_bf16 v[48:63], v[68:71], v[180:183], 0
    v_add_u32 v253, s47, v248
    ds_read_b32 v254, v253
    ds_read_b32 v255, v253 offset:256
    v_fmac_f32 v196, v7, v103
    v_mul_f32 v198, v8, v128
    v_fmac_f32 v198, v9, v129
    v_fmac_f32 v198, v10, v130
    v_fmac_f32 v198, v11, v131
    v_fmac_f32 v198, v12, v132
    v_mfma_f32_32x32x16_bf16 v[32:47], v[72:75], v[184:187], v[32:47]
    v_fmac_f32 v198, v13, v133
    v_fmac_f32 v198, v14, v134
    v_fmac_f32 v198, v15, v135
    v_mul_f32 v200, v16, v128
    v_fmac_f32 v200, v17, v129
    v_permlane32_swap_b32 v196, v198
    v_mfma_f32_32x32x16_bf16 v[48:63], v[76:79], v[184:187], v[48:63]
    s_waitcnt vmcnt(5)
    ds_read_b64_tr_b16 v[176:177], v244 offset:6144
    ds_read_b64_tr_b16 v[178:179], v244 offset:7168
    ds_read_b64_tr_b16 v[180:181], v245 offset:6144
    ds_read_b64_tr_b16 v[182:183], v245 offset:7168
    v_fmac_f32 v200, v18, v130
    v_fmac_f32 v200, v19, v131
    v_fmac_f32 v200, v20, v132
    v_fmac_f32 v200, v21, v133
    v_fmac_f32 v200, v22, v134
    v_fmac_f32 v200, v23, v135
    v_mfma_f32_32x32x8_bf16 v[32:47], v[80:81], v[188:189], v[32:47]
    v_add_f32 v198, v196, v198
    v_mul_f32_e64 v202, v24, -v128
    v_fma_f32 v202, v25, -v129, v202
    v_fma_f32 v202, v26, -v130, v202
    v_fma_f32 v202, v27, -v131, v202
    v_fma_f32 v202, v28, -v132, v202
    v_mfma_f32_32x32x8_bf16 v[48:63], v[84:85], v[188:189], v[48:63]
    v_fma_f32 v202, v29, -v133, v202
    v_fma_f32 v202, v30, -v134, v202
    v_fma_f32 v202, v31, -v135, v202
    s_nop 1
    v_permlane32_swap_b32 v200, v202
    v_add_f32 v202, v200, v202
    s_waitcnt vmcnt(3) lgkmcnt(0)
    v_mfma_f32_32x32x16_bf16 v[0:15], v[64:67], v[176:179], 0
    v_mul_f32 v197, v32, v104
    v_fmac_f32 v197, v33, v105
    v_fmac_f32 v197, v34, v106
    v_fmac_f32 v197, v35, v107
    v_fmac_f32 v197, v36, v108
    v_fmac_f32 v197, v37, v109
    v_fmac_f32 v197, v38, v110
    s_add_u32 m0, s21, 6144
    v_mfma_f32_32x32x16_bf16 v[16:31], v[68:71], v[176:179], 0
    buffer_load_dwordx4 v236, s[4:7], s36 offen  lds
    buffer_load_dwordx4 v237, s[8:11], s36 offen offset:1024  lds
    ds_read_b64_tr_b16 v[176:177], v244 offset:0
    ds_read_b64_tr_b16 v[178:179], v244 offset:1024
    ds_read_b64_tr_b16 v[184:185], v245 offset:0
    ds_read_b64_tr_b16 v[186:187], v245 offset:1024
    s_mov_b32 m0, s76
    s_mov_b64 exec, s[72:73]
    buffer_load_dwordx4 v254, s[12:15], 0 offen  lds
    s_mov_b32 m0, s77
    s_mov_b64 exec, s[74:75]
    buffer_load_dwordx4 v255, s[12:15], 0 offen  lds
    s_mov_b64 exec, -1
    v_fmac_f32 v197, v39, v111
    v_mul_f32 v199, v40, v136
    v_fmac_f32 v199, v41, v137
    v_fmac_f32 v199, v42, v138
    v_fmac_f32 v199, v43, v139
    v_fmac_f32 v199, v44, v140
    v_fmac_f32 v199, v45, v141
    s_waitcnt vmcnt(6) lgkmcnt(0)
    v_mfma_f32_32x32x16_bf16 v[0:15], v[72:75], v[176:179], v[0:15]
    v_fmac_f32 v199, v46, v142
    v_fmac_f32 v199, v47, v143
    v_mul_f32 v201, v48, v136
    v_fmac_f32 v201, v49, v137
    v_permlane32_swap_b32 v197, v199
    v_fmac_f32 v201, v50, v138
    v_fmac_f32 v201, v51, v139
    s_add_u32 m0, s21, 0
    v_mfma_f32_32x32x16_bf16 v[16:31], v[76:79], v[176:179], v[16:31]
    buffer_load_dwordx4 v238, s[4:7], s36 offen  lds
    ds_read_b64_tr_b16 v[176:177], v244 offset:2048
    ds_read_b64_tr_b16 v[188:189], v245 offset:2048
    v_fmac_f32 v201, v52, v140
    v_fmac_f32 v201, v53, v141
    v_fmac_f32 v201, v54, v142
    v_fmac_f32 v201, v55, v143
    v_add_f32 v199, v197, v199
    v_mul_f32_e64 v203, v56, -v136
    v_fma_f32 v203, v57, -v137, v203
    s_waitcnt lgkmcnt(0)
    v_mfma_f32_32x32x8_bf16 v[0:15], v[80:81], v[176:177], v[0:15]
    v_fma_f32 v203, v58, -v138, v203
    v_fma_f32 v203, v59, -v139, v203
    v_fma_f32 v203, v60, -v140, v203
    v_fma_f32 v203, v61, -v141, v203
    v_fma_f32 v203, v62, -v142, v203
    v_fma_f32 v203, v63, -v143, v203
    s_nop 1
    s_add_u32 m0, s21, 2048
    v_mfma_f32_32x32x8_bf16 v[16:31], v[84:85], v[176:177], v[16:31]
    buffer_load_dwordx4 v234, s[4:7], s37 offen  lds
    buffer_load_dwordx4 v235, s[8:11], s37 offen offset:1024  lds
    v_add_u32 v252, s42, v247
    ds_read_u16 v234, v252
    ds_read_u16 v235, v252 offset:64
    v_permlane32_swap_b32 v201, v203
    v_add_f32 v203, v201, v203
    s_set_gpr_idx_on s51, gpr_idx(DST)
    s_nop 0
    v_cvt_pk_bf16_f32 v204, v198, v199
    v_cvt_pk_bf16_f32 v205, v202, v203
    s_set_gpr_idx_off
    v_mfma_f32_32x32x16_bf16 v[32:47], v[64:67], v[180:183], 0
    v_mul_f32 v196, v0, v144
    v_fmac_f32 v196, v1, v145
    v_fmac_f32 v196, v2, v146
    v_fmac_f32 v196, v3, v147
    v_fmac_f32 v196, v4, v148
    v_fmac_f32 v196, v5, v149
    v_mfma_f32_32x32x16_bf16 v[48:63], v[68:71], v[180:183], 0
    v_fmac_f32 v196, v6, v150
    v_fmac_f32 v196, v7, v151
    v_mul_f32 v198, v8, v112
    v_fmac_f32 v198, v9, v113
    v_fmac_f32 v198, v10, v114
    v_mfma_f32_32x32x16_bf16 v[32:47], v[72:75], v[184:187], v[32:47]
    v_fmac_f32 v198, v11, v115
    v_fmac_f32 v198, v12, v116
    v_fmac_f32 v198, v13, v117
    v_fmac_f32 v198, v14, v118
    v_fmac_f32 v198, v15, v119
    v_mfma_f32_32x32x16_bf16 v[48:63], v[76:79], v[184:187], v[48:63]
    s_waitcnt vmcnt(7)
    ds_read_b64_tr_b16 v[176:177], v244 offset:4096
    ds_read_b64_tr_b16 v[178:179], v244 offset:5120
    ds_read_b64_tr_b16 v[180:181], v245 offset:4096
    ds_read_b64_tr_b16 v[182:183], v245 offset:5120
    v_mul_f32_e64 v200, v16, -v160
    v_fma_f32 v200, v17, -v161, v200
    v_fma_f32 v200, v18, -v162, v200
    v_fma_f32 v200, v19, -v163, v200
    v_fma_f32 v200, v20, -v164, v200
    v_fma_f32 v200, v21, -v165, v200
    v_mfma_f32_32x32x8_bf16 v[32:47], v[80:81], v[188:189], v[32:47]
    v_fma_f32 v200, v22, -v166, v200
    v_fma_f32 v200, v23, -v167, v200
    v_mul_f32_e64 v202, v24, -v160
    v_fma_f32 v202, v25, -v161, v202
    v_fma_f32 v202, v26, -v162, v202
    v_mfma_f32_32x32x8_bf16 v[48:63], v[84:85], v[188:189], v[48:63]
    v_fma_f32 v202, v27, -v163, v202
    v_fma_f32 v202, v28, -v164, v202
    v_fma_f32 v202, v29, -v165, v202
    v_fma_f32 v202, v30, -v166, v202
    v_fma_f32 v202, v31, -v167, v202
    s_waitcnt vmcnt(5) lgkmcnt(0)
    v_mfma_f32_32x32x16_bf16 v[0:15], v[64:67], v[176:179], 0
    v_mul_f32 v197, v32, v152
    v_fmac_f32 v197, v33, v153
    v_fmac_f32 v197, v34, v154
    v_fmac_f32 v197, v35, v155
    v_fmac_f32 v197, v36, v156
    v_fmac_f32 v197, v37, v157
    s_add_u32 m0, s21, 4096
    v_mfma_f32_32x32x16_bf16 v[16:31], v[68:71], v[176:179], 0
    buffer_load_dwordx4 v236, s[4:7], s37 offen  lds
    buffer_load_dwordx4 v237, s[8:11], s37 offen offset:1024  lds
    ds_read_b64_tr_b16 v[176:177], v244 offset:6144
    ds_read_b64_tr_b16 v[178:179], v244 offset:7168
    ds_read_b64_tr_b16 v[184:185], v245 offset:6144
    ds_read_b64_tr_b16 v[186:187], v245 offset:7168
    v_add_u32 v252, s43, v247
    ds_read_u16 v236, v252
    ds_read_u16 v237, v252 offset:64
    v_fmac_f32 v197, v38, v158
    v_fmac_f32 v197, v39, v159
    v_mul_f32 v199, v40, v120
    v_fmac_f32 v199, v41, v121
    v_fmac_f32 v199, v42, v122
    s_waitcnt vmcnt(4) lgkmcnt(2)
    v_mfma_f32_32x32x16_bf16 v[0:15], v[72:75], v[176:179], v[0:15]
    v_fmac_f32 v199, v43, v123
    v_fmac_f32 v199, v44, v124
    v_fmac_f32 v199, v45, v125
    v_fmac_f32 v199, v46, v126
    v_fmac_f32 v199, v47, v127
    s_add_u32 m0, s21, 6144
    v_mfma_f32_32x32x16_bf16 v[16:31], v[76:79], v[176:179], v[16:31]
    buffer_load_dwordx4 v238, s[4:7], s37 offen  lds
    ds_read_b64_tr_b16 v[176:177], v244 offset:0
    ds_read_b64_tr_b16 v[188:189], v245 offset:0
    v_add_u32 v252, s44, v247
    ds_read_u16 v238, v252
    ds_read_u16 v239, v252 offset:64
    v_mul_f32_e64 v201, v48, -v168
    v_fma_f32 v201, v49, -v169, v201
    v_fma_f32 v201, v50, -v170, v201
    v_fma_f32 v201, v51, -v171, v201
    v_fma_f32 v201, v52, -v172, v201
    v_fma_f32 v201, v53, -v173, v201
    s_waitcnt lgkmcnt(2)
    v_mfma_f32_32x32x8_bf16 v[0:15], v[80:81], v[176:177], v[0:15]
    v_fma_f32 v201, v54, -v174, v201
    v_fma_f32 v201, v55, -v175, v201
    v_mul_f32_e64 v203, v56, -v168
    v_fma_f32 v203, v57, -v169, v203
    v_fma_f32 v203, v58, -v170, v203
    s_add_u32 m0, s21, 0
    v_mfma_f32_32x32x8_bf16 v[16:31], v[84:85], v[176:177], v[16:31]
    v_lshl_add_u32 v234, v234, 10, v246
    v_lshl_add_u32 v235, v235, 10, v246
    buffer_load_dwordx4 v234, s[4:7], s38 offen  lds
    buffer_load_dwordx4 v235, s[8:11], s38 offen offset:1024  lds
    v_fma_f32 v203, v59, -v171, v203
    v_fma_f32 v203, v60, -v172, v203
    v_fma_f32 v203, v61, -v173, v203
    v_fma_f32 v203, v62, -v174, v203
    v_fma_f32 v203, v63, -v175, v203
    v_mfma_f32_32x32x16_bf16 v[32:47], v[64:67], v[180:183], 0
    v_mul_f32 v254, v0, v144
    v_fmac_f32 v254, v1, v145
    v_fmac_f32 v254, v2, v146
    v_mfma_f32_32x32x16_bf16 v[48:63], v[68:71], v[180:183], 0
    ds_swizzle_b32 v68, v68 offset:0x401F
    ds_swizzle_b32 v69, v69 offset:0x401F
    ds_swizzle_b32 v70, v70 offset:0x401F
    ds_swizzle_b32 v71, v71 offset:0x401F
    v_fmac_f32 v254, v3, v147
    v_fmac_f32 v254, v4, v148
    v_fmac_f32 v254, v5, v149
    v_mfma_f32_32x32x16_bf16 v[32:47], v[72:75], v[184:187], v[32:47]
    v_fmac_f32 v254, v6, v150
    v_fmac_f32 v254, v7, v151
    v_fmac_f32 v200, v8, v160
    v_mfma_f32_32x32x16_bf16 v[48:63], v[76:79], v[184:187], v[48:63]
    ds_swizzle_b32 v76, v76 offset:0x401F
    ds_swizzle_b32 v77, v77 offset:0x401F
    ds_swizzle_b32 v78, v78 offset:0x401F
    ds_swizzle_b32 v79, v79 offset:0x401F
    s_waitcnt vmcnt(5)
    ds_read_b64_tr_b16 v[176:177], v244 offset:2048
    ds_read_b64_tr_b16 v[178:179], v244 offset:3072
    ds_read_b64_tr_b16 v[180:181], v245 offset:2048
    ds_read_b64_tr_b16 v[182:183], v245 offset:3072
    v_fmac_f32 v200, v9, v161
    v_permlane32_swap_b32 v196, v254
    v_fmac_f32 v200, v10, v162
    v_mfma_f32_32x32x8_bf16 v[32:47], v[80:81], v[188:189], v[32:47]
    v_fmac_f32 v200, v11, v163
    v_fmac_f32 v200, v12, v164
    v_fmac_f32 v200, v13, v165
    v_mfma_f32_32x32x8_bf16 v[48:63], v[84:85], v[188:189], v[48:63]
    ds_swizzle_b32 v84, v84 offset:0x401F
    ds_swizzle_b32 v85, v85 offset:0x401F
    v_fmac_f32 v200, v14, v166
    v_fmac_f32 v200, v15, v167
    v_add_f32 v254, v196, v254
    s_waitcnt lgkmcnt(6)
    s_mov_b64 exec, s[56:57]
    v_xor_b32 v68, 0x80008000, v68
    v_xor_b32 v69, 0x80008000, v69
    v_xor_b32 v70, 0x80008000, v70
    v_xor_b32 v71, 0x80008000, v71
    v_xor_b32 v76, 0x80008000, v76
    v_xor_b32 v77, 0x80008000, v77
    v_xor_b32 v78, 0x80008000, v78
    v_xor_b32 v79, 0x80008000, v79
    s_mov_b64 exec, -1
    s_waitcnt vmcnt(3) lgkmcnt(2)
    v_mfma_f32_32x32x16_bf16 v[0:15], v[64:67], v[176:179], 0
    v_mul_f32 v255, v32, v152
    v_fmac_f32 v255, v33, v153
    v_fmac_f32 v255, v34, v154
    v_fmac_f32 v255, v35, v155
    s_add_u32 m0, s21, 2048
    v_mfma_f32_32x32x16_bf16 v[16:31], v[68:71], v[176:179], v[16:31]
    v_lshl_add_u32 v236, v236, 10, v246
    v_lshl_add_u32 v237, v237, 10, v246
    buffer_load_dwordx4 v236, s[4:7], s39 offen  lds
    buffer_load_dwordx4 v237, s[8:11], s39 offen offset:1024  lds
    ds_read_b64_tr_b16 v[176:177], v244 offset:4096
    ds_read_b64_tr_b16 v[178:179], v244 offset:5120
    ds_read_b64_tr_b16 v[184:185], v245 offset:4096
    ds_read_b64_tr_b16 v[186:187], v245 offset:5120
    v_fmac_f32 v255, v36, v156
    v_fmac_f32 v255, v37, v157
    v_fmac_f32 v255, v38, v158
    v_fmac_f32 v255, v39, v159
    s_waitcnt vmcnt(4) lgkmcnt(0)
    v_mfma_f32_32x32x16_bf16 v[0:15], v[72:75], v[176:179], v[0:15]
    v_fmac_f32 v201, v40, v168
    v_fmac_f32 v201, v41, v169
    v_permlane32_swap_b32 v197, v255
    s_add_u32 m0, s21, 4096
    v_mfma_f32_32x32x16_bf16 v[16:31], v[76:79], v[176:179], v[16:31]
    v_lshl_add_u32 v238, v238, 10, v246
    v_lshl_add_u32 v239, v239, 10, v246
    buffer_load_dwordx4 v238, s[4:7], s40 offen  lds
    buffer_load_dwordx4 v239, s[8:11], s40 offen offset:1024  lds
    ds_read_b64_tr_b16 v[176:177], v244 offset:6144
    ds_read_b64_tr_b16 v[188:189], v245 offset:6144
    v_fmac_f32 v201, v42, v170
    v_fmac_f32 v201, v43, v171
    v_fmac_f32 v201, v44, v172
    v_fmac_f32 v201, v45, v173
    s_waitcnt lgkmcnt(0)
    s_mov_b64 exec, s[56:57]
    v_xor_b32 v84, 0x80008000, v84
    v_xor_b32 v85, 0x80008000, v85
    s_mov_b64 exec, -1
    v_mfma_f32_32x32x8_bf16 v[0:15], v[80:81], v[176:177], v[0:15]
    v_fmac_f32 v201, v46, v174
    v_fmac_f32 v201, v47, v175
    v_add_f32 v255, v197, v255
    s_set_gpr_idx_on s51, gpr_idx(DST)
    s_nop 0
    v_cvt_pk_bf16_f32 v206, v254, v255
    s_set_gpr_idx_off
    s_add_u32 m0, s21, 6144
    v_mfma_f32_32x32x8_bf16 v[16:31], v[84:85], v[176:177], v[16:31]
    v_lshl_add_u32 v240, v240, 10, v246
    v_lshl_add_u32 v241, v241, 10, v246
    buffer_load_dwordx4 v240, s[4:7], s41 offen  lds
    buffer_load_dwordx4 v241, s[8:11], s41 offen offset:1024  lds
    v_mfma_f32_32x32x16_bf16 v[32:47], v[64:67], v[180:183], 0
    v_mul_f32 v254, v0, v144
    v_fmac_f32 v254, v1, v145
    v_fmac_f32 v254, v2, v146
    v_fmac_f32 v254, v3, v147
    v_fmac_f32 v254, v4, v148
    v_fmac_f32 v254, v5, v149
    v_fmac_f32 v254, v6, v150
    v_mfma_f32_32x32x16_bf16 v[48:63], v[68:71], v[180:183], v[48:63]
    v_fmac_f32 v254, v7, v151
    v_fma_f32 v202, v8, -v160, v202
    v_fma_f32 v202, v9, -v161, v202
    v_permlane32_swap_b32 v254, v200
    v_fma_f32 v202, v10, -v162, v202
    v_fma_f32 v202, v11, -v163, v202
    v_mfma_f32_32x32x16_bf16 v[32:47], v[72:75], v[184:187], v[32:47]
    v_fma_f32 v202, v12, -v164, v202
    v_fma_f32 v202, v13, -v165, v202
    v_fma_f32 v202, v14, -v166, v202
    v_fma_f32 v202, v15, -v167, v202
    v_add_f32 v200, v254, v200
    v_fmac_f32 v198, v16, v112
    v_permlane32_swap_b32 v202, v254
    v_mfma_f32_32x32x16_bf16 v[48:63], v[76:79], v[184:187], v[48:63]
    s_waitcnt vmcnt(6)
    ds_read_b64_tr_b16 v[176:177], v244 offset:0
    ds_read_b64_tr_b16 v[178:179], v244 offset:1024
    ds_read_b64_tr_b16 v[180:181], v245 offset:0
    ds_read_b64_tr_b16 v[182:183], v245 offset:1024
    v_fmac_f32 v198, v17, v113
    v_fmac_f32 v198, v18, v114
    v_fmac_f32 v198, v19, v115
    v_fmac_f32 v198, v20, v116
    v_fmac_f32 v198, v21, v117
    v_fmac_f32 v198, v22, v118
    v_mfma_f32_32x32x8_bf16 v[32:47], v[80:81], v[188:189], v[32:47]
    v_fmac_f32 v198, v23, v119
    v_add_f32 v254, v202, v254
    v_mul_f32 v196, v24, v160
    v_fmac_f32 v196, v25, v161
    v_fmac_f32 v196, v26, v162
    v_fmac_f32 v196, v27, v163
    v_fmac_f32 v196, v28, v164
    v_mfma_f32_32x32x8_bf16 v[48:63], v[84:85], v[188:189], v[48:63]
    v_add_u32 v249, s48, v249
    v_add_u32 v250, s49, v250
    ds_read_b64_tr_b16 v[64:65], v249 offset:0
    ds_read_b64_tr_b16 v[68:69], v249 offset:64
    ds_read_b64_tr_b16 v[66:67], v249 offset:256
    ds_read_b64_tr_b16 v[70:71], v249 offset:320
    s_mov_b64 exec, s[54:55]
    ds_read_u16_d16_hi v242, v250 offset:0
    s_mov_b64 exec, -1
    v_fmac_f32 v196, v29, v165
    v_fmac_f32 v196, v30, v166
    v_fmac_f32 v196, v31, v167
    s_nop 1
    v_permlane32_swap_b32 v198, v196
    v_add_f32 v196, v198, v196
    v_mul_f32 v255, v32, v152
    v_fmac_f32 v255, v33, v153
    v_fmac_f32 v255, v34, v154
    v_fmac_f32 v255, v35, v155
    v_fmac_f32 v255, v36, v156
    v_fmac_f32 v255, v37, v157
    v_fmac_f32 v255, v38, v158
    v_fmac_f32 v255, v39, v159
    v_fma_f32 v203, v40, -v168, v203
    v_fma_f32 v203, v41, -v169, v203
    v_permlane32_swap_b32 v255, v201
    v_fma_f32 v203, v42, -v170, v203
    v_fma_f32 v203, v43, -v171, v203
    v_fma_f32 v203, v44, -v172, v203
    v_fma_f32 v203, v45, -v173, v203
    v_fma_f32 v203, v46, -v174, v203
    v_fma_f32 v203, v47, -v175, v203
    v_add_f32 v201, v255, v201
    v_fmac_f32 v199, v48, v120
    v_permlane32_swap_b32 v203, v255
    v_fmac_f32 v199, v49, v121
    v_fmac_f32 v199, v50, v122
    v_fmac_f32 v199, v51, v123
    v_fmac_f32 v199, v52, v124
    v_fmac_f32 v199, v53, v125
    v_fmac_f32 v199, v54, v126
    v_fmac_f32 v199, v55, v127
    v_add_f32 v255, v203, v255
    v_mul_f32 v197, v56, v168
    v_fmac_f32 v197, v57, v169
    v_fmac_f32 v197, v58, v170
    v_fmac_f32 v197, v59, v171
    v_fmac_f32 v197, v60, v172
    v_fmac_f32 v197, v61, v173
    v_fmac_f32 v197, v62, v174
    v_fmac_f32 v197, v63, v175
    s_nop 1
    v_permlane32_swap_b32 v199, v197
    v_add_f32 v197, v199, v197
    s_set_gpr_idx_on s51, gpr_idx(DST)
    s_nop 0
    v_cvt_pk_bf16_f32 v207, v200, v201
    v_cvt_pk_bf16_f32 v209, v254, v255
    v_cvt_pk_bf16_f32 v208, v196, v197
    s_set_gpr_idx_off
    s_add_u32 s50, s50, 1
    s_add_u32 s51, s51, 6
    s_cmp_ge_u32 s50, 4
    s_cbranch_scc1 LAST0
    s_add_u32 s53, s53, 4
    s_xor_b32 s66, s53, s20
    s_bitcmp1_b32 s66, 2
    s_setprio 1
    s_cbranch_scc1 PRIO_6
    s_setprio 0
PRIO_6:
    s_cmp_eq_u32 s52, 4
    s_cbranch_scc1 ITEM_0_4
    s_cmp_eq_u32 s52, 5
    s_cbranch_scc1 ITEM_0_5
    s_cmp_eq_u32 s52, 3
    s_cbranch_scc1 ITEM_0_3
    s_cmp_eq_u32 s52, 6
    s_cbranch_scc1 ITEM_0_6
    s_cmp_eq_u32 s52, 8
    s_cbranch_scc1 ITEM_0_8
    s_branch ITEM_0_2
.p2align 6
ITEM_0_3:
    s_mov_b64 exec, s[54:55]
    ds_read_u16_d16_hi v243, v250 offset:128
    s_mov_b64 exec, -1
    ds_read_b64_tr_b16 v[72:73], v249 offset:512
    ds_read_b64_tr_b16 v[76:77], v249 offset:576
    s_waitcnt lgkmcnt(3)
    v_mul_f32_dpp v196, v242, v64 row_newbcast:0 row_mask:0xf bank_mask:0xf
    v_mul_f32_dpp v197, v242, v65 row_newbcast:1 row_mask:0xf bank_mask:0xf
    v_mul_f32_dpp v198, v242, v64 row_newbcast:8 row_mask:0xf bank_mask:0xf
    v_mul_f32_dpp v199, v242, v65 row_newbcast:9 row_mask:0xf bank_mask:0xf
    v_mul_f32_dpp v200, v242, v68 row_newbcast:2 row_mask:0xf bank_mask:0xf
    v_mul_f32_dpp v201, v242, v69 row_newbcast:3 row_mask:0xf bank_mask:0xf
    v_mul_f32_dpp v202, v242, v68 row_newbcast:10 row_mask:0xf bank_mask:0xf
    v_mul_f32_dpp v203, v242, v69 row_newbcast:11 row_mask:0xf bank_mask:0xf
    v_cvt_pk_bf16_f32 v64, v196, v197
    v_cvt_pk_bf16_f32 v68, v198, v199
    v_cvt_pk_bf16_f32 v65, v200, v201
    v_cvt_pk_bf16_f32 v69, v202, v203
    v_mul_f32_dpp v196, v242, v66 row_newbcast:4 row_mask:0xf bank_mask:0xf
    v_mul_f32_dpp v197, v242, v67 row_newbcast:5 row_mask:0xf bank_mask:0xf
    v_mul_f32_dpp v198, v242, v66 row_newbcast:12 row_mask:0xf bank_mask:0xf
    v_mul_f32_dpp v199, v242, v67 row_newbcast:13 row_mask:0xf bank_mask:0xf
    v_mul_f32_dpp v200, v242, v70 row_newbcast:6 row_mask:0xf bank_mask:0xf
    v_mul_f32_dpp v201, v242, v71 row_newbcast:7 row_mask:0xf bank_mask:0xf
    v_mul_f32_dpp v202, v242, v70 row_newbcast:14 row_mask:0xf bank_mask:0xf
    v_mul_f32_dpp v203, v242, v71 row_newbcast:15 row_mask:0xf bank_mask:0xf
    v_cvt_pk_bf16_f32 v66, v196, v197
    v_cvt_pk_bf16_f32 v70, v198, v199
    v_cvt_pk_bf16_f32 v67, v200, v201
    v_cvt_pk_bf16_f32 v71, v202, v203
    s_nop 0
    s_waitcnt vmcnt(4) lgkmcnt(0)
    v_mfma_f32_32x32x16_bf16 v[0:15], v[64:67], v[176:179], 0
    v_mul_f32_dpp v196, v243, v72 row_newbcast:0 row_mask:0xf bank_mask:0xf
    v_mul_f32_dpp v197, v243, v73 row_newbcast:1 row_mask:0xf bank_mask:0xf
    v_mul_f32_dpp v198, v243, v72 row_newbcast:8 row_mask:0xf bank_mask:0xf
    v_mul_f32_dpp v199, v243, v73 row_newbcast:9 row_mask:0xf bank_mask:0xf
    v_mul_f32_dpp v200, v243, v76 row_newbcast:2 row_mask:0xf bank_mask:0xf
    v_mul_f32_dpp v201, v243, v77 row_newbcast:3 row_mask:0xf bank_mask:0xf
    s_add_u32 m0, s21, 0
    v_mfma_f32_32x32x16_bf16 v[16:31], v[68:71], v[176:179], 0
    buffer_load_dwordx4 v234, s[4:7], s36 offen  lds
    buffer_load_dwordx4 v235, s[8:11], s36 offen offset:1024  lds
    ds_read_b64_tr_b16 v[176:177], v244 offset:2048
    ds_read_b64_tr_b16 v[184:185], v245 offset:2048
    v_mul_f32_dpp v202, v243, v76 row_newbcast:10 row_mask:0xf bank_mask:0xf
    v_mul_f32_dpp v203, v243, v77 row_newbcast:11 row_mask:0xf bank_mask:0xf
    v_cvt_pk_bf16_f32 v72, v196, v197
    v_cvt_pk_bf16_f32 v76, v198, v199
    v_cvt_pk_bf16_f32 v73, v200, v201
    v_cvt_pk_bf16_f32 v77, v202, v203
    s_nop 0
    s_waitcnt lgkmcnt(0)
    v_mfma_f32_32x32x8_bf16 v[0:15], v[72:73], v[176:177], v[0:15]
    s_add_u32 m0, s21, 2048
    v_mfma_f32_32x32x8_bf16 v[16:31], v[76:77], v[176:177], v[16:31]
    buffer_load_dwordx4 v236, s[4:7], s36 offen  lds
    s_mov_b32 m0, s50
    s_nop 0
    s_movrels_b32 s71, s23
    s_bfe_u32 s46, s71, 0x30012
    s_mov_b32 m0, s46
    s_and_b32 s66, s71, 0x3ffff
    s_movrels_b32 s68, s57
    s_movrels_b32 s69, s61
    s_sub_u32 s48, s66, s47
    s_mov_b32 s47, s66
    s_lshr_b32 s52, s71, 28
    s_lshl_b32 s67, s46, 9
    s_add_u32 s66, s66, s67
    s_sub_u32 s49, s66, s42
    s_mov_b32 s42, s66
    s_bfe_u32 s66, s68, 655360
    s_add_u32 s43, s42, s66
    s_bfe_u32 s39, s69, 655360
    s_bfe_u32 s66, s68, 655370
    s_add_u32 s44, s42, s66
    s_bfe_u32 s40, s69, 655370
    s_bfe_u32 s66, s68, 655380
    s_add_u32 s45, s42, s66
    s_bfe_u32 s41, s69, 655380
    s_and_b32 s66, s46, s33
    s_cselect_b32 s72, -1, 1
    s_cselect_b32 s76, s47, 163712
    s_cmp_ge_u32 s66, 2
    s_cselect_b32 s73, -1, 0
    s_add_u32 s77, s47, 1024
    s_cmp_ge_u32 s66, 4
    s_cselect_b32 s75, -1, 0
    s_cmp_ge_u32 s66, 3
    s_cselect_b32 s74, -1, 1
    s_cselect_b32 s77, s77, 163712
    v_add_u32 v252, s44, v247
    ds_read_u16 v238, v252
    ds_read_u16 v239, v252 offset:64
    v_add_u32 v252, s45, v247
    ds_read_u16 v240, v252
    ds_read_u16 v241, v252 offset:64
    v_mfma_f32_32x32x16_bf16 v[32:47], v[64:67], v[180:183], 0
    v_mul_f32 v196, v0, v96
    v_fmac_f32 v196, v1, v97
    v_fmac_f32 v196, v2, v98
    v_fmac_f32 v196, v3, v99
    v_fmac_f32 v196, v4, v100
    v_fmac_f32 v196, v5, v101
    v_fmac_f32 v196, v6, v102
    v_fmac_f32 v196, v7, v103
    v_mul_f32 v198, v8, v128
    v_fmac_f32 v198, v9, v129
    v_mfma_f32_32x32x16_bf16 v[48:63], v[68:71], v[180:183], 0
    v_add_u32 v253, s47, v248
    ds_read_b32 v254, v253
    ds_read_b32 v255, v253 offset:256
    s_waitcnt vmcnt(5)
    ds_read_b64_tr_b16 v[176:177], v244 offset:4096
    ds_read_b64_tr_b16 v[178:179], v244 offset:5120
    ds_read_b64_tr_b16 v[180:181], v245 offset:4096
    ds_read_b64_tr_b16 v[182:183], v245 offset:5120
    v_fmac_f32 v198, v10, v130
    v_fmac_f32 v198, v11, v131
    v_fmac_f32 v198, v12, v132
    v_fmac_f32 v198, v13, v133
    v_fmac_f32 v198, v14, v134
    v_fmac_f32 v198, v15, v135
    v_mul_f32 v200, v16, v128
    v_fmac_f32 v200, v17, v129
    v_permlane32_swap_b32 v196, v198
    v_mfma_f32_32x32x8_bf16 v[32:47], v[72:73], v[184:185], v[32:47]
    v_fmac_f32 v200, v18, v130
    v_fmac_f32 v200, v19, v131
    v_fmac_f32 v200, v20, v132
    v_fmac_f32 v200, v21, v133
    v_fmac_f32 v200, v22, v134
    v_fmac_f32 v200, v23, v135
    v_add_f32 v198, v196, v198
    v_mul_f32_e64 v202, v24, -v128
    v_fma_f32 v202, v25, -v129, v202
    v_mfma_f32_32x32x8_bf16 v[48:63], v[76:77], v[184:185], v[48:63]
    v_fma_f32 v202, v26, -v130, v202
    v_fma_f32 v202, v27, -v131, v202
    v_fma_f32 v202, v28, -v132, v202
    v_fma_f32 v202, v29, -v133, v202
    v_fma_f32 v202, v30, -v134, v202
    v_fma_f32 v202, v31, -v135, v202
    s_nop 1
    v_permlane32_swap_b32 v200, v202
    v_add_f32 v202, v200, v202
    s_waitcnt vmcnt(3) lgkmcnt(0)
    v_mfma_f32_32x32x16_bf16 v[0:15], v[64:67], v[176:179], 0
    v_mul_f32 v197, v32, v104
    v_fmac_f32 v197, v33, v105
    v_fmac_f32 v197, v34, v106
    v_fmac_f32 v197, v35, v107
    v_fmac_f32 v197, v36, v108
    v_fmac_f32 v197, v37, v109
    v_fmac_f32 v197, v38, v110
    v_fmac_f32 v197, v39, v111
    v_mul_f32 v199, v40, v136
    v_fmac_f32 v199, v41, v137
    v_fmac_f32 v199, v42, v138
    s_add_u32 m0, s21, 4096
    v_mfma_f32_32x32x16_bf16 v[16:31], v[68:71], v[176:179], 0
    buffer_load_dwordx4 v234, s[4:7], s37 offen  lds
    buffer_load_dwordx4 v235, s[8:11], s37 offen offset:1024  lds
    ds_read_b64_tr_b16 v[176:177], v244 offset:6144
    ds_read_b64_tr_b16 v[184:185], v245 offset:6144
    v_add_u32 v252, s42, v247
    ds_read_u16 v234, v252
    ds_read_u16 v235, v252 offset:64
    s_mov_b32 m0, s76
    s_mov_b64 exec, s[72:73]
    buffer_load_dwordx4 v254, s[12:15], 0 offen  lds
    s_mov_b32 m0, s77
    s_mov_b64 exec, s[74:75]
    buffer_load_dwordx4 v255, s[12:15], 0 offen  lds
    s_mov_b64 exec, -1
    v_fmac_f32 v199, v43, v139
    v_fmac_f32 v199, v44, v140
    v_fmac_f32 v199, v45, v141
    v_fmac_f32 v199, v46, v142
    v_fmac_f32 v199, v47, v143
    v_mul_f32 v201, v48, v136
    v_fmac_f32 v201, v49, v137
    v_permlane32_swap_b32 v197, v199
    v_fmac_f32 v201, v50, v138
    v_fmac_f32 v201, v51, v139
    s_waitcnt lgkmcnt(2)
    v_mfma_f32_32x32x8_bf16 v[0:15], v[72:73], v[176:177], v[0:15]
    v_fmac_f32 v201, v52, v140
    v_fmac_f32 v201, v53, v141
    v_fmac_f32 v201, v54, v142
    v_fmac_f32 v201, v55, v143
    v_add_f32 v199, v197, v199
    v_mul_f32_e64 v203, v56, -v136
    v_fma_f32 v203, v57, -v137, v203
    v_fma_f32 v203, v58, -v138, v203
    v_fma_f32 v203, v59, -v139, v203
    v_fma_f32 v203, v60, -v140, v203
    v_fma_f32 v203, v61, -v141, v203
    s_add_u32 m0, s21, 6144
    v_mfma_f32_32x32x8_bf16 v[16:31], v[76:77], v[176:177], v[16:31]
    buffer_load_dwordx4 v236, s[4:7], s37 offen  lds
    v_add_u32 v252, s43, v247
    ds_read_u16 v236, v252
    ds_read_u16 v237, v252 offset:64
    v_fma_f32 v203, v62, -v142, v203
    v_fma_f32 v203, v63, -v143, v203
    s_nop 1
    v_permlane32_swap_b32 v201, v203
    v_add_f32 v203, v201, v203
    s_set_gpr_idx_on s51, gpr_idx(DST)
    s_nop 0
    v_cvt_pk_bf16_f32 v204, v198, v199
    v_cvt_pk_bf16_f32 v205, v202, v203
    s_set_gpr_idx_off
    v_mfma_f32_32x32x16_bf16 v[32:47], v[64:67], v[180:183], 0
    v_mul_f32 v196, v0, v144
    v_fmac_f32 v196, v1, v145
    v_fmac_f32 v196, v2, v146
    v_fmac_f32 v196, v3, v147
    v_fmac_f32 v196, v4, v148
    v_fmac_f32 v196, v5, v149
    v_fmac_f32 v196, v6, v150
    v_fmac_f32 v196, v7, v151
    v_mfma_f32_32x32x16_bf16 v[48:63], v[68:71], v[180:183], 0
    s_waitcnt vmcnt(6)
    ds_read_b64_tr_b16 v[176:177], v244 offset:0
    ds_read_b64_tr_b16 v[178:179], v244 offset:1024
    ds_read_b64_tr_b16 v[180:181], v245 offset:0
    ds_read_b64_tr_b16 v[182:183], v245 offset:1024
    v_mul_f32 v198, v8, v112
    v_fmac_f32 v198, v9, v113
    v_fmac_f32 v198, v10, v114
    v_fmac_f32 v198, v11, v115
    v_fmac_f32 v198, v12, v116
    v_fmac_f32 v198, v13, v117
    v_fmac_f32 v198, v14, v118
    v_fmac_f32 v198, v15, v119
    v_mfma_f32_32x32x8_bf16 v[32:47], v[72:73], v[184:185], v[32:47]
    v_mul_f32_e64 v200, v16, -v160
    v_fma_f32 v200, v17, -v161, v200
    v_fma_f32 v200, v18, -v162, v200
    v_fma_f32 v200, v19, -v163, v200
    v_fma_f32 v200, v20, -v164, v200
    v_fma_f32 v200, v21, -v165, v200
    v_fma_f32 v200, v22, -v166, v200
    v_fma_f32 v200, v23, -v167, v200
    v_mfma_f32_32x32x8_bf16 v[48:63], v[76:77], v[184:185], v[48:63]
    v_mul_f32_e64 v202, v24, -v160
    v_fma_f32 v202, v25, -v161, v202
    v_fma_f32 v202, v26, -v162, v202
    v_fma_f32 v202, v27, -v163, v202
    v_fma_f32 v202, v28, -v164, v202
    v_fma_f32 v202, v29, -v165, v202
    v_fma_f32 v202, v30, -v166, v202
    v_fma_f32 v202, v31, -v167, v202
    s_waitcnt vmcnt(5) lgkmcnt(0)
    v_mfma_f32_32x32x16_bf16 v[0:15], v[64:67], v[176:179], 0
    v_mul_f32 v197, v32, v152
    v_fmac_f32 v197, v33, v153
    v_fmac_f32 v197, v34, v154
    v_fmac_f32 v197, v35, v155
    v_fmac_f32 v197, v36, v156
    v_fmac_f32 v197, v37, v157
    v_fmac_f32 v197, v38, v158
    v_fmac_f32 v197, v39, v159
    s_add_u32 m0, s21, 0
    v_mfma_f32_32x32x16_bf16 v[16:31], v[68:71], v[176:179], 0
    v_lshl_add_u32 v234, v234, 10, v246
    v_lshl_add_u32 v235, v235, 10, v246
    buffer_load_dwordx4 v234, s[4:7], s38 offen  lds
    buffer_load_dwordx4 v235, s[8:11], s38 offen offset:1024  lds
    ds_read_b64_tr_b16 v[176:177], v244 offset:2048
    ds_read_b64_tr_b16 v[184:185], v245 offset:2048
    v_mul_f32 v199, v40, v120
    v_fmac_f32 v199, v41, v121
    v_fmac_f32 v199, v42, v122
    v_fmac_f32 v199, v43, v123
    v_fmac_f32 v199, v44, v124
    v_fmac_f32 v199, v45, v125
    v_fmac_f32 v199, v46, v126
    v_fmac_f32 v199, v47, v127
    s_waitcnt lgkmcnt(0)
    v_mfma_f32_32x32x8_bf16 v[0:15], v[72:73], v[176:177], v[0:15]
    v_mul_f32_e64 v201, v48, -v168
    v_fma_f32 v201, v49, -v169, v201
    v_fma_f32 v201, v50, -v170, v201
    v_fma_f32 v201, v51, -v171, v201
    v_fma_f32 v201, v52, -v172, v201
    v_fma_f32 v201, v53, -v173, v201
    v_fma_f32 v201, v54, -v174, v201
    v_fma_f32 v201, v55, -v175, v201
    s_add_u32 m0, s21, 2048
    v_mfma_f32_32x32x8_bf16 v[16:31], v[76:77], v[176:177], v[16:31]
    v_lshl_add_u32 v236, v236, 10, v246
    v_lshl_add_u32 v237, v237, 10, v246
    buffer_load_dwordx4 v236, s[4:7], s39 offen  lds
    buffer_load_dwordx4 v237, s[8:11], s39 offen offset:1024  lds
    v_mul_f32_e64 v203, v56, -v168
    v_fma_f32 v203, v57, -v169, v203
    v_fma_f32 v203, v58, -v170, v203
    v_fma_f32 v203, v59, -v171, v203
    v_fma_f32 v203, v60, -v172, v203
    v_fma_f32 v203, v61, -v173, v203
    v_fma_f32 v203, v62, -v174, v203
    v_fma_f32 v203, v63, -v175, v203
    v_mfma_f32_32x32x16_bf16 v[32:47], v[64:67], v[180:183], 0
    v_mul_f32 v254, v0, v144
    v_fmac_f32 v254, v1, v145
    v_fmac_f32 v254, v2, v146
    v_fmac_f32 v254, v3, v147
    v_fmac_f32 v254, v4, v148
    v_mfma_f32_32x32x16_bf16 v[48:63], v[68:71], v[180:183], 0
    ds_swizzle_b32 v68, v68 offset:0x401F
    ds_swizzle_b32 v69, v69 offset:0x401F
    ds_swizzle_b32 v70, v70 offset:0x401F
    ds_swizzle_b32 v71, v71 offset:0x401F
    s_waitcnt vmcnt(7)
    ds_read_b64_tr_b16 v[176:177], v244 offset:4096
    ds_read_b64_tr_b16 v[178:179], v244 offset:5120
    ds_read_b64_tr_b16 v[180:181], v245 offset:4096
    ds_read_b64_tr_b16 v[182:183], v245 offset:5120
    v_fmac_f32 v254, v5, v149
    v_fmac_f32 v254, v6, v150
    v_fmac_f32 v254, v7, v151
    v_fmac_f32 v200, v8, v160
    v_mfma_f32_32x32x8_bf16 v[32:47], v[72:73], v[184:185], v[32:47]
    v_fmac_f32 v200, v9, v161
    v_permlane32_swap_b32 v196, v254
    v_fmac_f32 v200, v10, v162
    v_fmac_f32 v200, v11, v163
    v_fmac_f32 v200, v12, v164
    v_mfma_f32_32x32x8_bf16 v[48:63], v[76:77], v[184:185], v[48:63]
    ds_swizzle_b32 v76, v76 offset:0x401F
    ds_swizzle_b32 v77, v77 offset:0x401F
    v_fmac_f32 v200, v13, v165
    v_fmac_f32 v200, v14, v166
    v_fmac_f32 v200, v15, v167
    v_add_f32 v254, v196, v254
    s_waitcnt lgkmcnt(6)
    s_mov_b64 exec, s[56:57]
    v_xor_b32 v68, 0x80008000, v68
    v_xor_b32 v69, 0x80008000, v69
    v_xor_b32 v70, 0x80008000, v70
    v_xor_b32 v71, 0x80008000, v71
    s_mov_b64 exec, -1
    s_waitcnt vmcnt(4) lgkmcnt(2)
    v_mfma_f32_32x32x16_bf16 v[0:15], v[64:67], v[176:179], 0
    v_mul_f32 v255, v32, v152
    v_fmac_f32 v255, v33, v153
    v_fmac_f32 v255, v34, v154
    v_fmac_f32 v255, v35, v155
    v_fmac_f32 v255, v36, v156
    v_fmac_f32 v255, v37, v157
    s_add_u32 m0, s21, 4096
    v_mfma_f32_32x32x16_bf16 v[16:31], v[68:71], v[176:179], v[16:31]
    v_lshl_add_u32 v238, v238, 10, v246
    v_lshl_add_u32 v239, v239, 10, v246
    buffer_load_dwordx4 v238, s[4:7], s40 offen  lds
    buffer_load_dwordx4 v239, s[8:11], s40 offen offset:1024  lds
    ds_read_b64_tr_b16 v[176:177], v244 offset:6144
    ds_read_b64_tr_b16 v[184:185], v245 offset:6144
    v_fmac_f32 v255, v38, v158
    v_fmac_f32 v255, v39, v159
    v_fmac_f32 v201, v40, v168
    v_fmac_f32 v201, v41, v169
    v_permlane32_swap_b32 v197, v255
    s_waitcnt lgkmcnt(0)
    s_mov_b64 exec, s[56:57]
    v_xor_b32 v76, 0x80008000, v76
    v_xor_b32 v77, 0x80008000, v77
    s_mov_b64 exec, -1
    v_mfma_f32_32x32x8_bf16 v[0:15], v[72:73], v[176:177], v[0:15]
    v_fmac_f32 v201, v42, v170
    v_fmac_f32 v201, v43, v171
    v_fmac_f32 v201, v44, v172
    v_fmac_f32 v201, v45, v173
    v_fmac_f32 v201, v46, v174
    v_fmac_f32 v201, v47, v175
    s_add_u32 m0, s21, 6144
    v_mfma_f32_32x32x8_bf16 v[16:31], v[76:77], v[176:177], v[16:31]
    v_lshl_add_u32 v240, v240, 10, v246
    v_lshl_add_u32 v241, v241, 10, v246
    buffer_load_dwordx4 v240, s[4:7], s41 offen  lds
    buffer_load_dwordx4 v241, s[8:11], s41 offen offset:1024  lds
    v_add_f32 v255, v197, v255
    s_set_gpr_idx_on s51, gpr_idx(DST)
    s_nop 0
    v_cvt_pk_bf16_f32 v206, v254, v255
    s_set_gpr_idx_off
    v_mfma_f32_32x32x16_bf16 v[32:47], v[64:67], v[180:183], 0
    v_mul_f32 v254, v0, v144
    v_fmac_f32 v254, v1, v145
    v_fmac_f32 v254, v2, v146
    v_fmac_f32 v254, v3, v147
    v_fmac_f32 v254, v4, v148
    v_fmac_f32 v254, v5, v149
    v_fmac_f32 v254, v6, v150
    v_fmac_f32 v254, v7, v151
    v_fma_f32 v202, v8, -v160, v202
    v_fma_f32 v202, v9, -v161, v202
    v_mfma_f32_32x32x16_bf16 v[48:63], v[68:71], v[180:183], v[48:63]
    s_waitcnt vmcnt(6)
    ds_read_b64_tr_b16 v[176:177], v244 offset:0
    ds_read_b64_tr_b16 v[178:179], v244 offset:1024
    ds_read_b64_tr_b16 v[180:181], v245 offset:0
    ds_read_b64_tr_b16 v[182:183], v245 offset:1024
    v_permlane32_swap_b32 v254, v200
    v_fma_f32 v202, v10, -v162, v202
    v_fma_f32 v202, v11, -v163, v202
    v_fma_f32 v202, v12, -v164, v202
    v_fma_f32 v202, v13, -v165, v202
    v_fma_f32 v202, v14, -v166, v202
    v_fma_f32 v202, v15, -v167, v202
    v_add_f32 v200, v254, v200
    v_fmac_f32 v198, v16, v112
    v_permlane32_swap_b32 v202, v254
    v_mfma_f32_32x32x8_bf16 v[32:47], v[72:73], v[184:185], v[32:47]
    v_fmac_f32 v198, v17, v113
    v_fmac_f32 v198, v18, v114
    v_fmac_f32 v198, v19, v115
    v_fmac_f32 v198, v20, v116
    v_fmac_f32 v198, v21, v117
    v_fmac_f32 v198, v22, v118
    v_fmac_f32 v198, v23, v119
    v_add_f32 v254, v202, v254
    v_mul_f32 v196, v24, v160
    v_fmac_f32 v196, v25, v161
    v_mfma_f32_32x32x8_bf16 v[48:63], v[76:77], v[184:185], v[48:63]
    v_add_u32 v249, s48, v249
    v_add_u32 v250, s49, v250
    ds_read_b64_tr_b16 v[64:65], v249 offset:0
    ds_read_b64_tr_b16 v[68:69], v249 offset:64
    ds_read_b64_tr_b16 v[66:67], v249 offset:256
    ds_read_b64_tr_b16 v[70:71], v249 offset:320
    s_mov_b64 exec, s[54:55]
    ds_read_u16_d16_hi v242, v250 offset:0
    s_mov_b64 exec, -1
    v_fmac_f32 v196, v26, v162
    v_fmac_f32 v196, v27, v163
    v_fmac_f32 v196, v28, v164
    v_fmac_f32 v196, v29, v165
    v_fmac_f32 v196, v30, v166
    v_fmac_f32 v196, v31, v167
    s_nop 1
    v_permlane32_swap_b32 v198, v196
    v_add_f32 v196, v198, v196
    v_mul_f32 v255, v32, v152
    v_fmac_f32 v255, v33, v153
    v_fmac_f32 v255, v34, v154
    v_fmac_f32 v255, v35, v155
    v_fmac_f32 v255, v36, v156
    v_fmac_f32 v255, v37, v157
    v_fmac_f32 v255, v38, v158
    v_fmac_f32 v255, v39, v159
    v_fma_f32 v203, v40, -v168, v203
    v_fma_f32 v203, v41, -v169, v203
    v_permlane32_swap_b32 v255, v201
    v_fma_f32 v203, v42, -v170, v203
    v_fma_f32 v203, v43, -v171, v203
    v_fma_f32 v203, v44, -v172, v203
    v_fma_f32 v203, v45, -v173, v203
    v_fma_f32 v203, v46, -v174, v203
    v_fma_f32 v203, v47, -v175, v203
    v_add_f32 v201, v255, v201
    v_fmac_f32 v199, v48, v120
    v_permlane32_swap_b32 v203, v255
    v_fmac_f32 v199, v49, v121
    v_fmac_f32 v199, v50, v122
    v_fmac_f32 v199, v51, v123
    v_fmac_f32 v199, v52, v124
    v_fmac_f32 v199, v53, v125
    v_fmac_f32 v199, v54, v126
    v_fmac_f32 v199, v55, v127
    v_add_f32 v255, v203, v255
    v_mul_f32 v197, v56, v168
    v_fmac_f32 v197, v57, v169
    v_fmac_f32 v197, v58, v170
    v_fmac_f32 v197, v59, v171
    v_fmac_f32 v197, v60, v172
    v_fmac_f32 v197, v61, v173
    v_fmac_f32 v197, v62, v174
    v_fmac_f32 v197, v63, v175
    s_nop 1
    v_permlane32_swap_b32 v199, v197
    v_add_f32 v197, v199, v197
    s_set_gpr_idx_on s51, gpr_idx(DST)
    s_nop 0
    v_cvt_pk_bf16_f32 v207, v200, v201
    v_cvt_pk_bf16_f32 v209, v254, v255
    v_cvt_pk_bf16_f32 v208, v196, v197
    s_set_gpr_idx_off
    s_add_u32 s50, s50, 1
    s_add_u32 s51, s51, 6
    s_cmp_ge_u32 s50, 4
    s_cbranch_scc1 LAST0
    s_add_u32 s53, s53, 4
    s_xor_b32 s66, s53, s20
    s_bitcmp1_b32 s66, 2
    s_setprio 1
    s_cbranch_scc1 PRIO_7
    s_setprio 0
PRIO_7:
    s_cmp_eq_u32 s52, 4
    s_cbranch_scc1 ITEM_0_4
    s_cmp_eq_u32 s52, 5
    s_cbranch_scc1 ITEM_0_5
    s_cmp_eq_u32 s52, 3
    s_cbranch_scc1 ITEM_0_3
    s_cmp_eq_u32 s52, 6
    s_cbranch_scc1 ITEM_0_6
    s_cmp_eq_u32 s52, 8
    s_cbranch_scc1 ITEM_0_8
    s_branch ITEM_0_2
.p2align 6
ITEM_0_6:
    s_mov_b64 exec, s[54:55]
    ds_read_u16_d16_hi v243, v250 offset:128
    s_mov_b64 exec, -1
    ds_read_b64_tr_b16 v[72:73], v249 offset:512
    ds_read_b64_tr_b16 v[76:77], v249 offset:576
    ds_read_b64_tr_b16 v[74:75], v249 offset:768
    ds_read_b64_tr_b16 v[78:79], v249 offset:832
    ds_read_b64_tr_b16 v[80:81], v249 offset:1024
    ds_read_b64_tr_b16 v[84:85], v249 offset:1088
    ds_read_b64_tr_b16 v[82:83], v249 offset:1280
    ds_read_b64_tr_b16 v[86:87], v249 offset:1344
    s_waitcnt lgkmcnt(9)
    v_mul_f32_dpp v196, v242, v64 row_newbcast:0 row_mask:0xf bank_mask:0xf
    v_mul_f32_dpp v197, v242, v65 row_newbcast:1 row_mask:0xf bank_mask:0xf
    v_mul_f32_dpp v198, v242, v64 row_newbcast:8 row_mask:0xf bank_mask:0xf
    v_mul_f32_dpp v199, v242, v65 row_newbcast:9 row_mask:0xf bank_mask:0xf
    v_mul_f32_dpp v200, v242, v68 row_newbcast:2 row_mask:0xf bank_mask:0xf
    v_mul_f32_dpp v201, v242, v69 row_newbcast:3 row_mask:0xf bank_mask:0xf
    v_mul_f32_dpp v202, v242, v68 row_newbcast:10 row_mask:0xf bank_mask:0xf
    v_mul_f32_dpp v203, v242, v69 row_newbcast:11 row_mask:0xf bank_mask:0xf
    v_cvt_pk_bf16_f32 v64, v196, v197
    v_cvt_pk_bf16_f32 v68, v198, v199
    v_cvt_pk_bf16_f32 v65, v200, v201
    v_cvt_pk_bf16_f32 v69, v202, v203
    v_mul_f32_dpp v196, v242, v66 row_newbcast:4 row_mask:0xf bank_mask:0xf
    v_mul_f32_dpp v197, v242, v67 row_newbcast:5 row_mask:0xf bank_mask:0xf
    v_mul_f32_dpp v198, v242, v66 row_newbcast:12 row_mask:0xf bank_mask:0xf
    v_mul_f32_dpp v199, v242, v67 row_newbcast:13 row_mask:0xf bank_mask:0xf
    v_mul_f32_dpp v200, v242, v70 row_newbcast:6 row_mask:0xf bank_mask:0xf
    v_mul_f32_dpp v201, v242, v71 row_newbcast:7 row_mask:0xf bank_mask:0xf
    v_mul_f32_dpp v202, v242, v70 row_newbcast:14 row_mask:0xf bank_mask:0xf
    v_mul_f32_dpp v203, v242, v71 row_newbcast:15 row_mask:0xf bank_mask:0xf
    v_cvt_pk_bf16_f32 v66, v196, v197
    v_cvt_pk_bf16_f32 v70, v198, v199
    v_cvt_pk_bf16_f32 v67, v200, v201
    v_cvt_pk_bf16_f32 v71, v202, v203
    s_mov_b64 exec, s[54:55]
    ds_read_u16_d16_hi v242, v250 offset:256
    s_mov_b64 exec, -1
    s_waitcnt vmcnt(4) lgkmcnt(5)
    v_mfma_f32_32x32x16_bf16 v[0:15], v[64:67], v[176:179], 0
    v_mul_f32_dpp v196, v243, v72 row_newbcast:0 row_mask:0xf bank_mask:0xf
    v_mul_f32_dpp v197, v243, v73 row_newbcast:1 row_mask:0xf bank_mask:0xf
    v_mul_f32_dpp v198, v243, v72 row_newbcast:8 row_mask:0xf bank_mask:0xf
    v_mul_f32_dpp v199, v243, v73 row_newbcast:9 row_mask:0xf bank_mask:0xf
    v_mul_f32_dpp v200, v243, v76 row_newbcast:2 row_mask:0xf bank_mask:0xf
    v_mul_f32_dpp v201, v243, v77 row_newbcast:3 row_mask:0xf bank_mask:0xf
    v_mul_f32_dpp v202, v243, v76 row_newbcast:10 row_mask:0xf bank_mask:0xf
    v_mul_f32_dpp v203, v243, v77 row_newbcast:11 row_mask:0xf bank_mask:0xf
    v_cvt_pk_bf16_f32 v72, v196, v197
    v_cvt_pk_bf16_f32 v76, v198, v199
    v_cvt_pk_bf16_f32 v73, v200, v201
    v_cvt_pk_bf16_f32 v77, v202, v203
    s_add_u32 m0, s21, 0
    v_mfma_f32_32x32x16_bf16 v[16:31], v[68:71], v[176:179], 0
    buffer_load_dwordx4 v236, s[4:7], s35 offen  lds
    buffer_load_dwordx4 v237, s[8:11], s35 offen offset:1024  lds
    ds_read_b64_tr_b16 v[176:177], v244 offset:2048
    ds_read_b64_tr_b16 v[178:179], v244 offset:3072
    ds_read_b64_tr_b16 v[184:185], v245 offset:2048
    ds_read_b64_tr_b16 v[186:187], v245 offset:3072
    v_mul_f32_dpp v196, v243, v74 row_newbcast:4 row_mask:0xf bank_mask:0xf
    v_mul_f32_dpp v197, v243, v75 row_newbcast:5 row_mask:0xf bank_mask:0xf
    v_mul_f32_dpp v198, v243, v74 row_newbcast:12 row_mask:0xf bank_mask:0xf
    v_mul_f32_dpp v199, v243, v75 row_newbcast:13 row_mask:0xf bank_mask:0xf
    v_mul_f32_dpp v200, v243, v78 row_newbcast:6 row_mask:0xf bank_mask:0xf
    v_mul_f32_dpp v201, v243, v79 row_newbcast:7 row_mask:0xf bank_mask:0xf
    v_mul_f32_dpp v202, v243, v78 row_newbcast:14 row_mask:0xf bank_mask:0xf
    v_mul_f32_dpp v203, v243, v79 row_newbcast:15 row_mask:0xf bank_mask:0xf
    v_cvt_pk_bf16_f32 v74, v196, v197
    v_cvt_pk_bf16_f32 v78, v198, v199
    v_cvt_pk_bf16_f32 v75, v200, v201
    v_cvt_pk_bf16_f32 v79, v202, v203
    s_nop 0
    s_waitcnt vmcnt(4) lgkmcnt(0)
    v_mfma_f32_32x32x16_bf16 v[0:15], v[72:75], v[176:179], v[0:15]
    v_mul_f32_dpp v196, v242, v80 row_newbcast:0 row_mask:0xf bank_mask:0xf
    v_mul_f32_dpp v197, v242, v81 row_newbcast:1 row_mask:0xf bank_mask:0xf
    v_mul_f32_dpp v198, v242, v80 row_newbcast:8 row_mask:0xf bank_mask:0xf
    v_mul_f32_dpp v199, v242, v81 row_newbcast:9 row_mask:0xf bank_mask:0xf
    v_mul_f32_dpp v200, v242, v84 row_newbcast:2 row_mask:0xf bank_mask:0xf
    v_mul_f32_dpp v201, v242, v85 row_newbcast:3 row_mask:0xf bank_mask:0xf
    v_mul_f32_dpp v202, v242, v84 row_newbcast:10 row_mask:0xf bank_mask:0xf
    v_mul_f32_dpp v203, v242, v85 row_newbcast:11 row_mask:0xf bank_mask:0xf
    v_cvt_pk_bf16_f32 v80, v196, v197
    v_cvt_pk_bf16_f32 v84, v198, v199
    v_cvt_pk_bf16_f32 v81, v200, v201
    v_cvt_pk_bf16_f32 v85, v202, v203
    s_add_u32 m0, s21, 2048
    v_mfma_f32_32x32x16_bf16 v[16:31], v[76:79], v[176:179], v[16:31]
    buffer_load_dwordx4 v238, s[4:7], s35 offen  lds
    buffer_load_dwordx4 v239, s[8:11], s35 offen offset:1024  lds
    ds_read_b64_tr_b16 v[176:177], v244 offset:4096
    ds_read_b64_tr_b16 v[178:179], v244 offset:5120
    ds_read_b64_tr_b16 v[188:189], v245 offset:4096
    ds_read_b64_tr_b16 v[190:191], v245 offset:5120
    v_mul_f32_dpp v196, v242, v82 row_newbcast:4 row_mask:0xf bank_mask:0xf
    v_mul_f32_dpp v197, v242, v83 row_newbcast:5 row_mask:0xf bank_mask:0xf
    v_mul_f32_dpp v198, v242, v82 row_newbcast:12 row_mask:0xf bank_mask:0xf
    v_mul_f32_dpp v199, v242, v83 row_newbcast:13 row_mask:0xf bank_mask:0xf
    v_mul_f32_dpp v200, v242, v86 row_newbcast:6 row_mask:0xf bank_mask:0xf
    v_mul_f32_dpp v201, v242, v87 row_newbcast:7 row_mask:0xf bank_mask:0xf
    v_mul_f32_dpp v202, v242, v86 row_newbcast:14 row_mask:0xf bank_mask:0xf
    v_mul_f32_dpp v203, v242, v87 row_newbcast:15 row_mask:0xf bank_mask:0xf
    v_cvt_pk_bf16_f32 v82, v196, v197
    v_cvt_pk_bf16_f32 v86, v198, v199
    v_cvt_pk_bf16_f32 v83, v200, v201
    v_cvt_pk_bf16_f32 v87, v202, v203
    s_nop 0
    s_waitcnt lgkmcnt(0)
    v_mfma_f32_32x32x16_bf16 v[0:15], v[80:83], v[176:179], v[0:15]
    s_add_u32 m0, s21, 4096
    v_mfma_f32_32x32x16_bf16 v[16:31], v[84:87], v[176:179], v[16:31]
    buffer_load_dwordx4 v234, s[4:7], s36 offen  lds
    buffer_load_dwordx4 v235, s[8:11], s36 offen offset:1024  lds
    s_mov_b32 m0, s50
    s_nop 0
    s_movrels_b32 s71, s23
    s_bfe_u32 s46, s71, 0x30012
    s_mov_b32 m0, s46
    s_and_b32 s66, s71, 0x3ffff
    s_movrels_b32 s68, s57
    s_movrels_b32 s69, s61
    s_sub_u32 s48, s66, s47
    s_mov_b32 s47, s66
    s_lshr_b32 s52, s71, 28
    s_lshl_b32 s67, s46, 9
    s_add_u32 s66, s66, s67
    s_sub_u32 s49, s66, s42
    s_mov_b32 s42, s66
    s_bfe_u32 s66, s68, 655360
    s_add_u32 s43, s42, s66
    s_bfe_u32 s39, s69, 655360
    s_bfe_u32 s66, s68, 655370
    s_add_u32 s44, s42, s66
    s_bfe_u32 s40, s69, 655370
    s_bfe_u32 s66, s68, 655380
    s_add_u32 s45, s42, s66
    s_bfe_u32 s41, s69, 655380
    s_and_b32 s66, s46, s33
    s_cselect_b32 s72, -1, 1
    s_cselect_b32 s76, s47, 163712
    s_cmp_ge_u32 s66, 2
    s_cselect_b32 s73, -1, 0
    s_add_u32 s77, s47, 1024
    s_cmp_ge_u32 s66, 4
    s_cselect_b32 s75, -1, 0
    s_cmp_ge_u32 s66, 3
    s_cselect_b32 s74, -1, 1
    s_cselect_b32 s77, s77, 163712
    v_add_u32 v252, s45, v247
    ds_read_u16 v240, v252
    ds_read_u16 v241, v252 offset:64
    v_mfma_f32_32x32x16_bf16 v[32:47], v[64:67], v[180:183], 0
    v_mul_f32 v196, v0, v96
    v_fmac_f32 v196, v1, v97
    v_fmac_f32 v196, v2, v98
    v_fmac_f32 v196, v3, v99
    v_fmac_f32 v196, v4, v100
    v_fmac_f32 v196, v5, v101
    v_fmac_f32 v196, v6, v102
    v_mfma_f32_32x32x16_bf16 v[48:63], v[68:71], v[180:183], 0
    v_add_u32 v253, s47, v248
    ds_read_b32 v254, v253
    ds_read_b32 v255, v253 offset:256
    v_fmac_f32 v196, v7, v103
    v_mul_f32 v198, v8, v128
    v_fmac_f32 v198, v9, v129
    v_fmac_f32 v198, v10, v130
    v_fmac_f32 v198, v11, v131
    v_fmac_f32 v198, v12, v132
    v_mfma_f32_32x32x16_bf16 v[32:47], v[72:75], v[184:187], v[32:47]
    v_fmac_f32 v198, v13, v133
    v_fmac_f32 v198, v14, v134
    v_fmac_f32 v198, v15, v135
    v_mul_f32 v200, v16, v128
    v_fmac_f32 v200, v17, v129
    v_permlane32_swap_b32 v196, v198
    v_mfma_f32_32x32x16_bf16 v[48:63], v[76:79], v[184:187], v[48:63]
    s_waitcnt vmcnt(6)
    ds_read_b64_tr_b16 v[176:177], v244 offset:6144
    ds_read_b64_tr_b16 v[178:179], v244 offset:7168
    ds_read_b64_tr_b16 v[180:181], v245 offset:6144
    ds_read_b64_tr_b16 v[182:183], v245 offset:7168
    v_fmac_f32 v200, v18, v130
    v_fmac_f32 v200, v19, v131
    v_fmac_f32 v200, v20, v132
    v_fmac_f32 v200, v21, v133
    v_fmac_f32 v200, v22, v134
    v_fmac_f32 v200, v23, v135
    v_mfma_f32_32x32x16_bf16 v[32:47], v[80:83], v[188:191], v[32:47]
    v_add_f32 v198, v196, v198
    v_mul_f32_e64 v202, v24, -v128
    v_fma_f32 v202, v25, -v129, v202
    v_fma_f32 v202, v26, -v130, v202
    v_fma_f32 v202, v27, -v131, v202
    v_fma_f32 v202, v28, -v132, v202
    v_mfma_f32_32x32x16_bf16 v[48:63], v[84:87], v[188:191], v[48:63]
    v_fma_f32 v202, v29, -v133, v202
    v_fma_f32 v202, v30, -v134, v202
    v_fma_f32 v202, v31, -v135, v202
    s_nop 1
    v_permlane32_swap_b32 v200, v202
    v_add_f32 v202, v200, v202
    s_waitcnt vmcnt(4) lgkmcnt(0)
    v_mfma_f32_32x32x16_bf16 v[0:15], v[64:67], v[176:179], 0
    v_mul_f32 v197, v32, v104
    v_fmac_f32 v197, v33, v105
    v_fmac_f32 v197, v34, v106
    v_fmac_f32 v197, v35, v107
    v_fmac_f32 v197, v36, v108
    v_fmac_f32 v197, v37, v109
    v_fmac_f32 v197, v38, v110
    s_add_u32 m0, s21, 6144
    v_mfma_f32_32x32x16_bf16 v[16:31], v[68:71], v[176:179], 0
    buffer_load_dwordx4 v236, s[4:7], s36 offen  lds
    buffer_load_dwordx4 v237, s[8:11], s36 offen offset:1024  lds
    ds_read_b64_tr_b16 v[176:177], v244 offset:0
    ds_read_b64_tr_b16 v[178:179], v244 offset:1024
    ds_read_b64_tr_b16 v[184:185], v245 offset:0
    ds_read_b64_tr_b16 v[186:187], v245 offset:1024
    s_mov_b32 m0, s76
    s_mov_b64 exec, s[72:73]
    buffer_load_dwordx4 v254, s[12:15], 0 offen  lds
    s_mov_b32 m0, s77
    s_mov_b64 exec, s[74:75]
    buffer_load_dwordx4 v255, s[12:15], 0 offen  lds
    s_mov_b64 exec, -1
    v_fmac_f32 v197, v39, v111
    v_mul_f32 v199, v40, v136
    v_fmac_f32 v199, v41, v137
    v_fmac_f32 v199, v42, v138
    v_fmac_f32 v199, v43, v139
    v_fmac_f32 v199, v44, v140
    v_fmac_f32 v199, v45, v141
    s_waitcnt vmcnt(6) lgkmcnt(0)
    v_mfma_f32_32x32x16_bf16 v[0:15], v[72:75], v[176:179], v[0:15]
    v_fmac_f32 v199, v46, v142
    v_fmac_f32 v199, v47, v143
    v_mul_f32 v201, v48, v136
    v_fmac_f32 v201, v49, v137
    v_permlane32_swap_b32 v197, v199
    v_fmac_f32 v201, v50, v138
    v_fmac_f32 v201, v51, v139
    s_add_u32 m0, s21, 0
    v_mfma_f32_32x32x16_bf16 v[16:31], v[76:79], v[176:179], v[16:31]
    buffer_load_dwordx4 v238, s[4:7], s36 offen  lds
    buffer_load_dwordx4 v239, s[8:11], s36 offen offset:1024  lds
    ds_read_b64_tr_b16 v[176:177], v244 offset:2048
    ds_read_b64_tr_b16 v[178:179], v244 offset:3072
    ds_read_b64_tr_b16 v[188:189], v245 offset:2048
    ds_read_b64_tr_b16 v[190:191], v245 offset:3072
    v_fmac_f32 v201, v52, v140
    v_fmac_f32 v201, v53, v141
    v_fmac_f32 v201, v54, v142
    v_fmac_f32 v201, v55, v143
    v_add_f32 v199, v197, v199
    v_mul_f32_e64 v203, v56, -v136
    v_fma_f32 v203, v57, -v137, v203
    s_waitcnt lgkmcnt(0)
    v_mfma_f32_32x32x16_bf16 v[0:15], v[80:83], v[176:179], v[0:15]
    v_fma_f32 v203, v58, -v138, v203
    v_fma_f32 v203, v59, -v139, v203
    v_fma_f32 v203, v60, -v140, v203
    v_fma_f32 v203, v61, -v141, v203
    v_fma_f32 v203, v62, -v142, v203
    v_fma_f32 v203, v63, -v143, v203
    s_nop 1
    s_add_u32 m0, s21, 2048
    v_mfma_f32_32x32x16_bf16 v[16:31], v[84:87], v[176:179], v[16:31]
    buffer_load_dwordx4 v234, s[4:7], s37 offen  lds
    buffer_load_dwordx4 v235, s[8:11], s37 offen offset:1024  lds
    v_add_u32 v252, s42, v247
    ds_read_u16 v234, v252
    ds_read_u16 v235, v252 offset:64
    v_permlane32_swap_b32 v201, v203
    v_add_f32 v203, v201, v203
    s_set_gpr_idx_on s51, gpr_idx(DST)
    s_nop 0
    v_cvt_pk_bf16_f32 v204, v198, v199
    v_cvt_pk_bf16_f32 v205, v202, v203
    s_set_gpr_idx_off
    v_mfma_f32_32x32x16_bf16 v[32:47], v[64:67], v[180:183], 0
    v_mul_f32 v196, v0, v144
    v_fmac_f32 v196, v1, v145
    v_fmac_f32 v196, v2, v146
    v_fmac_f32 v196, v3, v147
    v_fmac_f32 v196, v4, v148
    v_fmac_f32 v196, v5, v149
    v_mfma_f32_32x32x16_bf16 v[48:63], v[68:71], v[180:183], 0
    v_fmac_f32 v196, v6, v150
    v_fmac_f32 v196, v7, v151
    v_mul_f32 v198, v8, v112
    v_fmac_f32 v198, v9, v113
    v_fmac_f32 v198, v10, v114
    v_mfma_f32_32x32x16_bf16 v[32:47], v[72:75], v[184:187], v[32:47]
    v_fmac_f32 v198, v11, v115
    v_fmac_f32 v198, v12, v116
    v_fmac_f32 v198, v13, v117
    v_fmac_f32 v198, v14, v118
    v_fmac_f32 v198, v15, v119
    v_mfma_f32_32x32x16_bf16 v[48:63], v[76:79], v[184:187], v[48:63]
    s_waitcnt vmcnt(8)
    ds_read_b64_tr_b16 v[176:177], v244 offset:4096
    ds_read_b64_tr_b16 v[178:179], v244 offset:5120
    ds_read_b64_tr_b16 v[180:181], v245 offset:4096
    ds_read_b64_tr_b16 v[182:183], v245 offset:5120
    v_mul_f32_e64 v200, v16, -v160
    v_fma_f32 v200, v17, -v161, v200
    v_fma_f32 v200, v18, -v162, v200
    v_fma_f32 v200, v19, -v163, v200
    v_fma_f32 v200, v20, -v164, v200
    v_fma_f32 v200, v21, -v165, v200
    v_mfma_f32_32x32x16_bf16 v[32:47], v[80:83], v[188:191], v[32:47]
    v_fma_f32 v200, v22, -v166, v200
    v_fma_f32 v200, v23, -v167, v200
    v_mul_f32_e64 v202, v24, -v160
    v_fma_f32 v202, v25, -v161, v202
    v_fma_f32 v202, v26, -v162, v202
    v_mfma_f32_32x32x16_bf16 v[48:63], v[84:87], v[188:191], v[48:63]
    v_fma_f32 v202, v27, -v163, v202
    v_fma_f32 v202, v28, -v164, v202
    v_fma_f32 v202, v29, -v165, v202
    v_fma_f32 v202, v30, -v166, v202
    v_fma_f32 v202, v31, -v167, v202
    s_waitcnt vmcnt(6) lgkmcnt(0)
    v_mfma_f32_32x32x16_bf16 v[0:15], v[64:67], v[176:179], 0
    v_mul_f32 v197, v32, v152
    v_fmac_f32 v197, v33, v153
    v_fmac_f32 v197, v34, v154
    v_fmac_f32 v197, v35, v155
    v_fmac_f32 v197, v36, v156
    v_fmac_f32 v197, v37, v157
    s_add_u32 m0, s21, 4096
    v_mfma_f32_32x32x16_bf16 v[16:31], v[68:71], v[176:179], 0
    buffer_load_dwordx4 v236, s[4:7], s37 offen  lds
    buffer_load_dwordx4 v237, s[8:11], s37 offen offset:1024  lds
    ds_read_b64_tr_b16 v[176:177], v244 offset:6144
    ds_read_b64_tr_b16 v[178:179], v244 offset:7168
    ds_read_b64_tr_b16 v[184:185], v245 offset:6144
    ds_read_b64_tr_b16 v[186:187], v245 offset:7168
    v_add_u32 v252, s43, v247
    ds_read_u16 v236, v252
    ds_read_u16 v237, v252 offset:64
    v_fmac_f32 v197, v38, v158
    v_fmac_f32 v197, v39, v159
    v_mul_f32 v199, v40, v120
    v_fmac_f32 v199, v41, v121
    v_fmac_f32 v199, v42, v122
    s_waitcnt vmcnt(4) lgkmcnt(2)
    v_mfma_f32_32x32x16_bf16 v[0:15], v[72:75], v[176:179], v[0:15]
    v_fmac_f32 v199, v43, v123
    v_fmac_f32 v199, v44, v124
    v_fmac_f32 v199, v45, v125
    v_fmac_f32 v199, v46, v126
    v_fmac_f32 v199, v47, v127
    s_add_u32 m0, s21, 6144
    v_mfma_f32_32x32x16_bf16 v[16:31], v[76:79], v[176:179], v[16:31]
    buffer_load_dwordx4 v238, s[4:7], s37 offen  lds
    buffer_load_dwordx4 v239, s[8:11], s37 offen offset:1024  lds
    ds_read_b64_tr_b16 v[176:177], v244 offset:0
    ds_read_b64_tr_b16 v[178:179], v244 offset:1024
    ds_read_b64_tr_b16 v[188:189], v245 offset:0
    ds_read_b64_tr_b16 v[190:191], v245 offset:1024
    v_add_u32 v252, s44, v247
    ds_read_u16 v238, v252
    ds_read_u16 v239, v252 offset:64
    v_mul_f32_e64 v201, v48, -v168
    v_fma_f32 v201, v49, -v169, v201
    v_fma_f32 v201, v50, -v170, v201
    v_fma_f32 v201, v51, -v171, v201
    v_fma_f32 v201, v52, -v172, v201
    v_fma_f32 v201, v53, -v173, v201
    s_waitcnt lgkmcnt(2)
    v_mfma_f32_32x32x16_bf16 v[0:15], v[80:83], v[176:179], v[0:15]
    v_fma_f32 v201, v54, -v174, v201
    v_fma_f32 v201, v55, -v175, v201
    v_mul_f32_e64 v203, v56, -v168
    v_fma_f32 v203, v57, -v169, v203
    v_fma_f32 v203, v58, -v170, v203
    s_add_u32 m0, s21, 0
    v_mfma_f32_32x32x16_bf16 v[16:31], v[84:87], v[176:179], v[16:31]
    v_lshl_add_u32 v234, v234, 10, v246
    v_lshl_add_u32 v235, v235, 10, v246
    buffer_load_dwordx4 v234, s[4:7], s38 offen  lds
    buffer_load_dwordx4 v235, s[8:11], s38 offen offset:1024  lds
    v_fma_f32 v203, v59, -v171, v203
    v_fma_f32 v203, v60, -v172, v203
    v_fma_f32 v203, v61, -v173, v203
    v_fma_f32 v203, v62, -v174, v203
    v_fma_f32 v203, v63, -v175, v203
    v_mfma_f32_32x32x16_bf16 v[32:47], v[64:67], v[180:183], 0
    v_mul_f32 v254, v0, v144
    v_fmac_f32 v254, v1, v145
    v_fmac_f32 v254, v2, v146
    v_mfma_f32_32x32x16_bf16 v[48:63], v[68:71], v[180:183], 0
    ds_swizzle_b32 v68, v68 offset:0x401F
    ds_swizzle_b32 v69, v69 offset:0x401F
    ds_swizzle_b32 v70, v70 offset:0x401F
    ds_swizzle_b32 v71, v71 offset:0x401F
    v_fmac_f32 v254, v3, v147
    v_fmac_f32 v254, v4, v148
    v_fmac_f32 v254, v5, v149
    v_mfma_f32_32x32x16_bf16 v[32:47], v[72:75], v[184:187], v[32:47]
    v_fmac_f32 v254, v6, v150
    v_fmac_f32 v254, v7, v151
    v_fmac_f32 v200, v8, v160
    v_mfma_f32_32x32x16_bf16 v[48:63], v[76:79], v[184:187], v[48:63]
    ds_swizzle_b32 v76, v76 offset:0x401F
    ds_swizzle_b32 v77, v77 offset:0x401F
    ds_swizzle_b32 v78, v78 offset:0x401F
    ds_swizzle_b32 v79, v79 offset:0x401F
    s_waitcnt vmcnt(6)
    ds_read_b64_tr_b16 v[176:177], v244 offset:2048
    ds_read_b64_tr_b16 v[178:179], v244 offset:3072
    ds_read_b64_tr_b16 v[180:181], v245 offset:2048
    ds_read_b64_tr_b16 v[182:183], v245 offset:3072
    v_fmac_f32 v200, v9, v161
    v_permlane32_swap_b32 v196, v254
    v_fmac_f32 v200, v10, v162
    v_mfma_f32_32x32x16_bf16 v[32:47], v[80:83], v[188:191], v[32:47]
    v_fmac_f32 v200, v11, v163
    v_fmac_f32 v200, v12, v164
    v_fmac_f32 v200, v13, v165
    v_mfma_f32_32x32x16_bf16 v[48:63], v[84:87], v[188:191], v[48:63]
    ds_swizzle_b32 v84, v84 offset:0x401F
    ds_swizzle_b32 v85, v85 offset:0x401F
    ds_swizzle_b32 v86, v86 offset:0x401F
    ds_swizzle_b32 v87, v87 offset:0x401F
    v_fmac_f32 v200, v14, v166
    v_fmac_f32 v200, v15, v167
    v_add_f32 v254, v196, v254
    s_waitcnt lgkmcnt(8)
    s_mov_b64 exec, s[56:57]
    v_xor_b32 v68, 0x80008000, v68
    v_xor_b32 v69, 0x80008000, v69
    v_xor_b32 v70, 0x80008000, v70
    v_xor_b32 v71, 0x80008000, v71
    v_xor_b32 v76, 0x80008000, v76
    v_xor_b32 v77, 0x80008000, v77
    v_xor_b32 v78, 0x80008000, v78
    v_xor_b32 v79, 0x80008000, v79
    s_mov_b64 exec, -1
    s_waitcnt vmcnt(4) lgkmcnt(4)
    v_mfma_f32_32x32x16_bf16 v[0:15], v[64:67], v[176:179], 0
    v_mul_f32 v255, v32, v152
    v_fmac_f32 v255, v33, v153
    v_fmac_f32 v255, v34, v154
    v_fmac_f32 v255, v35, v155
    s_add_u32 m0, s21, 2048
    v_mfma_f32_32x32x16_bf16 v[16:31], v[68:71], v[176:179], v[16:31]
    v_lshl_add_u32 v236, v236, 10, v246
    v_lshl_add_u32 v237, v237, 10, v246
    buffer_load_dwordx4 v236, s[4:7], s39 offen  lds
    buffer_load_dwordx4 v237, s[8:11], s39 offen offset:1024  lds
    ds_read_b64_tr_b16 v[176:177], v244 offset:4096
    ds_read_b64_tr_b16 v[178:179], v244 offset:5120
    ds_read_b64_tr_b16 v[184:185], v245 offset:4096
    ds_read_b64_tr_b16 v[186:187], v245 offset:5120
    v_fmac_f32 v255, v36, v156
    v_fmac_f32 v255, v37, v157
    v_fmac_f32 v255, v38, v158
    v_fmac_f32 v255, v39, v159
    s_waitcnt vmcnt(4) lgkmcnt(0)
    v_mfma_f32_32x32x16_bf16 v[0:15], v[72:75], v[176:179], v[0:15]
    v_fmac_f32 v201, v40, v168
    v_fmac_f32 v201, v41, v169
    v_permlane32_swap_b32 v197, v255
    s_add_u32 m0, s21, 4096
    v_mfma_f32_32x32x16_bf16 v[16:31], v[76:79], v[176:179], v[16:31]
    v_lshl_add_u32 v238, v238, 10, v246
    v_lshl_add_u32 v239, v239, 10, v246
    buffer_load_dwordx4 v238, s[4:7], s40 offen  lds
    buffer_load_dwordx4 v239, s[8:11], s40 offen offset:1024  lds
    ds_read_b64_tr_b16 v[176:177], v244 offset:6144
    ds_read_b64_tr_b16 v[178:179], v244 offset:7168
    ds_read_b64_tr_b16 v[188:189], v245 offset:6144
    ds_read_b64_tr_b16 v[190:191], v245 offset:7168
    v_fmac_f32 v201, v42, v170
    v_fmac_f32 v201, v43, v171
    v_fmac_f32 v201, v44, v172
    v_fmac_f32 v201, v45, v173
    s_waitcnt lgkmcnt(0)
    s_mov_b64 exec, s[56:57]
    v_xor_b32 v84, 0x80008000, v84
    v_xor_b32 v85, 0x80008000, v85
    v_xor_b32 v86, 0x80008000, v86
    v_xor_b32 v87, 0x80008000, v87
    s_mov_b64 exec, -1
    v_mfma_f32_32x32x16_bf16 v[0:15], v[80:83], v[176:179], v[0:15]
    v_fmac_f32 v201, v46, v174
    v_fmac_f32 v201, v47, v175
    v_add_f32 v255, v197, v255
    s_set_gpr_idx_on s51, gpr_idx(DST)
    s_nop 0
    v_cvt_pk_bf16_f32 v206, v254, v255
    s_set_gpr_idx_off
    s_add_u32 m0, s21, 6144
    v_mfma_f32_32x32x16_bf16 v[16:31], v[84:87], v[176:179], v[16:31]
    v_lshl_add_u32 v240, v240, 10, v246
    v_lshl_add_u32 v241, v241, 10, v246
    buffer_load_dwordx4 v240, s[4:7], s41 offen  lds
    buffer_load_dwordx4 v241, s[8:11], s41 offen offset:1024  lds
    v_mfma_f32_32x32x16_bf16 v[32:47], v[64:67], v[180:183], 0
    v_mul_f32 v254, v0, v144
    v_fmac_f32 v254, v1, v145
    v_fmac_f32 v254, v2, v146
    v_fmac_f32 v254, v3, v147
    v_fmac_f32 v254, v4, v148
    v_fmac_f32 v254, v5, v149
    v_fmac_f32 v254, v6, v150
    v_mfma_f32_32x32x16_bf16 v[48:63], v[68:71], v[180:183], v[48:63]
    v_fmac_f32 v254, v7, v151
    v_fma_f32 v202, v8, -v160, v202
    v_fma_f32 v202, v9, -v161, v202
    v_permlane32_swap_b32 v254, v200
    v_fma_f32 v202, v10, -v162, v202
    v_fma_f32 v202, v11, -v163, v202
    v_mfma_f32_32x32x16_bf16 v[32:47], v[72:75], v[184:187], v[32:47]
    v_fma_f32 v202, v12, -v164, v202
    v_fma_f32 v202, v13, -v165, v202
    v_fma_f32 v202, v14, -v166, v202
    v_fma_f32 v202, v15, -v167, v202
    v_add_f32 v200, v254, v200
    v_fmac_f32 v198, v16, v112
    v_permlane32_swap_b32 v202, v254
    v_mfma_f32_32x32x16_bf16 v[48:63], v[76:79], v[184:187], v[48:63]
    s_waitcnt vmcnt(6)
    ds_read_b64_tr_b16 v[176:177], v244 offset:0
    ds_read_b64_tr_b16 v[178:179], v244 offset:1024
    ds_read_b64_tr_b16 v[180:181], v245 offset:0
    ds_read_b64_tr_b16 v[182:183], v245 offset:1024
    v_fmac_f32 v198, v17, v113
    v_fmac_f32 v198, v18, v114
    v_fmac_f32 v198, v19, v115
    v_fmac_f32 v198, v20, v116
    v_fmac_f32 v198, v21, v117
    v_fmac_f32 v198, v22, v118
    v_mfma_f32_32x32x16_bf16 v[32:47], v[80:83], v[188:191], v[32:47]
    v_fmac_f32 v198, v23, v119
    v_add_f32 v254, v202, v254
    v_mul_f32 v196, v24, v160
    v_fmac_f32 v196, v25, v161
    v_fmac_f32 v196, v26, v162
    v_fmac_f32 v196, v27, v163
    v_fmac_f32 v196, v28, v164
    v_mfma_f32_32x32x16_bf16 v[48:63], v[84:87], v[188:191], v[48:63]
    v_add_u32 v249, s48, v249
    v_add_u32 v250, s49, v250
    ds_read_b64_tr_b16 v[64:65], v249 offset:0
    ds_read_b64_tr_b16 v[68:69], v249 offset:64
    ds_read_b64_tr_b16 v[66:67], v249 offset:256
    ds_read_b64_tr_b16 v[70:71], v249 offset:320
    s_mov_b64 exec, s[54:55]
    ds_read_u16_d16_hi v242, v250 offset:0
    s_mov_b64 exec, -1
    v_fmac_f32 v196, v29, v165
    v_fmac_f32 v196, v30, v166
    v_fmac_f32 v196, v31, v167
    s_nop 1
    v_permlane32_swap_b32 v198, v196
    v_add_f32 v196, v198, v196
    v_mul_f32 v255, v32, v152
    v_fmac_f32 v255, v33, v153
    v_fmac_f32 v255, v34, v154
    v_fmac_f32 v255, v35, v155
    v_fmac_f32 v255, v36, v156
    v_fmac_f32 v255, v37, v157
    v_fmac_f32 v255, v38, v158
    v_fmac_f32 v255, v39, v159
    v_fma_f32 v203, v40, -v168, v203
    v_fma_f32 v203, v41, -v169, v203
    v_permlane32_swap_b32 v255, v201
    v_fma_f32 v203, v42, -v170, v203
    v_fma_f32 v203, v43, -v171, v203
    v_fma_f32 v203, v44, -v172, v203
    v_fma_f32 v203, v45, -v173, v203
    v_fma_f32 v203, v46, -v174, v203
    v_fma_f32 v203, v47, -v175, v203
    v_add_f32 v201, v255, v201
    v_fmac_f32 v199, v48, v120
    v_permlane32_swap_b32 v203, v255
    v_fmac_f32 v199, v49, v121
    v_fmac_f32 v199, v50, v122
    v_fmac_f32 v199, v51, v123
    v_fmac_f32 v199, v52, v124
    v_fmac_f32 v199, v53, v125
    v_fmac_f32 v199, v54, v126
    v_fmac_f32 v199, v55, v127
    v_add_f32 v255, v203, v255
    v_mul_f32 v197, v56, v168
    v_fmac_f32 v197, v57, v169
    v_fmac_f32 v197, v58, v170
    v_fmac_f32 v197, v59, v171
    v_fmac_f32 v197, v60, v172
    v_fmac_f32 v197, v61, v173
    v_fmac_f32 v197, v62, v174
    v_fmac_f32 v197, v63, v175
    s_nop 1
    v_permlane32_swap_b32 v199, v197
    v_add_f32 v197, v199, v197
    s_set_gpr_idx_on s51, gpr_idx(DST)
    s_nop 0
    v_cvt_pk_bf16_f32 v207, v200, v201
    v_cvt_pk_bf16_f32 v209, v254, v255
    v_cvt_pk_bf16_f32 v208, v196, v197
    s_set_gpr_idx_off
    s_add_u32 s50, s50, 1
    s_add_u32 s51, s51, 6
    s_cmp_ge_u32 s50, 4
    s_cbranch_scc1 LAST0
    s_add_u32 s53, s53, 4
    s_xor_b32 s66, s53, s20
    s_bitcmp1_b32 s66, 2
    s_setprio 1
    s_cbranch_scc1 PRIO_8
    s_setprio 0
PRIO_8:
    s_cmp_eq_u32 s52, 4
    s_cbranch_scc1 ITEM_0_4
    s_cmp_eq_u32 s52, 5
    s_cbranch_scc1 ITEM_0_5
    s_cmp_eq_u32 s52, 3
    s_cbranch_scc1 ITEM_0_3
    s_cmp_eq_u32 s52, 6
    s_cbranch_scc1 ITEM_0_6
    s_cmp_eq_u32 s52, 8
    s_cbranch_scc1 ITEM_0_8
    s_branch ITEM_0_2
.p2align 6
ITEM_0_8:
    s_mov_b64 exec, s[54:55]
    ds_read_u16_d16_hi v243, v250 offset:128
    s_mov_b64 exec, -1
    ds_read_b64_tr_b16 v[72:73], v249 offset:512
    ds_read_b64_tr_b16 v[76:77], v249 offset:576
    ds_read_b64_tr_b16 v[74:75], v249 offset:768
    ds_read_b64_tr_b16 v[78:79], v249 offset:832
    ds_read_b64_tr_b16 v[80:81], v249 offset:1024
    ds_read_b64_tr_b16 v[84:85], v249 offset:1088
    ds_read_b64_tr_b16 v[82:83], v249 offset:1280
    ds_read_b64_tr_b16 v[86:87], v249 offset:1344
    ds_read_b64_tr_b16 v[88:89], v249 offset:1536
    ds_read_b64_tr_b16 v[92:93], v249 offset:1600
    ds_read_b64_tr_b16 v[90:91], v249 offset:1792
    ds_read_b64_tr_b16 v[94:95], v249 offset:1856
    s_waitcnt lgkmcnt(13)
    v_mul_f32_dpp v196, v242, v64 row_newbcast:0 row_mask:0xf bank_mask:0xf
    v_mul_f32_dpp v197, v242, v65 row_newbcast:1 row_mask:0xf bank_mask:0xf
    v_mul_f32_dpp v198, v242, v64 row_newbcast:8 row_mask:0xf bank_mask:0xf
    v_mul_f32_dpp v199, v242, v65 row_newbcast:9 row_mask:0xf bank_mask:0xf
    v_mul_f32_dpp v200, v242, v68 row_newbcast:2 row_mask:0xf bank_mask:0xf
    v_mul_f32_dpp v201, v242, v69 row_newbcast:3 row_mask:0xf bank_mask:0xf
    v_mul_f32_dpp v202, v242, v68 row_newbcast:10 row_mask:0xf bank_mask:0xf
    v_mul_f32_dpp v203, v242, v69 row_newbcast:11 row_mask:0xf bank_mask:0xf
    v_cvt_pk_bf16_f32 v64, v196, v197
    v_cvt_pk_bf16_f32 v68, v198, v199
    v_cvt_pk_bf16_f32 v65, v200, v201
    v_cvt_pk_bf16_f32 v69, v202, v203
    v_mul_f32_dpp v196, v242, v66 row_newbcast:4 row_mask:0xf bank_mask:0xf
    v_mul_f32_dpp v197, v242, v67 row_newbcast:5 row_mask:0xf bank_mask:0xf
    v_mul_f32_dpp v198, v242, v66 row_newbcast:12 row_mask:0xf bank_mask:0xf
    v_mul_f32_dpp v199, v242, v67 row_newbcast:13 row_mask:0xf bank_mask:0xf
    v_mul_f32_dpp v200, v242, v70 row_newbcast:6 row_mask:0xf bank_mask:0xf
    v_mul_f32_dpp v201, v242, v71 row_newbcast:7 row_mask:0xf bank_mask:0xf
    v_mul_f32_dpp v202, v242, v70 row_newbcast:14 row_mask:0xf bank_mask:0xf
    v_mul_f32_dpp v203, v242, v71 row_newbcast:15 row_mask:0xf bank_mask:0xf
    v_cvt_pk_bf16_f32 v66, v196, v197
    v_cvt_pk_bf16_f32 v70, v198, v199
    v_cvt_pk_bf16_f32 v67, v200, v201
    v_cvt_pk_bf16_f32 v71, v202, v203
    s_mov_b64 exec, s[54:55]
    ds_read_u16_d16_hi v242, v250 offset:256
    s_mov_b64 exec, -1
    s_waitcnt vmcnt(4) lgkmcnt(9)
    v_mfma_f32_32x32x16_bf16 v[0:15], v[64:67], v[176:179], 0
    v_mul_f32_dpp v196, v243, v72 row_newbcast:0 row_mask:0xf bank_mask:0xf
    v_mul_f32_dpp v197, v243, v73 row_newbcast:1 row_mask:0xf bank_mask:0xf
    v_mul_f32_dpp v198, v243, v72 row_newbcast:8 row_mask:0xf bank_mask:0xf
    v_mul_f32_dpp v199, v243, v73 row_newbcast:9 row_mask:0xf bank_mask:0xf
    v_mul_f32_dpp v200, v243, v76 row_newbcast:2 row_mask:0xf bank_mask:0xf
    v_mul_f32_dpp v201, v243, v77 row_newbcast:3 row_mask:0xf bank_mask:0xf
    v_mul_f32_dpp v202, v243, v76 row_newbcast:10 row_mask:0xf bank_mask:0xf
    v_mul_f32_dpp v203, v243, v77 row_newbcast:11 row_mask:0xf bank_mask:0xf
    v_cvt_pk_bf16_f32 v72, v196, v197
    v_cvt_pk_bf16_f32 v76, v198, v199
    v_cvt_pk_bf16_f32 v73, v200, v201
    v_cvt_pk_bf16_f32 v77, v202, v203
    s_add_u32 m0, s21, 0
    v_mfma_f32_32x32x16_bf16 v[16:31], v[68:71], v[176:179], 0
    buffer_load_dwordx4 v234, s[4:7], s35 offen  lds
    buffer_load_dwordx4 v235, s[8:11], s35 offen offset:1024  lds
    ds_read_b64_tr_b16 v[176:177], v244 offset:2048
    ds_read_b64_tr_b16 v[178:179], v244 offset:3072
    ds_read_b64_tr_b16 v[184:185], v245 offset:2048
    ds_read_b64_tr_b16 v[186:187], v245 offset:3072
    v_mul_f32_dpp v196, v243, v74 row_newbcast:4 row_mask:0xf bank_mask:0xf
    v_mul_f32_dpp v197, v243, v75 row_newbcast:5 row_mask:0xf bank_mask:0xf
    v_mul_f32_dpp v198, v243, v74 row_newbcast:12 row_mask:0xf bank_mask:0xf
    v_mul_f32_dpp v199, v243, v75 row_newbcast:13 row_mask:0xf bank_mask:0xf
    v_mul_f32_dpp v200, v243, v78 row_newbcast:6 row_mask:0xf bank_mask:0xf
    v_mul_f32_dpp v201, v243, v79 row_newbcast:7 row_mask:0xf bank_mask:0xf
    v_mul_f32_dpp v202, v243, v78 row_newbcast:14 row_mask:0xf bank_mask:0xf
    v_mul_f32_dpp v203, v243, v79 row_newbcast:15 row_mask:0xf bank_mask:0xf
    v_cvt_pk_bf16_f32 v74, v196, v197
    v_cvt_pk_bf16_f32 v78, v198, v199
    v_cvt_pk_bf16_f32 v75, v200, v201
    v_cvt_pk_bf16_f32 v79, v202, v203
    s_mov_b64 exec, s[54:55]
    ds_read_u16_d16_hi v243, v250 offset:384
    s_mov_b64 exec, -1
    s_waitcnt vmcnt(4) lgkmcnt(1)
    v_mfma_f32_32x32x16_bf16 v[0:15], v[72:75], v[176:179], v[0:15]
    v_mul_f32_dpp v196, v242, v80 row_newbcast:0 row_mask:0xf bank_mask:0xf
    v_mul_f32_dpp v197, v242, v81 row_newbcast:1 row_mask:0xf bank_mask:0xf
    v_mul_f32_dpp v198, v242, v80 row_newbcast:8 row_mask:0xf bank_mask:0xf
    v_mul_f32_dpp v199, v242, v81 row_newbcast:9 row_mask:0xf bank_mask:0xf
    v_mul_f32_dpp v200, v242, v84 row_newbcast:2 row_mask:0xf bank_mask:0xf
    v_mul_f32_dpp v201, v242, v85 row_newbcast:3 row_mask:0xf bank_mask:0xf
    v_mul_f32_dpp v202, v242, v84 row_newbcast:10 row_mask:0xf bank_mask:0xf
    v_mul_f32_dpp v203, v242, v85 row_newbcast:11 row_mask:0xf bank_mask:0xf
    v_cvt_pk_bf16_f32 v80, v196, v197
    v_cvt_pk_bf16_f32 v84, v198, v199
    v_cvt_pk_bf16_f32 v81, v200, v201
    v_cvt_pk_bf16_f32 v85, v202, v203
    s_add_u32 m0, s21, 2048
    v_mfma_f32_32x32x16_bf16 v[16:31], v[76:79], v[176:179], v[16:31]
    buffer_load_dwordx4 v236, s[4:7], s35 offen  lds
    buffer_load_dwordx4 v237, s[8:11], s35 offen offset:1024  lds
    ds_read_b64_tr_b16 v[176:177], v244 offset:4096
    ds_read_b64_tr_b16 v[178:179], v244 offset:5120
    ds_read_b64_tr_b16 v[188:189], v245 offset:4096
    ds_read_b64_tr_b16 v[190:191], v245 offset:5120
    v_mul_f32_dpp v196, v242, v82 row_newbcast:4 row_mask:0xf bank_mask:0xf
    v_mul_f32_dpp v197, v242, v83 row_newbcast:5 row_mask:0xf bank_mask:0xf
    v_mul_f32_dpp v198, v242, v82 row_newbcast:12 row_mask:0xf bank_mask:0xf
    v_mul_f32_dpp v199, v242, v83 row_newbcast:13 row_mask:0xf bank_mask:0xf
    v_mul_f32_dpp v200, v242, v86 row_newbcast:6 row_mask:0xf bank_mask:0xf
    v_mul_f32_dpp v201, v242, v87 row_newbcast:7 row_mask:0xf bank_mask:0xf
    v_mul_f32_dpp v202, v242, v86 row_newbcast:14 row_mask:0xf bank_mask:0xf
    v_mul_f32_dpp v203, v242, v87 row_newbcast:15 row_mask:0xf bank_mask:0xf
    v_cvt_pk_bf16_f32 v82, v196, v197
    v_cvt_pk_bf16_f32 v86, v198, v199
    v_cvt_pk_bf16_f32 v83, v200, v201
    v_cvt_pk_bf16_f32 v87, v202, v203
    s_nop 0
    s_waitcnt vmcnt(4) lgkmcnt(0)
    v_mfma_f32_32x32x16_bf16 v[0:15], v[80:83], v[176:179], v[0:15]
    v_mul_f32_dpp v196, v243, v88 row_newbcast:0 row_mask:0xf bank_mask:0xf
    v_mul_f32_dpp v197, v243, v89 row_newbcast:1 row_mask:0xf bank_mask:0xf
    v_mul_f32_dpp v198, v243, v88 row_newbcast:8 row_mask:0xf bank_mask:0xf
    v_mul_f32_dpp v199, v243, v89 row_newbcast:9 row_mask:0xf bank_mask:0xf
    v_mul_f32_dpp v200, v243, v92 row_newbcast:2 row_mask:0xf bank_mask:0xf
    v_mul_f32_dpp v201, v243, v93 row_newbcast:3 row_mask:0xf bank_mask:0xf
    v_mul_f32_dpp v202, v243, v92 row_newbcast:10 row_mask:0xf bank_mask:0xf
    v_mul_f32_dpp v203, v243, v93 row_newbcast:11 row_mask:0xf bank_mask:0xf
    v_cvt_pk_bf16_f32 v88, v196, v197
    v_cvt_pk_bf16_f32 v92, v198, v199
    v_cvt_pk_bf16_f32 v89, v200, v201
    v_cvt_pk_bf16_f32 v93, v202, v203
    s_add_u32 m0, s21, 4096
    v_mfma_f32_32x32x16_bf16 v[16:31], v[84:87], v[176:179], v[16:31]
    buffer_load_dwordx4 v238, s[4:7], s35 offen  lds
    buffer_load_dwordx4 v239, s[8:11], s35 offen offset:1024  lds
    ds_read_b64_tr_b16 v[176:177], v244 offset:6144
    ds_read_b64_tr_b16 v[178:179], v244 offset:7168
    ds_read_b64_tr_b16 v[192:193], v245 offset:6144
    ds_read_b64_tr_b16 v[194:195], v245 offset:7168
    v_mul_f32_dpp v196, v243, v90 row_newbcast:4 row_mask:0xf bank_mask:0xf
    v_mul_f32_dpp v197, v243, v91 row_newbcast:5 row_mask:0xf bank_mask:0xf
    v_mul_f32_dpp v198, v243, v90 row_newbcast:12 row_mask:0xf bank_mask:0xf
    v_mul_f32_dpp v199, v243, v91 row_newbcast:13 row_mask:0xf bank_mask:0xf
    v_mul_f32_dpp v200, v243, v94 row_newbcast:6 row_mask:0xf bank_mask:0xf
    v_mul_f32_dpp v201, v243, v95 row_newbcast:7 row_mask:0xf bank_mask:0xf
    v_mul_f32_dpp v202, v243, v94 row_newbcast:14 row_mask:0xf bank_mask:0xf
    v_mul_f32_dpp v203, v243, v95 row_newbcast:15 row_mask:0xf bank_mask:0xf
    v_cvt_pk_bf16_f32 v90, v196, v197
    v_cvt_pk_bf16_f32 v94, v198, v199
    v_cvt_pk_bf16_f32 v91, v200, v201
    v_cvt_pk_bf16_f32 v95, v202, v203
    s_nop 0
    s_waitcnt lgkmcnt(0)
    v_mfma_f32_32x32x16_bf16 v[0:15], v[88:91], v[176:179], v[0:15]
    s_add_u32 m0, s21, 6144
    v_mfma_f32_32x32x16_bf16 v[16:31], v[92:95], v[176:179], v[16:31]
    buffer_load_dwordx4 v240, s[4:7], s35 offen  lds
    buffer_load_dwordx4 v241, s[8:11], s35 offen offset:1024  lds
    s_mov_b32 m0, s50
    s_nop 0
    s_movrels_b32 s71, s23
    s_bfe_u32 s46, s71, 0x30012
    s_mov_b32 m0, s46
    s_and_b32 s66, s71, 0x3ffff
    s_movrels_b32 s68, s57
    s_movrels_b32 s69, s61
    s_sub_u32 s48, s66, s47
    s_mov_b32 s47, s66
    s_lshr_b32 s52, s71, 28
    s_lshl_b32 s67, s46, 9
    s_add_u32 s66, s66, s67
    s_sub_u32 s49, s66, s42
    s_mov_b32 s42, s66
    s_bfe_u32 s66, s68, 655360
    s_add_u32 s43, s42, s66
    s_bfe_u32 s39, s69, 655360
    s_bfe_u32 s66, s68, 655370
    s_add_u32 s44, s42, s66
    s_bfe_u32 s40, s69, 655370
    s_bfe_u32 s66, s68, 655380
    s_add_u32 s45, s42, s66
    s_bfe_u32 s41, s69, 655380
    s_and_b32 s66, s46, s33
    s_cselect_b32 s72, -1, 1
    s_cselect_b32 s76, s47, 163712
    s_cmp_ge_u32 s66, 2
    s_cselect_b32 s73, -1, 0
    s_add_u32 s77, s47, 1024
    s_cmp_ge_u32 s66, 4
    s_cselect_b32 s75, -1, 0
    s_cmp_ge_u32 s66, 3
    s_cselect_b32 s74, -1, 1
    s_cselect_b32 s77, s77, 163712
    v_mfma_f32_32x32x16_bf16 v[32:47], v[64:67], v[180:183], 0
    v_mul_f32 v196, v0, v96
    v_fmac_f32 v196, v1, v97
    v_fmac_f32 v196, v2, v98
    v_fmac_f32 v196, v3, v99
    v_fmac_f32 v196, v4, v100
    v_mfma_f32_32x32x16_bf16 v[48:63], v[68:71], v[180:183], 0
    v_add_u32 v253, s47, v248
    ds_read_b32 v254, v253
    ds_read_b32 v255, v253 offset:256
    v_fmac_f32 v196, v5, v101
    v_fmac_f32 v196, v6, v102
    v_fmac_f32 v196, v7, v103
    v_mul_f32 v198, v8, v128
    v_fmac_f32 v198, v9, v129
    v_mfma_f32_32x32x16_bf16 v[32:47], v[72:75], v[184:187], v[32:47]
    v_fmac_f32 v198, v10, v130
    v_fmac_f32 v198, v11, v131
    v_fmac_f32 v198, v12, v132
    v_fmac_f32 v198, v13, v133
    v_mfma_f32_32x32x16_bf16 v[48:63], v[76:79], v[184:187], v[48:63]
    v_fmac_f32 v198, v14, v134
    v_fmac_f32 v198, v15, v135
    v_mul_f32 v200, v16, v128
    v_fmac_f32 v200, v17, v129
    v_permlane32_swap_b32 v196, v198
    v_mfma_f32_32x32x16_bf16 v[32:47], v[80:83], v[188:191], v[32:47]
    v_fmac_f32 v200, v18, v130
    v_fmac_f32 v200, v19, v131
    v_fmac_f32 v200, v20, v132
    v_fmac_f32 v200, v21, v133
    v_fmac_f32 v200, v22, v134
    v_mfma_f32_32x32x16_bf16 v[48:63], v[84:87], v[188:191], v[48:63]
    s_waitcnt vmcnt(6)
    ds_read_b64_tr_b16 v[176:177], v244 offset:0
    ds_read_b64_tr_b16 v[178:179], v244 offset:1024
    ds_read_b64_tr_b16 v[180:181], v245 offset:0
    ds_read_b64_tr_b16 v[182:183], v245 offset:1024
    v_fmac_f32 v200, v23, v135
    v_add_f32 v198, v196, v198
    v_mul_f32_e64 v202, v24, -v128
    v_fma_f32 v202, v25, -v129, v202
    v_mfma_f32_32x32x16_bf16 v[32:47], v[88:91], v[192:195], v[32:47]
    v_fma_f32 v202, v26, -v130, v202
    v_fma_f32 v202, v27, -v131, v202
    v_fma_f32 v202, v28, -v132, v202
    v_fma_f32 v202, v29, -v133, v202
    v_fma_f32 v202, v30, -v134, v202
    v_mfma_f32_32x32x16_bf16 v[48:63], v[92:95], v[192:195], v[48:63]
    v_fma_f32 v202, v31, -v135, v202
    s_nop 1
    v_permlane32_swap_b32 v200, v202
    v_add_f32 v202, v200, v202
    s_waitcnt vmcnt(4) lgkmcnt(0)
    v_mfma_f32_32x32x16_bf16 v[0:15], v[64:67], v[176:179], 0
    v_mul_f32 v197, v32, v104
    v_fmac_f32 v197, v33, v105
    v_fmac_f32 v197, v34, v106
    v_fmac_f32 v197, v35, v107
    v_fmac_f32 v197, v36, v108
    v_fmac_f32 v197, v37, v109
    s_add_u32 m0, s21, 0
    v_mfma_f32_32x32x16_bf16 v[16:31], v[68:71], v[176:179], 0
    buffer_load_dwordx4 v234, s[4:7], s36 offen  lds
    buffer_load_dwordx4 v235, s[8:11], s36 offen offset:1024  lds
    ds_read_b64_tr_b16 v[176:177], v244 offset:2048
    ds_read_b64_tr_b16 v[178:179], v244 offset:3072
    ds_read_b64_tr_b16 v[184:185], v245 offset:2048
    ds_read_b64_tr_b16 v[186:187], v245 offset:3072
    s_mov_b32 m0, s76
    s_mov_b64 exec, s[72:73]
    buffer_load_dwordx4 v254, s[12:15], 0 offen  lds
    s_mov_b32 m0, s77
    s_mov_b64 exec, s[74:75]
    buffer_load_dwordx4 v255, s[12:15], 0 offen  lds
    s_mov_b64 exec, -1
    v_fmac_f32 v197, v38, v110
    v_fmac_f32 v197, v39, v111
    v_mul_f32 v199, v40, v136
    v_fmac_f32 v199, v41, v137
    v_fmac_f32 v199, v42, v138
    s_waitcnt vmcnt(6) lgkmcnt(0)
    v_mfma_f32_32x32x16_bf16 v[0:15], v[72:75], v[176:179], v[0:15]
    v_fmac_f32 v199, v43, v139
    v_fmac_f32 v199, v44, v140
    v_fmac_f32 v199, v45, v141
    v_fmac_f32 v199, v46, v142
    v_fmac_f32 v199, v47, v143
    s_add_u32 m0, s21, 2048
    v_mfma_f32_32x32x16_bf16 v[16:31], v[76:79], v[176:179], v[16:31]
    buffer_load_dwordx4 v236, s[4:7], s36 offen  lds
    buffer_load_dwordx4 v237, s[8:11], s36 offen offset:1024  lds
    ds_read_b64_tr_b16 v[176:177], v244 offset:4096
    ds_read_b64_tr_b16 v[178:179], v244 offset:5120
    ds_read_b64_tr_b16 v[188:189], v245 offset:4096
    ds_read_b64_tr_b16 v[190:191], v245 offset:5120
    v_mul_f32 v201, v48, v136
    v_fmac_f32 v201, v49, v137
    v_permlane32_swap_b32 v197, v199
    v_fmac_f32 v201, v50, v138
    v_fmac_f32 v201, v51, v139
    s_waitcnt vmcnt(6) lgkmcnt(0)
    v_mfma_f32_32x32x16_bf16 v[0:15], v[80:83], v[176:179], v[0:15]
    v_fmac_f32 v201, v52, v140
    v_fmac_f32 v201, v53, v141
    v_fmac_f32 v201, v54, v142
    v_fmac_f32 v201, v55, v143
    v_add_f32 v199, v197, v199
    v_mul_f32_e64 v203, v56, -v136
    s_add_u32 m0, s21, 4096
    v_mfma_f32_32x32x16_bf16 v[16:31], v[84:87], v[176:179], v[16:31]
    buffer_load_dwordx4 v238, s[4:7], s36 offen  lds
    buffer_load_dwordx4 v239, s[8:11], s36 offen offset:1024  lds
    ds_read_b64_tr_b16 v[176:177], v244 offset:6144
    ds_read_b64_tr_b16 v[178:179], v244 offset:7168
    ds_read_b64_tr_b16 v[192:193], v245 offset:6144
    ds_read_b64_tr_b16 v[194:195], v245 offset:7168
    v_fma_f32 v203, v57, -v137, v203
    v_fma_f32 v203, v58, -v138, v203
    v_fma_f32 v203, v59, -v139, v203
    v_fma_f32 v203, v60, -v140, v203
    v_fma_f32 v203, v61, -v141, v203
    s_waitcnt lgkmcnt(0)
    v_mfma_f32_32x32x16_bf16 v[0:15], v[88:91], v[176:179], v[0:15]
    v_fma_f32 v203, v62, -v142, v203
    v_fma_f32 v203, v63, -v143, v203
    s_nop 1
    v_permlane32_swap_b32 v201, v203
    v_add_f32 v203, v201, v203
    s_add_u32 m0, s21, 6144
    v_mfma_f32_32x32x16_bf16 v[16:31], v[92:95], v[176:179], v[16:31]
    buffer_load_dwordx4 v240, s[4:7], s36 offen  lds
    buffer_load_dwordx4 v241, s[8:11], s36 offen offset:1024  lds
    s_set_gpr_idx_on s51, gpr_idx(DST)
    s_nop 0
    v_cvt_pk_bf16_f32 v204, v198, v199
    v_cvt_pk_bf16_f32 v205, v202, v203
    s_set_gpr_idx_off
    v_mfma_f32_32x32x16_bf16 v[32:47], v[64:67], v[180:183], 0
    v_mul_f32 v196, v0, v144
    v_fmac_f32 v196, v1, v145
    v_fmac_f32 v196, v2, v146
    v_fmac_f32 v196, v3, v147
    v_mfma_f32_32x32x16_bf16 v[48:63], v[68:71], v[180:183], 0
    v_fmac_f32 v196, v4, v148
    v_fmac_f32 v196, v5, v149
    v_fmac_f32 v196, v6, v150
    v_fmac_f32 v196, v7, v151
    v_mfma_f32_32x32x16_bf16 v[32:47], v[72:75], v[184:187], v[32:47]
    v_mul_f32 v198, v8, v112
    v_fmac_f32 v198, v9, v113
    v_fmac_f32 v198, v10, v114
    v_fmac_f32 v198, v11, v115
    v_mfma_f32_32x32x16_bf16 v[48:63], v[76:79], v[184:187], v[48:63]
    v_fmac_f32 v198, v12, v116
    v_fmac_f32 v198, v13, v117
    v_fmac_f32 v198, v14, v118
    v_fmac_f32 v198, v15, v119
    v_mfma_f32_32x32x16_bf16 v[32:47], v[80:83], v[188:191], v[32:47]
    v_mul_f32_e64 v200, v16, -v160
    v_fma_f32 v200, v17, -v161, v200
    v_fma_f32 v200, v18, -v162, v200
    v_fma_f32 v200, v19, -v163, v200
    v_mfma_f32_32x32x16_bf16 v[48:63], v[84:87], v[188:191], v[48:63]
    s_waitcnt vmcnt(8)
    ds_read_b64_tr_b16 v[176:177], v244 offset:0
    ds_read_b64_tr_b16 v[178:179], v244 offset:1024
    ds_read_b64_tr_b16 v[180:181], v245 offset:0
    ds_read_b64_tr_b16 v[182:183], v245 offset:1024
    v_fma_f32 v200, v20, -v164, v200
    v_fma_f32 v200, v21, -v165, v200
    v_fma_f32 v200, v22, -v166, v200
    v_fma_f32 v200, v23, -v167, v200
    v_mfma_f32_32x32x16_bf16 v[32:47], v[88:91], v[192:195], v[32:47]
    v_mul_f32_e64 v202, v24, -v160
    v_fma_f32 v202, v25, -v161, v202
    v_fma_f32 v202, v26, -v162, v202
    v_fma_f32 v202, v27, -v163, v202
    v_mfma_f32_32x32x16_bf16 v[48:63], v[92:95], v[192:195], v[48:63]
    v_fma_f32 v202, v28, -v164, v202
    v_fma_f32 v202, v29, -v165, v202
    v_fma_f32 v202, v30, -v166, v202
    v_fma_f32 v202, v31, -v167, v202
    s_waitcnt vmcnt(4) lgkmcnt(0)
    v_mfma_f32_32x32x16_bf16 v[0:15], v[64:67], v[176:179], 0
    s_nop 0
    v_mul_f32 v197, v32, v152
    v_fmac_f32 v197, v33, v153
    v_fmac_f32 v197, v34, v154
    v_fmac_f32 v197, v35, v155
    s_add_u32 m0, s21, 0
    v_mfma_f32_32x32x16_bf16 v[16:31], v[68:71], v[176:179], 0
    buffer_load_dwordx4 v234, s[4:7], s37 offen  lds
    buffer_load_dwordx4 v235, s[8:11], s37 offen offset:1024  lds
    ds_read_b64_tr_b16 v[176:177], v244 offset:2048
    ds_read_b64_tr_b16 v[178:179], v244 offset:3072
    ds_read_b64_tr_b16 v[184:185], v245 offset:2048
    ds_read_b64_tr_b16 v[186:187], v245 offset:3072
    v_add_u32 v252, s42, v247
    ds_read_u16 v234, v252
    ds_read_u16 v235, v252 offset:64
    v_fmac_f32 v197, v36, v156
    v_fmac_f32 v197, v37, v157
    v_fmac_f32 v197, v38, v158
    v_fmac_f32 v197, v39, v159
    s_waitcnt vmcnt(4) lgkmcnt(2)
    v_mfma_f32_32x32x16_bf16 v[0:15], v[72:75], v[176:179], v[0:15]
    v_mul_f32 v199, v40, v120
    v_fmac_f32 v199, v41, v121
    v_fmac_f32 v199, v42, v122
    v_fmac_f32 v199, v43, v123
    s_add_u32 m0, s21, 2048
    v_mfma_f32_32x32x16_bf16 v[16:31], v[76:79], v[176:179], v[16:31]
    buffer_load_dwordx4 v236, s[4:7], s37 offen  lds
    buffer_load_dwordx4 v237, s[8:11], s37 offen offset:1024  lds
    ds_read_b64_tr_b16 v[176:177], v244 offset:4096
    ds_read_b64_tr_b16 v[178:179], v244 offset:5120
    ds_read_b64_tr_b16 v[188:189], v245 offset:4096
    ds_read_b64_tr_b16 v[190:191], v245 offset:5120
    v_add_u32 v252, s43, v247
    ds_read_u16 v236, v252
    ds_read_u16 v237, v252 offset:64
    v_fmac_f32 v199, v44, v124
    v_fmac_f32 v199, v45, v125
    v_fmac_f32 v199, v46, v126
    v_fmac_f32 v199, v47, v127
    s_waitcnt vmcnt(4) lgkmcnt(2)
    v_mfma_f32_32x32x16_bf16 v[0:15], v[80:83], v[176:179], v[0:15]
    v_mul_f32_e64 v201, v48, -v168
    v_fma_f32 v201, v49, -v169, v201
    v_fma_f32 v201, v50, -v170, v201
    v_fma_f32 v201, v51, -v171, v201
    s_add_u32 m0, s21, 4096
    v_mfma_f32_32x32x16_bf16 v[16:31], v[84:87], v[176:179], v[16:31]
    buffer_load_dwordx4 v238, s[4:7], s37 offen  lds
    buffer_load_dwordx4 v239, s[8:11], s37 offen offset:1024  lds
    ds_read_b64_tr_b16 v[176:177], v244 offset:6144
    ds_read_b64_tr_b16 v[178:179], v244 offset:7168
    ds_read_b64_tr_b16 v[192:193], v245 offset:6144
    ds_read_b64_tr_b16 v[194:195], v245 offset:7168
    v_add_u32 v252, s44, v247
    ds_read_u16 v238, v252
    ds_read_u16 v239, v252 offset:64
    v_fma_f32 v201, v52, -v172, v201
    v_fma_f32 v201, v53, -v173, v201
    v_fma_f32 v201, v54, -v174, v201
    v_fma_f32 v201, v55, -v175, v201
    s_waitcnt lgkmcnt(2)
    v_mfma_f32_32x32x16_bf16 v[0:15], v[88:91], v[176:179], v[0:15]
    v_mul_f32_e64 v203, v56, -v168
    v_fma_f32 v203, v57, -v169, v203
    v_fma_f32 v203, v58, -v170, v203
    v_fma_f32 v203, v59, -v171, v203
    s_add_u32 m0, s21, 6144
    v_mfma_f32_32x32x16_bf16 v[16:31], v[92:95], v[176:179], v[16:31]
    buffer_load_dwordx4 v240, s[4:7], s37 offen  lds
    buffer_load_dwordx4 v241, s[8:11], s37 offen offset:1024  lds
    v_add_u32 v252, s45, v247
    ds_read_u16 v240, v252
    ds_read_u16 v241, v252 offset:64
    v_fma_f32 v203, v60, -v172, v203
    v_fma_f32 v203, v61, -v173, v203
    v_fma_f32 v203, v62, -v174, v203
    v_fma_f32 v203, v63, -v175, v203
    v_mfma_f32_32x32x16_bf16 v[32:47], v[64:67], v[180:183], 0
    v_mul_f32 v254, v0, v144
    v_fmac_f32 v254, v1, v145
    v_fmac_f32 v254, v2, v146
    v_mfma_f32_32x32x16_bf16 v[48:63], v[68:71], v[180:183], 0
    ds_swizzle_b32 v68, v68 offset:0x401F
    ds_swizzle_b32 v69, v69 offset:0x401F
    ds_swizzle_b32 v70, v70 offset:0x401F
    ds_swizzle_b32 v71, v71 offset:0x401F
    v_fmac_f32 v254, v3, v147
    v_fmac_f32 v254, v4, v148
    v_mfma_f32_32x32x16_bf16 v[32:47], v[72:75], v[184:187], v[32:47]
    v_fmac_f32 v254, v5, v149
    v_fmac_f32 v254, v6, v150
    v_mfma_f32_32x32x16_bf16 v[48:63], v[76:79], v[184:187], v[48:63]
    ds_swizzle_b32 v76, v76 offset:0x401F
    ds_swizzle_b32 v77, v77 offset:0x401F
    ds_swizzle_b32 v78, v78 offset:0x401F
    ds_swizzle_b32 v79, v79 offset:0x401F
    v_fmac_f32 v254, v7, v151
    v_fmac_f32 v200, v8, v160
    v_mfma_f32_32x32x16_bf16 v[32:47], v[80:83], v[188:191], v[32:47]
    v_fmac_f32 v200, v9, v161
    v_permlane32_swap_b32 v196, v254
    v_fmac_f32 v200, v10, v162
    v_mfma_f32_32x32x16_bf16 v[48:63], v[84:87], v[188:191], v[48:63]
    ds_swizzle_b32 v84, v84 offset:0x401F
    ds_swizzle_b32 v85, v85 offset:0x401F
    ds_swizzle_b32 v86, v86 offset:0x401F
    ds_swizzle_b32 v87, v87 offset:0x401F
    s_waitcnt vmcnt(6)
    ds_read_b64_tr_b16 v[176:177], v244 offset:0
    ds_read_b64_tr_b16 v[178:179], v244 offset:1024
    ds_read_b64_tr_b16 v[180:181], v245 offset:0
    ds_read_b64_tr_b16 v[182:183], v245 offset:1024
    v_fmac_f32 v200, v11, v163
    v_fmac_f32 v200, v12, v164
    v_mfma_f32_32x32x16_bf16 v[32:47], v[88:91], v[192:195], v[32:47]
    v_fmac_f32 v200, v13, v165
    v_fmac_f32 v200, v14, v166
    v_mfma_f32_32x32x16_bf16 v[48:63], v[92:95], v[192:195], v[48:63]
    ds_swizzle_b32 v92, v92 offset:0x401F
    ds_swizzle_b32 v93, v93 offset:0x401F
    ds_swizzle_b32 v94, v94 offset:0x401F
    ds_swizzle_b32 v95, v95 offset:0x401F
    v_fmac_f32 v200, v15, v167
    v_add_f32 v254, v196, v254
    s_waitcnt lgkmcnt(8)
    s_mov_b64 exec, s[56:57]
    v_xor_b32 v68, 0x80008000, v68
    v_xor_b32 v69, 0x80008000, v69
    v_xor_b32 v70, 0x80008000, v70
    v_xor_b32 v71, 0x80008000, v71
    v_xor_b32 v76, 0x80008000, v76
    v_xor_b32 v77, 0x80008000, v77
    v_xor_b32 v78, 0x80008000, v78
    v_xor_b32 v79, 0x80008000, v79
    v_xor_b32 v84, 0x80008000, v84
    v_xor_b32 v85, 0x80008000, v85
    v_xor_b32 v86, 0x80008000, v86
    v_xor_b32 v87, 0x80008000, v87
    s_mov_b64 exec, -1
    s_waitcnt vmcnt(4) lgkmcnt(4)
    v_mfma_f32_32x32x16_bf16 v[0:15], v[64:67], v[176:179], 0
    v_mul_f32 v255, v32, v152
    v_fmac_f32 v255, v33, v153
    v_fmac_f32 v255, v34, v154
    s_add_u32 m0, s21, 0
    v_mfma_f32_32x32x16_bf16 v[16:31], v[68:71], v[176:179], v[16:31]
    v_lshl_add_u32 v234, v234, 10, v246
    v_lshl_add_u32 v235, v235, 10, v246
    buffer_load_dwordx4 v234, s[4:7], s38 offen  lds
    buffer_load_dwordx4 v235, s[8:11], s38 offen offset:1024  lds
    ds_read_b64_tr_b16 v[176:177], v244 offset:2048
    ds_read_b64_tr_b16 v[178:179], v244 offset:3072
    ds_read_b64_tr_b16 v[184:185], v245 offset:2048
    ds_read_b64_tr_b16 v[186:187], v245 offset:3072
    v_fmac_f32 v255, v35, v155
    v_fmac_f32 v255, v36, v156
    v_fmac_f32 v255, v37, v157
    s_waitcnt vmcnt(4) lgkmcnt(0)
    v_mfma_f32_32x32x16_bf16 v[0:15], v[72:75], v[176:179], v[0:15]
    v_fmac_f32 v255, v38, v158
    v_fmac_f32 v255, v39, v159
    v_fmac_f32 v201, v40, v168
    s_add_u32 m0, s21, 2048
    v_mfma_f32_32x32x16_bf16 v[16:31], v[76:79], v[176:179], v[16:31]
    v_lshl_add_u32 v236, v236, 10, v246
    v_lshl_add_u32 v237, v237, 10, v246
    buffer_load_dwordx4 v236, s[4:7], s39 offen  lds
    buffer_load_dwordx4 v237, s[8:11], s39 offen offset:1024  lds
    ds_read_b64_tr_b16 v[176:177], v244 offset:4096
    ds_read_b64_tr_b16 v[178:179], v244 offset:5120
    ds_read_b64_tr_b16 v[188:189], v245 offset:4096
    ds_read_b64_tr_b16 v[190:191], v245 offset:5120
    v_fmac_f32 v201, v41, v169
    v_permlane32_swap_b32 v197, v255
    s_waitcnt vmcnt(4) lgkmcnt(0)
    v_mfma_f32_32x32x16_bf16 v[0:15], v[80:83], v[176:179], v[0:15]
    v_fmac_f32 v201, v42, v170
    v_fmac_f32 v201, v43, v171
    v_fmac_f32 v201, v44, v172
    s_add_u32 m0, s21, 4096
    v_mfma_f32_32x32x16_bf16 v[16:31], v[84:87], v[176:179], v[16:31]
    v_lshl_add_u32 v238, v238, 10, v246
    v_lshl_add_u32 v239, v239, 10, v246
    buffer_load_dwordx4 v238, s[4:7], s40 offen  lds
    buffer_load_dwordx4 v239, s[8:11], s40 offen offset:1024  lds
    ds_read_b64_tr_b16 v[176:177], v244 offset:6144
    ds_read_b64_tr_b16 v[178:179], v244 offset:7168
    ds_read_b64_tr_b16 v[192:193], v245 offset:6144
    ds_read_b64_tr_b16 v[194:195], v245 offset:7168
    v_fmac_f32 v201, v45, v173
    v_fmac_f32 v201, v46, v174
    v_fmac_f32 v201, v47, v175
    s_waitcnt lgkmcnt(0)
    s_mov_b64 exec, s[56:57]
    v_xor_b32 v92, 0x80008000, v92
    v_xor_b32 v93, 0x80008000, v93
    v_xor_b32 v94, 0x80008000, v94
    v_xor_b32 v95, 0x80008000, v95
    s_mov_b64 exec, -1
    v_mfma_f32_32x32x16_bf16 v[0:15], v[88:91], v[176:179], v[0:15]
    v_add_f32 v255, v197, v255
    s_set_gpr_idx_on s51, gpr_idx(DST)
    s_nop 0
    v_cvt_pk_bf16_f32 v206, v254, v255
    s_set_gpr_idx_off
    s_add_u32 m0, s21, 6144
    v_mfma_f32_32x32x16_bf16 v[16:31], v[92:95], v[176:179], v[16:31]
    v_lshl_add_u32 v240, v240, 10, v246
    v_lshl_add_u32 v241, v241, 10, v246
    buffer_load_dwordx4 v240, s[4:7], s41 offen  lds
    buffer_load_dwordx4 v241, s[8:11], s41 offen offset:1024  lds
    v_mfma_f32_32x32x16_bf16 v[32:47], v[64:67], v[180:183], 0
    v_mul_f32 v254, v0, v144
    v_fmac_f32 v254, v1, v145
    v_fmac_f32 v254, v2, v146
    v_fmac_f32 v254, v3, v147
    v_fmac_f32 v254, v4, v148
    v_mfma_f32_32x32x16_bf16 v[48:63], v[68:71], v[180:183], v[48:63]
    v_fmac_f32 v254, v5, v149
    v_fmac_f32 v254, v6, v150
    v_fmac_f32 v254, v7, v151
    v_fma_f32 v202, v8, -v160, v202
    v_fma_f32 v202, v9, -v161, v202
    v_mfma_f32_32x32x16_bf16 v[32:47], v[72:75], v[184:187], v[32:47]
    v_permlane32_swap_b32 v254, v200
    v_fma_f32 v202, v10, -v162, v202
    v_fma_f32 v202, v11, -v163, v202
    v_fma_f32 v202, v12, -v164, v202
    v_fma_f32 v202, v13, -v165, v202
    v_mfma_f32_32x32x16_bf16 v[48:63], v[76:79], v[184:187], v[48:63]
    v_fma_f32 v202, v14, -v166, v202
    v_fma_f32 v202, v15, -v167, v202
    v_add_f32 v200, v254, v200
    v_fmac_f32 v198, v16, v112
    v_permlane32_swap_b32 v202, v254
    v_mfma_f32_32x32x16_bf16 v[32:47], v[80:83], v[188:191], v[32:47]
    v_fmac_f32 v198, v17, v113
    v_fmac_f32 v198, v18, v114
    v_fmac_f32 v198, v19, v115
    v_fmac_f32 v198, v20, v116
    v_fmac_f32 v198, v21, v117
    v_mfma_f32_32x32x16_bf16 v[48:63], v[84:87], v[188:191], v[48:63]
    s_waitcnt vmcnt(6)
    ds_read_b64_tr_b16 v[176:177], v244 offset:0
    ds_read_b64_tr_b16 v[178:179], v244 offset:1024
    ds_read_b64_tr_b16 v[180:181], v245 offset:0
    ds_read_b64_tr_b16 v[182:183], v245 offset:1024
    v_fmac_f32 v198, v22, v118
    v_fmac_f32 v198, v23, v119
    v_add_f32 v254, v202, v254
    v_mul_f32 v196, v24, v160
    v_fmac_f32 v196, v25, v161
    v_mfma_f32_32x32x16_bf16 v[32:47], v[88:91], v[192:195], v[32:47]
    v_fmac_f32 v196, v26, v162
    v_fmac_f32 v196, v27, v163
    v_fmac_f32 v196, v28, v164
    v_fmac_f32 v196, v29, v165
    v_fmac_f32 v196, v30, v166
    v_mfma_f32_32x32x16_bf16 v[48:63], v[92:95], v[192:195], v[48:63]
    v_add_u32 v249, s48, v249
    v_add_u32 v250, s49, v250
    ds_read_b64_tr_b16 v[64:65], v249 offset:0
    ds_read_b64_tr_b16 v[68:69], v249 offset:64
    ds_read_b64_tr_b16 v[66:67], v249 offset:256
    ds_read_b64_tr_b16 v[70:71], v249 offset:320
    s_mov_b64 exec, s[54:55]
    ds_read_u16_d16_hi v242, v250 offset:0
    s_mov_b64 exec, -1
    v_fmac_f32 v196, v31, v167
    s_nop 1
    v_permlane32_swap_b32 v198, v196
    v_add_f32 v196, v198, v196
    v_mul_f32 v255, v32, v152
    v_fmac_f32 v255, v33, v153
    v_fmac_f32 v255, v34, v154
    v_fmac_f32 v255, v35, v155
    v_fmac_f32 v255, v36, v156
    v_fmac_f32 v255, v37, v157
    v_fmac_f32 v255, v38, v158
    v_fmac_f32 v255, v39, v159
    v_fma_f32 v203, v40, -v168, v203
    v_fma_f32 v203, v41, -v169, v203
    v_permlane32_swap_b32 v255, v201
    v_fma_f32 v203, v42, -v170, v203
    v_fma_f32 v203, v43, -v171, v203
    v_fma_f32 v203, v44, -v172, v203
    v_fma_f32 v203, v45, -v173, v203
    v_fma_f32 v203, v46, -v174, v203
    v_fma_f32 v203, v47, -v175, v203
    v_add_f32 v201, v255, v201
    v_fmac_f32 v199, v48, v120
    v_permlane32_swap_b32 v203, v255
    v_fmac_f32 v199, v49, v121
    v_fmac_f32 v199, v50, v122
    v_fmac_f32 v199, v51, v123
    v_fmac_f32 v199, v52, v124
    v_fmac_f32 v199, v53, v125
    v_fmac_f32 v199, v54, v126
    v_fmac_f32 v199, v55, v127
    v_add_f32 v255, v203, v255
    v_mul_f32 v197, v56, v168
    v_fmac_f32 v197, v57, v169
    v_fmac_f32 v197, v58, v170
    v_fmac_f32 v197, v59, v171
    v_fmac_f32 v197, v60, v172
    v_fmac_f32 v197, v61, v173
    v_fmac_f32 v197, v62, v174
    v_fmac_f32 v197, v63, v175
    s_nop 1
    v_permlane32_swap_b32 v199, v197
    v_add_f32 v197, v199, v197
    s_set_gpr_idx_on s51, gpr_idx(DST)
    s_nop 0
    v_cvt_pk_bf16_f32 v207, v200, v201
    v_cvt_pk_bf16_f32 v209, v254, v255
    v_cvt_pk_bf16_f32 v208, v196, v197
    s_set_gpr_idx_off
    s_add_u32 s50, s50, 1
    s_add_u32 s51, s51, 6
    s_cmp_ge_u32 s50, 4
    s_cbranch_scc1 LAST0
    s_add_u32 s53, s53, 4
    s_xor_b32 s66, s53, s20
    s_bitcmp1_b32 s66, 2
    s_setprio 1
    s_cbranch_scc1 PRIO_9
    s_setprio 0
PRIO_9:
    s_cmp_eq_u32 s52, 4
    s_cbranch_scc1 ITEM_0_4
    s_cmp_eq_u32 s52, 5
    s_cbranch_scc1 ITEM_0_5
    s_cmp_eq_u32 s52, 3
    s_cbranch_scc1 ITEM_0_3
    s_cmp_eq_u32 s52, 6
    s_cbranch_scc1 ITEM_0_6
    s_cmp_eq_u32 s52, 8
    s_cbranch_scc1 ITEM_0_8
    s_branch ITEM_0_2
.p2align 6
ITEM_0_2:
    s_mov_b32 m0, s50
    s_nop 0
    s_movrels_b32 s71, s23
    s_bfe_u32 s46, s71, 0x30012
    s_mov_b32 m0, s46
    s_and_b32 s66, s71, 0x3ffff
    s_movrels_b32 s68, s57
    s_movrels_b32 s69, s61
    s_sub_u32 s48, s66, s47
    s_mov_b32 s47, s66
    s_lshr_b32 s52, s71, 28
    s_lshl_b32 s67, s46, 9
    s_add_u32 s66, s66, s67
    s_sub_u32 s49, s66, s42
    s_mov_b32 s42, s66
    s_bfe_u32 s66, s68, 655360
    s_add_u32 s43, s42, s66
    s_bfe_u32 s39, s69, 655360
    s_bfe_u32 s66, s68, 655370
    s_add_u32 s44, s42, s66
    s_bfe_u32 s40, s69, 655370
    s_bfe_u32 s66, s68, 655380
    s_add_u32 s45, s42, s66
    s_bfe_u32 s41, s69, 655380
    s_and_b32 s66, s46, s33
    s_cselect_b32 s72, -1, 1
    s_cselect_b32 s76, s47, 163712
    s_cmp_ge_u32 s66, 2
    s_cselect_b32 s73, -1, 0
    s_add_u32 s77, s47, 1024
    s_cmp_ge_u32 s66, 4
    s_cselect_b32 s75, -1, 0
    s_cmp_ge_u32 s66, 3
    s_cselect_b32 s74, -1, 1
    s_cselect_b32 s77, s77, 163712
    v_add_u32 v252, s42, v247
    ds_read_u16 v234, v252
    ds_read_u16 v235, v252 offset:64
    v_add_u32 v252, s43, v247
    ds_read_u16 v236, v252
    ds_read_u16 v237, v252 offset:64
    v_add_u32 v252, s44, v247
    ds_read_u16 v238, v252
    ds_read_u16 v239, v252 offset:64
    v_add_u32 v252, s45, v247
    ds_read_u16 v240, v252
    ds_read_u16 v241, v252 offset:64
    s_waitcnt lgkmcnt(8)
    v_mul_f32_dpp v196, v242, v64 row_newbcast:0 row_mask:0xf bank_mask:0xf
    v_mul_f32_dpp v197, v242, v65 row_newbcast:1 row_mask:0xf bank_mask:0xf
    v_mul_f32_dpp v198, v242, v64 row_newbcast:8 row_mask:0xf bank_mask:0xf
    v_mul_f32_dpp v199, v242, v65 row_newbcast:9 row_mask:0xf bank_mask:0xf
    v_mul_f32_dpp v200, v242, v68 row_newbcast:2 row_mask:0xf bank_mask:0xf
    v_mul_f32_dpp v201, v242, v69 row_newbcast:3 row_mask:0xf bank_mask:0xf
    v_mul_f32_dpp v202, v242, v68 row_newbcast:10 row_mask:0xf bank_mask:0xf
    v_mul_f32_dpp v203, v242, v69 row_newbcast:11 row_mask:0xf bank_mask:0xf
    v_cvt_pk_bf16_f32 v64, v196, v197
    v_cvt_pk_bf16_f32 v68, v198, v199
    v_cvt_pk_bf16_f32 v65, v200, v201
    v_cvt_pk_bf16_f32 v69, v202, v203
    v_mul_f32_dpp v196, v242, v66 row_newbcast:4 row_mask:0xf bank_mask:0xf
    v_mul_f32_dpp v197, v242, v67 row_newbcast:5 row_mask:0xf bank_mask:0xf
    v_mul_f32_dpp v198, v242, v66 row_newbcast:12 row_mask:0xf bank_mask:0xf
    v_mul_f32_dpp v199, v242, v67 row_newbcast:13 row_mask:0xf bank_mask:0xf
    v_mul_f32_dpp v200, v242, v70 row_newbcast:6 row_mask:0xf bank_mask:0xf
    v_mul_f32_dpp v201, v242, v71 row_newbcast:7 row_mask:0xf bank_mask:0xf
    v_mul_f32_dpp v202, v242, v70 row_newbcast:14 row_mask:0xf bank_mask:0xf
    v_mul_f32_dpp v203, v242, v71 row_newbcast:15 row_mask:0xf bank_mask:0xf
    v_cvt_pk_bf16_f32 v66, v196, v197
    v_cvt_pk_bf16_f32 v70, v198, v199
    v_cvt_pk_bf16_f32 v67, v200, v201
    v_cvt_pk_bf16_f32 v71, v202, v203
    s_nop 0
    s_waitcnt lgkmcnt(6)
    v_mfma_f32_32x32x16_bf16 v[0:15], v[64:67], v[176:179], 0
    s_add_u32 m0, s21, 0
    v_mfma_f32_32x32x16_bf16 v[16:31], v[68:71], v[176:179], 0
    v_lshl_add_u32 v234, v234, 10, v246
    v_lshl_add_u32 v235, v235, 10, v246
    buffer_load_dwordx4 v234, s[4:7], s38 offen  lds
    buffer_load_dwordx4 v235, s[8:11], s38 offen offset:1024  lds
    v_mfma_f32_32x32x16_bf16 v[32:47], v[64:67], v[180:183], 0
    s_nop 4
    v_mul_f32 v196, v0, v96
    v_fmac_f32 v196, v1, v97
    v_fmac_f32 v196, v2, v98
    v_fmac_f32 v196, v3, v99
    v_fmac_f32 v196, v4, v100
    v_fmac_f32 v196, v5, v101
    v_fmac_f32 v196, v6, v102
    v_fmac_f32 v196, v7, v103
    v_mul_f32 v198, v8, v128
    v_fmac_f32 v198, v9, v129
    v_fmac_f32 v198, v10, v130
    v_fmac_f32 v198, v11, v131
    v_fmac_f32 v198, v12, v132
    v_fmac_f32 v198, v13, v133
    v_fmac_f32 v198, v14, v134
    v_fmac_f32 v198, v15, v135
    v_mul_f32 v200, v16, v128
    v_fmac_f32 v200, v17, v129
    v_permlane32_swap_b32 v196, v198
    v_mfma_f32_32x32x16_bf16 v[48:63], v[68:71], v[180:183], 0
    v_add_u32 v253, s47, v248
    ds_read_b32 v254, v253
    ds_read_b32 v255, v253 offset:256
    s_waitcnt vmcnt(6)
    ds_read_b64_tr_b16 v[176:177], v244 offset:2048
    ds_read_b64_tr_b16 v[178:179], v244 offset:3072
    ds_read_b64_tr_b16 v[180:181], v245 offset:2048
    ds_read_b64_tr_b16 v[182:183], v245 offset:3072
    v_fmac_f32 v200, v18, v130
    v_fmac_f32 v200, v19, v131
    v_fmac_f32 v200, v20, v132
    v_fmac_f32 v200, v21, v133
    v_fmac_f32 v200, v22, v134
    v_fmac_f32 v200, v23, v135
    v_add_f32 v198, v196, v198
    v_mul_f32_e64 v202, v24, -v128
    v_fma_f32 v202, v25, -v129, v202
    v_fma_f32 v202, v26, -v130, v202
    v_fma_f32 v202, v27, -v131, v202
    v_fma_f32 v202, v28, -v132, v202
    v_fma_f32 v202, v29, -v133, v202
    v_fma_f32 v202, v30, -v134, v202
    v_fma_f32 v202, v31, -v135, v202
    s_nop 1
    v_permlane32_swap_b32 v200, v202
    v_add_f32 v202, v200, v202
    s_waitcnt lgkmcnt(0)
    v_mfma_f32_32x32x16_bf16 v[0:15], v[64:67], v[176:179], 0
    v_mul_f32 v197, v32, v104
    v_fmac_f32 v197, v33, v105
    v_fmac_f32 v197, v34, v106
    v_fmac_f32 v197, v35, v107
    v_fmac_f32 v197, v36, v108
    v_fmac_f32 v197, v37, v109
    v_fmac_f32 v197, v38, v110
    v_fmac_f32 v197, v39, v111
    v_mul_f32 v199, v40, v136
    v_fmac_f32 v199, v41, v137
    v_fmac_f32 v199, v42, v138
    v_fmac_f32 v199, v43, v139
    v_fmac_f32 v199, v44, v140
    v_fmac_f32 v199, v45, v141
    v_fmac_f32 v199, v46, v142
    v_fmac_f32 v199, v47, v143
    v_mul_f32 v201, v48, v136
    v_fmac_f32 v201, v49, v137
    v_permlane32_swap_b32 v197, v199
    v_fmac_f32 v201, v50, v138
    v_fmac_f32 v201, v51, v139
    s_add_u32 m0, s21, 2048
    v_mfma_f32_32x32x16_bf16 v[16:31], v[68:71], v[176:179], 0
    v_lshl_add_u32 v236, v236, 10, v246
    v_lshl_add_u32 v237, v237, 10, v246
    buffer_load_dwordx4 v236, s[4:7], s39 offen  lds
    buffer_load_dwordx4 v237, s[8:11], s39 offen offset:1024  lds
    s_mov_b32 m0, s76
    s_mov_b64 exec, s[72:73]
    buffer_load_dwordx4 v254, s[12:15], 0 offen  lds
    s_mov_b32 m0, s77
    s_mov_b64 exec, s[74:75]
    buffer_load_dwordx4 v255, s[12:15], 0 offen  lds
    s_mov_b64 exec, -1
    v_fmac_f32 v201, v52, v140
    v_fmac_f32 v201, v53, v141
    v_fmac_f32 v201, v54, v142
    v_fmac_f32 v201, v55, v143
    v_add_f32 v199, v197, v199
    v_mul_f32_e64 v203, v56, -v136
    v_fma_f32 v203, v57, -v137, v203
    v_fma_f32 v203, v58, -v138, v203
    v_fma_f32 v203, v59, -v139, v203
    v_fma_f32 v203, v60, -v140, v203
    v_fma_f32 v203, v61, -v141, v203
    v_fma_f32 v203, v62, -v142, v203
    v_fma_f32 v203, v63, -v143, v203
    s_nop 1
    v_permlane32_swap_b32 v201, v203
    v_add_f32 v203, v201, v203
    s_set_gpr_idx_on s51, gpr_idx(DST)
    s_nop 0
    v_cvt_pk_bf16_f32 v204, v198, v199
    v_cvt_pk_bf16_f32 v205, v202, v203
    s_set_gpr_idx_off
    v_mfma_f32_32x32x16_bf16 v[32:47], v[64:67], v[180:183], 0
    v_mul_f32 v196, v0, v144
    v_fmac_f32 v196, v1, v145
    v_fmac_f32 v196, v2, v146
    v_fmac_f32 v196, v3, v147
    v_fmac_f32 v196, v4, v148
    v_fmac_f32 v196, v5, v149
    v_fmac_f32 v196, v6, v150
    v_fmac_f32 v196, v7, v151
    v_mul_f32 v198, v8, v112
    v_fmac_f32 v198, v9, v113
    v_fmac_f32 v198, v10, v114
    v_fmac_f32 v198, v11, v115
    v_fmac_f32 v198, v12, v116
    v_fmac_f32 v198, v13, v117
    v_fmac_f32 v198, v14, v118
    v_fmac_f32 v198, v15, v119
    v_mfma_f32_32x32x16_bf16 v[48:63], v[68:71], v[180:183], 0
    s_waitcnt vmcnt(8)
    ds_read_b64_tr_b16 v[176:177], v244 offset:4096
    ds_read_b64_tr_b16 v[178:179], v244 offset:5120
    ds_read_b64_tr_b16 v[180:181], v245 offset:4096
    ds_read_b64_tr_b16 v[182:183], v245 offset:5120
    v_mul_f32_e64 v200, v16, -v160
    v_fma_f32 v200, v17, -v161, v200
    v_fma_f32 v200, v18, -v162, v200
    v_fma_f32 v200, v19, -v163, v200
    v_fma_f32 v200, v20, -v164, v200
    v_fma_f32 v200, v21, -v165, v200
    v_fma_f32 v200, v22, -v166, v200
    v_fma_f32 v200, v23, -v167, v200
    v_mul_f32_e64 v202, v24, -v160
    v_fma_f32 v202, v25, -v161, v202
    v_fma_f32 v202, v26, -v162, v202
    v_fma_f32 v202, v27, -v163, v202
    v_fma_f32 v202, v28, -v164, v202
    v_fma_f32 v202, v29, -v165, v202
    v_fma_f32 v202, v30, -v166, v202
    v_fma_f32 v202, v31, -v167, v202
    s_waitcnt lgkmcnt(0)
    v_mfma_f32_32x32x16_bf16 v[0:15], v[64:67], v[176:179], 0
    v_mul_f32 v197, v32, v152
    v_fmac_f32 v197, v33, v153
    v_fmac_f32 v197, v34, v154
    v_fmac_f32 v197, v35, v155
    v_fmac_f32 v197, v36, v156
    v_fmac_f32 v197, v37, v157
    v_fmac_f32 v197, v38, v158
    v_fmac_f32 v197, v39, v159
    v_mul_f32 v199, v40, v120
    v_fmac_f32 v199, v41, v121
    v_fmac_f32 v199, v42, v122
    v_fmac_f32 v199, v43, v123
    v_fmac_f32 v199, v44, v124
    v_fmac_f32 v199, v45, v125
    v_fmac_f32 v199, v46, v126
    v_fmac_f32 v199, v47, v127
    s_add_u32 m0, s21, 4096
    v_mfma_f32_32x32x16_bf16 v[16:31], v[68:71], v[176:179], 0
    v_lshl_add_u32 v238, v238, 10, v246
    v_lshl_add_u32 v239, v239, 10, v246
    buffer_load_dwordx4 v238, s[4:7], s40 offen  lds
    buffer_load_dwordx4 v239, s[8:11], s40 offen offset:1024  lds
    v_mul_f32_e64 v201, v48, -v168
    v_fma_f32 v201, v49, -v169, v201
    v_fma_f32 v201, v50, -v170, v201
    v_fma_f32 v201, v51, -v171, v201
    v_fma_f32 v201, v52, -v172, v201
    v_fma_f32 v201, v53, -v173, v201
    v_fma_f32 v201, v54, -v174, v201
    v_fma_f32 v201, v55, -v175, v201
    v_mul_f32_e64 v203, v56, -v168
    v_fma_f32 v203, v57, -v169, v203
    v_fma_f32 v203, v58, -v170, v203
    v_fma_f32 v203, v59, -v171, v203
    v_fma_f32 v203, v60, -v172, v203
    v_fma_f32 v203, v61, -v173, v203
    v_fma_f32 v203, v62, -v174, v203
    v_fma_f32 v203, v63, -v175, v203
    v_mfma_f32_32x32x16_bf16 v[32:47], v[64:67], v[180:183], 0
    v_mul_f32 v254, v0, v144
    v_fmac_f32 v254, v1, v145
    v_fmac_f32 v254, v2, v146
    v_fmac_f32 v254, v3, v147
    v_fmac_f32 v254, v4, v148
    v_fmac_f32 v254, v5, v149
    v_fmac_f32 v254, v6, v150
    v_fmac_f32 v254, v7, v151
    v_fmac_f32 v200, v8, v160
    v_mfma_f32_32x32x16_bf16 v[48:63], v[68:71], v[180:183], 0
    ds_swizzle_b32 v68, v68 offset:0x401F
    ds_swizzle_b32 v69, v69 offset:0x401F
    ds_swizzle_b32 v70, v70 offset:0x401F
    ds_swizzle_b32 v71, v71 offset:0x401F
    s_waitcnt vmcnt(8)
    ds_read_b64_tr_b16 v[176:177], v244 offset:6144
    ds_read_b64_tr_b16 v[178:179], v244 offset:7168
    ds_read_b64_tr_b16 v[180:181], v245 offset:6144
    ds_read_b64_tr_b16 v[182:183], v245 offset:7168
    v_fmac_f32 v200, v9, v161
    v_permlane32_swap_b32 v196, v254
    v_fmac_f32 v200, v10, v162
    v_fmac_f32 v200, v11, v163
    v_fmac_f32 v200, v12, v164
    v_fmac_f32 v200, v13, v165
    v_fmac_f32 v200, v14, v166
    v_fmac_f32 v200, v15, v167
    v_add_f32 v254, v196, v254
    s_waitcnt lgkmcnt(0)
    s_mov_b64 exec, s[56:57]
    v_xor_b32 v68, 0x80008000, v68
    v_xor_b32 v69, 0x80008000, v69
    v_xor_b32 v70, 0x80008000, v70
    v_xor_b32 v71, 0x80008000, v71
    s_mov_b64 exec, -1
    s_nop 0
    v_mfma_f32_32x32x16_bf16 v[0:15], v[64:67], v[176:179], 0
    v_mul_f32 v255, v32, v152
    v_fmac_f32 v255, v33, v153
    v_fmac_f32 v255, v34, v154
    v_fmac_f32 v255, v35, v155
    v_fmac_f32 v255, v36, v156
    v_fmac_f32 v255, v37, v157
    v_fmac_f32 v255, v38, v158
    v_fmac_f32 v255, v39, v159
    v_fmac_f32 v201, v40, v168
    v_fmac_f32 v201, v41, v169
    v_permlane32_swap_b32 v197, v255
    s_add_u32 m0, s21, 6144
    v_mfma_f32_32x32x16_bf16 v[16:31], v[68:71], v[176:179], v[16:31]
    v_lshl_add_u32 v240, v240, 10, v246
    v_lshl_add_u32 v241, v241, 10, v246
    buffer_load_dwordx4 v240, s[4:7], s41 offen  lds
    buffer_load_dwordx4 v241, s[8:11], s41 offen offset:1024  lds
    v_fmac_f32 v201, v42, v170
    v_fmac_f32 v201, v43, v171
    v_fmac_f32 v201, v44, v172
    v_fmac_f32 v201, v45, v173
    v_fmac_f32 v201, v46, v174
    v_fmac_f32 v201, v47, v175
    v_add_f32 v255, v197, v255
    s_set_gpr_idx_on s51, gpr_idx(DST)
    s_nop 0
    v_cvt_pk_bf16_f32 v206, v254, v255
    s_set_gpr_idx_off
    v_mfma_f32_32x32x16_bf16 v[32:47], v[64:67], v[180:183], 0
    v_mul_f32 v254, v0, v144
    v_fmac_f32 v254, v1, v145
    v_fmac_f32 v254, v2, v146
    v_fmac_f32 v254, v3, v147
    v_fmac_f32 v254, v4, v148
    v_fmac_f32 v254, v5, v149
    v_fmac_f32 v254, v6, v150
    v_fmac_f32 v254, v7, v151
    v_fma_f32 v202, v8, -v160, v202
    v_fma_f32 v202, v9, -v161, v202
    v_permlane32_swap_b32 v254, v200
    v_fma_f32 v202, v10, -v162, v202
    v_fma_f32 v202, v11, -v163, v202
    v_fma_f32 v202, v12, -v164, v202
    v_fma_f32 v202, v13, -v165, v202
    v_fma_f32 v202, v14, -v166, v202
    v_fma_f32 v202, v15, -v167, v202
    v_add_f32 v200, v254, v200
    v_fmac_f32 v198, v16, v112
    v_permlane32_swap_b32 v202, v254
    v_mfma_f32_32x32x16_bf16 v[48:63], v[68:71], v[180:183], v[48:63]
    s_waitcnt vmcnt(4)
    ds_read_b64_tr_b16 v[176:177], v244 offset:0
    ds_read_b64_tr_b16 v[178:179], v244 offset:1024
    ds_read_b64_tr_b16 v[180:181], v245 offset:0
    ds_read_b64_tr_b16 v[182:183], v245 offset:1024
    v_add_u32 v249, s48, v249
    v_add_u32 v250, s49, v250
    ds_read_b64_tr_b16 v[64:65], v249 offset:0
    ds_read_b64_tr_b16 v[68:69], v249 offset:64
    ds_read_b64_tr_b16 v[66:67], v249 offset:256
    ds_read_b64_tr_b16 v[70:71], v249 offset:320
    s_mov_b64 exec, s[54:55]
    ds_read_u16_d16_hi v242, v250 offset:0
    s_mov_b64 exec, -1
    v_fmac_f32 v198, v17, v113
    v_fmac_f32 v198, v18, v114
    v_fmac_f32 v198, v19, v115
    v_fmac_f32 v198, v20, v116
    v_fmac_f32 v198, v21, v117
    v_fmac_f32 v198, v22, v118
    v_fmac_f32 v198, v23, v119
    v_add_f32 v254, v202, v254
    v_mul_f32 v196, v24, v160
    v_fmac_f32 v196, v25, v161
    v_fmac_f32 v196, v26, v162
    v_fmac_f32 v196, v27, v163
    v_fmac_f32 v196, v28, v164
    v_fmac_f32 v196, v29, v165
    v_fmac_f32 v196, v30, v166
    v_fmac_f32 v196, v31, v167
    s_nop 1
    v_permlane32_swap_b32 v198, v196
    v_add_f32 v196, v198, v196
    v_mul_f32 v255, v32, v152
    v_fmac_f32 v255, v33, v153
    v_fmac_f32 v255, v34, v154
    v_fmac_f32 v255, v35, v155
    v_fmac_f32 v255, v36, v156
    v_fmac_f32 v255, v37, v157
    v_fmac_f32 v255, v38, v158
    v_fmac_f32 v255, v39, v159
    v_fma_f32 v203, v40, -v168, v203
    v_fma_f32 v203, v41, -v169, v203
    v_permlane32_swap_b32 v255, v201
    v_fma_f32 v203, v42, -v170, v203
    v_fma_f32 v203, v43, -v171, v203
    v_fma_f32 v203, v44, -v172, v203
    v_fma_f32 v203, v45, -v173, v203
    v_fma_f32 v203, v46, -v174, v203
    v_fma_f32 v203, v47, -v175, v203
    v_add_f32 v201, v255, v201
    v_fmac_f32 v199, v48, v120
    v_permlane32_swap_b32 v203, v255
    v_fmac_f32 v199, v49, v121
    v_fmac_f32 v199, v50, v122
    v_fmac_f32 v199, v51, v123
    v_fmac_f32 v199, v52, v124
    v_fmac_f32 v199, v53, v125
    v_fmac_f32 v199, v54, v126
    v_fmac_f32 v199, v55, v127
    v_add_f32 v255, v203, v255
    v_mul_f32 v197, v56, v168
    v_fmac_f32 v197, v57, v169
    v_fmac_f32 v197, v58, v170
    v_fmac_f32 v197, v59, v171
    v_fmac_f32 v197, v60, v172
    v_fmac_f32 v197, v61, v173
    v_fmac_f32 v197, v62, v174
    v_fmac_f32 v197, v63, v175
    s_nop 1
    v_permlane32_swap_b32 v199, v197
    v_add_f32 v197, v199, v197
    s_set_gpr_idx_on s51, gpr_idx(DST)
    s_nop 0
    v_cvt_pk_bf16_f32 v207, v200, v201
    v_cvt_pk_bf16_f32 v209, v254, v255
    v_cvt_pk_bf16_f32 v208, v196, v197
    s_set_gpr_idx_off
    s_add_u32 s50, s50, 1
    s_add_u32 s51, s51, 6
    s_cmp_ge_u32 s50, 4
    s_cbranch_scc1 LAST0
    s_add_u32 s53, s53, 4
    s_xor_b32 s66, s53, s20
    s_bitcmp1_b32 s66, 2
    s_setprio 1
    s_cbranch_scc1 PRIO_10
    s_setprio 0
PRIO_10:
    s_cmp_eq_u32 s52, 4
    s_cbranch_scc1 ITEM_0_4
    s_cmp_eq_u32 s52, 5
    s_cbranch_scc1 ITEM_0_5
    s_cmp_eq_u32 s52, 3
    s_cbranch_scc1 ITEM_0_3
    s_cmp_eq_u32 s52, 6
    s_cbranch_scc1 ITEM_0_6
    s_cmp_eq_u32 s52, 8
    s_cbranch_scc1 ITEM_0_8
    s_branch ITEM_0_2
.p2align 6
ITEM_1_4:
    s_mov_b64 exec, s[54:55]
    ds_read_u16_d16_hi v243, v250 offset:128
    s_mov_b64 exec, -1
    ds_read_b64_tr_b16 v[72:73], v249 offset:512
    ds_read_b64_tr_b16 v[76:77], v249 offset:576
    ds_read_b64_tr_b16 v[74:75], v249 offset:768
    ds_read_b64_tr_b16 v[78:79], v249 offset:832
    s_waitcnt lgkmcnt(5)
    v_mul_f32_dpp v196, v242, v64 row_newbcast:0 row_mask:0xf bank_mask:0xf
    v_mul_f32_dpp v197, v242, v65 row_newbcast:1 row_mask:0xf bank_mask:0xf
    v_mul_f32_dpp v198, v242, v64 row_newbcast:8 row_mask:0xf bank_mask:0xf
    v_mul_f32_dpp v199, v242, v65 row_newbcast:9 row_mask:0xf bank_mask:0xf
    v_mul_f32_dpp v200, v242, v68 row_newbcast:2 row_mask:0xf bank_mask:0xf
    v_mul_f32_dpp v201, v242, v69 row_newbcast:3 row_mask:0xf bank_mask:0xf
    v_mul_f32_dpp v202, v242, v68 row_newbcast:10 row_mask:0xf bank_mask:0xf
    v_mul_f32_dpp v203, v242, v69 row_newbcast:11 row_mask:0xf bank_mask:0xf
    v_cvt_pk_bf16_f32 v64, v196, v197
    v_cvt_pk_bf16_f32 v68, v198, v199
    v_cvt_pk_bf16_f32 v65, v200, v201
    v_cvt_pk_bf16_f32 v69, v202, v203
    v_mul_f32_dpp v196, v242, v66 row_newbcast:4 row_mask:0xf bank_mask:0xf
    v_mul_f32_dpp v197, v242, v67 row_newbcast:5 row_mask:0xf bank_mask:0xf
    v_mul_f32_dpp v198, v242, v66 row_newbcast:12 row_mask:0xf bank_mask:0xf
    v_mul_f32_dpp v199, v242, v67 row_newbcast:13 row_mask:0xf bank_mask:0xf
    v_mul_f32_dpp v200, v242, v70 row_newbcast:6 row_mask:0xf bank_mask:0xf
    v_mul_f32_dpp v201, v242, v71 row_newbcast:7 row_mask:0xf bank_mask:0xf
    v_mul_f32_dpp v202, v242, v70 row_newbcast:14 row_mask:0xf bank_mask:0xf
    v_mul_f32_dpp v203, v242, v71 row_newbcast:15 row_mask:0xf bank_mask:0xf
    v_cvt_pk_bf16_f32 v66, v196, v197
    v_cvt_pk_bf16_f32 v70, v198, v199
    v_cvt_pk_bf16_f32 v67, v200, v201
    v_cvt_pk_bf16_f32 v71, v202, v203
    s_nop 0
    s_waitcnt vmcnt(4) lgkmcnt(0)
    v_mfma_f32_32x32x16_bf16 v[0:15], v[64:67], v[176:179], 0
    v_mul_f32_dpp v196, v243, v72 row_newbcast:0 row_mask:0xf bank_mask:0xf
    v_mul_f32_dpp v197, v243, v73 row_newbcast:1 row_mask:0xf bank_mask:0xf
    v_mul_f32_dpp v198, v243, v72 row_newbcast:8 row_mask:0xf bank_mask:0xf
    v_mul_f32_dpp v199, v243, v73 row_newbcast:9 row_mask:0xf bank_mask:0xf
    v_mul_f32_dpp v200, v243, v76 row_newbcast:2 row_mask:0xf bank_mask:0xf
    v_mul_f32_dpp v201, v243, v77 row_newbcast:3 row_mask:0xf bank_mask:0xf
    v_mul_f32_dpp v202, v243, v76 row_newbcast:10 row_mask:0xf bank_mask:0xf
    v_mul_f32_dpp v203, v243, v77 row_newbcast:11 row_mask:0xf bank_mask:0xf
    v_cvt_pk_bf16_f32 v72, v196, v197
    v_cvt_pk_bf16_f32 v76, v198, v199
    v_cvt_pk_bf16_f32 v73, v200, v201
    v_cvt_pk_bf16_f32 v77, v202, v203
    s_add_u32 m0, s21, 0
    v_mfma_f32_32x32x16_bf16 v[16:31], v[68:71], v[176:179], 0
    buffer_load_dwordx4 v234, s[4:7], s36 offen  lds
    buffer_load_dwordx4 v235, s[8:11], s36 offen offset:1024  lds
    ds_read_b64_tr_b16 v[176:177], v244 offset:2048
    ds_read_b64_tr_b16 v[178:179], v244 offset:3072
    ds_read_b64_tr_b16 v[184:185], v245 offset:2048
    ds_read_b64_tr_b16 v[186:187], v245 offset:3072
    v_mul_f32_dpp v196, v243, v74 row_newbcast:4 row_mask:0xf bank_mask:0xf
    v_mul_f32_dpp v197, v243, v75 row_newbcast:5 row_mask:0xf bank_mask:0xf
    v_mul_f32_dpp v198, v243, v74 row_newbcast:12 row_mask:0xf bank_mask:0xf
    v_mul_f32_dpp v199, v243, v75 row_newbcast:13 row_mask:0xf bank_mask:0xf
    v_mul_f32_dpp v200, v243, v78 row_newbcast:6 row_mask:0xf bank_mask:0xf
    v_mul_f32_dpp v201, v243, v79 row_newbcast:7 row_mask:0xf bank_mask:0xf
    v_mul_f32_dpp v202, v243, v78 row_newbcast:14 row_mask:0xf bank_mask:0xf
    v_mul_f32_dpp v203, v243, v79 row_newbcast:15 row_mask:0xf bank_mask:0xf
    v_cvt_pk_bf16_f32 v74, v196, v197
    v_cvt_pk_bf16_f32 v78, v198, v199
    v_cvt_pk_bf16_f32 v75, v200, v201
    v_cvt_pk_bf16_f32 v79, v202, v203
    s_nop 0
    s_waitcnt lgkmcnt(0)
    v_mfma_f32_32x32x16_bf16 v[0:15], v[72:75], v[176:179], v[0:15]
    s_add_u32 m0, s21, 2048
    v_mfma_f32_32x32x16_bf16 v[16:31], v[76:79], v[176:179], v[16:31]
    buffer_load_dwordx4 v236, s[4:7], s36 offen  lds
    buffer_load_dwordx4 v237, s[8:11], s36 offen offset:1024  lds
    s_mov_b32 m0, s50
    s_nop 0
    s_movrels_b32 s71, s23
    s_movrels_b32 s33, s28
    s_and_b32 s70, s33, 0x70
    s_andn2_b32 s33, s33, 0x70
    v_xor_b32 v253, s70, v248
    v_add_u32 v253, s33, v253
    s_bfe_u32 s46, s71, 0x30012
    s_mov_b32 m0, s46
    s_and_b32 s66, s71, 0x3ffff
    s_movrels_b32 s68, s57
    s_movrels_b32 s69, s61
    s_sub_u32 s48, s66, s47
    s_mov_b32 s47, s66
    s_lshr_b32 s52, s71, 28
    s_lshl_b32 s67, s46, 9
    s_add_u32 s66, s66, s67
    s_sub_u32 s49, s66, s42
    s_mov_b32 s42, s66
    s_bfe_u32 s66, s68, 655360
    s_add_u32 s43, s42, s66
    s_bfe_u32 s39, s69, 655360
    s_bfe_u32 s66, s68, 655370
    s_add_u32 s44, s42, s66
    s_bfe_u32 s40, s69, 655370
    s_bfe_u32 s66, s68, 655380
    s_add_u32 s45, s42, s66
    s_bfe_u32 s41, s69, 655380
    v_add_u32 v252, s44, v247
    ds_read_u16 v238, v252
    ds_read_u16 v239, v252 offset:64
    v_add_u32 v252, s45, v247
    ds_read_u16 v240, v252
    ds_read_u16 v241, v252 offset:64
    v_mfma_f32_32x32x16_bf16 v[32:47], v[64:67], v[180:183], 0
    v_mul_f32 v196, v0, v96
    v_fmac_f32 v196, v1, v97
    v_fmac_f32 v196, v2, v98
    v_fmac_f32 v196, v3, v99
    v_fmac_f32 v196, v4, v100
    v_fmac_f32 v196, v5, v101
    v_fmac_f32 v196, v6, v102
    v_fmac_f32 v196, v7, v103
    v_mul_f32 v198, v8, v128
    v_fmac_f32 v198, v9, v129
    v_mfma_f32_32x32x16_bf16 v[48:63], v[68:71], v[180:183], 0
    s_waitcnt vmcnt(6)
    ds_read_b64_tr_b16 v[176:177], v244 offset:4096
    ds_read_b64_tr_b16 v[178:179], v244 offset:5120
    ds_read_b64_tr_b16 v[180:181], v245 offset:4096
    ds_read_b64_tr_b16 v[182:183], v245 offset:5120
    v_fmac_f32 v198, v10, v130
    v_fmac_f32 v198, v11, v131
    v_fmac_f32 v198, v12, v132
    v_fmac_f32 v198, v13, v133
    v_fmac_f32 v198, v14, v134
    v_fmac_f32 v198, v15, v135
    v_mul_f32 v200, v16, v128
    v_fmac_f32 v200, v17, v129
    v_permlane32_swap_b32 v196, v198
    v_mfma_f32_32x32x16_bf16 v[32:47], v[72:75], v[184:187], v[32:47]
    v_fmac_f32 v200, v18, v130
    v_fmac_f32 v200, v19, v131
    v_fmac_f32 v200, v20, v132
    v_fmac_f32 v200, v21, v133
    v_fmac_f32 v200, v22, v134
    v_fmac_f32 v200, v23, v135
    v_add_f32 v198, v196, v198
    v_mul_f32_e64 v202, v24, -v128
    v_fma_f32 v202, v25, -v129, v202
    v_mfma_f32_32x32x16_bf16 v[48:63], v[76:79], v[184:187], v[48:63]
    v_fma_f32 v202, v26, -v130, v202
    v_fma_f32 v202, v27, -v131, v202
    v_fma_f32 v202, v28, -v132, v202
    v_fma_f32 v202, v29, -v133, v202
    v_fma_f32 v202, v30, -v134, v202
    v_fma_f32 v202, v31, -v135, v202
    s_nop 1
    v_permlane32_swap_b32 v200, v202
    v_add_f32 v202, v200, v202
    s_waitcnt vmcnt(4) lgkmcnt(0)
    v_mfma_f32_32x32x16_bf16 v[0:15], v[64:67], v[176:179], 0
    v_mul_f32 v197, v32, v104
    v_fmac_f32 v197, v33, v105
    v_fmac_f32 v197, v34, v106
    v_fmac_f32 v197, v35, v107
    v_fmac_f32 v197, v36, v108
    v_fmac_f32 v197, v37, v109
    v_fmac_f32 v197, v38, v110
    v_fmac_f32 v197, v39, v111
    v_mul_f32 v199, v40, v136
    v_fmac_f32 v199, v41, v137
    s_add_u32 m0, s21, 4096
    v_mfma_f32_32x32x16_bf16 v[16:31], v[68:71], v[176:179], 0
    buffer_load_dwordx4 v234, s[4:7], s37 offen  lds
    buffer_load_dwordx4 v235, s[8:11], s37 offen offset:1024  lds
    ds_read_b64_tr_b16 v[176:177], v244 offset:6144
    ds_read_b64_tr_b16 v[178:179], v244 offset:7168
    ds_read_b64_tr_b16 v[184:185], v245 offset:6144
    ds_read_b64_tr_b16 v[186:187], v245 offset:7168
    v_add_u32 v252, s42, v247
    ds_read_u16 v234, v252
    ds_read_u16 v235, v252 offset:64
    v_fmac_f32 v199, v42, v138
    v_fmac_f32 v199, v43, v139
    v_fmac_f32 v199, v44, v140
    v_fmac_f32 v199, v45, v141
    v_fmac_f32 v199, v46, v142
    v_fmac_f32 v199, v47, v143
    v_mul_f32 v201, v48, v136
    v_fmac_f32 v201, v49, v137
    v_permlane32_swap_b32 v197, v199
    v_fmac_f32 v201, v50, v138
    s_waitcnt lgkmcnt(2)
    v_mfma_f32_32x32x16_bf16 v[0:15], v[72:75], v[176:179], v[0:15]
    v_fmac_f32 v201, v51, v139
    v_fmac_f32 v201, v52, v140
    v_fmac_f32 v201, v53, v141
    v_fmac_f32 v201, v54, v142
    v_fmac_f32 v201, v55, v143
    v_add_f32 v199, v197, v199
    v_mul_f32_e64 v203, v56, -v136
    v_fma_f32 v203, v57, -v137, v203
    v_fma_f32 v203, v58, -v138, v203
    v_fma_f32 v203, v59, -v139, v203
    s_add_u32 m0, s21, 6144
    v_mfma_f32_32x32x16_bf16 v[16:31], v[76:79], v[176:179], v[16:31]
    buffer_load_dwordx4 v236, s[4:7], s37 offen  lds
    buffer_load_dwordx4 v237, s[8:11], s37 offen offset:1024  lds
    v_add_u32 v252, s43, v247
    ds_read_u16 v236, v252
    ds_read_u16 v237, v252 offset:64
    v_fma_f32 v203, v60, -v140, v203
    v_fma_f32 v203, v61, -v141, v203
    v_fma_f32 v203, v62, -v142, v203
    v_fma_f32 v203, v63, -v143, v203
    s_nop 1
    v_permlane32_swap_b32 v201, v203
    v_add_f32 v203, v201, v203
    v_cvt_pk_bf16_f32 v192, v198, v199
    v_cvt_pk_bf16_f32 v193, v202, v203
    v_mfma_f32_32x32x16_bf16 v[32:47], v[64:67], v[180:183], 0
    v_mul_f32 v196, v0, v144
    v_fmac_f32 v196, v1, v145
    v_fmac_f32 v196, v2, v146
    v_fmac_f32 v196, v3, v147
    v_fmac_f32 v196, v4, v148
    v_fmac_f32 v196, v5, v149
    v_fmac_f32 v196, v6, v150
    v_fmac_f32 v196, v7, v151
    v_mfma_f32_32x32x16_bf16 v[48:63], v[68:71], v[180:183], 0
    s_waitcnt vmcnt(6)
    ds_read_b64_tr_b16 v[176:177], v244 offset:0
    ds_read_b64_tr_b16 v[178:179], v244 offset:1024
    ds_read_b64_tr_b16 v[180:181], v245 offset:0
    ds_read_b64_tr_b16 v[182:183], v245 offset:1024
    v_mul_f32 v198, v8, v112
    v_fmac_f32 v198, v9, v113
    v_fmac_f32 v198, v10, v114
    v_fmac_f32 v198, v11, v115
    v_fmac_f32 v198, v12, v116
    v_fmac_f32 v198, v13, v117
    v_fmac_f32 v198, v14, v118
    v_fmac_f32 v198, v15, v119
    v_mfma_f32_32x32x16_bf16 v[32:47], v[72:75], v[184:187], v[32:47]
    v_mul_f32_e64 v200, v16, -v160
    v_fma_f32 v200, v17, -v161, v200
    v_fma_f32 v200, v18, -v162, v200
    v_fma_f32 v200, v19, -v163, v200
    v_fma_f32 v200, v20, -v164, v200
    v_fma_f32 v200, v21, -v165, v200
    v_fma_f32 v200, v22, -v166, v200
    v_fma_f32 v200, v23, -v167, v200
    v_mfma_f32_32x32x16_bf16 v[48:63], v[76:79], v[184:187], v[48:63]
    v_mul_f32_e64 v202, v24, -v160
    v_fma_f32 v202, v25, -v161, v202
    v_fma_f32 v202, v26, -v162, v202
    v_fma_f32 v202, v27, -v163, v202
    v_fma_f32 v202, v28, -v164, v202
    v_fma_f32 v202, v29, -v165, v202
    v_fma_f32 v202, v30, -v166, v202
    v_fma_f32 v202, v31, -v167, v202
    s_waitcnt vmcnt(4) lgkmcnt(0)
    v_mfma_f32_32x32x16_bf16 v[0:15], v[64:67], v[176:179], 0
    v_mul_f32 v197, v32, v152
    v_fmac_f32 v197, v33, v153
    v_fmac_f32 v197, v34, v154
    v_fmac_f32 v197, v35, v155
    v_fmac_f32 v197, v36, v156
    v_fmac_f32 v197, v37, v157
    v_fmac_f32 v197, v38, v158
    v_fmac_f32 v197, v39, v159
    s_add_u32 m0, s21, 0
    v_mfma_f32_32x32x16_bf16 v[16:31], v[68:71], v[176:179], 0
    v_lshl_add_u32 v234, v234, 10, v246
    v_lshl_add_u32 v235, v235, 10, v246
    buffer_load_dwordx4 v234, s[4:7], s38 offen  lds
    buffer_load_dwordx4 v235, s[8:11], s38 offen offset:1024  lds
    ds_read_b64_tr_b16 v[176:177], v244 offset:2048
    ds_read_b64_tr_b16 v[178:179], v244 offset:3072
    ds_read_b64_tr_b16 v[184:185], v245 offset:2048
    ds_read_b64_tr_b16 v[186:187], v245 offset:3072
    v_mul_f32 v199, v40, v120
    v_fmac_f32 v199, v41, v121
    v_fmac_f32 v199, v42, v122
    v_fmac_f32 v199, v43, v123
    v_fmac_f32 v199, v44, v124
    v_fmac_f32 v199, v45, v125
    v_fmac_f32 v199, v46, v126
    v_fmac_f32 v199, v47, v127
    s_waitcnt lgkmcnt(0)
    v_mfma_f32_32x32x16_bf16 v[0:15], v[72:75], v[176:179], v[0:15]
    v_mul_f32_e64 v201, v48, -v168
    v_fma_f32 v201, v49, -v169, v201
    v_fma_f32 v201, v50, -v170, v201
    v_fma_f32 v201, v51, -v171, v201
    v_fma_f32 v201, v52, -v172, v201
    v_fma_f32 v201, v53, -v173, v201
    v_fma_f32 v201, v54, -v174, v201
    v_fma_f32 v201, v55, -v175, v201
    s_add_u32 m0, s21, 2048
    v_mfma_f32_32x32x16_bf16 v[16:31], v[76:79], v[176:179], v[16:31]
    v_lshl_add_u32 v236, v236, 10, v246
    v_lshl_add_u32 v237, v237, 10, v246
    buffer_load_dwordx4 v236, s[4:7], s39 offen  lds
    buffer_load_dwordx4 v237, s[8:11], s39 offen offset:1024  lds
    v_mul_f32_e64 v203, v56, -v168
    v_fma_f32 v203, v57, -v169, v203
    v_fma_f32 v203, v58, -v170, v203
    v_fma_f32 v203, v59, -v171, v203
    v_fma_f32 v203, v60, -v172, v203
    v_fma_f32 v203, v61, -v173, v203
    v_fma_f32 v203, v62, -v174, v203
    v_fma_f32 v203, v63, -v175, v203
    v_mfma_f32_32x32x16_bf16 v[32:47], v[64:67], v[180:183], 0
    v_mul_f32 v254, v0, v144
    v_fmac_f32 v254, v1, v145
    v_fmac_f32 v254, v2, v146
    v_fmac_f32 v254, v3, v147
    v_fmac_f32 v254, v4, v148
    v_mfma_f32_32x32x16_bf16 v[48:63], v[68:71], v[180:183], 0
    ds_swizzle_b32 v68, v68 offset:0x401F
    ds_swizzle_b32 v69, v69 offset:0x401F
    ds_swizzle_b32 v70, v70 offset:0x401F
    ds_swizzle_b32 v71, v71 offset:0x401F
    s_waitcnt vmcnt(6)
    ds_read_b64_tr_b16 v[176:177], v244 offset:4096
    ds_read_b64_tr_b16 v[178:179], v244 offset:5120
    ds_read_b64_tr_b16 v[180:181], v245 offset:4096
    ds_read_b64_tr_b16 v[182:183], v245 offset:5120
    v_fmac_f32 v254, v5, v149
    v_fmac_f32 v254, v6, v150
    v_fmac_f32 v254, v7, v151
    v_fmac_f32 v200, v8, v160
    v_mfma_f32_32x32x16_bf16 v[32:47], v[72:75], v[184:187], v[32:47]
    v_fmac_f32 v200, v9, v161
    v_permlane32_swap_b32 v196, v254
    v_fmac_f32 v200, v10, v162
    v_fmac_f32 v200, v11, v163
    v_fmac_f32 v200, v12, v164
    v_mfma_f32_32x32x16_bf16 v[48:63], v[76:79], v[184:187], v[48:63]
    ds_swizzle_b32 v76, v76 offset:0x401F
    ds_swizzle_b32 v77, v77 offset:0x401F
    ds_swizzle_b32 v78, v78 offset:0x401F
    ds_swizzle_b32 v79, v79 offset:0x401F
    v_fmac_f32 v200, v13, v165
    v_fmac_f32 v200, v14, v166
    v_fmac_f32 v200, v15, v167
    v_add_f32 v254, v196, v254
    s_waitcnt lgkmcnt(8)
    s_mov_b64 exec, s[56:57]
    v_xor_b32 v68, 0x80008000, v68
    v_xor_b32 v69, 0x80008000, v69
    v_xor_b32 v70, 0x80008000, v70
    v_xor_b32 v71, 0x80008000, v71
    s_mov_b64 exec, -1
    s_waitcnt vmcnt(4) lgkmcnt(4)
    v_mfma_f32_32x32x16_bf16 v[0:15], v[64:67], v[176:179], 0
    v_mul_f32 v255, v32, v152
    v_fmac_f32 v255, v33, v153
    v_fmac_f32 v255, v34, v154
    v_fmac_f32 v255, v35, v155
    v_fmac_f32 v255, v36, v156
    s_add_u32 m0, s21, 4096
    v_mfma_f32_32x32x16_bf16 v[16:31], v[68:71], v[176:179], v[16:31]
    v_lshl_add_u32 v238, v238, 10, v246
    v_lshl_add_u32 v239, v239, 10, v246
    buffer_load_dwordx4 v238, s[4:7], s40 offen  lds
    buffer_load_dwordx4 v239, s[8:11], s40 offen offset:1024  lds
    ds_read_b64_tr_b16 v[176:177], v244 offset:6144
    ds_read_b64_tr_b16 v[178:179], v244 offset:7168
    ds_read_b64_tr_b16 v[184:185], v245 offset:6144
    ds_read_b64_tr_b16 v[186:187], v245 offset:7168
    v_fmac_f32 v255, v37, v157
    v_fmac_f32 v255, v38, v158
    v_fmac_f32 v255, v39, v159
    v_fmac_f32 v201, v40, v168
    v_fmac_f32 v201, v41, v169
    s_waitcnt lgkmcnt(0)
    s_mov_b64 exec, s[56:57]
    v_xor_b32 v76, 0x80008000, v76
    v_xor_b32 v77, 0x80008000, v77
    v_xor_b32 v78, 0x80008000, v78
    v_xor_b32 v79, 0x80008000, v79
    s_mov_b64 exec, -1
    v_mfma_f32_32x32x16_bf16 v[0:15], v[72:75], v[176:179], v[0:15]
    v_permlane32_swap_b32 v197, v255
    v_fmac_f32 v201, v42, v170
    v_fmac_f32 v201, v43, v171
    v_fmac_f32 v201, v44, v172
    v_fmac_f32 v201, v45, v173
    s_add_u32 m0, s21, 6144
    v_mfma_f32_32x32x16_bf16 v[16:31], v[76:79], v[176:179], v[16:31]
    v_lshl_add_u32 v240, v240, 10, v246
    v_lshl_add_u32 v241, v241, 10, v246
    buffer_load_dwordx4 v240, s[4:7], s41 offen  lds
    buffer_load_dwordx4 v241, s[8:11], s41 offen offset:1024  lds
    v_fmac_f32 v201, v46, v174
    v_fmac_f32 v201, v47, v175
    v_add_f32 v255, v197, v255
    v_cvt_pk_bf16_f32 v194, v254, v255
    v_mfma_f32_32x32x16_bf16 v[32:47], v[64:67], v[180:183], 0
    v_mul_f32 v254, v0, v144
    v_fmac_f32 v254, v1, v145
    v_fmac_f32 v254, v2, v146
    v_fmac_f32 v254, v3, v147
    v_fmac_f32 v254, v4, v148
    v_fmac_f32 v254, v5, v149
    v_fmac_f32 v254, v6, v150
    v_fmac_f32 v254, v7, v151
    v_fma_f32 v202, v8, -v160, v202
    v_fma_f32 v202, v9, -v161, v202
    v_mfma_f32_32x32x16_bf16 v[48:63], v[68:71], v[180:183], v[48:63]
    s_waitcnt vmcnt(6)
    ds_read_b64_tr_b16 v[176:177], v244 offset:0
    ds_read_b64_tr_b16 v[178:179], v244 offset:1024
    ds_read_b64_tr_b16 v[180:181], v245 offset:0
    ds_read_b64_tr_b16 v[182:183], v245 offset:1024
    v_permlane32_swap_b32 v254, v200
    v_fma_f32 v202, v10, -v162, v202
    v_fma_f32 v202, v11, -v163, v202
    v_fma_f32 v202, v12, -v164, v202
    v_fma_f32 v202, v13, -v165, v202
    v_fma_f32 v202, v14, -v166, v202
    v_fma_f32 v202, v15, -v167, v202
    v_add_f32 v200, v254, v200
    v_fmac_f32 v198, v16, v112
    v_permlane32_swap_b32 v202, v254
    v_mfma_f32_32x32x16_bf16 v[32:47], v[72:75], v[184:187], v[32:47]
    v_fmac_f32 v198, v17, v113
    v_fmac_f32 v198, v18, v114
    v_fmac_f32 v198, v19, v115
    v_fmac_f32 v198, v20, v116
    v_fmac_f32 v198, v21, v117
    v_fmac_f32 v198, v22, v118
    v_fmac_f32 v198, v23, v119
    v_add_f32 v254, v202, v254
    v_mul_f32 v196, v24, v160
    v_fmac_f32 v196, v25, v161
    v_mfma_f32_32x32x16_bf16 v[48:63], v[76:79], v[184:187], v[48:63]
    v_add_u32 v249, s48, v249
    v_add_u32 v250, s49, v250
    ds_read_b32 v252, v251 offset:16
    ds_read_b64_tr_b16 v[64:65], v249 offset:0
    ds_read_b64_tr_b16 v[68:69], v249 offset:64
    ds_read_b64_tr_b16 v[66:67], v249 offset:256
    ds_read_b64_tr_b16 v[70:71], v249 offset:320
    s_mov_b64 exec, s[54:55]
    ds_read_u16_d16_hi v242, v250 offset:0
    s_mov_b64 exec, -1
    v_fmac_f32 v196, v26, v162
    v_fmac_f32 v196, v27, v163
    v_fmac_f32 v196, v28, v164
    v_fmac_f32 v196, v29, v165
    v_fmac_f32 v196, v30, v166
    v_fmac_f32 v196, v31, v167
    s_nop 1
    v_permlane32_swap_b32 v198, v196
    v_add_f32 v196, v198, v196
    v_mul_f32 v255, v32, v152
    v_fmac_f32 v255, v33, v153
    v_fmac_f32 v255, v34, v154
    v_fmac_f32 v255, v35, v155
    v_fmac_f32 v255, v36, v156
    v_fmac_f32 v255, v37, v157
    v_fmac_f32 v255, v38, v158
    v_fmac_f32 v255, v39, v159
    v_fma_f32 v203, v40, -v168, v203
    v_fma_f32 v203, v41, -v169, v203
    v_permlane32_swap_b32 v255, v201
    v_fma_f32 v203, v42, -v170, v203
    v_fma_f32 v203, v43, -v171, v203
    v_fma_f32 v203, v44, -v172, v203
    v_fma_f32 v203, v45, -v173, v203
    v_fma_f32 v203, v46, -v174, v203
    v_fma_f32 v203, v47, -v175, v203
    v_add_f32 v201, v255, v201
    v_fmac_f32 v199, v48, v120
    v_permlane32_swap_b32 v203, v255
    v_fmac_f32 v199, v49, v121
    v_fmac_f32 v199, v50, v122
    v_fmac_f32 v199, v51, v123
    v_fmac_f32 v199, v52, v124
    v_fmac_f32 v199, v53, v125
    v_fmac_f32 v199, v54, v126
    v_fmac_f32 v199, v55, v127
    v_add_f32 v255, v203, v255
    v_mul_f32 v197, v56, v168
    v_fmac_f32 v197, v57, v169
    v_fmac_f32 v197, v58, v170
    v_fmac_f32 v197, v59, v171
    v_fmac_f32 v197, v60, v172
    v_fmac_f32 v197, v61, v173
    v_fmac_f32 v197, v62, v174
    v_fmac_f32 v197, v63, v175
    s_nop 1
    v_permlane32_swap_b32 v199, v197
    v_add_f32 v197, v199, v197
    v_cvt_pk_bf16_f32 v200, v200, v201
    v_cvt_pk_bf16_f32 v254, v254, v255
    v_cvt_pk_bf16_f32 v196, v196, v197
    ds_write2st64_b32 v253, v192, v193 offset0:0 offset1:1
    ds_write2st64_b32 v253, v194, v200 offset0:2 offset1:3
    ds_write_b32 v253, v196 offset:1024
    s_mov_b64 exec, 0xffffffff
    ds_write_b32 v253, v254 offset:1280
    s_mov_b64 exec, -1
    s_add_u32 s50, s50, 1
    s_cmp_ge_u32 s50, 4
    s_cbranch_scc1 LAST1
    s_waitcnt lgkmcnt(9)
    v_readfirstlane_b32 s66, v252
    s_add_u32 s53, s53, 1
    v_mov_b32 v252, s53
    s_cmp_le_u32 s53, s66
    ds_write2_b32 v251, v252, v252 offset0:0 offset1:8
    s_setprio 1
    s_cbranch_scc1 PRIO_11
    s_setprio 0
PRIO_11:
    s_cmp_eq_u32 s52, 4
    s_cbranch_scc1 ITEM_1_4
    s_cmp_eq_u32 s52, 5
    s_cbranch_scc1 ITEM_1_5
    s_cmp_eq_u32 s52, 3
    s_cbranch_scc1 ITEM_1_3
    s_cmp_eq_u32 s52, 6
    s_cbranch_scc1 ITEM_1_6
    s_cmp_eq_u32 s52, 8
    s_cbranch_scc1 ITEM_1_8
    s_branch ITEM_1_2
.p2align 6
ITEM_1_5:
    s_mov_b64 exec, s[54:55]
    ds_read_u16_d16_hi v243, v250 offset:128
    s_mov_b64 exec, -1
    ds_read_b64_tr_b16 v[72:73], v249 offset:512
    ds_read_b64_tr_b16 v[76:77], v249 offset:576
    ds_read_b64_tr_b16 v[74:75], v249 offset:768
    ds_read_b64_tr_b16 v[78:79], v249 offset:832
    ds_read_b64_tr_b16 v[80:81], v249 offset:1024
    ds_read_b64_tr_b16 v[84:85], v249 offset:1088
    s_waitcnt lgkmcnt(7)
    v_mul_f32_dpp v196, v242, v64 row_newbcast:0 row_mask:0xf bank_mask:0xf
    v_mul_f32_dpp v197, v242, v65 row_newbcast:1 row_mask:0xf bank_mask:0xf
    v_mul_f32_dpp v198, v242, v64 row_newbcast:8 row_mask:0xf bank_mask:0xf
    v_mul_f32_dpp v199, v242, v65 row_newbcast:9 row_mask:0xf bank_mask:0xf
    v_mul_f32_dpp v200, v242, v68 row_newbcast:2 row_mask:0xf bank_mask:0xf
    v_mul_f32_dpp v201, v242, v69 row_newbcast:3 row_mask:0xf bank_mask:0xf
    v_mul_f32_dpp v202, v242, v68 row_newbcast:10 row_mask:0xf bank_mask:0xf
    v_mul_f32_dpp v203, v242, v69 row_newbcast:11 row_mask:0xf bank_mask:0xf
    v_cvt_pk_bf16_f32 v64, v196, v197
    v_cvt_pk_bf16_f32 v68, v198, v199
    v_cvt_pk_bf16_f32 v65, v200, v201
    v_cvt_pk_bf16_f32 v69, v202, v203
    v_mul_f32_dpp v196, v242, v66 row_newbcast:4 row_mask:0xf bank_mask:0xf
    v_mul_f32_dpp v197, v242, v67 row_newbcast:5 row_mask:0xf bank_mask:0xf
    v_mul_f32_dpp v198, v242, v66 row_newbcast:12 row_mask:0xf bank_mask:0xf
    v_mul_f32_dpp v199, v242, v67 row_newbcast:13 row_mask:0xf bank_mask:0xf
    v_mul_f32_dpp v200, v242, v70 row_newbcast:6 row_mask:0xf bank_mask:0xf
    v_mul_f32_dpp v201, v242, v71 row_newbcast:7 row_mask:0xf bank_mask:0xf
    v_mul_f32_dpp v202, v242, v70 row_newbcast:14 row_mask:0xf bank_mask:0xf
    v_mul_f32_dpp v203, v242, v71 row_newbcast:15 row_mask:0xf bank_mask:0xf
    v_cvt_pk_bf16_f32 v66, v196, v197
    v_cvt_pk_bf16_f32 v70, v198, v199
    v_cvt_pk_bf16_f32 v67, v200, v201
    v_cvt_pk_bf16_f32 v71, v202, v203
    s_mov_b64 exec, s[54:55]
    ds_read_u16_d16_hi v242, v250 offset:256
    s_mov_b64 exec, -1
    s_waitcnt vmcnt(4) lgkmcnt(3)
    v_mfma_f32_32x32x16_bf16 v[0:15], v[64:67], v[176:179], 0
    v_mul_f32_dpp v196, v243, v72 row_newbcast:0 row_mask:0xf bank_mask:0xf
    v_mul_f32_dpp v197, v243, v73 row_newbcast:1 row_mask:0xf bank_mask:0xf
    v_mul_f32_dpp v198, v243, v72 row_newbcast:8 row_mask:0xf bank_mask:0xf
    v_mul_f32_dpp v199, v243, v73 row_newbcast:9 row_mask:0xf bank_mask:0xf
    v_mul_f32_dpp v200, v243, v76 row_newbcast:2 row_mask:0xf bank_mask:0xf
    v_mul_f32_dpp v201, v243, v77 row_newbcast:3 row_mask:0xf bank_mask:0xf
    v_mul_f32_dpp v202, v243, v76 row_newbcast:10 row_mask:0xf bank_mask:0xf
    v_mul_f32_dpp v203, v243, v77 row_newbcast:11 row_mask:0xf bank_mask:0xf
    v_cvt_pk_bf16_f32 v72, v196, v197
    v_cvt_pk_bf16_f32 v76, v198, v199
    v_cvt_pk_bf16_f32 v73, v200, v201
    v_cvt_pk_bf16_f32 v77, v202, v203
    s_add_u32 m0, s21, 0
    v_mfma_f32_32x32x16_bf16 v[16:31], v[68:71], v[176:179], 0
    buffer_load_dwordx4 v236, s[4:7], s35 offen  lds
    buffer_load_dwordx4 v237, s[8:11], s35 offen offset:1024  lds
    ds_read_b64_tr_b16 v[176:177], v244 offset:2048
    ds_read_b64_tr_b16 v[178:179], v244 offset:3072
    ds_read_b64_tr_b16 v[184:185], v245 offset:2048
    ds_read_b64_tr_b16 v[186:187], v245 offset:3072
    v_mul_f32_dpp v196, v243, v74 row_newbcast:4 row_mask:0xf bank_mask:0xf
    v_mul_f32_dpp v197, v243, v75 row_newbcast:5 row_mask:0xf bank_mask:0xf
    v_mul_f32_dpp v198, v243, v74 row_newbcast:12 row_mask:0xf bank_mask:0xf
    v_mul_f32_dpp v199, v243, v75 row_newbcast:13 row_mask:0xf bank_mask:0xf
    v_mul_f32_dpp v200, v243, v78 row_newbcast:6 row_mask:0xf bank_mask:0xf
    v_mul_f32_dpp v201, v243, v79 row_newbcast:7 row_mask:0xf bank_mask:0xf
    v_mul_f32_dpp v202, v243, v78 row_newbcast:14 row_mask:0xf bank_mask:0xf
    v_mul_f32_dpp v203, v243, v79 row_newbcast:15 row_mask:0xf bank_mask:0xf
    v_cvt_pk_bf16_f32 v74, v196, v197
    v_cvt_pk_bf16_f32 v78, v198, v199
    v_cvt_pk_bf16_f32 v75, v200, v201
    v_cvt_pk_bf16_f32 v79, v202, v203
    s_nop 0
    s_waitcnt vmcnt(4) lgkmcnt(0)
    v_mfma_f32_32x32x16_bf16 v[0:15], v[72:75], v[176:179], v[0:15]
    v_mul_f32_dpp v196, v242, v80 row_newbcast:0 row_mask:0xf bank_mask:0xf
    v_mul_f32_dpp v197, v242, v81 row_newbcast:1 row_mask:0xf bank_mask:0xf
    v_mul_f32_dpp v198, v242, v80 row_newbcast:8 row_mask:0xf bank_mask:0xf
    v_mul_f32_dpp v199, v242, v81 row_newbcast:9 row_mask:0xf bank_mask:0xf
    v_mul_f32_dpp v200, v242, v84 row_newbcast:2 row_mask:0xf bank_mask:0xf
    v_mul_f32_dpp v201, v242, v85 row_newbcast:3 row_mask:0xf bank_mask:0xf
    s_add_u32 m0, s21, 2048
    v_mfma_f32_32x32x16_bf16 v[16:31], v[76:79], v[176:179], v[16:31]
    buffer_load_dwordx4 v238, s[4:7], s35 offen  lds
    ds_read_b64_tr_b16 v[176:177], v244 offset:4096
    ds_read_b64_tr_b16 v[188:189], v245 offset:4096
    v_mul_f32_dpp v202, v242, v84 row_newbcast:10 row_mask:0xf bank_mask:0xf
    v_mul_f32_dpp v203, v242, v85 row_newbcast:11 row_mask:0xf bank_mask:0xf
    v_cvt_pk_bf16_f32 v80, v196, v197
    v_cvt_pk_bf16_f32 v84, v198, v199
    v_cvt_pk_bf16_f32 v81, v200, v201
    v_cvt_pk_bf16_f32 v85, v202, v203
    s_nop 0
    s_waitcnt lgkmcnt(0)
    v_mfma_f32_32x32x8_bf16 v[0:15], v[80:81], v[176:177], v[0:15]
    s_add_u32 m0, s21, 4096
    v_mfma_f32_32x32x8_bf16 v[16:31], v[84:85], v[176:177], v[16:31]
    buffer_load_dwordx4 v234, s[4:7], s36 offen  lds
    buffer_load_dwordx4 v235, s[8:11], s36 offen offset:1024  lds
    s_mov_b32 m0, s50
    s_nop 0
    s_movrels_b32 s71, s23
    s_movrels_b32 s33, s28
    s_and_b32 s70, s33, 0x70
    s_andn2_b32 s33, s33, 0x70
    v_xor_b32 v253, s70, v248
    v_add_u32 v253, s33, v253
    s_bfe_u32 s46, s71, 0x30012
    s_mov_b32 m0, s46
    s_and_b32 s66, s71, 0x3ffff
    s_movrels_b32 s68, s57
    s_movrels_b32 s69, s61
    s_sub_u32 s48, s66, s47
    s_mov_b32 s47, s66
    s_lshr_b32 s52, s71, 28
    s_lshl_b32 s67, s46, 9
    s_add_u32 s66, s66, s67
    s_sub_u32 s49, s66, s42
    s_mov_b32 s42, s66
    s_bfe_u32 s66, s68, 655360
    s_add_u32 s43, s42, s66
    s_bfe_u32 s39, s69, 655360
    s_bfe_u32 s66, s68, 655370
    s_add_u32 s44, s42, s66
    s_bfe_u32 s40, s69, 655370
    s_bfe_u32 s66, s68, 655380
    s_add_u32 s45, s42, s66
    s_bfe_u32 s41, s69, 655380
    v_add_u32 v252, s45, v247
    ds_read_u16 v240, v252
    ds_read_u16 v241, v252 offset:64
    v_mfma_f32_32x32x16_bf16 v[32:47], v[64:67], v[180:183], 0
    v_mul_f32 v196, v0, v96
    v_fmac_f32 v196, v1, v97
    v_fmac_f32 v196, v2, v98
    v_fmac_f32 v196, v3, v99
    v_fmac_f32 v196, v4, v100
    v_fmac_f32 v196, v5, v101
    v_fmac_f32 v196, v6, v102
    v_mfma_f32_32x32x16_bf16 v[48:63], v[68:71], v[180:183], 0
    v_fmac_f32 v196, v7, v103
    v_mul_f32 v198, v8, v128
    v_fmac_f32 v198, v9, v129
    v_fmac_f32 v198, v10, v130
    v_fmac_f32 v198, v11, v131
    v_fmac_f32 v198, v12, v132
    v_mfma_f32_32x32x16_bf16 v[32:47], v[72:75], v[184:187], v[32:47]
    v_fmac_f32 v198, v13, v133
    v_fmac_f32 v198, v14, v134
    v_fmac_f32 v198, v15, v135
    v_mul_f32 v200, v16, v128
    v_fmac_f32 v200, v17, v129
    v_permlane32_swap_b32 v196, v198
    v_mfma_f32_32x32x16_bf16 v[48:63], v[76:79], v[184:187], v[48:63]
    s_waitcnt vmcnt(5)
    ds_read_b64_tr_b16 v[176:177], v244 offset:6144
    ds_read_b64_tr_b16 v[178:179], v244 offset:7168
    ds_read_b64_tr_b16 v[180:181], v245 offset:6144
    ds_read_b64_tr_b16 v[182:183], v245 offset:7168
    v_fmac_f32 v200, v18, v130
    v_fmac_f32 v200, v19, v131
    v_fmac_f32 v200, v20, v132
    v_fmac_f32 v200, v21, v133
    v_fmac_f32 v200, v22, v134
    v_fmac_f32 v200, v23, v135
    v_mfma_f32_32x32x8_bf16 v[32:47], v[80:81], v[188:189], v[32:47]
    v_add_f32 v198, v196, v198
    v_mul_f32_e64 v202, v24, -v128
    v_fma_f32 v202, v25, -v129, v202
    v_fma_f32 v202, v26, -v130, v202
    v_fma_f32 v202, v27, -v131, v202
    v_fma_f32 v202, v28, -v132, v202
    v_mfma_f32_32x32x8_bf16 v[48:63], v[84:85], v[188:189], v[48:63]
    v_fma_f32 v202, v29, -v133, v202
    v_fma_f32 v202, v30, -v134, v202
    v_fma_f32 v202, v31, -v135, v202
    s_nop 1
    v_permlane32_swap_b32 v200, v202
    v_add_f32 v202, v200, v202
    s_waitcnt vmcnt(3) lgkmcnt(0)
    v_mfma_f32_32x32x16_bf16 v[0:15], v[64:67], v[176:179], 0
    v_mul_f32 v197, v32, v104
    v_fmac_f32 v197, v33, v105
    v_fmac_f32 v197, v34, v106
    v_fmac_f32 v197, v35, v107
    v_fmac_f32 v197, v36, v108
    v_fmac_f32 v197, v37, v109
    v_fmac_f32 v197, v38, v110
    s_add_u32 m0, s21, 6144
    v_mfma_f32_32x32x16_bf16 v[16:31], v[68:71], v[176:179], 0
    buffer_load_dwordx4 v236, s[4:7], s36 offen  lds
    buffer_load_dwordx4 v237, s[8:11], s36 offen offset:1024  lds
    ds_read_b64_tr_b16 v[176:177], v244 offset:0
    ds_read_b64_tr_b16 v[178:179], v244 offset:1024
    ds_read_b64_tr_b16 v[184:185], v245 offset:0
    ds_read_b64_tr_b16 v[186:187], v245 offset:1024
    v_fmac_f32 v197, v39, v111
    v_mul_f32 v199, v40, v136
    v_fmac_f32 v199, v41, v137
    v_fmac_f32 v199, v42, v138
    v_fmac_f32 v199, v43, v139
    v_fmac_f32 v199, v44, v140
    s_waitcnt vmcnt(4) lgkmcnt(0)
    v_mfma_f32_32x32x16_bf16 v[0:15], v[72:75], v[176:179], v[0:15]
    v_fmac_f32 v199, v45, v141
    v_fmac_f32 v199, v46, v142
    v_fmac_f32 v199, v47, v143
    v_mul_f32 v201, v48, v136
    v_fmac_f32 v201, v49, v137
    v_permlane32_swap_b32 v197, v199
    v_fmac_f32 v201, v50, v138
    s_add_u32 m0, s21, 0
    v_mfma_f32_32x32x16_bf16 v[16:31], v[76:79], v[176:179], v[16:31]
    buffer_load_dwordx4 v238, s[4:7], s36 offen  lds
    ds_read_b64_tr_b16 v[176:177], v244 offset:2048
    ds_read_b64_tr_b16 v[188:189], v245 offset:2048
    v_fmac_f32 v201, v51, v139
    v_fmac_f32 v201, v52, v140
    v_fmac_f32 v201, v53, v141
    v_fmac_f32 v201, v54, v142
    v_fmac_f32 v201, v55, v143
    v_add_f32 v199, v197, v199
    s_waitcnt lgkmcnt(0)
    v_mfma_f32_32x32x8_bf16 v[0:15], v[80:81], v[176:177], v[0:15]
    v_mul_f32_e64 v203, v56, -v136
    v_fma_f32 v203, v57, -v137, v203
    v_fma_f32 v203, v58, -v138, v203
    v_fma_f32 v203, v59, -v139, v203
    v_fma_f32 v203, v60, -v140, v203
    v_fma_f32 v203, v61, -v141, v203
    v_fma_f32 v203, v62, -v142, v203
    s_add_u32 m0, s21, 2048
    v_mfma_f32_32x32x8_bf16 v[16:31], v[84:85], v[176:177], v[16:31]
    buffer_load_dwordx4 v234, s[4:7], s37 offen  lds
    buffer_load_dwordx4 v235, s[8:11], s37 offen offset:1024  lds
    v_add_u32 v252, s42, v247
    ds_read_u16 v234, v252
    ds_read_u16 v235, v252 offset:64
    v_fma_f32 v203, v63, -v143, v203
    s_nop 1
    v_permlane32_swap_b32 v201, v203
    v_add_f32 v203, v201, v203
    v_cvt_pk_bf16_f32 v192, v198, v199
    v_cvt_pk_bf16_f32 v193, v202, v203
    v_mfma_f32_32x32x16_bf16 v[32:47], v[64:67], v[180:183], 0
    v_mul_f32 v196, v0, v144
    v_fmac_f32 v196, v1, v145
    v_fmac_f32 v196, v2, v146
    v_fmac_f32 v196, v3, v147
    v_fmac_f32 v196, v4, v148
    v_fmac_f32 v196, v5, v149
    v_mfma_f32_32x32x16_bf16 v[48:63], v[68:71], v[180:183], 0
    v_fmac_f32 v196, v6, v150
    v_fmac_f32 v196, v7, v151
    v_mul_f32 v198, v8, v112
    v_fmac_f32 v198, v9, v113
    v_fmac_f32 v198, v10, v114
    v_mfma_f32_32x32x16_bf16 v[32:47], v[72:75], v[184:187], v[32:47]
    v_fmac_f32 v198, v11, v115
    v_fmac_f32 v198, v12, v116
    v_fmac_f32 v198, v13, v117
    v_fmac_f32 v198, v14, v118
    v_fmac_f32 v198, v15, v119
    v_mfma_f32_32x32x16_bf16 v[48:63], v[76:79], v[184:187], v[48:63]
    s_waitcnt vmcnt(5)
    ds_read_b64_tr_b16 v[176:177], v244 offset:4096
    ds_read_b64_tr_b16 v[178:179], v244 offset:5120
    ds_read_b64_tr_b16 v[180:181], v245 offset:4096
    ds_read_b64_tr_b16 v[182:183], v245 offset:5120
    v_mul_f32_e64 v200, v16, -v160
    v_fma_f32 v200, v17, -v161, v200
    v_fma_f32 v200, v18, -v162, v200
    v_fma_f32 v200, v19, -v163, v200
    v_fma_f32 v200, v20, -v164, v200
    v_fma_f32 v200, v21, -v165, v200
    v_mfma_f32_32x32x8_bf16 v[32:47], v[80:81], v[188:189], v[32:47]
    v_fma_f32 v200, v22, -v166, v200
    v_fma_f32 v200, v23, -v167, v200
    v_mul_f32_e64 v202, v24, -v160
    v_fma_f32 v202, v25, -v161, v202
    v_fma_f32 v202, v26, -v162, v202
    v_mfma_f32_32x32x8_bf16 v[48:63], v[84:85], v[188:189], v[48:63]
    v_fma_f32 v202, v27, -v163, v202
    v_fma_f32 v202, v28, -v164, v202
    v_fma_f32 v202, v29, -v165, v202
    v_fma_f32 v202, v30, -v166, v202
    v_fma_f32 v202, v31, -v167, v202
    s_waitcnt vmcnt(3) lgkmcnt(0)
    v_mfma_f32_32x32x16_bf16 v[0:15], v[64:67], v[176:179], 0
    v_mul_f32 v197, v32, v152
    v_fmac_f32 v197, v33, v153
    v_fmac_f32 v197, v34, v154
    v_fmac_f32 v197, v35, v155
    v_fmac_f32 v197, v36, v156
    v_fmac_f32 v197, v37, v157
    s_add_u32 m0, s21, 4096
    v_mfma_f32_32x32x16_bf16 v[16:31], v[68:71], v[176:179], 0
    buffer_load_dwordx4 v236, s[4:7], s37 offen  lds
    buffer_load_dwordx4 v237, s[8:11], s37 offen offset:1024  lds
    ds_read_b64_tr_b16 v[176:177], v244 offset:6144
    ds_read_b64_tr_b16 v[178:179], v244 offset:7168
    ds_read_b64_tr_b16 v[184:185], v245 offset:6144
    ds_read_b64_tr_b16 v[186:187], v245 offset:7168
    v_add_u32 v252, s43, v247
    ds_read_u16 v236, v252
    ds_read_u16 v237, v252 offset:64
    v_fmac_f32 v197, v38, v158
    v_fmac_f32 v197, v39, v159
    v_mul_f32 v199, v40, v120
    v_fmac_f32 v199, v41, v121
    v_fmac_f32 v199, v42, v122
    s_waitcnt vmcnt(4) lgkmcnt(2)
    v_mfma_f32_32x32x16_bf16 v[0:15], v[72:75], v[176:179], v[0:15]
    v_fmac_f32 v199, v43, v123
    v_fmac_f32 v199, v44, v124
    v_fmac_f32 v199, v45, v125
    v_fmac_f32 v199, v46, v126
    v_fmac_f32 v199, v47, v127
    s_add_u32 m0, s21, 6144
    v_mfma_f32_32x32x16_bf16 v[16:31], v[76:79], v[176:179], v[16:31]
    buffer_load_dwordx4 v238, s[4:7], s37 offen  lds
    ds_read_b64_tr_b16 v[176:177], v244 offset:0
    ds_read_b64_tr_b16 v[188:189], v245 offset:0
    v_add_u32 v252, s44, v247
    ds_read_u16 v238, v252
    ds_read_u16 v239, v252 offset:64
    v_mul_f32_e64 v201, v48, -v168
    v_fma_f32 v201, v49, -v169, v201
    v_fma_f32 v201, v50, -v170, v201
    v_fma_f32 v201, v51, -v171, v201
    v_fma_f32 v201, v52, -v172, v201
    v_fma_f32 v201, v53, -v173, v201
    s_waitcnt lgkmcnt(2)
    v_mfma_f32_32x32x8_bf16 v[0:15], v[80:81], v[176:177], v[0:15]
    v_fma_f32 v201, v54, -v174, v201
    v_fma_f32 v201, v55, -v175, v201
    v_mul_f32_e64 v203, v56, -v168
    v_fma_f32 v203, v57, -v169, v203
    v_fma_f32 v203, v58, -v170, v203
    s_add_u32 m0, s21, 0
    v_mfma_f32_32x32x8_bf16 v[16:31], v[84:85], v[176:177], v[16:31]
    v_lshl_add_u32 v234, v234, 10, v246
    v_lshl_add_u32 v235, v235, 10, v246
    buffer_load_dwordx4 v234, s[4:7], s38 offen  lds
    buffer_load_dwordx4 v235, s[8:11], s38 offen offset:1024  lds
    v_fma_f32 v203, v59, -v171, v203
    v_fma_f32 v203, v60, -v172, v203
    v_fma_f32 v203, v61, -v173, v203
    v_fma_f32 v203, v62, -v174, v203
    v_fma_f32 v203, v63, -v175, v203
    v_mfma_f32_32x32x16_bf16 v[32:47], v[64:67], v[180:183], 0
    v_mul_f32 v254, v0, v144
    v_fmac_f32 v254, v1, v145
    v_fmac_f32 v254, v2, v146
    v_mfma_f32_32x32x16_bf16 v[48:63], v[68:71], v[180:183], 0
    ds_swizzle_b32 v68, v68 offset:0x401F
    ds_swizzle_b32 v69, v69 offset:0x401F
    ds_swizzle_b32 v70, v70 offset:0x401F
    ds_swizzle_b32 v71, v71 offset:0x401F
    v_fmac_f32 v254, v3, v147
    v_fmac_f32 v254, v4, v148
    v_fmac_f32 v254, v5, v149
    v_mfma_f32_32x32x16_bf16 v[32:47], v[72:75], v[184:187], v[32:47]
    v_fmac_f32 v254, v6, v150
    v_fmac_f32 v254, v7, v151
    v_fmac_f32 v200, v8, v160
    v_mfma_f32_32x32x16_bf16 v[48:63], v[76:79], v[184:187], v[48:63]
    ds_swizzle_b32 v76, v76 offset:0x401F
    ds_swizzle_b32 v77, v77 offset:0x401F
    ds_swizzle_b32 v78, v78 offset:0x401F
    ds_swizzle_b32 v79, v79 offset:0x401F
    s_waitcnt vmcnt(5)
    ds_read_b64_tr_b16 v[176:177], v244 offset:2048
    ds_read_b64_tr_b16 v[178:179], v244 offset:3072
    ds_read_b64_tr_b16 v[180:181], v245 offset:2048
    ds_read_b64_tr_b16 v[182:183], v245 offset:3072
    v_fmac_f32 v200, v9, v161
    v_permlane32_swap_b32 v196, v254
    v_fmac_f32 v200, v10, v162
    v_mfma_f32_32x32x8_bf16 v[32:47], v[80:81], v[188:189], v[32:47]
    v_fmac_f32 v200, v11, v163
    v_fmac_f32 v200, v12, v164
    v_fmac_f32 v200, v13, v165
    v_mfma_f32_32x32x8_bf16 v[48:63], v[84:85], v[188:189], v[48:63]
    ds_swizzle_b32 v84, v84 offset:0x401F
    ds_swizzle_b32 v85, v85 offset:0x401F
    v_fmac_f32 v200, v14, v166
    v_fmac_f32 v200, v15, v167
    v_add_f32 v254, v196, v254
    s_waitcnt lgkmcnt(6)
    s_mov_b64 exec, s[56:57]
    v_xor_b32 v68, 0x80008000, v68
    v_xor_b32 v69, 0x80008000, v69
    v_xor_b32 v70, 0x80008000, v70
    v_xor_b32 v71, 0x80008000, v71
    v_xor_b32 v76, 0x80008000, v76
    v_xor_b32 v77, 0x80008000, v77
    v_xor_b32 v78, 0x80008000, v78
    v_xor_b32 v79, 0x80008000, v79
    s_mov_b64 exec, -1
    s_waitcnt vmcnt(3) lgkmcnt(2)
    v_mfma_f32_32x32x16_bf16 v[0:15], v[64:67], v[176:179], 0
    v_mul_f32 v255, v32, v152
    v_fmac_f32 v255, v33, v153
    v_fmac_f32 v255, v34, v154
    v_fmac_f32 v255, v35, v155
    s_add_u32 m0, s21, 2048
    v_mfma_f32_32x32x16_bf16 v[16:31], v[68:71], v[176:179], v[16:31]
    v_lshl_add_u32 v236, v236, 10, v246
    v_lshl_add_u32 v237, v237, 10, v246
    buffer_load_dwordx4 v236, s[4:7], s39 offen  lds
    buffer_load_dwordx4 v237, s[8:11], s39 offen offset:1024  lds
    ds_read_b64_tr_b16 v[176:177], v244 offset:4096
    ds_read_b64_tr_b16 v[178:179], v244 offset:5120
    ds_read_b64_tr_b16 v[184:185], v245 offset:4096
    ds_read_b64_tr_b16 v[186:187], v245 offset:5120
    v_fmac_f32 v255, v36, v156
    v_fmac_f32 v255, v37, v157
    v_fmac_f32 v255, v38, v158
    s_waitcnt vmcnt(4) lgkmcnt(0)
    v_mfma_f32_32x32x16_bf16 v[0:15], v[72:75], v[176:179], v[0:15]
    v_fmac_f32 v255, v39, v159
    v_fmac_f32 v201, v40, v168
    v_fmac_f32 v201, v41, v169
    s_add_u32 m0, s21, 4096
    v_mfma_f32_32x32x16_bf16 v[16:31], v[76:79], v[176:179], v[16:31]
    v_lshl_add_u32 v238, v238, 10, v246
    v_lshl_add_u32 v239, v239, 10, v246
    buffer_load_dwordx4 v238, s[4:7], s40 offen  lds
    buffer_load_dwordx4 v239, s[8:11], s40 offen offset:1024  lds
    ds_read_b64_tr_b16 v[176:177], v244 offset:6144
    ds_read_b64_tr_b16 v[188:189], v245 offset:6144
    v_permlane32_swap_b32 v197, v255
    v_fmac_f32 v201, v42, v170
    v_fmac_f32 v201, v43, v171
    s_waitcnt lgkmcnt(0)
    s_mov_b64 exec, s[56:57]
    v_xor_b32 v84, 0x80008000, v84
    v_xor_b32 v85, 0x80008000, v85
    s_mov_b64 exec, -1
    v_mfma_f32_32x32x8_bf16 v[0:15], v[80:81], v[176:177], v[0:15]
    v_fmac_f32 v201, v44, v172
    v_fmac_f32 v201, v45, v173
    v_fmac_f32 v201, v46, v174
    s_add_u32 m0, s21, 6144
    v_mfma_f32_32x32x8_bf16 v[16:31], v[84:85], v[176:177], v[16:31]
    v_lshl_add_u32 v240, v240, 10, v246
    v_lshl_add_u32 v241, v241, 10, v246
    buffer_load_dwordx4 v240, s[4:7], s41 offen  lds
    buffer_load_dwordx4 v241, s[8:11], s41 offen offset:1024  lds
    v_fmac_f32 v201, v47, v175
    v_add_f32 v255, v197, v255
    v_cvt_pk_bf16_f32 v194, v254, v255
    v_mfma_f32_32x32x16_bf16 v[32:47], v[64:67], v[180:183], 0
    v_mul_f32 v254, v0, v144
    v_fmac_f32 v254, v1, v145
    v_fmac_f32 v254, v2, v146
    v_fmac_f32 v254, v3, v147
    v_fmac_f32 v254, v4, v148
    v_fmac_f32 v254, v5, v149
    v_fmac_f32 v254, v6, v150
    v_mfma_f32_32x32x16_bf16 v[48:63], v[68:71], v[180:183], v[48:63]
    v_fmac_f32 v254, v7, v151
    v_fma_f32 v202, v8, -v160, v202
    v_fma_f32 v202, v9, -v161, v202
    v_permlane32_swap_b32 v254, v200
    v_fma_f32 v202, v10, -v162, v202
    v_fma_f32 v202, v11, -v163, v202
    v_mfma_f32_32x32x16_bf16 v[32:47], v[72:75], v[184:187], v[32:47]
    v_fma_f32 v202, v12, -v164, v202
    v_fma_f32 v202, v13, -v165, v202
    v_fma_f32 v202, v14, -v166, v202
    v_fma_f32 v202, v15, -v167, v202
    v_add_f32 v200, v254, v200
    v_fmac_f32 v198, v16, v112
    v_permlane32_swap_b32 v202, v254
    v_mfma_f32_32x32x16_bf16 v[48:63], v[76:79], v[184:187], v[48:63]
    s_waitcnt vmcnt(6)
    ds_read_b64_tr_b16 v[176:177], v244 offset:0
    ds_read_b64_tr_b16 v[178:179], v244 offset:1024
    ds_read_b64_tr_b16 v[180:181], v245 offset:0
    ds_read_b64_tr_b16 v[182:183], v245 offset:1024
    v_fmac_f32 v198, v17, v113
    v_fmac_f32 v198, v18, v114
    v_fmac_f32 v198, v19, v115
    v_fmac_f32 v198, v20, v116
    v_fmac_f32 v198, v21, v117
    v_fmac_f32 v198, v22, v118
    v_mfma_f32_32x32x8_bf16 v[32:47], v[80:81], v[188:189], v[32:47]
    v_fmac_f32 v198, v23, v119
    v_add_f32 v254, v202, v254
    v_mul_f32 v196, v24, v160
    v_fmac_f32 v196, v25, v161
    v_fmac_f32 v196, v26, v162
    v_fmac_f32 v196, v27, v163
    v_fmac_f32 v196, v28, v164
    v_mfma_f32_32x32x8_bf16 v[48:63], v[84:85], v[188:189], v[48:63]
    v_add_u32 v249, s48, v249
    v_add_u32 v250, s49, v250
    ds_read_b32 v252, v251 offset:16
    ds_read_b64_tr_b16 v[64:65], v249 offset:0
    ds_read_b64_tr_b16 v[68:69], v249 offset:64
    ds_read_b64_tr_b16 v[66:67], v249 offset:256
    ds_read_b64_tr_b16 v[70:71], v249 offset:320
    s_mov_b64 exec, s[54:55]
    ds_read_u16_d16_hi v242, v250 offset:0
    s_mov_b64 exec, -1
    v_fmac_f32 v196, v29, v165
    v_fmac_f32 v196, v30, v166
    v_fmac_f32 v196, v31, v167
    s_nop 1
    v_permlane32_swap_b32 v198, v196
    v_add_f32 v196, v198, v196
    v_mul_f32 v255, v32, v152
    v_fmac_f32 v255, v33, v153
    v_fmac_f32 v255, v34, v154
    v_fmac_f32 v255, v35, v155
    v_fmac_f32 v255, v36, v156
    v_fmac_f32 v255, v37, v157
    v_fmac_f32 v255, v38, v158
    v_fmac_f32 v255, v39, v159
    v_fma_f32 v203, v40, -v168, v203
    v_fma_f32 v203, v41, -v169, v203
    v_permlane32_swap_b32 v255, v201
    v_fma_f32 v203, v42, -v170, v203
    v_fma_f32 v203, v43, -v171, v203
    v_fma_f32 v203, v44, -v172, v203
    v_fma_f32 v203, v45, -v173, v203
    v_fma_f32 v203, v46, -v174, v203
    v_fma_f32 v203, v47, -v175, v203
    v_add_f32 v201, v255, v201
    v_fmac_f32 v199, v48, v120
    v_permlane32_swap_b32 v203, v255
    v_fmac_f32 v199, v49, v121
    v_fmac_f32 v199, v50, v122
    v_fmac_f32 v199, v51, v123
    v_fmac_f32 v199, v52, v124
    v_fmac_f32 v199, v53, v125
    v_fmac_f32 v199, v54, v126
    v_fmac_f32 v199, v55, v127
    v_add_f32 v255, v203, v255
    v_mul_f32 v197, v56, v168
    v_fmac_f32 v197, v57, v169
    v_fmac_f32 v197, v58, v170
    v_fmac_f32 v197, v59, v171
    v_fmac_f32 v197, v60, v172
    v_fmac_f32 v197, v61, v173
    v_fmac_f32 v197, v62, v174
    v_fmac_f32 v197, v63, v175
    s_nop 1
    v_permlane32_swap_b32 v199, v197
    v_add_f32 v197, v199, v197
    v_cvt_pk_bf16_f32 v200, v200, v201
    v_cvt_pk_bf16_f32 v254, v254, v255
    v_cvt_pk_bf16_f32 v196, v196, v197
    ds_write2st64_b32 v253, v192, v193 offset0:0 offset1:1
    ds_write2st64_b32 v253, v194, v200 offset0:2 offset1:3
    ds_write_b32 v253, v196 offset:1024
    s_mov_b64 exec, 0xffffffff
    ds_write_b32 v253, v254 offset:1280
    s_mov_b64 exec, -1
    s_add_u32 s50, s50, 1
    s_cmp_ge_u32 s50, 4
    s_cbranch_scc1 LAST1
    s_waitcnt lgkmcnt(9)
    v_readfirstlane_b32 s66, v252
    s_add_u32 s53, s53, 1
    v_mov_b32 v252, s53
    s_cmp_le_u32 s53, s66
    ds_write2_b32 v251, v252, v252 offset0:0 offset1:8
    s_setprio 1
    s_cbranch_scc1 PRIO_12
    s_setprio 0
PRIO_12:
    s_cmp_eq_u32 s52, 4
    s_cbranch_scc1 ITEM_1_4
    s_cmp_eq_u32 s52, 5
    s_cbranch_scc1 ITEM_1_5
    s_cmp_eq_u32 s52, 3
    s_cbranch_scc1 ITEM_1_3
    s_cmp_eq_u32 s52, 6
    s_cbranch_scc1 ITEM_1_6
    s_cmp_eq_u32 s52, 8
    s_cbranch_scc1 ITEM_1_8
    s_branch ITEM_1_2
.p2align 6
ITEM_1_3:
    s_mov_b64 exec, s[54:55]
    ds_read_u16_d16_hi v243, v250 offset:128
    s_mov_b64 exec, -1
    ds_read_b64_tr_b16 v[72:73], v249 offset:512
    ds_read_b64_tr_b16 v[76:77], v249 offset:576
    s_waitcnt lgkmcnt(3)
    v_mul_f32_dpp v196, v242, v64 row_newbcast:0 row_mask:0xf bank_mask:0xf
    v_mul_f32_dpp v197, v242, v65 row_newbcast:1 row_mask:0xf bank_mask:0xf
    v_mul_f32_dpp v198, v242, v64 row_newbcast:8 row_mask:0xf bank_mask:0xf
    v_mul_f32_dpp v199, v242, v65 row_newbcast:9 row_mask:0xf bank_mask:0xf
    v_mul_f32_dpp v200, v242, v68 row_newbcast:2 row_mask:0xf bank_mask:0xf
    v_mul_f32_dpp v201, v242, v69 row_newbcast:3 row_mask:0xf bank_mask:0xf
    v_mul_f32_dpp v202, v242, v68 row_newbcast:10 row_mask:0xf bank_mask:0xf
    v_mul_f32_dpp v203, v242, v69 row_newbcast:11 row_mask:0xf bank_mask:0xf
    v_cvt_pk_bf16_f32 v64, v196, v197
    v_cvt_pk_bf16_f32 v68, v198, v199
    v_cvt_pk_bf16_f32 v65, v200, v201
    v_cvt_pk_bf16_f32 v69, v202, v203
    v_mul_f32_dpp v196, v242, v66 row_newbcast:4 row_mask:0xf bank_mask:0xf
    v_mul_f32_dpp v197, v242, v67 row_newbcast:5 row_mask:0xf bank_mask:0xf
    v_mul_f32_dpp v198, v242, v66 row_newbcast:12 row_mask:0xf bank_mask:0xf
    v_mul_f32_dpp v199, v242, v67 row_newbcast:13 row_mask:0xf bank_mask:0xf
    v_mul_f32_dpp v200, v242, v70 row_newbcast:6 row_mask:0xf bank_mask:0xf
    v_mul_f32_dpp v201, v242, v71 row_newbcast:7 row_mask:0xf bank_mask:0xf
    v_mul_f32_dpp v202, v242, v70 row_newbcast:14 row_mask:0xf bank_mask:0xf
    v_mul_f32_dpp v203, v242, v71 row_newbcast:15 row_mask:0xf bank_mask:0xf
    v_cvt_pk_bf16_f32 v66, v196, v197
    v_cvt_pk_bf16_f32 v70, v198, v199
    v_cvt_pk_bf16_f32 v67, v200, v201
    v_cvt_pk_bf16_f32 v71, v202, v203
    s_nop 0
    s_waitcnt vmcnt(4) lgkmcnt(0)
    v_mfma_f32_32x32x16_bf16 v[0:15], v[64:67], v[176:179], 0
    v_mul_f32_dpp v196, v243, v72 row_newbcast:0 row_mask:0xf bank_mask:0xf
    v_mul_f32_dpp v197, v243, v73 row_newbcast:1 row_mask:0xf bank_mask:0xf
    v_mul_f32_dpp v198, v243, v72 row_newbcast:8 row_mask:0xf bank_mask:0xf
    v_mul_f32_dpp v199, v243, v73 row_newbcast:9 row_mask:0xf bank_mask:0xf
    v_mul_f32_dpp v200, v243, v76 row_newbcast:2 row_mask:0xf bank_mask:0xf
    v_mul_f32_dpp v201, v243, v77 row_newbcast:3 row_mask:0xf bank_mask:0xf
    s_add_u32 m0, s21, 0
    v_mfma_f32_32x32x16_bf16 v[16:31], v[68:71], v[176:179], 0
    buffer_load_dwordx4 v234, s[4:7], s36 offen  lds
    buffer_load_dwordx4 v235, s[8:11], s36 offen offset:1024  lds
    ds_read_b64_tr_b16 v[176:177], v244 offset:2048
    ds_read_b64_tr_b16 v[184:185], v245 offset:2048
    v_mul_f32_dpp v202, v243, v76 row_newbcast:10 row_mask:0xf bank_mask:0xf
    v_mul_f32_dpp v203, v243, v77 row_newbcast:11 row_mask:0xf bank_mask:0xf
    v_cvt_pk_bf16_f32 v72, v196, v197
    v_cvt_pk_bf16_f32 v76, v198, v199
    v_cvt_pk_bf16_f32 v73, v200, v201
    v_cvt_pk_bf16_f32 v77, v202, v203
    s_nop 0
    s_waitcnt lgkmcnt(0)
    v_mfma_f32_32x32x8_bf16 v[0:15], v[72:73], v[176:177], v[0:15]
    s_add_u32 m0, s21, 2048
    v_mfma_f32_32x32x8_bf16 v[16:31], v[76:77], v[176:177], v[16:31]
    buffer_load_dwordx4 v236, s[4:7], s36 offen  lds
    s_mov_b32 m0, s50
    s_nop 0
    s_movrels_b32 s71, s23
    s_movrels_b32 s33, s28
    s_and_b32 s70, s33, 0x70
    s_andn2_b32 s33, s33, 0x70
    v_xor_b32 v253, s70, v248
    v_add_u32 v253, s33, v253
    s_bfe_u32 s46, s71, 0x30012
    s_mov_b32 m0, s46
    s_and_b32 s66, s71, 0x3ffff
    s_movrels_b32 s68, s57
    s_movrels_b32 s69, s61
    s_sub_u32 s48, s66, s47
    s_mov_b32 s47, s66
    s_lshr_b32 s52, s71, 28
    s_lshl_b32 s67, s46, 9
    s_add_u32 s66, s66, s67
    s_sub_u32 s49, s66, s42
    s_mov_b32 s42, s66
    s_bfe_u32 s66, s68, 655360
    s_add_u32 s43, s42, s66
    s_bfe_u32 s39, s69, 655360
    s_bfe_u32 s66, s68, 655370
    s_add_u32 s44, s42, s66
    s_bfe_u32 s40, s69, 655370
    s_bfe_u32 s66, s68, 655380
    s_add_u32 s45, s42, s66
    s_bfe_u32 s41, s69, 655380
    v_add_u32 v252, s44, v247
    ds_read_u16 v238, v252
    ds_read_u16 v239, v252 offset:64
    v_add_u32 v252, s45, v247
    ds_read_u16 v240, v252
    ds_read_u16 v241, v252 offset:64
    v_mfma_f32_32x32x16_bf16 v[32:47], v[64:67], v[180:183], 0
    v_mul_f32 v196, v0, v96
    v_fmac_f32 v196, v1, v97
    v_fmac_f32 v196, v2, v98
    v_fmac_f32 v196, v3, v99
    v_fmac_f32 v196, v4, v100
    v_fmac_f32 v196, v5, v101
    v_fmac_f32 v196, v6, v102
    v_fmac_f32 v196, v7, v103
    v_mul_f32 v198, v8, v128
    v_fmac_f32 v198, v9, v129
    v_mfma_f32_32x32x16_bf16 v[48:63], v[68:71], v[180:183], 0
    s_waitcnt vmcnt(5)
    ds_read_b64_tr_b16 v[176:177], v244 offset:4096
    ds_read_b64_tr_b16 v[178:179], v244 offset:5120
    ds_read_b64_tr_b16 v[180:181], v245 offset:4096
    ds_read_b64_tr_b16 v[182:183], v245 offset:5120
    v_fmac_f32 v198, v10, v130
    v_fmac_f32 v198, v11, v131
    v_fmac_f32 v198, v12, v132
    v_fmac_f32 v198, v13, v133
    v_fmac_f32 v198, v14, v134
    v_fmac_f32 v198, v15, v135
    v_mul_f32 v200, v16, v128
    v_fmac_f32 v200, v17, v129
    v_permlane32_swap_b32 v196, v198
    v_mfma_f32_32x32x8_bf16 v[32:47], v[72:73], v[184:185], v[32:47]
    v_fmac_f32 v200, v18, v130
    v_fmac_f32 v200, v19, v131
    v_fmac_f32 v200, v20, v132
    v_fmac_f32 v200, v21, v133
    v_fmac_f32 v200, v22, v134
    v_fmac_f32 v200, v23, v135
    v_add_f32 v198, v196, v198
    v_mul_f32_e64 v202, v24, -v128
    v_fma_f32 v202, v25, -v129, v202
    v_mfma_f32_32x32x8_bf16 v[48:63], v[76:77], v[184:185], v[48:63]
    v_fma_f32 v202, v26, -v130, v202
    v_fma_f32 v202, v27, -v131, v202
    v_fma_f32 v202, v28, -v132, v202
    v_fma_f32 v202, v29, -v133, v202
    v_fma_f32 v202, v30, -v134, v202
    v_fma_f32 v202, v31, -v135, v202
    s_nop 1
    v_permlane32_swap_b32 v200, v202
    v_add_f32 v202, v200, v202
    s_waitcnt vmcnt(3) lgkmcnt(0)
    v_mfma_f32_32x32x16_bf16 v[0:15], v[64:67], v[176:179], 0
    v_mul_f32 v197, v32, v104
    v_fmac_f32 v197, v33, v105
    v_fmac_f32 v197, v34, v106
    v_fmac_f32 v197, v35, v107
    v_fmac_f32 v197, v36, v108
    v_fmac_f32 v197, v37, v109
    v_fmac_f32 v197, v38, v110
    v_fmac_f32 v197, v39, v111
    v_mul_f32 v199, v40, v136
    v_fmac_f32 v199, v41, v137
    s_add_u32 m0, s21, 4096
    v_mfma_f32_32x32x16_bf16 v[16:31], v[68:71], v[176:179], 0
    buffer_load_dwordx4 v234, s[4:7], s37 offen  lds
    buffer_load_dwordx4 v235, s[8:11], s37 offen offset:1024  lds
    ds_read_b64_tr_b16 v[176:177], v244 offset:6144
    ds_read_b64_tr_b16 v[184:185], v245 offset:6144
    v_add_u32 v252, s42, v247
    ds_read_u16 v234, v252
    ds_read_u16 v235, v252 offset:64
    v_fmac_f32 v199, v42, v138
    v_fmac_f32 v199, v43, v139
    v_fmac_f32 v199, v44, v140
    v_fmac_f32 v199, v45, v141
    v_fmac_f32 v199, v46, v142
    v_fmac_f32 v199, v47, v143
    v_mul_f32 v201, v48, v136
    v_fmac_f32 v201, v49, v137
    v_permlane32_swap_b32 v197, v199
    v_fmac_f32 v201, v50, v138
    s_waitcnt lgkmcnt(2)
    v_mfma_f32_32x32x8_bf16 v[0:15], v[72:73], v[176:177], v[0:15]
    v_fmac_f32 v201, v51, v139
    v_fmac_f32 v201, v52, v140
    v_fmac_f32 v201, v53, v141
    v_fmac_f32 v201, v54, v142
    v_fmac_f32 v201, v55, v143
    v_add_f32 v199, v197, v199
    v_mul_f32_e64 v203, v56, -v136
    v_fma_f32 v203, v57, -v137, v203
    v_fma_f32 v203, v58, -v138, v203
    v_fma_f32 v203, v59, -v139, v203
    s_add_u32 m0, s21, 6144
    v_mfma_f32_32x32x8_bf16 v[16:31], v[76:77], v[176:177], v[16:31]
    buffer_load_dwordx4 v236, s[4:7], s37 offen  lds
    v_add_u32 v252, s43, v247
    ds_read_u16 v236, v252
    ds_read_u16 v237, v252 offset:64
    v_fma_f32 v203, v60, -v140, v203
    v_fma_f32 v203, v61, -v141, v203
    v_fma_f32 v203, v62, -v142, v203
    v_fma_f32 v203, v63, -v143, v203
    s_nop 1
    v_permlane32_swap_b32 v201, v203
    v_add_f32 v203, v201, v203
    v_cvt_pk_bf16_f32 v192, v198, v199
    v_cvt_pk_bf16_f32 v193, v202, v203
    v_mfma_f32_32x32x16_bf16 v[32:47], v[64:67], v[180:183], 0
    v_mul_f32 v196, v0, v144
    v_fmac_f32 v196, v1, v145
    v_fmac_f32 v196, v2, v146
    v_fmac_f32 v196, v3, v147
    v_fmac_f32 v196, v4, v148
    v_fmac_f32 v196, v5, v149
    v_fmac_f32 v196, v6, v150
    v_fmac_f32 v196, v7, v151
    v_mfma_f32_32x32x16_bf16 v[48:63], v[68:71], v[180:183], 0
    s_waitcnt vmcnt(4)
    ds_read_b64_tr_b16 v[176:177], v244 offset:0
    ds_read_b64_tr_b16 v[178:179], v244 offset:1024
    ds_read_b64_tr_b16 v[180:181], v245 offset:0
    ds_read_b64_tr_b16 v[182:183], v245 offset:1024
    v_mul_f32 v198, v8, v112
    v_fmac_f32 v198, v9, v113
    v_fmac_f32 v198, v10, v114
    v_fmac_f32 v198, v11, v115
    v_fmac_f32 v198, v12, v116
    v_fmac_f32 v198, v13, v117
    v_fmac_f32 v198, v14, v118
    v_fmac_f32 v198, v15, v119
    v_mfma_f32_32x32x8_bf16 v[32:47], v[72:73], v[184:185], v[32:47]
    v_mul_f32_e64 v200, v16, -v160
    v_fma_f32 v200, v17, -v161, v200
    v_fma_f32 v200, v18, -v162, v200
    v_fma_f32 v200, v19, -v163, v200
    v_fma_f32 v200, v20, -v164, v200
    v_fma_f32 v200, v21, -v165, v200
    v_fma_f32 v200, v22, -v166, v200
    v_fma_f32 v200, v23, -v167, v200
    v_mfma_f32_32x32x8_bf16 v[48:63], v[76:77], v[184:185], v[48:63]
    v_mul_f32_e64 v202, v24, -v160
    v_fma_f32 v202, v25, -v161, v202
    v_fma_f32 v202, v26, -v162, v202
    v_fma_f32 v202, v27, -v163, v202
    v_fma_f32 v202, v28, -v164, v202
    v_fma_f32 v202, v29, -v165, v202
    v_fma_f32 v202, v30, -v166, v202
    v_fma_f32 v202, v31, -v167, v202
    s_waitcnt vmcnt(3) lgkmcnt(0)
    v_mfma_f32_32x32x16_bf16 v[0:15], v[64:67], v[176:179], 0
    v_mul_f32 v197, v32, v152
    v_fmac_f32 v197, v33, v153
    v_fmac_f32 v197, v34, v154
    v_fmac_f32 v197, v35, v155
    v_fmac_f32 v197, v36, v156
    v_fmac_f32 v197, v37, v157
    v_fmac_f32 v197, v38, v158
    v_fmac_f32 v197, v39, v159
    s_add_u32 m0, s21, 0
    v_mfma_f32_32x32x16_bf16 v[16:31], v[68:71], v[176:179], 0
    v_lshl_add_u32 v234, v234, 10, v246
    v_lshl_add_u32 v235, v235, 10, v246
    buffer_load_dwordx4 v234, s[4:7], s38 offen  lds
    buffer_load_dwordx4 v235, s[8:11], s38 offen offset:1024  lds
    ds_read_b64_tr_b16 v[176:177], v244 offset:2048
    ds_read_b64_tr_b16 v[184:185], v245 offset:2048
    v_mul_f32 v199, v40, v120
    v_fmac_f32 v199, v41, v121
    v_fmac_f32 v199, v42, v122
    v_fmac_f32 v199, v43, v123
    v_fmac_f32 v199, v44, v124
    v_fmac_f32 v199, v45, v125
    v_fmac_f32 v199, v46, v126
    v_fmac_f32 v199, v47, v127
    s_waitcnt lgkmcnt(0)
    v_mfma_f32_32x32x8_bf16 v[0:15], v[72:73], v[176:177], v[0:15]
    v_mul_f32_e64 v201, v48, -v168
    v_fma_f32 v201, v49, -v169, v201
    v_fma_f32 v201, v50, -v170, v201
    v_fma_f32 v201, v51, -v171, v201
    v_fma_f32 v201, v52, -v172, v201
    v_fma_f32 v201, v53, -v173, v201
    v_fma_f32 v201, v54, -v174, v201
    v_fma_f32 v201, v55, -v175, v201
    s_add_u32 m0, s21, 2048
    v_mfma_f32_32x32x8_bf16 v[16:31], v[76:77], v[176:177], v[16:31]
    v_lshl_add_u32 v236, v236, 10, v246
    v_lshl_add_u32 v237, v237, 10, v246
    buffer_load_dwordx4 v236, s[4:7], s39 offen  lds
    buffer_load_dwordx4 v237, s[8:11], s39 offen offset:1024  lds
    v_mul_f32_e64 v203, v56, -v168
    v_fma_f32 v203, v57, -v169, v203
    v_fma_f32 v203, v58, -v170, v203
    v_fma_f32 v203, v59, -v171, v203
    v_fma_f32 v203, v60, -v172, v203
    v_fma_f32 v203, v61, -v173, v203
    v_fma_f32 v203, v62, -v174, v203
    v_fma_f32 v203, v63, -v175, v203
    v_mfma_f32_32x32x16_bf16 v[32:47], v[64:67], v[180:183], 0
    v_mul_f32 v254, v0, v144
    v_fmac_f32 v254, v1, v145
    v_fmac_f32 v254, v2, v146
    v_fmac_f32 v254, v3, v147
    v_fmac_f32 v254, v4, v148
    v_mfma_f32_32x32x16_bf16 v[48:63], v[68:71], v[180:183], 0
    ds_swizzle_b32 v68, v68 offset:0x401F
    ds_swizzle_b32 v69, v69 offset:0x401F
    ds_swizzle_b32 v70, v70 offset:0x401F
    ds_swizzle_b32 v71, v71 offset:0x401F
    s_waitcnt vmcnt(5)
    ds_read_b64_tr_b16 v[176:177], v244 offset:4096
    ds_read_b64_tr_b16 v[178:179], v244 offset:5120
    ds_read_b64_tr_b16 v[180:181], v245 offset:4096
    ds_read_b64_tr_b16 v[182:183], v245 offset:5120
    v_fmac_f32 v254, v5, v149
    v_fmac_f32 v254, v6, v150
    v_fmac_f32 v254, v7, v151
    v_fmac_f32 v200, v8, v160
    v_mfma_f32_32x32x8_bf16 v[32:47], v[72:73], v[184:185], v[32:47]
    v_fmac_f32 v200, v9, v161
    v_permlane32_swap_b32 v196, v254
    v_fmac_f32 v200, v10, v162
    v_fmac_f32 v200, v11, v163
    v_fmac_f32 v200, v12, v164
    v_mfma_f32_32x32x8_bf16 v[48:63], v[76:77], v[184:185], v[48:63]
    ds_swizzle_b32 v76, v76 offset:0x401F
    ds_swizzle_b32 v77, v77 offset:0x401F
    v_fmac_f32 v200, v13, v165
    v_fmac_f32 v200, v14, v166
    v_fmac_f32 v200, v15, v167
    v_add_f32 v254, v196, v254
    s_waitcnt lgkmcnt(6)
    s_mov_b64 exec, s[56:57]
    v_xor_b32 v68, 0x80008000, v68
    v_xor_b32 v69, 0x80008000, v69
    v_xor_b32 v70, 0x80008000, v70
    v_xor_b32 v71, 0x80008000, v71
    s_mov_b64 exec, -1
    s_waitcnt vmcnt(4) lgkmcnt(2)
    v_mfma_f32_32x32x16_bf16 v[0:15], v[64:67], v[176:179], 0
    v_mul_f32 v255, v32, v152
    v_fmac_f32 v255, v33, v153
    v_fmac_f32 v255, v34, v154
    v_fmac_f32 v255, v35, v155
    v_fmac_f32 v255, v36, v156
    s_add_u32 m0, s21, 4096
    v_mfma_f32_32x32x16_bf16 v[16:31], v[68:71], v[176:179], v[16:31]
    v_lshl_add_u32 v238, v238, 10, v246
    v_lshl_add_u32 v239, v239, 10, v246
    buffer_load_dwordx4 v238, s[4:7], s40 offen  lds
    buffer_load_dwordx4 v239, s[8:11], s40 offen offset:1024  lds
    ds_read_b64_tr_b16 v[176:177], v244 offset:6144
    ds_read_b64_tr_b16 v[184:185], v245 offset:6144
    v_fmac_f32 v255, v37, v157
    v_fmac_f32 v255, v38, v158
    v_fmac_f32 v255, v39, v159
    v_fmac_f32 v201, v40, v168
    v_fmac_f32 v201, v41, v169
    s_waitcnt lgkmcnt(0)
    s_mov_b64 exec, s[56:57]
    v_xor_b32 v76, 0x80008000, v76
    v_xor_b32 v77, 0x80008000, v77
    s_mov_b64 exec, -1
    v_mfma_f32_32x32x8_bf16 v[0:15], v[72:73], v[176:177], v[0:15]
    v_permlane32_swap_b32 v197, v255
    v_fmac_f32 v201, v42, v170
    v_fmac_f32 v201, v43, v171
    v_fmac_f32 v201, v44, v172
    v_fmac_f32 v201, v45, v173
    s_add_u32 m0, s21, 6144
    v_mfma_f32_32x32x8_bf16 v[16:31], v[76:77], v[176:177], v[16:31]
    v_lshl_add_u32 v240, v240, 10, v246
    v_lshl_add_u32 v241, v241, 10, v246
    buffer_load_dwordx4 v240, s[4:7], s41 offen  lds
    buffer_load_dwordx4 v241, s[8:11], s41 offen offset:1024  lds
    v_fmac_f32 v201, v46, v174
    v_fmac_f32 v201, v47, v175
    v_add_f32 v255, v197, v255
    v_cvt_pk_bf16_f32 v194, v254, v255
    v_mfma_f32_32x32x16_bf16 v[32:47], v[64:67], v[180:183], 0
    v_mul_f32 v254, v0, v144
    v_fmac_f32 v254, v1, v145
    v_fmac_f32 v254, v2, v146
    v_fmac_f32 v254, v3, v147
    v_fmac_f32 v254, v4, v148
    v_fmac_f32 v254, v5, v149
    v_fmac_f32 v254, v6, v150
    v_fmac_f32 v254, v7, v151
    v_fma_f32 v202, v8, -v160, v202
    v_fma_f32 v202, v9, -v161, v202
    v_mfma_f32_32x32x16_bf16 v[48:63], v[68:71], v[180:183], v[48:63]
    s_waitcnt vmcnt(6)
    ds_read_b64_tr_b16 v[176:177], v244 offset:0
    ds_read_b64_tr_b16 v[178:179], v244 offset:1024
    ds_read_b64_tr_b16 v[180:181], v245 offset:0
    ds_read_b64_tr_b16 v[182:183], v245 offset:1024
    v_permlane32_swap_b32 v254, v200
    v_fma_f32 v202, v10, -v162, v202
    v_fma_f32 v202, v11, -v163, v202
    v_fma_f32 v202, v12, -v164, v202
    v_fma_f32 v202, v13, -v165, v202
    v_fma_f32 v202, v14, -v166, v202
    v_fma_f32 v202, v15, -v167, v202
    v_add_f32 v200, v254, v200
    v_fmac_f32 v198, v16, v112
    v_permlane32_swap_b32 v202, v254
    v_mfma_f32_32x32x8_bf16 v[32:47], v[72:73], v[184:185], v[32:47]
    v_fmac_f32 v198, v17, v113
    v_fmac_f32 v198, v18, v114
    v_fmac_f32 v198, v19, v115
    v_fmac_f32 v198, v20, v116
    v_fmac_f32 v198, v21, v117
    v_fmac_f32 v198, v22, v118
    v_fmac_f32 v198, v23, v119
    v_add_f32 v254, v202, v254
    v_mul_f32 v196, v24, v160
    v_fmac_f32 v196, v25, v161
    v_mfma_f32_32x32x8_bf16 v[48:63], v[76:77], v[184:185], v[48:63]
    v_add_u32 v249, s48, v249
    v_add_u32 v250, s49, v250
    ds_read_b32 v252, v251 offset:16
    ds_read_b64_tr_b16 v[64:65], v249 offset:0
    ds_read_b64_tr_b16 v[68:69], v249 offset:64
    ds_read_b64_tr_b16 v[66:67], v249 offset:256
    ds_read_b64_tr_b16 v[70:71], v249 offset:320
    s_mov_b64 exec, s[54:55]
    ds_read_u16_d16_hi v242, v250 offset:0
    s_mov_b64 exec, -1
    v_fmac_f32 v196, v26, v162
    v_fmac_f32 v196, v27, v163
    v_fmac_f32 v196, v28, v164
    v_fmac_f32 v196, v29, v165
    v_fmac_f32 v196, v30, v166
    v_fmac_f32 v196, v31, v167
    s_nop 1
    v_permlane32_swap_b32 v198, v196
    v_add_f32 v196, v198, v196
    v_mul_f32 v255, v32, v152
    v_fmac_f32 v255, v33, v153
    v_fmac_f32 v255, v34, v154
    v_fmac_f32 v255, v35, v155
    v_fmac_f32 v255, v36, v156
    v_fmac_f32 v255, v37, v157
    v_fmac_f32 v255, v38, v158
    v_fmac_f32 v255, v39, v159
    v_fma_f32 v203, v40, -v168, v203
    v_fma_f32 v203, v41, -v169, v203
    v_permlane32_swap_b32 v255, v201
    v_fma_f32 v203, v42, -v170, v203
    v_fma_f32 v203, v43, -v171, v203
    v_fma_f32 v203, v44, -v172, v203
    v_fma_f32 v203, v45, -v173, v203
    v_fma_f32 v203, v46, -v174, v203
    v_fma_f32 v203, v47, -v175, v203
    v_add_f32 v201, v255, v201
    v_fmac_f32 v199, v48, v120
    v_permlane32_swap_b32 v203, v255
    v_fmac_f32 v199, v49, v121
    v_fmac_f32 v199, v50, v122
    v_fmac_f32 v199, v51, v123
    v_fmac_f32 v199, v52, v124
    v_fmac_f32 v199, v53, v125
    v_fmac_f32 v199, v54, v126
    v_fmac_f32 v199, v55, v127
    v_add_f32 v255, v203, v255
    v_mul_f32 v197, v56, v168
    v_fmac_f32 v197, v57, v169
    v_fmac_f32 v197, v58, v170
    v_fmac_f32 v197, v59, v171
    v_fmac_f32 v197, v60, v172
    v_fmac_f32 v197, v61, v173
    v_fmac_f32 v197, v62, v174
    v_fmac_f32 v197, v63, v175
    s_nop 1
    v_permlane32_swap_b32 v199, v197
    v_add_f32 v197, v199, v197
    v_cvt_pk_bf16_f32 v200, v200, v201
    v_cvt_pk_bf16_f32 v254, v254, v255
    v_cvt_pk_bf16_f32 v196, v196, v197
    ds_write2st64_b32 v253, v192, v193 offset0:0 offset1:1
    ds_write2st64_b32 v253, v194, v200 offset0:2 offset1:3
    ds_write_b32 v253, v196 offset:1024
    s_mov_b64 exec, 0xffffffff
    ds_write_b32 v253, v254 offset:1280
    s_mov_b64 exec, -1
    s_add_u32 s50, s50, 1
    s_cmp_ge_u32 s50, 4
    s_cbranch_scc1 LAST1
    s_waitcnt lgkmcnt(9)
    v_readfirstlane_b32 s66, v252
    s_add_u32 s53, s53, 1
    v_mov_b32 v252, s53
    s_cmp_le_u32 s53, s66
    ds_write2_b32 v251, v252, v252 offset0:0 offset1:8
    s_setprio 1
    s_cbranch_scc1 PRIO_13
    s_setprio 0
PRIO_13:
    s_cmp_eq_u32 s52, 4
    s_cbranch_scc1 ITEM_1_4
    s_cmp_eq_u32 s52, 5
    s_cbranch_scc1 ITEM_1_5
    s_cmp_eq_u32 s52, 3
    s_cbranch_scc1 ITEM_1_3
    s_cmp_eq_u32 s52, 6
    s_cbranch_scc1 ITEM_1_6
    s_cmp_eq_u32 s52, 8
    s_cbranch_scc1 ITEM_1_8
    s_branch ITEM_1_2
.p2align 6
ITEM_1_6:
    s_mov_b64 exec, s[54:55]
    ds_read_u16_d16_hi v243, v250 offset:128
    s_mov_b64 exec, -1
    ds_read_b64_tr_b16 v[72:73], v249 offset:512
    ds_read_b64_tr_b16 v[76:77], v249 offset:576
    ds_read_b64_tr_b16 v[74:75], v249 offset:768
    ds_read_b64_tr_b16 v[78:79], v249 offset:832
    ds_read_b64_tr_b16 v[80:81], v249 offset:1024
    ds_read_b64_tr_b16 v[84:85], v249 offset:1088
    ds_read_b64_tr_b16 v[82:83], v249 offset:1280
    ds_read_b64_tr_b16 v[86:87], v249 offset:1344
    s_waitcnt lgkmcnt(9)
    v_mul_f32_dpp v196, v242, v64 row_newbcast:0 row_mask:0xf bank_mask:0xf
    v_mul_f32_dpp v197, v242, v65 row_newbcast:1 row_mask:0xf bank_mask:0xf
    v_mul_f32_dpp v198, v242, v64 row_newbcast:8 row_mask:0xf bank_mask:0xf
    v_mul_f32_dpp v199, v242, v65 row_newbcast:9 row_mask:0xf bank_mask:0xf
    v_mul_f32_dpp v200, v242, v68 row_newbcast:2 row_mask:0xf bank_mask:0xf
    v_mul_f32_dpp v201, v242, v69 row_newbcast:3 row_mask:0xf bank_mask:0xf
    v_mul_f32_dpp v202, v242, v68 row_newbcast:10 row_mask:0xf bank_mask:0xf
    v_mul_f32_dpp v203, v242, v69 row_newbcast:11 row_mask:0xf bank_mask:0xf
    v_cvt_pk_bf16_f32 v64, v196, v197
    v_cvt_pk_bf16_f32 v68, v198, v199
    v_cvt_pk_bf16_f32 v65, v200, v201
    v_cvt_pk_bf16_f32 v69, v202, v203
    v_mul_f32_dpp v196, v242, v66 row_newbcast:4 row_mask:0xf bank_mask:0xf
    v_mul_f32_dpp v197, v242, v67 row_newbcast:5 row_mask:0xf bank_mask:0xf
    v_mul_f32_dpp v198, v242, v66 row_newbcast:12 row_mask:0xf bank_mask:0xf
    v_mul_f32_dpp v199, v242, v67 row_newbcast:13 row_mask:0xf bank_mask:0xf
    v_mul_f32_dpp v200, v242, v70 row_newbcast:6 row_mask:0xf bank_mask:0xf
    v_mul_f32_dpp v201, v242, v71 row_newbcast:7 row_mask:0xf bank_mask:0xf
    v_mul_f32_dpp v202, v242, v70 row_newbcast:14 row_mask:0xf bank_mask:0xf
    v_mul_f32_dpp v203, v242, v71 row_newbcast:15 row_mask:0xf bank_mask:0xf
    v_cvt_pk_bf16_f32 v66, v196, v197
    v_cvt_pk_bf16_f32 v70, v198, v199
    v_cvt_pk_bf16_f32 v67, v200, v201
    v_cvt_pk_bf16_f32 v71, v202, v203
    s_mov_b64 exec, s[54:55]
    ds_read_u16_d16_hi v242, v250 offset:256
    s_mov_b64 exec, -1
    s_waitcnt vmcnt(4) lgkmcnt(5)
    v_mfma_f32_32x32x16_bf16 v[0:15], v[64:67], v[176:179], 0
    v_mul_f32_dpp v196, v243, v72 row_newbcast:0 row_mask:0xf bank_mask:0xf
    v_mul_f32_dpp v197, v243, v73 row_newbcast:1 row_mask:0xf bank_mask:0xf
    v_mul_f32_dpp v198, v243, v72 row_newbcast:8 row_mask:0xf bank_mask:0xf
    v_mul_f32_dpp v199, v243, v73 row_newbcast:9 row_mask:0xf bank_mask:0xf
    v_mul_f32_dpp v200, v243, v76 row_newbcast:2 row_mask:0xf bank_mask:0xf
    v_mul_f32_dpp v201, v243, v77 row_newbcast:3 row_mask:0xf bank_mask:0xf
    v_mul_f32_dpp v202, v243, v76 row_newbcast:10 row_mask:0xf bank_mask:0xf
    v_mul_f32_dpp v203, v243, v77 row_newbcast:11 row_mask:0xf bank_mask:0xf
    v_cvt_pk_bf16_f32 v72, v196, v197
    v_cvt_pk_bf16_f32 v76, v198, v199
    v_cvt_pk_bf16_f32 v73, v200, v201
    v_cvt_pk_bf16_f32 v77, v202, v203
    s_add_u32 m0, s21, 0
    v_mfma_f32_32x32x16_bf16 v[16:31], v[68:71], v[176:179], 0
    buffer_load_dwordx4 v236, s[4:7], s35 offen  lds
    buffer_load_dwordx4 v237, s[8:11], s35 offen offset:1024  lds
    ds_read_b64_tr_b16 v[176:177], v244 offset:2048
    ds_read_b64_tr_b16 v[178:179], v244 offset:3072
    ds_read_b64_tr_b16 v[184:185], v245 offset:2048
    ds_read_b64_tr_b16 v[186:187], v245 offset:3072
    v_mul_f32_dpp v196, v243, v74 row_newbcast:4 row_mask:0xf bank_mask:0xf
    v_mul_f32_dpp v197, v243, v75 row_newbcast:5 row_mask:0xf bank_mask:0xf
    v_mul_f32_dpp v198, v243, v74 row_newbcast:12 row_mask:0xf bank_mask:0xf
    v_mul_f32_dpp v199, v243, v75 row_newbcast:13 row_mask:0xf bank_mask:0xf
    v_mul_f32_dpp v200, v243, v78 row_newbcast:6 row_mask:0xf bank_mask:0xf
    v_mul_f32_dpp v201, v243, v79 row_newbcast:7 row_mask:0xf bank_mask:0xf
    v_mul_f32_dpp v202, v243, v78 row_newbcast:14 row_mask:0xf bank_mask:0xf
    v_mul_f32_dpp v203, v243, v79 row_newbcast:15 row_mask:0xf bank_mask:0xf
    v_cvt_pk_bf16_f32 v74, v196, v197
    v_cvt_pk_bf16_f32 v78, v198, v199
    v_cvt_pk_bf16_f32 v75, v200, v201
    v_cvt_pk_bf16_f32 v79, v202, v203
    s_nop 0
    s_waitcnt vmcnt(4) lgkmcnt(0)
    v_mfma_f32_32x32x16_bf16 v[0:15], v[72:75], v[176:179], v[0:15]
    v_mul_f32_dpp v196, v242, v80 row_newbcast:0 row_mask:0xf bank_mask:0xf
    v_mul_f32_dpp v197, v242, v81 row_newbcast:1 row_mask:0xf bank_mask:0xf
    v_mul_f32_dpp v198, v242, v80 row_newbcast:8 row_mask:0xf bank_mask:0xf
    v_mul_f32_dpp v199, v242, v81 row_newbcast:9 row_mask:0xf bank_mask:0xf
    v_mul_f32_dpp v200, v242, v84 row_newbcast:2 row_mask:0xf bank_mask:0xf
    v_mul_f32_dpp v201, v242, v85 row_newbcast:3 row_mask:0xf bank_mask:0xf
    v_mul_f32_dpp v202, v242, v84 row_newbcast:10 row_mask:0xf bank_mask:0xf
    v_mul_f32_dpp v203, v242, v85 row_newbcast:11 row_mask:0xf bank_mask:0xf
    v_cvt_pk_bf16_f32 v80, v196, v197
    v_cvt_pk_bf16_f32 v84, v198, v199
    v_cvt_pk_bf16_f32 v81, v200, v201
    v_cvt_pk_bf16_f32 v85, v202, v203
    s_add_u32 m0, s21, 2048
    v_mfma_f32_32x32x16_bf16 v[16:31], v[76:79], v[176:179], v[16:31]
    buffer_load_dwordx4 v238, s[4:7], s35 offen  lds
    buffer_load_dwordx4 v239, s[8:11], s35 offen offset:1024  lds
    ds_read_b64_tr_b16 v[176:177], v244 offset:4096
    ds_read_b64_tr_b16 v[178:179], v244 offset:5120
    ds_read_b64_tr_b16 v[188:189], v245 offset:4096
    ds_read_b64_tr_b16 v[190:191], v245 offset:5120
    v_mul_f32_dpp v196, v242, v82 row_newbcast:4 row_mask:0xf bank_mask:0xf
    v_mul_f32_dpp v197, v242, v83 row_newbcast:5 row_mask:0xf bank_mask:0xf
    v_mul_f32_dpp v198, v242, v82 row_newbcast:12 row_mask:0xf bank_mask:0xf
    v_mul_f32_dpp v199, v242, v83 row_newbcast:13 row_mask:0xf bank_mask:0xf
    v_mul_f32_dpp v200, v242, v86 row_newbcast:6 row_mask:0xf bank_mask:0xf
    v_mul_f32_dpp v201, v242, v87 row_newbcast:7 row_mask:0xf bank_mask:0xf
    v_mul_f32_dpp v202, v242, v86 row_newbcast:14 row_mask:0xf bank_mask:0xf
    v_mul_f32_dpp v203, v242, v87 row_newbcast:15 row_mask:0xf bank_mask:0xf
    v_cvt_pk_bf16_f32 v82, v196, v197
    v_cvt_pk_bf16_f32 v86, v198, v199
    v_cvt_pk_bf16_f32 v83, v200, v201
    v_cvt_pk_bf16_f32 v87, v202, v203
    s_nop 0
    s_waitcnt lgkmcnt(0)
    v_mfma_f32_32x32x16_bf16 v[0:15], v[80:83], v[176:179], v[0:15]
    s_add_u32 m0, s21, 4096
    v_mfma_f32_32x32x16_bf16 v[16:31], v[84:87], v[176:179], v[16:31]
    buffer_load_dwordx4 v234, s[4:7], s36 offen  lds
    buffer_load_dwordx4 v235, s[8:11], s36 offen offset:1024  lds
    s_mov_b32 m0, s50
    s_nop 0
    s_movrels_b32 s71, s23
    s_movrels_b32 s33, s28
    s_and_b32 s70, s33, 0x70
    s_andn2_b32 s33, s33, 0x70
    v_xor_b32 v253, s70, v248
    v_add_u32 v253, s33, v253
    s_bfe_u32 s46, s71, 0x30012
    s_mov_b32 m0, s46
    s_and_b32 s66, s71, 0x3ffff
    s_movrels_b32 s68, s57
    s_movrels_b32 s69, s61
    s_sub_u32 s48, s66, s47
    s_mov_b32 s47, s66
    s_lshr_b32 s52, s71, 28
    s_lshl_b32 s67, s46, 9
    s_add_u32 s66, s66, s67
    s_sub_u32 s49, s66, s42
    s_mov_b32 s42, s66
    s_bfe_u32 s66, s68, 655360
    s_add_u32 s43, s42, s66
    s_bfe_u32 s39, s69, 655360
    s_bfe_u32 s66, s68, 655370
    s_add_u32 s44, s42, s66
    s_bfe_u32 s40, s69, 655370
    s_bfe_u32 s66, s68, 655380
    s_add_u32 s45, s42, s66
    s_bfe_u32 s41, s69, 655380
    v_add_u32 v252, s45, v247
    ds_read_u16 v240, v252
    ds_read_u16 v241, v252 offset:64
    v_mfma_f32_32x32x16_bf16 v[32:47], v[64:67], v[180:183], 0
    v_mul_f32 v196, v0, v96
    v_fmac_f32 v196, v1, v97
    v_fmac_f32 v196, v2, v98
    v_fmac_f32 v196, v3, v99
    v_fmac_f32 v196, v4, v100
    v_fmac_f32 v196, v5, v101
    v_fmac_f32 v196, v6, v102
    v_mfma_f32_32x32x16_bf16 v[48:63], v[68:71], v[180:183], 0
    v_fmac_f32 v196, v7, v103
    v_mul_f32 v198, v8, v128
    v_fmac_f32 v198, v9, v129
    v_fmac_f32 v198, v10, v130
    v_fmac_f32 v198, v11, v131
    v_fmac_f32 v198, v12, v132
    v_mfma_f32_32x32x16_bf16 v[32:47], v[72:75], v[184:187], v[32:47]
    v_fmac_f32 v198, v13, v133
    v_fmac_f32 v198, v14, v134
    v_fmac_f32 v198, v15, v135
    v_mul_f32 v200, v16, v128
    v_fmac_f32 v200, v17, v129
    v_permlane32_swap_b32 v196, v198
    v_mfma_f32_32x32x16_bf16 v[48:63], v[76:79], v[184:187], v[48:63]
    s_waitcnt vmcnt(6)
    ds_read_b64_tr_b16 v[176:177], v244 offset:6144
    ds_read_b64_tr_b16 v[178:179], v244 offset:7168
    ds_read_b64_tr_b16 v[180:181], v245 offset:6144
    ds_read_b64_tr_b16 v[182:183], v245 offset:7168
    v_fmac_f32 v200, v18, v130
    v_fmac_f32 v200, v19, v131
    v_fmac_f32 v200, v20, v132
    v_fmac_f32 v200, v21, v133
    v_fmac_f32 v200, v22, v134
    v_fmac_f32 v200, v23, v135
    v_mfma_f32_32x32x16_bf16 v[32:47], v[80:83], v[188:191], v[32:47]
    v_add_f32 v198, v196, v198
    v_mul_f32_e64 v202, v24, -v128
    v_fma_f32 v202, v25, -v129, v202
    v_fma_f32 v202, v26, -v130, v202
    v_fma_f32 v202, v27, -v131, v202
    v_fma_f32 v202, v28, -v132, v202
    v_mfma_f32_32x32x16_bf16 v[48:63], v[84:87], v[188:191], v[48:63]
    v_fma_f32 v202, v29, -v133, v202
    v_fma_f32 v202, v30, -v134, v202
    v_fma_f32 v202, v31, -v135, v202
    s_nop 1
    v_permlane32_swap_b32 v200, v202
    v_add_f32 v202, v200, v202
    s_waitcnt vmcnt(4) lgkmcnt(0)
    v_mfma_f32_32x32x16_bf16 v[0:15], v[64:67], v[176:179], 0
    v_mul_f32 v197, v32, v104
    v_fmac_f32 v197, v33, v105
    v_fmac_f32 v197, v34, v106
    v_fmac_f32 v197, v35, v107
    v_fmac_f32 v197, v36, v108
    v_fmac_f32 v197, v37, v109
    v_fmac_f32 v197, v38, v110
    s_add_u32 m0, s21, 6144
    v_mfma_f32_32x32x16_bf16 v[16:31], v[68:71], v[176:179], 0
    buffer_load_dwordx4 v236, s[4:7], s36 offen  lds
    buffer_load_dwordx4 v237, s[8:11], s36 offen offset:1024  lds
    ds_read_b64_tr_b16 v[176:177], v244 offset:0
    ds_read_b64_tr_b16 v[178:179], v244 offset:1024
    ds_read_b64_tr_b16 v[184:185], v245 offset:0
    ds_read_b64_tr_b16 v[186:187], v245 offset:1024
    v_fmac_f32 v197, v39, v111
    v_mul_f32 v199, v40, v136
    v_fmac_f32 v199, v41, v137
    v_fmac_f32 v199, v42, v138
    v_fmac_f32 v199, v43, v139
    v_fmac_f32 v199, v44, v140
    s_waitcnt vmcnt(4) lgkmcnt(0)
    v_mfma_f32_32x32x16_bf16 v[0:15], v[72:75], v[176:179], v[0:15]
    v_fmac_f32 v199, v45, v141
    v_fmac_f32 v199, v46, v142
    v_fmac_f32 v199, v47, v143
    v_mul_f32 v201, v48, v136
    v_fmac_f32 v201, v49, v137
    v_permlane32_swap_b32 v197, v199
    v_fmac_f32 v201, v50, v138
    s_add_u32 m0, s21, 0
    v_mfma_f32_32x32x16_bf16 v[16:31], v[76:79], v[176:179], v[16:31]
    buffer_load_dwordx4 v238, s[4:7], s36 offen  lds
    buffer_load_dwordx4 v239, s[8:11], s36 offen offset:1024  lds
    ds_read_b64_tr_b16 v[176:177], v244 offset:2048
    ds_read_b64_tr_b16 v[178:179], v244 offset:3072
    ds_read_b64_tr_b16 v[188:189], v245 offset:2048
    ds_read_b64_tr_b16 v[190:191], v245 offset:3072
    v_fmac_f32 v201, v51, v139
    v_fmac_f32 v201, v52, v140
    v_fmac_f32 v201, v53, v141
    v_fmac_f32 v201, v54, v142
    v_fmac_f32 v201, v55, v143
    v_add_f32 v199, v197, v199
    s_waitcnt lgkmcnt(0)
    v_mfma_f32_32x32x16_bf16 v[0:15], v[80:83], v[176:179], v[0:15]
    v_mul_f32_e64 v203, v56, -v136
    v_fma_f32 v203, v57, -v137, v203
    v_fma_f32 v203, v58, -v138, v203
    v_fma_f32 v203, v59, -v139, v203
    v_fma_f32 v203, v60, -v140, v203
    v_fma_f32 v203, v61, -v141, v203
    v_fma_f32 v203, v62, -v142, v203
    s_add_u32 m0, s21, 2048
    v_mfma_f32_32x32x16_bf16 v[16:31], v[84:87], v[176:179], v[16:31]
    buffer_load_dwordx4 v234, s[4:7], s37 offen  lds
    buffer_load_dwordx4 v235, s[8:11], s37 offen offset:1024  lds
    v_add_u32 v252, s42, v247
    ds_read_u16 v234, v252
    ds_read_u16 v235, v252 offset:64
    v_fma_f32 v203, v63, -v143, v203
    s_nop 1
    v_permlane32_swap_b32 v201, v203
    v_add_f32 v203, v201, v203
    v_cvt_pk_bf16_f32 v192, v198, v199
    v_cvt_pk_bf16_f32 v193, v202, v203
    v_mfma_f32_32x32x16_bf16 v[32:47], v[64:67], v[180:183], 0
    v_mul_f32 v196, v0, v144
    v_fmac_f32 v196, v1, v145
    v_fmac_f32 v196, v2, v146
    v_fmac_f32 v196, v3, v147
    v_fmac_f32 v196, v4, v148
    v_fmac_f32 v196, v5, v149
    v_mfma_f32_32x32x16_bf16 v[48:63], v[68:71], v[180:183], 0
    v_fmac_f32 v196, v6, v150
    v_fmac_f32 v196, v7, v151
    v_mul_f32 v198, v8, v112
    v_fmac_f32 v198, v9, v113
    v_fmac_f32 v198, v10, v114
    v_mfma_f32_32x32x16_bf16 v[32:47], v[72:75], v[184:187], v[32:47]
    v_fmac_f32 v198, v11, v115
    v_fmac_f32 v198, v12, v116
    v_fmac_f32 v198, v13, v117
    v_fmac_f32 v198, v14, v118
    v_fmac_f32 v198, v15, v119
    v_mfma_f32_32x32x16_bf16 v[48:63], v[76:79], v[184:187], v[48:63]
    s_waitcnt vmcnt(6)
    ds_read_b64_tr_b16 v[176:177], v244 offset:4096
    ds_read_b64_tr_b16 v[178:179], v244 offset:5120
    ds_read_b64_tr_b16 v[180:181], v245 offset:4096
    ds_read_b64_tr_b16 v[182:183], v245 offset:5120
    v_mul_f32_e64 v200, v16, -v160
    v_fma_f32 v200, v17, -v161, v200
    v_fma_f32 v200, v18, -v162, v200
    v_fma_f32 v200, v19, -v163, v200
    v_fma_f32 v200, v20, -v164, v200
    v_fma_f32 v200, v21, -v165, v200
    v_mfma_f32_32x32x16_bf16 v[32:47], v[80:83], v[188:191], v[32:47]
    v_fma_f32 v200, v22, -v166, v200
    v_fma_f32 v200, v23, -v167, v200
    v_mul_f32_e64 v202, v24, -v160
    v_fma_f32 v202, v25, -v161, v202
    v_fma_f32 v202, v26, -v162, v202
    v_mfma_f32_32x32x16_bf16 v[48:63], v[84:87], v[188:191], v[48:63]
    v_fma_f32 v202, v27, -v163, v202
    v_fma_f32 v202, v28, -v164, v202
    v_fma_f32 v202, v29, -v165, v202
    v_fma_f32 v202, v30, -v166, v202
    v_fma_f32 v202, v31, -v167, v202
    s_waitcnt vmcnt(4) lgkmcnt(0)
    v_mfma_f32_32x32x16_bf16 v[0:15], v[64:67], v[176:179], 0
    v_mul_f32 v197, v32, v152
    v_fmac_f32 v197, v33, v153
    v_fmac_f32 v197, v34, v154
    v_fmac_f32 v197, v35, v155
    v_fmac_f32 v197, v36, v156
    v_fmac_f32 v197, v37, v157
    s_add_u32 m0, s21, 4096
    v_mfma_f32_32x32x16_bf16 v[16:31], v[68:71], v[176:179], 0
    buffer_load_dwordx4 v236, s[4:7], s37 offen  lds
    buffer_load_dwordx4 v237, s[8:11], s37 offen offset:1024  lds
    ds_read_b64_tr_b16 v[176:177], v244 offset:6144
    ds_read_b64_tr_b16 v[178:179], v244 offset:7168
    ds_read_b64_tr_b16 v[184:185], v245 offset:6144
    ds_read_b64_tr_b16 v[186:187], v245 offset:7168
    v_add_u32 v252, s43, v247
    ds_read_u16 v236, v252
    ds_read_u16 v237, v252 offset:64
    v_fmac_f32 v197, v38, v158
    v_fmac_f32 v197, v39, v159
    v_mul_f32 v199, v40, v120
    v_fmac_f32 v199, v41, v121
    v_fmac_f32 v199, v42, v122
    s_waitcnt vmcnt(4) lgkmcnt(2)
    v_mfma_f32_32x32x16_bf16 v[0:15], v[72:75], v[176:179], v[0:15]
    v_fmac_f32 v199, v43, v123
    v_fmac_f32 v199, v44, v124
    v_fmac_f32 v199, v45, v125
    v_fmac_f32 v199, v46, v126
    v_fmac_f32 v199, v47, v127
    s_add_u32 m0, s21, 6144
    v_mfma_f32_32x32x16_bf16 v[16:31], v[76:79], v[176:179], v[16:31]
    buffer_load_dwordx4 v238, s[4:7], s37 offen  lds
    buffer_load_dwordx4 v239, s[8:11], s37 offen offset:1024  lds
    ds_read_b64_tr_b16 v[176:177], v244 offset:0
    ds_read_b64_tr_b16 v[178:179], v244 offset:1024
    ds_read_b64_tr_b16 v[188:189], v245 offset:0
    ds_read_b64_tr_b16 v[190:191], v245 offset:1024
    v_add_u32 v252, s44, v247
    ds_read_u16 v238, v252
    ds_read_u16 v239, v252 offset:64
    v_mul_f32_e64 v201, v48, -v168
    v_fma_f32 v201, v49, -v169, v201
    v_fma_f32 v201, v50, -v170, v201
    v_fma_f32 v201, v51, -v171, v201
    v_fma_f32 v201, v52, -v172, v201
    v_fma_f32 v201, v53, -v173, v201
    s_waitcnt lgkmcnt(2)
    v_mfma_f32_32x32x16_bf16 v[0:15], v[80:83], v[176:179], v[0:15]
    v_fma_f32 v201, v54, -v174, v201
    v_fma_f32 v201, v55, -v175, v201
    v_mul_f32_e64 v203, v56, -v168
    v_fma_f32 v203, v57, -v169, v203
    v_fma_f32 v203, v58, -v170, v203
    s_add_u32 m0, s21, 0
    v_mfma_f32_32x32x16_bf16 v[16:31], v[84:87], v[176:179], v[16:31]
    v_lshl_add_u32 v234, v234, 10, v246
    v_lshl_add_u32 v235, v235, 10, v246
    buffer_load_dwordx4 v234, s[4:7], s38 offen  lds
    buffer_load_dwordx4 v235, s[8:11], s38 offen offset:1024  lds
    v_fma_f32 v203, v59, -v171, v203
    v_fma_f32 v203, v60, -v172, v203
    v_fma_f32 v203, v61, -v173, v203
    v_fma_f32 v203, v62, -v174, v203
    v_fma_f32 v203, v63, -v175, v203
    v_mfma_f32_32x32x16_bf16 v[32:47], v[64:67], v[180:183], 0
    v_mul_f32 v254, v0, v144
    v_fmac_f32 v254, v1, v145
    v_fmac_f32 v254, v2, v146
    v_mfma_f32_32x32x16_bf16 v[48:63], v[68:71], v[180:183], 0
    ds_swizzle_b32 v68, v68 offset:0x401F
    ds_swizzle_b32 v69, v69 offset:0x401F
    ds_swizzle_b32 v70, v70 offset:0x401F
    ds_swizzle_b32 v71, v71 offset:0x401F
    v_fmac_f32 v254, v3, v147
    v_fmac_f32 v254, v4, v148
    v_fmac_f32 v254, v5, v149
    v_mfma_f32_32x32x16_bf16 v[32:47], v[72:75], v[184:187], v[32:47]
    v_fmac_f32 v254, v6, v150
    v_fmac_f32 v254, v7, v151
    v_fmac_f32 v200, v8, v160
    v_mfma_f32_32x32x16_bf16 v[48:63], v[76:79], v[184:187], v[48:63]
    ds_swizzle_b32 v76, v76 offset:0x401F
    ds_swizzle_b32 v77, v77 offset:0x401F
    ds_swizzle_b32 v78, v78 offset:0x401F
    ds_swizzle_b32 v79, v79 offset:0x401F
    s_waitcnt vmcnt(6)
    ds_read_b64_tr_b16 v[176:177], v244 offset:2048
    ds_read_b64_tr_b16 v[178:179], v244 offset:3072
    ds_read_b64_tr_b16 v[180:181], v245 offset:2048
    ds_read_b64_tr_b16 v[182:183], v245 offset:3072
    v_fmac_f32 v200, v9, v161
    v_permlane32_swap_b32 v196, v254
    v_fmac_f32 v200, v10, v162
    v_mfma_f32_32x32x16_bf16 v[32:47], v[80:83], v[188:191], v[32:47]
    v_fmac_f32 v200, v11, v163
    v_fmac_f32 v200, v12, v164
    v_fmac_f32 v200, v13, v165
    v_mfma_f32_32x32x16_bf16 v[48:63], v[84:87], v[188:191], v[48:63]
    ds_swizzle_b32 v84, v84 offset:0x401F
    ds_swizzle_b32 v85, v85 offset:0x401F
    ds_swizzle_b32 v86, v86 offset:0x401F
    ds_swizzle_b32 v87, v87 offset:0x401F
    v_fmac_f32 v200, v14, v166
    v_fmac_f32 v200, v15, v167
    v_add_f32 v254, v196, v254
    s_waitcnt lgkmcnt(8)
    s_mov_b64 exec, s[56:57]
    v_xor_b32 v68, 0x80008000, v68
    v_xor_b32 v69, 0x80008000, v69
    v_xor_b32 v70, 0x80008000, v70
    v_xor_b32 v71, 0x80008000, v71
    v_xor_b32 v76, 0x80008000, v76
    v_xor_b32 v77, 0x80008000, v77
    v_xor_b32 v78, 0x80008000, v78
    v_xor_b32 v79, 0x80008000, v79
    s_mov_b64 exec, -1
    s_waitcnt vmcnt(4) lgkmcnt(4)
    v_mfma_f32_32x32x16_bf16 v[0:15], v[64:67], v[176:179], 0
    v_mul_f32 v255, v32, v152
    v_fmac_f32 v255, v33, v153
    v_fmac_f32 v255, v34, v154
    v_fmac_f32 v255, v35, v155
    s_add_u32 m0, s21, 2048
    v_mfma_f32_32x32x16_bf16 v[16:31], v[68:71], v[176:179], v[16:31]
    v_lshl_add_u32 v236, v236, 10, v246
    v_lshl_add_u32 v237, v237, 10, v246
    buffer_load_dwordx4 v236, s[4:7], s39 offen  lds
    buffer_load_dwordx4 v237, s[8:11], s39 offen offset:1024  lds
    ds_read_b64_tr_b16 v[176:177], v244 offset:4096
    ds_read_b64_tr_b16 v[178:179], v244 offset:5120
    ds_read_b64_tr_b16 v[184:185], v245 offset:4096
    ds_read_b64_tr_b16 v[186:187], v245 offset:5120
    v_fmac_f32 v255, v36, v156
    v_fmac_f32 v255, v37, v157
    v_fmac_f32 v255, v38, v158
    s_waitcnt vmcnt(4) lgkmcnt(0)
    v_mfma_f32_32x32x16_bf16 v[0:15], v[72:75], v[176:179], v[0:15]
    v_fmac_f32 v255, v39, v159
    v_fmac_f32 v201, v40, v168
    v_fmac_f32 v201, v41, v169
    s_add_u32 m0, s21, 4096
    v_mfma_f32_32x32x16_bf16 v[16:31], v[76:79], v[176:179], v[16:31]
    v_lshl_add_u32 v238, v238, 10, v246
    v_lshl_add_u32 v239, v239, 10, v246
    buffer_load_dwordx4 v238, s[4:7], s40 offen  lds
    buffer_load_dwordx4 v239, s[8:11], s40 offen offset:1024  lds
    ds_read_b64_tr_b16 v[176:177], v244 offset:6144
    ds_read_b64_tr_b16 v[178:179], v244 offset:7168
    ds_read_b64_tr_b16 v[188:189], v245 offset:6144
    ds_read_b64_tr_b16 v[190:191], v245 offset:7168
    v_permlane32_swap_b32 v197, v255
    v_fmac_f32 v201, v42, v170
    v_fmac_f32 v201, v43, v171
    s_waitcnt lgkmcnt(0)
    s_mov_b64 exec, s[56:57]
    v_xor_b32 v84, 0x80008000, v84
    v_xor_b32 v85, 0x80008000, v85
    v_xor_b32 v86, 0x80008000, v86
    v_xor_b32 v87, 0x80008000, v87
    s_mov_b64 exec, -1
    v_mfma_f32_32x32x16_bf16 v[0:15], v[80:83], v[176:179], v[0:15]
    v_fmac_f32 v201, v44, v172
    v_fmac_f32 v201, v45, v173
    v_fmac_f32 v201, v46, v174
    s_add_u32 m0, s21, 6144
    v_mfma_f32_32x32x16_bf16 v[16:31], v[84:87], v[176:179], v[16:31]
    v_lshl_add_u32 v240, v240, 10, v246
    v_lshl_add_u32 v241, v241, 10, v246
    buffer_load_dwordx4 v240, s[4:7], s41 offen  lds
    buffer_load_dwordx4 v241, s[8:11], s41 offen offset:1024  lds
    v_fmac_f32 v201, v47, v175
    v_add_f32 v255, v197, v255
    v_cvt_pk_bf16_f32 v194, v254, v255
    v_mfma_f32_32x32x16_bf16 v[32:47], v[64:67], v[180:183], 0
    v_mul_f32 v254, v0, v144
    v_fmac_f32 v254, v1, v145
    v_fmac_f32 v254, v2, v146
    v_fmac_f32 v254, v3, v147
    v_fmac_f32 v254, v4, v148
    v_fmac_f32 v254, v5, v149
    v_fmac_f32 v254, v6, v150
    v_mfma_f32_32x32x16_bf16 v[48:63], v[68:71], v[180:183], v[48:63]
    v_fmac_f32 v254, v7, v151
    v_fma_f32 v202, v8, -v160, v202
    v_fma_f32 v202, v9, -v161, v202
    v_permlane32_swap_b32 v254, v200
    v_fma_f32 v202, v10, -v162, v202
    v_fma_f32 v202, v11, -v163, v202
    v_mfma_f32_32x32x16_bf16 v[32:47], v[72:75], v[184:187], v[32:47]
    v_fma_f32 v202, v12, -v164, v202
    v_fma_f32 v202, v13, -v165, v202
    v_fma_f32 v202, v14, -v166, v202
    v_fma_f32 v202, v15, -v167, v202
    v_add_f32 v200, v254, v200
    v_fmac_f32 v198, v16, v112
    v_permlane32_swap_b32 v202, v254
    v_mfma_f32_32x32x16_bf16 v[48:63], v[76:79], v[184:187], v[48:63]
    s_waitcnt vmcnt(6)
    ds_read_b64_tr_b16 v[176:177], v244 offset:0
    ds_read_b64_tr_b16 v[178:179], v244 offset:1024
    ds_read_b64_tr_b16 v[180:181], v245 offset:0
    ds_read_b64_tr_b16 v[182:183], v245 offset:1024
    v_fmac_f32 v198, v17, v113
    v_fmac_f32 v198, v18, v114
    v_fmac_f32 v198, v19, v115
    v_fmac_f32 v198, v20, v116
    v_fmac_f32 v198, v21, v117
    v_fmac_f32 v198, v22, v118
    v_mfma_f32_32x32x16_bf16 v[32:47], v[80:83], v[188:191], v[32:47]
    v_fmac_f32 v198, v23, v119
    v_add_f32 v254, v202, v254
    v_mul_f32 v196, v24, v160
    v_fmac_f32 v196, v25, v161
    v_fmac_f32 v196, v26, v162
    v_fmac_f32 v196, v27, v163
    v_fmac_f32 v196, v28, v164
    v_mfma_f32_32x32x16_bf16 v[48:63], v[84:87], v[188:191], v[48:63]
    v_add_u32 v249, s48, v249
    v_add_u32 v250, s49, v250
    ds_read_b32 v252, v251 offset:16
    ds_read_b64_tr_b16 v[64:65], v249 offset:0
    ds_read_b64_tr_b16 v[68:69], v249 offset:64
    ds_read_b64_tr_b16 v[66:67], v249 offset:256
    ds_read_b64_tr_b16 v[70:71], v249 offset:320
    s_mov_b64 exec, s[54:55]
    ds_read_u16_d16_hi v242, v250 offset:0
    s_mov_b64 exec, -1
    v_fmac_f32 v196, v29, v165
    v_fmac_f32 v196, v30, v166
    v_fmac_f32 v196, v31, v167
    s_nop 1
    v_permlane32_swap_b32 v198, v196
    v_add_f32 v196, v198, v196
    v_mul_f32 v255, v32, v152
    v_fmac_f32 v255, v33, v153
    v_fmac_f32 v255, v34, v154
    v_fmac_f32 v255, v35, v155
    v_fmac_f32 v255, v36, v156
    v_fmac_f32 v255, v37, v157
    v_fmac_f32 v255, v38, v158
    v_fmac_f32 v255, v39, v159
    v_fma_f32 v203, v40, -v168, v203
    v_fma_f32 v203, v41, -v169, v203
    v_permlane32_swap_b32 v255, v201
    v_fma_f32 v203, v42, -v170, v203
    v_fma_f32 v203, v43, -v171, v203
    v_fma_f32 v203, v44, -v172, v203
    v_fma_f32 v203, v45, -v173, v203
    v_fma_f32 v203, v46, -v174, v203
    v_fma_f32 v203, v47, -v175, v203
    v_add_f32 v201, v255, v201
    v_fmac_f32 v199, v48, v120
    v_permlane32_swap_b32 v203, v255
    v_fmac_f32 v199, v49, v121
    v_fmac_f32 v199, v50, v122
    v_fmac_f32 v199, v51, v123
    v_fmac_f32 v199, v52, v124
    v_fmac_f32 v199, v53, v125
    v_fmac_f32 v199, v54, v126
    v_fmac_f32 v199, v55, v127
    v_add_f32 v255, v203, v255
    v_mul_f32 v197, v56, v168
    v_fmac_f32 v197, v57, v169
    v_fmac_f32 v197, v58, v170
    v_fmac_f32 v197, v59, v171
    v_fmac_f32 v197, v60, v172
    v_fmac_f32 v197, v61, v173
    v_fmac_f32 v197, v62, v174
    v_fmac_f32 v197, v63, v175
    s_nop 1
    v_permlane32_swap_b32 v199, v197
    v_add_f32 v197, v199, v197
    v_cvt_pk_bf16_f32 v200, v200, v201
    v_cvt_pk_bf16_f32 v254, v254, v255
    v_cvt_pk_bf16_f32 v196, v196, v197
    ds_write2st64_b32 v253, v192, v193 offset0:0 offset1:1
    ds_write2st64_b32 v253, v194, v200 offset0:2 offset1:3
    ds_write_b32 v253, v196 offset:1024
    s_mov_b64 exec, 0xffffffff
    ds_write_b32 v253, v254 offset:1280
    s_mov_b64 exec, -1
    s_add_u32 s50, s50, 1
    s_cmp_ge_u32 s50, 4
    s_cbranch_scc1 LAST1
    s_waitcnt lgkmcnt(9)
    v_readfirstlane_b32 s66, v252
    s_add_u32 s53, s53, 1
    v_mov_b32 v252, s53
    s_cmp_le_u32 s53, s66
    ds_write2_b32 v251, v252, v252 offset0:0 offset1:8
    s_setprio 1
    s_cbranch_scc1 PRIO_14
    s_setprio 0
PRIO_14:
    s_cmp_eq_u32 s52, 4
    s_cbranch_scc1 ITEM_1_4
    s_cmp_eq_u32 s52, 5
    s_cbranch_scc1 ITEM_1_5
    s_cmp_eq_u32 s52, 3
    s_cbranch_scc1 ITEM_1_3
    s_cmp_eq_u32 s52, 6
    s_cbranch_scc1 ITEM_1_6
    s_cmp_eq_u32 s52, 8
    s_cbranch_scc1 ITEM_1_8
    s_branch ITEM_1_2
.p2align 6
ITEM_1_8:
    s_mov_b64 exec, s[54:55]
    ds_read_u16_d16_hi v243, v250 offset:128
    s_mov_b64 exec, -1
    ds_read_b64_tr_b16 v[72:73], v249 offset:512
    ds_read_b64_tr_b16 v[76:77], v249 offset:576
    ds_read_b64_tr_b16 v[74:75], v249 offset:768
    ds_read_b64_tr_b16 v[78:79], v249 offset:832
    ds_read_b64_tr_b16 v[80:81], v249 offset:1024
    ds_read_b64_tr_b16 v[84:85], v249 offset:1088
    ds_read_b64_tr_b16 v[82:83], v249 offset:1280
    ds_read_b64_tr_b16 v[86:87], v249 offset:1344
    ds_read_b64_tr_b16 v[88:89], v249 offset:1536
    ds_read_b64_tr_b16 v[92:93], v249 offset:1600
    ds_read_b64_tr_b16 v[90:91], v249 offset:1792
    ds_read_b64_tr_b16 v[94:95], v249 offset:1856
    s_waitcnt lgkmcnt(13)
    v_mul_f32_dpp v196, v242, v64 row_newbcast:0 row_mask:0xf bank_mask:0xf
    v_mul_f32_dpp v197, v242, v65 row_newbcast:1 row_mask:0xf bank_mask:0xf
    v_mul_f32_dpp v198, v242, v64 row_newbcast:8 row_mask:0xf bank_mask:0xf
    v_mul_f32_dpp v199, v242, v65 row_newbcast:9 row_mask:0xf bank_mask:0xf
    v_mul_f32_dpp v200, v242, v68 row_newbcast:2 row_mask:0xf bank_mask:0xf
    v_mul_f32_dpp v201, v242, v69 row_newbcast:3 row_mask:0xf bank_mask:0xf
    v_mul_f32_dpp v202, v242, v68 row_newbcast:10 row_mask:0xf bank_mask:0xf
    v_mul_f32_dpp v203, v242, v69 row_newbcast:11 row_mask:0xf bank_mask:0xf
    v_cvt_pk_bf16_f32 v64, v196, v197
    v_cvt_pk_bf16_f32 v68, v198, v199
    v_cvt_pk_bf16_f32 v65, v200, v201
    v_cvt_pk_bf16_f32 v69, v202, v203
    v_mul_f32_dpp v196, v242, v66 row_newbcast:4 row_mask:0xf bank_mask:0xf
    v_mul_f32_dpp v197, v242, v67 row_newbcast:5 row_mask:0xf bank_mask:0xf
    v_mul_f32_dpp v198, v242, v66 row_newbcast:12 row_mask:0xf bank_mask:0xf
    v_mul_f32_dpp v199, v242, v67 row_newbcast:13 row_mask:0xf bank_mask:0xf
    v_mul_f32_dpp v200, v242, v70 row_newbcast:6 row_mask:0xf bank_mask:0xf
    v_mul_f32_dpp v201, v242, v71 row_newbcast:7 row_mask:0xf bank_mask:0xf
    v_mul_f32_dpp v202, v242, v70 row_newbcast:14 row_mask:0xf bank_mask:0xf
    v_mul_f32_dpp v203, v242, v71 row_newbcast:15 row_mask:0xf bank_mask:0xf
    v_cvt_pk_bf16_f32 v66, v196, v197
    v_cvt_pk_bf16_f32 v70, v198, v199
    v_cvt_pk_bf16_f32 v67, v200, v201
    v_cvt_pk_bf16_f32 v71, v202, v203
    s_mov_b64 exec, s[54:55]
    ds_read_u16_d16_hi v242, v250 offset:256
    s_mov_b64 exec, -1
    s_waitcnt vmcnt(4) lgkmcnt(9)
    v_mfma_f32_32x32x16_bf16 v[0:15], v[64:67], v[176:179], 0
    v_mul_f32_dpp v196, v243, v72 row_newbcast:0 row_mask:0xf bank_mask:0xf
    v_mul_f32_dpp v197, v243, v73 row_newbcast:1 row_mask:0xf bank_mask:0xf
    v_mul_f32_dpp v198, v243, v72 row_newbcast:8 row_mask:0xf bank_mask:0xf
    v_mul_f32_dpp v199, v243, v73 row_newbcast:9 row_mask:0xf bank_mask:0xf
    v_mul_f32_dpp v200, v243, v76 row_newbcast:2 row_mask:0xf bank_mask:0xf
    v_mul_f32_dpp v201, v243, v77 row_newbcast:3 row_mask:0xf bank_mask:0xf
    v_mul_f32_dpp v202, v243, v76 row_newbcast:10 row_mask:0xf bank_mask:0xf
    v_mul_f32_dpp v203, v243, v77 row_newbcast:11 row_mask:0xf bank_mask:0xf
    v_cvt_pk_bf16_f32 v72, v196, v197
    v_cvt_pk_bf16_f32 v76, v198, v199
    v_cvt_pk_bf16_f32 v73, v200, v201
    v_cvt_pk_bf16_f32 v77, v202, v203
    s_add_u32 m0, s21, 0
    v_mfma_f32_32x32x16_bf16 v[16:31], v[68:71], v[176:179], 0
    buffer_load_dwordx4 v234, s[4:7], s35 offen  lds
    buffer_load_dwordx4 v235, s[8:11], s35 offen offset:1024  lds
    ds_read_b64_tr_b16 v[176:177], v244 offset:2048
    ds_read_b64_tr_b16 v[178:179], v244 offset:3072
    ds_read_b64_tr_b16 v[184:185], v245 offset:2048
    ds_read_b64_tr_b16 v[186:187], v245 offset:3072
    v_mul_f32_dpp v196, v243, v74 row_newbcast:4 row_mask:0xf bank_mask:0xf
    v_mul_f32_dpp v197, v243, v75 row_newbcast:5 row_mask:0xf bank_mask:0xf
    v_mul_f32_dpp v198, v243, v74 row_newbcast:12 row_mask:0xf bank_mask:0xf
    v_mul_f32_dpp v199, v243, v75 row_newbcast:13 row_mask:0xf bank_mask:0xf
    v_mul_f32_dpp v200, v243, v78 row_newbcast:6 row_mask:0xf bank_mask:0xf
    v_mul_f32_dpp v201, v243, v79 row_newbcast:7 row_mask:0xf bank_mask:0xf
    v_mul_f32_dpp v202, v243, v78 row_newbcast:14 row_mask:0xf bank_mask:0xf
    v_mul_f32_dpp v203, v243, v79 row_newbcast:15 row_mask:0xf bank_mask:0xf
    v_cvt_pk_bf16_f32 v74, v196, v197
    v_cvt_pk_bf16_f32 v78, v198, v199
    v_cvt_pk_bf16_f32 v75, v200, v201
    v_cvt_pk_bf16_f32 v79, v202, v203
    s_mov_b64 exec, s[54:55]
    ds_read_u16_d16_hi v243, v250 offset:384
    s_mov_b64 exec, -1
    s_waitcnt vmcnt(4) lgkmcnt(1)
    v_mfma_f32_32x32x16_bf16 v[0:15], v[72:75], v[176:179], v[0:15]
    v_mul_f32_dpp v196, v242, v80 row_newbcast:0 row_mask:0xf bank_mask:0xf
    v_mul_f32_dpp v197, v242, v81 row_newbcast:1 row_mask:0xf bank_mask:0xf
    v_mul_f32_dpp v198, v242, v80 row_newbcast:8 row_mask:0xf bank_mask:0xf
    v_mul_f32_dpp v199, v242, v81 row_newbcast:9 row_mask:0xf bank_mask:0xf
    v_mul_f32_dpp v200, v242, v84 row_newbcast:2 row_mask:0xf bank_mask:0xf
    v_mul_f32_dpp v201, v242, v85 row_newbcast:3 row_mask:0xf bank_mask:0xf
    v_mul_f32_dpp v202, v242, v84 row_newbcast:10 row_mask:0xf bank_mask:0xf
    v_mul_f32_dpp v203, v242, v85 row_newbcast:11 row_mask:0xf bank_mask:0xf
    v_cvt_pk_bf16_f32 v80, v196, v197
    v_cvt_pk_bf16_f32 v84, v198, v199
    v_cvt_pk_bf16_f32 v81, v200, v201
    v_cvt_pk_bf16_f32 v85, v202, v203
    s_add_u32 m0, s21, 2048
    v_mfma_f32_32x32x16_bf16 v[16:31], v[76:79], v[176:179], v[16:31]
    buffer_load_dwordx4 v236, s[4:7], s35 offen  lds
    buffer_load_dwordx4 v237, s[8:11], s35 offen offset:1024  lds
    ds_read_b64_tr_b16 v[176:177], v244 offset:4096
    ds_read_b64_tr_b16 v[178:179], v244 offset:5120
    ds_read_b64_tr_b16 v[188:189], v245 offset:4096
    ds_read_b64_tr_b16 v[190:191], v245 offset:5120
    v_mul_f32_dpp v196, v242, v82 row_newbcast:4 row_mask:0xf bank_mask:0xf
    v_mul_f32_dpp v197, v242, v83 row_newbcast:5 row_mask:0xf bank_mask:0xf
    v_mul_f32_dpp v198, v242, v82 row_newbcast:12 row_mask:0xf bank_mask:0xf
    v_mul_f32_dpp v199, v242, v83 row_newbcast:13 row_mask:0xf bank_mask:0xf
    v_mul_f32_dpp v200, v242, v86 row_newbcast:6 row_mask:0xf bank_mask:0xf
    v_mul_f32_dpp v201, v242, v87 row_newbcast:7 row_mask:0xf bank_mask:0xf
    v_mul_f32_dpp v202, v242, v86 row_newbcast:14 row_mask:0xf bank_mask:0xf
    v_mul_f32_dpp v203, v242, v87 row_newbcast:15 row_mask:0xf bank_mask:0xf
    v_cvt_pk_bf16_f32 v82, v196, v197
    v_cvt_pk_bf16_f32 v86, v198, v199
    v_cvt_pk_bf16_f32 v83, v200, v201
    v_cvt_pk_bf16_f32 v87, v202, v203
    s_nop 0
    s_waitcnt vmcnt(4) lgkmcnt(0)
    v_mfma_f32_32x32x16_bf16 v[0:15], v[80:83], v[176:179], v[0:15]
    v_mul_f32_dpp v196, v243, v88 row_newbcast:0 row_mask:0xf bank_mask:0xf
    v_mul_f32_dpp v197, v243, v89 row_newbcast:1 row_mask:0xf bank_mask:0xf
    v_mul_f32_dpp v198, v243, v88 row_newbcast:8 row_mask:0xf bank_mask:0xf
    v_mul_f32_dpp v199, v243, v89 row_newbcast:9 row_mask:0xf bank_mask:0xf
    v_mul_f32_dpp v200, v243, v92 row_newbcast:2 row_mask:0xf bank_mask:0xf
    v_mul_f32_dpp v201, v243, v93 row_newbcast:3 row_mask:0xf bank_mask:0xf
    v_mul_f32_dpp v202, v243, v92 row_newbcast:10 row_mask:0xf bank_mask:0xf
    v_mul_f32_dpp v203, v243, v93 row_newbcast:11 row_mask:0xf bank_mask:0xf
    v_cvt_pk_bf16_f32 v88, v196, v197
    v_cvt_pk_bf16_f32 v92, v198, v199
    v_cvt_pk_bf16_f32 v89, v200, v201
    v_cvt_pk_bf16_f32 v93, v202, v203
    s_add_u32 m0, s21, 4096
    v_mfma_f32_32x32x16_bf16 v[16:31], v[84:87], v[176:179], v[16:31]
    buffer_load_dwordx4 v238, s[4:7], s35 offen  lds
    buffer_load_dwordx4 v239, s[8:11], s35 offen offset:1024  lds
    ds_read_b64_tr_b16 v[176:177], v244 offset:6144
    ds_read_b64_tr_b16 v[178:179], v244 offset:7168
    ds_read_b64_tr_b16 v[192:193], v245 offset:6144
    ds_read_b64_tr_b16 v[194:195], v245 offset:7168
    v_mul_f32_dpp v196, v243, v90 row_newbcast:4 row_mask:0xf bank_mask:0xf
    v_mul_f32_dpp v197, v243, v91 row_newbcast:5 row_mask:0xf bank_mask:0xf
    v_mul_f32_dpp v198, v243, v90 row_newbcast:12 row_mask:0xf bank_mask:0xf
    v_mul_f32_dpp v199, v243, v91 row_newbcast:13 row_mask:0xf bank_mask:0xf
    v_mul_f32_dpp v200, v243, v94 row_newbcast:6 row_mask:0xf bank_mask:0xf
    v_mul_f32_dpp v201, v243, v95 row_newbcast:7 row_mask:0xf bank_mask:0xf
    v_mul_f32_dpp v202, v243, v94 row_newbcast:14 row_mask:0xf bank_mask:0xf
    v_mul_f32_dpp v203, v243, v95 row_newbcast:15 row_mask:0xf bank_mask:0xf
    v_cvt_pk_bf16_f32 v90, v196, v197
    v_cvt_pk_bf16_f32 v94, v198, v199
    v_cvt_pk_bf16_f32 v91, v200, v201
    v_cvt_pk_bf16_f32 v95, v202, v203
    s_nop 0
    s_waitcnt lgkmcnt(0)
    v_mfma_f32_32x32x16_bf16 v[0:15], v[88:91], v[176:179], v[0:15]
    s_add_u32 m0, s21, 6144
    v_mfma_f32_32x32x16_bf16 v[16:31], v[92:95], v[176:179], v[16:31]
    buffer_load_dwordx4 v240, s[4:7], s35 offen  lds
    buffer_load_dwordx4 v241, s[8:11], s35 offen offset:1024  lds
    s_mov_b32 m0, s50
    s_nop 0
    s_movrels_b32 s71, s23
    s_movrels_b32 s33, s28
    s_and_b32 s70, s33, 0x70
    s_andn2_b32 s33, s33, 0x70
    v_xor_b32 v253, s70, v248
    v_add_u32 v253, s33, v253
    s_bfe_u32 s46, s71, 0x30012
    s_mov_b32 m0, s46
    s_and_b32 s66, s71, 0x3ffff
    s_movrels_b32 s68, s57
    s_movrels_b32 s69, s61
    s_sub_u32 s48, s66, s47
    s_mov_b32 s47, s66
    s_lshr_b32 s52, s71, 28
    s_lshl_b32 s67, s46, 9
    s_add_u32 s66, s66, s67
    s_sub_u32 s49, s66, s42
    s_mov_b32 s42, s66
    s_bfe_u32 s66, s68, 655360
    s_add_u32 s43, s42, s66
    s_bfe_u32 s39, s69, 655360
    s_bfe_u32 s66, s68, 655370
    s_add_u32 s44, s42, s66
    s_bfe_u32 s40, s69, 655370
    s_bfe_u32 s66, s68, 655380
    s_add_u32 s45, s42, s66
    s_bfe_u32 s41, s69, 655380
    v_mfma_f32_32x32x16_bf16 v[32:47], v[64:67], v[180:183], 0
    v_mul_f32 v196, v0, v96
    v_fmac_f32 v196, v1, v97
    v_fmac_f32 v196, v2, v98
    v_fmac_f32 v196, v3, v99
    v_fmac_f32 v196, v4, v100
    v_mfma_f32_32x32x16_bf16 v[48:63], v[68:71], v[180:183], 0
    v_fmac_f32 v196, v5, v101
    v_fmac_f32 v196, v6, v102
    v_fmac_f32 v196, v7, v103
    v_mul_f32 v198, v8, v128
    v_fmac_f32 v198, v9, v129
    v_mfma_f32_32x32x16_bf16 v[32:47], v[72:75], v[184:187], v[32:47]
    v_fmac_f32 v198, v10, v130
    v_fmac_f32 v198, v11, v131
    v_fmac_f32 v198, v12, v132
    v_fmac_f32 v198, v13, v133
    v_mfma_f32_32x32x16_bf16 v[48:63], v[76:79], v[184:187], v[48:63]
    v_fmac_f32 v198, v14, v134
    v_fmac_f32 v198, v15, v135
    v_mul_f32 v200, v16, v128
    v_fmac_f32 v200, v17, v129
    v_permlane32_swap_b32 v196, v198
    v_mfma_f32_32x32x16_bf16 v[32:47], v[80:83], v[188:191], v[32:47]
    v_fmac_f32 v200, v18, v130
    v_fmac_f32 v200, v19, v131
    v_fmac_f32 v200, v20, v132
    v_fmac_f32 v200, v21, v133
    v_fmac_f32 v200, v22, v134
    v_mfma_f32_32x32x16_bf16 v[48:63], v[84:87], v[188:191], v[48:63]
    s_waitcnt vmcnt(6)
    ds_read_b64_tr_b16 v[176:177], v244 offset:0
    ds_read_b64_tr_b16 v[178:179], v244 offset:1024
    ds_read_b64_tr_b16 v[180:181], v245 offset:0
    ds_read_b64_tr_b16 v[182:183], v245 offset:1024
    v_fmac_f32 v200, v23, v135
    v_add_f32 v198, v196, v198
    v_mul_f32_e64 v202, v24, -v128
    v_fma_f32 v202, v25, -v129, v202
    v_mfma_f32_32x32x16_bf16 v[32:47], v[88:91], v[192:195], v[32:47]
    v_fma_f32 v202, v26, -v130, v202
    v_fma_f32 v202, v27, -v131, v202
    v_fma_f32 v202, v28, -v132, v202
    v_fma_f32 v202, v29, -v133, v202
    v_fma_f32 v202, v30, -v134, v202
    v_mfma_f32_32x32x16_bf16 v[48:63], v[92:95], v[192:195], v[48:63]
    v_fma_f32 v202, v31, -v135, v202
    s_nop 1
    v_permlane32_swap_b32 v200, v202
    v_add_f32 v202, v200, v202
    s_waitcnt vmcnt(4) lgkmcnt(0)
    v_mfma_f32_32x32x16_bf16 v[0:15], v[64:67], v[176:179], 0
    v_mul_f32 v197, v32, v104
    v_fmac_f32 v197, v33, v105
    v_fmac_f32 v197, v34, v106
    v_fmac_f32 v197, v35, v107
    v_fmac_f32 v197, v36, v108
    s_add_u32 m0, s21, 0
    v_mfma_f32_32x32x16_bf16 v[16:31], v[68:71], v[176:179], 0
    buffer_load_dwordx4 v234, s[4:7], s36 offen  lds
    buffer_load_dwordx4 v235, s[8:11], s36 offen offset:1024  lds
    ds_read_b64_tr_b16 v[176:177], v244 offset:2048
    ds_read_b64_tr_b16 v[178:179], v244 offset:3072
    ds_read_b64_tr_b16 v[184:185], v245 offset:2048
    ds_read_b64_tr_b16 v[186:187], v245 offset:3072
    v_fmac_f32 v197, v37, v109
    v_fmac_f32 v197, v38, v110
    v_fmac_f32 v197, v39, v111
    v_mul_f32 v199, v40, v136
    v_fmac_f32 v199, v41, v137
    s_waitcnt vmcnt(4) lgkmcnt(0)
    v_mfma_f32_32x32x16_bf16 v[0:15], v[72:75], v[176:179], v[0:15]
    v_fmac_f32 v199, v42, v138
    v_fmac_f32 v199, v43, v139
    v_fmac_f32 v199, v44, v140
    v_fmac_f32 v199, v45, v141
    v_fmac_f32 v199, v46, v142
    s_add_u32 m0, s21, 2048
    v_mfma_f32_32x32x16_bf16 v[16:31], v[76:79], v[176:179], v[16:31]
    buffer_load_dwordx4 v236, s[4:7], s36 offen  lds
    buffer_load_dwordx4 v237, s[8:11], s36 offen offset:1024  lds
    ds_read_b64_tr_b16 v[176:177], v244 offset:4096
    ds_read_b64_tr_b16 v[178:179], v244 offset:5120
    ds_read_b64_tr_b16 v[188:189], v245 offset:4096
    ds_read_b64_tr_b16 v[190:191], v245 offset:5120
    v_fmac_f32 v199, v47, v143
    v_mul_f32 v201, v48, v136
    v_fmac_f32 v201, v49, v137
    v_permlane32_swap_b32 v197, v199
    v_fmac_f32 v201, v50, v138
    s_waitcnt vmcnt(4) lgkmcnt(0)
    v_mfma_f32_32x32x16_bf16 v[0:15], v[80:83], v[176:179], v[0:15]
    v_fmac_f32 v201, v51, v139
    v_fmac_f32 v201, v52, v140
    v_fmac_f32 v201, v53, v141
    v_fmac_f32 v201, v54, v142
    v_fmac_f32 v201, v55, v143
    s_add_u32 m0, s21, 4096
    v_mfma_f32_32x32x16_bf16 v[16:31], v[84:87], v[176:179], v[16:31]
    buffer_load_dwordx4 v238, s[4:7], s36 offen  lds
    buffer_load_dwordx4 v239, s[8:11], s36 offen offset:1024  lds
    ds_read_b64_tr_b16 v[176:177], v244 offset:6144
    ds_read_b64_tr_b16 v[178:179], v244 offset:7168
    ds_read_b64_tr_b16 v[192:193], v245 offset:6144
    ds_read_b64_tr_b16 v[194:195], v245 offset:7168
    v_add_f32 v199, v197, v199
    v_mul_f32_e64 v203, v56, -v136
    v_fma_f32 v203, v57, -v137, v203
    v_fma_f32 v203, v58, -v138, v203
    v_fma_f32 v203, v59, -v139, v203
    s_waitcnt lgkmcnt(0)
    v_mfma_f32_32x32x16_bf16 v[0:15], v[88:91], v[176:179], v[0:15]
    v_fma_f32 v203, v60, -v140, v203
    v_fma_f32 v203, v61, -v141, v203
    v_fma_f32 v203, v62, -v142, v203
    v_fma_f32 v203, v63, -v143, v203
    s_nop 1
    s_add_u32 m0, s21, 6144
    v_mfma_f32_32x32x16_bf16 v[16:31], v[92:95], v[176:179], v[16:31]
    buffer_load_dwordx4 v240, s[4:7], s36 offen  lds
    buffer_load_dwordx4 v241, s[8:11], s36 offen offset:1024  lds
    v_permlane32_swap_b32 v201, v203
    v_add_f32 v203, v201, v203
    v_cvt_pk_bf16_f32 v198, v198, v199
    v_cvt_pk_bf16_f32 v202, v202, v203
    ds_write2st64_b32 v253, v198, v202 offset0:0 offset1:1
    v_mfma_f32_32x32x16_bf16 v[32:47], v[64:67], v[180:183], 0
    v_mul_f32 v196, v0, v144
    v_fmac_f32 v196, v1, v145
    v_fmac_f32 v196, v2, v146
    v_fmac_f32 v196, v3, v147
    v_mfma_f32_32x32x16_bf16 v[48:63], v[68:71], v[180:183], 0
    v_fmac_f32 v196, v4, v148
    v_fmac_f32 v196, v5, v149
    v_fmac_f32 v196, v6, v150
    v_fmac_f32 v196, v7, v151
    v_mfma_f32_32x32x16_bf16 v[32:47], v[72:75], v[184:187], v[32:47]
    v_mul_f32 v198, v8, v112
    v_fmac_f32 v198, v9, v113
    v_fmac_f32 v198, v10, v114
    v_fmac_f32 v198, v11, v115
    v_mfma_f32_32x32x16_bf16 v[48:63], v[76:79], v[184:187], v[48:63]
    v_fmac_f32 v198, v12, v116
    v_fmac_f32 v198, v13, v117
    v_fmac_f32 v198, v14, v118
    v_fmac_f32 v198, v15, v119
    v_mfma_f32_32x32x16_bf16 v[32:47], v[80:83], v[188:191], v[32:47]
    v_mul_f32_e64 v200, v16, -v160
    v_fma_f32 v200, v17, -v161, v200
    v_fma_f32 v200, v18, -v162, v200
    v_fma_f32 v200, v19, -v163, v200
    v_mfma_f32_32x32x16_bf16 v[48:63], v[84:87], v[188:191], v[48:63]
    s_waitcnt vmcnt(6)
    ds_read_b64_tr_b16 v[176:177], v244 offset:0
    ds_read_b64_tr_b16 v[178:179], v244 offset:1024
    ds_read_b64_tr_b16 v[180:181], v245 offset:0
    ds_read_b64_tr_b16 v[182:183], v245 offset:1024
    v_fma_f32 v200, v20, -v164, v200
    v_fma_f32 v200, v21, -v165, v200
    v_fma_f32 v200, v22, -v166, v200
    v_fma_f32 v200, v23, -v167, v200
    v_mfma_f32_32x32x16_bf16 v[32:47], v[88:91], v[192:195], v[32:47]
    v_mul_f32_e64 v202, v24, -v160
    v_fma_f32 v202, v25, -v161, v202
    v_fma_f32 v202, v26, -v162, v202
    v_fma_f32 v202, v27, -v163, v202
    v_mfma_f32_32x32x16_bf16 v[48:63], v[92:95], v[192:195], v[48:63]
    v_fma_f32 v202, v28, -v164, v202
    v_fma_f32 v202, v29, -v165, v202
    v_fma_f32 v202, v30, -v166, v202
    v_fma_f32 v202, v31, -v167, v202
    s_waitcnt vmcnt(4) lgkmcnt(0)
    v_mfma_f32_32x32x16_bf16 v[0:15], v[64:67], v[176:179], 0
    s_nop 0
    v_mul_f32 v197, v32, v152
    v_fmac_f32 v197, v33, v153
    v_fmac_f32 v197, v34, v154
    v_fmac_f32 v197, v35, v155
    s_add_u32 m0, s21, 0
    v_mfma_f32_32x32x16_bf16 v[16:31], v[68:71], v[176:179], 0
    buffer_load_dwordx4 v234, s[4:7], s37 offen  lds
    buffer_load_dwordx4 v235, s[8:11], s37 offen offset:1024  lds
    ds_read_b64_tr_b16 v[176:177], v244 offset:2048
    ds_read_b64_tr_b16 v[178:179], v244 offset:3072
    ds_read_b64_tr_b16 v[184:185], v245 offset:2048
    ds_read_b64_tr_b16 v[186:187], v245 offset:3072
    v_add_u32 v252, s42, v247
    ds_read_u16 v234, v252
    ds_read_u16 v235, v252 offset:64
    v_fmac_f32 v197, v36, v156
    v_fmac_f32 v197, v37, v157
    v_fmac_f32 v197, v38, v158
    v_fmac_f32 v197, v39, v159
    s_waitcnt vmcnt(4) lgkmcnt(2)
    v_mfma_f32_32x32x16_bf16 v[0:15], v[72:75], v[176:179], v[0:15]
    v_mul_f32 v199, v40, v120
    v_fmac_f32 v199, v41, v121
    v_fmac_f32 v199, v42, v122
    v_fmac_f32 v199, v43, v123
    s_add_u32 m0, s21, 2048
    v_mfma_f32_32x32x16_bf16 v[16:31], v[76:79], v[176:179], v[16:31]
    buffer_load_dwordx4 v236, s[4:7], s37 offen  lds
    buffer_load_dwordx4 v237, s[8:11], s37 offen offset:1024  lds
    ds_read_b64_tr_b16 v[176:177], v244 offset:4096
    ds_read_b64_tr_b16 v[178:179], v244 offset:5120
    ds_read_b64_tr_b16 v[188:189], v245 offset:4096
    ds_read_b64_tr_b16 v[190:191], v245 offset:5120
    v_add_u32 v252, s43, v247
    ds_read_u16 v236, v252
    ds_read_u16 v237, v252 offset:64
    v_fmac_f32 v199, v44, v124
    v_fmac_f32 v199, v45, v125
    v_fmac_f32 v199, v46, v126
    v_fmac_f32 v199, v47, v127
    s_waitcnt vmcnt(4) lgkmcnt(2)
    v_mfma_f32_32x32x16_bf16 v[0:15], v[80:83], v[176:179], v[0:15]
    v_mul_f32_e64 v201, v48, -v168
    v_fma_f32 v201, v49, -v169, v201
    v_fma_f32 v201, v50, -v170, v201
    v_fma_f32 v201, v51, -v171, v201
    s_add_u32 m0, s21, 4096
    v_mfma_f32_32x32x16_bf16 v[16:31], v[84:87], v[176:179], v[16:31]
    buffer_load_dwordx4 v238, s[4:7], s37 offen  lds
    buffer_load_dwordx4 v239, s[8:11], s37 offen offset:1024  lds
    ds_read_b64_tr_b16 v[176:177], v244 offset:6144
    ds_read_b64_tr_b16 v[178:179], v244 offset:7168
    ds_read_b64_tr_b16 v[192:193], v245 offset:6144
    ds_read_b64_tr_b16 v[194:195], v245 offset:7168
    v_add_u32 v252, s44, v247
    ds_read_u16 v238, v252
    ds_read_u16 v239, v252 offset:64
    v_fma_f32 v201, v52, -v172, v201
    v_fma_f32 v201, v53, -v173, v201
    v_fma_f32 v201, v54, -v174, v201
    v_fma_f32 v201, v55, -v175, v201
    s_waitcnt lgkmcnt(2)
    v_mfma_f32_32x32x16_bf16 v[0:15], v[88:91], v[176:179], v[0:15]
    v_mul_f32_e64 v203, v56, -v168
    v_fma_f32 v203, v57, -v169, v203
    v_fma_f32 v203, v58, -v170, v203
    v_fma_f32 v203, v59, -v171, v203
    s_add_u32 m0, s21, 6144
    v_mfma_f32_32x32x16_bf16 v[16:31], v[92:95], v[176:179], v[16:31]
    buffer_load_dwordx4 v240, s[4:7], s37 offen  lds
    buffer_load_dwordx4 v241, s[8:11], s37 offen offset:1024  lds
    v_add_u32 v252, s45, v247
    ds_read_u16 v240, v252
    ds_read_u16 v241, v252 offset:64
    v_fma_f32 v203, v60, -v172, v203
    v_fma_f32 v203, v61, -v173, v203
    v_fma_f32 v203, v62, -v174, v203
    v_fma_f32 v203, v63, -v175, v203
    v_mfma_f32_32x32x16_bf16 v[32:47], v[64:67], v[180:183], 0
    v_mul_f32 v254, v0, v144
    v_fmac_f32 v254, v1, v145
    v_fmac_f32 v254, v2, v146
    v_mfma_f32_32x32x16_bf16 v[48:63], v[68:71], v[180:183], 0
    ds_swizzle_b32 v68, v68 offset:0x401F
    ds_swizzle_b32 v69, v69 offset:0x401F
    ds_swizzle_b32 v70, v70 offset:0x401F
    ds_swizzle_b32 v71, v71 offset:0x401F
    v_fmac_f32 v254, v3, v147
    v_fmac_f32 v254, v4, v148
    v_mfma_f32_32x32x16_bf16 v[32:47], v[72:75], v[184:187], v[32:47]
    v_fmac_f32 v254, v5, v149
    v_fmac_f32 v254, v6, v150
    v_mfma_f32_32x32x16_bf16 v[48:63], v[76:79], v[184:187], v[48:63]
    ds_swizzle_b32 v76, v76 offset:0x401F
    ds_swizzle_b32 v77, v77 offset:0x401F
    ds_swizzle_b32 v78, v78 offset:0x401F
    ds_swizzle_b32 v79, v79 offset:0x401F
    v_fmac_f32 v254, v7, v151
    v_fmac_f32 v200, v8, v160
    v_mfma_f32_32x32x16_bf16 v[32:47], v[80:83], v[188:191], v[32:47]
    v_fmac_f32 v200, v9, v161
    v_permlane32_swap_b32 v196, v254
    v_fmac_f32 v200, v10, v162
    v_mfma_f32_32x32x16_bf16 v[48:63], v[84:87], v[188:191], v[48:63]
    ds_swizzle_b32 v84, v84 offset:0x401F
    ds_swizzle_b32 v85, v85 offset:0x401F
    ds_swizzle_b32 v86, v86 offset:0x401F
    ds_swizzle_b32 v87, v87 offset:0x401F
    s_waitcnt vmcnt(6)
    ds_read_b64_tr_b16 v[176:177], v244 offset:0
    ds_read_b64_tr_b16 v[178:179], v244 offset:1024
    ds_read_b64_tr_b16 v[180:181], v245 offset:0
    ds_read_b64_tr_b16 v[182:183], v245 offset:1024
    v_fmac_f32 v200, v11, v163
    v_fmac_f32 v200, v12, v164
    v_mfma_f32_32x32x16_bf16 v[32:47], v[88:91], v[192:195], v[32:47]
    v_fmac_f32 v200, v13, v165
    v_fmac_f32 v200, v14, v166
    v_mfma_f32_32x32x16_bf16 v[48:63], v[92:95], v[192:195], v[48:63]
    ds_swizzle_b32 v92, v92 offset:0x401F
    ds_swizzle_b32 v93, v93 offset:0x401F
    ds_swizzle_b32 v94, v94 offset:0x401F
    ds_swizzle_b32 v95, v95 offset:0x401F
    v_fmac_f32 v200, v15, v167
    v_add_f32 v254, v196, v254
    s_waitcnt lgkmcnt(8)
    s_mov_b64 exec, s[56:57]
    v_xor_b32 v68, 0x80008000, v68
    v_xor_b32 v69, 0x80008000, v69
    v_xor_b32 v70, 0x80008000, v70
    v_xor_b32 v71, 0x80008000, v71
    v_xor_b32 v76, 0x80008000, v76
    v_xor_b32 v77, 0x80008000, v77
    v_xor_b32 v78, 0x80008000, v78
    v_xor_b32 v79, 0x80008000, v79
    v_xor_b32 v84, 0x80008000, v84
    v_xor_b32 v85, 0x80008000, v85
    v_xor_b32 v86, 0x80008000, v86
    v_xor_b32 v87, 0x80008000, v87
    s_mov_b64 exec, -1
    s_waitcnt vmcnt(4) lgkmcnt(4)
    v_mfma_f32_32x32x16_bf16 v[0:15], v[64:67], v[176:179], 0
    v_mul_f32 v255, v32, v152
    v_fmac_f32 v255, v33, v153
    v_fmac_f32 v255, v34, v154
    s_add_u32 m0, s21, 0
    v_mfma_f32_32x32x16_bf16 v[16:31], v[68:71], v[176:179], v[16:31]
    v_lshl_add_u32 v234, v234, 10, v246
    v_lshl_add_u32 v235, v235, 10, v246
    buffer_load_dwordx4 v234, s[4:7], s38 offen  lds
    buffer_load_dwordx4 v235, s[8:11], s38 offen offset:1024  lds
    ds_read_b64_tr_b16 v[176:177], v244 offset:2048
    ds_read_b64_tr_b16 v[178:179], v244 offset:3072
    ds_read_b64_tr_b16 v[184:185], v245 offset:2048
    ds_read_b64_tr_b16 v[186:187], v245 offset:3072
    v_fmac_f32 v255, v35, v155
    v_fmac_f32 v255, v36, v156
    s_waitcnt vmcnt(4) lgkmcnt(0)
    v_mfma_f32_32x32x16_bf16 v[0:15], v[72:75], v[176:179], v[0:15]
    v_fmac_f32 v255, v37, v157
    v_fmac_f32 v255, v38, v158
    v_fmac_f32 v255, v39, v159
    s_add_u32 m0, s21, 2048
    v_mfma_f32_32x32x16_bf16 v[16:31], v[76:79], v[176:179], v[16:31]
    v_lshl_add_u32 v236, v236, 10, v246
    v_lshl_add_u32 v237, v237, 10, v246
    buffer_load_dwordx4 v236, s[4:7], s39 offen  lds
    buffer_load_dwordx4 v237, s[8:11], s39 offen offset:1024  lds
    ds_read_b64_tr_b16 v[176:177], v244 offset:4096
    ds_read_b64_tr_b16 v[178:179], v244 offset:5120
    ds_read_b64_tr_b16 v[188:189], v245 offset:4096
    ds_read_b64_tr_b16 v[190:191], v245 offset:5120
    v_fmac_f32 v201, v40, v168
    v_fmac_f32 v201, v41, v169
    s_waitcnt vmcnt(4) lgkmcnt(0)
    v_mfma_f32_32x32x16_bf16 v[0:15], v[80:83], v[176:179], v[0:15]
    v_permlane32_swap_b32 v197, v255
    v_fmac_f32 v201, v42, v170
    v_fmac_f32 v201, v43, v171
    s_add_u32 m0, s21, 4096
    v_mfma_f32_32x32x16_bf16 v[16:31], v[84:87], v[176:179], v[16:31]
    v_lshl_add_u32 v238, v238, 10, v246
    v_lshl_add_u32 v239, v239, 10, v246
    buffer_load_dwordx4 v238, s[4:7], s40 offen  lds
    buffer_load_dwordx4 v239, s[8:11], s40 offen offset:1024  lds
    ds_read_b64_tr_b16 v[176:177], v244 offset:6144
    ds_read_b64_tr_b16 v[178:179], v244 offset:7168
    ds_read_b64_tr_b16 v[192:193], v245 offset:6144
    ds_read_b64_tr_b16 v[194:195], v245 offset:7168
    v_fmac_f32 v201, v44, v172
    v_fmac_f32 v201, v45, v173
    s_waitcnt lgkmcnt(0)
    s_mov_b64 exec, s[56:57]
    v_xor_b32 v92, 0x80008000, v92
    v_xor_b32 v93, 0x80008000, v93
    v_xor_b32 v94, 0x80008000, v94
    v_xor_b32 v95, 0x80008000, v95
    s_mov_b64 exec, -1
    v_mfma_f32_32x32x16_bf16 v[0:15], v[88:91], v[176:179], v[0:15]
    v_fmac_f32 v201, v46, v174
    v_fmac_f32 v201, v47, v175
    v_add_f32 v255, v197, v255
    s_add_u32 m0, s21, 6144
    v_mfma_f32_32x32x16_bf16 v[16:31], v[92:95], v[176:179], v[16:31]
    v_lshl_add_u32 v240, v240, 10, v246
    v_lshl_add_u32 v241, v241, 10, v246
    buffer_load_dwordx4 v240, s[4:7], s41 offen  lds
    buffer_load_dwordx4 v241, s[8:11], s41 offen offset:1024  lds
    v_cvt_pk_bf16_f32 v254, v254, v255
    ds_write_b32 v253, v254 offset:512
    v_mfma_f32_32x32x16_bf16 v[32:47], v[64:67], v[180:183], 0
    v_mul_f32 v254, v0, v144
    v_fmac_f32 v254, v1, v145
    v_fmac_f32 v254, v2, v146
    v_fmac_f32 v254, v3, v147
    v_fmac_f32 v254, v4, v148
    v_mfma_f32_32x32x16_bf16 v[48:63], v[68:71], v[180:183], v[48:63]
    v_fmac_f32 v254, v5, v149
    v_fmac_f32 v254, v6, v150
    v_fmac_f32 v254, v7, v151
    v_fma_f32 v202, v8, -v160, v202
    v_fma_f32 v202, v9, -v161, v202
    v_mfma_f32_32x32x16_bf16 v[32:47], v[72:75], v[184:187], v[32:47]
    v_permlane32_swap_b32 v254, v200
    v_fma_f32 v202, v10, -v162, v202
    v_fma_f32 v202, v11, -v163, v202
    v_fma_f32 v202, v12, -v164, v202
    v_fma_f32 v202, v13, -v165, v202
    v_mfma_f32_32x32x16_bf16 v[48:63], v[76:79], v[184:187], v[48:63]
    v_fma_f32 v202, v14, -v166, v202
    v_fma_f32 v202, v15, -v167, v202
    v_add_f32 v200, v254, v200
    v_fmac_f32 v198, v16, v112
    v_permlane32_swap_b32 v202, v254
    v_mfma_f32_32x32x16_bf16 v[32:47], v[80:83], v[188:191], v[32:47]
    v_fmac_f32 v198, v17, v113
    v_fmac_f32 v198, v18, v114
    v_fmac_f32 v198, v19, v115
    v_fmac_f32 v198, v20, v116
    v_fmac_f32 v198, v21, v117
    v_mfma_f32_32x32x16_bf16 v[48:63], v[84:87], v[188:191], v[48:63]
    s_waitcnt vmcnt(6)
    ds_read_b64_tr_b16 v[176:177], v244 offset:0
    ds_read_b64_tr_b16 v[178:179], v244 offset:1024
    ds_read_b64_tr_b16 v[180:181], v245 offset:0
    ds_read_b64_tr_b16 v[182:183], v245 offset:1024
    v_fmac_f32 v198, v22, v118
    v_fmac_f32 v198, v23, v119
    v_add_f32 v254, v202, v254
    v_mul_f32 v196, v24, v160
    v_fmac_f32 v196, v25, v161
    v_mfma_f32_32x32x16_bf16 v[32:47], v[88:91], v[192:195], v[32:47]
    v_fmac_f32 v196, v26, v162
    v_fmac_f32 v196, v27, v163
    v_fmac_f32 v196, v28, v164
    v_fmac_f32 v196, v29, v165
    v_fmac_f32 v196, v30, v166
    v_mfma_f32_32x32x16_bf16 v[48:63], v[92:95], v[192:195], v[48:63]
    v_add_u32 v249, s48, v249
    v_add_u32 v250, s49, v250
    ds_read_b32 v252, v251 offset:16
    ds_read_b64_tr_b16 v[64:65], v249 offset:0
    ds_read_b64_tr_b16 v[68:69], v249 offset:64
    ds_read_b64_tr_b16 v[66:67], v249 offset:256
    ds_read_b64_tr_b16 v[70:71], v249 offset:320
    s_mov_b64 exec, s[54:55]
    ds_read_u16_d16_hi v242, v250 offset:0
    s_mov_b64 exec, -1
    v_fmac_f32 v196, v31, v167
    s_nop 1
    v_permlane32_swap_b32 v198, v196
    v_add_f32 v196, v198, v196
    v_mul_f32 v255, v32, v152
    v_fmac_f32 v255, v33, v153
    v_fmac_f32 v255, v34, v154
    v_fmac_f32 v255, v35, v155
    v_fmac_f32 v255, v36, v156
    v_fmac_f32 v255, v37, v157
    v_fmac_f32 v255, v38, v158
    v_fmac_f32 v255, v39, v159
    v_fma_f32 v203, v40, -v168, v203
    v_fma_f32 v203, v41, -v169, v203
    v_permlane32_swap_b32 v255, v201
    v_fma_f32 v203, v42, -v170, v203
    v_fma_f32 v203, v43, -v171, v203
    v_fma_f32 v203, v44, -v172, v203
    v_fma_f32 v203, v45, -v173, v203
    v_fma_f32 v203, v46, -v174, v203
    v_fma_f32 v203, v47, -v175, v203
    v_add_f32 v201, v255, v201
    v_fmac_f32 v199, v48, v120
    v_permlane32_swap_b32 v203, v255
    v_fmac_f32 v199, v49, v121
    v_fmac_f32 v199, v50, v122
    v_fmac_f32 v199, v51, v123
    v_fmac_f32 v199, v52, v124
    v_fmac_f32 v199, v53, v125
    v_fmac_f32 v199, v54, v126
    v_fmac_f32 v199, v55, v127
    v_add_f32 v255, v203, v255
    v_mul_f32 v197, v56, v168
    v_fmac_f32 v197, v57, v169
    v_fmac_f32 v197, v58, v170
    v_fmac_f32 v197, v59, v171
    v_fmac_f32 v197, v60, v172
    v_fmac_f32 v197, v61, v173
    v_fmac_f32 v197, v62, v174
    v_fmac_f32 v197, v63, v175
    s_nop 1
    v_permlane32_swap_b32 v199, v197
    v_add_f32 v197, v199, v197
    v_cvt_pk_bf16_f32 v200, v200, v201
    v_cvt_pk_bf16_f32 v254, v254, v255
    v_cvt_pk_bf16_f32 v196, v196, v197
    ds_write2st64_b32 v253, v200, v196 offset0:3 offset1:4
    s_mov_b64 exec, 0xffffffff
    ds_write_b32 v253, v254 offset:1280
    s_mov_b64 exec, -1
    s_add_u32 s50, s50, 1
    s_cmp_ge_u32 s50, 4
    s_cbranch_scc1 LAST1
    s_waitcnt lgkmcnt(7)
    v_readfirstlane_b32 s66, v252
    s_add_u32 s53, s53, 1
    v_mov_b32 v252, s53
    s_cmp_le_u32 s53, s66
    ds_write2_b32 v251, v252, v252 offset0:0 offset1:8
    s_setprio 1
    s_cbranch_scc1 PRIO_15
    s_setprio 0
PRIO_15:
    s_cmp_eq_u32 s52, 4
    s_cbranch_scc1 ITEM_1_4
    s_cmp_eq_u32 s52, 5
    s_cbranch_scc1 ITEM_1_5
    s_cmp_eq_u32 s52, 3
    s_cbranch_scc1 ITEM_1_3
    s_cmp_eq_u32 s52, 6
    s_cbranch_scc1 ITEM_1_6
    s_cmp_eq_u32 s52, 8
    s_cbranch_scc1 ITEM_1_8
    s_branch ITEM_1_2
.p2align 6
ITEM_1_2:
    s_mov_b32 m0, s50
    s_nop 0
    s_movrels_b32 s71, s23
    s_movrels_b32 s33, s28
    s_and_b32 s70, s33, 0x70
    s_andn2_b32 s33, s33, 0x70
    v_xor_b32 v253, s70, v248
    v_add_u32 v253, s33, v253
    s_bfe_u32 s46, s71, 0x30012
    s_mov_b32 m0, s46
    s_and_b32 s66, s71, 0x3ffff
    s_movrels_b32 s68, s57
    s_movrels_b32 s69, s61
    s_sub_u32 s48, s66, s47
    s_mov_b32 s47, s66
    s_lshr_b32 s52, s71, 28
    s_lshl_b32 s67, s46, 9
    s_add_u32 s66, s66, s67
    s_sub_u32 s49, s66, s42
    s_mov_b32 s42, s66
    s_bfe_u32 s66, s68, 655360
    s_add_u32 s43, s42, s66
    s_bfe_u32 s39, s69, 655360
    s_bfe_u32 s66, s68, 655370
    s_add_u32 s44, s42, s66
    s_bfe_u32 s40, s69, 655370
    s_bfe_u32 s66, s68, 655380
    s_add_u32 s45, s42, s66
    s_bfe_u32 s41, s69, 655380
    v_add_u32 v252, s42, v247
    ds_read_u16 v234, v252
    ds_read_u16 v235, v252 offset:64
    v_add_u32 v252, s43, v247
    ds_read_u16 v236, v252
    ds_read_u16 v237, v252 offset:64
    v_add_u32 v252, s44, v247
    ds_read_u16 v238, v252
    ds_read_u16 v239, v252 offset:64
    v_add_u32 v252, s45, v247
    ds_read_u16 v240, v252
    ds_read_u16 v241, v252 offset:64
    s_waitcnt lgkmcnt(8)
    v_mul_f32_dpp v196, v242, v64 row_newbcast:0 row_mask:0xf bank_mask:0xf
    v_mul_f32_dpp v197, v242, v65 row_newbcast:1 row_mask:0xf bank_mask:0xf
    v_mul_f32_dpp v198, v242, v64 row_newbcast:8 row_mask:0xf bank_mask:0xf
    v_mul_f32_dpp v199, v242, v65 row_newbcast:9 row_mask:0xf bank_mask:0xf
    v_mul_f32_dpp v200, v242, v68 row_newbcast:2 row_mask:0xf bank_mask:0xf
    v_mul_f32_dpp v201, v242, v69 row_newbcast:3 row_mask:0xf bank_mask:0xf
    v_mul_f32_dpp v202, v242, v68 row_newbcast:10 row_mask:0xf bank_mask:0xf
    v_mul_f32_dpp v203, v242, v69 row_newbcast:11 row_mask:0xf bank_mask:0xf
    v_cvt_pk_bf16_f32 v64, v196, v197
    v_cvt_pk_bf16_f32 v68, v198, v199
    v_cvt_pk_bf16_f32 v65, v200, v201
    v_cvt_pk_bf16_f32 v69, v202, v203
    v_mul_f32_dpp v196, v242, v66 row_newbcast:4 row_mask:0xf bank_mask:0xf
    v_mul_f32_dpp v197, v242, v67 row_newbcast:5 row_mask:0xf bank_mask:0xf
    v_mul_f32_dpp v198, v242, v66 row_newbcast:12 row_mask:0xf bank_mask:0xf
    v_mul_f32_dpp v199, v242, v67 row_newbcast:13 row_mask:0xf bank_mask:0xf
    v_mul_f32_dpp v200, v242, v70 row_newbcast:6 row_mask:0xf bank_mask:0xf
    v_mul_f32_dpp v201, v242, v71 row_newbcast:7 row_mask:0xf bank_mask:0xf
    v_mul_f32_dpp v202, v242, v70 row_newbcast:14 row_mask:0xf bank_mask:0xf
    v_mul_f32_dpp v203, v242, v71 row_newbcast:15 row_mask:0xf bank_mask:0xf
    v_cvt_pk_bf16_f32 v66, v196, v197
    v_cvt_pk_bf16_f32 v70, v198, v199
    v_cvt_pk_bf16_f32 v67, v200, v201
    v_cvt_pk_bf16_f32 v71, v202, v203
    s_nop 0
    s_waitcnt lgkmcnt(6)
    v_mfma_f32_32x32x16_bf16 v[0:15], v[64:67], v[176:179], 0
    s_add_u32 m0, s21, 0
    v_mfma_f32_32x32x16_bf16 v[16:31], v[68:71], v[176:179], 0
    v_lshl_add_u32 v234, v234, 10, v246
    v_lshl_add_u32 v235, v235, 10, v246
    buffer_load_dwordx4 v234, s[4:7], s38 offen  lds
    buffer_load_dwordx4 v235, s[8:11], s38 offen offset:1024  lds
    v_mfma_f32_32x32x16_bf16 v[32:47], v[64:67], v[180:183], 0
    s_nop 4
    v_mul_f32 v196, v0, v96
    v_fmac_f32 v196, v1, v97
    v_fmac_f32 v196, v2, v98
    v_fmac_f32 v196, v3, v99
    v_fmac_f32 v196, v4, v100
    v_fmac_f32 v196, v5, v101
    v_fmac_f32 v196, v6, v102
    v_fmac_f32 v196, v7, v103
    v_mul_f32 v198, v8, v128
    v_fmac_f32 v198, v9, v129
    v_fmac_f32 v198, v10, v130
    v_fmac_f32 v198, v11, v131
    v_fmac_f32 v198, v12, v132
    v_fmac_f32 v198, v13, v133
    v_fmac_f32 v198, v14, v134
    v_fmac_f32 v198, v15, v135
    v_mul_f32 v200, v16, v128
    v_fmac_f32 v200, v17, v129
    v_permlane32_swap_b32 v196, v198
    v_mfma_f32_32x32x16_bf16 v[48:63], v[68:71], v[180:183], 0
    s_waitcnt vmcnt(6)
    ds_read_b64_tr_b16 v[176:177], v244 offset:2048
    ds_read_b64_tr_b16 v[178:179], v244 offset:3072
    ds_read_b64_tr_b16 v[180:181], v245 offset:2048
    ds_read_b64_tr_b16 v[182:183], v245 offset:3072
    v_fmac_f32 v200, v18, v130
    v_fmac_f32 v200, v19, v131
    v_fmac_f32 v200, v20, v132
    v_fmac_f32 v200, v21, v133
    v_fmac_f32 v200, v22, v134
    v_fmac_f32 v200, v23, v135
    v_add_f32 v198, v196, v198
    v_mul_f32_e64 v202, v24, -v128
    v_fma_f32 v202, v25, -v129, v202
    v_fma_f32 v202, v26, -v130, v202
    v_fma_f32 v202, v27, -v131, v202
    v_fma_f32 v202, v28, -v132, v202
    v_fma_f32 v202, v29, -v133, v202
    v_fma_f32 v202, v30, -v134, v202
    v_fma_f32 v202, v31, -v135, v202
    s_nop 1
    v_permlane32_swap_b32 v200, v202
    v_add_f32 v202, v200, v202
    s_waitcnt lgkmcnt(0)
    v_mfma_f32_32x32x16_bf16 v[0:15], v[64:67], v[176:179], 0
    v_mul_f32 v197, v32, v104
    v_fmac_f32 v197, v33, v105
    v_fmac_f32 v197, v34, v106
    v_fmac_f32 v197, v35, v107
    v_fmac_f32 v197, v36, v108
    v_fmac_f32 v197, v37, v109
    v_fmac_f32 v197, v38, v110
    v_fmac_f32 v197, v39, v111
    v_mul_f32 v199, v40, v136
    v_fmac_f32 v199, v41, v137
    v_fmac_f32 v199, v42, v138
    v_fmac_f32 v199, v43, v139
    v_fmac_f32 v199, v44, v140
    v_fmac_f32 v199, v45, v141
    v_fmac_f32 v199, v46, v142
    v_fmac_f32 v199, v47, v143
    v_mul_f32 v201, v48, v136
    v_fmac_f32 v201, v49, v137
    v_permlane32_swap_b32 v197, v199
    v_fmac_f32 v201, v50, v138
    s_add_u32 m0, s21, 2048
    v_mfma_f32_32x32x16_bf16 v[16:31], v[68:71], v[176:179], 0
    v_lshl_add_u32 v236, v236, 10, v246
    v_lshl_add_u32 v237, v237, 10, v246
    buffer_load_dwordx4 v236, s[4:7], s39 offen  lds
    buffer_load_dwordx4 v237, s[8:11], s39 offen offset:1024  lds
    v_fmac_f32 v201, v51, v139
    v_fmac_f32 v201, v52, v140
    v_fmac_f32 v201, v53, v141
    v_fmac_f32 v201, v54, v142
    v_fmac_f32 v201, v55, v143
    v_add_f32 v199, v197, v199
    v_mul_f32_e64 v203, v56, -v136
    v_fma_f32 v203, v57, -v137, v203
    v_fma_f32 v203, v58, -v138, v203
    v_fma_f32 v203, v59, -v139, v203
    v_fma_f32 v203, v60, -v140, v203
    v_fma_f32 v203, v61, -v141, v203
    v_fma_f32 v203, v62, -v142, v203
    v_fma_f32 v203, v63, -v143, v203
    s_nop 1
    v_permlane32_swap_b32 v201, v203
    v_add_f32 v203, v201, v203
    v_cvt_pk_bf16_f32 v192, v198, v199
    v_cvt_pk_bf16_f32 v193, v202, v203
    v_mfma_f32_32x32x16_bf16 v[32:47], v[64:67], v[180:183], 0
    v_mul_f32 v196, v0, v144
    v_fmac_f32 v196, v1, v145
    v_fmac_f32 v196, v2, v146
    v_fmac_f32 v196, v3, v147
    v_fmac_f32 v196, v4, v148
    v_fmac_f32 v196, v5, v149
    v_fmac_f32 v196, v6, v150
    v_fmac_f32 v196, v7, v151
    v_mul_f32 v198, v8, v112
    v_fmac_f32 v198, v9, v113
    v_fmac_f32 v198, v10, v114
    v_fmac_f32 v198, v11, v115
    v_fmac_f32 v198, v12, v116
    v_fmac_f32 v198, v13, v117
    v_fmac_f32 v198, v14, v118
    v_fmac_f32 v198, v15, v119
    v_mfma_f32_32x32x16_bf16 v[48:63], v[68:71], v[180:183], 0
    s_waitcnt vmcnt(6)
    ds_read_b64_tr_b16 v[176:177], v244 offset:4096
    ds_read_b64_tr_b16 v[178:179], v244 offset:5120
    ds_read_b64_tr_b16 v[180:181], v245 offset:4096
    ds_read_b64_tr_b16 v[182:183], v245 offset:5120
    v_mul_f32_e64 v200, v16, -v160
    v_fma_f32 v200, v17, -v161, v200
    v_fma_f32 v200, v18, -v162, v200
    v_fma_f32 v200, v19, -v163, v200
    v_fma_f32 v200, v20, -v164, v200
    v_fma_f32 v200, v21, -v165, v200
    v_fma_f32 v200, v22, -v166, v200
    v_fma_f32 v200, v23, -v167, v200
    v_mul_f32_e64 v202, v24, -v160
    v_fma_f32 v202, v25, -v161, v202
    v_fma_f32 v202, v26, -v162, v202
    v_fma_f32 v202, v27, -v163, v202
    v_fma_f32 v202, v28, -v164, v202
    v_fma_f32 v202, v29, -v165, v202
    v_fma_f32 v202, v30, -v166, v202
    v_fma_f32 v202, v31, -v167, v202
    s_waitcnt lgkmcnt(0)
    v_mfma_f32_32x32x16_bf16 v[0:15], v[64:67], v[176:179], 0
    v_mul_f32 v197, v32, v152
    v_fmac_f32 v197, v33, v153
    v_fmac_f32 v197, v34, v154
    v_fmac_f32 v197, v35, v155
    v_fmac_f32 v197, v36, v156
    v_fmac_f32 v197, v37, v157
    v_fmac_f32 v197, v38, v158
    v_fmac_f32 v197, v39, v159
    v_mul_f32 v199, v40, v120
    v_fmac_f32 v199, v41, v121
    v_fmac_f32 v199, v42, v122
    v_fmac_f32 v199, v43, v123
    v_fmac_f32 v199, v44, v124
    v_fmac_f32 v199, v45, v125
    v_fmac_f32 v199, v46, v126
    v_fmac_f32 v199, v47, v127
    s_add_u32 m0, s21, 4096
    v_mfma_f32_32x32x16_bf16 v[16:31], v[68:71], v[176:179], 0
    v_lshl_add_u32 v238, v238, 10, v246
    v_lshl_add_u32 v239, v239, 10, v246
    buffer_load_dwordx4 v238, s[4:7], s40 offen  lds
    buffer_load_dwordx4 v239, s[8:11], s40 offen offset:1024  lds
    v_mul_f32_e64 v201, v48, -v168
    v_fma_f32 v201, v49, -v169, v201
    v_fma_f32 v201, v50, -v170, v201
    v_fma_f32 v201, v51, -v171, v201
    v_fma_f32 v201, v52, -v172, v201
    v_fma_f32 v201, v53, -v173, v201
    v_fma_f32 v201, v54, -v174, v201
    v_fma_f32 v201, v55, -v175, v201
    v_mul_f32_e64 v203, v56, -v168
    v_fma_f32 v203, v57, -v169, v203
    v_fma_f32 v203, v58, -v170, v203
    v_fma_f32 v203, v59, -v171, v203
    v_fma_f32 v203, v60, -v172, v203
    v_fma_f32 v203, v61, -v173, v203
    v_fma_f32 v203, v62, -v174, v203
    v_fma_f32 v203, v63, -v175, v203
    v_mfma_f32_32x32x16_bf16 v[32:47], v[64:67], v[180:183], 0
    v_mul_f32 v254, v0, v144
    v_fmac_f32 v254, v1, v145
    v_fmac_f32 v254, v2, v146
    v_fmac_f32 v254, v3, v147
    v_fmac_f32 v254, v4, v148
    v_fmac_f32 v254, v5, v149
    v_fmac_f32 v254, v6, v150
    v_fmac_f32 v254, v7, v151
    v_fmac_f32 v200, v8, v160
    v_mfma_f32_32x32x16_bf16 v[48:63], v[68:71], v[180:183], 0
    ds_swizzle_b32 v68, v68 offset:0x401F
    ds_swizzle_b32 v69, v69 offset:0x401F
    ds_swizzle_b32 v70, v70 offset:0x401F
    ds_swizzle_b32 v71, v71 offset:0x401F
    s_waitcnt vmcnt(6)
    ds_read_b64_tr_b16 v[176:177], v244 offset:6144
    ds_read_b64_tr_b16 v[178:179], v244 offset:7168
    ds_read_b64_tr_b16 v[180:181], v245 offset:6144
    ds_read_b64_tr_b16 v[182:183], v245 offset:7168
    v_fmac_f32 v200, v9, v161
    v_permlane32_swap_b32 v196, v254
    v_fmac_f32 v200, v10, v162
    v_fmac_f32 v200, v11, v163
    v_fmac_f32 v200, v12, v164
    v_fmac_f32 v200, v13, v165
    v_fmac_f32 v200, v14, v166
    v_fmac_f32 v200, v15, v167
    v_add_f32 v254, v196, v254
    s_waitcnt lgkmcnt(0)
    s_mov_b64 exec, s[56:57]
    v_xor_b32 v68, 0x80008000, v68
    v_xor_b32 v69, 0x80008000, v69
    v_xor_b32 v70, 0x80008000, v70
    v_xor_b32 v71, 0x80008000, v71
    s_mov_b64 exec, -1
    s_nop 0
    v_mfma_f32_32x32x16_bf16 v[0:15], v[64:67], v[176:179], 0
    v_mul_f32 v255, v32, v152
    v_fmac_f32 v255, v33, v153
    v_fmac_f32 v255, v34, v154
    v_fmac_f32 v255, v35, v155
    v_fmac_f32 v255, v36, v156
    v_fmac_f32 v255, v37, v157
    v_fmac_f32 v255, v38, v158
    v_fmac_f32 v255, v39, v159
    v_fmac_f32 v201, v40, v168
    v_fmac_f32 v201, v41, v169
    s_add_u32 m0, s21, 6144
    v_mfma_f32_32x32x16_bf16 v[16:31], v[68:71], v[176:179], v[16:31]
    v_lshl_add_u32 v240, v240, 10, v246
    v_lshl_add_u32 v241, v241, 10, v246
    buffer_load_dwordx4 v240, s[4:7], s41 offen  lds
    buffer_load_dwordx4 v241, s[8:11], s41 offen offset:1024  lds
    v_permlane32_swap_b32 v197, v255
    v_fmac_f32 v201, v42, v170
    v_fmac_f32 v201, v43, v171
    v_fmac_f32 v201, v44, v172
    v_fmac_f32 v201, v45, v173
    v_fmac_f32 v201, v46, v174
    v_fmac_f32 v201, v47, v175
    v_add_f32 v255, v197, v255
    v_cvt_pk_bf16_f32 v194, v254, v255
    v_mfma_f32_32x32x16_bf16 v[32:47], v[64:67], v[180:183], 0
    v_mul_f32 v254, v0, v144
    v_fmac_f32 v254, v1, v145
    v_fmac_f32 v254, v2, v146
    v_fmac_f32 v254, v3, v147
    v_fmac_f32 v254, v4, v148
    v_fmac_f32 v254, v5, v149
    v_fmac_f32 v254, v6, v150
    v_fmac_f32 v254, v7, v151
    v_fma_f32 v202, v8, -v160, v202
    v_fma_f32 v202, v9, -v161, v202
    v_permlane32_swap_b32 v254, v200
    v_fma_f32 v202, v10, -v162, v202
    v_fma_f32 v202, v11, -v163, v202
    v_fma_f32 v202, v12, -v164, v202
    v_fma_f32 v202, v13, -v165, v202
    v_fma_f32 v202, v14, -v166, v202
    v_fma_f32 v202, v15, -v167, v202
    v_add_f32 v200, v254, v200
    v_fmac_f32 v198, v16, v112
    v_permlane32_swap_b32 v202, v254
    v_mfma_f32_32x32x16_bf16 v[48:63], v[68:71], v[180:183], v[48:63]
    s_waitcnt vmcnt(6)
    ds_read_b64_tr_b16 v[176:177], v244 offset:0
    ds_read_b64_tr_b16 v[178:179], v244 offset:1024
    ds_read_b64_tr_b16 v[180:181], v245 offset:0
    ds_read_b64_tr_b16 v[182:183], v245 offset:1024
    v_add_u32 v249, s48, v249
    v_add_u32 v250, s49, v250
    ds_read_b32 v252, v251 offset:16
    ds_read_b64_tr_b16 v[64:65], v249 offset:0
    ds_read_b64_tr_b16 v[68:69], v249 offset:64
    ds_read_b64_tr_b16 v[66:67], v249 offset:256
    ds_read_b64_tr_b16 v[70:71], v249 offset:320
    s_mov_b64 exec, s[54:55]
    ds_read_u16_d16_hi v242, v250 offset:0
    s_mov_b64 exec, -1
    v_fmac_f32 v198, v17, v113
    v_fmac_f32 v198, v18, v114
    v_fmac_f32 v198, v19, v115
    v_fmac_f32 v198, v20, v116
    v_fmac_f32 v198, v21, v117
    v_fmac_f32 v198, v22, v118
    v_fmac_f32 v198, v23, v119
    v_add_f32 v254, v202, v254
    v_mul_f32 v196, v24, v160
    v_fmac_f32 v196, v25, v161
    v_fmac_f32 v196, v26, v162
    v_fmac_f32 v196, v27, v163
    v_fmac_f32 v196, v28, v164
    v_fmac_f32 v196, v29, v165
    v_fmac_f32 v196, v30, v166
    v_fmac_f32 v196, v31, v167
    s_nop 1
    v_permlane32_swap_b32 v198, v196
    v_add_f32 v196, v198, v196
    v_mul_f32 v255, v32, v152
    v_fmac_f32 v255, v33, v153
    v_fmac_f32 v255, v34, v154
    v_fmac_f32 v255, v35, v155
    v_fmac_f32 v255, v36, v156
    v_fmac_f32 v255, v37, v157
    v_fmac_f32 v255, v38, v158
    v_fmac_f32 v255, v39, v159
    v_fma_f32 v203, v40, -v168, v203
    v_fma_f32 v203, v41, -v169, v203
    v_permlane32_swap_b32 v255, v201
    v_fma_f32 v203, v42, -v170, v203
    v_fma_f32 v203, v43, -v171, v203
    v_fma_f32 v203, v44, -v172, v203
    v_fma_f32 v203, v45, -v173, v203
    v_fma_f32 v203, v46, -v174, v203
    v_fma_f32 v203, v47, -v175, v203
    v_add_f32 v201, v255, v201
    v_fmac_f32 v199, v48, v120
    v_permlane32_swap_b32 v203, v255
    v_fmac_f32 v199, v49, v121
    v_fmac_f32 v199, v50, v122
    v_fmac_f32 v199, v51, v123
    v_fmac_f32 v199, v52, v124
    v_fmac_f32 v199, v53, v125
    v_fmac_f32 v199, v54, v126
    v_fmac_f32 v199, v55, v127
    v_add_f32 v255, v203, v255
    v_mul_f32 v197, v56, v168
    v_fmac_f32 v197, v57, v169
    v_fmac_f32 v197, v58, v170
    v_fmac_f32 v197, v59, v171
    v_fmac_f32 v197, v60, v172
    v_fmac_f32 v197, v61, v173
    v_fmac_f32 v197, v62, v174
    v_fmac_f32 v197, v63, v175
    s_nop 1
    v_permlane32_swap_b32 v199, v197
    v_add_f32 v197, v199, v197
    v_cvt_pk_bf16_f32 v200, v200, v201
    v_cvt_pk_bf16_f32 v254, v254, v255
    v_cvt_pk_bf16_f32 v196, v196, v197
    ds_write2st64_b32 v253, v192, v193 offset0:0 offset1:1
    ds_write2st64_b32 v253, v194, v200 offset0:2 offset1:3
    ds_write_b32 v253, v196 offset:1024
    s_mov_b64 exec, 0xffffffff
    ds_write_b32 v253, v254 offset:1280
    s_mov_b64 exec, -1
    s_add_u32 s50, s50, 1
    s_cmp_ge_u32 s50, 4
    s_cbranch_scc1 LAST1
    s_waitcnt lgkmcnt(9)
    v_readfirstlane_b32 s66, v252
    s_add_u32 s53, s53, 1
    v_mov_b32 v252, s53
    s_cmp_le_u32 s53, s66
    ds_write2_b32 v251, v252, v252 offset0:0 offset1:8
    s_setprio 1
    s_cbranch_scc1 PRIO_16
    s_setprio 0
PRIO_16:
    s_cmp_eq_u32 s52, 4
    s_cbranch_scc1 ITEM_1_4
    s_cmp_eq_u32 s52, 5
    s_cbranch_scc1 ITEM_1_5
    s_cmp_eq_u32 s52, 3
    s_cbranch_scc1 ITEM_1_3
    s_cmp_eq_u32 s52, 6
    s_cbranch_scc1 ITEM_1_6
    s_cmp_eq_u32 s52, 8
    s_cbranch_scc1 ITEM_1_8
    s_branch ITEM_1_2
.p2align 6
TAIL:
    s_setprio 0
    s_waitcnt vmcnt(0) lgkmcnt(0)
    v_lshrrev_b32 v176, 2, v248
    v_lshlrev_b32 v180, 2, v248
    s_cmp_eq_u32 s89, 0
    s_cbranch_scc1 T_flags
    s_mul_i32 s66, s20, 80
    v_lshlrev_b32 v2, 2, v176
    v_min_u32 v2, 76, v2
    s_mov_b32 s67, 262144
T_poll:
    buffer_load_dword v3, v2, s[16:19], s66 offen offset:128 sc1
    s_waitcnt vmcnt(0)
    v_cmp_ne_u32 vcc, s88, v3
    s_sub_u32 s67, s67, 1
    s_cselect_b64 vcc, 0, vcc
    s_cmp_eq_u64 vcc, 0
    s_cbranch_scc0 T_poll
    s_mov_b32 s89, 0
T_flags:
    s_mul_i32 s66, s20, 20480
    s_add_u32 s66, s66, 1024
    buffer_load_dwordx4 v[96:99], v180, s[16:19], s66 offen offset:0 sc1
    buffer_load_dwordx4 v[100:103], v180, s[16:19], s66 offen offset:1024 sc1
    buffer_load_dwordx4 v[104:107], v180, s[16:19], s66 offen offset:2048 sc1
    buffer_load_dwordx4 v[108:111], v180, s[16:19], s66 offen offset:3072 sc1
    s_add_u32 s66, s66, 4096
    buffer_load_dwordx4 v[112:115], v180, s[16:19], s66 offen offset:0 sc1
    buffer_load_dwordx4 v[116:119], v180, s[16:19], s66 offen offset:1024 sc1
    buffer_load_dwordx4 v[120:123], v180, s[16:19], s66 offen offset:2048 sc1
    buffer_load_dwordx4 v[124:127], v180, s[16:19], s66 offen offset:3072 sc1
    s_add_u32 s66, s66, 4096
    buffer_load_dwordx4 v[128:131], v180, s[16:19], s66 offen offset:0 sc1
    buffer_load_dwordx4 v[132:135], v180, s[16:19], s66 offen offset:1024 sc1
    buffer_load_dwordx4 v[136:139], v180, s[16:19], s66 offen offset:2048 sc1
    buffer_load_dwordx4 v[140:143], v180, s[16:19], s66 offen offset:3072 sc1
    s_add_u32 s66, s66, 4096
    buffer_load_dwordx4 v[144:147], v180, s[16:19], s66 offen offset:0 sc1
    buffer_load_dwordx4 v[148:151], v180, s[16:19], s66 offen offset:1024 sc1
    buffer_load_dwordx4 v[152:155], v180, s[16:19], s66 offen offset:2048 sc1
    buffer_load_dwordx4 v[156:159], v180, s[16:19], s66 offen offset:3072 sc1
    s_add_u32 s66, s66, 4096
    buffer_load_dwordx4 v[160:163], v180, s[16:19], s66 offen offset:0 sc1
    buffer_load_dwordx4 v[164:167], v180, s[16:19], s66 offen offset:1024 sc1
    buffer_load_dwordx4 v[168:171], v180, s[16:19], s66 offen offset:2048 sc1
    buffer_load_dwordx4 v[172:175], v180, s[16:19], s66 offen offset:3072 sc1
    s_lshr_b32 s67, s22, 17
    s_and_b32 s68, s67, 128
    s_and_b32 s67, s67, 0x70
    s_add_u32 s68, s68, s21
    v_xor_b32 v181, s67, v248
    v_add_u32 v181, s68, v181
    ds_write2st64_b32 v181, v204, v205 offset0:0 offset1:1
    ds_write2st64_b32 v181, v206, v207 offset0:2 offset1:3
    ds_write2st64_b32 v181, v208, v209 offset0:4 offset1:5
    s_lshr_b32 s67, s23, 17
    s_and_b32 s68, s67, 128
    s_and_b32 s67, s67, 0x70
    s_add_u32 s68, s68, s21
    v_xor_b32 v181, s67, v248
    v_add_u32 v181, s68, v181
    ds_write2st64_b32 v181, v210, v211 offset0:6 offset1:7
    ds_write2st64_b32 v181, v212, v213 offset0:8 offset1:9
    ds_write2st64_b32 v181, v214, v215 offset0:10 offset1:11
    s_lshr_b32 s67, s24, 17
    s_and_b32 s68, s67, 128
    s_and_b32 s67, s67, 0x70
    s_add_u32 s68, s68, s21
    v_xor_b32 v181, s67, v248
    v_add_u32 v181, s68, v181
    ds_write2st64_b32 v181, v216, v217 offset0:12 offset1:13
    ds_write2st64_b32 v181, v218, v219 offset0:14 offset1:15
    ds_write2st64_b32 v181, v220, v221 offset0:16 offset1:17
    s_lshr_b32 s67, s25, 17
    s_and_b32 s68, s67, 128
    s_and_b32 s67, s67, 0x70
    s_add_u32 s68, s68, s21
    v_xor_b32 v181, s67, v248
    v_add_u32 v181, s68, v181
    ds_write2st64_b32 v181, v222, v223 offset0:18 offset1:19
    ds_write2st64_b32 v181, v224, v225 offset0:20 offset1:21
    ds_write2st64_b32 v181, v226, v227 offset0:22 offset1:23
    s_lshr_b32 s67, s26, 17
    s_and_b32 s68, s67, 128
    s_and_b32 s67, s67, 0x70
    s_add_u32 s68, s68, s21
    v_xor_b32 v181, s67, v248
    v_add_u32 v181, s68, v181
    ds_write2st64_b32 v181, v228, v229 offset0:24 offset1:25
    ds_write2st64_b32 v181, v230, v231 offset0:26 offset1:27
    ds_write2st64_b32 v181, v232, v233 offset0:28 offset1:29
GEMM:
    v_and_b32 v177, 15, v176
    v_lshrrev_b32 v178, 4, v176
    v_and_b32 v179, 7, v177
    v_lshlrev_b32 v180, 3, v177
    v_lshlrev_b32 v181, 3, v179
    v_add_u32 v180, 163328, v180
    v_add_u32 v181, 163328, v181
    ds_read_b64 v[182:183], v180
    ds_read_b64 v[184:185], v180 offset:128
    ds_read_b64 v[186:187], v181 offset:256
    v_xor_b32 v180, v179, v178
    v_and_b32 v181, 8, v177
    v_xor_b32 v188, 4, v180
    v_add_u32 v189, v188, v181
    v_add_u32 v181, v180, v181
    s_waitcnt lgkmcnt(0)
    s_mov_b32 s4, s72
    s_and_b32 s5, s73, 0xffff
    s_mov_b32 s6, 10240000
    s_mov_b32 s7, 0x20000
    v_lshl_add_u32 v48, v180, 4, v182
    v_lshl_add_u32 v49, v188, 4, v182
    v_lshl_add_u32 v50, v180, 4, v183
    v_lshl_add_u32 v51, v188, 4, v183
    v_lshl_add_u32 v52, v180, 4, v184
    v_lshl_add_u32 v53, v188, 4, v184
    v_lshl_add_u32 v54, v180, 4, v185
    v_lshl_add_u32 v55, v188, 4, v185
    v_lshl_add_u32 v56, v181, 4, v186
    v_lshl_add_u32 v57, v189, 4, v186
    v_lshl_add_u32 v58, v181, 4, v187
    v_lshl_add_u32 v59, v189, 4, v187
    s_mov_b32 s67, 0xbfb8aa3b
    s_barrier
    ds_read_b128 v[76:79], v48 offset:0
    ds_read_b128 v[80:83], v52 offset:0
    ds_read_b128 v[84:87], v56 offset:0
    ds_read_b128 v[88:91], v49 offset:0
    ds_read_b128 v[92:95], v53 offset:0
    s_waitcnt vmcnt(19) lgkmcnt(4)
    v_mfma_f32_16x16x32_bf16 v[0:3], v[96:99], v[76:79], 0
    v_lshrrev_b32 v205, 1, v178
    v_lshl_add_u32 v205, s20, 1, v205
    ds_read_b128 v[76:79], v57 offset:0
    s_waitcnt lgkmcnt(4)
    v_mfma_f32_16x16x32_bf16 v[4:7], v[96:99], v[80:83], 0
    v_and_b32 v204, 7, v177
    v_xor_b32 v205, v205, v204
    ds_read_b128 v[80:83], v50 offset:0
    s_waitcnt lgkmcnt(4)
    v_mfma_f32_16x16x32_bf16 v[8:11], v[96:99], v[84:87], 0
    v_and_b32 v204, 1, v178
    v_lshlrev_b32 v204, 3, v204
    ds_read_b128 v[84:87], v54 offset:0
    s_waitcnt vmcnt(18) lgkmcnt(4)
    v_mfma_f32_16x16x32_bf16 v[0:3], v[100:103], v[88:91], v[0:3]
    v_lshl_add_u32 v205, v205, 4, v204
    v_and_b32 v204, 8, v177
    ds_read_b128 v[88:91], v58 offset:0
    s_waitcnt lgkmcnt(4)
    v_mfma_f32_16x16x32_bf16 v[4:7], v[100:103], v[92:95], v[4:7]
    v_lshl_add_u32 v204, v204, 4, v205
    v_lshl_add_u32 v204, v177, 10, v204
    ds_read_b128 v[92:95], v51 offset:0
    s_waitcnt lgkmcnt(4)
    v_mfma_f32_16x16x32_bf16 v[8:11], v[100:103], v[76:79], v[8:11]
    v_add_u32 v204, 65536, v204
    v_add_u32 v205, v205, v182
    ds_read_b128 v[76:79], v55 offset:0
    s_waitcnt vmcnt(17) lgkmcnt(4)
    v_mfma_f32_16x16x32_bf16 v[0:3], v[104:107], v[80:83], v[0:3]
    v_and_b32 v220, 8, v177
    v_mul_u32_u24 v220, 1008, v220
    ds_read_b128 v[80:83], v59 offset:0
    s_waitcnt lgkmcnt(4)
    v_mfma_f32_16x16x32_bf16 v[4:7], v[104:107], v[84:87], v[4:7]
    v_sub_u32 v220, v204, v220
    v_lshlrev_b32 v210, 4, v176
    ds_read_b128 v[84:87], v48 offset:1024
    s_waitcnt lgkmcnt(4)
    v_mfma_f32_16x16x32_bf16 v[8:11], v[104:107], v[88:91], v[8:11]
    s_lshl_b32 s68, s20, 1
    s_add_u32 s69, s68, 1
    ds_read_b128 v[88:91], v52 offset:1024
    s_waitcnt vmcnt(16) lgkmcnt(4)
    v_mfma_f32_16x16x32_bf16 v[0:3], v[108:111], v[92:95], v[0:3]
    v_readlane_b32 s24, v182, s68
    v_readlane_b32 s25, v182, s69
    ds_read_b128 v[92:95], v56 offset:1024
    s_waitcnt lgkmcnt(4)
    v_mfma_f32_16x16x32_bf16 v[4:7], v[108:111], v[76:79], v[4:7]
    s_and_b32 s70, s68, 7
    s_lshl_b32 s70, s70, 4
    ds_read_b128 v[76:79], v49 offset:1024
    s_waitcnt lgkmcnt(4)
    v_mfma_f32_16x16x32_bf16 v[8:11], v[108:111], v[80:83], v[8:11]
    v_xor_b32 v206, s70, v210
    v_xor_b32 v207, 16, v206
    ds_read_b128 v[80:83], v53 offset:1024
    s_waitcnt vmcnt(15) lgkmcnt(4)
    v_mfma_f32_16x16x32_bf16 v[0:3], v[112:115], v[84:87], v[0:3]
    v_add_u32 v208, s24, v206
    v_add_u32 v209, s25, v207
    ds_read_b128 v[84:87], v57 offset:1024
    s_waitcnt lgkmcnt(4)
    v_mfma_f32_16x16x32_bf16 v[4:7], v[112:115], v[88:91], v[4:7]
    s_lshl_b32 s70, s68, 10
    s_and_b32 s71, s68, 8
    ds_read_b128 v[88:91], v50 offset:1024
    s_waitcnt lgkmcnt(4)
    v_mfma_f32_16x16x32_bf16 v[8:11], v[112:115], v[92:95], v[8:11]
    s_lshl_b32 s71, s71, 4
    s_add_u32 s71, s71, s70
    ds_read_b128 v[92:95], v54 offset:1024
    s_waitcnt vmcnt(14) lgkmcnt(4)
    v_mfma_f32_16x16x32_bf16 v[0:3], v[116:119], v[76:79], v[0:3]
    s_add_u32 s71, s71, 65536
    v_add_u32 v206, s71, v206
    ds_read_b128 v[76:79], v58 offset:1024
    s_waitcnt lgkmcnt(4)
    v_mfma_f32_16x16x32_bf16 v[4:7], v[116:119], v[80:83], v[4:7]
    v_add_u32 v207, s71, v207
    s_mul_i32 s66, s2, 40960
    ds_read_b128 v[80:83], v51 offset:1024
    s_waitcnt lgkmcnt(4)
    v_mfma_f32_16x16x32_bf16 v[8:11], v[116:119], v[84:87], v[8:11]
    s_add_u32 s22, s66, s70
    s_add_u32 s23, s22, 0x4000
    ds_read_b128 v[84:87], v55 offset:1024
    s_waitcnt vmcnt(13) lgkmcnt(4)
    v_mfma_f32_16x16x32_bf16 v[0:3], v[120:123], v[88:91], v[0:3]
    s_lshl_b32 s70, s20, 10
    s_add_u32 s66, s66, s70
    ds_read_b128 v[88:91], v59 offset:1024
    s_waitcnt lgkmcnt(4)
    v_mfma_f32_16x16x32_bf16 v[4:7], v[120:123], v[92:95], v[4:7]
    s_add_u32 s66, s66, 0x8000
    s_add_u32 s70, s70, 65536
    ds_read_b128 v[92:95], v48 offset:128
    s_waitcnt lgkmcnt(4)
    v_mfma_f32_16x16x32_bf16 v[8:11], v[120:123], v[76:79], v[8:11]
    s_lshl_b32 s71, s20, 4
    v_xor_b32 v211, s71, v210
    ds_read_b128 v[76:79], v48 offset:256
    s_waitcnt vmcnt(12) lgkmcnt(4)
    v_mfma_f32_16x16x32_bf16 v[0:3], v[124:127], v[80:83], v[0:3]
    v_add_u32 v211, s70, v211
    ds_read_b128 v[80:83], v48 offset:384
    s_waitcnt lgkmcnt(4)
    v_mfma_f32_16x16x32_bf16 v[4:7], v[124:127], v[84:87], v[4:7]
    ds_read_b128 v[84:87], v49 offset:128
    s_waitcnt lgkmcnt(4)
    v_mfma_f32_16x16x32_bf16 v[8:11], v[124:127], v[88:91], v[8:11]
    ds_read_b128 v[88:91], v49 offset:256
    s_waitcnt vmcnt(11) lgkmcnt(4)
    v_mfma_f32_16x16x32_bf16 v[12:15], v[128:131], v[92:95], 0
    ds_read_b128 v[92:95], v49 offset:384
    s_waitcnt lgkmcnt(4)
    v_mfma_f32_16x16x32_bf16 v[24:27], v[128:131], v[76:79], 0
    ds_read_b128 v[76:79], v50 offset:128
    s_waitcnt lgkmcnt(4)
    v_mfma_f32_16x16x32_bf16 v[36:39], v[128:131], v[80:83], 0
    ds_read_b128 v[80:83], v50 offset:256
    s_waitcnt vmcnt(10) lgkmcnt(4)
    v_mfma_f32_16x16x32_bf16 v[12:15], v[132:135], v[84:87], v[12:15]
    v_mul_f32 v192, s67, v0
    v_mul_f32 v193, s67, v1
    ds_read_b128 v[84:87], v50 offset:384
    s_waitcnt lgkmcnt(4)
    v_mfma_f32_16x16x32_bf16 v[24:27], v[132:135], v[88:91], v[24:27]
    v_mul_f32 v194, s67, v2
    v_mul_f32 v195, s67, v3
    ds_read_b128 v[88:91], v51 offset:128
    s_waitcnt lgkmcnt(4)
    v_mfma_f32_16x16x32_bf16 v[36:39], v[132:135], v[92:95], v[36:39]
    v_exp_f32 v192, v192
    v_exp_f32 v193, v193
    ds_read_b128 v[92:95], v51 offset:256
    s_waitcnt vmcnt(9) lgkmcnt(4)
    v_mfma_f32_16x16x32_bf16 v[12:15], v[136:139], v[76:79], v[12:15]
    v_exp_f32 v194, v194
    v_exp_f32 v195, v195
    ds_read_b128 v[76:79], v51 offset:384
    s_waitcnt lgkmcnt(4)
    v_mfma_f32_16x16x32_bf16 v[24:27], v[136:139], v[80:83], v[24:27]
    v_add_f32 v192, 1.0, v192
    v_add_f32 v193, 1.0, v193
    ds_read_b128 v[80:83], v48 offset:512
    s_waitcnt lgkmcnt(4)
    v_mfma_f32_16x16x32_bf16 v[36:39], v[136:139], v[84:87], v[36:39]
    v_add_f32 v194, 1.0, v194
    v_add_f32 v195, 1.0, v195
    ds_read_b128 v[84:87], v48 offset:640
    s_waitcnt vmcnt(8) lgkmcnt(4)
    v_mfma_f32_16x16x32_bf16 v[12:15], v[140:143], v[88:91], v[12:15]
    v_rcp_f32 v192, v192
    v_rcp_f32 v193, v193
    ds_read_b128 v[88:91], v48 offset:768
    s_waitcnt lgkmcnt(4)
    v_mfma_f32_16x16x32_bf16 v[24:27], v[140:143], v[92:95], v[24:27]
    v_rcp_f32 v194, v194
    v_rcp_f32 v195, v195
    ds_read_b128 v[92:95], v49 offset:512
    s_waitcnt lgkmcnt(4)
    v_mfma_f32_16x16x32_bf16 v[36:39], v[140:143], v[76:79], v[36:39]
    v_mul_f32 v196, s67, v4
    v_mul_f32 v197, s67, v5
    ds_read_b128 v[76:79], v49 offset:640
    s_waitcnt vmcnt(7) lgkmcnt(4)
    v_mfma_f32_16x16x32_bf16 v[12:15], v[144:147], v[80:83], v[12:15]
    v_mul_f32 v198, s67, v6
    v_mul_f32 v199, s67, v7
    ds_read_b128 v[80:83], v49 offset:768
    s_waitcnt lgkmcnt(4)
    v_mfma_f32_16x16x32_bf16 v[24:27], v[144:147], v[84:87], v[24:27]
    v_exp_f32 v196, v196
    v_exp_f32 v197, v197
    ds_read_b128 v[84:87], v50 offset:512
    s_waitcnt lgkmcnt(4)
    v_mfma_f32_16x16x32_bf16 v[36:39], v[144:147], v[88:91], v[36:39]
    v_exp_f32 v198, v198
    v_exp_f32 v199, v199
    ds_read_b128 v[88:91], v50 offset:640
    s_waitcnt vmcnt(6) lgkmcnt(4)
    v_mfma_f32_16x16x32_bf16 v[12:15], v[148:151], v[92:95], v[12:15]
    v_add_f32 v196, 1.0, v196
    v_add_f32 v197, 1.0, v197
    ds_read_b128 v[92:95], v50 offset:768
    s_waitcnt lgkmcnt(4)
    v_mfma_f32_16x16x32_bf16 v[24:27], v[148:151], v[76:79], v[24:27]
    v_add_f32 v198, 1.0, v198
    v_add_f32 v199, 1.0, v199
    ds_read_b128 v[76:79], v51 offset:512
    s_waitcnt lgkmcnt(4)
    v_mfma_f32_16x16x32_bf16 v[36:39], v[148:151], v[80:83], v[36:39]
    v_rcp_f32 v196, v196
    v_rcp_f32 v197, v197
    ds_read_b128 v[80:83], v51 offset:640
    s_waitcnt vmcnt(5) lgkmcnt(4)
    v_mfma_f32_16x16x32_bf16 v[12:15], v[152:155], v[84:87], v[12:15]
    v_rcp_f32 v198, v198
    v_rcp_f32 v199, v199
    ds_read_b128 v[84:87], v51 offset:768
    s_waitcnt lgkmcnt(4)
    v_mfma_f32_16x16x32_bf16 v[24:27], v[152:155], v[88:91], v[24:27]
    v_mul_f32 v200, s67, v8
    v_mul_f32 v201, s67, v9
    ds_read_b128 v[88:91], v48 offset:1152
    s_waitcnt lgkmcnt(4)
    v_mfma_f32_16x16x32_bf16 v[36:39], v[152:155], v[92:95], v[36:39]
    v_mul_f32 v202, s67, v10
    v_mul_f32 v203, s67, v11
    ds_read_b128 v[92:95], v48 offset:1280
    s_waitcnt vmcnt(4) lgkmcnt(4)
    v_mfma_f32_16x16x32_bf16 v[12:15], v[156:159], v[76:79], v[12:15]
    v_exp_f32 v200, v200
    v_exp_f32 v201, v201
    ds_read_b128 v[76:79], v48 offset:896
    s_waitcnt lgkmcnt(4)
    v_mfma_f32_16x16x32_bf16 v[24:27], v[156:159], v[80:83], v[24:27]
    v_exp_f32 v202, v202
    v_exp_f32 v203, v203
    ds_read_b128 v[80:83], v49 offset:1152
    s_waitcnt lgkmcnt(4)
    v_mfma_f32_16x16x32_bf16 v[36:39], v[156:159], v[84:87], v[36:39]
    v_add_f32 v200, 1.0, v200
    v_add_f32 v201, 1.0, v201
    ds_read_b128 v[84:87], v49 offset:1280
    s_waitcnt vmcnt(3) lgkmcnt(4)
    v_mfma_f32_16x16x32_bf16 v[12:15], v[160:163], v[88:91], v[12:15]
    v_add_f32 v202, 1.0, v202
    v_add_f32 v203, 1.0, v203
    ds_read_b128 v[88:91], v49 offset:896
    s_waitcnt lgkmcnt(4)
    v_mfma_f32_16x16x32_bf16 v[24:27], v[160:163], v[92:95], v[24:27]
    v_rcp_f32 v200, v200
    v_rcp_f32 v201, v201
    ds_read_b128 v[92:95], v50 offset:1152
    s_waitcnt lgkmcnt(4)
    v_mfma_f32_16x16x32_bf16 v[36:39], v[160:163], v[76:79], v[36:39]
    v_rcp_f32 v202, v202
    v_rcp_f32 v203, v203
    ds_read_b128 v[76:79], v50 offset:1280
    s_waitcnt vmcnt(2) lgkmcnt(4)
    v_mfma_f32_16x16x32_bf16 v[12:15], v[164:167], v[80:83], v[12:15]
    v_cvt_pk_bf16_f32 v0, v0, v1
    v_cvt_pk_bf16_f32 v1, v2, v3
    ds_read_b128 v[80:83], v50 offset:896
    s_waitcnt lgkmcnt(4)
    v_mfma_f32_16x16x32_bf16 v[24:27], v[164:167], v[84:87], v[24:27]
    ds_write_b64 v204, v[0:1] offset:0
    ds_read_b128 v[84:87], v51 offset:1152
    s_waitcnt lgkmcnt(5)
    v_mfma_f32_16x16x32_bf16 v[36:39], v[164:167], v[88:91], v[36:39]
    v_mov_b32_dpp v200, v200 row_ror:8 row_mask:0xf bank_mask:0xc
    v_mov_b32_dpp v201, v201 row_ror:8 row_mask:0xf bank_mask:0xc
    ds_read_b128 v[88:91], v51 offset:1280
    s_waitcnt vmcnt(1) lgkmcnt(5)
    v_mfma_f32_16x16x32_bf16 v[12:15], v[168:171], v[92:95], v[12:15]
    v_mov_b32_dpp v202, v202 row_ror:8 row_mask:0xf bank_mask:0xc
    v_mov_b32_dpp v203, v203 row_ror:8 row_mask:0xf bank_mask:0xc
    ds_read_b128 v[92:95], v51 offset:896
    s_waitcnt lgkmcnt(5)
    v_mfma_f32_16x16x32_bf16 v[24:27], v[168:171], v[76:79], v[24:27]
    ds_read_b128 v[76:79], v52 offset:128
    s_waitcnt lgkmcnt(5)
    v_mfma_f32_16x16x32_bf16 v[36:39], v[168:171], v[80:83], v[36:39]
    ds_read_b128 v[80:83], v53 offset:128
    s_waitcnt vmcnt(0) lgkmcnt(4)
    v_mfma_f32_16x16x32_bf16 v[12:15], v[172:175], v[84:87], v[12:15]
    ds_read_b128 v[84:87], v54 offset:128
    s_waitcnt lgkmcnt(4)
    v_mfma_f32_16x16x32_bf16 v[24:27], v[172:175], v[88:91], v[24:27]
    ds_read_b128 v[88:91], v55 offset:128
    s_waitcnt lgkmcnt(4)
    v_mfma_f32_16x16x32_bf16 v[36:39], v[172:175], v[92:95], v[36:39]
    ds_read_b128 v[92:95], v52 offset:512
    s_waitcnt lgkmcnt(4)
    v_mfma_f32_16x16x32_bf16 v[16:19], v[128:131], v[76:79], 0
    ds_read_b128 v[76:79], v53 offset:512
    s_waitcnt lgkmcnt(4)
    v_mfma_f32_16x16x32_bf16 v[16:19], v[132:135], v[80:83], v[16:19]
    ds_read_b128 v[80:83], v54 offset:512
    s_waitcnt lgkmcnt(4)
    v_mfma_f32_16x16x32_bf16 v[16:19], v[136:139], v[84:87], v[16:19]
    v_mul_f32 v12, v12, v192
    v_mul_f32 v13, v13, v193
    ds_read_b128 v[84:87], v55 offset:512
    s_waitcnt lgkmcnt(4)
    v_mfma_f32_16x16x32_bf16 v[16:19], v[140:143], v[88:91], v[16:19]
    v_mul_f32 v14, v14, v194
    v_mul_f32 v15, v15, v195
    ds_read_b128 v[88:91], v52 offset:1152
    s_waitcnt lgkmcnt(4)
    v_mfma_f32_16x16x32_bf16 v[16:19], v[144:147], v[92:95], v[16:19]
    v_cvt_pk_bf16_f32 v12, v12, v13
    v_cvt_pk_bf16_f32 v13, v14, v15
    ds_read_b128 v[92:95], v53 offset:1152
    s_waitcnt lgkmcnt(4)
    v_mfma_f32_16x16x32_bf16 v[16:19], v[148:151], v[76:79], v[16:19]
    ds_write_b64 v204, v[12:13] offset:256
    v_mul_f32 v24, v24, v192
    ds_read_b128 v[76:79], v54 offset:1152
    s_waitcnt lgkmcnt(5)
    v_mfma_f32_16x16x32_bf16 v[16:19], v[152:155], v[80:83], v[16:19]
    v_mul_f32 v25, v25, v193
    v_mul_f32 v26, v26, v194
    ds_read_b128 v[80:83], v55 offset:1152
    s_waitcnt lgkmcnt(5)
    v_mfma_f32_16x16x32_bf16 v[16:19], v[156:159], v[84:87], v[16:19]
    v_mul_f32 v27, v27, v195
    v_cvt_pk_bf16_f32 v24, v24, v25
    ds_read_b128 v[84:87], v52 offset:256
    s_waitcnt lgkmcnt(5)
    v_mfma_f32_16x16x32_bf16 v[16:19], v[160:163], v[88:91], v[16:19]
    v_cvt_pk_bf16_f32 v25, v26, v27
    ds_write_b64 v204, v[24:25] offset:512
    ds_read_b128 v[88:91], v53 offset:256
    s_waitcnt lgkmcnt(6)
    v_mfma_f32_16x16x32_bf16 v[16:19], v[164:167], v[92:95], v[16:19]
    v_mul_f32 v36, v36, v192
    v_mul_f32 v37, v37, v193
    ds_read_b128 v[92:95], v54 offset:256
    s_waitcnt lgkmcnt(5)
    v_mfma_f32_16x16x32_bf16 v[16:19], v[168:171], v[76:79], v[16:19]
    v_mul_f32 v38, v38, v194
    v_mul_f32 v39, v39, v195
    ds_read_b128 v[76:79], v55 offset:256
    s_waitcnt lgkmcnt(5)
    v_mfma_f32_16x16x32_bf16 v[16:19], v[172:175], v[80:83], v[16:19]
    v_cvt_pk_bf16_f32 v36, v36, v37
    v_cvt_pk_bf16_f32 v37, v38, v39
    ds_read_b128 v[80:83], v52 offset:640
    s_waitcnt lgkmcnt(5)
    v_mfma_f32_16x16x32_bf16 v[28:31], v[128:131], v[84:87], 0
    ds_write_b64 v204, v[36:37] offset:768
    ds_read_b128 v[84:87], v53 offset:640
    s_waitcnt lgkmcnt(5)
    v_mfma_f32_16x16x32_bf16 v[28:31], v[132:135], v[88:91], v[28:31]
    ds_read_b128 v[88:91], v54 offset:640
    s_waitcnt lgkmcnt(5)
    v_mfma_f32_16x16x32_bf16 v[28:31], v[136:139], v[92:95], v[28:31]
    ds_read_b128 v[92:95], v55 offset:640
    s_waitcnt lgkmcnt(5)
    v_mfma_f32_16x16x32_bf16 v[28:31], v[140:143], v[76:79], v[28:31]
    ds_read_b128 v[76:79], v52 offset:1280
    s_waitcnt lgkmcnt(5)
    v_mfma_f32_16x16x32_bf16 v[28:31], v[144:147], v[80:83], v[28:31]
    ds_read_b128 v[80:83], v53 offset:1280
    s_waitcnt lgkmcnt(4)
    v_mfma_f32_16x16x32_bf16 v[28:31], v[148:151], v[84:87], v[28:31]
    s_barrier
    ds_read_b128 v[84:87], v54 offset:1280
    s_waitcnt lgkmcnt(4)
    v_mfma_f32_16x16x32_bf16 v[28:31], v[152:155], v[88:91], v[28:31]
    ds_read_b128 v[212:215], v206 offset:0
    ds_read_b128 v[216:219], v207 offset:1024
    ds_read_b128 v[88:91], v55 offset:1280
    s_waitcnt lgkmcnt(6)
    v_mfma_f32_16x16x32_bf16 v[28:31], v[156:159], v[92:95], v[28:31]
    ds_read_b128 v[92:95], v52 offset:384
    s_waitcnt lgkmcnt(6)
    v_mfma_f32_16x16x32_bf16 v[28:31], v[160:163], v[76:79], v[28:31]
    ds_read_b128 v[76:79], v53 offset:384
    s_waitcnt lgkmcnt(6)
    v_mfma_f32_16x16x32_bf16 v[28:31], v[164:167], v[80:83], v[28:31]
    ds_read_b128 v[80:83], v54 offset:384
    s_waitcnt lgkmcnt(6)
    v_mfma_f32_16x16x32_bf16 v[28:31], v[168:171], v[84:87], v[28:31]
    ds_read_b128 v[84:87], v55 offset:384
    s_waitcnt lgkmcnt(4)
    v_mfma_f32_16x16x32_bf16 v[28:31], v[172:175], v[88:91], v[28:31]
    buffer_store_dwordx4 v[212:215], v210, s[4:7], s22 offen offset:0 sc1
    ds_read_b128 v[88:91], v52 offset:768
    s_waitcnt lgkmcnt(4)
    v_mfma_f32_16x16x32_bf16 v[40:43], v[128:131], v[92:95], 0
    buffer_store_dwordx4 v[216:219], v210, s[4:7], s22 offen offset:1024 sc1
    ds_read_b128 v[92:95], v53 offset:768
    s_waitcnt lgkmcnt(4)
    v_mfma_f32_16x16x32_bf16 v[40:43], v[132:135], v[76:79], v[40:43]
    ds_read_b128 v[76:79], v54 offset:768
    s_waitcnt lgkmcnt(4)
    v_mfma_f32_16x16x32_bf16 v[40:43], v[136:139], v[80:83], v[40:43]
    ds_read_b128 v[80:83], v55 offset:768
    s_waitcnt lgkmcnt(4)
    v_mfma_f32_16x16x32_bf16 v[40:43], v[140:143], v[84:87], v[40:43]
    v_cvt_pk_bf16_f32 v4, v4, v5
    v_cvt_pk_bf16_f32 v5, v6, v7
    ds_read_b128 v[84:87], v52 offset:896
    s_waitcnt lgkmcnt(4)
    v_mfma_f32_16x16x32_bf16 v[40:43], v[144:147], v[88:91], v[40:43]
    ds_write_b64 v205, v[4:5] offset:0
    v_mul_f32 v16, v16, v196
    ds_read_b128 v[88:91], v53 offset:896
    s_waitcnt lgkmcnt(5)
    v_mfma_f32_16x16x32_bf16 v[40:43], v[148:151], v[92:95], v[40:43]
    v_mul_f32 v17, v17, v197
    v_mul_f32 v18, v18, v198
    ds_read_b128 v[92:95], v54 offset:896
    s_waitcnt lgkmcnt(5)
    v_mfma_f32_16x16x32_bf16 v[40:43], v[152:155], v[76:79], v[40:43]
    v_mul_f32 v19, v19, v199
    v_cvt_pk_bf16_f32 v16, v16, v17
    ds_read_b128 v[76:79], v55 offset:896
    s_waitcnt lgkmcnt(5)
    v_mfma_f32_16x16x32_bf16 v[40:43], v[156:159], v[80:83], v[40:43]
    v_cvt_pk_bf16_f32 v17, v18, v19
    ds_write_b64 v205, v[16:17] offset:256
    ds_read_b128 v[80:83], v56 offset:128
    s_waitcnt lgkmcnt(6)
    v_mfma_f32_16x16x32_bf16 v[40:43], v[160:163], v[84:87], v[40:43]
    v_mul_f32 v28, v28, v196
    v_mul_f32 v29, v29, v197
    ds_read_b128 v[84:87], v57 offset:128
    s_waitcnt lgkmcnt(5)
    v_mfma_f32_16x16x32_bf16 v[40:43], v[164:167], v[88:91], v[40:43]
    v_mul_f32 v30, v30, v198
    v_mul_f32 v31, v31, v199
    ds_read_b128 v[88:91], v58 offset:128
    s_waitcnt lgkmcnt(5)
    v_mfma_f32_16x16x32_bf16 v[40:43], v[168:171], v[92:95], v[40:43]
    v_cvt_pk_bf16_f32 v28, v28, v29
    v_cvt_pk_bf16_f32 v29, v30, v31
    ds_read_b128 v[92:95], v59 offset:128
    s_waitcnt lgkmcnt(5)
    v_mfma_f32_16x16x32_bf16 v[40:43], v[172:175], v[76:79], v[40:43]
    ds_write_b64 v205, v[28:29] offset:512
    ds_read_b128 v[76:79], v56 offset:512
    s_waitcnt lgkmcnt(5)
    v_mfma_f32_16x16x32_bf16 v[20:23], v[128:131], v[80:83], 0
    ds_read_b128 v[80:83], v57 offset:512
    s_waitcnt lgkmcnt(5)
    v_mfma_f32_16x16x32_bf16 v[20:23], v[132:135], v[84:87], v[20:23]
    ds_read_b128 v[84:87], v58 offset:512
    s_waitcnt lgkmcnt(5)
    v_mfma_f32_16x16x32_bf16 v[20:23], v[136:139], v[88:91], v[20:23]
    ds_read_b128 v[88:91], v59 offset:512
    s_waitcnt lgkmcnt(5)
    v_mfma_f32_16x16x32_bf16 v[20:23], v[140:143], v[92:95], v[20:23]
    v_mul_f32 v40, v40, v196
    v_mul_f32 v41, v41, v197
    ds_read_b128 v[92:95], v56 offset:1152
    s_waitcnt lgkmcnt(4)
    v_mfma_f32_16x16x32_bf16 v[20:23], v[144:147], v[76:79], v[20:23]
    v_mul_f32 v42, v42, v198
    v_mul_f32 v43, v43, v199
    ds_read_b128 v[76:79], v57 offset:1152
    s_waitcnt lgkmcnt(4)
    v_mfma_f32_16x16x32_bf16 v[20:23], v[148:151], v[80:83], v[20:23]
    v_cvt_pk_bf16_f32 v40, v40, v41
    v_cvt_pk_bf16_f32 v41, v42, v43
    ds_read_b128 v[80:83], v58 offset:1152
    s_waitcnt lgkmcnt(4)
    v_mfma_f32_16x16x32_bf16 v[20:23], v[152:155], v[84:87], v[20:23]
    ds_write_b64 v205, v[40:41] offset:768
    ds_read_b128 v[84:87], v59 offset:1152
    s_waitcnt lgkmcnt(5)
    v_mfma_f32_16x16x32_bf16 v[20:23], v[156:159], v[88:91], v[20:23]
    ds_read_b128 v[88:91], v56 offset:384
    s_waitcnt lgkmcnt(5)
    v_mfma_f32_16x16x32_bf16 v[20:23], v[160:163], v[92:95], v[20:23]
    ds_read_b128 v[92:95], v57 offset:384
    s_waitcnt lgkmcnt(5)
    v_mfma_f32_16x16x32_bf16 v[20:23], v[164:167], v[76:79], v[20:23]
    s_waitcnt lgkmcnt(3)
    s_barrier
    ds_read_b128 v[76:79], v58 offset:384
    v_mfma_f32_16x16x32_bf16 v[20:23], v[168:171], v[80:83], v[20:23]
    ds_read_b128 v[212:215], v208 offset:0
    ds_read_b128 v[216:219], v209 offset:0
    ds_read_b128 v[80:83], v59 offset:384
    s_waitcnt lgkmcnt(6)
    v_mfma_f32_16x16x32_bf16 v[20:23], v[172:175], v[84:87], v[20:23]
    ds_read_b128 v[84:87], v56 offset:768
    s_waitcnt lgkmcnt(6)
    v_mfma_f32_16x16x32_bf16 v[44:47], v[128:131], v[88:91], 0
    ds_read_b128 v[88:91], v57 offset:768
    s_waitcnt lgkmcnt(6)
    v_mfma_f32_16x16x32_bf16 v[44:47], v[132:135], v[92:95], v[44:47]
    ds_read_b128 v[92:95], v58 offset:768
    s_waitcnt lgkmcnt(6)
    v_mfma_f32_16x16x32_bf16 v[44:47], v[136:139], v[76:79], v[44:47]
    s_waitcnt lgkmcnt(5)
    buffer_store_dwordx4 v[212:215], v210, s[4:7], s23 offen offset:0 sc1
    ds_read_b128 v[76:79], v59 offset:768
    s_waitcnt lgkmcnt(4)
    v_mfma_f32_16x16x32_bf16 v[44:47], v[140:143], v[80:83], v[44:47]
    buffer_store_dwordx4 v[216:219], v210, s[4:7], s23 offen offset:1024 sc1
    ds_read_b128 v[80:83], v56 offset:896
    s_waitcnt lgkmcnt(4)
    v_mfma_f32_16x16x32_bf16 v[44:47], v[144:147], v[84:87], v[44:47]
    ds_read_b128 v[84:87], v57 offset:896
    s_waitcnt lgkmcnt(4)
    v_mfma_f32_16x16x32_bf16 v[44:47], v[148:151], v[88:91], v[44:47]
    ds_read_b128 v[88:91], v58 offset:896
    s_waitcnt lgkmcnt(4)
    v_mfma_f32_16x16x32_bf16 v[44:47], v[152:155], v[92:95], v[44:47]
    ds_read_b128 v[92:95], v59 offset:896
    s_waitcnt lgkmcnt(4)
    v_mfma_f32_16x16x32_bf16 v[44:47], v[156:159], v[76:79], v[44:47]
    v_cvt_pk_bf16_f32 v8, v8, v9
    v_cvt_pk_bf16_f32 v9, v10, v11
    s_waitcnt lgkmcnt(3)
    v_mfma_f32_16x16x32_bf16 v[44:47], v[160:163], v[80:83], v[44:47]
    ds_write_b64 v204, v[8:9] offset:0
    v_mul_f32 v20, v20, v200
    s_waitcnt lgkmcnt(3)
    v_mfma_f32_16x16x32_bf16 v[44:47], v[164:167], v[84:87], v[44:47]
    v_mul_f32 v21, v21, v201
    v_mul_f32 v22, v22, v202
    s_waitcnt lgkmcnt(2)
    v_mfma_f32_16x16x32_bf16 v[44:47], v[168:171], v[88:91], v[44:47]
    v_mul_f32 v23, v23, v203
    v_cvt_pk_bf16_f32 v20, v20, v21
    s_waitcnt lgkmcnt(1)
    v_mfma_f32_16x16x32_bf16 v[44:47], v[172:175], v[92:95], v[44:47]
    v_cvt_pk_bf16_f32 v21, v22, v23
    ds_write_b64 v220, v[20:21] offset:256
    s_nop 5
    v_mul_f32 v44, v44, v200
    v_mul_f32 v45, v45, v201
    v_mul_f32 v46, v46, v202
    v_mul_f32 v47, v47, v203
    v_cvt_pk_bf16_f32 v44, v44, v45
    v_cvt_pk_bf16_f32 v45, v46, v47
    ds_write_b64 v204, v[44:45] offset:768
    s_waitcnt lgkmcnt(0)
    s_barrier
    ds_read_b128 v[212:215], v211 offset:0
    s_waitcnt lgkmcnt(0)
    buffer_store_dwordx4 v[212:215], v210, s[4:7], s66 offen offset:0 sc1
    s_or_b32 s89, s89, s20
    s_cbranch_scc1 K2_end
    v_mov_b32 v0, 0
    v_mov_b32 v1, s88
    s_mov_b64 exec, 1
    buffer_store_dword v1, v0, s[16:19], 0 offen
K2_end:
K2_last:
    s_endpgm
SLOW:
    v_readlane_b32 s89, v4, 62
    s_waitcnt vmcnt(0) lgkmcnt(0)
    s_barrier
    s_load_dwordx2 s[22:23], s[0:1], 8
    s_load_dwordx2 s[24:25], s[0:1], 24
    s_load_dwordx2 s[26:27], s[0:1], 32
    s_load_dwordx2 s[28:29], s[0:1], 40
    s_load_dwordx2 s[30:31], s[0:1], 0
    v_mbcnt_lo_u32_b32 v240, -1, 0
    v_mbcnt_hi_u32_b32 v240, -1, v240
    v_lshrrev_b32 v229, 5, v240
    v_and_b32 v230, 31, v240
    v_lshlrev_b32 v241, 7, v229
    v_lshl_add_u32 v241, v230, 1, v241
    v_lshlrev_b32 v245, 4, v240
    v_mov_b32 v242, 0
    s_waitcnt lgkmcnt(0)
    s_mov_b32 s80, s22
    s_and_b32 s81, s23, 0xffff
    s_mov_b32 s82, 1920000
    s_mov_b32 s83, 0x20000
    s_mov_b32 s76, s24
    s_and_b32 s77, s25, 0xffff
    s_mov_b32 s78, 1280000
    s_mov_b32 s79, 0x20000
    s_mov_b32 s72, s26
    s_and_b32 s73, s27, 0xffff
    s_mov_b32 s74, 1280000
    s_mov_b32 s75, 0x20000
    s_mov_b32 s84, s28
    s_and_b32 s85, s29, 0xffff
    s_mov_b32 s86, 20480
    s_mov_b32 s87, 0x20000
    s_mov_b32 s4, s30
    s_and_b32 s5, s31, 0xffff
    s_mov_b32 s6, 10240000
    s_mov_b32 s7, 0x20000
    s_mov_b32 s66, 0
    buffer_load_ushort v0, v241, s[84:87], s66 offen offset:0
    buffer_load_ushort v1, v241, s[84:87], s66 offen offset:64
    buffer_load_ushort v2, v241, s[84:87], s66 offen offset:256
    buffer_load_ushort v3, v241, s[84:87], s66 offen offset:320
    buffer_load_ushort v4, v241, s[84:87], s66 offen offset:512
    buffer_load_ushort v5, v241, s[84:87], s66 offen offset:576
    buffer_load_ushort v6, v241, s[84:87], s66 offen offset:768
    buffer_load_ushort v7, v241, s[84:87], s66 offen offset:832
    buffer_load_ushort v8, v241, s[84:87], s66 offen offset:1024
    buffer_load_ushort v9, v241, s[84:87], s66 offen offset:1088
    s_waitcnt vmcnt(0)
    s_mov_b32 s66, 1280
    buffer_load_ushort v10, v241, s[84:87], s66 offen offset:0
    buffer_load_ushort v11, v241, s[84:87], s66 offen offset:64
    buffer_load_ushort v12, v241, s[84:87], s66 offen offset:256
    buffer_load_ushort v13, v241, s[84:87], s66 offen offset:320
    buffer_load_ushort v14, v241, s[84:87], s66 offen offset:512
    buffer_load_ushort v15, v241, s[84:87], s66 offen offset:576
    buffer_load_ushort v16, v241, s[84:87], s66 offen offset:768
    buffer_load_ushort v17, v241, s[84:87], s66 offen offset:832
    buffer_load_ushort v18, v241, s[84:87], s66 offen offset:1024
    buffer_load_ushort v19, v241, s[84:87], s66 offen offset:1088
    s_waitcnt vmcnt(0)
    s_mov_b32 s66, 2560
    buffer_load_ushort v20, v241, s[84:87], s66 offen offset:0
    buffer_load_ushort v21, v241, s[84:87], s66 offen offset:64
    buffer_load_ushort v22, v241, s[84:87], s66 offen offset:256
    buffer_load_ushort v23, v241, s[84:87], s66 offen offset:320
    buffer_load_ushort v24, v241, s[84:87], s66 offen offset:512
    buffer_load_ushort v25, v241, s[84:87], s66 offen offset:576
    buffer_load_ushort v26, v241, s[84:87], s66 offen offset:768
    buffer_load_ushort v27, v241, s[84:87], s66 offen offset:832
    buffer_load_ushort v28, v241, s[84:87], s66 offen offset:1024
    buffer_load_ushort v29, v241, s[84:87], s66 offen offset:1088
    s_waitcnt vmcnt(0)
    s_mov_b32 s66, 3840
    buffer_load_ushort v30, v241, s[84:87], s66 offen offset:0
    buffer_load_ushort v31, v241, s[84:87], s66 offen offset:64
    buffer_load_ushort v32, v241, s[84:87], s66 offen offset:256
    buffer_load_ushort v33, v241, s[84:87], s66 offen offset:320
    buffer_load_ushort v34, v241, s[84:87], s66 offen offset:512
    buffer_load_ushort v35, v241, s[84:87], s66 offen offset:576
    buffer_load_ushort v36, v241, s[84:87], s66 offen offset:768
    buffer_load_ushort v37, v241, s[84:87], s66 offen offset:832
    buffer_load_ushort v38, v241, s[84:87], s66 offen offset:1024
    buffer_load_ushort v39, v241, s[84:87], s66 offen offset:1088
    s_waitcnt vmcnt(0)
    s_mov_b32 s66, 5120
    buffer_load_ushort v40, v241, s[84:87], s66 offen offset:0
    buffer_load_ushort v41, v241, s[84:87], s66 offen offset:64
    buffer_load_ushort v42, v241, s[84:87], s66 offen offset:256
    buffer_load_ushort v43, v241, s[84:87], s66 offen offset:320
    buffer_load_ushort v44, v241, s[84:87], s66 offen offset:512
    buffer_load_ushort v45, v241, s[84:87], s66 offen offset:576
    buffer_load_ushort v46, v241, s[84:87], s66 offen offset:768
    buffer_load_ushort v47, v241, s[84:87], s66 offen offset:832
    buffer_load_ushort v48, v241, s[84:87], s66 offen offset:1024
    buffer_load_ushort v49, v241, s[84:87], s66 offen offset:1088
    s_waitcnt vmcnt(0)
    s_mov_b32 s66, 6400
    buffer_load_ushort v50, v241, s[84:87], s66 offen offset:0
    buffer_load_ushort v51, v241, s[84:87], s66 offen offset:64
    buffer_load_ushort v52, v241, s[84:87], s66 offen offset:256
    buffer_load_ushort v53, v241, s[84:87], s66 offen offset:320
    buffer_load_ushort v54, v241, s[84:87], s66 offen offset:512
    buffer_load_ushort v55, v241, s[84:87], s66 offen offset:576
    buffer_load_ushort v56, v241, s[84:87], s66 offen offset:768
    buffer_load_ushort v57, v241, s[84:87], s66 offen offset:832
    buffer_load_ushort v58, v241, s[84:87], s66 offen offset:1024
    buffer_load_ushort v59, v241, s[84:87], s66 offen offset:1088
    s_waitcnt vmcnt(0)
    s_mov_b32 s66, 7680
    buffer_load_ushort v60, v241, s[84:87], s66 offen offset:0
    buffer_load_ushort v61, v241, s[84:87], s66 offen offset:64
    buffer_load_ushort v62, v241, s[84:87], s66 offen offset:256
    buffer_load_ushort v63, v241, s[84:87], s66 offen offset:320
    buffer_load_ushort v64, v241, s[84:87], s66 offen offset:512
    buffer_load_ushort v65, v241, s[84:87], s66 offen offset:576
    buffer_load_ushort v66, v241, s[84:87], s66 offen offset:768
    buffer_load_ushort v67, v241, s[84:87], s66 offen offset:832
    buffer_load_ushort v68, v241, s[84:87], s66 offen offset:1024
    buffer_load_ushort v69, v241, s[84:87], s66 offen offset:1088
    s_waitcnt vmcnt(0)
    s_mov_b32 s66, 8960
    buffer_load_ushort v70, v241, s[84:87], s66 offen offset:0
    buffer_load_ushort v71, v241, s[84:87], s66 offen offset:64
    buffer_load_ushort v72, v241, s[84:87], s66 offen offset:256
    buffer_load_ushort v73, v241, s[84:87], s66 offen offset:320
    buffer_load_ushort v74, v241, s[84:87], s66 offen offset:512
    buffer_load_ushort v75, v241, s[84:87], s66 offen offset:576
    buffer_load_ushort v76, v241, s[84:87], s66 offen offset:768
    buffer_load_ushort v77, v241, s[84:87], s66 offen offset:832
    buffer_load_ushort v78, v241, s[84:87], s66 offen offset:1024
    buffer_load_ushort v79, v241, s[84:87], s66 offen offset:1088
    s_waitcnt vmcnt(0)
    s_mov_b32 s66, 10240
    buffer_load_ushort v80, v241, s[84:87], s66 offen offset:0
    buffer_load_ushort v81, v241, s[84:87], s66 offen offset:64
    buffer_load_ushort v82, v241, s[84:87], s66 offen offset:256
    buffer_load_ushort v83, v241, s[84:87], s66 offen offset:320
    buffer_load_ushort v84, v241, s[84:87], s66 offen offset:512
    buffer_load_ushort v85, v241, s[84:87], s66 offen offset:576
    buffer_load_ushort v86, v241, s[84:87], s66 offen offset:768
    buffer_load_ushort v87, v241, s[84:87], s66 offen offset:832
    buffer_load_ushort v88, v241, s[84:87], s66 offen offset:1024
    buffer_load_ushort v89, v241, s[84:87], s66 offen offset:1088
    s_waitcnt vmcnt(0)
    s_mov_b32 s66, 11520
    buffer_load_ushort v90, v241, s[84:87], s66 offen offset:0
    buffer_load_ushort v91, v241, s[84:87], s66 offen offset:64
    buffer_load_ushort v92, v241, s[84:87], s66 offen offset:256
    buffer_load_ushort v93, v241, s[84:87], s66 offen offset:320
    buffer_load_ushort v94, v241, s[84:87], s66 offen offset:512
    buffer_load_ushort v95, v241, s[84:87], s66 offen offset:576
    buffer_load_ushort v96, v241, s[84:87], s66 offen offset:768
    buffer_load_ushort v97, v241, s[84:87], s66 offen offset:832
    buffer_load_ushort v98, v241, s[84:87], s66 offen offset:1024
    buffer_load_ushort v99, v241, s[84:87], s66 offen offset:1088
    s_waitcnt vmcnt(0)
    s_mov_b32 s66, 12800
    buffer_load_ushort v100, v241, s[84:87], s66 offen offset:0
    buffer_load_ushort v101, v241, s[84:87], s66 offen offset:64
    buffer_load_ushort v102, v241, s[84:87], s66 offen offset:256
    buffer_load_ushort v103, v241, s[84:87], s66 offen offset:320
    buffer_load_ushort v104, v241, s[84:87], s66 offen offset:512
    buffer_load_ushort v105, v241, s[84:87], s66 offen offset:576
    buffer_load_ushort v106, v241, s[84:87], s66 offen offset:768
    buffer_load_ushort v107, v241, s[84:87], s66 offen offset:832
    buffer_load_ushort v108, v241, s[84:87], s66 offen offset:1024
    buffer_load_ushort v109, v241, s[84:87], s66 offen offset:1088
    s_waitcnt vmcnt(0)
    s_mov_b32 s66, 14080
    buffer_load_ushort v110, v241, s[84:87], s66 offen offset:0
    buffer_load_ushort v111, v241, s[84:87], s66 offen offset:64
    buffer_load_ushort v112, v241, s[84:87], s66 offen offset:256
    buffer_load_ushort v113, v241, s[84:87], s66 offen offset:320
    buffer_load_ushort v114, v241, s[84:87], s66 offen offset:512
    buffer_load_ushort v115, v241, s[84:87], s66 offen offset:576
    buffer_load_ushort v116, v241, s[84:87], s66 offen offset:768
    buffer_load_ushort v117, v241, s[84:87], s66 offen offset:832
    buffer_load_ushort v118, v241, s[84:87], s66 offen offset:1024
    buffer_load_ushort v119, v241, s[84:87], s66 offen offset:1088
    s_waitcnt vmcnt(0)
    s_mov_b32 s66, 15360
    buffer_load_ushort v120, v241, s[84:87], s66 offen offset:0
    buffer_load_ushort v121, v241, s[84:87], s66 offen offset:64
    buffer_load_ushort v122, v241, s[84:87], s66 offen offset:256
    buffer_load_ushort v123, v241, s[84:87], s66 offen offset:320
    buffer_load_ushort v124, v241, s[84:87], s66 offen offset:512
    buffer_load_ushort v125, v241, s[84:87], s66 offen offset:576
    buffer_load_ushort v126, v241, s[84:87], s66 offen offset:768
    buffer_load_ushort v127, v241, s[84:87], s66 offen offset:832
    buffer_load_ushort v128, v241, s[84:87], s66 offen offset:1024
    buffer_load_ushort v129, v241, s[84:87], s66 offen offset:1088
    s_waitcnt vmcnt(0)
    s_mov_b32 s66, 16640
    buffer_load_ushort v130, v241, s[84:87], s66 offen offset:0
    buffer_load_ushort v131, v241, s[84:87], s66 offen offset:64
    buffer_load_ushort v132, v241, s[84:87], s66 offen offset:256
    buffer_load_ushort v133, v241, s[84:87], s66 offen offset:320
    buffer_load_ushort v134, v241, s[84:87], s66 offen offset:512
    buffer_load_ushort v135, v241, s[84:87], s66 offen offset:576
    buffer_load_ushort v136, v241, s[84:87], s66 offen offset:768
    buffer_load_ushort v137, v241, s[84:87], s66 offen offset:832
    buffer_load_ushort v138, v241, s[84:87], s66 offen offset:1024
    buffer_load_ushort v139, v241, s[84:87], s66 offen offset:1088
    s_waitcnt vmcnt(0)
    s_mov_b32 s66, 17920
    buffer_load_ushort v140, v241, s[84:87], s66 offen offset:0
    buffer_load_ushort v141, v241, s[84:87], s66 offen offset:64
    buffer_load_ushort v142, v241, s[84:87], s66 offen offset:256
    buffer_load_ushort v143, v241, s[84:87], s66 offen offset:320
    buffer_load_ushort v144, v241, s[84:87], s66 offen offset:512
    buffer_load_ushort v145, v241, s[84:87], s66 offen offset:576
    buffer_load_ushort v146, v241, s[84:87], s66 offen offset:768
    buffer_load_ushort v147, v241, s[84:87], s66 offen offset:832
    buffer_load_ushort v148, v241, s[84:87], s66 offen offset:1024
    buffer_load_ushort v149, v241, s[84:87], s66 offen offset:1088
    s_waitcnt vmcnt(0)
    s_mov_b32 s66, 19200
    buffer_load_ushort v150, v241, s[84:87], s66 offen offset:0
    buffer_load_ushort v151, v241, s[84:87], s66 offen offset:64
    buffer_load_ushort v152, v241, s[84:87], s66 offen offset:256
    buffer_load_ushort v153, v241, s[84:87], s66 offen offset:320
    buffer_load_ushort v154, v241, s[84:87], s66 offen offset:512
    buffer_load_ushort v155, v241, s[84:87], s66 offen offset:576
    buffer_load_ushort v156, v241, s[84:87], s66 offen offset:768
    buffer_load_ushort v157, v241, s[84:87], s66 offen offset:832
    buffer_load_ushort v158, v241, s[84:87], s66 offen offset:1024
    buffer_load_ushort v159, v241, s[84:87], s66 offen offset:1088
    s_waitcnt vmcnt(0)
    v_lshlrev_b32 v0, 16, v0
    v_lshlrev_b32 v1, 16, v1
    v_lshlrev_b32 v2, 16, v2
    v_lshlrev_b32 v3, 16, v3
    v_lshlrev_b32 v4, 16, v4
    v_lshlrev_b32 v5, 16, v5
    v_lshlrev_b32 v6, 16, v6
    v_lshlrev_b32 v7, 16, v7
    v_lshlrev_b32 v8, 16, v8
    v_lshlrev_b32 v9, 16, v9
    v_lshlrev_b32 v10, 16, v10
    v_lshlrev_b32 v11, 16, v11
    v_lshlrev_b32 v12, 16, v12
    v_lshlrev_b32 v13, 16, v13
    v_lshlrev_b32 v14, 16, v14
    v_lshlrev_b32 v15, 16, v15
    v_lshlrev_b32 v16, 16, v16
    v_lshlrev_b32 v17, 16, v17
    v_lshlrev_b32 v18, 16, v18
    v_lshlrev_b32 v19, 16, v19
    v_lshlrev_b32 v20, 16, v20
    v_lshlrev_b32 v21, 16, v21
    v_lshlrev_b32 v22, 16, v22
    v_lshlrev_b32 v23, 16, v23
    v_lshlrev_b32 v24, 16, v24
    v_lshlrev_b32 v25, 16, v25
    v_lshlrev_b32 v26, 16, v26
    v_lshlrev_b32 v27, 16, v27
    v_lshlrev_b32 v28, 16, v28
    v_lshlrev_b32 v29, 16, v29
    v_lshlrev_b32 v30, 16, v30
    v_lshlrev_b32 v31, 16, v31
    v_lshlrev_b32 v32, 16, v32
    v_lshlrev_b32 v33, 16, v33
    v_lshlrev_b32 v34, 16, v34
    v_lshlrev_b32 v35, 16, v35
    v_lshlrev_b32 v36, 16, v36
    v_lshlrev_b32 v37, 16, v37
    v_lshlrev_b32 v38, 16, v38
    v_lshlrev_b32 v39, 16, v39
    v_lshlrev_b32 v40, 16, v40
    v_lshlrev_b32 v41, 16, v41
    v_lshlrev_b32 v42, 16, v42
    v_lshlrev_b32 v43, 16, v43
    v_lshlrev_b32 v44, 16, v44
    v_lshlrev_b32 v45, 16, v45
    v_lshlrev_b32 v46, 16, v46
    v_lshlrev_b32 v47, 16, v47
    v_lshlrev_b32 v48, 16, v48
    v_lshlrev_b32 v49, 16, v49
    v_lshlrev_b32 v50, 16, v50
    v_lshlrev_b32 v51, 16, v51
    v_lshlrev_b32 v52, 16, v52
    v_lshlrev_b32 v53, 16, v53
    v_lshlrev_b32 v54, 16, v54
    v_lshlrev_b32 v55, 16, v55
    v_lshlrev_b32 v56, 16, v56
    v_lshlrev_b32 v57, 16, v57
    v_lshlrev_b32 v58, 16, v58
    v_lshlrev_b32 v59, 16, v59
    v_lshlrev_b32 v60, 16, v60
    v_lshlrev_b32 v61, 16, v61
    v_lshlrev_b32 v62, 16, v62
    v_lshlrev_b32 v63, 16, v63
    v_lshlrev_b32 v64, 16, v64
    v_lshlrev_b32 v65, 16, v65
    v_lshlrev_b32 v66, 16, v66
    v_lshlrev_b32 v67, 16, v67
    v_lshlrev_b32 v68, 16, v68
    v_lshlrev_b32 v69, 16, v69
    v_lshlrev_b32 v70, 16, v70
    v_lshlrev_b32 v71, 16, v71
    v_lshlrev_b32 v72, 16, v72
    v_lshlrev_b32 v73, 16, v73
    v_lshlrev_b32 v74, 16, v74
    v_lshlrev_b32 v75, 16, v75
    v_lshlrev_b32 v76, 16, v76
    v_lshlrev_b32 v77, 16, v77
    v_lshlrev_b32 v78, 16, v78
    v_lshlrev_b32 v79, 16, v79
    v_lshlrev_b32 v80, 16, v80
    v_lshlrev_b32 v81, 16, v81
    v_lshlrev_b32 v82, 16, v82
    v_lshlrev_b32 v83, 16, v83
    v_lshlrev_b32 v84, 16, v84
    v_lshlrev_b32 v85, 16, v85
    v_lshlrev_b32 v86, 16, v86
    v_lshlrev_b32 v87, 16, v87
    v_lshlrev_b32 v88, 16, v88
    v_lshlrev_b32 v89, 16, v89
    v_lshlrev_b32 v90, 16, v90
    v_lshlrev_b32 v91, 16, v91
    v_lshlrev_b32 v92, 16, v92
    v_lshlrev_b32 v93, 16, v93
    v_lshlrev_b32 v94, 16, v94
    v_lshlrev_b32 v95, 16, v95
    v_lshlrev_b32 v96, 16, v96
    v_lshlrev_b32 v97, 16, v97
    v_lshlrev_b32 v98, 16, v98
    v_lshlrev_b32 v99, 16, v99
    v_lshlrev_b32 v100, 16, v100
    v_lshlrev_b32 v101, 16, v101
    v_lshlrev_b32 v102, 16, v102
    v_lshlrev_b32 v103, 16, v103
    v_lshlrev_b32 v104, 16, v104
    v_lshlrev_b32 v105, 16, v105
    v_lshlrev_b32 v106, 16, v106
    v_lshlrev_b32 v107, 16, v107
    v_lshlrev_b32 v108, 16, v108
    v_lshlrev_b32 v109, 16, v109
    v_lshlrev_b32 v110, 16, v110
    v_lshlrev_b32 v111, 16, v111
    v_lshlrev_b32 v112, 16, v112
    v_lshlrev_b32 v113, 16, v113
    v_lshlrev_b32 v114, 16, v114
    v_lshlrev_b32 v115, 16, v115
    v_lshlrev_b32 v116, 16, v116
    v_lshlrev_b32 v117, 16, v117
    v_lshlrev_b32 v118, 16, v118
    v_lshlrev_b32 v119, 16, v119
    v_lshlrev_b32 v120, 16, v120
    v_lshlrev_b32 v121, 16, v121
    v_lshlrev_b32 v122, 16, v122
    v_lshlrev_b32 v123, 16, v123
    v_lshlrev_b32 v124, 16, v124
    v_lshlrev_b32 v125, 16, v125
    v_lshlrev_b32 v126, 16, v126
    v_lshlrev_b32 v127, 16, v127
    v_lshlrev_b32 v128, 16, v128
    v_lshlrev_b32 v129, 16, v129
    v_lshlrev_b32 v130, 16, v130
    v_lshlrev_b32 v131, 16, v131
    v_lshlrev_b32 v132, 16, v132
    v_lshlrev_b32 v133, 16, v133
    v_lshlrev_b32 v134, 16, v134
    v_lshlrev_b32 v135, 16, v135
    v_lshlrev_b32 v136, 16, v136
    v_lshlrev_b32 v137, 16, v137
    v_lshlrev_b32 v138, 16, v138
    v_lshlrev_b32 v139, 16, v139
    v_lshlrev_b32 v140, 16, v140
    v_lshlrev_b32 v141, 16, v141
    v_lshlrev_b32 v142, 16, v142
    v_lshlrev_b32 v143, 16, v143
    v_lshlrev_b32 v144, 16, v144
    v_lshlrev_b32 v145, 16, v145
    v_lshlrev_b32 v146, 16, v146
    v_lshlrev_b32 v147, 16, v147
    v_lshlrev_b32 v148, 16, v148
    v_lshlrev_b32 v149, 16, v149
    v_lshlrev_b32 v150, 16, v150
    v_lshlrev_b32 v151, 16, v151
    v_lshlrev_b32 v152, 16, v152
    v_lshlrev_b32 v153, 16, v153
    v_lshlrev_b32 v154, 16, v154
    v_lshlrev_b32 v155, 16, v155
    v_lshlrev_b32 v156, 16, v156
    v_lshlrev_b32 v157, 16, v157
    v_lshlrev_b32 v158, 16, v158
    v_lshlrev_b32 v159, 16, v159
    s_mov_b32 s50, 0
SL_node:
    s_mul_i32 s34, s2, 40
    s_mul_i32 s66, s20, 5
    s_add_u32 s66, s66, s50
    s_add_u32 s34, s34, s66
    v_mov_b32 v160, 0
    v_mov_b32 v161, 0
    v_mov_b32 v162, 0
    v_mov_b32 v163, 0
    v_mov_b32 v164, 0
    v_mov_b32 v165, 0
    v_mov_b32 v166, 0
    v_mov_b32 v167, 0
    v_mov_b32 v168, 0
    v_mov_b32 v169, 0
    v_mov_b32 v170, 0
    v_mov_b32 v171, 0
    v_mov_b32 v172, 0
    v_mov_b32 v173, 0
    v_mov_b32 v174, 0
    v_mov_b32 v175, 0
    v_mov_b32 v176, 0
    v_mov_b32 v177, 0
    v_mov_b32 v178, 0
    v_mov_b32 v179, 0
    v_mov_b32 v180, 0
    v_mov_b32 v181, 0
    s_mov_b32 s35, 0
SL_scan:
    s_lshl_b32 s66, s35, 2
    buffer_load_dwordx4 v[236:239], v245, s[72:75], s66 offen
    s_waitcnt vmcnt(0)
    v_cmp_eq_u32 s[38:39], s34, v236
    v_cmp_eq_u32 s[40:41], s34, v237
    v_cmp_eq_u32 s[42:43], s34, v238
    v_cmp_eq_u32 s[44:45], s34, v239
    s_mov_b32 s36, 0
SL_bits:
    s_cmp_eq_u64 s[38:39], 0
    s_cbranch_scc1 SL_nexti
    s_ff1_i32_b64 s66, s[38:39]
    s_bitset0_b64 s[38:39], s66
    s_lshl_b32 s66, s66, 2
    s_add_u32 s37, s66, s36
    s_add_u32 s37, s37, s35
    s_lshl_b32 s66, s37, 2
    s_lshl_b32 s67, s37, 5
    s_mul_i32 s68, s37, 6
    buffer_load_dword v243, v242, s[76:79], s66 offen
    buffer_load_dwordx4 v[184:187], v242, s[12:15], s67 offen
    buffer_load_dwordx4 v[188:191], v242, s[12:15], s67 offen offset:16
    buffer_load_ushort v226, v242, s[80:83], s68 offen offset:0
    buffer_load_ushort v227, v242, s[80:83], s68 offen offset:2
    buffer_load_ushort v228, v242, s[80:83], s68 offen offset:4
    s_waitcnt vmcnt(5)
    v_lshl_add_u32 v243, v243, 10, v241
    buffer_load_ushort v208, v243, s[4:7], 0 offen offset:0
    buffer_load_ushort v209, v243, s[4:7], 0 offen offset:64
    buffer_load_ushort v210, v243, s[4:7], 0 offen offset:256
    buffer_load_ushort v211, v243, s[4:7], 0 offen offset:320
    buffer_load_ushort v212, v243, s[4:7], 0 offen offset:512
    buffer_load_ushort v213, v243, s[4:7], 0 offen offset:576
    buffer_load_ushort v214, v243, s[4:7], 0 offen offset:768
    buffer_load_ushort v215, v243, s[4:7], 0 offen offset:832
    s_waitcnt vmcnt(8)
    v_lshlrev_b32 v192, 16, v184
    v_and_b32 v193, 0xffff0000, v184
    v_lshlrev_b32 v194, 16, v185
    v_and_b32 v195, 0xffff0000, v185
    v_lshlrev_b32 v196, 16, v186
    v_and_b32 v197, 0xffff0000, v186
    v_lshlrev_b32 v198, 16, v187
    v_and_b32 v199, 0xffff0000, v187
    v_lshlrev_b32 v200, 16, v188
    v_and_b32 v201, 0xffff0000, v188
    v_lshlrev_b32 v202, 16, v189
    v_and_b32 v203, 0xffff0000, v189
    v_lshlrev_b32 v204, 16, v190
    v_and_b32 v205, 0xffff0000, v190
    v_lshlrev_b32 v206, 16, v191
    v_and_b32 v207, 0xffff0000, v191
    v_lshlrev_b32 v226, 16, v226
    v_lshlrev_b32 v227, 16, v227
    v_lshlrev_b32 v228, 16, v228
    v_mul_f32 v216, v192, v0
    v_mul_f32 v217, v192, v1
    v_mul_f32 v218, v192, v2
    v_mul_f32 v219, v192, v3
    v_mul_f32 v220, v192, v4
    v_mul_f32 v221, v192, v5
    v_mul_f32 v222, v192, v6
    v_mul_f32 v223, v192, v7
    v_mul_f32 v224, v192, v8
    v_mul_f32 v225, v192, v9
    v_fmac_f32 v216, v193, v10
    v_fmac_f32 v217, v193, v11
    v_fmac_f32 v218, v193, v12
    v_fmac_f32 v219, v193, v13
    v_fmac_f32 v220, v193, v14
    v_fmac_f32 v221, v193, v15
    v_fmac_f32 v222, v193, v16
    v_fmac_f32 v223, v193, v17
    v_fmac_f32 v224, v193, v18
    v_fmac_f32 v225, v193, v19
    v_fmac_f32 v216, v194, v20
    v_fmac_f32 v217, v194, v21
    v_fmac_f32 v218, v194, v22
    v_fmac_f32 v219, v194, v23
    v_fmac_f32 v220, v194, v24
    v_fmac_f32 v221, v194, v25
    v_fmac_f32 v222, v194, v26
    v_fmac_f32 v223, v194, v27
    v_fmac_f32 v224, v194, v28
    v_fmac_f32 v225, v194, v29
    v_fmac_f32 v216, v195, v30
    v_fmac_f32 v217, v195, v31
    v_fmac_f32 v218, v195, v32
    v_fmac_f32 v219, v195, v33
    v_fmac_f32 v220, v195, v34
    v_fmac_f32 v221, v195, v35
    v_fmac_f32 v222, v195, v36
    v_fmac_f32 v223, v195, v37
    v_fmac_f32 v224, v195, v38
    v_fmac_f32 v225, v195, v39
    v_fmac_f32 v216, v196, v40
    v_fmac_f32 v217, v196, v41
    v_fmac_f32 v218, v196, v42
    v_fmac_f32 v219, v196, v43
    v_fmac_f32 v220, v196, v44
    v_fmac_f32 v221, v196, v45
    v_fmac_f32 v222, v196, v46
    v_fmac_f32 v223, v196, v47
    v_fmac_f32 v224, v196, v48
    v_fmac_f32 v225, v196, v49
    v_fmac_f32 v216, v197, v50
    v_fmac_f32 v217, v197, v51
    v_fmac_f32 v218, v197, v52
    v_fmac_f32 v219, v197, v53
    v_fmac_f32 v220, v197, v54
    v_fmac_f32 v221, v197, v55
    v_fmac_f32 v222, v197, v56
    v_fmac_f32 v223, v197, v57
    v_fmac_f32 v224, v197, v58
    v_fmac_f32 v225, v197, v59
    v_fmac_f32 v216, v198, v60
    v_fmac_f32 v217, v198, v61
    v_fmac_f32 v218, v198, v62
    v_fmac_f32 v219, v198, v63
    v_fmac_f32 v220, v198, v64
    v_fmac_f32 v221, v198, v65
    v_fmac_f32 v222, v198, v66
    v_fmac_f32 v223, v198, v67
    v_fmac_f32 v224, v198, v68
    v_fmac_f32 v225, v198, v69
    v_fmac_f32 v216, v199, v70
    v_fmac_f32 v217, v199, v71
    v_fmac_f32 v218, v199, v72
    v_fmac_f32 v219, v199, v73
    v_fmac_f32 v220, v199, v74
    v_fmac_f32 v221, v199, v75
    v_fmac_f32 v222, v199, v76
    v_fmac_f32 v223, v199, v77
    v_fmac_f32 v224, v199, v78
    v_fmac_f32 v225, v199, v79
    v_fmac_f32 v216, v200, v80
    v_fmac_f32 v217, v200, v81
    v_fmac_f32 v218, v200, v82
    v_fmac_f32 v219, v200, v83
    v_fmac_f32 v220, v200, v84
    v_fmac_f32 v221, v200, v85
    v_fmac_f32 v222, v200, v86
    v_fmac_f32 v223, v200, v87
    v_fmac_f32 v224, v200, v88
    v_fmac_f32 v225, v200, v89
    v_fmac_f32 v216, v201, v90
    v_fmac_f32 v217, v201, v91
    v_fmac_f32 v218, v201, v92
    v_fmac_f32 v219, v201, v93
    v_fmac_f32 v220, v201, v94
    v_fmac_f32 v221, v201, v95
    v_fmac_f32 v222, v201, v96
    v_fmac_f32 v223, v201, v97
    v_fmac_f32 v224, v201, v98
    v_fmac_f32 v225, v201, v99
    v_fmac_f32 v216, v202, v100
    v_fmac_f32 v217, v202, v101
    v_fmac_f32 v218, v202, v102
    v_fmac_f32 v219, v202, v103
    v_fmac_f32 v220, v202, v104
    v_fmac_f32 v221, v202, v105
    v_fmac_f32 v222, v202, v106
    v_fmac_f32 v223, v202, v107
    v_fmac_f32 v224, v202, v108
    v_fmac_f32 v225, v202, v109
    v_fmac_f32 v216, v203, v110
    v_fmac_f32 v217, v203, v111
    v_fmac_f32 v218, v203, v112
    v_fmac_f32 v219, v203, v113
    v_fmac_f32 v220, v203, v114
    v_fmac_f32 v221, v203, v115
    v_fmac_f32 v222, v203, v116
    v_fmac_f32 v223, v203, v117
    v_fmac_f32 v224, v203, v118
    v_fmac_f32 v225, v203, v119
    v_fmac_f32 v216, v204, v120
    v_fmac_f32 v217, v204, v121
    v_fmac_f32 v218, v204, v122
    v_fmac_f32 v219, v204, v123
    v_fmac_f32 v220, v204, v124
    v_fmac_f32 v221, v204, v125
    v_fmac_f32 v222, v204, v126
    v_fmac_f32 v223, v204, v127
    v_fmac_f32 v224, v204, v128
    v_fmac_f32 v225, v204, v129
    v_fmac_f32 v216, v205, v130
    v_fmac_f32 v217, v205, v131
    v_fmac_f32 v218, v205, v132
    v_fmac_f32 v219, v205, v133
    v_fmac_f32 v220, v205, v134
    v_fmac_f32 v221, v205, v135
    v_fmac_f32 v222, v205, v136
    v_fmac_f32 v223, v205, v137
    v_fmac_f32 v224, v205, v138
    v_fmac_f32 v225, v205, v139
    v_fmac_f32 v216, v206, v140
    v_fmac_f32 v217, v206, v141
    v_fmac_f32 v218, v206, v142
    v_fmac_f32 v219, v206, v143
    v_fmac_f32 v220, v206, v144
    v_fmac_f32 v221, v206, v145
    v_fmac_f32 v222, v206, v146
    v_fmac_f32 v223, v206, v147
    v_fmac_f32 v224, v206, v148
    v_fmac_f32 v225, v206, v149
    v_fmac_f32 v216, v207, v150
    v_fmac_f32 v217, v207, v151
    v_fmac_f32 v218, v207, v152
    v_fmac_f32 v219, v207, v153
    v_fmac_f32 v220, v207, v154
    v_fmac_f32 v221, v207, v155
    v_fmac_f32 v222, v207, v156
    v_fmac_f32 v223, v207, v157
    v_fmac_f32 v224, v207, v158
    v_fmac_f32 v225, v207, v159
    s_waitcnt vmcnt(0)
    v_lshlrev_b32 v208, 16, v208
    v_lshlrev_b32 v209, 16, v209
    v_lshlrev_b32 v210, 16, v210
    v_lshlrev_b32 v211, 16, v211
    v_lshlrev_b32 v212, 16, v212
    v_lshlrev_b32 v213, 16, v213
    v_lshlrev_b32 v214, 16, v214
    v_lshlrev_b32 v215, 16, v215
    v_fmac_f32 v160, v208, v216
    v_mul_f32 v229, v210, v226
    v_fmac_f32 v229, v212, v227
    v_fmac_f32 v229, v214, v228
    v_fmac_f32 v176, v229, v218
    v_mul_f32 v229, v208, v220
    v_fmac_f32 v162, v229, v226
    v_fmac_f32 v168, v210, v222
    v_mul_f32 v230, v227, v214
    v_fma_f32 v230, -v228, v212, v230
    v_fmac_f32 v178, v230, v224
    v_fmac_f32 v164, v229, v227
    v_fmac_f32 v170, v212, v222
    v_mul_f32 v230, v228, v210
    v_fma_f32 v230, -v226, v214, v230
    v_fmac_f32 v180, v230, v224
    v_fmac_f32 v166, v229, v228
    v_fmac_f32 v172, v214, v222
    v_mul_f32 v230, v226, v212
    v_fma_f32 v230, -v227, v210, v230
    v_fmac_f32 v174, v230, v224
    v_fmac_f32 v161, v209, v217
    v_mul_f32 v229, v211, v226
    v_fmac_f32 v229, v213, v227
    v_fmac_f32 v229, v215, v228
    v_fmac_f32 v177, v229, v219
    v_mul_f32 v229, v209, v221
    v_fmac_f32 v163, v229, v226
    v_fmac_f32 v169, v211, v223
    v_mul_f32 v230, v227, v215
    v_fma_f32 v230, -v228, v213, v230
    v_fmac_f32 v179, v230, v225
    v_fmac_f32 v165, v229, v227
    v_fmac_f32 v171, v213, v223
    v_mul_f32 v230, v228, v211
    v_fma_f32 v230, -v226, v215, v230
    v_fmac_f32 v181, v230, v225
    v_fmac_f32 v167, v229, v228
    v_fmac_f32 v173, v215, v223
    v_mul_f32 v230, v226, v213
    v_fma_f32 v230, -v227, v211, v230
    v_fmac_f32 v175, v230, v225
    s_branch SL_bits
SL_nexti:
    s_mov_b64 s[38:39], s[40:41]
    s_mov_b64 s[40:41], s[42:43]
    s_mov_b64 s[42:43], s[44:45]
    s_add_u32 s36, s36, 1
    s_cmp_lt_u32 s36, 4
    s_cbranch_scc1 SL_bits
    s_add_u32 s35, s35, 256
    s_cmp_lt_u32 s35, 320000
    s_cbranch_scc1 SL_scan
    s_mul_i32 s66, s20, 5
    s_add_u32 s66, s66, s50
    s_lshl_b32 s67, s66, 4
    s_and_b32 s68, s67, 128
    s_and_b32 s67, s67, 0x70
    s_mul_i32 s69, s50, 1536
    s_add_u32 s69, s69, s21
    s_add_u32 s69, s69, s68
    s_mul_i32 s70, s66, 1536
    s_add_u32 s70, s70, 86016
    s_add_u32 s70, s70, s68
    v_mov_b32 v230, s69
    v_mov_b32 v231, s70
    v_cmp_gt_u32 vcc, 32, v240
    v_and_b32 v229, 31, v240
    v_lshlrev_b32 v229, 2, v229
    v_xor_b32 v229, s67, v229
    v_cndmask_b32 v244, v231, v230, vcc
    v_add_u32 v244, v244, v229
    v_cvt_pk_bf16_f32 v160, v160, v161
    ds_write_b32 v244, v160 offset:0
    v_cvt_pk_bf16_f32 v162, v162, v163
    ds_write_b32 v244, v162 offset:128
    v_cvt_pk_bf16_f32 v164, v164, v165
    ds_write_b32 v244, v164 offset:256
    v_cvt_pk_bf16_f32 v166, v166, v167
    ds_write_b32 v244, v166 offset:384
    v_cvt_pk_bf16_f32 v168, v168, v169
    ds_write_b32 v244, v168 offset:512
    v_cvt_pk_bf16_f32 v170, v170, v171
    ds_write_b32 v244, v170 offset:640
    v_cvt_pk_bf16_f32 v172, v172, v173
    ds_write_b32 v244, v172 offset:768
    v_cvt_pk_bf16_f32 v174, v174, v175
    ds_write_b32 v244, v174 offset:896
    v_cvt_pk_bf16_f32 v176, v176, v177
    ds_write_b32 v244, v176 offset:1024
    v_cvt_pk_bf16_f32 v178, v178, v179
    ds_write_b32 v244, v178 offset:1152
    v_cvt_pk_bf16_f32 v180, v180, v181
    ds_write_b32 v244, v180 offset:1280
    s_lshl_b32 s66, s66, 3
    s_add_u32 s66, s66, 163328
    v_mov_b32 v229, s66
    ds_write_b64 v229, v[230:231]
    s_add_u32 s50, s50, 1
    s_cmp_lt_u32 s50, 5
    s_cbranch_scc1 SL_node
    s_waitcnt lgkmcnt(0)
    s_barrier
    v_mov_b32 v176, v240
    s_load_dwordx4 s[84:87], s[0:1], 48
    s_mul_i32 s22, s20, 20
    s_waitcnt lgkmcnt(0)
    s_mul_i32 s24, s22, 3277
    s_lshr_b32 s24, s24, 16
    s_mul_i32 s68, s24, 20
    s_sub_u32 s68, s22, s68
    s_cmp_lt_u32 s68, 8
    s_cselect_b64 s[66:67], s[84:85], s[86:87]
    s_cselect_b32 s25, 0, 8
    s_sub_u32 s68, s68, s25
    s_and_b32 s25, s68, 1
    s_lshr_b32 s68, s68, 1
    s_lshl_b32 s68, s68, 14
    s_lshl_b32 s25, s25, 12
    s_add_u32 s68, s68, s25
    s_lshl_b32 s24, s24, 5
    s_add_u32 s68, s68, s24
    v_lshrrev_b32 v2, 4, v176
    v_lshlrev_b32 v2, 10, v2
    v_and_b32 v3, 15, v176
    v_lshl_add_u32 v2, v3, 1, v2
    v_add_u32 v2, s68, v2
    v_add_u32 v3, 8192, v2
    v_mov_b32 v4, 0
    v_mov_b32 v5, 0
    v_mov_b32 v6, 0
    v_mov_b32 v7, 0
    global_load_ushort v96, v2, s[66:67] offset:0
    global_load_short_d16_hi v4, v3, s[66:67] offset:0
    global_load_ushort v97, v2, s[66:67] offset:256
    global_load_short_d16_hi v5, v3, s[66:67] offset:256
    global_load_ushort v98, v2, s[66:67] offset:512
    global_load_short_d16_hi v6, v3, s[66:67] offset:512
    global_load_ushort v99, v2, s[66:67] offset:768
    global_load_short_d16_hi v7, v3, s[66:67] offset:768
    s_add_u32 s22, s22, 1
    s_waitcnt vmcnt(0)
    v_or_b32 v96, v96, v4
    v_or_b32 v97, v97, v5
    v_or_b32 v98, v98, v6
    v_or_b32 v99, v99, v7
    s_mul_i32 s24, s22, 3277
    s_lshr_b32 s24, s24, 16
    s_mul_i32 s68, s24, 20
    s_sub_u32 s68, s22, s68
    s_cmp_lt_u32 s68, 8
    s_cselect_b64 s[66:67], s[84:85], s[86:87]
    s_cselect_b32 s25, 0, 8
    s_sub_u32 s68, s68, s25
    s_and_b32 s25, s68, 1
    s_lshr_b32 s68, s68, 1
    s_lshl_b32 s68, s68, 14
    s_lshl_b32 s25, s25, 12
    s_add_u32 s68, s68, s25
    s_lshl_b32 s24, s24, 5
    s_add_u32 s68, s68, s24
    v_lshrrev_b32 v2, 4, v176
    v_lshlrev_b32 v2, 10, v2
    v_and_b32 v3, 15, v176
    v_lshl_add_u32 v2, v3, 1, v2
    v_add_u32 v2, s68, v2
    v_add_u32 v3, 8192, v2
    v_mov_b32 v4, 0
    v_mov_b32 v5, 0
    v_mov_b32 v6, 0
    v_mov_b32 v7, 0
    global_load_ushort v100, v2, s[66:67] offset:0
    global_load_short_d16_hi v4, v3, s[66:67] offset:0
    global_load_ushort v101, v2, s[66:67] offset:256
    global_load_short_d16_hi v5, v3, s[66:67] offset:256
    global_load_ushort v102, v2, s[66:67] offset:512
    global_load_short_d16_hi v6, v3, s[66:67] offset:512
    global_load_ushort v103, v2, s[66:67] offset:768
    global_load_short_d16_hi v7, v3, s[66:67] offset:768
    s_add_u32 s22, s22, 1
    s_waitcnt vmcnt(0)
    v_or_b32 v100, v100, v4
    v_or_b32 v101, v101, v5
    v_or_b32 v102, v102, v6
    v_or_b32 v103, v103, v7
    s_mul_i32 s24, s22, 3277
    s_lshr_b32 s24, s24, 16
    s_mul_i32 s68, s24, 20
    s_sub_u32 s68, s22, s68
    s_cmp_lt_u32 s68, 8
    s_cselect_b64 s[66:67], s[84:85], s[86:87]
    s_cselect_b32 s25, 0, 8
    s_sub_u32 s68, s68, s25
    s_and_b32 s25, s68, 1
    s_lshr_b32 s68, s68, 1
    s_lshl_b32 s68, s68, 14
    s_lshl_b32 s25, s25, 12
    s_add_u32 s68, s68, s25
    s_lshl_b32 s24, s24, 5
    s_add_u32 s68, s68, s24
    v_lshrrev_b32 v2, 4, v176
    v_lshlrev_b32 v2, 10, v2
    v_and_b32 v3, 15, v176
    v_lshl_add_u32 v2, v3, 1, v2
    v_add_u32 v2, s68, v2
    v_add_u32 v3, 8192, v2
    v_mov_b32 v4, 0
    v_mov_b32 v5, 0
    v_mov_b32 v6, 0
    v_mov_b32 v7, 0
    global_load_ushort v104, v2, s[66:67] offset:0
    global_load_short_d16_hi v4, v3, s[66:67] offset:0
    global_load_ushort v105, v2, s[66:67] offset:256
    global_load_short_d16_hi v5, v3, s[66:67] offset:256
    global_load_ushort v106, v2, s[66:67] offset:512
    global_load_short_d16_hi v6, v3, s[66:67] offset:512
    global_load_ushort v107, v2, s[66:67] offset:768
    global_load_short_d16_hi v7, v3, s[66:67] offset:768
    s_add_u32 s22, s22, 1
    s_waitcnt vmcnt(0)
    v_or_b32 v104, v104, v4
    v_or_b32 v105, v105, v5
    v_or_b32 v106, v106, v6
    v_or_b32 v107, v107, v7
    s_mul_i32 s24, s22, 3277
    s_lshr_b32 s24, s24, 16
    s_mul_i32 s68, s24, 20
    s_sub_u32 s68, s22, s68
    s_cmp_lt_u32 s68, 8
    s_cselect_b64 s[66:67], s[84:85], s[86:87]
    s_cselect_b32 s25, 0, 8
    s_sub_u32 s68, s68, s25
    s_and_b32 s25, s68, 1
    s_lshr_b32 s68, s68, 1
    s_lshl_b32 s68, s68, 14
    s_lshl_b32 s25, s25, 12
    s_add_u32 s68, s68, s25
    s_lshl_b32 s24, s24, 5
    s_add_u32 s68, s68, s24
    v_lshrrev_b32 v2, 4, v176
    v_lshlrev_b32 v2, 10, v2
    v_and_b32 v3, 15, v176
    v_lshl_add_u32 v2, v3, 1, v2
    v_add_u32 v2, s68, v2
    v_add_u32 v3, 8192, v2
    v_mov_b32 v4, 0
    v_mov_b32 v5, 0
    v_mov_b32 v6, 0
    v_mov_b32 v7, 0
    global_load_ushort v108, v2, s[66:67] offset:0
    global_load_short_d16_hi v4, v3, s[66:67] offset:0
    global_load_ushort v109, v2, s[66:67] offset:256
    global_load_short_d16_hi v5, v3, s[66:67] offset:256
    global_load_ushort v110, v2, s[66:67] offset:512
    global_load_short_d16_hi v6, v3, s[66:67] offset:512
    global_load_ushort v111, v2, s[66:67] offset:768
    global_load_short_d16_hi v7, v3, s[66:67] offset:768
    s_add_u32 s22, s22, 1
    s_waitcnt vmcnt(0)
    v_or_b32 v108, v108, v4
    v_or_b32 v109, v109, v5
    v_or_b32 v110, v110, v6
    v_or_b32 v111, v111, v7
    s_mul_i32 s24, s22, 3277
    s_lshr_b32 s24, s24, 16
    s_mul_i32 s68, s24, 20
    s_sub_u32 s68, s22, s68
    s_cmp_lt_u32 s68, 8
    s_cselect_b64 s[66:67], s[84:85], s[86:87]
    s_cselect_b32 s25, 0, 8
    s_sub_u32 s68, s68, s25
    s_and_b32 s25, s68, 1
    s_lshr_b32 s68, s68, 1
    s_lshl_b32 s68, s68, 14
    s_lshl_b32 s25, s25, 12
    s_add_u32 s68, s68, s25
    s_lshl_b32 s24, s24, 5
    s_add_u32 s68, s68, s24
    v_lshrrev_b32 v2, 4, v176
    v_lshlrev_b32 v2, 10, v2
    v_and_b32 v3, 15, v176
    v_lshl_add_u32 v2, v3, 1, v2
    v_add_u32 v2, s68, v2
    v_add_u32 v3, 8192, v2
    v_mov_b32 v4, 0
    v_mov_b32 v5, 0
    v_mov_b32 v6, 0
    v_mov_b32 v7, 0
    global_load_ushort v112, v2, s[66:67] offset:0
    global_load_short_d16_hi v4, v3, s[66:67] offset:0
    global_load_ushort v113, v2, s[66:67] offset:256
    global_load_short_d16_hi v5, v3, s[66:67] offset:256
    global_load_ushort v114, v2, s[66:67] offset:512
    global_load_short_d16_hi v6, v3, s[66:67] offset:512
    global_load_ushort v115, v2, s[66:67] offset:768
    global_load_short_d16_hi v7, v3, s[66:67] offset:768
    s_add_u32 s22, s22, 1
    s_waitcnt vmcnt(0)
    v_or_b32 v112, v112, v4
    v_or_b32 v113, v113, v5
    v_or_b32 v114, v114, v6
    v_or_b32 v115, v115, v7
    s_mul_i32 s24, s22, 3277
    s_lshr_b32 s24, s24, 16
    s_mul_i32 s68, s24, 20
    s_sub_u32 s68, s22, s68
    s_cmp_lt_u32 s68, 8
    s_cselect_b64 s[66:67], s[84:85], s[86:87]
    s_cselect_b32 s25, 0, 8
    s_sub_u32 s68, s68, s25
    s_and_b32 s25, s68, 1
    s_lshr_b32 s68, s68, 1
    s_lshl_b32 s68, s68, 14
    s_lshl_b32 s25, s25, 12
    s_add_u32 s68, s68, s25
    s_lshl_b32 s24, s24, 5
    s_add_u32 s68, s68, s24
    v_lshrrev_b32 v2, 4, v176
    v_lshlrev_b32 v2, 10, v2
    v_and_b32 v3, 15, v176
    v_lshl_add_u32 v2, v3, 1, v2
    v_add_u32 v2, s68, v2
    v_add_u32 v3, 8192, v2
    v_mov_b32 v4, 0
    v_mov_b32 v5, 0
    v_mov_b32 v6, 0
    v_mov_b32 v7, 0
    global_load_ushort v116, v2, s[66:67] offset:0
    global_load_short_d16_hi v4, v3, s[66:67] offset:0
    global_load_ushort v117, v2, s[66:67] offset:256
    global_load_short_d16_hi v5, v3, s[66:67] offset:256
    global_load_ushort v118, v2, s[66:67] offset:512
    global_load_short_d16_hi v6, v3, s[66:67] offset:512
    global_load_ushort v119, v2, s[66:67] offset:768
    global_load_short_d16_hi v7, v3, s[66:67] offset:768
    s_add_u32 s22, s22, 1
    s_waitcnt vmcnt(0)
    v_or_b32 v116, v116, v4
    v_or_b32 v117, v117, v5
    v_or_b32 v118, v118, v6
    v_or_b32 v119, v119, v7
    s_mul_i32 s24, s22, 3277
    s_lshr_b32 s24, s24, 16
    s_mul_i32 s68, s24, 20
    s_sub_u32 s68, s22, s68
    s_cmp_lt_u32 s68, 8
    s_cselect_b64 s[66:67], s[84:85], s[86:87]
    s_cselect_b32 s25, 0, 8
    s_sub_u32 s68, s68, s25
    s_and_b32 s25, s68, 1
    s_lshr_b32 s68, s68, 1
    s_lshl_b32 s68, s68, 14
    s_lshl_b32 s25, s25, 12
    s_add_u32 s68, s68, s25
    s_lshl_b32 s24, s24, 5
    s_add_u32 s68, s68, s24
    v_lshrrev_b32 v2, 4, v176
    v_lshlrev_b32 v2, 10, v2
    v_and_b32 v3, 15, v176
    v_lshl_add_u32 v2, v3, 1, v2
    v_add_u32 v2, s68, v2
    v_add_u32 v3, 8192, v2
    v_mov_b32 v4, 0
    v_mov_b32 v5, 0
    v_mov_b32 v6, 0
    v_mov_b32 v7, 0
    global_load_ushort v120, v2, s[66:67] offset:0
    global_load_short_d16_hi v4, v3, s[66:67] offset:0
    global_load_ushort v121, v2, s[66:67] offset:256
    global_load_short_d16_hi v5, v3, s[66:67] offset:256
    global_load_ushort v122, v2, s[66:67] offset:512
    global_load_short_d16_hi v6, v3, s[66:67] offset:512
    global_load_ushort v123, v2, s[66:67] offset:768
    global_load_short_d16_hi v7, v3, s[66:67] offset:768
    s_add_u32 s22, s22, 1
    s_waitcnt vmcnt(0)
    v_or_b32 v120, v120, v4
    v_or_b32 v121, v121, v5
    v_or_b32 v122, v122, v6
    v_or_b32 v123, v123, v7
    s_mul_i32 s24, s22, 3277
    s_lshr_b32 s24, s24, 16
    s_mul_i32 s68, s24, 20
    s_sub_u32 s68, s22, s68
    s_cmp_lt_u32 s68, 8
    s_cselect_b64 s[66:67], s[84:85], s[86:87]
    s_cselect_b32 s25, 0, 8
    s_sub_u32 s68, s68, s25
    s_and_b32 s25, s68, 1
    s_lshr_b32 s68, s68, 1
    s_lshl_b32 s68, s68, 14
    s_lshl_b32 s25, s25, 12
    s_add_u32 s68, s68, s25
    s_lshl_b32 s24, s24, 5
    s_add_u32 s68, s68, s24
    v_lshrrev_b32 v2, 4, v176
    v_lshlrev_b32 v2, 10, v2
    v_and_b32 v3, 15, v176
    v_lshl_add_u32 v2, v3, 1, v2
    v_add_u32 v2, s68, v2
    v_add_u32 v3, 8192, v2
    v_mov_b32 v4, 0
    v_mov_b32 v5, 0
    v_mov_b32 v6, 0
    v_mov_b32 v7, 0
    global_load_ushort v124, v2, s[66:67] offset:0
    global_load_short_d16_hi v4, v3, s[66:67] offset:0
    global_load_ushort v125, v2, s[66:67] offset:256
    global_load_short_d16_hi v5, v3, s[66:67] offset:256
    global_load_ushort v126, v2, s[66:67] offset:512
    global_load_short_d16_hi v6, v3, s[66:67] offset:512
    global_load_ushort v127, v2, s[66:67] offset:768
    global_load_short_d16_hi v7, v3, s[66:67] offset:768
    s_add_u32 s22, s22, 1
    s_waitcnt vmcnt(0)
    v_or_b32 v124, v124, v4
    v_or_b32 v125, v125, v5
    v_or_b32 v126, v126, v6
    v_or_b32 v127, v127, v7
    s_mul_i32 s24, s22, 3277
    s_lshr_b32 s24, s24, 16
    s_mul_i32 s68, s24, 20
    s_sub_u32 s68, s22, s68
    s_cmp_lt_u32 s68, 8
    s_cselect_b64 s[66:67], s[84:85], s[86:87]
    s_cselect_b32 s25, 0, 8
    s_sub_u32 s68, s68, s25
    s_and_b32 s25, s68, 1
    s_lshr_b32 s68, s68, 1
    s_lshl_b32 s68, s68, 14
    s_lshl_b32 s25, s25, 12
    s_add_u32 s68, s68, s25
    s_lshl_b32 s24, s24, 5
    s_add_u32 s68, s68, s24
    v_lshrrev_b32 v2, 4, v176
    v_lshlrev_b32 v2, 10, v2
    v_and_b32 v3, 15, v176
    v_lshl_add_u32 v2, v3, 1, v2
    v_add_u32 v2, s68, v2
    v_add_u32 v3, 8192, v2
    v_mov_b32 v4, 0
    v_mov_b32 v5, 0
    v_mov_b32 v6, 0
    v_mov_b32 v7, 0
    global_load_ushort v128, v2, s[66:67] offset:0
    global_load_short_d16_hi v4, v3, s[66:67] offset:0
    global_load_ushort v129, v2, s[66:67] offset:256
    global_load_short_d16_hi v5, v3, s[66:67] offset:256
    global_load_ushort v130, v2, s[66:67] offset:512
    global_load_short_d16_hi v6, v3, s[66:67] offset:512
    global_load_ushort v131, v2, s[66:67] offset:768
    global_load_short_d16_hi v7, v3, s[66:67] offset:768
    s_add_u32 s22, s22, 1
    s_waitcnt vmcnt(0)
    v_or_b32 v128, v128, v4
    v_or_b32 v129, v129, v5
    v_or_b32 v130, v130, v6
    v_or_b32 v131, v131, v7
    s_mul_i32 s24, s22, 3277
    s_lshr_b32 s24, s24, 16
    s_mul_i32 s68, s24, 20
    s_sub_u32 s68, s22, s68
    s_cmp_lt_u32 s68, 8
    s_cselect_b64 s[66:67], s[84:85], s[86:87]
    s_cselect_b32 s25, 0, 8
    s_sub_u32 s68, s68, s25
    s_and_b32 s25, s68, 1
    s_lshr_b32 s68, s68, 1
    s_lshl_b32 s68, s68, 14
    s_lshl_b32 s25, s25, 12
    s_add_u32 s68, s68, s25
    s_lshl_b32 s24, s24, 5
    s_add_u32 s68, s68, s24
    v_lshrrev_b32 v2, 4, v176
    v_lshlrev_b32 v2, 10, v2
    v_and_b32 v3, 15, v176
    v_lshl_add_u32 v2, v3, 1, v2
    v_add_u32 v2, s68, v2
    v_add_u32 v3, 8192, v2
    v_mov_b32 v4, 0
    v_mov_b32 v5, 0
    v_mov_b32 v6, 0
    v_mov_b32 v7, 0
    global_load_ushort v132, v2, s[66:67] offset:0
    global_load_short_d16_hi v4, v3, s[66:67] offset:0
    global_load_ushort v133, v2, s[66:67] offset:256
    global_load_short_d16_hi v5, v3, s[66:67] offset:256
    global_load_ushort v134, v2, s[66:67] offset:512
    global_load_short_d16_hi v6, v3, s[66:67] offset:512
    global_load_ushort v135, v2, s[66:67] offset:768
    global_load_short_d16_hi v7, v3, s[66:67] offset:768
    s_add_u32 s22, s22, 1
    s_waitcnt vmcnt(0)
    v_or_b32 v132, v132, v4
    v_or_b32 v133, v133, v5
    v_or_b32 v134, v134, v6
    v_or_b32 v135, v135, v7
    s_mul_i32 s24, s22, 3277
    s_lshr_b32 s24, s24, 16
    s_mul_i32 s68, s24, 20
    s_sub_u32 s68, s22, s68
    s_cmp_lt_u32 s68, 8
    s_cselect_b64 s[66:67], s[84:85], s[86:87]
    s_cselect_b32 s25, 0, 8
    s_sub_u32 s68, s68, s25
    s_and_b32 s25, s68, 1
    s_lshr_b32 s68, s68, 1
    s_lshl_b32 s68, s68, 14
    s_lshl_b32 s25, s25, 12
    s_add_u32 s68, s68, s25
    s_lshl_b32 s24, s24, 5
    s_add_u32 s68, s68, s24
    v_lshrrev_b32 v2, 4, v176
    v_lshlrev_b32 v2, 10, v2
    v_and_b32 v3, 15, v176
    v_lshl_add_u32 v2, v3, 1, v2
    v_add_u32 v2, s68, v2
    v_add_u32 v3, 8192, v2
    v_mov_b32 v4, 0
    v_mov_b32 v5, 0
    v_mov_b32 v6, 0
    v_mov_b32 v7, 0
    global_load_ushort v136, v2, s[66:67] offset:0
    global_load_short_d16_hi v4, v3, s[66:67] offset:0
    global_load_ushort v137, v2, s[66:67] offset:256
    global_load_short_d16_hi v5, v3, s[66:67] offset:256
    global_load_ushort v138, v2, s[66:67] offset:512
    global_load_short_d16_hi v6, v3, s[66:67] offset:512
    global_load_ushort v139, v2, s[66:67] offset:768
    global_load_short_d16_hi v7, v3, s[66:67] offset:768
    s_add_u32 s22, s22, 1
    s_waitcnt vmcnt(0)
    v_or_b32 v136, v136, v4
    v_or_b32 v137, v137, v5
    v_or_b32 v138, v138, v6
    v_or_b32 v139, v139, v7
    s_mul_i32 s24, s22, 3277
    s_lshr_b32 s24, s24, 16
    s_mul_i32 s68, s24, 20
    s_sub_u32 s68, s22, s68
    s_cmp_lt_u32 s68, 8
    s_cselect_b64 s[66:67], s[84:85], s[86:87]
    s_cselect_b32 s25, 0, 8
    s_sub_u32 s68, s68, s25
    s_and_b32 s25, s68, 1
    s_lshr_b32 s68, s68, 1
    s_lshl_b32 s68, s68, 14
    s_lshl_b32 s25, s25, 12
    s_add_u32 s68, s68, s25
    s_lshl_b32 s24, s24, 5
    s_add_u32 s68, s68, s24
    v_lshrrev_b32 v2, 4, v176
    v_lshlrev_b32 v2, 10, v2
    v_and_b32 v3, 15, v176
    v_lshl_add_u32 v2, v3, 1, v2
    v_add_u32 v2, s68, v2
    v_add_u32 v3, 8192, v2
    v_mov_b32 v4, 0
    v_mov_b32 v5, 0
    v_mov_b32 v6, 0
    v_mov_b32 v7, 0
    global_load_ushort v140, v2, s[66:67] offset:0
    global_load_short_d16_hi v4, v3, s[66:67] offset:0
    global_load_ushort v141, v2, s[66:67] offset:256
    global_load_short_d16_hi v5, v3, s[66:67] offset:256
    global_load_ushort v142, v2, s[66:67] offset:512
    global_load_short_d16_hi v6, v3, s[66:67] offset:512
    global_load_ushort v143, v2, s[66:67] offset:768
    global_load_short_d16_hi v7, v3, s[66:67] offset:768
    s_add_u32 s22, s22, 1
    s_waitcnt vmcnt(0)
    v_or_b32 v140, v140, v4
    v_or_b32 v141, v141, v5
    v_or_b32 v142, v142, v6
    v_or_b32 v143, v143, v7
    s_mul_i32 s24, s22, 3277
    s_lshr_b32 s24, s24, 16
    s_mul_i32 s68, s24, 20
    s_sub_u32 s68, s22, s68
    s_cmp_lt_u32 s68, 8
    s_cselect_b64 s[66:67], s[84:85], s[86:87]
    s_cselect_b32 s25, 0, 8
    s_sub_u32 s68, s68, s25
    s_and_b32 s25, s68, 1
    s_lshr_b32 s68, s68, 1
    s_lshl_b32 s68, s68, 14
    s_lshl_b32 s25, s25, 12
    s_add_u32 s68, s68, s25
    s_lshl_b32 s24, s24, 5
    s_add_u32 s68, s68, s24
    v_lshrrev_b32 v2, 4, v176
    v_lshlrev_b32 v2, 10, v2
    v_and_b32 v3, 15, v176
    v_lshl_add_u32 v2, v3, 1, v2
    v_add_u32 v2, s68, v2
    v_add_u32 v3, 8192, v2
    v_mov_b32 v4, 0
    v_mov_b32 v5, 0
    v_mov_b32 v6, 0
    v_mov_b32 v7, 0
    global_load_ushort v144, v2, s[66:67] offset:0
    global_load_short_d16_hi v4, v3, s[66:67] offset:0
    global_load_ushort v145, v2, s[66:67] offset:256
    global_load_short_d16_hi v5, v3, s[66:67] offset:256
    global_load_ushort v146, v2, s[66:67] offset:512
    global_load_short_d16_hi v6, v3, s[66:67] offset:512
    global_load_ushort v147, v2, s[66:67] offset:768
    global_load_short_d16_hi v7, v3, s[66:67] offset:768
    s_add_u32 s22, s22, 1
    s_waitcnt vmcnt(0)
    v_or_b32 v144, v144, v4
    v_or_b32 v145, v145, v5
    v_or_b32 v146, v146, v6
    v_or_b32 v147, v147, v7
    s_mul_i32 s24, s22, 3277
    s_lshr_b32 s24, s24, 16
    s_mul_i32 s68, s24, 20
    s_sub_u32 s68, s22, s68
    s_cmp_lt_u32 s68, 8
    s_cselect_b64 s[66:67], s[84:85], s[86:87]
    s_cselect_b32 s25, 0, 8
    s_sub_u32 s68, s68, s25
    s_and_b32 s25, s68, 1
    s_lshr_b32 s68, s68, 1
    s_lshl_b32 s68, s68, 14
    s_lshl_b32 s25, s25, 12
    s_add_u32 s68, s68, s25
    s_lshl_b32 s24, s24, 5
    s_add_u32 s68, s68, s24
    v_lshrrev_b32 v2, 4, v176
    v_lshlrev_b32 v2, 10, v2
    v_and_b32 v3, 15, v176
    v_lshl_add_u32 v2, v3, 1, v2
    v_add_u32 v2, s68, v2
    v_add_u32 v3, 8192, v2
    v_mov_b32 v4, 0
    v_mov_b32 v5, 0
    v_mov_b32 v6, 0
    v_mov_b32 v7, 0
    global_load_ushort v148, v2, s[66:67] offset:0
    global_load_short_d16_hi v4, v3, s[66:67] offset:0
    global_load_ushort v149, v2, s[66:67] offset:256
    global_load_short_d16_hi v5, v3, s[66:67] offset:256
    global_load_ushort v150, v2, s[66:67] offset:512
    global_load_short_d16_hi v6, v3, s[66:67] offset:512
    global_load_ushort v151, v2, s[66:67] offset:768
    global_load_short_d16_hi v7, v3, s[66:67] offset:768
    s_add_u32 s22, s22, 1
    s_waitcnt vmcnt(0)
    v_or_b32 v148, v148, v4
    v_or_b32 v149, v149, v5
    v_or_b32 v150, v150, v6
    v_or_b32 v151, v151, v7
    s_mul_i32 s24, s22, 3277
    s_lshr_b32 s24, s24, 16
    s_mul_i32 s68, s24, 20
    s_sub_u32 s68, s22, s68
    s_cmp_lt_u32 s68, 8
    s_cselect_b64 s[66:67], s[84:85], s[86:87]
    s_cselect_b32 s25, 0, 8
    s_sub_u32 s68, s68, s25
    s_and_b32 s25, s68, 1
    s_lshr_b32 s68, s68, 1
    s_lshl_b32 s68, s68, 14
    s_lshl_b32 s25, s25, 12
    s_add_u32 s68, s68, s25
    s_lshl_b32 s24, s24, 5
    s_add_u32 s68, s68, s24
    v_lshrrev_b32 v2, 4, v176
    v_lshlrev_b32 v2, 10, v2
    v_and_b32 v3, 15, v176
    v_lshl_add_u32 v2, v3, 1, v2
    v_add_u32 v2, s68, v2
    v_add_u32 v3, 8192, v2
    v_mov_b32 v4, 0
    v_mov_b32 v5, 0
    v_mov_b32 v6, 0
    v_mov_b32 v7, 0
    global_load_ushort v152, v2, s[66:67] offset:0
    global_load_short_d16_hi v4, v3, s[66:67] offset:0
    global_load_ushort v153, v2, s[66:67] offset:256
    global_load_short_d16_hi v5, v3, s[66:67] offset:256
    global_load_ushort v154, v2, s[66:67] offset:512
    global_load_short_d16_hi v6, v3, s[66:67] offset:512
    global_load_ushort v155, v2, s[66:67] offset:768
    global_load_short_d16_hi v7, v3, s[66:67] offset:768
    s_add_u32 s22, s22, 1
    s_waitcnt vmcnt(0)
    v_or_b32 v152, v152, v4
    v_or_b32 v153, v153, v5
    v_or_b32 v154, v154, v6
    v_or_b32 v155, v155, v7
    s_mul_i32 s24, s22, 3277
    s_lshr_b32 s24, s24, 16
    s_mul_i32 s68, s24, 20
    s_sub_u32 s68, s22, s68
    s_cmp_lt_u32 s68, 8
    s_cselect_b64 s[66:67], s[84:85], s[86:87]
    s_cselect_b32 s25, 0, 8
    s_sub_u32 s68, s68, s25
    s_and_b32 s25, s68, 1
    s_lshr_b32 s68, s68, 1
    s_lshl_b32 s68, s68, 14
    s_lshl_b32 s25, s25, 12
    s_add_u32 s68, s68, s25
    s_lshl_b32 s24, s24, 5
    s_add_u32 s68, s68, s24
    v_lshrrev_b32 v2, 4, v176
    v_lshlrev_b32 v2, 10, v2
    v_and_b32 v3, 15, v176
    v_lshl_add_u32 v2, v3, 1, v2
    v_add_u32 v2, s68, v2
    v_add_u32 v3, 8192, v2
    v_mov_b32 v4, 0
    v_mov_b32 v5, 0
    v_mov_b32 v6, 0
    v_mov_b32 v7, 0
    global_load_ushort v156, v2, s[66:67] offset:0
    global_load_short_d16_hi v4, v3, s[66:67] offset:0
    global_load_ushort v157, v2, s[66:67] offset:256
    global_load_short_d16_hi v5, v3, s[66:67] offset:256
    global_load_ushort v158, v2, s[66:67] offset:512
    global_load_short_d16_hi v6, v3, s[66:67] offset:512
    global_load_ushort v159, v2, s[66:67] offset:768
    global_load_short_d16_hi v7, v3, s[66:67] offset:768
    s_add_u32 s22, s22, 1
    s_waitcnt vmcnt(0)
    v_or_b32 v156, v156, v4
    v_or_b32 v157, v157, v5
    v_or_b32 v158, v158, v6
    v_or_b32 v159, v159, v7
    s_mul_i32 s24, s22, 3277
    s_lshr_b32 s24, s24, 16
    s_mul_i32 s68, s24, 20
    s_sub_u32 s68, s22, s68
    s_cmp_lt_u32 s68, 8
    s_cselect_b64 s[66:67], s[84:85], s[86:87]
    s_cselect_b32 s25, 0, 8
    s_sub_u32 s68, s68, s25
    s_and_b32 s25, s68, 1
    s_lshr_b32 s68, s68, 1
    s_lshl_b32 s68, s68, 14
    s_lshl_b32 s25, s25, 12
    s_add_u32 s68, s68, s25
    s_lshl_b32 s24, s24, 5
    s_add_u32 s68, s68, s24
    v_lshrrev_b32 v2, 4, v176
    v_lshlrev_b32 v2, 10, v2
    v_and_b32 v3, 15, v176
    v_lshl_add_u32 v2, v3, 1, v2
    v_add_u32 v2, s68, v2
    v_add_u32 v3, 8192, v2
    v_mov_b32 v4, 0
    v_mov_b32 v5, 0
    v_mov_b32 v6, 0
    v_mov_b32 v7, 0
    global_load_ushort v160, v2, s[66:67] offset:0
    global_load_short_d16_hi v4, v3, s[66:67] offset:0
    global_load_ushort v161, v2, s[66:67] offset:256
    global_load_short_d16_hi v5, v3, s[66:67] offset:256
    global_load_ushort v162, v2, s[66:67] offset:512
    global_load_short_d16_hi v6, v3, s[66:67] offset:512
    global_load_ushort v163, v2, s[66:67] offset:768
    global_load_short_d16_hi v7, v3, s[66:67] offset:768
    s_add_u32 s22, s22, 1
    s_waitcnt vmcnt(0)
    v_or_b32 v160, v160, v4
    v_or_b32 v161, v161, v5
    v_or_b32 v162, v162, v6
    v_or_b32 v163, v163, v7
    s_mul_i32 s24, s22, 3277
    s_lshr_b32 s24, s24, 16
    s_mul_i32 s68, s24, 20
    s_sub_u32 s68, s22, s68
    s_cmp_lt_u32 s68, 8
    s_cselect_b64 s[66:67], s[84:85], s[86:87]
    s_cselect_b32 s25, 0, 8
    s_sub_u32 s68, s68, s25
    s_and_b32 s25, s68, 1
    s_lshr_b32 s68, s68, 1
    s_lshl_b32 s68, s68, 14
    s_lshl_b32 s25, s25, 12
    s_add_u32 s68, s68, s25
    s_lshl_b32 s24, s24, 5
    s_add_u32 s68, s68, s24
    v_lshrrev_b32 v2, 4, v176
    v_lshlrev_b32 v2, 10, v2
    v_and_b32 v3, 15, v176
    v_lshl_add_u32 v2, v3, 1, v2
    v_add_u32 v2, s68, v2
    v_add_u32 v3, 8192, v2
    v_mov_b32 v4, 0
    v_mov_b32 v5, 0
    v_mov_b32 v6, 0
    v_mov_b32 v7, 0
    global_load_ushort v164, v2, s[66:67] offset:0
    global_load_short_d16_hi v4, v3, s[66:67] offset:0
    global_load_ushort v165, v2, s[66:67] offset:256
    global_load_short_d16_hi v5, v3, s[66:67] offset:256
    global_load_ushort v166, v2, s[66:67] offset:512
    global_load_short_d16_hi v6, v3, s[66:67] offset:512
    global_load_ushort v167, v2, s[66:67] offset:768
    global_load_short_d16_hi v7, v3, s[66:67] offset:768
    s_add_u32 s22, s22, 1
    s_waitcnt vmcnt(0)
    v_or_b32 v164, v164, v4
    v_or_b32 v165, v165, v5
    v_or_b32 v166, v166, v6
    v_or_b32 v167, v167, v7
    s_mul_i32 s24, s22, 3277
    s_lshr_b32 s24, s24, 16
    s_mul_i32 s68, s24, 20
    s_sub_u32 s68, s22, s68
    s_cmp_lt_u32 s68, 8
    s_cselect_b64 s[66:67], s[84:85], s[86:87]
    s_cselect_b32 s25, 0, 8
    s_sub_u32 s68, s68, s25
    s_and_b32 s25, s68, 1
    s_lshr_b32 s68, s68, 1
    s_lshl_b32 s68, s68, 14
    s_lshl_b32 s25, s25, 12
    s_add_u32 s68, s68, s25
    s_lshl_b32 s24, s24, 5
    s_add_u32 s68, s68, s24
    v_lshrrev_b32 v2, 4, v176
    v_lshlrev_b32 v2, 10, v2
    v_and_b32 v3, 15, v176
    v_lshl_add_u32 v2, v3, 1, v2
    v_add_u32 v2, s68, v2
    v_add_u32 v3, 8192, v2
    v_mov_b32 v4, 0
    v_mov_b32 v5, 0
    v_mov_b32 v6, 0
    v_mov_b32 v7, 0
    global_load_ushort v168, v2, s[66:67] offset:0
    global_load_short_d16_hi v4, v3, s[66:67] offset:0
    global_load_ushort v169, v2, s[66:67] offset:256
    global_load_short_d16_hi v5, v3, s[66:67] offset:256
    global_load_ushort v170, v2, s[66:67] offset:512
    global_load_short_d16_hi v6, v3, s[66:67] offset:512
    global_load_ushort v171, v2, s[66:67] offset:768
    global_load_short_d16_hi v7, v3, s[66:67] offset:768
    s_add_u32 s22, s22, 1
    s_waitcnt vmcnt(0)
    v_or_b32 v168, v168, v4
    v_or_b32 v169, v169, v5
    v_or_b32 v170, v170, v6
    v_or_b32 v171, v171, v7
    s_mul_i32 s24, s22, 3277
    s_lshr_b32 s24, s24, 16
    s_mul_i32 s68, s24, 20
    s_sub_u32 s68, s22, s68
    s_cmp_lt_u32 s68, 8
    s_cselect_b64 s[66:67], s[84:85], s[86:87]
    s_cselect_b32 s25, 0, 8
    s_sub_u32 s68, s68, s25
    s_and_b32 s25, s68, 1
    s_lshr_b32 s68, s68, 1
    s_lshl_b32 s68, s68, 14
    s_lshl_b32 s25, s25, 12
    s_add_u32 s68, s68, s25
    s_lshl_b32 s24, s24, 5
    s_add_u32 s68, s68, s24
    v_lshrrev_b32 v2, 4, v176
    v_lshlrev_b32 v2, 10, v2
    v_and_b32 v3, 15, v176
    v_lshl_add_u32 v2, v3, 1, v2
    v_add_u32 v2, s68, v2
    v_add_u32 v3, 8192, v2
    v_mov_b32 v4, 0
    v_mov_b32 v5, 0
    v_mov_b32 v6, 0
    v_mov_b32 v7, 0
    global_load_ushort v172, v2, s[66:67] offset:0
    global_load_short_d16_hi v4, v3, s[66:67] offset:0
    global_load_ushort v173, v2, s[66:67] offset:256
    global_load_short_d16_hi v5, v3, s[66:67] offset:256
    global_load_ushort v174, v2, s[66:67] offset:512
    global_load_short_d16_hi v6, v3, s[66:67] offset:512
    global_load_ushort v175, v2, s[66:67] offset:768
    global_load_short_d16_hi v7, v3, s[66:67] offset:768
    s_add_u32 s22, s22, 1
    s_waitcnt vmcnt(0)
    v_or_b32 v172, v172, v4
    v_or_b32 v173, v173, v5
    v_or_b32 v174, v174, v6
    v_or_b32 v175, v175, v7
    s_load_dwordx2 s[72:73], s[0:1], 72
    s_branch GEMM
.section .rodata,"a"
.p2align 6
.amdhsa_kernel standalone__tensor_product_equiv_equiformer__graph_kernel
  .amdhsa_next_free_vgpr 256
  .amdhsa_next_free_sgpr 90
  .amdhsa_accum_offset 256
  .amdhsa_group_segment_fixed_size 0
  .amdhsa_kernarg_size 96
  .amdhsa_user_sgpr_count 2
  .amdhsa_user_sgpr_kernarg_segment_ptr 1
  .amdhsa_system_sgpr_workgroup_id_x 1
.end_amdhsa_kernel
```

```asm
; @launch grid=(250,1,1) block=(512,1,1) lds=163840
.amdgcn_target "amdgcn-amd-amdhsa--gfx950"
.text
.globl standalone__tensor_product_equiv_equiformer__graph_kernel
.p2align 8
.type standalone__tensor_product_equiv_equiformer__graph_kernel,@function
standalone__tensor_product_equiv_equiformer__graph_kernel:
    s_cmp_ge_u32 s2, 250
    s_cbranch_scc1 K2_end
    s_load_dwordx16 s[72:87], s[0:1], 0
    s_load_dwordx2 s[70:71], s[0:1], 88
    v_lshrrev_b32 v2, 6, v0
    v_and_b32 v1, 63, v0
    v_readfirstlane_b32 s20, v2
    s_getpc_b64 s[66:67]
    v_lshlrev_b32 v95, 7, v1
    s_cmp_eq_u32 s20, 6
    s_cbranch_scc0 F_nopf0
    global_load_dword v95, v95, s[66:67]
F_nopf0:
    s_mul_i32 s66, s2, 5120
    s_mul_i32 s67, s2, 7680
    v_lshl_add_u32 v3, v0, 4, s66
    v_mul_u32_u24 v4, 24, v0
    v_add_u32 v4, s67, v4
    v_lshlrev_b32 v5, 2, v0
    v_mov_b32 v89, 0
    v_add_u32 v6, 98304, v5
    ds_write_b32 v6, v89
    s_cmp_ge_u32 s20, 5
    s_waitcnt lgkmcnt(0)
    s_cbranch_scc1 F_noload
    global_load_dwordx4 v[8:11], v3, s[80:81] nt
    global_load_dwordx4 v[12:15], v3, s[78:79] nt
    global_load_dwordx4 v[16:19], v4, s[74:75] nt
    global_load_dwordx2 v[20:21], v4, s[74:75] offset:16 nt
F_noload:
    s_load_dword s88, s[70:71], 0
    s_barrier
    v_lshlrev_b32 v248, 2, v1
    v_add_u32 v88, 162816, v248
    ds_write_b32 v88, v89
    ds_write_b32 v88, v89 offset:256
    v_lshlrev_b32 v86, 4, v1
    s_lshl_b32 s21, s20, 13
    v_lshrrev_b32 v6, 5, v1
    v_mul_u32_u24 v6, 5120, v6
    v_and_b32 v7, 31, v1
    v_lshl_add_u32 v6, v7, 1, v6
    s_lshr_b32 s66, s20, 2
    s_lshl_b32 s66, s66, 7
    s_and_b32 s67, s20, 3
    s_mul_i32 s67, s67, 5
    s_add_u32 s68, s67, 0
    s_lshr_b32 s24, s68, 2
    s_lshl_b32 s24, s24, 8
    s_bfe_u32 s69, s68, 0x10001
    s_lshl_b32 s69, s69, 6
    s_add_u32 s24, s24, s69
    s_and_b32 s69, s68, 1
    s_mul_i32 s69, s69, 10240
    s_add_u32 s24, s24, s69
    s_add_u32 s24, s24, s66
    s_add_u32 s68, s67, 1
    s_lshr_b32 s25, s68, 2
    s_lshl_b32 s25, s25, 8
    s_bfe_u32 s69, s68, 0x10001
    s_lshl_b32 s69, s69, 6
    s_add_u32 s25, s25, s69
    s_and_b32 s69, s68, 1
    s_mul_i32 s69, s69, 10240
    s_add_u32 s25, s25, s69
    s_add_u32 s25, s25, s66
    s_add_u32 s68, s67, 2
    s_lshr_b32 s26, s68, 2
    s_lshl_b32 s26, s26, 8
    s_bfe_u32 s69, s68, 0x10001
    s_lshl_b32 s69, s69, 6
    s_add_u32 s26, s26, s69
    s_and_b32 s69, s68, 1
    s_mul_i32 s69, s69, 10240
    s_add_u32 s26, s26, s69
    s_add_u32 s26, s26, s66
    s_add_u32 s68, s67, 3
    s_lshr_b32 s27, s68, 2
    s_lshl_b32 s27, s27, 8
    s_bfe_u32 s69, s68, 0x10001
    s_lshl_b32 s69, s69, 6
    s_add_u32 s27, s27, s69
    s_and_b32 s69, s68, 1
    s_mul_i32 s69, s69, 10240
    s_add_u32 s27, s27, s69
    s_add_u32 s27, s27, s66
    s_add_u32 s68, s67, 4
    s_lshr_b32 s28, s68, 2
    s_lshl_b32 s28, s28, 8
    s_bfe_u32 s69, s68, 0x10001
    s_lshl_b32 s69, s69, 6
    s_add_u32 s28, s28, s69
    s_and_b32 s69, s68, 1
    s_mul_i32 s69, s69, 10240
    s_add_u32 s28, s28, s69
    s_add_u32 s28, s28, s66
    v_mov_b32 v96, 0
    v_mov_b32 v97, 0
    v_mov_b32 v98, 0
    v_mov_b32 v99, 0
    v_mov_b32 v100, 0
    v_mov_b32 v101, 0
    v_mov_b32 v102, 0
    v_mov_b32 v103, 0
    v_mov_b32 v104, 0
    v_mov_b32 v105, 0
    v_mov_b32 v106, 0
    v_mov_b32 v107, 0
    v_mov_b32 v108, 0
    v_mov_b32 v109, 0
    v_mov_b32 v110, 0
    v_mov_b32 v111, 0
    v_mov_b32 v112, 0
    v_mov_b32 v113, 0
    v_mov_b32 v114, 0
    v_mov_b32 v115, 0
    v_mov_b32 v180, 0
    v_mov_b32 v181, 0
    v_mov_b32 v182, 0
    v_mov_b32 v183, 0
    s_mov_b32 s16, s70
    s_and_b32 s17, s71, 0xffff
    s_mov_b32 s18, 24165888
    s_mov_b32 s19, 0x20000
    v_lshrrev_b32 v2, 3, v1
    v_lshl_add_u32 v2, s20, 5, v2
    v_and_b32 v91, 7, v1
    v_mul_u32_u24 v94, 384, v2
    v_lshl_add_u32 v94, v91, 4, v94
    v_lshlrev_b32 v93, 2, v2
    v_add_u32 v93, 98304, v93
    v_mul_u32_u24 v92, 32000, v2
    v_lshl_add_u32 v92, v91, 4, v92
    v_mul_u32_u24 v90, 40960, v2
    s_mov_b32 s32, s82
    s_and_b32 s33, s83, 0xffff
    s_mov_b32 s34, 20480
    s_mov_b32 s35, 0x20000
    s_cmp_ge_u32 s20, 5
    s_cbranch_scc1 F_helper
    s_mov_b32 s22, 52429
    s_mov_b32 s23, 0x05040100
    s_mov_b32 s66, 98304
    s_movk_i32 s67, -40
    v_mov_b32 v7, 1
    v_add_u32 v31, 1, v5
    v_add_u32 v32, 2, v5
    v_add_u32 v33, 3, v5
    s_waitcnt vmcnt(3)
    v_mul_u32_u24 v22, s22, v8
    v_mul_u32_u24 v23, s22, v9
    v_mul_u32_u24 v24, s22, v10
    v_mul_u32_u24 v25, s22, v11
    v_lshrrev_b32 v22, 21, v22
    v_lshrrev_b32 v23, 21, v23
    v_lshrrev_b32 v24, 21, v24
    v_lshrrev_b32 v25, 21, v25
    v_lshl_add_u32 v34, v22, 2, s66
    ds_add_rtn_u32 v26, v34, v7
    v_lshl_add_u32 v35, v23, 2, s66
    ds_add_rtn_u32 v27, v35, v7
    v_lshl_add_u32 v36, v24, 2, s66
    ds_add_rtn_u32 v28, v36, v7
    v_lshl_add_u32 v37, v25, 2, s66
    ds_add_rtn_u32 v29, v37, v7
    buffer_load_short_d16_hi v96, v6, s[32:35], s24 offen offset:0
    buffer_load_short_d16_hi v97, v6, s[32:35], s24 offen offset:1280
    buffer_load_short_d16_hi v98, v6, s[32:35], s24 offen offset:2560
    buffer_load_short_d16_hi v99, v6, s[32:35], s24 offen offset:3840
    buffer_load_short_d16_hi v100, v6, s[32:35], s25 offen offset:0
    buffer_load_short_d16_hi v101, v6, s[32:35], s25 offen offset:1280
    buffer_load_short_d16_hi v102, v6, s[32:35], s25 offen offset:2560
    buffer_load_short_d16_hi v103, v6, s[32:35], s25 offen offset:3840
    buffer_load_short_d16_hi v104, v6, s[32:35], s26 offen offset:0
    buffer_load_short_d16_hi v105, v6, s[32:35], s26 offen offset:1280
    buffer_load_short_d16_hi v106, v6, s[32:35], s26 offen offset:2560
    buffer_load_short_d16_hi v107, v6, s[32:35], s26 offen offset:3840
    buffer_load_short_d16_hi v108, v6, s[32:35], s27 offen offset:0
    buffer_load_short_d16_hi v109, v6, s[32:35], s27 offen offset:1280
    buffer_load_short_d16_hi v110, v6, s[32:35], s27 offen offset:2560
    buffer_load_short_d16_hi v111, v6, s[32:35], s27 offen offset:3840
    buffer_load_short_d16_hi v112, v6, s[32:35], s28 offen offset:0
    buffer_load_short_d16_hi v113, v6, s[32:35], s28 offen offset:1280
    buffer_load_short_d16_hi v114, v6, s[32:35], s28 offen offset:2560
    buffer_load_short_d16_hi v115, v6, s[32:35], s28 offen offset:3840
    v_mad_i32_i24 v2, v22, s67, v8
    v_mul_u32_u24 v22, 384, v22
    v_lshl_or_b32 v42, v2, 11, v5
    v_mad_i32_i24 v2, v23, s67, v9
    v_mul_u32_u24 v23, 384, v23
    v_lshl_or_b32 v46, v2, 11, v31
    v_mad_i32_i24 v2, v24, s67, v10
    v_mul_u32_u24 v24, 384, v24
    v_lshl_or_b32 v50, v2, 11, v32
    v_mad_i32_i24 v2, v25, s67, v11
    v_mul_u32_u24 v25, 384, v25
    v_lshl_or_b32 v54, v2, 11, v33
    s_waitcnt vmcnt(20)
    v_mov_b32 v40, v16
    v_perm_b32 v41, v12, v17, s23
    v_alignbit_b32 v44, v18, v17, 16
    v_alignbit_b32 v45, v13, v18, 16
    v_mov_b32 v48, v19
    v_perm_b32 v49, v14, v20, s23
    v_alignbit_b32 v52, v21, v20, 16
    v_alignbit_b32 v53, v15, v21, 16
    v_xor_b32 v41, 0x8000, v41
    v_xor_b32 v45, 0x8000, v45
    v_xor_b32 v49, 0x8000, v49
    v_xor_b32 v53, 0x8000, v53
    s_waitcnt lgkmcnt(0)
    v_min_u32 v26, 23, v26
    v_lshl_add_u32 v34, v26, 4, v22
    ds_write_b128 v34, v[40:43]
    v_min_u32 v27, 23, v27
    v_lshl_add_u32 v35, v27, 4, v23
    ds_write_b128 v35, v[44:47]
    v_min_u32 v28, 23, v28
    v_lshl_add_u32 v36, v28, 4, v24
    ds_write_b128 v36, v[48:51]
    v_min_u32 v29, 23, v29
    v_lshl_add_u32 v37, v29, 4, v25
    ds_write_b128 v37, v[52:55]
    s_branch F_staged
F_helper:
    buffer_load_short_d16_hi v96, v6, s[32:35], s24 offen offset:0
    buffer_load_short_d16_hi v97, v6, s[32:35], s24 offen offset:1280
    buffer_load_short_d16_hi v98, v6, s[32:35], s24 offen offset:2560
    buffer_load_short_d16_hi v99, v6, s[32:35], s24 offen offset:3840
    buffer_load_short_d16_hi v100, v6, s[32:35], s25 offen offset:0
    buffer_load_short_d16_hi v101, v6, s[32:35], s25 offen offset:1280
    buffer_load_short_d16_hi v102, v6, s[32:35], s25 offen offset:2560
    buffer_load_short_d16_hi v103, v6, s[32:35], s25 offen offset:3840
    buffer_load_short_d16_hi v104, v6, s[32:35], s26 offen offset:0
    buffer_load_short_d16_hi v105, v6, s[32:35], s26 offen offset:1280
    buffer_load_short_d16_hi v106, v6, s[32:35], s26 offen offset:2560
    buffer_load_short_d16_hi v107, v6, s[32:35], s26 offen offset:3840
    buffer_load_short_d16_hi v108, v6, s[32:35], s27 offen offset:0
    buffer_load_short_d16_hi v109, v6, s[32:35], s27 offen offset:1280
    buffer_load_short_d16_hi v110, v6, s[32:35], s27 offen offset:2560
    buffer_load_short_d16_hi v111, v6, s[32:35], s27 offen offset:3840
    buffer_load_short_d16_hi v112, v6, s[32:35], s28 offen offset:0
    buffer_load_short_d16_hi v113, v6, s[32:35], s28 offen offset:1280
    buffer_load_short_d16_hi v114, v6, s[32:35], s28 offen offset:2560
    buffer_load_short_d16_hi v115, v6, s[32:35], s28 offen offset:3840
    s_cmp_eq_u32 s20, 6
    s_cbranch_scc0 F_nopf
    s_getpc_b64 s[66:67]
F_pc:
    s_lshr_b32 s68, s2, 3
    s_mul_i32 s68, s68, ((K2_last-F_pc)/128/31+1)*128
    v_lshl_add_u32 v2, v1, 7, s68
    v_min_u32 v2, K2_last-F_pc-4, v2
    v_cmp_gt_u32 vcc, (K2_last-F_pc)/128/31+1, v1
    s_mov_b64 exec, vcc
    global_load_dword v95, v2, s[66:67]
    s_mov_b64 exec, -1
F_nopf:
    s_cmp_eq_u32 s20, 7
    s_cbranch_scc0 F_staged
    s_cmp_lt_u32 s2, 160
    s_cbranch_scc0 F_staged
    s_mul_i32 s22, s2, 3277
    s_lshr_b32 s22, s22, 16
    s_mul_i32 s68, s22, 20
    s_sub_u32 s68, s2, s68
    s_cmp_lt_u32 s68, 8
    s_cselect_b64 s[66:67], s[84:85], s[86:87]
    s_cselect_b32 s23, 0, 8
    s_sub_u32 s68, s68, s23
    s_and_b32 s23, s68, 1
    s_lshr_b32 s68, s68, 1
    s_lshl_b32 s68, s68, 14
    s_lshl_b32 s23, s23, 12
    s_add_u32 s68, s68, s23
    s_lshl_b32 s22, s22, 5
    s_add_u32 s68, s68, s22
    v_lshrrev_b32 v2, 4, v1
    v_lshlrev_b32 v2, 10, v2
    v_and_b32 v3, 15, v1
    v_lshl_add_u32 v2, v3, 1, v2
    v_add_u32 v2, s68, v2
    v_add_u32 v3, 8192, v2
    global_load_ushort v176, v2, s[66:67] offset:0
    global_load_short_d16_hi v180, v3, s[66:67] offset:0
    global_load_ushort v177, v2, s[66:67] offset:256
    global_load_short_d16_hi v181, v3, s[66:67] offset:256
    global_load_ushort v178, v2, s[66:67] offset:512
    global_load_short_d16_hi v182, v3, s[66:67] offset:512
    global_load_ushort v179, v2, s[66:67] offset:768
    global_load_short_d16_hi v183, v3, s[66:67] offset:768
F_staged:
    s_lshl_b32 s66, s2, 7
    s_add_u32 s66, s66, 164864
    s_cmp_eq_u32 s20, 7
    s_cselect_b32 s22, 0xffff, -1
    s_cselect_b32 s23, 0, -1
    s_waitcnt lgkmcnt(0)
    s_add_u32 s88, s88, 1
    s_barrier
    ds_read_b32 v40, v93 offset:0
    ds_read_b128 v[8:11], v94 offset:0
    ds_read_b128 v[12:15], v94 offset:128
    ds_read_b32 v41, v93 offset:32
    ds_read_b128 v[16:19], v94 offset:3072
    ds_read_b128 v[20:23], v94 offset:3200
    ds_read_b32 v42, v93 offset:64
    ds_read_b128 v[24:27], v94 offset:6144
    ds_read_b128 v[28:31], v94 offset:6272
    ds_read_b32 v43, v93 offset:96
    ds_read_b128 v[32:35], v94 offset:9216
    ds_read_b128 v[36:39], v94 offset:9344
    s_waitcnt vmcnt(0)
    s_waitcnt lgkmcnt(9)
    v_min_u32 v5, 31, v40
    v_bfe_u32 v6, v14, 11, 6
    v_and_b32 v10, 0x1ffff, v10
    v_lshl_or_b32 v6, v5, 6, v6
    v_mov_b32 v11, s88
    v_lshl_or_b32 v10, v6, 17, v10
    v_mov_b32 v15, s88
    buffer_store_dwordx4 v[8:11], v92, s[16:19], s66 offen sc1
    v_cmp_lt_u32 vcc, 8, v40
    s_add_u32 s67, s66, 8000000
    s_mov_b64 exec, vcc
    s_cbranch_execz F_w0
    buffer_store_dwordx4 v[12:15], v92, s[16:19], s67 offen sc1
    v_cmp_lt_u32 vcc, 16, v40
    s_add_u32 s67, s67, 8000000
    s_mov_b64 exec, vcc
    s_cbranch_execz F_w0
    ds_read_b128 v[44:47], v94 offset:256
    s_waitcnt lgkmcnt(0)
    v_mov_b32 v47, s88
    buffer_store_dwordx4 v[44:47], v92, s[16:19], s67 offen sc1
    s_nop 1
F_w0:
    s_mov_b64 exec, -1
    s_add_u32 s66, s66, 256000
    s_waitcnt lgkmcnt(6)
    v_min_u32 v5, 31, v41
    v_bfe_u32 v6, v22, 11, 6
    v_and_b32 v18, 0x1ffff, v18
    v_lshl_or_b32 v6, v5, 6, v6
    v_mov_b32 v19, s88
    v_lshl_or_b32 v18, v6, 17, v18
    v_mov_b32 v23, s88
    buffer_store_dwordx4 v[16:19], v92, s[16:19], s66 offen sc1
    v_cmp_lt_u32 vcc, 8, v41
    s_add_u32 s67, s66, 8000000
    s_mov_b64 exec, vcc
    s_cbranch_execz F_w1
    buffer_store_dwordx4 v[20:23], v92, s[16:19], s67 offen sc1
    v_cmp_lt_u32 vcc, 16, v41
    s_add_u32 s67, s67, 8000000
    s_mov_b64 exec, vcc
    s_cbranch_execz F_w1
    ds_read_b128 v[44:47], v94 offset:3328
    s_waitcnt lgkmcnt(0)
    v_mov_b32 v47, s88
    buffer_store_dwordx4 v[44:47], v92, s[16:19], s67 offen sc1
    s_nop 1
F_w1:
    s_mov_b64 exec, -1
    s_add_u32 s66, s66, 256000
    s_waitcnt lgkmcnt(3)
    v_min_u32 v5, 31, v42
    v_bfe_u32 v6, v30, 11, 6
    v_and_b32 v26, 0x1ffff, v26
    v_lshl_or_b32 v6, v5, 6, v6
    v_mov_b32 v27, s88
    v_lshl_or_b32 v26, v6, 17, v26
    v_mov_b32 v31, s88
    buffer_store_dwordx4 v[24:27], v92, s[16:19], s66 offen sc1
    v_cmp_lt_u32 vcc, 8, v42
    s_add_u32 s67, s66, 8000000
    s_mov_b64 exec, vcc
    s_cbranch_execz F_w2
    buffer_store_dwordx4 v[28:31], v92, s[16:19], s67 offen sc1
    v_cmp_lt_u32 vcc, 16, v42
    s_add_u32 s67, s67, 8000000
    s_mov_b64 exec, vcc
    s_cbranch_execz F_w2
    ds_read_b128 v[44:47], v94 offset:6400
    s_waitcnt lgkmcnt(0)
    v_mov_b32 v47, s88
    buffer_store_dwordx4 v[44:47], v92, s[16:19], s67 offen sc1
    s_nop 1
F_w2:
    s_mov_b64 exec, -1
    s_add_u32 s66, s66, 256000
    s_waitcnt lgkmcnt(0)
    v_min_u32 v5, 31, v43
    v_bfe_u32 v6, v38, 11, 6
    v_and_b32 v34, 0x1ffff, v34
    v_lshl_or_b32 v6, v5, 6, v6
    v_mov_b32 v35, s88
    v_lshl_or_b32 v34, v6, 17, v34
    v_mov_b32 v39, s88
    s_mov_b64 exec, s[22:23]
    buffer_store_dwordx4 v[32:35], v92, s[16:19], s66 offen sc1
    v_cmp_lt_u32 vcc, 8, v43
    s_add_u32 s67, s66, 8000000
    s_mov_b64 exec, vcc
    s_cbranch_execz F_w3
    buffer_store_dwordx4 v[36:39], v92, s[16:19], s67 offen sc1
    v_cmp_lt_u32 vcc, 16, v43
    s_add_u32 s67, s67, 8000000
    s_mov_b64 exec, vcc
    s_cbranch_execz F_w3
    ds_read_b128 v[44:47], v94 offset:9472
    s_waitcnt lgkmcnt(0)
    v_mov_b32 v47, s88
    buffer_store_dwordx4 v[44:47], v92, s[16:19], s67 offen sc1
    s_nop 1
F_w3:
    s_mov_b64 exec, -1
    s_cmp_eq_u32 s20, 7
    s_cbranch_scc0 F_nofrag
    s_cmp_lt_u32 s2, 160
    s_cbranch_scc0 F_nofrag
    v_or_b32 v176, v176, v180
    v_or_b32 v177, v177, v181
    v_or_b32 v178, v178, v182
    v_or_b32 v179, v179, v183
    s_lshl_b32 s66, s2, 10
    s_add_u32 s66, s66, 1024
    buffer_store_dwordx4 v[176:179], v86, s[16:19], s66 offen sc1
F_nofrag:
    s_barrier
    s_mul_i32 s24, s2, 32000
    s_lshl_b32 s25, s20, 12
    s_add_u32 s24, s24, s25
    s_add_u32 s24, s24, 164864
    s_add_u32 s25, s24, 8000000
    s_add_u32 s26, s25, 8000000
    v_mov_b32 v22, 0
    v_mov_b32 v23, s88
    s_mul_i32 s68, s20, 5120
    s_cmp_ge_u32 s20, 4
    s_cselect_b32 s70, 45056, 0
    s_add_u32 s68, s68, s70
    v_add_u32 v2, s68, v86
    ds_write_b128 v2, v[96:99] offset:0
    ds_write_b128 v2, v[100:103] offset:1024
    ds_write_b128 v2, v[104:107] offset:2048
    ds_write_b128 v2, v[108:111] offset:3072
    ds_write_b128 v2, v[112:115] offset:4096
    v_mov_b32 v4, 2130738944
    v_mov_b32 v5, 2130738944
    v_mov_b32 v6, 2130738944
    v_mov_b32 v7, 2130738944
    v_lshlrev_b32 v2, 4, v0
    v_add_u32 v3, 86016, v2
    ds_write_b128 v3, v[4:7] offset:0
    ds_write_b128 v3, v[4:7] offset:8192
    ds_write_b128 v3, v[4:7] offset:16384
    ds_write_b128 v3, v[4:7] offset:24576
    ds_write_b128 v3, v[4:7] offset:32768
    ds_write_b128 v3, v[4:7] offset:40960
    ds_write_b128 v3, v[4:7] offset:49152
    ds_write_b128 v3, v[4:7] offset:57344
    v_add_u32 v3, 0x10000, v3
    ds_write_b128 v3, v[4:7] offset:0
    v_min_u32 v2, 3056, v2
    v_add_u32 v2, 159744, v2
    ds_write_b128 v2, v[4:7]
    s_sub_u32 s72, s72, 128
    s_subb_u32 s73, s73, 0
    s_mov_b32 s4, s72
    s_and_b32 s5, s73, 0xffff
    s_mov_b32 s6, 10240000
    s_mov_b32 s7, 0x20000
    s_sub_u32 s72, s72, 1024
    s_subb_u32 s73, s73, 0
    s_mov_b32 s8, s72
    s_and_b32 s9, s73, 0xffff
    s_mov_b32 s10, 10241024
    s_mov_b32 s11, 0x20000
    s_mov_b32 s12, s76
    s_and_b32 s13, s77, 0xffff
    s_mov_b32 s14, 10240000
    s_mov_b32 s15, 0x20000
    v_lshrrev_b32 v2, 5, v1
    v_bfe_u32 v3, v1, 2, 2
    v_and_b32 v4, 3, v1
    v_bfe_u32 v5, v1, 4, 1
    v_lshlrev_b32 v6, 9, v2
    v_lshl_add_u32 v6, v3, 7, v6
    v_lshl_add_u32 v6, v5, 5, v6
    v_lshl_add_u32 v6, v4, 3, v6
    v_lshrrev_b32 v7, 1, v3
    v_lshl_add_u32 v6, v7, 6, v6
    v_add_u32 v244, s21, v6
    v_xor_b32 v245, 64, v244
    v_lshlrev_b32 v6, 7, v2
    v_lshl_add_u32 v6, v7, 5, v6
    v_and_b32 v7, 1, v3
    v_xor_b32 v7, 1, v7
    v_mul_u32_u24 v7, 90112, v7
    v_add_u32 v6, v6, v7
    v_lshl_add_u32 v249, v4, 3, v6
    v_lshl_add_u32 v6, v2, 2, v4
    v_bfe_u32 v7, v1, 2, 1
    v_lshl_add_u32 v6, v7, 3, v6
    v_lshlrev_b32 v6, 3, v6
    v_bfe_u32 v7, v1, 3, 1
    v_add_u32 v5, 1, v5
    v_mul_u32_u24 v7, v7, v5
    v_lshl_add_u32 v250, v7, 1, v6
    v_and_b32 v6, 0x38, v1
    v_add_u32 v247, 6, v6
    v_lshrrev_b32 v6, 2, v1
    v_lshrrev_b32 v7, 4, v1
    v_xor_b32 v6, v6, v7
    v_and_b32 v6, 1, v6
    v_lshlrev_b32 v6, 6, v6
    v_lshl_add_u32 v246, v4, 4, v6
    v_mov_b32 v242, 1.0
    v_mov_b32 v243, 1.0
    s_mov_b32 s54, 0xffffff00
    s_mov_b32 s55, 0xffffff00
    s_mov_b32 s56, 0xffff
    s_mov_b32 s57, 0xffff
    s_mov_b32 s58, 0
    s_mov_b32 s59, 134217856
    s_mov_b32 s60, 262272
    s_mov_b32 s61, 402915456
    s_mov_b32 s62, 940179840
    s_mov_b32 s63, 403046528
    s_mov_b32 s64, 402784384
    s_mov_b32 s65, 134348928
    s_mov_b32 s38, 128
    s_mov_b32 s33, -1
    s_and_b32 s68, s20, 3
    s_lshl_b32 s68, s68, 2
    s_lshr_b32 s69, s20, 2
    s_add_u32 s68, s68, s69
    s_lshl_b32 s68, s68, 4
    s_add_u32 s68, s68, 163072
    v_mov_b32 v251, s68
    s_mov_b32 s53, 0
    s_mov_b32 s50, 0
    s_mov_b32 s51, 0
    s_mov_b32 s47, 0
    s_mov_b32 s42, 0
    s_mov_b32 s3, 0
    s_mov_b32 s89, 0
    s_mov_b32 s34, 128
    s_mov_b32 s35, 384
    s_mov_b32 s36, 640
    s_mov_b32 s37, 896
    s_waitcnt lgkmcnt(0)
    s_barrier
    buffer_load_dwordx4 v[8:11], v86, s[16:19], s24 offen offset:0 sc1
    buffer_load_dwordx4 v[12:15], v86, s[16:19], s24 offen offset:1024 sc1
    buffer_load_dwordx4 v[16:19], v86, s[16:19], s24 offen offset:2048 sc1
    s_mov_b64 exec, s[22:23]
    buffer_load_dwordx4 v[20:23], v86, s[16:19], s24 offen offset:3072 sc1
    s_mov_b64 exec, -1
    ds_read_b128 v[96:99], v86 offset:0
    ds_read_b128 v[100:103], v86 offset:1024
    ds_read_b128 v[104:107], v86 offset:2048
    ds_read_b128 v[108:111], v86 offset:3072
    ds_read_b128 v[112:115], v86 offset:4096
    ds_read_b128 v[116:119], v86 offset:5120
    ds_read_b128 v[120:123], v86 offset:6144
    ds_read_b128 v[124:127], v86 offset:7168
    ds_read_b128 v[128:131], v86 offset:8192
    ds_read_b128 v[132:135], v86 offset:9216
    ds_read_b128 v[136:139], v86 offset:10240
    ds_read_b128 v[140:143], v86 offset:11264
    ds_read_b128 v[144:147], v86 offset:12288
    ds_read_b128 v[148:151], v86 offset:13312
    ds_read_b128 v[152:155], v86 offset:14336
    ds_read_b128 v[156:159], v86 offset:15360
    ds_read_b128 v[160:163], v86 offset:16384
    ds_read_b128 v[164:167], v86 offset:17408
    ds_read_b128 v[168:171], v86 offset:18432
    ds_read_b128 v[172:175], v86 offset:19456
    s_mov_b32 s27, 32768
    s_mov_b32 s71, 162816
    v_mov_b32 v3, 1
    s_cmp_eq_u32 s20, 7
    s_cselect_b32 s52, 160, 0
    v_cmp_gt_u32 s[68:69], 40, v1
    s_mov_b64 s[28:29], 0xff
    s_lshr_b32 s66, s2, 3
    s_lshl_b32 s66, s66, 3
    s_add_u32 s66, s66, s20
    s_mul_i32 s66, s66, 40
    v_min_u32 v93, 39, v1
    v_add_u32 v93, s66, v93
    v_lshlrev_b32 v93, 10, v93
    v_mov_b32 v94, 0x7f000000
F_poll:
    s_waitcnt vmcnt(0)
F_poll1:
    v_cmp_ne_u32 s[72:73], s88, v11
    v_cmp_ne_u32 s[74:75], s88, v15
    v_cmp_ne_u32 s[76:77], s88, v19
    v_cmp_ne_u32 s[78:79], s88, v23
    s_or_b64 s[80:81], s[72:73], s[74:75]
    s_or_b64 s[82:83], s[76:77], s[78:79]
    s_or_b64 s[80:81], s[80:81], s[82:83]
    s_cbranch_scc1 F_again
F_got:
    v_bfe_u32 v2, v10, 23, 5
    v_bfe_u32 v60, v10, 11, 6
    v_cmp_gt_u32 s[80:81], v2, v91
    v_lshl_add_u32 v60, v60, 2, s71
    v_cmp_lt_u32 s[72:73], 8, v2
    v_max_u32 v89, v89, v2
    s_mov_b64 exec, s[80:81]
    ds_add_rtn_u32 v72, v60, v3
    s_mov_b64 exec, s[72:73]
    s_cbranch_execz F_h0
    buffer_load_dwordx4 v[24:27], v86, s[16:19], s25 offen offset:0 sc1
    v_sub_u32 v56, v2, v91
    v_bfe_u32 v64, v10, 17, 6
    v_cmp_lt_u32 vcc, 8, v56
    v_lshl_add_u32 v64, v64, 2, s71
    s_mov_b64 exec, vcc
    ds_add_rtn_u32 v76, v64, v3
F_h0:
    s_mov_b64 exec, -1
    v_bfe_u32 v2, v14, 23, 5
    v_bfe_u32 v61, v14, 11, 6
    v_cmp_gt_u32 s[82:83], v2, v91
    v_lshl_add_u32 v61, v61, 2, s71
    v_cmp_lt_u32 s[74:75], 8, v2
    v_max_u32 v89, v89, v2
    s_mov_b64 exec, s[82:83]
    ds_add_rtn_u32 v73, v61, v3
    s_mov_b64 exec, s[74:75]
    s_cbranch_execz F_h1
    buffer_load_dwordx4 v[28:31], v86, s[16:19], s25 offen offset:1024 sc1
    v_sub_u32 v57, v2, v91
    v_bfe_u32 v65, v14, 17, 6
    v_cmp_lt_u32 vcc, 8, v57
    v_lshl_add_u32 v65, v65, 2, s71
    s_mov_b64 exec, vcc
    ds_add_rtn_u32 v77, v65, v3
F_h1:
    s_mov_b64 exec, -1
    v_bfe_u32 v2, v18, 23, 5
    v_bfe_u32 v62, v18, 11, 6
    v_cmp_gt_u32 s[84:85], v2, v91
    v_lshl_add_u32 v62, v62, 2, s71
    v_cmp_lt_u32 s[76:77], 8, v2
    v_max_u32 v89, v89, v2
    s_mov_b64 exec, s[84:85]
    ds_add_rtn_u32 v74, v62, v3
    s_mov_b64 exec, s[76:77]
    s_cbranch_execz F_h2
    buffer_load_dwordx4 v[32:35], v86, s[16:19], s25 offen offset:2048 sc1
    v_sub_u32 v58, v2, v91
    v_bfe_u32 v66, v18, 17, 6
    v_cmp_lt_u32 vcc, 8, v58
    v_lshl_add_u32 v66, v66, 2, s71
    s_mov_b64 exec, vcc
    ds_add_rtn_u32 v78, v66, v3
F_h2:
    s_mov_b64 exec, -1
    v_bfe_u32 v2, v22, 23, 5
    v_bfe_u32 v63, v22, 11, 6
    v_cmp_gt_u32 s[86:87], v2, v91
    v_lshl_add_u32 v63, v63, 2, s71
    v_cmp_lt_u32 s[78:79], 8, v2
    v_max_u32 v89, v89, v2
    s_mov_b64 exec, s[86:87]
    ds_add_rtn_u32 v75, v63, v3
    s_mov_b64 exec, s[78:79]
    s_cbranch_execz F_h3
    buffer_load_dwordx4 v[36:39], v86, s[16:19], s25 offen offset:3072 sc1
    v_sub_u32 v59, v2, v91
    v_bfe_u32 v67, v22, 17, 6
    v_cmp_lt_u32 vcc, 8, v59
    v_lshl_add_u32 v67, v67, 2, s71
    s_mov_b64 exec, vcc
    ds_add_rtn_u32 v79, v67, v3
F_h3:
    s_mov_b64 exec, -1
    v_cmp_lt_u32 s[30:31], 16, v89
    s_mov_b32 s27, 262144
    s_cmp_lg_u64 s[30:31], 0
    s_cbranch_scc1 F_l3
F_l3r:
    v_and_b32 v10, 0x7ff, v10
    v_lshl_add_u32 v10, v10, 5, v90
    v_or_b32 v11, 16, v10
    v_and_b32 v14, 0x7ff, v14
    v_lshl_add_u32 v14, v14, 5, v90
    v_add_u32 v14, 327680, v14
    v_or_b32 v15, 16, v14
    v_and_b32 v18, 0x7ff, v18
    v_lshl_add_u32 v18, v18, 5, v90
    v_add_u32 v18, 655360, v18
    v_or_b32 v19, 16, v18
    v_and_b32 v22, 0x7ff, v22
    v_lshl_add_u32 v22, v22, 5, v90
    v_add_u32 v22, 983040, v22
    v_or_b32 v23, 16, v22
    s_cmp_lt_u32 s2, s52
    s_cbranch_scc1 F_flag
F_flagr:
    s_waitcnt lgkmcnt(0)
    s_barrier
    ds_read_b32 v4, v88
    buffer_load_dword v95, v93, s[4:7], 0 offen offset:128
    v_lshlrev_b32 v72, 3, v72
    v_lshlrev_b32 v73, 3, v73
    v_lshlrev_b32 v74, 3, v74
    v_lshlrev_b32 v75, 3, v75
    v_lshlrev_b32 v76, 3, v76
    v_lshlrev_b32 v77, 3, v77
    v_lshlrev_b32 v78, 3, v78
    v_lshlrev_b32 v79, 3, v79
    s_waitcnt lgkmcnt(0)
    v_add_u32 v5, 15, v4
    v_cmp_lt_u32 vcc, 64, v4
    v_lshrrev_b32 v5, 4, v5
    v_med3_u32 v5, v5, 1, 4
    v_mul_u32_u24 v6, 640, v5
    v_max_u32 v6, 1536, v6
    v_cndmask_b32 v6, 0, v6, s[68:69]
    s_cmp_lg_u64 vcc, 0
    s_cbranch_scc1 SLOW
    v_mov_b32 v7, v6
    v_add_u32 v2, 7, v4
    v_lshrrev_b32 v2, 3, v2
    v_add_u32_dpp v7, v7, v7 row_shr:1 row_mask:0xf bank_mask:0xf
    v_max_u32 v2, 2, v2
    v_cmp_eq_u32 vcc, 7, v2
    v_add_u32_dpp v7, v7, v7 row_shr:2 row_mask:0xf bank_mask:0xf
    v_lshlrev_b32 v92, 22, v5
    v_lshlrev_b32 v5, 18, v5
    v_add_u32_dpp v7, v7, v7 row_shr:4 row_mask:0xf bank_mask:0xf
    v_lshl_or_b32 v5, v1, 21, v5
    v_addc_co_u32 v2, vcc, 0, v2, vcc
    v_add_u32_dpp v7, v7, v7 row_shr:8 row_mask:0xf bank_mask:0xf
    v_lshl_or_b32 v5, v2, 28, v5
    v_med3_u32 v2, v2, 3, 6
    v_add_u32_dpp v7, v7, v7 row_bcast:15 row_mask:0xa bank_mask:0xf
    v_cndmask_b32 v2, 0, v2, s[68:69]
    v_mov_b32 v84, 63
    v_add_u32_dpp v7, v7, v7 row_bcast:31 row_mask:0xc bank_mask:0xf
    s_mov_b32 s71, 0x2000
    v_readlane_b32 s66, v7, 63
    v_sub_u32 v7, v7, v6
    v_add_u32 v7, 86016, v7
    v_lshrrev_b32 v6, 3, v7
    v_mad_u32_u24 v92, v7, s71, v92
    v_or_b32 v92, v92, v6
    ds_bpermute_b32 v60, v60, v92
    ds_bpermute_b32 v61, v61, v92
    ds_bpermute_b32 v62, v62, v92
    ds_bpermute_b32 v63, v63, v92
    ds_bpermute_b32 v64, v64, v92
    ds_bpermute_b32 v65, v65, v92
    ds_bpermute_b32 v66, v66, v92
    ds_bpermute_b32 v67, v67, v92
    v_cmp_eq_u32 vcc, 6, v2
    v_or_b32 v6, v5, v7
    s_cmp_gt_u32 s66, 76800
    s_cbranch_scc1 SLOW
    v_mbcnt_lo_u32_b32 v5, vcc_lo, 0
    v_mbcnt_hi_u32_b32 v5, vcc_hi, v5
    s_bcnt1_i32_b64 s71, vcc
    v_cndmask_b32 v84, v84, v5, vcc
    v_cmp_eq_u32 vcc, 5, v2
    v_mov_b32 v3, s71
    s_nop 0
    v_mbcnt_lo_u32_b32 v5, vcc_lo, v3
    v_mbcnt_hi_u32_b32 v5, vcc_hi, v5
    s_bcnt1_i32_b64 s71, vcc
    v_cndmask_b32 v84, v84, v5, vcc
    v_cmp_eq_u32 vcc, 4, v2
    v_add_u32 v3, s71, v3
    s_nop 0
    v_mbcnt_lo_u32_b32 v5, vcc_lo, v3
    v_mbcnt_hi_u32_b32 v5, vcc_hi, v5
    s_bcnt1_i32_b64 s71, vcc
    v_cndmask_b32 v84, v84, v5, vcc
    v_cmp_eq_u32 vcc, 3, v2
    v_add_u32 v3, s71, v3
    s_nop 0
    v_mbcnt_lo_u32_b32 v5, vcc_lo, v3
    v_mbcnt_hi_u32_b32 v5, vcc_hi, v5
    v_cndmask_b32 v84, v84, v5, vcc
    s_waitcnt lgkmcnt(7)
    v_mad_u32_u16 v2, v60, 8, v72
    v_mad_u32_u16 v3, v60, 8, v72 op_sel:[1,0,0,0]
    s_mov_b64 exec, s[80:81]
    ds_write_b64 v2, v[10:11]
    ds_write_b64 v3, v[8:9]
    s_mov_b64 exec, -1
    s_waitcnt lgkmcnt(8)
    v_mad_u32_u16 v2, v61, 8, v73
    v_mad_u32_u16 v3, v61, 8, v73 op_sel:[1,0,0,0]
    s_mov_b64 exec, s[82:83]
    ds_write_b64 v2, v[14:15]
    ds_write_b64 v3, v[12:13]
    s_mov_b64 exec, -1
    s_waitcnt lgkmcnt(9)
    v_mad_u32_u16 v2, v62, 8, v74
    v_mad_u32_u16 v3, v62, 8, v74 op_sel:[1,0,0,0]
    s_mov_b64 exec, s[84:85]
    ds_write_b64 v2, v[18:19]
    ds_write_b64 v3, v[16:17]
    s_mov_b64 exec, -1
    s_waitcnt lgkmcnt(10)
    v_mad_u32_u16 v2, v63, 8, v75
    v_mad_u32_u16 v3, v63, 8, v75 op_sel:[1,0,0,0]
    s_mov_b64 exec, s[86:87]
    ds_write_b64 v2, v[22:23]
    ds_write_b64 v3, v[20:21]
    s_mov_b64 exec, -1
    v_bfe_u32 v2, v84, 2, 1
    v_bfe_u32 v3, v84, 3, 1
    v_mul_u32_u24 v2, 3, v2
    v_lshl_or_b32 v3, v3, 2, v2
    v_xor_b32 v84, v84, v3
    s_lshr_b32 s66, s2, 3
    v_add_u32 v2, s66, v84
    v_lshlrev_b32 v2, 3, v2
    v_add_u32 v2, v2, v84
    v_cmp_gt_u32 vcc, 32, v84
    v_and_b32 v2, 24, v2
    v_and_or_b32 v2, v84, 7, v2
    v_cndmask_b32 v84, v84, v2, vcc
    v_cmp_eq_u32 vcc, s20, v84
    s_ff1_i32_b64 s67, vcc
    v_readlane_b32 s80, v6, s67
    s_waitcnt vmcnt(1) lgkmcnt(8)
    s_mov_b64 exec, s[72:73]
    s_cbranch_execz F_s0
F_sp0:
    v_cmp_ne_u32 vcc, s88, v27
    s_cbranch_vccnz F_sa0
F_sg0:
    v_cmpx_lt_u32 vcc, 8, v56
    v_and_b32 v26, 0x7ff, v26
    v_lshl_add_u32 v26, v26, 5, v90
    v_or_b32 v27, 16, v26
    v_mad_u32_u16 v2, v64, 8, v76
    v_mad_u32_u16 v3, v64, 8, v76 op_sel:[1,0,0,0]
    ds_write_b64 v2, v[26:27]
    ds_write_b64 v3, v[24:25]
F_s0:
    s_mov_b64 exec, s[74:75]
    s_cbranch_execz F_s1
F_sp1:
    v_cmp_ne_u32 vcc, s88, v31
    s_cbranch_vccnz F_sa1
F_sg1:
    v_cmpx_lt_u32 vcc, 8, v57
    v_and_b32 v30, 0x7ff, v30
    v_lshl_add_u32 v30, v30, 5, v90
    v_add_u32 v30, 327680, v30
    v_or_b32 v31, 16, v30
    v_mad_u32_u16 v2, v65, 8, v77
    v_mad_u32_u16 v3, v65, 8, v77 op_sel:[1,0,0,0]
    ds_write_b64 v2, v[30:31]
    ds_write_b64 v3, v[28:29]
F_s1:
    s_mov_b64 exec, s[76:77]
    s_cbranch_execz F_s2
F_sp2:
    v_cmp_ne_u32 vcc, s88, v35
    s_cbranch_vccnz F_sa2
F_sg2:
    v_cmpx_lt_u32 vcc, 8, v58
    v_and_b32 v34, 0x7ff, v34
    v_lshl_add_u32 v34, v34, 5, v90
    v_add_u32 v34, 655360, v34
    v_or_b32 v35, 16, v34
    v_mad_u32_u16 v2, v66, 8, v78
    v_mad_u32_u16 v3, v66, 8, v78 op_sel:[1,0,0,0]
    ds_write_b64 v2, v[34:35]
    ds_write_b64 v3, v[32:33]
F_s2:
    s_mov_b64 exec, s[78:79]
    s_cbranch_execz F_s3
F_sp3:
    v_cmp_ne_u32 vcc, s88, v39
    s_cbranch_vccnz F_sa3
F_sg3:
    v_cmpx_lt_u32 vcc, 8, v59
    v_and_b32 v38, 0x7ff, v38
    v_lshl_add_u32 v38, v38, 5, v90
    v_add_u32 v38, 983040, v38
    v_or_b32 v39, 16, v38
    v_mad_u32_u16 v2, v67, 8, v79
    v_mad_u32_u16 v3, v67, 8, v79 op_sel:[1,0,0,0]
    ds_write_b64 v2, v[38:39]
    ds_write_b64 v3, v[36:37]
F_s3:
    s_mov_b64 exec, -1
    s_cmp_lg_u64 s[30:31], 0
    s_cbranch_scc1 F_u
F_ur:
    s_mov_b32 s22, s80
    s_mov_b32 s27, s80
    s_mov_b32 s71, s80
    s_bfe_u32 s46, s71, 0x30012
    s_mov_b32 m0, s46
    s_and_b32 s66, s71, 0x3ffff
    s_movrels_b32 s68, s57
    s_movrels_b32 s69, s61
    s_sub_u32 s48, s66, s47
    s_mov_b32 s47, s66
    s_lshr_b32 s52, s71, 28
    s_lshl_b32 s67, s46, 9
    s_add_u32 s66, s66, s67
    s_sub_u32 s49, s66, s42
    s_mov_b32 s42, s66
    s_bfe_u32 s66, s68, 655360
    s_add_u32 s43, s42, s66
    s_bfe_u32 s39, s69, 655360
    s_bfe_u32 s66, s68, 655370
    s_add_u32 s44, s42, s66
    s_bfe_u32 s40, s69, 655370
    s_bfe_u32 s66, s68, 655380
    s_add_u32 s45, s42, s66
    s_bfe_u32 s41, s69, 655380
    s_and_b32 s66, s46, s33
    s_cselect_b32 s72, -1, 1
    s_cselect_b32 s76, s47, 163712
    s_cmp_ge_u32 s66, 2
    s_cselect_b32 s73, -1, 0
    s_add_u32 s77, s47, 1024
    s_cmp_ge_u32 s66, 4
    s_cselect_b32 s75, -1, 0
    s_cmp_ge_u32 s66, 3
    s_cselect_b32 s74, -1, 1
    s_cselect_b32 s77, s77, 163712
    s_mul_i32 s66, s20, 80
    v_min_u32 v2, 76, v248
    s_waitcnt lgkmcnt(0)
    s_barrier
    v_add_u32 v253, s47, v248
    ds_read_b32 v254, v253
    ds_read_b32 v255, v253 offset:256
    v_add_u32 v252, s42, v247
    ds_read_u16 v234, v252
    ds_read_u16 v235, v252 offset:64
    v_add_u32 v252, s43, v247
    ds_read_u16 v236, v252
    ds_read_u16 v237, v252 offset:64
    v_add_u32 v252, s44, v247
    ds_read_u16 v238, v252
    ds_read_u16 v239, v252 offset:64
    v_add_u32 v252, s45, v247
    ds_read_u16 v240, v252
    ds_read_u16 v241, v252 offset:64
    buffer_load_dword v3, v2, s[16:19], s66 offen offset:128 sc1
    v_add_u32 v249, s48, v249
    v_add_u32 v250, s49, v250
    s_waitcnt lgkmcnt(8)
    s_mov_b32 m0, s76
    s_mov_b64 exec, s[72:73]
    buffer_load_dwordx4 v254, s[12:15], 0 offen  lds
    s_mov_b32 m0, s77
    s_mov_b64 exec, s[74:75]
    buffer_load_dwordx4 v255, s[12:15], 0 offen  lds
    s_mov_b64 exec, -1
    s_waitcnt lgkmcnt(0)
    s_add_u32 m0, s21, 0
    v_lshl_add_u32 v234, v234, 10, v246
    v_lshl_add_u32 v235, v235, 10, v246
    buffer_load_dwordx4 v234, s[4:7], s38 offen  lds
    buffer_load_dwordx4 v235, s[8:11], s38 offen offset:1024  lds
    s_add_u32 m0, s21, 2048
    v_lshl_add_u32 v236, v236, 10, v246
    v_lshl_add_u32 v237, v237, 10, v246
    buffer_load_dwordx4 v236, s[4:7], s39 offen  lds
    buffer_load_dwordx4 v237, s[8:11], s39 offen offset:1024  lds
    s_add_u32 m0, s21, 4096
    v_lshl_add_u32 v238, v238, 10, v246
    v_lshl_add_u32 v239, v239, 10, v246
    buffer_load_dwordx4 v238, s[4:7], s40 offen  lds
    buffer_load_dwordx4 v239, s[8:11], s40 offen offset:1024  lds
    s_add_u32 m0, s21, 6144
    v_lshl_add_u32 v240, v240, 10, v246
    v_lshl_add_u32 v241, v241, 10, v246
    buffer_load_dwordx4 v240, s[4:7], s41 offen  lds
    buffer_load_dwordx4 v241, s[8:11], s41 offen offset:1024  lds
    v_lshrrev_b32 v8, 3, v84
    v_and_b32 v9, 7, v84
    v_lshlrev_b32 v9, 13, v9
    v_mul_u32_u24 v8, 1536, v8
    v_lshlrev_b32 v10, 4, v84
    v_and_b32 v5, 128, v10
    v_add3_u32 v8, v8, v9, v5
    v_xor_b32 v9, v10, v7
    v_and_b32 v9, 128, v9
    v_add_u32 v9, v9, v7
    v_and_b32 v4, 0x70, v10
    v_or_b32 v5, v9, v4
    s_add_u32 s66, s20, 0
    v_cmp_eq_u32 vcc, s66, v84
    s_ff1_i32_b64 s67, vcc
    v_readlane_b32 s28, v5, s67
    s_add_u32 s66, s20, 8
    v_cmp_eq_u32 vcc, s66, v84
    s_ff1_i32_b64 s67, vcc
    v_readlane_b32 s29, v5, s67
    v_readlane_b32 s23, v6, s67
    s_add_u32 s66, s20, 16
    v_cmp_eq_u32 vcc, s66, v84
    s_ff1_i32_b64 s67, vcc
    v_readlane_b32 s30, v5, s67
    v_readlane_b32 s24, v6, s67
    s_add_u32 s66, s20, 24
    v_cmp_eq_u32 vcc, s66, v84
    s_ff1_i32_b64 s67, vcc
    v_readlane_b32 s31, v5, s67
    v_readlane_b32 s25, v6, s67
    s_add_u32 s66, s20, 32
    v_cmp_eq_u32 vcc, s66, v84
    s_ff1_i32_b64 s67, vcc
    v_readlane_b32 s32, v5, s67
    v_readlane_b32 s26, v6, s67
    v_lshlrev_b32 v4, 3, v84
    v_add_u32 v4, 163328, v4
    s_mov_b32 exec_hi, 0xff
    ds_write_b64 v4, v[8:9]
    s_mov_b32 exec_hi, -1
    s_waitcnt lgkmcnt(0)
    v_mov_b32 v252, 0
    s_waitcnt vmcnt(6)
    v_cmp_ne_u32 vcc, s88, v3
    ds_read_b64_tr_b16 v[176:177], v244 offset:0
    ds_read_b64_tr_b16 v[178:179], v244 offset:1024
    ds_read_b64_tr_b16 v[180:181], v245 offset:0
    ds_read_b64_tr_b16 v[182:183], v245 offset:1024
    ds_read_b64_tr_b16 v[64:65], v249 offset:0
    ds_read_b64_tr_b16 v[68:69], v249 offset:64
    ds_read_b64_tr_b16 v[66:67], v249 offset:256
    ds_read_b64_tr_b16 v[70:71], v249 offset:320
    s_mov_b64 exec, s[54:55]
    ds_read_u16_d16_hi v242, v250 offset:0
    s_mov_b64 exec, -1
    s_or_b32 s89, vcc_lo, vcc_hi
    s_add_u32 s53, s53, 4
    s_xor_b32 s66, s53, s20
    s_bitcmp1_b32 s66, 2
    s_setprio 1
    s_cbranch_scc1 PRIO_1
    s_setprio 0
PRIO_1:
    s_cmp_eq_u32 s52, 4
    s_cbranch_scc1 ITEM_0_4
    s_cmp_eq_u32 s52, 5
    s_cbranch_scc1 ITEM_0_5
    s_cmp_eq_u32 s52, 3
    s_cbranch_scc1 ITEM_0_3
    s_cmp_eq_u32 s52, 6
    s_cbranch_scc1 ITEM_0_6
    s_cmp_eq_u32 s52, 8
    s_cbranch_scc1 ITEM_0_8
    s_branch ITEM_0_2
F_again:
    s_sub_u32 s27, s27, 1
    s_cbranch_scc1 F_late
    s_cmp_eq_u64 s[72:73], 0
    s_cbranch_scc1 F_p0
    buffer_load_dwordx4 v[8:11], v86, s[16:19], s24 offen offset:0 sc1
F_p0:
    s_cmp_eq_u64 s[74:75], 0
    s_cbranch_scc1 F_p1
    buffer_load_dwordx4 v[12:15], v86, s[16:19], s24 offen offset:1024 sc1
F_p1:
    s_cmp_eq_u64 s[76:77], 0
    s_cbranch_scc1 F_p2
    buffer_load_dwordx4 v[16:19], v86, s[16:19], s24 offen offset:2048 sc1
F_p2:
    s_cmp_eq_u64 s[78:79], 0
    s_cbranch_scc1 F_p3
    s_mov_b64 exec, s[22:23]
    buffer_load_dwordx4 v[20:23], v86, s[16:19], s24 offen offset:3072 sc1
    s_mov_b64 exec, -1
F_p3:
    s_branch F_poll
F_late:
    v_mov_b32 v2, 163064
    v_mov_b32 v4, 1000
    ds_write_b32 v2, v4
    v_mov_b32 v10, 0
    v_mov_b32 v14, 0
    v_mov_b32 v18, 0
    v_mov_b32 v22, 0
    s_branch F_got
F_l3:
    v_bfe_u32 v2, v10, 23, 5
    v_sub_u32 v56, v2, v91
    v_cmp_lt_u32 vcc, 16, v2
    s_mov_b64 exec, vcc
    s_cbranch_execz F_t0
F_tp0:
    buffer_load_dwordx4 v[40:43], v86, s[16:19], s26 offen offset:0 sc1
    s_waitcnt vmcnt(0)
    v_cmp_ne_u32 vcc, s88, v43
    s_sub_u32 s27, s27, 1
    s_cselect_b64 vcc, 0, vcc
    s_cmp_eq_u64 vcc, 0
    s_cbranch_scc0 F_tp0
    v_bfe_u32 v68, v42, 11, 6
    v_lshl_add_u32 v68, v68, 2, s71
    v_cmp_lt_i32 vcc, 16, v56
    s_mov_b64 exec, vcc
    ds_add_rtn_u32 v80, v68, v3
F_t0:
    s_mov_b64 exec, -1
    v_bfe_u32 v2, v14, 23, 5
    v_sub_u32 v57, v2, v91
    v_cmp_lt_u32 vcc, 16, v2
    s_mov_b64 exec, vcc
    s_cbranch_execz F_t1
F_tp1:
    buffer_load_dwordx4 v[44:47], v86, s[16:19], s26 offen offset:1024 sc1
    s_waitcnt vmcnt(0)
    v_cmp_ne_u32 vcc, s88, v47
    s_sub_u32 s27, s27, 1
    s_cselect_b64 vcc, 0, vcc
    s_cmp_eq_u64 vcc, 0
    s_cbranch_scc0 F_tp1
    v_bfe_u32 v69, v46, 11, 6
    v_lshl_add_u32 v69, v69, 2, s71
    v_cmp_lt_i32 vcc, 16, v57
    s_mov_b64 exec, vcc
    ds_add_rtn_u32 v81, v69, v3
F_t1:
    s_mov_b64 exec, -1
    v_bfe_u32 v2, v18, 23, 5
    v_sub_u32 v58, v2, v91
    v_cmp_lt_u32 vcc, 16, v2
    s_mov_b64 exec, vcc
    s_cbranch_execz F_t2
F_tp2:
    buffer_load_dwordx4 v[48:51], v86, s[16:19], s26 offen offset:2048 sc1
    s_waitcnt vmcnt(0)
    v_cmp_ne_u32 vcc, s88, v51
    s_sub_u32 s27, s27, 1
    s_cselect_b64 vcc, 0, vcc
    s_cmp_eq_u64 vcc, 0
    s_cbranch_scc0 F_tp2
    v_bfe_u32 v70, v50, 11, 6
    v_lshl_add_u32 v70, v70, 2, s71
    v_cmp_lt_i32 vcc, 16, v58
    s_mov_b64 exec, vcc
    ds_add_rtn_u32 v82, v70, v3
F_t2:
    s_mov_b64 exec, -1
    v_bfe_u32 v2, v22, 23, 5
    v_sub_u32 v59, v2, v91
    v_cmp_lt_u32 vcc, 16, v2
    s_mov_b64 exec, vcc
    s_cbranch_execz F_t3
F_tp3:
    buffer_load_dwordx4 v[52:55], v86, s[16:19], s26 offen offset:3072 sc1
    s_waitcnt vmcnt(0)
    v_cmp_ne_u32 vcc, s88, v55
    s_sub_u32 s27, s27, 1
    s_cselect_b64 vcc, 0, vcc
    s_cmp_eq_u64 vcc, 0
    s_cbranch_scc0 F_tp3
    v_bfe_u32 v71, v54, 11, 6
    v_lshl_add_u32 v71, v71, 2, s71
    v_cmp_lt_i32 vcc, 16, v59
    s_mov_b64 exec, vcc
    ds_add_rtn_u32 v83, v71, v3
F_t3:
    s_mov_b64 exec, -1
    v_mov_b32 v2, 163068
    v_mov_b32 v4, 1000
    v_cmp_lt_u32 vcc, 24, v89
    s_mov_b64 exec, vcc
    ds_write_b32 v2, v4
    s_mov_b64 exec, -1
    s_branch F_l3r
F_flag:
    s_lshl_b32 s66, s2, 2
    v_mov_b32 v2, 128
    v_mov_b32 v4, s88
    s_mov_b64 exec, 1
    buffer_store_dword v4, v2, s[16:19], s66 offen sc1
    s_mov_b64 exec, -1
    s_branch F_flagr
F_sa0:
    s_sub_u32 s27, s27, 1
    s_cbranch_scc1 F_sg0
    buffer_load_dwordx4 v[24:27], v86, s[16:19], s25 offen offset:0 sc1
    s_waitcnt vmcnt(0)
    s_branch F_sp0
F_sa1:
    s_sub_u32 s27, s27, 1
    s_cbranch_scc1 F_sg1
    buffer_load_dwordx4 v[28:31], v86, s[16:19], s25 offen offset:1024 sc1
    s_waitcnt vmcnt(0)
    s_branch F_sp1
F_sa2:
    s_sub_u32 s27, s27, 1
    s_cbranch_scc1 F_sg2
    buffer_load_dwordx4 v[32:35], v86, s[16:19], s25 offen offset:2048 sc1
    s_waitcnt vmcnt(0)
    s_branch F_sp2
F_sa3:
    s_sub_u32 s27, s27, 1
    s_cbranch_scc1 F_sg3
    buffer_load_dwordx4 v[36:39], v86, s[16:19], s25 offen offset:3072 sc1
    s_waitcnt vmcnt(0)
    s_branch F_sp3
F_u:
    ds_bpermute_b32 v68, v68, v92
    ds_bpermute_b32 v69, v69, v92
    ds_bpermute_b32 v70, v70, v92
    ds_bpermute_b32 v71, v71, v92
    s_waitcnt lgkmcnt(0)
    v_cmp_lt_i32 vcc, 16, v56
    s_mov_b64 exec, vcc
    s_cbranch_execz F_u0
    v_lshlrev_b32 v80, 3, v80
    v_and_b32 v42, 0x7ff, v42
    v_lshl_add_u32 v42, v42, 5, v90
    v_or_b32 v43, 16, v42
    v_mad_u32_u16 v2, v68, 8, v80
    v_mad_u32_u16 v3, v68, 8, v80 op_sel:[1,0,0,0]
    ds_write_b64 v2, v[42:43]
    ds_write_b64 v3, v[40:41]
F_u0:
    s_mov_b64 exec, -1
    v_cmp_lt_i32 vcc, 16, v57
    s_mov_b64 exec, vcc
    s_cbranch_execz F_u1
    v_lshlrev_b32 v81, 3, v81
    v_and_b32 v46, 0x7ff, v46
    v_lshl_add_u32 v46, v46, 5, v90
    v_add_u32 v46, 327680, v46
    v_or_b32 v47, 16, v46
    v_mad_u32_u16 v2, v69, 8, v81
    v_mad_u32_u16 v3, v69, 8, v81 op_sel:[1,0,0,0]
    ds_write_b64 v2, v[46:47]
    ds_write_b64 v3, v[44:45]
F_u1:
    s_mov_b64 exec, -1
    v_cmp_lt_i32 vcc, 16, v58
    s_mov_b64 exec, vcc
    s_cbranch_execz F_u2
    v_lshlrev_b32 v82, 3, v82
    v_and_b32 v50, 0x7ff, v50
    v_lshl_add_u32 v50, v50, 5, v90
    v_add_u32 v50, 655360, v50
    v_or_b32 v51, 16, v50
    v_mad_u32_u16 v2, v70, 8, v82
    v_mad_u32_u16 v3, v70, 8, v82 op_sel:[1,0,0,0]
    ds_write_b64 v2, v[50:51]
    ds_write_b64 v3, v[48:49]
F_u2:
    s_mov_b64 exec, -1
    v_cmp_lt_i32 vcc, 16, v59
    s_mov_b64 exec, vcc
    s_cbranch_execz F_u3
    v_lshlrev_b32 v83, 3, v83
    v_and_b32 v54, 0x7ff, v54
    v_lshl_add_u32 v54, v54, 5, v90
    v_add_u32 v54, 983040, v54
    v_or_b32 v55, 16, v54
    v_mad_u32_u16 v2, v71, 8, v83
    v_mad_u32_u16 v3, v71, 8, v83 op_sel:[1,0,0,0]
    ds_write_b64 v2, v[54:55]
    ds_write_b64 v3, v[52:53]
F_u3:
    s_mov_b64 exec, -1
    s_branch F_ur
LAST0:
    s_cmp_eq_u32 s50, 5
    s_cbranch_scc1 TO_PHASE1
    s_add_u32 s4, s4, 128
    s_addc_u32 s5, s5, 0
    s_add_u32 s8, s8, 128
    s_addc_u32 s9, s9, 0
    s_mov_b32 s34, 0
    s_mov_b32 s35, 256
    s_mov_b32 s36, 512
    s_mov_b32 s37, 768
    s_mov_b32 s33, 0
    s_add_u32 s53, s53, 4
    s_xor_b32 s66, s53, s20
    s_bitcmp1_b32 s66, 2
    s_setprio 1
    s_cbranch_scc1 PRIO_2
    s_setprio 0
PRIO_2:
    s_cmp_eq_u32 s52, 4
    s_cbranch_scc1 ITEM_0_4
    s_cmp_eq_u32 s52, 5
    s_cbranch_scc1 ITEM_0_5
    s_cmp_eq_u32 s52, 3
    s_cbranch_scc1 ITEM_0_3
    s_cmp_eq_u32 s52, 6
    s_cbranch_scc1 ITEM_0_6
    s_cmp_eq_u32 s52, 8
    s_cbranch_scc1 ITEM_0_8
    s_branch ITEM_0_2
TO_PHASE1:
    ds_read_b32 v252, v251 offset:16
    v_lshlrev_b32 v253, 2, v248
    v_add_u32 v253, 65536, v253
    ds_read_b128 v[96:99], v253 offset:0
    ds_read_b128 v[100:103], v253 offset:1024
    ds_read_b128 v[104:107], v253 offset:2048
    ds_read_b128 v[108:111], v253 offset:3072
    ds_read_b128 v[112:115], v253 offset:4096
    ds_read_b128 v[116:119], v253 offset:5120
    ds_read_b128 v[120:123], v253 offset:6144
    ds_read_b128 v[124:127], v253 offset:7168
    ds_read_b128 v[128:131], v253 offset:8192
    ds_read_b128 v[132:135], v253 offset:9216
    ds_read_b128 v[136:139], v253 offset:10240
    ds_read_b128 v[140:143], v253 offset:11264
    ds_read_b128 v[144:147], v253 offset:12288
    ds_read_b128 v[148:151], v253 offset:13312
    ds_read_b128 v[152:155], v253 offset:14336
    ds_read_b128 v[156:159], v253 offset:15360
    ds_read_b128 v[160:163], v253 offset:16384
    ds_read_b128 v[164:167], v253 offset:17408
    ds_read_b128 v[168:171], v253 offset:18432
    ds_read_b128 v[172:175], v253 offset:19456
    s_mov_b32 s34, 128
    s_mov_b32 s35, 384
    s_mov_b32 s36, 640
    s_mov_b32 s37, 896
    s_mov_b32 s50, 0
    s_waitcnt lgkmcnt(0)
    s_waitcnt lgkmcnt(0)
    v_readfirstlane_b32 s66, v252
    s_add_u32 s53, s53, 1
    v_mov_b32 v252, s53
    s_cmp_le_u32 s53, s66
    ds_write2_b32 v251, v252, v252 offset0:0 offset1:8
    s_setprio 1
    s_cbranch_scc1 PRIO_3
    s_setprio 0
PRIO_3:
    s_cmp_eq_u32 s52, 4
    s_cbranch_scc1 ITEM_1_4
    s_cmp_eq_u32 s52, 5
    s_cbranch_scc1 ITEM_1_5
    s_cmp_eq_u32 s52, 3
    s_cbranch_scc1 ITEM_1_3
    s_cmp_eq_u32 s52, 6
    s_cbranch_scc1 ITEM_1_6
    s_cmp_eq_u32 s52, 8
    s_cbranch_scc1 ITEM_1_8
    s_branch ITEM_1_2
LAST1:
    s_cmp_eq_u32 s89, 0
    s_cbranch_scc1 T_flagsL
    s_mul_i32 s66, s20, 80
    v_min_u32 v2, 76, v248
    s_mov_b32 s67, 262144
T_pollL:
    buffer_load_dword v3, v2, s[16:19], s66 offen offset:128 sc1
    s_waitcnt vmcnt(0)
    v_cmp_ne_u32 vcc, s88, v3
    s_sub_u32 s67, s67, 1
    s_cselect_b64 vcc, 0, vcc
    s_cmp_eq_u64 vcc, 0
    s_cbranch_scc0 T_pollL
    s_mov_b32 s89, 0
T_flagsL:
    v_lshlrev_b32 v246, 2, v248
    s_mul_i32 s51, s20, 20480
    s_add_u32 s51, s51, 1024
    s_load_dwordx2 s[72:73], s[0:1], 72
    s_waitcnt lgkmcnt(7)
    v_readfirstlane_b32 s66, v252
    s_add_u32 s53, s53, 1
    v_mov_b32 v252, s53
    s_cmp_le_u32 s53, s66
    ds_write2_b32 v251, v252, v252 offset0:0 offset1:8
    s_setprio 3
    s_cbranch_scc1 PRIO_4
    s_setprio 2
PRIO_4:
    s_cmp_eq_u32 s52, 4
    s_cbranch_scc1 ITEM_1_4
    s_cmp_eq_u32 s52, 5
    s_cbranch_scc1 ITEM_1_5
    s_cmp_eq_u32 s52, 3
    s_cbranch_scc1 ITEM_1_3
    s_cmp_eq_u32 s52, 6
    s_cbranch_scc1 ITEM_1_6
    s_cmp_eq_u32 s52, 8
    s_cbranch_scc1 ITEM_1_8
    s_branch ITEM_1_2
.p2align 6
ITEM_0_4:
    s_mov_b64 exec, s[54:55]
    ds_read_u16_d16_hi v243, v250 offset:128
    s_mov_b64 exec, -1
    ds_read_b64_tr_b16 v[72:73], v249 offset:512
    ds_read_b64_tr_b16 v[76:77], v249 offset:576
    ds_read_b64_tr_b16 v[74:75], v249 offset:768
    ds_read_b64_tr_b16 v[78:79], v249 offset:832
    s_waitcnt lgkmcnt(5)
    v_mul_f32_dpp v196, v242, v64 row_newbcast:0 row_mask:0xf bank_mask:0xf
    v_mul_f32_dpp v197, v242, v65 row_newbcast:1 row_mask:0xf bank_mask:0xf
    v_mul_f32_dpp v198, v242, v64 row_newbcast:8 row_mask:0xf bank_mask:0xf
    v_mul_f32_dpp v199, v242, v65 row_newbcast:9 row_mask:0xf bank_mask:0xf
    v_mul_f32_dpp v200, v242, v68 row_newbcast:2 row_mask:0xf bank_mask:0xf
    v_mul_f32_dpp v201, v242, v69 row_newbcast:3 row_mask:0xf bank_mask:0xf
    v_mul_f32_dpp v202, v242, v68 row_newbcast:10 row_mask:0xf bank_mask:0xf
    v_mul_f32_dpp v203, v242, v69 row_newbcast:11 row_mask:0xf bank_mask:0xf
    v_cvt_pk_bf16_f32 v64, v196, v197
    v_cvt_pk_bf16_f32 v68, v198, v199
    v_cvt_pk_bf16_f32 v65, v200, v201
    v_cvt_pk_bf16_f32 v69, v202, v203
    v_mul_f32_dpp v196, v242, v66 row_newbcast:4 row_mask:0xf bank_mask:0xf
    v_mul_f32_dpp v197, v242, v67 row_newbcast:5 row_mask:0xf bank_mask:0xf
    v_mul_f32_dpp v198, v242, v66 row_newbcast:12 row_mask:0xf bank_mask:0xf
    v_mul_f32_dpp v199, v242, v67 row_newbcast:13 row_mask:0xf bank_mask:0xf
    v_mul_f32_dpp v200, v242, v70 row_newbcast:6 row_mask:0xf bank_mask:0xf
    v_mul_f32_dpp v201, v242, v71 row_newbcast:7 row_mask:0xf bank_mask:0xf
    v_mul_f32_dpp v202, v242, v70 row_newbcast:14 row_mask:0xf bank_mask:0xf
    v_mul_f32_dpp v203, v242, v71 row_newbcast:15 row_mask:0xf bank_mask:0xf
    v_cvt_pk_bf16_f32 v66, v196, v197
    v_cvt_pk_bf16_f32 v70, v198, v199
    v_cvt_pk_bf16_f32 v67, v200, v201
    v_cvt_pk_bf16_f32 v71, v202, v203
    s_nop 0
    s_waitcnt vmcnt(4) lgkmcnt(0)
    v_mfma_f32_32x32x16_bf16 v[0:15], v[64:67], v[176:179], 0
    v_mul_f32_dpp v196, v243, v72 row_newbcast:0 row_mask:0xf bank_mask:0xf
    v_mul_f32_dpp v197, v243, v73 row_newbcast:1 row_mask:0xf bank_mask:0xf
    v_mul_f32_dpp v198, v243, v72 row_newbcast:8 row_mask:0xf bank_mask:0xf
    v_mul_f32_dpp v199, v243, v73 row_newbcast:9 row_mask:0xf bank_mask:0xf
    v_mul_f32_dpp v200, v243, v76 row_newbcast:2 row_mask:0xf bank_mask:0xf
    v_mul_f32_dpp v201, v243, v77 row_newbcast:3 row_mask:0xf bank_mask:0xf
    v_mul_f32_dpp v202, v243, v76 row_newbcast:10 row_mask:0xf bank_mask:0xf
    v_mul_f32_dpp v203, v243, v77 row_newbcast:11 row_mask:0xf bank_mask:0xf
    v_cvt_pk_bf16_f32 v72, v196, v197
    v_cvt_pk_bf16_f32 v76, v198, v199
    v_cvt_pk_bf16_f32 v73, v200, v201
    v_cvt_pk_bf16_f32 v77, v202, v203
    s_add_u32 m0, s21, 0
    v_mfma_f32_32x32x16_bf16 v[16:31], v[68:71], v[176:179], 0
    buffer_load_dwordx4 v234, s[4:7], s36 offen  lds
    buffer_load_dwordx4 v235, s[8:11], s36 offen offset:1024  lds
    ds_read_b64_tr_b16 v[176:177], v244 offset:2048
    ds_read_b64_tr_b16 v[178:179], v244 offset:3072
    ds_read_b64_tr_b16 v[184:185], v245 offset:2048
    ds_read_b64_tr_b16 v[186:187], v245 offset:3072
    v_mul_f32_dpp v196, v243, v74 row_newbcast:4 row_mask:0xf bank_mask:0xf
    v_mul_f32_dpp v197, v243, v75 row_newbcast:5 row_mask:0xf bank_mask:0xf
    v_mul_f32_dpp v198, v243, v74 row_newbcast:12 row_mask:0xf bank_mask:0xf
    v_mul_f32_dpp v199, v243, v75 row_newbcast:13 row_mask:0xf bank_mask:0xf
    v_mul_f32_dpp v200, v243, v78 row_newbcast:6 row_mask:0xf bank_mask:0xf
    v_mul_f32_dpp v201, v243, v79 row_newbcast:7 row_mask:0xf bank_mask:0xf
    v_mul_f32_dpp v202, v243, v78 row_newbcast:14 row_mask:0xf bank_mask:0xf
    v_mul_f32_dpp v203, v243, v79 row_newbcast:15 row_mask:0xf bank_mask:0xf
    v_cvt_pk_bf16_f32 v74, v196, v197
    v_cvt_pk_bf16_f32 v78, v198, v199
    v_cvt_pk_bf16_f32 v75, v200, v201
    v_cvt_pk_bf16_f32 v79, v202, v203
    s_nop 0
    s_waitcnt lgkmcnt(0)
    v_mfma_f32_32x32x16_bf16 v[0:15], v[72:75], v[176:179], v[0:15]
    s_add_u32 m0, s21, 2048
    v_mfma_f32_32x32x16_bf16 v[16:31], v[76:79], v[176:179], v[16:31]
    buffer_load_dwordx4 v236, s[4:7], s36 offen  lds
    buffer_load_dwordx4 v237, s[8:11], s36 offen offset:1024  lds
    s_mov_b32 m0, s50
    s_nop 0
    s_movrels_b32 s71, s23
    s_bfe_u32 s46, s71, 0x30012
    s_mov_b32 m0, s46
    s_and_b32 s66, s71, 0x3ffff
    s_movrels_b32 s68, s57
    s_movrels_b32 s69, s61
    s_sub_u32 s48, s66, s47
    s_mov_b32 s47, s66
    s_lshr_b32 s52, s71, 28
    s_lshl_b32 s67, s46, 9
    s_add_u32 s66, s66, s67
    s_sub_u32 s49, s66, s42
    s_mov_b32 s42, s66
    s_bfe_u32 s66, s68, 655360
    s_add_u32 s43, s42, s66
    s_bfe_u32 s39, s69, 655360
    s_bfe_u32 s66, s68, 655370
    s_add_u32 s44, s42, s66
    s_bfe_u32 s40, s69, 655370
    s_bfe_u32 s66, s68, 655380
    s_add_u32 s45, s42, s66
    s_bfe_u32 s41, s69, 655380
    s_and_b32 s66, s46, s33
    s_cselect_b32 s72, -1, 1
    s_cselect_b32 s76, s47, 163712
    s_cmp_ge_u32 s66, 2
    s_cselect_b32 s73, -1, 0
    s_add_u32 s77, s47, 1024
    s_cmp_ge_u32 s66, 4
    s_cselect_b32 s75, -1, 0
    s_cmp_ge_u32 s66, 3
    s_cselect_b32 s74, -1, 1
    s_cselect_b32 s77, s77, 163712
    v_add_u32 v252, s44, v247
    ds_read_u16 v238, v252
    ds_read_u16 v239, v252 offset:64
    v_add_u32 v252, s45, v247
    ds_read_u16 v240, v252
    ds_read_u16 v241, v252 offset:64
    v_mfma_f32_32x32x16_bf16 v[32:47], v[64:67], v[180:183], 0
    v_mul_f32 v196, v0, v96
    v_fmac_f32 v196, v1, v97
    v_fmac_f32 v196, v2, v98
    v_fmac_f32 v196, v3, v99
    v_fmac_f32 v196, v4, v100
    v_fmac_f32 v196, v5, v101
    v_fmac_f32 v196, v6, v102
    v_fmac_f32 v196, v7, v103
    v_mul_f32 v198, v8, v128
    v_fmac_f32 v198, v9, v129
    v_mfma_f32_32x32x16_bf16 v[48:63], v[68:71], v[180:183], 0
    s_waitcnt vmcnt(6)
    ds_read_b64_tr_b16 v[176:177], v244 offset:4096
    ds_read_b64_tr_b16 v[178:179], v244 offset:5120
    ds_read_b64_tr_b16 v[180:181], v245 offset:4096
    ds_read_b64_tr_b16 v[182:183], v245 offset:5120
    v_fmac_f32 v198, v10, v130
    v_fmac_f32 v198, v11, v131
    v_fmac_f32 v198, v12, v132
    v_fmac_f32 v198, v13, v133
    v_fmac_f32 v198, v14, v134
    v_fmac_f32 v198, v15, v135
    v_mul_f32 v200, v16, v128
    v_fmac_f32 v200, v17, v129
    v_permlane32_swap_b32 v196, v198
    v_mfma_f32_32x32x16_bf16 v[32:47], v[72:75], v[184:187], v[32:47]
    v_fmac_f32 v200, v18, v130
    v_fmac_f32 v200, v19, v131
    v_fmac_f32 v200, v20, v132
    v_fmac_f32 v200, v21, v133
    v_fmac_f32 v200, v22, v134
    v_fmac_f32 v200, v23, v135
    v_add_f32 v198, v196, v198
    v_mul_f32_e64 v202, v24, -v128
    v_fma_f32 v202, v25, -v129, v202
    v_mfma_f32_32x32x16_bf16 v[48:63], v[76:79], v[184:187], v[48:63]
    v_fma_f32 v202, v26, -v130, v202
    v_fma_f32 v202, v27, -v131, v202
    v_fma_f32 v202, v28, -v132, v202
    v_fma_f32 v202, v29, -v133, v202
    v_fma_f32 v202, v30, -v134, v202
    v_fma_f32 v202, v31, -v135, v202
    s_nop 1
    v_permlane32_swap_b32 v200, v202
    v_add_f32 v202, v200, v202
    s_waitcnt vmcnt(4) lgkmcnt(0)
    v_mfma_f32_32x32x16_bf16 v[0:15], v[64:67], v[176:179], 0
    v_mul_f32 v197, v32, v104
    v_fmac_f32 v197, v33, v105
    v_fmac_f32 v197, v34, v106
    v_fmac_f32 v197, v35, v107
    v_fmac_f32 v197, v36, v108
    v_fmac_f32 v197, v37, v109
    v_fmac_f32 v197, v38, v110
    v_fmac_f32 v197, v39, v111
    v_mul_f32 v199, v40, v136
    v_fmac_f32 v199, v41, v137
    v_fmac_f32 v199, v42, v138
    s_add_u32 m0, s21, 4096
    v_mfma_f32_32x32x16_bf16 v[16:31], v[68:71], v[176:179], 0
    buffer_load_dwordx4 v234, s[4:7], s37 offen  lds
    buffer_load_dwordx4 v235, s[8:11], s37 offen offset:1024  lds
    ds_read_b64_tr_b16 v[176:177], v244 offset:6144
    ds_read_b64_tr_b16 v[178:179], v244 offset:7168
    ds_read_b64_tr_b16 v[184:185], v245 offset:6144
    ds_read_b64_tr_b16 v[186:187], v245 offset:7168
    v_add_u32 v252, s42, v247
    ds_read_u16 v234, v252
    ds_read_u16 v235, v252 offset:64
    v_fmac_f32 v199, v43, v139
    v_fmac_f32 v199, v44, v140
    v_fmac_f32 v199, v45, v141
    v_fmac_f32 v199, v46, v142
    v_fmac_f32 v199, v47, v143
    v_mul_f32 v201, v48, v136
    v_fmac_f32 v201, v49, v137
    v_permlane32_swap_b32 v197, v199
    v_fmac_f32 v201, v50, v138
    v_fmac_f32 v201, v51, v139
    s_waitcnt lgkmcnt(2)
    v_mfma_f32_32x32x16_bf16 v[0:15], v[72:75], v[176:179], v[0:15]
    v_fmac_f32 v201, v52, v140
    v_fmac_f32 v201, v53, v141
    v_fmac_f32 v201, v54, v142
    v_fmac_f32 v201, v55, v143
    v_add_f32 v199, v197, v199
    v_mul_f32_e64 v203, v56, -v136
    v_fma_f32 v203, v57, -v137, v203
    v_fma_f32 v203, v58, -v138, v203
    v_fma_f32 v203, v59, -v139, v203
    v_fma_f32 v203, v60, -v140, v203
    v_fma_f32 v203, v61, -v141, v203
    s_add_u32 m0, s21, 6144
    v_mfma_f32_32x32x16_bf16 v[16:31], v[76:79], v[176:179], v[16:31]
    buffer_load_dwordx4 v236, s[4:7], s37 offen  lds
    buffer_load_dwordx4 v237, s[8:11], s37 offen offset:1024  lds
    v_add_u32 v252, s43, v247
    ds_read_u16 v236, v252
    ds_read_u16 v237, v252 offset:64
    v_fma_f32 v203, v62, -v142, v203
    v_fma_f32 v203, v63, -v143, v203
    s_nop 1
    v_permlane32_swap_b32 v201, v203
    v_add_f32 v203, v201, v203
    s_set_gpr_idx_on s51, gpr_idx(DST)
    s_nop 0
    v_cvt_pk_bf16_f32 v204, v198, v199
    v_cvt_pk_bf16_f32 v205, v202, v203
    s_set_gpr_idx_off
    v_mfma_f32_32x32x16_bf16 v[32:47], v[64:67], v[180:183], 0
    v_mul_f32 v196, v0, v144
    v_fmac_f32 v196, v1, v145
    v_fmac_f32 v196, v2, v146
    v_fmac_f32 v196, v3, v147
    v_fmac_f32 v196, v4, v148
    v_fmac_f32 v196, v5, v149
    v_fmac_f32 v196, v6, v150
    v_fmac_f32 v196, v7, v151
    v_mfma_f32_32x32x16_bf16 v[48:63], v[68:71], v[180:183], 0
    v_add_u32 v253, s47, v248
    ds_read_b32 v254, v253
    ds_read_b32 v255, v253 offset:256
    s_waitcnt vmcnt(6)
    ds_read_b64_tr_b16 v[176:177], v244 offset:0
    ds_read_b64_tr_b16 v[178:179], v244 offset:1024
    ds_read_b64_tr_b16 v[180:181], v245 offset:0
    ds_read_b64_tr_b16 v[182:183], v245 offset:1024
    v_mul_f32 v198, v8, v112
    v_fmac_f32 v198, v9, v113
    v_fmac_f32 v198, v10, v114
    v_fmac_f32 v198, v11, v115
    v_fmac_f32 v198, v12, v116
    v_fmac_f32 v198, v13, v117
    v_fmac_f32 v198, v14, v118
    v_fmac_f32 v198, v15, v119
    v_mfma_f32_32x32x16_bf16 v[32:47], v[72:75], v[184:187], v[32:47]
    v_mul_f32_e64 v200, v16, -v160
    v_fma_f32 v200, v17, -v161, v200
    v_fma_f32 v200, v18, -v162, v200
    v_fma_f32 v200, v19, -v163, v200
    v_fma_f32 v200, v20, -v164, v200
    v_fma_f32 v200, v21, -v165, v200
    v_fma_f32 v200, v22, -v166, v200
    v_fma_f32 v200, v23, -v167, v200
    v_mfma_f32_32x32x16_bf16 v[48:63], v[76:79], v[184:187], v[48:63]
    v_mul_f32_e64 v202, v24, -v160
    v_fma_f32 v202, v25, -v161, v202
    v_fma_f32 v202, v26, -v162, v202
    v_fma_f32 v202, v27, -v163, v202
    v_fma_f32 v202, v28, -v164, v202
    v_fma_f32 v202, v29, -v165, v202
    v_fma_f32 v202, v30, -v166, v202
    v_fma_f32 v202, v31, -v167, v202
    s_waitcnt vmcnt(4) lgkmcnt(0)
    v_mfma_f32_32x32x16_bf16 v[0:15], v[64:67], v[176:179], 0
    v_mul_f32 v197, v32, v152
    v_fmac_f32 v197, v33, v153
    v_fmac_f32 v197, v34, v154
    v_fmac_f32 v197, v35, v155
    v_fmac_f32 v197, v36, v156
    v_fmac_f32 v197, v37, v157
    v_fmac_f32 v197, v38, v158
    v_fmac_f32 v197, v39, v159
    s_add_u32 m0, s21, 0
    v_mfma_f32_32x32x16_bf16 v[16:31], v[68:71], v[176:179], 0
    v_lshl_add_u32 v234, v234, 10, v246
    v_lshl_add_u32 v235, v235, 10, v246
    buffer_load_dwordx4 v234, s[4:7], s38 offen  lds
    buffer_load_dwordx4 v235, s[8:11], s38 offen offset:1024  lds
    ds_read_b64_tr_b16 v[176:177], v244 offset:2048
    ds_read_b64_tr_b16 v[178:179], v244 offset:3072
    ds_read_b64_tr_b16 v[184:185], v245 offset:2048
    ds_read_b64_tr_b16 v[186:187], v245 offset:3072
    v_mul_f32 v199, v40, v120
    v_fmac_f32 v199, v41, v121
    v_fmac_f32 v199, v42, v122
    v_fmac_f32 v199, v43, v123
    v_fmac_f32 v199, v44, v124
    v_fmac_f32 v199, v45, v125
    v_fmac_f32 v199, v46, v126
    v_fmac_f32 v199, v47, v127
    s_waitcnt lgkmcnt(0)
    v_mfma_f32_32x32x16_bf16 v[0:15], v[72:75], v[176:179], v[0:15]
    v_mul_f32_e64 v201, v48, -v168
    v_fma_f32 v201, v49, -v169, v201
    v_fma_f32 v201, v50, -v170, v201
    v_fma_f32 v201, v51, -v171, v201
    v_fma_f32 v201, v52, -v172, v201
    v_fma_f32 v201, v53, -v173, v201
    v_fma_f32 v201, v54, -v174, v201
    v_fma_f32 v201, v55, -v175, v201
    s_add_u32 m0, s21, 2048
    v_mfma_f32_32x32x16_bf16 v[16:31], v[76:79], v[176:179], v[16:31]
    v_lshl_add_u32 v236, v236, 10, v246
    v_lshl_add_u32 v237, v237, 10, v246
    buffer_load_dwordx4 v236, s[4:7], s39 offen  lds
    buffer_load_dwordx4 v237, s[8:11], s39 offen offset:1024  lds
    s_mov_b32 m0, s76
    s_mov_b64 exec, s[72:73]
    buffer_load_dwordx4 v254, s[12:15], 0 offen  lds
    s_mov_b32 m0, s77
    s_mov_b64 exec, s[74:75]
    buffer_load_dwordx4 v255, s[12:15], 0 offen  lds
    s_mov_b64 exec, -1
    v_mul_f32_e64 v203, v56, -v168
    v_fma_f32 v203, v57, -v169, v203
    v_fma_f32 v203, v58, -v170, v203
    v_fma_f32 v203, v59, -v171, v203
    v_fma_f32 v203, v60, -v172, v203
    v_fma_f32 v203, v61, -v173, v203
    v_fma_f32 v203, v62, -v174, v203
    v_fma_f32 v203, v63, -v175, v203
    v_mfma_f32_32x32x16_bf16 v[32:47], v[64:67], v[180:183], 0
    v_mul_f32 v254, v0, v144
    v_fmac_f32 v254, v1, v145
    v_fmac_f32 v254, v2, v146
    v_fmac_f32 v254, v3, v147
    v_fmac_f32 v254, v4, v148
    v_mfma_f32_32x32x16_bf16 v[48:63], v[68:71], v[180:183], 0
    ds_swizzle_b32 v68, v68 offset:0x401F
    ds_swizzle_b32 v69, v69 offset:0x401F
    ds_swizzle_b32 v70, v70 offset:0x401F
    ds_swizzle_b32 v71, v71 offset:0x401F
    s_waitcnt vmcnt(8)
    ds_read_b64_tr_b16 v[176:177], v244 offset:4096
    ds_read_b64_tr_b16 v[178:179], v244 offset:5120
    ds_read_b64_tr_b16 v[180:181], v245 offset:4096
    ds_read_b64_tr_b16 v[182:183], v245 offset:5120
    v_fmac_f32 v254, v5, v149
    v_fmac_f32 v254, v6, v150
    v_fmac_f32 v254, v7, v151
    v_fmac_f32 v200, v8, v160
    v_mfma_f32_32x32x16_bf16 v[32:47], v[72:75], v[184:187], v[32:47]
    v_fmac_f32 v200, v9, v161
    v_permlane32_swap_b32 v196, v254
    v_fmac_f32 v200, v10, v162
    v_fmac_f32 v200, v11, v163
    v_fmac_f32 v200, v12, v164
    v_mfma_f32_32x32x16_bf16 v[48:63], v[76:79], v[184:187], v[48:63]
    ds_swizzle_b32 v76, v76 offset:0x401F
    ds_swizzle_b32 v77, v77 offset:0x401F
    ds_swizzle_b32 v78, v78 offset:0x401F
    ds_swizzle_b32 v79, v79 offset:0x401F
    v_fmac_f32 v200, v13, v165
    v_fmac_f32 v200, v14, v166
    v_fmac_f32 v200, v15, v167
    v_add_f32 v254, v196, v254
    s_waitcnt lgkmcnt(8)
    s_mov_b64 exec, s[56:57]
    v_xor_b32 v68, 0x80008000, v68
    v_xor_b32 v69, 0x80008000, v69
    v_xor_b32 v70, 0x80008000, v70
    v_xor_b32 v71, 0x80008000, v71
    s_mov_b64 exec, -1
    s_waitcnt vmcnt(6) lgkmcnt(4)
    v_mfma_f32_32x32x16_bf16 v[0:15], v[64:67], v[176:179], 0
    v_mul_f32 v255, v32, v152
    v_fmac_f32 v255, v33, v153
    v_fmac_f32 v255, v34, v154
    v_fmac_f32 v255, v35, v155
    v_fmac_f32 v255, v36, v156
    v_fmac_f32 v255, v37, v157
    s_add_u32 m0, s21, 4096
    v_mfma_f32_32x32x16_bf16 v[16:31], v[68:71], v[176:179], v[16:31]
    v_lshl_add_u32 v238, v238, 10, v246
    v_lshl_add_u32 v239, v239, 10, v246
    buffer_load_dwordx4 v238, s[4:7], s40 offen  lds
    buffer_load_dwordx4 v239, s[8:11], s40 offen offset:1024  lds
    ds_read_b64_tr_b16 v[176:177], v244 offset:6144
    ds_read_b64_tr_b16 v[178:179], v244 offset:7168
    ds_read_b64_tr_b16 v[184:185], v245 offset:6144
    ds_read_b64_tr_b16 v[186:187], v245 offset:7168
    v_fmac_f32 v255, v38, v158
    v_fmac_f32 v255, v39, v159
    v_fmac_f32 v201, v40, v168
    v_fmac_f32 v201, v41, v169
    v_permlane32_swap_b32 v197, v255
    s_waitcnt lgkmcnt(0)
    s_mov_b64 exec, s[56:57]
    v_xor_b32 v76, 0x80008000, v76
    v_xor_b32 v77, 0x80008000, v77
    v_xor_b32 v78, 0x80008000, v78
    v_xor_b32 v79, 0x80008000, v79
    s_mov_b64 exec, -1
    v_mfma_f32_32x32x16_bf16 v[0:15], v[72:75], v[176:179], v[0:15]
    v_fmac_f32 v201, v42, v170
    v_fmac_f32 v201, v43, v171
    v_fmac_f32 v201, v44, v172
    v_fmac_f32 v201, v45, v173
    v_fmac_f32 v201, v46, v174
    v_fmac_f32 v201, v47, v175
    s_add_u32 m0, s21, 6144
    v_mfma_f32_32x32x16_bf16 v[16:31], v[76:79], v[176:179], v[16:31]
    v_lshl_add_u32 v240, v240, 10, v246
    v_lshl_add_u32 v241, v241, 10, v246
    buffer_load_dwordx4 v240, s[4:7], s41 offen  lds
    buffer_load_dwordx4 v241, s[8:11], s41 offen offset:1024  lds
    v_add_f32 v255, v197, v255
    s_set_gpr_idx_on s51, gpr_idx(DST)
    s_nop 0
    v_cvt_pk_bf16_f32 v206, v254, v255
    s_set_gpr_idx_off
    v_mfma_f32_32x32x16_bf16 v[32:47], v[64:67], v[180:183], 0
    v_mul_f32 v254, v0, v144
    v_fmac_f32 v254, v1, v145
    v_fmac_f32 v254, v2, v146
    v_fmac_f32 v254, v3, v147
    v_fmac_f32 v254, v4, v148
    v_fmac_f32 v254, v5, v149
    v_fmac_f32 v254, v6, v150
    v_fmac_f32 v254, v7, v151
    v_fma_f32 v202, v8, -v160, v202
    v_fma_f32 v202, v9, -v161, v202
    v_mfma_f32_32x32x16_bf16 v[48:63], v[68:71], v[180:183], v[48:63]
    s_waitcnt vmcnt(8)
    ds_read_b64_tr_b16 v[176:177], v244 offset:0
    ds_read_b64_tr_b16 v[178:179], v244 offset:1024
    ds_read_b64_tr_b16 v[180:181], v245 offset:0
    ds_read_b64_tr_b16 v[182:183], v245 offset:1024
    v_permlane32_swap_b32 v254, v200
    v_fma_f32 v202, v10, -v162, v202
    v_fma_f32 v202, v11, -v163, v202
    v_fma_f32 v202, v12, -v164, v202
    v_fma_f32 v202, v13, -v165, v202
    v_fma_f32 v202, v14, -v166, v202
    v_fma_f32 v202, v15, -v167, v202
    v_add_f32 v200, v254, v200
    v_fmac_f32 v198, v16, v112
    v_permlane32_swap_b32 v202, v254
    v_mfma_f32_32x32x16_bf16 v[32:47], v[72:75], v[184:187], v[32:47]
    v_fmac_f32 v198, v17, v113
    v_fmac_f32 v198, v18, v114
    v_fmac_f32 v198, v19, v115
    v_fmac_f32 v198, v20, v116
    v_fmac_f32 v198, v21, v117
    v_fmac_f32 v198, v22, v118
    v_fmac_f32 v198, v23, v119
    v_add_f32 v254, v202, v254
    v_mul_f32 v196, v24, v160
    v_fmac_f32 v196, v25, v161
    v_mfma_f32_32x32x16_bf16 v[48:63], v[76:79], v[184:187], v[48:63]
    v_add_u32 v249, s48, v249
    v_add_u32 v250, s49, v250
    s_waitcnt vmcnt(4)
    ds_read_b64_tr_b16 v[64:65], v249 offset:0
    ds_read_b64_tr_b16 v[68:69], v249 offset:64
    ds_read_b64_tr_b16 v[66:67], v249 offset:256
    ds_read_b64_tr_b16 v[70:71], v249 offset:320
    s_mov_b64 exec, s[54:55]
    ds_read_u16_d16_hi v242, v250 offset:0
    s_mov_b64 exec, -1
    v_fmac_f32 v196, v26, v162
    v_fmac_f32 v196, v27, v163
    v_fmac_f32 v196, v28, v164
    v_fmac_f32 v196, v29, v165
    v_fmac_f32 v196, v30, v166
    v_fmac_f32 v196, v31, v167
    s_nop 1
    v_permlane32_swap_b32 v198, v196
    v_add_f32 v196, v198, v196
    v_mul_f32 v255, v32, v152
    v_fmac_f32 v255, v33, v153
    v_fmac_f32 v255, v34, v154
    v_fmac_f32 v255, v35, v155
    v_fmac_f32 v255, v36, v156
    v_fmac_f32 v255, v37, v157
    v_fmac_f32 v255, v38, v158
    v_fmac_f32 v255, v39, v159
    v_fma_f32 v203, v40, -v168, v203
    v_fma_f32 v203, v41, -v169, v203
    v_permlane32_swap_b32 v255, v201
    v_fma_f32 v203, v42, -v170, v203
    v_fma_f32 v203, v43, -v171, v203
    v_fma_f32 v203, v44, -v172, v203
    v_fma_f32 v203, v45, -v173, v203
    v_fma_f32 v203, v46, -v174, v203
    v_fma_f32 v203, v47, -v175, v203
    v_add_f32 v201, v255, v201
    v_fmac_f32 v199, v48, v120
    v_permlane32_swap_b32 v203, v255
    v_fmac_f32 v199, v49, v121
    v_fmac_f32 v199, v50, v122
    v_fmac_f32 v199, v51, v123
    v_fmac_f32 v199, v52, v124
    v_fmac_f32 v199, v53, v125
    v_fmac_f32 v199, v54, v126
    v_fmac_f32 v199, v55, v127
    v_add_f32 v255, v203, v255
    v_mul_f32 v197, v56, v168
    v_fmac_f32 v197, v57, v169
    v_fmac_f32 v197, v58, v170
    v_fmac_f32 v197, v59, v171
    v_fmac_f32 v197, v60, v172
    v_fmac_f32 v197, v61, v173
    v_fmac_f32 v197, v62, v174
    v_fmac_f32 v197, v63, v175
    s_nop 1
    v_permlane32_swap_b32 v199, v197
    v_add_f32 v197, v199, v197
    s_set_gpr_idx_on s51, gpr_idx(DST)
    s_nop 0
    v_cvt_pk_bf16_f32 v207, v200, v201
    v_cvt_pk_bf16_f32 v209, v254, v255
    v_cvt_pk_bf16_f32 v208, v196, v197
    s_set_gpr_idx_off
    s_add_u32 s50, s50, 1
    s_add_u32 s51, s51, 6
    s_cmp_ge_u32 s50, 4
    s_cbranch_scc1 LAST0
    s_add_u32 s53, s53, 4
    s_xor_b32 s66, s53, s20
    s_bitcmp1_b32 s66, 2
    s_setprio 1
    s_cbranch_scc1 PRIO_5
    s_setprio 0
PRIO_5:
    s_cmp_eq_u32 s52, 4
    s_cbranch_scc1 ITEM_0_4
    s_cmp_eq_u32 s52, 5
    s_cbranch_scc1 ITEM_0_5
    s_cmp_eq_u32 s52, 3
    s_cbranch_scc1 ITEM_0_3
    s_cmp_eq_u32 s52, 6
    s_cbranch_scc1 ITEM_0_6
    s_cmp_eq_u32 s52, 8
    s_cbranch_scc1 ITEM_0_8
    s_branch ITEM_0_2
.p2align 6
ITEM_0_5:
    s_mov_b64 exec, s[54:55]
    ds_read_u16_d16_hi v243, v250 offset:128
    s_mov_b64 exec, -1
    ds_read_b64_tr_b16 v[72:73], v249 offset:512
    ds_read_b64_tr_b16 v[76:77], v249 offset:576
    ds_read_b64_tr_b16 v[74:75], v249 offset:768
    ds_read_b64_tr_b16 v[78:79], v249 offset:832
    ds_read_b64_tr_b16 v[80:81], v249 offset:1024
    ds_read_b64_tr_b16 v[84:85], v249 offset:1088
    s_waitcnt lgkmcnt(7)
    v_mul_f32_dpp v196, v242, v64 row_newbcast:0 row_mask:0xf bank_mask:0xf
    v_mul_f32_dpp v197, v242, v65 row_newbcast:1 row_mask:0xf bank_mask:0xf
    v_mul_f32_dpp v198, v242, v64 row_newbcast:8 row_mask:0xf bank_mask:0xf
    v_mul_f32_dpp v199, v242, v65 row_newbcast:9 row_mask:0xf bank_mask:0xf
    v_mul_f32_dpp v200, v242, v68 row_newbcast:2 row_mask:0xf bank_mask:0xf
    v_mul_f32_dpp v201, v242, v69 row_newbcast:3 row_mask:0xf bank_mask:0xf
    v_mul_f32_dpp v202, v242, v68 row_newbcast:10 row_mask:0xf bank_mask:0xf
    v_mul_f32_dpp v203, v242, v69 row_newbcast:11 row_mask:0xf bank_mask:0xf
    v_cvt_pk_bf16_f32 v64, v196, v197
    v_cvt_pk_bf16_f32 v68, v198, v199
    v_cvt_pk_bf16_f32 v65, v200, v201
    v_cvt_pk_bf16_f32 v69, v202, v203
    v_mul_f32_dpp v196, v242, v66 row_newbcast:4 row_mask:0xf bank_mask:0xf
    v_mul_f32_dpp v197, v242, v67 row_newbcast:5 row_mask:0xf bank_mask:0xf
    v_mul_f32_dpp v198, v242, v66 row_newbcast:12 row_mask:0xf bank_mask:0xf
    v_mul_f32_dpp v199, v242, v67 row_newbcast:13 row_mask:0xf bank_mask:0xf
    v_mul_f32_dpp v200, v242, v70 row_newbcast:6 row_mask:0xf bank_mask:0xf
    v_mul_f32_dpp v201, v242, v71 row_newbcast:7 row_mask:0xf bank_mask:0xf
    v_mul_f32_dpp v202, v242, v70 row_newbcast:14 row_mask:0xf bank_mask:0xf
    v_mul_f32_dpp v203, v242, v71 row_newbcast:15 row_mask:0xf bank_mask:0xf
    v_cvt_pk_bf16_f32 v66, v196, v197
    v_cvt_pk_bf16_f32 v70, v198, v199
    v_cvt_pk_bf16_f32 v67, v200, v201
    v_cvt_pk_bf16_f32 v71, v202, v203
    s_mov_b64 exec, s[54:55]
    ds_read_u16_d16_hi v242, v250 offset:256
    s_mov_b64 exec, -1
    s_waitcnt vmcnt(4) lgkmcnt(3)
    v_mfma_f32_32x32x16_bf16 v[0:15], v[64:67], v[176:179], 0
    v_mul_f32_dpp v196, v243, v72 row_newbcast:0 row_mask:0xf bank_mask:0xf
    v_mul_f32_dpp v197, v243, v73 row_newbcast:1 row_mask:0xf bank_mask:0xf
    v_mul_f32_dpp v198, v243, v72 row_newbcast:8 row_mask:0xf bank_mask:0xf
    v_mul_f32_dpp v199, v243, v73 row_newbcast:9 row_mask:0xf bank_mask:0xf
    v_mul_f32_dpp v200, v243, v76 row_newbcast:2 row_mask:0xf bank_mask:0xf
    v_mul_f32_dpp v201, v243, v77 row_newbcast:3 row_mask:0xf bank_mask:0xf
    v_mul_f32_dpp v202, v243, v76 row_newbcast:10 row_mask:0xf bank_mask:0xf
    v_mul_f32_dpp v203, v243, v77 row_newbcast:11 row_mask:0xf bank_mask:0xf
    v_cvt_pk_bf16_f32 v72, v196, v197
    v_cvt_pk_bf16_f32 v76, v198, v199
    v_cvt_pk_bf16_f32 v73, v200, v201
    v_cvt_pk_bf16_f32 v77, v202, v203
    s_add_u32 m0, s21, 0
    v_mfma_f32_32x32x16_bf16 v[16:31], v[68:71], v[176:179], 0
    buffer_load_dwordx4 v236, s[4:7], s35 offen  lds
    buffer_load_dwordx4 v237, s[8:11], s35 offen offset:1024  lds
    ds_read_b64_tr_b16 v[176:177], v244 offset:2048
    ds_read_b64_tr_b16 v[178:179], v244 offset:3072
    ds_read_b64_tr_b16 v[184:185], v245 offset:2048
    ds_read_b64_tr_b16 v[186:187], v245 offset:3072
    v_mul_f32_dpp v196, v243, v74 row_newbcast:4 row_mask:0xf bank_mask:0xf
    v_mul_f32_dpp v197, v243, v75 row_newbcast:5 row_mask:0xf bank_mask:0xf
    v_mul_f32_dpp v198, v243, v74 row_newbcast:12 row_mask:0xf bank_mask:0xf
    v_mul_f32_dpp v199, v243, v75 row_newbcast:13 row_mask:0xf bank_mask:0xf
    v_mul_f32_dpp v200, v243, v78 row_newbcast:6 row_mask:0xf bank_mask:0xf
    v_mul_f32_dpp v201, v243, v79 row_newbcast:7 row_mask:0xf bank_mask:0xf
    v_mul_f32_dpp v202, v243, v78 row_newbcast:14 row_mask:0xf bank_mask:0xf
    v_mul_f32_dpp v203, v243, v79 row_newbcast:15 row_mask:0xf bank_mask:0xf
    v_cvt_pk_bf16_f32 v74, v196, v197
    v_cvt_pk_bf16_f32 v78, v198, v199
    v_cvt_pk_bf16_f32 v75, v200, v201
    v_cvt_pk_bf16_f32 v79, v202, v203
    s_nop 0
    s_waitcnt vmcnt(4) lgkmcnt(0)
    v_mfma_f32_32x32x16_bf16 v[0:15], v[72:75], v[176:179], v[0:15]
    v_mul_f32_dpp v196, v242, v80 row_newbcast:0 row_mask:0xf bank_mask:0xf
    v_mul_f32_dpp v197, v242, v81 row_newbcast:1 row_mask:0xf bank_mask:0xf
    v_mul_f32_dpp v198, v242, v80 row_newbcast:8 row_mask:0xf bank_mask:0xf
    v_mul_f32_dpp v199, v242, v81 row_newbcast:9 row_mask:0xf bank_mask:0xf
    v_mul_f32_dpp v200, v242, v84 row_newbcast:2 row_mask:0xf bank_mask:0xf
    v_mul_f32_dpp v201, v242, v85 row_newbcast:3 row_mask:0xf bank_mask:0xf
    s_add_u32 m0, s21, 2048
    v_mfma_f32_32x32x16_bf16 v[16:31], v[76:79], v[176:179], v[16:31]
    buffer_load_dwordx4 v238, s[4:7], s35 offen  lds
    ds_read_b64_tr_b16 v[176:177], v244 offset:4096
    ds_read_b64_tr_b16 v[188:189], v245 offset:4096
    v_mul_f32_dpp v202, v242, v84 row_newbcast:10 row_mask:0xf bank_mask:0xf
    v_mul_f32_dpp v203, v242, v85 row_newbcast:11 row_mask:0xf bank_mask:0xf
    v_cvt_pk_bf16_f32 v80, v196, v197
    v_cvt_pk_bf16_f32 v84, v198, v199
    v_cvt_pk_bf16_f32 v81, v200, v201
    v_cvt_pk_bf16_f32 v85, v202, v203
    s_nop 0
    s_waitcnt lgkmcnt(0)
    v_mfma_f32_32x32x8_bf16 v[0:15], v[80:81], v[176:177], v[0:15]
    s_add_u32 m0, s21, 4096
    v_mfma_f32_32x32x8_bf16 v[16:31], v[84:85], v[176:177], v[16:31]
    buffer_load_dwordx4 v234, s[4:7], s36 offen  lds
    buffer_load_dwordx4 v235, s[8:11], s36 offen offset:1024  lds
    s_mov_b32 m0, s50
    s_nop 0
    s_movrels_b32 s71, s23
    s_bfe_u32 s46, s71, 0x30012
    s_mov_b32 m0, s46
    s_and_b32 s66, s71, 0x3ffff
    s_movrels_b32 s68, s57
    s_movrels_b32 s69, s61
    s_sub_u32 s48, s66, s47
    s_mov_b32 s47, s66
    s_lshr_b32 s52, s71, 28
    s_lshl_b32 s67, s46, 9
    s_add_u32 s66, s66, s67
    s_sub_u32 s49, s66, s42
    s_mov_b32 s42, s66
    s_bfe_u32 s66, s68, 655360
    s_add_u32 s43, s42, s66
    s_bfe_u32 s39, s69, 655360
    s_bfe_u32 s66, s68, 655370
    s_add_u32 s44, s42, s66
    s_bfe_u32 s40, s69, 655370
    s_bfe_u32 s66, s68, 655380
    s_add_u32 s45, s42, s66
    s_bfe_u32 s41, s69, 655380
    s_and_b32 s66, s46, s33
    s_cselect_b32 s72, -1, 1
    s_cselect_b32 s76, s47, 163712
    s_cmp_ge_u32 s66, 2
    s_cselect_b32 s73, -1, 0
    s_add_u32 s77, s47, 1024
    s_cmp_ge_u32 s66, 4
    s_cselect_b32 s75, -1, 0
    s_cmp_ge_u32 s66, 3
    s_cselect_b32 s74, -1, 1
    s_cselect_b32 s77, s77, 163712
    v_add_u32 v252, s45, v247
    ds_read_u16 v240, v252
    ds_read_u16 v241, v252 offset:64
    v_mfma_f32_32x32x16_bf16 v[32:47], v[64:67], v[180:183], 0
    v_mul_f32 v196, v0, v96
    v_fmac_f32 v196, v1, v97
    v_fmac_f32 v196, v2, v98
    v_fmac_f32 v196, v3, v99
    v_fmac_f32 v196, v4, v100
    v_fmac_f32 v196, v5, v101
    v_fmac_f32 v196, v6, v102
    v_mfma_f32_32x32x16_bf16 v[48:63], v[68:71], v[180:183], 0
    v_fmac_f32 v196, v7, v103
    v_mul_f32 v198, v8, v128
    v_fmac_f32 v198, v9, v129
    v_fmac_f32 v198, v10, v130
    v_fmac_f32 v198, v11, v131
    v_fmac_f32 v198, v12, v132
    v_mfma_f32_32x32x16_bf16 v[32:47], v[72:75], v[184:187], v[32:47]
    v_fmac_f32 v198, v13, v133
    v_fmac_f32 v198, v14, v134
    v_fmac_f32 v198, v15, v135
    v_mul_f32 v200, v16, v128
    v_fmac_f32 v200, v17, v129
    v_permlane32_swap_b32 v196, v198
    v_mfma_f32_32x32x16_bf16 v[48:63], v[76:79], v[184:187], v[48:63]
    s_waitcnt vmcnt(5)
    ds_read_b64_tr_b16 v[176:177], v244 offset:6144
    ds_read_b64_tr_b16 v[178:179], v244 offset:7168
    ds_read_b64_tr_b16 v[180:181], v245 offset:6144
    ds_read_b64_tr_b16 v[182:183], v245 offset:7168
    v_fmac_f32 v200, v18, v130
    v_fmac_f32 v200, v19, v131
    v_fmac_f32 v200, v20, v132
    v_fmac_f32 v200, v21, v133
    v_fmac_f32 v200, v22, v134
    v_fmac_f32 v200, v23, v135
    v_mfma_f32_32x32x8_bf16 v[32:47], v[80:81], v[188:189], v[32:47]
    v_add_f32 v198, v196, v198
    v_mul_f32_e64 v202, v24, -v128
    v_fma_f32 v202, v25, -v129, v202
    v_fma_f32 v202, v26, -v130, v202
    v_fma_f32 v202, v27, -v131, v202
    v_fma_f32 v202, v28, -v132, v202
    v_mfma_f32_32x32x8_bf16 v[48:63], v[84:85], v[188:189], v[48:63]
    v_fma_f32 v202, v29, -v133, v202
    v_fma_f32 v202, v30, -v134, v202
    v_fma_f32 v202, v31, -v135, v202
    s_nop 1
    v_permlane32_swap_b32 v200, v202
    v_add_f32 v202, v200, v202
    s_waitcnt vmcnt(3) lgkmcnt(0)
    v_mfma_f32_32x32x16_bf16 v[0:15], v[64:67], v[176:179], 0
    v_mul_f32 v197, v32, v104
    v_fmac_f32 v197, v33, v105
    v_fmac_f32 v197, v34, v106
    v_fmac_f32 v197, v35, v107
    v_fmac_f32 v197, v36, v108
    v_fmac_f32 v197, v37, v109
    v_fmac_f32 v197, v38, v110
    s_add_u32 m0, s21, 6144
    v_mfma_f32_32x32x16_bf16 v[16:31], v[68:71], v[176:179], 0
    buffer_load_dwordx4 v236, s[4:7], s36 offen  lds
    buffer_load_dwordx4 v237, s[8:11], s36 offen offset:1024  lds
    ds_read_b64_tr_b16 v[176:177], v244 offset:0
    ds_read_b64_tr_b16 v[178:179], v244 offset:1024
    ds_read_b64_tr_b16 v[184:185], v245 offset:0
    ds_read_b64_tr_b16 v[186:187], v245 offset:1024
    v_fmac_f32 v197, v39, v111
    v_mul_f32 v199, v40, v136
    v_fmac_f32 v199, v41, v137
    v_fmac_f32 v199, v42, v138
    v_fmac_f32 v199, v43, v139
    v_fmac_f32 v199, v44, v140
    v_fmac_f32 v199, v45, v141
    s_waitcnt vmcnt(4) lgkmcnt(0)
    v_mfma_f32_32x32x16_bf16 v[0:15], v[72:75], v[176:179], v[0:15]
    v_fmac_f32 v199, v46, v142
    v_fmac_f32 v199, v47, v143
    v_mul_f32 v201, v48, v136
    v_fmac_f32 v201, v49, v137
    v_permlane32_swap_b32 v197, v199
    v_fmac_f32 v201, v50, v138
    v_fmac_f32 v201, v51, v139
    s_add_u32 m0, s21, 0
    v_mfma_f32_32x32x16_bf16 v[16:31], v[76:79], v[176:179], v[16:31]
    buffer_load_dwordx4 v238, s[4:7], s36 offen  lds
    ds_read_b64_tr_b16 v[176:177], v244 offset:2048
    ds_read_b64_tr_b16 v[188:189], v245 offset:2048
    v_fmac_f32 v201, v52, v140
    v_fmac_f32 v201, v53, v141
    v_fmac_f32 v201, v54, v142
    v_fmac_f32 v201, v55, v143
    v_add_f32 v199, v197, v199
    v_mul_f32_e64 v203, v56, -v136
    v_fma_f32 v203, v57, -v137, v203
    s_waitcnt lgkmcnt(0)
    v_mfma_f32_32x32x8_bf16 v[0:15], v[80:81], v[176:177], v[0:15]
    v_fma_f32 v203, v58, -v138, v203
    v_fma_f32 v203, v59, -v139, v203
    v_fma_f32 v203, v60, -v140, v203
    v_fma_f32 v203, v61, -v141, v203
    v_fma_f32 v203, v62, -v142, v203
    v_fma_f32 v203, v63, -v143, v203
    s_nop 1
    s_add_u32 m0, s21, 2048
    v_mfma_f32_32x32x8_bf16 v[16:31], v[84:85], v[176:177], v[16:31]
    buffer_load_dwordx4 v234, s[4:7], s37 offen  lds
    buffer_load_dwordx4 v235, s[8:11], s37 offen offset:1024  lds
    v_add_u32 v252, s42, v247
    ds_read_u16 v234, v252
    ds_read_u16 v235, v252 offset:64
    v_permlane32_swap_b32 v201, v203
    v_add_f32 v203, v201, v203
    s_set_gpr_idx_on s51, gpr_idx(DST)
    s_nop 0
    v_cvt_pk_bf16_f32 v204, v198, v199
    v_cvt_pk_bf16_f32 v205, v202, v203
    s_set_gpr_idx_off
    v_mfma_f32_32x32x16_bf16 v[32:47], v[64:67], v[180:183], 0
    v_mul_f32 v196, v0, v144
    v_fmac_f32 v196, v1, v145
    v_fmac_f32 v196, v2, v146
    v_fmac_f32 v196, v3, v147
    v_fmac_f32 v196, v4, v148
    v_fmac_f32 v196, v5, v149
    v_mfma_f32_32x32x16_bf16 v[48:63], v[68:71], v[180:183], 0
    v_add_u32 v253, s47, v248
    ds_read_b32 v254, v253
    ds_read_b32 v255, v253 offset:256
    v_fmac_f32 v196, v6, v150
    v_fmac_f32 v196, v7, v151
    v_mul_f32 v198, v8, v112
    v_fmac_f32 v198, v9, v113
    v_fmac_f32 v198, v10, v114
    v_mfma_f32_32x32x16_bf16 v[32:47], v[72:75], v[184:187], v[32:47]
    v_fmac_f32 v198, v11, v115
    v_fmac_f32 v198, v12, v116
    v_fmac_f32 v198, v13, v117
    v_fmac_f32 v198, v14, v118
    v_fmac_f32 v198, v15, v119
    v_mfma_f32_32x32x16_bf16 v[48:63], v[76:79], v[184:187], v[48:63]
    s_waitcnt vmcnt(5)
    ds_read_b64_tr_b16 v[176:177], v244 offset:4096
    ds_read_b64_tr_b16 v[178:179], v244 offset:5120
    ds_read_b64_tr_b16 v[180:181], v245 offset:4096
    ds_read_b64_tr_b16 v[182:183], v245 offset:5120
    v_mul_f32_e64 v200, v16, -v160
    v_fma_f32 v200, v17, -v161, v200
    v_fma_f32 v200, v18, -v162, v200
    v_fma_f32 v200, v19, -v163, v200
    v_fma_f32 v200, v20, -v164, v200
    v_fma_f32 v200, v21, -v165, v200
    v_mfma_f32_32x32x8_bf16 v[32:47], v[80:81], v[188:189], v[32:47]
    v_fma_f32 v200, v22, -v166, v200
    v_fma_f32 v200, v23, -v167, v200
    v_mul_f32_e64 v202, v24, -v160
    v_fma_f32 v202, v25, -v161, v202
    v_fma_f32 v202, v26, -v162, v202
    v_mfma_f32_32x32x8_bf16 v[48:63], v[84:85], v[188:189], v[48:63]
    v_fma_f32 v202, v27, -v163, v202
    v_fma_f32 v202, v28, -v164, v202
    v_fma_f32 v202, v29, -v165, v202
    v_fma_f32 v202, v30, -v166, v202
    v_fma_f32 v202, v31, -v167, v202
    s_waitcnt vmcnt(3) lgkmcnt(0)
    v_mfma_f32_32x32x16_bf16 v[0:15], v[64:67], v[176:179], 0
    v_mul_f32 v197, v32, v152
    v_fmac_f32 v197, v33, v153
    v_fmac_f32 v197, v34, v154
    v_fmac_f32 v197, v35, v155
    v_fmac_f32 v197, v36, v156
    v_fmac_f32 v197, v37, v157
    s_add_u32 m0, s21, 4096
    v_mfma_f32_32x32x16_bf16 v[16:31], v[68:71], v[176:179], 0
    buffer_load_dwordx4 v236, s[4:7], s37 offen  lds
    buffer_load_dwordx4 v237, s[8:11], s37 offen offset:1024  lds
    ds_read_b64_tr_b16 v[176:177], v244 offset:6144
    ds_read_b64_tr_b16 v[178:179], v244 offset:7168
    ds_read_b64_tr_b16 v[184:185], v245 offset:6144
    ds_read_b64_tr_b16 v[186:187], v245 offset:7168
    v_add_u32 v252, s43, v247
    ds_read_u16 v236, v252
    ds_read_u16 v237, v252 offset:64
    v_fmac_f32 v197, v38, v158
    v_fmac_f32 v197, v39, v159
    v_mul_f32 v199, v40, v120
    v_fmac_f32 v199, v41, v121
    v_fmac_f32 v199, v42, v122
    s_waitcnt vmcnt(4) lgkmcnt(2)
    v_mfma_f32_32x32x16_bf16 v[0:15], v[72:75], v[176:179], v[0:15]
    v_fmac_f32 v199, v43, v123
    v_fmac_f32 v199, v44, v124
    v_fmac_f32 v199, v45, v125
    v_fmac_f32 v199, v46, v126
    v_fmac_f32 v199, v47, v127
    s_add_u32 m0, s21, 6144
    v_mfma_f32_32x32x16_bf16 v[16:31], v[76:79], v[176:179], v[16:31]
    buffer_load_dwordx4 v238, s[4:7], s37 offen  lds
    ds_read_b64_tr_b16 v[176:177], v244 offset:0
    ds_read_b64_tr_b16 v[188:189], v245 offset:0
    v_add_u32 v252, s44, v247
    ds_read_u16 v238, v252
    ds_read_u16 v239, v252 offset:64
    v_mul_f32_e64 v201, v48, -v168
    v_fma_f32 v201, v49, -v169, v201
    v_fma_f32 v201, v50, -v170, v201
    v_fma_f32 v201, v51, -v171, v201
    v_fma_f32 v201, v52, -v172, v201
    v_fma_f32 v201, v53, -v173, v201
    s_waitcnt lgkmcnt(2)
    v_mfma_f32_32x32x8_bf16 v[0:15], v[80:81], v[176:177], v[0:15]
    v_fma_f32 v201, v54, -v174, v201
    v_fma_f32 v201, v55, -v175, v201
    v_mul_f32_e64 v203, v56, -v168
    v_fma_f32 v203, v57, -v169, v203
    v_fma_f32 v203, v58, -v170, v203
    s_add_u32 m0, s21, 0
    v_mfma_f32_32x32x8_bf16 v[16:31], v[84:85], v[176:177], v[16:31]
    v_lshl_add_u32 v234, v234, 10, v246
    v_lshl_add_u32 v235, v235, 10, v246
    buffer_load_dwordx4 v234, s[4:7], s38 offen  lds
    buffer_load_dwordx4 v235, s[8:11], s38 offen offset:1024  lds
    s_mov_b32 m0, s76
    s_mov_b64 exec, s[72:73]
    buffer_load_dwordx4 v254, s[12:15], 0 offen  lds
    s_mov_b32 m0, s77
    s_mov_b64 exec, s[74:75]
    buffer_load_dwordx4 v255, s[12:15], 0 offen  lds
    s_mov_b64 exec, -1
    v_fma_f32 v203, v59, -v171, v203
    v_fma_f32 v203, v60, -v172, v203
    v_fma_f32 v203, v61, -v173, v203
    v_fma_f32 v203, v62, -v174, v203
    v_fma_f32 v203, v63, -v175, v203
    v_mfma_f32_32x32x16_bf16 v[32:47], v[64:67], v[180:183], 0
    v_mul_f32 v254, v0, v144
    v_fmac_f32 v254, v1, v145
    v_fmac_f32 v254, v2, v146
    v_mfma_f32_32x32x16_bf16 v[48:63], v[68:71], v[180:183], 0
    ds_swizzle_b32 v68, v68 offset:0x401F
    ds_swizzle_b32 v69, v69 offset:0x401F
    ds_swizzle_b32 v70, v70 offset:0x401F
    ds_swizzle_b32 v71, v71 offset:0x401F
    v_fmac_f32 v254, v3, v147
    v_fmac_f32 v254, v4, v148
    v_fmac_f32 v254, v5, v149
    v_mfma_f32_32x32x16_bf16 v[32:47], v[72:75], v[184:187], v[32:47]
    v_fmac_f32 v254, v6, v150
    v_fmac_f32 v254, v7, v151
    v_fmac_f32 v200, v8, v160
    v_mfma_f32_32x32x16_bf16 v[48:63], v[76:79], v[184:187], v[48:63]
    ds_swizzle_b32 v76, v76 offset:0x401F
    ds_swizzle_b32 v77, v77 offset:0x401F
    ds_swizzle_b32 v78, v78 offset:0x401F
    ds_swizzle_b32 v79, v79 offset:0x401F
    s_waitcnt vmcnt(7)
    ds_read_b64_tr_b16 v[176:177], v244 offset:2048
    ds_read_b64_tr_b16 v[178:179], v244 offset:3072
    ds_read_b64_tr_b16 v[180:181], v245 offset:2048
    ds_read_b64_tr_b16 v[182:183], v245 offset:3072
    v_fmac_f32 v200, v9, v161
    v_permlane32_swap_b32 v196, v254
    v_fmac_f32 v200, v10, v162
    v_mfma_f32_32x32x8_bf16 v[32:47], v[80:81], v[188:189], v[32:47]
    v_fmac_f32 v200, v11, v163
    v_fmac_f32 v200, v12, v164
    v_fmac_f32 v200, v13, v165
    v_mfma_f32_32x32x8_bf16 v[48:63], v[84:85], v[188:189], v[48:63]
    ds_swizzle_b32 v84, v84 offset:0x401F
    ds_swizzle_b32 v85, v85 offset:0x401F
    v_fmac_f32 v200, v14, v166
    v_fmac_f32 v200, v15, v167
    v_add_f32 v254, v196, v254
    s_waitcnt lgkmcnt(6)
    s_mov_b64 exec, s[56:57]
    v_xor_b32 v68, 0x80008000, v68
    v_xor_b32 v69, 0x80008000, v69
    v_xor_b32 v70, 0x80008000, v70
    v_xor_b32 v71, 0x80008000, v71
    v_xor_b32 v76, 0x80008000, v76
    v_xor_b32 v77, 0x80008000, v77
    v_xor_b32 v78, 0x80008000, v78
    v_xor_b32 v79, 0x80008000, v79
    s_mov_b64 exec, -1
    s_waitcnt vmcnt(5) lgkmcnt(2)
    v_mfma_f32_32x32x16_bf16 v[0:15], v[64:67], v[176:179], 0
    v_mul_f32 v255, v32, v152
    v_fmac_f32 v255, v33, v153
    v_fmac_f32 v255, v34, v154
    v_fmac_f32 v255, v35, v155
    s_add_u32 m0, s21, 2048
    v_mfma_f32_32x32x16_bf16 v[16:31], v[68:71], v[176:179], v[16:31]
    v_lshl_add_u32 v236, v236, 10, v246
    v_lshl_add_u32 v237, v237, 10, v246
    buffer_load_dwordx4 v236, s[4:7], s39 offen  lds
    buffer_load_dwordx4 v237, s[8:11], s39 offen offset:1024  lds
    ds_read_b64_tr_b16 v[176:177], v244 offset:4096
    ds_read_b64_tr_b16 v[178:179], v244 offset:5120
    ds_read_b64_tr_b16 v[184:185], v245 offset:4096
    ds_read_b64_tr_b16 v[186:187], v245 offset:5120
    v_fmac_f32 v255, v36, v156
    v_fmac_f32 v255, v37, v157
    v_fmac_f32 v255, v38, v158
    v_fmac_f32 v255, v39, v159
    s_waitcnt vmcnt(6) lgkmcnt(0)
    v_mfma_f32_32x32x16_bf16 v[0:15], v[72:75], v[176:179], v[0:15]
    v_fmac_f32 v201, v40, v168
    v_fmac_f32 v201, v41, v169
    v_permlane32_swap_b32 v197, v255
    s_add_u32 m0, s21, 4096
    v_mfma_f32_32x32x16_bf16 v[16:31], v[76:79], v[176:179], v[16:31]
    v_lshl_add_u32 v238, v238, 10, v246
    v_lshl_add_u32 v239, v239, 10, v246
    buffer_load_dwordx4 v238, s[4:7], s40 offen  lds
    buffer_load_dwordx4 v239, s[8:11], s40 offen offset:1024  lds
    ds_read_b64_tr_b16 v[176:177], v244 offset:6144
    ds_read_b64_tr_b16 v[188:189], v245 offset:6144
    v_fmac_f32 v201, v42, v170
    v_fmac_f32 v201, v43, v171
    v_fmac_f32 v201, v44, v172
    v_fmac_f32 v201, v45, v173
    s_waitcnt lgkmcnt(0)
    s_mov_b64 exec, s[56:57]
    v_xor_b32 v84, 0x80008000, v84
    v_xor_b32 v85, 0x80008000, v85
    s_mov_b64 exec, -1
    v_mfma_f32_32x32x8_bf16 v[0:15], v[80:81], v[176:177], v[0:15]
    v_fmac_f32 v201, v46, v174
    v_fmac_f32 v201, v47, v175
    v_add_f32 v255, v197, v255
    s_set_gpr_idx_on s51, gpr_idx(DST)
    s_nop 0
    v_cvt_pk_bf16_f32 v206, v254, v255
    s_set_gpr_idx_off
    s_add_u32 m0, s21, 6144
    v_mfma_f32_32x32x8_bf16 v[16:31], v[84:85], v[176:177], v[16:31]
    v_lshl_add_u32 v240, v240, 10, v246
    v_lshl_add_u32 v241, v241, 10, v246
    buffer_load_dwordx4 v240, s[4:7], s41 offen  lds
    buffer_load_dwordx4 v241, s[8:11], s41 offen offset:1024  lds
    v_mfma_f32_32x32x16_bf16 v[32:47], v[64:67], v[180:183], 0
    v_mul_f32 v254, v0, v144
    v_fmac_f32 v254, v1, v145
    v_fmac_f32 v254, v2, v146
    v_fmac_f32 v254, v3, v147
    v_fmac_f32 v254, v4, v148
    v_fmac_f32 v254, v5, v149
    v_fmac_f32 v254, v6, v150
    v_mfma_f32_32x32x16_bf16 v[48:63], v[68:71], v[180:183], v[48:63]
    v_fmac_f32 v254, v7, v151
    v_fma_f32 v202, v8, -v160, v202
    v_fma_f32 v202, v9, -v161, v202
    v_permlane32_swap_b32 v254, v200
    v_fma_f32 v202, v10, -v162, v202
    v_fma_f32 v202, v11, -v163, v202
    v_mfma_f32_32x32x16_bf16 v[32:47], v[72:75], v[184:187], v[32:47]
    v_fma_f32 v202, v12, -v164, v202
    v_fma_f32 v202, v13, -v165, v202
    v_fma_f32 v202, v14, -v166, v202
    v_fma_f32 v202, v15, -v167, v202
    v_add_f32 v200, v254, v200
    v_fmac_f32 v198, v16, v112
    v_permlane32_swap_b32 v202, v254
    v_mfma_f32_32x32x16_bf16 v[48:63], v[76:79], v[184:187], v[48:63]
    s_waitcnt vmcnt(8)
    ds_read_b64_tr_b16 v[176:177], v244 offset:0
    ds_read_b64_tr_b16 v[178:179], v244 offset:1024
    ds_read_b64_tr_b16 v[180:181], v245 offset:0
    ds_read_b64_tr_b16 v[182:183], v245 offset:1024
    v_fmac_f32 v198, v17, v113
    v_fmac_f32 v198, v18, v114
    v_fmac_f32 v198, v19, v115
    v_fmac_f32 v198, v20, v116
    v_fmac_f32 v198, v21, v117
    v_fmac_f32 v198, v22, v118
    v_mfma_f32_32x32x8_bf16 v[32:47], v[80:81], v[188:189], v[32:47]
    v_fmac_f32 v198, v23, v119
    v_add_f32 v254, v202, v254
    v_mul_f32 v196, v24, v160
    v_fmac_f32 v196, v25, v161
    v_fmac_f32 v196, v26, v162
    v_fmac_f32 v196, v27, v163
    v_fmac_f32 v196, v28, v164
    v_mfma_f32_32x32x8_bf16 v[48:63], v[84:85], v[188:189], v[48:63]
    v_add_u32 v249, s48, v249
    v_add_u32 v250, s49, v250
    s_waitcnt vmcnt(6)
    ds_read_b64_tr_b16 v[64:65], v249 offset:0
    ds_read_b64_tr_b16 v[68:69], v249 offset:64
    ds_read_b64_tr_b16 v[66:67], v249 offset:256
    ds_read_b64_tr_b16 v[70:71], v249 offset:320
    s_mov_b64 exec, s[54:55]
    ds_read_u16_d16_hi v242, v250 offset:0
    s_mov_b64 exec, -1
    v_fmac_f32 v196, v29, v165
    v_fmac_f32 v196, v30, v166
    v_fmac_f32 v196, v31, v167
    s_nop 1
    v_permlane32_swap_b32 v198, v196
    v_add_f32 v196, v198, v196
    v_mul_f32 v255, v32, v152
    v_fmac_f32 v255, v33, v153
    v_fmac_f32 v255, v34, v154
    v_fmac_f32 v255, v35, v155
    v_fmac_f32 v255, v36, v156
    v_fmac_f32 v255, v37, v157
    v_fmac_f32 v255, v38, v158
    v_fmac_f32 v255, v39, v159
    v_fma_f32 v203, v40, -v168, v203
    v_fma_f32 v203, v41, -v169, v203
    v_permlane32_swap_b32 v255, v201
    v_fma_f32 v203, v42, -v170, v203
    v_fma_f32 v203, v43, -v171, v203
    v_fma_f32 v203, v44, -v172, v203
    v_fma_f32 v203, v45, -v173, v203
    v_fma_f32 v203, v46, -v174, v203
    v_fma_f32 v203, v47, -v175, v203
    v_add_f32 v201, v255, v201
    v_fmac_f32 v199, v48, v120
    v_permlane32_swap_b32 v203, v255
    v_fmac_f32 v199, v49, v121
    v_fmac_f32 v199, v50, v122
    v_fmac_f32 v199, v51, v123
    v_fmac_f32 v199, v52, v124
    v_fmac_f32 v199, v53, v125
    v_fmac_f32 v199, v54, v126
    v_fmac_f32 v199, v55, v127
    v_add_f32 v255, v203, v255
    v_mul_f32 v197, v56, v168
    v_fmac_f32 v197, v57, v169
    v_fmac_f32 v197, v58, v170
    v_fmac_f32 v197, v59, v171
    v_fmac_f32 v197, v60, v172
    v_fmac_f32 v197, v61, v173
    v_fmac_f32 v197, v62, v174
    v_fmac_f32 v197, v63, v175
    s_nop 1
    v_permlane32_swap_b32 v199, v197
    v_add_f32 v197, v199, v197
    s_set_gpr_idx_on s51, gpr_idx(DST)
    s_nop 0
    v_cvt_pk_bf16_f32 v207, v200, v201
    v_cvt_pk_bf16_f32 v209, v254, v255
    v_cvt_pk_bf16_f32 v208, v196, v197
    s_set_gpr_idx_off
    s_add_u32 s50, s50, 1
    s_add_u32 s51, s51, 6
    s_cmp_ge_u32 s50, 4
    s_cbranch_scc1 LAST0
    s_add_u32 s53, s53, 4
    s_xor_b32 s66, s53, s20
    s_bitcmp1_b32 s66, 2
    s_setprio 1
    s_cbranch_scc1 PRIO_6
    s_setprio 0
PRIO_6:
    s_cmp_eq_u32 s52, 4
    s_cbranch_scc1 ITEM_0_4
    s_cmp_eq_u32 s52, 5
    s_cbranch_scc1 ITEM_0_5
    s_cmp_eq_u32 s52, 3
    s_cbranch_scc1 ITEM_0_3
    s_cmp_eq_u32 s52, 6
    s_cbranch_scc1 ITEM_0_6
    s_cmp_eq_u32 s52, 8
    s_cbranch_scc1 ITEM_0_8
    s_branch ITEM_0_2
.p2align 6
ITEM_0_3:
    s_mov_b64 exec, s[54:55]
    ds_read_u16_d16_hi v243, v250 offset:128
    s_mov_b64 exec, -1
    ds_read_b64_tr_b16 v[72:73], v249 offset:512
    ds_read_b64_tr_b16 v[76:77], v249 offset:576
    s_waitcnt lgkmcnt(3)
    v_mul_f32_dpp v196, v242, v64 row_newbcast:0 row_mask:0xf bank_mask:0xf
    v_mul_f32_dpp v197, v242, v65 row_newbcast:1 row_mask:0xf bank_mask:0xf
    v_mul_f32_dpp v198, v242, v64 row_newbcast:8 row_mask:0xf bank_mask:0xf
    v_mul_f32_dpp v199, v242, v65 row_newbcast:9 row_mask:0xf bank_mask:0xf
    v_mul_f32_dpp v200, v242, v68 row_newbcast:2 row_mask:0xf bank_mask:0xf
    v_mul_f32_dpp v201, v242, v69 row_newbcast:3 row_mask:0xf bank_mask:0xf
    v_mul_f32_dpp v202, v242, v68 row_newbcast:10 row_mask:0xf bank_mask:0xf
    v_mul_f32_dpp v203, v242, v69 row_newbcast:11 row_mask:0xf bank_mask:0xf
    v_cvt_pk_bf16_f32 v64, v196, v197
    v_cvt_pk_bf16_f32 v68, v198, v199
    v_cvt_pk_bf16_f32 v65, v200, v201
    v_cvt_pk_bf16_f32 v69, v202, v203
    v_mul_f32_dpp v196, v242, v66 row_newbcast:4 row_mask:0xf bank_mask:0xf
    v_mul_f32_dpp v197, v242, v67 row_newbcast:5 row_mask:0xf bank_mask:0xf
    v_mul_f32_dpp v198, v242, v66 row_newbcast:12 row_mask:0xf bank_mask:0xf
    v_mul_f32_dpp v199, v242, v67 row_newbcast:13 row_mask:0xf bank_mask:0xf
    v_mul_f32_dpp v200, v242, v70 row_newbcast:6 row_mask:0xf bank_mask:0xf
    v_mul_f32_dpp v201, v242, v71 row_newbcast:7 row_mask:0xf bank_mask:0xf
    v_mul_f32_dpp v202, v242, v70 row_newbcast:14 row_mask:0xf bank_mask:0xf
    v_mul_f32_dpp v203, v242, v71 row_newbcast:15 row_mask:0xf bank_mask:0xf
    v_cvt_pk_bf16_f32 v66, v196, v197
    v_cvt_pk_bf16_f32 v70, v198, v199
    v_cvt_pk_bf16_f32 v67, v200, v201
    v_cvt_pk_bf16_f32 v71, v202, v203
    s_nop 0
    s_waitcnt vmcnt(4) lgkmcnt(0)
    v_mfma_f32_32x32x16_bf16 v[0:15], v[64:67], v[176:179], 0
    v_mul_f32_dpp v196, v243, v72 row_newbcast:0 row_mask:0xf bank_mask:0xf
    v_mul_f32_dpp v197, v243, v73 row_newbcast:1 row_mask:0xf bank_mask:0xf
    v_mul_f32_dpp v198, v243, v72 row_newbcast:8 row_mask:0xf bank_mask:0xf
    v_mul_f32_dpp v199, v243, v73 row_newbcast:9 row_mask:0xf bank_mask:0xf
    v_mul_f32_dpp v200, v243, v76 row_newbcast:2 row_mask:0xf bank_mask:0xf
    v_mul_f32_dpp v201, v243, v77 row_newbcast:3 row_mask:0xf bank_mask:0xf
    s_add_u32 m0, s21, 0
    v_mfma_f32_32x32x16_bf16 v[16:31], v[68:71], v[176:179], 0
    buffer_load_dwordx4 v234, s[4:7], s36 offen  lds
    buffer_load_dwordx4 v235, s[8:11], s36 offen offset:1024  lds
    ds_read_b64_tr_b16 v[176:177], v244 offset:2048
    ds_read_b64_tr_b16 v[184:185], v245 offset:2048
    v_mul_f32_dpp v202, v243, v76 row_newbcast:10 row_mask:0xf bank_mask:0xf
    v_mul_f32_dpp v203, v243, v77 row_newbcast:11 row_mask:0xf bank_mask:0xf
    v_cvt_pk_bf16_f32 v72, v196, v197
    v_cvt_pk_bf16_f32 v76, v198, v199
    v_cvt_pk_bf16_f32 v73, v200, v201
    v_cvt_pk_bf16_f32 v77, v202, v203
    s_nop 0
    s_waitcnt lgkmcnt(0)
    v_mfma_f32_32x32x8_bf16 v[0:15], v[72:73], v[176:177], v[0:15]
    s_add_u32 m0, s21, 2048
    v_mfma_f32_32x32x8_bf16 v[16:31], v[76:77], v[176:177], v[16:31]
    buffer_load_dwordx4 v236, s[4:7], s36 offen  lds
    s_mov_b32 m0, s50
    s_nop 0
    s_movrels_b32 s71, s23
    s_bfe_u32 s46, s71, 0x30012
    s_mov_b32 m0, s46
    s_and_b32 s66, s71, 0x3ffff
    s_movrels_b32 s68, s57
    s_movrels_b32 s69, s61
    s_sub_u32 s48, s66, s47
    s_mov_b32 s47, s66
    s_lshr_b32 s52, s71, 28
    s_lshl_b32 s67, s46, 9
    s_add_u32 s66, s66, s67
    s_sub_u32 s49, s66, s42
    s_mov_b32 s42, s66
    s_bfe_u32 s66, s68, 655360
    s_add_u32 s43, s42, s66
    s_bfe_u32 s39, s69, 655360
    s_bfe_u32 s66, s68, 655370
    s_add_u32 s44, s42, s66
    s_bfe_u32 s40, s69, 655370
    s_bfe_u32 s66, s68, 655380
    s_add_u32 s45, s42, s66
    s_bfe_u32 s41, s69, 655380
    s_and_b32 s66, s46, s33
    s_cselect_b32 s72, -1, 1
    s_cselect_b32 s76, s47, 163712
    s_cmp_ge_u32 s66, 2
    s_cselect_b32 s73, -1, 0
    s_add_u32 s77, s47, 1024
    s_cmp_ge_u32 s66, 4
    s_cselect_b32 s75, -1, 0
    s_cmp_ge_u32 s66, 3
    s_cselect_b32 s74, -1, 1
    s_cselect_b32 s77, s77, 163712
    v_add_u32 v252, s44, v247
    ds_read_u16 v238, v252
    ds_read_u16 v239, v252 offset:64
    v_add_u32 v252, s45, v247
    ds_read_u16 v240, v252
    ds_read_u16 v241, v252 offset:64
    v_mfma_f32_32x32x16_bf16 v[32:47], v[64:67], v[180:183], 0
    v_mul_f32 v196, v0, v96
    v_fmac_f32 v196, v1, v97
    v_fmac_f32 v196, v2, v98
    v_fmac_f32 v196, v3, v99
    v_fmac_f32 v196, v4, v100
    v_fmac_f32 v196, v5, v101
    v_fmac_f32 v196, v6, v102
    v_fmac_f32 v196, v7, v103
    v_mul_f32 v198, v8, v128
    v_fmac_f32 v198, v9, v129
    v_mfma_f32_32x32x16_bf16 v[48:63], v[68:71], v[180:183], 0
    s_waitcnt vmcnt(5)
    ds_read_b64_tr_b16 v[176:177], v244 offset:4096
    ds_read_b64_tr_b16 v[178:179], v244 offset:5120
    ds_read_b64_tr_b16 v[180:181], v245 offset:4096
    ds_read_b64_tr_b16 v[182:183], v245 offset:5120
    v_fmac_f32 v198, v10, v130
    v_fmac_f32 v198, v11, v131
    v_fmac_f32 v198, v12, v132
    v_fmac_f32 v198, v13, v133
    v_fmac_f32 v198, v14, v134
    v_fmac_f32 v198, v15, v135
    v_mul_f32 v200, v16, v128
    v_fmac_f32 v200, v17, v129
    v_permlane32_swap_b32 v196, v198
    v_mfma_f32_32x32x8_bf16 v[32:47], v[72:73], v[184:185], v[32:47]
    v_fmac_f32 v200, v18, v130
    v_fmac_f32 v200, v19, v131
    v_fmac_f32 v200, v20, v132
    v_fmac_f32 v200, v21, v133
    v_fmac_f32 v200, v22, v134
    v_fmac_f32 v200, v23, v135
    v_add_f32 v198, v196, v198
    v_mul_f32_e64 v202, v24, -v128
    v_fma_f32 v202, v25, -v129, v202
    v_mfma_f32_32x32x8_bf16 v[48:63], v[76:77], v[184:185], v[48:63]
    v_fma_f32 v202, v26, -v130, v202
    v_fma_f32 v202, v27, -v131, v202
    v_fma_f32 v202, v28, -v132, v202
    v_fma_f32 v202, v29, -v133, v202
    v_fma_f32 v202, v30, -v134, v202
    v_fma_f32 v202, v31, -v135, v202
    s_nop 1
    v_permlane32_swap_b32 v200, v202
    v_add_f32 v202, v200, v202
    s_waitcnt vmcnt(3) lgkmcnt(0)
    v_mfma_f32_32x32x16_bf16 v[0:15], v[64:67], v[176:179], 0
    v_mul_f32 v197, v32, v104
    v_fmac_f32 v197, v33, v105
    v_fmac_f32 v197, v34, v106
    v_fmac_f32 v197, v35, v107
    v_fmac_f32 v197, v36, v108
    v_fmac_f32 v197, v37, v109
    v_fmac_f32 v197, v38, v110
    v_fmac_f32 v197, v39, v111
    v_mul_f32 v199, v40, v136
    v_fmac_f32 v199, v41, v137
    v_fmac_f32 v199, v42, v138
    s_add_u32 m0, s21, 4096
    v_mfma_f32_32x32x16_bf16 v[16:31], v[68:71], v[176:179], 0
    buffer_load_dwordx4 v234, s[4:7], s37 offen  lds
    buffer_load_dwordx4 v235, s[8:11], s37 offen offset:1024  lds
    ds_read_b64_tr_b16 v[176:177], v244 offset:6144
    ds_read_b64_tr_b16 v[184:185], v245 offset:6144
    v_add_u32 v252, s42, v247
    ds_read_u16 v234, v252
    ds_read_u16 v235, v252 offset:64
    v_fmac_f32 v199, v43, v139
    v_fmac_f32 v199, v44, v140
    v_fmac_f32 v199, v45, v141
    v_fmac_f32 v199, v46, v142
    v_fmac_f32 v199, v47, v143
    v_mul_f32 v201, v48, v136
    v_fmac_f32 v201, v49, v137
    v_permlane32_swap_b32 v197, v199
    v_fmac_f32 v201, v50, v138
    v_fmac_f32 v201, v51, v139
    s_waitcnt lgkmcnt(2)
    v_mfma_f32_32x32x8_bf16 v[0:15], v[72:73], v[176:177], v[0:15]
    v_fmac_f32 v201, v52, v140
    v_fmac_f32 v201, v53, v141
    v_fmac_f32 v201, v54, v142
    v_fmac_f32 v201, v55, v143
    v_add_f32 v199, v197, v199
    v_mul_f32_e64 v203, v56, -v136
    v_fma_f32 v203, v57, -v137, v203
    v_fma_f32 v203, v58, -v138, v203
    v_fma_f32 v203, v59, -v139, v203
    v_fma_f32 v203, v60, -v140, v203
    v_fma_f32 v203, v61, -v141, v203
    s_add_u32 m0, s21, 6144
    v_mfma_f32_32x32x8_bf16 v[16:31], v[76:77], v[176:177], v[16:31]
    buffer_load_dwordx4 v236, s[4:7], s37 offen  lds
    v_add_u32 v252, s43, v247
    ds_read_u16 v236, v252
    ds_read_u16 v237, v252 offset:64
    v_fma_f32 v203, v62, -v142, v203
    v_fma_f32 v203, v63, -v143, v203
    s_nop 1
    v_permlane32_swap_b32 v201, v203
    v_add_f32 v203, v201, v203
    s_set_gpr_idx_on s51, gpr_idx(DST)
    s_nop 0
    v_cvt_pk_bf16_f32 v204, v198, v199
    v_cvt_pk_bf16_f32 v205, v202, v203
    s_set_gpr_idx_off
    v_mfma_f32_32x32x16_bf16 v[32:47], v[64:67], v[180:183], 0
    v_mul_f32 v196, v0, v144
    v_fmac_f32 v196, v1, v145
    v_fmac_f32 v196, v2, v146
    v_fmac_f32 v196, v3, v147
    v_fmac_f32 v196, v4, v148
    v_fmac_f32 v196, v5, v149
    v_fmac_f32 v196, v6, v150
    v_fmac_f32 v196, v7, v151
    v_mfma_f32_32x32x16_bf16 v[48:63], v[68:71], v[180:183], 0
    v_add_u32 v253, s47, v248
    ds_read_b32 v254, v253
    ds_read_b32 v255, v253 offset:256
    s_waitcnt vmcnt(4)
    ds_read_b64_tr_b16 v[176:177], v244 offset:0
    ds_read_b64_tr_b16 v[178:179], v244 offset:1024
    ds_read_b64_tr_b16 v[180:181], v245 offset:0
    ds_read_b64_tr_b16 v[182:183], v245 offset:1024
    v_mul_f32 v198, v8, v112
    v_fmac_f32 v198, v9, v113
    v_fmac_f32 v198, v10, v114
    v_fmac_f32 v198, v11, v115
    v_fmac_f32 v198, v12, v116
    v_fmac_f32 v198, v13, v117
    v_fmac_f32 v198, v14, v118
    v_fmac_f32 v198, v15, v119
    v_mfma_f32_32x32x8_bf16 v[32:47], v[72:73], v[184:185], v[32:47]
    v_mul_f32_e64 v200, v16, -v160
    v_fma_f32 v200, v17, -v161, v200
    v_fma_f32 v200, v18, -v162, v200
    v_fma_f32 v200, v19, -v163, v200
    v_fma_f32 v200, v20, -v164, v200
    v_fma_f32 v200, v21, -v165, v200
    v_fma_f32 v200, v22, -v166, v200
    v_fma_f32 v200, v23, -v167, v200
    v_mfma_f32_32x32x8_bf16 v[48:63], v[76:77], v[184:185], v[48:63]
    v_mul_f32_e64 v202, v24, -v160
    v_fma_f32 v202, v25, -v161, v202
    v_fma_f32 v202, v26, -v162, v202
    v_fma_f32 v202, v27, -v163, v202
    v_fma_f32 v202, v28, -v164, v202
    v_fma_f32 v202, v29, -v165, v202
    v_fma_f32 v202, v30, -v166, v202
    v_fma_f32 v202, v31, -v167, v202
    s_waitcnt vmcnt(3) lgkmcnt(0)
    v_mfma_f32_32x32x16_bf16 v[0:15], v[64:67], v[176:179], 0
    v_mul_f32 v197, v32, v152
    v_fmac_f32 v197, v33, v153
    v_fmac_f32 v197, v34, v154
    v_fmac_f32 v197, v35, v155
    v_fmac_f32 v197, v36, v156
    v_fmac_f32 v197, v37, v157
    v_fmac_f32 v197, v38, v158
    v_fmac_f32 v197, v39, v159
    s_add_u32 m0, s21, 0
    v_mfma_f32_32x32x16_bf16 v[16:31], v[68:71], v[176:179], 0
    v_lshl_add_u32 v234, v234, 10, v246
    v_lshl_add_u32 v235, v235, 10, v246
    buffer_load_dwordx4 v234, s[4:7], s38 offen  lds
    buffer_load_dwordx4 v235, s[8:11], s38 offen offset:1024  lds
    ds_read_b64_tr_b16 v[176:177], v244 offset:2048
    ds_read_b64_tr_b16 v[184:185], v245 offset:2048
    v_mul_f32 v199, v40, v120
    v_fmac_f32 v199, v41, v121
    v_fmac_f32 v199, v42, v122
    v_fmac_f32 v199, v43, v123
    v_fmac_f32 v199, v44, v124
    v_fmac_f32 v199, v45, v125
    v_fmac_f32 v199, v46, v126
    v_fmac_f32 v199, v47, v127
    s_waitcnt lgkmcnt(0)
    v_mfma_f32_32x32x8_bf16 v[0:15], v[72:73], v[176:177], v[0:15]
    v_mul_f32_e64 v201, v48, -v168
    v_fma_f32 v201, v49, -v169, v201
    v_fma_f32 v201, v50, -v170, v201
    v_fma_f32 v201, v51, -v171, v201
    v_fma_f32 v201, v52, -v172, v201
    v_fma_f32 v201, v53, -v173, v201
    v_fma_f32 v201, v54, -v174, v201
    v_fma_f32 v201, v55, -v175, v201
    s_add_u32 m0, s21, 2048
    v_mfma_f32_32x32x8_bf16 v[16:31], v[76:77], v[176:177], v[16:31]
    v_lshl_add_u32 v236, v236, 10, v246
    v_lshl_add_u32 v237, v237, 10, v246
    buffer_load_dwordx4 v236, s[4:7], s39 offen  lds
    buffer_load_dwordx4 v237, s[8:11], s39 offen offset:1024  lds
    s_mov_b32 m0, s76
    s_mov_b64 exec, s[72:73]
    buffer_load_dwordx4 v254, s[12:15], 0 offen  lds
    s_mov_b32 m0, s77
    s_mov_b64 exec, s[74:75]
    buffer_load_dwordx4 v255, s[12:15], 0 offen  lds
    s_mov_b64 exec, -1
    v_mul_f32_e64 v203, v56, -v168
    v_fma_f32 v203, v57, -v169, v203
    v_fma_f32 v203, v58, -v170, v203
    v_fma_f32 v203, v59, -v171, v203
    v_fma_f32 v203, v60, -v172, v203
    v_fma_f32 v203, v61, -v173, v203
    v_fma_f32 v203, v62, -v174, v203
    v_fma_f32 v203, v63, -v175, v203
    v_mfma_f32_32x32x16_bf16 v[32:47], v[64:67], v[180:183], 0
    v_mul_f32 v254, v0, v144
    v_fmac_f32 v254, v1, v145
    v_fmac_f32 v254, v2, v146
    v_fmac_f32 v254, v3, v147
    v_fmac_f32 v254, v4, v148
    v_mfma_f32_32x32x16_bf16 v[48:63], v[68:71], v[180:183], 0
    ds_swizzle_b32 v68, v68 offset:0x401F
    ds_swizzle_b32 v69, v69 offset:0x401F
    ds_swizzle_b32 v70, v70 offset:0x401F
    ds_swizzle_b32 v71, v71 offset:0x401F
    s_waitcnt vmcnt(7)
    ds_read_b64_tr_b16 v[176:177], v244 offset:4096
    ds_read_b64_tr_b16 v[178:179], v244 offset:5120
    ds_read_b64_tr_b16 v[180:181], v245 offset:4096
    ds_read_b64_tr_b16 v[182:183], v245 offset:5120
    v_fmac_f32 v254, v5, v149
    v_fmac_f32 v254, v6, v150
    v_fmac_f32 v254, v7, v151
    v_fmac_f32 v200, v8, v160
    v_mfma_f32_32x32x8_bf16 v[32:47], v[72:73], v[184:185], v[32:47]
    v_fmac_f32 v200, v9, v161
    v_permlane32_swap_b32 v196, v254
    v_fmac_f32 v200, v10, v162
    v_fmac_f32 v200, v11, v163
    v_fmac_f32 v200, v12, v164
    v_mfma_f32_32x32x8_bf16 v[48:63], v[76:77], v[184:185], v[48:63]
    ds_swizzle_b32 v76, v76 offset:0x401F
    ds_swizzle_b32 v77, v77 offset:0x401F
    v_fmac_f32 v200, v13, v165
    v_fmac_f32 v200, v14, v166
    v_fmac_f32 v200, v15, v167
    v_add_f32 v254, v196, v254
    s_waitcnt lgkmcnt(6)
    s_mov_b64 exec, s[56:57]
    v_xor_b32 v68, 0x80008000, v68
    v_xor_b32 v69, 0x80008000, v69
    v_xor_b32 v70, 0x80008000, v70
    v_xor_b32 v71, 0x80008000, v71
    s_mov_b64 exec, -1
    s_waitcnt vmcnt(6) lgkmcnt(2)
    v_mfma_f32_32x32x16_bf16 v[0:15], v[64:67], v[176:179], 0
    v_mul_f32 v255, v32, v152
    v_fmac_f32 v255, v33, v153
    v_fmac_f32 v255, v34, v154
    v_fmac_f32 v255, v35, v155
    v_fmac_f32 v255, v36, v156
    v_fmac_f32 v255, v37, v157
    s_add_u32 m0, s21, 4096
    v_mfma_f32_32x32x16_bf16 v[16:31], v[68:71], v[176:179], v[16:31]
    v_lshl_add_u32 v238, v238, 10, v246
    v_lshl_add_u32 v239, v239, 10, v246
    buffer_load_dwordx4 v238, s[4:7], s40 offen  lds
    buffer_load_dwordx4 v239, s[8:11], s40 offen offset:1024  lds
    ds_read_b64_tr_b16 v[176:177], v244 offset:6144
    ds_read_b64_tr_b16 v[184:185], v245 offset:6144
    v_fmac_f32 v255, v38, v158
    v_fmac_f32 v255, v39, v159
    v_fmac_f32 v201, v40, v168
    v_fmac_f32 v201, v41, v169
    v_permlane32_swap_b32 v197, v255
    s_waitcnt lgkmcnt(0)
    s_mov_b64 exec, s[56:57]
    v_xor_b32 v76, 0x80008000, v76
    v_xor_b32 v77, 0x80008000, v77
    s_mov_b64 exec, -1
    v_mfma_f32_32x32x8_bf16 v[0:15], v[72:73], v[176:177], v[0:15]
    v_fmac_f32 v201, v42, v170
    v_fmac_f32 v201, v43, v171
    v_fmac_f32 v201, v44, v172
    v_fmac_f32 v201, v45, v173
    v_fmac_f32 v201, v46, v174
    v_fmac_f32 v201, v47, v175
    s_add_u32 m0, s21, 6144
    v_mfma_f32_32x32x8_bf16 v[16:31], v[76:77], v[176:177], v[16:31]
    v_lshl_add_u32 v240, v240, 10, v246
    v_lshl_add_u32 v241, v241, 10, v246
    buffer_load_dwordx4 v240, s[4:7], s41 offen  lds
    buffer_load_dwordx4 v241, s[8:11], s41 offen offset:1024  lds
    v_add_f32 v255, v197, v255
    s_set_gpr_idx_on s51, gpr_idx(DST)
    s_nop 0
    v_cvt_pk_bf16_f32 v206, v254, v255
    s_set_gpr_idx_off
    v_mfma_f32_32x32x16_bf16 v[32:47], v[64:67], v[180:183], 0
    v_mul_f32 v254, v0, v144
    v_fmac_f32 v254, v1, v145
    v_fmac_f32 v254, v2, v146
    v_fmac_f32 v254, v3, v147
    v_fmac_f32 v254, v4, v148
    v_fmac_f32 v254, v5, v149
    v_fmac_f32 v254, v6, v150
    v_fmac_f32 v254, v7, v151
    v_fma_f32 v202, v8, -v160, v202
    v_fma_f32 v202, v9, -v161, v202
    v_mfma_f32_32x32x16_bf16 v[48:63], v[68:71], v[180:183], v[48:63]
    s_waitcnt vmcnt(8)
    ds_read_b64_tr_b16 v[176:177], v244 offset:0
    ds_read_b64_tr_b16 v[178:179], v244 offset:1024
    ds_read_b64_tr_b16 v[180:181], v245 offset:0
    ds_read_b64_tr_b16 v[182:183], v245 offset:1024
    v_permlane32_swap_b32 v254, v200
    v_fma_f32 v202, v10, -v162, v202
    v_fma_f32 v202, v11, -v163, v202
    v_fma_f32 v202, v12, -v164, v202
    v_fma_f32 v202, v13, -v165, v202
    v_fma_f32 v202, v14, -v166, v202
    v_fma_f32 v202, v15, -v167, v202
    v_add_f32 v200, v254, v200
    v_fmac_f32 v198, v16, v112
    v_permlane32_swap_b32 v202, v254
    v_mfma_f32_32x32x8_bf16 v[32:47], v[72:73], v[184:185], v[32:47]
    v_fmac_f32 v198, v17, v113
    v_fmac_f32 v198, v18, v114
    v_fmac_f32 v198, v19, v115
    v_fmac_f32 v198, v20, v116
    v_fmac_f32 v198, v21, v117
    v_fmac_f32 v198, v22, v118
    v_fmac_f32 v198, v23, v119
    v_add_f32 v254, v202, v254
    v_mul_f32 v196, v24, v160
    v_fmac_f32 v196, v25, v161
    v_mfma_f32_32x32x8_bf16 v[48:63], v[76:77], v[184:185], v[48:63]
    v_add_u32 v249, s48, v249
    v_add_u32 v250, s49, v250
    s_waitcnt vmcnt(4)
    ds_read_b64_tr_b16 v[64:65], v249 offset:0
    ds_read_b64_tr_b16 v[68:69], v249 offset:64
    ds_read_b64_tr_b16 v[66:67], v249 offset:256
    ds_read_b64_tr_b16 v[70:71], v249 offset:320
    s_mov_b64 exec, s[54:55]
    ds_read_u16_d16_hi v242, v250 offset:0
    s_mov_b64 exec, -1
    v_fmac_f32 v196, v26, v162
    v_fmac_f32 v196, v27, v163
    v_fmac_f32 v196, v28, v164
    v_fmac_f32 v196, v29, v165
    v_fmac_f32 v196, v30, v166
    v_fmac_f32 v196, v31, v167
    s_nop 1
    v_permlane32_swap_b32 v198, v196
    v_add_f32 v196, v198, v196
    v_mul_f32 v255, v32, v152
    v_fmac_f32 v255, v33, v153
    v_fmac_f32 v255, v34, v154
    v_fmac_f32 v255, v35, v155
    v_fmac_f32 v255, v36, v156
    v_fmac_f32 v255, v37, v157
    v_fmac_f32 v255, v38, v158
    v_fmac_f32 v255, v39, v159
    v_fma_f32 v203, v40, -v168, v203
    v_fma_f32 v203, v41, -v169, v203
    v_permlane32_swap_b32 v255, v201
    v_fma_f32 v203, v42, -v170, v203
    v_fma_f32 v203, v43, -v171, v203
    v_fma_f32 v203, v44, -v172, v203
    v_fma_f32 v203, v45, -v173, v203
    v_fma_f32 v203, v46, -v174, v203
    v_fma_f32 v203, v47, -v175, v203
    v_add_f32 v201, v255, v201
    v_fmac_f32 v199, v48, v120
    v_permlane32_swap_b32 v203, v255
    v_fmac_f32 v199, v49, v121
    v_fmac_f32 v199, v50, v122
    v_fmac_f32 v199, v51, v123
    v_fmac_f32 v199, v52, v124
    v_fmac_f32 v199, v53, v125
    v_fmac_f32 v199, v54, v126
    v_fmac_f32 v199, v55, v127
    v_add_f32 v255, v203, v255
    v_mul_f32 v197, v56, v168
    v_fmac_f32 v197, v57, v169
    v_fmac_f32 v197, v58, v170
    v_fmac_f32 v197, v59, v171
    v_fmac_f32 v197, v60, v172
    v_fmac_f32 v197, v61, v173
    v_fmac_f32 v197, v62, v174
    v_fmac_f32 v197, v63, v175
    s_nop 1
    v_permlane32_swap_b32 v199, v197
    v_add_f32 v197, v199, v197
    s_set_gpr_idx_on s51, gpr_idx(DST)
    s_nop 0
    v_cvt_pk_bf16_f32 v207, v200, v201
    v_cvt_pk_bf16_f32 v209, v254, v255
    v_cvt_pk_bf16_f32 v208, v196, v197
    s_set_gpr_idx_off
    s_add_u32 s50, s50, 1
    s_add_u32 s51, s51, 6
    s_cmp_ge_u32 s50, 4
    s_cbranch_scc1 LAST0
    s_add_u32 s53, s53, 4
    s_xor_b32 s66, s53, s20
    s_bitcmp1_b32 s66, 2
    s_setprio 1
    s_cbranch_scc1 PRIO_7
    s_setprio 0
PRIO_7:
    s_cmp_eq_u32 s52, 4
    s_cbranch_scc1 ITEM_0_4
    s_cmp_eq_u32 s52, 5
    s_cbranch_scc1 ITEM_0_5
    s_cmp_eq_u32 s52, 3
    s_cbranch_scc1 ITEM_0_3
    s_cmp_eq_u32 s52, 6
    s_cbranch_scc1 ITEM_0_6
    s_cmp_eq_u32 s52, 8
    s_cbranch_scc1 ITEM_0_8
    s_branch ITEM_0_2
.p2align 6
ITEM_0_6:
    s_mov_b64 exec, s[54:55]
    ds_read_u16_d16_hi v243, v250 offset:128
    s_mov_b64 exec, -1
    ds_read_b64_tr_b16 v[72:73], v249 offset:512
    ds_read_b64_tr_b16 v[76:77], v249 offset:576
    ds_read_b64_tr_b16 v[74:75], v249 offset:768
    ds_read_b64_tr_b16 v[78:79], v249 offset:832
    ds_read_b64_tr_b16 v[80:81], v249 offset:1024
    ds_read_b64_tr_b16 v[84:85], v249 offset:1088
    ds_read_b64_tr_b16 v[82:83], v249 offset:1280
    ds_read_b64_tr_b16 v[86:87], v249 offset:1344
    s_waitcnt lgkmcnt(9)
    v_mul_f32_dpp v196, v242, v64 row_newbcast:0 row_mask:0xf bank_mask:0xf
    v_mul_f32_dpp v197, v242, v65 row_newbcast:1 row_mask:0xf bank_mask:0xf
    v_mul_f32_dpp v198, v242, v64 row_newbcast:8 row_mask:0xf bank_mask:0xf
    v_mul_f32_dpp v199, v242, v65 row_newbcast:9 row_mask:0xf bank_mask:0xf
    v_mul_f32_dpp v200, v242, v68 row_newbcast:2 row_mask:0xf bank_mask:0xf
    v_mul_f32_dpp v201, v242, v69 row_newbcast:3 row_mask:0xf bank_mask:0xf
    v_mul_f32_dpp v202, v242, v68 row_newbcast:10 row_mask:0xf bank_mask:0xf
    v_mul_f32_dpp v203, v242, v69 row_newbcast:11 row_mask:0xf bank_mask:0xf
    v_cvt_pk_bf16_f32 v64, v196, v197
    v_cvt_pk_bf16_f32 v68, v198, v199
    v_cvt_pk_bf16_f32 v65, v200, v201
    v_cvt_pk_bf16_f32 v69, v202, v203
    v_mul_f32_dpp v196, v242, v66 row_newbcast:4 row_mask:0xf bank_mask:0xf
    v_mul_f32_dpp v197, v242, v67 row_newbcast:5 row_mask:0xf bank_mask:0xf
    v_mul_f32_dpp v198, v242, v66 row_newbcast:12 row_mask:0xf bank_mask:0xf
    v_mul_f32_dpp v199, v242, v67 row_newbcast:13 row_mask:0xf bank_mask:0xf
    v_mul_f32_dpp v200, v242, v70 row_newbcast:6 row_mask:0xf bank_mask:0xf
    v_mul_f32_dpp v201, v242, v71 row_newbcast:7 row_mask:0xf bank_mask:0xf
    v_mul_f32_dpp v202, v242, v70 row_newbcast:14 row_mask:0xf bank_mask:0xf
    v_mul_f32_dpp v203, v242, v71 row_newbcast:15 row_mask:0xf bank_mask:0xf
    v_cvt_pk_bf16_f32 v66, v196, v197
    v_cvt_pk_bf16_f32 v70, v198, v199
    v_cvt_pk_bf16_f32 v67, v200, v201
    v_cvt_pk_bf16_f32 v71, v202, v203
    s_mov_b64 exec, s[54:55]
    ds_read_u16_d16_hi v242, v250 offset:256
    s_mov_b64 exec, -1
    s_waitcnt vmcnt(4) lgkmcnt(5)
    v_mfma_f32_32x32x16_bf16 v[0:15], v[64:67], v[176:179], 0
    v_mul_f32_dpp v196, v243, v72 row_newbcast:0 row_mask:0xf bank_mask:0xf
    v_mul_f32_dpp v197, v243, v73 row_newbcast:1 row_mask:0xf bank_mask:0xf
    v_mul_f32_dpp v198, v243, v72 row_newbcast:8 row_mask:0xf bank_mask:0xf
    v_mul_f32_dpp v199, v243, v73 row_newbcast:9 row_mask:0xf bank_mask:0xf
    v_mul_f32_dpp v200, v243, v76 row_newbcast:2 row_mask:0xf bank_mask:0xf
    v_mul_f32_dpp v201, v243, v77 row_newbcast:3 row_mask:0xf bank_mask:0xf
    v_mul_f32_dpp v202, v243, v76 row_newbcast:10 row_mask:0xf bank_mask:0xf
    v_mul_f32_dpp v203, v243, v77 row_newbcast:11 row_mask:0xf bank_mask:0xf
    v_cvt_pk_bf16_f32 v72, v196, v197
    v_cvt_pk_bf16_f32 v76, v198, v199
    v_cvt_pk_bf16_f32 v73, v200, v201
    v_cvt_pk_bf16_f32 v77, v202, v203
    s_add_u32 m0, s21, 0
    v_mfma_f32_32x32x16_bf16 v[16:31], v[68:71], v[176:179], 0
    buffer_load_dwordx4 v236, s[4:7], s35 offen  lds
    buffer_load_dwordx4 v237, s[8:11], s35 offen offset:1024  lds
    ds_read_b64_tr_b16 v[176:177], v244 offset:2048
    ds_read_b64_tr_b16 v[178:179], v244 offset:3072
    ds_read_b64_tr_b16 v[184:185], v245 offset:2048
    ds_read_b64_tr_b16 v[186:187], v245 offset:3072
    v_mul_f32_dpp v196, v243, v74 row_newbcast:4 row_mask:0xf bank_mask:0xf
    v_mul_f32_dpp v197, v243, v75 row_newbcast:5 row_mask:0xf bank_mask:0xf
    v_mul_f32_dpp v198, v243, v74 row_newbcast:12 row_mask:0xf bank_mask:0xf
    v_mul_f32_dpp v199, v243, v75 row_newbcast:13 row_mask:0xf bank_mask:0xf
    v_mul_f32_dpp v200, v243, v78 row_newbcast:6 row_mask:0xf bank_mask:0xf
    v_mul_f32_dpp v201, v243, v79 row_newbcast:7 row_mask:0xf bank_mask:0xf
    v_mul_f32_dpp v202, v243, v78 row_newbcast:14 row_mask:0xf bank_mask:0xf
    v_mul_f32_dpp v203, v243, v79 row_newbcast:15 row_mask:0xf bank_mask:0xf
    v_cvt_pk_bf16_f32 v74, v196, v197
    v_cvt_pk_bf16_f32 v78, v198, v199
    v_cvt_pk_bf16_f32 v75, v200, v201
    v_cvt_pk_bf16_f32 v79, v202, v203
    s_nop 0
    s_waitcnt vmcnt(4) lgkmcnt(0)
    v_mfma_f32_32x32x16_bf16 v[0:15], v[72:75], v[176:179], v[0:15]
    v_mul_f32_dpp v196, v242, v80 row_newbcast:0 row_mask:0xf bank_mask:0xf
    v_mul_f32_dpp v197, v242, v81 row_newbcast:1 row_mask:0xf bank_mask:0xf
    v_mul_f32_dpp v198, v242, v80 row_newbcast:8 row_mask:0xf bank_mask:0xf
    v_mul_f32_dpp v199, v242, v81 row_newbcast:9 row_mask:0xf bank_mask:0xf
    v_mul_f32_dpp v200, v242, v84 row_newbcast:2 row_mask:0xf bank_mask:0xf
    v_mul_f32_dpp v201, v242, v85 row_newbcast:3 row_mask:0xf bank_mask:0xf
    v_mul_f32_dpp v202, v242, v84 row_newbcast:10 row_mask:0xf bank_mask:0xf
    v_mul_f32_dpp v203, v242, v85 row_newbcast:11 row_mask:0xf bank_mask:0xf
    v_cvt_pk_bf16_f32 v80, v196, v197
    v_cvt_pk_bf16_f32 v84, v198, v199
    v_cvt_pk_bf16_f32 v81, v200, v201
    v_cvt_pk_bf16_f32 v85, v202, v203
    s_add_u32 m0, s21, 2048
    v_mfma_f32_32x32x16_bf16 v[16:31], v[76:79], v[176:179], v[16:31]
    buffer_load_dwordx4 v238, s[4:7], s35 offen  lds
    buffer_load_dwordx4 v239, s[8:11], s35 offen offset:1024  lds
    ds_read_b64_tr_b16 v[176:177], v244 offset:4096
    ds_read_b64_tr_b16 v[178:179], v244 offset:5120
    ds_read_b64_tr_b16 v[188:189], v245 offset:4096
    ds_read_b64_tr_b16 v[190:191], v245 offset:5120
    v_mul_f32_dpp v196, v242, v82 row_newbcast:4 row_mask:0xf bank_mask:0xf
    v_mul_f32_dpp v197, v242, v83 row_newbcast:5 row_mask:0xf bank_mask:0xf
    v_mul_f32_dpp v198, v242, v82 row_newbcast:12 row_mask:0xf bank_mask:0xf
    v_mul_f32_dpp v199, v242, v83 row_newbcast:13 row_mask:0xf bank_mask:0xf
    v_mul_f32_dpp v200, v242, v86 row_newbcast:6 row_mask:0xf bank_mask:0xf
    v_mul_f32_dpp v201, v242, v87 row_newbcast:7 row_mask:0xf bank_mask:0xf
    v_mul_f32_dpp v202, v242, v86 row_newbcast:14 row_mask:0xf bank_mask:0xf
    v_mul_f32_dpp v203, v242, v87 row_newbcast:15 row_mask:0xf bank_mask:0xf
    v_cvt_pk_bf16_f32 v82, v196, v197
    v_cvt_pk_bf16_f32 v86, v198, v199
    v_cvt_pk_bf16_f32 v83, v200, v201
    v_cvt_pk_bf16_f32 v87, v202, v203
    s_nop 0
    s_waitcnt lgkmcnt(0)
    v_mfma_f32_32x32x16_bf16 v[0:15], v[80:83], v[176:179], v[0:15]
    s_add_u32 m0, s21, 4096
    v_mfma_f32_32x32x16_bf16 v[16:31], v[84:87], v[176:179], v[16:31]
    buffer_load_dwordx4 v234, s[4:7], s36 offen  lds
    buffer_load_dwordx4 v235, s[8:11], s36 offen offset:1024  lds
    s_mov_b32 m0, s50
    s_nop 0
    s_movrels_b32 s71, s23
    s_bfe_u32 s46, s71, 0x30012
    s_mov_b32 m0, s46
    s_and_b32 s66, s71, 0x3ffff
    s_movrels_b32 s68, s57
    s_movrels_b32 s69, s61
    s_sub_u32 s48, s66, s47
    s_mov_b32 s47, s66
    s_lshr_b32 s52, s71, 28
    s_lshl_b32 s67, s46, 9
    s_add_u32 s66, s66, s67
    s_sub_u32 s49, s66, s42
    s_mov_b32 s42, s66
    s_bfe_u32 s66, s68, 655360
    s_add_u32 s43, s42, s66
    s_bfe_u32 s39, s69, 655360
    s_bfe_u32 s66, s68, 655370
    s_add_u32 s44, s42, s66
    s_bfe_u32 s40, s69, 655370
    s_bfe_u32 s66, s68, 655380
    s_add_u32 s45, s42, s66
    s_bfe_u32 s41, s69, 655380
    s_and_b32 s66, s46, s33
    s_cselect_b32 s72, -1, 1
    s_cselect_b32 s76, s47, 163712
    s_cmp_ge_u32 s66, 2
    s_cselect_b32 s73, -1, 0
    s_add_u32 s77, s47, 1024
    s_cmp_ge_u32 s66, 4
    s_cselect_b32 s75, -1, 0
    s_cmp_ge_u32 s66, 3
    s_cselect_b32 s74, -1, 1
    s_cselect_b32 s77, s77, 163712
    v_add_u32 v252, s45, v247
    ds_read_u16 v240, v252
    ds_read_u16 v241, v252 offset:64
    v_mfma_f32_32x32x16_bf16 v[32:47], v[64:67], v[180:183], 0
    v_mul_f32 v196, v0, v96
    v_fmac_f32 v196, v1, v97
    v_fmac_f32 v196, v2, v98
    v_fmac_f32 v196, v3, v99
    v_fmac_f32 v196, v4, v100
    v_fmac_f32 v196, v5, v101
    v_fmac_f32 v196, v6, v102
    v_mfma_f32_32x32x16_bf16 v[48:63], v[68:71], v[180:183], 0
    v_fmac_f32 v196, v7, v103
    v_mul_f32 v198, v8, v128
    v_fmac_f32 v198, v9, v129
    v_fmac_f32 v198, v10, v130
    v_fmac_f32 v198, v11, v131
    v_fmac_f32 v198, v12, v132
    v_mfma_f32_32x32x16_bf16 v[32:47], v[72:75], v[184:187], v[32:47]
    v_fmac_f32 v198, v13, v133
    v_fmac_f32 v198, v14, v134
    v_fmac_f32 v198, v15, v135
    v_mul_f32 v200, v16, v128
    v_fmac_f32 v200, v17, v129
    v_permlane32_swap_b32 v196, v198
    v_mfma_f32_32x32x16_bf16 v[48:63], v[76:79], v[184:187], v[48:63]
    s_waitcnt vmcnt(6)
    ds_read_b64_tr_b16 v[176:177], v244 offset:6144
    ds_read_b64_tr_b16 v[178:179], v244 offset:7168
    ds_read_b64_tr_b16 v[180:181], v245 offset:6144
    ds_read_b64_tr_b16 v[182:183], v245 offset:7168
    v_fmac_f32 v200, v18, v130
    v_fmac_f32 v200, v19, v131
    v_fmac_f32 v200, v20, v132
    v_fmac_f32 v200, v21, v133
    v_fmac_f32 v200, v22, v134
    v_fmac_f32 v200, v23, v135
    v_mfma_f32_32x32x16_bf16 v[32:47], v[80:83], v[188:191], v[32:47]
    v_add_f32 v198, v196, v198
    v_mul_f32_e64 v202, v24, -v128
    v_fma_f32 v202, v25, -v129, v202
    v_fma_f32 v202, v26, -v130, v202
    v_fma_f32 v202, v27, -v131, v202
    v_fma_f32 v202, v28, -v132, v202
    v_mfma_f32_32x32x16_bf16 v[48:63], v[84:87], v[188:191], v[48:63]
    v_fma_f32 v202, v29, -v133, v202
    v_fma_f32 v202, v30, -v134, v202
    v_fma_f32 v202, v31, -v135, v202
    s_nop 1
    v_permlane32_swap_b32 v200, v202
    v_add_f32 v202, v200, v202
    s_waitcnt vmcnt(4) lgkmcnt(0)
    v_mfma_f32_32x32x16_bf16 v[0:15], v[64:67], v[176:179], 0
    v_mul_f32 v197, v32, v104
    v_fmac_f32 v197, v33, v105
    v_fmac_f32 v197, v34, v106
    v_fmac_f32 v197, v35, v107
    v_fmac_f32 v197, v36, v108
    v_fmac_f32 v197, v37, v109
    v_fmac_f32 v197, v38, v110
    s_add_u32 m0, s21, 6144
    v_mfma_f32_32x32x16_bf16 v[16:31], v[68:71], v[176:179], 0
    buffer_load_dwordx4 v236, s[4:7], s36 offen  lds
    buffer_load_dwordx4 v237, s[8:11], s36 offen offset:1024  lds
    ds_read_b64_tr_b16 v[176:177], v244 offset:0
    ds_read_b64_tr_b16 v[178:179], v244 offset:1024
    ds_read_b64_tr_b16 v[184:185], v245 offset:0
    ds_read_b64_tr_b16 v[186:187], v245 offset:1024
    v_fmac_f32 v197, v39, v111
    v_mul_f32 v199, v40, v136
    v_fmac_f32 v199, v41, v137
    v_fmac_f32 v199, v42, v138
    v_fmac_f32 v199, v43, v139
    v_fmac_f32 v199, v44, v140
    v_fmac_f32 v199, v45, v141
    s_waitcnt vmcnt(4) lgkmcnt(0)
    v_mfma_f32_32x32x16_bf16 v[0:15], v[72:75], v[176:179], v[0:15]
    v_fmac_f32 v199, v46, v142
    v_fmac_f32 v199, v47, v143
    v_mul_f32 v201, v48, v136
    v_fmac_f32 v201, v49, v137
    v_permlane32_swap_b32 v197, v199
    v_fmac_f32 v201, v50, v138
    v_fmac_f32 v201, v51, v139
    s_add_u32 m0, s21, 0
    v_mfma_f32_32x32x16_bf16 v[16:31], v[76:79], v[176:179], v[16:31]
    buffer_load_dwordx4 v238, s[4:7], s36 offen  lds
    buffer_load_dwordx4 v239, s[8:11], s36 offen offset:1024  lds
    ds_read_b64_tr_b16 v[176:177], v244 offset:2048
    ds_read_b64_tr_b16 v[178:179], v244 offset:3072
    ds_read_b64_tr_b16 v[188:189], v245 offset:2048
    ds_read_b64_tr_b16 v[190:191], v245 offset:3072
    v_fmac_f32 v201, v52, v140
    v_fmac_f32 v201, v53, v141
    v_fmac_f32 v201, v54, v142
    v_fmac_f32 v201, v55, v143
    v_add_f32 v199, v197, v199
    v_mul_f32_e64 v203, v56, -v136
    v_fma_f32 v203, v57, -v137, v203
    s_waitcnt lgkmcnt(0)
    v_mfma_f32_32x32x16_bf16 v[0:15], v[80:83], v[176:179], v[0:15]
    v_fma_f32 v203, v58, -v138, v203
    v_fma_f32 v203, v59, -v139, v203
    v_fma_f32 v203, v60, -v140, v203
    v_fma_f32 v203, v61, -v141, v203
    v_fma_f32 v203, v62, -v142, v203
    v_fma_f32 v203, v63, -v143, v203
    s_nop 1
    s_add_u32 m0, s21, 2048
    v_mfma_f32_32x32x16_bf16 v[16:31], v[84:87], v[176:179], v[16:31]
    buffer_load_dwordx4 v234, s[4:7], s37 offen  lds
    buffer_load_dwordx4 v235, s[8:11], s37 offen offset:1024  lds
    v_add_u32 v252, s42, v247
    ds_read_u16 v234, v252
    ds_read_u16 v235, v252 offset:64
    v_permlane32_swap_b32 v201, v203
    v_add_f32 v203, v201, v203
    s_set_gpr_idx_on s51, gpr_idx(DST)
    s_nop 0
    v_cvt_pk_bf16_f32 v204, v198, v199
    v_cvt_pk_bf16_f32 v205, v202, v203
    s_set_gpr_idx_off
    v_mfma_f32_32x32x16_bf16 v[32:47], v[64:67], v[180:183], 0
    v_mul_f32 v196, v0, v144
    v_fmac_f32 v196, v1, v145
    v_fmac_f32 v196, v2, v146
    v_fmac_f32 v196, v3, v147
    v_fmac_f32 v196, v4, v148
    v_fmac_f32 v196, v5, v149
    v_mfma_f32_32x32x16_bf16 v[48:63], v[68:71], v[180:183], 0
    v_add_u32 v253, s47, v248
    ds_read_b32 v254, v253
    ds_read_b32 v255, v253 offset:256
    v_fmac_f32 v196, v6, v150
    v_fmac_f32 v196, v7, v151
    v_mul_f32 v198, v8, v112
    v_fmac_f32 v198, v9, v113
    v_fmac_f32 v198, v10, v114
    v_mfma_f32_32x32x16_bf16 v[32:47], v[72:75], v[184:187], v[32:47]
    v_fmac_f32 v198, v11, v115
    v_fmac_f32 v198, v12, v116
    v_fmac_f32 v198, v13, v117
    v_fmac_f32 v198, v14, v118
    v_fmac_f32 v198, v15, v119
    v_mfma_f32_32x32x16_bf16 v[48:63], v[76:79], v[184:187], v[48:63]
    s_waitcnt vmcnt(6)
    ds_read_b64_tr_b16 v[176:177], v244 offset:4096
    ds_read_b64_tr_b16 v[178:179], v244 offset:5120
    ds_read_b64_tr_b16 v[180:181], v245 offset:4096
    ds_read_b64_tr_b16 v[182:183], v245 offset:5120
    v_mul_f32_e64 v200, v16, -v160
    v_fma_f32 v200, v17, -v161, v200
    v_fma_f32 v200, v18, -v162, v200
    v_fma_f32 v200, v19, -v163, v200
    v_fma_f32 v200, v20, -v164, v200
    v_fma_f32 v200, v21, -v165, v200
    v_mfma_f32_32x32x16_bf16 v[32:47], v[80:83], v[188:191], v[32:47]
    v_fma_f32 v200, v22, -v166, v200
    v_fma_f32 v200, v23, -v167, v200
    v_mul_f32_e64 v202, v24, -v160
    v_fma_f32 v202, v25, -v161, v202
    v_fma_f32 v202, v26, -v162, v202
    v_mfma_f32_32x32x16_bf16 v[48:63], v[84:87], v[188:191], v[48:63]
    v_fma_f32 v202, v27, -v163, v202
    v_fma_f32 v202, v28, -v164, v202
    v_fma_f32 v202, v29, -v165, v202
    v_fma_f32 v202, v30, -v166, v202
    v_fma_f32 v202, v31, -v167, v202
    s_waitcnt vmcnt(4) lgkmcnt(0)
    v_mfma_f32_32x32x16_bf16 v[0:15], v[64:67], v[176:179], 0
    v_mul_f32 v197, v32, v152
    v_fmac_f32 v197, v33, v153
    v_fmac_f32 v197, v34, v154
    v_fmac_f32 v197, v35, v155
    v_fmac_f32 v197, v36, v156
    v_fmac_f32 v197, v37, v157
    s_add_u32 m0, s21, 4096
    v_mfma_f32_32x32x16_bf16 v[16:31], v[68:71], v[176:179], 0
    buffer_load_dwordx4 v236, s[4:7], s37 offen  lds
    buffer_load_dwordx4 v237, s[8:11], s37 offen offset:1024  lds
    ds_read_b64_tr_b16 v[176:177], v244 offset:6144
    ds_read_b64_tr_b16 v[178:179], v244 offset:7168
    ds_read_b64_tr_b16 v[184:185], v245 offset:6144
    ds_read_b64_tr_b16 v[186:187], v245 offset:7168
    v_add_u32 v252, s43, v247
    ds_read_u16 v236, v252
    ds_read_u16 v237, v252 offset:64
    v_fmac_f32 v197, v38, v158
    v_fmac_f32 v197, v39, v159
    v_mul_f32 v199, v40, v120
    v_fmac_f32 v199, v41, v121
    v_fmac_f32 v199, v42, v122
    s_waitcnt vmcnt(4) lgkmcnt(2)
    v_mfma_f32_32x32x16_bf16 v[0:15], v[72:75], v[176:179], v[0:15]
    v_fmac_f32 v199, v43, v123
    v_fmac_f32 v199, v44, v124
    v_fmac_f32 v199, v45, v125
    v_fmac_f32 v199, v46, v126
    v_fmac_f32 v199, v47, v127
    s_add_u32 m0, s21, 6144
    v_mfma_f32_32x32x16_bf16 v[16:31], v[76:79], v[176:179], v[16:31]
    buffer_load_dwordx4 v238, s[4:7], s37 offen  lds
    buffer_load_dwordx4 v239, s[8:11], s37 offen offset:1024  lds
    ds_read_b64_tr_b16 v[176:177], v244 offset:0
    ds_read_b64_tr_b16 v[178:179], v244 offset:1024
    ds_read_b64_tr_b16 v[188:189], v245 offset:0
    ds_read_b64_tr_b16 v[190:191], v245 offset:1024
    v_add_u32 v252, s44, v247
    ds_read_u16 v238, v252
    ds_read_u16 v239, v252 offset:64
    v_mul_f32_e64 v201, v48, -v168
    v_fma_f32 v201, v49, -v169, v201
    v_fma_f32 v201, v50, -v170, v201
    v_fma_f32 v201, v51, -v171, v201
    v_fma_f32 v201, v52, -v172, v201
    v_fma_f32 v201, v53, -v173, v201
    s_waitcnt lgkmcnt(2)
    v_mfma_f32_32x32x16_bf16 v[0:15], v[80:83], v[176:179], v[0:15]
    v_fma_f32 v201, v54, -v174, v201
    v_fma_f32 v201, v55, -v175, v201
    v_mul_f32_e64 v203, v56, -v168
    v_fma_f32 v203, v57, -v169, v203
    v_fma_f32 v203, v58, -v170, v203
    s_add_u32 m0, s21, 0
    v_mfma_f32_32x32x16_bf16 v[16:31], v[84:87], v[176:179], v[16:31]
    v_lshl_add_u32 v234, v234, 10, v246
    v_lshl_add_u32 v235, v235, 10, v246
    buffer_load_dwordx4 v234, s[4:7], s38 offen  lds
    buffer_load_dwordx4 v235, s[8:11], s38 offen offset:1024  lds
    s_mov_b32 m0, s76
    s_mov_b64 exec, s[72:73]
    buffer_load_dwordx4 v254, s[12:15], 0 offen  lds
    s_mov_b32 m0, s77
    s_mov_b64 exec, s[74:75]
    buffer_load_dwordx4 v255, s[12:15], 0 offen  lds
    s_mov_b64 exec, -1
    v_fma_f32 v203, v59, -v171, v203
    v_fma_f32 v203, v60, -v172, v203
    v_fma_f32 v203, v61, -v173, v203
    v_fma_f32 v203, v62, -v174, v203
    v_fma_f32 v203, v63, -v175, v203
    v_mfma_f32_32x32x16_bf16 v[32:47], v[64:67], v[180:183], 0
    v_mul_f32 v254, v0, v144
    v_fmac_f32 v254, v1, v145
    v_fmac_f32 v254, v2, v146
    v_mfma_f32_32x32x16_bf16 v[48:63], v[68:71], v[180:183], 0
    ds_swizzle_b32 v68, v68 offset:0x401F
    ds_swizzle_b32 v69, v69 offset:0x401F
    ds_swizzle_b32 v70, v70 offset:0x401F
    ds_swizzle_b32 v71, v71 offset:0x401F
    v_fmac_f32 v254, v3, v147
    v_fmac_f32 v254, v4, v148
    v_fmac_f32 v254, v5, v149
    v_mfma_f32_32x32x16_bf16 v[32:47], v[72:75], v[184:187], v[32:47]
    v_fmac_f32 v254, v6, v150
    v_fmac_f32 v254, v7, v151
    v_fmac_f32 v200, v8, v160
    v_mfma_f32_32x32x16_bf16 v[48:63], v[76:79], v[184:187], v[48:63]
    ds_swizzle_b32 v76, v76 offset:0x401F
    ds_swizzle_b32 v77, v77 offset:0x401F
    ds_swizzle_b32 v78, v78 offset:0x401F
    ds_swizzle_b32 v79, v79 offset:0x401F
    s_waitcnt vmcnt(8)
    ds_read_b64_tr_b16 v[176:177], v244 offset:2048
    ds_read_b64_tr_b16 v[178:179], v244 offset:3072
    ds_read_b64_tr_b16 v[180:181], v245 offset:2048
    ds_read_b64_tr_b16 v[182:183], v245 offset:3072
    v_fmac_f32 v200, v9, v161
    v_permlane32_swap_b32 v196, v254
    v_fmac_f32 v200, v10, v162
    v_mfma_f32_32x32x16_bf16 v[32:47], v[80:83], v[188:191], v[32:47]
    v_fmac_f32 v200, v11, v163
    v_fmac_f32 v200, v12, v164
    v_fmac_f32 v200, v13, v165
    v_mfma_f32_32x32x16_bf16 v[48:63], v[84:87], v[188:191], v[48:63]
    ds_swizzle_b32 v84, v84 offset:0x401F
    ds_swizzle_b32 v85, v85 offset:0x401F
    ds_swizzle_b32 v86, v86 offset:0x401F
    ds_swizzle_b32 v87, v87 offset:0x401F
    v_fmac_f32 v200, v14, v166
    v_fmac_f32 v200, v15, v167
    v_add_f32 v254, v196, v254
    s_waitcnt lgkmcnt(8)
    s_mov_b64 exec, s[56:57]
    v_xor_b32 v68, 0x80008000, v68
    v_xor_b32 v69, 0x80008000, v69
    v_xor_b32 v70, 0x80008000, v70
    v_xor_b32 v71, 0x80008000, v71
    v_xor_b32 v76, 0x80008000, v76
    v_xor_b32 v77, 0x80008000, v77
    v_xor_b32 v78, 0x80008000, v78
    v_xor_b32 v79, 0x80008000, v79
    s_mov_b64 exec, -1
    s_waitcnt vmcnt(6) lgkmcnt(4)
    v_mfma_f32_32x32x16_bf16 v[0:15], v[64:67], v[176:179], 0
    v_mul_f32 v255, v32, v152
    v_fmac_f32 v255, v33, v153
    v_fmac_f32 v255, v34, v154
    v_fmac_f32 v255, v35, v155
    s_add_u32 m0, s21, 2048
    v_mfma_f32_32x32x16_bf16 v[16:31], v[68:71], v[176:179], v[16:31]
    v_lshl_add_u32 v236, v236, 10, v246
    v_lshl_add_u32 v237, v237, 10, v246
    buffer_load_dwordx4 v236, s[4:7], s39 offen  lds
    buffer_load_dwordx4 v237, s[8:11], s39 offen offset:1024  lds
    ds_read_b64_tr_b16 v[176:177], v244 offset:4096
    ds_read_b64_tr_b16 v[178:179], v244 offset:5120
    ds_read_b64_tr_b16 v[184:185], v245 offset:4096
    ds_read_b64_tr_b16 v[186:187], v245 offset:5120
    v_fmac_f32 v255, v36, v156
    v_fmac_f32 v255, v37, v157
    v_fmac_f32 v255, v38, v158
    v_fmac_f32 v255, v39, v159
    s_waitcnt vmcnt(6) lgkmcnt(0)
    v_mfma_f32_32x32x16_bf16 v[0:15], v[72:75], v[176:179], v[0:15]
    v_fmac_f32 v201, v40, v168
    v_fmac_f32 v201, v41, v169
    v_permlane32_swap_b32 v197, v255
    s_add_u32 m0, s21, 4096
    v_mfma_f32_32x32x16_bf16 v[16:31], v[76:79], v[176:179], v[16:31]
    v_lshl_add_u32 v238, v238, 10, v246
    v_lshl_add_u32 v239, v239, 10, v246
    buffer_load_dwordx4 v238, s[4:7], s40 offen  lds
    buffer_load_dwordx4 v239, s[8:11], s40 offen offset:1024  lds
    ds_read_b64_tr_b16 v[176:177], v244 offset:6144
    ds_read_b64_tr_b16 v[178:179], v244 offset:7168
    ds_read_b64_tr_b16 v[188:189], v245 offset:6144
    ds_read_b64_tr_b16 v[190:191], v245 offset:7168
    v_fmac_f32 v201, v42, v170
    v_fmac_f32 v201, v43, v171
    v_fmac_f32 v201, v44, v172
    v_fmac_f32 v201, v45, v173
    s_waitcnt lgkmcnt(0)
    s_mov_b64 exec, s[56:57]
    v_xor_b32 v84, 0x80008000, v84
    v_xor_b32 v85, 0x80008000, v85
    v_xor_b32 v86, 0x80008000, v86
    v_xor_b32 v87, 0x80008000, v87
    s_mov_b64 exec, -1
    v_mfma_f32_32x32x16_bf16 v[0:15], v[80:83], v[176:179], v[0:15]
    v_fmac_f32 v201, v46, v174
    v_fmac_f32 v201, v47, v175
    v_add_f32 v255, v197, v255
    s_set_gpr_idx_on s51, gpr_idx(DST)
    s_nop 0
    v_cvt_pk_bf16_f32 v206, v254, v255
    s_set_gpr_idx_off
    s_add_u32 m0, s21, 6144
    v_mfma_f32_32x32x16_bf16 v[16:31], v[84:87], v[176:179], v[16:31]
    v_lshl_add_u32 v240, v240, 10, v246
    v_lshl_add_u32 v241, v241, 10, v246
    buffer_load_dwordx4 v240, s[4:7], s41 offen  lds
    buffer_load_dwordx4 v241, s[8:11], s41 offen offset:1024  lds
    v_mfma_f32_32x32x16_bf16 v[32:47], v[64:67], v[180:183], 0
    v_mul_f32 v254, v0, v144
    v_fmac_f32 v254, v1, v145
    v_fmac_f32 v254, v2, v146
    v_fmac_f32 v254, v3, v147
    v_fmac_f32 v254, v4, v148
    v_fmac_f32 v254, v5, v149
    v_fmac_f32 v254, v6, v150
    v_mfma_f32_32x32x16_bf16 v[48:63], v[68:71], v[180:183], v[48:63]
    v_fmac_f32 v254, v7, v151
    v_fma_f32 v202, v8, -v160, v202
    v_fma_f32 v202, v9, -v161, v202
    v_permlane32_swap_b32 v254, v200
    v_fma_f32 v202, v10, -v162, v202
    v_fma_f32 v202, v11, -v163, v202
    v_mfma_f32_32x32x16_bf16 v[32:47], v[72:75], v[184:187], v[32:47]
    v_fma_f32 v202, v12, -v164, v202
    v_fma_f32 v202, v13, -v165, v202
    v_fma_f32 v202, v14, -v166, v202
    v_fma_f32 v202, v15, -v167, v202
    v_add_f32 v200, v254, v200
    v_fmac_f32 v198, v16, v112
    v_permlane32_swap_b32 v202, v254
    v_mfma_f32_32x32x16_bf16 v[48:63], v[76:79], v[184:187], v[48:63]
    s_waitcnt vmcnt(8)
    ds_read_b64_tr_b16 v[176:177], v244 offset:0
    ds_read_b64_tr_b16 v[178:179], v244 offset:1024
    ds_read_b64_tr_b16 v[180:181], v245 offset:0
    ds_read_b64_tr_b16 v[182:183], v245 offset:1024
    v_fmac_f32 v198, v17, v113
    v_fmac_f32 v198, v18, v114
    v_fmac_f32 v198, v19, v115
    v_fmac_f32 v198, v20, v116
    v_fmac_f32 v198, v21, v117
    v_fmac_f32 v198, v22, v118
    v_mfma_f32_32x32x16_bf16 v[32:47], v[80:83], v[188:191], v[32:47]
    v_fmac_f32 v198, v23, v119
    v_add_f32 v254, v202, v254
    v_mul_f32 v196, v24, v160
    v_fmac_f32 v196, v25, v161
    v_fmac_f32 v196, v26, v162
    v_fmac_f32 v196, v27, v163
    v_fmac_f32 v196, v28, v164
    v_mfma_f32_32x32x16_bf16 v[48:63], v[84:87], v[188:191], v[48:63]
    v_add_u32 v249, s48, v249
    v_add_u32 v250, s49, v250
    s_waitcnt vmcnt(6)
    ds_read_b64_tr_b16 v[64:65], v249 offset:0
    ds_read_b64_tr_b16 v[68:69], v249 offset:64
    ds_read_b64_tr_b16 v[66:67], v249 offset:256
    ds_read_b64_tr_b16 v[70:71], v249 offset:320
    s_mov_b64 exec, s[54:55]
    ds_read_u16_d16_hi v242, v250 offset:0
    s_mov_b64 exec, -1
    v_fmac_f32 v196, v29, v165
    v_fmac_f32 v196, v30, v166
    v_fmac_f32 v196, v31, v167
    s_nop 1
    v_permlane32_swap_b32 v198, v196
    v_add_f32 v196, v198, v196
    v_mul_f32 v255, v32, v152
    v_fmac_f32 v255, v33, v153
    v_fmac_f32 v255, v34, v154
    v_fmac_f32 v255, v35, v155
    v_fmac_f32 v255, v36, v156
    v_fmac_f32 v255, v37, v157
    v_fmac_f32 v255, v38, v158
    v_fmac_f32 v255, v39, v159
    v_fma_f32 v203, v40, -v168, v203
    v_fma_f32 v203, v41, -v169, v203
    v_permlane32_swap_b32 v255, v201
    v_fma_f32 v203, v42, -v170, v203
    v_fma_f32 v203, v43, -v171, v203
    v_fma_f32 v203, v44, -v172, v203
    v_fma_f32 v203, v45, -v173, v203
    v_fma_f32 v203, v46, -v174, v203
    v_fma_f32 v203, v47, -v175, v203
    v_add_f32 v201, v255, v201
    v_fmac_f32 v199, v48, v120
    v_permlane32_swap_b32 v203, v255
    v_fmac_f32 v199, v49, v121
    v_fmac_f32 v199, v50, v122
    v_fmac_f32 v199, v51, v123
    v_fmac_f32 v199, v52, v124
    v_fmac_f32 v199, v53, v125
    v_fmac_f32 v199, v54, v126
    v_fmac_f32 v199, v55, v127
    v_add_f32 v255, v203, v255
    v_mul_f32 v197, v56, v168
    v_fmac_f32 v197, v57, v169
    v_fmac_f32 v197, v58, v170
    v_fmac_f32 v197, v59, v171
    v_fmac_f32 v197, v60, v172
    v_fmac_f32 v197, v61, v173
    v_fmac_f32 v197, v62, v174
    v_fmac_f32 v197, v63, v175
    s_nop 1
    v_permlane32_swap_b32 v199, v197
    v_add_f32 v197, v199, v197
    s_set_gpr_idx_on s51, gpr_idx(DST)
    s_nop 0
    v_cvt_pk_bf16_f32 v207, v200, v201
    v_cvt_pk_bf16_f32 v209, v254, v255
    v_cvt_pk_bf16_f32 v208, v196, v197
    s_set_gpr_idx_off
    s_add_u32 s50, s50, 1
    s_add_u32 s51, s51, 6
    s_cmp_ge_u32 s50, 4
    s_cbranch_scc1 LAST0
    s_add_u32 s53, s53, 4
    s_xor_b32 s66, s53, s20
    s_bitcmp1_b32 s66, 2
    s_setprio 1
    s_cbranch_scc1 PRIO_8
    s_setprio 0
PRIO_8:
    s_cmp_eq_u32 s52, 4
    s_cbranch_scc1 ITEM_0_4
    s_cmp_eq_u32 s52, 5
    s_cbranch_scc1 ITEM_0_5
    s_cmp_eq_u32 s52, 3
    s_cbranch_scc1 ITEM_0_3
    s_cmp_eq_u32 s52, 6
    s_cbranch_scc1 ITEM_0_6
    s_cmp_eq_u32 s52, 8
    s_cbranch_scc1 ITEM_0_8
    s_branch ITEM_0_2
.p2align 6
ITEM_0_8:
    s_mov_b64 exec, s[54:55]
    ds_read_u16_d16_hi v243, v250 offset:128
    s_mov_b64 exec, -1
    ds_read_b64_tr_b16 v[72:73], v249 offset:512
    ds_read_b64_tr_b16 v[76:77], v249 offset:576
    ds_read_b64_tr_b16 v[74:75], v249 offset:768
    ds_read_b64_tr_b16 v[78:79], v249 offset:832
    ds_read_b64_tr_b16 v[80:81], v249 offset:1024
    ds_read_b64_tr_b16 v[84:85], v249 offset:1088
    ds_read_b64_tr_b16 v[82:83], v249 offset:1280
    ds_read_b64_tr_b16 v[86:87], v249 offset:1344
    ds_read_b64_tr_b16 v[88:89], v249 offset:1536
    ds_read_b64_tr_b16 v[92:93], v249 offset:1600
    ds_read_b64_tr_b16 v[90:91], v249 offset:1792
    ds_read_b64_tr_b16 v[94:95], v249 offset:1856
    s_waitcnt lgkmcnt(13)
    v_mul_f32_dpp v196, v242, v64 row_newbcast:0 row_mask:0xf bank_mask:0xf
    v_mul_f32_dpp v197, v242, v65 row_newbcast:1 row_mask:0xf bank_mask:0xf
    v_mul_f32_dpp v198, v242, v64 row_newbcast:8 row_mask:0xf bank_mask:0xf
    v_mul_f32_dpp v199, v242, v65 row_newbcast:9 row_mask:0xf bank_mask:0xf
    v_mul_f32_dpp v200, v242, v68 row_newbcast:2 row_mask:0xf bank_mask:0xf
    v_mul_f32_dpp v201, v242, v69 row_newbcast:3 row_mask:0xf bank_mask:0xf
    v_mul_f32_dpp v202, v242, v68 row_newbcast:10 row_mask:0xf bank_mask:0xf
    v_mul_f32_dpp v203, v242, v69 row_newbcast:11 row_mask:0xf bank_mask:0xf
    v_cvt_pk_bf16_f32 v64, v196, v197
    v_cvt_pk_bf16_f32 v68, v198, v199
    v_cvt_pk_bf16_f32 v65, v200, v201
    v_cvt_pk_bf16_f32 v69, v202, v203
    v_mul_f32_dpp v196, v242, v66 row_newbcast:4 row_mask:0xf bank_mask:0xf
    v_mul_f32_dpp v197, v242, v67 row_newbcast:5 row_mask:0xf bank_mask:0xf
    v_mul_f32_dpp v198, v242, v66 row_newbcast:12 row_mask:0xf bank_mask:0xf
    v_mul_f32_dpp v199, v242, v67 row_newbcast:13 row_mask:0xf bank_mask:0xf
    v_mul_f32_dpp v200, v242, v70 row_newbcast:6 row_mask:0xf bank_mask:0xf
    v_mul_f32_dpp v201, v242, v71 row_newbcast:7 row_mask:0xf bank_mask:0xf
    v_mul_f32_dpp v202, v242, v70 row_newbcast:14 row_mask:0xf bank_mask:0xf
    v_mul_f32_dpp v203, v242, v71 row_newbcast:15 row_mask:0xf bank_mask:0xf
    v_cvt_pk_bf16_f32 v66, v196, v197
    v_cvt_pk_bf16_f32 v70, v198, v199
    v_cvt_pk_bf16_f32 v67, v200, v201
    v_cvt_pk_bf16_f32 v71, v202, v203
    s_mov_b64 exec, s[54:55]
    ds_read_u16_d16_hi v242, v250 offset:256
    s_mov_b64 exec, -1
    s_waitcnt vmcnt(4) lgkmcnt(9)
    v_mfma_f32_32x32x16_bf16 v[0:15], v[64:67], v[176:179], 0
    v_mul_f32_dpp v196, v243, v72 row_newbcast:0 row_mask:0xf bank_mask:0xf
    v_mul_f32_dpp v197, v243, v73 row_newbcast:1 row_mask:0xf bank_mask:0xf
    v_mul_f32_dpp v198, v243, v72 row_newbcast:8 row_mask:0xf bank_mask:0xf
    v_mul_f32_dpp v199, v243, v73 row_newbcast:9 row_mask:0xf bank_mask:0xf
    v_mul_f32_dpp v200, v243, v76 row_newbcast:2 row_mask:0xf bank_mask:0xf
    v_mul_f32_dpp v201, v243, v77 row_newbcast:3 row_mask:0xf bank_mask:0xf
    v_mul_f32_dpp v202, v243, v76 row_newbcast:10 row_mask:0xf bank_mask:0xf
    v_mul_f32_dpp v203, v243, v77 row_newbcast:11 row_mask:0xf bank_mask:0xf
    v_cvt_pk_bf16_f32 v72, v196, v197
    v_cvt_pk_bf16_f32 v76, v198, v199
    v_cvt_pk_bf16_f32 v73, v200, v201
    v_cvt_pk_bf16_f32 v77, v202, v203
    s_add_u32 m0, s21, 0
    v_mfma_f32_32x32x16_bf16 v[16:31], v[68:71], v[176:179], 0
    buffer_load_dwordx4 v234, s[4:7], s35 offen  lds
    buffer_load_dwordx4 v235, s[8:11], s35 offen offset:1024  lds
    ds_read_b64_tr_b16 v[176:177], v244 offset:2048
    ds_read_b64_tr_b16 v[178:179], v244 offset:3072
    ds_read_b64_tr_b16 v[184:185], v245 offset:2048
    ds_read_b64_tr_b16 v[186:187], v245 offset:3072
    v_mul_f32_dpp v196, v243, v74 row_newbcast:4 row_mask:0xf bank_mask:0xf
    v_mul_f32_dpp v197, v243, v75 row_newbcast:5 row_mask:0xf bank_mask:0xf
    v_mul_f32_dpp v198, v243, v74 row_newbcast:12 row_mask:0xf bank_mask:0xf
    v_mul_f32_dpp v199, v243, v75 row_newbcast:13 row_mask:0xf bank_mask:0xf
    v_mul_f32_dpp v200, v243, v78 row_newbcast:6 row_mask:0xf bank_mask:0xf
    v_mul_f32_dpp v201, v243, v79 row_newbcast:7 row_mask:0xf bank_mask:0xf
    v_mul_f32_dpp v202, v243, v78 row_newbcast:14 row_mask:0xf bank_mask:0xf
    v_mul_f32_dpp v203, v243, v79 row_newbcast:15 row_mask:0xf bank_mask:0xf
    v_cvt_pk_bf16_f32 v74, v196, v197
    v_cvt_pk_bf16_f32 v78, v198, v199
    v_cvt_pk_bf16_f32 v75, v200, v201
    v_cvt_pk_bf16_f32 v79, v202, v203
    s_mov_b64 exec, s[54:55]
    ds_read_u16_d16_hi v243, v250 offset:384
    s_mov_b64 exec, -1
    s_waitcnt vmcnt(4) lgkmcnt(1)
    v_mfma_f32_32x32x16_bf16 v[0:15], v[72:75], v[176:179], v[0:15]
    v_mul_f32_dpp v196, v242, v80 row_newbcast:0 row_mask:0xf bank_mask:0xf
    v_mul_f32_dpp v197, v242, v81 row_newbcast:1 row_mask:0xf bank_mask:0xf
    v_mul_f32_dpp v198, v242, v80 row_newbcast:8 row_mask:0xf bank_mask:0xf
    v_mul_f32_dpp v199, v242, v81 row_newbcast:9 row_mask:0xf bank_mask:0xf
    v_mul_f32_dpp v200, v242, v84 row_newbcast:2 row_mask:0xf bank_mask:0xf
    v_mul_f32_dpp v201, v242, v85 row_newbcast:3 row_mask:0xf bank_mask:0xf
    v_mul_f32_dpp v202, v242, v84 row_newbcast:10 row_mask:0xf bank_mask:0xf
    v_mul_f32_dpp v203, v242, v85 row_newbcast:11 row_mask:0xf bank_mask:0xf
    v_cvt_pk_bf16_f32 v80, v196, v197
    v_cvt_pk_bf16_f32 v84, v198, v199
    v_cvt_pk_bf16_f32 v81, v200, v201
    v_cvt_pk_bf16_f32 v85, v202, v203
    s_add_u32 m0, s21, 2048
    v_mfma_f32_32x32x16_bf16 v[16:31], v[76:79], v[176:179], v[16:31]
    buffer_load_dwordx4 v236, s[4:7], s35 offen  lds
    buffer_load_dwordx4 v237, s[8:11], s35 offen offset:1024  lds
    ds_read_b64_tr_b16 v[176:177], v244 offset:4096
    ds_read_b64_tr_b16 v[178:179], v244 offset:5120
    ds_read_b64_tr_b16 v[188:189], v245 offset:4096
    ds_read_b64_tr_b16 v[190:191], v245 offset:5120
    v_mul_f32_dpp v196, v242, v82 row_newbcast:4 row_mask:0xf bank_mask:0xf
    v_mul_f32_dpp v197, v242, v83 row_newbcast:5 row_mask:0xf bank_mask:0xf
    v_mul_f32_dpp v198, v242, v82 row_newbcast:12 row_mask:0xf bank_mask:0xf
    v_mul_f32_dpp v199, v242, v83 row_newbcast:13 row_mask:0xf bank_mask:0xf
    v_mul_f32_dpp v200, v242, v86 row_newbcast:6 row_mask:0xf bank_mask:0xf
    v_mul_f32_dpp v201, v242, v87 row_newbcast:7 row_mask:0xf bank_mask:0xf
    v_mul_f32_dpp v202, v242, v86 row_newbcast:14 row_mask:0xf bank_mask:0xf
    v_mul_f32_dpp v203, v242, v87 row_newbcast:15 row_mask:0xf bank_mask:0xf
    v_cvt_pk_bf16_f32 v82, v196, v197
    v_cvt_pk_bf16_f32 v86, v198, v199
    v_cvt_pk_bf16_f32 v83, v200, v201
    v_cvt_pk_bf16_f32 v87, v202, v203
    s_nop 0
    s_waitcnt vmcnt(4) lgkmcnt(0)
    v_mfma_f32_32x32x16_bf16 v[0:15], v[80:83], v[176:179], v[0:15]
    v_mul_f32_dpp v196, v243, v88 row_newbcast:0 row_mask:0xf bank_mask:0xf
    v_mul_f32_dpp v197, v243, v89 row_newbcast:1 row_mask:0xf bank_mask:0xf
    v_mul_f32_dpp v198, v243, v88 row_newbcast:8 row_mask:0xf bank_mask:0xf
    v_mul_f32_dpp v199, v243, v89 row_newbcast:9 row_mask:0xf bank_mask:0xf
    v_mul_f32_dpp v200, v243, v92 row_newbcast:2 row_mask:0xf bank_mask:0xf
    v_mul_f32_dpp v201, v243, v93 row_newbcast:3 row_mask:0xf bank_mask:0xf
    v_mul_f32_dpp v202, v243, v92 row_newbcast:10 row_mask:0xf bank_mask:0xf
    v_mul_f32_dpp v203, v243, v93 row_newbcast:11 row_mask:0xf bank_mask:0xf
    v_cvt_pk_bf16_f32 v88, v196, v197
    v_cvt_pk_bf16_f32 v92, v198, v199
    v_cvt_pk_bf16_f32 v89, v200, v201
    v_cvt_pk_bf16_f32 v93, v202, v203
    s_add_u32 m0, s21, 4096
    v_mfma_f32_32x32x16_bf16 v[16:31], v[84:87], v[176:179], v[16:31]
    buffer_load_dwordx4 v238, s[4:7], s35 offen  lds
    buffer_load_dwordx4 v239, s[8:11], s35 offen offset:1024  lds
    ds_read_b64_tr_b16 v[176:177], v244 offset:6144
    ds_read_b64_tr_b16 v[178:179], v244 offset:7168
    ds_read_b64_tr_b16 v[192:193], v245 offset:6144
    ds_read_b64_tr_b16 v[194:195], v245 offset:7168
    v_mul_f32_dpp v196, v243, v90 row_newbcast:4 row_mask:0xf bank_mask:0xf
    v_mul_f32_dpp v197, v243, v91 row_newbcast:5 row_mask:0xf bank_mask:0xf
    v_mul_f32_dpp v198, v243, v90 row_newbcast:12 row_mask:0xf bank_mask:0xf
    v_mul_f32_dpp v199, v243, v91 row_newbcast:13 row_mask:0xf bank_mask:0xf
    v_mul_f32_dpp v200, v243, v94 row_newbcast:6 row_mask:0xf bank_mask:0xf
    v_mul_f32_dpp v201, v243, v95 row_newbcast:7 row_mask:0xf bank_mask:0xf
    v_mul_f32_dpp v202, v243, v94 row_newbcast:14 row_mask:0xf bank_mask:0xf
    v_mul_f32_dpp v203, v243, v95 row_newbcast:15 row_mask:0xf bank_mask:0xf
    v_cvt_pk_bf16_f32 v90, v196, v197
    v_cvt_pk_bf16_f32 v94, v198, v199
    v_cvt_pk_bf16_f32 v91, v200, v201
    v_cvt_pk_bf16_f32 v95, v202, v203
    s_nop 0
    s_waitcnt lgkmcnt(0)
    v_mfma_f32_32x32x16_bf16 v[0:15], v[88:91], v[176:179], v[0:15]
    s_add_u32 m0, s21, 6144
    v_mfma_f32_32x32x16_bf16 v[16:31], v[92:95], v[176:179], v[16:31]
    buffer_load_dwordx4 v240, s[4:7], s35 offen  lds
    buffer_load_dwordx4 v241, s[8:11], s35 offen offset:1024  lds
    s_mov_b32 m0, s50
    s_nop 0
    s_movrels_b32 s71, s23
    s_bfe_u32 s46, s71, 0x30012
    s_mov_b32 m0, s46
    s_and_b32 s66, s71, 0x3ffff
    s_movrels_b32 s68, s57
    s_movrels_b32 s69, s61
    s_sub_u32 s48, s66, s47
    s_mov_b32 s47, s66
    s_lshr_b32 s52, s71, 28
    s_lshl_b32 s67, s46, 9
    s_add_u32 s66, s66, s67
    s_sub_u32 s49, s66, s42
    s_mov_b32 s42, s66
    s_bfe_u32 s66, s68, 655360
    s_add_u32 s43, s42, s66
    s_bfe_u32 s39, s69, 655360
    s_bfe_u32 s66, s68, 655370
    s_add_u32 s44, s42, s66
    s_bfe_u32 s40, s69, 655370
    s_bfe_u32 s66, s68, 655380
    s_add_u32 s45, s42, s66
    s_bfe_u32 s41, s69, 655380
    s_and_b32 s66, s46, s33
    s_cselect_b32 s72, -1, 1
    s_cselect_b32 s76, s47, 163712
    s_cmp_ge_u32 s66, 2
    s_cselect_b32 s73, -1, 0
    s_add_u32 s77, s47, 1024
    s_cmp_ge_u32 s66, 4
    s_cselect_b32 s75, -1, 0
    s_cmp_ge_u32 s66, 3
    s_cselect_b32 s74, -1, 1
    s_cselect_b32 s77, s77, 163712
    v_mfma_f32_32x32x16_bf16 v[32:47], v[64:67], v[180:183], 0
    v_mul_f32 v196, v0, v96
    v_fmac_f32 v196, v1, v97
    v_fmac_f32 v196, v2, v98
    v_fmac_f32 v196, v3, v99
    v_fmac_f32 v196, v4, v100
    v_mfma_f32_32x32x16_bf16 v[48:63], v[68:71], v[180:183], 0
    v_fmac_f32 v196, v5, v101
    v_fmac_f32 v196, v6, v102
    v_fmac_f32 v196, v7, v103
    v_mul_f32 v198, v8, v128
    v_fmac_f32 v198, v9, v129
    v_mfma_f32_32x32x16_bf16 v[32:47], v[72:75], v[184:187], v[32:47]
    v_fmac_f32 v198, v10, v130
    v_fmac_f32 v198, v11, v131
    v_fmac_f32 v198, v12, v132
    v_fmac_f32 v198, v13, v133
    v_mfma_f32_32x32x16_bf16 v[48:63], v[76:79], v[184:187], v[48:63]
    v_fmac_f32 v198, v14, v134
    v_fmac_f32 v198, v15, v135
    v_mul_f32 v200, v16, v128
    v_fmac_f32 v200, v17, v129
    v_permlane32_swap_b32 v196, v198
    v_mfma_f32_32x32x16_bf16 v[32:47], v[80:83], v[188:191], v[32:47]
    v_fmac_f32 v200, v18, v130
    v_fmac_f32 v200, v19, v131
    v_fmac_f32 v200, v20, v132
    v_fmac_f32 v200, v21, v133
    v_fmac_f32 v200, v22, v134
    v_mfma_f32_32x32x16_bf16 v[48:63], v[84:87], v[188:191], v[48:63]
    s_waitcnt vmcnt(6)
    ds_read_b64_tr_b16 v[176:177], v244 offset:0
    ds_read_b64_tr_b16 v[178:179], v244 offset:1024
    ds_read_b64_tr_b16 v[180:181], v245 offset:0
    ds_read_b64_tr_b16 v[182:183], v245 offset:1024
    v_fmac_f32 v200, v23, v135
    v_add_f32 v198, v196, v198
    v_mul_f32_e64 v202, v24, -v128
    v_fma_f32 v202, v25, -v129, v202
    v_mfma_f32_32x32x16_bf16 v[32:47], v[88:91], v[192:195], v[32:47]
    v_fma_f32 v202, v26, -v130, v202
    v_fma_f32 v202, v27, -v131, v202
    v_fma_f32 v202, v28, -v132, v202
    v_fma_f32 v202, v29, -v133, v202
    v_fma_f32 v202, v30, -v134, v202
    v_mfma_f32_32x32x16_bf16 v[48:63], v[92:95], v[192:195], v[48:63]
    v_fma_f32 v202, v31, -v135, v202
    s_nop 1
    v_permlane32_swap_b32 v200, v202
    v_add_f32 v202, v200, v202
    s_waitcnt vmcnt(4) lgkmcnt(0)
    v_mfma_f32_32x32x16_bf16 v[0:15], v[64:67], v[176:179], 0
    v_mul_f32 v197, v32, v104
    v_fmac_f32 v197, v33, v105
    v_fmac_f32 v197, v34, v106
    v_fmac_f32 v197, v35, v107
    v_fmac_f32 v197, v36, v108
    v_fmac_f32 v197, v37, v109
    s_add_u32 m0, s21, 0
    v_mfma_f32_32x32x16_bf16 v[16:31], v[68:71], v[176:179], 0
    buffer_load_dwordx4 v234, s[4:7], s36 offen  lds
    buffer_load_dwordx4 v235, s[8:11], s36 offen offset:1024  lds
    ds_read_b64_tr_b16 v[176:177], v244 offset:2048
    ds_read_b64_tr_b16 v[178:179], v244 offset:3072
    ds_read_b64_tr_b16 v[184:185], v245 offset:2048
    ds_read_b64_tr_b16 v[186:187], v245 offset:3072
    v_fmac_f32 v197, v38, v110
    v_fmac_f32 v197, v39, v111
    v_mul_f32 v199, v40, v136
    v_fmac_f32 v199, v41, v137
    v_fmac_f32 v199, v42, v138
    s_waitcnt vmcnt(4) lgkmcnt(0)
    v_mfma_f32_32x32x16_bf16 v[0:15], v[72:75], v[176:179], v[0:15]
    v_fmac_f32 v199, v43, v139
    v_fmac_f32 v199, v44, v140
    v_fmac_f32 v199, v45, v141
    v_fmac_f32 v199, v46, v142
    v_fmac_f32 v199, v47, v143
    s_add_u32 m0, s21, 2048
    v_mfma_f32_32x32x16_bf16 v[16:31], v[76:79], v[176:179], v[16:31]
    buffer_load_dwordx4 v236, s[4:7], s36 offen  lds
    buffer_load_dwordx4 v237, s[8:11], s36 offen offset:1024  lds
    ds_read_b64_tr_b16 v[176:177], v244 offset:4096
    ds_read_b64_tr_b16 v[178:179], v244 offset:5120
    ds_read_b64_tr_b16 v[188:189], v245 offset:4096
    ds_read_b64_tr_b16 v[190:191], v245 offset:5120
    v_mul_f32 v201, v48, v136
    v_fmac_f32 v201, v49, v137
    v_permlane32_swap_b32 v197, v199
    v_fmac_f32 v201, v50, v138
    v_fmac_f32 v201, v51, v139
    s_waitcnt vmcnt(4) lgkmcnt(0)
    v_mfma_f32_32x32x16_bf16 v[0:15], v[80:83], v[176:179], v[0:15]
    v_fmac_f32 v201, v52, v140
    v_fmac_f32 v201, v53, v141
    v_fmac_f32 v201, v54, v142
    v_fmac_f32 v201, v55, v143
    v_add_f32 v199, v197, v199
    v_mul_f32_e64 v203, v56, -v136
    s_add_u32 m0, s21, 4096
    v_mfma_f32_32x32x16_bf16 v[16:31], v[84:87], v[176:179], v[16:31]
    buffer_load_dwordx4 v238, s[4:7], s36 offen  lds
    buffer_load_dwordx4 v239, s[8:11], s36 offen offset:1024  lds
    ds_read_b64_tr_b16 v[176:177], v244 offset:6144
    ds_read_b64_tr_b16 v[178:179], v244 offset:7168
    ds_read_b64_tr_b16 v[192:193], v245 offset:6144
    ds_read_b64_tr_b16 v[194:195], v245 offset:7168
    v_fma_f32 v203, v57, -v137, v203
    v_fma_f32 v203, v58, -v138, v203
    v_fma_f32 v203, v59, -v139, v203
    v_fma_f32 v203, v60, -v140, v203
    v_fma_f32 v203, v61, -v141, v203
    s_waitcnt lgkmcnt(0)
    v_mfma_f32_32x32x16_bf16 v[0:15], v[88:91], v[176:179], v[0:15]
    v_fma_f32 v203, v62, -v142, v203
    v_fma_f32 v203, v63, -v143, v203
    s_nop 1
    v_permlane32_swap_b32 v201, v203
    v_add_f32 v203, v201, v203
    s_add_u32 m0, s21, 6144
    v_mfma_f32_32x32x16_bf16 v[16:31], v[92:95], v[176:179], v[16:31]
    buffer_load_dwordx4 v240, s[4:7], s36 offen  lds
    buffer_load_dwordx4 v241, s[8:11], s36 offen offset:1024  lds
    s_set_gpr_idx_on s51, gpr_idx(DST)
    s_nop 0
    v_cvt_pk_bf16_f32 v204, v198, v199
    v_cvt_pk_bf16_f32 v205, v202, v203
    s_set_gpr_idx_off
    v_mfma_f32_32x32x16_bf16 v[32:47], v[64:67], v[180:183], 0
    v_mul_f32 v196, v0, v144
    v_fmac_f32 v196, v1, v145
    v_fmac_f32 v196, v2, v146
    v_fmac_f32 v196, v3, v147
    v_mfma_f32_32x32x16_bf16 v[48:63], v[68:71], v[180:183], 0
    v_add_u32 v253, s47, v248
    ds_read_b32 v254, v253
    ds_read_b32 v255, v253 offset:256
    v_fmac_f32 v196, v4, v148
    v_fmac_f32 v196, v5, v149
    v_fmac_f32 v196, v6, v150
    v_fmac_f32 v196, v7, v151
    v_mfma_f32_32x32x16_bf16 v[32:47], v[72:75], v[184:187], v[32:47]
    v_mul_f32 v198, v8, v112
    v_fmac_f32 v198, v9, v113
    v_fmac_f32 v198, v10, v114
    v_fmac_f32 v198, v11, v115
    v_mfma_f32_32x32x16_bf16 v[48:63], v[76:79], v[184:187], v[48:63]
    v_fmac_f32 v198, v12, v116
    v_fmac_f32 v198, v13, v117
    v_fmac_f32 v198, v14, v118
    v_fmac_f32 v198, v15, v119
    v_mfma_f32_32x32x16_bf16 v[32:47], v[80:83], v[188:191], v[32:47]
    v_mul_f32_e64 v200, v16, -v160
    v_fma_f32 v200, v17, -v161, v200
    v_fma_f32 v200, v18, -v162, v200
    v_fma_f32 v200, v19, -v163, v200
    v_mfma_f32_32x32x16_bf16 v[48:63], v[84:87], v[188:191], v[48:63]
    s_waitcnt vmcnt(6)
    ds_read_b64_tr_b16 v[176:177], v244 offset:0
    ds_read_b64_tr_b16 v[178:179], v244 offset:1024
    ds_read_b64_tr_b16 v[180:181], v245 offset:0
    ds_read_b64_tr_b16 v[182:183], v245 offset:1024
    v_fma_f32 v200, v20, -v164, v200
    v_fma_f32 v200, v21, -v165, v200
    v_fma_f32 v200, v22, -v166, v200
    v_fma_f32 v200, v23, -v167, v200
    v_mfma_f32_32x32x16_bf16 v[32:47], v[88:91], v[192:195], v[32:47]
    v_mul_f32_e64 v202, v24, -v160
    v_fma_f32 v202, v25, -v161, v202
    v_fma_f32 v202, v26, -v162, v202
    v_fma_f32 v202, v27, -v163, v202
    v_mfma_f32_32x32x16_bf16 v[48:63], v[92:95], v[192:195], v[48:63]
    v_fma_f32 v202, v28, -v164, v202
    v_fma_f32 v202, v29, -v165, v202
    v_fma_f32 v202, v30, -v166, v202
    v_fma_f32 v202, v31, -v167, v202
    s_waitcnt vmcnt(4) lgkmcnt(0)
    v_mfma_f32_32x32x16_bf16 v[0:15], v[64:67], v[176:179], 0
    s_nop 0
    v_mul_f32 v197, v32, v152
    v_fmac_f32 v197, v33, v153
    v_fmac_f32 v197, v34, v154
    v_fmac_f32 v197, v35, v155
    s_add_u32 m0, s21, 0
    v_mfma_f32_32x32x16_bf16 v[16:31], v[68:71], v[176:179], 0
    buffer_load_dwordx4 v234, s[4:7], s37 offen  lds
    buffer_load_dwordx4 v235, s[8:11], s37 offen offset:1024  lds
    ds_read_b64_tr_b16 v[176:177], v244 offset:2048
    ds_read_b64_tr_b16 v[178:179], v244 offset:3072
    ds_read_b64_tr_b16 v[184:185], v245 offset:2048
    ds_read_b64_tr_b16 v[186:187], v245 offset:3072
    v_add_u32 v252, s42, v247
    ds_read_u16 v234, v252
    ds_read_u16 v235, v252 offset:64
    v_fmac_f32 v197, v36, v156
    v_fmac_f32 v197, v37, v157
    v_fmac_f32 v197, v38, v158
    v_fmac_f32 v197, v39, v159
    s_waitcnt vmcnt(4) lgkmcnt(2)
    v_mfma_f32_32x32x16_bf16 v[0:15], v[72:75], v[176:179], v[0:15]
    v_mul_f32 v199, v40, v120
    v_fmac_f32 v199, v41, v121
    v_fmac_f32 v199, v42, v122
    v_fmac_f32 v199, v43, v123
    s_add_u32 m0, s21, 2048
    v_mfma_f32_32x32x16_bf16 v[16:31], v[76:79], v[176:179], v[16:31]
    buffer_load_dwordx4 v236, s[4:7], s37 offen  lds
    buffer_load_dwordx4 v237, s[8:11], s37 offen offset:1024  lds
    ds_read_b64_tr_b16 v[176:177], v244 offset:4096
    ds_read_b64_tr_b16 v[178:179], v244 offset:5120
    ds_read_b64_tr_b16 v[188:189], v245 offset:4096
    ds_read_b64_tr_b16 v[190:191], v245 offset:5120
    v_add_u32 v252, s43, v247
    ds_read_u16 v236, v252
    ds_read_u16 v237, v252 offset:64
    v_fmac_f32 v199, v44, v124
    v_fmac_f32 v199, v45, v125
    v_fmac_f32 v199, v46, v126
    v_fmac_f32 v199, v47, v127
    s_waitcnt vmcnt(4) lgkmcnt(2)
    v_mfma_f32_32x32x16_bf16 v[0:15], v[80:83], v[176:179], v[0:15]
    v_mul_f32_e64 v201, v48, -v168
    v_fma_f32 v201, v49, -v169, v201
    v_fma_f32 v201, v50, -v170, v201
    v_fma_f32 v201, v51, -v171, v201
    s_add_u32 m0, s21, 4096
    v_mfma_f32_32x32x16_bf16 v[16:31], v[84:87], v[176:179], v[16:31]
    buffer_load_dwordx4 v238, s[4:7], s37 offen  lds
    buffer_load_dwordx4 v239, s[8:11], s37 offen offset:1024  lds
    ds_read_b64_tr_b16 v[176:177], v244 offset:6144
    ds_read_b64_tr_b16 v[178:179], v244 offset:7168
    ds_read_b64_tr_b16 v[192:193], v245 offset:6144
    ds_read_b64_tr_b16 v[194:195], v245 offset:7168
    v_add_u32 v252, s44, v247
    ds_read_u16 v238, v252
    ds_read_u16 v239, v252 offset:64
    v_fma_f32 v201, v52, -v172, v201
    v_fma_f32 v201, v53, -v173, v201
    v_fma_f32 v201, v54, -v174, v201
    v_fma_f32 v201, v55, -v175, v201
    s_waitcnt lgkmcnt(2)
    v_mfma_f32_32x32x16_bf16 v[0:15], v[88:91], v[176:179], v[0:15]
    v_mul_f32_e64 v203, v56, -v168
    v_fma_f32 v203, v57, -v169, v203
    v_fma_f32 v203, v58, -v170, v203
    v_fma_f32 v203, v59, -v171, v203
    s_add_u32 m0, s21, 6144
    v_mfma_f32_32x32x16_bf16 v[16:31], v[92:95], v[176:179], v[16:31]
    buffer_load_dwordx4 v240, s[4:7], s37 offen  lds
    buffer_load_dwordx4 v241, s[8:11], s37 offen offset:1024  lds
    v_add_u32 v252, s45, v247
    ds_read_u16 v240, v252
    ds_read_u16 v241, v252 offset:64
    s_mov_b32 m0, s76
    s_mov_b64 exec, s[72:73]
    buffer_load_dwordx4 v254, s[12:15], 0 offen  lds
    s_mov_b32 m0, s77
    s_mov_b64 exec, s[74:75]
    buffer_load_dwordx4 v255, s[12:15], 0 offen  lds
    s_mov_b64 exec, -1
    v_fma_f32 v203, v60, -v172, v203
    v_fma_f32 v203, v61, -v173, v203
    v_fma_f32 v203, v62, -v174, v203
    v_fma_f32 v203, v63, -v175, v203
    v_mfma_f32_32x32x16_bf16 v[32:47], v[64:67], v[180:183], 0
    v_mul_f32 v254, v0, v144
    v_fmac_f32 v254, v1, v145
    v_fmac_f32 v254, v2, v146
    v_mfma_f32_32x32x16_bf16 v[48:63], v[68:71], v[180:183], 0
    ds_swizzle_b32 v68, v68 offset:0x401F
    ds_swizzle_b32 v69, v69 offset:0x401F
    ds_swizzle_b32 v70, v70 offset:0x401F
    ds_swizzle_b32 v71, v71 offset:0x401F
    v_fmac_f32 v254, v3, v147
    v_fmac_f32 v254, v4, v148
    v_mfma_f32_32x32x16_bf16 v[32:47], v[72:75], v[184:187], v[32:47]
    v_fmac_f32 v254, v5, v149
    v_fmac_f32 v254, v6, v150
    v_mfma_f32_32x32x16_bf16 v[48:63], v[76:79], v[184:187], v[48:63]
    ds_swizzle_b32 v76, v76 offset:0x401F
    ds_swizzle_b32 v77, v77 offset:0x401F
    ds_swizzle_b32 v78, v78 offset:0x401F
    ds_swizzle_b32 v79, v79 offset:0x401F
    v_fmac_f32 v254, v7, v151
    v_fmac_f32 v200, v8, v160
    v_mfma_f32_32x32x16_bf16 v[32:47], v[80:83], v[188:191], v[32:47]
    v_fmac_f32 v200, v9, v161
    v_permlane32_swap_b32 v196, v254
    v_fmac_f32 v200, v10, v162
    v_mfma_f32_32x32x16_bf16 v[48:63], v[84:87], v[188:191], v[48:63]
    ds_swizzle_b32 v84, v84 offset:0x401F
    ds_swizzle_b32 v85, v85 offset:0x401F
    ds_swizzle_b32 v86, v86 offset:0x401F
    ds_swizzle_b32 v87, v87 offset:0x401F
    s_waitcnt vmcnt(8)
    ds_read_b64_tr_b16 v[176:177], v244 offset:0
    ds_read_b64_tr_b16 v[178:179], v244 offset:1024
    ds_read_b64_tr_b16 v[180:181], v245 offset:0
    ds_read_b64_tr_b16 v[182:183], v245 offset:1024
    v_fmac_f32 v200, v11, v163
    v_fmac_f32 v200, v12, v164
    v_mfma_f32_32x32x16_bf16 v[32:47], v[88:91], v[192:195], v[32:47]
    v_fmac_f32 v200, v13, v165
    v_fmac_f32 v200, v14, v166
    v_mfma_f32_32x32x16_bf16 v[48:63], v[92:95], v[192:195], v[48:63]
    ds_swizzle_b32 v92, v92 offset:0x401F
    ds_swizzle_b32 v93, v93 offset:0x401F
    ds_swizzle_b32 v94, v94 offset:0x401F
    ds_swizzle_b32 v95, v95 offset:0x401F
    v_fmac_f32 v200, v15, v167
    v_add_f32 v254, v196, v254
    s_waitcnt lgkmcnt(8)
    s_mov_b64 exec, s[56:57]
    v_xor_b32 v68, 0x80008000, v68
    v_xor_b32 v69, 0x80008000, v69
    v_xor_b32 v70, 0x80008000, v70
    v_xor_b32 v71, 0x80008000, v71
    v_xor_b32 v76, 0x80008000, v76
    v_xor_b32 v77, 0x80008000, v77
    v_xor_b32 v78, 0x80008000, v78
    v_xor_b32 v79, 0x80008000, v79
    v_xor_b32 v84, 0x80008000, v84
    v_xor_b32 v85, 0x80008000, v85
    v_xor_b32 v86, 0x80008000, v86
    v_xor_b32 v87, 0x80008000, v87
    s_mov_b64 exec, -1
    s_waitcnt vmcnt(6) lgkmcnt(4)
    v_mfma_f32_32x32x16_bf16 v[0:15], v[64:67], v[176:179], 0
    v_mul_f32 v255, v32, v152
    v_fmac_f32 v255, v33, v153
    v_fmac_f32 v255, v34, v154
    s_add_u32 m0, s21, 0
    v_mfma_f32_32x32x16_bf16 v[16:31], v[68:71], v[176:179], v[16:31]
    v_lshl_add_u32 v234, v234, 10, v246
    v_lshl_add_u32 v235, v235, 10, v246
    buffer_load_dwordx4 v234, s[4:7], s38 offen  lds
    buffer_load_dwordx4 v235, s[8:11], s38 offen offset:1024  lds
    ds_read_b64_tr_b16 v[176:177], v244 offset:2048
    ds_read_b64_tr_b16 v[178:179], v244 offset:3072
    ds_read_b64_tr_b16 v[184:185], v245 offset:2048
    ds_read_b64_tr_b16 v[186:187], v245 offset:3072
    v_fmac_f32 v255, v35, v155
    v_fmac_f32 v255, v36, v156
    v_fmac_f32 v255, v37, v157
    s_waitcnt vmcnt(6) lgkmcnt(0)
    v_mfma_f32_32x32x16_bf16 v[0:15], v[72:75], v[176:179], v[0:15]
    v_fmac_f32 v255, v38, v158
    v_fmac_f32 v255, v39, v159
    v_fmac_f32 v201, v40, v168
    s_add_u32 m0, s21, 2048
    v_mfma_f32_32x32x16_bf16 v[16:31], v[76:79], v[176:179], v[16:31]
    v_lshl_add_u32 v236, v236, 10, v246
    v_lshl_add_u32 v237, v237, 10, v246
    buffer_load_dwordx4 v236, s[4:7], s39 offen  lds
    buffer_load_dwordx4 v237, s[8:11], s39 offen offset:1024  lds
    ds_read_b64_tr_b16 v[176:177], v244 offset:4096
    ds_read_b64_tr_b16 v[178:179], v244 offset:5120
    ds_read_b64_tr_b16 v[188:189], v245 offset:4096
    ds_read_b64_tr_b16 v[190:191], v245 offset:5120
    v_fmac_f32 v201, v41, v169
    v_permlane32_swap_b32 v197, v255
    s_waitcnt vmcnt(6) lgkmcnt(0)
    v_mfma_f32_32x32x16_bf16 v[0:15], v[80:83], v[176:179], v[0:15]
    v_fmac_f32 v201, v42, v170
    v_fmac_f32 v201, v43, v171
    v_fmac_f32 v201, v44, v172
    s_add_u32 m0, s21, 4096
    v_mfma_f32_32x32x16_bf16 v[16:31], v[84:87], v[176:179], v[16:31]
    v_lshl_add_u32 v238, v238, 10, v246
    v_lshl_add_u32 v239, v239, 10, v246
    buffer_load_dwordx4 v238, s[4:7], s40 offen  lds
    buffer_load_dwordx4 v239, s[8:11], s40 offen offset:1024  lds
    ds_read_b64_tr_b16 v[176:177], v244 offset:6144
    ds_read_b64_tr_b16 v[178:179], v244 offset:7168
    ds_read_b64_tr_b16 v[192:193], v245 offset:6144
    ds_read_b64_tr_b16 v[194:195], v245 offset:7168
    v_fmac_f32 v201, v45, v173
    v_fmac_f32 v201, v46, v174
    v_fmac_f32 v201, v47, v175
    s_waitcnt lgkmcnt(0)
    s_mov_b64 exec, s[56:57]
    v_xor_b32 v92, 0x80008000, v92
    v_xor_b32 v93, 0x80008000, v93
    v_xor_b32 v94, 0x80008000, v94
    v_xor_b32 v95, 0x80008000, v95
    s_mov_b64 exec, -1
    v_mfma_f32_32x32x16_bf16 v[0:15], v[88:91], v[176:179], v[0:15]
    v_add_f32 v255, v197, v255
    s_set_gpr_idx_on s51, gpr_idx(DST)
    s_nop 0
    v_cvt_pk_bf16_f32 v206, v254, v255
    s_set_gpr_idx_off
    s_add_u32 m0, s21, 6144
    v_mfma_f32_32x32x16_bf16 v[16:31], v[92:95], v[176:179], v[16:31]
    v_lshl_add_u32 v240, v240, 10, v246
    v_lshl_add_u32 v241, v241, 10, v246
    buffer_load_dwordx4 v240, s[4:7], s41 offen  lds
    buffer_load_dwordx4 v241, s[8:11], s41 offen offset:1024  lds
    v_mfma_f32_32x32x16_bf16 v[32:47], v[64:67], v[180:183], 0
    v_mul_f32 v254, v0, v144
    v_fmac_f32 v254, v1, v145
    v_fmac_f32 v254, v2, v146
    v_fmac_f32 v254, v3, v147
    v_fmac_f32 v254, v4, v148
    v_mfma_f32_32x32x16_bf16 v[48:63], v[68:71], v[180:183], v[48:63]
    v_fmac_f32 v254, v5, v149
    v_fmac_f32 v254, v6, v150
    v_fmac_f32 v254, v7, v151
    v_fma_f32 v202, v8, -v160, v202
    v_fma_f32 v202, v9, -v161, v202
    v_mfma_f32_32x32x16_bf16 v[32:47], v[72:75], v[184:187], v[32:47]
    v_permlane32_swap_b32 v254, v200
    v_fma_f32 v202, v10, -v162, v202
    v_fma_f32 v202, v11, -v163, v202
    v_fma_f32 v202, v12, -v164, v202
    v_fma_f32 v202, v13, -v165, v202
    v_mfma_f32_32x32x16_bf16 v[48:63], v[76:79], v[184:187], v[48:63]
    v_fma_f32 v202, v14, -v166, v202
    v_fma_f32 v202, v15, -v167, v202
    v_add_f32 v200, v254, v200
    v_fmac_f32 v198, v16, v112
    v_permlane32_swap_b32 v202, v254
    v_mfma_f32_32x32x16_bf16 v[32:47], v[80:83], v[188:191], v[32:47]
    v_fmac_f32 v198, v17, v113
    v_fmac_f32 v198, v18, v114
    v_fmac_f32 v198, v19, v115
    v_fmac_f32 v198, v20, v116
    v_fmac_f32 v198, v21, v117
    v_mfma_f32_32x32x16_bf16 v[48:63], v[84:87], v[188:191], v[48:63]
    s_waitcnt vmcnt(6)
    ds_read_b64_tr_b16 v[176:177], v244 offset:0
    ds_read_b64_tr_b16 v[178:179], v244 offset:1024
    ds_read_b64_tr_b16 v[180:181], v245 offset:0
    ds_read_b64_tr_b16 v[182:183], v245 offset:1024
    v_fmac_f32 v198, v22, v118
    v_fmac_f32 v198, v23, v119
    v_add_f32 v254, v202, v254
    v_mul_f32 v196, v24, v160
    v_fmac_f32 v196, v25, v161
    v_mfma_f32_32x32x16_bf16 v[32:47], v[88:91], v[192:195], v[32:47]
    v_fmac_f32 v196, v26, v162
    v_fmac_f32 v196, v27, v163
    v_fmac_f32 v196, v28, v164
    v_fmac_f32 v196, v29, v165
    v_fmac_f32 v196, v30, v166
    v_mfma_f32_32x32x16_bf16 v[48:63], v[92:95], v[192:195], v[48:63]
    v_add_u32 v249, s48, v249
    v_add_u32 v250, s49, v250
    ds_read_b64_tr_b16 v[64:65], v249 offset:0
    ds_read_b64_tr_b16 v[68:69], v249 offset:64
    ds_read_b64_tr_b16 v[66:67], v249 offset:256
    ds_read_b64_tr_b16 v[70:71], v249 offset:320
    s_mov_b64 exec, s[54:55]
    ds_read_u16_d16_hi v242, v250 offset:0
    s_mov_b64 exec, -1
    v_fmac_f32 v196, v31, v167
    s_nop 1
    v_permlane32_swap_b32 v198, v196
    v_add_f32 v196, v198, v196
    v_mul_f32 v255, v32, v152
    v_fmac_f32 v255, v33, v153
    v_fmac_f32 v255, v34, v154
    v_fmac_f32 v255, v35, v155
    v_fmac_f32 v255, v36, v156
    v_fmac_f32 v255, v37, v157
    v_fmac_f32 v255, v38, v158
    v_fmac_f32 v255, v39, v159
    v_fma_f32 v203, v40, -v168, v203
    v_fma_f32 v203, v41, -v169, v203
    v_permlane32_swap_b32 v255, v201
    v_fma_f32 v203, v42, -v170, v203
    v_fma_f32 v203, v43, -v171, v203
    v_fma_f32 v203, v44, -v172, v203
    v_fma_f32 v203, v45, -v173, v203
    v_fma_f32 v203, v46, -v174, v203
    v_fma_f32 v203, v47, -v175, v203
    v_add_f32 v201, v255, v201
    v_fmac_f32 v199, v48, v120
    v_permlane32_swap_b32 v203, v255
    v_fmac_f32 v199, v49, v121
    v_fmac_f32 v199, v50, v122
    v_fmac_f32 v199, v51, v123
    v_fmac_f32 v199, v52, v124
    v_fmac_f32 v199, v53, v125
    v_fmac_f32 v199, v54, v126
    v_fmac_f32 v199, v55, v127
    v_add_f32 v255, v203, v255
    v_mul_f32 v197, v56, v168
    v_fmac_f32 v197, v57, v169
    v_fmac_f32 v197, v58, v170
    v_fmac_f32 v197, v59, v171
    v_fmac_f32 v197, v60, v172
    v_fmac_f32 v197, v61, v173
    v_fmac_f32 v197, v62, v174
    v_fmac_f32 v197, v63, v175
    s_nop 1
    v_permlane32_swap_b32 v199, v197
    v_add_f32 v197, v199, v197
    s_set_gpr_idx_on s51, gpr_idx(DST)
    s_nop 0
    v_cvt_pk_bf16_f32 v207, v200, v201
    v_cvt_pk_bf16_f32 v209, v254, v255
    v_cvt_pk_bf16_f32 v208, v196, v197
    s_set_gpr_idx_off
    s_add_u32 s50, s50, 1
    s_add_u32 s51, s51, 6
    s_cmp_ge_u32 s50, 4
    s_cbranch_scc1 LAST0
    s_add_u32 s53, s53, 4
    s_xor_b32 s66, s53, s20
    s_bitcmp1_b32 s66, 2
    s_setprio 1
    s_cbranch_scc1 PRIO_9
    s_setprio 0
PRIO_9:
    s_cmp_eq_u32 s52, 4
    s_cbranch_scc1 ITEM_0_4
    s_cmp_eq_u32 s52, 5
    s_cbranch_scc1 ITEM_0_5
    s_cmp_eq_u32 s52, 3
    s_cbranch_scc1 ITEM_0_3
    s_cmp_eq_u32 s52, 6
    s_cbranch_scc1 ITEM_0_6
    s_cmp_eq_u32 s52, 8
    s_cbranch_scc1 ITEM_0_8
    s_branch ITEM_0_2
.p2align 6
ITEM_0_2:
    s_mov_b32 m0, s50
    s_nop 0
    s_movrels_b32 s71, s23
    s_bfe_u32 s46, s71, 0x30012
    s_mov_b32 m0, s46
    s_and_b32 s66, s71, 0x3ffff
    s_movrels_b32 s68, s57
    s_movrels_b32 s69, s61
    s_sub_u32 s48, s66, s47
    s_mov_b32 s47, s66
    s_lshr_b32 s52, s71, 28
    s_lshl_b32 s67, s46, 9
    s_add_u32 s66, s66, s67
    s_sub_u32 s49, s66, s42
    s_mov_b32 s42, s66
    s_bfe_u32 s66, s68, 655360
    s_add_u32 s43, s42, s66
    s_bfe_u32 s39, s69, 655360
    s_bfe_u32 s66, s68, 655370
    s_add_u32 s44, s42, s66
    s_bfe_u32 s40, s69, 655370
    s_bfe_u32 s66, s68, 655380
    s_add_u32 s45, s42, s66
    s_bfe_u32 s41, s69, 655380
    s_and_b32 s66, s46, s33
    s_cselect_b32 s72, -1, 1
    s_cselect_b32 s76, s47, 163712
    s_cmp_ge_u32 s66, 2
    s_cselect_b32 s73, -1, 0
    s_add_u32 s77, s47, 1024
    s_cmp_ge_u32 s66, 4
    s_cselect_b32 s75, -1, 0
    s_cmp_ge_u32 s66, 3
    s_cselect_b32 s74, -1, 1
    s_cselect_b32 s77, s77, 163712
    v_add_u32 v252, s42, v247
    ds_read_u16 v234, v252
    ds_read_u16 v235, v252 offset:64
    v_add_u32 v252, s43, v247
    ds_read_u16 v236, v252
    ds_read_u16 v237, v252 offset:64
    v_add_u32 v252, s44, v247
    ds_read_u16 v238, v252
    ds_read_u16 v239, v252 offset:64
    v_add_u32 v252, s45, v247
    ds_read_u16 v240, v252
    ds_read_u16 v241, v252 offset:64
    s_waitcnt lgkmcnt(8)
    v_mul_f32_dpp v196, v242, v64 row_newbcast:0 row_mask:0xf bank_mask:0xf
    v_mul_f32_dpp v197, v242, v65 row_newbcast:1 row_mask:0xf bank_mask:0xf
    v_mul_f32_dpp v198, v242, v64 row_newbcast:8 row_mask:0xf bank_mask:0xf
    v_mul_f32_dpp v199, v242, v65 row_newbcast:9 row_mask:0xf bank_mask:0xf
    v_mul_f32_dpp v200, v242, v68 row_newbcast:2 row_mask:0xf bank_mask:0xf
    v_mul_f32_dpp v201, v242, v69 row_newbcast:3 row_mask:0xf bank_mask:0xf
    v_mul_f32_dpp v202, v242, v68 row_newbcast:10 row_mask:0xf bank_mask:0xf
    v_mul_f32_dpp v203, v242, v69 row_newbcast:11 row_mask:0xf bank_mask:0xf
    v_cvt_pk_bf16_f32 v64, v196, v197
    v_cvt_pk_bf16_f32 v68, v198, v199
    v_cvt_pk_bf16_f32 v65, v200, v201
    v_cvt_pk_bf16_f32 v69, v202, v203
    v_mul_f32_dpp v196, v242, v66 row_newbcast:4 row_mask:0xf bank_mask:0xf
    v_mul_f32_dpp v197, v242, v67 row_newbcast:5 row_mask:0xf bank_mask:0xf
    v_mul_f32_dpp v198, v242, v66 row_newbcast:12 row_mask:0xf bank_mask:0xf
    v_mul_f32_dpp v199, v242, v67 row_newbcast:13 row_mask:0xf bank_mask:0xf
    v_mul_f32_dpp v200, v242, v70 row_newbcast:6 row_mask:0xf bank_mask:0xf
    v_mul_f32_dpp v201, v242, v71 row_newbcast:7 row_mask:0xf bank_mask:0xf
    v_mul_f32_dpp v202, v242, v70 row_newbcast:14 row_mask:0xf bank_mask:0xf
    v_mul_f32_dpp v203, v242, v71 row_newbcast:15 row_mask:0xf bank_mask:0xf
    v_cvt_pk_bf16_f32 v66, v196, v197
    v_cvt_pk_bf16_f32 v70, v198, v199
    v_cvt_pk_bf16_f32 v67, v200, v201
    v_cvt_pk_bf16_f32 v71, v202, v203
    s_nop 0
    s_waitcnt lgkmcnt(6)
    v_mfma_f32_32x32x16_bf16 v[0:15], v[64:67], v[176:179], 0
    s_add_u32 m0, s21, 0
    v_mfma_f32_32x32x16_bf16 v[16:31], v[68:71], v[176:179], 0
    v_lshl_add_u32 v234, v234, 10, v246
    v_lshl_add_u32 v235, v235, 10, v246
    buffer_load_dwordx4 v234, s[4:7], s38 offen  lds
    buffer_load_dwordx4 v235, s[8:11], s38 offen offset:1024  lds
    v_mfma_f32_32x32x16_bf16 v[32:47], v[64:67], v[180:183], 0
    s_nop 4
    v_mul_f32 v196, v0, v96
    v_fmac_f32 v196, v1, v97
    v_fmac_f32 v196, v2, v98
    v_fmac_f32 v196, v3, v99
    v_fmac_f32 v196, v4, v100
    v_fmac_f32 v196, v5, v101
    v_fmac_f32 v196, v6, v102
    v_fmac_f32 v196, v7, v103
    v_mul_f32 v198, v8, v128
    v_fmac_f32 v198, v9, v129
    v_fmac_f32 v198, v10, v130
    v_fmac_f32 v198, v11, v131
    v_fmac_f32 v198, v12, v132
    v_fmac_f32 v198, v13, v133
    v_fmac_f32 v198, v14, v134
    v_fmac_f32 v198, v15, v135
    v_mul_f32 v200, v16, v128
    v_fmac_f32 v200, v17, v129
    v_permlane32_swap_b32 v196, v198
    v_mfma_f32_32x32x16_bf16 v[48:63], v[68:71], v[180:183], 0
    s_waitcnt vmcnt(6)
    ds_read_b64_tr_b16 v[176:177], v244 offset:2048
    ds_read_b64_tr_b16 v[178:179], v244 offset:3072
    ds_read_b64_tr_b16 v[180:181], v245 offset:2048
    ds_read_b64_tr_b16 v[182:183], v245 offset:3072
    v_fmac_f32 v200, v18, v130
    v_fmac_f32 v200, v19, v131
    v_fmac_f32 v200, v20, v132
    v_fmac_f32 v200, v21, v133
    v_fmac_f32 v200, v22, v134
    v_fmac_f32 v200, v23, v135
    v_add_f32 v198, v196, v198
    v_mul_f32_e64 v202, v24, -v128
    v_fma_f32 v202, v25, -v129, v202
    v_fma_f32 v202, v26, -v130, v202
    v_fma_f32 v202, v27, -v131, v202
    v_fma_f32 v202, v28, -v132, v202
    v_fma_f32 v202, v29, -v133, v202
    v_fma_f32 v202, v30, -v134, v202
    v_fma_f32 v202, v31, -v135, v202
    s_nop 1
    v_permlane32_swap_b32 v200, v202
    v_add_f32 v202, v200, v202
    s_waitcnt lgkmcnt(0)
    v_mfma_f32_32x32x16_bf16 v[0:15], v[64:67], v[176:179], 0
    v_mul_f32 v197, v32, v104
    v_fmac_f32 v197, v33, v105
    v_fmac_f32 v197, v34, v106
    v_fmac_f32 v197, v35, v107
    v_fmac_f32 v197, v36, v108
    v_fmac_f32 v197, v37, v109
    v_fmac_f32 v197, v38, v110
    v_fmac_f32 v197, v39, v111
    v_mul_f32 v199, v40, v136
    v_fmac_f32 v199, v41, v137
    v_fmac_f32 v199, v42, v138
    v_fmac_f32 v199, v43, v139
    v_fmac_f32 v199, v44, v140
    v_fmac_f32 v199, v45, v141
    v_fmac_f32 v199, v46, v142
    v_fmac_f32 v199, v47, v143
    v_mul_f32 v201, v48, v136
    v_fmac_f32 v201, v49, v137
    v_permlane32_swap_b32 v197, v199
    v_fmac_f32 v201, v50, v138
    v_fmac_f32 v201, v51, v139
    s_add_u32 m0, s21, 2048
    v_mfma_f32_32x32x16_bf16 v[16:31], v[68:71], v[176:179], 0
    v_lshl_add_u32 v236, v236, 10, v246
    v_lshl_add_u32 v237, v237, 10, v246
    buffer_load_dwordx4 v236, s[4:7], s39 offen  lds
    buffer_load_dwordx4 v237, s[8:11], s39 offen offset:1024  lds
    v_fmac_f32 v201, v52, v140
    v_fmac_f32 v201, v53, v141
    v_fmac_f32 v201, v54, v142
    v_fmac_f32 v201, v55, v143
    v_add_f32 v199, v197, v199
    v_mul_f32_e64 v203, v56, -v136
    v_fma_f32 v203, v57, -v137, v203
    v_fma_f32 v203, v58, -v138, v203
    v_fma_f32 v203, v59, -v139, v203
    v_fma_f32 v203, v60, -v140, v203
    v_fma_f32 v203, v61, -v141, v203
    v_fma_f32 v203, v62, -v142, v203
    v_fma_f32 v203, v63, -v143, v203
    s_nop 1
    v_permlane32_swap_b32 v201, v203
    v_add_f32 v203, v201, v203
    s_set_gpr_idx_on s51, gpr_idx(DST)
    s_nop 0
    v_cvt_pk_bf16_f32 v204, v198, v199
    v_cvt_pk_bf16_f32 v205, v202, v203
    s_set_gpr_idx_off
    v_mfma_f32_32x32x16_bf16 v[32:47], v[64:67], v[180:183], 0
    v_mul_f32 v196, v0, v144
    v_fmac_f32 v196, v1, v145
    v_fmac_f32 v196, v2, v146
    v_fmac_f32 v196, v3, v147
    v_fmac_f32 v196, v4, v148
    v_fmac_f32 v196, v5, v149
    v_fmac_f32 v196, v6, v150
    v_fmac_f32 v196, v7, v151
    v_mul_f32 v198, v8, v112
    v_fmac_f32 v198, v9, v113
    v_fmac_f32 v198, v10, v114
    v_fmac_f32 v198, v11, v115
    v_fmac_f32 v198, v12, v116
    v_fmac_f32 v198, v13, v117
    v_fmac_f32 v198, v14, v118
    v_fmac_f32 v198, v15, v119
    v_mfma_f32_32x32x16_bf16 v[48:63], v[68:71], v[180:183], 0
    v_add_u32 v253, s47, v248
    ds_read_b32 v254, v253
    ds_read_b32 v255, v253 offset:256
    s_waitcnt vmcnt(6)
    ds_read_b64_tr_b16 v[176:177], v244 offset:4096
    ds_read_b64_tr_b16 v[178:179], v244 offset:5120
    ds_read_b64_tr_b16 v[180:181], v245 offset:4096
    ds_read_b64_tr_b16 v[182:183], v245 offset:5120
    v_mul_f32_e64 v200, v16, -v160
    v_fma_f32 v200, v17, -v161, v200
    v_fma_f32 v200, v18, -v162, v200
    v_fma_f32 v200, v19, -v163, v200
    v_fma_f32 v200, v20, -v164, v200
    v_fma_f32 v200, v21, -v165, v200
    v_fma_f32 v200, v22, -v166, v200
    v_fma_f32 v200, v23, -v167, v200
    v_mul_f32_e64 v202, v24, -v160
    v_fma_f32 v202, v25, -v161, v202
    v_fma_f32 v202, v26, -v162, v202
    v_fma_f32 v202, v27, -v163, v202
    v_fma_f32 v202, v28, -v164, v202
    v_fma_f32 v202, v29, -v165, v202
    v_fma_f32 v202, v30, -v166, v202
    v_fma_f32 v202, v31, -v167, v202
    s_waitcnt lgkmcnt(0)
    v_mfma_f32_32x32x16_bf16 v[0:15], v[64:67], v[176:179], 0
    v_mul_f32 v197, v32, v152
    v_fmac_f32 v197, v33, v153
    v_fmac_f32 v197, v34, v154
    v_fmac_f32 v197, v35, v155
    v_fmac_f32 v197, v36, v156
    v_fmac_f32 v197, v37, v157
    v_fmac_f32 v197, v38, v158
    v_fmac_f32 v197, v39, v159
    v_mul_f32 v199, v40, v120
    v_fmac_f32 v199, v41, v121
    v_fmac_f32 v199, v42, v122
    v_fmac_f32 v199, v43, v123
    v_fmac_f32 v199, v44, v124
    v_fmac_f32 v199, v45, v125
    v_fmac_f32 v199, v46, v126
    v_fmac_f32 v199, v47, v127
    s_add_u32 m0, s21, 4096
    v_mfma_f32_32x32x16_bf16 v[16:31], v[68:71], v[176:179], 0
    v_lshl_add_u32 v238, v238, 10, v246
    v_lshl_add_u32 v239, v239, 10, v246
    buffer_load_dwordx4 v238, s[4:7], s40 offen  lds
    buffer_load_dwordx4 v239, s[8:11], s40 offen offset:1024  lds
    s_mov_b32 m0, s76
    s_mov_b64 exec, s[72:73]
    buffer_load_dwordx4 v254, s[12:15], 0 offen  lds
    s_mov_b32 m0, s77
    s_mov_b64 exec, s[74:75]
    buffer_load_dwordx4 v255, s[12:15], 0 offen  lds
    s_mov_b64 exec, -1
    v_mul_f32_e64 v201, v48, -v168
    v_fma_f32 v201, v49, -v169, v201
    v_fma_f32 v201, v50, -v170, v201
    v_fma_f32 v201, v51, -v171, v201
    v_fma_f32 v201, v52, -v172, v201
    v_fma_f32 v201, v53, -v173, v201
    v_fma_f32 v201, v54, -v174, v201
    v_fma_f32 v201, v55, -v175, v201
    v_mul_f32_e64 v203, v56, -v168
    v_fma_f32 v203, v57, -v169, v203
    v_fma_f32 v203, v58, -v170, v203
    v_fma_f32 v203, v59, -v171, v203
    v_fma_f32 v203, v60, -v172, v203
    v_fma_f32 v203, v61, -v173, v203
    v_fma_f32 v203, v62, -v174, v203
    v_fma_f32 v203, v63, -v175, v203
    v_mfma_f32_32x32x16_bf16 v[32:47], v[64:67], v[180:183], 0
    v_mul_f32 v254, v0, v144
    v_fmac_f32 v254, v1, v145
    v_fmac_f32 v254, v2, v146
    v_fmac_f32 v254, v3, v147
    v_fmac_f32 v254, v4, v148
    v_fmac_f32 v254, v5, v149
    v_fmac_f32 v254, v6, v150
    v_fmac_f32 v254, v7, v151
    v_fmac_f32 v200, v8, v160
    v_mfma_f32_32x32x16_bf16 v[48:63], v[68:71], v[180:183], 0
    ds_swizzle_b32 v68, v68 offset:0x401F
    ds_swizzle_b32 v69, v69 offset:0x401F
    ds_swizzle_b32 v70, v70 offset:0x401F
    ds_swizzle_b32 v71, v71 offset:0x401F
    s_waitcnt vmcnt(8)
    ds_read_b64_tr_b16 v[176:177], v244 offset:6144
    ds_read_b64_tr_b16 v[178:179], v244 offset:7168
    ds_read_b64_tr_b16 v[180:181], v245 offset:6144
    ds_read_b64_tr_b16 v[182:183], v245 offset:7168
    v_fmac_f32 v200, v9, v161
    v_permlane32_swap_b32 v196, v254
    v_fmac_f32 v200, v10, v162
    v_fmac_f32 v200, v11, v163
    v_fmac_f32 v200, v12, v164
    v_fmac_f32 v200, v13, v165
    v_fmac_f32 v200, v14, v166
    v_fmac_f32 v200, v15, v167
    v_add_f32 v254, v196, v254
    s_waitcnt lgkmcnt(0)
    s_mov_b64 exec, s[56:57]
    v_xor_b32 v68, 0x80008000, v68
    v_xor_b32 v69, 0x80008000, v69
    v_xor_b32 v70, 0x80008000, v70
    v_xor_b32 v71, 0x80008000, v71
    s_mov_b64 exec, -1
    s_nop 0
    v_mfma_f32_32x32x16_bf16 v[0:15], v[64:67], v[176:179], 0
    v_mul_f32 v255, v32, v152
    v_fmac_f32 v255, v33, v153
    v_fmac_f32 v255, v34, v154
    v_fmac_f32 v255, v35, v155
    v_fmac_f32 v255, v36, v156
    v_fmac_f32 v255, v37, v157
    v_fmac_f32 v255, v38, v158
    v_fmac_f32 v255, v39, v159
    v_fmac_f32 v201, v40, v168
    v_fmac_f32 v201, v41, v169
    v_permlane32_swap_b32 v197, v255
    s_add_u32 m0, s21, 6144
    v_mfma_f32_32x32x16_bf16 v[16:31], v[68:71], v[176:179], v[16:31]
    v_lshl_add_u32 v240, v240, 10, v246
    v_lshl_add_u32 v241, v241, 10, v246
    buffer_load_dwordx4 v240, s[4:7], s41 offen  lds
    buffer_load_dwordx4 v241, s[8:11], s41 offen offset:1024  lds
    v_fmac_f32 v201, v42, v170
    v_fmac_f32 v201, v43, v171
    v_fmac_f32 v201, v44, v172
    v_fmac_f32 v201, v45, v173
    v_fmac_f32 v201, v46, v174
    v_fmac_f32 v201, v47, v175
    v_add_f32 v255, v197, v255
    s_set_gpr_idx_on s51, gpr_idx(DST)
    s_nop 0
    v_cvt_pk_bf16_f32 v206, v254, v255
    s_set_gpr_idx_off
    v_mfma_f32_32x32x16_bf16 v[32:47], v[64:67], v[180:183], 0
    v_mul_f32 v254, v0, v144
    v_fmac_f32 v254, v1, v145
    v_fmac_f32 v254, v2, v146
    v_fmac_f32 v254, v3, v147
    v_fmac_f32 v254, v4, v148
    v_fmac_f32 v254, v5, v149
    v_fmac_f32 v254, v6, v150
    v_fmac_f32 v254, v7, v151
    v_fma_f32 v202, v8, -v160, v202
    v_fma_f32 v202, v9, -v161, v202
    v_permlane32_swap_b32 v254, v200
    v_fma_f32 v202, v10, -v162, v202
    v_fma_f32 v202, v11, -v163, v202
    v_fma_f32 v202, v12, -v164, v202
    v_fma_f32 v202, v13, -v165, v202
    v_fma_f32 v202, v14, -v166, v202
    v_fma_f32 v202, v15, -v167, v202
    v_add_f32 v200, v254, v200
    v_fmac_f32 v198, v16, v112
    v_permlane32_swap_b32 v202, v254
    v_mfma_f32_32x32x16_bf16 v[48:63], v[68:71], v[180:183], v[48:63]
    s_waitcnt vmcnt(8)
    ds_read_b64_tr_b16 v[176:177], v244 offset:0
    ds_read_b64_tr_b16 v[178:179], v244 offset:1024
    ds_read_b64_tr_b16 v[180:181], v245 offset:0
    ds_read_b64_tr_b16 v[182:183], v245 offset:1024
    v_add_u32 v249, s48, v249
    v_add_u32 v250, s49, v250
    s_waitcnt vmcnt(2)
    ds_read_b64_tr_b16 v[64:65], v249 offset:0
    ds_read_b64_tr_b16 v[68:69], v249 offset:64
    ds_read_b64_tr_b16 v[66:67], v249 offset:256
    ds_read_b64_tr_b16 v[70:71], v249 offset:320
    s_mov_b64 exec, s[54:55]
    ds_read_u16_d16_hi v242, v250 offset:0
    s_mov_b64 exec, -1
    v_fmac_f32 v198, v17, v113
    v_fmac_f32 v198, v18, v114
    v_fmac_f32 v198, v19, v115
    v_fmac_f32 v198, v20, v116
    v_fmac_f32 v198, v21, v117
    v_fmac_f32 v198, v22, v118
    v_fmac_f32 v198, v23, v119
    v_add_f32 v254, v202, v254
    v_mul_f32 v196, v24, v160
    v_fmac_f32 v196, v25, v161
    v_fmac_f32 v196, v26, v162
    v_fmac_f32 v196, v27, v163
    v_fmac_f32 v196, v28, v164
    v_fmac_f32 v196, v29, v165
    v_fmac_f32 v196, v30, v166
    v_fmac_f32 v196, v31, v167
    s_nop 1
    v_permlane32_swap_b32 v198, v196
    v_add_f32 v196, v198, v196
    v_mul_f32 v255, v32, v152
    v_fmac_f32 v255, v33, v153
    v_fmac_f32 v255, v34, v154
    v_fmac_f32 v255, v35, v155
    v_fmac_f32 v255, v36, v156
    v_fmac_f32 v255, v37, v157
    v_fmac_f32 v255, v38, v158
    v_fmac_f32 v255, v39, v159
    v_fma_f32 v203, v40, -v168, v203
    v_fma_f32 v203, v41, -v169, v203
    v_permlane32_swap_b32 v255, v201
    v_fma_f32 v203, v42, -v170, v203
    v_fma_f32 v203, v43, -v171, v203
    v_fma_f32 v203, v44, -v172, v203
    v_fma_f32 v203, v45, -v173, v203
    v_fma_f32 v203, v46, -v174, v203
    v_fma_f32 v203, v47, -v175, v203
    v_add_f32 v201, v255, v201
    v_fmac_f32 v199, v48, v120
    v_permlane32_swap_b32 v203, v255
    v_fmac_f32 v199, v49, v121
    v_fmac_f32 v199, v50, v122
    v_fmac_f32 v199, v51, v123
    v_fmac_f32 v199, v52, v124
    v_fmac_f32 v199, v53, v125
    v_fmac_f32 v199, v54, v126
    v_fmac_f32 v199, v55, v127
    v_add_f32 v255, v203, v255
    v_mul_f32 v197, v56, v168
    v_fmac_f32 v197, v57, v169
    v_fmac_f32 v197, v58, v170
    v_fmac_f32 v197, v59, v171
    v_fmac_f32 v197, v60, v172
    v_fmac_f32 v197, v61, v173
    v_fmac_f32 v197, v62, v174
    v_fmac_f32 v197, v63, v175
    s_nop 1
    v_permlane32_swap_b32 v199, v197
    v_add_f32 v197, v199, v197
    s_set_gpr_idx_on s51, gpr_idx(DST)
    s_nop 0
    v_cvt_pk_bf16_f32 v207, v200, v201
    v_cvt_pk_bf16_f32 v209, v254, v255
    v_cvt_pk_bf16_f32 v208, v196, v197
    s_set_gpr_idx_off
    s_add_u32 s50, s50, 1
    s_add_u32 s51, s51, 6
    s_cmp_ge_u32 s50, 4
    s_cbranch_scc1 LAST0
    s_add_u32 s53, s53, 4
    s_xor_b32 s66, s53, s20
    s_bitcmp1_b32 s66, 2
    s_setprio 1
    s_cbranch_scc1 PRIO_10
    s_setprio 0
PRIO_10:
    s_cmp_eq_u32 s52, 4
    s_cbranch_scc1 ITEM_0_4
    s_cmp_eq_u32 s52, 5
    s_cbranch_scc1 ITEM_0_5
    s_cmp_eq_u32 s52, 3
    s_cbranch_scc1 ITEM_0_3
    s_cmp_eq_u32 s52, 6
    s_cbranch_scc1 ITEM_0_6
    s_cmp_eq_u32 s52, 8
    s_cbranch_scc1 ITEM_0_8
    s_branch ITEM_0_2
.p2align 6
ITEM_1_4:
    s_mov_b64 exec, s[54:55]
    ds_read_u16_d16_hi v243, v250 offset:128
    s_mov_b64 exec, -1
    ds_read_b64_tr_b16 v[72:73], v249 offset:512
    ds_read_b64_tr_b16 v[76:77], v249 offset:576
    ds_read_b64_tr_b16 v[74:75], v249 offset:768
    ds_read_b64_tr_b16 v[78:79], v249 offset:832
    s_waitcnt lgkmcnt(5)
    v_mul_f32_dpp v196, v242, v64 row_newbcast:0 row_mask:0xf bank_mask:0xf
    v_mul_f32_dpp v197, v242, v65 row_newbcast:1 row_mask:0xf bank_mask:0xf
    v_mul_f32_dpp v198, v242, v64 row_newbcast:8 row_mask:0xf bank_mask:0xf
    v_mul_f32_dpp v199, v242, v65 row_newbcast:9 row_mask:0xf bank_mask:0xf
    v_mul_f32_dpp v200, v242, v68 row_newbcast:2 row_mask:0xf bank_mask:0xf
    v_mul_f32_dpp v201, v242, v69 row_newbcast:3 row_mask:0xf bank_mask:0xf
    v_mul_f32_dpp v202, v242, v68 row_newbcast:10 row_mask:0xf bank_mask:0xf
    v_mul_f32_dpp v203, v242, v69 row_newbcast:11 row_mask:0xf bank_mask:0xf
    v_cvt_pk_bf16_f32 v64, v196, v197
    v_cvt_pk_bf16_f32 v68, v198, v199
    v_cvt_pk_bf16_f32 v65, v200, v201
    v_cvt_pk_bf16_f32 v69, v202, v203
    v_mul_f32_dpp v196, v242, v66 row_newbcast:4 row_mask:0xf bank_mask:0xf
    v_mul_f32_dpp v197, v242, v67 row_newbcast:5 row_mask:0xf bank_mask:0xf
    v_mul_f32_dpp v198, v242, v66 row_newbcast:12 row_mask:0xf bank_mask:0xf
    v_mul_f32_dpp v199, v242, v67 row_newbcast:13 row_mask:0xf bank_mask:0xf
    v_mul_f32_dpp v200, v242, v70 row_newbcast:6 row_mask:0xf bank_mask:0xf
    v_mul_f32_dpp v201, v242, v71 row_newbcast:7 row_mask:0xf bank_mask:0xf
    v_mul_f32_dpp v202, v242, v70 row_newbcast:14 row_mask:0xf bank_mask:0xf
    v_mul_f32_dpp v203, v242, v71 row_newbcast:15 row_mask:0xf bank_mask:0xf
    v_cvt_pk_bf16_f32 v66, v196, v197
    v_cvt_pk_bf16_f32 v70, v198, v199
    v_cvt_pk_bf16_f32 v67, v200, v201
    v_cvt_pk_bf16_f32 v71, v202, v203
    s_nop 0
    s_waitcnt vmcnt(4) lgkmcnt(0)
    v_mfma_f32_32x32x16_bf16 v[0:15], v[64:67], v[176:179], 0
    v_mul_f32_dpp v196, v243, v72 row_newbcast:0 row_mask:0xf bank_mask:0xf
    v_mul_f32_dpp v197, v243, v73 row_newbcast:1 row_mask:0xf bank_mask:0xf
    v_mul_f32_dpp v198, v243, v72 row_newbcast:8 row_mask:0xf bank_mask:0xf
    v_mul_f32_dpp v199, v243, v73 row_newbcast:9 row_mask:0xf bank_mask:0xf
    v_mul_f32_dpp v200, v243, v76 row_newbcast:2 row_mask:0xf bank_mask:0xf
    v_mul_f32_dpp v201, v243, v77 row_newbcast:3 row_mask:0xf bank_mask:0xf
    v_mul_f32_dpp v202, v243, v76 row_newbcast:10 row_mask:0xf bank_mask:0xf
    v_mul_f32_dpp v203, v243, v77 row_newbcast:11 row_mask:0xf bank_mask:0xf
    v_cvt_pk_bf16_f32 v72, v196, v197
    v_cvt_pk_bf16_f32 v76, v198, v199
    v_cvt_pk_bf16_f32 v73, v200, v201
    v_cvt_pk_bf16_f32 v77, v202, v203
    s_add_u32 m0, s21, 0
    v_mfma_f32_32x32x16_bf16 v[16:31], v[68:71], v[176:179], 0
    buffer_load_dwordx4 v234, s[4:7], s36 offen  lds
    buffer_load_dwordx4 v235, s[8:11], s36 offen offset:1024  lds
    ds_read_b64_tr_b16 v[176:177], v244 offset:2048
    ds_read_b64_tr_b16 v[178:179], v244 offset:3072
    ds_read_b64_tr_b16 v[184:185], v245 offset:2048
    ds_read_b64_tr_b16 v[186:187], v245 offset:3072
    v_mul_f32_dpp v196, v243, v74 row_newbcast:4 row_mask:0xf bank_mask:0xf
    v_mul_f32_dpp v197, v243, v75 row_newbcast:5 row_mask:0xf bank_mask:0xf
    v_mul_f32_dpp v198, v243, v74 row_newbcast:12 row_mask:0xf bank_mask:0xf
    v_mul_f32_dpp v199, v243, v75 row_newbcast:13 row_mask:0xf bank_mask:0xf
    v_mul_f32_dpp v200, v243, v78 row_newbcast:6 row_mask:0xf bank_mask:0xf
    v_mul_f32_dpp v201, v243, v79 row_newbcast:7 row_mask:0xf bank_mask:0xf
    v_mul_f32_dpp v202, v243, v78 row_newbcast:14 row_mask:0xf bank_mask:0xf
    v_mul_f32_dpp v203, v243, v79 row_newbcast:15 row_mask:0xf bank_mask:0xf
    v_cvt_pk_bf16_f32 v74, v196, v197
    v_cvt_pk_bf16_f32 v78, v198, v199
    v_cvt_pk_bf16_f32 v75, v200, v201
    v_cvt_pk_bf16_f32 v79, v202, v203
    s_nop 0
    s_waitcnt lgkmcnt(0)
    v_mfma_f32_32x32x16_bf16 v[0:15], v[72:75], v[176:179], v[0:15]
    s_add_u32 m0, s21, 2048
    v_mfma_f32_32x32x16_bf16 v[16:31], v[76:79], v[176:179], v[16:31]
    buffer_load_dwordx4 v236, s[4:7], s36 offen  lds
    buffer_load_dwordx4 v237, s[8:11], s36 offen offset:1024  lds
    s_mov_b32 m0, s50
    s_nop 0
    s_movrels_b32 s71, s23
    s_movrels_b32 s33, s28
    s_and_b32 s70, s33, 0x70
    s_andn2_b32 s33, s33, 0x70
    v_xor_b32 v253, s70, v248
    v_add_u32 v253, s33, v253
    s_bfe_u32 s46, s71, 0x30012
    s_mov_b32 m0, s46
    s_and_b32 s66, s71, 0x3ffff
    s_movrels_b32 s68, s57
    s_movrels_b32 s69, s61
    s_sub_u32 s48, s66, s47
    s_mov_b32 s47, s66
    s_lshr_b32 s52, s71, 28
    s_lshl_b32 s67, s46, 9
    s_add_u32 s66, s66, s67
    s_sub_u32 s49, s66, s42
    s_mov_b32 s42, s66
    s_bfe_u32 s66, s68, 655360
    s_add_u32 s43, s42, s66
    s_bfe_u32 s39, s69, 655360
    s_bfe_u32 s66, s68, 655370
    s_add_u32 s44, s42, s66
    s_bfe_u32 s40, s69, 655370
    s_bfe_u32 s66, s68, 655380
    s_add_u32 s45, s42, s66
    s_bfe_u32 s41, s69, 655380
    v_add_u32 v252, s44, v247
    ds_read_u16 v238, v252
    ds_read_u16 v239, v252 offset:64
    v_add_u32 v252, s45, v247
    ds_read_u16 v240, v252
    ds_read_u16 v241, v252 offset:64
    v_mfma_f32_32x32x16_bf16 v[32:47], v[64:67], v[180:183], 0
    v_mul_f32 v196, v0, v96
    v_fmac_f32 v196, v1, v97
    v_fmac_f32 v196, v2, v98
    v_fmac_f32 v196, v3, v99
    v_fmac_f32 v196, v4, v100
    v_fmac_f32 v196, v5, v101
    v_fmac_f32 v196, v6, v102
    v_fmac_f32 v196, v7, v103
    v_mul_f32 v198, v8, v128
    v_fmac_f32 v198, v9, v129
    v_mfma_f32_32x32x16_bf16 v[48:63], v[68:71], v[180:183], 0
    s_waitcnt vmcnt(6)
    ds_read_b64_tr_b16 v[176:177], v244 offset:4096
    ds_read_b64_tr_b16 v[178:179], v244 offset:5120
    ds_read_b64_tr_b16 v[180:181], v245 offset:4096
    ds_read_b64_tr_b16 v[182:183], v245 offset:5120
    v_fmac_f32 v198, v10, v130
    v_fmac_f32 v198, v11, v131
    v_fmac_f32 v198, v12, v132
    v_fmac_f32 v198, v13, v133
    v_fmac_f32 v198, v14, v134
    v_fmac_f32 v198, v15, v135
    v_mul_f32 v200, v16, v128
    v_fmac_f32 v200, v17, v129
    v_permlane32_swap_b32 v196, v198
    v_mfma_f32_32x32x16_bf16 v[32:47], v[72:75], v[184:187], v[32:47]
    v_fmac_f32 v200, v18, v130
    v_fmac_f32 v200, v19, v131
    v_fmac_f32 v200, v20, v132
    v_fmac_f32 v200, v21, v133
    v_fmac_f32 v200, v22, v134
    v_fmac_f32 v200, v23, v135
    v_add_f32 v198, v196, v198
    v_mul_f32_e64 v202, v24, -v128
    v_fma_f32 v202, v25, -v129, v202
    v_mfma_f32_32x32x16_bf16 v[48:63], v[76:79], v[184:187], v[48:63]
    v_fma_f32 v202, v26, -v130, v202
    v_fma_f32 v202, v27, -v131, v202
    v_fma_f32 v202, v28, -v132, v202
    v_fma_f32 v202, v29, -v133, v202
    v_fma_f32 v202, v30, -v134, v202
    v_fma_f32 v202, v31, -v135, v202
    s_nop 1
    v_permlane32_swap_b32 v200, v202
    v_add_f32 v202, v200, v202
    s_waitcnt vmcnt(4) lgkmcnt(0)
    v_mfma_f32_32x32x16_bf16 v[0:15], v[64:67], v[176:179], 0
    v_mul_f32 v197, v32, v104
    v_fmac_f32 v197, v33, v105
    v_fmac_f32 v197, v34, v106
    v_fmac_f32 v197, v35, v107
    v_fmac_f32 v197, v36, v108
    v_fmac_f32 v197, v37, v109
    v_fmac_f32 v197, v38, v110
    v_fmac_f32 v197, v39, v111
    v_mul_f32 v199, v40, v136
    v_fmac_f32 v199, v41, v137
    s_add_u32 m0, s21, 4096
    v_mfma_f32_32x32x16_bf16 v[16:31], v[68:71], v[176:179], 0
    buffer_load_dwordx4 v234, s[4:7], s37 offen  lds
    buffer_load_dwordx4 v235, s[8:11], s37 offen offset:1024  lds
    ds_read_b64_tr_b16 v[176:177], v244 offset:6144
    ds_read_b64_tr_b16 v[178:179], v244 offset:7168
    ds_read_b64_tr_b16 v[184:185], v245 offset:6144
    ds_read_b64_tr_b16 v[186:187], v245 offset:7168
    v_add_u32 v252, s42, v247
    ds_read_u16 v234, v252
    ds_read_u16 v235, v252 offset:64
    v_fmac_f32 v199, v42, v138
    v_fmac_f32 v199, v43, v139
    v_fmac_f32 v199, v44, v140
    v_fmac_f32 v199, v45, v141
    v_fmac_f32 v199, v46, v142
    v_fmac_f32 v199, v47, v143
    v_mul_f32 v201, v48, v136
    v_fmac_f32 v201, v49, v137
    v_permlane32_swap_b32 v197, v199
    v_fmac_f32 v201, v50, v138
    s_waitcnt lgkmcnt(2)
    v_mfma_f32_32x32x16_bf16 v[0:15], v[72:75], v[176:179], v[0:15]
    v_fmac_f32 v201, v51, v139
    v_fmac_f32 v201, v52, v140
    v_fmac_f32 v201, v53, v141
    v_fmac_f32 v201, v54, v142
    v_fmac_f32 v201, v55, v143
    v_add_f32 v199, v197, v199
    v_mul_f32_e64 v203, v56, -v136
    v_fma_f32 v203, v57, -v137, v203
    v_fma_f32 v203, v58, -v138, v203
    v_fma_f32 v203, v59, -v139, v203
    s_add_u32 m0, s21, 6144
    v_mfma_f32_32x32x16_bf16 v[16:31], v[76:79], v[176:179], v[16:31]
    buffer_load_dwordx4 v236, s[4:7], s37 offen  lds
    buffer_load_dwordx4 v237, s[8:11], s37 offen offset:1024  lds
    v_add_u32 v252, s43, v247
    ds_read_u16 v236, v252
    ds_read_u16 v237, v252 offset:64
    v_fma_f32 v203, v60, -v140, v203
    v_fma_f32 v203, v61, -v141, v203
    v_fma_f32 v203, v62, -v142, v203
    v_fma_f32 v203, v63, -v143, v203
    s_nop 1
    v_permlane32_swap_b32 v201, v203
    v_add_f32 v203, v201, v203
    v_cvt_pk_bf16_f32 v192, v198, v199
    v_cvt_pk_bf16_f32 v193, v202, v203
    v_mfma_f32_32x32x16_bf16 v[32:47], v[64:67], v[180:183], 0
    v_mul_f32 v196, v0, v144
    v_fmac_f32 v196, v1, v145
    v_fmac_f32 v196, v2, v146
    v_fmac_f32 v196, v3, v147
    v_fmac_f32 v196, v4, v148
    v_fmac_f32 v196, v5, v149
    v_fmac_f32 v196, v6, v150
    v_fmac_f32 v196, v7, v151
    v_mfma_f32_32x32x16_bf16 v[48:63], v[68:71], v[180:183], 0
    s_waitcnt vmcnt(6)
    ds_read_b64_tr_b16 v[176:177], v244 offset:0
    ds_read_b64_tr_b16 v[178:179], v244 offset:1024
    ds_read_b64_tr_b16 v[180:181], v245 offset:0
    ds_read_b64_tr_b16 v[182:183], v245 offset:1024
    v_mul_f32 v198, v8, v112
    v_fmac_f32 v198, v9, v113
    v_fmac_f32 v198, v10, v114
    v_fmac_f32 v198, v11, v115
    v_fmac_f32 v198, v12, v116
    v_fmac_f32 v198, v13, v117
    v_fmac_f32 v198, v14, v118
    v_fmac_f32 v198, v15, v119
    v_mfma_f32_32x32x16_bf16 v[32:47], v[72:75], v[184:187], v[32:47]
    v_mul_f32_e64 v200, v16, -v160
    v_fma_f32 v200, v17, -v161, v200
    v_fma_f32 v200, v18, -v162, v200
    v_fma_f32 v200, v19, -v163, v200
    v_fma_f32 v200, v20, -v164, v200
    v_fma_f32 v200, v21, -v165, v200
    v_fma_f32 v200, v22, -v166, v200
    v_fma_f32 v200, v23, -v167, v200
    v_mfma_f32_32x32x16_bf16 v[48:63], v[76:79], v[184:187], v[48:63]
    v_mul_f32_e64 v202, v24, -v160
    v_fma_f32 v202, v25, -v161, v202
    v_fma_f32 v202, v26, -v162, v202
    v_fma_f32 v202, v27, -v163, v202
    v_fma_f32 v202, v28, -v164, v202
    v_fma_f32 v202, v29, -v165, v202
    v_fma_f32 v202, v30, -v166, v202
    v_fma_f32 v202, v31, -v167, v202
    s_waitcnt vmcnt(4) lgkmcnt(0)
    v_mfma_f32_32x32x16_bf16 v[0:15], v[64:67], v[176:179], 0
    v_mul_f32 v197, v32, v152
    v_fmac_f32 v197, v33, v153
    v_fmac_f32 v197, v34, v154
    v_fmac_f32 v197, v35, v155
    v_fmac_f32 v197, v36, v156
    v_fmac_f32 v197, v37, v157
    v_fmac_f32 v197, v38, v158
    v_fmac_f32 v197, v39, v159
    s_add_u32 m0, s21, 0
    s_cmp_eq_u32 s50, 4
    v_mfma_f32_32x32x16_bf16 v[16:31], v[68:71], v[176:179], 0
    s_cbranch_scc1 WL_4_0
    v_lshl_add_u32 v234, v234, 10, v246
    v_lshl_add_u32 v235, v235, 10, v246
    buffer_load_dwordx4 v234, s[4:7], s38 offen  lds
    buffer_load_dwordx4 v235, s[8:11], s38 offen offset:1024  lds
WR_4_0:
    ds_read_b64_tr_b16 v[176:177], v244 offset:2048
    ds_read_b64_tr_b16 v[178:179], v244 offset:3072
    ds_read_b64_tr_b16 v[184:185], v245 offset:2048
    ds_read_b64_tr_b16 v[186:187], v245 offset:3072
    v_mul_f32 v199, v40, v120
    v_fmac_f32 v199, v41, v121
    v_fmac_f32 v199, v42, v122
    v_fmac_f32 v199, v43, v123
    v_fmac_f32 v199, v44, v124
    v_fmac_f32 v199, v45, v125
    v_fmac_f32 v199, v46, v126
    v_fmac_f32 v199, v47, v127
    s_waitcnt lgkmcnt(0)
    v_mfma_f32_32x32x16_bf16 v[0:15], v[72:75], v[176:179], v[0:15]
    v_mul_f32_e64 v201, v48, -v168
    v_fma_f32 v201, v49, -v169, v201
    v_fma_f32 v201, v50, -v170, v201
    v_fma_f32 v201, v51, -v171, v201
    v_fma_f32 v201, v52, -v172, v201
    v_fma_f32 v201, v53, -v173, v201
    v_fma_f32 v201, v54, -v174, v201
    v_fma_f32 v201, v55, -v175, v201
    s_add_u32 m0, s21, 2048
    s_cmp_eq_u32 s50, 4
    v_mfma_f32_32x32x16_bf16 v[16:31], v[76:79], v[176:179], v[16:31]
    s_cbranch_scc1 WL_4_1
    v_lshl_add_u32 v236, v236, 10, v246
    v_lshl_add_u32 v237, v237, 10, v246
    buffer_load_dwordx4 v236, s[4:7], s39 offen  lds
    buffer_load_dwordx4 v237, s[8:11], s39 offen offset:1024  lds
WR_4_1:
    v_mul_f32_e64 v203, v56, -v168
    v_fma_f32 v203, v57, -v169, v203
    v_fma_f32 v203, v58, -v170, v203
    v_fma_f32 v203, v59, -v171, v203
    v_fma_f32 v203, v60, -v172, v203
    v_fma_f32 v203, v61, -v173, v203
    v_fma_f32 v203, v62, -v174, v203
    v_fma_f32 v203, v63, -v175, v203
    v_mfma_f32_32x32x16_bf16 v[32:47], v[64:67], v[180:183], 0
    v_mul_f32 v254, v0, v144
    v_fmac_f32 v254, v1, v145
    v_fmac_f32 v254, v2, v146
    v_fmac_f32 v254, v3, v147
    v_fmac_f32 v254, v4, v148
    v_mfma_f32_32x32x16_bf16 v[48:63], v[68:71], v[180:183], 0
    ds_swizzle_b32 v68, v68 offset:0x401F
    ds_swizzle_b32 v69, v69 offset:0x401F
    ds_swizzle_b32 v70, v70 offset:0x401F
    ds_swizzle_b32 v71, v71 offset:0x401F
    s_waitcnt vmcnt(6)
    ds_read_b64_tr_b16 v[176:177], v244 offset:4096
    ds_read_b64_tr_b16 v[178:179], v244 offset:5120
    ds_read_b64_tr_b16 v[180:181], v245 offset:4096
    ds_read_b64_tr_b16 v[182:183], v245 offset:5120
    v_fmac_f32 v254, v5, v149
    v_fmac_f32 v254, v6, v150
    v_fmac_f32 v254, v7, v151
    v_fmac_f32 v200, v8, v160
    v_mfma_f32_32x32x16_bf16 v[32:47], v[72:75], v[184:187], v[32:47]
    v_fmac_f32 v200, v9, v161
    v_permlane32_swap_b32 v196, v254
    v_fmac_f32 v200, v10, v162
    v_fmac_f32 v200, v11, v163
    v_fmac_f32 v200, v12, v164
    v_mfma_f32_32x32x16_bf16 v[48:63], v[76:79], v[184:187], v[48:63]
    ds_swizzle_b32 v76, v76 offset:0x401F
    ds_swizzle_b32 v77, v77 offset:0x401F
    ds_swizzle_b32 v78, v78 offset:0x401F
    ds_swizzle_b32 v79, v79 offset:0x401F
    v_fmac_f32 v200, v13, v165
    v_fmac_f32 v200, v14, v166
    v_fmac_f32 v200, v15, v167
    v_add_f32 v254, v196, v254
    s_waitcnt lgkmcnt(8)
    s_mov_b64 exec, s[56:57]
    v_xor_b32 v68, 0x80008000, v68
    v_xor_b32 v69, 0x80008000, v69
    v_xor_b32 v70, 0x80008000, v70
    v_xor_b32 v71, 0x80008000, v71
    s_mov_b64 exec, -1
    s_waitcnt vmcnt(4) lgkmcnt(4)
    v_mfma_f32_32x32x16_bf16 v[0:15], v[64:67], v[176:179], 0
    v_mul_f32 v255, v32, v152
    v_fmac_f32 v255, v33, v153
    v_fmac_f32 v255, v34, v154
    v_fmac_f32 v255, v35, v155
    v_fmac_f32 v255, v36, v156
    s_add_u32 m0, s21, 4096
    s_cmp_eq_u32 s50, 4
    v_mfma_f32_32x32x16_bf16 v[16:31], v[68:71], v[176:179], v[16:31]
    s_cbranch_scc1 WL_4_2
    v_lshl_add_u32 v238, v238, 10, v246
    v_lshl_add_u32 v239, v239, 10, v246
    buffer_load_dwordx4 v238, s[4:7], s40 offen  lds
    buffer_load_dwordx4 v239, s[8:11], s40 offen offset:1024  lds
WR_4_2:
    ds_read_b64_tr_b16 v[176:177], v244 offset:6144
    ds_read_b64_tr_b16 v[178:179], v244 offset:7168
    ds_read_b64_tr_b16 v[184:185], v245 offset:6144
    ds_read_b64_tr_b16 v[186:187], v245 offset:7168
    v_fmac_f32 v255, v37, v157
    v_fmac_f32 v255, v38, v158
    v_fmac_f32 v255, v39, v159
    v_fmac_f32 v201, v40, v168
    v_fmac_f32 v201, v41, v169
    s_waitcnt lgkmcnt(0)
    s_mov_b64 exec, s[56:57]
    v_xor_b32 v76, 0x80008000, v76
    v_xor_b32 v77, 0x80008000, v77
    v_xor_b32 v78, 0x80008000, v78
    v_xor_b32 v79, 0x80008000, v79
    s_mov_b64 exec, -1
    v_mfma_f32_32x32x16_bf16 v[0:15], v[72:75], v[176:179], v[0:15]
    v_permlane32_swap_b32 v197, v255
    v_fmac_f32 v201, v42, v170
    v_fmac_f32 v201, v43, v171
    v_fmac_f32 v201, v44, v172
    v_fmac_f32 v201, v45, v173
    s_add_u32 m0, s21, 6144
    s_cmp_eq_u32 s50, 4
    v_mfma_f32_32x32x16_bf16 v[16:31], v[76:79], v[176:179], v[16:31]
    s_cbranch_scc1 WL_4_3
    v_lshl_add_u32 v240, v240, 10, v246
    v_lshl_add_u32 v241, v241, 10, v246
    buffer_load_dwordx4 v240, s[4:7], s41 offen  lds
    buffer_load_dwordx4 v241, s[8:11], s41 offen offset:1024  lds
WR_4_3:
    v_fmac_f32 v201, v46, v174
    v_fmac_f32 v201, v47, v175
    v_add_f32 v255, v197, v255
    v_cvt_pk_bf16_f32 v194, v254, v255
    v_mfma_f32_32x32x16_bf16 v[32:47], v[64:67], v[180:183], 0
    v_mul_f32 v254, v0, v144
    v_fmac_f32 v254, v1, v145
    v_fmac_f32 v254, v2, v146
    v_fmac_f32 v254, v3, v147
    v_fmac_f32 v254, v4, v148
    v_fmac_f32 v254, v5, v149
    v_fmac_f32 v254, v6, v150
    v_fmac_f32 v254, v7, v151
    v_fma_f32 v202, v8, -v160, v202
    v_fma_f32 v202, v9, -v161, v202
    v_mfma_f32_32x32x16_bf16 v[48:63], v[68:71], v[180:183], v[48:63]
    s_waitcnt vmcnt(6)
    ds_read_b64_tr_b16 v[176:177], v244 offset:0
    ds_read_b64_tr_b16 v[178:179], v244 offset:1024
    ds_read_b64_tr_b16 v[180:181], v245 offset:0
    ds_read_b64_tr_b16 v[182:183], v245 offset:1024
    v_permlane32_swap_b32 v254, v200
    v_fma_f32 v202, v10, -v162, v202
    v_fma_f32 v202, v11, -v163, v202
    v_fma_f32 v202, v12, -v164, v202
    v_fma_f32 v202, v13, -v165, v202
    v_fma_f32 v202, v14, -v166, v202
    v_fma_f32 v202, v15, -v167, v202
    v_add_f32 v200, v254, v200
    v_fmac_f32 v198, v16, v112
    v_permlane32_swap_b32 v202, v254
    v_mfma_f32_32x32x16_bf16 v[32:47], v[72:75], v[184:187], v[32:47]
    v_fmac_f32 v198, v17, v113
    v_fmac_f32 v198, v18, v114
    v_fmac_f32 v198, v19, v115
    v_fmac_f32 v198, v20, v116
    v_fmac_f32 v198, v21, v117
    v_fmac_f32 v198, v22, v118
    v_fmac_f32 v198, v23, v119
    v_add_f32 v254, v202, v254
    v_mul_f32 v196, v24, v160
    v_fmac_f32 v196, v25, v161
    v_mfma_f32_32x32x16_bf16 v[48:63], v[76:79], v[184:187], v[48:63]
    v_add_u32 v249, s48, v249
    v_add_u32 v250, s49, v250
    ds_read_b32 v252, v251 offset:16
    ds_read_b64_tr_b16 v[64:65], v249 offset:0
    ds_read_b64_tr_b16 v[68:69], v249 offset:64
    ds_read_b64_tr_b16 v[66:67], v249 offset:256
    ds_read_b64_tr_b16 v[70:71], v249 offset:320
    s_mov_b64 exec, s[54:55]
    ds_read_u16_d16_hi v242, v250 offset:0
    s_mov_b64 exec, -1
    v_fmac_f32 v196, v26, v162
    v_fmac_f32 v196, v27, v163
    v_fmac_f32 v196, v28, v164
    v_fmac_f32 v196, v29, v165
    v_fmac_f32 v196, v30, v166
    v_fmac_f32 v196, v31, v167
    s_nop 1
    v_permlane32_swap_b32 v198, v196
    v_add_f32 v196, v198, v196
    s_cmp_eq_u32 s50, 4
    s_cbranch_scc1 LEPI_0
    v_mul_f32 v255, v32, v152
    v_fmac_f32 v255, v33, v153
    v_fmac_f32 v255, v34, v154
    v_fmac_f32 v255, v35, v155
    v_fmac_f32 v255, v36, v156
    v_fmac_f32 v255, v37, v157
    v_fmac_f32 v255, v38, v158
    v_fmac_f32 v255, v39, v159
    v_fma_f32 v203, v40, -v168, v203
    v_fma_f32 v203, v41, -v169, v203
    v_permlane32_swap_b32 v255, v201
    v_fma_f32 v203, v42, -v170, v203
    v_fma_f32 v203, v43, -v171, v203
    v_fma_f32 v203, v44, -v172, v203
    v_fma_f32 v203, v45, -v173, v203
    v_fma_f32 v203, v46, -v174, v203
    v_fma_f32 v203, v47, -v175, v203
    v_add_f32 v201, v255, v201
    v_fmac_f32 v199, v48, v120
    v_permlane32_swap_b32 v203, v255
    v_fmac_f32 v199, v49, v121
    v_fmac_f32 v199, v50, v122
    v_fmac_f32 v199, v51, v123
    v_fmac_f32 v199, v52, v124
    v_fmac_f32 v199, v53, v125
    v_fmac_f32 v199, v54, v126
    v_fmac_f32 v199, v55, v127
    v_add_f32 v255, v203, v255
    v_mul_f32 v197, v56, v168
    v_fmac_f32 v197, v57, v169
    v_fmac_f32 v197, v58, v170
    v_fmac_f32 v197, v59, v171
    v_fmac_f32 v197, v60, v172
    v_fmac_f32 v197, v61, v173
    v_fmac_f32 v197, v62, v174
    v_fmac_f32 v197, v63, v175
    s_nop 1
    v_permlane32_swap_b32 v199, v197
    v_add_f32 v197, v199, v197
    v_cvt_pk_bf16_f32 v200, v200, v201
    v_cvt_pk_bf16_f32 v254, v254, v255
    v_cvt_pk_bf16_f32 v196, v196, v197
    ds_write2st64_b32 v253, v192, v193 offset0:0 offset1:1
    ds_write2st64_b32 v253, v194, v200 offset0:2 offset1:3
    ds_write_b32 v253, v196 offset:1024
    s_mov_b64 exec, 0xffffffff
    ds_write_b32 v253, v254 offset:1280
    s_mov_b64 exec, -1
    s_add_u32 s50, s50, 1
    s_cmp_ge_u32 s50, 4
    s_cbranch_scc1 LAST1
    s_waitcnt lgkmcnt(9)
    v_readfirstlane_b32 s66, v252
    s_add_u32 s53, s53, 1
    v_mov_b32 v252, s53
    s_cmp_le_u32 s53, s66
    ds_write2_b32 v251, v252, v252 offset0:0 offset1:8
    s_setprio 1
    s_cbranch_scc1 PRIO_11
    s_setprio 0
PRIO_11:
    s_cmp_eq_u32 s52, 4
    s_cbranch_scc1 ITEM_1_4
    s_cmp_eq_u32 s52, 5
    s_cbranch_scc1 ITEM_1_5
    s_cmp_eq_u32 s52, 3
    s_cbranch_scc1 ITEM_1_3
    s_cmp_eq_u32 s52, 6
    s_cbranch_scc1 ITEM_1_6
    s_cmp_eq_u32 s52, 8
    s_cbranch_scc1 ITEM_1_8
    s_branch ITEM_1_2
WL_4_0:
    s_add_u32 s66, s51, 0
    buffer_load_dwordx4 v[96:99], v246, s[16:19], s66 offen offset:2048 sc1
    buffer_load_dwordx4 v[100:103], v246, s[16:19], s66 offen offset:3072 sc1
    s_branch WR_4_0
WL_4_1:
    s_add_u32 s66, s51, 4096
    buffer_load_dwordx4 v[104:107], v246, s[16:19], s66 offen offset:2048 sc1
    buffer_load_dwordx4 v[108:111], v246, s[16:19], s66 offen offset:3072 sc1
    s_branch WR_4_1
WL_4_2:
    s_add_u32 s66, s51, 8192
    buffer_load_dwordx4 v[128:131], v246, s[16:19], s66 offen offset:2048 sc1
    buffer_load_dwordx4 v[132:135], v246, s[16:19], s66 offen offset:3072 sc1
    s_branch WR_4_2
WL_4_3:
    s_add_u32 s66, s51, 12288
    buffer_load_dwordx4 v[136:139], v246, s[16:19], s66 offen offset:2048 sc1
    buffer_load_dwordx4 v[140:143], v246, s[16:19], s66 offen offset:3072 sc1
    s_branch WR_4_3
.p2align 6
ITEM_1_5:
    s_mov_b64 exec, s[54:55]
    ds_read_u16_d16_hi v243, v250 offset:128
    s_mov_b64 exec, -1
    ds_read_b64_tr_b16 v[72:73], v249 offset:512
    ds_read_b64_tr_b16 v[76:77], v249 offset:576
    ds_read_b64_tr_b16 v[74:75], v249 offset:768
    ds_read_b64_tr_b16 v[78:79], v249 offset:832
    ds_read_b64_tr_b16 v[80:81], v249 offset:1024
    ds_read_b64_tr_b16 v[84:85], v249 offset:1088
    s_waitcnt lgkmcnt(7)
    v_mul_f32_dpp v196, v242, v64 row_newbcast:0 row_mask:0xf bank_mask:0xf
    v_mul_f32_dpp v197, v242, v65 row_newbcast:1 row_mask:0xf bank_mask:0xf
    v_mul_f32_dpp v198, v242, v64 row_newbcast:8 row_mask:0xf bank_mask:0xf
    v_mul_f32_dpp v199, v242, v65 row_newbcast:9 row_mask:0xf bank_mask:0xf
    v_mul_f32_dpp v200, v242, v68 row_newbcast:2 row_mask:0xf bank_mask:0xf
    v_mul_f32_dpp v201, v242, v69 row_newbcast:3 row_mask:0xf bank_mask:0xf
    v_mul_f32_dpp v202, v242, v68 row_newbcast:10 row_mask:0xf bank_mask:0xf
    v_mul_f32_dpp v203, v242, v69 row_newbcast:11 row_mask:0xf bank_mask:0xf
    v_cvt_pk_bf16_f32 v64, v196, v197
    v_cvt_pk_bf16_f32 v68, v198, v199
    v_cvt_pk_bf16_f32 v65, v200, v201
    v_cvt_pk_bf16_f32 v69, v202, v203
    v_mul_f32_dpp v196, v242, v66 row_newbcast:4 row_mask:0xf bank_mask:0xf
    v_mul_f32_dpp v197, v242, v67 row_newbcast:5 row_mask:0xf bank_mask:0xf
    v_mul_f32_dpp v198, v242, v66 row_newbcast:12 row_mask:0xf bank_mask:0xf
    v_mul_f32_dpp v199, v242, v67 row_newbcast:13 row_mask:0xf bank_mask:0xf
    v_mul_f32_dpp v200, v242, v70 row_newbcast:6 row_mask:0xf bank_mask:0xf
    v_mul_f32_dpp v201, v242, v71 row_newbcast:7 row_mask:0xf bank_mask:0xf
    v_mul_f32_dpp v202, v242, v70 row_newbcast:14 row_mask:0xf bank_mask:0xf
    v_mul_f32_dpp v203, v242, v71 row_newbcast:15 row_mask:0xf bank_mask:0xf
    v_cvt_pk_bf16_f32 v66, v196, v197
    v_cvt_pk_bf16_f32 v70, v198, v199
    v_cvt_pk_bf16_f32 v67, v200, v201
    v_cvt_pk_bf16_f32 v71, v202, v203
    s_mov_b64 exec, s[54:55]
    ds_read_u16_d16_hi v242, v250 offset:256
    s_mov_b64 exec, -1
    s_waitcnt vmcnt(4) lgkmcnt(3)
    v_mfma_f32_32x32x16_bf16 v[0:15], v[64:67], v[176:179], 0
    v_mul_f32_dpp v196, v243, v72 row_newbcast:0 row_mask:0xf bank_mask:0xf
    v_mul_f32_dpp v197, v243, v73 row_newbcast:1 row_mask:0xf bank_mask:0xf
    v_mul_f32_dpp v198, v243, v72 row_newbcast:8 row_mask:0xf bank_mask:0xf
    v_mul_f32_dpp v199, v243, v73 row_newbcast:9 row_mask:0xf bank_mask:0xf
    v_mul_f32_dpp v200, v243, v76 row_newbcast:2 row_mask:0xf bank_mask:0xf
    v_mul_f32_dpp v201, v243, v77 row_newbcast:3 row_mask:0xf bank_mask:0xf
    v_mul_f32_dpp v202, v243, v76 row_newbcast:10 row_mask:0xf bank_mask:0xf
    v_mul_f32_dpp v203, v243, v77 row_newbcast:11 row_mask:0xf bank_mask:0xf
    v_cvt_pk_bf16_f32 v72, v196, v197
    v_cvt_pk_bf16_f32 v76, v198, v199
    v_cvt_pk_bf16_f32 v73, v200, v201
    v_cvt_pk_bf16_f32 v77, v202, v203
    s_add_u32 m0, s21, 0
    v_mfma_f32_32x32x16_bf16 v[16:31], v[68:71], v[176:179], 0
    buffer_load_dwordx4 v236, s[4:7], s35 offen  lds
    buffer_load_dwordx4 v237, s[8:11], s35 offen offset:1024  lds
    ds_read_b64_tr_b16 v[176:177], v244 offset:2048
    ds_read_b64_tr_b16 v[178:179], v244 offset:3072
    ds_read_b64_tr_b16 v[184:185], v245 offset:2048
    ds_read_b64_tr_b16 v[186:187], v245 offset:3072
    v_mul_f32_dpp v196, v243, v74 row_newbcast:4 row_mask:0xf bank_mask:0xf
    v_mul_f32_dpp v197, v243, v75 row_newbcast:5 row_mask:0xf bank_mask:0xf
    v_mul_f32_dpp v198, v243, v74 row_newbcast:12 row_mask:0xf bank_mask:0xf
    v_mul_f32_dpp v199, v243, v75 row_newbcast:13 row_mask:0xf bank_mask:0xf
    v_mul_f32_dpp v200, v243, v78 row_newbcast:6 row_mask:0xf bank_mask:0xf
    v_mul_f32_dpp v201, v243, v79 row_newbcast:7 row_mask:0xf bank_mask:0xf
    v_mul_f32_dpp v202, v243, v78 row_newbcast:14 row_mask:0xf bank_mask:0xf
    v_mul_f32_dpp v203, v243, v79 row_newbcast:15 row_mask:0xf bank_mask:0xf
    v_cvt_pk_bf16_f32 v74, v196, v197
    v_cvt_pk_bf16_f32 v78, v198, v199
    v_cvt_pk_bf16_f32 v75, v200, v201
    v_cvt_pk_bf16_f32 v79, v202, v203
    s_nop 0
    s_waitcnt vmcnt(4) lgkmcnt(0)
    v_mfma_f32_32x32x16_bf16 v[0:15], v[72:75], v[176:179], v[0:15]
    v_mul_f32_dpp v196, v242, v80 row_newbcast:0 row_mask:0xf bank_mask:0xf
    v_mul_f32_dpp v197, v242, v81 row_newbcast:1 row_mask:0xf bank_mask:0xf
    v_mul_f32_dpp v198, v242, v80 row_newbcast:8 row_mask:0xf bank_mask:0xf
    v_mul_f32_dpp v199, v242, v81 row_newbcast:9 row_mask:0xf bank_mask:0xf
    v_mul_f32_dpp v200, v242, v84 row_newbcast:2 row_mask:0xf bank_mask:0xf
    v_mul_f32_dpp v201, v242, v85 row_newbcast:3 row_mask:0xf bank_mask:0xf
    s_add_u32 m0, s21, 2048
    v_mfma_f32_32x32x16_bf16 v[16:31], v[76:79], v[176:179], v[16:31]
    buffer_load_dwordx4 v238, s[4:7], s35 offen  lds
    ds_read_b64_tr_b16 v[176:177], v244 offset:4096
    ds_read_b64_tr_b16 v[188:189], v245 offset:4096
    v_mul_f32_dpp v202, v242, v84 row_newbcast:10 row_mask:0xf bank_mask:0xf
    v_mul_f32_dpp v203, v242, v85 row_newbcast:11 row_mask:0xf bank_mask:0xf
    v_cvt_pk_bf16_f32 v80, v196, v197
    v_cvt_pk_bf16_f32 v84, v198, v199
    v_cvt_pk_bf16_f32 v81, v200, v201
    v_cvt_pk_bf16_f32 v85, v202, v203
    s_nop 0
    s_waitcnt lgkmcnt(0)
    v_mfma_f32_32x32x8_bf16 v[0:15], v[80:81], v[176:177], v[0:15]
    s_add_u32 m0, s21, 4096
    v_mfma_f32_32x32x8_bf16 v[16:31], v[84:85], v[176:177], v[16:31]
    buffer_load_dwordx4 v234, s[4:7], s36 offen  lds
    buffer_load_dwordx4 v235, s[8:11], s36 offen offset:1024  lds
    s_mov_b32 m0, s50
    s_nop 0
    s_movrels_b32 s71, s23
    s_movrels_b32 s33, s28
    s_and_b32 s70, s33, 0x70
    s_andn2_b32 s33, s33, 0x70
    v_xor_b32 v253, s70, v248
    v_add_u32 v253, s33, v253
    s_bfe_u32 s46, s71, 0x30012
    s_mov_b32 m0, s46
    s_and_b32 s66, s71, 0x3ffff
    s_movrels_b32 s68, s57
    s_movrels_b32 s69, s61
    s_sub_u32 s48, s66, s47
    s_mov_b32 s47, s66
    s_lshr_b32 s52, s71, 28
    s_lshl_b32 s67, s46, 9
    s_add_u32 s66, s66, s67
    s_sub_u32 s49, s66, s42
    s_mov_b32 s42, s66
    s_bfe_u32 s66, s68, 655360
    s_add_u32 s43, s42, s66
    s_bfe_u32 s39, s69, 655360
    s_bfe_u32 s66, s68, 655370
    s_add_u32 s44, s42, s66
    s_bfe_u32 s40, s69, 655370
    s_bfe_u32 s66, s68, 655380
    s_add_u32 s45, s42, s66
    s_bfe_u32 s41, s69, 655380
    v_add_u32 v252, s45, v247
    ds_read_u16 v240, v252
    ds_read_u16 v241, v252 offset:64
    v_mfma_f32_32x32x16_bf16 v[32:47], v[64:67], v[180:183], 0
    v_mul_f32 v196, v0, v96
    v_fmac_f32 v196, v1, v97
    v_fmac_f32 v196, v2, v98
    v_fmac_f32 v196, v3, v99
    v_fmac_f32 v196, v4, v100
    v_fmac_f32 v196, v5, v101
    v_fmac_f32 v196, v6, v102
    v_mfma_f32_32x32x16_bf16 v[48:63], v[68:71], v[180:183], 0
    v_fmac_f32 v196, v7, v103
    v_mul_f32 v198, v8, v128
    v_fmac_f32 v198, v9, v129
    v_fmac_f32 v198, v10, v130
    v_fmac_f32 v198, v11, v131
    v_fmac_f32 v198, v12, v132
    v_mfma_f32_32x32x16_bf16 v[32:47], v[72:75], v[184:187], v[32:47]
    v_fmac_f32 v198, v13, v133
    v_fmac_f32 v198, v14, v134
    v_fmac_f32 v198, v15, v135
    v_mul_f32 v200, v16, v128
    v_fmac_f32 v200, v17, v129
    v_permlane32_swap_b32 v196, v198
    v_mfma_f32_32x32x16_bf16 v[48:63], v[76:79], v[184:187], v[48:63]
    s_waitcnt vmcnt(5)
    ds_read_b64_tr_b16 v[176:177], v244 offset:6144
    ds_read_b64_tr_b16 v[178:179], v244 offset:7168
    ds_read_b64_tr_b16 v[180:181], v245 offset:6144
    ds_read_b64_tr_b16 v[182:183], v245 offset:7168
    v_fmac_f32 v200, v18, v130
    v_fmac_f32 v200, v19, v131
    v_fmac_f32 v200, v20, v132
    v_fmac_f32 v200, v21, v133
    v_fmac_f32 v200, v22, v134
    v_fmac_f32 v200, v23, v135
    v_mfma_f32_32x32x8_bf16 v[32:47], v[80:81], v[188:189], v[32:47]
    v_add_f32 v198, v196, v198
    v_mul_f32_e64 v202, v24, -v128
    v_fma_f32 v202, v25, -v129, v202
    v_fma_f32 v202, v26, -v130, v202
    v_fma_f32 v202, v27, -v131, v202
    v_fma_f32 v202, v28, -v132, v202
    v_mfma_f32_32x32x8_bf16 v[48:63], v[84:85], v[188:189], v[48:63]
    v_fma_f32 v202, v29, -v133, v202
    v_fma_f32 v202, v30, -v134, v202
    v_fma_f32 v202, v31, -v135, v202
    s_nop 1
    v_permlane32_swap_b32 v200, v202
    v_add_f32 v202, v200, v202
    s_waitcnt vmcnt(3) lgkmcnt(0)
    v_mfma_f32_32x32x16_bf16 v[0:15], v[64:67], v[176:179], 0
    v_mul_f32 v197, v32, v104
    v_fmac_f32 v197, v33, v105
    v_fmac_f32 v197, v34, v106
    v_fmac_f32 v197, v35, v107
    v_fmac_f32 v197, v36, v108
    v_fmac_f32 v197, v37, v109
    v_fmac_f32 v197, v38, v110
    s_add_u32 m0, s21, 6144
    v_mfma_f32_32x32x16_bf16 v[16:31], v[68:71], v[176:179], 0
    buffer_load_dwordx4 v236, s[4:7], s36 offen  lds
    buffer_load_dwordx4 v237, s[8:11], s36 offen offset:1024  lds
    ds_read_b64_tr_b16 v[176:177], v244 offset:0
    ds_read_b64_tr_b16 v[178:179], v244 offset:1024
    ds_read_b64_tr_b16 v[184:185], v245 offset:0
    ds_read_b64_tr_b16 v[186:187], v245 offset:1024
    v_fmac_f32 v197, v39, v111
    v_mul_f32 v199, v40, v136
    v_fmac_f32 v199, v41, v137
    v_fmac_f32 v199, v42, v138
    v_fmac_f32 v199, v43, v139
    v_fmac_f32 v199, v44, v140
    s_waitcnt vmcnt(4) lgkmcnt(0)
    v_mfma_f32_32x32x16_bf16 v[0:15], v[72:75], v[176:179], v[0:15]
    v_fmac_f32 v199, v45, v141
    v_fmac_f32 v199, v46, v142
    v_fmac_f32 v199, v47, v143
    v_mul_f32 v201, v48, v136
    v_fmac_f32 v201, v49, v137
    v_permlane32_swap_b32 v197, v199
    v_fmac_f32 v201, v50, v138
    s_add_u32 m0, s21, 0
    v_mfma_f32_32x32x16_bf16 v[16:31], v[76:79], v[176:179], v[16:31]
    buffer_load_dwordx4 v238, s[4:7], s36 offen  lds
    ds_read_b64_tr_b16 v[176:177], v244 offset:2048
    ds_read_b64_tr_b16 v[188:189], v245 offset:2048
    v_fmac_f32 v201, v51, v139
    v_fmac_f32 v201, v52, v140
    v_fmac_f32 v201, v53, v141
    v_fmac_f32 v201, v54, v142
    v_fmac_f32 v201, v55, v143
    v_add_f32 v199, v197, v199
    s_waitcnt lgkmcnt(0)
    v_mfma_f32_32x32x8_bf16 v[0:15], v[80:81], v[176:177], v[0:15]
    v_mul_f32_e64 v203, v56, -v136
    v_fma_f32 v203, v57, -v137, v203
    v_fma_f32 v203, v58, -v138, v203
    v_fma_f32 v203, v59, -v139, v203
    v_fma_f32 v203, v60, -v140, v203
    v_fma_f32 v203, v61, -v141, v203
    v_fma_f32 v203, v62, -v142, v203
    s_add_u32 m0, s21, 2048
    v_mfma_f32_32x32x8_bf16 v[16:31], v[84:85], v[176:177], v[16:31]
    buffer_load_dwordx4 v234, s[4:7], s37 offen  lds
    buffer_load_dwordx4 v235, s[8:11], s37 offen offset:1024  lds
    v_add_u32 v252, s42, v247
    ds_read_u16 v234, v252
    ds_read_u16 v235, v252 offset:64
    v_fma_f32 v203, v63, -v143, v203
    s_nop 1
    v_permlane32_swap_b32 v201, v203
    v_add_f32 v203, v201, v203
    v_cvt_pk_bf16_f32 v192, v198, v199
    v_cvt_pk_bf16_f32 v193, v202, v203
    v_mfma_f32_32x32x16_bf16 v[32:47], v[64:67], v[180:183], 0
    v_mul_f32 v196, v0, v144
    v_fmac_f32 v196, v1, v145
    v_fmac_f32 v196, v2, v146
    v_fmac_f32 v196, v3, v147
    v_fmac_f32 v196, v4, v148
    v_fmac_f32 v196, v5, v149
    v_mfma_f32_32x32x16_bf16 v[48:63], v[68:71], v[180:183], 0
    v_fmac_f32 v196, v6, v150
    v_fmac_f32 v196, v7, v151
    v_mul_f32 v198, v8, v112
    v_fmac_f32 v198, v9, v113
    v_fmac_f32 v198, v10, v114
    v_mfma_f32_32x32x16_bf16 v[32:47], v[72:75], v[184:187], v[32:47]
    v_fmac_f32 v198, v11, v115
    v_fmac_f32 v198, v12, v116
    v_fmac_f32 v198, v13, v117
    v_fmac_f32 v198, v14, v118
    v_fmac_f32 v198, v15, v119
    v_mfma_f32_32x32x16_bf16 v[48:63], v[76:79], v[184:187], v[48:63]
    s_waitcnt vmcnt(5)
    ds_read_b64_tr_b16 v[176:177], v244 offset:4096
    ds_read_b64_tr_b16 v[178:179], v244 offset:5120
    ds_read_b64_tr_b16 v[180:181], v245 offset:4096
    ds_read_b64_tr_b16 v[182:183], v245 offset:5120
    v_mul_f32_e64 v200, v16, -v160
    v_fma_f32 v200, v17, -v161, v200
    v_fma_f32 v200, v18, -v162, v200
    v_fma_f32 v200, v19, -v163, v200
    v_fma_f32 v200, v20, -v164, v200
    v_fma_f32 v200, v21, -v165, v200
    v_mfma_f32_32x32x8_bf16 v[32:47], v[80:81], v[188:189], v[32:47]
    v_fma_f32 v200, v22, -v166, v200
    v_fma_f32 v200, v23, -v167, v200
    v_mul_f32_e64 v202, v24, -v160
    v_fma_f32 v202, v25, -v161, v202
    v_fma_f32 v202, v26, -v162, v202
    v_mfma_f32_32x32x8_bf16 v[48:63], v[84:85], v[188:189], v[48:63]
    v_fma_f32 v202, v27, -v163, v202
    v_fma_f32 v202, v28, -v164, v202
    v_fma_f32 v202, v29, -v165, v202
    v_fma_f32 v202, v30, -v166, v202
    v_fma_f32 v202, v31, -v167, v202
    s_waitcnt vmcnt(3) lgkmcnt(0)
    v_mfma_f32_32x32x16_bf16 v[0:15], v[64:67], v[176:179], 0
    v_mul_f32 v197, v32, v152
    v_fmac_f32 v197, v33, v153
    v_fmac_f32 v197, v34, v154
    v_fmac_f32 v197, v35, v155
    v_fmac_f32 v197, v36, v156
    v_fmac_f32 v197, v37, v157
    s_add_u32 m0, s21, 4096
    v_mfma_f32_32x32x16_bf16 v[16:31], v[68:71], v[176:179], 0
    buffer_load_dwordx4 v236, s[4:7], s37 offen  lds
    buffer_load_dwordx4 v237, s[8:11], s37 offen offset:1024  lds
    ds_read_b64_tr_b16 v[176:177], v244 offset:6144
    ds_read_b64_tr_b16 v[178:179], v244 offset:7168
    ds_read_b64_tr_b16 v[184:185], v245 offset:6144
    ds_read_b64_tr_b16 v[186:187], v245 offset:7168
    v_add_u32 v252, s43, v247
    ds_read_u16 v236, v252
    ds_read_u16 v237, v252 offset:64
    v_fmac_f32 v197, v38, v158
    v_fmac_f32 v197, v39, v159
    v_mul_f32 v199, v40, v120
    v_fmac_f32 v199, v41, v121
    v_fmac_f32 v199, v42, v122
    s_waitcnt vmcnt(4) lgkmcnt(2)
    v_mfma_f32_32x32x16_bf16 v[0:15], v[72:75], v[176:179], v[0:15]
    v_fmac_f32 v199, v43, v123
    v_fmac_f32 v199, v44, v124
    v_fmac_f32 v199, v45, v125
    v_fmac_f32 v199, v46, v126
    v_fmac_f32 v199, v47, v127
    s_add_u32 m0, s21, 6144
    v_mfma_f32_32x32x16_bf16 v[16:31], v[76:79], v[176:179], v[16:31]
    buffer_load_dwordx4 v238, s[4:7], s37 offen  lds
    ds_read_b64_tr_b16 v[176:177], v244 offset:0
    ds_read_b64_tr_b16 v[188:189], v245 offset:0
    v_add_u32 v252, s44, v247
    ds_read_u16 v238, v252
    ds_read_u16 v239, v252 offset:64
    v_mul_f32_e64 v201, v48, -v168
    v_fma_f32 v201, v49, -v169, v201
    v_fma_f32 v201, v50, -v170, v201
    v_fma_f32 v201, v51, -v171, v201
    v_fma_f32 v201, v52, -v172, v201
    v_fma_f32 v201, v53, -v173, v201
    s_waitcnt lgkmcnt(2)
    v_mfma_f32_32x32x8_bf16 v[0:15], v[80:81], v[176:177], v[0:15]
    v_fma_f32 v201, v54, -v174, v201
    v_fma_f32 v201, v55, -v175, v201
    v_mul_f32_e64 v203, v56, -v168
    v_fma_f32 v203, v57, -v169, v203
    v_fma_f32 v203, v58, -v170, v203
    s_add_u32 m0, s21, 0
    s_cmp_eq_u32 s50, 4
    v_mfma_f32_32x32x8_bf16 v[16:31], v[84:85], v[176:177], v[16:31]
    s_cbranch_scc1 WL_5_0
    v_lshl_add_u32 v234, v234, 10, v246
    v_lshl_add_u32 v235, v235, 10, v246
    buffer_load_dwordx4 v234, s[4:7], s38 offen  lds
    buffer_load_dwordx4 v235, s[8:11], s38 offen offset:1024  lds
WR_5_0:
    v_fma_f32 v203, v59, -v171, v203
    v_fma_f32 v203, v60, -v172, v203
    v_fma_f32 v203, v61, -v173, v203
    v_fma_f32 v203, v62, -v174, v203
    v_fma_f32 v203, v63, -v175, v203
    v_mfma_f32_32x32x16_bf16 v[32:47], v[64:67], v[180:183], 0
    v_mul_f32 v254, v0, v144
    v_fmac_f32 v254, v1, v145
    v_fmac_f32 v254, v2, v146
    v_mfma_f32_32x32x16_bf16 v[48:63], v[68:71], v[180:183], 0
    ds_swizzle_b32 v68, v68 offset:0x401F
    ds_swizzle_b32 v69, v69 offset:0x401F
    ds_swizzle_b32 v70, v70 offset:0x401F
    ds_swizzle_b32 v71, v71 offset:0x401F
    v_fmac_f32 v254, v3, v147
    v_fmac_f32 v254, v4, v148
    v_fmac_f32 v254, v5, v149
    v_mfma_f32_32x32x16_bf16 v[32:47], v[72:75], v[184:187], v[32:47]
    v_fmac_f32 v254, v6, v150
    v_fmac_f32 v254, v7, v151
    v_fmac_f32 v200, v8, v160
    v_mfma_f32_32x32x16_bf16 v[48:63], v[76:79], v[184:187], v[48:63]
    ds_swizzle_b32 v76, v76 offset:0x401F
    ds_swizzle_b32 v77, v77 offset:0x401F
    ds_swizzle_b32 v78, v78 offset:0x401F
    ds_swizzle_b32 v79, v79 offset:0x401F
    s_waitcnt vmcnt(5)
    ds_read_b64_tr_b16 v[176:177], v244 offset:2048
    ds_read_b64_tr_b16 v[178:179], v244 offset:3072
    ds_read_b64_tr_b16 v[180:181], v245 offset:2048
    ds_read_b64_tr_b16 v[182:183], v245 offset:3072
    v_fmac_f32 v200, v9, v161
    v_permlane32_swap_b32 v196, v254
    v_fmac_f32 v200, v10, v162
    v_mfma_f32_32x32x8_bf16 v[32:47], v[80:81], v[188:189], v[32:47]
    v_fmac_f32 v200, v11, v163
    v_fmac_f32 v200, v12, v164
    v_fmac_f32 v200, v13, v165
    v_mfma_f32_32x32x8_bf16 v[48:63], v[84:85], v[188:189], v[48:63]
    ds_swizzle_b32 v84, v84 offset:0x401F
    ds_swizzle_b32 v85, v85 offset:0x401F
    v_fmac_f32 v200, v14, v166
    v_fmac_f32 v200, v15, v167
    v_add_f32 v254, v196, v254
    s_waitcnt lgkmcnt(6)
    s_mov_b64 exec, s[56:57]
    v_xor_b32 v68, 0x80008000, v68
    v_xor_b32 v69, 0x80008000, v69
    v_xor_b32 v70, 0x80008000, v70
    v_xor_b32 v71, 0x80008000, v71
    v_xor_b32 v76, 0x80008000, v76
    v_xor_b32 v77, 0x80008000, v77
    v_xor_b32 v78, 0x80008000, v78
    v_xor_b32 v79, 0x80008000, v79
    s_mov_b64 exec, -1
    s_waitcnt vmcnt(3) lgkmcnt(2)
    v_mfma_f32_32x32x16_bf16 v[0:15], v[64:67], v[176:179], 0
    v_mul_f32 v255, v32, v152
    v_fmac_f32 v255, v33, v153
    v_fmac_f32 v255, v34, v154
    v_fmac_f32 v255, v35, v155
    s_add_u32 m0, s21, 2048
    s_cmp_eq_u32 s50, 4
    v_mfma_f32_32x32x16_bf16 v[16:31], v[68:71], v[176:179], v[16:31]
    s_cbranch_scc1 WL_5_1
    v_lshl_add_u32 v236, v236, 10, v246
    v_lshl_add_u32 v237, v237, 10, v246
    buffer_load_dwordx4 v236, s[4:7], s39 offen  lds
    buffer_load_dwordx4 v237, s[8:11], s39 offen offset:1024  lds
WR_5_1:
    ds_read_b64_tr_b16 v[176:177], v244 offset:4096
    ds_read_b64_tr_b16 v[178:179], v244 offset:5120
    ds_read_b64_tr_b16 v[184:185], v245 offset:4096
    ds_read_b64_tr_b16 v[186:187], v245 offset:5120
    v_fmac_f32 v255, v36, v156
    v_fmac_f32 v255, v37, v157
    v_fmac_f32 v255, v38, v158
    s_waitcnt vmcnt(4) lgkmcnt(0)
    v_mfma_f32_32x32x16_bf16 v[0:15], v[72:75], v[176:179], v[0:15]
    v_fmac_f32 v255, v39, v159
    v_fmac_f32 v201, v40, v168
    v_fmac_f32 v201, v41, v169
    s_add_u32 m0, s21, 4096
    s_cmp_eq_u32 s50, 4
    v_mfma_f32_32x32x16_bf16 v[16:31], v[76:79], v[176:179], v[16:31]
    s_cbranch_scc1 WL_5_2
    v_lshl_add_u32 v238, v238, 10, v246
    v_lshl_add_u32 v239, v239, 10, v246
    buffer_load_dwordx4 v238, s[4:7], s40 offen  lds
    buffer_load_dwordx4 v239, s[8:11], s40 offen offset:1024  lds
WR_5_2:
    ds_read_b64_tr_b16 v[176:177], v244 offset:6144
    ds_read_b64_tr_b16 v[188:189], v245 offset:6144
    v_permlane32_swap_b32 v197, v255
    v_fmac_f32 v201, v42, v170
    v_fmac_f32 v201, v43, v171
    s_waitcnt lgkmcnt(0)
    s_mov_b64 exec, s[56:57]
    v_xor_b32 v84, 0x80008000, v84
    v_xor_b32 v85, 0x80008000, v85
    s_mov_b64 exec, -1
    v_mfma_f32_32x32x8_bf16 v[0:15], v[80:81], v[176:177], v[0:15]
    v_fmac_f32 v201, v44, v172
    v_fmac_f32 v201, v45, v173
    v_fmac_f32 v201, v46, v174
    s_add_u32 m0, s21, 6144
    s_cmp_eq_u32 s50, 4
    v_mfma_f32_32x32x8_bf16 v[16:31], v[84:85], v[176:177], v[16:31]
    s_cbranch_scc1 WL_5_3
    v_lshl_add_u32 v240, v240, 10, v246
    v_lshl_add_u32 v241, v241, 10, v246
    buffer_load_dwordx4 v240, s[4:7], s41 offen  lds
    buffer_load_dwordx4 v241, s[8:11], s41 offen offset:1024  lds
WR_5_3:
    v_fmac_f32 v201, v47, v175
    v_add_f32 v255, v197, v255
    v_cvt_pk_bf16_f32 v194, v254, v255
    v_mfma_f32_32x32x16_bf16 v[32:47], v[64:67], v[180:183], 0
    v_mul_f32 v254, v0, v144
    v_fmac_f32 v254, v1, v145
    v_fmac_f32 v254, v2, v146
    v_fmac_f32 v254, v3, v147
    v_fmac_f32 v254, v4, v148
    v_fmac_f32 v254, v5, v149
    v_fmac_f32 v254, v6, v150
    v_mfma_f32_32x32x16_bf16 v[48:63], v[68:71], v[180:183], v[48:63]
    v_fmac_f32 v254, v7, v151
    v_fma_f32 v202, v8, -v160, v202
    v_fma_f32 v202, v9, -v161, v202
    v_permlane32_swap_b32 v254, v200
    v_fma_f32 v202, v10, -v162, v202
    v_fma_f32 v202, v11, -v163, v202
    v_mfma_f32_32x32x16_bf16 v[32:47], v[72:75], v[184:187], v[32:47]
    v_fma_f32 v202, v12, -v164, v202
    v_fma_f32 v202, v13, -v165, v202
    v_fma_f32 v202, v14, -v166, v202
    v_fma_f32 v202, v15, -v167, v202
    v_add_f32 v200, v254, v200
    v_fmac_f32 v198, v16, v112
    v_permlane32_swap_b32 v202, v254
    v_mfma_f32_32x32x16_bf16 v[48:63], v[76:79], v[184:187], v[48:63]
    s_waitcnt vmcnt(6)
    ds_read_b64_tr_b16 v[176:177], v244 offset:0
    ds_read_b64_tr_b16 v[178:179], v244 offset:1024
    ds_read_b64_tr_b16 v[180:181], v245 offset:0
    ds_read_b64_tr_b16 v[182:183], v245 offset:1024
    v_fmac_f32 v198, v17, v113
    v_fmac_f32 v198, v18, v114
    v_fmac_f32 v198, v19, v115
    v_fmac_f32 v198, v20, v116
    v_fmac_f32 v198, v21, v117
    v_fmac_f32 v198, v22, v118
    v_mfma_f32_32x32x8_bf16 v[32:47], v[80:81], v[188:189], v[32:47]
    v_fmac_f32 v198, v23, v119
    v_add_f32 v254, v202, v254
    v_mul_f32 v196, v24, v160
    v_fmac_f32 v196, v25, v161
    v_fmac_f32 v196, v26, v162
    v_fmac_f32 v196, v27, v163
    v_fmac_f32 v196, v28, v164
    v_mfma_f32_32x32x8_bf16 v[48:63], v[84:85], v[188:189], v[48:63]
    v_add_u32 v249, s48, v249
    v_add_u32 v250, s49, v250
    ds_read_b32 v252, v251 offset:16
    ds_read_b64_tr_b16 v[64:65], v249 offset:0
    ds_read_b64_tr_b16 v[68:69], v249 offset:64
    ds_read_b64_tr_b16 v[66:67], v249 offset:256
    ds_read_b64_tr_b16 v[70:71], v249 offset:320
    s_mov_b64 exec, s[54:55]
    ds_read_u16_d16_hi v242, v250 offset:0
    s_mov_b64 exec, -1
    v_fmac_f32 v196, v29, v165
    v_fmac_f32 v196, v30, v166
    v_fmac_f32 v196, v31, v167
    s_nop 1
    v_permlane32_swap_b32 v198, v196
    v_add_f32 v196, v198, v196
    s_cmp_eq_u32 s50, 4
    s_cbranch_scc1 LEPI_0
    v_mul_f32 v255, v32, v152
    v_fmac_f32 v255, v33, v153
    v_fmac_f32 v255, v34, v154
    v_fmac_f32 v255, v35, v155
    v_fmac_f32 v255, v36, v156
    v_fmac_f32 v255, v37, v157
    v_fmac_f32 v255, v38, v158
    v_fmac_f32 v255, v39, v159
    v_fma_f32 v203, v40, -v168, v203
    v_fma_f32 v203, v41, -v169, v203
    v_permlane32_swap_b32 v255, v201
    v_fma_f32 v203, v42, -v170, v203
    v_fma_f32 v203, v43, -v171, v203
    v_fma_f32 v203, v44, -v172, v203
    v_fma_f32 v203, v45, -v173, v203
    v_fma_f32 v203, v46, -v174, v203
    v_fma_f32 v203, v47, -v175, v203
    v_add_f32 v201, v255, v201
    v_fmac_f32 v199, v48, v120
    v_permlane32_swap_b32 v203, v255
    v_fmac_f32 v199, v49, v121
    v_fmac_f32 v199, v50, v122
    v_fmac_f32 v199, v51, v123
    v_fmac_f32 v199, v52, v124
    v_fmac_f32 v199, v53, v125
    v_fmac_f32 v199, v54, v126
    v_fmac_f32 v199, v55, v127
    v_add_f32 v255, v203, v255
    v_mul_f32 v197, v56, v168
    v_fmac_f32 v197, v57, v169
    v_fmac_f32 v197, v58, v170
    v_fmac_f32 v197, v59, v171
    v_fmac_f32 v197, v60, v172
    v_fmac_f32 v197, v61, v173
    v_fmac_f32 v197, v62, v174
    v_fmac_f32 v197, v63, v175
    s_nop 1
    v_permlane32_swap_b32 v199, v197
    v_add_f32 v197, v199, v197
    v_cvt_pk_bf16_f32 v200, v200, v201
    v_cvt_pk_bf16_f32 v254, v254, v255
    v_cvt_pk_bf16_f32 v196, v196, v197
    ds_write2st64_b32 v253, v192, v193 offset0:0 offset1:1
    ds_write2st64_b32 v253, v194, v200 offset0:2 offset1:3
    ds_write_b32 v253, v196 offset:1024
    s_mov_b64 exec, 0xffffffff
    ds_write_b32 v253, v254 offset:1280
    s_mov_b64 exec, -1
    s_add_u32 s50, s50, 1
    s_cmp_ge_u32 s50, 4
    s_cbranch_scc1 LAST1
    s_waitcnt lgkmcnt(9)
    v_readfirstlane_b32 s66, v252
    s_add_u32 s53, s53, 1
    v_mov_b32 v252, s53
    s_cmp_le_u32 s53, s66
    ds_write2_b32 v251, v252, v252 offset0:0 offset1:8
    s_setprio 1
    s_cbranch_scc1 PRIO_12
    s_setprio 0
PRIO_12:
    s_cmp_eq_u32 s52, 4
    s_cbranch_scc1 ITEM_1_4
    s_cmp_eq_u32 s52, 5
    s_cbranch_scc1 ITEM_1_5
    s_cmp_eq_u32 s52, 3
    s_cbranch_scc1 ITEM_1_3
    s_cmp_eq_u32 s52, 6
    s_cbranch_scc1 ITEM_1_6
    s_cmp_eq_u32 s52, 8
    s_cbranch_scc1 ITEM_1_8
    s_branch ITEM_1_2
WL_5_0:
    s_add_u32 s66, s51, 0
    buffer_load_dwordx4 v[96:99], v246, s[16:19], s66 offen offset:2048 sc1
    buffer_load_dwordx4 v[100:103], v246, s[16:19], s66 offen offset:3072 sc1
    s_branch WR_5_0
WL_5_1:
    s_add_u32 s66, s51, 4096
    buffer_load_dwordx4 v[104:107], v246, s[16:19], s66 offen offset:2048 sc1
    buffer_load_dwordx4 v[108:111], v246, s[16:19], s66 offen offset:3072 sc1
    s_branch WR_5_1
WL_5_2:
    s_add_u32 s66, s51, 8192
    buffer_load_dwordx4 v[128:131], v246, s[16:19], s66 offen offset:2048 sc1
    buffer_load_dwordx4 v[132:135], v246, s[16:19], s66 offen offset:3072 sc1
    s_branch WR_5_2
WL_5_3:
    s_add_u32 s66, s51, 12288
    buffer_load_dwordx4 v[136:139], v246, s[16:19], s66 offen offset:2048 sc1
    buffer_load_dwordx4 v[140:143], v246, s[16:19], s66 offen offset:3072 sc1
    s_branch WR_5_3
.p2align 6
ITEM_1_3:
    s_mov_b64 exec, s[54:55]
    ds_read_u16_d16_hi v243, v250 offset:128
    s_mov_b64 exec, -1
    ds_read_b64_tr_b16 v[72:73], v249 offset:512
    ds_read_b64_tr_b16 v[76:77], v249 offset:576
    s_waitcnt lgkmcnt(3)
    v_mul_f32_dpp v196, v242, v64 row_newbcast:0 row_mask:0xf bank_mask:0xf
    v_mul_f32_dpp v197, v242, v65 row_newbcast:1 row_mask:0xf bank_mask:0xf
    v_mul_f32_dpp v198, v242, v64 row_newbcast:8 row_mask:0xf bank_mask:0xf
    v_mul_f32_dpp v199, v242, v65 row_newbcast:9 row_mask:0xf bank_mask:0xf
    v_mul_f32_dpp v200, v242, v68 row_newbcast:2 row_mask:0xf bank_mask:0xf
    v_mul_f32_dpp v201, v242, v69 row_newbcast:3 row_mask:0xf bank_mask:0xf
    v_mul_f32_dpp v202, v242, v68 row_newbcast:10 row_mask:0xf bank_mask:0xf
    v_mul_f32_dpp v203, v242, v69 row_newbcast:11 row_mask:0xf bank_mask:0xf
    v_cvt_pk_bf16_f32 v64, v196, v197
    v_cvt_pk_bf16_f32 v68, v198, v199
    v_cvt_pk_bf16_f32 v65, v200, v201
    v_cvt_pk_bf16_f32 v69, v202, v203
    v_mul_f32_dpp v196, v242, v66 row_newbcast:4 row_mask:0xf bank_mask:0xf
    v_mul_f32_dpp v197, v242, v67 row_newbcast:5 row_mask:0xf bank_mask:0xf
    v_mul_f32_dpp v198, v242, v66 row_newbcast:12 row_mask:0xf bank_mask:0xf
    v_mul_f32_dpp v199, v242, v67 row_newbcast:13 row_mask:0xf bank_mask:0xf
    v_mul_f32_dpp v200, v242, v70 row_newbcast:6 row_mask:0xf bank_mask:0xf
    v_mul_f32_dpp v201, v242, v71 row_newbcast:7 row_mask:0xf bank_mask:0xf
    v_mul_f32_dpp v202, v242, v70 row_newbcast:14 row_mask:0xf bank_mask:0xf
    v_mul_f32_dpp v203, v242, v71 row_newbcast:15 row_mask:0xf bank_mask:0xf
    v_cvt_pk_bf16_f32 v66, v196, v197
    v_cvt_pk_bf16_f32 v70, v198, v199
    v_cvt_pk_bf16_f32 v67, v200, v201
    v_cvt_pk_bf16_f32 v71, v202, v203
    s_nop 0
    s_waitcnt vmcnt(4) lgkmcnt(0)
    v_mfma_f32_32x32x16_bf16 v[0:15], v[64:67], v[176:179], 0
    v_mul_f32_dpp v196, v243, v72 row_newbcast:0 row_mask:0xf bank_mask:0xf
    v_mul_f32_dpp v197, v243, v73 row_newbcast:1 row_mask:0xf bank_mask:0xf
    v_mul_f32_dpp v198, v243, v72 row_newbcast:8 row_mask:0xf bank_mask:0xf
    v_mul_f32_dpp v199, v243, v73 row_newbcast:9 row_mask:0xf bank_mask:0xf
    v_mul_f32_dpp v200, v243, v76 row_newbcast:2 row_mask:0xf bank_mask:0xf
    v_mul_f32_dpp v201, v243, v77 row_newbcast:3 row_mask:0xf bank_mask:0xf
    s_add_u32 m0, s21, 0
    v_mfma_f32_32x32x16_bf16 v[16:31], v[68:71], v[176:179], 0
    buffer_load_dwordx4 v234, s[4:7], s36 offen  lds
    buffer_load_dwordx4 v235, s[8:11], s36 offen offset:1024  lds
    ds_read_b64_tr_b16 v[176:177], v244 offset:2048
    ds_read_b64_tr_b16 v[184:185], v245 offset:2048
    v_mul_f32_dpp v202, v243, v76 row_newbcast:10 row_mask:0xf bank_mask:0xf
    v_mul_f32_dpp v203, v243, v77 row_newbcast:11 row_mask:0xf bank_mask:0xf
    v_cvt_pk_bf16_f32 v72, v196, v197
    v_cvt_pk_bf16_f32 v76, v198, v199
    v_cvt_pk_bf16_f32 v73, v200, v201
    v_cvt_pk_bf16_f32 v77, v202, v203
    s_nop 0
    s_waitcnt lgkmcnt(0)
    v_mfma_f32_32x32x8_bf16 v[0:15], v[72:73], v[176:177], v[0:15]
    s_add_u32 m0, s21, 2048
    v_mfma_f32_32x32x8_bf16 v[16:31], v[76:77], v[176:177], v[16:31]
    buffer_load_dwordx4 v236, s[4:7], s36 offen  lds
    s_mov_b32 m0, s50
    s_nop 0
    s_movrels_b32 s71, s23
    s_movrels_b32 s33, s28
    s_and_b32 s70, s33, 0x70
    s_andn2_b32 s33, s33, 0x70
    v_xor_b32 v253, s70, v248
    v_add_u32 v253, s33, v253
    s_bfe_u32 s46, s71, 0x30012
    s_mov_b32 m0, s46
    s_and_b32 s66, s71, 0x3ffff
    s_movrels_b32 s68, s57
    s_movrels_b32 s69, s61
    s_sub_u32 s48, s66, s47
    s_mov_b32 s47, s66
    s_lshr_b32 s52, s71, 28
    s_lshl_b32 s67, s46, 9
    s_add_u32 s66, s66, s67
    s_sub_u32 s49, s66, s42
    s_mov_b32 s42, s66
    s_bfe_u32 s66, s68, 655360
    s_add_u32 s43, s42, s66
    s_bfe_u32 s39, s69, 655360
    s_bfe_u32 s66, s68, 655370
    s_add_u32 s44, s42, s66
    s_bfe_u32 s40, s69, 655370
    s_bfe_u32 s66, s68, 655380
    s_add_u32 s45, s42, s66
    s_bfe_u32 s41, s69, 655380
    v_add_u32 v252, s44, v247
    ds_read_u16 v238, v252
    ds_read_u16 v239, v252 offset:64
    v_add_u32 v252, s45, v247
    ds_read_u16 v240, v252
    ds_read_u16 v241, v252 offset:64
    v_mfma_f32_32x32x16_bf16 v[32:47], v[64:67], v[180:183], 0
    v_mul_f32 v196, v0, v96
    v_fmac_f32 v196, v1, v97
    v_fmac_f32 v196, v2, v98
    v_fmac_f32 v196, v3, v99
    v_fmac_f32 v196, v4, v100
    v_fmac_f32 v196, v5, v101
    v_fmac_f32 v196, v6, v102
    v_fmac_f32 v196, v7, v103
    v_mul_f32 v198, v8, v128
    v_fmac_f32 v198, v9, v129
    v_mfma_f32_32x32x16_bf16 v[48:63], v[68:71], v[180:183], 0
    s_waitcnt vmcnt(5)
    ds_read_b64_tr_b16 v[176:177], v244 offset:4096
    ds_read_b64_tr_b16 v[178:179], v244 offset:5120
    ds_read_b64_tr_b16 v[180:181], v245 offset:4096
    ds_read_b64_tr_b16 v[182:183], v245 offset:5120
    v_fmac_f32 v198, v10, v130
    v_fmac_f32 v198, v11, v131
    v_fmac_f32 v198, v12, v132
    v_fmac_f32 v198, v13, v133
    v_fmac_f32 v198, v14, v134
    v_fmac_f32 v198, v15, v135
    v_mul_f32 v200, v16, v128
    v_fmac_f32 v200, v17, v129
    v_permlane32_swap_b32 v196, v198
    v_mfma_f32_32x32x8_bf16 v[32:47], v[72:73], v[184:185], v[32:47]
    v_fmac_f32 v200, v18, v130
    v_fmac_f32 v200, v19, v131
    v_fmac_f32 v200, v20, v132
    v_fmac_f32 v200, v21, v133
    v_fmac_f32 v200, v22, v134
    v_fmac_f32 v200, v23, v135
    v_add_f32 v198, v196, v198
    v_mul_f32_e64 v202, v24, -v128
    v_fma_f32 v202, v25, -v129, v202
    v_mfma_f32_32x32x8_bf16 v[48:63], v[76:77], v[184:185], v[48:63]
    v_fma_f32 v202, v26, -v130, v202
    v_fma_f32 v202, v27, -v131, v202
    v_fma_f32 v202, v28, -v132, v202
    v_fma_f32 v202, v29, -v133, v202
    v_fma_f32 v202, v30, -v134, v202
    v_fma_f32 v202, v31, -v135, v202
    s_nop 1
    v_permlane32_swap_b32 v200, v202
    v_add_f32 v202, v200, v202
    s_waitcnt vmcnt(3) lgkmcnt(0)
    v_mfma_f32_32x32x16_bf16 v[0:15], v[64:67], v[176:179], 0
    v_mul_f32 v197, v32, v104
    v_fmac_f32 v197, v33, v105
    v_fmac_f32 v197, v34, v106
    v_fmac_f32 v197, v35, v107
    v_fmac_f32 v197, v36, v108
    v_fmac_f32 v197, v37, v109
    v_fmac_f32 v197, v38, v110
    v_fmac_f32 v197, v39, v111
    v_mul_f32 v199, v40, v136
    v_fmac_f32 v199, v41, v137
    s_add_u32 m0, s21, 4096
    v_mfma_f32_32x32x16_bf16 v[16:31], v[68:71], v[176:179], 0
    buffer_load_dwordx4 v234, s[4:7], s37 offen  lds
    buffer_load_dwordx4 v235, s[8:11], s37 offen offset:1024  lds
    ds_read_b64_tr_b16 v[176:177], v244 offset:6144
    ds_read_b64_tr_b16 v[184:185], v245 offset:6144
    v_add_u32 v252, s42, v247
    ds_read_u16 v234, v252
    ds_read_u16 v235, v252 offset:64
    v_fmac_f32 v199, v42, v138
    v_fmac_f32 v199, v43, v139
    v_fmac_f32 v199, v44, v140
    v_fmac_f32 v199, v45, v141
    v_fmac_f32 v199, v46, v142
    v_fmac_f32 v199, v47, v143
    v_mul_f32 v201, v48, v136
    v_fmac_f32 v201, v49, v137
    v_permlane32_swap_b32 v197, v199
    v_fmac_f32 v201, v50, v138
    s_waitcnt lgkmcnt(2)
    v_mfma_f32_32x32x8_bf16 v[0:15], v[72:73], v[176:177], v[0:15]
    v_fmac_f32 v201, v51, v139
    v_fmac_f32 v201, v52, v140
    v_fmac_f32 v201, v53, v141
    v_fmac_f32 v201, v54, v142
    v_fmac_f32 v201, v55, v143
    v_add_f32 v199, v197, v199
    v_mul_f32_e64 v203, v56, -v136
    v_fma_f32 v203, v57, -v137, v203
    v_fma_f32 v203, v58, -v138, v203
    v_fma_f32 v203, v59, -v139, v203
    s_add_u32 m0, s21, 6144
    v_mfma_f32_32x32x8_bf16 v[16:31], v[76:77], v[176:177], v[16:31]
    buffer_load_dwordx4 v236, s[4:7], s37 offen  lds
    v_add_u32 v252, s43, v247
    ds_read_u16 v236, v252
    ds_read_u16 v237, v252 offset:64
    v_fma_f32 v203, v60, -v140, v203
    v_fma_f32 v203, v61, -v141, v203
    v_fma_f32 v203, v62, -v142, v203
    v_fma_f32 v203, v63, -v143, v203
    s_nop 1
    v_permlane32_swap_b32 v201, v203
    v_add_f32 v203, v201, v203
    v_cvt_pk_bf16_f32 v192, v198, v199
    v_cvt_pk_bf16_f32 v193, v202, v203
    v_mfma_f32_32x32x16_bf16 v[32:47], v[64:67], v[180:183], 0
    v_mul_f32 v196, v0, v144
    v_fmac_f32 v196, v1, v145
    v_fmac_f32 v196, v2, v146
    v_fmac_f32 v196, v3, v147
    v_fmac_f32 v196, v4, v148
    v_fmac_f32 v196, v5, v149
    v_fmac_f32 v196, v6, v150
    v_fmac_f32 v196, v7, v151
    v_mfma_f32_32x32x16_bf16 v[48:63], v[68:71], v[180:183], 0
    s_waitcnt vmcnt(4)
    ds_read_b64_tr_b16 v[176:177], v244 offset:0
    ds_read_b64_tr_b16 v[178:179], v244 offset:1024
    ds_read_b64_tr_b16 v[180:181], v245 offset:0
    ds_read_b64_tr_b16 v[182:183], v245 offset:1024
    v_mul_f32 v198, v8, v112
    v_fmac_f32 v198, v9, v113
    v_fmac_f32 v198, v10, v114
    v_fmac_f32 v198, v11, v115
    v_fmac_f32 v198, v12, v116
    v_fmac_f32 v198, v13, v117
    v_fmac_f32 v198, v14, v118
    v_fmac_f32 v198, v15, v119
    v_mfma_f32_32x32x8_bf16 v[32:47], v[72:73], v[184:185], v[32:47]
    v_mul_f32_e64 v200, v16, -v160
    v_fma_f32 v200, v17, -v161, v200
    v_fma_f32 v200, v18, -v162, v200
    v_fma_f32 v200, v19, -v163, v200
    v_fma_f32 v200, v20, -v164, v200
    v_fma_f32 v200, v21, -v165, v200
    v_fma_f32 v200, v22, -v166, v200
    v_fma_f32 v200, v23, -v167, v200
    v_mfma_f32_32x32x8_bf16 v[48:63], v[76:77], v[184:185], v[48:63]
    v_mul_f32_e64 v202, v24, -v160
    v_fma_f32 v202, v25, -v161, v202
    v_fma_f32 v202, v26, -v162, v202
    v_fma_f32 v202, v27, -v163, v202
    v_fma_f32 v202, v28, -v164, v202
    v_fma_f32 v202, v29, -v165, v202
    v_fma_f32 v202, v30, -v166, v202
    v_fma_f32 v202, v31, -v167, v202
    s_waitcnt vmcnt(3) lgkmcnt(0)
    v_mfma_f32_32x32x16_bf16 v[0:15], v[64:67], v[176:179], 0
    v_mul_f32 v197, v32, v152
    v_fmac_f32 v197, v33, v153
    v_fmac_f32 v197, v34, v154
    v_fmac_f32 v197, v35, v155
    v_fmac_f32 v197, v36, v156
    v_fmac_f32 v197, v37, v157
    v_fmac_f32 v197, v38, v158
    v_fmac_f32 v197, v39, v159
    s_add_u32 m0, s21, 0
    s_cmp_eq_u32 s50, 4
    v_mfma_f32_32x32x16_bf16 v[16:31], v[68:71], v[176:179], 0
    s_cbranch_scc1 WL_3_0
    v_lshl_add_u32 v234, v234, 10, v246
    v_lshl_add_u32 v235, v235, 10, v246
    buffer_load_dwordx4 v234, s[4:7], s38 offen  lds
    buffer_load_dwordx4 v235, s[8:11], s38 offen offset:1024  lds
WR_3_0:
    ds_read_b64_tr_b16 v[176:177], v244 offset:2048
    ds_read_b64_tr_b16 v[184:185], v245 offset:2048
    v_mul_f32 v199, v40, v120
    v_fmac_f32 v199, v41, v121
    v_fmac_f32 v199, v42, v122
    v_fmac_f32 v199, v43, v123
    v_fmac_f32 v199, v44, v124
    v_fmac_f32 v199, v45, v125
    v_fmac_f32 v199, v46, v126
    v_fmac_f32 v199, v47, v127
    s_waitcnt lgkmcnt(0)
    v_mfma_f32_32x32x8_bf16 v[0:15], v[72:73], v[176:177], v[0:15]
    v_mul_f32_e64 v201, v48, -v168
    v_fma_f32 v201, v49, -v169, v201
    v_fma_f32 v201, v50, -v170, v201
    v_fma_f32 v201, v51, -v171, v201
    v_fma_f32 v201, v52, -v172, v201
    v_fma_f32 v201, v53, -v173, v201
    v_fma_f32 v201, v54, -v174, v201
    v_fma_f32 v201, v55, -v175, v201
    s_add_u32 m0, s21, 2048
    s_cmp_eq_u32 s50, 4
    v_mfma_f32_32x32x8_bf16 v[16:31], v[76:77], v[176:177], v[16:31]
    s_cbranch_scc1 WL_3_1
    v_lshl_add_u32 v236, v236, 10, v246
    v_lshl_add_u32 v237, v237, 10, v246
    buffer_load_dwordx4 v236, s[4:7], s39 offen  lds
    buffer_load_dwordx4 v237, s[8:11], s39 offen offset:1024  lds
WR_3_1:
    v_mul_f32_e64 v203, v56, -v168
    v_fma_f32 v203, v57, -v169, v203
    v_fma_f32 v203, v58, -v170, v203
    v_fma_f32 v203, v59, -v171, v203
    v_fma_f32 v203, v60, -v172, v203
    v_fma_f32 v203, v61, -v173, v203
    v_fma_f32 v203, v62, -v174, v203
    v_fma_f32 v203, v63, -v175, v203
    v_mfma_f32_32x32x16_bf16 v[32:47], v[64:67], v[180:183], 0
    v_mul_f32 v254, v0, v144
    v_fmac_f32 v254, v1, v145
    v_fmac_f32 v254, v2, v146
    v_fmac_f32 v254, v3, v147
    v_fmac_f32 v254, v4, v148
    v_mfma_f32_32x32x16_bf16 v[48:63], v[68:71], v[180:183], 0
    ds_swizzle_b32 v68, v68 offset:0x401F
    ds_swizzle_b32 v69, v69 offset:0x401F
    ds_swizzle_b32 v70, v70 offset:0x401F
    ds_swizzle_b32 v71, v71 offset:0x401F
    s_waitcnt vmcnt(5)
    ds_read_b64_tr_b16 v[176:177], v244 offset:4096
    ds_read_b64_tr_b16 v[178:179], v244 offset:5120
    ds_read_b64_tr_b16 v[180:181], v245 offset:4096
    ds_read_b64_tr_b16 v[182:183], v245 offset:5120
    v_fmac_f32 v254, v5, v149
    v_fmac_f32 v254, v6, v150
    v_fmac_f32 v254, v7, v151
    v_fmac_f32 v200, v8, v160
    v_mfma_f32_32x32x8_bf16 v[32:47], v[72:73], v[184:185], v[32:47]
    v_fmac_f32 v200, v9, v161
    v_permlane32_swap_b32 v196, v254
    v_fmac_f32 v200, v10, v162
    v_fmac_f32 v200, v11, v163
    v_fmac_f32 v200, v12, v164
    v_mfma_f32_32x32x8_bf16 v[48:63], v[76:77], v[184:185], v[48:63]
    ds_swizzle_b32 v76, v76 offset:0x401F
    ds_swizzle_b32 v77, v77 offset:0x401F
    v_fmac_f32 v200, v13, v165
    v_fmac_f32 v200, v14, v166
    v_fmac_f32 v200, v15, v167
    v_add_f32 v254, v196, v254
    s_waitcnt lgkmcnt(6)
    s_mov_b64 exec, s[56:57]
    v_xor_b32 v68, 0x80008000, v68
    v_xor_b32 v69, 0x80008000, v69
    v_xor_b32 v70, 0x80008000, v70
    v_xor_b32 v71, 0x80008000, v71
    s_mov_b64 exec, -1
    s_waitcnt vmcnt(4) lgkmcnt(2)
    v_mfma_f32_32x32x16_bf16 v[0:15], v[64:67], v[176:179], 0
    v_mul_f32 v255, v32, v152
    v_fmac_f32 v255, v33, v153
    v_fmac_f32 v255, v34, v154
    v_fmac_f32 v255, v35, v155
    v_fmac_f32 v255, v36, v156
    s_add_u32 m0, s21, 4096
    s_cmp_eq_u32 s50, 4
    v_mfma_f32_32x32x16_bf16 v[16:31], v[68:71], v[176:179], v[16:31]
    s_cbranch_scc1 WL_3_2
    v_lshl_add_u32 v238, v238, 10, v246
    v_lshl_add_u32 v239, v239, 10, v246
    buffer_load_dwordx4 v238, s[4:7], s40 offen  lds
    buffer_load_dwordx4 v239, s[8:11], s40 offen offset:1024  lds
WR_3_2:
    ds_read_b64_tr_b16 v[176:177], v244 offset:6144
    ds_read_b64_tr_b16 v[184:185], v245 offset:6144
    v_fmac_f32 v255, v37, v157
    v_fmac_f32 v255, v38, v158
    v_fmac_f32 v255, v39, v159
    v_fmac_f32 v201, v40, v168
    v_fmac_f32 v201, v41, v169
    s_waitcnt lgkmcnt(0)
    s_mov_b64 exec, s[56:57]
    v_xor_b32 v76, 0x80008000, v76
    v_xor_b32 v77, 0x80008000, v77
    s_mov_b64 exec, -1
    v_mfma_f32_32x32x8_bf16 v[0:15], v[72:73], v[176:177], v[0:15]
    v_permlane32_swap_b32 v197, v255
    v_fmac_f32 v201, v42, v170
    v_fmac_f32 v201, v43, v171
    v_fmac_f32 v201, v44, v172
    v_fmac_f32 v201, v45, v173
    s_add_u32 m0, s21, 6144
    s_cmp_eq_u32 s50, 4
    v_mfma_f32_32x32x8_bf16 v[16:31], v[76:77], v[176:177], v[16:31]
    s_cbranch_scc1 WL_3_3
    v_lshl_add_u32 v240, v240, 10, v246
    v_lshl_add_u32 v241, v241, 10, v246
    buffer_load_dwordx4 v240, s[4:7], s41 offen  lds
    buffer_load_dwordx4 v241, s[8:11], s41 offen offset:1024  lds
WR_3_3:
    v_fmac_f32 v201, v46, v174
    v_fmac_f32 v201, v47, v175
    v_add_f32 v255, v197, v255
    v_cvt_pk_bf16_f32 v194, v254, v255
    v_mfma_f32_32x32x16_bf16 v[32:47], v[64:67], v[180:183], 0
    v_mul_f32 v254, v0, v144
    v_fmac_f32 v254, v1, v145
    v_fmac_f32 v254, v2, v146
    v_fmac_f32 v254, v3, v147
    v_fmac_f32 v254, v4, v148
    v_fmac_f32 v254, v5, v149
    v_fmac_f32 v254, v6, v150
    v_fmac_f32 v254, v7, v151
    v_fma_f32 v202, v8, -v160, v202
    v_fma_f32 v202, v9, -v161, v202
    v_mfma_f32_32x32x16_bf16 v[48:63], v[68:71], v[180:183], v[48:63]
    s_waitcnt vmcnt(6)
    ds_read_b64_tr_b16 v[176:177], v244 offset:0
    ds_read_b64_tr_b16 v[178:179], v244 offset:1024
    ds_read_b64_tr_b16 v[180:181], v245 offset:0
    ds_read_b64_tr_b16 v[182:183], v245 offset:1024
    v_permlane32_swap_b32 v254, v200
    v_fma_f32 v202, v10, -v162, v202
    v_fma_f32 v202, v11, -v163, v202
    v_fma_f32 v202, v12, -v164, v202
    v_fma_f32 v202, v13, -v165, v202
    v_fma_f32 v202, v14, -v166, v202
    v_fma_f32 v202, v15, -v167, v202
    v_add_f32 v200, v254, v200
    v_fmac_f32 v198, v16, v112
    v_permlane32_swap_b32 v202, v254
    v_mfma_f32_32x32x8_bf16 v[32:47], v[72:73], v[184:185], v[32:47]
    v_fmac_f32 v198, v17, v113
    v_fmac_f32 v198, v18, v114
    v_fmac_f32 v198, v19, v115
    v_fmac_f32 v198, v20, v116
    v_fmac_f32 v198, v21, v117
    v_fmac_f32 v198, v22, v118
    v_fmac_f32 v198, v23, v119
    v_add_f32 v254, v202, v254
    v_mul_f32 v196, v24, v160
    v_fmac_f32 v196, v25, v161
    v_mfma_f32_32x32x8_bf16 v[48:63], v[76:77], v[184:185], v[48:63]
    v_add_u32 v249, s48, v249
    v_add_u32 v250, s49, v250
    ds_read_b32 v252, v251 offset:16
    ds_read_b64_tr_b16 v[64:65], v249 offset:0
    ds_read_b64_tr_b16 v[68:69], v249 offset:64
    ds_read_b64_tr_b16 v[66:67], v249 offset:256
    ds_read_b64_tr_b16 v[70:71], v249 offset:320
    s_mov_b64 exec, s[54:55]
    ds_read_u16_d16_hi v242, v250 offset:0
    s_mov_b64 exec, -1
    v_fmac_f32 v196, v26, v162
    v_fmac_f32 v196, v27, v163
    v_fmac_f32 v196, v28, v164
    v_fmac_f32 v196, v29, v165
    v_fmac_f32 v196, v30, v166
    v_fmac_f32 v196, v31, v167
    s_nop 1
    v_permlane32_swap_b32 v198, v196
    v_add_f32 v196, v198, v196
    s_cmp_eq_u32 s50, 4
    s_cbranch_scc1 LEPI_0
    v_mul_f32 v255, v32, v152
    v_fmac_f32 v255, v33, v153
    v_fmac_f32 v255, v34, v154
    v_fmac_f32 v255, v35, v155
    v_fmac_f32 v255, v36, v156
    v_fmac_f32 v255, v37, v157
    v_fmac_f32 v255, v38, v158
    v_fmac_f32 v255, v39, v159
    v_fma_f32 v203, v40, -v168, v203
    v_fma_f32 v203, v41, -v169, v203
    v_permlane32_swap_b32 v255, v201
    v_fma_f32 v203, v42, -v170, v203
    v_fma_f32 v203, v43, -v171, v203
    v_fma_f32 v203, v44, -v172, v203
    v_fma_f32 v203, v45, -v173, v203
    v_fma_f32 v203, v46, -v174, v203
    v_fma_f32 v203, v47, -v175, v203
    v_add_f32 v201, v255, v201
    v_fmac_f32 v199, v48, v120
    v_permlane32_swap_b32 v203, v255
    v_fmac_f32 v199, v49, v121
    v_fmac_f32 v199, v50, v122
    v_fmac_f32 v199, v51, v123
    v_fmac_f32 v199, v52, v124
    v_fmac_f32 v199, v53, v125
    v_fmac_f32 v199, v54, v126
    v_fmac_f32 v199, v55, v127
    v_add_f32 v255, v203, v255
    v_mul_f32 v197, v56, v168
    v_fmac_f32 v197, v57, v169
    v_fmac_f32 v197, v58, v170
    v_fmac_f32 v197, v59, v171
    v_fmac_f32 v197, v60, v172
    v_fmac_f32 v197, v61, v173
    v_fmac_f32 v197, v62, v174
    v_fmac_f32 v197, v63, v175
    s_nop 1
    v_permlane32_swap_b32 v199, v197
    v_add_f32 v197, v199, v197
    v_cvt_pk_bf16_f32 v200, v200, v201
    v_cvt_pk_bf16_f32 v254, v254, v255
    v_cvt_pk_bf16_f32 v196, v196, v197
    ds_write2st64_b32 v253, v192, v193 offset0:0 offset1:1
    ds_write2st64_b32 v253, v194, v200 offset0:2 offset1:3
    ds_write_b32 v253, v196 offset:1024
    s_mov_b64 exec, 0xffffffff
    ds_write_b32 v253, v254 offset:1280
    s_mov_b64 exec, -1
    s_add_u32 s50, s50, 1
    s_cmp_ge_u32 s50, 4
    s_cbranch_scc1 LAST1
    s_waitcnt lgkmcnt(9)
    v_readfirstlane_b32 s66, v252
    s_add_u32 s53, s53, 1
    v_mov_b32 v252, s53
    s_cmp_le_u32 s53, s66
    ds_write2_b32 v251, v252, v252 offset0:0 offset1:8
    s_setprio 1
    s_cbranch_scc1 PRIO_13
    s_setprio 0
PRIO_13:
    s_cmp_eq_u32 s52, 4
    s_cbranch_scc1 ITEM_1_4
    s_cmp_eq_u32 s52, 5
    s_cbranch_scc1 ITEM_1_5
    s_cmp_eq_u32 s52, 3
    s_cbranch_scc1 ITEM_1_3
    s_cmp_eq_u32 s52, 6
    s_cbranch_scc1 ITEM_1_6
    s_cmp_eq_u32 s52, 8
    s_cbranch_scc1 ITEM_1_8
    s_branch ITEM_1_2
WL_3_0:
    s_add_u32 s66, s51, 0
    buffer_load_dwordx4 v[96:99], v246, s[16:19], s66 offen offset:2048 sc1
    buffer_load_dwordx4 v[100:103], v246, s[16:19], s66 offen offset:3072 sc1
    s_branch WR_3_0
WL_3_1:
    s_add_u32 s66, s51, 4096
    buffer_load_dwordx4 v[104:107], v246, s[16:19], s66 offen offset:2048 sc1
    buffer_load_dwordx4 v[108:111], v246, s[16:19], s66 offen offset:3072 sc1
    s_branch WR_3_1
WL_3_2:
    s_add_u32 s66, s51, 8192
    buffer_load_dwordx4 v[128:131], v246, s[16:19], s66 offen offset:2048 sc1
    buffer_load_dwordx4 v[132:135], v246, s[16:19], s66 offen offset:3072 sc1
    s_branch WR_3_2
WL_3_3:
    s_add_u32 s66, s51, 12288
    buffer_load_dwordx4 v[136:139], v246, s[16:19], s66 offen offset:2048 sc1
    buffer_load_dwordx4 v[140:143], v246, s[16:19], s66 offen offset:3072 sc1
    s_branch WR_3_3
.p2align 6
ITEM_1_6:
    s_mov_b64 exec, s[54:55]
    ds_read_u16_d16_hi v243, v250 offset:128
    s_mov_b64 exec, -1
    ds_read_b64_tr_b16 v[72:73], v249 offset:512
    ds_read_b64_tr_b16 v[76:77], v249 offset:576
    ds_read_b64_tr_b16 v[74:75], v249 offset:768
    ds_read_b64_tr_b16 v[78:79], v249 offset:832
    ds_read_b64_tr_b16 v[80:81], v249 offset:1024
    ds_read_b64_tr_b16 v[84:85], v249 offset:1088
    ds_read_b64_tr_b16 v[82:83], v249 offset:1280
    ds_read_b64_tr_b16 v[86:87], v249 offset:1344
    s_waitcnt lgkmcnt(9)
    v_mul_f32_dpp v196, v242, v64 row_newbcast:0 row_mask:0xf bank_mask:0xf
    v_mul_f32_dpp v197, v242, v65 row_newbcast:1 row_mask:0xf bank_mask:0xf
    v_mul_f32_dpp v198, v242, v64 row_newbcast:8 row_mask:0xf bank_mask:0xf
    v_mul_f32_dpp v199, v242, v65 row_newbcast:9 row_mask:0xf bank_mask:0xf
    v_mul_f32_dpp v200, v242, v68 row_newbcast:2 row_mask:0xf bank_mask:0xf
    v_mul_f32_dpp v201, v242, v69 row_newbcast:3 row_mask:0xf bank_mask:0xf
    v_mul_f32_dpp v202, v242, v68 row_newbcast:10 row_mask:0xf bank_mask:0xf
    v_mul_f32_dpp v203, v242, v69 row_newbcast:11 row_mask:0xf bank_mask:0xf
    v_cvt_pk_bf16_f32 v64, v196, v197
    v_cvt_pk_bf16_f32 v68, v198, v199
    v_cvt_pk_bf16_f32 v65, v200, v201
    v_cvt_pk_bf16_f32 v69, v202, v203
    v_mul_f32_dpp v196, v242, v66 row_newbcast:4 row_mask:0xf bank_mask:0xf
    v_mul_f32_dpp v197, v242, v67 row_newbcast:5 row_mask:0xf bank_mask:0xf
    v_mul_f32_dpp v198, v242, v66 row_newbcast:12 row_mask:0xf bank_mask:0xf
    v_mul_f32_dpp v199, v242, v67 row_newbcast:13 row_mask:0xf bank_mask:0xf
    v_mul_f32_dpp v200, v242, v70 row_newbcast:6 row_mask:0xf bank_mask:0xf
    v_mul_f32_dpp v201, v242, v71 row_newbcast:7 row_mask:0xf bank_mask:0xf
    v_mul_f32_dpp v202, v242, v70 row_newbcast:14 row_mask:0xf bank_mask:0xf
    v_mul_f32_dpp v203, v242, v71 row_newbcast:15 row_mask:0xf bank_mask:0xf
    v_cvt_pk_bf16_f32 v66, v196, v197
    v_cvt_pk_bf16_f32 v70, v198, v199
    v_cvt_pk_bf16_f32 v67, v200, v201
    v_cvt_pk_bf16_f32 v71, v202, v203
    s_mov_b64 exec, s[54:55]
    ds_read_u16_d16_hi v242, v250 offset:256
    s_mov_b64 exec, -1
    s_waitcnt vmcnt(4) lgkmcnt(5)
    v_mfma_f32_32x32x16_bf16 v[0:15], v[64:67], v[176:179], 0
    v_mul_f32_dpp v196, v243, v72 row_newbcast:0 row_mask:0xf bank_mask:0xf
    v_mul_f32_dpp v197, v243, v73 row_newbcast:1 row_mask:0xf bank_mask:0xf
    v_mul_f32_dpp v198, v243, v72 row_newbcast:8 row_mask:0xf bank_mask:0xf
    v_mul_f32_dpp v199, v243, v73 row_newbcast:9 row_mask:0xf bank_mask:0xf
    v_mul_f32_dpp v200, v243, v76 row_newbcast:2 row_mask:0xf bank_mask:0xf
    v_mul_f32_dpp v201, v243, v77 row_newbcast:3 row_mask:0xf bank_mask:0xf
    v_mul_f32_dpp v202, v243, v76 row_newbcast:10 row_mask:0xf bank_mask:0xf
    v_mul_f32_dpp v203, v243, v77 row_newbcast:11 row_mask:0xf bank_mask:0xf
    v_cvt_pk_bf16_f32 v72, v196, v197
    v_cvt_pk_bf16_f32 v76, v198, v199
    v_cvt_pk_bf16_f32 v73, v200, v201
    v_cvt_pk_bf16_f32 v77, v202, v203
    s_add_u32 m0, s21, 0
    v_mfma_f32_32x32x16_bf16 v[16:31], v[68:71], v[176:179], 0
    buffer_load_dwordx4 v236, s[4:7], s35 offen  lds
    buffer_load_dwordx4 v237, s[8:11], s35 offen offset:1024  lds
    ds_read_b64_tr_b16 v[176:177], v244 offset:2048
    ds_read_b64_tr_b16 v[178:179], v244 offset:3072
    ds_read_b64_tr_b16 v[184:185], v245 offset:2048
    ds_read_b64_tr_b16 v[186:187], v245 offset:3072
    v_mul_f32_dpp v196, v243, v74 row_newbcast:4 row_mask:0xf bank_mask:0xf
    v_mul_f32_dpp v197, v243, v75 row_newbcast:5 row_mask:0xf bank_mask:0xf
    v_mul_f32_dpp v198, v243, v74 row_newbcast:12 row_mask:0xf bank_mask:0xf
    v_mul_f32_dpp v199, v243, v75 row_newbcast:13 row_mask:0xf bank_mask:0xf
    v_mul_f32_dpp v200, v243, v78 row_newbcast:6 row_mask:0xf bank_mask:0xf
    v_mul_f32_dpp v201, v243, v79 row_newbcast:7 row_mask:0xf bank_mask:0xf
    v_mul_f32_dpp v202, v243, v78 row_newbcast:14 row_mask:0xf bank_mask:0xf
    v_mul_f32_dpp v203, v243, v79 row_newbcast:15 row_mask:0xf bank_mask:0xf
    v_cvt_pk_bf16_f32 v74, v196, v197
    v_cvt_pk_bf16_f32 v78, v198, v199
    v_cvt_pk_bf16_f32 v75, v200, v201
    v_cvt_pk_bf16_f32 v79, v202, v203
    s_nop 0
    s_waitcnt vmcnt(4) lgkmcnt(0)
    v_mfma_f32_32x32x16_bf16 v[0:15], v[72:75], v[176:179], v[0:15]
    v_mul_f32_dpp v196, v242, v80 row_newbcast:0 row_mask:0xf bank_mask:0xf
    v_mul_f32_dpp v197, v242, v81 row_newbcast:1 row_mask:0xf bank_mask:0xf
    v_mul_f32_dpp v198, v242, v80 row_newbcast:8 row_mask:0xf bank_mask:0xf
    v_mul_f32_dpp v199, v242, v81 row_newbcast:9 row_mask:0xf bank_mask:0xf
    v_mul_f32_dpp v200, v242, v84 row_newbcast:2 row_mask:0xf bank_mask:0xf
    v_mul_f32_dpp v201, v242, v85 row_newbcast:3 row_mask:0xf bank_mask:0xf
    v_mul_f32_dpp v202, v242, v84 row_newbcast:10 row_mask:0xf bank_mask:0xf
    v_mul_f32_dpp v203, v242, v85 row_newbcast:11 row_mask:0xf bank_mask:0xf
    v_cvt_pk_bf16_f32 v80, v196, v197
    v_cvt_pk_bf16_f32 v84, v198, v199
    v_cvt_pk_bf16_f32 v81, v200, v201
    v_cvt_pk_bf16_f32 v85, v202, v203
    s_add_u32 m0, s21, 2048
    v_mfma_f32_32x32x16_bf16 v[16:31], v[76:79], v[176:179], v[16:31]
    buffer_load_dwordx4 v238, s[4:7], s35 offen  lds
    buffer_load_dwordx4 v239, s[8:11], s35 offen offset:1024  lds
    ds_read_b64_tr_b16 v[176:177], v244 offset:4096
    ds_read_b64_tr_b16 v[178:179], v244 offset:5120
    ds_read_b64_tr_b16 v[188:189], v245 offset:4096
    ds_read_b64_tr_b16 v[190:191], v245 offset:5120
    v_mul_f32_dpp v196, v242, v82 row_newbcast:4 row_mask:0xf bank_mask:0xf
    v_mul_f32_dpp v197, v242, v83 row_newbcast:5 row_mask:0xf bank_mask:0xf
    v_mul_f32_dpp v198, v242, v82 row_newbcast:12 row_mask:0xf bank_mask:0xf
    v_mul_f32_dpp v199, v242, v83 row_newbcast:13 row_mask:0xf bank_mask:0xf
    v_mul_f32_dpp v200, v242, v86 row_newbcast:6 row_mask:0xf bank_mask:0xf
    v_mul_f32_dpp v201, v242, v87 row_newbcast:7 row_mask:0xf bank_mask:0xf
    v_mul_f32_dpp v202, v242, v86 row_newbcast:14 row_mask:0xf bank_mask:0xf
    v_mul_f32_dpp v203, v242, v87 row_newbcast:15 row_mask:0xf bank_mask:0xf
    v_cvt_pk_bf16_f32 v82, v196, v197
    v_cvt_pk_bf16_f32 v86, v198, v199
    v_cvt_pk_bf16_f32 v83, v200, v201
    v_cvt_pk_bf16_f32 v87, v202, v203
    s_nop 0
    s_waitcnt lgkmcnt(0)
    v_mfma_f32_32x32x16_bf16 v[0:15], v[80:83], v[176:179], v[0:15]
    s_add_u32 m0, s21, 4096
    v_mfma_f32_32x32x16_bf16 v[16:31], v[84:87], v[176:179], v[16:31]
    buffer_load_dwordx4 v234, s[4:7], s36 offen  lds
    buffer_load_dwordx4 v235, s[8:11], s36 offen offset:1024  lds
    s_mov_b32 m0, s50
    s_nop 0
    s_movrels_b32 s71, s23
    s_movrels_b32 s33, s28
    s_and_b32 s70, s33, 0x70
    s_andn2_b32 s33, s33, 0x70
    v_xor_b32 v253, s70, v248
    v_add_u32 v253, s33, v253
    s_bfe_u32 s46, s71, 0x30012
    s_mov_b32 m0, s46
    s_and_b32 s66, s71, 0x3ffff
    s_movrels_b32 s68, s57
    s_movrels_b32 s69, s61
    s_sub_u32 s48, s66, s47
    s_mov_b32 s47, s66
    s_lshr_b32 s52, s71, 28
    s_lshl_b32 s67, s46, 9
    s_add_u32 s66, s66, s67
    s_sub_u32 s49, s66, s42
    s_mov_b32 s42, s66
    s_bfe_u32 s66, s68, 655360
    s_add_u32 s43, s42, s66
    s_bfe_u32 s39, s69, 655360
    s_bfe_u32 s66, s68, 655370
    s_add_u32 s44, s42, s66
    s_bfe_u32 s40, s69, 655370
    s_bfe_u32 s66, s68, 655380
    s_add_u32 s45, s42, s66
    s_bfe_u32 s41, s69, 655380
    v_add_u32 v252, s45, v247
    ds_read_u16 v240, v252
    ds_read_u16 v241, v252 offset:64
    v_mfma_f32_32x32x16_bf16 v[32:47], v[64:67], v[180:183], 0
    v_mul_f32 v196, v0, v96
    v_fmac_f32 v196, v1, v97
    v_fmac_f32 v196, v2, v98
    v_fmac_f32 v196, v3, v99
    v_fmac_f32 v196, v4, v100
    v_fmac_f32 v196, v5, v101
    v_fmac_f32 v196, v6, v102
    v_mfma_f32_32x32x16_bf16 v[48:63], v[68:71], v[180:183], 0
    v_fmac_f32 v196, v7, v103
    v_mul_f32 v198, v8, v128
    v_fmac_f32 v198, v9, v129
    v_fmac_f32 v198, v10, v130
    v_fmac_f32 v198, v11, v131
    v_fmac_f32 v198, v12, v132
    v_mfma_f32_32x32x16_bf16 v[32:47], v[72:75], v[184:187], v[32:47]
    v_fmac_f32 v198, v13, v133
    v_fmac_f32 v198, v14, v134
    v_fmac_f32 v198, v15, v135
    v_mul_f32 v200, v16, v128
    v_fmac_f32 v200, v17, v129
    v_permlane32_swap_b32 v196, v198
    v_mfma_f32_32x32x16_bf16 v[48:63], v[76:79], v[184:187], v[48:63]
    s_waitcnt vmcnt(6)
    ds_read_b64_tr_b16 v[176:177], v244 offset:6144
    ds_read_b64_tr_b16 v[178:179], v244 offset:7168
    ds_read_b64_tr_b16 v[180:181], v245 offset:6144
    ds_read_b64_tr_b16 v[182:183], v245 offset:7168
    v_fmac_f32 v200, v18, v130
    v_fmac_f32 v200, v19, v131
    v_fmac_f32 v200, v20, v132
    v_fmac_f32 v200, v21, v133
    v_fmac_f32 v200, v22, v134
    v_fmac_f32 v200, v23, v135
    v_mfma_f32_32x32x16_bf16 v[32:47], v[80:83], v[188:191], v[32:47]
    v_add_f32 v198, v196, v198
    v_mul_f32_e64 v202, v24, -v128
    v_fma_f32 v202, v25, -v129, v202
    v_fma_f32 v202, v26, -v130, v202
    v_fma_f32 v202, v27, -v131, v202
    v_fma_f32 v202, v28, -v132, v202
    v_mfma_f32_32x32x16_bf16 v[48:63], v[84:87], v[188:191], v[48:63]
    v_fma_f32 v202, v29, -v133, v202
    v_fma_f32 v202, v30, -v134, v202
    v_fma_f32 v202, v31, -v135, v202
    s_nop 1
    v_permlane32_swap_b32 v200, v202
    v_add_f32 v202, v200, v202
    s_waitcnt vmcnt(4) lgkmcnt(0)
    v_mfma_f32_32x32x16_bf16 v[0:15], v[64:67], v[176:179], 0
    v_mul_f32 v197, v32, v104
    v_fmac_f32 v197, v33, v105
    v_fmac_f32 v197, v34, v106
    v_fmac_f32 v197, v35, v107
    v_fmac_f32 v197, v36, v108
    v_fmac_f32 v197, v37, v109
    v_fmac_f32 v197, v38, v110
    s_add_u32 m0, s21, 6144
    v_mfma_f32_32x32x16_bf16 v[16:31], v[68:71], v[176:179], 0
    buffer_load_dwordx4 v236, s[4:7], s36 offen  lds
    buffer_load_dwordx4 v237, s[8:11], s36 offen offset:1024  lds
    ds_read_b64_tr_b16 v[176:177], v244 offset:0
    ds_read_b64_tr_b16 v[178:179], v244 offset:1024
    ds_read_b64_tr_b16 v[184:185], v245 offset:0
    ds_read_b64_tr_b16 v[186:187], v245 offset:1024
    v_fmac_f32 v197, v39, v111
    v_mul_f32 v199, v40, v136
    v_fmac_f32 v199, v41, v137
    v_fmac_f32 v199, v42, v138
    v_fmac_f32 v199, v43, v139
    v_fmac_f32 v199, v44, v140
    s_waitcnt vmcnt(4) lgkmcnt(0)
    v_mfma_f32_32x32x16_bf16 v[0:15], v[72:75], v[176:179], v[0:15]
    v_fmac_f32 v199, v45, v141
    v_fmac_f32 v199, v46, v142
    v_fmac_f32 v199, v47, v143
    v_mul_f32 v201, v48, v136
    v_fmac_f32 v201, v49, v137
    v_permlane32_swap_b32 v197, v199
    v_fmac_f32 v201, v50, v138
    s_add_u32 m0, s21, 0
    v_mfma_f32_32x32x16_bf16 v[16:31], v[76:79], v[176:179], v[16:31]
    buffer_load_dwordx4 v238, s[4:7], s36 offen  lds
    buffer_load_dwordx4 v239, s[8:11], s36 offen offset:1024  lds
    ds_read_b64_tr_b16 v[176:177], v244 offset:2048
    ds_read_b64_tr_b16 v[178:179], v244 offset:3072
    ds_read_b64_tr_b16 v[188:189], v245 offset:2048
    ds_read_b64_tr_b16 v[190:191], v245 offset:3072
    v_fmac_f32 v201, v51, v139
    v_fmac_f32 v201, v52, v140
    v_fmac_f32 v201, v53, v141
    v_fmac_f32 v201, v54, v142
    v_fmac_f32 v201, v55, v143
    v_add_f32 v199, v197, v199
    s_waitcnt lgkmcnt(0)
    v_mfma_f32_32x32x16_bf16 v[0:15], v[80:83], v[176:179], v[0:15]
    v_mul_f32_e64 v203, v56, -v136
    v_fma_f32 v203, v57, -v137, v203
    v_fma_f32 v203, v58, -v138, v203
    v_fma_f32 v203, v59, -v139, v203
    v_fma_f32 v203, v60, -v140, v203
    v_fma_f32 v203, v61, -v141, v203
    v_fma_f32 v203, v62, -v142, v203
    s_add_u32 m0, s21, 2048
    v_mfma_f32_32x32x16_bf16 v[16:31], v[84:87], v[176:179], v[16:31]
    buffer_load_dwordx4 v234, s[4:7], s37 offen  lds
    buffer_load_dwordx4 v235, s[8:11], s37 offen offset:1024  lds
    v_add_u32 v252, s42, v247
    ds_read_u16 v234, v252
    ds_read_u16 v235, v252 offset:64
    v_fma_f32 v203, v63, -v143, v203
    s_nop 1
    v_permlane32_swap_b32 v201, v203
    v_add_f32 v203, v201, v203
    v_cvt_pk_bf16_f32 v192, v198, v199
    v_cvt_pk_bf16_f32 v193, v202, v203
    v_mfma_f32_32x32x16_bf16 v[32:47], v[64:67], v[180:183], 0
    v_mul_f32 v196, v0, v144
    v_fmac_f32 v196, v1, v145
    v_fmac_f32 v196, v2, v146
    v_fmac_f32 v196, v3, v147
    v_fmac_f32 v196, v4, v148
    v_fmac_f32 v196, v5, v149
    v_mfma_f32_32x32x16_bf16 v[48:63], v[68:71], v[180:183], 0
    v_fmac_f32 v196, v6, v150
    v_fmac_f32 v196, v7, v151
    v_mul_f32 v198, v8, v112
    v_fmac_f32 v198, v9, v113
    v_fmac_f32 v198, v10, v114
    v_mfma_f32_32x32x16_bf16 v[32:47], v[72:75], v[184:187], v[32:47]
    v_fmac_f32 v198, v11, v115
    v_fmac_f32 v198, v12, v116
    v_fmac_f32 v198, v13, v117
    v_fmac_f32 v198, v14, v118
    v_fmac_f32 v198, v15, v119
    v_mfma_f32_32x32x16_bf16 v[48:63], v[76:79], v[184:187], v[48:63]
    s_waitcnt vmcnt(6)
    ds_read_b64_tr_b16 v[176:177], v244 offset:4096
    ds_read_b64_tr_b16 v[178:179], v244 offset:5120
    ds_read_b64_tr_b16 v[180:181], v245 offset:4096
    ds_read_b64_tr_b16 v[182:183], v245 offset:5120
    v_mul_f32_e64 v200, v16, -v160
    v_fma_f32 v200, v17, -v161, v200
    v_fma_f32 v200, v18, -v162, v200
    v_fma_f32 v200, v19, -v163, v200
    v_fma_f32 v200, v20, -v164, v200
    v_fma_f32 v200, v21, -v165, v200
    v_mfma_f32_32x32x16_bf16 v[32:47], v[80:83], v[188:191], v[32:47]
    v_fma_f32 v200, v22, -v166, v200
    v_fma_f32 v200, v23, -v167, v200
    v_mul_f32_e64 v202, v24, -v160
    v_fma_f32 v202, v25, -v161, v202
    v_fma_f32 v202, v26, -v162, v202
    v_mfma_f32_32x32x16_bf16 v[48:63], v[84:87], v[188:191], v[48:63]
    v_fma_f32 v202, v27, -v163, v202
    v_fma_f32 v202, v28, -v164, v202
    v_fma_f32 v202, v29, -v165, v202
    v_fma_f32 v202, v30, -v166, v202
    v_fma_f32 v202, v31, -v167, v202
    s_waitcnt vmcnt(4) lgkmcnt(0)
    v_mfma_f32_32x32x16_bf16 v[0:15], v[64:67], v[176:179], 0
    v_mul_f32 v197, v32, v152
    v_fmac_f32 v197, v33, v153
    v_fmac_f32 v197, v34, v154
    v_fmac_f32 v197, v35, v155
    v_fmac_f32 v197, v36, v156
    v_fmac_f32 v197, v37, v157
    s_add_u32 m0, s21, 4096
    v_mfma_f32_32x32x16_bf16 v[16:31], v[68:71], v[176:179], 0
    buffer_load_dwordx4 v236, s[4:7], s37 offen  lds
    buffer_load_dwordx4 v237, s[8:11], s37 offen offset:1024  lds
    ds_read_b64_tr_b16 v[176:177], v244 offset:6144
    ds_read_b64_tr_b16 v[178:179], v244 offset:7168
    ds_read_b64_tr_b16 v[184:185], v245 offset:6144
    ds_read_b64_tr_b16 v[186:187], v245 offset:7168
    v_add_u32 v252, s43, v247
    ds_read_u16 v236, v252
    ds_read_u16 v237, v252 offset:64
    v_fmac_f32 v197, v38, v158
    v_fmac_f32 v197, v39, v159
    v_mul_f32 v199, v40, v120
    v_fmac_f32 v199, v41, v121
    v_fmac_f32 v199, v42, v122
    s_waitcnt vmcnt(4) lgkmcnt(2)
    v_mfma_f32_32x32x16_bf16 v[0:15], v[72:75], v[176:179], v[0:15]
    v_fmac_f32 v199, v43, v123
    v_fmac_f32 v199, v44, v124
    v_fmac_f32 v199, v45, v125
    v_fmac_f32 v199, v46, v126
    v_fmac_f32 v199, v47, v127
    s_add_u32 m0, s21, 6144
    v_mfma_f32_32x32x16_bf16 v[16:31], v[76:79], v[176:179], v[16:31]
    buffer_load_dwordx4 v238, s[4:7], s37 offen  lds
    buffer_load_dwordx4 v239, s[8:11], s37 offen offset:1024  lds
    ds_read_b64_tr_b16 v[176:177], v244 offset:0
    ds_read_b64_tr_b16 v[178:179], v244 offset:1024
    ds_read_b64_tr_b16 v[188:189], v245 offset:0
    ds_read_b64_tr_b16 v[190:191], v245 offset:1024
    v_add_u32 v252, s44, v247
    ds_read_u16 v238, v252
    ds_read_u16 v239, v252 offset:64
    v_mul_f32_e64 v201, v48, -v168
    v_fma_f32 v201, v49, -v169, v201
    v_fma_f32 v201, v50, -v170, v201
    v_fma_f32 v201, v51, -v171, v201
    v_fma_f32 v201, v52, -v172, v201
    v_fma_f32 v201, v53, -v173, v201
    s_waitcnt lgkmcnt(2)
    v_mfma_f32_32x32x16_bf16 v[0:15], v[80:83], v[176:179], v[0:15]
    v_fma_f32 v201, v54, -v174, v201
    v_fma_f32 v201, v55, -v175, v201
    v_mul_f32_e64 v203, v56, -v168
    v_fma_f32 v203, v57, -v169, v203
    v_fma_f32 v203, v58, -v170, v203
    s_add_u32 m0, s21, 0
    s_cmp_eq_u32 s50, 4
    v_mfma_f32_32x32x16_bf16 v[16:31], v[84:87], v[176:179], v[16:31]
    s_cbranch_scc1 WL_6_0
    v_lshl_add_u32 v234, v234, 10, v246
    v_lshl_add_u32 v235, v235, 10, v246
    buffer_load_dwordx4 v234, s[4:7], s38 offen  lds
    buffer_load_dwordx4 v235, s[8:11], s38 offen offset:1024  lds
WR_6_0:
    v_fma_f32 v203, v59, -v171, v203
    v_fma_f32 v203, v60, -v172, v203
    v_fma_f32 v203, v61, -v173, v203
    v_fma_f32 v203, v62, -v174, v203
    v_fma_f32 v203, v63, -v175, v203
    v_mfma_f32_32x32x16_bf16 v[32:47], v[64:67], v[180:183], 0
    v_mul_f32 v254, v0, v144
    v_fmac_f32 v254, v1, v145
    v_fmac_f32 v254, v2, v146
    v_mfma_f32_32x32x16_bf16 v[48:63], v[68:71], v[180:183], 0
    ds_swizzle_b32 v68, v68 offset:0x401F
    ds_swizzle_b32 v69, v69 offset:0x401F
    ds_swizzle_b32 v70, v70 offset:0x401F
    ds_swizzle_b32 v71, v71 offset:0x401F
    v_fmac_f32 v254, v3, v147
    v_fmac_f32 v254, v4, v148
    v_fmac_f32 v254, v5, v149
    v_mfma_f32_32x32x16_bf16 v[32:47], v[72:75], v[184:187], v[32:47]
    v_fmac_f32 v254, v6, v150
    v_fmac_f32 v254, v7, v151
    v_fmac_f32 v200, v8, v160
    v_mfma_f32_32x32x16_bf16 v[48:63], v[76:79], v[184:187], v[48:63]
    ds_swizzle_b32 v76, v76 offset:0x401F
    ds_swizzle_b32 v77, v77 offset:0x401F
    ds_swizzle_b32 v78, v78 offset:0x401F
    ds_swizzle_b32 v79, v79 offset:0x401F
    s_waitcnt vmcnt(6)
    ds_read_b64_tr_b16 v[176:177], v244 offset:2048
    ds_read_b64_tr_b16 v[178:179], v244 offset:3072
    ds_read_b64_tr_b16 v[180:181], v245 offset:2048
    ds_read_b64_tr_b16 v[182:183], v245 offset:3072
    v_fmac_f32 v200, v9, v161
    v_permlane32_swap_b32 v196, v254
    v_fmac_f32 v200, v10, v162
    v_mfma_f32_32x32x16_bf16 v[32:47], v[80:83], v[188:191], v[32:47]
    v_fmac_f32 v200, v11, v163
    v_fmac_f32 v200, v12, v164
    v_fmac_f32 v200, v13, v165
    v_mfma_f32_32x32x16_bf16 v[48:63], v[84:87], v[188:191], v[48:63]
    ds_swizzle_b32 v84, v84 offset:0x401F
    ds_swizzle_b32 v85, v85 offset:0x401F
    ds_swizzle_b32 v86, v86 offset:0x401F
    ds_swizzle_b32 v87, v87 offset:0x401F
    v_fmac_f32 v200, v14, v166
    v_fmac_f32 v200, v15, v167
    v_add_f32 v254, v196, v254
    s_waitcnt lgkmcnt(8)
    s_mov_b64 exec, s[56:57]
    v_xor_b32 v68, 0x80008000, v68
    v_xor_b32 v69, 0x80008000, v69
    v_xor_b32 v70, 0x80008000, v70
    v_xor_b32 v71, 0x80008000, v71
    v_xor_b32 v76, 0x80008000, v76
    v_xor_b32 v77, 0x80008000, v77
    v_xor_b32 v78, 0x80008000, v78
    v_xor_b32 v79, 0x80008000, v79
    s_mov_b64 exec, -1
    s_waitcnt vmcnt(4) lgkmcnt(4)
    v_mfma_f32_32x32x16_bf16 v[0:15], v[64:67], v[176:179], 0
    v_mul_f32 v255, v32, v152
    v_fmac_f32 v255, v33, v153
    v_fmac_f32 v255, v34, v154
    v_fmac_f32 v255, v35, v155
    s_add_u32 m0, s21, 2048
    s_cmp_eq_u32 s50, 4
    v_mfma_f32_32x32x16_bf16 v[16:31], v[68:71], v[176:179], v[16:31]
    s_cbranch_scc1 WL_6_1
    v_lshl_add_u32 v236, v236, 10, v246
    v_lshl_add_u32 v237, v237, 10, v246
    buffer_load_dwordx4 v236, s[4:7], s39 offen  lds
    buffer_load_dwordx4 v237, s[8:11], s39 offen offset:1024  lds
WR_6_1:
    ds_read_b64_tr_b16 v[176:177], v244 offset:4096
    ds_read_b64_tr_b16 v[178:179], v244 offset:5120
    ds_read_b64_tr_b16 v[184:185], v245 offset:4096
    ds_read_b64_tr_b16 v[186:187], v245 offset:5120
    v_fmac_f32 v255, v36, v156
    v_fmac_f32 v255, v37, v157
    v_fmac_f32 v255, v38, v158
    s_waitcnt vmcnt(4) lgkmcnt(0)
    v_mfma_f32_32x32x16_bf16 v[0:15], v[72:75], v[176:179], v[0:15]
    v_fmac_f32 v255, v39, v159
    v_fmac_f32 v201, v40, v168
    v_fmac_f32 v201, v41, v169
    s_add_u32 m0, s21, 4096
    s_cmp_eq_u32 s50, 4
    v_mfma_f32_32x32x16_bf16 v[16:31], v[76:79], v[176:179], v[16:31]
    s_cbranch_scc1 WL_6_2
    v_lshl_add_u32 v238, v238, 10, v246
    v_lshl_add_u32 v239, v239, 10, v246
    buffer_load_dwordx4 v238, s[4:7], s40 offen  lds
    buffer_load_dwordx4 v239, s[8:11], s40 offen offset:1024  lds
WR_6_2:
    ds_read_b64_tr_b16 v[176:177], v244 offset:6144
    ds_read_b64_tr_b16 v[178:179], v244 offset:7168
    ds_read_b64_tr_b16 v[188:189], v245 offset:6144
    ds_read_b64_tr_b16 v[190:191], v245 offset:7168
    v_permlane32_swap_b32 v197, v255
    v_fmac_f32 v201, v42, v170
    v_fmac_f32 v201, v43, v171
    s_waitcnt lgkmcnt(0)
    s_mov_b64 exec, s[56:57]
    v_xor_b32 v84, 0x80008000, v84
    v_xor_b32 v85, 0x80008000, v85
    v_xor_b32 v86, 0x80008000, v86
    v_xor_b32 v87, 0x80008000, v87
    s_mov_b64 exec, -1
    v_mfma_f32_32x32x16_bf16 v[0:15], v[80:83], v[176:179], v[0:15]
    v_fmac_f32 v201, v44, v172
    v_fmac_f32 v201, v45, v173
    v_fmac_f32 v201, v46, v174
    s_add_u32 m0, s21, 6144
    s_cmp_eq_u32 s50, 4
    v_mfma_f32_32x32x16_bf16 v[16:31], v[84:87], v[176:179], v[16:31]
    s_cbranch_scc1 WL_6_3
    v_lshl_add_u32 v240, v240, 10, v246
    v_lshl_add_u32 v241, v241, 10, v246
    buffer_load_dwordx4 v240, s[4:7], s41 offen  lds
    buffer_load_dwordx4 v241, s[8:11], s41 offen offset:1024  lds
WR_6_3:
    v_fmac_f32 v201, v47, v175
    v_add_f32 v255, v197, v255
    v_cvt_pk_bf16_f32 v194, v254, v255
    v_mfma_f32_32x32x16_bf16 v[32:47], v[64:67], v[180:183], 0
    v_mul_f32 v254, v0, v144
    v_fmac_f32 v254, v1, v145
    v_fmac_f32 v254, v2, v146
    v_fmac_f32 v254, v3, v147
    v_fmac_f32 v254, v4, v148
    v_fmac_f32 v254, v5, v149
    v_fmac_f32 v254, v6, v150
    v_mfma_f32_32x32x16_bf16 v[48:63], v[68:71], v[180:183], v[48:63]
    v_fmac_f32 v254, v7, v151
    v_fma_f32 v202, v8, -v160, v202
    v_fma_f32 v202, v9, -v161, v202
    v_permlane32_swap_b32 v254, v200
    v_fma_f32 v202, v10, -v162, v202
    v_fma_f32 v202, v11, -v163, v202
    v_mfma_f32_32x32x16_bf16 v[32:47], v[72:75], v[184:187], v[32:47]
    v_fma_f32 v202, v12, -v164, v202
    v_fma_f32 v202, v13, -v165, v202
    v_fma_f32 v202, v14, -v166, v202
    v_fma_f32 v202, v15, -v167, v202
    v_add_f32 v200, v254, v200
    v_fmac_f32 v198, v16, v112
    v_permlane32_swap_b32 v202, v254
    v_mfma_f32_32x32x16_bf16 v[48:63], v[76:79], v[184:187], v[48:63]
    s_waitcnt vmcnt(6)
    ds_read_b64_tr_b16 v[176:177], v244 offset:0
    ds_read_b64_tr_b16 v[178:179], v244 offset:1024
    ds_read_b64_tr_b16 v[180:181], v245 offset:0
    ds_read_b64_tr_b16 v[182:183], v245 offset:1024
    v_fmac_f32 v198, v17, v113
    v_fmac_f32 v198, v18, v114
    v_fmac_f32 v198, v19, v115
    v_fmac_f32 v198, v20, v116
    v_fmac_f32 v198, v21, v117
    v_fmac_f32 v198, v22, v118
    v_mfma_f32_32x32x16_bf16 v[32:47], v[80:83], v[188:191], v[32:47]
    v_fmac_f32 v198, v23, v119
    v_add_f32 v254, v202, v254
    v_mul_f32 v196, v24, v160
    v_fmac_f32 v196, v25, v161
    v_fmac_f32 v196, v26, v162
    v_fmac_f32 v196, v27, v163
    v_fmac_f32 v196, v28, v164
    v_mfma_f32_32x32x16_bf16 v[48:63], v[84:87], v[188:191], v[48:63]
    v_add_u32 v249, s48, v249
    v_add_u32 v250, s49, v250
    ds_read_b32 v252, v251 offset:16
    ds_read_b64_tr_b16 v[64:65], v249 offset:0
    ds_read_b64_tr_b16 v[68:69], v249 offset:64
    ds_read_b64_tr_b16 v[66:67], v249 offset:256
    ds_read_b64_tr_b16 v[70:71], v249 offset:320
    s_mov_b64 exec, s[54:55]
    ds_read_u16_d16_hi v242, v250 offset:0
    s_mov_b64 exec, -1
    v_fmac_f32 v196, v29, v165
    v_fmac_f32 v196, v30, v166
    v_fmac_f32 v196, v31, v167
    s_nop 1
    v_permlane32_swap_b32 v198, v196
    v_add_f32 v196, v198, v196
    s_cmp_eq_u32 s50, 4
    s_cbranch_scc1 LEPI_0
    v_mul_f32 v255, v32, v152
    v_fmac_f32 v255, v33, v153
    v_fmac_f32 v255, v34, v154
    v_fmac_f32 v255, v35, v155
    v_fmac_f32 v255, v36, v156
    v_fmac_f32 v255, v37, v157
    v_fmac_f32 v255, v38, v158
    v_fmac_f32 v255, v39, v159
    v_fma_f32 v203, v40, -v168, v203
    v_fma_f32 v203, v41, -v169, v203
    v_permlane32_swap_b32 v255, v201
    v_fma_f32 v203, v42, -v170, v203
    v_fma_f32 v203, v43, -v171, v203
    v_fma_f32 v203, v44, -v172, v203
    v_fma_f32 v203, v45, -v173, v203
    v_fma_f32 v203, v46, -v174, v203
    v_fma_f32 v203, v47, -v175, v203
    v_add_f32 v201, v255, v201
    v_fmac_f32 v199, v48, v120
    v_permlane32_swap_b32 v203, v255
    v_fmac_f32 v199, v49, v121
    v_fmac_f32 v199, v50, v122
    v_fmac_f32 v199, v51, v123
    v_fmac_f32 v199, v52, v124
    v_fmac_f32 v199, v53, v125
    v_fmac_f32 v199, v54, v126
    v_fmac_f32 v199, v55, v127
    v_add_f32 v255, v203, v255
    v_mul_f32 v197, v56, v168
    v_fmac_f32 v197, v57, v169
    v_fmac_f32 v197, v58, v170
    v_fmac_f32 v197, v59, v171
    v_fmac_f32 v197, v60, v172
    v_fmac_f32 v197, v61, v173
    v_fmac_f32 v197, v62, v174
    v_fmac_f32 v197, v63, v175
    s_nop 1
    v_permlane32_swap_b32 v199, v197
    v_add_f32 v197, v199, v197
    v_cvt_pk_bf16_f32 v200, v200, v201
    v_cvt_pk_bf16_f32 v254, v254, v255
    v_cvt_pk_bf16_f32 v196, v196, v197
    ds_write2st64_b32 v253, v192, v193 offset0:0 offset1:1
    ds_write2st64_b32 v253, v194, v200 offset0:2 offset1:3
    ds_write_b32 v253, v196 offset:1024
    s_mov_b64 exec, 0xffffffff
    ds_write_b32 v253, v254 offset:1280
    s_mov_b64 exec, -1
    s_add_u32 s50, s50, 1
    s_cmp_ge_u32 s50, 4
    s_cbranch_scc1 LAST1
    s_waitcnt lgkmcnt(9)
    v_readfirstlane_b32 s66, v252
    s_add_u32 s53, s53, 1
    v_mov_b32 v252, s53
    s_cmp_le_u32 s53, s66
    ds_write2_b32 v251, v252, v252 offset0:0 offset1:8
    s_setprio 1
    s_cbranch_scc1 PRIO_14
    s_setprio 0
PRIO_14:
    s_cmp_eq_u32 s52, 4
    s_cbranch_scc1 ITEM_1_4
    s_cmp_eq_u32 s52, 5
    s_cbranch_scc1 ITEM_1_5
    s_cmp_eq_u32 s52, 3
    s_cbranch_scc1 ITEM_1_3
    s_cmp_eq_u32 s52, 6
    s_cbranch_scc1 ITEM_1_6
    s_cmp_eq_u32 s52, 8
    s_cbranch_scc1 ITEM_1_8
    s_branch ITEM_1_2
WL_6_0:
    s_add_u32 s66, s51, 0
    buffer_load_dwordx4 v[96:99], v246, s[16:19], s66 offen offset:2048 sc1
    buffer_load_dwordx4 v[100:103], v246, s[16:19], s66 offen offset:3072 sc1
    s_branch WR_6_0
WL_6_1:
    s_add_u32 s66, s51, 4096
    buffer_load_dwordx4 v[104:107], v246, s[16:19], s66 offen offset:2048 sc1
    buffer_load_dwordx4 v[108:111], v246, s[16:19], s66 offen offset:3072 sc1
    s_branch WR_6_1
WL_6_2:
    s_add_u32 s66, s51, 8192
    buffer_load_dwordx4 v[128:131], v246, s[16:19], s66 offen offset:2048 sc1
    buffer_load_dwordx4 v[132:135], v246, s[16:19], s66 offen offset:3072 sc1
    s_branch WR_6_2
WL_6_3:
    s_add_u32 s66, s51, 12288
    buffer_load_dwordx4 v[136:139], v246, s[16:19], s66 offen offset:2048 sc1
    buffer_load_dwordx4 v[140:143], v246, s[16:19], s66 offen offset:3072 sc1
    s_branch WR_6_3
.p2align 6
ITEM_1_8:
    s_mov_b64 exec, s[54:55]
    ds_read_u16_d16_hi v243, v250 offset:128
    s_mov_b64 exec, -1
    ds_read_b64_tr_b16 v[72:73], v249 offset:512
    ds_read_b64_tr_b16 v[76:77], v249 offset:576
    ds_read_b64_tr_b16 v[74:75], v249 offset:768
    ds_read_b64_tr_b16 v[78:79], v249 offset:832
    ds_read_b64_tr_b16 v[80:81], v249 offset:1024
    ds_read_b64_tr_b16 v[84:85], v249 offset:1088
    ds_read_b64_tr_b16 v[82:83], v249 offset:1280
    ds_read_b64_tr_b16 v[86:87], v249 offset:1344
    ds_read_b64_tr_b16 v[88:89], v249 offset:1536
    ds_read_b64_tr_b16 v[92:93], v249 offset:1600
    ds_read_b64_tr_b16 v[90:91], v249 offset:1792
    ds_read_b64_tr_b16 v[94:95], v249 offset:1856
    s_waitcnt lgkmcnt(13)
    v_mul_f32_dpp v196, v242, v64 row_newbcast:0 row_mask:0xf bank_mask:0xf
    v_mul_f32_dpp v197, v242, v65 row_newbcast:1 row_mask:0xf bank_mask:0xf
    v_mul_f32_dpp v198, v242, v64 row_newbcast:8 row_mask:0xf bank_mask:0xf
    v_mul_f32_dpp v199, v242, v65 row_newbcast:9 row_mask:0xf bank_mask:0xf
    v_mul_f32_dpp v200, v242, v68 row_newbcast:2 row_mask:0xf bank_mask:0xf
    v_mul_f32_dpp v201, v242, v69 row_newbcast:3 row_mask:0xf bank_mask:0xf
    v_mul_f32_dpp v202, v242, v68 row_newbcast:10 row_mask:0xf bank_mask:0xf
    v_mul_f32_dpp v203, v242, v69 row_newbcast:11 row_mask:0xf bank_mask:0xf
    v_cvt_pk_bf16_f32 v64, v196, v197
    v_cvt_pk_bf16_f32 v68, v198, v199
    v_cvt_pk_bf16_f32 v65, v200, v201
    v_cvt_pk_bf16_f32 v69, v202, v203
    v_mul_f32_dpp v196, v242, v66 row_newbcast:4 row_mask:0xf bank_mask:0xf
    v_mul_f32_dpp v197, v242, v67 row_newbcast:5 row_mask:0xf bank_mask:0xf
    v_mul_f32_dpp v198, v242, v66 row_newbcast:12 row_mask:0xf bank_mask:0xf
    v_mul_f32_dpp v199, v242, v67 row_newbcast:13 row_mask:0xf bank_mask:0xf
    v_mul_f32_dpp v200, v242, v70 row_newbcast:6 row_mask:0xf bank_mask:0xf
    v_mul_f32_dpp v201, v242, v71 row_newbcast:7 row_mask:0xf bank_mask:0xf
    v_mul_f32_dpp v202, v242, v70 row_newbcast:14 row_mask:0xf bank_mask:0xf
    v_mul_f32_dpp v203, v242, v71 row_newbcast:15 row_mask:0xf bank_mask:0xf
    v_cvt_pk_bf16_f32 v66, v196, v197
    v_cvt_pk_bf16_f32 v70, v198, v199
    v_cvt_pk_bf16_f32 v67, v200, v201
    v_cvt_pk_bf16_f32 v71, v202, v203
    s_mov_b64 exec, s[54:55]
    ds_read_u16_d16_hi v242, v250 offset:256
    s_mov_b64 exec, -1
    s_waitcnt vmcnt(4) lgkmcnt(9)
    v_mfma_f32_32x32x16_bf16 v[0:15], v[64:67], v[176:179], 0
    v_mul_f32_dpp v196, v243, v72 row_newbcast:0 row_mask:0xf bank_mask:0xf
    v_mul_f32_dpp v197, v243, v73 row_newbcast:1 row_mask:0xf bank_mask:0xf
    v_mul_f32_dpp v198, v243, v72 row_newbcast:8 row_mask:0xf bank_mask:0xf
    v_mul_f32_dpp v199, v243, v73 row_newbcast:9 row_mask:0xf bank_mask:0xf
    v_mul_f32_dpp v200, v243, v76 row_newbcast:2 row_mask:0xf bank_mask:0xf
    v_mul_f32_dpp v201, v243, v77 row_newbcast:3 row_mask:0xf bank_mask:0xf
    v_mul_f32_dpp v202, v243, v76 row_newbcast:10 row_mask:0xf bank_mask:0xf
    v_mul_f32_dpp v203, v243, v77 row_newbcast:11 row_mask:0xf bank_mask:0xf
    v_cvt_pk_bf16_f32 v72, v196, v197
    v_cvt_pk_bf16_f32 v76, v198, v199
    v_cvt_pk_bf16_f32 v73, v200, v201
    v_cvt_pk_bf16_f32 v77, v202, v203
    s_add_u32 m0, s21, 0
    v_mfma_f32_32x32x16_bf16 v[16:31], v[68:71], v[176:179], 0
    buffer_load_dwordx4 v234, s[4:7], s35 offen  lds
    buffer_load_dwordx4 v235, s[8:11], s35 offen offset:1024  lds
    ds_read_b64_tr_b16 v[176:177], v244 offset:2048
    ds_read_b64_tr_b16 v[178:179], v244 offset:3072
    ds_read_b64_tr_b16 v[184:185], v245 offset:2048
    ds_read_b64_tr_b16 v[186:187], v245 offset:3072
    v_mul_f32_dpp v196, v243, v74 row_newbcast:4 row_mask:0xf bank_mask:0xf
    v_mul_f32_dpp v197, v243, v75 row_newbcast:5 row_mask:0xf bank_mask:0xf
    v_mul_f32_dpp v198, v243, v74 row_newbcast:12 row_mask:0xf bank_mask:0xf
    v_mul_f32_dpp v199, v243, v75 row_newbcast:13 row_mask:0xf bank_mask:0xf
    v_mul_f32_dpp v200, v243, v78 row_newbcast:6 row_mask:0xf bank_mask:0xf
    v_mul_f32_dpp v201, v243, v79 row_newbcast:7 row_mask:0xf bank_mask:0xf
    v_mul_f32_dpp v202, v243, v78 row_newbcast:14 row_mask:0xf bank_mask:0xf
    v_mul_f32_dpp v203, v243, v79 row_newbcast:15 row_mask:0xf bank_mask:0xf
    v_cvt_pk_bf16_f32 v74, v196, v197
    v_cvt_pk_bf16_f32 v78, v198, v199
    v_cvt_pk_bf16_f32 v75, v200, v201
    v_cvt_pk_bf16_f32 v79, v202, v203
    s_mov_b64 exec, s[54:55]
    ds_read_u16_d16_hi v243, v250 offset:384
    s_mov_b64 exec, -1
    s_waitcnt vmcnt(4) lgkmcnt(1)
    v_mfma_f32_32x32x16_bf16 v[0:15], v[72:75], v[176:179], v[0:15]
    v_mul_f32_dpp v196, v242, v80 row_newbcast:0 row_mask:0xf bank_mask:0xf
    v_mul_f32_dpp v197, v242, v81 row_newbcast:1 row_mask:0xf bank_mask:0xf
    v_mul_f32_dpp v198, v242, v80 row_newbcast:8 row_mask:0xf bank_mask:0xf
    v_mul_f32_dpp v199, v242, v81 row_newbcast:9 row_mask:0xf bank_mask:0xf
    v_mul_f32_dpp v200, v242, v84 row_newbcast:2 row_mask:0xf bank_mask:0xf
    v_mul_f32_dpp v201, v242, v85 row_newbcast:3 row_mask:0xf bank_mask:0xf
    v_mul_f32_dpp v202, v242, v84 row_newbcast:10 row_mask:0xf bank_mask:0xf
    v_mul_f32_dpp v203, v242, v85 row_newbcast:11 row_mask:0xf bank_mask:0xf
    v_cvt_pk_bf16_f32 v80, v196, v197
    v_cvt_pk_bf16_f32 v84, v198, v199
    v_cvt_pk_bf16_f32 v81, v200, v201
    v_cvt_pk_bf16_f32 v85, v202, v203
    s_add_u32 m0, s21, 2048
    v_mfma_f32_32x32x16_bf16 v[16:31], v[76:79], v[176:179], v[16:31]
    buffer_load_dwordx4 v236, s[4:7], s35 offen  lds
    buffer_load_dwordx4 v237, s[8:11], s35 offen offset:1024  lds
    ds_read_b64_tr_b16 v[176:177], v244 offset:4096
    ds_read_b64_tr_b16 v[178:179], v244 offset:5120
    ds_read_b64_tr_b16 v[188:189], v245 offset:4096
    ds_read_b64_tr_b16 v[190:191], v245 offset:5120
    v_mul_f32_dpp v196, v242, v82 row_newbcast:4 row_mask:0xf bank_mask:0xf
    v_mul_f32_dpp v197, v242, v83 row_newbcast:5 row_mask:0xf bank_mask:0xf
    v_mul_f32_dpp v198, v242, v82 row_newbcast:12 row_mask:0xf bank_mask:0xf
    v_mul_f32_dpp v199, v242, v83 row_newbcast:13 row_mask:0xf bank_mask:0xf
    v_mul_f32_dpp v200, v242, v86 row_newbcast:6 row_mask:0xf bank_mask:0xf
    v_mul_f32_dpp v201, v242, v87 row_newbcast:7 row_mask:0xf bank_mask:0xf
    v_mul_f32_dpp v202, v242, v86 row_newbcast:14 row_mask:0xf bank_mask:0xf
    v_mul_f32_dpp v203, v242, v87 row_newbcast:15 row_mask:0xf bank_mask:0xf
    v_cvt_pk_bf16_f32 v82, v196, v197
    v_cvt_pk_bf16_f32 v86, v198, v199
    v_cvt_pk_bf16_f32 v83, v200, v201
    v_cvt_pk_bf16_f32 v87, v202, v203
    s_nop 0
    s_waitcnt vmcnt(4) lgkmcnt(0)
    v_mfma_f32_32x32x16_bf16 v[0:15], v[80:83], v[176:179], v[0:15]
    v_mul_f32_dpp v196, v243, v88 row_newbcast:0 row_mask:0xf bank_mask:0xf
    v_mul_f32_dpp v197, v243, v89 row_newbcast:1 row_mask:0xf bank_mask:0xf
    v_mul_f32_dpp v198, v243, v88 row_newbcast:8 row_mask:0xf bank_mask:0xf
    v_mul_f32_dpp v199, v243, v89 row_newbcast:9 row_mask:0xf bank_mask:0xf
    v_mul_f32_dpp v200, v243, v92 row_newbcast:2 row_mask:0xf bank_mask:0xf
    v_mul_f32_dpp v201, v243, v93 row_newbcast:3 row_mask:0xf bank_mask:0xf
    v_mul_f32_dpp v202, v243, v92 row_newbcast:10 row_mask:0xf bank_mask:0xf
    v_mul_f32_dpp v203, v243, v93 row_newbcast:11 row_mask:0xf bank_mask:0xf
    v_cvt_pk_bf16_f32 v88, v196, v197
    v_cvt_pk_bf16_f32 v92, v198, v199
    v_cvt_pk_bf16_f32 v89, v200, v201
    v_cvt_pk_bf16_f32 v93, v202, v203
    s_add_u32 m0, s21, 4096
    v_mfma_f32_32x32x16_bf16 v[16:31], v[84:87], v[176:179], v[16:31]
    buffer_load_dwordx4 v238, s[4:7], s35 offen  lds
    buffer_load_dwordx4 v239, s[8:11], s35 offen offset:1024  lds
    ds_read_b64_tr_b16 v[176:177], v244 offset:6144
    ds_read_b64_tr_b16 v[178:179], v244 offset:7168
    ds_read_b64_tr_b16 v[192:193], v245 offset:6144
    ds_read_b64_tr_b16 v[194:195], v245 offset:7168
    v_mul_f32_dpp v196, v243, v90 row_newbcast:4 row_mask:0xf bank_mask:0xf
    v_mul_f32_dpp v197, v243, v91 row_newbcast:5 row_mask:0xf bank_mask:0xf
    v_mul_f32_dpp v198, v243, v90 row_newbcast:12 row_mask:0xf bank_mask:0xf
    v_mul_f32_dpp v199, v243, v91 row_newbcast:13 row_mask:0xf bank_mask:0xf
    v_mul_f32_dpp v200, v243, v94 row_newbcast:6 row_mask:0xf bank_mask:0xf
    v_mul_f32_dpp v201, v243, v95 row_newbcast:7 row_mask:0xf bank_mask:0xf
    v_mul_f32_dpp v202, v243, v94 row_newbcast:14 row_mask:0xf bank_mask:0xf
    v_mul_f32_dpp v203, v243, v95 row_newbcast:15 row_mask:0xf bank_mask:0xf
    v_cvt_pk_bf16_f32 v90, v196, v197
    v_cvt_pk_bf16_f32 v94, v198, v199
    v_cvt_pk_bf16_f32 v91, v200, v201
    v_cvt_pk_bf16_f32 v95, v202, v203
    s_nop 0
    s_waitcnt lgkmcnt(0)
    v_mfma_f32_32x32x16_bf16 v[0:15], v[88:91], v[176:179], v[0:15]
    s_add_u32 m0, s21, 6144
    v_mfma_f32_32x32x16_bf16 v[16:31], v[92:95], v[176:179], v[16:31]
    buffer_load_dwordx4 v240, s[4:7], s35 offen  lds
    buffer_load_dwordx4 v241, s[8:11], s35 offen offset:1024  lds
    s_mov_b32 m0, s50
    s_nop 0
    s_movrels_b32 s71, s23
    s_movrels_b32 s33, s28
    s_and_b32 s70, s33, 0x70
    s_andn2_b32 s33, s33, 0x70
    v_xor_b32 v253, s70, v248
    v_add_u32 v253, s33, v253
    s_bfe_u32 s46, s71, 0x30012
    s_mov_b32 m0, s46
    s_and_b32 s66, s71, 0x3ffff
    s_movrels_b32 s68, s57
    s_movrels_b32 s69, s61
    s_sub_u32 s48, s66, s47
    s_mov_b32 s47, s66
    s_lshr_b32 s52, s71, 28
    s_lshl_b32 s67, s46, 9
    s_add_u32 s66, s66, s67
    s_sub_u32 s49, s66, s42
    s_mov_b32 s42, s66
    s_bfe_u32 s66, s68, 655360
    s_add_u32 s43, s42, s66
    s_bfe_u32 s39, s69, 655360
    s_bfe_u32 s66, s68, 655370
    s_add_u32 s44, s42, s66
    s_bfe_u32 s40, s69, 655370
    s_bfe_u32 s66, s68, 655380
    s_add_u32 s45, s42, s66
    s_bfe_u32 s41, s69, 655380
    v_mfma_f32_32x32x16_bf16 v[32:47], v[64:67], v[180:183], 0
    v_mul_f32 v196, v0, v96
    v_fmac_f32 v196, v1, v97
    v_fmac_f32 v196, v2, v98
    v_fmac_f32 v196, v3, v99
    v_fmac_f32 v196, v4, v100
    v_mfma_f32_32x32x16_bf16 v[48:63], v[68:71], v[180:183], 0
    v_fmac_f32 v196, v5, v101
    v_fmac_f32 v196, v6, v102
    v_fmac_f32 v196, v7, v103
    v_mul_f32 v198, v8, v128
    v_fmac_f32 v198, v9, v129
    v_mfma_f32_32x32x16_bf16 v[32:47], v[72:75], v[184:187], v[32:47]
    v_fmac_f32 v198, v10, v130
    v_fmac_f32 v198, v11, v131
    v_fmac_f32 v198, v12, v132
    v_fmac_f32 v198, v13, v133
    v_mfma_f32_32x32x16_bf16 v[48:63], v[76:79], v[184:187], v[48:63]
    v_fmac_f32 v198, v14, v134
    v_fmac_f32 v198, v15, v135
    v_mul_f32 v200, v16, v128
    v_fmac_f32 v200, v17, v129
    v_permlane32_swap_b32 v196, v198
    v_mfma_f32_32x32x16_bf16 v[32:47], v[80:83], v[188:191], v[32:47]
    v_fmac_f32 v200, v18, v130
    v_fmac_f32 v200, v19, v131
    v_fmac_f32 v200, v20, v132
    v_fmac_f32 v200, v21, v133
    v_fmac_f32 v200, v22, v134
    v_mfma_f32_32x32x16_bf16 v[48:63], v[84:87], v[188:191], v[48:63]
    s_waitcnt vmcnt(6)
    ds_read_b64_tr_b16 v[176:177], v244 offset:0
    ds_read_b64_tr_b16 v[178:179], v244 offset:1024
    ds_read_b64_tr_b16 v[180:181], v245 offset:0
    ds_read_b64_tr_b16 v[182:183], v245 offset:1024
    v_fmac_f32 v200, v23, v135
    v_add_f32 v198, v196, v198
    v_mul_f32_e64 v202, v24, -v128
    v_fma_f32 v202, v25, -v129, v202
    v_mfma_f32_32x32x16_bf16 v[32:47], v[88:91], v[192:195], v[32:47]
    v_fma_f32 v202, v26, -v130, v202
    v_fma_f32 v202, v27, -v131, v202
    v_fma_f32 v202, v28, -v132, v202
    v_fma_f32 v202, v29, -v133, v202
    v_fma_f32 v202, v30, -v134, v202
    v_mfma_f32_32x32x16_bf16 v[48:63], v[92:95], v[192:195], v[48:63]
    v_fma_f32 v202, v31, -v135, v202
    s_nop 1
    v_permlane32_swap_b32 v200, v202
    v_add_f32 v202, v200, v202
    s_waitcnt vmcnt(4) lgkmcnt(0)
    v_mfma_f32_32x32x16_bf16 v[0:15], v[64:67], v[176:179], 0
    v_mul_f32 v197, v32, v104
    v_fmac_f32 v197, v33, v105
    v_fmac_f32 v197, v34, v106
    v_fmac_f32 v197, v35, v107
    v_fmac_f32 v197, v36, v108
    s_add_u32 m0, s21, 0
    v_mfma_f32_32x32x16_bf16 v[16:31], v[68:71], v[176:179], 0
    buffer_load_dwordx4 v234, s[4:7], s36 offen  lds
    buffer_load_dwordx4 v235, s[8:11], s36 offen offset:1024  lds
    ds_read_b64_tr_b16 v[176:177], v244 offset:2048
    ds_read_b64_tr_b16 v[178:179], v244 offset:3072
    ds_read_b64_tr_b16 v[184:185], v245 offset:2048
    ds_read_b64_tr_b16 v[186:187], v245 offset:3072
    v_fmac_f32 v197, v37, v109
    v_fmac_f32 v197, v38, v110
    v_fmac_f32 v197, v39, v111
    v_mul_f32 v199, v40, v136
    v_fmac_f32 v199, v41, v137
    s_waitcnt vmcnt(4) lgkmcnt(0)
    v_mfma_f32_32x32x16_bf16 v[0:15], v[72:75], v[176:179], v[0:15]
    v_fmac_f32 v199, v42, v138
    v_fmac_f32 v199, v43, v139
    v_fmac_f32 v199, v44, v140
    v_fmac_f32 v199, v45, v141
    v_fmac_f32 v199, v46, v142
    s_add_u32 m0, s21, 2048
    v_mfma_f32_32x32x16_bf16 v[16:31], v[76:79], v[176:179], v[16:31]
    buffer_load_dwordx4 v236, s[4:7], s36 offen  lds
    buffer_load_dwordx4 v237, s[8:11], s36 offen offset:1024  lds
    ds_read_b64_tr_b16 v[176:177], v244 offset:4096
    ds_read_b64_tr_b16 v[178:179], v244 offset:5120
    ds_read_b64_tr_b16 v[188:189], v245 offset:4096
    ds_read_b64_tr_b16 v[190:191], v245 offset:5120
    v_fmac_f32 v199, v47, v143
    v_mul_f32 v201, v48, v136
    v_fmac_f32 v201, v49, v137
    v_permlane32_swap_b32 v197, v199
    v_fmac_f32 v201, v50, v138
    s_waitcnt vmcnt(4) lgkmcnt(0)
    v_mfma_f32_32x32x16_bf16 v[0:15], v[80:83], v[176:179], v[0:15]
    v_fmac_f32 v201, v51, v139
    v_fmac_f32 v201, v52, v140
    v_fmac_f32 v201, v53, v141
    v_fmac_f32 v201, v54, v142
    v_fmac_f32 v201, v55, v143
    s_add_u32 m0, s21, 4096
    v_mfma_f32_32x32x16_bf16 v[16:31], v[84:87], v[176:179], v[16:31]
    buffer_load_dwordx4 v238, s[4:7], s36 offen  lds
    buffer_load_dwordx4 v239, s[8:11], s36 offen offset:1024  lds
    ds_read_b64_tr_b16 v[176:177], v244 offset:6144
    ds_read_b64_tr_b16 v[178:179], v244 offset:7168
    ds_read_b64_tr_b16 v[192:193], v245 offset:6144
    ds_read_b64_tr_b16 v[194:195], v245 offset:7168
    v_add_f32 v199, v197, v199
    v_mul_f32_e64 v203, v56, -v136
    v_fma_f32 v203, v57, -v137, v203
    v_fma_f32 v203, v58, -v138, v203
    v_fma_f32 v203, v59, -v139, v203
    s_waitcnt lgkmcnt(0)
    v_mfma_f32_32x32x16_bf16 v[0:15], v[88:91], v[176:179], v[0:15]
    v_fma_f32 v203, v60, -v140, v203
    v_fma_f32 v203, v61, -v141, v203
    v_fma_f32 v203, v62, -v142, v203
    v_fma_f32 v203, v63, -v143, v203
    s_nop 1
    s_add_u32 m0, s21, 6144
    v_mfma_f32_32x32x16_bf16 v[16:31], v[92:95], v[176:179], v[16:31]
    buffer_load_dwordx4 v240, s[4:7], s36 offen  lds
    buffer_load_dwordx4 v241, s[8:11], s36 offen offset:1024  lds
    v_permlane32_swap_b32 v201, v203
    v_add_f32 v203, v201, v203
    v_cvt_pk_bf16_f32 v198, v198, v199
    v_cvt_pk_bf16_f32 v202, v202, v203
    ds_write2st64_b32 v253, v198, v202 offset0:0 offset1:1
    v_mfma_f32_32x32x16_bf16 v[32:47], v[64:67], v[180:183], 0
    v_mul_f32 v196, v0, v144
    v_fmac_f32 v196, v1, v145
    v_fmac_f32 v196, v2, v146
    v_fmac_f32 v196, v3, v147
    v_mfma_f32_32x32x16_bf16 v[48:63], v[68:71], v[180:183], 0
    v_fmac_f32 v196, v4, v148
    v_fmac_f32 v196, v5, v149
    v_fmac_f32 v196, v6, v150
    v_fmac_f32 v196, v7, v151
    v_mfma_f32_32x32x16_bf16 v[32:47], v[72:75], v[184:187], v[32:47]
    v_mul_f32 v198, v8, v112
    v_fmac_f32 v198, v9, v113
    v_fmac_f32 v198, v10, v114
    v_fmac_f32 v198, v11, v115
    v_mfma_f32_32x32x16_bf16 v[48:63], v[76:79], v[184:187], v[48:63]
    v_fmac_f32 v198, v12, v116
    v_fmac_f32 v198, v13, v117
    v_fmac_f32 v198, v14, v118
    v_fmac_f32 v198, v15, v119
    v_mfma_f32_32x32x16_bf16 v[32:47], v[80:83], v[188:191], v[32:47]
    v_mul_f32_e64 v200, v16, -v160
    v_fma_f32 v200, v17, -v161, v200
    v_fma_f32 v200, v18, -v162, v200
    v_fma_f32 v200, v19, -v163, v200
    v_mfma_f32_32x32x16_bf16 v[48:63], v[84:87], v[188:191], v[48:63]
    s_waitcnt vmcnt(6)
    ds_read_b64_tr_b16 v[176:177], v244 offset:0
    ds_read_b64_tr_b16 v[178:179], v244 offset:1024
    ds_read_b64_tr_b16 v[180:181], v245 offset:0
    ds_read_b64_tr_b16 v[182:183], v245 offset:1024
    v_fma_f32 v200, v20, -v164, v200
    v_fma_f32 v200, v21, -v165, v200
    v_fma_f32 v200, v22, -v166, v200
    v_fma_f32 v200, v23, -v167, v200
    v_mfma_f32_32x32x16_bf16 v[32:47], v[88:91], v[192:195], v[32:47]
    v_mul_f32_e64 v202, v24, -v160
    v_fma_f32 v202, v25, -v161, v202
    v_fma_f32 v202, v26, -v162, v202
    v_fma_f32 v202, v27, -v163, v202
    v_mfma_f32_32x32x16_bf16 v[48:63], v[92:95], v[192:195], v[48:63]
    v_fma_f32 v202, v28, -v164, v202
    v_fma_f32 v202, v29, -v165, v202
    v_fma_f32 v202, v30, -v166, v202
    v_fma_f32 v202, v31, -v167, v202
    s_waitcnt vmcnt(4) lgkmcnt(0)
    v_mfma_f32_32x32x16_bf16 v[0:15], v[64:67], v[176:179], 0
    s_nop 0
    v_mul_f32 v197, v32, v152
    v_fmac_f32 v197, v33, v153
    v_fmac_f32 v197, v34, v154
    v_fmac_f32 v197, v35, v155
    s_add_u32 m0, s21, 0
    v_mfma_f32_32x32x16_bf16 v[16:31], v[68:71], v[176:179], 0
    buffer_load_dwordx4 v234, s[4:7], s37 offen  lds
    buffer_load_dwordx4 v235, s[8:11], s37 offen offset:1024  lds
    ds_read_b64_tr_b16 v[176:177], v244 offset:2048
    ds_read_b64_tr_b16 v[178:179], v244 offset:3072
    ds_read_b64_tr_b16 v[184:185], v245 offset:2048
    ds_read_b64_tr_b16 v[186:187], v245 offset:3072
    v_add_u32 v252, s42, v247
    ds_read_u16 v234, v252
    ds_read_u16 v235, v252 offset:64
    v_fmac_f32 v197, v36, v156
    v_fmac_f32 v197, v37, v157
    v_fmac_f32 v197, v38, v158
    v_fmac_f32 v197, v39, v159
    s_waitcnt vmcnt(4) lgkmcnt(2)
    v_mfma_f32_32x32x16_bf16 v[0:15], v[72:75], v[176:179], v[0:15]
    v_mul_f32 v199, v40, v120
    v_fmac_f32 v199, v41, v121
    v_fmac_f32 v199, v42, v122
    v_fmac_f32 v199, v43, v123
    s_add_u32 m0, s21, 2048
    v_mfma_f32_32x32x16_bf16 v[16:31], v[76:79], v[176:179], v[16:31]
    buffer_load_dwordx4 v236, s[4:7], s37 offen  lds
    buffer_load_dwordx4 v237, s[8:11], s37 offen offset:1024  lds
    ds_read_b64_tr_b16 v[176:177], v244 offset:4096
    ds_read_b64_tr_b16 v[178:179], v244 offset:5120
    ds_read_b64_tr_b16 v[188:189], v245 offset:4096
    ds_read_b64_tr_b16 v[190:191], v245 offset:5120
    v_add_u32 v252, s43, v247
    ds_read_u16 v236, v252
    ds_read_u16 v237, v252 offset:64
    v_fmac_f32 v199, v44, v124
    v_fmac_f32 v199, v45, v125
    v_fmac_f32 v199, v46, v126
    v_fmac_f32 v199, v47, v127
    s_waitcnt vmcnt(4) lgkmcnt(2)
    v_mfma_f32_32x32x16_bf16 v[0:15], v[80:83], v[176:179], v[0:15]
    v_mul_f32_e64 v201, v48, -v168
    v_fma_f32 v201, v49, -v169, v201
    v_fma_f32 v201, v50, -v170, v201
    v_fma_f32 v201, v51, -v171, v201
    s_add_u32 m0, s21, 4096
    v_mfma_f32_32x32x16_bf16 v[16:31], v[84:87], v[176:179], v[16:31]
    buffer_load_dwordx4 v238, s[4:7], s37 offen  lds
    buffer_load_dwordx4 v239, s[8:11], s37 offen offset:1024  lds
    ds_read_b64_tr_b16 v[176:177], v244 offset:6144
    ds_read_b64_tr_b16 v[178:179], v244 offset:7168
    ds_read_b64_tr_b16 v[192:193], v245 offset:6144
    ds_read_b64_tr_b16 v[194:195], v245 offset:7168
    v_add_u32 v252, s44, v247
    ds_read_u16 v238, v252
    ds_read_u16 v239, v252 offset:64
    v_fma_f32 v201, v52, -v172, v201
    v_fma_f32 v201, v53, -v173, v201
    v_fma_f32 v201, v54, -v174, v201
    v_fma_f32 v201, v55, -v175, v201
    s_waitcnt lgkmcnt(2)
    v_mfma_f32_32x32x16_bf16 v[0:15], v[88:91], v[176:179], v[0:15]
    v_mul_f32_e64 v203, v56, -v168
    v_fma_f32 v203, v57, -v169, v203
    v_fma_f32 v203, v58, -v170, v203
    v_fma_f32 v203, v59, -v171, v203
    s_add_u32 m0, s21, 6144
    v_mfma_f32_32x32x16_bf16 v[16:31], v[92:95], v[176:179], v[16:31]
    buffer_load_dwordx4 v240, s[4:7], s37 offen  lds
    buffer_load_dwordx4 v241, s[8:11], s37 offen offset:1024  lds
    v_add_u32 v252, s45, v247
    ds_read_u16 v240, v252
    ds_read_u16 v241, v252 offset:64
    v_fma_f32 v203, v60, -v172, v203
    v_fma_f32 v203, v61, -v173, v203
    v_fma_f32 v203, v62, -v174, v203
    v_fma_f32 v203, v63, -v175, v203
    v_mfma_f32_32x32x16_bf16 v[32:47], v[64:67], v[180:183], 0
    v_mul_f32 v254, v0, v144
    v_fmac_f32 v254, v1, v145
    v_fmac_f32 v254, v2, v146
    v_mfma_f32_32x32x16_bf16 v[48:63], v[68:71], v[180:183], 0
    ds_swizzle_b32 v68, v68 offset:0x401F
    ds_swizzle_b32 v69, v69 offset:0x401F
    ds_swizzle_b32 v70, v70 offset:0x401F
    ds_swizzle_b32 v71, v71 offset:0x401F
    v_fmac_f32 v254, v3, v147
    v_fmac_f32 v254, v4, v148
    v_mfma_f32_32x32x16_bf16 v[32:47], v[72:75], v[184:187], v[32:47]
    v_fmac_f32 v254, v5, v149
    v_fmac_f32 v254, v6, v150
    v_mfma_f32_32x32x16_bf16 v[48:63], v[76:79], v[184:187], v[48:63]
    ds_swizzle_b32 v76, v76 offset:0x401F
    ds_swizzle_b32 v77, v77 offset:0x401F
    ds_swizzle_b32 v78, v78 offset:0x401F
    ds_swizzle_b32 v79, v79 offset:0x401F
    v_fmac_f32 v254, v7, v151
    v_fmac_f32 v200, v8, v160
    v_mfma_f32_32x32x16_bf16 v[32:47], v[80:83], v[188:191], v[32:47]
    v_fmac_f32 v200, v9, v161
    v_permlane32_swap_b32 v196, v254
    v_fmac_f32 v200, v10, v162
    v_mfma_f32_32x32x16_bf16 v[48:63], v[84:87], v[188:191], v[48:63]
    ds_swizzle_b32 v84, v84 offset:0x401F
    ds_swizzle_b32 v85, v85 offset:0x401F
    ds_swizzle_b32 v86, v86 offset:0x401F
    ds_swizzle_b32 v87, v87 offset:0x401F
    s_waitcnt vmcnt(6)
    ds_read_b64_tr_b16 v[176:177], v244 offset:0
    ds_read_b64_tr_b16 v[178:179], v244 offset:1024
    ds_read_b64_tr_b16 v[180:181], v245 offset:0
    ds_read_b64_tr_b16 v[182:183], v245 offset:1024
    v_fmac_f32 v200, v11, v163
    v_fmac_f32 v200, v12, v164
    v_mfma_f32_32x32x16_bf16 v[32:47], v[88:91], v[192:195], v[32:47]
    v_fmac_f32 v200, v13, v165
    v_fmac_f32 v200, v14, v166
    v_mfma_f32_32x32x16_bf16 v[48:63], v[92:95], v[192:195], v[48:63]
    ds_swizzle_b32 v92, v92 offset:0x401F
    ds_swizzle_b32 v93, v93 offset:0x401F
    ds_swizzle_b32 v94, v94 offset:0x401F
    ds_swizzle_b32 v95, v95 offset:0x401F
    v_fmac_f32 v200, v15, v167
    v_add_f32 v254, v196, v254
    s_waitcnt lgkmcnt(8)
    s_mov_b64 exec, s[56:57]
    v_xor_b32 v68, 0x80008000, v68
    v_xor_b32 v69, 0x80008000, v69
    v_xor_b32 v70, 0x80008000, v70
    v_xor_b32 v71, 0x80008000, v71
    v_xor_b32 v76, 0x80008000, v76
    v_xor_b32 v77, 0x80008000, v77
    v_xor_b32 v78, 0x80008000, v78
    v_xor_b32 v79, 0x80008000, v79
    v_xor_b32 v84, 0x80008000, v84
    v_xor_b32 v85, 0x80008000, v85
    v_xor_b32 v86, 0x80008000, v86
    v_xor_b32 v87, 0x80008000, v87
    s_mov_b64 exec, -1
    s_waitcnt vmcnt(4) lgkmcnt(4)
    v_mfma_f32_32x32x16_bf16 v[0:15], v[64:67], v[176:179], 0
    v_mul_f32 v255, v32, v152
    v_fmac_f32 v255, v33, v153
    v_fmac_f32 v255, v34, v154
    s_add_u32 m0, s21, 0
    s_cmp_eq_u32 s50, 4
    v_mfma_f32_32x32x16_bf16 v[16:31], v[68:71], v[176:179], v[16:31]
    s_cbranch_scc1 WL_8_0
    v_lshl_add_u32 v234, v234, 10, v246
    v_lshl_add_u32 v235, v235, 10, v246
    buffer_load_dwordx4 v234, s[4:7], s38 offen  lds
    buffer_load_dwordx4 v235, s[8:11], s38 offen offset:1024  lds
WR_8_0:
    ds_read_b64_tr_b16 v[176:177], v244 offset:2048
    ds_read_b64_tr_b16 v[178:179], v244 offset:3072
    ds_read_b64_tr_b16 v[184:185], v245 offset:2048
    ds_read_b64_tr_b16 v[186:187], v245 offset:3072
    v_fmac_f32 v255, v35, v155
    v_fmac_f32 v255, v36, v156
    s_waitcnt vmcnt(4) lgkmcnt(0)
    v_mfma_f32_32x32x16_bf16 v[0:15], v[72:75], v[176:179], v[0:15]
    v_fmac_f32 v255, v37, v157
    v_fmac_f32 v255, v38, v158
    v_fmac_f32 v255, v39, v159
    s_add_u32 m0, s21, 2048
    s_cmp_eq_u32 s50, 4
    v_mfma_f32_32x32x16_bf16 v[16:31], v[76:79], v[176:179], v[16:31]
    s_cbranch_scc1 WL_8_1
    v_lshl_add_u32 v236, v236, 10, v246
    v_lshl_add_u32 v237, v237, 10, v246
    buffer_load_dwordx4 v236, s[4:7], s39 offen  lds
    buffer_load_dwordx4 v237, s[8:11], s39 offen offset:1024  lds
WR_8_1:
    ds_read_b64_tr_b16 v[176:177], v244 offset:4096
    ds_read_b64_tr_b16 v[178:179], v244 offset:5120
    ds_read_b64_tr_b16 v[188:189], v245 offset:4096
    ds_read_b64_tr_b16 v[190:191], v245 offset:5120
    v_fmac_f32 v201, v40, v168
    v_fmac_f32 v201, v41, v169
    s_waitcnt vmcnt(4) lgkmcnt(0)
    v_mfma_f32_32x32x16_bf16 v[0:15], v[80:83], v[176:179], v[0:15]
    v_permlane32_swap_b32 v197, v255
    v_fmac_f32 v201, v42, v170
    v_fmac_f32 v201, v43, v171
    s_add_u32 m0, s21, 4096
    s_cmp_eq_u32 s50, 4
    v_mfma_f32_32x32x16_bf16 v[16:31], v[84:87], v[176:179], v[16:31]
    s_cbranch_scc1 WL_8_2
    v_lshl_add_u32 v238, v238, 10, v246
    v_lshl_add_u32 v239, v239, 10, v246
    buffer_load_dwordx4 v238, s[4:7], s40 offen  lds
    buffer_load_dwordx4 v239, s[8:11], s40 offen offset:1024  lds
WR_8_2:
    ds_read_b64_tr_b16 v[176:177], v244 offset:6144
    ds_read_b64_tr_b16 v[178:179], v244 offset:7168
    ds_read_b64_tr_b16 v[192:193], v245 offset:6144
    ds_read_b64_tr_b16 v[194:195], v245 offset:7168
    v_fmac_f32 v201, v44, v172
    v_fmac_f32 v201, v45, v173
    s_waitcnt lgkmcnt(0)
    s_mov_b64 exec, s[56:57]
    v_xor_b32 v92, 0x80008000, v92
    v_xor_b32 v93, 0x80008000, v93
    v_xor_b32 v94, 0x80008000, v94
    v_xor_b32 v95, 0x80008000, v95
    s_mov_b64 exec, -1
    v_mfma_f32_32x32x16_bf16 v[0:15], v[88:91], v[176:179], v[0:15]
    v_fmac_f32 v201, v46, v174
    v_fmac_f32 v201, v47, v175
    v_add_f32 v255, v197, v255
    s_add_u32 m0, s21, 6144
    s_cmp_eq_u32 s50, 4
    v_mfma_f32_32x32x16_bf16 v[16:31], v[92:95], v[176:179], v[16:31]
    s_cbranch_scc1 WL_8_3
    v_lshl_add_u32 v240, v240, 10, v246
    v_lshl_add_u32 v241, v241, 10, v246
    buffer_load_dwordx4 v240, s[4:7], s41 offen  lds
    buffer_load_dwordx4 v241, s[8:11], s41 offen offset:1024  lds
WR_8_3:
    v_cvt_pk_bf16_f32 v254, v254, v255
    ds_write_b32 v253, v254 offset:512
    v_mfma_f32_32x32x16_bf16 v[32:47], v[64:67], v[180:183], 0
    v_mul_f32 v254, v0, v144
    v_fmac_f32 v254, v1, v145
    v_fmac_f32 v254, v2, v146
    v_fmac_f32 v254, v3, v147
    v_fmac_f32 v254, v4, v148
    v_mfma_f32_32x32x16_bf16 v[48:63], v[68:71], v[180:183], v[48:63]
    v_fmac_f32 v254, v5, v149
    v_fmac_f32 v254, v6, v150
    v_fmac_f32 v254, v7, v151
    v_fma_f32 v202, v8, -v160, v202
    v_fma_f32 v202, v9, -v161, v202
    v_mfma_f32_32x32x16_bf16 v[32:47], v[72:75], v[184:187], v[32:47]
    v_permlane32_swap_b32 v254, v200
    v_fma_f32 v202, v10, -v162, v202
    v_fma_f32 v202, v11, -v163, v202
    v_fma_f32 v202, v12, -v164, v202
    v_fma_f32 v202, v13, -v165, v202
    v_mfma_f32_32x32x16_bf16 v[48:63], v[76:79], v[184:187], v[48:63]
    v_fma_f32 v202, v14, -v166, v202
    v_fma_f32 v202, v15, -v167, v202
    v_add_f32 v200, v254, v200
    v_fmac_f32 v198, v16, v112
    v_permlane32_swap_b32 v202, v254
    v_mfma_f32_32x32x16_bf16 v[32:47], v[80:83], v[188:191], v[32:47]
    v_fmac_f32 v198, v17, v113
    v_fmac_f32 v198, v18, v114
    v_fmac_f32 v198, v19, v115
    v_fmac_f32 v198, v20, v116
    v_fmac_f32 v198, v21, v117
    v_mfma_f32_32x32x16_bf16 v[48:63], v[84:87], v[188:191], v[48:63]
    s_waitcnt vmcnt(6)
    ds_read_b64_tr_b16 v[176:177], v244 offset:0
    ds_read_b64_tr_b16 v[178:179], v244 offset:1024
    ds_read_b64_tr_b16 v[180:181], v245 offset:0
    ds_read_b64_tr_b16 v[182:183], v245 offset:1024
    v_fmac_f32 v198, v22, v118
    v_fmac_f32 v198, v23, v119
    v_add_f32 v254, v202, v254
    v_mul_f32 v196, v24, v160
    v_fmac_f32 v196, v25, v161
    v_mfma_f32_32x32x16_bf16 v[32:47], v[88:91], v[192:195], v[32:47]
    v_fmac_f32 v196, v26, v162
    v_fmac_f32 v196, v27, v163
    v_fmac_f32 v196, v28, v164
    v_fmac_f32 v196, v29, v165
    v_fmac_f32 v196, v30, v166
    v_mfma_f32_32x32x16_bf16 v[48:63], v[92:95], v[192:195], v[48:63]
    v_add_u32 v249, s48, v249
    v_add_u32 v250, s49, v250
    ds_read_b32 v252, v251 offset:16
    ds_read_b64_tr_b16 v[64:65], v249 offset:0
    ds_read_b64_tr_b16 v[68:69], v249 offset:64
    ds_read_b64_tr_b16 v[66:67], v249 offset:256
    ds_read_b64_tr_b16 v[70:71], v249 offset:320
    s_mov_b64 exec, s[54:55]
    ds_read_u16_d16_hi v242, v250 offset:0
    s_mov_b64 exec, -1
    v_fmac_f32 v196, v31, v167
    s_nop 1
    v_permlane32_swap_b32 v198, v196
    v_add_f32 v196, v198, v196
    s_cmp_eq_u32 s50, 4
    s_cbranch_scc1 LEPI_1
    v_mul_f32 v255, v32, v152
    v_fmac_f32 v255, v33, v153
    v_fmac_f32 v255, v34, v154
    v_fmac_f32 v255, v35, v155
    v_fmac_f32 v255, v36, v156
    v_fmac_f32 v255, v37, v157
    v_fmac_f32 v255, v38, v158
    v_fmac_f32 v255, v39, v159
    v_fma_f32 v203, v40, -v168, v203
    v_fma_f32 v203, v41, -v169, v203
    v_permlane32_swap_b32 v255, v201
    v_fma_f32 v203, v42, -v170, v203
    v_fma_f32 v203, v43, -v171, v203
    v_fma_f32 v203, v44, -v172, v203
    v_fma_f32 v203, v45, -v173, v203
    v_fma_f32 v203, v46, -v174, v203
    v_fma_f32 v203, v47, -v175, v203
    v_add_f32 v201, v255, v201
    v_fmac_f32 v199, v48, v120
    v_permlane32_swap_b32 v203, v255
    v_fmac_f32 v199, v49, v121
    v_fmac_f32 v199, v50, v122
    v_fmac_f32 v199, v51, v123
    v_fmac_f32 v199, v52, v124
    v_fmac_f32 v199, v53, v125
    v_fmac_f32 v199, v54, v126
    v_fmac_f32 v199, v55, v127
    v_add_f32 v255, v203, v255
    v_mul_f32 v197, v56, v168
    v_fmac_f32 v197, v57, v169
    v_fmac_f32 v197, v58, v170
    v_fmac_f32 v197, v59, v171
    v_fmac_f32 v197, v60, v172
    v_fmac_f32 v197, v61, v173
    v_fmac_f32 v197, v62, v174
    v_fmac_f32 v197, v63, v175
    s_nop 1
    v_permlane32_swap_b32 v199, v197
    v_add_f32 v197, v199, v197
    v_cvt_pk_bf16_f32 v200, v200, v201
    v_cvt_pk_bf16_f32 v254, v254, v255
    v_cvt_pk_bf16_f32 v196, v196, v197
    ds_write2st64_b32 v253, v200, v196 offset0:3 offset1:4
    s_mov_b64 exec, 0xffffffff
    ds_write_b32 v253, v254 offset:1280
    s_mov_b64 exec, -1
    s_add_u32 s50, s50, 1
    s_cmp_ge_u32 s50, 4
    s_cbranch_scc1 LAST1
    s_waitcnt lgkmcnt(7)
    v_readfirstlane_b32 s66, v252
    s_add_u32 s53, s53, 1
    v_mov_b32 v252, s53
    s_cmp_le_u32 s53, s66
    ds_write2_b32 v251, v252, v252 offset0:0 offset1:8
    s_setprio 1
    s_cbranch_scc1 PRIO_15
    s_setprio 0
PRIO_15:
    s_cmp_eq_u32 s52, 4
    s_cbranch_scc1 ITEM_1_4
    s_cmp_eq_u32 s52, 5
    s_cbranch_scc1 ITEM_1_5
    s_cmp_eq_u32 s52, 3
    s_cbranch_scc1 ITEM_1_3
    s_cmp_eq_u32 s52, 6
    s_cbranch_scc1 ITEM_1_6
    s_cmp_eq_u32 s52, 8
    s_cbranch_scc1 ITEM_1_8
    s_branch ITEM_1_2
WL_8_0:
    s_add_u32 s66, s51, 0
    buffer_load_dwordx4 v[96:99], v246, s[16:19], s66 offen offset:2048 sc1
    buffer_load_dwordx4 v[100:103], v246, s[16:19], s66 offen offset:3072 sc1
    s_branch WR_8_0
WL_8_1:
    s_add_u32 s66, s51, 4096
    buffer_load_dwordx4 v[104:107], v246, s[16:19], s66 offen offset:2048 sc1
    buffer_load_dwordx4 v[108:111], v246, s[16:19], s66 offen offset:3072 sc1
    s_branch WR_8_1
WL_8_2:
    s_add_u32 s66, s51, 8192
    buffer_load_dwordx4 v[128:131], v246, s[16:19], s66 offen offset:2048 sc1
    buffer_load_dwordx4 v[132:135], v246, s[16:19], s66 offen offset:3072 sc1
    s_branch WR_8_2
WL_8_3:
    s_add_u32 s66, s51, 12288
    buffer_load_dwordx4 v[136:139], v246, s[16:19], s66 offen offset:2048 sc1
    buffer_load_dwordx4 v[140:143], v246, s[16:19], s66 offen offset:3072 sc1
    s_branch WR_8_3
.p2align 6
ITEM_1_2:
    s_mov_b32 m0, s50
    s_nop 0
    s_movrels_b32 s71, s23
    s_movrels_b32 s33, s28
    s_and_b32 s70, s33, 0x70
    s_andn2_b32 s33, s33, 0x70
    v_xor_b32 v253, s70, v248
    v_add_u32 v253, s33, v253
    s_bfe_u32 s46, s71, 0x30012
    s_mov_b32 m0, s46
    s_and_b32 s66, s71, 0x3ffff
    s_movrels_b32 s68, s57
    s_movrels_b32 s69, s61
    s_sub_u32 s48, s66, s47
    s_mov_b32 s47, s66
    s_lshr_b32 s52, s71, 28
    s_lshl_b32 s67, s46, 9
    s_add_u32 s66, s66, s67
    s_sub_u32 s49, s66, s42
    s_mov_b32 s42, s66
    s_bfe_u32 s66, s68, 655360
    s_add_u32 s43, s42, s66
    s_bfe_u32 s39, s69, 655360
    s_bfe_u32 s66, s68, 655370
    s_add_u32 s44, s42, s66
    s_bfe_u32 s40, s69, 655370
    s_bfe_u32 s66, s68, 655380
    s_add_u32 s45, s42, s66
    s_bfe_u32 s41, s69, 655380
    v_add_u32 v252, s42, v247
    ds_read_u16 v234, v252
    ds_read_u16 v235, v252 offset:64
    v_add_u32 v252, s43, v247
    ds_read_u16 v236, v252
    ds_read_u16 v237, v252 offset:64
    v_add_u32 v252, s44, v247
    ds_read_u16 v238, v252
    ds_read_u16 v239, v252 offset:64
    v_add_u32 v252, s45, v247
    ds_read_u16 v240, v252
    ds_read_u16 v241, v252 offset:64
    s_waitcnt lgkmcnt(8)
    v_mul_f32_dpp v196, v242, v64 row_newbcast:0 row_mask:0xf bank_mask:0xf
    v_mul_f32_dpp v197, v242, v65 row_newbcast:1 row_mask:0xf bank_mask:0xf
    v_mul_f32_dpp v198, v242, v64 row_newbcast:8 row_mask:0xf bank_mask:0xf
    v_mul_f32_dpp v199, v242, v65 row_newbcast:9 row_mask:0xf bank_mask:0xf
    v_mul_f32_dpp v200, v242, v68 row_newbcast:2 row_mask:0xf bank_mask:0xf
    v_mul_f32_dpp v201, v242, v69 row_newbcast:3 row_mask:0xf bank_mask:0xf
    v_mul_f32_dpp v202, v242, v68 row_newbcast:10 row_mask:0xf bank_mask:0xf
    v_mul_f32_dpp v203, v242, v69 row_newbcast:11 row_mask:0xf bank_mask:0xf
    v_cvt_pk_bf16_f32 v64, v196, v197
    v_cvt_pk_bf16_f32 v68, v198, v199
    v_cvt_pk_bf16_f32 v65, v200, v201
    v_cvt_pk_bf16_f32 v69, v202, v203
    v_mul_f32_dpp v196, v242, v66 row_newbcast:4 row_mask:0xf bank_mask:0xf
    v_mul_f32_dpp v197, v242, v67 row_newbcast:5 row_mask:0xf bank_mask:0xf
    v_mul_f32_dpp v198, v242, v66 row_newbcast:12 row_mask:0xf bank_mask:0xf
    v_mul_f32_dpp v199, v242, v67 row_newbcast:13 row_mask:0xf bank_mask:0xf
    v_mul_f32_dpp v200, v242, v70 row_newbcast:6 row_mask:0xf bank_mask:0xf
    v_mul_f32_dpp v201, v242, v71 row_newbcast:7 row_mask:0xf bank_mask:0xf
    v_mul_f32_dpp v202, v242, v70 row_newbcast:14 row_mask:0xf bank_mask:0xf
    v_mul_f32_dpp v203, v242, v71 row_newbcast:15 row_mask:0xf bank_mask:0xf
    v_cvt_pk_bf16_f32 v66, v196, v197
    v_cvt_pk_bf16_f32 v70, v198, v199
    v_cvt_pk_bf16_f32 v67, v200, v201
    v_cvt_pk_bf16_f32 v71, v202, v203
    s_nop 0
    s_waitcnt lgkmcnt(6)
    v_mfma_f32_32x32x16_bf16 v[0:15], v[64:67], v[176:179], 0
    s_add_u32 m0, s21, 0
    s_cmp_eq_u32 s50, 4
    v_mfma_f32_32x32x16_bf16 v[16:31], v[68:71], v[176:179], 0
    s_cbranch_scc1 WL_2_0
    v_lshl_add_u32 v234, v234, 10, v246
    v_lshl_add_u32 v235, v235, 10, v246
    buffer_load_dwordx4 v234, s[4:7], s38 offen  lds
    buffer_load_dwordx4 v235, s[8:11], s38 offen offset:1024  lds
WR_2_0:
    v_mfma_f32_32x32x16_bf16 v[32:47], v[64:67], v[180:183], 0
    s_nop 2
    v_mul_f32 v196, v0, v96
    v_fmac_f32 v196, v1, v97
    v_fmac_f32 v196, v2, v98
    v_fmac_f32 v196, v3, v99
    v_fmac_f32 v196, v4, v100
    v_fmac_f32 v196, v5, v101
    v_fmac_f32 v196, v6, v102
    v_fmac_f32 v196, v7, v103
    v_mul_f32 v198, v8, v128
    v_fmac_f32 v198, v9, v129
    v_fmac_f32 v198, v10, v130
    v_fmac_f32 v198, v11, v131
    v_fmac_f32 v198, v12, v132
    v_fmac_f32 v198, v13, v133
    v_fmac_f32 v198, v14, v134
    v_fmac_f32 v198, v15, v135
    v_mul_f32 v200, v16, v128
    v_fmac_f32 v200, v17, v129
    v_permlane32_swap_b32 v196, v198
    v_mfma_f32_32x32x16_bf16 v[48:63], v[68:71], v[180:183], 0
    s_waitcnt vmcnt(6)
    ds_read_b64_tr_b16 v[176:177], v244 offset:2048
    ds_read_b64_tr_b16 v[178:179], v244 offset:3072
    ds_read_b64_tr_b16 v[180:181], v245 offset:2048
    ds_read_b64_tr_b16 v[182:183], v245 offset:3072
    v_fmac_f32 v200, v18, v130
    v_fmac_f32 v200, v19, v131
    v_fmac_f32 v200, v20, v132
    v_fmac_f32 v200, v21, v133
    v_fmac_f32 v200, v22, v134
    v_fmac_f32 v200, v23, v135
    v_add_f32 v198, v196, v198
    v_mul_f32_e64 v202, v24, -v128
    v_fma_f32 v202, v25, -v129, v202
    v_fma_f32 v202, v26, -v130, v202
    v_fma_f32 v202, v27, -v131, v202
    v_fma_f32 v202, v28, -v132, v202
    v_fma_f32 v202, v29, -v133, v202
    v_fma_f32 v202, v30, -v134, v202
    v_fma_f32 v202, v31, -v135, v202
    s_nop 1
    v_permlane32_swap_b32 v200, v202
    v_add_f32 v202, v200, v202
    s_waitcnt lgkmcnt(0)
    v_mfma_f32_32x32x16_bf16 v[0:15], v[64:67], v[176:179], 0
    v_mul_f32 v197, v32, v104
    v_fmac_f32 v197, v33, v105
    v_fmac_f32 v197, v34, v106
    v_fmac_f32 v197, v35, v107
    v_fmac_f32 v197, v36, v108
    v_fmac_f32 v197, v37, v109
    v_fmac_f32 v197, v38, v110
    v_fmac_f32 v197, v39, v111
    v_mul_f32 v199, v40, v136
    v_fmac_f32 v199, v41, v137
    v_fmac_f32 v199, v42, v138
    v_fmac_f32 v199, v43, v139
    v_fmac_f32 v199, v44, v140
    v_fmac_f32 v199, v45, v141
    v_fmac_f32 v199, v46, v142
    v_fmac_f32 v199, v47, v143
    v_mul_f32 v201, v48, v136
    v_fmac_f32 v201, v49, v137
    v_permlane32_swap_b32 v197, v199
    v_fmac_f32 v201, v50, v138
    s_add_u32 m0, s21, 2048
    s_cmp_eq_u32 s50, 4
    v_mfma_f32_32x32x16_bf16 v[16:31], v[68:71], v[176:179], 0
    s_cbranch_scc1 WL_2_1
    v_lshl_add_u32 v236, v236, 10, v246
    v_lshl_add_u32 v237, v237, 10, v246
    buffer_load_dwordx4 v236, s[4:7], s39 offen  lds
    buffer_load_dwordx4 v237, s[8:11], s39 offen offset:1024  lds
WR_2_1:
    v_fmac_f32 v201, v51, v139
    v_fmac_f32 v201, v52, v140
    v_fmac_f32 v201, v53, v141
    v_fmac_f32 v201, v54, v142
    v_fmac_f32 v201, v55, v143
    v_add_f32 v199, v197, v199
    v_mul_f32_e64 v203, v56, -v136
    v_fma_f32 v203, v57, -v137, v203
    v_fma_f32 v203, v58, -v138, v203
    v_fma_f32 v203, v59, -v139, v203
    v_fma_f32 v203, v60, -v140, v203
    v_fma_f32 v203, v61, -v141, v203
    v_fma_f32 v203, v62, -v142, v203
    v_fma_f32 v203, v63, -v143, v203
    s_nop 1
    v_permlane32_swap_b32 v201, v203
    v_add_f32 v203, v201, v203
    v_cvt_pk_bf16_f32 v192, v198, v199
    v_cvt_pk_bf16_f32 v193, v202, v203
    v_mfma_f32_32x32x16_bf16 v[32:47], v[64:67], v[180:183], 0
    v_mul_f32 v196, v0, v144
    v_fmac_f32 v196, v1, v145
    v_fmac_f32 v196, v2, v146
    v_fmac_f32 v196, v3, v147
    v_fmac_f32 v196, v4, v148
    v_fmac_f32 v196, v5, v149
    v_fmac_f32 v196, v6, v150
    v_fmac_f32 v196, v7, v151
    v_mul_f32 v198, v8, v112
    v_fmac_f32 v198, v9, v113
    v_fmac_f32 v198, v10, v114
    v_fmac_f32 v198, v11, v115
    v_fmac_f32 v198, v12, v116
    v_fmac_f32 v198, v13, v117
    v_fmac_f32 v198, v14, v118
    v_fmac_f32 v198, v15, v119
    v_mfma_f32_32x32x16_bf16 v[48:63], v[68:71], v[180:183], 0
    s_waitcnt vmcnt(6)
    ds_read_b64_tr_b16 v[176:177], v244 offset:4096
    ds_read_b64_tr_b16 v[178:179], v244 offset:5120
    ds_read_b64_tr_b16 v[180:181], v245 offset:4096
    ds_read_b64_tr_b16 v[182:183], v245 offset:5120
    v_mul_f32_e64 v200, v16, -v160
    v_fma_f32 v200, v17, -v161, v200
    v_fma_f32 v200, v18, -v162, v200
    v_fma_f32 v200, v19, -v163, v200
    v_fma_f32 v200, v20, -v164, v200
    v_fma_f32 v200, v21, -v165, v200
    v_fma_f32 v200, v22, -v166, v200
    v_fma_f32 v200, v23, -v167, v200
    v_mul_f32_e64 v202, v24, -v160
    v_fma_f32 v202, v25, -v161, v202
    v_fma_f32 v202, v26, -v162, v202
    v_fma_f32 v202, v27, -v163, v202
    v_fma_f32 v202, v28, -v164, v202
    v_fma_f32 v202, v29, -v165, v202
    v_fma_f32 v202, v30, -v166, v202
    v_fma_f32 v202, v31, -v167, v202
    s_waitcnt lgkmcnt(0)
    v_mfma_f32_32x32x16_bf16 v[0:15], v[64:67], v[176:179], 0
    v_mul_f32 v197, v32, v152
    v_fmac_f32 v197, v33, v153
    v_fmac_f32 v197, v34, v154
    v_fmac_f32 v197, v35, v155
    v_fmac_f32 v197, v36, v156
    v_fmac_f32 v197, v37, v157
    v_fmac_f32 v197, v38, v158
    v_fmac_f32 v197, v39, v159
    v_mul_f32 v199, v40, v120
    v_fmac_f32 v199, v41, v121
    v_fmac_f32 v199, v42, v122
    v_fmac_f32 v199, v43, v123
    v_fmac_f32 v199, v44, v124
    v_fmac_f32 v199, v45, v125
    v_fmac_f32 v199, v46, v126
    v_fmac_f32 v199, v47, v127
    s_add_u32 m0, s21, 4096
    s_cmp_eq_u32 s50, 4
    v_mfma_f32_32x32x16_bf16 v[16:31], v[68:71], v[176:179], 0
    s_cbranch_scc1 WL_2_2
    v_lshl_add_u32 v238, v238, 10, v246
    v_lshl_add_u32 v239, v239, 10, v246
    buffer_load_dwordx4 v238, s[4:7], s40 offen  lds
    buffer_load_dwordx4 v239, s[8:11], s40 offen offset:1024  lds
WR_2_2:
    v_mul_f32_e64 v201, v48, -v168
    v_fma_f32 v201, v49, -v169, v201
    v_fma_f32 v201, v50, -v170, v201
    v_fma_f32 v201, v51, -v171, v201
    v_fma_f32 v201, v52, -v172, v201
    v_fma_f32 v201, v53, -v173, v201
    v_fma_f32 v201, v54, -v174, v201
    v_fma_f32 v201, v55, -v175, v201
    v_mul_f32_e64 v203, v56, -v168
    v_fma_f32 v203, v57, -v169, v203
    v_fma_f32 v203, v58, -v170, v203
    v_fma_f32 v203, v59, -v171, v203
    v_fma_f32 v203, v60, -v172, v203
    v_fma_f32 v203, v61, -v173, v203
    v_fma_f32 v203, v62, -v174, v203
    v_fma_f32 v203, v63, -v175, v203
    v_mfma_f32_32x32x16_bf16 v[32:47], v[64:67], v[180:183], 0
    v_mul_f32 v254, v0, v144
    v_fmac_f32 v254, v1, v145
    v_fmac_f32 v254, v2, v146
    v_fmac_f32 v254, v3, v147
    v_fmac_f32 v254, v4, v148
    v_fmac_f32 v254, v5, v149
    v_fmac_f32 v254, v6, v150
    v_fmac_f32 v254, v7, v151
    v_fmac_f32 v200, v8, v160
    v_mfma_f32_32x32x16_bf16 v[48:63], v[68:71], v[180:183], 0
    ds_swizzle_b32 v68, v68 offset:0x401F
    ds_swizzle_b32 v69, v69 offset:0x401F
    ds_swizzle_b32 v70, v70 offset:0x401F
    ds_swizzle_b32 v71, v71 offset:0x401F
    s_waitcnt vmcnt(6)
    ds_read_b64_tr_b16 v[176:177], v244 offset:6144
    ds_read_b64_tr_b16 v[178:179], v244 offset:7168
    ds_read_b64_tr_b16 v[180:181], v245 offset:6144
    ds_read_b64_tr_b16 v[182:183], v245 offset:7168
    v_fmac_f32 v200, v9, v161
    v_permlane32_swap_b32 v196, v254
    v_fmac_f32 v200, v10, v162
    v_fmac_f32 v200, v11, v163
    v_fmac_f32 v200, v12, v164
    v_fmac_f32 v200, v13, v165
    v_fmac_f32 v200, v14, v166
    v_fmac_f32 v200, v15, v167
    v_add_f32 v254, v196, v254
    s_waitcnt lgkmcnt(0)
    s_mov_b64 exec, s[56:57]
    v_xor_b32 v68, 0x80008000, v68
    v_xor_b32 v69, 0x80008000, v69
    v_xor_b32 v70, 0x80008000, v70
    v_xor_b32 v71, 0x80008000, v71
    s_mov_b64 exec, -1
    s_nop 0
    v_mfma_f32_32x32x16_bf16 v[0:15], v[64:67], v[176:179], 0
    v_mul_f32 v255, v32, v152
    v_fmac_f32 v255, v33, v153
    v_fmac_f32 v255, v34, v154
    v_fmac_f32 v255, v35, v155
    v_fmac_f32 v255, v36, v156
    v_fmac_f32 v255, v37, v157
    v_fmac_f32 v255, v38, v158
    v_fmac_f32 v255, v39, v159
    v_fmac_f32 v201, v40, v168
    v_fmac_f32 v201, v41, v169
    s_add_u32 m0, s21, 6144
    s_cmp_eq_u32 s50, 4
    v_mfma_f32_32x32x16_bf16 v[16:31], v[68:71], v[176:179], v[16:31]
    s_cbranch_scc1 WL_2_3
    v_lshl_add_u32 v240, v240, 10, v246
    v_lshl_add_u32 v241, v241, 10, v246
    buffer_load_dwordx4 v240, s[4:7], s41 offen  lds
    buffer_load_dwordx4 v241, s[8:11], s41 offen offset:1024  lds
WR_2_3:
    v_permlane32_swap_b32 v197, v255
    v_fmac_f32 v201, v42, v170
    v_fmac_f32 v201, v43, v171
    v_fmac_f32 v201, v44, v172
    v_fmac_f32 v201, v45, v173
    v_fmac_f32 v201, v46, v174
    v_fmac_f32 v201, v47, v175
    v_add_f32 v255, v197, v255
    v_cvt_pk_bf16_f32 v194, v254, v255
    v_mfma_f32_32x32x16_bf16 v[32:47], v[64:67], v[180:183], 0
    v_mul_f32 v254, v0, v144
    v_fmac_f32 v254, v1, v145
    v_fmac_f32 v254, v2, v146
    v_fmac_f32 v254, v3, v147
    v_fmac_f32 v254, v4, v148
    v_fmac_f32 v254, v5, v149
    v_fmac_f32 v254, v6, v150
    v_fmac_f32 v254, v7, v151
    v_fma_f32 v202, v8, -v160, v202
    v_fma_f32 v202, v9, -v161, v202
    v_permlane32_swap_b32 v254, v200
    v_fma_f32 v202, v10, -v162, v202
    v_fma_f32 v202, v11, -v163, v202
    v_fma_f32 v202, v12, -v164, v202
    v_fma_f32 v202, v13, -v165, v202
    v_fma_f32 v202, v14, -v166, v202
    v_fma_f32 v202, v15, -v167, v202
    v_add_f32 v200, v254, v200
    v_fmac_f32 v198, v16, v112
    v_permlane32_swap_b32 v202, v254
    v_mfma_f32_32x32x16_bf16 v[48:63], v[68:71], v[180:183], v[48:63]
    s_waitcnt vmcnt(6)
    ds_read_b64_tr_b16 v[176:177], v244 offset:0
    ds_read_b64_tr_b16 v[178:179], v244 offset:1024
    ds_read_b64_tr_b16 v[180:181], v245 offset:0
    ds_read_b64_tr_b16 v[182:183], v245 offset:1024
    v_add_u32 v249, s48, v249
    v_add_u32 v250, s49, v250
    ds_read_b32 v252, v251 offset:16
    ds_read_b64_tr_b16 v[64:65], v249 offset:0
    ds_read_b64_tr_b16 v[68:69], v249 offset:64
    ds_read_b64_tr_b16 v[66:67], v249 offset:256
    ds_read_b64_tr_b16 v[70:71], v249 offset:320
    s_mov_b64 exec, s[54:55]
    ds_read_u16_d16_hi v242, v250 offset:0
    s_mov_b64 exec, -1
    v_fmac_f32 v198, v17, v113
    v_fmac_f32 v198, v18, v114
    v_fmac_f32 v198, v19, v115
    v_fmac_f32 v198, v20, v116
    v_fmac_f32 v198, v21, v117
    v_fmac_f32 v198, v22, v118
    v_fmac_f32 v198, v23, v119
    v_add_f32 v254, v202, v254
    v_mul_f32 v196, v24, v160
    v_fmac_f32 v196, v25, v161
    v_fmac_f32 v196, v26, v162
    v_fmac_f32 v196, v27, v163
    v_fmac_f32 v196, v28, v164
    v_fmac_f32 v196, v29, v165
    v_fmac_f32 v196, v30, v166
    v_fmac_f32 v196, v31, v167
    s_nop 1
    v_permlane32_swap_b32 v198, v196
    v_add_f32 v196, v198, v196
    s_cmp_eq_u32 s50, 4
    s_cbranch_scc1 LEPI_2
    v_mul_f32 v255, v32, v152
    v_fmac_f32 v255, v33, v153
    v_fmac_f32 v255, v34, v154
    v_fmac_f32 v255, v35, v155
    v_fmac_f32 v255, v36, v156
    v_fmac_f32 v255, v37, v157
    v_fmac_f32 v255, v38, v158
    v_fmac_f32 v255, v39, v159
    v_fma_f32 v203, v40, -v168, v203
    v_fma_f32 v203, v41, -v169, v203
    v_permlane32_swap_b32 v255, v201
    v_fma_f32 v203, v42, -v170, v203
    v_fma_f32 v203, v43, -v171, v203
    v_fma_f32 v203, v44, -v172, v203
    v_fma_f32 v203, v45, -v173, v203
    v_fma_f32 v203, v46, -v174, v203
    v_fma_f32 v203, v47, -v175, v203
    v_add_f32 v201, v255, v201
    v_fmac_f32 v199, v48, v120
    v_permlane32_swap_b32 v203, v255
    v_fmac_f32 v199, v49, v121
    v_fmac_f32 v199, v50, v122
    v_fmac_f32 v199, v51, v123
    v_fmac_f32 v199, v52, v124
    v_fmac_f32 v199, v53, v125
    v_fmac_f32 v199, v54, v126
    v_fmac_f32 v199, v55, v127
    v_add_f32 v255, v203, v255
    v_mul_f32 v197, v56, v168
    v_fmac_f32 v197, v57, v169
    v_fmac_f32 v197, v58, v170
    v_fmac_f32 v197, v59, v171
    v_fmac_f32 v197, v60, v172
    v_fmac_f32 v197, v61, v173
    v_fmac_f32 v197, v62, v174
    v_fmac_f32 v197, v63, v175
    s_nop 1
    v_permlane32_swap_b32 v199, v197
    v_add_f32 v197, v199, v197
    v_cvt_pk_bf16_f32 v200, v200, v201
    v_cvt_pk_bf16_f32 v254, v254, v255
    v_cvt_pk_bf16_f32 v196, v196, v197
    ds_write2st64_b32 v253, v192, v193 offset0:0 offset1:1
    ds_write2st64_b32 v253, v194, v200 offset0:2 offset1:3
    ds_write_b32 v253, v196 offset:1024
    s_mov_b64 exec, 0xffffffff
    ds_write_b32 v253, v254 offset:1280
    s_mov_b64 exec, -1
    s_add_u32 s50, s50, 1
    s_cmp_ge_u32 s50, 4
    s_cbranch_scc1 LAST1
    s_waitcnt lgkmcnt(9)
    v_readfirstlane_b32 s66, v252
    s_add_u32 s53, s53, 1
    v_mov_b32 v252, s53
    s_cmp_le_u32 s53, s66
    ds_write2_b32 v251, v252, v252 offset0:0 offset1:8
    s_setprio 1
    s_cbranch_scc1 PRIO_16
    s_setprio 0
PRIO_16:
    s_cmp_eq_u32 s52, 4
    s_cbranch_scc1 ITEM_1_4
    s_cmp_eq_u32 s52, 5
    s_cbranch_scc1 ITEM_1_5
    s_cmp_eq_u32 s52, 3
    s_cbranch_scc1 ITEM_1_3
    s_cmp_eq_u32 s52, 6
    s_cbranch_scc1 ITEM_1_6
    s_cmp_eq_u32 s52, 8
    s_cbranch_scc1 ITEM_1_8
    s_branch ITEM_1_2
WL_2_0:
    s_add_u32 s66, s51, 0
    buffer_load_dword v195, v246, s[16:19], s66 offen
    buffer_load_dword v195, v246, s[16:19], s66 offen
    s_branch WR_2_0
WL_2_1:
    s_add_u32 s66, s51, 4096
    buffer_load_dword v195, v246, s[16:19], s66 offen
    buffer_load_dword v195, v246, s[16:19], s66 offen
    s_branch WR_2_1
WL_2_2:
    s_add_u32 s66, s51, 8192
    buffer_load_dword v195, v246, s[16:19], s66 offen
    buffer_load_dword v195, v246, s[16:19], s66 offen
    s_branch WR_2_2
WL_2_3:
    s_add_u32 s66, s51, 12288
    buffer_load_dword v195, v246, s[16:19], s66 offen
    buffer_load_dword v195, v246, s[16:19], s66 offen
    s_branch WR_2_3
.p2align 6
.p2align 6
LEPI_2:
    s_lshl_b32 s71, s20, 4
    s_add_u32 s67, s51, 4096
    s_add_u32 s68, s51, 8192
    s_add_u32 s69, s51, 12288
    s_add_u32 s70, s51, 16384
    s_waitcnt lgkmcnt(0)
    buffer_load_dwordx4 v[96:99], v246, s[16:19], s51 offen offset:2048 sc1
    s_mov_b32 s52, 163072
    v_bfe_u32 v177, v248, 2, 4
    v_bfe_u32 v179, v248, 2, 3
    v_lshl_add_u32 v180, v177, 3, s52
    v_lshl_add_u32 v190, v177, 4, s52
    v_lshl_add_u32 v181, v179, 3, s52
    ds_read2_b64 v[182:185], v180 offset0:32 offset1:48
    ds_read_b32 v191, v190
    ds_read_b64 v[186:187], v181 offset:512
    v_lshrrev_b32 v178, 6, v248
    buffer_load_dwordx4 v[100:103], v246, s[16:19], s51 offen offset:3072 sc1
    v_xor_b32 v234, s71, v248
    v_add_u32 v234, s21, v234
    v_add_u32 v235, 128, v234
    v_mul_f32 v255, v32, v152
    buffer_load_dwordx4 v[104:107], v246, s[16:19], s67 offen offset:2048 sc1
    v_fmac_f32 v255, v33, v153
    v_fmac_f32 v255, v34, v154
    ds_write2st64_b32 v234, v204, v205 offset0:0 offset1:1
    v_fmac_f32 v255, v35, v155
    buffer_load_dwordx4 v[108:111], v246, s[16:19], s67 offen offset:3072 sc1
    v_fmac_f32 v255, v36, v156
    v_fmac_f32 v255, v37, v157
    ds_write2st64_b32 v234, v206, v207 offset0:2 offset1:3
    v_fmac_f32 v255, v38, v158
    buffer_load_dwordx4 v[128:131], v246, s[16:19], s68 offen offset:2048 sc1
    v_fmac_f32 v255, v39, v159
    v_fma_f32 v203, v40, -v168, v203
    ds_write2st64_b32 v234, v208, v209 offset0:4 offset1:5
    v_fma_f32 v203, v41, -v169, v203
    buffer_load_dwordx4 v[132:135], v246, s[16:19], s68 offen offset:3072 sc1
    v_permlane32_swap_b32 v255, v201
    v_fma_f32 v203, v42, -v170, v203
    ds_write2st64_b32 v235, v210, v211 offset0:6 offset1:7
    v_fma_f32 v203, v43, -v171, v203
    v_fma_f32 v203, v44, -v172, v203
    buffer_load_dwordx4 v[136:139], v246, s[16:19], s69 offen offset:2048 sc1
    v_fma_f32 v203, v45, -v173, v203
    ds_write2st64_b32 v235, v212, v213 offset0:8 offset1:9
    v_fma_f32 v203, v46, -v174, v203
    v_fma_f32 v203, v47, -v175, v203
    buffer_load_dwordx4 v[140:143], v246, s[16:19], s69 offen offset:3072 sc1
    v_add_f32 v201, v255, v201
    ds_write2st64_b32 v235, v214, v215 offset0:10 offset1:11
    v_fmac_f32 v199, v48, v120
    v_permlane32_swap_b32 v203, v255
    buffer_load_dwordx4 v[112:115], v246, s[16:19], s70 offen offset:2048 sc1
    v_fmac_f32 v199, v49, v121
    ds_write2st64_b32 v234, v216, v217 offset0:12 offset1:13
    v_fmac_f32 v199, v50, v122
    v_fmac_f32 v199, v51, v123
    buffer_load_dwordx4 v[116:119], v246, s[16:19], s70 offen offset:3072 sc1
    v_fmac_f32 v199, v52, v124
    ds_write2st64_b32 v234, v218, v219 offset0:14 offset1:15
    v_fmac_f32 v199, v53, v125
    v_fmac_f32 v199, v54, v126
    buffer_load_dwordx4 v[144:147], v246, s[16:19], s51 offen offset:0 sc1
    v_fmac_f32 v199, v55, v127
    v_add_f32 v255, v203, v255
    ds_write2st64_b32 v234, v220, v221 offset0:16 offset1:17
    v_mul_f32 v197, v56, v168
    buffer_load_dwordx4 v[148:151], v246, s[16:19], s51 offen offset:1024 sc1
    v_fmac_f32 v197, v57, v169
    v_fmac_f32 v197, v58, v170
    ds_write2st64_b32 v235, v222, v223 offset0:18 offset1:19
    v_fmac_f32 v197, v59, v171
    buffer_load_dwordx4 v[160:163], v246, s[16:19], s67 offen offset:0 sc1
    v_fmac_f32 v197, v60, v172
    v_fmac_f32 v197, v61, v173
    ds_write2st64_b32 v235, v224, v225 offset0:20 offset1:21
    v_fmac_f32 v197, v62, v174
    buffer_load_dwordx4 v[164:167], v246, s[16:19], s67 offen offset:1024 sc1
    v_fmac_f32 v197, v63, v175
    s_nop 1
    ds_write2st64_b32 v235, v226, v227 offset0:22 offset1:23
    v_permlane32_swap_b32 v199, v197
    ds_write2st64_b32 v234, v228, v229 offset0:24 offset1:25
    v_add_f32 v197, v199, v197
    v_cvt_pk_bf16_f32 v200, v200, v201
    ds_write2st64_b32 v234, v230, v231 offset0:26 offset1:27
    v_cvt_pk_bf16_f32 v254, v254, v255
    v_cvt_pk_bf16_f32 v196, v196, v197
    ds_write2st64_b32 v234, v232, v233 offset0:28 offset1:29
    ds_write2st64_b32 v253, v192, v193 offset0:0 offset1:1
    ds_write2st64_b32 v253, v194, v200 offset0:2 offset1:3
    ds_write_b32 v253, v196 offset:1024
    s_mov_b64 exec, 0xffffffff
    ds_write_b32 v253, v254 offset:1280
    s_mov_b64 exec, -1
    s_add_u32 s50, s53, 1
    v_mov_b32 v234, s50
    ds_write2_b32 v251, v234, v234 offset0:0 offset1:8
    s_waitcnt lgkmcnt(15)
    s_branch TAIL
.p2align 6
LEPI_1:
    s_lshl_b32 s71, s20, 4
    s_add_u32 s67, s51, 4096
    s_add_u32 s68, s51, 8192
    s_add_u32 s69, s51, 12288
    s_add_u32 s70, s51, 16384
    s_waitcnt lgkmcnt(0)
    buffer_load_dwordx4 v[112:115], v246, s[16:19], s70 offen offset:2048 sc1
    s_mov_b32 s52, 163072
    v_bfe_u32 v177, v248, 2, 4
    v_bfe_u32 v179, v248, 2, 3
    v_lshl_add_u32 v180, v177, 3, s52
    v_lshl_add_u32 v190, v177, 4, s52
    v_lshl_add_u32 v181, v179, 3, s52
    ds_read2_b64 v[182:185], v180 offset0:32 offset1:48
    ds_read_b32 v191, v190
    ds_read_b64 v[186:187], v181 offset:512
    v_lshrrev_b32 v178, 6, v248
    buffer_load_dwordx4 v[116:119], v246, s[16:19], s70 offen offset:3072 sc1
    v_xor_b32 v234, s71, v248
    v_add_u32 v234, s21, v234
    v_add_u32 v235, 128, v234
    v_mul_f32 v255, v32, v152
    v_fmac_f32 v255, v33, v153
    buffer_load_dwordx4 v[144:147], v246, s[16:19], s51 offen offset:0 sc1
    v_fmac_f32 v255, v34, v154
    v_fmac_f32 v255, v35, v155
    ds_write2st64_b32 v234, v204, v205 offset0:0 offset1:1
    v_fmac_f32 v255, v36, v156
    v_fmac_f32 v255, v37, v157
    buffer_load_dwordx4 v[148:151], v246, s[16:19], s51 offen offset:1024 sc1
    v_fmac_f32 v255, v38, v158
    v_fmac_f32 v255, v39, v159
    ds_write2st64_b32 v234, v206, v207 offset0:2 offset1:3
    v_fma_f32 v203, v40, -v168, v203
    v_fma_f32 v203, v41, -v169, v203
    v_permlane32_swap_b32 v255, v201
    buffer_load_dwordx4 v[160:163], v246, s[16:19], s67 offen offset:0 sc1
    v_fma_f32 v203, v42, -v170, v203
    v_fma_f32 v203, v43, -v171, v203
    ds_write2st64_b32 v234, v208, v209 offset0:4 offset1:5
    v_fma_f32 v203, v44, -v172, v203
    v_fma_f32 v203, v45, -v173, v203
    buffer_load_dwordx4 v[164:167], v246, s[16:19], s67 offen offset:1024 sc1
    v_fma_f32 v203, v46, -v174, v203
    v_fma_f32 v203, v47, -v175, v203
    ds_write2st64_b32 v235, v210, v211 offset0:6 offset1:7
    v_add_f32 v201, v255, v201
    v_fmac_f32 v199, v48, v120
    ds_write2st64_b32 v235, v212, v213 offset0:8 offset1:9
    v_permlane32_swap_b32 v203, v255
    v_fmac_f32 v199, v49, v121
    v_fmac_f32 v199, v50, v122
    ds_write2st64_b32 v235, v214, v215 offset0:10 offset1:11
    v_fmac_f32 v199, v51, v123
    v_fmac_f32 v199, v52, v124
    ds_write2st64_b32 v234, v216, v217 offset0:12 offset1:13
    v_fmac_f32 v199, v53, v125
    v_fmac_f32 v199, v54, v126
    ds_write2st64_b32 v234, v218, v219 offset0:14 offset1:15
    v_fmac_f32 v199, v55, v127
    v_add_f32 v255, v203, v255
    ds_write2st64_b32 v234, v220, v221 offset0:16 offset1:17
    v_mul_f32 v197, v56, v168
    v_fmac_f32 v197, v57, v169
    ds_write2st64_b32 v235, v222, v223 offset0:18 offset1:19
    v_fmac_f32 v197, v58, v170
    v_fmac_f32 v197, v59, v171
    v_fmac_f32 v197, v60, v172
    ds_write2st64_b32 v235, v224, v225 offset0:20 offset1:21
    v_fmac_f32 v197, v61, v173
    v_fmac_f32 v197, v62, v174
    ds_write2st64_b32 v235, v226, v227 offset0:22 offset1:23
    v_fmac_f32 v197, v63, v175
    s_nop 1
    ds_write2st64_b32 v234, v228, v229 offset0:24 offset1:25
    v_permlane32_swap_b32 v199, v197
    v_add_f32 v197, v199, v197
    ds_write2st64_b32 v234, v230, v231 offset0:26 offset1:27
    v_cvt_pk_bf16_f32 v200, v200, v201
    v_cvt_pk_bf16_f32 v254, v254, v255
    v_cvt_pk_bf16_f32 v196, v196, v197
    ds_write2st64_b32 v234, v232, v233 offset0:28 offset1:29
    ds_write2st64_b32 v253, v200, v196 offset0:3 offset1:4
    s_mov_b64 exec, 0xffffffff
    ds_write_b32 v253, v254 offset:1280
    s_mov_b64 exec, -1
    s_add_u32 s50, s53, 1
    v_mov_b32 v234, s50
    ds_write2_b32 v251, v234, v234 offset0:0 offset1:8
    s_waitcnt lgkmcnt(15)
    s_branch TAIL
.p2align 6
LEPI_0:
    s_lshl_b32 s71, s20, 4
    s_add_u32 s67, s51, 4096
    s_add_u32 s68, s51, 8192
    s_add_u32 s69, s51, 12288
    s_add_u32 s70, s51, 16384
    s_waitcnt lgkmcnt(0)
    buffer_load_dwordx4 v[112:115], v246, s[16:19], s70 offen offset:2048 sc1
    s_mov_b32 s52, 163072
    v_bfe_u32 v177, v248, 2, 4
    v_bfe_u32 v179, v248, 2, 3
    v_lshl_add_u32 v180, v177, 3, s52
    v_lshl_add_u32 v190, v177, 4, s52
    v_lshl_add_u32 v181, v179, 3, s52
    ds_read2_b64 v[182:185], v180 offset0:32 offset1:48
    ds_read_b32 v191, v190
    ds_read_b64 v[186:187], v181 offset:512
    v_lshrrev_b32 v178, 6, v248
    buffer_load_dwordx4 v[116:119], v246, s[16:19], s70 offen offset:3072 sc1
    v_xor_b32 v234, s71, v248
    v_add_u32 v234, s21, v234
    v_add_u32 v235, 128, v234
    v_mul_f32 v255, v32, v152
    v_fmac_f32 v255, v33, v153
    buffer_load_dwordx4 v[144:147], v246, s[16:19], s51 offen offset:0 sc1
    v_fmac_f32 v255, v34, v154
    v_fmac_f32 v255, v35, v155
    ds_write2st64_b32 v234, v204, v205 offset0:0 offset1:1
    v_fmac_f32 v255, v36, v156
    v_fmac_f32 v255, v37, v157
    buffer_load_dwordx4 v[148:151], v246, s[16:19], s51 offen offset:1024 sc1
    v_fmac_f32 v255, v38, v158
    v_fmac_f32 v255, v39, v159
    ds_write2st64_b32 v234, v206, v207 offset0:2 offset1:3
    v_fma_f32 v203, v40, -v168, v203
    v_fma_f32 v203, v41, -v169, v203
    v_permlane32_swap_b32 v255, v201
    buffer_load_dwordx4 v[160:163], v246, s[16:19], s67 offen offset:0 sc1
    v_fma_f32 v203, v42, -v170, v203
    v_fma_f32 v203, v43, -v171, v203
    ds_write2st64_b32 v234, v208, v209 offset0:4 offset1:5
    v_fma_f32 v203, v44, -v172, v203
    v_fma_f32 v203, v45, -v173, v203
    buffer_load_dwordx4 v[164:167], v246, s[16:19], s67 offen offset:1024 sc1
    v_fma_f32 v203, v46, -v174, v203
    v_fma_f32 v203, v47, -v175, v203
    ds_write2st64_b32 v235, v210, v211 offset0:6 offset1:7
    v_add_f32 v201, v255, v201
    v_fmac_f32 v199, v48, v120
    ds_write2st64_b32 v235, v212, v213 offset0:8 offset1:9
    v_permlane32_swap_b32 v203, v255
    v_fmac_f32 v199, v49, v121
    v_fmac_f32 v199, v50, v122
    ds_write2st64_b32 v235, v214, v215 offset0:10 offset1:11
    v_fmac_f32 v199, v51, v123
    v_fmac_f32 v199, v52, v124
    ds_write2st64_b32 v234, v216, v217 offset0:12 offset1:13
    v_fmac_f32 v199, v53, v125
    v_fmac_f32 v199, v54, v126
    ds_write2st64_b32 v234, v218, v219 offset0:14 offset1:15
    v_fmac_f32 v199, v55, v127
    v_add_f32 v255, v203, v255
    ds_write2st64_b32 v234, v220, v221 offset0:16 offset1:17
    v_mul_f32 v197, v56, v168
    v_fmac_f32 v197, v57, v169
    ds_write2st64_b32 v235, v222, v223 offset0:18 offset1:19
    v_fmac_f32 v197, v58, v170
    v_fmac_f32 v197, v59, v171
    v_fmac_f32 v197, v60, v172
    ds_write2st64_b32 v235, v224, v225 offset0:20 offset1:21
    v_fmac_f32 v197, v61, v173
    v_fmac_f32 v197, v62, v174
    ds_write2st64_b32 v235, v226, v227 offset0:22 offset1:23
    v_fmac_f32 v197, v63, v175
    s_nop 1
    ds_write2st64_b32 v234, v228, v229 offset0:24 offset1:25
    v_permlane32_swap_b32 v199, v197
    v_add_f32 v197, v199, v197
    ds_write2st64_b32 v234, v230, v231 offset0:26 offset1:27
    v_cvt_pk_bf16_f32 v200, v200, v201
    v_cvt_pk_bf16_f32 v254, v254, v255
    v_cvt_pk_bf16_f32 v196, v196, v197
    ds_write2st64_b32 v234, v232, v233 offset0:28 offset1:29
    ds_write2st64_b32 v253, v192, v193 offset0:0 offset1:1
    ds_write2st64_b32 v253, v194, v200 offset0:2 offset1:3
    ds_write_b32 v253, v196 offset:1024
    s_mov_b64 exec, 0xffffffff
    ds_write_b32 v253, v254 offset:1280
    s_mov_b64 exec, -1
    s_add_u32 s50, s53, 1
    v_mov_b32 v234, s50
    ds_write2_b32 v251, v234, v234 offset0:0 offset1:8
    s_waitcnt lgkmcnt(15)
TAIL:
    s_and_b32 s71, s20, 3
    s_lshl_b32 s71, s71, 2
    s_bitcmp0_b32 s20, 2
    s_addc_u32 s71, s71, 0
    v_readlane_b32 s71, v191, s71
    buffer_load_dwordx4 v[120:123], v246, s[16:19], s68 offen offset:0 sc1
    buffer_load_dwordx4 v[124:127], v246, s[16:19], s68 offen offset:1024 sc1
    s_cmp_eq_u32 s71, s50
    s_setprio 1
    s_cbranch_scc1 T_second
    s_setprio 0
T_second:
    buffer_load_dwordx4 v[152:155], v246, s[16:19], s69 offen offset:0 sc1
    buffer_load_dwordx4 v[156:159], v246, s[16:19], s69 offen offset:1024 sc1
    buffer_load_dwordx4 v[168:171], v246, s[16:19], s70 offen offset:0 sc1
    buffer_load_dwordx4 v[172:175], v246, s[16:19], s70 offen offset:1024 sc1
GEMM:
    v_cmp_gt_u32 vcc, s53, v191
    v_xor_b32 v180, v179, v178
    v_xor_b32 v188, 4, v180
    v_lshl_add_u32 v66, v180, 4, v183
    v_lshl_add_u32 v67, v188, 4, v183
    v_lshl_add_u32 v70, v180, 4, v185
    v_lshl_add_u32 v71, v188, 4, v185
    s_mov_b32 s4, s72
    s_and_b32 s5, s73, 0xffff
    s_mov_b32 s6, 10240000
    s_mov_b32 s7, 0x20000
    s_cbranch_vccnz T_pw
T_pwr:
    ds_read_b128 v[76:79], v66 offset:0
    ds_read_b128 v[80:83], v70 offset:0
    ds_read_b128 v[84:87], v67 offset:0
    ds_read_b128 v[88:91], v71 offset:0
    ds_read_b128 v[92:95], v66 offset:1024
    s_waitcnt vmcnt(19) lgkmcnt(4)
    v_mfma_f32_16x16x32_bf16 v[0:3], v[96:99], v[76:79], 0
    v_and_b32 v181, 8, v177
    v_add_u32 v189, v188, v181
    ds_read_b128 v[76:79], v70 offset:1024
    s_waitcnt lgkmcnt(4)
    v_mfma_f32_16x16x32_bf16 v[4:7], v[96:99], v[80:83], 0
    v_add_u32 v181, v180, v181
    v_lshl_add_u32 v64, v180, 4, v182
    ds_read_b128 v[80:83], v67 offset:1024
    s_waitcnt vmcnt(18) lgkmcnt(4)
    v_mfma_f32_16x16x32_bf16 v[0:3], v[100:103], v[84:87], v[0:3]
    v_lshl_add_u32 v65, v188, 4, v182
    v_lshl_add_u32 v68, v180, 4, v184
    ds_read_b128 v[84:87], v71 offset:1024
    s_waitcnt lgkmcnt(4)
    v_mfma_f32_16x16x32_bf16 v[4:7], v[100:103], v[88:91], v[4:7]
    v_lshl_add_u32 v69, v188, 4, v184
    v_lshl_add_u32 v72, v181, 4, v186
    ds_read_b128 v[88:91], v66 offset:128
    s_waitcnt vmcnt(17) lgkmcnt(4)
    v_mfma_f32_16x16x32_bf16 v[0:3], v[104:107], v[92:95], v[0:3]
    v_lshl_add_u32 v73, v189, 4, v186
    v_lshl_add_u32 v74, v181, 4, v187
    ds_read_b128 v[92:95], v66 offset:256
    s_waitcnt lgkmcnt(4)
    v_mfma_f32_16x16x32_bf16 v[4:7], v[104:107], v[76:79], v[4:7]
    v_lshl_add_u32 v75, v189, 4, v187
    s_mov_b32 s67, 0xbfb8aa3b
    ds_read_b128 v[76:79], v66 offset:384
    s_waitcnt vmcnt(16) lgkmcnt(4)
    v_mfma_f32_16x16x32_bf16 v[0:3], v[108:111], v[80:83], v[0:3]
    v_lshrrev_b32 v205, 1, v178
    v_lshl_add_u32 v205, s20, 1, v205
    ds_read_b128 v[80:83], v70 offset:128
    s_waitcnt lgkmcnt(4)
    v_mfma_f32_16x16x32_bf16 v[4:7], v[108:111], v[84:87], v[4:7]
    v_xor_b32 v205, v205, v179
    v_and_b32 v204, 1, v178
    ds_read_b128 v[84:87], v70 offset:256
    s_waitcnt vmcnt(15) lgkmcnt(4)
    v_mfma_f32_16x16x32_bf16 v[12:15], v[128:131], v[88:91], 0
    v_lshlrev_b32 v204, 3, v204
    v_lshl_add_u32 v205, v205, 4, v204
    ds_read_b128 v[88:91], v70 offset:384
    s_waitcnt lgkmcnt(4)
    v_mfma_f32_16x16x32_bf16 v[24:27], v[128:131], v[92:95], 0
    v_and_b32 v220, 8, v177
    v_lshl_add_u32 v204, v220, 4, v205
    ds_read_b128 v[92:95], v67 offset:128
    s_waitcnt lgkmcnt(4)
    v_mfma_f32_16x16x32_bf16 v[36:39], v[128:131], v[76:79], 0
    v_lshl_add_u32 v204, v177, 10, v204
    v_add_u32 v204, 65536, v204
    ds_read_b128 v[76:79], v67 offset:256
    s_waitcnt lgkmcnt(4)
    v_mfma_f32_16x16x32_bf16 v[16:19], v[128:131], v[80:83], 0
    v_add_u32 v205, v205, v182
    v_mul_u32_u24 v220, 1008, v220
    ds_read_b128 v[80:83], v67 offset:384
    s_waitcnt lgkmcnt(4)
    v_mfma_f32_16x16x32_bf16 v[28:31], v[128:131], v[84:87], 0
    v_sub_u32 v220, v204, v220
    s_lshl_b32 s70, s20, 4
    ds_read_b128 v[84:87], v71 offset:128
    s_waitcnt lgkmcnt(4)
    v_mfma_f32_16x16x32_bf16 v[40:43], v[128:131], v[88:91], 0
    v_xor_b32 v206, s70, v246
    s_lshl_b32 s70, s20, 10
    ds_read_b128 v[88:91], v71 offset:256
    s_waitcnt vmcnt(14) lgkmcnt(4)
    v_mfma_f32_16x16x32_bf16 v[12:15], v[132:135], v[92:95], v[12:15]
    s_add_u32 s70, s70, 65536
    v_add_u32 v207, s21, v206
    ds_read_b128 v[92:95], v71 offset:384
    s_waitcnt lgkmcnt(4)
    v_mfma_f32_16x16x32_bf16 v[24:27], v[132:135], v[76:79], v[24:27]
    v_add_u32 v206, s70, v206
    s_mul_i32 s66, s2, 40960
    ds_read_b128 v[76:79], v66 offset:512
    s_waitcnt lgkmcnt(4)
    v_mfma_f32_16x16x32_bf16 v[36:39], v[132:135], v[80:83], v[36:39]
    s_bfe_u32 s22, s22, 393237
    s_lshl_b32 s22, s22, 10
    ds_read_b128 v[80:83], v66 offset:640
    s_waitcnt lgkmcnt(4)
    v_mfma_f32_16x16x32_bf16 v[16:19], v[132:135], v[84:87], v[16:19]
    s_add_u32 s22, s22, s66
    s_bfe_u32 s23, s23, 393237
    ds_read_b128 v[84:87], v66 offset:768
    s_waitcnt lgkmcnt(4)
    v_mfma_f32_16x16x32_bf16 v[28:31], v[132:135], v[88:91], v[28:31]
    s_lshl_b32 s23, s23, 10
    s_add_u32 s23, s23, s66
    ds_read_b128 v[88:91], v70 offset:512
    s_waitcnt lgkmcnt(4)
    v_mfma_f32_16x16x32_bf16 v[40:43], v[132:135], v[92:95], v[40:43]
    s_bfe_u32 s24, s24, 393237
    s_lshl_b32 s24, s24, 10
    ds_read_b128 v[92:95], v70 offset:640
    s_waitcnt vmcnt(13) lgkmcnt(4)
    v_mfma_f32_16x16x32_bf16 v[12:15], v[136:139], v[76:79], v[12:15]
    s_add_u32 s24, s24, s66
    s_bfe_u32 s25, s25, 393237
    ds_read_b128 v[76:79], v70 offset:768
    s_waitcnt lgkmcnt(4)
    v_mfma_f32_16x16x32_bf16 v[24:27], v[136:139], v[80:83], v[24:27]
    s_lshl_b32 s25, s25, 10
    s_add_u32 s25, s25, s66
    ds_read_b128 v[80:83], v67 offset:512
    s_waitcnt lgkmcnt(4)
    v_mfma_f32_16x16x32_bf16 v[36:39], v[136:139], v[84:87], v[36:39]
    s_bfe_u32 s26, s26, 393237
    s_lshl_b32 s26, s26, 10
    ds_read_b128 v[84:87], v67 offset:640
    s_waitcnt lgkmcnt(4)
    v_mfma_f32_16x16x32_bf16 v[16:19], v[136:139], v[88:91], v[16:19]
    s_add_u32 s26, s26, s66
    ds_read_b128 v[88:91], v67 offset:768
    s_waitcnt lgkmcnt(4)
    v_mfma_f32_16x16x32_bf16 v[28:31], v[136:139], v[92:95], v[28:31]
    ds_read_b128 v[92:95], v71 offset:512
    s_waitcnt lgkmcnt(4)
    v_mfma_f32_16x16x32_bf16 v[40:43], v[136:139], v[76:79], v[40:43]
    ds_read_b128 v[76:79], v71 offset:640
    s_waitcnt vmcnt(12) lgkmcnt(4)
    v_mfma_f32_16x16x32_bf16 v[12:15], v[140:143], v[80:83], v[12:15]
    ds_read_b128 v[80:83], v71 offset:768
    s_waitcnt lgkmcnt(4)
    v_mfma_f32_16x16x32_bf16 v[24:27], v[140:143], v[84:87], v[24:27]
    ds_read_b128 v[84:87], v66 offset:1152
    s_waitcnt lgkmcnt(4)
    v_mfma_f32_16x16x32_bf16 v[36:39], v[140:143], v[88:91], v[36:39]
    ds_read_b128 v[88:91], v66 offset:1280
    s_waitcnt lgkmcnt(4)
    v_mfma_f32_16x16x32_bf16 v[16:19], v[140:143], v[92:95], v[16:19]
    ds_read_b128 v[92:95], v66 offset:896
    s_waitcnt lgkmcnt(4)
    v_mfma_f32_16x16x32_bf16 v[28:31], v[140:143], v[76:79], v[28:31]
    ds_read_b128 v[76:79], v70 offset:1152
    s_waitcnt lgkmcnt(4)
    v_mfma_f32_16x16x32_bf16 v[40:43], v[140:143], v[80:83], v[40:43]
    ds_read_b128 v[80:83], v70 offset:1280
    s_waitcnt vmcnt(11) lgkmcnt(4)
    v_mfma_f32_16x16x32_bf16 v[12:15], v[112:115], v[84:87], v[12:15]
    ds_read_b128 v[84:87], v70 offset:896
    s_waitcnt lgkmcnt(4)
    v_mfma_f32_16x16x32_bf16 v[24:27], v[112:115], v[88:91], v[24:27]
    ds_read_b128 v[88:91], v67 offset:1152
    s_waitcnt lgkmcnt(4)
    v_mfma_f32_16x16x32_bf16 v[36:39], v[112:115], v[92:95], v[36:39]
    ds_read_b128 v[92:95], v67 offset:1280
    s_waitcnt lgkmcnt(4)
    v_mfma_f32_16x16x32_bf16 v[16:19], v[112:115], v[76:79], v[16:19]
    ds_read_b128 v[76:79], v67 offset:896
    s_waitcnt lgkmcnt(4)
    v_mfma_f32_16x16x32_bf16 v[28:31], v[112:115], v[80:83], v[28:31]
    ds_read_b32 v191, v190
    ds_read_b128 v[80:83], v71 offset:1152
    s_waitcnt lgkmcnt(5)
    v_mfma_f32_16x16x32_bf16 v[40:43], v[112:115], v[84:87], v[40:43]
    ds_read_b128 v[84:87], v71 offset:1280
    s_waitcnt vmcnt(10) lgkmcnt(5)
    v_mfma_f32_16x16x32_bf16 v[12:15], v[116:119], v[88:91], v[12:15]
    ds_read_b128 v[88:91], v71 offset:896
    s_waitcnt lgkmcnt(5)
    v_mfma_f32_16x16x32_bf16 v[24:27], v[116:119], v[92:95], v[24:27]
    s_waitcnt lgkmcnt(3)
    v_cmp_gt_u32 vcc, s50, v191
    s_cbranch_vccnz T_aw
T_awr:
    ds_read_b128 v[92:95], v64 offset:0
    v_mfma_f32_16x16x32_bf16 v[36:39], v[116:119], v[76:79], v[36:39]
    ds_read_b128 v[76:79], v68 offset:0
    s_waitcnt lgkmcnt(4)
    v_mfma_f32_16x16x32_bf16 v[16:19], v[116:119], v[80:83], v[16:19]
    ds_read_b128 v[80:83], v65 offset:0
    s_waitcnt lgkmcnt(4)
    v_mfma_f32_16x16x32_bf16 v[28:31], v[116:119], v[84:87], v[28:31]
    ds_read_b128 v[84:87], v69 offset:0
    s_waitcnt lgkmcnt(4)
    v_mfma_f32_16x16x32_bf16 v[40:43], v[116:119], v[88:91], v[40:43]
    ds_read_b128 v[88:91], v64 offset:1024
    s_waitcnt vmcnt(9) lgkmcnt(4)
    v_mfma_f32_16x16x32_bf16 v[0:3], v[144:147], v[92:95], v[0:3]
    ds_read_b128 v[92:95], v68 offset:1024
    s_waitcnt lgkmcnt(4)
    v_mfma_f32_16x16x32_bf16 v[4:7], v[144:147], v[76:79], v[4:7]
    ds_read_b128 v[76:79], v65 offset:1024
    s_waitcnt vmcnt(8) lgkmcnt(4)
    v_mfma_f32_16x16x32_bf16 v[0:3], v[148:151], v[80:83], v[0:3]
    ds_read_b128 v[80:83], v69 offset:1024
    s_waitcnt lgkmcnt(4)
    v_mfma_f32_16x16x32_bf16 v[4:7], v[148:151], v[84:87], v[4:7]
    ds_read_b128 v[84:87], v72 offset:0
    s_waitcnt vmcnt(7) lgkmcnt(4)
    v_mfma_f32_16x16x32_bf16 v[0:3], v[160:163], v[88:91], v[0:3]
    ds_read_b128 v[88:91], v73 offset:0
    s_waitcnt lgkmcnt(4)
    v_mfma_f32_16x16x32_bf16 v[4:7], v[160:163], v[92:95], v[4:7]
    ds_read_b128 v[92:95], v74 offset:0
    s_waitcnt vmcnt(6) lgkmcnt(4)
    v_mfma_f32_16x16x32_bf16 v[0:3], v[164:167], v[76:79], v[0:3]
    ds_read_b128 v[76:79], v75 offset:0
    s_waitcnt lgkmcnt(4)
    v_mfma_f32_16x16x32_bf16 v[4:7], v[164:167], v[80:83], v[4:7]
    ds_read_b128 v[80:83], v72 offset:1024
    s_waitcnt lgkmcnt(4)
    v_mfma_f32_16x16x32_bf16 v[8:11], v[144:147], v[84:87], 0
    ds_read_b128 v[84:87], v73 offset:1024
    s_waitcnt lgkmcnt(4)
    v_mfma_f32_16x16x32_bf16 v[8:11], v[148:151], v[88:91], v[8:11]
    v_mul_f32 v192, s67, v0
    v_mul_f32 v193, s67, v1
    ds_read_b128 v[88:91], v74 offset:1024
    s_waitcnt lgkmcnt(4)
    v_mfma_f32_16x16x32_bf16 v[8:11], v[96:99], v[92:95], v[8:11]
    v_mul_f32 v194, s67, v2
    v_mul_f32 v195, s67, v3
    ds_read_b128 v[92:95], v75 offset:1024
    s_waitcnt lgkmcnt(4)
    v_mfma_f32_16x16x32_bf16 v[8:11], v[100:103], v[76:79], v[8:11]
    v_exp_f32 v192, v192
    v_exp_f32 v193, v193
    ds_read_b128 v[76:79], v64 offset:128
    s_waitcnt lgkmcnt(4)
    v_mfma_f32_16x16x32_bf16 v[8:11], v[160:163], v[80:83], v[8:11]
    v_exp_f32 v194, v194
    v_exp_f32 v195, v195
    ds_read_b128 v[80:83], v65 offset:128
    s_waitcnt lgkmcnt(4)
    v_mfma_f32_16x16x32_bf16 v[8:11], v[164:167], v[84:87], v[8:11]
    v_add_f32 v192, 1.0, v192
    v_add_f32 v193, 1.0, v193
    ds_read_b128 v[84:87], v64 offset:512
    s_waitcnt lgkmcnt(4)
    v_mfma_f32_16x16x32_bf16 v[8:11], v[104:107], v[88:91], v[8:11]
    v_add_f32 v194, 1.0, v194
    v_add_f32 v195, 1.0, v195
    ds_read_b128 v[88:91], v65 offset:512
    s_waitcnt lgkmcnt(4)
    v_mfma_f32_16x16x32_bf16 v[8:11], v[108:111], v[92:95], v[8:11]
    v_rcp_f32 v192, v192
    v_rcp_f32 v193, v193
    ds_read_b128 v[92:95], v64 offset:1152
    s_waitcnt vmcnt(5) lgkmcnt(4)
    v_mfma_f32_16x16x32_bf16 v[12:15], v[120:123], v[76:79], v[12:15]
    v_rcp_f32 v194, v194
    v_rcp_f32 v195, v195
    ds_read_b128 v[76:79], v65 offset:1152
    s_waitcnt vmcnt(4) lgkmcnt(4)
    v_mfma_f32_16x16x32_bf16 v[12:15], v[124:127], v[80:83], v[12:15]
    v_cvt_pk_bf16_f32 v0, v0, v1
    v_cvt_pk_bf16_f32 v1, v2, v3
    ds_read_b128 v[80:83], v64 offset:256
    s_waitcnt vmcnt(3) lgkmcnt(4)
    v_mfma_f32_16x16x32_bf16 v[12:15], v[152:155], v[84:87], v[12:15]
    ds_write_b64 v204, v[0:1] offset:0
    v_mul_f32 v196, s67, v4
    ds_read_b128 v[84:87], v65 offset:256
    s_waitcnt vmcnt(2) lgkmcnt(5)
    v_mfma_f32_16x16x32_bf16 v[12:15], v[156:159], v[88:91], v[12:15]
    v_mul_f32 v197, s67, v5
    v_mul_f32 v198, s67, v6
    ds_read_b128 v[88:91], v64 offset:640
    s_waitcnt vmcnt(1) lgkmcnt(5)
    v_mfma_f32_16x16x32_bf16 v[12:15], v[168:171], v[92:95], v[12:15]
    v_mul_f32 v199, s67, v7
    v_exp_f32 v196, v196
    ds_read_b128 v[92:95], v65 offset:640
    s_waitcnt vmcnt(0) lgkmcnt(5)
    v_mfma_f32_16x16x32_bf16 v[12:15], v[172:175], v[76:79], v[12:15]
    v_exp_f32 v197, v197
    v_exp_f32 v198, v198
    ds_read_b128 v[76:79], v64 offset:1280
    s_waitcnt lgkmcnt(5)
    v_mfma_f32_16x16x32_bf16 v[24:27], v[120:123], v[80:83], v[24:27]
    v_exp_f32 v199, v199
    v_add_f32 v196, 1.0, v196
    ds_read_b128 v[80:83], v65 offset:1280
    s_waitcnt lgkmcnt(4)
    v_mfma_f32_16x16x32_bf16 v[24:27], v[124:127], v[84:87], v[24:27]
    v_mul_f32 v12, v12, v192
    v_mul_f32 v13, v13, v193
    ds_read_b128 v[84:87], v64 offset:384
    s_waitcnt lgkmcnt(4)
    v_mfma_f32_16x16x32_bf16 v[24:27], v[152:155], v[88:91], v[24:27]
    v_mul_f32 v14, v14, v194
    v_mul_f32 v15, v15, v195
    ds_read_b128 v[88:91], v65 offset:384
    s_waitcnt lgkmcnt(4)
    v_mfma_f32_16x16x32_bf16 v[24:27], v[156:159], v[92:95], v[24:27]
    v_cvt_pk_bf16_f32 v12, v12, v13
    v_cvt_pk_bf16_f32 v13, v14, v15
    ds_read_b128 v[92:95], v64 offset:768
    s_waitcnt lgkmcnt(4)
    v_mfma_f32_16x16x32_bf16 v[24:27], v[168:171], v[76:79], v[24:27]
    ds_write_b64 v204, v[12:13] offset:256
    v_add_f32 v197, 1.0, v197
    ds_read_b128 v[76:79], v65 offset:768
    s_waitcnt lgkmcnt(5)
    v_mfma_f32_16x16x32_bf16 v[24:27], v[172:175], v[80:83], v[24:27]
    v_add_f32 v198, 1.0, v198
    v_add_f32 v199, 1.0, v199
    ds_read_b128 v[80:83], v64 offset:896
    s_waitcnt lgkmcnt(5)
    v_mfma_f32_16x16x32_bf16 v[36:39], v[120:123], v[84:87], v[36:39]
    v_rcp_f32 v196, v196
    v_rcp_f32 v197, v197
    ds_read_b128 v[84:87], v65 offset:896
    s_waitcnt lgkmcnt(5)
    v_mfma_f32_16x16x32_bf16 v[36:39], v[124:127], v[88:91], v[36:39]
    v_rcp_f32 v198, v198
    v_rcp_f32 v199, v199
    ds_read_b128 v[88:91], v68 offset:128
    s_waitcnt lgkmcnt(5)
    v_mfma_f32_16x16x32_bf16 v[36:39], v[152:155], v[92:95], v[36:39]
    v_mul_f32 v24, v24, v192
    v_mul_f32 v25, v25, v193
    ds_read_b128 v[92:95], v69 offset:128
    s_waitcnt lgkmcnt(4)
    v_mfma_f32_16x16x32_bf16 v[36:39], v[156:159], v[76:79], v[36:39]
    v_mul_f32 v26, v26, v194
    v_mul_f32 v27, v27, v195
    ds_read_b128 v[76:79], v68 offset:512
    s_waitcnt lgkmcnt(4)
    v_mfma_f32_16x16x32_bf16 v[36:39], v[168:171], v[80:83], v[36:39]
    v_cvt_pk_bf16_f32 v24, v24, v25
    v_cvt_pk_bf16_f32 v25, v26, v27
    ds_read_b128 v[80:83], v69 offset:512
    s_waitcnt lgkmcnt(4)
    v_mfma_f32_16x16x32_bf16 v[36:39], v[172:175], v[84:87], v[36:39]
    ds_write_b64 v204, v[24:25] offset:512
    v_mul_f32 v200, s67, v8
    ds_read_b128 v[84:87], v68 offset:1152
    s_waitcnt lgkmcnt(5)
    v_mfma_f32_16x16x32_bf16 v[16:19], v[120:123], v[88:91], v[16:19]
    v_mul_f32 v201, s67, v9
    v_mul_f32 v202, s67, v10
    ds_read_b128 v[88:91], v69 offset:1152
    s_waitcnt lgkmcnt(5)
    v_mfma_f32_16x16x32_bf16 v[16:19], v[124:127], v[92:95], v[16:19]
    v_mul_f32 v203, s67, v11
    v_exp_f32 v200, v200
    ds_read_b128 v[92:95], v68 offset:256
    s_waitcnt lgkmcnt(5)
    v_mfma_f32_16x16x32_bf16 v[16:19], v[152:155], v[76:79], v[16:19]
    v_mul_f32 v36, v36, v192
    v_mul_f32 v37, v37, v193
    ds_read_b128 v[76:79], v69 offset:256
    s_waitcnt lgkmcnt(5)
    v_mfma_f32_16x16x32_bf16 v[16:19], v[156:159], v[80:83], v[16:19]
    v_mul_f32 v38, v38, v194
    v_mul_f32 v39, v39, v195
    ds_read_b128 v[80:83], v68 offset:640
    s_waitcnt lgkmcnt(4)
    v_mfma_f32_16x16x32_bf16 v[16:19], v[168:171], v[84:87], v[16:19]
    v_cvt_pk_bf16_f32 v36, v36, v37
    v_cvt_pk_bf16_f32 v37, v38, v39
    ds_read_b128 v[84:87], v69 offset:640
    s_waitcnt lgkmcnt(4)
    v_mfma_f32_16x16x32_bf16 v[16:19], v[172:175], v[88:91], v[16:19]
    ds_write_b64 v204, v[36:37] offset:768
    v_exp_f32 v201, v201
    ds_read_b128 v[88:91], v68 offset:1280
    s_waitcnt lgkmcnt(5)
    v_mfma_f32_16x16x32_bf16 v[28:31], v[120:123], v[92:95], v[28:31]
    v_exp_f32 v202, v202
    v_exp_f32 v203, v203
    ds_read_b128 v[92:95], v69 offset:1280
    s_waitcnt lgkmcnt(5)
    v_mfma_f32_16x16x32_bf16 v[28:31], v[124:127], v[76:79], v[28:31]
    v_add_f32 v200, 1.0, v200
    v_add_f32 v201, 1.0, v201
    ds_read_b128 v[76:79], v68 offset:384
    s_waitcnt lgkmcnt(5)
    v_mfma_f32_16x16x32_bf16 v[28:31], v[152:155], v[80:83], v[28:31]
    v_add_f32 v202, 1.0, v202
    v_add_f32 v203, 1.0, v203
    ds_read_b128 v[80:83], v69 offset:384
    s_waitcnt lgkmcnt(5)
    v_mfma_f32_16x16x32_bf16 v[28:31], v[156:159], v[84:87], v[28:31]
    v_rcp_f32 v200, v200
    v_rcp_f32 v201, v201
    ds_read_b128 v[84:87], v68 offset:768
    s_waitcnt lgkmcnt(4)
    v_mfma_f32_16x16x32_bf16 v[28:31], v[168:171], v[88:91], v[28:31]
    v_rcp_f32 v202, v202
    v_rcp_f32 v203, v203
    ds_read_b128 v[88:91], v69 offset:768
    s_waitcnt lgkmcnt(4)
    v_mfma_f32_16x16x32_bf16 v[28:31], v[172:175], v[92:95], v[28:31]
    v_mov_b32_dpp v200, v200 row_ror:8 row_mask:0xf bank_mask:0xc
    ds_read_b128 v[92:95], v68 offset:896
    s_waitcnt lgkmcnt(4)
    v_mfma_f32_16x16x32_bf16 v[40:43], v[120:123], v[76:79], v[40:43]
    v_mov_b32_dpp v201, v201 row_ror:8 row_mask:0xf bank_mask:0xc
    v_mov_b32_dpp v202, v202 row_ror:8 row_mask:0xf bank_mask:0xc
    ds_read_b128 v[76:79], v69 offset:896
    s_waitcnt lgkmcnt(4)
    v_mfma_f32_16x16x32_bf16 v[40:43], v[124:127], v[80:83], v[40:43]
    v_mov_b32_dpp v203, v203 row_ror:8 row_mask:0xf bank_mask:0xc
    ds_read_b128 v[80:83], v72 offset:128
    s_waitcnt lgkmcnt(4)
    v_mfma_f32_16x16x32_bf16 v[40:43], v[152:155], v[84:87], v[40:43]
    s_barrier
    ds_read_b128 v[212:215], v206 offset:0
    ds_read_b128 v[84:87], v73 offset:128
    s_waitcnt lgkmcnt(5)
    v_mfma_f32_16x16x32_bf16 v[40:43], v[156:159], v[88:91], v[40:43]
    ds_read_b128 v[216:219], v206 offset:8320
    v_cvt_pk_bf16_f32 v4, v4, v5
    ds_read_b128 v[88:91], v74 offset:128
    s_waitcnt lgkmcnt(6)
    v_mfma_f32_16x16x32_bf16 v[40:43], v[168:171], v[92:95], v[40:43]
    v_cvt_pk_bf16_f32 v5, v6, v7
    ds_write_b64 v205, v[4:5] offset:0
    ds_read_b128 v[92:95], v75 offset:128
    s_waitcnt lgkmcnt(7)
    v_mfma_f32_16x16x32_bf16 v[40:43], v[172:175], v[76:79], v[40:43]
    v_mul_f32 v16, v16, v196
    v_mul_f32 v17, v17, v197
    ds_read_b128 v[76:79], v72 offset:512
    s_waitcnt lgkmcnt(7)
    v_mfma_f32_16x16x32_bf16 v[20:23], v[120:123], v[80:83], 0
    v_mul_f32 v18, v18, v198
    v_mul_f32 v19, v19, v199
    ds_read_b128 v[80:83], v73 offset:512
    s_waitcnt lgkmcnt(6)
    v_mfma_f32_16x16x32_bf16 v[20:23], v[124:127], v[84:87], v[20:23]
    v_cvt_pk_bf16_f32 v16, v16, v17
    v_cvt_pk_bf16_f32 v17, v18, v19
    ds_read_b128 v[84:87], v74 offset:512
    s_waitcnt lgkmcnt(5)
    v_mfma_f32_16x16x32_bf16 v[20:23], v[128:131], v[88:91], v[20:23]
    ds_write_b64 v205, v[16:17] offset:256
    ds_read_b128 v[88:91], v75 offset:512
    s_waitcnt lgkmcnt(5)
    v_mfma_f32_16x16x32_bf16 v[20:23], v[132:135], v[92:95], v[20:23]
    buffer_store_dwordx4 v[212:215], v246, s[4:7], s22 offen sc1
    ds_read_b128 v[92:95], v72 offset:1152
    s_waitcnt lgkmcnt(5)
    v_mfma_f32_16x16x32_bf16 v[20:23], v[152:155], v[76:79], v[20:23]
    buffer_store_dwordx4 v[216:219], v246, s[4:7], s23 offen sc1
    v_mul_f32 v28, v28, v196
    ds_read_b128 v[76:79], v73 offset:1152
    s_waitcnt lgkmcnt(5)
    v_mfma_f32_16x16x32_bf16 v[20:23], v[156:159], v[80:83], v[20:23]
    v_mul_f32 v29, v29, v197
    v_mul_f32 v30, v30, v198
    ds_read_b128 v[80:83], v74 offset:1152
    s_waitcnt lgkmcnt(5)
    v_mfma_f32_16x16x32_bf16 v[20:23], v[136:139], v[84:87], v[20:23]
    v_mul_f32 v31, v31, v199
    v_cvt_pk_bf16_f32 v28, v28, v29
    ds_read_b128 v[84:87], v75 offset:1152
    s_waitcnt lgkmcnt(4)
    v_mfma_f32_16x16x32_bf16 v[20:23], v[140:143], v[88:91], v[20:23]
    v_cvt_pk_bf16_f32 v29, v30, v31
    ds_write_b64 v205, v[28:29] offset:512
    ds_read_b128 v[88:91], v72 offset:384
    s_waitcnt lgkmcnt(5)
    v_mfma_f32_16x16x32_bf16 v[20:23], v[168:171], v[92:95], v[20:23]
    v_mul_f32 v40, v40, v196
    v_mul_f32 v41, v41, v197
    ds_read_b128 v[92:95], v73 offset:384
    s_waitcnt lgkmcnt(5)
    v_mfma_f32_16x16x32_bf16 v[20:23], v[172:175], v[76:79], v[20:23]
    v_mul_f32 v42, v42, v198
    v_mul_f32 v43, v43, v199
    ds_read_b128 v[76:79], v74 offset:384
    s_waitcnt lgkmcnt(5)
    v_mfma_f32_16x16x32_bf16 v[20:23], v[112:115], v[80:83], v[20:23]
    v_cvt_pk_bf16_f32 v40, v40, v41
    v_cvt_pk_bf16_f32 v41, v42, v43
    ds_read_b128 v[80:83], v75 offset:384
    s_waitcnt lgkmcnt(5)
    v_mfma_f32_16x16x32_bf16 v[20:23], v[116:119], v[84:87], v[20:23]
    ds_write_b64 v205, v[40:41] offset:768
    ds_read_b128 v[84:87], v72 offset:768
    s_waitcnt lgkmcnt(5)
    v_mfma_f32_16x16x32_bf16 v[44:47], v[120:123], v[88:91], 0
    ds_read_b128 v[88:91], v73 offset:768
    s_waitcnt lgkmcnt(5)
    v_mfma_f32_16x16x32_bf16 v[44:47], v[124:127], v[92:95], v[44:47]
    s_waitcnt lgkmcnt(2)
    s_barrier
    ds_read_b128 v[92:95], v74 offset:768
    v_mfma_f32_16x16x32_bf16 v[44:47], v[128:131], v[76:79], v[44:47]
    ds_read_b128 v[212:215], v207 offset:0
    ds_read_b128 v[216:219], v207 offset:1664
    ds_read_b128 v[76:79], v75 offset:768
    v_mfma_f32_16x16x32_bf16 v[44:47], v[132:135], v[80:83], v[44:47]
    ds_read_b128 v[80:83], v72 offset:896
    s_waitcnt lgkmcnt(6)
    v_mfma_f32_16x16x32_bf16 v[44:47], v[152:155], v[84:87], v[44:47]
    ds_read_b128 v[84:87], v73 offset:896
    s_waitcnt lgkmcnt(6)
    v_mfma_f32_16x16x32_bf16 v[44:47], v[156:159], v[88:91], v[44:47]
    ds_read_b128 v[88:91], v74 offset:896
    s_waitcnt lgkmcnt(6)
    v_mfma_f32_16x16x32_bf16 v[44:47], v[136:139], v[92:95], v[44:47]
    s_waitcnt lgkmcnt(5)
    buffer_store_dwordx4 v[212:215], v246, s[4:7], s24 offen sc1
    ds_read_b128 v[92:95], v75 offset:896
    s_waitcnt lgkmcnt(4)
    v_mfma_f32_16x16x32_bf16 v[44:47], v[140:143], v[76:79], v[44:47]
    buffer_store_dwordx4 v[216:219], v246, s[4:7], s25 offen sc1
    s_waitcnt lgkmcnt(3)
    v_mfma_f32_16x16x32_bf16 v[44:47], v[168:171], v[80:83], v[44:47]
    v_cvt_pk_bf16_f32 v8, v8, v9
    v_cvt_pk_bf16_f32 v9, v10, v11
    s_waitcnt lgkmcnt(2)
    v_mfma_f32_16x16x32_bf16 v[44:47], v[172:175], v[84:87], v[44:47]
    ds_write_b64 v204, v[8:9] offset:0
    v_mul_f32 v20, v20, v200
    s_waitcnt lgkmcnt(2)
    v_mfma_f32_16x16x32_bf16 v[44:47], v[112:115], v[88:91], v[44:47]
    v_mul_f32 v21, v21, v201
    v_mul_f32 v22, v22, v202
    s_waitcnt lgkmcnt(1)
    v_mfma_f32_16x16x32_bf16 v[44:47], v[116:119], v[92:95], v[44:47]
    v_mul_f32 v23, v23, v203
    v_cvt_pk_bf16_f32 v20, v20, v21
    v_cvt_pk_bf16_f32 v21, v22, v23
    ds_write_b64 v220, v[20:21] offset:256
    s_nop 3
    v_mul_f32 v44, v44, v200
    v_mul_f32 v45, v45, v201
    v_mul_f32 v46, v46, v202
    v_mul_f32 v47, v47, v203
    v_cvt_pk_bf16_f32 v44, v44, v45
    v_cvt_pk_bf16_f32 v45, v46, v47
    ds_write_b64 v204, v[44:45] offset:768
    s_waitcnt lgkmcnt(0)
    s_barrier
    ds_read_b128 v[212:215], v206 offset:0
    s_waitcnt lgkmcnt(0)
    buffer_store_dwordx4 v[212:215], v246, s[4:7], s26 offen sc1
    s_or_b32 s89, s89, s20
    s_cbranch_scc1 K2_end
    v_mov_b32 v0, 0
    v_mov_b32 v1, s88
    s_mov_b64 exec, 1
    buffer_store_dword v1, v0, s[16:19], 0 offen
    s_endpgm
T_pw:
    s_sleep 1
    ds_read_b32 v191, v190
    s_waitcnt lgkmcnt(0)
    v_cmp_gt_u32 vcc, s53, v191
    s_cbranch_vccnz T_pw
    s_branch T_pwr
T_aw:
    s_sleep 1
    ds_read_b32 v191, v190
    s_waitcnt lgkmcnt(0)
    v_cmp_gt_u32 vcc, s50, v191
    s_cbranch_vccnz T_aw
    s_branch T_awr
K2_end:
K2_last:
    s_endpgm
SLOW:
    v_readlane_b32 s89, v4, 62
    s_waitcnt vmcnt(0) lgkmcnt(0)
    s_barrier
    s_load_dwordx2 s[22:23], s[0:1], 8
    s_load_dwordx2 s[24:25], s[0:1], 24
    s_load_dwordx2 s[26:27], s[0:1], 32
    s_load_dwordx2 s[28:29], s[0:1], 40
    s_load_dwordx2 s[30:31], s[0:1], 0
    v_mbcnt_lo_u32_b32 v240, -1, 0
    v_mbcnt_hi_u32_b32 v240, -1, v240
    v_lshrrev_b32 v229, 5, v240
    v_and_b32 v230, 31, v240
    v_lshlrev_b32 v241, 7, v229
    v_lshl_add_u32 v241, v230, 1, v241
    v_lshlrev_b32 v245, 4, v240
    v_mov_b32 v242, 0
    s_waitcnt lgkmcnt(0)
    s_mov_b32 s80, s22
    s_and_b32 s81, s23, 0xffff
    s_mov_b32 s82, 1920000
    s_mov_b32 s83, 0x20000
    s_mov_b32 s76, s24
    s_and_b32 s77, s25, 0xffff
    s_mov_b32 s78, 1280000
    s_mov_b32 s79, 0x20000
    s_mov_b32 s72, s26
    s_and_b32 s73, s27, 0xffff
    s_mov_b32 s74, 1280000
    s_mov_b32 s75, 0x20000
    s_mov_b32 s84, s28
    s_and_b32 s85, s29, 0xffff
    s_mov_b32 s86, 20480
    s_mov_b32 s87, 0x20000
    s_mov_b32 s4, s30
    s_and_b32 s5, s31, 0xffff
    s_mov_b32 s6, 10240000
    s_mov_b32 s7, 0x20000
    s_mov_b32 s66, 0
    buffer_load_ushort v0, v241, s[84:87], s66 offen offset:0
    buffer_load_ushort v1, v241, s[84:87], s66 offen offset:64
    buffer_load_ushort v2, v241, s[84:87], s66 offen offset:256
    buffer_load_ushort v3, v241, s[84:87], s66 offen offset:320
    buffer_load_ushort v4, v241, s[84:87], s66 offen offset:512
    buffer_load_ushort v5, v241, s[84:87], s66 offen offset:576
    buffer_load_ushort v6, v241, s[84:87], s66 offen offset:768
    buffer_load_ushort v7, v241, s[84:87], s66 offen offset:832
    buffer_load_ushort v8, v241, s[84:87], s66 offen offset:1024
    buffer_load_ushort v9, v241, s[84:87], s66 offen offset:1088
    s_waitcnt vmcnt(0)
    s_mov_b32 s66, 1280
    buffer_load_ushort v10, v241, s[84:87], s66 offen offset:0
    buffer_load_ushort v11, v241, s[84:87], s66 offen offset:64
    buffer_load_ushort v12, v241, s[84:87], s66 offen offset:256
    buffer_load_ushort v13, v241, s[84:87], s66 offen offset:320
    buffer_load_ushort v14, v241, s[84:87], s66 offen offset:512
    buffer_load_ushort v15, v241, s[84:87], s66 offen offset:576
    buffer_load_ushort v16, v241, s[84:87], s66 offen offset:768
    buffer_load_ushort v17, v241, s[84:87], s66 offen offset:832
    buffer_load_ushort v18, v241, s[84:87], s66 offen offset:1024
    buffer_load_ushort v19, v241, s[84:87], s66 offen offset:1088
    s_waitcnt vmcnt(0)
    s_mov_b32 s66, 2560
    buffer_load_ushort v20, v241, s[84:87], s66 offen offset:0
    buffer_load_ushort v21, v241, s[84:87], s66 offen offset:64
    buffer_load_ushort v22, v241, s[84:87], s66 offen offset:256
    buffer_load_ushort v23, v241, s[84:87], s66 offen offset:320
    buffer_load_ushort v24, v241, s[84:87], s66 offen offset:512
    buffer_load_ushort v25, v241, s[84:87], s66 offen offset:576
    buffer_load_ushort v26, v241, s[84:87], s66 offen offset:768
    buffer_load_ushort v27, v241, s[84:87], s66 offen offset:832
    buffer_load_ushort v28, v241, s[84:87], s66 offen offset:1024
    buffer_load_ushort v29, v241, s[84:87], s66 offen offset:1088
    s_waitcnt vmcnt(0)
    s_mov_b32 s66, 3840
    buffer_load_ushort v30, v241, s[84:87], s66 offen offset:0
    buffer_load_ushort v31, v241, s[84:87], s66 offen offset:64
    buffer_load_ushort v32, v241, s[84:87], s66 offen offset:256
    buffer_load_ushort v33, v241, s[84:87], s66 offen offset:320
    buffer_load_ushort v34, v241, s[84:87], s66 offen offset:512
    buffer_load_ushort v35, v241, s[84:87], s66 offen offset:576
    buffer_load_ushort v36, v241, s[84:87], s66 offen offset:768
    buffer_load_ushort v37, v241, s[84:87], s66 offen offset:832
    buffer_load_ushort v38, v241, s[84:87], s66 offen offset:1024
    buffer_load_ushort v39, v241, s[84:87], s66 offen offset:1088
    s_waitcnt vmcnt(0)
    s_mov_b32 s66, 5120
    buffer_load_ushort v40, v241, s[84:87], s66 offen offset:0
    buffer_load_ushort v41, v241, s[84:87], s66 offen offset:64
    buffer_load_ushort v42, v241, s[84:87], s66 offen offset:256
    buffer_load_ushort v43, v241, s[84:87], s66 offen offset:320
    buffer_load_ushort v44, v241, s[84:87], s66 offen offset:512
    buffer_load_ushort v45, v241, s[84:87], s66 offen offset:576
    buffer_load_ushort v46, v241, s[84:87], s66 offen offset:768
    buffer_load_ushort v47, v241, s[84:87], s66 offen offset:832
    buffer_load_ushort v48, v241, s[84:87], s66 offen offset:1024
    buffer_load_ushort v49, v241, s[84:87], s66 offen offset:1088
    s_waitcnt vmcnt(0)
    s_mov_b32 s66, 6400
    buffer_load_ushort v50, v241, s[84:87], s66 offen offset:0
    buffer_load_ushort v51, v241, s[84:87], s66 offen offset:64
    buffer_load_ushort v52, v241, s[84:87], s66 offen offset:256
    buffer_load_ushort v53, v241, s[84:87], s66 offen offset:320
    buffer_load_ushort v54, v241, s[84:87], s66 offen offset:512
    buffer_load_ushort v55, v241, s[84:87], s66 offen offset:576
    buffer_load_ushort v56, v241, s[84:87], s66 offen offset:768
    buffer_load_ushort v57, v241, s[84:87], s66 offen offset:832
    buffer_load_ushort v58, v241, s[84:87], s66 offen offset:1024
    buffer_load_ushort v59, v241, s[84:87], s66 offen offset:1088
    s_waitcnt vmcnt(0)
    s_mov_b32 s66, 7680
    buffer_load_ushort v60, v241, s[84:87], s66 offen offset:0
    buffer_load_ushort v61, v241, s[84:87], s66 offen offset:64
    buffer_load_ushort v62, v241, s[84:87], s66 offen offset:256
    buffer_load_ushort v63, v241, s[84:87], s66 offen offset:320
    buffer_load_ushort v64, v241, s[84:87], s66 offen offset:512
    buffer_load_ushort v65, v241, s[84:87], s66 offen offset:576
    buffer_load_ushort v66, v241, s[84:87], s66 offen offset:768
    buffer_load_ushort v67, v241, s[84:87], s66 offen offset:832
    buffer_load_ushort v68, v241, s[84:87], s66 offen offset:1024
    buffer_load_ushort v69, v241, s[84:87], s66 offen offset:1088
    s_waitcnt vmcnt(0)
    s_mov_b32 s66, 8960
    buffer_load_ushort v70, v241, s[84:87], s66 offen offset:0
    buffer_load_ushort v71, v241, s[84:87], s66 offen offset:64
    buffer_load_ushort v72, v241, s[84:87], s66 offen offset:256
    buffer_load_ushort v73, v241, s[84:87], s66 offen offset:320
    buffer_load_ushort v74, v241, s[84:87], s66 offen offset:512
    buffer_load_ushort v75, v241, s[84:87], s66 offen offset:576
    buffer_load_ushort v76, v241, s[84:87], s66 offen offset:768
    buffer_load_ushort v77, v241, s[84:87], s66 offen offset:832
    buffer_load_ushort v78, v241, s[84:87], s66 offen offset:1024
    buffer_load_ushort v79, v241, s[84:87], s66 offen offset:1088
    s_waitcnt vmcnt(0)
    s_mov_b32 s66, 10240
    buffer_load_ushort v80, v241, s[84:87], s66 offen offset:0
    buffer_load_ushort v81, v241, s[84:87], s66 offen offset:64
    buffer_load_ushort v82, v241, s[84:87], s66 offen offset:256
    buffer_load_ushort v83, v241, s[84:87], s66 offen offset:320
    buffer_load_ushort v84, v241, s[84:87], s66 offen offset:512
    buffer_load_ushort v85, v241, s[84:87], s66 offen offset:576
    buffer_load_ushort v86, v241, s[84:87], s66 offen offset:768
    buffer_load_ushort v87, v241, s[84:87], s66 offen offset:832
    buffer_load_ushort v88, v241, s[84:87], s66 offen offset:1024
    buffer_load_ushort v89, v241, s[84:87], s66 offen offset:1088
    s_waitcnt vmcnt(0)
    s_mov_b32 s66, 11520
    buffer_load_ushort v90, v241, s[84:87], s66 offen offset:0
    buffer_load_ushort v91, v241, s[84:87], s66 offen offset:64
    buffer_load_ushort v92, v241, s[84:87], s66 offen offset:256
    buffer_load_ushort v93, v241, s[84:87], s66 offen offset:320
    buffer_load_ushort v94, v241, s[84:87], s66 offen offset:512
    buffer_load_ushort v95, v241, s[84:87], s66 offen offset:576
    buffer_load_ushort v96, v241, s[84:87], s66 offen offset:768
    buffer_load_ushort v97, v241, s[84:87], s66 offen offset:832
    buffer_load_ushort v98, v241, s[84:87], s66 offen offset:1024
    buffer_load_ushort v99, v241, s[84:87], s66 offen offset:1088
    s_waitcnt vmcnt(0)
    s_mov_b32 s66, 12800
    buffer_load_ushort v100, v241, s[84:87], s66 offen offset:0
    buffer_load_ushort v101, v241, s[84:87], s66 offen offset:64
    buffer_load_ushort v102, v241, s[84:87], s66 offen offset:256
    buffer_load_ushort v103, v241, s[84:87], s66 offen offset:320
    buffer_load_ushort v104, v241, s[84:87], s66 offen offset:512
    buffer_load_ushort v105, v241, s[84:87], s66 offen offset:576
    buffer_load_ushort v106, v241, s[84:87], s66 offen offset:768
    buffer_load_ushort v107, v241, s[84:87], s66 offen offset:832
    buffer_load_ushort v108, v241, s[84:87], s66 offen offset:1024
    buffer_load_ushort v109, v241, s[84:87], s66 offen offset:1088
    s_waitcnt vmcnt(0)
    s_mov_b32 s66, 14080
    buffer_load_ushort v110, v241, s[84:87], s66 offen offset:0
    buffer_load_ushort v111, v241, s[84:87], s66 offen offset:64
    buffer_load_ushort v112, v241, s[84:87], s66 offen offset:256
    buffer_load_ushort v113, v241, s[84:87], s66 offen offset:320
    buffer_load_ushort v114, v241, s[84:87], s66 offen offset:512
    buffer_load_ushort v115, v241, s[84:87], s66 offen offset:576
    buffer_load_ushort v116, v241, s[84:87], s66 offen offset:768
    buffer_load_ushort v117, v241, s[84:87], s66 offen offset:832
    buffer_load_ushort v118, v241, s[84:87], s66 offen offset:1024
    buffer_load_ushort v119, v241, s[84:87], s66 offen offset:1088
    s_waitcnt vmcnt(0)
    s_mov_b32 s66, 15360
    buffer_load_ushort v120, v241, s[84:87], s66 offen offset:0
    buffer_load_ushort v121, v241, s[84:87], s66 offen offset:64
    buffer_load_ushort v122, v241, s[84:87], s66 offen offset:256
    buffer_load_ushort v123, v241, s[84:87], s66 offen offset:320
    buffer_load_ushort v124, v241, s[84:87], s66 offen offset:512
    buffer_load_ushort v125, v241, s[84:87], s66 offen offset:576
    buffer_load_ushort v126, v241, s[84:87], s66 offen offset:768
    buffer_load_ushort v127, v241, s[84:87], s66 offen offset:832
    buffer_load_ushort v128, v241, s[84:87], s66 offen offset:1024
    buffer_load_ushort v129, v241, s[84:87], s66 offen offset:1088
    s_waitcnt vmcnt(0)
    s_mov_b32 s66, 16640
    buffer_load_ushort v130, v241, s[84:87], s66 offen offset:0
    buffer_load_ushort v131, v241, s[84:87], s66 offen offset:64
    buffer_load_ushort v132, v241, s[84:87], s66 offen offset:256
    buffer_load_ushort v133, v241, s[84:87], s66 offen offset:320
    buffer_load_ushort v134, v241, s[84:87], s66 offen offset:512
    buffer_load_ushort v135, v241, s[84:87], s66 offen offset:576
    buffer_load_ushort v136, v241, s[84:87], s66 offen offset:768
    buffer_load_ushort v137, v241, s[84:87], s66 offen offset:832
    buffer_load_ushort v138, v241, s[84:87], s66 offen offset:1024
    buffer_load_ushort v139, v241, s[84:87], s66 offen offset:1088
    s_waitcnt vmcnt(0)
    s_mov_b32 s66, 17920
    buffer_load_ushort v140, v241, s[84:87], s66 offen offset:0
    buffer_load_ushort v141, v241, s[84:87], s66 offen offset:64
    buffer_load_ushort v142, v241, s[84:87], s66 offen offset:256
    buffer_load_ushort v143, v241, s[84:87], s66 offen offset:320
    buffer_load_ushort v144, v241, s[84:87], s66 offen offset:512
    buffer_load_ushort v145, v241, s[84:87], s66 offen offset:576
    buffer_load_ushort v146, v241, s[84:87], s66 offen offset:768
    buffer_load_ushort v147, v241, s[84:87], s66 offen offset:832
    buffer_load_ushort v148, v241, s[84:87], s66 offen offset:1024
    buffer_load_ushort v149, v241, s[84:87], s66 offen offset:1088
    s_waitcnt vmcnt(0)
    s_mov_b32 s66, 19200
    buffer_load_ushort v150, v241, s[84:87], s66 offen offset:0
    buffer_load_ushort v151, v241, s[84:87], s66 offen offset:64
    buffer_load_ushort v152, v241, s[84:87], s66 offen offset:256
    buffer_load_ushort v153, v241, s[84:87], s66 offen offset:320
    buffer_load_ushort v154, v241, s[84:87], s66 offen offset:512
    buffer_load_ushort v155, v241, s[84:87], s66 offen offset:576
    buffer_load_ushort v156, v241, s[84:87], s66 offen offset:768
    buffer_load_ushort v157, v241, s[84:87], s66 offen offset:832
    buffer_load_ushort v158, v241, s[84:87], s66 offen offset:1024
    buffer_load_ushort v159, v241, s[84:87], s66 offen offset:1088
    s_waitcnt vmcnt(0)
    v_lshlrev_b32 v0, 16, v0
    v_lshlrev_b32 v1, 16, v1
    v_lshlrev_b32 v2, 16, v2
    v_lshlrev_b32 v3, 16, v3
    v_lshlrev_b32 v4, 16, v4
    v_lshlrev_b32 v5, 16, v5
    v_lshlrev_b32 v6, 16, v6
    v_lshlrev_b32 v7, 16, v7
    v_lshlrev_b32 v8, 16, v8
    v_lshlrev_b32 v9, 16, v9
    v_lshlrev_b32 v10, 16, v10
    v_lshlrev_b32 v11, 16, v11
    v_lshlrev_b32 v12, 16, v12
    v_lshlrev_b32 v13, 16, v13
    v_lshlrev_b32 v14, 16, v14
    v_lshlrev_b32 v15, 16, v15
    v_lshlrev_b32 v16, 16, v16
    v_lshlrev_b32 v17, 16, v17
    v_lshlrev_b32 v18, 16, v18
    v_lshlrev_b32 v19, 16, v19
    v_lshlrev_b32 v20, 16, v20
    v_lshlrev_b32 v21, 16, v21
    v_lshlrev_b32 v22, 16, v22
    v_lshlrev_b32 v23, 16, v23
    v_lshlrev_b32 v24, 16, v24
    v_lshlrev_b32 v25, 16, v25
    v_lshlrev_b32 v26, 16, v26
    v_lshlrev_b32 v27, 16, v27
    v_lshlrev_b32 v28, 16, v28
    v_lshlrev_b32 v29, 16, v29
    v_lshlrev_b32 v30, 16, v30
    v_lshlrev_b32 v31, 16, v31
    v_lshlrev_b32 v32, 16, v32
    v_lshlrev_b32 v33, 16, v33
    v_lshlrev_b32 v34, 16, v34
    v_lshlrev_b32 v35, 16, v35
    v_lshlrev_b32 v36, 16, v36
    v_lshlrev_b32 v37, 16, v37
    v_lshlrev_b32 v38, 16, v38
    v_lshlrev_b32 v39, 16, v39
    v_lshlrev_b32 v40, 16, v40
    v_lshlrev_b32 v41, 16, v41
    v_lshlrev_b32 v42, 16, v42
    v_lshlrev_b32 v43, 16, v43
    v_lshlrev_b32 v44, 16, v44
    v_lshlrev_b32 v45, 16, v45
    v_lshlrev_b32 v46, 16, v46
    v_lshlrev_b32 v47, 16, v47
    v_lshlrev_b32 v48, 16, v48
    v_lshlrev_b32 v49, 16, v49
    v_lshlrev_b32 v50, 16, v50
    v_lshlrev_b32 v51, 16, v51
    v_lshlrev_b32 v52, 16, v52
    v_lshlrev_b32 v53, 16, v53
    v_lshlrev_b32 v54, 16, v54
    v_lshlrev_b32 v55, 16, v55
    v_lshlrev_b32 v56, 16, v56
    v_lshlrev_b32 v57, 16, v57
    v_lshlrev_b32 v58, 16, v58
    v_lshlrev_b32 v59, 16, v59
    v_lshlrev_b32 v60, 16, v60
    v_lshlrev_b32 v61, 16, v61
    v_lshlrev_b32 v62, 16, v62
    v_lshlrev_b32 v63, 16, v63
    v_lshlrev_b32 v64, 16, v64
    v_lshlrev_b32 v65, 16, v65
    v_lshlrev_b32 v66, 16, v66
    v_lshlrev_b32 v67, 16, v67
    v_lshlrev_b32 v68, 16, v68
    v_lshlrev_b32 v69, 16, v69
    v_lshlrev_b32 v70, 16, v70
    v_lshlrev_b32 v71, 16, v71
    v_lshlrev_b32 v72, 16, v72
    v_lshlrev_b32 v73, 16, v73
    v_lshlrev_b32 v74, 16, v74
    v_lshlrev_b32 v75, 16, v75
    v_lshlrev_b32 v76, 16, v76
    v_lshlrev_b32 v77, 16, v77
    v_lshlrev_b32 v78, 16, v78
    v_lshlrev_b32 v79, 16, v79
    v_lshlrev_b32 v80, 16, v80
    v_lshlrev_b32 v81, 16, v81
    v_lshlrev_b32 v82, 16, v82
    v_lshlrev_b32 v83, 16, v83
    v_lshlrev_b32 v84, 16, v84
    v_lshlrev_b32 v85, 16, v85
    v_lshlrev_b32 v86, 16, v86
    v_lshlrev_b32 v87, 16, v87
    v_lshlrev_b32 v88, 16, v88
    v_lshlrev_b32 v89, 16, v89
    v_lshlrev_b32 v90, 16, v90
    v_lshlrev_b32 v91, 16, v91
    v_lshlrev_b32 v92, 16, v92
    v_lshlrev_b32 v93, 16, v93
    v_lshlrev_b32 v94, 16, v94
    v_lshlrev_b32 v95, 16, v95
    v_lshlrev_b32 v96, 16, v96
    v_lshlrev_b32 v97, 16, v97
    v_lshlrev_b32 v98, 16, v98
    v_lshlrev_b32 v99, 16, v99
    v_lshlrev_b32 v100, 16, v100
    v_lshlrev_b32 v101, 16, v101
    v_lshlrev_b32 v102, 16, v102
    v_lshlrev_b32 v103, 16, v103
    v_lshlrev_b32 v104, 16, v104
    v_lshlrev_b32 v105, 16, v105
    v_lshlrev_b32 v106, 16, v106
    v_lshlrev_b32 v107, 16, v107
    v_lshlrev_b32 v108, 16, v108
    v_lshlrev_b32 v109, 16, v109
    v_lshlrev_b32 v110, 16, v110
    v_lshlrev_b32 v111, 16, v111
    v_lshlrev_b32 v112, 16, v112
    v_lshlrev_b32 v113, 16, v113
    v_lshlrev_b32 v114, 16, v114
    v_lshlrev_b32 v115, 16, v115
    v_lshlrev_b32 v116, 16, v116
    v_lshlrev_b32 v117, 16, v117
    v_lshlrev_b32 v118, 16, v118
    v_lshlrev_b32 v119, 16, v119
    v_lshlrev_b32 v120, 16, v120
    v_lshlrev_b32 v121, 16, v121
    v_lshlrev_b32 v122, 16, v122
    v_lshlrev_b32 v123, 16, v123
    v_lshlrev_b32 v124, 16, v124
    v_lshlrev_b32 v125, 16, v125
    v_lshlrev_b32 v126, 16, v126
    v_lshlrev_b32 v127, 16, v127
    v_lshlrev_b32 v128, 16, v128
    v_lshlrev_b32 v129, 16, v129
    v_lshlrev_b32 v130, 16, v130
    v_lshlrev_b32 v131, 16, v131
    v_lshlrev_b32 v132, 16, v132
    v_lshlrev_b32 v133, 16, v133
    v_lshlrev_b32 v134, 16, v134
    v_lshlrev_b32 v135, 16, v135
    v_lshlrev_b32 v136, 16, v136
    v_lshlrev_b32 v137, 16, v137
    v_lshlrev_b32 v138, 16, v138
    v_lshlrev_b32 v139, 16, v139
    v_lshlrev_b32 v140, 16, v140
    v_lshlrev_b32 v141, 16, v141
    v_lshlrev_b32 v142, 16, v142
    v_lshlrev_b32 v143, 16, v143
    v_lshlrev_b32 v144, 16, v144
    v_lshlrev_b32 v145, 16, v145
    v_lshlrev_b32 v146, 16, v146
    v_lshlrev_b32 v147, 16, v147
    v_lshlrev_b32 v148, 16, v148
    v_lshlrev_b32 v149, 16, v149
    v_lshlrev_b32 v150, 16, v150
    v_lshlrev_b32 v151, 16, v151
    v_lshlrev_b32 v152, 16, v152
    v_lshlrev_b32 v153, 16, v153
    v_lshlrev_b32 v154, 16, v154
    v_lshlrev_b32 v155, 16, v155
    v_lshlrev_b32 v156, 16, v156
    v_lshlrev_b32 v157, 16, v157
    v_lshlrev_b32 v158, 16, v158
    v_lshlrev_b32 v159, 16, v159
    s_mov_b32 s50, 0
SL_node:
    s_mul_i32 s34, s2, 40
    s_lshl_b32 s66, s50, 3
    s_add_u32 s66, s66, s20
    s_add_u32 s34, s34, s66
    v_mov_b32 v160, 0
    v_mov_b32 v161, 0
    v_mov_b32 v162, 0
    v_mov_b32 v163, 0
    v_mov_b32 v164, 0
    v_mov_b32 v165, 0
    v_mov_b32 v166, 0
    v_mov_b32 v167, 0
    v_mov_b32 v168, 0
    v_mov_b32 v169, 0
    v_mov_b32 v170, 0
    v_mov_b32 v171, 0
    v_mov_b32 v172, 0
    v_mov_b32 v173, 0
    v_mov_b32 v174, 0
    v_mov_b32 v175, 0
    v_mov_b32 v176, 0
    v_mov_b32 v177, 0
    v_mov_b32 v178, 0
    v_mov_b32 v179, 0
    v_mov_b32 v180, 0
    v_mov_b32 v181, 0
    s_mov_b32 s35, 0
SL_scan:
    s_lshl_b32 s66, s35, 2
    buffer_load_dwordx4 v[236:239], v245, s[72:75], s66 offen
    s_waitcnt vmcnt(0)
    v_cmp_eq_u32 s[38:39], s34, v236
    v_cmp_eq_u32 s[40:41], s34, v237
    v_cmp_eq_u32 s[42:43], s34, v238
    v_cmp_eq_u32 s[44:45], s34, v239
    s_mov_b32 s36, 0
SL_bits:
    s_cmp_eq_u64 s[38:39], 0
    s_cbranch_scc1 SL_nexti
    s_ff1_i32_b64 s66, s[38:39]
    s_bitset0_b64 s[38:39], s66
    s_lshl_b32 s66, s66, 2
    s_add_u32 s37, s66, s36
    s_add_u32 s37, s37, s35
    s_lshl_b32 s66, s37, 2
    s_lshl_b32 s67, s37, 5
    s_mul_i32 s68, s37, 6
    buffer_load_dword v243, v242, s[76:79], s66 offen
    buffer_load_dwordx4 v[184:187], v242, s[12:15], s67 offen
    buffer_load_dwordx4 v[188:191], v242, s[12:15], s67 offen offset:16
    buffer_load_ushort v226, v242, s[80:83], s68 offen offset:0
    buffer_load_ushort v227, v242, s[80:83], s68 offen offset:2
    buffer_load_ushort v228, v242, s[80:83], s68 offen offset:4
    s_waitcnt vmcnt(5)
    v_lshl_add_u32 v243, v243, 10, v241
    buffer_load_ushort v208, v243, s[4:7], 0 offen offset:0
    buffer_load_ushort v209, v243, s[4:7], 0 offen offset:64
    buffer_load_ushort v210, v243, s[4:7], 0 offen offset:256
    buffer_load_ushort v211, v243, s[4:7], 0 offen offset:320
    buffer_load_ushort v212, v243, s[4:7], 0 offen offset:512
    buffer_load_ushort v213, v243, s[4:7], 0 offen offset:576
    buffer_load_ushort v214, v243, s[4:7], 0 offen offset:768
    buffer_load_ushort v215, v243, s[4:7], 0 offen offset:832
    s_waitcnt vmcnt(8)
    v_lshlrev_b32 v192, 16, v184
    v_and_b32 v193, 0xffff0000, v184
    v_lshlrev_b32 v194, 16, v185
    v_and_b32 v195, 0xffff0000, v185
    v_lshlrev_b32 v196, 16, v186
    v_and_b32 v197, 0xffff0000, v186
    v_lshlrev_b32 v198, 16, v187
    v_and_b32 v199, 0xffff0000, v187
    v_lshlrev_b32 v200, 16, v188
    v_and_b32 v201, 0xffff0000, v188
    v_lshlrev_b32 v202, 16, v189
    v_and_b32 v203, 0xffff0000, v189
    v_lshlrev_b32 v204, 16, v190
    v_and_b32 v205, 0xffff0000, v190
    v_lshlrev_b32 v206, 16, v191
    v_and_b32 v207, 0xffff0000, v191
    v_lshlrev_b32 v226, 16, v226
    v_lshlrev_b32 v227, 16, v227
    v_lshlrev_b32 v228, 16, v228
    v_mul_f32 v216, v192, v0
    v_mul_f32 v217, v192, v1
    v_mul_f32 v218, v192, v2
    v_mul_f32 v219, v192, v3
    v_mul_f32 v220, v192, v4
    v_mul_f32 v221, v192, v5
    v_mul_f32 v222, v192, v6
    v_mul_f32 v223, v192, v7
    v_mul_f32 v224, v192, v8
    v_mul_f32 v225, v192, v9
    v_fmac_f32 v216, v193, v10
    v_fmac_f32 v217, v193, v11
    v_fmac_f32 v218, v193, v12
    v_fmac_f32 v219, v193, v13
    v_fmac_f32 v220, v193, v14
    v_fmac_f32 v221, v193, v15
    v_fmac_f32 v222, v193, v16
    v_fmac_f32 v223, v193, v17
    v_fmac_f32 v224, v193, v18
    v_fmac_f32 v225, v193, v19
    v_fmac_f32 v216, v194, v20
    v_fmac_f32 v217, v194, v21
    v_fmac_f32 v218, v194, v22
    v_fmac_f32 v219, v194, v23
    v_fmac_f32 v220, v194, v24
    v_fmac_f32 v221, v194, v25
    v_fmac_f32 v222, v194, v26
    v_fmac_f32 v223, v194, v27
    v_fmac_f32 v224, v194, v28
    v_fmac_f32 v225, v194, v29
    v_fmac_f32 v216, v195, v30
    v_fmac_f32 v217, v195, v31
    v_fmac_f32 v218, v195, v32
    v_fmac_f32 v219, v195, v33
    v_fmac_f32 v220, v195, v34
    v_fmac_f32 v221, v195, v35
    v_fmac_f32 v222, v195, v36
    v_fmac_f32 v223, v195, v37
    v_fmac_f32 v224, v195, v38
    v_fmac_f32 v225, v195, v39
    v_fmac_f32 v216, v196, v40
    v_fmac_f32 v217, v196, v41
    v_fmac_f32 v218, v196, v42
    v_fmac_f32 v219, v196, v43
    v_fmac_f32 v220, v196, v44
    v_fmac_f32 v221, v196, v45
    v_fmac_f32 v222, v196, v46
    v_fmac_f32 v223, v196, v47
    v_fmac_f32 v224, v196, v48
    v_fmac_f32 v225, v196, v49
    v_fmac_f32 v216, v197, v50
    v_fmac_f32 v217, v197, v51
    v_fmac_f32 v218, v197, v52
    v_fmac_f32 v219, v197, v53
    v_fmac_f32 v220, v197, v54
    v_fmac_f32 v221, v197, v55
    v_fmac_f32 v222, v197, v56
    v_fmac_f32 v223, v197, v57
    v_fmac_f32 v224, v197, v58
    v_fmac_f32 v225, v197, v59
    v_fmac_f32 v216, v198, v60
    v_fmac_f32 v217, v198, v61
    v_fmac_f32 v218, v198, v62
    v_fmac_f32 v219, v198, v63
    v_fmac_f32 v220, v198, v64
    v_fmac_f32 v221, v198, v65
    v_fmac_f32 v222, v198, v66
    v_fmac_f32 v223, v198, v67
    v_fmac_f32 v224, v198, v68
    v_fmac_f32 v225, v198, v69
    v_fmac_f32 v216, v199, v70
    v_fmac_f32 v217, v199, v71
    v_fmac_f32 v218, v199, v72
    v_fmac_f32 v219, v199, v73
    v_fmac_f32 v220, v199, v74
    v_fmac_f32 v221, v199, v75
    v_fmac_f32 v222, v199, v76
    v_fmac_f32 v223, v199, v77
    v_fmac_f32 v224, v199, v78
    v_fmac_f32 v225, v199, v79
    v_fmac_f32 v216, v200, v80
    v_fmac_f32 v217, v200, v81
    v_fmac_f32 v218, v200, v82
    v_fmac_f32 v219, v200, v83
    v_fmac_f32 v220, v200, v84
    v_fmac_f32 v221, v200, v85
    v_fmac_f32 v222, v200, v86
    v_fmac_f32 v223, v200, v87
    v_fmac_f32 v224, v200, v88
    v_fmac_f32 v225, v200, v89
    v_fmac_f32 v216, v201, v90
    v_fmac_f32 v217, v201, v91
    v_fmac_f32 v218, v201, v92
    v_fmac_f32 v219, v201, v93
    v_fmac_f32 v220, v201, v94
    v_fmac_f32 v221, v201, v95
    v_fmac_f32 v222, v201, v96
    v_fmac_f32 v223, v201, v97
    v_fmac_f32 v224, v201, v98
    v_fmac_f32 v225, v201, v99
    v_fmac_f32 v216, v202, v100
    v_fmac_f32 v217, v202, v101
    v_fmac_f32 v218, v202, v102
    v_fmac_f32 v219, v202, v103
    v_fmac_f32 v220, v202, v104
    v_fmac_f32 v221, v202, v105
    v_fmac_f32 v222, v202, v106
    v_fmac_f32 v223, v202, v107
    v_fmac_f32 v224, v202, v108
    v_fmac_f32 v225, v202, v109
    v_fmac_f32 v216, v203, v110
    v_fmac_f32 v217, v203, v111
    v_fmac_f32 v218, v203, v112
    v_fmac_f32 v219, v203, v113
    v_fmac_f32 v220, v203, v114
    v_fmac_f32 v221, v203, v115
    v_fmac_f32 v222, v203, v116
    v_fmac_f32 v223, v203, v117
    v_fmac_f32 v224, v203, v118
    v_fmac_f32 v225, v203, v119
    v_fmac_f32 v216, v204, v120
    v_fmac_f32 v217, v204, v121
    v_fmac_f32 v218, v204, v122
    v_fmac_f32 v219, v204, v123
    v_fmac_f32 v220, v204, v124
    v_fmac_f32 v221, v204, v125
    v_fmac_f32 v222, v204, v126
    v_fmac_f32 v223, v204, v127
    v_fmac_f32 v224, v204, v128
    v_fmac_f32 v225, v204, v129
    v_fmac_f32 v216, v205, v130
    v_fmac_f32 v217, v205, v131
    v_fmac_f32 v218, v205, v132
    v_fmac_f32 v219, v205, v133
    v_fmac_f32 v220, v205, v134
    v_fmac_f32 v221, v205, v135
    v_fmac_f32 v222, v205, v136
    v_fmac_f32 v223, v205, v137
    v_fmac_f32 v224, v205, v138
    v_fmac_f32 v225, v205, v139
    v_fmac_f32 v216, v206, v140
    v_fmac_f32 v217, v206, v141
    v_fmac_f32 v218, v206, v142
    v_fmac_f32 v219, v206, v143
    v_fmac_f32 v220, v206, v144
    v_fmac_f32 v221, v206, v145
    v_fmac_f32 v222, v206, v146
    v_fmac_f32 v223, v206, v147
    v_fmac_f32 v224, v206, v148
    v_fmac_f32 v225, v206, v149
    v_fmac_f32 v216, v207, v150
    v_fmac_f32 v217, v207, v151
    v_fmac_f32 v218, v207, v152
    v_fmac_f32 v219, v207, v153
    v_fmac_f32 v220, v207, v154
    v_fmac_f32 v221, v207, v155
    v_fmac_f32 v222, v207, v156
    v_fmac_f32 v223, v207, v157
    v_fmac_f32 v224, v207, v158
    v_fmac_f32 v225, v207, v159
    s_waitcnt vmcnt(0)
    v_lshlrev_b32 v208, 16, v208
    v_lshlrev_b32 v209, 16, v209
    v_lshlrev_b32 v210, 16, v210
    v_lshlrev_b32 v211, 16, v211
    v_lshlrev_b32 v212, 16, v212
    v_lshlrev_b32 v213, 16, v213
    v_lshlrev_b32 v214, 16, v214
    v_lshlrev_b32 v215, 16, v215
    v_fmac_f32 v160, v208, v216
    v_mul_f32 v229, v210, v226
    v_fmac_f32 v229, v212, v227
    v_fmac_f32 v229, v214, v228
    v_fmac_f32 v176, v229, v218
    v_mul_f32 v229, v208, v220
    v_fmac_f32 v162, v229, v226
    v_fmac_f32 v168, v210, v222
    v_mul_f32 v230, v227, v214
    v_fma_f32 v230, -v228, v212, v230
    v_fmac_f32 v178, v230, v224
    v_fmac_f32 v164, v229, v227
    v_fmac_f32 v170, v212, v222
    v_mul_f32 v230, v228, v210
    v_fma_f32 v230, -v226, v214, v230
    v_fmac_f32 v180, v230, v224
    v_fmac_f32 v166, v229, v228
    v_fmac_f32 v172, v214, v222
    v_mul_f32 v230, v226, v212
    v_fma_f32 v230, -v227, v210, v230
    v_fmac_f32 v174, v230, v224
    v_fmac_f32 v161, v209, v217
    v_mul_f32 v229, v211, v226
    v_fmac_f32 v229, v213, v227
    v_fmac_f32 v229, v215, v228
    v_fmac_f32 v177, v229, v219
    v_mul_f32 v229, v209, v221
    v_fmac_f32 v163, v229, v226
    v_fmac_f32 v169, v211, v223
    v_mul_f32 v230, v227, v215
    v_fma_f32 v230, -v228, v213, v230
    v_fmac_f32 v179, v230, v225
    v_fmac_f32 v165, v229, v227
    v_fmac_f32 v171, v213, v223
    v_mul_f32 v230, v228, v211
    v_fma_f32 v230, -v226, v215, v230
    v_fmac_f32 v181, v230, v225
    v_fmac_f32 v167, v229, v228
    v_fmac_f32 v173, v215, v223
    v_mul_f32 v230, v226, v213
    v_fma_f32 v230, -v227, v211, v230
    v_fmac_f32 v175, v230, v225
    s_branch SL_bits
SL_nexti:
    s_mov_b64 s[38:39], s[40:41]
    s_mov_b64 s[40:41], s[42:43]
    s_mov_b64 s[42:43], s[44:45]
    s_add_u32 s36, s36, 1
    s_cmp_lt_u32 s36, 4
    s_cbranch_scc1 SL_bits
    s_add_u32 s35, s35, 256
    s_cmp_lt_u32 s35, 320000
    s_cbranch_scc1 SL_scan
    s_lshl_b32 s66, s50, 3
    s_add_u32 s66, s66, s20
    s_lshl_b32 s67, s66, 4
    s_and_b32 s68, s67, 128
    s_and_b32 s67, s67, 0x70
    s_mul_i32 s69, s50, 1536
    s_add_u32 s69, s69, s21
    s_add_u32 s69, s69, s68
    s_mul_i32 s70, s66, 1536
    s_add_u32 s70, s70, 86016
    s_add_u32 s70, s70, s68
    v_mov_b32 v230, s69
    v_mov_b32 v231, s70
    v_cmp_gt_u32 vcc, 32, v240
    v_and_b32 v229, 31, v240
    v_lshlrev_b32 v229, 2, v229
    v_xor_b32 v229, s67, v229
    v_cndmask_b32 v244, v231, v230, vcc
    v_add_u32 v244, v244, v229
    v_cvt_pk_bf16_f32 v160, v160, v161
    ds_write_b32 v244, v160 offset:0
    v_cvt_pk_bf16_f32 v162, v162, v163
    ds_write_b32 v244, v162 offset:128
    v_cvt_pk_bf16_f32 v164, v164, v165
    ds_write_b32 v244, v164 offset:256
    v_cvt_pk_bf16_f32 v166, v166, v167
    ds_write_b32 v244, v166 offset:384
    v_cvt_pk_bf16_f32 v168, v168, v169
    ds_write_b32 v244, v168 offset:512
    v_cvt_pk_bf16_f32 v170, v170, v171
    ds_write_b32 v244, v170 offset:640
    v_cvt_pk_bf16_f32 v172, v172, v173
    ds_write_b32 v244, v172 offset:768
    v_cvt_pk_bf16_f32 v174, v174, v175
    ds_write_b32 v244, v174 offset:896
    v_cvt_pk_bf16_f32 v176, v176, v177
    ds_write_b32 v244, v176 offset:1024
    v_cvt_pk_bf16_f32 v178, v178, v179
    ds_write_b32 v244, v178 offset:1152
    v_cvt_pk_bf16_f32 v180, v180, v181
    ds_write_b32 v244, v180 offset:1280
    s_lshl_b32 s66, s66, 3
    s_add_u32 s66, s66, 163328
    v_mov_b32 v229, s66
    ds_write_b64 v229, v[230:231]
    s_add_u32 s50, s50, 1
    s_cmp_lt_u32 s50, 5
    s_cbranch_scc1 SL_node
    s_waitcnt lgkmcnt(0)
    s_barrier
    v_mov_b32 v176, v240
    s_load_dwordx4 s[84:87], s[0:1], 48
    s_mul_i32 s22, s20, 20
    s_waitcnt lgkmcnt(0)
    s_mul_i32 s24, s22, 3277
    s_lshr_b32 s24, s24, 16
    s_mul_i32 s68, s24, 20
    s_sub_u32 s68, s22, s68
    s_cmp_lt_u32 s68, 8
    s_cselect_b64 s[66:67], s[84:85], s[86:87]
    s_cselect_b32 s25, 0, 8
    s_sub_u32 s68, s68, s25
    s_and_b32 s25, s68, 1
    s_lshr_b32 s68, s68, 1
    s_lshl_b32 s68, s68, 14
    s_lshl_b32 s25, s25, 12
    s_add_u32 s68, s68, s25
    s_lshl_b32 s24, s24, 5
    s_add_u32 s68, s68, s24
    v_lshrrev_b32 v2, 4, v176
    v_lshlrev_b32 v2, 10, v2
    v_and_b32 v3, 15, v176
    v_lshl_add_u32 v2, v3, 1, v2
    v_add_u32 v2, s68, v2
    v_add_u32 v3, 8192, v2
    v_mov_b32 v4, 0
    v_mov_b32 v5, 0
    v_mov_b32 v6, 0
    v_mov_b32 v7, 0
    global_load_ushort v144, v2, s[66:67] offset:0
    global_load_short_d16_hi v4, v3, s[66:67] offset:0
    global_load_ushort v145, v2, s[66:67] offset:256
    global_load_short_d16_hi v5, v3, s[66:67] offset:256
    global_load_ushort v146, v2, s[66:67] offset:512
    global_load_short_d16_hi v6, v3, s[66:67] offset:512
    global_load_ushort v147, v2, s[66:67] offset:768
    global_load_short_d16_hi v7, v3, s[66:67] offset:768
    s_add_u32 s22, s22, 1
    s_waitcnt vmcnt(0)
    v_or_b32 v144, v144, v4
    v_or_b32 v145, v145, v5
    v_or_b32 v146, v146, v6
    v_or_b32 v147, v147, v7
    s_mul_i32 s24, s22, 3277
    s_lshr_b32 s24, s24, 16
    s_mul_i32 s68, s24, 20
    s_sub_u32 s68, s22, s68
    s_cmp_lt_u32 s68, 8
    s_cselect_b64 s[66:67], s[84:85], s[86:87]
    s_cselect_b32 s25, 0, 8
    s_sub_u32 s68, s68, s25
    s_and_b32 s25, s68, 1
    s_lshr_b32 s68, s68, 1
    s_lshl_b32 s68, s68, 14
    s_lshl_b32 s25, s25, 12
    s_add_u32 s68, s68, s25
    s_lshl_b32 s24, s24, 5
    s_add_u32 s68, s68, s24
    v_lshrrev_b32 v2, 4, v176
    v_lshlrev_b32 v2, 10, v2
    v_and_b32 v3, 15, v176
    v_lshl_add_u32 v2, v3, 1, v2
    v_add_u32 v2, s68, v2
    v_add_u32 v3, 8192, v2
    v_mov_b32 v4, 0
    v_mov_b32 v5, 0
    v_mov_b32 v6, 0
    v_mov_b32 v7, 0
    global_load_ushort v148, v2, s[66:67] offset:0
    global_load_short_d16_hi v4, v3, s[66:67] offset:0
    global_load_ushort v149, v2, s[66:67] offset:256
    global_load_short_d16_hi v5, v3, s[66:67] offset:256
    global_load_ushort v150, v2, s[66:67] offset:512
    global_load_short_d16_hi v6, v3, s[66:67] offset:512
    global_load_ushort v151, v2, s[66:67] offset:768
    global_load_short_d16_hi v7, v3, s[66:67] offset:768
    s_add_u32 s22, s22, 1
    s_waitcnt vmcnt(0)
    v_or_b32 v148, v148, v4
    v_or_b32 v149, v149, v5
    v_or_b32 v150, v150, v6
    v_or_b32 v151, v151, v7
    s_mul_i32 s24, s22, 3277
    s_lshr_b32 s24, s24, 16
    s_mul_i32 s68, s24, 20
    s_sub_u32 s68, s22, s68
    s_cmp_lt_u32 s68, 8
    s_cselect_b64 s[66:67], s[84:85], s[86:87]
    s_cselect_b32 s25, 0, 8
    s_sub_u32 s68, s68, s25
    s_and_b32 s25, s68, 1
    s_lshr_b32 s68, s68, 1
    s_lshl_b32 s68, s68, 14
    s_lshl_b32 s25, s25, 12
    s_add_u32 s68, s68, s25
    s_lshl_b32 s24, s24, 5
    s_add_u32 s68, s68, s24
    v_lshrrev_b32 v2, 4, v176
    v_lshlrev_b32 v2, 10, v2
    v_and_b32 v3, 15, v176
    v_lshl_add_u32 v2, v3, 1, v2
    v_add_u32 v2, s68, v2
    v_add_u32 v3, 8192, v2
    v_mov_b32 v4, 0
    v_mov_b32 v5, 0
    v_mov_b32 v6, 0
    v_mov_b32 v7, 0
    global_load_ushort v96, v2, s[66:67] offset:0
    global_load_short_d16_hi v4, v3, s[66:67] offset:0
    global_load_ushort v97, v2, s[66:67] offset:256
    global_load_short_d16_hi v5, v3, s[66:67] offset:256
    global_load_ushort v98, v2, s[66:67] offset:512
    global_load_short_d16_hi v6, v3, s[66:67] offset:512
    global_load_ushort v99, v2, s[66:67] offset:768
    global_load_short_d16_hi v7, v3, s[66:67] offset:768
    s_add_u32 s22, s22, 1
    s_waitcnt vmcnt(0)
    v_or_b32 v96, v96, v4
    v_or_b32 v97, v97, v5
    v_or_b32 v98, v98, v6
    v_or_b32 v99, v99, v7
    s_mul_i32 s24, s22, 3277
    s_lshr_b32 s24, s24, 16
    s_mul_i32 s68, s24, 20
    s_sub_u32 s68, s22, s68
    s_cmp_lt_u32 s68, 8
    s_cselect_b64 s[66:67], s[84:85], s[86:87]
    s_cselect_b32 s25, 0, 8
    s_sub_u32 s68, s68, s25
    s_and_b32 s25, s68, 1
    s_lshr_b32 s68, s68, 1
    s_lshl_b32 s68, s68, 14
    s_lshl_b32 s25, s25, 12
    s_add_u32 s68, s68, s25
    s_lshl_b32 s24, s24, 5
    s_add_u32 s68, s68, s24
    v_lshrrev_b32 v2, 4, v176
    v_lshlrev_b32 v2, 10, v2
    v_and_b32 v3, 15, v176
    v_lshl_add_u32 v2, v3, 1, v2
    v_add_u32 v2, s68, v2
    v_add_u32 v3, 8192, v2
    v_mov_b32 v4, 0
    v_mov_b32 v5, 0
    v_mov_b32 v6, 0
    v_mov_b32 v7, 0
    global_load_ushort v100, v2, s[66:67] offset:0
    global_load_short_d16_hi v4, v3, s[66:67] offset:0
    global_load_ushort v101, v2, s[66:67] offset:256
    global_load_short_d16_hi v5, v3, s[66:67] offset:256
    global_load_ushort v102, v2, s[66:67] offset:512
    global_load_short_d16_hi v6, v3, s[66:67] offset:512
    global_load_ushort v103, v2, s[66:67] offset:768
    global_load_short_d16_hi v7, v3, s[66:67] offset:768
    s_add_u32 s22, s22, 1
    s_waitcnt vmcnt(0)
    v_or_b32 v100, v100, v4
    v_or_b32 v101, v101, v5
    v_or_b32 v102, v102, v6
    v_or_b32 v103, v103, v7
    s_mul_i32 s24, s22, 3277
    s_lshr_b32 s24, s24, 16
    s_mul_i32 s68, s24, 20
    s_sub_u32 s68, s22, s68
    s_cmp_lt_u32 s68, 8
    s_cselect_b64 s[66:67], s[84:85], s[86:87]
    s_cselect_b32 s25, 0, 8
    s_sub_u32 s68, s68, s25
    s_and_b32 s25, s68, 1
    s_lshr_b32 s68, s68, 1
    s_lshl_b32 s68, s68, 14
    s_lshl_b32 s25, s25, 12
    s_add_u32 s68, s68, s25
    s_lshl_b32 s24, s24, 5
    s_add_u32 s68, s68, s24
    v_lshrrev_b32 v2, 4, v176
    v_lshlrev_b32 v2, 10, v2
    v_and_b32 v3, 15, v176
    v_lshl_add_u32 v2, v3, 1, v2
    v_add_u32 v2, s68, v2
    v_add_u32 v3, 8192, v2
    v_mov_b32 v4, 0
    v_mov_b32 v5, 0
    v_mov_b32 v6, 0
    v_mov_b32 v7, 0
    global_load_ushort v160, v2, s[66:67] offset:0
    global_load_short_d16_hi v4, v3, s[66:67] offset:0
    global_load_ushort v161, v2, s[66:67] offset:256
    global_load_short_d16_hi v5, v3, s[66:67] offset:256
    global_load_ushort v162, v2, s[66:67] offset:512
    global_load_short_d16_hi v6, v3, s[66:67] offset:512
    global_load_ushort v163, v2, s[66:67] offset:768
    global_load_short_d16_hi v7, v3, s[66:67] offset:768
    s_add_u32 s22, s22, 1
    s_waitcnt vmcnt(0)
    v_or_b32 v160, v160, v4
    v_or_b32 v161, v161, v5
    v_or_b32 v162, v162, v6
    v_or_b32 v163, v163, v7
    s_mul_i32 s24, s22, 3277
    s_lshr_b32 s24, s24, 16
    s_mul_i32 s68, s24, 20
    s_sub_u32 s68, s22, s68
    s_cmp_lt_u32 s68, 8
    s_cselect_b64 s[66:67], s[84:85], s[86:87]
    s_cselect_b32 s25, 0, 8
    s_sub_u32 s68, s68, s25
    s_and_b32 s25, s68, 1
    s_lshr_b32 s68, s68, 1
    s_lshl_b32 s68, s68, 14
    s_lshl_b32 s25, s25, 12
    s_add_u32 s68, s68, s25
    s_lshl_b32 s24, s24, 5
    s_add_u32 s68, s68, s24
    v_lshrrev_b32 v2, 4, v176
    v_lshlrev_b32 v2, 10, v2
    v_and_b32 v3, 15, v176
    v_lshl_add_u32 v2, v3, 1, v2
    v_add_u32 v2, s68, v2
    v_add_u32 v3, 8192, v2
    v_mov_b32 v4, 0
    v_mov_b32 v5, 0
    v_mov_b32 v6, 0
    v_mov_b32 v7, 0
    global_load_ushort v164, v2, s[66:67] offset:0
    global_load_short_d16_hi v4, v3, s[66:67] offset:0
    global_load_ushort v165, v2, s[66:67] offset:256
    global_load_short_d16_hi v5, v3, s[66:67] offset:256
    global_load_ushort v166, v2, s[66:67] offset:512
    global_load_short_d16_hi v6, v3, s[66:67] offset:512
    global_load_ushort v167, v2, s[66:67] offset:768
    global_load_short_d16_hi v7, v3, s[66:67] offset:768
    s_add_u32 s22, s22, 1
    s_waitcnt vmcnt(0)
    v_or_b32 v164, v164, v4
    v_or_b32 v165, v165, v5
    v_or_b32 v166, v166, v6
    v_or_b32 v167, v167, v7
    s_mul_i32 s24, s22, 3277
    s_lshr_b32 s24, s24, 16
    s_mul_i32 s68, s24, 20
    s_sub_u32 s68, s22, s68
    s_cmp_lt_u32 s68, 8
    s_cselect_b64 s[66:67], s[84:85], s[86:87]
    s_cselect_b32 s25, 0, 8
    s_sub_u32 s68, s68, s25
    s_and_b32 s25, s68, 1
    s_lshr_b32 s68, s68, 1
    s_lshl_b32 s68, s68, 14
    s_lshl_b32 s25, s25, 12
    s_add_u32 s68, s68, s25
    s_lshl_b32 s24, s24, 5
    s_add_u32 s68, s68, s24
    v_lshrrev_b32 v2, 4, v176
    v_lshlrev_b32 v2, 10, v2
    v_and_b32 v3, 15, v176
    v_lshl_add_u32 v2, v3, 1, v2
    v_add_u32 v2, s68, v2
    v_add_u32 v3, 8192, v2
    v_mov_b32 v4, 0
    v_mov_b32 v5, 0
    v_mov_b32 v6, 0
    v_mov_b32 v7, 0
    global_load_ushort v104, v2, s[66:67] offset:0
    global_load_short_d16_hi v4, v3, s[66:67] offset:0
    global_load_ushort v105, v2, s[66:67] offset:256
    global_load_short_d16_hi v5, v3, s[66:67] offset:256
    global_load_ushort v106, v2, s[66:67] offset:512
    global_load_short_d16_hi v6, v3, s[66:67] offset:512
    global_load_ushort v107, v2, s[66:67] offset:768
    global_load_short_d16_hi v7, v3, s[66:67] offset:768
    s_add_u32 s22, s22, 1
    s_waitcnt vmcnt(0)
    v_or_b32 v104, v104, v4
    v_or_b32 v105, v105, v5
    v_or_b32 v106, v106, v6
    v_or_b32 v107, v107, v7
    s_mul_i32 s24, s22, 3277
    s_lshr_b32 s24, s24, 16
    s_mul_i32 s68, s24, 20
    s_sub_u32 s68, s22, s68
    s_cmp_lt_u32 s68, 8
    s_cselect_b64 s[66:67], s[84:85], s[86:87]
    s_cselect_b32 s25, 0, 8
    s_sub_u32 s68, s68, s25
    s_and_b32 s25, s68, 1
    s_lshr_b32 s68, s68, 1
    s_lshl_b32 s68, s68, 14
    s_lshl_b32 s25, s25, 12
    s_add_u32 s68, s68, s25
    s_lshl_b32 s24, s24, 5
    s_add_u32 s68, s68, s24
    v_lshrrev_b32 v2, 4, v176
    v_lshlrev_b32 v2, 10, v2
    v_and_b32 v3, 15, v176
    v_lshl_add_u32 v2, v3, 1, v2
    v_add_u32 v2, s68, v2
    v_add_u32 v3, 8192, v2
    v_mov_b32 v4, 0
    v_mov_b32 v5, 0
    v_mov_b32 v6, 0
    v_mov_b32 v7, 0
    global_load_ushort v108, v2, s[66:67] offset:0
    global_load_short_d16_hi v4, v3, s[66:67] offset:0
    global_load_ushort v109, v2, s[66:67] offset:256
    global_load_short_d16_hi v5, v3, s[66:67] offset:256
    global_load_ushort v110, v2, s[66:67] offset:512
    global_load_short_d16_hi v6, v3, s[66:67] offset:512
    global_load_ushort v111, v2, s[66:67] offset:768
    global_load_short_d16_hi v7, v3, s[66:67] offset:768
    s_add_u32 s22, s22, 1
    s_waitcnt vmcnt(0)
    v_or_b32 v108, v108, v4
    v_or_b32 v109, v109, v5
    v_or_b32 v110, v110, v6
    v_or_b32 v111, v111, v7
    s_mul_i32 s24, s22, 3277
    s_lshr_b32 s24, s24, 16
    s_mul_i32 s68, s24, 20
    s_sub_u32 s68, s22, s68
    s_cmp_lt_u32 s68, 8
    s_cselect_b64 s[66:67], s[84:85], s[86:87]
    s_cselect_b32 s25, 0, 8
    s_sub_u32 s68, s68, s25
    s_and_b32 s25, s68, 1
    s_lshr_b32 s68, s68, 1
    s_lshl_b32 s68, s68, 14
    s_lshl_b32 s25, s25, 12
    s_add_u32 s68, s68, s25
    s_lshl_b32 s24, s24, 5
    s_add_u32 s68, s68, s24
    v_lshrrev_b32 v2, 4, v176
    v_lshlrev_b32 v2, 10, v2
    v_and_b32 v3, 15, v176
    v_lshl_add_u32 v2, v3, 1, v2
    v_add_u32 v2, s68, v2
    v_add_u32 v3, 8192, v2
    v_mov_b32 v4, 0
    v_mov_b32 v5, 0
    v_mov_b32 v6, 0
    v_mov_b32 v7, 0
    global_load_ushort v120, v2, s[66:67] offset:0
    global_load_short_d16_hi v4, v3, s[66:67] offset:0
    global_load_ushort v121, v2, s[66:67] offset:256
    global_load_short_d16_hi v5, v3, s[66:67] offset:256
    global_load_ushort v122, v2, s[66:67] offset:512
    global_load_short_d16_hi v6, v3, s[66:67] offset:512
    global_load_ushort v123, v2, s[66:67] offset:768
    global_load_short_d16_hi v7, v3, s[66:67] offset:768
    s_add_u32 s22, s22, 1
    s_waitcnt vmcnt(0)
    v_or_b32 v120, v120, v4
    v_or_b32 v121, v121, v5
    v_or_b32 v122, v122, v6
    v_or_b32 v123, v123, v7
    s_mul_i32 s24, s22, 3277
    s_lshr_b32 s24, s24, 16
    s_mul_i32 s68, s24, 20
    s_sub_u32 s68, s22, s68
    s_cmp_lt_u32 s68, 8
    s_cselect_b64 s[66:67], s[84:85], s[86:87]
    s_cselect_b32 s25, 0, 8
    s_sub_u32 s68, s68, s25
    s_and_b32 s25, s68, 1
    s_lshr_b32 s68, s68, 1
    s_lshl_b32 s68, s68, 14
    s_lshl_b32 s25, s25, 12
    s_add_u32 s68, s68, s25
    s_lshl_b32 s24, s24, 5
    s_add_u32 s68, s68, s24
    v_lshrrev_b32 v2, 4, v176
    v_lshlrev_b32 v2, 10, v2
    v_and_b32 v3, 15, v176
    v_lshl_add_u32 v2, v3, 1, v2
    v_add_u32 v2, s68, v2
    v_add_u32 v3, 8192, v2
    v_mov_b32 v4, 0
    v_mov_b32 v5, 0
    v_mov_b32 v6, 0
    v_mov_b32 v7, 0
    global_load_ushort v124, v2, s[66:67] offset:0
    global_load_short_d16_hi v4, v3, s[66:67] offset:0
    global_load_ushort v125, v2, s[66:67] offset:256
    global_load_short_d16_hi v5, v3, s[66:67] offset:256
    global_load_ushort v126, v2, s[66:67] offset:512
    global_load_short_d16_hi v6, v3, s[66:67] offset:512
    global_load_ushort v127, v2, s[66:67] offset:768
    global_load_short_d16_hi v7, v3, s[66:67] offset:768
    s_add_u32 s22, s22, 1
    s_waitcnt vmcnt(0)
    v_or_b32 v124, v124, v4
    v_or_b32 v125, v125, v5
    v_or_b32 v126, v126, v6
    v_or_b32 v127, v127, v7
    s_mul_i32 s24, s22, 3277
    s_lshr_b32 s24, s24, 16
    s_mul_i32 s68, s24, 20
    s_sub_u32 s68, s22, s68
    s_cmp_lt_u32 s68, 8
    s_cselect_b64 s[66:67], s[84:85], s[86:87]
    s_cselect_b32 s25, 0, 8
    s_sub_u32 s68, s68, s25
    s_and_b32 s25, s68, 1
    s_lshr_b32 s68, s68, 1
    s_lshl_b32 s68, s68, 14
    s_lshl_b32 s25, s25, 12
    s_add_u32 s68, s68, s25
    s_lshl_b32 s24, s24, 5
    s_add_u32 s68, s68, s24
    v_lshrrev_b32 v2, 4, v176
    v_lshlrev_b32 v2, 10, v2
    v_and_b32 v3, 15, v176
    v_lshl_add_u32 v2, v3, 1, v2
    v_add_u32 v2, s68, v2
    v_add_u32 v3, 8192, v2
    v_mov_b32 v4, 0
    v_mov_b32 v5, 0
    v_mov_b32 v6, 0
    v_mov_b32 v7, 0
    global_load_ushort v128, v2, s[66:67] offset:0
    global_load_short_d16_hi v4, v3, s[66:67] offset:0
    global_load_ushort v129, v2, s[66:67] offset:256
    global_load_short_d16_hi v5, v3, s[66:67] offset:256
    global_load_ushort v130, v2, s[66:67] offset:512
    global_load_short_d16_hi v6, v3, s[66:67] offset:512
    global_load_ushort v131, v2, s[66:67] offset:768
    global_load_short_d16_hi v7, v3, s[66:67] offset:768
    s_add_u32 s22, s22, 1
    s_waitcnt vmcnt(0)
    v_or_b32 v128, v128, v4
    v_or_b32 v129, v129, v5
    v_or_b32 v130, v130, v6
    v_or_b32 v131, v131, v7
    s_mul_i32 s24, s22, 3277
    s_lshr_b32 s24, s24, 16
    s_mul_i32 s68, s24, 20
    s_sub_u32 s68, s22, s68
    s_cmp_lt_u32 s68, 8
    s_cselect_b64 s[66:67], s[84:85], s[86:87]
    s_cselect_b32 s25, 0, 8
    s_sub_u32 s68, s68, s25
    s_and_b32 s25, s68, 1
    s_lshr_b32 s68, s68, 1
    s_lshl_b32 s68, s68, 14
    s_lshl_b32 s25, s25, 12
    s_add_u32 s68, s68, s25
    s_lshl_b32 s24, s24, 5
    s_add_u32 s68, s68, s24
    v_lshrrev_b32 v2, 4, v176
    v_lshlrev_b32 v2, 10, v2
    v_and_b32 v3, 15, v176
    v_lshl_add_u32 v2, v3, 1, v2
    v_add_u32 v2, s68, v2
    v_add_u32 v3, 8192, v2
    v_mov_b32 v4, 0
    v_mov_b32 v5, 0
    v_mov_b32 v6, 0
    v_mov_b32 v7, 0
    global_load_ushort v132, v2, s[66:67] offset:0
    global_load_short_d16_hi v4, v3, s[66:67] offset:0
    global_load_ushort v133, v2, s[66:67] offset:256
    global_load_short_d16_hi v5, v3, s[66:67] offset:256
    global_load_ushort v134, v2, s[66:67] offset:512
    global_load_short_d16_hi v6, v3, s[66:67] offset:512
    global_load_ushort v135, v2, s[66:67] offset:768
    global_load_short_d16_hi v7, v3, s[66:67] offset:768
    s_add_u32 s22, s22, 1
    s_waitcnt vmcnt(0)
    v_or_b32 v132, v132, v4
    v_or_b32 v133, v133, v5
    v_or_b32 v134, v134, v6
    v_or_b32 v135, v135, v7
    s_mul_i32 s24, s22, 3277
    s_lshr_b32 s24, s24, 16
    s_mul_i32 s68, s24, 20
    s_sub_u32 s68, s22, s68
    s_cmp_lt_u32 s68, 8
    s_cselect_b64 s[66:67], s[84:85], s[86:87]
    s_cselect_b32 s25, 0, 8
    s_sub_u32 s68, s68, s25
    s_and_b32 s25, s68, 1
    s_lshr_b32 s68, s68, 1
    s_lshl_b32 s68, s68, 14
    s_lshl_b32 s25, s25, 12
    s_add_u32 s68, s68, s25
    s_lshl_b32 s24, s24, 5
    s_add_u32 s68, s68, s24
    v_lshrrev_b32 v2, 4, v176
    v_lshlrev_b32 v2, 10, v2
    v_and_b32 v3, 15, v176
    v_lshl_add_u32 v2, v3, 1, v2
    v_add_u32 v2, s68, v2
    v_add_u32 v3, 8192, v2
    v_mov_b32 v4, 0
    v_mov_b32 v5, 0
    v_mov_b32 v6, 0
    v_mov_b32 v7, 0
    global_load_ushort v152, v2, s[66:67] offset:0
    global_load_short_d16_hi v4, v3, s[66:67] offset:0
    global_load_ushort v153, v2, s[66:67] offset:256
    global_load_short_d16_hi v5, v3, s[66:67] offset:256
    global_load_ushort v154, v2, s[66:67] offset:512
    global_load_short_d16_hi v6, v3, s[66:67] offset:512
    global_load_ushort v155, v2, s[66:67] offset:768
    global_load_short_d16_hi v7, v3, s[66:67] offset:768
    s_add_u32 s22, s22, 1
    s_waitcnt vmcnt(0)
    v_or_b32 v152, v152, v4
    v_or_b32 v153, v153, v5
    v_or_b32 v154, v154, v6
    v_or_b32 v155, v155, v7
    s_mul_i32 s24, s22, 3277
    s_lshr_b32 s24, s24, 16
    s_mul_i32 s68, s24, 20
    s_sub_u32 s68, s22, s68
    s_cmp_lt_u32 s68, 8
    s_cselect_b64 s[66:67], s[84:85], s[86:87]
    s_cselect_b32 s25, 0, 8
    s_sub_u32 s68, s68, s25
    s_and_b32 s25, s68, 1
    s_lshr_b32 s68, s68, 1
    s_lshl_b32 s68, s68, 14
    s_lshl_b32 s25, s25, 12
    s_add_u32 s68, s68, s25
    s_lshl_b32 s24, s24, 5
    s_add_u32 s68, s68, s24
    v_lshrrev_b32 v2, 4, v176
    v_lshlrev_b32 v2, 10, v2
    v_and_b32 v3, 15, v176
    v_lshl_add_u32 v2, v3, 1, v2
    v_add_u32 v2, s68, v2
    v_add_u32 v3, 8192, v2
    v_mov_b32 v4, 0
    v_mov_b32 v5, 0
    v_mov_b32 v6, 0
    v_mov_b32 v7, 0
    global_load_ushort v156, v2, s[66:67] offset:0
    global_load_short_d16_hi v4, v3, s[66:67] offset:0
    global_load_ushort v157, v2, s[66:67] offset:256
    global_load_short_d16_hi v5, v3, s[66:67] offset:256
    global_load_ushort v158, v2, s[66:67] offset:512
    global_load_short_d16_hi v6, v3, s[66:67] offset:512
    global_load_ushort v159, v2, s[66:67] offset:768
    global_load_short_d16_hi v7, v3, s[66:67] offset:768
    s_add_u32 s22, s22, 1
    s_waitcnt vmcnt(0)
    v_or_b32 v156, v156, v4
    v_or_b32 v157, v157, v5
    v_or_b32 v158, v158, v6
    v_or_b32 v159, v159, v7
    s_mul_i32 s24, s22, 3277
    s_lshr_b32 s24, s24, 16
    s_mul_i32 s68, s24, 20
    s_sub_u32 s68, s22, s68
    s_cmp_lt_u32 s68, 8
    s_cselect_b64 s[66:67], s[84:85], s[86:87]
    s_cselect_b32 s25, 0, 8
    s_sub_u32 s68, s68, s25
    s_and_b32 s25, s68, 1
    s_lshr_b32 s68, s68, 1
    s_lshl_b32 s68, s68, 14
    s_lshl_b32 s25, s25, 12
    s_add_u32 s68, s68, s25
    s_lshl_b32 s24, s24, 5
    s_add_u32 s68, s68, s24
    v_lshrrev_b32 v2, 4, v176
    v_lshlrev_b32 v2, 10, v2
    v_and_b32 v3, 15, v176
    v_lshl_add_u32 v2, v3, 1, v2
    v_add_u32 v2, s68, v2
    v_add_u32 v3, 8192, v2
    v_mov_b32 v4, 0
    v_mov_b32 v5, 0
    v_mov_b32 v6, 0
    v_mov_b32 v7, 0
    global_load_ushort v136, v2, s[66:67] offset:0
    global_load_short_d16_hi v4, v3, s[66:67] offset:0
    global_load_ushort v137, v2, s[66:67] offset:256
    global_load_short_d16_hi v5, v3, s[66:67] offset:256
    global_load_ushort v138, v2, s[66:67] offset:512
    global_load_short_d16_hi v6, v3, s[66:67] offset:512
    global_load_ushort v139, v2, s[66:67] offset:768
    global_load_short_d16_hi v7, v3, s[66:67] offset:768
    s_add_u32 s22, s22, 1
    s_waitcnt vmcnt(0)
    v_or_b32 v136, v136, v4
    v_or_b32 v137, v137, v5
    v_or_b32 v138, v138, v6
    v_or_b32 v139, v139, v7
    s_mul_i32 s24, s22, 3277
    s_lshr_b32 s24, s24, 16
    s_mul_i32 s68, s24, 20
    s_sub_u32 s68, s22, s68
    s_cmp_lt_u32 s68, 8
    s_cselect_b64 s[66:67], s[84:85], s[86:87]
    s_cselect_b32 s25, 0, 8
    s_sub_u32 s68, s68, s25
    s_and_b32 s25, s68, 1
    s_lshr_b32 s68, s68, 1
    s_lshl_b32 s68, s68, 14
    s_lshl_b32 s25, s25, 12
    s_add_u32 s68, s68, s25
    s_lshl_b32 s24, s24, 5
    s_add_u32 s68, s68, s24
    v_lshrrev_b32 v2, 4, v176
    v_lshlrev_b32 v2, 10, v2
    v_and_b32 v3, 15, v176
    v_lshl_add_u32 v2, v3, 1, v2
    v_add_u32 v2, s68, v2
    v_add_u32 v3, 8192, v2
    v_mov_b32 v4, 0
    v_mov_b32 v5, 0
    v_mov_b32 v6, 0
    v_mov_b32 v7, 0
    global_load_ushort v140, v2, s[66:67] offset:0
    global_load_short_d16_hi v4, v3, s[66:67] offset:0
    global_load_ushort v141, v2, s[66:67] offset:256
    global_load_short_d16_hi v5, v3, s[66:67] offset:256
    global_load_ushort v142, v2, s[66:67] offset:512
    global_load_short_d16_hi v6, v3, s[66:67] offset:512
    global_load_ushort v143, v2, s[66:67] offset:768
    global_load_short_d16_hi v7, v3, s[66:67] offset:768
    s_add_u32 s22, s22, 1
    s_waitcnt vmcnt(0)
    v_or_b32 v140, v140, v4
    v_or_b32 v141, v141, v5
    v_or_b32 v142, v142, v6
    v_or_b32 v143, v143, v7
    s_mul_i32 s24, s22, 3277
    s_lshr_b32 s24, s24, 16
    s_mul_i32 s68, s24, 20
    s_sub_u32 s68, s22, s68
    s_cmp_lt_u32 s68, 8
    s_cselect_b64 s[66:67], s[84:85], s[86:87]
    s_cselect_b32 s25, 0, 8
    s_sub_u32 s68, s68, s25
    s_and_b32 s25, s68, 1
    s_lshr_b32 s68, s68, 1
    s_lshl_b32 s68, s68, 14
    s_lshl_b32 s25, s25, 12
    s_add_u32 s68, s68, s25
    s_lshl_b32 s24, s24, 5
    s_add_u32 s68, s68, s24
    v_lshrrev_b32 v2, 4, v176
    v_lshlrev_b32 v2, 10, v2
    v_and_b32 v3, 15, v176
    v_lshl_add_u32 v2, v3, 1, v2
    v_add_u32 v2, s68, v2
    v_add_u32 v3, 8192, v2
    v_mov_b32 v4, 0
    v_mov_b32 v5, 0
    v_mov_b32 v6, 0
    v_mov_b32 v7, 0
    global_load_ushort v168, v2, s[66:67] offset:0
    global_load_short_d16_hi v4, v3, s[66:67] offset:0
    global_load_ushort v169, v2, s[66:67] offset:256
    global_load_short_d16_hi v5, v3, s[66:67] offset:256
    global_load_ushort v170, v2, s[66:67] offset:512
    global_load_short_d16_hi v6, v3, s[66:67] offset:512
    global_load_ushort v171, v2, s[66:67] offset:768
    global_load_short_d16_hi v7, v3, s[66:67] offset:768
    s_add_u32 s22, s22, 1
    s_waitcnt vmcnt(0)
    v_or_b32 v168, v168, v4
    v_or_b32 v169, v169, v5
    v_or_b32 v170, v170, v6
    v_or_b32 v171, v171, v7
    s_mul_i32 s24, s22, 3277
    s_lshr_b32 s24, s24, 16
    s_mul_i32 s68, s24, 20
    s_sub_u32 s68, s22, s68
    s_cmp_lt_u32 s68, 8
    s_cselect_b64 s[66:67], s[84:85], s[86:87]
    s_cselect_b32 s25, 0, 8
    s_sub_u32 s68, s68, s25
    s_and_b32 s25, s68, 1
    s_lshr_b32 s68, s68, 1
    s_lshl_b32 s68, s68, 14
    s_lshl_b32 s25, s25, 12
    s_add_u32 s68, s68, s25
    s_lshl_b32 s24, s24, 5
    s_add_u32 s68, s68, s24
    v_lshrrev_b32 v2, 4, v176
    v_lshlrev_b32 v2, 10, v2
    v_and_b32 v3, 15, v176
    v_lshl_add_u32 v2, v3, 1, v2
    v_add_u32 v2, s68, v2
    v_add_u32 v3, 8192, v2
    v_mov_b32 v4, 0
    v_mov_b32 v5, 0
    v_mov_b32 v6, 0
    v_mov_b32 v7, 0
    global_load_ushort v172, v2, s[66:67] offset:0
    global_load_short_d16_hi v4, v3, s[66:67] offset:0
    global_load_ushort v173, v2, s[66:67] offset:256
    global_load_short_d16_hi v5, v3, s[66:67] offset:256
    global_load_ushort v174, v2, s[66:67] offset:512
    global_load_short_d16_hi v6, v3, s[66:67] offset:512
    global_load_ushort v175, v2, s[66:67] offset:768
    global_load_short_d16_hi v7, v3, s[66:67] offset:768
    s_add_u32 s22, s22, 1
    s_waitcnt vmcnt(0)
    v_or_b32 v172, v172, v4
    v_or_b32 v173, v173, v5
    v_or_b32 v174, v174, v6
    v_or_b32 v175, v175, v7
    s_mul_i32 s24, s22, 3277
    s_lshr_b32 s24, s24, 16
    s_mul_i32 s68, s24, 20
    s_sub_u32 s68, s22, s68
    s_cmp_lt_u32 s68, 8
    s_cselect_b64 s[66:67], s[84:85], s[86:87]
    s_cselect_b32 s25, 0, 8
    s_sub_u32 s68, s68, s25
    s_and_b32 s25, s68, 1
    s_lshr_b32 s68, s68, 1
    s_lshl_b32 s68, s68, 14
    s_lshl_b32 s25, s25, 12
    s_add_u32 s68, s68, s25
    s_lshl_b32 s24, s24, 5
    s_add_u32 s68, s68, s24
    v_lshrrev_b32 v2, 4, v176
    v_lshlrev_b32 v2, 10, v2
    v_and_b32 v3, 15, v176
    v_lshl_add_u32 v2, v3, 1, v2
    v_add_u32 v2, s68, v2
    v_add_u32 v3, 8192, v2
    v_mov_b32 v4, 0
    v_mov_b32 v5, 0
    v_mov_b32 v6, 0
    v_mov_b32 v7, 0
    global_load_ushort v112, v2, s[66:67] offset:0
    global_load_short_d16_hi v4, v3, s[66:67] offset:0
    global_load_ushort v113, v2, s[66:67] offset:256
    global_load_short_d16_hi v5, v3, s[66:67] offset:256
    global_load_ushort v114, v2, s[66:67] offset:512
    global_load_short_d16_hi v6, v3, s[66:67] offset:512
    global_load_ushort v115, v2, s[66:67] offset:768
    global_load_short_d16_hi v7, v3, s[66:67] offset:768
    s_add_u32 s22, s22, 1
    s_waitcnt vmcnt(0)
    v_or_b32 v112, v112, v4
    v_or_b32 v113, v113, v5
    v_or_b32 v114, v114, v6
    v_or_b32 v115, v115, v7
    s_mul_i32 s24, s22, 3277
    s_lshr_b32 s24, s24, 16
    s_mul_i32 s68, s24, 20
    s_sub_u32 s68, s22, s68
    s_cmp_lt_u32 s68, 8
    s_cselect_b64 s[66:67], s[84:85], s[86:87]
    s_cselect_b32 s25, 0, 8
    s_sub_u32 s68, s68, s25
    s_and_b32 s25, s68, 1
    s_lshr_b32 s68, s68, 1
    s_lshl_b32 s68, s68, 14
    s_lshl_b32 s25, s25, 12
    s_add_u32 s68, s68, s25
    s_lshl_b32 s24, s24, 5
    s_add_u32 s68, s68, s24
    v_lshrrev_b32 v2, 4, v176
    v_lshlrev_b32 v2, 10, v2
    v_and_b32 v3, 15, v176
    v_lshl_add_u32 v2, v3, 1, v2
    v_add_u32 v2, s68, v2
    v_add_u32 v3, 8192, v2
    v_mov_b32 v4, 0
    v_mov_b32 v5, 0
    v_mov_b32 v6, 0
    v_mov_b32 v7, 0
    global_load_ushort v116, v2, s[66:67] offset:0
    global_load_short_d16_hi v4, v3, s[66:67] offset:0
    global_load_ushort v117, v2, s[66:67] offset:256
    global_load_short_d16_hi v5, v3, s[66:67] offset:256
    global_load_ushort v118, v2, s[66:67] offset:512
    global_load_short_d16_hi v6, v3, s[66:67] offset:512
    global_load_ushort v119, v2, s[66:67] offset:768
    global_load_short_d16_hi v7, v3, s[66:67] offset:768
    s_add_u32 s22, s22, 1
    s_waitcnt vmcnt(0)
    v_or_b32 v116, v116, v4
    v_or_b32 v117, v117, v5
    v_or_b32 v118, v118, v6
    v_or_b32 v119, v119, v7
    s_load_dwordx2 s[72:73], s[0:1], 72
    v_lshlrev_b32 v248, 2, v176
    v_lshlrev_b32 v246, 4, v176
    s_mov_b32 s52, 163072
    v_bfe_u32 v177, v248, 2, 4
    v_bfe_u32 v179, v248, 2, 3
    v_lshl_add_u32 v180, v177, 3, s52
    v_lshl_add_u32 v190, v177, 4, s52
    v_lshl_add_u32 v181, v179, 3, s52
    ds_read2_b64 v[182:185], v180 offset0:32 offset1:48
    ds_read_b32 v191, v190
    ds_read_b64 v[186:187], v181 offset:512
    v_lshrrev_b32 v178, 6, v248
    s_add_u32 s22, s20, 0
    s_lshl_b32 s22, s22, 21
    s_add_u32 s23, s20, 8
    s_lshl_b32 s23, s23, 21
    s_add_u32 s24, s20, 16
    s_lshl_b32 s24, s24, 21
    s_add_u32 s25, s20, 24
    s_lshl_b32 s25, s25, 21
    s_add_u32 s26, s20, 32
    s_lshl_b32 s26, s26, 21
    s_mov_b32 s53, 0
    s_mov_b32 s50, 0
    s_waitcnt lgkmcnt(0)
    s_branch GEMM
.section .rodata,"a"
.p2align 6
.amdhsa_kernel standalone__tensor_product_equiv_equiformer__graph_kernel
  .amdhsa_next_free_vgpr 256
  .amdhsa_next_free_sgpr 90
  .amdhsa_accum_offset 256
  .amdhsa_group_segment_fixed_size 0
  .amdhsa_kernarg_size 96
  .amdhsa_user_sgpr_count 2
  .amdhsa_user_sgpr_kernarg_segment_ptr 1
  .amdhsa_system_sgpr_workgroup_id_x 1
.end_amdhsa_kernel
```

```asm
; @launch grid=(250,1,1) block=(512,1,1) lds=163840
.amdgcn_target "amdgcn-amd-amdhsa--gfx950"
.text
.globl standalone__tensor_product_equiv_equiformer__graph_kernel
.p2align 8
.type standalone__tensor_product_equiv_equiformer__graph_kernel,@function
standalone__tensor_product_equiv_equiformer__graph_kernel:
    s_cmp_ge_u32 s2, 250
    s_cbranch_scc1 K2_end
    s_load_dwordx16 s[72:87], s[0:1], 0
    s_load_dwordx2 s[70:71], s[0:1], 88
    v_lshrrev_b32 v2, 6, v0
    v_and_b32 v1, 63, v0
    v_readfirstlane_b32 s20, v2
    s_getpc_b64 s[66:67]
    v_lshlrev_b32 v95, 7, v1
    s_cmp_eq_u32 s20, 6
    s_cbranch_scc0 F_nopf0
    global_load_dword v95, v95, s[66:67]
F_nopf0:
    s_mul_i32 s66, s2, 5120
    s_mul_i32 s67, s2, 7680
    v_lshl_add_u32 v3, v0, 4, s66
    v_mul_u32_u24 v4, 24, v0
    v_add_u32 v4, s67, v4
    v_lshlrev_b32 v5, 2, v0
    v_mov_b32 v89, 0
    v_add_u32 v6, 98304, v5
    ds_write_b32 v6, v89
    s_cmp_ge_u32 s20, 5
    s_waitcnt lgkmcnt(0)
    s_cbranch_scc1 F_noload
    global_load_dwordx4 v[8:11], v3, s[80:81] nt
    global_load_dwordx4 v[12:15], v3, s[78:79] nt
    global_load_dwordx4 v[16:19], v4, s[74:75] nt
    global_load_dwordx2 v[20:21], v4, s[74:75] offset:16 nt
F_noload:
    s_load_dword s88, s[70:71], 0
    s_barrier
    v_lshlrev_b32 v248, 2, v1
    v_add_u32 v88, 162816, v248
    ds_write_b32 v88, v89
    ds_write_b32 v88, v89 offset:256
    v_lshlrev_b32 v86, 4, v1
    s_lshl_b32 s21, s20, 13
    v_lshrrev_b32 v6, 5, v1
    v_mul_u32_u24 v6, 5120, v6
    v_and_b32 v7, 31, v1
    v_lshl_add_u32 v6, v7, 1, v6
    s_lshr_b32 s66, s20, 2
    s_lshl_b32 s66, s66, 7
    s_and_b32 s67, s20, 3
    s_mul_i32 s67, s67, 5
    s_add_u32 s68, s67, 0
    s_lshr_b32 s24, s68, 2
    s_lshl_b32 s24, s24, 8
    s_bfe_u32 s69, s68, 0x10001
    s_lshl_b32 s69, s69, 6
    s_add_u32 s24, s24, s69
    s_and_b32 s69, s68, 1
    s_mul_i32 s69, s69, 10240
    s_add_u32 s24, s24, s69
    s_add_u32 s24, s24, s66
    s_add_u32 s68, s67, 1
    s_lshr_b32 s25, s68, 2
    s_lshl_b32 s25, s25, 8
    s_bfe_u32 s69, s68, 0x10001
    s_lshl_b32 s69, s69, 6
    s_add_u32 s25, s25, s69
    s_and_b32 s69, s68, 1
    s_mul_i32 s69, s69, 10240
    s_add_u32 s25, s25, s69
    s_add_u32 s25, s25, s66
    s_add_u32 s68, s67, 2
    s_lshr_b32 s26, s68, 2
    s_lshl_b32 s26, s26, 8
    s_bfe_u32 s69, s68, 0x10001
    s_lshl_b32 s69, s69, 6
    s_add_u32 s26, s26, s69
    s_and_b32 s69, s68, 1
    s_mul_i32 s69, s69, 10240
    s_add_u32 s26, s26, s69
    s_add_u32 s26, s26, s66
    s_add_u32 s68, s67, 3
    s_lshr_b32 s27, s68, 2
    s_lshl_b32 s27, s27, 8
    s_bfe_u32 s69, s68, 0x10001
    s_lshl_b32 s69, s69, 6
    s_add_u32 s27, s27, s69
    s_and_b32 s69, s68, 1
    s_mul_i32 s69, s69, 10240
    s_add_u32 s27, s27, s69
    s_add_u32 s27, s27, s66
    s_add_u32 s68, s67, 4
    s_lshr_b32 s28, s68, 2
    s_lshl_b32 s28, s28, 8
    s_bfe_u32 s69, s68, 0x10001
    s_lshl_b32 s69, s69, 6
    s_add_u32 s28, s28, s69
    s_and_b32 s69, s68, 1
    s_mul_i32 s69, s69, 10240
    s_add_u32 s28, s28, s69
    s_add_u32 s28, s28, s66
    v_mov_b32 v96, 0
    v_mov_b32 v97, 0
    v_mov_b32 v98, 0
    v_mov_b32 v99, 0
    v_mov_b32 v100, 0
    v_mov_b32 v101, 0
    v_mov_b32 v102, 0
    v_mov_b32 v103, 0
    v_mov_b32 v104, 0
    v_mov_b32 v105, 0
    v_mov_b32 v106, 0
    v_mov_b32 v107, 0
    v_mov_b32 v108, 0
    v_mov_b32 v109, 0
    v_mov_b32 v110, 0
    v_mov_b32 v111, 0
    v_mov_b32 v112, 0
    v_mov_b32 v113, 0
    v_mov_b32 v114, 0
    v_mov_b32 v115, 0
    v_mov_b32 v180, 0
    v_mov_b32 v181, 0
    v_mov_b32 v182, 0
    v_mov_b32 v183, 0
    s_mov_b32 s16, s70
    s_and_b32 s17, s71, 0xffff
    s_mov_b32 s18, 24165888
    s_mov_b32 s19, 0x20000
    v_lshrrev_b32 v2, 3, v1
    v_lshl_add_u32 v2, s20, 5, v2
    v_and_b32 v91, 7, v1
    v_mul_u32_u24 v94, 384, v2
    v_lshl_add_u32 v94, v91, 4, v94
    v_lshlrev_b32 v93, 2, v2
    v_add_u32 v93, 98304, v93
    v_mul_u32_u24 v92, 32000, v2
    v_lshl_add_u32 v92, v91, 4, v92
    v_mul_u32_u24 v90, 40960, v2
    s_mov_b32 s32, s82
    s_and_b32 s33, s83, 0xffff
    s_mov_b32 s34, 20480
    s_mov_b32 s35, 0x20000
    s_cmp_ge_u32 s20, 5
    s_cbranch_scc1 F_helper
    s_mov_b32 s22, 52429
    s_mov_b32 s23, 0x05040100
    s_mov_b32 s66, 98304
    s_movk_i32 s67, -40
    v_mov_b32 v7, 1
    v_add_u32 v31, 1, v5
    v_add_u32 v32, 2, v5
    v_add_u32 v33, 3, v5
    s_waitcnt vmcnt(3)
    v_mul_u32_u24 v22, s22, v8
    v_mul_u32_u24 v23, s22, v9
    v_mul_u32_u24 v24, s22, v10
    v_mul_u32_u24 v25, s22, v11
    v_lshrrev_b32 v22, 21, v22
    v_lshrrev_b32 v23, 21, v23
    v_lshrrev_b32 v24, 21, v24
    v_lshrrev_b32 v25, 21, v25
    v_lshl_add_u32 v34, v22, 2, s66
    ds_add_rtn_u32 v26, v34, v7
    v_lshl_add_u32 v35, v23, 2, s66
    ds_add_rtn_u32 v27, v35, v7
    v_lshl_add_u32 v36, v24, 2, s66
    ds_add_rtn_u32 v28, v36, v7
    v_lshl_add_u32 v37, v25, 2, s66
    ds_add_rtn_u32 v29, v37, v7
    buffer_load_short_d16_hi v96, v6, s[32:35], s24 offen offset:0
    buffer_load_short_d16_hi v97, v6, s[32:35], s24 offen offset:1280
    buffer_load_short_d16_hi v98, v6, s[32:35], s24 offen offset:2560
    buffer_load_short_d16_hi v99, v6, s[32:35], s24 offen offset:3840
    buffer_load_short_d16_hi v100, v6, s[32:35], s25 offen offset:0
    buffer_load_short_d16_hi v101, v6, s[32:35], s25 offen offset:1280
    buffer_load_short_d16_hi v102, v6, s[32:35], s25 offen offset:2560
    buffer_load_short_d16_hi v103, v6, s[32:35], s25 offen offset:3840
    buffer_load_short_d16_hi v104, v6, s[32:35], s26 offen offset:0
    buffer_load_short_d16_hi v105, v6, s[32:35], s26 offen offset:1280
    buffer_load_short_d16_hi v106, v6, s[32:35], s26 offen offset:2560
    buffer_load_short_d16_hi v107, v6, s[32:35], s26 offen offset:3840
    buffer_load_short_d16_hi v108, v6, s[32:35], s27 offen offset:0
    buffer_load_short_d16_hi v109, v6, s[32:35], s27 offen offset:1280
    buffer_load_short_d16_hi v110, v6, s[32:35], s27 offen offset:2560
    buffer_load_short_d16_hi v111, v6, s[32:35], s27 offen offset:3840
    buffer_load_short_d16_hi v112, v6, s[32:35], s28 offen offset:0
    buffer_load_short_d16_hi v113, v6, s[32:35], s28 offen offset:1280
    buffer_load_short_d16_hi v114, v6, s[32:35], s28 offen offset:2560
    buffer_load_short_d16_hi v115, v6, s[32:35], s28 offen offset:3840
    v_mad_i32_i24 v2, v22, s67, v8
    v_mul_u32_u24 v22, 384, v22
    v_lshl_or_b32 v42, v2, 11, v5
    v_mad_i32_i24 v2, v23, s67, v9
    v_mul_u32_u24 v23, 384, v23
    v_lshl_or_b32 v46, v2, 11, v31
    v_mad_i32_i24 v2, v24, s67, v10
    v_mul_u32_u24 v24, 384, v24
    v_lshl_or_b32 v50, v2, 11, v32
    v_mad_i32_i24 v2, v25, s67, v11
    v_mul_u32_u24 v25, 384, v25
    v_lshl_or_b32 v54, v2, 11, v33
    s_waitcnt vmcnt(20)
    v_mov_b32 v40, v16
    v_perm_b32 v41, v12, v17, s23
    v_alignbit_b32 v44, v18, v17, 16
    v_alignbit_b32 v45, v13, v18, 16
    v_mov_b32 v48, v19
    v_perm_b32 v49, v14, v20, s23
    v_alignbit_b32 v52, v21, v20, 16
    v_alignbit_b32 v53, v15, v21, 16
    v_xor_b32 v41, 0x8000, v41
    v_xor_b32 v45, 0x8000, v45
    v_xor_b32 v49, 0x8000, v49
    v_xor_b32 v53, 0x8000, v53
    s_waitcnt lgkmcnt(0)
    v_min_u32 v26, 23, v26
    v_lshl_add_u32 v34, v26, 4, v22
    ds_write_b128 v34, v[40:43]
    v_min_u32 v27, 23, v27
    v_lshl_add_u32 v35, v27, 4, v23
    ds_write_b128 v35, v[44:47]
    v_min_u32 v28, 23, v28
    v_lshl_add_u32 v36, v28, 4, v24
    ds_write_b128 v36, v[48:51]
    v_min_u32 v29, 23, v29
    v_lshl_add_u32 v37, v29, 4, v25
    ds_write_b128 v37, v[52:55]
    s_branch F_staged
F_helper:
    buffer_load_short_d16_hi v96, v6, s[32:35], s24 offen offset:0
    buffer_load_short_d16_hi v97, v6, s[32:35], s24 offen offset:1280
    buffer_load_short_d16_hi v98, v6, s[32:35], s24 offen offset:2560
    buffer_load_short_d16_hi v99, v6, s[32:35], s24 offen offset:3840
    buffer_load_short_d16_hi v100, v6, s[32:35], s25 offen offset:0
    buffer_load_short_d16_hi v101, v6, s[32:35], s25 offen offset:1280
    buffer_load_short_d16_hi v102, v6, s[32:35], s25 offen offset:2560
    buffer_load_short_d16_hi v103, v6, s[32:35], s25 offen offset:3840
    buffer_load_short_d16_hi v104, v6, s[32:35], s26 offen offset:0
    buffer_load_short_d16_hi v105, v6, s[32:35], s26 offen offset:1280
    buffer_load_short_d16_hi v106, v6, s[32:35], s26 offen offset:2560
    buffer_load_short_d16_hi v107, v6, s[32:35], s26 offen offset:3840
    buffer_load_short_d16_hi v108, v6, s[32:35], s27 offen offset:0
    buffer_load_short_d16_hi v109, v6, s[32:35], s27 offen offset:1280
    buffer_load_short_d16_hi v110, v6, s[32:35], s27 offen offset:2560
    buffer_load_short_d16_hi v111, v6, s[32:35], s27 offen offset:3840
    buffer_load_short_d16_hi v112, v6, s[32:35], s28 offen offset:0
    buffer_load_short_d16_hi v113, v6, s[32:35], s28 offen offset:1280
    buffer_load_short_d16_hi v114, v6, s[32:35], s28 offen offset:2560
    buffer_load_short_d16_hi v115, v6, s[32:35], s28 offen offset:3840
    s_cmp_eq_u32 s20, 6
    s_cbranch_scc0 F_nopf
    s_getpc_b64 s[66:67]
F_pc:
    s_lshr_b32 s68, s2, 3
    s_mul_i32 s68, s68, ((K2_last-F_pc)/128/31+1)*128
    v_lshl_add_u32 v2, v1, 7, s68
    v_min_u32 v2, K2_last-F_pc-4, v2
    v_cmp_gt_u32 vcc, (K2_last-F_pc)/128/31+1, v1
    s_mov_b64 exec, vcc
    global_load_dword v95, v2, s[66:67]
    s_mov_b64 exec, -1
F_nopf:
    s_cmp_eq_u32 s20, 7
    s_cbranch_scc0 F_staged
    s_cmp_lt_u32 s2, 160
    s_cbranch_scc0 F_staged
    s_mul_i32 s22, s2, 3277
    s_lshr_b32 s22, s22, 16
    s_mul_i32 s68, s22, 20
    s_sub_u32 s68, s2, s68
    s_cmp_lt_u32 s68, 8
    s_cselect_b64 s[66:67], s[84:85], s[86:87]
    s_cselect_b32 s23, 0, 8
    s_sub_u32 s68, s68, s23
    s_and_b32 s23, s68, 1
    s_lshr_b32 s68, s68, 1
    s_lshl_b32 s68, s68, 14
    s_lshl_b32 s23, s23, 12
    s_add_u32 s68, s68, s23
    s_lshl_b32 s22, s22, 5
    s_add_u32 s68, s68, s22
    v_lshrrev_b32 v2, 4, v1
    v_lshlrev_b32 v2, 10, v2
    v_and_b32 v3, 15, v1
    v_lshl_add_u32 v2, v3, 1, v2
    v_add_u32 v2, s68, v2
    v_add_u32 v3, 8192, v2
    global_load_ushort v176, v2, s[66:67] offset:0
    global_load_short_d16_hi v180, v3, s[66:67] offset:0
    global_load_ushort v177, v2, s[66:67] offset:256
    global_load_short_d16_hi v181, v3, s[66:67] offset:256
    global_load_ushort v178, v2, s[66:67] offset:512
    global_load_short_d16_hi v182, v3, s[66:67] offset:512
    global_load_ushort v179, v2, s[66:67] offset:768
    global_load_short_d16_hi v183, v3, s[66:67] offset:768
F_staged:
    s_lshl_b32 s66, s2, 7
    s_add_u32 s66, s66, 164864
    s_cmp_eq_u32 s20, 7
    s_cselect_b32 s22, 0xffff, -1
    s_cselect_b32 s23, 0, -1
    s_waitcnt lgkmcnt(0)
    s_add_u32 s88, s88, 1
    s_barrier
    ds_read_b32 v40, v93 offset:0
    ds_read_b128 v[8:11], v94 offset:0
    ds_read_b32 v14, v94 offset:136
    ds_read_b32 v41, v93 offset:32
    ds_read_b128 v[16:19], v94 offset:3072
    ds_read_b32 v22, v94 offset:3208
    ds_read_b32 v42, v93 offset:64
    ds_read_b128 v[24:27], v94 offset:6144
    ds_read_b32 v30, v94 offset:6280
    ds_read_b32 v43, v93 offset:96
    ds_read_b128 v[32:35], v94 offset:9216
    ds_read_b32 v38, v94 offset:9352
    s_add_u32 s28, s66, 0
    s_add_u32 s29, s66, 256000
    s_add_u32 s30, s66, 512000
    s_add_u32 s31, s66, 768000
    s_waitcnt lgkmcnt(9)
    v_min_u32 v5, 31, v40
    v_bfe_u32 v6, v14, 11, 6
    v_and_b32 v10, 0x1ffff, v10
    v_lshl_or_b32 v6, v5, 6, v6
    v_mov_b32 v11, s88
    v_lshl_or_b32 v10, v6, 17, v10
    buffer_store_dwordx4 v[8:11], v92, s[16:19], s28 offen sc1
    s_waitcnt lgkmcnt(6)
    v_min_u32 v5, 31, v41
    v_bfe_u32 v6, v22, 11, 6
    v_and_b32 v18, 0x1ffff, v18
    v_lshl_or_b32 v6, v5, 6, v6
    v_mov_b32 v19, s88
    v_lshl_or_b32 v18, v6, 17, v18
    buffer_store_dwordx4 v[16:19], v92, s[16:19], s29 offen sc1
    s_waitcnt lgkmcnt(3)
    v_min_u32 v5, 31, v42
    v_bfe_u32 v6, v30, 11, 6
    v_and_b32 v26, 0x1ffff, v26
    v_lshl_or_b32 v6, v5, 6, v6
    v_mov_b32 v27, s88
    v_lshl_or_b32 v26, v6, 17, v26
    buffer_store_dwordx4 v[24:27], v92, s[16:19], s30 offen sc1
    s_waitcnt lgkmcnt(0)
    v_min_u32 v5, 31, v43
    v_bfe_u32 v6, v38, 11, 6
    v_and_b32 v34, 0x1ffff, v34
    v_lshl_or_b32 v6, v5, 6, v6
    v_mov_b32 v35, s88
    v_lshl_or_b32 v34, v6, 17, v34
    s_mov_b64 exec, s[22:23]
    buffer_store_dwordx4 v[32:35], v92, s[16:19], s31 offen sc1
    s_mov_b64 exec, -1
    ds_read_b128 v[12:15], v94 offset:128
    ds_read_b128 v[20:23], v94 offset:3200
    ds_read_b128 v[28:31], v94 offset:6272
    ds_read_b128 v[36:39], v94 offset:9344
    s_waitcnt vmcnt(4)
F_now:
    v_cmp_lt_u32 vcc, 8, v40
    s_add_u32 s67, s28, 8000000
    s_waitcnt lgkmcnt(3)
    v_mov_b32 v15, s88
    s_mov_b64 exec, vcc
    s_cbranch_execz F_w0
    buffer_store_dwordx4 v[12:15], v92, s[16:19], s67 offen sc1
    v_cmp_lt_u32 vcc, 16, v40
    s_add_u32 s67, s67, 8000000
    s_mov_b64 exec, vcc
    s_cbranch_execz F_w0
    ds_read_b128 v[44:47], v94 offset:256
    s_waitcnt lgkmcnt(0)
    v_mov_b32 v47, s88
    buffer_store_dwordx4 v[44:47], v92, s[16:19], s67 offen sc1
    s_nop 1
F_w0:
    s_mov_b64 exec, -1
    v_cmp_lt_u32 vcc, 8, v41
    s_add_u32 s67, s29, 8000000
    s_waitcnt lgkmcnt(2)
    v_mov_b32 v23, s88
    s_mov_b64 exec, vcc
    s_cbranch_execz F_w1
    buffer_store_dwordx4 v[20:23], v92, s[16:19], s67 offen sc1
    v_cmp_lt_u32 vcc, 16, v41
    s_add_u32 s67, s67, 8000000
    s_mov_b64 exec, vcc
    s_cbranch_execz F_w1
    ds_read_b128 v[44:47], v94 offset:3328
    s_waitcnt lgkmcnt(0)
    v_mov_b32 v47, s88
    buffer_store_dwordx4 v[44:47], v92, s[16:19], s67 offen sc1
    s_nop 1
F_w1:
    s_mov_b64 exec, -1
    v_cmp_lt_u32 vcc, 8, v42
    s_add_u32 s67, s30, 8000000
    s_waitcnt lgkmcnt(1)
    v_mov_b32 v31, s88
    s_mov_b64 exec, vcc
    s_cbranch_execz F_w2
    buffer_store_dwordx4 v[28:31], v92, s[16:19], s67 offen sc1
    v_cmp_lt_u32 vcc, 16, v42
    s_add_u32 s67, s67, 8000000
    s_mov_b64 exec, vcc
    s_cbranch_execz F_w2
    ds_read_b128 v[44:47], v94 offset:6400
    s_waitcnt lgkmcnt(0)
    v_mov_b32 v47, s88
    buffer_store_dwordx4 v[44:47], v92, s[16:19], s67 offen sc1
    s_nop 1
F_w2:
    s_mov_b64 exec, -1
    v_cmp_lt_u32 vcc, 8, v43
    s_add_u32 s67, s31, 8000000
    s_and_b64 vcc, vcc, s[22:23]
    s_waitcnt lgkmcnt(0)
    v_mov_b32 v39, s88
    s_mov_b64 exec, vcc
    s_cbranch_execz F_w3
    buffer_store_dwordx4 v[36:39], v92, s[16:19], s67 offen sc1
    v_cmp_lt_u32 vcc, 16, v43
    s_add_u32 s67, s67, 8000000
    s_mov_b64 exec, vcc
    s_cbranch_execz F_w3
    ds_read_b128 v[44:47], v94 offset:9472
    s_waitcnt lgkmcnt(0)
    v_mov_b32 v47, s88
    buffer_store_dwordx4 v[44:47], v92, s[16:19], s67 offen sc1
    s_nop 1
F_w3:
    s_mov_b64 exec, -1
    s_cmp_eq_u32 s20, 7
    s_cbranch_scc0 F_nofrag
    s_cmp_lt_u32 s2, 160
    s_cbranch_scc0 F_nofrag
    v_or_b32 v176, v176, v180
    v_or_b32 v177, v177, v181
    v_or_b32 v178, v178, v182
    v_or_b32 v179, v179, v183
    s_lshl_b32 s66, s2, 10
    s_add_u32 s66, s66, 1024
    buffer_store_dwordx4 v[176:179], v86, s[16:19], s66 offen sc1
F_nofrag:
    s_barrier
    s_mul_i32 s24, s2, 32000
    s_lshl_b32 s25, s20, 12
    s_add_u32 s24, s24, s25
    s_add_u32 s24, s24, 164864
    s_add_u32 s25, s24, 8000000
    s_add_u32 s26, s25, 8000000
    v_mov_b32 v22, 0
    v_mov_b32 v23, s88
    s_mul_i32 s68, s20, 5120
    s_cmp_ge_u32 s20, 4
    s_cselect_b32 s70, 45056, 0
    s_add_u32 s68, s68, s70
    v_add_u32 v2, s68, v86
    ds_write_b128 v2, v[96:99] offset:0
    ds_write_b128 v2, v[100:103] offset:1024
    ds_write_b128 v2, v[104:107] offset:2048
    ds_write_b128 v2, v[108:111] offset:3072
    ds_write_b128 v2, v[112:115] offset:4096
    v_mov_b32 v4, 2130738944
    v_mov_b32 v5, 2130738944
    v_mov_b32 v6, 2130738944
    v_mov_b32 v7, 2130738944
    v_lshlrev_b32 v2, 4, v0
    v_add_u32 v3, 86016, v2
    ds_write_b128 v3, v[4:7] offset:0
    ds_write_b128 v3, v[4:7] offset:8192
    ds_write_b128 v3, v[4:7] offset:16384
    ds_write_b128 v3, v[4:7] offset:24576
    ds_write_b128 v3, v[4:7] offset:32768
    ds_write_b128 v3, v[4:7] offset:40960
    ds_write_b128 v3, v[4:7] offset:49152
    ds_write_b128 v3, v[4:7] offset:57344
    v_add_u32 v3, 0x10000, v3
    ds_write_b128 v3, v[4:7] offset:0
    v_min_u32 v2, 3056, v2
    v_add_u32 v2, 159744, v2
    ds_write_b128 v2, v[4:7]
    s_sub_u32 s72, s72, 128
    s_subb_u32 s73, s73, 0
    s_mov_b32 s4, s72
    s_and_b32 s5, s73, 0xffff
    s_mov_b32 s6, 10240000
    s_mov_b32 s7, 0x20000
    s_sub_u32 s72, s72, 1024
    s_subb_u32 s73, s73, 0
    s_mov_b32 s8, s72
    s_and_b32 s9, s73, 0xffff
    s_mov_b32 s10, 10241024
    s_mov_b32 s11, 0x20000
    s_mov_b32 s12, s76
    s_and_b32 s13, s77, 0xffff
    s_mov_b32 s14, 10240000
    s_mov_b32 s15, 0x20000
    v_lshrrev_b32 v2, 5, v1
    v_bfe_u32 v3, v1, 2, 2
    v_and_b32 v4, 3, v1
    v_bfe_u32 v5, v1, 4, 1
    v_lshlrev_b32 v6, 9, v2
    v_lshl_add_u32 v6, v3, 7, v6
    v_lshl_add_u32 v6, v5, 5, v6
    v_lshl_add_u32 v6, v4, 3, v6
    v_lshrrev_b32 v7, 1, v3
    v_lshl_add_u32 v6, v7, 6, v6
    v_add_u32 v244, s21, v6
    v_xor_b32 v245, 64, v244
    v_lshlrev_b32 v6, 7, v2
    v_lshl_add_u32 v6, v7, 5, v6
    v_and_b32 v7, 1, v3
    v_xor_b32 v7, 1, v7
    v_mul_u32_u24 v7, 90112, v7
    v_add_u32 v6, v6, v7
    v_lshl_add_u32 v249, v4, 3, v6
    v_lshl_add_u32 v6, v2, 2, v4
    v_bfe_u32 v7, v1, 2, 1
    v_lshl_add_u32 v6, v7, 3, v6
    v_lshlrev_b32 v6, 3, v6
    v_bfe_u32 v7, v1, 3, 1
    v_add_u32 v5, 1, v5
    v_mul_u32_u24 v7, v7, v5
    v_lshl_add_u32 v250, v7, 1, v6
    v_and_b32 v6, 0x38, v1
    v_add_u32 v247, 6, v6
    v_lshrrev_b32 v6, 2, v1
    v_lshrrev_b32 v7, 4, v1
    v_xor_b32 v6, v6, v7
    v_and_b32 v6, 1, v6
    v_lshlrev_b32 v6, 6, v6
    v_lshl_add_u32 v246, v4, 4, v6
    v_mov_b32 v242, 1.0
    v_mov_b32 v243, 1.0
    s_mov_b32 s54, 0xffffff00
    s_mov_b32 s55, 0xffffff00
    s_mov_b32 s56, 0xffff
    s_mov_b32 s57, 0xffff
    s_mov_b32 s58, 0
    s_mov_b32 s59, 134217856
    s_mov_b32 s60, 262272
    s_mov_b32 s61, 402915456
    s_mov_b32 s62, 940179840
    s_mov_b32 s63, 403046528
    s_mov_b32 s64, 402784384
    s_mov_b32 s65, 134348928
    s_mov_b32 s38, 128
    s_mov_b32 s33, -1
    s_and_b32 s68, s20, 3
    s_lshl_b32 s68, s68, 2
    s_lshr_b32 s69, s20, 2
    s_add_u32 s68, s68, s69
    s_lshl_b32 s68, s68, 4
    s_add_u32 s68, s68, 163072
    v_mov_b32 v251, s68
    s_mov_b32 s53, 0
    s_mov_b32 s50, 0
    s_mov_b32 s51, 0
    s_mov_b32 s47, 0
    s_mov_b32 s42, 0
    s_mov_b32 s3, 0
    s_mov_b32 s89, 0
    s_mov_b32 s34, 128
    s_mov_b32 s35, 384
    s_mov_b32 s36, 640
    s_mov_b32 s37, 896
    s_waitcnt lgkmcnt(0)
    s_barrier
    buffer_load_dwordx4 v[8:11], v86, s[16:19], s24 offen offset:0 sc1
    buffer_load_dwordx4 v[12:15], v86, s[16:19], s24 offen offset:1024 sc1
    buffer_load_dwordx4 v[16:19], v86, s[16:19], s24 offen offset:2048 sc1
    s_mov_b64 exec, s[22:23]
    buffer_load_dwordx4 v[20:23], v86, s[16:19], s24 offen offset:3072 sc1
    s_mov_b64 exec, -1
    ds_read_b128 v[96:99], v86 offset:0
    ds_read_b128 v[100:103], v86 offset:1024
    ds_read_b128 v[104:107], v86 offset:2048
    ds_read_b128 v[108:111], v86 offset:3072
    ds_read_b128 v[112:115], v86 offset:4096
    ds_read_b128 v[116:119], v86 offset:5120
    ds_read_b128 v[120:123], v86 offset:6144
    ds_read_b128 v[124:127], v86 offset:7168
    ds_read_b128 v[128:131], v86 offset:8192
    ds_read_b128 v[132:135], v86 offset:9216
    ds_read_b128 v[136:139], v86 offset:10240
    ds_read_b128 v[140:143], v86 offset:11264
    ds_read_b128 v[144:147], v86 offset:12288
    ds_read_b128 v[148:151], v86 offset:13312
    ds_read_b128 v[152:155], v86 offset:14336
    ds_read_b128 v[156:159], v86 offset:15360
    ds_read_b128 v[160:163], v86 offset:16384
    ds_read_b128 v[164:167], v86 offset:17408
    ds_read_b128 v[168:171], v86 offset:18432
    ds_read_b128 v[172:175], v86 offset:19456
    s_mov_b32 s27, 32768
    s_mov_b32 s71, 162816
    v_mov_b32 v3, 1
    s_cmp_eq_u32 s20, 7
    s_cselect_b32 s52, 160, 0
    v_cmp_gt_u32 s[68:69], 40, v1
    s_mov_b64 s[28:29], 0xff
    s_lshr_b32 s66, s2, 3
    s_lshl_b32 s66, s66, 3
    s_add_u32 s66, s66, s20
    s_mul_i32 s66, s66, 40
    v_min_u32 v93, 39, v1
    v_add_u32 v93, s66, v93
    v_lshlrev_b32 v93, 10, v93
    v_mov_b32 v94, 0x7f000000
F_poll:
    s_waitcnt vmcnt(0)
F_poll1:
    v_cmp_ne_u32 s[72:73], s88, v11
    v_cmp_ne_u32 s[74:75], s88, v15
    v_cmp_ne_u32 s[76:77], s88, v19
    v_cmp_ne_u32 s[78:79], s88, v23
    s_or_b64 s[80:81], s[72:73], s[74:75]
    s_or_b64 s[82:83], s[76:77], s[78:79]
    s_or_b64 s[80:81], s[80:81], s[82:83]
    s_cbranch_scc1 F_again
F_got:
    v_bfe_u32 v2, v10, 23, 5
    v_bfe_u32 v60, v10, 11, 6
    v_cmp_gt_u32 s[80:81], v2, v91
    v_lshl_add_u32 v60, v60, 2, s71
    v_cmp_lt_u32 s[72:73], 8, v2
    v_max_u32 v89, v89, v2
    s_mov_b64 exec, s[80:81]
    ds_add_rtn_u32 v72, v60, v3
    s_mov_b64 exec, s[72:73]
    s_cbranch_execz F_h0
    buffer_load_dwordx4 v[24:27], v86, s[16:19], s25 offen offset:0 sc1
    v_sub_u32 v56, v2, v91
    v_bfe_u32 v64, v10, 17, 6
    v_cmp_lt_u32 vcc, 8, v56
    v_lshl_add_u32 v64, v64, 2, s71
    s_mov_b64 exec, vcc
    ds_add_rtn_u32 v76, v64, v3
F_h0:
    s_mov_b64 exec, -1
    v_bfe_u32 v2, v14, 23, 5
    v_bfe_u32 v61, v14, 11, 6
    v_cmp_gt_u32 s[82:83], v2, v91
    v_lshl_add_u32 v61, v61, 2, s71
    v_cmp_lt_u32 s[74:75], 8, v2
    v_max_u32 v89, v89, v2
    s_mov_b64 exec, s[82:83]
    ds_add_rtn_u32 v73, v61, v3
    s_mov_b64 exec, s[74:75]
    s_cbranch_execz F_h1
    buffer_load_dwordx4 v[28:31], v86, s[16:19], s25 offen offset:1024 sc1
    v_sub_u32 v57, v2, v91
    v_bfe_u32 v65, v14, 17, 6
    v_cmp_lt_u32 vcc, 8, v57
    v_lshl_add_u32 v65, v65, 2, s71
    s_mov_b64 exec, vcc
    ds_add_rtn_u32 v77, v65, v3
F_h1:
    s_mov_b64 exec, -1
    v_bfe_u32 v2, v18, 23, 5
    v_bfe_u32 v62, v18, 11, 6
    v_cmp_gt_u32 s[84:85], v2, v91
    v_lshl_add_u32 v62, v62, 2, s71
    v_cmp_lt_u32 s[76:77], 8, v2
    v_max_u32 v89, v89, v2
    s_mov_b64 exec, s[84:85]
    ds_add_rtn_u32 v74, v62, v3
    s_mov_b64 exec, s[76:77]
    s_cbranch_execz F_h2
    buffer_load_dwordx4 v[32:35], v86, s[16:19], s25 offen offset:2048 sc1
    v_sub_u32 v58, v2, v91
    v_bfe_u32 v66, v18, 17, 6
    v_cmp_lt_u32 vcc, 8, v58
    v_lshl_add_u32 v66, v66, 2, s71
    s_mov_b64 exec, vcc
    ds_add_rtn_u32 v78, v66, v3
F_h2:
    s_mov_b64 exec, -1
    v_bfe_u32 v2, v22, 23, 5
    v_bfe_u32 v63, v22, 11, 6
    v_cmp_gt_u32 s[86:87], v2, v91
    v_lshl_add_u32 v63, v63, 2, s71
    v_cmp_lt_u32 s[78:79], 8, v2
    v_max_u32 v89, v89, v2
    s_mov_b64 exec, s[86:87]
    ds_add_rtn_u32 v75, v63, v3
    s_mov_b64 exec, s[78:79]
    s_cbranch_execz F_h3
    buffer_load_dwordx4 v[36:39], v86, s[16:19], s25 offen offset:3072 sc1
    v_sub_u32 v59, v2, v91
    v_bfe_u32 v67, v22, 17, 6
    v_cmp_lt_u32 vcc, 8, v59
    v_lshl_add_u32 v67, v67, 2, s71
    s_mov_b64 exec, vcc
    ds_add_rtn_u32 v79, v67, v3
F_h3:
    s_mov_b64 exec, -1
    v_cmp_lt_u32 s[30:31], 16, v89
    s_mov_b32 s27, 262144
    s_cmp_lg_u64 s[30:31], 0
    s_cbranch_scc1 F_l3
F_l3r:
    v_and_b32 v10, 0x7ff, v10
    v_lshl_add_u32 v10, v10, 5, v90
    v_or_b32 v11, 16, v10
    v_and_b32 v14, 0x7ff, v14
    v_lshl_add_u32 v14, v14, 5, v90
    v_add_u32 v14, 327680, v14
    v_or_b32 v15, 16, v14
    v_and_b32 v18, 0x7ff, v18
    v_lshl_add_u32 v18, v18, 5, v90
    v_add_u32 v18, 655360, v18
    v_or_b32 v19, 16, v18
    v_and_b32 v22, 0x7ff, v22
    v_lshl_add_u32 v22, v22, 5, v90
    v_add_u32 v22, 983040, v22
    v_or_b32 v23, 16, v22
    s_cmp_lt_u32 s2, s52
    s_cbranch_scc1 F_flag
F_flagr:
    s_waitcnt lgkmcnt(0)
    s_barrier
    ds_read_b32 v4, v88
    buffer_load_dword v95, v93, s[4:7], 0 offen offset:128
    v_lshlrev_b32 v72, 3, v72
    v_lshlrev_b32 v73, 3, v73
    v_lshlrev_b32 v74, 3, v74
    v_lshlrev_b32 v75, 3, v75
    v_lshlrev_b32 v76, 3, v76
    v_lshlrev_b32 v77, 3, v77
    v_lshlrev_b32 v78, 3, v78
    v_lshlrev_b32 v79, 3, v79
    s_waitcnt lgkmcnt(0)
    v_add_u32 v5, 15, v4
    v_cmp_lt_u32 vcc, 64, v4
    v_lshrrev_b32 v5, 4, v5
    v_med3_u32 v5, v5, 1, 4
    v_mul_u32_u24 v6, 640, v5
    v_max_u32 v6, 1536, v6
    v_cndmask_b32 v6, 0, v6, s[68:69]
    s_cmp_lg_u64 vcc, 0
    s_cbranch_scc1 SLOW
    v_mov_b32 v7, v6
    v_add_u32 v2, 7, v4
    v_lshrrev_b32 v2, 3, v2
    v_add_u32_dpp v7, v7, v7 row_shr:1 row_mask:0xf bank_mask:0xf
    v_max_u32 v2, 2, v2
    v_cmp_eq_u32 vcc, 7, v2
    v_add_u32_dpp v7, v7, v7 row_shr:2 row_mask:0xf bank_mask:0xf
    v_lshlrev_b32 v92, 22, v5
    v_lshlrev_b32 v5, 18, v5
    v_add_u32_dpp v7, v7, v7 row_shr:4 row_mask:0xf bank_mask:0xf
    v_lshl_or_b32 v5, v1, 21, v5
    v_addc_co_u32 v2, vcc, 0, v2, vcc
    v_add_u32_dpp v7, v7, v7 row_shr:8 row_mask:0xf bank_mask:0xf
    v_lshl_or_b32 v5, v2, 28, v5
    v_med3_u32 v2, v2, 3, 6
    v_add_u32_dpp v7, v7, v7 row_bcast:15 row_mask:0xa bank_mask:0xf
    v_cndmask_b32 v2, 0, v2, s[68:69]
    v_mov_b32 v84, 63
    v_add_u32_dpp v7, v7, v7 row_bcast:31 row_mask:0xc bank_mask:0xf
    s_mov_b32 s71, 0x2000
    v_readlane_b32 s66, v7, 63
    v_sub_u32 v7, v7, v6
    v_add_u32 v7, 86016, v7
    v_lshrrev_b32 v6, 3, v7
    v_mad_u32_u24 v92, v7, s71, v92
    v_or_b32 v92, v92, v6
    ds_bpermute_b32 v60, v60, v92
    ds_bpermute_b32 v61, v61, v92
    ds_bpermute_b32 v62, v62, v92
    ds_bpermute_b32 v63, v63, v92
    ds_bpermute_b32 v64, v64, v92
    ds_bpermute_b32 v65, v65, v92
    ds_bpermute_b32 v66, v66, v92
    ds_bpermute_b32 v67, v67, v92
    v_cmp_eq_u32 vcc, 6, v2
    v_or_b32 v6, v5, v7
    s_cmp_gt_u32 s66, 76800
    s_cbranch_scc1 SLOW
    v_mbcnt_lo_u32_b32 v5, vcc_lo, 0
    v_mbcnt_hi_u32_b32 v5, vcc_hi, v5
    s_bcnt1_i32_b64 s71, vcc
    v_cndmask_b32 v84, v84, v5, vcc
    v_cmp_eq_u32 vcc, 5, v2
    v_mov_b32 v3, s71
    s_nop 0
    v_mbcnt_lo_u32_b32 v5, vcc_lo, v3
    v_mbcnt_hi_u32_b32 v5, vcc_hi, v5
    s_bcnt1_i32_b64 s71, vcc
    v_cndmask_b32 v84, v84, v5, vcc
    v_cmp_eq_u32 vcc, 4, v2
    v_add_u32 v3, s71, v3
    s_nop 0
    v_mbcnt_lo_u32_b32 v5, vcc_lo, v3
    v_mbcnt_hi_u32_b32 v5, vcc_hi, v5
    s_bcnt1_i32_b64 s71, vcc
    v_cndmask_b32 v84, v84, v5, vcc
    v_cmp_eq_u32 vcc, 3, v2
    v_add_u32 v3, s71, v3
    s_nop 0
    v_mbcnt_lo_u32_b32 v5, vcc_lo, v3
    v_mbcnt_hi_u32_b32 v5, vcc_hi, v5
    v_cndmask_b32 v84, v84, v5, vcc
    s_waitcnt lgkmcnt(7)
    v_mad_u32_u16 v2, v60, 8, v72
    v_mad_u32_u16 v3, v60, 8, v72 op_sel:[1,0,0,0]
    s_mov_b64 exec, s[80:81]
    ds_write_b64 v2, v[10:11]
    ds_write_b64 v3, v[8:9]
    s_mov_b64 exec, -1
    s_waitcnt lgkmcnt(8)
    v_mad_u32_u16 v2, v61, 8, v73
    v_mad_u32_u16 v3, v61, 8, v73 op_sel:[1,0,0,0]
    s_mov_b64 exec, s[82:83]
    ds_write_b64 v2, v[14:15]
    ds_write_b64 v3, v[12:13]
    s_mov_b64 exec, -1
    s_waitcnt lgkmcnt(9)
    v_mad_u32_u16 v2, v62, 8, v74
    v_mad_u32_u16 v3, v62, 8, v74 op_sel:[1,0,0,0]
    s_mov_b64 exec, s[84:85]
    ds_write_b64 v2, v[18:19]
    ds_write_b64 v3, v[16:17]
    s_mov_b64 exec, -1
    s_waitcnt lgkmcnt(10)
    v_mad_u32_u16 v2, v63, 8, v75
    v_mad_u32_u16 v3, v63, 8, v75 op_sel:[1,0,0,0]
    s_mov_b64 exec, s[86:87]
    ds_write_b64 v2, v[22:23]
    ds_write_b64 v3, v[20:21]
    s_mov_b64 exec, -1
    v_bfe_u32 v2, v84, 2, 1
    v_bfe_u32 v3, v84, 3, 1
    v_mul_u32_u24 v2, 3, v2
    v_lshl_or_b32 v3, v3, 2, v2
    v_xor_b32 v84, v84, v3
    s_lshr_b32 s66, s2, 3
    v_add_u32 v2, s66, v84
    v_lshlrev_b32 v2, 3, v2
    v_add_u32 v2, v2, v84
    v_cmp_gt_u32 vcc, 32, v84
    v_and_b32 v2, 24, v2
    v_and_or_b32 v2, v84, 7, v2
    v_cndmask_b32 v84, v84, v2, vcc
    v_cmp_eq_u32 vcc, s20, v84
    s_ff1_i32_b64 s67, vcc
    v_readlane_b32 s80, v6, s67
    s_waitcnt vmcnt(1) lgkmcnt(8)
    s_mov_b64 exec, s[72:73]
    s_cbranch_execz F_s0
F_sp0:
    v_cmp_ne_u32 vcc, s88, v27
    s_cbranch_vccnz F_sa0
F_sg0:
    v_cmpx_lt_u32 vcc, 8, v56
    v_and_b32 v26, 0x7ff, v26
    v_lshl_add_u32 v26, v26, 5, v90
    v_or_b32 v27, 16, v26
    v_mad_u32_u16 v2, v64, 8, v76
    v_mad_u32_u16 v3, v64, 8, v76 op_sel:[1,0,0,0]
    ds_write_b64 v2, v[26:27]
    ds_write_b64 v3, v[24:25]
F_s0:
    s_mov_b64 exec, s[74:75]
    s_cbranch_execz F_s1
F_sp1:
    v_cmp_ne_u32 vcc, s88, v31
    s_cbranch_vccnz F_sa1
F_sg1:
    v_cmpx_lt_u32 vcc, 8, v57
    v_and_b32 v30, 0x7ff, v30
    v_lshl_add_u32 v30, v30, 5, v90
    v_add_u32 v30, 327680, v30
    v_or_b32 v31, 16, v30
    v_mad_u32_u16 v2, v65, 8, v77
    v_mad_u32_u16 v3, v65, 8, v77 op_sel:[1,0,0,0]
    ds_write_b64 v2, v[30:31]
    ds_write_b64 v3, v[28:29]
F_s1:
    s_mov_b64 exec, s[76:77]
    s_cbranch_execz F_s2
F_sp2:
    v_cmp_ne_u32 vcc, s88, v35
    s_cbranch_vccnz F_sa2
F_sg2:
    v_cmpx_lt_u32 vcc, 8, v58
    v_and_b32 v34, 0x7ff, v34
    v_lshl_add_u32 v34, v34, 5, v90
    v_add_u32 v34, 655360, v34
    v_or_b32 v35, 16, v34
    v_mad_u32_u16 v2, v66, 8, v78
    v_mad_u32_u16 v3, v66, 8, v78 op_sel:[1,0,0,0]
    ds_write_b64 v2, v[34:35]
    ds_write_b64 v3, v[32:33]
F_s2:
    s_mov_b64 exec, s[78:79]
    s_cbranch_execz F_s3
F_sp3:
    v_cmp_ne_u32 vcc, s88, v39
    s_cbranch_vccnz F_sa3
F_sg3:
    v_cmpx_lt_u32 vcc, 8, v59
    v_and_b32 v38, 0x7ff, v38
    v_lshl_add_u32 v38, v38, 5, v90
    v_add_u32 v38, 983040, v38
    v_or_b32 v39, 16, v38
    v_mad_u32_u16 v2, v67, 8, v79
    v_mad_u32_u16 v3, v67, 8, v79 op_sel:[1,0,0,0]
    ds_write_b64 v2, v[38:39]
    ds_write_b64 v3, v[36:37]
F_s3:
    s_mov_b64 exec, -1
    s_cmp_lg_u64 s[30:31], 0
    s_cbranch_scc1 F_u
F_ur:
    s_mov_b32 s22, s80
    s_mov_b32 s27, s80
    s_mov_b32 s71, s80
    s_bfe_u32 s46, s71, 0x30012
    s_mov_b32 m0, s46
    s_and_b32 s66, s71, 0x3ffff
    s_movrels_b32 s68, s57
    s_movrels_b32 s69, s61
    s_sub_u32 s48, s66, s47
    s_mov_b32 s47, s66
    s_lshr_b32 s52, s71, 28
    s_lshl_b32 s67, s46, 9
    s_add_u32 s66, s66, s67
    s_sub_u32 s49, s66, s42
    s_mov_b32 s42, s66
    s_bfe_u32 s66, s68, 655360
    s_add_u32 s43, s42, s66
    s_bfe_u32 s39, s69, 655360
    s_bfe_u32 s66, s68, 655370
    s_add_u32 s44, s42, s66
    s_bfe_u32 s40, s69, 655370
    s_bfe_u32 s66, s68, 655380
    s_add_u32 s45, s42, s66
    s_bfe_u32 s41, s69, 655380
    s_and_b32 s66, s46, s33
    s_cselect_b32 s72, -1, 1
    s_cselect_b32 s76, s47, 163712
    s_cmp_ge_u32 s66, 2
    s_cselect_b32 s73, -1, 0
    s_add_u32 s77, s47, 1024
    s_cmp_ge_u32 s66, 4
    s_cselect_b32 s75, -1, 0
    s_cmp_ge_u32 s66, 3
    s_cselect_b32 s74, -1, 1
    s_cselect_b32 s77, s77, 163712
    s_mul_i32 s66, s20, 80
    v_min_u32 v2, 76, v248
    s_waitcnt lgkmcnt(0)
    s_barrier
    v_add_u32 v253, s47, v248
    ds_read_b32 v254, v253
    ds_read_b32 v255, v253 offset:256
    v_add_u32 v252, s42, v247
    ds_read_u16 v234, v252
    ds_read_u16 v235, v252 offset:64
    v_add_u32 v252, s43, v247
    ds_read_u16 v236, v252
    ds_read_u16 v237, v252 offset:64
    v_add_u32 v252, s44, v247
    ds_read_u16 v238, v252
    ds_read_u16 v239, v252 offset:64
    v_add_u32 v252, s45, v247
    ds_read_u16 v240, v252
    ds_read_u16 v241, v252 offset:64
    buffer_load_dword v3, v2, s[16:19], s66 offen offset:128 sc1
    v_add_u32 v249, s48, v249
    v_add_u32 v250, s49, v250
    s_waitcnt lgkmcnt(8)
    s_mov_b32 m0, s76
    s_mov_b64 exec, s[72:73]
    buffer_load_dwordx4 v254, s[12:15], 0 offen  lds
    s_mov_b32 m0, s77
    s_mov_b64 exec, s[74:75]
    buffer_load_dwordx4 v255, s[12:15], 0 offen  lds
    s_mov_b64 exec, -1
    s_waitcnt lgkmcnt(0)
    s_add_u32 m0, s21, 0
    v_lshl_add_u32 v234, v234, 10, v246
    v_lshl_add_u32 v235, v235, 10, v246
    buffer_load_dwordx4 v234, s[4:7], s38 offen  lds
    buffer_load_dwordx4 v235, s[8:11], s38 offen offset:1024  lds
    s_add_u32 m0, s21, 2048
    v_lshl_add_u32 v236, v236, 10, v246
    v_lshl_add_u32 v237, v237, 10, v246
    buffer_load_dwordx4 v236, s[4:7], s39 offen  lds
    buffer_load_dwordx4 v237, s[8:11], s39 offen offset:1024  lds
    s_add_u32 m0, s21, 4096
    v_lshl_add_u32 v238, v238, 10, v246
    v_lshl_add_u32 v239, v239, 10, v246
    buffer_load_dwordx4 v238, s[4:7], s40 offen  lds
    buffer_load_dwordx4 v239, s[8:11], s40 offen offset:1024  lds
    s_add_u32 m0, s21, 6144
    v_lshl_add_u32 v240, v240, 10, v246
    v_lshl_add_u32 v241, v241, 10, v246
    buffer_load_dwordx4 v240, s[4:7], s41 offen  lds
    buffer_load_dwordx4 v241, s[8:11], s41 offen offset:1024  lds
    v_lshrrev_b32 v8, 3, v84
    v_and_b32 v9, 7, v84
    v_lshlrev_b32 v9, 13, v9
    v_mul_u32_u24 v8, 1536, v8
    v_lshlrev_b32 v10, 4, v84
    v_and_b32 v5, 128, v10
    v_add3_u32 v8, v8, v9, v5
    v_xor_b32 v9, v10, v7
    v_and_b32 v9, 128, v9
    v_add_u32 v9, v9, v7
    v_mov_b32 v5, v9
    s_add_u32 s66, s20, 0
    v_cmp_eq_u32 vcc, s66, v84
    s_ff1_i32_b64 s67, vcc
    v_readlane_b32 s28, v5, s67
    s_add_u32 s66, s20, 8
    v_cmp_eq_u32 vcc, s66, v84
    s_ff1_i32_b64 s67, vcc
    v_readlane_b32 s29, v5, s67
    v_readlane_b32 s23, v6, s67
    s_add_u32 s66, s20, 16
    v_cmp_eq_u32 vcc, s66, v84
    s_ff1_i32_b64 s67, vcc
    v_readlane_b32 s30, v5, s67
    v_readlane_b32 s24, v6, s67
    s_add_u32 s66, s20, 24
    v_cmp_eq_u32 vcc, s66, v84
    s_ff1_i32_b64 s67, vcc
    v_readlane_b32 s31, v5, s67
    v_readlane_b32 s25, v6, s67
    s_add_u32 s66, s20, 32
    v_cmp_eq_u32 vcc, s66, v84
    s_ff1_i32_b64 s67, vcc
    v_readlane_b32 s32, v5, s67
    v_readlane_b32 s26, v6, s67
    v_lshlrev_b32 v4, 3, v84
    v_add_u32 v4, 163328, v4
    s_mov_b32 exec_hi, 0xff
    ds_write_b64 v4, v[8:9]
    s_mov_b32 exec_hi, -1
    s_waitcnt lgkmcnt(0)
    v_mov_b32 v252, 0
    s_waitcnt vmcnt(6)
    v_cmp_ne_u32 vcc, s88, v3
    ds_read_b64_tr_b16 v[176:177], v244 offset:0
    ds_read_b64_tr_b16 v[178:179], v244 offset:1024
    ds_read_b64_tr_b16 v[180:181], v245 offset:0
    ds_read_b64_tr_b16 v[182:183], v245 offset:1024
    ds_read_b64_tr_b16 v[64:65], v249 offset:0
    ds_read_b64_tr_b16 v[68:69], v249 offset:64
    ds_read_b64_tr_b16 v[66:67], v249 offset:256
    ds_read_b64_tr_b16 v[70:71], v249 offset:320
    s_mov_b64 exec, s[54:55]
    ds_read_u16_d16_hi v242, v250 offset:0
    s_mov_b64 exec, -1
    s_or_b32 s89, vcc_lo, vcc_hi
    s_add_u32 s53, s53, 4
    s_xor_b32 s66, s53, s20
    s_bitcmp1_b32 s66, 2
    s_setprio 1
    s_cbranch_scc1 PRIO_1
    s_setprio 0
PRIO_1:
    s_cmp_eq_u32 s52, 4
    s_cbranch_scc1 ITEM_0_4
    s_cmp_eq_u32 s52, 5
    s_cbranch_scc1 ITEM_0_5
    s_cmp_eq_u32 s52, 3
    s_cbranch_scc1 ITEM_0_3
    s_cmp_eq_u32 s52, 6
    s_cbranch_scc1 ITEM_0_6
    s_cmp_eq_u32 s52, 8
    s_cbranch_scc1 ITEM_0_8
    s_branch ITEM_0_2
F_again:
    s_sub_u32 s27, s27, 1
    s_cbranch_scc1 F_late
    s_cmp_eq_u64 s[72:73], 0
    s_cbranch_scc1 F_p0
    s_mov_b64 exec, s[72:73]
    buffer_load_dwordx4 v[8:11], v86, s[16:19], s24 offen offset:0 sc1
    s_mov_b64 exec, -1
F_p0:
    s_cmp_eq_u64 s[74:75], 0
    s_cbranch_scc1 F_p1
    s_mov_b64 exec, s[74:75]
    buffer_load_dwordx4 v[12:15], v86, s[16:19], s24 offen offset:1024 sc1
    s_mov_b64 exec, -1
F_p1:
    s_cmp_eq_u64 s[76:77], 0
    s_cbranch_scc1 F_p2
    s_mov_b64 exec, s[76:77]
    buffer_load_dwordx4 v[16:19], v86, s[16:19], s24 offen offset:2048 sc1
    s_mov_b64 exec, -1
F_p2:
    s_cmp_eq_u64 s[78:79], 0
    s_cbranch_scc1 F_p3
    s_mov_b64 exec, s[78:79]
    buffer_load_dwordx4 v[20:23], v86, s[16:19], s24 offen offset:3072 sc1
    s_mov_b64 exec, -1
F_p3:
    s_branch F_poll
F_late:
    v_mov_b32 v2, 163064
    v_mov_b32 v4, 1000
    ds_write_b32 v2, v4
    v_mov_b32 v10, 0
    v_mov_b32 v14, 0
    v_mov_b32 v18, 0
    v_mov_b32 v22, 0
    s_branch F_got
F_l3:
    v_bfe_u32 v2, v10, 23, 5
    v_sub_u32 v56, v2, v91
    v_cmp_lt_u32 vcc, 16, v2
    s_mov_b64 exec, vcc
    s_cbranch_execz F_t0
F_tp0:
    buffer_load_dwordx4 v[40:43], v86, s[16:19], s26 offen offset:0 sc1
    s_waitcnt vmcnt(0)
    v_cmp_ne_u32 vcc, s88, v43
    s_sub_u32 s27, s27, 1
    s_cselect_b64 vcc, 0, vcc
    s_cmp_eq_u64 vcc, 0
    s_cbranch_scc0 F_tp0
    v_bfe_u32 v68, v42, 11, 6
    v_lshl_add_u32 v68, v68, 2, s71
    v_cmp_lt_i32 vcc, 16, v56
    s_mov_b64 exec, vcc
    ds_add_rtn_u32 v80, v68, v3
F_t0:
    s_mov_b64 exec, -1
    v_bfe_u32 v2, v14, 23, 5
    v_sub_u32 v57, v2, v91
    v_cmp_lt_u32 vcc, 16, v2
    s_mov_b64 exec, vcc
    s_cbranch_execz F_t1
F_tp1:
    buffer_load_dwordx4 v[44:47], v86, s[16:19], s26 offen offset:1024 sc1
    s_waitcnt vmcnt(0)
    v_cmp_ne_u32 vcc, s88, v47
    s_sub_u32 s27, s27, 1
    s_cselect_b64 vcc, 0, vcc
    s_cmp_eq_u64 vcc, 0
    s_cbranch_scc0 F_tp1
    v_bfe_u32 v69, v46, 11, 6
    v_lshl_add_u32 v69, v69, 2, s71
    v_cmp_lt_i32 vcc, 16, v57
    s_mov_b64 exec, vcc
    ds_add_rtn_u32 v81, v69, v3
F_t1:
    s_mov_b64 exec, -1
    v_bfe_u32 v2, v18, 23, 5
    v_sub_u32 v58, v2, v91
    v_cmp_lt_u32 vcc, 16, v2
    s_mov_b64 exec, vcc
    s_cbranch_execz F_t2
F_tp2:
    buffer_load_dwordx4 v[48:51], v86, s[16:19], s26 offen offset:2048 sc1
    s_waitcnt vmcnt(0)
    v_cmp_ne_u32 vcc, s88, v51
    s_sub_u32 s27, s27, 1
    s_cselect_b64 vcc, 0, vcc
    s_cmp_eq_u64 vcc, 0
    s_cbranch_scc0 F_tp2
    v_bfe_u32 v70, v50, 11, 6
    v_lshl_add_u32 v70, v70, 2, s71
    v_cmp_lt_i32 vcc, 16, v58
    s_mov_b64 exec, vcc
    ds_add_rtn_u32 v82, v70, v3
F_t2:
    s_mov_b64 exec, -1
    v_bfe_u32 v2, v22, 23, 5
    v_sub_u32 v59, v2, v91
    v_cmp_lt_u32 vcc, 16, v2
    s_mov_b64 exec, vcc
    s_cbranch_execz F_t3
F_tp3:
    buffer_load_dwordx4 v[52:55], v86, s[16:19], s26 offen offset:3072 sc1
    s_waitcnt vmcnt(0)
    v_cmp_ne_u32 vcc, s88, v55
    s_sub_u32 s27, s27, 1
    s_cselect_b64 vcc, 0, vcc
    s_cmp_eq_u64 vcc, 0
    s_cbranch_scc0 F_tp3
    v_bfe_u32 v71, v54, 11, 6
    v_lshl_add_u32 v71, v71, 2, s71
    v_cmp_lt_i32 vcc, 16, v59
    s_mov_b64 exec, vcc
    ds_add_rtn_u32 v83, v71, v3
F_t3:
    s_mov_b64 exec, -1
    v_mov_b32 v2, 163068
    v_mov_b32 v4, 1000
    v_cmp_lt_u32 vcc, 24, v89
    s_mov_b64 exec, vcc
    ds_write_b32 v2, v4
    s_mov_b64 exec, -1
    s_branch F_l3r
F_flag:
    s_lshl_b32 s66, s2, 2
    v_mov_b32 v2, 128
    v_mov_b32 v4, s88
    s_mov_b64 exec, 1
    buffer_store_dword v4, v2, s[16:19], s66 offen sc1
    s_mov_b64 exec, -1
    s_branch F_flagr
F_sa0:
    s_sub_u32 s27, s27, 1
    s_cbranch_scc1 F_sg0
    buffer_load_dwordx4 v[24:27], v86, s[16:19], s25 offen offset:0 sc1
    s_waitcnt vmcnt(0)
    s_branch F_sp0
F_sa1:
    s_sub_u32 s27, s27, 1
    s_cbranch_scc1 F_sg1
    buffer_load_dwordx4 v[28:31], v86, s[16:19], s25 offen offset:1024 sc1
    s_waitcnt vmcnt(0)
    s_branch F_sp1
F_sa2:
    s_sub_u32 s27, s27, 1
    s_cbranch_scc1 F_sg2
    buffer_load_dwordx4 v[32:35], v86, s[16:19], s25 offen offset:2048 sc1
    s_waitcnt vmcnt(0)
    s_branch F_sp2
F_sa3:
    s_sub_u32 s27, s27, 1
    s_cbranch_scc1 F_sg3
    buffer_load_dwordx4 v[36:39], v86, s[16:19], s25 offen offset:3072 sc1
    s_waitcnt vmcnt(0)
    s_branch F_sp3
F_u:
    ds_bpermute_b32 v68, v68, v92
    ds_bpermute_b32 v69, v69, v92
    ds_bpermute_b32 v70, v70, v92
    ds_bpermute_b32 v71, v71, v92
    s_waitcnt lgkmcnt(0)
    v_cmp_lt_i32 vcc, 16, v56
    s_mov_b64 exec, vcc
    s_cbranch_execz F_u0
    v_lshlrev_b32 v80, 3, v80
    v_and_b32 v42, 0x7ff, v42
    v_lshl_add_u32 v42, v42, 5, v90
    v_or_b32 v43, 16, v42
    v_mad_u32_u16 v2, v68, 8, v80
    v_mad_u32_u16 v3, v68, 8, v80 op_sel:[1,0,0,0]
    ds_write_b64 v2, v[42:43]
    ds_write_b64 v3, v[40:41]
F_u0:
    s_mov_b64 exec, -1
    v_cmp_lt_i32 vcc, 16, v57
    s_mov_b64 exec, vcc
    s_cbranch_execz F_u1
    v_lshlrev_b32 v81, 3, v81
    v_and_b32 v46, 0x7ff, v46
    v_lshl_add_u32 v46, v46, 5, v90
    v_add_u32 v46, 327680, v46
    v_or_b32 v47, 16, v46
    v_mad_u32_u16 v2, v69, 8, v81
    v_mad_u32_u16 v3, v69, 8, v81 op_sel:[1,0,0,0]
    ds_write_b64 v2, v[46:47]
    ds_write_b64 v3, v[44:45]
F_u1:
    s_mov_b64 exec, -1
    v_cmp_lt_i32 vcc, 16, v58
    s_mov_b64 exec, vcc
    s_cbranch_execz F_u2
    v_lshlrev_b32 v82, 3, v82
    v_and_b32 v50, 0x7ff, v50
    v_lshl_add_u32 v50, v50, 5, v90
    v_add_u32 v50, 655360, v50
    v_or_b32 v51, 16, v50
    v_mad_u32_u16 v2, v70, 8, v82
    v_mad_u32_u16 v3, v70, 8, v82 op_sel:[1,0,0,0]
    ds_write_b64 v2, v[50:51]
    ds_write_b64 v3, v[48:49]
F_u2:
    s_mov_b64 exec, -1
    v_cmp_lt_i32 vcc, 16, v59
    s_mov_b64 exec, vcc
    s_cbranch_execz F_u3
    v_lshlrev_b32 v83, 3, v83
    v_and_b32 v54, 0x7ff, v54
    v_lshl_add_u32 v54, v54, 5, v90
    v_add_u32 v54, 983040, v54
    v_or_b32 v55, 16, v54
    v_mad_u32_u16 v2, v71, 8, v83
    v_mad_u32_u16 v3, v71, 8, v83 op_sel:[1,0,0,0]
    ds_write_b64 v2, v[54:55]
    ds_write_b64 v3, v[52:53]
F_u3:
    s_mov_b64 exec, -1
    s_branch F_ur
LAST0:
    s_cmp_eq_u32 s50, 5
    s_cbranch_scc1 TO_PHASE1
    s_add_u32 s4, s4, 128
    s_addc_u32 s5, s5, 0
    s_add_u32 s8, s8, 128
    s_addc_u32 s9, s9, 0
    s_mov_b32 s34, 0
    s_mov_b32 s35, 256
    s_mov_b32 s36, 512
    s_mov_b32 s37, 768
    s_mov_b32 s33, 0
    s_add_u32 s53, s53, 4
    s_xor_b32 s66, s53, s20
    s_bitcmp1_b32 s66, 2
    s_setprio 1
    s_cbranch_scc1 PRIO_2
    s_setprio 0
PRIO_2:
    s_cmp_eq_u32 s52, 4
    s_cbranch_scc1 ITEM_0_4
    s_cmp_eq_u32 s52, 5
    s_cbranch_scc1 ITEM_0_5
    s_cmp_eq_u32 s52, 3
    s_cbranch_scc1 ITEM_0_3
    s_cmp_eq_u32 s52, 6
    s_cbranch_scc1 ITEM_0_6
    s_cmp_eq_u32 s52, 8
    s_cbranch_scc1 ITEM_0_8
    s_branch ITEM_0_2
TO_PHASE1:
    ds_read_b32 v252, v251 offset:16
    v_lshlrev_b32 v253, 2, v248
    v_add_u32 v253, 65536, v253
    ds_read_b128 v[96:99], v253 offset:0
    ds_read_b128 v[100:103], v253 offset:1024
    ds_read_b128 v[104:107], v253 offset:2048
    ds_read_b128 v[108:111], v253 offset:3072
    ds_read_b128 v[112:115], v253 offset:4096
    ds_read_b128 v[116:119], v253 offset:5120
    ds_read_b128 v[120:123], v253 offset:6144
    ds_read_b128 v[124:127], v253 offset:7168
    ds_read_b128 v[128:131], v253 offset:8192
    ds_read_b128 v[132:135], v253 offset:9216
    ds_read_b128 v[136:139], v253 offset:10240
    ds_read_b128 v[140:143], v253 offset:11264
    ds_read_b128 v[144:147], v253 offset:12288
    ds_read_b128 v[148:151], v253 offset:13312
    ds_read_b128 v[152:155], v253 offset:14336
    ds_read_b128 v[156:159], v253 offset:15360
    ds_read_b128 v[160:163], v253 offset:16384
    ds_read_b128 v[164:167], v253 offset:17408
    ds_read_b128 v[168:171], v253 offset:18432
    ds_read_b128 v[172:175], v253 offset:19456
    s_lshl_b32 s66, s20, 4
    v_xor_b32 v248, s66, v248
    s_mov_b32 s34, 128
    s_mov_b32 s35, 384
    s_mov_b32 s36, 640
    s_mov_b32 s37, 896
    s_mov_b32 s50, 0
    s_waitcnt lgkmcnt(0)
    s_waitcnt lgkmcnt(0)
    v_readfirstlane_b32 s66, v252
    s_add_u32 s53, s53, 1
    v_mov_b32 v252, s53
    s_cmp_le_u32 s53, s66
    ds_write2_b32 v251, v252, v252 offset0:0 offset1:8
    s_setprio 1
    s_cbranch_scc1 PRIO_3
    s_setprio 0
PRIO_3:
    s_cmp_eq_u32 s52, 4
    s_cbranch_scc1 ITEM_1_4
    s_cmp_eq_u32 s52, 5
    s_cbranch_scc1 ITEM_1_5
    s_cmp_eq_u32 s52, 3
    s_cbranch_scc1 ITEM_1_3
    s_cmp_eq_u32 s52, 6
    s_cbranch_scc1 ITEM_1_6
    s_cmp_eq_u32 s52, 8
    s_cbranch_scc1 ITEM_1_8
    s_branch ITEM_1_2
LAST1:
    s_cmp_eq_u32 s89, 0
    s_cbranch_scc1 T_flagsL
    s_mul_i32 s66, s20, 80
    v_min_u32 v2, 76, v248
    s_mov_b32 s67, 262144
T_pollL:
    buffer_load_dword v3, v2, s[16:19], s66 offen offset:128 sc1
    s_waitcnt vmcnt(0)
    v_cmp_ne_u32 vcc, s88, v3
    s_sub_u32 s67, s67, 1
    s_cselect_b64 vcc, 0, vcc
    s_cmp_eq_u64 vcc, 0
    s_cbranch_scc0 T_pollL
    s_mov_b32 s89, 0
T_flagsL:
    s_lshl_b32 s66, s20, 4
    v_xor_b32 v246, s66, v248
    v_lshlrev_b32 v246, 2, v246
    s_mul_i32 s51, s20, 20480
    s_add_u32 s51, s51, 1024
    s_load_dwordx2 s[72:73], s[0:1], 72
    s_waitcnt lgkmcnt(7)
    v_readfirstlane_b32 s66, v252
    s_add_u32 s53, s53, 1
    v_mov_b32 v252, s53
    s_cmp_le_u32 s53, s66
    ds_write2_b32 v251, v252, v252 offset0:0 offset1:8
    s_setprio 3
    s_cbranch_scc1 PRIO_4
    s_setprio 2
PRIO_4:
    s_cmp_eq_u32 s52, 4
    s_cbranch_scc1 ITEM_1_4
    s_cmp_eq_u32 s52, 5
    s_cbranch_scc1 ITEM_1_5
    s_cmp_eq_u32 s52, 3
    s_cbranch_scc1 ITEM_1_3
    s_cmp_eq_u32 s52, 6
    s_cbranch_scc1 ITEM_1_6
    s_cmp_eq_u32 s52, 8
    s_cbranch_scc1 ITEM_1_8
    s_branch ITEM_1_2
.p2align 6
ITEM_0_4:
    s_mov_b64 exec, s[54:55]
    ds_read_u16_d16_hi v243, v250 offset:128
    s_mov_b64 exec, -1
    ds_read_b64_tr_b16 v[72:73], v249 offset:512
    ds_read_b64_tr_b16 v[76:77], v249 offset:576
    ds_read_b64_tr_b16 v[74:75], v249 offset:768
    ds_read_b64_tr_b16 v[78:79], v249 offset:832
    s_waitcnt lgkmcnt(5)
    v_mul_f32_dpp v196, v242, v64 row_newbcast:0 row_mask:0xf bank_mask:0xf
    v_mul_f32_dpp v197, v242, v65 row_newbcast:1 row_mask:0xf bank_mask:0xf
    v_mul_f32_dpp v198, v242, v64 row_newbcast:8 row_mask:0xf bank_mask:0xf
    v_mul_f32_dpp v199, v242, v65 row_newbcast:9 row_mask:0xf bank_mask:0xf
    v_mul_f32_dpp v200, v242, v68 row_newbcast:2 row_mask:0xf bank_mask:0xf
    v_mul_f32_dpp v201, v242, v69 row_newbcast:3 row_mask:0xf bank_mask:0xf
    v_mul_f32_dpp v202, v242, v68 row_newbcast:10 row_mask:0xf bank_mask:0xf
    v_mul_f32_dpp v203, v242, v69 row_newbcast:11 row_mask:0xf bank_mask:0xf
    v_cvt_pk_bf16_f32 v64, v196, v197
    v_cvt_pk_bf16_f32 v68, v198, v199
    v_cvt_pk_bf16_f32 v65, v200, v201
    v_cvt_pk_bf16_f32 v69, v202, v203
    v_mul_f32_dpp v196, v242, v66 row_newbcast:4 row_mask:0xf bank_mask:0xf
    v_mul_f32_dpp v197, v242, v67 row_newbcast:5 row_mask:0xf bank_mask:0xf
    v_mul_f32_dpp v198, v242, v66 row_newbcast:12 row_mask:0xf bank_mask:0xf
    v_mul_f32_dpp v199, v242, v67 row_newbcast:13 row_mask:0xf bank_mask:0xf
    v_mul_f32_dpp v200, v242, v70 row_newbcast:6 row_mask:0xf bank_mask:0xf
    v_mul_f32_dpp v201, v242, v71 row_newbcast:7 row_mask:0xf bank_mask:0xf
    v_mul_f32_dpp v202, v242, v70 row_newbcast:14 row_mask:0xf bank_mask:0xf
    v_mul_f32_dpp v203, v242, v71 row_newbcast:15 row_mask:0xf bank_mask:0xf
    v_cvt_pk_bf16_f32 v66, v196, v197
    v_cvt_pk_bf16_f32 v70, v198, v199
    v_cvt_pk_bf16_f32 v67, v200, v201
    v_cvt_pk_bf16_f32 v71, v202, v203
    s_nop 0
    s_waitcnt vmcnt(4) lgkmcnt(0)
    v_mfma_f32_32x32x16_bf16 v[0:15], v[64:67], v[176:179], 0
    v_mul_f32_dpp v196, v243, v72 row_newbcast:0 row_mask:0xf bank_mask:0xf
    v_mul_f32_dpp v197, v243, v73 row_newbcast:1 row_mask:0xf bank_mask:0xf
    v_mul_f32_dpp v198, v243, v72 row_newbcast:8 row_mask:0xf bank_mask:0xf
    v_mul_f32_dpp v199, v243, v73 row_newbcast:9 row_mask:0xf bank_mask:0xf
    v_mul_f32_dpp v200, v243, v76 row_newbcast:2 row_mask:0xf bank_mask:0xf
    v_mul_f32_dpp v201, v243, v77 row_newbcast:3 row_mask:0xf bank_mask:0xf
    v_mul_f32_dpp v202, v243, v76 row_newbcast:10 row_mask:0xf bank_mask:0xf
    v_mul_f32_dpp v203, v243, v77 row_newbcast:11 row_mask:0xf bank_mask:0xf
    v_cvt_pk_bf16_f32 v72, v196, v197
    v_cvt_pk_bf16_f32 v76, v198, v199
    v_cvt_pk_bf16_f32 v73, v200, v201
    v_cvt_pk_bf16_f32 v77, v202, v203
    s_add_u32 m0, s21, 0
    v_mfma_f32_32x32x16_bf16 v[16:31], v[68:71], v[176:179], 0
    buffer_load_dwordx4 v234, s[4:7], s36 offen  lds
    buffer_load_dwordx4 v235, s[8:11], s36 offen offset:1024  lds
    ds_read_b64_tr_b16 v[176:177], v244 offset:2048
    ds_read_b64_tr_b16 v[178:179], v244 offset:3072
    ds_read_b64_tr_b16 v[184:185], v245 offset:2048
    ds_read_b64_tr_b16 v[186:187], v245 offset:3072
    v_mul_f32_dpp v196, v243, v74 row_newbcast:4 row_mask:0xf bank_mask:0xf
    v_mul_f32_dpp v197, v243, v75 row_newbcast:5 row_mask:0xf bank_mask:0xf
    v_mul_f32_dpp v198, v243, v74 row_newbcast:12 row_mask:0xf bank_mask:0xf
    v_mul_f32_dpp v199, v243, v75 row_newbcast:13 row_mask:0xf bank_mask:0xf
    v_mul_f32_dpp v200, v243, v78 row_newbcast:6 row_mask:0xf bank_mask:0xf
    v_mul_f32_dpp v201, v243, v79 row_newbcast:7 row_mask:0xf bank_mask:0xf
    v_mul_f32_dpp v202, v243, v78 row_newbcast:14 row_mask:0xf bank_mask:0xf
    v_mul_f32_dpp v203, v243, v79 row_newbcast:15 row_mask:0xf bank_mask:0xf
    v_cvt_pk_bf16_f32 v74, v196, v197
    v_cvt_pk_bf16_f32 v78, v198, v199
    v_cvt_pk_bf16_f32 v75, v200, v201
    v_cvt_pk_bf16_f32 v79, v202, v203
    s_nop 0
    s_waitcnt lgkmcnt(0)
    v_mfma_f32_32x32x16_bf16 v[0:15], v[72:75], v[176:179], v[0:15]
    s_add_u32 m0, s21, 2048
    v_mfma_f32_32x32x16_bf16 v[16:31], v[76:79], v[176:179], v[16:31]
    buffer_load_dwordx4 v236, s[4:7], s36 offen  lds
    buffer_load_dwordx4 v237, s[8:11], s36 offen offset:1024  lds
    s_mov_b32 m0, s50
    s_nop 0
    s_movrels_b32 s71, s23
    s_bfe_u32 s46, s71, 0x30012
    s_mov_b32 m0, s46
    s_and_b32 s66, s71, 0x3ffff
    s_movrels_b32 s68, s57
    s_movrels_b32 s69, s61
    s_sub_u32 s48, s66, s47
    s_mov_b32 s47, s66
    s_lshr_b32 s52, s71, 28
    s_lshl_b32 s67, s46, 9
    s_add_u32 s66, s66, s67
    s_sub_u32 s49, s66, s42
    s_mov_b32 s42, s66
    s_bfe_u32 s66, s68, 655360
    s_add_u32 s43, s42, s66
    s_bfe_u32 s39, s69, 655360
    s_bfe_u32 s66, s68, 655370
    s_add_u32 s44, s42, s66
    s_bfe_u32 s40, s69, 655370
    s_bfe_u32 s66, s68, 655380
    s_add_u32 s45, s42, s66
    s_bfe_u32 s41, s69, 655380
    s_and_b32 s66, s46, s33
    s_cselect_b32 s72, -1, 1
    s_cselect_b32 s76, s47, 163712
    s_cmp_ge_u32 s66, 2
    s_cselect_b32 s73, -1, 0
    s_add_u32 s77, s47, 1024
    s_cmp_ge_u32 s66, 4
    s_cselect_b32 s75, -1, 0
    s_cmp_ge_u32 s66, 3
    s_cselect_b32 s74, -1, 1
    s_cselect_b32 s77, s77, 163712
    v_add_u32 v252, s44, v247
    ds_read_u16 v238, v252
    ds_read_u16 v239, v252 offset:64
    v_add_u32 v252, s45, v247
    ds_read_u16 v240, v252
    ds_read_u16 v241, v252 offset:64
    v_mfma_f32_32x32x16_bf16 v[32:47], v[64:67], v[180:183], 0
    v_mul_f32 v196, v0, v96
    v_fmac_f32 v196, v1, v97
    v_fmac_f32 v196, v2, v98
    v_fmac_f32 v196, v3, v99
    v_fmac_f32 v196, v4, v100
    v_fmac_f32 v196, v5, v101
    v_fmac_f32 v196, v6, v102
    v_fmac_f32 v196, v7, v103
    v_mul_f32 v198, v8, v128
    v_fmac_f32 v198, v9, v129
    v_mfma_f32_32x32x16_bf16 v[48:63], v[68:71], v[180:183], 0
    s_waitcnt vmcnt(6)
    ds_read_b64_tr_b16 v[176:177], v244 offset:4096
    ds_read_b64_tr_b16 v[178:179], v244 offset:5120
    ds_read_b64_tr_b16 v[180:181], v245 offset:4096
    ds_read_b64_tr_b16 v[182:183], v245 offset:5120
    v_fmac_f32 v198, v10, v130
    v_fmac_f32 v198, v11, v131
    v_fmac_f32 v198, v12, v132
    v_fmac_f32 v198, v13, v133
    v_fmac_f32 v198, v14, v134
    v_fmac_f32 v198, v15, v135
    v_mul_f32 v200, v16, v128
    v_fmac_f32 v200, v17, v129
    v_permlane32_swap_b32 v196, v198
    v_mfma_f32_32x32x16_bf16 v[32:47], v[72:75], v[184:187], v[32:47]
    v_fmac_f32 v200, v18, v130
    v_fmac_f32 v200, v19, v131
    v_fmac_f32 v200, v20, v132
    v_fmac_f32 v200, v21, v133
    v_fmac_f32 v200, v22, v134
    v_fmac_f32 v200, v23, v135
    v_add_f32 v198, v196, v198
    v_mul_f32_e64 v202, v24, -v128
    v_fma_f32 v202, v25, -v129, v202
    v_mfma_f32_32x32x16_bf16 v[48:63], v[76:79], v[184:187], v[48:63]
    v_fma_f32 v202, v26, -v130, v202
    v_fma_f32 v202, v27, -v131, v202
    v_fma_f32 v202, v28, -v132, v202
    v_fma_f32 v202, v29, -v133, v202
    v_fma_f32 v202, v30, -v134, v202
    v_fma_f32 v202, v31, -v135, v202
    s_nop 1
    v_permlane32_swap_b32 v200, v202
    v_add_f32 v202, v200, v202
    s_waitcnt vmcnt(4) lgkmcnt(0)
    v_mfma_f32_32x32x16_bf16 v[0:15], v[64:67], v[176:179], 0
    v_mul_f32 v197, v32, v104
    v_fmac_f32 v197, v33, v105
    v_fmac_f32 v197, v34, v106
    v_fmac_f32 v197, v35, v107
    v_fmac_f32 v197, v36, v108
    v_fmac_f32 v197, v37, v109
    v_fmac_f32 v197, v38, v110
    v_fmac_f32 v197, v39, v111
    v_mul_f32 v199, v40, v136
    v_fmac_f32 v199, v41, v137
    v_fmac_f32 v199, v42, v138
    s_add_u32 m0, s21, 4096
    v_mfma_f32_32x32x16_bf16 v[16:31], v[68:71], v[176:179], 0
    buffer_load_dwordx4 v234, s[4:7], s37 offen  lds
    buffer_load_dwordx4 v235, s[8:11], s37 offen offset:1024  lds
    ds_read_b64_tr_b16 v[176:177], v244 offset:6144
    ds_read_b64_tr_b16 v[178:179], v244 offset:7168
    ds_read_b64_tr_b16 v[184:185], v245 offset:6144
    ds_read_b64_tr_b16 v[186:187], v245 offset:7168
    v_add_u32 v252, s42, v247
    ds_read_u16 v234, v252
    ds_read_u16 v235, v252 offset:64
    v_fmac_f32 v199, v43, v139
    v_fmac_f32 v199, v44, v140
    v_fmac_f32 v199, v45, v141
    v_fmac_f32 v199, v46, v142
    v_fmac_f32 v199, v47, v143
    v_mul_f32 v201, v48, v136
    v_fmac_f32 v201, v49, v137
    v_permlane32_swap_b32 v197, v199
    v_fmac_f32 v201, v50, v138
    v_fmac_f32 v201, v51, v139
    s_waitcnt lgkmcnt(2)
    v_mfma_f32_32x32x16_bf16 v[0:15], v[72:75], v[176:179], v[0:15]
    v_fmac_f32 v201, v52, v140
    v_fmac_f32 v201, v53, v141
    v_fmac_f32 v201, v54, v142
    v_fmac_f32 v201, v55, v143
    v_add_f32 v199, v197, v199
    v_mul_f32_e64 v203, v56, -v136
    v_fma_f32 v203, v57, -v137, v203
    v_fma_f32 v203, v58, -v138, v203
    v_fma_f32 v203, v59, -v139, v203
    v_fma_f32 v203, v60, -v140, v203
    v_fma_f32 v203, v61, -v141, v203
    s_add_u32 m0, s21, 6144
    v_mfma_f32_32x32x16_bf16 v[16:31], v[76:79], v[176:179], v[16:31]
    buffer_load_dwordx4 v236, s[4:7], s37 offen  lds
    buffer_load_dwordx4 v237, s[8:11], s37 offen offset:1024  lds
    v_add_u32 v252, s43, v247
    ds_read_u16 v236, v252
    ds_read_u16 v237, v252 offset:64
    v_fma_f32 v203, v62, -v142, v203
    v_fma_f32 v203, v63, -v143, v203
    s_nop 1
    v_permlane32_swap_b32 v201, v203
    v_add_f32 v203, v201, v203
    s_set_gpr_idx_on s51, gpr_idx(DST)
    s_nop 0
    v_cvt_pk_bf16_f32 v204, v198, v199
    v_cvt_pk_bf16_f32 v205, v202, v203
    s_set_gpr_idx_off
    v_mfma_f32_32x32x16_bf16 v[32:47], v[64:67], v[180:183], 0
    v_mul_f32 v196, v0, v144
    v_fmac_f32 v196, v1, v145
    v_fmac_f32 v196, v2, v146
    v_fmac_f32 v196, v3, v147
    v_fmac_f32 v196, v4, v148
    v_fmac_f32 v196, v5, v149
    v_fmac_f32 v196, v6, v150
    v_fmac_f32 v196, v7, v151
    v_mfma_f32_32x32x16_bf16 v[48:63], v[68:71], v[180:183], 0
    v_add_u32 v253, s47, v248
    ds_read_b32 v254, v253
    ds_read_b32 v255, v253 offset:256
    s_waitcnt vmcnt(6)
    ds_read_b64_tr_b16 v[176:177], v244 offset:0
    ds_read_b64_tr_b16 v[178:179], v244 offset:1024
    ds_read_b64_tr_b16 v[180:181], v245 offset:0
    ds_read_b64_tr_b16 v[182:183], v245 offset:1024
    v_mul_f32 v198, v8, v112
    v_fmac_f32 v198, v9, v113
    v_fmac_f32 v198, v10, v114
    v_fmac_f32 v198, v11, v115
    v_fmac_f32 v198, v12, v116
    v_fmac_f32 v198, v13, v117
    v_fmac_f32 v198, v14, v118
    v_fmac_f32 v198, v15, v119
    v_mfma_f32_32x32x16_bf16 v[32:47], v[72:75], v[184:187], v[32:47]
    v_mul_f32_e64 v200, v16, -v160
    v_fma_f32 v200, v17, -v161, v200
    v_fma_f32 v200, v18, -v162, v200
    v_fma_f32 v200, v19, -v163, v200
    v_fma_f32 v200, v20, -v164, v200
    v_fma_f32 v200, v21, -v165, v200
    v_fma_f32 v200, v22, -v166, v200
    v_fma_f32 v200, v23, -v167, v200
    v_mfma_f32_32x32x16_bf16 v[48:63], v[76:79], v[184:187], v[48:63]
    v_mul_f32_e64 v202, v24, -v160
    v_fma_f32 v202, v25, -v161, v202
    v_fma_f32 v202, v26, -v162, v202
    v_fma_f32 v202, v27, -v163, v202
    v_fma_f32 v202, v28, -v164, v202
    v_fma_f32 v202, v29, -v165, v202
    v_fma_f32 v202, v30, -v166, v202
    v_fma_f32 v202, v31, -v167, v202
    s_waitcnt vmcnt(4) lgkmcnt(0)
    v_mfma_f32_32x32x16_bf16 v[0:15], v[64:67], v[176:179], 0
    v_mul_f32 v197, v32, v152
    v_fmac_f32 v197, v33, v153
    v_fmac_f32 v197, v34, v154
    v_fmac_f32 v197, v35, v155
    v_fmac_f32 v197, v36, v156
    v_fmac_f32 v197, v37, v157
    v_fmac_f32 v197, v38, v158
    v_fmac_f32 v197, v39, v159
    s_add_u32 m0, s21, 0
    v_mfma_f32_32x32x16_bf16 v[16:31], v[68:71], v[176:179], 0
    v_lshl_add_u32 v234, v234, 10, v246
    v_lshl_add_u32 v235, v235, 10, v246
    buffer_load_dwordx4 v234, s[4:7], s38 offen  lds
    buffer_load_dwordx4 v235, s[8:11], s38 offen offset:1024  lds
    ds_read_b64_tr_b16 v[176:177], v244 offset:2048
    ds_read_b64_tr_b16 v[178:179], v244 offset:3072
    ds_read_b64_tr_b16 v[184:185], v245 offset:2048
    ds_read_b64_tr_b16 v[186:187], v245 offset:3072
    v_mul_f32 v199, v40, v120
    v_fmac_f32 v199, v41, v121
    v_fmac_f32 v199, v42, v122
    v_fmac_f32 v199, v43, v123
    v_fmac_f32 v199, v44, v124
    v_fmac_f32 v199, v45, v125
    v_fmac_f32 v199, v46, v126
    v_fmac_f32 v199, v47, v127
    s_waitcnt lgkmcnt(0)
    v_mfma_f32_32x32x16_bf16 v[0:15], v[72:75], v[176:179], v[0:15]
    v_mul_f32_e64 v201, v48, -v168
    v_fma_f32 v201, v49, -v169, v201
    v_fma_f32 v201, v50, -v170, v201
    v_fma_f32 v201, v51, -v171, v201
    v_fma_f32 v201, v52, -v172, v201
    v_fma_f32 v201, v53, -v173, v201
    v_fma_f32 v201, v54, -v174, v201
    v_fma_f32 v201, v55, -v175, v201
    s_add_u32 m0, s21, 2048
    v_mfma_f32_32x32x16_bf16 v[16:31], v[76:79], v[176:179], v[16:31]
    v_lshl_add_u32 v236, v236, 10, v246
    v_lshl_add_u32 v237, v237, 10, v246
    buffer_load_dwordx4 v236, s[4:7], s39 offen  lds
    buffer_load_dwordx4 v237, s[8:11], s39 offen offset:1024  lds
    s_mov_b32 m0, s76
    s_mov_b64 exec, s[72:73]
    buffer_load_dwordx4 v254, s[12:15], 0 offen  lds
    s_mov_b32 m0, s77
    s_mov_b64 exec, s[74:75]
    buffer_load_dwordx4 v255, s[12:15], 0 offen  lds
    s_mov_b64 exec, -1
    v_mul_f32_e64 v203, v56, -v168
    v_fma_f32 v203, v57, -v169, v203
    v_fma_f32 v203, v58, -v170, v203
    v_fma_f32 v203, v59, -v171, v203
    v_fma_f32 v203, v60, -v172, v203
    v_fma_f32 v203, v61, -v173, v203
    v_fma_f32 v203, v62, -v174, v203
    v_fma_f32 v203, v63, -v175, v203
    v_mfma_f32_32x32x16_bf16 v[32:47], v[64:67], v[180:183], 0
    v_mul_f32 v254, v0, v144
    v_fmac_f32 v254, v1, v145
    v_fmac_f32 v254, v2, v146
    v_fmac_f32 v254, v3, v147
    v_fmac_f32 v254, v4, v148
    v_mfma_f32_32x32x16_bf16 v[48:63], v[68:71], v[180:183], 0
    ds_swizzle_b32 v68, v68 offset:0x401F
    ds_swizzle_b32 v69, v69 offset:0x401F
    ds_swizzle_b32 v70, v70 offset:0x401F
    ds_swizzle_b32 v71, v71 offset:0x401F
    s_waitcnt vmcnt(8)
    ds_read_b64_tr_b16 v[176:177], v244 offset:4096
    ds_read_b64_tr_b16 v[178:179], v244 offset:5120
    ds_read_b64_tr_b16 v[180:181], v245 offset:4096
    ds_read_b64_tr_b16 v[182:183], v245 offset:5120
    v_fmac_f32 v254, v5, v149
    v_fmac_f32 v254, v6, v150
    v_fmac_f32 v254, v7, v151
    v_fmac_f32 v200, v8, v160
    v_mfma_f32_32x32x16_bf16 v[32:47], v[72:75], v[184:187], v[32:47]
    v_fmac_f32 v200, v9, v161
    v_permlane32_swap_b32 v196, v254
    v_fmac_f32 v200, v10, v162
    v_fmac_f32 v200, v11, v163
    v_fmac_f32 v200, v12, v164
    v_mfma_f32_32x32x16_bf16 v[48:63], v[76:79], v[184:187], v[48:63]
    ds_swizzle_b32 v76, v76 offset:0x401F
    ds_swizzle_b32 v77, v77 offset:0x401F
    ds_swizzle_b32 v78, v78 offset:0x401F
    ds_swizzle_b32 v79, v79 offset:0x401F
    v_fmac_f32 v200, v13, v165
    v_fmac_f32 v200, v14, v166
    v_fmac_f32 v200, v15, v167
    v_add_f32 v254, v196, v254
    s_waitcnt lgkmcnt(8)
    s_mov_b64 exec, s[56:57]
    v_xor_b32 v68, 0x80008000, v68
    v_xor_b32 v69, 0x80008000, v69
    v_xor_b32 v70, 0x80008000, v70
    v_xor_b32 v71, 0x80008000, v71
    s_mov_b64 exec, -1
    s_waitcnt vmcnt(6) lgkmcnt(4)
    v_mfma_f32_32x32x16_bf16 v[0:15], v[64:67], v[176:179], 0
    v_mul_f32 v255, v32, v152
    v_fmac_f32 v255, v33, v153
    v_fmac_f32 v255, v34, v154
    v_fmac_f32 v255, v35, v155
    v_fmac_f32 v255, v36, v156
    v_fmac_f32 v255, v37, v157
    s_add_u32 m0, s21, 4096
    v_mfma_f32_32x32x16_bf16 v[16:31], v[68:71], v[176:179], v[16:31]
    v_lshl_add_u32 v238, v238, 10, v246
    v_lshl_add_u32 v239, v239, 10, v246
    buffer_load_dwordx4 v238, s[4:7], s40 offen  lds
    buffer_load_dwordx4 v239, s[8:11], s40 offen offset:1024  lds
    ds_read_b64_tr_b16 v[176:177], v244 offset:6144
    ds_read_b64_tr_b16 v[178:179], v244 offset:7168
    ds_read_b64_tr_b16 v[184:185], v245 offset:6144
    ds_read_b64_tr_b16 v[186:187], v245 offset:7168
    v_fmac_f32 v255, v38, v158
    v_fmac_f32 v255, v39, v159
    v_fmac_f32 v201, v40, v168
    v_fmac_f32 v201, v41, v169
    v_permlane32_swap_b32 v197, v255
    s_waitcnt lgkmcnt(0)
    s_mov_b64 exec, s[56:57]
    v_xor_b32 v76, 0x80008000, v76
    v_xor_b32 v77, 0x80008000, v77
    v_xor_b32 v78, 0x80008000, v78
    v_xor_b32 v79, 0x80008000, v79
    s_mov_b64 exec, -1
    v_mfma_f32_32x32x16_bf16 v[0:15], v[72:75], v[176:179], v[0:15]
    v_fmac_f32 v201, v42, v170
    v_fmac_f32 v201, v43, v171
    v_fmac_f32 v201, v44, v172
    v_fmac_f32 v201, v45, v173
    v_fmac_f32 v201, v46, v174
    v_fmac_f32 v201, v47, v175
    s_add_u32 m0, s21, 6144
    v_mfma_f32_32x32x16_bf16 v[16:31], v[76:79], v[176:179], v[16:31]
    v_lshl_add_u32 v240, v240, 10, v246
    v_lshl_add_u32 v241, v241, 10, v246
    buffer_load_dwordx4 v240, s[4:7], s41 offen  lds
    buffer_load_dwordx4 v241, s[8:11], s41 offen offset:1024  lds
    v_add_f32 v255, v197, v255
    s_set_gpr_idx_on s51, gpr_idx(DST)
    s_nop 0
    v_cvt_pk_bf16_f32 v206, v254, v255
    s_set_gpr_idx_off
    v_mfma_f32_32x32x16_bf16 v[32:47], v[64:67], v[180:183], 0
    v_mul_f32 v254, v0, v144
    v_fmac_f32 v254, v1, v145
    v_fmac_f32 v254, v2, v146
    v_fmac_f32 v254, v3, v147
    v_fmac_f32 v254, v4, v148
    v_fmac_f32 v254, v5, v149
    v_fmac_f32 v254, v6, v150
    v_fmac_f32 v254, v7, v151
    v_fma_f32 v202, v8, -v160, v202
    v_fma_f32 v202, v9, -v161, v202
    v_mfma_f32_32x32x16_bf16 v[48:63], v[68:71], v[180:183], v[48:63]
    s_waitcnt vmcnt(8)
    ds_read_b64_tr_b16 v[176:177], v244 offset:0
    ds_read_b64_tr_b16 v[178:179], v244 offset:1024
    ds_read_b64_tr_b16 v[180:181], v245 offset:0
    ds_read_b64_tr_b16 v[182:183], v245 offset:1024
    v_permlane32_swap_b32 v254, v200
    v_fma_f32 v202, v10, -v162, v202
    v_fma_f32 v202, v11, -v163, v202
    v_fma_f32 v202, v12, -v164, v202
    v_fma_f32 v202, v13, -v165, v202
    v_fma_f32 v202, v14, -v166, v202
    v_fma_f32 v202, v15, -v167, v202
    v_add_f32 v200, v254, v200
    v_fmac_f32 v198, v16, v112
    v_permlane32_swap_b32 v202, v254
    v_mfma_f32_32x32x16_bf16 v[32:47], v[72:75], v[184:187], v[32:47]
    v_fmac_f32 v198, v17, v113
    v_fmac_f32 v198, v18, v114
    v_fmac_f32 v198, v19, v115
    v_fmac_f32 v198, v20, v116
    v_fmac_f32 v198, v21, v117
    v_fmac_f32 v198, v22, v118
    v_fmac_f32 v198, v23, v119
    v_add_f32 v254, v202, v254
    v_mul_f32 v196, v24, v160
    v_fmac_f32 v196, v25, v161
    v_mfma_f32_32x32x16_bf16 v[48:63], v[76:79], v[184:187], v[48:63]
    v_add_u32 v249, s48, v249
    v_add_u32 v250, s49, v250
    s_waitcnt vmcnt(4)
    ds_read_b64_tr_b16 v[64:65], v249 offset:0
    ds_read_b64_tr_b16 v[68:69], v249 offset:64
    ds_read_b64_tr_b16 v[66:67], v249 offset:256
    ds_read_b64_tr_b16 v[70:71], v249 offset:320
    s_mov_b64 exec, s[54:55]
    ds_read_u16_d16_hi v242, v250 offset:0
    s_mov_b64 exec, -1
    v_fmac_f32 v196, v26, v162
    v_fmac_f32 v196, v27, v163
    v_fmac_f32 v196, v28, v164
    v_fmac_f32 v196, v29, v165
    v_fmac_f32 v196, v30, v166
    v_fmac_f32 v196, v31, v167
    s_nop 1
    v_permlane32_swap_b32 v198, v196
    v_add_f32 v196, v198, v196
    v_mul_f32 v255, v32, v152
    v_fmac_f32 v255, v33, v153
    v_fmac_f32 v255, v34, v154
    v_fmac_f32 v255, v35, v155
    v_fmac_f32 v255, v36, v156
    v_fmac_f32 v255, v37, v157
    v_fmac_f32 v255, v38, v158
    v_fmac_f32 v255, v39, v159
    v_fma_f32 v203, v40, -v168, v203
    v_fma_f32 v203, v41, -v169, v203
    v_permlane32_swap_b32 v255, v201
    v_fma_f32 v203, v42, -v170, v203
    v_fma_f32 v203, v43, -v171, v203
    v_fma_f32 v203, v44, -v172, v203
    v_fma_f32 v203, v45, -v173, v203
    v_fma_f32 v203, v46, -v174, v203
    v_fma_f32 v203, v47, -v175, v203
    v_add_f32 v201, v255, v201
    v_fmac_f32 v199, v48, v120
    v_permlane32_swap_b32 v203, v255
    v_fmac_f32 v199, v49, v121
    v_fmac_f32 v199, v50, v122
    v_fmac_f32 v199, v51, v123
    v_fmac_f32 v199, v52, v124
    v_fmac_f32 v199, v53, v125
    v_fmac_f32 v199, v54, v126
    v_fmac_f32 v199, v55, v127
    v_add_f32 v255, v203, v255
    v_mul_f32 v197, v56, v168
    v_fmac_f32 v197, v57, v169
    v_fmac_f32 v197, v58, v170
    v_fmac_f32 v197, v59, v171
    v_fmac_f32 v197, v60, v172
    v_fmac_f32 v197, v61, v173
    v_fmac_f32 v197, v62, v174
    v_fmac_f32 v197, v63, v175
    s_nop 1
    v_permlane32_swap_b32 v199, v197
    v_add_f32 v197, v199, v197
    s_set_gpr_idx_on s51, gpr_idx(DST)
    s_nop 0
    v_cvt_pk_bf16_f32 v207, v200, v201
    v_cvt_pk_bf16_f32 v209, v254, v255
    v_cvt_pk_bf16_f32 v208, v196, v197
    s_set_gpr_idx_off
    s_add_u32 s50, s50, 1
    s_add_u32 s51, s51, 6
    s_cmp_ge_u32 s50, 4
    s_cbranch_scc1 LAST0
    s_add_u32 s53, s53, 4
    s_xor_b32 s66, s53, s20
    s_bitcmp1_b32 s66, 2
    s_setprio 1
    s_cbranch_scc1 PRIO_5
    s_setprio 0
PRIO_5:
    s_cmp_eq_u32 s52, 4
    s_cbranch_scc1 ITEM_0_4
    s_cmp_eq_u32 s52, 5
    s_cbranch_scc1 ITEM_0_5
    s_cmp_eq_u32 s52, 3
    s_cbranch_scc1 ITEM_0_3
    s_cmp_eq_u32 s52, 6
    s_cbranch_scc1 ITEM_0_6
    s_cmp_eq_u32 s52, 8
    s_cbranch_scc1 ITEM_0_8
    s_branch ITEM_0_2
.p2align 6
ITEM_0_5:
    s_mov_b64 exec, s[54:55]
    ds_read_u16_d16_hi v243, v250 offset:128
    s_mov_b64 exec, -1
    ds_read_b64_tr_b16 v[72:73], v249 offset:512
    ds_read_b64_tr_b16 v[76:77], v249 offset:576
    ds_read_b64_tr_b16 v[74:75], v249 offset:768
    ds_read_b64_tr_b16 v[78:79], v249 offset:832
    ds_read_b64_tr_b16 v[80:81], v249 offset:1024
    ds_read_b64_tr_b16 v[84:85], v249 offset:1088
    s_waitcnt lgkmcnt(7)
    v_mul_f32_dpp v196, v242, v64 row_newbcast:0 row_mask:0xf bank_mask:0xf
    v_mul_f32_dpp v197, v242, v65 row_newbcast:1 row_mask:0xf bank_mask:0xf
    v_mul_f32_dpp v198, v242, v64 row_newbcast:8 row_mask:0xf bank_mask:0xf
    v_mul_f32_dpp v199, v242, v65 row_newbcast:9 row_mask:0xf bank_mask:0xf
    v_mul_f32_dpp v200, v242, v68 row_newbcast:2 row_mask:0xf bank_mask:0xf
    v_mul_f32_dpp v201, v242, v69 row_newbcast:3 row_mask:0xf bank_mask:0xf
    v_mul_f32_dpp v202, v242, v68 row_newbcast:10 row_mask:0xf bank_mask:0xf
    v_mul_f32_dpp v203, v242, v69 row_newbcast:11 row_mask:0xf bank_mask:0xf
    v_cvt_pk_bf16_f32 v64, v196, v197
    v_cvt_pk_bf16_f32 v68, v198, v199
    v_cvt_pk_bf16_f32 v65, v200, v201
    v_cvt_pk_bf16_f32 v69, v202, v203
    v_mul_f32_dpp v196, v242, v66 row_newbcast:4 row_mask:0xf bank_mask:0xf
    v_mul_f32_dpp v197, v242, v67 row_newbcast:5 row_mask:0xf bank_mask:0xf
    v_mul_f32_dpp v198, v242, v66 row_newbcast:12 row_mask:0xf bank_mask:0xf
    v_mul_f32_dpp v199, v242, v67 row_newbcast:13 row_mask:0xf bank_mask:0xf
    v_mul_f32_dpp v200, v242, v70 row_newbcast:6 row_mask:0xf bank_mask:0xf
    v_mul_f32_dpp v201, v242, v71 row_newbcast:7 row_mask:0xf bank_mask:0xf
    v_mul_f32_dpp v202, v242, v70 row_newbcast:14 row_mask:0xf bank_mask:0xf
    v_mul_f32_dpp v203, v242, v71 row_newbcast:15 row_mask:0xf bank_mask:0xf
    v_cvt_pk_bf16_f32 v66, v196, v197
    v_cvt_pk_bf16_f32 v70, v198, v199
    v_cvt_pk_bf16_f32 v67, v200, v201
    v_cvt_pk_bf16_f32 v71, v202, v203
    s_mov_b64 exec, s[54:55]
    ds_read_u16_d16_hi v242, v250 offset:256
    s_mov_b64 exec, -1
    s_waitcnt vmcnt(4) lgkmcnt(3)
    v_mfma_f32_32x32x16_bf16 v[0:15], v[64:67], v[176:179], 0
    v_mul_f32_dpp v196, v243, v72 row_newbcast:0 row_mask:0xf bank_mask:0xf
    v_mul_f32_dpp v197, v243, v73 row_newbcast:1 row_mask:0xf bank_mask:0xf
    v_mul_f32_dpp v198, v243, v72 row_newbcast:8 row_mask:0xf bank_mask:0xf
    v_mul_f32_dpp v199, v243, v73 row_newbcast:9 row_mask:0xf bank_mask:0xf
    v_mul_f32_dpp v200, v243, v76 row_newbcast:2 row_mask:0xf bank_mask:0xf
    v_mul_f32_dpp v201, v243, v77 row_newbcast:3 row_mask:0xf bank_mask:0xf
    v_mul_f32_dpp v202, v243, v76 row_newbcast:10 row_mask:0xf bank_mask:0xf
    v_mul_f32_dpp v203, v243, v77 row_newbcast:11 row_mask:0xf bank_mask:0xf
    v_cvt_pk_bf16_f32 v72, v196, v197
    v_cvt_pk_bf16_f32 v76, v198, v199
    v_cvt_pk_bf16_f32 v73, v200, v201
    v_cvt_pk_bf16_f32 v77, v202, v203
    s_add_u32 m0, s21, 0
    v_mfma_f32_32x32x16_bf16 v[16:31], v[68:71], v[176:179], 0
    buffer_load_dwordx4 v236, s[4:7], s35 offen  lds
    buffer_load_dwordx4 v237, s[8:11], s35 offen offset:1024  lds
    ds_read_b64_tr_b16 v[176:177], v244 offset:2048
    ds_read_b64_tr_b16 v[178:179], v244 offset:3072
    ds_read_b64_tr_b16 v[184:185], v245 offset:2048
    ds_read_b64_tr_b16 v[186:187], v245 offset:3072
    v_mul_f32_dpp v196, v243, v74 row_newbcast:4 row_mask:0xf bank_mask:0xf
    v_mul_f32_dpp v197, v243, v75 row_newbcast:5 row_mask:0xf bank_mask:0xf
    v_mul_f32_dpp v198, v243, v74 row_newbcast:12 row_mask:0xf bank_mask:0xf
    v_mul_f32_dpp v199, v243, v75 row_newbcast:13 row_mask:0xf bank_mask:0xf
    v_mul_f32_dpp v200, v243, v78 row_newbcast:6 row_mask:0xf bank_mask:0xf
    v_mul_f32_dpp v201, v243, v79 row_newbcast:7 row_mask:0xf bank_mask:0xf
    v_mul_f32_dpp v202, v243, v78 row_newbcast:14 row_mask:0xf bank_mask:0xf
    v_mul_f32_dpp v203, v243, v79 row_newbcast:15 row_mask:0xf bank_mask:0xf
    v_cvt_pk_bf16_f32 v74, v196, v197
    v_cvt_pk_bf16_f32 v78, v198, v199
    v_cvt_pk_bf16_f32 v75, v200, v201
    v_cvt_pk_bf16_f32 v79, v202, v203
    s_nop 0
    s_waitcnt vmcnt(4) lgkmcnt(0)
    v_mfma_f32_32x32x16_bf16 v[0:15], v[72:75], v[176:179], v[0:15]
    v_mul_f32_dpp v196, v242, v80 row_newbcast:0 row_mask:0xf bank_mask:0xf
    v_mul_f32_dpp v197, v242, v81 row_newbcast:1 row_mask:0xf bank_mask:0xf
    v_mul_f32_dpp v198, v242, v80 row_newbcast:8 row_mask:0xf bank_mask:0xf
    v_mul_f32_dpp v199, v242, v81 row_newbcast:9 row_mask:0xf bank_mask:0xf
    v_mul_f32_dpp v200, v242, v84 row_newbcast:2 row_mask:0xf bank_mask:0xf
    v_mul_f32_dpp v201, v242, v85 row_newbcast:3 row_mask:0xf bank_mask:0xf
    s_add_u32 m0, s21, 2048
    v_mfma_f32_32x32x16_bf16 v[16:31], v[76:79], v[176:179], v[16:31]
    buffer_load_dwordx4 v238, s[4:7], s35 offen  lds
    ds_read_b64_tr_b16 v[176:177], v244 offset:4096
    ds_read_b64_tr_b16 v[188:189], v245 offset:4096
    v_mul_f32_dpp v202, v242, v84 row_newbcast:10 row_mask:0xf bank_mask:0xf
    v_mul_f32_dpp v203, v242, v85 row_newbcast:11 row_mask:0xf bank_mask:0xf
    v_cvt_pk_bf16_f32 v80, v196, v197
    v_cvt_pk_bf16_f32 v84, v198, v199
    v_cvt_pk_bf16_f32 v81, v200, v201
    v_cvt_pk_bf16_f32 v85, v202, v203
    s_nop 0
    s_waitcnt lgkmcnt(0)
    v_mfma_f32_32x32x8_bf16 v[0:15], v[80:81], v[176:177], v[0:15]
    s_add_u32 m0, s21, 4096
    v_mfma_f32_32x32x8_bf16 v[16:31], v[84:85], v[176:177], v[16:31]
    buffer_load_dwordx4 v234, s[4:7], s36 offen  lds
    buffer_load_dwordx4 v235, s[8:11], s36 offen offset:1024  lds
    s_mov_b32 m0, s50
    s_nop 0
    s_movrels_b32 s71, s23
    s_bfe_u32 s46, s71, 0x30012
    s_mov_b32 m0, s46
    s_and_b32 s66, s71, 0x3ffff
    s_movrels_b32 s68, s57
    s_movrels_b32 s69, s61
    s_sub_u32 s48, s66, s47
    s_mov_b32 s47, s66
    s_lshr_b32 s52, s71, 28
    s_lshl_b32 s67, s46, 9
    s_add_u32 s66, s66, s67
    s_sub_u32 s49, s66, s42
    s_mov_b32 s42, s66
    s_bfe_u32 s66, s68, 655360
    s_add_u32 s43, s42, s66
    s_bfe_u32 s39, s69, 655360
    s_bfe_u32 s66, s68, 655370
    s_add_u32 s44, s42, s66
    s_bfe_u32 s40, s69, 655370
    s_bfe_u32 s66, s68, 655380
    s_add_u32 s45, s42, s66
    s_bfe_u32 s41, s69, 655380
    s_and_b32 s66, s46, s33
    s_cselect_b32 s72, -1, 1
    s_cselect_b32 s76, s47, 163712
    s_cmp_ge_u32 s66, 2
    s_cselect_b32 s73, -1, 0
    s_add_u32 s77, s47, 1024
    s_cmp_ge_u32 s66, 4
    s_cselect_b32 s75, -1, 0
    s_cmp_ge_u32 s66, 3
    s_cselect_b32 s74, -1, 1
    s_cselect_b32 s77, s77, 163712
    v_add_u32 v252, s45, v247
    ds_read_u16 v240, v252
    ds_read_u16 v241, v252 offset:64
    v_mfma_f32_32x32x16_bf16 v[32:47], v[64:67], v[180:183], 0
    v_mul_f32 v196, v0, v96
    v_fmac_f32 v196, v1, v97
    v_fmac_f32 v196, v2, v98
    v_fmac_f32 v196, v3, v99
    v_fmac_f32 v196, v4, v100
    v_fmac_f32 v196, v5, v101
    v_fmac_f32 v196, v6, v102
    v_mfma_f32_32x32x16_bf16 v[48:63], v[68:71], v[180:183], 0
    v_fmac_f32 v196, v7, v103
    v_mul_f32 v198, v8, v128
    v_fmac_f32 v198, v9, v129
    v_fmac_f32 v198, v10, v130
    v_fmac_f32 v198, v11, v131
    v_fmac_f32 v198, v12, v132
    v_mfma_f32_32x32x16_bf16 v[32:47], v[72:75], v[184:187], v[32:47]
    v_fmac_f32 v198, v13, v133
    v_fmac_f32 v198, v14, v134
    v_fmac_f32 v198, v15, v135
    v_mul_f32 v200, v16, v128
    v_fmac_f32 v200, v17, v129
    v_permlane32_swap_b32 v196, v198
    v_mfma_f32_32x32x16_bf16 v[48:63], v[76:79], v[184:187], v[48:63]
    s_waitcnt vmcnt(5)
    ds_read_b64_tr_b16 v[176:177], v244 offset:6144
    ds_read_b64_tr_b16 v[178:179], v244 offset:7168
    ds_read_b64_tr_b16 v[180:181], v245 offset:6144
    ds_read_b64_tr_b16 v[182:183], v245 offset:7168
    v_fmac_f32 v200, v18, v130
    v_fmac_f32 v200, v19, v131
    v_fmac_f32 v200, v20, v132
    v_fmac_f32 v200, v21, v133
    v_fmac_f32 v200, v22, v134
    v_fmac_f32 v200, v23, v135
    v_mfma_f32_32x32x8_bf16 v[32:47], v[80:81], v[188:189], v[32:47]
    v_add_f32 v198, v196, v198
    v_mul_f32_e64 v202, v24, -v128
    v_fma_f32 v202, v25, -v129, v202
    v_fma_f32 v202, v26, -v130, v202
    v_fma_f32 v202, v27, -v131, v202
    v_fma_f32 v202, v28, -v132, v202
    v_mfma_f32_32x32x8_bf16 v[48:63], v[84:85], v[188:189], v[48:63]
    v_fma_f32 v202, v29, -v133, v202
    v_fma_f32 v202, v30, -v134, v202
    v_fma_f32 v202, v31, -v135, v202
    s_nop 1
    v_permlane32_swap_b32 v200, v202
    v_add_f32 v202, v200, v202
    s_waitcnt vmcnt(3) lgkmcnt(0)
    v_mfma_f32_32x32x16_bf16 v[0:15], v[64:67], v[176:179], 0
    v_mul_f32 v197, v32, v104
    v_fmac_f32 v197, v33, v105
    v_fmac_f32 v197, v34, v106
    v_fmac_f32 v197, v35, v107
    v_fmac_f32 v197, v36, v108
    v_fmac_f32 v197, v37, v109
    v_fmac_f32 v197, v38, v110
    s_add_u32 m0, s21, 6144
    v_mfma_f32_32x32x16_bf16 v[16:31], v[68:71], v[176:179], 0
    buffer_load_dwordx4 v236, s[4:7], s36 offen  lds
    buffer_load_dwordx4 v237, s[8:11], s36 offen offset:1024  lds
    ds_read_b64_tr_b16 v[176:177], v244 offset:0
    ds_read_b64_tr_b16 v[178:179], v244 offset:1024
    ds_read_b64_tr_b16 v[184:185], v245 offset:0
    ds_read_b64_tr_b16 v[186:187], v245 offset:1024
    v_fmac_f32 v197, v39, v111
    v_mul_f32 v199, v40, v136
    v_fmac_f32 v199, v41, v137
    v_fmac_f32 v199, v42, v138
    v_fmac_f32 v199, v43, v139
    v_fmac_f32 v199, v44, v140
    v_fmac_f32 v199, v45, v141
    s_waitcnt vmcnt(4) lgkmcnt(0)
    v_mfma_f32_32x32x16_bf16 v[0:15], v[72:75], v[176:179], v[0:15]
    v_fmac_f32 v199, v46, v142
    v_fmac_f32 v199, v47, v143
    v_mul_f32 v201, v48, v136
    v_fmac_f32 v201, v49, v137
    v_permlane32_swap_b32 v197, v199
    v_fmac_f32 v201, v50, v138
    v_fmac_f32 v201, v51, v139
    s_add_u32 m0, s21, 0
    v_mfma_f32_32x32x16_bf16 v[16:31], v[76:79], v[176:179], v[16:31]
    buffer_load_dwordx4 v238, s[4:7], s36 offen  lds
    ds_read_b64_tr_b16 v[176:177], v244 offset:2048
    ds_read_b64_tr_b16 v[188:189], v245 offset:2048
    v_fmac_f32 v201, v52, v140
    v_fmac_f32 v201, v53, v141
    v_fmac_f32 v201, v54, v142
    v_fmac_f32 v201, v55, v143
    v_add_f32 v199, v197, v199
    v_mul_f32_e64 v203, v56, -v136
    v_fma_f32 v203, v57, -v137, v203
    s_waitcnt lgkmcnt(0)
    v_mfma_f32_32x32x8_bf16 v[0:15], v[80:81], v[176:177], v[0:15]
    v_fma_f32 v203, v58, -v138, v203
    v_fma_f32 v203, v59, -v139, v203
    v_fma_f32 v203, v60, -v140, v203
    v_fma_f32 v203, v61, -v141, v203
    v_fma_f32 v203, v62, -v142, v203
    v_fma_f32 v203, v63, -v143, v203
    s_nop 1
    s_add_u32 m0, s21, 2048
    v_mfma_f32_32x32x8_bf16 v[16:31], v[84:85], v[176:177], v[16:31]
    buffer_load_dwordx4 v234, s[4:7], s37 offen  lds
    buffer_load_dwordx4 v235, s[8:11], s37 offen offset:1024  lds
    v_add_u32 v252, s42, v247
    ds_read_u16 v234, v252
    ds_read_u16 v235, v252 offset:64
    v_permlane32_swap_b32 v201, v203
    v_add_f32 v203, v201, v203
    s_set_gpr_idx_on s51, gpr_idx(DST)
    s_nop 0
    v_cvt_pk_bf16_f32 v204, v198, v199
    v_cvt_pk_bf16_f32 v205, v202, v203
    s_set_gpr_idx_off
    v_mfma_f32_32x32x16_bf16 v[32:47], v[64:67], v[180:183], 0
    v_mul_f32 v196, v0, v144
    v_fmac_f32 v196, v1, v145
    v_fmac_f32 v196, v2, v146
    v_fmac_f32 v196, v3, v147
    v_fmac_f32 v196, v4, v148
    v_fmac_f32 v196, v5, v149
    v_mfma_f32_32x32x16_bf16 v[48:63], v[68:71], v[180:183], 0
    v_add_u32 v253, s47, v248
    ds_read_b32 v254, v253
    ds_read_b32 v255, v253 offset:256
    v_fmac_f32 v196, v6, v150
    v_fmac_f32 v196, v7, v151
    v_mul_f32 v198, v8, v112
    v_fmac_f32 v198, v9, v113
    v_fmac_f32 v198, v10, v114
    v_mfma_f32_32x32x16_bf16 v[32:47], v[72:75], v[184:187], v[32:47]
    v_fmac_f32 v198, v11, v115
    v_fmac_f32 v198, v12, v116
    v_fmac_f32 v198, v13, v117
    v_fmac_f32 v198, v14, v118
    v_fmac_f32 v198, v15, v119
    v_mfma_f32_32x32x16_bf16 v[48:63], v[76:79], v[184:187], v[48:63]
    s_waitcnt vmcnt(5)
    ds_read_b64_tr_b16 v[176:177], v244 offset:4096
    ds_read_b64_tr_b16 v[178:179], v244 offset:5120
    ds_read_b64_tr_b16 v[180:181], v245 offset:4096
    ds_read_b64_tr_b16 v[182:183], v245 offset:5120
    v_mul_f32_e64 v200, v16, -v160
    v_fma_f32 v200, v17, -v161, v200
    v_fma_f32 v200, v18, -v162, v200
    v_fma_f32 v200, v19, -v163, v200
    v_fma_f32 v200, v20, -v164, v200
    v_fma_f32 v200, v21, -v165, v200
    v_mfma_f32_32x32x8_bf16 v[32:47], v[80:81], v[188:189], v[32:47]
    v_fma_f32 v200, v22, -v166, v200
    v_fma_f32 v200, v23, -v167, v200
    v_mul_f32_e64 v202, v24, -v160
    v_fma_f32 v202, v25, -v161, v202
    v_fma_f32 v202, v26, -v162, v202
    v_mfma_f32_32x32x8_bf16 v[48:63], v[84:85], v[188:189], v[48:63]
    v_fma_f32 v202, v27, -v163, v202
    v_fma_f32 v202, v28, -v164, v202
    v_fma_f32 v202, v29, -v165, v202
    v_fma_f32 v202, v30, -v166, v202
    v_fma_f32 v202, v31, -v167, v202
    s_waitcnt vmcnt(3) lgkmcnt(0)
    v_mfma_f32_32x32x16_bf16 v[0:15], v[64:67], v[176:179], 0
    v_mul_f32 v197, v32, v152
    v_fmac_f32 v197, v33, v153
    v_fmac_f32 v197, v34, v154
    v_fmac_f32 v197, v35, v155
    v_fmac_f32 v197, v36, v156
    v_fmac_f32 v197, v37, v157
    s_add_u32 m0, s21, 4096
    v_mfma_f32_32x32x16_bf16 v[16:31], v[68:71], v[176:179], 0
    buffer_load_dwordx4 v236, s[4:7], s37 offen  lds
    buffer_load_dwordx4 v237, s[8:11], s37 offen offset:1024  lds
    ds_read_b64_tr_b16 v[176:177], v244 offset:6144
    ds_read_b64_tr_b16 v[178:179], v244 offset:7168
    ds_read_b64_tr_b16 v[184:185], v245 offset:6144
    ds_read_b64_tr_b16 v[186:187], v245 offset:7168
    v_add_u32 v252, s43, v247
    ds_read_u16 v236, v252
    ds_read_u16 v237, v252 offset:64
    v_fmac_f32 v197, v38, v158
    v_fmac_f32 v197, v39, v159
    v_mul_f32 v199, v40, v120
    v_fmac_f32 v199, v41, v121
    v_fmac_f32 v199, v42, v122
    s_waitcnt vmcnt(4) lgkmcnt(2)
    v_mfma_f32_32x32x16_bf16 v[0:15], v[72:75], v[176:179], v[0:15]
    v_fmac_f32 v199, v43, v123
    v_fmac_f32 v199, v44, v124
    v_fmac_f32 v199, v45, v125
    v_fmac_f32 v199, v46, v126
    v_fmac_f32 v199, v47, v127
    s_add_u32 m0, s21, 6144
    v_mfma_f32_32x32x16_bf16 v[16:31], v[76:79], v[176:179], v[16:31]
    buffer_load_dwordx4 v238, s[4:7], s37 offen  lds
    ds_read_b64_tr_b16 v[176:177], v244 offset:0
    ds_read_b64_tr_b16 v[188:189], v245 offset:0
    v_add_u32 v252, s44, v247
    ds_read_u16 v238, v252
    ds_read_u16 v239, v252 offset:64
    v_mul_f32_e64 v201, v48, -v168
    v_fma_f32 v201, v49, -v169, v201
    v_fma_f32 v201, v50, -v170, v201
    v_fma_f32 v201, v51, -v171, v201
    v_fma_f32 v201, v52, -v172, v201
    v_fma_f32 v201, v53, -v173, v201
    s_waitcnt lgkmcnt(2)
    v_mfma_f32_32x32x8_bf16 v[0:15], v[80:81], v[176:177], v[0:15]
    v_fma_f32 v201, v54, -v174, v201
    v_fma_f32 v201, v55, -v175, v201
    v_mul_f32_e64 v203, v56, -v168
    v_fma_f32 v203, v57, -v169, v203
    v_fma_f32 v203, v58, -v170, v203
    s_add_u32 m0, s21, 0
    v_mfma_f32_32x32x8_bf16 v[16:31], v[84:85], v[176:177], v[16:31]
    v_lshl_add_u32 v234, v234, 10, v246
    v_lshl_add_u32 v235, v235, 10, v246
    buffer_load_dwordx4 v234, s[4:7], s38 offen  lds
    buffer_load_dwordx4 v235, s[8:11], s38 offen offset:1024  lds
    s_mov_b32 m0, s76
    s_mov_b64 exec, s[72:73]
    buffer_load_dwordx4 v254, s[12:15], 0 offen  lds
    s_mov_b32 m0, s77
    s_mov_b64 exec, s[74:75]
    buffer_load_dwordx4 v255, s[12:15], 0 offen  lds
    s_mov_b64 exec, -1
    v_fma_f32 v203, v59, -v171, v203
    v_fma_f32 v203, v60, -v172, v203
    v_fma_f32 v203, v61, -v173, v203
    v_fma_f32 v203, v62, -v174, v203
    v_fma_f32 v203, v63, -v175, v203
    v_mfma_f32_32x32x16_bf16 v[32:47], v[64:67], v[180:183], 0
    v_mul_f32 v254, v0, v144
    v_fmac_f32 v254, v1, v145
    v_fmac_f32 v254, v2, v146
    v_mfma_f32_32x32x16_bf16 v[48:63], v[68:71], v[180:183], 0
    ds_swizzle_b32 v68, v68 offset:0x401F
    ds_swizzle_b32 v69, v69 offset:0x401F
    ds_swizzle_b32 v70, v70 offset:0x401F
    ds_swizzle_b32 v71, v71 offset:0x401F
    v_fmac_f32 v254, v3, v147
    v_fmac_f32 v254, v4, v148
    v_fmac_f32 v254, v5, v149
    v_mfma_f32_32x32x16_bf16 v[32:47], v[72:75], v[184:187], v[32:47]
    v_fmac_f32 v254, v6, v150
    v_fmac_f32 v254, v7, v151
    v_fmac_f32 v200, v8, v160
    v_mfma_f32_32x32x16_bf16 v[48:63], v[76:79], v[184:187], v[48:63]
    ds_swizzle_b32 v76, v76 offset:0x401F
    ds_swizzle_b32 v77, v77 offset:0x401F
    ds_swizzle_b32 v78, v78 offset:0x401F
    ds_swizzle_b32 v79, v79 offset:0x401F
    s_waitcnt vmcnt(7)
    ds_read_b64_tr_b16 v[176:177], v244 offset:2048
    ds_read_b64_tr_b16 v[178:179], v244 offset:3072
    ds_read_b64_tr_b16 v[180:181], v245 offset:2048
    ds_read_b64_tr_b16 v[182:183], v245 offset:3072
    v_fmac_f32 v200, v9, v161
    v_permlane32_swap_b32 v196, v254
    v_fmac_f32 v200, v10, v162
    v_mfma_f32_32x32x8_bf16 v[32:47], v[80:81], v[188:189], v[32:47]
    v_fmac_f32 v200, v11, v163
    v_fmac_f32 v200, v12, v164
    v_fmac_f32 v200, v13, v165
    v_mfma_f32_32x32x8_bf16 v[48:63], v[84:85], v[188:189], v[48:63]
    ds_swizzle_b32 v84, v84 offset:0x401F
    ds_swizzle_b32 v85, v85 offset:0x401F
    v_fmac_f32 v200, v14, v166
    v_fmac_f32 v200, v15, v167
    v_add_f32 v254, v196, v254
    s_waitcnt lgkmcnt(6)
    s_mov_b64 exec, s[56:57]
    v_xor_b32 v68, 0x80008000, v68
    v_xor_b32 v69, 0x80008000, v69
    v_xor_b32 v70, 0x80008000, v70
    v_xor_b32 v71, 0x80008000, v71
    v_xor_b32 v76, 0x80008000, v76
    v_xor_b32 v77, 0x80008000, v77
    v_xor_b32 v78, 0x80008000, v78
    v_xor_b32 v79, 0x80008000, v79
    s_mov_b64 exec, -1
    s_waitcnt vmcnt(5) lgkmcnt(2)
    v_mfma_f32_32x32x16_bf16 v[0:15], v[64:67], v[176:179], 0
    v_mul_f32 v255, v32, v152
    v_fmac_f32 v255, v33, v153
    v_fmac_f32 v255, v34, v154
    v_fmac_f32 v255, v35, v155
    s_add_u32 m0, s21, 2048
    v_mfma_f32_32x32x16_bf16 v[16:31], v[68:71], v[176:179], v[16:31]
    v_lshl_add_u32 v236, v236, 10, v246
    v_lshl_add_u32 v237, v237, 10, v246
    buffer_load_dwordx4 v236, s[4:7], s39 offen  lds
    buffer_load_dwordx4 v237, s[8:11], s39 offen offset:1024  lds
    ds_read_b64_tr_b16 v[176:177], v244 offset:4096
    ds_read_b64_tr_b16 v[178:179], v244 offset:5120
    ds_read_b64_tr_b16 v[184:185], v245 offset:4096
    ds_read_b64_tr_b16 v[186:187], v245 offset:5120
    v_fmac_f32 v255, v36, v156
    v_fmac_f32 v255, v37, v157
    v_fmac_f32 v255, v38, v158
    v_fmac_f32 v255, v39, v159
    s_waitcnt vmcnt(6) lgkmcnt(0)
    v_mfma_f32_32x32x16_bf16 v[0:15], v[72:75], v[176:179], v[0:15]
    v_fmac_f32 v201, v40, v168
    v_fmac_f32 v201, v41, v169
    v_permlane32_swap_b32 v197, v255
    s_add_u32 m0, s21, 4096
    v_mfma_f32_32x32x16_bf16 v[16:31], v[76:79], v[176:179], v[16:31]
    v_lshl_add_u32 v238, v238, 10, v246
    v_lshl_add_u32 v239, v239, 10, v246
    buffer_load_dwordx4 v238, s[4:7], s40 offen  lds
    buffer_load_dwordx4 v239, s[8:11], s40 offen offset:1024  lds
    ds_read_b64_tr_b16 v[176:177], v244 offset:6144
    ds_read_b64_tr_b16 v[188:189], v245 offset:6144
    v_fmac_f32 v201, v42, v170
    v_fmac_f32 v201, v43, v171
    v_fmac_f32 v201, v44, v172
    v_fmac_f32 v201, v45, v173
    s_waitcnt lgkmcnt(0)
    s_mov_b64 exec, s[56:57]
    v_xor_b32 v84, 0x80008000, v84
    v_xor_b32 v85, 0x80008000, v85
    s_mov_b64 exec, -1
    v_mfma_f32_32x32x8_bf16 v[0:15], v[80:81], v[176:177], v[0:15]
    v_fmac_f32 v201, v46, v174
    v_fmac_f32 v201, v47, v175
    v_add_f32 v255, v197, v255
    s_set_gpr_idx_on s51, gpr_idx(DST)
    s_nop 0
    v_cvt_pk_bf16_f32 v206, v254, v255
    s_set_gpr_idx_off
    s_add_u32 m0, s21, 6144
    v_mfma_f32_32x32x8_bf16 v[16:31], v[84:85], v[176:177], v[16:31]
    v_lshl_add_u32 v240, v240, 10, v246
    v_lshl_add_u32 v241, v241, 10, v246
    buffer_load_dwordx4 v240, s[4:7], s41 offen  lds
    buffer_load_dwordx4 v241, s[8:11], s41 offen offset:1024  lds
    v_mfma_f32_32x32x16_bf16 v[32:47], v[64:67], v[180:183], 0
    v_mul_f32 v254, v0, v144
    v_fmac_f32 v254, v1, v145
    v_fmac_f32 v254, v2, v146
    v_fmac_f32 v254, v3, v147
    v_fmac_f32 v254, v4, v148
    v_fmac_f32 v254, v5, v149
    v_fmac_f32 v254, v6, v150
    v_mfma_f32_32x32x16_bf16 v[48:63], v[68:71], v[180:183], v[48:63]
    v_fmac_f32 v254, v7, v151
    v_fma_f32 v202, v8, -v160, v202
    v_fma_f32 v202, v9, -v161, v202
    v_permlane32_swap_b32 v254, v200
    v_fma_f32 v202, v10, -v162, v202
    v_fma_f32 v202, v11, -v163, v202
    v_mfma_f32_32x32x16_bf16 v[32:47], v[72:75], v[184:187], v[32:47]
    v_fma_f32 v202, v12, -v164, v202
    v_fma_f32 v202, v13, -v165, v202
    v_fma_f32 v202, v14, -v166, v202
    v_fma_f32 v202, v15, -v167, v202
    v_add_f32 v200, v254, v200
    v_fmac_f32 v198, v16, v112
    v_permlane32_swap_b32 v202, v254
    v_mfma_f32_32x32x16_bf16 v[48:63], v[76:79], v[184:187], v[48:63]
    s_waitcnt vmcnt(8)
    ds_read_b64_tr_b16 v[176:177], v244 offset:0
    ds_read_b64_tr_b16 v[178:179], v244 offset:1024
    ds_read_b64_tr_b16 v[180:181], v245 offset:0
    ds_read_b64_tr_b16 v[182:183], v245 offset:1024
    v_fmac_f32 v198, v17, v113
    v_fmac_f32 v198, v18, v114
    v_fmac_f32 v198, v19, v115
    v_fmac_f32 v198, v20, v116
    v_fmac_f32 v198, v21, v117
    v_fmac_f32 v198, v22, v118
    v_mfma_f32_32x32x8_bf16 v[32:47], v[80:81], v[188:189], v[32:47]
    v_fmac_f32 v198, v23, v119
    v_add_f32 v254, v202, v254
    v_mul_f32 v196, v24, v160
    v_fmac_f32 v196, v25, v161
    v_fmac_f32 v196, v26, v162
    v_fmac_f32 v196, v27, v163
    v_fmac_f32 v196, v28, v164
    v_mfma_f32_32x32x8_bf16 v[48:63], v[84:85], v[188:189], v[48:63]
    v_add_u32 v249, s48, v249
    v_add_u32 v250, s49, v250
    s_waitcnt vmcnt(6)
    ds_read_b64_tr_b16 v[64:65], v249 offset:0
    ds_read_b64_tr_b16 v[68:69], v249 offset:64
    ds_read_b64_tr_b16 v[66:67], v249 offset:256
    ds_read_b64_tr_b16 v[70:71], v249 offset:320
    s_mov_b64 exec, s[54:55]
    ds_read_u16_d16_hi v242, v250 offset:0
    s_mov_b64 exec, -1
    v_fmac_f32 v196, v29, v165
    v_fmac_f32 v196, v30, v166
    v_fmac_f32 v196, v31, v167
    s_nop 1
    v_permlane32_swap_b32 v198, v196
    v_add_f32 v196, v198, v196
    v_mul_f32 v255, v32, v152
    v_fmac_f32 v255, v33, v153
    v_fmac_f32 v255, v34, v154
    v_fmac_f32 v255, v35, v155
    v_fmac_f32 v255, v36, v156
    v_fmac_f32 v255, v37, v157
    v_fmac_f32 v255, v38, v158
    v_fmac_f32 v255, v39, v159
    v_fma_f32 v203, v40, -v168, v203
    v_fma_f32 v203, v41, -v169, v203
    v_permlane32_swap_b32 v255, v201
    v_fma_f32 v203, v42, -v170, v203
    v_fma_f32 v203, v43, -v171, v203
    v_fma_f32 v203, v44, -v172, v203
    v_fma_f32 v203, v45, -v173, v203
    v_fma_f32 v203, v46, -v174, v203
    v_fma_f32 v203, v47, -v175, v203
    v_add_f32 v201, v255, v201
    v_fmac_f32 v199, v48, v120
    v_permlane32_swap_b32 v203, v255
    v_fmac_f32 v199, v49, v121
    v_fmac_f32 v199, v50, v122
    v_fmac_f32 v199, v51, v123
    v_fmac_f32 v199, v52, v124
    v_fmac_f32 v199, v53, v125
    v_fmac_f32 v199, v54, v126
    v_fmac_f32 v199, v55, v127
    v_add_f32 v255, v203, v255
    v_mul_f32 v197, v56, v168
    v_fmac_f32 v197, v57, v169
    v_fmac_f32 v197, v58, v170
    v_fmac_f32 v197, v59, v171
    v_fmac_f32 v197, v60, v172
    v_fmac_f32 v197, v61, v173
    v_fmac_f32 v197, v62, v174
    v_fmac_f32 v197, v63, v175
    s_nop 1
    v_permlane32_swap_b32 v199, v197
    v_add_f32 v197, v199, v197
    s_set_gpr_idx_on s51, gpr_idx(DST)
    s_nop 0
    v_cvt_pk_bf16_f32 v207, v200, v201
    v_cvt_pk_bf16_f32 v209, v254, v255
    v_cvt_pk_bf16_f32 v208, v196, v197
    s_set_gpr_idx_off
    s_add_u32 s50, s50, 1
    s_add_u32 s51, s51, 6
    s_cmp_ge_u32 s50, 4
    s_cbranch_scc1 LAST0
    s_add_u32 s53, s53, 4
    s_xor_b32 s66, s53, s20
    s_bitcmp1_b32 s66, 2
    s_setprio 1
    s_cbranch_scc1 PRIO_6
    s_setprio 0
PRIO_6:
    s_cmp_eq_u32 s52, 4
    s_cbranch_scc1 ITEM_0_4
    s_cmp_eq_u32 s52, 5
    s_cbranch_scc1 ITEM_0_5
    s_cmp_eq_u32 s52, 3
    s_cbranch_scc1 ITEM_0_3
    s_cmp_eq_u32 s52, 6
    s_cbranch_scc1 ITEM_0_6
    s_cmp_eq_u32 s52, 8
    s_cbranch_scc1 ITEM_0_8
    s_branch ITEM_0_2
.p2align 6
ITEM_0_3:
    s_mov_b64 exec, s[54:55]
    ds_read_u16_d16_hi v243, v250 offset:128
    s_mov_b64 exec, -1
    ds_read_b64_tr_b16 v[72:73], v249 offset:512
    ds_read_b64_tr_b16 v[76:77], v249 offset:576
    s_waitcnt lgkmcnt(3)
    v_mul_f32_dpp v196, v242, v64 row_newbcast:0 row_mask:0xf bank_mask:0xf
    v_mul_f32_dpp v197, v242, v65 row_newbcast:1 row_mask:0xf bank_mask:0xf
    v_mul_f32_dpp v198, v242, v64 row_newbcast:8 row_mask:0xf bank_mask:0xf
    v_mul_f32_dpp v199, v242, v65 row_newbcast:9 row_mask:0xf bank_mask:0xf
    v_mul_f32_dpp v200, v242, v68 row_newbcast:2 row_mask:0xf bank_mask:0xf
    v_mul_f32_dpp v201, v242, v69 row_newbcast:3 row_mask:0xf bank_mask:0xf
    v_mul_f32_dpp v202, v242, v68 row_newbcast:10 row_mask:0xf bank_mask:0xf
    v_mul_f32_dpp v203, v242, v69 row_newbcast:11 row_mask:0xf bank_mask:0xf
    v_cvt_pk_bf16_f32 v64, v196, v197
    v_cvt_pk_bf16_f32 v68, v198, v199
    v_cvt_pk_bf16_f32 v65, v200, v201
    v_cvt_pk_bf16_f32 v69, v202, v203
    v_mul_f32_dpp v196, v242, v66 row_newbcast:4 row_mask:0xf bank_mask:0xf
    v_mul_f32_dpp v197, v242, v67 row_newbcast:5 row_mask:0xf bank_mask:0xf
    v_mul_f32_dpp v198, v242, v66 row_newbcast:12 row_mask:0xf bank_mask:0xf
    v_mul_f32_dpp v199, v242, v67 row_newbcast:13 row_mask:0xf bank_mask:0xf
    v_mul_f32_dpp v200, v242, v70 row_newbcast:6 row_mask:0xf bank_mask:0xf
    v_mul_f32_dpp v201, v242, v71 row_newbcast:7 row_mask:0xf bank_mask:0xf
    v_mul_f32_dpp v202, v242, v70 row_newbcast:14 row_mask:0xf bank_mask:0xf
    v_mul_f32_dpp v203, v242, v71 row_newbcast:15 row_mask:0xf bank_mask:0xf
    v_cvt_pk_bf16_f32 v66, v196, v197
    v_cvt_pk_bf16_f32 v70, v198, v199
    v_cvt_pk_bf16_f32 v67, v200, v201
    v_cvt_pk_bf16_f32 v71, v202, v203
    s_nop 0
    s_waitcnt vmcnt(4) lgkmcnt(0)
    v_mfma_f32_32x32x16_bf16 v[0:15], v[64:67], v[176:179], 0
    v_mul_f32_dpp v196, v243, v72 row_newbcast:0 row_mask:0xf bank_mask:0xf
    v_mul_f32_dpp v197, v243, v73 row_newbcast:1 row_mask:0xf bank_mask:0xf
    v_mul_f32_dpp v198, v243, v72 row_newbcast:8 row_mask:0xf bank_mask:0xf
    v_mul_f32_dpp v199, v243, v73 row_newbcast:9 row_mask:0xf bank_mask:0xf
    v_mul_f32_dpp v200, v243, v76 row_newbcast:2 row_mask:0xf bank_mask:0xf
    v_mul_f32_dpp v201, v243, v77 row_newbcast:3 row_mask:0xf bank_mask:0xf
    s_add_u32 m0, s21, 0
    v_mfma_f32_32x32x16_bf16 v[16:31], v[68:71], v[176:179], 0
    buffer_load_dwordx4 v234, s[4:7], s36 offen  lds
    buffer_load_dwordx4 v235, s[8:11], s36 offen offset:1024  lds
    ds_read_b64_tr_b16 v[176:177], v244 offset:2048
    ds_read_b64_tr_b16 v[184:185], v245 offset:2048
    v_mul_f32_dpp v202, v243, v76 row_newbcast:10 row_mask:0xf bank_mask:0xf
    v_mul_f32_dpp v203, v243, v77 row_newbcast:11 row_mask:0xf bank_mask:0xf
    v_cvt_pk_bf16_f32 v72, v196, v197
    v_cvt_pk_bf16_f32 v76, v198, v199
    v_cvt_pk_bf16_f32 v73, v200, v201
    v_cvt_pk_bf16_f32 v77, v202, v203
    s_nop 0
    s_waitcnt lgkmcnt(0)
    v_mfma_f32_32x32x8_bf16 v[0:15], v[72:73], v[176:177], v[0:15]
    s_add_u32 m0, s21, 2048
    v_mfma_f32_32x32x8_bf16 v[16:31], v[76:77], v[176:177], v[16:31]
    buffer_load_dwordx4 v236, s[4:7], s36 offen  lds
    s_mov_b32 m0, s50
    s_nop 0
    s_movrels_b32 s71, s23
    s_bfe_u32 s46, s71, 0x30012
    s_mov_b32 m0, s46
    s_and_b32 s66, s71, 0x3ffff
    s_movrels_b32 s68, s57
    s_movrels_b32 s69, s61
    s_sub_u32 s48, s66, s47
    s_mov_b32 s47, s66
    s_lshr_b32 s52, s71, 28
    s_lshl_b32 s67, s46, 9
    s_add_u32 s66, s66, s67
    s_sub_u32 s49, s66, s42
    s_mov_b32 s42, s66
    s_bfe_u32 s66, s68, 655360
    s_add_u32 s43, s42, s66
    s_bfe_u32 s39, s69, 655360
    s_bfe_u32 s66, s68, 655370
    s_add_u32 s44, s42, s66
    s_bfe_u32 s40, s69, 655370
    s_bfe_u32 s66, s68, 655380
    s_add_u32 s45, s42, s66
    s_bfe_u32 s41, s69, 655380
    s_and_b32 s66, s46, s33
    s_cselect_b32 s72, -1, 1
    s_cselect_b32 s76, s47, 163712
    s_cmp_ge_u32 s66, 2
    s_cselect_b32 s73, -1, 0
    s_add_u32 s77, s47, 1024
    s_cmp_ge_u32 s66, 4
    s_cselect_b32 s75, -1, 0
    s_cmp_ge_u32 s66, 3
    s_cselect_b32 s74, -1, 1
    s_cselect_b32 s77, s77, 163712
    v_add_u32 v252, s44, v247
    ds_read_u16 v238, v252
    ds_read_u16 v239, v252 offset:64
    v_add_u32 v252, s45, v247
    ds_read_u16 v240, v252
    ds_read_u16 v241, v252 offset:64
    v_mfma_f32_32x32x16_bf16 v[32:47], v[64:67], v[180:183], 0
    v_mul_f32 v196, v0, v96
    v_fmac_f32 v196, v1, v97
    v_fmac_f32 v196, v2, v98
    v_fmac_f32 v196, v3, v99
    v_fmac_f32 v196, v4, v100
    v_fmac_f32 v196, v5, v101
    v_fmac_f32 v196, v6, v102
    v_fmac_f32 v196, v7, v103
    v_mul_f32 v198, v8, v128
    v_fmac_f32 v198, v9, v129
    v_mfma_f32_32x32x16_bf16 v[48:63], v[68:71], v[180:183], 0
    s_waitcnt vmcnt(5)
    ds_read_b64_tr_b16 v[176:177], v244 offset:4096
    ds_read_b64_tr_b16 v[178:179], v244 offset:5120
    ds_read_b64_tr_b16 v[180:181], v245 offset:4096
    ds_read_b64_tr_b16 v[182:183], v245 offset:5120
    v_fmac_f32 v198, v10, v130
    v_fmac_f32 v198, v11, v131
    v_fmac_f32 v198, v12, v132
    v_fmac_f32 v198, v13, v133
    v_fmac_f32 v198, v14, v134
    v_fmac_f32 v198, v15, v135
    v_mul_f32 v200, v16, v128
    v_fmac_f32 v200, v17, v129
    v_permlane32_swap_b32 v196, v198
    v_mfma_f32_32x32x8_bf16 v[32:47], v[72:73], v[184:185], v[32:47]
    v_fmac_f32 v200, v18, v130
    v_fmac_f32 v200, v19, v131
    v_fmac_f32 v200, v20, v132
    v_fmac_f32 v200, v21, v133
    v_fmac_f32 v200, v22, v134
    v_fmac_f32 v200, v23, v135
    v_add_f32 v198, v196, v198
    v_mul_f32_e64 v202, v24, -v128
    v_fma_f32 v202, v25, -v129, v202
    v_mfma_f32_32x32x8_bf16 v[48:63], v[76:77], v[184:185], v[48:63]
    v_fma_f32 v202, v26, -v130, v202
    v_fma_f32 v202, v27, -v131, v202
    v_fma_f32 v202, v28, -v132, v202
    v_fma_f32 v202, v29, -v133, v202
    v_fma_f32 v202, v30, -v134, v202
    v_fma_f32 v202, v31, -v135, v202
    s_nop 1
    v_permlane32_swap_b32 v200, v202
    v_add_f32 v202, v200, v202
    s_waitcnt vmcnt(3) lgkmcnt(0)
    v_mfma_f32_32x32x16_bf16 v[0:15], v[64:67], v[176:179], 0
    v_mul_f32 v197, v32, v104
    v_fmac_f32 v197, v33, v105
    v_fmac_f32 v197, v34, v106
    v_fmac_f32 v197, v35, v107
    v_fmac_f32 v197, v36, v108
    v_fmac_f32 v197, v37, v109
    v_fmac_f32 v197, v38, v110
    v_fmac_f32 v197, v39, v111
    v_mul_f32 v199, v40, v136
    v_fmac_f32 v199, v41, v137
    v_fmac_f32 v199, v42, v138
    s_add_u32 m0, s21, 4096
    v_mfma_f32_32x32x16_bf16 v[16:31], v[68:71], v[176:179], 0
    buffer_load_dwordx4 v234, s[4:7], s37 offen  lds
    buffer_load_dwordx4 v235, s[8:11], s37 offen offset:1024  lds
    ds_read_b64_tr_b16 v[176:177], v244 offset:6144
    ds_read_b64_tr_b16 v[184:185], v245 offset:6144
    v_add_u32 v252, s42, v247
    ds_read_u16 v234, v252
    ds_read_u16 v235, v252 offset:64
    v_fmac_f32 v199, v43, v139
    v_fmac_f32 v199, v44, v140
    v_fmac_f32 v199, v45, v141
    v_fmac_f32 v199, v46, v142
    v_fmac_f32 v199, v47, v143
    v_mul_f32 v201, v48, v136
    v_fmac_f32 v201, v49, v137
    v_permlane32_swap_b32 v197, v199
    v_fmac_f32 v201, v50, v138
    v_fmac_f32 v201, v51, v139
    s_waitcnt lgkmcnt(2)
    v_mfma_f32_32x32x8_bf16 v[0:15], v[72:73], v[176:177], v[0:15]
    v_fmac_f32 v201, v52, v140
    v_fmac_f32 v201, v53, v141
    v_fmac_f32 v201, v54, v142
    v_fmac_f32 v201, v55, v143
    v_add_f32 v199, v197, v199
    v_mul_f32_e64 v203, v56, -v136
    v_fma_f32 v203, v57, -v137, v203
    v_fma_f32 v203, v58, -v138, v203
    v_fma_f32 v203, v59, -v139, v203
    v_fma_f32 v203, v60, -v140, v203
    v_fma_f32 v203, v61, -v141, v203
    s_add_u32 m0, s21, 6144
    v_mfma_f32_32x32x8_bf16 v[16:31], v[76:77], v[176:177], v[16:31]
    buffer_load_dwordx4 v236, s[4:7], s37 offen  lds
    v_add_u32 v252, s43, v247
    ds_read_u16 v236, v252
    ds_read_u16 v237, v252 offset:64
    v_fma_f32 v203, v62, -v142, v203
    v_fma_f32 v203, v63, -v143, v203
    s_nop 1
    v_permlane32_swap_b32 v201, v203
    v_add_f32 v203, v201, v203
    s_set_gpr_idx_on s51, gpr_idx(DST)
    s_nop 0
    v_cvt_pk_bf16_f32 v204, v198, v199
    v_cvt_pk_bf16_f32 v205, v202, v203
    s_set_gpr_idx_off
    v_mfma_f32_32x32x16_bf16 v[32:47], v[64:67], v[180:183], 0
    v_mul_f32 v196, v0, v144
    v_fmac_f32 v196, v1, v145
    v_fmac_f32 v196, v2, v146
    v_fmac_f32 v196, v3, v147
    v_fmac_f32 v196, v4, v148
    v_fmac_f32 v196, v5, v149
    v_fmac_f32 v196, v6, v150
    v_fmac_f32 v196, v7, v151
    v_mfma_f32_32x32x16_bf16 v[48:63], v[68:71], v[180:183], 0
    v_add_u32 v253, s47, v248
    ds_read_b32 v254, v253
    ds_read_b32 v255, v253 offset:256
    s_waitcnt vmcnt(4)
    ds_read_b64_tr_b16 v[176:177], v244 offset:0
    ds_read_b64_tr_b16 v[178:179], v244 offset:1024
    ds_read_b64_tr_b16 v[180:181], v245 offset:0
    ds_read_b64_tr_b16 v[182:183], v245 offset:1024
    v_mul_f32 v198, v8, v112
    v_fmac_f32 v198, v9, v113
    v_fmac_f32 v198, v10, v114
    v_fmac_f32 v198, v11, v115
    v_fmac_f32 v198, v12, v116
    v_fmac_f32 v198, v13, v117
    v_fmac_f32 v198, v14, v118
    v_fmac_f32 v198, v15, v119
    v_mfma_f32_32x32x8_bf16 v[32:47], v[72:73], v[184:185], v[32:47]
    v_mul_f32_e64 v200, v16, -v160
    v_fma_f32 v200, v17, -v161, v200
    v_fma_f32 v200, v18, -v162, v200
    v_fma_f32 v200, v19, -v163, v200
    v_fma_f32 v200, v20, -v164, v200
    v_fma_f32 v200, v21, -v165, v200
    v_fma_f32 v200, v22, -v166, v200
    v_fma_f32 v200, v23, -v167, v200
    v_mfma_f32_32x32x8_bf16 v[48:63], v[76:77], v[184:185], v[48:63]
    v_mul_f32_e64 v202, v24, -v160
    v_fma_f32 v202, v25, -v161, v202
    v_fma_f32 v202, v26, -v162, v202
    v_fma_f32 v202, v27, -v163, v202
    v_fma_f32 v202, v28, -v164, v202
    v_fma_f32 v202, v29, -v165, v202
    v_fma_f32 v202, v30, -v166, v202
    v_fma_f32 v202, v31, -v167, v202
    s_waitcnt vmcnt(3) lgkmcnt(0)
    v_mfma_f32_32x32x16_bf16 v[0:15], v[64:67], v[176:179], 0
    v_mul_f32 v197, v32, v152
    v_fmac_f32 v197, v33, v153
    v_fmac_f32 v197, v34, v154
    v_fmac_f32 v197, v35, v155
    v_fmac_f32 v197, v36, v156
    v_fmac_f32 v197, v37, v157
    v_fmac_f32 v197, v38, v158
    v_fmac_f32 v197, v39, v159
    s_add_u32 m0, s21, 0
    v_mfma_f32_32x32x16_bf16 v[16:31], v[68:71], v[176:179], 0
    v_lshl_add_u32 v234, v234, 10, v246
    v_lshl_add_u32 v235, v235, 10, v246
    buffer_load_dwordx4 v234, s[4:7], s38 offen  lds
    buffer_load_dwordx4 v235, s[8:11], s38 offen offset:1024  lds
    ds_read_b64_tr_b16 v[176:177], v244 offset:2048
    ds_read_b64_tr_b16 v[184:185], v245 offset:2048
    v_mul_f32 v199, v40, v120
    v_fmac_f32 v199, v41, v121
    v_fmac_f32 v199, v42, v122
    v_fmac_f32 v199, v43, v123
    v_fmac_f32 v199, v44, v124
    v_fmac_f32 v199, v45, v125
    v_fmac_f32 v199, v46, v126
    v_fmac_f32 v199, v47, v127
    s_waitcnt lgkmcnt(0)
    v_mfma_f32_32x32x8_bf16 v[0:15], v[72:73], v[176:177], v[0:15]
    v_mul_f32_e64 v201, v48, -v168
    v_fma_f32 v201, v49, -v169, v201
    v_fma_f32 v201, v50, -v170, v201
    v_fma_f32 v201, v51, -v171, v201
    v_fma_f32 v201, v52, -v172, v201
    v_fma_f32 v201, v53, -v173, v201
    v_fma_f32 v201, v54, -v174, v201
    v_fma_f32 v201, v55, -v175, v201
    s_add_u32 m0, s21, 2048
    v_mfma_f32_32x32x8_bf16 v[16:31], v[76:77], v[176:177], v[16:31]
    v_lshl_add_u32 v236, v236, 10, v246
    v_lshl_add_u32 v237, v237, 10, v246
    buffer_load_dwordx4 v236, s[4:7], s39 offen  lds
    buffer_load_dwordx4 v237, s[8:11], s39 offen offset:1024  lds
    s_mov_b32 m0, s76
    s_mov_b64 exec, s[72:73]
    buffer_load_dwordx4 v254, s[12:15], 0 offen  lds
    s_mov_b32 m0, s77
    s_mov_b64 exec, s[74:75]
    buffer_load_dwordx4 v255, s[12:15], 0 offen  lds
    s_mov_b64 exec, -1
    v_mul_f32_e64 v203, v56, -v168
    v_fma_f32 v203, v57, -v169, v203
    v_fma_f32 v203, v58, -v170, v203
    v_fma_f32 v203, v59, -v171, v203
    v_fma_f32 v203, v60, -v172, v203
    v_fma_f32 v203, v61, -v173, v203
    v_fma_f32 v203, v62, -v174, v203
    v_fma_f32 v203, v63, -v175, v203
    v_mfma_f32_32x32x16_bf16 v[32:47], v[64:67], v[180:183], 0
    v_mul_f32 v254, v0, v144
    v_fmac_f32 v254, v1, v145
    v_fmac_f32 v254, v2, v146
    v_fmac_f32 v254, v3, v147
    v_fmac_f32 v254, v4, v148
    v_mfma_f32_32x32x16_bf16 v[48:63], v[68:71], v[180:183], 0
    ds_swizzle_b32 v68, v68 offset:0x401F
    ds_swizzle_b32 v69, v69 offset:0x401F
    ds_swizzle_b32 v70, v70 offset:0x401F
    ds_swizzle_b32 v71, v71 offset:0x401F
    s_waitcnt vmcnt(7)
    ds_read_b64_tr_b16 v[176:177], v244 offset:4096
    ds_read_b64_tr_b16 v[178:179], v244 offset:5120
    ds_read_b64_tr_b16 v[180:181], v245 offset:4096
    ds_read_b64_tr_b16 v[182:183], v245 offset:5120
    v_fmac_f32 v254, v5, v149
    v_fmac_f32 v254, v6, v150
    v_fmac_f32 v254, v7, v151
    v_fmac_f32 v200, v8, v160
    v_mfma_f32_32x32x8_bf16 v[32:47], v[72:73], v[184:185], v[32:47]
    v_fmac_f32 v200, v9, v161
    v_permlane32_swap_b32 v196, v254
    v_fmac_f32 v200, v10, v162
    v_fmac_f32 v200, v11, v163
    v_fmac_f32 v200, v12, v164
    v_mfma_f32_32x32x8_bf16 v[48:63], v[76:77], v[184:185], v[48:63]
    ds_swizzle_b32 v76, v76 offset:0x401F
    ds_swizzle_b32 v77, v77 offset:0x401F
    v_fmac_f32 v200, v13, v165
    v_fmac_f32 v200, v14, v166
    v_fmac_f32 v200, v15, v167
    v_add_f32 v254, v196, v254
    s_waitcnt lgkmcnt(6)
    s_mov_b64 exec, s[56:57]
    v_xor_b32 v68, 0x80008000, v68
    v_xor_b32 v69, 0x80008000, v69
    v_xor_b32 v70, 0x80008000, v70
    v_xor_b32 v71, 0x80008000, v71
    s_mov_b64 exec, -1
    s_waitcnt vmcnt(6) lgkmcnt(2)
    v_mfma_f32_32x32x16_bf16 v[0:15], v[64:67], v[176:179], 0
    v_mul_f32 v255, v32, v152
    v_fmac_f32 v255, v33, v153
    v_fmac_f32 v255, v34, v154
    v_fmac_f32 v255, v35, v155
    v_fmac_f32 v255, v36, v156
    v_fmac_f32 v255, v37, v157
    s_add_u32 m0, s21, 4096
    v_mfma_f32_32x32x16_bf16 v[16:31], v[68:71], v[176:179], v[16:31]
    v_lshl_add_u32 v238, v238, 10, v246
    v_lshl_add_u32 v239, v239, 10, v246
    buffer_load_dwordx4 v238, s[4:7], s40 offen  lds
    buffer_load_dwordx4 v239, s[8:11], s40 offen offset:1024  lds
    ds_read_b64_tr_b16 v[176:177], v244 offset:6144
    ds_read_b64_tr_b16 v[184:185], v245 offset:6144
    v_fmac_f32 v255, v38, v158
    v_fmac_f32 v255, v39, v159
    v_fmac_f32 v201, v40, v168
    v_fmac_f32 v201, v41, v169
    v_permlane32_swap_b32 v197, v255
    s_waitcnt lgkmcnt(0)
    s_mov_b64 exec, s[56:57]
    v_xor_b32 v76, 0x80008000, v76
    v_xor_b32 v77, 0x80008000, v77
    s_mov_b64 exec, -1
    v_mfma_f32_32x32x8_bf16 v[0:15], v[72:73], v[176:177], v[0:15]
    v_fmac_f32 v201, v42, v170
    v_fmac_f32 v201, v43, v171
    v_fmac_f32 v201, v44, v172
    v_fmac_f32 v201, v45, v173
    v_fmac_f32 v201, v46, v174
    v_fmac_f32 v201, v47, v175
    s_add_u32 m0, s21, 6144
    v_mfma_f32_32x32x8_bf16 v[16:31], v[76:77], v[176:177], v[16:31]
    v_lshl_add_u32 v240, v240, 10, v246
    v_lshl_add_u32 v241, v241, 10, v246
    buffer_load_dwordx4 v240, s[4:7], s41 offen  lds
    buffer_load_dwordx4 v241, s[8:11], s41 offen offset:1024  lds
    v_add_f32 v255, v197, v255
    s_set_gpr_idx_on s51, gpr_idx(DST)
    s_nop 0
    v_cvt_pk_bf16_f32 v206, v254, v255
    s_set_gpr_idx_off
    v_mfma_f32_32x32x16_bf16 v[32:47], v[64:67], v[180:183], 0
    v_mul_f32 v254, v0, v144
    v_fmac_f32 v254, v1, v145
    v_fmac_f32 v254, v2, v146
    v_fmac_f32 v254, v3, v147
    v_fmac_f32 v254, v4, v148
    v_fmac_f32 v254, v5, v149
    v_fmac_f32 v254, v6, v150
    v_fmac_f32 v254, v7, v151
    v_fma_f32 v202, v8, -v160, v202
    v_fma_f32 v202, v9, -v161, v202
    v_mfma_f32_32x32x16_bf16 v[48:63], v[68:71], v[180:183], v[48:63]
    s_waitcnt vmcnt(8)
    ds_read_b64_tr_b16 v[176:177], v244 offset:0
    ds_read_b64_tr_b16 v[178:179], v244 offset:1024
    ds_read_b64_tr_b16 v[180:181], v245 offset:0
    ds_read_b64_tr_b16 v[182:183], v245 offset:1024
    v_permlane32_swap_b32 v254, v200
    v_fma_f32 v202, v10, -v162, v202
    v_fma_f32 v202, v11, -v163, v202
    v_fma_f32 v202, v12, -v164, v202
    v_fma_f32 v202, v13, -v165, v202
    v_fma_f32 v202, v14, -v166, v202
    v_fma_f32 v202, v15, -v167, v202
    v_add_f32 v200, v254, v200
    v_fmac_f32 v198, v16, v112
    v_permlane32_swap_b32 v202, v254
    v_mfma_f32_32x32x8_bf16 v[32:47], v[72:73], v[184:185], v[32:47]
    v_fmac_f32 v198, v17, v113
    v_fmac_f32 v198, v18, v114
    v_fmac_f32 v198, v19, v115
    v_fmac_f32 v198, v20, v116
    v_fmac_f32 v198, v21, v117
    v_fmac_f32 v198, v22, v118
    v_fmac_f32 v198, v23, v119
    v_add_f32 v254, v202, v254
    v_mul_f32 v196, v24, v160
    v_fmac_f32 v196, v25, v161
    v_mfma_f32_32x32x8_bf16 v[48:63], v[76:77], v[184:185], v[48:63]
    v_add_u32 v249, s48, v249
    v_add_u32 v250, s49, v250
    s_waitcnt vmcnt(4)
    ds_read_b64_tr_b16 v[64:65], v249 offset:0
    ds_read_b64_tr_b16 v[68:69], v249 offset:64
    ds_read_b64_tr_b16 v[66:67], v249 offset:256
    ds_read_b64_tr_b16 v[70:71], v249 offset:320
    s_mov_b64 exec, s[54:55]
    ds_read_u16_d16_hi v242, v250 offset:0
    s_mov_b64 exec, -1
    v_fmac_f32 v196, v26, v162
    v_fmac_f32 v196, v27, v163
    v_fmac_f32 v196, v28, v164
    v_fmac_f32 v196, v29, v165
    v_fmac_f32 v196, v30, v166
    v_fmac_f32 v196, v31, v167
    s_nop 1
    v_permlane32_swap_b32 v198, v196
    v_add_f32 v196, v198, v196
    v_mul_f32 v255, v32, v152
    v_fmac_f32 v255, v33, v153
    v_fmac_f32 v255, v34, v154
    v_fmac_f32 v255, v35, v155
    v_fmac_f32 v255, v36, v156
    v_fmac_f32 v255, v37, v157
    v_fmac_f32 v255, v38, v158
    v_fmac_f32 v255, v39, v159
    v_fma_f32 v203, v40, -v168, v203
    v_fma_f32 v203, v41, -v169, v203
    v_permlane32_swap_b32 v255, v201
    v_fma_f32 v203, v42, -v170, v203
    v_fma_f32 v203, v43, -v171, v203
    v_fma_f32 v203, v44, -v172, v203
    v_fma_f32 v203, v45, -v173, v203
    v_fma_f32 v203, v46, -v174, v203
    v_fma_f32 v203, v47, -v175, v203
    v_add_f32 v201, v255, v201
    v_fmac_f32 v199, v48, v120
    v_permlane32_swap_b32 v203, v255
    v_fmac_f32 v199, v49, v121
    v_fmac_f32 v199, v50, v122
    v_fmac_f32 v199, v51, v123
    v_fmac_f32 v199, v52, v124
    v_fmac_f32 v199, v53, v125
    v_fmac_f32 v199, v54, v126
    v_fmac_f32 v199, v55, v127
    v_add_f32 v255, v203, v255
    v_mul_f32 v197, v56, v168
    v_fmac_f32 v197, v57, v169
    v_fmac_f32 v197, v58, v170
    v_fmac_f32 v197, v59, v171
    v_fmac_f32 v197, v60, v172
    v_fmac_f32 v197, v61, v173
    v_fmac_f32 v197, v62, v174
    v_fmac_f32 v197, v63, v175
    s_nop 1
    v_permlane32_swap_b32 v199, v197
    v_add_f32 v197, v199, v197
    s_set_gpr_idx_on s51, gpr_idx(DST)
    s_nop 0
    v_cvt_pk_bf16_f32 v207, v200, v201
    v_cvt_pk_bf16_f32 v209, v254, v255
    v_cvt_pk_bf16_f32 v208, v196, v197
    s_set_gpr_idx_off
    s_add_u32 s50, s50, 1
    s_add_u32 s51, s51, 6
    s_cmp_ge_u32 s50, 4
    s_cbranch_scc1 LAST0
    s_add_u32 s53, s53, 4
    s_xor_b32 s66, s53, s20
    s_bitcmp1_b32 s66, 2
    s_setprio 1
    s_cbranch_scc1 PRIO_7
    s_setprio 0
PRIO_7:
    s_cmp_eq_u32 s52, 4
    s_cbranch_scc1 ITEM_0_4
    s_cmp_eq_u32 s52, 5
    s_cbranch_scc1 ITEM_0_5
    s_cmp_eq_u32 s52, 3
    s_cbranch_scc1 ITEM_0_3
    s_cmp_eq_u32 s52, 6
    s_cbranch_scc1 ITEM_0_6
    s_cmp_eq_u32 s52, 8
    s_cbranch_scc1 ITEM_0_8
    s_branch ITEM_0_2
.p2align 6
ITEM_0_6:
    s_mov_b64 exec, s[54:55]
    ds_read_u16_d16_hi v243, v250 offset:128
    s_mov_b64 exec, -1
    ds_read_b64_tr_b16 v[72:73], v249 offset:512
    ds_read_b64_tr_b16 v[76:77], v249 offset:576
    ds_read_b64_tr_b16 v[74:75], v249 offset:768
    ds_read_b64_tr_b16 v[78:79], v249 offset:832
    ds_read_b64_tr_b16 v[80:81], v249 offset:1024
    ds_read_b64_tr_b16 v[84:85], v249 offset:1088
    ds_read_b64_tr_b16 v[82:83], v249 offset:1280
    ds_read_b64_tr_b16 v[86:87], v249 offset:1344
    s_waitcnt lgkmcnt(9)
    v_mul_f32_dpp v196, v242, v64 row_newbcast:0 row_mask:0xf bank_mask:0xf
    v_mul_f32_dpp v197, v242, v65 row_newbcast:1 row_mask:0xf bank_mask:0xf
    v_mul_f32_dpp v198, v242, v64 row_newbcast:8 row_mask:0xf bank_mask:0xf
    v_mul_f32_dpp v199, v242, v65 row_newbcast:9 row_mask:0xf bank_mask:0xf
    v_mul_f32_dpp v200, v242, v68 row_newbcast:2 row_mask:0xf bank_mask:0xf
    v_mul_f32_dpp v201, v242, v69 row_newbcast:3 row_mask:0xf bank_mask:0xf
    v_mul_f32_dpp v202, v242, v68 row_newbcast:10 row_mask:0xf bank_mask:0xf
    v_mul_f32_dpp v203, v242, v69 row_newbcast:11 row_mask:0xf bank_mask:0xf
    v_cvt_pk_bf16_f32 v64, v196, v197
    v_cvt_pk_bf16_f32 v68, v198, v199
    v_cvt_pk_bf16_f32 v65, v200, v201
    v_cvt_pk_bf16_f32 v69, v202, v203
    v_mul_f32_dpp v196, v242, v66 row_newbcast:4 row_mask:0xf bank_mask:0xf
    v_mul_f32_dpp v197, v242, v67 row_newbcast:5 row_mask:0xf bank_mask:0xf
    v_mul_f32_dpp v198, v242, v66 row_newbcast:12 row_mask:0xf bank_mask:0xf
    v_mul_f32_dpp v199, v242, v67 row_newbcast:13 row_mask:0xf bank_mask:0xf
    v_mul_f32_dpp v200, v242, v70 row_newbcast:6 row_mask:0xf bank_mask:0xf
    v_mul_f32_dpp v201, v242, v71 row_newbcast:7 row_mask:0xf bank_mask:0xf
    v_mul_f32_dpp v202, v242, v70 row_newbcast:14 row_mask:0xf bank_mask:0xf
    v_mul_f32_dpp v203, v242, v71 row_newbcast:15 row_mask:0xf bank_mask:0xf
    v_cvt_pk_bf16_f32 v66, v196, v197
    v_cvt_pk_bf16_f32 v70, v198, v199
    v_cvt_pk_bf16_f32 v67, v200, v201
    v_cvt_pk_bf16_f32 v71, v202, v203
    s_mov_b64 exec, s[54:55]
    ds_read_u16_d16_hi v242, v250 offset:256
    s_mov_b64 exec, -1
    s_waitcnt vmcnt(4) lgkmcnt(5)
    v_mfma_f32_32x32x16_bf16 v[0:15], v[64:67], v[176:179], 0
    v_mul_f32_dpp v196, v243, v72 row_newbcast:0 row_mask:0xf bank_mask:0xf
    v_mul_f32_dpp v197, v243, v73 row_newbcast:1 row_mask:0xf bank_mask:0xf
    v_mul_f32_dpp v198, v243, v72 row_newbcast:8 row_mask:0xf bank_mask:0xf
    v_mul_f32_dpp v199, v243, v73 row_newbcast:9 row_mask:0xf bank_mask:0xf
    v_mul_f32_dpp v200, v243, v76 row_newbcast:2 row_mask:0xf bank_mask:0xf
    v_mul_f32_dpp v201, v243, v77 row_newbcast:3 row_mask:0xf bank_mask:0xf
    v_mul_f32_dpp v202, v243, v76 row_newbcast:10 row_mask:0xf bank_mask:0xf
    v_mul_f32_dpp v203, v243, v77 row_newbcast:11 row_mask:0xf bank_mask:0xf
    v_cvt_pk_bf16_f32 v72, v196, v197
    v_cvt_pk_bf16_f32 v76, v198, v199
    v_cvt_pk_bf16_f32 v73, v200, v201
    v_cvt_pk_bf16_f32 v77, v202, v203
    s_add_u32 m0, s21, 0
    v_mfma_f32_32x32x16_bf16 v[16:31], v[68:71], v[176:179], 0
    buffer_load_dwordx4 v236, s[4:7], s35 offen  lds
    buffer_load_dwordx4 v237, s[8:11], s35 offen offset:1024  lds
    ds_read_b64_tr_b16 v[176:177], v244 offset:2048
    ds_read_b64_tr_b16 v[178:179], v244 offset:3072
    ds_read_b64_tr_b16 v[184:185], v245 offset:2048
    ds_read_b64_tr_b16 v[186:187], v245 offset:3072
    v_mul_f32_dpp v196, v243, v74 row_newbcast:4 row_mask:0xf bank_mask:0xf
    v_mul_f32_dpp v197, v243, v75 row_newbcast:5 row_mask:0xf bank_mask:0xf
    v_mul_f32_dpp v198, v243, v74 row_newbcast:12 row_mask:0xf bank_mask:0xf
    v_mul_f32_dpp v199, v243, v75 row_newbcast:13 row_mask:0xf bank_mask:0xf
    v_mul_f32_dpp v200, v243, v78 row_newbcast:6 row_mask:0xf bank_mask:0xf
    v_mul_f32_dpp v201, v243, v79 row_newbcast:7 row_mask:0xf bank_mask:0xf
    v_mul_f32_dpp v202, v243, v78 row_newbcast:14 row_mask:0xf bank_mask:0xf
    v_mul_f32_dpp v203, v243, v79 row_newbcast:15 row_mask:0xf bank_mask:0xf
    v_cvt_pk_bf16_f32 v74, v196, v197
    v_cvt_pk_bf16_f32 v78, v198, v199
    v_cvt_pk_bf16_f32 v75, v200, v201
    v_cvt_pk_bf16_f32 v79, v202, v203
    s_nop 0
    s_waitcnt vmcnt(4) lgkmcnt(0)
    v_mfma_f32_32x32x16_bf16 v[0:15], v[72:75], v[176:179], v[0:15]
    v_mul_f32_dpp v196, v242, v80 row_newbcast:0 row_mask:0xf bank_mask:0xf
    v_mul_f32_dpp v197, v242, v81 row_newbcast:1 row_mask:0xf bank_mask:0xf
    v_mul_f32_dpp v198, v242, v80 row_newbcast:8 row_mask:0xf bank_mask:0xf
    v_mul_f32_dpp v199, v242, v81 row_newbcast:9 row_mask:0xf bank_mask:0xf
    v_mul_f32_dpp v200, v242, v84 row_newbcast:2 row_mask:0xf bank_mask:0xf
    v_mul_f32_dpp v201, v242, v85 row_newbcast:3 row_mask:0xf bank_mask:0xf
    v_mul_f32_dpp v202, v242, v84 row_newbcast:10 row_mask:0xf bank_mask:0xf
    v_mul_f32_dpp v203, v242, v85 row_newbcast:11 row_mask:0xf bank_mask:0xf
    v_cvt_pk_bf16_f32 v80, v196, v197
    v_cvt_pk_bf16_f32 v84, v198, v199
    v_cvt_pk_bf16_f32 v81, v200, v201
    v_cvt_pk_bf16_f32 v85, v202, v203
    s_add_u32 m0, s21, 2048
    v_mfma_f32_32x32x16_bf16 v[16:31], v[76:79], v[176:179], v[16:31]
    buffer_load_dwordx4 v238, s[4:7], s35 offen  lds
    buffer_load_dwordx4 v239, s[8:11], s35 offen offset:1024  lds
    ds_read_b64_tr_b16 v[176:177], v244 offset:4096
    ds_read_b64_tr_b16 v[178:179], v244 offset:5120
    ds_read_b64_tr_b16 v[188:189], v245 offset:4096
    ds_read_b64_tr_b16 v[190:191], v245 offset:5120
    v_mul_f32_dpp v196, v242, v82 row_newbcast:4 row_mask:0xf bank_mask:0xf
    v_mul_f32_dpp v197, v242, v83 row_newbcast:5 row_mask:0xf bank_mask:0xf
    v_mul_f32_dpp v198, v242, v82 row_newbcast:12 row_mask:0xf bank_mask:0xf
    v_mul_f32_dpp v199, v242, v83 row_newbcast:13 row_mask:0xf bank_mask:0xf
    v_mul_f32_dpp v200, v242, v86 row_newbcast:6 row_mask:0xf bank_mask:0xf
    v_mul_f32_dpp v201, v242, v87 row_newbcast:7 row_mask:0xf bank_mask:0xf
    v_mul_f32_dpp v202, v242, v86 row_newbcast:14 row_mask:0xf bank_mask:0xf
    v_mul_f32_dpp v203, v242, v87 row_newbcast:15 row_mask:0xf bank_mask:0xf
    v_cvt_pk_bf16_f32 v82, v196, v197
    v_cvt_pk_bf16_f32 v86, v198, v199
    v_cvt_pk_bf16_f32 v83, v200, v201
    v_cvt_pk_bf16_f32 v87, v202, v203
    s_nop 0
    s_waitcnt lgkmcnt(0)
    v_mfma_f32_32x32x16_bf16 v[0:15], v[80:83], v[176:179], v[0:15]
    s_add_u32 m0, s21, 4096
    v_mfma_f32_32x32x16_bf16 v[16:31], v[84:87], v[176:179], v[16:31]
    buffer_load_dwordx4 v234, s[4:7], s36 offen  lds
    buffer_load_dwordx4 v235, s[8:11], s36 offen offset:1024  lds
    s_mov_b32 m0, s50
    s_nop 0
    s_movrels_b32 s71, s23
    s_bfe_u32 s46, s71, 0x30012
    s_mov_b32 m0, s46
    s_and_b32 s66, s71, 0x3ffff
    s_movrels_b32 s68, s57
    s_movrels_b32 s69, s61
    s_sub_u32 s48, s66, s47
    s_mov_b32 s47, s66
    s_lshr_b32 s52, s71, 28
    s_lshl_b32 s67, s46, 9
    s_add_u32 s66, s66, s67
    s_sub_u32 s49, s66, s42
    s_mov_b32 s42, s66
    s_bfe_u32 s66, s68, 655360
    s_add_u32 s43, s42, s66
    s_bfe_u32 s39, s69, 655360
    s_bfe_u32 s66, s68, 655370
    s_add_u32 s44, s42, s66
    s_bfe_u32 s40, s69, 655370
    s_bfe_u32 s66, s68, 655380
    s_add_u32 s45, s42, s66
    s_bfe_u32 s41, s69, 655380
    s_and_b32 s66, s46, s33
    s_cselect_b32 s72, -1, 1
    s_cselect_b32 s76, s47, 163712
    s_cmp_ge_u32 s66, 2
    s_cselect_b32 s73, -1, 0
    s_add_u32 s77, s47, 1024
    s_cmp_ge_u32 s66, 4
    s_cselect_b32 s75, -1, 0
    s_cmp_ge_u32 s66, 3
    s_cselect_b32 s74, -1, 1
    s_cselect_b32 s77, s77, 163712
    v_add_u32 v252, s45, v247
    ds_read_u16 v240, v252
    ds_read_u16 v241, v252 offset:64
    v_mfma_f32_32x32x16_bf16 v[32:47], v[64:67], v[180:183], 0
    v_mul_f32 v196, v0, v96
    v_fmac_f32 v196, v1, v97
    v_fmac_f32 v196, v2, v98
    v_fmac_f32 v196, v3, v99
    v_fmac_f32 v196, v4, v100
    v_fmac_f32 v196, v5, v101
    v_fmac_f32 v196, v6, v102
    v_mfma_f32_32x32x16_bf16 v[48:63], v[68:71], v[180:183], 0
    v_fmac_f32 v196, v7, v103
    v_mul_f32 v198, v8, v128
    v_fmac_f32 v198, v9, v129
    v_fmac_f32 v198, v10, v130
    v_fmac_f32 v198, v11, v131
    v_fmac_f32 v198, v12, v132
    v_mfma_f32_32x32x16_bf16 v[32:47], v[72:75], v[184:187], v[32:47]
    v_fmac_f32 v198, v13, v133
    v_fmac_f32 v198, v14, v134
    v_fmac_f32 v198, v15, v135
    v_mul_f32 v200, v16, v128
    v_fmac_f32 v200, v17, v129
    v_permlane32_swap_b32 v196, v198
    v_mfma_f32_32x32x16_bf16 v[48:63], v[76:79], v[184:187], v[48:63]
    s_waitcnt vmcnt(6)
    ds_read_b64_tr_b16 v[176:177], v244 offset:6144
    ds_read_b64_tr_b16 v[178:179], v244 offset:7168
    ds_read_b64_tr_b16 v[180:181], v245 offset:6144
    ds_read_b64_tr_b16 v[182:183], v245 offset:7168
    v_fmac_f32 v200, v18, v130
    v_fmac_f32 v200, v19, v131
    v_fmac_f32 v200, v20, v132
    v_fmac_f32 v200, v21, v133
    v_fmac_f32 v200, v22, v134
    v_fmac_f32 v200, v23, v135
    v_mfma_f32_32x32x16_bf16 v[32:47], v[80:83], v[188:191], v[32:47]
    v_add_f32 v198, v196, v198
    v_mul_f32_e64 v202, v24, -v128
    v_fma_f32 v202, v25, -v129, v202
    v_fma_f32 v202, v26, -v130, v202
    v_fma_f32 v202, v27, -v131, v202
    v_fma_f32 v202, v28, -v132, v202
    v_mfma_f32_32x32x16_bf16 v[48:63], v[84:87], v[188:191], v[48:63]
    v_fma_f32 v202, v29, -v133, v202
    v_fma_f32 v202, v30, -v134, v202
    v_fma_f32 v202, v31, -v135, v202
    s_nop 1
    v_permlane32_swap_b32 v200, v202
    v_add_f32 v202, v200, v202
    s_waitcnt vmcnt(4) lgkmcnt(0)
    v_mfma_f32_32x32x16_bf16 v[0:15], v[64:67], v[176:179], 0
    v_mul_f32 v197, v32, v104
    v_fmac_f32 v197, v33, v105
    v_fmac_f32 v197, v34, v106
    v_fmac_f32 v197, v35, v107
    v_fmac_f32 v197, v36, v108
    v_fmac_f32 v197, v37, v109
    v_fmac_f32 v197, v38, v110
    s_add_u32 m0, s21, 6144
    v_mfma_f32_32x32x16_bf16 v[16:31], v[68:71], v[176:179], 0
    buffer_load_dwordx4 v236, s[4:7], s36 offen  lds
    buffer_load_dwordx4 v237, s[8:11], s36 offen offset:1024  lds
    ds_read_b64_tr_b16 v[176:177], v244 offset:0
    ds_read_b64_tr_b16 v[178:179], v244 offset:1024
    ds_read_b64_tr_b16 v[184:185], v245 offset:0
    ds_read_b64_tr_b16 v[186:187], v245 offset:1024
    v_fmac_f32 v197, v39, v111
    v_mul_f32 v199, v40, v136
    v_fmac_f32 v199, v41, v137
    v_fmac_f32 v199, v42, v138
    v_fmac_f32 v199, v43, v139
    v_fmac_f32 v199, v44, v140
    v_fmac_f32 v199, v45, v141
    s_waitcnt vmcnt(4) lgkmcnt(0)
    v_mfma_f32_32x32x16_bf16 v[0:15], v[72:75], v[176:179], v[0:15]
    v_fmac_f32 v199, v46, v142
    v_fmac_f32 v199, v47, v143
    v_mul_f32 v201, v48, v136
    v_fmac_f32 v201, v49, v137
    v_permlane32_swap_b32 v197, v199
    v_fmac_f32 v201, v50, v138
    v_fmac_f32 v201, v51, v139
    s_add_u32 m0, s21, 0
    v_mfma_f32_32x32x16_bf16 v[16:31], v[76:79], v[176:179], v[16:31]
    buffer_load_dwordx4 v238, s[4:7], s36 offen  lds
    buffer_load_dwordx4 v239, s[8:11], s36 offen offset:1024  lds
    ds_read_b64_tr_b16 v[176:177], v244 offset:2048
    ds_read_b64_tr_b16 v[178:179], v244 offset:3072
    ds_read_b64_tr_b16 v[188:189], v245 offset:2048
    ds_read_b64_tr_b16 v[190:191], v245 offset:3072
    v_fmac_f32 v201, v52, v140
    v_fmac_f32 v201, v53, v141
    v_fmac_f32 v201, v54, v142
    v_fmac_f32 v201, v55, v143
    v_add_f32 v199, v197, v199
    v_mul_f32_e64 v203, v56, -v136
    v_fma_f32 v203, v57, -v137, v203
    s_waitcnt lgkmcnt(0)
    v_mfma_f32_32x32x16_bf16 v[0:15], v[80:83], v[176:179], v[0:15]
    v_fma_f32 v203, v58, -v138, v203
    v_fma_f32 v203, v59, -v139, v203
    v_fma_f32 v203, v60, -v140, v203
    v_fma_f32 v203, v61, -v141, v203
    v_fma_f32 v203, v62, -v142, v203
    v_fma_f32 v203, v63, -v143, v203
    s_nop 1
    s_add_u32 m0, s21, 2048
    v_mfma_f32_32x32x16_bf16 v[16:31], v[84:87], v[176:179], v[16:31]
    buffer_load_dwordx4 v234, s[4:7], s37 offen  lds
    buffer_load_dwordx4 v235, s[8:11], s37 offen offset:1024  lds
    v_add_u32 v252, s42, v247
    ds_read_u16 v234, v252
    ds_read_u16 v235, v252 offset:64
    v_permlane32_swap_b32 v201, v203
    v_add_f32 v203, v201, v203
    s_set_gpr_idx_on s51, gpr_idx(DST)
    s_nop 0
    v_cvt_pk_bf16_f32 v204, v198, v199
    v_cvt_pk_bf16_f32 v205, v202, v203
    s_set_gpr_idx_off
    v_mfma_f32_32x32x16_bf16 v[32:47], v[64:67], v[180:183], 0
    v_mul_f32 v196, v0, v144
    v_fmac_f32 v196, v1, v145
    v_fmac_f32 v196, v2, v146
    v_fmac_f32 v196, v3, v147
    v_fmac_f32 v196, v4, v148
    v_fmac_f32 v196, v5, v149
    v_mfma_f32_32x32x16_bf16 v[48:63], v[68:71], v[180:183], 0
    v_add_u32 v253, s47, v248
    ds_read_b32 v254, v253
    ds_read_b32 v255, v253 offset:256
    v_fmac_f32 v196, v6, v150
    v_fmac_f32 v196, v7, v151
    v_mul_f32 v198, v8, v112
    v_fmac_f32 v198, v9, v113
    v_fmac_f32 v198, v10, v114
    v_mfma_f32_32x32x16_bf16 v[32:47], v[72:75], v[184:187], v[32:47]
    v_fmac_f32 v198, v11, v115
    v_fmac_f32 v198, v12, v116
    v_fmac_f32 v198, v13, v117
    v_fmac_f32 v198, v14, v118
    v_fmac_f32 v198, v15, v119
    v_mfma_f32_32x32x16_bf16 v[48:63], v[76:79], v[184:187], v[48:63]
    s_waitcnt vmcnt(6)
    ds_read_b64_tr_b16 v[176:177], v244 offset:4096
    ds_read_b64_tr_b16 v[178:179], v244 offset:5120
    ds_read_b64_tr_b16 v[180:181], v245 offset:4096
    ds_read_b64_tr_b16 v[182:183], v245 offset:5120
    v_mul_f32_e64 v200, v16, -v160
    v_fma_f32 v200, v17, -v161, v200
    v_fma_f32 v200, v18, -v162, v200
    v_fma_f32 v200, v19, -v163, v200
    v_fma_f32 v200, v20, -v164, v200
    v_fma_f32 v200, v21, -v165, v200
    v_mfma_f32_32x32x16_bf16 v[32:47], v[80:83], v[188:191], v[32:47]
    v_fma_f32 v200, v22, -v166, v200
    v_fma_f32 v200, v23, -v167, v200
    v_mul_f32_e64 v202, v24, -v160
    v_fma_f32 v202, v25, -v161, v202
    v_fma_f32 v202, v26, -v162, v202
    v_mfma_f32_32x32x16_bf16 v[48:63], v[84:87], v[188:191], v[48:63]
    v_fma_f32 v202, v27, -v163, v202
    v_fma_f32 v202, v28, -v164, v202
    v_fma_f32 v202, v29, -v165, v202
    v_fma_f32 v202, v30, -v166, v202
    v_fma_f32 v202, v31, -v167, v202
    s_waitcnt vmcnt(4) lgkmcnt(0)
    v_mfma_f32_32x32x16_bf16 v[0:15], v[64:67], v[176:179], 0
    v_mul_f32 v197, v32, v152
    v_fmac_f32 v197, v33, v153
    v_fmac_f32 v197, v34, v154
    v_fmac_f32 v197, v35, v155
    v_fmac_f32 v197, v36, v156
    v_fmac_f32 v197, v37, v157
    s_add_u32 m0, s21, 4096
    v_mfma_f32_32x32x16_bf16 v[16:31], v[68:71], v[176:179], 0
    buffer_load_dwordx4 v236, s[4:7], s37 offen  lds
    buffer_load_dwordx4 v237, s[8:11], s37 offen offset:1024  lds
    ds_read_b64_tr_b16 v[176:177], v244 offset:6144
    ds_read_b64_tr_b16 v[178:179], v244 offset:7168
    ds_read_b64_tr_b16 v[184:185], v245 offset:6144
    ds_read_b64_tr_b16 v[186:187], v245 offset:7168
    v_add_u32 v252, s43, v247
    ds_read_u16 v236, v252
    ds_read_u16 v237, v252 offset:64
    v_fmac_f32 v197, v38, v158
    v_fmac_f32 v197, v39, v159
    v_mul_f32 v199, v40, v120
    v_fmac_f32 v199, v41, v121
    v_fmac_f32 v199, v42, v122
    s_waitcnt vmcnt(4) lgkmcnt(2)
    v_mfma_f32_32x32x16_bf16 v[0:15], v[72:75], v[176:179], v[0:15]
    v_fmac_f32 v199, v43, v123
    v_fmac_f32 v199, v44, v124
    v_fmac_f32 v199, v45, v125
    v_fmac_f32 v199, v46, v126
    v_fmac_f32 v199, v47, v127
    s_add_u32 m0, s21, 6144
    v_mfma_f32_32x32x16_bf16 v[16:31], v[76:79], v[176:179], v[16:31]
    buffer_load_dwordx4 v238, s[4:7], s37 offen  lds
    buffer_load_dwordx4 v239, s[8:11], s37 offen offset:1024  lds
    ds_read_b64_tr_b16 v[176:177], v244 offset:0
    ds_read_b64_tr_b16 v[178:179], v244 offset:1024
    ds_read_b64_tr_b16 v[188:189], v245 offset:0
    ds_read_b64_tr_b16 v[190:191], v245 offset:1024
    v_add_u32 v252, s44, v247
    ds_read_u16 v238, v252
    ds_read_u16 v239, v252 offset:64
    v_mul_f32_e64 v201, v48, -v168
    v_fma_f32 v201, v49, -v169, v201
    v_fma_f32 v201, v50, -v170, v201
    v_fma_f32 v201, v51, -v171, v201
    v_fma_f32 v201, v52, -v172, v201
    v_fma_f32 v201, v53, -v173, v201
    s_waitcnt lgkmcnt(2)
    v_mfma_f32_32x32x16_bf16 v[0:15], v[80:83], v[176:179], v[0:15]
    v_fma_f32 v201, v54, -v174, v201
    v_fma_f32 v201, v55, -v175, v201
    v_mul_f32_e64 v203, v56, -v168
    v_fma_f32 v203, v57, -v169, v203
    v_fma_f32 v203, v58, -v170, v203
    s_add_u32 m0, s21, 0
    v_mfma_f32_32x32x16_bf16 v[16:31], v[84:87], v[176:179], v[16:31]
    v_lshl_add_u32 v234, v234, 10, v246
    v_lshl_add_u32 v235, v235, 10, v246
    buffer_load_dwordx4 v234, s[4:7], s38 offen  lds
    buffer_load_dwordx4 v235, s[8:11], s38 offen offset:1024  lds
    s_mov_b32 m0, s76
    s_mov_b64 exec, s[72:73]
    buffer_load_dwordx4 v254, s[12:15], 0 offen  lds
    s_mov_b32 m0, s77
    s_mov_b64 exec, s[74:75]
    buffer_load_dwordx4 v255, s[12:15], 0 offen  lds
    s_mov_b64 exec, -1
    v_fma_f32 v203, v59, -v171, v203
    v_fma_f32 v203, v60, -v172, v203
    v_fma_f32 v203, v61, -v173, v203
    v_fma_f32 v203, v62, -v174, v203
    v_fma_f32 v203, v63, -v175, v203
    v_mfma_f32_32x32x16_bf16 v[32:47], v[64:67], v[180:183], 0
    v_mul_f32 v254, v0, v144
    v_fmac_f32 v254, v1, v145
    v_fmac_f32 v254, v2, v146
    v_mfma_f32_32x32x16_bf16 v[48:63], v[68:71], v[180:183], 0
    ds_swizzle_b32 v68, v68 offset:0x401F
    ds_swizzle_b32 v69, v69 offset:0x401F
    ds_swizzle_b32 v70, v70 offset:0x401F
    ds_swizzle_b32 v71, v71 offset:0x401F
    v_fmac_f32 v254, v3, v147
    v_fmac_f32 v254, v4, v148
    v_fmac_f32 v254, v5, v149
    v_mfma_f32_32x32x16_bf16 v[32:47], v[72:75], v[184:187], v[32:47]
    v_fmac_f32 v254, v6, v150
    v_fmac_f32 v254, v7, v151
    v_fmac_f32 v200, v8, v160
    v_mfma_f32_32x32x16_bf16 v[48:63], v[76:79], v[184:187], v[48:63]
    ds_swizzle_b32 v76, v76 offset:0x401F
    ds_swizzle_b32 v77, v77 offset:0x401F
    ds_swizzle_b32 v78, v78 offset:0x401F
    ds_swizzle_b32 v79, v79 offset:0x401F
    s_waitcnt vmcnt(8)
    ds_read_b64_tr_b16 v[176:177], v244 offset:2048
    ds_read_b64_tr_b16 v[178:179], v244 offset:3072
    ds_read_b64_tr_b16 v[180:181], v245 offset:2048
    ds_read_b64_tr_b16 v[182:183], v245 offset:3072
    v_fmac_f32 v200, v9, v161
    v_permlane32_swap_b32 v196, v254
    v_fmac_f32 v200, v10, v162
    v_mfma_f32_32x32x16_bf16 v[32:47], v[80:83], v[188:191], v[32:47]
    v_fmac_f32 v200, v11, v163
    v_fmac_f32 v200, v12, v164
    v_fmac_f32 v200, v13, v165
    v_mfma_f32_32x32x16_bf16 v[48:63], v[84:87], v[188:191], v[48:63]
    ds_swizzle_b32 v84, v84 offset:0x401F
    ds_swizzle_b32 v85, v85 offset:0x401F
    ds_swizzle_b32 v86, v86 offset:0x401F
    ds_swizzle_b32 v87, v87 offset:0x401F
    v_fmac_f32 v200, v14, v166
    v_fmac_f32 v200, v15, v167
    v_add_f32 v254, v196, v254
    s_waitcnt lgkmcnt(8)
    s_mov_b64 exec, s[56:57]
    v_xor_b32 v68, 0x80008000, v68
    v_xor_b32 v69, 0x80008000, v69
    v_xor_b32 v70, 0x80008000, v70
    v_xor_b32 v71, 0x80008000, v71
    v_xor_b32 v76, 0x80008000, v76
    v_xor_b32 v77, 0x80008000, v77
    v_xor_b32 v78, 0x80008000, v78
    v_xor_b32 v79, 0x80008000, v79
    s_mov_b64 exec, -1
    s_waitcnt vmcnt(6) lgkmcnt(4)
    v_mfma_f32_32x32x16_bf16 v[0:15], v[64:67], v[176:179], 0
    v_mul_f32 v255, v32, v152
    v_fmac_f32 v255, v33, v153
    v_fmac_f32 v255, v34, v154
    v_fmac_f32 v255, v35, v155
    s_add_u32 m0, s21, 2048
    v_mfma_f32_32x32x16_bf16 v[16:31], v[68:71], v[176:179], v[16:31]
    v_lshl_add_u32 v236, v236, 10, v246
    v_lshl_add_u32 v237, v237, 10, v246
    buffer_load_dwordx4 v236, s[4:7], s39 offen  lds
    buffer_load_dwordx4 v237, s[8:11], s39 offen offset:1024  lds
    ds_read_b64_tr_b16 v[176:177], v244 offset:4096
    ds_read_b64_tr_b16 v[178:179], v244 offset:5120
    ds_read_b64_tr_b16 v[184:185], v245 offset:4096
    ds_read_b64_tr_b16 v[186:187], v245 offset:5120
    v_fmac_f32 v255, v36, v156
    v_fmac_f32 v255, v37, v157
    v_fmac_f32 v255, v38, v158
    v_fmac_f32 v255, v39, v159
    s_waitcnt vmcnt(6) lgkmcnt(0)
    v_mfma_f32_32x32x16_bf16 v[0:15], v[72:75], v[176:179], v[0:15]
    v_fmac_f32 v201, v40, v168
    v_fmac_f32 v201, v41, v169
    v_permlane32_swap_b32 v197, v255
    s_add_u32 m0, s21, 4096
    v_mfma_f32_32x32x16_bf16 v[16:31], v[76:79], v[176:179], v[16:31]
    v_lshl_add_u32 v238, v238, 10, v246
    v_lshl_add_u32 v239, v239, 10, v246
    buffer_load_dwordx4 v238, s[4:7], s40 offen  lds
    buffer_load_dwordx4 v239, s[8:11], s40 offen offset:1024  lds
    ds_read_b64_tr_b16 v[176:177], v244 offset:6144
    ds_read_b64_tr_b16 v[178:179], v244 offset:7168
    ds_read_b64_tr_b16 v[188:189], v245 offset:6144
    ds_read_b64_tr_b16 v[190:191], v245 offset:7168
    v_fmac_f32 v201, v42, v170
    v_fmac_f32 v201, v43, v171
    v_fmac_f32 v201, v44, v172
    v_fmac_f32 v201, v45, v173
    s_waitcnt lgkmcnt(0)
    s_mov_b64 exec, s[56:57]
    v_xor_b32 v84, 0x80008000, v84
    v_xor_b32 v85, 0x80008000, v85
    v_xor_b32 v86, 0x80008000, v86
    v_xor_b32 v87, 0x80008000, v87
    s_mov_b64 exec, -1
    v_mfma_f32_32x32x16_bf16 v[0:15], v[80:83], v[176:179], v[0:15]
    v_fmac_f32 v201, v46, v174
    v_fmac_f32 v201, v47, v175
    v_add_f32 v255, v197, v255
    s_set_gpr_idx_on s51, gpr_idx(DST)
    s_nop 0
    v_cvt_pk_bf16_f32 v206, v254, v255
    s_set_gpr_idx_off
    s_add_u32 m0, s21, 6144
    v_mfma_f32_32x32x16_bf16 v[16:31], v[84:87], v[176:179], v[16:31]
    v_lshl_add_u32 v240, v240, 10, v246
    v_lshl_add_u32 v241, v241, 10, v246
    buffer_load_dwordx4 v240, s[4:7], s41 offen  lds
    buffer_load_dwordx4 v241, s[8:11], s41 offen offset:1024  lds
    v_mfma_f32_32x32x16_bf16 v[32:47], v[64:67], v[180:183], 0
    v_mul_f32 v254, v0, v144
    v_fmac_f32 v254, v1, v145
    v_fmac_f32 v254, v2, v146
    v_fmac_f32 v254, v3, v147
    v_fmac_f32 v254, v4, v148
    v_fmac_f32 v254, v5, v149
    v_fmac_f32 v254, v6, v150
    v_mfma_f32_32x32x16_bf16 v[48:63], v[68:71], v[180:183], v[48:63]
    v_fmac_f32 v254, v7, v151
    v_fma_f32 v202, v8, -v160, v202
    v_fma_f32 v202, v9, -v161, v202
    v_permlane32_swap_b32 v254, v200
    v_fma_f32 v202, v10, -v162, v202
    v_fma_f32 v202, v11, -v163, v202
    v_mfma_f32_32x32x16_bf16 v[32:47], v[72:75], v[184:187], v[32:47]
    v_fma_f32 v202, v12, -v164, v202
    v_fma_f32 v202, v13, -v165, v202
    v_fma_f32 v202, v14, -v166, v202
    v_fma_f32 v202, v15, -v167, v202
    v_add_f32 v200, v254, v200
    v_fmac_f32 v198, v16, v112
    v_permlane32_swap_b32 v202, v254
    v_mfma_f32_32x32x16_bf16 v[48:63], v[76:79], v[184:187], v[48:63]
    s_waitcnt vmcnt(8)
    ds_read_b64_tr_b16 v[176:177], v244 offset:0
    ds_read_b64_tr_b16 v[178:179], v244 offset:1024
    ds_read_b64_tr_b16 v[180:181], v245 offset:0
    ds_read_b64_tr_b16 v[182:183], v245 offset:1024
    v_fmac_f32 v198, v17, v113
    v_fmac_f32 v198, v18, v114
    v_fmac_f32 v198, v19, v115
    v_fmac_f32 v198, v20, v116
    v_fmac_f32 v198, v21, v117
    v_fmac_f32 v198, v22, v118
    v_mfma_f32_32x32x16_bf16 v[32:47], v[80:83], v[188:191], v[32:47]
    v_fmac_f32 v198, v23, v119
    v_add_f32 v254, v202, v254
    v_mul_f32 v196, v24, v160
    v_fmac_f32 v196, v25, v161
    v_fmac_f32 v196, v26, v162
    v_fmac_f32 v196, v27, v163
    v_fmac_f32 v196, v28, v164
    v_mfma_f32_32x32x16_bf16 v[48:63], v[84:87], v[188:191], v[48:63]
    v_add_u32 v249, s48, v249
    v_add_u32 v250, s49, v250
    s_waitcnt vmcnt(6)
    ds_read_b64_tr_b16 v[64:65], v249 offset:0
    ds_read_b64_tr_b16 v[68:69], v249 offset:64
    ds_read_b64_tr_b16 v[66:67], v249 offset:256
    ds_read_b64_tr_b16 v[70:71], v249 offset:320
    s_mov_b64 exec, s[54:55]
    ds_read_u16_d16_hi v242, v250 offset:0
    s_mov_b64 exec, -1
    v_fmac_f32 v196, v29, v165
    v_fmac_f32 v196, v30, v166
    v_fmac_f32 v196, v31, v167
    s_nop 1
    v_permlane32_swap_b32 v198, v196
    v_add_f32 v196, v198, v196
    v_mul_f32 v255, v32, v152
    v_fmac_f32 v255, v33, v153
    v_fmac_f32 v255, v34, v154
    v_fmac_f32 v255, v35, v155
    v_fmac_f32 v255, v36, v156
    v_fmac_f32 v255, v37, v157
    v_fmac_f32 v255, v38, v158
    v_fmac_f32 v255, v39, v159
    v_fma_f32 v203, v40, -v168, v203
    v_fma_f32 v203, v41, -v169, v203
    v_permlane32_swap_b32 v255, v201
    v_fma_f32 v203, v42, -v170, v203
    v_fma_f32 v203, v43, -v171, v203
    v_fma_f32 v203, v44, -v172, v203
    v_fma_f32 v203, v45, -v173, v203
    v_fma_f32 v203, v46, -v174, v203
    v_fma_f32 v203, v47, -v175, v203
    v_add_f32 v201, v255, v201
    v_fmac_f32 v199, v48, v120
    v_permlane32_swap_b32 v203, v255
    v_fmac_f32 v199, v49, v121
    v_fmac_f32 v199, v50, v122
    v_fmac_f32 v199, v51, v123
    v_fmac_f32 v199, v52, v124
    v_fmac_f32 v199, v53, v125
    v_fmac_f32 v199, v54, v126
    v_fmac_f32 v199, v55, v127
    v_add_f32 v255, v203, v255
    v_mul_f32 v197, v56, v168
    v_fmac_f32 v197, v57, v169
    v_fmac_f32 v197, v58, v170
    v_fmac_f32 v197, v59, v171
    v_fmac_f32 v197, v60, v172
    v_fmac_f32 v197, v61, v173
    v_fmac_f32 v197, v62, v174
    v_fmac_f32 v197, v63, v175
    s_nop 1
    v_permlane32_swap_b32 v199, v197
    v_add_f32 v197, v199, v197
    s_set_gpr_idx_on s51, gpr_idx(DST)
    s_nop 0
    v_cvt_pk_bf16_f32 v207, v200, v201
    v_cvt_pk_bf16_f32 v209, v254, v255
    v_cvt_pk_bf16_f32 v208, v196, v197
    s_set_gpr_idx_off
    s_add_u32 s50, s50, 1
    s_add_u32 s51, s51, 6
    s_cmp_ge_u32 s50, 4
    s_cbranch_scc1 LAST0
    s_add_u32 s53, s53, 4
    s_xor_b32 s66, s53, s20
    s_bitcmp1_b32 s66, 2
    s_setprio 1
    s_cbranch_scc1 PRIO_8
    s_setprio 0
PRIO_8:
    s_cmp_eq_u32 s52, 4
    s_cbranch_scc1 ITEM_0_4
    s_cmp_eq_u32 s52, 5
    s_cbranch_scc1 ITEM_0_5
    s_cmp_eq_u32 s52, 3
    s_cbranch_scc1 ITEM_0_3
    s_cmp_eq_u32 s52, 6
    s_cbranch_scc1 ITEM_0_6
    s_cmp_eq_u32 s52, 8
    s_cbranch_scc1 ITEM_0_8
    s_branch ITEM_0_2
.p2align 6
ITEM_0_8:
    s_mov_b64 exec, s[54:55]
    ds_read_u16_d16_hi v243, v250 offset:128
    s_mov_b64 exec, -1
    ds_read_b64_tr_b16 v[72:73], v249 offset:512
    ds_read_b64_tr_b16 v[76:77], v249 offset:576
    ds_read_b64_tr_b16 v[74:75], v249 offset:768
    ds_read_b64_tr_b16 v[78:79], v249 offset:832
    ds_read_b64_tr_b16 v[80:81], v249 offset:1024
    ds_read_b64_tr_b16 v[84:85], v249 offset:1088
    ds_read_b64_tr_b16 v[82:83], v249 offset:1280
    ds_read_b64_tr_b16 v[86:87], v249 offset:1344
    ds_read_b64_tr_b16 v[88:89], v249 offset:1536
    ds_read_b64_tr_b16 v[92:93], v249 offset:1600
    ds_read_b64_tr_b16 v[90:91], v249 offset:1792
    ds_read_b64_tr_b16 v[94:95], v249 offset:1856
    s_waitcnt lgkmcnt(13)
    v_mul_f32_dpp v196, v242, v64 row_newbcast:0 row_mask:0xf bank_mask:0xf
    v_mul_f32_dpp v197, v242, v65 row_newbcast:1 row_mask:0xf bank_mask:0xf
    v_mul_f32_dpp v198, v242, v64 row_newbcast:8 row_mask:0xf bank_mask:0xf
    v_mul_f32_dpp v199, v242, v65 row_newbcast:9 row_mask:0xf bank_mask:0xf
    v_mul_f32_dpp v200, v242, v68 row_newbcast:2 row_mask:0xf bank_mask:0xf
    v_mul_f32_dpp v201, v242, v69 row_newbcast:3 row_mask:0xf bank_mask:0xf
    v_mul_f32_dpp v202, v242, v68 row_newbcast:10 row_mask:0xf bank_mask:0xf
    v_mul_f32_dpp v203, v242, v69 row_newbcast:11 row_mask:0xf bank_mask:0xf
    v_cvt_pk_bf16_f32 v64, v196, v197
    v_cvt_pk_bf16_f32 v68, v198, v199
    v_cvt_pk_bf16_f32 v65, v200, v201
    v_cvt_pk_bf16_f32 v69, v202, v203
    v_mul_f32_dpp v196, v242, v66 row_newbcast:4 row_mask:0xf bank_mask:0xf
    v_mul_f32_dpp v197, v242, v67 row_newbcast:5 row_mask:0xf bank_mask:0xf
    v_mul_f32_dpp v198, v242, v66 row_newbcast:12 row_mask:0xf bank_mask:0xf
    v_mul_f32_dpp v199, v242, v67 row_newbcast:13 row_mask:0xf bank_mask:0xf
    v_mul_f32_dpp v200, v242, v70 row_newbcast:6 row_mask:0xf bank_mask:0xf
    v_mul_f32_dpp v201, v242, v71 row_newbcast:7 row_mask:0xf bank_mask:0xf
    v_mul_f32_dpp v202, v242, v70 row_newbcast:14 row_mask:0xf bank_mask:0xf
    v_mul_f32_dpp v203, v242, v71 row_newbcast:15 row_mask:0xf bank_mask:0xf
    v_cvt_pk_bf16_f32 v66, v196, v197
    v_cvt_pk_bf16_f32 v70, v198, v199
    v_cvt_pk_bf16_f32 v67, v200, v201
    v_cvt_pk_bf16_f32 v71, v202, v203
    s_mov_b64 exec, s[54:55]
    ds_read_u16_d16_hi v242, v250 offset:256
    s_mov_b64 exec, -1
    s_waitcnt vmcnt(4) lgkmcnt(9)
    v_mfma_f32_32x32x16_bf16 v[0:15], v[64:67], v[176:179], 0
    v_mul_f32_dpp v196, v243, v72 row_newbcast:0 row_mask:0xf bank_mask:0xf
    v_mul_f32_dpp v197, v243, v73 row_newbcast:1 row_mask:0xf bank_mask:0xf
    v_mul_f32_dpp v198, v243, v72 row_newbcast:8 row_mask:0xf bank_mask:0xf
    v_mul_f32_dpp v199, v243, v73 row_newbcast:9 row_mask:0xf bank_mask:0xf
    v_mul_f32_dpp v200, v243, v76 row_newbcast:2 row_mask:0xf bank_mask:0xf
    v_mul_f32_dpp v201, v243, v77 row_newbcast:3 row_mask:0xf bank_mask:0xf
    v_mul_f32_dpp v202, v243, v76 row_newbcast:10 row_mask:0xf bank_mask:0xf
    v_mul_f32_dpp v203, v243, v77 row_newbcast:11 row_mask:0xf bank_mask:0xf
    v_cvt_pk_bf16_f32 v72, v196, v197
    v_cvt_pk_bf16_f32 v76, v198, v199
    v_cvt_pk_bf16_f32 v73, v200, v201
    v_cvt_pk_bf16_f32 v77, v202, v203
    s_add_u32 m0, s21, 0
    v_mfma_f32_32x32x16_bf16 v[16:31], v[68:71], v[176:179], 0
    buffer_load_dwordx4 v234, s[4:7], s35 offen  lds
    buffer_load_dwordx4 v235, s[8:11], s35 offen offset:1024  lds
    ds_read_b64_tr_b16 v[176:177], v244 offset:2048
    ds_read_b64_tr_b16 v[178:179], v244 offset:3072
    ds_read_b64_tr_b16 v[184:185], v245 offset:2048
    ds_read_b64_tr_b16 v[186:187], v245 offset:3072
    v_mul_f32_dpp v196, v243, v74 row_newbcast:4 row_mask:0xf bank_mask:0xf
    v_mul_f32_dpp v197, v243, v75 row_newbcast:5 row_mask:0xf bank_mask:0xf
    v_mul_f32_dpp v198, v243, v74 row_newbcast:12 row_mask:0xf bank_mask:0xf
    v_mul_f32_dpp v199, v243, v75 row_newbcast:13 row_mask:0xf bank_mask:0xf
    v_mul_f32_dpp v200, v243, v78 row_newbcast:6 row_mask:0xf bank_mask:0xf
    v_mul_f32_dpp v201, v243, v79 row_newbcast:7 row_mask:0xf bank_mask:0xf
    v_mul_f32_dpp v202, v243, v78 row_newbcast:14 row_mask:0xf bank_mask:0xf
    v_mul_f32_dpp v203, v243, v79 row_newbcast:15 row_mask:0xf bank_mask:0xf
    v_cvt_pk_bf16_f32 v74, v196, v197
    v_cvt_pk_bf16_f32 v78, v198, v199
    v_cvt_pk_bf16_f32 v75, v200, v201
    v_cvt_pk_bf16_f32 v79, v202, v203
    s_mov_b64 exec, s[54:55]
    ds_read_u16_d16_hi v243, v250 offset:384
    s_mov_b64 exec, -1
    s_waitcnt vmcnt(4) lgkmcnt(1)
    v_mfma_f32_32x32x16_bf16 v[0:15], v[72:75], v[176:179], v[0:15]
    v_mul_f32_dpp v196, v242, v80 row_newbcast:0 row_mask:0xf bank_mask:0xf
    v_mul_f32_dpp v197, v242, v81 row_newbcast:1 row_mask:0xf bank_mask:0xf
    v_mul_f32_dpp v198, v242, v80 row_newbcast:8 row_mask:0xf bank_mask:0xf
    v_mul_f32_dpp v199, v242, v81 row_newbcast:9 row_mask:0xf bank_mask:0xf
    v_mul_f32_dpp v200, v242, v84 row_newbcast:2 row_mask:0xf bank_mask:0xf
    v_mul_f32_dpp v201, v242, v85 row_newbcast:3 row_mask:0xf bank_mask:0xf
    v_mul_f32_dpp v202, v242, v84 row_newbcast:10 row_mask:0xf bank_mask:0xf
    v_mul_f32_dpp v203, v242, v85 row_newbcast:11 row_mask:0xf bank_mask:0xf
    v_cvt_pk_bf16_f32 v80, v196, v197
    v_cvt_pk_bf16_f32 v84, v198, v199
    v_cvt_pk_bf16_f32 v81, v200, v201
    v_cvt_pk_bf16_f32 v85, v202, v203
    s_add_u32 m0, s21, 2048
    v_mfma_f32_32x32x16_bf16 v[16:31], v[76:79], v[176:179], v[16:31]
    buffer_load_dwordx4 v236, s[4:7], s35 offen  lds
    buffer_load_dwordx4 v237, s[8:11], s35 offen offset:1024  lds
    ds_read_b64_tr_b16 v[176:177], v244 offset:4096
    ds_read_b64_tr_b16 v[178:179], v244 offset:5120
    ds_read_b64_tr_b16 v[188:189], v245 offset:4096
    ds_read_b64_tr_b16 v[190:191], v245 offset:5120
    v_mul_f32_dpp v196, v242, v82 row_newbcast:4 row_mask:0xf bank_mask:0xf
    v_mul_f32_dpp v197, v242, v83 row_newbcast:5 row_mask:0xf bank_mask:0xf
    v_mul_f32_dpp v198, v242, v82 row_newbcast:12 row_mask:0xf bank_mask:0xf
    v_mul_f32_dpp v199, v242, v83 row_newbcast:13 row_mask:0xf bank_mask:0xf
    v_mul_f32_dpp v200, v242, v86 row_newbcast:6 row_mask:0xf bank_mask:0xf
    v_mul_f32_dpp v201, v242, v87 row_newbcast:7 row_mask:0xf bank_mask:0xf
    v_mul_f32_dpp v202, v242, v86 row_newbcast:14 row_mask:0xf bank_mask:0xf
    v_mul_f32_dpp v203, v242, v87 row_newbcast:15 row_mask:0xf bank_mask:0xf
    v_cvt_pk_bf16_f32 v82, v196, v197
    v_cvt_pk_bf16_f32 v86, v198, v199
    v_cvt_pk_bf16_f32 v83, v200, v201
    v_cvt_pk_bf16_f32 v87, v202, v203
    s_nop 0
    s_waitcnt vmcnt(4) lgkmcnt(0)
    v_mfma_f32_32x32x16_bf16 v[0:15], v[80:83], v[176:179], v[0:15]
    v_mul_f32_dpp v196, v243, v88 row_newbcast:0 row_mask:0xf bank_mask:0xf
    v_mul_f32_dpp v197, v243, v89 row_newbcast:1 row_mask:0xf bank_mask:0xf
    v_mul_f32_dpp v198, v243, v88 row_newbcast:8 row_mask:0xf bank_mask:0xf
    v_mul_f32_dpp v199, v243, v89 row_newbcast:9 row_mask:0xf bank_mask:0xf
    v_mul_f32_dpp v200, v243, v92 row_newbcast:2 row_mask:0xf bank_mask:0xf
    v_mul_f32_dpp v201, v243, v93 row_newbcast:3 row_mask:0xf bank_mask:0xf
    v_mul_f32_dpp v202, v243, v92 row_newbcast:10 row_mask:0xf bank_mask:0xf
    v_mul_f32_dpp v203, v243, v93 row_newbcast:11 row_mask:0xf bank_mask:0xf
    v_cvt_pk_bf16_f32 v88, v196, v197
    v_cvt_pk_bf16_f32 v92, v198, v199
    v_cvt_pk_bf16_f32 v89, v200, v201
    v_cvt_pk_bf16_f32 v93, v202, v203
    s_add_u32 m0, s21, 4096
    v_mfma_f32_32x32x16_bf16 v[16:31], v[84:87], v[176:179], v[16:31]
    buffer_load_dwordx4 v238, s[4:7], s35 offen  lds
    buffer_load_dwordx4 v239, s[8:11], s35 offen offset:1024  lds
    ds_read_b64_tr_b16 v[176:177], v244 offset:6144
    ds_read_b64_tr_b16 v[178:179], v244 offset:7168
    ds_read_b64_tr_b16 v[192:193], v245 offset:6144
    ds_read_b64_tr_b16 v[194:195], v245 offset:7168
    v_mul_f32_dpp v196, v243, v90 row_newbcast:4 row_mask:0xf bank_mask:0xf
    v_mul_f32_dpp v197, v243, v91 row_newbcast:5 row_mask:0xf bank_mask:0xf
    v_mul_f32_dpp v198, v243, v90 row_newbcast:12 row_mask:0xf bank_mask:0xf
    v_mul_f32_dpp v199, v243, v91 row_newbcast:13 row_mask:0xf bank_mask:0xf
    v_mul_f32_dpp v200, v243, v94 row_newbcast:6 row_mask:0xf bank_mask:0xf
    v_mul_f32_dpp v201, v243, v95 row_newbcast:7 row_mask:0xf bank_mask:0xf
    v_mul_f32_dpp v202, v243, v94 row_newbcast:14 row_mask:0xf bank_mask:0xf
    v_mul_f32_dpp v203, v243, v95 row_newbcast:15 row_mask:0xf bank_mask:0xf
    v_cvt_pk_bf16_f32 v90, v196, v197
    v_cvt_pk_bf16_f32 v94, v198, v199
    v_cvt_pk_bf16_f32 v91, v200, v201
    v_cvt_pk_bf16_f32 v95, v202, v203
    s_nop 0
    s_waitcnt lgkmcnt(0)
    v_mfma_f32_32x32x16_bf16 v[0:15], v[88:91], v[176:179], v[0:15]
    s_add_u32 m0, s21, 6144
    v_mfma_f32_32x32x16_bf16 v[16:31], v[92:95], v[176:179], v[16:31]
    buffer_load_dwordx4 v240, s[4:7], s35 offen  lds
    buffer_load_dwordx4 v241, s[8:11], s35 offen offset:1024  lds
    s_mov_b32 m0, s50
    s_nop 0
    s_movrels_b32 s71, s23
    s_bfe_u32 s46, s71, 0x30012
    s_mov_b32 m0, s46
    s_and_b32 s66, s71, 0x3ffff
    s_movrels_b32 s68, s57
    s_movrels_b32 s69, s61
    s_sub_u32 s48, s66, s47
    s_mov_b32 s47, s66
    s_lshr_b32 s52, s71, 28
    s_lshl_b32 s67, s46, 9
    s_add_u32 s66, s66, s67
    s_sub_u32 s49, s66, s42
    s_mov_b32 s42, s66
    s_bfe_u32 s66, s68, 655360
    s_add_u32 s43, s42, s66
    s_bfe_u32 s39, s69, 655360
    s_bfe_u32 s66, s68, 655370
    s_add_u32 s44, s42, s66
    s_bfe_u32 s40, s69, 655370
    s_bfe_u32 s66, s68, 655380
    s_add_u32 s45, s42, s66
    s_bfe_u32 s41, s69, 655380
    s_and_b32 s66, s46, s33
    s_cselect_b32 s72, -1, 1
    s_cselect_b32 s76, s47, 163712
    s_cmp_ge_u32 s66, 2
    s_cselect_b32 s73, -1, 0
    s_add_u32 s77, s47, 1024
    s_cmp_ge_u32 s66, 4
    s_cselect_b32 s75, -1, 0
    s_cmp_ge_u32 s66, 3
    s_cselect_b32 s74, -1, 1
    s_cselect_b32 s77, s77, 163712
    v_mfma_f32_32x32x16_bf16 v[32:47], v[64:67], v[180:183], 0
    v_mul_f32 v196, v0, v96
    v_fmac_f32 v196, v1, v97
    v_fmac_f32 v196, v2, v98
    v_fmac_f32 v196, v3, v99
    v_fmac_f32 v196, v4, v100
    v_mfma_f32_32x32x16_bf16 v[48:63], v[68:71], v[180:183], 0
    v_fmac_f32 v196, v5, v101
    v_fmac_f32 v196, v6, v102
    v_fmac_f32 v196, v7, v103
    v_mul_f32 v198, v8, v128
    v_fmac_f32 v198, v9, v129
    v_mfma_f32_32x32x16_bf16 v[32:47], v[72:75], v[184:187], v[32:47]
    v_fmac_f32 v198, v10, v130
    v_fmac_f32 v198, v11, v131
    v_fmac_f32 v198, v12, v132
    v_fmac_f32 v198, v13, v133
    v_mfma_f32_32x32x16_bf16 v[48:63], v[76:79], v[184:187], v[48:63]
    v_fmac_f32 v198, v14, v134
    v_fmac_f32 v198, v15, v135
    v_mul_f32 v200, v16, v128
    v_fmac_f32 v200, v17, v129
    v_permlane32_swap_b32 v196, v198
    v_mfma_f32_32x32x16_bf16 v[32:47], v[80:83], v[188:191], v[32:47]
    v_fmac_f32 v200, v18, v130
    v_fmac_f32 v200, v19, v131
    v_fmac_f32 v200, v20, v132
    v_fmac_f32 v200, v21, v133
    v_fmac_f32 v200, v22, v134
    v_mfma_f32_32x32x16_bf16 v[48:63], v[84:87], v[188:191], v[48:63]
    s_waitcnt vmcnt(6)
    ds_read_b64_tr_b16 v[176:177], v244 offset:0
    ds_read_b64_tr_b16 v[178:179], v244 offset:1024
    ds_read_b64_tr_b16 v[180:181], v245 offset:0
    ds_read_b64_tr_b16 v[182:183], v245 offset:1024
    v_fmac_f32 v200, v23, v135
    v_add_f32 v198, v196, v198
    v_mul_f32_e64 v202, v24, -v128
    v_fma_f32 v202, v25, -v129, v202
    v_mfma_f32_32x32x16_bf16 v[32:47], v[88:91], v[192:195], v[32:47]
    v_fma_f32 v202, v26, -v130, v202
    v_fma_f32 v202, v27, -v131, v202
    v_fma_f32 v202, v28, -v132, v202
    v_fma_f32 v202, v29, -v133, v202
    v_fma_f32 v202, v30, -v134, v202
    v_mfma_f32_32x32x16_bf16 v[48:63], v[92:95], v[192:195], v[48:63]
    v_fma_f32 v202, v31, -v135, v202
    s_nop 1
    v_permlane32_swap_b32 v200, v202
    v_add_f32 v202, v200, v202
    s_waitcnt vmcnt(4) lgkmcnt(0)
    v_mfma_f32_32x32x16_bf16 v[0:15], v[64:67], v[176:179], 0
    v_mul_f32 v197, v32, v104
    v_fmac_f32 v197, v33, v105
    v_fmac_f32 v197, v34, v106
    v_fmac_f32 v197, v35, v107
    v_fmac_f32 v197, v36, v108
    v_fmac_f32 v197, v37, v109
    s_add_u32 m0, s21, 0
    v_mfma_f32_32x32x16_bf16 v[16:31], v[68:71], v[176:179], 0
    buffer_load_dwordx4 v234, s[4:7], s36 offen  lds
    buffer_load_dwordx4 v235, s[8:11], s36 offen offset:1024  lds
    ds_read_b64_tr_b16 v[176:177], v244 offset:2048
    ds_read_b64_tr_b16 v[178:179], v244 offset:3072
    ds_read_b64_tr_b16 v[184:185], v245 offset:2048
    ds_read_b64_tr_b16 v[186:187], v245 offset:3072
    v_fmac_f32 v197, v38, v110
    v_fmac_f32 v197, v39, v111
    v_mul_f32 v199, v40, v136
    v_fmac_f32 v199, v41, v137
    v_fmac_f32 v199, v42, v138
    s_waitcnt vmcnt(4) lgkmcnt(0)
    v_mfma_f32_32x32x16_bf16 v[0:15], v[72:75], v[176:179], v[0:15]
    v_fmac_f32 v199, v43, v139
    v_fmac_f32 v199, v44, v140
    v_fmac_f32 v199, v45, v141
    v_fmac_f32 v199, v46, v142
    v_fmac_f32 v199, v47, v143
    s_add_u32 m0, s21, 2048
    v_mfma_f32_32x32x16_bf16 v[16:31], v[76:79], v[176:179], v[16:31]
    buffer_load_dwordx4 v236, s[4:7], s36 offen  lds
    buffer_load_dwordx4 v237, s[8:11], s36 offen offset:1024  lds
    ds_read_b64_tr_b16 v[176:177], v244 offset:4096
    ds_read_b64_tr_b16 v[178:179], v244 offset:5120
    ds_read_b64_tr_b16 v[188:189], v245 offset:4096
    ds_read_b64_tr_b16 v[190:191], v245 offset:5120
    v_mul_f32 v201, v48, v136
    v_fmac_f32 v201, v49, v137
    v_permlane32_swap_b32 v197, v199
    v_fmac_f32 v201, v50, v138
    v_fmac_f32 v201, v51, v139
    s_waitcnt vmcnt(4) lgkmcnt(0)
    v_mfma_f32_32x32x16_bf16 v[0:15], v[80:83], v[176:179], v[0:15]
    v_fmac_f32 v201, v52, v140
    v_fmac_f32 v201, v53, v141
    v_fmac_f32 v201, v54, v142
    v_fmac_f32 v201, v55, v143
    v_add_f32 v199, v197, v199
    v_mul_f32_e64 v203, v56, -v136
    s_add_u32 m0, s21, 4096
    v_mfma_f32_32x32x16_bf16 v[16:31], v[84:87], v[176:179], v[16:31]
    buffer_load_dwordx4 v238, s[4:7], s36 offen  lds
    buffer_load_dwordx4 v239, s[8:11], s36 offen offset:1024  lds
    ds_read_b64_tr_b16 v[176:177], v244 offset:6144
    ds_read_b64_tr_b16 v[178:179], v244 offset:7168
    ds_read_b64_tr_b16 v[192:193], v245 offset:6144
    ds_read_b64_tr_b16 v[194:195], v245 offset:7168
    v_fma_f32 v203, v57, -v137, v203
    v_fma_f32 v203, v58, -v138, v203
    v_fma_f32 v203, v59, -v139, v203
    v_fma_f32 v203, v60, -v140, v203
    v_fma_f32 v203, v61, -v141, v203
    s_waitcnt lgkmcnt(0)
    v_mfma_f32_32x32x16_bf16 v[0:15], v[88:91], v[176:179], v[0:15]
    v_fma_f32 v203, v62, -v142, v203
    v_fma_f32 v203, v63, -v143, v203
    s_nop 1
    v_permlane32_swap_b32 v201, v203
    v_add_f32 v203, v201, v203
    s_add_u32 m0, s21, 6144
    v_mfma_f32_32x32x16_bf16 v[16:31], v[92:95], v[176:179], v[16:31]
    buffer_load_dwordx4 v240, s[4:7], s36 offen  lds
    buffer_load_dwordx4 v241, s[8:11], s36 offen offset:1024  lds
    s_set_gpr_idx_on s51, gpr_idx(DST)
    s_nop 0
    v_cvt_pk_bf16_f32 v204, v198, v199
    v_cvt_pk_bf16_f32 v205, v202, v203
    s_set_gpr_idx_off
    v_mfma_f32_32x32x16_bf16 v[32:47], v[64:67], v[180:183], 0
    v_mul_f32 v196, v0, v144
    v_fmac_f32 v196, v1, v145
    v_fmac_f32 v196, v2, v146
    v_fmac_f32 v196, v3, v147
    v_mfma_f32_32x32x16_bf16 v[48:63], v[68:71], v[180:183], 0
    v_add_u32 v253, s47, v248
    ds_read_b32 v254, v253
    ds_read_b32 v255, v253 offset:256
    v_fmac_f32 v196, v4, v148
    v_fmac_f32 v196, v5, v149
    v_fmac_f32 v196, v6, v150
    v_fmac_f32 v196, v7, v151
    v_mfma_f32_32x32x16_bf16 v[32:47], v[72:75], v[184:187], v[32:47]
    v_mul_f32 v198, v8, v112
    v_fmac_f32 v198, v9, v113
    v_fmac_f32 v198, v10, v114
    v_fmac_f32 v198, v11, v115
    v_mfma_f32_32x32x16_bf16 v[48:63], v[76:79], v[184:187], v[48:63]
    v_fmac_f32 v198, v12, v116
    v_fmac_f32 v198, v13, v117
    v_fmac_f32 v198, v14, v118
    v_fmac_f32 v198, v15, v119
    v_mfma_f32_32x32x16_bf16 v[32:47], v[80:83], v[188:191], v[32:47]
    v_mul_f32_e64 v200, v16, -v160
    v_fma_f32 v200, v17, -v161, v200
    v_fma_f32 v200, v18, -v162, v200
    v_fma_f32 v200, v19, -v163, v200
    v_mfma_f32_32x32x16_bf16 v[48:63], v[84:87], v[188:191], v[48:63]
    s_waitcnt vmcnt(6)
    ds_read_b64_tr_b16 v[176:177], v244 offset:0
    ds_read_b64_tr_b16 v[178:179], v244 offset:1024
    ds_read_b64_tr_b16 v[180:181], v245 offset:0
    ds_read_b64_tr_b16 v[182:183], v245 offset:1024
    v_fma_f32 v200, v20, -v164, v200
    v_fma_f32 v200, v21, -v165, v200
    v_fma_f32 v200, v22, -v166, v200
    v_fma_f32 v200, v23, -v167, v200
    v_mfma_f32_32x32x16_bf16 v[32:47], v[88:91], v[192:195], v[32:47]
    v_mul_f32_e64 v202, v24, -v160
    v_fma_f32 v202, v25, -v161, v202
    v_fma_f32 v202, v26, -v162, v202
    v_fma_f32 v202, v27, -v163, v202
    v_mfma_f32_32x32x16_bf16 v[48:63], v[92:95], v[192:195], v[48:63]
    v_fma_f32 v202, v28, -v164, v202
    v_fma_f32 v202, v29, -v165, v202
    v_fma_f32 v202, v30, -v166, v202
    v_fma_f32 v202, v31, -v167, v202
    s_waitcnt vmcnt(4) lgkmcnt(0)
    v_mfma_f32_32x32x16_bf16 v[0:15], v[64:67], v[176:179], 0
    s_nop 0
    v_mul_f32 v197, v32, v152
    v_fmac_f32 v197, v33, v153
    v_fmac_f32 v197, v34, v154
    v_fmac_f32 v197, v35, v155
    s_add_u32 m0, s21, 0
    v_mfma_f32_32x32x16_bf16 v[16:31], v[68:71], v[176:179], 0
    buffer_load_dwordx4 v234, s[4:7], s37 offen  lds
    buffer_load_dwordx4 v235, s[8:11], s37 offen offset:1024  lds
    ds_read_b64_tr_b16 v[176:177], v244 offset:2048
    ds_read_b64_tr_b16 v[178:179], v244 offset:3072
    ds_read_b64_tr_b16 v[184:185], v245 offset:2048
    ds_read_b64_tr_b16 v[186:187], v245 offset:3072
    v_add_u32 v252, s42, v247
    ds_read_u16 v234, v252
    ds_read_u16 v235, v252 offset:64
    v_fmac_f32 v197, v36, v156
    v_fmac_f32 v197, v37, v157
    v_fmac_f32 v197, v38, v158
    v_fmac_f32 v197, v39, v159
    s_waitcnt vmcnt(4) lgkmcnt(2)
    v_mfma_f32_32x32x16_bf16 v[0:15], v[72:75], v[176:179], v[0:15]
    v_mul_f32 v199, v40, v120
    v_fmac_f32 v199, v41, v121
    v_fmac_f32 v199, v42, v122
    v_fmac_f32 v199, v43, v123
    s_add_u32 m0, s21, 2048
    v_mfma_f32_32x32x16_bf16 v[16:31], v[76:79], v[176:179], v[16:31]
    buffer_load_dwordx4 v236, s[4:7], s37 offen  lds
    buffer_load_dwordx4 v237, s[8:11], s37 offen offset:1024  lds
    ds_read_b64_tr_b16 v[176:177], v244 offset:4096
    ds_read_b64_tr_b16 v[178:179], v244 offset:5120
    ds_read_b64_tr_b16 v[188:189], v245 offset:4096
    ds_read_b64_tr_b16 v[190:191], v245 offset:5120
    v_add_u32 v252, s43, v247
    ds_read_u16 v236, v252
    ds_read_u16 v237, v252 offset:64
    v_fmac_f32 v199, v44, v124
    v_fmac_f32 v199, v45, v125
    v_fmac_f32 v199, v46, v126
    v_fmac_f32 v199, v47, v127
    s_waitcnt vmcnt(4) lgkmcnt(2)
    v_mfma_f32_32x32x16_bf16 v[0:15], v[80:83], v[176:179], v[0:15]
    v_mul_f32_e64 v201, v48, -v168
    v_fma_f32 v201, v49, -v169, v201
    v_fma_f32 v201, v50, -v170, v201
    v_fma_f32 v201, v51, -v171, v201
    s_add_u32 m0, s21, 4096
    v_mfma_f32_32x32x16_bf16 v[16:31], v[84:87], v[176:179], v[16:31]
    buffer_load_dwordx4 v238, s[4:7], s37 offen  lds
    buffer_load_dwordx4 v239, s[8:11], s37 offen offset:1024  lds
    ds_read_b64_tr_b16 v[176:177], v244 offset:6144
    ds_read_b64_tr_b16 v[178:179], v244 offset:7168
    ds_read_b64_tr_b16 v[192:193], v245 offset:6144
    ds_read_b64_tr_b16 v[194:195], v245 offset:7168
    v_add_u32 v252, s44, v247
    ds_read_u16 v238, v252
    ds_read_u16 v239, v252 offset:64
    v_fma_f32 v201, v52, -v172, v201
    v_fma_f32 v201, v53, -v173, v201
    v_fma_f32 v201, v54, -v174, v201
    v_fma_f32 v201, v55, -v175, v201
    s_waitcnt lgkmcnt(2)
    v_mfma_f32_32x32x16_bf16 v[0:15], v[88:91], v[176:179], v[0:15]
    v_mul_f32_e64 v203, v56, -v168
    v_fma_f32 v203, v57, -v169, v203
    v_fma_f32 v203, v58, -v170, v203
    v_fma_f32 v203, v59, -v171, v203
    s_add_u32 m0, s21, 6144
    v_mfma_f32_32x32x16_bf16 v[16:31], v[92:95], v[176:179], v[16:31]
    buffer_load_dwordx4 v240, s[4:7], s37 offen  lds
    buffer_load_dwordx4 v241, s[8:11], s37 offen offset:1024  lds
    v_add_u32 v252, s45, v247
    ds_read_u16 v240, v252
    ds_read_u16 v241, v252 offset:64
    s_mov_b32 m0, s76
    s_mov_b64 exec, s[72:73]
    buffer_load_dwordx4 v254, s[12:15], 0 offen  lds
    s_mov_b32 m0, s77
    s_mov_b64 exec, s[74:75]
    buffer_load_dwordx4 v255, s[12:15], 0 offen  lds
    s_mov_b64 exec, -1
    v_fma_f32 v203, v60, -v172, v203
    v_fma_f32 v203, v61, -v173, v203
    v_fma_f32 v203, v62, -v174, v203
    v_fma_f32 v203, v63, -v175, v203
    v_mfma_f32_32x32x16_bf16 v[32:47], v[64:67], v[180:183], 0
    v_mul_f32 v254, v0, v144
    v_fmac_f32 v254, v1, v145
    v_fmac_f32 v254, v2, v146
    v_mfma_f32_32x32x16_bf16 v[48:63], v[68:71], v[180:183], 0
    ds_swizzle_b32 v68, v68 offset:0x401F
    ds_swizzle_b32 v69, v69 offset:0x401F
    ds_swizzle_b32 v70, v70 offset:0x401F
    ds_swizzle_b32 v71, v71 offset:0x401F
    v_fmac_f32 v254, v3, v147
    v_fmac_f32 v254, v4, v148
    v_mfma_f32_32x32x16_bf16 v[32:47], v[72:75], v[184:187], v[32:47]
    v_fmac_f32 v254, v5, v149
    v_fmac_f32 v254, v6, v150
    v_mfma_f32_32x32x16_bf16 v[48:63], v[76:79], v[184:187], v[48:63]
    ds_swizzle_b32 v76, v76 offset:0x401F
    ds_swizzle_b32 v77, v77 offset:0x401F
    ds_swizzle_b32 v78, v78 offset:0x401F
    ds_swizzle_b32 v79, v79 offset:0x401F
    v_fmac_f32 v254, v7, v151
    v_fmac_f32 v200, v8, v160
    v_mfma_f32_32x32x16_bf16 v[32:47], v[80:83], v[188:191], v[32:47]
    v_fmac_f32 v200, v9, v161
    v_permlane32_swap_b32 v196, v254
    v_fmac_f32 v200, v10, v162
    v_mfma_f32_32x32x16_bf16 v[48:63], v[84:87], v[188:191], v[48:63]
    ds_swizzle_b32 v84, v84 offset:0x401F
    ds_swizzle_b32 v85, v85 offset:0x401F
    ds_swizzle_b32 v86, v86 offset:0x401F
    ds_swizzle_b32 v87, v87 offset:0x401F
    s_waitcnt vmcnt(8)
    ds_read_b64_tr_b16 v[176:177], v244 offset:0
    ds_read_b64_tr_b16 v[178:179], v244 offset:1024
    ds_read_b64_tr_b16 v[180:181], v245 offset:0
    ds_read_b64_tr_b16 v[182:183], v245 offset:1024
    v_fmac_f32 v200, v11, v163
    v_fmac_f32 v200, v12, v164
    v_mfma_f32_32x32x16_bf16 v[32:47], v[88:91], v[192:195], v[32:47]
    v_fmac_f32 v200, v13, v165
    v_fmac_f32 v200, v14, v166
    v_mfma_f32_32x32x16_bf16 v[48:63], v[92:95], v[192:195], v[48:63]
    ds_swizzle_b32 v92, v92 offset:0x401F
    ds_swizzle_b32 v93, v93 offset:0x401F
    ds_swizzle_b32 v94, v94 offset:0x401F
    ds_swizzle_b32 v95, v95 offset:0x401F
    v_fmac_f32 v200, v15, v167
    v_add_f32 v254, v196, v254
    s_waitcnt lgkmcnt(8)
    s_mov_b64 exec, s[56:57]
    v_xor_b32 v68, 0x80008000, v68
    v_xor_b32 v69, 0x80008000, v69
    v_xor_b32 v70, 0x80008000, v70
    v_xor_b32 v71, 0x80008000, v71
    v_xor_b32 v76, 0x80008000, v76
    v_xor_b32 v77, 0x80008000, v77
    v_xor_b32 v78, 0x80008000, v78
    v_xor_b32 v79, 0x80008000, v79
    v_xor_b32 v84, 0x80008000, v84
    v_xor_b32 v85, 0x80008000, v85
    v_xor_b32 v86, 0x80008000, v86
    v_xor_b32 v87, 0x80008000, v87
    s_mov_b64 exec, -1
    s_waitcnt vmcnt(6) lgkmcnt(4)
    v_mfma_f32_32x32x16_bf16 v[0:15], v[64:67], v[176:179], 0
    v_mul_f32 v255, v32, v152
    v_fmac_f32 v255, v33, v153
    v_fmac_f32 v255, v34, v154
    s_add_u32 m0, s21, 0
    v_mfma_f32_32x32x16_bf16 v[16:31], v[68:71], v[176:179], v[16:31]
    v_lshl_add_u32 v234, v234, 10, v246
    v_lshl_add_u32 v235, v235, 10, v246
    buffer_load_dwordx4 v234, s[4:7], s38 offen  lds
    buffer_load_dwordx4 v235, s[8:11], s38 offen offset:1024  lds
    ds_read_b64_tr_b16 v[176:177], v244 offset:2048
    ds_read_b64_tr_b16 v[178:179], v244 offset:3072
    ds_read_b64_tr_b16 v[184:185], v245 offset:2048
    ds_read_b64_tr_b16 v[186:187], v245 offset:3072
    v_fmac_f32 v255, v35, v155
    v_fmac_f32 v255, v36, v156
    v_fmac_f32 v255, v37, v157
    s_waitcnt vmcnt(6) lgkmcnt(0)
    v_mfma_f32_32x32x16_bf16 v[0:15], v[72:75], v[176:179], v[0:15]
    v_fmac_f32 v255, v38, v158
    v_fmac_f32 v255, v39, v159
    v_fmac_f32 v201, v40, v168
    s_add_u32 m0, s21, 2048
    v_mfma_f32_32x32x16_bf16 v[16:31], v[76:79], v[176:179], v[16:31]
    v_lshl_add_u32 v236, v236, 10, v246
    v_lshl_add_u32 v237, v237, 10, v246
    buffer_load_dwordx4 v236, s[4:7], s39 offen  lds
    buffer_load_dwordx4 v237, s[8:11], s39 offen offset:1024  lds
    ds_read_b64_tr_b16 v[176:177], v244 offset:4096
    ds_read_b64_tr_b16 v[178:179], v244 offset:5120
    ds_read_b64_tr_b16 v[188:189], v245 offset:4096
    ds_read_b64_tr_b16 v[190:191], v245 offset:5120
    v_fmac_f32 v201, v41, v169
    v_permlane32_swap_b32 v197, v255
    s_waitcnt vmcnt(6) lgkmcnt(0)
    v_mfma_f32_32x32x16_bf16 v[0:15], v[80:83], v[176:179], v[0:15]
    v_fmac_f32 v201, v42, v170
    v_fmac_f32 v201, v43, v171
    v_fmac_f32 v201, v44, v172
    s_add_u32 m0, s21, 4096
    v_mfma_f32_32x32x16_bf16 v[16:31], v[84:87], v[176:179], v[16:31]
    v_lshl_add_u32 v238, v238, 10, v246
    v_lshl_add_u32 v239, v239, 10, v246
    buffer_load_dwordx4 v238, s[4:7], s40 offen  lds
    buffer_load_dwordx4 v239, s[8:11], s40 offen offset:1024  lds
    ds_read_b64_tr_b16 v[176:177], v244 offset:6144
    ds_read_b64_tr_b16 v[178:179], v244 offset:7168
    ds_read_b64_tr_b16 v[192:193], v245 offset:6144
    ds_read_b64_tr_b16 v[194:195], v245 offset:7168
    v_fmac_f32 v201, v45, v173
    v_fmac_f32 v201, v46, v174
    v_fmac_f32 v201, v47, v175
    s_waitcnt lgkmcnt(0)
    s_mov_b64 exec, s[56:57]
    v_xor_b32 v92, 0x80008000, v92
    v_xor_b32 v93, 0x80008000, v93
    v_xor_b32 v94, 0x80008000, v94
    v_xor_b32 v95, 0x80008000, v95
    s_mov_b64 exec, -1
    v_mfma_f32_32x32x16_bf16 v[0:15], v[88:91], v[176:179], v[0:15]
    v_add_f32 v255, v197, v255
    s_set_gpr_idx_on s51, gpr_idx(DST)
    s_nop 0
    v_cvt_pk_bf16_f32 v206, v254, v255
    s_set_gpr_idx_off
    s_add_u32 m0, s21, 6144
    v_mfma_f32_32x32x16_bf16 v[16:31], v[92:95], v[176:179], v[16:31]
    v_lshl_add_u32 v240, v240, 10, v246
    v_lshl_add_u32 v241, v241, 10, v246
    buffer_load_dwordx4 v240, s[4:7], s41 offen  lds
    buffer_load_dwordx4 v241, s[8:11], s41 offen offset:1024  lds
    v_mfma_f32_32x32x16_bf16 v[32:47], v[64:67], v[180:183], 0
    v_mul_f32 v254, v0, v144
    v_fmac_f32 v254, v1, v145
    v_fmac_f32 v254, v2, v146
    v_fmac_f32 v254, v3, v147
    v_fmac_f32 v254, v4, v148
    v_mfma_f32_32x32x16_bf16 v[48:63], v[68:71], v[180:183], v[48:63]
    v_fmac_f32 v254, v5, v149
    v_fmac_f32 v254, v6, v150
    v_fmac_f32 v254, v7, v151
    v_fma_f32 v202, v8, -v160, v202
    v_fma_f32 v202, v9, -v161, v202
    v_mfma_f32_32x32x16_bf16 v[32:47], v[72:75], v[184:187], v[32:47]
    v_permlane32_swap_b32 v254, v200
    v_fma_f32 v202, v10, -v162, v202
    v_fma_f32 v202, v11, -v163, v202
    v_fma_f32 v202, v12, -v164, v202
    v_fma_f32 v202, v13, -v165, v202
    v_mfma_f32_32x32x16_bf16 v[48:63], v[76:79], v[184:187], v[48:63]
    v_fma_f32 v202, v14, -v166, v202
    v_fma_f32 v202, v15, -v167, v202
    v_add_f32 v200, v254, v200
    v_fmac_f32 v198, v16, v112
    v_permlane32_swap_b32 v202, v254
    v_mfma_f32_32x32x16_bf16 v[32:47], v[80:83], v[188:191], v[32:47]
    v_fmac_f32 v198, v17, v113
    v_fmac_f32 v198, v18, v114
    v_fmac_f32 v198, v19, v115
    v_fmac_f32 v198, v20, v116
    v_fmac_f32 v198, v21, v117
    v_mfma_f32_32x32x16_bf16 v[48:63], v[84:87], v[188:191], v[48:63]
    s_waitcnt vmcnt(6)
    ds_read_b64_tr_b16 v[176:177], v244 offset:0
    ds_read_b64_tr_b16 v[178:179], v244 offset:1024
    ds_read_b64_tr_b16 v[180:181], v245 offset:0
    ds_read_b64_tr_b16 v[182:183], v245 offset:1024
    v_fmac_f32 v198, v22, v118
    v_fmac_f32 v198, v23, v119
    v_add_f32 v254, v202, v254
    v_mul_f32 v196, v24, v160
    v_fmac_f32 v196, v25, v161
    v_mfma_f32_32x32x16_bf16 v[32:47], v[88:91], v[192:195], v[32:47]
    v_fmac_f32 v196, v26, v162
    v_fmac_f32 v196, v27, v163
    v_fmac_f32 v196, v28, v164
    v_fmac_f32 v196, v29, v165
    v_fmac_f32 v196, v30, v166
    v_mfma_f32_32x32x16_bf16 v[48:63], v[92:95], v[192:195], v[48:63]
    v_add_u32 v249, s48, v249
    v_add_u32 v250, s49, v250
    ds_read_b64_tr_b16 v[64:65], v249 offset:0
    ds_read_b64_tr_b16 v[68:69], v249 offset:64
    ds_read_b64_tr_b16 v[66:67], v249 offset:256
    ds_read_b64_tr_b16 v[70:71], v249 offset:320
    s_mov_b64 exec, s[54:55]
    ds_read_u16_d16_hi v242, v250 offset:0
    s_mov_b64 exec, -1
    v_fmac_f32 v196, v31, v167
    s_nop 1
    v_permlane32_swap_b32 v198, v196
    v_add_f32 v196, v198, v196
    v_mul_f32 v255, v32, v152
    v_fmac_f32 v255, v33, v153
    v_fmac_f32 v255, v34, v154
    v_fmac_f32 v255, v35, v155
    v_fmac_f32 v255, v36, v156
    v_fmac_f32 v255, v37, v157
    v_fmac_f32 v255, v38, v158
    v_fmac_f32 v255, v39, v159
    v_fma_f32 v203, v40, -v168, v203
    v_fma_f32 v203, v41, -v169, v203
    v_permlane32_swap_b32 v255, v201
    v_fma_f32 v203, v42, -v170, v203
    v_fma_f32 v203, v43, -v171, v203
    v_fma_f32 v203, v44, -v172, v203
    v_fma_f32 v203, v45, -v173, v203
    v_fma_f32 v203, v46, -v174, v203
    v_fma_f32 v203, v47, -v175, v203
    v_add_f32 v201, v255, v201
    v_fmac_f32 v199, v48, v120
    v_permlane32_swap_b32 v203, v255
    v_fmac_f32 v199, v49, v121
    v_fmac_f32 v199, v50, v122
    v_fmac_f32 v199, v51, v123
    v_fmac_f32 v199, v52, v124
    v_fmac_f32 v199, v53, v125
    v_fmac_f32 v199, v54, v126
    v_fmac_f32 v199, v55, v127
    v_add_f32 v255, v203, v255
    v_mul_f32 v197, v56, v168
    v_fmac_f32 v197, v57, v169
    v_fmac_f32 v197, v58, v170
    v_fmac_f32 v197, v59, v171
    v_fmac_f32 v197, v60, v172
    v_fmac_f32 v197, v61, v173
    v_fmac_f32 v197, v62, v174
    v_fmac_f32 v197, v63, v175
    s_nop 1
    v_permlane32_swap_b32 v199, v197
    v_add_f32 v197, v199, v197
    s_set_gpr_idx_on s51, gpr_idx(DST)
    s_nop 0
    v_cvt_pk_bf16_f32 v207, v200, v201
    v_cvt_pk_bf16_f32 v209, v254, v255
    v_cvt_pk_bf16_f32 v208, v196, v197
    s_set_gpr_idx_off
    s_add_u32 s50, s50, 1
    s_add_u32 s51, s51, 6
    s_cmp_ge_u32 s50, 4
    s_cbranch_scc1 LAST0
    s_add_u32 s53, s53, 4
    s_xor_b32 s66, s53, s20
    s_bitcmp1_b32 s66, 2
    s_setprio 1
    s_cbranch_scc1 PRIO_9
    s_setprio 0
PRIO_9:
    s_cmp_eq_u32 s52, 4
    s_cbranch_scc1 ITEM_0_4
    s_cmp_eq_u32 s52, 5
    s_cbranch_scc1 ITEM_0_5
    s_cmp_eq_u32 s52, 3
    s_cbranch_scc1 ITEM_0_3
    s_cmp_eq_u32 s52, 6
    s_cbranch_scc1 ITEM_0_6
    s_cmp_eq_u32 s52, 8
    s_cbranch_scc1 ITEM_0_8
    s_branch ITEM_0_2
.p2align 6
ITEM_0_2:
    s_mov_b32 m0, s50
    s_nop 0
    s_movrels_b32 s71, s23
    s_bfe_u32 s46, s71, 0x30012
    s_mov_b32 m0, s46
    s_and_b32 s66, s71, 0x3ffff
    s_movrels_b32 s68, s57
    s_movrels_b32 s69, s61
    s_sub_u32 s48, s66, s47
    s_mov_b32 s47, s66
    s_lshr_b32 s52, s71, 28
    s_lshl_b32 s67, s46, 9
    s_add_u32 s66, s66, s67
    s_sub_u32 s49, s66, s42
    s_mov_b32 s42, s66
    s_bfe_u32 s66, s68, 655360
    s_add_u32 s43, s42, s66
    s_bfe_u32 s39, s69, 655360
    s_bfe_u32 s66, s68, 655370
    s_add_u32 s44, s42, s66
    s_bfe_u32 s40, s69, 655370
    s_bfe_u32 s66, s68, 655380
    s_add_u32 s45, s42, s66
    s_bfe_u32 s41, s69, 655380
    s_and_b32 s66, s46, s33
    s_cselect_b32 s72, -1, 1
    s_cselect_b32 s76, s47, 163712
    s_cmp_ge_u32 s66, 2
    s_cselect_b32 s73, -1, 0
    s_add_u32 s77, s47, 1024
    s_cmp_ge_u32 s66, 4
    s_cselect_b32 s75, -1, 0
    s_cmp_ge_u32 s66, 3
    s_cselect_b32 s74, -1, 1
    s_cselect_b32 s77, s77, 163712
    v_add_u32 v252, s42, v247
    ds_read_u16 v234, v252
    ds_read_u16 v235, v252 offset:64
    v_add_u32 v252, s43, v247
    ds_read_u16 v236, v252
    ds_read_u16 v237, v252 offset:64
    v_add_u32 v252, s44, v247
    ds_read_u16 v238, v252
    ds_read_u16 v239, v252 offset:64
    v_add_u32 v252, s45, v247
    ds_read_u16 v240, v252
    ds_read_u16 v241, v252 offset:64
    s_waitcnt lgkmcnt(8)
    v_mul_f32_dpp v196, v242, v64 row_newbcast:0 row_mask:0xf bank_mask:0xf
    v_mul_f32_dpp v197, v242, v65 row_newbcast:1 row_mask:0xf bank_mask:0xf
    v_mul_f32_dpp v198, v242, v64 row_newbcast:8 row_mask:0xf bank_mask:0xf
    v_mul_f32_dpp v199, v242, v65 row_newbcast:9 row_mask:0xf bank_mask:0xf
    v_mul_f32_dpp v200, v242, v68 row_newbcast:2 row_mask:0xf bank_mask:0xf
    v_mul_f32_dpp v201, v242, v69 row_newbcast:3 row_mask:0xf bank_mask:0xf
    v_mul_f32_dpp v202, v242, v68 row_newbcast:10 row_mask:0xf bank_mask:0xf
    v_mul_f32_dpp v203, v242, v69 row_newbcast:11 row_mask:0xf bank_mask:0xf
    v_cvt_pk_bf16_f32 v64, v196, v197
    v_cvt_pk_bf16_f32 v68, v198, v199
    v_cvt_pk_bf16_f32 v65, v200, v201
    v_cvt_pk_bf16_f32 v69, v202, v203
    v_mul_f32_dpp v196, v242, v66 row_newbcast:4 row_mask:0xf bank_mask:0xf
    v_mul_f32_dpp v197, v242, v67 row_newbcast:5 row_mask:0xf bank_mask:0xf
    v_mul_f32_dpp v198, v242, v66 row_newbcast:12 row_mask:0xf bank_mask:0xf
    v_mul_f32_dpp v199, v242, v67 row_newbcast:13 row_mask:0xf bank_mask:0xf
    v_mul_f32_dpp v200, v242, v70 row_newbcast:6 row_mask:0xf bank_mask:0xf
    v_mul_f32_dpp v201, v242, v71 row_newbcast:7 row_mask:0xf bank_mask:0xf
    v_mul_f32_dpp v202, v242, v70 row_newbcast:14 row_mask:0xf bank_mask:0xf
    v_mul_f32_dpp v203, v242, v71 row_newbcast:15 row_mask:0xf bank_mask:0xf
    v_cvt_pk_bf16_f32 v66, v196, v197
    v_cvt_pk_bf16_f32 v70, v198, v199
    v_cvt_pk_bf16_f32 v67, v200, v201
    v_cvt_pk_bf16_f32 v71, v202, v203
    s_nop 0
    s_waitcnt lgkmcnt(6)
    v_mfma_f32_32x32x16_bf16 v[0:15], v[64:67], v[176:179], 0
    s_add_u32 m0, s21, 0
    v_mfma_f32_32x32x16_bf16 v[16:31], v[68:71], v[176:179], 0
    v_lshl_add_u32 v234, v234, 10, v246
    v_lshl_add_u32 v235, v235, 10, v246
    buffer_load_dwordx4 v234, s[4:7], s38 offen  lds
    buffer_load_dwordx4 v235, s[8:11], s38 offen offset:1024  lds
    v_mfma_f32_32x32x16_bf16 v[32:47], v[64:67], v[180:183], 0
    s_nop 4
    v_mul_f32 v196, v0, v96
    v_fmac_f32 v196, v1, v97
    v_fmac_f32 v196, v2, v98
    v_fmac_f32 v196, v3, v99
    v_fmac_f32 v196, v4, v100
    v_fmac_f32 v196, v5, v101
    v_fmac_f32 v196, v6, v102
    v_fmac_f32 v196, v7, v103
    v_mul_f32 v198, v8, v128
    v_fmac_f32 v198, v9, v129
    v_fmac_f32 v198, v10, v130
    v_fmac_f32 v198, v11, v131
    v_fmac_f32 v198, v12, v132
    v_fmac_f32 v198, v13, v133
    v_fmac_f32 v198, v14, v134
    v_fmac_f32 v198, v15, v135
    v_mul_f32 v200, v16, v128
    v_fmac_f32 v200, v17, v129
    v_permlane32_swap_b32 v196, v198
    v_mfma_f32_32x32x16_bf16 v[48:63], v[68:71], v[180:183], 0
    s_waitcnt vmcnt(6)
    ds_read_b64_tr_b16 v[176:177], v244 offset:2048
    ds_read_b64_tr_b16 v[178:179], v244 offset:3072
    ds_read_b64_tr_b16 v[180:181], v245 offset:2048
    ds_read_b64_tr_b16 v[182:183], v245 offset:3072
    v_fmac_f32 v200, v18, v130
    v_fmac_f32 v200, v19, v131
    v_fmac_f32 v200, v20, v132
    v_fmac_f32 v200, v21, v133
    v_fmac_f32 v200, v22, v134
    v_fmac_f32 v200, v23, v135
    v_add_f32 v198, v196, v198
    v_mul_f32_e64 v202, v24, -v128
    v_fma_f32 v202, v25, -v129, v202
    v_fma_f32 v202, v26, -v130, v202
    v_fma_f32 v202, v27, -v131, v202
    v_fma_f32 v202, v28, -v132, v202
    v_fma_f32 v202, v29, -v133, v202
    v_fma_f32 v202, v30, -v134, v202
    v_fma_f32 v202, v31, -v135, v202
    s_nop 1
    v_permlane32_swap_b32 v200, v202
    v_add_f32 v202, v200, v202
    s_waitcnt lgkmcnt(0)
    v_mfma_f32_32x32x16_bf16 v[0:15], v[64:67], v[176:179], 0
    v_mul_f32 v197, v32, v104
    v_fmac_f32 v197, v33, v105
    v_fmac_f32 v197, v34, v106
    v_fmac_f32 v197, v35, v107
    v_fmac_f32 v197, v36, v108
    v_fmac_f32 v197, v37, v109
    v_fmac_f32 v197, v38, v110
    v_fmac_f32 v197, v39, v111
    v_mul_f32 v199, v40, v136
    v_fmac_f32 v199, v41, v137
    v_fmac_f32 v199, v42, v138
    v_fmac_f32 v199, v43, v139
    v_fmac_f32 v199, v44, v140
    v_fmac_f32 v199, v45, v141
    v_fmac_f32 v199, v46, v142
    v_fmac_f32 v199, v47, v143
    v_mul_f32 v201, v48, v136
    v_fmac_f32 v201, v49, v137
    v_permlane32_swap_b32 v197, v199
    v_fmac_f32 v201, v50, v138
    v_fmac_f32 v201, v51, v139
    s_add_u32 m0, s21, 2048
    v_mfma_f32_32x32x16_bf16 v[16:31], v[68:71], v[176:179], 0
    v_lshl_add_u32 v236, v236, 10, v246
    v_lshl_add_u32 v237, v237, 10, v246
    buffer_load_dwordx4 v236, s[4:7], s39 offen  lds
    buffer_load_dwordx4 v237, s[8:11], s39 offen offset:1024  lds
    v_fmac_f32 v201, v52, v140
    v_fmac_f32 v201, v53, v141
    v_fmac_f32 v201, v54, v142
    v_fmac_f32 v201, v55, v143
    v_add_f32 v199, v197, v199
    v_mul_f32_e64 v203, v56, -v136
    v_fma_f32 v203, v57, -v137, v203
    v_fma_f32 v203, v58, -v138, v203
    v_fma_f32 v203, v59, -v139, v203
    v_fma_f32 v203, v60, -v140, v203
    v_fma_f32 v203, v61, -v141, v203
    v_fma_f32 v203, v62, -v142, v203
    v_fma_f32 v203, v63, -v143, v203
    s_nop 1
    v_permlane32_swap_b32 v201, v203
    v_add_f32 v203, v201, v203
    s_set_gpr_idx_on s51, gpr_idx(DST)
    s_nop 0
    v_cvt_pk_bf16_f32 v204, v198, v199
    v_cvt_pk_bf16_f32 v205, v202, v203
    s_set_gpr_idx_off
    v_mfma_f32_32x32x16_bf16 v[32:47], v[64:67], v[180:183], 0
    v_mul_f32 v196, v0, v144
    v_fmac_f32 v196, v1, v145
    v_fmac_f32 v196, v2, v146
    v_fmac_f32 v196, v3, v147
    v_fmac_f32 v196, v4, v148
    v_fmac_f32 v196, v5, v149
    v_fmac_f32 v196, v6, v150
    v_fmac_f32 v196, v7, v151
    v_mul_f32 v198, v8, v112
    v_fmac_f32 v198, v9, v113
    v_fmac_f32 v198, v10, v114
    v_fmac_f32 v198, v11, v115
    v_fmac_f32 v198, v12, v116
    v_fmac_f32 v198, v13, v117
    v_fmac_f32 v198, v14, v118
    v_fmac_f32 v198, v15, v119
    v_mfma_f32_32x32x16_bf16 v[48:63], v[68:71], v[180:183], 0
    v_add_u32 v253, s47, v248
    ds_read_b32 v254, v253
    ds_read_b32 v255, v253 offset:256
    s_waitcnt vmcnt(6)
    ds_read_b64_tr_b16 v[176:177], v244 offset:4096
    ds_read_b64_tr_b16 v[178:179], v244 offset:5120
    ds_read_b64_tr_b16 v[180:181], v245 offset:4096
    ds_read_b64_tr_b16 v[182:183], v245 offset:5120
    v_mul_f32_e64 v200, v16, -v160
    v_fma_f32 v200, v17, -v161, v200
    v_fma_f32 v200, v18, -v162, v200
    v_fma_f32 v200, v19, -v163, v200
    v_fma_f32 v200, v20, -v164, v200
    v_fma_f32 v200, v21, -v165, v200
    v_fma_f32 v200, v22, -v166, v200
    v_fma_f32 v200, v23, -v167, v200
    v_mul_f32_e64 v202, v24, -v160
    v_fma_f32 v202, v25, -v161, v202
    v_fma_f32 v202, v26, -v162, v202
    v_fma_f32 v202, v27, -v163, v202
    v_fma_f32 v202, v28, -v164, v202
    v_fma_f32 v202, v29, -v165, v202
    v_fma_f32 v202, v30, -v166, v202
    v_fma_f32 v202, v31, -v167, v202
    s_waitcnt lgkmcnt(0)
    v_mfma_f32_32x32x16_bf16 v[0:15], v[64:67], v[176:179], 0
    v_mul_f32 v197, v32, v152
    v_fmac_f32 v197, v33, v153
    v_fmac_f32 v197, v34, v154
    v_fmac_f32 v197, v35, v155
    v_fmac_f32 v197, v36, v156
    v_fmac_f32 v197, v37, v157
    v_fmac_f32 v197, v38, v158
    v_fmac_f32 v197, v39, v159
    v_mul_f32 v199, v40, v120
    v_fmac_f32 v199, v41, v121
    v_fmac_f32 v199, v42, v122
    v_fmac_f32 v199, v43, v123
    v_fmac_f32 v199, v44, v124
    v_fmac_f32 v199, v45, v125
    v_fmac_f32 v199, v46, v126
    v_fmac_f32 v199, v47, v127
    s_add_u32 m0, s21, 4096
    v_mfma_f32_32x32x16_bf16 v[16:31], v[68:71], v[176:179], 0
    v_lshl_add_u32 v238, v238, 10, v246
    v_lshl_add_u32 v239, v239, 10, v246
    buffer_load_dwordx4 v238, s[4:7], s40 offen  lds
    buffer_load_dwordx4 v239, s[8:11], s40 offen offset:1024  lds
    s_mov_b32 m0, s76
    s_mov_b64 exec, s[72:73]
    buffer_load_dwordx4 v254, s[12:15], 0 offen  lds
    s_mov_b32 m0, s77
    s_mov_b64 exec, s[74:75]
    buffer_load_dwordx4 v255, s[12:15], 0 offen  lds
    s_mov_b64 exec, -1
    v_mul_f32_e64 v201, v48, -v168
    v_fma_f32 v201, v49, -v169, v201
    v_fma_f32 v201, v50, -v170, v201
    v_fma_f32 v201, v51, -v171, v201
    v_fma_f32 v201, v52, -v172, v201
    v_fma_f32 v201, v53, -v173, v201
    v_fma_f32 v201, v54, -v174, v201
    v_fma_f32 v201, v55, -v175, v201
    v_mul_f32_e64 v203, v56, -v168
    v_fma_f32 v203, v57, -v169, v203
    v_fma_f32 v203, v58, -v170, v203
    v_fma_f32 v203, v59, -v171, v203
    v_fma_f32 v203, v60, -v172, v203
    v_fma_f32 v203, v61, -v173, v203
    v_fma_f32 v203, v62, -v174, v203
    v_fma_f32 v203, v63, -v175, v203
    v_mfma_f32_32x32x16_bf16 v[32:47], v[64:67], v[180:183], 0
    v_mul_f32 v254, v0, v144
    v_fmac_f32 v254, v1, v145
    v_fmac_f32 v254, v2, v146
    v_fmac_f32 v254, v3, v147
    v_fmac_f32 v254, v4, v148
    v_fmac_f32 v254, v5, v149
    v_fmac_f32 v254, v6, v150
    v_fmac_f32 v254, v7, v151
    v_fmac_f32 v200, v8, v160
    v_mfma_f32_32x32x16_bf16 v[48:63], v[68:71], v[180:183], 0
    ds_swizzle_b32 v68, v68 offset:0x401F
    ds_swizzle_b32 v69, v69 offset:0x401F
    ds_swizzle_b32 v70, v70 offset:0x401F
    ds_swizzle_b32 v71, v71 offset:0x401F
    s_waitcnt vmcnt(8)
    ds_read_b64_tr_b16 v[176:177], v244 offset:6144
    ds_read_b64_tr_b16 v[178:179], v244 offset:7168
    ds_read_b64_tr_b16 v[180:181], v245 offset:6144
    ds_read_b64_tr_b16 v[182:183], v245 offset:7168
    v_fmac_f32 v200, v9, v161
    v_permlane32_swap_b32 v196, v254
    v_fmac_f32 v200, v10, v162
    v_fmac_f32 v200, v11, v163
    v_fmac_f32 v200, v12, v164
    v_fmac_f32 v200, v13, v165
    v_fmac_f32 v200, v14, v166
    v_fmac_f32 v200, v15, v167
    v_add_f32 v254, v196, v254
    s_waitcnt lgkmcnt(0)
    s_mov_b64 exec, s[56:57]
    v_xor_b32 v68, 0x80008000, v68
    v_xor_b32 v69, 0x80008000, v69
    v_xor_b32 v70, 0x80008000, v70
    v_xor_b32 v71, 0x80008000, v71
    s_mov_b64 exec, -1
    s_nop 0
    v_mfma_f32_32x32x16_bf16 v[0:15], v[64:67], v[176:179], 0
    v_mul_f32 v255, v32, v152
    v_fmac_f32 v255, v33, v153
    v_fmac_f32 v255, v34, v154
    v_fmac_f32 v255, v35, v155
    v_fmac_f32 v255, v36, v156
    v_fmac_f32 v255, v37, v157
    v_fmac_f32 v255, v38, v158
    v_fmac_f32 v255, v39, v159
    v_fmac_f32 v201, v40, v168
    v_fmac_f32 v201, v41, v169
    v_permlane32_swap_b32 v197, v255
    s_add_u32 m0, s21, 6144
    v_mfma_f32_32x32x16_bf16 v[16:31], v[68:71], v[176:179], v[16:31]
    v_lshl_add_u32 v240, v240, 10, v246
    v_lshl_add_u32 v241, v241, 10, v246
    buffer_load_dwordx4 v240, s[4:7], s41 offen  lds
    buffer_load_dwordx4 v241, s[8:11], s41 offen offset:1024  lds
    v_fmac_f32 v201, v42, v170
    v_fmac_f32 v201, v43, v171
    v_fmac_f32 v201, v44, v172
    v_fmac_f32 v201, v45, v173
    v_fmac_f32 v201, v46, v174
    v_fmac_f32 v201, v47, v175
    v_add_f32 v255, v197, v255
    s_set_gpr_idx_on s51, gpr_idx(DST)
    s_nop 0
    v_cvt_pk_bf16_f32 v206, v254, v255
    s_set_gpr_idx_off
    v_mfma_f32_32x32x16_bf16 v[32:47], v[64:67], v[180:183], 0
    v_mul_f32 v254, v0, v144
    v_fmac_f32 v254, v1, v145
    v_fmac_f32 v254, v2, v146
    v_fmac_f32 v254, v3, v147
    v_fmac_f32 v254, v4, v148
    v_fmac_f32 v254, v5, v149
    v_fmac_f32 v254, v6, v150
    v_fmac_f32 v254, v7, v151
    v_fma_f32 v202, v8, -v160, v202
    v_fma_f32 v202, v9, -v161, v202
    v_permlane32_swap_b32 v254, v200
    v_fma_f32 v202, v10, -v162, v202
    v_fma_f32 v202, v11, -v163, v202
    v_fma_f32 v202, v12, -v164, v202
    v_fma_f32 v202, v13, -v165, v202
    v_fma_f32 v202, v14, -v166, v202
    v_fma_f32 v202, v15, -v167, v202
    v_add_f32 v200, v254, v200
    v_fmac_f32 v198, v16, v112
    v_permlane32_swap_b32 v202, v254
    v_mfma_f32_32x32x16_bf16 v[48:63], v[68:71], v[180:183], v[48:63]
    s_waitcnt vmcnt(8)
    ds_read_b64_tr_b16 v[176:177], v244 offset:0
    ds_read_b64_tr_b16 v[178:179], v244 offset:1024
    ds_read_b64_tr_b16 v[180:181], v245 offset:0
    ds_read_b64_tr_b16 v[182:183], v245 offset:1024
    v_add_u32 v249, s48, v249
    v_add_u32 v250, s49, v250
    s_waitcnt vmcnt(2)
    ds_read_b64_tr_b16 v[64:65], v249 offset:0
    ds_read_b64_tr_b16 v[68:69], v249 offset:64
    ds_read_b64_tr_b16 v[66:67], v249 offset:256
    ds_read_b64_tr_b16 v[70:71], v249 offset:320
    s_mov_b64 exec, s[54:55]
    ds_read_u16_d16_hi v242, v250 offset:0
    s_mov_b64 exec, -1
    v_fmac_f32 v198, v17, v113
    v_fmac_f32 v198, v18, v114
    v_fmac_f32 v198, v19, v115
    v_fmac_f32 v198, v20, v116
    v_fmac_f32 v198, v21, v117
    v_fmac_f32 v198, v22, v118
    v_fmac_f32 v198, v23, v119
    v_add_f32 v254, v202, v254
    v_mul_f32 v196, v24, v160
    v_fmac_f32 v196, v25, v161
    v_fmac_f32 v196, v26, v162
    v_fmac_f32 v196, v27, v163
    v_fmac_f32 v196, v28, v164
    v_fmac_f32 v196, v29, v165
    v_fmac_f32 v196, v30, v166
    v_fmac_f32 v196, v31, v167
    s_nop 1
    v_permlane32_swap_b32 v198, v196
    v_add_f32 v196, v198, v196
    v_mul_f32 v255, v32, v152
    v_fmac_f32 v255, v33, v153
    v_fmac_f32 v255, v34, v154
    v_fmac_f32 v255, v35, v155
    v_fmac_f32 v255, v36, v156
    v_fmac_f32 v255, v37, v157
    v_fmac_f32 v255, v38, v158
    v_fmac_f32 v255, v39, v159
    v_fma_f32 v203, v40, -v168, v203
    v_fma_f32 v203, v41, -v169, v203
    v_permlane32_swap_b32 v255, v201
    v_fma_f32 v203, v42, -v170, v203
    v_fma_f32 v203, v43, -v171, v203
    v_fma_f32 v203, v44, -v172, v203
    v_fma_f32 v203, v45, -v173, v203
    v_fma_f32 v203, v46, -v174, v203
    v_fma_f32 v203, v47, -v175, v203
    v_add_f32 v201, v255, v201
    v_fmac_f32 v199, v48, v120
    v_permlane32_swap_b32 v203, v255
    v_fmac_f32 v199, v49, v121
    v_fmac_f32 v199, v50, v122
    v_fmac_f32 v199, v51, v123
    v_fmac_f32 v199, v52, v124
    v_fmac_f32 v199, v53, v125
    v_fmac_f32 v199, v54, v126
    v_fmac_f32 v199, v55, v127
    v_add_f32 v255, v203, v255
    v_mul_f32 v197, v56, v168
    v_fmac_f32 v197, v57, v169
    v_fmac_f32 v197, v58, v170
    v_fmac_f32 v197, v59, v171
    v_fmac_f32 v197, v60, v172
    v_fmac_f32 v197, v61, v173
    v_fmac_f32 v197, v62, v174
    v_fmac_f32 v197, v63, v175
    s_nop 1
    v_permlane32_swap_b32 v199, v197
    v_add_f32 v197, v199, v197
    s_set_gpr_idx_on s51, gpr_idx(DST)
    s_nop 0
    v_cvt_pk_bf16_f32 v207, v200, v201
    v_cvt_pk_bf16_f32 v209, v254, v255
    v_cvt_pk_bf16_f32 v208, v196, v197
    s_set_gpr_idx_off
    s_add_u32 s50, s50, 1
    s_add_u32 s51, s51, 6
    s_cmp_ge_u32 s50, 4
    s_cbranch_scc1 LAST0
    s_add_u32 s53, s53, 4
    s_xor_b32 s66, s53, s20
    s_bitcmp1_b32 s66, 2
    s_setprio 1
    s_cbranch_scc1 PRIO_10
    s_setprio 0
PRIO_10:
    s_cmp_eq_u32 s52, 4
    s_cbranch_scc1 ITEM_0_4
    s_cmp_eq_u32 s52, 5
    s_cbranch_scc1 ITEM_0_5
    s_cmp_eq_u32 s52, 3
    s_cbranch_scc1 ITEM_0_3
    s_cmp_eq_u32 s52, 6
    s_cbranch_scc1 ITEM_0_6
    s_cmp_eq_u32 s52, 8
    s_cbranch_scc1 ITEM_0_8
    s_branch ITEM_0_2
.p2align 6
ITEM_1_4:
    s_mov_b64 exec, s[54:55]
    ds_read_u16_d16_hi v243, v250 offset:128
    s_mov_b64 exec, -1
    ds_read_b64_tr_b16 v[72:73], v249 offset:512
    ds_read_b64_tr_b16 v[76:77], v249 offset:576
    ds_read_b64_tr_b16 v[74:75], v249 offset:768
    ds_read_b64_tr_b16 v[78:79], v249 offset:832
    s_waitcnt lgkmcnt(5)
    v_mul_f32_dpp v196, v242, v64 row_newbcast:0 row_mask:0xf bank_mask:0xf
    v_mul_f32_dpp v197, v242, v65 row_newbcast:1 row_mask:0xf bank_mask:0xf
    v_mul_f32_dpp v198, v242, v64 row_newbcast:8 row_mask:0xf bank_mask:0xf
    v_mul_f32_dpp v199, v242, v65 row_newbcast:9 row_mask:0xf bank_mask:0xf
    v_mul_f32_dpp v200, v242, v68 row_newbcast:2 row_mask:0xf bank_mask:0xf
    v_mul_f32_dpp v201, v242, v69 row_newbcast:3 row_mask:0xf bank_mask:0xf
    v_mul_f32_dpp v202, v242, v68 row_newbcast:10 row_mask:0xf bank_mask:0xf
    v_mul_f32_dpp v203, v242, v69 row_newbcast:11 row_mask:0xf bank_mask:0xf
    v_cvt_pk_bf16_f32 v64, v196, v197
    v_cvt_pk_bf16_f32 v68, v198, v199
    v_cvt_pk_bf16_f32 v65, v200, v201
    v_cvt_pk_bf16_f32 v69, v202, v203
    v_mul_f32_dpp v196, v242, v66 row_newbcast:4 row_mask:0xf bank_mask:0xf
    v_mul_f32_dpp v197, v242, v67 row_newbcast:5 row_mask:0xf bank_mask:0xf
    v_mul_f32_dpp v198, v242, v66 row_newbcast:12 row_mask:0xf bank_mask:0xf
    v_mul_f32_dpp v199, v242, v67 row_newbcast:13 row_mask:0xf bank_mask:0xf
    v_mul_f32_dpp v200, v242, v70 row_newbcast:6 row_mask:0xf bank_mask:0xf
    v_mul_f32_dpp v201, v242, v71 row_newbcast:7 row_mask:0xf bank_mask:0xf
    v_mul_f32_dpp v202, v242, v70 row_newbcast:14 row_mask:0xf bank_mask:0xf
    v_mul_f32_dpp v203, v242, v71 row_newbcast:15 row_mask:0xf bank_mask:0xf
    v_cvt_pk_bf16_f32 v66, v196, v197
    v_cvt_pk_bf16_f32 v70, v198, v199
    v_cvt_pk_bf16_f32 v67, v200, v201
    v_cvt_pk_bf16_f32 v71, v202, v203
    s_nop 0
    s_waitcnt vmcnt(4) lgkmcnt(0)
    v_mfma_f32_32x32x16_bf16 v[0:15], v[64:67], v[176:179], 0
    v_mul_f32_dpp v196, v243, v72 row_newbcast:0 row_mask:0xf bank_mask:0xf
    v_mul_f32_dpp v197, v243, v73 row_newbcast:1 row_mask:0xf bank_mask:0xf
    v_mul_f32_dpp v198, v243, v72 row_newbcast:8 row_mask:0xf bank_mask:0xf
    v_mul_f32_dpp v199, v243, v73 row_newbcast:9 row_mask:0xf bank_mask:0xf
    v_mul_f32_dpp v200, v243, v76 row_newbcast:2 row_mask:0xf bank_mask:0xf
    v_mul_f32_dpp v201, v243, v77 row_newbcast:3 row_mask:0xf bank_mask:0xf
    v_mul_f32_dpp v202, v243, v76 row_newbcast:10 row_mask:0xf bank_mask:0xf
    v_mul_f32_dpp v203, v243, v77 row_newbcast:11 row_mask:0xf bank_mask:0xf
    v_cvt_pk_bf16_f32 v72, v196, v197
    v_cvt_pk_bf16_f32 v76, v198, v199
    v_cvt_pk_bf16_f32 v73, v200, v201
    v_cvt_pk_bf16_f32 v77, v202, v203
    s_add_u32 m0, s21, 0
    v_mfma_f32_32x32x16_bf16 v[16:31], v[68:71], v[176:179], 0
    buffer_load_dwordx4 v234, s[4:7], s36 offen  lds
    buffer_load_dwordx4 v235, s[8:11], s36 offen offset:1024  lds
    ds_read_b64_tr_b16 v[176:177], v244 offset:2048
    ds_read_b64_tr_b16 v[178:179], v244 offset:3072
    ds_read_b64_tr_b16 v[184:185], v245 offset:2048
    ds_read_b64_tr_b16 v[186:187], v245 offset:3072
    v_mul_f32_dpp v196, v243, v74 row_newbcast:4 row_mask:0xf bank_mask:0xf
    v_mul_f32_dpp v197, v243, v75 row_newbcast:5 row_mask:0xf bank_mask:0xf
    v_mul_f32_dpp v198, v243, v74 row_newbcast:12 row_mask:0xf bank_mask:0xf
    v_mul_f32_dpp v199, v243, v75 row_newbcast:13 row_mask:0xf bank_mask:0xf
    v_mul_f32_dpp v200, v243, v78 row_newbcast:6 row_mask:0xf bank_mask:0xf
    v_mul_f32_dpp v201, v243, v79 row_newbcast:7 row_mask:0xf bank_mask:0xf
    v_mul_f32_dpp v202, v243, v78 row_newbcast:14 row_mask:0xf bank_mask:0xf
    v_mul_f32_dpp v203, v243, v79 row_newbcast:15 row_mask:0xf bank_mask:0xf
    v_cvt_pk_bf16_f32 v74, v196, v197
    v_cvt_pk_bf16_f32 v78, v198, v199
    v_cvt_pk_bf16_f32 v75, v200, v201
    v_cvt_pk_bf16_f32 v79, v202, v203
    s_nop 0
    s_waitcnt lgkmcnt(0)
    v_mfma_f32_32x32x16_bf16 v[0:15], v[72:75], v[176:179], v[0:15]
    s_add_u32 m0, s21, 2048
    v_mfma_f32_32x32x16_bf16 v[16:31], v[76:79], v[176:179], v[16:31]
    buffer_load_dwordx4 v236, s[4:7], s36 offen  lds
    buffer_load_dwordx4 v237, s[8:11], s36 offen offset:1024  lds
    s_mov_b32 m0, s50
    s_nop 0
    s_movrels_b32 s71, s23
    s_movrels_b32 s33, s28
    v_add_u32 v253, s33, v248
    s_bfe_u32 s46, s71, 0x30012
    s_mov_b32 m0, s46
    s_and_b32 s66, s71, 0x3ffff
    s_movrels_b32 s68, s57
    s_movrels_b32 s69, s61
    s_sub_u32 s48, s66, s47
    s_mov_b32 s47, s66
    s_lshr_b32 s52, s71, 28
    s_lshl_b32 s67, s46, 9
    s_add_u32 s66, s66, s67
    s_sub_u32 s49, s66, s42
    s_mov_b32 s42, s66
    s_bfe_u32 s66, s68, 655360
    s_add_u32 s43, s42, s66
    s_bfe_u32 s39, s69, 655360
    s_bfe_u32 s66, s68, 655370
    s_add_u32 s44, s42, s66
    s_bfe_u32 s40, s69, 655370
    s_bfe_u32 s66, s68, 655380
    s_add_u32 s45, s42, s66
    s_bfe_u32 s41, s69, 655380
    v_add_u32 v252, s44, v247
    ds_read_u16 v238, v252
    ds_read_u16 v239, v252 offset:64
    v_add_u32 v252, s45, v247
    ds_read_u16 v240, v252
    ds_read_u16 v241, v252 offset:64
    v_mfma_f32_32x32x16_bf16 v[32:47], v[64:67], v[180:183], 0
    v_mul_f32 v196, v0, v96
    v_fmac_f32 v196, v1, v97
    v_fmac_f32 v196, v2, v98
    v_fmac_f32 v196, v3, v99
    v_fmac_f32 v196, v4, v100
    v_fmac_f32 v196, v5, v101
    v_fmac_f32 v196, v6, v102
    v_fmac_f32 v196, v7, v103
    v_mul_f32 v198, v8, v128
    v_fmac_f32 v198, v9, v129
    v_mfma_f32_32x32x16_bf16 v[48:63], v[68:71], v[180:183], 0
    s_waitcnt vmcnt(6)
    ds_read_b64_tr_b16 v[176:177], v244 offset:4096
    ds_read_b64_tr_b16 v[178:179], v244 offset:5120
    ds_read_b64_tr_b16 v[180:181], v245 offset:4096
    ds_read_b64_tr_b16 v[182:183], v245 offset:5120
    v_fmac_f32 v198, v10, v130
    v_fmac_f32 v198, v11, v131
    v_fmac_f32 v198, v12, v132
    v_fmac_f32 v198, v13, v133
    v_fmac_f32 v198, v14, v134
    v_fmac_f32 v198, v15, v135
    v_mul_f32 v200, v16, v128
    v_fmac_f32 v200, v17, v129
    v_permlane32_swap_b32 v196, v198
    v_mfma_f32_32x32x16_bf16 v[32:47], v[72:75], v[184:187], v[32:47]
    v_fmac_f32 v200, v18, v130
    v_fmac_f32 v200, v19, v131
    v_fmac_f32 v200, v20, v132
    v_fmac_f32 v200, v21, v133
    v_fmac_f32 v200, v22, v134
    v_fmac_f32 v200, v23, v135
    v_add_f32 v198, v196, v198
    v_mul_f32_e64 v202, v24, -v128
    v_fma_f32 v202, v25, -v129, v202
    v_mfma_f32_32x32x16_bf16 v[48:63], v[76:79], v[184:187], v[48:63]
    v_fma_f32 v202, v26, -v130, v202
    v_fma_f32 v202, v27, -v131, v202
    v_fma_f32 v202, v28, -v132, v202
    v_fma_f32 v202, v29, -v133, v202
    v_fma_f32 v202, v30, -v134, v202
    v_fma_f32 v202, v31, -v135, v202
    s_nop 1
    v_permlane32_swap_b32 v200, v202
    v_add_f32 v202, v200, v202
    s_waitcnt vmcnt(4) lgkmcnt(0)
    v_mfma_f32_32x32x16_bf16 v[0:15], v[64:67], v[176:179], 0
    v_mul_f32 v197, v32, v104
    v_fmac_f32 v197, v33, v105
    v_fmac_f32 v197, v34, v106
    v_fmac_f32 v197, v35, v107
    v_fmac_f32 v197, v36, v108
    v_fmac_f32 v197, v37, v109
    v_fmac_f32 v197, v38, v110
    v_fmac_f32 v197, v39, v111
    v_mul_f32 v199, v40, v136
    v_fmac_f32 v199, v41, v137
    s_add_u32 m0, s21, 4096
    v_mfma_f32_32x32x16_bf16 v[16:31], v[68:71], v[176:179], 0
    buffer_load_dwordx4 v234, s[4:7], s37 offen  lds
    buffer_load_dwordx4 v235, s[8:11], s37 offen offset:1024  lds
    ds_read_b64_tr_b16 v[176:177], v244 offset:6144
    ds_read_b64_tr_b16 v[178:179], v244 offset:7168
    ds_read_b64_tr_b16 v[184:185], v245 offset:6144
    ds_read_b64_tr_b16 v[186:187], v245 offset:7168
    v_add_u32 v252, s42, v247
    ds_read_u16 v234, v252
    ds_read_u16 v235, v252 offset:64
    v_fmac_f32 v199, v42, v138
    v_fmac_f32 v199, v43, v139
    v_fmac_f32 v199, v44, v140
    v_fmac_f32 v199, v45, v141
    v_fmac_f32 v199, v46, v142
    v_fmac_f32 v199, v47, v143
    v_mul_f32 v201, v48, v136
    v_fmac_f32 v201, v49, v137
    v_permlane32_swap_b32 v197, v199
    v_fmac_f32 v201, v50, v138
    s_waitcnt lgkmcnt(2)
    v_mfma_f32_32x32x16_bf16 v[0:15], v[72:75], v[176:179], v[0:15]
    v_fmac_f32 v201, v51, v139
    v_fmac_f32 v201, v52, v140
    v_fmac_f32 v201, v53, v141
    v_fmac_f32 v201, v54, v142
    v_fmac_f32 v201, v55, v143
    v_add_f32 v199, v197, v199
    v_mul_f32_e64 v203, v56, -v136
    v_fma_f32 v203, v57, -v137, v203
    v_fma_f32 v203, v58, -v138, v203
    v_fma_f32 v203, v59, -v139, v203
    s_add_u32 m0, s21, 6144
    v_mfma_f32_32x32x16_bf16 v[16:31], v[76:79], v[176:179], v[16:31]
    buffer_load_dwordx4 v236, s[4:7], s37 offen  lds
    buffer_load_dwordx4 v237, s[8:11], s37 offen offset:1024  lds
    v_add_u32 v252, s43, v247
    ds_read_u16 v236, v252
    ds_read_u16 v237, v252 offset:64
    v_fma_f32 v203, v60, -v140, v203
    v_fma_f32 v203, v61, -v141, v203
    v_fma_f32 v203, v62, -v142, v203
    v_fma_f32 v203, v63, -v143, v203
    s_nop 1
    v_permlane32_swap_b32 v201, v203
    v_add_f32 v203, v201, v203
    v_cvt_pk_bf16_f32 v192, v198, v199
    v_cvt_pk_bf16_f32 v193, v202, v203
    v_mfma_f32_32x32x16_bf16 v[32:47], v[64:67], v[180:183], 0
    v_mul_f32 v196, v0, v144
    v_fmac_f32 v196, v1, v145
    v_fmac_f32 v196, v2, v146
    v_fmac_f32 v196, v3, v147
    v_fmac_f32 v196, v4, v148
    v_fmac_f32 v196, v5, v149
    v_fmac_f32 v196, v6, v150
    v_fmac_f32 v196, v7, v151
    v_mfma_f32_32x32x16_bf16 v[48:63], v[68:71], v[180:183], 0
    s_waitcnt vmcnt(6)
    ds_read_b64_tr_b16 v[176:177], v244 offset:0
    ds_read_b64_tr_b16 v[178:179], v244 offset:1024
    ds_read_b64_tr_b16 v[180:181], v245 offset:0
    ds_read_b64_tr_b16 v[182:183], v245 offset:1024
    v_mul_f32 v198, v8, v112
    v_fmac_f32 v198, v9, v113
    v_fmac_f32 v198, v10, v114
    v_fmac_f32 v198, v11, v115
    v_fmac_f32 v198, v12, v116
    v_fmac_f32 v198, v13, v117
    v_fmac_f32 v198, v14, v118
    v_fmac_f32 v198, v15, v119
    v_mfma_f32_32x32x16_bf16 v[32:47], v[72:75], v[184:187], v[32:47]
    v_mul_f32_e64 v200, v16, -v160
    v_fma_f32 v200, v17, -v161, v200
    v_fma_f32 v200, v18, -v162, v200
    v_fma_f32 v200, v19, -v163, v200
    v_fma_f32 v200, v20, -v164, v200
    v_fma_f32 v200, v21, -v165, v200
    v_fma_f32 v200, v22, -v166, v200
    v_fma_f32 v200, v23, -v167, v200
    v_mfma_f32_32x32x16_bf16 v[48:63], v[76:79], v[184:187], v[48:63]
    v_mul_f32_e64 v202, v24, -v160
    v_fma_f32 v202, v25, -v161, v202
    v_fma_f32 v202, v26, -v162, v202
    v_fma_f32 v202, v27, -v163, v202
    v_fma_f32 v202, v28, -v164, v202
    v_fma_f32 v202, v29, -v165, v202
    v_fma_f32 v202, v30, -v166, v202
    v_fma_f32 v202, v31, -v167, v202
    s_waitcnt vmcnt(4) lgkmcnt(0)
    v_mfma_f32_32x32x16_bf16 v[0:15], v[64:67], v[176:179], 0
    v_mul_f32 v197, v32, v152
    v_fmac_f32 v197, v33, v153
    v_fmac_f32 v197, v34, v154
    v_fmac_f32 v197, v35, v155
    v_fmac_f32 v197, v36, v156
    v_fmac_f32 v197, v37, v157
    v_fmac_f32 v197, v38, v158
    v_fmac_f32 v197, v39, v159
    s_add_u32 m0, s21, 0
    s_cmp_eq_u32 s50, 4
    v_mfma_f32_32x32x16_bf16 v[16:31], v[68:71], v[176:179], 0
    s_cbranch_scc1 WL_4_0
    v_lshl_add_u32 v234, v234, 10, v246
    v_lshl_add_u32 v235, v235, 10, v246
    buffer_load_dwordx4 v234, s[4:7], s38 offen  lds
    buffer_load_dwordx4 v235, s[8:11], s38 offen offset:1024  lds
WR_4_0:
    ds_read_b64_tr_b16 v[176:177], v244 offset:2048
    ds_read_b64_tr_b16 v[178:179], v244 offset:3072
    ds_read_b64_tr_b16 v[184:185], v245 offset:2048
    ds_read_b64_tr_b16 v[186:187], v245 offset:3072
    v_mul_f32 v199, v40, v120
    v_fmac_f32 v199, v41, v121
    v_fmac_f32 v199, v42, v122
    v_fmac_f32 v199, v43, v123
    v_fmac_f32 v199, v44, v124
    v_fmac_f32 v199, v45, v125
    v_fmac_f32 v199, v46, v126
    v_fmac_f32 v199, v47, v127
    s_waitcnt lgkmcnt(0)
    v_mfma_f32_32x32x16_bf16 v[0:15], v[72:75], v[176:179], v[0:15]
    v_mul_f32_e64 v201, v48, -v168
    v_fma_f32 v201, v49, -v169, v201
    v_fma_f32 v201, v50, -v170, v201
    v_fma_f32 v201, v51, -v171, v201
    v_fma_f32 v201, v52, -v172, v201
    v_fma_f32 v201, v53, -v173, v201
    v_fma_f32 v201, v54, -v174, v201
    v_fma_f32 v201, v55, -v175, v201
    s_add_u32 m0, s21, 2048
    s_cmp_eq_u32 s50, 4
    v_mfma_f32_32x32x16_bf16 v[16:31], v[76:79], v[176:179], v[16:31]
    s_cbranch_scc1 WL_4_1
    v_lshl_add_u32 v236, v236, 10, v246
    v_lshl_add_u32 v237, v237, 10, v246
    buffer_load_dwordx4 v236, s[4:7], s39 offen  lds
    buffer_load_dwordx4 v237, s[8:11], s39 offen offset:1024  lds
WR_4_1:
    v_mul_f32_e64 v203, v56, -v168
    v_fma_f32 v203, v57, -v169, v203
    v_fma_f32 v203, v58, -v170, v203
    v_fma_f32 v203, v59, -v171, v203
    v_fma_f32 v203, v60, -v172, v203
    v_fma_f32 v203, v61, -v173, v203
    v_fma_f32 v203, v62, -v174, v203
    v_fma_f32 v203, v63, -v175, v203
    v_mfma_f32_32x32x16_bf16 v[32:47], v[64:67], v[180:183], 0
    v_mul_f32 v254, v0, v144
    v_fmac_f32 v254, v1, v145
    v_fmac_f32 v254, v2, v146
    v_fmac_f32 v254, v3, v147
    v_fmac_f32 v254, v4, v148
    v_mfma_f32_32x32x16_bf16 v[48:63], v[68:71], v[180:183], 0
    ds_swizzle_b32 v68, v68 offset:0x401F
    ds_swizzle_b32 v69, v69 offset:0x401F
    ds_swizzle_b32 v70, v70 offset:0x401F
    ds_swizzle_b32 v71, v71 offset:0x401F
    s_waitcnt vmcnt(6)
    ds_read_b64_tr_b16 v[176:177], v244 offset:4096
    ds_read_b64_tr_b16 v[178:179], v244 offset:5120
    ds_read_b64_tr_b16 v[180:181], v245 offset:4096
    ds_read_b64_tr_b16 v[182:183], v245 offset:5120
    v_fmac_f32 v254, v5, v149
    v_fmac_f32 v254, v6, v150
    v_fmac_f32 v254, v7, v151
    v_fmac_f32 v200, v8, v160
    v_mfma_f32_32x32x16_bf16 v[32:47], v[72:75], v[184:187], v[32:47]
    v_fmac_f32 v200, v9, v161
    v_permlane32_swap_b32 v196, v254
    v_fmac_f32 v200, v10, v162
    v_fmac_f32 v200, v11, v163
    v_fmac_f32 v200, v12, v164
    v_mfma_f32_32x32x16_bf16 v[48:63], v[76:79], v[184:187], v[48:63]
    ds_swizzle_b32 v76, v76 offset:0x401F
    ds_swizzle_b32 v77, v77 offset:0x401F
    ds_swizzle_b32 v78, v78 offset:0x401F
    ds_swizzle_b32 v79, v79 offset:0x401F
    v_fmac_f32 v200, v13, v165
    v_fmac_f32 v200, v14, v166
    v_fmac_f32 v200, v15, v167
    v_add_f32 v254, v196, v254
    s_waitcnt lgkmcnt(8)
    s_mov_b64 exec, s[56:57]
    v_xor_b32 v68, 0x80008000, v68
    v_xor_b32 v69, 0x80008000, v69
    v_xor_b32 v70, 0x80008000, v70
    v_xor_b32 v71, 0x80008000, v71
    s_mov_b64 exec, -1
    s_waitcnt vmcnt(4) lgkmcnt(4)
    v_mfma_f32_32x32x16_bf16 v[0:15], v[64:67], v[176:179], 0
    v_mul_f32 v255, v32, v152
    v_fmac_f32 v255, v33, v153
    v_fmac_f32 v255, v34, v154
    v_fmac_f32 v255, v35, v155
    v_fmac_f32 v255, v36, v156
    s_add_u32 m0, s21, 4096
    s_cmp_eq_u32 s50, 4
    v_mfma_f32_32x32x16_bf16 v[16:31], v[68:71], v[176:179], v[16:31]
    s_cbranch_scc1 WL_4_2
    v_lshl_add_u32 v238, v238, 10, v246
    v_lshl_add_u32 v239, v239, 10, v246
    buffer_load_dwordx4 v238, s[4:7], s40 offen  lds
    buffer_load_dwordx4 v239, s[8:11], s40 offen offset:1024  lds
WR_4_2:
    ds_read_b64_tr_b16 v[176:177], v244 offset:6144
    ds_read_b64_tr_b16 v[178:179], v244 offset:7168
    ds_read_b64_tr_b16 v[184:185], v245 offset:6144
    ds_read_b64_tr_b16 v[186:187], v245 offset:7168
    v_fmac_f32 v255, v37, v157
    v_fmac_f32 v255, v38, v158
    v_fmac_f32 v255, v39, v159
    v_fmac_f32 v201, v40, v168
    v_fmac_f32 v201, v41, v169
    s_waitcnt lgkmcnt(0)
    s_mov_b64 exec, s[56:57]
    v_xor_b32 v76, 0x80008000, v76
    v_xor_b32 v77, 0x80008000, v77
    v_xor_b32 v78, 0x80008000, v78
    v_xor_b32 v79, 0x80008000, v79
    s_mov_b64 exec, -1
    v_mfma_f32_32x32x16_bf16 v[0:15], v[72:75], v[176:179], v[0:15]
    v_permlane32_swap_b32 v197, v255
    v_fmac_f32 v201, v42, v170
    v_fmac_f32 v201, v43, v171
    v_fmac_f32 v201, v44, v172
    v_fmac_f32 v201, v45, v173
    s_add_u32 m0, s21, 6144
    s_cmp_eq_u32 s50, 4
    v_mfma_f32_32x32x16_bf16 v[16:31], v[76:79], v[176:179], v[16:31]
    s_cbranch_scc1 WL_4_3
    v_lshl_add_u32 v240, v240, 10, v246
    v_lshl_add_u32 v241, v241, 10, v246
    buffer_load_dwordx4 v240, s[4:7], s41 offen  lds
    buffer_load_dwordx4 v241, s[8:11], s41 offen offset:1024  lds
WR_4_3:
    v_fmac_f32 v201, v46, v174
    v_fmac_f32 v201, v47, v175
    v_add_f32 v255, v197, v255
    v_cvt_pk_bf16_f32 v194, v254, v255
    v_mfma_f32_32x32x16_bf16 v[32:47], v[64:67], v[180:183], 0
    v_mul_f32 v254, v0, v144
    v_fmac_f32 v254, v1, v145
    v_fmac_f32 v254, v2, v146
    v_fmac_f32 v254, v3, v147
    v_fmac_f32 v254, v4, v148
    v_fmac_f32 v254, v5, v149
    v_fmac_f32 v254, v6, v150
    v_fmac_f32 v254, v7, v151
    v_fma_f32 v202, v8, -v160, v202
    v_fma_f32 v202, v9, -v161, v202
    v_mfma_f32_32x32x16_bf16 v[48:63], v[68:71], v[180:183], v[48:63]
    s_waitcnt vmcnt(6)
    ds_read_b64_tr_b16 v[176:177], v244 offset:0
    ds_read_b64_tr_b16 v[178:179], v244 offset:1024
    ds_read_b64_tr_b16 v[180:181], v245 offset:0
    ds_read_b64_tr_b16 v[182:183], v245 offset:1024
    v_permlane32_swap_b32 v254, v200
    v_fma_f32 v202, v10, -v162, v202
    v_fma_f32 v202, v11, -v163, v202
    v_fma_f32 v202, v12, -v164, v202
    v_fma_f32 v202, v13, -v165, v202
    v_fma_f32 v202, v14, -v166, v202
    v_fma_f32 v202, v15, -v167, v202
    v_add_f32 v200, v254, v200
    v_fmac_f32 v198, v16, v112
    v_permlane32_swap_b32 v202, v254
    v_mfma_f32_32x32x16_bf16 v[32:47], v[72:75], v[184:187], v[32:47]
    v_fmac_f32 v198, v17, v113
    v_fmac_f32 v198, v18, v114
    v_fmac_f32 v198, v19, v115
    v_fmac_f32 v198, v20, v116
    v_fmac_f32 v198, v21, v117
    v_fmac_f32 v198, v22, v118
    v_fmac_f32 v198, v23, v119
    v_add_f32 v254, v202, v254
    v_mul_f32 v196, v24, v160
    v_fmac_f32 v196, v25, v161
    v_mfma_f32_32x32x16_bf16 v[48:63], v[76:79], v[184:187], v[48:63]
    v_add_u32 v249, s48, v249
    v_add_u32 v250, s49, v250
    ds_read_b32 v252, v251 offset:16
    ds_read_b64_tr_b16 v[64:65], v249 offset:0
    ds_read_b64_tr_b16 v[68:69], v249 offset:64
    ds_read_b64_tr_b16 v[66:67], v249 offset:256
    ds_read_b64_tr_b16 v[70:71], v249 offset:320
    s_mov_b64 exec, s[54:55]
    ds_read_u16_d16_hi v242, v250 offset:0
    s_mov_b64 exec, -1
    v_fmac_f32 v196, v26, v162
    v_fmac_f32 v196, v27, v163
    v_fmac_f32 v196, v28, v164
    v_fmac_f32 v196, v29, v165
    v_fmac_f32 v196, v30, v166
    v_fmac_f32 v196, v31, v167
    s_nop 1
    v_permlane32_swap_b32 v198, v196
    v_add_f32 v196, v198, v196
    s_cmp_eq_u32 s50, 4
    s_cbranch_scc1 LEPI_0
    v_mul_f32 v255, v32, v152
    v_fmac_f32 v255, v33, v153
    v_fmac_f32 v255, v34, v154
    v_fmac_f32 v255, v35, v155
    v_fmac_f32 v255, v36, v156
    v_fmac_f32 v255, v37, v157
    v_fmac_f32 v255, v38, v158
    v_fmac_f32 v255, v39, v159
    v_fma_f32 v203, v40, -v168, v203
    v_fma_f32 v203, v41, -v169, v203
    v_permlane32_swap_b32 v255, v201
    v_fma_f32 v203, v42, -v170, v203
    v_fma_f32 v203, v43, -v171, v203
    v_fma_f32 v203, v44, -v172, v203
    v_fma_f32 v203, v45, -v173, v203
    v_fma_f32 v203, v46, -v174, v203
    v_fma_f32 v203, v47, -v175, v203
    v_add_f32 v201, v255, v201
    v_fmac_f32 v199, v48, v120
    v_permlane32_swap_b32 v203, v255
    v_fmac_f32 v199, v49, v121
    v_fmac_f32 v199, v50, v122
    v_fmac_f32 v199, v51, v123
    v_fmac_f32 v199, v52, v124
    v_fmac_f32 v199, v53, v125
    v_fmac_f32 v199, v54, v126
    v_fmac_f32 v199, v55, v127
    v_add_f32 v255, v203, v255
    v_mul_f32 v197, v56, v168
    v_fmac_f32 v197, v57, v169
    v_fmac_f32 v197, v58, v170
    v_fmac_f32 v197, v59, v171
    v_fmac_f32 v197, v60, v172
    v_fmac_f32 v197, v61, v173
    v_fmac_f32 v197, v62, v174
    v_fmac_f32 v197, v63, v175
    s_nop 1
    v_permlane32_swap_b32 v199, v197
    v_add_f32 v197, v199, v197
    v_cvt_pk_bf16_f32 v200, v200, v201
    v_cvt_pk_bf16_f32 v254, v254, v255
    v_cvt_pk_bf16_f32 v196, v196, v197
    ds_write2st64_b32 v253, v192, v193 offset0:0 offset1:1
    ds_write2st64_b32 v253, v194, v200 offset0:2 offset1:3
    ds_write_b32 v253, v196 offset:1024
    s_mov_b64 exec, 0xffffffff
    ds_write_b32 v253, v254 offset:1280
    s_mov_b64 exec, -1
    s_add_u32 s50, s50, 1
    s_cmp_ge_u32 s50, 4
    s_cbranch_scc1 LAST1
    s_waitcnt lgkmcnt(9)
    v_readfirstlane_b32 s66, v252
    s_add_u32 s53, s53, 1
    v_mov_b32 v252, s53
    s_cmp_le_u32 s53, s66
    ds_write2_b32 v251, v252, v252 offset0:0 offset1:8
    s_setprio 1
    s_cbranch_scc1 PRIO_11
    s_setprio 0
PRIO_11:
    s_cmp_eq_u32 s52, 4
    s_cbranch_scc1 ITEM_1_4
    s_cmp_eq_u32 s52, 5
    s_cbranch_scc1 ITEM_1_5
    s_cmp_eq_u32 s52, 3
    s_cbranch_scc1 ITEM_1_3
    s_cmp_eq_u32 s52, 6
    s_cbranch_scc1 ITEM_1_6
    s_cmp_eq_u32 s52, 8
    s_cbranch_scc1 ITEM_1_8
    s_branch ITEM_1_2
WL_4_0:
    s_add_u32 s66, s51, 0
    buffer_load_dwordx4 v[96:99], v246, s[16:19], s66 offen offset:2048 sc1
    buffer_load_dwordx4 v[100:103], v246, s[16:19], s66 offen offset:3072 sc1
    s_branch WR_4_0
WL_4_1:
    s_add_u32 s66, s51, 4096
    buffer_load_dwordx4 v[104:107], v246, s[16:19], s66 offen offset:2048 sc1
    buffer_load_dwordx4 v[108:111], v246, s[16:19], s66 offen offset:3072 sc1
    s_branch WR_4_1
WL_4_2:
    s_add_u32 s66, s51, 8192
    buffer_load_dwordx4 v[128:131], v246, s[16:19], s66 offen offset:2048 sc1
    buffer_load_dwordx4 v[132:135], v246, s[16:19], s66 offen offset:3072 sc1
    s_branch WR_4_2
WL_4_3:
    s_add_u32 s66, s51, 12288
    buffer_load_dwordx4 v[136:139], v246, s[16:19], s66 offen offset:2048 sc1
    buffer_load_dwordx4 v[140:143], v246, s[16:19], s66 offen offset:3072 sc1
    s_branch WR_4_3
.p2align 6
ITEM_1_5:
    s_mov_b64 exec, s[54:55]
    ds_read_u16_d16_hi v243, v250 offset:128
    s_mov_b64 exec, -1
    ds_read_b64_tr_b16 v[72:73], v249 offset:512
    ds_read_b64_tr_b16 v[76:77], v249 offset:576
    ds_read_b64_tr_b16 v[74:75], v249 offset:768
    ds_read_b64_tr_b16 v[78:79], v249 offset:832
    ds_read_b64_tr_b16 v[80:81], v249 offset:1024
    ds_read_b64_tr_b16 v[84:85], v249 offset:1088
    s_waitcnt lgkmcnt(7)
    v_mul_f32_dpp v196, v242, v64 row_newbcast:0 row_mask:0xf bank_mask:0xf
    v_mul_f32_dpp v197, v242, v65 row_newbcast:1 row_mask:0xf bank_mask:0xf
    v_mul_f32_dpp v198, v242, v64 row_newbcast:8 row_mask:0xf bank_mask:0xf
    v_mul_f32_dpp v199, v242, v65 row_newbcast:9 row_mask:0xf bank_mask:0xf
    v_mul_f32_dpp v200, v242, v68 row_newbcast:2 row_mask:0xf bank_mask:0xf
    v_mul_f32_dpp v201, v242, v69 row_newbcast:3 row_mask:0xf bank_mask:0xf
    v_mul_f32_dpp v202, v242, v68 row_newbcast:10 row_mask:0xf bank_mask:0xf
    v_mul_f32_dpp v203, v242, v69 row_newbcast:11 row_mask:0xf bank_mask:0xf
    v_cvt_pk_bf16_f32 v64, v196, v197
    v_cvt_pk_bf16_f32 v68, v198, v199
    v_cvt_pk_bf16_f32 v65, v200, v201
    v_cvt_pk_bf16_f32 v69, v202, v203
    v_mul_f32_dpp v196, v242, v66 row_newbcast:4 row_mask:0xf bank_mask:0xf
    v_mul_f32_dpp v197, v242, v67 row_newbcast:5 row_mask:0xf bank_mask:0xf
    v_mul_f32_dpp v198, v242, v66 row_newbcast:12 row_mask:0xf bank_mask:0xf
    v_mul_f32_dpp v199, v242, v67 row_newbcast:13 row_mask:0xf bank_mask:0xf
    v_mul_f32_dpp v200, v242, v70 row_newbcast:6 row_mask:0xf bank_mask:0xf
    v_mul_f32_dpp v201, v242, v71 row_newbcast:7 row_mask:0xf bank_mask:0xf
    v_mul_f32_dpp v202, v242, v70 row_newbcast:14 row_mask:0xf bank_mask:0xf
    v_mul_f32_dpp v203, v242, v71 row_newbcast:15 row_mask:0xf bank_mask:0xf
    v_cvt_pk_bf16_f32 v66, v196, v197
    v_cvt_pk_bf16_f32 v70, v198, v199
    v_cvt_pk_bf16_f32 v67, v200, v201
    v_cvt_pk_bf16_f32 v71, v202, v203
    s_mov_b64 exec, s[54:55]
    ds_read_u16_d16_hi v242, v250 offset:256
    s_mov_b64 exec, -1
    s_waitcnt vmcnt(4) lgkmcnt(3)
    v_mfma_f32_32x32x16_bf16 v[0:15], v[64:67], v[176:179], 0
    v_mul_f32_dpp v196, v243, v72 row_newbcast:0 row_mask:0xf bank_mask:0xf
    v_mul_f32_dpp v197, v243, v73 row_newbcast:1 row_mask:0xf bank_mask:0xf
    v_mul_f32_dpp v198, v243, v72 row_newbcast:8 row_mask:0xf bank_mask:0xf
    v_mul_f32_dpp v199, v243, v73 row_newbcast:9 row_mask:0xf bank_mask:0xf
    v_mul_f32_dpp v200, v243, v76 row_newbcast:2 row_mask:0xf bank_mask:0xf
    v_mul_f32_dpp v201, v243, v77 row_newbcast:3 row_mask:0xf bank_mask:0xf
    v_mul_f32_dpp v202, v243, v76 row_newbcast:10 row_mask:0xf bank_mask:0xf
    v_mul_f32_dpp v203, v243, v77 row_newbcast:11 row_mask:0xf bank_mask:0xf
    v_cvt_pk_bf16_f32 v72, v196, v197
    v_cvt_pk_bf16_f32 v76, v198, v199
    v_cvt_pk_bf16_f32 v73, v200, v201
    v_cvt_pk_bf16_f32 v77, v202, v203
    s_add_u32 m0, s21, 0
    v_mfma_f32_32x32x16_bf16 v[16:31], v[68:71], v[176:179], 0
    buffer_load_dwordx4 v236, s[4:7], s35 offen  lds
    buffer_load_dwordx4 v237, s[8:11], s35 offen offset:1024  lds
    ds_read_b64_tr_b16 v[176:177], v244 offset:2048
    ds_read_b64_tr_b16 v[178:179], v244 offset:3072
    ds_read_b64_tr_b16 v[184:185], v245 offset:2048
    ds_read_b64_tr_b16 v[186:187], v245 offset:3072
    v_mul_f32_dpp v196, v243, v74 row_newbcast:4 row_mask:0xf bank_mask:0xf
    v_mul_f32_dpp v197, v243, v75 row_newbcast:5 row_mask:0xf bank_mask:0xf
    v_mul_f32_dpp v198, v243, v74 row_newbcast:12 row_mask:0xf bank_mask:0xf
    v_mul_f32_dpp v199, v243, v75 row_newbcast:13 row_mask:0xf bank_mask:0xf
    v_mul_f32_dpp v200, v243, v78 row_newbcast:6 row_mask:0xf bank_mask:0xf
    v_mul_f32_dpp v201, v243, v79 row_newbcast:7 row_mask:0xf bank_mask:0xf
    v_mul_f32_dpp v202, v243, v78 row_newbcast:14 row_mask:0xf bank_mask:0xf
    v_mul_f32_dpp v203, v243, v79 row_newbcast:15 row_mask:0xf bank_mask:0xf
    v_cvt_pk_bf16_f32 v74, v196, v197
    v_cvt_pk_bf16_f32 v78, v198, v199
    v_cvt_pk_bf16_f32 v75, v200, v201
    v_cvt_pk_bf16_f32 v79, v202, v203
    s_nop 0
    s_waitcnt vmcnt(4) lgkmcnt(0)
    v_mfma_f32_32x32x16_bf16 v[0:15], v[72:75], v[176:179], v[0:15]
    v_mul_f32_dpp v196, v242, v80 row_newbcast:0 row_mask:0xf bank_mask:0xf
    v_mul_f32_dpp v197, v242, v81 row_newbcast:1 row_mask:0xf bank_mask:0xf
    v_mul_f32_dpp v198, v242, v80 row_newbcast:8 row_mask:0xf bank_mask:0xf
    v_mul_f32_dpp v199, v242, v81 row_newbcast:9 row_mask:0xf bank_mask:0xf
    v_mul_f32_dpp v200, v242, v84 row_newbcast:2 row_mask:0xf bank_mask:0xf
    v_mul_f32_dpp v201, v242, v85 row_newbcast:3 row_mask:0xf bank_mask:0xf
    s_add_u32 m0, s21, 2048
    v_mfma_f32_32x32x16_bf16 v[16:31], v[76:79], v[176:179], v[16:31]
    buffer_load_dwordx4 v238, s[4:7], s35 offen  lds
    ds_read_b64_tr_b16 v[176:177], v244 offset:4096
    ds_read_b64_tr_b16 v[188:189], v245 offset:4096
    v_mul_f32_dpp v202, v242, v84 row_newbcast:10 row_mask:0xf bank_mask:0xf
    v_mul_f32_dpp v203, v242, v85 row_newbcast:11 row_mask:0xf bank_mask:0xf
    v_cvt_pk_bf16_f32 v80, v196, v197
    v_cvt_pk_bf16_f32 v84, v198, v199
    v_cvt_pk_bf16_f32 v81, v200, v201
    v_cvt_pk_bf16_f32 v85, v202, v203
    s_nop 0
    s_waitcnt lgkmcnt(0)
    v_mfma_f32_32x32x8_bf16 v[0:15], v[80:81], v[176:177], v[0:15]
    s_add_u32 m0, s21, 4096
    v_mfma_f32_32x32x8_bf16 v[16:31], v[84:85], v[176:177], v[16:31]
    buffer_load_dwordx4 v234, s[4:7], s36 offen  lds
    buffer_load_dwordx4 v235, s[8:11], s36 offen offset:1024  lds
    s_mov_b32 m0, s50
    s_nop 0
    s_movrels_b32 s71, s23
    s_movrels_b32 s33, s28
    v_add_u32 v253, s33, v248
    s_bfe_u32 s46, s71, 0x30012
    s_mov_b32 m0, s46
    s_and_b32 s66, s71, 0x3ffff
    s_movrels_b32 s68, s57
    s_movrels_b32 s69, s61
    s_sub_u32 s48, s66, s47
    s_mov_b32 s47, s66
    s_lshr_b32 s52, s71, 28
    s_lshl_b32 s67, s46, 9
    s_add_u32 s66, s66, s67
    s_sub_u32 s49, s66, s42
    s_mov_b32 s42, s66
    s_bfe_u32 s66, s68, 655360
    s_add_u32 s43, s42, s66
    s_bfe_u32 s39, s69, 655360
    s_bfe_u32 s66, s68, 655370
    s_add_u32 s44, s42, s66
    s_bfe_u32 s40, s69, 655370
    s_bfe_u32 s66, s68, 655380
    s_add_u32 s45, s42, s66
    s_bfe_u32 s41, s69, 655380
    v_add_u32 v252, s45, v247
    ds_read_u16 v240, v252
    ds_read_u16 v241, v252 offset:64
    v_mfma_f32_32x32x16_bf16 v[32:47], v[64:67], v[180:183], 0
    v_mul_f32 v196, v0, v96
    v_fmac_f32 v196, v1, v97
    v_fmac_f32 v196, v2, v98
    v_fmac_f32 v196, v3, v99
    v_fmac_f32 v196, v4, v100
    v_fmac_f32 v196, v5, v101
    v_fmac_f32 v196, v6, v102
    v_mfma_f32_32x32x16_bf16 v[48:63], v[68:71], v[180:183], 0
    v_fmac_f32 v196, v7, v103
    v_mul_f32 v198, v8, v128
    v_fmac_f32 v198, v9, v129
    v_fmac_f32 v198, v10, v130
    v_fmac_f32 v198, v11, v131
    v_fmac_f32 v198, v12, v132
    v_mfma_f32_32x32x16_bf16 v[32:47], v[72:75], v[184:187], v[32:47]
    v_fmac_f32 v198, v13, v133
    v_fmac_f32 v198, v14, v134
    v_fmac_f32 v198, v15, v135
    v_mul_f32 v200, v16, v128
    v_fmac_f32 v200, v17, v129
    v_permlane32_swap_b32 v196, v198
    v_mfma_f32_32x32x16_bf16 v[48:63], v[76:79], v[184:187], v[48:63]
    s_waitcnt vmcnt(5)
    ds_read_b64_tr_b16 v[176:177], v244 offset:6144
    ds_read_b64_tr_b16 v[178:179], v244 offset:7168
    ds_read_b64_tr_b16 v[180:181], v245 offset:6144
    ds_read_b64_tr_b16 v[182:183], v245 offset:7168
    v_fmac_f32 v200, v18, v130
    v_fmac_f32 v200, v19, v131
    v_fmac_f32 v200, v20, v132
    v_fmac_f32 v200, v21, v133
    v_fmac_f32 v200, v22, v134
    v_fmac_f32 v200, v23, v135
    v_mfma_f32_32x32x8_bf16 v[32:47], v[80:81], v[188:189], v[32:47]
    v_add_f32 v198, v196, v198
    v_mul_f32_e64 v202, v24, -v128
    v_fma_f32 v202, v25, -v129, v202
    v_fma_f32 v202, v26, -v130, v202
    v_fma_f32 v202, v27, -v131, v202
    v_fma_f32 v202, v28, -v132, v202
    v_mfma_f32_32x32x8_bf16 v[48:63], v[84:85], v[188:189], v[48:63]
    v_fma_f32 v202, v29, -v133, v202
    v_fma_f32 v202, v30, -v134, v202
    v_fma_f32 v202, v31, -v135, v202
    s_nop 1
    v_permlane32_swap_b32 v200, v202
    v_add_f32 v202, v200, v202
    s_waitcnt vmcnt(3) lgkmcnt(0)
    v_mfma_f32_32x32x16_bf16 v[0:15], v[64:67], v[176:179], 0
    v_mul_f32 v197, v32, v104
    v_fmac_f32 v197, v33, v105
    v_fmac_f32 v197, v34, v106
    v_fmac_f32 v197, v35, v107
    v_fmac_f32 v197, v36, v108
    v_fmac_f32 v197, v37, v109
    v_fmac_f32 v197, v38, v110
    s_add_u32 m0, s21, 6144
    v_mfma_f32_32x32x16_bf16 v[16:31], v[68:71], v[176:179], 0
    buffer_load_dwordx4 v236, s[4:7], s36 offen  lds
    buffer_load_dwordx4 v237, s[8:11], s36 offen offset:1024  lds
    ds_read_b64_tr_b16 v[176:177], v244 offset:0
    ds_read_b64_tr_b16 v[178:179], v244 offset:1024
    ds_read_b64_tr_b16 v[184:185], v245 offset:0
    ds_read_b64_tr_b16 v[186:187], v245 offset:1024
    v_fmac_f32 v197, v39, v111
    v_mul_f32 v199, v40, v136
    v_fmac_f32 v199, v41, v137
    v_fmac_f32 v199, v42, v138
    v_fmac_f32 v199, v43, v139
    v_fmac_f32 v199, v44, v140
    s_waitcnt vmcnt(4) lgkmcnt(0)
    v_mfma_f32_32x32x16_bf16 v[0:15], v[72:75], v[176:179], v[0:15]
    v_fmac_f32 v199, v45, v141
    v_fmac_f32 v199, v46, v142
    v_fmac_f32 v199, v47, v143
    v_mul_f32 v201, v48, v136
    v_fmac_f32 v201, v49, v137
    v_permlane32_swap_b32 v197, v199
    v_fmac_f32 v201, v50, v138
    s_add_u32 m0, s21, 0
    v_mfma_f32_32x32x16_bf16 v[16:31], v[76:79], v[176:179], v[16:31]
    buffer_load_dwordx4 v238, s[4:7], s36 offen  lds
    ds_read_b64_tr_b16 v[176:177], v244 offset:2048
    ds_read_b64_tr_b16 v[188:189], v245 offset:2048
    v_fmac_f32 v201, v51, v139
    v_fmac_f32 v201, v52, v140
    v_fmac_f32 v201, v53, v141
    v_fmac_f32 v201, v54, v142
    v_fmac_f32 v201, v55, v143
    v_add_f32 v199, v197, v199
    s_waitcnt lgkmcnt(0)
    v_mfma_f32_32x32x8_bf16 v[0:15], v[80:81], v[176:177], v[0:15]
    v_mul_f32_e64 v203, v56, -v136
    v_fma_f32 v203, v57, -v137, v203
    v_fma_f32 v203, v58, -v138, v203
    v_fma_f32 v203, v59, -v139, v203
    v_fma_f32 v203, v60, -v140, v203
    v_fma_f32 v203, v61, -v141, v203
    v_fma_f32 v203, v62, -v142, v203
    s_add_u32 m0, s21, 2048
    v_mfma_f32_32x32x8_bf16 v[16:31], v[84:85], v[176:177], v[16:31]
    buffer_load_dwordx4 v234, s[4:7], s37 offen  lds
    buffer_load_dwordx4 v235, s[8:11], s37 offen offset:1024  lds
    v_add_u32 v252, s42, v247
    ds_read_u16 v234, v252
    ds_read_u16 v235, v252 offset:64
    v_fma_f32 v203, v63, -v143, v203
    s_nop 1
    v_permlane32_swap_b32 v201, v203
    v_add_f32 v203, v201, v203
    v_cvt_pk_bf16_f32 v192, v198, v199
    v_cvt_pk_bf16_f32 v193, v202, v203
    v_mfma_f32_32x32x16_bf16 v[32:47], v[64:67], v[180:183], 0
    v_mul_f32 v196, v0, v144
    v_fmac_f32 v196, v1, v145
    v_fmac_f32 v196, v2, v146
    v_fmac_f32 v196, v3, v147
    v_fmac_f32 v196, v4, v148
    v_fmac_f32 v196, v5, v149
    v_mfma_f32_32x32x16_bf16 v[48:63], v[68:71], v[180:183], 0
    v_fmac_f32 v196, v6, v150
    v_fmac_f32 v196, v7, v151
    v_mul_f32 v198, v8, v112
    v_fmac_f32 v198, v9, v113
    v_fmac_f32 v198, v10, v114
    v_mfma_f32_32x32x16_bf16 v[32:47], v[72:75], v[184:187], v[32:47]
    v_fmac_f32 v198, v11, v115
    v_fmac_f32 v198, v12, v116
    v_fmac_f32 v198, v13, v117
    v_fmac_f32 v198, v14, v118
    v_fmac_f32 v198, v15, v119
    v_mfma_f32_32x32x16_bf16 v[48:63], v[76:79], v[184:187], v[48:63]
    s_waitcnt vmcnt(5)
    ds_read_b64_tr_b16 v[176:177], v244 offset:4096
    ds_read_b64_tr_b16 v[178:179], v244 offset:5120
    ds_read_b64_tr_b16 v[180:181], v245 offset:4096
    ds_read_b64_tr_b16 v[182:183], v245 offset:5120
    v_mul_f32_e64 v200, v16, -v160
    v_fma_f32 v200, v17, -v161, v200
    v_fma_f32 v200, v18, -v162, v200
    v_fma_f32 v200, v19, -v163, v200
    v_fma_f32 v200, v20, -v164, v200
    v_fma_f32 v200, v21, -v165, v200
    v_mfma_f32_32x32x8_bf16 v[32:47], v[80:81], v[188:189], v[32:47]
    v_fma_f32 v200, v22, -v166, v200
    v_fma_f32 v200, v23, -v167, v200
    v_mul_f32_e64 v202, v24, -v160
    v_fma_f32 v202, v25, -v161, v202
    v_fma_f32 v202, v26, -v162, v202
    v_mfma_f32_32x32x8_bf16 v[48:63], v[84:85], v[188:189], v[48:63]
    v_fma_f32 v202, v27, -v163, v202
    v_fma_f32 v202, v28, -v164, v202
    v_fma_f32 v202, v29, -v165, v202
    v_fma_f32 v202, v30, -v166, v202
    v_fma_f32 v202, v31, -v167, v202
    s_waitcnt vmcnt(3) lgkmcnt(0)
    v_mfma_f32_32x32x16_bf16 v[0:15], v[64:67], v[176:179], 0
    v_mul_f32 v197, v32, v152
    v_fmac_f32 v197, v33, v153
    v_fmac_f32 v197, v34, v154
    v_fmac_f32 v197, v35, v155
    v_fmac_f32 v197, v36, v156
    v_fmac_f32 v197, v37, v157
    s_add_u32 m0, s21, 4096
    v_mfma_f32_32x32x16_bf16 v[16:31], v[68:71], v[176:179], 0
    buffer_load_dwordx4 v236, s[4:7], s37 offen  lds
    buffer_load_dwordx4 v237, s[8:11], s37 offen offset:1024  lds
    ds_read_b64_tr_b16 v[176:177], v244 offset:6144
    ds_read_b64_tr_b16 v[178:179], v244 offset:7168
    ds_read_b64_tr_b16 v[184:185], v245 offset:6144
    ds_read_b64_tr_b16 v[186:187], v245 offset:7168
    v_add_u32 v252, s43, v247
    ds_read_u16 v236, v252
    ds_read_u16 v237, v252 offset:64
    v_fmac_f32 v197, v38, v158
    v_fmac_f32 v197, v39, v159
    v_mul_f32 v199, v40, v120
    v_fmac_f32 v199, v41, v121
    v_fmac_f32 v199, v42, v122
    s_waitcnt vmcnt(4) lgkmcnt(2)
    v_mfma_f32_32x32x16_bf16 v[0:15], v[72:75], v[176:179], v[0:15]
    v_fmac_f32 v199, v43, v123
    v_fmac_f32 v199, v44, v124
    v_fmac_f32 v199, v45, v125
    v_fmac_f32 v199, v46, v126
    v_fmac_f32 v199, v47, v127
    s_add_u32 m0, s21, 6144
    v_mfma_f32_32x32x16_bf16 v[16:31], v[76:79], v[176:179], v[16:31]
    buffer_load_dwordx4 v238, s[4:7], s37 offen  lds
    ds_read_b64_tr_b16 v[176:177], v244 offset:0
    ds_read_b64_tr_b16 v[188:189], v245 offset:0
    v_add_u32 v252, s44, v247
    ds_read_u16 v238, v252
    ds_read_u16 v239, v252 offset:64
    v_mul_f32_e64 v201, v48, -v168
    v_fma_f32 v201, v49, -v169, v201
    v_fma_f32 v201, v50, -v170, v201
    v_fma_f32 v201, v51, -v171, v201
    v_fma_f32 v201, v52, -v172, v201
    v_fma_f32 v201, v53, -v173, v201
    s_waitcnt lgkmcnt(2)
    v_mfma_f32_32x32x8_bf16 v[0:15], v[80:81], v[176:177], v[0:15]
    v_fma_f32 v201, v54, -v174, v201
    v_fma_f32 v201, v55, -v175, v201
    v_mul_f32_e64 v203, v56, -v168
    v_fma_f32 v203, v57, -v169, v203
    v_fma_f32 v203, v58, -v170, v203
    s_add_u32 m0, s21, 0
    s_cmp_eq_u32 s50, 4
    v_mfma_f32_32x32x8_bf16 v[16:31], v[84:85], v[176:177], v[16:31]
    s_cbranch_scc1 WL_5_0
    v_lshl_add_u32 v234, v234, 10, v246
    v_lshl_add_u32 v235, v235, 10, v246
    buffer_load_dwordx4 v234, s[4:7], s38 offen  lds
    buffer_load_dwordx4 v235, s[8:11], s38 offen offset:1024  lds
WR_5_0:
    v_fma_f32 v203, v59, -v171, v203
    v_fma_f32 v203, v60, -v172, v203
    v_fma_f32 v203, v61, -v173, v203
    v_fma_f32 v203, v62, -v174, v203
    v_fma_f32 v203, v63, -v175, v203
    v_mfma_f32_32x32x16_bf16 v[32:47], v[64:67], v[180:183], 0
    v_mul_f32 v254, v0, v144
    v_fmac_f32 v254, v1, v145
    v_fmac_f32 v254, v2, v146
    v_mfma_f32_32x32x16_bf16 v[48:63], v[68:71], v[180:183], 0
    ds_swizzle_b32 v68, v68 offset:0x401F
    ds_swizzle_b32 v69, v69 offset:0x401F
    ds_swizzle_b32 v70, v70 offset:0x401F
    ds_swizzle_b32 v71, v71 offset:0x401F
    v_fmac_f32 v254, v3, v147
    v_fmac_f32 v254, v4, v148
    v_fmac_f32 v254, v5, v149
    v_mfma_f32_32x32x16_bf16 v[32:47], v[72:75], v[184:187], v[32:47]
    v_fmac_f32 v254, v6, v150
    v_fmac_f32 v254, v7, v151
    v_fmac_f32 v200, v8, v160
    v_mfma_f32_32x32x16_bf16 v[48:63], v[76:79], v[184:187], v[48:63]
    ds_swizzle_b32 v76, v76 offset:0x401F
    ds_swizzle_b32 v77, v77 offset:0x401F
    ds_swizzle_b32 v78, v78 offset:0x401F
    ds_swizzle_b32 v79, v79 offset:0x401F
    s_waitcnt vmcnt(5)
    ds_read_b64_tr_b16 v[176:177], v244 offset:2048
    ds_read_b64_tr_b16 v[178:179], v244 offset:3072
    ds_read_b64_tr_b16 v[180:181], v245 offset:2048
    ds_read_b64_tr_b16 v[182:183], v245 offset:3072
    v_fmac_f32 v200, v9, v161
    v_permlane32_swap_b32 v196, v254
    v_fmac_f32 v200, v10, v162
    v_mfma_f32_32x32x8_bf16 v[32:47], v[80:81], v[188:189], v[32:47]
    v_fmac_f32 v200, v11, v163
    v_fmac_f32 v200, v12, v164
    v_fmac_f32 v200, v13, v165
    v_mfma_f32_32x32x8_bf16 v[48:63], v[84:85], v[188:189], v[48:63]
    ds_swizzle_b32 v84, v84 offset:0x401F
    ds_swizzle_b32 v85, v85 offset:0x401F
    v_fmac_f32 v200, v14, v166
    v_fmac_f32 v200, v15, v167
    v_add_f32 v254, v196, v254
    s_waitcnt lgkmcnt(6)
    s_mov_b64 exec, s[56:57]
    v_xor_b32 v68, 0x80008000, v68
    v_xor_b32 v69, 0x80008000, v69
    v_xor_b32 v70, 0x80008000, v70
    v_xor_b32 v71, 0x80008000, v71
    v_xor_b32 v76, 0x80008000, v76
    v_xor_b32 v77, 0x80008000, v77
    v_xor_b32 v78, 0x80008000, v78
    v_xor_b32 v79, 0x80008000, v79
    s_mov_b64 exec, -1
    s_waitcnt vmcnt(3) lgkmcnt(2)
    v_mfma_f32_32x32x16_bf16 v[0:15], v[64:67], v[176:179], 0
    v_mul_f32 v255, v32, v152
    v_fmac_f32 v255, v33, v153
    v_fmac_f32 v255, v34, v154
    v_fmac_f32 v255, v35, v155
    s_add_u32 m0, s21, 2048
    s_cmp_eq_u32 s50, 4
    v_mfma_f32_32x32x16_bf16 v[16:31], v[68:71], v[176:179], v[16:31]
    s_cbranch_scc1 WL_5_1
    v_lshl_add_u32 v236, v236, 10, v246
    v_lshl_add_u32 v237, v237, 10, v246
    buffer_load_dwordx4 v236, s[4:7], s39 offen  lds
    buffer_load_dwordx4 v237, s[8:11], s39 offen offset:1024  lds
WR_5_1:
    ds_read_b64_tr_b16 v[176:177], v244 offset:4096
    ds_read_b64_tr_b16 v[178:179], v244 offset:5120
    ds_read_b64_tr_b16 v[184:185], v245 offset:4096
    ds_read_b64_tr_b16 v[186:187], v245 offset:5120
    v_fmac_f32 v255, v36, v156
    v_fmac_f32 v255, v37, v157
    v_fmac_f32 v255, v38, v158
    s_waitcnt vmcnt(4) lgkmcnt(0)
    v_mfma_f32_32x32x16_bf16 v[0:15], v[72:75], v[176:179], v[0:15]
    v_fmac_f32 v255, v39, v159
    v_fmac_f32 v201, v40, v168
    v_fmac_f32 v201, v41, v169
    s_add_u32 m0, s21, 4096
    s_cmp_eq_u32 s50, 4
    v_mfma_f32_32x32x16_bf16 v[16:31], v[76:79], v[176:179], v[16:31]
    s_cbranch_scc1 WL_5_2
    v_lshl_add_u32 v238, v238, 10, v246
    v_lshl_add_u32 v239, v239, 10, v246
    buffer_load_dwordx4 v238, s[4:7], s40 offen  lds
    buffer_load_dwordx4 v239, s[8:11], s40 offen offset:1024  lds
WR_5_2:
    ds_read_b64_tr_b16 v[176:177], v244 offset:6144
    ds_read_b64_tr_b16 v[188:189], v245 offset:6144
    v_permlane32_swap_b32 v197, v255
    v_fmac_f32 v201, v42, v170
    v_fmac_f32 v201, v43, v171
    s_waitcnt lgkmcnt(0)
    s_mov_b64 exec, s[56:57]
    v_xor_b32 v84, 0x80008000, v84
    v_xor_b32 v85, 0x80008000, v85
    s_mov_b64 exec, -1
    v_mfma_f32_32x32x8_bf16 v[0:15], v[80:81], v[176:177], v[0:15]
    v_fmac_f32 v201, v44, v172
    v_fmac_f32 v201, v45, v173
    v_fmac_f32 v201, v46, v174
    s_add_u32 m0, s21, 6144
    s_cmp_eq_u32 s50, 4
    v_mfma_f32_32x32x8_bf16 v[16:31], v[84:85], v[176:177], v[16:31]
    s_cbranch_scc1 WL_5_3
    v_lshl_add_u32 v240, v240, 10, v246
    v_lshl_add_u32 v241, v241, 10, v246
    buffer_load_dwordx4 v240, s[4:7], s41 offen  lds
    buffer_load_dwordx4 v241, s[8:11], s41 offen offset:1024  lds
WR_5_3:
    v_fmac_f32 v201, v47, v175
    v_add_f32 v255, v197, v255
    v_cvt_pk_bf16_f32 v194, v254, v255
    v_mfma_f32_32x32x16_bf16 v[32:47], v[64:67], v[180:183], 0
    v_mul_f32 v254, v0, v144
    v_fmac_f32 v254, v1, v145
    v_fmac_f32 v254, v2, v146
    v_fmac_f32 v254, v3, v147
    v_fmac_f32 v254, v4, v148
    v_fmac_f32 v254, v5, v149
    v_fmac_f32 v254, v6, v150
    v_mfma_f32_32x32x16_bf16 v[48:63], v[68:71], v[180:183], v[48:63]
    v_fmac_f32 v254, v7, v151
    v_fma_f32 v202, v8, -v160, v202
    v_fma_f32 v202, v9, -v161, v202
    v_permlane32_swap_b32 v254, v200
    v_fma_f32 v202, v10, -v162, v202
    v_fma_f32 v202, v11, -v163, v202
    v_mfma_f32_32x32x16_bf16 v[32:47], v[72:75], v[184:187], v[32:47]
    v_fma_f32 v202, v12, -v164, v202
    v_fma_f32 v202, v13, -v165, v202
    v_fma_f32 v202, v14, -v166, v202
    v_fma_f32 v202, v15, -v167, v202
    v_add_f32 v200, v254, v200
    v_fmac_f32 v198, v16, v112
    v_permlane32_swap_b32 v202, v254
    v_mfma_f32_32x32x16_bf16 v[48:63], v[76:79], v[184:187], v[48:63]
    s_waitcnt vmcnt(6)
    ds_read_b64_tr_b16 v[176:177], v244 offset:0
    ds_read_b64_tr_b16 v[178:179], v244 offset:1024
    ds_read_b64_tr_b16 v[180:181], v245 offset:0
    ds_read_b64_tr_b16 v[182:183], v245 offset:1024
    v_fmac_f32 v198, v17, v113
    v_fmac_f32 v198, v18, v114
    v_fmac_f32 v198, v19, v115
    v_fmac_f32 v198, v20, v116
    v_fmac_f32 v198, v21, v117
    v_fmac_f32 v198, v22, v118
    v_mfma_f32_32x32x8_bf16 v[32:47], v[80:81], v[188:189], v[32:47]
    v_fmac_f32 v198, v23, v119
    v_add_f32 v254, v202, v254
    v_mul_f32 v196, v24, v160
    v_fmac_f32 v196, v25, v161
    v_fmac_f32 v196, v26, v162
    v_fmac_f32 v196, v27, v163
    v_fmac_f32 v196, v28, v164
    v_mfma_f32_32x32x8_bf16 v[48:63], v[84:85], v[188:189], v[48:63]
    v_add_u32 v249, s48, v249
    v_add_u32 v250, s49, v250
    ds_read_b32 v252, v251 offset:16
    ds_read_b64_tr_b16 v[64:65], v249 offset:0
    ds_read_b64_tr_b16 v[68:69], v249 offset:64
    ds_read_b64_tr_b16 v[66:67], v249 offset:256
    ds_read_b64_tr_b16 v[70:71], v249 offset:320
    s_mov_b64 exec, s[54:55]
    ds_read_u16_d16_hi v242, v250 offset:0
    s_mov_b64 exec, -1
    v_fmac_f32 v196, v29, v165
    v_fmac_f32 v196, v30, v166
    v_fmac_f32 v196, v31, v167
    s_nop 1
    v_permlane32_swap_b32 v198, v196
    v_add_f32 v196, v198, v196
    s_cmp_eq_u32 s50, 4
    s_cbranch_scc1 LEPI_0
    v_mul_f32 v255, v32, v152
    v_fmac_f32 v255, v33, v153
    v_fmac_f32 v255, v34, v154
    v_fmac_f32 v255, v35, v155
    v_fmac_f32 v255, v36, v156
    v_fmac_f32 v255, v37, v157
    v_fmac_f32 v255, v38, v158
    v_fmac_f32 v255, v39, v159
    v_fma_f32 v203, v40, -v168, v203
    v_fma_f32 v203, v41, -v169, v203
    v_permlane32_swap_b32 v255, v201
    v_fma_f32 v203, v42, -v170, v203
    v_fma_f32 v203, v43, -v171, v203
    v_fma_f32 v203, v44, -v172, v203
    v_fma_f32 v203, v45, -v173, v203
    v_fma_f32 v203, v46, -v174, v203
    v_fma_f32 v203, v47, -v175, v203
    v_add_f32 v201, v255, v201
    v_fmac_f32 v199, v48, v120
    v_permlane32_swap_b32 v203, v255
    v_fmac_f32 v199, v49, v121
    v_fmac_f32 v199, v50, v122
    v_fmac_f32 v199, v51, v123
    v_fmac_f32 v199, v52, v124
    v_fmac_f32 v199, v53, v125
    v_fmac_f32 v199, v54, v126
    v_fmac_f32 v199, v55, v127
    v_add_f32 v255, v203, v255
    v_mul_f32 v197, v56, v168
    v_fmac_f32 v197, v57, v169
    v_fmac_f32 v197, v58, v170
    v_fmac_f32 v197, v59, v171
    v_fmac_f32 v197, v60, v172
    v_fmac_f32 v197, v61, v173
    v_fmac_f32 v197, v62, v174
    v_fmac_f32 v197, v63, v175
    s_nop 1
    v_permlane32_swap_b32 v199, v197
    v_add_f32 v197, v199, v197
    v_cvt_pk_bf16_f32 v200, v200, v201
    v_cvt_pk_bf16_f32 v254, v254, v255
    v_cvt_pk_bf16_f32 v196, v196, v197
    ds_write2st64_b32 v253, v192, v193 offset0:0 offset1:1
    ds_write2st64_b32 v253, v194, v200 offset0:2 offset1:3
    ds_write_b32 v253, v196 offset:1024
    s_mov_b64 exec, 0xffffffff
    ds_write_b32 v253, v254 offset:1280
    s_mov_b64 exec, -1
    s_add_u32 s50, s50, 1
    s_cmp_ge_u32 s50, 4
    s_cbranch_scc1 LAST1
    s_waitcnt lgkmcnt(9)
    v_readfirstlane_b32 s66, v252
    s_add_u32 s53, s53, 1
    v_mov_b32 v252, s53
    s_cmp_le_u32 s53, s66
    ds_write2_b32 v251, v252, v252 offset0:0 offset1:8
    s_setprio 1
    s_cbranch_scc1 PRIO_12
    s_setprio 0
PRIO_12:
    s_cmp_eq_u32 s52, 4
    s_cbranch_scc1 ITEM_1_4
    s_cmp_eq_u32 s52, 5
    s_cbranch_scc1 ITEM_1_5
    s_cmp_eq_u32 s52, 3
    s_cbranch_scc1 ITEM_1_3
    s_cmp_eq_u32 s52, 6
    s_cbranch_scc1 ITEM_1_6
    s_cmp_eq_u32 s52, 8
    s_cbranch_scc1 ITEM_1_8
    s_branch ITEM_1_2
WL_5_0:
    s_add_u32 s66, s51, 0
    buffer_load_dwordx4 v[96:99], v246, s[16:19], s66 offen offset:2048 sc1
    buffer_load_dwordx4 v[100:103], v246, s[16:19], s66 offen offset:3072 sc1
    s_branch WR_5_0
WL_5_1:
    s_add_u32 s66, s51, 4096
    buffer_load_dwordx4 v[104:107], v246, s[16:19], s66 offen offset:2048 sc1
    buffer_load_dwordx4 v[108:111], v246, s[16:19], s66 offen offset:3072 sc1
    s_branch WR_5_1
WL_5_2:
    s_add_u32 s66, s51, 8192
    buffer_load_dwordx4 v[128:131], v246, s[16:19], s66 offen offset:2048 sc1
    buffer_load_dwordx4 v[132:135], v246, s[16:19], s66 offen offset:3072 sc1
    s_branch WR_5_2
WL_5_3:
    s_add_u32 s66, s51, 12288
    buffer_load_dwordx4 v[136:139], v246, s[16:19], s66 offen offset:2048 sc1
    buffer_load_dwordx4 v[140:143], v246, s[16:19], s66 offen offset:3072 sc1
    s_branch WR_5_3
.p2align 6
ITEM_1_3:
    s_mov_b64 exec, s[54:55]
    ds_read_u16_d16_hi v243, v250 offset:128
    s_mov_b64 exec, -1
    ds_read_b64_tr_b16 v[72:73], v249 offset:512
    ds_read_b64_tr_b16 v[76:77], v249 offset:576
    s_waitcnt lgkmcnt(3)
    v_mul_f32_dpp v196, v242, v64 row_newbcast:0 row_mask:0xf bank_mask:0xf
    v_mul_f32_dpp v197, v242, v65 row_newbcast:1 row_mask:0xf bank_mask:0xf
    v_mul_f32_dpp v198, v242, v64 row_newbcast:8 row_mask:0xf bank_mask:0xf
    v_mul_f32_dpp v199, v242, v65 row_newbcast:9 row_mask:0xf bank_mask:0xf
    v_mul_f32_dpp v200, v242, v68 row_newbcast:2 row_mask:0xf bank_mask:0xf
    v_mul_f32_dpp v201, v242, v69 row_newbcast:3 row_mask:0xf bank_mask:0xf
    v_mul_f32_dpp v202, v242, v68 row_newbcast:10 row_mask:0xf bank_mask:0xf
    v_mul_f32_dpp v203, v242, v69 row_newbcast:11 row_mask:0xf bank_mask:0xf
    v_cvt_pk_bf16_f32 v64, v196, v197
    v_cvt_pk_bf16_f32 v68, v198, v199
    v_cvt_pk_bf16_f32 v65, v200, v201
    v_cvt_pk_bf16_f32 v69, v202, v203
    v_mul_f32_dpp v196, v242, v66 row_newbcast:4 row_mask:0xf bank_mask:0xf
    v_mul_f32_dpp v197, v242, v67 row_newbcast:5 row_mask:0xf bank_mask:0xf
    v_mul_f32_dpp v198, v242, v66 row_newbcast:12 row_mask:0xf bank_mask:0xf
    v_mul_f32_dpp v199, v242, v67 row_newbcast:13 row_mask:0xf bank_mask:0xf
    v_mul_f32_dpp v200, v242, v70 row_newbcast:6 row_mask:0xf bank_mask:0xf
    v_mul_f32_dpp v201, v242, v71 row_newbcast:7 row_mask:0xf bank_mask:0xf
    v_mul_f32_dpp v202, v242, v70 row_newbcast:14 row_mask:0xf bank_mask:0xf
    v_mul_f32_dpp v203, v242, v71 row_newbcast:15 row_mask:0xf bank_mask:0xf
    v_cvt_pk_bf16_f32 v66, v196, v197
    v_cvt_pk_bf16_f32 v70, v198, v199
    v_cvt_pk_bf16_f32 v67, v200, v201
    v_cvt_pk_bf16_f32 v71, v202, v203
    s_nop 0
    s_waitcnt vmcnt(4) lgkmcnt(0)
    v_mfma_f32_32x32x16_bf16 v[0:15], v[64:67], v[176:179], 0
    v_mul_f32_dpp v196, v243, v72 row_newbcast:0 row_mask:0xf bank_mask:0xf
    v_mul_f32_dpp v197, v243, v73 row_newbcast:1 row_mask:0xf bank_mask:0xf
    v_mul_f32_dpp v198, v243, v72 row_newbcast:8 row_mask:0xf bank_mask:0xf
    v_mul_f32_dpp v199, v243, v73 row_newbcast:9 row_mask:0xf bank_mask:0xf
    v_mul_f32_dpp v200, v243, v76 row_newbcast:2 row_mask:0xf bank_mask:0xf
    v_mul_f32_dpp v201, v243, v77 row_newbcast:3 row_mask:0xf bank_mask:0xf
    s_add_u32 m0, s21, 0
    v_mfma_f32_32x32x16_bf16 v[16:31], v[68:71], v[176:179], 0
    buffer_load_dwordx4 v234, s[4:7], s36 offen  lds
    buffer_load_dwordx4 v235, s[8:11], s36 offen offset:1024  lds
    ds_read_b64_tr_b16 v[176:177], v244 offset:2048
    ds_read_b64_tr_b16 v[184:185], v245 offset:2048
    v_mul_f32_dpp v202, v243, v76 row_newbcast:10 row_mask:0xf bank_mask:0xf
    v_mul_f32_dpp v203, v243, v77 row_newbcast:11 row_mask:0xf bank_mask:0xf
    v_cvt_pk_bf16_f32 v72, v196, v197
    v_cvt_pk_bf16_f32 v76, v198, v199
    v_cvt_pk_bf16_f32 v73, v200, v201
    v_cvt_pk_bf16_f32 v77, v202, v203
    s_nop 0
    s_waitcnt lgkmcnt(0)
    v_mfma_f32_32x32x8_bf16 v[0:15], v[72:73], v[176:177], v[0:15]
    s_add_u32 m0, s21, 2048
    v_mfma_f32_32x32x8_bf16 v[16:31], v[76:77], v[176:177], v[16:31]
    buffer_load_dwordx4 v236, s[4:7], s36 offen  lds
    s_mov_b32 m0, s50
    s_nop 0
    s_movrels_b32 s71, s23
    s_movrels_b32 s33, s28
    v_add_u32 v253, s33, v248
    s_bfe_u32 s46, s71, 0x30012
    s_mov_b32 m0, s46
    s_and_b32 s66, s71, 0x3ffff
    s_movrels_b32 s68, s57
    s_movrels_b32 s69, s61
    s_sub_u32 s48, s66, s47
    s_mov_b32 s47, s66
    s_lshr_b32 s52, s71, 28
    s_lshl_b32 s67, s46, 9
    s_add_u32 s66, s66, s67
    s_sub_u32 s49, s66, s42
    s_mov_b32 s42, s66
    s_bfe_u32 s66, s68, 655360
    s_add_u32 s43, s42, s66
    s_bfe_u32 s39, s69, 655360
    s_bfe_u32 s66, s68, 655370
    s_add_u32 s44, s42, s66
    s_bfe_u32 s40, s69, 655370
    s_bfe_u32 s66, s68, 655380
    s_add_u32 s45, s42, s66
    s_bfe_u32 s41, s69, 655380
    v_add_u32 v252, s44, v247
    ds_read_u16 v238, v252
    ds_read_u16 v239, v252 offset:64
    v_add_u32 v252, s45, v247
    ds_read_u16 v240, v252
    ds_read_u16 v241, v252 offset:64
    v_mfma_f32_32x32x16_bf16 v[32:47], v[64:67], v[180:183], 0
    v_mul_f32 v196, v0, v96
    v_fmac_f32 v196, v1, v97
    v_fmac_f32 v196, v2, v98
    v_fmac_f32 v196, v3, v99
    v_fmac_f32 v196, v4, v100
    v_fmac_f32 v196, v5, v101
    v_fmac_f32 v196, v6, v102
    v_fmac_f32 v196, v7, v103
    v_mul_f32 v198, v8, v128
    v_fmac_f32 v198, v9, v129
    v_mfma_f32_32x32x16_bf16 v[48:63], v[68:71], v[180:183], 0
    s_waitcnt vmcnt(5)
    ds_read_b64_tr_b16 v[176:177], v244 offset:4096
    ds_read_b64_tr_b16 v[178:179], v244 offset:5120
    ds_read_b64_tr_b16 v[180:181], v245 offset:4096
    ds_read_b64_tr_b16 v[182:183], v245 offset:5120
    v_fmac_f32 v198, v10, v130
    v_fmac_f32 v198, v11, v131
    v_fmac_f32 v198, v12, v132
    v_fmac_f32 v198, v13, v133
    v_fmac_f32 v198, v14, v134
    v_fmac_f32 v198, v15, v135
    v_mul_f32 v200, v16, v128
    v_fmac_f32 v200, v17, v129
    v_permlane32_swap_b32 v196, v198
    v_mfma_f32_32x32x8_bf16 v[32:47], v[72:73], v[184:185], v[32:47]
    v_fmac_f32 v200, v18, v130
    v_fmac_f32 v200, v19, v131
    v_fmac_f32 v200, v20, v132
    v_fmac_f32 v200, v21, v133
    v_fmac_f32 v200, v22, v134
    v_fmac_f32 v200, v23, v135
    v_add_f32 v198, v196, v198
    v_mul_f32_e64 v202, v24, -v128
    v_fma_f32 v202, v25, -v129, v202
    v_mfma_f32_32x32x8_bf16 v[48:63], v[76:77], v[184:185], v[48:63]
    v_fma_f32 v202, v26, -v130, v202
    v_fma_f32 v202, v27, -v131, v202
    v_fma_f32 v202, v28, -v132, v202
    v_fma_f32 v202, v29, -v133, v202
    v_fma_f32 v202, v30, -v134, v202
    v_fma_f32 v202, v31, -v135, v202
    s_nop 1
    v_permlane32_swap_b32 v200, v202
    v_add_f32 v202, v200, v202
    s_waitcnt vmcnt(3) lgkmcnt(0)
    v_mfma_f32_32x32x16_bf16 v[0:15], v[64:67], v[176:179], 0
    v_mul_f32 v197, v32, v104
    v_fmac_f32 v197, v33, v105
    v_fmac_f32 v197, v34, v106
    v_fmac_f32 v197, v35, v107
    v_fmac_f32 v197, v36, v108
    v_fmac_f32 v197, v37, v109
    v_fmac_f32 v197, v38, v110
    v_fmac_f32 v197, v39, v111
    v_mul_f32 v199, v40, v136
    v_fmac_f32 v199, v41, v137
    s_add_u32 m0, s21, 4096
    v_mfma_f32_32x32x16_bf16 v[16:31], v[68:71], v[176:179], 0
    buffer_load_dwordx4 v234, s[4:7], s37 offen  lds
    buffer_load_dwordx4 v235, s[8:11], s37 offen offset:1024  lds
    ds_read_b64_tr_b16 v[176:177], v244 offset:6144
    ds_read_b64_tr_b16 v[184:185], v245 offset:6144
    v_add_u32 v252, s42, v247
    ds_read_u16 v234, v252
    ds_read_u16 v235, v252 offset:64
    v_fmac_f32 v199, v42, v138
    v_fmac_f32 v199, v43, v139
    v_fmac_f32 v199, v44, v140
    v_fmac_f32 v199, v45, v141
    v_fmac_f32 v199, v46, v142
    v_fmac_f32 v199, v47, v143
    v_mul_f32 v201, v48, v136
    v_fmac_f32 v201, v49, v137
    v_permlane32_swap_b32 v197, v199
    v_fmac_f32 v201, v50, v138
    s_waitcnt lgkmcnt(2)
    v_mfma_f32_32x32x8_bf16 v[0:15], v[72:73], v[176:177], v[0:15]
    v_fmac_f32 v201, v51, v139
    v_fmac_f32 v201, v52, v140
    v_fmac_f32 v201, v53, v141
    v_fmac_f32 v201, v54, v142
    v_fmac_f32 v201, v55, v143
    v_add_f32 v199, v197, v199
    v_mul_f32_e64 v203, v56, -v136
    v_fma_f32 v203, v57, -v137, v203
    v_fma_f32 v203, v58, -v138, v203
    v_fma_f32 v203, v59, -v139, v203
    s_add_u32 m0, s21, 6144
    v_mfma_f32_32x32x8_bf16 v[16:31], v[76:77], v[176:177], v[16:31]
    buffer_load_dwordx4 v236, s[4:7], s37 offen  lds
    v_add_u32 v252, s43, v247
    ds_read_u16 v236, v252
    ds_read_u16 v237, v252 offset:64
    v_fma_f32 v203, v60, -v140, v203
    v_fma_f32 v203, v61, -v141, v203
    v_fma_f32 v203, v62, -v142, v203
    v_fma_f32 v203, v63, -v143, v203
    s_nop 1
    v_permlane32_swap_b32 v201, v203
    v_add_f32 v203, v201, v203
    v_cvt_pk_bf16_f32 v192, v198, v199
    v_cvt_pk_bf16_f32 v193, v202, v203
    v_mfma_f32_32x32x16_bf16 v[32:47], v[64:67], v[180:183], 0
    v_mul_f32 v196, v0, v144
    v_fmac_f32 v196, v1, v145
    v_fmac_f32 v196, v2, v146
    v_fmac_f32 v196, v3, v147
    v_fmac_f32 v196, v4, v148
    v_fmac_f32 v196, v5, v149
    v_fmac_f32 v196, v6, v150
    v_fmac_f32 v196, v7, v151
    v_mfma_f32_32x32x16_bf16 v[48:63], v[68:71], v[180:183], 0
    s_waitcnt vmcnt(4)
    ds_read_b64_tr_b16 v[176:177], v244 offset:0
    ds_read_b64_tr_b16 v[178:179], v244 offset:1024
    ds_read_b64_tr_b16 v[180:181], v245 offset:0
    ds_read_b64_tr_b16 v[182:183], v245 offset:1024
    v_mul_f32 v198, v8, v112
    v_fmac_f32 v198, v9, v113
    v_fmac_f32 v198, v10, v114
    v_fmac_f32 v198, v11, v115
    v_fmac_f32 v198, v12, v116
    v_fmac_f32 v198, v13, v117
    v_fmac_f32 v198, v14, v118
    v_fmac_f32 v198, v15, v119
    v_mfma_f32_32x32x8_bf16 v[32:47], v[72:73], v[184:185], v[32:47]
    v_mul_f32_e64 v200, v16, -v160
    v_fma_f32 v200, v17, -v161, v200
    v_fma_f32 v200, v18, -v162, v200
    v_fma_f32 v200, v19, -v163, v200
    v_fma_f32 v200, v20, -v164, v200
    v_fma_f32 v200, v21, -v165, v200
    v_fma_f32 v200, v22, -v166, v200
    v_fma_f32 v200, v23, -v167, v200
    v_mfma_f32_32x32x8_bf16 v[48:63], v[76:77], v[184:185], v[48:63]
    v_mul_f32_e64 v202, v24, -v160
    v_fma_f32 v202, v25, -v161, v202
    v_fma_f32 v202, v26, -v162, v202
    v_fma_f32 v202, v27, -v163, v202
    v_fma_f32 v202, v28, -v164, v202
    v_fma_f32 v202, v29, -v165, v202
    v_fma_f32 v202, v30, -v166, v202
    v_fma_f32 v202, v31, -v167, v202
    s_waitcnt vmcnt(3) lgkmcnt(0)
    v_mfma_f32_32x32x16_bf16 v[0:15], v[64:67], v[176:179], 0
    v_mul_f32 v197, v32, v152
    v_fmac_f32 v197, v33, v153
    v_fmac_f32 v197, v34, v154
    v_fmac_f32 v197, v35, v155
    v_fmac_f32 v197, v36, v156
    v_fmac_f32 v197, v37, v157
    v_fmac_f32 v197, v38, v158
    v_fmac_f32 v197, v39, v159
    s_add_u32 m0, s21, 0
    s_cmp_eq_u32 s50, 4
    v_mfma_f32_32x32x16_bf16 v[16:31], v[68:71], v[176:179], 0
    s_cbranch_scc1 WL_3_0
    v_lshl_add_u32 v234, v234, 10, v246
    v_lshl_add_u32 v235, v235, 10, v246
    buffer_load_dwordx4 v234, s[4:7], s38 offen  lds
    buffer_load_dwordx4 v235, s[8:11], s38 offen offset:1024  lds
WR_3_0:
    ds_read_b64_tr_b16 v[176:177], v244 offset:2048
    ds_read_b64_tr_b16 v[184:185], v245 offset:2048
    v_mul_f32 v199, v40, v120
    v_fmac_f32 v199, v41, v121
    v_fmac_f32 v199, v42, v122
    v_fmac_f32 v199, v43, v123
    v_fmac_f32 v199, v44, v124
    v_fmac_f32 v199, v45, v125
    v_fmac_f32 v199, v46, v126
    v_fmac_f32 v199, v47, v127
    s_waitcnt lgkmcnt(0)
    v_mfma_f32_32x32x8_bf16 v[0:15], v[72:73], v[176:177], v[0:15]
    v_mul_f32_e64 v201, v48, -v168
    v_fma_f32 v201, v49, -v169, v201
    v_fma_f32 v201, v50, -v170, v201
    v_fma_f32 v201, v51, -v171, v201
    v_fma_f32 v201, v52, -v172, v201
    v_fma_f32 v201, v53, -v173, v201
    v_fma_f32 v201, v54, -v174, v201
    v_fma_f32 v201, v55, -v175, v201
    s_add_u32 m0, s21, 2048
    s_cmp_eq_u32 s50, 4
    v_mfma_f32_32x32x8_bf16 v[16:31], v[76:77], v[176:177], v[16:31]
    s_cbranch_scc1 WL_3_1
    v_lshl_add_u32 v236, v236, 10, v246
    v_lshl_add_u32 v237, v237, 10, v246
    buffer_load_dwordx4 v236, s[4:7], s39 offen  lds
    buffer_load_dwordx4 v237, s[8:11], s39 offen offset:1024  lds
WR_3_1:
    v_mul_f32_e64 v203, v56, -v168
    v_fma_f32 v203, v57, -v169, v203
    v_fma_f32 v203, v58, -v170, v203
    v_fma_f32 v203, v59, -v171, v203
    v_fma_f32 v203, v60, -v172, v203
    v_fma_f32 v203, v61, -v173, v203
    v_fma_f32 v203, v62, -v174, v203
    v_fma_f32 v203, v63, -v175, v203
    v_mfma_f32_32x32x16_bf16 v[32:47], v[64:67], v[180:183], 0
    v_mul_f32 v254, v0, v144
    v_fmac_f32 v254, v1, v145
    v_fmac_f32 v254, v2, v146
    v_fmac_f32 v254, v3, v147
    v_fmac_f32 v254, v4, v148
    v_mfma_f32_32x32x16_bf16 v[48:63], v[68:71], v[180:183], 0
    ds_swizzle_b32 v68, v68 offset:0x401F
    ds_swizzle_b32 v69, v69 offset:0x401F
    ds_swizzle_b32 v70, v70 offset:0x401F
    ds_swizzle_b32 v71, v71 offset:0x401F
    s_waitcnt vmcnt(5)
    ds_read_b64_tr_b16 v[176:177], v244 offset:4096
    ds_read_b64_tr_b16 v[178:179], v244 offset:5120
    ds_read_b64_tr_b16 v[180:181], v245 offset:4096
    ds_read_b64_tr_b16 v[182:183], v245 offset:5120
    v_fmac_f32 v254, v5, v149
    v_fmac_f32 v254, v6, v150
    v_fmac_f32 v254, v7, v151
    v_fmac_f32 v200, v8, v160
    v_mfma_f32_32x32x8_bf16 v[32:47], v[72:73], v[184:185], v[32:47]
    v_fmac_f32 v200, v9, v161
    v_permlane32_swap_b32 v196, v254
    v_fmac_f32 v200, v10, v162
    v_fmac_f32 v200, v11, v163
    v_fmac_f32 v200, v12, v164
    v_mfma_f32_32x32x8_bf16 v[48:63], v[76:77], v[184:185], v[48:63]
    ds_swizzle_b32 v76, v76 offset:0x401F
    ds_swizzle_b32 v77, v77 offset:0x401F
    v_fmac_f32 v200, v13, v165
    v_fmac_f32 v200, v14, v166
    v_fmac_f32 v200, v15, v167
    v_add_f32 v254, v196, v254
    s_waitcnt lgkmcnt(6)
    s_mov_b64 exec, s[56:57]
    v_xor_b32 v68, 0x80008000, v68
    v_xor_b32 v69, 0x80008000, v69
    v_xor_b32 v70, 0x80008000, v70
    v_xor_b32 v71, 0x80008000, v71
    s_mov_b64 exec, -1
    s_waitcnt vmcnt(4) lgkmcnt(2)
    v_mfma_f32_32x32x16_bf16 v[0:15], v[64:67], v[176:179], 0
    v_mul_f32 v255, v32, v152
    v_fmac_f32 v255, v33, v153
    v_fmac_f32 v255, v34, v154
    v_fmac_f32 v255, v35, v155
    v_fmac_f32 v255, v36, v156
    s_add_u32 m0, s21, 4096
    s_cmp_eq_u32 s50, 4
    v_mfma_f32_32x32x16_bf16 v[16:31], v[68:71], v[176:179], v[16:31]
    s_cbranch_scc1 WL_3_2
    v_lshl_add_u32 v238, v238, 10, v246
    v_lshl_add_u32 v239, v239, 10, v246
    buffer_load_dwordx4 v238, s[4:7], s40 offen  lds
    buffer_load_dwordx4 v239, s[8:11], s40 offen offset:1024  lds
WR_3_2:
    ds_read_b64_tr_b16 v[176:177], v244 offset:6144
    ds_read_b64_tr_b16 v[184:185], v245 offset:6144
    v_fmac_f32 v255, v37, v157
    v_fmac_f32 v255, v38, v158
    v_fmac_f32 v255, v39, v159
    v_fmac_f32 v201, v40, v168
    v_fmac_f32 v201, v41, v169
    s_waitcnt lgkmcnt(0)
    s_mov_b64 exec, s[56:57]
    v_xor_b32 v76, 0x80008000, v76
    v_xor_b32 v77, 0x80008000, v77
    s_mov_b64 exec, -1
    v_mfma_f32_32x32x8_bf16 v[0:15], v[72:73], v[176:177], v[0:15]
    v_permlane32_swap_b32 v197, v255
    v_fmac_f32 v201, v42, v170
    v_fmac_f32 v201, v43, v171
    v_fmac_f32 v201, v44, v172
    v_fmac_f32 v201, v45, v173
    s_add_u32 m0, s21, 6144
    s_cmp_eq_u32 s50, 4
    v_mfma_f32_32x32x8_bf16 v[16:31], v[76:77], v[176:177], v[16:31]
    s_cbranch_scc1 WL_3_3
    v_lshl_add_u32 v240, v240, 10, v246
    v_lshl_add_u32 v241, v241, 10, v246
    buffer_load_dwordx4 v240, s[4:7], s41 offen  lds
    buffer_load_dwordx4 v241, s[8:11], s41 offen offset:1024  lds
WR_3_3:
    v_fmac_f32 v201, v46, v174
    v_fmac_f32 v201, v47, v175
    v_add_f32 v255, v197, v255
    v_cvt_pk_bf16_f32 v194, v254, v255
    v_mfma_f32_32x32x16_bf16 v[32:47], v[64:67], v[180:183], 0
    v_mul_f32 v254, v0, v144
    v_fmac_f32 v254, v1, v145
    v_fmac_f32 v254, v2, v146
    v_fmac_f32 v254, v3, v147
    v_fmac_f32 v254, v4, v148
    v_fmac_f32 v254, v5, v149
    v_fmac_f32 v254, v6, v150
    v_fmac_f32 v254, v7, v151
    v_fma_f32 v202, v8, -v160, v202
    v_fma_f32 v202, v9, -v161, v202
    v_mfma_f32_32x32x16_bf16 v[48:63], v[68:71], v[180:183], v[48:63]
    s_waitcnt vmcnt(6)
    ds_read_b64_tr_b16 v[176:177], v244 offset:0
    ds_read_b64_tr_b16 v[178:179], v244 offset:1024
    ds_read_b64_tr_b16 v[180:181], v245 offset:0
    ds_read_b64_tr_b16 v[182:183], v245 offset:1024
    v_permlane32_swap_b32 v254, v200
    v_fma_f32 v202, v10, -v162, v202
    v_fma_f32 v202, v11, -v163, v202
    v_fma_f32 v202, v12, -v164, v202
    v_fma_f32 v202, v13, -v165, v202
    v_fma_f32 v202, v14, -v166, v202
    v_fma_f32 v202, v15, -v167, v202
    v_add_f32 v200, v254, v200
    v_fmac_f32 v198, v16, v112
    v_permlane32_swap_b32 v202, v254
    v_mfma_f32_32x32x8_bf16 v[32:47], v[72:73], v[184:185], v[32:47]
    v_fmac_f32 v198, v17, v113
    v_fmac_f32 v198, v18, v114
    v_fmac_f32 v198, v19, v115
    v_fmac_f32 v198, v20, v116
    v_fmac_f32 v198, v21, v117
    v_fmac_f32 v198, v22, v118
    v_fmac_f32 v198, v23, v119
    v_add_f32 v254, v202, v254
    v_mul_f32 v196, v24, v160
    v_fmac_f32 v196, v25, v161
    v_mfma_f32_32x32x8_bf16 v[48:63], v[76:77], v[184:185], v[48:63]
    v_add_u32 v249, s48, v249
    v_add_u32 v250, s49, v250
    ds_read_b32 v252, v251 offset:16
    ds_read_b64_tr_b16 v[64:65], v249 offset:0
    ds_read_b64_tr_b16 v[68:69], v249 offset:64
    ds_read_b64_tr_b16 v[66:67], v249 offset:256
    ds_read_b64_tr_b16 v[70:71], v249 offset:320
    s_mov_b64 exec, s[54:55]
    ds_read_u16_d16_hi v242, v250 offset:0
    s_mov_b64 exec, -1
    v_fmac_f32 v196, v26, v162
    v_fmac_f32 v196, v27, v163
    v_fmac_f32 v196, v28, v164
    v_fmac_f32 v196, v29, v165
    v_fmac_f32 v196, v30, v166
    v_fmac_f32 v196, v31, v167
    s_nop 1
    v_permlane32_swap_b32 v198, v196
    v_add_f32 v196, v198, v196
    s_cmp_eq_u32 s50, 4
    s_cbranch_scc1 LEPI_0
    v_mul_f32 v255, v32, v152
    v_fmac_f32 v255, v33, v153
    v_fmac_f32 v255, v34, v154
    v_fmac_f32 v255, v35, v155
    v_fmac_f32 v255, v36, v156
    v_fmac_f32 v255, v37, v157
    v_fmac_f32 v255, v38, v158
    v_fmac_f32 v255, v39, v159
    v_fma_f32 v203, v40, -v168, v203
    v_fma_f32 v203, v41, -v169, v203
    v_permlane32_swap_b32 v255, v201
    v_fma_f32 v203, v42, -v170, v203
    v_fma_f32 v203, v43, -v171, v203
    v_fma_f32 v203, v44, -v172, v203
    v_fma_f32 v203, v45, -v173, v203
    v_fma_f32 v203, v46, -v174, v203
    v_fma_f32 v203, v47, -v175, v203
    v_add_f32 v201, v255, v201
    v_fmac_f32 v199, v48, v120
    v_permlane32_swap_b32 v203, v255
    v_fmac_f32 v199, v49, v121
    v_fmac_f32 v199, v50, v122
    v_fmac_f32 v199, v51, v123
    v_fmac_f32 v199, v52, v124
    v_fmac_f32 v199, v53, v125
    v_fmac_f32 v199, v54, v126
    v_fmac_f32 v199, v55, v127
    v_add_f32 v255, v203, v255
    v_mul_f32 v197, v56, v168
    v_fmac_f32 v197, v57, v169
    v_fmac_f32 v197, v58, v170
    v_fmac_f32 v197, v59, v171
    v_fmac_f32 v197, v60, v172
    v_fmac_f32 v197, v61, v173
    v_fmac_f32 v197, v62, v174
    v_fmac_f32 v197, v63, v175
    s_nop 1
    v_permlane32_swap_b32 v199, v197
    v_add_f32 v197, v199, v197
    v_cvt_pk_bf16_f32 v200, v200, v201
    v_cvt_pk_bf16_f32 v254, v254, v255
    v_cvt_pk_bf16_f32 v196, v196, v197
    ds_write2st64_b32 v253, v192, v193 offset0:0 offset1:1
    ds_write2st64_b32 v253, v194, v200 offset0:2 offset1:3
    ds_write_b32 v253, v196 offset:1024
    s_mov_b64 exec, 0xffffffff
    ds_write_b32 v253, v254 offset:1280
    s_mov_b64 exec, -1
    s_add_u32 s50, s50, 1
    s_cmp_ge_u32 s50, 4
    s_cbranch_scc1 LAST1
    s_waitcnt lgkmcnt(9)
    v_readfirstlane_b32 s66, v252
    s_add_u32 s53, s53, 1
    v_mov_b32 v252, s53
    s_cmp_le_u32 s53, s66
    ds_write2_b32 v251, v252, v252 offset0:0 offset1:8
    s_setprio 1
    s_cbranch_scc1 PRIO_13
    s_setprio 0
PRIO_13:
    s_cmp_eq_u32 s52, 4
    s_cbranch_scc1 ITEM_1_4
    s_cmp_eq_u32 s52, 5
    s_cbranch_scc1 ITEM_1_5
    s_cmp_eq_u32 s52, 3
    s_cbranch_scc1 ITEM_1_3
    s_cmp_eq_u32 s52, 6
    s_cbranch_scc1 ITEM_1_6
    s_cmp_eq_u32 s52, 8
    s_cbranch_scc1 ITEM_1_8
    s_branch ITEM_1_2
WL_3_0:
    s_add_u32 s66, s51, 0
    buffer_load_dwordx4 v[96:99], v246, s[16:19], s66 offen offset:2048 sc1
    buffer_load_dwordx4 v[100:103], v246, s[16:19], s66 offen offset:3072 sc1
    s_branch WR_3_0
WL_3_1:
    s_add_u32 s66, s51, 4096
    buffer_load_dwordx4 v[104:107], v246, s[16:19], s66 offen offset:2048 sc1
    buffer_load_dwordx4 v[108:111], v246, s[16:19], s66 offen offset:3072 sc1
    s_branch WR_3_1
WL_3_2:
    s_add_u32 s66, s51, 8192
    buffer_load_dwordx4 v[128:131], v246, s[16:19], s66 offen offset:2048 sc1
    buffer_load_dwordx4 v[132:135], v246, s[16:19], s66 offen offset:3072 sc1
    s_branch WR_3_2
WL_3_3:
    s_add_u32 s66, s51, 12288
    buffer_load_dwordx4 v[136:139], v246, s[16:19], s66 offen offset:2048 sc1
    buffer_load_dwordx4 v[140:143], v246, s[16:19], s66 offen offset:3072 sc1
    s_branch WR_3_3
.p2align 6
ITEM_1_6:
    s_mov_b64 exec, s[54:55]
    ds_read_u16_d16_hi v243, v250 offset:128
    s_mov_b64 exec, -1
    ds_read_b64_tr_b16 v[72:73], v249 offset:512
    ds_read_b64_tr_b16 v[76:77], v249 offset:576
    ds_read_b64_tr_b16 v[74:75], v249 offset:768
    ds_read_b64_tr_b16 v[78:79], v249 offset:832
    ds_read_b64_tr_b16 v[80:81], v249 offset:1024
    ds_read_b64_tr_b16 v[84:85], v249 offset:1088
    ds_read_b64_tr_b16 v[82:83], v249 offset:1280
    ds_read_b64_tr_b16 v[86:87], v249 offset:1344
    s_waitcnt lgkmcnt(9)
    v_mul_f32_dpp v196, v242, v64 row_newbcast:0 row_mask:0xf bank_mask:0xf
    v_mul_f32_dpp v197, v242, v65 row_newbcast:1 row_mask:0xf bank_mask:0xf
    v_mul_f32_dpp v198, v242, v64 row_newbcast:8 row_mask:0xf bank_mask:0xf
    v_mul_f32_dpp v199, v242, v65 row_newbcast:9 row_mask:0xf bank_mask:0xf
    v_mul_f32_dpp v200, v242, v68 row_newbcast:2 row_mask:0xf bank_mask:0xf
    v_mul_f32_dpp v201, v242, v69 row_newbcast:3 row_mask:0xf bank_mask:0xf
    v_mul_f32_dpp v202, v242, v68 row_newbcast:10 row_mask:0xf bank_mask:0xf
    v_mul_f32_dpp v203, v242, v69 row_newbcast:11 row_mask:0xf bank_mask:0xf
    v_cvt_pk_bf16_f32 v64, v196, v197
    v_cvt_pk_bf16_f32 v68, v198, v199
    v_cvt_pk_bf16_f32 v65, v200, v201
    v_cvt_pk_bf16_f32 v69, v202, v203
    v_mul_f32_dpp v196, v242, v66 row_newbcast:4 row_mask:0xf bank_mask:0xf
    v_mul_f32_dpp v197, v242, v67 row_newbcast:5 row_mask:0xf bank_mask:0xf
    v_mul_f32_dpp v198, v242, v66 row_newbcast:12 row_mask:0xf bank_mask:0xf
    v_mul_f32_dpp v199, v242, v67 row_newbcast:13 row_mask:0xf bank_mask:0xf
    v_mul_f32_dpp v200, v242, v70 row_newbcast:6 row_mask:0xf bank_mask:0xf
    v_mul_f32_dpp v201, v242, v71 row_newbcast:7 row_mask:0xf bank_mask:0xf
    v_mul_f32_dpp v202, v242, v70 row_newbcast:14 row_mask:0xf bank_mask:0xf
    v_mul_f32_dpp v203, v242, v71 row_newbcast:15 row_mask:0xf bank_mask:0xf
    v_cvt_pk_bf16_f32 v66, v196, v197
    v_cvt_pk_bf16_f32 v70, v198, v199
    v_cvt_pk_bf16_f32 v67, v200, v201
    v_cvt_pk_bf16_f32 v71, v202, v203
    s_mov_b64 exec, s[54:55]
    ds_read_u16_d16_hi v242, v250 offset:256
    s_mov_b64 exec, -1
    s_waitcnt vmcnt(4) lgkmcnt(5)
    v_mfma_f32_32x32x16_bf16 v[0:15], v[64:67], v[176:179], 0
    v_mul_f32_dpp v196, v243, v72 row_newbcast:0 row_mask:0xf bank_mask:0xf
    v_mul_f32_dpp v197, v243, v73 row_newbcast:1 row_mask:0xf bank_mask:0xf
    v_mul_f32_dpp v198, v243, v72 row_newbcast:8 row_mask:0xf bank_mask:0xf
    v_mul_f32_dpp v199, v243, v73 row_newbcast:9 row_mask:0xf bank_mask:0xf
    v_mul_f32_dpp v200, v243, v76 row_newbcast:2 row_mask:0xf bank_mask:0xf
    v_mul_f32_dpp v201, v243, v77 row_newbcast:3 row_mask:0xf bank_mask:0xf
    v_mul_f32_dpp v202, v243, v76 row_newbcast:10 row_mask:0xf bank_mask:0xf
    v_mul_f32_dpp v203, v243, v77 row_newbcast:11 row_mask:0xf bank_mask:0xf
    v_cvt_pk_bf16_f32 v72, v196, v197
    v_cvt_pk_bf16_f32 v76, v198, v199
    v_cvt_pk_bf16_f32 v73, v200, v201
    v_cvt_pk_bf16_f32 v77, v202, v203
    s_add_u32 m0, s21, 0
    v_mfma_f32_32x32x16_bf16 v[16:31], v[68:71], v[176:179], 0
    buffer_load_dwordx4 v236, s[4:7], s35 offen  lds
    buffer_load_dwordx4 v237, s[8:11], s35 offen offset:1024  lds
    ds_read_b64_tr_b16 v[176:177], v244 offset:2048
    ds_read_b64_tr_b16 v[178:179], v244 offset:3072
    ds_read_b64_tr_b16 v[184:185], v245 offset:2048
    ds_read_b64_tr_b16 v[186:187], v245 offset:3072
    v_mul_f32_dpp v196, v243, v74 row_newbcast:4 row_mask:0xf bank_mask:0xf
    v_mul_f32_dpp v197, v243, v75 row_newbcast:5 row_mask:0xf bank_mask:0xf
    v_mul_f32_dpp v198, v243, v74 row_newbcast:12 row_mask:0xf bank_mask:0xf
    v_mul_f32_dpp v199, v243, v75 row_newbcast:13 row_mask:0xf bank_mask:0xf
    v_mul_f32_dpp v200, v243, v78 row_newbcast:6 row_mask:0xf bank_mask:0xf
    v_mul_f32_dpp v201, v243, v79 row_newbcast:7 row_mask:0xf bank_mask:0xf
    v_mul_f32_dpp v202, v243, v78 row_newbcast:14 row_mask:0xf bank_mask:0xf
    v_mul_f32_dpp v203, v243, v79 row_newbcast:15 row_mask:0xf bank_mask:0xf
    v_cvt_pk_bf16_f32 v74, v196, v197
    v_cvt_pk_bf16_f32 v78, v198, v199
    v_cvt_pk_bf16_f32 v75, v200, v201
    v_cvt_pk_bf16_f32 v79, v202, v203
    s_nop 0
    s_waitcnt vmcnt(4) lgkmcnt(0)
    v_mfma_f32_32x32x16_bf16 v[0:15], v[72:75], v[176:179], v[0:15]
    v_mul_f32_dpp v196, v242, v80 row_newbcast:0 row_mask:0xf bank_mask:0xf
    v_mul_f32_dpp v197, v242, v81 row_newbcast:1 row_mask:0xf bank_mask:0xf
    v_mul_f32_dpp v198, v242, v80 row_newbcast:8 row_mask:0xf bank_mask:0xf
    v_mul_f32_dpp v199, v242, v81 row_newbcast:9 row_mask:0xf bank_mask:0xf
    v_mul_f32_dpp v200, v242, v84 row_newbcast:2 row_mask:0xf bank_mask:0xf
    v_mul_f32_dpp v201, v242, v85 row_newbcast:3 row_mask:0xf bank_mask:0xf
    v_mul_f32_dpp v202, v242, v84 row_newbcast:10 row_mask:0xf bank_mask:0xf
    v_mul_f32_dpp v203, v242, v85 row_newbcast:11 row_mask:0xf bank_mask:0xf
    v_cvt_pk_bf16_f32 v80, v196, v197
    v_cvt_pk_bf16_f32 v84, v198, v199
    v_cvt_pk_bf16_f32 v81, v200, v201
    v_cvt_pk_bf16_f32 v85, v202, v203
    s_add_u32 m0, s21, 2048
    v_mfma_f32_32x32x16_bf16 v[16:31], v[76:79], v[176:179], v[16:31]
    buffer_load_dwordx4 v238, s[4:7], s35 offen  lds
    buffer_load_dwordx4 v239, s[8:11], s35 offen offset:1024  lds
    ds_read_b64_tr_b16 v[176:177], v244 offset:4096
    ds_read_b64_tr_b16 v[178:179], v244 offset:5120
    ds_read_b64_tr_b16 v[188:189], v245 offset:4096
    ds_read_b64_tr_b16 v[190:191], v245 offset:5120
    v_mul_f32_dpp v196, v242, v82 row_newbcast:4 row_mask:0xf bank_mask:0xf
    v_mul_f32_dpp v197, v242, v83 row_newbcast:5 row_mask:0xf bank_mask:0xf
    v_mul_f32_dpp v198, v242, v82 row_newbcast:12 row_mask:0xf bank_mask:0xf
    v_mul_f32_dpp v199, v242, v83 row_newbcast:13 row_mask:0xf bank_mask:0xf
    v_mul_f32_dpp v200, v242, v86 row_newbcast:6 row_mask:0xf bank_mask:0xf
    v_mul_f32_dpp v201, v242, v87 row_newbcast:7 row_mask:0xf bank_mask:0xf
    v_mul_f32_dpp v202, v242, v86 row_newbcast:14 row_mask:0xf bank_mask:0xf
    v_mul_f32_dpp v203, v242, v87 row_newbcast:15 row_mask:0xf bank_mask:0xf
    v_cvt_pk_bf16_f32 v82, v196, v197
    v_cvt_pk_bf16_f32 v86, v198, v199
    v_cvt_pk_bf16_f32 v83, v200, v201
    v_cvt_pk_bf16_f32 v87, v202, v203
    s_nop 0
    s_waitcnt lgkmcnt(0)
    v_mfma_f32_32x32x16_bf16 v[0:15], v[80:83], v[176:179], v[0:15]
    s_add_u32 m0, s21, 4096
    v_mfma_f32_32x32x16_bf16 v[16:31], v[84:87], v[176:179], v[16:31]
    buffer_load_dwordx4 v234, s[4:7], s36 offen  lds
    buffer_load_dwordx4 v235, s[8:11], s36 offen offset:1024  lds
    s_mov_b32 m0, s50
    s_nop 0
    s_movrels_b32 s71, s23
    s_movrels_b32 s33, s28
    v_add_u32 v253, s33, v248
    s_bfe_u32 s46, s71, 0x30012
    s_mov_b32 m0, s46
    s_and_b32 s66, s71, 0x3ffff
    s_movrels_b32 s68, s57
    s_movrels_b32 s69, s61
    s_sub_u32 s48, s66, s47
    s_mov_b32 s47, s66
    s_lshr_b32 s52, s71, 28
    s_lshl_b32 s67, s46, 9
    s_add_u32 s66, s66, s67
    s_sub_u32 s49, s66, s42
    s_mov_b32 s42, s66
    s_bfe_u32 s66, s68, 655360
    s_add_u32 s43, s42, s66
    s_bfe_u32 s39, s69, 655360
    s_bfe_u32 s66, s68, 655370
    s_add_u32 s44, s42, s66
    s_bfe_u32 s40, s69, 655370
    s_bfe_u32 s66, s68, 655380
    s_add_u32 s45, s42, s66
    s_bfe_u32 s41, s69, 655380
    v_add_u32 v252, s45, v247
    ds_read_u16 v240, v252
    ds_read_u16 v241, v252 offset:64
    v_mfma_f32_32x32x16_bf16 v[32:47], v[64:67], v[180:183], 0
    v_mul_f32 v196, v0, v96
    v_fmac_f32 v196, v1, v97
    v_fmac_f32 v196, v2, v98
    v_fmac_f32 v196, v3, v99
    v_fmac_f32 v196, v4, v100
    v_fmac_f32 v196, v5, v101
    v_fmac_f32 v196, v6, v102
    v_mfma_f32_32x32x16_bf16 v[48:63], v[68:71], v[180:183], 0
    v_fmac_f32 v196, v7, v103
    v_mul_f32 v198, v8, v128
    v_fmac_f32 v198, v9, v129
    v_fmac_f32 v198, v10, v130
    v_fmac_f32 v198, v11, v131
    v_fmac_f32 v198, v12, v132
    v_mfma_f32_32x32x16_bf16 v[32:47], v[72:75], v[184:187], v[32:47]
    v_fmac_f32 v198, v13, v133
    v_fmac_f32 v198, v14, v134
    v_fmac_f32 v198, v15, v135
    v_mul_f32 v200, v16, v128
    v_fmac_f32 v200, v17, v129
    v_permlane32_swap_b32 v196, v198
    v_mfma_f32_32x32x16_bf16 v[48:63], v[76:79], v[184:187], v[48:63]
    s_waitcnt vmcnt(6)
    ds_read_b64_tr_b16 v[176:177], v244 offset:6144
    ds_read_b64_tr_b16 v[178:179], v244 offset:7168
    ds_read_b64_tr_b16 v[180:181], v245 offset:6144
    ds_read_b64_tr_b16 v[182:183], v245 offset:7168
    v_fmac_f32 v200, v18, v130
    v_fmac_f32 v200, v19, v131
    v_fmac_f32 v200, v20, v132
    v_fmac_f32 v200, v21, v133
    v_fmac_f32 v200, v22, v134
    v_fmac_f32 v200, v23, v135
    v_mfma_f32_32x32x16_bf16 v[32:47], v[80:83], v[188:191], v[32:47]
    v_add_f32 v198, v196, v198
    v_mul_f32_e64 v202, v24, -v128
    v_fma_f32 v202, v25, -v129, v202
    v_fma_f32 v202, v26, -v130, v202
    v_fma_f32 v202, v27, -v131, v202
    v_fma_f32 v202, v28, -v132, v202
    v_mfma_f32_32x32x16_bf16 v[48:63], v[84:87], v[188:191], v[48:63]
    v_fma_f32 v202, v29, -v133, v202
    v_fma_f32 v202, v30, -v134, v202
    v_fma_f32 v202, v31, -v135, v202
    s_nop 1
    v_permlane32_swap_b32 v200, v202
    v_add_f32 v202, v200, v202
    s_waitcnt vmcnt(4) lgkmcnt(0)
    v_mfma_f32_32x32x16_bf16 v[0:15], v[64:67], v[176:179], 0
    v_mul_f32 v197, v32, v104
    v_fmac_f32 v197, v33, v105
    v_fmac_f32 v197, v34, v106
    v_fmac_f32 v197, v35, v107
    v_fmac_f32 v197, v36, v108
    v_fmac_f32 v197, v37, v109
    v_fmac_f32 v197, v38, v110
    s_add_u32 m0, s21, 6144
    v_mfma_f32_32x32x16_bf16 v[16:31], v[68:71], v[176:179], 0
    buffer_load_dwordx4 v236, s[4:7], s36 offen  lds
    buffer_load_dwordx4 v237, s[8:11], s36 offen offset:1024  lds
    ds_read_b64_tr_b16 v[176:177], v244 offset:0
    ds_read_b64_tr_b16 v[178:179], v244 offset:1024
    ds_read_b64_tr_b16 v[184:185], v245 offset:0
    ds_read_b64_tr_b16 v[186:187], v245 offset:1024
    v_fmac_f32 v197, v39, v111
    v_mul_f32 v199, v40, v136
    v_fmac_f32 v199, v41, v137
    v_fmac_f32 v199, v42, v138
    v_fmac_f32 v199, v43, v139
    v_fmac_f32 v199, v44, v140
    s_waitcnt vmcnt(4) lgkmcnt(0)
    v_mfma_f32_32x32x16_bf16 v[0:15], v[72:75], v[176:179], v[0:15]
    v_fmac_f32 v199, v45, v141
    v_fmac_f32 v199, v46, v142
    v_fmac_f32 v199, v47, v143
    v_mul_f32 v201, v48, v136
    v_fmac_f32 v201, v49, v137
    v_permlane32_swap_b32 v197, v199
    v_fmac_f32 v201, v50, v138
    s_add_u32 m0, s21, 0
    v_mfma_f32_32x32x16_bf16 v[16:31], v[76:79], v[176:179], v[16:31]
    buffer_load_dwordx4 v238, s[4:7], s36 offen  lds
    buffer_load_dwordx4 v239, s[8:11], s36 offen offset:1024  lds
    ds_read_b64_tr_b16 v[176:177], v244 offset:2048
    ds_read_b64_tr_b16 v[178:179], v244 offset:3072
    ds_read_b64_tr_b16 v[188:189], v245 offset:2048
    ds_read_b64_tr_b16 v[190:191], v245 offset:3072
    v_fmac_f32 v201, v51, v139
    v_fmac_f32 v201, v52, v140
    v_fmac_f32 v201, v53, v141
    v_fmac_f32 v201, v54, v142
    v_fmac_f32 v201, v55, v143
    v_add_f32 v199, v197, v199
    s_waitcnt lgkmcnt(0)
    v_mfma_f32_32x32x16_bf16 v[0:15], v[80:83], v[176:179], v[0:15]
    v_mul_f32_e64 v203, v56, -v136
    v_fma_f32 v203, v57, -v137, v203
    v_fma_f32 v203, v58, -v138, v203
    v_fma_f32 v203, v59, -v139, v203
    v_fma_f32 v203, v60, -v140, v203
    v_fma_f32 v203, v61, -v141, v203
    v_fma_f32 v203, v62, -v142, v203
    s_add_u32 m0, s21, 2048
    v_mfma_f32_32x32x16_bf16 v[16:31], v[84:87], v[176:179], v[16:31]
    buffer_load_dwordx4 v234, s[4:7], s37 offen  lds
    buffer_load_dwordx4 v235, s[8:11], s37 offen offset:1024  lds
    v_add_u32 v252, s42, v247
    ds_read_u16 v234, v252
    ds_read_u16 v235, v252 offset:64
    v_fma_f32 v203, v63, -v143, v203
    s_nop 1
    v_permlane32_swap_b32 v201, v203
    v_add_f32 v203, v201, v203
    v_cvt_pk_bf16_f32 v192, v198, v199
    v_cvt_pk_bf16_f32 v193, v202, v203
    v_mfma_f32_32x32x16_bf16 v[32:47], v[64:67], v[180:183], 0
    v_mul_f32 v196, v0, v144
    v_fmac_f32 v196, v1, v145
    v_fmac_f32 v196, v2, v146
    v_fmac_f32 v196, v3, v147
    v_fmac_f32 v196, v4, v148
    v_fmac_f32 v196, v5, v149
    v_mfma_f32_32x32x16_bf16 v[48:63], v[68:71], v[180:183], 0
    v_fmac_f32 v196, v6, v150
    v_fmac_f32 v196, v7, v151
    v_mul_f32 v198, v8, v112
    v_fmac_f32 v198, v9, v113
    v_fmac_f32 v198, v10, v114
    v_mfma_f32_32x32x16_bf16 v[32:47], v[72:75], v[184:187], v[32:47]
    v_fmac_f32 v198, v11, v115
    v_fmac_f32 v198, v12, v116
    v_fmac_f32 v198, v13, v117
    v_fmac_f32 v198, v14, v118
    v_fmac_f32 v198, v15, v119
    v_mfma_f32_32x32x16_bf16 v[48:63], v[76:79], v[184:187], v[48:63]
    s_waitcnt vmcnt(6)
    ds_read_b64_tr_b16 v[176:177], v244 offset:4096
    ds_read_b64_tr_b16 v[178:179], v244 offset:5120
    ds_read_b64_tr_b16 v[180:181], v245 offset:4096
    ds_read_b64_tr_b16 v[182:183], v245 offset:5120
    v_mul_f32_e64 v200, v16, -v160
    v_fma_f32 v200, v17, -v161, v200
    v_fma_f32 v200, v18, -v162, v200
    v_fma_f32 v200, v19, -v163, v200
    v_fma_f32 v200, v20, -v164, v200
    v_fma_f32 v200, v21, -v165, v200
    v_mfma_f32_32x32x16_bf16 v[32:47], v[80:83], v[188:191], v[32:47]
    v_fma_f32 v200, v22, -v166, v200
    v_fma_f32 v200, v23, -v167, v200
    v_mul_f32_e64 v202, v24, -v160
    v_fma_f32 v202, v25, -v161, v202
    v_fma_f32 v202, v26, -v162, v202
    v_mfma_f32_32x32x16_bf16 v[48:63], v[84:87], v[188:191], v[48:63]
    v_fma_f32 v202, v27, -v163, v202
    v_fma_f32 v202, v28, -v164, v202
    v_fma_f32 v202, v29, -v165, v202
    v_fma_f32 v202, v30, -v166, v202
    v_fma_f32 v202, v31, -v167, v202
    s_waitcnt vmcnt(4) lgkmcnt(0)
    v_mfma_f32_32x32x16_bf16 v[0:15], v[64:67], v[176:179], 0
    v_mul_f32 v197, v32, v152
    v_fmac_f32 v197, v33, v153
    v_fmac_f32 v197, v34, v154
    v_fmac_f32 v197, v35, v155
    v_fmac_f32 v197, v36, v156
    v_fmac_f32 v197, v37, v157
    s_add_u32 m0, s21, 4096
    v_mfma_f32_32x32x16_bf16 v[16:31], v[68:71], v[176:179], 0
    buffer_load_dwordx4 v236, s[4:7], s37 offen  lds
    buffer_load_dwordx4 v237, s[8:11], s37 offen offset:1024  lds
    ds_read_b64_tr_b16 v[176:177], v244 offset:6144
    ds_read_b64_tr_b16 v[178:179], v244 offset:7168
    ds_read_b64_tr_b16 v[184:185], v245 offset:6144
    ds_read_b64_tr_b16 v[186:187], v245 offset:7168
    v_add_u32 v252, s43, v247
    ds_read_u16 v236, v252
    ds_read_u16 v237, v252 offset:64
    v_fmac_f32 v197, v38, v158
    v_fmac_f32 v197, v39, v159
    v_mul_f32 v199, v40, v120
    v_fmac_f32 v199, v41, v121
    v_fmac_f32 v199, v42, v122
    s_waitcnt vmcnt(4) lgkmcnt(2)
    v_mfma_f32_32x32x16_bf16 v[0:15], v[72:75], v[176:179], v[0:15]
    v_fmac_f32 v199, v43, v123
    v_fmac_f32 v199, v44, v124
    v_fmac_f32 v199, v45, v125
    v_fmac_f32 v199, v46, v126
    v_fmac_f32 v199, v47, v127
    s_add_u32 m0, s21, 6144
    v_mfma_f32_32x32x16_bf16 v[16:31], v[76:79], v[176:179], v[16:31]
    buffer_load_dwordx4 v238, s[4:7], s37 offen  lds
    buffer_load_dwordx4 v239, s[8:11], s37 offen offset:1024  lds
    ds_read_b64_tr_b16 v[176:177], v244 offset:0
    ds_read_b64_tr_b16 v[178:179], v244 offset:1024
    ds_read_b64_tr_b16 v[188:189], v245 offset:0
    ds_read_b64_tr_b16 v[190:191], v245 offset:1024
    v_add_u32 v252, s44, v247
    ds_read_u16 v238, v252
    ds_read_u16 v239, v252 offset:64
    v_mul_f32_e64 v201, v48, -v168
    v_fma_f32 v201, v49, -v169, v201
    v_fma_f32 v201, v50, -v170, v201
    v_fma_f32 v201, v51, -v171, v201
    v_fma_f32 v201, v52, -v172, v201
    v_fma_f32 v201, v53, -v173, v201
    s_waitcnt lgkmcnt(2)
    v_mfma_f32_32x32x16_bf16 v[0:15], v[80:83], v[176:179], v[0:15]
    v_fma_f32 v201, v54, -v174, v201
    v_fma_f32 v201, v55, -v175, v201
    v_mul_f32_e64 v203, v56, -v168
    v_fma_f32 v203, v57, -v169, v203
    v_fma_f32 v203, v58, -v170, v203
    s_add_u32 m0, s21, 0
    s_cmp_eq_u32 s50, 4
    v_mfma_f32_32x32x16_bf16 v[16:31], v[84:87], v[176:179], v[16:31]
    s_cbranch_scc1 WL_6_0
    v_lshl_add_u32 v234, v234, 10, v246
    v_lshl_add_u32 v235, v235, 10, v246
    buffer_load_dwordx4 v234, s[4:7], s38 offen  lds
    buffer_load_dwordx4 v235, s[8:11], s38 offen offset:1024  lds
WR_6_0:
    v_fma_f32 v203, v59, -v171, v203
    v_fma_f32 v203, v60, -v172, v203
    v_fma_f32 v203, v61, -v173, v203
    v_fma_f32 v203, v62, -v174, v203
    v_fma_f32 v203, v63, -v175, v203
    v_mfma_f32_32x32x16_bf16 v[32:47], v[64:67], v[180:183], 0
    v_mul_f32 v254, v0, v144
    v_fmac_f32 v254, v1, v145
    v_fmac_f32 v254, v2, v146
    v_mfma_f32_32x32x16_bf16 v[48:63], v[68:71], v[180:183], 0
    ds_swizzle_b32 v68, v68 offset:0x401F
    ds_swizzle_b32 v69, v69 offset:0x401F
    ds_swizzle_b32 v70, v70 offset:0x401F
    ds_swizzle_b32 v71, v71 offset:0x401F
    v_fmac_f32 v254, v3, v147
    v_fmac_f32 v254, v4, v148
    v_fmac_f32 v254, v5, v149
    v_mfma_f32_32x32x16_bf16 v[32:47], v[72:75], v[184:187], v[32:47]
    v_fmac_f32 v254, v6, v150
    v_fmac_f32 v254, v7, v151
    v_fmac_f32 v200, v8, v160
    v_mfma_f32_32x32x16_bf16 v[48:63], v[76:79], v[184:187], v[48:63]
    ds_swizzle_b32 v76, v76 offset:0x401F
    ds_swizzle_b32 v77, v77 offset:0x401F
    ds_swizzle_b32 v78, v78 offset:0x401F
    ds_swizzle_b32 v79, v79 offset:0x401F
    s_waitcnt vmcnt(6)
    ds_read_b64_tr_b16 v[176:177], v244 offset:2048
    ds_read_b64_tr_b16 v[178:179], v244 offset:3072
    ds_read_b64_tr_b16 v[180:181], v245 offset:2048
    ds_read_b64_tr_b16 v[182:183], v245 offset:3072
    v_fmac_f32 v200, v9, v161
    v_permlane32_swap_b32 v196, v254
    v_fmac_f32 v200, v10, v162
    v_mfma_f32_32x32x16_bf16 v[32:47], v[80:83], v[188:191], v[32:47]
    v_fmac_f32 v200, v11, v163
    v_fmac_f32 v200, v12, v164
    v_fmac_f32 v200, v13, v165
    v_mfma_f32_32x32x16_bf16 v[48:63], v[84:87], v[188:191], v[48:63]
    ds_swizzle_b32 v84, v84 offset:0x401F
    ds_swizzle_b32 v85, v85 offset:0x401F
    ds_swizzle_b32 v86, v86 offset:0x401F
    ds_swizzle_b32 v87, v87 offset:0x401F
    v_fmac_f32 v200, v14, v166
    v_fmac_f32 v200, v15, v167
    v_add_f32 v254, v196, v254
    s_waitcnt lgkmcnt(8)
    s_mov_b64 exec, s[56:57]
    v_xor_b32 v68, 0x80008000, v68
    v_xor_b32 v69, 0x80008000, v69
    v_xor_b32 v70, 0x80008000, v70
    v_xor_b32 v71, 0x80008000, v71
    v_xor_b32 v76, 0x80008000, v76
    v_xor_b32 v77, 0x80008000, v77
    v_xor_b32 v78, 0x80008000, v78
    v_xor_b32 v79, 0x80008000, v79
    s_mov_b64 exec, -1
    s_waitcnt vmcnt(4) lgkmcnt(4)
    v_mfma_f32_32x32x16_bf16 v[0:15], v[64:67], v[176:179], 0
    v_mul_f32 v255, v32, v152
    v_fmac_f32 v255, v33, v153
    v_fmac_f32 v255, v34, v154
    v_fmac_f32 v255, v35, v155
    s_add_u32 m0, s21, 2048
    s_cmp_eq_u32 s50, 4
    v_mfma_f32_32x32x16_bf16 v[16:31], v[68:71], v[176:179], v[16:31]
    s_cbranch_scc1 WL_6_1
    v_lshl_add_u32 v236, v236, 10, v246
    v_lshl_add_u32 v237, v237, 10, v246
    buffer_load_dwordx4 v236, s[4:7], s39 offen  lds
    buffer_load_dwordx4 v237, s[8:11], s39 offen offset:1024  lds
WR_6_1:
    ds_read_b64_tr_b16 v[176:177], v244 offset:4096
    ds_read_b64_tr_b16 v[178:179], v244 offset:5120
    ds_read_b64_tr_b16 v[184:185], v245 offset:4096
    ds_read_b64_tr_b16 v[186:187], v245 offset:5120
    v_fmac_f32 v255, v36, v156
    v_fmac_f32 v255, v37, v157
    v_fmac_f32 v255, v38, v158
    s_waitcnt vmcnt(4) lgkmcnt(0)
    v_mfma_f32_32x32x16_bf16 v[0:15], v[72:75], v[176:179], v[0:15]
    v_fmac_f32 v255, v39, v159
    v_fmac_f32 v201, v40, v168
    v_fmac_f32 v201, v41, v169
    s_add_u32 m0, s21, 4096
    s_cmp_eq_u32 s50, 4
    v_mfma_f32_32x32x16_bf16 v[16:31], v[76:79], v[176:179], v[16:31]
    s_cbranch_scc1 WL_6_2
    v_lshl_add_u32 v238, v238, 10, v246
    v_lshl_add_u32 v239, v239, 10, v246
    buffer_load_dwordx4 v238, s[4:7], s40 offen  lds
    buffer_load_dwordx4 v239, s[8:11], s40 offen offset:1024  lds
WR_6_2:
    ds_read_b64_tr_b16 v[176:177], v244 offset:6144
    ds_read_b64_tr_b16 v[178:179], v244 offset:7168
    ds_read_b64_tr_b16 v[188:189], v245 offset:6144
    ds_read_b64_tr_b16 v[190:191], v245 offset:7168
    v_permlane32_swap_b32 v197, v255
    v_fmac_f32 v201, v42, v170
    v_fmac_f32 v201, v43, v171
    s_waitcnt lgkmcnt(0)
    s_mov_b64 exec, s[56:57]
    v_xor_b32 v84, 0x80008000, v84
    v_xor_b32 v85, 0x80008000, v85
    v_xor_b32 v86, 0x80008000, v86
    v_xor_b32 v87, 0x80008000, v87
    s_mov_b64 exec, -1
    v_mfma_f32_32x32x16_bf16 v[0:15], v[80:83], v[176:179], v[0:15]
    v_fmac_f32 v201, v44, v172
    v_fmac_f32 v201, v45, v173
    v_fmac_f32 v201, v46, v174
    s_add_u32 m0, s21, 6144
    s_cmp_eq_u32 s50, 4
    v_mfma_f32_32x32x16_bf16 v[16:31], v[84:87], v[176:179], v[16:31]
    s_cbranch_scc1 WL_6_3
    v_lshl_add_u32 v240, v240, 10, v246
    v_lshl_add_u32 v241, v241, 10, v246
    buffer_load_dwordx4 v240, s[4:7], s41 offen  lds
    buffer_load_dwordx4 v241, s[8:11], s41 offen offset:1024  lds
WR_6_3:
    v_fmac_f32 v201, v47, v175
    v_add_f32 v255, v197, v255
    v_cvt_pk_bf16_f32 v194, v254, v255
    v_mfma_f32_32x32x16_bf16 v[32:47], v[64:67], v[180:183], 0
    v_mul_f32 v254, v0, v144
    v_fmac_f32 v254, v1, v145
    v_fmac_f32 v254, v2, v146
    v_fmac_f32 v254, v3, v147
    v_fmac_f32 v254, v4, v148
    v_fmac_f32 v254, v5, v149
    v_fmac_f32 v254, v6, v150
    v_mfma_f32_32x32x16_bf16 v[48:63], v[68:71], v[180:183], v[48:63]
    v_fmac_f32 v254, v7, v151
    v_fma_f32 v202, v8, -v160, v202
    v_fma_f32 v202, v9, -v161, v202
    v_permlane32_swap_b32 v254, v200
    v_fma_f32 v202, v10, -v162, v202
    v_fma_f32 v202, v11, -v163, v202
    v_mfma_f32_32x32x16_bf16 v[32:47], v[72:75], v[184:187], v[32:47]
    v_fma_f32 v202, v12, -v164, v202
    v_fma_f32 v202, v13, -v165, v202
    v_fma_f32 v202, v14, -v166, v202
    v_fma_f32 v202, v15, -v167, v202
    v_add_f32 v200, v254, v200
    v_fmac_f32 v198, v16, v112
    v_permlane32_swap_b32 v202, v254
    v_mfma_f32_32x32x16_bf16 v[48:63], v[76:79], v[184:187], v[48:63]
    s_waitcnt vmcnt(6)
    ds_read_b64_tr_b16 v[176:177], v244 offset:0
    ds_read_b64_tr_b16 v[178:179], v244 offset:1024
    ds_read_b64_tr_b16 v[180:181], v245 offset:0
    ds_read_b64_tr_b16 v[182:183], v245 offset:1024
    v_fmac_f32 v198, v17, v113
    v_fmac_f32 v198, v18, v114
    v_fmac_f32 v198, v19, v115
    v_fmac_f32 v198, v20, v116
    v_fmac_f32 v198, v21, v117
    v_fmac_f32 v198, v22, v118
    v_mfma_f32_32x32x16_bf16 v[32:47], v[80:83], v[188:191], v[32:47]
    v_fmac_f32 v198, v23, v119
    v_add_f32 v254, v202, v254
    v_mul_f32 v196, v24, v160
    v_fmac_f32 v196, v25, v161
    v_fmac_f32 v196, v26, v162
    v_fmac_f32 v196, v27, v163
    v_fmac_f32 v196, v28, v164
    v_mfma_f32_32x32x16_bf16 v[48:63], v[84:87], v[188:191], v[48:63]
    v_add_u32 v249, s48, v249
    v_add_u32 v250, s49, v250
    ds_read_b32 v252, v251 offset:16
    ds_read_b64_tr_b16 v[64:65], v249 offset:0
    ds_read_b64_tr_b16 v[68:69], v249 offset:64
    ds_read_b64_tr_b16 v[66:67], v249 offset:256
    ds_read_b64_tr_b16 v[70:71], v249 offset:320
    s_mov_b64 exec, s[54:55]
    ds_read_u16_d16_hi v242, v250 offset:0
    s_mov_b64 exec, -1
    v_fmac_f32 v196, v29, v165
    v_fmac_f32 v196, v30, v166
    v_fmac_f32 v196, v31, v167
    s_nop 1
    v_permlane32_swap_b32 v198, v196
    v_add_f32 v196, v198, v196
    s_cmp_eq_u32 s50, 4
    s_cbranch_scc1 LEPI_0
    v_mul_f32 v255, v32, v152
    v_fmac_f32 v255, v33, v153
    v_fmac_f32 v255, v34, v154
    v_fmac_f32 v255, v35, v155
    v_fmac_f32 v255, v36, v156
    v_fmac_f32 v255, v37, v157
    v_fmac_f32 v255, v38, v158
    v_fmac_f32 v255, v39, v159
    v_fma_f32 v203, v40, -v168, v203
    v_fma_f32 v203, v41, -v169, v203
    v_permlane32_swap_b32 v255, v201
    v_fma_f32 v203, v42, -v170, v203
    v_fma_f32 v203, v43, -v171, v203
    v_fma_f32 v203, v44, -v172, v203
    v_fma_f32 v203, v45, -v173, v203
    v_fma_f32 v203, v46, -v174, v203
    v_fma_f32 v203, v47, -v175, v203
    v_add_f32 v201, v255, v201
    v_fmac_f32 v199, v48, v120
    v_permlane32_swap_b32 v203, v255
    v_fmac_f32 v199, v49, v121
    v_fmac_f32 v199, v50, v122
    v_fmac_f32 v199, v51, v123
    v_fmac_f32 v199, v52, v124
    v_fmac_f32 v199, v53, v125
    v_fmac_f32 v199, v54, v126
    v_fmac_f32 v199, v55, v127
    v_add_f32 v255, v203, v255
    v_mul_f32 v197, v56, v168
    v_fmac_f32 v197, v57, v169
    v_fmac_f32 v197, v58, v170
    v_fmac_f32 v197, v59, v171
    v_fmac_f32 v197, v60, v172
    v_fmac_f32 v197, v61, v173
    v_fmac_f32 v197, v62, v174
    v_fmac_f32 v197, v63, v175
    s_nop 1
    v_permlane32_swap_b32 v199, v197
    v_add_f32 v197, v199, v197
    v_cvt_pk_bf16_f32 v200, v200, v201
    v_cvt_pk_bf16_f32 v254, v254, v255
    v_cvt_pk_bf16_f32 v196, v196, v197
    ds_write2st64_b32 v253, v192, v193 offset0:0 offset1:1
    ds_write2st64_b32 v253, v194, v200 offset0:2 offset1:3
    ds_write_b32 v253, v196 offset:1024
    s_mov_b64 exec, 0xffffffff
    ds_write_b32 v253, v254 offset:1280
    s_mov_b64 exec, -1
    s_add_u32 s50, s50, 1
    s_cmp_ge_u32 s50, 4
    s_cbranch_scc1 LAST1
    s_waitcnt lgkmcnt(9)
    v_readfirstlane_b32 s66, v252
    s_add_u32 s53, s53, 1
    v_mov_b32 v252, s53
    s_cmp_le_u32 s53, s66
    ds_write2_b32 v251, v252, v252 offset0:0 offset1:8
    s_setprio 1
    s_cbranch_scc1 PRIO_14
    s_setprio 0
PRIO_14:
    s_cmp_eq_u32 s52, 4
    s_cbranch_scc1 ITEM_1_4
    s_cmp_eq_u32 s52, 5
    s_cbranch_scc1 ITEM_1_5
    s_cmp_eq_u32 s52, 3
    s_cbranch_scc1 ITEM_1_3
    s_cmp_eq_u32 s52, 6
    s_cbranch_scc1 ITEM_1_6
    s_cmp_eq_u32 s52, 8
    s_cbranch_scc1 ITEM_1_8
    s_branch ITEM_1_2
WL_6_0:
    s_add_u32 s66, s51, 0
    buffer_load_dwordx4 v[96:99], v246, s[16:19], s66 offen offset:2048 sc1
    buffer_load_dwordx4 v[100:103], v246, s[16:19], s66 offen offset:3072 sc1
    s_branch WR_6_0
WL_6_1:
    s_add_u32 s66, s51, 4096
    buffer_load_dwordx4 v[104:107], v246, s[16:19], s66 offen offset:2048 sc1
    buffer_load_dwordx4 v[108:111], v246, s[16:19], s66 offen offset:3072 sc1
    s_branch WR_6_1
WL_6_2:
    s_add_u32 s66, s51, 8192
    buffer_load_dwordx4 v[128:131], v246, s[16:19], s66 offen offset:2048 sc1
    buffer_load_dwordx4 v[132:135], v246, s[16:19], s66 offen offset:3072 sc1
    s_branch WR_6_2
WL_6_3:
    s_add_u32 s66, s51, 12288
    buffer_load_dwordx4 v[136:139], v246, s[16:19], s66 offen offset:2048 sc1
    buffer_load_dwordx4 v[140:143], v246, s[16:19], s66 offen offset:3072 sc1
    s_branch WR_6_3
.p2align 6
ITEM_1_8:
    s_mov_b64 exec, s[54:55]
    ds_read_u16_d16_hi v243, v250 offset:128
    s_mov_b64 exec, -1
    ds_read_b64_tr_b16 v[72:73], v249 offset:512
    ds_read_b64_tr_b16 v[76:77], v249 offset:576
    ds_read_b64_tr_b16 v[74:75], v249 offset:768
    ds_read_b64_tr_b16 v[78:79], v249 offset:832
    ds_read_b64_tr_b16 v[80:81], v249 offset:1024
    ds_read_b64_tr_b16 v[84:85], v249 offset:1088
    ds_read_b64_tr_b16 v[82:83], v249 offset:1280
    ds_read_b64_tr_b16 v[86:87], v249 offset:1344
    ds_read_b64_tr_b16 v[88:89], v249 offset:1536
    ds_read_b64_tr_b16 v[92:93], v249 offset:1600
    ds_read_b64_tr_b16 v[90:91], v249 offset:1792
    ds_read_b64_tr_b16 v[94:95], v249 offset:1856
    s_waitcnt lgkmcnt(13)
    v_mul_f32_dpp v196, v242, v64 row_newbcast:0 row_mask:0xf bank_mask:0xf
    v_mul_f32_dpp v197, v242, v65 row_newbcast:1 row_mask:0xf bank_mask:0xf
    v_mul_f32_dpp v198, v242, v64 row_newbcast:8 row_mask:0xf bank_mask:0xf
    v_mul_f32_dpp v199, v242, v65 row_newbcast:9 row_mask:0xf bank_mask:0xf
    v_mul_f32_dpp v200, v242, v68 row_newbcast:2 row_mask:0xf bank_mask:0xf
    v_mul_f32_dpp v201, v242, v69 row_newbcast:3 row_mask:0xf bank_mask:0xf
    v_mul_f32_dpp v202, v242, v68 row_newbcast:10 row_mask:0xf bank_mask:0xf
    v_mul_f32_dpp v203, v242, v69 row_newbcast:11 row_mask:0xf bank_mask:0xf
    v_cvt_pk_bf16_f32 v64, v196, v197
    v_cvt_pk_bf16_f32 v68, v198, v199
    v_cvt_pk_bf16_f32 v65, v200, v201
    v_cvt_pk_bf16_f32 v69, v202, v203
    v_mul_f32_dpp v196, v242, v66 row_newbcast:4 row_mask:0xf bank_mask:0xf
    v_mul_f32_dpp v197, v242, v67 row_newbcast:5 row_mask:0xf bank_mask:0xf
    v_mul_f32_dpp v198, v242, v66 row_newbcast:12 row_mask:0xf bank_mask:0xf
    v_mul_f32_dpp v199, v242, v67 row_newbcast:13 row_mask:0xf bank_mask:0xf
    v_mul_f32_dpp v200, v242, v70 row_newbcast:6 row_mask:0xf bank_mask:0xf
    v_mul_f32_dpp v201, v242, v71 row_newbcast:7 row_mask:0xf bank_mask:0xf
    v_mul_f32_dpp v202, v242, v70 row_newbcast:14 row_mask:0xf bank_mask:0xf
    v_mul_f32_dpp v203, v242, v71 row_newbcast:15 row_mask:0xf bank_mask:0xf
    v_cvt_pk_bf16_f32 v66, v196, v197
    v_cvt_pk_bf16_f32 v70, v198, v199
    v_cvt_pk_bf16_f32 v67, v200, v201
    v_cvt_pk_bf16_f32 v71, v202, v203
    s_mov_b64 exec, s[54:55]
    ds_read_u16_d16_hi v242, v250 offset:256
    s_mov_b64 exec, -1
    s_waitcnt vmcnt(4) lgkmcnt(9)
    v_mfma_f32_32x32x16_bf16 v[0:15], v[64:67], v[176:179], 0
    v_mul_f32_dpp v196, v243, v72 row_newbcast:0 row_mask:0xf bank_mask:0xf
    v_mul_f32_dpp v197, v243, v73 row_newbcast:1 row_mask:0xf bank_mask:0xf
    v_mul_f32_dpp v198, v243, v72 row_newbcast:8 row_mask:0xf bank_mask:0xf
    v_mul_f32_dpp v199, v243, v73 row_newbcast:9 row_mask:0xf bank_mask:0xf
    v_mul_f32_dpp v200, v243, v76 row_newbcast:2 row_mask:0xf bank_mask:0xf
    v_mul_f32_dpp v201, v243, v77 row_newbcast:3 row_mask:0xf bank_mask:0xf
    v_mul_f32_dpp v202, v243, v76 row_newbcast:10 row_mask:0xf bank_mask:0xf
    v_mul_f32_dpp v203, v243, v77 row_newbcast:11 row_mask:0xf bank_mask:0xf
    v_cvt_pk_bf16_f32 v72, v196, v197
    v_cvt_pk_bf16_f32 v76, v198, v199
    v_cvt_pk_bf16_f32 v73, v200, v201
    v_cvt_pk_bf16_f32 v77, v202, v203
    s_add_u32 m0, s21, 0
    v_mfma_f32_32x32x16_bf16 v[16:31], v[68:71], v[176:179], 0
    buffer_load_dwordx4 v234, s[4:7], s35 offen  lds
    buffer_load_dwordx4 v235, s[8:11], s35 offen offset:1024  lds
    ds_read_b64_tr_b16 v[176:177], v244 offset:2048
    ds_read_b64_tr_b16 v[178:179], v244 offset:3072
    ds_read_b64_tr_b16 v[184:185], v245 offset:2048
    ds_read_b64_tr_b16 v[186:187], v245 offset:3072
    v_mul_f32_dpp v196, v243, v74 row_newbcast:4 row_mask:0xf bank_mask:0xf
    v_mul_f32_dpp v197, v243, v75 row_newbcast:5 row_mask:0xf bank_mask:0xf
    v_mul_f32_dpp v198, v243, v74 row_newbcast:12 row_mask:0xf bank_mask:0xf
    v_mul_f32_dpp v199, v243, v75 row_newbcast:13 row_mask:0xf bank_mask:0xf
    v_mul_f32_dpp v200, v243, v78 row_newbcast:6 row_mask:0xf bank_mask:0xf
    v_mul_f32_dpp v201, v243, v79 row_newbcast:7 row_mask:0xf bank_mask:0xf
    v_mul_f32_dpp v202, v243, v78 row_newbcast:14 row_mask:0xf bank_mask:0xf
    v_mul_f32_dpp v203, v243, v79 row_newbcast:15 row_mask:0xf bank_mask:0xf
    v_cvt_pk_bf16_f32 v74, v196, v197
    v_cvt_pk_bf16_f32 v78, v198, v199
    v_cvt_pk_bf16_f32 v75, v200, v201
    v_cvt_pk_bf16_f32 v79, v202, v203
    s_mov_b64 exec, s[54:55]
    ds_read_u16_d16_hi v243, v250 offset:384
    s_mov_b64 exec, -1
    s_waitcnt vmcnt(4) lgkmcnt(1)
    v_mfma_f32_32x32x16_bf16 v[0:15], v[72:75], v[176:179], v[0:15]
    v_mul_f32_dpp v196, v242, v80 row_newbcast:0 row_mask:0xf bank_mask:0xf
    v_mul_f32_dpp v197, v242, v81 row_newbcast:1 row_mask:0xf bank_mask:0xf
    v_mul_f32_dpp v198, v242, v80 row_newbcast:8 row_mask:0xf bank_mask:0xf
    v_mul_f32_dpp v199, v242, v81 row_newbcast:9 row_mask:0xf bank_mask:0xf
    v_mul_f32_dpp v200, v242, v84 row_newbcast:2 row_mask:0xf bank_mask:0xf
    v_mul_f32_dpp v201, v242, v85 row_newbcast:3 row_mask:0xf bank_mask:0xf
    v_mul_f32_dpp v202, v242, v84 row_newbcast:10 row_mask:0xf bank_mask:0xf
    v_mul_f32_dpp v203, v242, v85 row_newbcast:11 row_mask:0xf bank_mask:0xf
    v_cvt_pk_bf16_f32 v80, v196, v197
    v_cvt_pk_bf16_f32 v84, v198, v199
    v_cvt_pk_bf16_f32 v81, v200, v201
    v_cvt_pk_bf16_f32 v85, v202, v203
    s_add_u32 m0, s21, 2048
    v_mfma_f32_32x32x16_bf16 v[16:31], v[76:79], v[176:179], v[16:31]
    buffer_load_dwordx4 v236, s[4:7], s35 offen  lds
    buffer_load_dwordx4 v237, s[8:11], s35 offen offset:1024  lds
    ds_read_b64_tr_b16 v[176:177], v244 offset:4096
    ds_read_b64_tr_b16 v[178:179], v244 offset:5120
    ds_read_b64_tr_b16 v[188:189], v245 offset:4096
    ds_read_b64_tr_b16 v[190:191], v245 offset:5120
    v_mul_f32_dpp v196, v242, v82 row_newbcast:4 row_mask:0xf bank_mask:0xf
    v_mul_f32_dpp v197, v242, v83 row_newbcast:5 row_mask:0xf bank_mask:0xf
    v_mul_f32_dpp v198, v242, v82 row_newbcast:12 row_mask:0xf bank_mask:0xf
    v_mul_f32_dpp v199, v242, v83 row_newbcast:13 row_mask:0xf bank_mask:0xf
    v_mul_f32_dpp v200, v242, v86 row_newbcast:6 row_mask:0xf bank_mask:0xf
    v_mul_f32_dpp v201, v242, v87 row_newbcast:7 row_mask:0xf bank_mask:0xf
    v_mul_f32_dpp v202, v242, v86 row_newbcast:14 row_mask:0xf bank_mask:0xf
    v_mul_f32_dpp v203, v242, v87 row_newbcast:15 row_mask:0xf bank_mask:0xf
    v_cvt_pk_bf16_f32 v82, v196, v197
    v_cvt_pk_bf16_f32 v86, v198, v199
    v_cvt_pk_bf16_f32 v83, v200, v201
    v_cvt_pk_bf16_f32 v87, v202, v203
    s_nop 0
    s_waitcnt vmcnt(4) lgkmcnt(0)
    v_mfma_f32_32x32x16_bf16 v[0:15], v[80:83], v[176:179], v[0:15]
    v_mul_f32_dpp v196, v243, v88 row_newbcast:0 row_mask:0xf bank_mask:0xf
    v_mul_f32_dpp v197, v243, v89 row_newbcast:1 row_mask:0xf bank_mask:0xf
    v_mul_f32_dpp v198, v243, v88 row_newbcast:8 row_mask:0xf bank_mask:0xf
    v_mul_f32_dpp v199, v243, v89 row_newbcast:9 row_mask:0xf bank_mask:0xf
    v_mul_f32_dpp v200, v243, v92 row_newbcast:2 row_mask:0xf bank_mask:0xf
    v_mul_f32_dpp v201, v243, v93 row_newbcast:3 row_mask:0xf bank_mask:0xf
    v_mul_f32_dpp v202, v243, v92 row_newbcast:10 row_mask:0xf bank_mask:0xf
    v_mul_f32_dpp v203, v243, v93 row_newbcast:11 row_mask:0xf bank_mask:0xf
    v_cvt_pk_bf16_f32 v88, v196, v197
    v_cvt_pk_bf16_f32 v92, v198, v199
    v_cvt_pk_bf16_f32 v89, v200, v201
    v_cvt_pk_bf16_f32 v93, v202, v203
    s_add_u32 m0, s21, 4096
    v_mfma_f32_32x32x16_bf16 v[16:31], v[84:87], v[176:179], v[16:31]
    buffer_load_dwordx4 v238, s[4:7], s35 offen  lds
    buffer_load_dwordx4 v239, s[8:11], s35 offen offset:1024  lds
    ds_read_b64_tr_b16 v[176:177], v244 offset:6144
    ds_read_b64_tr_b16 v[178:179], v244 offset:7168
    ds_read_b64_tr_b16 v[192:193], v245 offset:6144
    ds_read_b64_tr_b16 v[194:195], v245 offset:7168
    v_mul_f32_dpp v196, v243, v90 row_newbcast:4 row_mask:0xf bank_mask:0xf
    v_mul_f32_dpp v197, v243, v91 row_newbcast:5 row_mask:0xf bank_mask:0xf
    v_mul_f32_dpp v198, v243, v90 row_newbcast:12 row_mask:0xf bank_mask:0xf
    v_mul_f32_dpp v199, v243, v91 row_newbcast:13 row_mask:0xf bank_mask:0xf
    v_mul_f32_dpp v200, v243, v94 row_newbcast:6 row_mask:0xf bank_mask:0xf
    v_mul_f32_dpp v201, v243, v95 row_newbcast:7 row_mask:0xf bank_mask:0xf
    v_mul_f32_dpp v202, v243, v94 row_newbcast:14 row_mask:0xf bank_mask:0xf
    v_mul_f32_dpp v203, v243, v95 row_newbcast:15 row_mask:0xf bank_mask:0xf
    v_cvt_pk_bf16_f32 v90, v196, v197
    v_cvt_pk_bf16_f32 v94, v198, v199
    v_cvt_pk_bf16_f32 v91, v200, v201
    v_cvt_pk_bf16_f32 v95, v202, v203
    s_nop 0
    s_waitcnt lgkmcnt(0)
    v_mfma_f32_32x32x16_bf16 v[0:15], v[88:91], v[176:179], v[0:15]
    s_add_u32 m0, s21, 6144
    v_mfma_f32_32x32x16_bf16 v[16:31], v[92:95], v[176:179], v[16:31]
    buffer_load_dwordx4 v240, s[4:7], s35 offen  lds
    buffer_load_dwordx4 v241, s[8:11], s35 offen offset:1024  lds
    s_mov_b32 m0, s50
    s_nop 0
    s_movrels_b32 s71, s23
    s_movrels_b32 s33, s28
    v_add_u32 v253, s33, v248
    s_bfe_u32 s46, s71, 0x30012
    s_mov_b32 m0, s46
    s_and_b32 s66, s71, 0x3ffff
    s_movrels_b32 s68, s57
    s_movrels_b32 s69, s61
    s_sub_u32 s48, s66, s47
    s_mov_b32 s47, s66
    s_lshr_b32 s52, s71, 28
    s_lshl_b32 s67, s46, 9
    s_add_u32 s66, s66, s67
    s_sub_u32 s49, s66, s42
    s_mov_b32 s42, s66
    s_bfe_u32 s66, s68, 655360
    s_add_u32 s43, s42, s66
    s_bfe_u32 s39, s69, 655360
    s_bfe_u32 s66, s68, 655370
    s_add_u32 s44, s42, s66
    s_bfe_u32 s40, s69, 655370
    s_bfe_u32 s66, s68, 655380
    s_add_u32 s45, s42, s66
    s_bfe_u32 s41, s69, 655380
    v_mfma_f32_32x32x16_bf16 v[32:47], v[64:67], v[180:183], 0
    v_mul_f32 v196, v0, v96
    v_fmac_f32 v196, v1, v97
    v_fmac_f32 v196, v2, v98
    v_fmac_f32 v196, v3, v99
    v_fmac_f32 v196, v4, v100
    v_mfma_f32_32x32x16_bf16 v[48:63], v[68:71], v[180:183], 0
    v_fmac_f32 v196, v5, v101
    v_fmac_f32 v196, v6, v102
    v_fmac_f32 v196, v7, v103
    v_mul_f32 v198, v8, v128
    v_fmac_f32 v198, v9, v129
    v_mfma_f32_32x32x16_bf16 v[32:47], v[72:75], v[184:187], v[32:47]
    v_fmac_f32 v198, v10, v130
    v_fmac_f32 v198, v11, v131
    v_fmac_f32 v198, v12, v132
    v_fmac_f32 v198, v13, v133
    v_mfma_f32_32x32x16_bf16 v[48:63], v[76:79], v[184:187], v[48:63]
    v_fmac_f32 v198, v14, v134
    v_fmac_f32 v198, v15, v135
    v_mul_f32 v200, v16, v128
    v_fmac_f32 v200, v17, v129
    v_permlane32_swap_b32 v196, v198
    v_mfma_f32_32x32x16_bf16 v[32:47], v[80:83], v[188:191], v[32:47]
    v_fmac_f32 v200, v18, v130
    v_fmac_f32 v200, v19, v131
    v_fmac_f32 v200, v20, v132
    v_fmac_f32 v200, v21, v133
    v_fmac_f32 v200, v22, v134
    v_mfma_f32_32x32x16_bf16 v[48:63], v[84:87], v[188:191], v[48:63]
    s_waitcnt vmcnt(6)
    ds_read_b64_tr_b16 v[176:177], v244 offset:0
    ds_read_b64_tr_b16 v[178:179], v244 offset:1024
    ds_read_b64_tr_b16 v[180:181], v245 offset:0
    ds_read_b64_tr_b16 v[182:183], v245 offset:1024
    v_fmac_f32 v200, v23, v135
    v_add_f32 v198, v196, v198
    v_mul_f32_e64 v202, v24, -v128
    v_fma_f32 v202, v25, -v129, v202
    v_mfma_f32_32x32x16_bf16 v[32:47], v[88:91], v[192:195], v[32:47]
    v_fma_f32 v202, v26, -v130, v202
    v_fma_f32 v202, v27, -v131, v202
    v_fma_f32 v202, v28, -v132, v202
    v_fma_f32 v202, v29, -v133, v202
    v_fma_f32 v202, v30, -v134, v202
    v_mfma_f32_32x32x16_bf16 v[48:63], v[92:95], v[192:195], v[48:63]
    v_fma_f32 v202, v31, -v135, v202
    s_nop 1
    v_permlane32_swap_b32 v200, v202
    v_add_f32 v202, v200, v202
    s_waitcnt vmcnt(4) lgkmcnt(0)
    v_mfma_f32_32x32x16_bf16 v[0:15], v[64:67], v[176:179], 0
    v_mul_f32 v197, v32, v104
    v_fmac_f32 v197, v33, v105
    v_fmac_f32 v197, v34, v106
    v_fmac_f32 v197, v35, v107
    v_fmac_f32 v197, v36, v108
    s_add_u32 m0, s21, 0
    v_mfma_f32_32x32x16_bf16 v[16:31], v[68:71], v[176:179], 0
    buffer_load_dwordx4 v234, s[4:7], s36 offen  lds
    buffer_load_dwordx4 v235, s[8:11], s36 offen offset:1024  lds
    ds_read_b64_tr_b16 v[176:177], v244 offset:2048
    ds_read_b64_tr_b16 v[178:179], v244 offset:3072
    ds_read_b64_tr_b16 v[184:185], v245 offset:2048
    ds_read_b64_tr_b16 v[186:187], v245 offset:3072
    v_fmac_f32 v197, v37, v109
    v_fmac_f32 v197, v38, v110
    v_fmac_f32 v197, v39, v111
    v_mul_f32 v199, v40, v136
    v_fmac_f32 v199, v41, v137
    s_waitcnt vmcnt(4) lgkmcnt(0)
    v_mfma_f32_32x32x16_bf16 v[0:15], v[72:75], v[176:179], v[0:15]
    v_fmac_f32 v199, v42, v138
    v_fmac_f32 v199, v43, v139
    v_fmac_f32 v199, v44, v140
    v_fmac_f32 v199, v45, v141
    v_fmac_f32 v199, v46, v142
    s_add_u32 m0, s21, 2048
    v_mfma_f32_32x32x16_bf16 v[16:31], v[76:79], v[176:179], v[16:31]
    buffer_load_dwordx4 v236, s[4:7], s36 offen  lds
    buffer_load_dwordx4 v237, s[8:11], s36 offen offset:1024  lds
    ds_read_b64_tr_b16 v[176:177], v244 offset:4096
    ds_read_b64_tr_b16 v[178:179], v244 offset:5120
    ds_read_b64_tr_b16 v[188:189], v245 offset:4096
    ds_read_b64_tr_b16 v[190:191], v245 offset:5120
    v_fmac_f32 v199, v47, v143
    v_mul_f32 v201, v48, v136
    v_fmac_f32 v201, v49, v137
    v_permlane32_swap_b32 v197, v199
    v_fmac_f32 v201, v50, v138
    s_waitcnt vmcnt(4) lgkmcnt(0)
    v_mfma_f32_32x32x16_bf16 v[0:15], v[80:83], v[176:179], v[0:15]
    v_fmac_f32 v201, v51, v139
    v_fmac_f32 v201, v52, v140
    v_fmac_f32 v201, v53, v141
    v_fmac_f32 v201, v54, v142
    v_fmac_f32 v201, v55, v143
    s_add_u32 m0, s21, 4096
    v_mfma_f32_32x32x16_bf16 v[16:31], v[84:87], v[176:179], v[16:31]
    buffer_load_dwordx4 v238, s[4:7], s36 offen  lds
    buffer_load_dwordx4 v239, s[8:11], s36 offen offset:1024  lds
    ds_read_b64_tr_b16 v[176:177], v244 offset:6144
    ds_read_b64_tr_b16 v[178:179], v244 offset:7168
    ds_read_b64_tr_b16 v[192:193], v245 offset:6144
    ds_read_b64_tr_b16 v[194:195], v245 offset:7168
    v_add_f32 v199, v197, v199
    v_mul_f32_e64 v203, v56, -v136
    v_fma_f32 v203, v57, -v137, v203
    v_fma_f32 v203, v58, -v138, v203
    v_fma_f32 v203, v59, -v139, v203
    s_waitcnt lgkmcnt(0)
    v_mfma_f32_32x32x16_bf16 v[0:15], v[88:91], v[176:179], v[0:15]
    v_fma_f32 v203, v60, -v140, v203
    v_fma_f32 v203, v61, -v141, v203
    v_fma_f32 v203, v62, -v142, v203
    v_fma_f32 v203, v63, -v143, v203
    s_nop 1
    s_add_u32 m0, s21, 6144
    v_mfma_f32_32x32x16_bf16 v[16:31], v[92:95], v[176:179], v[16:31]
    buffer_load_dwordx4 v240, s[4:7], s36 offen  lds
    buffer_load_dwordx4 v241, s[8:11], s36 offen offset:1024  lds
    v_permlane32_swap_b32 v201, v203
    v_add_f32 v203, v201, v203
    v_cvt_pk_bf16_f32 v198, v198, v199
    v_cvt_pk_bf16_f32 v202, v202, v203
    ds_write2st64_b32 v253, v198, v202 offset0:0 offset1:1
    v_mfma_f32_32x32x16_bf16 v[32:47], v[64:67], v[180:183], 0
    v_mul_f32 v196, v0, v144
    v_fmac_f32 v196, v1, v145
    v_fmac_f32 v196, v2, v146
    v_fmac_f32 v196, v3, v147
    v_mfma_f32_32x32x16_bf16 v[48:63], v[68:71], v[180:183], 0
    v_fmac_f32 v196, v4, v148
    v_fmac_f32 v196, v5, v149
    v_fmac_f32 v196, v6, v150
    v_fmac_f32 v196, v7, v151
    v_mfma_f32_32x32x16_bf16 v[32:47], v[72:75], v[184:187], v[32:47]
    v_mul_f32 v198, v8, v112
    v_fmac_f32 v198, v9, v113
    v_fmac_f32 v198, v10, v114
    v_fmac_f32 v198, v11, v115
    v_mfma_f32_32x32x16_bf16 v[48:63], v[76:79], v[184:187], v[48:63]
    v_fmac_f32 v198, v12, v116
    v_fmac_f32 v198, v13, v117
    v_fmac_f32 v198, v14, v118
    v_fmac_f32 v198, v15, v119
    v_mfma_f32_32x32x16_bf16 v[32:47], v[80:83], v[188:191], v[32:47]
    v_mul_f32_e64 v200, v16, -v160
    v_fma_f32 v200, v17, -v161, v200
    v_fma_f32 v200, v18, -v162, v200
    v_fma_f32 v200, v19, -v163, v200
    v_mfma_f32_32x32x16_bf16 v[48:63], v[84:87], v[188:191], v[48:63]
    s_waitcnt vmcnt(6)
    ds_read_b64_tr_b16 v[176:177], v244 offset:0
    ds_read_b64_tr_b16 v[178:179], v244 offset:1024
    ds_read_b64_tr_b16 v[180:181], v245 offset:0
    ds_read_b64_tr_b16 v[182:183], v245 offset:1024
    v_fma_f32 v200, v20, -v164, v200
    v_fma_f32 v200, v21, -v165, v200
    v_fma_f32 v200, v22, -v166, v200
    v_fma_f32 v200, v23, -v167, v200
    v_mfma_f32_32x32x16_bf16 v[32:47], v[88:91], v[192:195], v[32:47]
    v_mul_f32_e64 v202, v24, -v160
    v_fma_f32 v202, v25, -v161, v202
    v_fma_f32 v202, v26, -v162, v202
    v_fma_f32 v202, v27, -v163, v202
    v_mfma_f32_32x32x16_bf16 v[48:63], v[92:95], v[192:195], v[48:63]
    v_fma_f32 v202, v28, -v164, v202
    v_fma_f32 v202, v29, -v165, v202
    v_fma_f32 v202, v30, -v166, v202
    v_fma_f32 v202, v31, -v167, v202
    s_waitcnt vmcnt(4) lgkmcnt(0)
    v_mfma_f32_32x32x16_bf16 v[0:15], v[64:67], v[176:179], 0
    s_nop 0
    v_mul_f32 v197, v32, v152
    v_fmac_f32 v197, v33, v153
    v_fmac_f32 v197, v34, v154
    v_fmac_f32 v197, v35, v155
    s_add_u32 m0, s21, 0
    v_mfma_f32_32x32x16_bf16 v[16:31], v[68:71], v[176:179], 0
    buffer_load_dwordx4 v234, s[4:7], s37 offen  lds
    buffer_load_dwordx4 v235, s[8:11], s37 offen offset:1024  lds
    ds_read_b64_tr_b16 v[176:177], v244 offset:2048
    ds_read_b64_tr_b16 v[178:179], v244 offset:3072
    ds_read_b64_tr_b16 v[184:185], v245 offset:2048
    ds_read_b64_tr_b16 v[186:187], v245 offset:3072
    v_add_u32 v252, s42, v247
    ds_read_u16 v234, v252
    ds_read_u16 v235, v252 offset:64
    v_fmac_f32 v197, v36, v156
    v_fmac_f32 v197, v37, v157
    v_fmac_f32 v197, v38, v158
    v_fmac_f32 v197, v39, v159
    s_waitcnt vmcnt(4) lgkmcnt(2)
    v_mfma_f32_32x32x16_bf16 v[0:15], v[72:75], v[176:179], v[0:15]
    v_mul_f32 v199, v40, v120
    v_fmac_f32 v199, v41, v121
    v_fmac_f32 v199, v42, v122
    v_fmac_f32 v199, v43, v123
    s_add_u32 m0, s21, 2048
    v_mfma_f32_32x32x16_bf16 v[16:31], v[76:79], v[176:179], v[16:31]
    buffer_load_dwordx4 v236, s[4:7], s37 offen  lds
    buffer_load_dwordx4 v237, s[8:11], s37 offen offset:1024  lds
    ds_read_b64_tr_b16 v[176:177], v244 offset:4096
    ds_read_b64_tr_b16 v[178:179], v244 offset:5120
    ds_read_b64_tr_b16 v[188:189], v245 offset:4096
    ds_read_b64_tr_b16 v[190:191], v245 offset:5120
    v_add_u32 v252, s43, v247
    ds_read_u16 v236, v252
    ds_read_u16 v237, v252 offset:64
    v_fmac_f32 v199, v44, v124
    v_fmac_f32 v199, v45, v125
    v_fmac_f32 v199, v46, v126
    v_fmac_f32 v199, v47, v127
    s_waitcnt vmcnt(4) lgkmcnt(2)
    v_mfma_f32_32x32x16_bf16 v[0:15], v[80:83], v[176:179], v[0:15]
    v_mul_f32_e64 v201, v48, -v168
    v_fma_f32 v201, v49, -v169, v201
    v_fma_f32 v201, v50, -v170, v201
    v_fma_f32 v201, v51, -v171, v201
    s_add_u32 m0, s21, 4096
    v_mfma_f32_32x32x16_bf16 v[16:31], v[84:87], v[176:179], v[16:31]
    buffer_load_dwordx4 v238, s[4:7], s37 offen  lds
    buffer_load_dwordx4 v239, s[8:11], s37 offen offset:1024  lds
    ds_read_b64_tr_b16 v[176:177], v244 offset:6144
    ds_read_b64_tr_b16 v[178:179], v244 offset:7168
    ds_read_b64_tr_b16 v[192:193], v245 offset:6144
    ds_read_b64_tr_b16 v[194:195], v245 offset:7168
    v_add_u32 v252, s44, v247
    ds_read_u16 v238, v252
    ds_read_u16 v239, v252 offset:64
    v_fma_f32 v201, v52, -v172, v201
    v_fma_f32 v201, v53, -v173, v201
    v_fma_f32 v201, v54, -v174, v201
    v_fma_f32 v201, v55, -v175, v201
    s_waitcnt lgkmcnt(2)
    v_mfma_f32_32x32x16_bf16 v[0:15], v[88:91], v[176:179], v[0:15]
    v_mul_f32_e64 v203, v56, -v168
    v_fma_f32 v203, v57, -v169, v203
    v_fma_f32 v203, v58, -v170, v203
    v_fma_f32 v203, v59, -v171, v203
    s_add_u32 m0, s21, 6144
    v_mfma_f32_32x32x16_bf16 v[16:31], v[92:95], v[176:179], v[16:31]
    buffer_load_dwordx4 v240, s[4:7], s37 offen  lds
    buffer_load_dwordx4 v241, s[8:11], s37 offen offset:1024  lds
    v_add_u32 v252, s45, v247
    ds_read_u16 v240, v252
    ds_read_u16 v241, v252 offset:64
    v_fma_f32 v203, v60, -v172, v203
    v_fma_f32 v203, v61, -v173, v203
    v_fma_f32 v203, v62, -v174, v203
    v_fma_f32 v203, v63, -v175, v203
    v_mfma_f32_32x32x16_bf16 v[32:47], v[64:67], v[180:183], 0
    v_mul_f32 v254, v0, v144
    v_fmac_f32 v254, v1, v145
    v_fmac_f32 v254, v2, v146
    v_mfma_f32_32x32x16_bf16 v[48:63], v[68:71], v[180:183], 0
    ds_swizzle_b32 v68, v68 offset:0x401F
    ds_swizzle_b32 v69, v69 offset:0x401F
    ds_swizzle_b32 v70, v70 offset:0x401F
    ds_swizzle_b32 v71, v71 offset:0x401F
    v_fmac_f32 v254, v3, v147
    v_fmac_f32 v254, v4, v148
    v_mfma_f32_32x32x16_bf16 v[32:47], v[72:75], v[184:187], v[32:47]
    v_fmac_f32 v254, v5, v149
    v_fmac_f32 v254, v6, v150
    v_mfma_f32_32x32x16_bf16 v[48:63], v[76:79], v[184:187], v[48:63]
    ds_swizzle_b32 v76, v76 offset:0x401F
    ds_swizzle_b32 v77, v77 offset:0x401F
    ds_swizzle_b32 v78, v78 offset:0x401F
    ds_swizzle_b32 v79, v79 offset:0x401F
    v_fmac_f32 v254, v7, v151
    v_fmac_f32 v200, v8, v160
    v_mfma_f32_32x32x16_bf16 v[32:47], v[80:83], v[188:191], v[32:47]
    v_fmac_f32 v200, v9, v161
    v_permlane32_swap_b32 v196, v254
    v_fmac_f32 v200, v10, v162
    v_mfma_f32_32x32x16_bf16 v[48:63], v[84:87], v[188:191], v[48:63]
    ds_swizzle_b32 v84, v84 offset:0x401F
    ds_swizzle_b32 v85, v85 offset:0x401F
    ds_swizzle_b32 v86, v86 offset:0x401F
    ds_swizzle_b32 v87, v87 offset:0x401F
    s_waitcnt vmcnt(6)
    ds_read_b64_tr_b16 v[176:177], v244 offset:0
    ds_read_b64_tr_b16 v[178:179], v244 offset:1024
    ds_read_b64_tr_b16 v[180:181], v245 offset:0
    ds_read_b64_tr_b16 v[182:183], v245 offset:1024
    v_fmac_f32 v200, v11, v163
    v_fmac_f32 v200, v12, v164
    v_mfma_f32_32x32x16_bf16 v[32:47], v[88:91], v[192:195], v[32:47]
    v_fmac_f32 v200, v13, v165
    v_fmac_f32 v200, v14, v166
    v_mfma_f32_32x32x16_bf16 v[48:63], v[92:95], v[192:195], v[48:63]
    ds_swizzle_b32 v92, v92 offset:0x401F
    ds_swizzle_b32 v93, v93 offset:0x401F
    ds_swizzle_b32 v94, v94 offset:0x401F
    ds_swizzle_b32 v95, v95 offset:0x401F
    v_fmac_f32 v200, v15, v167
    v_add_f32 v254, v196, v254
    s_waitcnt lgkmcnt(8)
    s_mov_b64 exec, s[56:57]
    v_xor_b32 v68, 0x80008000, v68
    v_xor_b32 v69, 0x80008000, v69
    v_xor_b32 v70, 0x80008000, v70
    v_xor_b32 v71, 0x80008000, v71
    v_xor_b32 v76, 0x80008000, v76
    v_xor_b32 v77, 0x80008000, v77
    v_xor_b32 v78, 0x80008000, v78
    v_xor_b32 v79, 0x80008000, v79
    v_xor_b32 v84, 0x80008000, v84
    v_xor_b32 v85, 0x80008000, v85
    v_xor_b32 v86, 0x80008000, v86
    v_xor_b32 v87, 0x80008000, v87
    s_mov_b64 exec, -1
    s_waitcnt vmcnt(4) lgkmcnt(4)
    v_mfma_f32_32x32x16_bf16 v[0:15], v[64:67], v[176:179], 0
    v_mul_f32 v255, v32, v152
    v_fmac_f32 v255, v33, v153
    v_fmac_f32 v255, v34, v154
    s_add_u32 m0, s21, 0
    s_cmp_eq_u32 s50, 4
    v_mfma_f32_32x32x16_bf16 v[16:31], v[68:71], v[176:179], v[16:31]
    s_cbranch_scc1 WL_8_0
    v_lshl_add_u32 v234, v234, 10, v246
    v_lshl_add_u32 v235, v235, 10, v246
    buffer_load_dwordx4 v234, s[4:7], s38 offen  lds
    buffer_load_dwordx4 v235, s[8:11], s38 offen offset:1024  lds
WR_8_0:
    ds_read_b64_tr_b16 v[176:177], v244 offset:2048
    ds_read_b64_tr_b16 v[178:179], v244 offset:3072
    ds_read_b64_tr_b16 v[184:185], v245 offset:2048
    ds_read_b64_tr_b16 v[186:187], v245 offset:3072
    v_fmac_f32 v255, v35, v155
    v_fmac_f32 v255, v36, v156
    s_waitcnt vmcnt(4) lgkmcnt(0)
    v_mfma_f32_32x32x16_bf16 v[0:15], v[72:75], v[176:179], v[0:15]
    v_fmac_f32 v255, v37, v157
    v_fmac_f32 v255, v38, v158
    v_fmac_f32 v255, v39, v159
    s_add_u32 m0, s21, 2048
    s_cmp_eq_u32 s50, 4
    v_mfma_f32_32x32x16_bf16 v[16:31], v[76:79], v[176:179], v[16:31]
    s_cbranch_scc1 WL_8_1
    v_lshl_add_u32 v236, v236, 10, v246
    v_lshl_add_u32 v237, v237, 10, v246
    buffer_load_dwordx4 v236, s[4:7], s39 offen  lds
    buffer_load_dwordx4 v237, s[8:11], s39 offen offset:1024  lds
WR_8_1:
    ds_read_b64_tr_b16 v[176:177], v244 offset:4096
    ds_read_b64_tr_b16 v[178:179], v244 offset:5120
    ds_read_b64_tr_b16 v[188:189], v245 offset:4096
    ds_read_b64_tr_b16 v[190:191], v245 offset:5120
    v_fmac_f32 v201, v40, v168
    v_fmac_f32 v201, v41, v169
    s_waitcnt vmcnt(4) lgkmcnt(0)
    v_mfma_f32_32x32x16_bf16 v[0:15], v[80:83], v[176:179], v[0:15]
    v_permlane32_swap_b32 v197, v255
    v_fmac_f32 v201, v42, v170
    v_fmac_f32 v201, v43, v171
    s_add_u32 m0, s21, 4096
    s_cmp_eq_u32 s50, 4
    v_mfma_f32_32x32x16_bf16 v[16:31], v[84:87], v[176:179], v[16:31]
    s_cbranch_scc1 WL_8_2
    v_lshl_add_u32 v238, v238, 10, v246
    v_lshl_add_u32 v239, v239, 10, v246
    buffer_load_dwordx4 v238, s[4:7], s40 offen  lds
    buffer_load_dwordx4 v239, s[8:11], s40 offen offset:1024  lds
WR_8_2:
    ds_read_b64_tr_b16 v[176:177], v244 offset:6144
    ds_read_b64_tr_b16 v[178:179], v244 offset:7168
    ds_read_b64_tr_b16 v[192:193], v245 offset:6144
    ds_read_b64_tr_b16 v[194:195], v245 offset:7168
    v_fmac_f32 v201, v44, v172
    v_fmac_f32 v201, v45, v173
    s_waitcnt lgkmcnt(0)
    s_mov_b64 exec, s[56:57]
    v_xor_b32 v92, 0x80008000, v92
    v_xor_b32 v93, 0x80008000, v93
    v_xor_b32 v94, 0x80008000, v94
    v_xor_b32 v95, 0x80008000, v95
    s_mov_b64 exec, -1
    v_mfma_f32_32x32x16_bf16 v[0:15], v[88:91], v[176:179], v[0:15]
    v_fmac_f32 v201, v46, v174
    v_fmac_f32 v201, v47, v175
    v_add_f32 v255, v197, v255
    s_add_u32 m0, s21, 6144
    s_cmp_eq_u32 s50, 4
    v_mfma_f32_32x32x16_bf16 v[16:31], v[92:95], v[176:179], v[16:31]
    s_cbranch_scc1 WL_8_3
    v_lshl_add_u32 v240, v240, 10, v246
    v_lshl_add_u32 v241, v241, 10, v246
    buffer_load_dwordx4 v240, s[4:7], s41 offen  lds
    buffer_load_dwordx4 v241, s[8:11], s41 offen offset:1024  lds
WR_8_3:
    v_cvt_pk_bf16_f32 v254, v254, v255
    ds_write_b32 v253, v254 offset:512
    v_mfma_f32_32x32x16_bf16 v[32:47], v[64:67], v[180:183], 0
    v_mul_f32 v254, v0, v144
    v_fmac_f32 v254, v1, v145
    v_fmac_f32 v254, v2, v146
    v_fmac_f32 v254, v3, v147
    v_fmac_f32 v254, v4, v148
    v_mfma_f32_32x32x16_bf16 v[48:63], v[68:71], v[180:183], v[48:63]
    v_fmac_f32 v254, v5, v149
    v_fmac_f32 v254, v6, v150
    v_fmac_f32 v254, v7, v151
    v_fma_f32 v202, v8, -v160, v202
    v_fma_f32 v202, v9, -v161, v202
    v_mfma_f32_32x32x16_bf16 v[32:47], v[72:75], v[184:187], v[32:47]
    v_permlane32_swap_b32 v254, v200
    v_fma_f32 v202, v10, -v162, v202
    v_fma_f32 v202, v11, -v163, v202
    v_fma_f32 v202, v12, -v164, v202
    v_fma_f32 v202, v13, -v165, v202
    v_mfma_f32_32x32x16_bf16 v[48:63], v[76:79], v[184:187], v[48:63]
    v_fma_f32 v202, v14, -v166, v202
    v_fma_f32 v202, v15, -v167, v202
    v_add_f32 v200, v254, v200
    v_fmac_f32 v198, v16, v112
    v_permlane32_swap_b32 v202, v254
    v_mfma_f32_32x32x16_bf16 v[32:47], v[80:83], v[188:191], v[32:47]
    v_fmac_f32 v198, v17, v113
    v_fmac_f32 v198, v18, v114
    v_fmac_f32 v198, v19, v115
    v_fmac_f32 v198, v20, v116
    v_fmac_f32 v198, v21, v117
    v_mfma_f32_32x32x16_bf16 v[48:63], v[84:87], v[188:191], v[48:63]
    s_waitcnt vmcnt(6)
    ds_read_b64_tr_b16 v[176:177], v244 offset:0
    ds_read_b64_tr_b16 v[178:179], v244 offset:1024
    ds_read_b64_tr_b16 v[180:181], v245 offset:0
    ds_read_b64_tr_b16 v[182:183], v245 offset:1024
    v_fmac_f32 v198, v22, v118
    v_fmac_f32 v198, v23, v119
    v_add_f32 v254, v202, v254
    v_mul_f32 v196, v24, v160
    v_fmac_f32 v196, v25, v161
    v_mfma_f32_32x32x16_bf16 v[32:47], v[88:91], v[192:195], v[32:47]
    v_fmac_f32 v196, v26, v162
    v_fmac_f32 v196, v27, v163
    v_fmac_f32 v196, v28, v164
    v_fmac_f32 v196, v29, v165
    v_fmac_f32 v196, v30, v166
    v_mfma_f32_32x32x16_bf16 v[48:63], v[92:95], v[192:195], v[48:63]
    v_add_u32 v249, s48, v249
    v_add_u32 v250, s49, v250
    ds_read_b32 v252, v251 offset:16
    ds_read_b64_tr_b16 v[64:65], v249 offset:0
    ds_read_b64_tr_b16 v[68:69], v249 offset:64
    ds_read_b64_tr_b16 v[66:67], v249 offset:256
    ds_read_b64_tr_b16 v[70:71], v249 offset:320
    s_mov_b64 exec, s[54:55]
    ds_read_u16_d16_hi v242, v250 offset:0
    s_mov_b64 exec, -1
    v_fmac_f32 v196, v31, v167
    s_nop 1
    v_permlane32_swap_b32 v198, v196
    v_add_f32 v196, v198, v196
    s_cmp_eq_u32 s50, 4
    s_cbranch_scc1 LEPI_1
    v_mul_f32 v255, v32, v152
    v_fmac_f32 v255, v33, v153
    v_fmac_f32 v255, v34, v154
    v_fmac_f32 v255, v35, v155
    v_fmac_f32 v255, v36, v156
    v_fmac_f32 v255, v37, v157
    v_fmac_f32 v255, v38, v158
    v_fmac_f32 v255, v39, v159
    v_fma_f32 v203, v40, -v168, v203
    v_fma_f32 v203, v41, -v169, v203
    v_permlane32_swap_b32 v255, v201
    v_fma_f32 v203, v42, -v170, v203
    v_fma_f32 v203, v43, -v171, v203
    v_fma_f32 v203, v44, -v172, v203
    v_fma_f32 v203, v45, -v173, v203
    v_fma_f32 v203, v46, -v174, v203
    v_fma_f32 v203, v47, -v175, v203
    v_add_f32 v201, v255, v201
    v_fmac_f32 v199, v48, v120
    v_permlane32_swap_b32 v203, v255
    v_fmac_f32 v199, v49, v121
    v_fmac_f32 v199, v50, v122
    v_fmac_f32 v199, v51, v123
    v_fmac_f32 v199, v52, v124
    v_fmac_f32 v199, v53, v125
    v_fmac_f32 v199, v54, v126
    v_fmac_f32 v199, v55, v127
    v_add_f32 v255, v203, v255
    v_mul_f32 v197, v56, v168
    v_fmac_f32 v197, v57, v169
    v_fmac_f32 v197, v58, v170
    v_fmac_f32 v197, v59, v171
    v_fmac_f32 v197, v60, v172
    v_fmac_f32 v197, v61, v173
    v_fmac_f32 v197, v62, v174
    v_fmac_f32 v197, v63, v175
    s_nop 1
    v_permlane32_swap_b32 v199, v197
    v_add_f32 v197, v199, v197
    v_cvt_pk_bf16_f32 v200, v200, v201
    v_cvt_pk_bf16_f32 v254, v254, v255
    v_cvt_pk_bf16_f32 v196, v196, v197
    ds_write2st64_b32 v253, v200, v196 offset0:3 offset1:4
    s_mov_b64 exec, 0xffffffff
    ds_write_b32 v253, v254 offset:1280
    s_mov_b64 exec, -1
    s_add_u32 s50, s50, 1
    s_cmp_ge_u32 s50, 4
    s_cbranch_scc1 LAST1
    s_waitcnt lgkmcnt(7)
    v_readfirstlane_b32 s66, v252
    s_add_u32 s53, s53, 1
    v_mov_b32 v252, s53
    s_cmp_le_u32 s53, s66
    ds_write2_b32 v251, v252, v252 offset0:0 offset1:8
    s_setprio 1
    s_cbranch_scc1 PRIO_15
    s_setprio 0
PRIO_15:
    s_cmp_eq_u32 s52, 4
    s_cbranch_scc1 ITEM_1_4
    s_cmp_eq_u32 s52, 5
    s_cbranch_scc1 ITEM_1_5
    s_cmp_eq_u32 s52, 3
    s_cbranch_scc1 ITEM_1_3
    s_cmp_eq_u32 s52, 6
    s_cbranch_scc1 ITEM_1_6
    s_cmp_eq_u32 s52, 8
    s_cbranch_scc1 ITEM_1_8
    s_branch ITEM_1_2
WL_8_0:
    s_add_u32 s66, s51, 0
    buffer_load_dwordx4 v[96:99], v246, s[16:19], s66 offen offset:2048 sc1
    buffer_load_dwordx4 v[100:103], v246, s[16:19], s66 offen offset:3072 sc1
    s_branch WR_8_0
WL_8_1:
    s_add_u32 s66, s51, 4096
    buffer_load_dwordx4 v[104:107], v246, s[16:19], s66 offen offset:2048 sc1
    buffer_load_dwordx4 v[108:111], v246, s[16:19], s66 offen offset:3072 sc1
    s_branch WR_8_1
WL_8_2:
    s_add_u32 s66, s51, 8192
    buffer_load_dwordx4 v[128:131], v246, s[16:19], s66 offen offset:2048 sc1
    buffer_load_dwordx4 v[132:135], v246, s[16:19], s66 offen offset:3072 sc1
    s_branch WR_8_2
WL_8_3:
    s_add_u32 s66, s51, 12288
    buffer_load_dwordx4 v[136:139], v246, s[16:19], s66 offen offset:2048 sc1
    buffer_load_dwordx4 v[140:143], v246, s[16:19], s66 offen offset:3072 sc1
    s_branch WR_8_3
.p2align 6
ITEM_1_2:
    s_mov_b32 m0, s50
    s_nop 0
    s_movrels_b32 s71, s23
    s_movrels_b32 s33, s28
    v_add_u32 v253, s33, v248
    s_bfe_u32 s46, s71, 0x30012
    s_mov_b32 m0, s46
    s_and_b32 s66, s71, 0x3ffff
    s_movrels_b32 s68, s57
    s_movrels_b32 s69, s61
    s_sub_u32 s48, s66, s47
    s_mov_b32 s47, s66
    s_lshr_b32 s52, s71, 28
    s_lshl_b32 s67, s46, 9
    s_add_u32 s66, s66, s67
    s_sub_u32 s49, s66, s42
    s_mov_b32 s42, s66
    s_bfe_u32 s66, s68, 655360
    s_add_u32 s43, s42, s66
    s_bfe_u32 s39, s69, 655360
    s_bfe_u32 s66, s68, 655370
    s_add_u32 s44, s42, s66
    s_bfe_u32 s40, s69, 655370
    s_bfe_u32 s66, s68, 655380
    s_add_u32 s45, s42, s66
    s_bfe_u32 s41, s69, 655380
    v_add_u32 v252, s42, v247
    ds_read_u16 v234, v252
    ds_read_u16 v235, v252 offset:64
    v_add_u32 v252, s43, v247
    ds_read_u16 v236, v252
    ds_read_u16 v237, v252 offset:64
    v_add_u32 v252, s44, v247
    ds_read_u16 v238, v252
    ds_read_u16 v239, v252 offset:64
    v_add_u32 v252, s45, v247
    ds_read_u16 v240, v252
    ds_read_u16 v241, v252 offset:64
    s_waitcnt lgkmcnt(8)
    v_mul_f32_dpp v196, v242, v64 row_newbcast:0 row_mask:0xf bank_mask:0xf
    v_mul_f32_dpp v197, v242, v65 row_newbcast:1 row_mask:0xf bank_mask:0xf
    v_mul_f32_dpp v198, v242, v64 row_newbcast:8 row_mask:0xf bank_mask:0xf
    v_mul_f32_dpp v199, v242, v65 row_newbcast:9 row_mask:0xf bank_mask:0xf
    v_mul_f32_dpp v200, v242, v68 row_newbcast:2 row_mask:0xf bank_mask:0xf
    v_mul_f32_dpp v201, v242, v69 row_newbcast:3 row_mask:0xf bank_mask:0xf
    v_mul_f32_dpp v202, v242, v68 row_newbcast:10 row_mask:0xf bank_mask:0xf
    v_mul_f32_dpp v203, v242, v69 row_newbcast:11 row_mask:0xf bank_mask:0xf
    v_cvt_pk_bf16_f32 v64, v196, v197
    v_cvt_pk_bf16_f32 v68, v198, v199
    v_cvt_pk_bf16_f32 v65, v200, v201
    v_cvt_pk_bf16_f32 v69, v202, v203
    v_mul_f32_dpp v196, v242, v66 row_newbcast:4 row_mask:0xf bank_mask:0xf
    v_mul_f32_dpp v197, v242, v67 row_newbcast:5 row_mask:0xf bank_mask:0xf
    v_mul_f32_dpp v198, v242, v66 row_newbcast:12 row_mask:0xf bank_mask:0xf
    v_mul_f32_dpp v199, v242, v67 row_newbcast:13 row_mask:0xf bank_mask:0xf
    v_mul_f32_dpp v200, v242, v70 row_newbcast:6 row_mask:0xf bank_mask:0xf
    v_mul_f32_dpp v201, v242, v71 row_newbcast:7 row_mask:0xf bank_mask:0xf
    v_mul_f32_dpp v202, v242, v70 row_newbcast:14 row_mask:0xf bank_mask:0xf
    v_mul_f32_dpp v203, v242, v71 row_newbcast:15 row_mask:0xf bank_mask:0xf
    v_cvt_pk_bf16_f32 v66, v196, v197
    v_cvt_pk_bf16_f32 v70, v198, v199
    v_cvt_pk_bf16_f32 v67, v200, v201
    v_cvt_pk_bf16_f32 v71, v202, v203
    s_nop 0
    s_waitcnt lgkmcnt(6)
    v_mfma_f32_32x32x16_bf16 v[0:15], v[64:67], v[176:179], 0
    s_add_u32 m0, s21, 0
    s_cmp_eq_u32 s50, 4
    v_mfma_f32_32x32x16_bf16 v[16:31], v[68:71], v[176:179], 0
    s_cbranch_scc1 WL_2_0
    v_lshl_add_u32 v234, v234, 10, v246
    v_lshl_add_u32 v235, v235, 10, v246
    buffer_load_dwordx4 v234, s[4:7], s38 offen  lds
    buffer_load_dwordx4 v235, s[8:11], s38 offen offset:1024  lds
WR_2_0:
    v_mfma_f32_32x32x16_bf16 v[32:47], v[64:67], v[180:183], 0
    s_nop 2
    v_mul_f32 v196, v0, v96
    v_fmac_f32 v196, v1, v97
    v_fmac_f32 v196, v2, v98
    v_fmac_f32 v196, v3, v99
    v_fmac_f32 v196, v4, v100
    v_fmac_f32 v196, v5, v101
    v_fmac_f32 v196, v6, v102
    v_fmac_f32 v196, v7, v103
    v_mul_f32 v198, v8, v128
    v_fmac_f32 v198, v9, v129
    v_fmac_f32 v198, v10, v130
    v_fmac_f32 v198, v11, v131
    v_fmac_f32 v198, v12, v132
    v_fmac_f32 v198, v13, v133
    v_fmac_f32 v198, v14, v134
    v_fmac_f32 v198, v15, v135
    v_mul_f32 v200, v16, v128
    v_fmac_f32 v200, v17, v129
    v_permlane32_swap_b32 v196, v198
    v_mfma_f32_32x32x16_bf16 v[48:63], v[68:71], v[180:183], 0
    s_waitcnt vmcnt(6)
    ds_read_b64_tr_b16 v[176:177], v244 offset:2048
    ds_read_b64_tr_b16 v[178:179], v244 offset:3072
    ds_read_b64_tr_b16 v[180:181], v245 offset:2048
    ds_read_b64_tr_b16 v[182:183], v245 offset:3072
    v_fmac_f32 v200, v18, v130
    v_fmac_f32 v200, v19, v131
    v_fmac_f32 v200, v20, v132
    v_fmac_f32 v200, v21, v133
    v_fmac_f32 v200, v22, v134
    v_fmac_f32 v200, v23, v135
    v_add_f32 v198, v196, v198
    v_mul_f32_e64 v202, v24, -v128
    v_fma_f32 v202, v25, -v129, v202
    v_fma_f32 v202, v26, -v130, v202
    v_fma_f32 v202, v27, -v131, v202
    v_fma_f32 v202, v28, -v132, v202
    v_fma_f32 v202, v29, -v133, v202
    v_fma_f32 v202, v30, -v134, v202
    v_fma_f32 v202, v31, -v135, v202
    s_nop 1
    v_permlane32_swap_b32 v200, v202
    v_add_f32 v202, v200, v202
    s_waitcnt lgkmcnt(0)
    v_mfma_f32_32x32x16_bf16 v[0:15], v[64:67], v[176:179], 0
    v_mul_f32 v197, v32, v104
    v_fmac_f32 v197, v33, v105
    v_fmac_f32 v197, v34, v106
    v_fmac_f32 v197, v35, v107
    v_fmac_f32 v197, v36, v108
    v_fmac_f32 v197, v37, v109
    v_fmac_f32 v197, v38, v110
    v_fmac_f32 v197, v39, v111
    v_mul_f32 v199, v40, v136
    v_fmac_f32 v199, v41, v137
    v_fmac_f32 v199, v42, v138
    v_fmac_f32 v199, v43, v139
    v_fmac_f32 v199, v44, v140
    v_fmac_f32 v199, v45, v141
    v_fmac_f32 v199, v46, v142
    v_fmac_f32 v199, v47, v143
    v_mul_f32 v201, v48, v136
    v_fmac_f32 v201, v49, v137
    v_permlane32_swap_b32 v197, v199
    v_fmac_f32 v201, v50, v138
    s_add_u32 m0, s21, 2048
    s_cmp_eq_u32 s50, 4
    v_mfma_f32_32x32x16_bf16 v[16:31], v[68:71], v[176:179], 0
    s_cbranch_scc1 WL_2_1
    v_lshl_add_u32 v236, v236, 10, v246
    v_lshl_add_u32 v237, v237, 10, v246
    buffer_load_dwordx4 v236, s[4:7], s39 offen  lds
    buffer_load_dwordx4 v237, s[8:11], s39 offen offset:1024  lds
WR_2_1:
    v_fmac_f32 v201, v51, v139
    v_fmac_f32 v201, v52, v140
    v_fmac_f32 v201, v53, v141
    v_fmac_f32 v201, v54, v142
    v_fmac_f32 v201, v55, v143
    v_add_f32 v199, v197, v199
    v_mul_f32_e64 v203, v56, -v136
    v_fma_f32 v203, v57, -v137, v203
    v_fma_f32 v203, v58, -v138, v203
    v_fma_f32 v203, v59, -v139, v203
    v_fma_f32 v203, v60, -v140, v203
    v_fma_f32 v203, v61, -v141, v203
    v_fma_f32 v203, v62, -v142, v203
    v_fma_f32 v203, v63, -v143, v203
    s_nop 1
    v_permlane32_swap_b32 v201, v203
    v_add_f32 v203, v201, v203
    v_cvt_pk_bf16_f32 v192, v198, v199
    v_cvt_pk_bf16_f32 v193, v202, v203
    v_mfma_f32_32x32x16_bf16 v[32:47], v[64:67], v[180:183], 0
    v_mul_f32 v196, v0, v144
    v_fmac_f32 v196, v1, v145
    v_fmac_f32 v196, v2, v146
    v_fmac_f32 v196, v3, v147
    v_fmac_f32 v196, v4, v148
    v_fmac_f32 v196, v5, v149
    v_fmac_f32 v196, v6, v150
    v_fmac_f32 v196, v7, v151
    v_mul_f32 v198, v8, v112
    v_fmac_f32 v198, v9, v113
    v_fmac_f32 v198, v10, v114
    v_fmac_f32 v198, v11, v115
    v_fmac_f32 v198, v12, v116
    v_fmac_f32 v198, v13, v117
    v_fmac_f32 v198, v14, v118
    v_fmac_f32 v198, v15, v119
    v_mfma_f32_32x32x16_bf16 v[48:63], v[68:71], v[180:183], 0
    s_waitcnt vmcnt(6)
    ds_read_b64_tr_b16 v[176:177], v244 offset:4096
    ds_read_b64_tr_b16 v[178:179], v244 offset:5120
    ds_read_b64_tr_b16 v[180:181], v245 offset:4096
    ds_read_b64_tr_b16 v[182:183], v245 offset:5120
    v_mul_f32_e64 v200, v16, -v160
    v_fma_f32 v200, v17, -v161, v200
    v_fma_f32 v200, v18, -v162, v200
    v_fma_f32 v200, v19, -v163, v200
    v_fma_f32 v200, v20, -v164, v200
    v_fma_f32 v200, v21, -v165, v200
    v_fma_f32 v200, v22, -v166, v200
    v_fma_f32 v200, v23, -v167, v200
    v_mul_f32_e64 v202, v24, -v160
    v_fma_f32 v202, v25, -v161, v202
    v_fma_f32 v202, v26, -v162, v202
    v_fma_f32 v202, v27, -v163, v202
    v_fma_f32 v202, v28, -v164, v202
    v_fma_f32 v202, v29, -v165, v202
    v_fma_f32 v202, v30, -v166, v202
    v_fma_f32 v202, v31, -v167, v202
    s_waitcnt lgkmcnt(0)
    v_mfma_f32_32x32x16_bf16 v[0:15], v[64:67], v[176:179], 0
    v_mul_f32 v197, v32, v152
    v_fmac_f32 v197, v33, v153
    v_fmac_f32 v197, v34, v154
    v_fmac_f32 v197, v35, v155
    v_fmac_f32 v197, v36, v156
    v_fmac_f32 v197, v37, v157
    v_fmac_f32 v197, v38, v158
    v_fmac_f32 v197, v39, v159
    v_mul_f32 v199, v40, v120
    v_fmac_f32 v199, v41, v121
    v_fmac_f32 v199, v42, v122
    v_fmac_f32 v199, v43, v123
    v_fmac_f32 v199, v44, v124
    v_fmac_f32 v199, v45, v125
    v_fmac_f32 v199, v46, v126
    v_fmac_f32 v199, v47, v127
    s_add_u32 m0, s21, 4096
    s_cmp_eq_u32 s50, 4
    v_mfma_f32_32x32x16_bf16 v[16:31], v[68:71], v[176:179], 0
    s_cbranch_scc1 WL_2_2
    v_lshl_add_u32 v238, v238, 10, v246
    v_lshl_add_u32 v239, v239, 10, v246
    buffer_load_dwordx4 v238, s[4:7], s40 offen  lds
    buffer_load_dwordx4 v239, s[8:11], s40 offen offset:1024  lds
WR_2_2:
    v_mul_f32_e64 v201, v48, -v168
    v_fma_f32 v201, v49, -v169, v201
    v_fma_f32 v201, v50, -v170, v201
    v_fma_f32 v201, v51, -v171, v201
    v_fma_f32 v201, v52, -v172, v201
    v_fma_f32 v201, v53, -v173, v201
    v_fma_f32 v201, v54, -v174, v201
    v_fma_f32 v201, v55, -v175, v201
    v_mul_f32_e64 v203, v56, -v168
    v_fma_f32 v203, v57, -v169, v203
    v_fma_f32 v203, v58, -v170, v203
    v_fma_f32 v203, v59, -v171, v203
    v_fma_f32 v203, v60, -v172, v203
    v_fma_f32 v203, v61, -v173, v203
    v_fma_f32 v203, v62, -v174, v203
    v_fma_f32 v203, v63, -v175, v203
    v_mfma_f32_32x32x16_bf16 v[32:47], v[64:67], v[180:183], 0
    v_mul_f32 v254, v0, v144
    v_fmac_f32 v254, v1, v145
    v_fmac_f32 v254, v2, v146
    v_fmac_f32 v254, v3, v147
    v_fmac_f32 v254, v4, v148
    v_fmac_f32 v254, v5, v149
    v_fmac_f32 v254, v6, v150
    v_fmac_f32 v254, v7, v151
    v_fmac_f32 v200, v8, v160
    v_mfma_f32_32x32x16_bf16 v[48:63], v[68:71], v[180:183], 0
    ds_swizzle_b32 v68, v68 offset:0x401F
    ds_swizzle_b32 v69, v69 offset:0x401F
    ds_swizzle_b32 v70, v70 offset:0x401F
    ds_swizzle_b32 v71, v71 offset:0x401F
    s_waitcnt vmcnt(6)
    ds_read_b64_tr_b16 v[176:177], v244 offset:6144
    ds_read_b64_tr_b16 v[178:179], v244 offset:7168
    ds_read_b64_tr_b16 v[180:181], v245 offset:6144
    ds_read_b64_tr_b16 v[182:183], v245 offset:7168
    v_fmac_f32 v200, v9, v161
    v_permlane32_swap_b32 v196, v254
    v_fmac_f32 v200, v10, v162
    v_fmac_f32 v200, v11, v163
    v_fmac_f32 v200, v12, v164
    v_fmac_f32 v200, v13, v165
    v_fmac_f32 v200, v14, v166
    v_fmac_f32 v200, v15, v167
    v_add_f32 v254, v196, v254
    s_waitcnt lgkmcnt(0)
    s_mov_b64 exec, s[56:57]
    v_xor_b32 v68, 0x80008000, v68
    v_xor_b32 v69, 0x80008000, v69
    v_xor_b32 v70, 0x80008000, v70
    v_xor_b32 v71, 0x80008000, v71
    s_mov_b64 exec, -1
    s_nop 0
    v_mfma_f32_32x32x16_bf16 v[0:15], v[64:67], v[176:179], 0
    v_mul_f32 v255, v32, v152
    v_fmac_f32 v255, v33, v153
    v_fmac_f32 v255, v34, v154
    v_fmac_f32 v255, v35, v155
    v_fmac_f32 v255, v36, v156
    v_fmac_f32 v255, v37, v157
    v_fmac_f32 v255, v38, v158
    v_fmac_f32 v255, v39, v159
    v_fmac_f32 v201, v40, v168
    v_fmac_f32 v201, v41, v169
    s_add_u32 m0, s21, 6144
    s_cmp_eq_u32 s50, 4
    v_mfma_f32_32x32x16_bf16 v[16:31], v[68:71], v[176:179], v[16:31]
    s_cbranch_scc1 WL_2_3
    v_lshl_add_u32 v240, v240, 10, v246
    v_lshl_add_u32 v241, v241, 10, v246
    buffer_load_dwordx4 v240, s[4:7], s41 offen  lds
    buffer_load_dwordx4 v241, s[8:11], s41 offen offset:1024  lds
WR_2_3:
    v_permlane32_swap_b32 v197, v255
    v_fmac_f32 v201, v42, v170
    v_fmac_f32 v201, v43, v171
    v_fmac_f32 v201, v44, v172
    v_fmac_f32 v201, v45, v173
    v_fmac_f32 v201, v46, v174
    v_fmac_f32 v201, v47, v175
    v_add_f32 v255, v197, v255
    v_cvt_pk_bf16_f32 v194, v254, v255
    v_mfma_f32_32x32x16_bf16 v[32:47], v[64:67], v[180:183], 0
    v_mul_f32 v254, v0, v144
    v_fmac_f32 v254, v1, v145
    v_fmac_f32 v254, v2, v146
    v_fmac_f32 v254, v3, v147
    v_fmac_f32 v254, v4, v148
    v_fmac_f32 v254, v5, v149
    v_fmac_f32 v254, v6, v150
    v_fmac_f32 v254, v7, v151
    v_fma_f32 v202, v8, -v160, v202
    v_fma_f32 v202, v9, -v161, v202
    v_permlane32_swap_b32 v254, v200
    v_fma_f32 v202, v10, -v162, v202
    v_fma_f32 v202, v11, -v163, v202
    v_fma_f32 v202, v12, -v164, v202
    v_fma_f32 v202, v13, -v165, v202
    v_fma_f32 v202, v14, -v166, v202
    v_fma_f32 v202, v15, -v167, v202
    v_add_f32 v200, v254, v200
    v_fmac_f32 v198, v16, v112
    v_permlane32_swap_b32 v202, v254
    v_mfma_f32_32x32x16_bf16 v[48:63], v[68:71], v[180:183], v[48:63]
    s_waitcnt vmcnt(6)
    ds_read_b64_tr_b16 v[176:177], v244 offset:0
    ds_read_b64_tr_b16 v[178:179], v244 offset:1024
    ds_read_b64_tr_b16 v[180:181], v245 offset:0
    ds_read_b64_tr_b16 v[182:183], v245 offset:1024
    v_add_u32 v249, s48, v249
    v_add_u32 v250, s49, v250
    ds_read_b32 v252, v251 offset:16
    ds_read_b64_tr_b16 v[64:65], v249 offset:0
    ds_read_b64_tr_b16 v[68:69], v249 offset:64
    ds_read_b64_tr_b16 v[66:67], v249 offset:256
    ds_read_b64_tr_b16 v[70:71], v249 offset:320
    s_mov_b64 exec, s[54:55]
    ds_read_u16_d16_hi v242, v250 offset:0
    s_mov_b64 exec, -1
    v_fmac_f32 v198, v17, v113
    v_fmac_f32 v198, v18, v114
    v_fmac_f32 v198, v19, v115
    v_fmac_f32 v198, v20, v116
    v_fmac_f32 v198, v21, v117
    v_fmac_f32 v198, v22, v118
    v_fmac_f32 v198, v23, v119
    v_add_f32 v254, v202, v254
    v_mul_f32 v196, v24, v160
    v_fmac_f32 v196, v25, v161
    v_fmac_f32 v196, v26, v162
    v_fmac_f32 v196, v27, v163
    v_fmac_f32 v196, v28, v164
    v_fmac_f32 v196, v29, v165
    v_fmac_f32 v196, v30, v166
    v_fmac_f32 v196, v31, v167
    s_nop 1
    v_permlane32_swap_b32 v198, v196
    v_add_f32 v196, v198, v196
    s_cmp_eq_u32 s50, 4
    s_cbranch_scc1 LEPI_2
    v_mul_f32 v255, v32, v152
    v_fmac_f32 v255, v33, v153
    v_fmac_f32 v255, v34, v154
    v_fmac_f32 v255, v35, v155
    v_fmac_f32 v255, v36, v156
    v_fmac_f32 v255, v37, v157
    v_fmac_f32 v255, v38, v158
    v_fmac_f32 v255, v39, v159
    v_fma_f32 v203, v40, -v168, v203
    v_fma_f32 v203, v41, -v169, v203
    v_permlane32_swap_b32 v255, v201
    v_fma_f32 v203, v42, -v170, v203
    v_fma_f32 v203, v43, -v171, v203
    v_fma_f32 v203, v44, -v172, v203
    v_fma_f32 v203, v45, -v173, v203
    v_fma_f32 v203, v46, -v174, v203
    v_fma_f32 v203, v47, -v175, v203
    v_add_f32 v201, v255, v201
    v_fmac_f32 v199, v48, v120
    v_permlane32_swap_b32 v203, v255
    v_fmac_f32 v199, v49, v121
    v_fmac_f32 v199, v50, v122
    v_fmac_f32 v199, v51, v123
    v_fmac_f32 v199, v52, v124
    v_fmac_f32 v199, v53, v125
    v_fmac_f32 v199, v54, v126
    v_fmac_f32 v199, v55, v127
    v_add_f32 v255, v203, v255
    v_mul_f32 v197, v56, v168
    v_fmac_f32 v197, v57, v169
    v_fmac_f32 v197, v58, v170
    v_fmac_f32 v197, v59, v171
    v_fmac_f32 v197, v60, v172
    v_fmac_f32 v197, v61, v173
    v_fmac_f32 v197, v62, v174
    v_fmac_f32 v197, v63, v175
    s_nop 1
    v_permlane32_swap_b32 v199, v197
    v_add_f32 v197, v199, v197
    v_cvt_pk_bf16_f32 v200, v200, v201
    v_cvt_pk_bf16_f32 v254, v254, v255
    v_cvt_pk_bf16_f32 v196, v196, v197
    ds_write2st64_b32 v253, v192, v193 offset0:0 offset1:1
    ds_write2st64_b32 v253, v194, v200 offset0:2 offset1:3
    ds_write_b32 v253, v196 offset:1024
    s_mov_b64 exec, 0xffffffff
    ds_write_b32 v253, v254 offset:1280
    s_mov_b64 exec, -1
    s_add_u32 s50, s50, 1
    s_cmp_ge_u32 s50, 4
    s_cbranch_scc1 LAST1
    s_waitcnt lgkmcnt(9)
    v_readfirstlane_b32 s66, v252
    s_add_u32 s53, s53, 1
    v_mov_b32 v252, s53
    s_cmp_le_u32 s53, s66
    ds_write2_b32 v251, v252, v252 offset0:0 offset1:8
    s_setprio 1
    s_cbranch_scc1 PRIO_16
    s_setprio 0
PRIO_16:
    s_cmp_eq_u32 s52, 4
    s_cbranch_scc1 ITEM_1_4
    s_cmp_eq_u32 s52, 5
    s_cbranch_scc1 ITEM_1_5
    s_cmp_eq_u32 s52, 3
    s_cbranch_scc1 ITEM_1_3
    s_cmp_eq_u32 s52, 6
    s_cbranch_scc1 ITEM_1_6
    s_cmp_eq_u32 s52, 8
    s_cbranch_scc1 ITEM_1_8
    s_branch ITEM_1_2
WL_2_0:
    s_add_u32 s66, s51, 0
    buffer_load_dword v195, v246, s[16:19], s66 offen
    buffer_load_dword v195, v246, s[16:19], s66 offen
    s_branch WR_2_0
WL_2_1:
    s_add_u32 s66, s51, 4096
    buffer_load_dword v195, v246, s[16:19], s66 offen
    buffer_load_dword v195, v246, s[16:19], s66 offen
    s_branch WR_2_1
WL_2_2:
    s_add_u32 s66, s51, 8192
    buffer_load_dword v195, v246, s[16:19], s66 offen
    buffer_load_dword v195, v246, s[16:19], s66 offen
    s_branch WR_2_2
WL_2_3:
    s_add_u32 s66, s51, 12288
    buffer_load_dword v195, v246, s[16:19], s66 offen
    buffer_load_dword v195, v246, s[16:19], s66 offen
    s_branch WR_2_3
.p2align 6
.p2align 6
LEPI_2:
    s_lshl_b32 s71, s20, 4
    s_add_u32 s67, s51, 4096
    s_add_u32 s68, s51, 8192
    s_add_u32 s69, s51, 12288
    s_add_u32 s70, s51, 16384
    s_waitcnt lgkmcnt(0)
    buffer_load_dwordx4 v[96:99], v246, s[16:19], s51 offen offset:2048 sc1
    s_mov_b32 s52, 163072
    v_bfe_u32 v177, v246, 4, 4
    v_bfe_u32 v179, v246, 4, 3
    v_lshl_add_u32 v180, v177, 3, s52
    v_lshl_add_u32 v190, v177, 4, s52
    v_lshl_add_u32 v181, v179, 3, s52
    ds_read2_b64 v[182:185], v180 offset0:32 offset1:48
    ds_read_b32 v191, v190
    ds_read_b64 v[186:187], v181 offset:512
    v_lshrrev_b32 v178, 8, v246
    buffer_load_dwordx4 v[100:103], v246, s[16:19], s51 offen offset:3072 sc1
    v_add_u32 v234, s21, v248
    v_add_u32 v235, 128, v234
    v_mul_f32 v255, v32, v152
    buffer_load_dwordx4 v[104:107], v246, s[16:19], s67 offen offset:2048 sc1
    v_fmac_f32 v255, v33, v153
    v_fmac_f32 v255, v34, v154
    ds_write2st64_b32 v234, v204, v205 offset0:0 offset1:1
    v_fmac_f32 v255, v35, v155
    buffer_load_dwordx4 v[108:111], v246, s[16:19], s67 offen offset:3072 sc1
    v_fmac_f32 v255, v36, v156
    v_fmac_f32 v255, v37, v157
    ds_write2st64_b32 v234, v206, v207 offset0:2 offset1:3
    v_fmac_f32 v255, v38, v158
    buffer_load_dwordx4 v[128:131], v246, s[16:19], s68 offen offset:2048 sc1
    v_fmac_f32 v255, v39, v159
    v_fma_f32 v203, v40, -v168, v203
    ds_write2st64_b32 v234, v208, v209 offset0:4 offset1:5
    v_fma_f32 v203, v41, -v169, v203
    buffer_load_dwordx4 v[132:135], v246, s[16:19], s68 offen offset:3072 sc1
    v_permlane32_swap_b32 v255, v201
    v_fma_f32 v203, v42, -v170, v203
    ds_write2st64_b32 v235, v210, v211 offset0:6 offset1:7
    v_fma_f32 v203, v43, -v171, v203
    v_fma_f32 v203, v44, -v172, v203
    buffer_load_dwordx4 v[136:139], v246, s[16:19], s69 offen offset:2048 sc1
    v_fma_f32 v203, v45, -v173, v203
    ds_write2st64_b32 v235, v212, v213 offset0:8 offset1:9
    v_fma_f32 v203, v46, -v174, v203
    v_fma_f32 v203, v47, -v175, v203
    buffer_load_dwordx4 v[140:143], v246, s[16:19], s69 offen offset:3072 sc1
    v_add_f32 v201, v255, v201
    ds_write2st64_b32 v235, v214, v215 offset0:10 offset1:11
    v_fmac_f32 v199, v48, v120
    v_permlane32_swap_b32 v203, v255
    buffer_load_dwordx4 v[112:115], v246, s[16:19], s70 offen offset:2048 sc1
    v_fmac_f32 v199, v49, v121
    ds_write2st64_b32 v234, v216, v217 offset0:12 offset1:13
    v_fmac_f32 v199, v50, v122
    v_fmac_f32 v199, v51, v123
    buffer_load_dwordx4 v[116:119], v246, s[16:19], s70 offen offset:3072 sc1
    v_fmac_f32 v199, v52, v124
    ds_write2st64_b32 v234, v218, v219 offset0:14 offset1:15
    v_fmac_f32 v199, v53, v125
    v_fmac_f32 v199, v54, v126
    buffer_load_dwordx4 v[144:147], v246, s[16:19], s51 offen offset:0 sc1
    v_fmac_f32 v199, v55, v127
    v_add_f32 v255, v203, v255
    ds_write2st64_b32 v234, v220, v221 offset0:16 offset1:17
    v_mul_f32 v197, v56, v168
    buffer_load_dwordx4 v[148:151], v246, s[16:19], s51 offen offset:1024 sc1
    v_fmac_f32 v197, v57, v169
    v_fmac_f32 v197, v58, v170
    ds_write2st64_b32 v235, v222, v223 offset0:18 offset1:19
    v_fmac_f32 v197, v59, v171
    buffer_load_dwordx4 v[160:163], v246, s[16:19], s67 offen offset:0 sc1
    v_fmac_f32 v197, v60, v172
    v_fmac_f32 v197, v61, v173
    ds_write2st64_b32 v235, v224, v225 offset0:20 offset1:21
    v_fmac_f32 v197, v62, v174
    buffer_load_dwordx4 v[164:167], v246, s[16:19], s67 offen offset:1024 sc1
    v_fmac_f32 v197, v63, v175
    s_nop 1
    ds_write2st64_b32 v235, v226, v227 offset0:22 offset1:23
    v_permlane32_swap_b32 v199, v197
    ds_write2st64_b32 v234, v228, v229 offset0:24 offset1:25
    v_add_f32 v197, v199, v197
    v_cvt_pk_bf16_f32 v200, v200, v201
    ds_write2st64_b32 v234, v230, v231 offset0:26 offset1:27
    v_cvt_pk_bf16_f32 v254, v254, v255
    v_cvt_pk_bf16_f32 v196, v196, v197
    ds_write2st64_b32 v234, v232, v233 offset0:28 offset1:29
    ds_write2st64_b32 v253, v192, v193 offset0:0 offset1:1
    ds_write2st64_b32 v253, v194, v200 offset0:2 offset1:3
    ds_write_b32 v253, v196 offset:1024
    s_mov_b64 exec, 0xffffffff
    ds_write_b32 v253, v254 offset:1280
    s_mov_b64 exec, -1
    s_add_u32 s50, s53, 1
    v_mov_b32 v234, s50
    ds_write2_b32 v251, v234, v234 offset0:0 offset1:8
    s_waitcnt lgkmcnt(15)
    s_branch TAIL
.p2align 6
LEPI_1:
    s_lshl_b32 s71, s20, 4
    s_add_u32 s67, s51, 4096
    s_add_u32 s68, s51, 8192
    s_add_u32 s69, s51, 12288
    s_add_u32 s70, s51, 16384
    s_waitcnt lgkmcnt(0)
    buffer_load_dwordx4 v[112:115], v246, s[16:19], s70 offen offset:2048 sc1
    s_mov_b32 s52, 163072
    v_bfe_u32 v177, v246, 4, 4
    v_bfe_u32 v179, v246, 4, 3
    v_lshl_add_u32 v180, v177, 3, s52
    v_lshl_add_u32 v190, v177, 4, s52
    v_lshl_add_u32 v181, v179, 3, s52
    ds_read2_b64 v[182:185], v180 offset0:32 offset1:48
    ds_read_b32 v191, v190
    ds_read_b64 v[186:187], v181 offset:512
    v_lshrrev_b32 v178, 8, v246
    buffer_load_dwordx4 v[116:119], v246, s[16:19], s70 offen offset:3072 sc1
    v_add_u32 v234, s21, v248
    v_add_u32 v235, 128, v234
    v_mul_f32 v255, v32, v152
    v_fmac_f32 v255, v33, v153
    buffer_load_dwordx4 v[144:147], v246, s[16:19], s51 offen offset:0 sc1
    v_fmac_f32 v255, v34, v154
    v_fmac_f32 v255, v35, v155
    ds_write2st64_b32 v234, v204, v205 offset0:0 offset1:1
    v_fmac_f32 v255, v36, v156
    v_fmac_f32 v255, v37, v157
    buffer_load_dwordx4 v[148:151], v246, s[16:19], s51 offen offset:1024 sc1
    v_fmac_f32 v255, v38, v158
    v_fmac_f32 v255, v39, v159
    ds_write2st64_b32 v234, v206, v207 offset0:2 offset1:3
    v_fma_f32 v203, v40, -v168, v203
    v_fma_f32 v203, v41, -v169, v203
    v_permlane32_swap_b32 v255, v201
    buffer_load_dwordx4 v[160:163], v246, s[16:19], s67 offen offset:0 sc1
    v_fma_f32 v203, v42, -v170, v203
    v_fma_f32 v203, v43, -v171, v203
    ds_write2st64_b32 v234, v208, v209 offset0:4 offset1:5
    v_fma_f32 v203, v44, -v172, v203
    v_fma_f32 v203, v45, -v173, v203
    buffer_load_dwordx4 v[164:167], v246, s[16:19], s67 offen offset:1024 sc1
    v_fma_f32 v203, v46, -v174, v203
    v_fma_f32 v203, v47, -v175, v203
    ds_write2st64_b32 v235, v210, v211 offset0:6 offset1:7
    v_add_f32 v201, v255, v201
    v_fmac_f32 v199, v48, v120
    ds_write2st64_b32 v235, v212, v213 offset0:8 offset1:9
    v_permlane32_swap_b32 v203, v255
    v_fmac_f32 v199, v49, v121
    v_fmac_f32 v199, v50, v122
    ds_write2st64_b32 v235, v214, v215 offset0:10 offset1:11
    v_fmac_f32 v199, v51, v123
    v_fmac_f32 v199, v52, v124
    ds_write2st64_b32 v234, v216, v217 offset0:12 offset1:13
    v_fmac_f32 v199, v53, v125
    v_fmac_f32 v199, v54, v126
    ds_write2st64_b32 v234, v218, v219 offset0:14 offset1:15
    v_fmac_f32 v199, v55, v127
    v_add_f32 v255, v203, v255
    ds_write2st64_b32 v234, v220, v221 offset0:16 offset1:17
    v_mul_f32 v197, v56, v168
    v_fmac_f32 v197, v57, v169
    ds_write2st64_b32 v235, v222, v223 offset0:18 offset1:19
    v_fmac_f32 v197, v58, v170
    v_fmac_f32 v197, v59, v171
    v_fmac_f32 v197, v60, v172
    ds_write2st64_b32 v235, v224, v225 offset0:20 offset1:21
    v_fmac_f32 v197, v61, v173
    v_fmac_f32 v197, v62, v174
    ds_write2st64_b32 v235, v226, v227 offset0:22 offset1:23
    v_fmac_f32 v197, v63, v175
    s_nop 1
    ds_write2st64_b32 v234, v228, v229 offset0:24 offset1:25
    v_permlane32_swap_b32 v199, v197
    v_add_f32 v197, v199, v197
    ds_write2st64_b32 v234, v230, v231 offset0:26 offset1:27
    v_cvt_pk_bf16_f32 v200, v200, v201
    v_cvt_pk_bf16_f32 v254, v254, v255
    v_cvt_pk_bf16_f32 v196, v196, v197
    ds_write2st64_b32 v234, v232, v233 offset0:28 offset1:29
    ds_write2st64_b32 v253, v200, v196 offset0:3 offset1:4
    s_mov_b64 exec, 0xffffffff
    ds_write_b32 v253, v254 offset:1280
    s_mov_b64 exec, -1
    s_add_u32 s50, s53, 1
    v_mov_b32 v234, s50
    ds_write2_b32 v251, v234, v234 offset0:0 offset1:8
    s_waitcnt lgkmcnt(15)
    s_branch TAIL
.p2align 6
LEPI_0:
    s_lshl_b32 s71, s20, 4
    s_add_u32 s67, s51, 4096
    s_add_u32 s68, s51, 8192
    s_add_u32 s69, s51, 12288
    s_add_u32 s70, s51, 16384
    s_waitcnt lgkmcnt(0)
    buffer_load_dwordx4 v[112:115], v246, s[16:19], s70 offen offset:2048 sc1
    s_mov_b32 s52, 163072
    v_bfe_u32 v177, v246, 4, 4
    v_bfe_u32 v179, v246, 4, 3
    v_lshl_add_u32 v180, v177, 3, s52
    v_lshl_add_u32 v190, v177, 4, s52
    v_lshl_add_u32 v181, v179, 3, s52
    ds_read2_b64 v[182:185], v180 offset0:32 offset1:48
    ds_read_b32 v191, v190
    ds_read_b64 v[186:187], v181 offset:512
    v_lshrrev_b32 v178, 8, v246
    buffer_load_dwordx4 v[116:119], v246, s[16:19], s70 offen offset:3072 sc1
    v_add_u32 v234, s21, v248
    v_add_u32 v235, 128, v234
    v_mul_f32 v255, v32, v152
    v_fmac_f32 v255, v33, v153
    buffer_load_dwordx4 v[144:147], v246, s[16:19], s51 offen offset:0 sc1
    v_fmac_f32 v255, v34, v154
    v_fmac_f32 v255, v35, v155
    ds_write2st64_b32 v234, v204, v205 offset0:0 offset1:1
    v_fmac_f32 v255, v36, v156
    v_fmac_f32 v255, v37, v157
    buffer_load_dwordx4 v[148:151], v246, s[16:19], s51 offen offset:1024 sc1
    v_fmac_f32 v255, v38, v158
    v_fmac_f32 v255, v39, v159
    ds_write2st64_b32 v234, v206, v207 offset0:2 offset1:3
    v_fma_f32 v203, v40, -v168, v203
    v_fma_f32 v203, v41, -v169, v203
    v_permlane32_swap_b32 v255, v201
    buffer_load_dwordx4 v[160:163], v246, s[16:19], s67 offen offset:0 sc1
    v_fma_f32 v203, v42, -v170, v203
    v_fma_f32 v203, v43, -v171, v203
    ds_write2st64_b32 v234, v208, v209 offset0:4 offset1:5
    v_fma_f32 v203, v44, -v172, v203
    v_fma_f32 v203, v45, -v173, v203
    buffer_load_dwordx4 v[164:167], v246, s[16:19], s67 offen offset:1024 sc1
    v_fma_f32 v203, v46, -v174, v203
    v_fma_f32 v203, v47, -v175, v203
    ds_write2st64_b32 v235, v210, v211 offset0:6 offset1:7
    v_add_f32 v201, v255, v201
    v_fmac_f32 v199, v48, v120
    ds_write2st64_b32 v235, v212, v213 offset0:8 offset1:9
    v_permlane32_swap_b32 v203, v255
    v_fmac_f32 v199, v49, v121
    v_fmac_f32 v199, v50, v122
    ds_write2st64_b32 v235, v214, v215 offset0:10 offset1:11
    v_fmac_f32 v199, v51, v123
    v_fmac_f32 v199, v52, v124
    ds_write2st64_b32 v234, v216, v217 offset0:12 offset1:13
    v_fmac_f32 v199, v53, v125
    v_fmac_f32 v199, v54, v126
    ds_write2st64_b32 v234, v218, v219 offset0:14 offset1:15
    v_fmac_f32 v199, v55, v127
    v_add_f32 v255, v203, v255
    ds_write2st64_b32 v234, v220, v221 offset0:16 offset1:17
    v_mul_f32 v197, v56, v168
    v_fmac_f32 v197, v57, v169
    ds_write2st64_b32 v235, v222, v223 offset0:18 offset1:19
    v_fmac_f32 v197, v58, v170
    v_fmac_f32 v197, v59, v171
    v_fmac_f32 v197, v60, v172
    ds_write2st64_b32 v235, v224, v225 offset0:20 offset1:21
    v_fmac_f32 v197, v61, v173
    v_fmac_f32 v197, v62, v174
    ds_write2st64_b32 v235, v226, v227 offset0:22 offset1:23
    v_fmac_f32 v197, v63, v175
    s_nop 1
    ds_write2st64_b32 v234, v228, v229 offset0:24 offset1:25
    v_permlane32_swap_b32 v199, v197
    v_add_f32 v197, v199, v197
    ds_write2st64_b32 v234, v230, v231 offset0:26 offset1:27
    v_cvt_pk_bf16_f32 v200, v200, v201
    v_cvt_pk_bf16_f32 v254, v254, v255
    v_cvt_pk_bf16_f32 v196, v196, v197
    ds_write2st64_b32 v234, v232, v233 offset0:28 offset1:29
    ds_write2st64_b32 v253, v192, v193 offset0:0 offset1:1
    ds_write2st64_b32 v253, v194, v200 offset0:2 offset1:3
    ds_write_b32 v253, v196 offset:1024
    s_mov_b64 exec, 0xffffffff
    ds_write_b32 v253, v254 offset:1280
    s_mov_b64 exec, -1
    s_add_u32 s50, s53, 1
    v_mov_b32 v234, s50
    ds_write2_b32 v251, v234, v234 offset0:0 offset1:8
    s_waitcnt lgkmcnt(15)
TAIL:
    s_and_b32 s71, s20, 3
    s_lshl_b32 s71, s71, 2
    s_bitcmp0_b32 s20, 2
    s_addc_u32 s71, s71, 0
    v_readlane_b32 s71, v191, s71
    buffer_load_dwordx4 v[120:123], v246, s[16:19], s68 offen offset:0 sc1
    buffer_load_dwordx4 v[124:127], v246, s[16:19], s68 offen offset:1024 sc1
    s_cmp_ge_u32 s71, s50
    s_setprio 1
    s_cbranch_scc1 T_second
    s_setprio 0
T_second:
    buffer_load_dwordx4 v[152:155], v246, s[16:19], s69 offen offset:0 sc1
    buffer_load_dwordx4 v[156:159], v246, s[16:19], s69 offen offset:1024 sc1
    buffer_load_dwordx4 v[168:171], v246, s[16:19], s70 offen offset:0 sc1
    buffer_load_dwordx4 v[172:175], v246, s[16:19], s70 offen offset:1024 sc1
GEMM:
    v_cmp_gt_u32 vcc, s53, v191
    v_xor_b32 v180, v179, v178
    v_xor_b32 v188, 4, v180
    v_lshl_add_u32 v66, v180, 4, v183
    v_lshl_add_u32 v67, v188, 4, v183
    v_lshl_add_u32 v70, v180, 4, v185
    v_lshl_add_u32 v71, v188, 4, v185
    s_mov_b32 s4, s72
    s_and_b32 s5, s73, 0xffff
    s_mov_b32 s6, 10240000
    s_mov_b32 s7, 0x20000
    s_cbranch_vccnz T_pw
T_pwr:
    ds_read_b128 v[76:79], v66 offset:0
    ds_read_b128 v[80:83], v70 offset:0
    ds_read_b128 v[84:87], v67 offset:0
    ds_read_b128 v[88:91], v71 offset:0
    ds_read_b128 v[92:95], v66 offset:1024
    s_waitcnt vmcnt(19) lgkmcnt(4)
    v_mfma_f32_16x16x32_bf16 v[0:3], v[96:99], v[76:79], 0
    v_and_b32 v181, 8, v177
    v_add_u32 v189, v188, v181
    ds_read_b128 v[76:79], v70 offset:1024
    s_waitcnt lgkmcnt(4)
    v_mfma_f32_16x16x32_bf16 v[4:7], v[96:99], v[80:83], 0
    v_add_u32 v181, v180, v181
    v_lshl_add_u32 v64, v180, 4, v182
    ds_read_b128 v[80:83], v67 offset:1024
    s_waitcnt vmcnt(18) lgkmcnt(4)
    v_mfma_f32_16x16x32_bf16 v[0:3], v[100:103], v[84:87], v[0:3]
    v_lshl_add_u32 v65, v188, 4, v182
    v_lshl_add_u32 v68, v180, 4, v184
    ds_read_b128 v[84:87], v71 offset:1024
    s_waitcnt lgkmcnt(4)
    v_mfma_f32_16x16x32_bf16 v[4:7], v[100:103], v[88:91], v[4:7]
    v_lshl_add_u32 v69, v188, 4, v184
    v_lshl_add_u32 v72, v181, 4, v186
    ds_read_b128 v[88:91], v66 offset:128
    s_waitcnt vmcnt(17) lgkmcnt(4)
    v_mfma_f32_16x16x32_bf16 v[0:3], v[104:107], v[92:95], v[0:3]
    v_lshl_add_u32 v73, v189, 4, v186
    v_lshl_add_u32 v74, v181, 4, v187
    ds_read_b128 v[92:95], v66 offset:256
    s_waitcnt lgkmcnt(4)
    v_mfma_f32_16x16x32_bf16 v[4:7], v[104:107], v[76:79], v[4:7]
    v_lshl_add_u32 v75, v189, 4, v187
    s_mov_b32 s67, 0xbfb8aa3b
    ds_read_b128 v[76:79], v66 offset:384
    s_waitcnt vmcnt(16) lgkmcnt(4)
    v_mfma_f32_16x16x32_bf16 v[0:3], v[108:111], v[80:83], v[0:3]
    v_lshrrev_b32 v205, 1, v178
    v_lshl_add_u32 v205, s20, 1, v205
    ds_read_b128 v[80:83], v70 offset:128
    s_waitcnt lgkmcnt(4)
    v_mfma_f32_16x16x32_bf16 v[4:7], v[108:111], v[84:87], v[4:7]
    v_xor_b32 v205, v205, v179
    v_and_b32 v204, 1, v178
    ds_read_b128 v[84:87], v70 offset:256
    s_waitcnt vmcnt(15) lgkmcnt(4)
    v_mfma_f32_16x16x32_bf16 v[12:15], v[128:131], v[88:91], 0
    v_lshlrev_b32 v204, 3, v204
    v_lshl_add_u32 v205, v205, 4, v204
    ds_read_b128 v[88:91], v70 offset:384
    s_waitcnt lgkmcnt(4)
    v_mfma_f32_16x16x32_bf16 v[24:27], v[128:131], v[92:95], 0
    v_and_b32 v220, 8, v177
    v_lshl_add_u32 v204, v220, 4, v205
    ds_read_b128 v[92:95], v67 offset:128
    s_waitcnt lgkmcnt(4)
    v_mfma_f32_16x16x32_bf16 v[36:39], v[128:131], v[76:79], 0
    v_lshl_add_u32 v204, v177, 10, v204
    v_add_u32 v204, 65536, v204
    ds_read_b128 v[76:79], v67 offset:256
    s_waitcnt lgkmcnt(4)
    v_mfma_f32_16x16x32_bf16 v[16:19], v[128:131], v[80:83], 0
    v_add_u32 v205, v205, v182
    v_mul_u32_u24 v220, 1008, v220
    ds_read_b128 v[80:83], v67 offset:384
    s_waitcnt lgkmcnt(4)
    v_mfma_f32_16x16x32_bf16 v[28:31], v[128:131], v[84:87], 0
    v_sub_u32 v220, v204, v220
    s_lshl_b32 s70, s20, 4
    ds_read_b128 v[84:87], v71 offset:128
    s_waitcnt lgkmcnt(4)
    v_mfma_f32_16x16x32_bf16 v[40:43], v[128:131], v[88:91], 0
    v_xor_b32 v206, s70, v246
    s_lshl_b32 s70, s20, 10
    ds_read_b128 v[88:91], v71 offset:256
    s_waitcnt vmcnt(14) lgkmcnt(4)
    v_mfma_f32_16x16x32_bf16 v[12:15], v[132:135], v[92:95], v[12:15]
    s_add_u32 s70, s70, 65536
    v_add_u32 v207, s21, v206
    ds_read_b128 v[92:95], v71 offset:384
    s_waitcnt lgkmcnt(4)
    v_mfma_f32_16x16x32_bf16 v[24:27], v[132:135], v[76:79], v[24:27]
    v_add_u32 v206, s70, v206
    s_mul_i32 s66, s2, 40960
    ds_read_b128 v[76:79], v66 offset:512
    s_waitcnt lgkmcnt(4)
    v_mfma_f32_16x16x32_bf16 v[36:39], v[132:135], v[80:83], v[36:39]
    s_bfe_u32 s22, s22, 393237
    s_lshl_b32 s22, s22, 10
    ds_read_b128 v[80:83], v66 offset:640
    s_waitcnt lgkmcnt(4)
    v_mfma_f32_16x16x32_bf16 v[16:19], v[132:135], v[84:87], v[16:19]
    s_add_u32 s22, s22, s66
    s_bfe_u32 s23, s23, 393237
    ds_read_b128 v[84:87], v66 offset:768
    s_waitcnt lgkmcnt(4)
    v_mfma_f32_16x16x32_bf16 v[28:31], v[132:135], v[88:91], v[28:31]
    s_lshl_b32 s23, s23, 10
    s_add_u32 s23, s23, s66
    ds_read_b128 v[88:91], v70 offset:512
    s_waitcnt lgkmcnt(4)
    v_mfma_f32_16x16x32_bf16 v[40:43], v[132:135], v[92:95], v[40:43]
    s_bfe_u32 s24, s24, 393237
    s_lshl_b32 s24, s24, 10
    ds_read_b128 v[92:95], v70 offset:640
    s_waitcnt vmcnt(13) lgkmcnt(4)
    v_mfma_f32_16x16x32_bf16 v[12:15], v[136:139], v[76:79], v[12:15]
    s_add_u32 s24, s24, s66
    s_bfe_u32 s25, s25, 393237
    ds_read_b128 v[76:79], v70 offset:768
    s_waitcnt lgkmcnt(4)
    v_mfma_f32_16x16x32_bf16 v[24:27], v[136:139], v[80:83], v[24:27]
    s_lshl_b32 s25, s25, 10
    s_add_u32 s25, s25, s66
    ds_read_b128 v[80:83], v67 offset:512
    s_waitcnt lgkmcnt(4)
    v_mfma_f32_16x16x32_bf16 v[36:39], v[136:139], v[84:87], v[36:39]
    s_bfe_u32 s26, s26, 393237
    s_lshl_b32 s26, s26, 10
    ds_read_b128 v[84:87], v67 offset:640
    s_waitcnt lgkmcnt(4)
    v_mfma_f32_16x16x32_bf16 v[16:19], v[136:139], v[88:91], v[16:19]
    s_add_u32 s26, s26, s66
    ds_read_b128 v[88:91], v67 offset:768
    s_waitcnt lgkmcnt(4)
    v_mfma_f32_16x16x32_bf16 v[28:31], v[136:139], v[92:95], v[28:31]
    ds_read_b128 v[92:95], v71 offset:512
    s_waitcnt lgkmcnt(4)
    v_mfma_f32_16x16x32_bf16 v[40:43], v[136:139], v[76:79], v[40:43]
    ds_read_b128 v[76:79], v71 offset:640
    s_waitcnt vmcnt(12) lgkmcnt(4)
    v_mfma_f32_16x16x32_bf16 v[12:15], v[140:143], v[80:83], v[12:15]
    ds_read_b128 v[80:83], v71 offset:768
    s_waitcnt lgkmcnt(4)
    v_mfma_f32_16x16x32_bf16 v[24:27], v[140:143], v[84:87], v[24:27]
    ds_read_b128 v[84:87], v66 offset:1152
    s_waitcnt lgkmcnt(4)
    v_mfma_f32_16x16x32_bf16 v[36:39], v[140:143], v[88:91], v[36:39]
    ds_read_b128 v[88:91], v66 offset:1280
    s_waitcnt lgkmcnt(4)
    v_mfma_f32_16x16x32_bf16 v[16:19], v[140:143], v[92:95], v[16:19]
    ds_read_b128 v[92:95], v66 offset:896
    s_waitcnt lgkmcnt(4)
    v_mfma_f32_16x16x32_bf16 v[28:31], v[140:143], v[76:79], v[28:31]
    ds_read_b128 v[76:79], v70 offset:1152
    s_waitcnt lgkmcnt(4)
    v_mfma_f32_16x16x32_bf16 v[40:43], v[140:143], v[80:83], v[40:43]
    ds_read_b128 v[80:83], v70 offset:1280
    s_waitcnt vmcnt(11) lgkmcnt(4)
    v_mfma_f32_16x16x32_bf16 v[12:15], v[112:115], v[84:87], v[12:15]
    ds_read_b128 v[84:87], v70 offset:896
    s_waitcnt lgkmcnt(4)
    v_mfma_f32_16x16x32_bf16 v[24:27], v[112:115], v[88:91], v[24:27]
    ds_read_b128 v[88:91], v67 offset:1152
    s_waitcnt lgkmcnt(4)
    v_mfma_f32_16x16x32_bf16 v[36:39], v[112:115], v[92:95], v[36:39]
    ds_read_b128 v[92:95], v67 offset:1280
    s_waitcnt lgkmcnt(4)
    v_mfma_f32_16x16x32_bf16 v[16:19], v[112:115], v[76:79], v[16:19]
    ds_read_b128 v[76:79], v67 offset:896
    s_waitcnt lgkmcnt(4)
    v_mfma_f32_16x16x32_bf16 v[28:31], v[112:115], v[80:83], v[28:31]
    ds_read_b32 v191, v190
    ds_read_b128 v[80:83], v71 offset:1152
    s_waitcnt lgkmcnt(5)
    v_mfma_f32_16x16x32_bf16 v[40:43], v[112:115], v[84:87], v[40:43]
    ds_read_b128 v[84:87], v71 offset:1280
    s_waitcnt vmcnt(10) lgkmcnt(5)
    v_mfma_f32_16x16x32_bf16 v[12:15], v[116:119], v[88:91], v[12:15]
    ds_read_b128 v[88:91], v71 offset:896
    s_waitcnt lgkmcnt(5)
    v_mfma_f32_16x16x32_bf16 v[24:27], v[116:119], v[92:95], v[24:27]
    s_waitcnt lgkmcnt(3)
    v_cmp_gt_u32 vcc, s50, v191
    s_cbranch_vccnz T_aw
T_awr:
    ds_read_b128 v[92:95], v64 offset:0
    v_mfma_f32_16x16x32_bf16 v[36:39], v[116:119], v[76:79], v[36:39]
    ds_read_b128 v[76:79], v68 offset:0
    s_waitcnt lgkmcnt(4)
    v_mfma_f32_16x16x32_bf16 v[16:19], v[116:119], v[80:83], v[16:19]
    ds_read_b128 v[80:83], v65 offset:0
    s_waitcnt lgkmcnt(4)
    v_mfma_f32_16x16x32_bf16 v[28:31], v[116:119], v[84:87], v[28:31]
    ds_read_b128 v[84:87], v69 offset:0
    s_waitcnt lgkmcnt(4)
    v_mfma_f32_16x16x32_bf16 v[40:43], v[116:119], v[88:91], v[40:43]
    ds_read_b128 v[88:91], v64 offset:1024
    s_waitcnt vmcnt(9) lgkmcnt(4)
    v_mfma_f32_16x16x32_bf16 v[0:3], v[144:147], v[92:95], v[0:3]
    ds_read_b128 v[92:95], v68 offset:1024
    s_waitcnt lgkmcnt(4)
    v_mfma_f32_16x16x32_bf16 v[4:7], v[144:147], v[76:79], v[4:7]
    ds_read_b128 v[76:79], v65 offset:1024
    s_waitcnt vmcnt(8) lgkmcnt(4)
    v_mfma_f32_16x16x32_bf16 v[0:3], v[148:151], v[80:83], v[0:3]
    ds_read_b128 v[80:83], v69 offset:1024
    s_waitcnt lgkmcnt(4)
    v_mfma_f32_16x16x32_bf16 v[4:7], v[148:151], v[84:87], v[4:7]
    ds_read_b128 v[84:87], v72 offset:0
    s_waitcnt vmcnt(7) lgkmcnt(4)
    v_mfma_f32_16x16x32_bf16 v[0:3], v[160:163], v[88:91], v[0:3]
    ds_read_b128 v[88:91], v73 offset:0
    s_waitcnt lgkmcnt(4)
    v_mfma_f32_16x16x32_bf16 v[4:7], v[160:163], v[92:95], v[4:7]
    ds_read_b128 v[92:95], v74 offset:0
    s_waitcnt vmcnt(6) lgkmcnt(4)
    v_mfma_f32_16x16x32_bf16 v[0:3], v[164:167], v[76:79], v[0:3]
    ds_read_b128 v[76:79], v75 offset:0
    s_waitcnt lgkmcnt(4)
    v_mfma_f32_16x16x32_bf16 v[4:7], v[164:167], v[80:83], v[4:7]
    ds_read_b128 v[80:83], v72 offset:1024
    s_waitcnt lgkmcnt(4)
    v_mfma_f32_16x16x32_bf16 v[8:11], v[144:147], v[84:87], 0
    ds_read_b128 v[84:87], v73 offset:1024
    s_waitcnt lgkmcnt(4)
    v_mfma_f32_16x16x32_bf16 v[8:11], v[148:151], v[88:91], v[8:11]
    v_mul_f32 v192, s67, v0
    v_mul_f32 v193, s67, v1
    ds_read_b128 v[88:91], v74 offset:1024
    s_waitcnt lgkmcnt(4)
    v_mfma_f32_16x16x32_bf16 v[8:11], v[96:99], v[92:95], v[8:11]
    v_mul_f32 v194, s67, v2
    v_mul_f32 v195, s67, v3
    ds_read_b128 v[92:95], v75 offset:1024
    s_waitcnt lgkmcnt(4)
    v_mfma_f32_16x16x32_bf16 v[8:11], v[100:103], v[76:79], v[8:11]
    v_exp_f32 v192, v192
    v_exp_f32 v193, v193
    ds_read_b128 v[76:79], v64 offset:128
    s_waitcnt lgkmcnt(4)
    v_mfma_f32_16x16x32_bf16 v[8:11], v[160:163], v[80:83], v[8:11]
    v_exp_f32 v194, v194
    v_exp_f32 v195, v195
    ds_read_b128 v[80:83], v65 offset:128
    s_waitcnt lgkmcnt(4)
    v_mfma_f32_16x16x32_bf16 v[8:11], v[164:167], v[84:87], v[8:11]
    v_add_f32 v192, 1.0, v192
    v_add_f32 v193, 1.0, v193
    ds_read_b128 v[84:87], v64 offset:512
    s_waitcnt lgkmcnt(4)
    v_mfma_f32_16x16x32_bf16 v[8:11], v[104:107], v[88:91], v[8:11]
    v_add_f32 v194, 1.0, v194
    v_add_f32 v195, 1.0, v195
    ds_read_b128 v[88:91], v65 offset:512
    s_waitcnt lgkmcnt(4)
    v_mfma_f32_16x16x32_bf16 v[8:11], v[108:111], v[92:95], v[8:11]
    v_rcp_f32 v192, v192
    v_rcp_f32 v193, v193
    ds_read_b128 v[92:95], v64 offset:1152
    s_waitcnt vmcnt(5) lgkmcnt(4)
    v_mfma_f32_16x16x32_bf16 v[12:15], v[120:123], v[76:79], v[12:15]
    v_rcp_f32 v194, v194
    v_rcp_f32 v195, v195
    ds_read_b128 v[76:79], v65 offset:1152
    s_waitcnt vmcnt(4) lgkmcnt(4)
    v_mfma_f32_16x16x32_bf16 v[12:15], v[124:127], v[80:83], v[12:15]
    v_cvt_pk_bf16_f32 v0, v0, v1
    v_cvt_pk_bf16_f32 v1, v2, v3
    ds_read_b128 v[80:83], v64 offset:256
    s_waitcnt vmcnt(3) lgkmcnt(4)
    v_mfma_f32_16x16x32_bf16 v[12:15], v[152:155], v[84:87], v[12:15]
    ds_write_b64 v204, v[0:1] offset:0
    v_mul_f32 v196, s67, v4
    ds_read_b128 v[84:87], v65 offset:256
    s_waitcnt vmcnt(2) lgkmcnt(5)
    v_mfma_f32_16x16x32_bf16 v[12:15], v[156:159], v[88:91], v[12:15]
    v_mul_f32 v197, s67, v5
    v_mul_f32 v198, s67, v6
    ds_read_b128 v[88:91], v64 offset:640
    s_waitcnt vmcnt(1) lgkmcnt(5)
    v_mfma_f32_16x16x32_bf16 v[12:15], v[168:171], v[92:95], v[12:15]
    v_mul_f32 v199, s67, v7
    v_exp_f32 v196, v196
    ds_read_b128 v[92:95], v65 offset:640
    s_waitcnt vmcnt(0) lgkmcnt(5)
    v_mfma_f32_16x16x32_bf16 v[12:15], v[172:175], v[76:79], v[12:15]
    v_exp_f32 v197, v197
    v_exp_f32 v198, v198
    ds_read_b128 v[76:79], v64 offset:1280
    s_waitcnt lgkmcnt(5)
    v_mfma_f32_16x16x32_bf16 v[24:27], v[120:123], v[80:83], v[24:27]
    v_exp_f32 v199, v199
    v_add_f32 v196, 1.0, v196
    ds_read_b128 v[80:83], v65 offset:1280
    s_waitcnt lgkmcnt(4)
    v_mfma_f32_16x16x32_bf16 v[24:27], v[124:127], v[84:87], v[24:27]
    v_mul_f32 v12, v12, v192
    v_mul_f32 v13, v13, v193
    ds_read_b128 v[84:87], v64 offset:384
    s_waitcnt lgkmcnt(4)
    v_mfma_f32_16x16x32_bf16 v[24:27], v[152:155], v[88:91], v[24:27]
    v_mul_f32 v14, v14, v194
    v_mul_f32 v15, v15, v195
    ds_read_b128 v[88:91], v65 offset:384
    s_waitcnt lgkmcnt(4)
    v_mfma_f32_16x16x32_bf16 v[24:27], v[156:159], v[92:95], v[24:27]
    v_cvt_pk_bf16_f32 v12, v12, v13
    v_cvt_pk_bf16_f32 v13, v14, v15
    ds_read_b128 v[92:95], v64 offset:768
    s_waitcnt lgkmcnt(4)
    v_mfma_f32_16x16x32_bf16 v[24:27], v[168:171], v[76:79], v[24:27]
    ds_write_b64 v204, v[12:13] offset:256
    v_add_f32 v197, 1.0, v197
    ds_read_b128 v[76:79], v65 offset:768
    s_waitcnt lgkmcnt(5)
    v_mfma_f32_16x16x32_bf16 v[24:27], v[172:175], v[80:83], v[24:27]
    v_add_f32 v198, 1.0, v198
    v_add_f32 v199, 1.0, v199
    ds_read_b128 v[80:83], v64 offset:896
    s_waitcnt lgkmcnt(5)
    v_mfma_f32_16x16x32_bf16 v[36:39], v[120:123], v[84:87], v[36:39]
    v_rcp_f32 v196, v196
    v_rcp_f32 v197, v197
    ds_read_b128 v[84:87], v65 offset:896
    s_waitcnt lgkmcnt(5)
    v_mfma_f32_16x16x32_bf16 v[36:39], v[124:127], v[88:91], v[36:39]
    v_rcp_f32 v198, v198
    v_rcp_f32 v199, v199
    ds_read_b128 v[88:91], v68 offset:128
    s_waitcnt lgkmcnt(5)
    v_mfma_f32_16x16x32_bf16 v[36:39], v[152:155], v[92:95], v[36:39]
    v_mul_f32 v24, v24, v192
    v_mul_f32 v25, v25, v193
    ds_read_b128 v[92:95], v69 offset:128
    s_waitcnt lgkmcnt(4)
    v_mfma_f32_16x16x32_bf16 v[36:39], v[156:159], v[76:79], v[36:39]
    v_mul_f32 v26, v26, v194
    v_mul_f32 v27, v27, v195
    ds_read_b128 v[76:79], v68 offset:512
    s_waitcnt lgkmcnt(4)
    v_mfma_f32_16x16x32_bf16 v[36:39], v[168:171], v[80:83], v[36:39]
    v_cvt_pk_bf16_f32 v24, v24, v25
    v_cvt_pk_bf16_f32 v25, v26, v27
    ds_read_b128 v[80:83], v69 offset:512
    s_waitcnt lgkmcnt(4)
    v_mfma_f32_16x16x32_bf16 v[36:39], v[172:175], v[84:87], v[36:39]
    ds_write_b64 v204, v[24:25] offset:512
    v_mul_f32 v200, s67, v8
    ds_read_b128 v[84:87], v68 offset:1152
    s_waitcnt lgkmcnt(5)
    v_mfma_f32_16x16x32_bf16 v[16:19], v[120:123], v[88:91], v[16:19]
    v_mul_f32 v201, s67, v9
    v_mul_f32 v202, s67, v10
    ds_read_b128 v[88:91], v69 offset:1152
    s_waitcnt lgkmcnt(5)
    v_mfma_f32_16x16x32_bf16 v[16:19], v[124:127], v[92:95], v[16:19]
    v_mul_f32 v203, s67, v11
    v_exp_f32 v200, v200
    ds_read_b128 v[92:95], v68 offset:256
    s_waitcnt lgkmcnt(5)
    v_mfma_f32_16x16x32_bf16 v[16:19], v[152:155], v[76:79], v[16:19]
    v_mul_f32 v36, v36, v192
    v_mul_f32 v37, v37, v193
    ds_read_b128 v[76:79], v69 offset:256
    s_waitcnt lgkmcnt(5)
    v_mfma_f32_16x16x32_bf16 v[16:19], v[156:159], v[80:83], v[16:19]
    v_mul_f32 v38, v38, v194
    v_mul_f32 v39, v39, v195
    ds_read_b128 v[80:83], v68 offset:640
    s_waitcnt lgkmcnt(4)
    v_mfma_f32_16x16x32_bf16 v[16:19], v[168:171], v[84:87], v[16:19]
    v_cvt_pk_bf16_f32 v36, v36, v37
    v_cvt_pk_bf16_f32 v37, v38, v39
    ds_read_b128 v[84:87], v69 offset:640
    s_waitcnt lgkmcnt(4)
    v_mfma_f32_16x16x32_bf16 v[16:19], v[172:175], v[88:91], v[16:19]
    ds_write_b64 v204, v[36:37] offset:768
    v_exp_f32 v201, v201
    ds_read_b128 v[88:91], v68 offset:1280
    s_waitcnt lgkmcnt(5)
    v_mfma_f32_16x16x32_bf16 v[28:31], v[120:123], v[92:95], v[28:31]
    v_exp_f32 v202, v202
    v_exp_f32 v203, v203
    ds_read_b128 v[92:95], v69 offset:1280
    s_waitcnt lgkmcnt(5)
    v_mfma_f32_16x16x32_bf16 v[28:31], v[124:127], v[76:79], v[28:31]
    v_add_f32 v200, 1.0, v200
    v_add_f32 v201, 1.0, v201
    ds_read_b128 v[76:79], v68 offset:384
    s_waitcnt lgkmcnt(5)
    v_mfma_f32_16x16x32_bf16 v[28:31], v[152:155], v[80:83], v[28:31]
    v_add_f32 v202, 1.0, v202
    v_add_f32 v203, 1.0, v203
    ds_read_b128 v[80:83], v69 offset:384
    s_waitcnt lgkmcnt(5)
    v_mfma_f32_16x16x32_bf16 v[28:31], v[156:159], v[84:87], v[28:31]
    v_rcp_f32 v200, v200
    v_rcp_f32 v201, v201
    ds_read_b128 v[84:87], v68 offset:768
    s_waitcnt lgkmcnt(4)
    v_mfma_f32_16x16x32_bf16 v[28:31], v[168:171], v[88:91], v[28:31]
    v_rcp_f32 v202, v202
    v_rcp_f32 v203, v203
    ds_read_b128 v[88:91], v69 offset:768
    s_waitcnt lgkmcnt(4)
    v_mfma_f32_16x16x32_bf16 v[28:31], v[172:175], v[92:95], v[28:31]
    v_mov_b32_dpp v200, v200 row_ror:8 row_mask:0xf bank_mask:0xc
    ds_read_b128 v[92:95], v68 offset:896
    s_waitcnt lgkmcnt(4)
    v_mfma_f32_16x16x32_bf16 v[40:43], v[120:123], v[76:79], v[40:43]
    v_mov_b32_dpp v201, v201 row_ror:8 row_mask:0xf bank_mask:0xc
    v_mov_b32_dpp v202, v202 row_ror:8 row_mask:0xf bank_mask:0xc
    ds_read_b128 v[76:79], v69 offset:896
    s_waitcnt lgkmcnt(4)
    v_mfma_f32_16x16x32_bf16 v[40:43], v[124:127], v[80:83], v[40:43]
    v_mov_b32_dpp v203, v203 row_ror:8 row_mask:0xf bank_mask:0xc
    ds_read_b128 v[80:83], v72 offset:128
    s_waitcnt lgkmcnt(4)
    v_mfma_f32_16x16x32_bf16 v[40:43], v[152:155], v[84:87], v[40:43]
    s_barrier
    ds_read_b128 v[212:215], v206 offset:0
    ds_read_b128 v[84:87], v73 offset:128
    s_waitcnt lgkmcnt(5)
    v_mfma_f32_16x16x32_bf16 v[40:43], v[156:159], v[88:91], v[40:43]
    ds_read_b128 v[216:219], v206 offset:8320
    v_cvt_pk_bf16_f32 v4, v4, v5
    ds_read_b128 v[88:91], v74 offset:128
    s_waitcnt lgkmcnt(6)
    v_mfma_f32_16x16x32_bf16 v[40:43], v[168:171], v[92:95], v[40:43]
    v_cvt_pk_bf16_f32 v5, v6, v7
    ds_write_b64 v205, v[4:5] offset:0
    ds_read_b128 v[92:95], v75 offset:128
    s_waitcnt lgkmcnt(7)
    v_mfma_f32_16x16x32_bf16 v[40:43], v[172:175], v[76:79], v[40:43]
    v_mul_f32 v16, v16, v196
    v_mul_f32 v17, v17, v197
    ds_read_b128 v[76:79], v72 offset:512
    s_waitcnt lgkmcnt(7)
    v_mfma_f32_16x16x32_bf16 v[20:23], v[120:123], v[80:83], 0
    v_mul_f32 v18, v18, v198
    v_mul_f32 v19, v19, v199
    ds_read_b128 v[80:83], v73 offset:512
    s_waitcnt lgkmcnt(6)
    v_mfma_f32_16x16x32_bf16 v[20:23], v[124:127], v[84:87], v[20:23]
    v_cvt_pk_bf16_f32 v16, v16, v17
    v_cvt_pk_bf16_f32 v17, v18, v19
    ds_read_b128 v[84:87], v74 offset:512
    s_waitcnt lgkmcnt(5)
    v_mfma_f32_16x16x32_bf16 v[20:23], v[128:131], v[88:91], v[20:23]
    ds_write_b64 v205, v[16:17] offset:256
    ds_read_b128 v[88:91], v75 offset:512
    s_waitcnt lgkmcnt(5)
    v_mfma_f32_16x16x32_bf16 v[20:23], v[132:135], v[92:95], v[20:23]
    buffer_store_dwordx4 v[212:215], v246, s[4:7], s22 offen sc1
    ds_read_b128 v[92:95], v72 offset:1152
    s_waitcnt lgkmcnt(5)
    v_mfma_f32_16x16x32_bf16 v[20:23], v[152:155], v[76:79], v[20:23]
    buffer_store_dwordx4 v[216:219], v246, s[4:7], s23 offen sc1
    v_mul_f32 v28, v28, v196
    ds_read_b128 v[76:79], v73 offset:1152
    s_waitcnt lgkmcnt(5)
    v_mfma_f32_16x16x32_bf16 v[20:23], v[156:159], v[80:83], v[20:23]
    v_mul_f32 v29, v29, v197
    v_mul_f32 v30, v30, v198
    ds_read_b128 v[80:83], v74 offset:1152
    s_waitcnt lgkmcnt(5)
    v_mfma_f32_16x16x32_bf16 v[20:23], v[136:139], v[84:87], v[20:23]
    v_mul_f32 v31, v31, v199
    v_cvt_pk_bf16_f32 v28, v28, v29
    ds_read_b128 v[84:87], v75 offset:1152
    s_waitcnt lgkmcnt(4)
    v_mfma_f32_16x16x32_bf16 v[20:23], v[140:143], v[88:91], v[20:23]
    v_cvt_pk_bf16_f32 v29, v30, v31
    ds_write_b64 v205, v[28:29] offset:512
    ds_read_b128 v[88:91], v72 offset:384
    s_waitcnt lgkmcnt(5)
    v_mfma_f32_16x16x32_bf16 v[20:23], v[168:171], v[92:95], v[20:23]
    v_mul_f32 v40, v40, v196
    v_mul_f32 v41, v41, v197
    ds_read_b128 v[92:95], v73 offset:384
    s_waitcnt lgkmcnt(5)
    v_mfma_f32_16x16x32_bf16 v[20:23], v[172:175], v[76:79], v[20:23]
    v_mul_f32 v42, v42, v198
    v_mul_f32 v43, v43, v199
    ds_read_b128 v[76:79], v74 offset:384
    s_waitcnt lgkmcnt(5)
    v_mfma_f32_16x16x32_bf16 v[20:23], v[112:115], v[80:83], v[20:23]
    v_cvt_pk_bf16_f32 v40, v40, v41
    v_cvt_pk_bf16_f32 v41, v42, v43
    ds_read_b128 v[80:83], v75 offset:384
    s_waitcnt lgkmcnt(5)
    v_mfma_f32_16x16x32_bf16 v[20:23], v[116:119], v[84:87], v[20:23]
    ds_write_b64 v205, v[40:41] offset:768
    ds_read_b128 v[84:87], v72 offset:768
    s_waitcnt lgkmcnt(5)
    v_mfma_f32_16x16x32_bf16 v[44:47], v[120:123], v[88:91], 0
    ds_read_b128 v[88:91], v73 offset:768
    s_waitcnt lgkmcnt(5)
    v_mfma_f32_16x16x32_bf16 v[44:47], v[124:127], v[92:95], v[44:47]
    s_waitcnt lgkmcnt(2)
    s_barrier
    ds_read_b128 v[92:95], v74 offset:768
    v_mfma_f32_16x16x32_bf16 v[44:47], v[128:131], v[76:79], v[44:47]
    ds_read_b128 v[212:215], v207 offset:0
    ds_read_b128 v[216:219], v207 offset:1664
    ds_read_b128 v[76:79], v75 offset:768
    v_mfma_f32_16x16x32_bf16 v[44:47], v[132:135], v[80:83], v[44:47]
    ds_read_b128 v[80:83], v72 offset:896
    s_waitcnt lgkmcnt(6)
    v_mfma_f32_16x16x32_bf16 v[44:47], v[152:155], v[84:87], v[44:47]
    ds_read_b128 v[84:87], v73 offset:896
    s_waitcnt lgkmcnt(6)
    v_mfma_f32_16x16x32_bf16 v[44:47], v[156:159], v[88:91], v[44:47]
    ds_read_b128 v[88:91], v74 offset:896
    s_waitcnt lgkmcnt(6)
    v_mfma_f32_16x16x32_bf16 v[44:47], v[136:139], v[92:95], v[44:47]
    s_waitcnt lgkmcnt(5)
    buffer_store_dwordx4 v[212:215], v246, s[4:7], s24 offen sc1
    ds_read_b128 v[92:95], v75 offset:896
    s_waitcnt lgkmcnt(4)
    v_mfma_f32_16x16x32_bf16 v[44:47], v[140:143], v[76:79], v[44:47]
    buffer_store_dwordx4 v[216:219], v246, s[4:7], s25 offen sc1
    s_waitcnt lgkmcnt(3)
    v_mfma_f32_16x16x32_bf16 v[44:47], v[168:171], v[80:83], v[44:47]
    v_cvt_pk_bf16_f32 v8, v8, v9
    v_cvt_pk_bf16_f32 v9, v10, v11
    s_waitcnt lgkmcnt(2)
    v_mfma_f32_16x16x32_bf16 v[44:47], v[172:175], v[84:87], v[44:47]
    ds_write_b64 v204, v[8:9] offset:0
    v_mul_f32 v20, v20, v200
    s_waitcnt lgkmcnt(2)
    v_mfma_f32_16x16x32_bf16 v[44:47], v[112:115], v[88:91], v[44:47]
    v_mul_f32 v21, v21, v201
    v_mul_f32 v22, v22, v202
    s_waitcnt lgkmcnt(1)
    v_mfma_f32_16x16x32_bf16 v[44:47], v[116:119], v[92:95], v[44:47]
    v_mul_f32 v23, v23, v203
    v_cvt_pk_bf16_f32 v20, v20, v21
    v_cvt_pk_bf16_f32 v21, v22, v23
    ds_write_b64 v220, v[20:21] offset:256
    s_nop 3
    v_mul_f32 v44, v44, v200
    v_mul_f32 v45, v45, v201
    v_mul_f32 v46, v46, v202
    v_mul_f32 v47, v47, v203
    v_cvt_pk_bf16_f32 v44, v44, v45
    v_cvt_pk_bf16_f32 v45, v46, v47
    ds_write_b64 v204, v[44:45] offset:768
    s_waitcnt lgkmcnt(0)
    s_barrier
    ds_read_b128 v[212:215], v206 offset:0
    s_waitcnt lgkmcnt(0)
    buffer_store_dwordx4 v[212:215], v246, s[4:7], s26 offen sc1
    s_or_b32 s89, s89, s20
    s_cbranch_scc1 K2_end
    v_mov_b32 v0, 0
    v_mov_b32 v1, s88
    s_mov_b64 exec, 1
    buffer_store_dword v1, v0, s[16:19], 0 offen
    s_endpgm
T_pw:
    s_sleep 1
    ds_read_b32 v191, v190
    s_waitcnt lgkmcnt(0)
    v_cmp_gt_u32 vcc, s53, v191
    s_cbranch_vccnz T_pw
    s_branch T_pwr
T_aw:
    s_sleep 1
    ds_read_b32 v191, v190
    s_waitcnt lgkmcnt(0)
    v_cmp_gt_u32 vcc, s50, v191
    s_cbranch_vccnz T_aw
    s_branch T_awr
K2_end:
K2_last:
    s_endpgm
SLOW:
    v_readlane_b32 s89, v4, 62
    s_waitcnt vmcnt(0) lgkmcnt(0)
    s_barrier
    s_load_dwordx2 s[22:23], s[0:1], 8
    s_load_dwordx2 s[24:25], s[0:1], 24
    s_load_dwordx2 s[26:27], s[0:1], 32
    s_load_dwordx2 s[28:29], s[0:1], 40
    s_load_dwordx2 s[30:31], s[0:1], 0
    v_mbcnt_lo_u32_b32 v240, -1, 0
    v_mbcnt_hi_u32_b32 v240, -1, v240
    v_lshrrev_b32 v229, 5, v240
    v_and_b32 v230, 31, v240
    v_lshlrev_b32 v241, 7, v229
    v_lshl_add_u32 v241, v230, 1, v241
    v_lshlrev_b32 v245, 4, v240
    v_mov_b32 v242, 0
    s_waitcnt lgkmcnt(0)
    s_mov_b32 s80, s22
    s_and_b32 s81, s23, 0xffff
    s_mov_b32 s82, 1920000
    s_mov_b32 s83, 0x20000
    s_mov_b32 s76, s24
    s_and_b32 s77, s25, 0xffff
    s_mov_b32 s78, 1280000
    s_mov_b32 s79, 0x20000
    s_mov_b32 s72, s26
    s_and_b32 s73, s27, 0xffff
    s_mov_b32 s74, 1280000
    s_mov_b32 s75, 0x20000
    s_mov_b32 s84, s28
    s_and_b32 s85, s29, 0xffff
    s_mov_b32 s86, 20480
    s_mov_b32 s87, 0x20000
    s_mov_b32 s4, s30
    s_and_b32 s5, s31, 0xffff
    s_mov_b32 s6, 10240000
    s_mov_b32 s7, 0x20000
    s_mov_b32 s66, 0
    buffer_load_ushort v0, v241, s[84:87], s66 offen offset:0
    buffer_load_ushort v1, v241, s[84:87], s66 offen offset:64
    buffer_load_ushort v2, v241, s[84:87], s66 offen offset:256
    buffer_load_ushort v3, v241, s[84:87], s66 offen offset:320
    buffer_load_ushort v4, v241, s[84:87], s66 offen offset:512
    buffer_load_ushort v5, v241, s[84:87], s66 offen offset:576
    buffer_load_ushort v6, v241, s[84:87], s66 offen offset:768
    buffer_load_ushort v7, v241, s[84:87], s66 offen offset:832
    buffer_load_ushort v8, v241, s[84:87], s66 offen offset:1024
    buffer_load_ushort v9, v241, s[84:87], s66 offen offset:1088
    s_waitcnt vmcnt(0)
    s_mov_b32 s66, 1280
    buffer_load_ushort v10, v241, s[84:87], s66 offen offset:0
    buffer_load_ushort v11, v241, s[84:87], s66 offen offset:64
    buffer_load_ushort v12, v241, s[84:87], s66 offen offset:256
    buffer_load_ushort v13, v241, s[84:87], s66 offen offset:320
    buffer_load_ushort v14, v241, s[84:87], s66 offen offset:512
    buffer_load_ushort v15, v241, s[84:87], s66 offen offset:576
    buffer_load_ushort v16, v241, s[84:87], s66 offen offset:768
    buffer_load_ushort v17, v241, s[84:87], s66 offen offset:832
    buffer_load_ushort v18, v241, s[84:87], s66 offen offset:1024
    buffer_load_ushort v19, v241, s[84:87], s66 offen offset:1088
    s_waitcnt vmcnt(0)
    s_mov_b32 s66, 2560
    buffer_load_ushort v20, v241, s[84:87], s66 offen offset:0
    buffer_load_ushort v21, v241, s[84:87], s66 offen offset:64
    buffer_load_ushort v22, v241, s[84:87], s66 offen offset:256
    buffer_load_ushort v23, v241, s[84:87], s66 offen offset:320
    buffer_load_ushort v24, v241, s[84:87], s66 offen offset:512
    buffer_load_ushort v25, v241, s[84:87], s66 offen offset:576
    buffer_load_ushort v26, v241, s[84:87], s66 offen offset:768
    buffer_load_ushort v27, v241, s[84:87], s66 offen offset:832
    buffer_load_ushort v28, v241, s[84:87], s66 offen offset:1024
    buffer_load_ushort v29, v241, s[84:87], s66 offen offset:1088
    s_waitcnt vmcnt(0)
    s_mov_b32 s66, 3840
    buffer_load_ushort v30, v241, s[84:87], s66 offen offset:0
    buffer_load_ushort v31, v241, s[84:87], s66 offen offset:64
    buffer_load_ushort v32, v241, s[84:87], s66 offen offset:256
    buffer_load_ushort v33, v241, s[84:87], s66 offen offset:320
    buffer_load_ushort v34, v241, s[84:87], s66 offen offset:512
    buffer_load_ushort v35, v241, s[84:87], s66 offen offset:576
    buffer_load_ushort v36, v241, s[84:87], s66 offen offset:768
    buffer_load_ushort v37, v241, s[84:87], s66 offen offset:832
    buffer_load_ushort v38, v241, s[84:87], s66 offen offset:1024
    buffer_load_ushort v39, v241, s[84:87], s66 offen offset:1088
    s_waitcnt vmcnt(0)
    s_mov_b32 s66, 5120
    buffer_load_ushort v40, v241, s[84:87], s66 offen offset:0
    buffer_load_ushort v41, v241, s[84:87], s66 offen offset:64
    buffer_load_ushort v42, v241, s[84:87], s66 offen offset:256
    buffer_load_ushort v43, v241, s[84:87], s66 offen offset:320
    buffer_load_ushort v44, v241, s[84:87], s66 offen offset:512
    buffer_load_ushort v45, v241, s[84:87], s66 offen offset:576
    buffer_load_ushort v46, v241, s[84:87], s66 offen offset:768
    buffer_load_ushort v47, v241, s[84:87], s66 offen offset:832
    buffer_load_ushort v48, v241, s[84:87], s66 offen offset:1024
    buffer_load_ushort v49, v241, s[84:87], s66 offen offset:1088
    s_waitcnt vmcnt(0)
    s_mov_b32 s66, 6400
    buffer_load_ushort v50, v241, s[84:87], s66 offen offset:0
    buffer_load_ushort v51, v241, s[84:87], s66 offen offset:64
    buffer_load_ushort v52, v241, s[84:87], s66 offen offset:256
    buffer_load_ushort v53, v241, s[84:87], s66 offen offset:320
    buffer_load_ushort v54, v241, s[84:87], s66 offen offset:512
    buffer_load_ushort v55, v241, s[84:87], s66 offen offset:576
    buffer_load_ushort v56, v241, s[84:87], s66 offen offset:768
    buffer_load_ushort v57, v241, s[84:87], s66 offen offset:832
    buffer_load_ushort v58, v241, s[84:87], s66 offen offset:1024
    buffer_load_ushort v59, v241, s[84:87], s66 offen offset:1088
    s_waitcnt vmcnt(0)
    s_mov_b32 s66, 7680
    buffer_load_ushort v60, v241, s[84:87], s66 offen offset:0
    buffer_load_ushort v61, v241, s[84:87], s66 offen offset:64
    buffer_load_ushort v62, v241, s[84:87], s66 offen offset:256
    buffer_load_ushort v63, v241, s[84:87], s66 offen offset:320
    buffer_load_ushort v64, v241, s[84:87], s66 offen offset:512
    buffer_load_ushort v65, v241, s[84:87], s66 offen offset:576
    buffer_load_ushort v66, v241, s[84:87], s66 offen offset:768
    buffer_load_ushort v67, v241, s[84:87], s66 offen offset:832
    buffer_load_ushort v68, v241, s[84:87], s66 offen offset:1024
    buffer_load_ushort v69, v241, s[84:87], s66 offen offset:1088
    s_waitcnt vmcnt(0)
    s_mov_b32 s66, 8960
    buffer_load_ushort v70, v241, s[84:87], s66 offen offset:0
    buffer_load_ushort v71, v241, s[84:87], s66 offen offset:64
    buffer_load_ushort v72, v241, s[84:87], s66 offen offset:256
    buffer_load_ushort v73, v241, s[84:87], s66 offen offset:320
    buffer_load_ushort v74, v241, s[84:87], s66 offen offset:512
    buffer_load_ushort v75, v241, s[84:87], s66 offen offset:576
    buffer_load_ushort v76, v241, s[84:87], s66 offen offset:768
    buffer_load_ushort v77, v241, s[84:87], s66 offen offset:832
    buffer_load_ushort v78, v241, s[84:87], s66 offen offset:1024
    buffer_load_ushort v79, v241, s[84:87], s66 offen offset:1088
    s_waitcnt vmcnt(0)
    s_mov_b32 s66, 10240
    buffer_load_ushort v80, v241, s[84:87], s66 offen offset:0
    buffer_load_ushort v81, v241, s[84:87], s66 offen offset:64
    buffer_load_ushort v82, v241, s[84:87], s66 offen offset:256
    buffer_load_ushort v83, v241, s[84:87], s66 offen offset:320
    buffer_load_ushort v84, v241, s[84:87], s66 offen offset:512
    buffer_load_ushort v85, v241, s[84:87], s66 offen offset:576
    buffer_load_ushort v86, v241, s[84:87], s66 offen offset:768
    buffer_load_ushort v87, v241, s[84:87], s66 offen offset:832
    buffer_load_ushort v88, v241, s[84:87], s66 offen offset:1024
    buffer_load_ushort v89, v241, s[84:87], s66 offen offset:1088
    s_waitcnt vmcnt(0)
    s_mov_b32 s66, 11520
    buffer_load_ushort v90, v241, s[84:87], s66 offen offset:0
    buffer_load_ushort v91, v241, s[84:87], s66 offen offset:64
    buffer_load_ushort v92, v241, s[84:87], s66 offen offset:256
    buffer_load_ushort v93, v241, s[84:87], s66 offen offset:320
    buffer_load_ushort v94, v241, s[84:87], s66 offen offset:512
    buffer_load_ushort v95, v241, s[84:87], s66 offen offset:576
    buffer_load_ushort v96, v241, s[84:87], s66 offen offset:768
    buffer_load_ushort v97, v241, s[84:87], s66 offen offset:832
    buffer_load_ushort v98, v241, s[84:87], s66 offen offset:1024
    buffer_load_ushort v99, v241, s[84:87], s66 offen offset:1088
    s_waitcnt vmcnt(0)
    s_mov_b32 s66, 12800
    buffer_load_ushort v100, v241, s[84:87], s66 offen offset:0
    buffer_load_ushort v101, v241, s[84:87], s66 offen offset:64
    buffer_load_ushort v102, v241, s[84:87], s66 offen offset:256
    buffer_load_ushort v103, v241, s[84:87], s66 offen offset:320
    buffer_load_ushort v104, v241, s[84:87], s66 offen offset:512
    buffer_load_ushort v105, v241, s[84:87], s66 offen offset:576
    buffer_load_ushort v106, v241, s[84:87], s66 offen offset:768
    buffer_load_ushort v107, v241, s[84:87], s66 offen offset:832
    buffer_load_ushort v108, v241, s[84:87], s66 offen offset:1024
    buffer_load_ushort v109, v241, s[84:87], s66 offen offset:1088
    s_waitcnt vmcnt(0)
    s_mov_b32 s66, 14080
    buffer_load_ushort v110, v241, s[84:87], s66 offen offset:0
    buffer_load_ushort v111, v241, s[84:87], s66 offen offset:64
    buffer_load_ushort v112, v241, s[84:87], s66 offen offset:256
    buffer_load_ushort v113, v241, s[84:87], s66 offen offset:320
    buffer_load_ushort v114, v241, s[84:87], s66 offen offset:512
    buffer_load_ushort v115, v241, s[84:87], s66 offen offset:576
    buffer_load_ushort v116, v241, s[84:87], s66 offen offset:768
    buffer_load_ushort v117, v241, s[84:87], s66 offen offset:832
    buffer_load_ushort v118, v241, s[84:87], s66 offen offset:1024
    buffer_load_ushort v119, v241, s[84:87], s66 offen offset:1088
    s_waitcnt vmcnt(0)
    s_mov_b32 s66, 15360
    buffer_load_ushort v120, v241, s[84:87], s66 offen offset:0
    buffer_load_ushort v121, v241, s[84:87], s66 offen offset:64
    buffer_load_ushort v122, v241, s[84:87], s66 offen offset:256
    buffer_load_ushort v123, v241, s[84:87], s66 offen offset:320
    buffer_load_ushort v124, v241, s[84:87], s66 offen offset:512
    buffer_load_ushort v125, v241, s[84:87], s66 offen offset:576
    buffer_load_ushort v126, v241, s[84:87], s66 offen offset:768
    buffer_load_ushort v127, v241, s[84:87], s66 offen offset:832
    buffer_load_ushort v128, v241, s[84:87], s66 offen offset:1024
    buffer_load_ushort v129, v241, s[84:87], s66 offen offset:1088
    s_waitcnt vmcnt(0)
    s_mov_b32 s66, 16640
    buffer_load_ushort v130, v241, s[84:87], s66 offen offset:0
    buffer_load_ushort v131, v241, s[84:87], s66 offen offset:64
    buffer_load_ushort v132, v241, s[84:87], s66 offen offset:256
    buffer_load_ushort v133, v241, s[84:87], s66 offen offset:320
    buffer_load_ushort v134, v241, s[84:87], s66 offen offset:512
    buffer_load_ushort v135, v241, s[84:87], s66 offen offset:576
    buffer_load_ushort v136, v241, s[84:87], s66 offen offset:768
    buffer_load_ushort v137, v241, s[84:87], s66 offen offset:832
    buffer_load_ushort v138, v241, s[84:87], s66 offen offset:1024
    buffer_load_ushort v139, v241, s[84:87], s66 offen offset:1088
    s_waitcnt vmcnt(0)
    s_mov_b32 s66, 17920
    buffer_load_ushort v140, v241, s[84:87], s66 offen offset:0
    buffer_load_ushort v141, v241, s[84:87], s66 offen offset:64
    buffer_load_ushort v142, v241, s[84:87], s66 offen offset:256
    buffer_load_ushort v143, v241, s[84:87], s66 offen offset:320
    buffer_load_ushort v144, v241, s[84:87], s66 offen offset:512
    buffer_load_ushort v145, v241, s[84:87], s66 offen offset:576
    buffer_load_ushort v146, v241, s[84:87], s66 offen offset:768
    buffer_load_ushort v147, v241, s[84:87], s66 offen offset:832
    buffer_load_ushort v148, v241, s[84:87], s66 offen offset:1024
    buffer_load_ushort v149, v241, s[84:87], s66 offen offset:1088
    s_waitcnt vmcnt(0)
    s_mov_b32 s66, 19200
    buffer_load_ushort v150, v241, s[84:87], s66 offen offset:0
    buffer_load_ushort v151, v241, s[84:87], s66 offen offset:64
    buffer_load_ushort v152, v241, s[84:87], s66 offen offset:256
    buffer_load_ushort v153, v241, s[84:87], s66 offen offset:320
    buffer_load_ushort v154, v241, s[84:87], s66 offen offset:512
    buffer_load_ushort v155, v241, s[84:87], s66 offen offset:576
    buffer_load_ushort v156, v241, s[84:87], s66 offen offset:768
    buffer_load_ushort v157, v241, s[84:87], s66 offen offset:832
    buffer_load_ushort v158, v241, s[84:87], s66 offen offset:1024
    buffer_load_ushort v159, v241, s[84:87], s66 offen offset:1088
    s_waitcnt vmcnt(0)
    v_lshlrev_b32 v0, 16, v0
    v_lshlrev_b32 v1, 16, v1
    v_lshlrev_b32 v2, 16, v2
    v_lshlrev_b32 v3, 16, v3
    v_lshlrev_b32 v4, 16, v4
    v_lshlrev_b32 v5, 16, v5
    v_lshlrev_b32 v6, 16, v6
    v_lshlrev_b32 v7, 16, v7
    v_lshlrev_b32 v8, 16, v8
    v_lshlrev_b32 v9, 16, v9
    v_lshlrev_b32 v10, 16, v10
    v_lshlrev_b32 v11, 16, v11
    v_lshlrev_b32 v12, 16, v12
    v_lshlrev_b32 v13, 16, v13
    v_lshlrev_b32 v14, 16, v14
    v_lshlrev_b32 v15, 16, v15
    v_lshlrev_b32 v16, 16, v16
    v_lshlrev_b32 v17, 16, v17
    v_lshlrev_b32 v18, 16, v18
    v_lshlrev_b32 v19, 16, v19
    v_lshlrev_b32 v20, 16, v20
    v_lshlrev_b32 v21, 16, v21
    v_lshlrev_b32 v22, 16, v22
    v_lshlrev_b32 v23, 16, v23
    v_lshlrev_b32 v24, 16, v24
    v_lshlrev_b32 v25, 16, v25
    v_lshlrev_b32 v26, 16, v26
    v_lshlrev_b32 v27, 16, v27
    v_lshlrev_b32 v28, 16, v28
    v_lshlrev_b32 v29, 16, v29
    v_lshlrev_b32 v30, 16, v30
    v_lshlrev_b32 v31, 16, v31
    v_lshlrev_b32 v32, 16, v32
    v_lshlrev_b32 v33, 16, v33
    v_lshlrev_b32 v34, 16, v34
    v_lshlrev_b32 v35, 16, v35
    v_lshlrev_b32 v36, 16, v36
    v_lshlrev_b32 v37, 16, v37
    v_lshlrev_b32 v38, 16, v38
    v_lshlrev_b32 v39, 16, v39
    v_lshlrev_b32 v40, 16, v40
    v_lshlrev_b32 v41, 16, v41
    v_lshlrev_b32 v42, 16, v42
    v_lshlrev_b32 v43, 16, v43
    v_lshlrev_b32 v44, 16, v44
    v_lshlrev_b32 v45, 16, v45
    v_lshlrev_b32 v46, 16, v46
    v_lshlrev_b32 v47, 16, v47
    v_lshlrev_b32 v48, 16, v48
    v_lshlrev_b32 v49, 16, v49
    v_lshlrev_b32 v50, 16, v50
    v_lshlrev_b32 v51, 16, v51
    v_lshlrev_b32 v52, 16, v52
    v_lshlrev_b32 v53, 16, v53
    v_lshlrev_b32 v54, 16, v54
    v_lshlrev_b32 v55, 16, v55
    v_lshlrev_b32 v56, 16, v56
    v_lshlrev_b32 v57, 16, v57
    v_lshlrev_b32 v58, 16, v58
    v_lshlrev_b32 v59, 16, v59
    v_lshlrev_b32 v60, 16, v60
    v_lshlrev_b32 v61, 16, v61
    v_lshlrev_b32 v62, 16, v62
    v_lshlrev_b32 v63, 16, v63
    v_lshlrev_b32 v64, 16, v64
    v_lshlrev_b32 v65, 16, v65
    v_lshlrev_b32 v66, 16, v66
    v_lshlrev_b32 v67, 16, v67
    v_lshlrev_b32 v68, 16, v68
    v_lshlrev_b32 v69, 16, v69
    v_lshlrev_b32 v70, 16, v70
    v_lshlrev_b32 v71, 16, v71
    v_lshlrev_b32 v72, 16, v72
    v_lshlrev_b32 v73, 16, v73
    v_lshlrev_b32 v74, 16, v74
    v_lshlrev_b32 v75, 16, v75
    v_lshlrev_b32 v76, 16, v76
    v_lshlrev_b32 v77, 16, v77
    v_lshlrev_b32 v78, 16, v78
    v_lshlrev_b32 v79, 16, v79
    v_lshlrev_b32 v80, 16, v80
    v_lshlrev_b32 v81, 16, v81
    v_lshlrev_b32 v82, 16, v82
    v_lshlrev_b32 v83, 16, v83
    v_lshlrev_b32 v84, 16, v84
    v_lshlrev_b32 v85, 16, v85
    v_lshlrev_b32 v86, 16, v86
    v_lshlrev_b32 v87, 16, v87
    v_lshlrev_b32 v88, 16, v88
    v_lshlrev_b32 v89, 16, v89
    v_lshlrev_b32 v90, 16, v90
    v_lshlrev_b32 v91, 16, v91
    v_lshlrev_b32 v92, 16, v92
    v_lshlrev_b32 v93, 16, v93
    v_lshlrev_b32 v94, 16, v94
    v_lshlrev_b32 v95, 16, v95
    v_lshlrev_b32 v96, 16, v96
    v_lshlrev_b32 v97, 16, v97
    v_lshlrev_b32 v98, 16, v98
    v_lshlrev_b32 v99, 16, v99
    v_lshlrev_b32 v100, 16, v100
    v_lshlrev_b32 v101, 16, v101
    v_lshlrev_b32 v102, 16, v102
    v_lshlrev_b32 v103, 16, v103
    v_lshlrev_b32 v104, 16, v104
    v_lshlrev_b32 v105, 16, v105
    v_lshlrev_b32 v106, 16, v106
    v_lshlrev_b32 v107, 16, v107
    v_lshlrev_b32 v108, 16, v108
    v_lshlrev_b32 v109, 16, v109
    v_lshlrev_b32 v110, 16, v110
    v_lshlrev_b32 v111, 16, v111
    v_lshlrev_b32 v112, 16, v112
    v_lshlrev_b32 v113, 16, v113
    v_lshlrev_b32 v114, 16, v114
    v_lshlrev_b32 v115, 16, v115
    v_lshlrev_b32 v116, 16, v116
    v_lshlrev_b32 v117, 16, v117
    v_lshlrev_b32 v118, 16, v118
    v_lshlrev_b32 v119, 16, v119
    v_lshlrev_b32 v120, 16, v120
    v_lshlrev_b32 v121, 16, v121
    v_lshlrev_b32 v122, 16, v122
    v_lshlrev_b32 v123, 16, v123
    v_lshlrev_b32 v124, 16, v124
    v_lshlrev_b32 v125, 16, v125
    v_lshlrev_b32 v126, 16, v126
    v_lshlrev_b32 v127, 16, v127
    v_lshlrev_b32 v128, 16, v128
    v_lshlrev_b32 v129, 16, v129
    v_lshlrev_b32 v130, 16, v130
    v_lshlrev_b32 v131, 16, v131
    v_lshlrev_b32 v132, 16, v132
    v_lshlrev_b32 v133, 16, v133
    v_lshlrev_b32 v134, 16, v134
    v_lshlrev_b32 v135, 16, v135
    v_lshlrev_b32 v136, 16, v136
    v_lshlrev_b32 v137, 16, v137
    v_lshlrev_b32 v138, 16, v138
    v_lshlrev_b32 v139, 16, v139
    v_lshlrev_b32 v140, 16, v140
    v_lshlrev_b32 v141, 16, v141
    v_lshlrev_b32 v142, 16, v142
    v_lshlrev_b32 v143, 16, v143
    v_lshlrev_b32 v144, 16, v144
    v_lshlrev_b32 v145, 16, v145
    v_lshlrev_b32 v146, 16, v146
    v_lshlrev_b32 v147, 16, v147
    v_lshlrev_b32 v148, 16, v148
    v_lshlrev_b32 v149, 16, v149
    v_lshlrev_b32 v150, 16, v150
    v_lshlrev_b32 v151, 16, v151
    v_lshlrev_b32 v152, 16, v152
    v_lshlrev_b32 v153, 16, v153
    v_lshlrev_b32 v154, 16, v154
    v_lshlrev_b32 v155, 16, v155
    v_lshlrev_b32 v156, 16, v156
    v_lshlrev_b32 v157, 16, v157
    v_lshlrev_b32 v158, 16, v158
    v_lshlrev_b32 v159, 16, v159
    s_mov_b32 s50, 0
SL_node:
    s_mul_i32 s34, s2, 40
    s_lshl_b32 s66, s50, 3
    s_add_u32 s66, s66, s20
    s_add_u32 s34, s34, s66
    v_mov_b32 v160, 0
    v_mov_b32 v161, 0
    v_mov_b32 v162, 0
    v_mov_b32 v163, 0
    v_mov_b32 v164, 0
    v_mov_b32 v165, 0
    v_mov_b32 v166, 0
    v_mov_b32 v167, 0
    v_mov_b32 v168, 0
    v_mov_b32 v169, 0
    v_mov_b32 v170, 0
    v_mov_b32 v171, 0
    v_mov_b32 v172, 0
    v_mov_b32 v173, 0
    v_mov_b32 v174, 0
    v_mov_b32 v175, 0
    v_mov_b32 v176, 0
    v_mov_b32 v177, 0
    v_mov_b32 v178, 0
    v_mov_b32 v179, 0
    v_mov_b32 v180, 0
    v_mov_b32 v181, 0
    s_mov_b32 s35, 0
SL_scan:
    s_lshl_b32 s66, s35, 2
    buffer_load_dwordx4 v[236:239], v245, s[72:75], s66 offen
    s_waitcnt vmcnt(0)
    v_cmp_eq_u32 s[38:39], s34, v236
    v_cmp_eq_u32 s[40:41], s34, v237
    v_cmp_eq_u32 s[42:43], s34, v238
    v_cmp_eq_u32 s[44:45], s34, v239
    s_mov_b32 s36, 0
SL_bits:
    s_cmp_eq_u64 s[38:39], 0
    s_cbranch_scc1 SL_nexti
    s_ff1_i32_b64 s66, s[38:39]
    s_bitset0_b64 s[38:39], s66
    s_lshl_b32 s66, s66, 2
    s_add_u32 s37, s66, s36
    s_add_u32 s37, s37, s35
    s_lshl_b32 s66, s37, 2
    s_lshl_b32 s67, s37, 5
    s_mul_i32 s68, s37, 6
    buffer_load_dword v243, v242, s[76:79], s66 offen
    buffer_load_dwordx4 v[184:187], v242, s[12:15], s67 offen
    buffer_load_dwordx4 v[188:191], v242, s[12:15], s67 offen offset:16
    buffer_load_ushort v226, v242, s[80:83], s68 offen offset:0
    buffer_load_ushort v227, v242, s[80:83], s68 offen offset:2
    buffer_load_ushort v228, v242, s[80:83], s68 offen offset:4
    s_waitcnt vmcnt(5)
    v_lshl_add_u32 v243, v243, 10, v241
    buffer_load_ushort v208, v243, s[4:7], 0 offen offset:0
    buffer_load_ushort v209, v243, s[4:7], 0 offen offset:64
    buffer_load_ushort v210, v243, s[4:7], 0 offen offset:256
    buffer_load_ushort v211, v243, s[4:7], 0 offen offset:320
    buffer_load_ushort v212, v243, s[4:7], 0 offen offset:512
    buffer_load_ushort v213, v243, s[4:7], 0 offen offset:576
    buffer_load_ushort v214, v243, s[4:7], 0 offen offset:768
    buffer_load_ushort v215, v243, s[4:7], 0 offen offset:832
    s_waitcnt vmcnt(8)
    v_lshlrev_b32 v192, 16, v184
    v_and_b32 v193, 0xffff0000, v184
    v_lshlrev_b32 v194, 16, v185
    v_and_b32 v195, 0xffff0000, v185
    v_lshlrev_b32 v196, 16, v186
    v_and_b32 v197, 0xffff0000, v186
    v_lshlrev_b32 v198, 16, v187
    v_and_b32 v199, 0xffff0000, v187
    v_lshlrev_b32 v200, 16, v188
    v_and_b32 v201, 0xffff0000, v188
    v_lshlrev_b32 v202, 16, v189
    v_and_b32 v203, 0xffff0000, v189
    v_lshlrev_b32 v204, 16, v190
    v_and_b32 v205, 0xffff0000, v190
    v_lshlrev_b32 v206, 16, v191
    v_and_b32 v207, 0xffff0000, v191
    v_lshlrev_b32 v226, 16, v226
    v_lshlrev_b32 v227, 16, v227
    v_lshlrev_b32 v228, 16, v228
    v_mul_f32 v216, v192, v0
    v_mul_f32 v217, v192, v1
    v_mul_f32 v218, v192, v2
    v_mul_f32 v219, v192, v3
    v_mul_f32 v220, v192, v4
    v_mul_f32 v221, v192, v5
    v_mul_f32 v222, v192, v6
    v_mul_f32 v223, v192, v7
    v_mul_f32 v224, v192, v8
    v_mul_f32 v225, v192, v9
    v_fmac_f32 v216, v193, v10
    v_fmac_f32 v217, v193, v11
    v_fmac_f32 v218, v193, v12
    v_fmac_f32 v219, v193, v13
    v_fmac_f32 v220, v193, v14
    v_fmac_f32 v221, v193, v15
    v_fmac_f32 v222, v193, v16
    v_fmac_f32 v223, v193, v17
    v_fmac_f32 v224, v193, v18
    v_fmac_f32 v225, v193, v19
    v_fmac_f32 v216, v194, v20
    v_fmac_f32 v217, v194, v21
    v_fmac_f32 v218, v194, v22
    v_fmac_f32 v219, v194, v23
    v_fmac_f32 v220, v194, v24
    v_fmac_f32 v221, v194, v25
    v_fmac_f32 v222, v194, v26
    v_fmac_f32 v223, v194, v27
    v_fmac_f32 v224, v194, v28
    v_fmac_f32 v225, v194, v29
    v_fmac_f32 v216, v195, v30
    v_fmac_f32 v217, v195, v31
    v_fmac_f32 v218, v195, v32
    v_fmac_f32 v219, v195, v33
    v_fmac_f32 v220, v195, v34
    v_fmac_f32 v221, v195, v35
    v_fmac_f32 v222, v195, v36
    v_fmac_f32 v223, v195, v37
    v_fmac_f32 v224, v195, v38
    v_fmac_f32 v225, v195, v39
    v_fmac_f32 v216, v196, v40
    v_fmac_f32 v217, v196, v41
    v_fmac_f32 v218, v196, v42
    v_fmac_f32 v219, v196, v43
    v_fmac_f32 v220, v196, v44
    v_fmac_f32 v221, v196, v45
    v_fmac_f32 v222, v196, v46
    v_fmac_f32 v223, v196, v47
    v_fmac_f32 v224, v196, v48
    v_fmac_f32 v225, v196, v49
    v_fmac_f32 v216, v197, v50
    v_fmac_f32 v217, v197, v51
    v_fmac_f32 v218, v197, v52
    v_fmac_f32 v219, v197, v53
    v_fmac_f32 v220, v197, v54
    v_fmac_f32 v221, v197, v55
    v_fmac_f32 v222, v197, v56
    v_fmac_f32 v223, v197, v57
    v_fmac_f32 v224, v197, v58
    v_fmac_f32 v225, v197, v59
    v_fmac_f32 v216, v198, v60
    v_fmac_f32 v217, v198, v61
    v_fmac_f32 v218, v198, v62
    v_fmac_f32 v219, v198, v63
    v_fmac_f32 v220, v198, v64
    v_fmac_f32 v221, v198, v65
    v_fmac_f32 v222, v198, v66
    v_fmac_f32 v223, v198, v67
    v_fmac_f32 v224, v198, v68
    v_fmac_f32 v225, v198, v69
    v_fmac_f32 v216, v199, v70
    v_fmac_f32 v217, v199, v71
    v_fmac_f32 v218, v199, v72
    v_fmac_f32 v219, v199, v73
    v_fmac_f32 v220, v199, v74
    v_fmac_f32 v221, v199, v75
    v_fmac_f32 v222, v199, v76
    v_fmac_f32 v223, v199, v77
    v_fmac_f32 v224, v199, v78
    v_fmac_f32 v225, v199, v79
    v_fmac_f32 v216, v200, v80
    v_fmac_f32 v217, v200, v81
    v_fmac_f32 v218, v200, v82
    v_fmac_f32 v219, v200, v83
    v_fmac_f32 v220, v200, v84
    v_fmac_f32 v221, v200, v85
    v_fmac_f32 v222, v200, v86
    v_fmac_f32 v223, v200, v87
    v_fmac_f32 v224, v200, v88
    v_fmac_f32 v225, v200, v89
    v_fmac_f32 v216, v201, v90
    v_fmac_f32 v217, v201, v91
    v_fmac_f32 v218, v201, v92
    v_fmac_f32 v219, v201, v93
    v_fmac_f32 v220, v201, v94
    v_fmac_f32 v221, v201, v95
    v_fmac_f32 v222, v201, v96
    v_fmac_f32 v223, v201, v97
    v_fmac_f32 v224, v201, v98
    v_fmac_f32 v225, v201, v99
    v_fmac_f32 v216, v202, v100
    v_fmac_f32 v217, v202, v101
    v_fmac_f32 v218, v202, v102
    v_fmac_f32 v219, v202, v103
    v_fmac_f32 v220, v202, v104
    v_fmac_f32 v221, v202, v105
    v_fmac_f32 v222, v202, v106
    v_fmac_f32 v223, v202, v107
    v_fmac_f32 v224, v202, v108
    v_fmac_f32 v225, v202, v109
    v_fmac_f32 v216, v203, v110
    v_fmac_f32 v217, v203, v111
    v_fmac_f32 v218, v203, v112
    v_fmac_f32 v219, v203, v113
    v_fmac_f32 v220, v203, v114
    v_fmac_f32 v221, v203, v115
    v_fmac_f32 v222, v203, v116
    v_fmac_f32 v223, v203, v117
    v_fmac_f32 v224, v203, v118
    v_fmac_f32 v225, v203, v119
    v_fmac_f32 v216, v204, v120
    v_fmac_f32 v217, v204, v121
    v_fmac_f32 v218, v204, v122
    v_fmac_f32 v219, v204, v123
    v_fmac_f32 v220, v204, v124
    v_fmac_f32 v221, v204, v125
    v_fmac_f32 v222, v204, v126
    v_fmac_f32 v223, v204, v127
    v_fmac_f32 v224, v204, v128
    v_fmac_f32 v225, v204, v129
    v_fmac_f32 v216, v205, v130
    v_fmac_f32 v217, v205, v131
    v_fmac_f32 v218, v205, v132
    v_fmac_f32 v219, v205, v133
    v_fmac_f32 v220, v205, v134
    v_fmac_f32 v221, v205, v135
    v_fmac_f32 v222, v205, v136
    v_fmac_f32 v223, v205, v137
    v_fmac_f32 v224, v205, v138
    v_fmac_f32 v225, v205, v139
    v_fmac_f32 v216, v206, v140
    v_fmac_f32 v217, v206, v141
    v_fmac_f32 v218, v206, v142
    v_fmac_f32 v219, v206, v143
    v_fmac_f32 v220, v206, v144
    v_fmac_f32 v221, v206, v145
    v_fmac_f32 v222, v206, v146
    v_fmac_f32 v223, v206, v147
    v_fmac_f32 v224, v206, v148
    v_fmac_f32 v225, v206, v149
    v_fmac_f32 v216, v207, v150
    v_fmac_f32 v217, v207, v151
    v_fmac_f32 v218, v207, v152
    v_fmac_f32 v219, v207, v153
    v_fmac_f32 v220, v207, v154
    v_fmac_f32 v221, v207, v155
    v_fmac_f32 v222, v207, v156
    v_fmac_f32 v223, v207, v157
    v_fmac_f32 v224, v207, v158
    v_fmac_f32 v225, v207, v159
    s_waitcnt vmcnt(0)
    v_lshlrev_b32 v208, 16, v208
    v_lshlrev_b32 v209, 16, v209
    v_lshlrev_b32 v210, 16, v210
    v_lshlrev_b32 v211, 16, v211
    v_lshlrev_b32 v212, 16, v212
    v_lshlrev_b32 v213, 16, v213
    v_lshlrev_b32 v214, 16, v214
    v_lshlrev_b32 v215, 16, v215
    v_fmac_f32 v160, v208, v216
    v_mul_f32 v229, v210, v226
    v_fmac_f32 v229, v212, v227
    v_fmac_f32 v229, v214, v228
    v_fmac_f32 v176, v229, v218
    v_mul_f32 v229, v208, v220
    v_fmac_f32 v162, v229, v226
    v_fmac_f32 v168, v210, v222
    v_mul_f32 v230, v227, v214
    v_fma_f32 v230, -v228, v212, v230
    v_fmac_f32 v178, v230, v224
    v_fmac_f32 v164, v229, v227
    v_fmac_f32 v170, v212, v222
    v_mul_f32 v230, v228, v210
    v_fma_f32 v230, -v226, v214, v230
    v_fmac_f32 v180, v230, v224
    v_fmac_f32 v166, v229, v228
    v_fmac_f32 v172, v214, v222
    v_mul_f32 v230, v226, v212
    v_fma_f32 v230, -v227, v210, v230
    v_fmac_f32 v174, v230, v224
    v_fmac_f32 v161, v209, v217
    v_mul_f32 v229, v211, v226
    v_fmac_f32 v229, v213, v227
    v_fmac_f32 v229, v215, v228
    v_fmac_f32 v177, v229, v219
    v_mul_f32 v229, v209, v221
    v_fmac_f32 v163, v229, v226
    v_fmac_f32 v169, v211, v223
    v_mul_f32 v230, v227, v215
    v_fma_f32 v230, -v228, v213, v230
    v_fmac_f32 v179, v230, v225
    v_fmac_f32 v165, v229, v227
    v_fmac_f32 v171, v213, v223
    v_mul_f32 v230, v228, v211
    v_fma_f32 v230, -v226, v215, v230
    v_fmac_f32 v181, v230, v225
    v_fmac_f32 v167, v229, v228
    v_fmac_f32 v173, v215, v223
    v_mul_f32 v230, v226, v213
    v_fma_f32 v230, -v227, v211, v230
    v_fmac_f32 v175, v230, v225
    s_branch SL_bits
SL_nexti:
    s_mov_b64 s[38:39], s[40:41]
    s_mov_b64 s[40:41], s[42:43]
    s_mov_b64 s[42:43], s[44:45]
    s_add_u32 s36, s36, 1
    s_cmp_lt_u32 s36, 4
    s_cbranch_scc1 SL_bits
    s_add_u32 s35, s35, 256
    s_cmp_lt_u32 s35, 320000
    s_cbranch_scc1 SL_scan
    s_lshl_b32 s66, s50, 3
    s_add_u32 s66, s66, s20
    s_lshl_b32 s67, s66, 4
    s_and_b32 s68, s67, 128
    s_and_b32 s67, s67, 0x70
    s_mul_i32 s69, s50, 1536
    s_add_u32 s69, s69, s21
    s_add_u32 s69, s69, s68
    s_mul_i32 s70, s66, 1536
    s_add_u32 s70, s70, 86016
    s_add_u32 s70, s70, s68
    v_mov_b32 v230, s69
    v_mov_b32 v231, s70
    v_cmp_gt_u32 vcc, 32, v240
    v_and_b32 v229, 31, v240
    v_lshlrev_b32 v229, 2, v229
    v_xor_b32 v229, s67, v229
    v_cndmask_b32 v244, v231, v230, vcc
    v_add_u32 v244, v244, v229
    v_cvt_pk_bf16_f32 v160, v160, v161
    ds_write_b32 v244, v160 offset:0
    v_cvt_pk_bf16_f32 v162, v162, v163
    ds_write_b32 v244, v162 offset:128
    v_cvt_pk_bf16_f32 v164, v164, v165
    ds_write_b32 v244, v164 offset:256
    v_cvt_pk_bf16_f32 v166, v166, v167
    ds_write_b32 v244, v166 offset:384
    v_cvt_pk_bf16_f32 v168, v168, v169
    ds_write_b32 v244, v168 offset:512
    v_cvt_pk_bf16_f32 v170, v170, v171
    ds_write_b32 v244, v170 offset:640
    v_cvt_pk_bf16_f32 v172, v172, v173
    ds_write_b32 v244, v172 offset:768
    v_cvt_pk_bf16_f32 v174, v174, v175
    ds_write_b32 v244, v174 offset:896
    v_cvt_pk_bf16_f32 v176, v176, v177
    ds_write_b32 v244, v176 offset:1024
    v_cvt_pk_bf16_f32 v178, v178, v179
    ds_write_b32 v244, v178 offset:1152
    v_cvt_pk_bf16_f32 v180, v180, v181
    ds_write_b32 v244, v180 offset:1280
    s_lshl_b32 s66, s66, 3
    s_add_u32 s66, s66, 163328
    v_mov_b32 v229, s66
    ds_write_b64 v229, v[230:231]
    s_add_u32 s50, s50, 1
    s_cmp_lt_u32 s50, 5
    s_cbranch_scc1 SL_node
    s_waitcnt lgkmcnt(0)
    s_barrier
    v_mov_b32 v176, v240
    s_load_dwordx4 s[84:87], s[0:1], 48
    s_mul_i32 s22, s20, 20
    s_waitcnt lgkmcnt(0)
    s_mul_i32 s24, s22, 3277
    s_lshr_b32 s24, s24, 16
    s_mul_i32 s68, s24, 20
    s_sub_u32 s68, s22, s68
    s_cmp_lt_u32 s68, 8
    s_cselect_b64 s[66:67], s[84:85], s[86:87]
    s_cselect_b32 s25, 0, 8
    s_sub_u32 s68, s68, s25
    s_and_b32 s25, s68, 1
    s_lshr_b32 s68, s68, 1
    s_lshl_b32 s68, s68, 14
    s_lshl_b32 s25, s25, 12
    s_add_u32 s68, s68, s25
    s_lshl_b32 s24, s24, 5
    s_add_u32 s68, s68, s24
    v_lshrrev_b32 v2, 4, v176
    v_lshlrev_b32 v2, 10, v2
    v_and_b32 v3, 15, v176
    v_lshl_add_u32 v2, v3, 1, v2
    v_add_u32 v2, s68, v2
    v_add_u32 v3, 8192, v2
    v_mov_b32 v4, 0
    v_mov_b32 v5, 0
    v_mov_b32 v6, 0
    v_mov_b32 v7, 0
    global_load_ushort v144, v2, s[66:67] offset:0
    global_load_short_d16_hi v4, v3, s[66:67] offset:0
    global_load_ushort v145, v2, s[66:67] offset:256
    global_load_short_d16_hi v5, v3, s[66:67] offset:256
    global_load_ushort v146, v2, s[66:67] offset:512
    global_load_short_d16_hi v6, v3, s[66:67] offset:512
    global_load_ushort v147, v2, s[66:67] offset:768
    global_load_short_d16_hi v7, v3, s[66:67] offset:768
    s_add_u32 s22, s22, 1
    s_waitcnt vmcnt(0)
    v_or_b32 v144, v144, v4
    v_or_b32 v145, v145, v5
    v_or_b32 v146, v146, v6
    v_or_b32 v147, v147, v7
    s_mul_i32 s24, s22, 3277
    s_lshr_b32 s24, s24, 16
    s_mul_i32 s68, s24, 20
    s_sub_u32 s68, s22, s68
    s_cmp_lt_u32 s68, 8
    s_cselect_b64 s[66:67], s[84:85], s[86:87]
    s_cselect_b32 s25, 0, 8
    s_sub_u32 s68, s68, s25
    s_and_b32 s25, s68, 1
    s_lshr_b32 s68, s68, 1
    s_lshl_b32 s68, s68, 14
    s_lshl_b32 s25, s25, 12
    s_add_u32 s68, s68, s25
    s_lshl_b32 s24, s24, 5
    s_add_u32 s68, s68, s24
    v_lshrrev_b32 v2, 4, v176
    v_lshlrev_b32 v2, 10, v2
    v_and_b32 v3, 15, v176
    v_lshl_add_u32 v2, v3, 1, v2
    v_add_u32 v2, s68, v2
    v_add_u32 v3, 8192, v2
    v_mov_b32 v4, 0
    v_mov_b32 v5, 0
    v_mov_b32 v6, 0
    v_mov_b32 v7, 0
    global_load_ushort v148, v2, s[66:67] offset:0
    global_load_short_d16_hi v4, v3, s[66:67] offset:0
    global_load_ushort v149, v2, s[66:67] offset:256
    global_load_short_d16_hi v5, v3, s[66:67] offset:256
    global_load_ushort v150, v2, s[66:67] offset:512
    global_load_short_d16_hi v6, v3, s[66:67] offset:512
    global_load_ushort v151, v2, s[66:67] offset:768
    global_load_short_d16_hi v7, v3, s[66:67] offset:768
    s_add_u32 s22, s22, 1
    s_waitcnt vmcnt(0)
    v_or_b32 v148, v148, v4
    v_or_b32 v149, v149, v5
    v_or_b32 v150, v150, v6
    v_or_b32 v151, v151, v7
    s_mul_i32 s24, s22, 3277
    s_lshr_b32 s24, s24, 16
    s_mul_i32 s68, s24, 20
    s_sub_u32 s68, s22, s68
    s_cmp_lt_u32 s68, 8
    s_cselect_b64 s[66:67], s[84:85], s[86:87]
    s_cselect_b32 s25, 0, 8
    s_sub_u32 s68, s68, s25
    s_and_b32 s25, s68, 1
    s_lshr_b32 s68, s68, 1
    s_lshl_b32 s68, s68, 14
    s_lshl_b32 s25, s25, 12
    s_add_u32 s68, s68, s25
    s_lshl_b32 s24, s24, 5
    s_add_u32 s68, s68, s24
    v_lshrrev_b32 v2, 4, v176
    v_lshlrev_b32 v2, 10, v2
    v_and_b32 v3, 15, v176
    v_lshl_add_u32 v2, v3, 1, v2
    v_add_u32 v2, s68, v2
    v_add_u32 v3, 8192, v2
    v_mov_b32 v4, 0
    v_mov_b32 v5, 0
    v_mov_b32 v6, 0
    v_mov_b32 v7, 0
    global_load_ushort v96, v2, s[66:67] offset:0
    global_load_short_d16_hi v4, v3, s[66:67] offset:0
    global_load_ushort v97, v2, s[66:67] offset:256
    global_load_short_d16_hi v5, v3, s[66:67] offset:256
    global_load_ushort v98, v2, s[66:67] offset:512
    global_load_short_d16_hi v6, v3, s[66:67] offset:512
    global_load_ushort v99, v2, s[66:67] offset:768
    global_load_short_d16_hi v7, v3, s[66:67] offset:768
    s_add_u32 s22, s22, 1
    s_waitcnt vmcnt(0)
    v_or_b32 v96, v96, v4
    v_or_b32 v97, v97, v5
    v_or_b32 v98, v98, v6
    v_or_b32 v99, v99, v7
    s_mul_i32 s24, s22, 3277
    s_lshr_b32 s24, s24, 16
    s_mul_i32 s68, s24, 20
    s_sub_u32 s68, s22, s68
    s_cmp_lt_u32 s68, 8
    s_cselect_b64 s[66:67], s[84:85], s[86:87]
    s_cselect_b32 s25, 0, 8
    s_sub_u32 s68, s68, s25
    s_and_b32 s25, s68, 1
    s_lshr_b32 s68, s68, 1
    s_lshl_b32 s68, s68, 14
    s_lshl_b32 s25, s25, 12
    s_add_u32 s68, s68, s25
    s_lshl_b32 s24, s24, 5
    s_add_u32 s68, s68, s24
    v_lshrrev_b32 v2, 4, v176
    v_lshlrev_b32 v2, 10, v2
    v_and_b32 v3, 15, v176
    v_lshl_add_u32 v2, v3, 1, v2
    v_add_u32 v2, s68, v2
    v_add_u32 v3, 8192, v2
    v_mov_b32 v4, 0
    v_mov_b32 v5, 0
    v_mov_b32 v6, 0
    v_mov_b32 v7, 0
    global_load_ushort v100, v2, s[66:67] offset:0
    global_load_short_d16_hi v4, v3, s[66:67] offset:0
    global_load_ushort v101, v2, s[66:67] offset:256
    global_load_short_d16_hi v5, v3, s[66:67] offset:256
    global_load_ushort v102, v2, s[66:67] offset:512
    global_load_short_d16_hi v6, v3, s[66:67] offset:512
    global_load_ushort v103, v2, s[66:67] offset:768
    global_load_short_d16_hi v7, v3, s[66:67] offset:768
    s_add_u32 s22, s22, 1
    s_waitcnt vmcnt(0)
    v_or_b32 v100, v100, v4
    v_or_b32 v101, v101, v5
    v_or_b32 v102, v102, v6
    v_or_b32 v103, v103, v7
    s_mul_i32 s24, s22, 3277
    s_lshr_b32 s24, s24, 16
    s_mul_i32 s68, s24, 20
    s_sub_u32 s68, s22, s68
    s_cmp_lt_u32 s68, 8
    s_cselect_b64 s[66:67], s[84:85], s[86:87]
    s_cselect_b32 s25, 0, 8
    s_sub_u32 s68, s68, s25
    s_and_b32 s25, s68, 1
    s_lshr_b32 s68, s68, 1
    s_lshl_b32 s68, s68, 14
    s_lshl_b32 s25, s25, 12
    s_add_u32 s68, s68, s25
    s_lshl_b32 s24, s24, 5
    s_add_u32 s68, s68, s24
    v_lshrrev_b32 v2, 4, v176
    v_lshlrev_b32 v2, 10, v2
    v_and_b32 v3, 15, v176
    v_lshl_add_u32 v2, v3, 1, v2
    v_add_u32 v2, s68, v2
    v_add_u32 v3, 8192, v2
    v_mov_b32 v4, 0
    v_mov_b32 v5, 0
    v_mov_b32 v6, 0
    v_mov_b32 v7, 0
    global_load_ushort v160, v2, s[66:67] offset:0
    global_load_short_d16_hi v4, v3, s[66:67] offset:0
    global_load_ushort v161, v2, s[66:67] offset:256
    global_load_short_d16_hi v5, v3, s[66:67] offset:256
    global_load_ushort v162, v2, s[66:67] offset:512
    global_load_short_d16_hi v6, v3, s[66:67] offset:512
    global_load_ushort v163, v2, s[66:67] offset:768
    global_load_short_d16_hi v7, v3, s[66:67] offset:768
    s_add_u32 s22, s22, 1
    s_waitcnt vmcnt(0)
    v_or_b32 v160, v160, v4
    v_or_b32 v161, v161, v5
    v_or_b32 v162, v162, v6
    v_or_b32 v163, v163, v7
    s_mul_i32 s24, s22, 3277
    s_lshr_b32 s24, s24, 16
    s_mul_i32 s68, s24, 20
    s_sub_u32 s68, s22, s68
    s_cmp_lt_u32 s68, 8
    s_cselect_b64 s[66:67], s[84:85], s[86:87]
    s_cselect_b32 s25, 0, 8
    s_sub_u32 s68, s68, s25
    s_and_b32 s25, s68, 1
    s_lshr_b32 s68, s68, 1
    s_lshl_b32 s68, s68, 14
    s_lshl_b32 s25, s25, 12
    s_add_u32 s68, s68, s25
    s_lshl_b32 s24, s24, 5
    s_add_u32 s68, s68, s24
    v_lshrrev_b32 v2, 4, v176
    v_lshlrev_b32 v2, 10, v2
    v_and_b32 v3, 15, v176
    v_lshl_add_u32 v2, v3, 1, v2
    v_add_u32 v2, s68, v2
    v_add_u32 v3, 8192, v2
    v_mov_b32 v4, 0
    v_mov_b32 v5, 0
    v_mov_b32 v6, 0
    v_mov_b32 v7, 0
    global_load_ushort v164, v2, s[66:67] offset:0
    global_load_short_d16_hi v4, v3, s[66:67] offset:0
    global_load_ushort v165, v2, s[66:67] offset:256
    global_load_short_d16_hi v5, v3, s[66:67] offset:256
    global_load_ushort v166, v2, s[66:67] offset:512
    global_load_short_d16_hi v6, v3, s[66:67] offset:512
    global_load_ushort v167, v2, s[66:67] offset:768
    global_load_short_d16_hi v7, v3, s[66:67] offset:768
    s_add_u32 s22, s22, 1
    s_waitcnt vmcnt(0)
    v_or_b32 v164, v164, v4
    v_or_b32 v165, v165, v5
    v_or_b32 v166, v166, v6
    v_or_b32 v167, v167, v7
    s_mul_i32 s24, s22, 3277
    s_lshr_b32 s24, s24, 16
    s_mul_i32 s68, s24, 20
    s_sub_u32 s68, s22, s68
    s_cmp_lt_u32 s68, 8
    s_cselect_b64 s[66:67], s[84:85], s[86:87]
    s_cselect_b32 s25, 0, 8
    s_sub_u32 s68, s68, s25
    s_and_b32 s25, s68, 1
    s_lshr_b32 s68, s68, 1
    s_lshl_b32 s68, s68, 14
    s_lshl_b32 s25, s25, 12
    s_add_u32 s68, s68, s25
    s_lshl_b32 s24, s24, 5
    s_add_u32 s68, s68, s24
    v_lshrrev_b32 v2, 4, v176
    v_lshlrev_b32 v2, 10, v2
    v_and_b32 v3, 15, v176
    v_lshl_add_u32 v2, v3, 1, v2
    v_add_u32 v2, s68, v2
    v_add_u32 v3, 8192, v2
    v_mov_b32 v4, 0
    v_mov_b32 v5, 0
    v_mov_b32 v6, 0
    v_mov_b32 v7, 0
    global_load_ushort v104, v2, s[66:67] offset:0
    global_load_short_d16_hi v4, v3, s[66:67] offset:0
    global_load_ushort v105, v2, s[66:67] offset:256
    global_load_short_d16_hi v5, v3, s[66:67] offset:256
    global_load_ushort v106, v2, s[66:67] offset:512
    global_load_short_d16_hi v6, v3, s[66:67] offset:512
    global_load_ushort v107, v2, s[66:67] offset:768
    global_load_short_d16_hi v7, v3, s[66:67] offset:768
    s_add_u32 s22, s22, 1
    s_waitcnt vmcnt(0)
    v_or_b32 v104, v104, v4
    v_or_b32 v105, v105, v5
    v_or_b32 v106, v106, v6
    v_or_b32 v107, v107, v7
    s_mul_i32 s24, s22, 3277
    s_lshr_b32 s24, s24, 16
    s_mul_i32 s68, s24, 20
    s_sub_u32 s68, s22, s68
    s_cmp_lt_u32 s68, 8
    s_cselect_b64 s[66:67], s[84:85], s[86:87]
    s_cselect_b32 s25, 0, 8
    s_sub_u32 s68, s68, s25
    s_and_b32 s25, s68, 1
    s_lshr_b32 s68, s68, 1
    s_lshl_b32 s68, s68, 14
    s_lshl_b32 s25, s25, 12
    s_add_u32 s68, s68, s25
    s_lshl_b32 s24, s24, 5
    s_add_u32 s68, s68, s24
    v_lshrrev_b32 v2, 4, v176
    v_lshlrev_b32 v2, 10, v2
    v_and_b32 v3, 15, v176
    v_lshl_add_u32 v2, v3, 1, v2
    v_add_u32 v2, s68, v2
    v_add_u32 v3, 8192, v2
    v_mov_b32 v4, 0
    v_mov_b32 v5, 0
    v_mov_b32 v6, 0
    v_mov_b32 v7, 0
    global_load_ushort v108, v2, s[66:67] offset:0
    global_load_short_d16_hi v4, v3, s[66:67] offset:0
    global_load_ushort v109, v2, s[66:67] offset:256
    global_load_short_d16_hi v5, v3, s[66:67] offset:256
    global_load_ushort v110, v2, s[66:67] offset:512
    global_load_short_d16_hi v6, v3, s[66:67] offset:512
    global_load_ushort v111, v2, s[66:67] offset:768
    global_load_short_d16_hi v7, v3, s[66:67] offset:768
    s_add_u32 s22, s22, 1
    s_waitcnt vmcnt(0)
    v_or_b32 v108, v108, v4
    v_or_b32 v109, v109, v5
    v_or_b32 v110, v110, v6
    v_or_b32 v111, v111, v7
    s_mul_i32 s24, s22, 3277
    s_lshr_b32 s24, s24, 16
    s_mul_i32 s68, s24, 20
    s_sub_u32 s68, s22, s68
    s_cmp_lt_u32 s68, 8
    s_cselect_b64 s[66:67], s[84:85], s[86:87]
    s_cselect_b32 s25, 0, 8
    s_sub_u32 s68, s68, s25
    s_and_b32 s25, s68, 1
    s_lshr_b32 s68, s68, 1
    s_lshl_b32 s68, s68, 14
    s_lshl_b32 s25, s25, 12
    s_add_u32 s68, s68, s25
    s_lshl_b32 s24, s24, 5
    s_add_u32 s68, s68, s24
    v_lshrrev_b32 v2, 4, v176
    v_lshlrev_b32 v2, 10, v2
    v_and_b32 v3, 15, v176
    v_lshl_add_u32 v2, v3, 1, v2
    v_add_u32 v2, s68, v2
    v_add_u32 v3, 8192, v2
    v_mov_b32 v4, 0
    v_mov_b32 v5, 0
    v_mov_b32 v6, 0
    v_mov_b32 v7, 0
    global_load_ushort v120, v2, s[66:67] offset:0
    global_load_short_d16_hi v4, v3, s[66:67] offset:0
    global_load_ushort v121, v2, s[66:67] offset:256
    global_load_short_d16_hi v5, v3, s[66:67] offset:256
    global_load_ushort v122, v2, s[66:67] offset:512
    global_load_short_d16_hi v6, v3, s[66:67] offset:512
    global_load_ushort v123, v2, s[66:67] offset:768
    global_load_short_d16_hi v7, v3, s[66:67] offset:768
    s_add_u32 s22, s22, 1
    s_waitcnt vmcnt(0)
    v_or_b32 v120, v120, v4
    v_or_b32 v121, v121, v5
    v_or_b32 v122, v122, v6
    v_or_b32 v123, v123, v7
    s_mul_i32 s24, s22, 3277
    s_lshr_b32 s24, s24, 16
    s_mul_i32 s68, s24, 20
    s_sub_u32 s68, s22, s68
    s_cmp_lt_u32 s68, 8
    s_cselect_b64 s[66:67], s[84:85], s[86:87]
    s_cselect_b32 s25, 0, 8
    s_sub_u32 s68, s68, s25
    s_and_b32 s25, s68, 1
    s_lshr_b32 s68, s68, 1
    s_lshl_b32 s68, s68, 14
    s_lshl_b32 s25, s25, 12
    s_add_u32 s68, s68, s25
    s_lshl_b32 s24, s24, 5
    s_add_u32 s68, s68, s24
    v_lshrrev_b32 v2, 4, v176
    v_lshlrev_b32 v2, 10, v2
    v_and_b32 v3, 15, v176
    v_lshl_add_u32 v2, v3, 1, v2
    v_add_u32 v2, s68, v2
    v_add_u32 v3, 8192, v2
    v_mov_b32 v4, 0
    v_mov_b32 v5, 0
    v_mov_b32 v6, 0
    v_mov_b32 v7, 0
    global_load_ushort v124, v2, s[66:67] offset:0
    global_load_short_d16_hi v4, v3, s[66:67] offset:0
    global_load_ushort v125, v2, s[66:67] offset:256
    global_load_short_d16_hi v5, v3, s[66:67] offset:256
    global_load_ushort v126, v2, s[66:67] offset:512
    global_load_short_d16_hi v6, v3, s[66:67] offset:512
    global_load_ushort v127, v2, s[66:67] offset:768
    global_load_short_d16_hi v7, v3, s[66:67] offset:768
    s_add_u32 s22, s22, 1
    s_waitcnt vmcnt(0)
    v_or_b32 v124, v124, v4
    v_or_b32 v125, v125, v5
    v_or_b32 v126, v126, v6
    v_or_b32 v127, v127, v7
    s_mul_i32 s24, s22, 3277
    s_lshr_b32 s24, s24, 16
    s_mul_i32 s68, s24, 20
    s_sub_u32 s68, s22, s68
    s_cmp_lt_u32 s68, 8
    s_cselect_b64 s[66:67], s[84:85], s[86:87]
    s_cselect_b32 s25, 0, 8
    s_sub_u32 s68, s68, s25
    s_and_b32 s25, s68, 1
    s_lshr_b32 s68, s68, 1
    s_lshl_b32 s68, s68, 14
    s_lshl_b32 s25, s25, 12
    s_add_u32 s68, s68, s25
    s_lshl_b32 s24, s24, 5
    s_add_u32 s68, s68, s24
    v_lshrrev_b32 v2, 4, v176
    v_lshlrev_b32 v2, 10, v2
    v_and_b32 v3, 15, v176
    v_lshl_add_u32 v2, v3, 1, v2
    v_add_u32 v2, s68, v2
    v_add_u32 v3, 8192, v2
    v_mov_b32 v4, 0
    v_mov_b32 v5, 0
    v_mov_b32 v6, 0
    v_mov_b32 v7, 0
    global_load_ushort v128, v2, s[66:67] offset:0
    global_load_short_d16_hi v4, v3, s[66:67] offset:0
    global_load_ushort v129, v2, s[66:67] offset:256
    global_load_short_d16_hi v5, v3, s[66:67] offset:256
    global_load_ushort v130, v2, s[66:67] offset:512
    global_load_short_d16_hi v6, v3, s[66:67] offset:512
    global_load_ushort v131, v2, s[66:67] offset:768
    global_load_short_d16_hi v7, v3, s[66:67] offset:768
    s_add_u32 s22, s22, 1
    s_waitcnt vmcnt(0)
    v_or_b32 v128, v128, v4
    v_or_b32 v129, v129, v5
    v_or_b32 v130, v130, v6
    v_or_b32 v131, v131, v7
    s_mul_i32 s24, s22, 3277
    s_lshr_b32 s24, s24, 16
    s_mul_i32 s68, s24, 20
    s_sub_u32 s68, s22, s68
    s_cmp_lt_u32 s68, 8
    s_cselect_b64 s[66:67], s[84:85], s[86:87]
    s_cselect_b32 s25, 0, 8
    s_sub_u32 s68, s68, s25
    s_and_b32 s25, s68, 1
    s_lshr_b32 s68, s68, 1
    s_lshl_b32 s68, s68, 14
    s_lshl_b32 s25, s25, 12
    s_add_u32 s68, s68, s25
    s_lshl_b32 s24, s24, 5
    s_add_u32 s68, s68, s24
    v_lshrrev_b32 v2, 4, v176
    v_lshlrev_b32 v2, 10, v2
    v_and_b32 v3, 15, v176
    v_lshl_add_u32 v2, v3, 1, v2
    v_add_u32 v2, s68, v2
    v_add_u32 v3, 8192, v2
    v_mov_b32 v4, 0
    v_mov_b32 v5, 0
    v_mov_b32 v6, 0
    v_mov_b32 v7, 0
    global_load_ushort v132, v2, s[66:67] offset:0
    global_load_short_d16_hi v4, v3, s[66:67] offset:0
    global_load_ushort v133, v2, s[66:67] offset:256
    global_load_short_d16_hi v5, v3, s[66:67] offset:256
    global_load_ushort v134, v2, s[66:67] offset:512
    global_load_short_d16_hi v6, v3, s[66:67] offset:512
    global_load_ushort v135, v2, s[66:67] offset:768
    global_load_short_d16_hi v7, v3, s[66:67] offset:768
    s_add_u32 s22, s22, 1
    s_waitcnt vmcnt(0)
    v_or_b32 v132, v132, v4
    v_or_b32 v133, v133, v5
    v_or_b32 v134, v134, v6
    v_or_b32 v135, v135, v7
    s_mul_i32 s24, s22, 3277
    s_lshr_b32 s24, s24, 16
    s_mul_i32 s68, s24, 20
    s_sub_u32 s68, s22, s68
    s_cmp_lt_u32 s68, 8
    s_cselect_b64 s[66:67], s[84:85], s[86:87]
    s_cselect_b32 s25, 0, 8
    s_sub_u32 s68, s68, s25
    s_and_b32 s25, s68, 1
    s_lshr_b32 s68, s68, 1
    s_lshl_b32 s68, s68, 14
    s_lshl_b32 s25, s25, 12
    s_add_u32 s68, s68, s25
    s_lshl_b32 s24, s24, 5
    s_add_u32 s68, s68, s24
    v_lshrrev_b32 v2, 4, v176
    v_lshlrev_b32 v2, 10, v2
    v_and_b32 v3, 15, v176
    v_lshl_add_u32 v2, v3, 1, v2
    v_add_u32 v2, s68, v2
    v_add_u32 v3, 8192, v2
    v_mov_b32 v4, 0
    v_mov_b32 v5, 0
    v_mov_b32 v6, 0
    v_mov_b32 v7, 0
    global_load_ushort v152, v2, s[66:67] offset:0
    global_load_short_d16_hi v4, v3, s[66:67] offset:0
    global_load_ushort v153, v2, s[66:67] offset:256
    global_load_short_d16_hi v5, v3, s[66:67] offset:256
    global_load_ushort v154, v2, s[66:67] offset:512
    global_load_short_d16_hi v6, v3, s[66:67] offset:512
    global_load_ushort v155, v2, s[66:67] offset:768
    global_load_short_d16_hi v7, v3, s[66:67] offset:768
    s_add_u32 s22, s22, 1
    s_waitcnt vmcnt(0)
    v_or_b32 v152, v152, v4
    v_or_b32 v153, v153, v5
    v_or_b32 v154, v154, v6
    v_or_b32 v155, v155, v7
    s_mul_i32 s24, s22, 3277
    s_lshr_b32 s24, s24, 16
    s_mul_i32 s68, s24, 20
    s_sub_u32 s68, s22, s68
    s_cmp_lt_u32 s68, 8
    s_cselect_b64 s[66:67], s[84:85], s[86:87]
    s_cselect_b32 s25, 0, 8
    s_sub_u32 s68, s68, s25
    s_and_b32 s25, s68, 1
    s_lshr_b32 s68, s68, 1
    s_lshl_b32 s68, s68, 14
    s_lshl_b32 s25, s25, 12
    s_add_u32 s68, s68, s25
    s_lshl_b32 s24, s24, 5
    s_add_u32 s68, s68, s24
    v_lshrrev_b32 v2, 4, v176
    v_lshlrev_b32 v2, 10, v2
    v_and_b32 v3, 15, v176
    v_lshl_add_u32 v2, v3, 1, v2
    v_add_u32 v2, s68, v2
    v_add_u32 v3, 8192, v2
    v_mov_b32 v4, 0
    v_mov_b32 v5, 0
    v_mov_b32 v6, 0
    v_mov_b32 v7, 0
    global_load_ushort v156, v2, s[66:67] offset:0
    global_load_short_d16_hi v4, v3, s[66:67] offset:0
    global_load_ushort v157, v2, s[66:67] offset:256
    global_load_short_d16_hi v5, v3, s[66:67] offset:256
    global_load_ushort v158, v2, s[66:67] offset:512
    global_load_short_d16_hi v6, v3, s[66:67] offset:512
    global_load_ushort v159, v2, s[66:67] offset:768
    global_load_short_d16_hi v7, v3, s[66:67] offset:768
    s_add_u32 s22, s22, 1
    s_waitcnt vmcnt(0)
    v_or_b32 v156, v156, v4
    v_or_b32 v157, v157, v5
    v_or_b32 v158, v158, v6
    v_or_b32 v159, v159, v7
    s_mul_i32 s24, s22, 3277
    s_lshr_b32 s24, s24, 16
    s_mul_i32 s68, s24, 20
    s_sub_u32 s68, s22, s68
    s_cmp_lt_u32 s68, 8
    s_cselect_b64 s[66:67], s[84:85], s[86:87]
    s_cselect_b32 s25, 0, 8
    s_sub_u32 s68, s68, s25
    s_and_b32 s25, s68, 1
    s_lshr_b32 s68, s68, 1
    s_lshl_b32 s68, s68, 14
    s_lshl_b32 s25, s25, 12
    s_add_u32 s68, s68, s25
    s_lshl_b32 s24, s24, 5
    s_add_u32 s68, s68, s24
    v_lshrrev_b32 v2, 4, v176
    v_lshlrev_b32 v2, 10, v2
    v_and_b32 v3, 15, v176
    v_lshl_add_u32 v2, v3, 1, v2
    v_add_u32 v2, s68, v2
    v_add_u32 v3, 8192, v2
    v_mov_b32 v4, 0
    v_mov_b32 v5, 0
    v_mov_b32 v6, 0
    v_mov_b32 v7, 0
    global_load_ushort v136, v2, s[66:67] offset:0
    global_load_short_d16_hi v4, v3, s[66:67] offset:0
    global_load_ushort v137, v2, s[66:67] offset:256
    global_load_short_d16_hi v5, v3, s[66:67] offset:256
    global_load_ushort v138, v2, s[66:67] offset:512
    global_load_short_d16_hi v6, v3, s[66:67] offset:512
    global_load_ushort v139, v2, s[66:67] offset:768
    global_load_short_d16_hi v7, v3, s[66:67] offset:768
    s_add_u32 s22, s22, 1
    s_waitcnt vmcnt(0)
    v_or_b32 v136, v136, v4
    v_or_b32 v137, v137, v5
    v_or_b32 v138, v138, v6
    v_or_b32 v139, v139, v7
    s_mul_i32 s24, s22, 3277
    s_lshr_b32 s24, s24, 16
    s_mul_i32 s68, s24, 20
    s_sub_u32 s68, s22, s68
    s_cmp_lt_u32 s68, 8
    s_cselect_b64 s[66:67], s[84:85], s[86:87]
    s_cselect_b32 s25, 0, 8
    s_sub_u32 s68, s68, s25
    s_and_b32 s25, s68, 1
    s_lshr_b32 s68, s68, 1
    s_lshl_b32 s68, s68, 14
    s_lshl_b32 s25, s25, 12
    s_add_u32 s68, s68, s25
    s_lshl_b32 s24, s24, 5
    s_add_u32 s68, s68, s24
    v_lshrrev_b32 v2, 4, v176
    v_lshlrev_b32 v2, 10, v2
    v_and_b32 v3, 15, v176
    v_lshl_add_u32 v2, v3, 1, v2
    v_add_u32 v2, s68, v2
    v_add_u32 v3, 8192, v2
    v_mov_b32 v4, 0
    v_mov_b32 v5, 0
    v_mov_b32 v6, 0
    v_mov_b32 v7, 0
    global_load_ushort v140, v2, s[66:67] offset:0
    global_load_short_d16_hi v4, v3, s[66:67] offset:0
    global_load_ushort v141, v2, s[66:67] offset:256
    global_load_short_d16_hi v5, v3, s[66:67] offset:256
    global_load_ushort v142, v2, s[66:67] offset:512
    global_load_short_d16_hi v6, v3, s[66:67] offset:512
    global_load_ushort v143, v2, s[66:67] offset:768
    global_load_short_d16_hi v7, v3, s[66:67] offset:768
    s_add_u32 s22, s22, 1
    s_waitcnt vmcnt(0)
    v_or_b32 v140, v140, v4
    v_or_b32 v141, v141, v5
    v_or_b32 v142, v142, v6
    v_or_b32 v143, v143, v7
    s_mul_i32 s24, s22, 3277
    s_lshr_b32 s24, s24, 16
    s_mul_i32 s68, s24, 20
    s_sub_u32 s68, s22, s68
    s_cmp_lt_u32 s68, 8
    s_cselect_b64 s[66:67], s[84:85], s[86:87]
    s_cselect_b32 s25, 0, 8
    s_sub_u32 s68, s68, s25
    s_and_b32 s25, s68, 1
    s_lshr_b32 s68, s68, 1
    s_lshl_b32 s68, s68, 14
    s_lshl_b32 s25, s25, 12
    s_add_u32 s68, s68, s25
    s_lshl_b32 s24, s24, 5
    s_add_u32 s68, s68, s24
    v_lshrrev_b32 v2, 4, v176
    v_lshlrev_b32 v2, 10, v2
    v_and_b32 v3, 15, v176
    v_lshl_add_u32 v2, v3, 1, v2
    v_add_u32 v2, s68, v2
    v_add_u32 v3, 8192, v2
    v_mov_b32 v4, 0
    v_mov_b32 v5, 0
    v_mov_b32 v6, 0
    v_mov_b32 v7, 0
    global_load_ushort v168, v2, s[66:67] offset:0
    global_load_short_d16_hi v4, v3, s[66:67] offset:0
    global_load_ushort v169, v2, s[66:67] offset:256
    global_load_short_d16_hi v5, v3, s[66:67] offset:256
    global_load_ushort v170, v2, s[66:67] offset:512
    global_load_short_d16_hi v6, v3, s[66:67] offset:512
    global_load_ushort v171, v2, s[66:67] offset:768
    global_load_short_d16_hi v7, v3, s[66:67] offset:768
    s_add_u32 s22, s22, 1
    s_waitcnt vmcnt(0)
    v_or_b32 v168, v168, v4
    v_or_b32 v169, v169, v5
    v_or_b32 v170, v170, v6
    v_or_b32 v171, v171, v7
    s_mul_i32 s24, s22, 3277
    s_lshr_b32 s24, s24, 16
    s_mul_i32 s68, s24, 20
    s_sub_u32 s68, s22, s68
    s_cmp_lt_u32 s68, 8
    s_cselect_b64 s[66:67], s[84:85], s[86:87]
    s_cselect_b32 s25, 0, 8
    s_sub_u32 s68, s68, s25
    s_and_b32 s25, s68, 1
    s_lshr_b32 s68, s68, 1
    s_lshl_b32 s68, s68, 14
    s_lshl_b32 s25, s25, 12
    s_add_u32 s68, s68, s25
    s_lshl_b32 s24, s24, 5
    s_add_u32 s68, s68, s24
    v_lshrrev_b32 v2, 4, v176
    v_lshlrev_b32 v2, 10, v2
    v_and_b32 v3, 15, v176
    v_lshl_add_u32 v2, v3, 1, v2
    v_add_u32 v2, s68, v2
    v_add_u32 v3, 8192, v2
    v_mov_b32 v4, 0
    v_mov_b32 v5, 0
    v_mov_b32 v6, 0
    v_mov_b32 v7, 0
    global_load_ushort v172, v2, s[66:67] offset:0
    global_load_short_d16_hi v4, v3, s[66:67] offset:0
    global_load_ushort v173, v2, s[66:67] offset:256
    global_load_short_d16_hi v5, v3, s[66:67] offset:256
    global_load_ushort v174, v2, s[66:67] offset:512
    global_load_short_d16_hi v6, v3, s[66:67] offset:512
    global_load_ushort v175, v2, s[66:67] offset:768
    global_load_short_d16_hi v7, v3, s[66:67] offset:768
    s_add_u32 s22, s22, 1
    s_waitcnt vmcnt(0)
    v_or_b32 v172, v172, v4
    v_or_b32 v173, v173, v5
    v_or_b32 v174, v174, v6
    v_or_b32 v175, v175, v7
    s_mul_i32 s24, s22, 3277
    s_lshr_b32 s24, s24, 16
    s_mul_i32 s68, s24, 20
    s_sub_u32 s68, s22, s68
    s_cmp_lt_u32 s68, 8
    s_cselect_b64 s[66:67], s[84:85], s[86:87]
    s_cselect_b32 s25, 0, 8
    s_sub_u32 s68, s68, s25
    s_and_b32 s25, s68, 1
    s_lshr_b32 s68, s68, 1
    s_lshl_b32 s68, s68, 14
    s_lshl_b32 s25, s25, 12
    s_add_u32 s68, s68, s25
    s_lshl_b32 s24, s24, 5
    s_add_u32 s68, s68, s24
    v_lshrrev_b32 v2, 4, v176
    v_lshlrev_b32 v2, 10, v2
    v_and_b32 v3, 15, v176
    v_lshl_add_u32 v2, v3, 1, v2
    v_add_u32 v2, s68, v2
    v_add_u32 v3, 8192, v2
    v_mov_b32 v4, 0
    v_mov_b32 v5, 0
    v_mov_b32 v6, 0
    v_mov_b32 v7, 0
    global_load_ushort v112, v2, s[66:67] offset:0
    global_load_short_d16_hi v4, v3, s[66:67] offset:0
    global_load_ushort v113, v2, s[66:67] offset:256
    global_load_short_d16_hi v5, v3, s[66:67] offset:256
    global_load_ushort v114, v2, s[66:67] offset:512
    global_load_short_d16_hi v6, v3, s[66:67] offset:512
    global_load_ushort v115, v2, s[66:67] offset:768
    global_load_short_d16_hi v7, v3, s[66:67] offset:768
    s_add_u32 s22, s22, 1
    s_waitcnt vmcnt(0)
    v_or_b32 v112, v112, v4
    v_or_b32 v113, v113, v5
    v_or_b32 v114, v114, v6
    v_or_b32 v115, v115, v7
    s_mul_i32 s24, s22, 3277
    s_lshr_b32 s24, s24, 16
    s_mul_i32 s68, s24, 20
    s_sub_u32 s68, s22, s68
    s_cmp_lt_u32 s68, 8
    s_cselect_b64 s[66:67], s[84:85], s[86:87]
    s_cselect_b32 s25, 0, 8
    s_sub_u32 s68, s68, s25
    s_and_b32 s25, s68, 1
    s_lshr_b32 s68, s68, 1
    s_lshl_b32 s68, s68, 14
    s_lshl_b32 s25, s25, 12
    s_add_u32 s68, s68, s25
    s_lshl_b32 s24, s24, 5
    s_add_u32 s68, s68, s24
    v_lshrrev_b32 v2, 4, v176
    v_lshlrev_b32 v2, 10, v2
    v_and_b32 v3, 15, v176
    v_lshl_add_u32 v2, v3, 1, v2
    v_add_u32 v2, s68, v2
    v_add_u32 v3, 8192, v2
    v_mov_b32 v4, 0
    v_mov_b32 v5, 0
    v_mov_b32 v6, 0
    v_mov_b32 v7, 0
    global_load_ushort v116, v2, s[66:67] offset:0
    global_load_short_d16_hi v4, v3, s[66:67] offset:0
    global_load_ushort v117, v2, s[66:67] offset:256
    global_load_short_d16_hi v5, v3, s[66:67] offset:256
    global_load_ushort v118, v2, s[66:67] offset:512
    global_load_short_d16_hi v6, v3, s[66:67] offset:512
    global_load_ushort v119, v2, s[66:67] offset:768
    global_load_short_d16_hi v7, v3, s[66:67] offset:768
    s_add_u32 s22, s22, 1
    s_waitcnt vmcnt(0)
    v_or_b32 v116, v116, v4
    v_or_b32 v117, v117, v5
    v_or_b32 v118, v118, v6
    v_or_b32 v119, v119, v7
    s_load_dwordx2 s[72:73], s[0:1], 72
    v_lshlrev_b32 v246, 4, v176
    s_mov_b32 s52, 163072
    v_bfe_u32 v177, v246, 4, 4
    v_bfe_u32 v179, v246, 4, 3
    v_lshl_add_u32 v180, v177, 3, s52
    v_lshl_add_u32 v190, v177, 4, s52
    v_lshl_add_u32 v181, v179, 3, s52
    ds_read2_b64 v[182:185], v180 offset0:32 offset1:48
    ds_read_b32 v191, v190
    ds_read_b64 v[186:187], v181 offset:512
    v_lshrrev_b32 v178, 8, v246
    s_add_u32 s22, s20, 0
    s_mul_i32 s28, s22, 1536
    s_add_u32 s28, s28, 86016
    s_lshl_b32 s22, s22, 21
    s_add_u32 s23, s20, 8
    s_mul_i32 s29, s23, 1536
    s_add_u32 s29, s29, 86144
    s_lshl_b32 s23, s23, 21
    s_add_u32 s24, s20, 16
    s_mul_i32 s30, s24, 1536
    s_add_u32 s30, s30, 86016
    s_lshl_b32 s24, s24, 21
    s_add_u32 s25, s20, 24
    s_lshl_b32 s25, s25, 21
    s_add_u32 s26, s20, 32
    s_lshl_b32 s26, s26, 21
    s_mov_b32 s53, 0
    s_mov_b32 s50, 0
    s_waitcnt lgkmcnt(0)
    s_branch GEMM
.section .rodata,"a"
.p2align 6
.amdhsa_kernel standalone__tensor_product_equiv_equiformer__graph_kernel
  .amdhsa_next_free_vgpr 256
  .amdhsa_next_free_sgpr 90
  .amdhsa_accum_offset 256
  .amdhsa_group_segment_fixed_size 0
  .amdhsa_kernarg_size 96
  .amdhsa_user_sgpr_count 2
  .amdhsa_user_sgpr_kernarg_segment_ptr 1
  .amdhsa_system_sgpr_workgroup_id_x 1
.end_amdhsa_kernel
```

```asm
; @launch grid=(250,1,1) block=(512,1,1) lds=163840
.amdgcn_target "amdgcn-amd-amdhsa--gfx950"
.text
.globl standalone__tensor_product_equiv_equiformer__graph_kernel
.p2align 8
.type standalone__tensor_product_equiv_equiformer__graph_kernel,@function
standalone__tensor_product_equiv_equiformer__graph_kernel:
    s_cmp_ge_u32 s2, 250
    s_cbranch_scc1 K2_end
    s_load_dwordx16 s[72:87], s[0:1], 0
    s_load_dwordx2 s[70:71], s[0:1], 88
    v_lshrrev_b32 v2, 6, v0
    v_and_b32 v1, 63, v0
    v_readfirstlane_b32 s20, v2
    s_getpc_b64 s[66:67]
    v_lshlrev_b32 v95, 7, v1
    s_cmp_eq_u32 s20, 6
    s_cbranch_scc0 F_nopf0
    global_load_dword v95, v95, s[66:67]
F_nopf0:
    s_mul_i32 s66, s2, 5120
    s_mul_i32 s67, s2, 7680
    v_lshl_add_u32 v3, v0, 4, s66
    v_mul_u32_u24 v4, 24, v0
    v_add_u32 v4, s67, v4
    v_lshlrev_b32 v5, 2, v0
    v_mov_b32 v89, 0
    v_add_u32 v6, 98304, v5
    ds_write_b32 v6, v89
    s_cmp_ge_u32 s20, 5
    s_waitcnt lgkmcnt(0)
    s_cbranch_scc1 F_noload
    global_load_dwordx4 v[8:11], v3, s[80:81] nt
    global_load_dwordx4 v[12:15], v3, s[78:79] nt
    global_load_dwordx4 v[16:19], v4, s[74:75] nt
    global_load_dwordx2 v[20:21], v4, s[74:75] offset:16 nt
F_noload:
    s_load_dword s88, s[70:71], 0
    s_barrier
    v_lshlrev_b32 v248, 2, v1
    v_add_u32 v88, 162816, v248
    ds_write_b32 v88, v89
    ds_write_b32 v88, v89 offset:256
    v_lshlrev_b32 v86, 4, v1
    s_lshl_b32 s21, s20, 13
    v_lshrrev_b32 v6, 5, v1
    v_mul_u32_u24 v6, 5120, v6
    v_and_b32 v7, 31, v1
    v_lshl_add_u32 v6, v7, 1, v6
    s_lshr_b32 s66, s20, 2
    s_lshl_b32 s66, s66, 7
    s_and_b32 s67, s20, 3
    s_mul_i32 s67, s67, 5
    s_add_u32 s68, s67, 0
    s_lshr_b32 s24, s68, 2
    s_lshl_b32 s24, s24, 8
    s_bfe_u32 s69, s68, 0x10001
    s_lshl_b32 s69, s69, 6
    s_add_u32 s24, s24, s69
    s_and_b32 s69, s68, 1
    s_mul_i32 s69, s69, 10240
    s_add_u32 s24, s24, s69
    s_add_u32 s24, s24, s66
    s_add_u32 s68, s67, 1
    s_lshr_b32 s25, s68, 2
    s_lshl_b32 s25, s25, 8
    s_bfe_u32 s69, s68, 0x10001
    s_lshl_b32 s69, s69, 6
    s_add_u32 s25, s25, s69
    s_and_b32 s69, s68, 1
    s_mul_i32 s69, s69, 10240
    s_add_u32 s25, s25, s69
    s_add_u32 s25, s25, s66
    s_add_u32 s68, s67, 2
    s_lshr_b32 s26, s68, 2
    s_lshl_b32 s26, s26, 8
    s_bfe_u32 s69, s68, 0x10001
    s_lshl_b32 s69, s69, 6
    s_add_u32 s26, s26, s69
    s_and_b32 s69, s68, 1
    s_mul_i32 s69, s69, 10240
    s_add_u32 s26, s26, s69
    s_add_u32 s26, s26, s66
    s_add_u32 s68, s67, 3
    s_lshr_b32 s27, s68, 2
    s_lshl_b32 s27, s27, 8
    s_bfe_u32 s69, s68, 0x10001
    s_lshl_b32 s69, s69, 6
    s_add_u32 s27, s27, s69
    s_and_b32 s69, s68, 1
    s_mul_i32 s69, s69, 10240
    s_add_u32 s27, s27, s69
    s_add_u32 s27, s27, s66
    s_add_u32 s68, s67, 4
    s_lshr_b32 s28, s68, 2
    s_lshl_b32 s28, s28, 8
    s_bfe_u32 s69, s68, 0x10001
    s_lshl_b32 s69, s69, 6
    s_add_u32 s28, s28, s69
    s_and_b32 s69, s68, 1
    s_mul_i32 s69, s69, 10240
    s_add_u32 s28, s28, s69
    s_add_u32 s28, s28, s66
    v_mov_b32 v96, 0
    v_mov_b32 v97, 0
    v_mov_b32 v98, 0
    v_mov_b32 v99, 0
    v_mov_b32 v100, 0
    v_mov_b32 v101, 0
    v_mov_b32 v102, 0
    v_mov_b32 v103, 0
    v_mov_b32 v104, 0
    v_mov_b32 v105, 0
    v_mov_b32 v106, 0
    v_mov_b32 v107, 0
    v_mov_b32 v108, 0
    v_mov_b32 v109, 0
    v_mov_b32 v110, 0
    v_mov_b32 v111, 0
    v_mov_b32 v112, 0
    v_mov_b32 v113, 0
    v_mov_b32 v114, 0
    v_mov_b32 v115, 0
    v_mov_b32 v180, 0
    v_mov_b32 v181, 0
    v_mov_b32 v182, 0
    v_mov_b32 v183, 0
    s_mov_b32 s16, s70
    s_and_b32 s17, s71, 0xffff
    s_mov_b32 s18, 24165888
    s_mov_b32 s19, 0x20000
    v_lshrrev_b32 v2, 3, v1
    v_lshl_add_u32 v2, s20, 5, v2
    v_and_b32 v91, 7, v1
    v_mul_u32_u24 v94, 384, v2
    v_lshl_add_u32 v94, v91, 4, v94
    v_lshlrev_b32 v93, 2, v2
    v_add_u32 v93, 98304, v93
    v_mul_u32_u24 v92, 32000, v2
    v_lshl_add_u32 v92, v91, 4, v92
    v_mul_u32_u24 v90, 40960, v2
    s_mov_b32 s32, s82
    s_and_b32 s33, s83, 0xffff
    s_mov_b32 s34, 20480
    s_mov_b32 s35, 0x20000
    s_cmp_ge_u32 s20, 5
    s_cbranch_scc1 F_helper
    s_mov_b32 s22, 52429
    s_mov_b32 s23, 0x05040100
    s_mov_b32 s66, 98304
    s_movk_i32 s67, -40
    v_mov_b32 v7, 1
    v_add_u32 v31, 1, v5
    v_add_u32 v32, 2, v5
    v_add_u32 v33, 3, v5
    s_waitcnt vmcnt(3)
    v_mul_u32_u24 v22, s22, v8
    v_mul_u32_u24 v23, s22, v9
    v_mul_u32_u24 v24, s22, v10
    v_mul_u32_u24 v25, s22, v11
    v_lshrrev_b32 v22, 21, v22
    v_lshrrev_b32 v23, 21, v23
    v_lshrrev_b32 v24, 21, v24
    v_lshrrev_b32 v25, 21, v25
    v_lshl_add_u32 v34, v22, 2, s66
    ds_add_rtn_u32 v26, v34, v7
    v_lshl_add_u32 v35, v23, 2, s66
    ds_add_rtn_u32 v27, v35, v7
    v_lshl_add_u32 v36, v24, 2, s66
    ds_add_rtn_u32 v28, v36, v7
    v_lshl_add_u32 v37, v25, 2, s66
    ds_add_rtn_u32 v29, v37, v7
    buffer_load_short_d16_hi v96, v6, s[32:35], s24 offen offset:0
    buffer_load_short_d16_hi v97, v6, s[32:35], s24 offen offset:1280
    buffer_load_short_d16_hi v98, v6, s[32:35], s24 offen offset:2560
    buffer_load_short_d16_hi v99, v6, s[32:35], s24 offen offset:3840
    buffer_load_short_d16_hi v100, v6, s[32:35], s25 offen offset:0
    buffer_load_short_d16_hi v101, v6, s[32:35], s25 offen offset:1280
    buffer_load_short_d16_hi v102, v6, s[32:35], s25 offen offset:2560
    buffer_load_short_d16_hi v103, v6, s[32:35], s25 offen offset:3840
    buffer_load_short_d16_hi v104, v6, s[32:35], s26 offen offset:0
    buffer_load_short_d16_hi v105, v6, s[32:35], s26 offen offset:1280
    buffer_load_short_d16_hi v106, v6, s[32:35], s26 offen offset:2560
    buffer_load_short_d16_hi v107, v6, s[32:35], s26 offen offset:3840
    buffer_load_short_d16_hi v108, v6, s[32:35], s27 offen offset:0
    buffer_load_short_d16_hi v109, v6, s[32:35], s27 offen offset:1280
    buffer_load_short_d16_hi v110, v6, s[32:35], s27 offen offset:2560
    buffer_load_short_d16_hi v111, v6, s[32:35], s27 offen offset:3840
    buffer_load_short_d16_hi v112, v6, s[32:35], s28 offen offset:0
    buffer_load_short_d16_hi v113, v6, s[32:35], s28 offen offset:1280
    buffer_load_short_d16_hi v114, v6, s[32:35], s28 offen offset:2560
    buffer_load_short_d16_hi v115, v6, s[32:35], s28 offen offset:3840
    v_mad_i32_i24 v2, v22, s67, v8
    v_mul_u32_u24 v22, 384, v22
    v_lshl_or_b32 v42, v2, 11, v5
    v_mad_i32_i24 v2, v23, s67, v9
    v_mul_u32_u24 v23, 384, v23
    v_lshl_or_b32 v46, v2, 11, v31
    v_mad_i32_i24 v2, v24, s67, v10
    v_mul_u32_u24 v24, 384, v24
    v_lshl_or_b32 v50, v2, 11, v32
    v_mad_i32_i24 v2, v25, s67, v11
    v_mul_u32_u24 v25, 384, v25
    v_lshl_or_b32 v54, v2, 11, v33
    s_waitcnt vmcnt(20)
    v_mov_b32 v40, v16
    v_perm_b32 v41, v12, v17, s23
    v_alignbit_b32 v44, v18, v17, 16
    v_alignbit_b32 v45, v13, v18, 16
    v_mov_b32 v48, v19
    v_perm_b32 v49, v14, v20, s23
    v_alignbit_b32 v52, v21, v20, 16
    v_alignbit_b32 v53, v15, v21, 16
    v_xor_b32 v41, 0x8000, v41
    v_xor_b32 v45, 0x8000, v45
    v_xor_b32 v49, 0x8000, v49
    v_xor_b32 v53, 0x8000, v53
    s_waitcnt lgkmcnt(0)
    v_min_u32 v26, 23, v26
    v_lshl_add_u32 v34, v26, 4, v22
    ds_write_b128 v34, v[40:43]
    v_min_u32 v27, 23, v27
    v_lshl_add_u32 v35, v27, 4, v23
    ds_write_b128 v35, v[44:47]
    v_min_u32 v28, 23, v28
    v_lshl_add_u32 v36, v28, 4, v24
    ds_write_b128 v36, v[48:51]
    v_min_u32 v29, 23, v29
    v_lshl_add_u32 v37, v29, 4, v25
    ds_write_b128 v37, v[52:55]
    s_branch F_staged
F_helper:
    buffer_load_short_d16_hi v96, v6, s[32:35], s24 offen offset:0
    buffer_load_short_d16_hi v97, v6, s[32:35], s24 offen offset:1280
    buffer_load_short_d16_hi v98, v6, s[32:35], s24 offen offset:2560
    buffer_load_short_d16_hi v99, v6, s[32:35], s24 offen offset:3840
    buffer_load_short_d16_hi v100, v6, s[32:35], s25 offen offset:0
    buffer_load_short_d16_hi v101, v6, s[32:35], s25 offen offset:1280
    buffer_load_short_d16_hi v102, v6, s[32:35], s25 offen offset:2560
    buffer_load_short_d16_hi v103, v6, s[32:35], s25 offen offset:3840
    buffer_load_short_d16_hi v104, v6, s[32:35], s26 offen offset:0
    buffer_load_short_d16_hi v105, v6, s[32:35], s26 offen offset:1280
    buffer_load_short_d16_hi v106, v6, s[32:35], s26 offen offset:2560
    buffer_load_short_d16_hi v107, v6, s[32:35], s26 offen offset:3840
    buffer_load_short_d16_hi v108, v6, s[32:35], s27 offen offset:0
    buffer_load_short_d16_hi v109, v6, s[32:35], s27 offen offset:1280
    buffer_load_short_d16_hi v110, v6, s[32:35], s27 offen offset:2560
    buffer_load_short_d16_hi v111, v6, s[32:35], s27 offen offset:3840
    buffer_load_short_d16_hi v112, v6, s[32:35], s28 offen offset:0
    buffer_load_short_d16_hi v113, v6, s[32:35], s28 offen offset:1280
    buffer_load_short_d16_hi v114, v6, s[32:35], s28 offen offset:2560
    buffer_load_short_d16_hi v115, v6, s[32:35], s28 offen offset:3840
    s_cmp_eq_u32 s20, 6
    s_cbranch_scc0 F_nopf
    s_getpc_b64 s[66:67]
F_pc:
    s_lshr_b32 s68, s2, 3
    s_mul_i32 s68, s68, ((K2_last-F_pc)/128/31+1)*128
    v_lshl_add_u32 v2, v1, 7, s68
    v_min_u32 v2, K2_last-F_pc-4, v2
    v_cmp_gt_u32 vcc, (K2_last-F_pc)/128/31+1, v1
    s_mov_b64 exec, vcc
    global_load_dword v95, v2, s[66:67]
    s_mov_b64 exec, -1
F_nopf:
    s_cmp_eq_u32 s20, 7
    s_cbranch_scc0 F_staged
    s_cmp_lt_u32 s2, 160
    s_cbranch_scc0 F_staged
    s_mul_i32 s22, s2, 3277
    s_lshr_b32 s22, s22, 16
    s_mul_i32 s68, s22, 20
    s_sub_u32 s68, s2, s68
    s_cmp_lt_u32 s68, 8
    s_cselect_b64 s[66:67], s[84:85], s[86:87]
    s_cselect_b32 s23, 0, 8
    s_sub_u32 s68, s68, s23
    s_and_b32 s23, s68, 1
    s_lshr_b32 s68, s68, 1
    s_lshl_b32 s68, s68, 14
    s_lshl_b32 s23, s23, 12
    s_add_u32 s68, s68, s23
    s_lshl_b32 s22, s22, 5
    s_add_u32 s68, s68, s22
    v_lshrrev_b32 v2, 4, v1
    v_lshlrev_b32 v2, 10, v2
    v_and_b32 v3, 15, v1
    v_lshl_add_u32 v2, v3, 1, v2
    v_add_u32 v2, s68, v2
    v_add_u32 v3, 8192, v2
    global_load_ushort v176, v2, s[66:67] offset:0
    global_load_short_d16_hi v180, v3, s[66:67] offset:0
    global_load_ushort v177, v2, s[66:67] offset:256
    global_load_short_d16_hi v181, v3, s[66:67] offset:256
    global_load_ushort v178, v2, s[66:67] offset:512
    global_load_short_d16_hi v182, v3, s[66:67] offset:512
    global_load_ushort v179, v2, s[66:67] offset:768
    global_load_short_d16_hi v183, v3, s[66:67] offset:768
F_staged:
    s_lshl_b32 s66, s2, 7
    s_add_u32 s66, s66, 164864
    s_cmp_eq_u32 s20, 7
    s_cselect_b32 s22, 0xffff, -1
    s_cselect_b32 s23, 0, -1
    s_waitcnt lgkmcnt(0)
    s_add_u32 s88, s88, 1
    s_barrier
    ds_read_b32 v40, v93 offset:0
    ds_read_b128 v[8:11], v94 offset:0
    ds_read_b32 v14, v94 offset:136
    ds_read_b32 v41, v93 offset:32
    ds_read_b128 v[16:19], v94 offset:3072
    ds_read_b32 v22, v94 offset:3208
    ds_read_b32 v42, v93 offset:64
    ds_read_b128 v[24:27], v94 offset:6144
    ds_read_b32 v30, v94 offset:6280
    ds_read_b32 v43, v93 offset:96
    ds_read_b128 v[32:35], v94 offset:9216
    ds_read_b32 v38, v94 offset:9352
    s_add_u32 s28, s66, 0
    s_add_u32 s29, s66, 256000
    s_add_u32 s30, s66, 512000
    s_add_u32 s31, s66, 768000
    s_waitcnt lgkmcnt(9)
    v_min_u32 v5, 31, v40
    v_bfe_u32 v6, v14, 11, 6
    v_and_b32 v10, 0x1ffff, v10
    v_lshl_or_b32 v6, v5, 6, v6
    v_mov_b32 v11, s88
    v_lshl_or_b32 v10, v6, 17, v10
    buffer_store_dwordx4 v[8:11], v92, s[16:19], s28 offen sc1
    s_waitcnt lgkmcnt(6)
    v_min_u32 v5, 31, v41
    v_bfe_u32 v6, v22, 11, 6
    v_and_b32 v18, 0x1ffff, v18
    v_lshl_or_b32 v6, v5, 6, v6
    v_mov_b32 v19, s88
    v_lshl_or_b32 v18, v6, 17, v18
    buffer_store_dwordx4 v[16:19], v92, s[16:19], s29 offen sc1
    s_waitcnt lgkmcnt(3)
    v_min_u32 v5, 31, v42
    v_bfe_u32 v6, v30, 11, 6
    v_and_b32 v26, 0x1ffff, v26
    v_lshl_or_b32 v6, v5, 6, v6
    v_mov_b32 v27, s88
    v_lshl_or_b32 v26, v6, 17, v26
    buffer_store_dwordx4 v[24:27], v92, s[16:19], s30 offen sc1
    s_waitcnt lgkmcnt(0)
    v_min_u32 v5, 31, v43
    v_bfe_u32 v6, v38, 11, 6
    v_and_b32 v34, 0x1ffff, v34
    v_lshl_or_b32 v6, v5, 6, v6
    v_mov_b32 v35, s88
    v_lshl_or_b32 v34, v6, 17, v34
    s_mov_b64 exec, s[22:23]
    buffer_store_dwordx4 v[32:35], v92, s[16:19], s31 offen sc1
    s_mov_b64 exec, -1
    ds_read_b128 v[12:15], v94 offset:128
    ds_read_b128 v[20:23], v94 offset:3200
    ds_read_b128 v[28:31], v94 offset:6272
    ds_read_b128 v[36:39], v94 offset:9344
    s_waitcnt vmcnt(4)
F_now:
    v_cmp_lt_u32 vcc, 8, v40
    s_add_u32 s67, s28, 8000000
    s_waitcnt lgkmcnt(3)
    v_mov_b32 v15, s88
    s_mov_b64 exec, vcc
    s_cbranch_execz F_w0
    buffer_store_dwordx4 v[12:15], v92, s[16:19], s67 offen sc1
    v_cmp_lt_u32 vcc, 16, v40
    s_add_u32 s67, s67, 8000000
    s_mov_b64 exec, vcc
    s_cbranch_execz F_w0
    ds_read_b128 v[44:47], v94 offset:256
    s_waitcnt lgkmcnt(0)
    v_mov_b32 v47, s88
    buffer_store_dwordx4 v[44:47], v92, s[16:19], s67 offen sc1
    s_nop 1
F_w0:
    s_mov_b64 exec, -1
    v_cmp_lt_u32 vcc, 8, v41
    s_add_u32 s67, s29, 8000000
    s_waitcnt lgkmcnt(2)
    v_mov_b32 v23, s88
    s_mov_b64 exec, vcc
    s_cbranch_execz F_w1
    buffer_store_dwordx4 v[20:23], v92, s[16:19], s67 offen sc1
    v_cmp_lt_u32 vcc, 16, v41
    s_add_u32 s67, s67, 8000000
    s_mov_b64 exec, vcc
    s_cbranch_execz F_w1
    ds_read_b128 v[44:47], v94 offset:3328
    s_waitcnt lgkmcnt(0)
    v_mov_b32 v47, s88
    buffer_store_dwordx4 v[44:47], v92, s[16:19], s67 offen sc1
    s_nop 1
F_w1:
    s_mov_b64 exec, -1
    v_cmp_lt_u32 vcc, 8, v42
    s_add_u32 s67, s30, 8000000
    s_waitcnt lgkmcnt(1)
    v_mov_b32 v31, s88
    s_mov_b64 exec, vcc
    s_cbranch_execz F_w2
    buffer_store_dwordx4 v[28:31], v92, s[16:19], s67 offen sc1
    v_cmp_lt_u32 vcc, 16, v42
    s_add_u32 s67, s67, 8000000
    s_mov_b64 exec, vcc
    s_cbranch_execz F_w2
    ds_read_b128 v[44:47], v94 offset:6400
    s_waitcnt lgkmcnt(0)
    v_mov_b32 v47, s88
    buffer_store_dwordx4 v[44:47], v92, s[16:19], s67 offen sc1
    s_nop 1
F_w2:
    s_mov_b64 exec, -1
    v_cmp_lt_u32 vcc, 8, v43
    s_add_u32 s67, s31, 8000000
    s_and_b64 vcc, vcc, s[22:23]
    s_waitcnt lgkmcnt(0)
    v_mov_b32 v39, s88
    s_mov_b64 exec, vcc
    s_cbranch_execz F_w3
    buffer_store_dwordx4 v[36:39], v92, s[16:19], s67 offen sc1
    v_cmp_lt_u32 vcc, 16, v43
    s_add_u32 s67, s67, 8000000
    s_mov_b64 exec, vcc
    s_cbranch_execz F_w3
    ds_read_b128 v[44:47], v94 offset:9472
    s_waitcnt lgkmcnt(0)
    v_mov_b32 v47, s88
    buffer_store_dwordx4 v[44:47], v92, s[16:19], s67 offen sc1
    s_nop 1
F_w3:
    s_mov_b64 exec, -1
    s_cmp_eq_u32 s20, 7
    s_cbranch_scc0 F_nofrag
    s_cmp_lt_u32 s2, 160
    s_cbranch_scc0 F_nofrag
    v_or_b32 v176, v176, v180
    v_or_b32 v177, v177, v181
    v_or_b32 v178, v178, v182
    v_or_b32 v179, v179, v183
    s_lshl_b32 s66, s2, 10
    s_add_u32 s66, s66, 1024
    buffer_store_dwordx4 v[176:179], v86, s[16:19], s66 offen sc1
F_nofrag:
    s_barrier
    s_mul_i32 s24, s2, 32000
    s_lshl_b32 s25, s20, 12
    s_add_u32 s24, s24, s25
    s_add_u32 s24, s24, 164864
    s_add_u32 s25, s24, 8000000
    s_add_u32 s26, s25, 8000000
    v_mov_b32 v22, 0
    v_mov_b32 v23, s88
    s_mul_i32 s68, s20, 5120
    s_cmp_ge_u32 s20, 4
    s_cselect_b32 s70, 45056, 0
    s_add_u32 s68, s68, s70
    v_add_u32 v2, s68, v86
    ds_write_b128 v2, v[96:99] offset:0
    ds_write_b128 v2, v[100:103] offset:1024
    ds_write_b128 v2, v[104:107] offset:2048
    ds_write_b128 v2, v[108:111] offset:3072
    ds_write_b128 v2, v[112:115] offset:4096
    v_mov_b32 v4, 2130738944
    v_mov_b32 v5, 2130738944
    v_mov_b32 v6, 2130738944
    v_mov_b32 v7, 2130738944
    v_lshlrev_b32 v2, 4, v0
    v_add_u32 v3, 86016, v2
    ds_write_b128 v3, v[4:7] offset:0
    ds_write_b128 v3, v[4:7] offset:8192
    ds_write_b128 v3, v[4:7] offset:16384
    ds_write_b128 v3, v[4:7] offset:24576
    ds_write_b128 v3, v[4:7] offset:32768
    ds_write_b128 v3, v[4:7] offset:40960
    ds_write_b128 v3, v[4:7] offset:49152
    ds_write_b128 v3, v[4:7] offset:57344
    v_add_u32 v3, 0x10000, v3
    ds_write_b128 v3, v[4:7] offset:0
    v_min_u32 v2, 3056, v2
    v_add_u32 v2, 159744, v2
    ds_write_b128 v2, v[4:7]
    s_sub_u32 s72, s72, 128
    s_subb_u32 s73, s73, 0
    s_mov_b32 s4, s72
    s_and_b32 s5, s73, 0xffff
    s_mov_b32 s6, 10240000
    s_mov_b32 s7, 0x20000
    s_sub_u32 s72, s72, 1024
    s_subb_u32 s73, s73, 0
    s_mov_b32 s8, s72
    s_and_b32 s9, s73, 0xffff
    s_mov_b32 s10, 10241024
    s_mov_b32 s11, 0x20000
    s_mov_b32 s12, s76
    s_and_b32 s13, s77, 0xffff
    s_mov_b32 s14, 10240000
    s_mov_b32 s15, 0x20000
    v_lshrrev_b32 v2, 5, v1
    v_bfe_u32 v3, v1, 2, 2
    v_and_b32 v4, 3, v1
    v_bfe_u32 v5, v1, 4, 1
    v_lshlrev_b32 v6, 9, v2
    v_lshl_add_u32 v6, v3, 7, v6
    v_lshl_add_u32 v6, v5, 5, v6
    v_lshl_add_u32 v6, v4, 3, v6
    v_lshrrev_b32 v7, 1, v3
    v_lshl_add_u32 v6, v7, 6, v6
    v_add_u32 v244, s21, v6
    v_xor_b32 v245, 64, v244
    v_lshlrev_b32 v6, 7, v2
    v_lshl_add_u32 v6, v7, 5, v6
    v_and_b32 v7, 1, v3
    v_xor_b32 v7, 1, v7
    v_mul_u32_u24 v7, 90112, v7
    v_add_u32 v6, v6, v7
    v_lshl_add_u32 v249, v4, 3, v6
    v_lshl_add_u32 v6, v2, 2, v4
    v_bfe_u32 v7, v1, 2, 1
    v_lshl_add_u32 v6, v7, 3, v6
    v_lshlrev_b32 v6, 3, v6
    v_bfe_u32 v7, v1, 3, 1
    v_add_u32 v5, 1, v5
    v_mul_u32_u24 v7, v7, v5
    v_lshl_add_u32 v250, v7, 1, v6
    v_and_b32 v6, 0x38, v1
    v_add_u32 v247, 6, v6
    v_lshrrev_b32 v6, 2, v1
    v_lshrrev_b32 v7, 4, v1
    v_xor_b32 v6, v6, v7
    v_and_b32 v6, 1, v6
    v_lshlrev_b32 v6, 6, v6
    v_lshl_add_u32 v246, v4, 4, v6
    v_mov_b32 v242, 1.0
    v_mov_b32 v243, 1.0
    s_mov_b32 s54, 0xffffff00
    s_mov_b32 s55, 0xffffff00
    s_mov_b32 s56, 0xffff
    s_mov_b32 s57, 0xffff
    s_mov_b32 s58, 0
    s_mov_b32 s59, 134217856
    s_mov_b32 s60, 262272
    s_mov_b32 s61, 402915456
    s_mov_b32 s62, 940179840
    s_mov_b32 s63, 403046528
    s_mov_b32 s64, 402784384
    s_mov_b32 s65, 134348928
    s_mov_b32 s38, 128
    s_mov_b32 s33, -1
    s_and_b32 s68, s20, 3
    s_lshl_b32 s68, s68, 2
    s_lshr_b32 s69, s20, 2
    s_add_u32 s68, s68, s69
    s_lshl_b32 s68, s68, 4
    s_add_u32 s68, s68, 163072
    v_mov_b32 v251, s68
    s_mov_b32 s53, 0
    s_mov_b32 s50, 0
    s_mov_b32 s51, 0
    s_mov_b32 s47, 0
    s_mov_b32 s42, 0
    s_mov_b32 s3, 0
    s_mov_b32 s89, 0
    s_mov_b32 s34, 128
    s_mov_b32 s35, 384
    s_mov_b32 s36, 640
    s_mov_b32 s37, 896
    s_waitcnt lgkmcnt(0)
    s_barrier
    buffer_load_dwordx4 v[8:11], v86, s[16:19], s24 offen offset:0 sc1
    buffer_load_dwordx4 v[12:15], v86, s[16:19], s24 offen offset:1024 sc1
    buffer_load_dwordx4 v[16:19], v86, s[16:19], s24 offen offset:2048 sc1
    s_mov_b64 exec, s[22:23]
    buffer_load_dwordx4 v[20:23], v86, s[16:19], s24 offen offset:3072 sc1
    s_mov_b64 exec, -1
    ds_read_b128 v[96:99], v86 offset:0
    ds_read_b128 v[100:103], v86 offset:1024
    ds_read_b128 v[104:107], v86 offset:2048
    ds_read_b128 v[108:111], v86 offset:3072
    ds_read_b128 v[112:115], v86 offset:4096
    ds_read_b128 v[116:119], v86 offset:5120
    ds_read_b128 v[120:123], v86 offset:6144
    ds_read_b128 v[124:127], v86 offset:7168
    ds_read_b128 v[128:131], v86 offset:8192
    ds_read_b128 v[132:135], v86 offset:9216
    ds_read_b128 v[136:139], v86 offset:10240
    ds_read_b128 v[140:143], v86 offset:11264
    ds_read_b128 v[144:147], v86 offset:12288
    ds_read_b128 v[148:151], v86 offset:13312
    ds_read_b128 v[152:155], v86 offset:14336
    ds_read_b128 v[156:159], v86 offset:15360
    ds_read_b128 v[160:163], v86 offset:16384
    ds_read_b128 v[164:167], v86 offset:17408
    ds_read_b128 v[168:171], v86 offset:18432
    ds_read_b128 v[172:175], v86 offset:19456
    s_mov_b32 s27, 32768
    s_mov_b32 s71, 162816
    v_mov_b32 v3, 1
    s_cmp_eq_u32 s20, 7
    s_cselect_b32 s52, 160, 0
    v_cmp_gt_u32 s[68:69], 40, v1
    s_mov_b64 s[28:29], 0xff
    s_lshr_b32 s66, s2, 3
    s_lshl_b32 s66, s66, 3
    s_add_u32 s66, s66, s20
    s_mul_i32 s66, s66, 16
    v_min_u32 v93, 15, v1
    v_add_u32 v93, s66, v93
    v_lshlrev_b32 v93, 10, v93
    v_mov_b32 v94, 0x7f000000
F_poll:
    s_waitcnt vmcnt(0)
F_poll1:
    v_cmp_ne_u32 s[72:73], s88, v11
    v_cmp_ne_u32 s[74:75], s88, v15
    v_cmp_ne_u32 s[76:77], s88, v19
    v_cmp_ne_u32 s[78:79], s88, v23
    s_or_b64 s[80:81], s[72:73], s[74:75]
    s_or_b64 s[82:83], s[76:77], s[78:79]
    s_or_b64 s[80:81], s[80:81], s[82:83]
    s_cbranch_scc1 F_again
F_got:
    v_bfe_u32 v2, v10, 23, 5
    v_bfe_u32 v60, v10, 11, 6
    v_cmp_gt_u32 s[80:81], v2, v91
    v_lshl_add_u32 v60, v60, 2, s71
    v_cmp_lt_u32 s[72:73], 8, v2
    v_max_u32 v89, v89, v2
    s_mov_b64 exec, s[80:81]
    ds_add_rtn_u32 v72, v60, v3
    s_mov_b64 exec, s[72:73]
    s_cbranch_execz F_h0
    buffer_load_dwordx4 v[24:27], v86, s[16:19], s25 offen offset:0 sc1
    v_sub_u32 v56, v2, v91
    v_bfe_u32 v64, v10, 17, 6
    v_cmp_lt_u32 vcc, 8, v56
    v_lshl_add_u32 v64, v64, 2, s71
    s_mov_b64 exec, vcc
    ds_add_rtn_u32 v76, v64, v3
F_h0:
    s_mov_b64 exec, -1
    v_bfe_u32 v2, v14, 23, 5
    v_bfe_u32 v61, v14, 11, 6
    v_cmp_gt_u32 s[82:83], v2, v91
    v_lshl_add_u32 v61, v61, 2, s71
    v_cmp_lt_u32 s[74:75], 8, v2
    v_max_u32 v89, v89, v2
    s_mov_b64 exec, s[82:83]
    ds_add_rtn_u32 v73, v61, v3
    s_mov_b64 exec, s[74:75]
    s_cbranch_execz F_h1
    buffer_load_dwordx4 v[28:31], v86, s[16:19], s25 offen offset:1024 sc1
    v_sub_u32 v57, v2, v91
    v_bfe_u32 v65, v14, 17, 6
    v_cmp_lt_u32 vcc, 8, v57
    v_lshl_add_u32 v65, v65, 2, s71
    s_mov_b64 exec, vcc
    ds_add_rtn_u32 v77, v65, v3
F_h1:
    s_mov_b64 exec, -1
    v_bfe_u32 v2, v18, 23, 5
    v_bfe_u32 v62, v18, 11, 6
    v_cmp_gt_u32 s[84:85], v2, v91
    v_lshl_add_u32 v62, v62, 2, s71
    v_cmp_lt_u32 s[76:77], 8, v2
    v_max_u32 v89, v89, v2
    s_mov_b64 exec, s[84:85]
    ds_add_rtn_u32 v74, v62, v3
    s_mov_b64 exec, s[76:77]
    s_cbranch_execz F_h2
    buffer_load_dwordx4 v[32:35], v86, s[16:19], s25 offen offset:2048 sc1
    v_sub_u32 v58, v2, v91
    v_bfe_u32 v66, v18, 17, 6
    v_cmp_lt_u32 vcc, 8, v58
    v_lshl_add_u32 v66, v66, 2, s71
    s_mov_b64 exec, vcc
    ds_add_rtn_u32 v78, v66, v3
F_h2:
    s_mov_b64 exec, -1
    v_bfe_u32 v2, v22, 23, 5
    v_bfe_u32 v63, v22, 11, 6
    v_cmp_gt_u32 s[86:87], v2, v91
    v_lshl_add_u32 v63, v63, 2, s71
    v_cmp_lt_u32 s[78:79], 8, v2
    v_max_u32 v89, v89, v2
    s_mov_b64 exec, s[86:87]
    ds_add_rtn_u32 v75, v63, v3
    s_mov_b64 exec, s[78:79]
    s_cbranch_execz F_h3
    buffer_load_dwordx4 v[36:39], v86, s[16:19], s25 offen offset:3072 sc1
    v_sub_u32 v59, v2, v91
    v_bfe_u32 v67, v22, 17, 6
    v_cmp_lt_u32 vcc, 8, v59
    v_lshl_add_u32 v67, v67, 2, s71
    s_mov_b64 exec, vcc
    ds_add_rtn_u32 v79, v67, v3
F_h3:
    s_mov_b64 exec, -1
    v_cmp_lt_u32 s[30:31], 16, v89
    s_mov_b32 s27, 262144
    s_cmp_lg_u64 s[30:31], 0
    s_cbranch_scc1 F_l3
F_l3r:
    v_and_b32 v10, 0x7ff, v10
    v_lshl_add_u32 v10, v10, 5, v90
    v_or_b32 v11, 16, v10
    v_and_b32 v14, 0x7ff, v14
    v_lshl_add_u32 v14, v14, 5, v90
    v_add_u32 v14, 327680, v14
    v_or_b32 v15, 16, v14
    v_and_b32 v18, 0x7ff, v18
    v_lshl_add_u32 v18, v18, 5, v90
    v_add_u32 v18, 655360, v18
    v_or_b32 v19, 16, v18
    v_and_b32 v22, 0x7ff, v22
    v_lshl_add_u32 v22, v22, 5, v90
    v_add_u32 v22, 983040, v22
    v_or_b32 v23, 16, v22
    s_cmp_lt_u32 s2, s52
    s_cbranch_scc1 F_flag
F_flagr:
    s_waitcnt lgkmcnt(0)
    s_barrier
    ds_read_b32 v4, v88
    buffer_load_dword v95, v93, s[4:7], 0 offen offset:128
    v_lshlrev_b32 v72, 3, v72
    v_lshlrev_b32 v73, 3, v73
    v_lshlrev_b32 v74, 3, v74
    v_lshlrev_b32 v75, 3, v75
    v_lshlrev_b32 v76, 3, v76
    v_lshlrev_b32 v77, 3, v77
    v_lshlrev_b32 v78, 3, v78
    v_lshlrev_b32 v79, 3, v79
    s_waitcnt lgkmcnt(0)
    v_add_u32 v5, 15, v4
    v_cmp_lt_u32 vcc, 64, v4
    v_lshrrev_b32 v5, 4, v5
    v_med3_u32 v5, v5, 1, 4
    v_mul_u32_u24 v6, 640, v5
    v_max_u32 v6, 1536, v6
    v_cndmask_b32 v6, 0, v6, s[68:69]
    s_cmp_lg_u64 vcc, 0
    s_cbranch_scc1 SLOW
    v_mov_b32 v7, v6
    v_add_u32 v2, 7, v4
    v_lshrrev_b32 v2, 3, v2
    v_add_u32_dpp v7, v7, v7 row_shr:1 row_mask:0xf bank_mask:0xf
    v_max_u32 v2, 2, v2
    v_cmp_eq_u32 vcc, 7, v2
    v_add_u32_dpp v7, v7, v7 row_shr:2 row_mask:0xf bank_mask:0xf
    v_lshlrev_b32 v92, 22, v5
    v_lshlrev_b32 v5, 18, v5
    v_add_u32_dpp v7, v7, v7 row_shr:4 row_mask:0xf bank_mask:0xf
    v_lshl_or_b32 v5, v1, 21, v5
    v_addc_co_u32 v2, vcc, 0, v2, vcc
    v_add_u32_dpp v7, v7, v7 row_shr:8 row_mask:0xf bank_mask:0xf
    v_lshl_or_b32 v5, v2, 28, v5
    v_med3_u32 v2, v2, 3, 7
    v_add_u32_dpp v7, v7, v7 row_bcast:15 row_mask:0xa bank_mask:0xf
    v_cndmask_b32 v2, 0, v2, s[68:69]
    v_mov_b32 v84, 63
    v_add_u32_dpp v7, v7, v7 row_bcast:31 row_mask:0xc bank_mask:0xf
    s_mov_b32 s71, 0x2000
    v_readlane_b32 s66, v7, 63
    v_sub_u32 v7, v7, v6
    v_add_u32 v7, 86016, v7
    v_lshrrev_b32 v6, 3, v7
    v_mad_u32_u24 v92, v7, s71, v92
    v_or_b32 v92, v92, v6
    v_cmp_eq_u32 vcc, 7, v2
    v_or_b32 v6, v5, v7
    s_cmp_gt_u32 s66, 76800
    s_cbranch_scc1 SLOW
    v_mbcnt_lo_u32_b32 v5, vcc_lo, 0
    v_mbcnt_hi_u32_b32 v5, vcc_hi, v5
    s_bcnt1_i32_b64 s66, vcc
    v_cndmask_b32 v84, v84, v5, vcc
    v_cmp_eq_u32 vcc, 6, v2
    v_mov_b32 v3, s66
    s_nop 0
    v_mbcnt_lo_u32_b32 v5, vcc_lo, v3
    v_mbcnt_hi_u32_b32 v5, vcc_hi, v5
    s_bcnt1_i32_b64 s67, vcc
    v_cndmask_b32 v84, v84, v5, vcc
    v_cmp_eq_u32 vcc, 5, v2
    s_add_u32 s67, s67, s66
    v_mov_b32 v3, s67
    v_mbcnt_lo_u32_b32 v5, vcc_lo, v3
    v_mbcnt_hi_u32_b32 v5, vcc_hi, v5
    s_bcnt1_i32_b64 s70, vcc
    v_cndmask_b32 v84, v84, v5, vcc
    v_cmp_eq_u32 vcc, 4, v2
    s_add_u32 s70, s70, s67
    v_mov_b32 v3, s70
    v_mbcnt_lo_u32_b32 v5, vcc_lo, v3
    v_mbcnt_hi_u32_b32 v5, vcc_hi, v5
    s_bcnt1_i32_b64 s71, vcc
    v_cndmask_b32 v84, v84, v5, vcc
    v_cmp_eq_u32 vcc, 3, v2
    s_add_u32 s71, s71, s70
    v_mov_b32 v3, s71
    v_mbcnt_lo_u32_b32 v5, vcc_lo, v3
    v_mbcnt_hi_u32_b32 v5, vcc_hi, v5
    v_cndmask_b32 v84, v84, v5, vcc
    s_add_u32 s71, s70, s66
    s_add_u32 s68, s71, s67
    s_andn2_b32 s70, s70, 3
    s_add_u32 s69, s70, 4
    s_andn2_b32 s67, s67, 3
    v_lshrrev_b32 v3, 1, v84
    v_mov_b32 v2, s68
    v_xor_b32 v3, v3, v84
    v_bfi_b32 v3, 4, v3, v84
    v_cmpx_gt_u32 vcc, s69, v84
    v_mov_b32 v2, s66
    v_cmpx_gt_u32 vcc, s70, v84
    v_mov_b32 v2, s71
    v_cmpx_gt_u32 vcc, s67, v84
    v_mov_b32 v2, 0
    s_mov_b64 exec, -1
    v_add_u32 v2, v2, v84
    v_bfi_b32 v84, 3, v2, v3
    s_lshr_b32 s66, s2, 3
    v_add_u32 v2, s66, v84
    v_lshlrev_b32 v2, 3, v2
    v_add_u32 v2, v2, v84
    v_cmp_gt_u32 vcc, 32, v84
    v_and_b32 v2, 24, v2
    v_and_or_b32 v2, v84, 7, v2
    v_cndmask_b32 v84, v84, v2, vcc
    v_subrev_u32 v2, 4, v84
    v_and_b32 v2, 0x80000000, v2
    v_or_b32 v92, v92, v2
    ds_bpermute_b32 v60, v60, v92
    ds_bpermute_b32 v61, v61, v92
    ds_bpermute_b32 v62, v62, v92
    ds_bpermute_b32 v63, v63, v92
    ds_bpermute_b32 v64, v64, v92
    ds_bpermute_b32 v65, v65, v92
    ds_bpermute_b32 v66, v66, v92
    ds_bpermute_b32 v67, v67, v92
    v_cmp_eq_u32 vcc, s20, v84
    s_ff1_i32_b64 s67, vcc
    s_waitcnt lgkmcnt(7)
    v_cmp_gt_i32 vcc, 0, v60
    v_and_b32 v60, 0x7fffffff, v60
    s_and_b64 exec, vcc, s[80:81]
    buffer_load_dword v95, v10, s[12:15], 0 offen
    s_mov_b64 exec, -1
    v_mad_u32_u16 v2, v60, 8, v72
    v_mad_u32_u16 v3, v60, 8, v72 op_sel:[1,0,0,0]
    s_mov_b64 exec, s[80:81]
    ds_write_b64 v2, v[10:11]
    ds_write_b64 v3, v[8:9]
    s_mov_b64 exec, -1
    s_waitcnt lgkmcnt(8)
    v_cmp_gt_i32 vcc, 0, v61
    v_and_b32 v61, 0x7fffffff, v61
    s_and_b64 exec, vcc, s[82:83]
    buffer_load_dword v95, v14, s[12:15], 0 offen
    s_mov_b64 exec, -1
    v_mad_u32_u16 v2, v61, 8, v73
    v_mad_u32_u16 v3, v61, 8, v73 op_sel:[1,0,0,0]
    s_mov_b64 exec, s[82:83]
    ds_write_b64 v2, v[14:15]
    ds_write_b64 v3, v[12:13]
    s_mov_b64 exec, -1
    s_waitcnt lgkmcnt(9)
    v_cmp_gt_i32 vcc, 0, v62
    v_and_b32 v62, 0x7fffffff, v62
    s_and_b64 exec, vcc, s[84:85]
    buffer_load_dword v95, v18, s[12:15], 0 offen
    s_mov_b64 exec, -1
    v_mad_u32_u16 v2, v62, 8, v74
    v_mad_u32_u16 v3, v62, 8, v74 op_sel:[1,0,0,0]
    s_mov_b64 exec, s[84:85]
    ds_write_b64 v2, v[18:19]
    ds_write_b64 v3, v[16:17]
    s_mov_b64 exec, -1
    s_waitcnt lgkmcnt(10)
    v_cmp_gt_i32 vcc, 0, v63
    v_and_b32 v63, 0x7fffffff, v63
    s_and_b64 exec, vcc, s[86:87]
    buffer_load_dword v95, v22, s[12:15], 0 offen
    s_mov_b64 exec, -1
    v_mad_u32_u16 v2, v63, 8, v75
    v_mad_u32_u16 v3, v63, 8, v75 op_sel:[1,0,0,0]
    s_mov_b64 exec, s[86:87]
    ds_write_b64 v2, v[22:23]
    ds_write_b64 v3, v[20:21]
    s_mov_b64 exec, -1
    v_readlane_b32 s80, v6, s67
    s_waitcnt vmcnt(5) lgkmcnt(8)
    s_mov_b64 exec, s[72:73]
    s_cbranch_execz F_s0
F_sp0:
    v_cmp_ne_u32 vcc, s88, v27
    s_cbranch_vccnz F_sa0
F_sg0:
    v_cmpx_lt_u32 vcc, 8, v56
    v_and_b32 v26, 0x7ff, v26
    v_lshl_add_u32 v26, v26, 5, v90
    v_or_b32 v27, 16, v26
    v_cmp_gt_i32 vcc, 0, v64
    v_and_b32 v64, 0x7fffffff, v64
    s_and_saveexec_b64 s[82:83], vcc
    s_cbranch_execz F_x0
    buffer_load_dword v95, v26, s[12:15], 0 offen
F_x0:
    s_mov_b64 exec, s[82:83]
    v_mad_u32_u16 v2, v64, 8, v76
    v_mad_u32_u16 v3, v64, 8, v76 op_sel:[1,0,0,0]
    ds_write_b64 v2, v[26:27]
    ds_write_b64 v3, v[24:25]
F_s0:
    s_mov_b64 exec, s[74:75]
    s_cbranch_execz F_s1
F_sp1:
    v_cmp_ne_u32 vcc, s88, v31
    s_cbranch_vccnz F_sa1
F_sg1:
    v_cmpx_lt_u32 vcc, 8, v57
    v_and_b32 v30, 0x7ff, v30
    v_lshl_add_u32 v30, v30, 5, v90
    v_add_u32 v30, 327680, v30
    v_or_b32 v31, 16, v30
    v_cmp_gt_i32 vcc, 0, v65
    v_and_b32 v65, 0x7fffffff, v65
    s_and_saveexec_b64 s[82:83], vcc
    s_cbranch_execz F_x1
    buffer_load_dword v95, v30, s[12:15], 0 offen
F_x1:
    s_mov_b64 exec, s[82:83]
    v_mad_u32_u16 v2, v65, 8, v77
    v_mad_u32_u16 v3, v65, 8, v77 op_sel:[1,0,0,0]
    ds_write_b64 v2, v[30:31]
    ds_write_b64 v3, v[28:29]
F_s1:
    s_mov_b64 exec, s[76:77]
    s_cbranch_execz F_s2
F_sp2:
    v_cmp_ne_u32 vcc, s88, v35
    s_cbranch_vccnz F_sa2
F_sg2:
    v_cmpx_lt_u32 vcc, 8, v58
    v_and_b32 v34, 0x7ff, v34
    v_lshl_add_u32 v34, v34, 5, v90
    v_add_u32 v34, 655360, v34
    v_or_b32 v35, 16, v34
    v_cmp_gt_i32 vcc, 0, v66
    v_and_b32 v66, 0x7fffffff, v66
    s_and_saveexec_b64 s[82:83], vcc
    s_cbranch_execz F_x2
    buffer_load_dword v95, v34, s[12:15], 0 offen
F_x2:
    s_mov_b64 exec, s[82:83]
    v_mad_u32_u16 v2, v66, 8, v78
    v_mad_u32_u16 v3, v66, 8, v78 op_sel:[1,0,0,0]
    ds_write_b64 v2, v[34:35]
    ds_write_b64 v3, v[32:33]
F_s2:
    s_mov_b64 exec, s[78:79]
    s_cbranch_execz F_s3
F_sp3:
    v_cmp_ne_u32 vcc, s88, v39
    s_cbranch_vccnz F_sa3
F_sg3:
    v_cmpx_lt_u32 vcc, 8, v59
    v_and_b32 v38, 0x7ff, v38
    v_lshl_add_u32 v38, v38, 5, v90
    v_add_u32 v38, 983040, v38
    v_or_b32 v39, 16, v38
    v_cmp_gt_i32 vcc, 0, v67
    v_and_b32 v67, 0x7fffffff, v67
    s_and_saveexec_b64 s[82:83], vcc
    s_cbranch_execz F_x3
    buffer_load_dword v95, v38, s[12:15], 0 offen
F_x3:
    s_mov_b64 exec, s[82:83]
    v_mad_u32_u16 v2, v67, 8, v79
    v_mad_u32_u16 v3, v67, 8, v79 op_sel:[1,0,0,0]
    ds_write_b64 v2, v[38:39]
    ds_write_b64 v3, v[36:37]
F_s3:
    s_mov_b64 exec, -1
    s_cmp_lg_u64 s[30:31], 0
    s_cbranch_scc1 F_u
F_ur:
    s_mov_b32 s22, s80
    s_mov_b32 s27, s80
    s_mov_b32 s71, s80
    s_bfe_u32 s46, s71, 0x30012
    s_mov_b32 m0, s46
    s_and_b32 s66, s71, 0x3ffff
    s_movrels_b32 s68, s57
    s_movrels_b32 s69, s61
    s_sub_u32 s48, s66, s47
    s_mov_b32 s47, s66
    s_lshr_b32 s52, s71, 28
    s_lshl_b32 s67, s46, 9
    s_add_u32 s66, s66, s67
    s_sub_u32 s49, s66, s42
    s_mov_b32 s42, s66
    s_bfe_u32 s66, s68, 655360
    s_add_u32 s43, s42, s66
    s_bfe_u32 s39, s69, 655360
    s_bfe_u32 s66, s68, 655370
    s_add_u32 s44, s42, s66
    s_bfe_u32 s40, s69, 655370
    s_bfe_u32 s66, s68, 655380
    s_add_u32 s45, s42, s66
    s_bfe_u32 s41, s69, 655380
    s_and_b32 s66, s46, s33
    s_cselect_b32 s72, -1, 1
    s_cselect_b32 s76, s47, 163712
    s_cmp_ge_u32 s66, 2
    s_cselect_b32 s73, -1, 0
    s_add_u32 s77, s47, 1024
    s_cmp_ge_u32 s66, 4
    s_cselect_b32 s75, -1, 0
    s_cmp_ge_u32 s66, 3
    s_cselect_b32 s74, -1, 1
    s_cselect_b32 s77, s77, 163712
    s_mul_i32 s66, s20, 80
    v_min_u32 v2, 76, v248
    s_waitcnt lgkmcnt(0)
    s_barrier
    v_add_u32 v253, s47, v248
    ds_read_b32 v254, v253
    ds_read_b32 v255, v253 offset:256
    v_add_u32 v252, s42, v247
    ds_read_u16 v234, v252
    ds_read_u16 v235, v252 offset:64
    v_add_u32 v252, s43, v247
    ds_read_u16 v236, v252
    ds_read_u16 v237, v252 offset:64
    v_add_u32 v252, s44, v247
    ds_read_u16 v238, v252
    ds_read_u16 v239, v252 offset:64
    v_add_u32 v252, s45, v247
    ds_read_u16 v240, v252
    ds_read_u16 v241, v252 offset:64
    buffer_load_dword v3, v2, s[16:19], s66 offen offset:128 sc1
    v_add_u32 v249, s48, v249
    v_add_u32 v250, s49, v250
    s_waitcnt lgkmcnt(8)
    s_mov_b32 m0, s76
    s_mov_b64 exec, s[72:73]
    buffer_load_dwordx4 v254, s[12:15], 0 offen  lds
    s_mov_b32 m0, s77
    s_mov_b64 exec, s[74:75]
    buffer_load_dwordx4 v255, s[12:15], 0 offen  lds
    s_mov_b64 exec, -1
    s_waitcnt lgkmcnt(0)
    s_add_u32 m0, s21, 0
    v_lshl_add_u32 v234, v234, 10, v246
    v_lshl_add_u32 v235, v235, 10, v246
    buffer_load_dwordx4 v234, s[4:7], s38 offen  lds
    buffer_load_dwordx4 v235, s[8:11], s38 offen offset:1024  lds
    s_add_u32 m0, s21, 2048
    v_lshl_add_u32 v236, v236, 10, v246
    v_lshl_add_u32 v237, v237, 10, v246
    buffer_load_dwordx4 v236, s[4:7], s39 offen  lds
    buffer_load_dwordx4 v237, s[8:11], s39 offen offset:1024  lds
    s_add_u32 m0, s21, 4096
    v_lshl_add_u32 v238, v238, 10, v246
    v_lshl_add_u32 v239, v239, 10, v246
    buffer_load_dwordx4 v238, s[4:7], s40 offen  lds
    buffer_load_dwordx4 v239, s[8:11], s40 offen offset:1024  lds
    s_add_u32 m0, s21, 6144
    v_lshl_add_u32 v240, v240, 10, v246
    v_lshl_add_u32 v241, v241, 10, v246
    buffer_load_dwordx4 v240, s[4:7], s41 offen  lds
    buffer_load_dwordx4 v241, s[8:11], s41 offen offset:1024  lds
    v_lshrrev_b32 v8, 3, v84
    v_and_b32 v9, 7, v84
    v_lshlrev_b32 v9, 13, v9
    v_mul_u32_u24 v8, 1536, v8
    v_lshlrev_b32 v10, 4, v84
    v_and_b32 v5, 128, v10
    v_add3_u32 v8, v8, v9, v5
    v_xor_b32 v9, v10, v7
    v_and_b32 v9, 128, v9
    v_add_u32 v9, v9, v7
    v_mov_b32 v5, v9
    s_add_u32 s66, s20, 0
    v_cmp_eq_u32 vcc, s66, v84
    s_ff1_i32_b64 s67, vcc
    v_readlane_b32 s28, v5, s67
    s_add_u32 s66, s20, 8
    v_cmp_eq_u32 vcc, s66, v84
    s_ff1_i32_b64 s67, vcc
    v_readlane_b32 s29, v5, s67
    v_readlane_b32 s23, v6, s67
    s_add_u32 s66, s20, 16
    v_cmp_eq_u32 vcc, s66, v84
    s_ff1_i32_b64 s67, vcc
    v_readlane_b32 s30, v5, s67
    v_readlane_b32 s24, v6, s67
    s_add_u32 s66, s20, 24
    v_cmp_eq_u32 vcc, s66, v84
    s_ff1_i32_b64 s67, vcc
    v_readlane_b32 s31, v5, s67
    v_readlane_b32 s25, v6, s67
    s_add_u32 s66, s20, 32
    v_cmp_eq_u32 vcc, s66, v84
    s_ff1_i32_b64 s67, vcc
    v_readlane_b32 s32, v5, s67
    v_readlane_b32 s26, v6, s67
    v_lshlrev_b32 v4, 3, v84
    v_add_u32 v4, 163328, v4
    s_mov_b32 exec_hi, 0xff
    ds_write_b64 v4, v[8:9]
    s_mov_b32 exec_hi, -1
    s_waitcnt lgkmcnt(0)
    v_mov_b32 v252, 0
    s_waitcnt vmcnt(6)
    v_cmp_ne_u32 vcc, s88, v3
    ds_read_b64_tr_b16 v[176:177], v244 offset:0
    ds_read_b64_tr_b16 v[178:179], v244 offset:1024
    ds_read_b64_tr_b16 v[180:181], v245 offset:0
    ds_read_b64_tr_b16 v[182:183], v245 offset:1024
    ds_read_b64_tr_b16 v[64:65], v249 offset:0
    ds_read_b64_tr_b16 v[68:69], v249 offset:64
    ds_read_b64_tr_b16 v[66:67], v249 offset:256
    ds_read_b64_tr_b16 v[70:71], v249 offset:320
    s_mov_b64 exec, s[54:55]
    ds_read_u16_d16_hi v242, v250 offset:0
    s_mov_b64 exec, -1
    s_or_b32 s89, vcc_lo, vcc_hi
    s_add_u32 s53, s53, 4
    s_xor_b32 s66, s53, s20
    s_bitcmp1_b32 s66, 2
    s_setprio 1
    s_cbranch_scc1 PRIO_1
    s_setprio 0
PRIO_1:
    s_cmp_eq_u32 s52, 4
    s_cbranch_scc1 ITEM_0_4
    s_cmp_eq_u32 s52, 5
    s_cbranch_scc1 ITEM_0_5
    s_cmp_eq_u32 s52, 3
    s_cbranch_scc1 ITEM_0_3
    s_cmp_eq_u32 s52, 6
    s_cbranch_scc1 ITEM_0_6
    s_cmp_eq_u32 s52, 8
    s_cbranch_scc1 ITEM_0_8
    s_branch ITEM_0_2
F_again:
    s_sub_u32 s27, s27, 1
    s_cbranch_scc1 F_late
    s_cmp_eq_u64 s[72:73], 0
    s_cbranch_scc1 F_p0
    s_mov_b64 exec, s[72:73]
    buffer_load_dwordx4 v[8:11], v86, s[16:19], s24 offen offset:0 sc1
    s_mov_b64 exec, -1
F_p0:
    s_cmp_eq_u64 s[74:75], 0
    s_cbranch_scc1 F_p1
    s_mov_b64 exec, s[74:75]
    buffer_load_dwordx4 v[12:15], v86, s[16:19], s24 offen offset:1024 sc1
    s_mov_b64 exec, -1
F_p1:
    s_cmp_eq_u64 s[76:77], 0
    s_cbranch_scc1 F_p2
    s_mov_b64 exec, s[76:77]
    buffer_load_dwordx4 v[16:19], v86, s[16:19], s24 offen offset:2048 sc1
    s_mov_b64 exec, -1
F_p2:
    s_cmp_eq_u64 s[78:79], 0
    s_cbranch_scc1 F_p3
    s_mov_b64 exec, s[78:79]
    buffer_load_dwordx4 v[20:23], v86, s[16:19], s24 offen offset:3072 sc1
    s_mov_b64 exec, -1
F_p3:
    s_branch F_poll
F_late:
    v_mov_b32 v2, 163064
    v_mov_b32 v4, 1000
    ds_write_b32 v2, v4
    v_mov_b32 v10, 0
    v_mov_b32 v14, 0
    v_mov_b32 v18, 0
    v_mov_b32 v22, 0
    s_branch F_got
F_l3:
    v_bfe_u32 v2, v10, 23, 5
    v_sub_u32 v56, v2, v91
    v_cmp_lt_u32 vcc, 16, v2
    s_mov_b64 exec, vcc
    s_cbranch_execz F_t0
F_tp0:
    buffer_load_dwordx4 v[40:43], v86, s[16:19], s26 offen offset:0 sc1
    s_waitcnt vmcnt(0)
    v_cmp_ne_u32 vcc, s88, v43
    s_sub_u32 s27, s27, 1
    s_cselect_b64 vcc, 0, vcc
    s_cmp_eq_u64 vcc, 0
    s_cbranch_scc0 F_tp0
    v_bfe_u32 v68, v42, 11, 6
    v_lshl_add_u32 v68, v68, 2, s71
    v_cmp_lt_i32 vcc, 16, v56
    s_mov_b64 exec, vcc
    ds_add_rtn_u32 v80, v68, v3
F_t0:
    s_mov_b64 exec, -1
    v_bfe_u32 v2, v14, 23, 5
    v_sub_u32 v57, v2, v91
    v_cmp_lt_u32 vcc, 16, v2
    s_mov_b64 exec, vcc
    s_cbranch_execz F_t1
F_tp1:
    buffer_load_dwordx4 v[44:47], v86, s[16:19], s26 offen offset:1024 sc1
    s_waitcnt vmcnt(0)
    v_cmp_ne_u32 vcc, s88, v47
    s_sub_u32 s27, s27, 1
    s_cselect_b64 vcc, 0, vcc
    s_cmp_eq_u64 vcc, 0
    s_cbranch_scc0 F_tp1
    v_bfe_u32 v69, v46, 11, 6
    v_lshl_add_u32 v69, v69, 2, s71
    v_cmp_lt_i32 vcc, 16, v57
    s_mov_b64 exec, vcc
    ds_add_rtn_u32 v81, v69, v3
F_t1:
    s_mov_b64 exec, -1
    v_bfe_u32 v2, v18, 23, 5
    v_sub_u32 v58, v2, v91
    v_cmp_lt_u32 vcc, 16, v2
    s_mov_b64 exec, vcc
    s_cbranch_execz F_t2
F_tp2:
    buffer_load_dwordx4 v[48:51], v86, s[16:19], s26 offen offset:2048 sc1
    s_waitcnt vmcnt(0)
    v_cmp_ne_u32 vcc, s88, v51
    s_sub_u32 s27, s27, 1
    s_cselect_b64 vcc, 0, vcc
    s_cmp_eq_u64 vcc, 0
    s_cbranch_scc0 F_tp2
    v_bfe_u32 v70, v50, 11, 6
    v_lshl_add_u32 v70, v70, 2, s71
    v_cmp_lt_i32 vcc, 16, v58
    s_mov_b64 exec, vcc
    ds_add_rtn_u32 v82, v70, v3
F_t2:
    s_mov_b64 exec, -1
    v_bfe_u32 v2, v22, 23, 5
    v_sub_u32 v59, v2, v91
    v_cmp_lt_u32 vcc, 16, v2
    s_mov_b64 exec, vcc
    s_cbranch_execz F_t3
F_tp3:
    buffer_load_dwordx4 v[52:55], v86, s[16:19], s26 offen offset:3072 sc1
    s_waitcnt vmcnt(0)
    v_cmp_ne_u32 vcc, s88, v55
    s_sub_u32 s27, s27, 1
    s_cselect_b64 vcc, 0, vcc
    s_cmp_eq_u64 vcc, 0
    s_cbranch_scc0 F_tp3
    v_bfe_u32 v71, v54, 11, 6
    v_lshl_add_u32 v71, v71, 2, s71
    v_cmp_lt_i32 vcc, 16, v59
    s_mov_b64 exec, vcc
    ds_add_rtn_u32 v83, v71, v3
F_t3:
    s_mov_b64 exec, -1
    v_mov_b32 v2, 163068
    v_mov_b32 v4, 1000
    v_cmp_lt_u32 vcc, 24, v89
    s_mov_b64 exec, vcc
    ds_write_b32 v2, v4
    s_mov_b64 exec, -1
    s_branch F_l3r
F_flag:
    s_lshl_b32 s66, s2, 2
    v_mov_b32 v2, 128
    v_mov_b32 v4, s88
    s_mov_b64 exec, 1
    buffer_store_dword v4, v2, s[16:19], s66 offen sc1
    s_mov_b64 exec, -1
    s_branch F_flagr
F_sa0:
    s_sub_u32 s27, s27, 1
    s_cbranch_scc1 F_sg0
    buffer_load_dwordx4 v[24:27], v86, s[16:19], s25 offen offset:0 sc1
    s_waitcnt vmcnt(0)
    s_branch F_sp0
F_sa1:
    s_sub_u32 s27, s27, 1
    s_cbranch_scc1 F_sg1
    buffer_load_dwordx4 v[28:31], v86, s[16:19], s25 offen offset:1024 sc1
    s_waitcnt vmcnt(0)
    s_branch F_sp1
F_sa2:
    s_sub_u32 s27, s27, 1
    s_cbranch_scc1 F_sg2
    buffer_load_dwordx4 v[32:35], v86, s[16:19], s25 offen offset:2048 sc1
    s_waitcnt vmcnt(0)
    s_branch F_sp2
F_sa3:
    s_sub_u32 s27, s27, 1
    s_cbranch_scc1 F_sg3
    buffer_load_dwordx4 v[36:39], v86, s[16:19], s25 offen offset:3072 sc1
    s_waitcnt vmcnt(0)
    s_branch F_sp3
F_u:
    ds_bpermute_b32 v68, v68, v92
    ds_bpermute_b32 v69, v69, v92
    ds_bpermute_b32 v70, v70, v92
    ds_bpermute_b32 v71, v71, v92
    s_waitcnt lgkmcnt(0)
    v_cmp_lt_i32 vcc, 16, v56
    s_mov_b64 exec, vcc
    s_cbranch_execz F_u0
    v_lshlrev_b32 v80, 3, v80
    v_and_b32 v42, 0x7ff, v42
    v_lshl_add_u32 v42, v42, 5, v90
    v_or_b32 v43, 16, v42
    v_and_b32 v68, 0x7fffffff, v68
    v_mad_u32_u16 v2, v68, 8, v80
    v_mad_u32_u16 v3, v68, 8, v80 op_sel:[1,0,0,0]
    ds_write_b64 v2, v[42:43]
    ds_write_b64 v3, v[40:41]
F_u0:
    s_mov_b64 exec, -1
    v_cmp_lt_i32 vcc, 16, v57
    s_mov_b64 exec, vcc
    s_cbranch_execz F_u1
    v_lshlrev_b32 v81, 3, v81
    v_and_b32 v46, 0x7ff, v46
    v_lshl_add_u32 v46, v46, 5, v90
    v_add_u32 v46, 327680, v46
    v_or_b32 v47, 16, v46
    v_and_b32 v69, 0x7fffffff, v69
    v_mad_u32_u16 v2, v69, 8, v81
    v_mad_u32_u16 v3, v69, 8, v81 op_sel:[1,0,0,0]
    ds_write_b64 v2, v[46:47]
    ds_write_b64 v3, v[44:45]
F_u1:
    s_mov_b64 exec, -1
    v_cmp_lt_i32 vcc, 16, v58
    s_mov_b64 exec, vcc
    s_cbranch_execz F_u2
    v_lshlrev_b32 v82, 3, v82
    v_and_b32 v50, 0x7ff, v50
    v_lshl_add_u32 v50, v50, 5, v90
    v_add_u32 v50, 655360, v50
    v_or_b32 v51, 16, v50
    v_and_b32 v70, 0x7fffffff, v70
    v_mad_u32_u16 v2, v70, 8, v82
    v_mad_u32_u16 v3, v70, 8, v82 op_sel:[1,0,0,0]
    ds_write_b64 v2, v[50:51]
    ds_write_b64 v3, v[48:49]
F_u2:
    s_mov_b64 exec, -1
    v_cmp_lt_i32 vcc, 16, v59
    s_mov_b64 exec, vcc
    s_cbranch_execz F_u3
    v_lshlrev_b32 v83, 3, v83
    v_and_b32 v54, 0x7ff, v54
    v_lshl_add_u32 v54, v54, 5, v90
    v_add_u32 v54, 983040, v54
    v_or_b32 v55, 16, v54
    v_and_b32 v71, 0x7fffffff, v71
    v_mad_u32_u16 v2, v71, 8, v83
    v_mad_u32_u16 v3, v71, 8, v83 op_sel:[1,0,0,0]
    ds_write_b64 v2, v[54:55]
    ds_write_b64 v3, v[52:53]
F_u3:
    s_mov_b64 exec, -1
    s_branch F_ur
LAST0:
    s_cmp_eq_u32 s50, 5
    s_cbranch_scc1 TO_PHASE1
    s_add_u32 s4, s4, 128
    s_addc_u32 s5, s5, 0
    s_add_u32 s8, s8, 128
    s_addc_u32 s9, s9, 0
    s_mov_b32 s34, 0
    s_mov_b32 s35, 256
    s_mov_b32 s36, 512
    s_mov_b32 s37, 768
    s_mov_b32 s33, 0
    s_add_u32 s53, s53, 4
    s_xor_b32 s66, s53, s20
    s_bitcmp1_b32 s66, 2
    s_setprio 1
    s_cbranch_scc1 PRIO_2
    s_setprio 0
PRIO_2:
    s_cmp_eq_u32 s52, 4
    s_cbranch_scc1 ITEM_0_4
    s_cmp_eq_u32 s52, 5
    s_cbranch_scc1 ITEM_0_5
    s_cmp_eq_u32 s52, 3
    s_cbranch_scc1 ITEM_0_3
    s_cmp_eq_u32 s52, 6
    s_cbranch_scc1 ITEM_0_6
    s_cmp_eq_u32 s52, 8
    s_cbranch_scc1 ITEM_0_8
    s_branch ITEM_0_2
TO_PHASE1:
    ds_read_b32 v252, v251 offset:16
    v_lshlrev_b32 v253, 2, v248
    v_add_u32 v253, 65536, v253
    ds_read_b128 v[96:99], v253 offset:0
    ds_read_b128 v[100:103], v253 offset:1024
    ds_read_b128 v[104:107], v253 offset:2048
    ds_read_b128 v[108:111], v253 offset:3072
    ds_read_b128 v[112:115], v253 offset:4096
    ds_read_b128 v[116:119], v253 offset:5120
    ds_read_b128 v[120:123], v253 offset:6144
    ds_read_b128 v[124:127], v253 offset:7168
    ds_read_b128 v[128:131], v253 offset:8192
    ds_read_b128 v[132:135], v253 offset:9216
    ds_read_b128 v[136:139], v253 offset:10240
    ds_read_b128 v[140:143], v253 offset:11264
    ds_read_b128 v[144:147], v253 offset:12288
    ds_read_b128 v[148:151], v253 offset:13312
    ds_read_b128 v[152:155], v253 offset:14336
    ds_read_b128 v[156:159], v253 offset:15360
    ds_read_b128 v[160:163], v253 offset:16384
    ds_read_b128 v[164:167], v253 offset:17408
    ds_read_b128 v[168:171], v253 offset:18432
    ds_read_b128 v[172:175], v253 offset:19456
    s_lshl_b32 s66, s20, 4
    v_xor_b32 v248, s66, v248
    s_mov_b32 s34, 128
    s_mov_b32 s35, 384
    s_mov_b32 s36, 640
    s_mov_b32 s37, 896
    s_mov_b32 s50, 0
    s_waitcnt lgkmcnt(0)
    s_waitcnt lgkmcnt(0)
    v_readfirstlane_b32 s66, v252
    s_add_u32 s53, s53, 1
    v_mov_b32 v252, s53
    s_cmp_le_u32 s53, s66
    ds_write2_b32 v251, v252, v252 offset0:0 offset1:8
    s_setprio 1
    s_cbranch_scc1 PRIO_3
    s_setprio 0
PRIO_3:
    s_cmp_eq_u32 s52, 4
    s_cbranch_scc1 ITEM_1_4
    s_cmp_eq_u32 s52, 5
    s_cbranch_scc1 ITEM_1_5
    s_cmp_eq_u32 s52, 3
    s_cbranch_scc1 ITEM_1_3
    s_cmp_eq_u32 s52, 6
    s_cbranch_scc1 ITEM_1_6
    s_cmp_eq_u32 s52, 8
    s_cbranch_scc1 ITEM_1_8
    s_branch ITEM_1_2
LAST1:
    s_cmp_eq_u32 s89, 0
    s_cbranch_scc1 T_flagsL
    s_mul_i32 s66, s20, 80
    v_min_u32 v2, 76, v248
    s_mov_b32 s67, 262144
T_pollL:
    buffer_load_dword v3, v2, s[16:19], s66 offen offset:128 sc1
    s_waitcnt vmcnt(0)
    v_cmp_ne_u32 vcc, s88, v3
    s_sub_u32 s67, s67, 1
    s_cselect_b64 vcc, 0, vcc
    s_cmp_eq_u64 vcc, 0
    s_cbranch_scc0 T_pollL
    s_mov_b32 s89, 0
T_flagsL:
    s_lshl_b32 s66, s20, 4
    v_xor_b32 v246, s66, v248
    v_lshlrev_b32 v246, 2, v246
    s_mul_i32 s51, s20, 20480
    s_add_u32 s51, s51, 1024
    s_load_dwordx2 s[72:73], s[0:1], 72
    s_waitcnt lgkmcnt(7)
    v_readfirstlane_b32 s66, v252
    s_add_u32 s53, s53, 1
    v_mov_b32 v252, s53
    s_cmp_le_u32 s53, s66
    ds_write2_b32 v251, v252, v252 offset0:0 offset1:8
    s_setprio 3
    s_cbranch_scc1 PRIO_4
    s_setprio 2
PRIO_4:
    s_cmp_eq_u32 s52, 4
    s_cbranch_scc1 ITEM_1_4
    s_cmp_eq_u32 s52, 5
    s_cbranch_scc1 ITEM_1_5
    s_cmp_eq_u32 s52, 3
    s_cbranch_scc1 ITEM_1_3
    s_cmp_eq_u32 s52, 6
    s_cbranch_scc1 ITEM_1_6
    s_cmp_eq_u32 s52, 8
    s_cbranch_scc1 ITEM_1_8
    s_branch ITEM_1_2
.p2align 6
ITEM_0_4:
    s_mov_b64 exec, s[54:55]
    ds_read_u16_d16_hi v243, v250 offset:128
    s_mov_b64 exec, -1
    ds_read_b64_tr_b16 v[72:73], v249 offset:512
    ds_read_b64_tr_b16 v[76:77], v249 offset:576
    ds_read_b64_tr_b16 v[74:75], v249 offset:768
    ds_read_b64_tr_b16 v[78:79], v249 offset:832
    s_waitcnt lgkmcnt(5)
    v_mul_f32_dpp v196, v242, v64 row_newbcast:0 row_mask:0xf bank_mask:0xf
    v_mul_f32_dpp v197, v242, v65 row_newbcast:1 row_mask:0xf bank_mask:0xf
    v_mul_f32_dpp v198, v242, v64 row_newbcast:8 row_mask:0xf bank_mask:0xf
    v_mul_f32_dpp v199, v242, v65 row_newbcast:9 row_mask:0xf bank_mask:0xf
    v_mul_f32_dpp v200, v242, v68 row_newbcast:2 row_mask:0xf bank_mask:0xf
    v_mul_f32_dpp v201, v242, v69 row_newbcast:3 row_mask:0xf bank_mask:0xf
    v_mul_f32_dpp v202, v242, v68 row_newbcast:10 row_mask:0xf bank_mask:0xf
    v_mul_f32_dpp v203, v242, v69 row_newbcast:11 row_mask:0xf bank_mask:0xf
    v_cvt_pk_bf16_f32 v64, v196, v197
    v_cvt_pk_bf16_f32 v68, v198, v199
    v_cvt_pk_bf16_f32 v65, v200, v201
    v_cvt_pk_bf16_f32 v69, v202, v203
    v_mul_f32_dpp v196, v242, v66 row_newbcast:4 row_mask:0xf bank_mask:0xf
    v_mul_f32_dpp v197, v242, v67 row_newbcast:5 row_mask:0xf bank_mask:0xf
    v_mul_f32_dpp v198, v242, v66 row_newbcast:12 row_mask:0xf bank_mask:0xf
    v_mul_f32_dpp v199, v242, v67 row_newbcast:13 row_mask:0xf bank_mask:0xf
    v_mul_f32_dpp v200, v242, v70 row_newbcast:6 row_mask:0xf bank_mask:0xf
    v_mul_f32_dpp v201, v242, v71 row_newbcast:7 row_mask:0xf bank_mask:0xf
    v_mul_f32_dpp v202, v242, v70 row_newbcast:14 row_mask:0xf bank_mask:0xf
    v_mul_f32_dpp v203, v242, v71 row_newbcast:15 row_mask:0xf bank_mask:0xf
    v_cvt_pk_bf16_f32 v66, v196, v197
    v_cvt_pk_bf16_f32 v70, v198, v199
    v_cvt_pk_bf16_f32 v67, v200, v201
    v_cvt_pk_bf16_f32 v71, v202, v203
    s_nop 0
    s_waitcnt vmcnt(4) lgkmcnt(0)
    v_mfma_f32_32x32x16_bf16 v[0:15], v[64:67], v[176:179], 0
    v_mul_f32_dpp v196, v243, v72 row_newbcast:0 row_mask:0xf bank_mask:0xf
    v_mul_f32_dpp v197, v243, v73 row_newbcast:1 row_mask:0xf bank_mask:0xf
    v_mul_f32_dpp v198, v243, v72 row_newbcast:8 row_mask:0xf bank_mask:0xf
    v_mul_f32_dpp v199, v243, v73 row_newbcast:9 row_mask:0xf bank_mask:0xf
    v_mul_f32_dpp v200, v243, v76 row_newbcast:2 row_mask:0xf bank_mask:0xf
    v_mul_f32_dpp v201, v243, v77 row_newbcast:3 row_mask:0xf bank_mask:0xf
    v_mul_f32_dpp v202, v243, v76 row_newbcast:10 row_mask:0xf bank_mask:0xf
    v_mul_f32_dpp v203, v243, v77 row_newbcast:11 row_mask:0xf bank_mask:0xf
    v_cvt_pk_bf16_f32 v72, v196, v197
    v_cvt_pk_bf16_f32 v76, v198, v199
    v_cvt_pk_bf16_f32 v73, v200, v201
    v_cvt_pk_bf16_f32 v77, v202, v203
    s_add_u32 m0, s21, 0
    v_mfma_f32_32x32x16_bf16 v[16:31], v[68:71], v[176:179], 0
    buffer_load_dwordx4 v234, s[4:7], s36 offen  lds
    buffer_load_dwordx4 v235, s[8:11], s36 offen offset:1024  lds
    ds_read_b64_tr_b16 v[176:177], v244 offset:2048
    ds_read_b64_tr_b16 v[178:179], v244 offset:3072
    ds_read_b64_tr_b16 v[184:185], v245 offset:2048
    ds_read_b64_tr_b16 v[186:187], v245 offset:3072
    v_mul_f32_dpp v196, v243, v74 row_newbcast:4 row_mask:0xf bank_mask:0xf
    v_mul_f32_dpp v197, v243, v75 row_newbcast:5 row_mask:0xf bank_mask:0xf
    v_mul_f32_dpp v198, v243, v74 row_newbcast:12 row_mask:0xf bank_mask:0xf
    v_mul_f32_dpp v199, v243, v75 row_newbcast:13 row_mask:0xf bank_mask:0xf
    v_mul_f32_dpp v200, v243, v78 row_newbcast:6 row_mask:0xf bank_mask:0xf
    v_mul_f32_dpp v201, v243, v79 row_newbcast:7 row_mask:0xf bank_mask:0xf
    v_mul_f32_dpp v202, v243, v78 row_newbcast:14 row_mask:0xf bank_mask:0xf
    v_mul_f32_dpp v203, v243, v79 row_newbcast:15 row_mask:0xf bank_mask:0xf
    v_cvt_pk_bf16_f32 v74, v196, v197
    v_cvt_pk_bf16_f32 v78, v198, v199
    v_cvt_pk_bf16_f32 v75, v200, v201
    v_cvt_pk_bf16_f32 v79, v202, v203
    s_nop 0
    s_waitcnt lgkmcnt(0)
    v_mfma_f32_32x32x16_bf16 v[0:15], v[72:75], v[176:179], v[0:15]
    s_add_u32 m0, s21, 2048
    v_mfma_f32_32x32x16_bf16 v[16:31], v[76:79], v[176:179], v[16:31]
    buffer_load_dwordx4 v236, s[4:7], s36 offen  lds
    buffer_load_dwordx4 v237, s[8:11], s36 offen offset:1024  lds
    s_mov_b32 m0, s50
    s_nop 0
    s_movrels_b32 s71, s23
    s_bfe_u32 s46, s71, 0x30012
    s_mov_b32 m0, s46
    s_and_b32 s66, s71, 0x3ffff
    s_movrels_b32 s68, s57
    s_movrels_b32 s69, s61
    s_sub_u32 s48, s66, s47
    s_mov_b32 s47, s66
    s_lshr_b32 s52, s71, 28
    s_lshl_b32 s67, s46, 9
    s_add_u32 s66, s66, s67
    s_sub_u32 s49, s66, s42
    s_mov_b32 s42, s66
    s_bfe_u32 s66, s68, 655360
    s_add_u32 s43, s42, s66
    s_bfe_u32 s39, s69, 655360
    s_bfe_u32 s66, s68, 655370
    s_add_u32 s44, s42, s66
    s_bfe_u32 s40, s69, 655370
    s_bfe_u32 s66, s68, 655380
    s_add_u32 s45, s42, s66
    s_bfe_u32 s41, s69, 655380
    s_and_b32 s66, s46, s33
    s_cselect_b32 s72, -1, 1
    s_cselect_b32 s76, s47, 163712
    s_cmp_ge_u32 s66, 2
    s_cselect_b32 s73, -1, 0
    s_add_u32 s77, s47, 1024
    s_cmp_ge_u32 s66, 4
    s_cselect_b32 s75, -1, 0
    s_cmp_ge_u32 s66, 3
    s_cselect_b32 s74, -1, 1
    s_cselect_b32 s77, s77, 163712
    v_add_u32 v252, s44, v247
    ds_read_u16 v238, v252
    ds_read_u16 v239, v252 offset:64
    v_add_u32 v252, s45, v247
    ds_read_u16 v240, v252
    ds_read_u16 v241, v252 offset:64
    v_mfma_f32_32x32x16_bf16 v[32:47], v[64:67], v[180:183], 0
    v_mul_f32 v196, v0, v96
    v_fmac_f32 v196, v1, v97
    v_fmac_f32 v196, v2, v98
    v_fmac_f32 v196, v3, v99
    v_fmac_f32 v196, v4, v100
    v_fmac_f32 v196, v5, v101
    v_fmac_f32 v196, v6, v102
    v_fmac_f32 v196, v7, v103
    v_mul_f32 v198, v8, v128
    v_fmac_f32 v198, v9, v129
    v_mfma_f32_32x32x16_bf16 v[48:63], v[68:71], v[180:183], 0
    s_waitcnt vmcnt(6)
    ds_read_b64_tr_b16 v[176:177], v244 offset:4096
    ds_read_b64_tr_b16 v[178:179], v244 offset:5120
    ds_read_b64_tr_b16 v[180:181], v245 offset:4096
    ds_read_b64_tr_b16 v[182:183], v245 offset:5120
    v_fmac_f32 v198, v10, v130
    v_fmac_f32 v198, v11, v131
    v_fmac_f32 v198, v12, v132
    v_fmac_f32 v198, v13, v133
    v_fmac_f32 v198, v14, v134
    v_fmac_f32 v198, v15, v135
    v_mul_f32 v200, v16, v128
    v_fmac_f32 v200, v17, v129
    v_permlane32_swap_b32 v196, v198
    v_mfma_f32_32x32x16_bf16 v[32:47], v[72:75], v[184:187], v[32:47]
    v_fmac_f32 v200, v18, v130
    v_fmac_f32 v200, v19, v131
    v_fmac_f32 v200, v20, v132
    v_fmac_f32 v200, v21, v133
    v_fmac_f32 v200, v22, v134
    v_fmac_f32 v200, v23, v135
    v_add_f32 v198, v196, v198
    v_mul_f32_e64 v202, v24, -v128
    v_fma_f32 v202, v25, -v129, v202
    v_mfma_f32_32x32x16_bf16 v[48:63], v[76:79], v[184:187], v[48:63]
    v_fma_f32 v202, v26, -v130, v202
    v_fma_f32 v202, v27, -v131, v202
    v_fma_f32 v202, v28, -v132, v202
    v_fma_f32 v202, v29, -v133, v202
    v_fma_f32 v202, v30, -v134, v202
    v_fma_f32 v202, v31, -v135, v202
    s_nop 1
    v_permlane32_swap_b32 v200, v202
    v_add_f32 v202, v200, v202
    s_waitcnt vmcnt(4) lgkmcnt(0)
    v_mfma_f32_32x32x16_bf16 v[0:15], v[64:67], v[176:179], 0
    v_mul_f32 v197, v32, v104
    v_fmac_f32 v197, v33, v105
    v_fmac_f32 v197, v34, v106
    v_fmac_f32 v197, v35, v107
    v_fmac_f32 v197, v36, v108
    v_fmac_f32 v197, v37, v109
    v_fmac_f32 v197, v38, v110
    v_fmac_f32 v197, v39, v111
    v_mul_f32 v199, v40, v136
    v_fmac_f32 v199, v41, v137
    v_fmac_f32 v199, v42, v138
    s_add_u32 m0, s21, 4096
    v_mfma_f32_32x32x16_bf16 v[16:31], v[68:71], v[176:179], 0
    buffer_load_dwordx4 v234, s[4:7], s37 offen  lds
    buffer_load_dwordx4 v235, s[8:11], s37 offen offset:1024  lds
    ds_read_b64_tr_b16 v[176:177], v244 offset:6144
    ds_read_b64_tr_b16 v[178:179], v244 offset:7168
    ds_read_b64_tr_b16 v[184:185], v245 offset:6144
    ds_read_b64_tr_b16 v[186:187], v245 offset:7168
    v_add_u32 v252, s42, v247
    ds_read_u16 v234, v252
    ds_read_u16 v235, v252 offset:64
    v_fmac_f32 v199, v43, v139
    v_fmac_f32 v199, v44, v140
    v_fmac_f32 v199, v45, v141
    v_fmac_f32 v199, v46, v142
    v_fmac_f32 v199, v47, v143
    v_mul_f32 v201, v48, v136
    v_fmac_f32 v201, v49, v137
    v_permlane32_swap_b32 v197, v199
    v_fmac_f32 v201, v50, v138
    v_fmac_f32 v201, v51, v139
    s_waitcnt lgkmcnt(2)
    v_mfma_f32_32x32x16_bf16 v[0:15], v[72:75], v[176:179], v[0:15]
    v_fmac_f32 v201, v52, v140
    v_fmac_f32 v201, v53, v141
    v_fmac_f32 v201, v54, v142
    v_fmac_f32 v201, v55, v143
    v_add_f32 v199, v197, v199
    v_mul_f32_e64 v203, v56, -v136
    v_fma_f32 v203, v57, -v137, v203
    v_fma_f32 v203, v58, -v138, v203
    v_fma_f32 v203, v59, -v139, v203
    v_fma_f32 v203, v60, -v140, v203
    v_fma_f32 v203, v61, -v141, v203
    s_add_u32 m0, s21, 6144
    v_mfma_f32_32x32x16_bf16 v[16:31], v[76:79], v[176:179], v[16:31]
    buffer_load_dwordx4 v236, s[4:7], s37 offen  lds
    buffer_load_dwordx4 v237, s[8:11], s37 offen offset:1024  lds
    v_add_u32 v252, s43, v247
    ds_read_u16 v236, v252
    ds_read_u16 v237, v252 offset:64
    v_fma_f32 v203, v62, -v142, v203
    v_fma_f32 v203, v63, -v143, v203
    s_nop 1
    v_permlane32_swap_b32 v201, v203
    v_add_f32 v203, v201, v203
    s_set_gpr_idx_on s51, gpr_idx(DST)
    s_nop 0
    v_cvt_pk_bf16_f32 v204, v198, v199
    v_cvt_pk_bf16_f32 v205, v202, v203
    s_set_gpr_idx_off
    v_mfma_f32_32x32x16_bf16 v[32:47], v[64:67], v[180:183], 0
    v_mul_f32 v196, v0, v144
    v_fmac_f32 v196, v1, v145
    v_fmac_f32 v196, v2, v146
    v_fmac_f32 v196, v3, v147
    v_fmac_f32 v196, v4, v148
    v_fmac_f32 v196, v5, v149
    v_fmac_f32 v196, v6, v150
    v_fmac_f32 v196, v7, v151
    v_mfma_f32_32x32x16_bf16 v[48:63], v[68:71], v[180:183], 0
    v_add_u32 v253, s47, v248
    ds_read_b32 v254, v253
    ds_read_b32 v255, v253 offset:256
    s_waitcnt vmcnt(6)
    ds_read_b64_tr_b16 v[176:177], v244 offset:0
    ds_read_b64_tr_b16 v[178:179], v244 offset:1024
    ds_read_b64_tr_b16 v[180:181], v245 offset:0
    ds_read_b64_tr_b16 v[182:183], v245 offset:1024
    v_mul_f32 v198, v8, v112
    v_fmac_f32 v198, v9, v113
    v_fmac_f32 v198, v10, v114
    v_fmac_f32 v198, v11, v115
    v_fmac_f32 v198, v12, v116
    v_fmac_f32 v198, v13, v117
    v_fmac_f32 v198, v14, v118
    v_fmac_f32 v198, v15, v119
    v_mfma_f32_32x32x16_bf16 v[32:47], v[72:75], v[184:187], v[32:47]
    v_mul_f32_e64 v200, v16, -v160
    v_fma_f32 v200, v17, -v161, v200
    v_fma_f32 v200, v18, -v162, v200
    v_fma_f32 v200, v19, -v163, v200
    v_fma_f32 v200, v20, -v164, v200
    v_fma_f32 v200, v21, -v165, v200
    v_fma_f32 v200, v22, -v166, v200
    v_fma_f32 v200, v23, -v167, v200
    v_mfma_f32_32x32x16_bf16 v[48:63], v[76:79], v[184:187], v[48:63]
    v_mul_f32_e64 v202, v24, -v160
    v_fma_f32 v202, v25, -v161, v202
    v_fma_f32 v202, v26, -v162, v202
    v_fma_f32 v202, v27, -v163, v202
    v_fma_f32 v202, v28, -v164, v202
    v_fma_f32 v202, v29, -v165, v202
    v_fma_f32 v202, v30, -v166, v202
    v_fma_f32 v202, v31, -v167, v202
    s_waitcnt vmcnt(4) lgkmcnt(0)
    v_mfma_f32_32x32x16_bf16 v[0:15], v[64:67], v[176:179], 0
    v_mul_f32 v197, v32, v152
    v_fmac_f32 v197, v33, v153
    v_fmac_f32 v197, v34, v154
    v_fmac_f32 v197, v35, v155
    v_fmac_f32 v197, v36, v156
    v_fmac_f32 v197, v37, v157
    v_fmac_f32 v197, v38, v158
    v_fmac_f32 v197, v39, v159
    s_add_u32 m0, s21, 0
    v_mfma_f32_32x32x16_bf16 v[16:31], v[68:71], v[176:179], 0
    v_lshl_add_u32 v234, v234, 10, v246
    v_lshl_add_u32 v235, v235, 10, v246
    buffer_load_dwordx4 v234, s[4:7], s38 offen  lds
    buffer_load_dwordx4 v235, s[8:11], s38 offen offset:1024  lds
    ds_read_b64_tr_b16 v[176:177], v244 offset:2048
    ds_read_b64_tr_b16 v[178:179], v244 offset:3072
    ds_read_b64_tr_b16 v[184:185], v245 offset:2048
    ds_read_b64_tr_b16 v[186:187], v245 offset:3072
    v_mul_f32 v199, v40, v120
    v_fmac_f32 v199, v41, v121
    v_fmac_f32 v199, v42, v122
    v_fmac_f32 v199, v43, v123
    v_fmac_f32 v199, v44, v124
    v_fmac_f32 v199, v45, v125
    v_fmac_f32 v199, v46, v126
    v_fmac_f32 v199, v47, v127
    s_waitcnt lgkmcnt(0)
    v_mfma_f32_32x32x16_bf16 v[0:15], v[72:75], v[176:179], v[0:15]
    v_mul_f32_e64 v201, v48, -v168
    v_fma_f32 v201, v49, -v169, v201
    v_fma_f32 v201, v50, -v170, v201
    v_fma_f32 v201, v51, -v171, v201
    v_fma_f32 v201, v52, -v172, v201
    v_fma_f32 v201, v53, -v173, v201
    v_fma_f32 v201, v54, -v174, v201
    v_fma_f32 v201, v55, -v175, v201
    s_add_u32 m0, s21, 2048
    v_mfma_f32_32x32x16_bf16 v[16:31], v[76:79], v[176:179], v[16:31]
    v_lshl_add_u32 v236, v236, 10, v246
    v_lshl_add_u32 v237, v237, 10, v246
    buffer_load_dwordx4 v236, s[4:7], s39 offen  lds
    buffer_load_dwordx4 v237, s[8:11], s39 offen offset:1024  lds
    s_mov_b32 m0, s76
    s_mov_b64 exec, s[72:73]
    buffer_load_dwordx4 v254, s[12:15], 0 offen  lds
    s_mov_b32 m0, s77
    s_mov_b64 exec, s[74:75]
    buffer_load_dwordx4 v255, s[12:15], 0 offen  lds
    s_mov_b64 exec, -1
    v_mul_f32_e64 v203, v56, -v168
    v_fma_f32 v203, v57, -v169, v203
    v_fma_f32 v203, v58, -v170, v203
    v_fma_f32 v203, v59, -v171, v203
    v_fma_f32 v203, v60, -v172, v203
    v_fma_f32 v203, v61, -v173, v203
    v_fma_f32 v203, v62, -v174, v203
    v_fma_f32 v203, v63, -v175, v203
    v_mfma_f32_32x32x16_bf16 v[32:47], v[64:67], v[180:183], 0
    v_mul_f32 v254, v0, v144
    v_fmac_f32 v254, v1, v145
    v_fmac_f32 v254, v2, v146
    v_fmac_f32 v254, v3, v147
    v_fmac_f32 v254, v4, v148
    v_mfma_f32_32x32x16_bf16 v[48:63], v[68:71], v[180:183], 0
    ds_swizzle_b32 v68, v68 offset:0x401F
    ds_swizzle_b32 v69, v69 offset:0x401F
    ds_swizzle_b32 v70, v70 offset:0x401F
    ds_swizzle_b32 v71, v71 offset:0x401F
    s_waitcnt vmcnt(8)
    ds_read_b64_tr_b16 v[176:177], v244 offset:4096
    ds_read_b64_tr_b16 v[178:179], v244 offset:5120
    ds_read_b64_tr_b16 v[180:181], v245 offset:4096
    ds_read_b64_tr_b16 v[182:183], v245 offset:5120
    v_fmac_f32 v254, v5, v149
    v_fmac_f32 v254, v6, v150
    v_fmac_f32 v254, v7, v151
    v_fmac_f32 v200, v8, v160
    v_mfma_f32_32x32x16_bf16 v[32:47], v[72:75], v[184:187], v[32:47]
    v_fmac_f32 v200, v9, v161
    v_permlane32_swap_b32 v196, v254
    v_fmac_f32 v200, v10, v162
    v_fmac_f32 v200, v11, v163
    v_fmac_f32 v200, v12, v164
    v_mfma_f32_32x32x16_bf16 v[48:63], v[76:79], v[184:187], v[48:63]
    ds_swizzle_b32 v76, v76 offset:0x401F
    ds_swizzle_b32 v77, v77 offset:0x401F
    ds_swizzle_b32 v78, v78 offset:0x401F
    ds_swizzle_b32 v79, v79 offset:0x401F
    v_fmac_f32 v200, v13, v165
    v_fmac_f32 v200, v14, v166
    v_fmac_f32 v200, v15, v167
    v_add_f32 v254, v196, v254
    s_waitcnt lgkmcnt(8)
    s_mov_b64 exec, s[56:57]
    v_xor_b32 v68, 0x80008000, v68
    v_xor_b32 v69, 0x80008000, v69
    v_xor_b32 v70, 0x80008000, v70
    v_xor_b32 v71, 0x80008000, v71
    s_mov_b64 exec, -1
    s_waitcnt vmcnt(6) lgkmcnt(4)
    v_mfma_f32_32x32x16_bf16 v[0:15], v[64:67], v[176:179], 0
    v_mul_f32 v255, v32, v152
    v_fmac_f32 v255, v33, v153
    v_fmac_f32 v255, v34, v154
    v_fmac_f32 v255, v35, v155
    v_fmac_f32 v255, v36, v156
    v_fmac_f32 v255, v37, v157
    s_add_u32 m0, s21, 4096
    v_mfma_f32_32x32x16_bf16 v[16:31], v[68:71], v[176:179], v[16:31]
    v_lshl_add_u32 v238, v238, 10, v246
    v_lshl_add_u32 v239, v239, 10, v246
    buffer_load_dwordx4 v238, s[4:7], s40 offen  lds
    buffer_load_dwordx4 v239, s[8:11], s40 offen offset:1024  lds
    ds_read_b64_tr_b16 v[176:177], v244 offset:6144
    ds_read_b64_tr_b16 v[178:179], v244 offset:7168
    ds_read_b64_tr_b16 v[184:185], v245 offset:6144
    ds_read_b64_tr_b16 v[186:187], v245 offset:7168
    v_fmac_f32 v255, v38, v158
    v_fmac_f32 v255, v39, v159
    v_fmac_f32 v201, v40, v168
    v_fmac_f32 v201, v41, v169
    v_permlane32_swap_b32 v197, v255
    s_waitcnt lgkmcnt(0)
    s_mov_b64 exec, s[56:57]
    v_xor_b32 v76, 0x80008000, v76
    v_xor_b32 v77, 0x80008000, v77
    v_xor_b32 v78, 0x80008000, v78
    v_xor_b32 v79, 0x80008000, v79
    s_mov_b64 exec, -1
    v_mfma_f32_32x32x16_bf16 v[0:15], v[72:75], v[176:179], v[0:15]
    v_fmac_f32 v201, v42, v170
    v_fmac_f32 v201, v43, v171
    v_fmac_f32 v201, v44, v172
    v_fmac_f32 v201, v45, v173
    v_fmac_f32 v201, v46, v174
    v_fmac_f32 v201, v47, v175
    s_add_u32 m0, s21, 6144
    v_mfma_f32_32x32x16_bf16 v[16:31], v[76:79], v[176:179], v[16:31]
    v_lshl_add_u32 v240, v240, 10, v246
    v_lshl_add_u32 v241, v241, 10, v246
    buffer_load_dwordx4 v240, s[4:7], s41 offen  lds
    buffer_load_dwordx4 v241, s[8:11], s41 offen offset:1024  lds
    v_add_f32 v255, v197, v255
    s_set_gpr_idx_on s51, gpr_idx(DST)
    s_nop 0
    v_cvt_pk_bf16_f32 v206, v254, v255
    s_set_gpr_idx_off
    v_mfma_f32_32x32x16_bf16 v[32:47], v[64:67], v[180:183], 0
    v_mul_f32 v254, v0, v144
    v_fmac_f32 v254, v1, v145
    v_fmac_f32 v254, v2, v146
    v_fmac_f32 v254, v3, v147
    v_fmac_f32 v254, v4, v148
    v_fmac_f32 v254, v5, v149
    v_fmac_f32 v254, v6, v150
    v_fmac_f32 v254, v7, v151
    v_fma_f32 v202, v8, -v160, v202
    v_fma_f32 v202, v9, -v161, v202
    v_mfma_f32_32x32x16_bf16 v[48:63], v[68:71], v[180:183], v[48:63]
    s_waitcnt vmcnt(8)
    ds_read_b64_tr_b16 v[176:177], v244 offset:0
    ds_read_b64_tr_b16 v[178:179], v244 offset:1024
    ds_read_b64_tr_b16 v[180:181], v245 offset:0
    ds_read_b64_tr_b16 v[182:183], v245 offset:1024
    v_permlane32_swap_b32 v254, v200
    v_fma_f32 v202, v10, -v162, v202
    v_fma_f32 v202, v11, -v163, v202
    v_fma_f32 v202, v12, -v164, v202
    v_fma_f32 v202, v13, -v165, v202
    v_fma_f32 v202, v14, -v166, v202
    v_fma_f32 v202, v15, -v167, v202
    v_add_f32 v200, v254, v200
    v_fmac_f32 v198, v16, v112
    v_permlane32_swap_b32 v202, v254
    v_mfma_f32_32x32x16_bf16 v[32:47], v[72:75], v[184:187], v[32:47]
    v_fmac_f32 v198, v17, v113
    v_fmac_f32 v198, v18, v114
    v_fmac_f32 v198, v19, v115
    v_fmac_f32 v198, v20, v116
    v_fmac_f32 v198, v21, v117
    v_fmac_f32 v198, v22, v118
    v_fmac_f32 v198, v23, v119
    v_add_f32 v254, v202, v254
    v_mul_f32 v196, v24, v160
    v_fmac_f32 v196, v25, v161
    v_mfma_f32_32x32x16_bf16 v[48:63], v[76:79], v[184:187], v[48:63]
    v_add_u32 v249, s48, v249
    v_add_u32 v250, s49, v250
    s_waitcnt vmcnt(4)
    ds_read_b64_tr_b16 v[64:65], v249 offset:0
    ds_read_b64_tr_b16 v[68:69], v249 offset:64
    ds_read_b64_tr_b16 v[66:67], v249 offset:256
    ds_read_b64_tr_b16 v[70:71], v249 offset:320
    s_mov_b64 exec, s[54:55]
    ds_read_u16_d16_hi v242, v250 offset:0
    s_mov_b64 exec, -1
    v_fmac_f32 v196, v26, v162
    v_fmac_f32 v196, v27, v163
    v_fmac_f32 v196, v28, v164
    v_fmac_f32 v196, v29, v165
    v_fmac_f32 v196, v30, v166
    v_fmac_f32 v196, v31, v167
    s_nop 1
    v_permlane32_swap_b32 v198, v196
    v_add_f32 v196, v198, v196
    v_mul_f32 v255, v32, v152
    v_fmac_f32 v255, v33, v153
    v_fmac_f32 v255, v34, v154
    v_fmac_f32 v255, v35, v155
    v_fmac_f32 v255, v36, v156
    v_fmac_f32 v255, v37, v157
    v_fmac_f32 v255, v38, v158
    v_fmac_f32 v255, v39, v159
    v_fma_f32 v203, v40, -v168, v203
    v_fma_f32 v203, v41, -v169, v203
    v_permlane32_swap_b32 v255, v201
    v_fma_f32 v203, v42, -v170, v203
    v_fma_f32 v203, v43, -v171, v203
    v_fma_f32 v203, v44, -v172, v203
    v_fma_f32 v203, v45, -v173, v203
    v_fma_f32 v203, v46, -v174, v203
    v_fma_f32 v203, v47, -v175, v203
    v_add_f32 v201, v255, v201
    v_fmac_f32 v199, v48, v120
    v_permlane32_swap_b32 v203, v255
    v_fmac_f32 v199, v49, v121
    v_fmac_f32 v199, v50, v122
    v_fmac_f32 v199, v51, v123
    v_fmac_f32 v199, v52, v124
    v_fmac_f32 v199, v53, v125
    v_fmac_f32 v199, v54, v126
    v_fmac_f32 v199, v55, v127
    v_add_f32 v255, v203, v255
    v_mul_f32 v197, v56, v168
    v_fmac_f32 v197, v57, v169
    v_fmac_f32 v197, v58, v170
    v_fmac_f32 v197, v59, v171
    v_fmac_f32 v197, v60, v172
    v_fmac_f32 v197, v61, v173
    v_fmac_f32 v197, v62, v174
    v_fmac_f32 v197, v63, v175
    s_nop 1
    v_permlane32_swap_b32 v199, v197
    v_add_f32 v197, v199, v197
    s_set_gpr_idx_on s51, gpr_idx(DST)
    s_nop 0
    v_cvt_pk_bf16_f32 v207, v200, v201
    v_cvt_pk_bf16_f32 v209, v254, v255
    v_cvt_pk_bf16_f32 v208, v196, v197
    s_set_gpr_idx_off
    s_add_u32 s50, s50, 1
    s_add_u32 s51, s51, 6
    s_cmp_ge_u32 s50, 4
    s_cbranch_scc1 LAST0
    s_add_u32 s53, s53, 4
    s_xor_b32 s66, s53, s20
    s_bitcmp1_b32 s66, 2
    s_setprio 1
    s_cbranch_scc1 PRIO_5
    s_setprio 0
PRIO_5:
    s_cmp_eq_u32 s52, 4
    s_cbranch_scc1 ITEM_0_4
    s_cmp_eq_u32 s52, 5
    s_cbranch_scc1 ITEM_0_5
    s_cmp_eq_u32 s52, 3
    s_cbranch_scc1 ITEM_0_3
    s_cmp_eq_u32 s52, 6
    s_cbranch_scc1 ITEM_0_6
    s_cmp_eq_u32 s52, 8
    s_cbranch_scc1 ITEM_0_8
    s_branch ITEM_0_2
.p2align 6
ITEM_0_5:
    s_mov_b64 exec, s[54:55]
    ds_read_u16_d16_hi v243, v250 offset:128
    s_mov_b64 exec, -1
    ds_read_b64_tr_b16 v[72:73], v249 offset:512
    ds_read_b64_tr_b16 v[76:77], v249 offset:576
    ds_read_b64_tr_b16 v[74:75], v249 offset:768
    ds_read_b64_tr_b16 v[78:79], v249 offset:832
    ds_read_b64_tr_b16 v[80:81], v249 offset:1024
    ds_read_b64_tr_b16 v[84:85], v249 offset:1088
    s_waitcnt lgkmcnt(7)
    v_mul_f32_dpp v196, v242, v64 row_newbcast:0 row_mask:0xf bank_mask:0xf
    v_mul_f32_dpp v197, v242, v65 row_newbcast:1 row_mask:0xf bank_mask:0xf
    v_mul_f32_dpp v198, v242, v64 row_newbcast:8 row_mask:0xf bank_mask:0xf
    v_mul_f32_dpp v199, v242, v65 row_newbcast:9 row_mask:0xf bank_mask:0xf
    v_mul_f32_dpp v200, v242, v68 row_newbcast:2 row_mask:0xf bank_mask:0xf
    v_mul_f32_dpp v201, v242, v69 row_newbcast:3 row_mask:0xf bank_mask:0xf
    v_mul_f32_dpp v202, v242, v68 row_newbcast:10 row_mask:0xf bank_mask:0xf
    v_mul_f32_dpp v203, v242, v69 row_newbcast:11 row_mask:0xf bank_mask:0xf
    v_cvt_pk_bf16_f32 v64, v196, v197
    v_cvt_pk_bf16_f32 v68, v198, v199
    v_cvt_pk_bf16_f32 v65, v200, v201
    v_cvt_pk_bf16_f32 v69, v202, v203
    v_mul_f32_dpp v196, v242, v66 row_newbcast:4 row_mask:0xf bank_mask:0xf
    v_mul_f32_dpp v197, v242, v67 row_newbcast:5 row_mask:0xf bank_mask:0xf
    v_mul_f32_dpp v198, v242, v66 row_newbcast:12 row_mask:0xf bank_mask:0xf
    v_mul_f32_dpp v199, v242, v67 row_newbcast:13 row_mask:0xf bank_mask:0xf
    v_mul_f32_dpp v200, v242, v70 row_newbcast:6 row_mask:0xf bank_mask:0xf
    v_mul_f32_dpp v201, v242, v71 row_newbcast:7 row_mask:0xf bank_mask:0xf
    v_mul_f32_dpp v202, v242, v70 row_newbcast:14 row_mask:0xf bank_mask:0xf
    v_mul_f32_dpp v203, v242, v71 row_newbcast:15 row_mask:0xf bank_mask:0xf
    v_cvt_pk_bf16_f32 v66, v196, v197
    v_cvt_pk_bf16_f32 v70, v198, v199
    v_cvt_pk_bf16_f32 v67, v200, v201
    v_cvt_pk_bf16_f32 v71, v202, v203
    s_mov_b64 exec, s[54:55]
    ds_read_u16_d16_hi v242, v250 offset:256
    s_mov_b64 exec, -1
    s_waitcnt vmcnt(4) lgkmcnt(3)
    v_mfma_f32_32x32x16_bf16 v[0:15], v[64:67], v[176:179], 0
    v_mul_f32_dpp v196, v243, v72 row_newbcast:0 row_mask:0xf bank_mask:0xf
    v_mul_f32_dpp v197, v243, v73 row_newbcast:1 row_mask:0xf bank_mask:0xf
    v_mul_f32_dpp v198, v243, v72 row_newbcast:8 row_mask:0xf bank_mask:0xf
    v_mul_f32_dpp v199, v243, v73 row_newbcast:9 row_mask:0xf bank_mask:0xf
    v_mul_f32_dpp v200, v243, v76 row_newbcast:2 row_mask:0xf bank_mask:0xf
    v_mul_f32_dpp v201, v243, v77 row_newbcast:3 row_mask:0xf bank_mask:0xf
    v_mul_f32_dpp v202, v243, v76 row_newbcast:10 row_mask:0xf bank_mask:0xf
    v_mul_f32_dpp v203, v243, v77 row_newbcast:11 row_mask:0xf bank_mask:0xf
    v_cvt_pk_bf16_f32 v72, v196, v197
    v_cvt_pk_bf16_f32 v76, v198, v199
    v_cvt_pk_bf16_f32 v73, v200, v201
    v_cvt_pk_bf16_f32 v77, v202, v203
    s_add_u32 m0, s21, 0
    v_mfma_f32_32x32x16_bf16 v[16:31], v[68:71], v[176:179], 0
    buffer_load_dwordx4 v236, s[4:7], s35 offen  lds
    buffer_load_dwordx4 v237, s[8:11], s35 offen offset:1024  lds
    ds_read_b64_tr_b16 v[176:177], v244 offset:2048
    ds_read_b64_tr_b16 v[178:179], v244 offset:3072
    ds_read_b64_tr_b16 v[184:185], v245 offset:2048
    ds_read_b64_tr_b16 v[186:187], v245 offset:3072
    v_mul_f32_dpp v196, v243, v74 row_newbcast:4 row_mask:0xf bank_mask:0xf
    v_mul_f32_dpp v197, v243, v75 row_newbcast:5 row_mask:0xf bank_mask:0xf
    v_mul_f32_dpp v198, v243, v74 row_newbcast:12 row_mask:0xf bank_mask:0xf
    v_mul_f32_dpp v199, v243, v75 row_newbcast:13 row_mask:0xf bank_mask:0xf
    v_mul_f32_dpp v200, v243, v78 row_newbcast:6 row_mask:0xf bank_mask:0xf
    v_mul_f32_dpp v201, v243, v79 row_newbcast:7 row_mask:0xf bank_mask:0xf
    v_mul_f32_dpp v202, v243, v78 row_newbcast:14 row_mask:0xf bank_mask:0xf
    v_mul_f32_dpp v203, v243, v79 row_newbcast:15 row_mask:0xf bank_mask:0xf
    v_cvt_pk_bf16_f32 v74, v196, v197
    v_cvt_pk_bf16_f32 v78, v198, v199
    v_cvt_pk_bf16_f32 v75, v200, v201
    v_cvt_pk_bf16_f32 v79, v202, v203
    s_nop 0
    s_waitcnt vmcnt(4) lgkmcnt(0)
    v_mfma_f32_32x32x16_bf16 v[0:15], v[72:75], v[176:179], v[0:15]
    v_mul_f32_dpp v196, v242, v80 row_newbcast:0 row_mask:0xf bank_mask:0xf
    v_mul_f32_dpp v197, v242, v81 row_newbcast:1 row_mask:0xf bank_mask:0xf
    v_mul_f32_dpp v198, v242, v80 row_newbcast:8 row_mask:0xf bank_mask:0xf
    v_mul_f32_dpp v199, v242, v81 row_newbcast:9 row_mask:0xf bank_mask:0xf
    v_mul_f32_dpp v200, v242, v84 row_newbcast:2 row_mask:0xf bank_mask:0xf
    v_mul_f32_dpp v201, v242, v85 row_newbcast:3 row_mask:0xf bank_mask:0xf
    s_add_u32 m0, s21, 2048
    v_mfma_f32_32x32x16_bf16 v[16:31], v[76:79], v[176:179], v[16:31]
    buffer_load_dwordx4 v238, s[4:7], s35 offen  lds
    ds_read_b64_tr_b16 v[176:177], v244 offset:4096
    ds_read_b64_tr_b16 v[188:189], v245 offset:4096
    v_mul_f32_dpp v202, v242, v84 row_newbcast:10 row_mask:0xf bank_mask:0xf
    v_mul_f32_dpp v203, v242, v85 row_newbcast:11 row_mask:0xf bank_mask:0xf
    v_cvt_pk_bf16_f32 v80, v196, v197
    v_cvt_pk_bf16_f32 v84, v198, v199
    v_cvt_pk_bf16_f32 v81, v200, v201
    v_cvt_pk_bf16_f32 v85, v202, v203
    s_nop 0
    s_waitcnt lgkmcnt(0)
    v_mfma_f32_32x32x8_bf16 v[0:15], v[80:81], v[176:177], v[0:15]
    s_add_u32 m0, s21, 4096
    v_mfma_f32_32x32x8_bf16 v[16:31], v[84:85], v[176:177], v[16:31]
    buffer_load_dwordx4 v234, s[4:7], s36 offen  lds
    buffer_load_dwordx4 v235, s[8:11], s36 offen offset:1024  lds
    s_mov_b32 m0, s50
    s_nop 0
    s_movrels_b32 s71, s23
    s_bfe_u32 s46, s71, 0x30012
    s_mov_b32 m0, s46
    s_and_b32 s66, s71, 0x3ffff
    s_movrels_b32 s68, s57
    s_movrels_b32 s69, s61
    s_sub_u32 s48, s66, s47
    s_mov_b32 s47, s66
    s_lshr_b32 s52, s71, 28
    s_lshl_b32 s67, s46, 9
    s_add_u32 s66, s66, s67
    s_sub_u32 s49, s66, s42
    s_mov_b32 s42, s66
    s_bfe_u32 s66, s68, 655360
    s_add_u32 s43, s42, s66
    s_bfe_u32 s39, s69, 655360
    s_bfe_u32 s66, s68, 655370
    s_add_u32 s44, s42, s66
    s_bfe_u32 s40, s69, 655370
    s_bfe_u32 s66, s68, 655380
    s_add_u32 s45, s42, s66
    s_bfe_u32 s41, s69, 655380
    s_and_b32 s66, s46, s33
    s_cselect_b32 s72, -1, 1
    s_cselect_b32 s76, s47, 163712
    s_cmp_ge_u32 s66, 2
    s_cselect_b32 s73, -1, 0
    s_add_u32 s77, s47, 1024
    s_cmp_ge_u32 s66, 4
    s_cselect_b32 s75, -1, 0
    s_cmp_ge_u32 s66, 3
    s_cselect_b32 s74, -1, 1
    s_cselect_b32 s77, s77, 163712
    v_add_u32 v252, s45, v247
    ds_read_u16 v240, v252
    ds_read_u16 v241, v252 offset:64
    v_mfma_f32_32x32x16_bf16 v[32:47], v[64:67], v[180:183], 0
    v_mul_f32 v196, v0, v96
    v_fmac_f32 v196, v1, v97
    v_fmac_f32 v196, v2, v98
    v_fmac_f32 v196, v3, v99
    v_fmac_f32 v196, v4, v100
    v_fmac_f32 v196, v5, v101
    v_fmac_f32 v196, v6, v102
    v_mfma_f32_32x32x16_bf16 v[48:63], v[68:71], v[180:183], 0
    v_fmac_f32 v196, v7, v103
    v_mul_f32 v198, v8, v128
    v_fmac_f32 v198, v9, v129
    v_fmac_f32 v198, v10, v130
    v_fmac_f32 v198, v11, v131
    v_fmac_f32 v198, v12, v132
    v_mfma_f32_32x32x16_bf16 v[32:47], v[72:75], v[184:187], v[32:47]
    v_fmac_f32 v198, v13, v133
    v_fmac_f32 v198, v14, v134
    v_fmac_f32 v198, v15, v135
    v_mul_f32 v200, v16, v128
    v_fmac_f32 v200, v17, v129
    v_permlane32_swap_b32 v196, v198
    v_mfma_f32_32x32x16_bf16 v[48:63], v[76:79], v[184:187], v[48:63]
    s_waitcnt vmcnt(5)
    ds_read_b64_tr_b16 v[176:177], v244 offset:6144
    ds_read_b64_tr_b16 v[178:179], v244 offset:7168
    ds_read_b64_tr_b16 v[180:181], v245 offset:6144
    ds_read_b64_tr_b16 v[182:183], v245 offset:7168
    v_fmac_f32 v200, v18, v130
    v_fmac_f32 v200, v19, v131
    v_fmac_f32 v200, v20, v132
    v_fmac_f32 v200, v21, v133
    v_fmac_f32 v200, v22, v134
    v_fmac_f32 v200, v23, v135
    v_mfma_f32_32x32x8_bf16 v[32:47], v[80:81], v[188:189], v[32:47]
    v_add_f32 v198, v196, v198
    v_mul_f32_e64 v202, v24, -v128
    v_fma_f32 v202, v25, -v129, v202
    v_fma_f32 v202, v26, -v130, v202
    v_fma_f32 v202, v27, -v131, v202
    v_fma_f32 v202, v28, -v132, v202
    v_mfma_f32_32x32x8_bf16 v[48:63], v[84:85], v[188:189], v[48:63]
    v_fma_f32 v202, v29, -v133, v202
    v_fma_f32 v202, v30, -v134, v202
    v_fma_f32 v202, v31, -v135, v202
    s_nop 1
    v_permlane32_swap_b32 v200, v202
    v_add_f32 v202, v200, v202
    s_waitcnt vmcnt(3) lgkmcnt(0)
    v_mfma_f32_32x32x16_bf16 v[0:15], v[64:67], v[176:179], 0
    v_mul_f32 v197, v32, v104
    v_fmac_f32 v197, v33, v105
    v_fmac_f32 v197, v34, v106
    v_fmac_f32 v197, v35, v107
    v_fmac_f32 v197, v36, v108
    v_fmac_f32 v197, v37, v109
    v_fmac_f32 v197, v38, v110
    s_add_u32 m0, s21, 6144
    v_mfma_f32_32x32x16_bf16 v[16:31], v[68:71], v[176:179], 0
    buffer_load_dwordx4 v236, s[4:7], s36 offen  lds
    buffer_load_dwordx4 v237, s[8:11], s36 offen offset:1024  lds
    ds_read_b64_tr_b16 v[176:177], v244 offset:0
    ds_read_b64_tr_b16 v[178:179], v244 offset:1024
    ds_read_b64_tr_b16 v[184:185], v245 offset:0
    ds_read_b64_tr_b16 v[186:187], v245 offset:1024
    v_fmac_f32 v197, v39, v111
    v_mul_f32 v199, v40, v136
    v_fmac_f32 v199, v41, v137
    v_fmac_f32 v199, v42, v138
    v_fmac_f32 v199, v43, v139
    v_fmac_f32 v199, v44, v140
    v_fmac_f32 v199, v45, v141
    s_waitcnt vmcnt(4) lgkmcnt(0)
    v_mfma_f32_32x32x16_bf16 v[0:15], v[72:75], v[176:179], v[0:15]
    v_fmac_f32 v199, v46, v142
    v_fmac_f32 v199, v47, v143
    v_mul_f32 v201, v48, v136
    v_fmac_f32 v201, v49, v137
    v_permlane32_swap_b32 v197, v199
    v_fmac_f32 v201, v50, v138
    v_fmac_f32 v201, v51, v139
    s_add_u32 m0, s21, 0
    v_mfma_f32_32x32x16_bf16 v[16:31], v[76:79], v[176:179], v[16:31]
    buffer_load_dwordx4 v238, s[4:7], s36 offen  lds
    ds_read_b64_tr_b16 v[176:177], v244 offset:2048
    ds_read_b64_tr_b16 v[188:189], v245 offset:2048
    v_fmac_f32 v201, v52, v140
    v_fmac_f32 v201, v53, v141
    v_fmac_f32 v201, v54, v142
    v_fmac_f32 v201, v55, v143
    v_add_f32 v199, v197, v199
    v_mul_f32_e64 v203, v56, -v136
    v_fma_f32 v203, v57, -v137, v203
    s_waitcnt lgkmcnt(0)
    v_mfma_f32_32x32x8_bf16 v[0:15], v[80:81], v[176:177], v[0:15]
    v_fma_f32 v203, v58, -v138, v203
    v_fma_f32 v203, v59, -v139, v203
    v_fma_f32 v203, v60, -v140, v203
    v_fma_f32 v203, v61, -v141, v203
    v_fma_f32 v203, v62, -v142, v203
    v_fma_f32 v203, v63, -v143, v203
    s_nop 1
    s_add_u32 m0, s21, 2048
    v_mfma_f32_32x32x8_bf16 v[16:31], v[84:85], v[176:177], v[16:31]
    buffer_load_dwordx4 v234, s[4:7], s37 offen  lds
    buffer_load_dwordx4 v235, s[8:11], s37 offen offset:1024  lds
    v_add_u32 v252, s42, v247
    ds_read_u16 v234, v252
    ds_read_u16 v235, v252 offset:64
    v_permlane32_swap_b32 v201, v203
    v_add_f32 v203, v201, v203
    s_set_gpr_idx_on s51, gpr_idx(DST)
    s_nop 0
    v_cvt_pk_bf16_f32 v204, v198, v199
    v_cvt_pk_bf16_f32 v205, v202, v203
    s_set_gpr_idx_off
    v_mfma_f32_32x32x16_bf16 v[32:47], v[64:67], v[180:183], 0
    v_mul_f32 v196, v0, v144
    v_fmac_f32 v196, v1, v145
    v_fmac_f32 v196, v2, v146
    v_fmac_f32 v196, v3, v147
    v_fmac_f32 v196, v4, v148
    v_fmac_f32 v196, v5, v149
    v_mfma_f32_32x32x16_bf16 v[48:63], v[68:71], v[180:183], 0
    v_add_u32 v253, s47, v248
    ds_read_b32 v254, v253
    ds_read_b32 v255, v253 offset:256
    v_fmac_f32 v196, v6, v150
    v_fmac_f32 v196, v7, v151
    v_mul_f32 v198, v8, v112
    v_fmac_f32 v198, v9, v113
    v_fmac_f32 v198, v10, v114
    v_mfma_f32_32x32x16_bf16 v[32:47], v[72:75], v[184:187], v[32:47]
    v_fmac_f32 v198, v11, v115
    v_fmac_f32 v198, v12, v116
    v_fmac_f32 v198, v13, v117
    v_fmac_f32 v198, v14, v118
    v_fmac_f32 v198, v15, v119
    v_mfma_f32_32x32x16_bf16 v[48:63], v[76:79], v[184:187], v[48:63]
    s_waitcnt vmcnt(5)
    ds_read_b64_tr_b16 v[176:177], v244 offset:4096
    ds_read_b64_tr_b16 v[178:179], v244 offset:5120
    ds_read_b64_tr_b16 v[180:181], v245 offset:4096
    ds_read_b64_tr_b16 v[182:183], v245 offset:5120
    v_mul_f32_e64 v200, v16, -v160
    v_fma_f32 v200, v17, -v161, v200
    v_fma_f32 v200, v18, -v162, v200
    v_fma_f32 v200, v19, -v163, v200
    v_fma_f32 v200, v20, -v164, v200
    v_fma_f32 v200, v21, -v165, v200
    v_mfma_f32_32x32x8_bf16 v[32:47], v[80:81], v[188:189], v[32:47]
    v_fma_f32 v200, v22, -v166, v200
    v_fma_f32 v200, v23, -v167, v200
    v_mul_f32_e64 v202, v24, -v160
    v_fma_f32 v202, v25, -v161, v202
    v_fma_f32 v202, v26, -v162, v202
    v_mfma_f32_32x32x8_bf16 v[48:63], v[84:85], v[188:189], v[48:63]
    v_fma_f32 v202, v27, -v163, v202
    v_fma_f32 v202, v28, -v164, v202
    v_fma_f32 v202, v29, -v165, v202
    v_fma_f32 v202, v30, -v166, v202
    v_fma_f32 v202, v31, -v167, v202
    s_waitcnt vmcnt(3) lgkmcnt(0)
    v_mfma_f32_32x32x16_bf16 v[0:15], v[64:67], v[176:179], 0
    v_mul_f32 v197, v32, v152
    v_fmac_f32 v197, v33, v153
    v_fmac_f32 v197, v34, v154
    v_fmac_f32 v197, v35, v155
    v_fmac_f32 v197, v36, v156
    v_fmac_f32 v197, v37, v157
    s_add_u32 m0, s21, 4096
    v_mfma_f32_32x32x16_bf16 v[16:31], v[68:71], v[176:179], 0
    buffer_load_dwordx4 v236, s[4:7], s37 offen  lds
    buffer_load_dwordx4 v237, s[8:11], s37 offen offset:1024  lds
    ds_read_b64_tr_b16 v[176:177], v244 offset:6144
    ds_read_b64_tr_b16 v[178:179], v244 offset:7168
    ds_read_b64_tr_b16 v[184:185], v245 offset:6144
    ds_read_b64_tr_b16 v[186:187], v245 offset:7168
    v_add_u32 v252, s43, v247
    ds_read_u16 v236, v252
    ds_read_u16 v237, v252 offset:64
    v_fmac_f32 v197, v38, v158
    v_fmac_f32 v197, v39, v159
    v_mul_f32 v199, v40, v120
    v_fmac_f32 v199, v41, v121
    v_fmac_f32 v199, v42, v122
    s_waitcnt vmcnt(4) lgkmcnt(2)
    v_mfma_f32_32x32x16_bf16 v[0:15], v[72:75], v[176:179], v[0:15]
    v_fmac_f32 v199, v43, v123
    v_fmac_f32 v199, v44, v124
    v_fmac_f32 v199, v45, v125
    v_fmac_f32 v199, v46, v126
    v_fmac_f32 v199, v47, v127
    s_add_u32 m0, s21, 6144
    v_mfma_f32_32x32x16_bf16 v[16:31], v[76:79], v[176:179], v[16:31]
    buffer_load_dwordx4 v238, s[4:7], s37 offen  lds
    ds_read_b64_tr_b16 v[176:177], v244 offset:0
    ds_read_b64_tr_b16 v[188:189], v245 offset:0
    v_add_u32 v252, s44, v247
    ds_read_u16 v238, v252
    ds_read_u16 v239, v252 offset:64
    v_mul_f32_e64 v201, v48, -v168
    v_fma_f32 v201, v49, -v169, v201
    v_fma_f32 v201, v50, -v170, v201
    v_fma_f32 v201, v51, -v171, v201
    v_fma_f32 v201, v52, -v172, v201
    v_fma_f32 v201, v53, -v173, v201
    s_waitcnt lgkmcnt(2)
    v_mfma_f32_32x32x8_bf16 v[0:15], v[80:81], v[176:177], v[0:15]
    v_fma_f32 v201, v54, -v174, v201
    v_fma_f32 v201, v55, -v175, v201
    v_mul_f32_e64 v203, v56, -v168
    v_fma_f32 v203, v57, -v169, v203
    v_fma_f32 v203, v58, -v170, v203
    s_add_u32 m0, s21, 0
    v_mfma_f32_32x32x8_bf16 v[16:31], v[84:85], v[176:177], v[16:31]
    v_lshl_add_u32 v234, v234, 10, v246
    v_lshl_add_u32 v235, v235, 10, v246
    buffer_load_dwordx4 v234, s[4:7], s38 offen  lds
    buffer_load_dwordx4 v235, s[8:11], s38 offen offset:1024  lds
    s_mov_b32 m0, s76
    s_mov_b64 exec, s[72:73]
    buffer_load_dwordx4 v254, s[12:15], 0 offen  lds
    s_mov_b32 m0, s77
    s_mov_b64 exec, s[74:75]
    buffer_load_dwordx4 v255, s[12:15], 0 offen  lds
    s_mov_b64 exec, -1
    v_fma_f32 v203, v59, -v171, v203
    v_fma_f32 v203, v60, -v172, v203
    v_fma_f32 v203, v61, -v173, v203
    v_fma_f32 v203, v62, -v174, v203
    v_fma_f32 v203, v63, -v175, v203
    v_mfma_f32_32x32x16_bf16 v[32:47], v[64:67], v[180:183], 0
    v_mul_f32 v254, v0, v144
    v_fmac_f32 v254, v1, v145
    v_fmac_f32 v254, v2, v146
    v_mfma_f32_32x32x16_bf16 v[48:63], v[68:71], v[180:183], 0
    ds_swizzle_b32 v68, v68 offset:0x401F
    ds_swizzle_b32 v69, v69 offset:0x401F
    ds_swizzle_b32 v70, v70 offset:0x401F
    ds_swizzle_b32 v71, v71 offset:0x401F
    v_fmac_f32 v254, v3, v147
    v_fmac_f32 v254, v4, v148
    v_fmac_f32 v254, v5, v149
    v_mfma_f32_32x32x16_bf16 v[32:47], v[72:75], v[184:187], v[32:47]
    v_fmac_f32 v254, v6, v150
    v_fmac_f32 v254, v7, v151
    v_fmac_f32 v200, v8, v160
    v_mfma_f32_32x32x16_bf16 v[48:63], v[76:79], v[184:187], v[48:63]
    ds_swizzle_b32 v76, v76 offset:0x401F
    ds_swizzle_b32 v77, v77 offset:0x401F
    ds_swizzle_b32 v78, v78 offset:0x401F
    ds_swizzle_b32 v79, v79 offset:0x401F
    s_waitcnt vmcnt(7)
    ds_read_b64_tr_b16 v[176:177], v244 offset:2048
    ds_read_b64_tr_b16 v[178:179], v244 offset:3072
    ds_read_b64_tr_b16 v[180:181], v245 offset:2048
    ds_read_b64_tr_b16 v[182:183], v245 offset:3072
    v_fmac_f32 v200, v9, v161
    v_permlane32_swap_b32 v196, v254
    v_fmac_f32 v200, v10, v162
    v_mfma_f32_32x32x8_bf16 v[32:47], v[80:81], v[188:189], v[32:47]
    v_fmac_f32 v200, v11, v163
    v_fmac_f32 v200, v12, v164
    v_fmac_f32 v200, v13, v165
    v_mfma_f32_32x32x8_bf16 v[48:63], v[84:85], v[188:189], v[48:63]
    ds_swizzle_b32 v84, v84 offset:0x401F
    ds_swizzle_b32 v85, v85 offset:0x401F
    v_fmac_f32 v200, v14, v166
    v_fmac_f32 v200, v15, v167
    v_add_f32 v254, v196, v254
    s_waitcnt lgkmcnt(6)
    s_mov_b64 exec, s[56:57]
    v_xor_b32 v68, 0x80008000, v68
    v_xor_b32 v69, 0x80008000, v69
    v_xor_b32 v70, 0x80008000, v70
    v_xor_b32 v71, 0x80008000, v71
    v_xor_b32 v76, 0x80008000, v76
    v_xor_b32 v77, 0x80008000, v77
    v_xor_b32 v78, 0x80008000, v78
    v_xor_b32 v79, 0x80008000, v79
    s_mov_b64 exec, -1
    s_waitcnt vmcnt(5) lgkmcnt(2)
    v_mfma_f32_32x32x16_bf16 v[0:15], v[64:67], v[176:179], 0
    v_mul_f32 v255, v32, v152
    v_fmac_f32 v255, v33, v153
    v_fmac_f32 v255, v34, v154
    v_fmac_f32 v255, v35, v155
    s_add_u32 m0, s21, 2048
    v_mfma_f32_32x32x16_bf16 v[16:31], v[68:71], v[176:179], v[16:31]
    v_lshl_add_u32 v236, v236, 10, v246
    v_lshl_add_u32 v237, v237, 10, v246
    buffer_load_dwordx4 v236, s[4:7], s39 offen  lds
    buffer_load_dwordx4 v237, s[8:11], s39 offen offset:1024  lds
    ds_read_b64_tr_b16 v[176:177], v244 offset:4096
    ds_read_b64_tr_b16 v[178:179], v244 offset:5120
    ds_read_b64_tr_b16 v[184:185], v245 offset:4096
    ds_read_b64_tr_b16 v[186:187], v245 offset:5120
    v_fmac_f32 v255, v36, v156
    v_fmac_f32 v255, v37, v157
    v_fmac_f32 v255, v38, v158
    v_fmac_f32 v255, v39, v159
    s_waitcnt vmcnt(6) lgkmcnt(0)
    v_mfma_f32_32x32x16_bf16 v[0:15], v[72:75], v[176:179], v[0:15]
    v_fmac_f32 v201, v40, v168
    v_fmac_f32 v201, v41, v169
    v_permlane32_swap_b32 v197, v255
    s_add_u32 m0, s21, 4096
    v_mfma_f32_32x32x16_bf16 v[16:31], v[76:79], v[176:179], v[16:31]
    v_lshl_add_u32 v238, v238, 10, v246
    v_lshl_add_u32 v239, v239, 10, v246
    buffer_load_dwordx4 v238, s[4:7], s40 offen  lds
    buffer_load_dwordx4 v239, s[8:11], s40 offen offset:1024  lds
    ds_read_b64_tr_b16 v[176:177], v244 offset:6144
    ds_read_b64_tr_b16 v[188:189], v245 offset:6144
    v_fmac_f32 v201, v42, v170
    v_fmac_f32 v201, v43, v171
    v_fmac_f32 v201, v44, v172
    v_fmac_f32 v201, v45, v173
    s_waitcnt lgkmcnt(0)
    s_mov_b64 exec, s[56:57]
    v_xor_b32 v84, 0x80008000, v84
    v_xor_b32 v85, 0x80008000, v85
    s_mov_b64 exec, -1
    v_mfma_f32_32x32x8_bf16 v[0:15], v[80:81], v[176:177], v[0:15]
    v_fmac_f32 v201, v46, v174
    v_fmac_f32 v201, v47, v175
    v_add_f32 v255, v197, v255
    s_set_gpr_idx_on s51, gpr_idx(DST)
    s_nop 0
    v_cvt_pk_bf16_f32 v206, v254, v255
    s_set_gpr_idx_off
    s_add_u32 m0, s21, 6144
    v_mfma_f32_32x32x8_bf16 v[16:31], v[84:85], v[176:177], v[16:31]
    v_lshl_add_u32 v240, v240, 10, v246
    v_lshl_add_u32 v241, v241, 10, v246
    buffer_load_dwordx4 v240, s[4:7], s41 offen  lds
    buffer_load_dwordx4 v241, s[8:11], s41 offen offset:1024  lds
    v_mfma_f32_32x32x16_bf16 v[32:47], v[64:67], v[180:183], 0
    v_mul_f32 v254, v0, v144
    v_fmac_f32 v254, v1, v145
    v_fmac_f32 v254, v2, v146
    v_fmac_f32 v254, v3, v147
    v_fmac_f32 v254, v4, v148
    v_fmac_f32 v254, v5, v149
    v_fmac_f32 v254, v6, v150
    v_mfma_f32_32x32x16_bf16 v[48:63], v[68:71], v[180:183], v[48:63]
    v_fmac_f32 v254, v7, v151
    v_fma_f32 v202, v8, -v160, v202
    v_fma_f32 v202, v9, -v161, v202
    v_permlane32_swap_b32 v254, v200
    v_fma_f32 v202, v10, -v162, v202
    v_fma_f32 v202, v11, -v163, v202
    v_mfma_f32_32x32x16_bf16 v[32:47], v[72:75], v[184:187], v[32:47]
    v_fma_f32 v202, v12, -v164, v202
    v_fma_f32 v202, v13, -v165, v202
    v_fma_f32 v202, v14, -v166, v202
    v_fma_f32 v202, v15, -v167, v202
    v_add_f32 v200, v254, v200
    v_fmac_f32 v198, v16, v112
    v_permlane32_swap_b32 v202, v254
    v_mfma_f32_32x32x16_bf16 v[48:63], v[76:79], v[184:187], v[48:63]
    s_waitcnt vmcnt(8)
    ds_read_b64_tr_b16 v[176:177], v244 offset:0
    ds_read_b64_tr_b16 v[178:179], v244 offset:1024
    ds_read_b64_tr_b16 v[180:181], v245 offset:0
    ds_read_b64_tr_b16 v[182:183], v245 offset:1024
    v_fmac_f32 v198, v17, v113
    v_fmac_f32 v198, v18, v114
    v_fmac_f32 v198, v19, v115
    v_fmac_f32 v198, v20, v116
    v_fmac_f32 v198, v21, v117
    v_fmac_f32 v198, v22, v118
    v_mfma_f32_32x32x8_bf16 v[32:47], v[80:81], v[188:189], v[32:47]
    v_fmac_f32 v198, v23, v119
    v_add_f32 v254, v202, v254
    v_mul_f32 v196, v24, v160
    v_fmac_f32 v196, v25, v161
    v_fmac_f32 v196, v26, v162
    v_fmac_f32 v196, v27, v163
    v_fmac_f32 v196, v28, v164
    v_mfma_f32_32x32x8_bf16 v[48:63], v[84:85], v[188:189], v[48:63]
    v_add_u32 v249, s48, v249
    v_add_u32 v250, s49, v250
    s_waitcnt vmcnt(6)
    ds_read_b64_tr_b16 v[64:65], v249 offset:0
    ds_read_b64_tr_b16 v[68:69], v249 offset:64
    ds_read_b64_tr_b16 v[66:67], v249 offset:256
    ds_read_b64_tr_b16 v[70:71], v249 offset:320
    s_mov_b64 exec, s[54:55]
    ds_read_u16_d16_hi v242, v250 offset:0
    s_mov_b64 exec, -1
    v_fmac_f32 v196, v29, v165
    v_fmac_f32 v196, v30, v166
    v_fmac_f32 v196, v31, v167
    s_nop 1
    v_permlane32_swap_b32 v198, v196
    v_add_f32 v196, v198, v196
    v_mul_f32 v255, v32, v152
    v_fmac_f32 v255, v33, v153
    v_fmac_f32 v255, v34, v154
    v_fmac_f32 v255, v35, v155
    v_fmac_f32 v255, v36, v156
    v_fmac_f32 v255, v37, v157
    v_fmac_f32 v255, v38, v158
    v_fmac_f32 v255, v39, v159
    v_fma_f32 v203, v40, -v168, v203
    v_fma_f32 v203, v41, -v169, v203
    v_permlane32_swap_b32 v255, v201
    v_fma_f32 v203, v42, -v170, v203
    v_fma_f32 v203, v43, -v171, v203
    v_fma_f32 v203, v44, -v172, v203
    v_fma_f32 v203, v45, -v173, v203
    v_fma_f32 v203, v46, -v174, v203
    v_fma_f32 v203, v47, -v175, v203
    v_add_f32 v201, v255, v201
    v_fmac_f32 v199, v48, v120
    v_permlane32_swap_b32 v203, v255
    v_fmac_f32 v199, v49, v121
    v_fmac_f32 v199, v50, v122
    v_fmac_f32 v199, v51, v123
    v_fmac_f32 v199, v52, v124
    v_fmac_f32 v199, v53, v125
    v_fmac_f32 v199, v54, v126
    v_fmac_f32 v199, v55, v127
    v_add_f32 v255, v203, v255
    v_mul_f32 v197, v56, v168
    v_fmac_f32 v197, v57, v169
    v_fmac_f32 v197, v58, v170
    v_fmac_f32 v197, v59, v171
    v_fmac_f32 v197, v60, v172
    v_fmac_f32 v197, v61, v173
    v_fmac_f32 v197, v62, v174
    v_fmac_f32 v197, v63, v175
    s_nop 1
    v_permlane32_swap_b32 v199, v197
    v_add_f32 v197, v199, v197
    s_set_gpr_idx_on s51, gpr_idx(DST)
    s_nop 0
    v_cvt_pk_bf16_f32 v207, v200, v201
    v_cvt_pk_bf16_f32 v209, v254, v255
    v_cvt_pk_bf16_f32 v208, v196, v197
    s_set_gpr_idx_off
    s_add_u32 s50, s50, 1
    s_add_u32 s51, s51, 6
    s_cmp_ge_u32 s50, 4
    s_cbranch_scc1 LAST0
    s_add_u32 s53, s53, 4
    s_xor_b32 s66, s53, s20
    s_bitcmp1_b32 s66, 2
    s_setprio 1
    s_cbranch_scc1 PRIO_6
    s_setprio 0
PRIO_6:
    s_cmp_eq_u32 s52, 4
    s_cbranch_scc1 ITEM_0_4
    s_cmp_eq_u32 s52, 5
    s_cbranch_scc1 ITEM_0_5
    s_cmp_eq_u32 s52, 3
    s_cbranch_scc1 ITEM_0_3
    s_cmp_eq_u32 s52, 6
    s_cbranch_scc1 ITEM_0_6
    s_cmp_eq_u32 s52, 8
    s_cbranch_scc1 ITEM_0_8
    s_branch ITEM_0_2
.p2align 6
ITEM_0_3:
    s_mov_b64 exec, s[54:55]
    ds_read_u16_d16_hi v243, v250 offset:128
    s_mov_b64 exec, -1
    ds_read_b64_tr_b16 v[72:73], v249 offset:512
    ds_read_b64_tr_b16 v[76:77], v249 offset:576
    s_waitcnt lgkmcnt(3)
    v_mul_f32_dpp v196, v242, v64 row_newbcast:0 row_mask:0xf bank_mask:0xf
    v_mul_f32_dpp v197, v242, v65 row_newbcast:1 row_mask:0xf bank_mask:0xf
    v_mul_f32_dpp v198, v242, v64 row_newbcast:8 row_mask:0xf bank_mask:0xf
    v_mul_f32_dpp v199, v242, v65 row_newbcast:9 row_mask:0xf bank_mask:0xf
    v_mul_f32_dpp v200, v242, v68 row_newbcast:2 row_mask:0xf bank_mask:0xf
    v_mul_f32_dpp v201, v242, v69 row_newbcast:3 row_mask:0xf bank_mask:0xf
    v_mul_f32_dpp v202, v242, v68 row_newbcast:10 row_mask:0xf bank_mask:0xf
    v_mul_f32_dpp v203, v242, v69 row_newbcast:11 row_mask:0xf bank_mask:0xf
    v_cvt_pk_bf16_f32 v64, v196, v197
    v_cvt_pk_bf16_f32 v68, v198, v199
    v_cvt_pk_bf16_f32 v65, v200, v201
    v_cvt_pk_bf16_f32 v69, v202, v203
    v_mul_f32_dpp v196, v242, v66 row_newbcast:4 row_mask:0xf bank_mask:0xf
    v_mul_f32_dpp v197, v242, v67 row_newbcast:5 row_mask:0xf bank_mask:0xf
    v_mul_f32_dpp v198, v242, v66 row_newbcast:12 row_mask:0xf bank_mask:0xf
    v_mul_f32_dpp v199, v242, v67 row_newbcast:13 row_mask:0xf bank_mask:0xf
    v_mul_f32_dpp v200, v242, v70 row_newbcast:6 row_mask:0xf bank_mask:0xf
    v_mul_f32_dpp v201, v242, v71 row_newbcast:7 row_mask:0xf bank_mask:0xf
    v_mul_f32_dpp v202, v242, v70 row_newbcast:14 row_mask:0xf bank_mask:0xf
    v_mul_f32_dpp v203, v242, v71 row_newbcast:15 row_mask:0xf bank_mask:0xf
    v_cvt_pk_bf16_f32 v66, v196, v197
    v_cvt_pk_bf16_f32 v70, v198, v199
    v_cvt_pk_bf16_f32 v67, v200, v201
    v_cvt_pk_bf16_f32 v71, v202, v203
    s_nop 0
    s_waitcnt vmcnt(4) lgkmcnt(0)
    v_mfma_f32_32x32x16_bf16 v[0:15], v[64:67], v[176:179], 0
    v_mul_f32_dpp v196, v243, v72 row_newbcast:0 row_mask:0xf bank_mask:0xf
    v_mul_f32_dpp v197, v243, v73 row_newbcast:1 row_mask:0xf bank_mask:0xf
    v_mul_f32_dpp v198, v243, v72 row_newbcast:8 row_mask:0xf bank_mask:0xf
    v_mul_f32_dpp v199, v243, v73 row_newbcast:9 row_mask:0xf bank_mask:0xf
    v_mul_f32_dpp v200, v243, v76 row_newbcast:2 row_mask:0xf bank_mask:0xf
    v_mul_f32_dpp v201, v243, v77 row_newbcast:3 row_mask:0xf bank_mask:0xf
    s_add_u32 m0, s21, 0
    v_mfma_f32_32x32x16_bf16 v[16:31], v[68:71], v[176:179], 0
    buffer_load_dwordx4 v234, s[4:7], s36 offen  lds
    buffer_load_dwordx4 v235, s[8:11], s36 offen offset:1024  lds
    ds_read_b64_tr_b16 v[176:177], v244 offset:2048
    ds_read_b64_tr_b16 v[184:185], v245 offset:2048
    v_mul_f32_dpp v202, v243, v76 row_newbcast:10 row_mask:0xf bank_mask:0xf
    v_mul_f32_dpp v203, v243, v77 row_newbcast:11 row_mask:0xf bank_mask:0xf
    v_cvt_pk_bf16_f32 v72, v196, v197
    v_cvt_pk_bf16_f32 v76, v198, v199
    v_cvt_pk_bf16_f32 v73, v200, v201
    v_cvt_pk_bf16_f32 v77, v202, v203
    s_nop 0
    s_waitcnt lgkmcnt(0)
    v_mfma_f32_32x32x8_bf16 v[0:15], v[72:73], v[176:177], v[0:15]
    s_add_u32 m0, s21, 2048
    v_mfma_f32_32x32x8_bf16 v[16:31], v[76:77], v[176:177], v[16:31]
    buffer_load_dwordx4 v236, s[4:7], s36 offen  lds
    s_mov_b32 m0, s50
    s_nop 0
    s_movrels_b32 s71, s23
    s_bfe_u32 s46, s71, 0x30012
    s_mov_b32 m0, s46
    s_and_b32 s66, s71, 0x3ffff
    s_movrels_b32 s68, s57
    s_movrels_b32 s69, s61
    s_sub_u32 s48, s66, s47
    s_mov_b32 s47, s66
    s_lshr_b32 s52, s71, 28
    s_lshl_b32 s67, s46, 9
    s_add_u32 s66, s66, s67
    s_sub_u32 s49, s66, s42
    s_mov_b32 s42, s66
    s_bfe_u32 s66, s68, 655360
    s_add_u32 s43, s42, s66
    s_bfe_u32 s39, s69, 655360
    s_bfe_u32 s66, s68, 655370
    s_add_u32 s44, s42, s66
    s_bfe_u32 s40, s69, 655370
    s_bfe_u32 s66, s68, 655380
    s_add_u32 s45, s42, s66
    s_bfe_u32 s41, s69, 655380
    s_and_b32 s66, s46, s33
    s_cselect_b32 s72, -1, 1
    s_cselect_b32 s76, s47, 163712
    s_cmp_ge_u32 s66, 2
    s_cselect_b32 s73, -1, 0
    s_add_u32 s77, s47, 1024
    s_cmp_ge_u32 s66, 4
    s_cselect_b32 s75, -1, 0
    s_cmp_ge_u32 s66, 3
    s_cselect_b32 s74, -1, 1
    s_cselect_b32 s77, s77, 163712
    v_add_u32 v252, s44, v247
    ds_read_u16 v238, v252
    ds_read_u16 v239, v252 offset:64
    v_add_u32 v252, s45, v247
    ds_read_u16 v240, v252
    ds_read_u16 v241, v252 offset:64
    v_mfma_f32_32x32x16_bf16 v[32:47], v[64:67], v[180:183], 0
    v_mul_f32 v196, v0, v96
    v_fmac_f32 v196, v1, v97
    v_fmac_f32 v196, v2, v98
    v_fmac_f32 v196, v3, v99
    v_fmac_f32 v196, v4, v100
    v_fmac_f32 v196, v5, v101
    v_fmac_f32 v196, v6, v102
    v_fmac_f32 v196, v7, v103
    v_mul_f32 v198, v8, v128
    v_fmac_f32 v198, v9, v129
    v_mfma_f32_32x32x16_bf16 v[48:63], v[68:71], v[180:183], 0
    s_waitcnt vmcnt(5)
    ds_read_b64_tr_b16 v[176:177], v244 offset:4096
    ds_read_b64_tr_b16 v[178:179], v244 offset:5120
    ds_read_b64_tr_b16 v[180:181], v245 offset:4096
    ds_read_b64_tr_b16 v[182:183], v245 offset:5120
    v_fmac_f32 v198, v10, v130
    v_fmac_f32 v198, v11, v131
    v_fmac_f32 v198, v12, v132
    v_fmac_f32 v198, v13, v133
    v_fmac_f32 v198, v14, v134
    v_fmac_f32 v198, v15, v135
    v_mul_f32 v200, v16, v128
    v_fmac_f32 v200, v17, v129
    v_permlane32_swap_b32 v196, v198
    v_mfma_f32_32x32x8_bf16 v[32:47], v[72:73], v[184:185], v[32:47]
    v_fmac_f32 v200, v18, v130
    v_fmac_f32 v200, v19, v131
    v_fmac_f32 v200, v20, v132
    v_fmac_f32 v200, v21, v133
    v_fmac_f32 v200, v22, v134
    v_fmac_f32 v200, v23, v135
    v_add_f32 v198, v196, v198
    v_mul_f32_e64 v202, v24, -v128
    v_fma_f32 v202, v25, -v129, v202
    v_mfma_f32_32x32x8_bf16 v[48:63], v[76:77], v[184:185], v[48:63]
    v_fma_f32 v202, v26, -v130, v202
    v_fma_f32 v202, v27, -v131, v202
    v_fma_f32 v202, v28, -v132, v202
    v_fma_f32 v202, v29, -v133, v202
    v_fma_f32 v202, v30, -v134, v202
    v_fma_f32 v202, v31, -v135, v202
    s_nop 1
    v_permlane32_swap_b32 v200, v202
    v_add_f32 v202, v200, v202
    s_waitcnt vmcnt(3) lgkmcnt(0)
    v_mfma_f32_32x32x16_bf16 v[0:15], v[64:67], v[176:179], 0
    v_mul_f32 v197, v32, v104
    v_fmac_f32 v197, v33, v105
    v_fmac_f32 v197, v34, v106
    v_fmac_f32 v197, v35, v107
    v_fmac_f32 v197, v36, v108
    v_fmac_f32 v197, v37, v109
    v_fmac_f32 v197, v38, v110
    v_fmac_f32 v197, v39, v111
    v_mul_f32 v199, v40, v136
    v_fmac_f32 v199, v41, v137
    v_fmac_f32 v199, v42, v138
    s_add_u32 m0, s21, 4096
    v_mfma_f32_32x32x16_bf16 v[16:31], v[68:71], v[176:179], 0
    buffer_load_dwordx4 v234, s[4:7], s37 offen  lds
    buffer_load_dwordx4 v235, s[8:11], s37 offen offset:1024  lds
    ds_read_b64_tr_b16 v[176:177], v244 offset:6144
    ds_read_b64_tr_b16 v[184:185], v245 offset:6144
    v_add_u32 v252, s42, v247
    ds_read_u16 v234, v252
    ds_read_u16 v235, v252 offset:64
    v_fmac_f32 v199, v43, v139
    v_fmac_f32 v199, v44, v140
    v_fmac_f32 v199, v45, v141
    v_fmac_f32 v199, v46, v142
    v_fmac_f32 v199, v47, v143
    v_mul_f32 v201, v48, v136
    v_fmac_f32 v201, v49, v137
    v_permlane32_swap_b32 v197, v199
    v_fmac_f32 v201, v50, v138
    v_fmac_f32 v201, v51, v139
    s_waitcnt lgkmcnt(2)
    v_mfma_f32_32x32x8_bf16 v[0:15], v[72:73], v[176:177], v[0:15]
    v_fmac_f32 v201, v52, v140
    v_fmac_f32 v201, v53, v141
    v_fmac_f32 v201, v54, v142
    v_fmac_f32 v201, v55, v143
    v_add_f32 v199, v197, v199
    v_mul_f32_e64 v203, v56, -v136
    v_fma_f32 v203, v57, -v137, v203
    v_fma_f32 v203, v58, -v138, v203
    v_fma_f32 v203, v59, -v139, v203
    v_fma_f32 v203, v60, -v140, v203
    v_fma_f32 v203, v61, -v141, v203
    s_add_u32 m0, s21, 6144
    v_mfma_f32_32x32x8_bf16 v[16:31], v[76:77], v[176:177], v[16:31]
    buffer_load_dwordx4 v236, s[4:7], s37 offen  lds
    v_add_u32 v252, s43, v247
    ds_read_u16 v236, v252
    ds_read_u16 v237, v252 offset:64
    v_fma_f32 v203, v62, -v142, v203
    v_fma_f32 v203, v63, -v143, v203
    s_nop 1
    v_permlane32_swap_b32 v201, v203
    v_add_f32 v203, v201, v203
    s_set_gpr_idx_on s51, gpr_idx(DST)
    s_nop 0
    v_cvt_pk_bf16_f32 v204, v198, v199
    v_cvt_pk_bf16_f32 v205, v202, v203
    s_set_gpr_idx_off
    v_mfma_f32_32x32x16_bf16 v[32:47], v[64:67], v[180:183], 0
    v_mul_f32 v196, v0, v144
    v_fmac_f32 v196, v1, v145
    v_fmac_f32 v196, v2, v146
    v_fmac_f32 v196, v3, v147
    v_fmac_f32 v196, v4, v148
    v_fmac_f32 v196, v5, v149
    v_fmac_f32 v196, v6, v150
    v_fmac_f32 v196, v7, v151
    v_mfma_f32_32x32x16_bf16 v[48:63], v[68:71], v[180:183], 0
    v_add_u32 v253, s47, v248
    ds_read_b32 v254, v253
    ds_read_b32 v255, v253 offset:256
    s_waitcnt vmcnt(4)
    ds_read_b64_tr_b16 v[176:177], v244 offset:0
    ds_read_b64_tr_b16 v[178:179], v244 offset:1024
    ds_read_b64_tr_b16 v[180:181], v245 offset:0
    ds_read_b64_tr_b16 v[182:183], v245 offset:1024
    v_mul_f32 v198, v8, v112
    v_fmac_f32 v198, v9, v113
    v_fmac_f32 v198, v10, v114
    v_fmac_f32 v198, v11, v115
    v_fmac_f32 v198, v12, v116
    v_fmac_f32 v198, v13, v117
    v_fmac_f32 v198, v14, v118
    v_fmac_f32 v198, v15, v119
    v_mfma_f32_32x32x8_bf16 v[32:47], v[72:73], v[184:185], v[32:47]
    v_mul_f32_e64 v200, v16, -v160
    v_fma_f32 v200, v17, -v161, v200
    v_fma_f32 v200, v18, -v162, v200
    v_fma_f32 v200, v19, -v163, v200
    v_fma_f32 v200, v20, -v164, v200
    v_fma_f32 v200, v21, -v165, v200
    v_fma_f32 v200, v22, -v166, v200
    v_fma_f32 v200, v23, -v167, v200
    v_mfma_f32_32x32x8_bf16 v[48:63], v[76:77], v[184:185], v[48:63]
    v_mul_f32_e64 v202, v24, -v160
    v_fma_f32 v202, v25, -v161, v202
    v_fma_f32 v202, v26, -v162, v202
    v_fma_f32 v202, v27, -v163, v202
    v_fma_f32 v202, v28, -v164, v202
    v_fma_f32 v202, v29, -v165, v202
    v_fma_f32 v202, v30, -v166, v202
    v_fma_f32 v202, v31, -v167, v202
    s_waitcnt vmcnt(3) lgkmcnt(0)
    v_mfma_f32_32x32x16_bf16 v[0:15], v[64:67], v[176:179], 0
    v_mul_f32 v197, v32, v152
    v_fmac_f32 v197, v33, v153
    v_fmac_f32 v197, v34, v154
    v_fmac_f32 v197, v35, v155
    v_fmac_f32 v197, v36, v156
    v_fmac_f32 v197, v37, v157
    v_fmac_f32 v197, v38, v158
    v_fmac_f32 v197, v39, v159
    s_add_u32 m0, s21, 0
    v_mfma_f32_32x32x16_bf16 v[16:31], v[68:71], v[176:179], 0
    v_lshl_add_u32 v234, v234, 10, v246
    v_lshl_add_u32 v235, v235, 10, v246
    buffer_load_dwordx4 v234, s[4:7], s38 offen  lds
    buffer_load_dwordx4 v235, s[8:11], s38 offen offset:1024  lds
    ds_read_b64_tr_b16 v[176:177], v244 offset:2048
    ds_read_b64_tr_b16 v[184:185], v245 offset:2048
    v_mul_f32 v199, v40, v120
    v_fmac_f32 v199, v41, v121
    v_fmac_f32 v199, v42, v122
    v_fmac_f32 v199, v43, v123
    v_fmac_f32 v199, v44, v124
    v_fmac_f32 v199, v45, v125
    v_fmac_f32 v199, v46, v126
    v_fmac_f32 v199, v47, v127
    s_waitcnt lgkmcnt(0)
    v_mfma_f32_32x32x8_bf16 v[0:15], v[72:73], v[176:177], v[0:15]
    v_mul_f32_e64 v201, v48, -v168
    v_fma_f32 v201, v49, -v169, v201
    v_fma_f32 v201, v50, -v170, v201
    v_fma_f32 v201, v51, -v171, v201
    v_fma_f32 v201, v52, -v172, v201
    v_fma_f32 v201, v53, -v173, v201
    v_fma_f32 v201, v54, -v174, v201
    v_fma_f32 v201, v55, -v175, v201
    s_add_u32 m0, s21, 2048
    v_mfma_f32_32x32x8_bf16 v[16:31], v[76:77], v[176:177], v[16:31]
    v_lshl_add_u32 v236, v236, 10, v246
    v_lshl_add_u32 v237, v237, 10, v246
    buffer_load_dwordx4 v236, s[4:7], s39 offen  lds
    buffer_load_dwordx4 v237, s[8:11], s39 offen offset:1024  lds
    s_mov_b32 m0, s76
    s_mov_b64 exec, s[72:73]
    buffer_load_dwordx4 v254, s[12:15], 0 offen  lds
    s_mov_b32 m0, s77
    s_mov_b64 exec, s[74:75]
    buffer_load_dwordx4 v255, s[12:15], 0 offen  lds
    s_mov_b64 exec, -1
    v_mul_f32_e64 v203, v56, -v168
    v_fma_f32 v203, v57, -v169, v203
    v_fma_f32 v203, v58, -v170, v203
    v_fma_f32 v203, v59, -v171, v203
    v_fma_f32 v203, v60, -v172, v203
    v_fma_f32 v203, v61, -v173, v203
    v_fma_f32 v203, v62, -v174, v203
    v_fma_f32 v203, v63, -v175, v203
    v_mfma_f32_32x32x16_bf16 v[32:47], v[64:67], v[180:183], 0
    v_mul_f32 v254, v0, v144
    v_fmac_f32 v254, v1, v145
    v_fmac_f32 v254, v2, v146
    v_fmac_f32 v254, v3, v147
    v_fmac_f32 v254, v4, v148
    v_mfma_f32_32x32x16_bf16 v[48:63], v[68:71], v[180:183], 0
    ds_swizzle_b32 v68, v68 offset:0x401F
    ds_swizzle_b32 v69, v69 offset:0x401F
    ds_swizzle_b32 v70, v70 offset:0x401F
    ds_swizzle_b32 v71, v71 offset:0x401F
    s_waitcnt vmcnt(7)
    ds_read_b64_tr_b16 v[176:177], v244 offset:4096
    ds_read_b64_tr_b16 v[178:179], v244 offset:5120
    ds_read_b64_tr_b16 v[180:181], v245 offset:4096
    ds_read_b64_tr_b16 v[182:183], v245 offset:5120
    v_fmac_f32 v254, v5, v149
    v_fmac_f32 v254, v6, v150
    v_fmac_f32 v254, v7, v151
    v_fmac_f32 v200, v8, v160
    v_mfma_f32_32x32x8_bf16 v[32:47], v[72:73], v[184:185], v[32:47]
    v_fmac_f32 v200, v9, v161
    v_permlane32_swap_b32 v196, v254
    v_fmac_f32 v200, v10, v162
    v_fmac_f32 v200, v11, v163
    v_fmac_f32 v200, v12, v164
    v_mfma_f32_32x32x8_bf16 v[48:63], v[76:77], v[184:185], v[48:63]
    ds_swizzle_b32 v76, v76 offset:0x401F
    ds_swizzle_b32 v77, v77 offset:0x401F
    v_fmac_f32 v200, v13, v165
    v_fmac_f32 v200, v14, v166
    v_fmac_f32 v200, v15, v167
    v_add_f32 v254, v196, v254
    s_waitcnt lgkmcnt(6)
    s_mov_b64 exec, s[56:57]
    v_xor_b32 v68, 0x80008000, v68
    v_xor_b32 v69, 0x80008000, v69
    v_xor_b32 v70, 0x80008000, v70
    v_xor_b32 v71, 0x80008000, v71
    s_mov_b64 exec, -1
    s_waitcnt vmcnt(6) lgkmcnt(2)
    v_mfma_f32_32x32x16_bf16 v[0:15], v[64:67], v[176:179], 0
    v_mul_f32 v255, v32, v152
    v_fmac_f32 v255, v33, v153
    v_fmac_f32 v255, v34, v154
    v_fmac_f32 v255, v35, v155
    v_fmac_f32 v255, v36, v156
    v_fmac_f32 v255, v37, v157
    s_add_u32 m0, s21, 4096
    v_mfma_f32_32x32x16_bf16 v[16:31], v[68:71], v[176:179], v[16:31]
    v_lshl_add_u32 v238, v238, 10, v246
    v_lshl_add_u32 v239, v239, 10, v246
    buffer_load_dwordx4 v238, s[4:7], s40 offen  lds
    buffer_load_dwordx4 v239, s[8:11], s40 offen offset:1024  lds
    ds_read_b64_tr_b16 v[176:177], v244 offset:6144
    ds_read_b64_tr_b16 v[184:185], v245 offset:6144
    v_fmac_f32 v255, v38, v158
    v_fmac_f32 v255, v39, v159
    v_fmac_f32 v201, v40, v168
    v_fmac_f32 v201, v41, v169
    v_permlane32_swap_b32 v197, v255
    s_waitcnt lgkmcnt(0)
    s_mov_b64 exec, s[56:57]
    v_xor_b32 v76, 0x80008000, v76
    v_xor_b32 v77, 0x80008000, v77
    s_mov_b64 exec, -1
    v_mfma_f32_32x32x8_bf16 v[0:15], v[72:73], v[176:177], v[0:15]
    v_fmac_f32 v201, v42, v170
    v_fmac_f32 v201, v43, v171
    v_fmac_f32 v201, v44, v172
    v_fmac_f32 v201, v45, v173
    v_fmac_f32 v201, v46, v174
    v_fmac_f32 v201, v47, v175
    s_add_u32 m0, s21, 6144
    v_mfma_f32_32x32x8_bf16 v[16:31], v[76:77], v[176:177], v[16:31]
    v_lshl_add_u32 v240, v240, 10, v246
    v_lshl_add_u32 v241, v241, 10, v246
    buffer_load_dwordx4 v240, s[4:7], s41 offen  lds
    buffer_load_dwordx4 v241, s[8:11], s41 offen offset:1024  lds
    v_add_f32 v255, v197, v255
    s_set_gpr_idx_on s51, gpr_idx(DST)
    s_nop 0
    v_cvt_pk_bf16_f32 v206, v254, v255
    s_set_gpr_idx_off
    v_mfma_f32_32x32x16_bf16 v[32:47], v[64:67], v[180:183], 0
    v_mul_f32 v254, v0, v144
    v_fmac_f32 v254, v1, v145
    v_fmac_f32 v254, v2, v146
    v_fmac_f32 v254, v3, v147
    v_fmac_f32 v254, v4, v148
    v_fmac_f32 v254, v5, v149
    v_fmac_f32 v254, v6, v150
    v_fmac_f32 v254, v7, v151
    v_fma_f32 v202, v8, -v160, v202
    v_fma_f32 v202, v9, -v161, v202
    v_mfma_f32_32x32x16_bf16 v[48:63], v[68:71], v[180:183], v[48:63]
    s_waitcnt vmcnt(8)
    ds_read_b64_tr_b16 v[176:177], v244 offset:0
    ds_read_b64_tr_b16 v[178:179], v244 offset:1024
    ds_read_b64_tr_b16 v[180:181], v245 offset:0
    ds_read_b64_tr_b16 v[182:183], v245 offset:1024
    v_permlane32_swap_b32 v254, v200
    v_fma_f32 v202, v10, -v162, v202
    v_fma_f32 v202, v11, -v163, v202
    v_fma_f32 v202, v12, -v164, v202
    v_fma_f32 v202, v13, -v165, v202
    v_fma_f32 v202, v14, -v166, v202
    v_fma_f32 v202, v15, -v167, v202
    v_add_f32 v200, v254, v200
    v_fmac_f32 v198, v16, v112
    v_permlane32_swap_b32 v202, v254
    v_mfma_f32_32x32x8_bf16 v[32:47], v[72:73], v[184:185], v[32:47]
    v_fmac_f32 v198, v17, v113
    v_fmac_f32 v198, v18, v114
    v_fmac_f32 v198, v19, v115
    v_fmac_f32 v198, v20, v116
    v_fmac_f32 v198, v21, v117
    v_fmac_f32 v198, v22, v118
    v_fmac_f32 v198, v23, v119
    v_add_f32 v254, v202, v254
    v_mul_f32 v196, v24, v160
    v_fmac_f32 v196, v25, v161
    v_mfma_f32_32x32x8_bf16 v[48:63], v[76:77], v[184:185], v[48:63]
    v_add_u32 v249, s48, v249
    v_add_u32 v250, s49, v250
    s_waitcnt vmcnt(4)
    ds_read_b64_tr_b16 v[64:65], v249 offset:0
    ds_read_b64_tr_b16 v[68:69], v249 offset:64
    ds_read_b64_tr_b16 v[66:67], v249 offset:256
    ds_read_b64_tr_b16 v[70:71], v249 offset:320
    s_mov_b64 exec, s[54:55]
    ds_read_u16_d16_hi v242, v250 offset:0
    s_mov_b64 exec, -1
    v_fmac_f32 v196, v26, v162
    v_fmac_f32 v196, v27, v163
    v_fmac_f32 v196, v28, v164
    v_fmac_f32 v196, v29, v165
    v_fmac_f32 v196, v30, v166
    v_fmac_f32 v196, v31, v167
    s_nop 1
    v_permlane32_swap_b32 v198, v196
    v_add_f32 v196, v198, v196
    v_mul_f32 v255, v32, v152
    v_fmac_f32 v255, v33, v153
    v_fmac_f32 v255, v34, v154
    v_fmac_f32 v255, v35, v155
    v_fmac_f32 v255, v36, v156
    v_fmac_f32 v255, v37, v157
    v_fmac_f32 v255, v38, v158
    v_fmac_f32 v255, v39, v159
    v_fma_f32 v203, v40, -v168, v203
    v_fma_f32 v203, v41, -v169, v203
    v_permlane32_swap_b32 v255, v201
    v_fma_f32 v203, v42, -v170, v203
    v_fma_f32 v203, v43, -v171, v203
    v_fma_f32 v203, v44, -v172, v203
    v_fma_f32 v203, v45, -v173, v203
    v_fma_f32 v203, v46, -v174, v203
    v_fma_f32 v203, v47, -v175, v203
    v_add_f32 v201, v255, v201
    v_fmac_f32 v199, v48, v120
    v_permlane32_swap_b32 v203, v255
    v_fmac_f32 v199, v49, v121
    v_fmac_f32 v199, v50, v122
    v_fmac_f32 v199, v51, v123
    v_fmac_f32 v199, v52, v124
    v_fmac_f32 v199, v53, v125
    v_fmac_f32 v199, v54, v126
    v_fmac_f32 v199, v55, v127
    v_add_f32 v255, v203, v255
    v_mul_f32 v197, v56, v168
    v_fmac_f32 v197, v57, v169
    v_fmac_f32 v197, v58, v170
    v_fmac_f32 v197, v59, v171
    v_fmac_f32 v197, v60, v172
    v_fmac_f32 v197, v61, v173
    v_fmac_f32 v197, v62, v174
    v_fmac_f32 v197, v63, v175
    s_nop 1
    v_permlane32_swap_b32 v199, v197
    v_add_f32 v197, v199, v197
    s_set_gpr_idx_on s51, gpr_idx(DST)
    s_nop 0
    v_cvt_pk_bf16_f32 v207, v200, v201
    v_cvt_pk_bf16_f32 v209, v254, v255
    v_cvt_pk_bf16_f32 v208, v196, v197
    s_set_gpr_idx_off
    s_add_u32 s50, s50, 1
    s_add_u32 s51, s51, 6
    s_cmp_ge_u32 s50, 4
    s_cbranch_scc1 LAST0
    s_add_u32 s53, s53, 4
    s_xor_b32 s66, s53, s20
    s_bitcmp1_b32 s66, 2
    s_setprio 1
    s_cbranch_scc1 PRIO_7
    s_setprio 0
PRIO_7:
    s_cmp_eq_u32 s52, 4
    s_cbranch_scc1 ITEM_0_4
    s_cmp_eq_u32 s52, 5
    s_cbranch_scc1 ITEM_0_5
    s_cmp_eq_u32 s52, 3
    s_cbranch_scc1 ITEM_0_3
    s_cmp_eq_u32 s52, 6
    s_cbranch_scc1 ITEM_0_6
    s_cmp_eq_u32 s52, 8
    s_cbranch_scc1 ITEM_0_8
    s_branch ITEM_0_2
.p2align 6
ITEM_0_6:
    s_mov_b64 exec, s[54:55]
    ds_read_u16_d16_hi v243, v250 offset:128
    s_mov_b64 exec, -1
    ds_read_b64_tr_b16 v[72:73], v249 offset:512
    ds_read_b64_tr_b16 v[76:77], v249 offset:576
    ds_read_b64_tr_b16 v[74:75], v249 offset:768
    ds_read_b64_tr_b16 v[78:79], v249 offset:832
    ds_read_b64_tr_b16 v[80:81], v249 offset:1024
    ds_read_b64_tr_b16 v[84:85], v249 offset:1088
    ds_read_b64_tr_b16 v[82:83], v249 offset:1280
    ds_read_b64_tr_b16 v[86:87], v249 offset:1344
    s_waitcnt lgkmcnt(9)
    v_mul_f32_dpp v196, v242, v64 row_newbcast:0 row_mask:0xf bank_mask:0xf
    v_mul_f32_dpp v197, v242, v65 row_newbcast:1 row_mask:0xf bank_mask:0xf
    v_mul_f32_dpp v198, v242, v64 row_newbcast:8 row_mask:0xf bank_mask:0xf
    v_mul_f32_dpp v199, v242, v65 row_newbcast:9 row_mask:0xf bank_mask:0xf
    v_mul_f32_dpp v200, v242, v68 row_newbcast:2 row_mask:0xf bank_mask:0xf
    v_mul_f32_dpp v201, v242, v69 row_newbcast:3 row_mask:0xf bank_mask:0xf
    v_mul_f32_dpp v202, v242, v68 row_newbcast:10 row_mask:0xf bank_mask:0xf
    v_mul_f32_dpp v203, v242, v69 row_newbcast:11 row_mask:0xf bank_mask:0xf
    v_cvt_pk_bf16_f32 v64, v196, v197
    v_cvt_pk_bf16_f32 v68, v198, v199
    v_cvt_pk_bf16_f32 v65, v200, v201
    v_cvt_pk_bf16_f32 v69, v202, v203
    v_mul_f32_dpp v196, v242, v66 row_newbcast:4 row_mask:0xf bank_mask:0xf
    v_mul_f32_dpp v197, v242, v67 row_newbcast:5 row_mask:0xf bank_mask:0xf
    v_mul_f32_dpp v198, v242, v66 row_newbcast:12 row_mask:0xf bank_mask:0xf
    v_mul_f32_dpp v199, v242, v67 row_newbcast:13 row_mask:0xf bank_mask:0xf
    v_mul_f32_dpp v200, v242, v70 row_newbcast:6 row_mask:0xf bank_mask:0xf
    v_mul_f32_dpp v201, v242, v71 row_newbcast:7 row_mask:0xf bank_mask:0xf
    v_mul_f32_dpp v202, v242, v70 row_newbcast:14 row_mask:0xf bank_mask:0xf
    v_mul_f32_dpp v203, v242, v71 row_newbcast:15 row_mask:0xf bank_mask:0xf
    v_cvt_pk_bf16_f32 v66, v196, v197
    v_cvt_pk_bf16_f32 v70, v198, v199
    v_cvt_pk_bf16_f32 v67, v200, v201
    v_cvt_pk_bf16_f32 v71, v202, v203
    s_mov_b64 exec, s[54:55]
    ds_read_u16_d16_hi v242, v250 offset:256
    s_mov_b64 exec, -1
    s_waitcnt vmcnt(4) lgkmcnt(5)
    v_mfma_f32_32x32x16_bf16 v[0:15], v[64:67], v[176:179], 0
    v_mul_f32_dpp v196, v243, v72 row_newbcast:0 row_mask:0xf bank_mask:0xf
    v_mul_f32_dpp v197, v243, v73 row_newbcast:1 row_mask:0xf bank_mask:0xf
    v_mul_f32_dpp v198, v243, v72 row_newbcast:8 row_mask:0xf bank_mask:0xf
    v_mul_f32_dpp v199, v243, v73 row_newbcast:9 row_mask:0xf bank_mask:0xf
    v_mul_f32_dpp v200, v243, v76 row_newbcast:2 row_mask:0xf bank_mask:0xf
    v_mul_f32_dpp v201, v243, v77 row_newbcast:3 row_mask:0xf bank_mask:0xf
    v_mul_f32_dpp v202, v243, v76 row_newbcast:10 row_mask:0xf bank_mask:0xf
    v_mul_f32_dpp v203, v243, v77 row_newbcast:11 row_mask:0xf bank_mask:0xf
    v_cvt_pk_bf16_f32 v72, v196, v197
    v_cvt_pk_bf16_f32 v76, v198, v199
    v_cvt_pk_bf16_f32 v73, v200, v201
    v_cvt_pk_bf16_f32 v77, v202, v203
    s_add_u32 m0, s21, 0
    v_mfma_f32_32x32x16_bf16 v[16:31], v[68:71], v[176:179], 0
    buffer_load_dwordx4 v236, s[4:7], s35 offen  lds
    buffer_load_dwordx4 v237, s[8:11], s35 offen offset:1024  lds
    ds_read_b64_tr_b16 v[176:177], v244 offset:2048
    ds_read_b64_tr_b16 v[178:179], v244 offset:3072
    ds_read_b64_tr_b16 v[184:185], v245 offset:2048
    ds_read_b64_tr_b16 v[186:187], v245 offset:3072
    v_mul_f32_dpp v196, v243, v74 row_newbcast:4 row_mask:0xf bank_mask:0xf
    v_mul_f32_dpp v197, v243, v75 row_newbcast:5 row_mask:0xf bank_mask:0xf
    v_mul_f32_dpp v198, v243, v74 row_newbcast:12 row_mask:0xf bank_mask:0xf
    v_mul_f32_dpp v199, v243, v75 row_newbcast:13 row_mask:0xf bank_mask:0xf
    v_mul_f32_dpp v200, v243, v78 row_newbcast:6 row_mask:0xf bank_mask:0xf
    v_mul_f32_dpp v201, v243, v79 row_newbcast:7 row_mask:0xf bank_mask:0xf
    v_mul_f32_dpp v202, v243, v78 row_newbcast:14 row_mask:0xf bank_mask:0xf
    v_mul_f32_dpp v203, v243, v79 row_newbcast:15 row_mask:0xf bank_mask:0xf
    v_cvt_pk_bf16_f32 v74, v196, v197
    v_cvt_pk_bf16_f32 v78, v198, v199
    v_cvt_pk_bf16_f32 v75, v200, v201
    v_cvt_pk_bf16_f32 v79, v202, v203
    s_nop 0
    s_waitcnt vmcnt(4) lgkmcnt(0)
    v_mfma_f32_32x32x16_bf16 v[0:15], v[72:75], v[176:179], v[0:15]
    v_mul_f32_dpp v196, v242, v80 row_newbcast:0 row_mask:0xf bank_mask:0xf
    v_mul_f32_dpp v197, v242, v81 row_newbcast:1 row_mask:0xf bank_mask:0xf
    v_mul_f32_dpp v198, v242, v80 row_newbcast:8 row_mask:0xf bank_mask:0xf
    v_mul_f32_dpp v199, v242, v81 row_newbcast:9 row_mask:0xf bank_mask:0xf
    v_mul_f32_dpp v200, v242, v84 row_newbcast:2 row_mask:0xf bank_mask:0xf
    v_mul_f32_dpp v201, v242, v85 row_newbcast:3 row_mask:0xf bank_mask:0xf
    v_mul_f32_dpp v202, v242, v84 row_newbcast:10 row_mask:0xf bank_mask:0xf
    v_mul_f32_dpp v203, v242, v85 row_newbcast:11 row_mask:0xf bank_mask:0xf
    v_cvt_pk_bf16_f32 v80, v196, v197
    v_cvt_pk_bf16_f32 v84, v198, v199
    v_cvt_pk_bf16_f32 v81, v200, v201
    v_cvt_pk_bf16_f32 v85, v202, v203
    s_add_u32 m0, s21, 2048
    v_mfma_f32_32x32x16_bf16 v[16:31], v[76:79], v[176:179], v[16:31]
    buffer_load_dwordx4 v238, s[4:7], s35 offen  lds
    buffer_load_dwordx4 v239, s[8:11], s35 offen offset:1024  lds
    ds_read_b64_tr_b16 v[176:177], v244 offset:4096
    ds_read_b64_tr_b16 v[178:179], v244 offset:5120
    ds_read_b64_tr_b16 v[188:189], v245 offset:4096
    ds_read_b64_tr_b16 v[190:191], v245 offset:5120
    v_mul_f32_dpp v196, v242, v82 row_newbcast:4 row_mask:0xf bank_mask:0xf
    v_mul_f32_dpp v197, v242, v83 row_newbcast:5 row_mask:0xf bank_mask:0xf
    v_mul_f32_dpp v198, v242, v82 row_newbcast:12 row_mask:0xf bank_mask:0xf
    v_mul_f32_dpp v199, v242, v83 row_newbcast:13 row_mask:0xf bank_mask:0xf
    v_mul_f32_dpp v200, v242, v86 row_newbcast:6 row_mask:0xf bank_mask:0xf
    v_mul_f32_dpp v201, v242, v87 row_newbcast:7 row_mask:0xf bank_mask:0xf
    v_mul_f32_dpp v202, v242, v86 row_newbcast:14 row_mask:0xf bank_mask:0xf
    v_mul_f32_dpp v203, v242, v87 row_newbcast:15 row_mask:0xf bank_mask:0xf
    v_cvt_pk_bf16_f32 v82, v196, v197
    v_cvt_pk_bf16_f32 v86, v198, v199
    v_cvt_pk_bf16_f32 v83, v200, v201
    v_cvt_pk_bf16_f32 v87, v202, v203
    s_nop 0
    s_waitcnt lgkmcnt(0)
    v_mfma_f32_32x32x16_bf16 v[0:15], v[80:83], v[176:179], v[0:15]
    s_add_u32 m0, s21, 4096
    v_mfma_f32_32x32x16_bf16 v[16:31], v[84:87], v[176:179], v[16:31]
    buffer_load_dwordx4 v234, s[4:7], s36 offen  lds
    buffer_load_dwordx4 v235, s[8:11], s36 offen offset:1024  lds
    s_mov_b32 m0, s50
    s_nop 0
    s_movrels_b32 s71, s23
    s_bfe_u32 s46, s71, 0x30012
    s_mov_b32 m0, s46
    s_and_b32 s66, s71, 0x3ffff
    s_movrels_b32 s68, s57
    s_movrels_b32 s69, s61
    s_sub_u32 s48, s66, s47
    s_mov_b32 s47, s66
    s_lshr_b32 s52, s71, 28
    s_lshl_b32 s67, s46, 9
    s_add_u32 s66, s66, s67
    s_sub_u32 s49, s66, s42
    s_mov_b32 s42, s66
    s_bfe_u32 s66, s68, 655360
    s_add_u32 s43, s42, s66
    s_bfe_u32 s39, s69, 655360
    s_bfe_u32 s66, s68, 655370
    s_add_u32 s44, s42, s66
    s_bfe_u32 s40, s69, 655370
    s_bfe_u32 s66, s68, 655380
    s_add_u32 s45, s42, s66
    s_bfe_u32 s41, s69, 655380
    s_and_b32 s66, s46, s33
    s_cselect_b32 s72, -1, 1
    s_cselect_b32 s76, s47, 163712
    s_cmp_ge_u32 s66, 2
    s_cselect_b32 s73, -1, 0
    s_add_u32 s77, s47, 1024
    s_cmp_ge_u32 s66, 4
    s_cselect_b32 s75, -1, 0
    s_cmp_ge_u32 s66, 3
    s_cselect_b32 s74, -1, 1
    s_cselect_b32 s77, s77, 163712
    v_add_u32 v252, s45, v247
    ds_read_u16 v240, v252
    ds_read_u16 v241, v252 offset:64
    v_mfma_f32_32x32x16_bf16 v[32:47], v[64:67], v[180:183], 0
    v_mul_f32 v196, v0, v96
    v_fmac_f32 v196, v1, v97
    v_fmac_f32 v196, v2, v98
    v_fmac_f32 v196, v3, v99
    v_fmac_f32 v196, v4, v100
    v_fmac_f32 v196, v5, v101
    v_fmac_f32 v196, v6, v102
    v_mfma_f32_32x32x16_bf16 v[48:63], v[68:71], v[180:183], 0
    v_fmac_f32 v196, v7, v103
    v_mul_f32 v198, v8, v128
    v_fmac_f32 v198, v9, v129
    v_fmac_f32 v198, v10, v130
    v_fmac_f32 v198, v11, v131
    v_fmac_f32 v198, v12, v132
    v_mfma_f32_32x32x16_bf16 v[32:47], v[72:75], v[184:187], v[32:47]
    v_fmac_f32 v198, v13, v133
    v_fmac_f32 v198, v14, v134
    v_fmac_f32 v198, v15, v135
    v_mul_f32 v200, v16, v128
    v_fmac_f32 v200, v17, v129
    v_permlane32_swap_b32 v196, v198
    v_mfma_f32_32x32x16_bf16 v[48:63], v[76:79], v[184:187], v[48:63]
    s_waitcnt vmcnt(6)
    ds_read_b64_tr_b16 v[176:177], v244 offset:6144
    ds_read_b64_tr_b16 v[178:179], v244 offset:7168
    ds_read_b64_tr_b16 v[180:181], v245 offset:6144
    ds_read_b64_tr_b16 v[182:183], v245 offset:7168
    v_fmac_f32 v200, v18, v130
    v_fmac_f32 v200, v19, v131
    v_fmac_f32 v200, v20, v132
    v_fmac_f32 v200, v21, v133
    v_fmac_f32 v200, v22, v134
    v_fmac_f32 v200, v23, v135
    v_mfma_f32_32x32x16_bf16 v[32:47], v[80:83], v[188:191], v[32:47]
    v_add_f32 v198, v196, v198
    v_mul_f32_e64 v202, v24, -v128
    v_fma_f32 v202, v25, -v129, v202
    v_fma_f32 v202, v26, -v130, v202
    v_fma_f32 v202, v27, -v131, v202
    v_fma_f32 v202, v28, -v132, v202
    v_mfma_f32_32x32x16_bf16 v[48:63], v[84:87], v[188:191], v[48:63]
    v_fma_f32 v202, v29, -v133, v202
    v_fma_f32 v202, v30, -v134, v202
    v_fma_f32 v202, v31, -v135, v202
    s_nop 1
    v_permlane32_swap_b32 v200, v202
    v_add_f32 v202, v200, v202
    s_waitcnt vmcnt(4) lgkmcnt(0)
    v_mfma_f32_32x32x16_bf16 v[0:15], v[64:67], v[176:179], 0
    v_mul_f32 v197, v32, v104
    v_fmac_f32 v197, v33, v105
    v_fmac_f32 v197, v34, v106
    v_fmac_f32 v197, v35, v107
    v_fmac_f32 v197, v36, v108
    v_fmac_f32 v197, v37, v109
    v_fmac_f32 v197, v38, v110
    s_add_u32 m0, s21, 6144
    v_mfma_f32_32x32x16_bf16 v[16:31], v[68:71], v[176:179], 0
    buffer_load_dwordx4 v236, s[4:7], s36 offen  lds
    buffer_load_dwordx4 v237, s[8:11], s36 offen offset:1024  lds
    ds_read_b64_tr_b16 v[176:177], v244 offset:0
    ds_read_b64_tr_b16 v[178:179], v244 offset:1024
    ds_read_b64_tr_b16 v[184:185], v245 offset:0
    ds_read_b64_tr_b16 v[186:187], v245 offset:1024
    v_fmac_f32 v197, v39, v111
    v_mul_f32 v199, v40, v136
    v_fmac_f32 v199, v41, v137
    v_fmac_f32 v199, v42, v138
    v_fmac_f32 v199, v43, v139
    v_fmac_f32 v199, v44, v140
    v_fmac_f32 v199, v45, v141
    s_waitcnt vmcnt(4) lgkmcnt(0)
    v_mfma_f32_32x32x16_bf16 v[0:15], v[72:75], v[176:179], v[0:15]
    v_fmac_f32 v199, v46, v142
    v_fmac_f32 v199, v47, v143
    v_mul_f32 v201, v48, v136
    v_fmac_f32 v201, v49, v137
    v_permlane32_swap_b32 v197, v199
    v_fmac_f32 v201, v50, v138
    v_fmac_f32 v201, v51, v139
    s_add_u32 m0, s21, 0
    v_mfma_f32_32x32x16_bf16 v[16:31], v[76:79], v[176:179], v[16:31]
    buffer_load_dwordx4 v238, s[4:7], s36 offen  lds
    buffer_load_dwordx4 v239, s[8:11], s36 offen offset:1024  lds
    ds_read_b64_tr_b16 v[176:177], v244 offset:2048
    ds_read_b64_tr_b16 v[178:179], v244 offset:3072
    ds_read_b64_tr_b16 v[188:189], v245 offset:2048
    ds_read_b64_tr_b16 v[190:191], v245 offset:3072
    v_fmac_f32 v201, v52, v140
    v_fmac_f32 v201, v53, v141
    v_fmac_f32 v201, v54, v142
    v_fmac_f32 v201, v55, v143
    v_add_f32 v199, v197, v199
    v_mul_f32_e64 v203, v56, -v136
    v_fma_f32 v203, v57, -v137, v203
    s_waitcnt lgkmcnt(0)
    v_mfma_f32_32x32x16_bf16 v[0:15], v[80:83], v[176:179], v[0:15]
    v_fma_f32 v203, v58, -v138, v203
    v_fma_f32 v203, v59, -v139, v203
    v_fma_f32 v203, v60, -v140, v203
    v_fma_f32 v203, v61, -v141, v203
    v_fma_f32 v203, v62, -v142, v203
    v_fma_f32 v203, v63, -v143, v203
    s_nop 1
    s_add_u32 m0, s21, 2048
    v_mfma_f32_32x32x16_bf16 v[16:31], v[84:87], v[176:179], v[16:31]
    buffer_load_dwordx4 v234, s[4:7], s37 offen  lds
    buffer_load_dwordx4 v235, s[8:11], s37 offen offset:1024  lds
    v_add_u32 v252, s42, v247
    ds_read_u16 v234, v252
    ds_read_u16 v235, v252 offset:64
    v_permlane32_swap_b32 v201, v203
    v_add_f32 v203, v201, v203
    s_set_gpr_idx_on s51, gpr_idx(DST)
    s_nop 0
    v_cvt_pk_bf16_f32 v204, v198, v199
    v_cvt_pk_bf16_f32 v205, v202, v203
    s_set_gpr_idx_off
    v_mfma_f32_32x32x16_bf16 v[32:47], v[64:67], v[180:183], 0
    v_mul_f32 v196, v0, v144
    v_fmac_f32 v196, v1, v145
    v_fmac_f32 v196, v2, v146
    v_fmac_f32 v196, v3, v147
    v_fmac_f32 v196, v4, v148
    v_fmac_f32 v196, v5, v149
    v_mfma_f32_32x32x16_bf16 v[48:63], v[68:71], v[180:183], 0
    v_add_u32 v253, s47, v248
    ds_read_b32 v254, v253
    ds_read_b32 v255, v253 offset:256
    v_fmac_f32 v196, v6, v150
    v_fmac_f32 v196, v7, v151
    v_mul_f32 v198, v8, v112
    v_fmac_f32 v198, v9, v113
    v_fmac_f32 v198, v10, v114
    v_mfma_f32_32x32x16_bf16 v[32:47], v[72:75], v[184:187], v[32:47]
    v_fmac_f32 v198, v11, v115
    v_fmac_f32 v198, v12, v116
    v_fmac_f32 v198, v13, v117
    v_fmac_f32 v198, v14, v118
    v_fmac_f32 v198, v15, v119
    v_mfma_f32_32x32x16_bf16 v[48:63], v[76:79], v[184:187], v[48:63]
    s_waitcnt vmcnt(6)
    ds_read_b64_tr_b16 v[176:177], v244 offset:4096
    ds_read_b64_tr_b16 v[178:179], v244 offset:5120
    ds_read_b64_tr_b16 v[180:181], v245 offset:4096
    ds_read_b64_tr_b16 v[182:183], v245 offset:5120
    v_mul_f32_e64 v200, v16, -v160
    v_fma_f32 v200, v17, -v161, v200
    v_fma_f32 v200, v18, -v162, v200
    v_fma_f32 v200, v19, -v163, v200
    v_fma_f32 v200, v20, -v164, v200
    v_fma_f32 v200, v21, -v165, v200
    v_mfma_f32_32x32x16_bf16 v[32:47], v[80:83], v[188:191], v[32:47]
    v_fma_f32 v200, v22, -v166, v200
    v_fma_f32 v200, v23, -v167, v200
    v_mul_f32_e64 v202, v24, -v160
    v_fma_f32 v202, v25, -v161, v202
    v_fma_f32 v202, v26, -v162, v202
    v_mfma_f32_32x32x16_bf16 v[48:63], v[84:87], v[188:191], v[48:63]
    v_fma_f32 v202, v27, -v163, v202
    v_fma_f32 v202, v28, -v164, v202
    v_fma_f32 v202, v29, -v165, v202
    v_fma_f32 v202, v30, -v166, v202
    v_fma_f32 v202, v31, -v167, v202
    s_waitcnt vmcnt(4) lgkmcnt(0)
    v_mfma_f32_32x32x16_bf16 v[0:15], v[64:67], v[176:179], 0
    v_mul_f32 v197, v32, v152
    v_fmac_f32 v197, v33, v153
    v_fmac_f32 v197, v34, v154
    v_fmac_f32 v197, v35, v155
    v_fmac_f32 v197, v36, v156
    v_fmac_f32 v197, v37, v157
    s_add_u32 m0, s21, 4096
    v_mfma_f32_32x32x16_bf16 v[16:31], v[68:71], v[176:179], 0
    buffer_load_dwordx4 v236, s[4:7], s37 offen  lds
    buffer_load_dwordx4 v237, s[8:11], s37 offen offset:1024  lds
    ds_read_b64_tr_b16 v[176:177], v244 offset:6144
    ds_read_b64_tr_b16 v[178:179], v244 offset:7168
    ds_read_b64_tr_b16 v[184:185], v245 offset:6144
    ds_read_b64_tr_b16 v[186:187], v245 offset:7168
    v_add_u32 v252, s43, v247
    ds_read_u16 v236, v252
    ds_read_u16 v237, v252 offset:64
    v_fmac_f32 v197, v38, v158
    v_fmac_f32 v197, v39, v159
    v_mul_f32 v199, v40, v120
    v_fmac_f32 v199, v41, v121
    v_fmac_f32 v199, v42, v122
    s_waitcnt vmcnt(4) lgkmcnt(2)
    v_mfma_f32_32x32x16_bf16 v[0:15], v[72:75], v[176:179], v[0:15]
    v_fmac_f32 v199, v43, v123
    v_fmac_f32 v199, v44, v124
    v_fmac_f32 v199, v45, v125
    v_fmac_f32 v199, v46, v126
    v_fmac_f32 v199, v47, v127
    s_add_u32 m0, s21, 6144
    v_mfma_f32_32x32x16_bf16 v[16:31], v[76:79], v[176:179], v[16:31]
    buffer_load_dwordx4 v238, s[4:7], s37 offen  lds
    buffer_load_dwordx4 v239, s[8:11], s37 offen offset:1024  lds
    ds_read_b64_tr_b16 v[176:177], v244 offset:0
    ds_read_b64_tr_b16 v[178:179], v244 offset:1024
    ds_read_b64_tr_b16 v[188:189], v245 offset:0
    ds_read_b64_tr_b16 v[190:191], v245 offset:1024
    v_add_u32 v252, s44, v247
    ds_read_u16 v238, v252
    ds_read_u16 v239, v252 offset:64
    v_mul_f32_e64 v201, v48, -v168
    v_fma_f32 v201, v49, -v169, v201
    v_fma_f32 v201, v50, -v170, v201
    v_fma_f32 v201, v51, -v171, v201
    v_fma_f32 v201, v52, -v172, v201
    v_fma_f32 v201, v53, -v173, v201
    s_waitcnt lgkmcnt(2)
    v_mfma_f32_32x32x16_bf16 v[0:15], v[80:83], v[176:179], v[0:15]
    v_fma_f32 v201, v54, -v174, v201
    v_fma_f32 v201, v55, -v175, v201
    v_mul_f32_e64 v203, v56, -v168
    v_fma_f32 v203, v57, -v169, v203
    v_fma_f32 v203, v58, -v170, v203
    s_add_u32 m0, s21, 0
    v_mfma_f32_32x32x16_bf16 v[16:31], v[84:87], v[176:179], v[16:31]
    v_lshl_add_u32 v234, v234, 10, v246
    v_lshl_add_u32 v235, v235, 10, v246
    buffer_load_dwordx4 v234, s[4:7], s38 offen  lds
    buffer_load_dwordx4 v235, s[8:11], s38 offen offset:1024  lds
    s_mov_b32 m0, s76
    s_mov_b64 exec, s[72:73]
    buffer_load_dwordx4 v254, s[12:15], 0 offen  lds
    s_mov_b32 m0, s77
    s_mov_b64 exec, s[74:75]
    buffer_load_dwordx4 v255, s[12:15], 0 offen  lds
    s_mov_b64 exec, -1
    v_fma_f32 v203, v59, -v171, v203
    v_fma_f32 v203, v60, -v172, v203
    v_fma_f32 v203, v61, -v173, v203
    v_fma_f32 v203, v62, -v174, v203
    v_fma_f32 v203, v63, -v175, v203
    v_mfma_f32_32x32x16_bf16 v[32:47], v[64:67], v[180:183], 0
    v_mul_f32 v254, v0, v144
    v_fmac_f32 v254, v1, v145
    v_fmac_f32 v254, v2, v146
    v_mfma_f32_32x32x16_bf16 v[48:63], v[68:71], v[180:183], 0
    ds_swizzle_b32 v68, v68 offset:0x401F
    ds_swizzle_b32 v69, v69 offset:0x401F
    ds_swizzle_b32 v70, v70 offset:0x401F
    ds_swizzle_b32 v71, v71 offset:0x401F
    v_fmac_f32 v254, v3, v147
    v_fmac_f32 v254, v4, v148
    v_fmac_f32 v254, v5, v149
    v_mfma_f32_32x32x16_bf16 v[32:47], v[72:75], v[184:187], v[32:47]
    v_fmac_f32 v254, v6, v150
    v_fmac_f32 v254, v7, v151
    v_fmac_f32 v200, v8, v160
    v_mfma_f32_32x32x16_bf16 v[48:63], v[76:79], v[184:187], v[48:63]
    ds_swizzle_b32 v76, v76 offset:0x401F
    ds_swizzle_b32 v77, v77 offset:0x401F
    ds_swizzle_b32 v78, v78 offset:0x401F
    ds_swizzle_b32 v79, v79 offset:0x401F
    s_waitcnt vmcnt(8)
    ds_read_b64_tr_b16 v[176:177], v244 offset:2048
    ds_read_b64_tr_b16 v[178:179], v244 offset:3072
    ds_read_b64_tr_b16 v[180:181], v245 offset:2048
    ds_read_b64_tr_b16 v[182:183], v245 offset:3072
    v_fmac_f32 v200, v9, v161
    v_permlane32_swap_b32 v196, v254
    v_fmac_f32 v200, v10, v162
    v_mfma_f32_32x32x16_bf16 v[32:47], v[80:83], v[188:191], v[32:47]
    v_fmac_f32 v200, v11, v163
    v_fmac_f32 v200, v12, v164
    v_fmac_f32 v200, v13, v165
    v_mfma_f32_32x32x16_bf16 v[48:63], v[84:87], v[188:191], v[48:63]
    ds_swizzle_b32 v84, v84 offset:0x401F
    ds_swizzle_b32 v85, v85 offset:0x401F
    ds_swizzle_b32 v86, v86 offset:0x401F
    ds_swizzle_b32 v87, v87 offset:0x401F
    v_fmac_f32 v200, v14, v166
    v_fmac_f32 v200, v15, v167
    v_add_f32 v254, v196, v254
    s_waitcnt lgkmcnt(8)
    s_mov_b64 exec, s[56:57]
    v_xor_b32 v68, 0x80008000, v68
    v_xor_b32 v69, 0x80008000, v69
    v_xor_b32 v70, 0x80008000, v70
    v_xor_b32 v71, 0x80008000, v71
    v_xor_b32 v76, 0x80008000, v76
    v_xor_b32 v77, 0x80008000, v77
    v_xor_b32 v78, 0x80008000, v78
    v_xor_b32 v79, 0x80008000, v79
    s_mov_b64 exec, -1
    s_waitcnt vmcnt(6) lgkmcnt(4)
    v_mfma_f32_32x32x16_bf16 v[0:15], v[64:67], v[176:179], 0
    v_mul_f32 v255, v32, v152
    v_fmac_f32 v255, v33, v153
    v_fmac_f32 v255, v34, v154
    v_fmac_f32 v255, v35, v155
    s_add_u32 m0, s21, 2048
    v_mfma_f32_32x32x16_bf16 v[16:31], v[68:71], v[176:179], v[16:31]
    v_lshl_add_u32 v236, v236, 10, v246
    v_lshl_add_u32 v237, v237, 10, v246
    buffer_load_dwordx4 v236, s[4:7], s39 offen  lds
    buffer_load_dwordx4 v237, s[8:11], s39 offen offset:1024  lds
    ds_read_b64_tr_b16 v[176:177], v244 offset:4096
    ds_read_b64_tr_b16 v[178:179], v244 offset:5120
    ds_read_b64_tr_b16 v[184:185], v245 offset:4096
    ds_read_b64_tr_b16 v[186:187], v245 offset:5120
    v_fmac_f32 v255, v36, v156
    v_fmac_f32 v255, v37, v157
    v_fmac_f32 v255, v38, v158
    v_fmac_f32 v255, v39, v159
    s_waitcnt vmcnt(6) lgkmcnt(0)
    v_mfma_f32_32x32x16_bf16 v[0:15], v[72:75], v[176:179], v[0:15]
    v_fmac_f32 v201, v40, v168
    v_fmac_f32 v201, v41, v169
    v_permlane32_swap_b32 v197, v255
    s_add_u32 m0, s21, 4096
    v_mfma_f32_32x32x16_bf16 v[16:31], v[76:79], v[176:179], v[16:31]
    v_lshl_add_u32 v238, v238, 10, v246
    v_lshl_add_u32 v239, v239, 10, v246
    buffer_load_dwordx4 v238, s[4:7], s40 offen  lds
    buffer_load_dwordx4 v239, s[8:11], s40 offen offset:1024  lds
    ds_read_b64_tr_b16 v[176:177], v244 offset:6144
    ds_read_b64_tr_b16 v[178:179], v244 offset:7168
    ds_read_b64_tr_b16 v[188:189], v245 offset:6144
    ds_read_b64_tr_b16 v[190:191], v245 offset:7168
    v_fmac_f32 v201, v42, v170
    v_fmac_f32 v201, v43, v171
    v_fmac_f32 v201, v44, v172
    v_fmac_f32 v201, v45, v173
    s_waitcnt lgkmcnt(0)
    s_mov_b64 exec, s[56:57]
    v_xor_b32 v84, 0x80008000, v84
    v_xor_b32 v85, 0x80008000, v85
    v_xor_b32 v86, 0x80008000, v86
    v_xor_b32 v87, 0x80008000, v87
    s_mov_b64 exec, -1
    v_mfma_f32_32x32x16_bf16 v[0:15], v[80:83], v[176:179], v[0:15]
    v_fmac_f32 v201, v46, v174
    v_fmac_f32 v201, v47, v175
    v_add_f32 v255, v197, v255
    s_set_gpr_idx_on s51, gpr_idx(DST)
    s_nop 0
    v_cvt_pk_bf16_f32 v206, v254, v255
    s_set_gpr_idx_off
    s_add_u32 m0, s21, 6144
    v_mfma_f32_32x32x16_bf16 v[16:31], v[84:87], v[176:179], v[16:31]
    v_lshl_add_u32 v240, v240, 10, v246
    v_lshl_add_u32 v241, v241, 10, v246
    buffer_load_dwordx4 v240, s[4:7], s41 offen  lds
    buffer_load_dwordx4 v241, s[8:11], s41 offen offset:1024  lds
    v_mfma_f32_32x32x16_bf16 v[32:47], v[64:67], v[180:183], 0
    v_mul_f32 v254, v0, v144
    v_fmac_f32 v254, v1, v145
    v_fmac_f32 v254, v2, v146
    v_fmac_f32 v254, v3, v147
    v_fmac_f32 v254, v4, v148
    v_fmac_f32 v254, v5, v149
    v_fmac_f32 v254, v6, v150
    v_mfma_f32_32x32x16_bf16 v[48:63], v[68:71], v[180:183], v[48:63]
    v_fmac_f32 v254, v7, v151
    v_fma_f32 v202, v8, -v160, v202
    v_fma_f32 v202, v9, -v161, v202
    v_permlane32_swap_b32 v254, v200
    v_fma_f32 v202, v10, -v162, v202
    v_fma_f32 v202, v11, -v163, v202
    v_mfma_f32_32x32x16_bf16 v[32:47], v[72:75], v[184:187], v[32:47]
    v_fma_f32 v202, v12, -v164, v202
    v_fma_f32 v202, v13, -v165, v202
    v_fma_f32 v202, v14, -v166, v202
    v_fma_f32 v202, v15, -v167, v202
    v_add_f32 v200, v254, v200
    v_fmac_f32 v198, v16, v112
    v_permlane32_swap_b32 v202, v254
    v_mfma_f32_32x32x16_bf16 v[48:63], v[76:79], v[184:187], v[48:63]
    s_waitcnt vmcnt(8)
    ds_read_b64_tr_b16 v[176:177], v244 offset:0
    ds_read_b64_tr_b16 v[178:179], v244 offset:1024
    ds_read_b64_tr_b16 v[180:181], v245 offset:0
    ds_read_b64_tr_b16 v[182:183], v245 offset:1024
    v_fmac_f32 v198, v17, v113
    v_fmac_f32 v198, v18, v114
    v_fmac_f32 v198, v19, v115
    v_fmac_f32 v198, v20, v116
    v_fmac_f32 v198, v21, v117
    v_fmac_f32 v198, v22, v118
    v_mfma_f32_32x32x16_bf16 v[32:47], v[80:83], v[188:191], v[32:47]
    v_fmac_f32 v198, v23, v119
    v_add_f32 v254, v202, v254
    v_mul_f32 v196, v24, v160
    v_fmac_f32 v196, v25, v161
    v_fmac_f32 v196, v26, v162
    v_fmac_f32 v196, v27, v163
    v_fmac_f32 v196, v28, v164
    v_mfma_f32_32x32x16_bf16 v[48:63], v[84:87], v[188:191], v[48:63]
    v_add_u32 v249, s48, v249
    v_add_u32 v250, s49, v250
    s_waitcnt vmcnt(6)
    ds_read_b64_tr_b16 v[64:65], v249 offset:0
    ds_read_b64_tr_b16 v[68:69], v249 offset:64
    ds_read_b64_tr_b16 v[66:67], v249 offset:256
    ds_read_b64_tr_b16 v[70:71], v249 offset:320
    s_mov_b64 exec, s[54:55]
    ds_read_u16_d16_hi v242, v250 offset:0
    s_mov_b64 exec, -1
    v_fmac_f32 v196, v29, v165
    v_fmac_f32 v196, v30, v166
    v_fmac_f32 v196, v31, v167
    s_nop 1
    v_permlane32_swap_b32 v198, v196
    v_add_f32 v196, v198, v196
    v_mul_f32 v255, v32, v152
    v_fmac_f32 v255, v33, v153
    v_fmac_f32 v255, v34, v154
    v_fmac_f32 v255, v35, v155
    v_fmac_f32 v255, v36, v156
    v_fmac_f32 v255, v37, v157
    v_fmac_f32 v255, v38, v158
    v_fmac_f32 v255, v39, v159
    v_fma_f32 v203, v40, -v168, v203
    v_fma_f32 v203, v41, -v169, v203
    v_permlane32_swap_b32 v255, v201
    v_fma_f32 v203, v42, -v170, v203
    v_fma_f32 v203, v43, -v171, v203
    v_fma_f32 v203, v44, -v172, v203
    v_fma_f32 v203, v45, -v173, v203
    v_fma_f32 v203, v46, -v174, v203
    v_fma_f32 v203, v47, -v175, v203
    v_add_f32 v201, v255, v201
    v_fmac_f32 v199, v48, v120
    v_permlane32_swap_b32 v203, v255
    v_fmac_f32 v199, v49, v121
    v_fmac_f32 v199, v50, v122
    v_fmac_f32 v199, v51, v123
    v_fmac_f32 v199, v52, v124
    v_fmac_f32 v199, v53, v125
    v_fmac_f32 v199, v54, v126
    v_fmac_f32 v199, v55, v127
    v_add_f32 v255, v203, v255
    v_mul_f32 v197, v56, v168
    v_fmac_f32 v197, v57, v169
    v_fmac_f32 v197, v58, v170
    v_fmac_f32 v197, v59, v171
    v_fmac_f32 v197, v60, v172
    v_fmac_f32 v197, v61, v173
    v_fmac_f32 v197, v62, v174
    v_fmac_f32 v197, v63, v175
    s_nop 1
    v_permlane32_swap_b32 v199, v197
    v_add_f32 v197, v199, v197
    s_set_gpr_idx_on s51, gpr_idx(DST)
    s_nop 0
    v_cvt_pk_bf16_f32 v207, v200, v201
    v_cvt_pk_bf16_f32 v209, v254, v255
    v_cvt_pk_bf16_f32 v208, v196, v197
    s_set_gpr_idx_off
    s_add_u32 s50, s50, 1
    s_add_u32 s51, s51, 6
    s_cmp_ge_u32 s50, 4
    s_cbranch_scc1 LAST0
    s_add_u32 s53, s53, 4
    s_xor_b32 s66, s53, s20
    s_bitcmp1_b32 s66, 2
    s_setprio 1
    s_cbranch_scc1 PRIO_8
    s_setprio 0
PRIO_8:
    s_cmp_eq_u32 s52, 4
    s_cbranch_scc1 ITEM_0_4
    s_cmp_eq_u32 s52, 5
    s_cbranch_scc1 ITEM_0_5
    s_cmp_eq_u32 s52, 3
    s_cbranch_scc1 ITEM_0_3
    s_cmp_eq_u32 s52, 6
    s_cbranch_scc1 ITEM_0_6
    s_cmp_eq_u32 s52, 8
    s_cbranch_scc1 ITEM_0_8
    s_branch ITEM_0_2
.p2align 6
ITEM_0_8:
    s_mov_b64 exec, s[54:55]
    ds_read_u16_d16_hi v243, v250 offset:128
    s_mov_b64 exec, -1
    ds_read_b64_tr_b16 v[72:73], v249 offset:512
    ds_read_b64_tr_b16 v[76:77], v249 offset:576
    ds_read_b64_tr_b16 v[74:75], v249 offset:768
    ds_read_b64_tr_b16 v[78:79], v249 offset:832
    ds_read_b64_tr_b16 v[80:81], v249 offset:1024
    ds_read_b64_tr_b16 v[84:85], v249 offset:1088
    ds_read_b64_tr_b16 v[82:83], v249 offset:1280
    ds_read_b64_tr_b16 v[86:87], v249 offset:1344
    ds_read_b64_tr_b16 v[88:89], v249 offset:1536
    ds_read_b64_tr_b16 v[92:93], v249 offset:1600
    ds_read_b64_tr_b16 v[90:91], v249 offset:1792
    ds_read_b64_tr_b16 v[94:95], v249 offset:1856
    s_waitcnt lgkmcnt(13)
    v_mul_f32_dpp v196, v242, v64 row_newbcast:0 row_mask:0xf bank_mask:0xf
    v_mul_f32_dpp v197, v242, v65 row_newbcast:1 row_mask:0xf bank_mask:0xf
    v_mul_f32_dpp v198, v242, v64 row_newbcast:8 row_mask:0xf bank_mask:0xf
    v_mul_f32_dpp v199, v242, v65 row_newbcast:9 row_mask:0xf bank_mask:0xf
    v_mul_f32_dpp v200, v242, v68 row_newbcast:2 row_mask:0xf bank_mask:0xf
    v_mul_f32_dpp v201, v242, v69 row_newbcast:3 row_mask:0xf bank_mask:0xf
    v_mul_f32_dpp v202, v242, v68 row_newbcast:10 row_mask:0xf bank_mask:0xf
    v_mul_f32_dpp v203, v242, v69 row_newbcast:11 row_mask:0xf bank_mask:0xf
    v_cvt_pk_bf16_f32 v64, v196, v197
    v_cvt_pk_bf16_f32 v68, v198, v199
    v_cvt_pk_bf16_f32 v65, v200, v201
    v_cvt_pk_bf16_f32 v69, v202, v203
    v_mul_f32_dpp v196, v242, v66 row_newbcast:4 row_mask:0xf bank_mask:0xf
    v_mul_f32_dpp v197, v242, v67 row_newbcast:5 row_mask:0xf bank_mask:0xf
    v_mul_f32_dpp v198, v242, v66 row_newbcast:12 row_mask:0xf bank_mask:0xf
    v_mul_f32_dpp v199, v242, v67 row_newbcast:13 row_mask:0xf bank_mask:0xf
    v_mul_f32_dpp v200, v242, v70 row_newbcast:6 row_mask:0xf bank_mask:0xf
    v_mul_f32_dpp v201, v242, v71 row_newbcast:7 row_mask:0xf bank_mask:0xf
    v_mul_f32_dpp v202, v242, v70 row_newbcast:14 row_mask:0xf bank_mask:0xf
    v_mul_f32_dpp v203, v242, v71 row_newbcast:15 row_mask:0xf bank_mask:0xf
    v_cvt_pk_bf16_f32 v66, v196, v197
    v_cvt_pk_bf16_f32 v70, v198, v199
    v_cvt_pk_bf16_f32 v67, v200, v201
    v_cvt_pk_bf16_f32 v71, v202, v203
    s_mov_b64 exec, s[54:55]
    ds_read_u16_d16_hi v242, v250 offset:256
    s_mov_b64 exec, -1
    s_waitcnt vmcnt(4) lgkmcnt(9)
    v_mfma_f32_32x32x16_bf16 v[0:15], v[64:67], v[176:179], 0
    v_mul_f32_dpp v196, v243, v72 row_newbcast:0 row_mask:0xf bank_mask:0xf
    v_mul_f32_dpp v197, v243, v73 row_newbcast:1 row_mask:0xf bank_mask:0xf
    v_mul_f32_dpp v198, v243, v72 row_newbcast:8 row_mask:0xf bank_mask:0xf
    v_mul_f32_dpp v199, v243, v73 row_newbcast:9 row_mask:0xf bank_mask:0xf
    v_mul_f32_dpp v200, v243, v76 row_newbcast:2 row_mask:0xf bank_mask:0xf
    v_mul_f32_dpp v201, v243, v77 row_newbcast:3 row_mask:0xf bank_mask:0xf
    v_mul_f32_dpp v202, v243, v76 row_newbcast:10 row_mask:0xf bank_mask:0xf
    v_mul_f32_dpp v203, v243, v77 row_newbcast:11 row_mask:0xf bank_mask:0xf
    v_cvt_pk_bf16_f32 v72, v196, v197
    v_cvt_pk_bf16_f32 v76, v198, v199
    v_cvt_pk_bf16_f32 v73, v200, v201
    v_cvt_pk_bf16_f32 v77, v202, v203
    s_add_u32 m0, s21, 0
    v_mfma_f32_32x32x16_bf16 v[16:31], v[68:71], v[176:179], 0
    buffer_load_dwordx4 v234, s[4:7], s35 offen  lds
    buffer_load_dwordx4 v235, s[8:11], s35 offen offset:1024  lds
    ds_read_b64_tr_b16 v[176:177], v244 offset:2048
    ds_read_b64_tr_b16 v[178:179], v244 offset:3072
    ds_read_b64_tr_b16 v[184:185], v245 offset:2048
    ds_read_b64_tr_b16 v[186:187], v245 offset:3072
    v_mul_f32_dpp v196, v243, v74 row_newbcast:4 row_mask:0xf bank_mask:0xf
    v_mul_f32_dpp v197, v243, v75 row_newbcast:5 row_mask:0xf bank_mask:0xf
    v_mul_f32_dpp v198, v243, v74 row_newbcast:12 row_mask:0xf bank_mask:0xf
    v_mul_f32_dpp v199, v243, v75 row_newbcast:13 row_mask:0xf bank_mask:0xf
    v_mul_f32_dpp v200, v243, v78 row_newbcast:6 row_mask:0xf bank_mask:0xf
    v_mul_f32_dpp v201, v243, v79 row_newbcast:7 row_mask:0xf bank_mask:0xf
    v_mul_f32_dpp v202, v243, v78 row_newbcast:14 row_mask:0xf bank_mask:0xf
    v_mul_f32_dpp v203, v243, v79 row_newbcast:15 row_mask:0xf bank_mask:0xf
    v_cvt_pk_bf16_f32 v74, v196, v197
    v_cvt_pk_bf16_f32 v78, v198, v199
    v_cvt_pk_bf16_f32 v75, v200, v201
    v_cvt_pk_bf16_f32 v79, v202, v203
    s_mov_b64 exec, s[54:55]
    ds_read_u16_d16_hi v243, v250 offset:384
    s_mov_b64 exec, -1
    s_waitcnt vmcnt(4) lgkmcnt(1)
    v_mfma_f32_32x32x16_bf16 v[0:15], v[72:75], v[176:179], v[0:15]
    v_mul_f32_dpp v196, v242, v80 row_newbcast:0 row_mask:0xf bank_mask:0xf
    v_mul_f32_dpp v197, v242, v81 row_newbcast:1 row_mask:0xf bank_mask:0xf
    v_mul_f32_dpp v198, v242, v80 row_newbcast:8 row_mask:0xf bank_mask:0xf
    v_mul_f32_dpp v199, v242, v81 row_newbcast:9 row_mask:0xf bank_mask:0xf
    v_mul_f32_dpp v200, v242, v84 row_newbcast:2 row_mask:0xf bank_mask:0xf
    v_mul_f32_dpp v201, v242, v85 row_newbcast:3 row_mask:0xf bank_mask:0xf
    v_mul_f32_dpp v202, v242, v84 row_newbcast:10 row_mask:0xf bank_mask:0xf
    v_mul_f32_dpp v203, v242, v85 row_newbcast:11 row_mask:0xf bank_mask:0xf
    v_cvt_pk_bf16_f32 v80, v196, v197
    v_cvt_pk_bf16_f32 v84, v198, v199
    v_cvt_pk_bf16_f32 v81, v200, v201
    v_cvt_pk_bf16_f32 v85, v202, v203
    s_add_u32 m0, s21, 2048
    v_mfma_f32_32x32x16_bf16 v[16:31], v[76:79], v[176:179], v[16:31]
    buffer_load_dwordx4 v236, s[4:7], s35 offen  lds
    buffer_load_dwordx4 v237, s[8:11], s35 offen offset:1024  lds
    ds_read_b64_tr_b16 v[176:177], v244 offset:4096
    ds_read_b64_tr_b16 v[178:179], v244 offset:5120
    ds_read_b64_tr_b16 v[188:189], v245 offset:4096
    ds_read_b64_tr_b16 v[190:191], v245 offset:5120
    v_mul_f32_dpp v196, v242, v82 row_newbcast:4 row_mask:0xf bank_mask:0xf
    v_mul_f32_dpp v197, v242, v83 row_newbcast:5 row_mask:0xf bank_mask:0xf
    v_mul_f32_dpp v198, v242, v82 row_newbcast:12 row_mask:0xf bank_mask:0xf
    v_mul_f32_dpp v199, v242, v83 row_newbcast:13 row_mask:0xf bank_mask:0xf
    v_mul_f32_dpp v200, v242, v86 row_newbcast:6 row_mask:0xf bank_mask:0xf
    v_mul_f32_dpp v201, v242, v87 row_newbcast:7 row_mask:0xf bank_mask:0xf
    v_mul_f32_dpp v202, v242, v86 row_newbcast:14 row_mask:0xf bank_mask:0xf
    v_mul_f32_dpp v203, v242, v87 row_newbcast:15 row_mask:0xf bank_mask:0xf
    v_cvt_pk_bf16_f32 v82, v196, v197
    v_cvt_pk_bf16_f32 v86, v198, v199
    v_cvt_pk_bf16_f32 v83, v200, v201
    v_cvt_pk_bf16_f32 v87, v202, v203
    s_nop 0
    s_waitcnt vmcnt(4) lgkmcnt(0)
    v_mfma_f32_32x32x16_bf16 v[0:15], v[80:83], v[176:179], v[0:15]
    v_mul_f32_dpp v196, v243, v88 row_newbcast:0 row_mask:0xf bank_mask:0xf
    v_mul_f32_dpp v197, v243, v89 row_newbcast:1 row_mask:0xf bank_mask:0xf
    v_mul_f32_dpp v198, v243, v88 row_newbcast:8 row_mask:0xf bank_mask:0xf
    v_mul_f32_dpp v199, v243, v89 row_newbcast:9 row_mask:0xf bank_mask:0xf
    v_mul_f32_dpp v200, v243, v92 row_newbcast:2 row_mask:0xf bank_mask:0xf
    v_mul_f32_dpp v201, v243, v93 row_newbcast:3 row_mask:0xf bank_mask:0xf
    v_mul_f32_dpp v202, v243, v92 row_newbcast:10 row_mask:0xf bank_mask:0xf
    v_mul_f32_dpp v203, v243, v93 row_newbcast:11 row_mask:0xf bank_mask:0xf
    v_cvt_pk_bf16_f32 v88, v196, v197
    v_cvt_pk_bf16_f32 v92, v198, v199
    v_cvt_pk_bf16_f32 v89, v200, v201
    v_cvt_pk_bf16_f32 v93, v202, v203
    s_add_u32 m0, s21, 4096
    v_mfma_f32_32x32x16_bf16 v[16:31], v[84:87], v[176:179], v[16:31]
    buffer_load_dwordx4 v238, s[4:7], s35 offen  lds
    buffer_load_dwordx4 v239, s[8:11], s35 offen offset:1024  lds
    ds_read_b64_tr_b16 v[176:177], v244 offset:6144
    ds_read_b64_tr_b16 v[178:179], v244 offset:7168
    ds_read_b64_tr_b16 v[192:193], v245 offset:6144
    ds_read_b64_tr_b16 v[194:195], v245 offset:7168
    v_mul_f32_dpp v196, v243, v90 row_newbcast:4 row_mask:0xf bank_mask:0xf
    v_mul_f32_dpp v197, v243, v91 row_newbcast:5 row_mask:0xf bank_mask:0xf
    v_mul_f32_dpp v198, v243, v90 row_newbcast:12 row_mask:0xf bank_mask:0xf
    v_mul_f32_dpp v199, v243, v91 row_newbcast:13 row_mask:0xf bank_mask:0xf
    v_mul_f32_dpp v200, v243, v94 row_newbcast:6 row_mask:0xf bank_mask:0xf
    v_mul_f32_dpp v201, v243, v95 row_newbcast:7 row_mask:0xf bank_mask:0xf
    v_mul_f32_dpp v202, v243, v94 row_newbcast:14 row_mask:0xf bank_mask:0xf
    v_mul_f32_dpp v203, v243, v95 row_newbcast:15 row_mask:0xf bank_mask:0xf
    v_cvt_pk_bf16_f32 v90, v196, v197
    v_cvt_pk_bf16_f32 v94, v198, v199
    v_cvt_pk_bf16_f32 v91, v200, v201
    v_cvt_pk_bf16_f32 v95, v202, v203
    s_nop 0
    s_waitcnt lgkmcnt(0)
    v_mfma_f32_32x32x16_bf16 v[0:15], v[88:91], v[176:179], v[0:15]
    s_add_u32 m0, s21, 6144
    v_mfma_f32_32x32x16_bf16 v[16:31], v[92:95], v[176:179], v[16:31]
    buffer_load_dwordx4 v240, s[4:7], s35 offen  lds
    buffer_load_dwordx4 v241, s[8:11], s35 offen offset:1024  lds
    s_mov_b32 m0, s50
    s_nop 0
    s_movrels_b32 s71, s23
    s_bfe_u32 s46, s71, 0x30012
    s_mov_b32 m0, s46
    s_and_b32 s66, s71, 0x3ffff
    s_movrels_b32 s68, s57
    s_movrels_b32 s69, s61
    s_sub_u32 s48, s66, s47
    s_mov_b32 s47, s66
    s_lshr_b32 s52, s71, 28
    s_lshl_b32 s67, s46, 9
    s_add_u32 s66, s66, s67
    s_sub_u32 s49, s66, s42
    s_mov_b32 s42, s66
    s_bfe_u32 s66, s68, 655360
    s_add_u32 s43, s42, s66
    s_bfe_u32 s39, s69, 655360
    s_bfe_u32 s66, s68, 655370
    s_add_u32 s44, s42, s66
    s_bfe_u32 s40, s69, 655370
    s_bfe_u32 s66, s68, 655380
    s_add_u32 s45, s42, s66
    s_bfe_u32 s41, s69, 655380
    s_and_b32 s66, s46, s33
    s_cselect_b32 s72, -1, 1
    s_cselect_b32 s76, s47, 163712
    s_cmp_ge_u32 s66, 2
    s_cselect_b32 s73, -1, 0
    s_add_u32 s77, s47, 1024
    s_cmp_ge_u32 s66, 4
    s_cselect_b32 s75, -1, 0
    s_cmp_ge_u32 s66, 3
    s_cselect_b32 s74, -1, 1
    s_cselect_b32 s77, s77, 163712
    v_mfma_f32_32x32x16_bf16 v[32:47], v[64:67], v[180:183], 0
    v_mul_f32 v196, v0, v96
    v_fmac_f32 v196, v1, v97
    v_fmac_f32 v196, v2, v98
    v_fmac_f32 v196, v3, v99
    v_fmac_f32 v196, v4, v100
    v_mfma_f32_32x32x16_bf16 v[48:63], v[68:71], v[180:183], 0
    v_fmac_f32 v196, v5, v101
    v_fmac_f32 v196, v6, v102
    v_fmac_f32 v196, v7, v103
    v_mul_f32 v198, v8, v128
    v_fmac_f32 v198, v9, v129
    v_mfma_f32_32x32x16_bf16 v[32:47], v[72:75], v[184:187], v[32:47]
    v_fmac_f32 v198, v10, v130
    v_fmac_f32 v198, v11, v131
    v_fmac_f32 v198, v12, v132
    v_fmac_f32 v198, v13, v133
    v_mfma_f32_32x32x16_bf16 v[48:63], v[76:79], v[184:187], v[48:63]
    v_fmac_f32 v198, v14, v134
    v_fmac_f32 v198, v15, v135
    v_mul_f32 v200, v16, v128
    v_fmac_f32 v200, v17, v129
    v_permlane32_swap_b32 v196, v198
    v_mfma_f32_32x32x16_bf16 v[32:47], v[80:83], v[188:191], v[32:47]
    v_fmac_f32 v200, v18, v130
    v_fmac_f32 v200, v19, v131
    v_fmac_f32 v200, v20, v132
    v_fmac_f32 v200, v21, v133
    v_fmac_f32 v200, v22, v134
    v_mfma_f32_32x32x16_bf16 v[48:63], v[84:87], v[188:191], v[48:63]
    s_waitcnt vmcnt(6)
    ds_read_b64_tr_b16 v[176:177], v244 offset:0
    ds_read_b64_tr_b16 v[178:179], v244 offset:1024
    ds_read_b64_tr_b16 v[180:181], v245 offset:0
    ds_read_b64_tr_b16 v[182:183], v245 offset:1024
    v_fmac_f32 v200, v23, v135
    v_add_f32 v198, v196, v198
    v_mul_f32_e64 v202, v24, -v128
    v_fma_f32 v202, v25, -v129, v202
    v_mfma_f32_32x32x16_bf16 v[32:47], v[88:91], v[192:195], v[32:47]
    v_fma_f32 v202, v26, -v130, v202
    v_fma_f32 v202, v27, -v131, v202
    v_fma_f32 v202, v28, -v132, v202
    v_fma_f32 v202, v29, -v133, v202
    v_fma_f32 v202, v30, -v134, v202
    v_mfma_f32_32x32x16_bf16 v[48:63], v[92:95], v[192:195], v[48:63]
    v_fma_f32 v202, v31, -v135, v202
    s_nop 1
    v_permlane32_swap_b32 v200, v202
    v_add_f32 v202, v200, v202
    s_waitcnt vmcnt(4) lgkmcnt(0)
    v_mfma_f32_32x32x16_bf16 v[0:15], v[64:67], v[176:179], 0
    v_mul_f32 v197, v32, v104
    v_fmac_f32 v197, v33, v105
    v_fmac_f32 v197, v34, v106
    v_fmac_f32 v197, v35, v107
    v_fmac_f32 v197, v36, v108
    v_fmac_f32 v197, v37, v109
    s_add_u32 m0, s21, 0
    v_mfma_f32_32x32x16_bf16 v[16:31], v[68:71], v[176:179], 0
    buffer_load_dwordx4 v234, s[4:7], s36 offen  lds
    buffer_load_dwordx4 v235, s[8:11], s36 offen offset:1024  lds
    ds_read_b64_tr_b16 v[176:177], v244 offset:2048
    ds_read_b64_tr_b16 v[178:179], v244 offset:3072
    ds_read_b64_tr_b16 v[184:185], v245 offset:2048
    ds_read_b64_tr_b16 v[186:187], v245 offset:3072
    v_fmac_f32 v197, v38, v110
    v_fmac_f32 v197, v39, v111
    v_mul_f32 v199, v40, v136
    v_fmac_f32 v199, v41, v137
    v_fmac_f32 v199, v42, v138
    s_waitcnt vmcnt(4) lgkmcnt(0)
    v_mfma_f32_32x32x16_bf16 v[0:15], v[72:75], v[176:179], v[0:15]
    v_fmac_f32 v199, v43, v139
    v_fmac_f32 v199, v44, v140
    v_fmac_f32 v199, v45, v141
    v_fmac_f32 v199, v46, v142
    v_fmac_f32 v199, v47, v143
    s_add_u32 m0, s21, 2048
    v_mfma_f32_32x32x16_bf16 v[16:31], v[76:79], v[176:179], v[16:31]
    buffer_load_dwordx4 v236, s[4:7], s36 offen  lds
    buffer_load_dwordx4 v237, s[8:11], s36 offen offset:1024  lds
    ds_read_b64_tr_b16 v[176:177], v244 offset:4096
    ds_read_b64_tr_b16 v[178:179], v244 offset:5120
    ds_read_b64_tr_b16 v[188:189], v245 offset:4096
    ds_read_b64_tr_b16 v[190:191], v245 offset:5120
    v_mul_f32 v201, v48, v136
    v_fmac_f32 v201, v49, v137
    v_permlane32_swap_b32 v197, v199
    v_fmac_f32 v201, v50, v138
    v_fmac_f32 v201, v51, v139
    s_waitcnt vmcnt(4) lgkmcnt(0)
    v_mfma_f32_32x32x16_bf16 v[0:15], v[80:83], v[176:179], v[0:15]
    v_fmac_f32 v201, v52, v140
    v_fmac_f32 v201, v53, v141
    v_fmac_f32 v201, v54, v142
    v_fmac_f32 v201, v55, v143
    v_add_f32 v199, v197, v199
    v_mul_f32_e64 v203, v56, -v136
    s_add_u32 m0, s21, 4096
    v_mfma_f32_32x32x16_bf16 v[16:31], v[84:87], v[176:179], v[16:31]
    buffer_load_dwordx4 v238, s[4:7], s36 offen  lds
    buffer_load_dwordx4 v239, s[8:11], s36 offen offset:1024  lds
    ds_read_b64_tr_b16 v[176:177], v244 offset:6144
    ds_read_b64_tr_b16 v[178:179], v244 offset:7168
    ds_read_b64_tr_b16 v[192:193], v245 offset:6144
    ds_read_b64_tr_b16 v[194:195], v245 offset:7168
    v_fma_f32 v203, v57, -v137, v203
    v_fma_f32 v203, v58, -v138, v203
    v_fma_f32 v203, v59, -v139, v203
    v_fma_f32 v203, v60, -v140, v203
    v_fma_f32 v203, v61, -v141, v203
    s_waitcnt lgkmcnt(0)
    v_mfma_f32_32x32x16_bf16 v[0:15], v[88:91], v[176:179], v[0:15]
    v_fma_f32 v203, v62, -v142, v203
    v_fma_f32 v203, v63, -v143, v203
    s_nop 1
    v_permlane32_swap_b32 v201, v203
    v_add_f32 v203, v201, v203
    s_add_u32 m0, s21, 6144
    v_mfma_f32_32x32x16_bf16 v[16:31], v[92:95], v[176:179], v[16:31]
    buffer_load_dwordx4 v240, s[4:7], s36 offen  lds
    buffer_load_dwordx4 v241, s[8:11], s36 offen offset:1024  lds
    s_set_gpr_idx_on s51, gpr_idx(DST)
    s_nop 0
    v_cvt_pk_bf16_f32 v204, v198, v199
    v_cvt_pk_bf16_f32 v205, v202, v203
    s_set_gpr_idx_off
    v_mfma_f32_32x32x16_bf16 v[32:47], v[64:67], v[180:183], 0
    v_mul_f32 v196, v0, v144
    v_fmac_f32 v196, v1, v145
    v_fmac_f32 v196, v2, v146
    v_fmac_f32 v196, v3, v147
    v_mfma_f32_32x32x16_bf16 v[48:63], v[68:71], v[180:183], 0
    v_add_u32 v253, s47, v248
    ds_read_b32 v254, v253
    ds_read_b32 v255, v253 offset:256
    v_fmac_f32 v196, v4, v148
    v_fmac_f32 v196, v5, v149
    v_fmac_f32 v196, v6, v150
    v_fmac_f32 v196, v7, v151
    v_mfma_f32_32x32x16_bf16 v[32:47], v[72:75], v[184:187], v[32:47]
    v_mul_f32 v198, v8, v112
    v_fmac_f32 v198, v9, v113
    v_fmac_f32 v198, v10, v114
    v_fmac_f32 v198, v11, v115
    v_mfma_f32_32x32x16_bf16 v[48:63], v[76:79], v[184:187], v[48:63]
    v_fmac_f32 v198, v12, v116
    v_fmac_f32 v198, v13, v117
    v_fmac_f32 v198, v14, v118
    v_fmac_f32 v198, v15, v119
    v_mfma_f32_32x32x16_bf16 v[32:47], v[80:83], v[188:191], v[32:47]
    v_mul_f32_e64 v200, v16, -v160
    v_fma_f32 v200, v17, -v161, v200
    v_fma_f32 v200, v18, -v162, v200
    v_fma_f32 v200, v19, -v163, v200
    v_mfma_f32_32x32x16_bf16 v[48:63], v[84:87], v[188:191], v[48:63]
    s_waitcnt vmcnt(6)
    ds_read_b64_tr_b16 v[176:177], v244 offset:0
    ds_read_b64_tr_b16 v[178:179], v244 offset:1024
    ds_read_b64_tr_b16 v[180:181], v245 offset:0
    ds_read_b64_tr_b16 v[182:183], v245 offset:1024
    v_fma_f32 v200, v20, -v164, v200
    v_fma_f32 v200, v21, -v165, v200
    v_fma_f32 v200, v22, -v166, v200
    v_fma_f32 v200, v23, -v167, v200
    v_mfma_f32_32x32x16_bf16 v[32:47], v[88:91], v[192:195], v[32:47]
    v_mul_f32_e64 v202, v24, -v160
    v_fma_f32 v202, v25, -v161, v202
    v_fma_f32 v202, v26, -v162, v202
    v_fma_f32 v202, v27, -v163, v202
    v_mfma_f32_32x32x16_bf16 v[48:63], v[92:95], v[192:195], v[48:63]
    v_fma_f32 v202, v28, -v164, v202
    v_fma_f32 v202, v29, -v165, v202
    v_fma_f32 v202, v30, -v166, v202
    v_fma_f32 v202, v31, -v167, v202
    s_waitcnt vmcnt(4) lgkmcnt(0)
    v_mfma_f32_32x32x16_bf16 v[0:15], v[64:67], v[176:179], 0
    s_nop 0
    v_mul_f32 v197, v32, v152
    v_fmac_f32 v197, v33, v153
    v_fmac_f32 v197, v34, v154
    v_fmac_f32 v197, v35, v155
    s_add_u32 m0, s21, 0
    v_mfma_f32_32x32x16_bf16 v[16:31], v[68:71], v[176:179], 0
    buffer_load_dwordx4 v234, s[4:7], s37 offen  lds
    buffer_load_dwordx4 v235, s[8:11], s37 offen offset:1024  lds
    ds_read_b64_tr_b16 v[176:177], v244 offset:2048
    ds_read_b64_tr_b16 v[178:179], v244 offset:3072
    ds_read_b64_tr_b16 v[184:185], v245 offset:2048
    ds_read_b64_tr_b16 v[186:187], v245 offset:3072
    v_add_u32 v252, s42, v247
    ds_read_u16 v234, v252
    ds_read_u16 v235, v252 offset:64
    v_fmac_f32 v197, v36, v156
    v_fmac_f32 v197, v37, v157
    v_fmac_f32 v197, v38, v158
    v_fmac_f32 v197, v39, v159
    s_waitcnt vmcnt(4) lgkmcnt(2)
    v_mfma_f32_32x32x16_bf16 v[0:15], v[72:75], v[176:179], v[0:15]
    v_mul_f32 v199, v40, v120
    v_fmac_f32 v199, v41, v121
    v_fmac_f32 v199, v42, v122
    v_fmac_f32 v199, v43, v123
    s_add_u32 m0, s21, 2048
    v_mfma_f32_32x32x16_bf16 v[16:31], v[76:79], v[176:179], v[16:31]
    buffer_load_dwordx4 v236, s[4:7], s37 offen  lds
    buffer_load_dwordx4 v237, s[8:11], s37 offen offset:1024  lds
    ds_read_b64_tr_b16 v[176:177], v244 offset:4096
    ds_read_b64_tr_b16 v[178:179], v244 offset:5120
    ds_read_b64_tr_b16 v[188:189], v245 offset:4096
    ds_read_b64_tr_b16 v[190:191], v245 offset:5120
    v_add_u32 v252, s43, v247
    ds_read_u16 v236, v252
    ds_read_u16 v237, v252 offset:64
    v_fmac_f32 v199, v44, v124
    v_fmac_f32 v199, v45, v125
    v_fmac_f32 v199, v46, v126
    v_fmac_f32 v199, v47, v127
    s_waitcnt vmcnt(4) lgkmcnt(2)
    v_mfma_f32_32x32x16_bf16 v[0:15], v[80:83], v[176:179], v[0:15]
    v_mul_f32_e64 v201, v48, -v168
    v_fma_f32 v201, v49, -v169, v201
    v_fma_f32 v201, v50, -v170, v201
    v_fma_f32 v201, v51, -v171, v201
    s_add_u32 m0, s21, 4096
    v_mfma_f32_32x32x16_bf16 v[16:31], v[84:87], v[176:179], v[16:31]
    buffer_load_dwordx4 v238, s[4:7], s37 offen  lds
    buffer_load_dwordx4 v239, s[8:11], s37 offen offset:1024  lds
    ds_read_b64_tr_b16 v[176:177], v244 offset:6144
    ds_read_b64_tr_b16 v[178:179], v244 offset:7168
    ds_read_b64_tr_b16 v[192:193], v245 offset:6144
    ds_read_b64_tr_b16 v[194:195], v245 offset:7168
    v_add_u32 v252, s44, v247
    ds_read_u16 v238, v252
    ds_read_u16 v239, v252 offset:64
    v_fma_f32 v201, v52, -v172, v201
    v_fma_f32 v201, v53, -v173, v201
    v_fma_f32 v201, v54, -v174, v201
    v_fma_f32 v201, v55, -v175, v201
    s_waitcnt lgkmcnt(2)
    v_mfma_f32_32x32x16_bf16 v[0:15], v[88:91], v[176:179], v[0:15]
    v_mul_f32_e64 v203, v56, -v168
    v_fma_f32 v203, v57, -v169, v203
    v_fma_f32 v203, v58, -v170, v203
    v_fma_f32 v203, v59, -v171, v203
    s_add_u32 m0, s21, 6144
    v_mfma_f32_32x32x16_bf16 v[16:31], v[92:95], v[176:179], v[16:31]
    buffer_load_dwordx4 v240, s[4:7], s37 offen  lds
    buffer_load_dwordx4 v241, s[8:11], s37 offen offset:1024  lds
    v_add_u32 v252, s45, v247
    ds_read_u16 v240, v252
    ds_read_u16 v241, v252 offset:64
    s_mov_b32 m0, s76
    s_mov_b64 exec, s[72:73]
    buffer_load_dwordx4 v254, s[12:15], 0 offen  lds
    s_mov_b32 m0, s77
    s_mov_b64 exec, s[74:75]
    buffer_load_dwordx4 v255, s[12:15], 0 offen  lds
    s_mov_b64 exec, -1
    v_fma_f32 v203, v60, -v172, v203
    v_fma_f32 v203, v61, -v173, v203
    v_fma_f32 v203, v62, -v174, v203
    v_fma_f32 v203, v63, -v175, v203
    v_mfma_f32_32x32x16_bf16 v[32:47], v[64:67], v[180:183], 0
    v_mul_f32 v254, v0, v144
    v_fmac_f32 v254, v1, v145
    v_fmac_f32 v254, v2, v146
    v_mfma_f32_32x32x16_bf16 v[48:63], v[68:71], v[180:183], 0
    ds_swizzle_b32 v68, v68 offset:0x401F
    ds_swizzle_b32 v69, v69 offset:0x401F
    ds_swizzle_b32 v70, v70 offset:0x401F
    ds_swizzle_b32 v71, v71 offset:0x401F
    v_fmac_f32 v254, v3, v147
    v_fmac_f32 v254, v4, v148
    v_mfma_f32_32x32x16_bf16 v[32:47], v[72:75], v[184:187], v[32:47]
    v_fmac_f32 v254, v5, v149
    v_fmac_f32 v254, v6, v150
    v_mfma_f32_32x32x16_bf16 v[48:63], v[76:79], v[184:187], v[48:63]
    ds_swizzle_b32 v76, v76 offset:0x401F
    ds_swizzle_b32 v77, v77 offset:0x401F
    ds_swizzle_b32 v78, v78 offset:0x401F
    ds_swizzle_b32 v79, v79 offset:0x401F
    v_fmac_f32 v254, v7, v151
    v_fmac_f32 v200, v8, v160
    v_mfma_f32_32x32x16_bf16 v[32:47], v[80:83], v[188:191], v[32:47]
    v_fmac_f32 v200, v9, v161
    v_permlane32_swap_b32 v196, v254
    v_fmac_f32 v200, v10, v162
    v_mfma_f32_32x32x16_bf16 v[48:63], v[84:87], v[188:191], v[48:63]
    ds_swizzle_b32 v84, v84 offset:0x401F
    ds_swizzle_b32 v85, v85 offset:0x401F
    ds_swizzle_b32 v86, v86 offset:0x401F
    ds_swizzle_b32 v87, v87 offset:0x401F
    s_waitcnt vmcnt(8)
    ds_read_b64_tr_b16 v[176:177], v244 offset:0
    ds_read_b64_tr_b16 v[178:179], v244 offset:1024
    ds_read_b64_tr_b16 v[180:181], v245 offset:0
    ds_read_b64_tr_b16 v[182:183], v245 offset:1024
    v_fmac_f32 v200, v11, v163
    v_fmac_f32 v200, v12, v164
    v_mfma_f32_32x32x16_bf16 v[32:47], v[88:91], v[192:195], v[32:47]
    v_fmac_f32 v200, v13, v165
    v_fmac_f32 v200, v14, v166
    v_mfma_f32_32x32x16_bf16 v[48:63], v[92:95], v[192:195], v[48:63]
    ds_swizzle_b32 v92, v92 offset:0x401F
    ds_swizzle_b32 v93, v93 offset:0x401F
    ds_swizzle_b32 v94, v94 offset:0x401F
    ds_swizzle_b32 v95, v95 offset:0x401F
    v_fmac_f32 v200, v15, v167
    v_add_f32 v254, v196, v254
    s_waitcnt lgkmcnt(8)
    s_mov_b64 exec, s[56:57]
    v_xor_b32 v68, 0x80008000, v68
    v_xor_b32 v69, 0x80008000, v69
    v_xor_b32 v70, 0x80008000, v70
    v_xor_b32 v71, 0x80008000, v71
    v_xor_b32 v76, 0x80008000, v76
    v_xor_b32 v77, 0x80008000, v77
    v_xor_b32 v78, 0x80008000, v78
    v_xor_b32 v79, 0x80008000, v79
    v_xor_b32 v84, 0x80008000, v84
    v_xor_b32 v85, 0x80008000, v85
    v_xor_b32 v86, 0x80008000, v86
    v_xor_b32 v87, 0x80008000, v87
    s_mov_b64 exec, -1
    s_waitcnt vmcnt(6) lgkmcnt(4)
    v_mfma_f32_32x32x16_bf16 v[0:15], v[64:67], v[176:179], 0
    v_mul_f32 v255, v32, v152
    v_fmac_f32 v255, v33, v153
    v_fmac_f32 v255, v34, v154
    s_add_u32 m0, s21, 0
    v_mfma_f32_32x32x16_bf16 v[16:31], v[68:71], v[176:179], v[16:31]
    v_lshl_add_u32 v234, v234, 10, v246
    v_lshl_add_u32 v235, v235, 10, v246
    buffer_load_dwordx4 v234, s[4:7], s38 offen  lds
    buffer_load_dwordx4 v235, s[8:11], s38 offen offset:1024  lds
    ds_read_b64_tr_b16 v[176:177], v244 offset:2048
    ds_read_b64_tr_b16 v[178:179], v244 offset:3072
    ds_read_b64_tr_b16 v[184:185], v245 offset:2048
    ds_read_b64_tr_b16 v[186:187], v245 offset:3072
    v_fmac_f32 v255, v35, v155
    v_fmac_f32 v255, v36, v156
    v_fmac_f32 v255, v37, v157
    s_waitcnt vmcnt(6) lgkmcnt(0)
    v_mfma_f32_32x32x16_bf16 v[0:15], v[72:75], v[176:179], v[0:15]
    v_fmac_f32 v255, v38, v158
    v_fmac_f32 v255, v39, v159
    v_fmac_f32 v201, v40, v168
    s_add_u32 m0, s21, 2048
    v_mfma_f32_32x32x16_bf16 v[16:31], v[76:79], v[176:179], v[16:31]
    v_lshl_add_u32 v236, v236, 10, v246
    v_lshl_add_u32 v237, v237, 10, v246
    buffer_load_dwordx4 v236, s[4:7], s39 offen  lds
    buffer_load_dwordx4 v237, s[8:11], s39 offen offset:1024  lds
    ds_read_b64_tr_b16 v[176:177], v244 offset:4096
    ds_read_b64_tr_b16 v[178:179], v244 offset:5120
    ds_read_b64_tr_b16 v[188:189], v245 offset:4096
    ds_read_b64_tr_b16 v[190:191], v245 offset:5120
    v_fmac_f32 v201, v41, v169
    v_permlane32_swap_b32 v197, v255
    s_waitcnt vmcnt(6) lgkmcnt(0)
    v_mfma_f32_32x32x16_bf16 v[0:15], v[80:83], v[176:179], v[0:15]
    v_fmac_f32 v201, v42, v170
    v_fmac_f32 v201, v43, v171
    v_fmac_f32 v201, v44, v172
    s_add_u32 m0, s21, 4096
    v_mfma_f32_32x32x16_bf16 v[16:31], v[84:87], v[176:179], v[16:31]
    v_lshl_add_u32 v238, v238, 10, v246
    v_lshl_add_u32 v239, v239, 10, v246
    buffer_load_dwordx4 v238, s[4:7], s40 offen  lds
    buffer_load_dwordx4 v239, s[8:11], s40 offen offset:1024  lds
    ds_read_b64_tr_b16 v[176:177], v244 offset:6144
    ds_read_b64_tr_b16 v[178:179], v244 offset:7168
    ds_read_b64_tr_b16 v[192:193], v245 offset:6144
    ds_read_b64_tr_b16 v[194:195], v245 offset:7168
    v_fmac_f32 v201, v45, v173
    v_fmac_f32 v201, v46, v174
    v_fmac_f32 v201, v47, v175
    s_waitcnt lgkmcnt(0)
    s_mov_b64 exec, s[56:57]
    v_xor_b32 v92, 0x80008000, v92
    v_xor_b32 v93, 0x80008000, v93
    v_xor_b32 v94, 0x80008000, v94
    v_xor_b32 v95, 0x80008000, v95
    s_mov_b64 exec, -1
    v_mfma_f32_32x32x16_bf16 v[0:15], v[88:91], v[176:179], v[0:15]
    v_add_f32 v255, v197, v255
    s_set_gpr_idx_on s51, gpr_idx(DST)
    s_nop 0
    v_cvt_pk_bf16_f32 v206, v254, v255
    s_set_gpr_idx_off
    s_add_u32 m0, s21, 6144
    v_mfma_f32_32x32x16_bf16 v[16:31], v[92:95], v[176:179], v[16:31]
    v_lshl_add_u32 v240, v240, 10, v246
    v_lshl_add_u32 v241, v241, 10, v246
    buffer_load_dwordx4 v240, s[4:7], s41 offen  lds
    buffer_load_dwordx4 v241, s[8:11], s41 offen offset:1024  lds
    v_mfma_f32_32x32x16_bf16 v[32:47], v[64:67], v[180:183], 0
    v_mul_f32 v254, v0, v144
    v_fmac_f32 v254, v1, v145
    v_fmac_f32 v254, v2, v146
    v_fmac_f32 v254, v3, v147
    v_fmac_f32 v254, v4, v148
    v_mfma_f32_32x32x16_bf16 v[48:63], v[68:71], v[180:183], v[48:63]
    v_fmac_f32 v254, v5, v149
    v_fmac_f32 v254, v6, v150
    v_fmac_f32 v254, v7, v151
    v_fma_f32 v202, v8, -v160, v202
    v_fma_f32 v202, v9, -v161, v202
    v_mfma_f32_32x32x16_bf16 v[32:47], v[72:75], v[184:187], v[32:47]
    v_permlane32_swap_b32 v254, v200
    v_fma_f32 v202, v10, -v162, v202
    v_fma_f32 v202, v11, -v163, v202
    v_fma_f32 v202, v12, -v164, v202
    v_fma_f32 v202, v13, -v165, v202
    v_mfma_f32_32x32x16_bf16 v[48:63], v[76:79], v[184:187], v[48:63]
    v_fma_f32 v202, v14, -v166, v202
    v_fma_f32 v202, v15, -v167, v202
    v_add_f32 v200, v254, v200
    v_fmac_f32 v198, v16, v112
    v_permlane32_swap_b32 v202, v254
    v_mfma_f32_32x32x16_bf16 v[32:47], v[80:83], v[188:191], v[32:47]
    v_fmac_f32 v198, v17, v113
    v_fmac_f32 v198, v18, v114
    v_fmac_f32 v198, v19, v115
    v_fmac_f32 v198, v20, v116
    v_fmac_f32 v198, v21, v117
    v_mfma_f32_32x32x16_bf16 v[48:63], v[84:87], v[188:191], v[48:63]
    s_waitcnt vmcnt(6)
    ds_read_b64_tr_b16 v[176:177], v244 offset:0
    ds_read_b64_tr_b16 v[178:179], v244 offset:1024
    ds_read_b64_tr_b16 v[180:181], v245 offset:0
    ds_read_b64_tr_b16 v[182:183], v245 offset:1024
    v_fmac_f32 v198, v22, v118
    v_fmac_f32 v198, v23, v119
    v_add_f32 v254, v202, v254
    v_mul_f32 v196, v24, v160
    v_fmac_f32 v196, v25, v161
    v_mfma_f32_32x32x16_bf16 v[32:47], v[88:91], v[192:195], v[32:47]
    v_fmac_f32 v196, v26, v162
    v_fmac_f32 v196, v27, v163
    v_fmac_f32 v196, v28, v164
    v_fmac_f32 v196, v29, v165
    v_fmac_f32 v196, v30, v166
    v_mfma_f32_32x32x16_bf16 v[48:63], v[92:95], v[192:195], v[48:63]
    v_add_u32 v249, s48, v249
    v_add_u32 v250, s49, v250
    ds_read_b64_tr_b16 v[64:65], v249 offset:0
    ds_read_b64_tr_b16 v[68:69], v249 offset:64
    ds_read_b64_tr_b16 v[66:67], v249 offset:256
    ds_read_b64_tr_b16 v[70:71], v249 offset:320
    s_mov_b64 exec, s[54:55]
    ds_read_u16_d16_hi v242, v250 offset:0
    s_mov_b64 exec, -1
    v_fmac_f32 v196, v31, v167
    s_nop 1
    v_permlane32_swap_b32 v198, v196
    v_add_f32 v196, v198, v196
    v_mul_f32 v255, v32, v152
    v_fmac_f32 v255, v33, v153
    v_fmac_f32 v255, v34, v154
    v_fmac_f32 v255, v35, v155
    v_fmac_f32 v255, v36, v156
    v_fmac_f32 v255, v37, v157
    v_fmac_f32 v255, v38, v158
    v_fmac_f32 v255, v39, v159
    v_fma_f32 v203, v40, -v168, v203
    v_fma_f32 v203, v41, -v169, v203
    v_permlane32_swap_b32 v255, v201
    v_fma_f32 v203, v42, -v170, v203
    v_fma_f32 v203, v43, -v171, v203
    v_fma_f32 v203, v44, -v172, v203
    v_fma_f32 v203, v45, -v173, v203
    v_fma_f32 v203, v46, -v174, v203
    v_fma_f32 v203, v47, -v175, v203
    v_add_f32 v201, v255, v201
    v_fmac_f32 v199, v48, v120
    v_permlane32_swap_b32 v203, v255
    v_fmac_f32 v199, v49, v121
    v_fmac_f32 v199, v50, v122
    v_fmac_f32 v199, v51, v123
    v_fmac_f32 v199, v52, v124
    v_fmac_f32 v199, v53, v125
    v_fmac_f32 v199, v54, v126
    v_fmac_f32 v199, v55, v127
    v_add_f32 v255, v203, v255
    v_mul_f32 v197, v56, v168
    v_fmac_f32 v197, v57, v169
    v_fmac_f32 v197, v58, v170
    v_fmac_f32 v197, v59, v171
    v_fmac_f32 v197, v60, v172
    v_fmac_f32 v197, v61, v173
    v_fmac_f32 v197, v62, v174
    v_fmac_f32 v197, v63, v175
    s_nop 1
    v_permlane32_swap_b32 v199, v197
    v_add_f32 v197, v199, v197
    s_set_gpr_idx_on s51, gpr_idx(DST)
    s_nop 0
    v_cvt_pk_bf16_f32 v207, v200, v201
    v_cvt_pk_bf16_f32 v209, v254, v255
    v_cvt_pk_bf16_f32 v208, v196, v197
    s_set_gpr_idx_off
    s_add_u32 s50, s50, 1
    s_add_u32 s51, s51, 6
    s_cmp_ge_u32 s50, 4
    s_cbranch_scc1 LAST0
    s_add_u32 s53, s53, 4
    s_xor_b32 s66, s53, s20
    s_bitcmp1_b32 s66, 2
    s_setprio 1
    s_cbranch_scc1 PRIO_9
    s_setprio 0
PRIO_9:
    s_cmp_eq_u32 s52, 4
    s_cbranch_scc1 ITEM_0_4
    s_cmp_eq_u32 s52, 5
    s_cbranch_scc1 ITEM_0_5
    s_cmp_eq_u32 s52, 3
    s_cbranch_scc1 ITEM_0_3
    s_cmp_eq_u32 s52, 6
    s_cbranch_scc1 ITEM_0_6
    s_cmp_eq_u32 s52, 8
    s_cbranch_scc1 ITEM_0_8
    s_branch ITEM_0_2
.p2align 6
ITEM_0_2:
    s_mov_b32 m0, s50
    s_nop 0
    s_movrels_b32 s71, s23
    s_bfe_u32 s46, s71, 0x30012
    s_mov_b32 m0, s46
    s_and_b32 s66, s71, 0x3ffff
    s_movrels_b32 s68, s57
    s_movrels_b32 s69, s61
    s_sub_u32 s48, s66, s47
    s_mov_b32 s47, s66
    s_lshr_b32 s52, s71, 28
    s_lshl_b32 s67, s46, 9
    s_add_u32 s66, s66, s67
    s_sub_u32 s49, s66, s42
    s_mov_b32 s42, s66
    s_bfe_u32 s66, s68, 655360
    s_add_u32 s43, s42, s66
    s_bfe_u32 s39, s69, 655360
    s_bfe_u32 s66, s68, 655370
    s_add_u32 s44, s42, s66
    s_bfe_u32 s40, s69, 655370
    s_bfe_u32 s66, s68, 655380
    s_add_u32 s45, s42, s66
    s_bfe_u32 s41, s69, 655380
    s_and_b32 s66, s46, s33
    s_cselect_b32 s72, -1, 1
    s_cselect_b32 s76, s47, 163712
    s_cmp_ge_u32 s66, 2
    s_cselect_b32 s73, -1, 0
    s_add_u32 s77, s47, 1024
    s_cmp_ge_u32 s66, 4
    s_cselect_b32 s75, -1, 0
    s_cmp_ge_u32 s66, 3
    s_cselect_b32 s74, -1, 1
    s_cselect_b32 s77, s77, 163712
    v_add_u32 v252, s42, v247
    ds_read_u16 v234, v252
    ds_read_u16 v235, v252 offset:64
    v_add_u32 v252, s43, v247
    ds_read_u16 v236, v252
    ds_read_u16 v237, v252 offset:64
    v_add_u32 v252, s44, v247
    ds_read_u16 v238, v252
    ds_read_u16 v239, v252 offset:64
    v_add_u32 v252, s45, v247
    ds_read_u16 v240, v252
    ds_read_u16 v241, v252 offset:64
    s_waitcnt lgkmcnt(8)
    v_mul_f32_dpp v196, v242, v64 row_newbcast:0 row_mask:0xf bank_mask:0xf
    v_mul_f32_dpp v197, v242, v65 row_newbcast:1 row_mask:0xf bank_mask:0xf
    v_mul_f32_dpp v198, v242, v64 row_newbcast:8 row_mask:0xf bank_mask:0xf
    v_mul_f32_dpp v199, v242, v65 row_newbcast:9 row_mask:0xf bank_mask:0xf
    v_mul_f32_dpp v200, v242, v68 row_newbcast:2 row_mask:0xf bank_mask:0xf
    v_mul_f32_dpp v201, v242, v69 row_newbcast:3 row_mask:0xf bank_mask:0xf
    v_mul_f32_dpp v202, v242, v68 row_newbcast:10 row_mask:0xf bank_mask:0xf
    v_mul_f32_dpp v203, v242, v69 row_newbcast:11 row_mask:0xf bank_mask:0xf
    v_cvt_pk_bf16_f32 v64, v196, v197
    v_cvt_pk_bf16_f32 v68, v198, v199
    v_cvt_pk_bf16_f32 v65, v200, v201
    v_cvt_pk_bf16_f32 v69, v202, v203
    v_mul_f32_dpp v196, v242, v66 row_newbcast:4 row_mask:0xf bank_mask:0xf
    v_mul_f32_dpp v197, v242, v67 row_newbcast:5 row_mask:0xf bank_mask:0xf
    v_mul_f32_dpp v198, v242, v66 row_newbcast:12 row_mask:0xf bank_mask:0xf
    v_mul_f32_dpp v199, v242, v67 row_newbcast:13 row_mask:0xf bank_mask:0xf
    v_mul_f32_dpp v200, v242, v70 row_newbcast:6 row_mask:0xf bank_mask:0xf
    v_mul_f32_dpp v201, v242, v71 row_newbcast:7 row_mask:0xf bank_mask:0xf
    v_mul_f32_dpp v202, v242, v70 row_newbcast:14 row_mask:0xf bank_mask:0xf
    v_mul_f32_dpp v203, v242, v71 row_newbcast:15 row_mask:0xf bank_mask:0xf
    v_cvt_pk_bf16_f32 v66, v196, v197
    v_cvt_pk_bf16_f32 v70, v198, v199
    v_cvt_pk_bf16_f32 v67, v200, v201
    v_cvt_pk_bf16_f32 v71, v202, v203
    s_nop 0
    s_waitcnt lgkmcnt(6)
    v_mfma_f32_32x32x16_bf16 v[0:15], v[64:67], v[176:179], 0
    s_add_u32 m0, s21, 0
    v_mfma_f32_32x32x16_bf16 v[16:31], v[68:71], v[176:179], 0
    v_lshl_add_u32 v234, v234, 10, v246
    v_lshl_add_u32 v235, v235, 10, v246
    buffer_load_dwordx4 v234, s[4:7], s38 offen  lds
    buffer_load_dwordx4 v235, s[8:11], s38 offen offset:1024  lds
    v_mfma_f32_32x32x16_bf16 v[32:47], v[64:67], v[180:183], 0
    s_nop 4
    v_mul_f32 v196, v0, v96
    v_fmac_f32 v196, v1, v97
    v_fmac_f32 v196, v2, v98
    v_fmac_f32 v196, v3, v99
    v_fmac_f32 v196, v4, v100
    v_fmac_f32 v196, v5, v101
    v_fmac_f32 v196, v6, v102
    v_fmac_f32 v196, v7, v103
    v_mul_f32 v198, v8, v128
    v_fmac_f32 v198, v9, v129
    v_fmac_f32 v198, v10, v130
    v_fmac_f32 v198, v11, v131
    v_fmac_f32 v198, v12, v132
    v_fmac_f32 v198, v13, v133
    v_fmac_f32 v198, v14, v134
    v_fmac_f32 v198, v15, v135
    v_mul_f32 v200, v16, v128
    v_fmac_f32 v200, v17, v129
    v_permlane32_swap_b32 v196, v198
    v_mfma_f32_32x32x16_bf16 v[48:63], v[68:71], v[180:183], 0
    s_waitcnt vmcnt(6)
    ds_read_b64_tr_b16 v[176:177], v244 offset:2048
    ds_read_b64_tr_b16 v[178:179], v244 offset:3072
    ds_read_b64_tr_b16 v[180:181], v245 offset:2048
    ds_read_b64_tr_b16 v[182:183], v245 offset:3072
    v_fmac_f32 v200, v18, v130
    v_fmac_f32 v200, v19, v131
    v_fmac_f32 v200, v20, v132
    v_fmac_f32 v200, v21, v133
    v_fmac_f32 v200, v22, v134
    v_fmac_f32 v200, v23, v135
    v_add_f32 v198, v196, v198
    v_mul_f32_e64 v202, v24, -v128
    v_fma_f32 v202, v25, -v129, v202
    v_fma_f32 v202, v26, -v130, v202
    v_fma_f32 v202, v27, -v131, v202
    v_fma_f32 v202, v28, -v132, v202
    v_fma_f32 v202, v29, -v133, v202
    v_fma_f32 v202, v30, -v134, v202
    v_fma_f32 v202, v31, -v135, v202
    s_nop 1
    v_permlane32_swap_b32 v200, v202
    v_add_f32 v202, v200, v202
    s_waitcnt lgkmcnt(0)
    v_mfma_f32_32x32x16_bf16 v[0:15], v[64:67], v[176:179], 0
    v_mul_f32 v197, v32, v104
    v_fmac_f32 v197, v33, v105
    v_fmac_f32 v197, v34, v106
    v_fmac_f32 v197, v35, v107
    v_fmac_f32 v197, v36, v108
    v_fmac_f32 v197, v37, v109
    v_fmac_f32 v197, v38, v110
    v_fmac_f32 v197, v39, v111
    v_mul_f32 v199, v40, v136
    v_fmac_f32 v199, v41, v137
    v_fmac_f32 v199, v42, v138
    v_fmac_f32 v199, v43, v139
    v_fmac_f32 v199, v44, v140
    v_fmac_f32 v199, v45, v141
    v_fmac_f32 v199, v46, v142
    v_fmac_f32 v199, v47, v143
    v_mul_f32 v201, v48, v136
    v_fmac_f32 v201, v49, v137
    v_permlane32_swap_b32 v197, v199
    v_fmac_f32 v201, v50, v138
    v_fmac_f32 v201, v51, v139
    s_add_u32 m0, s21, 2048
    v_mfma_f32_32x32x16_bf16 v[16:31], v[68:71], v[176:179], 0
    v_lshl_add_u32 v236, v236, 10, v246
    v_lshl_add_u32 v237, v237, 10, v246
    buffer_load_dwordx4 v236, s[4:7], s39 offen  lds
    buffer_load_dwordx4 v237, s[8:11], s39 offen offset:1024  lds
    v_fmac_f32 v201, v52, v140
    v_fmac_f32 v201, v53, v141
    v_fmac_f32 v201, v54, v142
    v_fmac_f32 v201, v55, v143
    v_add_f32 v199, v197, v199
    v_mul_f32_e64 v203, v56, -v136
    v_fma_f32 v203, v57, -v137, v203
    v_fma_f32 v203, v58, -v138, v203
    v_fma_f32 v203, v59, -v139, v203
    v_fma_f32 v203, v60, -v140, v203
    v_fma_f32 v203, v61, -v141, v203
    v_fma_f32 v203, v62, -v142, v203
    v_fma_f32 v203, v63, -v143, v203
    s_nop 1
    v_permlane32_swap_b32 v201, v203
    v_add_f32 v203, v201, v203
    s_set_gpr_idx_on s51, gpr_idx(DST)
    s_nop 0
    v_cvt_pk_bf16_f32 v204, v198, v199
    v_cvt_pk_bf16_f32 v205, v202, v203
    s_set_gpr_idx_off
    v_mfma_f32_32x32x16_bf16 v[32:47], v[64:67], v[180:183], 0
    v_mul_f32 v196, v0, v144
    v_fmac_f32 v196, v1, v145
    v_fmac_f32 v196, v2, v146
    v_fmac_f32 v196, v3, v147
    v_fmac_f32 v196, v4, v148
    v_fmac_f32 v196, v5, v149
    v_fmac_f32 v196, v6, v150
    v_fmac_f32 v196, v7, v151
    v_mul_f32 v198, v8, v112
    v_fmac_f32 v198, v9, v113
    v_fmac_f32 v198, v10, v114
    v_fmac_f32 v198, v11, v115
    v_fmac_f32 v198, v12, v116
    v_fmac_f32 v198, v13, v117
    v_fmac_f32 v198, v14, v118
    v_fmac_f32 v198, v15, v119
    v_mfma_f32_32x32x16_bf16 v[48:63], v[68:71], v[180:183], 0
    v_add_u32 v253, s47, v248
    ds_read_b32 v254, v253
    ds_read_b32 v255, v253 offset:256
    s_waitcnt vmcnt(6)
    ds_read_b64_tr_b16 v[176:177], v244 offset:4096
    ds_read_b64_tr_b16 v[178:179], v244 offset:5120
    ds_read_b64_tr_b16 v[180:181], v245 offset:4096
    ds_read_b64_tr_b16 v[182:183], v245 offset:5120
    v_mul_f32_e64 v200, v16, -v160
    v_fma_f32 v200, v17, -v161, v200
    v_fma_f32 v200, v18, -v162, v200
    v_fma_f32 v200, v19, -v163, v200
    v_fma_f32 v200, v20, -v164, v200
    v_fma_f32 v200, v21, -v165, v200
    v_fma_f32 v200, v22, -v166, v200
    v_fma_f32 v200, v23, -v167, v200
    v_mul_f32_e64 v202, v24, -v160
    v_fma_f32 v202, v25, -v161, v202
    v_fma_f32 v202, v26, -v162, v202
    v_fma_f32 v202, v27, -v163, v202
    v_fma_f32 v202, v28, -v164, v202
    v_fma_f32 v202, v29, -v165, v202
    v_fma_f32 v202, v30, -v166, v202
    v_fma_f32 v202, v31, -v167, v202
    s_waitcnt lgkmcnt(0)
    v_mfma_f32_32x32x16_bf16 v[0:15], v[64:67], v[176:179], 0
    v_mul_f32 v197, v32, v152
    v_fmac_f32 v197, v33, v153
    v_fmac_f32 v197, v34, v154
    v_fmac_f32 v197, v35, v155
    v_fmac_f32 v197, v36, v156
    v_fmac_f32 v197, v37, v157
    v_fmac_f32 v197, v38, v158
    v_fmac_f32 v197, v39, v159
    v_mul_f32 v199, v40, v120
    v_fmac_f32 v199, v41, v121
    v_fmac_f32 v199, v42, v122
    v_fmac_f32 v199, v43, v123
    v_fmac_f32 v199, v44, v124
    v_fmac_f32 v199, v45, v125
    v_fmac_f32 v199, v46, v126
    v_fmac_f32 v199, v47, v127
    s_add_u32 m0, s21, 4096
    v_mfma_f32_32x32x16_bf16 v[16:31], v[68:71], v[176:179], 0
    v_lshl_add_u32 v238, v238, 10, v246
    v_lshl_add_u32 v239, v239, 10, v246
    buffer_load_dwordx4 v238, s[4:7], s40 offen  lds
    buffer_load_dwordx4 v239, s[8:11], s40 offen offset:1024  lds
    s_mov_b32 m0, s76
    s_mov_b64 exec, s[72:73]
    buffer_load_dwordx4 v254, s[12:15], 0 offen  lds
    s_mov_b32 m0, s77
    s_mov_b64 exec, s[74:75]
    buffer_load_dwordx4 v255, s[12:15], 0 offen  lds
    s_mov_b64 exec, -1
    v_mul_f32_e64 v201, v48, -v168
    v_fma_f32 v201, v49, -v169, v201
    v_fma_f32 v201, v50, -v170, v201
    v_fma_f32 v201, v51, -v171, v201
    v_fma_f32 v201, v52, -v172, v201
    v_fma_f32 v201, v53, -v173, v201
    v_fma_f32 v201, v54, -v174, v201
    v_fma_f32 v201, v55, -v175, v201
    v_mul_f32_e64 v203, v56, -v168
    v_fma_f32 v203, v57, -v169, v203
    v_fma_f32 v203, v58, -v170, v203
    v_fma_f32 v203, v59, -v171, v203
    v_fma_f32 v203, v60, -v172, v203
    v_fma_f32 v203, v61, -v173, v203
    v_fma_f32 v203, v62, -v174, v203
    v_fma_f32 v203, v63, -v175, v203
    v_mfma_f32_32x32x16_bf16 v[32:47], v[64:67], v[180:183], 0
    v_mul_f32 v254, v0, v144
    v_fmac_f32 v254, v1, v145
    v_fmac_f32 v254, v2, v146
    v_fmac_f32 v254, v3, v147
    v_fmac_f32 v254, v4, v148
    v_fmac_f32 v254, v5, v149
    v_fmac_f32 v254, v6, v150
    v_fmac_f32 v254, v7, v151
    v_fmac_f32 v200, v8, v160
    v_mfma_f32_32x32x16_bf16 v[48:63], v[68:71], v[180:183], 0
    ds_swizzle_b32 v68, v68 offset:0x401F
    ds_swizzle_b32 v69, v69 offset:0x401F
    ds_swizzle_b32 v70, v70 offset:0x401F
    ds_swizzle_b32 v71, v71 offset:0x401F
    s_waitcnt vmcnt(8)
    ds_read_b64_tr_b16 v[176:177], v244 offset:6144
    ds_read_b64_tr_b16 v[178:179], v244 offset:7168
    ds_read_b64_tr_b16 v[180:181], v245 offset:6144
    ds_read_b64_tr_b16 v[182:183], v245 offset:7168
    v_fmac_f32 v200, v9, v161
    v_permlane32_swap_b32 v196, v254
    v_fmac_f32 v200, v10, v162
    v_fmac_f32 v200, v11, v163
    v_fmac_f32 v200, v12, v164
    v_fmac_f32 v200, v13, v165
    v_fmac_f32 v200, v14, v166
    v_fmac_f32 v200, v15, v167
    v_add_f32 v254, v196, v254
    s_waitcnt lgkmcnt(0)
    s_mov_b64 exec, s[56:57]
    v_xor_b32 v68, 0x80008000, v68
    v_xor_b32 v69, 0x80008000, v69
    v_xor_b32 v70, 0x80008000, v70
    v_xor_b32 v71, 0x80008000, v71
    s_mov_b64 exec, -1
    s_nop 0
    v_mfma_f32_32x32x16_bf16 v[0:15], v[64:67], v[176:179], 0
    v_mul_f32 v255, v32, v152
    v_fmac_f32 v255, v33, v153
    v_fmac_f32 v255, v34, v154
    v_fmac_f32 v255, v35, v155
    v_fmac_f32 v255, v36, v156
    v_fmac_f32 v255, v37, v157
    v_fmac_f32 v255, v38, v158
    v_fmac_f32 v255, v39, v159
    v_fmac_f32 v201, v40, v168
    v_fmac_f32 v201, v41, v169
    v_permlane32_swap_b32 v197, v255
    s_add_u32 m0, s21, 6144
    v_mfma_f32_32x32x16_bf16 v[16:31], v[68:71], v[176:179], v[16:31]
    v_lshl_add_u32 v240, v240, 10, v246
    v_lshl_add_u32 v241, v241, 10, v246
    buffer_load_dwordx4 v240, s[4:7], s41 offen  lds
    buffer_load_dwordx4 v241, s[8:11], s41 offen offset:1024  lds
    v_fmac_f32 v201, v42, v170
    v_fmac_f32 v201, v43, v171
    v_fmac_f32 v201, v44, v172
    v_fmac_f32 v201, v45, v173
    v_fmac_f32 v201, v46, v174
    v_fmac_f32 v201, v47, v175
    v_add_f32 v255, v197, v255
    s_set_gpr_idx_on s51, gpr_idx(DST)
    s_nop 0
    v_cvt_pk_bf16_f32 v206, v254, v255
    s_set_gpr_idx_off
    v_mfma_f32_32x32x16_bf16 v[32:47], v[64:67], v[180:183], 0
    v_mul_f32 v254, v0, v144
    v_fmac_f32 v254, v1, v145
    v_fmac_f32 v254, v2, v146
    v_fmac_f32 v254, v3, v147
    v_fmac_f32 v254, v4, v148
    v_fmac_f32 v254, v5, v149
    v_fmac_f32 v254, v6, v150
    v_fmac_f32 v254, v7, v151
    v_fma_f32 v202, v8, -v160, v202
    v_fma_f32 v202, v9, -v161, v202
    v_permlane32_swap_b32 v254, v200
    v_fma_f32 v202, v10, -v162, v202
    v_fma_f32 v202, v11, -v163, v202
    v_fma_f32 v202, v12, -v164, v202
    v_fma_f32 v202, v13, -v165, v202
    v_fma_f32 v202, v14, -v166, v202
    v_fma_f32 v202, v15, -v167, v202
    v_add_f32 v200, v254, v200
    v_fmac_f32 v198, v16, v112
    v_permlane32_swap_b32 v202, v254
    v_mfma_f32_32x32x16_bf16 v[48:63], v[68:71], v[180:183], v[48:63]
    s_waitcnt vmcnt(8)
    ds_read_b64_tr_b16 v[176:177], v244 offset:0
    ds_read_b64_tr_b16 v[178:179], v244 offset:1024
    ds_read_b64_tr_b16 v[180:181], v245 offset:0
    ds_read_b64_tr_b16 v[182:183], v245 offset:1024
    v_add_u32 v249, s48, v249
    v_add_u32 v250, s49, v250
    s_waitcnt vmcnt(2)
    ds_read_b64_tr_b16 v[64:65], v249 offset:0
    ds_read_b64_tr_b16 v[68:69], v249 offset:64
    ds_read_b64_tr_b16 v[66:67], v249 offset:256
    ds_read_b64_tr_b16 v[70:71], v249 offset:320
    s_mov_b64 exec, s[54:55]
    ds_read_u16_d16_hi v242, v250 offset:0
    s_mov_b64 exec, -1
    v_fmac_f32 v198, v17, v113
    v_fmac_f32 v198, v18, v114
    v_fmac_f32 v198, v19, v115
    v_fmac_f32 v198, v20, v116
    v_fmac_f32 v198, v21, v117
    v_fmac_f32 v198, v22, v118
    v_fmac_f32 v198, v23, v119
    v_add_f32 v254, v202, v254
    v_mul_f32 v196, v24, v160
    v_fmac_f32 v196, v25, v161
    v_fmac_f32 v196, v26, v162
    v_fmac_f32 v196, v27, v163
    v_fmac_f32 v196, v28, v164
    v_fmac_f32 v196, v29, v165
    v_fmac_f32 v196, v30, v166
    v_fmac_f32 v196, v31, v167
    s_nop 1
    v_permlane32_swap_b32 v198, v196
    v_add_f32 v196, v198, v196
    v_mul_f32 v255, v32, v152
    v_fmac_f32 v255, v33, v153
    v_fmac_f32 v255, v34, v154
    v_fmac_f32 v255, v35, v155
    v_fmac_f32 v255, v36, v156
    v_fmac_f32 v255, v37, v157
    v_fmac_f32 v255, v38, v158
    v_fmac_f32 v255, v39, v159
    v_fma_f32 v203, v40, -v168, v203
    v_fma_f32 v203, v41, -v169, v203
    v_permlane32_swap_b32 v255, v201
    v_fma_f32 v203, v42, -v170, v203
    v_fma_f32 v203, v43, -v171, v203
    v_fma_f32 v203, v44, -v172, v203
    v_fma_f32 v203, v45, -v173, v203
    v_fma_f32 v203, v46, -v174, v203
    v_fma_f32 v203, v47, -v175, v203
    v_add_f32 v201, v255, v201
    v_fmac_f32 v199, v48, v120
    v_permlane32_swap_b32 v203, v255
    v_fmac_f32 v199, v49, v121
    v_fmac_f32 v199, v50, v122
    v_fmac_f32 v199, v51, v123
    v_fmac_f32 v199, v52, v124
    v_fmac_f32 v199, v53, v125
    v_fmac_f32 v199, v54, v126
    v_fmac_f32 v199, v55, v127
    v_add_f32 v255, v203, v255
    v_mul_f32 v197, v56, v168
    v_fmac_f32 v197, v57, v169
    v_fmac_f32 v197, v58, v170
    v_fmac_f32 v197, v59, v171
    v_fmac_f32 v197, v60, v172
    v_fmac_f32 v197, v61, v173
    v_fmac_f32 v197, v62, v174
    v_fmac_f32 v197, v63, v175
    s_nop 1
    v_permlane32_swap_b32 v199, v197
    v_add_f32 v197, v199, v197
    s_set_gpr_idx_on s51, gpr_idx(DST)
    s_nop 0
    v_cvt_pk_bf16_f32 v207, v200, v201
    v_cvt_pk_bf16_f32 v209, v254, v255
    v_cvt_pk_bf16_f32 v208, v196, v197
    s_set_gpr_idx_off
    s_add_u32 s50, s50, 1
    s_add_u32 s51, s51, 6
    s_cmp_ge_u32 s50, 4
    s_cbranch_scc1 LAST0
    s_add_u32 s53, s53, 4
    s_xor_b32 s66, s53, s20
    s_bitcmp1_b32 s66, 2
    s_setprio 1
    s_cbranch_scc1 PRIO_10
    s_setprio 0
PRIO_10:
    s_cmp_eq_u32 s52, 4
    s_cbranch_scc1 ITEM_0_4
    s_cmp_eq_u32 s52, 5
    s_cbranch_scc1 ITEM_0_5
    s_cmp_eq_u32 s52, 3
    s_cbranch_scc1 ITEM_0_3
    s_cmp_eq_u32 s52, 6
    s_cbranch_scc1 ITEM_0_6
    s_cmp_eq_u32 s52, 8
    s_cbranch_scc1 ITEM_0_8
    s_branch ITEM_0_2
.p2align 6
ITEM_1_4:
    s_mov_b64 exec, s[54:55]
    ds_read_u16_d16_hi v243, v250 offset:128
    s_mov_b64 exec, -1
    ds_read_b64_tr_b16 v[72:73], v249 offset:512
    ds_read_b64_tr_b16 v[76:77], v249 offset:576
    ds_read_b64_tr_b16 v[74:75], v249 offset:768
    ds_read_b64_tr_b16 v[78:79], v249 offset:832
    s_waitcnt lgkmcnt(5)
    v_mul_f32_dpp v196, v242, v64 row_newbcast:0 row_mask:0xf bank_mask:0xf
    v_mul_f32_dpp v197, v242, v65 row_newbcast:1 row_mask:0xf bank_mask:0xf
    v_mul_f32_dpp v198, v242, v64 row_newbcast:8 row_mask:0xf bank_mask:0xf
    v_mul_f32_dpp v199, v242, v65 row_newbcast:9 row_mask:0xf bank_mask:0xf
    v_mul_f32_dpp v200, v242, v68 row_newbcast:2 row_mask:0xf bank_mask:0xf
    v_mul_f32_dpp v201, v242, v69 row_newbcast:3 row_mask:0xf bank_mask:0xf
    v_mul_f32_dpp v202, v242, v68 row_newbcast:10 row_mask:0xf bank_mask:0xf
    v_mul_f32_dpp v203, v242, v69 row_newbcast:11 row_mask:0xf bank_mask:0xf
    v_cvt_pk_bf16_f32 v64, v196, v197
    v_cvt_pk_bf16_f32 v68, v198, v199
    v_cvt_pk_bf16_f32 v65, v200, v201
    v_cvt_pk_bf16_f32 v69, v202, v203
    v_mul_f32_dpp v196, v242, v66 row_newbcast:4 row_mask:0xf bank_mask:0xf
    v_mul_f32_dpp v197, v242, v67 row_newbcast:5 row_mask:0xf bank_mask:0xf
    v_mul_f32_dpp v198, v242, v66 row_newbcast:12 row_mask:0xf bank_mask:0xf
    v_mul_f32_dpp v199, v242, v67 row_newbcast:13 row_mask:0xf bank_mask:0xf
    v_mul_f32_dpp v200, v242, v70 row_newbcast:6 row_mask:0xf bank_mask:0xf
    v_mul_f32_dpp v201, v242, v71 row_newbcast:7 row_mask:0xf bank_mask:0xf
    v_mul_f32_dpp v202, v242, v70 row_newbcast:14 row_mask:0xf bank_mask:0xf
    v_mul_f32_dpp v203, v242, v71 row_newbcast:15 row_mask:0xf bank_mask:0xf
    v_cvt_pk_bf16_f32 v66, v196, v197
    v_cvt_pk_bf16_f32 v70, v198, v199
    v_cvt_pk_bf16_f32 v67, v200, v201
    v_cvt_pk_bf16_f32 v71, v202, v203
    s_nop 0
    s_waitcnt vmcnt(4) lgkmcnt(0)
    v_mfma_f32_32x32x16_bf16 v[0:15], v[64:67], v[176:179], 0
    v_mul_f32_dpp v196, v243, v72 row_newbcast:0 row_mask:0xf bank_mask:0xf
    v_mul_f32_dpp v197, v243, v73 row_newbcast:1 row_mask:0xf bank_mask:0xf
    v_mul_f32_dpp v198, v243, v72 row_newbcast:8 row_mask:0xf bank_mask:0xf
    v_mul_f32_dpp v199, v243, v73 row_newbcast:9 row_mask:0xf bank_mask:0xf
    v_mul_f32_dpp v200, v243, v76 row_newbcast:2 row_mask:0xf bank_mask:0xf
    v_mul_f32_dpp v201, v243, v77 row_newbcast:3 row_mask:0xf bank_mask:0xf
    v_mul_f32_dpp v202, v243, v76 row_newbcast:10 row_mask:0xf bank_mask:0xf
    v_mul_f32_dpp v203, v243, v77 row_newbcast:11 row_mask:0xf bank_mask:0xf
    v_cvt_pk_bf16_f32 v72, v196, v197
    v_cvt_pk_bf16_f32 v76, v198, v199
    v_cvt_pk_bf16_f32 v73, v200, v201
    v_cvt_pk_bf16_f32 v77, v202, v203
    s_add_u32 m0, s21, 0
    v_mfma_f32_32x32x16_bf16 v[16:31], v[68:71], v[176:179], 0
    buffer_load_dwordx4 v234, s[4:7], s36 offen  lds
    buffer_load_dwordx4 v235, s[8:11], s36 offen offset:1024  lds
    ds_read_b64_tr_b16 v[176:177], v244 offset:2048
    ds_read_b64_tr_b16 v[178:179], v244 offset:3072
    ds_read_b64_tr_b16 v[184:185], v245 offset:2048
    ds_read_b64_tr_b16 v[186:187], v245 offset:3072
    v_mul_f32_dpp v196, v243, v74 row_newbcast:4 row_mask:0xf bank_mask:0xf
    v_mul_f32_dpp v197, v243, v75 row_newbcast:5 row_mask:0xf bank_mask:0xf
    v_mul_f32_dpp v198, v243, v74 row_newbcast:12 row_mask:0xf bank_mask:0xf
    v_mul_f32_dpp v199, v243, v75 row_newbcast:13 row_mask:0xf bank_mask:0xf
    v_mul_f32_dpp v200, v243, v78 row_newbcast:6 row_mask:0xf bank_mask:0xf
    v_mul_f32_dpp v201, v243, v79 row_newbcast:7 row_mask:0xf bank_mask:0xf
    v_mul_f32_dpp v202, v243, v78 row_newbcast:14 row_mask:0xf bank_mask:0xf
    v_mul_f32_dpp v203, v243, v79 row_newbcast:15 row_mask:0xf bank_mask:0xf
    v_cvt_pk_bf16_f32 v74, v196, v197
    v_cvt_pk_bf16_f32 v78, v198, v199
    v_cvt_pk_bf16_f32 v75, v200, v201
    v_cvt_pk_bf16_f32 v79, v202, v203
    s_nop 0
    s_waitcnt lgkmcnt(0)
    v_mfma_f32_32x32x16_bf16 v[0:15], v[72:75], v[176:179], v[0:15]
    s_add_u32 m0, s21, 2048
    v_mfma_f32_32x32x16_bf16 v[16:31], v[76:79], v[176:179], v[16:31]
    buffer_load_dwordx4 v236, s[4:7], s36 offen  lds
    buffer_load_dwordx4 v237, s[8:11], s36 offen offset:1024  lds
    s_mov_b32 m0, s50
    s_nop 0
    s_movrels_b32 s71, s23
    s_movrels_b32 s33, s28
    v_add_u32 v253, s33, v248
    s_bfe_u32 s46, s71, 0x30012
    s_mov_b32 m0, s46
    s_and_b32 s66, s71, 0x3ffff
    s_movrels_b32 s68, s57
    s_movrels_b32 s69, s61
    s_sub_u32 s48, s66, s47
    s_mov_b32 s47, s66
    s_lshr_b32 s52, s71, 28
    s_lshl_b32 s67, s46, 9
    s_add_u32 s66, s66, s67
    s_sub_u32 s49, s66, s42
    s_mov_b32 s42, s66
    s_bfe_u32 s66, s68, 655360
    s_add_u32 s43, s42, s66
    s_bfe_u32 s39, s69, 655360
    s_bfe_u32 s66, s68, 655370
    s_add_u32 s44, s42, s66
    s_bfe_u32 s40, s69, 655370
    s_bfe_u32 s66, s68, 655380
    s_add_u32 s45, s42, s66
    s_bfe_u32 s41, s69, 655380
    v_add_u32 v252, s44, v247
    ds_read_u16 v238, v252
    ds_read_u16 v239, v252 offset:64
    v_add_u32 v252, s45, v247
    ds_read_u16 v240, v252
    ds_read_u16 v241, v252 offset:64
    v_mfma_f32_32x32x16_bf16 v[32:47], v[64:67], v[180:183], 0
    v_mul_f32 v196, v0, v96
    v_fmac_f32 v196, v1, v97
    v_fmac_f32 v196, v2, v98
    v_fmac_f32 v196, v3, v99
    v_fmac_f32 v196, v4, v100
    v_fmac_f32 v196, v5, v101
    v_fmac_f32 v196, v6, v102
    v_fmac_f32 v196, v7, v103
    v_mul_f32 v198, v8, v128
    v_fmac_f32 v198, v9, v129
    v_mfma_f32_32x32x16_bf16 v[48:63], v[68:71], v[180:183], 0
    s_waitcnt vmcnt(6)
    ds_read_b64_tr_b16 v[176:177], v244 offset:4096
    ds_read_b64_tr_b16 v[178:179], v244 offset:5120
    ds_read_b64_tr_b16 v[180:181], v245 offset:4096
    ds_read_b64_tr_b16 v[182:183], v245 offset:5120
    v_fmac_f32 v198, v10, v130
    v_fmac_f32 v198, v11, v131
    v_fmac_f32 v198, v12, v132
    v_fmac_f32 v198, v13, v133
    v_fmac_f32 v198, v14, v134
    v_fmac_f32 v198, v15, v135
    v_mul_f32 v200, v16, v128
    v_fmac_f32 v200, v17, v129
    v_permlane32_swap_b32 v196, v198
    v_mfma_f32_32x32x16_bf16 v[32:47], v[72:75], v[184:187], v[32:47]
    v_fmac_f32 v200, v18, v130
    v_fmac_f32 v200, v19, v131
    v_fmac_f32 v200, v20, v132
    v_fmac_f32 v200, v21, v133
    v_fmac_f32 v200, v22, v134
    v_fmac_f32 v200, v23, v135
    v_add_f32 v198, v196, v198
    v_mul_f32_e64 v202, v24, -v128
    v_fma_f32 v202, v25, -v129, v202
    v_mfma_f32_32x32x16_bf16 v[48:63], v[76:79], v[184:187], v[48:63]
    v_fma_f32 v202, v26, -v130, v202
    v_fma_f32 v202, v27, -v131, v202
    v_fma_f32 v202, v28, -v132, v202
    v_fma_f32 v202, v29, -v133, v202
    v_fma_f32 v202, v30, -v134, v202
    v_fma_f32 v202, v31, -v135, v202
    s_nop 1
    v_permlane32_swap_b32 v200, v202
    v_add_f32 v202, v200, v202
    s_waitcnt vmcnt(4) lgkmcnt(0)
    v_mfma_f32_32x32x16_bf16 v[0:15], v[64:67], v[176:179], 0
    v_mul_f32 v197, v32, v104
    v_fmac_f32 v197, v33, v105
    v_fmac_f32 v197, v34, v106
    v_fmac_f32 v197, v35, v107
    v_fmac_f32 v197, v36, v108
    v_fmac_f32 v197, v37, v109
    v_fmac_f32 v197, v38, v110
    v_fmac_f32 v197, v39, v111
    v_mul_f32 v199, v40, v136
    v_fmac_f32 v199, v41, v137
    s_add_u32 m0, s21, 4096
    v_mfma_f32_32x32x16_bf16 v[16:31], v[68:71], v[176:179], 0
    buffer_load_dwordx4 v234, s[4:7], s37 offen  lds
    buffer_load_dwordx4 v235, s[8:11], s37 offen offset:1024  lds
    ds_read_b64_tr_b16 v[176:177], v244 offset:6144
    ds_read_b64_tr_b16 v[178:179], v244 offset:7168
    ds_read_b64_tr_b16 v[184:185], v245 offset:6144
    ds_read_b64_tr_b16 v[186:187], v245 offset:7168
    v_add_u32 v252, s42, v247
    ds_read_u16 v234, v252
    ds_read_u16 v235, v252 offset:64
    v_fmac_f32 v199, v42, v138
    v_fmac_f32 v199, v43, v139
    v_fmac_f32 v199, v44, v140
    v_fmac_f32 v199, v45, v141
    v_fmac_f32 v199, v46, v142
    v_fmac_f32 v199, v47, v143
    v_mul_f32 v201, v48, v136
    v_fmac_f32 v201, v49, v137
    v_permlane32_swap_b32 v197, v199
    v_fmac_f32 v201, v50, v138
    s_waitcnt lgkmcnt(2)
    v_mfma_f32_32x32x16_bf16 v[0:15], v[72:75], v[176:179], v[0:15]
    v_fmac_f32 v201, v51, v139
    v_fmac_f32 v201, v52, v140
    v_fmac_f32 v201, v53, v141
    v_fmac_f32 v201, v54, v142
    v_fmac_f32 v201, v55, v143
    v_add_f32 v199, v197, v199
    v_mul_f32_e64 v203, v56, -v136
    v_fma_f32 v203, v57, -v137, v203
    v_fma_f32 v203, v58, -v138, v203
    v_fma_f32 v203, v59, -v139, v203
    s_add_u32 m0, s21, 6144
    v_mfma_f32_32x32x16_bf16 v[16:31], v[76:79], v[176:179], v[16:31]
    buffer_load_dwordx4 v236, s[4:7], s37 offen  lds
    buffer_load_dwordx4 v237, s[8:11], s37 offen offset:1024  lds
    v_add_u32 v252, s43, v247
    ds_read_u16 v236, v252
    ds_read_u16 v237, v252 offset:64
    v_fma_f32 v203, v60, -v140, v203
    v_fma_f32 v203, v61, -v141, v203
    v_fma_f32 v203, v62, -v142, v203
    v_fma_f32 v203, v63, -v143, v203
    s_nop 1
    v_permlane32_swap_b32 v201, v203
    v_add_f32 v203, v201, v203
    v_cvt_pk_bf16_f32 v192, v198, v199
    v_cvt_pk_bf16_f32 v193, v202, v203
    v_mfma_f32_32x32x16_bf16 v[32:47], v[64:67], v[180:183], 0
    v_mul_f32 v196, v0, v144
    v_fmac_f32 v196, v1, v145
    v_fmac_f32 v196, v2, v146
    v_fmac_f32 v196, v3, v147
    v_fmac_f32 v196, v4, v148
    v_fmac_f32 v196, v5, v149
    v_fmac_f32 v196, v6, v150
    v_fmac_f32 v196, v7, v151
    v_mfma_f32_32x32x16_bf16 v[48:63], v[68:71], v[180:183], 0
    s_waitcnt vmcnt(6)
    ds_read_b64_tr_b16 v[176:177], v244 offset:0
    ds_read_b64_tr_b16 v[178:179], v244 offset:1024
    ds_read_b64_tr_b16 v[180:181], v245 offset:0
    ds_read_b64_tr_b16 v[182:183], v245 offset:1024
    v_mul_f32 v198, v8, v112
    v_fmac_f32 v198, v9, v113
    v_fmac_f32 v198, v10, v114
    v_fmac_f32 v198, v11, v115
    v_fmac_f32 v198, v12, v116
    v_fmac_f32 v198, v13, v117
    v_fmac_f32 v198, v14, v118
    v_fmac_f32 v198, v15, v119
    v_mfma_f32_32x32x16_bf16 v[32:47], v[72:75], v[184:187], v[32:47]
    v_mul_f32_e64 v200, v16, -v160
    v_fma_f32 v200, v17, -v161, v200
    v_fma_f32 v200, v18, -v162, v200
    v_fma_f32 v200, v19, -v163, v200
    v_fma_f32 v200, v20, -v164, v200
    v_fma_f32 v200, v21, -v165, v200
    v_fma_f32 v200, v22, -v166, v200
    v_fma_f32 v200, v23, -v167, v200
    v_mfma_f32_32x32x16_bf16 v[48:63], v[76:79], v[184:187], v[48:63]
    v_mul_f32_e64 v202, v24, -v160
    v_fma_f32 v202, v25, -v161, v202
    v_fma_f32 v202, v26, -v162, v202
    v_fma_f32 v202, v27, -v163, v202
    v_fma_f32 v202, v28, -v164, v202
    v_fma_f32 v202, v29, -v165, v202
    v_fma_f32 v202, v30, -v166, v202
    v_fma_f32 v202, v31, -v167, v202
    s_waitcnt vmcnt(4) lgkmcnt(0)
    v_mfma_f32_32x32x16_bf16 v[0:15], v[64:67], v[176:179], 0
    v_mul_f32 v197, v32, v152
    v_fmac_f32 v197, v33, v153
    v_fmac_f32 v197, v34, v154
    v_fmac_f32 v197, v35, v155
    v_fmac_f32 v197, v36, v156
    v_fmac_f32 v197, v37, v157
    v_fmac_f32 v197, v38, v158
    v_fmac_f32 v197, v39, v159
    s_add_u32 m0, s21, 0
    s_cmp_eq_u32 s50, 4
    v_mfma_f32_32x32x16_bf16 v[16:31], v[68:71], v[176:179], 0
    s_cbranch_scc1 WL_4_0
    v_lshl_add_u32 v234, v234, 10, v246
    v_lshl_add_u32 v235, v235, 10, v246
    buffer_load_dwordx4 v234, s[4:7], s38 offen  lds
    buffer_load_dwordx4 v235, s[8:11], s38 offen offset:1024  lds
WR_4_0:
    ds_read_b64_tr_b16 v[176:177], v244 offset:2048
    ds_read_b64_tr_b16 v[178:179], v244 offset:3072
    ds_read_b64_tr_b16 v[184:185], v245 offset:2048
    ds_read_b64_tr_b16 v[186:187], v245 offset:3072
    v_mul_f32 v199, v40, v120
    v_fmac_f32 v199, v41, v121
    v_fmac_f32 v199, v42, v122
    v_fmac_f32 v199, v43, v123
    v_fmac_f32 v199, v44, v124
    v_fmac_f32 v199, v45, v125
    v_fmac_f32 v199, v46, v126
    v_fmac_f32 v199, v47, v127
    s_waitcnt lgkmcnt(0)
    v_mfma_f32_32x32x16_bf16 v[0:15], v[72:75], v[176:179], v[0:15]
    v_mul_f32_e64 v201, v48, -v168
    v_fma_f32 v201, v49, -v169, v201
    v_fma_f32 v201, v50, -v170, v201
    v_fma_f32 v201, v51, -v171, v201
    v_fma_f32 v201, v52, -v172, v201
    v_fma_f32 v201, v53, -v173, v201
    v_fma_f32 v201, v54, -v174, v201
    v_fma_f32 v201, v55, -v175, v201
    s_add_u32 m0, s21, 2048
    s_cmp_eq_u32 s50, 4
    v_mfma_f32_32x32x16_bf16 v[16:31], v[76:79], v[176:179], v[16:31]
    s_cbranch_scc1 WL_4_1
    v_lshl_add_u32 v236, v236, 10, v246
    v_lshl_add_u32 v237, v237, 10, v246
    buffer_load_dwordx4 v236, s[4:7], s39 offen  lds
    buffer_load_dwordx4 v237, s[8:11], s39 offen offset:1024  lds
WR_4_1:
    v_mul_f32_e64 v203, v56, -v168
    v_fma_f32 v203, v57, -v169, v203
    v_fma_f32 v203, v58, -v170, v203
    v_fma_f32 v203, v59, -v171, v203
    v_fma_f32 v203, v60, -v172, v203
    v_fma_f32 v203, v61, -v173, v203
    v_fma_f32 v203, v62, -v174, v203
    v_fma_f32 v203, v63, -v175, v203
    v_mfma_f32_32x32x16_bf16 v[32:47], v[64:67], v[180:183], 0
    v_mul_f32 v254, v0, v144
    v_fmac_f32 v254, v1, v145
    v_fmac_f32 v254, v2, v146
    v_fmac_f32 v254, v3, v147
    v_fmac_f32 v254, v4, v148
    v_mfma_f32_32x32x16_bf16 v[48:63], v[68:71], v[180:183], 0
    ds_swizzle_b32 v68, v68 offset:0x401F
    ds_swizzle_b32 v69, v69 offset:0x401F
    ds_swizzle_b32 v70, v70 offset:0x401F
    ds_swizzle_b32 v71, v71 offset:0x401F
    s_waitcnt vmcnt(6)
    ds_read_b64_tr_b16 v[176:177], v244 offset:4096
    ds_read_b64_tr_b16 v[178:179], v244 offset:5120
    ds_read_b64_tr_b16 v[180:181], v245 offset:4096
    ds_read_b64_tr_b16 v[182:183], v245 offset:5120
    v_fmac_f32 v254, v5, v149
    v_fmac_f32 v254, v6, v150
    v_fmac_f32 v254, v7, v151
    v_fmac_f32 v200, v8, v160
    v_mfma_f32_32x32x16_bf16 v[32:47], v[72:75], v[184:187], v[32:47]
    v_fmac_f32 v200, v9, v161
    v_permlane32_swap_b32 v196, v254
    v_fmac_f32 v200, v10, v162
    v_fmac_f32 v200, v11, v163
    v_fmac_f32 v200, v12, v164
    v_mfma_f32_32x32x16_bf16 v[48:63], v[76:79], v[184:187], v[48:63]
    ds_swizzle_b32 v76, v76 offset:0x401F
    ds_swizzle_b32 v77, v77 offset:0x401F
    ds_swizzle_b32 v78, v78 offset:0x401F
    ds_swizzle_b32 v79, v79 offset:0x401F
    v_fmac_f32 v200, v13, v165
    v_fmac_f32 v200, v14, v166
    v_fmac_f32 v200, v15, v167
    v_add_f32 v254, v196, v254
    s_waitcnt lgkmcnt(8)
    s_mov_b64 exec, s[56:57]
    v_xor_b32 v68, 0x80008000, v68
    v_xor_b32 v69, 0x80008000, v69
    v_xor_b32 v70, 0x80008000, v70
    v_xor_b32 v71, 0x80008000, v71
    s_mov_b64 exec, -1
    s_waitcnt vmcnt(4) lgkmcnt(4)
    v_mfma_f32_32x32x16_bf16 v[0:15], v[64:67], v[176:179], 0
    v_mul_f32 v255, v32, v152
    v_fmac_f32 v255, v33, v153
    v_fmac_f32 v255, v34, v154
    v_fmac_f32 v255, v35, v155
    v_fmac_f32 v255, v36, v156
    s_add_u32 m0, s21, 4096
    s_cmp_eq_u32 s50, 4
    v_mfma_f32_32x32x16_bf16 v[16:31], v[68:71], v[176:179], v[16:31]
    s_cbranch_scc1 WL_4_2
    v_lshl_add_u32 v238, v238, 10, v246
    v_lshl_add_u32 v239, v239, 10, v246
    buffer_load_dwordx4 v238, s[4:7], s40 offen  lds
    buffer_load_dwordx4 v239, s[8:11], s40 offen offset:1024  lds
WR_4_2:
    ds_read_b64_tr_b16 v[176:177], v244 offset:6144
    ds_read_b64_tr_b16 v[178:179], v244 offset:7168
    ds_read_b64_tr_b16 v[184:185], v245 offset:6144
    ds_read_b64_tr_b16 v[186:187], v245 offset:7168
    v_fmac_f32 v255, v37, v157
    v_fmac_f32 v255, v38, v158
    v_fmac_f32 v255, v39, v159
    v_fmac_f32 v201, v40, v168
    v_fmac_f32 v201, v41, v169
    s_waitcnt lgkmcnt(0)
    s_mov_b64 exec, s[56:57]
    v_xor_b32 v76, 0x80008000, v76
    v_xor_b32 v77, 0x80008000, v77
    v_xor_b32 v78, 0x80008000, v78
    v_xor_b32 v79, 0x80008000, v79
    s_mov_b64 exec, -1
    v_mfma_f32_32x32x16_bf16 v[0:15], v[72:75], v[176:179], v[0:15]
    v_permlane32_swap_b32 v197, v255
    v_fmac_f32 v201, v42, v170
    v_fmac_f32 v201, v43, v171
    v_fmac_f32 v201, v44, v172
    v_fmac_f32 v201, v45, v173
    s_add_u32 m0, s21, 6144
    s_cmp_eq_u32 s50, 4
    v_mfma_f32_32x32x16_bf16 v[16:31], v[76:79], v[176:179], v[16:31]
    s_cbranch_scc1 WL_4_3
    v_lshl_add_u32 v240, v240, 10, v246
    v_lshl_add_u32 v241, v241, 10, v246
    buffer_load_dwordx4 v240, s[4:7], s41 offen  lds
    buffer_load_dwordx4 v241, s[8:11], s41 offen offset:1024  lds
WR_4_3:
    v_fmac_f32 v201, v46, v174
    v_fmac_f32 v201, v47, v175
    v_add_f32 v255, v197, v255
    v_cvt_pk_bf16_f32 v194, v254, v255
    v_mfma_f32_32x32x16_bf16 v[32:47], v[64:67], v[180:183], 0
    v_mul_f32 v254, v0, v144
    v_fmac_f32 v254, v1, v145
    v_fmac_f32 v254, v2, v146
    v_fmac_f32 v254, v3, v147
    v_fmac_f32 v254, v4, v148
    v_fmac_f32 v254, v5, v149
    v_fmac_f32 v254, v6, v150
    v_fmac_f32 v254, v7, v151
    v_fma_f32 v202, v8, -v160, v202
    v_fma_f32 v202, v9, -v161, v202
    v_mfma_f32_32x32x16_bf16 v[48:63], v[68:71], v[180:183], v[48:63]
    s_waitcnt vmcnt(6)
    ds_read_b64_tr_b16 v[176:177], v244 offset:0
    ds_read_b64_tr_b16 v[178:179], v244 offset:1024
    ds_read_b64_tr_b16 v[180:181], v245 offset:0
    ds_read_b64_tr_b16 v[182:183], v245 offset:1024
    v_permlane32_swap_b32 v254, v200
    v_fma_f32 v202, v10, -v162, v202
    v_fma_f32 v202, v11, -v163, v202
    v_fma_f32 v202, v12, -v164, v202
    v_fma_f32 v202, v13, -v165, v202
    v_fma_f32 v202, v14, -v166, v202
    v_fma_f32 v202, v15, -v167, v202
    v_add_f32 v200, v254, v200
    v_fmac_f32 v198, v16, v112
    v_permlane32_swap_b32 v202, v254
    v_mfma_f32_32x32x16_bf16 v[32:47], v[72:75], v[184:187], v[32:47]
    v_fmac_f32 v198, v17, v113
    v_fmac_f32 v198, v18, v114
    v_fmac_f32 v198, v19, v115
    v_fmac_f32 v198, v20, v116
    v_fmac_f32 v198, v21, v117
    v_fmac_f32 v198, v22, v118
    v_fmac_f32 v198, v23, v119
    v_add_f32 v254, v202, v254
    v_mul_f32 v196, v24, v160
    v_fmac_f32 v196, v25, v161
    v_mfma_f32_32x32x16_bf16 v[48:63], v[76:79], v[184:187], v[48:63]
    v_add_u32 v249, s48, v249
    v_add_u32 v250, s49, v250
    ds_read_b32 v252, v251 offset:16
    ds_read_b64_tr_b16 v[64:65], v249 offset:0
    ds_read_b64_tr_b16 v[68:69], v249 offset:64
    ds_read_b64_tr_b16 v[66:67], v249 offset:256
    ds_read_b64_tr_b16 v[70:71], v249 offset:320
    s_mov_b64 exec, s[54:55]
    ds_read_u16_d16_hi v242, v250 offset:0
    s_mov_b64 exec, -1
    v_fmac_f32 v196, v26, v162
    v_fmac_f32 v196, v27, v163
    v_fmac_f32 v196, v28, v164
    v_fmac_f32 v196, v29, v165
    v_fmac_f32 v196, v30, v166
    v_fmac_f32 v196, v31, v167
    s_nop 1
    v_permlane32_swap_b32 v198, v196
    v_add_f32 v196, v198, v196
    s_cmp_eq_u32 s50, 4
    s_cbranch_scc1 LEPI_0
    v_mul_f32 v255, v32, v152
    v_fmac_f32 v255, v33, v153
    v_fmac_f32 v255, v34, v154
    v_fmac_f32 v255, v35, v155
    v_fmac_f32 v255, v36, v156
    v_fmac_f32 v255, v37, v157
    v_fmac_f32 v255, v38, v158
    v_fmac_f32 v255, v39, v159
    v_fma_f32 v203, v40, -v168, v203
    v_fma_f32 v203, v41, -v169, v203
    v_permlane32_swap_b32 v255, v201
    v_fma_f32 v203, v42, -v170, v203
    v_fma_f32 v203, v43, -v171, v203
    v_fma_f32 v203, v44, -v172, v203
    v_fma_f32 v203, v45, -v173, v203
    v_fma_f32 v203, v46, -v174, v203
    v_fma_f32 v203, v47, -v175, v203
    v_add_f32 v201, v255, v201
    v_fmac_f32 v199, v48, v120
    v_permlane32_swap_b32 v203, v255
    v_fmac_f32 v199, v49, v121
    v_fmac_f32 v199, v50, v122
    v_fmac_f32 v199, v51, v123
    v_fmac_f32 v199, v52, v124
    v_fmac_f32 v199, v53, v125
    v_fmac_f32 v199, v54, v126
    v_fmac_f32 v199, v55, v127
    v_add_f32 v255, v203, v255
    v_mul_f32 v197, v56, v168
    v_fmac_f32 v197, v57, v169
    v_fmac_f32 v197, v58, v170
    v_fmac_f32 v197, v59, v171
    v_fmac_f32 v197, v60, v172
    v_fmac_f32 v197, v61, v173
    v_fmac_f32 v197, v62, v174
    v_fmac_f32 v197, v63, v175
    s_nop 1
    v_permlane32_swap_b32 v199, v197
    v_add_f32 v197, v199, v197
    v_cvt_pk_bf16_f32 v200, v200, v201
    v_cvt_pk_bf16_f32 v254, v254, v255
    v_cvt_pk_bf16_f32 v196, v196, v197
    ds_write2st64_b32 v253, v192, v193 offset0:0 offset1:1
    ds_write2st64_b32 v253, v194, v200 offset0:2 offset1:3
    ds_write_b32 v253, v196 offset:1024
    s_mov_b64 exec, 0xffffffff
    ds_write_b32 v253, v254 offset:1280
    s_mov_b64 exec, -1
    s_add_u32 s50, s50, 1
    s_cmp_ge_u32 s50, 4
    s_cbranch_scc1 LAST1
    s_waitcnt lgkmcnt(9)
    v_readfirstlane_b32 s66, v252
    s_add_u32 s53, s53, 1
    v_mov_b32 v252, s53
    s_cmp_le_u32 s53, s66
    ds_write2_b32 v251, v252, v252 offset0:0 offset1:8
    s_setprio 1
    s_cbranch_scc1 PRIO_11
    s_setprio 0
PRIO_11:
    s_cmp_eq_u32 s52, 4
    s_cbranch_scc1 ITEM_1_4
    s_cmp_eq_u32 s52, 5
    s_cbranch_scc1 ITEM_1_5
    s_cmp_eq_u32 s52, 3
    s_cbranch_scc1 ITEM_1_3
    s_cmp_eq_u32 s52, 6
    s_cbranch_scc1 ITEM_1_6
    s_cmp_eq_u32 s52, 8
    s_cbranch_scc1 ITEM_1_8
    s_branch ITEM_1_2
WL_4_0:
    s_add_u32 s66, s51, 0
    buffer_load_dwordx4 v[96:99], v246, s[16:19], s66 offen offset:2048 sc1
    buffer_load_dwordx4 v[100:103], v246, s[16:19], s66 offen offset:3072 sc1
    s_branch WR_4_0
WL_4_1:
    s_add_u32 s66, s51, 4096
    buffer_load_dwordx4 v[104:107], v246, s[16:19], s66 offen offset:2048 sc1
    buffer_load_dwordx4 v[108:111], v246, s[16:19], s66 offen offset:3072 sc1
    s_branch WR_4_1
WL_4_2:
    s_add_u32 s66, s51, 8192
    buffer_load_dwordx4 v[128:131], v246, s[16:19], s66 offen offset:2048 sc1
    buffer_load_dwordx4 v[132:135], v246, s[16:19], s66 offen offset:3072 sc1
    s_branch WR_4_2
WL_4_3:
    s_add_u32 s66, s51, 12288
    buffer_load_dwordx4 v[136:139], v246, s[16:19], s66 offen offset:2048 sc1
    buffer_load_dwordx4 v[140:143], v246, s[16:19], s66 offen offset:3072 sc1
    s_branch WR_4_3
.p2align 6
ITEM_1_5:
    s_mov_b64 exec, s[54:55]
    ds_read_u16_d16_hi v243, v250 offset:128
    s_mov_b64 exec, -1
    ds_read_b64_tr_b16 v[72:73], v249 offset:512
    ds_read_b64_tr_b16 v[76:77], v249 offset:576
    ds_read_b64_tr_b16 v[74:75], v249 offset:768
    ds_read_b64_tr_b16 v[78:79], v249 offset:832
    ds_read_b64_tr_b16 v[80:81], v249 offset:1024
    ds_read_b64_tr_b16 v[84:85], v249 offset:1088
    s_waitcnt lgkmcnt(7)
    v_mul_f32_dpp v196, v242, v64 row_newbcast:0 row_mask:0xf bank_mask:0xf
    v_mul_f32_dpp v197, v242, v65 row_newbcast:1 row_mask:0xf bank_mask:0xf
    v_mul_f32_dpp v198, v242, v64 row_newbcast:8 row_mask:0xf bank_mask:0xf
    v_mul_f32_dpp v199, v242, v65 row_newbcast:9 row_mask:0xf bank_mask:0xf
    v_mul_f32_dpp v200, v242, v68 row_newbcast:2 row_mask:0xf bank_mask:0xf
    v_mul_f32_dpp v201, v242, v69 row_newbcast:3 row_mask:0xf bank_mask:0xf
    v_mul_f32_dpp v202, v242, v68 row_newbcast:10 row_mask:0xf bank_mask:0xf
    v_mul_f32_dpp v203, v242, v69 row_newbcast:11 row_mask:0xf bank_mask:0xf
    v_cvt_pk_bf16_f32 v64, v196, v197
    v_cvt_pk_bf16_f32 v68, v198, v199
    v_cvt_pk_bf16_f32 v65, v200, v201
    v_cvt_pk_bf16_f32 v69, v202, v203
    v_mul_f32_dpp v196, v242, v66 row_newbcast:4 row_mask:0xf bank_mask:0xf
    v_mul_f32_dpp v197, v242, v67 row_newbcast:5 row_mask:0xf bank_mask:0xf
    v_mul_f32_dpp v198, v242, v66 row_newbcast:12 row_mask:0xf bank_mask:0xf
    v_mul_f32_dpp v199, v242, v67 row_newbcast:13 row_mask:0xf bank_mask:0xf
    v_mul_f32_dpp v200, v242, v70 row_newbcast:6 row_mask:0xf bank_mask:0xf
    v_mul_f32_dpp v201, v242, v71 row_newbcast:7 row_mask:0xf bank_mask:0xf
    v_mul_f32_dpp v202, v242, v70 row_newbcast:14 row_mask:0xf bank_mask:0xf
    v_mul_f32_dpp v203, v242, v71 row_newbcast:15 row_mask:0xf bank_mask:0xf
    v_cvt_pk_bf16_f32 v66, v196, v197
    v_cvt_pk_bf16_f32 v70, v198, v199
    v_cvt_pk_bf16_f32 v67, v200, v201
    v_cvt_pk_bf16_f32 v71, v202, v203
    s_mov_b64 exec, s[54:55]
    ds_read_u16_d16_hi v242, v250 offset:256
    s_mov_b64 exec, -1
    s_waitcnt vmcnt(4) lgkmcnt(3)
    v_mfma_f32_32x32x16_bf16 v[0:15], v[64:67], v[176:179], 0
    v_mul_f32_dpp v196, v243, v72 row_newbcast:0 row_mask:0xf bank_mask:0xf
    v_mul_f32_dpp v197, v243, v73 row_newbcast:1 row_mask:0xf bank_mask:0xf
    v_mul_f32_dpp v198, v243, v72 row_newbcast:8 row_mask:0xf bank_mask:0xf
    v_mul_f32_dpp v199, v243, v73 row_newbcast:9 row_mask:0xf bank_mask:0xf
    v_mul_f32_dpp v200, v243, v76 row_newbcast:2 row_mask:0xf bank_mask:0xf
    v_mul_f32_dpp v201, v243, v77 row_newbcast:3 row_mask:0xf bank_mask:0xf
    v_mul_f32_dpp v202, v243, v76 row_newbcast:10 row_mask:0xf bank_mask:0xf
    v_mul_f32_dpp v203, v243, v77 row_newbcast:11 row_mask:0xf bank_mask:0xf
    v_cvt_pk_bf16_f32 v72, v196, v197
    v_cvt_pk_bf16_f32 v76, v198, v199
    v_cvt_pk_bf16_f32 v73, v200, v201
    v_cvt_pk_bf16_f32 v77, v202, v203
    s_add_u32 m0, s21, 0
    v_mfma_f32_32x32x16_bf16 v[16:31], v[68:71], v[176:179], 0
    buffer_load_dwordx4 v236, s[4:7], s35 offen  lds
    buffer_load_dwordx4 v237, s[8:11], s35 offen offset:1024  lds
    ds_read_b64_tr_b16 v[176:177], v244 offset:2048
    ds_read_b64_tr_b16 v[178:179], v244 offset:3072
    ds_read_b64_tr_b16 v[184:185], v245 offset:2048
    ds_read_b64_tr_b16 v[186:187], v245 offset:3072
    v_mul_f32_dpp v196, v243, v74 row_newbcast:4 row_mask:0xf bank_mask:0xf
    v_mul_f32_dpp v197, v243, v75 row_newbcast:5 row_mask:0xf bank_mask:0xf
    v_mul_f32_dpp v198, v243, v74 row_newbcast:12 row_mask:0xf bank_mask:0xf
    v_mul_f32_dpp v199, v243, v75 row_newbcast:13 row_mask:0xf bank_mask:0xf
    v_mul_f32_dpp v200, v243, v78 row_newbcast:6 row_mask:0xf bank_mask:0xf
    v_mul_f32_dpp v201, v243, v79 row_newbcast:7 row_mask:0xf bank_mask:0xf
    v_mul_f32_dpp v202, v243, v78 row_newbcast:14 row_mask:0xf bank_mask:0xf
    v_mul_f32_dpp v203, v243, v79 row_newbcast:15 row_mask:0xf bank_mask:0xf
    v_cvt_pk_bf16_f32 v74, v196, v197
    v_cvt_pk_bf16_f32 v78, v198, v199
    v_cvt_pk_bf16_f32 v75, v200, v201
    v_cvt_pk_bf16_f32 v79, v202, v203
    s_nop 0
    s_waitcnt vmcnt(4) lgkmcnt(0)
    v_mfma_f32_32x32x16_bf16 v[0:15], v[72:75], v[176:179], v[0:15]
    v_mul_f32_dpp v196, v242, v80 row_newbcast:0 row_mask:0xf bank_mask:0xf
    v_mul_f32_dpp v197, v242, v81 row_newbcast:1 row_mask:0xf bank_mask:0xf
    v_mul_f32_dpp v198, v242, v80 row_newbcast:8 row_mask:0xf bank_mask:0xf
    v_mul_f32_dpp v199, v242, v81 row_newbcast:9 row_mask:0xf bank_mask:0xf
    v_mul_f32_dpp v200, v242, v84 row_newbcast:2 row_mask:0xf bank_mask:0xf
    v_mul_f32_dpp v201, v242, v85 row_newbcast:3 row_mask:0xf bank_mask:0xf
    s_add_u32 m0, s21, 2048
    v_mfma_f32_32x32x16_bf16 v[16:31], v[76:79], v[176:179], v[16:31]
    buffer_load_dwordx4 v238, s[4:7], s35 offen  lds
    ds_read_b64_tr_b16 v[176:177], v244 offset:4096
    ds_read_b64_tr_b16 v[188:189], v245 offset:4096
    v_mul_f32_dpp v202, v242, v84 row_newbcast:10 row_mask:0xf bank_mask:0xf
    v_mul_f32_dpp v203, v242, v85 row_newbcast:11 row_mask:0xf bank_mask:0xf
    v_cvt_pk_bf16_f32 v80, v196, v197
    v_cvt_pk_bf16_f32 v84, v198, v199
    v_cvt_pk_bf16_f32 v81, v200, v201
    v_cvt_pk_bf16_f32 v85, v202, v203
    s_nop 0
    s_waitcnt lgkmcnt(0)
    v_mfma_f32_32x32x8_bf16 v[0:15], v[80:81], v[176:177], v[0:15]
    s_add_u32 m0, s21, 4096
    v_mfma_f32_32x32x8_bf16 v[16:31], v[84:85], v[176:177], v[16:31]
    buffer_load_dwordx4 v234, s[4:7], s36 offen  lds
    buffer_load_dwordx4 v235, s[8:11], s36 offen offset:1024  lds
    s_mov_b32 m0, s50
    s_nop 0
    s_movrels_b32 s71, s23
    s_movrels_b32 s33, s28
    v_add_u32 v253, s33, v248
    s_bfe_u32 s46, s71, 0x30012
    s_mov_b32 m0, s46
    s_and_b32 s66, s71, 0x3ffff
    s_movrels_b32 s68, s57
    s_movrels_b32 s69, s61
    s_sub_u32 s48, s66, s47
    s_mov_b32 s47, s66
    s_lshr_b32 s52, s71, 28
    s_lshl_b32 s67, s46, 9
    s_add_u32 s66, s66, s67
    s_sub_u32 s49, s66, s42
    s_mov_b32 s42, s66
    s_bfe_u32 s66, s68, 655360
    s_add_u32 s43, s42, s66
    s_bfe_u32 s39, s69, 655360
    s_bfe_u32 s66, s68, 655370
    s_add_u32 s44, s42, s66
    s_bfe_u32 s40, s69, 655370
    s_bfe_u32 s66, s68, 655380
    s_add_u32 s45, s42, s66
    s_bfe_u32 s41, s69, 655380
    v_add_u32 v252, s45, v247
    ds_read_u16 v240, v252
    ds_read_u16 v241, v252 offset:64
    v_mfma_f32_32x32x16_bf16 v[32:47], v[64:67], v[180:183], 0
    v_mul_f32 v196, v0, v96
    v_fmac_f32 v196, v1, v97
    v_fmac_f32 v196, v2, v98
    v_fmac_f32 v196, v3, v99
    v_fmac_f32 v196, v4, v100
    v_fmac_f32 v196, v5, v101
    v_fmac_f32 v196, v6, v102
    v_mfma_f32_32x32x16_bf16 v[48:63], v[68:71], v[180:183], 0
    v_fmac_f32 v196, v7, v103
    v_mul_f32 v198, v8, v128
    v_fmac_f32 v198, v9, v129
    v_fmac_f32 v198, v10, v130
    v_fmac_f32 v198, v11, v131
    v_fmac_f32 v198, v12, v132
    v_mfma_f32_32x32x16_bf16 v[32:47], v[72:75], v[184:187], v[32:47]
    v_fmac_f32 v198, v13, v133
    v_fmac_f32 v198, v14, v134
    v_fmac_f32 v198, v15, v135
    v_mul_f32 v200, v16, v128
    v_fmac_f32 v200, v17, v129
    v_permlane32_swap_b32 v196, v198
    v_mfma_f32_32x32x16_bf16 v[48:63], v[76:79], v[184:187], v[48:63]
    s_waitcnt vmcnt(5)
    ds_read_b64_tr_b16 v[176:177], v244 offset:6144
    ds_read_b64_tr_b16 v[178:179], v244 offset:7168
    ds_read_b64_tr_b16 v[180:181], v245 offset:6144
    ds_read_b64_tr_b16 v[182:183], v245 offset:7168
    v_fmac_f32 v200, v18, v130
    v_fmac_f32 v200, v19, v131
    v_fmac_f32 v200, v20, v132
    v_fmac_f32 v200, v21, v133
    v_fmac_f32 v200, v22, v134
    v_fmac_f32 v200, v23, v135
    v_mfma_f32_32x32x8_bf16 v[32:47], v[80:81], v[188:189], v[32:47]
    v_add_f32 v198, v196, v198
    v_mul_f32_e64 v202, v24, -v128
    v_fma_f32 v202, v25, -v129, v202
    v_fma_f32 v202, v26, -v130, v202
    v_fma_f32 v202, v27, -v131, v202
    v_fma_f32 v202, v28, -v132, v202
    v_mfma_f32_32x32x8_bf16 v[48:63], v[84:85], v[188:189], v[48:63]
    v_fma_f32 v202, v29, -v133, v202
    v_fma_f32 v202, v30, -v134, v202
    v_fma_f32 v202, v31, -v135, v202
    s_nop 1
    v_permlane32_swap_b32 v200, v202
    v_add_f32 v202, v200, v202
    s_waitcnt vmcnt(3) lgkmcnt(0)
    v_mfma_f32_32x32x16_bf16 v[0:15], v[64:67], v[176:179], 0
    v_mul_f32 v197, v32, v104
    v_fmac_f32 v197, v33, v105
    v_fmac_f32 v197, v34, v106
    v_fmac_f32 v197, v35, v107
    v_fmac_f32 v197, v36, v108
    v_fmac_f32 v197, v37, v109
    v_fmac_f32 v197, v38, v110
    s_add_u32 m0, s21, 6144
    v_mfma_f32_32x32x16_bf16 v[16:31], v[68:71], v[176:179], 0
    buffer_load_dwordx4 v236, s[4:7], s36 offen  lds
    buffer_load_dwordx4 v237, s[8:11], s36 offen offset:1024  lds
    ds_read_b64_tr_b16 v[176:177], v244 offset:0
    ds_read_b64_tr_b16 v[178:179], v244 offset:1024
    ds_read_b64_tr_b16 v[184:185], v245 offset:0
    ds_read_b64_tr_b16 v[186:187], v245 offset:1024
    v_fmac_f32 v197, v39, v111
    v_mul_f32 v199, v40, v136
    v_fmac_f32 v199, v41, v137
    v_fmac_f32 v199, v42, v138
    v_fmac_f32 v199, v43, v139
    v_fmac_f32 v199, v44, v140
    s_waitcnt vmcnt(4) lgkmcnt(0)
    v_mfma_f32_32x32x16_bf16 v[0:15], v[72:75], v[176:179], v[0:15]
    v_fmac_f32 v199, v45, v141
    v_fmac_f32 v199, v46, v142
    v_fmac_f32 v199, v47, v143
    v_mul_f32 v201, v48, v136
    v_fmac_f32 v201, v49, v137
    v_permlane32_swap_b32 v197, v199
    v_fmac_f32 v201, v50, v138
    s_add_u32 m0, s21, 0
    v_mfma_f32_32x32x16_bf16 v[16:31], v[76:79], v[176:179], v[16:31]
    buffer_load_dwordx4 v238, s[4:7], s36 offen  lds
    ds_read_b64_tr_b16 v[176:177], v244 offset:2048
    ds_read_b64_tr_b16 v[188:189], v245 offset:2048
    v_fmac_f32 v201, v51, v139
    v_fmac_f32 v201, v52, v140
    v_fmac_f32 v201, v53, v141
    v_fmac_f32 v201, v54, v142
    v_fmac_f32 v201, v55, v143
    v_add_f32 v199, v197, v199
    s_waitcnt lgkmcnt(0)
    v_mfma_f32_32x32x8_bf16 v[0:15], v[80:81], v[176:177], v[0:15]
    v_mul_f32_e64 v203, v56, -v136
    v_fma_f32 v203, v57, -v137, v203
    v_fma_f32 v203, v58, -v138, v203
    v_fma_f32 v203, v59, -v139, v203
    v_fma_f32 v203, v60, -v140, v203
    v_fma_f32 v203, v61, -v141, v203
    v_fma_f32 v203, v62, -v142, v203
    s_add_u32 m0, s21, 2048
    v_mfma_f32_32x32x8_bf16 v[16:31], v[84:85], v[176:177], v[16:31]
    buffer_load_dwordx4 v234, s[4:7], s37 offen  lds
    buffer_load_dwordx4 v235, s[8:11], s37 offen offset:1024  lds
    v_add_u32 v252, s42, v247
    ds_read_u16 v234, v252
    ds_read_u16 v235, v252 offset:64
    v_fma_f32 v203, v63, -v143, v203
    s_nop 1
    v_permlane32_swap_b32 v201, v203
    v_add_f32 v203, v201, v203
    v_cvt_pk_bf16_f32 v192, v198, v199
    v_cvt_pk_bf16_f32 v193, v202, v203
    v_mfma_f32_32x32x16_bf16 v[32:47], v[64:67], v[180:183], 0
    v_mul_f32 v196, v0, v144
    v_fmac_f32 v196, v1, v145
    v_fmac_f32 v196, v2, v146
    v_fmac_f32 v196, v3, v147
    v_fmac_f32 v196, v4, v148
    v_fmac_f32 v196, v5, v149
    v_mfma_f32_32x32x16_bf16 v[48:63], v[68:71], v[180:183], 0
    v_fmac_f32 v196, v6, v150
    v_fmac_f32 v196, v7, v151
    v_mul_f32 v198, v8, v112
    v_fmac_f32 v198, v9, v113
    v_fmac_f32 v198, v10, v114
    v_mfma_f32_32x32x16_bf16 v[32:47], v[72:75], v[184:187], v[32:47]
    v_fmac_f32 v198, v11, v115
    v_fmac_f32 v198, v12, v116
    v_fmac_f32 v198, v13, v117
    v_fmac_f32 v198, v14, v118
    v_fmac_f32 v198, v15, v119
    v_mfma_f32_32x32x16_bf16 v[48:63], v[76:79], v[184:187], v[48:63]
    s_waitcnt vmcnt(5)
    ds_read_b64_tr_b16 v[176:177], v244 offset:4096
    ds_read_b64_tr_b16 v[178:179], v244 offset:5120
    ds_read_b64_tr_b16 v[180:181], v245 offset:4096
    ds_read_b64_tr_b16 v[182:183], v245 offset:5120
    v_mul_f32_e64 v200, v16, -v160
    v_fma_f32 v200, v17, -v161, v200
    v_fma_f32 v200, v18, -v162, v200
    v_fma_f32 v200, v19, -v163, v200
    v_fma_f32 v200, v20, -v164, v200
    v_fma_f32 v200, v21, -v165, v200
    v_mfma_f32_32x32x8_bf16 v[32:47], v[80:81], v[188:189], v[32:47]
    v_fma_f32 v200, v22, -v166, v200
    v_fma_f32 v200, v23, -v167, v200
    v_mul_f32_e64 v202, v24, -v160
    v_fma_f32 v202, v25, -v161, v202
    v_fma_f32 v202, v26, -v162, v202
    v_mfma_f32_32x32x8_bf16 v[48:63], v[84:85], v[188:189], v[48:63]
    v_fma_f32 v202, v27, -v163, v202
    v_fma_f32 v202, v28, -v164, v202
    v_fma_f32 v202, v29, -v165, v202
    v_fma_f32 v202, v30, -v166, v202
    v_fma_f32 v202, v31, -v167, v202
    s_waitcnt vmcnt(3) lgkmcnt(0)
    v_mfma_f32_32x32x16_bf16 v[0:15], v[64:67], v[176:179], 0
    v_mul_f32 v197, v32, v152
    v_fmac_f32 v197, v33, v153
    v_fmac_f32 v197, v34, v154
    v_fmac_f32 v197, v35, v155
    v_fmac_f32 v197, v36, v156
    v_fmac_f32 v197, v37, v157
    s_add_u32 m0, s21, 4096
    v_mfma_f32_32x32x16_bf16 v[16:31], v[68:71], v[176:179], 0
    buffer_load_dwordx4 v236, s[4:7], s37 offen  lds
    buffer_load_dwordx4 v237, s[8:11], s37 offen offset:1024  lds
    ds_read_b64_tr_b16 v[176:177], v244 offset:6144
    ds_read_b64_tr_b16 v[178:179], v244 offset:7168
    ds_read_b64_tr_b16 v[184:185], v245 offset:6144
    ds_read_b64_tr_b16 v[186:187], v245 offset:7168
    v_add_u32 v252, s43, v247
    ds_read_u16 v236, v252
    ds_read_u16 v237, v252 offset:64
    v_fmac_f32 v197, v38, v158
    v_fmac_f32 v197, v39, v159
    v_mul_f32 v199, v40, v120
    v_fmac_f32 v199, v41, v121
    v_fmac_f32 v199, v42, v122
    s_waitcnt vmcnt(4) lgkmcnt(2)
    v_mfma_f32_32x32x16_bf16 v[0:15], v[72:75], v[176:179], v[0:15]
    v_fmac_f32 v199, v43, v123
    v_fmac_f32 v199, v44, v124
    v_fmac_f32 v199, v45, v125
    v_fmac_f32 v199, v46, v126
    v_fmac_f32 v199, v47, v127
    s_add_u32 m0, s21, 6144
    v_mfma_f32_32x32x16_bf16 v[16:31], v[76:79], v[176:179], v[16:31]
    buffer_load_dwordx4 v238, s[4:7], s37 offen  lds
    ds_read_b64_tr_b16 v[176:177], v244 offset:0
    ds_read_b64_tr_b16 v[188:189], v245 offset:0
    v_add_u32 v252, s44, v247
    ds_read_u16 v238, v252
    ds_read_u16 v239, v252 offset:64
    v_mul_f32_e64 v201, v48, -v168
    v_fma_f32 v201, v49, -v169, v201
    v_fma_f32 v201, v50, -v170, v201
    v_fma_f32 v201, v51, -v171, v201
    v_fma_f32 v201, v52, -v172, v201
    v_fma_f32 v201, v53, -v173, v201
    s_waitcnt lgkmcnt(2)
    v_mfma_f32_32x32x8_bf16 v[0:15], v[80:81], v[176:177], v[0:15]
    v_fma_f32 v201, v54, -v174, v201
    v_fma_f32 v201, v55, -v175, v201
    v_mul_f32_e64 v203, v56, -v168
    v_fma_f32 v203, v57, -v169, v203
    v_fma_f32 v203, v58, -v170, v203
    s_add_u32 m0, s21, 0
    s_cmp_eq_u32 s50, 4
    v_mfma_f32_32x32x8_bf16 v[16:31], v[84:85], v[176:177], v[16:31]
    s_cbranch_scc1 WL_5_0
    v_lshl_add_u32 v234, v234, 10, v246
    v_lshl_add_u32 v235, v235, 10, v246
    buffer_load_dwordx4 v234, s[4:7], s38 offen  lds
    buffer_load_dwordx4 v235, s[8:11], s38 offen offset:1024  lds
WR_5_0:
    v_fma_f32 v203, v59, -v171, v203
    v_fma_f32 v203, v60, -v172, v203
    v_fma_f32 v203, v61, -v173, v203
    v_fma_f32 v203, v62, -v174, v203
    v_fma_f32 v203, v63, -v175, v203
    v_mfma_f32_32x32x16_bf16 v[32:47], v[64:67], v[180:183], 0
    v_mul_f32 v254, v0, v144
    v_fmac_f32 v254, v1, v145
    v_fmac_f32 v254, v2, v146
    v_mfma_f32_32x32x16_bf16 v[48:63], v[68:71], v[180:183], 0
    ds_swizzle_b32 v68, v68 offset:0x401F
    ds_swizzle_b32 v69, v69 offset:0x401F
    ds_swizzle_b32 v70, v70 offset:0x401F
    ds_swizzle_b32 v71, v71 offset:0x401F
    v_fmac_f32 v254, v3, v147
    v_fmac_f32 v254, v4, v148
    v_fmac_f32 v254, v5, v149
    v_mfma_f32_32x32x16_bf16 v[32:47], v[72:75], v[184:187], v[32:47]
    v_fmac_f32 v254, v6, v150
    v_fmac_f32 v254, v7, v151
    v_fmac_f32 v200, v8, v160
    v_mfma_f32_32x32x16_bf16 v[48:63], v[76:79], v[184:187], v[48:63]
    ds_swizzle_b32 v76, v76 offset:0x401F
    ds_swizzle_b32 v77, v77 offset:0x401F
    ds_swizzle_b32 v78, v78 offset:0x401F
    ds_swizzle_b32 v79, v79 offset:0x401F
    s_waitcnt vmcnt(5)
    ds_read_b64_tr_b16 v[176:177], v244 offset:2048
    ds_read_b64_tr_b16 v[178:179], v244 offset:3072
    ds_read_b64_tr_b16 v[180:181], v245 offset:2048
    ds_read_b64_tr_b16 v[182:183], v245 offset:3072
    v_fmac_f32 v200, v9, v161
    v_permlane32_swap_b32 v196, v254
    v_fmac_f32 v200, v10, v162
    v_mfma_f32_32x32x8_bf16 v[32:47], v[80:81], v[188:189], v[32:47]
    v_fmac_f32 v200, v11, v163
    v_fmac_f32 v200, v12, v164
    v_fmac_f32 v200, v13, v165
    v_mfma_f32_32x32x8_bf16 v[48:63], v[84:85], v[188:189], v[48:63]
    ds_swizzle_b32 v84, v84 offset:0x401F
    ds_swizzle_b32 v85, v85 offset:0x401F
    v_fmac_f32 v200, v14, v166
    v_fmac_f32 v200, v15, v167
    v_add_f32 v254, v196, v254
    s_waitcnt lgkmcnt(6)
    s_mov_b64 exec, s[56:57]
    v_xor_b32 v68, 0x80008000, v68
    v_xor_b32 v69, 0x80008000, v69
    v_xor_b32 v70, 0x80008000, v70
    v_xor_b32 v71, 0x80008000, v71
    v_xor_b32 v76, 0x80008000, v76
    v_xor_b32 v77, 0x80008000, v77
    v_xor_b32 v78, 0x80008000, v78
    v_xor_b32 v79, 0x80008000, v79
    s_mov_b64 exec, -1
    s_waitcnt vmcnt(3) lgkmcnt(2)
    v_mfma_f32_32x32x16_bf16 v[0:15], v[64:67], v[176:179], 0
    v_mul_f32 v255, v32, v152
    v_fmac_f32 v255, v33, v153
    v_fmac_f32 v255, v34, v154
    v_fmac_f32 v255, v35, v155
    s_add_u32 m0, s21, 2048
    s_cmp_eq_u32 s50, 4
    v_mfma_f32_32x32x16_bf16 v[16:31], v[68:71], v[176:179], v[16:31]
    s_cbranch_scc1 WL_5_1
    v_lshl_add_u32 v236, v236, 10, v246
    v_lshl_add_u32 v237, v237, 10, v246
    buffer_load_dwordx4 v236, s[4:7], s39 offen  lds
    buffer_load_dwordx4 v237, s[8:11], s39 offen offset:1024  lds
WR_5_1:
    ds_read_b64_tr_b16 v[176:177], v244 offset:4096
    ds_read_b64_tr_b16 v[178:179], v244 offset:5120
    ds_read_b64_tr_b16 v[184:185], v245 offset:4096
    ds_read_b64_tr_b16 v[186:187], v245 offset:5120
    v_fmac_f32 v255, v36, v156
    v_fmac_f32 v255, v37, v157
    v_fmac_f32 v255, v38, v158
    s_waitcnt vmcnt(4) lgkmcnt(0)
    v_mfma_f32_32x32x16_bf16 v[0:15], v[72:75], v[176:179], v[0:15]
    v_fmac_f32 v255, v39, v159
    v_fmac_f32 v201, v40, v168
    v_fmac_f32 v201, v41, v169
    s_add_u32 m0, s21, 4096
    s_cmp_eq_u32 s50, 4
    v_mfma_f32_32x32x16_bf16 v[16:31], v[76:79], v[176:179], v[16:31]
    s_cbranch_scc1 WL_5_2
    v_lshl_add_u32 v238, v238, 10, v246
    v_lshl_add_u32 v239, v239, 10, v246
    buffer_load_dwordx4 v238, s[4:7], s40 offen  lds
    buffer_load_dwordx4 v239, s[8:11], s40 offen offset:1024  lds
WR_5_2:
    ds_read_b64_tr_b16 v[176:177], v244 offset:6144
    ds_read_b64_tr_b16 v[188:189], v245 offset:6144
    v_permlane32_swap_b32 v197, v255
    v_fmac_f32 v201, v42, v170
    v_fmac_f32 v201, v43, v171
    s_waitcnt lgkmcnt(0)
    s_mov_b64 exec, s[56:57]
    v_xor_b32 v84, 0x80008000, v84
    v_xor_b32 v85, 0x80008000, v85
    s_mov_b64 exec, -1
    v_mfma_f32_32x32x8_bf16 v[0:15], v[80:81], v[176:177], v[0:15]
    v_fmac_f32 v201, v44, v172
    v_fmac_f32 v201, v45, v173
    v_fmac_f32 v201, v46, v174
    s_add_u32 m0, s21, 6144
    s_cmp_eq_u32 s50, 4
    v_mfma_f32_32x32x8_bf16 v[16:31], v[84:85], v[176:177], v[16:31]
    s_cbranch_scc1 WL_5_3
    v_lshl_add_u32 v240, v240, 10, v246
    v_lshl_add_u32 v241, v241, 10, v246
    buffer_load_dwordx4 v240, s[4:7], s41 offen  lds
    buffer_load_dwordx4 v241, s[8:11], s41 offen offset:1024  lds
WR_5_3:
    v_fmac_f32 v201, v47, v175
    v_add_f32 v255, v197, v255
    v_cvt_pk_bf16_f32 v194, v254, v255
    v_mfma_f32_32x32x16_bf16 v[32:47], v[64:67], v[180:183], 0
    v_mul_f32 v254, v0, v144
    v_fmac_f32 v254, v1, v145
    v_fmac_f32 v254, v2, v146
    v_fmac_f32 v254, v3, v147
    v_fmac_f32 v254, v4, v148
    v_fmac_f32 v254, v5, v149
    v_fmac_f32 v254, v6, v150
    v_mfma_f32_32x32x16_bf16 v[48:63], v[68:71], v[180:183], v[48:63]
    v_fmac_f32 v254, v7, v151
    v_fma_f32 v202, v8, -v160, v202
    v_fma_f32 v202, v9, -v161, v202
    v_permlane32_swap_b32 v254, v200
    v_fma_f32 v202, v10, -v162, v202
    v_fma_f32 v202, v11, -v163, v202
    v_mfma_f32_32x32x16_bf16 v[32:47], v[72:75], v[184:187], v[32:47]
    v_fma_f32 v202, v12, -v164, v202
    v_fma_f32 v202, v13, -v165, v202
    v_fma_f32 v202, v14, -v166, v202
    v_fma_f32 v202, v15, -v167, v202
    v_add_f32 v200, v254, v200
    v_fmac_f32 v198, v16, v112
    v_permlane32_swap_b32 v202, v254
    v_mfma_f32_32x32x16_bf16 v[48:63], v[76:79], v[184:187], v[48:63]
    s_waitcnt vmcnt(6)
    ds_read_b64_tr_b16 v[176:177], v244 offset:0
    ds_read_b64_tr_b16 v[178:179], v244 offset:1024
    ds_read_b64_tr_b16 v[180:181], v245 offset:0
    ds_read_b64_tr_b16 v[182:183], v245 offset:1024
    v_fmac_f32 v198, v17, v113
    v_fmac_f32 v198, v18, v114
    v_fmac_f32 v198, v19, v115
    v_fmac_f32 v198, v20, v116
    v_fmac_f32 v198, v21, v117
    v_fmac_f32 v198, v22, v118
    v_mfma_f32_32x32x8_bf16 v[32:47], v[80:81], v[188:189], v[32:47]
    v_fmac_f32 v198, v23, v119
    v_add_f32 v254, v202, v254
    v_mul_f32 v196, v24, v160
    v_fmac_f32 v196, v25, v161
    v_fmac_f32 v196, v26, v162
    v_fmac_f32 v196, v27, v163
    v_fmac_f32 v196, v28, v164
    v_mfma_f32_32x32x8_bf16 v[48:63], v[84:85], v[188:189], v[48:63]
    v_add_u32 v249, s48, v249
    v_add_u32 v250, s49, v250
    ds_read_b32 v252, v251 offset:16
    ds_read_b64_tr_b16 v[64:65], v249 offset:0
    ds_read_b64_tr_b16 v[68:69], v249 offset:64
    ds_read_b64_tr_b16 v[66:67], v249 offset:256
    ds_read_b64_tr_b16 v[70:71], v249 offset:320
    s_mov_b64 exec, s[54:55]
    ds_read_u16_d16_hi v242, v250 offset:0
    s_mov_b64 exec, -1
    v_fmac_f32 v196, v29, v165
    v_fmac_f32 v196, v30, v166
    v_fmac_f32 v196, v31, v167
    s_nop 1
    v_permlane32_swap_b32 v198, v196
    v_add_f32 v196, v198, v196
    s_cmp_eq_u32 s50, 4
    s_cbranch_scc1 LEPI_0
    v_mul_f32 v255, v32, v152
    v_fmac_f32 v255, v33, v153
    v_fmac_f32 v255, v34, v154
    v_fmac_f32 v255, v35, v155
    v_fmac_f32 v255, v36, v156
    v_fmac_f32 v255, v37, v157
    v_fmac_f32 v255, v38, v158
    v_fmac_f32 v255, v39, v159
    v_fma_f32 v203, v40, -v168, v203
    v_fma_f32 v203, v41, -v169, v203
    v_permlane32_swap_b32 v255, v201
    v_fma_f32 v203, v42, -v170, v203
    v_fma_f32 v203, v43, -v171, v203
    v_fma_f32 v203, v44, -v172, v203
    v_fma_f32 v203, v45, -v173, v203
    v_fma_f32 v203, v46, -v174, v203
    v_fma_f32 v203, v47, -v175, v203
    v_add_f32 v201, v255, v201
    v_fmac_f32 v199, v48, v120
    v_permlane32_swap_b32 v203, v255
    v_fmac_f32 v199, v49, v121
    v_fmac_f32 v199, v50, v122
    v_fmac_f32 v199, v51, v123
    v_fmac_f32 v199, v52, v124
    v_fmac_f32 v199, v53, v125
    v_fmac_f32 v199, v54, v126
    v_fmac_f32 v199, v55, v127
    v_add_f32 v255, v203, v255
    v_mul_f32 v197, v56, v168
    v_fmac_f32 v197, v57, v169
    v_fmac_f32 v197, v58, v170
    v_fmac_f32 v197, v59, v171
    v_fmac_f32 v197, v60, v172
    v_fmac_f32 v197, v61, v173
    v_fmac_f32 v197, v62, v174
    v_fmac_f32 v197, v63, v175
    s_nop 1
    v_permlane32_swap_b32 v199, v197
    v_add_f32 v197, v199, v197
    v_cvt_pk_bf16_f32 v200, v200, v201
    v_cvt_pk_bf16_f32 v254, v254, v255
    v_cvt_pk_bf16_f32 v196, v196, v197
    ds_write2st64_b32 v253, v192, v193 offset0:0 offset1:1
    ds_write2st64_b32 v253, v194, v200 offset0:2 offset1:3
    ds_write_b32 v253, v196 offset:1024
    s_mov_b64 exec, 0xffffffff
    ds_write_b32 v253, v254 offset:1280
    s_mov_b64 exec, -1
    s_add_u32 s50, s50, 1
    s_cmp_ge_u32 s50, 4
    s_cbranch_scc1 LAST1
    s_waitcnt lgkmcnt(9)
    v_readfirstlane_b32 s66, v252
    s_add_u32 s53, s53, 1
    v_mov_b32 v252, s53
    s_cmp_le_u32 s53, s66
    ds_write2_b32 v251, v252, v252 offset0:0 offset1:8
    s_setprio 1
    s_cbranch_scc1 PRIO_12
    s_setprio 0
PRIO_12:
    s_cmp_eq_u32 s52, 4
    s_cbranch_scc1 ITEM_1_4
    s_cmp_eq_u32 s52, 5
    s_cbranch_scc1 ITEM_1_5
    s_cmp_eq_u32 s52, 3
    s_cbranch_scc1 ITEM_1_3
    s_cmp_eq_u32 s52, 6
    s_cbranch_scc1 ITEM_1_6
    s_cmp_eq_u32 s52, 8
    s_cbranch_scc1 ITEM_1_8
    s_branch ITEM_1_2
WL_5_0:
    s_add_u32 s66, s51, 0
    buffer_load_dwordx4 v[96:99], v246, s[16:19], s66 offen offset:2048 sc1
    buffer_load_dwordx4 v[100:103], v246, s[16:19], s66 offen offset:3072 sc1
    s_branch WR_5_0
WL_5_1:
    s_add_u32 s66, s51, 4096
    buffer_load_dwordx4 v[104:107], v246, s[16:19], s66 offen offset:2048 sc1
    buffer_load_dwordx4 v[108:111], v246, s[16:19], s66 offen offset:3072 sc1
    s_branch WR_5_1
WL_5_2:
    s_add_u32 s66, s51, 8192
    buffer_load_dwordx4 v[128:131], v246, s[16:19], s66 offen offset:2048 sc1
    buffer_load_dwordx4 v[132:135], v246, s[16:19], s66 offen offset:3072 sc1
    s_branch WR_5_2
WL_5_3:
    s_add_u32 s66, s51, 12288
    buffer_load_dwordx4 v[136:139], v246, s[16:19], s66 offen offset:2048 sc1
    buffer_load_dwordx4 v[140:143], v246, s[16:19], s66 offen offset:3072 sc1
    s_branch WR_5_3
.p2align 6
ITEM_1_3:
    s_mov_b64 exec, s[54:55]
    ds_read_u16_d16_hi v243, v250 offset:128
    s_mov_b64 exec, -1
    ds_read_b64_tr_b16 v[72:73], v249 offset:512
    ds_read_b64_tr_b16 v[76:77], v249 offset:576
    s_waitcnt lgkmcnt(3)
    v_mul_f32_dpp v196, v242, v64 row_newbcast:0 row_mask:0xf bank_mask:0xf
    v_mul_f32_dpp v197, v242, v65 row_newbcast:1 row_mask:0xf bank_mask:0xf
    v_mul_f32_dpp v198, v242, v64 row_newbcast:8 row_mask:0xf bank_mask:0xf
    v_mul_f32_dpp v199, v242, v65 row_newbcast:9 row_mask:0xf bank_mask:0xf
    v_mul_f32_dpp v200, v242, v68 row_newbcast:2 row_mask:0xf bank_mask:0xf
    v_mul_f32_dpp v201, v242, v69 row_newbcast:3 row_mask:0xf bank_mask:0xf
    v_mul_f32_dpp v202, v242, v68 row_newbcast:10 row_mask:0xf bank_mask:0xf
    v_mul_f32_dpp v203, v242, v69 row_newbcast:11 row_mask:0xf bank_mask:0xf
    v_cvt_pk_bf16_f32 v64, v196, v197
    v_cvt_pk_bf16_f32 v68, v198, v199
    v_cvt_pk_bf16_f32 v65, v200, v201
    v_cvt_pk_bf16_f32 v69, v202, v203
    v_mul_f32_dpp v196, v242, v66 row_newbcast:4 row_mask:0xf bank_mask:0xf
    v_mul_f32_dpp v197, v242, v67 row_newbcast:5 row_mask:0xf bank_mask:0xf
    v_mul_f32_dpp v198, v242, v66 row_newbcast:12 row_mask:0xf bank_mask:0xf
    v_mul_f32_dpp v199, v242, v67 row_newbcast:13 row_mask:0xf bank_mask:0xf
    v_mul_f32_dpp v200, v242, v70 row_newbcast:6 row_mask:0xf bank_mask:0xf
    v_mul_f32_dpp v201, v242, v71 row_newbcast:7 row_mask:0xf bank_mask:0xf
    v_mul_f32_dpp v202, v242, v70 row_newbcast:14 row_mask:0xf bank_mask:0xf
    v_mul_f32_dpp v203, v242, v71 row_newbcast:15 row_mask:0xf bank_mask:0xf
    v_cvt_pk_bf16_f32 v66, v196, v197
    v_cvt_pk_bf16_f32 v70, v198, v199
    v_cvt_pk_bf16_f32 v67, v200, v201
    v_cvt_pk_bf16_f32 v71, v202, v203
    s_nop 0
    s_waitcnt vmcnt(4) lgkmcnt(0)
    v_mfma_f32_32x32x16_bf16 v[0:15], v[64:67], v[176:179], 0
    v_mul_f32_dpp v196, v243, v72 row_newbcast:0 row_mask:0xf bank_mask:0xf
    v_mul_f32_dpp v197, v243, v73 row_newbcast:1 row_mask:0xf bank_mask:0xf
    v_mul_f32_dpp v198, v243, v72 row_newbcast:8 row_mask:0xf bank_mask:0xf
    v_mul_f32_dpp v199, v243, v73 row_newbcast:9 row_mask:0xf bank_mask:0xf
    v_mul_f32_dpp v200, v243, v76 row_newbcast:2 row_mask:0xf bank_mask:0xf
    v_mul_f32_dpp v201, v243, v77 row_newbcast:3 row_mask:0xf bank_mask:0xf
    s_add_u32 m0, s21, 0
    v_mfma_f32_32x32x16_bf16 v[16:31], v[68:71], v[176:179], 0
    buffer_load_dwordx4 v234, s[4:7], s36 offen  lds
    buffer_load_dwordx4 v235, s[8:11], s36 offen offset:1024  lds
    ds_read_b64_tr_b16 v[176:177], v244 offset:2048
    ds_read_b64_tr_b16 v[184:185], v245 offset:2048
    v_mul_f32_dpp v202, v243, v76 row_newbcast:10 row_mask:0xf bank_mask:0xf
    v_mul_f32_dpp v203, v243, v77 row_newbcast:11 row_mask:0xf bank_mask:0xf
    v_cvt_pk_bf16_f32 v72, v196, v197
    v_cvt_pk_bf16_f32 v76, v198, v199
    v_cvt_pk_bf16_f32 v73, v200, v201
    v_cvt_pk_bf16_f32 v77, v202, v203
    s_nop 0
    s_waitcnt lgkmcnt(0)
    v_mfma_f32_32x32x8_bf16 v[0:15], v[72:73], v[176:177], v[0:15]
    s_add_u32 m0, s21, 2048
    v_mfma_f32_32x32x8_bf16 v[16:31], v[76:77], v[176:177], v[16:31]
    buffer_load_dwordx4 v236, s[4:7], s36 offen  lds
    s_mov_b32 m0, s50
    s_nop 0
    s_movrels_b32 s71, s23
    s_movrels_b32 s33, s28
    v_add_u32 v253, s33, v248
    s_bfe_u32 s46, s71, 0x30012
    s_mov_b32 m0, s46
    s_and_b32 s66, s71, 0x3ffff
    s_movrels_b32 s68, s57
    s_movrels_b32 s69, s61
    s_sub_u32 s48, s66, s47
    s_mov_b32 s47, s66
    s_lshr_b32 s52, s71, 28
    s_lshl_b32 s67, s46, 9
    s_add_u32 s66, s66, s67
    s_sub_u32 s49, s66, s42
    s_mov_b32 s42, s66
    s_bfe_u32 s66, s68, 655360
    s_add_u32 s43, s42, s66
    s_bfe_u32 s39, s69, 655360
    s_bfe_u32 s66, s68, 655370
    s_add_u32 s44, s42, s66
    s_bfe_u32 s40, s69, 655370
    s_bfe_u32 s66, s68, 655380
    s_add_u32 s45, s42, s66
    s_bfe_u32 s41, s69, 655380
    v_add_u32 v252, s44, v247
    ds_read_u16 v238, v252
    ds_read_u16 v239, v252 offset:64
    v_add_u32 v252, s45, v247
    ds_read_u16 v240, v252
    ds_read_u16 v241, v252 offset:64
    v_mfma_f32_32x32x16_bf16 v[32:47], v[64:67], v[180:183], 0
    v_mul_f32 v196, v0, v96
    v_fmac_f32 v196, v1, v97
    v_fmac_f32 v196, v2, v98
    v_fmac_f32 v196, v3, v99
    v_fmac_f32 v196, v4, v100
    v_fmac_f32 v196, v5, v101
    v_fmac_f32 v196, v6, v102
    v_fmac_f32 v196, v7, v103
    v_mul_f32 v198, v8, v128
    v_fmac_f32 v198, v9, v129
    v_mfma_f32_32x32x16_bf16 v[48:63], v[68:71], v[180:183], 0
    s_waitcnt vmcnt(5)
    ds_read_b64_tr_b16 v[176:177], v244 offset:4096
    ds_read_b64_tr_b16 v[178:179], v244 offset:5120
    ds_read_b64_tr_b16 v[180:181], v245 offset:4096
    ds_read_b64_tr_b16 v[182:183], v245 offset:5120
    v_fmac_f32 v198, v10, v130
    v_fmac_f32 v198, v11, v131
    v_fmac_f32 v198, v12, v132
    v_fmac_f32 v198, v13, v133
    v_fmac_f32 v198, v14, v134
    v_fmac_f32 v198, v15, v135
    v_mul_f32 v200, v16, v128
    v_fmac_f32 v200, v17, v129
    v_permlane32_swap_b32 v196, v198
    v_mfma_f32_32x32x8_bf16 v[32:47], v[72:73], v[184:185], v[32:47]
    v_fmac_f32 v200, v18, v130
    v_fmac_f32 v200, v19, v131
    v_fmac_f32 v200, v20, v132
    v_fmac_f32 v200, v21, v133
    v_fmac_f32 v200, v22, v134
    v_fmac_f32 v200, v23, v135
    v_add_f32 v198, v196, v198
    v_mul_f32_e64 v202, v24, -v128
    v_fma_f32 v202, v25, -v129, v202
    v_mfma_f32_32x32x8_bf16 v[48:63], v[76:77], v[184:185], v[48:63]
    v_fma_f32 v202, v26, -v130, v202
    v_fma_f32 v202, v27, -v131, v202
    v_fma_f32 v202, v28, -v132, v202
    v_fma_f32 v202, v29, -v133, v202
    v_fma_f32 v202, v30, -v134, v202
    v_fma_f32 v202, v31, -v135, v202
    s_nop 1
    v_permlane32_swap_b32 v200, v202
    v_add_f32 v202, v200, v202
    s_waitcnt vmcnt(3) lgkmcnt(0)
    v_mfma_f32_32x32x16_bf16 v[0:15], v[64:67], v[176:179], 0
    v_mul_f32 v197, v32, v104
    v_fmac_f32 v197, v33, v105
    v_fmac_f32 v197, v34, v106
    v_fmac_f32 v197, v35, v107
    v_fmac_f32 v197, v36, v108
    v_fmac_f32 v197, v37, v109
    v_fmac_f32 v197, v38, v110
    v_fmac_f32 v197, v39, v111
    v_mul_f32 v199, v40, v136
    v_fmac_f32 v199, v41, v137
    s_add_u32 m0, s21, 4096
    v_mfma_f32_32x32x16_bf16 v[16:31], v[68:71], v[176:179], 0
    buffer_load_dwordx4 v234, s[4:7], s37 offen  lds
    buffer_load_dwordx4 v235, s[8:11], s37 offen offset:1024  lds
    ds_read_b64_tr_b16 v[176:177], v244 offset:6144
    ds_read_b64_tr_b16 v[184:185], v245 offset:6144
    v_add_u32 v252, s42, v247
    ds_read_u16 v234, v252
    ds_read_u16 v235, v252 offset:64
    v_fmac_f32 v199, v42, v138
    v_fmac_f32 v199, v43, v139
    v_fmac_f32 v199, v44, v140
    v_fmac_f32 v199, v45, v141
    v_fmac_f32 v199, v46, v142
    v_fmac_f32 v199, v47, v143
    v_mul_f32 v201, v48, v136
    v_fmac_f32 v201, v49, v137
    v_permlane32_swap_b32 v197, v199
    v_fmac_f32 v201, v50, v138
    s_waitcnt lgkmcnt(2)
    v_mfma_f32_32x32x8_bf16 v[0:15], v[72:73], v[176:177], v[0:15]
    v_fmac_f32 v201, v51, v139
    v_fmac_f32 v201, v52, v140
    v_fmac_f32 v201, v53, v141
    v_fmac_f32 v201, v54, v142
    v_fmac_f32 v201, v55, v143
    v_add_f32 v199, v197, v199
    v_mul_f32_e64 v203, v56, -v136
    v_fma_f32 v203, v57, -v137, v203
    v_fma_f32 v203, v58, -v138, v203
    v_fma_f32 v203, v59, -v139, v203
    s_add_u32 m0, s21, 6144
    v_mfma_f32_32x32x8_bf16 v[16:31], v[76:77], v[176:177], v[16:31]
    buffer_load_dwordx4 v236, s[4:7], s37 offen  lds
    v_add_u32 v252, s43, v247
    ds_read_u16 v236, v252
    ds_read_u16 v237, v252 offset:64
    v_fma_f32 v203, v60, -v140, v203
    v_fma_f32 v203, v61, -v141, v203
    v_fma_f32 v203, v62, -v142, v203
    v_fma_f32 v203, v63, -v143, v203
    s_nop 1
    v_permlane32_swap_b32 v201, v203
    v_add_f32 v203, v201, v203
    v_cvt_pk_bf16_f32 v192, v198, v199
    v_cvt_pk_bf16_f32 v193, v202, v203
    v_mfma_f32_32x32x16_bf16 v[32:47], v[64:67], v[180:183], 0
    v_mul_f32 v196, v0, v144
    v_fmac_f32 v196, v1, v145
    v_fmac_f32 v196, v2, v146
    v_fmac_f32 v196, v3, v147
    v_fmac_f32 v196, v4, v148
    v_fmac_f32 v196, v5, v149
    v_fmac_f32 v196, v6, v150
    v_fmac_f32 v196, v7, v151
    v_mfma_f32_32x32x16_bf16 v[48:63], v[68:71], v[180:183], 0
    s_waitcnt vmcnt(4)
    ds_read_b64_tr_b16 v[176:177], v244 offset:0
    ds_read_b64_tr_b16 v[178:179], v244 offset:1024
    ds_read_b64_tr_b16 v[180:181], v245 offset:0
    ds_read_b64_tr_b16 v[182:183], v245 offset:1024
    v_mul_f32 v198, v8, v112
    v_fmac_f32 v198, v9, v113
    v_fmac_f32 v198, v10, v114
    v_fmac_f32 v198, v11, v115
    v_fmac_f32 v198, v12, v116
    v_fmac_f32 v198, v13, v117
    v_fmac_f32 v198, v14, v118
    v_fmac_f32 v198, v15, v119
    v_mfma_f32_32x32x8_bf16 v[32:47], v[72:73], v[184:185], v[32:47]
    v_mul_f32_e64 v200, v16, -v160
    v_fma_f32 v200, v17, -v161, v200
    v_fma_f32 v200, v18, -v162, v200
    v_fma_f32 v200, v19, -v163, v200
    v_fma_f32 v200, v20, -v164, v200
    v_fma_f32 v200, v21, -v165, v200
    v_fma_f32 v200, v22, -v166, v200
    v_fma_f32 v200, v23, -v167, v200
    v_mfma_f32_32x32x8_bf16 v[48:63], v[76:77], v[184:185], v[48:63]
    v_mul_f32_e64 v202, v24, -v160
    v_fma_f32 v202, v25, -v161, v202
    v_fma_f32 v202, v26, -v162, v202
    v_fma_f32 v202, v27, -v163, v202
    v_fma_f32 v202, v28, -v164, v202
    v_fma_f32 v202, v29, -v165, v202
    v_fma_f32 v202, v30, -v166, v202
    v_fma_f32 v202, v31, -v167, v202
    s_waitcnt vmcnt(3) lgkmcnt(0)
    v_mfma_f32_32x32x16_bf16 v[0:15], v[64:67], v[176:179], 0
    v_mul_f32 v197, v32, v152
    v_fmac_f32 v197, v33, v153
    v_fmac_f32 v197, v34, v154
    v_fmac_f32 v197, v35, v155
    v_fmac_f32 v197, v36, v156
    v_fmac_f32 v197, v37, v157
    v_fmac_f32 v197, v38, v158
    v_fmac_f32 v197, v39, v159
    s_add_u32 m0, s21, 0
    s_cmp_eq_u32 s50, 4
    v_mfma_f32_32x32x16_bf16 v[16:31], v[68:71], v[176:179], 0
    s_cbranch_scc1 WL_3_0
    v_lshl_add_u32 v234, v234, 10, v246
    v_lshl_add_u32 v235, v235, 10, v246
    buffer_load_dwordx4 v234, s[4:7], s38 offen  lds
    buffer_load_dwordx4 v235, s[8:11], s38 offen offset:1024  lds
WR_3_0:
    ds_read_b64_tr_b16 v[176:177], v244 offset:2048
    ds_read_b64_tr_b16 v[184:185], v245 offset:2048
    v_mul_f32 v199, v40, v120
    v_fmac_f32 v199, v41, v121
    v_fmac_f32 v199, v42, v122
    v_fmac_f32 v199, v43, v123
    v_fmac_f32 v199, v44, v124
    v_fmac_f32 v199, v45, v125
    v_fmac_f32 v199, v46, v126
    v_fmac_f32 v199, v47, v127
    s_waitcnt lgkmcnt(0)
    v_mfma_f32_32x32x8_bf16 v[0:15], v[72:73], v[176:177], v[0:15]
    v_mul_f32_e64 v201, v48, -v168
    v_fma_f32 v201, v49, -v169, v201
    v_fma_f32 v201, v50, -v170, v201
    v_fma_f32 v201, v51, -v171, v201
    v_fma_f32 v201, v52, -v172, v201
    v_fma_f32 v201, v53, -v173, v201
    v_fma_f32 v201, v54, -v174, v201
    v_fma_f32 v201, v55, -v175, v201
    s_add_u32 m0, s21, 2048
    s_cmp_eq_u32 s50, 4
    v_mfma_f32_32x32x8_bf16 v[16:31], v[76:77], v[176:177], v[16:31]
    s_cbranch_scc1 WL_3_1
    v_lshl_add_u32 v236, v236, 10, v246
    v_lshl_add_u32 v237, v237, 10, v246
    buffer_load_dwordx4 v236, s[4:7], s39 offen  lds
    buffer_load_dwordx4 v237, s[8:11], s39 offen offset:1024  lds
WR_3_1:
    v_mul_f32_e64 v203, v56, -v168
    v_fma_f32 v203, v57, -v169, v203
    v_fma_f32 v203, v58, -v170, v203
    v_fma_f32 v203, v59, -v171, v203
    v_fma_f32 v203, v60, -v172, v203
    v_fma_f32 v203, v61, -v173, v203
    v_fma_f32 v203, v62, -v174, v203
    v_fma_f32 v203, v63, -v175, v203
    v_mfma_f32_32x32x16_bf16 v[32:47], v[64:67], v[180:183], 0
    v_mul_f32 v254, v0, v144
    v_fmac_f32 v254, v1, v145
    v_fmac_f32 v254, v2, v146
    v_fmac_f32 v254, v3, v147
    v_fmac_f32 v254, v4, v148
    v_mfma_f32_32x32x16_bf16 v[48:63], v[68:71], v[180:183], 0
    ds_swizzle_b32 v68, v68 offset:0x401F
    ds_swizzle_b32 v69, v69 offset:0x401F
    ds_swizzle_b32 v70, v70 offset:0x401F
    ds_swizzle_b32 v71, v71 offset:0x401F
    s_waitcnt vmcnt(5)
    ds_read_b64_tr_b16 v[176:177], v244 offset:4096
    ds_read_b64_tr_b16 v[178:179], v244 offset:5120
    ds_read_b64_tr_b16 v[180:181], v245 offset:4096
    ds_read_b64_tr_b16 v[182:183], v245 offset:5120
    v_fmac_f32 v254, v5, v149
    v_fmac_f32 v254, v6, v150
    v_fmac_f32 v254, v7, v151
    v_fmac_f32 v200, v8, v160
    v_mfma_f32_32x32x8_bf16 v[32:47], v[72:73], v[184:185], v[32:47]
    v_fmac_f32 v200, v9, v161
    v_permlane32_swap_b32 v196, v254
    v_fmac_f32 v200, v10, v162
    v_fmac_f32 v200, v11, v163
    v_fmac_f32 v200, v12, v164
    v_mfma_f32_32x32x8_bf16 v[48:63], v[76:77], v[184:185], v[48:63]
    ds_swizzle_b32 v76, v76 offset:0x401F
    ds_swizzle_b32 v77, v77 offset:0x401F
    v_fmac_f32 v200, v13, v165
    v_fmac_f32 v200, v14, v166
    v_fmac_f32 v200, v15, v167
    v_add_f32 v254, v196, v254
    s_waitcnt lgkmcnt(6)
    s_mov_b64 exec, s[56:57]
    v_xor_b32 v68, 0x80008000, v68
    v_xor_b32 v69, 0x80008000, v69
    v_xor_b32 v70, 0x80008000, v70
    v_xor_b32 v71, 0x80008000, v71
    s_mov_b64 exec, -1
    s_waitcnt vmcnt(4) lgkmcnt(2)
    v_mfma_f32_32x32x16_bf16 v[0:15], v[64:67], v[176:179], 0
    v_mul_f32 v255, v32, v152
    v_fmac_f32 v255, v33, v153
    v_fmac_f32 v255, v34, v154
    v_fmac_f32 v255, v35, v155
    v_fmac_f32 v255, v36, v156
    s_add_u32 m0, s21, 4096
    s_cmp_eq_u32 s50, 4
    v_mfma_f32_32x32x16_bf16 v[16:31], v[68:71], v[176:179], v[16:31]
    s_cbranch_scc1 WL_3_2
    v_lshl_add_u32 v238, v238, 10, v246
    v_lshl_add_u32 v239, v239, 10, v246
    buffer_load_dwordx4 v238, s[4:7], s40 offen  lds
    buffer_load_dwordx4 v239, s[8:11], s40 offen offset:1024  lds
WR_3_2:
    ds_read_b64_tr_b16 v[176:177], v244 offset:6144
    ds_read_b64_tr_b16 v[184:185], v245 offset:6144
    v_fmac_f32 v255, v37, v157
    v_fmac_f32 v255, v38, v158
    v_fmac_f32 v255, v39, v159
    v_fmac_f32 v201, v40, v168
    v_fmac_f32 v201, v41, v169
    s_waitcnt lgkmcnt(0)
    s_mov_b64 exec, s[56:57]
    v_xor_b32 v76, 0x80008000, v76
    v_xor_b32 v77, 0x80008000, v77
    s_mov_b64 exec, -1
    v_mfma_f32_32x32x8_bf16 v[0:15], v[72:73], v[176:177], v[0:15]
    v_permlane32_swap_b32 v197, v255
    v_fmac_f32 v201, v42, v170
    v_fmac_f32 v201, v43, v171
    v_fmac_f32 v201, v44, v172
    v_fmac_f32 v201, v45, v173
    s_add_u32 m0, s21, 6144
    s_cmp_eq_u32 s50, 4
    v_mfma_f32_32x32x8_bf16 v[16:31], v[76:77], v[176:177], v[16:31]
    s_cbranch_scc1 WL_3_3
    v_lshl_add_u32 v240, v240, 10, v246
    v_lshl_add_u32 v241, v241, 10, v246
    buffer_load_dwordx4 v240, s[4:7], s41 offen  lds
    buffer_load_dwordx4 v241, s[8:11], s41 offen offset:1024  lds
WR_3_3:
    v_fmac_f32 v201, v46, v174
    v_fmac_f32 v201, v47, v175
    v_add_f32 v255, v197, v255
    v_cvt_pk_bf16_f32 v194, v254, v255
    v_mfma_f32_32x32x16_bf16 v[32:47], v[64:67], v[180:183], 0
    v_mul_f32 v254, v0, v144
    v_fmac_f32 v254, v1, v145
    v_fmac_f32 v254, v2, v146
    v_fmac_f32 v254, v3, v147
    v_fmac_f32 v254, v4, v148
    v_fmac_f32 v254, v5, v149
    v_fmac_f32 v254, v6, v150
    v_fmac_f32 v254, v7, v151
    v_fma_f32 v202, v8, -v160, v202
    v_fma_f32 v202, v9, -v161, v202
    v_mfma_f32_32x32x16_bf16 v[48:63], v[68:71], v[180:183], v[48:63]
    s_waitcnt vmcnt(6)
    ds_read_b64_tr_b16 v[176:177], v244 offset:0
    ds_read_b64_tr_b16 v[178:179], v244 offset:1024
    ds_read_b64_tr_b16 v[180:181], v245 offset:0
    ds_read_b64_tr_b16 v[182:183], v245 offset:1024
    v_permlane32_swap_b32 v254, v200
    v_fma_f32 v202, v10, -v162, v202
    v_fma_f32 v202, v11, -v163, v202
    v_fma_f32 v202, v12, -v164, v202
    v_fma_f32 v202, v13, -v165, v202
    v_fma_f32 v202, v14, -v166, v202
    v_fma_f32 v202, v15, -v167, v202
    v_add_f32 v200, v254, v200
    v_fmac_f32 v198, v16, v112
    v_permlane32_swap_b32 v202, v254
    v_mfma_f32_32x32x8_bf16 v[32:47], v[72:73], v[184:185], v[32:47]
    v_fmac_f32 v198, v17, v113
    v_fmac_f32 v198, v18, v114
    v_fmac_f32 v198, v19, v115
    v_fmac_f32 v198, v20, v116
    v_fmac_f32 v198, v21, v117
    v_fmac_f32 v198, v22, v118
    v_fmac_f32 v198, v23, v119
    v_add_f32 v254, v202, v254
    v_mul_f32 v196, v24, v160
    v_fmac_f32 v196, v25, v161
    v_mfma_f32_32x32x8_bf16 v[48:63], v[76:77], v[184:185], v[48:63]
    v_add_u32 v249, s48, v249
    v_add_u32 v250, s49, v250
    ds_read_b32 v252, v251 offset:16
    ds_read_b64_tr_b16 v[64:65], v249 offset:0
    ds_read_b64_tr_b16 v[68:69], v249 offset:64
    ds_read_b64_tr_b16 v[66:67], v249 offset:256
    ds_read_b64_tr_b16 v[70:71], v249 offset:320
    s_mov_b64 exec, s[54:55]
    ds_read_u16_d16_hi v242, v250 offset:0
    s_mov_b64 exec, -1
    v_fmac_f32 v196, v26, v162
    v_fmac_f32 v196, v27, v163
    v_fmac_f32 v196, v28, v164
    v_fmac_f32 v196, v29, v165
    v_fmac_f32 v196, v30, v166
    v_fmac_f32 v196, v31, v167
    s_nop 1
    v_permlane32_swap_b32 v198, v196
    v_add_f32 v196, v198, v196
    s_cmp_eq_u32 s50, 4
    s_cbranch_scc1 LEPI_0
    v_mul_f32 v255, v32, v152
    v_fmac_f32 v255, v33, v153
    v_fmac_f32 v255, v34, v154
    v_fmac_f32 v255, v35, v155
    v_fmac_f32 v255, v36, v156
    v_fmac_f32 v255, v37, v157
    v_fmac_f32 v255, v38, v158
    v_fmac_f32 v255, v39, v159
    v_fma_f32 v203, v40, -v168, v203
    v_fma_f32 v203, v41, -v169, v203
    v_permlane32_swap_b32 v255, v201
    v_fma_f32 v203, v42, -v170, v203
    v_fma_f32 v203, v43, -v171, v203
    v_fma_f32 v203, v44, -v172, v203
    v_fma_f32 v203, v45, -v173, v203
    v_fma_f32 v203, v46, -v174, v203
    v_fma_f32 v203, v47, -v175, v203
    v_add_f32 v201, v255, v201
    v_fmac_f32 v199, v48, v120
    v_permlane32_swap_b32 v203, v255
    v_fmac_f32 v199, v49, v121
    v_fmac_f32 v199, v50, v122
    v_fmac_f32 v199, v51, v123
    v_fmac_f32 v199, v52, v124
    v_fmac_f32 v199, v53, v125
    v_fmac_f32 v199, v54, v126
    v_fmac_f32 v199, v55, v127
    v_add_f32 v255, v203, v255
    v_mul_f32 v197, v56, v168
    v_fmac_f32 v197, v57, v169
    v_fmac_f32 v197, v58, v170
    v_fmac_f32 v197, v59, v171
    v_fmac_f32 v197, v60, v172
    v_fmac_f32 v197, v61, v173
    v_fmac_f32 v197, v62, v174
    v_fmac_f32 v197, v63, v175
    s_nop 1
    v_permlane32_swap_b32 v199, v197
    v_add_f32 v197, v199, v197
    v_cvt_pk_bf16_f32 v200, v200, v201
    v_cvt_pk_bf16_f32 v254, v254, v255
    v_cvt_pk_bf16_f32 v196, v196, v197
    ds_write2st64_b32 v253, v192, v193 offset0:0 offset1:1
    ds_write2st64_b32 v253, v194, v200 offset0:2 offset1:3
    ds_write_b32 v253, v196 offset:1024
    s_mov_b64 exec, 0xffffffff
    ds_write_b32 v253, v254 offset:1280
    s_mov_b64 exec, -1
    s_add_u32 s50, s50, 1
    s_cmp_ge_u32 s50, 4
    s_cbranch_scc1 LAST1
    s_waitcnt lgkmcnt(9)
    v_readfirstlane_b32 s66, v252
    s_add_u32 s53, s53, 1
    v_mov_b32 v252, s53
    s_cmp_le_u32 s53, s66
    ds_write2_b32 v251, v252, v252 offset0:0 offset1:8
    s_setprio 1
    s_cbranch_scc1 PRIO_13
    s_setprio 0
PRIO_13:
    s_cmp_eq_u32 s52, 4
    s_cbranch_scc1 ITEM_1_4
    s_cmp_eq_u32 s52, 5
    s_cbranch_scc1 ITEM_1_5
    s_cmp_eq_u32 s52, 3
    s_cbranch_scc1 ITEM_1_3
    s_cmp_eq_u32 s52, 6
    s_cbranch_scc1 ITEM_1_6
    s_cmp_eq_u32 s52, 8
    s_cbranch_scc1 ITEM_1_8
    s_branch ITEM_1_2
WL_3_0:
    s_add_u32 s66, s51, 0
    buffer_load_dwordx4 v[96:99], v246, s[16:19], s66 offen offset:2048 sc1
    buffer_load_dwordx4 v[100:103], v246, s[16:19], s66 offen offset:3072 sc1
    s_branch WR_3_0
WL_3_1:
    s_add_u32 s66, s51, 4096
    buffer_load_dwordx4 v[104:107], v246, s[16:19], s66 offen offset:2048 sc1
    buffer_load_dwordx4 v[108:111], v246, s[16:19], s66 offen offset:3072 sc1
    s_branch WR_3_1
WL_3_2:
    s_add_u32 s66, s51, 8192
    buffer_load_dwordx4 v[128:131], v246, s[16:19], s66 offen offset:2048 sc1
    buffer_load_dwordx4 v[132:135], v246, s[16:19], s66 offen offset:3072 sc1
    s_branch WR_3_2
WL_3_3:
    s_add_u32 s66, s51, 12288
    buffer_load_dwordx4 v[136:139], v246, s[16:19], s66 offen offset:2048 sc1
    buffer_load_dwordx4 v[140:143], v246, s[16:19], s66 offen offset:3072 sc1
    s_branch WR_3_3
.p2align 6
ITEM_1_6:
    s_mov_b64 exec, s[54:55]
    ds_read_u16_d16_hi v243, v250 offset:128
    s_mov_b64 exec, -1
    ds_read_b64_tr_b16 v[72:73], v249 offset:512
    ds_read_b64_tr_b16 v[76:77], v249 offset:576
    ds_read_b64_tr_b16 v[74:75], v249 offset:768
    ds_read_b64_tr_b16 v[78:79], v249 offset:832
    ds_read_b64_tr_b16 v[80:81], v249 offset:1024
    ds_read_b64_tr_b16 v[84:85], v249 offset:1088
    ds_read_b64_tr_b16 v[82:83], v249 offset:1280
    ds_read_b64_tr_b16 v[86:87], v249 offset:1344
    s_waitcnt lgkmcnt(9)
    v_mul_f32_dpp v196, v242, v64 row_newbcast:0 row_mask:0xf bank_mask:0xf
    v_mul_f32_dpp v197, v242, v65 row_newbcast:1 row_mask:0xf bank_mask:0xf
    v_mul_f32_dpp v198, v242, v64 row_newbcast:8 row_mask:0xf bank_mask:0xf
    v_mul_f32_dpp v199, v242, v65 row_newbcast:9 row_mask:0xf bank_mask:0xf
    v_mul_f32_dpp v200, v242, v68 row_newbcast:2 row_mask:0xf bank_mask:0xf
    v_mul_f32_dpp v201, v242, v69 row_newbcast:3 row_mask:0xf bank_mask:0xf
    v_mul_f32_dpp v202, v242, v68 row_newbcast:10 row_mask:0xf bank_mask:0xf
    v_mul_f32_dpp v203, v242, v69 row_newbcast:11 row_mask:0xf bank_mask:0xf
    v_cvt_pk_bf16_f32 v64, v196, v197
    v_cvt_pk_bf16_f32 v68, v198, v199
    v_cvt_pk_bf16_f32 v65, v200, v201
    v_cvt_pk_bf16_f32 v69, v202, v203
    v_mul_f32_dpp v196, v242, v66 row_newbcast:4 row_mask:0xf bank_mask:0xf
    v_mul_f32_dpp v197, v242, v67 row_newbcast:5 row_mask:0xf bank_mask:0xf
    v_mul_f32_dpp v198, v242, v66 row_newbcast:12 row_mask:0xf bank_mask:0xf
    v_mul_f32_dpp v199, v242, v67 row_newbcast:13 row_mask:0xf bank_mask:0xf
    v_mul_f32_dpp v200, v242, v70 row_newbcast:6 row_mask:0xf bank_mask:0xf
    v_mul_f32_dpp v201, v242, v71 row_newbcast:7 row_mask:0xf bank_mask:0xf
    v_mul_f32_dpp v202, v242, v70 row_newbcast:14 row_mask:0xf bank_mask:0xf
    v_mul_f32_dpp v203, v242, v71 row_newbcast:15 row_mask:0xf bank_mask:0xf
    v_cvt_pk_bf16_f32 v66, v196, v197
    v_cvt_pk_bf16_f32 v70, v198, v199
    v_cvt_pk_bf16_f32 v67, v200, v201
    v_cvt_pk_bf16_f32 v71, v202, v203
    s_mov_b64 exec, s[54:55]
    ds_read_u16_d16_hi v242, v250 offset:256
    s_mov_b64 exec, -1
    s_waitcnt vmcnt(4) lgkmcnt(5)
    v_mfma_f32_32x32x16_bf16 v[0:15], v[64:67], v[176:179], 0
    v_mul_f32_dpp v196, v243, v72 row_newbcast:0 row_mask:0xf bank_mask:0xf
    v_mul_f32_dpp v197, v243, v73 row_newbcast:1 row_mask:0xf bank_mask:0xf
    v_mul_f32_dpp v198, v243, v72 row_newbcast:8 row_mask:0xf bank_mask:0xf
    v_mul_f32_dpp v199, v243, v73 row_newbcast:9 row_mask:0xf bank_mask:0xf
    v_mul_f32_dpp v200, v243, v76 row_newbcast:2 row_mask:0xf bank_mask:0xf
    v_mul_f32_dpp v201, v243, v77 row_newbcast:3 row_mask:0xf bank_mask:0xf
    v_mul_f32_dpp v202, v243, v76 row_newbcast:10 row_mask:0xf bank_mask:0xf
    v_mul_f32_dpp v203, v243, v77 row_newbcast:11 row_mask:0xf bank_mask:0xf
    v_cvt_pk_bf16_f32 v72, v196, v197
    v_cvt_pk_bf16_f32 v76, v198, v199
    v_cvt_pk_bf16_f32 v73, v200, v201
    v_cvt_pk_bf16_f32 v77, v202, v203
    s_add_u32 m0, s21, 0
    v_mfma_f32_32x32x16_bf16 v[16:31], v[68:71], v[176:179], 0
    buffer_load_dwordx4 v236, s[4:7], s35 offen  lds
    buffer_load_dwordx4 v237, s[8:11], s35 offen offset:1024  lds
    ds_read_b64_tr_b16 v[176:177], v244 offset:2048
    ds_read_b64_tr_b16 v[178:179], v244 offset:3072
    ds_read_b64_tr_b16 v[184:185], v245 offset:2048
    ds_read_b64_tr_b16 v[186:187], v245 offset:3072
    v_mul_f32_dpp v196, v243, v74 row_newbcast:4 row_mask:0xf bank_mask:0xf
    v_mul_f32_dpp v197, v243, v75 row_newbcast:5 row_mask:0xf bank_mask:0xf
    v_mul_f32_dpp v198, v243, v74 row_newbcast:12 row_mask:0xf bank_mask:0xf
    v_mul_f32_dpp v199, v243, v75 row_newbcast:13 row_mask:0xf bank_mask:0xf
    v_mul_f32_dpp v200, v243, v78 row_newbcast:6 row_mask:0xf bank_mask:0xf
    v_mul_f32_dpp v201, v243, v79 row_newbcast:7 row_mask:0xf bank_mask:0xf
    v_mul_f32_dpp v202, v243, v78 row_newbcast:14 row_mask:0xf bank_mask:0xf
    v_mul_f32_dpp v203, v243, v79 row_newbcast:15 row_mask:0xf bank_mask:0xf
    v_cvt_pk_bf16_f32 v74, v196, v197
    v_cvt_pk_bf16_f32 v78, v198, v199
    v_cvt_pk_bf16_f32 v75, v200, v201
    v_cvt_pk_bf16_f32 v79, v202, v203
    s_nop 0
    s_waitcnt vmcnt(4) lgkmcnt(0)
    v_mfma_f32_32x32x16_bf16 v[0:15], v[72:75], v[176:179], v[0:15]
    v_mul_f32_dpp v196, v242, v80 row_newbcast:0 row_mask:0xf bank_mask:0xf
    v_mul_f32_dpp v197, v242, v81 row_newbcast:1 row_mask:0xf bank_mask:0xf
    v_mul_f32_dpp v198, v242, v80 row_newbcast:8 row_mask:0xf bank_mask:0xf
    v_mul_f32_dpp v199, v242, v81 row_newbcast:9 row_mask:0xf bank_mask:0xf
    v_mul_f32_dpp v200, v242, v84 row_newbcast:2 row_mask:0xf bank_mask:0xf
    v_mul_f32_dpp v201, v242, v85 row_newbcast:3 row_mask:0xf bank_mask:0xf
    v_mul_f32_dpp v202, v242, v84 row_newbcast:10 row_mask:0xf bank_mask:0xf
    v_mul_f32_dpp v203, v242, v85 row_newbcast:11 row_mask:0xf bank_mask:0xf
    v_cvt_pk_bf16_f32 v80, v196, v197
    v_cvt_pk_bf16_f32 v84, v198, v199
    v_cvt_pk_bf16_f32 v81, v200, v201
    v_cvt_pk_bf16_f32 v85, v202, v203
    s_add_u32 m0, s21, 2048
    v_mfma_f32_32x32x16_bf16 v[16:31], v[76:79], v[176:179], v[16:31]
    buffer_load_dwordx4 v238, s[4:7], s35 offen  lds
    buffer_load_dwordx4 v239, s[8:11], s35 offen offset:1024  lds
    ds_read_b64_tr_b16 v[176:177], v244 offset:4096
    ds_read_b64_tr_b16 v[178:179], v244 offset:5120
    ds_read_b64_tr_b16 v[188:189], v245 offset:4096
    ds_read_b64_tr_b16 v[190:191], v245 offset:5120
    v_mul_f32_dpp v196, v242, v82 row_newbcast:4 row_mask:0xf bank_mask:0xf
    v_mul_f32_dpp v197, v242, v83 row_newbcast:5 row_mask:0xf bank_mask:0xf
    v_mul_f32_dpp v198, v242, v82 row_newbcast:12 row_mask:0xf bank_mask:0xf
    v_mul_f32_dpp v199, v242, v83 row_newbcast:13 row_mask:0xf bank_mask:0xf
    v_mul_f32_dpp v200, v242, v86 row_newbcast:6 row_mask:0xf bank_mask:0xf
    v_mul_f32_dpp v201, v242, v87 row_newbcast:7 row_mask:0xf bank_mask:0xf
    v_mul_f32_dpp v202, v242, v86 row_newbcast:14 row_mask:0xf bank_mask:0xf
    v_mul_f32_dpp v203, v242, v87 row_newbcast:15 row_mask:0xf bank_mask:0xf
    v_cvt_pk_bf16_f32 v82, v196, v197
    v_cvt_pk_bf16_f32 v86, v198, v199
    v_cvt_pk_bf16_f32 v83, v200, v201
    v_cvt_pk_bf16_f32 v87, v202, v203
    s_nop 0
    s_waitcnt lgkmcnt(0)
    v_mfma_f32_32x32x16_bf16 v[0:15], v[80:83], v[176:179], v[0:15]
    s_add_u32 m0, s21, 4096
    v_mfma_f32_32x32x16_bf16 v[16:31], v[84:87], v[176:179], v[16:31]
    buffer_load_dwordx4 v234, s[4:7], s36 offen  lds
    buffer_load_dwordx4 v235, s[8:11], s36 offen offset:1024  lds
    s_mov_b32 m0, s50
    s_nop 0
    s_movrels_b32 s71, s23
    s_movrels_b32 s33, s28
    v_add_u32 v253, s33, v248
    s_bfe_u32 s46, s71, 0x30012
    s_mov_b32 m0, s46
    s_and_b32 s66, s71, 0x3ffff
    s_movrels_b32 s68, s57
    s_movrels_b32 s69, s61
    s_sub_u32 s48, s66, s47
    s_mov_b32 s47, s66
    s_lshr_b32 s52, s71, 28
    s_lshl_b32 s67, s46, 9
    s_add_u32 s66, s66, s67
    s_sub_u32 s49, s66, s42
    s_mov_b32 s42, s66
    s_bfe_u32 s66, s68, 655360
    s_add_u32 s43, s42, s66
    s_bfe_u32 s39, s69, 655360
    s_bfe_u32 s66, s68, 655370
    s_add_u32 s44, s42, s66
    s_bfe_u32 s40, s69, 655370
    s_bfe_u32 s66, s68, 655380
    s_add_u32 s45, s42, s66
    s_bfe_u32 s41, s69, 655380
    v_add_u32 v252, s45, v247
    ds_read_u16 v240, v252
    ds_read_u16 v241, v252 offset:64
    v_mfma_f32_32x32x16_bf16 v[32:47], v[64:67], v[180:183], 0
    v_mul_f32 v196, v0, v96
    v_fmac_f32 v196, v1, v97
    v_fmac_f32 v196, v2, v98
    v_fmac_f32 v196, v3, v99
    v_fmac_f32 v196, v4, v100
    v_fmac_f32 v196, v5, v101
    v_fmac_f32 v196, v6, v102
    v_mfma_f32_32x32x16_bf16 v[48:63], v[68:71], v[180:183], 0
    v_fmac_f32 v196, v7, v103
    v_mul_f32 v198, v8, v128
    v_fmac_f32 v198, v9, v129
    v_fmac_f32 v198, v10, v130
    v_fmac_f32 v198, v11, v131
    v_fmac_f32 v198, v12, v132
    v_mfma_f32_32x32x16_bf16 v[32:47], v[72:75], v[184:187], v[32:47]
    v_fmac_f32 v198, v13, v133
    v_fmac_f32 v198, v14, v134
    v_fmac_f32 v198, v15, v135
    v_mul_f32 v200, v16, v128
    v_fmac_f32 v200, v17, v129
    v_permlane32_swap_b32 v196, v198
    v_mfma_f32_32x32x16_bf16 v[48:63], v[76:79], v[184:187], v[48:63]
    s_waitcnt vmcnt(6)
    ds_read_b64_tr_b16 v[176:177], v244 offset:6144
    ds_read_b64_tr_b16 v[178:179], v244 offset:7168
    ds_read_b64_tr_b16 v[180:181], v245 offset:6144
    ds_read_b64_tr_b16 v[182:183], v245 offset:7168
    v_fmac_f32 v200, v18, v130
    v_fmac_f32 v200, v19, v131
    v_fmac_f32 v200, v20, v132
    v_fmac_f32 v200, v21, v133
    v_fmac_f32 v200, v22, v134
    v_fmac_f32 v200, v23, v135
    v_mfma_f32_32x32x16_bf16 v[32:47], v[80:83], v[188:191], v[32:47]
    v_add_f32 v198, v196, v198
    v_mul_f32_e64 v202, v24, -v128
    v_fma_f32 v202, v25, -v129, v202
    v_fma_f32 v202, v26, -v130, v202
    v_fma_f32 v202, v27, -v131, v202
    v_fma_f32 v202, v28, -v132, v202
    v_mfma_f32_32x32x16_bf16 v[48:63], v[84:87], v[188:191], v[48:63]
    v_fma_f32 v202, v29, -v133, v202
    v_fma_f32 v202, v30, -v134, v202
    v_fma_f32 v202, v31, -v135, v202
    s_nop 1
    v_permlane32_swap_b32 v200, v202
    v_add_f32 v202, v200, v202
    s_waitcnt vmcnt(4) lgkmcnt(0)
    v_mfma_f32_32x32x16_bf16 v[0:15], v[64:67], v[176:179], 0
    v_mul_f32 v197, v32, v104
    v_fmac_f32 v197, v33, v105
    v_fmac_f32 v197, v34, v106
    v_fmac_f32 v197, v35, v107
    v_fmac_f32 v197, v36, v108
    v_fmac_f32 v197, v37, v109
    v_fmac_f32 v197, v38, v110
    s_add_u32 m0, s21, 6144
    v_mfma_f32_32x32x16_bf16 v[16:31], v[68:71], v[176:179], 0
    buffer_load_dwordx4 v236, s[4:7], s36 offen  lds
    buffer_load_dwordx4 v237, s[8:11], s36 offen offset:1024  lds
    ds_read_b64_tr_b16 v[176:177], v244 offset:0
    ds_read_b64_tr_b16 v[178:179], v244 offset:1024
    ds_read_b64_tr_b16 v[184:185], v245 offset:0
    ds_read_b64_tr_b16 v[186:187], v245 offset:1024
    v_fmac_f32 v197, v39, v111
    v_mul_f32 v199, v40, v136
    v_fmac_f32 v199, v41, v137
    v_fmac_f32 v199, v42, v138
    v_fmac_f32 v199, v43, v139
    v_fmac_f32 v199, v44, v140
    s_waitcnt vmcnt(4) lgkmcnt(0)
    v_mfma_f32_32x32x16_bf16 v[0:15], v[72:75], v[176:179], v[0:15]
    v_fmac_f32 v199, v45, v141
    v_fmac_f32 v199, v46, v142
    v_fmac_f32 v199, v47, v143
    v_mul_f32 v201, v48, v136
    v_fmac_f32 v201, v49, v137
    v_permlane32_swap_b32 v197, v199
    v_fmac_f32 v201, v50, v138
    s_add_u32 m0, s21, 0
    v_mfma_f32_32x32x16_bf16 v[16:31], v[76:79], v[176:179], v[16:31]
    buffer_load_dwordx4 v238, s[4:7], s36 offen  lds
    buffer_load_dwordx4 v239, s[8:11], s36 offen offset:1024  lds
    ds_read_b64_tr_b16 v[176:177], v244 offset:2048
    ds_read_b64_tr_b16 v[178:179], v244 offset:3072
    ds_read_b64_tr_b16 v[188:189], v245 offset:2048
    ds_read_b64_tr_b16 v[190:191], v245 offset:3072
    v_fmac_f32 v201, v51, v139
    v_fmac_f32 v201, v52, v140
    v_fmac_f32 v201, v53, v141
    v_fmac_f32 v201, v54, v142
    v_fmac_f32 v201, v55, v143
    v_add_f32 v199, v197, v199
    s_waitcnt lgkmcnt(0)
    v_mfma_f32_32x32x16_bf16 v[0:15], v[80:83], v[176:179], v[0:15]
    v_mul_f32_e64 v203, v56, -v136
    v_fma_f32 v203, v57, -v137, v203
    v_fma_f32 v203, v58, -v138, v203
    v_fma_f32 v203, v59, -v139, v203
    v_fma_f32 v203, v60, -v140, v203
    v_fma_f32 v203, v61, -v141, v203
    v_fma_f32 v203, v62, -v142, v203
    s_add_u32 m0, s21, 2048
    v_mfma_f32_32x32x16_bf16 v[16:31], v[84:87], v[176:179], v[16:31]
    buffer_load_dwordx4 v234, s[4:7], s37 offen  lds
    buffer_load_dwordx4 v235, s[8:11], s37 offen offset:1024  lds
    v_add_u32 v252, s42, v247
    ds_read_u16 v234, v252
    ds_read_u16 v235, v252 offset:64
    v_fma_f32 v203, v63, -v143, v203
    s_nop 1
    v_permlane32_swap_b32 v201, v203
    v_add_f32 v203, v201, v203
    v_cvt_pk_bf16_f32 v192, v198, v199
    v_cvt_pk_bf16_f32 v193, v202, v203
    v_mfma_f32_32x32x16_bf16 v[32:47], v[64:67], v[180:183], 0
    v_mul_f32 v196, v0, v144
    v_fmac_f32 v196, v1, v145
    v_fmac_f32 v196, v2, v146
    v_fmac_f32 v196, v3, v147
    v_fmac_f32 v196, v4, v148
    v_fmac_f32 v196, v5, v149
    v_mfma_f32_32x32x16_bf16 v[48:63], v[68:71], v[180:183], 0
    v_fmac_f32 v196, v6, v150
    v_fmac_f32 v196, v7, v151
    v_mul_f32 v198, v8, v112
    v_fmac_f32 v198, v9, v113
    v_fmac_f32 v198, v10, v114
    v_mfma_f32_32x32x16_bf16 v[32:47], v[72:75], v[184:187], v[32:47]
    v_fmac_f32 v198, v11, v115
    v_fmac_f32 v198, v12, v116
    v_fmac_f32 v198, v13, v117
    v_fmac_f32 v198, v14, v118
    v_fmac_f32 v198, v15, v119
    v_mfma_f32_32x32x16_bf16 v[48:63], v[76:79], v[184:187], v[48:63]
    s_waitcnt vmcnt(6)
    ds_read_b64_tr_b16 v[176:177], v244 offset:4096
    ds_read_b64_tr_b16 v[178:179], v244 offset:5120
    ds_read_b64_tr_b16 v[180:181], v245 offset:4096
    ds_read_b64_tr_b16 v[182:183], v245 offset:5120
    v_mul_f32_e64 v200, v16, -v160
    v_fma_f32 v200, v17, -v161, v200
    v_fma_f32 v200, v18, -v162, v200
    v_fma_f32 v200, v19, -v163, v200
    v_fma_f32 v200, v20, -v164, v200
    v_fma_f32 v200, v21, -v165, v200
    v_mfma_f32_32x32x16_bf16 v[32:47], v[80:83], v[188:191], v[32:47]
    v_fma_f32 v200, v22, -v166, v200
    v_fma_f32 v200, v23, -v167, v200
    v_mul_f32_e64 v202, v24, -v160
    v_fma_f32 v202, v25, -v161, v202
    v_fma_f32 v202, v26, -v162, v202
    v_mfma_f32_32x32x16_bf16 v[48:63], v[84:87], v[188:191], v[48:63]
    v_fma_f32 v202, v27, -v163, v202
    v_fma_f32 v202, v28, -v164, v202
    v_fma_f32 v202, v29, -v165, v202
    v_fma_f32 v202, v30, -v166, v202
    v_fma_f32 v202, v31, -v167, v202
    s_waitcnt vmcnt(4) lgkmcnt(0)
    v_mfma_f32_32x32x16_bf16 v[0:15], v[64:67], v[176:179], 0
    v_mul_f32 v197, v32, v152
    v_fmac_f32 v197, v33, v153
    v_fmac_f32 v197, v34, v154
    v_fmac_f32 v197, v35, v155
    v_fmac_f32 v197, v36, v156
    v_fmac_f32 v197, v37, v157
    s_add_u32 m0, s21, 4096
    v_mfma_f32_32x32x16_bf16 v[16:31], v[68:71], v[176:179], 0
    buffer_load_dwordx4 v236, s[4:7], s37 offen  lds
    buffer_load_dwordx4 v237, s[8:11], s37 offen offset:1024  lds
    ds_read_b64_tr_b16 v[176:177], v244 offset:6144
    ds_read_b64_tr_b16 v[178:179], v244 offset:7168
    ds_read_b64_tr_b16 v[184:185], v245 offset:6144
    ds_read_b64_tr_b16 v[186:187], v245 offset:7168
    v_add_u32 v252, s43, v247
    ds_read_u16 v236, v252
    ds_read_u16 v237, v252 offset:64
    v_fmac_f32 v197, v38, v158
    v_fmac_f32 v197, v39, v159
    v_mul_f32 v199, v40, v120
    v_fmac_f32 v199, v41, v121
    v_fmac_f32 v199, v42, v122
    s_waitcnt vmcnt(4) lgkmcnt(2)
    v_mfma_f32_32x32x16_bf16 v[0:15], v[72:75], v[176:179], v[0:15]
    v_fmac_f32 v199, v43, v123
    v_fmac_f32 v199, v44, v124
    v_fmac_f32 v199, v45, v125
    v_fmac_f32 v199, v46, v126
    v_fmac_f32 v199, v47, v127
    s_add_u32 m0, s21, 6144
    v_mfma_f32_32x32x16_bf16 v[16:31], v[76:79], v[176:179], v[16:31]
    buffer_load_dwordx4 v238, s[4:7], s37 offen  lds
    buffer_load_dwordx4 v239, s[8:11], s37 offen offset:1024  lds
    ds_read_b64_tr_b16 v[176:177], v244 offset:0
    ds_read_b64_tr_b16 v[178:179], v244 offset:1024
    ds_read_b64_tr_b16 v[188:189], v245 offset:0
    ds_read_b64_tr_b16 v[190:191], v245 offset:1024
    v_add_u32 v252, s44, v247
    ds_read_u16 v238, v252
    ds_read_u16 v239, v252 offset:64
    v_mul_f32_e64 v201, v48, -v168
    v_fma_f32 v201, v49, -v169, v201
    v_fma_f32 v201, v50, -v170, v201
    v_fma_f32 v201, v51, -v171, v201
    v_fma_f32 v201, v52, -v172, v201
    v_fma_f32 v201, v53, -v173, v201
    s_waitcnt lgkmcnt(2)
    v_mfma_f32_32x32x16_bf16 v[0:15], v[80:83], v[176:179], v[0:15]
    v_fma_f32 v201, v54, -v174, v201
    v_fma_f32 v201, v55, -v175, v201
    v_mul_f32_e64 v203, v56, -v168
    v_fma_f32 v203, v57, -v169, v203
    v_fma_f32 v203, v58, -v170, v203
    s_add_u32 m0, s21, 0
    s_cmp_eq_u32 s50, 4
    v_mfma_f32_32x32x16_bf16 v[16:31], v[84:87], v[176:179], v[16:31]
    s_cbranch_scc1 WL_6_0
    v_lshl_add_u32 v234, v234, 10, v246
    v_lshl_add_u32 v235, v235, 10, v246
    buffer_load_dwordx4 v234, s[4:7], s38 offen  lds
    buffer_load_dwordx4 v235, s[8:11], s38 offen offset:1024  lds
WR_6_0:
    v_fma_f32 v203, v59, -v171, v203
    v_fma_f32 v203, v60, -v172, v203
    v_fma_f32 v203, v61, -v173, v203
    v_fma_f32 v203, v62, -v174, v203
    v_fma_f32 v203, v63, -v175, v203
    v_mfma_f32_32x32x16_bf16 v[32:47], v[64:67], v[180:183], 0
    v_mul_f32 v254, v0, v144
    v_fmac_f32 v254, v1, v145
    v_fmac_f32 v254, v2, v146
    v_mfma_f32_32x32x16_bf16 v[48:63], v[68:71], v[180:183], 0
    ds_swizzle_b32 v68, v68 offset:0x401F
    ds_swizzle_b32 v69, v69 offset:0x401F
    ds_swizzle_b32 v70, v70 offset:0x401F
    ds_swizzle_b32 v71, v71 offset:0x401F
    v_fmac_f32 v254, v3, v147
    v_fmac_f32 v254, v4, v148
    v_fmac_f32 v254, v5, v149
    v_mfma_f32_32x32x16_bf16 v[32:47], v[72:75], v[184:187], v[32:47]
    v_fmac_f32 v254, v6, v150
    v_fmac_f32 v254, v7, v151
    v_fmac_f32 v200, v8, v160
    v_mfma_f32_32x32x16_bf16 v[48:63], v[76:79], v[184:187], v[48:63]
    ds_swizzle_b32 v76, v76 offset:0x401F
    ds_swizzle_b32 v77, v77 offset:0x401F
    ds_swizzle_b32 v78, v78 offset:0x401F
    ds_swizzle_b32 v79, v79 offset:0x401F
    s_waitcnt vmcnt(6)
    ds_read_b64_tr_b16 v[176:177], v244 offset:2048
    ds_read_b64_tr_b16 v[178:179], v244 offset:3072
    ds_read_b64_tr_b16 v[180:181], v245 offset:2048
    ds_read_b64_tr_b16 v[182:183], v245 offset:3072
    v_fmac_f32 v200, v9, v161
    v_permlane32_swap_b32 v196, v254
    v_fmac_f32 v200, v10, v162
    v_mfma_f32_32x32x16_bf16 v[32:47], v[80:83], v[188:191], v[32:47]
    v_fmac_f32 v200, v11, v163
    v_fmac_f32 v200, v12, v164
    v_fmac_f32 v200, v13, v165
    v_mfma_f32_32x32x16_bf16 v[48:63], v[84:87], v[188:191], v[48:63]
    ds_swizzle_b32 v84, v84 offset:0x401F
    ds_swizzle_b32 v85, v85 offset:0x401F
    ds_swizzle_b32 v86, v86 offset:0x401F
    ds_swizzle_b32 v87, v87 offset:0x401F
    v_fmac_f32 v200, v14, v166
    v_fmac_f32 v200, v15, v167
    v_add_f32 v254, v196, v254
    s_waitcnt lgkmcnt(8)
    s_mov_b64 exec, s[56:57]
    v_xor_b32 v68, 0x80008000, v68
    v_xor_b32 v69, 0x80008000, v69
    v_xor_b32 v70, 0x80008000, v70
    v_xor_b32 v71, 0x80008000, v71
    v_xor_b32 v76, 0x80008000, v76
    v_xor_b32 v77, 0x80008000, v77
    v_xor_b32 v78, 0x80008000, v78
    v_xor_b32 v79, 0x80008000, v79
    s_mov_b64 exec, -1
    s_waitcnt vmcnt(4) lgkmcnt(4)
    v_mfma_f32_32x32x16_bf16 v[0:15], v[64:67], v[176:179], 0
    v_mul_f32 v255, v32, v152
    v_fmac_f32 v255, v33, v153
    v_fmac_f32 v255, v34, v154
    v_fmac_f32 v255, v35, v155
    s_add_u32 m0, s21, 2048
    s_cmp_eq_u32 s50, 4
    v_mfma_f32_32x32x16_bf16 v[16:31], v[68:71], v[176:179], v[16:31]
    s_cbranch_scc1 WL_6_1
    v_lshl_add_u32 v236, v236, 10, v246
    v_lshl_add_u32 v237, v237, 10, v246
    buffer_load_dwordx4 v236, s[4:7], s39 offen  lds
    buffer_load_dwordx4 v237, s[8:11], s39 offen offset:1024  lds
WR_6_1:
    ds_read_b64_tr_b16 v[176:177], v244 offset:4096
    ds_read_b64_tr_b16 v[178:179], v244 offset:5120
    ds_read_b64_tr_b16 v[184:185], v245 offset:4096
    ds_read_b64_tr_b16 v[186:187], v245 offset:5120
    v_fmac_f32 v255, v36, v156
    v_fmac_f32 v255, v37, v157
    v_fmac_f32 v255, v38, v158
    s_waitcnt vmcnt(4) lgkmcnt(0)
    v_mfma_f32_32x32x16_bf16 v[0:15], v[72:75], v[176:179], v[0:15]
    v_fmac_f32 v255, v39, v159
    v_fmac_f32 v201, v40, v168
    v_fmac_f32 v201, v41, v169
    s_add_u32 m0, s21, 4096
    s_cmp_eq_u32 s50, 4
    v_mfma_f32_32x32x16_bf16 v[16:31], v[76:79], v[176:179], v[16:31]
    s_cbranch_scc1 WL_6_2
    v_lshl_add_u32 v238, v238, 10, v246
    v_lshl_add_u32 v239, v239, 10, v246
    buffer_load_dwordx4 v238, s[4:7], s40 offen  lds
    buffer_load_dwordx4 v239, s[8:11], s40 offen offset:1024  lds
WR_6_2:
    ds_read_b64_tr_b16 v[176:177], v244 offset:6144
    ds_read_b64_tr_b16 v[178:179], v244 offset:7168
    ds_read_b64_tr_b16 v[188:189], v245 offset:6144
    ds_read_b64_tr_b16 v[190:191], v245 offset:7168
    v_permlane32_swap_b32 v197, v255
    v_fmac_f32 v201, v42, v170
    v_fmac_f32 v201, v43, v171
    s_waitcnt lgkmcnt(0)
    s_mov_b64 exec, s[56:57]
    v_xor_b32 v84, 0x80008000, v84
    v_xor_b32 v85, 0x80008000, v85
    v_xor_b32 v86, 0x80008000, v86
    v_xor_b32 v87, 0x80008000, v87
    s_mov_b64 exec, -1
    v_mfma_f32_32x32x16_bf16 v[0:15], v[80:83], v[176:179], v[0:15]
    v_fmac_f32 v201, v44, v172
    v_fmac_f32 v201, v45, v173
    v_fmac_f32 v201, v46, v174
    s_add_u32 m0, s21, 6144
    s_cmp_eq_u32 s50, 4
    v_mfma_f32_32x32x16_bf16 v[16:31], v[84:87], v[176:179], v[16:31]
    s_cbranch_scc1 WL_6_3
    v_lshl_add_u32 v240, v240, 10, v246
    v_lshl_add_u32 v241, v241, 10, v246
    buffer_load_dwordx4 v240, s[4:7], s41 offen  lds
    buffer_load_dwordx4 v241, s[8:11], s41 offen offset:1024  lds
WR_6_3:
    v_fmac_f32 v201, v47, v175
    v_add_f32 v255, v197, v255
    v_cvt_pk_bf16_f32 v194, v254, v255
    v_mfma_f32_32x32x16_bf16 v[32:47], v[64:67], v[180:183], 0
    v_mul_f32 v254, v0, v144
    v_fmac_f32 v254, v1, v145
    v_fmac_f32 v254, v2, v146
    v_fmac_f32 v254, v3, v147
    v_fmac_f32 v254, v4, v148
    v_fmac_f32 v254, v5, v149
    v_fmac_f32 v254, v6, v150
    v_mfma_f32_32x32x16_bf16 v[48:63], v[68:71], v[180:183], v[48:63]
    v_fmac_f32 v254, v7, v151
    v_fma_f32 v202, v8, -v160, v202
    v_fma_f32 v202, v9, -v161, v202
    v_permlane32_swap_b32 v254, v200
    v_fma_f32 v202, v10, -v162, v202
    v_fma_f32 v202, v11, -v163, v202
    v_mfma_f32_32x32x16_bf16 v[32:47], v[72:75], v[184:187], v[32:47]
    v_fma_f32 v202, v12, -v164, v202
    v_fma_f32 v202, v13, -v165, v202
    v_fma_f32 v202, v14, -v166, v202
    v_fma_f32 v202, v15, -v167, v202
    v_add_f32 v200, v254, v200
    v_fmac_f32 v198, v16, v112
    v_permlane32_swap_b32 v202, v254
    v_mfma_f32_32x32x16_bf16 v[48:63], v[76:79], v[184:187], v[48:63]
    s_waitcnt vmcnt(6)
    ds_read_b64_tr_b16 v[176:177], v244 offset:0
    ds_read_b64_tr_b16 v[178:179], v244 offset:1024
    ds_read_b64_tr_b16 v[180:181], v245 offset:0
    ds_read_b64_tr_b16 v[182:183], v245 offset:1024
    v_fmac_f32 v198, v17, v113
    v_fmac_f32 v198, v18, v114
    v_fmac_f32 v198, v19, v115
    v_fmac_f32 v198, v20, v116
    v_fmac_f32 v198, v21, v117
    v_fmac_f32 v198, v22, v118
    v_mfma_f32_32x32x16_bf16 v[32:47], v[80:83], v[188:191], v[32:47]
    v_fmac_f32 v198, v23, v119
    v_add_f32 v254, v202, v254
    v_mul_f32 v196, v24, v160
    v_fmac_f32 v196, v25, v161
    v_fmac_f32 v196, v26, v162
    v_fmac_f32 v196, v27, v163
    v_fmac_f32 v196, v28, v164
    v_mfma_f32_32x32x16_bf16 v[48:63], v[84:87], v[188:191], v[48:63]
    v_add_u32 v249, s48, v249
    v_add_u32 v250, s49, v250
    ds_read_b32 v252, v251 offset:16
    ds_read_b64_tr_b16 v[64:65], v249 offset:0
    ds_read_b64_tr_b16 v[68:69], v249 offset:64
    ds_read_b64_tr_b16 v[66:67], v249 offset:256
    ds_read_b64_tr_b16 v[70:71], v249 offset:320
    s_mov_b64 exec, s[54:55]
    ds_read_u16_d16_hi v242, v250 offset:0
    s_mov_b64 exec, -1
    v_fmac_f32 v196, v29, v165
    v_fmac_f32 v196, v30, v166
    v_fmac_f32 v196, v31, v167
    s_nop 1
    v_permlane32_swap_b32 v198, v196
    v_add_f32 v196, v198, v196
    s_cmp_eq_u32 s50, 4
    s_cbranch_scc1 LEPI_0
    v_mul_f32 v255, v32, v152
    v_fmac_f32 v255, v33, v153
    v_fmac_f32 v255, v34, v154
    v_fmac_f32 v255, v35, v155
    v_fmac_f32 v255, v36, v156
    v_fmac_f32 v255, v37, v157
    v_fmac_f32 v255, v38, v158
    v_fmac_f32 v255, v39, v159
    v_fma_f32 v203, v40, -v168, v203
    v_fma_f32 v203, v41, -v169, v203
    v_permlane32_swap_b32 v255, v201
    v_fma_f32 v203, v42, -v170, v203
    v_fma_f32 v203, v43, -v171, v203
    v_fma_f32 v203, v44, -v172, v203
    v_fma_f32 v203, v45, -v173, v203
    v_fma_f32 v203, v46, -v174, v203
    v_fma_f32 v203, v47, -v175, v203
    v_add_f32 v201, v255, v201
    v_fmac_f32 v199, v48, v120
    v_permlane32_swap_b32 v203, v255
    v_fmac_f32 v199, v49, v121
    v_fmac_f32 v199, v50, v122
    v_fmac_f32 v199, v51, v123
    v_fmac_f32 v199, v52, v124
    v_fmac_f32 v199, v53, v125
    v_fmac_f32 v199, v54, v126
    v_fmac_f32 v199, v55, v127
    v_add_f32 v255, v203, v255
    v_mul_f32 v197, v56, v168
    v_fmac_f32 v197, v57, v169
    v_fmac_f32 v197, v58, v170
    v_fmac_f32 v197, v59, v171
    v_fmac_f32 v197, v60, v172
    v_fmac_f32 v197, v61, v173
    v_fmac_f32 v197, v62, v174
    v_fmac_f32 v197, v63, v175
    s_nop 1
    v_permlane32_swap_b32 v199, v197
    v_add_f32 v197, v199, v197
    v_cvt_pk_bf16_f32 v200, v200, v201
    v_cvt_pk_bf16_f32 v254, v254, v255
    v_cvt_pk_bf16_f32 v196, v196, v197
    ds_write2st64_b32 v253, v192, v193 offset0:0 offset1:1
    ds_write2st64_b32 v253, v194, v200 offset0:2 offset1:3
    ds_write_b32 v253, v196 offset:1024
    s_mov_b64 exec, 0xffffffff
    ds_write_b32 v253, v254 offset:1280
    s_mov_b64 exec, -1
    s_add_u32 s50, s50, 1
    s_cmp_ge_u32 s50, 4
    s_cbranch_scc1 LAST1
    s_waitcnt lgkmcnt(9)
    v_readfirstlane_b32 s66, v252
    s_add_u32 s53, s53, 1
    v_mov_b32 v252, s53
    s_cmp_le_u32 s53, s66
    ds_write2_b32 v251, v252, v252 offset0:0 offset1:8
    s_setprio 1
    s_cbranch_scc1 PRIO_14
    s_setprio 0
PRIO_14:
    s_cmp_eq_u32 s52, 4
    s_cbranch_scc1 ITEM_1_4
    s_cmp_eq_u32 s52, 5
    s_cbranch_scc1 ITEM_1_5
    s_cmp_eq_u32 s52, 3
    s_cbranch_scc1 ITEM_1_3
    s_cmp_eq_u32 s52, 6
    s_cbranch_scc1 ITEM_1_6
    s_cmp_eq_u32 s52, 8
    s_cbranch_scc1 ITEM_1_8
    s_branch ITEM_1_2
WL_6_0:
    s_add_u32 s66, s51, 0
    buffer_load_dwordx4 v[96:99], v246, s[16:19], s66 offen offset:2048 sc1
    buffer_load_dwordx4 v[100:103], v246, s[16:19], s66 offen offset:3072 sc1
    s_branch WR_6_0
WL_6_1:
    s_add_u32 s66, s51, 4096
    buffer_load_dwordx4 v[104:107], v246, s[16:19], s66 offen offset:2048 sc1
    buffer_load_dwordx4 v[108:111], v246, s[16:19], s66 offen offset:3072 sc1
    s_branch WR_6_1
WL_6_2:
    s_add_u32 s66, s51, 8192
    buffer_load_dwordx4 v[128:131], v246, s[16:19], s66 offen offset:2048 sc1
    buffer_load_dwordx4 v[132:135], v246, s[16:19], s66 offen offset:3072 sc1
    s_branch WR_6_2
WL_6_3:
    s_add_u32 s66, s51, 12288
    buffer_load_dwordx4 v[136:139], v246, s[16:19], s66 offen offset:2048 sc1
    buffer_load_dwordx4 v[140:143], v246, s[16:19], s66 offen offset:3072 sc1
    s_branch WR_6_3
.p2align 6
ITEM_1_8:
    s_mov_b64 exec, s[54:55]
    ds_read_u16_d16_hi v243, v250 offset:128
    s_mov_b64 exec, -1
    ds_read_b64_tr_b16 v[72:73], v249 offset:512
    ds_read_b64_tr_b16 v[76:77], v249 offset:576
    ds_read_b64_tr_b16 v[74:75], v249 offset:768
    ds_read_b64_tr_b16 v[78:79], v249 offset:832
    ds_read_b64_tr_b16 v[80:81], v249 offset:1024
    ds_read_b64_tr_b16 v[84:85], v249 offset:1088
    ds_read_b64_tr_b16 v[82:83], v249 offset:1280
    ds_read_b64_tr_b16 v[86:87], v249 offset:1344
    ds_read_b64_tr_b16 v[88:89], v249 offset:1536
    ds_read_b64_tr_b16 v[92:93], v249 offset:1600
    ds_read_b64_tr_b16 v[90:91], v249 offset:1792
    ds_read_b64_tr_b16 v[94:95], v249 offset:1856
    s_waitcnt lgkmcnt(13)
    v_mul_f32_dpp v196, v242, v64 row_newbcast:0 row_mask:0xf bank_mask:0xf
    v_mul_f32_dpp v197, v242, v65 row_newbcast:1 row_mask:0xf bank_mask:0xf
    v_mul_f32_dpp v198, v242, v64 row_newbcast:8 row_mask:0xf bank_mask:0xf
    v_mul_f32_dpp v199, v242, v65 row_newbcast:9 row_mask:0xf bank_mask:0xf
    v_mul_f32_dpp v200, v242, v68 row_newbcast:2 row_mask:0xf bank_mask:0xf
    v_mul_f32_dpp v201, v242, v69 row_newbcast:3 row_mask:0xf bank_mask:0xf
    v_mul_f32_dpp v202, v242, v68 row_newbcast:10 row_mask:0xf bank_mask:0xf
    v_mul_f32_dpp v203, v242, v69 row_newbcast:11 row_mask:0xf bank_mask:0xf
    v_cvt_pk_bf16_f32 v64, v196, v197
    v_cvt_pk_bf16_f32 v68, v198, v199
    v_cvt_pk_bf16_f32 v65, v200, v201
    v_cvt_pk_bf16_f32 v69, v202, v203
    v_mul_f32_dpp v196, v242, v66 row_newbcast:4 row_mask:0xf bank_mask:0xf
    v_mul_f32_dpp v197, v242, v67 row_newbcast:5 row_mask:0xf bank_mask:0xf
    v_mul_f32_dpp v198, v242, v66 row_newbcast:12 row_mask:0xf bank_mask:0xf
    v_mul_f32_dpp v199, v242, v67 row_newbcast:13 row_mask:0xf bank_mask:0xf
    v_mul_f32_dpp v200, v242, v70 row_newbcast:6 row_mask:0xf bank_mask:0xf
    v_mul_f32_dpp v201, v242, v71 row_newbcast:7 row_mask:0xf bank_mask:0xf
    v_mul_f32_dpp v202, v242, v70 row_newbcast:14 row_mask:0xf bank_mask:0xf
    v_mul_f32_dpp v203, v242, v71 row_newbcast:15 row_mask:0xf bank_mask:0xf
    v_cvt_pk_bf16_f32 v66, v196, v197
    v_cvt_pk_bf16_f32 v70, v198, v199
    v_cvt_pk_bf16_f32 v67, v200, v201
    v_cvt_pk_bf16_f32 v71, v202, v203
    s_mov_b64 exec, s[54:55]
    ds_read_u16_d16_hi v242, v250 offset:256
    s_mov_b64 exec, -1
    s_waitcnt vmcnt(4) lgkmcnt(9)
    v_mfma_f32_32x32x16_bf16 v[0:15], v[64:67], v[176:179], 0
    v_mul_f32_dpp v196, v243, v72 row_newbcast:0 row_mask:0xf bank_mask:0xf
    v_mul_f32_dpp v197, v243, v73 row_newbcast:1 row_mask:0xf bank_mask:0xf
    v_mul_f32_dpp v198, v243, v72 row_newbcast:8 row_mask:0xf bank_mask:0xf
    v_mul_f32_dpp v199, v243, v73 row_newbcast:9 row_mask:0xf bank_mask:0xf
    v_mul_f32_dpp v200, v243, v76 row_newbcast:2 row_mask:0xf bank_mask:0xf
    v_mul_f32_dpp v201, v243, v77 row_newbcast:3 row_mask:0xf bank_mask:0xf
    v_mul_f32_dpp v202, v243, v76 row_newbcast:10 row_mask:0xf bank_mask:0xf
    v_mul_f32_dpp v203, v243, v77 row_newbcast:11 row_mask:0xf bank_mask:0xf
    v_cvt_pk_bf16_f32 v72, v196, v197
    v_cvt_pk_bf16_f32 v76, v198, v199
    v_cvt_pk_bf16_f32 v73, v200, v201
    v_cvt_pk_bf16_f32 v77, v202, v203
    s_add_u32 m0, s21, 0
    v_mfma_f32_32x32x16_bf16 v[16:31], v[68:71], v[176:179], 0
    buffer_load_dwordx4 v234, s[4:7], s35 offen  lds
    buffer_load_dwordx4 v235, s[8:11], s35 offen offset:1024  lds
    ds_read_b64_tr_b16 v[176:177], v244 offset:2048
    ds_read_b64_tr_b16 v[178:179], v244 offset:3072
    ds_read_b64_tr_b16 v[184:185], v245 offset:2048
    ds_read_b64_tr_b16 v[186:187], v245 offset:3072
    v_mul_f32_dpp v196, v243, v74 row_newbcast:4 row_mask:0xf bank_mask:0xf
    v_mul_f32_dpp v197, v243, v75 row_newbcast:5 row_mask:0xf bank_mask:0xf
    v_mul_f32_dpp v198, v243, v74 row_newbcast:12 row_mask:0xf bank_mask:0xf
    v_mul_f32_dpp v199, v243, v75 row_newbcast:13 row_mask:0xf bank_mask:0xf
    v_mul_f32_dpp v200, v243, v78 row_newbcast:6 row_mask:0xf bank_mask:0xf
    v_mul_f32_dpp v201, v243, v79 row_newbcast:7 row_mask:0xf bank_mask:0xf
    v_mul_f32_dpp v202, v243, v78 row_newbcast:14 row_mask:0xf bank_mask:0xf
    v_mul_f32_dpp v203, v243, v79 row_newbcast:15 row_mask:0xf bank_mask:0xf
    v_cvt_pk_bf16_f32 v74, v196, v197
    v_cvt_pk_bf16_f32 v78, v198, v199
    v_cvt_pk_bf16_f32 v75, v200, v201
    v_cvt_pk_bf16_f32 v79, v202, v203
    s_mov_b64 exec, s[54:55]
    ds_read_u16_d16_hi v243, v250 offset:384
    s_mov_b64 exec, -1
    s_waitcnt vmcnt(4) lgkmcnt(1)
    v_mfma_f32_32x32x16_bf16 v[0:15], v[72:75], v[176:179], v[0:15]
    v_mul_f32_dpp v196, v242, v80 row_newbcast:0 row_mask:0xf bank_mask:0xf
    v_mul_f32_dpp v197, v242, v81 row_newbcast:1 row_mask:0xf bank_mask:0xf
    v_mul_f32_dpp v198, v242, v80 row_newbcast:8 row_mask:0xf bank_mask:0xf
    v_mul_f32_dpp v199, v242, v81 row_newbcast:9 row_mask:0xf bank_mask:0xf
    v_mul_f32_dpp v200, v242, v84 row_newbcast:2 row_mask:0xf bank_mask:0xf
    v_mul_f32_dpp v201, v242, v85 row_newbcast:3 row_mask:0xf bank_mask:0xf
    v_mul_f32_dpp v202, v242, v84 row_newbcast:10 row_mask:0xf bank_mask:0xf
    v_mul_f32_dpp v203, v242, v85 row_newbcast:11 row_mask:0xf bank_mask:0xf
    v_cvt_pk_bf16_f32 v80, v196, v197
    v_cvt_pk_bf16_f32 v84, v198, v199
    v_cvt_pk_bf16_f32 v81, v200, v201
    v_cvt_pk_bf16_f32 v85, v202, v203
    s_add_u32 m0, s21, 2048
    v_mfma_f32_32x32x16_bf16 v[16:31], v[76:79], v[176:179], v[16:31]
    buffer_load_dwordx4 v236, s[4:7], s35 offen  lds
    buffer_load_dwordx4 v237, s[8:11], s35 offen offset:1024  lds
    ds_read_b64_tr_b16 v[176:177], v244 offset:4096
    ds_read_b64_tr_b16 v[178:179], v244 offset:5120
    ds_read_b64_tr_b16 v[188:189], v245 offset:4096
    ds_read_b64_tr_b16 v[190:191], v245 offset:5120
    v_mul_f32_dpp v196, v242, v82 row_newbcast:4 row_mask:0xf bank_mask:0xf
    v_mul_f32_dpp v197, v242, v83 row_newbcast:5 row_mask:0xf bank_mask:0xf
    v_mul_f32_dpp v198, v242, v82 row_newbcast:12 row_mask:0xf bank_mask:0xf
    v_mul_f32_dpp v199, v242, v83 row_newbcast:13 row_mask:0xf bank_mask:0xf
    v_mul_f32_dpp v200, v242, v86 row_newbcast:6 row_mask:0xf bank_mask:0xf
    v_mul_f32_dpp v201, v242, v87 row_newbcast:7 row_mask:0xf bank_mask:0xf
    v_mul_f32_dpp v202, v242, v86 row_newbcast:14 row_mask:0xf bank_mask:0xf
    v_mul_f32_dpp v203, v242, v87 row_newbcast:15 row_mask:0xf bank_mask:0xf
    v_cvt_pk_bf16_f32 v82, v196, v197
    v_cvt_pk_bf16_f32 v86, v198, v199
    v_cvt_pk_bf16_f32 v83, v200, v201
    v_cvt_pk_bf16_f32 v87, v202, v203
    s_nop 0
    s_waitcnt vmcnt(4) lgkmcnt(0)
    v_mfma_f32_32x32x16_bf16 v[0:15], v[80:83], v[176:179], v[0:15]
    v_mul_f32_dpp v196, v243, v88 row_newbcast:0 row_mask:0xf bank_mask:0xf
    v_mul_f32_dpp v197, v243, v89 row_newbcast:1 row_mask:0xf bank_mask:0xf
    v_mul_f32_dpp v198, v243, v88 row_newbcast:8 row_mask:0xf bank_mask:0xf
    v_mul_f32_dpp v199, v243, v89 row_newbcast:9 row_mask:0xf bank_mask:0xf
    v_mul_f32_dpp v200, v243, v92 row_newbcast:2 row_mask:0xf bank_mask:0xf
    v_mul_f32_dpp v201, v243, v93 row_newbcast:3 row_mask:0xf bank_mask:0xf
    v_mul_f32_dpp v202, v243, v92 row_newbcast:10 row_mask:0xf bank_mask:0xf
    v_mul_f32_dpp v203, v243, v93 row_newbcast:11 row_mask:0xf bank_mask:0xf
    v_cvt_pk_bf16_f32 v88, v196, v197
    v_cvt_pk_bf16_f32 v92, v198, v199
    v_cvt_pk_bf16_f32 v89, v200, v201
    v_cvt_pk_bf16_f32 v93, v202, v203
    s_add_u32 m0, s21, 4096
    v_mfma_f32_32x32x16_bf16 v[16:31], v[84:87], v[176:179], v[16:31]
    buffer_load_dwordx4 v238, s[4:7], s35 offen  lds
    buffer_load_dwordx4 v239, s[8:11], s35 offen offset:1024  lds
    ds_read_b64_tr_b16 v[176:177], v244 offset:6144
    ds_read_b64_tr_b16 v[178:179], v244 offset:7168
    ds_read_b64_tr_b16 v[192:193], v245 offset:6144
    ds_read_b64_tr_b16 v[194:195], v245 offset:7168
    v_mul_f32_dpp v196, v243, v90 row_newbcast:4 row_mask:0xf bank_mask:0xf
    v_mul_f32_dpp v197, v243, v91 row_newbcast:5 row_mask:0xf bank_mask:0xf
    v_mul_f32_dpp v198, v243, v90 row_newbcast:12 row_mask:0xf bank_mask:0xf
    v_mul_f32_dpp v199, v243, v91 row_newbcast:13 row_mask:0xf bank_mask:0xf
    v_mul_f32_dpp v200, v243, v94 row_newbcast:6 row_mask:0xf bank_mask:0xf
    v_mul_f32_dpp v201, v243, v95 row_newbcast:7 row_mask:0xf bank_mask:0xf
    v_mul_f32_dpp v202, v243, v94 row_newbcast:14 row_mask:0xf bank_mask:0xf
    v_mul_f32_dpp v203, v243, v95 row_newbcast:15 row_mask:0xf bank_mask:0xf
    v_cvt_pk_bf16_f32 v90, v196, v197
    v_cvt_pk_bf16_f32 v94, v198, v199
    v_cvt_pk_bf16_f32 v91, v200, v201
    v_cvt_pk_bf16_f32 v95, v202, v203
    s_nop 0
    s_waitcnt lgkmcnt(0)
    v_mfma_f32_32x32x16_bf16 v[0:15], v[88:91], v[176:179], v[0:15]
    s_add_u32 m0, s21, 6144
    v_mfma_f32_32x32x16_bf16 v[16:31], v[92:95], v[176:179], v[16:31]
    buffer_load_dwordx4 v240, s[4:7], s35 offen  lds
    buffer_load_dwordx4 v241, s[8:11], s35 offen offset:1024  lds
    s_mov_b32 m0, s50
    s_nop 0
    s_movrels_b32 s71, s23
    s_movrels_b32 s33, s28
    v_add_u32 v253, s33, v248
    s_bfe_u32 s46, s71, 0x30012
    s_mov_b32 m0, s46
    s_and_b32 s66, s71, 0x3ffff
    s_movrels_b32 s68, s57
    s_movrels_b32 s69, s61
    s_sub_u32 s48, s66, s47
    s_mov_b32 s47, s66
    s_lshr_b32 s52, s71, 28
    s_lshl_b32 s67, s46, 9
    s_add_u32 s66, s66, s67
    s_sub_u32 s49, s66, s42
    s_mov_b32 s42, s66
    s_bfe_u32 s66, s68, 655360
    s_add_u32 s43, s42, s66
    s_bfe_u32 s39, s69, 655360
    s_bfe_u32 s66, s68, 655370
    s_add_u32 s44, s42, s66
    s_bfe_u32 s40, s69, 655370
    s_bfe_u32 s66, s68, 655380
    s_add_u32 s45, s42, s66
    s_bfe_u32 s41, s69, 655380
    v_mfma_f32_32x32x16_bf16 v[32:47], v[64:67], v[180:183], 0
    v_mul_f32 v196, v0, v96
    v_fmac_f32 v196, v1, v97
    v_fmac_f32 v196, v2, v98
    v_fmac_f32 v196, v3, v99
    v_fmac_f32 v196, v4, v100
    v_mfma_f32_32x32x16_bf16 v[48:63], v[68:71], v[180:183], 0
    v_fmac_f32 v196, v5, v101
    v_fmac_f32 v196, v6, v102
    v_fmac_f32 v196, v7, v103
    v_mul_f32 v198, v8, v128
    v_fmac_f32 v198, v9, v129
    v_mfma_f32_32x32x16_bf16 v[32:47], v[72:75], v[184:187], v[32:47]
    v_fmac_f32 v198, v10, v130
    v_fmac_f32 v198, v11, v131
    v_fmac_f32 v198, v12, v132
    v_fmac_f32 v198, v13, v133
    v_mfma_f32_32x32x16_bf16 v[48:63], v[76:79], v[184:187], v[48:63]
    v_fmac_f32 v198, v14, v134
    v_fmac_f32 v198, v15, v135
    v_mul_f32 v200, v16, v128
    v_fmac_f32 v200, v17, v129
    v_permlane32_swap_b32 v196, v198
    v_mfma_f32_32x32x16_bf16 v[32:47], v[80:83], v[188:191], v[32:47]
    v_fmac_f32 v200, v18, v130
    v_fmac_f32 v200, v19, v131
    v_fmac_f32 v200, v20, v132
    v_fmac_f32 v200, v21, v133
    v_fmac_f32 v200, v22, v134
    v_mfma_f32_32x32x16_bf16 v[48:63], v[84:87], v[188:191], v[48:63]
    s_waitcnt vmcnt(6)
    ds_read_b64_tr_b16 v[176:177], v244 offset:0
    ds_read_b64_tr_b16 v[178:179], v244 offset:1024
    ds_read_b64_tr_b16 v[180:181], v245 offset:0
    ds_read_b64_tr_b16 v[182:183], v245 offset:1024
    v_fmac_f32 v200, v23, v135
    v_add_f32 v198, v196, v198
    v_mul_f32_e64 v202, v24, -v128
    v_fma_f32 v202, v25, -v129, v202
    v_mfma_f32_32x32x16_bf16 v[32:47], v[88:91], v[192:195], v[32:47]
    v_fma_f32 v202, v26, -v130, v202
    v_fma_f32 v202, v27, -v131, v202
    v_fma_f32 v202, v28, -v132, v202
    v_fma_f32 v202, v29, -v133, v202
    v_fma_f32 v202, v30, -v134, v202
    v_mfma_f32_32x32x16_bf16 v[48:63], v[92:95], v[192:195], v[48:63]
    v_fma_f32 v202, v31, -v135, v202
    s_nop 1
    v_permlane32_swap_b32 v200, v202
    v_add_f32 v202, v200, v202
    s_waitcnt vmcnt(4) lgkmcnt(0)
    v_mfma_f32_32x32x16_bf16 v[0:15], v[64:67], v[176:179], 0
    v_mul_f32 v197, v32, v104
    v_fmac_f32 v197, v33, v105
    v_fmac_f32 v197, v34, v106
    v_fmac_f32 v197, v35, v107
    v_fmac_f32 v197, v36, v108
    s_add_u32 m0, s21, 0
    v_mfma_f32_32x32x16_bf16 v[16:31], v[68:71], v[176:179], 0
    buffer_load_dwordx4 v234, s[4:7], s36 offen  lds
    buffer_load_dwordx4 v235, s[8:11], s36 offen offset:1024  lds
    ds_read_b64_tr_b16 v[176:177], v244 offset:2048
    ds_read_b64_tr_b16 v[178:179], v244 offset:3072
    ds_read_b64_tr_b16 v[184:185], v245 offset:2048
    ds_read_b64_tr_b16 v[186:187], v245 offset:3072
    v_fmac_f32 v197, v37, v109
    v_fmac_f32 v197, v38, v110
    v_fmac_f32 v197, v39, v111
    v_mul_f32 v199, v40, v136
    v_fmac_f32 v199, v41, v137
    s_waitcnt vmcnt(4) lgkmcnt(0)
    v_mfma_f32_32x32x16_bf16 v[0:15], v[72:75], v[176:179], v[0:15]
    v_fmac_f32 v199, v42, v138
    v_fmac_f32 v199, v43, v139
    v_fmac_f32 v199, v44, v140
    v_fmac_f32 v199, v45, v141
    v_fmac_f32 v199, v46, v142
    s_add_u32 m0, s21, 2048
    v_mfma_f32_32x32x16_bf16 v[16:31], v[76:79], v[176:179], v[16:31]
    buffer_load_dwordx4 v236, s[4:7], s36 offen  lds
    buffer_load_dwordx4 v237, s[8:11], s36 offen offset:1024  lds
    ds_read_b64_tr_b16 v[176:177], v244 offset:4096
    ds_read_b64_tr_b16 v[178:179], v244 offset:5120
    ds_read_b64_tr_b16 v[188:189], v245 offset:4096
    ds_read_b64_tr_b16 v[190:191], v245 offset:5120
    v_fmac_f32 v199, v47, v143
    v_mul_f32 v201, v48, v136
    v_fmac_f32 v201, v49, v137
    v_permlane32_swap_b32 v197, v199
    v_fmac_f32 v201, v50, v138
    s_waitcnt vmcnt(4) lgkmcnt(0)
    v_mfma_f32_32x32x16_bf16 v[0:15], v[80:83], v[176:179], v[0:15]
    v_fmac_f32 v201, v51, v139
    v_fmac_f32 v201, v52, v140
    v_fmac_f32 v201, v53, v141
    v_fmac_f32 v201, v54, v142
    v_fmac_f32 v201, v55, v143
    s_add_u32 m0, s21, 4096
    v_mfma_f32_32x32x16_bf16 v[16:31], v[84:87], v[176:179], v[16:31]
    buffer_load_dwordx4 v238, s[4:7], s36 offen  lds
    buffer_load_dwordx4 v239, s[8:11], s36 offen offset:1024  lds
    ds_read_b64_tr_b16 v[176:177], v244 offset:6144
    ds_read_b64_tr_b16 v[178:179], v244 offset:7168
    ds_read_b64_tr_b16 v[192:193], v245 offset:6144
    ds_read_b64_tr_b16 v[194:195], v245 offset:7168
    v_add_f32 v199, v197, v199
    v_mul_f32_e64 v203, v56, -v136
    v_fma_f32 v203, v57, -v137, v203
    v_fma_f32 v203, v58, -v138, v203
    v_fma_f32 v203, v59, -v139, v203
    s_waitcnt lgkmcnt(0)
    v_mfma_f32_32x32x16_bf16 v[0:15], v[88:91], v[176:179], v[0:15]
    v_fma_f32 v203, v60, -v140, v203
    v_fma_f32 v203, v61, -v141, v203
    v_fma_f32 v203, v62, -v142, v203
    v_fma_f32 v203, v63, -v143, v203
    s_nop 1
    s_add_u32 m0, s21, 6144
    v_mfma_f32_32x32x16_bf16 v[16:31], v[92:95], v[176:179], v[16:31]
    buffer_load_dwordx4 v240, s[4:7], s36 offen  lds
    buffer_load_dwordx4 v241, s[8:11], s36 offen offset:1024  lds
    v_permlane32_swap_b32 v201, v203
    v_add_f32 v203, v201, v203
    v_cvt_pk_bf16_f32 v198, v198, v199
    v_cvt_pk_bf16_f32 v202, v202, v203
    ds_write2st64_b32 v253, v198, v202 offset0:0 offset1:1
    v_mfma_f32_32x32x16_bf16 v[32:47], v[64:67], v[180:183], 0
    v_mul_f32 v196, v0, v144
    v_fmac_f32 v196, v1, v145
    v_fmac_f32 v196, v2, v146
    v_fmac_f32 v196, v3, v147
    v_mfma_f32_32x32x16_bf16 v[48:63], v[68:71], v[180:183], 0
    v_fmac_f32 v196, v4, v148
    v_fmac_f32 v196, v5, v149
    v_fmac_f32 v196, v6, v150
    v_fmac_f32 v196, v7, v151
    v_mfma_f32_32x32x16_bf16 v[32:47], v[72:75], v[184:187], v[32:47]
    v_mul_f32 v198, v8, v112
    v_fmac_f32 v198, v9, v113
    v_fmac_f32 v198, v10, v114
    v_fmac_f32 v198, v11, v115
    v_mfma_f32_32x32x16_bf16 v[48:63], v[76:79], v[184:187], v[48:63]
    v_fmac_f32 v198, v12, v116
    v_fmac_f32 v198, v13, v117
    v_fmac_f32 v198, v14, v118
    v_fmac_f32 v198, v15, v119
    v_mfma_f32_32x32x16_bf16 v[32:47], v[80:83], v[188:191], v[32:47]
    v_mul_f32_e64 v200, v16, -v160
    v_fma_f32 v200, v17, -v161, v200
    v_fma_f32 v200, v18, -v162, v200
    v_fma_f32 v200, v19, -v163, v200
    v_mfma_f32_32x32x16_bf16 v[48:63], v[84:87], v[188:191], v[48:63]
    s_waitcnt vmcnt(6)
    ds_read_b64_tr_b16 v[176:177], v244 offset:0
    ds_read_b64_tr_b16 v[178:179], v244 offset:1024
    ds_read_b64_tr_b16 v[180:181], v245 offset:0
    ds_read_b64_tr_b16 v[182:183], v245 offset:1024
    v_fma_f32 v200, v20, -v164, v200
    v_fma_f32 v200, v21, -v165, v200
    v_fma_f32 v200, v22, -v166, v200
    v_fma_f32 v200, v23, -v167, v200
    v_mfma_f32_32x32x16_bf16 v[32:47], v[88:91], v[192:195], v[32:47]
    v_mul_f32_e64 v202, v24, -v160
    v_fma_f32 v202, v25, -v161, v202
    v_fma_f32 v202, v26, -v162, v202
    v_fma_f32 v202, v27, -v163, v202
    v_mfma_f32_32x32x16_bf16 v[48:63], v[92:95], v[192:195], v[48:63]
    v_fma_f32 v202, v28, -v164, v202
    v_fma_f32 v202, v29, -v165, v202
    v_fma_f32 v202, v30, -v166, v202
    v_fma_f32 v202, v31, -v167, v202
    s_waitcnt vmcnt(4) lgkmcnt(0)
    v_mfma_f32_32x32x16_bf16 v[0:15], v[64:67], v[176:179], 0
    s_nop 0
    v_mul_f32 v197, v32, v152
    v_fmac_f32 v197, v33, v153
    v_fmac_f32 v197, v34, v154
    v_fmac_f32 v197, v35, v155
    s_add_u32 m0, s21, 0
    v_mfma_f32_32x32x16_bf16 v[16:31], v[68:71], v[176:179], 0
    buffer_load_dwordx4 v234, s[4:7], s37 offen  lds
    buffer_load_dwordx4 v235, s[8:11], s37 offen offset:1024  lds
    ds_read_b64_tr_b16 v[176:177], v244 offset:2048
    ds_read_b64_tr_b16 v[178:179], v244 offset:3072
    ds_read_b64_tr_b16 v[184:185], v245 offset:2048
    ds_read_b64_tr_b16 v[186:187], v245 offset:3072
    v_add_u32 v252, s42, v247
    ds_read_u16 v234, v252
    ds_read_u16 v235, v252 offset:64
    v_fmac_f32 v197, v36, v156
    v_fmac_f32 v197, v37, v157
    v_fmac_f32 v197, v38, v158
    v_fmac_f32 v197, v39, v159
    s_waitcnt vmcnt(4) lgkmcnt(2)
    v_mfma_f32_32x32x16_bf16 v[0:15], v[72:75], v[176:179], v[0:15]
    v_mul_f32 v199, v40, v120
    v_fmac_f32 v199, v41, v121
    v_fmac_f32 v199, v42, v122
    v_fmac_f32 v199, v43, v123
    s_add_u32 m0, s21, 2048
    v_mfma_f32_32x32x16_bf16 v[16:31], v[76:79], v[176:179], v[16:31]
    buffer_load_dwordx4 v236, s[4:7], s37 offen  lds
    buffer_load_dwordx4 v237, s[8:11], s37 offen offset:1024  lds
    ds_read_b64_tr_b16 v[176:177], v244 offset:4096
    ds_read_b64_tr_b16 v[178:179], v244 offset:5120
    ds_read_b64_tr_b16 v[188:189], v245 offset:4096
    ds_read_b64_tr_b16 v[190:191], v245 offset:5120
    v_add_u32 v252, s43, v247
    ds_read_u16 v236, v252
    ds_read_u16 v237, v252 offset:64
    v_fmac_f32 v199, v44, v124
    v_fmac_f32 v199, v45, v125
    v_fmac_f32 v199, v46, v126
    v_fmac_f32 v199, v47, v127
    s_waitcnt vmcnt(4) lgkmcnt(2)
    v_mfma_f32_32x32x16_bf16 v[0:15], v[80:83], v[176:179], v[0:15]
    v_mul_f32_e64 v201, v48, -v168
    v_fma_f32 v201, v49, -v169, v201
    v_fma_f32 v201, v50, -v170, v201
    v_fma_f32 v201, v51, -v171, v201
    s_add_u32 m0, s21, 4096
    v_mfma_f32_32x32x16_bf16 v[16:31], v[84:87], v[176:179], v[16:31]
    buffer_load_dwordx4 v238, s[4:7], s37 offen  lds
    buffer_load_dwordx4 v239, s[8:11], s37 offen offset:1024  lds
    ds_read_b64_tr_b16 v[176:177], v244 offset:6144
    ds_read_b64_tr_b16 v[178:179], v244 offset:7168
    ds_read_b64_tr_b16 v[192:193], v245 offset:6144
    ds_read_b64_tr_b16 v[194:195], v245 offset:7168
    v_add_u32 v252, s44, v247
    ds_read_u16 v238, v252
    ds_read_u16 v239, v252 offset:64
    v_fma_f32 v201, v52, -v172, v201
    v_fma_f32 v201, v53, -v173, v201
    v_fma_f32 v201, v54, -v174, v201
    v_fma_f32 v201, v55, -v175, v201
    s_waitcnt lgkmcnt(2)
    v_mfma_f32_32x32x16_bf16 v[0:15], v[88:91], v[176:179], v[0:15]
    v_mul_f32_e64 v203, v56, -v168
    v_fma_f32 v203, v57, -v169, v203
    v_fma_f32 v203, v58, -v170, v203
    v_fma_f32 v203, v59, -v171, v203
    s_add_u32 m0, s21, 6144
    v_mfma_f32_32x32x16_bf16 v[16:31], v[92:95], v[176:179], v[16:31]
    buffer_load_dwordx4 v240, s[4:7], s37 offen  lds
    buffer_load_dwordx4 v241, s[8:11], s37 offen offset:1024  lds
    v_add_u32 v252, s45, v247
    ds_read_u16 v240, v252
    ds_read_u16 v241, v252 offset:64
    v_fma_f32 v203, v60, -v172, v203
    v_fma_f32 v203, v61, -v173, v203
    v_fma_f32 v203, v62, -v174, v203
    v_fma_f32 v203, v63, -v175, v203
    v_mfma_f32_32x32x16_bf16 v[32:47], v[64:67], v[180:183], 0
    v_mul_f32 v254, v0, v144
    v_fmac_f32 v254, v1, v145
    v_fmac_f32 v254, v2, v146
    v_mfma_f32_32x32x16_bf16 v[48:63], v[68:71], v[180:183], 0
    ds_swizzle_b32 v68, v68 offset:0x401F
    ds_swizzle_b32 v69, v69 offset:0x401F
    ds_swizzle_b32 v70, v70 offset:0x401F
    ds_swizzle_b32 v71, v71 offset:0x401F
    v_fmac_f32 v254, v3, v147
    v_fmac_f32 v254, v4, v148
    v_mfma_f32_32x32x16_bf16 v[32:47], v[72:75], v[184:187], v[32:47]
    v_fmac_f32 v254, v5, v149
    v_fmac_f32 v254, v6, v150
    v_mfma_f32_32x32x16_bf16 v[48:63], v[76:79], v[184:187], v[48:63]
    ds_swizzle_b32 v76, v76 offset:0x401F
    ds_swizzle_b32 v77, v77 offset:0x401F
    ds_swizzle_b32 v78, v78 offset:0x401F
    ds_swizzle_b32 v79, v79 offset:0x401F
    v_fmac_f32 v254, v7, v151
    v_fmac_f32 v200, v8, v160
    v_mfma_f32_32x32x16_bf16 v[32:47], v[80:83], v[188:191], v[32:47]
    v_fmac_f32 v200, v9, v161
    v_permlane32_swap_b32 v196, v254
    v_fmac_f32 v200, v10, v162
    v_mfma_f32_32x32x16_bf16 v[48:63], v[84:87], v[188:191], v[48:63]
    ds_swizzle_b32 v84, v84 offset:0x401F
    ds_swizzle_b32 v85, v85 offset:0x401F
    ds_swizzle_b32 v86, v86 offset:0x401F
    ds_swizzle_b32 v87, v87 offset:0x401F
    s_waitcnt vmcnt(6)
    ds_read_b64_tr_b16 v[176:177], v244 offset:0
    ds_read_b64_tr_b16 v[178:179], v244 offset:1024
    ds_read_b64_tr_b16 v[180:181], v245 offset:0
    ds_read_b64_tr_b16 v[182:183], v245 offset:1024
    v_fmac_f32 v200, v11, v163
    v_fmac_f32 v200, v12, v164
    v_mfma_f32_32x32x16_bf16 v[32:47], v[88:91], v[192:195], v[32:47]
    v_fmac_f32 v200, v13, v165
    v_fmac_f32 v200, v14, v166
    v_mfma_f32_32x32x16_bf16 v[48:63], v[92:95], v[192:195], v[48:63]
    ds_swizzle_b32 v92, v92 offset:0x401F
    ds_swizzle_b32 v93, v93 offset:0x401F
    ds_swizzle_b32 v94, v94 offset:0x401F
    ds_swizzle_b32 v95, v95 offset:0x401F
    v_fmac_f32 v200, v15, v167
    v_add_f32 v254, v196, v254
    s_waitcnt lgkmcnt(8)
    s_mov_b64 exec, s[56:57]
    v_xor_b32 v68, 0x80008000, v68
    v_xor_b32 v69, 0x80008000, v69
    v_xor_b32 v70, 0x80008000, v70
    v_xor_b32 v71, 0x80008000, v71
    v_xor_b32 v76, 0x80008000, v76
    v_xor_b32 v77, 0x80008000, v77
    v_xor_b32 v78, 0x80008000, v78
    v_xor_b32 v79, 0x80008000, v79
    v_xor_b32 v84, 0x80008000, v84
    v_xor_b32 v85, 0x80008000, v85
    v_xor_b32 v86, 0x80008000, v86
    v_xor_b32 v87, 0x80008000, v87
    s_mov_b64 exec, -1
    s_waitcnt vmcnt(4) lgkmcnt(4)
    v_mfma_f32_32x32x16_bf16 v[0:15], v[64:67], v[176:179], 0
    v_mul_f32 v255, v32, v152
    v_fmac_f32 v255, v33, v153
    v_fmac_f32 v255, v34, v154
    s_add_u32 m0, s21, 0
    s_cmp_eq_u32 s50, 4
    v_mfma_f32_32x32x16_bf16 v[16:31], v[68:71], v[176:179], v[16:31]
    s_cbranch_scc1 WL_8_0
    v_lshl_add_u32 v234, v234, 10, v246
    v_lshl_add_u32 v235, v235, 10, v246
    buffer_load_dwordx4 v234, s[4:7], s38 offen  lds
    buffer_load_dwordx4 v235, s[8:11], s38 offen offset:1024  lds
WR_8_0:
    ds_read_b64_tr_b16 v[176:177], v244 offset:2048
    ds_read_b64_tr_b16 v[178:179], v244 offset:3072
    ds_read_b64_tr_b16 v[184:185], v245 offset:2048
    ds_read_b64_tr_b16 v[186:187], v245 offset:3072
    v_fmac_f32 v255, v35, v155
    v_fmac_f32 v255, v36, v156
    s_waitcnt vmcnt(4) lgkmcnt(0)
    v_mfma_f32_32x32x16_bf16 v[0:15], v[72:75], v[176:179], v[0:15]
    v_fmac_f32 v255, v37, v157
    v_fmac_f32 v255, v38, v158
    v_fmac_f32 v255, v39, v159
    s_add_u32 m0, s21, 2048
    s_cmp_eq_u32 s50, 4
    v_mfma_f32_32x32x16_bf16 v[16:31], v[76:79], v[176:179], v[16:31]
    s_cbranch_scc1 WL_8_1
    v_lshl_add_u32 v236, v236, 10, v246
    v_lshl_add_u32 v237, v237, 10, v246
    buffer_load_dwordx4 v236, s[4:7], s39 offen  lds
    buffer_load_dwordx4 v237, s[8:11], s39 offen offset:1024  lds
WR_8_1:
    ds_read_b64_tr_b16 v[176:177], v244 offset:4096
    ds_read_b64_tr_b16 v[178:179], v244 offset:5120
    ds_read_b64_tr_b16 v[188:189], v245 offset:4096
    ds_read_b64_tr_b16 v[190:191], v245 offset:5120
    v_fmac_f32 v201, v40, v168
    v_fmac_f32 v201, v41, v169
    s_waitcnt vmcnt(4) lgkmcnt(0)
    v_mfma_f32_32x32x16_bf16 v[0:15], v[80:83], v[176:179], v[0:15]
    v_permlane32_swap_b32 v197, v255
    v_fmac_f32 v201, v42, v170
    v_fmac_f32 v201, v43, v171
    s_add_u32 m0, s21, 4096
    s_cmp_eq_u32 s50, 4
    v_mfma_f32_32x32x16_bf16 v[16:31], v[84:87], v[176:179], v[16:31]
    s_cbranch_scc1 WL_8_2
    v_lshl_add_u32 v238, v238, 10, v246
    v_lshl_add_u32 v239, v239, 10, v246
    buffer_load_dwordx4 v238, s[4:7], s40 offen  lds
    buffer_load_dwordx4 v239, s[8:11], s40 offen offset:1024  lds
WR_8_2:
    ds_read_b64_tr_b16 v[176:177], v244 offset:6144
    ds_read_b64_tr_b16 v[178:179], v244 offset:7168
    ds_read_b64_tr_b16 v[192:193], v245 offset:6144
    ds_read_b64_tr_b16 v[194:195], v245 offset:7168
    v_fmac_f32 v201, v44, v172
    v_fmac_f32 v201, v45, v173
    s_waitcnt lgkmcnt(0)
    s_mov_b64 exec, s[56:57]
    v_xor_b32 v92, 0x80008000, v92
    v_xor_b32 v93, 0x80008000, v93
    v_xor_b32 v94, 0x80008000, v94
    v_xor_b32 v95, 0x80008000, v95
    s_mov_b64 exec, -1
    v_mfma_f32_32x32x16_bf16 v[0:15], v[88:91], v[176:179], v[0:15]
    v_fmac_f32 v201, v46, v174
    v_fmac_f32 v201, v47, v175
    v_add_f32 v255, v197, v255
    s_add_u32 m0, s21, 6144
    s_cmp_eq_u32 s50, 4
    v_mfma_f32_32x32x16_bf16 v[16:31], v[92:95], v[176:179], v[16:31]
    s_cbranch_scc1 WL_8_3
    v_lshl_add_u32 v240, v240, 10, v246
    v_lshl_add_u32 v241, v241, 10, v246
    buffer_load_dwordx4 v240, s[4:7], s41 offen  lds
    buffer_load_dwordx4 v241, s[8:11], s41 offen offset:1024  lds
WR_8_3:
    v_cvt_pk_bf16_f32 v254, v254, v255
    ds_write_b32 v253, v254 offset:512
    v_mfma_f32_32x32x16_bf16 v[32:47], v[64:67], v[180:183], 0
    v_mul_f32 v254, v0, v144
    v_fmac_f32 v254, v1, v145
    v_fmac_f32 v254, v2, v146
    v_fmac_f32 v254, v3, v147
    v_fmac_f32 v254, v4, v148
    v_mfma_f32_32x32x16_bf16 v[48:63], v[68:71], v[180:183], v[48:63]
    v_fmac_f32 v254, v5, v149
    v_fmac_f32 v254, v6, v150
    v_fmac_f32 v254, v7, v151
    v_fma_f32 v202, v8, -v160, v202
    v_fma_f32 v202, v9, -v161, v202
    v_mfma_f32_32x32x16_bf16 v[32:47], v[72:75], v[184:187], v[32:47]
    v_permlane32_swap_b32 v254, v200
    v_fma_f32 v202, v10, -v162, v202
    v_fma_f32 v202, v11, -v163, v202
    v_fma_f32 v202, v12, -v164, v202
    v_fma_f32 v202, v13, -v165, v202
    v_mfma_f32_32x32x16_bf16 v[48:63], v[76:79], v[184:187], v[48:63]
    v_fma_f32 v202, v14, -v166, v202
    v_fma_f32 v202, v15, -v167, v202
    v_add_f32 v200, v254, v200
    v_fmac_f32 v198, v16, v112
    v_permlane32_swap_b32 v202, v254
    v_mfma_f32_32x32x16_bf16 v[32:47], v[80:83], v[188:191], v[32:47]
    v_fmac_f32 v198, v17, v113
    v_fmac_f32 v198, v18, v114
    v_fmac_f32 v198, v19, v115
    v_fmac_f32 v198, v20, v116
    v_fmac_f32 v198, v21, v117
    v_mfma_f32_32x32x16_bf16 v[48:63], v[84:87], v[188:191], v[48:63]
    s_waitcnt vmcnt(6)
    ds_read_b64_tr_b16 v[176:177], v244 offset:0
    ds_read_b64_tr_b16 v[178:179], v244 offset:1024
    ds_read_b64_tr_b16 v[180:181], v245 offset:0
    ds_read_b64_tr_b16 v[182:183], v245 offset:1024
    v_fmac_f32 v198, v22, v118
    v_fmac_f32 v198, v23, v119
    v_add_f32 v254, v202, v254
    v_mul_f32 v196, v24, v160
    v_fmac_f32 v196, v25, v161
    v_mfma_f32_32x32x16_bf16 v[32:47], v[88:91], v[192:195], v[32:47]
    v_fmac_f32 v196, v26, v162
    v_fmac_f32 v196, v27, v163
    v_fmac_f32 v196, v28, v164
    v_fmac_f32 v196, v29, v165
    v_fmac_f32 v196, v30, v166
    v_mfma_f32_32x32x16_bf16 v[48:63], v[92:95], v[192:195], v[48:63]
    v_add_u32 v249, s48, v249
    v_add_u32 v250, s49, v250
    ds_read_b32 v252, v251 offset:16
    ds_read_b64_tr_b16 v[64:65], v249 offset:0
    ds_read_b64_tr_b16 v[68:69], v249 offset:64
    ds_read_b64_tr_b16 v[66:67], v249 offset:256
    ds_read_b64_tr_b16 v[70:71], v249 offset:320
    s_mov_b64 exec, s[54:55]
    ds_read_u16_d16_hi v242, v250 offset:0
    s_mov_b64 exec, -1
    v_fmac_f32 v196, v31, v167
    s_nop 1
    v_permlane32_swap_b32 v198, v196
    v_add_f32 v196, v198, v196
    s_cmp_eq_u32 s50, 4
    s_cbranch_scc1 LEPI_1
    v_mul_f32 v255, v32, v152
    v_fmac_f32 v255, v33, v153
    v_fmac_f32 v255, v34, v154
    v_fmac_f32 v255, v35, v155
    v_fmac_f32 v255, v36, v156
    v_fmac_f32 v255, v37, v157
    v_fmac_f32 v255, v38, v158
    v_fmac_f32 v255, v39, v159
    v_fma_f32 v203, v40, -v168, v203
    v_fma_f32 v203, v41, -v169, v203
    v_permlane32_swap_b32 v255, v201
    v_fma_f32 v203, v42, -v170, v203
    v_fma_f32 v203, v43, -v171, v203
    v_fma_f32 v203, v44, -v172, v203
    v_fma_f32 v203, v45, -v173, v203
    v_fma_f32 v203, v46, -v174, v203
    v_fma_f32 v203, v47, -v175, v203
    v_add_f32 v201, v255, v201
    v_fmac_f32 v199, v48, v120
    v_permlane32_swap_b32 v203, v255
    v_fmac_f32 v199, v49, v121
    v_fmac_f32 v199, v50, v122
    v_fmac_f32 v199, v51, v123
    v_fmac_f32 v199, v52, v124
    v_fmac_f32 v199, v53, v125
    v_fmac_f32 v199, v54, v126
    v_fmac_f32 v199, v55, v127
    v_add_f32 v255, v203, v255
    v_mul_f32 v197, v56, v168
    v_fmac_f32 v197, v57, v169
    v_fmac_f32 v197, v58, v170
    v_fmac_f32 v197, v59, v171
    v_fmac_f32 v197, v60, v172
    v_fmac_f32 v197, v61, v173
    v_fmac_f32 v197, v62, v174
    v_fmac_f32 v197, v63, v175
    s_nop 1
    v_permlane32_swap_b32 v199, v197
    v_add_f32 v197, v199, v197
    v_cvt_pk_bf16_f32 v200, v200, v201
    v_cvt_pk_bf16_f32 v254, v254, v255
    v_cvt_pk_bf16_f32 v196, v196, v197
    ds_write2st64_b32 v253, v200, v196 offset0:3 offset1:4
    s_mov_b64 exec, 0xffffffff
    ds_write_b32 v253, v254 offset:1280
    s_mov_b64 exec, -1
    s_add_u32 s50, s50, 1
    s_cmp_ge_u32 s50, 4
    s_cbranch_scc1 LAST1
    s_waitcnt lgkmcnt(7)
    v_readfirstlane_b32 s66, v252
    s_add_u32 s53, s53, 1
    v_mov_b32 v252, s53
    s_cmp_le_u32 s53, s66
    ds_write2_b32 v251, v252, v252 offset0:0 offset1:8
    s_setprio 1
    s_cbranch_scc1 PRIO_15
    s_setprio 0
PRIO_15:
    s_cmp_eq_u32 s52, 4
    s_cbranch_scc1 ITEM_1_4
    s_cmp_eq_u32 s52, 5
    s_cbranch_scc1 ITEM_1_5
    s_cmp_eq_u32 s52, 3
    s_cbranch_scc1 ITEM_1_3
    s_cmp_eq_u32 s52, 6
    s_cbranch_scc1 ITEM_1_6
    s_cmp_eq_u32 s52, 8
    s_cbranch_scc1 ITEM_1_8
    s_branch ITEM_1_2
WL_8_0:
    s_add_u32 s66, s51, 0
    buffer_load_dwordx4 v[96:99], v246, s[16:19], s66 offen offset:2048 sc1
    buffer_load_dwordx4 v[100:103], v246, s[16:19], s66 offen offset:3072 sc1
    s_branch WR_8_0
WL_8_1:
    s_add_u32 s66, s51, 4096
    buffer_load_dwordx4 v[104:107], v246, s[16:19], s66 offen offset:2048 sc1
    buffer_load_dwordx4 v[108:111], v246, s[16:19], s66 offen offset:3072 sc1
    s_branch WR_8_1
WL_8_2:
    s_add_u32 s66, s51, 8192
    buffer_load_dwordx4 v[128:131], v246, s[16:19], s66 offen offset:2048 sc1
    buffer_load_dwordx4 v[132:135], v246, s[16:19], s66 offen offset:3072 sc1
    s_branch WR_8_2
WL_8_3:
    s_add_u32 s66, s51, 12288
    buffer_load_dwordx4 v[136:139], v246, s[16:19], s66 offen offset:2048 sc1
    buffer_load_dwordx4 v[140:143], v246, s[16:19], s66 offen offset:3072 sc1
    s_branch WR_8_3
.p2align 6
ITEM_1_2:
    s_mov_b32 m0, s50
    s_nop 0
    s_movrels_b32 s71, s23
    s_movrels_b32 s33, s28
    v_add_u32 v253, s33, v248
    s_bfe_u32 s46, s71, 0x30012
    s_mov_b32 m0, s46
    s_and_b32 s66, s71, 0x3ffff
    s_movrels_b32 s68, s57
    s_movrels_b32 s69, s61
    s_sub_u32 s48, s66, s47
    s_mov_b32 s47, s66
    s_lshr_b32 s52, s71, 28
    s_lshl_b32 s67, s46, 9
    s_add_u32 s66, s66, s67
    s_sub_u32 s49, s66, s42
    s_mov_b32 s42, s66
    s_bfe_u32 s66, s68, 655360
    s_add_u32 s43, s42, s66
    s_bfe_u32 s39, s69, 655360
    s_bfe_u32 s66, s68, 655370
    s_add_u32 s44, s42, s66
    s_bfe_u32 s40, s69, 655370
    s_bfe_u32 s66, s68, 655380
    s_add_u32 s45, s42, s66
    s_bfe_u32 s41, s69, 655380
    v_add_u32 v252, s42, v247
    ds_read_u16 v234, v252
    ds_read_u16 v235, v252 offset:64
    v_add_u32 v252, s43, v247
    ds_read_u16 v236, v252
    ds_read_u16 v237, v252 offset:64
    v_add_u32 v252, s44, v247
    ds_read_u16 v238, v252
    ds_read_u16 v239, v252 offset:64
    v_add_u32 v252, s45, v247
    ds_read_u16 v240, v252
    ds_read_u16 v241, v252 offset:64
    s_waitcnt lgkmcnt(8)
    v_mul_f32_dpp v196, v242, v64 row_newbcast:0 row_mask:0xf bank_mask:0xf
    v_mul_f32_dpp v197, v242, v65 row_newbcast:1 row_mask:0xf bank_mask:0xf
    v_mul_f32_dpp v198, v242, v64 row_newbcast:8 row_mask:0xf bank_mask:0xf
    v_mul_f32_dpp v199, v242, v65 row_newbcast:9 row_mask:0xf bank_mask:0xf
    v_mul_f32_dpp v200, v242, v68 row_newbcast:2 row_mask:0xf bank_mask:0xf
    v_mul_f32_dpp v201, v242, v69 row_newbcast:3 row_mask:0xf bank_mask:0xf
    v_mul_f32_dpp v202, v242, v68 row_newbcast:10 row_mask:0xf bank_mask:0xf
    v_mul_f32_dpp v203, v242, v69 row_newbcast:11 row_mask:0xf bank_mask:0xf
    v_cvt_pk_bf16_f32 v64, v196, v197
    v_cvt_pk_bf16_f32 v68, v198, v199
    v_cvt_pk_bf16_f32 v65, v200, v201
    v_cvt_pk_bf16_f32 v69, v202, v203
    v_mul_f32_dpp v196, v242, v66 row_newbcast:4 row_mask:0xf bank_mask:0xf
    v_mul_f32_dpp v197, v242, v67 row_newbcast:5 row_mask:0xf bank_mask:0xf
    v_mul_f32_dpp v198, v242, v66 row_newbcast:12 row_mask:0xf bank_mask:0xf
    v_mul_f32_dpp v199, v242, v67 row_newbcast:13 row_mask:0xf bank_mask:0xf
    v_mul_f32_dpp v200, v242, v70 row_newbcast:6 row_mask:0xf bank_mask:0xf
    v_mul_f32_dpp v201, v242, v71 row_newbcast:7 row_mask:0xf bank_mask:0xf
    v_mul_f32_dpp v202, v242, v70 row_newbcast:14 row_mask:0xf bank_mask:0xf
    v_mul_f32_dpp v203, v242, v71 row_newbcast:15 row_mask:0xf bank_mask:0xf
    v_cvt_pk_bf16_f32 v66, v196, v197
    v_cvt_pk_bf16_f32 v70, v198, v199
    v_cvt_pk_bf16_f32 v67, v200, v201
    v_cvt_pk_bf16_f32 v71, v202, v203
    s_nop 0
    s_waitcnt lgkmcnt(6)
    v_mfma_f32_32x32x16_bf16 v[0:15], v[64:67], v[176:179], 0
    s_add_u32 m0, s21, 0
    s_cmp_eq_u32 s50, 4
    v_mfma_f32_32x32x16_bf16 v[16:31], v[68:71], v[176:179], 0
    s_cbranch_scc1 WL_2_0
    v_lshl_add_u32 v234, v234, 10, v246
    v_lshl_add_u32 v235, v235, 10, v246
    buffer_load_dwordx4 v234, s[4:7], s38 offen  lds
    buffer_load_dwordx4 v235, s[8:11], s38 offen offset:1024  lds
WR_2_0:
    v_mfma_f32_32x32x16_bf16 v[32:47], v[64:67], v[180:183], 0
    s_nop 2
    v_mul_f32 v196, v0, v96
    v_fmac_f32 v196, v1, v97
    v_fmac_f32 v196, v2, v98
    v_fmac_f32 v196, v3, v99
    v_fmac_f32 v196, v4, v100
    v_fmac_f32 v196, v5, v101
    v_fmac_f32 v196, v6, v102
    v_fmac_f32 v196, v7, v103
    v_mul_f32 v198, v8, v128
    v_fmac_f32 v198, v9, v129
    v_fmac_f32 v198, v10, v130
    v_fmac_f32 v198, v11, v131
    v_fmac_f32 v198, v12, v132
    v_fmac_f32 v198, v13, v133
    v_fmac_f32 v198, v14, v134
    v_fmac_f32 v198, v15, v135
    v_mul_f32 v200, v16, v128
    v_fmac_f32 v200, v17, v129
    v_permlane32_swap_b32 v196, v198
    v_mfma_f32_32x32x16_bf16 v[48:63], v[68:71], v[180:183], 0
    s_waitcnt vmcnt(6)
    ds_read_b64_tr_b16 v[176:177], v244 offset:2048
    ds_read_b64_tr_b16 v[178:179], v244 offset:3072
    ds_read_b64_tr_b16 v[180:181], v245 offset:2048
    ds_read_b64_tr_b16 v[182:183], v245 offset:3072
    v_fmac_f32 v200, v18, v130
    v_fmac_f32 v200, v19, v131
    v_fmac_f32 v200, v20, v132
    v_fmac_f32 v200, v21, v133
    v_fmac_f32 v200, v22, v134
    v_fmac_f32 v200, v23, v135
    v_add_f32 v198, v196, v198
    v_mul_f32_e64 v202, v24, -v128
    v_fma_f32 v202, v25, -v129, v202
    v_fma_f32 v202, v26, -v130, v202
    v_fma_f32 v202, v27, -v131, v202
    v_fma_f32 v202, v28, -v132, v202
    v_fma_f32 v202, v29, -v133, v202
    v_fma_f32 v202, v30, -v134, v202
    v_fma_f32 v202, v31, -v135, v202
    s_nop 1
    v_permlane32_swap_b32 v200, v202
    v_add_f32 v202, v200, v202
    s_waitcnt lgkmcnt(0)
    v_mfma_f32_32x32x16_bf16 v[0:15], v[64:67], v[176:179], 0
    v_mul_f32 v197, v32, v104
    v_fmac_f32 v197, v33, v105
    v_fmac_f32 v197, v34, v106
    v_fmac_f32 v197, v35, v107
    v_fmac_f32 v197, v36, v108
    v_fmac_f32 v197, v37, v109
    v_fmac_f32 v197, v38, v110
    v_fmac_f32 v197, v39, v111
    v_mul_f32 v199, v40, v136
    v_fmac_f32 v199, v41, v137
    v_fmac_f32 v199, v42, v138
    v_fmac_f32 v199, v43, v139
    v_fmac_f32 v199, v44, v140
    v_fmac_f32 v199, v45, v141
    v_fmac_f32 v199, v46, v142
    v_fmac_f32 v199, v47, v143
    v_mul_f32 v201, v48, v136
    v_fmac_f32 v201, v49, v137
    v_permlane32_swap_b32 v197, v199
    v_fmac_f32 v201, v50, v138
    s_add_u32 m0, s21, 2048
    s_cmp_eq_u32 s50, 4
    v_mfma_f32_32x32x16_bf16 v[16:31], v[68:71], v[176:179], 0
    s_cbranch_scc1 WL_2_1
    v_lshl_add_u32 v236, v236, 10, v246
    v_lshl_add_u32 v237, v237, 10, v246
    buffer_load_dwordx4 v236, s[4:7], s39 offen  lds
    buffer_load_dwordx4 v237, s[8:11], s39 offen offset:1024  lds
WR_2_1:
    v_fmac_f32 v201, v51, v139
    v_fmac_f32 v201, v52, v140
    v_fmac_f32 v201, v53, v141
    v_fmac_f32 v201, v54, v142
    v_fmac_f32 v201, v55, v143
    v_add_f32 v199, v197, v199
    v_mul_f32_e64 v203, v56, -v136
    v_fma_f32 v203, v57, -v137, v203
    v_fma_f32 v203, v58, -v138, v203
    v_fma_f32 v203, v59, -v139, v203
    v_fma_f32 v203, v60, -v140, v203
    v_fma_f32 v203, v61, -v141, v203
    v_fma_f32 v203, v62, -v142, v203
    v_fma_f32 v203, v63, -v143, v203
    s_nop 1
    v_permlane32_swap_b32 v201, v203
    v_add_f32 v203, v201, v203
    v_cvt_pk_bf16_f32 v192, v198, v199
    v_cvt_pk_bf16_f32 v193, v202, v203
    v_mfma_f32_32x32x16_bf16 v[32:47], v[64:67], v[180:183], 0
    v_mul_f32 v196, v0, v144
    v_fmac_f32 v196, v1, v145
    v_fmac_f32 v196, v2, v146
    v_fmac_f32 v196, v3, v147
    v_fmac_f32 v196, v4, v148
    v_fmac_f32 v196, v5, v149
    v_fmac_f32 v196, v6, v150
    v_fmac_f32 v196, v7, v151
    v_mul_f32 v198, v8, v112
    v_fmac_f32 v198, v9, v113
    v_fmac_f32 v198, v10, v114
    v_fmac_f32 v198, v11, v115
    v_fmac_f32 v198, v12, v116
    v_fmac_f32 v198, v13, v117
    v_fmac_f32 v198, v14, v118
    v_fmac_f32 v198, v15, v119
    v_mfma_f32_32x32x16_bf16 v[48:63], v[68:71], v[180:183], 0
    s_waitcnt vmcnt(6)
    ds_read_b64_tr_b16 v[176:177], v244 offset:4096
    ds_read_b64_tr_b16 v[178:179], v244 offset:5120
    ds_read_b64_tr_b16 v[180:181], v245 offset:4096
    ds_read_b64_tr_b16 v[182:183], v245 offset:5120
    v_mul_f32_e64 v200, v16, -v160
    v_fma_f32 v200, v17, -v161, v200
    v_fma_f32 v200, v18, -v162, v200
    v_fma_f32 v200, v19, -v163, v200
    v_fma_f32 v200, v20, -v164, v200
    v_fma_f32 v200, v21, -v165, v200
    v_fma_f32 v200, v22, -v166, v200
    v_fma_f32 v200, v23, -v167, v200
    v_mul_f32_e64 v202, v24, -v160
    v_fma_f32 v202, v25, -v161, v202
    v_fma_f32 v202, v26, -v162, v202
    v_fma_f32 v202, v27, -v163, v202
    v_fma_f32 v202, v28, -v164, v202
    v_fma_f32 v202, v29, -v165, v202
    v_fma_f32 v202, v30, -v166, v202
    v_fma_f32 v202, v31, -v167, v202
    s_waitcnt lgkmcnt(0)
    v_mfma_f32_32x32x16_bf16 v[0:15], v[64:67], v[176:179], 0
    v_mul_f32 v197, v32, v152
    v_fmac_f32 v197, v33, v153
    v_fmac_f32 v197, v34, v154
    v_fmac_f32 v197, v35, v155
    v_fmac_f32 v197, v36, v156
    v_fmac_f32 v197, v37, v157
    v_fmac_f32 v197, v38, v158
    v_fmac_f32 v197, v39, v159
    v_mul_f32 v199, v40, v120
    v_fmac_f32 v199, v41, v121
    v_fmac_f32 v199, v42, v122
    v_fmac_f32 v199, v43, v123
    v_fmac_f32 v199, v44, v124
    v_fmac_f32 v199, v45, v125
    v_fmac_f32 v199, v46, v126
    v_fmac_f32 v199, v47, v127
    s_add_u32 m0, s21, 4096
    s_cmp_eq_u32 s50, 4
    v_mfma_f32_32x32x16_bf16 v[16:31], v[68:71], v[176:179], 0
    s_cbranch_scc1 WL_2_2
    v_lshl_add_u32 v238, v238, 10, v246
    v_lshl_add_u32 v239, v239, 10, v246
    buffer_load_dwordx4 v238, s[4:7], s40 offen  lds
    buffer_load_dwordx4 v239, s[8:11], s40 offen offset:1024  lds
WR_2_2:
    v_mul_f32_e64 v201, v48, -v168
    v_fma_f32 v201, v49, -v169, v201
    v_fma_f32 v201, v50, -v170, v201
    v_fma_f32 v201, v51, -v171, v201
    v_fma_f32 v201, v52, -v172, v201
    v_fma_f32 v201, v53, -v173, v201
    v_fma_f32 v201, v54, -v174, v201
    v_fma_f32 v201, v55, -v175, v201
    v_mul_f32_e64 v203, v56, -v168
    v_fma_f32 v203, v57, -v169, v203
    v_fma_f32 v203, v58, -v170, v203
    v_fma_f32 v203, v59, -v171, v203
    v_fma_f32 v203, v60, -v172, v203
    v_fma_f32 v203, v61, -v173, v203
    v_fma_f32 v203, v62, -v174, v203
    v_fma_f32 v203, v63, -v175, v203
    v_mfma_f32_32x32x16_bf16 v[32:47], v[64:67], v[180:183], 0
    v_mul_f32 v254, v0, v144
    v_fmac_f32 v254, v1, v145
    v_fmac_f32 v254, v2, v146
    v_fmac_f32 v254, v3, v147
    v_fmac_f32 v254, v4, v148
    v_fmac_f32 v254, v5, v149
    v_fmac_f32 v254, v6, v150
    v_fmac_f32 v254, v7, v151
    v_fmac_f32 v200, v8, v160
    v_mfma_f32_32x32x16_bf16 v[48:63], v[68:71], v[180:183], 0
    ds_swizzle_b32 v68, v68 offset:0x401F
    ds_swizzle_b32 v69, v69 offset:0x401F
    ds_swizzle_b32 v70, v70 offset:0x401F
    ds_swizzle_b32 v71, v71 offset:0x401F
    s_waitcnt vmcnt(6)
    ds_read_b64_tr_b16 v[176:177], v244 offset:6144
    ds_read_b64_tr_b16 v[178:179], v244 offset:7168
    ds_read_b64_tr_b16 v[180:181], v245 offset:6144
    ds_read_b64_tr_b16 v[182:183], v245 offset:7168
    v_fmac_f32 v200, v9, v161
    v_permlane32_swap_b32 v196, v254
    v_fmac_f32 v200, v10, v162
    v_fmac_f32 v200, v11, v163
    v_fmac_f32 v200, v12, v164
    v_fmac_f32 v200, v13, v165
    v_fmac_f32 v200, v14, v166
    v_fmac_f32 v200, v15, v167
    v_add_f32 v254, v196, v254
    s_waitcnt lgkmcnt(0)
    s_mov_b64 exec, s[56:57]
    v_xor_b32 v68, 0x80008000, v68
    v_xor_b32 v69, 0x80008000, v69
    v_xor_b32 v70, 0x80008000, v70
    v_xor_b32 v71, 0x80008000, v71
    s_mov_b64 exec, -1
    s_nop 0
    v_mfma_f32_32x32x16_bf16 v[0:15], v[64:67], v[176:179], 0
    v_mul_f32 v255, v32, v152
    v_fmac_f32 v255, v33, v153
    v_fmac_f32 v255, v34, v154
    v_fmac_f32 v255, v35, v155
    v_fmac_f32 v255, v36, v156
    v_fmac_f32 v255, v37, v157
    v_fmac_f32 v255, v38, v158
    v_fmac_f32 v255, v39, v159
    v_fmac_f32 v201, v40, v168
    v_fmac_f32 v201, v41, v169
    s_add_u32 m0, s21, 6144
    s_cmp_eq_u32 s50, 4
    v_mfma_f32_32x32x16_bf16 v[16:31], v[68:71], v[176:179], v[16:31]
    s_cbranch_scc1 WL_2_3
    v_lshl_add_u32 v240, v240, 10, v246
    v_lshl_add_u32 v241, v241, 10, v246
    buffer_load_dwordx4 v240, s[4:7], s41 offen  lds
    buffer_load_dwordx4 v241, s[8:11], s41 offen offset:1024  lds
WR_2_3:
    v_permlane32_swap_b32 v197, v255
    v_fmac_f32 v201, v42, v170
    v_fmac_f32 v201, v43, v171
    v_fmac_f32 v201, v44, v172
    v_fmac_f32 v201, v45, v173
    v_fmac_f32 v201, v46, v174
    v_fmac_f32 v201, v47, v175
    v_add_f32 v255, v197, v255
    v_cvt_pk_bf16_f32 v194, v254, v255
    v_mfma_f32_32x32x16_bf16 v[32:47], v[64:67], v[180:183], 0
    v_mul_f32 v254, v0, v144
    v_fmac_f32 v254, v1, v145
    v_fmac_f32 v254, v2, v146
    v_fmac_f32 v254, v3, v147
    v_fmac_f32 v254, v4, v148
    v_fmac_f32 v254, v5, v149
    v_fmac_f32 v254, v6, v150
    v_fmac_f32 v254, v7, v151
    v_fma_f32 v202, v8, -v160, v202
    v_fma_f32 v202, v9, -v161, v202
    v_permlane32_swap_b32 v254, v200
    v_fma_f32 v202, v10, -v162, v202
    v_fma_f32 v202, v11, -v163, v202
    v_fma_f32 v202, v12, -v164, v202
    v_fma_f32 v202, v13, -v165, v202
    v_fma_f32 v202, v14, -v166, v202
    v_fma_f32 v202, v15, -v167, v202
    v_add_f32 v200, v254, v200
    v_fmac_f32 v198, v16, v112
    v_permlane32_swap_b32 v202, v254
    v_mfma_f32_32x32x16_bf16 v[48:63], v[68:71], v[180:183], v[48:63]
    s_waitcnt vmcnt(6)
    ds_read_b64_tr_b16 v[176:177], v244 offset:0
    ds_read_b64_tr_b16 v[178:179], v244 offset:1024
    ds_read_b64_tr_b16 v[180:181], v245 offset:0
    ds_read_b64_tr_b16 v[182:183], v245 offset:1024
    v_add_u32 v249, s48, v249
    v_add_u32 v250, s49, v250
    ds_read_b32 v252, v251 offset:16
    ds_read_b64_tr_b16 v[64:65], v249 offset:0
    ds_read_b64_tr_b16 v[68:69], v249 offset:64
    ds_read_b64_tr_b16 v[66:67], v249 offset:256
    ds_read_b64_tr_b16 v[70:71], v249 offset:320
    s_mov_b64 exec, s[54:55]
    ds_read_u16_d16_hi v242, v250 offset:0
    s_mov_b64 exec, -1
    v_fmac_f32 v198, v17, v113
    v_fmac_f32 v198, v18, v114
    v_fmac_f32 v198, v19, v115
    v_fmac_f32 v198, v20, v116
    v_fmac_f32 v198, v21, v117
    v_fmac_f32 v198, v22, v118
    v_fmac_f32 v198, v23, v119
    v_add_f32 v254, v202, v254
    v_mul_f32 v196, v24, v160
    v_fmac_f32 v196, v25, v161
    v_fmac_f32 v196, v26, v162
    v_fmac_f32 v196, v27, v163
    v_fmac_f32 v196, v28, v164
    v_fmac_f32 v196, v29, v165
    v_fmac_f32 v196, v30, v166
    v_fmac_f32 v196, v31, v167
    s_nop 1
    v_permlane32_swap_b32 v198, v196
    v_add_f32 v196, v198, v196
    s_cmp_eq_u32 s50, 4
    s_cbranch_scc1 LEPI_2
    v_mul_f32 v255, v32, v152
    v_fmac_f32 v255, v33, v153
    v_fmac_f32 v255, v34, v154
    v_fmac_f32 v255, v35, v155
    v_fmac_f32 v255, v36, v156
    v_fmac_f32 v255, v37, v157
    v_fmac_f32 v255, v38, v158
    v_fmac_f32 v255, v39, v159
    v_fma_f32 v203, v40, -v168, v203
    v_fma_f32 v203, v41, -v169, v203
    v_permlane32_swap_b32 v255, v201
    v_fma_f32 v203, v42, -v170, v203
    v_fma_f32 v203, v43, -v171, v203
    v_fma_f32 v203, v44, -v172, v203
    v_fma_f32 v203, v45, -v173, v203
    v_fma_f32 v203, v46, -v174, v203
    v_fma_f32 v203, v47, -v175, v203
    v_add_f32 v201, v255, v201
    v_fmac_f32 v199, v48, v120
    v_permlane32_swap_b32 v203, v255
    v_fmac_f32 v199, v49, v121
    v_fmac_f32 v199, v50, v122
    v_fmac_f32 v199, v51, v123
    v_fmac_f32 v199, v52, v124
    v_fmac_f32 v199, v53, v125
    v_fmac_f32 v199, v54, v126
    v_fmac_f32 v199, v55, v127
    v_add_f32 v255, v203, v255
    v_mul_f32 v197, v56, v168
    v_fmac_f32 v197, v57, v169
    v_fmac_f32 v197, v58, v170
    v_fmac_f32 v197, v59, v171
    v_fmac_f32 v197, v60, v172
    v_fmac_f32 v197, v61, v173
    v_fmac_f32 v197, v62, v174
    v_fmac_f32 v197, v63, v175
    s_nop 1
    v_permlane32_swap_b32 v199, v197
    v_add_f32 v197, v199, v197
    v_cvt_pk_bf16_f32 v200, v200, v201
    v_cvt_pk_bf16_f32 v254, v254, v255
    v_cvt_pk_bf16_f32 v196, v196, v197
    ds_write2st64_b32 v253, v192, v193 offset0:0 offset1:1
    ds_write2st64_b32 v253, v194, v200 offset0:2 offset1:3
    ds_write_b32 v253, v196 offset:1024
    s_mov_b64 exec, 0xffffffff
    ds_write_b32 v253, v254 offset:1280
    s_mov_b64 exec, -1
    s_add_u32 s50, s50, 1
    s_cmp_ge_u32 s50, 4
    s_cbranch_scc1 LAST1
    s_waitcnt lgkmcnt(9)
    v_readfirstlane_b32 s66, v252
    s_add_u32 s53, s53, 1
    v_mov_b32 v252, s53
    s_cmp_le_u32 s53, s66
    ds_write2_b32 v251, v252, v252 offset0:0 offset1:8
    s_setprio 1
    s_cbranch_scc1 PRIO_16
    s_setprio 0
PRIO_16:
    s_cmp_eq_u32 s52, 4
    s_cbranch_scc1 ITEM_1_4
    s_cmp_eq_u32 s52, 5
    s_cbranch_scc1 ITEM_1_5
    s_cmp_eq_u32 s52, 3
    s_cbranch_scc1 ITEM_1_3
    s_cmp_eq_u32 s52, 6
    s_cbranch_scc1 ITEM_1_6
    s_cmp_eq_u32 s52, 8
    s_cbranch_scc1 ITEM_1_8
    s_branch ITEM_1_2
WL_2_0:
    s_add_u32 s66, s51, 0
    buffer_load_dword v195, v246, s[16:19], s66 offen
    buffer_load_dword v195, v246, s[16:19], s66 offen
    s_branch WR_2_0
WL_2_1:
    s_add_u32 s66, s51, 4096
    buffer_load_dword v195, v246, s[16:19], s66 offen
    buffer_load_dword v195, v246, s[16:19], s66 offen
    s_branch WR_2_1
WL_2_2:
    s_add_u32 s66, s51, 8192
    buffer_load_dword v195, v246, s[16:19], s66 offen
    buffer_load_dword v195, v246, s[16:19], s66 offen
    s_branch WR_2_2
WL_2_3:
    s_add_u32 s66, s51, 12288
    buffer_load_dword v195, v246, s[16:19], s66 offen
    buffer_load_dword v195, v246, s[16:19], s66 offen
    s_branch WR_2_3
.p2align 6
.p2align 6
LEPI_2:
    s_lshl_b32 s71, s20, 4
    s_add_u32 s67, s51, 4096
    s_add_u32 s68, s51, 8192
    s_add_u32 s69, s51, 12288
    s_add_u32 s70, s51, 16384
    s_waitcnt lgkmcnt(0)
    buffer_load_dwordx4 v[96:99], v246, s[16:19], s51 offen offset:2048 sc1
    s_mov_b32 s52, 163072
    v_bfe_u32 v177, v246, 4, 4
    v_bfe_u32 v179, v246, 4, 3
    v_lshl_add_u32 v180, v177, 3, s52
    v_lshl_add_u32 v190, v177, 4, s52
    v_lshl_add_u32 v181, v179, 3, s52
    ds_read2_b64 v[182:185], v180 offset0:32 offset1:48
    ds_read_b32 v191, v190
    ds_read_b64 v[186:187], v181 offset:512
    v_lshrrev_b32 v178, 8, v246
    buffer_load_dwordx4 v[100:103], v246, s[16:19], s51 offen offset:3072 sc1
    v_add_u32 v234, s21, v248
    v_add_u32 v235, 128, v234
    v_mul_f32 v255, v32, v152
    buffer_load_dwordx4 v[104:107], v246, s[16:19], s67 offen offset:2048 sc1
    v_fmac_f32 v255, v33, v153
    v_fmac_f32 v255, v34, v154
    ds_write2st64_b32 v234, v204, v205 offset0:0 offset1:1
    v_fmac_f32 v255, v35, v155
    buffer_load_dwordx4 v[108:111], v246, s[16:19], s67 offen offset:3072 sc1
    v_fmac_f32 v255, v36, v156
    v_fmac_f32 v255, v37, v157
    ds_write2st64_b32 v234, v206, v207 offset0:2 offset1:3
    v_fmac_f32 v255, v38, v158
    buffer_load_dwordx4 v[128:131], v246, s[16:19], s68 offen offset:2048 sc1
    v_fmac_f32 v255, v39, v159
    v_fma_f32 v203, v40, -v168, v203
    ds_write2st64_b32 v234, v208, v209 offset0:4 offset1:5
    v_fma_f32 v203, v41, -v169, v203
    buffer_load_dwordx4 v[132:135], v246, s[16:19], s68 offen offset:3072 sc1
    v_permlane32_swap_b32 v255, v201
    v_fma_f32 v203, v42, -v170, v203
    ds_write2st64_b32 v235, v210, v211 offset0:6 offset1:7
    v_fma_f32 v203, v43, -v171, v203
    v_fma_f32 v203, v44, -v172, v203
    buffer_load_dwordx4 v[136:139], v246, s[16:19], s69 offen offset:2048 sc1
    v_fma_f32 v203, v45, -v173, v203
    ds_write2st64_b32 v235, v212, v213 offset0:8 offset1:9
    v_fma_f32 v203, v46, -v174, v203
    v_fma_f32 v203, v47, -v175, v203
    buffer_load_dwordx4 v[140:143], v246, s[16:19], s69 offen offset:3072 sc1
    v_add_f32 v201, v255, v201
    ds_write2st64_b32 v235, v214, v215 offset0:10 offset1:11
    v_fmac_f32 v199, v48, v120
    v_permlane32_swap_b32 v203, v255
    buffer_load_dwordx4 v[112:115], v246, s[16:19], s70 offen offset:2048 sc1
    v_fmac_f32 v199, v49, v121
    ds_write2st64_b32 v234, v216, v217 offset0:12 offset1:13
    v_fmac_f32 v199, v50, v122
    v_fmac_f32 v199, v51, v123
    buffer_load_dwordx4 v[116:119], v246, s[16:19], s70 offen offset:3072 sc1
    v_fmac_f32 v199, v52, v124
    ds_write2st64_b32 v234, v218, v219 offset0:14 offset1:15
    v_fmac_f32 v199, v53, v125
    v_fmac_f32 v199, v54, v126
    buffer_load_dwordx4 v[144:147], v246, s[16:19], s51 offen offset:0 sc1
    v_fmac_f32 v199, v55, v127
    v_add_f32 v255, v203, v255
    ds_write2st64_b32 v234, v220, v221 offset0:16 offset1:17
    v_mul_f32 v197, v56, v168
    buffer_load_dwordx4 v[148:151], v246, s[16:19], s51 offen offset:1024 sc1
    v_fmac_f32 v197, v57, v169
    v_fmac_f32 v197, v58, v170
    ds_write2st64_b32 v235, v222, v223 offset0:18 offset1:19
    v_fmac_f32 v197, v59, v171
    buffer_load_dwordx4 v[160:163], v246, s[16:19], s67 offen offset:0 sc1
    v_fmac_f32 v197, v60, v172
    v_fmac_f32 v197, v61, v173
    ds_write2st64_b32 v235, v224, v225 offset0:20 offset1:21
    v_fmac_f32 v197, v62, v174
    buffer_load_dwordx4 v[164:167], v246, s[16:19], s67 offen offset:1024 sc1
    v_fmac_f32 v197, v63, v175
    s_nop 1
    ds_write2st64_b32 v235, v226, v227 offset0:22 offset1:23
    v_permlane32_swap_b32 v199, v197
    ds_write2st64_b32 v234, v228, v229 offset0:24 offset1:25
    v_add_f32 v197, v199, v197
    v_cvt_pk_bf16_f32 v200, v200, v201
    ds_write2st64_b32 v234, v230, v231 offset0:26 offset1:27
    v_cvt_pk_bf16_f32 v254, v254, v255
    v_cvt_pk_bf16_f32 v196, v196, v197
    ds_write2st64_b32 v234, v232, v233 offset0:28 offset1:29
    ds_write2st64_b32 v253, v192, v193 offset0:0 offset1:1
    ds_write2st64_b32 v253, v194, v200 offset0:2 offset1:3
    ds_write_b32 v253, v196 offset:1024
    s_mov_b64 exec, 0xffffffff
    ds_write_b32 v253, v254 offset:1280
    s_mov_b64 exec, -1
    s_add_u32 s50, s53, 1
    v_mov_b32 v234, s50
    ds_write2_b32 v251, v234, v234 offset0:0 offset1:8
    s_waitcnt lgkmcnt(15)
    s_branch TAIL
.p2align 6
LEPI_1:
    s_lshl_b32 s71, s20, 4
    s_add_u32 s67, s51, 4096
    s_add_u32 s68, s51, 8192
    s_add_u32 s69, s51, 12288
    s_add_u32 s70, s51, 16384
    s_waitcnt lgkmcnt(0)
    buffer_load_dwordx4 v[112:115], v246, s[16:19], s70 offen offset:2048 sc1
    s_mov_b32 s52, 163072
    v_bfe_u32 v177, v246, 4, 4
    v_bfe_u32 v179, v246, 4, 3
    v_lshl_add_u32 v180, v177, 3, s52
    v_lshl_add_u32 v190, v177, 4, s52
    v_lshl_add_u32 v181, v179, 3, s52
    ds_read2_b64 v[182:185], v180 offset0:32 offset1:48
    ds_read_b32 v191, v190
    ds_read_b64 v[186:187], v181 offset:512
    v_lshrrev_b32 v178, 8, v246
    buffer_load_dwordx4 v[116:119], v246, s[16:19], s70 offen offset:3072 sc1
    v_add_u32 v234, s21, v248
    v_add_u32 v235, 128, v234
    v_mul_f32 v255, v32, v152
    v_fmac_f32 v255, v33, v153
    buffer_load_dwordx4 v[144:147], v246, s[16:19], s51 offen offset:0 sc1
    v_fmac_f32 v255, v34, v154
    v_fmac_f32 v255, v35, v155
    ds_write2st64_b32 v234, v204, v205 offset0:0 offset1:1
    v_fmac_f32 v255, v36, v156
    v_fmac_f32 v255, v37, v157
    buffer_load_dwordx4 v[148:151], v246, s[16:19], s51 offen offset:1024 sc1
    v_fmac_f32 v255, v38, v158
    v_fmac_f32 v255, v39, v159
    ds_write2st64_b32 v234, v206, v207 offset0:2 offset1:3
    v_fma_f32 v203, v40, -v168, v203
    v_fma_f32 v203, v41, -v169, v203
    v_permlane32_swap_b32 v255, v201
    buffer_load_dwordx4 v[160:163], v246, s[16:19], s67 offen offset:0 sc1
    v_fma_f32 v203, v42, -v170, v203
    v_fma_f32 v203, v43, -v171, v203
    ds_write2st64_b32 v234, v208, v209 offset0:4 offset1:5
    v_fma_f32 v203, v44, -v172, v203
    v_fma_f32 v203, v45, -v173, v203
    buffer_load_dwordx4 v[164:167], v246, s[16:19], s67 offen offset:1024 sc1
    v_fma_f32 v203, v46, -v174, v203
    v_fma_f32 v203, v47, -v175, v203
    ds_write2st64_b32 v235, v210, v211 offset0:6 offset1:7
    v_add_f32 v201, v255, v201
    v_fmac_f32 v199, v48, v120
    ds_write2st64_b32 v235, v212, v213 offset0:8 offset1:9
    v_permlane32_swap_b32 v203, v255
    v_fmac_f32 v199, v49, v121
    v_fmac_f32 v199, v50, v122
    ds_write2st64_b32 v235, v214, v215 offset0:10 offset1:11
    v_fmac_f32 v199, v51, v123
    v_fmac_f32 v199, v52, v124
    ds_write2st64_b32 v234, v216, v217 offset0:12 offset1:13
    v_fmac_f32 v199, v53, v125
    v_fmac_f32 v199, v54, v126
    ds_write2st64_b32 v234, v218, v219 offset0:14 offset1:15
    v_fmac_f32 v199, v55, v127
    v_add_f32 v255, v203, v255
    ds_write2st64_b32 v234, v220, v221 offset0:16 offset1:17
    v_mul_f32 v197, v56, v168
    v_fmac_f32 v197, v57, v169
    ds_write2st64_b32 v235, v222, v223 offset0:18 offset1:19
    v_fmac_f32 v197, v58, v170
    v_fmac_f32 v197, v59, v171
    v_fmac_f32 v197, v60, v172
    ds_write2st64_b32 v235, v224, v225 offset0:20 offset1:21
    v_fmac_f32 v197, v61, v173
    v_fmac_f32 v197, v62, v174
    ds_write2st64_b32 v235, v226, v227 offset0:22 offset1:23
    v_fmac_f32 v197, v63, v175
    s_nop 1
    ds_write2st64_b32 v234, v228, v229 offset0:24 offset1:25
    v_permlane32_swap_b32 v199, v197
    v_add_f32 v197, v199, v197
    ds_write2st64_b32 v234, v230, v231 offset0:26 offset1:27
    v_cvt_pk_bf16_f32 v200, v200, v201
    v_cvt_pk_bf16_f32 v254, v254, v255
    v_cvt_pk_bf16_f32 v196, v196, v197
    ds_write2st64_b32 v234, v232, v233 offset0:28 offset1:29
    ds_write2st64_b32 v253, v200, v196 offset0:3 offset1:4
    s_mov_b64 exec, 0xffffffff
    ds_write_b32 v253, v254 offset:1280
    s_mov_b64 exec, -1
    s_add_u32 s50, s53, 1
    v_mov_b32 v234, s50
    ds_write2_b32 v251, v234, v234 offset0:0 offset1:8
    s_waitcnt lgkmcnt(15)
    s_branch TAIL
.p2align 6
LEPI_0:
    s_lshl_b32 s71, s20, 4
    s_add_u32 s67, s51, 4096
    s_add_u32 s68, s51, 8192
    s_add_u32 s69, s51, 12288
    s_add_u32 s70, s51, 16384
    s_waitcnt lgkmcnt(0)
    buffer_load_dwordx4 v[112:115], v246, s[16:19], s70 offen offset:2048 sc1
    s_mov_b32 s52, 163072
    v_bfe_u32 v177, v246, 4, 4
    v_bfe_u32 v179, v246, 4, 3
    v_lshl_add_u32 v180, v177, 3, s52
    v_lshl_add_u32 v190, v177, 4, s52
    v_lshl_add_u32 v181, v179, 3, s52
    ds_read2_b64 v[182:185], v180 offset0:32 offset1:48
    ds_read_b32 v191, v190
    ds_read_b64 v[186:187], v181 offset:512
    v_lshrrev_b32 v178, 8, v246
    buffer_load_dwordx4 v[116:119], v246, s[16:19], s70 offen offset:3072 sc1
    v_add_u32 v234, s21, v248
    v_add_u32 v235, 128, v234
    v_mul_f32 v255, v32, v152
    v_fmac_f32 v255, v33, v153
    buffer_load_dwordx4 v[144:147], v246, s[16:19], s51 offen offset:0 sc1
    v_fmac_f32 v255, v34, v154
    v_fmac_f32 v255, v35, v155
    ds_write2st64_b32 v234, v204, v205 offset0:0 offset1:1
    v_fmac_f32 v255, v36, v156
    v_fmac_f32 v255, v37, v157
    buffer_load_dwordx4 v[148:151], v246, s[16:19], s51 offen offset:1024 sc1
    v_fmac_f32 v255, v38, v158
    v_fmac_f32 v255, v39, v159
    ds_write2st64_b32 v234, v206, v207 offset0:2 offset1:3
    v_fma_f32 v203, v40, -v168, v203
    v_fma_f32 v203, v41, -v169, v203
    v_permlane32_swap_b32 v255, v201
    buffer_load_dwordx4 v[160:163], v246, s[16:19], s67 offen offset:0 sc1
    v_fma_f32 v203, v42, -v170, v203
    v_fma_f32 v203, v43, -v171, v203
    ds_write2st64_b32 v234, v208, v209 offset0:4 offset1:5
    v_fma_f32 v203, v44, -v172, v203
    v_fma_f32 v203, v45, -v173, v203
    buffer_load_dwordx4 v[164:167], v246, s[16:19], s67 offen offset:1024 sc1
    v_fma_f32 v203, v46, -v174, v203
    v_fma_f32 v203, v47, -v175, v203
    ds_write2st64_b32 v235, v210, v211 offset0:6 offset1:7
    v_add_f32 v201, v255, v201
    v_fmac_f32 v199, v48, v120
    ds_write2st64_b32 v235, v212, v213 offset0:8 offset1:9
    v_permlane32_swap_b32 v203, v255
    v_fmac_f32 v199, v49, v121
    v_fmac_f32 v199, v50, v122
    ds_write2st64_b32 v235, v214, v215 offset0:10 offset1:11
    v_fmac_f32 v199, v51, v123
    v_fmac_f32 v199, v52, v124
    ds_write2st64_b32 v234, v216, v217 offset0:12 offset1:13
    v_fmac_f32 v199, v53, v125
    v_fmac_f32 v199, v54, v126
    ds_write2st64_b32 v234, v218, v219 offset0:14 offset1:15
    v_fmac_f32 v199, v55, v127
    v_add_f32 v255, v203, v255
    ds_write2st64_b32 v234, v220, v221 offset0:16 offset1:17
    v_mul_f32 v197, v56, v168
    v_fmac_f32 v197, v57, v169
    ds_write2st64_b32 v235, v222, v223 offset0:18 offset1:19
    v_fmac_f32 v197, v58, v170
    v_fmac_f32 v197, v59, v171
    v_fmac_f32 v197, v60, v172
    ds_write2st64_b32 v235, v224, v225 offset0:20 offset1:21
    v_fmac_f32 v197, v61, v173
    v_fmac_f32 v197, v62, v174
    ds_write2st64_b32 v235, v226, v227 offset0:22 offset1:23
    v_fmac_f32 v197, v63, v175
    s_nop 1
    ds_write2st64_b32 v234, v228, v229 offset0:24 offset1:25
    v_permlane32_swap_b32 v199, v197
    v_add_f32 v197, v199, v197
    ds_write2st64_b32 v234, v230, v231 offset0:26 offset1:27
    v_cvt_pk_bf16_f32 v200, v200, v201
    v_cvt_pk_bf16_f32 v254, v254, v255
    v_cvt_pk_bf16_f32 v196, v196, v197
    ds_write2st64_b32 v234, v232, v233 offset0:28 offset1:29
    ds_write2st64_b32 v253, v192, v193 offset0:0 offset1:1
    ds_write2st64_b32 v253, v194, v200 offset0:2 offset1:3
    ds_write_b32 v253, v196 offset:1024
    s_mov_b64 exec, 0xffffffff
    ds_write_b32 v253, v254 offset:1280
    s_mov_b64 exec, -1
    s_add_u32 s50, s53, 1
    v_mov_b32 v234, s50
    ds_write2_b32 v251, v234, v234 offset0:0 offset1:8
    s_waitcnt lgkmcnt(15)
TAIL:
    s_and_b32 s71, s20, 3
    s_lshl_b32 s71, s71, 2
    s_bitcmp0_b32 s20, 2
    s_addc_u32 s71, s71, 0
    v_readlane_b32 s71, v191, s71
    buffer_load_dwordx4 v[120:123], v246, s[16:19], s68 offen offset:0 sc1
    buffer_load_dwordx4 v[124:127], v246, s[16:19], s68 offen offset:1024 sc1
    s_cmp_ge_u32 s71, s50
    s_setprio 1
    s_cbranch_scc1 T_second
    s_setprio 0
T_second:
    buffer_load_dwordx4 v[152:155], v246, s[16:19], s69 offen offset:0 sc1
    buffer_load_dwordx4 v[156:159], v246, s[16:19], s69 offen offset:1024 sc1
    buffer_load_dwordx4 v[168:171], v246, s[16:19], s70 offen offset:0 sc1
    buffer_load_dwordx4 v[172:175], v246, s[16:19], s70 offen offset:1024 sc1
GEMM:
    v_cmp_gt_u32 vcc, s53, v191
    v_xor_b32 v180, v179, v178
    v_xor_b32 v188, 4, v180
    v_lshl_add_u32 v66, v180, 4, v183
    v_lshl_add_u32 v67, v188, 4, v183
    v_lshl_add_u32 v70, v180, 4, v185
    v_lshl_add_u32 v71, v188, 4, v185
    s_mov_b32 s4, s72
    s_and_b32 s5, s73, 0xffff
    s_mov_b32 s6, 10240000
    s_mov_b32 s7, 0x20000
    s_cbranch_vccnz T_pw
T_pwr:
    ds_read_b128 v[76:79], v66 offset:0
    ds_read_b128 v[80:83], v70 offset:0
    ds_read_b128 v[84:87], v67 offset:0
    ds_read_b128 v[88:91], v71 offset:0
    ds_read_b128 v[92:95], v66 offset:1024
    s_waitcnt vmcnt(19) lgkmcnt(4)
    v_mfma_f32_16x16x32_bf16 v[0:3], v[96:99], v[76:79], 0
    v_and_b32 v181, 8, v177
    v_add_u32 v189, v188, v181
    ds_read_b128 v[76:79], v70 offset:1024
    s_waitcnt lgkmcnt(4)
    v_mfma_f32_16x16x32_bf16 v[4:7], v[96:99], v[80:83], 0
    v_add_u32 v181, v180, v181
    v_lshl_add_u32 v64, v180, 4, v182
    ds_read_b128 v[80:83], v67 offset:1024
    s_waitcnt vmcnt(18) lgkmcnt(4)
    v_mfma_f32_16x16x32_bf16 v[0:3], v[100:103], v[84:87], v[0:3]
    v_lshl_add_u32 v65, v188, 4, v182
    v_lshl_add_u32 v68, v180, 4, v184
    ds_read_b128 v[84:87], v71 offset:1024
    s_waitcnt lgkmcnt(4)
    v_mfma_f32_16x16x32_bf16 v[4:7], v[100:103], v[88:91], v[4:7]
    v_lshl_add_u32 v69, v188, 4, v184
    v_lshl_add_u32 v72, v181, 4, v186
    ds_read_b128 v[88:91], v66 offset:128
    s_waitcnt vmcnt(17) lgkmcnt(4)
    v_mfma_f32_16x16x32_bf16 v[0:3], v[104:107], v[92:95], v[0:3]
    v_lshl_add_u32 v73, v189, 4, v186
    v_lshl_add_u32 v74, v181, 4, v187
    ds_read_b128 v[92:95], v66 offset:256
    s_waitcnt lgkmcnt(4)
    v_mfma_f32_16x16x32_bf16 v[4:7], v[104:107], v[76:79], v[4:7]
    v_lshl_add_u32 v75, v189, 4, v187
    s_mov_b32 s67, 0xbfb8aa3b
    ds_read_b128 v[76:79], v66 offset:384
    s_waitcnt vmcnt(16) lgkmcnt(4)
    v_mfma_f32_16x16x32_bf16 v[0:3], v[108:111], v[80:83], v[0:3]
    v_lshrrev_b32 v205, 1, v178
    v_lshl_add_u32 v205, s20, 1, v205
    ds_read_b128 v[80:83], v70 offset:128
    s_waitcnt lgkmcnt(4)
    v_mfma_f32_16x16x32_bf16 v[4:7], v[108:111], v[84:87], v[4:7]
    v_xor_b32 v205, v205, v179
    v_and_b32 v204, 1, v178
    ds_read_b128 v[84:87], v70 offset:256
    s_waitcnt vmcnt(15) lgkmcnt(4)
    v_mfma_f32_16x16x32_bf16 v[12:15], v[128:131], v[88:91], 0
    v_lshlrev_b32 v204, 3, v204
    v_lshl_add_u32 v205, v205, 4, v204
    ds_read_b128 v[88:91], v70 offset:384
    s_waitcnt lgkmcnt(4)
    v_mfma_f32_16x16x32_bf16 v[24:27], v[128:131], v[92:95], 0
    v_and_b32 v220, 8, v177
    v_lshl_add_u32 v204, v220, 4, v205
    ds_read_b128 v[92:95], v67 offset:128
    s_waitcnt lgkmcnt(4)
    v_mfma_f32_16x16x32_bf16 v[36:39], v[128:131], v[76:79], 0
    v_lshl_add_u32 v204, v177, 10, v204
    v_add_u32 v204, 65536, v204
    ds_read_b128 v[76:79], v67 offset:256
    s_waitcnt lgkmcnt(4)
    v_mfma_f32_16x16x32_bf16 v[16:19], v[128:131], v[80:83], 0
    v_add_u32 v205, v205, v182
    v_mul_u32_u24 v220, 1008, v220
    ds_read_b128 v[80:83], v67 offset:384
    s_waitcnt lgkmcnt(4)
    v_mfma_f32_16x16x32_bf16 v[28:31], v[128:131], v[84:87], 0
    v_sub_u32 v220, v204, v220
    s_lshl_b32 s70, s20, 4
    ds_read_b128 v[84:87], v71 offset:128
    s_waitcnt lgkmcnt(4)
    v_mfma_f32_16x16x32_bf16 v[40:43], v[128:131], v[88:91], 0
    v_xor_b32 v206, s70, v246
    s_lshl_b32 s70, s20, 10
    ds_read_b128 v[88:91], v71 offset:256
    s_waitcnt vmcnt(14) lgkmcnt(4)
    v_mfma_f32_16x16x32_bf16 v[12:15], v[132:135], v[92:95], v[12:15]
    s_add_u32 s70, s70, 65536
    v_add_u32 v207, s21, v206
    ds_read_b128 v[92:95], v71 offset:384
    s_waitcnt lgkmcnt(4)
    v_mfma_f32_16x16x32_bf16 v[24:27], v[132:135], v[76:79], v[24:27]
    v_add_u32 v206, s70, v206
    s_mul_i32 s66, s2, 40960
    ds_read_b128 v[76:79], v66 offset:512
    s_waitcnt lgkmcnt(4)
    v_mfma_f32_16x16x32_bf16 v[36:39], v[132:135], v[80:83], v[36:39]
    s_bfe_u32 s22, s22, 393237
    s_lshl_b32 s22, s22, 10
    ds_read_b128 v[80:83], v66 offset:640
    s_waitcnt lgkmcnt(4)
    v_mfma_f32_16x16x32_bf16 v[16:19], v[132:135], v[84:87], v[16:19]
    s_add_u32 s22, s22, s66
    s_bfe_u32 s23, s23, 393237
    ds_read_b128 v[84:87], v66 offset:768
    s_waitcnt lgkmcnt(4)
    v_mfma_f32_16x16x32_bf16 v[28:31], v[132:135], v[88:91], v[28:31]
    s_lshl_b32 s23, s23, 10
    s_add_u32 s23, s23, s66
    ds_read_b128 v[88:91], v70 offset:512
    s_waitcnt lgkmcnt(4)
    v_mfma_f32_16x16x32_bf16 v[40:43], v[132:135], v[92:95], v[40:43]
    s_bfe_u32 s24, s24, 393237
    s_lshl_b32 s24, s24, 10
    ds_read_b128 v[92:95], v70 offset:640
    s_waitcnt vmcnt(13) lgkmcnt(4)
    v_mfma_f32_16x16x32_bf16 v[12:15], v[136:139], v[76:79], v[12:15]
    s_add_u32 s24, s24, s66
    s_bfe_u32 s25, s25, 393237
    ds_read_b128 v[76:79], v70 offset:768
    s_waitcnt lgkmcnt(4)
    v_mfma_f32_16x16x32_bf16 v[24:27], v[136:139], v[80:83], v[24:27]
    s_lshl_b32 s25, s25, 10
    s_add_u32 s25, s25, s66
    ds_read_b128 v[80:83], v67 offset:512
    s_waitcnt lgkmcnt(4)
    v_mfma_f32_16x16x32_bf16 v[36:39], v[136:139], v[84:87], v[36:39]
    s_bfe_u32 s26, s26, 393237
    s_lshl_b32 s26, s26, 10
    ds_read_b128 v[84:87], v67 offset:640
    s_waitcnt lgkmcnt(4)
    v_mfma_f32_16x16x32_bf16 v[16:19], v[136:139], v[88:91], v[16:19]
    s_add_u32 s26, s26, s66
    ds_read_b128 v[88:91], v67 offset:768
    s_waitcnt lgkmcnt(4)
    v_mfma_f32_16x16x32_bf16 v[28:31], v[136:139], v[92:95], v[28:31]
    ds_read_b128 v[92:95], v71 offset:512
    s_waitcnt lgkmcnt(4)
    v_mfma_f32_16x16x32_bf16 v[40:43], v[136:139], v[76:79], v[40:43]
    ds_read_b128 v[76:79], v71 offset:640
    s_waitcnt vmcnt(12) lgkmcnt(4)
    v_mfma_f32_16x16x32_bf16 v[12:15], v[140:143], v[80:83], v[12:15]
    ds_read_b128 v[80:83], v71 offset:768
    s_waitcnt lgkmcnt(4)
    v_mfma_f32_16x16x32_bf16 v[24:27], v[140:143], v[84:87], v[24:27]
    ds_read_b128 v[84:87], v66 offset:1152
    s_waitcnt lgkmcnt(4)
    v_mfma_f32_16x16x32_bf16 v[36:39], v[140:143], v[88:91], v[36:39]
    ds_read_b128 v[88:91], v66 offset:1280
    s_waitcnt lgkmcnt(4)
    v_mfma_f32_16x16x32_bf16 v[16:19], v[140:143], v[92:95], v[16:19]
    ds_read_b128 v[92:95], v66 offset:896
    s_waitcnt lgkmcnt(4)
    v_mfma_f32_16x16x32_bf16 v[28:31], v[140:143], v[76:79], v[28:31]
    ds_read_b128 v[76:79], v70 offset:1152
    s_waitcnt lgkmcnt(4)
    v_mfma_f32_16x16x32_bf16 v[40:43], v[140:143], v[80:83], v[40:43]
    ds_read_b128 v[80:83], v70 offset:1280
    s_waitcnt vmcnt(11) lgkmcnt(4)
    v_mfma_f32_16x16x32_bf16 v[12:15], v[112:115], v[84:87], v[12:15]
    ds_read_b128 v[84:87], v70 offset:896
    s_waitcnt lgkmcnt(4)
    v_mfma_f32_16x16x32_bf16 v[24:27], v[112:115], v[88:91], v[24:27]
    ds_read_b128 v[88:91], v67 offset:1152
    s_waitcnt lgkmcnt(4)
    v_mfma_f32_16x16x32_bf16 v[36:39], v[112:115], v[92:95], v[36:39]
    ds_read_b128 v[92:95], v67 offset:1280
    s_waitcnt lgkmcnt(4)
    v_mfma_f32_16x16x32_bf16 v[16:19], v[112:115], v[76:79], v[16:19]
    ds_read_b128 v[76:79], v67 offset:896
    s_waitcnt lgkmcnt(4)
    v_mfma_f32_16x16x32_bf16 v[28:31], v[112:115], v[80:83], v[28:31]
    ds_read_b32 v191, v190
    ds_read_b128 v[80:83], v71 offset:1152
    s_waitcnt lgkmcnt(5)
    v_mfma_f32_16x16x32_bf16 v[40:43], v[112:115], v[84:87], v[40:43]
    ds_read_b128 v[84:87], v71 offset:1280
    s_waitcnt vmcnt(10) lgkmcnt(5)
    v_mfma_f32_16x16x32_bf16 v[12:15], v[116:119], v[88:91], v[12:15]
    ds_read_b128 v[88:91], v71 offset:896
    s_waitcnt lgkmcnt(5)
    v_mfma_f32_16x16x32_bf16 v[24:27], v[116:119], v[92:95], v[24:27]
    s_waitcnt lgkmcnt(3)
    v_cmp_gt_u32 vcc, s50, v191
    s_cbranch_vccnz T_aw
T_awr:
    ds_read_b128 v[92:95], v64 offset:0
    v_mfma_f32_16x16x32_bf16 v[36:39], v[116:119], v[76:79], v[36:39]
    ds_read_b128 v[76:79], v68 offset:0
    s_waitcnt lgkmcnt(4)
    v_mfma_f32_16x16x32_bf16 v[16:19], v[116:119], v[80:83], v[16:19]
    ds_read_b128 v[80:83], v65 offset:0
    s_waitcnt lgkmcnt(4)
    v_mfma_f32_16x16x32_bf16 v[28:31], v[116:119], v[84:87], v[28:31]
    ds_read_b128 v[84:87], v69 offset:0
    s_waitcnt lgkmcnt(4)
    v_mfma_f32_16x16x32_bf16 v[40:43], v[116:119], v[88:91], v[40:43]
    ds_read_b128 v[88:91], v64 offset:1024
    s_waitcnt vmcnt(9) lgkmcnt(4)
    v_mfma_f32_16x16x32_bf16 v[0:3], v[144:147], v[92:95], v[0:3]
    ds_read_b128 v[92:95], v68 offset:1024
    s_waitcnt lgkmcnt(4)
    v_mfma_f32_16x16x32_bf16 v[4:7], v[144:147], v[76:79], v[4:7]
    ds_read_b128 v[76:79], v65 offset:1024
    s_waitcnt vmcnt(8) lgkmcnt(4)
    v_mfma_f32_16x16x32_bf16 v[0:3], v[148:151], v[80:83], v[0:3]
    ds_read_b128 v[80:83], v69 offset:1024
    s_waitcnt lgkmcnt(4)
    v_mfma_f32_16x16x32_bf16 v[4:7], v[148:151], v[84:87], v[4:7]
    ds_read_b128 v[84:87], v72 offset:0
    s_waitcnt vmcnt(7) lgkmcnt(4)
    v_mfma_f32_16x16x32_bf16 v[0:3], v[160:163], v[88:91], v[0:3]
    ds_read_b128 v[88:91], v73 offset:0
    s_waitcnt lgkmcnt(4)
    v_mfma_f32_16x16x32_bf16 v[4:7], v[160:163], v[92:95], v[4:7]
    ds_read_b128 v[92:95], v74 offset:0
    s_waitcnt vmcnt(6) lgkmcnt(4)
    v_mfma_f32_16x16x32_bf16 v[0:3], v[164:167], v[76:79], v[0:3]
    ds_read_b128 v[76:79], v75 offset:0
    s_waitcnt lgkmcnt(4)
    v_mfma_f32_16x16x32_bf16 v[4:7], v[164:167], v[80:83], v[4:7]
    ds_read_b128 v[80:83], v72 offset:1024
    s_waitcnt lgkmcnt(4)
    v_mfma_f32_16x16x32_bf16 v[8:11], v[144:147], v[84:87], 0
    ds_read_b128 v[84:87], v73 offset:1024
    s_waitcnt lgkmcnt(4)
    v_mfma_f32_16x16x32_bf16 v[8:11], v[148:151], v[88:91], v[8:11]
    v_mul_f32 v192, s67, v0
    v_mul_f32 v193, s67, v1
    ds_read_b128 v[88:91], v74 offset:1024
    s_waitcnt lgkmcnt(4)
    v_mfma_f32_16x16x32_bf16 v[8:11], v[96:99], v[92:95], v[8:11]
    v_mul_f32 v194, s67, v2
    v_mul_f32 v195, s67, v3
    ds_read_b128 v[92:95], v75 offset:1024
    s_waitcnt lgkmcnt(4)
    v_mfma_f32_16x16x32_bf16 v[8:11], v[100:103], v[76:79], v[8:11]
    v_exp_f32 v192, v192
    v_exp_f32 v193, v193
    ds_read_b128 v[76:79], v64 offset:128
    s_waitcnt lgkmcnt(4)
    v_mfma_f32_16x16x32_bf16 v[8:11], v[160:163], v[80:83], v[8:11]
    v_exp_f32 v194, v194
    v_exp_f32 v195, v195
    ds_read_b128 v[80:83], v65 offset:128
    s_waitcnt lgkmcnt(4)
    v_mfma_f32_16x16x32_bf16 v[8:11], v[164:167], v[84:87], v[8:11]
    v_add_f32 v192, 1.0, v192
    v_add_f32 v193, 1.0, v193
    ds_read_b128 v[84:87], v64 offset:512
    s_waitcnt lgkmcnt(4)
    v_mfma_f32_16x16x32_bf16 v[8:11], v[104:107], v[88:91], v[8:11]
    v_add_f32 v194, 1.0, v194
    v_add_f32 v195, 1.0, v195
    ds_read_b128 v[88:91], v65 offset:512
    s_waitcnt lgkmcnt(4)
    v_mfma_f32_16x16x32_bf16 v[8:11], v[108:111], v[92:95], v[8:11]
    v_rcp_f32 v192, v192
    v_rcp_f32 v193, v193
    ds_read_b128 v[92:95], v64 offset:1152
    s_waitcnt vmcnt(5) lgkmcnt(4)
    v_mfma_f32_16x16x32_bf16 v[12:15], v[120:123], v[76:79], v[12:15]
    v_rcp_f32 v194, v194
    v_rcp_f32 v195, v195
    ds_read_b128 v[76:79], v65 offset:1152
    s_waitcnt vmcnt(4) lgkmcnt(4)
    v_mfma_f32_16x16x32_bf16 v[12:15], v[124:127], v[80:83], v[12:15]
    v_cvt_pk_bf16_f32 v0, v0, v1
    v_cvt_pk_bf16_f32 v1, v2, v3
    ds_read_b128 v[80:83], v64 offset:256
    s_waitcnt vmcnt(3) lgkmcnt(4)
    v_mfma_f32_16x16x32_bf16 v[12:15], v[152:155], v[84:87], v[12:15]
    ds_write_b64 v204, v[0:1] offset:0
    v_mul_f32 v196, s67, v4
    ds_read_b128 v[84:87], v65 offset:256
    s_waitcnt vmcnt(2) lgkmcnt(5)
    v_mfma_f32_16x16x32_bf16 v[12:15], v[156:159], v[88:91], v[12:15]
    v_mul_f32 v197, s67, v5
    v_mul_f32 v198, s67, v6
    ds_read_b128 v[88:91], v64 offset:640
    s_waitcnt vmcnt(1) lgkmcnt(5)
    v_mfma_f32_16x16x32_bf16 v[12:15], v[168:171], v[92:95], v[12:15]
    v_mul_f32 v199, s67, v7
    v_exp_f32 v196, v196
    ds_read_b128 v[92:95], v65 offset:640
    s_waitcnt vmcnt(0) lgkmcnt(5)
    v_mfma_f32_16x16x32_bf16 v[12:15], v[172:175], v[76:79], v[12:15]
    v_exp_f32 v197, v197
    v_exp_f32 v198, v198
    ds_read_b128 v[76:79], v64 offset:1280
    s_waitcnt lgkmcnt(5)
    v_mfma_f32_16x16x32_bf16 v[24:27], v[120:123], v[80:83], v[24:27]
    v_exp_f32 v199, v199
    v_add_f32 v196, 1.0, v196
    ds_read_b128 v[80:83], v65 offset:1280
    s_waitcnt lgkmcnt(4)
    v_mfma_f32_16x16x32_bf16 v[24:27], v[124:127], v[84:87], v[24:27]
    v_mul_f32 v12, v12, v192
    v_mul_f32 v13, v13, v193
    ds_read_b128 v[84:87], v64 offset:384
    s_waitcnt lgkmcnt(4)
    v_mfma_f32_16x16x32_bf16 v[24:27], v[152:155], v[88:91], v[24:27]
    v_mul_f32 v14, v14, v194
    v_mul_f32 v15, v15, v195
    ds_read_b128 v[88:91], v65 offset:384
    s_waitcnt lgkmcnt(4)
    v_mfma_f32_16x16x32_bf16 v[24:27], v[156:159], v[92:95], v[24:27]
    v_cvt_pk_bf16_f32 v12, v12, v13
    v_cvt_pk_bf16_f32 v13, v14, v15
    ds_read_b128 v[92:95], v64 offset:768
    s_waitcnt lgkmcnt(4)
    v_mfma_f32_16x16x32_bf16 v[24:27], v[168:171], v[76:79], v[24:27]
    ds_write_b64 v204, v[12:13] offset:256
    v_add_f32 v197, 1.0, v197
    ds_read_b128 v[76:79], v65 offset:768
    s_waitcnt lgkmcnt(5)
    v_mfma_f32_16x16x32_bf16 v[24:27], v[172:175], v[80:83], v[24:27]
    v_add_f32 v198, 1.0, v198
    v_add_f32 v199, 1.0, v199
    ds_read_b128 v[80:83], v64 offset:896
    s_waitcnt lgkmcnt(5)
    v_mfma_f32_16x16x32_bf16 v[36:39], v[120:123], v[84:87], v[36:39]
    v_rcp_f32 v196, v196
    v_rcp_f32 v197, v197
    ds_read_b128 v[84:87], v65 offset:896
    s_waitcnt lgkmcnt(5)
    v_mfma_f32_16x16x32_bf16 v[36:39], v[124:127], v[88:91], v[36:39]
    v_rcp_f32 v198, v198
    v_rcp_f32 v199, v199
    ds_read_b128 v[88:91], v68 offset:128
    s_waitcnt lgkmcnt(5)
    v_mfma_f32_16x16x32_bf16 v[36:39], v[152:155], v[92:95], v[36:39]
    v_mul_f32 v24, v24, v192
    v_mul_f32 v25, v25, v193
    ds_read_b128 v[92:95], v69 offset:128
    s_waitcnt lgkmcnt(4)
    v_mfma_f32_16x16x32_bf16 v[36:39], v[156:159], v[76:79], v[36:39]
    v_mul_f32 v26, v26, v194
    v_mul_f32 v27, v27, v195
    ds_read_b128 v[76:79], v68 offset:512
    s_waitcnt lgkmcnt(4)
    v_mfma_f32_16x16x32_bf16 v[36:39], v[168:171], v[80:83], v[36:39]
    v_cvt_pk_bf16_f32 v24, v24, v25
    v_cvt_pk_bf16_f32 v25, v26, v27
    ds_read_b128 v[80:83], v69 offset:512
    s_waitcnt lgkmcnt(4)
    v_mfma_f32_16x16x32_bf16 v[36:39], v[172:175], v[84:87], v[36:39]
    ds_write_b64 v204, v[24:25] offset:512
    v_mul_f32 v200, s67, v8
    ds_read_b128 v[84:87], v68 offset:1152
    s_waitcnt lgkmcnt(5)
    v_mfma_f32_16x16x32_bf16 v[16:19], v[120:123], v[88:91], v[16:19]
    v_mul_f32 v201, s67, v9
    v_mul_f32 v202, s67, v10
    ds_read_b128 v[88:91], v69 offset:1152
    s_waitcnt lgkmcnt(5)
    v_mfma_f32_16x16x32_bf16 v[16:19], v[124:127], v[92:95], v[16:19]
    v_mul_f32 v203, s67, v11
    v_exp_f32 v200, v200
    ds_read_b128 v[92:95], v68 offset:256
    s_waitcnt lgkmcnt(5)
    v_mfma_f32_16x16x32_bf16 v[16:19], v[152:155], v[76:79], v[16:19]
    v_mul_f32 v36, v36, v192
    v_mul_f32 v37, v37, v193
    ds_read_b128 v[76:79], v69 offset:256
    s_waitcnt lgkmcnt(5)
    v_mfma_f32_16x16x32_bf16 v[16:19], v[156:159], v[80:83], v[16:19]
    v_mul_f32 v38, v38, v194
    v_mul_f32 v39, v39, v195
    ds_read_b128 v[80:83], v68 offset:640
    s_waitcnt lgkmcnt(4)
    v_mfma_f32_16x16x32_bf16 v[16:19], v[168:171], v[84:87], v[16:19]
    v_cvt_pk_bf16_f32 v36, v36, v37
    v_cvt_pk_bf16_f32 v37, v38, v39
    ds_read_b128 v[84:87], v69 offset:640
    s_waitcnt lgkmcnt(4)
    v_mfma_f32_16x16x32_bf16 v[16:19], v[172:175], v[88:91], v[16:19]
    ds_write_b64 v204, v[36:37] offset:768
    v_exp_f32 v201, v201
    ds_read_b128 v[88:91], v68 offset:1280
    s_waitcnt lgkmcnt(5)
    v_mfma_f32_16x16x32_bf16 v[28:31], v[120:123], v[92:95], v[28:31]
    v_exp_f32 v202, v202
    v_exp_f32 v203, v203
    ds_read_b128 v[92:95], v69 offset:1280
    s_waitcnt lgkmcnt(5)
    v_mfma_f32_16x16x32_bf16 v[28:31], v[124:127], v[76:79], v[28:31]
    v_add_f32 v200, 1.0, v200
    v_add_f32 v201, 1.0, v201
    ds_read_b128 v[76:79], v68 offset:384
    s_waitcnt lgkmcnt(5)
    v_mfma_f32_16x16x32_bf16 v[28:31], v[152:155], v[80:83], v[28:31]
    v_add_f32 v202, 1.0, v202
    v_add_f32 v203, 1.0, v203
    ds_read_b128 v[80:83], v69 offset:384
    s_waitcnt lgkmcnt(5)
    v_mfma_f32_16x16x32_bf16 v[28:31], v[156:159], v[84:87], v[28:31]
    v_rcp_f32 v200, v200
    v_rcp_f32 v201, v201
    ds_read_b128 v[84:87], v68 offset:768
    s_waitcnt lgkmcnt(4)
    v_mfma_f32_16x16x32_bf16 v[28:31], v[168:171], v[88:91], v[28:31]
    v_rcp_f32 v202, v202
    v_rcp_f32 v203, v203
    ds_read_b128 v[88:91], v69 offset:768
    s_waitcnt lgkmcnt(4)
    v_mfma_f32_16x16x32_bf16 v[28:31], v[172:175], v[92:95], v[28:31]
    v_mov_b32_dpp v200, v200 row_ror:8 row_mask:0xf bank_mask:0xc
    ds_read_b128 v[92:95], v68 offset:896
    s_waitcnt lgkmcnt(4)
    v_mfma_f32_16x16x32_bf16 v[40:43], v[120:123], v[76:79], v[40:43]
    v_mov_b32_dpp v201, v201 row_ror:8 row_mask:0xf bank_mask:0xc
    v_mov_b32_dpp v202, v202 row_ror:8 row_mask:0xf bank_mask:0xc
    ds_read_b128 v[76:79], v69 offset:896
    s_waitcnt lgkmcnt(4)
    v_mfma_f32_16x16x32_bf16 v[40:43], v[124:127], v[80:83], v[40:43]
    v_mov_b32_dpp v203, v203 row_ror:8 row_mask:0xf bank_mask:0xc
    ds_read_b128 v[80:83], v72 offset:128
    s_waitcnt lgkmcnt(4)
    v_mfma_f32_16x16x32_bf16 v[40:43], v[152:155], v[84:87], v[40:43]
    s_barrier
    ds_read_b128 v[212:215], v206 offset:0
    ds_read_b128 v[84:87], v73 offset:128
    s_waitcnt lgkmcnt(5)
    v_mfma_f32_16x16x32_bf16 v[40:43], v[156:159], v[88:91], v[40:43]
    ds_read_b128 v[216:219], v206 offset:8320
    v_cvt_pk_bf16_f32 v4, v4, v5
    ds_read_b128 v[88:91], v74 offset:128
    s_waitcnt lgkmcnt(6)
    v_mfma_f32_16x16x32_bf16 v[40:43], v[168:171], v[92:95], v[40:43]
    v_cvt_pk_bf16_f32 v5, v6, v7
    ds_write_b64 v205, v[4:5] offset:0
    ds_read_b128 v[92:95], v75 offset:128
    s_waitcnt lgkmcnt(7)
    v_mfma_f32_16x16x32_bf16 v[40:43], v[172:175], v[76:79], v[40:43]
    v_mul_f32 v16, v16, v196
    v_mul_f32 v17, v17, v197
    ds_read_b128 v[76:79], v72 offset:512
    s_waitcnt lgkmcnt(7)
    v_mfma_f32_16x16x32_bf16 v[20:23], v[120:123], v[80:83], 0
    v_mul_f32 v18, v18, v198
    v_mul_f32 v19, v19, v199
    ds_read_b128 v[80:83], v73 offset:512
    s_waitcnt lgkmcnt(6)
    v_mfma_f32_16x16x32_bf16 v[20:23], v[124:127], v[84:87], v[20:23]
    v_cvt_pk_bf16_f32 v16, v16, v17
    v_cvt_pk_bf16_f32 v17, v18, v19
    ds_read_b128 v[84:87], v74 offset:512
    s_waitcnt lgkmcnt(5)
    v_mfma_f32_16x16x32_bf16 v[20:23], v[128:131], v[88:91], v[20:23]
    ds_write_b64 v205, v[16:17] offset:256
    ds_read_b128 v[88:91], v75 offset:512
    s_waitcnt lgkmcnt(5)
    v_mfma_f32_16x16x32_bf16 v[20:23], v[132:135], v[92:95], v[20:23]
    buffer_store_dwordx4 v[212:215], v246, s[4:7], s22 offen sc1
    ds_read_b128 v[92:95], v72 offset:1152
    s_waitcnt lgkmcnt(5)
    v_mfma_f32_16x16x32_bf16 v[20:23], v[152:155], v[76:79], v[20:23]
    buffer_store_dwordx4 v[216:219], v246, s[4:7], s23 offen sc1
    v_mul_f32 v28, v28, v196
    ds_read_b128 v[76:79], v73 offset:1152
    s_waitcnt lgkmcnt(5)
    v_mfma_f32_16x16x32_bf16 v[20:23], v[156:159], v[80:83], v[20:23]
    v_mul_f32 v29, v29, v197
    v_mul_f32 v30, v30, v198
    ds_read_b128 v[80:83], v74 offset:1152
    s_waitcnt lgkmcnt(5)
    v_mfma_f32_16x16x32_bf16 v[20:23], v[136:139], v[84:87], v[20:23]
    v_mul_f32 v31, v31, v199
    v_cvt_pk_bf16_f32 v28, v28, v29
    ds_read_b128 v[84:87], v75 offset:1152
    s_waitcnt lgkmcnt(4)
    v_mfma_f32_16x16x32_bf16 v[20:23], v[140:143], v[88:91], v[20:23]
    v_cvt_pk_bf16_f32 v29, v30, v31
    ds_write_b64 v205, v[28:29] offset:512
    ds_read_b128 v[88:91], v72 offset:384
    s_waitcnt lgkmcnt(5)
    v_mfma_f32_16x16x32_bf16 v[20:23], v[168:171], v[92:95], v[20:23]
    v_mul_f32 v40, v40, v196
    v_mul_f32 v41, v41, v197
    ds_read_b128 v[92:95], v73 offset:384
    s_waitcnt lgkmcnt(5)
    v_mfma_f32_16x16x32_bf16 v[20:23], v[172:175], v[76:79], v[20:23]
    v_mul_f32 v42, v42, v198
    v_mul_f32 v43, v43, v199
    ds_read_b128 v[76:79], v74 offset:384
    s_waitcnt lgkmcnt(5)
    v_mfma_f32_16x16x32_bf16 v[20:23], v[112:115], v[80:83], v[20:23]
    v_cvt_pk_bf16_f32 v40, v40, v41
    v_cvt_pk_bf16_f32 v41, v42, v43
    ds_read_b128 v[80:83], v75 offset:384
    s_waitcnt lgkmcnt(5)
    v_mfma_f32_16x16x32_bf16 v[20:23], v[116:119], v[84:87], v[20:23]
    ds_write_b64 v205, v[40:41] offset:768
    ds_read_b128 v[84:87], v72 offset:768
    s_waitcnt lgkmcnt(5)
    v_mfma_f32_16x16x32_bf16 v[44:47], v[120:123], v[88:91], 0
    ds_read_b128 v[88:91], v73 offset:768
    s_waitcnt lgkmcnt(5)
    v_mfma_f32_16x16x32_bf16 v[44:47], v[124:127], v[92:95], v[44:47]
    s_waitcnt lgkmcnt(2)
    s_barrier
    ds_read_b128 v[92:95], v74 offset:768
    v_mfma_f32_16x16x32_bf16 v[44:47], v[128:131], v[76:79], v[44:47]
    ds_read_b128 v[212:215], v207 offset:0
    ds_read_b128 v[216:219], v207 offset:1664
    ds_read_b128 v[76:79], v75 offset:768
    v_mfma_f32_16x16x32_bf16 v[44:47], v[132:135], v[80:83], v[44:47]
    ds_read_b128 v[80:83], v72 offset:896
    s_waitcnt lgkmcnt(6)
    v_mfma_f32_16x16x32_bf16 v[44:47], v[152:155], v[84:87], v[44:47]
    ds_read_b128 v[84:87], v73 offset:896
    s_waitcnt lgkmcnt(6)
    v_mfma_f32_16x16x32_bf16 v[44:47], v[156:159], v[88:91], v[44:47]
    ds_read_b128 v[88:91], v74 offset:896
    s_waitcnt lgkmcnt(6)
    v_mfma_f32_16x16x32_bf16 v[44:47], v[136:139], v[92:95], v[44:47]
    s_waitcnt lgkmcnt(5)
    buffer_store_dwordx4 v[212:215], v246, s[4:7], s24 offen sc1
    ds_read_b128 v[92:95], v75 offset:896
    s_waitcnt lgkmcnt(4)
    v_mfma_f32_16x16x32_bf16 v[44:47], v[140:143], v[76:79], v[44:47]
    buffer_store_dwordx4 v[216:219], v246, s[4:7], s25 offen sc1
    s_waitcnt lgkmcnt(3)
    v_mfma_f32_16x16x32_bf16 v[44:47], v[168:171], v[80:83], v[44:47]
    v_cvt_pk_bf16_f32 v8, v8, v9
    v_cvt_pk_bf16_f32 v9, v10, v11
    s_waitcnt lgkmcnt(2)
    v_mfma_f32_16x16x32_bf16 v[44:47], v[172:175], v[84:87], v[44:47]
    ds_write_b64 v204, v[8:9] offset:0
    v_mul_f32 v20, v20, v200
    s_waitcnt lgkmcnt(2)
    v_mfma_f32_16x16x32_bf16 v[44:47], v[112:115], v[88:91], v[44:47]
    v_mul_f32 v21, v21, v201
    v_mul_f32 v22, v22, v202
    s_waitcnt lgkmcnt(1)
    v_mfma_f32_16x16x32_bf16 v[44:47], v[116:119], v[92:95], v[44:47]
    v_mul_f32 v23, v23, v203
    v_cvt_pk_bf16_f32 v20, v20, v21
    v_cvt_pk_bf16_f32 v21, v22, v23
    ds_write_b64 v220, v[20:21] offset:256
    s_nop 3
    v_mul_f32 v44, v44, v200
    v_mul_f32 v45, v45, v201
    v_mul_f32 v46, v46, v202
    v_mul_f32 v47, v47, v203
    v_cvt_pk_bf16_f32 v44, v44, v45
    v_cvt_pk_bf16_f32 v45, v46, v47
    ds_write_b64 v204, v[44:45] offset:768
    s_waitcnt lgkmcnt(0)
    s_barrier
    ds_read_b128 v[212:215], v206 offset:0
    s_waitcnt lgkmcnt(0)
    buffer_store_dwordx4 v[212:215], v246, s[4:7], s26 offen sc1
    s_or_b32 s89, s89, s20
    s_cbranch_scc1 K2_end
    v_mov_b32 v0, 0
    v_mov_b32 v1, s88
    s_mov_b64 exec, 1
    buffer_store_dword v1, v0, s[16:19], 0 offen
    s_endpgm
T_pw:
    s_sleep 1
    ds_read_b32 v191, v190
    s_waitcnt lgkmcnt(0)
    v_cmp_gt_u32 vcc, s53, v191
    s_cbranch_vccnz T_pw
    s_branch T_pwr
T_aw:
    s_sleep 1
    ds_read_b32 v191, v190
    s_waitcnt lgkmcnt(0)
    v_cmp_gt_u32 vcc, s50, v191
    s_cbranch_vccnz T_aw
    s_branch T_awr
K2_end:
K2_last:
    s_endpgm
SLOW:
    v_readlane_b32 s89, v4, 62
    s_waitcnt vmcnt(0) lgkmcnt(0)
    s_barrier
    s_load_dwordx2 s[22:23], s[0:1], 8
    s_load_dwordx2 s[24:25], s[0:1], 24
    s_load_dwordx2 s[26:27], s[0:1], 32
    s_load_dwordx2 s[28:29], s[0:1], 40
    s_load_dwordx2 s[30:31], s[0:1], 0
    v_mbcnt_lo_u32_b32 v240, -1, 0
    v_mbcnt_hi_u32_b32 v240, -1, v240
    v_lshrrev_b32 v229, 5, v240
    v_and_b32 v230, 31, v240
    v_lshlrev_b32 v241, 7, v229
    v_lshl_add_u32 v241, v230, 1, v241
    v_lshlrev_b32 v245, 4, v240
    v_mov_b32 v242, 0
    s_waitcnt lgkmcnt(0)
    s_mov_b32 s80, s22
    s_and_b32 s81, s23, 0xffff
    s_mov_b32 s82, 1920000
    s_mov_b32 s83, 0x20000
    s_mov_b32 s76, s24
    s_and_b32 s77, s25, 0xffff
    s_mov_b32 s78, 1280000
    s_mov_b32 s79, 0x20000
    s_mov_b32 s72, s26
    s_and_b32 s73, s27, 0xffff
    s_mov_b32 s74, 1280000
    s_mov_b32 s75, 0x20000
    s_mov_b32 s84, s28
    s_and_b32 s85, s29, 0xffff
    s_mov_b32 s86, 20480
    s_mov_b32 s87, 0x20000
    s_mov_b32 s4, s30
    s_and_b32 s5, s31, 0xffff
    s_mov_b32 s6, 10240000
    s_mov_b32 s7, 0x20000
    s_mov_b32 s66, 0
    buffer_load_ushort v0, v241, s[84:87], s66 offen offset:0
    buffer_load_ushort v1, v241, s[84:87], s66 offen offset:64
    buffer_load_ushort v2, v241, s[84:87], s66 offen offset:256
    buffer_load_ushort v3, v241, s[84:87], s66 offen offset:320
    buffer_load_ushort v4, v241, s[84:87], s66 offen offset:512
    buffer_load_ushort v5, v241, s[84:87], s66 offen offset:576
    buffer_load_ushort v6, v241, s[84:87], s66 offen offset:768
    buffer_load_ushort v7, v241, s[84:87], s66 offen offset:832
    buffer_load_ushort v8, v241, s[84:87], s66 offen offset:1024
    buffer_load_ushort v9, v241, s[84:87], s66 offen offset:1088
    s_waitcnt vmcnt(0)
    s_mov_b32 s66, 1280
    buffer_load_ushort v10, v241, s[84:87], s66 offen offset:0
    buffer_load_ushort v11, v241, s[84:87], s66 offen offset:64
    buffer_load_ushort v12, v241, s[84:87], s66 offen offset:256
    buffer_load_ushort v13, v241, s[84:87], s66 offen offset:320
    buffer_load_ushort v14, v241, s[84:87], s66 offen offset:512
    buffer_load_ushort v15, v241, s[84:87], s66 offen offset:576
    buffer_load_ushort v16, v241, s[84:87], s66 offen offset:768
    buffer_load_ushort v17, v241, s[84:87], s66 offen offset:832
    buffer_load_ushort v18, v241, s[84:87], s66 offen offset:1024
    buffer_load_ushort v19, v241, s[84:87], s66 offen offset:1088
    s_waitcnt vmcnt(0)
    s_mov_b32 s66, 2560
    buffer_load_ushort v20, v241, s[84:87], s66 offen offset:0
    buffer_load_ushort v21, v241, s[84:87], s66 offen offset:64
    buffer_load_ushort v22, v241, s[84:87], s66 offen offset:256
    buffer_load_ushort v23, v241, s[84:87], s66 offen offset:320
    buffer_load_ushort v24, v241, s[84:87], s66 offen offset:512
    buffer_load_ushort v25, v241, s[84:87], s66 offen offset:576
    buffer_load_ushort v26, v241, s[84:87], s66 offen offset:768
    buffer_load_ushort v27, v241, s[84:87], s66 offen offset:832
    buffer_load_ushort v28, v241, s[84:87], s66 offen offset:1024
    buffer_load_ushort v29, v241, s[84:87], s66 offen offset:1088
    s_waitcnt vmcnt(0)
    s_mov_b32 s66, 3840
    buffer_load_ushort v30, v241, s[84:87], s66 offen offset:0
    buffer_load_ushort v31, v241, s[84:87], s66 offen offset:64
    buffer_load_ushort v32, v241, s[84:87], s66 offen offset:256
    buffer_load_ushort v33, v241, s[84:87], s66 offen offset:320
    buffer_load_ushort v34, v241, s[84:87], s66 offen offset:512
    buffer_load_ushort v35, v241, s[84:87], s66 offen offset:576
    buffer_load_ushort v36, v241, s[84:87], s66 offen offset:768
    buffer_load_ushort v37, v241, s[84:87], s66 offen offset:832
    buffer_load_ushort v38, v241, s[84:87], s66 offen offset:1024
    buffer_load_ushort v39, v241, s[84:87], s66 offen offset:1088
    s_waitcnt vmcnt(0)
    s_mov_b32 s66, 5120
    buffer_load_ushort v40, v241, s[84:87], s66 offen offset:0
    buffer_load_ushort v41, v241, s[84:87], s66 offen offset:64
    buffer_load_ushort v42, v241, s[84:87], s66 offen offset:256
    buffer_load_ushort v43, v241, s[84:87], s66 offen offset:320
    buffer_load_ushort v44, v241, s[84:87], s66 offen offset:512
    buffer_load_ushort v45, v241, s[84:87], s66 offen offset:576
    buffer_load_ushort v46, v241, s[84:87], s66 offen offset:768
    buffer_load_ushort v47, v241, s[84:87], s66 offen offset:832
    buffer_load_ushort v48, v241, s[84:87], s66 offen offset:1024
    buffer_load_ushort v49, v241, s[84:87], s66 offen offset:1088
    s_waitcnt vmcnt(0)
    s_mov_b32 s66, 6400
    buffer_load_ushort v50, v241, s[84:87], s66 offen offset:0
    buffer_load_ushort v51, v241, s[84:87], s66 offen offset:64
    buffer_load_ushort v52, v241, s[84:87], s66 offen offset:256
    buffer_load_ushort v53, v241, s[84:87], s66 offen offset:320
    buffer_load_ushort v54, v241, s[84:87], s66 offen offset:512
    buffer_load_ushort v55, v241, s[84:87], s66 offen offset:576
    buffer_load_ushort v56, v241, s[84:87], s66 offen offset:768
    buffer_load_ushort v57, v241, s[84:87], s66 offen offset:832
    buffer_load_ushort v58, v241, s[84:87], s66 offen offset:1024
    buffer_load_ushort v59, v241, s[84:87], s66 offen offset:1088
    s_waitcnt vmcnt(0)
    s_mov_b32 s66, 7680
    buffer_load_ushort v60, v241, s[84:87], s66 offen offset:0
    buffer_load_ushort v61, v241, s[84:87], s66 offen offset:64
    buffer_load_ushort v62, v241, s[84:87], s66 offen offset:256
    buffer_load_ushort v63, v241, s[84:87], s66 offen offset:320
    buffer_load_ushort v64, v241, s[84:87], s66 offen offset:512
    buffer_load_ushort v65, v241, s[84:87], s66 offen offset:576
    buffer_load_ushort v66, v241, s[84:87], s66 offen offset:768
    buffer_load_ushort v67, v241, s[84:87], s66 offen offset:832
    buffer_load_ushort v68, v241, s[84:87], s66 offen offset:1024
    buffer_load_ushort v69, v241, s[84:87], s66 offen offset:1088
    s_waitcnt vmcnt(0)
    s_mov_b32 s66, 8960
    buffer_load_ushort v70, v241, s[84:87], s66 offen offset:0
    buffer_load_ushort v71, v241, s[84:87], s66 offen offset:64
    buffer_load_ushort v72, v241, s[84:87], s66 offen offset:256
    buffer_load_ushort v73, v241, s[84:87], s66 offen offset:320
    buffer_load_ushort v74, v241, s[84:87], s66 offen offset:512
    buffer_load_ushort v75, v241, s[84:87], s66 offen offset:576
    buffer_load_ushort v76, v241, s[84:87], s66 offen offset:768
    buffer_load_ushort v77, v241, s[84:87], s66 offen offset:832
    buffer_load_ushort v78, v241, s[84:87], s66 offen offset:1024
    buffer_load_ushort v79, v241, s[84:87], s66 offen offset:1088
    s_waitcnt vmcnt(0)
    s_mov_b32 s66, 10240
    buffer_load_ushort v80, v241, s[84:87], s66 offen offset:0
    buffer_load_ushort v81, v241, s[84:87], s66 offen offset:64
    buffer_load_ushort v82, v241, s[84:87], s66 offen offset:256
    buffer_load_ushort v83, v241, s[84:87], s66 offen offset:320
    buffer_load_ushort v84, v241, s[84:87], s66 offen offset:512
    buffer_load_ushort v85, v241, s[84:87], s66 offen offset:576
    buffer_load_ushort v86, v241, s[84:87], s66 offen offset:768
    buffer_load_ushort v87, v241, s[84:87], s66 offen offset:832
    buffer_load_ushort v88, v241, s[84:87], s66 offen offset:1024
    buffer_load_ushort v89, v241, s[84:87], s66 offen offset:1088
    s_waitcnt vmcnt(0)
    s_mov_b32 s66, 11520
    buffer_load_ushort v90, v241, s[84:87], s66 offen offset:0
    buffer_load_ushort v91, v241, s[84:87], s66 offen offset:64
    buffer_load_ushort v92, v241, s[84:87], s66 offen offset:256
    buffer_load_ushort v93, v241, s[84:87], s66 offen offset:320
    buffer_load_ushort v94, v241, s[84:87], s66 offen offset:512
    buffer_load_ushort v95, v241, s[84:87], s66 offen offset:576
    buffer_load_ushort v96, v241, s[84:87], s66 offen offset:768
    buffer_load_ushort v97, v241, s[84:87], s66 offen offset:832
    buffer_load_ushort v98, v241, s[84:87], s66 offen offset:1024
    buffer_load_ushort v99, v241, s[84:87], s66 offen offset:1088
    s_waitcnt vmcnt(0)
    s_mov_b32 s66, 12800
    buffer_load_ushort v100, v241, s[84:87], s66 offen offset:0
    buffer_load_ushort v101, v241, s[84:87], s66 offen offset:64
    buffer_load_ushort v102, v241, s[84:87], s66 offen offset:256
    buffer_load_ushort v103, v241, s[84:87], s66 offen offset:320
    buffer_load_ushort v104, v241, s[84:87], s66 offen offset:512
    buffer_load_ushort v105, v241, s[84:87], s66 offen offset:576
    buffer_load_ushort v106, v241, s[84:87], s66 offen offset:768
    buffer_load_ushort v107, v241, s[84:87], s66 offen offset:832
    buffer_load_ushort v108, v241, s[84:87], s66 offen offset:1024
    buffer_load_ushort v109, v241, s[84:87], s66 offen offset:1088
    s_waitcnt vmcnt(0)
    s_mov_b32 s66, 14080
    buffer_load_ushort v110, v241, s[84:87], s66 offen offset:0
    buffer_load_ushort v111, v241, s[84:87], s66 offen offset:64
    buffer_load_ushort v112, v241, s[84:87], s66 offen offset:256
    buffer_load_ushort v113, v241, s[84:87], s66 offen offset:320
    buffer_load_ushort v114, v241, s[84:87], s66 offen offset:512
    buffer_load_ushort v115, v241, s[84:87], s66 offen offset:576
    buffer_load_ushort v116, v241, s[84:87], s66 offen offset:768
    buffer_load_ushort v117, v241, s[84:87], s66 offen offset:832
    buffer_load_ushort v118, v241, s[84:87], s66 offen offset:1024
    buffer_load_ushort v119, v241, s[84:87], s66 offen offset:1088
    s_waitcnt vmcnt(0)
    s_mov_b32 s66, 15360
    buffer_load_ushort v120, v241, s[84:87], s66 offen offset:0
    buffer_load_ushort v121, v241, s[84:87], s66 offen offset:64
    buffer_load_ushort v122, v241, s[84:87], s66 offen offset:256
    buffer_load_ushort v123, v241, s[84:87], s66 offen offset:320
    buffer_load_ushort v124, v241, s[84:87], s66 offen offset:512
    buffer_load_ushort v125, v241, s[84:87], s66 offen offset:576
    buffer_load_ushort v126, v241, s[84:87], s66 offen offset:768
    buffer_load_ushort v127, v241, s[84:87], s66 offen offset:832
    buffer_load_ushort v128, v241, s[84:87], s66 offen offset:1024
    buffer_load_ushort v129, v241, s[84:87], s66 offen offset:1088
    s_waitcnt vmcnt(0)
    s_mov_b32 s66, 16640
    buffer_load_ushort v130, v241, s[84:87], s66 offen offset:0
    buffer_load_ushort v131, v241, s[84:87], s66 offen offset:64
    buffer_load_ushort v132, v241, s[84:87], s66 offen offset:256
    buffer_load_ushort v133, v241, s[84:87], s66 offen offset:320
    buffer_load_ushort v134, v241, s[84:87], s66 offen offset:512
    buffer_load_ushort v135, v241, s[84:87], s66 offen offset:576
    buffer_load_ushort v136, v241, s[84:87], s66 offen offset:768
    buffer_load_ushort v137, v241, s[84:87], s66 offen offset:832
    buffer_load_ushort v138, v241, s[84:87], s66 offen offset:1024
    buffer_load_ushort v139, v241, s[84:87], s66 offen offset:1088
    s_waitcnt vmcnt(0)
    s_mov_b32 s66, 17920
    buffer_load_ushort v140, v241, s[84:87], s66 offen offset:0
    buffer_load_ushort v141, v241, s[84:87], s66 offen offset:64
    buffer_load_ushort v142, v241, s[84:87], s66 offen offset:256
    buffer_load_ushort v143, v241, s[84:87], s66 offen offset:320
    buffer_load_ushort v144, v241, s[84:87], s66 offen offset:512
    buffer_load_ushort v145, v241, s[84:87], s66 offen offset:576
    buffer_load_ushort v146, v241, s[84:87], s66 offen offset:768
    buffer_load_ushort v147, v241, s[84:87], s66 offen offset:832
    buffer_load_ushort v148, v241, s[84:87], s66 offen offset:1024
    buffer_load_ushort v149, v241, s[84:87], s66 offen offset:1088
    s_waitcnt vmcnt(0)
    s_mov_b32 s66, 19200
    buffer_load_ushort v150, v241, s[84:87], s66 offen offset:0
    buffer_load_ushort v151, v241, s[84:87], s66 offen offset:64
    buffer_load_ushort v152, v241, s[84:87], s66 offen offset:256
    buffer_load_ushort v153, v241, s[84:87], s66 offen offset:320
    buffer_load_ushort v154, v241, s[84:87], s66 offen offset:512
    buffer_load_ushort v155, v241, s[84:87], s66 offen offset:576
    buffer_load_ushort v156, v241, s[84:87], s66 offen offset:768
    buffer_load_ushort v157, v241, s[84:87], s66 offen offset:832
    buffer_load_ushort v158, v241, s[84:87], s66 offen offset:1024
    buffer_load_ushort v159, v241, s[84:87], s66 offen offset:1088
    s_waitcnt vmcnt(0)
    v_lshlrev_b32 v0, 16, v0
    v_lshlrev_b32 v1, 16, v1
    v_lshlrev_b32 v2, 16, v2
    v_lshlrev_b32 v3, 16, v3
    v_lshlrev_b32 v4, 16, v4
    v_lshlrev_b32 v5, 16, v5
    v_lshlrev_b32 v6, 16, v6
    v_lshlrev_b32 v7, 16, v7
    v_lshlrev_b32 v8, 16, v8
    v_lshlrev_b32 v9, 16, v9
    v_lshlrev_b32 v10, 16, v10
    v_lshlrev_b32 v11, 16, v11
    v_lshlrev_b32 v12, 16, v12
    v_lshlrev_b32 v13, 16, v13
    v_lshlrev_b32 v14, 16, v14
    v_lshlrev_b32 v15, 16, v15
    v_lshlrev_b32 v16, 16, v16
    v_lshlrev_b32 v17, 16, v17
    v_lshlrev_b32 v18, 16, v18
    v_lshlrev_b32 v19, 16, v19
    v_lshlrev_b32 v20, 16, v20
    v_lshlrev_b32 v21, 16, v21
    v_lshlrev_b32 v22, 16, v22
    v_lshlrev_b32 v23, 16, v23
    v_lshlrev_b32 v24, 16, v24
    v_lshlrev_b32 v25, 16, v25
    v_lshlrev_b32 v26, 16, v26
    v_lshlrev_b32 v27, 16, v27
    v_lshlrev_b32 v28, 16, v28
    v_lshlrev_b32 v29, 16, v29
    v_lshlrev_b32 v30, 16, v30
    v_lshlrev_b32 v31, 16, v31
    v_lshlrev_b32 v32, 16, v32
    v_lshlrev_b32 v33, 16, v33
    v_lshlrev_b32 v34, 16, v34
    v_lshlrev_b32 v35, 16, v35
    v_lshlrev_b32 v36, 16, v36
    v_lshlrev_b32 v37, 16, v37
    v_lshlrev_b32 v38, 16, v38
    v_lshlrev_b32 v39, 16, v39
    v_lshlrev_b32 v40, 16, v40
    v_lshlrev_b32 v41, 16, v41
    v_lshlrev_b32 v42, 16, v42
    v_lshlrev_b32 v43, 16, v43
    v_lshlrev_b32 v44, 16, v44
    v_lshlrev_b32 v45, 16, v45
    v_lshlrev_b32 v46, 16, v46
    v_lshlrev_b32 v47, 16, v47
    v_lshlrev_b32 v48, 16, v48
    v_lshlrev_b32 v49, 16, v49
    v_lshlrev_b32 v50, 16, v50
    v_lshlrev_b32 v51, 16, v51
    v_lshlrev_b32 v52, 16, v52
    v_lshlrev_b32 v53, 16, v53
    v_lshlrev_b32 v54, 16, v54
    v_lshlrev_b32 v55, 16, v55
    v_lshlrev_b32 v56, 16, v56
    v_lshlrev_b32 v57, 16, v57
    v_lshlrev_b32 v58, 16, v58
    v_lshlrev_b32 v59, 16, v59
    v_lshlrev_b32 v60, 16, v60
    v_lshlrev_b32 v61, 16, v61
    v_lshlrev_b32 v62, 16, v62
    v_lshlrev_b32 v63, 16, v63
    v_lshlrev_b32 v64, 16, v64
    v_lshlrev_b32 v65, 16, v65
    v_lshlrev_b32 v66, 16, v66
    v_lshlrev_b32 v67, 16, v67
    v_lshlrev_b32 v68, 16, v68
    v_lshlrev_b32 v69, 16, v69
    v_lshlrev_b32 v70, 16, v70
    v_lshlrev_b32 v71, 16, v71
    v_lshlrev_b32 v72, 16, v72
    v_lshlrev_b32 v73, 16, v73
    v_lshlrev_b32 v74, 16, v74
    v_lshlrev_b32 v75, 16, v75
    v_lshlrev_b32 v76, 16, v76
    v_lshlrev_b32 v77, 16, v77
    v_lshlrev_b32 v78, 16, v78
    v_lshlrev_b32 v79, 16, v79
    v_lshlrev_b32 v80, 16, v80
    v_lshlrev_b32 v81, 16, v81
    v_lshlrev_b32 v82, 16, v82
    v_lshlrev_b32 v83, 16, v83
    v_lshlrev_b32 v84, 16, v84
    v_lshlrev_b32 v85, 16, v85
    v_lshlrev_b32 v86, 16, v86
    v_lshlrev_b32 v87, 16, v87
    v_lshlrev_b32 v88, 16, v88
    v_lshlrev_b32 v89, 16, v89
    v_lshlrev_b32 v90, 16, v90
    v_lshlrev_b32 v91, 16, v91
    v_lshlrev_b32 v92, 16, v92
    v_lshlrev_b32 v93, 16, v93
    v_lshlrev_b32 v94, 16, v94
    v_lshlrev_b32 v95, 16, v95
    v_lshlrev_b32 v96, 16, v96
    v_lshlrev_b32 v97, 16, v97
    v_lshlrev_b32 v98, 16, v98
    v_lshlrev_b32 v99, 16, v99
    v_lshlrev_b32 v100, 16, v100
    v_lshlrev_b32 v101, 16, v101
    v_lshlrev_b32 v102, 16, v102
    v_lshlrev_b32 v103, 16, v103
    v_lshlrev_b32 v104, 16, v104
    v_lshlrev_b32 v105, 16, v105
    v_lshlrev_b32 v106, 16, v106
    v_lshlrev_b32 v107, 16, v107
    v_lshlrev_b32 v108, 16, v108
    v_lshlrev_b32 v109, 16, v109
    v_lshlrev_b32 v110, 16, v110
    v_lshlrev_b32 v111, 16, v111
    v_lshlrev_b32 v112, 16, v112
    v_lshlrev_b32 v113, 16, v113
    v_lshlrev_b32 v114, 16, v114
    v_lshlrev_b32 v115, 16, v115
    v_lshlrev_b32 v116, 16, v116
    v_lshlrev_b32 v117, 16, v117
    v_lshlrev_b32 v118, 16, v118
    v_lshlrev_b32 v119, 16, v119
    v_lshlrev_b32 v120, 16, v120
    v_lshlrev_b32 v121, 16, v121
    v_lshlrev_b32 v122, 16, v122
    v_lshlrev_b32 v123, 16, v123
    v_lshlrev_b32 v124, 16, v124
    v_lshlrev_b32 v125, 16, v125
    v_lshlrev_b32 v126, 16, v126
    v_lshlrev_b32 v127, 16, v127
    v_lshlrev_b32 v128, 16, v128
    v_lshlrev_b32 v129, 16, v129
    v_lshlrev_b32 v130, 16, v130
    v_lshlrev_b32 v131, 16, v131
    v_lshlrev_b32 v132, 16, v132
    v_lshlrev_b32 v133, 16, v133
    v_lshlrev_b32 v134, 16, v134
    v_lshlrev_b32 v135, 16, v135
    v_lshlrev_b32 v136, 16, v136
    v_lshlrev_b32 v137, 16, v137
    v_lshlrev_b32 v138, 16, v138
    v_lshlrev_b32 v139, 16, v139
    v_lshlrev_b32 v140, 16, v140
    v_lshlrev_b32 v141, 16, v141
    v_lshlrev_b32 v142, 16, v142
    v_lshlrev_b32 v143, 16, v143
    v_lshlrev_b32 v144, 16, v144
    v_lshlrev_b32 v145, 16, v145
    v_lshlrev_b32 v146, 16, v146
    v_lshlrev_b32 v147, 16, v147
    v_lshlrev_b32 v148, 16, v148
    v_lshlrev_b32 v149, 16, v149
    v_lshlrev_b32 v150, 16, v150
    v_lshlrev_b32 v151, 16, v151
    v_lshlrev_b32 v152, 16, v152
    v_lshlrev_b32 v153, 16, v153
    v_lshlrev_b32 v154, 16, v154
    v_lshlrev_b32 v155, 16, v155
    v_lshlrev_b32 v156, 16, v156
    v_lshlrev_b32 v157, 16, v157
    v_lshlrev_b32 v158, 16, v158
    v_lshlrev_b32 v159, 16, v159
    s_mov_b32 s50, 0
SL_node:
    s_mul_i32 s34, s2, 40
    s_lshl_b32 s66, s50, 3
    s_add_u32 s66, s66, s20
    s_add_u32 s34, s34, s66
    v_mov_b32 v160, 0
    v_mov_b32 v161, 0
    v_mov_b32 v162, 0
    v_mov_b32 v163, 0
    v_mov_b32 v164, 0
    v_mov_b32 v165, 0
    v_mov_b32 v166, 0
    v_mov_b32 v167, 0
    v_mov_b32 v168, 0
    v_mov_b32 v169, 0
    v_mov_b32 v170, 0
    v_mov_b32 v171, 0
    v_mov_b32 v172, 0
    v_mov_b32 v173, 0
    v_mov_b32 v174, 0
    v_mov_b32 v175, 0
    v_mov_b32 v176, 0
    v_mov_b32 v177, 0
    v_mov_b32 v178, 0
    v_mov_b32 v179, 0
    v_mov_b32 v180, 0
    v_mov_b32 v181, 0
    s_mov_b32 s35, 0
SL_scan:
    s_lshl_b32 s66, s35, 2
    buffer_load_dwordx4 v[236:239], v245, s[72:75], s66 offen
    s_waitcnt vmcnt(0)
    v_cmp_eq_u32 s[38:39], s34, v236
    v_cmp_eq_u32 s[40:41], s34, v237
    v_cmp_eq_u32 s[42:43], s34, v238
    v_cmp_eq_u32 s[44:45], s34, v239
    s_mov_b32 s36, 0
SL_bits:
    s_cmp_eq_u64 s[38:39], 0
    s_cbranch_scc1 SL_nexti
    s_ff1_i32_b64 s66, s[38:39]
    s_bitset0_b64 s[38:39], s66
    s_lshl_b32 s66, s66, 2
    s_add_u32 s37, s66, s36
    s_add_u32 s37, s37, s35
    s_lshl_b32 s66, s37, 2
    s_lshl_b32 s67, s37, 5
    s_mul_i32 s68, s37, 6
    buffer_load_dword v243, v242, s[76:79], s66 offen
    buffer_load_dwordx4 v[184:187], v242, s[12:15], s67 offen
    buffer_load_dwordx4 v[188:191], v242, s[12:15], s67 offen offset:16
    buffer_load_ushort v226, v242, s[80:83], s68 offen offset:0
    buffer_load_ushort v227, v242, s[80:83], s68 offen offset:2
    buffer_load_ushort v228, v242, s[80:83], s68 offen offset:4
    s_waitcnt vmcnt(5)
    v_lshl_add_u32 v243, v243, 10, v241
    buffer_load_ushort v208, v243, s[4:7], 0 offen offset:0
    buffer_load_ushort v209, v243, s[4:7], 0 offen offset:64
    buffer_load_ushort v210, v243, s[4:7], 0 offen offset:256
    buffer_load_ushort v211, v243, s[4:7], 0 offen offset:320
    buffer_load_ushort v212, v243, s[4:7], 0 offen offset:512
    buffer_load_ushort v213, v243, s[4:7], 0 offen offset:576
    buffer_load_ushort v214, v243, s[4:7], 0 offen offset:768
    buffer_load_ushort v215, v243, s[4:7], 0 offen offset:832
    s_waitcnt vmcnt(8)
    v_lshlrev_b32 v192, 16, v184
    v_and_b32 v193, 0xffff0000, v184
    v_lshlrev_b32 v194, 16, v185
    v_and_b32 v195, 0xffff0000, v185
    v_lshlrev_b32 v196, 16, v186
    v_and_b32 v197, 0xffff0000, v186
    v_lshlrev_b32 v198, 16, v187
    v_and_b32 v199, 0xffff0000, v187
    v_lshlrev_b32 v200, 16, v188
    v_and_b32 v201, 0xffff0000, v188
    v_lshlrev_b32 v202, 16, v189
    v_and_b32 v203, 0xffff0000, v189
    v_lshlrev_b32 v204, 16, v190
    v_and_b32 v205, 0xffff0000, v190
    v_lshlrev_b32 v206, 16, v191
    v_and_b32 v207, 0xffff0000, v191
    v_lshlrev_b32 v226, 16, v226
    v_lshlrev_b32 v227, 16, v227
    v_lshlrev_b32 v228, 16, v228
    v_mul_f32 v216, v192, v0
    v_mul_f32 v217, v192, v1
    v_mul_f32 v218, v192, v2
    v_mul_f32 v219, v192, v3
    v_mul_f32 v220, v192, v4
    v_mul_f32 v221, v192, v5
    v_mul_f32 v222, v192, v6
    v_mul_f32 v223, v192, v7
    v_mul_f32 v224, v192, v8
    v_mul_f32 v225, v192, v9
    v_fmac_f32 v216, v193, v10
    v_fmac_f32 v217, v193, v11
    v_fmac_f32 v218, v193, v12
    v_fmac_f32 v219, v193, v13
    v_fmac_f32 v220, v193, v14
    v_fmac_f32 v221, v193, v15
    v_fmac_f32 v222, v193, v16
    v_fmac_f32 v223, v193, v17
    v_fmac_f32 v224, v193, v18
    v_fmac_f32 v225, v193, v19
    v_fmac_f32 v216, v194, v20
    v_fmac_f32 v217, v194, v21
    v_fmac_f32 v218, v194, v22
    v_fmac_f32 v219, v194, v23
    v_fmac_f32 v220, v194, v24
    v_fmac_f32 v221, v194, v25
    v_fmac_f32 v222, v194, v26
    v_fmac_f32 v223, v194, v27
    v_fmac_f32 v224, v194, v28
    v_fmac_f32 v225, v194, v29
    v_fmac_f32 v216, v195, v30
    v_fmac_f32 v217, v195, v31
    v_fmac_f32 v218, v195, v32
    v_fmac_f32 v219, v195, v33
    v_fmac_f32 v220, v195, v34
    v_fmac_f32 v221, v195, v35
    v_fmac_f32 v222, v195, v36
    v_fmac_f32 v223, v195, v37
    v_fmac_f32 v224, v195, v38
    v_fmac_f32 v225, v195, v39
    v_fmac_f32 v216, v196, v40
    v_fmac_f32 v217, v196, v41
    v_fmac_f32 v218, v196, v42
    v_fmac_f32 v219, v196, v43
    v_fmac_f32 v220, v196, v44
    v_fmac_f32 v221, v196, v45
    v_fmac_f32 v222, v196, v46
    v_fmac_f32 v223, v196, v47
    v_fmac_f32 v224, v196, v48
    v_fmac_f32 v225, v196, v49
    v_fmac_f32 v216, v197, v50
    v_fmac_f32 v217, v197, v51
    v_fmac_f32 v218, v197, v52
    v_fmac_f32 v219, v197, v53
    v_fmac_f32 v220, v197, v54
    v_fmac_f32 v221, v197, v55
    v_fmac_f32 v222, v197, v56
    v_fmac_f32 v223, v197, v57
    v_fmac_f32 v224, v197, v58
    v_fmac_f32 v225, v197, v59
    v_fmac_f32 v216, v198, v60
    v_fmac_f32 v217, v198, v61
    v_fmac_f32 v218, v198, v62
    v_fmac_f32 v219, v198, v63
    v_fmac_f32 v220, v198, v64
    v_fmac_f32 v221, v198, v65
    v_fmac_f32 v222, v198, v66
    v_fmac_f32 v223, v198, v67
    v_fmac_f32 v224, v198, v68
    v_fmac_f32 v225, v198, v69
    v_fmac_f32 v216, v199, v70
    v_fmac_f32 v217, v199, v71
    v_fmac_f32 v218, v199, v72
    v_fmac_f32 v219, v199, v73
    v_fmac_f32 v220, v199, v74
    v_fmac_f32 v221, v199, v75
    v_fmac_f32 v222, v199, v76
    v_fmac_f32 v223, v199, v77
    v_fmac_f32 v224, v199, v78
    v_fmac_f32 v225, v199, v79
    v_fmac_f32 v216, v200, v80
    v_fmac_f32 v217, v200, v81
    v_fmac_f32 v218, v200, v82
    v_fmac_f32 v219, v200, v83
    v_fmac_f32 v220, v200, v84
    v_fmac_f32 v221, v200, v85
    v_fmac_f32 v222, v200, v86
    v_fmac_f32 v223, v200, v87
    v_fmac_f32 v224, v200, v88
    v_fmac_f32 v225, v200, v89
    v_fmac_f32 v216, v201, v90
    v_fmac_f32 v217, v201, v91
    v_fmac_f32 v218, v201, v92
    v_fmac_f32 v219, v201, v93
    v_fmac_f32 v220, v201, v94
    v_fmac_f32 v221, v201, v95
    v_fmac_f32 v222, v201, v96
    v_fmac_f32 v223, v201, v97
    v_fmac_f32 v224, v201, v98
    v_fmac_f32 v225, v201, v99
    v_fmac_f32 v216, v202, v100
    v_fmac_f32 v217, v202, v101
    v_fmac_f32 v218, v202, v102
    v_fmac_f32 v219, v202, v103
    v_fmac_f32 v220, v202, v104
    v_fmac_f32 v221, v202, v105
    v_fmac_f32 v222, v202, v106
    v_fmac_f32 v223, v202, v107
    v_fmac_f32 v224, v202, v108
    v_fmac_f32 v225, v202, v109
    v_fmac_f32 v216, v203, v110
    v_fmac_f32 v217, v203, v111
    v_fmac_f32 v218, v203, v112
    v_fmac_f32 v219, v203, v113
    v_fmac_f32 v220, v203, v114
    v_fmac_f32 v221, v203, v115
    v_fmac_f32 v222, v203, v116
    v_fmac_f32 v223, v203, v117
    v_fmac_f32 v224, v203, v118
    v_fmac_f32 v225, v203, v119
    v_fmac_f32 v216, v204, v120
    v_fmac_f32 v217, v204, v121
    v_fmac_f32 v218, v204, v122
    v_fmac_f32 v219, v204, v123
    v_fmac_f32 v220, v204, v124
    v_fmac_f32 v221, v204, v125
    v_fmac_f32 v222, v204, v126
    v_fmac_f32 v223, v204, v127
    v_fmac_f32 v224, v204, v128
    v_fmac_f32 v225, v204, v129
    v_fmac_f32 v216, v205, v130
    v_fmac_f32 v217, v205, v131
    v_fmac_f32 v218, v205, v132
    v_fmac_f32 v219, v205, v133
    v_fmac_f32 v220, v205, v134
    v_fmac_f32 v221, v205, v135
    v_fmac_f32 v222, v205, v136
    v_fmac_f32 v223, v205, v137
    v_fmac_f32 v224, v205, v138
    v_fmac_f32 v225, v205, v139
    v_fmac_f32 v216, v206, v140
    v_fmac_f32 v217, v206, v141
    v_fmac_f32 v218, v206, v142
    v_fmac_f32 v219, v206, v143
    v_fmac_f32 v220, v206, v144
    v_fmac_f32 v221, v206, v145
    v_fmac_f32 v222, v206, v146
    v_fmac_f32 v223, v206, v147
    v_fmac_f32 v224, v206, v148
    v_fmac_f32 v225, v206, v149
    v_fmac_f32 v216, v207, v150
    v_fmac_f32 v217, v207, v151
    v_fmac_f32 v218, v207, v152
    v_fmac_f32 v219, v207, v153
    v_fmac_f32 v220, v207, v154
    v_fmac_f32 v221, v207, v155
    v_fmac_f32 v222, v207, v156
    v_fmac_f32 v223, v207, v157
    v_fmac_f32 v224, v207, v158
    v_fmac_f32 v225, v207, v159
    s_waitcnt vmcnt(0)
    v_lshlrev_b32 v208, 16, v208
    v_lshlrev_b32 v209, 16, v209
    v_lshlrev_b32 v210, 16, v210
    v_lshlrev_b32 v211, 16, v211
    v_lshlrev_b32 v212, 16, v212
    v_lshlrev_b32 v213, 16, v213
    v_lshlrev_b32 v214, 16, v214
    v_lshlrev_b32 v215, 16, v215
    v_fmac_f32 v160, v208, v216
    v_mul_f32 v229, v210, v226
    v_fmac_f32 v229, v212, v227
    v_fmac_f32 v229, v214, v228
    v_fmac_f32 v176, v229, v218
    v_mul_f32 v229, v208, v220
    v_fmac_f32 v162, v229, v226
    v_fmac_f32 v168, v210, v222
    v_mul_f32 v230, v227, v214
    v_fma_f32 v230, -v228, v212, v230
    v_fmac_f32 v178, v230, v224
    v_fmac_f32 v164, v229, v227
    v_fmac_f32 v170, v212, v222
    v_mul_f32 v230, v228, v210
    v_fma_f32 v230, -v226, v214, v230
    v_fmac_f32 v180, v230, v224
    v_fmac_f32 v166, v229, v228
    v_fmac_f32 v172, v214, v222
    v_mul_f32 v230, v226, v212
    v_fma_f32 v230, -v227, v210, v230
    v_fmac_f32 v174, v230, v224
    v_fmac_f32 v161, v209, v217
    v_mul_f32 v229, v211, v226
    v_fmac_f32 v229, v213, v227
    v_fmac_f32 v229, v215, v228
    v_fmac_f32 v177, v229, v219
    v_mul_f32 v229, v209, v221
    v_fmac_f32 v163, v229, v226
    v_fmac_f32 v169, v211, v223
    v_mul_f32 v230, v227, v215
    v_fma_f32 v230, -v228, v213, v230
    v_fmac_f32 v179, v230, v225
    v_fmac_f32 v165, v229, v227
    v_fmac_f32 v171, v213, v223
    v_mul_f32 v230, v228, v211
    v_fma_f32 v230, -v226, v215, v230
    v_fmac_f32 v181, v230, v225
    v_fmac_f32 v167, v229, v228
    v_fmac_f32 v173, v215, v223
    v_mul_f32 v230, v226, v213
    v_fma_f32 v230, -v227, v211, v230
    v_fmac_f32 v175, v230, v225
    s_branch SL_bits
SL_nexti:
    s_mov_b64 s[38:39], s[40:41]
    s_mov_b64 s[40:41], s[42:43]
    s_mov_b64 s[42:43], s[44:45]
    s_add_u32 s36, s36, 1
    s_cmp_lt_u32 s36, 4
    s_cbranch_scc1 SL_bits
    s_add_u32 s35, s35, 256
    s_cmp_lt_u32 s35, 320000
    s_cbranch_scc1 SL_scan
    s_lshl_b32 s66, s50, 3
    s_add_u32 s66, s66, s20
    s_lshl_b32 s67, s66, 4
    s_and_b32 s68, s67, 128
    s_and_b32 s67, s67, 0x70
    s_mul_i32 s69, s50, 1536
    s_add_u32 s69, s69, s21
    s_add_u32 s69, s69, s68
    s_mul_i32 s70, s66, 1536
    s_add_u32 s70, s70, 86016
    s_add_u32 s70, s70, s68
    v_mov_b32 v230, s69
    v_mov_b32 v231, s70
    v_cmp_gt_u32 vcc, 32, v240
    v_and_b32 v229, 31, v240
    v_lshlrev_b32 v229, 2, v229
    v_xor_b32 v229, s67, v229
    v_cndmask_b32 v244, v231, v230, vcc
    v_add_u32 v244, v244, v229
    v_cvt_pk_bf16_f32 v160, v160, v161
    ds_write_b32 v244, v160 offset:0
    v_cvt_pk_bf16_f32 v162, v162, v163
    ds_write_b32 v244, v162 offset:128
    v_cvt_pk_bf16_f32 v164, v164, v165
    ds_write_b32 v244, v164 offset:256
    v_cvt_pk_bf16_f32 v166, v166, v167
    ds_write_b32 v244, v166 offset:384
    v_cvt_pk_bf16_f32 v168, v168, v169
    ds_write_b32 v244, v168 offset:512
    v_cvt_pk_bf16_f32 v170, v170, v171
    ds_write_b32 v244, v170 offset:640
    v_cvt_pk_bf16_f32 v172, v172, v173
    ds_write_b32 v244, v172 offset:768
    v_cvt_pk_bf16_f32 v174, v174, v175
    ds_write_b32 v244, v174 offset:896
    v_cvt_pk_bf16_f32 v176, v176, v177
    ds_write_b32 v244, v176 offset:1024
    v_cvt_pk_bf16_f32 v178, v178, v179
    ds_write_b32 v244, v178 offset:1152
    v_cvt_pk_bf16_f32 v180, v180, v181
    ds_write_b32 v244, v180 offset:1280
    s_lshl_b32 s66, s66, 3
    s_add_u32 s66, s66, 163328
    v_mov_b32 v229, s66
    ds_write_b64 v229, v[230:231]
    s_add_u32 s50, s50, 1
    s_cmp_lt_u32 s50, 5
    s_cbranch_scc1 SL_node
    s_waitcnt lgkmcnt(0)
    s_barrier
    v_mov_b32 v176, v240
    s_load_dwordx4 s[84:87], s[0:1], 48
    s_mul_i32 s22, s20, 20
    s_waitcnt lgkmcnt(0)
    s_mul_i32 s24, s22, 3277
    s_lshr_b32 s24, s24, 16
    s_mul_i32 s68, s24, 20
    s_sub_u32 s68, s22, s68
    s_cmp_lt_u32 s68, 8
    s_cselect_b64 s[66:67], s[84:85], s[86:87]
    s_cselect_b32 s25, 0, 8
    s_sub_u32 s68, s68, s25
    s_and_b32 s25, s68, 1
    s_lshr_b32 s68, s68, 1
    s_lshl_b32 s68, s68, 14
    s_lshl_b32 s25, s25, 12
    s_add_u32 s68, s68, s25
    s_lshl_b32 s24, s24, 5
    s_add_u32 s68, s68, s24
    v_lshrrev_b32 v2, 4, v176
    v_lshlrev_b32 v2, 10, v2
    v_and_b32 v3, 15, v176
    v_lshl_add_u32 v2, v3, 1, v2
    v_add_u32 v2, s68, v2
    v_add_u32 v3, 8192, v2
    v_mov_b32 v4, 0
    v_mov_b32 v5, 0
    v_mov_b32 v6, 0
    v_mov_b32 v7, 0
    global_load_ushort v144, v2, s[66:67] offset:0
    global_load_short_d16_hi v4, v3, s[66:67] offset:0
    global_load_ushort v145, v2, s[66:67] offset:256
    global_load_short_d16_hi v5, v3, s[66:67] offset:256
    global_load_ushort v146, v2, s[66:67] offset:512
    global_load_short_d16_hi v6, v3, s[66:67] offset:512
    global_load_ushort v147, v2, s[66:67] offset:768
    global_load_short_d16_hi v7, v3, s[66:67] offset:768
    s_add_u32 s22, s22, 1
    s_waitcnt vmcnt(0)
    v_or_b32 v144, v144, v4
    v_or_b32 v145, v145, v5
    v_or_b32 v146, v146, v6
    v_or_b32 v147, v147, v7
    s_mul_i32 s24, s22, 3277
    s_lshr_b32 s24, s24, 16
    s_mul_i32 s68, s24, 20
    s_sub_u32 s68, s22, s68
    s_cmp_lt_u32 s68, 8
    s_cselect_b64 s[66:67], s[84:85], s[86:87]
    s_cselect_b32 s25, 0, 8
    s_sub_u32 s68, s68, s25
    s_and_b32 s25, s68, 1
    s_lshr_b32 s68, s68, 1
    s_lshl_b32 s68, s68, 14
    s_lshl_b32 s25, s25, 12
    s_add_u32 s68, s68, s25
    s_lshl_b32 s24, s24, 5
    s_add_u32 s68, s68, s24
    v_lshrrev_b32 v2, 4, v176
    v_lshlrev_b32 v2, 10, v2
    v_and_b32 v3, 15, v176
    v_lshl_add_u32 v2, v3, 1, v2
    v_add_u32 v2, s68, v2
    v_add_u32 v3, 8192, v2
    v_mov_b32 v4, 0
    v_mov_b32 v5, 0
    v_mov_b32 v6, 0
    v_mov_b32 v7, 0
    global_load_ushort v148, v2, s[66:67] offset:0
    global_load_short_d16_hi v4, v3, s[66:67] offset:0
    global_load_ushort v149, v2, s[66:67] offset:256
    global_load_short_d16_hi v5, v3, s[66:67] offset:256
    global_load_ushort v150, v2, s[66:67] offset:512
    global_load_short_d16_hi v6, v3, s[66:67] offset:512
    global_load_ushort v151, v2, s[66:67] offset:768
    global_load_short_d16_hi v7, v3, s[66:67] offset:768
    s_add_u32 s22, s22, 1
    s_waitcnt vmcnt(0)
    v_or_b32 v148, v148, v4
    v_or_b32 v149, v149, v5
    v_or_b32 v150, v150, v6
    v_or_b32 v151, v151, v7
    s_mul_i32 s24, s22, 3277
    s_lshr_b32 s24, s24, 16
    s_mul_i32 s68, s24, 20
    s_sub_u32 s68, s22, s68
    s_cmp_lt_u32 s68, 8
    s_cselect_b64 s[66:67], s[84:85], s[86:87]
    s_cselect_b32 s25, 0, 8
    s_sub_u32 s68, s68, s25
    s_and_b32 s25, s68, 1
    s_lshr_b32 s68, s68, 1
    s_lshl_b32 s68, s68, 14
    s_lshl_b32 s25, s25, 12
    s_add_u32 s68, s68, s25
    s_lshl_b32 s24, s24, 5
    s_add_u32 s68, s68, s24
    v_lshrrev_b32 v2, 4, v176
    v_lshlrev_b32 v2, 10, v2
    v_and_b32 v3, 15, v176
    v_lshl_add_u32 v2, v3, 1, v2
    v_add_u32 v2, s68, v2
    v_add_u32 v3, 8192, v2
    v_mov_b32 v4, 0
    v_mov_b32 v5, 0
    v_mov_b32 v6, 0
    v_mov_b32 v7, 0
    global_load_ushort v96, v2, s[66:67] offset:0
    global_load_short_d16_hi v4, v3, s[66:67] offset:0
    global_load_ushort v97, v2, s[66:67] offset:256
    global_load_short_d16_hi v5, v3, s[66:67] offset:256
    global_load_ushort v98, v2, s[66:67] offset:512
    global_load_short_d16_hi v6, v3, s[66:67] offset:512
    global_load_ushort v99, v2, s[66:67] offset:768
    global_load_short_d16_hi v7, v3, s[66:67] offset:768
    s_add_u32 s22, s22, 1
    s_waitcnt vmcnt(0)
    v_or_b32 v96, v96, v4
    v_or_b32 v97, v97, v5
    v_or_b32 v98, v98, v6
    v_or_b32 v99, v99, v7
    s_mul_i32 s24, s22, 3277
    s_lshr_b32 s24, s24, 16
    s_mul_i32 s68, s24, 20
    s_sub_u32 s68, s22, s68
    s_cmp_lt_u32 s68, 8
    s_cselect_b64 s[66:67], s[84:85], s[86:87]
    s_cselect_b32 s25, 0, 8
    s_sub_u32 s68, s68, s25
    s_and_b32 s25, s68, 1
    s_lshr_b32 s68, s68, 1
    s_lshl_b32 s68, s68, 14
    s_lshl_b32 s25, s25, 12
    s_add_u32 s68, s68, s25
    s_lshl_b32 s24, s24, 5
    s_add_u32 s68, s68, s24
    v_lshrrev_b32 v2, 4, v176
    v_lshlrev_b32 v2, 10, v2
    v_and_b32 v3, 15, v176
    v_lshl_add_u32 v2, v3, 1, v2
    v_add_u32 v2, s68, v2
    v_add_u32 v3, 8192, v2
    v_mov_b32 v4, 0
    v_mov_b32 v5, 0
    v_mov_b32 v6, 0
    v_mov_b32 v7, 0
    global_load_ushort v100, v2, s[66:67] offset:0
    global_load_short_d16_hi v4, v3, s[66:67] offset:0
    global_load_ushort v101, v2, s[66:67] offset:256
    global_load_short_d16_hi v5, v3, s[66:67] offset:256
    global_load_ushort v102, v2, s[66:67] offset:512
    global_load_short_d16_hi v6, v3, s[66:67] offset:512
    global_load_ushort v103, v2, s[66:67] offset:768
    global_load_short_d16_hi v7, v3, s[66:67] offset:768
    s_add_u32 s22, s22, 1
    s_waitcnt vmcnt(0)
    v_or_b32 v100, v100, v4
    v_or_b32 v101, v101, v5
    v_or_b32 v102, v102, v6
    v_or_b32 v103, v103, v7
    s_mul_i32 s24, s22, 3277
    s_lshr_b32 s24, s24, 16
    s_mul_i32 s68, s24, 20
    s_sub_u32 s68, s22, s68
    s_cmp_lt_u32 s68, 8
    s_cselect_b64 s[66:67], s[84:85], s[86:87]
    s_cselect_b32 s25, 0, 8
    s_sub_u32 s68, s68, s25
    s_and_b32 s25, s68, 1
    s_lshr_b32 s68, s68, 1
    s_lshl_b32 s68, s68, 14
    s_lshl_b32 s25, s25, 12
    s_add_u32 s68, s68, s25
    s_lshl_b32 s24, s24, 5
    s_add_u32 s68, s68, s24
    v_lshrrev_b32 v2, 4, v176
    v_lshlrev_b32 v2, 10, v2
    v_and_b32 v3, 15, v176
    v_lshl_add_u32 v2, v3, 1, v2
    v_add_u32 v2, s68, v2
    v_add_u32 v3, 8192, v2
    v_mov_b32 v4, 0
    v_mov_b32 v5, 0
    v_mov_b32 v6, 0
    v_mov_b32 v7, 0
    global_load_ushort v160, v2, s[66:67] offset:0
    global_load_short_d16_hi v4, v3, s[66:67] offset:0
    global_load_ushort v161, v2, s[66:67] offset:256
    global_load_short_d16_hi v5, v3, s[66:67] offset:256
    global_load_ushort v162, v2, s[66:67] offset:512
    global_load_short_d16_hi v6, v3, s[66:67] offset:512
    global_load_ushort v163, v2, s[66:67] offset:768
    global_load_short_d16_hi v7, v3, s[66:67] offset:768
    s_add_u32 s22, s22, 1
    s_waitcnt vmcnt(0)
    v_or_b32 v160, v160, v4
    v_or_b32 v161, v161, v5
    v_or_b32 v162, v162, v6
    v_or_b32 v163, v163, v7
    s_mul_i32 s24, s22, 3277
    s_lshr_b32 s24, s24, 16
    s_mul_i32 s68, s24, 20
    s_sub_u32 s68, s22, s68
    s_cmp_lt_u32 s68, 8
    s_cselect_b64 s[66:67], s[84:85], s[86:87]
    s_cselect_b32 s25, 0, 8
    s_sub_u32 s68, s68, s25
    s_and_b32 s25, s68, 1
    s_lshr_b32 s68, s68, 1
    s_lshl_b32 s68, s68, 14
    s_lshl_b32 s25, s25, 12
    s_add_u32 s68, s68, s25
    s_lshl_b32 s24, s24, 5
    s_add_u32 s68, s68, s24
    v_lshrrev_b32 v2, 4, v176
    v_lshlrev_b32 v2, 10, v2
    v_and_b32 v3, 15, v176
    v_lshl_add_u32 v2, v3, 1, v2
    v_add_u32 v2, s68, v2
    v_add_u32 v3, 8192, v2
    v_mov_b32 v4, 0
    v_mov_b32 v5, 0
    v_mov_b32 v6, 0
    v_mov_b32 v7, 0
    global_load_ushort v164, v2, s[66:67] offset:0
    global_load_short_d16_hi v4, v3, s[66:67] offset:0
    global_load_ushort v165, v2, s[66:67] offset:256
    global_load_short_d16_hi v5, v3, s[66:67] offset:256
    global_load_ushort v166, v2, s[66:67] offset:512
    global_load_short_d16_hi v6, v3, s[66:67] offset:512
    global_load_ushort v167, v2, s[66:67] offset:768
    global_load_short_d16_hi v7, v3, s[66:67] offset:768
    s_add_u32 s22, s22, 1
    s_waitcnt vmcnt(0)
    v_or_b32 v164, v164, v4
    v_or_b32 v165, v165, v5
    v_or_b32 v166, v166, v6
    v_or_b32 v167, v167, v7
    s_mul_i32 s24, s22, 3277
    s_lshr_b32 s24, s24, 16
    s_mul_i32 s68, s24, 20
    s_sub_u32 s68, s22, s68
    s_cmp_lt_u32 s68, 8
    s_cselect_b64 s[66:67], s[84:85], s[86:87]
    s_cselect_b32 s25, 0, 8
    s_sub_u32 s68, s68, s25
    s_and_b32 s25, s68, 1
    s_lshr_b32 s68, s68, 1
    s_lshl_b32 s68, s68, 14
    s_lshl_b32 s25, s25, 12
    s_add_u32 s68, s68, s25
    s_lshl_b32 s24, s24, 5
    s_add_u32 s68, s68, s24
    v_lshrrev_b32 v2, 4, v176
    v_lshlrev_b32 v2, 10, v2
    v_and_b32 v3, 15, v176
    v_lshl_add_u32 v2, v3, 1, v2
    v_add_u32 v2, s68, v2
    v_add_u32 v3, 8192, v2
    v_mov_b32 v4, 0
    v_mov_b32 v5, 0
    v_mov_b32 v6, 0
    v_mov_b32 v7, 0
    global_load_ushort v104, v2, s[66:67] offset:0
    global_load_short_d16_hi v4, v3, s[66:67] offset:0
    global_load_ushort v105, v2, s[66:67] offset:256
    global_load_short_d16_hi v5, v3, s[66:67] offset:256
    global_load_ushort v106, v2, s[66:67] offset:512
    global_load_short_d16_hi v6, v3, s[66:67] offset:512
    global_load_ushort v107, v2, s[66:67] offset:768
    global_load_short_d16_hi v7, v3, s[66:67] offset:768
    s_add_u32 s22, s22, 1
    s_waitcnt vmcnt(0)
    v_or_b32 v104, v104, v4
    v_or_b32 v105, v105, v5
    v_or_b32 v106, v106, v6
    v_or_b32 v107, v107, v7
    s_mul_i32 s24, s22, 3277
    s_lshr_b32 s24, s24, 16
    s_mul_i32 s68, s24, 20
    s_sub_u32 s68, s22, s68
    s_cmp_lt_u32 s68, 8
    s_cselect_b64 s[66:67], s[84:85], s[86:87]
    s_cselect_b32 s25, 0, 8
    s_sub_u32 s68, s68, s25
    s_and_b32 s25, s68, 1
    s_lshr_b32 s68, s68, 1
    s_lshl_b32 s68, s68, 14
    s_lshl_b32 s25, s25, 12
    s_add_u32 s68, s68, s25
    s_lshl_b32 s24, s24, 5
    s_add_u32 s68, s68, s24
    v_lshrrev_b32 v2, 4, v176
    v_lshlrev_b32 v2, 10, v2
    v_and_b32 v3, 15, v176
    v_lshl_add_u32 v2, v3, 1, v2
    v_add_u32 v2, s68, v2
    v_add_u32 v3, 8192, v2
    v_mov_b32 v4, 0
    v_mov_b32 v5, 0
    v_mov_b32 v6, 0
    v_mov_b32 v7, 0
    global_load_ushort v108, v2, s[66:67] offset:0
    global_load_short_d16_hi v4, v3, s[66:67] offset:0
    global_load_ushort v109, v2, s[66:67] offset:256
    global_load_short_d16_hi v5, v3, s[66:67] offset:256
    global_load_ushort v110, v2, s[66:67] offset:512
    global_load_short_d16_hi v6, v3, s[66:67] offset:512
    global_load_ushort v111, v2, s[66:67] offset:768
    global_load_short_d16_hi v7, v3, s[66:67] offset:768
    s_add_u32 s22, s22, 1
    s_waitcnt vmcnt(0)
    v_or_b32 v108, v108, v4
    v_or_b32 v109, v109, v5
    v_or_b32 v110, v110, v6
    v_or_b32 v111, v111, v7
    s_mul_i32 s24, s22, 3277
    s_lshr_b32 s24, s24, 16
    s_mul_i32 s68, s24, 20
    s_sub_u32 s68, s22, s68
    s_cmp_lt_u32 s68, 8
    s_cselect_b64 s[66:67], s[84:85], s[86:87]
    s_cselect_b32 s25, 0, 8
    s_sub_u32 s68, s68, s25
    s_and_b32 s25, s68, 1
    s_lshr_b32 s68, s68, 1
    s_lshl_b32 s68, s68, 14
    s_lshl_b32 s25, s25, 12
    s_add_u32 s68, s68, s25
    s_lshl_b32 s24, s24, 5
    s_add_u32 s68, s68, s24
    v_lshrrev_b32 v2, 4, v176
    v_lshlrev_b32 v2, 10, v2
    v_and_b32 v3, 15, v176
    v_lshl_add_u32 v2, v3, 1, v2
    v_add_u32 v2, s68, v2
    v_add_u32 v3, 8192, v2
    v_mov_b32 v4, 0
    v_mov_b32 v5, 0
    v_mov_b32 v6, 0
    v_mov_b32 v7, 0
    global_load_ushort v120, v2, s[66:67] offset:0
    global_load_short_d16_hi v4, v3, s[66:67] offset:0
    global_load_ushort v121, v2, s[66:67] offset:256
    global_load_short_d16_hi v5, v3, s[66:67] offset:256
    global_load_ushort v122, v2, s[66:67] offset:512
    global_load_short_d16_hi v6, v3, s[66:67] offset:512
    global_load_ushort v123, v2, s[66:67] offset:768
    global_load_short_d16_hi v7, v3, s[66:67] offset:768
    s_add_u32 s22, s22, 1
    s_waitcnt vmcnt(0)
    v_or_b32 v120, v120, v4
    v_or_b32 v121, v121, v5
    v_or_b32 v122, v122, v6
    v_or_b32 v123, v123, v7
    s_mul_i32 s24, s22, 3277
    s_lshr_b32 s24, s24, 16
    s_mul_i32 s68, s24, 20
    s_sub_u32 s68, s22, s68
    s_cmp_lt_u32 s68, 8
    s_cselect_b64 s[66:67], s[84:85], s[86:87]
    s_cselect_b32 s25, 0, 8
    s_sub_u32 s68, s68, s25
    s_and_b32 s25, s68, 1
    s_lshr_b32 s68, s68, 1
    s_lshl_b32 s68, s68, 14
    s_lshl_b32 s25, s25, 12
    s_add_u32 s68, s68, s25
    s_lshl_b32 s24, s24, 5
    s_add_u32 s68, s68, s24
    v_lshrrev_b32 v2, 4, v176
    v_lshlrev_b32 v2, 10, v2
    v_and_b32 v3, 15, v176
    v_lshl_add_u32 v2, v3, 1, v2
    v_add_u32 v2, s68, v2
    v_add_u32 v3, 8192, v2
    v_mov_b32 v4, 0
    v_mov_b32 v5, 0
    v_mov_b32 v6, 0
    v_mov_b32 v7, 0
    global_load_ushort v124, v2, s[66:67] offset:0
    global_load_short_d16_hi v4, v3, s[66:67] offset:0
    global_load_ushort v125, v2, s[66:67] offset:256
    global_load_short_d16_hi v5, v3, s[66:67] offset:256
    global_load_ushort v126, v2, s[66:67] offset:512
    global_load_short_d16_hi v6, v3, s[66:67] offset:512
    global_load_ushort v127, v2, s[66:67] offset:768
    global_load_short_d16_hi v7, v3, s[66:67] offset:768
    s_add_u32 s22, s22, 1
    s_waitcnt vmcnt(0)
    v_or_b32 v124, v124, v4
    v_or_b32 v125, v125, v5
    v_or_b32 v126, v126, v6
    v_or_b32 v127, v127, v7
    s_mul_i32 s24, s22, 3277
    s_lshr_b32 s24, s24, 16
    s_mul_i32 s68, s24, 20
    s_sub_u32 s68, s22, s68
    s_cmp_lt_u32 s68, 8
    s_cselect_b64 s[66:67], s[84:85], s[86:87]
    s_cselect_b32 s25, 0, 8
    s_sub_u32 s68, s68, s25
    s_and_b32 s25, s68, 1
    s_lshr_b32 s68, s68, 1
    s_lshl_b32 s68, s68, 14
    s_lshl_b32 s25, s25, 12
    s_add_u32 s68, s68, s25
    s_lshl_b32 s24, s24, 5
    s_add_u32 s68, s68, s24
    v_lshrrev_b32 v2, 4, v176
    v_lshlrev_b32 v2, 10, v2
    v_and_b32 v3, 15, v176
    v_lshl_add_u32 v2, v3, 1, v2
    v_add_u32 v2, s68, v2
    v_add_u32 v3, 8192, v2
    v_mov_b32 v4, 0
    v_mov_b32 v5, 0
    v_mov_b32 v6, 0
    v_mov_b32 v7, 0
    global_load_ushort v128, v2, s[66:67] offset:0
    global_load_short_d16_hi v4, v3, s[66:67] offset:0
    global_load_ushort v129, v2, s[66:67] offset:256
    global_load_short_d16_hi v5, v3, s[66:67] offset:256
    global_load_ushort v130, v2, s[66:67] offset:512
    global_load_short_d16_hi v6, v3, s[66:67] offset:512
    global_load_ushort v131, v2, s[66:67] offset:768
    global_load_short_d16_hi v7, v3, s[66:67] offset:768
    s_add_u32 s22, s22, 1
    s_waitcnt vmcnt(0)
    v_or_b32 v128, v128, v4
    v_or_b32 v129, v129, v5
    v_or_b32 v130, v130, v6
    v_or_b32 v131, v131, v7
    s_mul_i32 s24, s22, 3277
    s_lshr_b32 s24, s24, 16
    s_mul_i32 s68, s24, 20
    s_sub_u32 s68, s22, s68
    s_cmp_lt_u32 s68, 8
    s_cselect_b64 s[66:67], s[84:85], s[86:87]
    s_cselect_b32 s25, 0, 8
    s_sub_u32 s68, s68, s25
    s_and_b32 s25, s68, 1
    s_lshr_b32 s68, s68, 1
    s_lshl_b32 s68, s68, 14
    s_lshl_b32 s25, s25, 12
    s_add_u32 s68, s68, s25
    s_lshl_b32 s24, s24, 5
    s_add_u32 s68, s68, s24
    v_lshrrev_b32 v2, 4, v176
    v_lshlrev_b32 v2, 10, v2
    v_and_b32 v3, 15, v176
    v_lshl_add_u32 v2, v3, 1, v2
    v_add_u32 v2, s68, v2
    v_add_u32 v3, 8192, v2
    v_mov_b32 v4, 0
    v_mov_b32 v5, 0
    v_mov_b32 v6, 0
    v_mov_b32 v7, 0
    global_load_ushort v132, v2, s[66:67] offset:0
    global_load_short_d16_hi v4, v3, s[66:67] offset:0
    global_load_ushort v133, v2, s[66:67] offset:256
    global_load_short_d16_hi v5, v3, s[66:67] offset:256
    global_load_ushort v134, v2, s[66:67] offset:512
    global_load_short_d16_hi v6, v3, s[66:67] offset:512
    global_load_ushort v135, v2, s[66:67] offset:768
    global_load_short_d16_hi v7, v3, s[66:67] offset:768
    s_add_u32 s22, s22, 1
    s_waitcnt vmcnt(0)
    v_or_b32 v132, v132, v4
    v_or_b32 v133, v133, v5
    v_or_b32 v134, v134, v6
    v_or_b32 v135, v135, v7
    s_mul_i32 s24, s22, 3277
    s_lshr_b32 s24, s24, 16
    s_mul_i32 s68, s24, 20
    s_sub_u32 s68, s22, s68
    s_cmp_lt_u32 s68, 8
    s_cselect_b64 s[66:67], s[84:85], s[86:87]
    s_cselect_b32 s25, 0, 8
    s_sub_u32 s68, s68, s25
    s_and_b32 s25, s68, 1
    s_lshr_b32 s68, s68, 1
    s_lshl_b32 s68, s68, 14
    s_lshl_b32 s25, s25, 12
    s_add_u32 s68, s68, s25
    s_lshl_b32 s24, s24, 5
    s_add_u32 s68, s68, s24
    v_lshrrev_b32 v2, 4, v176
    v_lshlrev_b32 v2, 10, v2
    v_and_b32 v3, 15, v176
    v_lshl_add_u32 v2, v3, 1, v2
    v_add_u32 v2, s68, v2
    v_add_u32 v3, 8192, v2
    v_mov_b32 v4, 0
    v_mov_b32 v5, 0
    v_mov_b32 v6, 0
    v_mov_b32 v7, 0
    global_load_ushort v152, v2, s[66:67] offset:0
    global_load_short_d16_hi v4, v3, s[66:67] offset:0
    global_load_ushort v153, v2, s[66:67] offset:256
    global_load_short_d16_hi v5, v3, s[66:67] offset:256
    global_load_ushort v154, v2, s[66:67] offset:512
    global_load_short_d16_hi v6, v3, s[66:67] offset:512
    global_load_ushort v155, v2, s[66:67] offset:768
    global_load_short_d16_hi v7, v3, s[66:67] offset:768
    s_add_u32 s22, s22, 1
    s_waitcnt vmcnt(0)
    v_or_b32 v152, v152, v4
    v_or_b32 v153, v153, v5
    v_or_b32 v154, v154, v6
    v_or_b32 v155, v155, v7
    s_mul_i32 s24, s22, 3277
    s_lshr_b32 s24, s24, 16
    s_mul_i32 s68, s24, 20
    s_sub_u32 s68, s22, s68
    s_cmp_lt_u32 s68, 8
    s_cselect_b64 s[66:67], s[84:85], s[86:87]
    s_cselect_b32 s25, 0, 8
    s_sub_u32 s68, s68, s25
    s_and_b32 s25, s68, 1
    s_lshr_b32 s68, s68, 1
    s_lshl_b32 s68, s68, 14
    s_lshl_b32 s25, s25, 12
    s_add_u32 s68, s68, s25
    s_lshl_b32 s24, s24, 5
    s_add_u32 s68, s68, s24
    v_lshrrev_b32 v2, 4, v176
    v_lshlrev_b32 v2, 10, v2
    v_and_b32 v3, 15, v176
    v_lshl_add_u32 v2, v3, 1, v2
    v_add_u32 v2, s68, v2
    v_add_u32 v3, 8192, v2
    v_mov_b32 v4, 0
    v_mov_b32 v5, 0
    v_mov_b32 v6, 0
    v_mov_b32 v7, 0
    global_load_ushort v156, v2, s[66:67] offset:0
    global_load_short_d16_hi v4, v3, s[66:67] offset:0
    global_load_ushort v157, v2, s[66:67] offset:256
    global_load_short_d16_hi v5, v3, s[66:67] offset:256
    global_load_ushort v158, v2, s[66:67] offset:512
    global_load_short_d16_hi v6, v3, s[66:67] offset:512
    global_load_ushort v159, v2, s[66:67] offset:768
    global_load_short_d16_hi v7, v3, s[66:67] offset:768
    s_add_u32 s22, s22, 1
    s_waitcnt vmcnt(0)
    v_or_b32 v156, v156, v4
    v_or_b32 v157, v157, v5
    v_or_b32 v158, v158, v6
    v_or_b32 v159, v159, v7
    s_mul_i32 s24, s22, 3277
    s_lshr_b32 s24, s24, 16
    s_mul_i32 s68, s24, 20
    s_sub_u32 s68, s22, s68
    s_cmp_lt_u32 s68, 8
    s_cselect_b64 s[66:67], s[84:85], s[86:87]
    s_cselect_b32 s25, 0, 8
    s_sub_u32 s68, s68, s25
    s_and_b32 s25, s68, 1
    s_lshr_b32 s68, s68, 1
    s_lshl_b32 s68, s68, 14
    s_lshl_b32 s25, s25, 12
    s_add_u32 s68, s68, s25
    s_lshl_b32 s24, s24, 5
    s_add_u32 s68, s68, s24
    v_lshrrev_b32 v2, 4, v176
    v_lshlrev_b32 v2, 10, v2
    v_and_b32 v3, 15, v176
    v_lshl_add_u32 v2, v3, 1, v2
    v_add_u32 v2, s68, v2
    v_add_u32 v3, 8192, v2
    v_mov_b32 v4, 0
    v_mov_b32 v5, 0
    v_mov_b32 v6, 0
    v_mov_b32 v7, 0
    global_load_ushort v136, v2, s[66:67] offset:0
    global_load_short_d16_hi v4, v3, s[66:67] offset:0
    global_load_ushort v137, v2, s[66:67] offset:256
    global_load_short_d16_hi v5, v3, s[66:67] offset:256
    global_load_ushort v138, v2, s[66:67] offset:512
    global_load_short_d16_hi v6, v3, s[66:67] offset:512
    global_load_ushort v139, v2, s[66:67] offset:768
    global_load_short_d16_hi v7, v3, s[66:67] offset:768
    s_add_u32 s22, s22, 1
    s_waitcnt vmcnt(0)
    v_or_b32 v136, v136, v4
    v_or_b32 v137, v137, v5
    v_or_b32 v138, v138, v6
    v_or_b32 v139, v139, v7
    s_mul_i32 s24, s22, 3277
    s_lshr_b32 s24, s24, 16
    s_mul_i32 s68, s24, 20
    s_sub_u32 s68, s22, s68
    s_cmp_lt_u32 s68, 8
    s_cselect_b64 s[66:67], s[84:85], s[86:87]
    s_cselect_b32 s25, 0, 8
    s_sub_u32 s68, s68, s25
    s_and_b32 s25, s68, 1
    s_lshr_b32 s68, s68, 1
    s_lshl_b32 s68, s68, 14
    s_lshl_b32 s25, s25, 12
    s_add_u32 s68, s68, s25
    s_lshl_b32 s24, s24, 5
    s_add_u32 s68, s68, s24
    v_lshrrev_b32 v2, 4, v176
    v_lshlrev_b32 v2, 10, v2
    v_and_b32 v3, 15, v176
    v_lshl_add_u32 v2, v3, 1, v2
    v_add_u32 v2, s68, v2
    v_add_u32 v3, 8192, v2
    v_mov_b32 v4, 0
    v_mov_b32 v5, 0
    v_mov_b32 v6, 0
    v_mov_b32 v7, 0
    global_load_ushort v140, v2, s[66:67] offset:0
    global_load_short_d16_hi v4, v3, s[66:67] offset:0
    global_load_ushort v141, v2, s[66:67] offset:256
    global_load_short_d16_hi v5, v3, s[66:67] offset:256
    global_load_ushort v142, v2, s[66:67] offset:512
    global_load_short_d16_hi v6, v3, s[66:67] offset:512
    global_load_ushort v143, v2, s[66:67] offset:768
    global_load_short_d16_hi v7, v3, s[66:67] offset:768
    s_add_u32 s22, s22, 1
    s_waitcnt vmcnt(0)
    v_or_b32 v140, v140, v4
    v_or_b32 v141, v141, v5
    v_or_b32 v142, v142, v6
    v_or_b32 v143, v143, v7
    s_mul_i32 s24, s22, 3277
    s_lshr_b32 s24, s24, 16
    s_mul_i32 s68, s24, 20
    s_sub_u32 s68, s22, s68
    s_cmp_lt_u32 s68, 8
    s_cselect_b64 s[66:67], s[84:85], s[86:87]
    s_cselect_b32 s25, 0, 8
    s_sub_u32 s68, s68, s25
    s_and_b32 s25, s68, 1
    s_lshr_b32 s68, s68, 1
    s_lshl_b32 s68, s68, 14
    s_lshl_b32 s25, s25, 12
    s_add_u32 s68, s68, s25
    s_lshl_b32 s24, s24, 5
    s_add_u32 s68, s68, s24
    v_lshrrev_b32 v2, 4, v176
    v_lshlrev_b32 v2, 10, v2
    v_and_b32 v3, 15, v176
    v_lshl_add_u32 v2, v3, 1, v2
    v_add_u32 v2, s68, v2
    v_add_u32 v3, 8192, v2
    v_mov_b32 v4, 0
    v_mov_b32 v5, 0
    v_mov_b32 v6, 0
    v_mov_b32 v7, 0
    global_load_ushort v168, v2, s[66:67] offset:0
    global_load_short_d16_hi v4, v3, s[66:67] offset:0
    global_load_ushort v169, v2, s[66:67] offset:256
    global_load_short_d16_hi v5, v3, s[66:67] offset:256
    global_load_ushort v170, v2, s[66:67] offset:512
    global_load_short_d16_hi v6, v3, s[66:67] offset:512
    global_load_ushort v171, v2, s[66:67] offset:768
    global_load_short_d16_hi v7, v3, s[66:67] offset:768
    s_add_u32 s22, s22, 1
    s_waitcnt vmcnt(0)
    v_or_b32 v168, v168, v4
    v_or_b32 v169, v169, v5
    v_or_b32 v170, v170, v6
    v_or_b32 v171, v171, v7
    s_mul_i32 s24, s22, 3277
    s_lshr_b32 s24, s24, 16
    s_mul_i32 s68, s24, 20
    s_sub_u32 s68, s22, s68
    s_cmp_lt_u32 s68, 8
    s_cselect_b64 s[66:67], s[84:85], s[86:87]
    s_cselect_b32 s25, 0, 8
    s_sub_u32 s68, s68, s25
    s_and_b32 s25, s68, 1
    s_lshr_b32 s68, s68, 1
    s_lshl_b32 s68, s68, 14
    s_lshl_b32 s25, s25, 12
    s_add_u32 s68, s68, s25
    s_lshl_b32 s24, s24, 5
    s_add_u32 s68, s68, s24
    v_lshrrev_b32 v2, 4, v176
    v_lshlrev_b32 v2, 10, v2
    v_and_b32 v3, 15, v176
    v_lshl_add_u32 v2, v3, 1, v2
    v_add_u32 v2, s68, v2
    v_add_u32 v3, 8192, v2
    v_mov_b32 v4, 0
    v_mov_b32 v5, 0
    v_mov_b32 v6, 0
    v_mov_b32 v7, 0
    global_load_ushort v172, v2, s[66:67] offset:0
    global_load_short_d16_hi v4, v3, s[66:67] offset:0
    global_load_ushort v173, v2, s[66:67] offset:256
    global_load_short_d16_hi v5, v3, s[66:67] offset:256
    global_load_ushort v174, v2, s[66:67] offset:512
    global_load_short_d16_hi v6, v3, s[66:67] offset:512
    global_load_ushort v175, v2, s[66:67] offset:768
    global_load_short_d16_hi v7, v3, s[66:67] offset:768
    s_add_u32 s22, s22, 1
    s_waitcnt vmcnt(0)
    v_or_b32 v172, v172, v4
    v_or_b32 v173, v173, v5
    v_or_b32 v174, v174, v6
    v_or_b32 v175, v175, v7
    s_mul_i32 s24, s22, 3277
    s_lshr_b32 s24, s24, 16
    s_mul_i32 s68, s24, 20
    s_sub_u32 s68, s22, s68
    s_cmp_lt_u32 s68, 8
    s_cselect_b64 s[66:67], s[84:85], s[86:87]
    s_cselect_b32 s25, 0, 8
    s_sub_u32 s68, s68, s25
    s_and_b32 s25, s68, 1
    s_lshr_b32 s68, s68, 1
    s_lshl_b32 s68, s68, 14
    s_lshl_b32 s25, s25, 12
    s_add_u32 s68, s68, s25
    s_lshl_b32 s24, s24, 5
    s_add_u32 s68, s68, s24
    v_lshrrev_b32 v2, 4, v176
    v_lshlrev_b32 v2, 10, v2
    v_and_b32 v3, 15, v176
    v_lshl_add_u32 v2, v3, 1, v2
    v_add_u32 v2, s68, v2
    v_add_u32 v3, 8192, v2
    v_mov_b32 v4, 0
    v_mov_b32 v5, 0
    v_mov_b32 v6, 0
    v_mov_b32 v7, 0
    global_load_ushort v112, v2, s[66:67] offset:0
    global_load_short_d16_hi v4, v3, s[66:67] offset:0
    global_load_ushort v113, v2, s[66:67] offset:256
    global_load_short_d16_hi v5, v3, s[66:67] offset:256
    global_load_ushort v114, v2, s[66:67] offset:512
    global_load_short_d16_hi v6, v3, s[66:67] offset:512
    global_load_ushort v115, v2, s[66:67] offset:768
    global_load_short_d16_hi v7, v3, s[66:67] offset:768
    s_add_u32 s22, s22, 1
    s_waitcnt vmcnt(0)
    v_or_b32 v112, v112, v4
    v_or_b32 v113, v113, v5
    v_or_b32 v114, v114, v6
    v_or_b32 v115, v115, v7
    s_mul_i32 s24, s22, 3277
    s_lshr_b32 s24, s24, 16
    s_mul_i32 s68, s24, 20
    s_sub_u32 s68, s22, s68
    s_cmp_lt_u32 s68, 8
    s_cselect_b64 s[66:67], s[84:85], s[86:87]
    s_cselect_b32 s25, 0, 8
    s_sub_u32 s68, s68, s25
    s_and_b32 s25, s68, 1
    s_lshr_b32 s68, s68, 1
    s_lshl_b32 s68, s68, 14
    s_lshl_b32 s25, s25, 12
    s_add_u32 s68, s68, s25
    s_lshl_b32 s24, s24, 5
    s_add_u32 s68, s68, s24
    v_lshrrev_b32 v2, 4, v176
    v_lshlrev_b32 v2, 10, v2
    v_and_b32 v3, 15, v176
    v_lshl_add_u32 v2, v3, 1, v2
    v_add_u32 v2, s68, v2
    v_add_u32 v3, 8192, v2
    v_mov_b32 v4, 0
    v_mov_b32 v5, 0
    v_mov_b32 v6, 0
    v_mov_b32 v7, 0
    global_load_ushort v116, v2, s[66:67] offset:0
    global_load_short_d16_hi v4, v3, s[66:67] offset:0
    global_load_ushort v117, v2, s[66:67] offset:256
    global_load_short_d16_hi v5, v3, s[66:67] offset:256
    global_load_ushort v118, v2, s[66:67] offset:512
    global_load_short_d16_hi v6, v3, s[66:67] offset:512
    global_load_ushort v119, v2, s[66:67] offset:768
    global_load_short_d16_hi v7, v3, s[66:67] offset:768
    s_add_u32 s22, s22, 1
    s_waitcnt vmcnt(0)
    v_or_b32 v116, v116, v4
    v_or_b32 v117, v117, v5
    v_or_b32 v118, v118, v6
    v_or_b32 v119, v119, v7
    s_load_dwordx2 s[72:73], s[0:1], 72
    v_lshlrev_b32 v246, 4, v176
    s_mov_b32 s52, 163072
    v_bfe_u32 v177, v246, 4, 4
    v_bfe_u32 v179, v246, 4, 3
    v_lshl_add_u32 v180, v177, 3, s52
    v_lshl_add_u32 v190, v177, 4, s52
    v_lshl_add_u32 v181, v179, 3, s52
    ds_read2_b64 v[182:185], v180 offset0:32 offset1:48
    ds_read_b32 v191, v190
    ds_read_b64 v[186:187], v181 offset:512
    v_lshrrev_b32 v178, 8, v246
    s_add_u32 s22, s20, 0
    s_mul_i32 s28, s22, 1536
    s_add_u32 s28, s28, 86016
    s_lshl_b32 s22, s22, 21
    s_add_u32 s23, s20, 8
    s_mul_i32 s29, s23, 1536
    s_add_u32 s29, s29, 86144
    s_lshl_b32 s23, s23, 21
    s_add_u32 s24, s20, 16
    s_mul_i32 s30, s24, 1536
    s_add_u32 s30, s30, 86016
    s_lshl_b32 s24, s24, 21
    s_add_u32 s25, s20, 24
    s_lshl_b32 s25, s25, 21
    s_add_u32 s26, s20, 32
    s_lshl_b32 s26, s26, 21
    s_mov_b32 s53, 0
    s_mov_b32 s50, 0
    s_waitcnt lgkmcnt(0)
    s_branch GEMM
.section .rodata,"a"
.p2align 6
.amdhsa_kernel standalone__tensor_product_equiv_equiformer__graph_kernel
  .amdhsa_next_free_vgpr 256
  .amdhsa_next_free_sgpr 90
  .amdhsa_accum_offset 256
  .amdhsa_group_segment_fixed_size 0
  .amdhsa_kernarg_size 96
  .amdhsa_user_sgpr_count 2
  .amdhsa_user_sgpr_kernarg_segment_ptr 1
  .amdhsa_system_sgpr_workgroup_id_x 1
.end_amdhsa_kernel
```

```asm
; @launch grid=(250,1,1) block=(512,1,1) lds=163840
.amdgcn_target "amdgcn-amd-amdhsa--gfx950"
.text
.globl standalone__tensor_product_equiv_equiformer__graph_kernel
.p2align 8
.type standalone__tensor_product_equiv_equiformer__graph_kernel,@function
standalone__tensor_product_equiv_equiformer__graph_kernel:
    s_cmp_ge_u32 s2, 250
    s_cbranch_scc1 K2_end
    s_load_dwordx16 s[72:87], s[0:1], 0
    s_load_dwordx2 s[70:71], s[0:1], 88
    v_lshrrev_b32 v2, 6, v0
    v_and_b32 v1, 63, v0
    v_readfirstlane_b32 s20, v2
    s_getpc_b64 s[66:67]
    v_lshlrev_b32 v95, 7, v1
    s_cmp_eq_u32 s20, 6
    s_cbranch_scc0 F_nopf0
    global_load_dword v95, v95, s[66:67]
F_nopf0:
    s_mul_i32 s66, s2, 5120
    s_mul_i32 s67, s2, 7680
    v_lshl_add_u32 v3, v0, 4, s66
    v_mul_u32_u24 v4, 24, v0
    v_add_u32 v4, s67, v4
    v_lshlrev_b32 v5, 2, v0
    v_mov_b32 v89, 0
    v_add_u32 v6, 98304, v5
    ds_write_b32 v6, v89
    s_cmp_ge_u32 s20, 5
    s_waitcnt lgkmcnt(0)
    s_cbranch_scc1 F_noload
    global_load_dwordx4 v[8:11], v3, s[80:81] nt
    global_load_dwordx4 v[12:15], v3, s[78:79] nt
    global_load_dwordx4 v[16:19], v4, s[74:75] nt
    global_load_dwordx2 v[20:21], v4, s[74:75] offset:16 nt
F_noload:
    s_load_dword s88, s[70:71], 0
    s_barrier
    v_lshlrev_b32 v248, 2, v1
    v_add_u32 v88, 162816, v248
    ds_write_b32 v88, v89
    ds_write_b32 v88, v89 offset:256
    v_lshlrev_b32 v86, 4, v1
    s_lshl_b32 s21, s20, 13
    v_lshrrev_b32 v6, 5, v1
    v_mul_u32_u24 v6, 5120, v6
    v_and_b32 v7, 31, v1
    v_lshl_add_u32 v6, v7, 1, v6
    s_lshr_b32 s66, s20, 2
    s_lshl_b32 s66, s66, 7
    s_and_b32 s67, s20, 3
    s_mul_i32 s67, s67, 5
    s_add_u32 s68, s67, 0
    s_lshr_b32 s24, s68, 2
    s_lshl_b32 s24, s24, 8
    s_bfe_u32 s69, s68, 0x10001
    s_lshl_b32 s69, s69, 6
    s_add_u32 s24, s24, s69
    s_and_b32 s69, s68, 1
    s_mul_i32 s69, s69, 10240
    s_add_u32 s24, s24, s69
    s_add_u32 s24, s24, s66
    s_add_u32 s68, s67, 1
    s_lshr_b32 s25, s68, 2
    s_lshl_b32 s25, s25, 8
    s_bfe_u32 s69, s68, 0x10001
    s_lshl_b32 s69, s69, 6
    s_add_u32 s25, s25, s69
    s_and_b32 s69, s68, 1
    s_mul_i32 s69, s69, 10240
    s_add_u32 s25, s25, s69
    s_add_u32 s25, s25, s66
    s_add_u32 s68, s67, 2
    s_lshr_b32 s26, s68, 2
    s_lshl_b32 s26, s26, 8
    s_bfe_u32 s69, s68, 0x10001
    s_lshl_b32 s69, s69, 6
    s_add_u32 s26, s26, s69
    s_and_b32 s69, s68, 1
    s_mul_i32 s69, s69, 10240
    s_add_u32 s26, s26, s69
    s_add_u32 s26, s26, s66
    s_add_u32 s68, s67, 3
    s_lshr_b32 s27, s68, 2
    s_lshl_b32 s27, s27, 8
    s_bfe_u32 s69, s68, 0x10001
    s_lshl_b32 s69, s69, 6
    s_add_u32 s27, s27, s69
    s_and_b32 s69, s68, 1
    s_mul_i32 s69, s69, 10240
    s_add_u32 s27, s27, s69
    s_add_u32 s27, s27, s66
    s_add_u32 s68, s67, 4
    s_lshr_b32 s28, s68, 2
    s_lshl_b32 s28, s28, 8
    s_bfe_u32 s69, s68, 0x10001
    s_lshl_b32 s69, s69, 6
    s_add_u32 s28, s28, s69
    s_and_b32 s69, s68, 1
    s_mul_i32 s69, s69, 10240
    s_add_u32 s28, s28, s69
    s_add_u32 s28, s28, s66
    v_mov_b32 v96, 0
    v_mov_b32 v97, 0
    v_mov_b32 v98, 0
    v_mov_b32 v99, 0
    v_mov_b32 v100, 0
    v_mov_b32 v101, 0
    v_mov_b32 v102, 0
    v_mov_b32 v103, 0
    v_mov_b32 v104, 0
    v_mov_b32 v105, 0
    v_mov_b32 v106, 0
    v_mov_b32 v107, 0
    v_mov_b32 v108, 0
    v_mov_b32 v109, 0
    v_mov_b32 v110, 0
    v_mov_b32 v111, 0
    v_mov_b32 v112, 0
    v_mov_b32 v113, 0
    v_mov_b32 v114, 0
    v_mov_b32 v115, 0
    v_mov_b32 v180, 0
    v_mov_b32 v181, 0
    v_mov_b32 v182, 0
    v_mov_b32 v183, 0
    s_mov_b32 s16, s70
    s_and_b32 s17, s71, 0xffff
    s_mov_b32 s18, 24165888
    s_mov_b32 s19, 0x20000
    v_lshrrev_b32 v2, 3, v1
    v_lshl_add_u32 v2, s20, 5, v2
    v_and_b32 v91, 7, v1
    v_mul_u32_u24 v94, 384, v2
    v_lshl_add_u32 v94, v91, 4, v94
    v_lshlrev_b32 v93, 2, v2
    v_add_u32 v93, 98304, v93
    v_mul_u32_u24 v92, 32000, v2
    v_lshl_add_u32 v92, v91, 4, v92
    v_mul_u32_u24 v90, 40960, v2
    s_mov_b32 s32, s82
    s_and_b32 s33, s83, 0xffff
    s_mov_b32 s34, 20480
    s_mov_b32 s35, 0x20000
    s_cmp_ge_u32 s20, 5
    s_cbranch_scc1 F_helper
    s_mov_b32 s22, 52429
    s_mov_b32 s23, 0x05040100
    s_mov_b32 s66, 98304
    s_movk_i32 s67, -40
    v_mov_b32 v7, 1
    v_add_u32 v31, 1, v5
    v_add_u32 v32, 2, v5
    v_add_u32 v33, 3, v5
    s_waitcnt vmcnt(3)
    v_mul_u32_u24 v22, s22, v8
    v_mul_u32_u24 v23, s22, v9
    v_mul_u32_u24 v24, s22, v10
    v_mul_u32_u24 v25, s22, v11
    v_lshrrev_b32 v22, 21, v22
    v_lshrrev_b32 v23, 21, v23
    v_lshrrev_b32 v24, 21, v24
    v_lshrrev_b32 v25, 21, v25
    v_lshl_add_u32 v34, v22, 2, s66
    ds_add_rtn_u32 v26, v34, v7
    v_lshl_add_u32 v35, v23, 2, s66
    ds_add_rtn_u32 v27, v35, v7
    v_lshl_add_u32 v36, v24, 2, s66
    ds_add_rtn_u32 v28, v36, v7
    v_lshl_add_u32 v37, v25, 2, s66
    ds_add_rtn_u32 v29, v37, v7
    buffer_load_short_d16_hi v96, v6, s[32:35], s24 offen offset:0
    buffer_load_short_d16_hi v97, v6, s[32:35], s24 offen offset:1280
    buffer_load_short_d16_hi v98, v6, s[32:35], s24 offen offset:2560
    buffer_load_short_d16_hi v99, v6, s[32:35], s24 offen offset:3840
    buffer_load_short_d16_hi v100, v6, s[32:35], s25 offen offset:0
    buffer_load_short_d16_hi v101, v6, s[32:35], s25 offen offset:1280
    buffer_load_short_d16_hi v102, v6, s[32:35], s25 offen offset:2560
    buffer_load_short_d16_hi v103, v6, s[32:35], s25 offen offset:3840
    buffer_load_short_d16_hi v104, v6, s[32:35], s26 offen offset:0
    buffer_load_short_d16_hi v105, v6, s[32:35], s26 offen offset:1280
    buffer_load_short_d16_hi v106, v6, s[32:35], s26 offen offset:2560
    buffer_load_short_d16_hi v107, v6, s[32:35], s26 offen offset:3840
    buffer_load_short_d16_hi v108, v6, s[32:35], s27 offen offset:0
    buffer_load_short_d16_hi v109, v6, s[32:35], s27 offen offset:1280
    buffer_load_short_d16_hi v110, v6, s[32:35], s27 offen offset:2560
    buffer_load_short_d16_hi v111, v6, s[32:35], s27 offen offset:3840
    buffer_load_short_d16_hi v112, v6, s[32:35], s28 offen offset:0
    buffer_load_short_d16_hi v113, v6, s[32:35], s28 offen offset:1280
    buffer_load_short_d16_hi v114, v6, s[32:35], s28 offen offset:2560
    buffer_load_short_d16_hi v115, v6, s[32:35], s28 offen offset:3840
    v_mad_i32_i24 v2, v22, s67, v8
    v_mul_u32_u24 v22, 384, v22
    v_lshl_or_b32 v42, v2, 11, v5
    v_mad_i32_i24 v2, v23, s67, v9
    v_mul_u32_u24 v23, 384, v23
    v_lshl_or_b32 v46, v2, 11, v31
    v_mad_i32_i24 v2, v24, s67, v10
    v_mul_u32_u24 v24, 384, v24
    v_lshl_or_b32 v50, v2, 11, v32
    v_mad_i32_i24 v2, v25, s67, v11
    v_mul_u32_u24 v25, 384, v25
    v_lshl_or_b32 v54, v2, 11, v33
    s_waitcnt vmcnt(20)
    v_mov_b32 v40, v16
    v_perm_b32 v41, v12, v17, s23
    v_alignbit_b32 v44, v18, v17, 16
    v_alignbit_b32 v45, v13, v18, 16
    v_mov_b32 v48, v19
    v_perm_b32 v49, v14, v20, s23
    v_alignbit_b32 v52, v21, v20, 16
    v_alignbit_b32 v53, v15, v21, 16
    v_xor_b32 v41, 0x8000, v41
    v_xor_b32 v45, 0x8000, v45
    v_xor_b32 v49, 0x8000, v49
    v_xor_b32 v53, 0x8000, v53
    s_waitcnt lgkmcnt(0)
    v_min_u32 v26, 23, v26
    v_lshl_add_u32 v34, v26, 4, v22
    ds_write_b128 v34, v[40:43]
    v_min_u32 v27, 23, v27
    v_lshl_add_u32 v35, v27, 4, v23
    ds_write_b128 v35, v[44:47]
    v_min_u32 v28, 23, v28
    v_lshl_add_u32 v36, v28, 4, v24
    ds_write_b128 v36, v[48:51]
    v_min_u32 v29, 23, v29
    v_lshl_add_u32 v37, v29, 4, v25
    ds_write_b128 v37, v[52:55]
    s_branch F_staged
F_helper:
    buffer_load_short_d16_hi v96, v6, s[32:35], s24 offen offset:0
    buffer_load_short_d16_hi v97, v6, s[32:35], s24 offen offset:1280
    buffer_load_short_d16_hi v98, v6, s[32:35], s24 offen offset:2560
    buffer_load_short_d16_hi v99, v6, s[32:35], s24 offen offset:3840
    buffer_load_short_d16_hi v100, v6, s[32:35], s25 offen offset:0
    buffer_load_short_d16_hi v101, v6, s[32:35], s25 offen offset:1280
    buffer_load_short_d16_hi v102, v6, s[32:35], s25 offen offset:2560
    buffer_load_short_d16_hi v103, v6, s[32:35], s25 offen offset:3840
    buffer_load_short_d16_hi v104, v6, s[32:35], s26 offen offset:0
    buffer_load_short_d16_hi v105, v6, s[32:35], s26 offen offset:1280
    buffer_load_short_d16_hi v106, v6, s[32:35], s26 offen offset:2560
    buffer_load_short_d16_hi v107, v6, s[32:35], s26 offen offset:3840
    buffer_load_short_d16_hi v108, v6, s[32:35], s27 offen offset:0
    buffer_load_short_d16_hi v109, v6, s[32:35], s27 offen offset:1280
    buffer_load_short_d16_hi v110, v6, s[32:35], s27 offen offset:2560
    buffer_load_short_d16_hi v111, v6, s[32:35], s27 offen offset:3840
    buffer_load_short_d16_hi v112, v6, s[32:35], s28 offen offset:0
    buffer_load_short_d16_hi v113, v6, s[32:35], s28 offen offset:1280
    buffer_load_short_d16_hi v114, v6, s[32:35], s28 offen offset:2560
    buffer_load_short_d16_hi v115, v6, s[32:35], s28 offen offset:3840
    s_cmp_eq_u32 s20, 6
    s_cbranch_scc0 F_nopf
    s_getpc_b64 s[66:67]
F_pc:
    s_lshr_b32 s68, s2, 3
    s_mul_i32 s68, s68, ((K2_last-F_pc)/128/31+1)*128
    v_lshl_add_u32 v2, v1, 7, s68
    v_min_u32 v2, K2_last-F_pc-4, v2
    v_cmp_gt_u32 vcc, (K2_last-F_pc)/128/31+1, v1
    s_mov_b64 exec, vcc
    global_load_dword v95, v2, s[66:67]
    s_mov_b64 exec, -1
F_nopf:
    s_cmp_eq_u32 s20, 7
    s_cbranch_scc0 F_staged
    s_cmp_lt_u32 s2, 160
    s_cbranch_scc0 F_staged
    s_mul_i32 s22, s2, 3277
    s_lshr_b32 s22, s22, 16
    s_mul_i32 s68, s22, 20
    s_sub_u32 s68, s2, s68
    s_cmp_lt_u32 s68, 8
    s_cselect_b64 s[66:67], s[84:85], s[86:87]
    s_cselect_b32 s23, 0, 8
    s_sub_u32 s68, s68, s23
    s_and_b32 s23, s68, 1
    s_lshr_b32 s68, s68, 1
    s_lshl_b32 s68, s68, 14
    s_lshl_b32 s23, s23, 12
    s_add_u32 s68, s68, s23
    s_lshl_b32 s22, s22, 5
    s_add_u32 s68, s68, s22
    v_lshrrev_b32 v2, 4, v1
    v_lshlrev_b32 v2, 10, v2
    v_and_b32 v3, 15, v1
    v_lshl_add_u32 v2, v3, 1, v2
    v_add_u32 v2, s68, v2
    v_add_u32 v3, 8192, v2
    global_load_ushort v176, v2, s[66:67] offset:0
    global_load_short_d16_hi v180, v3, s[66:67] offset:0
    global_load_ushort v177, v2, s[66:67] offset:256
    global_load_short_d16_hi v181, v3, s[66:67] offset:256
    global_load_ushort v178, v2, s[66:67] offset:512
    global_load_short_d16_hi v182, v3, s[66:67] offset:512
    global_load_ushort v179, v2, s[66:67] offset:768
    global_load_short_d16_hi v183, v3, s[66:67] offset:768
F_staged:
    s_lshl_b32 s66, s2, 7
    s_add_u32 s66, s66, 164864
    s_cmp_eq_u32 s20, 7
    s_cselect_b32 s22, 0xffff, -1
    s_cselect_b32 s23, 0, -1
    s_waitcnt lgkmcnt(0)
    s_add_u32 s88, s88, 1
    s_barrier
    ds_read_b32 v40, v93 offset:0
    ds_read_b128 v[8:11], v94 offset:0
    ds_read_b32 v14, v94 offset:136
    ds_read_b32 v41, v93 offset:32
    ds_read_b128 v[16:19], v94 offset:3072
    ds_read_b32 v22, v94 offset:3208
    ds_read_b32 v42, v93 offset:64
    ds_read_b128 v[24:27], v94 offset:6144
    ds_read_b32 v30, v94 offset:6280
    ds_read_b32 v43, v93 offset:96
    ds_read_b128 v[32:35], v94 offset:9216
    ds_read_b32 v38, v94 offset:9352
    s_add_u32 s28, s66, 0
    s_add_u32 s29, s66, 256000
    s_add_u32 s30, s66, 512000
    s_add_u32 s31, s66, 768000
    s_waitcnt lgkmcnt(9)
    v_min_u32 v5, 31, v40
    v_bfe_u32 v6, v14, 11, 6
    v_and_b32 v10, 0x1ffff, v10
    v_lshl_or_b32 v6, v5, 6, v6
    v_mov_b32 v11, s88
    v_lshl_or_b32 v10, v6, 17, v10
    buffer_store_dwordx4 v[8:11], v92, s[16:19], s28 offen sc1
    s_waitcnt lgkmcnt(6)
    v_min_u32 v5, 31, v41
    v_bfe_u32 v6, v22, 11, 6
    v_and_b32 v18, 0x1ffff, v18
    v_lshl_or_b32 v6, v5, 6, v6
    v_mov_b32 v19, s88
    v_lshl_or_b32 v18, v6, 17, v18
    buffer_store_dwordx4 v[16:19], v92, s[16:19], s29 offen sc1
    s_waitcnt lgkmcnt(3)
    v_min_u32 v5, 31, v42
    v_bfe_u32 v6, v30, 11, 6
    v_and_b32 v26, 0x1ffff, v26
    v_lshl_or_b32 v6, v5, 6, v6
    v_mov_b32 v27, s88
    v_lshl_or_b32 v26, v6, 17, v26
    buffer_store_dwordx4 v[24:27], v92, s[16:19], s30 offen sc1
    s_waitcnt lgkmcnt(0)
    v_min_u32 v5, 31, v43
    v_bfe_u32 v6, v38, 11, 6
    v_and_b32 v34, 0x1ffff, v34
    v_lshl_or_b32 v6, v5, 6, v6
    v_mov_b32 v35, s88
    v_lshl_or_b32 v34, v6, 17, v34
    s_mov_b64 exec, s[22:23]
    buffer_store_dwordx4 v[32:35], v92, s[16:19], s31 offen sc1
    s_mov_b64 exec, -1
    ds_read_b128 v[12:15], v94 offset:128
    ds_read_b128 v[20:23], v94 offset:3200
    ds_read_b128 v[28:31], v94 offset:6272
    ds_read_b128 v[36:39], v94 offset:9344
    s_waitcnt vmcnt(4)
F_now:
    v_cmp_lt_u32 vcc, 8, v40
    s_add_u32 s67, s28, 8000000
    s_waitcnt lgkmcnt(3)
    v_mov_b32 v15, s88
    s_mov_b64 exec, vcc
    s_cbranch_execz F_w0
    buffer_store_dwordx4 v[12:15], v92, s[16:19], s67 offen sc1
    v_cmp_lt_u32 vcc, 16, v40
    s_add_u32 s67, s67, 8000000
    s_mov_b64 exec, vcc
    s_cbranch_execz F_w0
    ds_read_b128 v[44:47], v94 offset:256
    s_waitcnt lgkmcnt(0)
    v_mov_b32 v47, s88
    buffer_store_dwordx4 v[44:47], v92, s[16:19], s67 offen sc1
    s_nop 1
F_w0:
    s_mov_b64 exec, -1
    v_cmp_lt_u32 vcc, 8, v41
    s_add_u32 s67, s29, 8000000
    s_waitcnt lgkmcnt(2)
    v_mov_b32 v23, s88
    s_mov_b64 exec, vcc
    s_cbranch_execz F_w1
    buffer_store_dwordx4 v[20:23], v92, s[16:19], s67 offen sc1
    v_cmp_lt_u32 vcc, 16, v41
    s_add_u32 s67, s67, 8000000
    s_mov_b64 exec, vcc
    s_cbranch_execz F_w1
    ds_read_b128 v[44:47], v94 offset:3328
    s_waitcnt lgkmcnt(0)
    v_mov_b32 v47, s88
    buffer_store_dwordx4 v[44:47], v92, s[16:19], s67 offen sc1
    s_nop 1
F_w1:
    s_mov_b64 exec, -1
    v_cmp_lt_u32 vcc, 8, v42
    s_add_u32 s67, s30, 8000000
    s_waitcnt lgkmcnt(1)
    v_mov_b32 v31, s88
    s_mov_b64 exec, vcc
    s_cbranch_execz F_w2
    buffer_store_dwordx4 v[28:31], v92, s[16:19], s67 offen sc1
    v_cmp_lt_u32 vcc, 16, v42
    s_add_u32 s67, s67, 8000000
    s_mov_b64 exec, vcc
    s_cbranch_execz F_w2
    ds_read_b128 v[44:47], v94 offset:6400
    s_waitcnt lgkmcnt(0)
    v_mov_b32 v47, s88
    buffer_store_dwordx4 v[44:47], v92, s[16:19], s67 offen sc1
    s_nop 1
F_w2:
    s_mov_b64 exec, -1
    v_cmp_lt_u32 vcc, 8, v43
    s_add_u32 s67, s31, 8000000
    s_and_b64 vcc, vcc, s[22:23]
    s_waitcnt lgkmcnt(0)
    v_mov_b32 v39, s88
    s_mov_b64 exec, vcc
    s_cbranch_execz F_w3
    buffer_store_dwordx4 v[36:39], v92, s[16:19], s67 offen sc1
    v_cmp_lt_u32 vcc, 16, v43
    s_add_u32 s67, s67, 8000000
    s_mov_b64 exec, vcc
    s_cbranch_execz F_w3
    ds_read_b128 v[44:47], v94 offset:9472
    s_waitcnt lgkmcnt(0)
    v_mov_b32 v47, s88
    buffer_store_dwordx4 v[44:47], v92, s[16:19], s67 offen sc1
    s_nop 1
F_w3:
    s_mov_b64 exec, -1
    s_cmp_eq_u32 s20, 7
    s_cbranch_scc0 F_nofrag
    s_cmp_lt_u32 s2, 160
    s_cbranch_scc0 F_nofrag
    v_or_b32 v176, v176, v180
    v_or_b32 v177, v177, v181
    v_or_b32 v178, v178, v182
    v_or_b32 v179, v179, v183
    s_lshl_b32 s66, s2, 10
    s_add_u32 s66, s66, 1024
    buffer_store_dwordx4 v[176:179], v86, s[16:19], s66 offen sc1
F_nofrag:
    s_barrier
    s_mul_i32 s24, s2, 32000
    s_lshl_b32 s25, s20, 12
    s_add_u32 s24, s24, s25
    s_add_u32 s24, s24, 164864
    s_add_u32 s25, s24, 8000000
    s_add_u32 s26, s25, 8000000
    v_mov_b32 v22, 0
    v_mov_b32 v23, s88
    s_mul_i32 s68, s20, 5120
    s_cmp_ge_u32 s20, 4
    s_cselect_b32 s70, 45056, 0
    s_add_u32 s68, s68, s70
    v_add_u32 v2, s68, v86
    ds_write_b128 v2, v[96:99] offset:0
    ds_write_b128 v2, v[100:103] offset:1024
    ds_write_b128 v2, v[104:107] offset:2048
    ds_write_b128 v2, v[108:111] offset:3072
    ds_write_b128 v2, v[112:115] offset:4096
    v_mov_b32 v4, 2130738944
    v_mov_b32 v5, 2130738944
    v_mov_b32 v6, 2130738944
    v_mov_b32 v7, 2130738944
    v_lshlrev_b32 v2, 4, v0
    v_add_u32 v3, 86016, v2
    ds_write_b128 v3, v[4:7] offset:0
    ds_write_b128 v3, v[4:7] offset:8192
    ds_write_b128 v3, v[4:7] offset:16384
    ds_write_b128 v3, v[4:7] offset:24576
    ds_write_b128 v3, v[4:7] offset:32768
    ds_write_b128 v3, v[4:7] offset:40960
    ds_write_b128 v3, v[4:7] offset:49152
    ds_write_b128 v3, v[4:7] offset:57344
    v_add_u32 v3, 0x10000, v3
    ds_write_b128 v3, v[4:7] offset:0
    v_min_u32 v2, 3056, v2
    v_add_u32 v2, 159744, v2
    ds_write_b128 v2, v[4:7]
    s_sub_u32 s72, s72, 128
    s_subb_u32 s73, s73, 0
    s_mov_b32 s4, s72
    s_and_b32 s5, s73, 0xffff
    s_mov_b32 s6, 10240000
    s_mov_b32 s7, 0x20000
    s_sub_u32 s72, s72, 1024
    s_subb_u32 s73, s73, 0
    s_mov_b32 s8, s72
    s_and_b32 s9, s73, 0xffff
    s_mov_b32 s10, 10241024
    s_mov_b32 s11, 0x20000
    s_mov_b32 s12, s76
    s_and_b32 s13, s77, 0xffff
    s_mov_b32 s14, 10240000
    s_mov_b32 s15, 0x20000
    v_lshrrev_b32 v2, 5, v1
    v_bfe_u32 v3, v1, 2, 2
    v_and_b32 v4, 3, v1
    v_bfe_u32 v5, v1, 4, 1
    v_lshlrev_b32 v6, 9, v2
    v_lshl_add_u32 v6, v3, 7, v6
    v_lshl_add_u32 v6, v5, 5, v6
    v_lshl_add_u32 v6, v4, 3, v6
    v_lshrrev_b32 v7, 1, v3
    v_lshl_add_u32 v6, v7, 6, v6
    v_add_u32 v244, s21, v6
    v_xor_b32 v245, 64, v244
    v_lshlrev_b32 v6, 7, v2
    v_lshl_add_u32 v6, v7, 5, v6
    v_and_b32 v7, 1, v3
    v_xor_b32 v7, 1, v7
    v_mul_u32_u24 v7, 90112, v7
    v_add_u32 v6, v6, v7
    v_lshl_add_u32 v249, v4, 3, v6
    v_lshl_add_u32 v6, v2, 2, v4
    v_bfe_u32 v7, v1, 2, 1
    v_lshl_add_u32 v6, v7, 3, v6
    v_lshlrev_b32 v6, 3, v6
    v_bfe_u32 v7, v1, 3, 1
    v_add_u32 v5, 1, v5
    v_mul_u32_u24 v7, v7, v5
    v_lshl_add_u32 v250, v7, 1, v6
    v_and_b32 v6, 0x38, v1
    v_add_u32 v247, 6, v6
    v_lshrrev_b32 v6, 2, v1
    v_lshrrev_b32 v7, 4, v1
    v_xor_b32 v6, v6, v7
    v_and_b32 v6, 1, v6
    v_lshlrev_b32 v6, 6, v6
    v_lshl_add_u32 v246, v4, 4, v6
    v_mov_b32 v242, 1.0
    v_mov_b32 v243, 1.0
    s_mov_b32 s54, 0xffffff00
    s_mov_b32 s55, 0xffffff00
    s_mov_b32 s56, 0xffff
    s_mov_b32 s57, 0xffff
    s_mov_b32 s58, 0
    s_mov_b32 s59, 134217856
    s_mov_b32 s60, 262272
    s_mov_b32 s61, 402915456
    s_mov_b32 s62, 940179840
    s_mov_b32 s63, 403046528
    s_mov_b32 s64, 402784384
    s_mov_b32 s65, 134348928
    s_mov_b32 s38, 128
    s_mov_b32 s33, -1
    s_and_b32 s68, s20, 3
    s_lshl_b32 s68, s68, 2
    s_lshr_b32 s69, s20, 2
    s_add_u32 s68, s68, s69
    s_lshl_b32 s68, s68, 4
    s_add_u32 s68, s68, 163072
    v_mov_b32 v251, s68
    s_mov_b32 s53, 0
    s_mov_b32 s50, 0
    s_mov_b32 s51, 0
    s_mov_b32 s47, 0
    s_mov_b32 s42, 0
    s_mov_b32 s3, 0
    s_mov_b32 s89, 0
    s_mov_b32 s34, 128
    s_mov_b32 s35, 384
    s_mov_b32 s36, 640
    s_mov_b32 s37, 896
    s_waitcnt lgkmcnt(0)
    s_barrier
    buffer_load_dwordx4 v[8:11], v86, s[16:19], s24 offen offset:0 sc1
    buffer_load_dwordx4 v[12:15], v86, s[16:19], s24 offen offset:1024 sc1
    buffer_load_dwordx4 v[16:19], v86, s[16:19], s24 offen offset:2048 sc1
    s_mov_b64 exec, s[22:23]
    buffer_load_dwordx4 v[20:23], v86, s[16:19], s24 offen offset:3072 sc1
    s_mov_b64 exec, -1
    ds_read_b128 v[96:99], v86 offset:0
    ds_read_b128 v[100:103], v86 offset:1024
    ds_read_b128 v[104:107], v86 offset:2048
    ds_read_b128 v[108:111], v86 offset:3072
    ds_read_b128 v[112:115], v86 offset:4096
    ds_read_b128 v[116:119], v86 offset:5120
    ds_read_b128 v[120:123], v86 offset:6144
    ds_read_b128 v[124:127], v86 offset:7168
    ds_read_b128 v[128:131], v86 offset:8192
    ds_read_b128 v[132:135], v86 offset:9216
    ds_read_b128 v[136:139], v86 offset:10240
    ds_read_b128 v[140:143], v86 offset:11264
    ds_read_b128 v[144:147], v86 offset:12288
    ds_read_b128 v[148:151], v86 offset:13312
    ds_read_b128 v[152:155], v86 offset:14336
    ds_read_b128 v[156:159], v86 offset:15360
    ds_read_b128 v[160:163], v86 offset:16384
    ds_read_b128 v[164:167], v86 offset:17408
    ds_read_b128 v[168:171], v86 offset:18432
    ds_read_b128 v[172:175], v86 offset:19456
    s_mov_b32 s27, 32768
    s_mov_b32 s71, 162816
    v_mov_b32 v3, 1
    s_cmp_eq_u32 s20, 7
    s_cselect_b32 s52, 160, 0
    v_cmp_gt_u32 s[68:69], 40, v1
    s_mov_b64 s[28:29], 0xff
    s_lshr_b32 s66, s2, 3
    s_lshl_b32 s66, s66, 3
    s_add_u32 s66, s66, s20
    s_mul_i32 s66, s66, 14
    v_min_u32 v93, 13, v1
    v_add_u32 v93, s66, v93
    v_lshlrev_b32 v93, 10, v93
    v_mov_b32 v94, 0x7f000000
F_poll:
    s_waitcnt vmcnt(0)
F_poll1:
    v_cmp_ne_u32 s[72:73], s88, v11
    v_cmp_ne_u32 s[74:75], s88, v15
    v_cmp_ne_u32 s[76:77], s88, v19
    v_cmp_ne_u32 s[78:79], s88, v23
    s_or_b64 s[80:81], s[72:73], s[74:75]
    s_or_b64 s[82:83], s[76:77], s[78:79]
    s_or_b64 s[80:81], s[80:81], s[82:83]
    s_cbranch_scc1 F_again
F_got:
    v_bfe_u32 v2, v10, 23, 5
    v_bfe_u32 v60, v10, 11, 6
    v_cmp_gt_u32 s[80:81], v2, v91
    v_lshl_add_u32 v60, v60, 2, s71
    v_cmp_lt_u32 s[72:73], 8, v2
    v_max_u32 v89, v89, v2
    s_mov_b64 exec, s[80:81]
    ds_add_rtn_u32 v72, v60, v3
    s_mov_b64 exec, s[72:73]
    s_cbranch_execz F_h0
    buffer_load_dwordx4 v[24:27], v86, s[16:19], s25 offen offset:0 sc1
    v_sub_u32 v56, v2, v91
    v_bfe_u32 v64, v10, 17, 6
    v_cmp_lt_u32 vcc, 8, v56
    v_lshl_add_u32 v64, v64, 2, s71
    s_mov_b64 exec, vcc
    ds_add_rtn_u32 v76, v64, v3
F_h0:
    s_mov_b64 exec, -1
    v_bfe_u32 v2, v14, 23, 5
    v_bfe_u32 v61, v14, 11, 6
    v_cmp_gt_u32 s[82:83], v2, v91
    v_lshl_add_u32 v61, v61, 2, s71
    v_cmp_lt_u32 s[74:75], 8, v2
    v_max_u32 v89, v89, v2
    s_mov_b64 exec, s[82:83]
    ds_add_rtn_u32 v73, v61, v3
    s_mov_b64 exec, s[74:75]
    s_cbranch_execz F_h1
    buffer_load_dwordx4 v[28:31], v86, s[16:19], s25 offen offset:1024 sc1
    v_sub_u32 v57, v2, v91
    v_bfe_u32 v65, v14, 17, 6
    v_cmp_lt_u32 vcc, 8, v57
    v_lshl_add_u32 v65, v65, 2, s71
    s_mov_b64 exec, vcc
    ds_add_rtn_u32 v77, v65, v3
F_h1:
    s_mov_b64 exec, -1
    v_bfe_u32 v2, v18, 23, 5
    v_bfe_u32 v62, v18, 11, 6
    v_cmp_gt_u32 s[84:85], v2, v91
    v_lshl_add_u32 v62, v62, 2, s71
    v_cmp_lt_u32 s[76:77], 8, v2
    v_max_u32 v89, v89, v2
    s_mov_b64 exec, s[84:85]
    ds_add_rtn_u32 v74, v62, v3
    s_mov_b64 exec, s[76:77]
    s_cbranch_execz F_h2
    buffer_load_dwordx4 v[32:35], v86, s[16:19], s25 offen offset:2048 sc1
    v_sub_u32 v58, v2, v91
    v_bfe_u32 v66, v18, 17, 6
    v_cmp_lt_u32 vcc, 8, v58
    v_lshl_add_u32 v66, v66, 2, s71
    s_mov_b64 exec, vcc
    ds_add_rtn_u32 v78, v66, v3
F_h2:
    s_mov_b64 exec, -1
    v_bfe_u32 v2, v22, 23, 5
    v_bfe_u32 v63, v22, 11, 6
    v_cmp_gt_u32 s[86:87], v2, v91
    v_lshl_add_u32 v63, v63, 2, s71
    v_cmp_lt_u32 s[78:79], 8, v2
    v_max_u32 v89, v89, v2
    s_mov_b64 exec, s[86:87]
    ds_add_rtn_u32 v75, v63, v3
    s_mov_b64 exec, s[78:79]
    s_cbranch_execz F_h3
    buffer_load_dwordx4 v[36:39], v86, s[16:19], s25 offen offset:3072 sc1
    v_sub_u32 v59, v2, v91
    v_bfe_u32 v67, v22, 17, 6
    v_cmp_lt_u32 vcc, 8, v59
    v_lshl_add_u32 v67, v67, 2, s71
    s_mov_b64 exec, vcc
    ds_add_rtn_u32 v79, v67, v3
F_h3:
    s_mov_b64 exec, -1
    v_cmp_lt_u32 s[30:31], 16, v89
    s_mov_b32 s27, 262144
    s_cmp_lg_u64 s[30:31], 0
    s_cbranch_scc1 F_l3
F_l3r:
    v_and_b32 v10, 0x7ff, v10
    v_lshl_add_u32 v10, v10, 5, v90
    v_or_b32 v11, 16, v10
    v_and_b32 v14, 0x7ff, v14
    v_lshl_add_u32 v14, v14, 5, v90
    v_add_u32 v14, 327680, v14
    v_or_b32 v15, 16, v14
    v_and_b32 v18, 0x7ff, v18
    v_lshl_add_u32 v18, v18, 5, v90
    v_add_u32 v18, 655360, v18
    v_or_b32 v19, 16, v18
    v_and_b32 v22, 0x7ff, v22
    v_lshl_add_u32 v22, v22, 5, v90
    v_add_u32 v22, 983040, v22
    v_or_b32 v23, 16, v22
    s_cmp_lt_u32 s2, s52
    s_cbranch_scc1 F_flag
F_flagr:
    s_waitcnt lgkmcnt(0)
    s_barrier
    ds_read_b32 v4, v88
    buffer_load_dword v95, v93, s[4:7], 0 offen offset:128
    v_lshlrev_b32 v72, 3, v72
    v_lshlrev_b32 v73, 3, v73
    v_lshlrev_b32 v74, 3, v74
    v_lshlrev_b32 v75, 3, v75
    v_lshlrev_b32 v76, 3, v76
    v_lshlrev_b32 v77, 3, v77
    v_lshlrev_b32 v78, 3, v78
    v_lshlrev_b32 v79, 3, v79
    s_waitcnt lgkmcnt(0)
    v_add_u32 v2, 7, v4
    v_cmp_lt_u32 vcc, 64, v4
    v_lshrrev_b32 v2, 3, v2
    v_max_u32 v2, 2, v2
    s_cmp_lg_u64 vcc, 0
    s_cbranch_scc1 SLOW
    v_med3_u32 v3, v2, 3, 7
    v_cmp_eq_u32 vcc, 7, v2
    v_mad_u32_u24 v3, v3, 6, 14
    v_lshlrev_b32_e64 v6, v3, 1
    v_cndmask_b32 v6, 0, v6, s[68:69]
    v_addc_co_u32 v2, vcc, 0, v2, vcc
    v_mov_b32 v7, v6
    v_add_u32 v5, 1, v2
    v_lshrrev_b32 v5, 1, v5
    v_add_u32_dpp v7, v7, v7 row_shr:1 row_mask:0xf bank_mask:0xf
    v_lshlrev_b32 v92, 22, v5
    v_lshlrev_b32 v5, 18, v5
    v_add_u32_dpp v7, v7, v7 row_shr:2 row_mask:0xf bank_mask:0xf
    v_lshl_or_b32 v5, v1, 21, v5
    v_lshl_or_b32 v5, v2, 28, v5
    v_add_u32_dpp v7, v7, v7 row_shr:4 row_mask:0xf bank_mask:0xf
    s_mov_b32 s26, 86016
    s_mov_b32 s24, 0x2000
    v_add_u32_dpp v7, v7, v7 row_shr:8 row_mask:0xf bank_mask:0xf
    s_nop 1
    v_add_u32_dpp v7, v7, v7 row_bcast:15 row_mask:0xa bank_mask:0xf
    s_nop 1
    v_add_u32_dpp v7, v7, v7 row_bcast:31 row_mask:0xc bank_mask:0xf
    s_nop 0
    v_readlane_b32 s71, v7, 63
    v_sub_u32 v7, v7, v6
    s_lshr_b32 s66, s71, 24
    s_lshr_b32 s67, s71, 6
    s_lshr_b32 s70, s71, 12
    s_lshr_b32 s71, s71, 18
    s_add_u32 s67, s67, s70
    s_add_u32 s71, s71, s66
    s_add_u32 s71, s71, s67
    v_add_u32 v7, s71, v7
    s_bfe_u32 s70, s71, 393222
    v_bfe_u32 v7, v7, v3, 6
    s_bfe_u32 s67, s71, 393228
    v_cndmask_b32 v84, 63, v7, s[68:69]
    s_mul_i32 s68, s70, 3
    v_min_u32 v2, s70, v7
    s_mul_i32 s69, s66, 5
    v_min_u32 v3, s66, v7
    s_add_u32 s68, s68, s69
    v_mul_u32_u24 v7, 12, v7
    s_cmp_gt_u32 s68, 120
    v_mad_u32_u24 v7, v2, 3, v7
    s_cbranch_scc1 SLOW
    v_mad_u32_u24 v7, v3, 5, v7
    v_lshl_add_u32 v7, v7, 7, s26
    v_lshrrev_b32 v6, 3, v7
    v_mad_u32_u24 v92, v7, s24, v92
    v_or_b32 v92, v92, v6
    v_or_b32 v6, v5, v7
    s_add_u32 s71, s70, s66
    s_add_u32 s68, s71, s67
    s_andn2_b32 s70, s70, 3
    s_add_u32 s69, s70, 4
    s_andn2_b32 s67, s67, 3
    v_lshrrev_b32 v3, 1, v84
    v_mov_b32 v2, s68
    v_xor_b32 v3, v3, v84
    v_bfi_b32 v3, 4, v3, v84
    v_cmpx_gt_u32 vcc, s69, v84
    v_mov_b32 v2, s66
    v_cmpx_gt_u32 vcc, s70, v84
    v_mov_b32 v2, s71
    v_cmpx_gt_u32 vcc, s67, v84
    v_mov_b32 v2, 0
    s_mov_b64 exec, -1
    v_add_u32 v2, v2, v84
    v_bfi_b32 v84, 3, v2, v3
    s_lshr_b32 s66, s2, 3
    v_cmp_gt_u32 vcc, 32, v84
    v_add_u32 v2, s66, v84
    v_lshl_add_u32 v2, v2, 3, v84
    v_bfi_b32 v2, 24, v2, v84
    v_cndmask_b32 v84, v84, v2, vcc
    v_subrev_u32 v2, 6, v84
    v_and_b32 v2, 0x80000000, v2
    v_or_b32 v92, v92, v2
    ds_bpermute_b32 v60, v60, v92
    ds_bpermute_b32 v61, v61, v92
    ds_bpermute_b32 v62, v62, v92
    ds_bpermute_b32 v63, v63, v92
    ds_bpermute_b32 v64, v64, v92
    ds_bpermute_b32 v65, v65, v92
    ds_bpermute_b32 v66, v66, v92
    ds_bpermute_b32 v67, v67, v92
    v_cmp_eq_u32 vcc, s20, v84
    s_ff1_i32_b64 s67, vcc
    v_readlane_b32 s71, v6, s67
    s_mov_b32 s22, s71
    s_bfe_u32 s46, s71, 0x30012
    s_mov_b32 m0, s46
    s_and_b32 s66, s71, 0x3ffff
    s_movrels_b32 s68, s57
    s_movrels_b32 s69, s61
    s_sub_u32 s48, s66, s47
    s_mov_b32 s47, s66
    s_lshr_b32 s52, s71, 28
    s_lshl_b32 s67, s46, 9
    s_add_u32 s66, s66, s67
    s_sub_u32 s49, s66, s42
    s_mov_b32 s42, s66
    s_bfe_u32 s66, s68, 655360
    s_add_u32 s43, s42, s66
    s_bfe_u32 s39, s69, 655360
    s_bfe_u32 s66, s68, 655370
    s_add_u32 s44, s42, s66
    s_bfe_u32 s40, s69, 655370
    s_bfe_u32 s66, s68, 655380
    s_add_u32 s45, s42, s66
    s_bfe_u32 s41, s69, 655380
    s_waitcnt lgkmcnt(7)
    v_cmp_gt_i32 vcc, 0, v60
    v_and_b32 v60, 0x7fffffff, v60
    s_and_b64 exec, vcc, s[80:81]
    buffer_load_dword v95, v10, s[12:15], 0 offen
    s_mov_b64 exec, -1
    v_mad_u32_u16 v2, v60, 8, v72
    v_mad_u32_u16 v3, v60, 8, v72 op_sel:[1,0,0,0]
    s_mov_b64 exec, s[80:81]
    ds_write_b64 v2, v[10:11]
    ds_write_b64 v3, v[8:9]
    s_mov_b64 exec, -1
    s_waitcnt lgkmcnt(8)
    v_cmp_gt_i32 vcc, 0, v61
    v_and_b32 v61, 0x7fffffff, v61
    s_and_b64 exec, vcc, s[82:83]
    buffer_load_dword v95, v14, s[12:15], 0 offen
    s_mov_b64 exec, -1
    v_mad_u32_u16 v2, v61, 8, v73
    v_mad_u32_u16 v3, v61, 8, v73 op_sel:[1,0,0,0]
    s_mov_b64 exec, s[82:83]
    ds_write_b64 v2, v[14:15]
    ds_write_b64 v3, v[12:13]
    s_mov_b64 exec, -1
    s_waitcnt lgkmcnt(9)
    v_cmp_gt_i32 vcc, 0, v62
    v_and_b32 v62, 0x7fffffff, v62
    s_and_b64 exec, vcc, s[84:85]
    buffer_load_dword v95, v18, s[12:15], 0 offen
    s_mov_b64 exec, -1
    v_mad_u32_u16 v2, v62, 8, v74
    v_mad_u32_u16 v3, v62, 8, v74 op_sel:[1,0,0,0]
    s_mov_b64 exec, s[84:85]
    ds_write_b64 v2, v[18:19]
    ds_write_b64 v3, v[16:17]
    s_mov_b64 exec, -1
    s_waitcnt lgkmcnt(10)
    v_cmp_gt_i32 vcc, 0, v63
    v_and_b32 v63, 0x7fffffff, v63
    s_and_b64 exec, vcc, s[86:87]
    buffer_load_dword v95, v22, s[12:15], 0 offen
    s_mov_b64 exec, -1
    v_mad_u32_u16 v2, v63, 8, v75
    v_mad_u32_u16 v3, v63, 8, v75 op_sel:[1,0,0,0]
    s_mov_b64 exec, s[86:87]
    ds_write_b64 v2, v[22:23]
    ds_write_b64 v3, v[20:21]
    s_mov_b64 exec, -1
    s_waitcnt vmcnt(5) lgkmcnt(8)
    s_mov_b64 exec, s[72:73]
    s_cbranch_execz F_s0
F_sp0:
    v_cmp_ne_u32 vcc, s88, v27
    s_cbranch_vccnz F_sa0
F_sg0:
    v_cmpx_lt_u32 vcc, 8, v56
    v_and_b32 v26, 0x7ff, v26
    v_lshl_add_u32 v26, v26, 5, v90
    v_or_b32 v27, 16, v26
    v_cmp_gt_i32 vcc, 0, v64
    v_and_b32 v64, 0x7fffffff, v64
    s_and_saveexec_b64 s[82:83], vcc
    s_cbranch_execz F_x0
    buffer_load_dword v95, v26, s[12:15], 0 offen
F_x0:
    s_mov_b64 exec, s[82:83]
    v_mad_u32_u16 v2, v64, 8, v76
    v_mad_u32_u16 v3, v64, 8, v76 op_sel:[1,0,0,0]
    ds_write_b64 v2, v[26:27]
    ds_write_b64 v3, v[24:25]
F_s0:
    s_mov_b64 exec, s[74:75]
    s_cbranch_execz F_s1
F_sp1:
    v_cmp_ne_u32 vcc, s88, v31
    s_cbranch_vccnz F_sa1
F_sg1:
    v_cmpx_lt_u32 vcc, 8, v57
    v_and_b32 v30, 0x7ff, v30
    v_lshl_add_u32 v30, v30, 5, v90
    v_add_u32 v30, 327680, v30
    v_or_b32 v31, 16, v30
    v_cmp_gt_i32 vcc, 0, v65
    v_and_b32 v65, 0x7fffffff, v65
    s_and_saveexec_b64 s[82:83], vcc
    s_cbranch_execz F_x1
    buffer_load_dword v95, v30, s[12:15], 0 offen
F_x1:
    s_mov_b64 exec, s[82:83]
    v_mad_u32_u16 v2, v65, 8, v77
    v_mad_u32_u16 v3, v65, 8, v77 op_sel:[1,0,0,0]
    ds_write_b64 v2, v[30:31]
    ds_write_b64 v3, v[28:29]
F_s1:
    s_mov_b64 exec, s[76:77]
    s_cbranch_execz F_s2
F_sp2:
    v_cmp_ne_u32 vcc, s88, v35
    s_cbranch_vccnz F_sa2
F_sg2:
    v_cmpx_lt_u32 vcc, 8, v58
    v_and_b32 v34, 0x7ff, v34
    v_lshl_add_u32 v34, v34, 5, v90
    v_add_u32 v34, 655360, v34
    v_or_b32 v35, 16, v34
    v_cmp_gt_i32 vcc, 0, v66
    v_and_b32 v66, 0x7fffffff, v66
    s_and_saveexec_b64 s[82:83], vcc
    s_cbranch_execz F_x2
    buffer_load_dword v95, v34, s[12:15], 0 offen
F_x2:
    s_mov_b64 exec, s[82:83]
    v_mad_u32_u16 v2, v66, 8, v78
    v_mad_u32_u16 v3, v66, 8, v78 op_sel:[1,0,0,0]
    ds_write_b64 v2, v[34:35]
    ds_write_b64 v3, v[32:33]
F_s2:
    s_mov_b64 exec, s[78:79]
    s_cbranch_execz F_s3
F_sp3:
    v_cmp_ne_u32 vcc, s88, v39
    s_cbranch_vccnz F_sa3
F_sg3:
    v_cmpx_lt_u32 vcc, 8, v59
    v_and_b32 v38, 0x7ff, v38
    v_lshl_add_u32 v38, v38, 5, v90
    v_add_u32 v38, 983040, v38
    v_or_b32 v39, 16, v38
    v_cmp_gt_i32 vcc, 0, v67
    v_and_b32 v67, 0x7fffffff, v67
    s_and_saveexec_b64 s[82:83], vcc
    s_cbranch_execz F_x3
    buffer_load_dword v95, v38, s[12:15], 0 offen
F_x3:
    s_mov_b64 exec, s[82:83]
    v_mad_u32_u16 v2, v67, 8, v79
    v_mad_u32_u16 v3, v67, 8, v79 op_sel:[1,0,0,0]
    ds_write_b64 v2, v[38:39]
    ds_write_b64 v3, v[36:37]
F_s3:
    s_mov_b64 exec, -1
    s_cmp_lg_u64 s[30:31], 0
    s_cbranch_scc1 F_u
F_ur:
    s_mov_b32 s27, s22
    s_and_b32 s66, s46, s33
    s_cselect_b32 s72, -1, 1
    s_cselect_b32 s76, s47, 163712
    s_cmp_ge_u32 s66, 2
    s_cselect_b32 s73, -1, 0
    s_add_u32 s77, s47, 1024
    s_cmp_ge_u32 s66, 4
    s_cselect_b32 s75, -1, 0
    s_cmp_ge_u32 s66, 3
    s_cselect_b32 s74, -1, 1
    s_cselect_b32 s77, s77, 163712
    s_mul_i32 s66, s20, 80
    v_min_u32 v2, 76, v248
    s_waitcnt lgkmcnt(0)
    s_barrier
    v_add_u32 v253, s47, v248
    ds_read_b32 v254, v253
    ds_read_b32 v255, v253 offset:256
    v_add_u32 v252, s42, v247
    ds_read_u16 v234, v252
    ds_read_u16 v235, v252 offset:64
    v_add_u32 v252, s43, v247
    ds_read_u16 v236, v252
    ds_read_u16 v237, v252 offset:64
    v_add_u32 v252, s44, v247
    ds_read_u16 v238, v252
    ds_read_u16 v239, v252 offset:64
    v_add_u32 v252, s45, v247
    ds_read_u16 v240, v252
    ds_read_u16 v241, v252 offset:64
    buffer_load_dword v3, v2, s[16:19], s66 offen offset:128 sc1
    v_add_u32 v249, s48, v249
    v_add_u32 v250, s49, v250
    s_waitcnt lgkmcnt(8)
    s_mov_b32 m0, s76
    s_mov_b64 exec, s[72:73]
    buffer_load_dwordx4 v254, s[12:15], 0 offen  lds
    s_mov_b32 m0, s77
    s_mov_b64 exec, s[74:75]
    buffer_load_dwordx4 v255, s[12:15], 0 offen  lds
    s_mov_b64 exec, -1
    s_waitcnt lgkmcnt(0)
    s_add_u32 m0, s21, 0
    v_lshl_add_u32 v234, v234, 10, v246
    v_lshl_add_u32 v235, v235, 10, v246
    buffer_load_dwordx4 v234, s[4:7], s38 offen  lds
    buffer_load_dwordx4 v235, s[8:11], s38 offen offset:1024  lds
    s_add_u32 m0, s21, 2048
    v_lshl_add_u32 v236, v236, 10, v246
    v_lshl_add_u32 v237, v237, 10, v246
    buffer_load_dwordx4 v236, s[4:7], s39 offen  lds
    buffer_load_dwordx4 v237, s[8:11], s39 offen offset:1024  lds
    s_add_u32 m0, s21, 4096
    v_lshl_add_u32 v238, v238, 10, v246
    v_lshl_add_u32 v239, v239, 10, v246
    buffer_load_dwordx4 v238, s[4:7], s40 offen  lds
    buffer_load_dwordx4 v239, s[8:11], s40 offen offset:1024  lds
    s_add_u32 m0, s21, 6144
    v_lshl_add_u32 v240, v240, 10, v246
    v_lshl_add_u32 v241, v241, 10, v246
    buffer_load_dwordx4 v240, s[4:7], s41 offen  lds
    buffer_load_dwordx4 v241, s[8:11], s41 offen offset:1024  lds
    v_lshrrev_b32 v8, 3, v84
    v_and_b32 v9, 7, v84
    v_lshlrev_b32 v9, 13, v9
    v_mul_u32_u24 v8, 1536, v8
    v_lshlrev_b32 v10, 4, v84
    v_and_b32 v5, 128, v10
    v_add3_u32 v8, v8, v9, v5
    v_xor_b32 v9, v10, v7
    v_and_b32 v9, 128, v9
    v_add_u32 v9, v9, v7
    v_mov_b32 v5, v9
    s_add_u32 s66, s20, 0
    v_cmp_eq_u32 vcc, s66, v84
    s_ff1_i32_b64 s67, vcc
    v_readlane_b32 s28, v5, s67
    s_add_u32 s66, s20, 8
    v_cmp_eq_u32 vcc, s66, v84
    s_ff1_i32_b64 s67, vcc
    v_readlane_b32 s29, v5, s67
    v_readlane_b32 s23, v6, s67
    s_add_u32 s66, s20, 16
    v_cmp_eq_u32 vcc, s66, v84
    s_ff1_i32_b64 s67, vcc
    v_readlane_b32 s30, v5, s67
    v_readlane_b32 s24, v6, s67
    s_add_u32 s66, s20, 24
    v_cmp_eq_u32 vcc, s66, v84
    s_ff1_i32_b64 s67, vcc
    v_readlane_b32 s31, v5, s67
    v_readlane_b32 s25, v6, s67
    s_add_u32 s66, s20, 32
    v_cmp_eq_u32 vcc, s66, v84
    s_ff1_i32_b64 s67, vcc
    v_readlane_b32 s32, v5, s67
    v_readlane_b32 s26, v6, s67
    v_lshlrev_b32 v4, 3, v84
    v_add_u32 v4, 163328, v4
    s_mov_b32 exec_hi, 0xff
    ds_write_b64 v4, v[8:9]
    s_mov_b32 exec_hi, -1
    s_waitcnt lgkmcnt(0)
    v_mov_b32 v252, 0
    s_waitcnt vmcnt(6)
    v_cmp_ne_u32 vcc, s88, v3
    ds_read_b64_tr_b16 v[176:177], v244 offset:0
    ds_read_b64_tr_b16 v[178:179], v244 offset:1024
    ds_read_b64_tr_b16 v[180:181], v245 offset:0
    ds_read_b64_tr_b16 v[182:183], v245 offset:1024
    ds_read_b64_tr_b16 v[64:65], v249 offset:0
    ds_read_b64_tr_b16 v[68:69], v249 offset:64
    ds_read_b64_tr_b16 v[66:67], v249 offset:256
    ds_read_b64_tr_b16 v[70:71], v249 offset:320
    s_mov_b64 exec, s[54:55]
    ds_read_u16_d16_hi v242, v250 offset:0
    s_mov_b64 exec, -1
    s_or_b32 s89, vcc_lo, vcc_hi
    s_add_u32 s53, s53, 4
    s_xor_b32 s66, s53, s20
    s_bitcmp1_b32 s66, 2
    s_setprio 1
    s_cbranch_scc1 PRIO_1
    s_setprio 0
PRIO_1:
    s_cmp_eq_u32 s52, 4
    s_cbranch_scc1 ITEM_0_4
    s_cmp_eq_u32 s52, 5
    s_cbranch_scc1 ITEM_0_5
    s_cmp_eq_u32 s52, 3
    s_cbranch_scc1 ITEM_0_3
    s_cmp_eq_u32 s52, 6
    s_cbranch_scc1 ITEM_0_6
    s_cmp_eq_u32 s52, 8
    s_cbranch_scc1 ITEM_0_8
    s_branch ITEM_0_2
F_again:
    s_sub_u32 s27, s27, 1
    s_cbranch_scc1 F_late
    s_cmp_eq_u64 s[72:73], 0
    s_cbranch_scc1 F_p0
    s_mov_b64 exec, s[72:73]
    buffer_load_dwordx4 v[8:11], v86, s[16:19], s24 offen offset:0 sc1
    s_mov_b64 exec, -1
F_p0:
    s_cmp_eq_u64 s[74:75], 0
    s_cbranch_scc1 F_p1
    s_mov_b64 exec, s[74:75]
    buffer_load_dwordx4 v[12:15], v86, s[16:19], s24 offen offset:1024 sc1
    s_mov_b64 exec, -1
F_p1:
    s_cmp_eq_u64 s[76:77], 0
    s_cbranch_scc1 F_p2
    s_mov_b64 exec, s[76:77]
    buffer_load_dwordx4 v[16:19], v86, s[16:19], s24 offen offset:2048 sc1
    s_mov_b64 exec, -1
F_p2:
    s_cmp_eq_u64 s[78:79], 0
    s_cbranch_scc1 F_p3
    s_mov_b64 exec, s[78:79]
    buffer_load_dwordx4 v[20:23], v86, s[16:19], s24 offen offset:3072 sc1
    s_mov_b64 exec, -1
F_p3:
    s_branch F_poll
F_late:
    v_mov_b32 v2, 163064
    v_mov_b32 v4, 1000
    ds_write_b32 v2, v4
    v_mov_b32 v10, 0
    v_mov_b32 v14, 0
    v_mov_b32 v18, 0
    v_mov_b32 v22, 0
    s_branch F_got
F_l3:
    v_bfe_u32 v2, v10, 23, 5
    v_sub_u32 v56, v2, v91
    v_cmp_lt_u32 vcc, 16, v2
    s_mov_b64 exec, vcc
    s_cbranch_execz F_t0
F_tp0:
    buffer_load_dwordx4 v[40:43], v86, s[16:19], s26 offen offset:0 sc1
    s_waitcnt vmcnt(0)
    v_cmp_ne_u32 vcc, s88, v43
    s_sub_u32 s27, s27, 1
    s_cselect_b64 vcc, 0, vcc
    s_cmp_eq_u64 vcc, 0
    s_cbranch_scc0 F_tp0
    v_bfe_u32 v68, v42, 11, 6
    v_lshl_add_u32 v68, v68, 2, s71
    v_cmp_lt_i32 vcc, 16, v56
    s_mov_b64 exec, vcc
    ds_add_rtn_u32 v80, v68, v3
F_t0:
    s_mov_b64 exec, -1
    v_bfe_u32 v2, v14, 23, 5
    v_sub_u32 v57, v2, v91
    v_cmp_lt_u32 vcc, 16, v2
    s_mov_b64 exec, vcc
    s_cbranch_execz F_t1
F_tp1:
    buffer_load_dwordx4 v[44:47], v86, s[16:19], s26 offen offset:1024 sc1
    s_waitcnt vmcnt(0)
    v_cmp_ne_u32 vcc, s88, v47
    s_sub_u32 s27, s27, 1
    s_cselect_b64 vcc, 0, vcc
    s_cmp_eq_u64 vcc, 0
    s_cbranch_scc0 F_tp1
    v_bfe_u32 v69, v46, 11, 6
    v_lshl_add_u32 v69, v69, 2, s71
    v_cmp_lt_i32 vcc, 16, v57
    s_mov_b64 exec, vcc
    ds_add_rtn_u32 v81, v69, v3
F_t1:
    s_mov_b64 exec, -1
    v_bfe_u32 v2, v18, 23, 5
    v_sub_u32 v58, v2, v91
    v_cmp_lt_u32 vcc, 16, v2
    s_mov_b64 exec, vcc
    s_cbranch_execz F_t2
F_tp2:
    buffer_load_dwordx4 v[48:51], v86, s[16:19], s26 offen offset:2048 sc1
    s_waitcnt vmcnt(0)
    v_cmp_ne_u32 vcc, s88, v51
    s_sub_u32 s27, s27, 1
    s_cselect_b64 vcc, 0, vcc
    s_cmp_eq_u64 vcc, 0
    s_cbranch_scc0 F_tp2
    v_bfe_u32 v70, v50, 11, 6
    v_lshl_add_u32 v70, v70, 2, s71
    v_cmp_lt_i32 vcc, 16, v58
    s_mov_b64 exec, vcc
    ds_add_rtn_u32 v82, v70, v3
F_t2:
    s_mov_b64 exec, -1
    v_bfe_u32 v2, v22, 23, 5
    v_sub_u32 v59, v2, v91
    v_cmp_lt_u32 vcc, 16, v2
    s_mov_b64 exec, vcc
    s_cbranch_execz F_t3
F_tp3:
    buffer_load_dwordx4 v[52:55], v86, s[16:19], s26 offen offset:3072 sc1
    s_waitcnt vmcnt(0)
    v_cmp_ne_u32 vcc, s88, v55
    s_sub_u32 s27, s27, 1
    s_cselect_b64 vcc, 0, vcc
    s_cmp_eq_u64 vcc, 0
    s_cbranch_scc0 F_tp3
    v_bfe_u32 v71, v54, 11, 6
    v_lshl_add_u32 v71, v71, 2, s71
    v_cmp_lt_i32 vcc, 16, v59
    s_mov_b64 exec, vcc
    ds_add_rtn_u32 v83, v71, v3
F_t3:
    s_mov_b64 exec, -1
    v_mov_b32 v2, 163068
    v_mov_b32 v4, 1000
    v_cmp_lt_u32 vcc, 24, v89
    s_mov_b64 exec, vcc
    ds_write_b32 v2, v4
    s_mov_b64 exec, -1
    s_branch F_l3r
F_flag:
    s_lshl_b32 s66, s2, 2
    v_mov_b32 v2, 128
    v_mov_b32 v4, s88
    s_mov_b64 exec, 1
    buffer_store_dword v4, v2, s[16:19], s66 offen sc1
    s_mov_b64 exec, -1
    s_branch F_flagr
F_sa0:
    s_sub_u32 s27, s27, 1
    s_cbranch_scc1 F_sg0
    buffer_load_dwordx4 v[24:27], v86, s[16:19], s25 offen offset:0 sc1
    s_waitcnt vmcnt(0)
    s_branch F_sp0
F_sa1:
    s_sub_u32 s27, s27, 1
    s_cbranch_scc1 F_sg1
    buffer_load_dwordx4 v[28:31], v86, s[16:19], s25 offen offset:1024 sc1
    s_waitcnt vmcnt(0)
    s_branch F_sp1
F_sa2:
    s_sub_u32 s27, s27, 1
    s_cbranch_scc1 F_sg2
    buffer_load_dwordx4 v[32:35], v86, s[16:19], s25 offen offset:2048 sc1
    s_waitcnt vmcnt(0)
    s_branch F_sp2
F_sa3:
    s_sub_u32 s27, s27, 1
    s_cbranch_scc1 F_sg3
    buffer_load_dwordx4 v[36:39], v86, s[16:19], s25 offen offset:3072 sc1
    s_waitcnt vmcnt(0)
    s_branch F_sp3
F_u:
    ds_bpermute_b32 v68, v68, v92
    ds_bpermute_b32 v69, v69, v92
    ds_bpermute_b32 v70, v70, v92
    ds_bpermute_b32 v71, v71, v92
    s_waitcnt lgkmcnt(0)
    v_cmp_lt_i32 vcc, 16, v56
    s_mov_b64 exec, vcc
    s_cbranch_execz F_u0
    v_lshlrev_b32 v80, 3, v80
    v_and_b32 v42, 0x7ff, v42
    v_lshl_add_u32 v42, v42, 5, v90
    v_or_b32 v43, 16, v42
    v_and_b32 v68, 0x7fffffff, v68
    v_mad_u32_u16 v2, v68, 8, v80
    v_mad_u32_u16 v3, v68, 8, v80 op_sel:[1,0,0,0]
    ds_write_b64 v2, v[42:43]
    ds_write_b64 v3, v[40:41]
F_u0:
    s_mov_b64 exec, -1
    v_cmp_lt_i32 vcc, 16, v57
    s_mov_b64 exec, vcc
    s_cbranch_execz F_u1
    v_lshlrev_b32 v81, 3, v81
    v_and_b32 v46, 0x7ff, v46
    v_lshl_add_u32 v46, v46, 5, v90
    v_add_u32 v46, 327680, v46
    v_or_b32 v47, 16, v46
    v_and_b32 v69, 0x7fffffff, v69
    v_mad_u32_u16 v2, v69, 8, v81
    v_mad_u32_u16 v3, v69, 8, v81 op_sel:[1,0,0,0]
    ds_write_b64 v2, v[46:47]
    ds_write_b64 v3, v[44:45]
F_u1:
    s_mov_b64 exec, -1
    v_cmp_lt_i32 vcc, 16, v58
    s_mov_b64 exec, vcc
    s_cbranch_execz F_u2
    v_lshlrev_b32 v82, 3, v82
    v_and_b32 v50, 0x7ff, v50
    v_lshl_add_u32 v50, v50, 5, v90
    v_add_u32 v50, 655360, v50
    v_or_b32 v51, 16, v50
    v_and_b32 v70, 0x7fffffff, v70
    v_mad_u32_u16 v2, v70, 8, v82
    v_mad_u32_u16 v3, v70, 8, v82 op_sel:[1,0,0,0]
    ds_write_b64 v2, v[50:51]
    ds_write_b64 v3, v[48:49]
F_u2:
    s_mov_b64 exec, -1
    v_cmp_lt_i32 vcc, 16, v59
    s_mov_b64 exec, vcc
    s_cbranch_execz F_u3
    v_lshlrev_b32 v83, 3, v83
    v_and_b32 v54, 0x7ff, v54
    v_lshl_add_u32 v54, v54, 5, v90
    v_add_u32 v54, 983040, v54
    v_or_b32 v55, 16, v54
    v_and_b32 v71, 0x7fffffff, v71
    v_mad_u32_u16 v2, v71, 8, v83
    v_mad_u32_u16 v3, v71, 8, v83 op_sel:[1,0,0,0]
    ds_write_b64 v2, v[54:55]
    ds_write_b64 v3, v[52:53]
F_u3:
    s_mov_b64 exec, -1
    s_branch F_ur
LAST0:
    s_cmp_eq_u32 s50, 5
    s_cbranch_scc1 TO_PHASE1
    s_add_u32 s4, s4, 128
    s_addc_u32 s5, s5, 0
    s_add_u32 s8, s8, 128
    s_addc_u32 s9, s9, 0
    s_mov_b32 s34, 0
    s_mov_b32 s35, 256
    s_mov_b32 s36, 512
    s_mov_b32 s37, 768
    s_mov_b32 s33, 0
    s_add_u32 s53, s53, 4
    s_xor_b32 s66, s53, s20
    s_bitcmp1_b32 s66, 2
    s_setprio 1
    s_cbranch_scc1 PRIO_2
    s_setprio 0
PRIO_2:
    s_cmp_eq_u32 s52, 4
    s_cbranch_scc1 ITEM_0_4
    s_cmp_eq_u32 s52, 5
    s_cbranch_scc1 ITEM_0_5
    s_cmp_eq_u32 s52, 3
    s_cbranch_scc1 ITEM_0_3
    s_cmp_eq_u32 s52, 6
    s_cbranch_scc1 ITEM_0_6
    s_cmp_eq_u32 s52, 8
    s_cbranch_scc1 ITEM_0_8
    s_branch ITEM_0_2
TO_PHASE1:
    ds_read_b32 v252, v251 offset:16
    v_lshlrev_b32 v253, 2, v248
    v_add_u32 v253, 65536, v253
    ds_read_b128 v[96:99], v253 offset:0
    ds_read_b128 v[100:103], v253 offset:1024
    ds_read_b128 v[104:107], v253 offset:2048
    ds_read_b128 v[108:111], v253 offset:3072
    ds_read_b128 v[112:115], v253 offset:4096
    ds_read_b128 v[116:119], v253 offset:5120
    ds_read_b128 v[120:123], v253 offset:6144
    ds_read_b128 v[124:127], v253 offset:7168
    ds_read_b128 v[128:131], v253 offset:8192
    ds_read_b128 v[132:135], v253 offset:9216
    ds_read_b128 v[136:139], v253 offset:10240
    ds_read_b128 v[140:143], v253 offset:11264
    ds_read_b128 v[144:147], v253 offset:12288
    ds_read_b128 v[148:151], v253 offset:13312
    ds_read_b128 v[152:155], v253 offset:14336
    ds_read_b128 v[156:159], v253 offset:15360
    ds_read_b128 v[160:163], v253 offset:16384
    ds_read_b128 v[164:167], v253 offset:17408
    ds_read_b128 v[168:171], v253 offset:18432
    ds_read_b128 v[172:175], v253 offset:19456
    s_lshl_b32 s66, s20, 4
    v_xor_b32 v248, s66, v248
    s_mov_b32 s34, 128
    s_mov_b32 s35, 384
    s_mov_b32 s36, 640
    s_mov_b32 s37, 896
    s_mov_b32 s50, 0
    s_waitcnt lgkmcnt(0)
    s_waitcnt lgkmcnt(0)
    v_readfirstlane_b32 s66, v252
    s_add_u32 s53, s53, 1
    v_mov_b32 v252, s53
    s_cmp_le_u32 s53, s66
    ds_write2_b32 v251, v252, v252 offset0:0 offset1:8
    s_setprio 1
    s_cbranch_scc1 PRIO_3
    s_setprio 0
PRIO_3:
    s_cmp_eq_u32 s52, 4
    s_cbranch_scc1 ITEM_1_4
    s_cmp_eq_u32 s52, 5
    s_cbranch_scc1 ITEM_1_5
    s_cmp_eq_u32 s52, 3
    s_cbranch_scc1 ITEM_1_3
    s_cmp_eq_u32 s52, 6
    s_cbranch_scc1 ITEM_1_6
    s_cmp_eq_u32 s52, 8
    s_cbranch_scc1 ITEM_1_8
    s_branch ITEM_1_2
LAST1:
    s_cmp_eq_u32 s89, 0
    s_cbranch_scc1 T_flagsL
    s_mul_i32 s66, s20, 80
    v_min_u32 v2, 76, v248
    s_mov_b32 s67, 262144
T_pollL:
    buffer_load_dword v3, v2, s[16:19], s66 offen offset:128 sc1
    s_waitcnt vmcnt(0)
    v_cmp_ne_u32 vcc, s88, v3
    s_sub_u32 s67, s67, 1
    s_cselect_b64 vcc, 0, vcc
    s_cmp_eq_u64 vcc, 0
    s_cbranch_scc0 T_pollL
    s_mov_b32 s89, 0
T_flagsL:
    s_lshl_b32 s66, s20, 4
    v_xor_b32 v246, s66, v248
    v_lshlrev_b32 v246, 2, v246
    s_mul_i32 s51, s20, 20480
    s_add_u32 s51, s51, 1024
    s_load_dwordx2 s[72:73], s[0:1], 72
    s_waitcnt lgkmcnt(7)
    v_readfirstlane_b32 s66, v252
    s_add_u32 s53, s53, 1
    v_mov_b32 v252, s53
    s_cmp_le_u32 s53, s66
    ds_write2_b32 v251, v252, v252 offset0:0 offset1:8
    s_setprio 3
    s_cbranch_scc1 PRIO_4
    s_setprio 2
PRIO_4:
    s_cmp_eq_u32 s52, 4
    s_cbranch_scc1 ITEM_1_4
    s_cmp_eq_u32 s52, 5
    s_cbranch_scc1 ITEM_1_5
    s_cmp_eq_u32 s52, 3
    s_cbranch_scc1 ITEM_1_3
    s_cmp_eq_u32 s52, 6
    s_cbranch_scc1 ITEM_1_6
    s_cmp_eq_u32 s52, 8
    s_cbranch_scc1 ITEM_1_8
    s_branch ITEM_1_2
.p2align 6
ITEM_0_4:
    s_mov_b64 exec, s[54:55]
    ds_read_u16_d16_hi v243, v250 offset:128
    s_mov_b64 exec, -1
    ds_read_b64_tr_b16 v[72:73], v249 offset:512
    ds_read_b64_tr_b16 v[76:77], v249 offset:576
    ds_read_b64_tr_b16 v[74:75], v249 offset:768
    ds_read_b64_tr_b16 v[78:79], v249 offset:832
    s_waitcnt lgkmcnt(5)
    v_mul_f32_dpp v196, v242, v64 row_newbcast:0 row_mask:0xf bank_mask:0xf
    v_mul_f32_dpp v197, v242, v65 row_newbcast:1 row_mask:0xf bank_mask:0xf
    v_mul_f32_dpp v198, v242, v64 row_newbcast:8 row_mask:0xf bank_mask:0xf
    v_mul_f32_dpp v199, v242, v65 row_newbcast:9 row_mask:0xf bank_mask:0xf
    v_mul_f32_dpp v200, v242, v68 row_newbcast:2 row_mask:0xf bank_mask:0xf
    v_mul_f32_dpp v201, v242, v69 row_newbcast:3 row_mask:0xf bank_mask:0xf
    v_mul_f32_dpp v202, v242, v68 row_newbcast:10 row_mask:0xf bank_mask:0xf
    v_mul_f32_dpp v203, v242, v69 row_newbcast:11 row_mask:0xf bank_mask:0xf
    v_cvt_pk_bf16_f32 v64, v196, v197
    v_cvt_pk_bf16_f32 v68, v198, v199
    v_cvt_pk_bf16_f32 v65, v200, v201
    v_cvt_pk_bf16_f32 v69, v202, v203
    v_mul_f32_dpp v196, v242, v66 row_newbcast:4 row_mask:0xf bank_mask:0xf
    v_mul_f32_dpp v197, v242, v67 row_newbcast:5 row_mask:0xf bank_mask:0xf
    v_mul_f32_dpp v198, v242, v66 row_newbcast:12 row_mask:0xf bank_mask:0xf
    v_mul_f32_dpp v199, v242, v67 row_newbcast:13 row_mask:0xf bank_mask:0xf
    v_mul_f32_dpp v200, v242, v70 row_newbcast:6 row_mask:0xf bank_mask:0xf
    v_mul_f32_dpp v201, v242, v71 row_newbcast:7 row_mask:0xf bank_mask:0xf
    v_mul_f32_dpp v202, v242, v70 row_newbcast:14 row_mask:0xf bank_mask:0xf
    v_mul_f32_dpp v203, v242, v71 row_newbcast:15 row_mask:0xf bank_mask:0xf
    v_cvt_pk_bf16_f32 v66, v196, v197
    v_cvt_pk_bf16_f32 v70, v198, v199
    v_cvt_pk_bf16_f32 v67, v200, v201
    v_cvt_pk_bf16_f32 v71, v202, v203
    s_nop 0
    s_waitcnt vmcnt(4) lgkmcnt(0)
    v_mfma_f32_32x32x16_bf16 v[0:15], v[64:67], v[176:179], 0
    v_mul_f32_dpp v196, v243, v72 row_newbcast:0 row_mask:0xf bank_mask:0xf
    v_mul_f32_dpp v197, v243, v73 row_newbcast:1 row_mask:0xf bank_mask:0xf
    v_mul_f32_dpp v198, v243, v72 row_newbcast:8 row_mask:0xf bank_mask:0xf
    v_mul_f32_dpp v199, v243, v73 row_newbcast:9 row_mask:0xf bank_mask:0xf
    v_mul_f32_dpp v200, v243, v76 row_newbcast:2 row_mask:0xf bank_mask:0xf
    v_mul_f32_dpp v201, v243, v77 row_newbcast:3 row_mask:0xf bank_mask:0xf
    v_mul_f32_dpp v202, v243, v76 row_newbcast:10 row_mask:0xf bank_mask:0xf
    v_mul_f32_dpp v203, v243, v77 row_newbcast:11 row_mask:0xf bank_mask:0xf
    v_cvt_pk_bf16_f32 v72, v196, v197
    v_cvt_pk_bf16_f32 v76, v198, v199
    v_cvt_pk_bf16_f32 v73, v200, v201
    v_cvt_pk_bf16_f32 v77, v202, v203
    s_add_u32 m0, s21, 0
    v_mfma_f32_32x32x16_bf16 v[16:31], v[68:71], v[176:179], 0
    buffer_load_dwordx4 v234, s[4:7], s36 offen  lds
    buffer_load_dwordx4 v235, s[8:11], s36 offen offset:1024  lds
    ds_read_b64_tr_b16 v[176:177], v244 offset:2048
    ds_read_b64_tr_b16 v[178:179], v244 offset:3072
    ds_read_b64_tr_b16 v[184:185], v245 offset:2048
    ds_read_b64_tr_b16 v[186:187], v245 offset:3072
    v_mul_f32_dpp v196, v243, v74 row_newbcast:4 row_mask:0xf bank_mask:0xf
    v_mul_f32_dpp v197, v243, v75 row_newbcast:5 row_mask:0xf bank_mask:0xf
    v_mul_f32_dpp v198, v243, v74 row_newbcast:12 row_mask:0xf bank_mask:0xf
    v_mul_f32_dpp v199, v243, v75 row_newbcast:13 row_mask:0xf bank_mask:0xf
    v_mul_f32_dpp v200, v243, v78 row_newbcast:6 row_mask:0xf bank_mask:0xf
    v_mul_f32_dpp v201, v243, v79 row_newbcast:7 row_mask:0xf bank_mask:0xf
    v_mul_f32_dpp v202, v243, v78 row_newbcast:14 row_mask:0xf bank_mask:0xf
    v_mul_f32_dpp v203, v243, v79 row_newbcast:15 row_mask:0xf bank_mask:0xf
    v_cvt_pk_bf16_f32 v74, v196, v197
    v_cvt_pk_bf16_f32 v78, v198, v199
    v_cvt_pk_bf16_f32 v75, v200, v201
    v_cvt_pk_bf16_f32 v79, v202, v203
    s_nop 0
    s_waitcnt lgkmcnt(0)
    v_mfma_f32_32x32x16_bf16 v[0:15], v[72:75], v[176:179], v[0:15]
    s_add_u32 m0, s21, 2048
    v_mfma_f32_32x32x16_bf16 v[16:31], v[76:79], v[176:179], v[16:31]
    buffer_load_dwordx4 v236, s[4:7], s36 offen  lds
    buffer_load_dwordx4 v237, s[8:11], s36 offen offset:1024  lds
    s_mov_b32 m0, s50
    s_nop 0
    s_movrels_b32 s71, s23
    s_bfe_u32 s46, s71, 0x30012
    s_mov_b32 m0, s46
    s_and_b32 s66, s71, 0x3ffff
    s_movrels_b32 s68, s57
    s_movrels_b32 s69, s61
    s_sub_u32 s48, s66, s47
    s_mov_b32 s47, s66
    s_lshr_b32 s52, s71, 28
    s_lshl_b32 s67, s46, 9
    s_add_u32 s66, s66, s67
    s_sub_u32 s49, s66, s42
    s_mov_b32 s42, s66
    s_bfe_u32 s66, s68, 655360
    s_add_u32 s43, s42, s66
    s_bfe_u32 s39, s69, 655360
    s_bfe_u32 s66, s68, 655370
    s_add_u32 s44, s42, s66
    s_bfe_u32 s40, s69, 655370
    s_bfe_u32 s66, s68, 655380
    s_add_u32 s45, s42, s66
    s_bfe_u32 s41, s69, 655380
    s_and_b32 s66, s46, s33
    s_cselect_b32 s72, -1, 1
    s_cselect_b32 s76, s47, 163712
    s_cmp_ge_u32 s66, 2
    s_cselect_b32 s73, -1, 0
    s_add_u32 s77, s47, 1024
    s_cmp_ge_u32 s66, 4
    s_cselect_b32 s75, -1, 0
    s_cmp_ge_u32 s66, 3
    s_cselect_b32 s74, -1, 1
    s_cselect_b32 s77, s77, 163712
    v_add_u32 v252, s44, v247
    ds_read_u16 v238, v252
    ds_read_u16 v239, v252 offset:64
    v_add_u32 v252, s45, v247
    ds_read_u16 v240, v252
    ds_read_u16 v241, v252 offset:64
    v_mfma_f32_32x32x16_bf16 v[32:47], v[64:67], v[180:183], 0
    v_mul_f32 v196, v0, v96
    v_fmac_f32 v196, v1, v97
    v_fmac_f32 v196, v2, v98
    v_fmac_f32 v196, v3, v99
    v_fmac_f32 v196, v4, v100
    v_fmac_f32 v196, v5, v101
    v_fmac_f32 v196, v6, v102
    v_fmac_f32 v196, v7, v103
    v_mul_f32 v198, v8, v128
    v_fmac_f32 v198, v9, v129
    v_mfma_f32_32x32x16_bf16 v[48:63], v[68:71], v[180:183], 0
    s_waitcnt vmcnt(6)
    ds_read_b64_tr_b16 v[176:177], v244 offset:4096
    ds_read_b64_tr_b16 v[178:179], v244 offset:5120
    ds_read_b64_tr_b16 v[180:181], v245 offset:4096
    ds_read_b64_tr_b16 v[182:183], v245 offset:5120
    v_fmac_f32 v198, v10, v130
    v_fmac_f32 v198, v11, v131
    v_fmac_f32 v198, v12, v132
    v_fmac_f32 v198, v13, v133
    v_fmac_f32 v198, v14, v134
    v_fmac_f32 v198, v15, v135
    v_mul_f32 v200, v16, v128
    v_fmac_f32 v200, v17, v129
    v_permlane32_swap_b32 v196, v198
    v_mfma_f32_32x32x16_bf16 v[32:47], v[72:75], v[184:187], v[32:47]
    v_fmac_f32 v200, v18, v130
    v_fmac_f32 v200, v19, v131
    v_fmac_f32 v200, v20, v132
    v_fmac_f32 v200, v21, v133
    v_fmac_f32 v200, v22, v134
    v_fmac_f32 v200, v23, v135
    v_add_f32 v198, v196, v198
    v_mul_f32_e64 v202, v24, -v128
    v_fma_f32 v202, v25, -v129, v202
    v_mfma_f32_32x32x16_bf16 v[48:63], v[76:79], v[184:187], v[48:63]
    v_fma_f32 v202, v26, -v130, v202
    v_fma_f32 v202, v27, -v131, v202
    v_fma_f32 v202, v28, -v132, v202
    v_fma_f32 v202, v29, -v133, v202
    v_fma_f32 v202, v30, -v134, v202
    v_fma_f32 v202, v31, -v135, v202
    s_nop 1
    v_permlane32_swap_b32 v200, v202
    v_add_f32 v202, v200, v202
    s_waitcnt vmcnt(4) lgkmcnt(0)
    v_mfma_f32_32x32x16_bf16 v[0:15], v[64:67], v[176:179], 0
    v_mul_f32 v197, v32, v104
    v_fmac_f32 v197, v33, v105
    v_fmac_f32 v197, v34, v106
    v_fmac_f32 v197, v35, v107
    v_fmac_f32 v197, v36, v108
    v_fmac_f32 v197, v37, v109
    v_fmac_f32 v197, v38, v110
    v_fmac_f32 v197, v39, v111
    v_mul_f32 v199, v40, v136
    v_fmac_f32 v199, v41, v137
    v_fmac_f32 v199, v42, v138
    s_add_u32 m0, s21, 4096
    v_mfma_f32_32x32x16_bf16 v[16:31], v[68:71], v[176:179], 0
    buffer_load_dwordx4 v234, s[4:7], s37 offen  lds
    buffer_load_dwordx4 v235, s[8:11], s37 offen offset:1024  lds
    ds_read_b64_tr_b16 v[176:177], v244 offset:6144
    ds_read_b64_tr_b16 v[178:179], v244 offset:7168
    ds_read_b64_tr_b16 v[184:185], v245 offset:6144
    ds_read_b64_tr_b16 v[186:187], v245 offset:7168
    v_add_u32 v252, s42, v247
    ds_read_u16 v234, v252
    ds_read_u16 v235, v252 offset:64
    v_fmac_f32 v199, v43, v139
    v_fmac_f32 v199, v44, v140
    v_fmac_f32 v199, v45, v141
    v_fmac_f32 v199, v46, v142
    v_fmac_f32 v199, v47, v143
    v_mul_f32 v201, v48, v136
    v_fmac_f32 v201, v49, v137
    v_permlane32_swap_b32 v197, v199
    v_fmac_f32 v201, v50, v138
    v_fmac_f32 v201, v51, v139
    s_waitcnt lgkmcnt(2)
    v_mfma_f32_32x32x16_bf16 v[0:15], v[72:75], v[176:179], v[0:15]
    v_fmac_f32 v201, v52, v140
    v_fmac_f32 v201, v53, v141
    v_fmac_f32 v201, v54, v142
    v_fmac_f32 v201, v55, v143
    v_add_f32 v199, v197, v199
    v_mul_f32_e64 v203, v56, -v136
    v_fma_f32 v203, v57, -v137, v203
    v_fma_f32 v203, v58, -v138, v203
    v_fma_f32 v203, v59, -v139, v203
    v_fma_f32 v203, v60, -v140, v203
    v_fma_f32 v203, v61, -v141, v203
    s_add_u32 m0, s21, 6144
    v_mfma_f32_32x32x16_bf16 v[16:31], v[76:79], v[176:179], v[16:31]
    buffer_load_dwordx4 v236, s[4:7], s37 offen  lds
    buffer_load_dwordx4 v237, s[8:11], s37 offen offset:1024  lds
    v_add_u32 v252, s43, v247
    ds_read_u16 v236, v252
    ds_read_u16 v237, v252 offset:64
    v_fma_f32 v203, v62, -v142, v203
    v_fma_f32 v203, v63, -v143, v203
    s_nop 1
    v_permlane32_swap_b32 v201, v203
    v_add_f32 v203, v201, v203
    s_set_gpr_idx_on s51, gpr_idx(DST)
    s_nop 0
    v_cvt_pk_bf16_f32 v204, v198, v199
    v_cvt_pk_bf16_f32 v205, v202, v203
    s_set_gpr_idx_off
    v_mfma_f32_32x32x16_bf16 v[32:47], v[64:67], v[180:183], 0
    v_mul_f32 v196, v0, v144
    v_fmac_f32 v196, v1, v145
    v_fmac_f32 v196, v2, v146
    v_fmac_f32 v196, v3, v147
    v_fmac_f32 v196, v4, v148
    v_fmac_f32 v196, v5, v149
    v_fmac_f32 v196, v6, v150
    v_fmac_f32 v196, v7, v151
    v_mfma_f32_32x32x16_bf16 v[48:63], v[68:71], v[180:183], 0
    v_add_u32 v253, s47, v248
    ds_read_b32 v254, v253
    ds_read_b32 v255, v253 offset:256
    s_waitcnt vmcnt(6)
    ds_read_b64_tr_b16 v[176:177], v244 offset:0
    ds_read_b64_tr_b16 v[178:179], v244 offset:1024
    ds_read_b64_tr_b16 v[180:181], v245 offset:0
    ds_read_b64_tr_b16 v[182:183], v245 offset:1024
    v_mul_f32 v198, v8, v112
    v_fmac_f32 v198, v9, v113
    v_fmac_f32 v198, v10, v114
    v_fmac_f32 v198, v11, v115
    v_fmac_f32 v198, v12, v116
    v_fmac_f32 v198, v13, v117
    v_fmac_f32 v198, v14, v118
    v_fmac_f32 v198, v15, v119
    v_mfma_f32_32x32x16_bf16 v[32:47], v[72:75], v[184:187], v[32:47]
    v_mul_f32_e64 v200, v16, -v160
    v_fma_f32 v200, v17, -v161, v200
    v_fma_f32 v200, v18, -v162, v200
    v_fma_f32 v200, v19, -v163, v200
    v_fma_f32 v200, v20, -v164, v200
    v_fma_f32 v200, v21, -v165, v200
    v_fma_f32 v200, v22, -v166, v200
    v_fma_f32 v200, v23, -v167, v200
    v_mfma_f32_32x32x16_bf16 v[48:63], v[76:79], v[184:187], v[48:63]
    v_mul_f32_e64 v202, v24, -v160
    v_fma_f32 v202, v25, -v161, v202
    v_fma_f32 v202, v26, -v162, v202
    v_fma_f32 v202, v27, -v163, v202
    v_fma_f32 v202, v28, -v164, v202
    v_fma_f32 v202, v29, -v165, v202
    v_fma_f32 v202, v30, -v166, v202
    v_fma_f32 v202, v31, -v167, v202
    s_waitcnt vmcnt(4) lgkmcnt(0)
    v_mfma_f32_32x32x16_bf16 v[0:15], v[64:67], v[176:179], 0
    v_mul_f32 v197, v32, v152
    v_fmac_f32 v197, v33, v153
    v_fmac_f32 v197, v34, v154
    v_fmac_f32 v197, v35, v155
    v_fmac_f32 v197, v36, v156
    v_fmac_f32 v197, v37, v157
    v_fmac_f32 v197, v38, v158
    v_fmac_f32 v197, v39, v159
    s_add_u32 m0, s21, 0
    v_mfma_f32_32x32x16_bf16 v[16:31], v[68:71], v[176:179], 0
    v_lshl_add_u32 v234, v234, 10, v246
    v_lshl_add_u32 v235, v235, 10, v246
    buffer_load_dwordx4 v234, s[4:7], s38 offen  lds
    buffer_load_dwordx4 v235, s[8:11], s38 offen offset:1024  lds
    ds_read_b64_tr_b16 v[176:177], v244 offset:2048
    ds_read_b64_tr_b16 v[178:179], v244 offset:3072
    ds_read_b64_tr_b16 v[184:185], v245 offset:2048
    ds_read_b64_tr_b16 v[186:187], v245 offset:3072
    v_mul_f32 v199, v40, v120
    v_fmac_f32 v199, v41, v121
    v_fmac_f32 v199, v42, v122
    v_fmac_f32 v199, v43, v123
    v_fmac_f32 v199, v44, v124
    v_fmac_f32 v199, v45, v125
    v_fmac_f32 v199, v46, v126
    v_fmac_f32 v199, v47, v127
    s_waitcnt lgkmcnt(0)
    v_mfma_f32_32x32x16_bf16 v[0:15], v[72:75], v[176:179], v[0:15]
    v_mul_f32_e64 v201, v48, -v168
    v_fma_f32 v201, v49, -v169, v201
    v_fma_f32 v201, v50, -v170, v201
    v_fma_f32 v201, v51, -v171, v201
    v_fma_f32 v201, v52, -v172, v201
    v_fma_f32 v201, v53, -v173, v201
    v_fma_f32 v201, v54, -v174, v201
    v_fma_f32 v201, v55, -v175, v201
    s_add_u32 m0, s21, 2048
    v_mfma_f32_32x32x16_bf16 v[16:31], v[76:79], v[176:179], v[16:31]
    v_lshl_add_u32 v236, v236, 10, v246
    v_lshl_add_u32 v237, v237, 10, v246
    buffer_load_dwordx4 v236, s[4:7], s39 offen  lds
    buffer_load_dwordx4 v237, s[8:11], s39 offen offset:1024  lds
    s_mov_b32 m0, s76
    s_mov_b64 exec, s[72:73]
    buffer_load_dwordx4 v254, s[12:15], 0 offen  lds
    s_mov_b32 m0, s77
    s_mov_b64 exec, s[74:75]
    buffer_load_dwordx4 v255, s[12:15], 0 offen  lds
    s_mov_b64 exec, -1
    v_mul_f32_e64 v203, v56, -v168
    v_fma_f32 v203, v57, -v169, v203
    v_fma_f32 v203, v58, -v170, v203
    v_fma_f32 v203, v59, -v171, v203
    v_fma_f32 v203, v60, -v172, v203
    v_fma_f32 v203, v61, -v173, v203
    v_fma_f32 v203, v62, -v174, v203
    v_fma_f32 v203, v63, -v175, v203
    v_mfma_f32_32x32x16_bf16 v[32:47], v[64:67], v[180:183], 0
    v_mul_f32 v254, v0, v144
    v_fmac_f32 v254, v1, v145
    v_fmac_f32 v254, v2, v146
    v_fmac_f32 v254, v3, v147
    v_fmac_f32 v254, v4, v148
    v_mfma_f32_32x32x16_bf16 v[48:63], v[68:71], v[180:183], 0
    ds_swizzle_b32 v68, v68 offset:0x401F
    ds_swizzle_b32 v69, v69 offset:0x401F
    ds_swizzle_b32 v70, v70 offset:0x401F
    ds_swizzle_b32 v71, v71 offset:0x401F
    s_waitcnt vmcnt(8)
    ds_read_b64_tr_b16 v[176:177], v244 offset:4096
    ds_read_b64_tr_b16 v[178:179], v244 offset:5120
    ds_read_b64_tr_b16 v[180:181], v245 offset:4096
    ds_read_b64_tr_b16 v[182:183], v245 offset:5120
    v_fmac_f32 v254, v5, v149
    v_fmac_f32 v254, v6, v150
    v_fmac_f32 v254, v7, v151
    v_fmac_f32 v200, v8, v160
    v_mfma_f32_32x32x16_bf16 v[32:47], v[72:75], v[184:187], v[32:47]
    v_fmac_f32 v200, v9, v161
    v_permlane32_swap_b32 v196, v254
    v_fmac_f32 v200, v10, v162
    v_fmac_f32 v200, v11, v163
    v_fmac_f32 v200, v12, v164
    v_mfma_f32_32x32x16_bf16 v[48:63], v[76:79], v[184:187], v[48:63]
    ds_swizzle_b32 v76, v76 offset:0x401F
    ds_swizzle_b32 v77, v77 offset:0x401F
    ds_swizzle_b32 v78, v78 offset:0x401F
    ds_swizzle_b32 v79, v79 offset:0x401F
    v_fmac_f32 v200, v13, v165
    v_fmac_f32 v200, v14, v166
    v_fmac_f32 v200, v15, v167
    v_add_f32 v254, v196, v254
    s_waitcnt lgkmcnt(8)
    s_mov_b64 exec, s[56:57]
    v_xor_b32 v68, 0x80008000, v68
    v_xor_b32 v69, 0x80008000, v69
    v_xor_b32 v70, 0x80008000, v70
    v_xor_b32 v71, 0x80008000, v71
    s_mov_b64 exec, -1
    s_waitcnt vmcnt(6) lgkmcnt(4)
    v_mfma_f32_32x32x16_bf16 v[0:15], v[64:67], v[176:179], 0
    v_mul_f32 v255, v32, v152
    v_fmac_f32 v255, v33, v153
    v_fmac_f32 v255, v34, v154
    v_fmac_f32 v255, v35, v155
    v_fmac_f32 v255, v36, v156
    v_fmac_f32 v255, v37, v157
    s_add_u32 m0, s21, 4096
    v_mfma_f32_32x32x16_bf16 v[16:31], v[68:71], v[176:179], v[16:31]
    v_lshl_add_u32 v238, v238, 10, v246
    v_lshl_add_u32 v239, v239, 10, v246
    buffer_load_dwordx4 v238, s[4:7], s40 offen  lds
    buffer_load_dwordx4 v239, s[8:11], s40 offen offset:1024  lds
    ds_read_b64_tr_b16 v[176:177], v244 offset:6144
    ds_read_b64_tr_b16 v[178:179], v244 offset:7168
    ds_read_b64_tr_b16 v[184:185], v245 offset:6144
    ds_read_b64_tr_b16 v[186:187], v245 offset:7168
    v_fmac_f32 v255, v38, v158
    v_fmac_f32 v255, v39, v159
    v_fmac_f32 v201, v40, v168
    v_fmac_f32 v201, v41, v169
    v_permlane32_swap_b32 v197, v255
    s_waitcnt lgkmcnt(0)
    s_mov_b64 exec, s[56:57]
    v_xor_b32 v76, 0x80008000, v76
    v_xor_b32 v77, 0x80008000, v77
    v_xor_b32 v78, 0x80008000, v78
    v_xor_b32 v79, 0x80008000, v79
    s_mov_b64 exec, -1
    v_mfma_f32_32x32x16_bf16 v[0:15], v[72:75], v[176:179], v[0:15]
    v_fmac_f32 v201, v42, v170
    v_fmac_f32 v201, v43, v171
    v_fmac_f32 v201, v44, v172
    v_fmac_f32 v201, v45, v173
    v_fmac_f32 v201, v46, v174
    v_fmac_f32 v201, v47, v175
    s_add_u32 m0, s21, 6144
    v_mfma_f32_32x32x16_bf16 v[16:31], v[76:79], v[176:179], v[16:31]
    v_lshl_add_u32 v240, v240, 10, v246
    v_lshl_add_u32 v241, v241, 10, v246
    buffer_load_dwordx4 v240, s[4:7], s41 offen  lds
    buffer_load_dwordx4 v241, s[8:11], s41 offen offset:1024  lds
    v_add_f32 v255, v197, v255
    s_set_gpr_idx_on s51, gpr_idx(DST)
    s_nop 0
    v_cvt_pk_bf16_f32 v206, v254, v255
    s_set_gpr_idx_off
    v_mfma_f32_32x32x16_bf16 v[32:47], v[64:67], v[180:183], 0
    v_mul_f32 v254, v0, v144
    v_fmac_f32 v254, v1, v145
    v_fmac_f32 v254, v2, v146
    v_fmac_f32 v254, v3, v147
    v_fmac_f32 v254, v4, v148
    v_fmac_f32 v254, v5, v149
    v_fmac_f32 v254, v6, v150
    v_fmac_f32 v254, v7, v151
    v_fma_f32 v202, v8, -v160, v202
    v_fma_f32 v202, v9, -v161, v202
    v_mfma_f32_32x32x16_bf16 v[48:63], v[68:71], v[180:183], v[48:63]
    s_waitcnt vmcnt(8)
    ds_read_b64_tr_b16 v[176:177], v244 offset:0
    ds_read_b64_tr_b16 v[178:179], v244 offset:1024
    ds_read_b64_tr_b16 v[180:181], v245 offset:0
    ds_read_b64_tr_b16 v[182:183], v245 offset:1024
    v_permlane32_swap_b32 v254, v200
    v_fma_f32 v202, v10, -v162, v202
    v_fma_f32 v202, v11, -v163, v202
    v_fma_f32 v202, v12, -v164, v202
    v_fma_f32 v202, v13, -v165, v202
    v_fma_f32 v202, v14, -v166, v202
    v_fma_f32 v202, v15, -v167, v202
    v_add_f32 v200, v254, v200
    v_fmac_f32 v198, v16, v112
    v_permlane32_swap_b32 v202, v254
    v_mfma_f32_32x32x16_bf16 v[32:47], v[72:75], v[184:187], v[32:47]
    v_fmac_f32 v198, v17, v113
    v_fmac_f32 v198, v18, v114
    v_fmac_f32 v198, v19, v115
    v_fmac_f32 v198, v20, v116
    v_fmac_f32 v198, v21, v117
    v_fmac_f32 v198, v22, v118
    v_fmac_f32 v198, v23, v119
    v_add_f32 v254, v202, v254
    v_mul_f32 v196, v24, v160
    v_fmac_f32 v196, v25, v161
    v_mfma_f32_32x32x16_bf16 v[48:63], v[76:79], v[184:187], v[48:63]
    v_add_u32 v249, s48, v249
    v_add_u32 v250, s49, v250
    s_waitcnt vmcnt(4)
    ds_read_b64_tr_b16 v[64:65], v249 offset:0
    ds_read_b64_tr_b16 v[68:69], v249 offset:64
    ds_read_b64_tr_b16 v[66:67], v249 offset:256
    ds_read_b64_tr_b16 v[70:71], v249 offset:320
    s_mov_b64 exec, s[54:55]
    ds_read_u16_d16_hi v242, v250 offset:0
    s_mov_b64 exec, -1
    v_fmac_f32 v196, v26, v162
    v_fmac_f32 v196, v27, v163
    v_fmac_f32 v196, v28, v164
    v_fmac_f32 v196, v29, v165
    v_fmac_f32 v196, v30, v166
    v_fmac_f32 v196, v31, v167
    s_nop 1
    v_permlane32_swap_b32 v198, v196
    v_add_f32 v196, v198, v196
    v_mul_f32 v255, v32, v152
    v_fmac_f32 v255, v33, v153
    v_fmac_f32 v255, v34, v154
    v_fmac_f32 v255, v35, v155
    v_fmac_f32 v255, v36, v156
    v_fmac_f32 v255, v37, v157
    v_fmac_f32 v255, v38, v158
    v_fmac_f32 v255, v39, v159
    v_fma_f32 v203, v40, -v168, v203
    v_fma_f32 v203, v41, -v169, v203
    v_permlane32_swap_b32 v255, v201
    v_fma_f32 v203, v42, -v170, v203
    v_fma_f32 v203, v43, -v171, v203
    v_fma_f32 v203, v44, -v172, v203
    v_fma_f32 v203, v45, -v173, v203
    v_fma_f32 v203, v46, -v174, v203
    v_fma_f32 v203, v47, -v175, v203
    v_add_f32 v201, v255, v201
    v_fmac_f32 v199, v48, v120
    v_permlane32_swap_b32 v203, v255
    v_fmac_f32 v199, v49, v121
    v_fmac_f32 v199, v50, v122
    v_fmac_f32 v199, v51, v123
    v_fmac_f32 v199, v52, v124
    v_fmac_f32 v199, v53, v125
    v_fmac_f32 v199, v54, v126
    v_fmac_f32 v199, v55, v127
    v_add_f32 v255, v203, v255
    v_mul_f32 v197, v56, v168
    v_fmac_f32 v197, v57, v169
    v_fmac_f32 v197, v58, v170
    v_fmac_f32 v197, v59, v171
    v_fmac_f32 v197, v60, v172
    v_fmac_f32 v197, v61, v173
    v_fmac_f32 v197, v62, v174
    v_fmac_f32 v197, v63, v175
    s_nop 1
    v_permlane32_swap_b32 v199, v197
    v_add_f32 v197, v199, v197
    s_set_gpr_idx_on s51, gpr_idx(DST)
    s_nop 0
    v_cvt_pk_bf16_f32 v207, v200, v201
    v_cvt_pk_bf16_f32 v209, v254, v255
    v_cvt_pk_bf16_f32 v208, v196, v197
    s_set_gpr_idx_off
    s_add_u32 s50, s50, 1
    s_add_u32 s51, s51, 6
    s_cmp_ge_u32 s50, 4
    s_cbranch_scc1 LAST0
    s_add_u32 s53, s53, 4
    s_xor_b32 s66, s53, s20
    s_bitcmp1_b32 s66, 2
    s_setprio 1
    s_cbranch_scc1 PRIO_5
    s_setprio 0
PRIO_5:
    s_cmp_eq_u32 s52, 4
    s_cbranch_scc1 ITEM_0_4
    s_cmp_eq_u32 s52, 5
    s_cbranch_scc1 ITEM_0_5
    s_cmp_eq_u32 s52, 3
    s_cbranch_scc1 ITEM_0_3
    s_cmp_eq_u32 s52, 6
    s_cbranch_scc1 ITEM_0_6
    s_cmp_eq_u32 s52, 8
    s_cbranch_scc1 ITEM_0_8
    s_branch ITEM_0_2
.p2align 6
ITEM_0_5:
    s_mov_b64 exec, s[54:55]
    ds_read_u16_d16_hi v243, v250 offset:128
    s_mov_b64 exec, -1
    ds_read_b64_tr_b16 v[72:73], v249 offset:512
    ds_read_b64_tr_b16 v[76:77], v249 offset:576
    ds_read_b64_tr_b16 v[74:75], v249 offset:768
    ds_read_b64_tr_b16 v[78:79], v249 offset:832
    ds_read_b64_tr_b16 v[80:81], v249 offset:1024
    ds_read_b64_tr_b16 v[84:85], v249 offset:1088
    s_waitcnt lgkmcnt(7)
    v_mul_f32_dpp v196, v242, v64 row_newbcast:0 row_mask:0xf bank_mask:0xf
    v_mul_f32_dpp v197, v242, v65 row_newbcast:1 row_mask:0xf bank_mask:0xf
    v_mul_f32_dpp v198, v242, v64 row_newbcast:8 row_mask:0xf bank_mask:0xf
    v_mul_f32_dpp v199, v242, v65 row_newbcast:9 row_mask:0xf bank_mask:0xf
    v_mul_f32_dpp v200, v242, v68 row_newbcast:2 row_mask:0xf bank_mask:0xf
    v_mul_f32_dpp v201, v242, v69 row_newbcast:3 row_mask:0xf bank_mask:0xf
    v_mul_f32_dpp v202, v242, v68 row_newbcast:10 row_mask:0xf bank_mask:0xf
    v_mul_f32_dpp v203, v242, v69 row_newbcast:11 row_mask:0xf bank_mask:0xf
    v_cvt_pk_bf16_f32 v64, v196, v197
    v_cvt_pk_bf16_f32 v68, v198, v199
    v_cvt_pk_bf16_f32 v65, v200, v201
    v_cvt_pk_bf16_f32 v69, v202, v203
    v_mul_f32_dpp v196, v242, v66 row_newbcast:4 row_mask:0xf bank_mask:0xf
    v_mul_f32_dpp v197, v242, v67 row_newbcast:5 row_mask:0xf bank_mask:0xf
    v_mul_f32_dpp v198, v242, v66 row_newbcast:12 row_mask:0xf bank_mask:0xf
    v_mul_f32_dpp v199, v242, v67 row_newbcast:13 row_mask:0xf bank_mask:0xf
    v_mul_f32_dpp v200, v242, v70 row_newbcast:6 row_mask:0xf bank_mask:0xf
    v_mul_f32_dpp v201, v242, v71 row_newbcast:7 row_mask:0xf bank_mask:0xf
    v_mul_f32_dpp v202, v242, v70 row_newbcast:14 row_mask:0xf bank_mask:0xf
    v_mul_f32_dpp v203, v242, v71 row_newbcast:15 row_mask:0xf bank_mask:0xf
    v_cvt_pk_bf16_f32 v66, v196, v197
    v_cvt_pk_bf16_f32 v70, v198, v199
    v_cvt_pk_bf16_f32 v67, v200, v201
    v_cvt_pk_bf16_f32 v71, v202, v203
    s_mov_b64 exec, s[54:55]
    ds_read_u16_d16_hi v242, v250 offset:256
    s_mov_b64 exec, -1
    s_waitcnt vmcnt(4) lgkmcnt(3)
    v_mfma_f32_32x32x16_bf16 v[0:15], v[64:67], v[176:179], 0
    v_mul_f32_dpp v196, v243, v72 row_newbcast:0 row_mask:0xf bank_mask:0xf
    v_mul_f32_dpp v197, v243, v73 row_newbcast:1 row_mask:0xf bank_mask:0xf
    v_mul_f32_dpp v198, v243, v72 row_newbcast:8 row_mask:0xf bank_mask:0xf
    v_mul_f32_dpp v199, v243, v73 row_newbcast:9 row_mask:0xf bank_mask:0xf
    v_mul_f32_dpp v200, v243, v76 row_newbcast:2 row_mask:0xf bank_mask:0xf
    v_mul_f32_dpp v201, v243, v77 row_newbcast:3 row_mask:0xf bank_mask:0xf
    v_mul_f32_dpp v202, v243, v76 row_newbcast:10 row_mask:0xf bank_mask:0xf
    v_mul_f32_dpp v203, v243, v77 row_newbcast:11 row_mask:0xf bank_mask:0xf
    v_cvt_pk_bf16_f32 v72, v196, v197
    v_cvt_pk_bf16_f32 v76, v198, v199
    v_cvt_pk_bf16_f32 v73, v200, v201
    v_cvt_pk_bf16_f32 v77, v202, v203
    s_add_u32 m0, s21, 0
    v_mfma_f32_32x32x16_bf16 v[16:31], v[68:71], v[176:179], 0
    buffer_load_dwordx4 v236, s[4:7], s35 offen  lds
    buffer_load_dwordx4 v237, s[8:11], s35 offen offset:1024  lds
    ds_read_b64_tr_b16 v[176:177], v244 offset:2048
    ds_read_b64_tr_b16 v[178:179], v244 offset:3072
    ds_read_b64_tr_b16 v[184:185], v245 offset:2048
    ds_read_b64_tr_b16 v[186:187], v245 offset:3072
    v_mul_f32_dpp v196, v243, v74 row_newbcast:4 row_mask:0xf bank_mask:0xf
    v_mul_f32_dpp v197, v243, v75 row_newbcast:5 row_mask:0xf bank_mask:0xf
    v_mul_f32_dpp v198, v243, v74 row_newbcast:12 row_mask:0xf bank_mask:0xf
    v_mul_f32_dpp v199, v243, v75 row_newbcast:13 row_mask:0xf bank_mask:0xf
    v_mul_f32_dpp v200, v243, v78 row_newbcast:6 row_mask:0xf bank_mask:0xf
    v_mul_f32_dpp v201, v243, v79 row_newbcast:7 row_mask:0xf bank_mask:0xf
    v_mul_f32_dpp v202, v243, v78 row_newbcast:14 row_mask:0xf bank_mask:0xf
    v_mul_f32_dpp v203, v243, v79 row_newbcast:15 row_mask:0xf bank_mask:0xf
    v_cvt_pk_bf16_f32 v74, v196, v197
    v_cvt_pk_bf16_f32 v78, v198, v199
    v_cvt_pk_bf16_f32 v75, v200, v201
    v_cvt_pk_bf16_f32 v79, v202, v203
    s_nop 0
    s_waitcnt vmcnt(4) lgkmcnt(0)
    v_mfma_f32_32x32x16_bf16 v[0:15], v[72:75], v[176:179], v[0:15]
    v_mul_f32_dpp v196, v242, v80 row_newbcast:0 row_mask:0xf bank_mask:0xf
    v_mul_f32_dpp v197, v242, v81 row_newbcast:1 row_mask:0xf bank_mask:0xf
    v_mul_f32_dpp v198, v242, v80 row_newbcast:8 row_mask:0xf bank_mask:0xf
    v_mul_f32_dpp v199, v242, v81 row_newbcast:9 row_mask:0xf bank_mask:0xf
    v_mul_f32_dpp v200, v242, v84 row_newbcast:2 row_mask:0xf bank_mask:0xf
    v_mul_f32_dpp v201, v242, v85 row_newbcast:3 row_mask:0xf bank_mask:0xf
    s_add_u32 m0, s21, 2048
    v_mfma_f32_32x32x16_bf16 v[16:31], v[76:79], v[176:179], v[16:31]
    buffer_load_dwordx4 v238, s[4:7], s35 offen  lds
    ds_read_b64_tr_b16 v[176:177], v244 offset:4096
    ds_read_b64_tr_b16 v[188:189], v245 offset:4096
    v_mul_f32_dpp v202, v242, v84 row_newbcast:10 row_mask:0xf bank_mask:0xf
    v_mul_f32_dpp v203, v242, v85 row_newbcast:11 row_mask:0xf bank_mask:0xf
    v_cvt_pk_bf16_f32 v80, v196, v197
    v_cvt_pk_bf16_f32 v84, v198, v199
    v_cvt_pk_bf16_f32 v81, v200, v201
    v_cvt_pk_bf16_f32 v85, v202, v203
    s_nop 0
    s_waitcnt lgkmcnt(0)
    v_mfma_f32_32x32x8_bf16 v[0:15], v[80:81], v[176:177], v[0:15]
    s_add_u32 m0, s21, 4096
    v_mfma_f32_32x32x8_bf16 v[16:31], v[84:85], v[176:177], v[16:31]
    buffer_load_dwordx4 v234, s[4:7], s36 offen  lds
    buffer_load_dwordx4 v235, s[8:11], s36 offen offset:1024  lds
    s_mov_b32 m0, s50
    s_nop 0
    s_movrels_b32 s71, s23
    s_bfe_u32 s46, s71, 0x30012
    s_mov_b32 m0, s46
    s_and_b32 s66, s71, 0x3ffff
    s_movrels_b32 s68, s57
    s_movrels_b32 s69, s61
    s_sub_u32 s48, s66, s47
    s_mov_b32 s47, s66
    s_lshr_b32 s52, s71, 28
    s_lshl_b32 s67, s46, 9
    s_add_u32 s66, s66, s67
    s_sub_u32 s49, s66, s42
    s_mov_b32 s42, s66
    s_bfe_u32 s66, s68, 655360
    s_add_u32 s43, s42, s66
    s_bfe_u32 s39, s69, 655360
    s_bfe_u32 s66, s68, 655370
    s_add_u32 s44, s42, s66
    s_bfe_u32 s40, s69, 655370
    s_bfe_u32 s66, s68, 655380
    s_add_u32 s45, s42, s66
    s_bfe_u32 s41, s69, 655380
    s_and_b32 s66, s46, s33
    s_cselect_b32 s72, -1, 1
    s_cselect_b32 s76, s47, 163712
    s_cmp_ge_u32 s66, 2
    s_cselect_b32 s73, -1, 0
    s_add_u32 s77, s47, 1024
    s_cmp_ge_u32 s66, 4
    s_cselect_b32 s75, -1, 0
    s_cmp_ge_u32 s66, 3
    s_cselect_b32 s74, -1, 1
    s_cselect_b32 s77, s77, 163712
    v_add_u32 v252, s45, v247
    ds_read_u16 v240, v252
    ds_read_u16 v241, v252 offset:64
    v_mfma_f32_32x32x16_bf16 v[32:47], v[64:67], v[180:183], 0
    v_mul_f32 v196, v0, v96
    v_fmac_f32 v196, v1, v97
    v_fmac_f32 v196, v2, v98
    v_fmac_f32 v196, v3, v99
    v_fmac_f32 v196, v4, v100
    v_fmac_f32 v196, v5, v101
    v_fmac_f32 v196, v6, v102
    v_mfma_f32_32x32x16_bf16 v[48:63], v[68:71], v[180:183], 0
    v_fmac_f32 v196, v7, v103
    v_mul_f32 v198, v8, v128
    v_fmac_f32 v198, v9, v129
    v_fmac_f32 v198, v10, v130
    v_fmac_f32 v198, v11, v131
    v_fmac_f32 v198, v12, v132
    v_mfma_f32_32x32x16_bf16 v[32:47], v[72:75], v[184:187], v[32:47]
    v_fmac_f32 v198, v13, v133
    v_fmac_f32 v198, v14, v134
    v_fmac_f32 v198, v15, v135
    v_mul_f32 v200, v16, v128
    v_fmac_f32 v200, v17, v129
    v_permlane32_swap_b32 v196, v198
    v_mfma_f32_32x32x16_bf16 v[48:63], v[76:79], v[184:187], v[48:63]
    s_waitcnt vmcnt(5)
    ds_read_b64_tr_b16 v[176:177], v244 offset:6144
    ds_read_b64_tr_b16 v[178:179], v244 offset:7168
    ds_read_b64_tr_b16 v[180:181], v245 offset:6144
    ds_read_b64_tr_b16 v[182:183], v245 offset:7168
    v_fmac_f32 v200, v18, v130
    v_fmac_f32 v200, v19, v131
    v_fmac_f32 v200, v20, v132
    v_fmac_f32 v200, v21, v133
    v_fmac_f32 v200, v22, v134
    v_fmac_f32 v200, v23, v135
    v_mfma_f32_32x32x8_bf16 v[32:47], v[80:81], v[188:189], v[32:47]
    v_add_f32 v198, v196, v198
    v_mul_f32_e64 v202, v24, -v128
    v_fma_f32 v202, v25, -v129, v202
    v_fma_f32 v202, v26, -v130, v202
    v_fma_f32 v202, v27, -v131, v202
    v_fma_f32 v202, v28, -v132, v202
    v_mfma_f32_32x32x8_bf16 v[48:63], v[84:85], v[188:189], v[48:63]
    v_fma_f32 v202, v29, -v133, v202
    v_fma_f32 v202, v30, -v134, v202
    v_fma_f32 v202, v31, -v135, v202
    s_nop 1
    v_permlane32_swap_b32 v200, v202
    v_add_f32 v202, v200, v202
    s_waitcnt vmcnt(3) lgkmcnt(0)
    v_mfma_f32_32x32x16_bf16 v[0:15], v[64:67], v[176:179], 0
    v_mul_f32 v197, v32, v104
    v_fmac_f32 v197, v33, v105
    v_fmac_f32 v197, v34, v106
    v_fmac_f32 v197, v35, v107
    v_fmac_f32 v197, v36, v108
    v_fmac_f32 v197, v37, v109
    v_fmac_f32 v197, v38, v110
    s_add_u32 m0, s21, 6144
    v_mfma_f32_32x32x16_bf16 v[16:31], v[68:71], v[176:179], 0
    buffer_load_dwordx4 v236, s[4:7], s36 offen  lds
    buffer_load_dwordx4 v237, s[8:11], s36 offen offset:1024  lds
    ds_read_b64_tr_b16 v[176:177], v244 offset:0
    ds_read_b64_tr_b16 v[178:179], v244 offset:1024
    ds_read_b64_tr_b16 v[184:185], v245 offset:0
    ds_read_b64_tr_b16 v[186:187], v245 offset:1024
    v_fmac_f32 v197, v39, v111
    v_mul_f32 v199, v40, v136
    v_fmac_f32 v199, v41, v137
    v_fmac_f32 v199, v42, v138
    v_fmac_f32 v199, v43, v139
    v_fmac_f32 v199, v44, v140
    v_fmac_f32 v199, v45, v141
    s_waitcnt vmcnt(4) lgkmcnt(0)
    v_mfma_f32_32x32x16_bf16 v[0:15], v[72:75], v[176:179], v[0:15]
    v_fmac_f32 v199, v46, v142
    v_fmac_f32 v199, v47, v143
    v_mul_f32 v201, v48, v136
    v_fmac_f32 v201, v49, v137
    v_permlane32_swap_b32 v197, v199
    v_fmac_f32 v201, v50, v138
    v_fmac_f32 v201, v51, v139
    s_add_u32 m0, s21, 0
    v_mfma_f32_32x32x16_bf16 v[16:31], v[76:79], v[176:179], v[16:31]
    buffer_load_dwordx4 v238, s[4:7], s36 offen  lds
    ds_read_b64_tr_b16 v[176:177], v244 offset:2048
    ds_read_b64_tr_b16 v[188:189], v245 offset:2048
    v_fmac_f32 v201, v52, v140
    v_fmac_f32 v201, v53, v141
    v_fmac_f32 v201, v54, v142
    v_fmac_f32 v201, v55, v143
    v_add_f32 v199, v197, v199
    v_mul_f32_e64 v203, v56, -v136
    v_fma_f32 v203, v57, -v137, v203
    s_waitcnt lgkmcnt(0)
    v_mfma_f32_32x32x8_bf16 v[0:15], v[80:81], v[176:177], v[0:15]
    v_fma_f32 v203, v58, -v138, v203
    v_fma_f32 v203, v59, -v139, v203
    v_fma_f32 v203, v60, -v140, v203
    v_fma_f32 v203, v61, -v141, v203
    v_fma_f32 v203, v62, -v142, v203
    v_fma_f32 v203, v63, -v143, v203
    s_nop 1
    s_add_u32 m0, s21, 2048
    v_mfma_f32_32x32x8_bf16 v[16:31], v[84:85], v[176:177], v[16:31]
    buffer_load_dwordx4 v234, s[4:7], s37 offen  lds
    buffer_load_dwordx4 v235, s[8:11], s37 offen offset:1024  lds
    v_add_u32 v252, s42, v247
    ds_read_u16 v234, v252
    ds_read_u16 v235, v252 offset:64
    v_permlane32_swap_b32 v201, v203
    v_add_f32 v203, v201, v203
    s_set_gpr_idx_on s51, gpr_idx(DST)
    s_nop 0
    v_cvt_pk_bf16_f32 v204, v198, v199
    v_cvt_pk_bf16_f32 v205, v202, v203
    s_set_gpr_idx_off
    v_mfma_f32_32x32x16_bf16 v[32:47], v[64:67], v[180:183], 0
    v_mul_f32 v196, v0, v144
    v_fmac_f32 v196, v1, v145
    v_fmac_f32 v196, v2, v146
    v_fmac_f32 v196, v3, v147
    v_fmac_f32 v196, v4, v148
    v_fmac_f32 v196, v5, v149
    v_mfma_f32_32x32x16_bf16 v[48:63], v[68:71], v[180:183], 0
    v_add_u32 v253, s47, v248
    ds_read_b32 v254, v253
    ds_read_b32 v255, v253 offset:256
    v_fmac_f32 v196, v6, v150
    v_fmac_f32 v196, v7, v151
    v_mul_f32 v198, v8, v112
    v_fmac_f32 v198, v9, v113
    v_fmac_f32 v198, v10, v114
    v_mfma_f32_32x32x16_bf16 v[32:47], v[72:75], v[184:187], v[32:47]
    v_fmac_f32 v198, v11, v115
    v_fmac_f32 v198, v12, v116
    v_fmac_f32 v198, v13, v117
    v_fmac_f32 v198, v14, v118
    v_fmac_f32 v198, v15, v119
    v_mfma_f32_32x32x16_bf16 v[48:63], v[76:79], v[184:187], v[48:63]
    s_waitcnt vmcnt(5)
    ds_read_b64_tr_b16 v[176:177], v244 offset:4096
    ds_read_b64_tr_b16 v[178:179], v244 offset:5120
    ds_read_b64_tr_b16 v[180:181], v245 offset:4096
    ds_read_b64_tr_b16 v[182:183], v245 offset:5120
    v_mul_f32_e64 v200, v16, -v160
    v_fma_f32 v200, v17, -v161, v200
    v_fma_f32 v200, v18, -v162, v200
    v_fma_f32 v200, v19, -v163, v200
    v_fma_f32 v200, v20, -v164, v200
    v_fma_f32 v200, v21, -v165, v200
    v_mfma_f32_32x32x8_bf16 v[32:47], v[80:81], v[188:189], v[32:47]
    v_fma_f32 v200, v22, -v166, v200
    v_fma_f32 v200, v23, -v167, v200
    v_mul_f32_e64 v202, v24, -v160
    v_fma_f32 v202, v25, -v161, v202
    v_fma_f32 v202, v26, -v162, v202
    v_mfma_f32_32x32x8_bf16 v[48:63], v[84:85], v[188:189], v[48:63]
    v_fma_f32 v202, v27, -v163, v202
    v_fma_f32 v202, v28, -v164, v202
    v_fma_f32 v202, v29, -v165, v202
    v_fma_f32 v202, v30, -v166, v202
    v_fma_f32 v202, v31, -v167, v202
    s_waitcnt vmcnt(3) lgkmcnt(0)
    v_mfma_f32_32x32x16_bf16 v[0:15], v[64:67], v[176:179], 0
    v_mul_f32 v197, v32, v152
    v_fmac_f32 v197, v33, v153
    v_fmac_f32 v197, v34, v154
    v_fmac_f32 v197, v35, v155
    v_fmac_f32 v197, v36, v156
    v_fmac_f32 v197, v37, v157
    s_add_u32 m0, s21, 4096
    v_mfma_f32_32x32x16_bf16 v[16:31], v[68:71], v[176:179], 0
    buffer_load_dwordx4 v236, s[4:7], s37 offen  lds
    buffer_load_dwordx4 v237, s[8:11], s37 offen offset:1024  lds
    ds_read_b64_tr_b16 v[176:177], v244 offset:6144
    ds_read_b64_tr_b16 v[178:179], v244 offset:7168
    ds_read_b64_tr_b16 v[184:185], v245 offset:6144
    ds_read_b64_tr_b16 v[186:187], v245 offset:7168
    v_add_u32 v252, s43, v247
    ds_read_u16 v236, v252
    ds_read_u16 v237, v252 offset:64
    v_fmac_f32 v197, v38, v158
    v_fmac_f32 v197, v39, v159
    v_mul_f32 v199, v40, v120
    v_fmac_f32 v199, v41, v121
    v_fmac_f32 v199, v42, v122
    s_waitcnt vmcnt(4) lgkmcnt(2)
    v_mfma_f32_32x32x16_bf16 v[0:15], v[72:75], v[176:179], v[0:15]
    v_fmac_f32 v199, v43, v123
    v_fmac_f32 v199, v44, v124
    v_fmac_f32 v199, v45, v125
    v_fmac_f32 v199, v46, v126
    v_fmac_f32 v199, v47, v127
    s_add_u32 m0, s21, 6144
    v_mfma_f32_32x32x16_bf16 v[16:31], v[76:79], v[176:179], v[16:31]
    buffer_load_dwordx4 v238, s[4:7], s37 offen  lds
    ds_read_b64_tr_b16 v[176:177], v244 offset:0
    ds_read_b64_tr_b16 v[188:189], v245 offset:0
    v_add_u32 v252, s44, v247
    ds_read_u16 v238, v252
    ds_read_u16 v239, v252 offset:64
    v_mul_f32_e64 v201, v48, -v168
    v_fma_f32 v201, v49, -v169, v201
    v_fma_f32 v201, v50, -v170, v201
    v_fma_f32 v201, v51, -v171, v201
    v_fma_f32 v201, v52, -v172, v201
    v_fma_f32 v201, v53, -v173, v201
    s_waitcnt lgkmcnt(2)
    v_mfma_f32_32x32x8_bf16 v[0:15], v[80:81], v[176:177], v[0:15]
    v_fma_f32 v201, v54, -v174, v201
    v_fma_f32 v201, v55, -v175, v201
    v_mul_f32_e64 v203, v56, -v168
    v_fma_f32 v203, v57, -v169, v203
    v_fma_f32 v203, v58, -v170, v203
    s_add_u32 m0, s21, 0
    v_mfma_f32_32x32x8_bf16 v[16:31], v[84:85], v[176:177], v[16:31]
    v_lshl_add_u32 v234, v234, 10, v246
    v_lshl_add_u32 v235, v235, 10, v246
    buffer_load_dwordx4 v234, s[4:7], s38 offen  lds
    buffer_load_dwordx4 v235, s[8:11], s38 offen offset:1024  lds
    s_mov_b32 m0, s76
    s_mov_b64 exec, s[72:73]
    buffer_load_dwordx4 v254, s[12:15], 0 offen  lds
    s_mov_b32 m0, s77
    s_mov_b64 exec, s[74:75]
    buffer_load_dwordx4 v255, s[12:15], 0 offen  lds
    s_mov_b64 exec, -1
    v_fma_f32 v203, v59, -v171, v203
    v_fma_f32 v203, v60, -v172, v203
    v_fma_f32 v203, v61, -v173, v203
    v_fma_f32 v203, v62, -v174, v203
    v_fma_f32 v203, v63, -v175, v203
    v_mfma_f32_32x32x16_bf16 v[32:47], v[64:67], v[180:183], 0
    v_mul_f32 v254, v0, v144
    v_fmac_f32 v254, v1, v145
    v_fmac_f32 v254, v2, v146
    v_mfma_f32_32x32x16_bf16 v[48:63], v[68:71], v[180:183], 0
    ds_swizzle_b32 v68, v68 offset:0x401F
    ds_swizzle_b32 v69, v69 offset:0x401F
    ds_swizzle_b32 v70, v70 offset:0x401F
    ds_swizzle_b32 v71, v71 offset:0x401F
    v_fmac_f32 v254, v3, v147
    v_fmac_f32 v254, v4, v148
    v_fmac_f32 v254, v5, v149
    v_mfma_f32_32x32x16_bf16 v[32:47], v[72:75], v[184:187], v[32:47]
    v_fmac_f32 v254, v6, v150
    v_fmac_f32 v254, v7, v151
    v_fmac_f32 v200, v8, v160
    v_mfma_f32_32x32x16_bf16 v[48:63], v[76:79], v[184:187], v[48:63]
    ds_swizzle_b32 v76, v76 offset:0x401F
    ds_swizzle_b32 v77, v77 offset:0x401F
    ds_swizzle_b32 v78, v78 offset:0x401F
    ds_swizzle_b32 v79, v79 offset:0x401F
    s_waitcnt vmcnt(7)
    ds_read_b64_tr_b16 v[176:177], v244 offset:2048
    ds_read_b64_tr_b16 v[178:179], v244 offset:3072
    ds_read_b64_tr_b16 v[180:181], v245 offset:2048
    ds_read_b64_tr_b16 v[182:183], v245 offset:3072
    v_fmac_f32 v200, v9, v161
    v_permlane32_swap_b32 v196, v254
    v_fmac_f32 v200, v10, v162
    v_mfma_f32_32x32x8_bf16 v[32:47], v[80:81], v[188:189], v[32:47]
    v_fmac_f32 v200, v11, v163
    v_fmac_f32 v200, v12, v164
    v_fmac_f32 v200, v13, v165
    v_mfma_f32_32x32x8_bf16 v[48:63], v[84:85], v[188:189], v[48:63]
    ds_swizzle_b32 v84, v84 offset:0x401F
    ds_swizzle_b32 v85, v85 offset:0x401F
    v_fmac_f32 v200, v14, v166
    v_fmac_f32 v200, v15, v167
    v_add_f32 v254, v196, v254
    s_waitcnt lgkmcnt(6)
    s_mov_b64 exec, s[56:57]
    v_xor_b32 v68, 0x80008000, v68
    v_xor_b32 v69, 0x80008000, v69
    v_xor_b32 v70, 0x80008000, v70
    v_xor_b32 v71, 0x80008000, v71
    v_xor_b32 v76, 0x80008000, v76
    v_xor_b32 v77, 0x80008000, v77
    v_xor_b32 v78, 0x80008000, v78
    v_xor_b32 v79, 0x80008000, v79
    s_mov_b64 exec, -1
    s_waitcnt vmcnt(5) lgkmcnt(2)
    v_mfma_f32_32x32x16_bf16 v[0:15], v[64:67], v[176:179], 0
    v_mul_f32 v255, v32, v152
    v_fmac_f32 v255, v33, v153
    v_fmac_f32 v255, v34, v154
    v_fmac_f32 v255, v35, v155
    s_add_u32 m0, s21, 2048
    v_mfma_f32_32x32x16_bf16 v[16:31], v[68:71], v[176:179], v[16:31]
    v_lshl_add_u32 v236, v236, 10, v246
    v_lshl_add_u32 v237, v237, 10, v246
    buffer_load_dwordx4 v236, s[4:7], s39 offen  lds
    buffer_load_dwordx4 v237, s[8:11], s39 offen offset:1024  lds
    ds_read_b64_tr_b16 v[176:177], v244 offset:4096
    ds_read_b64_tr_b16 v[178:179], v244 offset:5120
    ds_read_b64_tr_b16 v[184:185], v245 offset:4096
    ds_read_b64_tr_b16 v[186:187], v245 offset:5120
    v_fmac_f32 v255, v36, v156
    v_fmac_f32 v255, v37, v157
    v_fmac_f32 v255, v38, v158
    v_fmac_f32 v255, v39, v159
    s_waitcnt vmcnt(6) lgkmcnt(0)
    v_mfma_f32_32x32x16_bf16 v[0:15], v[72:75], v[176:179], v[0:15]
    v_fmac_f32 v201, v40, v168
    v_fmac_f32 v201, v41, v169
    v_permlane32_swap_b32 v197, v255
    s_add_u32 m0, s21, 4096
    v_mfma_f32_32x32x16_bf16 v[16:31], v[76:79], v[176:179], v[16:31]
    v_lshl_add_u32 v238, v238, 10, v246
    v_lshl_add_u32 v239, v239, 10, v246
    buffer_load_dwordx4 v238, s[4:7], s40 offen  lds
    buffer_load_dwordx4 v239, s[8:11], s40 offen offset:1024  lds
    ds_read_b64_tr_b16 v[176:177], v244 offset:6144
    ds_read_b64_tr_b16 v[188:189], v245 offset:6144
    v_fmac_f32 v201, v42, v170
    v_fmac_f32 v201, v43, v171
    v_fmac_f32 v201, v44, v172
    v_fmac_f32 v201, v45, v173
    s_waitcnt lgkmcnt(0)
    s_mov_b64 exec, s[56:57]
    v_xor_b32 v84, 0x80008000, v84
    v_xor_b32 v85, 0x80008000, v85
    s_mov_b64 exec, -1
    v_mfma_f32_32x32x8_bf16 v[0:15], v[80:81], v[176:177], v[0:15]
    v_fmac_f32 v201, v46, v174
    v_fmac_f32 v201, v47, v175
    v_add_f32 v255, v197, v255
    s_set_gpr_idx_on s51, gpr_idx(DST)
    s_nop 0
    v_cvt_pk_bf16_f32 v206, v254, v255
    s_set_gpr_idx_off
    s_add_u32 m0, s21, 6144
    v_mfma_f32_32x32x8_bf16 v[16:31], v[84:85], v[176:177], v[16:31]
    v_lshl_add_u32 v240, v240, 10, v246
    v_lshl_add_u32 v241, v241, 10, v246
    buffer_load_dwordx4 v240, s[4:7], s41 offen  lds
    buffer_load_dwordx4 v241, s[8:11], s41 offen offset:1024  lds
    v_mfma_f32_32x32x16_bf16 v[32:47], v[64:67], v[180:183], 0
    v_mul_f32 v254, v0, v144
    v_fmac_f32 v254, v1, v145
    v_fmac_f32 v254, v2, v146
    v_fmac_f32 v254, v3, v147
    v_fmac_f32 v254, v4, v148
    v_fmac_f32 v254, v5, v149
    v_fmac_f32 v254, v6, v150
    v_mfma_f32_32x32x16_bf16 v[48:63], v[68:71], v[180:183], v[48:63]
    v_fmac_f32 v254, v7, v151
    v_fma_f32 v202, v8, -v160, v202
    v_fma_f32 v202, v9, -v161, v202
    v_permlane32_swap_b32 v254, v200
    v_fma_f32 v202, v10, -v162, v202
    v_fma_f32 v202, v11, -v163, v202
    v_mfma_f32_32x32x16_bf16 v[32:47], v[72:75], v[184:187], v[32:47]
    v_fma_f32 v202, v12, -v164, v202
    v_fma_f32 v202, v13, -v165, v202
    v_fma_f32 v202, v14, -v166, v202
    v_fma_f32 v202, v15, -v167, v202
    v_add_f32 v200, v254, v200
    v_fmac_f32 v198, v16, v112
    v_permlane32_swap_b32 v202, v254
    v_mfma_f32_32x32x16_bf16 v[48:63], v[76:79], v[184:187], v[48:63]
    s_waitcnt vmcnt(8)
    ds_read_b64_tr_b16 v[176:177], v244 offset:0
    ds_read_b64_tr_b16 v[178:179], v244 offset:1024
    ds_read_b64_tr_b16 v[180:181], v245 offset:0
    ds_read_b64_tr_b16 v[182:183], v245 offset:1024
    v_fmac_f32 v198, v17, v113
    v_fmac_f32 v198, v18, v114
    v_fmac_f32 v198, v19, v115
    v_fmac_f32 v198, v20, v116
    v_fmac_f32 v198, v21, v117
    v_fmac_f32 v198, v22, v118
    v_mfma_f32_32x32x8_bf16 v[32:47], v[80:81], v[188:189], v[32:47]
    v_fmac_f32 v198, v23, v119
    v_add_f32 v254, v202, v254
    v_mul_f32 v196, v24, v160
    v_fmac_f32 v196, v25, v161
    v_fmac_f32 v196, v26, v162
    v_fmac_f32 v196, v27, v163
    v_fmac_f32 v196, v28, v164
    v_mfma_f32_32x32x8_bf16 v[48:63], v[84:85], v[188:189], v[48:63]
    v_add_u32 v249, s48, v249
    v_add_u32 v250, s49, v250
    s_waitcnt vmcnt(6)
    ds_read_b64_tr_b16 v[64:65], v249 offset:0
    ds_read_b64_tr_b16 v[68:69], v249 offset:64
    ds_read_b64_tr_b16 v[66:67], v249 offset:256
    ds_read_b64_tr_b16 v[70:71], v249 offset:320
    s_mov_b64 exec, s[54:55]
    ds_read_u16_d16_hi v242, v250 offset:0
    s_mov_b64 exec, -1
    v_fmac_f32 v196, v29, v165
    v_fmac_f32 v196, v30, v166
    v_fmac_f32 v196, v31, v167
    s_nop 1
    v_permlane32_swap_b32 v198, v196
    v_add_f32 v196, v198, v196
    v_mul_f32 v255, v32, v152
    v_fmac_f32 v255, v33, v153
    v_fmac_f32 v255, v34, v154
    v_fmac_f32 v255, v35, v155
    v_fmac_f32 v255, v36, v156
    v_fmac_f32 v255, v37, v157
    v_fmac_f32 v255, v38, v158
    v_fmac_f32 v255, v39, v159
    v_fma_f32 v203, v40, -v168, v203
    v_fma_f32 v203, v41, -v169, v203
    v_permlane32_swap_b32 v255, v201
    v_fma_f32 v203, v42, -v170, v203
    v_fma_f32 v203, v43, -v171, v203
    v_fma_f32 v203, v44, -v172, v203
    v_fma_f32 v203, v45, -v173, v203
    v_fma_f32 v203, v46, -v174, v203
    v_fma_f32 v203, v47, -v175, v203
    v_add_f32 v201, v255, v201
    v_fmac_f32 v199, v48, v120
    v_permlane32_swap_b32 v203, v255
    v_fmac_f32 v199, v49, v121
    v_fmac_f32 v199, v50, v122
    v_fmac_f32 v199, v51, v123
    v_fmac_f32 v199, v52, v124
    v_fmac_f32 v199, v53, v125
    v_fmac_f32 v199, v54, v126
    v_fmac_f32 v199, v55, v127
    v_add_f32 v255, v203, v255
    v_mul_f32 v197, v56, v168
    v_fmac_f32 v197, v57, v169
    v_fmac_f32 v197, v58, v170
    v_fmac_f32 v197, v59, v171
    v_fmac_f32 v197, v60, v172
    v_fmac_f32 v197, v61, v173
    v_fmac_f32 v197, v62, v174
    v_fmac_f32 v197, v63, v175
    s_nop 1
    v_permlane32_swap_b32 v199, v197
    v_add_f32 v197, v199, v197
    s_set_gpr_idx_on s51, gpr_idx(DST)
    s_nop 0
    v_cvt_pk_bf16_f32 v207, v200, v201
    v_cvt_pk_bf16_f32 v209, v254, v255
    v_cvt_pk_bf16_f32 v208, v196, v197
    s_set_gpr_idx_off
    s_add_u32 s50, s50, 1
    s_add_u32 s51, s51, 6
    s_cmp_ge_u32 s50, 4
    s_cbranch_scc1 LAST0
    s_add_u32 s53, s53, 4
    s_xor_b32 s66, s53, s20
    s_bitcmp1_b32 s66, 2
    s_setprio 1
    s_cbranch_scc1 PRIO_6
    s_setprio 0
PRIO_6:
    s_cmp_eq_u32 s52, 4
    s_cbranch_scc1 ITEM_0_4
    s_cmp_eq_u32 s52, 5
    s_cbranch_scc1 ITEM_0_5
    s_cmp_eq_u32 s52, 3
    s_cbranch_scc1 ITEM_0_3
    s_cmp_eq_u32 s52, 6
    s_cbranch_scc1 ITEM_0_6
    s_cmp_eq_u32 s52, 8
    s_cbranch_scc1 ITEM_0_8
    s_branch ITEM_0_2
.p2align 6
ITEM_0_3:
    s_mov_b64 exec, s[54:55]
    ds_read_u16_d16_hi v243, v250 offset:128
    s_mov_b64 exec, -1
    ds_read_b64_tr_b16 v[72:73], v249 offset:512
    ds_read_b64_tr_b16 v[76:77], v249 offset:576
    s_waitcnt lgkmcnt(3)
    v_mul_f32_dpp v196, v242, v64 row_newbcast:0 row_mask:0xf bank_mask:0xf
    v_mul_f32_dpp v197, v242, v65 row_newbcast:1 row_mask:0xf bank_mask:0xf
    v_mul_f32_dpp v198, v242, v64 row_newbcast:8 row_mask:0xf bank_mask:0xf
    v_mul_f32_dpp v199, v242, v65 row_newbcast:9 row_mask:0xf bank_mask:0xf
    v_mul_f32_dpp v200, v242, v68 row_newbcast:2 row_mask:0xf bank_mask:0xf
    v_mul_f32_dpp v201, v242, v69 row_newbcast:3 row_mask:0xf bank_mask:0xf
    v_mul_f32_dpp v202, v242, v68 row_newbcast:10 row_mask:0xf bank_mask:0xf
    v_mul_f32_dpp v203, v242, v69 row_newbcast:11 row_mask:0xf bank_mask:0xf
    v_cvt_pk_bf16_f32 v64, v196, v197
    v_cvt_pk_bf16_f32 v68, v198, v199
    v_cvt_pk_bf16_f32 v65, v200, v201
    v_cvt_pk_bf16_f32 v69, v202, v203
    v_mul_f32_dpp v196, v242, v66 row_newbcast:4 row_mask:0xf bank_mask:0xf
    v_mul_f32_dpp v197, v242, v67 row_newbcast:5 row_mask:0xf bank_mask:0xf
    v_mul_f32_dpp v198, v242, v66 row_newbcast:12 row_mask:0xf bank_mask:0xf
    v_mul_f32_dpp v199, v242, v67 row_newbcast:13 row_mask:0xf bank_mask:0xf
    v_mul_f32_dpp v200, v242, v70 row_newbcast:6 row_mask:0xf bank_mask:0xf
    v_mul_f32_dpp v201, v242, v71 row_newbcast:7 row_mask:0xf bank_mask:0xf
    v_mul_f32_dpp v202, v242, v70 row_newbcast:14 row_mask:0xf bank_mask:0xf
    v_mul_f32_dpp v203, v242, v71 row_newbcast:15 row_mask:0xf bank_mask:0xf
    v_cvt_pk_bf16_f32 v66, v196, v197
    v_cvt_pk_bf16_f32 v70, v198, v199
    v_cvt_pk_bf16_f32 v67, v200, v201
    v_cvt_pk_bf16_f32 v71, v202, v203
    s_nop 0
    s_waitcnt vmcnt(4) lgkmcnt(0)
    v_mfma_f32_32x32x16_bf16 v[0:15], v[64:67], v[176:179], 0
    v_mul_f32_dpp v196, v243, v72 row_newbcast:0 row_mask:0xf bank_mask:0xf
    v_mul_f32_dpp v197, v243, v73 row_newbcast:1 row_mask:0xf bank_mask:0xf
    v_mul_f32_dpp v198, v243, v72 row_newbcast:8 row_mask:0xf bank_mask:0xf
    v_mul_f32_dpp v199, v243, v73 row_newbcast:9 row_mask:0xf bank_mask:0xf
    v_mul_f32_dpp v200, v243, v76 row_newbcast:2 row_mask:0xf bank_mask:0xf
    v_mul_f32_dpp v201, v243, v77 row_newbcast:3 row_mask:0xf bank_mask:0xf
    s_add_u32 m0, s21, 0
    v_mfma_f32_32x32x16_bf16 v[16:31], v[68:71], v[176:179], 0
    buffer_load_dwordx4 v234, s[4:7], s36 offen  lds
    buffer_load_dwordx4 v235, s[8:11], s36 offen offset:1024  lds
    ds_read_b64_tr_b16 v[176:177], v244 offset:2048
    ds_read_b64_tr_b16 v[184:185], v245 offset:2048
    v_mul_f32_dpp v202, v243, v76 row_newbcast:10 row_mask:0xf bank_mask:0xf
    v_mul_f32_dpp v203, v243, v77 row_newbcast:11 row_mask:0xf bank_mask:0xf
    v_cvt_pk_bf16_f32 v72, v196, v197
    v_cvt_pk_bf16_f32 v76, v198, v199
    v_cvt_pk_bf16_f32 v73, v200, v201
    v_cvt_pk_bf16_f32 v77, v202, v203
    s_nop 0
    s_waitcnt lgkmcnt(0)
    v_mfma_f32_32x32x8_bf16 v[0:15], v[72:73], v[176:177], v[0:15]
    s_add_u32 m0, s21, 2048
    v_mfma_f32_32x32x8_bf16 v[16:31], v[76:77], v[176:177], v[16:31]
    buffer_load_dwordx4 v236, s[4:7], s36 offen  lds
    s_mov_b32 m0, s50
    s_nop 0
    s_movrels_b32 s71, s23
    s_bfe_u32 s46, s71, 0x30012
    s_mov_b32 m0, s46
    s_and_b32 s66, s71, 0x3ffff
    s_movrels_b32 s68, s57
    s_movrels_b32 s69, s61
    s_sub_u32 s48, s66, s47
    s_mov_b32 s47, s66
    s_lshr_b32 s52, s71, 28
    s_lshl_b32 s67, s46, 9
    s_add_u32 s66, s66, s67
    s_sub_u32 s49, s66, s42
    s_mov_b32 s42, s66
    s_bfe_u32 s66, s68, 655360
    s_add_u32 s43, s42, s66
    s_bfe_u32 s39, s69, 655360
    s_bfe_u32 s66, s68, 655370
    s_add_u32 s44, s42, s66
    s_bfe_u32 s40, s69, 655370
    s_bfe_u32 s66, s68, 655380
    s_add_u32 s45, s42, s66
    s_bfe_u32 s41, s69, 655380
    s_and_b32 s66, s46, s33
    s_cselect_b32 s72, -1, 1
    s_cselect_b32 s76, s47, 163712
    s_cmp_ge_u32 s66, 2
    s_cselect_b32 s73, -1, 0
    s_add_u32 s77, s47, 1024
    s_cmp_ge_u32 s66, 4
    s_cselect_b32 s75, -1, 0
    s_cmp_ge_u32 s66, 3
    s_cselect_b32 s74, -1, 1
    s_cselect_b32 s77, s77, 163712
    v_add_u32 v252, s44, v247
    ds_read_u16 v238, v252
    ds_read_u16 v239, v252 offset:64
    v_add_u32 v252, s45, v247
    ds_read_u16 v240, v252
    ds_read_u16 v241, v252 offset:64
    v_mfma_f32_32x32x16_bf16 v[32:47], v[64:67], v[180:183], 0
    v_mul_f32 v196, v0, v96
    v_fmac_f32 v196, v1, v97
    v_fmac_f32 v196, v2, v98
    v_fmac_f32 v196, v3, v99
    v_fmac_f32 v196, v4, v100
    v_fmac_f32 v196, v5, v101
    v_fmac_f32 v196, v6, v102
    v_fmac_f32 v196, v7, v103
    v_mul_f32 v198, v8, v128
    v_fmac_f32 v198, v9, v129
    v_mfma_f32_32x32x16_bf16 v[48:63], v[68:71], v[180:183], 0
    s_waitcnt vmcnt(5)
    ds_read_b64_tr_b16 v[176:177], v244 offset:4096
    ds_read_b64_tr_b16 v[178:179], v244 offset:5120
    ds_read_b64_tr_b16 v[180:181], v245 offset:4096
    ds_read_b64_tr_b16 v[182:183], v245 offset:5120
    v_fmac_f32 v198, v10, v130
    v_fmac_f32 v198, v11, v131
    v_fmac_f32 v198, v12, v132
    v_fmac_f32 v198, v13, v133
    v_fmac_f32 v198, v14, v134
    v_fmac_f32 v198, v15, v135
    v_mul_f32 v200, v16, v128
    v_fmac_f32 v200, v17, v129
    v_permlane32_swap_b32 v196, v198
    v_mfma_f32_32x32x8_bf16 v[32:47], v[72:73], v[184:185], v[32:47]
    v_fmac_f32 v200, v18, v130
    v_fmac_f32 v200, v19, v131
    v_fmac_f32 v200, v20, v132
    v_fmac_f32 v200, v21, v133
    v_fmac_f32 v200, v22, v134
    v_fmac_f32 v200, v23, v135
    v_add_f32 v198, v196, v198
    v_mul_f32_e64 v202, v24, -v128
    v_fma_f32 v202, v25, -v129, v202
    v_mfma_f32_32x32x8_bf16 v[48:63], v[76:77], v[184:185], v[48:63]
    v_fma_f32 v202, v26, -v130, v202
    v_fma_f32 v202, v27, -v131, v202
    v_fma_f32 v202, v28, -v132, v202
    v_fma_f32 v202, v29, -v133, v202
    v_fma_f32 v202, v30, -v134, v202
    v_fma_f32 v202, v31, -v135, v202
    s_nop 1
    v_permlane32_swap_b32 v200, v202
    v_add_f32 v202, v200, v202
    s_waitcnt vmcnt(3) lgkmcnt(0)
    v_mfma_f32_32x32x16_bf16 v[0:15], v[64:67], v[176:179], 0
    v_mul_f32 v197, v32, v104
    v_fmac_f32 v197, v33, v105
    v_fmac_f32 v197, v34, v106
    v_fmac_f32 v197, v35, v107
    v_fmac_f32 v197, v36, v108
    v_fmac_f32 v197, v37, v109
    v_fmac_f32 v197, v38, v110
    v_fmac_f32 v197, v39, v111
    v_mul_f32 v199, v40, v136
    v_fmac_f32 v199, v41, v137
    v_fmac_f32 v199, v42, v138
    s_add_u32 m0, s21, 4096
    v_mfma_f32_32x32x16_bf16 v[16:31], v[68:71], v[176:179], 0
    buffer_load_dwordx4 v234, s[4:7], s37 offen  lds
    buffer_load_dwordx4 v235, s[8:11], s37 offen offset:1024  lds
    ds_read_b64_tr_b16 v[176:177], v244 offset:6144
    ds_read_b64_tr_b16 v[184:185], v245 offset:6144
    v_add_u32 v252, s42, v247
    ds_read_u16 v234, v252
    ds_read_u16 v235, v252 offset:64
    v_fmac_f32 v199, v43, v139
    v_fmac_f32 v199, v44, v140
    v_fmac_f32 v199, v45, v141
    v_fmac_f32 v199, v46, v142
    v_fmac_f32 v199, v47, v143
    v_mul_f32 v201, v48, v136
    v_fmac_f32 v201, v49, v137
    v_permlane32_swap_b32 v197, v199
    v_fmac_f32 v201, v50, v138
    v_fmac_f32 v201, v51, v139
    s_waitcnt lgkmcnt(2)
    v_mfma_f32_32x32x8_bf16 v[0:15], v[72:73], v[176:177], v[0:15]
    v_fmac_f32 v201, v52, v140
    v_fmac_f32 v201, v53, v141
    v_fmac_f32 v201, v54, v142
    v_fmac_f32 v201, v55, v143
    v_add_f32 v199, v197, v199
    v_mul_f32_e64 v203, v56, -v136
    v_fma_f32 v203, v57, -v137, v203
    v_fma_f32 v203, v58, -v138, v203
    v_fma_f32 v203, v59, -v139, v203
    v_fma_f32 v203, v60, -v140, v203
    v_fma_f32 v203, v61, -v141, v203
    s_add_u32 m0, s21, 6144
    v_mfma_f32_32x32x8_bf16 v[16:31], v[76:77], v[176:177], v[16:31]
    buffer_load_dwordx4 v236, s[4:7], s37 offen  lds
    v_add_u32 v252, s43, v247
    ds_read_u16 v236, v252
    ds_read_u16 v237, v252 offset:64
    v_fma_f32 v203, v62, -v142, v203
    v_fma_f32 v203, v63, -v143, v203
    s_nop 1
    v_permlane32_swap_b32 v201, v203
    v_add_f32 v203, v201, v203
    s_set_gpr_idx_on s51, gpr_idx(DST)
    s_nop 0
    v_cvt_pk_bf16_f32 v204, v198, v199
    v_cvt_pk_bf16_f32 v205, v202, v203
    s_set_gpr_idx_off
    v_mfma_f32_32x32x16_bf16 v[32:47], v[64:67], v[180:183], 0
    v_mul_f32 v196, v0, v144
    v_fmac_f32 v196, v1, v145
    v_fmac_f32 v196, v2, v146
    v_fmac_f32 v196, v3, v147
    v_fmac_f32 v196, v4, v148
    v_fmac_f32 v196, v5, v149
    v_fmac_f32 v196, v6, v150
    v_fmac_f32 v196, v7, v151
    v_mfma_f32_32x32x16_bf16 v[48:63], v[68:71], v[180:183], 0
    v_add_u32 v253, s47, v248
    ds_read_b32 v254, v253
    ds_read_b32 v255, v253 offset:256
    s_waitcnt vmcnt(4)
    ds_read_b64_tr_b16 v[176:177], v244 offset:0
    ds_read_b64_tr_b16 v[178:179], v244 offset:1024
    ds_read_b64_tr_b16 v[180:181], v245 offset:0
    ds_read_b64_tr_b16 v[182:183], v245 offset:1024
    v_mul_f32 v198, v8, v112
    v_fmac_f32 v198, v9, v113
    v_fmac_f32 v198, v10, v114
    v_fmac_f32 v198, v11, v115
    v_fmac_f32 v198, v12, v116
    v_fmac_f32 v198, v13, v117
    v_fmac_f32 v198, v14, v118
    v_fmac_f32 v198, v15, v119
    v_mfma_f32_32x32x8_bf16 v[32:47], v[72:73], v[184:185], v[32:47]
    v_mul_f32_e64 v200, v16, -v160
    v_fma_f32 v200, v17, -v161, v200
    v_fma_f32 v200, v18, -v162, v200
    v_fma_f32 v200, v19, -v163, v200
    v_fma_f32 v200, v20, -v164, v200
    v_fma_f32 v200, v21, -v165, v200
    v_fma_f32 v200, v22, -v166, v200
    v_fma_f32 v200, v23, -v167, v200
    v_mfma_f32_32x32x8_bf16 v[48:63], v[76:77], v[184:185], v[48:63]
    v_mul_f32_e64 v202, v24, -v160
    v_fma_f32 v202, v25, -v161, v202
    v_fma_f32 v202, v26, -v162, v202
    v_fma_f32 v202, v27, -v163, v202
    v_fma_f32 v202, v28, -v164, v202
    v_fma_f32 v202, v29, -v165, v202
    v_fma_f32 v202, v30, -v166, v202
    v_fma_f32 v202, v31, -v167, v202
    s_waitcnt vmcnt(3) lgkmcnt(0)
    v_mfma_f32_32x32x16_bf16 v[0:15], v[64:67], v[176:179], 0
    v_mul_f32 v197, v32, v152
    v_fmac_f32 v197, v33, v153
    v_fmac_f32 v197, v34, v154
    v_fmac_f32 v197, v35, v155
    v_fmac_f32 v197, v36, v156
    v_fmac_f32 v197, v37, v157
    v_fmac_f32 v197, v38, v158
    v_fmac_f32 v197, v39, v159
    s_add_u32 m0, s21, 0
    v_mfma_f32_32x32x16_bf16 v[16:31], v[68:71], v[176:179], 0
    v_lshl_add_u32 v234, v234, 10, v246
    v_lshl_add_u32 v235, v235, 10, v246
    buffer_load_dwordx4 v234, s[4:7], s38 offen  lds
    buffer_load_dwordx4 v235, s[8:11], s38 offen offset:1024  lds
    ds_read_b64_tr_b16 v[176:177], v244 offset:2048
    ds_read_b64_tr_b16 v[184:185], v245 offset:2048
    v_mul_f32 v199, v40, v120
    v_fmac_f32 v199, v41, v121
    v_fmac_f32 v199, v42, v122
    v_fmac_f32 v199, v43, v123
    v_fmac_f32 v199, v44, v124
    v_fmac_f32 v199, v45, v125
    v_fmac_f32 v199, v46, v126
    v_fmac_f32 v199, v47, v127
    s_waitcnt lgkmcnt(0)
    v_mfma_f32_32x32x8_bf16 v[0:15], v[72:73], v[176:177], v[0:15]
    v_mul_f32_e64 v201, v48, -v168
    v_fma_f32 v201, v49, -v169, v201
    v_fma_f32 v201, v50, -v170, v201
    v_fma_f32 v201, v51, -v171, v201
    v_fma_f32 v201, v52, -v172, v201
    v_fma_f32 v201, v53, -v173, v201
    v_fma_f32 v201, v54, -v174, v201
    v_fma_f32 v201, v55, -v175, v201
    s_add_u32 m0, s21, 2048
    v_mfma_f32_32x32x8_bf16 v[16:31], v[76:77], v[176:177], v[16:31]
    v_lshl_add_u32 v236, v236, 10, v246
    v_lshl_add_u32 v237, v237, 10, v246
    buffer_load_dwordx4 v236, s[4:7], s39 offen  lds
    buffer_load_dwordx4 v237, s[8:11], s39 offen offset:1024  lds
    s_mov_b32 m0, s76
    s_mov_b64 exec, s[72:73]
    buffer_load_dwordx4 v254, s[12:15], 0 offen  lds
    s_mov_b32 m0, s77
    s_mov_b64 exec, s[74:75]
    buffer_load_dwordx4 v255, s[12:15], 0 offen  lds
    s_mov_b64 exec, -1
    v_mul_f32_e64 v203, v56, -v168
    v_fma_f32 v203, v57, -v169, v203
    v_fma_f32 v203, v58, -v170, v203
    v_fma_f32 v203, v59, -v171, v203
    v_fma_f32 v203, v60, -v172, v203
    v_fma_f32 v203, v61, -v173, v203
    v_fma_f32 v203, v62, -v174, v203
    v_fma_f32 v203, v63, -v175, v203
    v_mfma_f32_32x32x16_bf16 v[32:47], v[64:67], v[180:183], 0
    v_mul_f32 v254, v0, v144
    v_fmac_f32 v254, v1, v145
    v_fmac_f32 v254, v2, v146
    v_fmac_f32 v254, v3, v147
    v_fmac_f32 v254, v4, v148
    v_mfma_f32_32x32x16_bf16 v[48:63], v[68:71], v[180:183], 0
    ds_swizzle_b32 v68, v68 offset:0x401F
    ds_swizzle_b32 v69, v69 offset:0x401F
    ds_swizzle_b32 v70, v70 offset:0x401F
    ds_swizzle_b32 v71, v71 offset:0x401F
    s_waitcnt vmcnt(7)
    ds_read_b64_tr_b16 v[176:177], v244 offset:4096
    ds_read_b64_tr_b16 v[178:179], v244 offset:5120
    ds_read_b64_tr_b16 v[180:181], v245 offset:4096
    ds_read_b64_tr_b16 v[182:183], v245 offset:5120
    v_fmac_f32 v254, v5, v149
    v_fmac_f32 v254, v6, v150
    v_fmac_f32 v254, v7, v151
    v_fmac_f32 v200, v8, v160
    v_mfma_f32_32x32x8_bf16 v[32:47], v[72:73], v[184:185], v[32:47]
    v_fmac_f32 v200, v9, v161
    v_permlane32_swap_b32 v196, v254
    v_fmac_f32 v200, v10, v162
    v_fmac_f32 v200, v11, v163
    v_fmac_f32 v200, v12, v164
    v_mfma_f32_32x32x8_bf16 v[48:63], v[76:77], v[184:185], v[48:63]
    ds_swizzle_b32 v76, v76 offset:0x401F
    ds_swizzle_b32 v77, v77 offset:0x401F
    v_fmac_f32 v200, v13, v165
    v_fmac_f32 v200, v14, v166
    v_fmac_f32 v200, v15, v167
    v_add_f32 v254, v196, v254
    s_waitcnt lgkmcnt(6)
    s_mov_b64 exec, s[56:57]
    v_xor_b32 v68, 0x80008000, v68
    v_xor_b32 v69, 0x80008000, v69
    v_xor_b32 v70, 0x80008000, v70
    v_xor_b32 v71, 0x80008000, v71
    s_mov_b64 exec, -1
    s_waitcnt vmcnt(6) lgkmcnt(2)
    v_mfma_f32_32x32x16_bf16 v[0:15], v[64:67], v[176:179], 0
    v_mul_f32 v255, v32, v152
    v_fmac_f32 v255, v33, v153
    v_fmac_f32 v255, v34, v154
    v_fmac_f32 v255, v35, v155
    v_fmac_f32 v255, v36, v156
    v_fmac_f32 v255, v37, v157
    s_add_u32 m0, s21, 4096
    v_mfma_f32_32x32x16_bf16 v[16:31], v[68:71], v[176:179], v[16:31]
    v_lshl_add_u32 v238, v238, 10, v246
    v_lshl_add_u32 v239, v239, 10, v246
    buffer_load_dwordx4 v238, s[4:7], s40 offen  lds
    buffer_load_dwordx4 v239, s[8:11], s40 offen offset:1024  lds
    ds_read_b64_tr_b16 v[176:177], v244 offset:6144
    ds_read_b64_tr_b16 v[184:185], v245 offset:6144
    v_fmac_f32 v255, v38, v158
    v_fmac_f32 v255, v39, v159
    v_fmac_f32 v201, v40, v168
    v_fmac_f32 v201, v41, v169
    v_permlane32_swap_b32 v197, v255
    s_waitcnt lgkmcnt(0)
    s_mov_b64 exec, s[56:57]
    v_xor_b32 v76, 0x80008000, v76
    v_xor_b32 v77, 0x80008000, v77
    s_mov_b64 exec, -1
    v_mfma_f32_32x32x8_bf16 v[0:15], v[72:73], v[176:177], v[0:15]
    v_fmac_f32 v201, v42, v170
    v_fmac_f32 v201, v43, v171
    v_fmac_f32 v201, v44, v172
    v_fmac_f32 v201, v45, v173
    v_fmac_f32 v201, v46, v174
    v_fmac_f32 v201, v47, v175
    s_add_u32 m0, s21, 6144
    v_mfma_f32_32x32x8_bf16 v[16:31], v[76:77], v[176:177], v[16:31]
    v_lshl_add_u32 v240, v240, 10, v246
    v_lshl_add_u32 v241, v241, 10, v246
    buffer_load_dwordx4 v240, s[4:7], s41 offen  lds
    buffer_load_dwordx4 v241, s[8:11], s41 offen offset:1024  lds
    v_add_f32 v255, v197, v255
    s_set_gpr_idx_on s51, gpr_idx(DST)
    s_nop 0
    v_cvt_pk_bf16_f32 v206, v254, v255
    s_set_gpr_idx_off
    v_mfma_f32_32x32x16_bf16 v[32:47], v[64:67], v[180:183], 0
    v_mul_f32 v254, v0, v144
    v_fmac_f32 v254, v1, v145
    v_fmac_f32 v254, v2, v146
    v_fmac_f32 v254, v3, v147
    v_fmac_f32 v254, v4, v148
    v_fmac_f32 v254, v5, v149
    v_fmac_f32 v254, v6, v150
    v_fmac_f32 v254, v7, v151
    v_fma_f32 v202, v8, -v160, v202
    v_fma_f32 v202, v9, -v161, v202
    v_mfma_f32_32x32x16_bf16 v[48:63], v[68:71], v[180:183], v[48:63]
    s_waitcnt vmcnt(8)
    ds_read_b64_tr_b16 v[176:177], v244 offset:0
    ds_read_b64_tr_b16 v[178:179], v244 offset:1024
    ds_read_b64_tr_b16 v[180:181], v245 offset:0
    ds_read_b64_tr_b16 v[182:183], v245 offset:1024
    v_permlane32_swap_b32 v254, v200
    v_fma_f32 v202, v10, -v162, v202
    v_fma_f32 v202, v11, -v163, v202
    v_fma_f32 v202, v12, -v164, v202
    v_fma_f32 v202, v13, -v165, v202
    v_fma_f32 v202, v14, -v166, v202
    v_fma_f32 v202, v15, -v167, v202
    v_add_f32 v200, v254, v200
    v_fmac_f32 v198, v16, v112
    v_permlane32_swap_b32 v202, v254
    v_mfma_f32_32x32x8_bf16 v[32:47], v[72:73], v[184:185], v[32:47]
    v_fmac_f32 v198, v17, v113
    v_fmac_f32 v198, v18, v114
    v_fmac_f32 v198, v19, v115
    v_fmac_f32 v198, v20, v116
    v_fmac_f32 v198, v21, v117
    v_fmac_f32 v198, v22, v118
    v_fmac_f32 v198, v23, v119
    v_add_f32 v254, v202, v254
    v_mul_f32 v196, v24, v160
    v_fmac_f32 v196, v25, v161
    v_mfma_f32_32x32x8_bf16 v[48:63], v[76:77], v[184:185], v[48:63]
    v_add_u32 v249, s48, v249
    v_add_u32 v250, s49, v250
    s_waitcnt vmcnt(4)
    ds_read_b64_tr_b16 v[64:65], v249 offset:0
    ds_read_b64_tr_b16 v[68:69], v249 offset:64
    ds_read_b64_tr_b16 v[66:67], v249 offset:256
    ds_read_b64_tr_b16 v[70:71], v249 offset:320
    s_mov_b64 exec, s[54:55]
    ds_read_u16_d16_hi v242, v250 offset:0
    s_mov_b64 exec, -1
    v_fmac_f32 v196, v26, v162
    v_fmac_f32 v196, v27, v163
    v_fmac_f32 v196, v28, v164
    v_fmac_f32 v196, v29, v165
    v_fmac_f32 v196, v30, v166
    v_fmac_f32 v196, v31, v167
    s_nop 1
    v_permlane32_swap_b32 v198, v196
    v_add_f32 v196, v198, v196
    v_mul_f32 v255, v32, v152
    v_fmac_f32 v255, v33, v153
    v_fmac_f32 v255, v34, v154
    v_fmac_f32 v255, v35, v155
    v_fmac_f32 v255, v36, v156
    v_fmac_f32 v255, v37, v157
    v_fmac_f32 v255, v38, v158
    v_fmac_f32 v255, v39, v159
    v_fma_f32 v203, v40, -v168, v203
    v_fma_f32 v203, v41, -v169, v203
    v_permlane32_swap_b32 v255, v201
    v_fma_f32 v203, v42, -v170, v203
    v_fma_f32 v203, v43, -v171, v203
    v_fma_f32 v203, v44, -v172, v203
    v_fma_f32 v203, v45, -v173, v203
    v_fma_f32 v203, v46, -v174, v203
    v_fma_f32 v203, v47, -v175, v203
    v_add_f32 v201, v255, v201
    v_fmac_f32 v199, v48, v120
    v_permlane32_swap_b32 v203, v255
    v_fmac_f32 v199, v49, v121
    v_fmac_f32 v199, v50, v122
    v_fmac_f32 v199, v51, v123
    v_fmac_f32 v199, v52, v124
    v_fmac_f32 v199, v53, v125
    v_fmac_f32 v199, v54, v126
    v_fmac_f32 v199, v55, v127
    v_add_f32 v255, v203, v255
    v_mul_f32 v197, v56, v168
    v_fmac_f32 v197, v57, v169
    v_fmac_f32 v197, v58, v170
    v_fmac_f32 v197, v59, v171
    v_fmac_f32 v197, v60, v172
    v_fmac_f32 v197, v61, v173
    v_fmac_f32 v197, v62, v174
    v_fmac_f32 v197, v63, v175
    s_nop 1
    v_permlane32_swap_b32 v199, v197
    v_add_f32 v197, v199, v197
    s_set_gpr_idx_on s51, gpr_idx(DST)
    s_nop 0
    v_cvt_pk_bf16_f32 v207, v200, v201
    v_cvt_pk_bf16_f32 v209, v254, v255
    v_cvt_pk_bf16_f32 v208, v196, v197
    s_set_gpr_idx_off
    s_add_u32 s50, s50, 1
    s_add_u32 s51, s51, 6
    s_cmp_ge_u32 s50, 4
    s_cbranch_scc1 LAST0
    s_add_u32 s53, s53, 4
    s_xor_b32 s66, s53, s20
    s_bitcmp1_b32 s66, 2
    s_setprio 1
    s_cbranch_scc1 PRIO_7
    s_setprio 0
PRIO_7:
    s_cmp_eq_u32 s52, 4
    s_cbranch_scc1 ITEM_0_4
    s_cmp_eq_u32 s52, 5
    s_cbranch_scc1 ITEM_0_5
    s_cmp_eq_u32 s52, 3
    s_cbranch_scc1 ITEM_0_3
    s_cmp_eq_u32 s52, 6
    s_cbranch_scc1 ITEM_0_6
    s_cmp_eq_u32 s52, 8
    s_cbranch_scc1 ITEM_0_8
    s_branch ITEM_0_2
.p2align 6
ITEM_0_6:
    s_mov_b64 exec, s[54:55]
    ds_read_u16_d16_hi v243, v250 offset:128
    s_mov_b64 exec, -1
    ds_read_b64_tr_b16 v[72:73], v249 offset:512
    ds_read_b64_tr_b16 v[76:77], v249 offset:576
    ds_read_b64_tr_b16 v[74:75], v249 offset:768
    ds_read_b64_tr_b16 v[78:79], v249 offset:832
    ds_read_b64_tr_b16 v[80:81], v249 offset:1024
    ds_read_b64_tr_b16 v[84:85], v249 offset:1088
    ds_read_b64_tr_b16 v[82:83], v249 offset:1280
    ds_read_b64_tr_b16 v[86:87], v249 offset:1344
    s_waitcnt lgkmcnt(9)
    v_mul_f32_dpp v196, v242, v64 row_newbcast:0 row_mask:0xf bank_mask:0xf
    v_mul_f32_dpp v197, v242, v65 row_newbcast:1 row_mask:0xf bank_mask:0xf
    v_mul_f32_dpp v198, v242, v64 row_newbcast:8 row_mask:0xf bank_mask:0xf
    v_mul_f32_dpp v199, v242, v65 row_newbcast:9 row_mask:0xf bank_mask:0xf
    v_mul_f32_dpp v200, v242, v68 row_newbcast:2 row_mask:0xf bank_mask:0xf
    v_mul_f32_dpp v201, v242, v69 row_newbcast:3 row_mask:0xf bank_mask:0xf
    v_mul_f32_dpp v202, v242, v68 row_newbcast:10 row_mask:0xf bank_mask:0xf
    v_mul_f32_dpp v203, v242, v69 row_newbcast:11 row_mask:0xf bank_mask:0xf
    v_cvt_pk_bf16_f32 v64, v196, v197
    v_cvt_pk_bf16_f32 v68, v198, v199
    v_cvt_pk_bf16_f32 v65, v200, v201
    v_cvt_pk_bf16_f32 v69, v202, v203
    v_mul_f32_dpp v196, v242, v66 row_newbcast:4 row_mask:0xf bank_mask:0xf
    v_mul_f32_dpp v197, v242, v67 row_newbcast:5 row_mask:0xf bank_mask:0xf
    v_mul_f32_dpp v198, v242, v66 row_newbcast:12 row_mask:0xf bank_mask:0xf
    v_mul_f32_dpp v199, v242, v67 row_newbcast:13 row_mask:0xf bank_mask:0xf
    v_mul_f32_dpp v200, v242, v70 row_newbcast:6 row_mask:0xf bank_mask:0xf
    v_mul_f32_dpp v201, v242, v71 row_newbcast:7 row_mask:0xf bank_mask:0xf
    v_mul_f32_dpp v202, v242, v70 row_newbcast:14 row_mask:0xf bank_mask:0xf
    v_mul_f32_dpp v203, v242, v71 row_newbcast:15 row_mask:0xf bank_mask:0xf
    v_cvt_pk_bf16_f32 v66, v196, v197
    v_cvt_pk_bf16_f32 v70, v198, v199
    v_cvt_pk_bf16_f32 v67, v200, v201
    v_cvt_pk_bf16_f32 v71, v202, v203
    s_mov_b64 exec, s[54:55]
    ds_read_u16_d16_hi v242, v250 offset:256
    s_mov_b64 exec, -1
    s_waitcnt vmcnt(4) lgkmcnt(5)
    v_mfma_f32_32x32x16_bf16 v[0:15], v[64:67], v[176:179], 0
    v_mul_f32_dpp v196, v243, v72 row_newbcast:0 row_mask:0xf bank_mask:0xf
    v_mul_f32_dpp v197, v243, v73 row_newbcast:1 row_mask:0xf bank_mask:0xf
    v_mul_f32_dpp v198, v243, v72 row_newbcast:8 row_mask:0xf bank_mask:0xf
    v_mul_f32_dpp v199, v243, v73 row_newbcast:9 row_mask:0xf bank_mask:0xf
    v_mul_f32_dpp v200, v243, v76 row_newbcast:2 row_mask:0xf bank_mask:0xf
    v_mul_f32_dpp v201, v243, v77 row_newbcast:3 row_mask:0xf bank_mask:0xf
    v_mul_f32_dpp v202, v243, v76 row_newbcast:10 row_mask:0xf bank_mask:0xf
    v_mul_f32_dpp v203, v243, v77 row_newbcast:11 row_mask:0xf bank_mask:0xf
    v_cvt_pk_bf16_f32 v72, v196, v197
    v_cvt_pk_bf16_f32 v76, v198, v199
    v_cvt_pk_bf16_f32 v73, v200, v201
    v_cvt_pk_bf16_f32 v77, v202, v203
    s_add_u32 m0, s21, 0
    v_mfma_f32_32x32x16_bf16 v[16:31], v[68:71], v[176:179], 0
    buffer_load_dwordx4 v236, s[4:7], s35 offen  lds
    buffer_load_dwordx4 v237, s[8:11], s35 offen offset:1024  lds
    ds_read_b64_tr_b16 v[176:177], v244 offset:2048
    ds_read_b64_tr_b16 v[178:179], v244 offset:3072
    ds_read_b64_tr_b16 v[184:185], v245 offset:2048
    ds_read_b64_tr_b16 v[186:187], v245 offset:3072
    v_mul_f32_dpp v196, v243, v74 row_newbcast:4 row_mask:0xf bank_mask:0xf
    v_mul_f32_dpp v197, v243, v75 row_newbcast:5 row_mask:0xf bank_mask:0xf
    v_mul_f32_dpp v198, v243, v74 row_newbcast:12 row_mask:0xf bank_mask:0xf
    v_mul_f32_dpp v199, v243, v75 row_newbcast:13 row_mask:0xf bank_mask:0xf
    v_mul_f32_dpp v200, v243, v78 row_newbcast:6 row_mask:0xf bank_mask:0xf
    v_mul_f32_dpp v201, v243, v79 row_newbcast:7 row_mask:0xf bank_mask:0xf
    v_mul_f32_dpp v202, v243, v78 row_newbcast:14 row_mask:0xf bank_mask:0xf
    v_mul_f32_dpp v203, v243, v79 row_newbcast:15 row_mask:0xf bank_mask:0xf
    v_cvt_pk_bf16_f32 v74, v196, v197
    v_cvt_pk_bf16_f32 v78, v198, v199
    v_cvt_pk_bf16_f32 v75, v200, v201
    v_cvt_pk_bf16_f32 v79, v202, v203
    s_nop 0
    s_waitcnt vmcnt(4) lgkmcnt(0)
    v_mfma_f32_32x32x16_bf16 v[0:15], v[72:75], v[176:179], v[0:15]
    v_mul_f32_dpp v196, v242, v80 row_newbcast:0 row_mask:0xf bank_mask:0xf
    v_mul_f32_dpp v197, v242, v81 row_newbcast:1 row_mask:0xf bank_mask:0xf
    v_mul_f32_dpp v198, v242, v80 row_newbcast:8 row_mask:0xf bank_mask:0xf
    v_mul_f32_dpp v199, v242, v81 row_newbcast:9 row_mask:0xf bank_mask:0xf
    v_mul_f32_dpp v200, v242, v84 row_newbcast:2 row_mask:0xf bank_mask:0xf
    v_mul_f32_dpp v201, v242, v85 row_newbcast:3 row_mask:0xf bank_mask:0xf
    v_mul_f32_dpp v202, v242, v84 row_newbcast:10 row_mask:0xf bank_mask:0xf
    v_mul_f32_dpp v203, v242, v85 row_newbcast:11 row_mask:0xf bank_mask:0xf
    v_cvt_pk_bf16_f32 v80, v196, v197
    v_cvt_pk_bf16_f32 v84, v198, v199
    v_cvt_pk_bf16_f32 v81, v200, v201
    v_cvt_pk_bf16_f32 v85, v202, v203
    s_add_u32 m0, s21, 2048
    v_mfma_f32_32x32x16_bf16 v[16:31], v[76:79], v[176:179], v[16:31]
    buffer_load_dwordx4 v238, s[4:7], s35 offen  lds
    buffer_load_dwordx4 v239, s[8:11], s35 offen offset:1024  lds
    ds_read_b64_tr_b16 v[176:177], v244 offset:4096
    ds_read_b64_tr_b16 v[178:179], v244 offset:5120
    ds_read_b64_tr_b16 v[188:189], v245 offset:4096
    ds_read_b64_tr_b16 v[190:191], v245 offset:5120
    v_mul_f32_dpp v196, v242, v82 row_newbcast:4 row_mask:0xf bank_mask:0xf
    v_mul_f32_dpp v197, v242, v83 row_newbcast:5 row_mask:0xf bank_mask:0xf
    v_mul_f32_dpp v198, v242, v82 row_newbcast:12 row_mask:0xf bank_mask:0xf
    v_mul_f32_dpp v199, v242, v83 row_newbcast:13 row_mask:0xf bank_mask:0xf
    v_mul_f32_dpp v200, v242, v86 row_newbcast:6 row_mask:0xf bank_mask:0xf
    v_mul_f32_dpp v201, v242, v87 row_newbcast:7 row_mask:0xf bank_mask:0xf
    v_mul_f32_dpp v202, v242, v86 row_newbcast:14 row_mask:0xf bank_mask:0xf
    v_mul_f32_dpp v203, v242, v87 row_newbcast:15 row_mask:0xf bank_mask:0xf
    v_cvt_pk_bf16_f32 v82, v196, v197
    v_cvt_pk_bf16_f32 v86, v198, v199
    v_cvt_pk_bf16_f32 v83, v200, v201
    v_cvt_pk_bf16_f32 v87, v202, v203
    s_nop 0
    s_waitcnt lgkmcnt(0)
    v_mfma_f32_32x32x16_bf16 v[0:15], v[80:83], v[176:179], v[0:15]
    s_add_u32 m0, s21, 4096
    v_mfma_f32_32x32x16_bf16 v[16:31], v[84:87], v[176:179], v[16:31]
    buffer_load_dwordx4 v234, s[4:7], s36 offen  lds
    buffer_load_dwordx4 v235, s[8:11], s36 offen offset:1024  lds
    s_mov_b32 m0, s50
    s_nop 0
    s_movrels_b32 s71, s23
    s_bfe_u32 s46, s71, 0x30012
    s_mov_b32 m0, s46
    s_and_b32 s66, s71, 0x3ffff
    s_movrels_b32 s68, s57
    s_movrels_b32 s69, s61
    s_sub_u32 s48, s66, s47
    s_mov_b32 s47, s66
    s_lshr_b32 s52, s71, 28
    s_lshl_b32 s67, s46, 9
    s_add_u32 s66, s66, s67
    s_sub_u32 s49, s66, s42
    s_mov_b32 s42, s66
    s_bfe_u32 s66, s68, 655360
    s_add_u32 s43, s42, s66
    s_bfe_u32 s39, s69, 655360
    s_bfe_u32 s66, s68, 655370
    s_add_u32 s44, s42, s66
    s_bfe_u32 s40, s69, 655370
    s_bfe_u32 s66, s68, 655380
    s_add_u32 s45, s42, s66
    s_bfe_u32 s41, s69, 655380
    s_and_b32 s66, s46, s33
    s_cselect_b32 s72, -1, 1
    s_cselect_b32 s76, s47, 163712
    s_cmp_ge_u32 s66, 2
    s_cselect_b32 s73, -1, 0
    s_add_u32 s77, s47, 1024
    s_cmp_ge_u32 s66, 4
    s_cselect_b32 s75, -1, 0
    s_cmp_ge_u32 s66, 3
    s_cselect_b32 s74, -1, 1
    s_cselect_b32 s77, s77, 163712
    v_add_u32 v252, s45, v247
    ds_read_u16 v240, v252
    ds_read_u16 v241, v252 offset:64
    v_mfma_f32_32x32x16_bf16 v[32:47], v[64:67], v[180:183], 0
    v_mul_f32 v196, v0, v96
    v_fmac_f32 v196, v1, v97
    v_fmac_f32 v196, v2, v98
    v_fmac_f32 v196, v3, v99
    v_fmac_f32 v196, v4, v100
    v_fmac_f32 v196, v5, v101
    v_fmac_f32 v196, v6, v102
    v_mfma_f32_32x32x16_bf16 v[48:63], v[68:71], v[180:183], 0
    v_fmac_f32 v196, v7, v103
    v_mul_f32 v198, v8, v128
    v_fmac_f32 v198, v9, v129
    v_fmac_f32 v198, v10, v130
    v_fmac_f32 v198, v11, v131
    v_fmac_f32 v198, v12, v132
    v_mfma_f32_32x32x16_bf16 v[32:47], v[72:75], v[184:187], v[32:47]
    v_fmac_f32 v198, v13, v133
    v_fmac_f32 v198, v14, v134
    v_fmac_f32 v198, v15, v135
    v_mul_f32 v200, v16, v128
    v_fmac_f32 v200, v17, v129
    v_permlane32_swap_b32 v196, v198
    v_mfma_f32_32x32x16_bf16 v[48:63], v[76:79], v[184:187], v[48:63]
    s_waitcnt vmcnt(6)
    ds_read_b64_tr_b16 v[176:177], v244 offset:6144
    ds_read_b64_tr_b16 v[178:179], v244 offset:7168
    ds_read_b64_tr_b16 v[180:181], v245 offset:6144
    ds_read_b64_tr_b16 v[182:183], v245 offset:7168
    v_fmac_f32 v200, v18, v130
    v_fmac_f32 v200, v19, v131
    v_fmac_f32 v200, v20, v132
    v_fmac_f32 v200, v21, v133
    v_fmac_f32 v200, v22, v134
    v_fmac_f32 v200, v23, v135
    v_mfma_f32_32x32x16_bf16 v[32:47], v[80:83], v[188:191], v[32:47]
    v_add_f32 v198, v196, v198
    v_mul_f32_e64 v202, v24, -v128
    v_fma_f32 v202, v25, -v129, v202
    v_fma_f32 v202, v26, -v130, v202
    v_fma_f32 v202, v27, -v131, v202
    v_fma_f32 v202, v28, -v132, v202
    v_mfma_f32_32x32x16_bf16 v[48:63], v[84:87], v[188:191], v[48:63]
    v_fma_f32 v202, v29, -v133, v202
    v_fma_f32 v202, v30, -v134, v202
    v_fma_f32 v202, v31, -v135, v202
    s_nop 1
    v_permlane32_swap_b32 v200, v202
    v_add_f32 v202, v200, v202
    s_waitcnt vmcnt(4) lgkmcnt(0)
    v_mfma_f32_32x32x16_bf16 v[0:15], v[64:67], v[176:179], 0
    v_mul_f32 v197, v32, v104
    v_fmac_f32 v197, v33, v105
    v_fmac_f32 v197, v34, v106
    v_fmac_f32 v197, v35, v107
    v_fmac_f32 v197, v36, v108
    v_fmac_f32 v197, v37, v109
    v_fmac_f32 v197, v38, v110
    s_add_u32 m0, s21, 6144
    v_mfma_f32_32x32x16_bf16 v[16:31], v[68:71], v[176:179], 0
    buffer_load_dwordx4 v236, s[4:7], s36 offen  lds
    buffer_load_dwordx4 v237, s[8:11], s36 offen offset:1024  lds
    ds_read_b64_tr_b16 v[176:177], v244 offset:0
    ds_read_b64_tr_b16 v[178:179], v244 offset:1024
    ds_read_b64_tr_b16 v[184:185], v245 offset:0
    ds_read_b64_tr_b16 v[186:187], v245 offset:1024
    v_fmac_f32 v197, v39, v111
    v_mul_f32 v199, v40, v136
    v_fmac_f32 v199, v41, v137
    v_fmac_f32 v199, v42, v138
    v_fmac_f32 v199, v43, v139
    v_fmac_f32 v199, v44, v140
    v_fmac_f32 v199, v45, v141
    s_waitcnt vmcnt(4) lgkmcnt(0)
    v_mfma_f32_32x32x16_bf16 v[0:15], v[72:75], v[176:179], v[0:15]
    v_fmac_f32 v199, v46, v142
    v_fmac_f32 v199, v47, v143
    v_mul_f32 v201, v48, v136
    v_fmac_f32 v201, v49, v137
    v_permlane32_swap_b32 v197, v199
    v_fmac_f32 v201, v50, v138
    v_fmac_f32 v201, v51, v139
    s_add_u32 m0, s21, 0
    v_mfma_f32_32x32x16_bf16 v[16:31], v[76:79], v[176:179], v[16:31]
    buffer_load_dwordx4 v238, s[4:7], s36 offen  lds
    buffer_load_dwordx4 v239, s[8:11], s36 offen offset:1024  lds
    ds_read_b64_tr_b16 v[176:177], v244 offset:2048
    ds_read_b64_tr_b16 v[178:179], v244 offset:3072
    ds_read_b64_tr_b16 v[188:189], v245 offset:2048
    ds_read_b64_tr_b16 v[190:191], v245 offset:3072
    v_fmac_f32 v201, v52, v140
    v_fmac_f32 v201, v53, v141
    v_fmac_f32 v201, v54, v142
    v_fmac_f32 v201, v55, v143
    v_add_f32 v199, v197, v199
    v_mul_f32_e64 v203, v56, -v136
    v_fma_f32 v203, v57, -v137, v203
    s_waitcnt lgkmcnt(0)
    v_mfma_f32_32x32x16_bf16 v[0:15], v[80:83], v[176:179], v[0:15]
    v_fma_f32 v203, v58, -v138, v203
    v_fma_f32 v203, v59, -v139, v203
    v_fma_f32 v203, v60, -v140, v203
    v_fma_f32 v203, v61, -v141, v203
    v_fma_f32 v203, v62, -v142, v203
    v_fma_f32 v203, v63, -v143, v203
    s_nop 1
    s_add_u32 m0, s21, 2048
    v_mfma_f32_32x32x16_bf16 v[16:31], v[84:87], v[176:179], v[16:31]
    buffer_load_dwordx4 v234, s[4:7], s37 offen  lds
    buffer_load_dwordx4 v235, s[8:11], s37 offen offset:1024  lds
    v_add_u32 v252, s42, v247
    ds_read_u16 v234, v252
    ds_read_u16 v235, v252 offset:64
    v_permlane32_swap_b32 v201, v203
    v_add_f32 v203, v201, v203
    s_set_gpr_idx_on s51, gpr_idx(DST)
    s_nop 0
    v_cvt_pk_bf16_f32 v204, v198, v199
    v_cvt_pk_bf16_f32 v205, v202, v203
    s_set_gpr_idx_off
    v_mfma_f32_32x32x16_bf16 v[32:47], v[64:67], v[180:183], 0
    v_mul_f32 v196, v0, v144
    v_fmac_f32 v196, v1, v145
    v_fmac_f32 v196, v2, v146
    v_fmac_f32 v196, v3, v147
    v_fmac_f32 v196, v4, v148
    v_fmac_f32 v196, v5, v149
    v_mfma_f32_32x32x16_bf16 v[48:63], v[68:71], v[180:183], 0
    v_add_u32 v253, s47, v248
    ds_read_b32 v254, v253
    ds_read_b32 v255, v253 offset:256
    v_fmac_f32 v196, v6, v150
    v_fmac_f32 v196, v7, v151
    v_mul_f32 v198, v8, v112
    v_fmac_f32 v198, v9, v113
    v_fmac_f32 v198, v10, v114
    v_mfma_f32_32x32x16_bf16 v[32:47], v[72:75], v[184:187], v[32:47]
    v_fmac_f32 v198, v11, v115
    v_fmac_f32 v198, v12, v116
    v_fmac_f32 v198, v13, v117
    v_fmac_f32 v198, v14, v118
    v_fmac_f32 v198, v15, v119
    v_mfma_f32_32x32x16_bf16 v[48:63], v[76:79], v[184:187], v[48:63]
    s_waitcnt vmcnt(6)
    ds_read_b64_tr_b16 v[176:177], v244 offset:4096
    ds_read_b64_tr_b16 v[178:179], v244 offset:5120
    ds_read_b64_tr_b16 v[180:181], v245 offset:4096
    ds_read_b64_tr_b16 v[182:183], v245 offset:5120
    v_mul_f32_e64 v200, v16, -v160
    v_fma_f32 v200, v17, -v161, v200
    v_fma_f32 v200, v18, -v162, v200
    v_fma_f32 v200, v19, -v163, v200
    v_fma_f32 v200, v20, -v164, v200
    v_fma_f32 v200, v21, -v165, v200
    v_mfma_f32_32x32x16_bf16 v[32:47], v[80:83], v[188:191], v[32:47]
    v_fma_f32 v200, v22, -v166, v200
    v_fma_f32 v200, v23, -v167, v200
    v_mul_f32_e64 v202, v24, -v160
    v_fma_f32 v202, v25, -v161, v202
    v_fma_f32 v202, v26, -v162, v202
    v_mfma_f32_32x32x16_bf16 v[48:63], v[84:87], v[188:191], v[48:63]
    v_fma_f32 v202, v27, -v163, v202
    v_fma_f32 v202, v28, -v164, v202
    v_fma_f32 v202, v29, -v165, v202
    v_fma_f32 v202, v30, -v166, v202
    v_fma_f32 v202, v31, -v167, v202
    s_waitcnt vmcnt(4) lgkmcnt(0)
    v_mfma_f32_32x32x16_bf16 v[0:15], v[64:67], v[176:179], 0
    v_mul_f32 v197, v32, v152
    v_fmac_f32 v197, v33, v153
    v_fmac_f32 v197, v34, v154
    v_fmac_f32 v197, v35, v155
    v_fmac_f32 v197, v36, v156
    v_fmac_f32 v197, v37, v157
    s_add_u32 m0, s21, 4096
    v_mfma_f32_32x32x16_bf16 v[16:31], v[68:71], v[176:179], 0
    buffer_load_dwordx4 v236, s[4:7], s37 offen  lds
    buffer_load_dwordx4 v237, s[8:11], s37 offen offset:1024  lds
    ds_read_b64_tr_b16 v[176:177], v244 offset:6144
    ds_read_b64_tr_b16 v[178:179], v244 offset:7168
    ds_read_b64_tr_b16 v[184:185], v245 offset:6144
    ds_read_b64_tr_b16 v[186:187], v245 offset:7168
    v_add_u32 v252, s43, v247
    ds_read_u16 v236, v252
    ds_read_u16 v237, v252 offset:64
    v_fmac_f32 v197, v38, v158
    v_fmac_f32 v197, v39, v159
    v_mul_f32 v199, v40, v120
    v_fmac_f32 v199, v41, v121
    v_fmac_f32 v199, v42, v122
    s_waitcnt vmcnt(4) lgkmcnt(2)
    v_mfma_f32_32x32x16_bf16 v[0:15], v[72:75], v[176:179], v[0:15]
    v_fmac_f32 v199, v43, v123
    v_fmac_f32 v199, v44, v124
    v_fmac_f32 v199, v45, v125
    v_fmac_f32 v199, v46, v126
    v_fmac_f32 v199, v47, v127
    s_add_u32 m0, s21, 6144
    v_mfma_f32_32x32x16_bf16 v[16:31], v[76:79], v[176:179], v[16:31]
    buffer_load_dwordx4 v238, s[4:7], s37 offen  lds
    buffer_load_dwordx4 v239, s[8:11], s37 offen offset:1024  lds
    ds_read_b64_tr_b16 v[176:177], v244 offset:0
    ds_read_b64_tr_b16 v[178:179], v244 offset:1024
    ds_read_b64_tr_b16 v[188:189], v245 offset:0
    ds_read_b64_tr_b16 v[190:191], v245 offset:1024
    v_add_u32 v252, s44, v247
    ds_read_u16 v238, v252
    ds_read_u16 v239, v252 offset:64
    v_mul_f32_e64 v201, v48, -v168
    v_fma_f32 v201, v49, -v169, v201
    v_fma_f32 v201, v50, -v170, v201
    v_fma_f32 v201, v51, -v171, v201
    v_fma_f32 v201, v52, -v172, v201
    v_fma_f32 v201, v53, -v173, v201
    s_waitcnt lgkmcnt(2)
    v_mfma_f32_32x32x16_bf16 v[0:15], v[80:83], v[176:179], v[0:15]
    v_fma_f32 v201, v54, -v174, v201
    v_fma_f32 v201, v55, -v175, v201
    v_mul_f32_e64 v203, v56, -v168
    v_fma_f32 v203, v57, -v169, v203
    v_fma_f32 v203, v58, -v170, v203
    s_add_u32 m0, s21, 0
    v_mfma_f32_32x32x16_bf16 v[16:31], v[84:87], v[176:179], v[16:31]
    v_lshl_add_u32 v234, v234, 10, v246
    v_lshl_add_u32 v235, v235, 10, v246
    buffer_load_dwordx4 v234, s[4:7], s38 offen  lds
    buffer_load_dwordx4 v235, s[8:11], s38 offen offset:1024  lds
    s_mov_b32 m0, s76
    s_mov_b64 exec, s[72:73]
    buffer_load_dwordx4 v254, s[12:15], 0 offen  lds
    s_mov_b32 m0, s77
    s_mov_b64 exec, s[74:75]
    buffer_load_dwordx4 v255, s[12:15], 0 offen  lds
    s_mov_b64 exec, -1
    v_fma_f32 v203, v59, -v171, v203
    v_fma_f32 v203, v60, -v172, v203
    v_fma_f32 v203, v61, -v173, v203
    v_fma_f32 v203, v62, -v174, v203
    v_fma_f32 v203, v63, -v175, v203
    v_mfma_f32_32x32x16_bf16 v[32:47], v[64:67], v[180:183], 0
    v_mul_f32 v254, v0, v144
    v_fmac_f32 v254, v1, v145
    v_fmac_f32 v254, v2, v146
    v_mfma_f32_32x32x16_bf16 v[48:63], v[68:71], v[180:183], 0
    ds_swizzle_b32 v68, v68 offset:0x401F
    ds_swizzle_b32 v69, v69 offset:0x401F
    ds_swizzle_b32 v70, v70 offset:0x401F
    ds_swizzle_b32 v71, v71 offset:0x401F
    v_fmac_f32 v254, v3, v147
    v_fmac_f32 v254, v4, v148
    v_fmac_f32 v254, v5, v149
    v_mfma_f32_32x32x16_bf16 v[32:47], v[72:75], v[184:187], v[32:47]
    v_fmac_f32 v254, v6, v150
    v_fmac_f32 v254, v7, v151
    v_fmac_f32 v200, v8, v160
    v_mfma_f32_32x32x16_bf16 v[48:63], v[76:79], v[184:187], v[48:63]
    ds_swizzle_b32 v76, v76 offset:0x401F
    ds_swizzle_b32 v77, v77 offset:0x401F
    ds_swizzle_b32 v78, v78 offset:0x401F
    ds_swizzle_b32 v79, v79 offset:0x401F
    s_waitcnt vmcnt(8)
    ds_read_b64_tr_b16 v[176:177], v244 offset:2048
    ds_read_b64_tr_b16 v[178:179], v244 offset:3072
    ds_read_b64_tr_b16 v[180:181], v245 offset:2048
    ds_read_b64_tr_b16 v[182:183], v245 offset:3072
    v_fmac_f32 v200, v9, v161
    v_permlane32_swap_b32 v196, v254
    v_fmac_f32 v200, v10, v162
    v_mfma_f32_32x32x16_bf16 v[32:47], v[80:83], v[188:191], v[32:47]
    v_fmac_f32 v200, v11, v163
    v_fmac_f32 v200, v12, v164
    v_fmac_f32 v200, v13, v165
    v_mfma_f32_32x32x16_bf16 v[48:63], v[84:87], v[188:191], v[48:63]
    ds_swizzle_b32 v84, v84 offset:0x401F
    ds_swizzle_b32 v85, v85 offset:0x401F
    ds_swizzle_b32 v86, v86 offset:0x401F
    ds_swizzle_b32 v87, v87 offset:0x401F
    v_fmac_f32 v200, v14, v166
    v_fmac_f32 v200, v15, v167
    v_add_f32 v254, v196, v254
    s_waitcnt lgkmcnt(8)
    s_mov_b64 exec, s[56:57]
    v_xor_b32 v68, 0x80008000, v68
    v_xor_b32 v69, 0x80008000, v69
    v_xor_b32 v70, 0x80008000, v70
    v_xor_b32 v71, 0x80008000, v71
    v_xor_b32 v76, 0x80008000, v76
    v_xor_b32 v77, 0x80008000, v77
    v_xor_b32 v78, 0x80008000, v78
    v_xor_b32 v79, 0x80008000, v79
    s_mov_b64 exec, -1
    s_waitcnt vmcnt(6) lgkmcnt(4)
    v_mfma_f32_32x32x16_bf16 v[0:15], v[64:67], v[176:179], 0
    v_mul_f32 v255, v32, v152
    v_fmac_f32 v255, v33, v153
    v_fmac_f32 v255, v34, v154
    v_fmac_f32 v255, v35, v155
    s_add_u32 m0, s21, 2048
    v_mfma_f32_32x32x16_bf16 v[16:31], v[68:71], v[176:179], v[16:31]
    v_lshl_add_u32 v236, v236, 10, v246
    v_lshl_add_u32 v237, v237, 10, v246
    buffer_load_dwordx4 v236, s[4:7], s39 offen  lds
    buffer_load_dwordx4 v237, s[8:11], s39 offen offset:1024  lds
    ds_read_b64_tr_b16 v[176:177], v244 offset:4096
    ds_read_b64_tr_b16 v[178:179], v244 offset:5120
    ds_read_b64_tr_b16 v[184:185], v245 offset:4096
    ds_read_b64_tr_b16 v[186:187], v245 offset:5120
    v_fmac_f32 v255, v36, v156
    v_fmac_f32 v255, v37, v157
    v_fmac_f32 v255, v38, v158
    v_fmac_f32 v255, v39, v159
    s_waitcnt vmcnt(6) lgkmcnt(0)
    v_mfma_f32_32x32x16_bf16 v[0:15], v[72:75], v[176:179], v[0:15]
    v_fmac_f32 v201, v40, v168
    v_fmac_f32 v201, v41, v169
    v_permlane32_swap_b32 v197, v255
    s_add_u32 m0, s21, 4096
    v_mfma_f32_32x32x16_bf16 v[16:31], v[76:79], v[176:179], v[16:31]
    v_lshl_add_u32 v238, v238, 10, v246
    v_lshl_add_u32 v239, v239, 10, v246
    buffer_load_dwordx4 v238, s[4:7], s40 offen  lds
    buffer_load_dwordx4 v239, s[8:11], s40 offen offset:1024  lds
    ds_read_b64_tr_b16 v[176:177], v244 offset:6144
    ds_read_b64_tr_b16 v[178:179], v244 offset:7168
    ds_read_b64_tr_b16 v[188:189], v245 offset:6144
    ds_read_b64_tr_b16 v[190:191], v245 offset:7168
    v_fmac_f32 v201, v42, v170
    v_fmac_f32 v201, v43, v171
    v_fmac_f32 v201, v44, v172
    v_fmac_f32 v201, v45, v173
    s_waitcnt lgkmcnt(0)
    s_mov_b64 exec, s[56:57]
    v_xor_b32 v84, 0x80008000, v84
    v_xor_b32 v85, 0x80008000, v85
    v_xor_b32 v86, 0x80008000, v86
    v_xor_b32 v87, 0x80008000, v87
    s_mov_b64 exec, -1
    v_mfma_f32_32x32x16_bf16 v[0:15], v[80:83], v[176:179], v[0:15]
    v_fmac_f32 v201, v46, v174
    v_fmac_f32 v201, v47, v175
    v_add_f32 v255, v197, v255
    s_set_gpr_idx_on s51, gpr_idx(DST)
    s_nop 0
    v_cvt_pk_bf16_f32 v206, v254, v255
    s_set_gpr_idx_off
    s_add_u32 m0, s21, 6144
    v_mfma_f32_32x32x16_bf16 v[16:31], v[84:87], v[176:179], v[16:31]
    v_lshl_add_u32 v240, v240, 10, v246
    v_lshl_add_u32 v241, v241, 10, v246
    buffer_load_dwordx4 v240, s[4:7], s41 offen  lds
    buffer_load_dwordx4 v241, s[8:11], s41 offen offset:1024  lds
    v_mfma_f32_32x32x16_bf16 v[32:47], v[64:67], v[180:183], 0
    v_mul_f32 v254, v0, v144
    v_fmac_f32 v254, v1, v145
    v_fmac_f32 v254, v2, v146
    v_fmac_f32 v254, v3, v147
    v_fmac_f32 v254, v4, v148
    v_fmac_f32 v254, v5, v149
    v_fmac_f32 v254, v6, v150
    v_mfma_f32_32x32x16_bf16 v[48:63], v[68:71], v[180:183], v[48:63]
    v_fmac_f32 v254, v7, v151
    v_fma_f32 v202, v8, -v160, v202
    v_fma_f32 v202, v9, -v161, v202
    v_permlane32_swap_b32 v254, v200
    v_fma_f32 v202, v10, -v162, v202
    v_fma_f32 v202, v11, -v163, v202
    v_mfma_f32_32x32x16_bf16 v[32:47], v[72:75], v[184:187], v[32:47]
    v_fma_f32 v202, v12, -v164, v202
    v_fma_f32 v202, v13, -v165, v202
    v_fma_f32 v202, v14, -v166, v202
    v_fma_f32 v202, v15, -v167, v202
    v_add_f32 v200, v254, v200
    v_fmac_f32 v198, v16, v112
    v_permlane32_swap_b32 v202, v254
    v_mfma_f32_32x32x16_bf16 v[48:63], v[76:79], v[184:187], v[48:63]
    s_waitcnt vmcnt(8)
    ds_read_b64_tr_b16 v[176:177], v244 offset:0
    ds_read_b64_tr_b16 v[178:179], v244 offset:1024
    ds_read_b64_tr_b16 v[180:181], v245 offset:0
    ds_read_b64_tr_b16 v[182:183], v245 offset:1024
    v_fmac_f32 v198, v17, v113
    v_fmac_f32 v198, v18, v114
    v_fmac_f32 v198, v19, v115
    v_fmac_f32 v198, v20, v116
    v_fmac_f32 v198, v21, v117
    v_fmac_f32 v198, v22, v118
    v_mfma_f32_32x32x16_bf16 v[32:47], v[80:83], v[188:191], v[32:47]
    v_fmac_f32 v198, v23, v119
    v_add_f32 v254, v202, v254
    v_mul_f32 v196, v24, v160
    v_fmac_f32 v196, v25, v161
    v_fmac_f32 v196, v26, v162
    v_fmac_f32 v196, v27, v163
    v_fmac_f32 v196, v28, v164
    v_mfma_f32_32x32x16_bf16 v[48:63], v[84:87], v[188:191], v[48:63]
    v_add_u32 v249, s48, v249
    v_add_u32 v250, s49, v250
    s_waitcnt vmcnt(6)
    ds_read_b64_tr_b16 v[64:65], v249 offset:0
    ds_read_b64_tr_b16 v[68:69], v249 offset:64
    ds_read_b64_tr_b16 v[66:67], v249 offset:256
    ds_read_b64_tr_b16 v[70:71], v249 offset:320
    s_mov_b64 exec, s[54:55]
    ds_read_u16_d16_hi v242, v250 offset:0
    s_mov_b64 exec, -1
    v_fmac_f32 v196, v29, v165
    v_fmac_f32 v196, v30, v166
    v_fmac_f32 v196, v31, v167
    s_nop 1
    v_permlane32_swap_b32 v198, v196
    v_add_f32 v196, v198, v196
    v_mul_f32 v255, v32, v152
    v_fmac_f32 v255, v33, v153
    v_fmac_f32 v255, v34, v154
    v_fmac_f32 v255, v35, v155
    v_fmac_f32 v255, v36, v156
    v_fmac_f32 v255, v37, v157
    v_fmac_f32 v255, v38, v158
    v_fmac_f32 v255, v39, v159
    v_fma_f32 v203, v40, -v168, v203
    v_fma_f32 v203, v41, -v169, v203
    v_permlane32_swap_b32 v255, v201
    v_fma_f32 v203, v42, -v170, v203
    v_fma_f32 v203, v43, -v171, v203
    v_fma_f32 v203, v44, -v172, v203
    v_fma_f32 v203, v45, -v173, v203
    v_fma_f32 v203, v46, -v174, v203
    v_fma_f32 v203, v47, -v175, v203
    v_add_f32 v201, v255, v201
    v_fmac_f32 v199, v48, v120
    v_permlane32_swap_b32 v203, v255
    v_fmac_f32 v199, v49, v121
    v_fmac_f32 v199, v50, v122
    v_fmac_f32 v199, v51, v123
    v_fmac_f32 v199, v52, v124
    v_fmac_f32 v199, v53, v125
    v_fmac_f32 v199, v54, v126
    v_fmac_f32 v199, v55, v127
    v_add_f32 v255, v203, v255
    v_mul_f32 v197, v56, v168
    v_fmac_f32 v197, v57, v169
    v_fmac_f32 v197, v58, v170
    v_fmac_f32 v197, v59, v171
    v_fmac_f32 v197, v60, v172
    v_fmac_f32 v197, v61, v173
    v_fmac_f32 v197, v62, v174
    v_fmac_f32 v197, v63, v175
    s_nop 1
    v_permlane32_swap_b32 v199, v197
    v_add_f32 v197, v199, v197
    s_set_gpr_idx_on s51, gpr_idx(DST)
    s_nop 0
    v_cvt_pk_bf16_f32 v207, v200, v201
    v_cvt_pk_bf16_f32 v209, v254, v255
    v_cvt_pk_bf16_f32 v208, v196, v197
    s_set_gpr_idx_off
    s_add_u32 s50, s50, 1
    s_add_u32 s51, s51, 6
    s_cmp_ge_u32 s50, 4
    s_cbranch_scc1 LAST0
    s_add_u32 s53, s53, 4
    s_xor_b32 s66, s53, s20
    s_bitcmp1_b32 s66, 2
    s_setprio 1
    s_cbranch_scc1 PRIO_8
    s_setprio 0
PRIO_8:
    s_cmp_eq_u32 s52, 4
    s_cbranch_scc1 ITEM_0_4
    s_cmp_eq_u32 s52, 5
    s_cbranch_scc1 ITEM_0_5
    s_cmp_eq_u32 s52, 3
    s_cbranch_scc1 ITEM_0_3
    s_cmp_eq_u32 s52, 6
    s_cbranch_scc1 ITEM_0_6
    s_cmp_eq_u32 s52, 8
    s_cbranch_scc1 ITEM_0_8
    s_branch ITEM_0_2
.p2align 6
ITEM_0_8:
    s_mov_b64 exec, s[54:55]
    ds_read_u16_d16_hi v243, v250 offset:128
    s_mov_b64 exec, -1
    ds_read_b64_tr_b16 v[72:73], v249 offset:512
    ds_read_b64_tr_b16 v[76:77], v249 offset:576
    ds_read_b64_tr_b16 v[74:75], v249 offset:768
    ds_read_b64_tr_b16 v[78:79], v249 offset:832
    ds_read_b64_tr_b16 v[80:81], v249 offset:1024
    ds_read_b64_tr_b16 v[84:85], v249 offset:1088
    ds_read_b64_tr_b16 v[82:83], v249 offset:1280
    ds_read_b64_tr_b16 v[86:87], v249 offset:1344
    ds_read_b64_tr_b16 v[88:89], v249 offset:1536
    ds_read_b64_tr_b16 v[92:93], v249 offset:1600
    ds_read_b64_tr_b16 v[90:91], v249 offset:1792
    ds_read_b64_tr_b16 v[94:95], v249 offset:1856
    s_waitcnt lgkmcnt(13)
    v_mul_f32_dpp v196, v242, v64 row_newbcast:0 row_mask:0xf bank_mask:0xf
    v_mul_f32_dpp v197, v242, v65 row_newbcast:1 row_mask:0xf bank_mask:0xf
    v_mul_f32_dpp v198, v242, v64 row_newbcast:8 row_mask:0xf bank_mask:0xf
    v_mul_f32_dpp v199, v242, v65 row_newbcast:9 row_mask:0xf bank_mask:0xf
    v_mul_f32_dpp v200, v242, v68 row_newbcast:2 row_mask:0xf bank_mask:0xf
    v_mul_f32_dpp v201, v242, v69 row_newbcast:3 row_mask:0xf bank_mask:0xf
    v_mul_f32_dpp v202, v242, v68 row_newbcast:10 row_mask:0xf bank_mask:0xf
    v_mul_f32_dpp v203, v242, v69 row_newbcast:11 row_mask:0xf bank_mask:0xf
    v_cvt_pk_bf16_f32 v64, v196, v197
    v_cvt_pk_bf16_f32 v68, v198, v199
    v_cvt_pk_bf16_f32 v65, v200, v201
    v_cvt_pk_bf16_f32 v69, v202, v203
    v_mul_f32_dpp v196, v242, v66 row_newbcast:4 row_mask:0xf bank_mask:0xf
    v_mul_f32_dpp v197, v242, v67 row_newbcast:5 row_mask:0xf bank_mask:0xf
    v_mul_f32_dpp v198, v242, v66 row_newbcast:12 row_mask:0xf bank_mask:0xf
    v_mul_f32_dpp v199, v242, v67 row_newbcast:13 row_mask:0xf bank_mask:0xf
    v_mul_f32_dpp v200, v242, v70 row_newbcast:6 row_mask:0xf bank_mask:0xf
    v_mul_f32_dpp v201, v242, v71 row_newbcast:7 row_mask:0xf bank_mask:0xf
    v_mul_f32_dpp v202, v242, v70 row_newbcast:14 row_mask:0xf bank_mask:0xf
    v_mul_f32_dpp v203, v242, v71 row_newbcast:15 row_mask:0xf bank_mask:0xf
    v_cvt_pk_bf16_f32 v66, v196, v197
    v_cvt_pk_bf16_f32 v70, v198, v199
    v_cvt_pk_bf16_f32 v67, v200, v201
    v_cvt_pk_bf16_f32 v71, v202, v203
    s_mov_b64 exec, s[54:55]
    ds_read_u16_d16_hi v242, v250 offset:256
    s_mov_b64 exec, -1
    s_waitcnt vmcnt(4) lgkmcnt(9)
    v_mfma_f32_32x32x16_bf16 v[0:15], v[64:67], v[176:179], 0
    v_mul_f32_dpp v196, v243, v72 row_newbcast:0 row_mask:0xf bank_mask:0xf
    v_mul_f32_dpp v197, v243, v73 row_newbcast:1 row_mask:0xf bank_mask:0xf
    v_mul_f32_dpp v198, v243, v72 row_newbcast:8 row_mask:0xf bank_mask:0xf
    v_mul_f32_dpp v199, v243, v73 row_newbcast:9 row_mask:0xf bank_mask:0xf
    v_mul_f32_dpp v200, v243, v76 row_newbcast:2 row_mask:0xf bank_mask:0xf
    v_mul_f32_dpp v201, v243, v77 row_newbcast:3 row_mask:0xf bank_mask:0xf
    v_mul_f32_dpp v202, v243, v76 row_newbcast:10 row_mask:0xf bank_mask:0xf
    v_mul_f32_dpp v203, v243, v77 row_newbcast:11 row_mask:0xf bank_mask:0xf
    v_cvt_pk_bf16_f32 v72, v196, v197
    v_cvt_pk_bf16_f32 v76, v198, v199
    v_cvt_pk_bf16_f32 v73, v200, v201
    v_cvt_pk_bf16_f32 v77, v202, v203
    s_add_u32 m0, s21, 0
    v_mfma_f32_32x32x16_bf16 v[16:31], v[68:71], v[176:179], 0
    buffer_load_dwordx4 v234, s[4:7], s35 offen  lds
    buffer_load_dwordx4 v235, s[8:11], s35 offen offset:1024  lds
    ds_read_b64_tr_b16 v[176:177], v244 offset:2048
    ds_read_b64_tr_b16 v[178:179], v244 offset:3072
    ds_read_b64_tr_b16 v[184:185], v245 offset:2048
    ds_read_b64_tr_b16 v[186:187], v245 offset:3072
    v_mul_f32_dpp v196, v243, v74 row_newbcast:4 row_mask:0xf bank_mask:0xf
    v_mul_f32_dpp v197, v243, v75 row_newbcast:5 row_mask:0xf bank_mask:0xf
    v_mul_f32_dpp v198, v243, v74 row_newbcast:12 row_mask:0xf bank_mask:0xf
    v_mul_f32_dpp v199, v243, v75 row_newbcast:13 row_mask:0xf bank_mask:0xf
    v_mul_f32_dpp v200, v243, v78 row_newbcast:6 row_mask:0xf bank_mask:0xf
    v_mul_f32_dpp v201, v243, v79 row_newbcast:7 row_mask:0xf bank_mask:0xf
    v_mul_f32_dpp v202, v243, v78 row_newbcast:14 row_mask:0xf bank_mask:0xf
    v_mul_f32_dpp v203, v243, v79 row_newbcast:15 row_mask:0xf bank_mask:0xf
    v_cvt_pk_bf16_f32 v74, v196, v197
    v_cvt_pk_bf16_f32 v78, v198, v199
    v_cvt_pk_bf16_f32 v75, v200, v201
    v_cvt_pk_bf16_f32 v79, v202, v203
    s_mov_b64 exec, s[54:55]
    ds_read_u16_d16_hi v243, v250 offset:384
    s_mov_b64 exec, -1
    s_waitcnt vmcnt(4) lgkmcnt(1)
    v_mfma_f32_32x32x16_bf16 v[0:15], v[72:75], v[176:179], v[0:15]
    v_mul_f32_dpp v196, v242, v80 row_newbcast:0 row_mask:0xf bank_mask:0xf
    v_mul_f32_dpp v197, v242, v81 row_newbcast:1 row_mask:0xf bank_mask:0xf
    v_mul_f32_dpp v198, v242, v80 row_newbcast:8 row_mask:0xf bank_mask:0xf
    v_mul_f32_dpp v199, v242, v81 row_newbcast:9 row_mask:0xf bank_mask:0xf
    v_mul_f32_dpp v200, v242, v84 row_newbcast:2 row_mask:0xf bank_mask:0xf
    v_mul_f32_dpp v201, v242, v85 row_newbcast:3 row_mask:0xf bank_mask:0xf
    v_mul_f32_dpp v202, v242, v84 row_newbcast:10 row_mask:0xf bank_mask:0xf
    v_mul_f32_dpp v203, v242, v85 row_newbcast:11 row_mask:0xf bank_mask:0xf
    v_cvt_pk_bf16_f32 v80, v196, v197
    v_cvt_pk_bf16_f32 v84, v198, v199
    v_cvt_pk_bf16_f32 v81, v200, v201
    v_cvt_pk_bf16_f32 v85, v202, v203
    s_add_u32 m0, s21, 2048
    v_mfma_f32_32x32x16_bf16 v[16:31], v[76:79], v[176:179], v[16:31]
    buffer_load_dwordx4 v236, s[4:7], s35 offen  lds
    buffer_load_dwordx4 v237, s[8:11], s35 offen offset:1024  lds
    ds_read_b64_tr_b16 v[176:177], v244 offset:4096
    ds_read_b64_tr_b16 v[178:179], v244 offset:5120
    ds_read_b64_tr_b16 v[188:189], v245 offset:4096
    ds_read_b64_tr_b16 v[190:191], v245 offset:5120
    v_mul_f32_dpp v196, v242, v82 row_newbcast:4 row_mask:0xf bank_mask:0xf
    v_mul_f32_dpp v197, v242, v83 row_newbcast:5 row_mask:0xf bank_mask:0xf
    v_mul_f32_dpp v198, v242, v82 row_newbcast:12 row_mask:0xf bank_mask:0xf
    v_mul_f32_dpp v199, v242, v83 row_newbcast:13 row_mask:0xf bank_mask:0xf
    v_mul_f32_dpp v200, v242, v86 row_newbcast:6 row_mask:0xf bank_mask:0xf
    v_mul_f32_dpp v201, v242, v87 row_newbcast:7 row_mask:0xf bank_mask:0xf
    v_mul_f32_dpp v202, v242, v86 row_newbcast:14 row_mask:0xf bank_mask:0xf
    v_mul_f32_dpp v203, v242, v87 row_newbcast:15 row_mask:0xf bank_mask:0xf
    v_cvt_pk_bf16_f32 v82, v196, v197
    v_cvt_pk_bf16_f32 v86, v198, v199
    v_cvt_pk_bf16_f32 v83, v200, v201
    v_cvt_pk_bf16_f32 v87, v202, v203
    s_nop 0
    s_waitcnt vmcnt(4) lgkmcnt(0)
    v_mfma_f32_32x32x16_bf16 v[0:15], v[80:83], v[176:179], v[0:15]
    v_mul_f32_dpp v196, v243, v88 row_newbcast:0 row_mask:0xf bank_mask:0xf
    v_mul_f32_dpp v197, v243, v89 row_newbcast:1 row_mask:0xf bank_mask:0xf
    v_mul_f32_dpp v198, v243, v88 row_newbcast:8 row_mask:0xf bank_mask:0xf
    v_mul_f32_dpp v199, v243, v89 row_newbcast:9 row_mask:0xf bank_mask:0xf
    v_mul_f32_dpp v200, v243, v92 row_newbcast:2 row_mask:0xf bank_mask:0xf
    v_mul_f32_dpp v201, v243, v93 row_newbcast:3 row_mask:0xf bank_mask:0xf
    v_mul_f32_dpp v202, v243, v92 row_newbcast:10 row_mask:0xf bank_mask:0xf
    v_mul_f32_dpp v203, v243, v93 row_newbcast:11 row_mask:0xf bank_mask:0xf
    v_cvt_pk_bf16_f32 v88, v196, v197
    v_cvt_pk_bf16_f32 v92, v198, v199
    v_cvt_pk_bf16_f32 v89, v200, v201
    v_cvt_pk_bf16_f32 v93, v202, v203
    s_add_u32 m0, s21, 4096
    v_mfma_f32_32x32x16_bf16 v[16:31], v[84:87], v[176:179], v[16:31]
    buffer_load_dwordx4 v238, s[4:7], s35 offen  lds
    buffer_load_dwordx4 v239, s[8:11], s35 offen offset:1024  lds
    ds_read_b64_tr_b16 v[176:177], v244 offset:6144
    ds_read_b64_tr_b16 v[178:179], v244 offset:7168
    ds_read_b64_tr_b16 v[192:193], v245 offset:6144
    ds_read_b64_tr_b16 v[194:195], v245 offset:7168
    v_mul_f32_dpp v196, v243, v90 row_newbcast:4 row_mask:0xf bank_mask:0xf
    v_mul_f32_dpp v197, v243, v91 row_newbcast:5 row_mask:0xf bank_mask:0xf
    v_mul_f32_dpp v198, v243, v90 row_newbcast:12 row_mask:0xf bank_mask:0xf
    v_mul_f32_dpp v199, v243, v91 row_newbcast:13 row_mask:0xf bank_mask:0xf
    v_mul_f32_dpp v200, v243, v94 row_newbcast:6 row_mask:0xf bank_mask:0xf
    v_mul_f32_dpp v201, v243, v95 row_newbcast:7 row_mask:0xf bank_mask:0xf
    v_mul_f32_dpp v202, v243, v94 row_newbcast:14 row_mask:0xf bank_mask:0xf
    v_mul_f32_dpp v203, v243, v95 row_newbcast:15 row_mask:0xf bank_mask:0xf
    v_cvt_pk_bf16_f32 v90, v196, v197
    v_cvt_pk_bf16_f32 v94, v198, v199
    v_cvt_pk_bf16_f32 v91, v200, v201
    v_cvt_pk_bf16_f32 v95, v202, v203
    s_nop 0
    s_waitcnt lgkmcnt(0)
    v_mfma_f32_32x32x16_bf16 v[0:15], v[88:91], v[176:179], v[0:15]
    s_add_u32 m0, s21, 6144
    v_mfma_f32_32x32x16_bf16 v[16:31], v[92:95], v[176:179], v[16:31]
    buffer_load_dwordx4 v240, s[4:7], s35 offen  lds
    buffer_load_dwordx4 v241, s[8:11], s35 offen offset:1024  lds
    s_mov_b32 m0, s50
    s_nop 0
    s_movrels_b32 s71, s23
    s_bfe_u32 s46, s71, 0x30012
    s_mov_b32 m0, s46
    s_and_b32 s66, s71, 0x3ffff
    s_movrels_b32 s68, s57
    s_movrels_b32 s69, s61
    s_sub_u32 s48, s66, s47
    s_mov_b32 s47, s66
    s_lshr_b32 s52, s71, 28
    s_lshl_b32 s67, s46, 9
    s_add_u32 s66, s66, s67
    s_sub_u32 s49, s66, s42
    s_mov_b32 s42, s66
    s_bfe_u32 s66, s68, 655360
    s_add_u32 s43, s42, s66
    s_bfe_u32 s39, s69, 655360
    s_bfe_u32 s66, s68, 655370
    s_add_u32 s44, s42, s66
    s_bfe_u32 s40, s69, 655370
    s_bfe_u32 s66, s68, 655380
    s_add_u32 s45, s42, s66
    s_bfe_u32 s41, s69, 655380
    s_and_b32 s66, s46, s33
    s_cselect_b32 s72, -1, 1
    s_cselect_b32 s76, s47, 163712
    s_cmp_ge_u32 s66, 2
    s_cselect_b32 s73, -1, 0
    s_add_u32 s77, s47, 1024
    s_cmp_ge_u32 s66, 4
    s_cselect_b32 s75, -1, 0
    s_cmp_ge_u32 s66, 3
    s_cselect_b32 s74, -1, 1
    s_cselect_b32 s77, s77, 163712
    v_mfma_f32_32x32x16_bf16 v[32:47], v[64:67], v[180:183], 0
    v_mul_f32 v196, v0, v96
    v_fmac_f32 v196, v1, v97
    v_fmac_f32 v196, v2, v98
    v_fmac_f32 v196, v3, v99
    v_fmac_f32 v196, v4, v100
    v_mfma_f32_32x32x16_bf16 v[48:63], v[68:71], v[180:183], 0
    v_fmac_f32 v196, v5, v101
    v_fmac_f32 v196, v6, v102
    v_fmac_f32 v196, v7, v103
    v_mul_f32 v198, v8, v128
    v_fmac_f32 v198, v9, v129
    v_mfma_f32_32x32x16_bf16 v[32:47], v[72:75], v[184:187], v[32:47]
    v_fmac_f32 v198, v10, v130
    v_fmac_f32 v198, v11, v131
    v_fmac_f32 v198, v12, v132
    v_fmac_f32 v198, v13, v133
    v_mfma_f32_32x32x16_bf16 v[48:63], v[76:79], v[184:187], v[48:63]
    v_fmac_f32 v198, v14, v134
    v_fmac_f32 v198, v15, v135
    v_mul_f32 v200, v16, v128
    v_fmac_f32 v200, v17, v129
    v_permlane32_swap_b32 v196, v198
    v_mfma_f32_32x32x16_bf16 v[32:47], v[80:83], v[188:191], v[32:47]
    v_fmac_f32 v200, v18, v130
    v_fmac_f32 v200, v19, v131
    v_fmac_f32 v200, v20, v132
    v_fmac_f32 v200, v21, v133
    v_fmac_f32 v200, v22, v134
    v_mfma_f32_32x32x16_bf16 v[48:63], v[84:87], v[188:191], v[48:63]
    s_waitcnt vmcnt(6)
    ds_read_b64_tr_b16 v[176:177], v244 offset:0
    ds_read_b64_tr_b16 v[178:179], v244 offset:1024
    ds_read_b64_tr_b16 v[180:181], v245 offset:0
    ds_read_b64_tr_b16 v[182:183], v245 offset:1024
    v_fmac_f32 v200, v23, v135
    v_add_f32 v198, v196, v198
    v_mul_f32_e64 v202, v24, -v128
    v_fma_f32 v202, v25, -v129, v202
    v_mfma_f32_32x32x16_bf16 v[32:47], v[88:91], v[192:195], v[32:47]
    v_fma_f32 v202, v26, -v130, v202
    v_fma_f32 v202, v27, -v131, v202
    v_fma_f32 v202, v28, -v132, v202
    v_fma_f32 v202, v29, -v133, v202
    v_fma_f32 v202, v30, -v134, v202
    v_mfma_f32_32x32x16_bf16 v[48:63], v[92:95], v[192:195], v[48:63]
    v_fma_f32 v202, v31, -v135, v202
    s_nop 1
    v_permlane32_swap_b32 v200, v202
    v_add_f32 v202, v200, v202
    s_waitcnt vmcnt(4) lgkmcnt(0)
    v_mfma_f32_32x32x16_bf16 v[0:15], v[64:67], v[176:179], 0
    v_mul_f32 v197, v32, v104
    v_fmac_f32 v197, v33, v105
    v_fmac_f32 v197, v34, v106
    v_fmac_f32 v197, v35, v107
    v_fmac_f32 v197, v36, v108
    v_fmac_f32 v197, v37, v109
    s_add_u32 m0, s21, 0
    v_mfma_f32_32x32x16_bf16 v[16:31], v[68:71], v[176:179], 0
    buffer_load_dwordx4 v234, s[4:7], s36 offen  lds
    buffer_load_dwordx4 v235, s[8:11], s36 offen offset:1024  lds
    ds_read_b64_tr_b16 v[176:177], v244 offset:2048
    ds_read_b64_tr_b16 v[178:179], v244 offset:3072
    ds_read_b64_tr_b16 v[184:185], v245 offset:2048
    ds_read_b64_tr_b16 v[186:187], v245 offset:3072
    v_fmac_f32 v197, v38, v110
    v_fmac_f32 v197, v39, v111
    v_mul_f32 v199, v40, v136
    v_fmac_f32 v199, v41, v137
    v_fmac_f32 v199, v42, v138
    s_waitcnt vmcnt(4) lgkmcnt(0)
    v_mfma_f32_32x32x16_bf16 v[0:15], v[72:75], v[176:179], v[0:15]
    v_fmac_f32 v199, v43, v139
    v_fmac_f32 v199, v44, v140
    v_fmac_f32 v199, v45, v141
    v_fmac_f32 v199, v46, v142
    v_fmac_f32 v199, v47, v143
    s_add_u32 m0, s21, 2048
    v_mfma_f32_32x32x16_bf16 v[16:31], v[76:79], v[176:179], v[16:31]
    buffer_load_dwordx4 v236, s[4:7], s36 offen  lds
    buffer_load_dwordx4 v237, s[8:11], s36 offen offset:1024  lds
    ds_read_b64_tr_b16 v[176:177], v244 offset:4096
    ds_read_b64_tr_b16 v[178:179], v244 offset:5120
    ds_read_b64_tr_b16 v[188:189], v245 offset:4096
    ds_read_b64_tr_b16 v[190:191], v245 offset:5120
    v_mul_f32 v201, v48, v136
    v_fmac_f32 v201, v49, v137
    v_permlane32_swap_b32 v197, v199
    v_fmac_f32 v201, v50, v138
    v_fmac_f32 v201, v51, v139
    s_waitcnt vmcnt(4) lgkmcnt(0)
    v_mfma_f32_32x32x16_bf16 v[0:15], v[80:83], v[176:179], v[0:15]
    v_fmac_f32 v201, v52, v140
    v_fmac_f32 v201, v53, v141
    v_fmac_f32 v201, v54, v142
    v_fmac_f32 v201, v55, v143
    v_add_f32 v199, v197, v199
    v_mul_f32_e64 v203, v56, -v136
    s_add_u32 m0, s21, 4096
    v_mfma_f32_32x32x16_bf16 v[16:31], v[84:87], v[176:179], v[16:31]
    buffer_load_dwordx4 v238, s[4:7], s36 offen  lds
    buffer_load_dwordx4 v239, s[8:11], s36 offen offset:1024  lds
    ds_read_b64_tr_b16 v[176:177], v244 offset:6144
    ds_read_b64_tr_b16 v[178:179], v244 offset:7168
    ds_read_b64_tr_b16 v[192:193], v245 offset:6144
    ds_read_b64_tr_b16 v[194:195], v245 offset:7168
    v_fma_f32 v203, v57, -v137, v203
    v_fma_f32 v203, v58, -v138, v203
    v_fma_f32 v203, v59, -v139, v203
    v_fma_f32 v203, v60, -v140, v203
    v_fma_f32 v203, v61, -v141, v203
    s_waitcnt lgkmcnt(0)
    v_mfma_f32_32x32x16_bf16 v[0:15], v[88:91], v[176:179], v[0:15]
    v_fma_f32 v203, v62, -v142, v203
    v_fma_f32 v203, v63, -v143, v203
    s_nop 1
    v_permlane32_swap_b32 v201, v203
    v_add_f32 v203, v201, v203
    s_add_u32 m0, s21, 6144
    v_mfma_f32_32x32x16_bf16 v[16:31], v[92:95], v[176:179], v[16:31]
    buffer_load_dwordx4 v240, s[4:7], s36 offen  lds
    buffer_load_dwordx4 v241, s[8:11], s36 offen offset:1024  lds
    s_set_gpr_idx_on s51, gpr_idx(DST)
    s_nop 0
    v_cvt_pk_bf16_f32 v204, v198, v199
    v_cvt_pk_bf16_f32 v205, v202, v203
    s_set_gpr_idx_off
    v_mfma_f32_32x32x16_bf16 v[32:47], v[64:67], v[180:183], 0
    v_mul_f32 v196, v0, v144
    v_fmac_f32 v196, v1, v145
    v_fmac_f32 v196, v2, v146
    v_fmac_f32 v196, v3, v147
    v_mfma_f32_32x32x16_bf16 v[48:63], v[68:71], v[180:183], 0
    v_add_u32 v253, s47, v248
    ds_read_b32 v254, v253
    ds_read_b32 v255, v253 offset:256
    v_fmac_f32 v196, v4, v148
    v_fmac_f32 v196, v5, v149
    v_fmac_f32 v196, v6, v150
    v_fmac_f32 v196, v7, v151
    v_mfma_f32_32x32x16_bf16 v[32:47], v[72:75], v[184:187], v[32:47]
    v_mul_f32 v198, v8, v112
    v_fmac_f32 v198, v9, v113
    v_fmac_f32 v198, v10, v114
    v_fmac_f32 v198, v11, v115
    v_mfma_f32_32x32x16_bf16 v[48:63], v[76:79], v[184:187], v[48:63]
    v_fmac_f32 v198, v12, v116
    v_fmac_f32 v198, v13, v117
    v_fmac_f32 v198, v14, v118
    v_fmac_f32 v198, v15, v119
    v_mfma_f32_32x32x16_bf16 v[32:47], v[80:83], v[188:191], v[32:47]
    v_mul_f32_e64 v200, v16, -v160
    v_fma_f32 v200, v17, -v161, v200
    v_fma_f32 v200, v18, -v162, v200
    v_fma_f32 v200, v19, -v163, v200
    v_mfma_f32_32x32x16_bf16 v[48:63], v[84:87], v[188:191], v[48:63]
    s_waitcnt vmcnt(6)
    ds_read_b64_tr_b16 v[176:177], v244 offset:0
    ds_read_b64_tr_b16 v[178:179], v244 offset:1024
    ds_read_b64_tr_b16 v[180:181], v245 offset:0
    ds_read_b64_tr_b16 v[182:183], v245 offset:1024
    v_fma_f32 v200, v20, -v164, v200
    v_fma_f32 v200, v21, -v165, v200
    v_fma_f32 v200, v22, -v166, v200
    v_fma_f32 v200, v23, -v167, v200
    v_mfma_f32_32x32x16_bf16 v[32:47], v[88:91], v[192:195], v[32:47]
    v_mul_f32_e64 v202, v24, -v160
    v_fma_f32 v202, v25, -v161, v202
    v_fma_f32 v202, v26, -v162, v202
    v_fma_f32 v202, v27, -v163, v202
    v_mfma_f32_32x32x16_bf16 v[48:63], v[92:95], v[192:195], v[48:63]
    v_fma_f32 v202, v28, -v164, v202
    v_fma_f32 v202, v29, -v165, v202
    v_fma_f32 v202, v30, -v166, v202
    v_fma_f32 v202, v31, -v167, v202
    s_waitcnt vmcnt(4) lgkmcnt(0)
    v_mfma_f32_32x32x16_bf16 v[0:15], v[64:67], v[176:179], 0
    s_nop 0
    v_mul_f32 v197, v32, v152
    v_fmac_f32 v197, v33, v153
    v_fmac_f32 v197, v34, v154
    v_fmac_f32 v197, v35, v155
    s_add_u32 m0, s21, 0
    v_mfma_f32_32x32x16_bf16 v[16:31], v[68:71], v[176:179], 0
    buffer_load_dwordx4 v234, s[4:7], s37 offen  lds
    buffer_load_dwordx4 v235, s[8:11], s37 offen offset:1024  lds
    ds_read_b64_tr_b16 v[176:177], v244 offset:2048
    ds_read_b64_tr_b16 v[178:179], v244 offset:3072
    ds_read_b64_tr_b16 v[184:185], v245 offset:2048
    ds_read_b64_tr_b16 v[186:187], v245 offset:3072
    v_add_u32 v252, s42, v247
    ds_read_u16 v234, v252
    ds_read_u16 v235, v252 offset:64
    v_fmac_f32 v197, v36, v156
    v_fmac_f32 v197, v37, v157
    v_fmac_f32 v197, v38, v158
    v_fmac_f32 v197, v39, v159
    s_waitcnt vmcnt(4) lgkmcnt(2)
    v_mfma_f32_32x32x16_bf16 v[0:15], v[72:75], v[176:179], v[0:15]
    v_mul_f32 v199, v40, v120
    v_fmac_f32 v199, v41, v121
    v_fmac_f32 v199, v42, v122
    v_fmac_f32 v199, v43, v123
    s_add_u32 m0, s21, 2048
    v_mfma_f32_32x32x16_bf16 v[16:31], v[76:79], v[176:179], v[16:31]
    buffer_load_dwordx4 v236, s[4:7], s37 offen  lds
    buffer_load_dwordx4 v237, s[8:11], s37 offen offset:1024  lds
    ds_read_b64_tr_b16 v[176:177], v244 offset:4096
    ds_read_b64_tr_b16 v[178:179], v244 offset:5120
    ds_read_b64_tr_b16 v[188:189], v245 offset:4096
    ds_read_b64_tr_b16 v[190:191], v245 offset:5120
    v_add_u32 v252, s43, v247
    ds_read_u16 v236, v252
    ds_read_u16 v237, v252 offset:64
    v_fmac_f32 v199, v44, v124
    v_fmac_f32 v199, v45, v125
    v_fmac_f32 v199, v46, v126
    v_fmac_f32 v199, v47, v127
    s_waitcnt vmcnt(4) lgkmcnt(2)
    v_mfma_f32_32x32x16_bf16 v[0:15], v[80:83], v[176:179], v[0:15]
    v_mul_f32_e64 v201, v48, -v168
    v_fma_f32 v201, v49, -v169, v201
    v_fma_f32 v201, v50, -v170, v201
    v_fma_f32 v201, v51, -v171, v201
    s_add_u32 m0, s21, 4096
    v_mfma_f32_32x32x16_bf16 v[16:31], v[84:87], v[176:179], v[16:31]
    buffer_load_dwordx4 v238, s[4:7], s37 offen  lds
    buffer_load_dwordx4 v239, s[8:11], s37 offen offset:1024  lds
    ds_read_b64_tr_b16 v[176:177], v244 offset:6144
    ds_read_b64_tr_b16 v[178:179], v244 offset:7168
    ds_read_b64_tr_b16 v[192:193], v245 offset:6144
    ds_read_b64_tr_b16 v[194:195], v245 offset:7168
    v_add_u32 v252, s44, v247
    ds_read_u16 v238, v252
    ds_read_u16 v239, v252 offset:64
    v_fma_f32 v201, v52, -v172, v201
    v_fma_f32 v201, v53, -v173, v201
    v_fma_f32 v201, v54, -v174, v201
    v_fma_f32 v201, v55, -v175, v201
    s_waitcnt lgkmcnt(2)
    v_mfma_f32_32x32x16_bf16 v[0:15], v[88:91], v[176:179], v[0:15]
    v_mul_f32_e64 v203, v56, -v168
    v_fma_f32 v203, v57, -v169, v203
    v_fma_f32 v203, v58, -v170, v203
    v_fma_f32 v203, v59, -v171, v203
    s_add_u32 m0, s21, 6144
    v_mfma_f32_32x32x16_bf16 v[16:31], v[92:95], v[176:179], v[16:31]
    buffer_load_dwordx4 v240, s[4:7], s37 offen  lds
    buffer_load_dwordx4 v241, s[8:11], s37 offen offset:1024  lds
    v_add_u32 v252, s45, v247
    ds_read_u16 v240, v252
    ds_read_u16 v241, v252 offset:64
    s_mov_b32 m0, s76
    s_mov_b64 exec, s[72:73]
    buffer_load_dwordx4 v254, s[12:15], 0 offen  lds
    s_mov_b32 m0, s77
    s_mov_b64 exec, s[74:75]
    buffer_load_dwordx4 v255, s[12:15], 0 offen  lds
    s_mov_b64 exec, -1
    v_fma_f32 v203, v60, -v172, v203
    v_fma_f32 v203, v61, -v173, v203
    v_fma_f32 v203, v62, -v174, v203
    v_fma_f32 v203, v63, -v175, v203
    v_mfma_f32_32x32x16_bf16 v[32:47], v[64:67], v[180:183], 0
    v_mul_f32 v254, v0, v144
    v_fmac_f32 v254, v1, v145
    v_fmac_f32 v254, v2, v146
    v_mfma_f32_32x32x16_bf16 v[48:63], v[68:71], v[180:183], 0
    ds_swizzle_b32 v68, v68 offset:0x401F
    ds_swizzle_b32 v69, v69 offset:0x401F
    ds_swizzle_b32 v70, v70 offset:0x401F
    ds_swizzle_b32 v71, v71 offset:0x401F
    v_fmac_f32 v254, v3, v147
    v_fmac_f32 v254, v4, v148
    v_mfma_f32_32x32x16_bf16 v[32:47], v[72:75], v[184:187], v[32:47]
    v_fmac_f32 v254, v5, v149
    v_fmac_f32 v254, v6, v150
    v_mfma_f32_32x32x16_bf16 v[48:63], v[76:79], v[184:187], v[48:63]
    ds_swizzle_b32 v76, v76 offset:0x401F
    ds_swizzle_b32 v77, v77 offset:0x401F
    ds_swizzle_b32 v78, v78 offset:0x401F
    ds_swizzle_b32 v79, v79 offset:0x401F
    v_fmac_f32 v254, v7, v151
    v_fmac_f32 v200, v8, v160
    v_mfma_f32_32x32x16_bf16 v[32:47], v[80:83], v[188:191], v[32:47]
    v_fmac_f32 v200, v9, v161
    v_permlane32_swap_b32 v196, v254
    v_fmac_f32 v200, v10, v162
    v_mfma_f32_32x32x16_bf16 v[48:63], v[84:87], v[188:191], v[48:63]
    ds_swizzle_b32 v84, v84 offset:0x401F
    ds_swizzle_b32 v85, v85 offset:0x401F
    ds_swizzle_b32 v86, v86 offset:0x401F
    ds_swizzle_b32 v87, v87 offset:0x401F
    s_waitcnt vmcnt(8)
    ds_read_b64_tr_b16 v[176:177], v244 offset:0
    ds_read_b64_tr_b16 v[178:179], v244 offset:1024
    ds_read_b64_tr_b16 v[180:181], v245 offset:0
    ds_read_b64_tr_b16 v[182:183], v245 offset:1024
    v_fmac_f32 v200, v11, v163
    v_fmac_f32 v200, v12, v164
    v_mfma_f32_32x32x16_bf16 v[32:47], v[88:91], v[192:195], v[32:47]
    v_fmac_f32 v200, v13, v165
    v_fmac_f32 v200, v14, v166
    v_mfma_f32_32x32x16_bf16 v[48:63], v[92:95], v[192:195], v[48:63]
    ds_swizzle_b32 v92, v92 offset:0x401F
    ds_swizzle_b32 v93, v93 offset:0x401F
    ds_swizzle_b32 v94, v94 offset:0x401F
    ds_swizzle_b32 v95, v95 offset:0x401F
    v_fmac_f32 v200, v15, v167
    v_add_f32 v254, v196, v254
    s_waitcnt lgkmcnt(8)
    s_mov_b64 exec, s[56:57]
    v_xor_b32 v68, 0x80008000, v68
    v_xor_b32 v69, 0x80008000, v69
    v_xor_b32 v70, 0x80008000, v70
    v_xor_b32 v71, 0x80008000, v71
    v_xor_b32 v76, 0x80008000, v76
    v_xor_b32 v77, 0x80008000, v77
    v_xor_b32 v78, 0x80008000, v78
    v_xor_b32 v79, 0x80008000, v79
    v_xor_b32 v84, 0x80008000, v84
    v_xor_b32 v85, 0x80008000, v85
    v_xor_b32 v86, 0x80008000, v86
    v_xor_b32 v87, 0x80008000, v87
    s_mov_b64 exec, -1
    s_waitcnt vmcnt(6) lgkmcnt(4)
    v_mfma_f32_32x32x16_bf16 v[0:15], v[64:67], v[176:179], 0
    v_mul_f32 v255, v32, v152
    v_fmac_f32 v255, v33, v153
    v_fmac_f32 v255, v34, v154
    s_add_u32 m0, s21, 0
    v_mfma_f32_32x32x16_bf16 v[16:31], v[68:71], v[176:179], v[16:31]
    v_lshl_add_u32 v234, v234, 10, v246
    v_lshl_add_u32 v235, v235, 10, v246
    buffer_load_dwordx4 v234, s[4:7], s38 offen  lds
    buffer_load_dwordx4 v235, s[8:11], s38 offen offset:1024  lds
    ds_read_b64_tr_b16 v[176:177], v244 offset:2048
    ds_read_b64_tr_b16 v[178:179], v244 offset:3072
    ds_read_b64_tr_b16 v[184:185], v245 offset:2048
    ds_read_b64_tr_b16 v[186:187], v245 offset:3072
    v_fmac_f32 v255, v35, v155
    v_fmac_f32 v255, v36, v156
    v_fmac_f32 v255, v37, v157
    s_waitcnt vmcnt(6) lgkmcnt(0)
    v_mfma_f32_32x32x16_bf16 v[0:15], v[72:75], v[176:179], v[0:15]
    v_fmac_f32 v255, v38, v158
    v_fmac_f32 v255, v39, v159
    v_fmac_f32 v201, v40, v168
    s_add_u32 m0, s21, 2048
    v_mfma_f32_32x32x16_bf16 v[16:31], v[76:79], v[176:179], v[16:31]
    v_lshl_add_u32 v236, v236, 10, v246
    v_lshl_add_u32 v237, v237, 10, v246
    buffer_load_dwordx4 v236, s[4:7], s39 offen  lds
    buffer_load_dwordx4 v237, s[8:11], s39 offen offset:1024  lds
    ds_read_b64_tr_b16 v[176:177], v244 offset:4096
    ds_read_b64_tr_b16 v[178:179], v244 offset:5120
    ds_read_b64_tr_b16 v[188:189], v245 offset:4096
    ds_read_b64_tr_b16 v[190:191], v245 offset:5120
    v_fmac_f32 v201, v41, v169
    v_permlane32_swap_b32 v197, v255
    s_waitcnt vmcnt(6) lgkmcnt(0)
    v_mfma_f32_32x32x16_bf16 v[0:15], v[80:83], v[176:179], v[0:15]
    v_fmac_f32 v201, v42, v170
    v_fmac_f32 v201, v43, v171
    v_fmac_f32 v201, v44, v172
    s_add_u32 m0, s21, 4096
    v_mfma_f32_32x32x16_bf16 v[16:31], v[84:87], v[176:179], v[16:31]
    v_lshl_add_u32 v238, v238, 10, v246
    v_lshl_add_u32 v239, v239, 10, v246
    buffer_load_dwordx4 v238, s[4:7], s40 offen  lds
    buffer_load_dwordx4 v239, s[8:11], s40 offen offset:1024  lds
    ds_read_b64_tr_b16 v[176:177], v244 offset:6144
    ds_read_b64_tr_b16 v[178:179], v244 offset:7168
    ds_read_b64_tr_b16 v[192:193], v245 offset:6144
    ds_read_b64_tr_b16 v[194:195], v245 offset:7168
    v_fmac_f32 v201, v45, v173
    v_fmac_f32 v201, v46, v174
    v_fmac_f32 v201, v47, v175
    s_waitcnt lgkmcnt(0)
    s_mov_b64 exec, s[56:57]
    v_xor_b32 v92, 0x80008000, v92
    v_xor_b32 v93, 0x80008000, v93
    v_xor_b32 v94, 0x80008000, v94
    v_xor_b32 v95, 0x80008000, v95
    s_mov_b64 exec, -1
    v_mfma_f32_32x32x16_bf16 v[0:15], v[88:91], v[176:179], v[0:15]
    v_add_f32 v255, v197, v255
    s_set_gpr_idx_on s51, gpr_idx(DST)
    s_nop 0
    v_cvt_pk_bf16_f32 v206, v254, v255
    s_set_gpr_idx_off
    s_add_u32 m0, s21, 6144
    v_mfma_f32_32x32x16_bf16 v[16:31], v[92:95], v[176:179], v[16:31]
    v_lshl_add_u32 v240, v240, 10, v246
    v_lshl_add_u32 v241, v241, 10, v246
    buffer_load_dwordx4 v240, s[4:7], s41 offen  lds
    buffer_load_dwordx4 v241, s[8:11], s41 offen offset:1024  lds
    v_mfma_f32_32x32x16_bf16 v[32:47], v[64:67], v[180:183], 0
    v_mul_f32 v254, v0, v144
    v_fmac_f32 v254, v1, v145
    v_fmac_f32 v254, v2, v146
    v_fmac_f32 v254, v3, v147
    v_fmac_f32 v254, v4, v148
    v_mfma_f32_32x32x16_bf16 v[48:63], v[68:71], v[180:183], v[48:63]
    v_fmac_f32 v254, v5, v149
    v_fmac_f32 v254, v6, v150
    v_fmac_f32 v254, v7, v151
    v_fma_f32 v202, v8, -v160, v202
    v_fma_f32 v202, v9, -v161, v202
    v_mfma_f32_32x32x16_bf16 v[32:47], v[72:75], v[184:187], v[32:47]
    v_permlane32_swap_b32 v254, v200
    v_fma_f32 v202, v10, -v162, v202
    v_fma_f32 v202, v11, -v163, v202
    v_fma_f32 v202, v12, -v164, v202
    v_fma_f32 v202, v13, -v165, v202
    v_mfma_f32_32x32x16_bf16 v[48:63], v[76:79], v[184:187], v[48:63]
    v_fma_f32 v202, v14, -v166, v202
    v_fma_f32 v202, v15, -v167, v202
    v_add_f32 v200, v254, v200
    v_fmac_f32 v198, v16, v112
    v_permlane32_swap_b32 v202, v254
    v_mfma_f32_32x32x16_bf16 v[32:47], v[80:83], v[188:191], v[32:47]
    v_fmac_f32 v198, v17, v113
    v_fmac_f32 v198, v18, v114
    v_fmac_f32 v198, v19, v115
    v_fmac_f32 v198, v20, v116
    v_fmac_f32 v198, v21, v117
    v_mfma_f32_32x32x16_bf16 v[48:63], v[84:87], v[188:191], v[48:63]
    s_waitcnt vmcnt(6)
    ds_read_b64_tr_b16 v[176:177], v244 offset:0
    ds_read_b64_tr_b16 v[178:179], v244 offset:1024
    ds_read_b64_tr_b16 v[180:181], v245 offset:0
    ds_read_b64_tr_b16 v[182:183], v245 offset:1024
    v_fmac_f32 v198, v22, v118
    v_fmac_f32 v198, v23, v119
    v_add_f32 v254, v202, v254
    v_mul_f32 v196, v24, v160
    v_fmac_f32 v196, v25, v161
    v_mfma_f32_32x32x16_bf16 v[32:47], v[88:91], v[192:195], v[32:47]
    v_fmac_f32 v196, v26, v162
    v_fmac_f32 v196, v27, v163
    v_fmac_f32 v196, v28, v164
    v_fmac_f32 v196, v29, v165
    v_fmac_f32 v196, v30, v166
    v_mfma_f32_32x32x16_bf16 v[48:63], v[92:95], v[192:195], v[48:63]
    v_add_u32 v249, s48, v249
    v_add_u32 v250, s49, v250
    ds_read_b64_tr_b16 v[64:65], v249 offset:0
    ds_read_b64_tr_b16 v[68:69], v249 offset:64
    ds_read_b64_tr_b16 v[66:67], v249 offset:256
    ds_read_b64_tr_b16 v[70:71], v249 offset:320
    s_mov_b64 exec, s[54:55]
    ds_read_u16_d16_hi v242, v250 offset:0
    s_mov_b64 exec, -1
    v_fmac_f32 v196, v31, v167
    s_nop 1
    v_permlane32_swap_b32 v198, v196
    v_add_f32 v196, v198, v196
    v_mul_f32 v255, v32, v152
    v_fmac_f32 v255, v33, v153
    v_fmac_f32 v255, v34, v154
    v_fmac_f32 v255, v35, v155
    v_fmac_f32 v255, v36, v156
    v_fmac_f32 v255, v37, v157
    v_fmac_f32 v255, v38, v158
    v_fmac_f32 v255, v39, v159
    v_fma_f32 v203, v40, -v168, v203
    v_fma_f32 v203, v41, -v169, v203
    v_permlane32_swap_b32 v255, v201
    v_fma_f32 v203, v42, -v170, v203
    v_fma_f32 v203, v43, -v171, v203
    v_fma_f32 v203, v44, -v172, v203
    v_fma_f32 v203, v45, -v173, v203
    v_fma_f32 v203, v46, -v174, v203
    v_fma_f32 v203, v47, -v175, v203
    v_add_f32 v201, v255, v201
    v_fmac_f32 v199, v48, v120
    v_permlane32_swap_b32 v203, v255
    v_fmac_f32 v199, v49, v121
    v_fmac_f32 v199, v50, v122
    v_fmac_f32 v199, v51, v123
    v_fmac_f32 v199, v52, v124
    v_fmac_f32 v199, v53, v125
    v_fmac_f32 v199, v54, v126
    v_fmac_f32 v199, v55, v127
    v_add_f32 v255, v203, v255
    v_mul_f32 v197, v56, v168
    v_fmac_f32 v197, v57, v169
    v_fmac_f32 v197, v58, v170
    v_fmac_f32 v197, v59, v171
    v_fmac_f32 v197, v60, v172
    v_fmac_f32 v197, v61, v173
    v_fmac_f32 v197, v62, v174
    v_fmac_f32 v197, v63, v175
    s_nop 1
    v_permlane32_swap_b32 v199, v197
    v_add_f32 v197, v199, v197
    s_set_gpr_idx_on s51, gpr_idx(DST)
    s_nop 0
    v_cvt_pk_bf16_f32 v207, v200, v201
    v_cvt_pk_bf16_f32 v209, v254, v255
    v_cvt_pk_bf16_f32 v208, v196, v197
    s_set_gpr_idx_off
    s_add_u32 s50, s50, 1
    s_add_u32 s51, s51, 6
    s_cmp_ge_u32 s50, 4
    s_cbranch_scc1 LAST0
    s_add_u32 s53, s53, 4
    s_xor_b32 s66, s53, s20
    s_bitcmp1_b32 s66, 2
    s_setprio 1
    s_cbranch_scc1 PRIO_9
    s_setprio 0
PRIO_9:
    s_cmp_eq_u32 s52, 4
    s_cbranch_scc1 ITEM_0_4
    s_cmp_eq_u32 s52, 5
    s_cbranch_scc1 ITEM_0_5
    s_cmp_eq_u32 s52, 3
    s_cbranch_scc1 ITEM_0_3
    s_cmp_eq_u32 s52, 6
    s_cbranch_scc1 ITEM_0_6
    s_cmp_eq_u32 s52, 8
    s_cbranch_scc1 ITEM_0_8
    s_branch ITEM_0_2
.p2align 6
ITEM_0_2:
    s_mov_b32 m0, s50
    s_nop 0
    s_movrels_b32 s71, s23
    s_bfe_u32 s46, s71, 0x30012
    s_mov_b32 m0, s46
    s_and_b32 s66, s71, 0x3ffff
    s_movrels_b32 s68, s57
    s_movrels_b32 s69, s61
    s_sub_u32 s48, s66, s47
    s_mov_b32 s47, s66
    s_lshr_b32 s52, s71, 28
    s_lshl_b32 s67, s46, 9
    s_add_u32 s66, s66, s67
    s_sub_u32 s49, s66, s42
    s_mov_b32 s42, s66
    s_bfe_u32 s66, s68, 655360
    s_add_u32 s43, s42, s66
    s_bfe_u32 s39, s69, 655360
    s_bfe_u32 s66, s68, 655370
    s_add_u32 s44, s42, s66
    s_bfe_u32 s40, s69, 655370
    s_bfe_u32 s66, s68, 655380
    s_add_u32 s45, s42, s66
    s_bfe_u32 s41, s69, 655380
    s_and_b32 s66, s46, s33
    s_cselect_b32 s72, -1, 1
    s_cselect_b32 s76, s47, 163712
    s_cmp_ge_u32 s66, 2
    s_cselect_b32 s73, -1, 0
    s_add_u32 s77, s47, 1024
    s_cmp_ge_u32 s66, 4
    s_cselect_b32 s75, -1, 0
    s_cmp_ge_u32 s66, 3
    s_cselect_b32 s74, -1, 1
    s_cselect_b32 s77, s77, 163712
    v_add_u32 v252, s42, v247
    ds_read_u16 v234, v252
    ds_read_u16 v235, v252 offset:64
    v_add_u32 v252, s43, v247
    ds_read_u16 v236, v252
    ds_read_u16 v237, v252 offset:64
    v_add_u32 v252, s44, v247
    ds_read_u16 v238, v252
    ds_read_u16 v239, v252 offset:64
    v_add_u32 v252, s45, v247
    ds_read_u16 v240, v252
    ds_read_u16 v241, v252 offset:64
    s_waitcnt lgkmcnt(8)
    v_mul_f32_dpp v196, v242, v64 row_newbcast:0 row_mask:0xf bank_mask:0xf
    v_mul_f32_dpp v197, v242, v65 row_newbcast:1 row_mask:0xf bank_mask:0xf
    v_mul_f32_dpp v198, v242, v64 row_newbcast:8 row_mask:0xf bank_mask:0xf
    v_mul_f32_dpp v199, v242, v65 row_newbcast:9 row_mask:0xf bank_mask:0xf
    v_mul_f32_dpp v200, v242, v68 row_newbcast:2 row_mask:0xf bank_mask:0xf
    v_mul_f32_dpp v201, v242, v69 row_newbcast:3 row_mask:0xf bank_mask:0xf
    v_mul_f32_dpp v202, v242, v68 row_newbcast:10 row_mask:0xf bank_mask:0xf
    v_mul_f32_dpp v203, v242, v69 row_newbcast:11 row_mask:0xf bank_mask:0xf
    v_cvt_pk_bf16_f32 v64, v196, v197
    v_cvt_pk_bf16_f32 v68, v198, v199
    v_cvt_pk_bf16_f32 v65, v200, v201
    v_cvt_pk_bf16_f32 v69, v202, v203
    v_mul_f32_dpp v196, v242, v66 row_newbcast:4 row_mask:0xf bank_mask:0xf
    v_mul_f32_dpp v197, v242, v67 row_newbcast:5 row_mask:0xf bank_mask:0xf
    v_mul_f32_dpp v198, v242, v66 row_newbcast:12 row_mask:0xf bank_mask:0xf
    v_mul_f32_dpp v199, v242, v67 row_newbcast:13 row_mask:0xf bank_mask:0xf
    v_mul_f32_dpp v200, v242, v70 row_newbcast:6 row_mask:0xf bank_mask:0xf
    v_mul_f32_dpp v201, v242, v71 row_newbcast:7 row_mask:0xf bank_mask:0xf
    v_mul_f32_dpp v202, v242, v70 row_newbcast:14 row_mask:0xf bank_mask:0xf
    v_mul_f32_dpp v203, v242, v71 row_newbcast:15 row_mask:0xf bank_mask:0xf
    v_cvt_pk_bf16_f32 v66, v196, v197
    v_cvt_pk_bf16_f32 v70, v198, v199
    v_cvt_pk_bf16_f32 v67, v200, v201
    v_cvt_pk_bf16_f32 v71, v202, v203
    s_nop 0
    s_waitcnt lgkmcnt(6)
    v_mfma_f32_32x32x16_bf16 v[0:15], v[64:67], v[176:179], 0
    s_add_u32 m0, s21, 0
    v_mfma_f32_32x32x16_bf16 v[16:31], v[68:71], v[176:179], 0
    v_lshl_add_u32 v234, v234, 10, v246
    v_lshl_add_u32 v235, v235, 10, v246
    buffer_load_dwordx4 v234, s[4:7], s38 offen  lds
    buffer_load_dwordx4 v235, s[8:11], s38 offen offset:1024  lds
    v_mfma_f32_32x32x16_bf16 v[32:47], v[64:67], v[180:183], 0
    s_nop 4
    v_mul_f32 v196, v0, v96
    v_fmac_f32 v196, v1, v97
    v_fmac_f32 v196, v2, v98
    v_fmac_f32 v196, v3, v99
    v_fmac_f32 v196, v4, v100
    v_fmac_f32 v196, v5, v101
    v_fmac_f32 v196, v6, v102
    v_fmac_f32 v196, v7, v103
    v_mul_f32 v198, v8, v128
    v_fmac_f32 v198, v9, v129
    v_fmac_f32 v198, v10, v130
    v_fmac_f32 v198, v11, v131
    v_fmac_f32 v198, v12, v132
    v_fmac_f32 v198, v13, v133
    v_fmac_f32 v198, v14, v134
    v_fmac_f32 v198, v15, v135
    v_mul_f32 v200, v16, v128
    v_fmac_f32 v200, v17, v129
    v_permlane32_swap_b32 v196, v198
    v_mfma_f32_32x32x16_bf16 v[48:63], v[68:71], v[180:183], 0
    s_waitcnt vmcnt(6)
    ds_read_b64_tr_b16 v[176:177], v244 offset:2048
    ds_read_b64_tr_b16 v[178:179], v244 offset:3072
    ds_read_b64_tr_b16 v[180:181], v245 offset:2048
    ds_read_b64_tr_b16 v[182:183], v245 offset:3072
    v_fmac_f32 v200, v18, v130
    v_fmac_f32 v200, v19, v131
    v_fmac_f32 v200, v20, v132
    v_fmac_f32 v200, v21, v133
    v_fmac_f32 v200, v22, v134
    v_fmac_f32 v200, v23, v135
    v_add_f32 v198, v196, v198
    v_mul_f32_e64 v202, v24, -v128
    v_fma_f32 v202, v25, -v129, v202
    v_fma_f32 v202, v26, -v130, v202
    v_fma_f32 v202, v27, -v131, v202
    v_fma_f32 v202, v28, -v132, v202
    v_fma_f32 v202, v29, -v133, v202
    v_fma_f32 v202, v30, -v134, v202
    v_fma_f32 v202, v31, -v135, v202
    s_nop 1
    v_permlane32_swap_b32 v200, v202
    v_add_f32 v202, v200, v202
    s_waitcnt lgkmcnt(0)
    v_mfma_f32_32x32x16_bf16 v[0:15], v[64:67], v[176:179], 0
    v_mul_f32 v197, v32, v104
    v_fmac_f32 v197, v33, v105
    v_fmac_f32 v197, v34, v106
    v_fmac_f32 v197, v35, v107
    v_fmac_f32 v197, v36, v108
    v_fmac_f32 v197, v37, v109
    v_fmac_f32 v197, v38, v110
    v_fmac_f32 v197, v39, v111
    v_mul_f32 v199, v40, v136
    v_fmac_f32 v199, v41, v137
    v_fmac_f32 v199, v42, v138
    v_fmac_f32 v199, v43, v139
    v_fmac_f32 v199, v44, v140
    v_fmac_f32 v199, v45, v141
    v_fmac_f32 v199, v46, v142
    v_fmac_f32 v199, v47, v143
    v_mul_f32 v201, v48, v136
    v_fmac_f32 v201, v49, v137
    v_permlane32_swap_b32 v197, v199
    v_fmac_f32 v201, v50, v138
    v_fmac_f32 v201, v51, v139
    s_add_u32 m0, s21, 2048
    v_mfma_f32_32x32x16_bf16 v[16:31], v[68:71], v[176:179], 0
    v_lshl_add_u32 v236, v236, 10, v246
    v_lshl_add_u32 v237, v237, 10, v246
    buffer_load_dwordx4 v236, s[4:7], s39 offen  lds
    buffer_load_dwordx4 v237, s[8:11], s39 offen offset:1024  lds
    v_fmac_f32 v201, v52, v140
    v_fmac_f32 v201, v53, v141
    v_fmac_f32 v201, v54, v142
    v_fmac_f32 v201, v55, v143
    v_add_f32 v199, v197, v199
    v_mul_f32_e64 v203, v56, -v136
    v_fma_f32 v203, v57, -v137, v203
    v_fma_f32 v203, v58, -v138, v203
    v_fma_f32 v203, v59, -v139, v203
    v_fma_f32 v203, v60, -v140, v203
    v_fma_f32 v203, v61, -v141, v203
    v_fma_f32 v203, v62, -v142, v203
    v_fma_f32 v203, v63, -v143, v203
    s_nop 1
    v_permlane32_swap_b32 v201, v203
    v_add_f32 v203, v201, v203
    s_set_gpr_idx_on s51, gpr_idx(DST)
    s_nop 0
    v_cvt_pk_bf16_f32 v204, v198, v199
    v_cvt_pk_bf16_f32 v205, v202, v203
    s_set_gpr_idx_off
    v_mfma_f32_32x32x16_bf16 v[32:47], v[64:67], v[180:183], 0
    v_mul_f32 v196, v0, v144
    v_fmac_f32 v196, v1, v145
    v_fmac_f32 v196, v2, v146
    v_fmac_f32 v196, v3, v147
    v_fmac_f32 v196, v4, v148
    v_fmac_f32 v196, v5, v149
    v_fmac_f32 v196, v6, v150
    v_fmac_f32 v196, v7, v151
    v_mul_f32 v198, v8, v112
    v_fmac_f32 v198, v9, v113
    v_fmac_f32 v198, v10, v114
    v_fmac_f32 v198, v11, v115
    v_fmac_f32 v198, v12, v116
    v_fmac_f32 v198, v13, v117
    v_fmac_f32 v198, v14, v118
    v_fmac_f32 v198, v15, v119
    v_mfma_f32_32x32x16_bf16 v[48:63], v[68:71], v[180:183], 0
    v_add_u32 v253, s47, v248
    ds_read_b32 v254, v253
    ds_read_b32 v255, v253 offset:256
    s_waitcnt vmcnt(6)
    ds_read_b64_tr_b16 v[176:177], v244 offset:4096
    ds_read_b64_tr_b16 v[178:179], v244 offset:5120
    ds_read_b64_tr_b16 v[180:181], v245 offset:4096
    ds_read_b64_tr_b16 v[182:183], v245 offset:5120
    v_mul_f32_e64 v200, v16, -v160
    v_fma_f32 v200, v17, -v161, v200
    v_fma_f32 v200, v18, -v162, v200
    v_fma_f32 v200, v19, -v163, v200
    v_fma_f32 v200, v20, -v164, v200
    v_fma_f32 v200, v21, -v165, v200
    v_fma_f32 v200, v22, -v166, v200
    v_fma_f32 v200, v23, -v167, v200
    v_mul_f32_e64 v202, v24, -v160
    v_fma_f32 v202, v25, -v161, v202
    v_fma_f32 v202, v26, -v162, v202
    v_fma_f32 v202, v27, -v163, v202
    v_fma_f32 v202, v28, -v164, v202
    v_fma_f32 v202, v29, -v165, v202
    v_fma_f32 v202, v30, -v166, v202
    v_fma_f32 v202, v31, -v167, v202
    s_waitcnt lgkmcnt(0)
    v_mfma_f32_32x32x16_bf16 v[0:15], v[64:67], v[176:179], 0
    v_mul_f32 v197, v32, v152
    v_fmac_f32 v197, v33, v153
    v_fmac_f32 v197, v34, v154
    v_fmac_f32 v197, v35, v155
    v_fmac_f32 v197, v36, v156
    v_fmac_f32 v197, v37, v157
    v_fmac_f32 v197, v38, v158
    v_fmac_f32 v197, v39, v159
    v_mul_f32 v199, v40, v120
    v_fmac_f32 v199, v41, v121
    v_fmac_f32 v199, v42, v122
    v_fmac_f32 v199, v43, v123
    v_fmac_f32 v199, v44, v124
    v_fmac_f32 v199, v45, v125
    v_fmac_f32 v199, v46, v126
    v_fmac_f32 v199, v47, v127
    s_add_u32 m0, s21, 4096
    v_mfma_f32_32x32x16_bf16 v[16:31], v[68:71], v[176:179], 0
    v_lshl_add_u32 v238, v238, 10, v246
    v_lshl_add_u32 v239, v239, 10, v246
    buffer_load_dwordx4 v238, s[4:7], s40 offen  lds
    buffer_load_dwordx4 v239, s[8:11], s40 offen offset:1024  lds
    s_mov_b32 m0, s76
    s_mov_b64 exec, s[72:73]
    buffer_load_dwordx4 v254, s[12:15], 0 offen  lds
    s_mov_b32 m0, s77
    s_mov_b64 exec, s[74:75]
    buffer_load_dwordx4 v255, s[12:15], 0 offen  lds
    s_mov_b64 exec, -1
    v_mul_f32_e64 v201, v48, -v168
    v_fma_f32 v201, v49, -v169, v201
    v_fma_f32 v201, v50, -v170, v201
    v_fma_f32 v201, v51, -v171, v201
    v_fma_f32 v201, v52, -v172, v201
    v_fma_f32 v201, v53, -v173, v201
    v_fma_f32 v201, v54, -v174, v201
    v_fma_f32 v201, v55, -v175, v201
    v_mul_f32_e64 v203, v56, -v168
    v_fma_f32 v203, v57, -v169, v203
    v_fma_f32 v203, v58, -v170, v203
    v_fma_f32 v203, v59, -v171, v203
    v_fma_f32 v203, v60, -v172, v203
    v_fma_f32 v203, v61, -v173, v203
    v_fma_f32 v203, v62, -v174, v203
    v_fma_f32 v203, v63, -v175, v203
    v_mfma_f32_32x32x16_bf16 v[32:47], v[64:67], v[180:183], 0
    v_mul_f32 v254, v0, v144
    v_fmac_f32 v254, v1, v145
    v_fmac_f32 v254, v2, v146
    v_fmac_f32 v254, v3, v147
    v_fmac_f32 v254, v4, v148
    v_fmac_f32 v254, v5, v149
    v_fmac_f32 v254, v6, v150
    v_fmac_f32 v254, v7, v151
    v_fmac_f32 v200, v8, v160
    v_mfma_f32_32x32x16_bf16 v[48:63], v[68:71], v[180:183], 0
    ds_swizzle_b32 v68, v68 offset:0x401F
    ds_swizzle_b32 v69, v69 offset:0x401F
    ds_swizzle_b32 v70, v70 offset:0x401F
    ds_swizzle_b32 v71, v71 offset:0x401F
    s_waitcnt vmcnt(8)
    ds_read_b64_tr_b16 v[176:177], v244 offset:6144
    ds_read_b64_tr_b16 v[178:179], v244 offset:7168
    ds_read_b64_tr_b16 v[180:181], v245 offset:6144
    ds_read_b64_tr_b16 v[182:183], v245 offset:7168
    v_fmac_f32 v200, v9, v161
    v_permlane32_swap_b32 v196, v254
    v_fmac_f32 v200, v10, v162
    v_fmac_f32 v200, v11, v163
    v_fmac_f32 v200, v12, v164
    v_fmac_f32 v200, v13, v165
    v_fmac_f32 v200, v14, v166
    v_fmac_f32 v200, v15, v167
    v_add_f32 v254, v196, v254
    s_waitcnt lgkmcnt(0)
    s_mov_b64 exec, s[56:57]
    v_xor_b32 v68, 0x80008000, v68
    v_xor_b32 v69, 0x80008000, v69
    v_xor_b32 v70, 0x80008000, v70
    v_xor_b32 v71, 0x80008000, v71
    s_mov_b64 exec, -1
    s_nop 0
    v_mfma_f32_32x32x16_bf16 v[0:15], v[64:67], v[176:179], 0
    v_mul_f32 v255, v32, v152
    v_fmac_f32 v255, v33, v153
    v_fmac_f32 v255, v34, v154
    v_fmac_f32 v255, v35, v155
    v_fmac_f32 v255, v36, v156
    v_fmac_f32 v255, v37, v157
    v_fmac_f32 v255, v38, v158
    v_fmac_f32 v255, v39, v159
    v_fmac_f32 v201, v40, v168
    v_fmac_f32 v201, v41, v169
    v_permlane32_swap_b32 v197, v255
    s_add_u32 m0, s21, 6144
    v_mfma_f32_32x32x16_bf16 v[16:31], v[68:71], v[176:179], v[16:31]
    v_lshl_add_u32 v240, v240, 10, v246
    v_lshl_add_u32 v241, v241, 10, v246
    buffer_load_dwordx4 v240, s[4:7], s41 offen  lds
    buffer_load_dwordx4 v241, s[8:11], s41 offen offset:1024  lds
    v_fmac_f32 v201, v42, v170
    v_fmac_f32 v201, v43, v171
    v_fmac_f32 v201, v44, v172
    v_fmac_f32 v201, v45, v173
    v_fmac_f32 v201, v46, v174
    v_fmac_f32 v201, v47, v175
    v_add_f32 v255, v197, v255
    s_set_gpr_idx_on s51, gpr_idx(DST)
    s_nop 0
    v_cvt_pk_bf16_f32 v206, v254, v255
    s_set_gpr_idx_off
    v_mfma_f32_32x32x16_bf16 v[32:47], v[64:67], v[180:183], 0
    v_mul_f32 v254, v0, v144
    v_fmac_f32 v254, v1, v145
    v_fmac_f32 v254, v2, v146
    v_fmac_f32 v254, v3, v147
    v_fmac_f32 v254, v4, v148
    v_fmac_f32 v254, v5, v149
    v_fmac_f32 v254, v6, v150
    v_fmac_f32 v254, v7, v151
    v_fma_f32 v202, v8, -v160, v202
    v_fma_f32 v202, v9, -v161, v202
    v_permlane32_swap_b32 v254, v200
    v_fma_f32 v202, v10, -v162, v202
    v_fma_f32 v202, v11, -v163, v202
    v_fma_f32 v202, v12, -v164, v202
    v_fma_f32 v202, v13, -v165, v202
    v_fma_f32 v202, v14, -v166, v202
    v_fma_f32 v202, v15, -v167, v202
    v_add_f32 v200, v254, v200
    v_fmac_f32 v198, v16, v112
    v_permlane32_swap_b32 v202, v254
    v_mfma_f32_32x32x16_bf16 v[48:63], v[68:71], v[180:183], v[48:63]
    s_waitcnt vmcnt(8)
    ds_read_b64_tr_b16 v[176:177], v244 offset:0
    ds_read_b64_tr_b16 v[178:179], v244 offset:1024
    ds_read_b64_tr_b16 v[180:181], v245 offset:0
    ds_read_b64_tr_b16 v[182:183], v245 offset:1024
    v_add_u32 v249, s48, v249
    v_add_u32 v250, s49, v250
    s_waitcnt vmcnt(2)
    ds_read_b64_tr_b16 v[64:65], v249 offset:0
    ds_read_b64_tr_b16 v[68:69], v249 offset:64
    ds_read_b64_tr_b16 v[66:67], v249 offset:256
    ds_read_b64_tr_b16 v[70:71], v249 offset:320
    s_mov_b64 exec, s[54:55]
    ds_read_u16_d16_hi v242, v250 offset:0
    s_mov_b64 exec, -1
    v_fmac_f32 v198, v17, v113
    v_fmac_f32 v198, v18, v114
    v_fmac_f32 v198, v19, v115
    v_fmac_f32 v198, v20, v116
    v_fmac_f32 v198, v21, v117
    v_fmac_f32 v198, v22, v118
    v_fmac_f32 v198, v23, v119
    v_add_f32 v254, v202, v254
    v_mul_f32 v196, v24, v160
    v_fmac_f32 v196, v25, v161
    v_fmac_f32 v196, v26, v162
    v_fmac_f32 v196, v27, v163
    v_fmac_f32 v196, v28, v164
    v_fmac_f32 v196, v29, v165
    v_fmac_f32 v196, v30, v166
    v_fmac_f32 v196, v31, v167
    s_nop 1
    v_permlane32_swap_b32 v198, v196
    v_add_f32 v196, v198, v196
    v_mul_f32 v255, v32, v152
    v_fmac_f32 v255, v33, v153
    v_fmac_f32 v255, v34, v154
    v_fmac_f32 v255, v35, v155
    v_fmac_f32 v255, v36, v156
    v_fmac_f32 v255, v37, v157
    v_fmac_f32 v255, v38, v158
    v_fmac_f32 v255, v39, v159
    v_fma_f32 v203, v40, -v168, v203
    v_fma_f32 v203, v41, -v169, v203
    v_permlane32_swap_b32 v255, v201
    v_fma_f32 v203, v42, -v170, v203
    v_fma_f32 v203, v43, -v171, v203
    v_fma_f32 v203, v44, -v172, v203
    v_fma_f32 v203, v45, -v173, v203
    v_fma_f32 v203, v46, -v174, v203
    v_fma_f32 v203, v47, -v175, v203
    v_add_f32 v201, v255, v201
    v_fmac_f32 v199, v48, v120
    v_permlane32_swap_b32 v203, v255
    v_fmac_f32 v199, v49, v121
    v_fmac_f32 v199, v50, v122
    v_fmac_f32 v199, v51, v123
    v_fmac_f32 v199, v52, v124
    v_fmac_f32 v199, v53, v125
    v_fmac_f32 v199, v54, v126
    v_fmac_f32 v199, v55, v127
    v_add_f32 v255, v203, v255
    v_mul_f32 v197, v56, v168
    v_fmac_f32 v197, v57, v169
    v_fmac_f32 v197, v58, v170
    v_fmac_f32 v197, v59, v171
    v_fmac_f32 v197, v60, v172
    v_fmac_f32 v197, v61, v173
    v_fmac_f32 v197, v62, v174
    v_fmac_f32 v197, v63, v175
    s_nop 1
    v_permlane32_swap_b32 v199, v197
    v_add_f32 v197, v199, v197
    s_set_gpr_idx_on s51, gpr_idx(DST)
    s_nop 0
    v_cvt_pk_bf16_f32 v207, v200, v201
    v_cvt_pk_bf16_f32 v209, v254, v255
    v_cvt_pk_bf16_f32 v208, v196, v197
    s_set_gpr_idx_off
    s_add_u32 s50, s50, 1
    s_add_u32 s51, s51, 6
    s_cmp_ge_u32 s50, 4
    s_cbranch_scc1 LAST0
    s_add_u32 s53, s53, 4
    s_xor_b32 s66, s53, s20
    s_bitcmp1_b32 s66, 2
    s_setprio 1
    s_cbranch_scc1 PRIO_10
    s_setprio 0
PRIO_10:
    s_cmp_eq_u32 s52, 4
    s_cbranch_scc1 ITEM_0_4
    s_cmp_eq_u32 s52, 5
    s_cbranch_scc1 ITEM_0_5
    s_cmp_eq_u32 s52, 3
    s_cbranch_scc1 ITEM_0_3
    s_cmp_eq_u32 s52, 6
    s_cbranch_scc1 ITEM_0_6
    s_cmp_eq_u32 s52, 8
    s_cbranch_scc1 ITEM_0_8
    s_branch ITEM_0_2
.p2align 6
ITEM_1_4:
    s_mov_b64 exec, s[54:55]
    ds_read_u16_d16_hi v243, v250 offset:128
    s_mov_b64 exec, -1
    ds_read_b64_tr_b16 v[72:73], v249 offset:512
    ds_read_b64_tr_b16 v[76:77], v249 offset:576
    ds_read_b64_tr_b16 v[74:75], v249 offset:768
    ds_read_b64_tr_b16 v[78:79], v249 offset:832
    s_waitcnt lgkmcnt(5)
    v_mul_f32_dpp v196, v242, v64 row_newbcast:0 row_mask:0xf bank_mask:0xf
    v_mul_f32_dpp v197, v242, v65 row_newbcast:1 row_mask:0xf bank_mask:0xf
    v_mul_f32_dpp v198, v242, v64 row_newbcast:8 row_mask:0xf bank_mask:0xf
    v_mul_f32_dpp v199, v242, v65 row_newbcast:9 row_mask:0xf bank_mask:0xf
    v_mul_f32_dpp v200, v242, v68 row_newbcast:2 row_mask:0xf bank_mask:0xf
    v_mul_f32_dpp v201, v242, v69 row_newbcast:3 row_mask:0xf bank_mask:0xf
    v_mul_f32_dpp v202, v242, v68 row_newbcast:10 row_mask:0xf bank_mask:0xf
    v_mul_f32_dpp v203, v242, v69 row_newbcast:11 row_mask:0xf bank_mask:0xf
    v_cvt_pk_bf16_f32 v64, v196, v197
    v_cvt_pk_bf16_f32 v68, v198, v199
    v_cvt_pk_bf16_f32 v65, v200, v201
    v_cvt_pk_bf16_f32 v69, v202, v203
    v_mul_f32_dpp v196, v242, v66 row_newbcast:4 row_mask:0xf bank_mask:0xf
    v_mul_f32_dpp v197, v242, v67 row_newbcast:5 row_mask:0xf bank_mask:0xf
    v_mul_f32_dpp v198, v242, v66 row_newbcast:12 row_mask:0xf bank_mask:0xf
    v_mul_f32_dpp v199, v242, v67 row_newbcast:13 row_mask:0xf bank_mask:0xf
    v_mul_f32_dpp v200, v242, v70 row_newbcast:6 row_mask:0xf bank_mask:0xf
    v_mul_f32_dpp v201, v242, v71 row_newbcast:7 row_mask:0xf bank_mask:0xf
    v_mul_f32_dpp v202, v242, v70 row_newbcast:14 row_mask:0xf bank_mask:0xf
    v_mul_f32_dpp v203, v242, v71 row_newbcast:15 row_mask:0xf bank_mask:0xf
    v_cvt_pk_bf16_f32 v66, v196, v197
    v_cvt_pk_bf16_f32 v70, v198, v199
    v_cvt_pk_bf16_f32 v67, v200, v201
    v_cvt_pk_bf16_f32 v71, v202, v203
    s_nop 0
    s_waitcnt vmcnt(4) lgkmcnt(0)
    v_mfma_f32_32x32x16_bf16 v[0:15], v[64:67], v[176:179], 0
    v_mul_f32_dpp v196, v243, v72 row_newbcast:0 row_mask:0xf bank_mask:0xf
    v_mul_f32_dpp v197, v243, v73 row_newbcast:1 row_mask:0xf bank_mask:0xf
    v_mul_f32_dpp v198, v243, v72 row_newbcast:8 row_mask:0xf bank_mask:0xf
    v_mul_f32_dpp v199, v243, v73 row_newbcast:9 row_mask:0xf bank_mask:0xf
    v_mul_f32_dpp v200, v243, v76 row_newbcast:2 row_mask:0xf bank_mask:0xf
    v_mul_f32_dpp v201, v243, v77 row_newbcast:3 row_mask:0xf bank_mask:0xf
    v_mul_f32_dpp v202, v243, v76 row_newbcast:10 row_mask:0xf bank_mask:0xf
    v_mul_f32_dpp v203, v243, v77 row_newbcast:11 row_mask:0xf bank_mask:0xf
    v_cvt_pk_bf16_f32 v72, v196, v197
    v_cvt_pk_bf16_f32 v76, v198, v199
    v_cvt_pk_bf16_f32 v73, v200, v201
    v_cvt_pk_bf16_f32 v77, v202, v203
    s_add_u32 m0, s21, 0
    v_mfma_f32_32x32x16_bf16 v[16:31], v[68:71], v[176:179], 0
    buffer_load_dwordx4 v234, s[4:7], s36 offen  lds
    buffer_load_dwordx4 v235, s[8:11], s36 offen offset:1024  lds
    ds_read_b64_tr_b16 v[176:177], v244 offset:2048
    ds_read_b64_tr_b16 v[178:179], v244 offset:3072
    ds_read_b64_tr_b16 v[184:185], v245 offset:2048
    ds_read_b64_tr_b16 v[186:187], v245 offset:3072
    v_mul_f32_dpp v196, v243, v74 row_newbcast:4 row_mask:0xf bank_mask:0xf
    v_mul_f32_dpp v197, v243, v75 row_newbcast:5 row_mask:0xf bank_mask:0xf
    v_mul_f32_dpp v198, v243, v74 row_newbcast:12 row_mask:0xf bank_mask:0xf
    v_mul_f32_dpp v199, v243, v75 row_newbcast:13 row_mask:0xf bank_mask:0xf
    v_mul_f32_dpp v200, v243, v78 row_newbcast:6 row_mask:0xf bank_mask:0xf
    v_mul_f32_dpp v201, v243, v79 row_newbcast:7 row_mask:0xf bank_mask:0xf
    v_mul_f32_dpp v202, v243, v78 row_newbcast:14 row_mask:0xf bank_mask:0xf
    v_mul_f32_dpp v203, v243, v79 row_newbcast:15 row_mask:0xf bank_mask:0xf
    v_cvt_pk_bf16_f32 v74, v196, v197
    v_cvt_pk_bf16_f32 v78, v198, v199
    v_cvt_pk_bf16_f32 v75, v200, v201
    v_cvt_pk_bf16_f32 v79, v202, v203
    s_nop 0
    s_waitcnt lgkmcnt(0)
    v_mfma_f32_32x32x16_bf16 v[0:15], v[72:75], v[176:179], v[0:15]
    s_add_u32 m0, s21, 2048
    v_mfma_f32_32x32x16_bf16 v[16:31], v[76:79], v[176:179], v[16:31]
    buffer_load_dwordx4 v236, s[4:7], s36 offen  lds
    buffer_load_dwordx4 v237, s[8:11], s36 offen offset:1024  lds
    s_mov_b32 m0, s50
    s_nop 0
    s_movrels_b32 s71, s23
    s_movrels_b32 s33, s28
    v_add_u32 v253, s33, v248
    s_bfe_u32 s46, s71, 0x30012
    s_mov_b32 m0, s46
    s_and_b32 s66, s71, 0x3ffff
    s_movrels_b32 s68, s57
    s_movrels_b32 s69, s61
    s_sub_u32 s48, s66, s47
    s_mov_b32 s47, s66
    s_lshr_b32 s52, s71, 28
    s_lshl_b32 s67, s46, 9
    s_add_u32 s66, s66, s67
    s_sub_u32 s49, s66, s42
    s_mov_b32 s42, s66
    s_bfe_u32 s66, s68, 655360
    s_add_u32 s43, s42, s66
    s_bfe_u32 s39, s69, 655360
    s_bfe_u32 s66, s68, 655370
    s_add_u32 s44, s42, s66
    s_bfe_u32 s40, s69, 655370
    s_bfe_u32 s66, s68, 655380
    s_add_u32 s45, s42, s66
    s_bfe_u32 s41, s69, 655380
    v_add_u32 v252, s44, v247
    ds_read_u16 v238, v252
    ds_read_u16 v239, v252 offset:64
    v_add_u32 v252, s45, v247
    ds_read_u16 v240, v252
    ds_read_u16 v241, v252 offset:64
    v_mfma_f32_32x32x16_bf16 v[32:47], v[64:67], v[180:183], 0
    v_mul_f32 v196, v0, v96
    v_fmac_f32 v196, v1, v97
    v_fmac_f32 v196, v2, v98
    v_fmac_f32 v196, v3, v99
    v_fmac_f32 v196, v4, v100
    v_fmac_f32 v196, v5, v101
    v_fmac_f32 v196, v6, v102
    v_fmac_f32 v196, v7, v103
    v_mul_f32 v198, v8, v128
    v_fmac_f32 v198, v9, v129
    v_mfma_f32_32x32x16_bf16 v[48:63], v[68:71], v[180:183], 0
    s_waitcnt vmcnt(6)
    ds_read_b64_tr_b16 v[176:177], v244 offset:4096
    ds_read_b64_tr_b16 v[178:179], v244 offset:5120
    ds_read_b64_tr_b16 v[180:181], v245 offset:4096
    ds_read_b64_tr_b16 v[182:183], v245 offset:5120
    v_fmac_f32 v198, v10, v130
    v_fmac_f32 v198, v11, v131
    v_fmac_f32 v198, v12, v132
    v_fmac_f32 v198, v13, v133
    v_fmac_f32 v198, v14, v134
    v_fmac_f32 v198, v15, v135
    v_mul_f32 v200, v16, v128
    v_fmac_f32 v200, v17, v129
    v_permlane32_swap_b32 v196, v198
    v_mfma_f32_32x32x16_bf16 v[32:47], v[72:75], v[184:187], v[32:47]
    v_fmac_f32 v200, v18, v130
    v_fmac_f32 v200, v19, v131
    v_fmac_f32 v200, v20, v132
    v_fmac_f32 v200, v21, v133
    v_fmac_f32 v200, v22, v134
    v_fmac_f32 v200, v23, v135
    v_add_f32 v198, v196, v198
    v_mul_f32_e64 v202, v24, -v128
    v_fma_f32 v202, v25, -v129, v202
    v_mfma_f32_32x32x16_bf16 v[48:63], v[76:79], v[184:187], v[48:63]
    v_fma_f32 v202, v26, -v130, v202
    v_fma_f32 v202, v27, -v131, v202
    v_fma_f32 v202, v28, -v132, v202
    v_fma_f32 v202, v29, -v133, v202
    v_fma_f32 v202, v30, -v134, v202
    v_fma_f32 v202, v31, -v135, v202
    s_nop 1
    v_permlane32_swap_b32 v200, v202
    v_add_f32 v202, v200, v202
    s_waitcnt vmcnt(4) lgkmcnt(0)
    v_mfma_f32_32x32x16_bf16 v[0:15], v[64:67], v[176:179], 0
    v_mul_f32 v197, v32, v104
    v_fmac_f32 v197, v33, v105
    v_fmac_f32 v197, v34, v106
    v_fmac_f32 v197, v35, v107
    v_fmac_f32 v197, v36, v108
    v_fmac_f32 v197, v37, v109
    v_fmac_f32 v197, v38, v110
    v_fmac_f32 v197, v39, v111
    v_mul_f32 v199, v40, v136
    v_fmac_f32 v199, v41, v137
    s_add_u32 m0, s21, 4096
    v_mfma_f32_32x32x16_bf16 v[16:31], v[68:71], v[176:179], 0
    buffer_load_dwordx4 v234, s[4:7], s37 offen  lds
    buffer_load_dwordx4 v235, s[8:11], s37 offen offset:1024  lds
    ds_read_b64_tr_b16 v[176:177], v244 offset:6144
    ds_read_b64_tr_b16 v[178:179], v244 offset:7168
    ds_read_b64_tr_b16 v[184:185], v245 offset:6144
    ds_read_b64_tr_b16 v[186:187], v245 offset:7168
    v_add_u32 v252, s42, v247
    ds_read_u16 v234, v252
    ds_read_u16 v235, v252 offset:64
    v_fmac_f32 v199, v42, v138
    v_fmac_f32 v199, v43, v139
    v_fmac_f32 v199, v44, v140
    v_fmac_f32 v199, v45, v141
    v_fmac_f32 v199, v46, v142
    v_fmac_f32 v199, v47, v143
    v_mul_f32 v201, v48, v136
    v_fmac_f32 v201, v49, v137
    v_permlane32_swap_b32 v197, v199
    v_fmac_f32 v201, v50, v138
    s_waitcnt lgkmcnt(2)
    v_mfma_f32_32x32x16_bf16 v[0:15], v[72:75], v[176:179], v[0:15]
    v_fmac_f32 v201, v51, v139
    v_fmac_f32 v201, v52, v140
    v_fmac_f32 v201, v53, v141
    v_fmac_f32 v201, v54, v142
    v_fmac_f32 v201, v55, v143
    v_add_f32 v199, v197, v199
    v_mul_f32_e64 v203, v56, -v136
    v_fma_f32 v203, v57, -v137, v203
    v_fma_f32 v203, v58, -v138, v203
    v_fma_f32 v203, v59, -v139, v203
    s_add_u32 m0, s21, 6144
    v_mfma_f32_32x32x16_bf16 v[16:31], v[76:79], v[176:179], v[16:31]
    buffer_load_dwordx4 v236, s[4:7], s37 offen  lds
    buffer_load_dwordx4 v237, s[8:11], s37 offen offset:1024  lds
    v_add_u32 v252, s43, v247
    ds_read_u16 v236, v252
    ds_read_u16 v237, v252 offset:64
    v_fma_f32 v203, v60, -v140, v203
    v_fma_f32 v203, v61, -v141, v203
    v_fma_f32 v203, v62, -v142, v203
    v_fma_f32 v203, v63, -v143, v203
    s_nop 1
    v_permlane32_swap_b32 v201, v203
    v_add_f32 v203, v201, v203
    v_cvt_pk_bf16_f32 v192, v198, v199
    v_cvt_pk_bf16_f32 v193, v202, v203
    v_mfma_f32_32x32x16_bf16 v[32:47], v[64:67], v[180:183], 0
    v_mul_f32 v196, v0, v144
    v_fmac_f32 v196, v1, v145
    v_fmac_f32 v196, v2, v146
    v_fmac_f32 v196, v3, v147
    v_fmac_f32 v196, v4, v148
    v_fmac_f32 v196, v5, v149
    v_fmac_f32 v196, v6, v150
    v_fmac_f32 v196, v7, v151
    v_mfma_f32_32x32x16_bf16 v[48:63], v[68:71], v[180:183], 0
    s_waitcnt vmcnt(6)
    ds_read_b64_tr_b16 v[176:177], v244 offset:0
    ds_read_b64_tr_b16 v[178:179], v244 offset:1024
    ds_read_b64_tr_b16 v[180:181], v245 offset:0
    ds_read_b64_tr_b16 v[182:183], v245 offset:1024
    v_mul_f32 v198, v8, v112
    v_fmac_f32 v198, v9, v113
    v_fmac_f32 v198, v10, v114
    v_fmac_f32 v198, v11, v115
    v_fmac_f32 v198, v12, v116
    v_fmac_f32 v198, v13, v117
    v_fmac_f32 v198, v14, v118
    v_fmac_f32 v198, v15, v119
    v_mfma_f32_32x32x16_bf16 v[32:47], v[72:75], v[184:187], v[32:47]
    v_mul_f32_e64 v200, v16, -v160
    v_fma_f32 v200, v17, -v161, v200
    v_fma_f32 v200, v18, -v162, v200
    v_fma_f32 v200, v19, -v163, v200
    v_fma_f32 v200, v20, -v164, v200
    v_fma_f32 v200, v21, -v165, v200
    v_fma_f32 v200, v22, -v166, v200
    v_fma_f32 v200, v23, -v167, v200
    v_mfma_f32_32x32x16_bf16 v[48:63], v[76:79], v[184:187], v[48:63]
    v_mul_f32_e64 v202, v24, -v160
    v_fma_f32 v202, v25, -v161, v202
    v_fma_f32 v202, v26, -v162, v202
    v_fma_f32 v202, v27, -v163, v202
    v_fma_f32 v202, v28, -v164, v202
    v_fma_f32 v202, v29, -v165, v202
    v_fma_f32 v202, v30, -v166, v202
    v_fma_f32 v202, v31, -v167, v202
    s_waitcnt vmcnt(4) lgkmcnt(0)
    v_mfma_f32_32x32x16_bf16 v[0:15], v[64:67], v[176:179], 0
    v_mul_f32 v197, v32, v152
    v_fmac_f32 v197, v33, v153
    v_fmac_f32 v197, v34, v154
    v_fmac_f32 v197, v35, v155
    v_fmac_f32 v197, v36, v156
    v_fmac_f32 v197, v37, v157
    v_fmac_f32 v197, v38, v158
    v_fmac_f32 v197, v39, v159
    s_add_u32 m0, s21, 0
    s_cmp_eq_u32 s50, 4
    v_mfma_f32_32x32x16_bf16 v[16:31], v[68:71], v[176:179], 0
    s_cbranch_scc1 WL_4_0
    v_lshl_add_u32 v234, v234, 10, v246
    v_lshl_add_u32 v235, v235, 10, v246
    buffer_load_dwordx4 v234, s[4:7], s38 offen  lds
    buffer_load_dwordx4 v235, s[8:11], s38 offen offset:1024  lds
WR_4_0:
    ds_read_b64_tr_b16 v[176:177], v244 offset:2048
    ds_read_b64_tr_b16 v[178:179], v244 offset:3072
    ds_read_b64_tr_b16 v[184:185], v245 offset:2048
    ds_read_b64_tr_b16 v[186:187], v245 offset:3072
    v_mul_f32 v199, v40, v120
    v_fmac_f32 v199, v41, v121
    v_fmac_f32 v199, v42, v122
    v_fmac_f32 v199, v43, v123
    v_fmac_f32 v199, v44, v124
    v_fmac_f32 v199, v45, v125
    v_fmac_f32 v199, v46, v126
    v_fmac_f32 v199, v47, v127
    s_waitcnt lgkmcnt(0)
    v_mfma_f32_32x32x16_bf16 v[0:15], v[72:75], v[176:179], v[0:15]
    v_mul_f32_e64 v201, v48, -v168
    v_fma_f32 v201, v49, -v169, v201
    v_fma_f32 v201, v50, -v170, v201
    v_fma_f32 v201, v51, -v171, v201
    v_fma_f32 v201, v52, -v172, v201
    v_fma_f32 v201, v53, -v173, v201
    v_fma_f32 v201, v54, -v174, v201
    v_fma_f32 v201, v55, -v175, v201
    s_add_u32 m0, s21, 2048
    s_cmp_eq_u32 s50, 4
    v_mfma_f32_32x32x16_bf16 v[16:31], v[76:79], v[176:179], v[16:31]
    s_cbranch_scc1 WL_4_1
    v_lshl_add_u32 v236, v236, 10, v246
    v_lshl_add_u32 v237, v237, 10, v246
    buffer_load_dwordx4 v236, s[4:7], s39 offen  lds
    buffer_load_dwordx4 v237, s[8:11], s39 offen offset:1024  lds
WR_4_1:
    v_mul_f32_e64 v203, v56, -v168
    v_fma_f32 v203, v57, -v169, v203
    v_fma_f32 v203, v58, -v170, v203
    v_fma_f32 v203, v59, -v171, v203
    v_fma_f32 v203, v60, -v172, v203
    v_fma_f32 v203, v61, -v173, v203
    v_fma_f32 v203, v62, -v174, v203
    v_fma_f32 v203, v63, -v175, v203
    v_mfma_f32_32x32x16_bf16 v[32:47], v[64:67], v[180:183], 0
    v_mul_f32 v254, v0, v144
    v_fmac_f32 v254, v1, v145
    v_fmac_f32 v254, v2, v146
    v_fmac_f32 v254, v3, v147
    v_fmac_f32 v254, v4, v148
    v_mfma_f32_32x32x16_bf16 v[48:63], v[68:71], v[180:183], 0
    ds_swizzle_b32 v68, v68 offset:0x401F
    ds_swizzle_b32 v69, v69 offset:0x401F
    ds_swizzle_b32 v70, v70 offset:0x401F
    ds_swizzle_b32 v71, v71 offset:0x401F
    s_waitcnt vmcnt(6)
    ds_read_b64_tr_b16 v[176:177], v244 offset:4096
    ds_read_b64_tr_b16 v[178:179], v244 offset:5120
    ds_read_b64_tr_b16 v[180:181], v245 offset:4096
    ds_read_b64_tr_b16 v[182:183], v245 offset:5120
    v_fmac_f32 v254, v5, v149
    v_fmac_f32 v254, v6, v150
    v_fmac_f32 v254, v7, v151
    v_fmac_f32 v200, v8, v160
    v_mfma_f32_32x32x16_bf16 v[32:47], v[72:75], v[184:187], v[32:47]
    v_fmac_f32 v200, v9, v161
    v_permlane32_swap_b32 v196, v254
    v_fmac_f32 v200, v10, v162
    v_fmac_f32 v200, v11, v163
    v_fmac_f32 v200, v12, v164
    v_mfma_f32_32x32x16_bf16 v[48:63], v[76:79], v[184:187], v[48:63]
    ds_swizzle_b32 v76, v76 offset:0x401F
    ds_swizzle_b32 v77, v77 offset:0x401F
    ds_swizzle_b32 v78, v78 offset:0x401F
    ds_swizzle_b32 v79, v79 offset:0x401F
    v_fmac_f32 v200, v13, v165
    v_fmac_f32 v200, v14, v166
    v_fmac_f32 v200, v15, v167
    v_add_f32 v254, v196, v254
    s_waitcnt lgkmcnt(8)
    s_mov_b64 exec, s[56:57]
    v_xor_b32 v68, 0x80008000, v68
    v_xor_b32 v69, 0x80008000, v69
    v_xor_b32 v70, 0x80008000, v70
    v_xor_b32 v71, 0x80008000, v71
    s_mov_b64 exec, -1
    s_waitcnt vmcnt(4) lgkmcnt(4)
    v_mfma_f32_32x32x16_bf16 v[0:15], v[64:67], v[176:179], 0
    v_mul_f32 v255, v32, v152
    v_fmac_f32 v255, v33, v153
    v_fmac_f32 v255, v34, v154
    v_fmac_f32 v255, v35, v155
    v_fmac_f32 v255, v36, v156
    s_add_u32 m0, s21, 4096
    s_cmp_eq_u32 s50, 4
    v_mfma_f32_32x32x16_bf16 v[16:31], v[68:71], v[176:179], v[16:31]
    s_cbranch_scc1 WL_4_2
    v_lshl_add_u32 v238, v238, 10, v246
    v_lshl_add_u32 v239, v239, 10, v246
    buffer_load_dwordx4 v238, s[4:7], s40 offen  lds
    buffer_load_dwordx4 v239, s[8:11], s40 offen offset:1024  lds
WR_4_2:
    ds_read_b64_tr_b16 v[176:177], v244 offset:6144
    ds_read_b64_tr_b16 v[178:179], v244 offset:7168
    ds_read_b64_tr_b16 v[184:185], v245 offset:6144
    ds_read_b64_tr_b16 v[186:187], v245 offset:7168
    v_fmac_f32 v255, v37, v157
    v_fmac_f32 v255, v38, v158
    v_fmac_f32 v255, v39, v159
    v_fmac_f32 v201, v40, v168
    v_fmac_f32 v201, v41, v169
    s_waitcnt lgkmcnt(0)
    s_mov_b64 exec, s[56:57]
    v_xor_b32 v76, 0x80008000, v76
    v_xor_b32 v77, 0x80008000, v77
    v_xor_b32 v78, 0x80008000, v78
    v_xor_b32 v79, 0x80008000, v79
    s_mov_b64 exec, -1
    v_mfma_f32_32x32x16_bf16 v[0:15], v[72:75], v[176:179], v[0:15]
    v_permlane32_swap_b32 v197, v255
    v_fmac_f32 v201, v42, v170
    v_fmac_f32 v201, v43, v171
    v_fmac_f32 v201, v44, v172
    v_fmac_f32 v201, v45, v173
    s_add_u32 m0, s21, 6144
    s_cmp_eq_u32 s50, 4
    v_mfma_f32_32x32x16_bf16 v[16:31], v[76:79], v[176:179], v[16:31]
    s_cbranch_scc1 WL_4_3
    v_lshl_add_u32 v240, v240, 10, v246
    v_lshl_add_u32 v241, v241, 10, v246
    buffer_load_dwordx4 v240, s[4:7], s41 offen  lds
    buffer_load_dwordx4 v241, s[8:11], s41 offen offset:1024  lds
WR_4_3:
    v_fmac_f32 v201, v46, v174
    v_fmac_f32 v201, v47, v175
    v_add_f32 v255, v197, v255
    v_cvt_pk_bf16_f32 v194, v254, v255
    v_mfma_f32_32x32x16_bf16 v[32:47], v[64:67], v[180:183], 0
    v_mul_f32 v254, v0, v144
    v_fmac_f32 v254, v1, v145
    v_fmac_f32 v254, v2, v146
    v_fmac_f32 v254, v3, v147
    v_fmac_f32 v254, v4, v148
    v_fmac_f32 v254, v5, v149
    v_fmac_f32 v254, v6, v150
    v_fmac_f32 v254, v7, v151
    v_fma_f32 v202, v8, -v160, v202
    v_fma_f32 v202, v9, -v161, v202
    v_mfma_f32_32x32x16_bf16 v[48:63], v[68:71], v[180:183], v[48:63]
    s_waitcnt vmcnt(6)
    ds_read_b64_tr_b16 v[176:177], v244 offset:0
    ds_read_b64_tr_b16 v[178:179], v244 offset:1024
    ds_read_b64_tr_b16 v[180:181], v245 offset:0
    ds_read_b64_tr_b16 v[182:183], v245 offset:1024
    v_permlane32_swap_b32 v254, v200
    v_fma_f32 v202, v10, -v162, v202
    v_fma_f32 v202, v11, -v163, v202
    v_fma_f32 v202, v12, -v164, v202
    v_fma_f32 v202, v13, -v165, v202
    v_fma_f32 v202, v14, -v166, v202
    v_fma_f32 v202, v15, -v167, v202
    v_add_f32 v200, v254, v200
    v_fmac_f32 v198, v16, v112
    v_permlane32_swap_b32 v202, v254
    v_mfma_f32_32x32x16_bf16 v[32:47], v[72:75], v[184:187], v[32:47]
    v_fmac_f32 v198, v17, v113
    v_fmac_f32 v198, v18, v114
    v_fmac_f32 v198, v19, v115
    v_fmac_f32 v198, v20, v116
    v_fmac_f32 v198, v21, v117
    v_fmac_f32 v198, v22, v118
    v_fmac_f32 v198, v23, v119
    v_add_f32 v254, v202, v254
    v_mul_f32 v196, v24, v160
    v_fmac_f32 v196, v25, v161
    v_mfma_f32_32x32x16_bf16 v[48:63], v[76:79], v[184:187], v[48:63]
    v_add_u32 v249, s48, v249
    v_add_u32 v250, s49, v250
    ds_read_b32 v252, v251 offset:16
    ds_read_b64_tr_b16 v[64:65], v249 offset:0
    ds_read_b64_tr_b16 v[68:69], v249 offset:64
    ds_read_b64_tr_b16 v[66:67], v249 offset:256
    ds_read_b64_tr_b16 v[70:71], v249 offset:320
    s_mov_b64 exec, s[54:55]
    ds_read_u16_d16_hi v242, v250 offset:0
    s_mov_b64 exec, -1
    v_fmac_f32 v196, v26, v162
    v_fmac_f32 v196, v27, v163
    v_fmac_f32 v196, v28, v164
    v_fmac_f32 v196, v29, v165
    v_fmac_f32 v196, v30, v166
    v_fmac_f32 v196, v31, v167
    s_nop 1
    v_permlane32_swap_b32 v198, v196
    v_add_f32 v196, v198, v196
    s_cmp_eq_u32 s50, 4
    s_cbranch_scc1 LEPI_0
    v_mul_f32 v255, v32, v152
    v_fmac_f32 v255, v33, v153
    v_fmac_f32 v255, v34, v154
    v_fmac_f32 v255, v35, v155
    v_fmac_f32 v255, v36, v156
    v_fmac_f32 v255, v37, v157
    v_fmac_f32 v255, v38, v158
    v_fmac_f32 v255, v39, v159
    v_fma_f32 v203, v40, -v168, v203
    v_fma_f32 v203, v41, -v169, v203
    v_permlane32_swap_b32 v255, v201
    v_fma_f32 v203, v42, -v170, v203
    v_fma_f32 v203, v43, -v171, v203
    v_fma_f32 v203, v44, -v172, v203
    v_fma_f32 v203, v45, -v173, v203
    v_fma_f32 v203, v46, -v174, v203
    v_fma_f32 v203, v47, -v175, v203
    v_add_f32 v201, v255, v201
    v_fmac_f32 v199, v48, v120
    v_permlane32_swap_b32 v203, v255
    v_fmac_f32 v199, v49, v121
    v_fmac_f32 v199, v50, v122
    v_fmac_f32 v199, v51, v123
    v_fmac_f32 v199, v52, v124
    v_fmac_f32 v199, v53, v125
    v_fmac_f32 v199, v54, v126
    v_fmac_f32 v199, v55, v127
    v_add_f32 v255, v203, v255
    v_mul_f32 v197, v56, v168
    v_fmac_f32 v197, v57, v169
    v_fmac_f32 v197, v58, v170
    v_fmac_f32 v197, v59, v171
    v_fmac_f32 v197, v60, v172
    v_fmac_f32 v197, v61, v173
    v_fmac_f32 v197, v62, v174
    v_fmac_f32 v197, v63, v175
    s_nop 1
    v_permlane32_swap_b32 v199, v197
    v_add_f32 v197, v199, v197
    v_cvt_pk_bf16_f32 v200, v200, v201
    v_cvt_pk_bf16_f32 v254, v254, v255
    v_cvt_pk_bf16_f32 v196, v196, v197
    ds_write2st64_b32 v253, v192, v193 offset0:0 offset1:1
    ds_write2st64_b32 v253, v194, v200 offset0:2 offset1:3
    ds_write_b32 v253, v196 offset:1024
    s_mov_b64 exec, 0xffffffff
    ds_write_b32 v253, v254 offset:1280
    s_mov_b64 exec, -1
    s_add_u32 s50, s50, 1
    s_cmp_ge_u32 s50, 4
    s_cbranch_scc1 LAST1
    s_waitcnt lgkmcnt(9)
    v_readfirstlane_b32 s66, v252
    s_add_u32 s53, s53, 1
    v_mov_b32 v252, s53
    s_cmp_le_u32 s53, s66
    ds_write2_b32 v251, v252, v252 offset0:0 offset1:8
    s_setprio 1
    s_cbranch_scc1 PRIO_11
    s_setprio 0
PRIO_11:
    s_cmp_eq_u32 s52, 4
    s_cbranch_scc1 ITEM_1_4
    s_cmp_eq_u32 s52, 5
    s_cbranch_scc1 ITEM_1_5
    s_cmp_eq_u32 s52, 3
    s_cbranch_scc1 ITEM_1_3
    s_cmp_eq_u32 s52, 6
    s_cbranch_scc1 ITEM_1_6
    s_cmp_eq_u32 s52, 8
    s_cbranch_scc1 ITEM_1_8
    s_branch ITEM_1_2
WL_4_0:
    s_add_u32 s66, s51, 0
    buffer_load_dwordx4 v[96:99], v246, s[16:19], s66 offen offset:2048 sc1
    buffer_load_dwordx4 v[100:103], v246, s[16:19], s66 offen offset:3072 sc1
    s_branch WR_4_0
WL_4_1:
    s_add_u32 s66, s51, 4096
    buffer_load_dwordx4 v[104:107], v246, s[16:19], s66 offen offset:2048 sc1
    buffer_load_dwordx4 v[108:111], v246, s[16:19], s66 offen offset:3072 sc1
    s_branch WR_4_1
WL_4_2:
    s_add_u32 s66, s51, 8192
    buffer_load_dwordx4 v[128:131], v246, s[16:19], s66 offen offset:2048 sc1
    buffer_load_dwordx4 v[132:135], v246, s[16:19], s66 offen offset:3072 sc1
    s_branch WR_4_2
WL_4_3:
    s_add_u32 s66, s51, 12288
    buffer_load_dwordx4 v[136:139], v246, s[16:19], s66 offen offset:2048 sc1
    buffer_load_dwordx4 v[140:143], v246, s[16:19], s66 offen offset:3072 sc1
    s_branch WR_4_3
.p2align 6
ITEM_1_5:
    s_mov_b64 exec, s[54:55]
    ds_read_u16_d16_hi v243, v250 offset:128
    s_mov_b64 exec, -1
    ds_read_b64_tr_b16 v[72:73], v249 offset:512
    ds_read_b64_tr_b16 v[76:77], v249 offset:576
    ds_read_b64_tr_b16 v[74:75], v249 offset:768
    ds_read_b64_tr_b16 v[78:79], v249 offset:832
    ds_read_b64_tr_b16 v[80:81], v249 offset:1024
    ds_read_b64_tr_b16 v[84:85], v249 offset:1088
    s_waitcnt lgkmcnt(7)
    v_mul_f32_dpp v196, v242, v64 row_newbcast:0 row_mask:0xf bank_mask:0xf
    v_mul_f32_dpp v197, v242, v65 row_newbcast:1 row_mask:0xf bank_mask:0xf
    v_mul_f32_dpp v198, v242, v64 row_newbcast:8 row_mask:0xf bank_mask:0xf
    v_mul_f32_dpp v199, v242, v65 row_newbcast:9 row_mask:0xf bank_mask:0xf
    v_mul_f32_dpp v200, v242, v68 row_newbcast:2 row_mask:0xf bank_mask:0xf
    v_mul_f32_dpp v201, v242, v69 row_newbcast:3 row_mask:0xf bank_mask:0xf
    v_mul_f32_dpp v202, v242, v68 row_newbcast:10 row_mask:0xf bank_mask:0xf
    v_mul_f32_dpp v203, v242, v69 row_newbcast:11 row_mask:0xf bank_mask:0xf
    v_cvt_pk_bf16_f32 v64, v196, v197
    v_cvt_pk_bf16_f32 v68, v198, v199
    v_cvt_pk_bf16_f32 v65, v200, v201
    v_cvt_pk_bf16_f32 v69, v202, v203
    v_mul_f32_dpp v196, v242, v66 row_newbcast:4 row_mask:0xf bank_mask:0xf
    v_mul_f32_dpp v197, v242, v67 row_newbcast:5 row_mask:0xf bank_mask:0xf
    v_mul_f32_dpp v198, v242, v66 row_newbcast:12 row_mask:0xf bank_mask:0xf
    v_mul_f32_dpp v199, v242, v67 row_newbcast:13 row_mask:0xf bank_mask:0xf
    v_mul_f32_dpp v200, v242, v70 row_newbcast:6 row_mask:0xf bank_mask:0xf
    v_mul_f32_dpp v201, v242, v71 row_newbcast:7 row_mask:0xf bank_mask:0xf
    v_mul_f32_dpp v202, v242, v70 row_newbcast:14 row_mask:0xf bank_mask:0xf
    v_mul_f32_dpp v203, v242, v71 row_newbcast:15 row_mask:0xf bank_mask:0xf
    v_cvt_pk_bf16_f32 v66, v196, v197
    v_cvt_pk_bf16_f32 v70, v198, v199
    v_cvt_pk_bf16_f32 v67, v200, v201
    v_cvt_pk_bf16_f32 v71, v202, v203
    s_mov_b64 exec, s[54:55]
    ds_read_u16_d16_hi v242, v250 offset:256
    s_mov_b64 exec, -1
    s_waitcnt vmcnt(4) lgkmcnt(3)
    v_mfma_f32_32x32x16_bf16 v[0:15], v[64:67], v[176:179], 0
    v_mul_f32_dpp v196, v243, v72 row_newbcast:0 row_mask:0xf bank_mask:0xf
    v_mul_f32_dpp v197, v243, v73 row_newbcast:1 row_mask:0xf bank_mask:0xf
    v_mul_f32_dpp v198, v243, v72 row_newbcast:8 row_mask:0xf bank_mask:0xf
    v_mul_f32_dpp v199, v243, v73 row_newbcast:9 row_mask:0xf bank_mask:0xf
    v_mul_f32_dpp v200, v243, v76 row_newbcast:2 row_mask:0xf bank_mask:0xf
    v_mul_f32_dpp v201, v243, v77 row_newbcast:3 row_mask:0xf bank_mask:0xf
    v_mul_f32_dpp v202, v243, v76 row_newbcast:10 row_mask:0xf bank_mask:0xf
    v_mul_f32_dpp v203, v243, v77 row_newbcast:11 row_mask:0xf bank_mask:0xf
    v_cvt_pk_bf16_f32 v72, v196, v197
    v_cvt_pk_bf16_f32 v76, v198, v199
    v_cvt_pk_bf16_f32 v73, v200, v201
    v_cvt_pk_bf16_f32 v77, v202, v203
    s_add_u32 m0, s21, 0
    v_mfma_f32_32x32x16_bf16 v[16:31], v[68:71], v[176:179], 0
    buffer_load_dwordx4 v236, s[4:7], s35 offen  lds
    buffer_load_dwordx4 v237, s[8:11], s35 offen offset:1024  lds
    ds_read_b64_tr_b16 v[176:177], v244 offset:2048
    ds_read_b64_tr_b16 v[178:179], v244 offset:3072
    ds_read_b64_tr_b16 v[184:185], v245 offset:2048
    ds_read_b64_tr_b16 v[186:187], v245 offset:3072
    v_mul_f32_dpp v196, v243, v74 row_newbcast:4 row_mask:0xf bank_mask:0xf
    v_mul_f32_dpp v197, v243, v75 row_newbcast:5 row_mask:0xf bank_mask:0xf
    v_mul_f32_dpp v198, v243, v74 row_newbcast:12 row_mask:0xf bank_mask:0xf
    v_mul_f32_dpp v199, v243, v75 row_newbcast:13 row_mask:0xf bank_mask:0xf
    v_mul_f32_dpp v200, v243, v78 row_newbcast:6 row_mask:0xf bank_mask:0xf
    v_mul_f32_dpp v201, v243, v79 row_newbcast:7 row_mask:0xf bank_mask:0xf
    v_mul_f32_dpp v202, v243, v78 row_newbcast:14 row_mask:0xf bank_mask:0xf
    v_mul_f32_dpp v203, v243, v79 row_newbcast:15 row_mask:0xf bank_mask:0xf
    v_cvt_pk_bf16_f32 v74, v196, v197
    v_cvt_pk_bf16_f32 v78, v198, v199
    v_cvt_pk_bf16_f32 v75, v200, v201
    v_cvt_pk_bf16_f32 v79, v202, v203
    s_nop 0
    s_waitcnt vmcnt(4) lgkmcnt(0)
    v_mfma_f32_32x32x16_bf16 v[0:15], v[72:75], v[176:179], v[0:15]
    v_mul_f32_dpp v196, v242, v80 row_newbcast:0 row_mask:0xf bank_mask:0xf
    v_mul_f32_dpp v197, v242, v81 row_newbcast:1 row_mask:0xf bank_mask:0xf
    v_mul_f32_dpp v198, v242, v80 row_newbcast:8 row_mask:0xf bank_mask:0xf
    v_mul_f32_dpp v199, v242, v81 row_newbcast:9 row_mask:0xf bank_mask:0xf
    v_mul_f32_dpp v200, v242, v84 row_newbcast:2 row_mask:0xf bank_mask:0xf
    v_mul_f32_dpp v201, v242, v85 row_newbcast:3 row_mask:0xf bank_mask:0xf
    s_add_u32 m0, s21, 2048
    v_mfma_f32_32x32x16_bf16 v[16:31], v[76:79], v[176:179], v[16:31]
    buffer_load_dwordx4 v238, s[4:7], s35 offen  lds
    ds_read_b64_tr_b16 v[176:177], v244 offset:4096
    ds_read_b64_tr_b16 v[188:189], v245 offset:4096
    v_mul_f32_dpp v202, v242, v84 row_newbcast:10 row_mask:0xf bank_mask:0xf
    v_mul_f32_dpp v203, v242, v85 row_newbcast:11 row_mask:0xf bank_mask:0xf
    v_cvt_pk_bf16_f32 v80, v196, v197
    v_cvt_pk_bf16_f32 v84, v198, v199
    v_cvt_pk_bf16_f32 v81, v200, v201
    v_cvt_pk_bf16_f32 v85, v202, v203
    s_nop 0
    s_waitcnt lgkmcnt(0)
    v_mfma_f32_32x32x8_bf16 v[0:15], v[80:81], v[176:177], v[0:15]
    s_add_u32 m0, s21, 4096
    v_mfma_f32_32x32x8_bf16 v[16:31], v[84:85], v[176:177], v[16:31]
    buffer_load_dwordx4 v234, s[4:7], s36 offen  lds
    buffer_load_dwordx4 v235, s[8:11], s36 offen offset:1024  lds
    s_mov_b32 m0, s50
    s_nop 0
    s_movrels_b32 s71, s23
    s_movrels_b32 s33, s28
    v_add_u32 v253, s33, v248
    s_bfe_u32 s46, s71, 0x30012
    s_mov_b32 m0, s46
    s_and_b32 s66, s71, 0x3ffff
    s_movrels_b32 s68, s57
    s_movrels_b32 s69, s61
    s_sub_u32 s48, s66, s47
    s_mov_b32 s47, s66
    s_lshr_b32 s52, s71, 28
    s_lshl_b32 s67, s46, 9
    s_add_u32 s66, s66, s67
    s_sub_u32 s49, s66, s42
    s_mov_b32 s42, s66
    s_bfe_u32 s66, s68, 655360
    s_add_u32 s43, s42, s66
    s_bfe_u32 s39, s69, 655360
    s_bfe_u32 s66, s68, 655370
    s_add_u32 s44, s42, s66
    s_bfe_u32 s40, s69, 655370
    s_bfe_u32 s66, s68, 655380
    s_add_u32 s45, s42, s66
    s_bfe_u32 s41, s69, 655380
    v_add_u32 v252, s45, v247
    ds_read_u16 v240, v252
    ds_read_u16 v241, v252 offset:64
    v_mfma_f32_32x32x16_bf16 v[32:47], v[64:67], v[180:183], 0
    v_mul_f32 v196, v0, v96
    v_fmac_f32 v196, v1, v97
    v_fmac_f32 v196, v2, v98
    v_fmac_f32 v196, v3, v99
    v_fmac_f32 v196, v4, v100
    v_fmac_f32 v196, v5, v101
    v_fmac_f32 v196, v6, v102
    v_mfma_f32_32x32x16_bf16 v[48:63], v[68:71], v[180:183], 0
    v_fmac_f32 v196, v7, v103
    v_mul_f32 v198, v8, v128
    v_fmac_f32 v198, v9, v129
    v_fmac_f32 v198, v10, v130
    v_fmac_f32 v198, v11, v131
    v_fmac_f32 v198, v12, v132
    v_mfma_f32_32x32x16_bf16 v[32:47], v[72:75], v[184:187], v[32:47]
    v_fmac_f32 v198, v13, v133
    v_fmac_f32 v198, v14, v134
    v_fmac_f32 v198, v15, v135
    v_mul_f32 v200, v16, v128
    v_fmac_f32 v200, v17, v129
    v_permlane32_swap_b32 v196, v198
    v_mfma_f32_32x32x16_bf16 v[48:63], v[76:79], v[184:187], v[48:63]
    s_waitcnt vmcnt(5)
    ds_read_b64_tr_b16 v[176:177], v244 offset:6144
    ds_read_b64_tr_b16 v[178:179], v244 offset:7168
    ds_read_b64_tr_b16 v[180:181], v245 offset:6144
    ds_read_b64_tr_b16 v[182:183], v245 offset:7168
    v_fmac_f32 v200, v18, v130
    v_fmac_f32 v200, v19, v131
    v_fmac_f32 v200, v20, v132
    v_fmac_f32 v200, v21, v133
    v_fmac_f32 v200, v22, v134
    v_fmac_f32 v200, v23, v135
    v_mfma_f32_32x32x8_bf16 v[32:47], v[80:81], v[188:189], v[32:47]
    v_add_f32 v198, v196, v198
    v_mul_f32_e64 v202, v24, -v128
    v_fma_f32 v202, v25, -v129, v202
    v_fma_f32 v202, v26, -v130, v202
    v_fma_f32 v202, v27, -v131, v202
    v_fma_f32 v202, v28, -v132, v202
    v_mfma_f32_32x32x8_bf16 v[48:63], v[84:85], v[188:189], v[48:63]
    v_fma_f32 v202, v29, -v133, v202
    v_fma_f32 v202, v30, -v134, v202
    v_fma_f32 v202, v31, -v135, v202
    s_nop 1
    v_permlane32_swap_b32 v200, v202
    v_add_f32 v202, v200, v202
    s_waitcnt vmcnt(3) lgkmcnt(0)
    v_mfma_f32_32x32x16_bf16 v[0:15], v[64:67], v[176:179], 0
    v_mul_f32 v197, v32, v104
    v_fmac_f32 v197, v33, v105
    v_fmac_f32 v197, v34, v106
    v_fmac_f32 v197, v35, v107
    v_fmac_f32 v197, v36, v108
    v_fmac_f32 v197, v37, v109
    v_fmac_f32 v197, v38, v110
    s_add_u32 m0, s21, 6144
    v_mfma_f32_32x32x16_bf16 v[16:31], v[68:71], v[176:179], 0
    buffer_load_dwordx4 v236, s[4:7], s36 offen  lds
    buffer_load_dwordx4 v237, s[8:11], s36 offen offset:1024  lds
    ds_read_b64_tr_b16 v[176:177], v244 offset:0
    ds_read_b64_tr_b16 v[178:179], v244 offset:1024
    ds_read_b64_tr_b16 v[184:185], v245 offset:0
    ds_read_b64_tr_b16 v[186:187], v245 offset:1024
    v_fmac_f32 v197, v39, v111
    v_mul_f32 v199, v40, v136
    v_fmac_f32 v199, v41, v137
    v_fmac_f32 v199, v42, v138
    v_fmac_f32 v199, v43, v139
    v_fmac_f32 v199, v44, v140
    s_waitcnt vmcnt(4) lgkmcnt(0)
    v_mfma_f32_32x32x16_bf16 v[0:15], v[72:75], v[176:179], v[0:15]
    v_fmac_f32 v199, v45, v141
    v_fmac_f32 v199, v46, v142
    v_fmac_f32 v199, v47, v143
    v_mul_f32 v201, v48, v136
    v_fmac_f32 v201, v49, v137
    v_permlane32_swap_b32 v197, v199
    v_fmac_f32 v201, v50, v138
    s_add_u32 m0, s21, 0
    v_mfma_f32_32x32x16_bf16 v[16:31], v[76:79], v[176:179], v[16:31]
    buffer_load_dwordx4 v238, s[4:7], s36 offen  lds
    ds_read_b64_tr_b16 v[176:177], v244 offset:2048
    ds_read_b64_tr_b16 v[188:189], v245 offset:2048
    v_fmac_f32 v201, v51, v139
    v_fmac_f32 v201, v52, v140
    v_fmac_f32 v201, v53, v141
    v_fmac_f32 v201, v54, v142
    v_fmac_f32 v201, v55, v143
    v_add_f32 v199, v197, v199
    s_waitcnt lgkmcnt(0)
    v_mfma_f32_32x32x8_bf16 v[0:15], v[80:81], v[176:177], v[0:15]
    v_mul_f32_e64 v203, v56, -v136
    v_fma_f32 v203, v57, -v137, v203
    v_fma_f32 v203, v58, -v138, v203
    v_fma_f32 v203, v59, -v139, v203
    v_fma_f32 v203, v60, -v140, v203
    v_fma_f32 v203, v61, -v141, v203
    v_fma_f32 v203, v62, -v142, v203
    s_add_u32 m0, s21, 2048
    v_mfma_f32_32x32x8_bf16 v[16:31], v[84:85], v[176:177], v[16:31]
    buffer_load_dwordx4 v234, s[4:7], s37 offen  lds
    buffer_load_dwordx4 v235, s[8:11], s37 offen offset:1024  lds
    v_add_u32 v252, s42, v247
    ds_read_u16 v234, v252
    ds_read_u16 v235, v252 offset:64
    v_fma_f32 v203, v63, -v143, v203
    s_nop 1
    v_permlane32_swap_b32 v201, v203
    v_add_f32 v203, v201, v203
    v_cvt_pk_bf16_f32 v192, v198, v199
    v_cvt_pk_bf16_f32 v193, v202, v203
    v_mfma_f32_32x32x16_bf16 v[32:47], v[64:67], v[180:183], 0
    v_mul_f32 v196, v0, v144
    v_fmac_f32 v196, v1, v145
    v_fmac_f32 v196, v2, v146
    v_fmac_f32 v196, v3, v147
    v_fmac_f32 v196, v4, v148
    v_fmac_f32 v196, v5, v149
    v_mfma_f32_32x32x16_bf16 v[48:63], v[68:71], v[180:183], 0
    v_fmac_f32 v196, v6, v150
    v_fmac_f32 v196, v7, v151
    v_mul_f32 v198, v8, v112
    v_fmac_f32 v198, v9, v113
    v_fmac_f32 v198, v10, v114
    v_mfma_f32_32x32x16_bf16 v[32:47], v[72:75], v[184:187], v[32:47]
    v_fmac_f32 v198, v11, v115
    v_fmac_f32 v198, v12, v116
    v_fmac_f32 v198, v13, v117
    v_fmac_f32 v198, v14, v118
    v_fmac_f32 v198, v15, v119
    v_mfma_f32_32x32x16_bf16 v[48:63], v[76:79], v[184:187], v[48:63]
    s_waitcnt vmcnt(5)
    ds_read_b64_tr_b16 v[176:177], v244 offset:4096
    ds_read_b64_tr_b16 v[178:179], v244 offset:5120
    ds_read_b64_tr_b16 v[180:181], v245 offset:4096
    ds_read_b64_tr_b16 v[182:183], v245 offset:5120
    v_mul_f32_e64 v200, v16, -v160
    v_fma_f32 v200, v17, -v161, v200
    v_fma_f32 v200, v18, -v162, v200
    v_fma_f32 v200, v19, -v163, v200
    v_fma_f32 v200, v20, -v164, v200
    v_fma_f32 v200, v21, -v165, v200
    v_mfma_f32_32x32x8_bf16 v[32:47], v[80:81], v[188:189], v[32:47]
    v_fma_f32 v200, v22, -v166, v200
    v_fma_f32 v200, v23, -v167, v200
    v_mul_f32_e64 v202, v24, -v160
    v_fma_f32 v202, v25, -v161, v202
    v_fma_f32 v202, v26, -v162, v202
    v_mfma_f32_32x32x8_bf16 v[48:63], v[84:85], v[188:189], v[48:63]
    v_fma_f32 v202, v27, -v163, v202
    v_fma_f32 v202, v28, -v164, v202
    v_fma_f32 v202, v29, -v165, v202
    v_fma_f32 v202, v30, -v166, v202
    v_fma_f32 v202, v31, -v167, v202
    s_waitcnt vmcnt(3) lgkmcnt(0)
    v_mfma_f32_32x32x16_bf16 v[0:15], v[64:67], v[176:179], 0
    v_mul_f32 v197, v32, v152
    v_fmac_f32 v197, v33, v153
    v_fmac_f32 v197, v34, v154
    v_fmac_f32 v197, v35, v155
    v_fmac_f32 v197, v36, v156
    v_fmac_f32 v197, v37, v157
    s_add_u32 m0, s21, 4096
    v_mfma_f32_32x32x16_bf16 v[16:31], v[68:71], v[176:179], 0
    buffer_load_dwordx4 v236, s[4:7], s37 offen  lds
    buffer_load_dwordx4 v237, s[8:11], s37 offen offset:1024  lds
    ds_read_b64_tr_b16 v[176:177], v244 offset:6144
    ds_read_b64_tr_b16 v[178:179], v244 offset:7168
    ds_read_b64_tr_b16 v[184:185], v245 offset:6144
    ds_read_b64_tr_b16 v[186:187], v245 offset:7168
    v_add_u32 v252, s43, v247
    ds_read_u16 v236, v252
    ds_read_u16 v237, v252 offset:64
    v_fmac_f32 v197, v38, v158
    v_fmac_f32 v197, v39, v159
    v_mul_f32 v199, v40, v120
    v_fmac_f32 v199, v41, v121
    v_fmac_f32 v199, v42, v122
    s_waitcnt vmcnt(4) lgkmcnt(2)
    v_mfma_f32_32x32x16_bf16 v[0:15], v[72:75], v[176:179], v[0:15]
    v_fmac_f32 v199, v43, v123
    v_fmac_f32 v199, v44, v124
    v_fmac_f32 v199, v45, v125
    v_fmac_f32 v199, v46, v126
    v_fmac_f32 v199, v47, v127
    s_add_u32 m0, s21, 6144
    v_mfma_f32_32x32x16_bf16 v[16:31], v[76:79], v[176:179], v[16:31]
    buffer_load_dwordx4 v238, s[4:7], s37 offen  lds
    ds_read_b64_tr_b16 v[176:177], v244 offset:0
    ds_read_b64_tr_b16 v[188:189], v245 offset:0
    v_add_u32 v252, s44, v247
    ds_read_u16 v238, v252
    ds_read_u16 v239, v252 offset:64
    v_mul_f32_e64 v201, v48, -v168
    v_fma_f32 v201, v49, -v169, v201
    v_fma_f32 v201, v50, -v170, v201
    v_fma_f32 v201, v51, -v171, v201
    v_fma_f32 v201, v52, -v172, v201
    v_fma_f32 v201, v53, -v173, v201
    s_waitcnt lgkmcnt(2)
    v_mfma_f32_32x32x8_bf16 v[0:15], v[80:81], v[176:177], v[0:15]
    v_fma_f32 v201, v54, -v174, v201
    v_fma_f32 v201, v55, -v175, v201
    v_mul_f32_e64 v203, v56, -v168
    v_fma_f32 v203, v57, -v169, v203
    v_fma_f32 v203, v58, -v170, v203
    s_add_u32 m0, s21, 0
    s_cmp_eq_u32 s50, 4
    v_mfma_f32_32x32x8_bf16 v[16:31], v[84:85], v[176:177], v[16:31]
    s_cbranch_scc1 WL_5_0
    v_lshl_add_u32 v234, v234, 10, v246
    v_lshl_add_u32 v235, v235, 10, v246
    buffer_load_dwordx4 v234, s[4:7], s38 offen  lds
    buffer_load_dwordx4 v235, s[8:11], s38 offen offset:1024  lds
WR_5_0:
    v_fma_f32 v203, v59, -v171, v203
    v_fma_f32 v203, v60, -v172, v203
    v_fma_f32 v203, v61, -v173, v203
    v_fma_f32 v203, v62, -v174, v203
    v_fma_f32 v203, v63, -v175, v203
    v_mfma_f32_32x32x16_bf16 v[32:47], v[64:67], v[180:183], 0
    v_mul_f32 v254, v0, v144
    v_fmac_f32 v254, v1, v145
    v_fmac_f32 v254, v2, v146
    v_mfma_f32_32x32x16_bf16 v[48:63], v[68:71], v[180:183], 0
    ds_swizzle_b32 v68, v68 offset:0x401F
    ds_swizzle_b32 v69, v69 offset:0x401F
    ds_swizzle_b32 v70, v70 offset:0x401F
    ds_swizzle_b32 v71, v71 offset:0x401F
    v_fmac_f32 v254, v3, v147
    v_fmac_f32 v254, v4, v148
    v_fmac_f32 v254, v5, v149
    v_mfma_f32_32x32x16_bf16 v[32:47], v[72:75], v[184:187], v[32:47]
    v_fmac_f32 v254, v6, v150
    v_fmac_f32 v254, v7, v151
    v_fmac_f32 v200, v8, v160
    v_mfma_f32_32x32x16_bf16 v[48:63], v[76:79], v[184:187], v[48:63]
    ds_swizzle_b32 v76, v76 offset:0x401F
    ds_swizzle_b32 v77, v77 offset:0x401F
    ds_swizzle_b32 v78, v78 offset:0x401F
    ds_swizzle_b32 v79, v79 offset:0x401F
    s_waitcnt vmcnt(5)
    ds_read_b64_tr_b16 v[176:177], v244 offset:2048
    ds_read_b64_tr_b16 v[178:179], v244 offset:3072
    ds_read_b64_tr_b16 v[180:181], v245 offset:2048
    ds_read_b64_tr_b16 v[182:183], v245 offset:3072
    v_fmac_f32 v200, v9, v161
    v_permlane32_swap_b32 v196, v254
    v_fmac_f32 v200, v10, v162
    v_mfma_f32_32x32x8_bf16 v[32:47], v[80:81], v[188:189], v[32:47]
    v_fmac_f32 v200, v11, v163
    v_fmac_f32 v200, v12, v164
    v_fmac_f32 v200, v13, v165
    v_mfma_f32_32x32x8_bf16 v[48:63], v[84:85], v[188:189], v[48:63]
    ds_swizzle_b32 v84, v84 offset:0x401F
    ds_swizzle_b32 v85, v85 offset:0x401F
    v_fmac_f32 v200, v14, v166
    v_fmac_f32 v200, v15, v167
    v_add_f32 v254, v196, v254
    s_waitcnt lgkmcnt(6)
    s_mov_b64 exec, s[56:57]
    v_xor_b32 v68, 0x80008000, v68
    v_xor_b32 v69, 0x80008000, v69
    v_xor_b32 v70, 0x80008000, v70
    v_xor_b32 v71, 0x80008000, v71
    v_xor_b32 v76, 0x80008000, v76
    v_xor_b32 v77, 0x80008000, v77
    v_xor_b32 v78, 0x80008000, v78
    v_xor_b32 v79, 0x80008000, v79
    s_mov_b64 exec, -1
    s_waitcnt vmcnt(3) lgkmcnt(2)
    v_mfma_f32_32x32x16_bf16 v[0:15], v[64:67], v[176:179], 0
    v_mul_f32 v255, v32, v152
    v_fmac_f32 v255, v33, v153
    v_fmac_f32 v255, v34, v154
    v_fmac_f32 v255, v35, v155
    s_add_u32 m0, s21, 2048
    s_cmp_eq_u32 s50, 4
    v_mfma_f32_32x32x16_bf16 v[16:31], v[68:71], v[176:179], v[16:31]
    s_cbranch_scc1 WL_5_1
    v_lshl_add_u32 v236, v236, 10, v246
    v_lshl_add_u32 v237, v237, 10, v246
    buffer_load_dwordx4 v236, s[4:7], s39 offen  lds
    buffer_load_dwordx4 v237, s[8:11], s39 offen offset:1024  lds
WR_5_1:
    ds_read_b64_tr_b16 v[176:177], v244 offset:4096
    ds_read_b64_tr_b16 v[178:179], v244 offset:5120
    ds_read_b64_tr_b16 v[184:185], v245 offset:4096
    ds_read_b64_tr_b16 v[186:187], v245 offset:5120
    v_fmac_f32 v255, v36, v156
    v_fmac_f32 v255, v37, v157
    v_fmac_f32 v255, v38, v158
    s_waitcnt vmcnt(4) lgkmcnt(0)
    v_mfma_f32_32x32x16_bf16 v[0:15], v[72:75], v[176:179], v[0:15]
    v_fmac_f32 v255, v39, v159
    v_fmac_f32 v201, v40, v168
    v_fmac_f32 v201, v41, v169
    s_add_u32 m0, s21, 4096
    s_cmp_eq_u32 s50, 4
    v_mfma_f32_32x32x16_bf16 v[16:31], v[76:79], v[176:179], v[16:31]
    s_cbranch_scc1 WL_5_2
    v_lshl_add_u32 v238, v238, 10, v246
    v_lshl_add_u32 v239, v239, 10, v246
    buffer_load_dwordx4 v238, s[4:7], s40 offen  lds
    buffer_load_dwordx4 v239, s[8:11], s40 offen offset:1024  lds
WR_5_2:
    ds_read_b64_tr_b16 v[176:177], v244 offset:6144
    ds_read_b64_tr_b16 v[188:189], v245 offset:6144
    v_permlane32_swap_b32 v197, v255
    v_fmac_f32 v201, v42, v170
    v_fmac_f32 v201, v43, v171
    s_waitcnt lgkmcnt(0)
    s_mov_b64 exec, s[56:57]
    v_xor_b32 v84, 0x80008000, v84
    v_xor_b32 v85, 0x80008000, v85
    s_mov_b64 exec, -1
    v_mfma_f32_32x32x8_bf16 v[0:15], v[80:81], v[176:177], v[0:15]
    v_fmac_f32 v201, v44, v172
    v_fmac_f32 v201, v45, v173
    v_fmac_f32 v201, v46, v174
    s_add_u32 m0, s21, 6144
    s_cmp_eq_u32 s50, 4
    v_mfma_f32_32x32x8_bf16 v[16:31], v[84:85], v[176:177], v[16:31]
    s_cbranch_scc1 WL_5_3
    v_lshl_add_u32 v240, v240, 10, v246
    v_lshl_add_u32 v241, v241, 10, v246
    buffer_load_dwordx4 v240, s[4:7], s41 offen  lds
    buffer_load_dwordx4 v241, s[8:11], s41 offen offset:1024  lds
WR_5_3:
    v_fmac_f32 v201, v47, v175
    v_add_f32 v255, v197, v255
    v_cvt_pk_bf16_f32 v194, v254, v255
    v_mfma_f32_32x32x16_bf16 v[32:47], v[64:67], v[180:183], 0
    v_mul_f32 v254, v0, v144
    v_fmac_f32 v254, v1, v145
    v_fmac_f32 v254, v2, v146
    v_fmac_f32 v254, v3, v147
    v_fmac_f32 v254, v4, v148
    v_fmac_f32 v254, v5, v149
    v_fmac_f32 v254, v6, v150
    v_mfma_f32_32x32x16_bf16 v[48:63], v[68:71], v[180:183], v[48:63]
    v_fmac_f32 v254, v7, v151
    v_fma_f32 v202, v8, -v160, v202
    v_fma_f32 v202, v9, -v161, v202
    v_permlane32_swap_b32 v254, v200
    v_fma_f32 v202, v10, -v162, v202
    v_fma_f32 v202, v11, -v163, v202
    v_mfma_f32_32x32x16_bf16 v[32:47], v[72:75], v[184:187], v[32:47]
    v_fma_f32 v202, v12, -v164, v202
    v_fma_f32 v202, v13, -v165, v202
    v_fma_f32 v202, v14, -v166, v202
    v_fma_f32 v202, v15, -v167, v202
    v_add_f32 v200, v254, v200
    v_fmac_f32 v198, v16, v112
    v_permlane32_swap_b32 v202, v254
    v_mfma_f32_32x32x16_bf16 v[48:63], v[76:79], v[184:187], v[48:63]
    s_waitcnt vmcnt(6)
    ds_read_b64_tr_b16 v[176:177], v244 offset:0
    ds_read_b64_tr_b16 v[178:179], v244 offset:1024
    ds_read_b64_tr_b16 v[180:181], v245 offset:0
    ds_read_b64_tr_b16 v[182:183], v245 offset:1024
    v_fmac_f32 v198, v17, v113
    v_fmac_f32 v198, v18, v114
    v_fmac_f32 v198, v19, v115
    v_fmac_f32 v198, v20, v116
    v_fmac_f32 v198, v21, v117
    v_fmac_f32 v198, v22, v118
    v_mfma_f32_32x32x8_bf16 v[32:47], v[80:81], v[188:189], v[32:47]
    v_fmac_f32 v198, v23, v119
    v_add_f32 v254, v202, v254
    v_mul_f32 v196, v24, v160
    v_fmac_f32 v196, v25, v161
    v_fmac_f32 v196, v26, v162
    v_fmac_f32 v196, v27, v163
    v_fmac_f32 v196, v28, v164
    v_mfma_f32_32x32x8_bf16 v[48:63], v[84:85], v[188:189], v[48:63]
    v_add_u32 v249, s48, v249
    v_add_u32 v250, s49, v250
    ds_read_b32 v252, v251 offset:16
    ds_read_b64_tr_b16 v[64:65], v249 offset:0
    ds_read_b64_tr_b16 v[68:69], v249 offset:64
    ds_read_b64_tr_b16 v[66:67], v249 offset:256
    ds_read_b64_tr_b16 v[70:71], v249 offset:320
    s_mov_b64 exec, s[54:55]
    ds_read_u16_d16_hi v242, v250 offset:0
    s_mov_b64 exec, -1
    v_fmac_f32 v196, v29, v165
    v_fmac_f32 v196, v30, v166
    v_fmac_f32 v196, v31, v167
    s_nop 1
    v_permlane32_swap_b32 v198, v196
    v_add_f32 v196, v198, v196
    s_cmp_eq_u32 s50, 4
    s_cbranch_scc1 LEPI_0
    v_mul_f32 v255, v32, v152
    v_fmac_f32 v255, v33, v153
    v_fmac_f32 v255, v34, v154
    v_fmac_f32 v255, v35, v155
    v_fmac_f32 v255, v36, v156
    v_fmac_f32 v255, v37, v157
    v_fmac_f32 v255, v38, v158
    v_fmac_f32 v255, v39, v159
    v_fma_f32 v203, v40, -v168, v203
    v_fma_f32 v203, v41, -v169, v203
    v_permlane32_swap_b32 v255, v201
    v_fma_f32 v203, v42, -v170, v203
    v_fma_f32 v203, v43, -v171, v203
    v_fma_f32 v203, v44, -v172, v203
    v_fma_f32 v203, v45, -v173, v203
    v_fma_f32 v203, v46, -v174, v203
    v_fma_f32 v203, v47, -v175, v203
    v_add_f32 v201, v255, v201
    v_fmac_f32 v199, v48, v120
    v_permlane32_swap_b32 v203, v255
    v_fmac_f32 v199, v49, v121
    v_fmac_f32 v199, v50, v122
    v_fmac_f32 v199, v51, v123
    v_fmac_f32 v199, v52, v124
    v_fmac_f32 v199, v53, v125
    v_fmac_f32 v199, v54, v126
    v_fmac_f32 v199, v55, v127
    v_add_f32 v255, v203, v255
    v_mul_f32 v197, v56, v168
    v_fmac_f32 v197, v57, v169
    v_fmac_f32 v197, v58, v170
    v_fmac_f32 v197, v59, v171
    v_fmac_f32 v197, v60, v172
    v_fmac_f32 v197, v61, v173
    v_fmac_f32 v197, v62, v174
    v_fmac_f32 v197, v63, v175
    s_nop 1
    v_permlane32_swap_b32 v199, v197
    v_add_f32 v197, v199, v197
    v_cvt_pk_bf16_f32 v200, v200, v201
    v_cvt_pk_bf16_f32 v254, v254, v255
    v_cvt_pk_bf16_f32 v196, v196, v197
    ds_write2st64_b32 v253, v192, v193 offset0:0 offset1:1
    ds_write2st64_b32 v253, v194, v200 offset0:2 offset1:3
    ds_write_b32 v253, v196 offset:1024
    s_mov_b64 exec, 0xffffffff
    ds_write_b32 v253, v254 offset:1280
    s_mov_b64 exec, -1
    s_add_u32 s50, s50, 1
    s_cmp_ge_u32 s50, 4
    s_cbranch_scc1 LAST1
    s_waitcnt lgkmcnt(9)
    v_readfirstlane_b32 s66, v252
    s_add_u32 s53, s53, 1
    v_mov_b32 v252, s53
    s_cmp_le_u32 s53, s66
    ds_write2_b32 v251, v252, v252 offset0:0 offset1:8
    s_setprio 1
    s_cbranch_scc1 PRIO_12
    s_setprio 0
PRIO_12:
    s_cmp_eq_u32 s52, 4
    s_cbranch_scc1 ITEM_1_4
    s_cmp_eq_u32 s52, 5
    s_cbranch_scc1 ITEM_1_5
    s_cmp_eq_u32 s52, 3
    s_cbranch_scc1 ITEM_1_3
    s_cmp_eq_u32 s52, 6
    s_cbranch_scc1 ITEM_1_6
    s_cmp_eq_u32 s52, 8
    s_cbranch_scc1 ITEM_1_8
    s_branch ITEM_1_2
WL_5_0:
    s_add_u32 s66, s51, 0
    buffer_load_dwordx4 v[96:99], v246, s[16:19], s66 offen offset:2048 sc1
    buffer_load_dwordx4 v[100:103], v246, s[16:19], s66 offen offset:3072 sc1
    s_branch WR_5_0
WL_5_1:
    s_add_u32 s66, s51, 4096
    buffer_load_dwordx4 v[104:107], v246, s[16:19], s66 offen offset:2048 sc1
    buffer_load_dwordx4 v[108:111], v246, s[16:19], s66 offen offset:3072 sc1
    s_branch WR_5_1
WL_5_2:
    s_add_u32 s66, s51, 8192
    buffer_load_dwordx4 v[128:131], v246, s[16:19], s66 offen offset:2048 sc1
    buffer_load_dwordx4 v[132:135], v246, s[16:19], s66 offen offset:3072 sc1
    s_branch WR_5_2
WL_5_3:
    s_add_u32 s66, s51, 12288
    buffer_load_dwordx4 v[136:139], v246, s[16:19], s66 offen offset:2048 sc1
    buffer_load_dwordx4 v[140:143], v246, s[16:19], s66 offen offset:3072 sc1
    s_branch WR_5_3
.p2align 6
ITEM_1_3:
    s_mov_b64 exec, s[54:55]
    ds_read_u16_d16_hi v243, v250 offset:128
    s_mov_b64 exec, -1
    ds_read_b64_tr_b16 v[72:73], v249 offset:512
    ds_read_b64_tr_b16 v[76:77], v249 offset:576
    s_waitcnt lgkmcnt(3)
    v_mul_f32_dpp v196, v242, v64 row_newbcast:0 row_mask:0xf bank_mask:0xf
    v_mul_f32_dpp v197, v242, v65 row_newbcast:1 row_mask:0xf bank_mask:0xf
    v_mul_f32_dpp v198, v242, v64 row_newbcast:8 row_mask:0xf bank_mask:0xf
    v_mul_f32_dpp v199, v242, v65 row_newbcast:9 row_mask:0xf bank_mask:0xf
    v_mul_f32_dpp v200, v242, v68 row_newbcast:2 row_mask:0xf bank_mask:0xf
    v_mul_f32_dpp v201, v242, v69 row_newbcast:3 row_mask:0xf bank_mask:0xf
    v_mul_f32_dpp v202, v242, v68 row_newbcast:10 row_mask:0xf bank_mask:0xf
    v_mul_f32_dpp v203, v242, v69 row_newbcast:11 row_mask:0xf bank_mask:0xf
    v_cvt_pk_bf16_f32 v64, v196, v197
    v_cvt_pk_bf16_f32 v68, v198, v199
    v_cvt_pk_bf16_f32 v65, v200, v201
    v_cvt_pk_bf16_f32 v69, v202, v203
    v_mul_f32_dpp v196, v242, v66 row_newbcast:4 row_mask:0xf bank_mask:0xf
    v_mul_f32_dpp v197, v242, v67 row_newbcast:5 row_mask:0xf bank_mask:0xf
    v_mul_f32_dpp v198, v242, v66 row_newbcast:12 row_mask:0xf bank_mask:0xf
    v_mul_f32_dpp v199, v242, v67 row_newbcast:13 row_mask:0xf bank_mask:0xf
    v_mul_f32_dpp v200, v242, v70 row_newbcast:6 row_mask:0xf bank_mask:0xf
    v_mul_f32_dpp v201, v242, v71 row_newbcast:7 row_mask:0xf bank_mask:0xf
    v_mul_f32_dpp v202, v242, v70 row_newbcast:14 row_mask:0xf bank_mask:0xf
    v_mul_f32_dpp v203, v242, v71 row_newbcast:15 row_mask:0xf bank_mask:0xf
    v_cvt_pk_bf16_f32 v66, v196, v197
    v_cvt_pk_bf16_f32 v70, v198, v199
    v_cvt_pk_bf16_f32 v67, v200, v201
    v_cvt_pk_bf16_f32 v71, v202, v203
    s_nop 0
    s_waitcnt vmcnt(4) lgkmcnt(0)
    v_mfma_f32_32x32x16_bf16 v[0:15], v[64:67], v[176:179], 0
    v_mul_f32_dpp v196, v243, v72 row_newbcast:0 row_mask:0xf bank_mask:0xf
    v_mul_f32_dpp v197, v243, v73 row_newbcast:1 row_mask:0xf bank_mask:0xf
    v_mul_f32_dpp v198, v243, v72 row_newbcast:8 row_mask:0xf bank_mask:0xf
    v_mul_f32_dpp v199, v243, v73 row_newbcast:9 row_mask:0xf bank_mask:0xf
    v_mul_f32_dpp v200, v243, v76 row_newbcast:2 row_mask:0xf bank_mask:0xf
    v_mul_f32_dpp v201, v243, v77 row_newbcast:3 row_mask:0xf bank_mask:0xf
    s_add_u32 m0, s21, 0
    v_mfma_f32_32x32x16_bf16 v[16:31], v[68:71], v[176:179], 0
    buffer_load_dwordx4 v234, s[4:7], s36 offen  lds
    buffer_load_dwordx4 v235, s[8:11], s36 offen offset:1024  lds
    ds_read_b64_tr_b16 v[176:177], v244 offset:2048
    ds_read_b64_tr_b16 v[184:185], v245 offset:2048
    v_mul_f32_dpp v202, v243, v76 row_newbcast:10 row_mask:0xf bank_mask:0xf
    v_mul_f32_dpp v203, v243, v77 row_newbcast:11 row_mask:0xf bank_mask:0xf
    v_cvt_pk_bf16_f32 v72, v196, v197
    v_cvt_pk_bf16_f32 v76, v198, v199
    v_cvt_pk_bf16_f32 v73, v200, v201
    v_cvt_pk_bf16_f32 v77, v202, v203
    s_nop 0
    s_waitcnt lgkmcnt(0)
    v_mfma_f32_32x32x8_bf16 v[0:15], v[72:73], v[176:177], v[0:15]
    s_add_u32 m0, s21, 2048
    v_mfma_f32_32x32x8_bf16 v[16:31], v[76:77], v[176:177], v[16:31]
    buffer_load_dwordx4 v236, s[4:7], s36 offen  lds
    s_mov_b32 m0, s50
    s_nop 0
    s_movrels_b32 s71, s23
    s_movrels_b32 s33, s28
    v_add_u32 v253, s33, v248
    s_bfe_u32 s46, s71, 0x30012
    s_mov_b32 m0, s46
    s_and_b32 s66, s71, 0x3ffff
    s_movrels_b32 s68, s57
    s_movrels_b32 s69, s61
    s_sub_u32 s48, s66, s47
    s_mov_b32 s47, s66
    s_lshr_b32 s52, s71, 28
    s_lshl_b32 s67, s46, 9
    s_add_u32 s66, s66, s67
    s_sub_u32 s49, s66, s42
    s_mov_b32 s42, s66
    s_bfe_u32 s66, s68, 655360
    s_add_u32 s43, s42, s66
    s_bfe_u32 s39, s69, 655360
    s_bfe_u32 s66, s68, 655370
    s_add_u32 s44, s42, s66
    s_bfe_u32 s40, s69, 655370
    s_bfe_u32 s66, s68, 655380
    s_add_u32 s45, s42, s66
    s_bfe_u32 s41, s69, 655380
    v_add_u32 v252, s44, v247
    ds_read_u16 v238, v252
    ds_read_u16 v239, v252 offset:64
    v_add_u32 v252, s45, v247
    ds_read_u16 v240, v252
    ds_read_u16 v241, v252 offset:64
    v_mfma_f32_32x32x16_bf16 v[32:47], v[64:67], v[180:183], 0
    v_mul_f32 v196, v0, v96
    v_fmac_f32 v196, v1, v97
    v_fmac_f32 v196, v2, v98
    v_fmac_f32 v196, v3, v99
    v_fmac_f32 v196, v4, v100
    v_fmac_f32 v196, v5, v101
    v_fmac_f32 v196, v6, v102
    v_fmac_f32 v196, v7, v103
    v_mul_f32 v198, v8, v128
    v_fmac_f32 v198, v9, v129
    v_mfma_f32_32x32x16_bf16 v[48:63], v[68:71], v[180:183], 0
    s_waitcnt vmcnt(5)
    ds_read_b64_tr_b16 v[176:177], v244 offset:4096
    ds_read_b64_tr_b16 v[178:179], v244 offset:5120
    ds_read_b64_tr_b16 v[180:181], v245 offset:4096
    ds_read_b64_tr_b16 v[182:183], v245 offset:5120
    v_fmac_f32 v198, v10, v130
    v_fmac_f32 v198, v11, v131
    v_fmac_f32 v198, v12, v132
    v_fmac_f32 v198, v13, v133
    v_fmac_f32 v198, v14, v134
    v_fmac_f32 v198, v15, v135
    v_mul_f32 v200, v16, v128
    v_fmac_f32 v200, v17, v129
    v_permlane32_swap_b32 v196, v198
    v_mfma_f32_32x32x8_bf16 v[32:47], v[72:73], v[184:185], v[32:47]
    v_fmac_f32 v200, v18, v130
    v_fmac_f32 v200, v19, v131
    v_fmac_f32 v200, v20, v132
    v_fmac_f32 v200, v21, v133
    v_fmac_f32 v200, v22, v134
    v_fmac_f32 v200, v23, v135
    v_add_f32 v198, v196, v198
    v_mul_f32_e64 v202, v24, -v128
    v_fma_f32 v202, v25, -v129, v202
    v_mfma_f32_32x32x8_bf16 v[48:63], v[76:77], v[184:185], v[48:63]
    v_fma_f32 v202, v26, -v130, v202
    v_fma_f32 v202, v27, -v131, v202
    v_fma_f32 v202, v28, -v132, v202
    v_fma_f32 v202, v29, -v133, v202
    v_fma_f32 v202, v30, -v134, v202
    v_fma_f32 v202, v31, -v135, v202
    s_nop 1
    v_permlane32_swap_b32 v200, v202
    v_add_f32 v202, v200, v202
    s_waitcnt vmcnt(3) lgkmcnt(0)
    v_mfma_f32_32x32x16_bf16 v[0:15], v[64:67], v[176:179], 0
    v_mul_f32 v197, v32, v104
    v_fmac_f32 v197, v33, v105
    v_fmac_f32 v197, v34, v106
    v_fmac_f32 v197, v35, v107
    v_fmac_f32 v197, v36, v108
    v_fmac_f32 v197, v37, v109
    v_fmac_f32 v197, v38, v110
    v_fmac_f32 v197, v39, v111
    v_mul_f32 v199, v40, v136
    v_fmac_f32 v199, v41, v137
    s_add_u32 m0, s21, 4096
    v_mfma_f32_32x32x16_bf16 v[16:31], v[68:71], v[176:179], 0
    buffer_load_dwordx4 v234, s[4:7], s37 offen  lds
    buffer_load_dwordx4 v235, s[8:11], s37 offen offset:1024  lds
    ds_read_b64_tr_b16 v[176:177], v244 offset:6144
    ds_read_b64_tr_b16 v[184:185], v245 offset:6144
    v_add_u32 v252, s42, v247
    ds_read_u16 v234, v252
    ds_read_u16 v235, v252 offset:64
    v_fmac_f32 v199, v42, v138
    v_fmac_f32 v199, v43, v139
    v_fmac_f32 v199, v44, v140
    v_fmac_f32 v199, v45, v141
    v_fmac_f32 v199, v46, v142
    v_fmac_f32 v199, v47, v143
    v_mul_f32 v201, v48, v136
    v_fmac_f32 v201, v49, v137
    v_permlane32_swap_b32 v197, v199
    v_fmac_f32 v201, v50, v138
    s_waitcnt lgkmcnt(2)
    v_mfma_f32_32x32x8_bf16 v[0:15], v[72:73], v[176:177], v[0:15]
    v_fmac_f32 v201, v51, v139
    v_fmac_f32 v201, v52, v140
    v_fmac_f32 v201, v53, v141
    v_fmac_f32 v201, v54, v142
    v_fmac_f32 v201, v55, v143
    v_add_f32 v199, v197, v199
    v_mul_f32_e64 v203, v56, -v136
    v_fma_f32 v203, v57, -v137, v203
    v_fma_f32 v203, v58, -v138, v203
    v_fma_f32 v203, v59, -v139, v203
    s_add_u32 m0, s21, 6144
    v_mfma_f32_32x32x8_bf16 v[16:31], v[76:77], v[176:177], v[16:31]
    buffer_load_dwordx4 v236, s[4:7], s37 offen  lds
    v_add_u32 v252, s43, v247
    ds_read_u16 v236, v252
    ds_read_u16 v237, v252 offset:64
    v_fma_f32 v203, v60, -v140, v203
    v_fma_f32 v203, v61, -v141, v203
    v_fma_f32 v203, v62, -v142, v203
    v_fma_f32 v203, v63, -v143, v203
    s_nop 1
    v_permlane32_swap_b32 v201, v203
    v_add_f32 v203, v201, v203
    v_cvt_pk_bf16_f32 v192, v198, v199
    v_cvt_pk_bf16_f32 v193, v202, v203
    v_mfma_f32_32x32x16_bf16 v[32:47], v[64:67], v[180:183], 0
    v_mul_f32 v196, v0, v144
    v_fmac_f32 v196, v1, v145
    v_fmac_f32 v196, v2, v146
    v_fmac_f32 v196, v3, v147
    v_fmac_f32 v196, v4, v148
    v_fmac_f32 v196, v5, v149
    v_fmac_f32 v196, v6, v150
    v_fmac_f32 v196, v7, v151
    v_mfma_f32_32x32x16_bf16 v[48:63], v[68:71], v[180:183], 0
    s_waitcnt vmcnt(4)
    ds_read_b64_tr_b16 v[176:177], v244 offset:0
    ds_read_b64_tr_b16 v[178:179], v244 offset:1024
    ds_read_b64_tr_b16 v[180:181], v245 offset:0
    ds_read_b64_tr_b16 v[182:183], v245 offset:1024
    v_mul_f32 v198, v8, v112
    v_fmac_f32 v198, v9, v113
    v_fmac_f32 v198, v10, v114
    v_fmac_f32 v198, v11, v115
    v_fmac_f32 v198, v12, v116
    v_fmac_f32 v198, v13, v117
    v_fmac_f32 v198, v14, v118
    v_fmac_f32 v198, v15, v119
    v_mfma_f32_32x32x8_bf16 v[32:47], v[72:73], v[184:185], v[32:47]
    v_mul_f32_e64 v200, v16, -v160
    v_fma_f32 v200, v17, -v161, v200
    v_fma_f32 v200, v18, -v162, v200
    v_fma_f32 v200, v19, -v163, v200
    v_fma_f32 v200, v20, -v164, v200
    v_fma_f32 v200, v21, -v165, v200
    v_fma_f32 v200, v22, -v166, v200
    v_fma_f32 v200, v23, -v167, v200
    v_mfma_f32_32x32x8_bf16 v[48:63], v[76:77], v[184:185], v[48:63]
    v_mul_f32_e64 v202, v24, -v160
    v_fma_f32 v202, v25, -v161, v202
    v_fma_f32 v202, v26, -v162, v202
    v_fma_f32 v202, v27, -v163, v202
    v_fma_f32 v202, v28, -v164, v202
    v_fma_f32 v202, v29, -v165, v202
    v_fma_f32 v202, v30, -v166, v202
    v_fma_f32 v202, v31, -v167, v202
    s_waitcnt vmcnt(3) lgkmcnt(0)
    v_mfma_f32_32x32x16_bf16 v[0:15], v[64:67], v[176:179], 0
    v_mul_f32 v197, v32, v152
    v_fmac_f32 v197, v33, v153
    v_fmac_f32 v197, v34, v154
    v_fmac_f32 v197, v35, v155
    v_fmac_f32 v197, v36, v156
    v_fmac_f32 v197, v37, v157
    v_fmac_f32 v197, v38, v158
    v_fmac_f32 v197, v39, v159
    s_add_u32 m0, s21, 0
    s_cmp_eq_u32 s50, 4
    v_mfma_f32_32x32x16_bf16 v[16:31], v[68:71], v[176:179], 0
    s_cbranch_scc1 WL_3_0
    v_lshl_add_u32 v234, v234, 10, v246
    v_lshl_add_u32 v235, v235, 10, v246
    buffer_load_dwordx4 v234, s[4:7], s38 offen  lds
    buffer_load_dwordx4 v235, s[8:11], s38 offen offset:1024  lds
WR_3_0:
    ds_read_b64_tr_b16 v[176:177], v244 offset:2048
    ds_read_b64_tr_b16 v[184:185], v245 offset:2048
    v_mul_f32 v199, v40, v120
    v_fmac_f32 v199, v41, v121
    v_fmac_f32 v199, v42, v122
    v_fmac_f32 v199, v43, v123
    v_fmac_f32 v199, v44, v124
    v_fmac_f32 v199, v45, v125
    v_fmac_f32 v199, v46, v126
    v_fmac_f32 v199, v47, v127
    s_waitcnt lgkmcnt(0)
    v_mfma_f32_32x32x8_bf16 v[0:15], v[72:73], v[176:177], v[0:15]
    v_mul_f32_e64 v201, v48, -v168
    v_fma_f32 v201, v49, -v169, v201
    v_fma_f32 v201, v50, -v170, v201
    v_fma_f32 v201, v51, -v171, v201
    v_fma_f32 v201, v52, -v172, v201
    v_fma_f32 v201, v53, -v173, v201
    v_fma_f32 v201, v54, -v174, v201
    v_fma_f32 v201, v55, -v175, v201
    s_add_u32 m0, s21, 2048
    s_cmp_eq_u32 s50, 4
    v_mfma_f32_32x32x8_bf16 v[16:31], v[76:77], v[176:177], v[16:31]
    s_cbranch_scc1 WL_3_1
    v_lshl_add_u32 v236, v236, 10, v246
    v_lshl_add_u32 v237, v237, 10, v246
    buffer_load_dwordx4 v236, s[4:7], s39 offen  lds
    buffer_load_dwordx4 v237, s[8:11], s39 offen offset:1024  lds
WR_3_1:
    v_mul_f32_e64 v203, v56, -v168
    v_fma_f32 v203, v57, -v169, v203
    v_fma_f32 v203, v58, -v170, v203
    v_fma_f32 v203, v59, -v171, v203
    v_fma_f32 v203, v60, -v172, v203
    v_fma_f32 v203, v61, -v173, v203
    v_fma_f32 v203, v62, -v174, v203
    v_fma_f32 v203, v63, -v175, v203
    v_mfma_f32_32x32x16_bf16 v[32:47], v[64:67], v[180:183], 0
    v_mul_f32 v254, v0, v144
    v_fmac_f32 v254, v1, v145
    v_fmac_f32 v254, v2, v146
    v_fmac_f32 v254, v3, v147
    v_fmac_f32 v254, v4, v148
    v_mfma_f32_32x32x16_bf16 v[48:63], v[68:71], v[180:183], 0
    ds_swizzle_b32 v68, v68 offset:0x401F
    ds_swizzle_b32 v69, v69 offset:0x401F
    ds_swizzle_b32 v70, v70 offset:0x401F
    ds_swizzle_b32 v71, v71 offset:0x401F
    s_waitcnt vmcnt(5)
    ds_read_b64_tr_b16 v[176:177], v244 offset:4096
    ds_read_b64_tr_b16 v[178:179], v244 offset:5120
    ds_read_b64_tr_b16 v[180:181], v245 offset:4096
    ds_read_b64_tr_b16 v[182:183], v245 offset:5120
    v_fmac_f32 v254, v5, v149
    v_fmac_f32 v254, v6, v150
    v_fmac_f32 v254, v7, v151
    v_fmac_f32 v200, v8, v160
    v_mfma_f32_32x32x8_bf16 v[32:47], v[72:73], v[184:185], v[32:47]
    v_fmac_f32 v200, v9, v161
    v_permlane32_swap_b32 v196, v254
    v_fmac_f32 v200, v10, v162
    v_fmac_f32 v200, v11, v163
    v_fmac_f32 v200, v12, v164
    v_mfma_f32_32x32x8_bf16 v[48:63], v[76:77], v[184:185], v[48:63]
    ds_swizzle_b32 v76, v76 offset:0x401F
    ds_swizzle_b32 v77, v77 offset:0x401F
    v_fmac_f32 v200, v13, v165
    v_fmac_f32 v200, v14, v166
    v_fmac_f32 v200, v15, v167
    v_add_f32 v254, v196, v254
    s_waitcnt lgkmcnt(6)
    s_mov_b64 exec, s[56:57]
    v_xor_b32 v68, 0x80008000, v68
    v_xor_b32 v69, 0x80008000, v69
    v_xor_b32 v70, 0x80008000, v70
    v_xor_b32 v71, 0x80008000, v71
    s_mov_b64 exec, -1
    s_waitcnt vmcnt(4) lgkmcnt(2)
    v_mfma_f32_32x32x16_bf16 v[0:15], v[64:67], v[176:179], 0
    v_mul_f32 v255, v32, v152
    v_fmac_f32 v255, v33, v153
    v_fmac_f32 v255, v34, v154
    v_fmac_f32 v255, v35, v155
    v_fmac_f32 v255, v36, v156
    s_add_u32 m0, s21, 4096
    s_cmp_eq_u32 s50, 4
    v_mfma_f32_32x32x16_bf16 v[16:31], v[68:71], v[176:179], v[16:31]
    s_cbranch_scc1 WL_3_2
    v_lshl_add_u32 v238, v238, 10, v246
    v_lshl_add_u32 v239, v239, 10, v246
    buffer_load_dwordx4 v238, s[4:7], s40 offen  lds
    buffer_load_dwordx4 v239, s[8:11], s40 offen offset:1024  lds
WR_3_2:
    ds_read_b64_tr_b16 v[176:177], v244 offset:6144
    ds_read_b64_tr_b16 v[184:185], v245 offset:6144
    v_fmac_f32 v255, v37, v157
    v_fmac_f32 v255, v38, v158
    v_fmac_f32 v255, v39, v159
    v_fmac_f32 v201, v40, v168
    v_fmac_f32 v201, v41, v169
    s_waitcnt lgkmcnt(0)
    s_mov_b64 exec, s[56:57]
    v_xor_b32 v76, 0x80008000, v76
    v_xor_b32 v77, 0x80008000, v77
    s_mov_b64 exec, -1
    v_mfma_f32_32x32x8_bf16 v[0:15], v[72:73], v[176:177], v[0:15]
    v_permlane32_swap_b32 v197, v255
    v_fmac_f32 v201, v42, v170
    v_fmac_f32 v201, v43, v171
    v_fmac_f32 v201, v44, v172
    v_fmac_f32 v201, v45, v173
    s_add_u32 m0, s21, 6144
    s_cmp_eq_u32 s50, 4
    v_mfma_f32_32x32x8_bf16 v[16:31], v[76:77], v[176:177], v[16:31]
    s_cbranch_scc1 WL_3_3
    v_lshl_add_u32 v240, v240, 10, v246
    v_lshl_add_u32 v241, v241, 10, v246
    buffer_load_dwordx4 v240, s[4:7], s41 offen  lds
    buffer_load_dwordx4 v241, s[8:11], s41 offen offset:1024  lds
WR_3_3:
    v_fmac_f32 v201, v46, v174
    v_fmac_f32 v201, v47, v175
    v_add_f32 v255, v197, v255
    v_cvt_pk_bf16_f32 v194, v254, v255
    v_mfma_f32_32x32x16_bf16 v[32:47], v[64:67], v[180:183], 0
    v_mul_f32 v254, v0, v144
    v_fmac_f32 v254, v1, v145
    v_fmac_f32 v254, v2, v146
    v_fmac_f32 v254, v3, v147
    v_fmac_f32 v254, v4, v148
    v_fmac_f32 v254, v5, v149
    v_fmac_f32 v254, v6, v150
    v_fmac_f32 v254, v7, v151
    v_fma_f32 v202, v8, -v160, v202
    v_fma_f32 v202, v9, -v161, v202
    v_mfma_f32_32x32x16_bf16 v[48:63], v[68:71], v[180:183], v[48:63]
    s_waitcnt vmcnt(6)
    ds_read_b64_tr_b16 v[176:177], v244 offset:0
    ds_read_b64_tr_b16 v[178:179], v244 offset:1024
    ds_read_b64_tr_b16 v[180:181], v245 offset:0
    ds_read_b64_tr_b16 v[182:183], v245 offset:1024
    v_permlane32_swap_b32 v254, v200
    v_fma_f32 v202, v10, -v162, v202
    v_fma_f32 v202, v11, -v163, v202
    v_fma_f32 v202, v12, -v164, v202
    v_fma_f32 v202, v13, -v165, v202
    v_fma_f32 v202, v14, -v166, v202
    v_fma_f32 v202, v15, -v167, v202
    v_add_f32 v200, v254, v200
    v_fmac_f32 v198, v16, v112
    v_permlane32_swap_b32 v202, v254
    v_mfma_f32_32x32x8_bf16 v[32:47], v[72:73], v[184:185], v[32:47]
    v_fmac_f32 v198, v17, v113
    v_fmac_f32 v198, v18, v114
    v_fmac_f32 v198, v19, v115
    v_fmac_f32 v198, v20, v116
    v_fmac_f32 v198, v21, v117
    v_fmac_f32 v198, v22, v118
    v_fmac_f32 v198, v23, v119
    v_add_f32 v254, v202, v254
    v_mul_f32 v196, v24, v160
    v_fmac_f32 v196, v25, v161
    v_mfma_f32_32x32x8_bf16 v[48:63], v[76:77], v[184:185], v[48:63]
    v_add_u32 v249, s48, v249
    v_add_u32 v250, s49, v250
    ds_read_b32 v252, v251 offset:16
    ds_read_b64_tr_b16 v[64:65], v249 offset:0
    ds_read_b64_tr_b16 v[68:69], v249 offset:64
    ds_read_b64_tr_b16 v[66:67], v249 offset:256
    ds_read_b64_tr_b16 v[70:71], v249 offset:320
    s_mov_b64 exec, s[54:55]
    ds_read_u16_d16_hi v242, v250 offset:0
    s_mov_b64 exec, -1
    v_fmac_f32 v196, v26, v162
    v_fmac_f32 v196, v27, v163
    v_fmac_f32 v196, v28, v164
    v_fmac_f32 v196, v29, v165
    v_fmac_f32 v196, v30, v166
    v_fmac_f32 v196, v31, v167
    s_nop 1
    v_permlane32_swap_b32 v198, v196
    v_add_f32 v196, v198, v196
    s_cmp_eq_u32 s50, 4
    s_cbranch_scc1 LEPI_0
    v_mul_f32 v255, v32, v152
    v_fmac_f32 v255, v33, v153
    v_fmac_f32 v255, v34, v154
    v_fmac_f32 v255, v35, v155
    v_fmac_f32 v255, v36, v156
    v_fmac_f32 v255, v37, v157
    v_fmac_f32 v255, v38, v158
    v_fmac_f32 v255, v39, v159
    v_fma_f32 v203, v40, -v168, v203
    v_fma_f32 v203, v41, -v169, v203
    v_permlane32_swap_b32 v255, v201
    v_fma_f32 v203, v42, -v170, v203
    v_fma_f32 v203, v43, -v171, v203
    v_fma_f32 v203, v44, -v172, v203
    v_fma_f32 v203, v45, -v173, v203
    v_fma_f32 v203, v46, -v174, v203
    v_fma_f32 v203, v47, -v175, v203
    v_add_f32 v201, v255, v201
    v_fmac_f32 v199, v48, v120
    v_permlane32_swap_b32 v203, v255
    v_fmac_f32 v199, v49, v121
    v_fmac_f32 v199, v50, v122
    v_fmac_f32 v199, v51, v123
    v_fmac_f32 v199, v52, v124
    v_fmac_f32 v199, v53, v125
    v_fmac_f32 v199, v54, v126
    v_fmac_f32 v199, v55, v127
    v_add_f32 v255, v203, v255
    v_mul_f32 v197, v56, v168
    v_fmac_f32 v197, v57, v169
    v_fmac_f32 v197, v58, v170
    v_fmac_f32 v197, v59, v171
    v_fmac_f32 v197, v60, v172
    v_fmac_f32 v197, v61, v173
    v_fmac_f32 v197, v62, v174
    v_fmac_f32 v197, v63, v175
    s_nop 1
    v_permlane32_swap_b32 v199, v197
    v_add_f32 v197, v199, v197
    v_cvt_pk_bf16_f32 v200, v200, v201
    v_cvt_pk_bf16_f32 v254, v254, v255
    v_cvt_pk_bf16_f32 v196, v196, v197
    ds_write2st64_b32 v253, v192, v193 offset0:0 offset1:1
    ds_write2st64_b32 v253, v194, v200 offset0:2 offset1:3
    ds_write_b32 v253, v196 offset:1024
    s_mov_b64 exec, 0xffffffff
    ds_write_b32 v253, v254 offset:1280
    s_mov_b64 exec, -1
    s_add_u32 s50, s50, 1
    s_cmp_ge_u32 s50, 4
    s_cbranch_scc1 LAST1
    s_waitcnt lgkmcnt(9)
    v_readfirstlane_b32 s66, v252
    s_add_u32 s53, s53, 1
    v_mov_b32 v252, s53
    s_cmp_le_u32 s53, s66
    ds_write2_b32 v251, v252, v252 offset0:0 offset1:8
    s_setprio 1
    s_cbranch_scc1 PRIO_13
    s_setprio 0
PRIO_13:
    s_cmp_eq_u32 s52, 4
    s_cbranch_scc1 ITEM_1_4
    s_cmp_eq_u32 s52, 5
    s_cbranch_scc1 ITEM_1_5
    s_cmp_eq_u32 s52, 3
    s_cbranch_scc1 ITEM_1_3
    s_cmp_eq_u32 s52, 6
    s_cbranch_scc1 ITEM_1_6
    s_cmp_eq_u32 s52, 8
    s_cbranch_scc1 ITEM_1_8
    s_branch ITEM_1_2
WL_3_0:
    s_add_u32 s66, s51, 0
    buffer_load_dwordx4 v[96:99], v246, s[16:19], s66 offen offset:2048 sc1
    buffer_load_dwordx4 v[100:103], v246, s[16:19], s66 offen offset:3072 sc1
    s_branch WR_3_0
WL_3_1:
    s_add_u32 s66, s51, 4096
    buffer_load_dwordx4 v[104:107], v246, s[16:19], s66 offen offset:2048 sc1
    buffer_load_dwordx4 v[108:111], v246, s[16:19], s66 offen offset:3072 sc1
    s_branch WR_3_1
WL_3_2:
    s_add_u32 s66, s51, 8192
    buffer_load_dwordx4 v[128:131], v246, s[16:19], s66 offen offset:2048 sc1
    buffer_load_dwordx4 v[132:135], v246, s[16:19], s66 offen offset:3072 sc1
    s_branch WR_3_2
WL_3_3:
    s_add_u32 s66, s51, 12288
    buffer_load_dwordx4 v[136:139], v246, s[16:19], s66 offen offset:2048 sc1
    buffer_load_dwordx4 v[140:143], v246, s[16:19], s66 offen offset:3072 sc1
    s_branch WR_3_3
.p2align 6
ITEM_1_6:
    s_mov_b64 exec, s[54:55]
    ds_read_u16_d16_hi v243, v250 offset:128
    s_mov_b64 exec, -1
    ds_read_b64_tr_b16 v[72:73], v249 offset:512
    ds_read_b64_tr_b16 v[76:77], v249 offset:576
    ds_read_b64_tr_b16 v[74:75], v249 offset:768
    ds_read_b64_tr_b16 v[78:79], v249 offset:832
    ds_read_b64_tr_b16 v[80:81], v249 offset:1024
    ds_read_b64_tr_b16 v[84:85], v249 offset:1088
    ds_read_b64_tr_b16 v[82:83], v249 offset:1280
    ds_read_b64_tr_b16 v[86:87], v249 offset:1344
    s_waitcnt lgkmcnt(9)
    v_mul_f32_dpp v196, v242, v64 row_newbcast:0 row_mask:0xf bank_mask:0xf
    v_mul_f32_dpp v197, v242, v65 row_newbcast:1 row_mask:0xf bank_mask:0xf
    v_mul_f32_dpp v198, v242, v64 row_newbcast:8 row_mask:0xf bank_mask:0xf
    v_mul_f32_dpp v199, v242, v65 row_newbcast:9 row_mask:0xf bank_mask:0xf
    v_mul_f32_dpp v200, v242, v68 row_newbcast:2 row_mask:0xf bank_mask:0xf
    v_mul_f32_dpp v201, v242, v69 row_newbcast:3 row_mask:0xf bank_mask:0xf
    v_mul_f32_dpp v202, v242, v68 row_newbcast:10 row_mask:0xf bank_mask:0xf
    v_mul_f32_dpp v203, v242, v69 row_newbcast:11 row_mask:0xf bank_mask:0xf
    v_cvt_pk_bf16_f32 v64, v196, v197
    v_cvt_pk_bf16_f32 v68, v198, v199
    v_cvt_pk_bf16_f32 v65, v200, v201
    v_cvt_pk_bf16_f32 v69, v202, v203
    v_mul_f32_dpp v196, v242, v66 row_newbcast:4 row_mask:0xf bank_mask:0xf
    v_mul_f32_dpp v197, v242, v67 row_newbcast:5 row_mask:0xf bank_mask:0xf
    v_mul_f32_dpp v198, v242, v66 row_newbcast:12 row_mask:0xf bank_mask:0xf
    v_mul_f32_dpp v199, v242, v67 row_newbcast:13 row_mask:0xf bank_mask:0xf
    v_mul_f32_dpp v200, v242, v70 row_newbcast:6 row_mask:0xf bank_mask:0xf
    v_mul_f32_dpp v201, v242, v71 row_newbcast:7 row_mask:0xf bank_mask:0xf
    v_mul_f32_dpp v202, v242, v70 row_newbcast:14 row_mask:0xf bank_mask:0xf
    v_mul_f32_dpp v203, v242, v71 row_newbcast:15 row_mask:0xf bank_mask:0xf
    v_cvt_pk_bf16_f32 v66, v196, v197
    v_cvt_pk_bf16_f32 v70, v198, v199
    v_cvt_pk_bf16_f32 v67, v200, v201
    v_cvt_pk_bf16_f32 v71, v202, v203
    s_mov_b64 exec, s[54:55]
    ds_read_u16_d16_hi v242, v250 offset:256
    s_mov_b64 exec, -1
    s_waitcnt vmcnt(4) lgkmcnt(5)
    v_mfma_f32_32x32x16_bf16 v[0:15], v[64:67], v[176:179], 0
    v_mul_f32_dpp v196, v243, v72 row_newbcast:0 row_mask:0xf bank_mask:0xf
    v_mul_f32_dpp v197, v243, v73 row_newbcast:1 row_mask:0xf bank_mask:0xf
    v_mul_f32_dpp v198, v243, v72 row_newbcast:8 row_mask:0xf bank_mask:0xf
    v_mul_f32_dpp v199, v243, v73 row_newbcast:9 row_mask:0xf bank_mask:0xf
    v_mul_f32_dpp v200, v243, v76 row_newbcast:2 row_mask:0xf bank_mask:0xf
    v_mul_f32_dpp v201, v243, v77 row_newbcast:3 row_mask:0xf bank_mask:0xf
    v_mul_f32_dpp v202, v243, v76 row_newbcast:10 row_mask:0xf bank_mask:0xf
    v_mul_f32_dpp v203, v243, v77 row_newbcast:11 row_mask:0xf bank_mask:0xf
    v_cvt_pk_bf16_f32 v72, v196, v197
    v_cvt_pk_bf16_f32 v76, v198, v199
    v_cvt_pk_bf16_f32 v73, v200, v201
    v_cvt_pk_bf16_f32 v77, v202, v203
    s_add_u32 m0, s21, 0
    v_mfma_f32_32x32x16_bf16 v[16:31], v[68:71], v[176:179], 0
    buffer_load_dwordx4 v236, s[4:7], s35 offen  lds
    buffer_load_dwordx4 v237, s[8:11], s35 offen offset:1024  lds
    ds_read_b64_tr_b16 v[176:177], v244 offset:2048
    ds_read_b64_tr_b16 v[178:179], v244 offset:3072
    ds_read_b64_tr_b16 v[184:185], v245 offset:2048
    ds_read_b64_tr_b16 v[186:187], v245 offset:3072
    v_mul_f32_dpp v196, v243, v74 row_newbcast:4 row_mask:0xf bank_mask:0xf
    v_mul_f32_dpp v197, v243, v75 row_newbcast:5 row_mask:0xf bank_mask:0xf
    v_mul_f32_dpp v198, v243, v74 row_newbcast:12 row_mask:0xf bank_mask:0xf
    v_mul_f32_dpp v199, v243, v75 row_newbcast:13 row_mask:0xf bank_mask:0xf
    v_mul_f32_dpp v200, v243, v78 row_newbcast:6 row_mask:0xf bank_mask:0xf
    v_mul_f32_dpp v201, v243, v79 row_newbcast:7 row_mask:0xf bank_mask:0xf
    v_mul_f32_dpp v202, v243, v78 row_newbcast:14 row_mask:0xf bank_mask:0xf
    v_mul_f32_dpp v203, v243, v79 row_newbcast:15 row_mask:0xf bank_mask:0xf
    v_cvt_pk_bf16_f32 v74, v196, v197
    v_cvt_pk_bf16_f32 v78, v198, v199
    v_cvt_pk_bf16_f32 v75, v200, v201
    v_cvt_pk_bf16_f32 v79, v202, v203
    s_nop 0
    s_waitcnt vmcnt(4) lgkmcnt(0)
    v_mfma_f32_32x32x16_bf16 v[0:15], v[72:75], v[176:179], v[0:15]
    v_mul_f32_dpp v196, v242, v80 row_newbcast:0 row_mask:0xf bank_mask:0xf
    v_mul_f32_dpp v197, v242, v81 row_newbcast:1 row_mask:0xf bank_mask:0xf
    v_mul_f32_dpp v198, v242, v80 row_newbcast:8 row_mask:0xf bank_mask:0xf
    v_mul_f32_dpp v199, v242, v81 row_newbcast:9 row_mask:0xf bank_mask:0xf
    v_mul_f32_dpp v200, v242, v84 row_newbcast:2 row_mask:0xf bank_mask:0xf
    v_mul_f32_dpp v201, v242, v85 row_newbcast:3 row_mask:0xf bank_mask:0xf
    v_mul_f32_dpp v202, v242, v84 row_newbcast:10 row_mask:0xf bank_mask:0xf
    v_mul_f32_dpp v203, v242, v85 row_newbcast:11 row_mask:0xf bank_mask:0xf
    v_cvt_pk_bf16_f32 v80, v196, v197
    v_cvt_pk_bf16_f32 v84, v198, v199
    v_cvt_pk_bf16_f32 v81, v200, v201
    v_cvt_pk_bf16_f32 v85, v202, v203
    s_add_u32 m0, s21, 2048
    v_mfma_f32_32x32x16_bf16 v[16:31], v[76:79], v[176:179], v[16:31]
    buffer_load_dwordx4 v238, s[4:7], s35 offen  lds
    buffer_load_dwordx4 v239, s[8:11], s35 offen offset:1024  lds
    ds_read_b64_tr_b16 v[176:177], v244 offset:4096
    ds_read_b64_tr_b16 v[178:179], v244 offset:5120
    ds_read_b64_tr_b16 v[188:189], v245 offset:4096
    ds_read_b64_tr_b16 v[190:191], v245 offset:5120
    v_mul_f32_dpp v196, v242, v82 row_newbcast:4 row_mask:0xf bank_mask:0xf
    v_mul_f32_dpp v197, v242, v83 row_newbcast:5 row_mask:0xf bank_mask:0xf
    v_mul_f32_dpp v198, v242, v82 row_newbcast:12 row_mask:0xf bank_mask:0xf
    v_mul_f32_dpp v199, v242, v83 row_newbcast:13 row_mask:0xf bank_mask:0xf
    v_mul_f32_dpp v200, v242, v86 row_newbcast:6 row_mask:0xf bank_mask:0xf
    v_mul_f32_dpp v201, v242, v87 row_newbcast:7 row_mask:0xf bank_mask:0xf
    v_mul_f32_dpp v202, v242, v86 row_newbcast:14 row_mask:0xf bank_mask:0xf
    v_mul_f32_dpp v203, v242, v87 row_newbcast:15 row_mask:0xf bank_mask:0xf
    v_cvt_pk_bf16_f32 v82, v196, v197
    v_cvt_pk_bf16_f32 v86, v198, v199
    v_cvt_pk_bf16_f32 v83, v200, v201
    v_cvt_pk_bf16_f32 v87, v202, v203
    s_nop 0
    s_waitcnt lgkmcnt(0)
    v_mfma_f32_32x32x16_bf16 v[0:15], v[80:83], v[176:179], v[0:15]
    s_add_u32 m0, s21, 4096
    v_mfma_f32_32x32x16_bf16 v[16:31], v[84:87], v[176:179], v[16:31]
    buffer_load_dwordx4 v234, s[4:7], s36 offen  lds
    buffer_load_dwordx4 v235, s[8:11], s36 offen offset:1024  lds
    s_mov_b32 m0, s50
    s_nop 0
    s_movrels_b32 s71, s23
    s_movrels_b32 s33, s28
    v_add_u32 v253, s33, v248
    s_bfe_u32 s46, s71, 0x30012
    s_mov_b32 m0, s46
    s_and_b32 s66, s71, 0x3ffff
    s_movrels_b32 s68, s57
    s_movrels_b32 s69, s61
    s_sub_u32 s48, s66, s47
    s_mov_b32 s47, s66
    s_lshr_b32 s52, s71, 28
    s_lshl_b32 s67, s46, 9
    s_add_u32 s66, s66, s67
    s_sub_u32 s49, s66, s42
    s_mov_b32 s42, s66
    s_bfe_u32 s66, s68, 655360
    s_add_u32 s43, s42, s66
    s_bfe_u32 s39, s69, 655360
    s_bfe_u32 s66, s68, 655370
    s_add_u32 s44, s42, s66
    s_bfe_u32 s40, s69, 655370
    s_bfe_u32 s66, s68, 655380
    s_add_u32 s45, s42, s66
    s_bfe_u32 s41, s69, 655380
    v_add_u32 v252, s45, v247
    ds_read_u16 v240, v252
    ds_read_u16 v241, v252 offset:64
    v_mfma_f32_32x32x16_bf16 v[32:47], v[64:67], v[180:183], 0
    v_mul_f32 v196, v0, v96
    v_fmac_f32 v196, v1, v97
    v_fmac_f32 v196, v2, v98
    v_fmac_f32 v196, v3, v99
    v_fmac_f32 v196, v4, v100
    v_fmac_f32 v196, v5, v101
    v_fmac_f32 v196, v6, v102
    v_mfma_f32_32x32x16_bf16 v[48:63], v[68:71], v[180:183], 0
    v_fmac_f32 v196, v7, v103
    v_mul_f32 v198, v8, v128
    v_fmac_f32 v198, v9, v129
    v_fmac_f32 v198, v10, v130
    v_fmac_f32 v198, v11, v131
    v_fmac_f32 v198, v12, v132
    v_mfma_f32_32x32x16_bf16 v[32:47], v[72:75], v[184:187], v[32:47]
    v_fmac_f32 v198, v13, v133
    v_fmac_f32 v198, v14, v134
    v_fmac_f32 v198, v15, v135
    v_mul_f32 v200, v16, v128
    v_fmac_f32 v200, v17, v129
    v_permlane32_swap_b32 v196, v198
    v_mfma_f32_32x32x16_bf16 v[48:63], v[76:79], v[184:187], v[48:63]
    s_waitcnt vmcnt(6)
    ds_read_b64_tr_b16 v[176:177], v244 offset:6144
    ds_read_b64_tr_b16 v[178:179], v244 offset:7168
    ds_read_b64_tr_b16 v[180:181], v245 offset:6144
    ds_read_b64_tr_b16 v[182:183], v245 offset:7168
    v_fmac_f32 v200, v18, v130
    v_fmac_f32 v200, v19, v131
    v_fmac_f32 v200, v20, v132
    v_fmac_f32 v200, v21, v133
    v_fmac_f32 v200, v22, v134
    v_fmac_f32 v200, v23, v135
    v_mfma_f32_32x32x16_bf16 v[32:47], v[80:83], v[188:191], v[32:47]
    v_add_f32 v198, v196, v198
    v_mul_f32_e64 v202, v24, -v128
    v_fma_f32 v202, v25, -v129, v202
    v_fma_f32 v202, v26, -v130, v202
    v_fma_f32 v202, v27, -v131, v202
    v_fma_f32 v202, v28, -v132, v202
    v_mfma_f32_32x32x16_bf16 v[48:63], v[84:87], v[188:191], v[48:63]
    v_fma_f32 v202, v29, -v133, v202
    v_fma_f32 v202, v30, -v134, v202
    v_fma_f32 v202, v31, -v135, v202
    s_nop 1
    v_permlane32_swap_b32 v200, v202
    v_add_f32 v202, v200, v202
    s_waitcnt vmcnt(4) lgkmcnt(0)
    v_mfma_f32_32x32x16_bf16 v[0:15], v[64:67], v[176:179], 0
    v_mul_f32 v197, v32, v104
    v_fmac_f32 v197, v33, v105
    v_fmac_f32 v197, v34, v106
    v_fmac_f32 v197, v35, v107
    v_fmac_f32 v197, v36, v108
    v_fmac_f32 v197, v37, v109
    v_fmac_f32 v197, v38, v110
    s_add_u32 m0, s21, 6144
    v_mfma_f32_32x32x16_bf16 v[16:31], v[68:71], v[176:179], 0
    buffer_load_dwordx4 v236, s[4:7], s36 offen  lds
    buffer_load_dwordx4 v237, s[8:11], s36 offen offset:1024  lds
    ds_read_b64_tr_b16 v[176:177], v244 offset:0
    ds_read_b64_tr_b16 v[178:179], v244 offset:1024
    ds_read_b64_tr_b16 v[184:185], v245 offset:0
    ds_read_b64_tr_b16 v[186:187], v245 offset:1024
    v_fmac_f32 v197, v39, v111
    v_mul_f32 v199, v40, v136
    v_fmac_f32 v199, v41, v137
    v_fmac_f32 v199, v42, v138
    v_fmac_f32 v199, v43, v139
    v_fmac_f32 v199, v44, v140
    s_waitcnt vmcnt(4) lgkmcnt(0)
    v_mfma_f32_32x32x16_bf16 v[0:15], v[72:75], v[176:179], v[0:15]
    v_fmac_f32 v199, v45, v141
    v_fmac_f32 v199, v46, v142
    v_fmac_f32 v199, v47, v143
    v_mul_f32 v201, v48, v136
    v_fmac_f32 v201, v49, v137
    v_permlane32_swap_b32 v197, v199
    v_fmac_f32 v201, v50, v138
    s_add_u32 m0, s21, 0
    v_mfma_f32_32x32x16_bf16 v[16:31], v[76:79], v[176:179], v[16:31]
    buffer_load_dwordx4 v238, s[4:7], s36 offen  lds
    buffer_load_dwordx4 v239, s[8:11], s36 offen offset:1024  lds
    ds_read_b64_tr_b16 v[176:177], v244 offset:2048
    ds_read_b64_tr_b16 v[178:179], v244 offset:3072
    ds_read_b64_tr_b16 v[188:189], v245 offset:2048
    ds_read_b64_tr_b16 v[190:191], v245 offset:3072
    v_fmac_f32 v201, v51, v139
    v_fmac_f32 v201, v52, v140
    v_fmac_f32 v201, v53, v141
    v_fmac_f32 v201, v54, v142
    v_fmac_f32 v201, v55, v143
    v_add_f32 v199, v197, v199
    s_waitcnt lgkmcnt(0)
    v_mfma_f32_32x32x16_bf16 v[0:15], v[80:83], v[176:179], v[0:15]
    v_mul_f32_e64 v203, v56, -v136
    v_fma_f32 v203, v57, -v137, v203
    v_fma_f32 v203, v58, -v138, v203
    v_fma_f32 v203, v59, -v139, v203
    v_fma_f32 v203, v60, -v140, v203
    v_fma_f32 v203, v61, -v141, v203
    v_fma_f32 v203, v62, -v142, v203
    s_add_u32 m0, s21, 2048
    v_mfma_f32_32x32x16_bf16 v[16:31], v[84:87], v[176:179], v[16:31]
    buffer_load_dwordx4 v234, s[4:7], s37 offen  lds
    buffer_load_dwordx4 v235, s[8:11], s37 offen offset:1024  lds
    v_add_u32 v252, s42, v247
    ds_read_u16 v234, v252
    ds_read_u16 v235, v252 offset:64
    v_fma_f32 v203, v63, -v143, v203
    s_nop 1
    v_permlane32_swap_b32 v201, v203
    v_add_f32 v203, v201, v203
    v_cvt_pk_bf16_f32 v192, v198, v199
    v_cvt_pk_bf16_f32 v193, v202, v203
    v_mfma_f32_32x32x16_bf16 v[32:47], v[64:67], v[180:183], 0
    v_mul_f32 v196, v0, v144
    v_fmac_f32 v196, v1, v145
    v_fmac_f32 v196, v2, v146
    v_fmac_f32 v196, v3, v147
    v_fmac_f32 v196, v4, v148
    v_fmac_f32 v196, v5, v149
    v_mfma_f32_32x32x16_bf16 v[48:63], v[68:71], v[180:183], 0
    v_fmac_f32 v196, v6, v150
    v_fmac_f32 v196, v7, v151
    v_mul_f32 v198, v8, v112
    v_fmac_f32 v198, v9, v113
    v_fmac_f32 v198, v10, v114
    v_mfma_f32_32x32x16_bf16 v[32:47], v[72:75], v[184:187], v[32:47]
    v_fmac_f32 v198, v11, v115
    v_fmac_f32 v198, v12, v116
    v_fmac_f32 v198, v13, v117
    v_fmac_f32 v198, v14, v118
    v_fmac_f32 v198, v15, v119
    v_mfma_f32_32x32x16_bf16 v[48:63], v[76:79], v[184:187], v[48:63]
    s_waitcnt vmcnt(6)
    ds_read_b64_tr_b16 v[176:177], v244 offset:4096
    ds_read_b64_tr_b16 v[178:179], v244 offset:5120
    ds_read_b64_tr_b16 v[180:181], v245 offset:4096
    ds_read_b64_tr_b16 v[182:183], v245 offset:5120
    v_mul_f32_e64 v200, v16, -v160
    v_fma_f32 v200, v17, -v161, v200
    v_fma_f32 v200, v18, -v162, v200
    v_fma_f32 v200, v19, -v163, v200
    v_fma_f32 v200, v20, -v164, v200
    v_fma_f32 v200, v21, -v165, v200
    v_mfma_f32_32x32x16_bf16 v[32:47], v[80:83], v[188:191], v[32:47]
    v_fma_f32 v200, v22, -v166, v200
    v_fma_f32 v200, v23, -v167, v200
    v_mul_f32_e64 v202, v24, -v160
    v_fma_f32 v202, v25, -v161, v202
    v_fma_f32 v202, v26, -v162, v202
    v_mfma_f32_32x32x16_bf16 v[48:63], v[84:87], v[188:191], v[48:63]
    v_fma_f32 v202, v27, -v163, v202
    v_fma_f32 v202, v28, -v164, v202
    v_fma_f32 v202, v29, -v165, v202
    v_fma_f32 v202, v30, -v166, v202
    v_fma_f32 v202, v31, -v167, v202
    s_waitcnt vmcnt(4) lgkmcnt(0)
    v_mfma_f32_32x32x16_bf16 v[0:15], v[64:67], v[176:179], 0
    v_mul_f32 v197, v32, v152
    v_fmac_f32 v197, v33, v153
    v_fmac_f32 v197, v34, v154
    v_fmac_f32 v197, v35, v155
    v_fmac_f32 v197, v36, v156
    v_fmac_f32 v197, v37, v157
    s_add_u32 m0, s21, 4096
    v_mfma_f32_32x32x16_bf16 v[16:31], v[68:71], v[176:179], 0
    buffer_load_dwordx4 v236, s[4:7], s37 offen  lds
    buffer_load_dwordx4 v237, s[8:11], s37 offen offset:1024  lds
    ds_read_b64_tr_b16 v[176:177], v244 offset:6144
    ds_read_b64_tr_b16 v[178:179], v244 offset:7168
    ds_read_b64_tr_b16 v[184:185], v245 offset:6144
    ds_read_b64_tr_b16 v[186:187], v245 offset:7168
    v_add_u32 v252, s43, v247
    ds_read_u16 v236, v252
    ds_read_u16 v237, v252 offset:64
    v_fmac_f32 v197, v38, v158
    v_fmac_f32 v197, v39, v159
    v_mul_f32 v199, v40, v120
    v_fmac_f32 v199, v41, v121
    v_fmac_f32 v199, v42, v122
    s_waitcnt vmcnt(4) lgkmcnt(2)
    v_mfma_f32_32x32x16_bf16 v[0:15], v[72:75], v[176:179], v[0:15]
    v_fmac_f32 v199, v43, v123
    v_fmac_f32 v199, v44, v124
    v_fmac_f32 v199, v45, v125
    v_fmac_f32 v199, v46, v126
    v_fmac_f32 v199, v47, v127
    s_add_u32 m0, s21, 6144
    v_mfma_f32_32x32x16_bf16 v[16:31], v[76:79], v[176:179], v[16:31]
    buffer_load_dwordx4 v238, s[4:7], s37 offen  lds
    buffer_load_dwordx4 v239, s[8:11], s37 offen offset:1024  lds
    ds_read_b64_tr_b16 v[176:177], v244 offset:0
    ds_read_b64_tr_b16 v[178:179], v244 offset:1024
    ds_read_b64_tr_b16 v[188:189], v245 offset:0
    ds_read_b64_tr_b16 v[190:191], v245 offset:1024
    v_add_u32 v252, s44, v247
    ds_read_u16 v238, v252
    ds_read_u16 v239, v252 offset:64
    v_mul_f32_e64 v201, v48, -v168
    v_fma_f32 v201, v49, -v169, v201
    v_fma_f32 v201, v50, -v170, v201
    v_fma_f32 v201, v51, -v171, v201
    v_fma_f32 v201, v52, -v172, v201
    v_fma_f32 v201, v53, -v173, v201
    s_waitcnt lgkmcnt(2)
    v_mfma_f32_32x32x16_bf16 v[0:15], v[80:83], v[176:179], v[0:15]
    v_fma_f32 v201, v54, -v174, v201
    v_fma_f32 v201, v55, -v175, v201
    v_mul_f32_e64 v203, v56, -v168
    v_fma_f32 v203, v57, -v169, v203
    v_fma_f32 v203, v58, -v170, v203
    s_add_u32 m0, s21, 0
    s_cmp_eq_u32 s50, 4
    v_mfma_f32_32x32x16_bf16 v[16:31], v[84:87], v[176:179], v[16:31]
    s_cbranch_scc1 WL_6_0
    v_lshl_add_u32 v234, v234, 10, v246
    v_lshl_add_u32 v235, v235, 10, v246
    buffer_load_dwordx4 v234, s[4:7], s38 offen  lds
    buffer_load_dwordx4 v235, s[8:11], s38 offen offset:1024  lds
WR_6_0:
    v_fma_f32 v203, v59, -v171, v203
    v_fma_f32 v203, v60, -v172, v203
    v_fma_f32 v203, v61, -v173, v203
    v_fma_f32 v203, v62, -v174, v203
    v_fma_f32 v203, v63, -v175, v203
    v_mfma_f32_32x32x16_bf16 v[32:47], v[64:67], v[180:183], 0
    v_mul_f32 v254, v0, v144
    v_fmac_f32 v254, v1, v145
    v_fmac_f32 v254, v2, v146
    v_mfma_f32_32x32x16_bf16 v[48:63], v[68:71], v[180:183], 0
    ds_swizzle_b32 v68, v68 offset:0x401F
    ds_swizzle_b32 v69, v69 offset:0x401F
    ds_swizzle_b32 v70, v70 offset:0x401F
    ds_swizzle_b32 v71, v71 offset:0x401F
    v_fmac_f32 v254, v3, v147
    v_fmac_f32 v254, v4, v148
    v_fmac_f32 v254, v5, v149
    v_mfma_f32_32x32x16_bf16 v[32:47], v[72:75], v[184:187], v[32:47]
    v_fmac_f32 v254, v6, v150
    v_fmac_f32 v254, v7, v151
    v_fmac_f32 v200, v8, v160
    v_mfma_f32_32x32x16_bf16 v[48:63], v[76:79], v[184:187], v[48:63]
    ds_swizzle_b32 v76, v76 offset:0x401F
    ds_swizzle_b32 v77, v77 offset:0x401F
    ds_swizzle_b32 v78, v78 offset:0x401F
    ds_swizzle_b32 v79, v79 offset:0x401F
    s_waitcnt vmcnt(6)
    ds_read_b64_tr_b16 v[176:177], v244 offset:2048
    ds_read_b64_tr_b16 v[178:179], v244 offset:3072
    ds_read_b64_tr_b16 v[180:181], v245 offset:2048
    ds_read_b64_tr_b16 v[182:183], v245 offset:3072
    v_fmac_f32 v200, v9, v161
    v_permlane32_swap_b32 v196, v254
    v_fmac_f32 v200, v10, v162
    v_mfma_f32_32x32x16_bf16 v[32:47], v[80:83], v[188:191], v[32:47]
    v_fmac_f32 v200, v11, v163
    v_fmac_f32 v200, v12, v164
    v_fmac_f32 v200, v13, v165
    v_mfma_f32_32x32x16_bf16 v[48:63], v[84:87], v[188:191], v[48:63]
    ds_swizzle_b32 v84, v84 offset:0x401F
    ds_swizzle_b32 v85, v85 offset:0x401F
    ds_swizzle_b32 v86, v86 offset:0x401F
    ds_swizzle_b32 v87, v87 offset:0x401F
    v_fmac_f32 v200, v14, v166
    v_fmac_f32 v200, v15, v167
    v_add_f32 v254, v196, v254
    s_waitcnt lgkmcnt(8)
    s_mov_b64 exec, s[56:57]
    v_xor_b32 v68, 0x80008000, v68
    v_xor_b32 v69, 0x80008000, v69
    v_xor_b32 v70, 0x80008000, v70
    v_xor_b32 v71, 0x80008000, v71
    v_xor_b32 v76, 0x80008000, v76
    v_xor_b32 v77, 0x80008000, v77
    v_xor_b32 v78, 0x80008000, v78
    v_xor_b32 v79, 0x80008000, v79
    s_mov_b64 exec, -1
    s_waitcnt vmcnt(4) lgkmcnt(4)
    v_mfma_f32_32x32x16_bf16 v[0:15], v[64:67], v[176:179], 0
    v_mul_f32 v255, v32, v152
    v_fmac_f32 v255, v33, v153
    v_fmac_f32 v255, v34, v154
    v_fmac_f32 v255, v35, v155
    s_add_u32 m0, s21, 2048
    s_cmp_eq_u32 s50, 4
    v_mfma_f32_32x32x16_bf16 v[16:31], v[68:71], v[176:179], v[16:31]
    s_cbranch_scc1 WL_6_1
    v_lshl_add_u32 v236, v236, 10, v246
    v_lshl_add_u32 v237, v237, 10, v246
    buffer_load_dwordx4 v236, s[4:7], s39 offen  lds
    buffer_load_dwordx4 v237, s[8:11], s39 offen offset:1024  lds
WR_6_1:
    ds_read_b64_tr_b16 v[176:177], v244 offset:4096
    ds_read_b64_tr_b16 v[178:179], v244 offset:5120
    ds_read_b64_tr_b16 v[184:185], v245 offset:4096
    ds_read_b64_tr_b16 v[186:187], v245 offset:5120
    v_fmac_f32 v255, v36, v156
    v_fmac_f32 v255, v37, v157
    v_fmac_f32 v255, v38, v158
    s_waitcnt vmcnt(4) lgkmcnt(0)
    v_mfma_f32_32x32x16_bf16 v[0:15], v[72:75], v[176:179], v[0:15]
    v_fmac_f32 v255, v39, v159
    v_fmac_f32 v201, v40, v168
    v_fmac_f32 v201, v41, v169
    s_add_u32 m0, s21, 4096
    s_cmp_eq_u32 s50, 4
    v_mfma_f32_32x32x16_bf16 v[16:31], v[76:79], v[176:179], v[16:31]
    s_cbranch_scc1 WL_6_2
    v_lshl_add_u32 v238, v238, 10, v246
    v_lshl_add_u32 v239, v239, 10, v246
    buffer_load_dwordx4 v238, s[4:7], s40 offen  lds
    buffer_load_dwordx4 v239, s[8:11], s40 offen offset:1024  lds
WR_6_2:
    ds_read_b64_tr_b16 v[176:177], v244 offset:6144
    ds_read_b64_tr_b16 v[178:179], v244 offset:7168
    ds_read_b64_tr_b16 v[188:189], v245 offset:6144
    ds_read_b64_tr_b16 v[190:191], v245 offset:7168
    v_permlane32_swap_b32 v197, v255
    v_fmac_f32 v201, v42, v170
    v_fmac_f32 v201, v43, v171
    s_waitcnt lgkmcnt(0)
    s_mov_b64 exec, s[56:57]
    v_xor_b32 v84, 0x80008000, v84
    v_xor_b32 v85, 0x80008000, v85
    v_xor_b32 v86, 0x80008000, v86
    v_xor_b32 v87, 0x80008000, v87
    s_mov_b64 exec, -1
    v_mfma_f32_32x32x16_bf16 v[0:15], v[80:83], v[176:179], v[0:15]
    v_fmac_f32 v201, v44, v172
    v_fmac_f32 v201, v45, v173
    v_fmac_f32 v201, v46, v174
    s_add_u32 m0, s21, 6144
    s_cmp_eq_u32 s50, 4
    v_mfma_f32_32x32x16_bf16 v[16:31], v[84:87], v[176:179], v[16:31]
    s_cbranch_scc1 WL_6_3
    v_lshl_add_u32 v240, v240, 10, v246
    v_lshl_add_u32 v241, v241, 10, v246
    buffer_load_dwordx4 v240, s[4:7], s41 offen  lds
    buffer_load_dwordx4 v241, s[8:11], s41 offen offset:1024  lds
WR_6_3:
    v_fmac_f32 v201, v47, v175
    v_add_f32 v255, v197, v255
    v_cvt_pk_bf16_f32 v194, v254, v255
    v_mfma_f32_32x32x16_bf16 v[32:47], v[64:67], v[180:183], 0
    v_mul_f32 v254, v0, v144
    v_fmac_f32 v254, v1, v145
    v_fmac_f32 v254, v2, v146
    v_fmac_f32 v254, v3, v147
    v_fmac_f32 v254, v4, v148
    v_fmac_f32 v254, v5, v149
    v_fmac_f32 v254, v6, v150
    v_mfma_f32_32x32x16_bf16 v[48:63], v[68:71], v[180:183], v[48:63]
    v_fmac_f32 v254, v7, v151
    v_fma_f32 v202, v8, -v160, v202
    v_fma_f32 v202, v9, -v161, v202
    v_permlane32_swap_b32 v254, v200
    v_fma_f32 v202, v10, -v162, v202
    v_fma_f32 v202, v11, -v163, v202
    v_mfma_f32_32x32x16_bf16 v[32:47], v[72:75], v[184:187], v[32:47]
    v_fma_f32 v202, v12, -v164, v202
    v_fma_f32 v202, v13, -v165, v202
    v_fma_f32 v202, v14, -v166, v202
    v_fma_f32 v202, v15, -v167, v202
    v_add_f32 v200, v254, v200
    v_fmac_f32 v198, v16, v112
    v_permlane32_swap_b32 v202, v254
    v_mfma_f32_32x32x16_bf16 v[48:63], v[76:79], v[184:187], v[48:63]
    s_waitcnt vmcnt(6)
    ds_read_b64_tr_b16 v[176:177], v244 offset:0
    ds_read_b64_tr_b16 v[178:179], v244 offset:1024
    ds_read_b64_tr_b16 v[180:181], v245 offset:0
    ds_read_b64_tr_b16 v[182:183], v245 offset:1024
    v_fmac_f32 v198, v17, v113
    v_fmac_f32 v198, v18, v114
    v_fmac_f32 v198, v19, v115
    v_fmac_f32 v198, v20, v116
    v_fmac_f32 v198, v21, v117
    v_fmac_f32 v198, v22, v118
    v_mfma_f32_32x32x16_bf16 v[32:47], v[80:83], v[188:191], v[32:47]
    v_fmac_f32 v198, v23, v119
    v_add_f32 v254, v202, v254
    v_mul_f32 v196, v24, v160
    v_fmac_f32 v196, v25, v161
    v_fmac_f32 v196, v26, v162
    v_fmac_f32 v196, v27, v163
    v_fmac_f32 v196, v28, v164
    v_mfma_f32_32x32x16_bf16 v[48:63], v[84:87], v[188:191], v[48:63]
    v_add_u32 v249, s48, v249
    v_add_u32 v250, s49, v250
    ds_read_b32 v252, v251 offset:16
    ds_read_b64_tr_b16 v[64:65], v249 offset:0
    ds_read_b64_tr_b16 v[68:69], v249 offset:64
    ds_read_b64_tr_b16 v[66:67], v249 offset:256
    ds_read_b64_tr_b16 v[70:71], v249 offset:320
    s_mov_b64 exec, s[54:55]
    ds_read_u16_d16_hi v242, v250 offset:0
    s_mov_b64 exec, -1
    v_fmac_f32 v196, v29, v165
    v_fmac_f32 v196, v30, v166
    v_fmac_f32 v196, v31, v167
    s_nop 1
    v_permlane32_swap_b32 v198, v196
    v_add_f32 v196, v198, v196
    s_cmp_eq_u32 s50, 4
    s_cbranch_scc1 LEPI_0
    v_mul_f32 v255, v32, v152
    v_fmac_f32 v255, v33, v153
    v_fmac_f32 v255, v34, v154
    v_fmac_f32 v255, v35, v155
    v_fmac_f32 v255, v36, v156
    v_fmac_f32 v255, v37, v157
    v_fmac_f32 v255, v38, v158
    v_fmac_f32 v255, v39, v159
    v_fma_f32 v203, v40, -v168, v203
    v_fma_f32 v203, v41, -v169, v203
    v_permlane32_swap_b32 v255, v201
    v_fma_f32 v203, v42, -v170, v203
    v_fma_f32 v203, v43, -v171, v203
    v_fma_f32 v203, v44, -v172, v203
    v_fma_f32 v203, v45, -v173, v203
    v_fma_f32 v203, v46, -v174, v203
    v_fma_f32 v203, v47, -v175, v203
    v_add_f32 v201, v255, v201
    v_fmac_f32 v199, v48, v120
    v_permlane32_swap_b32 v203, v255
    v_fmac_f32 v199, v49, v121
    v_fmac_f32 v199, v50, v122
    v_fmac_f32 v199, v51, v123
    v_fmac_f32 v199, v52, v124
    v_fmac_f32 v199, v53, v125
    v_fmac_f32 v199, v54, v126
    v_fmac_f32 v199, v55, v127
    v_add_f32 v255, v203, v255
    v_mul_f32 v197, v56, v168
    v_fmac_f32 v197, v57, v169
    v_fmac_f32 v197, v58, v170
    v_fmac_f32 v197, v59, v171
    v_fmac_f32 v197, v60, v172
    v_fmac_f32 v197, v61, v173
    v_fmac_f32 v197, v62, v174
    v_fmac_f32 v197, v63, v175
    s_nop 1
    v_permlane32_swap_b32 v199, v197
    v_add_f32 v197, v199, v197
    v_cvt_pk_bf16_f32 v200, v200, v201
    v_cvt_pk_bf16_f32 v254, v254, v255
    v_cvt_pk_bf16_f32 v196, v196, v197
    ds_write2st64_b32 v253, v192, v193 offset0:0 offset1:1
    ds_write2st64_b32 v253, v194, v200 offset0:2 offset1:3
    ds_write_b32 v253, v196 offset:1024
    s_mov_b64 exec, 0xffffffff
    ds_write_b32 v253, v254 offset:1280
    s_mov_b64 exec, -1
    s_add_u32 s50, s50, 1
    s_cmp_ge_u32 s50, 4
    s_cbranch_scc1 LAST1
    s_waitcnt lgkmcnt(9)
    v_readfirstlane_b32 s66, v252
    s_add_u32 s53, s53, 1
    v_mov_b32 v252, s53
    s_cmp_le_u32 s53, s66
    ds_write2_b32 v251, v252, v252 offset0:0 offset1:8
    s_setprio 1
    s_cbranch_scc1 PRIO_14
    s_setprio 0
PRIO_14:
    s_cmp_eq_u32 s52, 4
    s_cbranch_scc1 ITEM_1_4
    s_cmp_eq_u32 s52, 5
    s_cbranch_scc1 ITEM_1_5
    s_cmp_eq_u32 s52, 3
    s_cbranch_scc1 ITEM_1_3
    s_cmp_eq_u32 s52, 6
    s_cbranch_scc1 ITEM_1_6
    s_cmp_eq_u32 s52, 8
    s_cbranch_scc1 ITEM_1_8
    s_branch ITEM_1_2
WL_6_0:
    s_add_u32 s66, s51, 0
    buffer_load_dwordx4 v[96:99], v246, s[16:19], s66 offen offset:2048 sc1
    buffer_load_dwordx4 v[100:103], v246, s[16:19], s66 offen offset:3072 sc1
    s_branch WR_6_0
WL_6_1:
    s_add_u32 s66, s51, 4096
    buffer_load_dwordx4 v[104:107], v246, s[16:19], s66 offen offset:2048 sc1
    buffer_load_dwordx4 v[108:111], v246, s[16:19], s66 offen offset:3072 sc1
    s_branch WR_6_1
WL_6_2:
    s_add_u32 s66, s51, 8192
    buffer_load_dwordx4 v[128:131], v246, s[16:19], s66 offen offset:2048 sc1
    buffer_load_dwordx4 v[132:135], v246, s[16:19], s66 offen offset:3072 sc1
    s_branch WR_6_2
WL_6_3:
    s_add_u32 s66, s51, 12288
    buffer_load_dwordx4 v[136:139], v246, s[16:19], s66 offen offset:2048 sc1
    buffer_load_dwordx4 v[140:143], v246, s[16:19], s66 offen offset:3072 sc1
    s_branch WR_6_3
.p2align 6
ITEM_1_8:
    s_mov_b64 exec, s[54:55]
    ds_read_u16_d16_hi v243, v250 offset:128
    s_mov_b64 exec, -1
    ds_read_b64_tr_b16 v[72:73], v249 offset:512
    ds_read_b64_tr_b16 v[76:77], v249 offset:576
    ds_read_b64_tr_b16 v[74:75], v249 offset:768
    ds_read_b64_tr_b16 v[78:79], v249 offset:832
    ds_read_b64_tr_b16 v[80:81], v249 offset:1024
    ds_read_b64_tr_b16 v[84:85], v249 offset:1088
    ds_read_b64_tr_b16 v[82:83], v249 offset:1280
    ds_read_b64_tr_b16 v[86:87], v249 offset:1344
    ds_read_b64_tr_b16 v[88:89], v249 offset:1536
    ds_read_b64_tr_b16 v[92:93], v249 offset:1600
    ds_read_b64_tr_b16 v[90:91], v249 offset:1792
    ds_read_b64_tr_b16 v[94:95], v249 offset:1856
    s_waitcnt lgkmcnt(13)
    v_mul_f32_dpp v196, v242, v64 row_newbcast:0 row_mask:0xf bank_mask:0xf
    v_mul_f32_dpp v197, v242, v65 row_newbcast:1 row_mask:0xf bank_mask:0xf
    v_mul_f32_dpp v198, v242, v64 row_newbcast:8 row_mask:0xf bank_mask:0xf
    v_mul_f32_dpp v199, v242, v65 row_newbcast:9 row_mask:0xf bank_mask:0xf
    v_mul_f32_dpp v200, v242, v68 row_newbcast:2 row_mask:0xf bank_mask:0xf
    v_mul_f32_dpp v201, v242, v69 row_newbcast:3 row_mask:0xf bank_mask:0xf
    v_mul_f32_dpp v202, v242, v68 row_newbcast:10 row_mask:0xf bank_mask:0xf
    v_mul_f32_dpp v203, v242, v69 row_newbcast:11 row_mask:0xf bank_mask:0xf
    v_cvt_pk_bf16_f32 v64, v196, v197
    v_cvt_pk_bf16_f32 v68, v198, v199
    v_cvt_pk_bf16_f32 v65, v200, v201
    v_cvt_pk_bf16_f32 v69, v202, v203
    v_mul_f32_dpp v196, v242, v66 row_newbcast:4 row_mask:0xf bank_mask:0xf
    v_mul_f32_dpp v197, v242, v67 row_newbcast:5 row_mask:0xf bank_mask:0xf
    v_mul_f32_dpp v198, v242, v66 row_newbcast:12 row_mask:0xf bank_mask:0xf
    v_mul_f32_dpp v199, v242, v67 row_newbcast:13 row_mask:0xf bank_mask:0xf
    v_mul_f32_dpp v200, v242, v70 row_newbcast:6 row_mask:0xf bank_mask:0xf
    v_mul_f32_dpp v201, v242, v71 row_newbcast:7 row_mask:0xf bank_mask:0xf
    v_mul_f32_dpp v202, v242, v70 row_newbcast:14 row_mask:0xf bank_mask:0xf
    v_mul_f32_dpp v203, v242, v71 row_newbcast:15 row_mask:0xf bank_mask:0xf
    v_cvt_pk_bf16_f32 v66, v196, v197
    v_cvt_pk_bf16_f32 v70, v198, v199
    v_cvt_pk_bf16_f32 v67, v200, v201
    v_cvt_pk_bf16_f32 v71, v202, v203
    s_mov_b64 exec, s[54:55]
    ds_read_u16_d16_hi v242, v250 offset:256
    s_mov_b64 exec, -1
    s_waitcnt vmcnt(4) lgkmcnt(9)
    v_mfma_f32_32x32x16_bf16 v[0:15], v[64:67], v[176:179], 0
    v_mul_f32_dpp v196, v243, v72 row_newbcast:0 row_mask:0xf bank_mask:0xf
    v_mul_f32_dpp v197, v243, v73 row_newbcast:1 row_mask:0xf bank_mask:0xf
    v_mul_f32_dpp v198, v243, v72 row_newbcast:8 row_mask:0xf bank_mask:0xf
    v_mul_f32_dpp v199, v243, v73 row_newbcast:9 row_mask:0xf bank_mask:0xf
    v_mul_f32_dpp v200, v243, v76 row_newbcast:2 row_mask:0xf bank_mask:0xf
    v_mul_f32_dpp v201, v243, v77 row_newbcast:3 row_mask:0xf bank_mask:0xf
    v_mul_f32_dpp v202, v243, v76 row_newbcast:10 row_mask:0xf bank_mask:0xf
    v_mul_f32_dpp v203, v243, v77 row_newbcast:11 row_mask:0xf bank_mask:0xf
    v_cvt_pk_bf16_f32 v72, v196, v197
    v_cvt_pk_bf16_f32 v76, v198, v199
    v_cvt_pk_bf16_f32 v73, v200, v201
    v_cvt_pk_bf16_f32 v77, v202, v203
    s_add_u32 m0, s21, 0
    v_mfma_f32_32x32x16_bf16 v[16:31], v[68:71], v[176:179], 0
    buffer_load_dwordx4 v234, s[4:7], s35 offen  lds
    buffer_load_dwordx4 v235, s[8:11], s35 offen offset:1024  lds
    ds_read_b64_tr_b16 v[176:177], v244 offset:2048
    ds_read_b64_tr_b16 v[178:179], v244 offset:3072
    ds_read_b64_tr_b16 v[184:185], v245 offset:2048
    ds_read_b64_tr_b16 v[186:187], v245 offset:3072
    v_mul_f32_dpp v196, v243, v74 row_newbcast:4 row_mask:0xf bank_mask:0xf
    v_mul_f32_dpp v197, v243, v75 row_newbcast:5 row_mask:0xf bank_mask:0xf
    v_mul_f32_dpp v198, v243, v74 row_newbcast:12 row_mask:0xf bank_mask:0xf
    v_mul_f32_dpp v199, v243, v75 row_newbcast:13 row_mask:0xf bank_mask:0xf
    v_mul_f32_dpp v200, v243, v78 row_newbcast:6 row_mask:0xf bank_mask:0xf
    v_mul_f32_dpp v201, v243, v79 row_newbcast:7 row_mask:0xf bank_mask:0xf
    v_mul_f32_dpp v202, v243, v78 row_newbcast:14 row_mask:0xf bank_mask:0xf
    v_mul_f32_dpp v203, v243, v79 row_newbcast:15 row_mask:0xf bank_mask:0xf
    v_cvt_pk_bf16_f32 v74, v196, v197
    v_cvt_pk_bf16_f32 v78, v198, v199
    v_cvt_pk_bf16_f32 v75, v200, v201
    v_cvt_pk_bf16_f32 v79, v202, v203
    s_mov_b64 exec, s[54:55]
    ds_read_u16_d16_hi v243, v250 offset:384
    s_mov_b64 exec, -1
    s_waitcnt vmcnt(4) lgkmcnt(1)
    v_mfma_f32_32x32x16_bf16 v[0:15], v[72:75], v[176:179], v[0:15]
    v_mul_f32_dpp v196, v242, v80 row_newbcast:0 row_mask:0xf bank_mask:0xf
    v_mul_f32_dpp v197, v242, v81 row_newbcast:1 row_mask:0xf bank_mask:0xf
    v_mul_f32_dpp v198, v242, v80 row_newbcast:8 row_mask:0xf bank_mask:0xf
    v_mul_f32_dpp v199, v242, v81 row_newbcast:9 row_mask:0xf bank_mask:0xf
    v_mul_f32_dpp v200, v242, v84 row_newbcast:2 row_mask:0xf bank_mask:0xf
    v_mul_f32_dpp v201, v242, v85 row_newbcast:3 row_mask:0xf bank_mask:0xf
    v_mul_f32_dpp v202, v242, v84 row_newbcast:10 row_mask:0xf bank_mask:0xf
    v_mul_f32_dpp v203, v242, v85 row_newbcast:11 row_mask:0xf bank_mask:0xf
    v_cvt_pk_bf16_f32 v80, v196, v197
    v_cvt_pk_bf16_f32 v84, v198, v199
    v_cvt_pk_bf16_f32 v81, v200, v201
    v_cvt_pk_bf16_f32 v85, v202, v203
    s_add_u32 m0, s21, 2048
    v_mfma_f32_32x32x16_bf16 v[16:31], v[76:79], v[176:179], v[16:31]
    buffer_load_dwordx4 v236, s[4:7], s35 offen  lds
    buffer_load_dwordx4 v237, s[8:11], s35 offen offset:1024  lds
    ds_read_b64_tr_b16 v[176:177], v244 offset:4096
    ds_read_b64_tr_b16 v[178:179], v244 offset:5120
    ds_read_b64_tr_b16 v[188:189], v245 offset:4096
    ds_read_b64_tr_b16 v[190:191], v245 offset:5120
    v_mul_f32_dpp v196, v242, v82 row_newbcast:4 row_mask:0xf bank_mask:0xf
    v_mul_f32_dpp v197, v242, v83 row_newbcast:5 row_mask:0xf bank_mask:0xf
    v_mul_f32_dpp v198, v242, v82 row_newbcast:12 row_mask:0xf bank_mask:0xf
    v_mul_f32_dpp v199, v242, v83 row_newbcast:13 row_mask:0xf bank_mask:0xf
    v_mul_f32_dpp v200, v242, v86 row_newbcast:6 row_mask:0xf bank_mask:0xf
    v_mul_f32_dpp v201, v242, v87 row_newbcast:7 row_mask:0xf bank_mask:0xf
    v_mul_f32_dpp v202, v242, v86 row_newbcast:14 row_mask:0xf bank_mask:0xf
    v_mul_f32_dpp v203, v242, v87 row_newbcast:15 row_mask:0xf bank_mask:0xf
    v_cvt_pk_bf16_f32 v82, v196, v197
    v_cvt_pk_bf16_f32 v86, v198, v199
    v_cvt_pk_bf16_f32 v83, v200, v201
    v_cvt_pk_bf16_f32 v87, v202, v203
    s_nop 0
    s_waitcnt vmcnt(4) lgkmcnt(0)
    v_mfma_f32_32x32x16_bf16 v[0:15], v[80:83], v[176:179], v[0:15]
    v_mul_f32_dpp v196, v243, v88 row_newbcast:0 row_mask:0xf bank_mask:0xf
    v_mul_f32_dpp v197, v243, v89 row_newbcast:1 row_mask:0xf bank_mask:0xf
    v_mul_f32_dpp v198, v243, v88 row_newbcast:8 row_mask:0xf bank_mask:0xf
    v_mul_f32_dpp v199, v243, v89 row_newbcast:9 row_mask:0xf bank_mask:0xf
    v_mul_f32_dpp v200, v243, v92 row_newbcast:2 row_mask:0xf bank_mask:0xf
    v_mul_f32_dpp v201, v243, v93 row_newbcast:3 row_mask:0xf bank_mask:0xf
    v_mul_f32_dpp v202, v243, v92 row_newbcast:10 row_mask:0xf bank_mask:0xf
    v_mul_f32_dpp v203, v243, v93 row_newbcast:11 row_mask:0xf bank_mask:0xf
    v_cvt_pk_bf16_f32 v88, v196, v197
    v_cvt_pk_bf16_f32 v92, v198, v199
    v_cvt_pk_bf16_f32 v89, v200, v201
    v_cvt_pk_bf16_f32 v93, v202, v203
    s_add_u32 m0, s21, 4096
    v_mfma_f32_32x32x16_bf16 v[16:31], v[84:87], v[176:179], v[16:31]
    buffer_load_dwordx4 v238, s[4:7], s35 offen  lds
    buffer_load_dwordx4 v239, s[8:11], s35 offen offset:1024  lds
    ds_read_b64_tr_b16 v[176:177], v244 offset:6144
    ds_read_b64_tr_b16 v[178:179], v244 offset:7168
    ds_read_b64_tr_b16 v[192:193], v245 offset:6144
    ds_read_b64_tr_b16 v[194:195], v245 offset:7168
    v_mul_f32_dpp v196, v243, v90 row_newbcast:4 row_mask:0xf bank_mask:0xf
    v_mul_f32_dpp v197, v243, v91 row_newbcast:5 row_mask:0xf bank_mask:0xf
    v_mul_f32_dpp v198, v243, v90 row_newbcast:12 row_mask:0xf bank_mask:0xf
    v_mul_f32_dpp v199, v243, v91 row_newbcast:13 row_mask:0xf bank_mask:0xf
    v_mul_f32_dpp v200, v243, v94 row_newbcast:6 row_mask:0xf bank_mask:0xf
    v_mul_f32_dpp v201, v243, v95 row_newbcast:7 row_mask:0xf bank_mask:0xf
    v_mul_f32_dpp v202, v243, v94 row_newbcast:14 row_mask:0xf bank_mask:0xf
    v_mul_f32_dpp v203, v243, v95 row_newbcast:15 row_mask:0xf bank_mask:0xf
    v_cvt_pk_bf16_f32 v90, v196, v197
    v_cvt_pk_bf16_f32 v94, v198, v199
    v_cvt_pk_bf16_f32 v91, v200, v201
    v_cvt_pk_bf16_f32 v95, v202, v203
    s_nop 0
    s_waitcnt lgkmcnt(0)
    v_mfma_f32_32x32x16_bf16 v[0:15], v[88:91], v[176:179], v[0:15]
    s_add_u32 m0, s21, 6144
    v_mfma_f32_32x32x16_bf16 v[16:31], v[92:95], v[176:179], v[16:31]
    buffer_load_dwordx4 v240, s[4:7], s35 offen  lds
    buffer_load_dwordx4 v241, s[8:11], s35 offen offset:1024  lds
    s_mov_b32 m0, s50
    s_nop 0
    s_movrels_b32 s71, s23
    s_movrels_b32 s33, s28
    v_add_u32 v253, s33, v248
    s_bfe_u32 s46, s71, 0x30012
    s_mov_b32 m0, s46
    s_and_b32 s66, s71, 0x3ffff
    s_movrels_b32 s68, s57
    s_movrels_b32 s69, s61
    s_sub_u32 s48, s66, s47
    s_mov_b32 s47, s66
    s_lshr_b32 s52, s71, 28
    s_lshl_b32 s67, s46, 9
    s_add_u32 s66, s66, s67
    s_sub_u32 s49, s66, s42
    s_mov_b32 s42, s66
    s_bfe_u32 s66, s68, 655360
    s_add_u32 s43, s42, s66
    s_bfe_u32 s39, s69, 655360
    s_bfe_u32 s66, s68, 655370
    s_add_u32 s44, s42, s66
    s_bfe_u32 s40, s69, 655370
    s_bfe_u32 s66, s68, 655380
    s_add_u32 s45, s42, s66
    s_bfe_u32 s41, s69, 655380
    v_mfma_f32_32x32x16_bf16 v[32:47], v[64:67], v[180:183], 0
    v_mul_f32 v196, v0, v96
    v_fmac_f32 v196, v1, v97
    v_fmac_f32 v196, v2, v98
    v_fmac_f32 v196, v3, v99
    v_fmac_f32 v196, v4, v100
    v_mfma_f32_32x32x16_bf16 v[48:63], v[68:71], v[180:183], 0
    v_fmac_f32 v196, v5, v101
    v_fmac_f32 v196, v6, v102
    v_fmac_f32 v196, v7, v103
    v_mul_f32 v198, v8, v128
    v_fmac_f32 v198, v9, v129
    v_mfma_f32_32x32x16_bf16 v[32:47], v[72:75], v[184:187], v[32:47]
    v_fmac_f32 v198, v10, v130
    v_fmac_f32 v198, v11, v131
    v_fmac_f32 v198, v12, v132
    v_fmac_f32 v198, v13, v133
    v_mfma_f32_32x32x16_bf16 v[48:63], v[76:79], v[184:187], v[48:63]
    v_fmac_f32 v198, v14, v134
    v_fmac_f32 v198, v15, v135
    v_mul_f32 v200, v16, v128
    v_fmac_f32 v200, v17, v129
    v_permlane32_swap_b32 v196, v198
    v_mfma_f32_32x32x16_bf16 v[32:47], v[80:83], v[188:191], v[32:47]
    v_fmac_f32 v200, v18, v130
    v_fmac_f32 v200, v19, v131
    v_fmac_f32 v200, v20, v132
    v_fmac_f32 v200, v21, v133
    v_fmac_f32 v200, v22, v134
    v_mfma_f32_32x32x16_bf16 v[48:63], v[84:87], v[188:191], v[48:63]
    s_waitcnt vmcnt(6)
    ds_read_b64_tr_b16 v[176:177], v244 offset:0
    ds_read_b64_tr_b16 v[178:179], v244 offset:1024
    ds_read_b64_tr_b16 v[180:181], v245 offset:0
    ds_read_b64_tr_b16 v[182:183], v245 offset:1024
    v_fmac_f32 v200, v23, v135
    v_add_f32 v198, v196, v198
    v_mul_f32_e64 v202, v24, -v128
    v_fma_f32 v202, v25, -v129, v202
    v_mfma_f32_32x32x16_bf16 v[32:47], v[88:91], v[192:195], v[32:47]
    v_fma_f32 v202, v26, -v130, v202
    v_fma_f32 v202, v27, -v131, v202
    v_fma_f32 v202, v28, -v132, v202
    v_fma_f32 v202, v29, -v133, v202
    v_fma_f32 v202, v30, -v134, v202
    v_mfma_f32_32x32x16_bf16 v[48:63], v[92:95], v[192:195], v[48:63]
    v_fma_f32 v202, v31, -v135, v202
    s_nop 1
    v_permlane32_swap_b32 v200, v202
    v_add_f32 v202, v200, v202
    s_waitcnt vmcnt(4) lgkmcnt(0)
    v_mfma_f32_32x32x16_bf16 v[0:15], v[64:67], v[176:179], 0
    v_mul_f32 v197, v32, v104
    v_fmac_f32 v197, v33, v105
    v_fmac_f32 v197, v34, v106
    v_fmac_f32 v197, v35, v107
    v_fmac_f32 v197, v36, v108
    s_add_u32 m0, s21, 0
    v_mfma_f32_32x32x16_bf16 v[16:31], v[68:71], v[176:179], 0
    buffer_load_dwordx4 v234, s[4:7], s36 offen  lds
    buffer_load_dwordx4 v235, s[8:11], s36 offen offset:1024  lds
    ds_read_b64_tr_b16 v[176:177], v244 offset:2048
    ds_read_b64_tr_b16 v[178:179], v244 offset:3072
    ds_read_b64_tr_b16 v[184:185], v245 offset:2048
    ds_read_b64_tr_b16 v[186:187], v245 offset:3072
    v_fmac_f32 v197, v37, v109
    v_fmac_f32 v197, v38, v110
    v_fmac_f32 v197, v39, v111
    v_mul_f32 v199, v40, v136
    v_fmac_f32 v199, v41, v137
    s_waitcnt vmcnt(4) lgkmcnt(0)
    v_mfma_f32_32x32x16_bf16 v[0:15], v[72:75], v[176:179], v[0:15]
    v_fmac_f32 v199, v42, v138
    v_fmac_f32 v199, v43, v139
    v_fmac_f32 v199, v44, v140
    v_fmac_f32 v199, v45, v141
    v_fmac_f32 v199, v46, v142
    s_add_u32 m0, s21, 2048
    v_mfma_f32_32x32x16_bf16 v[16:31], v[76:79], v[176:179], v[16:31]
    buffer_load_dwordx4 v236, s[4:7], s36 offen  lds
    buffer_load_dwordx4 v237, s[8:11], s36 offen offset:1024  lds
    ds_read_b64_tr_b16 v[176:177], v244 offset:4096
    ds_read_b64_tr_b16 v[178:179], v244 offset:5120
    ds_read_b64_tr_b16 v[188:189], v245 offset:4096
    ds_read_b64_tr_b16 v[190:191], v245 offset:5120
    v_fmac_f32 v199, v47, v143
    v_mul_f32 v201, v48, v136
    v_fmac_f32 v201, v49, v137
    v_permlane32_swap_b32 v197, v199
    v_fmac_f32 v201, v50, v138
    s_waitcnt vmcnt(4) lgkmcnt(0)
    v_mfma_f32_32x32x16_bf16 v[0:15], v[80:83], v[176:179], v[0:15]
    v_fmac_f32 v201, v51, v139
    v_fmac_f32 v201, v52, v140
    v_fmac_f32 v201, v53, v141
    v_fmac_f32 v201, v54, v142
    v_fmac_f32 v201, v55, v143
    s_add_u32 m0, s21, 4096
    v_mfma_f32_32x32x16_bf16 v[16:31], v[84:87], v[176:179], v[16:31]
    buffer_load_dwordx4 v238, s[4:7], s36 offen  lds
    buffer_load_dwordx4 v239, s[8:11], s36 offen offset:1024  lds
    ds_read_b64_tr_b16 v[176:177], v244 offset:6144
    ds_read_b64_tr_b16 v[178:179], v244 offset:7168
    ds_read_b64_tr_b16 v[192:193], v245 offset:6144
    ds_read_b64_tr_b16 v[194:195], v245 offset:7168
    v_add_f32 v199, v197, v199
    v_mul_f32_e64 v203, v56, -v136
    v_fma_f32 v203, v57, -v137, v203
    v_fma_f32 v203, v58, -v138, v203
    v_fma_f32 v203, v59, -v139, v203
    s_waitcnt lgkmcnt(0)
    v_mfma_f32_32x32x16_bf16 v[0:15], v[88:91], v[176:179], v[0:15]
    v_fma_f32 v203, v60, -v140, v203
    v_fma_f32 v203, v61, -v141, v203
    v_fma_f32 v203, v62, -v142, v203
    v_fma_f32 v203, v63, -v143, v203
    s_nop 1
    s_add_u32 m0, s21, 6144
    v_mfma_f32_32x32x16_bf16 v[16:31], v[92:95], v[176:179], v[16:31]
    buffer_load_dwordx4 v240, s[4:7], s36 offen  lds
    buffer_load_dwordx4 v241, s[8:11], s36 offen offset:1024  lds
    v_permlane32_swap_b32 v201, v203
    v_add_f32 v203, v201, v203
    v_cvt_pk_bf16_f32 v198, v198, v199
    v_cvt_pk_bf16_f32 v202, v202, v203
    ds_write2st64_b32 v253, v198, v202 offset0:0 offset1:1
    v_mfma_f32_32x32x16_bf16 v[32:47], v[64:67], v[180:183], 0
    v_mul_f32 v196, v0, v144
    v_fmac_f32 v196, v1, v145
    v_fmac_f32 v196, v2, v146
    v_fmac_f32 v196, v3, v147
    v_mfma_f32_32x32x16_bf16 v[48:63], v[68:71], v[180:183], 0
    v_fmac_f32 v196, v4, v148
    v_fmac_f32 v196, v5, v149
    v_fmac_f32 v196, v6, v150
    v_fmac_f32 v196, v7, v151
    v_mfma_f32_32x32x16_bf16 v[32:47], v[72:75], v[184:187], v[32:47]
    v_mul_f32 v198, v8, v112
    v_fmac_f32 v198, v9, v113
    v_fmac_f32 v198, v10, v114
    v_fmac_f32 v198, v11, v115
    v_mfma_f32_32x32x16_bf16 v[48:63], v[76:79], v[184:187], v[48:63]
    v_fmac_f32 v198, v12, v116
    v_fmac_f32 v198, v13, v117
    v_fmac_f32 v198, v14, v118
    v_fmac_f32 v198, v15, v119
    v_mfma_f32_32x32x16_bf16 v[32:47], v[80:83], v[188:191], v[32:47]
    v_mul_f32_e64 v200, v16, -v160
    v_fma_f32 v200, v17, -v161, v200
    v_fma_f32 v200, v18, -v162, v200
    v_fma_f32 v200, v19, -v163, v200
    v_mfma_f32_32x32x16_bf16 v[48:63], v[84:87], v[188:191], v[48:63]
    s_waitcnt vmcnt(6)
    ds_read_b64_tr_b16 v[176:177], v244 offset:0
    ds_read_b64_tr_b16 v[178:179], v244 offset:1024
    ds_read_b64_tr_b16 v[180:181], v245 offset:0
    ds_read_b64_tr_b16 v[182:183], v245 offset:1024
    v_fma_f32 v200, v20, -v164, v200
    v_fma_f32 v200, v21, -v165, v200
    v_fma_f32 v200, v22, -v166, v200
    v_fma_f32 v200, v23, -v167, v200
    v_mfma_f32_32x32x16_bf16 v[32:47], v[88:91], v[192:195], v[32:47]
    v_mul_f32_e64 v202, v24, -v160
    v_fma_f32 v202, v25, -v161, v202
    v_fma_f32 v202, v26, -v162, v202
    v_fma_f32 v202, v27, -v163, v202
    v_mfma_f32_32x32x16_bf16 v[48:63], v[92:95], v[192:195], v[48:63]
    v_fma_f32 v202, v28, -v164, v202
    v_fma_f32 v202, v29, -v165, v202
    v_fma_f32 v202, v30, -v166, v202
    v_fma_f32 v202, v31, -v167, v202
    s_waitcnt vmcnt(4) lgkmcnt(0)
    v_mfma_f32_32x32x16_bf16 v[0:15], v[64:67], v[176:179], 0
    s_nop 0
    v_mul_f32 v197, v32, v152
    v_fmac_f32 v197, v33, v153
    v_fmac_f32 v197, v34, v154
    v_fmac_f32 v197, v35, v155
    s_add_u32 m0, s21, 0
    v_mfma_f32_32x32x16_bf16 v[16:31], v[68:71], v[176:179], 0
    buffer_load_dwordx4 v234, s[4:7], s37 offen  lds
    buffer_load_dwordx4 v235, s[8:11], s37 offen offset:1024  lds
    ds_read_b64_tr_b16 v[176:177], v244 offset:2048
    ds_read_b64_tr_b16 v[178:179], v244 offset:3072
    ds_read_b64_tr_b16 v[184:185], v245 offset:2048
    ds_read_b64_tr_b16 v[186:187], v245 offset:3072
    v_add_u32 v252, s42, v247
    ds_read_u16 v234, v252
    ds_read_u16 v235, v252 offset:64
    v_fmac_f32 v197, v36, v156
    v_fmac_f32 v197, v37, v157
    v_fmac_f32 v197, v38, v158
    v_fmac_f32 v197, v39, v159
    s_waitcnt vmcnt(4) lgkmcnt(2)
    v_mfma_f32_32x32x16_bf16 v[0:15], v[72:75], v[176:179], v[0:15]
    v_mul_f32 v199, v40, v120
    v_fmac_f32 v199, v41, v121
    v_fmac_f32 v199, v42, v122
    v_fmac_f32 v199, v43, v123
    s_add_u32 m0, s21, 2048
    v_mfma_f32_32x32x16_bf16 v[16:31], v[76:79], v[176:179], v[16:31]
    buffer_load_dwordx4 v236, s[4:7], s37 offen  lds
    buffer_load_dwordx4 v237, s[8:11], s37 offen offset:1024  lds
    ds_read_b64_tr_b16 v[176:177], v244 offset:4096
    ds_read_b64_tr_b16 v[178:179], v244 offset:5120
    ds_read_b64_tr_b16 v[188:189], v245 offset:4096
    ds_read_b64_tr_b16 v[190:191], v245 offset:5120
    v_add_u32 v252, s43, v247
    ds_read_u16 v236, v252
    ds_read_u16 v237, v252 offset:64
    v_fmac_f32 v199, v44, v124
    v_fmac_f32 v199, v45, v125
    v_fmac_f32 v199, v46, v126
    v_fmac_f32 v199, v47, v127
    s_waitcnt vmcnt(4) lgkmcnt(2)
    v_mfma_f32_32x32x16_bf16 v[0:15], v[80:83], v[176:179], v[0:15]
    v_mul_f32_e64 v201, v48, -v168
    v_fma_f32 v201, v49, -v169, v201
    v_fma_f32 v201, v50, -v170, v201
    v_fma_f32 v201, v51, -v171, v201
    s_add_u32 m0, s21, 4096
    v_mfma_f32_32x32x16_bf16 v[16:31], v[84:87], v[176:179], v[16:31]
    buffer_load_dwordx4 v238, s[4:7], s37 offen  lds
    buffer_load_dwordx4 v239, s[8:11], s37 offen offset:1024  lds
    ds_read_b64_tr_b16 v[176:177], v244 offset:6144
    ds_read_b64_tr_b16 v[178:179], v244 offset:7168
    ds_read_b64_tr_b16 v[192:193], v245 offset:6144
    ds_read_b64_tr_b16 v[194:195], v245 offset:7168
    v_add_u32 v252, s44, v247
    ds_read_u16 v238, v252
    ds_read_u16 v239, v252 offset:64
    v_fma_f32 v201, v52, -v172, v201
    v_fma_f32 v201, v53, -v173, v201
    v_fma_f32 v201, v54, -v174, v201
    v_fma_f32 v201, v55, -v175, v201
    s_waitcnt lgkmcnt(2)
    v_mfma_f32_32x32x16_bf16 v[0:15], v[88:91], v[176:179], v[0:15]
    v_mul_f32_e64 v203, v56, -v168
    v_fma_f32 v203, v57, -v169, v203
    v_fma_f32 v203, v58, -v170, v203
    v_fma_f32 v203, v59, -v171, v203
    s_add_u32 m0, s21, 6144
    v_mfma_f32_32x32x16_bf16 v[16:31], v[92:95], v[176:179], v[16:31]
    buffer_load_dwordx4 v240, s[4:7], s37 offen  lds
    buffer_load_dwordx4 v241, s[8:11], s37 offen offset:1024  lds
    v_add_u32 v252, s45, v247
    ds_read_u16 v240, v252
    ds_read_u16 v241, v252 offset:64
    v_fma_f32 v203, v60, -v172, v203
    v_fma_f32 v203, v61, -v173, v203
    v_fma_f32 v203, v62, -v174, v203
    v_fma_f32 v203, v63, -v175, v203
    v_mfma_f32_32x32x16_bf16 v[32:47], v[64:67], v[180:183], 0
    v_mul_f32 v254, v0, v144
    v_fmac_f32 v254, v1, v145
    v_fmac_f32 v254, v2, v146
    v_mfma_f32_32x32x16_bf16 v[48:63], v[68:71], v[180:183], 0
    ds_swizzle_b32 v68, v68 offset:0x401F
    ds_swizzle_b32 v69, v69 offset:0x401F
    ds_swizzle_b32 v70, v70 offset:0x401F
    ds_swizzle_b32 v71, v71 offset:0x401F
    v_fmac_f32 v254, v3, v147
    v_fmac_f32 v254, v4, v148
    v_mfma_f32_32x32x16_bf16 v[32:47], v[72:75], v[184:187], v[32:47]
    v_fmac_f32 v254, v5, v149
    v_fmac_f32 v254, v6, v150
    v_mfma_f32_32x32x16_bf16 v[48:63], v[76:79], v[184:187], v[48:63]
    ds_swizzle_b32 v76, v76 offset:0x401F
    ds_swizzle_b32 v77, v77 offset:0x401F
    ds_swizzle_b32 v78, v78 offset:0x401F
    ds_swizzle_b32 v79, v79 offset:0x401F
    v_fmac_f32 v254, v7, v151
    v_fmac_f32 v200, v8, v160
    v_mfma_f32_32x32x16_bf16 v[32:47], v[80:83], v[188:191], v[32:47]
    v_fmac_f32 v200, v9, v161
    v_permlane32_swap_b32 v196, v254
    v_fmac_f32 v200, v10, v162
    v_mfma_f32_32x32x16_bf16 v[48:63], v[84:87], v[188:191], v[48:63]
    ds_swizzle_b32 v84, v84 offset:0x401F
    ds_swizzle_b32 v85, v85 offset:0x401F
    ds_swizzle_b32 v86, v86 offset:0x401F
    ds_swizzle_b32 v87, v87 offset:0x401F
    s_waitcnt vmcnt(6)
    ds_read_b64_tr_b16 v[176:177], v244 offset:0
    ds_read_b64_tr_b16 v[178:179], v244 offset:1024
    ds_read_b64_tr_b16 v[180:181], v245 offset:0
    ds_read_b64_tr_b16 v[182:183], v245 offset:1024
    v_fmac_f32 v200, v11, v163
    v_fmac_f32 v200, v12, v164
    v_mfma_f32_32x32x16_bf16 v[32:47], v[88:91], v[192:195], v[32:47]
    v_fmac_f32 v200, v13, v165
    v_fmac_f32 v200, v14, v166
    v_mfma_f32_32x32x16_bf16 v[48:63], v[92:95], v[192:195], v[48:63]
    ds_swizzle_b32 v92, v92 offset:0x401F
    ds_swizzle_b32 v93, v93 offset:0x401F
    ds_swizzle_b32 v94, v94 offset:0x401F
    ds_swizzle_b32 v95, v95 offset:0x401F
    v_fmac_f32 v200, v15, v167
    v_add_f32 v254, v196, v254
    s_waitcnt lgkmcnt(8)
    s_mov_b64 exec, s[56:57]
    v_xor_b32 v68, 0x80008000, v68
    v_xor_b32 v69, 0x80008000, v69
    v_xor_b32 v70, 0x80008000, v70
    v_xor_b32 v71, 0x80008000, v71
    v_xor_b32 v76, 0x80008000, v76
    v_xor_b32 v77, 0x80008000, v77
    v_xor_b32 v78, 0x80008000, v78
    v_xor_b32 v79, 0x80008000, v79
    v_xor_b32 v84, 0x80008000, v84
    v_xor_b32 v85, 0x80008000, v85
    v_xor_b32 v86, 0x80008000, v86
    v_xor_b32 v87, 0x80008000, v87
    s_mov_b64 exec, -1
    s_waitcnt vmcnt(4) lgkmcnt(4)
    v_mfma_f32_32x32x16_bf16 v[0:15], v[64:67], v[176:179], 0
    v_mul_f32 v255, v32, v152
    v_fmac_f32 v255, v33, v153
    v_fmac_f32 v255, v34, v154
    s_add_u32 m0, s21, 0
    s_cmp_eq_u32 s50, 4
    v_mfma_f32_32x32x16_bf16 v[16:31], v[68:71], v[176:179], v[16:31]
    s_cbranch_scc1 WL_8_0
    v_lshl_add_u32 v234, v234, 10, v246
    v_lshl_add_u32 v235, v235, 10, v246
    buffer_load_dwordx4 v234, s[4:7], s38 offen  lds
    buffer_load_dwordx4 v235, s[8:11], s38 offen offset:1024  lds
WR_8_0:
    ds_read_b64_tr_b16 v[176:177], v244 offset:2048
    ds_read_b64_tr_b16 v[178:179], v244 offset:3072
    ds_read_b64_tr_b16 v[184:185], v245 offset:2048
    ds_read_b64_tr_b16 v[186:187], v245 offset:3072
    v_fmac_f32 v255, v35, v155
    v_fmac_f32 v255, v36, v156
    s_waitcnt vmcnt(4) lgkmcnt(0)
    v_mfma_f32_32x32x16_bf16 v[0:15], v[72:75], v[176:179], v[0:15]
    v_fmac_f32 v255, v37, v157
    v_fmac_f32 v255, v38, v158
    v_fmac_f32 v255, v39, v159
    s_add_u32 m0, s21, 2048
    s_cmp_eq_u32 s50, 4
    v_mfma_f32_32x32x16_bf16 v[16:31], v[76:79], v[176:179], v[16:31]
    s_cbranch_scc1 WL_8_1
    v_lshl_add_u32 v236, v236, 10, v246
    v_lshl_add_u32 v237, v237, 10, v246
    buffer_load_dwordx4 v236, s[4:7], s39 offen  lds
    buffer_load_dwordx4 v237, s[8:11], s39 offen offset:1024  lds
WR_8_1:
    ds_read_b64_tr_b16 v[176:177], v244 offset:4096
    ds_read_b64_tr_b16 v[178:179], v244 offset:5120
    ds_read_b64_tr_b16 v[188:189], v245 offset:4096
    ds_read_b64_tr_b16 v[190:191], v245 offset:5120
    v_fmac_f32 v201, v40, v168
    v_fmac_f32 v201, v41, v169
    s_waitcnt vmcnt(4) lgkmcnt(0)
    v_mfma_f32_32x32x16_bf16 v[0:15], v[80:83], v[176:179], v[0:15]
    v_permlane32_swap_b32 v197, v255
    v_fmac_f32 v201, v42, v170
    v_fmac_f32 v201, v43, v171
    s_add_u32 m0, s21, 4096
    s_cmp_eq_u32 s50, 4
    v_mfma_f32_32x32x16_bf16 v[16:31], v[84:87], v[176:179], v[16:31]
    s_cbranch_scc1 WL_8_2
    v_lshl_add_u32 v238, v238, 10, v246
    v_lshl_add_u32 v239, v239, 10, v246
    buffer_load_dwordx4 v238, s[4:7], s40 offen  lds
    buffer_load_dwordx4 v239, s[8:11], s40 offen offset:1024  lds
WR_8_2:
    ds_read_b64_tr_b16 v[176:177], v244 offset:6144
    ds_read_b64_tr_b16 v[178:179], v244 offset:7168
    ds_read_b64_tr_b16 v[192:193], v245 offset:6144
    ds_read_b64_tr_b16 v[194:195], v245 offset:7168
    v_fmac_f32 v201, v44, v172
    v_fmac_f32 v201, v45, v173
    s_waitcnt lgkmcnt(0)
    s_mov_b64 exec, s[56:57]
    v_xor_b32 v92, 0x80008000, v92
    v_xor_b32 v93, 0x80008000, v93
    v_xor_b32 v94, 0x80008000, v94
    v_xor_b32 v95, 0x80008000, v95
    s_mov_b64 exec, -1
    v_mfma_f32_32x32x16_bf16 v[0:15], v[88:91], v[176:179], v[0:15]
    v_fmac_f32 v201, v46, v174
    v_fmac_f32 v201, v47, v175
    v_add_f32 v255, v197, v255
    s_add_u32 m0, s21, 6144
    s_cmp_eq_u32 s50, 4
    v_mfma_f32_32x32x16_bf16 v[16:31], v[92:95], v[176:179], v[16:31]
    s_cbranch_scc1 WL_8_3
    v_lshl_add_u32 v240, v240, 10, v246
    v_lshl_add_u32 v241, v241, 10, v246
    buffer_load_dwordx4 v240, s[4:7], s41 offen  lds
    buffer_load_dwordx4 v241, s[8:11], s41 offen offset:1024  lds
WR_8_3:
    v_cvt_pk_bf16_f32 v254, v254, v255
    ds_write_b32 v253, v254 offset:512
    v_mfma_f32_32x32x16_bf16 v[32:47], v[64:67], v[180:183], 0
    v_mul_f32 v254, v0, v144
    v_fmac_f32 v254, v1, v145
    v_fmac_f32 v254, v2, v146
    v_fmac_f32 v254, v3, v147
    v_fmac_f32 v254, v4, v148
    v_mfma_f32_32x32x16_bf16 v[48:63], v[68:71], v[180:183], v[48:63]
    v_fmac_f32 v254, v5, v149
    v_fmac_f32 v254, v6, v150
    v_fmac_f32 v254, v7, v151
    v_fma_f32 v202, v8, -v160, v202
    v_fma_f32 v202, v9, -v161, v202
    v_mfma_f32_32x32x16_bf16 v[32:47], v[72:75], v[184:187], v[32:47]
    v_permlane32_swap_b32 v254, v200
    v_fma_f32 v202, v10, -v162, v202
    v_fma_f32 v202, v11, -v163, v202
    v_fma_f32 v202, v12, -v164, v202
    v_fma_f32 v202, v13, -v165, v202
    v_mfma_f32_32x32x16_bf16 v[48:63], v[76:79], v[184:187], v[48:63]
    v_fma_f32 v202, v14, -v166, v202
    v_fma_f32 v202, v15, -v167, v202
    v_add_f32 v200, v254, v200
    v_fmac_f32 v198, v16, v112
    v_permlane32_swap_b32 v202, v254
    v_mfma_f32_32x32x16_bf16 v[32:47], v[80:83], v[188:191], v[32:47]
    v_fmac_f32 v198, v17, v113
    v_fmac_f32 v198, v18, v114
    v_fmac_f32 v198, v19, v115
    v_fmac_f32 v198, v20, v116
    v_fmac_f32 v198, v21, v117
    v_mfma_f32_32x32x16_bf16 v[48:63], v[84:87], v[188:191], v[48:63]
    s_waitcnt vmcnt(6)
    ds_read_b64_tr_b16 v[176:177], v244 offset:0
    ds_read_b64_tr_b16 v[178:179], v244 offset:1024
    ds_read_b64_tr_b16 v[180:181], v245 offset:0
    ds_read_b64_tr_b16 v[182:183], v245 offset:1024
    v_fmac_f32 v198, v22, v118
    v_fmac_f32 v198, v23, v119
    v_add_f32 v254, v202, v254
    v_mul_f32 v196, v24, v160
    v_fmac_f32 v196, v25, v161
    v_mfma_f32_32x32x16_bf16 v[32:47], v[88:91], v[192:195], v[32:47]
    v_fmac_f32 v196, v26, v162
    v_fmac_f32 v196, v27, v163
    v_fmac_f32 v196, v28, v164
    v_fmac_f32 v196, v29, v165
    v_fmac_f32 v196, v30, v166
    v_mfma_f32_32x32x16_bf16 v[48:63], v[92:95], v[192:195], v[48:63]
    v_add_u32 v249, s48, v249
    v_add_u32 v250, s49, v250
    ds_read_b32 v252, v251 offset:16
    ds_read_b64_tr_b16 v[64:65], v249 offset:0
    ds_read_b64_tr_b16 v[68:69], v249 offset:64
    ds_read_b64_tr_b16 v[66:67], v249 offset:256
    ds_read_b64_tr_b16 v[70:71], v249 offset:320
    s_mov_b64 exec, s[54:55]
    ds_read_u16_d16_hi v242, v250 offset:0
    s_mov_b64 exec, -1
    v_fmac_f32 v196, v31, v167
    s_nop 1
    v_permlane32_swap_b32 v198, v196
    v_add_f32 v196, v198, v196
    s_cmp_eq_u32 s50, 4
    s_cbranch_scc1 LEPI_1
    v_mul_f32 v255, v32, v152
    v_fmac_f32 v255, v33, v153
    v_fmac_f32 v255, v34, v154
    v_fmac_f32 v255, v35, v155
    v_fmac_f32 v255, v36, v156
    v_fmac_f32 v255, v37, v157
    v_fmac_f32 v255, v38, v158
    v_fmac_f32 v255, v39, v159
    v_fma_f32 v203, v40, -v168, v203
    v_fma_f32 v203, v41, -v169, v203
    v_permlane32_swap_b32 v255, v201
    v_fma_f32 v203, v42, -v170, v203
    v_fma_f32 v203, v43, -v171, v203
    v_fma_f32 v203, v44, -v172, v203
    v_fma_f32 v203, v45, -v173, v203
    v_fma_f32 v203, v46, -v174, v203
    v_fma_f32 v203, v47, -v175, v203
    v_add_f32 v201, v255, v201
    v_fmac_f32 v199, v48, v120
    v_permlane32_swap_b32 v203, v255
    v_fmac_f32 v199, v49, v121
    v_fmac_f32 v199, v50, v122
    v_fmac_f32 v199, v51, v123
    v_fmac_f32 v199, v52, v124
    v_fmac_f32 v199, v53, v125
    v_fmac_f32 v199, v54, v126
    v_fmac_f32 v199, v55, v127
    v_add_f32 v255, v203, v255
    v_mul_f32 v197, v56, v168
    v_fmac_f32 v197, v57, v169
    v_fmac_f32 v197, v58, v170
    v_fmac_f32 v197, v59, v171
    v_fmac_f32 v197, v60, v172
    v_fmac_f32 v197, v61, v173
    v_fmac_f32 v197, v62, v174
    v_fmac_f32 v197, v63, v175
    s_nop 1
    v_permlane32_swap_b32 v199, v197
    v_add_f32 v197, v199, v197
    v_cvt_pk_bf16_f32 v200, v200, v201
    v_cvt_pk_bf16_f32 v254, v254, v255
    v_cvt_pk_bf16_f32 v196, v196, v197
    ds_write2st64_b32 v253, v200, v196 offset0:3 offset1:4
    s_mov_b64 exec, 0xffffffff
    ds_write_b32 v253, v254 offset:1280
    s_mov_b64 exec, -1
    s_add_u32 s50, s50, 1
    s_cmp_ge_u32 s50, 4
    s_cbranch_scc1 LAST1
    s_waitcnt lgkmcnt(7)
    v_readfirstlane_b32 s66, v252
    s_add_u32 s53, s53, 1
    v_mov_b32 v252, s53
    s_cmp_le_u32 s53, s66
    ds_write2_b32 v251, v252, v252 offset0:0 offset1:8
    s_setprio 1
    s_cbranch_scc1 PRIO_15
    s_setprio 0
PRIO_15:
    s_cmp_eq_u32 s52, 4
    s_cbranch_scc1 ITEM_1_4
    s_cmp_eq_u32 s52, 5
    s_cbranch_scc1 ITEM_1_5
    s_cmp_eq_u32 s52, 3
    s_cbranch_scc1 ITEM_1_3
    s_cmp_eq_u32 s52, 6
    s_cbranch_scc1 ITEM_1_6
    s_cmp_eq_u32 s52, 8
    s_cbranch_scc1 ITEM_1_8
    s_branch ITEM_1_2
WL_8_0:
    s_add_u32 s66, s51, 0
    buffer_load_dwordx4 v[96:99], v246, s[16:19], s66 offen offset:2048 sc1
    buffer_load_dwordx4 v[100:103], v246, s[16:19], s66 offen offset:3072 sc1
    s_branch WR_8_0
WL_8_1:
    s_add_u32 s66, s51, 4096
    buffer_load_dwordx4 v[104:107], v246, s[16:19], s66 offen offset:2048 sc1
    buffer_load_dwordx4 v[108:111], v246, s[16:19], s66 offen offset:3072 sc1
    s_branch WR_8_1
WL_8_2:
    s_add_u32 s66, s51, 8192
    buffer_load_dwordx4 v[128:131], v246, s[16:19], s66 offen offset:2048 sc1
    buffer_load_dwordx4 v[132:135], v246, s[16:19], s66 offen offset:3072 sc1
    s_branch WR_8_2
WL_8_3:
    s_add_u32 s66, s51, 12288
    buffer_load_dwordx4 v[136:139], v246, s[16:19], s66 offen offset:2048 sc1
    buffer_load_dwordx4 v[140:143], v246, s[16:19], s66 offen offset:3072 sc1
    s_branch WR_8_3
.p2align 6
ITEM_1_2:
    s_mov_b32 m0, s50
    s_nop 0
    s_movrels_b32 s71, s23
    s_movrels_b32 s33, s28
    v_add_u32 v253, s33, v248
    s_bfe_u32 s46, s71, 0x30012
    s_mov_b32 m0, s46
    s_and_b32 s66, s71, 0x3ffff
    s_movrels_b32 s68, s57
    s_movrels_b32 s69, s61
    s_sub_u32 s48, s66, s47
    s_mov_b32 s47, s66
    s_lshr_b32 s52, s71, 28
    s_lshl_b32 s67, s46, 9
    s_add_u32 s66, s66, s67
    s_sub_u32 s49, s66, s42
    s_mov_b32 s42, s66
    s_bfe_u32 s66, s68, 655360
    s_add_u32 s43, s42, s66
    s_bfe_u32 s39, s69, 655360
    s_bfe_u32 s66, s68, 655370
    s_add_u32 s44, s42, s66
    s_bfe_u32 s40, s69, 655370
    s_bfe_u32 s66, s68, 655380
    s_add_u32 s45, s42, s66
    s_bfe_u32 s41, s69, 655380
    v_add_u32 v252, s42, v247
    ds_read_u16 v234, v252
    ds_read_u16 v235, v252 offset:64
    v_add_u32 v252, s43, v247
    ds_read_u16 v236, v252
    ds_read_u16 v237, v252 offset:64
    v_add_u32 v252, s44, v247
    ds_read_u16 v238, v252
    ds_read_u16 v239, v252 offset:64
    v_add_u32 v252, s45, v247
    ds_read_u16 v240, v252
    ds_read_u16 v241, v252 offset:64
    s_waitcnt lgkmcnt(8)
    v_mul_f32_dpp v196, v242, v64 row_newbcast:0 row_mask:0xf bank_mask:0xf
    v_mul_f32_dpp v197, v242, v65 row_newbcast:1 row_mask:0xf bank_mask:0xf
    v_mul_f32_dpp v198, v242, v64 row_newbcast:8 row_mask:0xf bank_mask:0xf
    v_mul_f32_dpp v199, v242, v65 row_newbcast:9 row_mask:0xf bank_mask:0xf
    v_mul_f32_dpp v200, v242, v68 row_newbcast:2 row_mask:0xf bank_mask:0xf
    v_mul_f32_dpp v201, v242, v69 row_newbcast:3 row_mask:0xf bank_mask:0xf
    v_mul_f32_dpp v202, v242, v68 row_newbcast:10 row_mask:0xf bank_mask:0xf
    v_mul_f32_dpp v203, v242, v69 row_newbcast:11 row_mask:0xf bank_mask:0xf
    v_cvt_pk_bf16_f32 v64, v196, v197
    v_cvt_pk_bf16_f32 v68, v198, v199
    v_cvt_pk_bf16_f32 v65, v200, v201
    v_cvt_pk_bf16_f32 v69, v202, v203
    v_mul_f32_dpp v196, v242, v66 row_newbcast:4 row_mask:0xf bank_mask:0xf
    v_mul_f32_dpp v197, v242, v67 row_newbcast:5 row_mask:0xf bank_mask:0xf
    v_mul_f32_dpp v198, v242, v66 row_newbcast:12 row_mask:0xf bank_mask:0xf
    v_mul_f32_dpp v199, v242, v67 row_newbcast:13 row_mask:0xf bank_mask:0xf
    v_mul_f32_dpp v200, v242, v70 row_newbcast:6 row_mask:0xf bank_mask:0xf
    v_mul_f32_dpp v201, v242, v71 row_newbcast:7 row_mask:0xf bank_mask:0xf
    v_mul_f32_dpp v202, v242, v70 row_newbcast:14 row_mask:0xf bank_mask:0xf
    v_mul_f32_dpp v203, v242, v71 row_newbcast:15 row_mask:0xf bank_mask:0xf
    v_cvt_pk_bf16_f32 v66, v196, v197
    v_cvt_pk_bf16_f32 v70, v198, v199
    v_cvt_pk_bf16_f32 v67, v200, v201
    v_cvt_pk_bf16_f32 v71, v202, v203
    s_nop 0
    s_waitcnt lgkmcnt(6)
    v_mfma_f32_32x32x16_bf16 v[0:15], v[64:67], v[176:179], 0
    s_add_u32 m0, s21, 0
    s_cmp_eq_u32 s50, 4
    v_mfma_f32_32x32x16_bf16 v[16:31], v[68:71], v[176:179], 0
    s_cbranch_scc1 WL_2_0
    v_lshl_add_u32 v234, v234, 10, v246
    v_lshl_add_u32 v235, v235, 10, v246
    buffer_load_dwordx4 v234, s[4:7], s38 offen  lds
    buffer_load_dwordx4 v235, s[8:11], s38 offen offset:1024  lds
WR_2_0:
    v_mfma_f32_32x32x16_bf16 v[32:47], v[64:67], v[180:183], 0
    s_nop 2
    v_mul_f32 v196, v0, v96
    v_fmac_f32 v196, v1, v97
    v_fmac_f32 v196, v2, v98
    v_fmac_f32 v196, v3, v99
    v_fmac_f32 v196, v4, v100
    v_fmac_f32 v196, v5, v101
    v_fmac_f32 v196, v6, v102
    v_fmac_f32 v196, v7, v103
    v_mul_f32 v198, v8, v128
    v_fmac_f32 v198, v9, v129
    v_fmac_f32 v198, v10, v130
    v_fmac_f32 v198, v11, v131
    v_fmac_f32 v198, v12, v132
    v_fmac_f32 v198, v13, v133
    v_fmac_f32 v198, v14, v134
    v_fmac_f32 v198, v15, v135
    v_mul_f32 v200, v16, v128
    v_fmac_f32 v200, v17, v129
    v_permlane32_swap_b32 v196, v198
    v_mfma_f32_32x32x16_bf16 v[48:63], v[68:71], v[180:183], 0
    s_waitcnt vmcnt(6)
    ds_read_b64_tr_b16 v[176:177], v244 offset:2048
    ds_read_b64_tr_b16 v[178:179], v244 offset:3072
    ds_read_b64_tr_b16 v[180:181], v245 offset:2048
    ds_read_b64_tr_b16 v[182:183], v245 offset:3072
    v_fmac_f32 v200, v18, v130
    v_fmac_f32 v200, v19, v131
    v_fmac_f32 v200, v20, v132
    v_fmac_f32 v200, v21, v133
    v_fmac_f32 v200, v22, v134
    v_fmac_f32 v200, v23, v135
    v_add_f32 v198, v196, v198
    v_mul_f32_e64 v202, v24, -v128
    v_fma_f32 v202, v25, -v129, v202
    v_fma_f32 v202, v26, -v130, v202
    v_fma_f32 v202, v27, -v131, v202
    v_fma_f32 v202, v28, -v132, v202
    v_fma_f32 v202, v29, -v133, v202
    v_fma_f32 v202, v30, -v134, v202
    v_fma_f32 v202, v31, -v135, v202
    s_nop 1
    v_permlane32_swap_b32 v200, v202
    v_add_f32 v202, v200, v202
    s_waitcnt lgkmcnt(0)
    v_mfma_f32_32x32x16_bf16 v[0:15], v[64:67], v[176:179], 0
    v_mul_f32 v197, v32, v104
    v_fmac_f32 v197, v33, v105
    v_fmac_f32 v197, v34, v106
    v_fmac_f32 v197, v35, v107
    v_fmac_f32 v197, v36, v108
    v_fmac_f32 v197, v37, v109
    v_fmac_f32 v197, v38, v110
    v_fmac_f32 v197, v39, v111
    v_mul_f32 v199, v40, v136
    v_fmac_f32 v199, v41, v137
    v_fmac_f32 v199, v42, v138
    v_fmac_f32 v199, v43, v139
    v_fmac_f32 v199, v44, v140
    v_fmac_f32 v199, v45, v141
    v_fmac_f32 v199, v46, v142
    v_fmac_f32 v199, v47, v143
    v_mul_f32 v201, v48, v136
    v_fmac_f32 v201, v49, v137
    v_permlane32_swap_b32 v197, v199
    v_fmac_f32 v201, v50, v138
    s_add_u32 m0, s21, 2048
    s_cmp_eq_u32 s50, 4
    v_mfma_f32_32x32x16_bf16 v[16:31], v[68:71], v[176:179], 0
    s_cbranch_scc1 WL_2_1
    v_lshl_add_u32 v236, v236, 10, v246
    v_lshl_add_u32 v237, v237, 10, v246
    buffer_load_dwordx4 v236, s[4:7], s39 offen  lds
    buffer_load_dwordx4 v237, s[8:11], s39 offen offset:1024  lds
WR_2_1:
    v_fmac_f32 v201, v51, v139
    v_fmac_f32 v201, v52, v140
    v_fmac_f32 v201, v53, v141
    v_fmac_f32 v201, v54, v142
    v_fmac_f32 v201, v55, v143
    v_add_f32 v199, v197, v199
    v_mul_f32_e64 v203, v56, -v136
    v_fma_f32 v203, v57, -v137, v203
    v_fma_f32 v203, v58, -v138, v203
    v_fma_f32 v203, v59, -v139, v203
    v_fma_f32 v203, v60, -v140, v203
    v_fma_f32 v203, v61, -v141, v203
    v_fma_f32 v203, v62, -v142, v203
    v_fma_f32 v203, v63, -v143, v203
    s_nop 1
    v_permlane32_swap_b32 v201, v203
    v_add_f32 v203, v201, v203
    v_cvt_pk_bf16_f32 v192, v198, v199
    v_cvt_pk_bf16_f32 v193, v202, v203
    v_mfma_f32_32x32x16_bf16 v[32:47], v[64:67], v[180:183], 0
    v_mul_f32 v196, v0, v144
    v_fmac_f32 v196, v1, v145
    v_fmac_f32 v196, v2, v146
    v_fmac_f32 v196, v3, v147
    v_fmac_f32 v196, v4, v148
    v_fmac_f32 v196, v5, v149
    v_fmac_f32 v196, v6, v150
    v_fmac_f32 v196, v7, v151
    v_mul_f32 v198, v8, v112
    v_fmac_f32 v198, v9, v113
    v_fmac_f32 v198, v10, v114
    v_fmac_f32 v198, v11, v115
    v_fmac_f32 v198, v12, v116
    v_fmac_f32 v198, v13, v117
    v_fmac_f32 v198, v14, v118
    v_fmac_f32 v198, v15, v119
    v_mfma_f32_32x32x16_bf16 v[48:63], v[68:71], v[180:183], 0
    s_waitcnt vmcnt(6)
    ds_read_b64_tr_b16 v[176:177], v244 offset:4096
    ds_read_b64_tr_b16 v[178:179], v244 offset:5120
    ds_read_b64_tr_b16 v[180:181], v245 offset:4096
    ds_read_b64_tr_b16 v[182:183], v245 offset:5120
    v_mul_f32_e64 v200, v16, -v160
    v_fma_f32 v200, v17, -v161, v200
    v_fma_f32 v200, v18, -v162, v200
    v_fma_f32 v200, v19, -v163, v200
    v_fma_f32 v200, v20, -v164, v200
    v_fma_f32 v200, v21, -v165, v200
    v_fma_f32 v200, v22, -v166, v200
    v_fma_f32 v200, v23, -v167, v200
    v_mul_f32_e64 v202, v24, -v160
    v_fma_f32 v202, v25, -v161, v202
    v_fma_f32 v202, v26, -v162, v202
    v_fma_f32 v202, v27, -v163, v202
    v_fma_f32 v202, v28, -v164, v202
    v_fma_f32 v202, v29, -v165, v202
    v_fma_f32 v202, v30, -v166, v202
    v_fma_f32 v202, v31, -v167, v202
    s_waitcnt lgkmcnt(0)
    v_mfma_f32_32x32x16_bf16 v[0:15], v[64:67], v[176:179], 0
    v_mul_f32 v197, v32, v152
    v_fmac_f32 v197, v33, v153
    v_fmac_f32 v197, v34, v154
    v_fmac_f32 v197, v35, v155
    v_fmac_f32 v197, v36, v156
    v_fmac_f32 v197, v37, v157
    v_fmac_f32 v197, v38, v158
    v_fmac_f32 v197, v39, v159
    v_mul_f32 v199, v40, v120
    v_fmac_f32 v199, v41, v121
    v_fmac_f32 v199, v42, v122
    v_fmac_f32 v199, v43, v123
    v_fmac_f32 v199, v44, v124
    v_fmac_f32 v199, v45, v125
    v_fmac_f32 v199, v46, v126
    v_fmac_f32 v199, v47, v127
    s_add_u32 m0, s21, 4096
    s_cmp_eq_u32 s50, 4
    v_mfma_f32_32x32x16_bf16 v[16:31], v[68:71], v[176:179], 0
    s_cbranch_scc1 WL_2_2
    v_lshl_add_u32 v238, v238, 10, v246
    v_lshl_add_u32 v239, v239, 10, v246
    buffer_load_dwordx4 v238, s[4:7], s40 offen  lds
    buffer_load_dwordx4 v239, s[8:11], s40 offen offset:1024  lds
WR_2_2:
    v_mul_f32_e64 v201, v48, -v168
    v_fma_f32 v201, v49, -v169, v201
    v_fma_f32 v201, v50, -v170, v201
    v_fma_f32 v201, v51, -v171, v201
    v_fma_f32 v201, v52, -v172, v201
    v_fma_f32 v201, v53, -v173, v201
    v_fma_f32 v201, v54, -v174, v201
    v_fma_f32 v201, v55, -v175, v201
    v_mul_f32_e64 v203, v56, -v168
    v_fma_f32 v203, v57, -v169, v203
    v_fma_f32 v203, v58, -v170, v203
    v_fma_f32 v203, v59, -v171, v203
    v_fma_f32 v203, v60, -v172, v203
    v_fma_f32 v203, v61, -v173, v203
    v_fma_f32 v203, v62, -v174, v203
    v_fma_f32 v203, v63, -v175, v203
    v_mfma_f32_32x32x16_bf16 v[32:47], v[64:67], v[180:183], 0
    v_mul_f32 v254, v0, v144
    v_fmac_f32 v254, v1, v145
    v_fmac_f32 v254, v2, v146
    v_fmac_f32 v254, v3, v147
    v_fmac_f32 v254, v4, v148
    v_fmac_f32 v254, v5, v149
    v_fmac_f32 v254, v6, v150
    v_fmac_f32 v254, v7, v151
    v_fmac_f32 v200, v8, v160
    v_mfma_f32_32x32x16_bf16 v[48:63], v[68:71], v[180:183], 0
    ds_swizzle_b32 v68, v68 offset:0x401F
    ds_swizzle_b32 v69, v69 offset:0x401F
    ds_swizzle_b32 v70, v70 offset:0x401F
    ds_swizzle_b32 v71, v71 offset:0x401F
    s_waitcnt vmcnt(6)
    ds_read_b64_tr_b16 v[176:177], v244 offset:6144
    ds_read_b64_tr_b16 v[178:179], v244 offset:7168
    ds_read_b64_tr_b16 v[180:181], v245 offset:6144
    ds_read_b64_tr_b16 v[182:183], v245 offset:7168
    v_fmac_f32 v200, v9, v161
    v_permlane32_swap_b32 v196, v254
    v_fmac_f32 v200, v10, v162
    v_fmac_f32 v200, v11, v163
    v_fmac_f32 v200, v12, v164
    v_fmac_f32 v200, v13, v165
    v_fmac_f32 v200, v14, v166
    v_fmac_f32 v200, v15, v167
    v_add_f32 v254, v196, v254
    s_waitcnt lgkmcnt(0)
    s_mov_b64 exec, s[56:57]
    v_xor_b32 v68, 0x80008000, v68
    v_xor_b32 v69, 0x80008000, v69
    v_xor_b32 v70, 0x80008000, v70
    v_xor_b32 v71, 0x80008000, v71
    s_mov_b64 exec, -1
    s_nop 0
    v_mfma_f32_32x32x16_bf16 v[0:15], v[64:67], v[176:179], 0
    v_mul_f32 v255, v32, v152
    v_fmac_f32 v255, v33, v153
    v_fmac_f32 v255, v34, v154
    v_fmac_f32 v255, v35, v155
    v_fmac_f32 v255, v36, v156
    v_fmac_f32 v255, v37, v157
    v_fmac_f32 v255, v38, v158
    v_fmac_f32 v255, v39, v159
    v_fmac_f32 v201, v40, v168
    v_fmac_f32 v201, v41, v169
    s_add_u32 m0, s21, 6144
    s_cmp_eq_u32 s50, 4
    v_mfma_f32_32x32x16_bf16 v[16:31], v[68:71], v[176:179], v[16:31]
    s_cbranch_scc1 WL_2_3
    v_lshl_add_u32 v240, v240, 10, v246
    v_lshl_add_u32 v241, v241, 10, v246
    buffer_load_dwordx4 v240, s[4:7], s41 offen  lds
    buffer_load_dwordx4 v241, s[8:11], s41 offen offset:1024  lds
WR_2_3:
    v_permlane32_swap_b32 v197, v255
    v_fmac_f32 v201, v42, v170
    v_fmac_f32 v201, v43, v171
    v_fmac_f32 v201, v44, v172
    v_fmac_f32 v201, v45, v173
    v_fmac_f32 v201, v46, v174
    v_fmac_f32 v201, v47, v175
    v_add_f32 v255, v197, v255
    v_cvt_pk_bf16_f32 v194, v254, v255
    v_mfma_f32_32x32x16_bf16 v[32:47], v[64:67], v[180:183], 0
    v_mul_f32 v254, v0, v144
    v_fmac_f32 v254, v1, v145
    v_fmac_f32 v254, v2, v146
    v_fmac_f32 v254, v3, v147
    v_fmac_f32 v254, v4, v148
    v_fmac_f32 v254, v5, v149
    v_fmac_f32 v254, v6, v150
    v_fmac_f32 v254, v7, v151
    v_fma_f32 v202, v8, -v160, v202
    v_fma_f32 v202, v9, -v161, v202
    v_permlane32_swap_b32 v254, v200
    v_fma_f32 v202, v10, -v162, v202
    v_fma_f32 v202, v11, -v163, v202
    v_fma_f32 v202, v12, -v164, v202
    v_fma_f32 v202, v13, -v165, v202
    v_fma_f32 v202, v14, -v166, v202
    v_fma_f32 v202, v15, -v167, v202
    v_add_f32 v200, v254, v200
    v_fmac_f32 v198, v16, v112
    v_permlane32_swap_b32 v202, v254
    v_mfma_f32_32x32x16_bf16 v[48:63], v[68:71], v[180:183], v[48:63]
    s_waitcnt vmcnt(6)
    ds_read_b64_tr_b16 v[176:177], v244 offset:0
    ds_read_b64_tr_b16 v[178:179], v244 offset:1024
    ds_read_b64_tr_b16 v[180:181], v245 offset:0
    ds_read_b64_tr_b16 v[182:183], v245 offset:1024
    v_add_u32 v249, s48, v249
    v_add_u32 v250, s49, v250
    ds_read_b32 v252, v251 offset:16
    ds_read_b64_tr_b16 v[64:65], v249 offset:0
    ds_read_b64_tr_b16 v[68:69], v249 offset:64
    ds_read_b64_tr_b16 v[66:67], v249 offset:256
    ds_read_b64_tr_b16 v[70:71], v249 offset:320
    s_mov_b64 exec, s[54:55]
    ds_read_u16_d16_hi v242, v250 offset:0
    s_mov_b64 exec, -1
    v_fmac_f32 v198, v17, v113
    v_fmac_f32 v198, v18, v114
    v_fmac_f32 v198, v19, v115
    v_fmac_f32 v198, v20, v116
    v_fmac_f32 v198, v21, v117
    v_fmac_f32 v198, v22, v118
    v_fmac_f32 v198, v23, v119
    v_add_f32 v254, v202, v254
    v_mul_f32 v196, v24, v160
    v_fmac_f32 v196, v25, v161
    v_fmac_f32 v196, v26, v162
    v_fmac_f32 v196, v27, v163
    v_fmac_f32 v196, v28, v164
    v_fmac_f32 v196, v29, v165
    v_fmac_f32 v196, v30, v166
    v_fmac_f32 v196, v31, v167
    s_nop 1
    v_permlane32_swap_b32 v198, v196
    v_add_f32 v196, v198, v196
    s_cmp_eq_u32 s50, 4
    s_cbranch_scc1 LEPI_2
    v_mul_f32 v255, v32, v152
    v_fmac_f32 v255, v33, v153
    v_fmac_f32 v255, v34, v154
    v_fmac_f32 v255, v35, v155
    v_fmac_f32 v255, v36, v156
    v_fmac_f32 v255, v37, v157
    v_fmac_f32 v255, v38, v158
    v_fmac_f32 v255, v39, v159
    v_fma_f32 v203, v40, -v168, v203
    v_fma_f32 v203, v41, -v169, v203
    v_permlane32_swap_b32 v255, v201
    v_fma_f32 v203, v42, -v170, v203
    v_fma_f32 v203, v43, -v171, v203
    v_fma_f32 v203, v44, -v172, v203
    v_fma_f32 v203, v45, -v173, v203
    v_fma_f32 v203, v46, -v174, v203
    v_fma_f32 v203, v47, -v175, v203
    v_add_f32 v201, v255, v201
    v_fmac_f32 v199, v48, v120
    v_permlane32_swap_b32 v203, v255
    v_fmac_f32 v199, v49, v121
    v_fmac_f32 v199, v50, v122
    v_fmac_f32 v199, v51, v123
    v_fmac_f32 v199, v52, v124
    v_fmac_f32 v199, v53, v125
    v_fmac_f32 v199, v54, v126
    v_fmac_f32 v199, v55, v127
    v_add_f32 v255, v203, v255
    v_mul_f32 v197, v56, v168
    v_fmac_f32 v197, v57, v169
    v_fmac_f32 v197, v58, v170
    v_fmac_f32 v197, v59, v171
    v_fmac_f32 v197, v60, v172
    v_fmac_f32 v197, v61, v173
    v_fmac_f32 v197, v62, v174
    v_fmac_f32 v197, v63, v175
    s_nop 1
    v_permlane32_swap_b32 v199, v197
    v_add_f32 v197, v199, v197
    v_cvt_pk_bf16_f32 v200, v200, v201
    v_cvt_pk_bf16_f32 v254, v254, v255
    v_cvt_pk_bf16_f32 v196, v196, v197
    ds_write2st64_b32 v253, v192, v193 offset0:0 offset1:1
    ds_write2st64_b32 v253, v194, v200 offset0:2 offset1:3
    ds_write_b32 v253, v196 offset:1024
    s_mov_b64 exec, 0xffffffff
    ds_write_b32 v253, v254 offset:1280
    s_mov_b64 exec, -1
    s_add_u32 s50, s50, 1
    s_cmp_ge_u32 s50, 4
    s_cbranch_scc1 LAST1
    s_waitcnt lgkmcnt(9)
    v_readfirstlane_b32 s66, v252
    s_add_u32 s53, s53, 1
    v_mov_b32 v252, s53
    s_cmp_le_u32 s53, s66
    ds_write2_b32 v251, v252, v252 offset0:0 offset1:8
    s_setprio 1
    s_cbranch_scc1 PRIO_16
    s_setprio 0
PRIO_16:
    s_cmp_eq_u32 s52, 4
    s_cbranch_scc1 ITEM_1_4
    s_cmp_eq_u32 s52, 5
    s_cbranch_scc1 ITEM_1_5
    s_cmp_eq_u32 s52, 3
    s_cbranch_scc1 ITEM_1_3
    s_cmp_eq_u32 s52, 6
    s_cbranch_scc1 ITEM_1_6
    s_cmp_eq_u32 s52, 8
    s_cbranch_scc1 ITEM_1_8
    s_branch ITEM_1_2
WL_2_0:
    s_add_u32 s66, s51, 0
    buffer_load_dword v195, v246, s[16:19], s66 offen
    buffer_load_dword v195, v246, s[16:19], s66 offen
    s_branch WR_2_0
WL_2_1:
    s_add_u32 s66, s51, 4096
    buffer_load_dword v195, v246, s[16:19], s66 offen
    buffer_load_dword v195, v246, s[16:19], s66 offen
    s_branch WR_2_1
WL_2_2:
    s_add_u32 s66, s51, 8192
    buffer_load_dword v195, v246, s[16:19], s66 offen
    buffer_load_dword v195, v246, s[16:19], s66 offen
    s_branch WR_2_2
WL_2_3:
    s_add_u32 s66, s51, 12288
    buffer_load_dword v195, v246, s[16:19], s66 offen
    buffer_load_dword v195, v246, s[16:19], s66 offen
    s_branch WR_2_3
.p2align 6
.p2align 6
LEPI_2:
    s_lshl_b32 s71, s20, 4
    s_add_u32 s67, s51, 4096
    s_add_u32 s68, s51, 8192
    s_add_u32 s69, s51, 12288
    s_add_u32 s70, s51, 16384
    s_waitcnt lgkmcnt(0)
    buffer_load_dwordx4 v[96:99], v246, s[16:19], s51 offen offset:2048 sc1
    s_mov_b32 s52, 163072
    v_bfe_u32 v177, v246, 4, 4
    v_bfe_u32 v179, v246, 4, 3
    v_lshl_add_u32 v180, v177, 3, s52
    v_lshl_add_u32 v190, v177, 4, s52
    v_lshl_add_u32 v181, v179, 3, s52
    ds_read2_b64 v[182:185], v180 offset0:32 offset1:48
    ds_read_b32 v191, v190
    ds_read_b64 v[186:187], v181 offset:512
    v_lshrrev_b32 v178, 8, v246
    buffer_load_dwordx4 v[100:103], v246, s[16:19], s51 offen offset:3072 sc1
    v_add_u32 v234, s21, v248
    v_add_u32 v235, 128, v234
    v_mul_f32 v255, v32, v152
    buffer_load_dwordx4 v[104:107], v246, s[16:19], s67 offen offset:2048 sc1
    v_fmac_f32 v255, v33, v153
    v_fmac_f32 v255, v34, v154
    ds_write2st64_b32 v234, v204, v205 offset0:0 offset1:1
    v_fmac_f32 v255, v35, v155
    buffer_load_dwordx4 v[108:111], v246, s[16:19], s67 offen offset:3072 sc1
    v_fmac_f32 v255, v36, v156
    v_fmac_f32 v255, v37, v157
    ds_write2st64_b32 v234, v206, v207 offset0:2 offset1:3
    v_fmac_f32 v255, v38, v158
    buffer_load_dwordx4 v[128:131], v246, s[16:19], s68 offen offset:2048 sc1
    v_fmac_f32 v255, v39, v159
    v_fma_f32 v203, v40, -v168, v203
    ds_write2st64_b32 v234, v208, v209 offset0:4 offset1:5
    v_fma_f32 v203, v41, -v169, v203
    buffer_load_dwordx4 v[132:135], v246, s[16:19], s68 offen offset:3072 sc1
    v_permlane32_swap_b32 v255, v201
    v_fma_f32 v203, v42, -v170, v203
    ds_write2st64_b32 v235, v210, v211 offset0:6 offset1:7
    v_fma_f32 v203, v43, -v171, v203
    v_fma_f32 v203, v44, -v172, v203
    buffer_load_dwordx4 v[136:139], v246, s[16:19], s69 offen offset:2048 sc1
    v_fma_f32 v203, v45, -v173, v203
    ds_write2st64_b32 v235, v212, v213 offset0:8 offset1:9
    v_fma_f32 v203, v46, -v174, v203
    v_fma_f32 v203, v47, -v175, v203
    buffer_load_dwordx4 v[140:143], v246, s[16:19], s69 offen offset:3072 sc1
    v_add_f32 v201, v255, v201
    ds_write2st64_b32 v235, v214, v215 offset0:10 offset1:11
    v_fmac_f32 v199, v48, v120
    v_permlane32_swap_b32 v203, v255
    buffer_load_dwordx4 v[112:115], v246, s[16:19], s70 offen offset:2048 sc1
    v_fmac_f32 v199, v49, v121
    ds_write2st64_b32 v234, v216, v217 offset0:12 offset1:13
    v_fmac_f32 v199, v50, v122
    v_fmac_f32 v199, v51, v123
    buffer_load_dwordx4 v[116:119], v246, s[16:19], s70 offen offset:3072 sc1
    v_fmac_f32 v199, v52, v124
    ds_write2st64_b32 v234, v218, v219 offset0:14 offset1:15
    v_fmac_f32 v199, v53, v125
    v_fmac_f32 v199, v54, v126
    buffer_load_dwordx4 v[144:147], v246, s[16:19], s51 offen offset:0 sc1
    v_fmac_f32 v199, v55, v127
    v_add_f32 v255, v203, v255
    ds_write2st64_b32 v234, v220, v221 offset0:16 offset1:17
    v_mul_f32 v197, v56, v168
    buffer_load_dwordx4 v[148:151], v246, s[16:19], s51 offen offset:1024 sc1
    v_fmac_f32 v197, v57, v169
    v_fmac_f32 v197, v58, v170
    ds_write2st64_b32 v235, v222, v223 offset0:18 offset1:19
    v_fmac_f32 v197, v59, v171
    buffer_load_dwordx4 v[160:163], v246, s[16:19], s67 offen offset:0 sc1
    v_fmac_f32 v197, v60, v172
    v_fmac_f32 v197, v61, v173
    ds_write2st64_b32 v235, v224, v225 offset0:20 offset1:21
    v_fmac_f32 v197, v62, v174
    buffer_load_dwordx4 v[164:167], v246, s[16:19], s67 offen offset:1024 sc1
    v_fmac_f32 v197, v63, v175
    s_nop 1
    ds_write2st64_b32 v235, v226, v227 offset0:22 offset1:23
    v_permlane32_swap_b32 v199, v197
    ds_write2st64_b32 v234, v228, v229 offset0:24 offset1:25
    v_add_f32 v197, v199, v197
    v_cvt_pk_bf16_f32 v200, v200, v201
    ds_write2st64_b32 v234, v230, v231 offset0:26 offset1:27
    v_cvt_pk_bf16_f32 v254, v254, v255
    v_cvt_pk_bf16_f32 v196, v196, v197
    ds_write2st64_b32 v234, v232, v233 offset0:28 offset1:29
    ds_write2st64_b32 v253, v192, v193 offset0:0 offset1:1
    ds_write2st64_b32 v253, v194, v200 offset0:2 offset1:3
    ds_write_b32 v253, v196 offset:1024
    s_mov_b64 exec, 0xffffffff
    ds_write_b32 v253, v254 offset:1280
    s_mov_b64 exec, -1
    s_add_u32 s50, s53, 1
    v_mov_b32 v234, s50
    ds_write2_b32 v251, v234, v234 offset0:0 offset1:8
    s_waitcnt lgkmcnt(15)
    s_branch TAIL
.p2align 6
LEPI_1:
    s_lshl_b32 s71, s20, 4
    s_add_u32 s67, s51, 4096
    s_add_u32 s68, s51, 8192
    s_add_u32 s69, s51, 12288
    s_add_u32 s70, s51, 16384
    s_waitcnt lgkmcnt(0)
    buffer_load_dwordx4 v[112:115], v246, s[16:19], s70 offen offset:2048 sc1
    s_mov_b32 s52, 163072
    v_bfe_u32 v177, v246, 4, 4
    v_bfe_u32 v179, v246, 4, 3
    v_lshl_add_u32 v180, v177, 3, s52
    v_lshl_add_u32 v190, v177, 4, s52
    v_lshl_add_u32 v181, v179, 3, s52
    ds_read2_b64 v[182:185], v180 offset0:32 offset1:48
    ds_read_b32 v191, v190
    ds_read_b64 v[186:187], v181 offset:512
    v_lshrrev_b32 v178, 8, v246
    buffer_load_dwordx4 v[116:119], v246, s[16:19], s70 offen offset:3072 sc1
    v_add_u32 v234, s21, v248
    v_add_u32 v235, 128, v234
    v_mul_f32 v255, v32, v152
    v_fmac_f32 v255, v33, v153
    buffer_load_dwordx4 v[144:147], v246, s[16:19], s51 offen offset:0 sc1
    v_fmac_f32 v255, v34, v154
    v_fmac_f32 v255, v35, v155
    ds_write2st64_b32 v234, v204, v205 offset0:0 offset1:1
    v_fmac_f32 v255, v36, v156
    v_fmac_f32 v255, v37, v157
    buffer_load_dwordx4 v[148:151], v246, s[16:19], s51 offen offset:1024 sc1
    v_fmac_f32 v255, v38, v158
    v_fmac_f32 v255, v39, v159
    ds_write2st64_b32 v234, v206, v207 offset0:2 offset1:3
    v_fma_f32 v203, v40, -v168, v203
    v_fma_f32 v203, v41, -v169, v203
    v_permlane32_swap_b32 v255, v201
    buffer_load_dwordx4 v[160:163], v246, s[16:19], s67 offen offset:0 sc1
    v_fma_f32 v203, v42, -v170, v203
    v_fma_f32 v203, v43, -v171, v203
    ds_write2st64_b32 v234, v208, v209 offset0:4 offset1:5
    v_fma_f32 v203, v44, -v172, v203
    v_fma_f32 v203, v45, -v173, v203
    buffer_load_dwordx4 v[164:167], v246, s[16:19], s67 offen offset:1024 sc1
    v_fma_f32 v203, v46, -v174, v203
    v_fma_f32 v203, v47, -v175, v203
    ds_write2st64_b32 v235, v210, v211 offset0:6 offset1:7
    v_add_f32 v201, v255, v201
    v_fmac_f32 v199, v48, v120
    ds_write2st64_b32 v235, v212, v213 offset0:8 offset1:9
    v_permlane32_swap_b32 v203, v255
    v_fmac_f32 v199, v49, v121
    v_fmac_f32 v199, v50, v122
    ds_write2st64_b32 v235, v214, v215 offset0:10 offset1:11
    v_fmac_f32 v199, v51, v123
    v_fmac_f32 v199, v52, v124
    ds_write2st64_b32 v234, v216, v217 offset0:12 offset1:13
    v_fmac_f32 v199, v53, v125
    v_fmac_f32 v199, v54, v126
    ds_write2st64_b32 v234, v218, v219 offset0:14 offset1:15
    v_fmac_f32 v199, v55, v127
    v_add_f32 v255, v203, v255
    ds_write2st64_b32 v234, v220, v221 offset0:16 offset1:17
    v_mul_f32 v197, v56, v168
    v_fmac_f32 v197, v57, v169
    ds_write2st64_b32 v235, v222, v223 offset0:18 offset1:19
    v_fmac_f32 v197, v58, v170
    v_fmac_f32 v197, v59, v171
    v_fmac_f32 v197, v60, v172
    ds_write2st64_b32 v235, v224, v225 offset0:20 offset1:21
    v_fmac_f32 v197, v61, v173
    v_fmac_f32 v197, v62, v174
    ds_write2st64_b32 v235, v226, v227 offset0:22 offset1:23
    v_fmac_f32 v197, v63, v175
    s_nop 1
    ds_write2st64_b32 v234, v228, v229 offset0:24 offset1:25
    v_permlane32_swap_b32 v199, v197
    v_add_f32 v197, v199, v197
    ds_write2st64_b32 v234, v230, v231 offset0:26 offset1:27
    v_cvt_pk_bf16_f32 v200, v200, v201
    v_cvt_pk_bf16_f32 v254, v254, v255
    v_cvt_pk_bf16_f32 v196, v196, v197
    ds_write2st64_b32 v234, v232, v233 offset0:28 offset1:29
    ds_write2st64_b32 v253, v200, v196 offset0:3 offset1:4
    s_mov_b64 exec, 0xffffffff
    ds_write_b32 v253, v254 offset:1280
    s_mov_b64 exec, -1
    s_add_u32 s50, s53, 1
    v_mov_b32 v234, s50
    ds_write2_b32 v251, v234, v234 offset0:0 offset1:8
    s_waitcnt lgkmcnt(15)
    s_branch TAIL
.p2align 6
LEPI_0:
    s_lshl_b32 s71, s20, 4
    s_add_u32 s67, s51, 4096
    s_add_u32 s68, s51, 8192
    s_add_u32 s69, s51, 12288
    s_add_u32 s70, s51, 16384
    s_waitcnt lgkmcnt(0)
    buffer_load_dwordx4 v[112:115], v246, s[16:19], s70 offen offset:2048 sc1
    s_mov_b32 s52, 163072
    v_bfe_u32 v177, v246, 4, 4
    v_bfe_u32 v179, v246, 4, 3
    v_lshl_add_u32 v180, v177, 3, s52
    v_lshl_add_u32 v190, v177, 4, s52
    v_lshl_add_u32 v181, v179, 3, s52
    ds_read2_b64 v[182:185], v180 offset0:32 offset1:48
    ds_read_b32 v191, v190
    ds_read_b64 v[186:187], v181 offset:512
    v_lshrrev_b32 v178, 8, v246
    buffer_load_dwordx4 v[116:119], v246, s[16:19], s70 offen offset:3072 sc1
    v_add_u32 v234, s21, v248
    v_add_u32 v235, 128, v234
    v_mul_f32 v255, v32, v152
    v_fmac_f32 v255, v33, v153
    buffer_load_dwordx4 v[144:147], v246, s[16:19], s51 offen offset:0 sc1
    v_fmac_f32 v255, v34, v154
    v_fmac_f32 v255, v35, v155
    ds_write2st64_b32 v234, v204, v205 offset0:0 offset1:1
    v_fmac_f32 v255, v36, v156
    v_fmac_f32 v255, v37, v157
    buffer_load_dwordx4 v[148:151], v246, s[16:19], s51 offen offset:1024 sc1
    v_fmac_f32 v255, v38, v158
    v_fmac_f32 v255, v39, v159
    ds_write2st64_b32 v234, v206, v207 offset0:2 offset1:3
    v_fma_f32 v203, v40, -v168, v203
    v_fma_f32 v203, v41, -v169, v203
    v_permlane32_swap_b32 v255, v201
    buffer_load_dwordx4 v[160:163], v246, s[16:19], s67 offen offset:0 sc1
    v_fma_f32 v203, v42, -v170, v203
    v_fma_f32 v203, v43, -v171, v203
    ds_write2st64_b32 v234, v208, v209 offset0:4 offset1:5
    v_fma_f32 v203, v44, -v172, v203
    v_fma_f32 v203, v45, -v173, v203
    buffer_load_dwordx4 v[164:167], v246, s[16:19], s67 offen offset:1024 sc1
    v_fma_f32 v203, v46, -v174, v203
    v_fma_f32 v203, v47, -v175, v203
    ds_write2st64_b32 v235, v210, v211 offset0:6 offset1:7
    v_add_f32 v201, v255, v201
    v_fmac_f32 v199, v48, v120
    ds_write2st64_b32 v235, v212, v213 offset0:8 offset1:9
    v_permlane32_swap_b32 v203, v255
    v_fmac_f32 v199, v49, v121
    v_fmac_f32 v199, v50, v122
    ds_write2st64_b32 v235, v214, v215 offset0:10 offset1:11
    v_fmac_f32 v199, v51, v123
    v_fmac_f32 v199, v52, v124
    ds_write2st64_b32 v234, v216, v217 offset0:12 offset1:13
    v_fmac_f32 v199, v53, v125
    v_fmac_f32 v199, v54, v126
    ds_write2st64_b32 v234, v218, v219 offset0:14 offset1:15
    v_fmac_f32 v199, v55, v127
    v_add_f32 v255, v203, v255
    ds_write2st64_b32 v234, v220, v221 offset0:16 offset1:17
    v_mul_f32 v197, v56, v168
    v_fmac_f32 v197, v57, v169
    ds_write2st64_b32 v235, v222, v223 offset0:18 offset1:19
    v_fmac_f32 v197, v58, v170
    v_fmac_f32 v197, v59, v171
    v_fmac_f32 v197, v60, v172
    ds_write2st64_b32 v235, v224, v225 offset0:20 offset1:21
    v_fmac_f32 v197, v61, v173
    v_fmac_f32 v197, v62, v174
    ds_write2st64_b32 v235, v226, v227 offset0:22 offset1:23
    v_fmac_f32 v197, v63, v175
    s_nop 1
    ds_write2st64_b32 v234, v228, v229 offset0:24 offset1:25
    v_permlane32_swap_b32 v199, v197
    v_add_f32 v197, v199, v197
    ds_write2st64_b32 v234, v230, v231 offset0:26 offset1:27
    v_cvt_pk_bf16_f32 v200, v200, v201
    v_cvt_pk_bf16_f32 v254, v254, v255
    v_cvt_pk_bf16_f32 v196, v196, v197
    ds_write2st64_b32 v234, v232, v233 offset0:28 offset1:29
    ds_write2st64_b32 v253, v192, v193 offset0:0 offset1:1
    ds_write2st64_b32 v253, v194, v200 offset0:2 offset1:3
    ds_write_b32 v253, v196 offset:1024
    s_mov_b64 exec, 0xffffffff
    ds_write_b32 v253, v254 offset:1280
    s_mov_b64 exec, -1
    s_add_u32 s50, s53, 1
    v_mov_b32 v234, s50
    ds_write2_b32 v251, v234, v234 offset0:0 offset1:8
    s_waitcnt lgkmcnt(15)
TAIL:
    s_and_b32 s71, s20, 3
    s_lshl_b32 s71, s71, 2
    s_bitcmp0_b32 s20, 2
    s_addc_u32 s71, s71, 0
    v_readlane_b32 s71, v191, s71
    buffer_load_dwordx4 v[120:123], v246, s[16:19], s68 offen offset:0 sc1
    buffer_load_dwordx4 v[124:127], v246, s[16:19], s68 offen offset:1024 sc1
    s_cmp_ge_u32 s71, s50
    s_setprio 1
    s_cbranch_scc1 T_second
    s_setprio 0
T_second:
    buffer_load_dwordx4 v[152:155], v246, s[16:19], s69 offen offset:0 sc1
    buffer_load_dwordx4 v[156:159], v246, s[16:19], s69 offen offset:1024 sc1
    buffer_load_dwordx4 v[168:171], v246, s[16:19], s70 offen offset:0 sc1
    buffer_load_dwordx4 v[172:175], v246, s[16:19], s70 offen offset:1024 sc1
GEMM:
    v_cmp_gt_u32 vcc, s53, v191
    v_xor_b32 v180, v179, v178
    v_xor_b32 v188, 4, v180
    v_lshl_add_u32 v66, v180, 4, v183
    v_lshl_add_u32 v67, v188, 4, v183
    v_lshl_add_u32 v70, v180, 4, v185
    v_lshl_add_u32 v71, v188, 4, v185
    s_mov_b32 s4, s72
    s_and_b32 s5, s73, 0xffff
    s_mov_b32 s6, 10240000
    s_mov_b32 s7, 0x20000
    s_cbranch_vccnz T_pw
T_pwr:
    ds_read_b128 v[76:79], v66 offset:0
    ds_read_b128 v[80:83], v70 offset:0
    ds_read_b128 v[84:87], v67 offset:0
    ds_read_b128 v[88:91], v71 offset:0
    ds_read_b128 v[92:95], v66 offset:1024
    s_waitcnt vmcnt(19) lgkmcnt(4)
    v_mfma_f32_16x16x32_bf16 v[0:3], v[96:99], v[76:79], 0
    v_and_b32 v181, 8, v177
    v_add_u32 v189, v188, v181
    ds_read_b128 v[76:79], v70 offset:1024
    s_waitcnt lgkmcnt(4)
    v_mfma_f32_16x16x32_bf16 v[4:7], v[96:99], v[80:83], 0
    v_add_u32 v181, v180, v181
    v_lshl_add_u32 v64, v180, 4, v182
    ds_read_b128 v[80:83], v67 offset:1024
    s_waitcnt vmcnt(18) lgkmcnt(4)
    v_mfma_f32_16x16x32_bf16 v[0:3], v[100:103], v[84:87], v[0:3]
    v_lshl_add_u32 v65, v188, 4, v182
    v_lshl_add_u32 v68, v180, 4, v184
    ds_read_b128 v[84:87], v71 offset:1024
    s_waitcnt lgkmcnt(4)
    v_mfma_f32_16x16x32_bf16 v[4:7], v[100:103], v[88:91], v[4:7]
    v_lshl_add_u32 v69, v188, 4, v184
    v_lshl_add_u32 v72, v181, 4, v186
    ds_read_b128 v[88:91], v66 offset:128
    s_waitcnt vmcnt(17) lgkmcnt(4)
    v_mfma_f32_16x16x32_bf16 v[0:3], v[104:107], v[92:95], v[0:3]
    v_lshl_add_u32 v73, v189, 4, v186
    v_lshl_add_u32 v74, v181, 4, v187
    ds_read_b128 v[92:95], v66 offset:256
    s_waitcnt lgkmcnt(4)
    v_mfma_f32_16x16x32_bf16 v[4:7], v[104:107], v[76:79], v[4:7]
    v_lshl_add_u32 v75, v189, 4, v187
    s_mov_b32 s67, 0xbfb8aa3b
    ds_read_b128 v[76:79], v66 offset:384
    s_waitcnt vmcnt(16) lgkmcnt(4)
    v_mfma_f32_16x16x32_bf16 v[0:3], v[108:111], v[80:83], v[0:3]
    v_lshrrev_b32 v205, 1, v178
    v_lshl_add_u32 v205, s20, 1, v205
    ds_read_b128 v[80:83], v70 offset:128
    s_waitcnt lgkmcnt(4)
    v_mfma_f32_16x16x32_bf16 v[4:7], v[108:111], v[84:87], v[4:7]
    v_xor_b32 v205, v205, v179
    v_and_b32 v204, 1, v178
    ds_read_b128 v[84:87], v70 offset:256
    s_waitcnt vmcnt(15) lgkmcnt(4)
    v_mfma_f32_16x16x32_bf16 v[12:15], v[128:131], v[88:91], 0
    v_lshlrev_b32 v204, 3, v204
    v_lshl_add_u32 v205, v205, 4, v204
    ds_read_b128 v[88:91], v70 offset:384
    s_waitcnt lgkmcnt(4)
    v_mfma_f32_16x16x32_bf16 v[24:27], v[128:131], v[92:95], 0
    v_and_b32 v220, 8, v177
    v_lshl_add_u32 v204, v220, 4, v205
    ds_read_b128 v[92:95], v67 offset:128
    s_waitcnt lgkmcnt(4)
    v_mfma_f32_16x16x32_bf16 v[36:39], v[128:131], v[76:79], 0
    v_lshl_add_u32 v204, v177, 10, v204
    v_add_u32 v204, 65536, v204
    ds_read_b128 v[76:79], v67 offset:256
    s_waitcnt lgkmcnt(4)
    v_mfma_f32_16x16x32_bf16 v[16:19], v[128:131], v[80:83], 0
    v_add_u32 v205, v205, v182
    v_mul_u32_u24 v220, 1008, v220
    ds_read_b128 v[80:83], v67 offset:384
    s_waitcnt lgkmcnt(4)
    v_mfma_f32_16x16x32_bf16 v[28:31], v[128:131], v[84:87], 0
    v_sub_u32 v220, v204, v220
    s_lshl_b32 s70, s20, 4
    ds_read_b128 v[84:87], v71 offset:128
    s_waitcnt lgkmcnt(4)
    v_mfma_f32_16x16x32_bf16 v[40:43], v[128:131], v[88:91], 0
    v_xor_b32 v206, s70, v246
    s_lshl_b32 s70, s20, 10
    ds_read_b128 v[88:91], v71 offset:256
    s_waitcnt vmcnt(14) lgkmcnt(4)
    v_mfma_f32_16x16x32_bf16 v[12:15], v[132:135], v[92:95], v[12:15]
    s_add_u32 s70, s70, 65536
    v_add_u32 v207, s21, v206
    ds_read_b128 v[92:95], v71 offset:384
    s_waitcnt lgkmcnt(4)
    v_mfma_f32_16x16x32_bf16 v[24:27], v[132:135], v[76:79], v[24:27]
    v_add_u32 v206, s70, v206
    s_mul_i32 s66, s2, 40960
    ds_read_b128 v[76:79], v66 offset:512
    s_waitcnt lgkmcnt(4)
    v_mfma_f32_16x16x32_bf16 v[36:39], v[132:135], v[80:83], v[36:39]
    s_bfe_u32 s22, s22, 393237
    s_lshl_b32 s22, s22, 10
    ds_read_b128 v[80:83], v66 offset:640
    s_waitcnt lgkmcnt(4)
    v_mfma_f32_16x16x32_bf16 v[16:19], v[132:135], v[84:87], v[16:19]
    s_add_u32 s22, s22, s66
    s_bfe_u32 s23, s23, 393237
    ds_read_b128 v[84:87], v66 offset:768
    s_waitcnt lgkmcnt(4)
    v_mfma_f32_16x16x32_bf16 v[28:31], v[132:135], v[88:91], v[28:31]
    s_lshl_b32 s23, s23, 10
    s_add_u32 s23, s23, s66
    ds_read_b128 v[88:91], v70 offset:512
    s_waitcnt lgkmcnt(4)
    v_mfma_f32_16x16x32_bf16 v[40:43], v[132:135], v[92:95], v[40:43]
    s_bfe_u32 s24, s24, 393237
    s_lshl_b32 s24, s24, 10
    ds_read_b128 v[92:95], v70 offset:640
    s_waitcnt vmcnt(13) lgkmcnt(4)
    v_mfma_f32_16x16x32_bf16 v[12:15], v[136:139], v[76:79], v[12:15]
    s_add_u32 s24, s24, s66
    s_bfe_u32 s25, s25, 393237
    ds_read_b128 v[76:79], v70 offset:768
    s_waitcnt lgkmcnt(4)
    v_mfma_f32_16x16x32_bf16 v[24:27], v[136:139], v[80:83], v[24:27]
    s_lshl_b32 s25, s25, 10
    s_add_u32 s25, s25, s66
    ds_read_b128 v[80:83], v67 offset:512
    s_waitcnt lgkmcnt(4)
    v_mfma_f32_16x16x32_bf16 v[36:39], v[136:139], v[84:87], v[36:39]
    s_bfe_u32 s26, s26, 393237
    s_lshl_b32 s26, s26, 10
    ds_read_b128 v[84:87], v67 offset:640
    s_waitcnt lgkmcnt(4)
    v_mfma_f32_16x16x32_bf16 v[16:19], v[136:139], v[88:91], v[16:19]
    s_add_u32 s26, s26, s66
    ds_read_b128 v[88:91], v67 offset:768
    s_waitcnt lgkmcnt(4)
    v_mfma_f32_16x16x32_bf16 v[28:31], v[136:139], v[92:95], v[28:31]
    ds_read_b128 v[92:95], v71 offset:512
    s_waitcnt lgkmcnt(4)
    v_mfma_f32_16x16x32_bf16 v[40:43], v[136:139], v[76:79], v[40:43]
    ds_read_b128 v[76:79], v71 offset:640
    s_waitcnt vmcnt(12) lgkmcnt(4)
    v_mfma_f32_16x16x32_bf16 v[12:15], v[140:143], v[80:83], v[12:15]
    ds_read_b128 v[80:83], v71 offset:768
    s_waitcnt lgkmcnt(4)
    v_mfma_f32_16x16x32_bf16 v[24:27], v[140:143], v[84:87], v[24:27]
    ds_read_b128 v[84:87], v66 offset:1152
    s_waitcnt lgkmcnt(4)
    v_mfma_f32_16x16x32_bf16 v[36:39], v[140:143], v[88:91], v[36:39]
    ds_read_b128 v[88:91], v66 offset:1280
    s_waitcnt lgkmcnt(4)
    v_mfma_f32_16x16x32_bf16 v[16:19], v[140:143], v[92:95], v[16:19]
    ds_read_b128 v[92:95], v66 offset:896
    s_waitcnt lgkmcnt(4)
    v_mfma_f32_16x16x32_bf16 v[28:31], v[140:143], v[76:79], v[28:31]
    ds_read_b128 v[76:79], v70 offset:1152
    s_waitcnt lgkmcnt(4)
    v_mfma_f32_16x16x32_bf16 v[40:43], v[140:143], v[80:83], v[40:43]
    ds_read_b128 v[80:83], v70 offset:1280
    s_waitcnt vmcnt(11) lgkmcnt(4)
    v_mfma_f32_16x16x32_bf16 v[12:15], v[112:115], v[84:87], v[12:15]
    ds_read_b128 v[84:87], v70 offset:896
    s_waitcnt lgkmcnt(4)
    v_mfma_f32_16x16x32_bf16 v[24:27], v[112:115], v[88:91], v[24:27]
    ds_read_b128 v[88:91], v67 offset:1152
    s_waitcnt lgkmcnt(4)
    v_mfma_f32_16x16x32_bf16 v[36:39], v[112:115], v[92:95], v[36:39]
    ds_read_b128 v[92:95], v67 offset:1280
    s_waitcnt lgkmcnt(4)
    v_mfma_f32_16x16x32_bf16 v[16:19], v[112:115], v[76:79], v[16:19]
    ds_read_b128 v[76:79], v67 offset:896
    s_waitcnt lgkmcnt(4)
    v_mfma_f32_16x16x32_bf16 v[28:31], v[112:115], v[80:83], v[28:31]
    ds_read_b32 v191, v190
    ds_read_b128 v[80:83], v71 offset:1152
    s_waitcnt lgkmcnt(5)
    v_mfma_f32_16x16x32_bf16 v[40:43], v[112:115], v[84:87], v[40:43]
    ds_read_b128 v[84:87], v71 offset:1280
    s_waitcnt vmcnt(10) lgkmcnt(5)
    v_mfma_f32_16x16x32_bf16 v[12:15], v[116:119], v[88:91], v[12:15]
    ds_read_b128 v[88:91], v71 offset:896
    s_waitcnt lgkmcnt(5)
    v_mfma_f32_16x16x32_bf16 v[24:27], v[116:119], v[92:95], v[24:27]
    s_waitcnt lgkmcnt(3)
    v_cmp_gt_u32 vcc, s50, v191
    s_cbranch_vccnz T_aw
T_awr:
    ds_read_b128 v[92:95], v64 offset:0
    v_mfma_f32_16x16x32_bf16 v[36:39], v[116:119], v[76:79], v[36:39]
    ds_read_b128 v[76:79], v68 offset:0
    s_waitcnt lgkmcnt(4)
    v_mfma_f32_16x16x32_bf16 v[16:19], v[116:119], v[80:83], v[16:19]
    ds_read_b128 v[80:83], v65 offset:0
    s_waitcnt lgkmcnt(4)
    v_mfma_f32_16x16x32_bf16 v[28:31], v[116:119], v[84:87], v[28:31]
    ds_read_b128 v[84:87], v69 offset:0
    s_waitcnt lgkmcnt(4)
    v_mfma_f32_16x16x32_bf16 v[40:43], v[116:119], v[88:91], v[40:43]
    ds_read_b128 v[88:91], v64 offset:1024
    s_waitcnt vmcnt(9) lgkmcnt(4)
    v_mfma_f32_16x16x32_bf16 v[0:3], v[144:147], v[92:95], v[0:3]
    ds_read_b128 v[92:95], v68 offset:1024
    s_waitcnt lgkmcnt(4)
    v_mfma_f32_16x16x32_bf16 v[4:7], v[144:147], v[76:79], v[4:7]
    ds_read_b128 v[76:79], v65 offset:1024
    s_waitcnt vmcnt(8) lgkmcnt(4)
    v_mfma_f32_16x16x32_bf16 v[0:3], v[148:151], v[80:83], v[0:3]
    ds_read_b128 v[80:83], v69 offset:1024
    s_waitcnt lgkmcnt(4)
    v_mfma_f32_16x16x32_bf16 v[4:7], v[148:151], v[84:87], v[4:7]
    ds_read_b128 v[84:87], v72 offset:0
    s_waitcnt vmcnt(7) lgkmcnt(4)
    v_mfma_f32_16x16x32_bf16 v[0:3], v[160:163], v[88:91], v[0:3]
    ds_read_b128 v[88:91], v73 offset:0
    s_waitcnt lgkmcnt(4)
    v_mfma_f32_16x16x32_bf16 v[4:7], v[160:163], v[92:95], v[4:7]
    ds_read_b128 v[92:95], v74 offset:0
    s_waitcnt vmcnt(6) lgkmcnt(4)
    v_mfma_f32_16x16x32_bf16 v[0:3], v[164:167], v[76:79], v[0:3]
    ds_read_b128 v[76:79], v75 offset:0
    s_waitcnt lgkmcnt(4)
    v_mfma_f32_16x16x32_bf16 v[4:7], v[164:167], v[80:83], v[4:7]
    ds_read_b128 v[80:83], v72 offset:1024
    s_waitcnt lgkmcnt(4)
    v_mfma_f32_16x16x32_bf16 v[8:11], v[144:147], v[84:87], 0
    ds_read_b128 v[84:87], v73 offset:1024
    s_waitcnt lgkmcnt(4)
    v_mfma_f32_16x16x32_bf16 v[8:11], v[148:151], v[88:91], v[8:11]
    v_mul_f32 v192, s67, v0
    v_mul_f32 v193, s67, v1
    ds_read_b128 v[88:91], v74 offset:1024
    s_waitcnt lgkmcnt(4)
    v_mfma_f32_16x16x32_bf16 v[8:11], v[96:99], v[92:95], v[8:11]
    v_mul_f32 v194, s67, v2
    v_mul_f32 v195, s67, v3
    ds_read_b128 v[92:95], v75 offset:1024
    s_waitcnt lgkmcnt(4)
    v_mfma_f32_16x16x32_bf16 v[8:11], v[100:103], v[76:79], v[8:11]
    v_exp_f32 v192, v192
    v_exp_f32 v193, v193
    ds_read_b128 v[76:79], v64 offset:128
    s_waitcnt lgkmcnt(4)
    v_mfma_f32_16x16x32_bf16 v[8:11], v[160:163], v[80:83], v[8:11]
    v_exp_f32 v194, v194
    v_exp_f32 v195, v195
    ds_read_b128 v[80:83], v65 offset:128
    s_waitcnt lgkmcnt(4)
    v_mfma_f32_16x16x32_bf16 v[8:11], v[164:167], v[84:87], v[8:11]
    v_add_f32 v192, 1.0, v192
    v_add_f32 v193, 1.0, v193
    ds_read_b128 v[84:87], v64 offset:512
    s_waitcnt lgkmcnt(4)
    v_mfma_f32_16x16x32_bf16 v[8:11], v[104:107], v[88:91], v[8:11]
    v_add_f32 v194, 1.0, v194
    v_add_f32 v195, 1.0, v195
    ds_read_b128 v[88:91], v65 offset:512
    s_waitcnt lgkmcnt(4)
    v_mfma_f32_16x16x32_bf16 v[8:11], v[108:111], v[92:95], v[8:11]
    v_rcp_f32 v192, v192
    v_rcp_f32 v193, v193
    ds_read_b128 v[92:95], v64 offset:1152
    s_waitcnt vmcnt(5) lgkmcnt(4)
    v_mfma_f32_16x16x32_bf16 v[12:15], v[120:123], v[76:79], v[12:15]
    v_rcp_f32 v194, v194
    v_rcp_f32 v195, v195
    ds_read_b128 v[76:79], v65 offset:1152
    s_waitcnt vmcnt(4) lgkmcnt(4)
    v_mfma_f32_16x16x32_bf16 v[12:15], v[124:127], v[80:83], v[12:15]
    v_cvt_pk_bf16_f32 v0, v0, v1
    v_cvt_pk_bf16_f32 v1, v2, v3
    ds_read_b128 v[80:83], v64 offset:256
    s_waitcnt vmcnt(3) lgkmcnt(4)
    v_mfma_f32_16x16x32_bf16 v[12:15], v[152:155], v[84:87], v[12:15]
    ds_write_b64 v204, v[0:1] offset:0
    v_mul_f32 v196, s67, v4
    ds_read_b128 v[84:87], v65 offset:256
    s_waitcnt vmcnt(2) lgkmcnt(5)
    v_mfma_f32_16x16x32_bf16 v[12:15], v[156:159], v[88:91], v[12:15]
    v_mul_f32 v197, s67, v5
    v_mul_f32 v198, s67, v6
    ds_read_b128 v[88:91], v64 offset:640
    s_waitcnt vmcnt(1) lgkmcnt(5)
    v_mfma_f32_16x16x32_bf16 v[12:15], v[168:171], v[92:95], v[12:15]
    v_mul_f32 v199, s67, v7
    v_exp_f32 v196, v196
    ds_read_b128 v[92:95], v65 offset:640
    s_waitcnt vmcnt(0) lgkmcnt(5)
    v_mfma_f32_16x16x32_bf16 v[12:15], v[172:175], v[76:79], v[12:15]
    v_exp_f32 v197, v197
    v_exp_f32 v198, v198
    ds_read_b128 v[76:79], v64 offset:1280
    s_waitcnt lgkmcnt(5)
    v_mfma_f32_16x16x32_bf16 v[24:27], v[120:123], v[80:83], v[24:27]
    v_exp_f32 v199, v199
    v_add_f32 v196, 1.0, v196
    ds_read_b128 v[80:83], v65 offset:1280
    s_waitcnt lgkmcnt(4)
    v_mfma_f32_16x16x32_bf16 v[24:27], v[124:127], v[84:87], v[24:27]
    v_mul_f32 v12, v12, v192
    v_mul_f32 v13, v13, v193
    ds_read_b128 v[84:87], v64 offset:384
    s_waitcnt lgkmcnt(4)
    v_mfma_f32_16x16x32_bf16 v[24:27], v[152:155], v[88:91], v[24:27]
    v_mul_f32 v14, v14, v194
    v_mul_f32 v15, v15, v195
    ds_read_b128 v[88:91], v65 offset:384
    s_waitcnt lgkmcnt(4)
    v_mfma_f32_16x16x32_bf16 v[24:27], v[156:159], v[92:95], v[24:27]
    v_cvt_pk_bf16_f32 v12, v12, v13
    v_cvt_pk_bf16_f32 v13, v14, v15
    ds_read_b128 v[92:95], v64 offset:768
    s_waitcnt lgkmcnt(4)
    v_mfma_f32_16x16x32_bf16 v[24:27], v[168:171], v[76:79], v[24:27]
    ds_write_b64 v204, v[12:13] offset:256
    v_add_f32 v197, 1.0, v197
    ds_read_b128 v[76:79], v65 offset:768
    s_waitcnt lgkmcnt(5)
    v_mfma_f32_16x16x32_bf16 v[24:27], v[172:175], v[80:83], v[24:27]
    v_add_f32 v198, 1.0, v198
    v_add_f32 v199, 1.0, v199
    ds_read_b128 v[80:83], v64 offset:896
    s_waitcnt lgkmcnt(5)
    v_mfma_f32_16x16x32_bf16 v[36:39], v[120:123], v[84:87], v[36:39]
    v_rcp_f32 v196, v196
    v_rcp_f32 v197, v197
    ds_read_b128 v[84:87], v65 offset:896
    s_waitcnt lgkmcnt(5)
    v_mfma_f32_16x16x32_bf16 v[36:39], v[124:127], v[88:91], v[36:39]
    v_rcp_f32 v198, v198
    v_rcp_f32 v199, v199
    ds_read_b128 v[88:91], v68 offset:128
    s_waitcnt lgkmcnt(5)
    v_mfma_f32_16x16x32_bf16 v[36:39], v[152:155], v[92:95], v[36:39]
    v_mul_f32 v24, v24, v192
    v_mul_f32 v25, v25, v193
    ds_read_b128 v[92:95], v69 offset:128
    s_waitcnt lgkmcnt(4)
    v_mfma_f32_16x16x32_bf16 v[36:39], v[156:159], v[76:79], v[36:39]
    v_mul_f32 v26, v26, v194
    v_mul_f32 v27, v27, v195
    ds_read_b128 v[76:79], v68 offset:512
    s_waitcnt lgkmcnt(4)
    v_mfma_f32_16x16x32_bf16 v[36:39], v[168:171], v[80:83], v[36:39]
    v_cvt_pk_bf16_f32 v24, v24, v25
    v_cvt_pk_bf16_f32 v25, v26, v27
    ds_read_b128 v[80:83], v69 offset:512
    s_waitcnt lgkmcnt(4)
    v_mfma_f32_16x16x32_bf16 v[36:39], v[172:175], v[84:87], v[36:39]
    ds_write_b64 v204, v[24:25] offset:512
    v_mul_f32 v200, s67, v8
    ds_read_b128 v[84:87], v68 offset:1152
    s_waitcnt lgkmcnt(5)
    v_mfma_f32_16x16x32_bf16 v[16:19], v[120:123], v[88:91], v[16:19]
    v_mul_f32 v201, s67, v9
    v_mul_f32 v202, s67, v10
    ds_read_b128 v[88:91], v69 offset:1152
    s_waitcnt lgkmcnt(5)
    v_mfma_f32_16x16x32_bf16 v[16:19], v[124:127], v[92:95], v[16:19]
    v_mul_f32 v203, s67, v11
    v_exp_f32 v200, v200
    ds_read_b128 v[92:95], v68 offset:256
    s_waitcnt lgkmcnt(5)
    v_mfma_f32_16x16x32_bf16 v[16:19], v[152:155], v[76:79], v[16:19]
    v_mul_f32 v36, v36, v192
    v_mul_f32 v37, v37, v193
    ds_read_b128 v[76:79], v69 offset:256
    s_waitcnt lgkmcnt(5)
    v_mfma_f32_16x16x32_bf16 v[16:19], v[156:159], v[80:83], v[16:19]
    v_mul_f32 v38, v38, v194
    v_mul_f32 v39, v39, v195
    ds_read_b128 v[80:83], v68 offset:640
    s_waitcnt lgkmcnt(4)
    v_mfma_f32_16x16x32_bf16 v[16:19], v[168:171], v[84:87], v[16:19]
    v_cvt_pk_bf16_f32 v36, v36, v37
    v_cvt_pk_bf16_f32 v37, v38, v39
    ds_read_b128 v[84:87], v69 offset:640
    s_waitcnt lgkmcnt(4)
    v_mfma_f32_16x16x32_bf16 v[16:19], v[172:175], v[88:91], v[16:19]
    ds_write_b64 v204, v[36:37] offset:768
    v_exp_f32 v201, v201
    ds_read_b128 v[88:91], v68 offset:1280
    s_waitcnt lgkmcnt(5)
    v_mfma_f32_16x16x32_bf16 v[28:31], v[120:123], v[92:95], v[28:31]
    v_exp_f32 v202, v202
    v_exp_f32 v203, v203
    ds_read_b128 v[92:95], v69 offset:1280
    s_waitcnt lgkmcnt(5)
    v_mfma_f32_16x16x32_bf16 v[28:31], v[124:127], v[76:79], v[28:31]
    v_add_f32 v200, 1.0, v200
    v_add_f32 v201, 1.0, v201
    ds_read_b128 v[76:79], v68 offset:384
    s_waitcnt lgkmcnt(5)
    v_mfma_f32_16x16x32_bf16 v[28:31], v[152:155], v[80:83], v[28:31]
    v_add_f32 v202, 1.0, v202
    v_add_f32 v203, 1.0, v203
    ds_read_b128 v[80:83], v69 offset:384
    s_waitcnt lgkmcnt(5)
    v_mfma_f32_16x16x32_bf16 v[28:31], v[156:159], v[84:87], v[28:31]
    v_rcp_f32 v200, v200
    v_rcp_f32 v201, v201
    ds_read_b128 v[84:87], v68 offset:768
    s_waitcnt lgkmcnt(4)
    v_mfma_f32_16x16x32_bf16 v[28:31], v[168:171], v[88:91], v[28:31]
    v_rcp_f32 v202, v202
    v_rcp_f32 v203, v203
    ds_read_b128 v[88:91], v69 offset:768
    s_waitcnt lgkmcnt(4)
    v_mfma_f32_16x16x32_bf16 v[28:31], v[172:175], v[92:95], v[28:31]
    v_mov_b32_dpp v200, v200 row_ror:8 row_mask:0xf bank_mask:0xc
    ds_read_b128 v[92:95], v68 offset:896
    s_waitcnt lgkmcnt(4)
    v_mfma_f32_16x16x32_bf16 v[40:43], v[120:123], v[76:79], v[40:43]
    v_mov_b32_dpp v201, v201 row_ror:8 row_mask:0xf bank_mask:0xc
    v_mov_b32_dpp v202, v202 row_ror:8 row_mask:0xf bank_mask:0xc
    ds_read_b128 v[76:79], v69 offset:896
    s_waitcnt lgkmcnt(4)
    v_mfma_f32_16x16x32_bf16 v[40:43], v[124:127], v[80:83], v[40:43]
    v_mov_b32_dpp v203, v203 row_ror:8 row_mask:0xf bank_mask:0xc
    ds_read_b128 v[80:83], v72 offset:128
    s_waitcnt lgkmcnt(4)
    v_mfma_f32_16x16x32_bf16 v[40:43], v[152:155], v[84:87], v[40:43]
    s_barrier
    ds_read_b128 v[212:215], v206 offset:0
    ds_read_b128 v[84:87], v73 offset:128
    s_waitcnt lgkmcnt(5)
    v_mfma_f32_16x16x32_bf16 v[40:43], v[156:159], v[88:91], v[40:43]
    ds_read_b128 v[216:219], v206 offset:8320
    v_cvt_pk_bf16_f32 v4, v4, v5
    ds_read_b128 v[88:91], v74 offset:128
    s_waitcnt lgkmcnt(6)
    v_mfma_f32_16x16x32_bf16 v[40:43], v[168:171], v[92:95], v[40:43]
    v_cvt_pk_bf16_f32 v5, v6, v7
    ds_write_b64 v205, v[4:5] offset:0
    ds_read_b128 v[92:95], v75 offset:128
    s_waitcnt lgkmcnt(7)
    v_mfma_f32_16x16x32_bf16 v[40:43], v[172:175], v[76:79], v[40:43]
    v_mul_f32 v16, v16, v196
    v_mul_f32 v17, v17, v197
    ds_read_b128 v[76:79], v72 offset:512
    s_waitcnt lgkmcnt(7)
    v_mfma_f32_16x16x32_bf16 v[20:23], v[120:123], v[80:83], 0
    v_mul_f32 v18, v18, v198
    v_mul_f32 v19, v19, v199
    ds_read_b128 v[80:83], v73 offset:512
    s_waitcnt lgkmcnt(6)
    v_mfma_f32_16x16x32_bf16 v[20:23], v[124:127], v[84:87], v[20:23]
    v_cvt_pk_bf16_f32 v16, v16, v17
    v_cvt_pk_bf16_f32 v17, v18, v19
    ds_read_b128 v[84:87], v74 offset:512
    s_waitcnt lgkmcnt(5)
    v_mfma_f32_16x16x32_bf16 v[20:23], v[128:131], v[88:91], v[20:23]
    ds_write_b64 v205, v[16:17] offset:256
    ds_read_b128 v[88:91], v75 offset:512
    s_waitcnt lgkmcnt(5)
    v_mfma_f32_16x16x32_bf16 v[20:23], v[132:135], v[92:95], v[20:23]
    buffer_store_dwordx4 v[212:215], v246, s[4:7], s22 offen sc1
    ds_read_b128 v[92:95], v72 offset:1152
    s_waitcnt lgkmcnt(5)
    v_mfma_f32_16x16x32_bf16 v[20:23], v[152:155], v[76:79], v[20:23]
    buffer_store_dwordx4 v[216:219], v246, s[4:7], s23 offen sc1
    v_mul_f32 v28, v28, v196
    ds_read_b128 v[76:79], v73 offset:1152
    s_waitcnt lgkmcnt(5)
    v_mfma_f32_16x16x32_bf16 v[20:23], v[156:159], v[80:83], v[20:23]
    v_mul_f32 v29, v29, v197
    v_mul_f32 v30, v30, v198
    ds_read_b128 v[80:83], v74 offset:1152
    s_waitcnt lgkmcnt(5)
    v_mfma_f32_16x16x32_bf16 v[20:23], v[136:139], v[84:87], v[20:23]
    v_mul_f32 v31, v31, v199
    v_cvt_pk_bf16_f32 v28, v28, v29
    ds_read_b128 v[84:87], v75 offset:1152
    s_waitcnt lgkmcnt(4)
    v_mfma_f32_16x16x32_bf16 v[20:23], v[140:143], v[88:91], v[20:23]
    v_cvt_pk_bf16_f32 v29, v30, v31
    ds_write_b64 v205, v[28:29] offset:512
    ds_read_b128 v[88:91], v72 offset:384
    s_waitcnt lgkmcnt(5)
    v_mfma_f32_16x16x32_bf16 v[20:23], v[168:171], v[92:95], v[20:23]
    v_mul_f32 v40, v40, v196
    v_mul_f32 v41, v41, v197
    ds_read_b128 v[92:95], v73 offset:384
    s_waitcnt lgkmcnt(5)
    v_mfma_f32_16x16x32_bf16 v[20:23], v[172:175], v[76:79], v[20:23]
    v_mul_f32 v42, v42, v198
    v_mul_f32 v43, v43, v199
    ds_read_b128 v[76:79], v74 offset:384
    s_waitcnt lgkmcnt(5)
    v_mfma_f32_16x16x32_bf16 v[20:23], v[112:115], v[80:83], v[20:23]
    v_cvt_pk_bf16_f32 v40, v40, v41
    v_cvt_pk_bf16_f32 v41, v42, v43
    ds_read_b128 v[80:83], v75 offset:384
    s_waitcnt lgkmcnt(5)
    v_mfma_f32_16x16x32_bf16 v[20:23], v[116:119], v[84:87], v[20:23]
    ds_write_b64 v205, v[40:41] offset:768
    ds_read_b128 v[84:87], v72 offset:768
    s_waitcnt lgkmcnt(5)
    v_mfma_f32_16x16x32_bf16 v[44:47], v[120:123], v[88:91], 0
    ds_read_b128 v[88:91], v73 offset:768
    s_waitcnt lgkmcnt(5)
    v_mfma_f32_16x16x32_bf16 v[44:47], v[124:127], v[92:95], v[44:47]
    s_waitcnt lgkmcnt(2)
    s_barrier
    ds_read_b128 v[92:95], v74 offset:768
    v_mfma_f32_16x16x32_bf16 v[44:47], v[128:131], v[76:79], v[44:47]
    ds_read_b128 v[212:215], v207 offset:0
    ds_read_b128 v[216:219], v207 offset:1664
    ds_read_b128 v[76:79], v75 offset:768
    v_mfma_f32_16x16x32_bf16 v[44:47], v[132:135], v[80:83], v[44:47]
    ds_read_b128 v[80:83], v72 offset:896
    s_waitcnt lgkmcnt(6)
    v_mfma_f32_16x16x32_bf16 v[44:47], v[152:155], v[84:87], v[44:47]
    ds_read_b128 v[84:87], v73 offset:896
    s_waitcnt lgkmcnt(6)
    v_mfma_f32_16x16x32_bf16 v[44:47], v[156:159], v[88:91], v[44:47]
    ds_read_b128 v[88:91], v74 offset:896
    s_waitcnt lgkmcnt(6)
    v_mfma_f32_16x16x32_bf16 v[44:47], v[136:139], v[92:95], v[44:47]
    s_waitcnt lgkmcnt(5)
    buffer_store_dwordx4 v[212:215], v246, s[4:7], s24 offen sc1
    ds_read_b128 v[92:95], v75 offset:896
    s_waitcnt lgkmcnt(4)
    v_mfma_f32_16x16x32_bf16 v[44:47], v[140:143], v[76:79], v[44:47]
    buffer_store_dwordx4 v[216:219], v246, s[4:7], s25 offen sc1
    s_waitcnt lgkmcnt(3)
    v_mfma_f32_16x16x32_bf16 v[44:47], v[168:171], v[80:83], v[44:47]
    v_cvt_pk_bf16_f32 v8, v8, v9
    v_cvt_pk_bf16_f32 v9, v10, v11
    s_waitcnt lgkmcnt(2)
    v_mfma_f32_16x16x32_bf16 v[44:47], v[172:175], v[84:87], v[44:47]
    ds_write_b64 v204, v[8:9] offset:0
    v_mul_f32 v20, v20, v200
    s_waitcnt lgkmcnt(2)
    v_mfma_f32_16x16x32_bf16 v[44:47], v[112:115], v[88:91], v[44:47]
    v_mul_f32 v21, v21, v201
    v_mul_f32 v22, v22, v202
    s_waitcnt lgkmcnt(1)
    v_mfma_f32_16x16x32_bf16 v[44:47], v[116:119], v[92:95], v[44:47]
    v_mul_f32 v23, v23, v203
    v_cvt_pk_bf16_f32 v20, v20, v21
    v_cvt_pk_bf16_f32 v21, v22, v23
    ds_write_b64 v220, v[20:21] offset:256
    s_nop 3
    v_mul_f32 v44, v44, v200
    v_mul_f32 v45, v45, v201
    v_mul_f32 v46, v46, v202
    v_mul_f32 v47, v47, v203
    v_cvt_pk_bf16_f32 v44, v44, v45
    v_cvt_pk_bf16_f32 v45, v46, v47
    ds_write_b64 v204, v[44:45] offset:768
    s_waitcnt lgkmcnt(0)
    s_barrier
    ds_read_b128 v[212:215], v206 offset:0
    s_waitcnt lgkmcnt(0)
    buffer_store_dwordx4 v[212:215], v246, s[4:7], s26 offen sc1
    s_or_b32 s89, s89, s20
    s_cbranch_scc1 K2_end
    v_mov_b32 v0, 0
    v_mov_b32 v1, s88
    s_mov_b64 exec, 1
    buffer_store_dword v1, v0, s[16:19], 0 offen
    s_endpgm
T_pw:
    s_sleep 1
    ds_read_b32 v191, v190
    s_waitcnt lgkmcnt(0)
    v_cmp_gt_u32 vcc, s53, v191
    s_cbranch_vccnz T_pw
    s_branch T_pwr
T_aw:
    s_sleep 1
    ds_read_b32 v191, v190
    s_waitcnt lgkmcnt(0)
    v_cmp_gt_u32 vcc, s50, v191
    s_cbranch_vccnz T_aw
    s_branch T_awr
K2_end:
K2_last:
    s_endpgm
SLOW:
    v_readlane_b32 s89, v4, 62
    s_waitcnt vmcnt(0) lgkmcnt(0)
    s_barrier
    s_load_dwordx2 s[22:23], s[0:1], 8
    s_load_dwordx2 s[24:25], s[0:1], 24
    s_load_dwordx2 s[26:27], s[0:1], 32
    s_load_dwordx2 s[28:29], s[0:1], 40
    s_load_dwordx2 s[30:31], s[0:1], 0
    v_mbcnt_lo_u32_b32 v240, -1, 0
    v_mbcnt_hi_u32_b32 v240, -1, v240
    v_lshrrev_b32 v229, 5, v240
    v_and_b32 v230, 31, v240
    v_lshlrev_b32 v241, 7, v229
    v_lshl_add_u32 v241, v230, 1, v241
    v_lshlrev_b32 v245, 4, v240
    v_mov_b32 v242, 0
    s_waitcnt lgkmcnt(0)
    s_mov_b32 s80, s22
    s_and_b32 s81, s23, 0xffff
    s_mov_b32 s82, 1920000
    s_mov_b32 s83, 0x20000
    s_mov_b32 s76, s24
    s_and_b32 s77, s25, 0xffff
    s_mov_b32 s78, 1280000
    s_mov_b32 s79, 0x20000
    s_mov_b32 s72, s26
    s_and_b32 s73, s27, 0xffff
    s_mov_b32 s74, 1280000
    s_mov_b32 s75, 0x20000
    s_mov_b32 s84, s28
    s_and_b32 s85, s29, 0xffff
    s_mov_b32 s86, 20480
    s_mov_b32 s87, 0x20000
    s_mov_b32 s4, s30
    s_and_b32 s5, s31, 0xffff
    s_mov_b32 s6, 10240000
    s_mov_b32 s7, 0x20000
    s_mov_b32 s66, 0
    buffer_load_ushort v0, v241, s[84:87], s66 offen offset:0
    buffer_load_ushort v1, v241, s[84:87], s66 offen offset:64
    buffer_load_ushort v2, v241, s[84:87], s66 offen offset:256
    buffer_load_ushort v3, v241, s[84:87], s66 offen offset:320
    buffer_load_ushort v4, v241, s[84:87], s66 offen offset:512
    buffer_load_ushort v5, v241, s[84:87], s66 offen offset:576
    buffer_load_ushort v6, v241, s[84:87], s66 offen offset:768
    buffer_load_ushort v7, v241, s[84:87], s66 offen offset:832
    buffer_load_ushort v8, v241, s[84:87], s66 offen offset:1024
    buffer_load_ushort v9, v241, s[84:87], s66 offen offset:1088
    s_waitcnt vmcnt(0)
    s_mov_b32 s66, 1280
    buffer_load_ushort v10, v241, s[84:87], s66 offen offset:0
    buffer_load_ushort v11, v241, s[84:87], s66 offen offset:64
    buffer_load_ushort v12, v241, s[84:87], s66 offen offset:256
    buffer_load_ushort v13, v241, s[84:87], s66 offen offset:320
    buffer_load_ushort v14, v241, s[84:87], s66 offen offset:512
    buffer_load_ushort v15, v241, s[84:87], s66 offen offset:576
    buffer_load_ushort v16, v241, s[84:87], s66 offen offset:768
    buffer_load_ushort v17, v241, s[84:87], s66 offen offset:832
    buffer_load_ushort v18, v241, s[84:87], s66 offen offset:1024
    buffer_load_ushort v19, v241, s[84:87], s66 offen offset:1088
    s_waitcnt vmcnt(0)
    s_mov_b32 s66, 2560
    buffer_load_ushort v20, v241, s[84:87], s66 offen offset:0
    buffer_load_ushort v21, v241, s[84:87], s66 offen offset:64
    buffer_load_ushort v22, v241, s[84:87], s66 offen offset:256
    buffer_load_ushort v23, v241, s[84:87], s66 offen offset:320
    buffer_load_ushort v24, v241, s[84:87], s66 offen offset:512
    buffer_load_ushort v25, v241, s[84:87], s66 offen offset:576
    buffer_load_ushort v26, v241, s[84:87], s66 offen offset:768
    buffer_load_ushort v27, v241, s[84:87], s66 offen offset:832
    buffer_load_ushort v28, v241, s[84:87], s66 offen offset:1024
    buffer_load_ushort v29, v241, s[84:87], s66 offen offset:1088
    s_waitcnt vmcnt(0)
    s_mov_b32 s66, 3840
    buffer_load_ushort v30, v241, s[84:87], s66 offen offset:0
    buffer_load_ushort v31, v241, s[84:87], s66 offen offset:64
    buffer_load_ushort v32, v241, s[84:87], s66 offen offset:256
    buffer_load_ushort v33, v241, s[84:87], s66 offen offset:320
    buffer_load_ushort v34, v241, s[84:87], s66 offen offset:512
    buffer_load_ushort v35, v241, s[84:87], s66 offen offset:576
    buffer_load_ushort v36, v241, s[84:87], s66 offen offset:768
    buffer_load_ushort v37, v241, s[84:87], s66 offen offset:832
    buffer_load_ushort v38, v241, s[84:87], s66 offen offset:1024
    buffer_load_ushort v39, v241, s[84:87], s66 offen offset:1088
    s_waitcnt vmcnt(0)
    s_mov_b32 s66, 5120
    buffer_load_ushort v40, v241, s[84:87], s66 offen offset:0
    buffer_load_ushort v41, v241, s[84:87], s66 offen offset:64
    buffer_load_ushort v42, v241, s[84:87], s66 offen offset:256
    buffer_load_ushort v43, v241, s[84:87], s66 offen offset:320
    buffer_load_ushort v44, v241, s[84:87], s66 offen offset:512
    buffer_load_ushort v45, v241, s[84:87], s66 offen offset:576
    buffer_load_ushort v46, v241, s[84:87], s66 offen offset:768
    buffer_load_ushort v47, v241, s[84:87], s66 offen offset:832
    buffer_load_ushort v48, v241, s[84:87], s66 offen offset:1024
    buffer_load_ushort v49, v241, s[84:87], s66 offen offset:1088
    s_waitcnt vmcnt(0)
    s_mov_b32 s66, 6400
    buffer_load_ushort v50, v241, s[84:87], s66 offen offset:0
    buffer_load_ushort v51, v241, s[84:87], s66 offen offset:64
    buffer_load_ushort v52, v241, s[84:87], s66 offen offset:256
    buffer_load_ushort v53, v241, s[84:87], s66 offen offset:320
    buffer_load_ushort v54, v241, s[84:87], s66 offen offset:512
    buffer_load_ushort v55, v241, s[84:87], s66 offen offset:576
    buffer_load_ushort v56, v241, s[84:87], s66 offen offset:768
    buffer_load_ushort v57, v241, s[84:87], s66 offen offset:832
    buffer_load_ushort v58, v241, s[84:87], s66 offen offset:1024
    buffer_load_ushort v59, v241, s[84:87], s66 offen offset:1088
    s_waitcnt vmcnt(0)
    s_mov_b32 s66, 7680
    buffer_load_ushort v60, v241, s[84:87], s66 offen offset:0
    buffer_load_ushort v61, v241, s[84:87], s66 offen offset:64
    buffer_load_ushort v62, v241, s[84:87], s66 offen offset:256
    buffer_load_ushort v63, v241, s[84:87], s66 offen offset:320
    buffer_load_ushort v64, v241, s[84:87], s66 offen offset:512
    buffer_load_ushort v65, v241, s[84:87], s66 offen offset:576
    buffer_load_ushort v66, v241, s[84:87], s66 offen offset:768
    buffer_load_ushort v67, v241, s[84:87], s66 offen offset:832
    buffer_load_ushort v68, v241, s[84:87], s66 offen offset:1024
    buffer_load_ushort v69, v241, s[84:87], s66 offen offset:1088
    s_waitcnt vmcnt(0)
    s_mov_b32 s66, 8960
    buffer_load_ushort v70, v241, s[84:87], s66 offen offset:0
    buffer_load_ushort v71, v241, s[84:87], s66 offen offset:64
    buffer_load_ushort v72, v241, s[84:87], s66 offen offset:256
    buffer_load_ushort v73, v241, s[84:87], s66 offen offset:320
    buffer_load_ushort v74, v241, s[84:87], s66 offen offset:512
    buffer_load_ushort v75, v241, s[84:87], s66 offen offset:576
    buffer_load_ushort v76, v241, s[84:87], s66 offen offset:768
    buffer_load_ushort v77, v241, s[84:87], s66 offen offset:832
    buffer_load_ushort v78, v241, s[84:87], s66 offen offset:1024
    buffer_load_ushort v79, v241, s[84:87], s66 offen offset:1088
    s_waitcnt vmcnt(0)
    s_mov_b32 s66, 10240
    buffer_load_ushort v80, v241, s[84:87], s66 offen offset:0
    buffer_load_ushort v81, v241, s[84:87], s66 offen offset:64
    buffer_load_ushort v82, v241, s[84:87], s66 offen offset:256
    buffer_load_ushort v83, v241, s[84:87], s66 offen offset:320
    buffer_load_ushort v84, v241, s[84:87], s66 offen offset:512
    buffer_load_ushort v85, v241, s[84:87], s66 offen offset:576
    buffer_load_ushort v86, v241, s[84:87], s66 offen offset:768
    buffer_load_ushort v87, v241, s[84:87], s66 offen offset:832
    buffer_load_ushort v88, v241, s[84:87], s66 offen offset:1024
    buffer_load_ushort v89, v241, s[84:87], s66 offen offset:1088
    s_waitcnt vmcnt(0)
    s_mov_b32 s66, 11520
    buffer_load_ushort v90, v241, s[84:87], s66 offen offset:0
    buffer_load_ushort v91, v241, s[84:87], s66 offen offset:64
    buffer_load_ushort v92, v241, s[84:87], s66 offen offset:256
    buffer_load_ushort v93, v241, s[84:87], s66 offen offset:320
    buffer_load_ushort v94, v241, s[84:87], s66 offen offset:512
    buffer_load_ushort v95, v241, s[84:87], s66 offen offset:576
    buffer_load_ushort v96, v241, s[84:87], s66 offen offset:768
    buffer_load_ushort v97, v241, s[84:87], s66 offen offset:832
    buffer_load_ushort v98, v241, s[84:87], s66 offen offset:1024
    buffer_load_ushort v99, v241, s[84:87], s66 offen offset:1088
    s_waitcnt vmcnt(0)
    s_mov_b32 s66, 12800
    buffer_load_ushort v100, v241, s[84:87], s66 offen offset:0
    buffer_load_ushort v101, v241, s[84:87], s66 offen offset:64
    buffer_load_ushort v102, v241, s[84:87], s66 offen offset:256
    buffer_load_ushort v103, v241, s[84:87], s66 offen offset:320
    buffer_load_ushort v104, v241, s[84:87], s66 offen offset:512
    buffer_load_ushort v105, v241, s[84:87], s66 offen offset:576
    buffer_load_ushort v106, v241, s[84:87], s66 offen offset:768
    buffer_load_ushort v107, v241, s[84:87], s66 offen offset:832
    buffer_load_ushort v108, v241, s[84:87], s66 offen offset:1024
    buffer_load_ushort v109, v241, s[84:87], s66 offen offset:1088
    s_waitcnt vmcnt(0)
    s_mov_b32 s66, 14080
    buffer_load_ushort v110, v241, s[84:87], s66 offen offset:0
    buffer_load_ushort v111, v241, s[84:87], s66 offen offset:64
    buffer_load_ushort v112, v241, s[84:87], s66 offen offset:256
    buffer_load_ushort v113, v241, s[84:87], s66 offen offset:320
    buffer_load_ushort v114, v241, s[84:87], s66 offen offset:512
    buffer_load_ushort v115, v241, s[84:87], s66 offen offset:576
    buffer_load_ushort v116, v241, s[84:87], s66 offen offset:768
    buffer_load_ushort v117, v241, s[84:87], s66 offen offset:832
    buffer_load_ushort v118, v241, s[84:87], s66 offen offset:1024
    buffer_load_ushort v119, v241, s[84:87], s66 offen offset:1088
    s_waitcnt vmcnt(0)
    s_mov_b32 s66, 15360
    buffer_load_ushort v120, v241, s[84:87], s66 offen offset:0
    buffer_load_ushort v121, v241, s[84:87], s66 offen offset:64
    buffer_load_ushort v122, v241, s[84:87], s66 offen offset:256
    buffer_load_ushort v123, v241, s[84:87], s66 offen offset:320
    buffer_load_ushort v124, v241, s[84:87], s66 offen offset:512
    buffer_load_ushort v125, v241, s[84:87], s66 offen offset:576
    buffer_load_ushort v126, v241, s[84:87], s66 offen offset:768
    buffer_load_ushort v127, v241, s[84:87], s66 offen offset:832
    buffer_load_ushort v128, v241, s[84:87], s66 offen offset:1024
    buffer_load_ushort v129, v241, s[84:87], s66 offen offset:1088
    s_waitcnt vmcnt(0)
    s_mov_b32 s66, 16640
    buffer_load_ushort v130, v241, s[84:87], s66 offen offset:0
    buffer_load_ushort v131, v241, s[84:87], s66 offen offset:64
    buffer_load_ushort v132, v241, s[84:87], s66 offen offset:256
    buffer_load_ushort v133, v241, s[84:87], s66 offen offset:320
    buffer_load_ushort v134, v241, s[84:87], s66 offen offset:512
    buffer_load_ushort v135, v241, s[84:87], s66 offen offset:576
    buffer_load_ushort v136, v241, s[84:87], s66 offen offset:768
    buffer_load_ushort v137, v241, s[84:87], s66 offen offset:832
    buffer_load_ushort v138, v241, s[84:87], s66 offen offset:1024
    buffer_load_ushort v139, v241, s[84:87], s66 offen offset:1088
    s_waitcnt vmcnt(0)
    s_mov_b32 s66, 17920
    buffer_load_ushort v140, v241, s[84:87], s66 offen offset:0
    buffer_load_ushort v141, v241, s[84:87], s66 offen offset:64
    buffer_load_ushort v142, v241, s[84:87], s66 offen offset:256
    buffer_load_ushort v143, v241, s[84:87], s66 offen offset:320
    buffer_load_ushort v144, v241, s[84:87], s66 offen offset:512
    buffer_load_ushort v145, v241, s[84:87], s66 offen offset:576
    buffer_load_ushort v146, v241, s[84:87], s66 offen offset:768
    buffer_load_ushort v147, v241, s[84:87], s66 offen offset:832
    buffer_load_ushort v148, v241, s[84:87], s66 offen offset:1024
    buffer_load_ushort v149, v241, s[84:87], s66 offen offset:1088
    s_waitcnt vmcnt(0)
    s_mov_b32 s66, 19200
    buffer_load_ushort v150, v241, s[84:87], s66 offen offset:0
    buffer_load_ushort v151, v241, s[84:87], s66 offen offset:64
    buffer_load_ushort v152, v241, s[84:87], s66 offen offset:256
    buffer_load_ushort v153, v241, s[84:87], s66 offen offset:320
    buffer_load_ushort v154, v241, s[84:87], s66 offen offset:512
    buffer_load_ushort v155, v241, s[84:87], s66 offen offset:576
    buffer_load_ushort v156, v241, s[84:87], s66 offen offset:768
    buffer_load_ushort v157, v241, s[84:87], s66 offen offset:832
    buffer_load_ushort v158, v241, s[84:87], s66 offen offset:1024
    buffer_load_ushort v159, v241, s[84:87], s66 offen offset:1088
    s_waitcnt vmcnt(0)
    v_lshlrev_b32 v0, 16, v0
    v_lshlrev_b32 v1, 16, v1
    v_lshlrev_b32 v2, 16, v2
    v_lshlrev_b32 v3, 16, v3
    v_lshlrev_b32 v4, 16, v4
    v_lshlrev_b32 v5, 16, v5
    v_lshlrev_b32 v6, 16, v6
    v_lshlrev_b32 v7, 16, v7
    v_lshlrev_b32 v8, 16, v8
    v_lshlrev_b32 v9, 16, v9
    v_lshlrev_b32 v10, 16, v10
    v_lshlrev_b32 v11, 16, v11
    v_lshlrev_b32 v12, 16, v12
    v_lshlrev_b32 v13, 16, v13
    v_lshlrev_b32 v14, 16, v14
    v_lshlrev_b32 v15, 16, v15
    v_lshlrev_b32 v16, 16, v16
    v_lshlrev_b32 v17, 16, v17
    v_lshlrev_b32 v18, 16, v18
    v_lshlrev_b32 v19, 16, v19
    v_lshlrev_b32 v20, 16, v20
    v_lshlrev_b32 v21, 16, v21
    v_lshlrev_b32 v22, 16, v22
    v_lshlrev_b32 v23, 16, v23
    v_lshlrev_b32 v24, 16, v24
    v_lshlrev_b32 v25, 16, v25
    v_lshlrev_b32 v26, 16, v26
    v_lshlrev_b32 v27, 16, v27
    v_lshlrev_b32 v28, 16, v28
    v_lshlrev_b32 v29, 16, v29
    v_lshlrev_b32 v30, 16, v30
    v_lshlrev_b32 v31, 16, v31
    v_lshlrev_b32 v32, 16, v32
    v_lshlrev_b32 v33, 16, v33
    v_lshlrev_b32 v34, 16, v34
    v_lshlrev_b32 v35, 16, v35
    v_lshlrev_b32 v36, 16, v36
    v_lshlrev_b32 v37, 16, v37
    v_lshlrev_b32 v38, 16, v38
    v_lshlrev_b32 v39, 16, v39
    v_lshlrev_b32 v40, 16, v40
    v_lshlrev_b32 v41, 16, v41
    v_lshlrev_b32 v42, 16, v42
    v_lshlrev_b32 v43, 16, v43
    v_lshlrev_b32 v44, 16, v44
    v_lshlrev_b32 v45, 16, v45
    v_lshlrev_b32 v46, 16, v46
    v_lshlrev_b32 v47, 16, v47
    v_lshlrev_b32 v48, 16, v48
    v_lshlrev_b32 v49, 16, v49
    v_lshlrev_b32 v50, 16, v50
    v_lshlrev_b32 v51, 16, v51
    v_lshlrev_b32 v52, 16, v52
    v_lshlrev_b32 v53, 16, v53
    v_lshlrev_b32 v54, 16, v54
    v_lshlrev_b32 v55, 16, v55
    v_lshlrev_b32 v56, 16, v56
    v_lshlrev_b32 v57, 16, v57
    v_lshlrev_b32 v58, 16, v58
    v_lshlrev_b32 v59, 16, v59
    v_lshlrev_b32 v60, 16, v60
    v_lshlrev_b32 v61, 16, v61
    v_lshlrev_b32 v62, 16, v62
    v_lshlrev_b32 v63, 16, v63
    v_lshlrev_b32 v64, 16, v64
    v_lshlrev_b32 v65, 16, v65
    v_lshlrev_b32 v66, 16, v66
    v_lshlrev_b32 v67, 16, v67
    v_lshlrev_b32 v68, 16, v68
    v_lshlrev_b32 v69, 16, v69
    v_lshlrev_b32 v70, 16, v70
    v_lshlrev_b32 v71, 16, v71
    v_lshlrev_b32 v72, 16, v72
    v_lshlrev_b32 v73, 16, v73
    v_lshlrev_b32 v74, 16, v74
    v_lshlrev_b32 v75, 16, v75
    v_lshlrev_b32 v76, 16, v76
    v_lshlrev_b32 v77, 16, v77
    v_lshlrev_b32 v78, 16, v78
    v_lshlrev_b32 v79, 16, v79
    v_lshlrev_b32 v80, 16, v80
    v_lshlrev_b32 v81, 16, v81
    v_lshlrev_b32 v82, 16, v82
    v_lshlrev_b32 v83, 16, v83
    v_lshlrev_b32 v84, 16, v84
    v_lshlrev_b32 v85, 16, v85
    v_lshlrev_b32 v86, 16, v86
    v_lshlrev_b32 v87, 16, v87
    v_lshlrev_b32 v88, 16, v88
    v_lshlrev_b32 v89, 16, v89
    v_lshlrev_b32 v90, 16, v90
    v_lshlrev_b32 v91, 16, v91
    v_lshlrev_b32 v92, 16, v92
    v_lshlrev_b32 v93, 16, v93
    v_lshlrev_b32 v94, 16, v94
    v_lshlrev_b32 v95, 16, v95
    v_lshlrev_b32 v96, 16, v96
    v_lshlrev_b32 v97, 16, v97
    v_lshlrev_b32 v98, 16, v98
    v_lshlrev_b32 v99, 16, v99
    v_lshlrev_b32 v100, 16, v100
    v_lshlrev_b32 v101, 16, v101
    v_lshlrev_b32 v102, 16, v102
    v_lshlrev_b32 v103, 16, v103
    v_lshlrev_b32 v104, 16, v104
    v_lshlrev_b32 v105, 16, v105
    v_lshlrev_b32 v106, 16, v106
    v_lshlrev_b32 v107, 16, v107
    v_lshlrev_b32 v108, 16, v108
    v_lshlrev_b32 v109, 16, v109
    v_lshlrev_b32 v110, 16, v110
    v_lshlrev_b32 v111, 16, v111
    v_lshlrev_b32 v112, 16, v112
    v_lshlrev_b32 v113, 16, v113
    v_lshlrev_b32 v114, 16, v114
    v_lshlrev_b32 v115, 16, v115
    v_lshlrev_b32 v116, 16, v116
    v_lshlrev_b32 v117, 16, v117
    v_lshlrev_b32 v118, 16, v118
    v_lshlrev_b32 v119, 16, v119
    v_lshlrev_b32 v120, 16, v120
    v_lshlrev_b32 v121, 16, v121
    v_lshlrev_b32 v122, 16, v122
    v_lshlrev_b32 v123, 16, v123
    v_lshlrev_b32 v124, 16, v124
    v_lshlrev_b32 v125, 16, v125
    v_lshlrev_b32 v126, 16, v126
    v_lshlrev_b32 v127, 16, v127
    v_lshlrev_b32 v128, 16, v128
    v_lshlrev_b32 v129, 16, v129
    v_lshlrev_b32 v130, 16, v130
    v_lshlrev_b32 v131, 16, v131
    v_lshlrev_b32 v132, 16, v132
    v_lshlrev_b32 v133, 16, v133
    v_lshlrev_b32 v134, 16, v134
    v_lshlrev_b32 v135, 16, v135
    v_lshlrev_b32 v136, 16, v136
    v_lshlrev_b32 v137, 16, v137
    v_lshlrev_b32 v138, 16, v138
    v_lshlrev_b32 v139, 16, v139
    v_lshlrev_b32 v140, 16, v140
    v_lshlrev_b32 v141, 16, v141
    v_lshlrev_b32 v142, 16, v142
    v_lshlrev_b32 v143, 16, v143
    v_lshlrev_b32 v144, 16, v144
    v_lshlrev_b32 v145, 16, v145
    v_lshlrev_b32 v146, 16, v146
    v_lshlrev_b32 v147, 16, v147
    v_lshlrev_b32 v148, 16, v148
    v_lshlrev_b32 v149, 16, v149
    v_lshlrev_b32 v150, 16, v150
    v_lshlrev_b32 v151, 16, v151
    v_lshlrev_b32 v152, 16, v152
    v_lshlrev_b32 v153, 16, v153
    v_lshlrev_b32 v154, 16, v154
    v_lshlrev_b32 v155, 16, v155
    v_lshlrev_b32 v156, 16, v156
    v_lshlrev_b32 v157, 16, v157
    v_lshlrev_b32 v158, 16, v158
    v_lshlrev_b32 v159, 16, v159
    s_mov_b32 s50, 0
SL_node:
    s_mul_i32 s34, s2, 40
    s_lshl_b32 s66, s50, 3
    s_add_u32 s66, s66, s20
    s_add_u32 s34, s34, s66
    v_mov_b32 v160, 0
    v_mov_b32 v161, 0
    v_mov_b32 v162, 0
    v_mov_b32 v163, 0
    v_mov_b32 v164, 0
    v_mov_b32 v165, 0
    v_mov_b32 v166, 0
    v_mov_b32 v167, 0
    v_mov_b32 v168, 0
    v_mov_b32 v169, 0
    v_mov_b32 v170, 0
    v_mov_b32 v171, 0
    v_mov_b32 v172, 0
    v_mov_b32 v173, 0
    v_mov_b32 v174, 0
    v_mov_b32 v175, 0
    v_mov_b32 v176, 0
    v_mov_b32 v177, 0
    v_mov_b32 v178, 0
    v_mov_b32 v179, 0
    v_mov_b32 v180, 0
    v_mov_b32 v181, 0
    s_mov_b32 s35, 0
SL_scan:
    s_lshl_b32 s66, s35, 2
    buffer_load_dwordx4 v[236:239], v245, s[72:75], s66 offen
    s_waitcnt vmcnt(0)
    v_cmp_eq_u32 s[38:39], s34, v236
    v_cmp_eq_u32 s[40:41], s34, v237
    v_cmp_eq_u32 s[42:43], s34, v238
    v_cmp_eq_u32 s[44:45], s34, v239
    s_mov_b32 s36, 0
SL_bits:
    s_cmp_eq_u64 s[38:39], 0
    s_cbranch_scc1 SL_nexti
    s_ff1_i32_b64 s66, s[38:39]
    s_bitset0_b64 s[38:39], s66
    s_lshl_b32 s66, s66, 2
    s_add_u32 s37, s66, s36
    s_add_u32 s37, s37, s35
    s_lshl_b32 s66, s37, 2
    s_lshl_b32 s67, s37, 5
    s_mul_i32 s68, s37, 6
    buffer_load_dword v243, v242, s[76:79], s66 offen
    buffer_load_dwordx4 v[184:187], v242, s[12:15], s67 offen
    buffer_load_dwordx4 v[188:191], v242, s[12:15], s67 offen offset:16
    buffer_load_ushort v226, v242, s[80:83], s68 offen offset:0
    buffer_load_ushort v227, v242, s[80:83], s68 offen offset:2
    buffer_load_ushort v228, v242, s[80:83], s68 offen offset:4
    s_waitcnt vmcnt(5)
    v_lshl_add_u32 v243, v243, 10, v241
    buffer_load_ushort v208, v243, s[4:7], 0 offen offset:0
    buffer_load_ushort v209, v243, s[4:7], 0 offen offset:64
    buffer_load_ushort v210, v243, s[4:7], 0 offen offset:256
    buffer_load_ushort v211, v243, s[4:7], 0 offen offset:320
    buffer_load_ushort v212, v243, s[4:7], 0 offen offset:512
    buffer_load_ushort v213, v243, s[4:7], 0 offen offset:576
    buffer_load_ushort v214, v243, s[4:7], 0 offen offset:768
    buffer_load_ushort v215, v243, s[4:7], 0 offen offset:832
    s_waitcnt vmcnt(8)
    v_lshlrev_b32 v192, 16, v184
    v_and_b32 v193, 0xffff0000, v184
    v_lshlrev_b32 v194, 16, v185
    v_and_b32 v195, 0xffff0000, v185
    v_lshlrev_b32 v196, 16, v186
    v_and_b32 v197, 0xffff0000, v186
    v_lshlrev_b32 v198, 16, v187
    v_and_b32 v199, 0xffff0000, v187
    v_lshlrev_b32 v200, 16, v188
    v_and_b32 v201, 0xffff0000, v188
    v_lshlrev_b32 v202, 16, v189
    v_and_b32 v203, 0xffff0000, v189
    v_lshlrev_b32 v204, 16, v190
    v_and_b32 v205, 0xffff0000, v190
    v_lshlrev_b32 v206, 16, v191
    v_and_b32 v207, 0xffff0000, v191
    v_lshlrev_b32 v226, 16, v226
    v_lshlrev_b32 v227, 16, v227
    v_lshlrev_b32 v228, 16, v228
    v_mul_f32 v216, v192, v0
    v_mul_f32 v217, v192, v1
    v_mul_f32 v218, v192, v2
    v_mul_f32 v219, v192, v3
    v_mul_f32 v220, v192, v4
    v_mul_f32 v221, v192, v5
    v_mul_f32 v222, v192, v6
    v_mul_f32 v223, v192, v7
    v_mul_f32 v224, v192, v8
    v_mul_f32 v225, v192, v9
    v_fmac_f32 v216, v193, v10
    v_fmac_f32 v217, v193, v11
    v_fmac_f32 v218, v193, v12
    v_fmac_f32 v219, v193, v13
    v_fmac_f32 v220, v193, v14
    v_fmac_f32 v221, v193, v15
    v_fmac_f32 v222, v193, v16
    v_fmac_f32 v223, v193, v17
    v_fmac_f32 v224, v193, v18
    v_fmac_f32 v225, v193, v19
    v_fmac_f32 v216, v194, v20
    v_fmac_f32 v217, v194, v21
    v_fmac_f32 v218, v194, v22
    v_fmac_f32 v219, v194, v23
    v_fmac_f32 v220, v194, v24
    v_fmac_f32 v221, v194, v25
    v_fmac_f32 v222, v194, v26
    v_fmac_f32 v223, v194, v27
    v_fmac_f32 v224, v194, v28
    v_fmac_f32 v225, v194, v29
    v_fmac_f32 v216, v195, v30
    v_fmac_f32 v217, v195, v31
    v_fmac_f32 v218, v195, v32
    v_fmac_f32 v219, v195, v33
    v_fmac_f32 v220, v195, v34
    v_fmac_f32 v221, v195, v35
    v_fmac_f32 v222, v195, v36
    v_fmac_f32 v223, v195, v37
    v_fmac_f32 v224, v195, v38
    v_fmac_f32 v225, v195, v39
    v_fmac_f32 v216, v196, v40
    v_fmac_f32 v217, v196, v41
    v_fmac_f32 v218, v196, v42
    v_fmac_f32 v219, v196, v43
    v_fmac_f32 v220, v196, v44
    v_fmac_f32 v221, v196, v45
    v_fmac_f32 v222, v196, v46
    v_fmac_f32 v223, v196, v47
    v_fmac_f32 v224, v196, v48
    v_fmac_f32 v225, v196, v49
    v_fmac_f32 v216, v197, v50
    v_fmac_f32 v217, v197, v51
    v_fmac_f32 v218, v197, v52
    v_fmac_f32 v219, v197, v53
    v_fmac_f32 v220, v197, v54
    v_fmac_f32 v221, v197, v55
    v_fmac_f32 v222, v197, v56
    v_fmac_f32 v223, v197, v57
    v_fmac_f32 v224, v197, v58
    v_fmac_f32 v225, v197, v59
    v_fmac_f32 v216, v198, v60
    v_fmac_f32 v217, v198, v61
    v_fmac_f32 v218, v198, v62
    v_fmac_f32 v219, v198, v63
    v_fmac_f32 v220, v198, v64
    v_fmac_f32 v221, v198, v65
    v_fmac_f32 v222, v198, v66
    v_fmac_f32 v223, v198, v67
    v_fmac_f32 v224, v198, v68
    v_fmac_f32 v225, v198, v69
    v_fmac_f32 v216, v199, v70
    v_fmac_f32 v217, v199, v71
    v_fmac_f32 v218, v199, v72
    v_fmac_f32 v219, v199, v73
    v_fmac_f32 v220, v199, v74
    v_fmac_f32 v221, v199, v75
    v_fmac_f32 v222, v199, v76
    v_fmac_f32 v223, v199, v77
    v_fmac_f32 v224, v199, v78
    v_fmac_f32 v225, v199, v79
    v_fmac_f32 v216, v200, v80
    v_fmac_f32 v217, v200, v81
    v_fmac_f32 v218, v200, v82
    v_fmac_f32 v219, v200, v83
    v_fmac_f32 v220, v200, v84
    v_fmac_f32 v221, v200, v85
    v_fmac_f32 v222, v200, v86
    v_fmac_f32 v223, v200, v87
    v_fmac_f32 v224, v200, v88
    v_fmac_f32 v225, v200, v89
    v_fmac_f32 v216, v201, v90
    v_fmac_f32 v217, v201, v91
    v_fmac_f32 v218, v201, v92
    v_fmac_f32 v219, v201, v93
    v_fmac_f32 v220, v201, v94
    v_fmac_f32 v221, v201, v95
    v_fmac_f32 v222, v201, v96
    v_fmac_f32 v223, v201, v97
    v_fmac_f32 v224, v201, v98
    v_fmac_f32 v225, v201, v99
    v_fmac_f32 v216, v202, v100
    v_fmac_f32 v217, v202, v101
    v_fmac_f32 v218, v202, v102
    v_fmac_f32 v219, v202, v103
    v_fmac_f32 v220, v202, v104
    v_fmac_f32 v221, v202, v105
    v_fmac_f32 v222, v202, v106
    v_fmac_f32 v223, v202, v107
    v_fmac_f32 v224, v202, v108
    v_fmac_f32 v225, v202, v109
    v_fmac_f32 v216, v203, v110
    v_fmac_f32 v217, v203, v111
    v_fmac_f32 v218, v203, v112
    v_fmac_f32 v219, v203, v113
    v_fmac_f32 v220, v203, v114
    v_fmac_f32 v221, v203, v115
    v_fmac_f32 v222, v203, v116
    v_fmac_f32 v223, v203, v117
    v_fmac_f32 v224, v203, v118
    v_fmac_f32 v225, v203, v119
    v_fmac_f32 v216, v204, v120
    v_fmac_f32 v217, v204, v121
    v_fmac_f32 v218, v204, v122
    v_fmac_f32 v219, v204, v123
    v_fmac_f32 v220, v204, v124
    v_fmac_f32 v221, v204, v125
    v_fmac_f32 v222, v204, v126
    v_fmac_f32 v223, v204, v127
    v_fmac_f32 v224, v204, v128
    v_fmac_f32 v225, v204, v129
    v_fmac_f32 v216, v205, v130
    v_fmac_f32 v217, v205, v131
    v_fmac_f32 v218, v205, v132
    v_fmac_f32 v219, v205, v133
    v_fmac_f32 v220, v205, v134
    v_fmac_f32 v221, v205, v135
    v_fmac_f32 v222, v205, v136
    v_fmac_f32 v223, v205, v137
    v_fmac_f32 v224, v205, v138
    v_fmac_f32 v225, v205, v139
    v_fmac_f32 v216, v206, v140
    v_fmac_f32 v217, v206, v141
    v_fmac_f32 v218, v206, v142
    v_fmac_f32 v219, v206, v143
    v_fmac_f32 v220, v206, v144
    v_fmac_f32 v221, v206, v145
    v_fmac_f32 v222, v206, v146
    v_fmac_f32 v223, v206, v147
    v_fmac_f32 v224, v206, v148
    v_fmac_f32 v225, v206, v149
    v_fmac_f32 v216, v207, v150
    v_fmac_f32 v217, v207, v151
    v_fmac_f32 v218, v207, v152
    v_fmac_f32 v219, v207, v153
    v_fmac_f32 v220, v207, v154
    v_fmac_f32 v221, v207, v155
    v_fmac_f32 v222, v207, v156
    v_fmac_f32 v223, v207, v157
    v_fmac_f32 v224, v207, v158
    v_fmac_f32 v225, v207, v159
    s_waitcnt vmcnt(0)
    v_lshlrev_b32 v208, 16, v208
    v_lshlrev_b32 v209, 16, v209
    v_lshlrev_b32 v210, 16, v210
    v_lshlrev_b32 v211, 16, v211
    v_lshlrev_b32 v212, 16, v212
    v_lshlrev_b32 v213, 16, v213
    v_lshlrev_b32 v214, 16, v214
    v_lshlrev_b32 v215, 16, v215
    v_fmac_f32 v160, v208, v216
    v_mul_f32 v229, v210, v226
    v_fmac_f32 v229, v212, v227
    v_fmac_f32 v229, v214, v228
    v_fmac_f32 v176, v229, v218
    v_mul_f32 v229, v208, v220
    v_fmac_f32 v162, v229, v226
    v_fmac_f32 v168, v210, v222
    v_mul_f32 v230, v227, v214
    v_fma_f32 v230, -v228, v212, v230
    v_fmac_f32 v178, v230, v224
    v_fmac_f32 v164, v229, v227
    v_fmac_f32 v170, v212, v222
    v_mul_f32 v230, v228, v210
    v_fma_f32 v230, -v226, v214, v230
    v_fmac_f32 v180, v230, v224
    v_fmac_f32 v166, v229, v228
    v_fmac_f32 v172, v214, v222
    v_mul_f32 v230, v226, v212
    v_fma_f32 v230, -v227, v210, v230
    v_fmac_f32 v174, v230, v224
    v_fmac_f32 v161, v209, v217
    v_mul_f32 v229, v211, v226
    v_fmac_f32 v229, v213, v227
    v_fmac_f32 v229, v215, v228
    v_fmac_f32 v177, v229, v219
    v_mul_f32 v229, v209, v221
    v_fmac_f32 v163, v229, v226
    v_fmac_f32 v169, v211, v223
    v_mul_f32 v230, v227, v215
    v_fma_f32 v230, -v228, v213, v230
    v_fmac_f32 v179, v230, v225
    v_fmac_f32 v165, v229, v227
    v_fmac_f32 v171, v213, v223
    v_mul_f32 v230, v228, v211
    v_fma_f32 v230, -v226, v215, v230
    v_fmac_f32 v181, v230, v225
    v_fmac_f32 v167, v229, v228
    v_fmac_f32 v173, v215, v223
    v_mul_f32 v230, v226, v213
    v_fma_f32 v230, -v227, v211, v230
    v_fmac_f32 v175, v230, v225
    s_branch SL_bits
SL_nexti:
    s_mov_b64 s[38:39], s[40:41]
    s_mov_b64 s[40:41], s[42:43]
    s_mov_b64 s[42:43], s[44:45]
    s_add_u32 s36, s36, 1
    s_cmp_lt_u32 s36, 4
    s_cbranch_scc1 SL_bits
    s_add_u32 s35, s35, 256
    s_cmp_lt_u32 s35, 320000
    s_cbranch_scc1 SL_scan
    s_lshl_b32 s66, s50, 3
    s_add_u32 s66, s66, s20
    s_lshl_b32 s67, s66, 4
    s_and_b32 s68, s67, 128
    s_and_b32 s67, s67, 0x70
    s_mul_i32 s69, s50, 1536
    s_add_u32 s69, s69, s21
    s_add_u32 s69, s69, s68
    s_mul_i32 s70, s66, 1536
    s_add_u32 s70, s70, 86016
    s_add_u32 s70, s70, s68
    v_mov_b32 v230, s69
    v_mov_b32 v231, s70
    v_cmp_gt_u32 vcc, 32, v240
    v_and_b32 v229, 31, v240
    v_lshlrev_b32 v229, 2, v229
    v_xor_b32 v229, s67, v229
    v_cndmask_b32 v244, v231, v230, vcc
    v_add_u32 v244, v244, v229
    v_cvt_pk_bf16_f32 v160, v160, v161
    ds_write_b32 v244, v160 offset:0
    v_cvt_pk_bf16_f32 v162, v162, v163
    ds_write_b32 v244, v162 offset:128
    v_cvt_pk_bf16_f32 v164, v164, v165
    ds_write_b32 v244, v164 offset:256
    v_cvt_pk_bf16_f32 v166, v166, v167
    ds_write_b32 v244, v166 offset:384
    v_cvt_pk_bf16_f32 v168, v168, v169
    ds_write_b32 v244, v168 offset:512
    v_cvt_pk_bf16_f32 v170, v170, v171
    ds_write_b32 v244, v170 offset:640
    v_cvt_pk_bf16_f32 v172, v172, v173
    ds_write_b32 v244, v172 offset:768
    v_cvt_pk_bf16_f32 v174, v174, v175
    ds_write_b32 v244, v174 offset:896
    v_cvt_pk_bf16_f32 v176, v176, v177
    ds_write_b32 v244, v176 offset:1024
    v_cvt_pk_bf16_f32 v178, v178, v179
    ds_write_b32 v244, v178 offset:1152
    v_cvt_pk_bf16_f32 v180, v180, v181
    ds_write_b32 v244, v180 offset:1280
    s_lshl_b32 s66, s66, 3
    s_add_u32 s66, s66, 163328
    v_mov_b32 v229, s66
    ds_write_b64 v229, v[230:231]
    s_add_u32 s50, s50, 1
    s_cmp_lt_u32 s50, 5
    s_cbranch_scc1 SL_node
    s_waitcnt lgkmcnt(0)
    s_barrier
    v_mov_b32 v176, v240
    s_load_dwordx4 s[84:87], s[0:1], 48
    s_mul_i32 s22, s20, 20
    s_waitcnt lgkmcnt(0)
    s_mul_i32 s24, s22, 3277
    s_lshr_b32 s24, s24, 16
    s_mul_i32 s68, s24, 20
    s_sub_u32 s68, s22, s68
    s_cmp_lt_u32 s68, 8
    s_cselect_b64 s[66:67], s[84:85], s[86:87]
    s_cselect_b32 s25, 0, 8
    s_sub_u32 s68, s68, s25
    s_and_b32 s25, s68, 1
    s_lshr_b32 s68, s68, 1
    s_lshl_b32 s68, s68, 14
    s_lshl_b32 s25, s25, 12
    s_add_u32 s68, s68, s25
    s_lshl_b32 s24, s24, 5
    s_add_u32 s68, s68, s24
    v_lshrrev_b32 v2, 4, v176
    v_lshlrev_b32 v2, 10, v2
    v_and_b32 v3, 15, v176
    v_lshl_add_u32 v2, v3, 1, v2
    v_add_u32 v2, s68, v2
    v_add_u32 v3, 8192, v2
    v_mov_b32 v4, 0
    v_mov_b32 v5, 0
    v_mov_b32 v6, 0
    v_mov_b32 v7, 0
    global_load_ushort v144, v2, s[66:67] offset:0
    global_load_short_d16_hi v4, v3, s[66:67] offset:0
    global_load_ushort v145, v2, s[66:67] offset:256
    global_load_short_d16_hi v5, v3, s[66:67] offset:256
    global_load_ushort v146, v2, s[66:67] offset:512
    global_load_short_d16_hi v6, v3, s[66:67] offset:512
    global_load_ushort v147, v2, s[66:67] offset:768
    global_load_short_d16_hi v7, v3, s[66:67] offset:768
    s_add_u32 s22, s22, 1
    s_waitcnt vmcnt(0)
    v_or_b32 v144, v144, v4
    v_or_b32 v145, v145, v5
    v_or_b32 v146, v146, v6
    v_or_b32 v147, v147, v7
    s_mul_i32 s24, s22, 3277
    s_lshr_b32 s24, s24, 16
    s_mul_i32 s68, s24, 20
    s_sub_u32 s68, s22, s68
    s_cmp_lt_u32 s68, 8
    s_cselect_b64 s[66:67], s[84:85], s[86:87]
    s_cselect_b32 s25, 0, 8
    s_sub_u32 s68, s68, s25
    s_and_b32 s25, s68, 1
    s_lshr_b32 s68, s68, 1
    s_lshl_b32 s68, s68, 14
    s_lshl_b32 s25, s25, 12
    s_add_u32 s68, s68, s25
    s_lshl_b32 s24, s24, 5
    s_add_u32 s68, s68, s24
    v_lshrrev_b32 v2, 4, v176
    v_lshlrev_b32 v2, 10, v2
    v_and_b32 v3, 15, v176
    v_lshl_add_u32 v2, v3, 1, v2
    v_add_u32 v2, s68, v2
    v_add_u32 v3, 8192, v2
    v_mov_b32 v4, 0
    v_mov_b32 v5, 0
    v_mov_b32 v6, 0
    v_mov_b32 v7, 0
    global_load_ushort v148, v2, s[66:67] offset:0
    global_load_short_d16_hi v4, v3, s[66:67] offset:0
    global_load_ushort v149, v2, s[66:67] offset:256
    global_load_short_d16_hi v5, v3, s[66:67] offset:256
    global_load_ushort v150, v2, s[66:67] offset:512
    global_load_short_d16_hi v6, v3, s[66:67] offset:512
    global_load_ushort v151, v2, s[66:67] offset:768
    global_load_short_d16_hi v7, v3, s[66:67] offset:768
    s_add_u32 s22, s22, 1
    s_waitcnt vmcnt(0)
    v_or_b32 v148, v148, v4
    v_or_b32 v149, v149, v5
    v_or_b32 v150, v150, v6
    v_or_b32 v151, v151, v7
    s_mul_i32 s24, s22, 3277
    s_lshr_b32 s24, s24, 16
    s_mul_i32 s68, s24, 20
    s_sub_u32 s68, s22, s68
    s_cmp_lt_u32 s68, 8
    s_cselect_b64 s[66:67], s[84:85], s[86:87]
    s_cselect_b32 s25, 0, 8
    s_sub_u32 s68, s68, s25
    s_and_b32 s25, s68, 1
    s_lshr_b32 s68, s68, 1
    s_lshl_b32 s68, s68, 14
    s_lshl_b32 s25, s25, 12
    s_add_u32 s68, s68, s25
    s_lshl_b32 s24, s24, 5
    s_add_u32 s68, s68, s24
    v_lshrrev_b32 v2, 4, v176
    v_lshlrev_b32 v2, 10, v2
    v_and_b32 v3, 15, v176
    v_lshl_add_u32 v2, v3, 1, v2
    v_add_u32 v2, s68, v2
    v_add_u32 v3, 8192, v2
    v_mov_b32 v4, 0
    v_mov_b32 v5, 0
    v_mov_b32 v6, 0
    v_mov_b32 v7, 0
    global_load_ushort v96, v2, s[66:67] offset:0
    global_load_short_d16_hi v4, v3, s[66:67] offset:0
    global_load_ushort v97, v2, s[66:67] offset:256
    global_load_short_d16_hi v5, v3, s[66:67] offset:256
    global_load_ushort v98, v2, s[66:67] offset:512
    global_load_short_d16_hi v6, v3, s[66:67] offset:512
    global_load_ushort v99, v2, s[66:67] offset:768
    global_load_short_d16_hi v7, v3, s[66:67] offset:768
    s_add_u32 s22, s22, 1
    s_waitcnt vmcnt(0)
    v_or_b32 v96, v96, v4
    v_or_b32 v97, v97, v5
    v_or_b32 v98, v98, v6
    v_or_b32 v99, v99, v7
    s_mul_i32 s24, s22, 3277
    s_lshr_b32 s24, s24, 16
    s_mul_i32 s68, s24, 20
    s_sub_u32 s68, s22, s68
    s_cmp_lt_u32 s68, 8
    s_cselect_b64 s[66:67], s[84:85], s[86:87]
    s_cselect_b32 s25, 0, 8
    s_sub_u32 s68, s68, s25
    s_and_b32 s25, s68, 1
    s_lshr_b32 s68, s68, 1
    s_lshl_b32 s68, s68, 14
    s_lshl_b32 s25, s25, 12
    s_add_u32 s68, s68, s25
    s_lshl_b32 s24, s24, 5
    s_add_u32 s68, s68, s24
    v_lshrrev_b32 v2, 4, v176
    v_lshlrev_b32 v2, 10, v2
    v_and_b32 v3, 15, v176
    v_lshl_add_u32 v2, v3, 1, v2
    v_add_u32 v2, s68, v2
    v_add_u32 v3, 8192, v2
    v_mov_b32 v4, 0
    v_mov_b32 v5, 0
    v_mov_b32 v6, 0
    v_mov_b32 v7, 0
    global_load_ushort v100, v2, s[66:67] offset:0
    global_load_short_d16_hi v4, v3, s[66:67] offset:0
    global_load_ushort v101, v2, s[66:67] offset:256
    global_load_short_d16_hi v5, v3, s[66:67] offset:256
    global_load_ushort v102, v2, s[66:67] offset:512
    global_load_short_d16_hi v6, v3, s[66:67] offset:512
    global_load_ushort v103, v2, s[66:67] offset:768
    global_load_short_d16_hi v7, v3, s[66:67] offset:768
    s_add_u32 s22, s22, 1
    s_waitcnt vmcnt(0)
    v_or_b32 v100, v100, v4
    v_or_b32 v101, v101, v5
    v_or_b32 v102, v102, v6
    v_or_b32 v103, v103, v7
    s_mul_i32 s24, s22, 3277
    s_lshr_b32 s24, s24, 16
    s_mul_i32 s68, s24, 20
    s_sub_u32 s68, s22, s68
    s_cmp_lt_u32 s68, 8
    s_cselect_b64 s[66:67], s[84:85], s[86:87]
    s_cselect_b32 s25, 0, 8
    s_sub_u32 s68, s68, s25
    s_and_b32 s25, s68, 1
    s_lshr_b32 s68, s68, 1
    s_lshl_b32 s68, s68, 14
    s_lshl_b32 s25, s25, 12
    s_add_u32 s68, s68, s25
    s_lshl_b32 s24, s24, 5
    s_add_u32 s68, s68, s24
    v_lshrrev_b32 v2, 4, v176
    v_lshlrev_b32 v2, 10, v2
    v_and_b32 v3, 15, v176
    v_lshl_add_u32 v2, v3, 1, v2
    v_add_u32 v2, s68, v2
    v_add_u32 v3, 8192, v2
    v_mov_b32 v4, 0
    v_mov_b32 v5, 0
    v_mov_b32 v6, 0
    v_mov_b32 v7, 0
    global_load_ushort v160, v2, s[66:67] offset:0
    global_load_short_d16_hi v4, v3, s[66:67] offset:0
    global_load_ushort v161, v2, s[66:67] offset:256
    global_load_short_d16_hi v5, v3, s[66:67] offset:256
    global_load_ushort v162, v2, s[66:67] offset:512
    global_load_short_d16_hi v6, v3, s[66:67] offset:512
    global_load_ushort v163, v2, s[66:67] offset:768
    global_load_short_d16_hi v7, v3, s[66:67] offset:768
    s_add_u32 s22, s22, 1
    s_waitcnt vmcnt(0)
    v_or_b32 v160, v160, v4
    v_or_b32 v161, v161, v5
    v_or_b32 v162, v162, v6
    v_or_b32 v163, v163, v7
    s_mul_i32 s24, s22, 3277
    s_lshr_b32 s24, s24, 16
    s_mul_i32 s68, s24, 20
    s_sub_u32 s68, s22, s68
    s_cmp_lt_u32 s68, 8
    s_cselect_b64 s[66:67], s[84:85], s[86:87]
    s_cselect_b32 s25, 0, 8
    s_sub_u32 s68, s68, s25
    s_and_b32 s25, s68, 1
    s_lshr_b32 s68, s68, 1
    s_lshl_b32 s68, s68, 14
    s_lshl_b32 s25, s25, 12
    s_add_u32 s68, s68, s25
    s_lshl_b32 s24, s24, 5
    s_add_u32 s68, s68, s24
    v_lshrrev_b32 v2, 4, v176
    v_lshlrev_b32 v2, 10, v2
    v_and_b32 v3, 15, v176
    v_lshl_add_u32 v2, v3, 1, v2
    v_add_u32 v2, s68, v2
    v_add_u32 v3, 8192, v2
    v_mov_b32 v4, 0
    v_mov_b32 v5, 0
    v_mov_b32 v6, 0
    v_mov_b32 v7, 0
    global_load_ushort v164, v2, s[66:67] offset:0
    global_load_short_d16_hi v4, v3, s[66:67] offset:0
    global_load_ushort v165, v2, s[66:67] offset:256
    global_load_short_d16_hi v5, v3, s[66:67] offset:256
    global_load_ushort v166, v2, s[66:67] offset:512
    global_load_short_d16_hi v6, v3, s[66:67] offset:512
    global_load_ushort v167, v2, s[66:67] offset:768
    global_load_short_d16_hi v7, v3, s[66:67] offset:768
    s_add_u32 s22, s22, 1
    s_waitcnt vmcnt(0)
    v_or_b32 v164, v164, v4
    v_or_b32 v165, v165, v5
    v_or_b32 v166, v166, v6
    v_or_b32 v167, v167, v7
    s_mul_i32 s24, s22, 3277
    s_lshr_b32 s24, s24, 16
    s_mul_i32 s68, s24, 20
    s_sub_u32 s68, s22, s68
    s_cmp_lt_u32 s68, 8
    s_cselect_b64 s[66:67], s[84:85], s[86:87]
    s_cselect_b32 s25, 0, 8
    s_sub_u32 s68, s68, s25
    s_and_b32 s25, s68, 1
    s_lshr_b32 s68, s68, 1
    s_lshl_b32 s68, s68, 14
    s_lshl_b32 s25, s25, 12
    s_add_u32 s68, s68, s25
    s_lshl_b32 s24, s24, 5
    s_add_u32 s68, s68, s24
    v_lshrrev_b32 v2, 4, v176
    v_lshlrev_b32 v2, 10, v2
    v_and_b32 v3, 15, v176
    v_lshl_add_u32 v2, v3, 1, v2
    v_add_u32 v2, s68, v2
    v_add_u32 v3, 8192, v2
    v_mov_b32 v4, 0
    v_mov_b32 v5, 0
    v_mov_b32 v6, 0
    v_mov_b32 v7, 0
    global_load_ushort v104, v2, s[66:67] offset:0
    global_load_short_d16_hi v4, v3, s[66:67] offset:0
    global_load_ushort v105, v2, s[66:67] offset:256
    global_load_short_d16_hi v5, v3, s[66:67] offset:256
    global_load_ushort v106, v2, s[66:67] offset:512
    global_load_short_d16_hi v6, v3, s[66:67] offset:512
    global_load_ushort v107, v2, s[66:67] offset:768
    global_load_short_d16_hi v7, v3, s[66:67] offset:768
    s_add_u32 s22, s22, 1
    s_waitcnt vmcnt(0)
    v_or_b32 v104, v104, v4
    v_or_b32 v105, v105, v5
    v_or_b32 v106, v106, v6
    v_or_b32 v107, v107, v7
    s_mul_i32 s24, s22, 3277
    s_lshr_b32 s24, s24, 16
    s_mul_i32 s68, s24, 20
    s_sub_u32 s68, s22, s68
    s_cmp_lt_u32 s68, 8
    s_cselect_b64 s[66:67], s[84:85], s[86:87]
    s_cselect_b32 s25, 0, 8
    s_sub_u32 s68, s68, s25
    s_and_b32 s25, s68, 1
    s_lshr_b32 s68, s68, 1
    s_lshl_b32 s68, s68, 14
    s_lshl_b32 s25, s25, 12
    s_add_u32 s68, s68, s25
    s_lshl_b32 s24, s24, 5
    s_add_u32 s68, s68, s24
    v_lshrrev_b32 v2, 4, v176
    v_lshlrev_b32 v2, 10, v2
    v_and_b32 v3, 15, v176
    v_lshl_add_u32 v2, v3, 1, v2
    v_add_u32 v2, s68, v2
    v_add_u32 v3, 8192, v2
    v_mov_b32 v4, 0
    v_mov_b32 v5, 0
    v_mov_b32 v6, 0
    v_mov_b32 v7, 0
    global_load_ushort v108, v2, s[66:67] offset:0
    global_load_short_d16_hi v4, v3, s[66:67] offset:0
    global_load_ushort v109, v2, s[66:67] offset:256
    global_load_short_d16_hi v5, v3, s[66:67] offset:256
    global_load_ushort v110, v2, s[66:67] offset:512
    global_load_short_d16_hi v6, v3, s[66:67] offset:512
    global_load_ushort v111, v2, s[66:67] offset:768
    global_load_short_d16_hi v7, v3, s[66:67] offset:768
    s_add_u32 s22, s22, 1
    s_waitcnt vmcnt(0)
    v_or_b32 v108, v108, v4
    v_or_b32 v109, v109, v5
    v_or_b32 v110, v110, v6
    v_or_b32 v111, v111, v7
    s_mul_i32 s24, s22, 3277
    s_lshr_b32 s24, s24, 16
    s_mul_i32 s68, s24, 20
    s_sub_u32 s68, s22, s68
    s_cmp_lt_u32 s68, 8
    s_cselect_b64 s[66:67], s[84:85], s[86:87]
    s_cselect_b32 s25, 0, 8
    s_sub_u32 s68, s68, s25
    s_and_b32 s25, s68, 1
    s_lshr_b32 s68, s68, 1
    s_lshl_b32 s68, s68, 14
    s_lshl_b32 s25, s25, 12
    s_add_u32 s68, s68, s25
    s_lshl_b32 s24, s24, 5
    s_add_u32 s68, s68, s24
    v_lshrrev_b32 v2, 4, v176
    v_lshlrev_b32 v2, 10, v2
    v_and_b32 v3, 15, v176
    v_lshl_add_u32 v2, v3, 1, v2
    v_add_u32 v2, s68, v2
    v_add_u32 v3, 8192, v2
    v_mov_b32 v4, 0
    v_mov_b32 v5, 0
    v_mov_b32 v6, 0
    v_mov_b32 v7, 0
    global_load_ushort v120, v2, s[66:67] offset:0
    global_load_short_d16_hi v4, v3, s[66:67] offset:0
    global_load_ushort v121, v2, s[66:67] offset:256
    global_load_short_d16_hi v5, v3, s[66:67] offset:256
    global_load_ushort v122, v2, s[66:67] offset:512
    global_load_short_d16_hi v6, v3, s[66:67] offset:512
    global_load_ushort v123, v2, s[66:67] offset:768
    global_load_short_d16_hi v7, v3, s[66:67] offset:768
    s_add_u32 s22, s22, 1
    s_waitcnt vmcnt(0)
    v_or_b32 v120, v120, v4
    v_or_b32 v121, v121, v5
    v_or_b32 v122, v122, v6
    v_or_b32 v123, v123, v7
    s_mul_i32 s24, s22, 3277
    s_lshr_b32 s24, s24, 16
    s_mul_i32 s68, s24, 20
    s_sub_u32 s68, s22, s68
    s_cmp_lt_u32 s68, 8
    s_cselect_b64 s[66:67], s[84:85], s[86:87]
    s_cselect_b32 s25, 0, 8
    s_sub_u32 s68, s68, s25
    s_and_b32 s25, s68, 1
    s_lshr_b32 s68, s68, 1
    s_lshl_b32 s68, s68, 14
    s_lshl_b32 s25, s25, 12
    s_add_u32 s68, s68, s25
    s_lshl_b32 s24, s24, 5
    s_add_u32 s68, s68, s24
    v_lshrrev_b32 v2, 4, v176
    v_lshlrev_b32 v2, 10, v2
    v_and_b32 v3, 15, v176
    v_lshl_add_u32 v2, v3, 1, v2
    v_add_u32 v2, s68, v2
    v_add_u32 v3, 8192, v2
    v_mov_b32 v4, 0
    v_mov_b32 v5, 0
    v_mov_b32 v6, 0
    v_mov_b32 v7, 0
    global_load_ushort v124, v2, s[66:67] offset:0
    global_load_short_d16_hi v4, v3, s[66:67] offset:0
    global_load_ushort v125, v2, s[66:67] offset:256
    global_load_short_d16_hi v5, v3, s[66:67] offset:256
    global_load_ushort v126, v2, s[66:67] offset:512
    global_load_short_d16_hi v6, v3, s[66:67] offset:512
    global_load_ushort v127, v2, s[66:67] offset:768
    global_load_short_d16_hi v7, v3, s[66:67] offset:768
    s_add_u32 s22, s22, 1
    s_waitcnt vmcnt(0)
    v_or_b32 v124, v124, v4
    v_or_b32 v125, v125, v5
    v_or_b32 v126, v126, v6
    v_or_b32 v127, v127, v7
    s_mul_i32 s24, s22, 3277
    s_lshr_b32 s24, s24, 16
    s_mul_i32 s68, s24, 20
    s_sub_u32 s68, s22, s68
    s_cmp_lt_u32 s68, 8
    s_cselect_b64 s[66:67], s[84:85], s[86:87]
    s_cselect_b32 s25, 0, 8
    s_sub_u32 s68, s68, s25
    s_and_b32 s25, s68, 1
    s_lshr_b32 s68, s68, 1
    s_lshl_b32 s68, s68, 14
    s_lshl_b32 s25, s25, 12
    s_add_u32 s68, s68, s25
    s_lshl_b32 s24, s24, 5
    s_add_u32 s68, s68, s24
    v_lshrrev_b32 v2, 4, v176
    v_lshlrev_b32 v2, 10, v2
    v_and_b32 v3, 15, v176
    v_lshl_add_u32 v2, v3, 1, v2
    v_add_u32 v2, s68, v2
    v_add_u32 v3, 8192, v2
    v_mov_b32 v4, 0
    v_mov_b32 v5, 0
    v_mov_b32 v6, 0
    v_mov_b32 v7, 0
    global_load_ushort v128, v2, s[66:67] offset:0
    global_load_short_d16_hi v4, v3, s[66:67] offset:0
    global_load_ushort v129, v2, s[66:67] offset:256
    global_load_short_d16_hi v5, v3, s[66:67] offset:256
    global_load_ushort v130, v2, s[66:67] offset:512
    global_load_short_d16_hi v6, v3, s[66:67] offset:512
    global_load_ushort v131, v2, s[66:67] offset:768
    global_load_short_d16_hi v7, v3, s[66:67] offset:768
    s_add_u32 s22, s22, 1
    s_waitcnt vmcnt(0)
    v_or_b32 v128, v128, v4
    v_or_b32 v129, v129, v5
    v_or_b32 v130, v130, v6
    v_or_b32 v131, v131, v7
    s_mul_i32 s24, s22, 3277
    s_lshr_b32 s24, s24, 16
    s_mul_i32 s68, s24, 20
    s_sub_u32 s68, s22, s68
    s_cmp_lt_u32 s68, 8
    s_cselect_b64 s[66:67], s[84:85], s[86:87]
    s_cselect_b32 s25, 0, 8
    s_sub_u32 s68, s68, s25
    s_and_b32 s25, s68, 1
    s_lshr_b32 s68, s68, 1
    s_lshl_b32 s68, s68, 14
    s_lshl_b32 s25, s25, 12
    s_add_u32 s68, s68, s25
    s_lshl_b32 s24, s24, 5
    s_add_u32 s68, s68, s24
    v_lshrrev_b32 v2, 4, v176
    v_lshlrev_b32 v2, 10, v2
    v_and_b32 v3, 15, v176
    v_lshl_add_u32 v2, v3, 1, v2
    v_add_u32 v2, s68, v2
    v_add_u32 v3, 8192, v2
    v_mov_b32 v4, 0
    v_mov_b32 v5, 0
    v_mov_b32 v6, 0
    v_mov_b32 v7, 0
    global_load_ushort v132, v2, s[66:67] offset:0
    global_load_short_d16_hi v4, v3, s[66:67] offset:0
    global_load_ushort v133, v2, s[66:67] offset:256
    global_load_short_d16_hi v5, v3, s[66:67] offset:256
    global_load_ushort v134, v2, s[66:67] offset:512
    global_load_short_d16_hi v6, v3, s[66:67] offset:512
    global_load_ushort v135, v2, s[66:67] offset:768
    global_load_short_d16_hi v7, v3, s[66:67] offset:768
    s_add_u32 s22, s22, 1
    s_waitcnt vmcnt(0)
    v_or_b32 v132, v132, v4
    v_or_b32 v133, v133, v5
    v_or_b32 v134, v134, v6
    v_or_b32 v135, v135, v7
    s_mul_i32 s24, s22, 3277
    s_lshr_b32 s24, s24, 16
    s_mul_i32 s68, s24, 20
    s_sub_u32 s68, s22, s68
    s_cmp_lt_u32 s68, 8
    s_cselect_b64 s[66:67], s[84:85], s[86:87]
    s_cselect_b32 s25, 0, 8
    s_sub_u32 s68, s68, s25
    s_and_b32 s25, s68, 1
    s_lshr_b32 s68, s68, 1
    s_lshl_b32 s68, s68, 14
    s_lshl_b32 s25, s25, 12
    s_add_u32 s68, s68, s25
    s_lshl_b32 s24, s24, 5
    s_add_u32 s68, s68, s24
    v_lshrrev_b32 v2, 4, v176
    v_lshlrev_b32 v2, 10, v2
    v_and_b32 v3, 15, v176
    v_lshl_add_u32 v2, v3, 1, v2
    v_add_u32 v2, s68, v2
    v_add_u32 v3, 8192, v2
    v_mov_b32 v4, 0
    v_mov_b32 v5, 0
    v_mov_b32 v6, 0
    v_mov_b32 v7, 0
    global_load_ushort v152, v2, s[66:67] offset:0
    global_load_short_d16_hi v4, v3, s[66:67] offset:0
    global_load_ushort v153, v2, s[66:67] offset:256
    global_load_short_d16_hi v5, v3, s[66:67] offset:256
    global_load_ushort v154, v2, s[66:67] offset:512
    global_load_short_d16_hi v6, v3, s[66:67] offset:512
    global_load_ushort v155, v2, s[66:67] offset:768
    global_load_short_d16_hi v7, v3, s[66:67] offset:768
    s_add_u32 s22, s22, 1
    s_waitcnt vmcnt(0)
    v_or_b32 v152, v152, v4
    v_or_b32 v153, v153, v5
    v_or_b32 v154, v154, v6
    v_or_b32 v155, v155, v7
    s_mul_i32 s24, s22, 3277
    s_lshr_b32 s24, s24, 16
    s_mul_i32 s68, s24, 20
    s_sub_u32 s68, s22, s68
    s_cmp_lt_u32 s68, 8
    s_cselect_b64 s[66:67], s[84:85], s[86:87]
    s_cselect_b32 s25, 0, 8
    s_sub_u32 s68, s68, s25
    s_and_b32 s25, s68, 1
    s_lshr_b32 s68, s68, 1
    s_lshl_b32 s68, s68, 14
    s_lshl_b32 s25, s25, 12
    s_add_u32 s68, s68, s25
    s_lshl_b32 s24, s24, 5
    s_add_u32 s68, s68, s24
    v_lshrrev_b32 v2, 4, v176
    v_lshlrev_b32 v2, 10, v2
    v_and_b32 v3, 15, v176
    v_lshl_add_u32 v2, v3, 1, v2
    v_add_u32 v2, s68, v2
    v_add_u32 v3, 8192, v2
    v_mov_b32 v4, 0
    v_mov_b32 v5, 0
    v_mov_b32 v6, 0
    v_mov_b32 v7, 0
    global_load_ushort v156, v2, s[66:67] offset:0
    global_load_short_d16_hi v4, v3, s[66:67] offset:0
    global_load_ushort v157, v2, s[66:67] offset:256
    global_load_short_d16_hi v5, v3, s[66:67] offset:256
    global_load_ushort v158, v2, s[66:67] offset:512
    global_load_short_d16_hi v6, v3, s[66:67] offset:512
    global_load_ushort v159, v2, s[66:67] offset:768
    global_load_short_d16_hi v7, v3, s[66:67] offset:768
    s_add_u32 s22, s22, 1
    s_waitcnt vmcnt(0)
    v_or_b32 v156, v156, v4
    v_or_b32 v157, v157, v5
    v_or_b32 v158, v158, v6
    v_or_b32 v159, v159, v7
    s_mul_i32 s24, s22, 3277
    s_lshr_b32 s24, s24, 16
    s_mul_i32 s68, s24, 20
    s_sub_u32 s68, s22, s68
    s_cmp_lt_u32 s68, 8
    s_cselect_b64 s[66:67], s[84:85], s[86:87]
    s_cselect_b32 s25, 0, 8
    s_sub_u32 s68, s68, s25
    s_and_b32 s25, s68, 1
    s_lshr_b32 s68, s68, 1
    s_lshl_b32 s68, s68, 14
    s_lshl_b32 s25, s25, 12
    s_add_u32 s68, s68, s25
    s_lshl_b32 s24, s24, 5
    s_add_u32 s68, s68, s24
    v_lshrrev_b32 v2, 4, v176
    v_lshlrev_b32 v2, 10, v2
    v_and_b32 v3, 15, v176
    v_lshl_add_u32 v2, v3, 1, v2
    v_add_u32 v2, s68, v2
    v_add_u32 v3, 8192, v2
    v_mov_b32 v4, 0
    v_mov_b32 v5, 0
    v_mov_b32 v6, 0
    v_mov_b32 v7, 0
    global_load_ushort v136, v2, s[66:67] offset:0
    global_load_short_d16_hi v4, v3, s[66:67] offset:0
    global_load_ushort v137, v2, s[66:67] offset:256
    global_load_short_d16_hi v5, v3, s[66:67] offset:256
    global_load_ushort v138, v2, s[66:67] offset:512
    global_load_short_d16_hi v6, v3, s[66:67] offset:512
    global_load_ushort v139, v2, s[66:67] offset:768
    global_load_short_d16_hi v7, v3, s[66:67] offset:768
    s_add_u32 s22, s22, 1
    s_waitcnt vmcnt(0)
    v_or_b32 v136, v136, v4
    v_or_b32 v137, v137, v5
    v_or_b32 v138, v138, v6
    v_or_b32 v139, v139, v7
    s_mul_i32 s24, s22, 3277
    s_lshr_b32 s24, s24, 16
    s_mul_i32 s68, s24, 20
    s_sub_u32 s68, s22, s68
    s_cmp_lt_u32 s68, 8
    s_cselect_b64 s[66:67], s[84:85], s[86:87]
    s_cselect_b32 s25, 0, 8
    s_sub_u32 s68, s68, s25
    s_and_b32 s25, s68, 1
    s_lshr_b32 s68, s68, 1
    s_lshl_b32 s68, s68, 14
    s_lshl_b32 s25, s25, 12
    s_add_u32 s68, s68, s25
    s_lshl_b32 s24, s24, 5
    s_add_u32 s68, s68, s24
    v_lshrrev_b32 v2, 4, v176
    v_lshlrev_b32 v2, 10, v2
    v_and_b32 v3, 15, v176
    v_lshl_add_u32 v2, v3, 1, v2
    v_add_u32 v2, s68, v2
    v_add_u32 v3, 8192, v2
    v_mov_b32 v4, 0
    v_mov_b32 v5, 0
    v_mov_b32 v6, 0
    v_mov_b32 v7, 0
    global_load_ushort v140, v2, s[66:67] offset:0
    global_load_short_d16_hi v4, v3, s[66:67] offset:0
    global_load_ushort v141, v2, s[66:67] offset:256
    global_load_short_d16_hi v5, v3, s[66:67] offset:256
    global_load_ushort v142, v2, s[66:67] offset:512
    global_load_short_d16_hi v6, v3, s[66:67] offset:512
    global_load_ushort v143, v2, s[66:67] offset:768
    global_load_short_d16_hi v7, v3, s[66:67] offset:768
    s_add_u32 s22, s22, 1
    s_waitcnt vmcnt(0)
    v_or_b32 v140, v140, v4
    v_or_b32 v141, v141, v5
    v_or_b32 v142, v142, v6
    v_or_b32 v143, v143, v7
    s_mul_i32 s24, s22, 3277
    s_lshr_b32 s24, s24, 16
    s_mul_i32 s68, s24, 20
    s_sub_u32 s68, s22, s68
    s_cmp_lt_u32 s68, 8
    s_cselect_b64 s[66:67], s[84:85], s[86:87]
    s_cselect_b32 s25, 0, 8
    s_sub_u32 s68, s68, s25
    s_and_b32 s25, s68, 1
    s_lshr_b32 s68, s68, 1
    s_lshl_b32 s68, s68, 14
    s_lshl_b32 s25, s25, 12
    s_add_u32 s68, s68, s25
    s_lshl_b32 s24, s24, 5
    s_add_u32 s68, s68, s24
    v_lshrrev_b32 v2, 4, v176
    v_lshlrev_b32 v2, 10, v2
    v_and_b32 v3, 15, v176
    v_lshl_add_u32 v2, v3, 1, v2
    v_add_u32 v2, s68, v2
    v_add_u32 v3, 8192, v2
    v_mov_b32 v4, 0
    v_mov_b32 v5, 0
    v_mov_b32 v6, 0
    v_mov_b32 v7, 0
    global_load_ushort v168, v2, s[66:67] offset:0
    global_load_short_d16_hi v4, v3, s[66:67] offset:0
    global_load_ushort v169, v2, s[66:67] offset:256
    global_load_short_d16_hi v5, v3, s[66:67] offset:256
    global_load_ushort v170, v2, s[66:67] offset:512
    global_load_short_d16_hi v6, v3, s[66:67] offset:512
    global_load_ushort v171, v2, s[66:67] offset:768
    global_load_short_d16_hi v7, v3, s[66:67] offset:768
    s_add_u32 s22, s22, 1
    s_waitcnt vmcnt(0)
    v_or_b32 v168, v168, v4
    v_or_b32 v169, v169, v5
    v_or_b32 v170, v170, v6
    v_or_b32 v171, v171, v7
    s_mul_i32 s24, s22, 3277
    s_lshr_b32 s24, s24, 16
    s_mul_i32 s68, s24, 20
    s_sub_u32 s68, s22, s68
    s_cmp_lt_u32 s68, 8
    s_cselect_b64 s[66:67], s[84:85], s[86:87]
    s_cselect_b32 s25, 0, 8
    s_sub_u32 s68, s68, s25
    s_and_b32 s25, s68, 1
    s_lshr_b32 s68, s68, 1
    s_lshl_b32 s68, s68, 14
    s_lshl_b32 s25, s25, 12
    s_add_u32 s68, s68, s25
    s_lshl_b32 s24, s24, 5
    s_add_u32 s68, s68, s24
    v_lshrrev_b32 v2, 4, v176
    v_lshlrev_b32 v2, 10, v2
    v_and_b32 v3, 15, v176
    v_lshl_add_u32 v2, v3, 1, v2
    v_add_u32 v2, s68, v2
    v_add_u32 v3, 8192, v2
    v_mov_b32 v4, 0
    v_mov_b32 v5, 0
    v_mov_b32 v6, 0
    v_mov_b32 v7, 0
    global_load_ushort v172, v2, s[66:67] offset:0
    global_load_short_d16_hi v4, v3, s[66:67] offset:0
    global_load_ushort v173, v2, s[66:67] offset:256
    global_load_short_d16_hi v5, v3, s[66:67] offset:256
    global_load_ushort v174, v2, s[66:67] offset:512
    global_load_short_d16_hi v6, v3, s[66:67] offset:512
    global_load_ushort v175, v2, s[66:67] offset:768
    global_load_short_d16_hi v7, v3, s[66:67] offset:768
    s_add_u32 s22, s22, 1
    s_waitcnt vmcnt(0)
    v_or_b32 v172, v172, v4
    v_or_b32 v173, v173, v5
    v_or_b32 v174, v174, v6
    v_or_b32 v175, v175, v7
    s_mul_i32 s24, s22, 3277
    s_lshr_b32 s24, s24, 16
    s_mul_i32 s68, s24, 20
    s_sub_u32 s68, s22, s68
    s_cmp_lt_u32 s68, 8
    s_cselect_b64 s[66:67], s[84:85], s[86:87]
    s_cselect_b32 s25, 0, 8
    s_sub_u32 s68, s68, s25
    s_and_b32 s25, s68, 1
    s_lshr_b32 s68, s68, 1
    s_lshl_b32 s68, s68, 14
    s_lshl_b32 s25, s25, 12
    s_add_u32 s68, s68, s25
    s_lshl_b32 s24, s24, 5
    s_add_u32 s68, s68, s24
    v_lshrrev_b32 v2, 4, v176
    v_lshlrev_b32 v2, 10, v2
    v_and_b32 v3, 15, v176
    v_lshl_add_u32 v2, v3, 1, v2
    v_add_u32 v2, s68, v2
    v_add_u32 v3, 8192, v2
    v_mov_b32 v4, 0
    v_mov_b32 v5, 0
    v_mov_b32 v6, 0
    v_mov_b32 v7, 0
    global_load_ushort v112, v2, s[66:67] offset:0
    global_load_short_d16_hi v4, v3, s[66:67] offset:0
    global_load_ushort v113, v2, s[66:67] offset:256
    global_load_short_d16_hi v5, v3, s[66:67] offset:256
    global_load_ushort v114, v2, s[66:67] offset:512
    global_load_short_d16_hi v6, v3, s[66:67] offset:512
    global_load_ushort v115, v2, s[66:67] offset:768
    global_load_short_d16_hi v7, v3, s[66:67] offset:768
    s_add_u32 s22, s22, 1
    s_waitcnt vmcnt(0)
    v_or_b32 v112, v112, v4
    v_or_b32 v113, v113, v5
    v_or_b32 v114, v114, v6
    v_or_b32 v115, v115, v7
    s_mul_i32 s24, s22, 3277
    s_lshr_b32 s24, s24, 16
    s_mul_i32 s68, s24, 20
    s_sub_u32 s68, s22, s68
    s_cmp_lt_u32 s68, 8
    s_cselect_b64 s[66:67], s[84:85], s[86:87]
    s_cselect_b32 s25, 0, 8
    s_sub_u32 s68, s68, s25
    s_and_b32 s25, s68, 1
    s_lshr_b32 s68, s68, 1
    s_lshl_b32 s68, s68, 14
    s_lshl_b32 s25, s25, 12
    s_add_u32 s68, s68, s25
    s_lshl_b32 s24, s24, 5
    s_add_u32 s68, s68, s24
    v_lshrrev_b32 v2, 4, v176
    v_lshlrev_b32 v2, 10, v2
    v_and_b32 v3, 15, v176
    v_lshl_add_u32 v2, v3, 1, v2
    v_add_u32 v2, s68, v2
    v_add_u32 v3, 8192, v2
    v_mov_b32 v4, 0
    v_mov_b32 v5, 0
    v_mov_b32 v6, 0
    v_mov_b32 v7, 0
    global_load_ushort v116, v2, s[66:67] offset:0
    global_load_short_d16_hi v4, v3, s[66:67] offset:0
    global_load_ushort v117, v2, s[66:67] offset:256
    global_load_short_d16_hi v5, v3, s[66:67] offset:256
    global_load_ushort v118, v2, s[66:67] offset:512
    global_load_short_d16_hi v6, v3, s[66:67] offset:512
    global_load_ushort v119, v2, s[66:67] offset:768
    global_load_short_d16_hi v7, v3, s[66:67] offset:768
    s_add_u32 s22, s22, 1
    s_waitcnt vmcnt(0)
    v_or_b32 v116, v116, v4
    v_or_b32 v117, v117, v5
    v_or_b32 v118, v118, v6
    v_or_b32 v119, v119, v7
    s_load_dwordx2 s[72:73], s[0:1], 72
    v_lshlrev_b32 v246, 4, v176
    s_mov_b32 s52, 163072
    v_bfe_u32 v177, v246, 4, 4
    v_bfe_u32 v179, v246, 4, 3
    v_lshl_add_u32 v180, v177, 3, s52
    v_lshl_add_u32 v190, v177, 4, s52
    v_lshl_add_u32 v181, v179, 3, s52
    ds_read2_b64 v[182:185], v180 offset0:32 offset1:48
    ds_read_b32 v191, v190
    ds_read_b64 v[186:187], v181 offset:512
    v_lshrrev_b32 v178, 8, v246
    s_add_u32 s22, s20, 0
    s_mul_i32 s28, s22, 1536
    s_add_u32 s28, s28, 86016
    s_lshl_b32 s22, s22, 21
    s_add_u32 s23, s20, 8
    s_mul_i32 s29, s23, 1536
    s_add_u32 s29, s29, 86144
    s_lshl_b32 s23, s23, 21
    s_add_u32 s24, s20, 16
    s_mul_i32 s30, s24, 1536
    s_add_u32 s30, s30, 86016
    s_lshl_b32 s24, s24, 21
    s_add_u32 s25, s20, 24
    s_lshl_b32 s25, s25, 21
    s_add_u32 s26, s20, 32
    s_lshl_b32 s26, s26, 21
    s_mov_b32 s53, 0
    s_mov_b32 s50, 0
    s_waitcnt lgkmcnt(0)
    s_branch GEMM
.section .rodata,"a"
.p2align 6
.amdhsa_kernel standalone__tensor_product_equiv_equiformer__graph_kernel
  .amdhsa_next_free_vgpr 256
  .amdhsa_next_free_sgpr 90
  .amdhsa_accum_offset 256
  .amdhsa_group_segment_fixed_size 0
  .amdhsa_kernarg_size 96
  .amdhsa_user_sgpr_count 2
  .amdhsa_user_sgpr_kernarg_segment_ptr 1
  .amdhsa_system_sgpr_workgroup_id_x 1
.end_amdhsa_kernel
```

```asm
; @launch grid=(250,1,1) block=(512,1,1) lds=163840
.amdgcn_target "amdgcn-amd-amdhsa--gfx950"
.text
.globl standalone__tensor_product_equiv_equiformer__graph_kernel
.p2align 8
.type standalone__tensor_product_equiv_equiformer__graph_kernel,@function
standalone__tensor_product_equiv_equiformer__graph_kernel:
    s_cmp_ge_u32 s2, 250
    s_cbranch_scc1 K2_end
    s_load_dwordx16 s[72:87], s[0:1], 0
    s_load_dwordx2 s[70:71], s[0:1], 88
    v_lshrrev_b32 v2, 6, v0
    v_and_b32 v1, 63, v0
    v_readfirstlane_b32 s20, v2
    s_getpc_b64 s[66:67]
    v_lshlrev_b32 v95, 7, v1
    s_cmp_eq_u32 s20, 6
    s_cbranch_scc0 F_nopf0
    global_load_dword v95, v95, s[66:67]
F_nopf0:
    s_mul_i32 s66, s2, 5120
    s_mul_i32 s67, s2, 7680
    v_lshl_add_u32 v3, v0, 4, s66
    v_mul_u32_u24 v4, 24, v0
    v_add_u32 v4, s67, v4
    v_lshlrev_b32 v5, 2, v0
    v_mov_b32 v89, 0
    v_add_u32 v6, 98304, v5
    ds_write_b32 v6, v89
    s_cmp_ge_u32 s20, 5
    s_waitcnt lgkmcnt(0)
    s_cbranch_scc1 F_noload
    global_load_dwordx4 v[8:11], v3, s[80:81] nt
    global_load_dwordx4 v[12:15], v3, s[78:79] nt
    global_load_dwordx4 v[16:19], v4, s[74:75] nt
    global_load_dwordx2 v[20:21], v4, s[74:75] offset:16 nt
F_noload:
    s_load_dword s88, s[70:71], 0
    s_barrier
    v_lshlrev_b32 v248, 2, v1
    v_add_u32 v88, 162816, v248
    ds_write_b32 v88, v89
    ds_write_b32 v88, v89 offset:256
    v_lshlrev_b32 v86, 4, v1
    s_lshl_b32 s21, s20, 13
    v_lshrrev_b32 v6, 5, v1
    v_mul_u32_u24 v6, 5120, v6
    v_and_b32 v7, 31, v1
    v_lshl_add_u32 v6, v7, 1, v6
    s_lshr_b32 s66, s20, 2
    s_lshl_b32 s66, s66, 7
    s_and_b32 s67, s20, 3
    s_mul_i32 s67, s67, 5
    s_add_u32 s68, s67, 0
    s_lshr_b32 s24, s68, 2
    s_lshl_b32 s24, s24, 8
    s_bfe_u32 s69, s68, 0x10001
    s_lshl_b32 s69, s69, 6
    s_add_u32 s24, s24, s69
    s_and_b32 s69, s68, 1
    s_mul_i32 s69, s69, 10240
    s_add_u32 s24, s24, s69
    s_add_u32 s24, s24, s66
    s_add_u32 s68, s67, 1
    s_lshr_b32 s25, s68, 2
    s_lshl_b32 s25, s25, 8
    s_bfe_u32 s69, s68, 0x10001
    s_lshl_b32 s69, s69, 6
    s_add_u32 s25, s25, s69
    s_and_b32 s69, s68, 1
    s_mul_i32 s69, s69, 10240
    s_add_u32 s25, s25, s69
    s_add_u32 s25, s25, s66
    s_add_u32 s68, s67, 2
    s_lshr_b32 s26, s68, 2
    s_lshl_b32 s26, s26, 8
    s_bfe_u32 s69, s68, 0x10001
    s_lshl_b32 s69, s69, 6
    s_add_u32 s26, s26, s69
    s_and_b32 s69, s68, 1
    s_mul_i32 s69, s69, 10240
    s_add_u32 s26, s26, s69
    s_add_u32 s26, s26, s66
    s_add_u32 s68, s67, 3
    s_lshr_b32 s27, s68, 2
    s_lshl_b32 s27, s27, 8
    s_bfe_u32 s69, s68, 0x10001
    s_lshl_b32 s69, s69, 6
    s_add_u32 s27, s27, s69
    s_and_b32 s69, s68, 1
    s_mul_i32 s69, s69, 10240
    s_add_u32 s27, s27, s69
    s_add_u32 s27, s27, s66
    s_add_u32 s68, s67, 4
    s_lshr_b32 s28, s68, 2
    s_lshl_b32 s28, s28, 8
    s_bfe_u32 s69, s68, 0x10001
    s_lshl_b32 s69, s69, 6
    s_add_u32 s28, s28, s69
    s_and_b32 s69, s68, 1
    s_mul_i32 s69, s69, 10240
    s_add_u32 s28, s28, s69
    s_add_u32 s28, s28, s66
    v_mov_b32 v96, 0
    v_mov_b32 v97, 0
    v_mov_b32 v98, 0
    v_mov_b32 v99, 0
    v_mov_b32 v100, 0
    v_mov_b32 v101, 0
    v_mov_b32 v102, 0
    v_mov_b32 v103, 0
    v_mov_b32 v104, 0
    v_mov_b32 v105, 0
    v_mov_b32 v106, 0
    v_mov_b32 v107, 0
    v_mov_b32 v108, 0
    v_mov_b32 v109, 0
    v_mov_b32 v110, 0
    v_mov_b32 v111, 0
    v_mov_b32 v112, 0
    v_mov_b32 v113, 0
    v_mov_b32 v114, 0
    v_mov_b32 v115, 0
    v_mov_b32 v180, 0
    v_mov_b32 v181, 0
    v_mov_b32 v182, 0
    v_mov_b32 v183, 0
    s_mov_b32 s16, s70
    s_and_b32 s17, s71, 0xffff
    s_mov_b32 s18, 24165888
    s_mov_b32 s19, 0x20000
    v_lshrrev_b32 v2, 3, v1
    v_lshl_add_u32 v2, s20, 5, v2
    v_and_b32 v91, 7, v1
    v_mul_u32_u24 v94, 384, v2
    v_lshl_add_u32 v94, v91, 4, v94
    v_lshlrev_b32 v93, 2, v2
    v_add_u32 v93, 98304, v93
    v_mul_u32_u24 v92, 32000, v2
    v_lshl_add_u32 v92, v91, 4, v92
    v_mul_u32_u24 v90, 40960, v2
    s_mov_b32 s32, s82
    s_and_b32 s33, s83, 0xffff
    s_mov_b32 s34, 20480
    s_mov_b32 s35, 0x20000
    s_cmp_ge_u32 s20, 5
    s_cbranch_scc1 F_helper
    s_mov_b32 s22, 52429
    s_mov_b32 s23, 0x05040100
    s_mov_b32 s66, 98304
    s_movk_i32 s67, -40
    v_mov_b32 v7, 1
    v_add_u32 v31, 1, v5
    v_add_u32 v32, 2, v5
    v_add_u32 v33, 3, v5
    s_waitcnt vmcnt(3)
    v_mul_u32_u24 v22, s22, v8
    v_mul_u32_u24 v23, s22, v9
    v_mul_u32_u24 v24, s22, v10
    v_mul_u32_u24 v25, s22, v11
    v_lshrrev_b32 v22, 21, v22
    v_lshrrev_b32 v23, 21, v23
    v_lshrrev_b32 v24, 21, v24
    v_lshrrev_b32 v25, 21, v25
    v_lshl_add_u32 v34, v22, 2, s66
    ds_add_rtn_u32 v26, v34, v7
    v_lshl_add_u32 v35, v23, 2, s66
    ds_add_rtn_u32 v27, v35, v7
    v_lshl_add_u32 v36, v24, 2, s66
    ds_add_rtn_u32 v28, v36, v7
    v_lshl_add_u32 v37, v25, 2, s66
    ds_add_rtn_u32 v29, v37, v7
    buffer_load_short_d16_hi v96, v6, s[32:35], s24 offen offset:0
    buffer_load_short_d16_hi v97, v6, s[32:35], s24 offen offset:1280
    buffer_load_short_d16_hi v98, v6, s[32:35], s24 offen offset:2560
    buffer_load_short_d16_hi v99, v6, s[32:35], s24 offen offset:3840
    buffer_load_short_d16_hi v100, v6, s[32:35], s25 offen offset:0
    buffer_load_short_d16_hi v101, v6, s[32:35], s25 offen offset:1280
    buffer_load_short_d16_hi v102, v6, s[32:35], s25 offen offset:2560
    buffer_load_short_d16_hi v103, v6, s[32:35], s25 offen offset:3840
    buffer_load_short_d16_hi v104, v6, s[32:35], s26 offen offset:0
    buffer_load_short_d16_hi v105, v6, s[32:35], s26 offen offset:1280
    buffer_load_short_d16_hi v106, v6, s[32:35], s26 offen offset:2560
    buffer_load_short_d16_hi v107, v6, s[32:35], s26 offen offset:3840
    buffer_load_short_d16_hi v108, v6, s[32:35], s27 offen offset:0
    buffer_load_short_d16_hi v109, v6, s[32:35], s27 offen offset:1280
    buffer_load_short_d16_hi v110, v6, s[32:35], s27 offen offset:2560
    buffer_load_short_d16_hi v111, v6, s[32:35], s27 offen offset:3840
    buffer_load_short_d16_hi v112, v6, s[32:35], s28 offen offset:0
    buffer_load_short_d16_hi v113, v6, s[32:35], s28 offen offset:1280
    buffer_load_short_d16_hi v114, v6, s[32:35], s28 offen offset:2560
    buffer_load_short_d16_hi v115, v6, s[32:35], s28 offen offset:3840
    v_mad_i32_i24 v2, v22, s67, v8
    v_mul_u32_u24 v22, 384, v22
    v_lshl_or_b32 v42, v2, 11, v5
    v_mad_i32_i24 v2, v23, s67, v9
    v_mul_u32_u24 v23, 384, v23
    v_lshl_or_b32 v46, v2, 11, v31
    v_mad_i32_i24 v2, v24, s67, v10
    v_mul_u32_u24 v24, 384, v24
    v_lshl_or_b32 v50, v2, 11, v32
    v_mad_i32_i24 v2, v25, s67, v11
    v_mul_u32_u24 v25, 384, v25
    v_lshl_or_b32 v54, v2, 11, v33
    s_waitcnt vmcnt(20)
    v_mov_b32 v40, v16
    v_perm_b32 v41, v12, v17, s23
    v_alignbit_b32 v44, v18, v17, 16
    v_alignbit_b32 v45, v13, v18, 16
    v_mov_b32 v48, v19
    v_perm_b32 v49, v14, v20, s23
    v_alignbit_b32 v52, v21, v20, 16
    v_alignbit_b32 v53, v15, v21, 16
    v_xor_b32 v41, 0x8000, v41
    v_xor_b32 v45, 0x8000, v45
    v_xor_b32 v49, 0x8000, v49
    v_xor_b32 v53, 0x8000, v53
    s_waitcnt lgkmcnt(0)
    v_min_u32 v26, 23, v26
    v_lshl_add_u32 v34, v26, 4, v22
    ds_write_b128 v34, v[40:43]
    v_min_u32 v27, 23, v27
    v_lshl_add_u32 v35, v27, 4, v23
    ds_write_b128 v35, v[44:47]
    v_min_u32 v28, 23, v28
    v_lshl_add_u32 v36, v28, 4, v24
    ds_write_b128 v36, v[48:51]
    v_min_u32 v29, 23, v29
    v_lshl_add_u32 v37, v29, 4, v25
    ds_write_b128 v37, v[52:55]
    s_branch F_staged
F_helper:
    buffer_load_short_d16_hi v96, v6, s[32:35], s24 offen offset:0
    buffer_load_short_d16_hi v97, v6, s[32:35], s24 offen offset:1280
    buffer_load_short_d16_hi v98, v6, s[32:35], s24 offen offset:2560
    buffer_load_short_d16_hi v99, v6, s[32:35], s24 offen offset:3840
    buffer_load_short_d16_hi v100, v6, s[32:35], s25 offen offset:0
    buffer_load_short_d16_hi v101, v6, s[32:35], s25 offen offset:1280
    buffer_load_short_d16_hi v102, v6, s[32:35], s25 offen offset:2560
    buffer_load_short_d16_hi v103, v6, s[32:35], s25 offen offset:3840
    buffer_load_short_d16_hi v104, v6, s[32:35], s26 offen offset:0
    buffer_load_short_d16_hi v105, v6, s[32:35], s26 offen offset:1280
    buffer_load_short_d16_hi v106, v6, s[32:35], s26 offen offset:2560
    buffer_load_short_d16_hi v107, v6, s[32:35], s26 offen offset:3840
    buffer_load_short_d16_hi v108, v6, s[32:35], s27 offen offset:0
    buffer_load_short_d16_hi v109, v6, s[32:35], s27 offen offset:1280
    buffer_load_short_d16_hi v110, v6, s[32:35], s27 offen offset:2560
    buffer_load_short_d16_hi v111, v6, s[32:35], s27 offen offset:3840
    buffer_load_short_d16_hi v112, v6, s[32:35], s28 offen offset:0
    buffer_load_short_d16_hi v113, v6, s[32:35], s28 offen offset:1280
    buffer_load_short_d16_hi v114, v6, s[32:35], s28 offen offset:2560
    buffer_load_short_d16_hi v115, v6, s[32:35], s28 offen offset:3840
    s_cmp_eq_u32 s20, 6
    s_cbranch_scc0 F_nopf
    s_getpc_b64 s[66:67]
F_pc:
    s_lshr_b32 s68, s2, 3
    s_mul_i32 s68, s68, ((K2_last-F_pc)/128/31+1)*128
    v_lshl_add_u32 v2, v1, 7, s68
    v_min_u32 v2, K2_last-F_pc-4, v2
    v_cmp_gt_u32 vcc, (K2_last-F_pc)/128/31+1, v1
    s_mov_b64 exec, vcc
    global_load_dword v95, v2, s[66:67]
    s_mov_b64 exec, -1
F_nopf:
    s_cmp_eq_u32 s20, 7
    s_cbranch_scc0 F_staged
    s_cmp_lt_u32 s2, 160
    s_cbranch_scc0 F_staged
    s_mul_i32 s22, s2, 3277
    s_lshr_b32 s22, s22, 16
    s_mul_i32 s68, s22, 20
    s_sub_u32 s68, s2, s68
    s_cmp_lt_u32 s68, 8
    s_cselect_b64 s[66:67], s[84:85], s[86:87]
    s_cselect_b32 s23, 0, 8
    s_sub_u32 s68, s68, s23
    s_and_b32 s23, s68, 1
    s_lshr_b32 s68, s68, 1
    s_lshl_b32 s68, s68, 14
    s_lshl_b32 s23, s23, 12
    s_add_u32 s68, s68, s23
    s_lshl_b32 s22, s22, 5
    s_add_u32 s68, s68, s22
    v_lshrrev_b32 v2, 4, v1
    v_lshlrev_b32 v2, 10, v2
    v_and_b32 v3, 15, v1
    v_lshl_add_u32 v2, v3, 1, v2
    v_add_u32 v2, s68, v2
    v_add_u32 v3, 8192, v2
    global_load_ushort v176, v2, s[66:67] offset:0
    global_load_short_d16_hi v180, v3, s[66:67] offset:0
    global_load_ushort v177, v2, s[66:67] offset:256
    global_load_short_d16_hi v181, v3, s[66:67] offset:256
    global_load_ushort v178, v2, s[66:67] offset:512
    global_load_short_d16_hi v182, v3, s[66:67] offset:512
    global_load_ushort v179, v2, s[66:67] offset:768
    global_load_short_d16_hi v183, v3, s[66:67] offset:768
F_staged:
    s_lshl_b32 s66, s2, 7
    s_add_u32 s66, s66, 164864
    s_cmp_eq_u32 s20, 7
    s_cselect_b32 s22, 0xffff, -1
    s_cselect_b32 s23, 0, -1
    s_waitcnt lgkmcnt(0)
    s_add_u32 s88, s88, 1
    s_barrier
    ds_read_b32 v40, v93 offset:0
    ds_read_b128 v[8:11], v94 offset:0
    ds_read_b32 v14, v94 offset:136
    ds_read_b32 v41, v93 offset:32
    ds_read_b128 v[16:19], v94 offset:3072
    ds_read_b32 v22, v94 offset:3208
    ds_read_b32 v42, v93 offset:64
    ds_read_b128 v[24:27], v94 offset:6144
    ds_read_b32 v30, v94 offset:6280
    ds_read_b32 v43, v93 offset:96
    ds_read_b128 v[32:35], v94 offset:9216
    ds_read_b32 v38, v94 offset:9352
    s_add_u32 s28, s66, 0
    s_add_u32 s29, s66, 256000
    s_add_u32 s30, s66, 512000
    s_add_u32 s31, s66, 768000
    s_waitcnt lgkmcnt(9)
    v_min_u32 v5, 31, v40
    v_bfe_u32 v6, v14, 11, 6
    v_and_b32 v10, 0x1ffff, v10
    v_lshl_or_b32 v6, v5, 6, v6
    v_mov_b32 v11, s88
    v_lshl_or_b32 v10, v6, 17, v10
    buffer_store_dwordx4 v[8:11], v92, s[16:19], s28 offen sc1
    s_waitcnt lgkmcnt(6)
    v_min_u32 v5, 31, v41
    v_bfe_u32 v6, v22, 11, 6
    v_and_b32 v18, 0x1ffff, v18
    v_lshl_or_b32 v6, v5, 6, v6
    v_mov_b32 v19, s88
    v_lshl_or_b32 v18, v6, 17, v18
    buffer_store_dwordx4 v[16:19], v92, s[16:19], s29 offen sc1
    s_waitcnt lgkmcnt(3)
    v_min_u32 v5, 31, v42
    v_bfe_u32 v6, v30, 11, 6
    v_and_b32 v26, 0x1ffff, v26
    v_lshl_or_b32 v6, v5, 6, v6
    v_mov_b32 v27, s88
    v_lshl_or_b32 v26, v6, 17, v26
    buffer_store_dwordx4 v[24:27], v92, s[16:19], s30 offen sc1
    s_waitcnt lgkmcnt(0)
    v_min_u32 v5, 31, v43
    v_bfe_u32 v6, v38, 11, 6
    v_and_b32 v34, 0x1ffff, v34
    v_lshl_or_b32 v6, v5, 6, v6
    v_mov_b32 v35, s88
    v_lshl_or_b32 v34, v6, 17, v34
    s_mov_b64 exec, s[22:23]
    buffer_store_dwordx4 v[32:35], v92, s[16:19], s31 offen sc1
    s_mov_b64 exec, -1
    ds_read_b128 v[12:15], v94 offset:128
    ds_read_b128 v[20:23], v94 offset:3200
    ds_read_b128 v[28:31], v94 offset:6272
    ds_read_b128 v[36:39], v94 offset:9344
    s_waitcnt vmcnt(4)
F_now:
    v_cmp_lt_u32 vcc, 8, v40
    s_add_u32 s67, s28, 8000000
    s_waitcnt lgkmcnt(3)
    v_mov_b32 v15, s88
    s_mov_b64 exec, vcc
    s_cbranch_execz F_w0
    buffer_store_dwordx4 v[12:15], v92, s[16:19], s67 offen sc1
    v_cmp_lt_u32 vcc, 16, v40
    s_add_u32 s67, s67, 8000000
    s_mov_b64 exec, vcc
    s_cbranch_execz F_w0
    ds_read_b128 v[44:47], v94 offset:256
    s_waitcnt lgkmcnt(0)
    v_mov_b32 v47, s88
    buffer_store_dwordx4 v[44:47], v92, s[16:19], s67 offen sc1
    s_nop 1
F_w0:
    s_mov_b64 exec, -1
    v_cmp_lt_u32 vcc, 8, v41
    s_add_u32 s67, s29, 8000000
    s_waitcnt lgkmcnt(2)
    v_mov_b32 v23, s88
    s_mov_b64 exec, vcc
    s_cbranch_execz F_w1
    buffer_store_dwordx4 v[20:23], v92, s[16:19], s67 offen sc1
    v_cmp_lt_u32 vcc, 16, v41
    s_add_u32 s67, s67, 8000000
    s_mov_b64 exec, vcc
    s_cbranch_execz F_w1
    ds_read_b128 v[44:47], v94 offset:3328
    s_waitcnt lgkmcnt(0)
    v_mov_b32 v47, s88
    buffer_store_dwordx4 v[44:47], v92, s[16:19], s67 offen sc1
    s_nop 1
F_w1:
    s_mov_b64 exec, -1
    v_cmp_lt_u32 vcc, 8, v42
    s_add_u32 s67, s30, 8000000
    s_waitcnt lgkmcnt(1)
    v_mov_b32 v31, s88
    s_mov_b64 exec, vcc
    s_cbranch_execz F_w2
    buffer_store_dwordx4 v[28:31], v92, s[16:19], s67 offen sc1
    v_cmp_lt_u32 vcc, 16, v42
    s_add_u32 s67, s67, 8000000
    s_mov_b64 exec, vcc
    s_cbranch_execz F_w2
    ds_read_b128 v[44:47], v94 offset:6400
    s_waitcnt lgkmcnt(0)
    v_mov_b32 v47, s88
    buffer_store_dwordx4 v[44:47], v92, s[16:19], s67 offen sc1
    s_nop 1
F_w2:
    s_mov_b64 exec, -1
    v_cmp_lt_u32 vcc, 8, v43
    s_add_u32 s67, s31, 8000000
    s_and_b64 vcc, vcc, s[22:23]
    s_waitcnt lgkmcnt(0)
    v_mov_b32 v39, s88
    s_mov_b64 exec, vcc
    s_cbranch_execz F_w3
    buffer_store_dwordx4 v[36:39], v92, s[16:19], s67 offen sc1
    v_cmp_lt_u32 vcc, 16, v43
    s_add_u32 s67, s67, 8000000
    s_mov_b64 exec, vcc
    s_cbranch_execz F_w3
    ds_read_b128 v[44:47], v94 offset:9472
    s_waitcnt lgkmcnt(0)
    v_mov_b32 v47, s88
    buffer_store_dwordx4 v[44:47], v92, s[16:19], s67 offen sc1
    s_nop 1
F_w3:
    s_mov_b64 exec, -1
    s_cmp_eq_u32 s20, 7
    s_cbranch_scc0 F_nofrag
    s_cmp_lt_u32 s2, 160
    s_cbranch_scc0 F_nofrag
    v_or_b32 v176, v176, v180
    v_or_b32 v177, v177, v181
    v_or_b32 v178, v178, v182
    v_or_b32 v179, v179, v183
    s_lshl_b32 s66, s2, 10
    s_add_u32 s66, s66, 1024
    buffer_store_dwordx4 v[176:179], v86, s[16:19], s66 offen sc1
F_nofrag:
    s_barrier
    s_mul_i32 s24, s2, 32000
    s_lshl_b32 s25, s20, 12
    s_add_u32 s24, s24, s25
    s_add_u32 s24, s24, 164864
    s_add_u32 s25, s24, 8000000
    s_add_u32 s26, s25, 8000000
    v_mov_b32 v22, 0
    v_mov_b32 v23, s88
    s_mul_i32 s68, s20, 5120
    s_cmp_ge_u32 s20, 4
    s_cselect_b32 s70, 45056, 0
    s_add_u32 s68, s68, s70
    v_add_u32 v2, s68, v86
    ds_write_b128 v2, v[96:99] offset:0
    ds_write_b128 v2, v[100:103] offset:1024
    ds_write_b128 v2, v[104:107] offset:2048
    ds_write_b128 v2, v[108:111] offset:3072
    ds_write_b128 v2, v[112:115] offset:4096
    v_mov_b32 v4, 2130738944
    v_mov_b32 v5, 2130738944
    v_mov_b32 v6, 2130738944
    v_mov_b32 v7, 2130738944
    v_lshlrev_b32 v2, 4, v0
    v_add_u32 v3, 86016, v2
    ds_write_b128 v3, v[4:7] offset:0
    ds_write_b128 v3, v[4:7] offset:8192
    ds_write_b128 v3, v[4:7] offset:16384
    ds_write_b128 v3, v[4:7] offset:24576
    ds_write_b128 v3, v[4:7] offset:32768
    ds_write_b128 v3, v[4:7] offset:40960
    ds_write_b128 v3, v[4:7] offset:49152
    ds_write_b128 v3, v[4:7] offset:57344
    v_add_u32 v3, 0x10000, v3
    ds_write_b128 v3, v[4:7] offset:0
    v_min_u32 v2, 3056, v2
    v_add_u32 v2, 159744, v2
    ds_write_b128 v2, v[4:7]
    s_sub_u32 s72, s72, 128
    s_subb_u32 s73, s73, 0
    s_mov_b32 s4, s72
    s_and_b32 s5, s73, 0xffff
    s_mov_b32 s6, 10240000
    s_mov_b32 s7, 0x20000
    s_sub_u32 s72, s72, 1024
    s_subb_u32 s73, s73, 0
    s_mov_b32 s8, s72
    s_and_b32 s9, s73, 0xffff
    s_mov_b32 s10, 10241024
    s_mov_b32 s11, 0x20000
    s_mov_b32 s12, s76
    s_and_b32 s13, s77, 0xffff
    s_mov_b32 s14, 10240000
    s_mov_b32 s15, 0x20000
    v_lshrrev_b32 v2, 5, v1
    v_bfe_u32 v3, v1, 2, 2
    v_and_b32 v4, 3, v1
    v_bfe_u32 v5, v1, 4, 1
    v_lshlrev_b32 v6, 9, v2
    v_lshl_add_u32 v6, v3, 7, v6
    v_lshl_add_u32 v6, v5, 5, v6
    v_lshl_add_u32 v6, v4, 3, v6
    v_lshrrev_b32 v7, 1, v3
    v_lshl_add_u32 v6, v7, 6, v6
    v_add_u32 v244, s21, v6
    v_xor_b32 v245, 64, v244
    v_lshlrev_b32 v6, 7, v2
    v_lshl_add_u32 v6, v7, 5, v6
    v_and_b32 v7, 1, v3
    v_xor_b32 v7, 1, v7
    v_mul_u32_u24 v7, 90112, v7
    v_add_u32 v6, v6, v7
    v_lshl_add_u32 v249, v4, 3, v6
    v_lshl_add_u32 v6, v2, 2, v4
    v_bfe_u32 v7, v1, 2, 1
    v_lshl_add_u32 v6, v7, 3, v6
    v_lshlrev_b32 v6, 3, v6
    v_bfe_u32 v7, v1, 3, 1
    v_add_u32 v5, 1, v5
    v_mul_u32_u24 v7, v7, v5
    v_lshl_add_u32 v250, v7, 1, v6
    v_and_b32 v6, 0x38, v1
    v_add_u32 v247, 4, v6
    v_lshrrev_b32 v6, 2, v1
    v_lshrrev_b32 v7, 4, v1
    v_xor_b32 v6, v6, v7
    v_and_b32 v6, 1, v6
    v_lshlrev_b32 v6, 6, v6
    v_lshl_add_u32 v246, v4, 4, v6
    v_mov_b32 v242, 1.0
    v_mov_b32 v243, 1.0
    s_mov_b32 s54, 0xffffff00
    s_mov_b32 s55, 0xffffff00
    s_mov_b32 s56, 0xffff
    s_mov_b32 s57, 0xffff
    s_mov_b32 s58, 0
    s_mov_b32 s59, 134217856
    s_mov_b32 s60, 262272
    s_mov_b32 s61, 402915456
    s_mov_b32 s62, 940179840
    s_mov_b32 s63, 403046528
    s_mov_b32 s64, 402784384
    s_mov_b32 s65, 134348928
    s_mov_b32 s38, 128
    s_mov_b32 s33, -1
    s_and_b32 s68, s20, 3
    s_lshl_b32 s68, s68, 2
    s_lshr_b32 s69, s20, 2
    s_add_u32 s68, s68, s69
    s_lshl_b32 s68, s68, 4
    s_add_u32 s68, s68, 163072
    v_mov_b32 v251, s68
    s_mov_b32 s53, 0
    s_mov_b32 s50, 0
    s_mov_b32 s51, 0
    s_mov_b32 s47, 0
    s_mov_b32 s42, 0
    s_mov_b32 s3, 0
    s_mov_b32 s89, 0
    s_mov_b32 s34, 128
    s_mov_b32 s35, 384
    s_mov_b32 s36, 640
    s_mov_b32 s37, 896
    s_movk_i32 s3, 1024
    s_waitcnt lgkmcnt(0)
    s_barrier
    buffer_load_dwordx4 v[8:11], v86, s[16:19], s24 offen offset:0 sc1
    buffer_load_dwordx4 v[12:15], v86, s[16:19], s24 offen offset:1024 sc1
    buffer_load_dwordx4 v[16:19], v86, s[16:19], s24 offen offset:2048 sc1
    s_mov_b64 exec, s[22:23]
    buffer_load_dwordx4 v[20:23], v86, s[16:19], s24 offen offset:3072 sc1
    s_mov_b64 exec, -1
    ds_read_b128 v[96:99], v86 offset:0
    ds_read_b128 v[100:103], v86 offset:1024
    ds_read_b128 v[104:107], v86 offset:2048
    ds_read_b128 v[108:111], v86 offset:3072
    ds_read_b128 v[112:115], v86 offset:4096
    ds_read_b128 v[116:119], v86 offset:5120
    ds_read_b128 v[120:123], v86 offset:6144
    ds_read_b128 v[124:127], v86 offset:7168
    ds_read_b128 v[128:131], v86 offset:8192
    ds_read_b128 v[132:135], v86 offset:9216
    ds_read_b128 v[136:139], v86 offset:10240
    ds_read_b128 v[140:143], v86 offset:11264
    ds_read_b128 v[144:147], v86 offset:12288
    ds_read_b128 v[148:151], v86 offset:13312
    ds_read_b128 v[152:155], v86 offset:14336
    ds_read_b128 v[156:159], v86 offset:15360
    ds_read_b128 v[160:163], v86 offset:16384
    ds_read_b128 v[164:167], v86 offset:17408
    ds_read_b128 v[168:171], v86 offset:18432
    ds_read_b128 v[172:175], v86 offset:19456
    s_mov_b32 s27, 32768
    s_mov_b32 s71, 162816
    v_mov_b32 v3, 1
    s_cmp_eq_u32 s20, 7
    s_cselect_b32 s52, 160, 0
    v_cmp_gt_u32 s[68:69], 40, v1
    s_mov_b64 s[28:29], 0xff
    s_lshr_b32 s66, s2, 3
    s_lshl_b32 s66, s66, 3
    s_add_u32 s66, s66, s20
    s_mul_i32 s66, s66, 14
    v_min_u32 v93, 13, v1
    v_add_u32 v93, s66, v93
    v_lshlrev_b32 v93, 10, v93
    v_mov_b32 v94, 0x7f000000
F_poll:
    s_waitcnt vmcnt(0)
F_poll1:
    v_cmp_ne_u32 s[72:73], s88, v11
    v_cmp_ne_u32 s[74:75], s88, v15
    v_cmp_ne_u32 s[76:77], s88, v19
    v_cmp_ne_u32 s[78:79], s88, v23
    s_or_b64 s[80:81], s[72:73], s[74:75]
    s_or_b64 s[82:83], s[76:77], s[78:79]
    s_or_b64 s[80:81], s[80:81], s[82:83]
    s_cbranch_scc1 F_again
F_got:
    v_bfe_u32 v2, v10, 23, 5
    v_bfe_u32 v60, v10, 11, 6
    v_cmp_gt_u32 s[80:81], v2, v91
    v_lshl_add_u32 v60, v60, 2, s71
    v_cmp_lt_u32 s[72:73], 8, v2
    v_max_u32 v89, v89, v2
    s_mov_b64 exec, s[80:81]
    ds_add_rtn_u32 v72, v60, v3
    s_mov_b64 exec, s[72:73]
    s_cbranch_execz F_h0
    buffer_load_dwordx4 v[24:27], v86, s[16:19], s25 offen offset:0 sc1
    v_sub_u32 v56, v2, v91
    v_bfe_u32 v64, v10, 17, 6
    v_cmp_lt_u32 vcc, 8, v56
    v_lshl_add_u32 v64, v64, 2, s71
    s_mov_b64 exec, vcc
    ds_add_rtn_u32 v76, v64, v3
F_h0:
    s_mov_b64 exec, -1
    v_bfe_u32 v2, v14, 23, 5
    v_bfe_u32 v61, v14, 11, 6
    v_cmp_gt_u32 s[82:83], v2, v91
    v_lshl_add_u32 v61, v61, 2, s71
    v_cmp_lt_u32 s[74:75], 8, v2
    v_max_u32 v89, v89, v2
    s_mov_b64 exec, s[82:83]
    ds_add_rtn_u32 v73, v61, v3
    s_mov_b64 exec, s[74:75]
    s_cbranch_execz F_h1
    buffer_load_dwordx4 v[28:31], v86, s[16:19], s25 offen offset:1024 sc1
    v_sub_u32 v57, v2, v91
    v_bfe_u32 v65, v14, 17, 6
    v_cmp_lt_u32 vcc, 8, v57
    v_lshl_add_u32 v65, v65, 2, s71
    s_mov_b64 exec, vcc
    ds_add_rtn_u32 v77, v65, v3
F_h1:
    s_mov_b64 exec, -1
    v_bfe_u32 v2, v18, 23, 5
    v_bfe_u32 v62, v18, 11, 6
    v_cmp_gt_u32 s[84:85], v2, v91
    v_lshl_add_u32 v62, v62, 2, s71
    v_cmp_lt_u32 s[76:77], 8, v2
    v_max_u32 v89, v89, v2
    s_mov_b64 exec, s[84:85]
    ds_add_rtn_u32 v74, v62, v3
    s_mov_b64 exec, s[76:77]
    s_cbranch_execz F_h2
    buffer_load_dwordx4 v[32:35], v86, s[16:19], s25 offen offset:2048 sc1
    v_sub_u32 v58, v2, v91
    v_bfe_u32 v66, v18, 17, 6
    v_cmp_lt_u32 vcc, 8, v58
    v_lshl_add_u32 v66, v66, 2, s71
    s_mov_b64 exec, vcc
    ds_add_rtn_u32 v78, v66, v3
F_h2:
    s_mov_b64 exec, -1
    v_bfe_u32 v2, v22, 23, 5
    v_bfe_u32 v63, v22, 11, 6
    v_cmp_gt_u32 s[86:87], v2, v91
    v_lshl_add_u32 v63, v63, 2, s71
    v_cmp_lt_u32 s[78:79], 8, v2
    v_max_u32 v89, v89, v2
    s_mov_b64 exec, s[86:87]
    ds_add_rtn_u32 v75, v63, v3
    s_mov_b64 exec, s[78:79]
    s_cbranch_execz F_h3
    buffer_load_dwordx4 v[36:39], v86, s[16:19], s25 offen offset:3072 sc1
    v_sub_u32 v59, v2, v91
    v_bfe_u32 v67, v22, 17, 6
    v_cmp_lt_u32 vcc, 8, v59
    v_lshl_add_u32 v67, v67, 2, s71
    s_mov_b64 exec, vcc
    ds_add_rtn_u32 v79, v67, v3
F_h3:
    s_mov_b64 exec, -1
    v_cmp_lt_u32 s[30:31], 16, v89
    s_mov_b32 s27, 262144
    s_cmp_lg_u64 s[30:31], 0
    s_cbranch_scc1 F_l3
F_l3r:
    v_and_b32 v10, 0x7ff, v10
    v_lshl_add_u32 v10, v10, 5, v90
    v_or_b32 v11, 16, v10
    v_and_b32 v14, 0x7ff, v14
    v_lshl_add_u32 v14, v14, 5, v90
    v_add_u32 v14, 327680, v14
    v_or_b32 v15, 16, v14
    v_and_b32 v18, 0x7ff, v18
    v_lshl_add_u32 v18, v18, 5, v90
    v_add_u32 v18, 655360, v18
    v_or_b32 v19, 16, v18
    v_and_b32 v22, 0x7ff, v22
    v_lshl_add_u32 v22, v22, 5, v90
    v_add_u32 v22, 983040, v22
    v_or_b32 v23, 16, v22
    s_cmp_lt_u32 s2, s52
    s_cbranch_scc1 F_flag
F_flagr:
    s_waitcnt lgkmcnt(0)
    s_barrier
    ds_read_b32 v4, v88
    buffer_load_dword v95, v93, s[4:7], 0 offen offset:128
    v_lshlrev_b32 v72, 3, v72
    v_lshlrev_b32 v73, 3, v73
    v_lshlrev_b32 v74, 3, v74
    v_lshlrev_b32 v75, 3, v75
    v_lshlrev_b32 v76, 3, v76
    v_lshlrev_b32 v77, 3, v77
    v_lshlrev_b32 v78, 3, v78
    v_lshlrev_b32 v79, 3, v79
    s_waitcnt lgkmcnt(0)
    v_add_u32 v2, 7, v4
    v_cmp_lt_u32 vcc, 64, v4
    v_lshrrev_b32 v2, 3, v2
    v_max_u32 v2, 2, v2
    s_cmp_lg_u64 vcc, 0
    s_cbranch_scc1 SLOW
    v_med3_u32 v3, v2, 3, 7
    v_cmp_eq_u32 vcc, 7, v2
    v_mad_u32_u24 v3, v3, 6, 14
    v_lshlrev_b32_e64 v6, v3, 1
    v_cndmask_b32 v6, 0, v6, s[68:69]
    v_addc_co_u32 v2, vcc, 0, v2, vcc
    v_mov_b32 v7, v6
    v_add_u32 v5, 1, v2
    v_lshrrev_b32 v5, 1, v5
    v_add_u32_dpp v7, v7, v7 row_shr:1 row_mask:0xf bank_mask:0xf
    v_lshlrev_b32 v92, 22, v5
    v_lshlrev_b32 v5, 18, v5
    v_add_u32_dpp v7, v7, v7 row_shr:2 row_mask:0xf bank_mask:0xf
    v_lshl_or_b32 v5, v1, 21, v5
    v_lshl_or_b32 v5, v2, 28, v5
    v_add_u32_dpp v7, v7, v7 row_shr:4 row_mask:0xf bank_mask:0xf
    s_mov_b32 s26, 86016
    s_mov_b32 s24, 0x2000
    v_add_u32_dpp v7, v7, v7 row_shr:8 row_mask:0xf bank_mask:0xf
    s_nop 1
    v_add_u32_dpp v7, v7, v7 row_bcast:15 row_mask:0xa bank_mask:0xf
    s_nop 1
    v_add_u32_dpp v7, v7, v7 row_bcast:31 row_mask:0xc bank_mask:0xf
    s_nop 0
    v_readlane_b32 s71, v7, 63
    v_sub_u32 v7, v7, v6
    s_lshr_b32 s66, s71, 24
    s_lshr_b32 s67, s71, 6
    s_lshr_b32 s70, s71, 12
    s_lshr_b32 s71, s71, 18
    s_add_u32 s67, s67, s70
    s_add_u32 s71, s71, s66
    s_add_u32 s71, s71, s67
    v_add_u32 v7, s71, v7
    s_bfe_u32 s70, s71, 393222
    v_bfe_u32 v7, v7, v3, 6
    s_bfe_u32 s67, s71, 393228
    v_cndmask_b32 v84, 63, v7, s[68:69]
    s_mul_i32 s68, s70, 3
    v_min_u32 v2, s70, v7
    s_mul_i32 s69, s66, 5
    v_min_u32 v3, s66, v7
    s_add_u32 s68, s68, s69
    v_mul_u32_u24 v7, 12, v7
    s_cmp_gt_u32 s68, 120
    v_mad_u32_u24 v7, v2, 3, v7
    s_cbranch_scc1 SLOW
    v_mad_u32_u24 v7, v3, 5, v7
    v_lshl_add_u32 v7, v7, 7, s26
    v_lshrrev_b32 v6, 3, v7
    v_mad_u32_u24 v92, v7, s24, v92
    v_or_b32 v92, v92, v6
    v_or_b32 v6, v5, v7
    s_add_u32 s71, s70, s66
    s_add_u32 s68, s71, s67
    s_andn2_b32 s70, s70, 3
    s_add_u32 s69, s70, 4
    s_andn2_b32 s67, s67, 3
    v_lshrrev_b32 v3, 1, v84
    v_mov_b32 v2, s68
    v_xor_b32 v3, v3, v84
    v_bfi_b32 v3, 4, v3, v84
    v_cmpx_gt_u32 vcc, s69, v84
    v_mov_b32 v2, s66
    v_cmpx_gt_u32 vcc, s70, v84
    v_mov_b32 v2, s71
    v_cmpx_gt_u32 vcc, s67, v84
    v_mov_b32 v2, 0
    s_mov_b64 exec, -1
    v_add_u32 v2, v2, v84
    v_bfi_b32 v84, 3, v2, v3
    s_lshr_b32 s66, s2, 3
    v_cmp_gt_u32 vcc, 32, v84
    v_add_u32 v2, s66, v84
    v_lshl_add_u32 v2, v2, 3, v84
    v_bfi_b32 v2, 24, v2, v84
    v_cndmask_b32 v84, v84, v2, vcc
    v_subrev_u32 v2, 6, v84
    v_and_b32 v2, 0x80000000, v2
    v_or_b32 v92, v92, v2
    ds_bpermute_b32 v60, v60, v92
    ds_bpermute_b32 v61, v61, v92
    ds_bpermute_b32 v62, v62, v92
    ds_bpermute_b32 v63, v63, v92
    ds_bpermute_b32 v64, v64, v92
    ds_bpermute_b32 v65, v65, v92
    ds_bpermute_b32 v66, v66, v92
    ds_bpermute_b32 v67, v67, v92
    v_cmp_eq_u32 vcc, s20, v84
    s_ff1_i32_b64 s67, vcc
    v_readlane_b32 s71, v6, s67
    s_mov_b32 s22, s71
    s_bfe_u32 s46, s71, 0x30012
    s_mov_b32 m0, s46
    s_and_b32 s66, s71, 0x3ffff
    s_movrels_b32 s68, s57
    s_movrels_b32 s69, s61
    s_sub_u32 s48, s66, s47
    s_mov_b32 s47, s66
    s_lshr_b32 s52, s71, 28
    s_lshl_b32 s67, s46, 9
    s_add_u32 s66, s66, s67
    s_sub_u32 s49, s66, s42
    s_mov_b32 s42, s66
    s_bfe_u32 s66, s68, 655360
    s_add_u32 s43, s42, s66
    s_bfe_u32 s39, s69, 655360
    s_bfe_u32 s66, s68, 655370
    s_add_u32 s44, s42, s66
    s_bfe_u32 s40, s69, 655370
    s_bfe_u32 s66, s68, 655380
    s_add_u32 s45, s42, s66
    s_bfe_u32 s41, s69, 655380
    s_waitcnt lgkmcnt(7)
    v_cmp_gt_i32 vcc, 0, v60
    v_and_b32 v60, 0x7fffffff, v60
    s_and_b64 exec, vcc, s[80:81]
    buffer_load_dword v95, v10, s[12:15], 0 offen
    s_mov_b64 exec, -1
    v_mad_u32_u16 v2, v60, 8, v72
    v_mad_u32_u16 v3, v60, 8, v72 op_sel:[1,0,0,0]
    s_mov_b64 exec, s[80:81]
    ds_write_b64 v2, v[10:11]
    ds_write_b64 v3, v[8:9]
    s_mov_b64 exec, -1
    s_waitcnt lgkmcnt(8)
    v_cmp_gt_i32 vcc, 0, v61
    v_and_b32 v61, 0x7fffffff, v61
    s_and_b64 exec, vcc, s[82:83]
    buffer_load_dword v95, v14, s[12:15], 0 offen
    s_mov_b64 exec, -1
    v_mad_u32_u16 v2, v61, 8, v73
    v_mad_u32_u16 v3, v61, 8, v73 op_sel:[1,0,0,0]
    s_mov_b64 exec, s[82:83]
    ds_write_b64 v2, v[14:15]
    ds_write_b64 v3, v[12:13]
    s_mov_b64 exec, -1
    s_waitcnt lgkmcnt(9)
    v_cmp_gt_i32 vcc, 0, v62
    v_and_b32 v62, 0x7fffffff, v62
    s_and_b64 exec, vcc, s[84:85]
    buffer_load_dword v95, v18, s[12:15], 0 offen
    s_mov_b64 exec, -1
    v_mad_u32_u16 v2, v62, 8, v74
    v_mad_u32_u16 v3, v62, 8, v74 op_sel:[1,0,0,0]
    s_mov_b64 exec, s[84:85]
    ds_write_b64 v2, v[18:19]
    ds_write_b64 v3, v[16:17]
    s_mov_b64 exec, -1
    s_waitcnt lgkmcnt(10)
    v_cmp_gt_i32 vcc, 0, v63
    v_and_b32 v63, 0x7fffffff, v63
    s_and_b64 exec, vcc, s[86:87]
    buffer_load_dword v95, v22, s[12:15], 0 offen
    s_mov_b64 exec, -1
    v_mad_u32_u16 v2, v63, 8, v75
    v_mad_u32_u16 v3, v63, 8, v75 op_sel:[1,0,0,0]
    s_mov_b64 exec, s[86:87]
    ds_write_b64 v2, v[22:23]
    ds_write_b64 v3, v[20:21]
    s_mov_b64 exec, -1
    s_waitcnt vmcnt(5) lgkmcnt(8)
    s_mov_b64 exec, s[72:73]
    s_cbranch_execz F_s0
F_sp0:
    v_cmp_ne_u32 vcc, s88, v27
    s_cbranch_vccnz F_sa0
F_sg0:
    v_cmpx_lt_u32 vcc, 8, v56
    v_and_b32 v26, 0x7ff, v26
    v_lshl_add_u32 v26, v26, 5, v90
    v_or_b32 v27, 16, v26
    v_cmp_gt_i32 vcc, 0, v64
    v_and_b32 v64, 0x7fffffff, v64
    s_and_saveexec_b64 s[82:83], vcc
    s_cbranch_execz F_x0
    buffer_load_dword v95, v26, s[12:15], 0 offen
F_x0:
    s_mov_b64 exec, s[82:83]
    v_mad_u32_u16 v2, v64, 8, v76
    v_mad_u32_u16 v3, v64, 8, v76 op_sel:[1,0,0,0]
    ds_write_b64 v2, v[26:27]
    ds_write_b64 v3, v[24:25]
F_s0:
    s_mov_b64 exec, s[74:75]
    s_cbranch_execz F_s1
F_sp1:
    v_cmp_ne_u32 vcc, s88, v31
    s_cbranch_vccnz F_sa1
F_sg1:
    v_cmpx_lt_u32 vcc, 8, v57
    v_and_b32 v30, 0x7ff, v30
    v_lshl_add_u32 v30, v30, 5, v90
    v_add_u32 v30, 327680, v30
    v_or_b32 v31, 16, v30
    v_cmp_gt_i32 vcc, 0, v65
    v_and_b32 v65, 0x7fffffff, v65
    s_and_saveexec_b64 s[82:83], vcc
    s_cbranch_execz F_x1
    buffer_load_dword v95, v30, s[12:15], 0 offen
F_x1:
    s_mov_b64 exec, s[82:83]
    v_mad_u32_u16 v2, v65, 8, v77
    v_mad_u32_u16 v3, v65, 8, v77 op_sel:[1,0,0,0]
    ds_write_b64 v2, v[30:31]
    ds_write_b64 v3, v[28:29]
F_s1:
    s_mov_b64 exec, s[76:77]
    s_cbranch_execz F_s2
F_sp2:
    v_cmp_ne_u32 vcc, s88, v35
    s_cbranch_vccnz F_sa2
F_sg2:
    v_cmpx_lt_u32 vcc, 8, v58
    v_and_b32 v34, 0x7ff, v34
    v_lshl_add_u32 v34, v34, 5, v90
    v_add_u32 v34, 655360, v34
    v_or_b32 v35, 16, v34
    v_cmp_gt_i32 vcc, 0, v66
    v_and_b32 v66, 0x7fffffff, v66
    s_and_saveexec_b64 s[82:83], vcc
    s_cbranch_execz F_x2
    buffer_load_dword v95, v34, s[12:15], 0 offen
F_x2:
    s_mov_b64 exec, s[82:83]
    v_mad_u32_u16 v2, v66, 8, v78
    v_mad_u32_u16 v3, v66, 8, v78 op_sel:[1,0,0,0]
    ds_write_b64 v2, v[34:35]
    ds_write_b64 v3, v[32:33]
F_s2:
    s_mov_b64 exec, s[78:79]
    s_cbranch_execz F_s3
F_sp3:
    v_cmp_ne_u32 vcc, s88, v39
    s_cbranch_vccnz F_sa3
F_sg3:
    v_cmpx_lt_u32 vcc, 8, v59
    v_and_b32 v38, 0x7ff, v38
    v_lshl_add_u32 v38, v38, 5, v90
    v_add_u32 v38, 983040, v38
    v_or_b32 v39, 16, v38
    v_cmp_gt_i32 vcc, 0, v67
    v_and_b32 v67, 0x7fffffff, v67
    s_and_saveexec_b64 s[82:83], vcc
    s_cbranch_execz F_x3
    buffer_load_dword v95, v38, s[12:15], 0 offen
F_x3:
    s_mov_b64 exec, s[82:83]
    v_mad_u32_u16 v2, v67, 8, v79
    v_mad_u32_u16 v3, v67, 8, v79 op_sel:[1,0,0,0]
    ds_write_b64 v2, v[38:39]
    ds_write_b64 v3, v[36:37]
F_s3:
    s_mov_b64 exec, -1
    s_cmp_lg_u64 s[30:31], 0
    s_cbranch_scc1 F_u
F_ur:
    s_mov_b32 s27, s22
    s_and_b32 s66, s46, s33
    s_cselect_b32 s72, -1, 1
    s_cselect_b32 s76, s47, 163712
    s_cmp_ge_u32 s66, 2
    s_cselect_b32 s73, -1, 0
    s_add_u32 s77, s47, 1024
    s_cmp_ge_u32 s66, 4
    s_cselect_b32 s75, -1, 0
    s_cmp_ge_u32 s66, 3
    s_cselect_b32 s74, -1, 1
    s_cselect_b32 s77, s77, 163712
    s_mul_i32 s66, s20, 80
    v_min_u32 v2, 76, v248
    s_waitcnt lgkmcnt(0)
    s_barrier
    v_add_u32 v253, s47, v248
    ds_read_b32 v254, v253
    ds_read_b32 v255, v253 offset:256
    v_add_u32 v252, s42, v247
    ds_read2_b32 v[234:235], v252 offset0:0 offset1:16
    v_add_u32 v252, s43, v247
    ds_read2_b32 v[236:237], v252 offset0:0 offset1:16
    v_add_u32 v252, s44, v247
    ds_read2_b32 v[238:239], v252 offset0:0 offset1:16
    v_add_u32 v252, s45, v247
    ds_read2_b32 v[240:241], v252 offset0:0 offset1:16
    buffer_load_dword v3, v2, s[16:19], s66 offen offset:128 sc1
    v_add_u32 v249, s48, v249
    v_add_u32 v250, s49, v250
    s_waitcnt lgkmcnt(4)
    s_mov_b32 m0, s76
    s_mov_b64 exec, s[72:73]
    buffer_load_dwordx4 v254, s[12:15], 0 offen  lds
    s_mov_b32 m0, s77
    s_mov_b64 exec, s[74:75]
    buffer_load_dwordx4 v255, s[12:15], 0 offen  lds
    s_mov_b64 exec, -1
    s_waitcnt lgkmcnt(0)
    s_add_u32 m0, s21, 0
    v_mad_u32_u16 v234, v234, s3, v246 op_sel:[1,0,0,0]
    v_mad_u32_u16 v235, v235, s3, v246 op_sel:[1,0,0,0]
    buffer_load_dwordx4 v234, s[4:7], s38 offen  lds
    buffer_load_dwordx4 v235, s[8:11], s38 offen offset:1024  lds
    s_add_u32 m0, s21, 2048
    v_mad_u32_u16 v236, v236, s3, v246 op_sel:[1,0,0,0]
    v_mad_u32_u16 v237, v237, s3, v246 op_sel:[1,0,0,0]
    buffer_load_dwordx4 v236, s[4:7], s39 offen  lds
    buffer_load_dwordx4 v237, s[8:11], s39 offen offset:1024  lds
    s_add_u32 m0, s21, 4096
    v_mad_u32_u16 v238, v238, s3, v246 op_sel:[1,0,0,0]
    v_mad_u32_u16 v239, v239, s3, v246 op_sel:[1,0,0,0]
    buffer_load_dwordx4 v238, s[4:7], s40 offen  lds
    buffer_load_dwordx4 v239, s[8:11], s40 offen offset:1024  lds
    s_add_u32 m0, s21, 6144
    v_mad_u32_u16 v240, v240, s3, v246 op_sel:[1,0,0,0]
    v_mad_u32_u16 v241, v241, s3, v246 op_sel:[1,0,0,0]
    buffer_load_dwordx4 v240, s[4:7], s41 offen  lds
    buffer_load_dwordx4 v241, s[8:11], s41 offen offset:1024  lds
    v_lshrrev_b32 v8, 3, v84
    v_and_b32 v9, 7, v84
    v_lshlrev_b32 v9, 13, v9
    v_mul_u32_u24 v8, 1536, v8
    v_lshlrev_b32 v10, 4, v84
    v_and_b32 v5, 128, v10
    v_add3_u32 v8, v8, v9, v5
    v_xor_b32 v9, v10, v7
    v_and_b32 v9, 128, v9
    v_add_u32 v9, v9, v7
    v_mov_b32 v5, v9
    s_add_u32 s66, s20, 0
    v_cmp_eq_u32 vcc, s66, v84
    s_ff1_i32_b64 s67, vcc
    v_readlane_b32 s28, v5, s67
    s_add_u32 s66, s20, 8
    v_cmp_eq_u32 vcc, s66, v84
    s_ff1_i32_b64 s67, vcc
    v_readlane_b32 s29, v5, s67
    v_readlane_b32 s23, v6, s67
    s_add_u32 s66, s20, 16
    v_cmp_eq_u32 vcc, s66, v84
    s_ff1_i32_b64 s67, vcc
    v_readlane_b32 s30, v5, s67
    v_readlane_b32 s24, v6, s67
    s_add_u32 s66, s20, 24
    v_cmp_eq_u32 vcc, s66, v84
    s_ff1_i32_b64 s67, vcc
    v_readlane_b32 s31, v5, s67
    v_readlane_b32 s25, v6, s67
    s_add_u32 s66, s20, 32
    v_cmp_eq_u32 vcc, s66, v84
    s_ff1_i32_b64 s67, vcc
    v_readlane_b32 s32, v5, s67
    v_readlane_b32 s26, v6, s67
    v_lshlrev_b32 v4, 3, v84
    v_add_u32 v4, 163328, v4
    s_mov_b32 exec_hi, 0xff
    ds_write_b64 v4, v[8:9]
    s_mov_b32 exec_hi, -1
    s_waitcnt lgkmcnt(0)
    v_mov_b32 v252, 0
    s_waitcnt vmcnt(6)
    v_cmp_ne_u32 vcc, s88, v3
    ds_read_b64_tr_b16 v[176:177], v244 offset:0
    ds_read_b64_tr_b16 v[178:179], v244 offset:1024
    ds_read_b64_tr_b16 v[180:181], v245 offset:0
    ds_read_b64_tr_b16 v[182:183], v245 offset:1024
    ds_read_b64_tr_b16 v[72:73], v249 offset:0
    ds_read_b64_tr_b16 v[76:77], v249 offset:64
    ds_read_b64_tr_b16 v[74:75], v249 offset:256
    ds_read_b64_tr_b16 v[78:79], v249 offset:320
    s_mov_b64 exec, s[54:55]
    ds_read_u16_d16_hi v242, v250 offset:0
    s_mov_b64 exec, -1
    s_or_b32 s89, vcc_lo, vcc_hi
    s_add_u32 s53, s53, 4
    s_xor_b32 s66, s53, s20
    s_bitcmp1_b32 s66, 2
    s_setprio 1
    s_cbranch_scc1 PRIO_1
    s_setprio 0
PRIO_1:
    s_cmp_eq_u32 s52, 4
    s_cbranch_scc1 ITEM_0_4
    s_cmp_eq_u32 s52, 5
    s_cbranch_scc1 ITEM_0_5
    s_cmp_eq_u32 s52, 3
    s_cbranch_scc1 ITEM_0_3
    s_cmp_eq_u32 s52, 6
    s_cbranch_scc1 ITEM_0_6
    s_cmp_eq_u32 s52, 8
    s_cbranch_scc1 ITEM_0_8
    s_branch ITEM_0_2
F_again:
    s_sub_u32 s27, s27, 1
    s_cbranch_scc1 F_late
    s_cmp_eq_u64 s[72:73], 0
    s_cbranch_scc1 F_p0
    s_mov_b64 exec, s[72:73]
    buffer_load_dwordx4 v[8:11], v86, s[16:19], s24 offen offset:0 sc1
    s_mov_b64 exec, -1
F_p0:
    s_cmp_eq_u64 s[74:75], 0
    s_cbranch_scc1 F_p1
    s_mov_b64 exec, s[74:75]
    buffer_load_dwordx4 v[12:15], v86, s[16:19], s24 offen offset:1024 sc1
    s_mov_b64 exec, -1
F_p1:
    s_cmp_eq_u64 s[76:77], 0
    s_cbranch_scc1 F_p2
    s_mov_b64 exec, s[76:77]
    buffer_load_dwordx4 v[16:19], v86, s[16:19], s24 offen offset:2048 sc1
    s_mov_b64 exec, -1
F_p2:
    s_cmp_eq_u64 s[78:79], 0
    s_cbranch_scc1 F_p3
    s_mov_b64 exec, s[78:79]
    buffer_load_dwordx4 v[20:23], v86, s[16:19], s24 offen offset:3072 sc1
    s_mov_b64 exec, -1
F_p3:
    s_branch F_poll
F_late:
    v_mov_b32 v2, 163064
    v_mov_b32 v4, 1000
    ds_write_b32 v2, v4
    v_mov_b32 v10, 0
    v_mov_b32 v14, 0
    v_mov_b32 v18, 0
    v_mov_b32 v22, 0
    s_branch F_got
F_l3:
    v_bfe_u32 v2, v10, 23, 5
    v_sub_u32 v56, v2, v91
    v_cmp_lt_u32 vcc, 16, v2
    s_mov_b64 exec, vcc
    s_cbranch_execz F_t0
F_tp0:
    buffer_load_dwordx4 v[40:43], v86, s[16:19], s26 offen offset:0 sc1
    s_waitcnt vmcnt(0)
    v_cmp_ne_u32 vcc, s88, v43
    s_sub_u32 s27, s27, 1
    s_cselect_b64 vcc, 0, vcc
    s_cmp_eq_u64 vcc, 0
    s_cbranch_scc0 F_tp0
    v_bfe_u32 v68, v42, 11, 6
    v_lshl_add_u32 v68, v68, 2, s71
    v_cmp_lt_i32 vcc, 16, v56
    s_mov_b64 exec, vcc
    ds_add_rtn_u32 v80, v68, v3
F_t0:
    s_mov_b64 exec, -1
    v_bfe_u32 v2, v14, 23, 5
    v_sub_u32 v57, v2, v91
    v_cmp_lt_u32 vcc, 16, v2
    s_mov_b64 exec, vcc
    s_cbranch_execz F_t1
F_tp1:
    buffer_load_dwordx4 v[44:47], v86, s[16:19], s26 offen offset:1024 sc1
    s_waitcnt vmcnt(0)
    v_cmp_ne_u32 vcc, s88, v47
    s_sub_u32 s27, s27, 1
    s_cselect_b64 vcc, 0, vcc
    s_cmp_eq_u64 vcc, 0
    s_cbranch_scc0 F_tp1
    v_bfe_u32 v69, v46, 11, 6
    v_lshl_add_u32 v69, v69, 2, s71
    v_cmp_lt_i32 vcc, 16, v57
    s_mov_b64 exec, vcc
    ds_add_rtn_u32 v81, v69, v3
F_t1:
    s_mov_b64 exec, -1
    v_bfe_u32 v2, v18, 23, 5
    v_sub_u32 v58, v2, v91
    v_cmp_lt_u32 vcc, 16, v2
    s_mov_b64 exec, vcc
    s_cbranch_execz F_t2
F_tp2:
    buffer_load_dwordx4 v[48:51], v86, s[16:19], s26 offen offset:2048 sc1
    s_waitcnt vmcnt(0)
    v_cmp_ne_u32 vcc, s88, v51
    s_sub_u32 s27, s27, 1
    s_cselect_b64 vcc, 0, vcc
    s_cmp_eq_u64 vcc, 0
    s_cbranch_scc0 F_tp2
    v_bfe_u32 v70, v50, 11, 6
    v_lshl_add_u32 v70, v70, 2, s71
    v_cmp_lt_i32 vcc, 16, v58
    s_mov_b64 exec, vcc
    ds_add_rtn_u32 v82, v70, v3
F_t2:
    s_mov_b64 exec, -1
    v_bfe_u32 v2, v22, 23, 5
    v_sub_u32 v59, v2, v91
    v_cmp_lt_u32 vcc, 16, v2
    s_mov_b64 exec, vcc
    s_cbranch_execz F_t3
F_tp3:
    buffer_load_dwordx4 v[52:55], v86, s[16:19], s26 offen offset:3072 sc1
    s_waitcnt vmcnt(0)
    v_cmp_ne_u32 vcc, s88, v55
    s_sub_u32 s27, s27, 1
    s_cselect_b64 vcc, 0, vcc
    s_cmp_eq_u64 vcc, 0
    s_cbranch_scc0 F_tp3
    v_bfe_u32 v71, v54, 11, 6
    v_lshl_add_u32 v71, v71, 2, s71
    v_cmp_lt_i32 vcc, 16, v59
    s_mov_b64 exec, vcc
    ds_add_rtn_u32 v83, v71, v3
F_t3:
    s_mov_b64 exec, -1
    v_mov_b32 v2, 163068
    v_mov_b32 v4, 1000
    v_cmp_lt_u32 vcc, 24, v89
    s_mov_b64 exec, vcc
    ds_write_b32 v2, v4
    s_mov_b64 exec, -1
    s_branch F_l3r
F_flag:
    s_lshl_b32 s66, s2, 2
    v_mov_b32 v2, 128
    v_mov_b32 v4, s88
    s_mov_b64 exec, 1
    buffer_store_dword v4, v2, s[16:19], s66 offen sc1
    s_mov_b64 exec, -1
    s_branch F_flagr
F_sa0:
    s_sub_u32 s27, s27, 1
    s_cbranch_scc1 F_sg0
    buffer_load_dwordx4 v[24:27], v86, s[16:19], s25 offen offset:0 sc1
    s_waitcnt vmcnt(0)
    s_branch F_sp0
F_sa1:
    s_sub_u32 s27, s27, 1
    s_cbranch_scc1 F_sg1
    buffer_load_dwordx4 v[28:31], v86, s[16:19], s25 offen offset:1024 sc1
    s_waitcnt vmcnt(0)
    s_branch F_sp1
F_sa2:
    s_sub_u32 s27, s27, 1
    s_cbranch_scc1 F_sg2
    buffer_load_dwordx4 v[32:35], v86, s[16:19], s25 offen offset:2048 sc1
    s_waitcnt vmcnt(0)
    s_branch F_sp2
F_sa3:
    s_sub_u32 s27, s27, 1
    s_cbranch_scc1 F_sg3
    buffer_load_dwordx4 v[36:39], v86, s[16:19], s25 offen offset:3072 sc1
    s_waitcnt vmcnt(0)
    s_branch F_sp3
F_u:
    ds_bpermute_b32 v68, v68, v92
    ds_bpermute_b32 v69, v69, v92
    ds_bpermute_b32 v70, v70, v92
    ds_bpermute_b32 v71, v71, v92
    s_waitcnt lgkmcnt(0)
    v_cmp_lt_i32 vcc, 16, v56
    s_mov_b64 exec, vcc
    s_cbranch_execz F_u0
    v_lshlrev_b32 v80, 3, v80
    v_and_b32 v42, 0x7ff, v42
    v_lshl_add_u32 v42, v42, 5, v90
    v_or_b32 v43, 16, v42
    v_and_b32 v68, 0x7fffffff, v68
    v_mad_u32_u16 v2, v68, 8, v80
    v_mad_u32_u16 v3, v68, 8, v80 op_sel:[1,0,0,0]
    ds_write_b64 v2, v[42:43]
    ds_write_b64 v3, v[40:41]
F_u0:
    s_mov_b64 exec, -1
    v_cmp_lt_i32 vcc, 16, v57
    s_mov_b64 exec, vcc
    s_cbranch_execz F_u1
    v_lshlrev_b32 v81, 3, v81
    v_and_b32 v46, 0x7ff, v46
    v_lshl_add_u32 v46, v46, 5, v90
    v_add_u32 v46, 327680, v46
    v_or_b32 v47, 16, v46
    v_and_b32 v69, 0x7fffffff, v69
    v_mad_u32_u16 v2, v69, 8, v81
    v_mad_u32_u16 v3, v69, 8, v81 op_sel:[1,0,0,0]
    ds_write_b64 v2, v[46:47]
    ds_write_b64 v3, v[44:45]
F_u1:
    s_mov_b64 exec, -1
    v_cmp_lt_i32 vcc, 16, v58
    s_mov_b64 exec, vcc
    s_cbranch_execz F_u2
    v_lshlrev_b32 v82, 3, v82
    v_and_b32 v50, 0x7ff, v50
    v_lshl_add_u32 v50, v50, 5, v90
    v_add_u32 v50, 655360, v50
    v_or_b32 v51, 16, v50
    v_and_b32 v70, 0x7fffffff, v70
    v_mad_u32_u16 v2, v70, 8, v82
    v_mad_u32_u16 v3, v70, 8, v82 op_sel:[1,0,0,0]
    ds_write_b64 v2, v[50:51]
    ds_write_b64 v3, v[48:49]
F_u2:
    s_mov_b64 exec, -1
    v_cmp_lt_i32 vcc, 16, v59
    s_mov_b64 exec, vcc
    s_cbranch_execz F_u3
    v_lshlrev_b32 v83, 3, v83
    v_and_b32 v54, 0x7ff, v54
    v_lshl_add_u32 v54, v54, 5, v90
    v_add_u32 v54, 983040, v54
    v_or_b32 v55, 16, v54
    v_and_b32 v71, 0x7fffffff, v71
    v_mad_u32_u16 v2, v71, 8, v83
    v_mad_u32_u16 v3, v71, 8, v83 op_sel:[1,0,0,0]
    ds_write_b64 v2, v[54:55]
    ds_write_b64 v3, v[52:53]
F_u3:
    s_mov_b64 exec, -1
    s_branch F_ur
LAST0:
    s_cmp_eq_u32 s50, 5
    s_cbranch_scc1 TO_PHASE1
    s_add_u32 s4, s4, 128
    s_addc_u32 s5, s5, 0
    s_add_u32 s8, s8, 128
    s_addc_u32 s9, s9, 0
    s_mov_b32 s34, 0
    s_mov_b32 s35, 256
    s_mov_b32 s36, 512
    s_mov_b32 s37, 768
    s_mov_b32 s33, 0
    s_add_u32 s53, s53, 4
    s_xor_b32 s66, s53, s20
    s_bitcmp1_b32 s66, 2
    s_setprio 1
    s_cbranch_scc1 PRIO_2
    s_setprio 0
PRIO_2:
    s_cmp_eq_u32 s52, 4
    s_cbranch_scc1 ITEM_0_4
    s_cmp_eq_u32 s52, 5
    s_cbranch_scc1 ITEM_0_5
    s_cmp_eq_u32 s52, 3
    s_cbranch_scc1 ITEM_0_3
    s_cmp_eq_u32 s52, 6
    s_cbranch_scc1 ITEM_0_6
    s_cmp_eq_u32 s52, 8
    s_cbranch_scc1 ITEM_0_8
    s_branch ITEM_0_2
TO_PHASE1:
    ds_read_b32 v252, v251 offset:16
    v_lshlrev_b32 v253, 2, v248
    v_add_u32 v253, 65536, v253
    ds_read_b128 v[96:99], v253 offset:0
    ds_read_b128 v[100:103], v253 offset:1024
    ds_read_b128 v[104:107], v253 offset:2048
    ds_read_b128 v[108:111], v253 offset:3072
    ds_read_b128 v[112:115], v253 offset:4096
    ds_read_b128 v[116:119], v253 offset:5120
    ds_read_b128 v[120:123], v253 offset:6144
    ds_read_b128 v[124:127], v253 offset:7168
    ds_read_b128 v[128:131], v253 offset:8192
    ds_read_b128 v[132:135], v253 offset:9216
    ds_read_b128 v[136:139], v253 offset:10240
    ds_read_b128 v[140:143], v253 offset:11264
    ds_read_b128 v[144:147], v253 offset:12288
    ds_read_b128 v[148:151], v253 offset:13312
    ds_read_b128 v[152:155], v253 offset:14336
    ds_read_b128 v[156:159], v253 offset:15360
    ds_read_b128 v[160:163], v253 offset:16384
    ds_read_b128 v[164:167], v253 offset:17408
    ds_read_b128 v[168:171], v253 offset:18432
    ds_read_b128 v[172:175], v253 offset:19456
    s_lshl_b32 s66, s20, 4
    v_xor_b32 v248, s66, v248
    s_mov_b32 s34, 128
    s_mov_b32 s35, 384
    s_mov_b32 s36, 640
    s_mov_b32 s37, 896
    s_mov_b32 s50, 0
    s_mov_b64 vcc, 0
    s_waitcnt lgkmcnt(0)
    s_waitcnt lgkmcnt(0)
    v_readfirstlane_b32 s66, v252
    s_add_u32 s53, s53, 1
    v_mov_b32 v252, s53
    s_cmp_le_u32 s53, s66
    ds_write2_b32 v251, v252, v252 offset0:0 offset1:8
    s_setprio 1
    s_cbranch_scc1 PRIO_3
    s_setprio 0
PRIO_3:
    s_cmp_eq_u32 s52, 4
    s_cbranch_scc1 ITEM_1_4
    s_cmp_eq_u32 s52, 5
    s_cbranch_scc1 ITEM_1_5
    s_cmp_eq_u32 s52, 3
    s_cbranch_scc1 ITEM_1_3
    s_cmp_eq_u32 s52, 6
    s_cbranch_scc1 ITEM_1_6
    s_cmp_eq_u32 s52, 8
    s_cbranch_scc1 ITEM_1_8
    s_branch ITEM_1_2
LAST1:
    s_cmp_eq_u32 s89, 0
    s_cbranch_scc1 T_flagsL
    s_mul_i32 s66, s20, 80
    v_min_u32 v2, 76, v248
    s_mov_b32 s67, 262144
T_pollL:
    buffer_load_dword v3, v2, s[16:19], s66 offen offset:128 sc1
    s_waitcnt vmcnt(0)
    v_cmp_ne_u32 vcc, s88, v3
    s_sub_u32 s67, s67, 1
    s_cselect_b64 vcc, 0, vcc
    s_cmp_eq_u64 vcc, 0
    s_cbranch_scc0 T_pollL
    s_mov_b32 s89, 0
T_flagsL:
    s_lshl_b32 s66, s20, 4
    v_xor_b32 v246, s66, v248
    v_lshlrev_b32 v246, 2, v246
    s_mul_i32 s51, s20, 20480
    s_add_u32 s51, s51, 1024
    s_mov_b64 vcc, -1
    s_load_dwordx2 s[72:73], s[0:1], 72
    s_waitcnt lgkmcnt(7)
    v_readfirstlane_b32 s66, v252
    s_add_u32 s53, s53, 1
    v_mov_b32 v252, s53
    s_cmp_le_u32 s53, s66
    ds_write2_b32 v251, v252, v252 offset0:0 offset1:8
    s_setprio 3
    s_cbranch_scc1 PRIO_4
    s_setprio 2
PRIO_4:
    s_cmp_eq_u32 s52, 4
    s_cbranch_scc1 ITEM_1_4
    s_cmp_eq_u32 s52, 5
    s_cbranch_scc1 ITEM_1_5
    s_cmp_eq_u32 s52, 3
    s_cbranch_scc1 ITEM_1_3
    s_cmp_eq_u32 s52, 6
    s_cbranch_scc1 ITEM_1_6
    s_cmp_eq_u32 s52, 8
    s_cbranch_scc1 ITEM_1_8
    s_branch ITEM_1_2
.p2align 6
ITEM_0_4:
    s_mov_b64 exec, s[54:55]
    ds_read_u16_d16_hi v243, v250 offset:128
    s_mov_b64 exec, -1
    ds_read_b64_tr_b16 v[80:81], v249 offset:512
    ds_read_b64_tr_b16 v[84:85], v249 offset:576
    ds_read_b64_tr_b16 v[82:83], v249 offset:768
    ds_read_b64_tr_b16 v[86:87], v249 offset:832
    s_waitcnt lgkmcnt(5)
    v_mul_f32_dpp v196, v242, v72 row_newbcast:0 row_mask:0xf bank_mask:0xf
    v_mul_f32_dpp v197, v242, v73 row_newbcast:1 row_mask:0xf bank_mask:0xf
    v_mul_f32_dpp v198, v242, v72 row_newbcast:8 row_mask:0xf bank_mask:0xf
    v_mul_f32_dpp v199, v242, v73 row_newbcast:9 row_mask:0xf bank_mask:0xf
    v_mul_f32_dpp v200, v242, v76 row_newbcast:2 row_mask:0xf bank_mask:0xf
    v_mul_f32_dpp v201, v242, v77 row_newbcast:3 row_mask:0xf bank_mask:0xf
    v_mul_f32_dpp v202, v242, v76 row_newbcast:10 row_mask:0xf bank_mask:0xf
    v_mul_f32_dpp v203, v242, v77 row_newbcast:11 row_mask:0xf bank_mask:0xf
    v_cvt_pk_bf16_f32 v72, v196, v197
    v_cvt_pk_bf16_f32 v76, v198, v199
    v_cvt_pk_bf16_f32 v73, v200, v201
    v_cvt_pk_bf16_f32 v77, v202, v203
    v_mul_f32_dpp v196, v242, v74 row_newbcast:4 row_mask:0xf bank_mask:0xf
    v_mul_f32_dpp v197, v242, v75 row_newbcast:5 row_mask:0xf bank_mask:0xf
    v_mul_f32_dpp v198, v242, v74 row_newbcast:12 row_mask:0xf bank_mask:0xf
    v_mul_f32_dpp v199, v242, v75 row_newbcast:13 row_mask:0xf bank_mask:0xf
    v_mul_f32_dpp v200, v242, v78 row_newbcast:6 row_mask:0xf bank_mask:0xf
    v_mul_f32_dpp v201, v242, v79 row_newbcast:7 row_mask:0xf bank_mask:0xf
    v_mul_f32_dpp v202, v242, v78 row_newbcast:14 row_mask:0xf bank_mask:0xf
    v_mul_f32_dpp v203, v242, v79 row_newbcast:15 row_mask:0xf bank_mask:0xf
    v_cvt_pk_bf16_f32 v74, v196, v197
    v_cvt_pk_bf16_f32 v78, v198, v199
    v_cvt_pk_bf16_f32 v75, v200, v201
    v_cvt_pk_bf16_f32 v79, v202, v203
    s_waitcnt vmcnt(4) lgkmcnt(0)
    v_mfma_f32_32x32x16_bf16 v[0:15], v[72:75], v[176:179], 0
    v_mul_f32_dpp v196, v243, v80 row_newbcast:0 row_mask:0xf bank_mask:0xf
    v_mul_f32_dpp v197, v243, v81 row_newbcast:1 row_mask:0xf bank_mask:0xf
    v_mul_f32_dpp v198, v243, v80 row_newbcast:8 row_mask:0xf bank_mask:0xf
    v_mul_f32_dpp v199, v243, v81 row_newbcast:9 row_mask:0xf bank_mask:0xf
    v_mul_f32_dpp v200, v243, v84 row_newbcast:2 row_mask:0xf bank_mask:0xf
    v_mul_f32_dpp v201, v243, v85 row_newbcast:3 row_mask:0xf bank_mask:0xf
    s_add_u32 m0, s21, 0
    v_mfma_f32_32x32x16_bf16 v[48:63], v[76:79], v[176:179], 0
    buffer_load_dwordx4 v234, s[4:7], s36 offen  lds
    buffer_load_dwordx4 v235, s[8:11], s36 offen offset:1024  lds
    ds_read_b64_tr_b16 v[176:177], v244 offset:2048
    ds_read_b64_tr_b16 v[178:179], v244 offset:3072
    ds_read_b64_tr_b16 v[184:185], v245 offset:2048
    ds_read_b64_tr_b16 v[186:187], v245 offset:3072
    v_mul_f32_dpp v202, v243, v84 row_newbcast:10 row_mask:0xf bank_mask:0xf
    v_mul_f32_dpp v203, v243, v85 row_newbcast:11 row_mask:0xf bank_mask:0xf
    v_cvt_pk_bf16_f32 v80, v196, v197
    v_cvt_pk_bf16_f32 v84, v198, v199
    v_cvt_pk_bf16_f32 v81, v200, v201
    v_cvt_pk_bf16_f32 v85, v202, v203
    v_mul_f32_dpp v196, v243, v82 row_newbcast:4 row_mask:0xf bank_mask:0xf
    v_mul_f32_dpp v197, v243, v83 row_newbcast:5 row_mask:0xf bank_mask:0xf
    v_mul_f32_dpp v198, v243, v82 row_newbcast:12 row_mask:0xf bank_mask:0xf
    v_mul_f32_dpp v199, v243, v83 row_newbcast:13 row_mask:0xf bank_mask:0xf
    v_mul_f32_dpp v200, v243, v86 row_newbcast:6 row_mask:0xf bank_mask:0xf
    v_mul_f32_dpp v201, v243, v87 row_newbcast:7 row_mask:0xf bank_mask:0xf
    v_mul_f32_dpp v202, v243, v86 row_newbcast:14 row_mask:0xf bank_mask:0xf
    v_mul_f32_dpp v203, v243, v87 row_newbcast:15 row_mask:0xf bank_mask:0xf
    v_cvt_pk_bf16_f32 v82, v196, v197
    v_cvt_pk_bf16_f32 v86, v198, v199
    v_cvt_pk_bf16_f32 v83, v200, v201
    v_cvt_pk_bf16_f32 v87, v202, v203
    s_waitcnt lgkmcnt(0)
    v_mfma_f32_32x32x16_bf16 v[0:15], v[80:83], v[176:179], v[0:15]
    s_add_u32 m0, s21, 2048
    v_mfma_f32_32x32x16_bf16 v[48:63], v[84:87], v[176:179], v[48:63]
    buffer_load_dwordx4 v236, s[4:7], s36 offen  lds
    buffer_load_dwordx4 v237, s[8:11], s36 offen offset:1024  lds
    s_mov_b32 m0, s50
    s_nop 0
    s_movrels_b32 s71, s23
    s_bfe_u32 s46, s71, 0x30012
    s_mov_b32 m0, s46
    s_and_b32 s66, s71, 0x3ffff
    s_movrels_b32 s68, s57
    s_movrels_b32 s69, s61
    s_sub_u32 s48, s66, s47
    s_mov_b32 s47, s66
    s_lshr_b32 s52, s71, 28
    s_lshl_b32 s67, s46, 9
    s_add_u32 s66, s66, s67
    s_sub_u32 s49, s66, s42
    s_mov_b32 s42, s66
    s_bfe_u32 s66, s68, 655360
    s_add_u32 s43, s42, s66
    s_bfe_u32 s39, s69, 655360
    s_bfe_u32 s66, s68, 655370
    s_add_u32 s44, s42, s66
    s_bfe_u32 s40, s69, 655370
    s_bfe_u32 s66, s68, 655380
    s_add_u32 s45, s42, s66
    s_bfe_u32 s41, s69, 655380
    s_and_b32 s66, s46, s33
    s_cselect_b32 s72, -1, 1
    s_cselect_b32 s76, s47, 163712
    s_cmp_ge_u32 s66, 2
    s_cselect_b32 s73, -1, 0
    s_add_u32 s77, s47, 1024
    s_cmp_ge_u32 s66, 4
    s_cselect_b32 s75, -1, 0
    s_cmp_ge_u32 s66, 3
    s_cselect_b32 s74, -1, 1
    s_cselect_b32 s77, s77, 163712
    v_add_u32 v252, s44, v247
    ds_read2_b32 v[238:239], v252 offset0:0 offset1:16
    v_add_u32 v252, s45, v247
    ds_read2_b32 v[240:241], v252 offset0:0 offset1:16
    v_mfma_f32_32x32x16_bf16 v[16:31], v[72:75], v[180:183], 0
    v_mul_f32 v196, v0, v96
    v_fmac_f32 v196, v1, v97
    v_fmac_f32 v196, v2, v98
    v_fmac_f32 v196, v3, v99
    v_fmac_f32 v196, v4, v100
    v_fmac_f32 v196, v5, v101
    v_mfma_f32_32x32x16_bf16 v[32:47], v[76:79], v[180:183], 0
    s_waitcnt vmcnt(6)
    ds_read_b64_tr_b16 v[176:177], v244 offset:4096
    ds_read_b64_tr_b16 v[178:179], v244 offset:5120
    ds_read_b64_tr_b16 v[180:181], v245 offset:4096
    ds_read_b64_tr_b16 v[182:183], v245 offset:5120
    v_fmac_f32 v196, v6, v102
    v_fmac_f32 v196, v7, v103
    v_mul_f32 v198, v8, v128
    v_fmac_f32 v198, v9, v129
    v_fmac_f32 v198, v10, v130
    v_fmac_f32 v198, v11, v131
    v_fmac_f32 v198, v12, v132
    v_fmac_f32 v198, v13, v133
    v_fmac_f32 v198, v14, v134
    v_fmac_f32 v198, v15, v135
    v_mul_f32 v200, v48, v128
    v_fmac_f32 v200, v49, v129
    v_permlane32_swap_b32 v196, v198
    v_fmac_f32 v200, v50, v130
    v_fmac_f32 v200, v51, v131
    v_fmac_f32 v200, v52, v132
    v_fmac_f32 v200, v53, v133
    v_fmac_f32 v200, v54, v134
    v_mfma_f32_32x32x16_bf16 v[16:31], v[80:83], v[184:187], v[16:31]
    v_fmac_f32 v200, v55, v135
    v_add_f32 v198, v196, v198
    v_mul_f32_e64 v202, v56, -v128
    v_fma_f32 v202, v57, -v129, v202
    v_fma_f32 v202, v58, -v130, v202
    v_fma_f32 v202, v59, -v131, v202
    v_mfma_f32_32x32x16_bf16 v[32:47], v[84:87], v[184:187], v[32:47]
    v_fma_f32 v202, v60, -v132, v202
    v_fma_f32 v202, v61, -v133, v202
    v_fma_f32 v202, v62, -v134, v202
    v_fma_f32 v202, v63, -v135, v202
    s_nop 1
    v_permlane32_swap_b32 v200, v202
    v_add_f32 v202, v200, v202
    s_waitcnt vmcnt(4) lgkmcnt(0)
    v_mfma_f32_32x32x16_bf16 v[0:15], v[72:75], v[176:179], 0
    v_mul_f32 v197, v16, v104
    v_fmac_f32 v197, v17, v105
    v_fmac_f32 v197, v18, v106
    v_fmac_f32 v197, v19, v107
    v_fmac_f32 v197, v20, v108
    v_fmac_f32 v197, v21, v109
    s_add_u32 m0, s21, 4096
    v_mfma_f32_32x32x16_bf16 v[48:63], v[76:79], v[176:179], 0
    buffer_load_dwordx4 v234, s[4:7], s37 offen  lds
    buffer_load_dwordx4 v235, s[8:11], s37 offen offset:1024  lds
    ds_read_b64_tr_b16 v[176:177], v244 offset:6144
    ds_read_b64_tr_b16 v[178:179], v244 offset:7168
    ds_read_b64_tr_b16 v[184:185], v245 offset:6144
    ds_read_b64_tr_b16 v[186:187], v245 offset:7168
    v_add_u32 v252, s42, v247
    ds_read2_b32 v[234:235], v252 offset0:0 offset1:16
    v_fmac_f32 v197, v22, v110
    v_fmac_f32 v197, v23, v111
    v_mul_f32 v199, v24, v136
    v_fmac_f32 v199, v25, v137
    v_fmac_f32 v199, v26, v138
    v_fmac_f32 v199, v27, v139
    v_fmac_f32 v199, v28, v140
    v_fmac_f32 v199, v29, v141
    v_fmac_f32 v199, v30, v142
    v_fmac_f32 v199, v31, v143
    v_mul_f32 v201, v32, v136
    v_fmac_f32 v201, v33, v137
    v_permlane32_swap_b32 v197, v199
    v_fmac_f32 v201, v34, v138
    v_fmac_f32 v201, v35, v139
    v_fmac_f32 v201, v36, v140
    v_fmac_f32 v201, v37, v141
    v_fmac_f32 v201, v38, v142
    v_fmac_f32 v201, v39, v143
    v_add_f32 v199, v197, v199
    v_mul_f32_e64 v203, v40, -v136
    v_fma_f32 v203, v41, -v137, v203
    v_fma_f32 v203, v42, -v138, v203
    v_fma_f32 v203, v43, -v139, v203
    s_waitcnt lgkmcnt(1)
    v_mfma_f32_32x32x16_bf16 v[0:15], v[80:83], v[176:179], v[0:15]
    v_fma_f32 v203, v44, -v140, v203
    v_fma_f32 v203, v45, -v141, v203
    v_fma_f32 v203, v46, -v142, v203
    v_fma_f32 v203, v47, -v143, v203
    s_nop 1
    v_permlane32_swap_b32 v201, v203
    v_add_f32 v203, v201, v203
    s_add_u32 m0, s21, 6144
    v_mfma_f32_32x32x16_bf16 v[48:63], v[84:87], v[176:179], v[48:63]
    buffer_load_dwordx4 v236, s[4:7], s37 offen  lds
    buffer_load_dwordx4 v237, s[8:11], s37 offen offset:1024  lds
    v_add_u32 v252, s43, v247
    ds_read2_b32 v[236:237], v252 offset0:0 offset1:16
    s_set_gpr_idx_on s51, gpr_idx(DST)
    s_nop 0
    v_cvt_pk_bf16_f32 v204, v198, v199
    v_cvt_pk_bf16_f32 v205, v202, v203
    s_set_gpr_idx_off
    v_mfma_f32_32x32x16_bf16 v[16:31], v[72:75], v[180:183], 0
    v_mul_f32 v196, v0, v144
    v_fmac_f32 v196, v1, v145
    v_fmac_f32 v196, v2, v146
    v_fmac_f32 v196, v3, v147
    v_fmac_f32 v196, v4, v148
    v_fmac_f32 v196, v5, v149
    v_mfma_f32_32x32x16_bf16 v[32:47], v[76:79], v[180:183], 0
    s_waitcnt vmcnt(6)
    ds_read_b64_tr_b16 v[176:177], v244 offset:0
    ds_read_b64_tr_b16 v[178:179], v244 offset:1024
    ds_read_b64_tr_b16 v[180:181], v245 offset:0
    ds_read_b64_tr_b16 v[182:183], v245 offset:1024
    v_fmac_f32 v196, v6, v150
    v_fmac_f32 v196, v7, v151
    v_mul_f32 v198, v8, v112
    v_fmac_f32 v198, v9, v113
    v_fmac_f32 v198, v10, v114
    v_fmac_f32 v198, v11, v115
    v_fmac_f32 v198, v12, v116
    v_fmac_f32 v198, v13, v117
    v_fmac_f32 v198, v14, v118
    v_fmac_f32 v198, v15, v119
    v_mul_f32_e64 v200, v48, -v160
    v_fma_f32 v200, v49, -v161, v200
    v_fma_f32 v200, v50, -v162, v200
    v_fma_f32 v200, v51, -v163, v200
    v_mfma_f32_32x32x16_bf16 v[16:31], v[80:83], v[184:187], v[16:31]
    v_fma_f32 v200, v52, -v164, v200
    v_fma_f32 v200, v53, -v165, v200
    v_fma_f32 v200, v54, -v166, v200
    v_fma_f32 v200, v55, -v167, v200
    v_mul_f32_e64 v202, v56, -v160
    v_fma_f32 v202, v57, -v161, v202
    v_mfma_f32_32x32x16_bf16 v[32:47], v[84:87], v[184:187], v[32:47]
    v_fma_f32 v202, v58, -v162, v202
    v_fma_f32 v202, v59, -v163, v202
    v_fma_f32 v202, v60, -v164, v202
    v_fma_f32 v202, v61, -v165, v202
    v_fma_f32 v202, v62, -v166, v202
    v_fma_f32 v202, v63, -v167, v202
    s_waitcnt vmcnt(4) lgkmcnt(0)
    v_mfma_f32_32x32x16_bf16 v[0:15], v[72:75], v[176:179], 0
    v_mul_f32 v197, v16, v152
    v_fmac_f32 v197, v17, v153
    v_fmac_f32 v197, v18, v154
    v_fmac_f32 v197, v19, v155
    v_fmac_f32 v197, v20, v156
    v_fmac_f32 v197, v21, v157
    s_add_u32 m0, s21, 0
    v_mfma_f32_32x32x16_bf16 v[48:63], v[76:79], v[176:179], 0
    v_mad_u32_u16 v234, v234, s3, v246 op_sel:[1,0,0,0]
    v_mad_u32_u16 v235, v235, s3, v246 op_sel:[1,0,0,0]
    buffer_load_dwordx4 v234, s[4:7], s38 offen  lds
    buffer_load_dwordx4 v235, s[8:11], s38 offen offset:1024  lds
    ds_read_b64_tr_b16 v[176:177], v244 offset:2048
    ds_read_b64_tr_b16 v[178:179], v244 offset:3072
    ds_read_b64_tr_b16 v[184:185], v245 offset:2048
    ds_read_b64_tr_b16 v[186:187], v245 offset:3072
    v_fmac_f32 v197, v22, v158
    v_fmac_f32 v197, v23, v159
    v_mul_f32 v199, v24, v120
    v_fmac_f32 v199, v25, v121
    v_fmac_f32 v199, v26, v122
    v_fmac_f32 v199, v27, v123
    v_fmac_f32 v199, v28, v124
    v_fmac_f32 v199, v29, v125
    v_fmac_f32 v199, v30, v126
    v_fmac_f32 v199, v31, v127
    v_mul_f32_e64 v201, v32, -v168
    v_fma_f32 v201, v33, -v169, v201
    v_fma_f32 v201, v34, -v170, v201
    v_fma_f32 v201, v35, -v171, v201
    v_fma_f32 v201, v36, -v172, v201
    v_fma_f32 v201, v37, -v173, v201
    v_fma_f32 v201, v38, -v174, v201
    v_fma_f32 v201, v39, -v175, v201
    s_waitcnt lgkmcnt(0)
    v_mfma_f32_32x32x16_bf16 v[0:15], v[80:83], v[176:179], v[0:15]
    v_mul_f32_e64 v203, v40, -v168
    v_fma_f32 v203, v41, -v169, v203
    v_fma_f32 v203, v42, -v170, v203
    v_fma_f32 v203, v43, -v171, v203
    v_fma_f32 v203, v44, -v172, v203
    v_fma_f32 v203, v45, -v173, v203
    s_add_u32 m0, s21, 2048
    v_mfma_f32_32x32x16_bf16 v[48:63], v[84:87], v[176:179], v[48:63]
    v_mad_u32_u16 v236, v236, s3, v246 op_sel:[1,0,0,0]
    v_mad_u32_u16 v237, v237, s3, v246 op_sel:[1,0,0,0]
    buffer_load_dwordx4 v236, s[4:7], s39 offen  lds
    buffer_load_dwordx4 v237, s[8:11], s39 offen offset:1024  lds
    v_fma_f32 v203, v46, -v174, v203
    v_fma_f32 v203, v47, -v175, v203
    v_mfma_f32_32x32x16_bf16 v[16:31], v[72:75], v[180:183], 0
    v_mul_f32 v254, v0, v144
    v_fmac_f32 v254, v1, v145
    v_fmac_f32 v254, v2, v146
    v_fmac_f32 v254, v3, v147
    v_fmac_f32 v254, v4, v148
    v_fmac_f32 v254, v5, v149
    v_mfma_f32_32x32x16_bf16 v[32:47], v[76:79], v[180:183], 0
    v_add_u32 v253, s47, v248
    ds_read_b32 v192, v253
    ds_read_b32 v193, v253 offset:256
    s_waitcnt vmcnt(6)
    ds_read_b64_tr_b16 v[176:177], v244 offset:4096
    ds_read_b64_tr_b16 v[178:179], v244 offset:5120
    ds_read_b64_tr_b16 v[180:181], v245 offset:4096
    ds_read_b64_tr_b16 v[182:183], v245 offset:5120
    v_fmac_f32 v254, v6, v150
    v_fmac_f32 v254, v7, v151
    v_fmac_f32 v200, v8, v160
    v_fmac_f32 v200, v9, v161
    v_permlane32_swap_b32 v196, v254
    v_fmac_f32 v200, v10, v162
    v_fmac_f32 v200, v11, v163
    v_fmac_f32 v200, v12, v164
    v_mfma_f32_32x32x16_bf16 v[16:31], v[80:83], v[184:187], v[16:31]
    v_fmac_f32 v200, v13, v165
    v_fmac_f32 v200, v14, v166
    v_fmac_f32 v200, v15, v167
    v_add_f32 v254, v196, v254
    v_xor_b32 v64, 0x80000000, v48
    v_xor_b32 v65, 0x80000000, v49
    v_mfma_f32_32x32x16_bf16 v[32:47], v[84:87], v[184:187], v[32:47]
    v_xor_b32 v66, 0x80000000, v50
    v_xor_b32 v67, 0x80000000, v51
    v_xor_b32 v68, 0x80000000, v52
    v_xor_b32 v69, 0x80000000, v53
    v_xor_b32 v70, 0x80000000, v54
    v_xor_b32 v71, 0x80000000, v55
    s_waitcnt vmcnt(4) lgkmcnt(0)
    v_mfma_f32_32x32x16_bf16 v[0:15], v[72:75], v[176:179], 0
    v_mul_f32 v255, v16, v152
    v_fmac_f32 v255, v17, v153
    v_fmac_f32 v255, v18, v154
    v_fmac_f32 v255, v19, v155
    v_fmac_f32 v255, v20, v156
    v_fmac_f32 v255, v21, v157
    s_mov_b32 m0, s76
    s_mov_b64 exec, s[72:73]
    buffer_load_dwordx4 v192, s[12:15], 0 offen  lds
    s_mov_b32 m0, s77
    s_mov_b64 exec, s[74:75]
    buffer_load_dwordx4 v193, s[12:15], 0 offen  lds
    s_mov_b64 exec, -1
    s_add_u32 m0, s21, 4096
    v_mfma_f32_32x32x16_bf16 v[56:71], v[76:79], v[176:179], v[56:71]
    v_mad_u32_u16 v238, v238, s3, v246 op_sel:[1,0,0,0]
    v_mad_u32_u16 v239, v239, s3, v246 op_sel:[1,0,0,0]
    buffer_load_dwordx4 v238, s[4:7], s40 offen  lds
    buffer_load_dwordx4 v239, s[8:11], s40 offen offset:1024  lds
    ds_read_b64_tr_b16 v[176:177], v244 offset:6144
    ds_read_b64_tr_b16 v[178:179], v244 offset:7168
    ds_read_b64_tr_b16 v[184:185], v245 offset:6144
    ds_read_b64_tr_b16 v[186:187], v245 offset:7168
    v_fmac_f32 v255, v22, v158
    v_fmac_f32 v255, v23, v159
    v_fmac_f32 v201, v24, v168
    v_fmac_f32 v201, v25, v169
    v_permlane32_swap_b32 v197, v255
    v_fmac_f32 v201, v26, v170
    v_fmac_f32 v201, v27, v171
    v_fmac_f32 v201, v28, v172
    v_fmac_f32 v201, v29, v173
    v_fmac_f32 v201, v30, v174
    v_fmac_f32 v201, v31, v175
    v_add_f32 v255, v197, v255
    v_xor_b32 v48, 0x80000000, v32
    s_waitcnt lgkmcnt(0)
    v_mfma_f32_32x32x16_bf16 v[0:15], v[80:83], v[176:179], v[0:15]
    v_xor_b32 v49, 0x80000000, v33
    v_xor_b32 v50, 0x80000000, v34
    v_xor_b32 v51, 0x80000000, v35
    v_xor_b32 v52, 0x80000000, v36
    v_xor_b32 v53, 0x80000000, v37
    v_xor_b32 v54, 0x80000000, v38
    s_add_u32 m0, s21, 6144
    v_mfma_f32_32x32x16_bf16 v[56:71], v[84:87], v[176:179], v[56:71]
    v_mad_u32_u16 v240, v240, s3, v246 op_sel:[1,0,0,0]
    v_mad_u32_u16 v241, v241, s3, v246 op_sel:[1,0,0,0]
    buffer_load_dwordx4 v240, s[4:7], s41 offen  lds
    buffer_load_dwordx4 v241, s[8:11], s41 offen offset:1024  lds
    v_xor_b32 v55, 0x80000000, v39
    s_set_gpr_idx_on s51, gpr_idx(DST)
    s_nop 0
    v_cvt_pk_bf16_f32 v206, v254, v255
    s_set_gpr_idx_off
    v_mfma_f32_32x32x16_bf16 v[16:31], v[72:75], v[180:183], 0
    v_mul_f32 v254, v0, v144
    v_fmac_f32 v254, v1, v145
    v_fmac_f32 v254, v2, v146
    v_fmac_f32 v254, v3, v147
    v_fmac_f32 v254, v4, v148
    v_fmac_f32 v254, v5, v149
    v_mfma_f32_32x32x16_bf16 v[40:55], v[76:79], v[180:183], v[40:55]
    s_waitcnt vmcnt(8)
    ds_read_b64_tr_b16 v[176:177], v244 offset:0
    ds_read_b64_tr_b16 v[178:179], v244 offset:1024
    ds_read_b64_tr_b16 v[180:181], v245 offset:0
    ds_read_b64_tr_b16 v[182:183], v245 offset:1024
    v_fmac_f32 v254, v6, v150
    v_fmac_f32 v254, v7, v151
    v_fma_f32 v202, v8, -v160, v202
    v_fma_f32 v202, v9, -v161, v202
    v_permlane32_swap_b32 v254, v200
    v_fma_f32 v202, v10, -v162, v202
    v_fma_f32 v202, v11, -v163, v202
    v_fma_f32 v202, v12, -v164, v202
    v_fma_f32 v202, v13, -v165, v202
    v_fma_f32 v202, v14, -v166, v202
    v_fma_f32 v202, v15, -v167, v202
    v_add_f32 v200, v254, v200
    v_fma_f32 v198, v64, -v112, v198
    v_permlane32_swap_b32 v202, v254
    v_fma_f32 v198, v65, -v113, v198
    v_fma_f32 v198, v66, -v114, v198
    v_fma_f32 v198, v67, -v115, v198
    v_fma_f32 v198, v68, -v116, v198
    v_fma_f32 v198, v69, -v117, v198
    v_fma_f32 v198, v70, -v118, v198
    v_fma_f32 v198, v71, -v119, v198
    v_add_f32 v254, v202, v254
    v_mfma_f32_32x32x16_bf16 v[16:31], v[80:83], v[184:187], v[16:31]
    v_mul_f32 v196, v56, v160
    v_fmac_f32 v196, v57, v161
    v_fmac_f32 v196, v58, v162
    v_fmac_f32 v196, v59, v163
    v_fmac_f32 v196, v60, v164
    v_fmac_f32 v196, v61, v165
    v_mfma_f32_32x32x16_bf16 v[40:55], v[84:87], v[184:187], v[40:55]
    v_add_u32 v249, s48, v249
    v_add_u32 v250, s49, v250
    v_fmac_f32 v196, v62, v166
    v_fmac_f32 v196, v63, v167
    s_nop 1
    v_permlane32_swap_b32 v198, v196
    v_add_f32 v196, v198, v196
    v_mul_f32 v255, v16, v152
    v_fmac_f32 v255, v17, v153
    v_fmac_f32 v255, v18, v154
    v_fmac_f32 v255, v19, v155
    v_fmac_f32 v255, v20, v156
    v_fmac_f32 v255, v21, v157
    v_fmac_f32 v255, v22, v158
    v_fmac_f32 v255, v23, v159
    v_fma_f32 v203, v24, -v168, v203
    v_fma_f32 v203, v25, -v169, v203
    v_permlane32_swap_b32 v255, v201
    v_fma_f32 v203, v26, -v170, v203
    v_fma_f32 v203, v27, -v171, v203
    v_fma_f32 v203, v28, -v172, v203
    v_fma_f32 v203, v29, -v173, v203
    v_fma_f32 v203, v30, -v174, v203
    v_fma_f32 v203, v31, -v175, v203
    v_add_f32 v201, v255, v201
    v_fma_f32 v199, v48, -v120, v199
    v_permlane32_swap_b32 v203, v255
    v_fma_f32 v199, v49, -v121, v199
    v_fma_f32 v199, v50, -v122, v199
    v_fma_f32 v199, v51, -v123, v199
    s_waitcnt vmcnt(4)
    ds_read_b64_tr_b16 v[72:73], v249 offset:0
    ds_read_b64_tr_b16 v[76:77], v249 offset:64
    ds_read_b64_tr_b16 v[74:75], v249 offset:256
    ds_read_b64_tr_b16 v[78:79], v249 offset:320
    s_mov_b64 exec, s[54:55]
    ds_read_u16_d16_hi v242, v250 offset:0
    s_mov_b64 exec, -1
    v_fma_f32 v199, v52, -v124, v199
    v_fma_f32 v199, v53, -v125, v199
    v_fma_f32 v199, v54, -v126, v199
    v_fma_f32 v199, v55, -v127, v199
    v_add_f32 v255, v203, v255
    v_mul_f32 v197, v40, v168
    v_fmac_f32 v197, v41, v169
    v_fmac_f32 v197, v42, v170
    v_fmac_f32 v197, v43, v171
    v_fmac_f32 v197, v44, v172
    v_fmac_f32 v197, v45, v173
    v_fmac_f32 v197, v46, v174
    v_fmac_f32 v197, v47, v175
    s_nop 1
    v_permlane32_swap_b32 v199, v197
    v_add_f32 v197, v199, v197
    s_set_gpr_idx_on s51, gpr_idx(DST)
    s_nop 0
    v_cvt_pk_bf16_f32 v207, v200, v201
    v_cvt_pk_bf16_f32 v209, v254, v255
    v_cvt_pk_bf16_f32 v208, v196, v197
    s_set_gpr_idx_off
    s_add_u32 s50, s50, 1
    s_add_u32 s51, s51, 6
    s_cmp_ge_u32 s50, 4
    s_cbranch_scc1 LAST0
    s_add_u32 s53, s53, 4
    s_xor_b32 s66, s53, s20
    s_bitcmp1_b32 s66, 2
    s_setprio 1
    s_cbranch_scc1 PRIO_5
    s_setprio 0
PRIO_5:
    s_cmp_eq_u32 s52, 4
    s_cbranch_scc1 ITEM_0_4
    s_cmp_eq_u32 s52, 5
    s_cbranch_scc1 ITEM_0_5
    s_cmp_eq_u32 s52, 3
    s_cbranch_scc1 ITEM_0_3
    s_cmp_eq_u32 s52, 6
    s_cbranch_scc1 ITEM_0_6
    s_cmp_eq_u32 s52, 8
    s_cbranch_scc1 ITEM_0_8
    s_branch ITEM_0_2
.p2align 6
ITEM_0_5:
    s_mov_b64 exec, s[54:55]
    ds_read_u16_d16_hi v243, v250 offset:128
    s_mov_b64 exec, -1
    ds_read_b64_tr_b16 v[80:81], v249 offset:512
    ds_read_b64_tr_b16 v[84:85], v249 offset:576
    ds_read_b64_tr_b16 v[82:83], v249 offset:768
    ds_read_b64_tr_b16 v[86:87], v249 offset:832
    ds_read_b64_tr_b16 v[88:89], v249 offset:1024
    ds_read_b64_tr_b16 v[92:93], v249 offset:1088
    s_waitcnt lgkmcnt(7)
    v_mul_f32_dpp v196, v242, v72 row_newbcast:0 row_mask:0xf bank_mask:0xf
    v_mul_f32_dpp v197, v242, v73 row_newbcast:1 row_mask:0xf bank_mask:0xf
    v_mul_f32_dpp v198, v242, v72 row_newbcast:8 row_mask:0xf bank_mask:0xf
    v_mul_f32_dpp v199, v242, v73 row_newbcast:9 row_mask:0xf bank_mask:0xf
    v_mul_f32_dpp v200, v242, v76 row_newbcast:2 row_mask:0xf bank_mask:0xf
    v_mul_f32_dpp v201, v242, v77 row_newbcast:3 row_mask:0xf bank_mask:0xf
    v_mul_f32_dpp v202, v242, v76 row_newbcast:10 row_mask:0xf bank_mask:0xf
    v_mul_f32_dpp v203, v242, v77 row_newbcast:11 row_mask:0xf bank_mask:0xf
    v_cvt_pk_bf16_f32 v72, v196, v197
    v_cvt_pk_bf16_f32 v76, v198, v199
    v_cvt_pk_bf16_f32 v73, v200, v201
    v_cvt_pk_bf16_f32 v77, v202, v203
    v_mul_f32_dpp v196, v242, v74 row_newbcast:4 row_mask:0xf bank_mask:0xf
    v_mul_f32_dpp v197, v242, v75 row_newbcast:5 row_mask:0xf bank_mask:0xf
    v_mul_f32_dpp v198, v242, v74 row_newbcast:12 row_mask:0xf bank_mask:0xf
    v_mul_f32_dpp v199, v242, v75 row_newbcast:13 row_mask:0xf bank_mask:0xf
    v_mul_f32_dpp v200, v242, v78 row_newbcast:6 row_mask:0xf bank_mask:0xf
    v_mul_f32_dpp v201, v242, v79 row_newbcast:7 row_mask:0xf bank_mask:0xf
    v_mul_f32_dpp v202, v242, v78 row_newbcast:14 row_mask:0xf bank_mask:0xf
    v_mul_f32_dpp v203, v242, v79 row_newbcast:15 row_mask:0xf bank_mask:0xf
    v_cvt_pk_bf16_f32 v74, v196, v197
    v_cvt_pk_bf16_f32 v78, v198, v199
    v_cvt_pk_bf16_f32 v75, v200, v201
    v_cvt_pk_bf16_f32 v79, v202, v203
    s_mov_b64 exec, s[54:55]
    ds_read_u16_d16_hi v242, v250 offset:256
    s_mov_b64 exec, -1
    s_waitcnt vmcnt(4) lgkmcnt(3)
    v_mfma_f32_32x32x16_bf16 v[0:15], v[72:75], v[176:179], 0
    v_mul_f32_dpp v196, v243, v80 row_newbcast:0 row_mask:0xf bank_mask:0xf
    v_mul_f32_dpp v197, v243, v81 row_newbcast:1 row_mask:0xf bank_mask:0xf
    v_mul_f32_dpp v198, v243, v80 row_newbcast:8 row_mask:0xf bank_mask:0xf
    v_mul_f32_dpp v199, v243, v81 row_newbcast:9 row_mask:0xf bank_mask:0xf
    v_mul_f32_dpp v200, v243, v84 row_newbcast:2 row_mask:0xf bank_mask:0xf
    v_mul_f32_dpp v201, v243, v85 row_newbcast:3 row_mask:0xf bank_mask:0xf
    s_add_u32 m0, s21, 0
    v_mfma_f32_32x32x16_bf16 v[48:63], v[76:79], v[176:179], 0
    buffer_load_dwordx4 v236, s[4:7], s35 offen  lds
    buffer_load_dwordx4 v237, s[8:11], s35 offen offset:1024  lds
    ds_read_b64_tr_b16 v[176:177], v244 offset:2048
    ds_read_b64_tr_b16 v[178:179], v244 offset:3072
    ds_read_b64_tr_b16 v[184:185], v245 offset:2048
    ds_read_b64_tr_b16 v[186:187], v245 offset:3072
    v_mul_f32_dpp v202, v243, v84 row_newbcast:10 row_mask:0xf bank_mask:0xf
    v_mul_f32_dpp v203, v243, v85 row_newbcast:11 row_mask:0xf bank_mask:0xf
    v_cvt_pk_bf16_f32 v80, v196, v197
    v_cvt_pk_bf16_f32 v84, v198, v199
    v_cvt_pk_bf16_f32 v81, v200, v201
    v_cvt_pk_bf16_f32 v85, v202, v203
    v_mul_f32_dpp v196, v243, v82 row_newbcast:4 row_mask:0xf bank_mask:0xf
    v_mul_f32_dpp v197, v243, v83 row_newbcast:5 row_mask:0xf bank_mask:0xf
    v_mul_f32_dpp v198, v243, v82 row_newbcast:12 row_mask:0xf bank_mask:0xf
    v_mul_f32_dpp v199, v243, v83 row_newbcast:13 row_mask:0xf bank_mask:0xf
    v_mul_f32_dpp v200, v243, v86 row_newbcast:6 row_mask:0xf bank_mask:0xf
    v_mul_f32_dpp v201, v243, v87 row_newbcast:7 row_mask:0xf bank_mask:0xf
    v_mul_f32_dpp v202, v243, v86 row_newbcast:14 row_mask:0xf bank_mask:0xf
    v_mul_f32_dpp v203, v243, v87 row_newbcast:15 row_mask:0xf bank_mask:0xf
    v_cvt_pk_bf16_f32 v82, v196, v197
    v_cvt_pk_bf16_f32 v86, v198, v199
    v_cvt_pk_bf16_f32 v83, v200, v201
    v_cvt_pk_bf16_f32 v87, v202, v203
    s_waitcnt vmcnt(4) lgkmcnt(0)
    v_mfma_f32_32x32x16_bf16 v[0:15], v[80:83], v[176:179], v[0:15]
    v_mul_f32_dpp v196, v242, v88 row_newbcast:0 row_mask:0xf bank_mask:0xf
    v_mul_f32_dpp v197, v242, v89 row_newbcast:1 row_mask:0xf bank_mask:0xf
    v_mul_f32_dpp v198, v242, v88 row_newbcast:8 row_mask:0xf bank_mask:0xf
    v_mul_f32_dpp v199, v242, v89 row_newbcast:9 row_mask:0xf bank_mask:0xf
    v_mul_f32_dpp v200, v242, v92 row_newbcast:2 row_mask:0xf bank_mask:0xf
    v_mul_f32_dpp v201, v242, v93 row_newbcast:3 row_mask:0xf bank_mask:0xf
    s_add_u32 m0, s21, 2048
    v_mfma_f32_32x32x16_bf16 v[48:63], v[84:87], v[176:179], v[48:63]
    buffer_load_dwordx4 v238, s[4:7], s35 offen  lds
    ds_read_b64_tr_b16 v[176:177], v244 offset:4096
    ds_read_b64_tr_b16 v[188:189], v245 offset:4096
    v_mul_f32_dpp v202, v242, v92 row_newbcast:10 row_mask:0xf bank_mask:0xf
    v_mul_f32_dpp v203, v242, v93 row_newbcast:11 row_mask:0xf bank_mask:0xf
    v_cvt_pk_bf16_f32 v88, v196, v197
    v_cvt_pk_bf16_f32 v92, v198, v199
    v_cvt_pk_bf16_f32 v89, v200, v201
    v_cvt_pk_bf16_f32 v93, v202, v203
    s_waitcnt lgkmcnt(0)
    v_mfma_f32_32x32x8_bf16 v[0:15], v[88:89], v[176:177], v[0:15]
    s_add_u32 m0, s21, 4096
    v_mfma_f32_32x32x8_bf16 v[48:63], v[92:93], v[176:177], v[48:63]
    buffer_load_dwordx4 v234, s[4:7], s36 offen  lds
    buffer_load_dwordx4 v235, s[8:11], s36 offen offset:1024  lds
    s_mov_b32 m0, s50
    s_nop 0
    s_movrels_b32 s71, s23
    s_bfe_u32 s46, s71, 0x30012
    s_mov_b32 m0, s46
    s_and_b32 s66, s71, 0x3ffff
    s_movrels_b32 s68, s57
    s_movrels_b32 s69, s61
    s_sub_u32 s48, s66, s47
    s_mov_b32 s47, s66
    s_lshr_b32 s52, s71, 28
    s_lshl_b32 s67, s46, 9
    s_add_u32 s66, s66, s67
    s_sub_u32 s49, s66, s42
    s_mov_b32 s42, s66
    s_bfe_u32 s66, s68, 655360
    s_add_u32 s43, s42, s66
    s_bfe_u32 s39, s69, 655360
    s_bfe_u32 s66, s68, 655370
    s_add_u32 s44, s42, s66
    s_bfe_u32 s40, s69, 655370
    s_bfe_u32 s66, s68, 655380
    s_add_u32 s45, s42, s66
    s_bfe_u32 s41, s69, 655380
    s_and_b32 s66, s46, s33
    s_cselect_b32 s72, -1, 1
    s_cselect_b32 s76, s47, 163712
    s_cmp_ge_u32 s66, 2
    s_cselect_b32 s73, -1, 0
    s_add_u32 s77, s47, 1024
    s_cmp_ge_u32 s66, 4
    s_cselect_b32 s75, -1, 0
    s_cmp_ge_u32 s66, 3
    s_cselect_b32 s74, -1, 1
    s_cselect_b32 s77, s77, 163712
    v_add_u32 v252, s45, v247
    ds_read2_b32 v[240:241], v252 offset0:0 offset1:16
    v_mfma_f32_32x32x16_bf16 v[16:31], v[72:75], v[180:183], 0
    v_mul_f32 v196, v0, v96
    v_fmac_f32 v196, v1, v97
    v_fmac_f32 v196, v2, v98
    v_fmac_f32 v196, v3, v99
    v_fmac_f32 v196, v4, v100
    v_fmac_f32 v196, v5, v101
    v_mfma_f32_32x32x16_bf16 v[32:47], v[76:79], v[180:183], 0
    v_fmac_f32 v196, v6, v102
    v_fmac_f32 v196, v7, v103
    v_mul_f32 v198, v8, v128
    v_fmac_f32 v198, v9, v129
    v_fmac_f32 v198, v10, v130
    v_fmac_f32 v198, v11, v131
    v_fmac_f32 v198, v12, v132
    v_fmac_f32 v198, v13, v133
    v_fmac_f32 v198, v14, v134
    v_fmac_f32 v198, v15, v135
    v_mfma_f32_32x32x16_bf16 v[16:31], v[80:83], v[184:187], v[16:31]
    v_mul_f32 v200, v48, v128
    v_fmac_f32 v200, v49, v129
    v_permlane32_swap_b32 v196, v198
    v_fmac_f32 v200, v50, v130
    v_fmac_f32 v200, v51, v131
    v_fmac_f32 v200, v52, v132
    v_mfma_f32_32x32x16_bf16 v[32:47], v[84:87], v[184:187], v[32:47]
    s_waitcnt vmcnt(5)
    ds_read_b64_tr_b16 v[176:177], v244 offset:6144
    ds_read_b64_tr_b16 v[178:179], v244 offset:7168
    ds_read_b64_tr_b16 v[180:181], v245 offset:6144
    ds_read_b64_tr_b16 v[182:183], v245 offset:7168
    v_fmac_f32 v200, v53, v133
    v_fmac_f32 v200, v54, v134
    v_mfma_f32_32x32x8_bf16 v[16:31], v[88:89], v[188:189], v[16:31]
    v_fmac_f32 v200, v55, v135
    v_add_f32 v198, v196, v198
    v_mul_f32_e64 v202, v56, -v128
    v_fma_f32 v202, v57, -v129, v202
    v_fma_f32 v202, v58, -v130, v202
    v_fma_f32 v202, v59, -v131, v202
    v_mfma_f32_32x32x8_bf16 v[32:47], v[92:93], v[188:189], v[32:47]
    v_fma_f32 v202, v60, -v132, v202
    v_fma_f32 v202, v61, -v133, v202
    v_fma_f32 v202, v62, -v134, v202
    v_fma_f32 v202, v63, -v135, v202
    s_nop 1
    v_permlane32_swap_b32 v200, v202
    v_add_f32 v202, v200, v202
    s_waitcnt vmcnt(3) lgkmcnt(0)
    v_mfma_f32_32x32x16_bf16 v[0:15], v[72:75], v[176:179], 0
    v_mul_f32 v197, v16, v104
    v_fmac_f32 v197, v17, v105
    v_fmac_f32 v197, v18, v106
    v_fmac_f32 v197, v19, v107
    v_fmac_f32 v197, v20, v108
    v_fmac_f32 v197, v21, v109
    s_add_u32 m0, s21, 6144
    v_mfma_f32_32x32x16_bf16 v[48:63], v[76:79], v[176:179], 0
    buffer_load_dwordx4 v236, s[4:7], s36 offen  lds
    buffer_load_dwordx4 v237, s[8:11], s36 offen offset:1024  lds
    ds_read_b64_tr_b16 v[176:177], v244 offset:0
    ds_read_b64_tr_b16 v[178:179], v244 offset:1024
    ds_read_b64_tr_b16 v[184:185], v245 offset:0
    ds_read_b64_tr_b16 v[186:187], v245 offset:1024
    v_fmac_f32 v197, v22, v110
    v_fmac_f32 v197, v23, v111
    v_mul_f32 v199, v24, v136
    v_fmac_f32 v199, v25, v137
    v_fmac_f32 v199, v26, v138
    v_fmac_f32 v199, v27, v139
    v_fmac_f32 v199, v28, v140
    v_fmac_f32 v199, v29, v141
    v_fmac_f32 v199, v30, v142
    v_fmac_f32 v199, v31, v143
    v_mul_f32 v201, v32, v136
    v_fmac_f32 v201, v33, v137
    v_permlane32_swap_b32 v197, v199
    v_fmac_f32 v201, v34, v138
    v_fmac_f32 v201, v35, v139
    s_waitcnt vmcnt(4) lgkmcnt(0)
    v_mfma_f32_32x32x16_bf16 v[0:15], v[80:83], v[176:179], v[0:15]
    v_fmac_f32 v201, v36, v140
    v_fmac_f32 v201, v37, v141
    v_fmac_f32 v201, v38, v142
    v_fmac_f32 v201, v39, v143
    v_add_f32 v199, v197, v199
    v_mul_f32_e64 v203, v40, -v136
    s_add_u32 m0, s21, 0
    v_mfma_f32_32x32x16_bf16 v[48:63], v[84:87], v[176:179], v[48:63]
    buffer_load_dwordx4 v238, s[4:7], s36 offen  lds
    ds_read_b64_tr_b16 v[176:177], v244 offset:2048
    ds_read_b64_tr_b16 v[188:189], v245 offset:2048
    v_fma_f32 v203, v41, -v137, v203
    v_fma_f32 v203, v42, -v138, v203
    v_fma_f32 v203, v43, -v139, v203
    s_waitcnt lgkmcnt(0)
    v_mfma_f32_32x32x8_bf16 v[0:15], v[88:89], v[176:177], v[0:15]
    v_fma_f32 v203, v44, -v140, v203
    v_fma_f32 v203, v45, -v141, v203
    v_fma_f32 v203, v46, -v142, v203
    v_fma_f32 v203, v47, -v143, v203
    s_nop 1
    v_permlane32_swap_b32 v201, v203
    v_add_f32 v203, v201, v203
    s_add_u32 m0, s21, 2048
    v_mfma_f32_32x32x8_bf16 v[48:63], v[92:93], v[176:177], v[48:63]
    buffer_load_dwordx4 v234, s[4:7], s37 offen  lds
    buffer_load_dwordx4 v235, s[8:11], s37 offen offset:1024  lds
    v_add_u32 v252, s42, v247
    ds_read2_b32 v[234:235], v252 offset0:0 offset1:16
    s_set_gpr_idx_on s51, gpr_idx(DST)
    s_nop 0
    v_cvt_pk_bf16_f32 v204, v198, v199
    v_cvt_pk_bf16_f32 v205, v202, v203
    s_set_gpr_idx_off
    v_mfma_f32_32x32x16_bf16 v[16:31], v[72:75], v[180:183], 0
    v_mul_f32 v196, v0, v144
    v_fmac_f32 v196, v1, v145
    v_fmac_f32 v196, v2, v146
    v_fmac_f32 v196, v3, v147
    v_fmac_f32 v196, v4, v148
    v_fmac_f32 v196, v5, v149
    v_mfma_f32_32x32x16_bf16 v[32:47], v[76:79], v[180:183], 0
    v_fmac_f32 v196, v6, v150
    v_fmac_f32 v196, v7, v151
    v_mul_f32 v198, v8, v112
    v_fmac_f32 v198, v9, v113
    v_fmac_f32 v198, v10, v114
    v_fmac_f32 v198, v11, v115
    v_mfma_f32_32x32x16_bf16 v[16:31], v[80:83], v[184:187], v[16:31]
    v_fmac_f32 v198, v12, v116
    v_fmac_f32 v198, v13, v117
    v_fmac_f32 v198, v14, v118
    v_fmac_f32 v198, v15, v119
    v_mul_f32_e64 v200, v48, -v160
    v_fma_f32 v200, v49, -v161, v200
    v_mfma_f32_32x32x16_bf16 v[32:47], v[84:87], v[184:187], v[32:47]
    s_waitcnt vmcnt(5)
    ds_read_b64_tr_b16 v[176:177], v244 offset:4096
    ds_read_b64_tr_b16 v[178:179], v244 offset:5120
    ds_read_b64_tr_b16 v[180:181], v245 offset:4096
    ds_read_b64_tr_b16 v[182:183], v245 offset:5120
    v_fma_f32 v200, v50, -v162, v200
    v_fma_f32 v200, v51, -v163, v200
    v_mfma_f32_32x32x8_bf16 v[16:31], v[88:89], v[188:189], v[16:31]
    v_fma_f32 v200, v52, -v164, v200
    v_fma_f32 v200, v53, -v165, v200
    v_fma_f32 v200, v54, -v166, v200
    v_fma_f32 v200, v55, -v167, v200
    v_mul_f32_e64 v202, v56, -v160
    v_fma_f32 v202, v57, -v161, v202
    v_mfma_f32_32x32x8_bf16 v[32:47], v[92:93], v[188:189], v[32:47]
    v_fma_f32 v202, v58, -v162, v202
    v_fma_f32 v202, v59, -v163, v202
    v_fma_f32 v202, v60, -v164, v202
    v_fma_f32 v202, v61, -v165, v202
    v_fma_f32 v202, v62, -v166, v202
    v_fma_f32 v202, v63, -v167, v202
    s_waitcnt vmcnt(3) lgkmcnt(0)
    v_mfma_f32_32x32x16_bf16 v[0:15], v[72:75], v[176:179], 0
    v_mul_f32 v197, v16, v152
    v_fmac_f32 v197, v17, v153
    v_fmac_f32 v197, v18, v154
    v_fmac_f32 v197, v19, v155
    v_fmac_f32 v197, v20, v156
    v_fmac_f32 v197, v21, v157
    s_add_u32 m0, s21, 4096
    v_mfma_f32_32x32x16_bf16 v[48:63], v[76:79], v[176:179], 0
    buffer_load_dwordx4 v236, s[4:7], s37 offen  lds
    buffer_load_dwordx4 v237, s[8:11], s37 offen offset:1024  lds
    ds_read_b64_tr_b16 v[176:177], v244 offset:6144
    ds_read_b64_tr_b16 v[178:179], v244 offset:7168
    ds_read_b64_tr_b16 v[184:185], v245 offset:6144
    ds_read_b64_tr_b16 v[186:187], v245 offset:7168
    v_add_u32 v252, s43, v247
    ds_read2_b32 v[236:237], v252 offset0:0 offset1:16
    v_fmac_f32 v197, v22, v158
    v_fmac_f32 v197, v23, v159
    v_mul_f32 v199, v24, v120
    v_fmac_f32 v199, v25, v121
    v_fmac_f32 v199, v26, v122
    v_fmac_f32 v199, v27, v123
    v_fmac_f32 v199, v28, v124
    v_fmac_f32 v199, v29, v125
    v_fmac_f32 v199, v30, v126
    v_fmac_f32 v199, v31, v127
    v_mul_f32_e64 v201, v32, -v168
    s_waitcnt vmcnt(4) lgkmcnt(1)
    v_mfma_f32_32x32x16_bf16 v[0:15], v[80:83], v[176:179], v[0:15]
    v_fma_f32 v201, v33, -v169, v201
    v_fma_f32 v201, v34, -v170, v201
    v_fma_f32 v201, v35, -v171, v201
    v_fma_f32 v201, v36, -v172, v201
    v_fma_f32 v201, v37, -v173, v201
    v_fma_f32 v201, v38, -v174, v201
    s_add_u32 m0, s21, 6144
    v_mfma_f32_32x32x16_bf16 v[48:63], v[84:87], v[176:179], v[48:63]
    buffer_load_dwordx4 v238, s[4:7], s37 offen  lds
    ds_read_b64_tr_b16 v[176:177], v244 offset:0
    ds_read_b64_tr_b16 v[188:189], v245 offset:0
    v_add_u32 v252, s44, v247
    ds_read2_b32 v[238:239], v252 offset0:0 offset1:16
    v_fma_f32 v201, v39, -v175, v201
    s_waitcnt lgkmcnt(1)
    v_mfma_f32_32x32x8_bf16 v[0:15], v[88:89], v[176:177], v[0:15]
    v_mul_f32_e64 v203, v40, -v168
    v_fma_f32 v203, v41, -v169, v203
    v_fma_f32 v203, v42, -v170, v203
    v_fma_f32 v203, v43, -v171, v203
    v_fma_f32 v203, v44, -v172, v203
    v_fma_f32 v203, v45, -v173, v203
    s_add_u32 m0, s21, 0
    v_mfma_f32_32x32x8_bf16 v[48:63], v[92:93], v[176:177], v[48:63]
    v_mad_u32_u16 v234, v234, s3, v246 op_sel:[1,0,0,0]
    v_mad_u32_u16 v235, v235, s3, v246 op_sel:[1,0,0,0]
    buffer_load_dwordx4 v234, s[4:7], s38 offen  lds
    buffer_load_dwordx4 v235, s[8:11], s38 offen offset:1024  lds
    v_fma_f32 v203, v46, -v174, v203
    v_fma_f32 v203, v47, -v175, v203
    v_mfma_f32_32x32x16_bf16 v[16:31], v[72:75], v[180:183], 0
    v_mul_f32 v254, v0, v144
    v_fmac_f32 v254, v1, v145
    v_fmac_f32 v254, v2, v146
    v_fmac_f32 v254, v3, v147
    v_fmac_f32 v254, v4, v148
    v_fmac_f32 v254, v5, v149
    v_mfma_f32_32x32x16_bf16 v[32:47], v[76:79], v[180:183], 0
    v_add_u32 v253, s47, v248
    ds_read_b32 v192, v253
    ds_read_b32 v193, v253 offset:256
    v_mfma_f32_32x32x16_bf16 v[16:31], v[80:83], v[184:187], v[16:31]
    v_fmac_f32 v254, v6, v150
    v_fmac_f32 v254, v7, v151
    v_fmac_f32 v200, v8, v160
    v_fmac_f32 v200, v9, v161
    v_permlane32_swap_b32 v196, v254
    v_fmac_f32 v200, v10, v162
    v_mfma_f32_32x32x16_bf16 v[32:47], v[84:87], v[184:187], v[32:47]
    s_waitcnt vmcnt(5)
    ds_read_b64_tr_b16 v[176:177], v244 offset:2048
    ds_read_b64_tr_b16 v[178:179], v244 offset:3072
    ds_read_b64_tr_b16 v[180:181], v245 offset:2048
    ds_read_b64_tr_b16 v[182:183], v245 offset:3072
    v_fmac_f32 v200, v11, v163
    v_fmac_f32 v200, v12, v164
    v_mfma_f32_32x32x8_bf16 v[16:31], v[88:89], v[188:189], v[16:31]
    v_fmac_f32 v200, v13, v165
    v_fmac_f32 v200, v14, v166
    v_fmac_f32 v200, v15, v167
    v_add_f32 v254, v196, v254
    v_xor_b32 v64, 0x80000000, v48
    v_xor_b32 v65, 0x80000000, v49
    v_mfma_f32_32x32x8_bf16 v[32:47], v[92:93], v[188:189], v[32:47]
    v_xor_b32 v66, 0x80000000, v50
    v_xor_b32 v67, 0x80000000, v51
    v_xor_b32 v68, 0x80000000, v52
    v_xor_b32 v69, 0x80000000, v53
    v_xor_b32 v70, 0x80000000, v54
    v_xor_b32 v71, 0x80000000, v55
    s_waitcnt vmcnt(3) lgkmcnt(0)
    v_mfma_f32_32x32x16_bf16 v[0:15], v[72:75], v[176:179], 0
    v_mul_f32 v255, v16, v152
    v_fmac_f32 v255, v17, v153
    v_fmac_f32 v255, v18, v154
    v_fmac_f32 v255, v19, v155
    v_fmac_f32 v255, v20, v156
    v_fmac_f32 v255, v21, v157
    s_mov_b32 m0, s76
    s_mov_b64 exec, s[72:73]
    buffer_load_dwordx4 v192, s[12:15], 0 offen  lds
    s_mov_b32 m0, s77
    s_mov_b64 exec, s[74:75]
    buffer_load_dwordx4 v193, s[12:15], 0 offen  lds
    s_mov_b64 exec, -1
    s_add_u32 m0, s21, 2048
    v_mfma_f32_32x32x16_bf16 v[56:71], v[76:79], v[176:179], v[56:71]
    v_mad_u32_u16 v236, v236, s3, v246 op_sel:[1,0,0,0]
    v_mad_u32_u16 v237, v237, s3, v246 op_sel:[1,0,0,0]
    buffer_load_dwordx4 v236, s[4:7], s39 offen  lds
    buffer_load_dwordx4 v237, s[8:11], s39 offen offset:1024  lds
    ds_read_b64_tr_b16 v[176:177], v244 offset:4096
    ds_read_b64_tr_b16 v[178:179], v244 offset:5120
    ds_read_b64_tr_b16 v[184:185], v245 offset:4096
    ds_read_b64_tr_b16 v[186:187], v245 offset:5120
    v_fmac_f32 v255, v22, v158
    v_fmac_f32 v255, v23, v159
    v_fmac_f32 v201, v24, v168
    v_fmac_f32 v201, v25, v169
    v_permlane32_swap_b32 v197, v255
    v_fmac_f32 v201, v26, v170
    v_fmac_f32 v201, v27, v171
    s_waitcnt vmcnt(6) lgkmcnt(0)
    v_mfma_f32_32x32x16_bf16 v[0:15], v[80:83], v[176:179], v[0:15]
    v_fmac_f32 v201, v28, v172
    v_fmac_f32 v201, v29, v173
    v_fmac_f32 v201, v30, v174
    v_fmac_f32 v201, v31, v175
    v_add_f32 v255, v197, v255
    v_xor_b32 v48, 0x80000000, v32
    s_add_u32 m0, s21, 4096
    v_mfma_f32_32x32x16_bf16 v[56:71], v[84:87], v[176:179], v[56:71]
    v_mad_u32_u16 v238, v238, s3, v246 op_sel:[1,0,0,0]
    v_mad_u32_u16 v239, v239, s3, v246 op_sel:[1,0,0,0]
    buffer_load_dwordx4 v238, s[4:7], s40 offen  lds
    buffer_load_dwordx4 v239, s[8:11], s40 offen offset:1024  lds
    ds_read_b64_tr_b16 v[176:177], v244 offset:6144
    ds_read_b64_tr_b16 v[188:189], v245 offset:6144
    s_waitcnt lgkmcnt(0)
    v_mfma_f32_32x32x8_bf16 v[0:15], v[88:89], v[176:177], v[0:15]
    v_xor_b32 v49, 0x80000000, v33
    v_xor_b32 v50, 0x80000000, v34
    v_xor_b32 v51, 0x80000000, v35
    v_xor_b32 v52, 0x80000000, v36
    v_xor_b32 v53, 0x80000000, v37
    v_xor_b32 v54, 0x80000000, v38
    s_add_u32 m0, s21, 6144
    v_mfma_f32_32x32x8_bf16 v[56:71], v[92:93], v[176:177], v[56:71]
    v_mad_u32_u16 v240, v240, s3, v246 op_sel:[1,0,0,0]
    v_mad_u32_u16 v241, v241, s3, v246 op_sel:[1,0,0,0]
    buffer_load_dwordx4 v240, s[4:7], s41 offen  lds
    buffer_load_dwordx4 v241, s[8:11], s41 offen offset:1024  lds
    v_xor_b32 v55, 0x80000000, v39
    s_set_gpr_idx_on s51, gpr_idx(DST)
    s_nop 0
    v_cvt_pk_bf16_f32 v206, v254, v255
    s_set_gpr_idx_off
    v_mfma_f32_32x32x16_bf16 v[16:31], v[72:75], v[180:183], 0
    v_mul_f32 v254, v0, v144
    v_fmac_f32 v254, v1, v145
    v_fmac_f32 v254, v2, v146
    v_fmac_f32 v254, v3, v147
    v_fmac_f32 v254, v4, v148
    v_fmac_f32 v254, v5, v149
    v_mfma_f32_32x32x16_bf16 v[40:55], v[76:79], v[180:183], v[40:55]
    v_fmac_f32 v254, v6, v150
    v_fmac_f32 v254, v7, v151
    v_fma_f32 v202, v8, -v160, v202
    v_fma_f32 v202, v9, -v161, v202
    v_permlane32_swap_b32 v254, v200
    v_fma_f32 v202, v10, -v162, v202
    v_fma_f32 v202, v11, -v163, v202
    v_fma_f32 v202, v12, -v164, v202
    v_fma_f32 v202, v13, -v165, v202
    v_fma_f32 v202, v14, -v166, v202
    v_fma_f32 v202, v15, -v167, v202
    v_add_f32 v200, v254, v200
    v_fma_f32 v198, v64, -v112, v198
    v_permlane32_swap_b32 v202, v254
    v_mfma_f32_32x32x16_bf16 v[16:31], v[80:83], v[184:187], v[16:31]
    v_fma_f32 v198, v65, -v113, v198
    v_fma_f32 v198, v66, -v114, v198
    v_fma_f32 v198, v67, -v115, v198
    v_fma_f32 v198, v68, -v116, v198
    v_fma_f32 v198, v69, -v117, v198
    v_fma_f32 v198, v70, -v118, v198
    v_mfma_f32_32x32x16_bf16 v[40:55], v[84:87], v[184:187], v[40:55]
    s_waitcnt vmcnt(8)
    ds_read_b64_tr_b16 v[176:177], v244 offset:0
    ds_read_b64_tr_b16 v[178:179], v244 offset:1024
    ds_read_b64_tr_b16 v[180:181], v245 offset:0
    ds_read_b64_tr_b16 v[182:183], v245 offset:1024
    v_fma_f32 v198, v71, -v119, v198
    v_add_f32 v254, v202, v254
    v_mfma_f32_32x32x8_bf16 v[16:31], v[88:89], v[188:189], v[16:31]
    v_mul_f32 v196, v56, v160
    v_fmac_f32 v196, v57, v161
    v_fmac_f32 v196, v58, v162
    v_fmac_f32 v196, v59, v163
    v_fmac_f32 v196, v60, v164
    v_fmac_f32 v196, v61, v165
    v_mfma_f32_32x32x8_bf16 v[40:55], v[92:93], v[188:189], v[40:55]
    v_add_u32 v249, s48, v249
    v_add_u32 v250, s49, v250
    v_fmac_f32 v196, v62, v166
    v_fmac_f32 v196, v63, v167
    s_nop 1
    v_permlane32_swap_b32 v198, v196
    v_add_f32 v196, v198, v196
    v_mul_f32 v255, v16, v152
    v_fmac_f32 v255, v17, v153
    v_fmac_f32 v255, v18, v154
    v_fmac_f32 v255, v19, v155
    v_fmac_f32 v255, v20, v156
    v_fmac_f32 v255, v21, v157
    v_fmac_f32 v255, v22, v158
    v_fmac_f32 v255, v23, v159
    v_fma_f32 v203, v24, -v168, v203
    v_fma_f32 v203, v25, -v169, v203
    v_permlane32_swap_b32 v255, v201
    v_fma_f32 v203, v26, -v170, v203
    v_fma_f32 v203, v27, -v171, v203
    v_fma_f32 v203, v28, -v172, v203
    v_fma_f32 v203, v29, -v173, v203
    v_fma_f32 v203, v30, -v174, v203
    v_fma_f32 v203, v31, -v175, v203
    v_add_f32 v201, v255, v201
    v_fma_f32 v199, v48, -v120, v199
    v_permlane32_swap_b32 v203, v255
    v_fma_f32 v199, v49, -v121, v199
    v_fma_f32 v199, v50, -v122, v199
    v_fma_f32 v199, v51, -v123, v199
    s_waitcnt vmcnt(6)
    ds_read_b64_tr_b16 v[72:73], v249 offset:0
    ds_read_b64_tr_b16 v[76:77], v249 offset:64
    ds_read_b64_tr_b16 v[74:75], v249 offset:256
    ds_read_b64_tr_b16 v[78:79], v249 offset:320
    s_mov_b64 exec, s[54:55]
    ds_read_u16_d16_hi v242, v250 offset:0
    s_mov_b64 exec, -1
    v_fma_f32 v199, v52, -v124, v199
    v_fma_f32 v199, v53, -v125, v199
    v_fma_f32 v199, v54, -v126, v199
    v_fma_f32 v199, v55, -v127, v199
    v_add_f32 v255, v203, v255
    v_mul_f32 v197, v40, v168
    v_fmac_f32 v197, v41, v169
    v_fmac_f32 v197, v42, v170
    v_fmac_f32 v197, v43, v171
    v_fmac_f32 v197, v44, v172
    v_fmac_f32 v197, v45, v173
    v_fmac_f32 v197, v46, v174
    v_fmac_f32 v197, v47, v175
    s_nop 1
    v_permlane32_swap_b32 v199, v197
    v_add_f32 v197, v199, v197
    s_set_gpr_idx_on s51, gpr_idx(DST)
    s_nop 0
    v_cvt_pk_bf16_f32 v207, v200, v201
    v_cvt_pk_bf16_f32 v209, v254, v255
    v_cvt_pk_bf16_f32 v208, v196, v197
    s_set_gpr_idx_off
    s_add_u32 s50, s50, 1
    s_add_u32 s51, s51, 6
    s_cmp_ge_u32 s50, 4
    s_cbranch_scc1 LAST0
    s_add_u32 s53, s53, 4
    s_xor_b32 s66, s53, s20
    s_bitcmp1_b32 s66, 2
    s_setprio 1
    s_cbranch_scc1 PRIO_6
    s_setprio 0
PRIO_6:
    s_cmp_eq_u32 s52, 4
    s_cbranch_scc1 ITEM_0_4
    s_cmp_eq_u32 s52, 5
    s_cbranch_scc1 ITEM_0_5
    s_cmp_eq_u32 s52, 3
    s_cbranch_scc1 ITEM_0_3
    s_cmp_eq_u32 s52, 6
    s_cbranch_scc1 ITEM_0_6
    s_cmp_eq_u32 s52, 8
    s_cbranch_scc1 ITEM_0_8
    s_branch ITEM_0_2
.p2align 6
ITEM_0_3:
    s_mov_b64 exec, s[54:55]
    ds_read_u16_d16_hi v243, v250 offset:128
    s_mov_b64 exec, -1
    ds_read_b64_tr_b16 v[80:81], v249 offset:512
    ds_read_b64_tr_b16 v[84:85], v249 offset:576
    s_waitcnt lgkmcnt(3)
    v_mul_f32_dpp v196, v242, v72 row_newbcast:0 row_mask:0xf bank_mask:0xf
    v_mul_f32_dpp v197, v242, v73 row_newbcast:1 row_mask:0xf bank_mask:0xf
    v_mul_f32_dpp v198, v242, v72 row_newbcast:8 row_mask:0xf bank_mask:0xf
    v_mul_f32_dpp v199, v242, v73 row_newbcast:9 row_mask:0xf bank_mask:0xf
    v_mul_f32_dpp v200, v242, v76 row_newbcast:2 row_mask:0xf bank_mask:0xf
    v_mul_f32_dpp v201, v242, v77 row_newbcast:3 row_mask:0xf bank_mask:0xf
    v_mul_f32_dpp v202, v242, v76 row_newbcast:10 row_mask:0xf bank_mask:0xf
    v_mul_f32_dpp v203, v242, v77 row_newbcast:11 row_mask:0xf bank_mask:0xf
    v_cvt_pk_bf16_f32 v72, v196, v197
    v_cvt_pk_bf16_f32 v76, v198, v199
    v_cvt_pk_bf16_f32 v73, v200, v201
    v_cvt_pk_bf16_f32 v77, v202, v203
    v_mul_f32_dpp v196, v242, v74 row_newbcast:4 row_mask:0xf bank_mask:0xf
    v_mul_f32_dpp v197, v242, v75 row_newbcast:5 row_mask:0xf bank_mask:0xf
    v_mul_f32_dpp v198, v242, v74 row_newbcast:12 row_mask:0xf bank_mask:0xf
    v_mul_f32_dpp v199, v242, v75 row_newbcast:13 row_mask:0xf bank_mask:0xf
    v_mul_f32_dpp v200, v242, v78 row_newbcast:6 row_mask:0xf bank_mask:0xf
    v_mul_f32_dpp v201, v242, v79 row_newbcast:7 row_mask:0xf bank_mask:0xf
    v_mul_f32_dpp v202, v242, v78 row_newbcast:14 row_mask:0xf bank_mask:0xf
    v_mul_f32_dpp v203, v242, v79 row_newbcast:15 row_mask:0xf bank_mask:0xf
    v_cvt_pk_bf16_f32 v74, v196, v197
    v_cvt_pk_bf16_f32 v78, v198, v199
    v_cvt_pk_bf16_f32 v75, v200, v201
    v_cvt_pk_bf16_f32 v79, v202, v203
    s_waitcnt vmcnt(4) lgkmcnt(0)
    v_mfma_f32_32x32x16_bf16 v[0:15], v[72:75], v[176:179], 0
    v_mul_f32_dpp v196, v243, v80 row_newbcast:0 row_mask:0xf bank_mask:0xf
    v_mul_f32_dpp v197, v243, v81 row_newbcast:1 row_mask:0xf bank_mask:0xf
    v_mul_f32_dpp v198, v243, v80 row_newbcast:8 row_mask:0xf bank_mask:0xf
    v_mul_f32_dpp v199, v243, v81 row_newbcast:9 row_mask:0xf bank_mask:0xf
    v_mul_f32_dpp v200, v243, v84 row_newbcast:2 row_mask:0xf bank_mask:0xf
    v_mul_f32_dpp v201, v243, v85 row_newbcast:3 row_mask:0xf bank_mask:0xf
    s_add_u32 m0, s21, 0
    v_mfma_f32_32x32x16_bf16 v[48:63], v[76:79], v[176:179], 0
    buffer_load_dwordx4 v234, s[4:7], s36 offen  lds
    buffer_load_dwordx4 v235, s[8:11], s36 offen offset:1024  lds
    ds_read_b64_tr_b16 v[176:177], v244 offset:2048
    ds_read_b64_tr_b16 v[184:185], v245 offset:2048
    v_mul_f32_dpp v202, v243, v84 row_newbcast:10 row_mask:0xf bank_mask:0xf
    v_mul_f32_dpp v203, v243, v85 row_newbcast:11 row_mask:0xf bank_mask:0xf
    v_cvt_pk_bf16_f32 v80, v196, v197
    v_cvt_pk_bf16_f32 v84, v198, v199
    v_cvt_pk_bf16_f32 v81, v200, v201
    v_cvt_pk_bf16_f32 v85, v202, v203
    s_waitcnt lgkmcnt(0)
    v_mfma_f32_32x32x8_bf16 v[0:15], v[80:81], v[176:177], v[0:15]
    s_add_u32 m0, s21, 2048
    v_mfma_f32_32x32x8_bf16 v[48:63], v[84:85], v[176:177], v[48:63]
    buffer_load_dwordx4 v236, s[4:7], s36 offen  lds
    s_mov_b32 m0, s50
    s_nop 0
    s_movrels_b32 s71, s23
    s_bfe_u32 s46, s71, 0x30012
    s_mov_b32 m0, s46
    s_and_b32 s66, s71, 0x3ffff
    s_movrels_b32 s68, s57
    s_movrels_b32 s69, s61
    s_sub_u32 s48, s66, s47
    s_mov_b32 s47, s66
    s_lshr_b32 s52, s71, 28
    s_lshl_b32 s67, s46, 9
    s_add_u32 s66, s66, s67
    s_sub_u32 s49, s66, s42
    s_mov_b32 s42, s66
    s_bfe_u32 s66, s68, 655360
    s_add_u32 s43, s42, s66
    s_bfe_u32 s39, s69, 655360
    s_bfe_u32 s66, s68, 655370
    s_add_u32 s44, s42, s66
    s_bfe_u32 s40, s69, 655370
    s_bfe_u32 s66, s68, 655380
    s_add_u32 s45, s42, s66
    s_bfe_u32 s41, s69, 655380
    s_and_b32 s66, s46, s33
    s_cselect_b32 s72, -1, 1
    s_cselect_b32 s76, s47, 163712
    s_cmp_ge_u32 s66, 2
    s_cselect_b32 s73, -1, 0
    s_add_u32 s77, s47, 1024
    s_cmp_ge_u32 s66, 4
    s_cselect_b32 s75, -1, 0
    s_cmp_ge_u32 s66, 3
    s_cselect_b32 s74, -1, 1
    s_cselect_b32 s77, s77, 163712
    v_add_u32 v252, s44, v247
    ds_read2_b32 v[238:239], v252 offset0:0 offset1:16
    v_add_u32 v252, s45, v247
    ds_read2_b32 v[240:241], v252 offset0:0 offset1:16
    v_mfma_f32_32x32x16_bf16 v[16:31], v[72:75], v[180:183], 0
    v_mul_f32 v196, v0, v96
    v_fmac_f32 v196, v1, v97
    v_fmac_f32 v196, v2, v98
    v_fmac_f32 v196, v3, v99
    v_fmac_f32 v196, v4, v100
    v_fmac_f32 v196, v5, v101
    v_mfma_f32_32x32x16_bf16 v[32:47], v[76:79], v[180:183], 0
    s_waitcnt vmcnt(5)
    ds_read_b64_tr_b16 v[176:177], v244 offset:4096
    ds_read_b64_tr_b16 v[178:179], v244 offset:5120
    ds_read_b64_tr_b16 v[180:181], v245 offset:4096
    ds_read_b64_tr_b16 v[182:183], v245 offset:5120
    v_fmac_f32 v196, v6, v102
    v_fmac_f32 v196, v7, v103
    v_mul_f32 v198, v8, v128
    v_fmac_f32 v198, v9, v129
    v_fmac_f32 v198, v10, v130
    v_fmac_f32 v198, v11, v131
    v_fmac_f32 v198, v12, v132
    v_fmac_f32 v198, v13, v133
    v_fmac_f32 v198, v14, v134
    v_fmac_f32 v198, v15, v135
    v_mul_f32 v200, v48, v128
    v_fmac_f32 v200, v49, v129
    v_permlane32_swap_b32 v196, v198
    v_fmac_f32 v200, v50, v130
    v_fmac_f32 v200, v51, v131
    v_fmac_f32 v200, v52, v132
    v_fmac_f32 v200, v53, v133
    v_fmac_f32 v200, v54, v134
    v_mfma_f32_32x32x8_bf16 v[16:31], v[80:81], v[184:185], v[16:31]
    v_fmac_f32 v200, v55, v135
    v_add_f32 v198, v196, v198
    v_mul_f32_e64 v202, v56, -v128
    v_fma_f32 v202, v57, -v129, v202
    v_fma_f32 v202, v58, -v130, v202
    v_fma_f32 v202, v59, -v131, v202
    v_mfma_f32_32x32x8_bf16 v[32:47], v[84:85], v[184:185], v[32:47]
    v_fma_f32 v202, v60, -v132, v202
    v_fma_f32 v202, v61, -v133, v202
    v_fma_f32 v202, v62, -v134, v202
    v_fma_f32 v202, v63, -v135, v202
    s_nop 1
    v_permlane32_swap_b32 v200, v202
    v_add_f32 v202, v200, v202
    s_waitcnt vmcnt(3) lgkmcnt(0)
    v_mfma_f32_32x32x16_bf16 v[0:15], v[72:75], v[176:179], 0
    v_mul_f32 v197, v16, v104
    v_fmac_f32 v197, v17, v105
    v_fmac_f32 v197, v18, v106
    v_fmac_f32 v197, v19, v107
    v_fmac_f32 v197, v20, v108
    v_fmac_f32 v197, v21, v109
    s_add_u32 m0, s21, 4096
    v_mfma_f32_32x32x16_bf16 v[48:63], v[76:79], v[176:179], 0
    buffer_load_dwordx4 v234, s[4:7], s37 offen  lds
    buffer_load_dwordx4 v235, s[8:11], s37 offen offset:1024  lds
    ds_read_b64_tr_b16 v[176:177], v244 offset:6144
    ds_read_b64_tr_b16 v[184:185], v245 offset:6144
    v_add_u32 v252, s42, v247
    ds_read2_b32 v[234:235], v252 offset0:0 offset1:16
    v_fmac_f32 v197, v22, v110
    v_fmac_f32 v197, v23, v111
    v_mul_f32 v199, v24, v136
    v_fmac_f32 v199, v25, v137
    v_fmac_f32 v199, v26, v138
    v_fmac_f32 v199, v27, v139
    v_fmac_f32 v199, v28, v140
    v_fmac_f32 v199, v29, v141
    v_fmac_f32 v199, v30, v142
    v_fmac_f32 v199, v31, v143
    v_mul_f32 v201, v32, v136
    v_fmac_f32 v201, v33, v137
    v_permlane32_swap_b32 v197, v199
    v_fmac_f32 v201, v34, v138
    v_fmac_f32 v201, v35, v139
    v_fmac_f32 v201, v36, v140
    v_fmac_f32 v201, v37, v141
    v_fmac_f32 v201, v38, v142
    v_fmac_f32 v201, v39, v143
    v_add_f32 v199, v197, v199
    v_mul_f32_e64 v203, v40, -v136
    v_fma_f32 v203, v41, -v137, v203
    v_fma_f32 v203, v42, -v138, v203
    s_waitcnt lgkmcnt(1)
    v_mfma_f32_32x32x8_bf16 v[0:15], v[80:81], v[176:177], v[0:15]
    v_fma_f32 v203, v43, -v139, v203
    v_fma_f32 v203, v44, -v140, v203
    v_fma_f32 v203, v45, -v141, v203
    v_fma_f32 v203, v46, -v142, v203
    v_fma_f32 v203, v47, -v143, v203
    s_nop 1
    v_permlane32_swap_b32 v201, v203
    s_add_u32 m0, s21, 6144
    v_mfma_f32_32x32x8_bf16 v[48:63], v[84:85], v[176:177], v[48:63]
    buffer_load_dwordx4 v236, s[4:7], s37 offen  lds
    v_add_u32 v252, s43, v247
    ds_read2_b32 v[236:237], v252 offset0:0 offset1:16
    v_add_f32 v203, v201, v203
    s_set_gpr_idx_on s51, gpr_idx(DST)
    s_nop 0
    v_cvt_pk_bf16_f32 v204, v198, v199
    v_cvt_pk_bf16_f32 v205, v202, v203
    s_set_gpr_idx_off
    v_mfma_f32_32x32x16_bf16 v[16:31], v[72:75], v[180:183], 0
    v_mul_f32 v196, v0, v144
    v_fmac_f32 v196, v1, v145
    v_fmac_f32 v196, v2, v146
    v_fmac_f32 v196, v3, v147
    v_fmac_f32 v196, v4, v148
    v_fmac_f32 v196, v5, v149
    v_mfma_f32_32x32x16_bf16 v[32:47], v[76:79], v[180:183], 0
    s_waitcnt vmcnt(4)
    ds_read_b64_tr_b16 v[176:177], v244 offset:0
    ds_read_b64_tr_b16 v[178:179], v244 offset:1024
    ds_read_b64_tr_b16 v[180:181], v245 offset:0
    ds_read_b64_tr_b16 v[182:183], v245 offset:1024
    v_fmac_f32 v196, v6, v150
    v_fmac_f32 v196, v7, v151
    v_mul_f32 v198, v8, v112
    v_fmac_f32 v198, v9, v113
    v_fmac_f32 v198, v10, v114
    v_fmac_f32 v198, v11, v115
    v_fmac_f32 v198, v12, v116
    v_fmac_f32 v198, v13, v117
    v_fmac_f32 v198, v14, v118
    v_fmac_f32 v198, v15, v119
    v_mul_f32_e64 v200, v48, -v160
    v_fma_f32 v200, v49, -v161, v200
    v_fma_f32 v200, v50, -v162, v200
    v_fma_f32 v200, v51, -v163, v200
    v_mfma_f32_32x32x8_bf16 v[16:31], v[80:81], v[184:185], v[16:31]
    v_fma_f32 v200, v52, -v164, v200
    v_fma_f32 v200, v53, -v165, v200
    v_fma_f32 v200, v54, -v166, v200
    v_fma_f32 v200, v55, -v167, v200
    v_mul_f32_e64 v202, v56, -v160
    v_fma_f32 v202, v57, -v161, v202
    v_mfma_f32_32x32x8_bf16 v[32:47], v[84:85], v[184:185], v[32:47]
    v_fma_f32 v202, v58, -v162, v202
    v_fma_f32 v202, v59, -v163, v202
    v_fma_f32 v202, v60, -v164, v202
    v_fma_f32 v202, v61, -v165, v202
    v_fma_f32 v202, v62, -v166, v202
    v_fma_f32 v202, v63, -v167, v202
    s_waitcnt vmcnt(3) lgkmcnt(0)
    v_mfma_f32_32x32x16_bf16 v[0:15], v[72:75], v[176:179], 0
    v_mul_f32 v197, v16, v152
    v_fmac_f32 v197, v17, v153
    v_fmac_f32 v197, v18, v154
    v_fmac_f32 v197, v19, v155
    v_fmac_f32 v197, v20, v156
    v_fmac_f32 v197, v21, v157
    s_add_u32 m0, s21, 0
    v_mfma_f32_32x32x16_bf16 v[48:63], v[76:79], v[176:179], 0
    v_mad_u32_u16 v234, v234, s3, v246 op_sel:[1,0,0,0]
    v_mad_u32_u16 v235, v235, s3, v246 op_sel:[1,0,0,0]
    buffer_load_dwordx4 v234, s[4:7], s38 offen  lds
    buffer_load_dwordx4 v235, s[8:11], s38 offen offset:1024  lds
    ds_read_b64_tr_b16 v[176:177], v244 offset:2048
    ds_read_b64_tr_b16 v[184:185], v245 offset:2048
    v_fmac_f32 v197, v22, v158
    v_fmac_f32 v197, v23, v159
    v_mul_f32 v199, v24, v120
    v_fmac_f32 v199, v25, v121
    v_fmac_f32 v199, v26, v122
    v_fmac_f32 v199, v27, v123
    v_fmac_f32 v199, v28, v124
    v_fmac_f32 v199, v29, v125
    v_fmac_f32 v199, v30, v126
    v_fmac_f32 v199, v31, v127
    v_mul_f32_e64 v201, v32, -v168
    v_fma_f32 v201, v33, -v169, v201
    v_fma_f32 v201, v34, -v170, v201
    v_fma_f32 v201, v35, -v171, v201
    v_fma_f32 v201, v36, -v172, v201
    v_fma_f32 v201, v37, -v173, v201
    v_fma_f32 v201, v38, -v174, v201
    v_fma_f32 v201, v39, -v175, v201
    s_waitcnt lgkmcnt(0)
    v_mfma_f32_32x32x8_bf16 v[0:15], v[80:81], v[176:177], v[0:15]
    v_mul_f32_e64 v203, v40, -v168
    v_fma_f32 v203, v41, -v169, v203
    v_fma_f32 v203, v42, -v170, v203
    v_fma_f32 v203, v43, -v171, v203
    v_fma_f32 v203, v44, -v172, v203
    v_fma_f32 v203, v45, -v173, v203
    s_add_u32 m0, s21, 2048
    v_mfma_f32_32x32x8_bf16 v[48:63], v[84:85], v[176:177], v[48:63]
    v_mad_u32_u16 v236, v236, s3, v246 op_sel:[1,0,0,0]
    v_mad_u32_u16 v237, v237, s3, v246 op_sel:[1,0,0,0]
    buffer_load_dwordx4 v236, s[4:7], s39 offen  lds
    buffer_load_dwordx4 v237, s[8:11], s39 offen offset:1024  lds
    v_fma_f32 v203, v46, -v174, v203
    v_fma_f32 v203, v47, -v175, v203
    v_mfma_f32_32x32x16_bf16 v[16:31], v[72:75], v[180:183], 0
    v_mul_f32 v254, v0, v144
    v_fmac_f32 v254, v1, v145
    v_fmac_f32 v254, v2, v146
    v_fmac_f32 v254, v3, v147
    v_fmac_f32 v254, v4, v148
    v_fmac_f32 v254, v5, v149
    v_mfma_f32_32x32x16_bf16 v[32:47], v[76:79], v[180:183], 0
    v_add_u32 v253, s47, v248
    ds_read_b32 v192, v253
    ds_read_b32 v193, v253 offset:256
    s_waitcnt vmcnt(5)
    ds_read_b64_tr_b16 v[176:177], v244 offset:4096
    ds_read_b64_tr_b16 v[178:179], v244 offset:5120
    ds_read_b64_tr_b16 v[180:181], v245 offset:4096
    ds_read_b64_tr_b16 v[182:183], v245 offset:5120
    v_fmac_f32 v254, v6, v150
    v_fmac_f32 v254, v7, v151
    v_fmac_f32 v200, v8, v160
    v_fmac_f32 v200, v9, v161
    v_permlane32_swap_b32 v196, v254
    v_fmac_f32 v200, v10, v162
    v_fmac_f32 v200, v11, v163
    v_fmac_f32 v200, v12, v164
    v_mfma_f32_32x32x8_bf16 v[16:31], v[80:81], v[184:185], v[16:31]
    v_fmac_f32 v200, v13, v165
    v_fmac_f32 v200, v14, v166
    v_fmac_f32 v200, v15, v167
    v_add_f32 v254, v196, v254
    v_xor_b32 v64, 0x80000000, v48
    v_xor_b32 v65, 0x80000000, v49
    v_mfma_f32_32x32x8_bf16 v[32:47], v[84:85], v[184:185], v[32:47]
    v_xor_b32 v66, 0x80000000, v50
    v_xor_b32 v67, 0x80000000, v51
    v_xor_b32 v68, 0x80000000, v52
    v_xor_b32 v69, 0x80000000, v53
    v_xor_b32 v70, 0x80000000, v54
    v_xor_b32 v71, 0x80000000, v55
    s_waitcnt vmcnt(4) lgkmcnt(0)
    v_mfma_f32_32x32x16_bf16 v[0:15], v[72:75], v[176:179], 0
    v_mul_f32 v255, v16, v152
    v_fmac_f32 v255, v17, v153
    v_fmac_f32 v255, v18, v154
    v_fmac_f32 v255, v19, v155
    v_fmac_f32 v255, v20, v156
    v_fmac_f32 v255, v21, v157
    s_mov_b32 m0, s76
    s_mov_b64 exec, s[72:73]
    buffer_load_dwordx4 v192, s[12:15], 0 offen  lds
    s_mov_b32 m0, s77
    s_mov_b64 exec, s[74:75]
    buffer_load_dwordx4 v193, s[12:15], 0 offen  lds
    s_mov_b64 exec, -1
    s_add_u32 m0, s21, 4096
    v_mfma_f32_32x32x16_bf16 v[56:71], v[76:79], v[176:179], v[56:71]
    v_mad_u32_u16 v238, v238, s3, v246 op_sel:[1,0,0,0]
    v_mad_u32_u16 v239, v239, s3, v246 op_sel:[1,0,0,0]
    buffer_load_dwordx4 v238, s[4:7], s40 offen  lds
    buffer_load_dwordx4 v239, s[8:11], s40 offen offset:1024  lds
    ds_read_b64_tr_b16 v[176:177], v244 offset:6144
    ds_read_b64_tr_b16 v[184:185], v245 offset:6144
    v_fmac_f32 v255, v22, v158
    v_fmac_f32 v255, v23, v159
    v_fmac_f32 v201, v24, v168
    v_fmac_f32 v201, v25, v169
    v_permlane32_swap_b32 v197, v255
    v_fmac_f32 v201, v26, v170
    v_fmac_f32 v201, v27, v171
    v_fmac_f32 v201, v28, v172
    v_fmac_f32 v201, v29, v173
    v_fmac_f32 v201, v30, v174
    v_fmac_f32 v201, v31, v175
    v_add_f32 v255, v197, v255
    v_xor_b32 v48, 0x80000000, v32
    s_waitcnt lgkmcnt(0)
    v_mfma_f32_32x32x8_bf16 v[0:15], v[80:81], v[176:177], v[0:15]
    v_xor_b32 v49, 0x80000000, v33
    v_xor_b32 v50, 0x80000000, v34
    v_xor_b32 v51, 0x80000000, v35
    v_xor_b32 v52, 0x80000000, v36
    v_xor_b32 v53, 0x80000000, v37
    v_xor_b32 v54, 0x80000000, v38
    s_add_u32 m0, s21, 6144
    v_mfma_f32_32x32x8_bf16 v[56:71], v[84:85], v[176:177], v[56:71]
    v_mad_u32_u16 v240, v240, s3, v246 op_sel:[1,0,0,0]
    v_mad_u32_u16 v241, v241, s3, v246 op_sel:[1,0,0,0]
    buffer_load_dwordx4 v240, s[4:7], s41 offen  lds
    buffer_load_dwordx4 v241, s[8:11], s41 offen offset:1024  lds
    v_xor_b32 v55, 0x80000000, v39
    s_set_gpr_idx_on s51, gpr_idx(DST)
    s_nop 0
    v_cvt_pk_bf16_f32 v206, v254, v255
    s_set_gpr_idx_off
    v_mfma_f32_32x32x16_bf16 v[16:31], v[72:75], v[180:183], 0
    v_mul_f32 v254, v0, v144
    v_fmac_f32 v254, v1, v145
    v_fmac_f32 v254, v2, v146
    v_fmac_f32 v254, v3, v147
    v_fmac_f32 v254, v4, v148
    v_fmac_f32 v254, v5, v149
    v_mfma_f32_32x32x16_bf16 v[40:55], v[76:79], v[180:183], v[40:55]
    s_waitcnt vmcnt(8)
    ds_read_b64_tr_b16 v[176:177], v244 offset:0
    ds_read_b64_tr_b16 v[178:179], v244 offset:1024
    ds_read_b64_tr_b16 v[180:181], v245 offset:0
    ds_read_b64_tr_b16 v[182:183], v245 offset:1024
    v_fmac_f32 v254, v6, v150
    v_fmac_f32 v254, v7, v151
    v_fma_f32 v202, v8, -v160, v202
    v_fma_f32 v202, v9, -v161, v202
    v_permlane32_swap_b32 v254, v200
    v_fma_f32 v202, v10, -v162, v202
    v_fma_f32 v202, v11, -v163, v202
    v_fma_f32 v202, v12, -v164, v202
    v_fma_f32 v202, v13, -v165, v202
    v_fma_f32 v202, v14, -v166, v202
    v_fma_f32 v202, v15, -v167, v202
    v_add_f32 v200, v254, v200
    v_fma_f32 v198, v64, -v112, v198
    v_permlane32_swap_b32 v202, v254
    v_fma_f32 v198, v65, -v113, v198
    v_fma_f32 v198, v66, -v114, v198
    v_fma_f32 v198, v67, -v115, v198
    v_fma_f32 v198, v68, -v116, v198
    v_fma_f32 v198, v69, -v117, v198
    v_fma_f32 v198, v70, -v118, v198
    v_fma_f32 v198, v71, -v119, v198
    v_add_f32 v254, v202, v254
    v_mfma_f32_32x32x8_bf16 v[16:31], v[80:81], v[184:185], v[16:31]
    v_mul_f32 v196, v56, v160
    v_fmac_f32 v196, v57, v161
    v_fmac_f32 v196, v58, v162
    v_fmac_f32 v196, v59, v163
    v_fmac_f32 v196, v60, v164
    v_fmac_f32 v196, v61, v165
    v_mfma_f32_32x32x8_bf16 v[40:55], v[84:85], v[184:185], v[40:55]
    v_add_u32 v249, s48, v249
    v_add_u32 v250, s49, v250
    v_fmac_f32 v196, v62, v166
    v_fmac_f32 v196, v63, v167
    s_nop 1
    v_permlane32_swap_b32 v198, v196
    v_add_f32 v196, v198, v196
    v_mul_f32 v255, v16, v152
    v_fmac_f32 v255, v17, v153
    v_fmac_f32 v255, v18, v154
    v_fmac_f32 v255, v19, v155
    v_fmac_f32 v255, v20, v156
    v_fmac_f32 v255, v21, v157
    v_fmac_f32 v255, v22, v158
    v_fmac_f32 v255, v23, v159
    v_fma_f32 v203, v24, -v168, v203
    v_fma_f32 v203, v25, -v169, v203
    v_permlane32_swap_b32 v255, v201
    v_fma_f32 v203, v26, -v170, v203
    v_fma_f32 v203, v27, -v171, v203
    v_fma_f32 v203, v28, -v172, v203
    v_fma_f32 v203, v29, -v173, v203
    v_fma_f32 v203, v30, -v174, v203
    v_fma_f32 v203, v31, -v175, v203
    v_add_f32 v201, v255, v201
    v_fma_f32 v199, v48, -v120, v199
    v_permlane32_swap_b32 v203, v255
    v_fma_f32 v199, v49, -v121, v199
    v_fma_f32 v199, v50, -v122, v199
    v_fma_f32 v199, v51, -v123, v199
    s_waitcnt vmcnt(4)
    ds_read_b64_tr_b16 v[72:73], v249 offset:0
    ds_read_b64_tr_b16 v[76:77], v249 offset:64
    ds_read_b64_tr_b16 v[74:75], v249 offset:256
    ds_read_b64_tr_b16 v[78:79], v249 offset:320
    s_mov_b64 exec, s[54:55]
    ds_read_u16_d16_hi v242, v250 offset:0
    s_mov_b64 exec, -1
    v_fma_f32 v199, v52, -v124, v199
    v_fma_f32 v199, v53, -v125, v199
    v_fma_f32 v199, v54, -v126, v199
    v_fma_f32 v199, v55, -v127, v199
    v_add_f32 v255, v203, v255
    v_mul_f32 v197, v40, v168
    v_fmac_f32 v197, v41, v169
    v_fmac_f32 v197, v42, v170
    v_fmac_f32 v197, v43, v171
    v_fmac_f32 v197, v44, v172
    v_fmac_f32 v197, v45, v173
    v_fmac_f32 v197, v46, v174
    v_fmac_f32 v197, v47, v175
    s_nop 1
    v_permlane32_swap_b32 v199, v197
    v_add_f32 v197, v199, v197
    s_set_gpr_idx_on s51, gpr_idx(DST)
    s_nop 0
    v_cvt_pk_bf16_f32 v207, v200, v201
    v_cvt_pk_bf16_f32 v209, v254, v255
    v_cvt_pk_bf16_f32 v208, v196, v197
    s_set_gpr_idx_off
    s_add_u32 s50, s50, 1
    s_add_u32 s51, s51, 6
    s_cmp_ge_u32 s50, 4
    s_cbranch_scc1 LAST0
    s_add_u32 s53, s53, 4
    s_xor_b32 s66, s53, s20
    s_bitcmp1_b32 s66, 2
    s_setprio 1
    s_cbranch_scc1 PRIO_7
    s_setprio 0
PRIO_7:
    s_cmp_eq_u32 s52, 4
    s_cbranch_scc1 ITEM_0_4
    s_cmp_eq_u32 s52, 5
    s_cbranch_scc1 ITEM_0_5
    s_cmp_eq_u32 s52, 3
    s_cbranch_scc1 ITEM_0_3
    s_cmp_eq_u32 s52, 6
    s_cbranch_scc1 ITEM_0_6
    s_cmp_eq_u32 s52, 8
    s_cbranch_scc1 ITEM_0_8
    s_branch ITEM_0_2
.p2align 6
ITEM_0_6:
    s_mov_b64 exec, s[54:55]
    ds_read_u16_d16_hi v243, v250 offset:128
    s_mov_b64 exec, -1
    ds_read_b64_tr_b16 v[80:81], v249 offset:512
    ds_read_b64_tr_b16 v[84:85], v249 offset:576
    ds_read_b64_tr_b16 v[82:83], v249 offset:768
    ds_read_b64_tr_b16 v[86:87], v249 offset:832
    ds_read_b64_tr_b16 v[88:89], v249 offset:1024
    ds_read_b64_tr_b16 v[92:93], v249 offset:1088
    ds_read_b64_tr_b16 v[90:91], v249 offset:1280
    ds_read_b64_tr_b16 v[94:95], v249 offset:1344
    s_waitcnt lgkmcnt(9)
    v_mul_f32_dpp v196, v242, v72 row_newbcast:0 row_mask:0xf bank_mask:0xf
    v_mul_f32_dpp v197, v242, v73 row_newbcast:1 row_mask:0xf bank_mask:0xf
    v_mul_f32_dpp v198, v242, v72 row_newbcast:8 row_mask:0xf bank_mask:0xf
    v_mul_f32_dpp v199, v242, v73 row_newbcast:9 row_mask:0xf bank_mask:0xf
    v_mul_f32_dpp v200, v242, v76 row_newbcast:2 row_mask:0xf bank_mask:0xf
    v_mul_f32_dpp v201, v242, v77 row_newbcast:3 row_mask:0xf bank_mask:0xf
    v_mul_f32_dpp v202, v242, v76 row_newbcast:10 row_mask:0xf bank_mask:0xf
    v_mul_f32_dpp v203, v242, v77 row_newbcast:11 row_mask:0xf bank_mask:0xf
    v_cvt_pk_bf16_f32 v72, v196, v197
    v_cvt_pk_bf16_f32 v76, v198, v199
    v_cvt_pk_bf16_f32 v73, v200, v201
    v_cvt_pk_bf16_f32 v77, v202, v203
    v_mul_f32_dpp v196, v242, v74 row_newbcast:4 row_mask:0xf bank_mask:0xf
    v_mul_f32_dpp v197, v242, v75 row_newbcast:5 row_mask:0xf bank_mask:0xf
    v_mul_f32_dpp v198, v242, v74 row_newbcast:12 row_mask:0xf bank_mask:0xf
    v_mul_f32_dpp v199, v242, v75 row_newbcast:13 row_mask:0xf bank_mask:0xf
    v_mul_f32_dpp v200, v242, v78 row_newbcast:6 row_mask:0xf bank_mask:0xf
    v_mul_f32_dpp v201, v242, v79 row_newbcast:7 row_mask:0xf bank_mask:0xf
    v_mul_f32_dpp v202, v242, v78 row_newbcast:14 row_mask:0xf bank_mask:0xf
    v_mul_f32_dpp v203, v242, v79 row_newbcast:15 row_mask:0xf bank_mask:0xf
    v_cvt_pk_bf16_f32 v74, v196, v197
    v_cvt_pk_bf16_f32 v78, v198, v199
    v_cvt_pk_bf16_f32 v75, v200, v201
    v_cvt_pk_bf16_f32 v79, v202, v203
    s_mov_b64 exec, s[54:55]
    ds_read_u16_d16_hi v242, v250 offset:256
    s_mov_b64 exec, -1
    s_waitcnt vmcnt(4) lgkmcnt(5)
    v_mfma_f32_32x32x16_bf16 v[0:15], v[72:75], v[176:179], 0
    v_mul_f32_dpp v196, v243, v80 row_newbcast:0 row_mask:0xf bank_mask:0xf
    v_mul_f32_dpp v197, v243, v81 row_newbcast:1 row_mask:0xf bank_mask:0xf
    v_mul_f32_dpp v198, v243, v80 row_newbcast:8 row_mask:0xf bank_mask:0xf
    v_mul_f32_dpp v199, v243, v81 row_newbcast:9 row_mask:0xf bank_mask:0xf
    v_mul_f32_dpp v200, v243, v84 row_newbcast:2 row_mask:0xf bank_mask:0xf
    v_mul_f32_dpp v201, v243, v85 row_newbcast:3 row_mask:0xf bank_mask:0xf
    s_add_u32 m0, s21, 0
    v_mfma_f32_32x32x16_bf16 v[48:63], v[76:79], v[176:179], 0
    buffer_load_dwordx4 v236, s[4:7], s35 offen  lds
    buffer_load_dwordx4 v237, s[8:11], s35 offen offset:1024  lds
    ds_read_b64_tr_b16 v[176:177], v244 offset:2048
    ds_read_b64_tr_b16 v[178:179], v244 offset:3072
    ds_read_b64_tr_b16 v[184:185], v245 offset:2048
    ds_read_b64_tr_b16 v[186:187], v245 offset:3072
    v_mul_f32_dpp v202, v243, v84 row_newbcast:10 row_mask:0xf bank_mask:0xf
    v_mul_f32_dpp v203, v243, v85 row_newbcast:11 row_mask:0xf bank_mask:0xf
    v_cvt_pk_bf16_f32 v80, v196, v197
    v_cvt_pk_bf16_f32 v84, v198, v199
    v_cvt_pk_bf16_f32 v81, v200, v201
    v_cvt_pk_bf16_f32 v85, v202, v203
    v_mul_f32_dpp v196, v243, v82 row_newbcast:4 row_mask:0xf bank_mask:0xf
    v_mul_f32_dpp v197, v243, v83 row_newbcast:5 row_mask:0xf bank_mask:0xf
    v_mul_f32_dpp v198, v243, v82 row_newbcast:12 row_mask:0xf bank_mask:0xf
    v_mul_f32_dpp v199, v243, v83 row_newbcast:13 row_mask:0xf bank_mask:0xf
    v_mul_f32_dpp v200, v243, v86 row_newbcast:6 row_mask:0xf bank_mask:0xf
    v_mul_f32_dpp v201, v243, v87 row_newbcast:7 row_mask:0xf bank_mask:0xf
    v_mul_f32_dpp v202, v243, v86 row_newbcast:14 row_mask:0xf bank_mask:0xf
    v_mul_f32_dpp v203, v243, v87 row_newbcast:15 row_mask:0xf bank_mask:0xf
    v_cvt_pk_bf16_f32 v82, v196, v197
    v_cvt_pk_bf16_f32 v86, v198, v199
    v_cvt_pk_bf16_f32 v83, v200, v201
    v_cvt_pk_bf16_f32 v87, v202, v203
    s_waitcnt vmcnt(4) lgkmcnt(0)
    v_mfma_f32_32x32x16_bf16 v[0:15], v[80:83], v[176:179], v[0:15]
    v_mul_f32_dpp v196, v242, v88 row_newbcast:0 row_mask:0xf bank_mask:0xf
    v_mul_f32_dpp v197, v242, v89 row_newbcast:1 row_mask:0xf bank_mask:0xf
    v_mul_f32_dpp v198, v242, v88 row_newbcast:8 row_mask:0xf bank_mask:0xf
    v_mul_f32_dpp v199, v242, v89 row_newbcast:9 row_mask:0xf bank_mask:0xf
    v_mul_f32_dpp v200, v242, v92 row_newbcast:2 row_mask:0xf bank_mask:0xf
    v_mul_f32_dpp v201, v242, v93 row_newbcast:3 row_mask:0xf bank_mask:0xf
    s_add_u32 m0, s21, 2048
    v_mfma_f32_32x32x16_bf16 v[48:63], v[84:87], v[176:179], v[48:63]
    buffer_load_dwordx4 v238, s[4:7], s35 offen  lds
    buffer_load_dwordx4 v239, s[8:11], s35 offen offset:1024  lds
    ds_read_b64_tr_b16 v[176:177], v244 offset:4096
    ds_read_b64_tr_b16 v[178:179], v244 offset:5120
    ds_read_b64_tr_b16 v[188:189], v245 offset:4096
    ds_read_b64_tr_b16 v[190:191], v245 offset:5120
    v_mul_f32_dpp v202, v242, v92 row_newbcast:10 row_mask:0xf bank_mask:0xf
    v_mul_f32_dpp v203, v242, v93 row_newbcast:11 row_mask:0xf bank_mask:0xf
    v_cvt_pk_bf16_f32 v88, v196, v197
    v_cvt_pk_bf16_f32 v92, v198, v199
    v_cvt_pk_bf16_f32 v89, v200, v201
    v_cvt_pk_bf16_f32 v93, v202, v203
    v_mul_f32_dpp v196, v242, v90 row_newbcast:4 row_mask:0xf bank_mask:0xf
    v_mul_f32_dpp v197, v242, v91 row_newbcast:5 row_mask:0xf bank_mask:0xf
    v_mul_f32_dpp v198, v242, v90 row_newbcast:12 row_mask:0xf bank_mask:0xf
    v_mul_f32_dpp v199, v242, v91 row_newbcast:13 row_mask:0xf bank_mask:0xf
    v_mul_f32_dpp v200, v242, v94 row_newbcast:6 row_mask:0xf bank_mask:0xf
    v_mul_f32_dpp v201, v242, v95 row_newbcast:7 row_mask:0xf bank_mask:0xf
    v_mul_f32_dpp v202, v242, v94 row_newbcast:14 row_mask:0xf bank_mask:0xf
    v_mul_f32_dpp v203, v242, v95 row_newbcast:15 row_mask:0xf bank_mask:0xf
    v_cvt_pk_bf16_f32 v90, v196, v197
    v_cvt_pk_bf16_f32 v94, v198, v199
    v_cvt_pk_bf16_f32 v91, v200, v201
    v_cvt_pk_bf16_f32 v95, v202, v203
    s_waitcnt lgkmcnt(0)
    v_mfma_f32_32x32x16_bf16 v[0:15], v[88:91], v[176:179], v[0:15]
    s_add_u32 m0, s21, 4096
    v_mfma_f32_32x32x16_bf16 v[48:63], v[92:95], v[176:179], v[48:63]
    buffer_load_dwordx4 v234, s[4:7], s36 offen  lds
    buffer_load_dwordx4 v235, s[8:11], s36 offen offset:1024  lds
    s_mov_b32 m0, s50
    s_nop 0
    s_movrels_b32 s71, s23
    s_bfe_u32 s46, s71, 0x30012
    s_mov_b32 m0, s46
    s_and_b32 s66, s71, 0x3ffff
    s_movrels_b32 s68, s57
    s_movrels_b32 s69, s61
    s_sub_u32 s48, s66, s47
    s_mov_b32 s47, s66
    s_lshr_b32 s52, s71, 28
    s_lshl_b32 s67, s46, 9
    s_add_u32 s66, s66, s67
    s_sub_u32 s49, s66, s42
    s_mov_b32 s42, s66
    s_bfe_u32 s66, s68, 655360
    s_add_u32 s43, s42, s66
    s_bfe_u32 s39, s69, 655360
    s_bfe_u32 s66, s68, 655370
    s_add_u32 s44, s42, s66
    s_bfe_u32 s40, s69, 655370
    s_bfe_u32 s66, s68, 655380
    s_add_u32 s45, s42, s66
    s_bfe_u32 s41, s69, 655380
    s_and_b32 s66, s46, s33
    s_cselect_b32 s72, -1, 1
    s_cselect_b32 s76, s47, 163712
    s_cmp_ge_u32 s66, 2
    s_cselect_b32 s73, -1, 0
    s_add_u32 s77, s47, 1024
    s_cmp_ge_u32 s66, 4
    s_cselect_b32 s75, -1, 0
    s_cmp_ge_u32 s66, 3
    s_cselect_b32 s74, -1, 1
    s_cselect_b32 s77, s77, 163712
    v_add_u32 v252, s45, v247
    ds_read2_b32 v[240:241], v252 offset0:0 offset1:16
    v_mfma_f32_32x32x16_bf16 v[16:31], v[72:75], v[180:183], 0
    v_mul_f32 v196, v0, v96
    v_fmac_f32 v196, v1, v97
    v_fmac_f32 v196, v2, v98
    v_fmac_f32 v196, v3, v99
    v_fmac_f32 v196, v4, v100
    v_fmac_f32 v196, v5, v101
    v_mfma_f32_32x32x16_bf16 v[32:47], v[76:79], v[180:183], 0
    v_fmac_f32 v196, v6, v102
    v_fmac_f32 v196, v7, v103
    v_mul_f32 v198, v8, v128
    v_fmac_f32 v198, v9, v129
    v_fmac_f32 v198, v10, v130
    v_fmac_f32 v198, v11, v131
    v_fmac_f32 v198, v12, v132
    v_fmac_f32 v198, v13, v133
    v_fmac_f32 v198, v14, v134
    v_fmac_f32 v198, v15, v135
    v_mfma_f32_32x32x16_bf16 v[16:31], v[80:83], v[184:187], v[16:31]
    v_mul_f32 v200, v48, v128
    v_fmac_f32 v200, v49, v129
    v_permlane32_swap_b32 v196, v198
    v_fmac_f32 v200, v50, v130
    v_fmac_f32 v200, v51, v131
    v_fmac_f32 v200, v52, v132
    v_mfma_f32_32x32x16_bf16 v[32:47], v[84:87], v[184:187], v[32:47]
    s_waitcnt vmcnt(6)
    ds_read_b64_tr_b16 v[176:177], v244 offset:6144
    ds_read_b64_tr_b16 v[178:179], v244 offset:7168
    ds_read_b64_tr_b16 v[180:181], v245 offset:6144
    ds_read_b64_tr_b16 v[182:183], v245 offset:7168
    v_fmac_f32 v200, v53, v133
    v_fmac_f32 v200, v54, v134
    v_mfma_f32_32x32x16_bf16 v[16:31], v[88:91], v[188:191], v[16:31]
    v_fmac_f32 v200, v55, v135
    v_add_f32 v198, v196, v198
    v_mul_f32_e64 v202, v56, -v128
    v_fma_f32 v202, v57, -v129, v202
    v_fma_f32 v202, v58, -v130, v202
    v_fma_f32 v202, v59, -v131, v202
    v_mfma_f32_32x32x16_bf16 v[32:47], v[92:95], v[188:191], v[32:47]
    v_fma_f32 v202, v60, -v132, v202
    v_fma_f32 v202, v61, -v133, v202
    v_fma_f32 v202, v62, -v134, v202
    v_fma_f32 v202, v63, -v135, v202
    s_nop 1
    v_permlane32_swap_b32 v200, v202
    v_add_f32 v202, v200, v202
    s_waitcnt vmcnt(4) lgkmcnt(0)
    v_mfma_f32_32x32x16_bf16 v[0:15], v[72:75], v[176:179], 0
    v_mul_f32 v197, v16, v104
    v_fmac_f32 v197, v17, v105
    v_fmac_f32 v197, v18, v106
    v_fmac_f32 v197, v19, v107
    v_fmac_f32 v197, v20, v108
    v_fmac_f32 v197, v21, v109
    s_add_u32 m0, s21, 6144
    v_mfma_f32_32x32x16_bf16 v[48:63], v[76:79], v[176:179], 0
    buffer_load_dwordx4 v236, s[4:7], s36 offen  lds
    buffer_load_dwordx4 v237, s[8:11], s36 offen offset:1024  lds
    ds_read_b64_tr_b16 v[176:177], v244 offset:0
    ds_read_b64_tr_b16 v[178:179], v244 offset:1024
    ds_read_b64_tr_b16 v[184:185], v245 offset:0
    ds_read_b64_tr_b16 v[186:187], v245 offset:1024
    v_fmac_f32 v197, v22, v110
    v_fmac_f32 v197, v23, v111
    v_mul_f32 v199, v24, v136
    v_fmac_f32 v199, v25, v137
    v_fmac_f32 v199, v26, v138
    v_fmac_f32 v199, v27, v139
    v_fmac_f32 v199, v28, v140
    v_fmac_f32 v199, v29, v141
    v_fmac_f32 v199, v30, v142
    v_fmac_f32 v199, v31, v143
    v_mul_f32 v201, v32, v136
    v_fmac_f32 v201, v33, v137
    v_permlane32_swap_b32 v197, v199
    v_fmac_f32 v201, v34, v138
    v_fmac_f32 v201, v35, v139
    v_fmac_f32 v201, v36, v140
    v_fmac_f32 v201, v37, v141
    v_fmac_f32 v201, v38, v142
    s_waitcnt vmcnt(4) lgkmcnt(0)
    v_mfma_f32_32x32x16_bf16 v[0:15], v[80:83], v[176:179], v[0:15]
    v_fmac_f32 v201, v39, v143
    v_add_f32 v199, v197, v199
    v_mul_f32_e64 v203, v40, -v136
    v_fma_f32 v203, v41, -v137, v203
    v_fma_f32 v203, v42, -v138, v203
    v_fma_f32 v203, v43, -v139, v203
    s_add_u32 m0, s21, 0
    v_mfma_f32_32x32x16_bf16 v[48:63], v[84:87], v[176:179], v[48:63]
    buffer_load_dwordx4 v238, s[4:7], s36 offen  lds
    buffer_load_dwordx4 v239, s[8:11], s36 offen offset:1024  lds
    ds_read_b64_tr_b16 v[176:177], v244 offset:2048
    ds_read_b64_tr_b16 v[178:179], v244 offset:3072
    ds_read_b64_tr_b16 v[188:189], v245 offset:2048
    ds_read_b64_tr_b16 v[190:191], v245 offset:3072
    s_waitcnt lgkmcnt(0)
    v_mfma_f32_32x32x16_bf16 v[0:15], v[88:91], v[176:179], v[0:15]
    v_fma_f32 v203, v44, -v140, v203
    v_fma_f32 v203, v45, -v141, v203
    v_fma_f32 v203, v46, -v142, v203
    v_fma_f32 v203, v47, -v143, v203
    s_nop 1
    v_permlane32_swap_b32 v201, v203
    v_add_f32 v203, v201, v203
    s_add_u32 m0, s21, 2048
    v_mfma_f32_32x32x16_bf16 v[48:63], v[92:95], v[176:179], v[48:63]
    buffer_load_dwordx4 v234, s[4:7], s37 offen  lds
    buffer_load_dwordx4 v235, s[8:11], s37 offen offset:1024  lds
    v_add_u32 v252, s42, v247
    ds_read2_b32 v[234:235], v252 offset0:0 offset1:16
    s_set_gpr_idx_on s51, gpr_idx(DST)
    s_nop 0
    v_cvt_pk_bf16_f32 v204, v198, v199
    v_cvt_pk_bf16_f32 v205, v202, v203
    s_set_gpr_idx_off
    v_mfma_f32_32x32x16_bf16 v[16:31], v[72:75], v[180:183], 0
    v_mul_f32 v196, v0, v144
    v_fmac_f32 v196, v1, v145
    v_fmac_f32 v196, v2, v146
    v_fmac_f32 v196, v3, v147
    v_fmac_f32 v196, v4, v148
    v_fmac_f32 v196, v5, v149
    v_mfma_f32_32x32x16_bf16 v[32:47], v[76:79], v[180:183], 0
    v_fmac_f32 v196, v6, v150
    v_fmac_f32 v196, v7, v151
    v_mul_f32 v198, v8, v112
    v_fmac_f32 v198, v9, v113
    v_fmac_f32 v198, v10, v114
    v_fmac_f32 v198, v11, v115
    v_mfma_f32_32x32x16_bf16 v[16:31], v[80:83], v[184:187], v[16:31]
    v_fmac_f32 v198, v12, v116
    v_fmac_f32 v198, v13, v117
    v_fmac_f32 v198, v14, v118
    v_fmac_f32 v198, v15, v119
    v_mul_f32_e64 v200, v48, -v160
    v_fma_f32 v200, v49, -v161, v200
    v_mfma_f32_32x32x16_bf16 v[32:47], v[84:87], v[184:187], v[32:47]
    s_waitcnt vmcnt(6)
    ds_read_b64_tr_b16 v[176:177], v244 offset:4096
    ds_read_b64_tr_b16 v[178:179], v244 offset:5120
    ds_read_b64_tr_b16 v[180:181], v245 offset:4096
    ds_read_b64_tr_b16 v[182:183], v245 offset:5120
    v_fma_f32 v200, v50, -v162, v200
    v_fma_f32 v200, v51, -v163, v200
    v_mfma_f32_32x32x16_bf16 v[16:31], v[88:91], v[188:191], v[16:31]
    v_fma_f32 v200, v52, -v164, v200
    v_fma_f32 v200, v53, -v165, v200
    v_fma_f32 v200, v54, -v166, v200
    v_fma_f32 v200, v55, -v167, v200
    v_mul_f32_e64 v202, v56, -v160
    v_fma_f32 v202, v57, -v161, v202
    v_mfma_f32_32x32x16_bf16 v[32:47], v[92:95], v[188:191], v[32:47]
    v_fma_f32 v202, v58, -v162, v202
    v_fma_f32 v202, v59, -v163, v202
    v_fma_f32 v202, v60, -v164, v202
    v_fma_f32 v202, v61, -v165, v202
    v_fma_f32 v202, v62, -v166, v202
    v_fma_f32 v202, v63, -v167, v202
    s_waitcnt vmcnt(4) lgkmcnt(0)
    v_mfma_f32_32x32x16_bf16 v[0:15], v[72:75], v[176:179], 0
    v_mul_f32 v197, v16, v152
    v_fmac_f32 v197, v17, v153
    v_fmac_f32 v197, v18, v154
    v_fmac_f32 v197, v19, v155
    v_fmac_f32 v197, v20, v156
    v_fmac_f32 v197, v21, v157
    s_add_u32 m0, s21, 4096
    v_mfma_f32_32x32x16_bf16 v[48:63], v[76:79], v[176:179], 0
    buffer_load_dwordx4 v236, s[4:7], s37 offen  lds
    buffer_load_dwordx4 v237, s[8:11], s37 offen offset:1024  lds
    ds_read_b64_tr_b16 v[176:177], v244 offset:6144
    ds_read_b64_tr_b16 v[178:179], v244 offset:7168
    ds_read_b64_tr_b16 v[184:185], v245 offset:6144
    ds_read_b64_tr_b16 v[186:187], v245 offset:7168
    v_add_u32 v252, s43, v247
    ds_read2_b32 v[236:237], v252 offset0:0 offset1:16
    v_fmac_f32 v197, v22, v158
    v_fmac_f32 v197, v23, v159
    v_mul_f32 v199, v24, v120
    v_fmac_f32 v199, v25, v121
    v_fmac_f32 v199, v26, v122
    v_fmac_f32 v199, v27, v123
    v_fmac_f32 v199, v28, v124
    v_fmac_f32 v199, v29, v125
    v_fmac_f32 v199, v30, v126
    v_fmac_f32 v199, v31, v127
    v_mul_f32_e64 v201, v32, -v168
    v_fma_f32 v201, v33, -v169, v201
    s_waitcnt vmcnt(4) lgkmcnt(1)
    v_mfma_f32_32x32x16_bf16 v[0:15], v[80:83], v[176:179], v[0:15]
    v_fma_f32 v201, v34, -v170, v201
    v_fma_f32 v201, v35, -v171, v201
    v_fma_f32 v201, v36, -v172, v201
    v_fma_f32 v201, v37, -v173, v201
    v_fma_f32 v201, v38, -v174, v201
    v_fma_f32 v201, v39, -v175, v201
    s_add_u32 m0, s21, 6144
    v_mfma_f32_32x32x16_bf16 v[48:63], v[84:87], v[176:179], v[48:63]
    buffer_load_dwordx4 v238, s[4:7], s37 offen  lds
    buffer_load_dwordx4 v239, s[8:11], s37 offen offset:1024  lds
    ds_read_b64_tr_b16 v[176:177], v244 offset:0
    ds_read_b64_tr_b16 v[178:179], v244 offset:1024
    ds_read_b64_tr_b16 v[188:189], v245 offset:0
    ds_read_b64_tr_b16 v[190:191], v245 offset:1024
    v_add_u32 v252, s44, v247
    ds_read2_b32 v[238:239], v252 offset0:0 offset1:16
    s_waitcnt lgkmcnt(1)
    v_mfma_f32_32x32x16_bf16 v[0:15], v[88:91], v[176:179], v[0:15]
    v_mul_f32_e64 v203, v40, -v168
    v_fma_f32 v203, v41, -v169, v203
    v_fma_f32 v203, v42, -v170, v203
    v_fma_f32 v203, v43, -v171, v203
    v_fma_f32 v203, v44, -v172, v203
    v_fma_f32 v203, v45, -v173, v203
    s_add_u32 m0, s21, 0
    v_mfma_f32_32x32x16_bf16 v[48:63], v[92:95], v[176:179], v[48:63]
    v_mad_u32_u16 v234, v234, s3, v246 op_sel:[1,0,0,0]
    v_mad_u32_u16 v235, v235, s3, v246 op_sel:[1,0,0,0]
    buffer_load_dwordx4 v234, s[4:7], s38 offen  lds
    buffer_load_dwordx4 v235, s[8:11], s38 offen offset:1024  lds
    v_fma_f32 v203, v46, -v174, v203
    v_fma_f32 v203, v47, -v175, v203
    v_mfma_f32_32x32x16_bf16 v[16:31], v[72:75], v[180:183], 0
    v_mul_f32 v254, v0, v144
    v_fmac_f32 v254, v1, v145
    v_fmac_f32 v254, v2, v146
    v_fmac_f32 v254, v3, v147
    v_fmac_f32 v254, v4, v148
    v_fmac_f32 v254, v5, v149
    v_mfma_f32_32x32x16_bf16 v[32:47], v[76:79], v[180:183], 0
    v_add_u32 v253, s47, v248
    ds_read_b32 v192, v253
    ds_read_b32 v193, v253 offset:256
    v_mfma_f32_32x32x16_bf16 v[16:31], v[80:83], v[184:187], v[16:31]
    v_fmac_f32 v254, v6, v150
    v_fmac_f32 v254, v7, v151
    v_fmac_f32 v200, v8, v160
    v_fmac_f32 v200, v9, v161
    v_permlane32_swap_b32 v196, v254
    v_fmac_f32 v200, v10, v162
    v_mfma_f32_32x32x16_bf16 v[32:47], v[84:87], v[184:187], v[32:47]
    s_waitcnt vmcnt(6)
    ds_read_b64_tr_b16 v[176:177], v244 offset:2048
    ds_read_b64_tr_b16 v[178:179], v244 offset:3072
    ds_read_b64_tr_b16 v[180:181], v245 offset:2048
    ds_read_b64_tr_b16 v[182:183], v245 offset:3072
    v_fmac_f32 v200, v11, v163
    v_fmac_f32 v200, v12, v164
    v_mfma_f32_32x32x16_bf16 v[16:31], v[88:91], v[188:191], v[16:31]
    v_fmac_f32 v200, v13, v165
    v_fmac_f32 v200, v14, v166
    v_fmac_f32 v200, v15, v167
    v_add_f32 v254, v196, v254
    v_xor_b32 v64, 0x80000000, v48
    v_xor_b32 v65, 0x80000000, v49
    v_mfma_f32_32x32x16_bf16 v[32:47], v[92:95], v[188:191], v[32:47]
    v_xor_b32 v66, 0x80000000, v50
    v_xor_b32 v67, 0x80000000, v51
    v_xor_b32 v68, 0x80000000, v52
    v_xor_b32 v69, 0x80000000, v53
    v_xor_b32 v70, 0x80000000, v54
    v_xor_b32 v71, 0x80000000, v55
    s_waitcnt vmcnt(4) lgkmcnt(0)
    v_mfma_f32_32x32x16_bf16 v[0:15], v[72:75], v[176:179], 0
    v_mul_f32 v255, v16, v152
    v_fmac_f32 v255, v17, v153
    v_fmac_f32 v255, v18, v154
    v_fmac_f32 v255, v19, v155
    v_fmac_f32 v255, v20, v156
    v_fmac_f32 v255, v21, v157
    s_mov_b32 m0, s76
    s_mov_b64 exec, s[72:73]
    buffer_load_dwordx4 v192, s[12:15], 0 offen  lds
    s_mov_b32 m0, s77
    s_mov_b64 exec, s[74:75]
    buffer_load_dwordx4 v193, s[12:15], 0 offen  lds
    s_mov_b64 exec, -1
    s_add_u32 m0, s21, 2048
    v_mfma_f32_32x32x16_bf16 v[56:71], v[76:79], v[176:179], v[56:71]
    v_mad_u32_u16 v236, v236, s3, v246 op_sel:[1,0,0,0]
    v_mad_u32_u16 v237, v237, s3, v246 op_sel:[1,0,0,0]
    buffer_load_dwordx4 v236, s[4:7], s39 offen  lds
    buffer_load_dwordx4 v237, s[8:11], s39 offen offset:1024  lds
    ds_read_b64_tr_b16 v[176:177], v244 offset:4096
    ds_read_b64_tr_b16 v[178:179], v244 offset:5120
    ds_read_b64_tr_b16 v[184:185], v245 offset:4096
    ds_read_b64_tr_b16 v[186:187], v245 offset:5120
    v_fmac_f32 v255, v22, v158
    v_fmac_f32 v255, v23, v159
    v_fmac_f32 v201, v24, v168
    v_fmac_f32 v201, v25, v169
    v_permlane32_swap_b32 v197, v255
    v_fmac_f32 v201, v26, v170
    v_fmac_f32 v201, v27, v171
    s_waitcnt vmcnt(6) lgkmcnt(0)
    v_mfma_f32_32x32x16_bf16 v[0:15], v[80:83], v[176:179], v[0:15]
    v_fmac_f32 v201, v28, v172
    v_fmac_f32 v201, v29, v173
    v_fmac_f32 v201, v30, v174
    v_fmac_f32 v201, v31, v175
    v_add_f32 v255, v197, v255
    v_xor_b32 v48, 0x80000000, v32
    s_add_u32 m0, s21, 4096
    v_mfma_f32_32x32x16_bf16 v[56:71], v[84:87], v[176:179], v[56:71]
    v_mad_u32_u16 v238, v238, s3, v246 op_sel:[1,0,0,0]
    v_mad_u32_u16 v239, v239, s3, v246 op_sel:[1,0,0,0]
    buffer_load_dwordx4 v238, s[4:7], s40 offen  lds
    buffer_load_dwordx4 v239, s[8:11], s40 offen offset:1024  lds
    ds_read_b64_tr_b16 v[176:177], v244 offset:6144
    ds_read_b64_tr_b16 v[178:179], v244 offset:7168
    ds_read_b64_tr_b16 v[188:189], v245 offset:6144
    ds_read_b64_tr_b16 v[190:191], v245 offset:7168
    s_waitcnt lgkmcnt(0)
    v_mfma_f32_32x32x16_bf16 v[0:15], v[88:91], v[176:179], v[0:15]
    v_xor_b32 v49, 0x80000000, v33
    v_xor_b32 v50, 0x80000000, v34
    v_xor_b32 v51, 0x80000000, v35
    v_xor_b32 v52, 0x80000000, v36
    v_xor_b32 v53, 0x80000000, v37
    v_xor_b32 v54, 0x80000000, v38
    s_add_u32 m0, s21, 6144
    v_mfma_f32_32x32x16_bf16 v[56:71], v[92:95], v[176:179], v[56:71]
    v_mad_u32_u16 v240, v240, s3, v246 op_sel:[1,0,0,0]
    v_mad_u32_u16 v241, v241, s3, v246 op_sel:[1,0,0,0]
    buffer_load_dwordx4 v240, s[4:7], s41 offen  lds
    buffer_load_dwordx4 v241, s[8:11], s41 offen offset:1024  lds
    v_xor_b32 v55, 0x80000000, v39
    s_set_gpr_idx_on s51, gpr_idx(DST)
    s_nop 0
    v_cvt_pk_bf16_f32 v206, v254, v255
    s_set_gpr_idx_off
    v_mfma_f32_32x32x16_bf16 v[16:31], v[72:75], v[180:183], 0
    v_mul_f32 v254, v0, v144
    v_fmac_f32 v254, v1, v145
    v_fmac_f32 v254, v2, v146
    v_fmac_f32 v254, v3, v147
    v_fmac_f32 v254, v4, v148
    v_fmac_f32 v254, v5, v149
    v_mfma_f32_32x32x16_bf16 v[40:55], v[76:79], v[180:183], v[40:55]
    v_fmac_f32 v254, v6, v150
    v_fmac_f32 v254, v7, v151
    v_fma_f32 v202, v8, -v160, v202
    v_fma_f32 v202, v9, -v161, v202
    v_permlane32_swap_b32 v254, v200
    v_fma_f32 v202, v10, -v162, v202
    v_fma_f32 v202, v11, -v163, v202
    v_fma_f32 v202, v12, -v164, v202
    v_fma_f32 v202, v13, -v165, v202
    v_fma_f32 v202, v14, -v166, v202
    v_fma_f32 v202, v15, -v167, v202
    v_add_f32 v200, v254, v200
    v_fma_f32 v198, v64, -v112, v198
    v_permlane32_swap_b32 v202, v254
    v_mfma_f32_32x32x16_bf16 v[16:31], v[80:83], v[184:187], v[16:31]
    v_fma_f32 v198, v65, -v113, v198
    v_fma_f32 v198, v66, -v114, v198
    v_fma_f32 v198, v67, -v115, v198
    v_fma_f32 v198, v68, -v116, v198
    v_fma_f32 v198, v69, -v117, v198
    v_fma_f32 v198, v70, -v118, v198
    v_mfma_f32_32x32x16_bf16 v[40:55], v[84:87], v[184:187], v[40:55]
    s_waitcnt vmcnt(8)
    ds_read_b64_tr_b16 v[176:177], v244 offset:0
    ds_read_b64_tr_b16 v[178:179], v244 offset:1024
    ds_read_b64_tr_b16 v[180:181], v245 offset:0
    ds_read_b64_tr_b16 v[182:183], v245 offset:1024
    v_fma_f32 v198, v71, -v119, v198
    v_add_f32 v254, v202, v254
    v_mfma_f32_32x32x16_bf16 v[16:31], v[88:91], v[188:191], v[16:31]
    v_mul_f32 v196, v56, v160
    v_fmac_f32 v196, v57, v161
    v_fmac_f32 v196, v58, v162
    v_fmac_f32 v196, v59, v163
    v_fmac_f32 v196, v60, v164
    v_fmac_f32 v196, v61, v165
    v_mfma_f32_32x32x16_bf16 v[40:55], v[92:95], v[188:191], v[40:55]
    v_add_u32 v249, s48, v249
    v_add_u32 v250, s49, v250
    v_fmac_f32 v196, v62, v166
    v_fmac_f32 v196, v63, v167
    s_nop 1
    v_permlane32_swap_b32 v198, v196
    v_add_f32 v196, v198, v196
    v_mul_f32 v255, v16, v152
    v_fmac_f32 v255, v17, v153
    v_fmac_f32 v255, v18, v154
    v_fmac_f32 v255, v19, v155
    v_fmac_f32 v255, v20, v156
    v_fmac_f32 v255, v21, v157
    v_fmac_f32 v255, v22, v158
    v_fmac_f32 v255, v23, v159
    v_fma_f32 v203, v24, -v168, v203
    v_fma_f32 v203, v25, -v169, v203
    v_permlane32_swap_b32 v255, v201
    v_fma_f32 v203, v26, -v170, v203
    v_fma_f32 v203, v27, -v171, v203
    v_fma_f32 v203, v28, -v172, v203
    v_fma_f32 v203, v29, -v173, v203
    v_fma_f32 v203, v30, -v174, v203
    v_fma_f32 v203, v31, -v175, v203
    v_add_f32 v201, v255, v201
    v_fma_f32 v199, v48, -v120, v199
    v_permlane32_swap_b32 v203, v255
    v_fma_f32 v199, v49, -v121, v199
    v_fma_f32 v199, v50, -v122, v199
    v_fma_f32 v199, v51, -v123, v199
    s_waitcnt vmcnt(6)
    ds_read_b64_tr_b16 v[72:73], v249 offset:0
    ds_read_b64_tr_b16 v[76:77], v249 offset:64
    ds_read_b64_tr_b16 v[74:75], v249 offset:256
    ds_read_b64_tr_b16 v[78:79], v249 offset:320
    s_mov_b64 exec, s[54:55]
    ds_read_u16_d16_hi v242, v250 offset:0
    s_mov_b64 exec, -1
    v_fma_f32 v199, v52, -v124, v199
    v_fma_f32 v199, v53, -v125, v199
    v_fma_f32 v199, v54, -v126, v199
    v_fma_f32 v199, v55, -v127, v199
    v_add_f32 v255, v203, v255
    v_mul_f32 v197, v40, v168
    v_fmac_f32 v197, v41, v169
    v_fmac_f32 v197, v42, v170
    v_fmac_f32 v197, v43, v171
    v_fmac_f32 v197, v44, v172
    v_fmac_f32 v197, v45, v173
    v_fmac_f32 v197, v46, v174
    v_fmac_f32 v197, v47, v175
    s_nop 1
    v_permlane32_swap_b32 v199, v197
    v_add_f32 v197, v199, v197
    s_set_gpr_idx_on s51, gpr_idx(DST)
    s_nop 0
    v_cvt_pk_bf16_f32 v207, v200, v201
    v_cvt_pk_bf16_f32 v209, v254, v255
    v_cvt_pk_bf16_f32 v208, v196, v197
    s_set_gpr_idx_off
    s_add_u32 s50, s50, 1
    s_add_u32 s51, s51, 6
    s_cmp_ge_u32 s50, 4
    s_cbranch_scc1 LAST0
    s_add_u32 s53, s53, 4
    s_xor_b32 s66, s53, s20
    s_bitcmp1_b32 s66, 2
    s_setprio 1
    s_cbranch_scc1 PRIO_8
    s_setprio 0
PRIO_8:
    s_cmp_eq_u32 s52, 4
    s_cbranch_scc1 ITEM_0_4
    s_cmp_eq_u32 s52, 5
    s_cbranch_scc1 ITEM_0_5
    s_cmp_eq_u32 s52, 3
    s_cbranch_scc1 ITEM_0_3
    s_cmp_eq_u32 s52, 6
    s_cbranch_scc1 ITEM_0_6
    s_cmp_eq_u32 s52, 8
    s_cbranch_scc1 ITEM_0_8
    s_branch ITEM_0_2
.p2align 6
ITEM_0_8:
    s_mov_b64 exec, s[54:55]
    ds_read_u16_d16_hi v243, v250 offset:128
    s_mov_b64 exec, -1
    ds_read_b64_tr_b16 v[80:81], v249 offset:512
    ds_read_b64_tr_b16 v[84:85], v249 offset:576
    ds_read_b64_tr_b16 v[82:83], v249 offset:768
    ds_read_b64_tr_b16 v[86:87], v249 offset:832
    ds_read_b64_tr_b16 v[88:89], v249 offset:1024
    ds_read_b64_tr_b16 v[92:93], v249 offset:1088
    ds_read_b64_tr_b16 v[90:91], v249 offset:1280
    ds_read_b64_tr_b16 v[94:95], v249 offset:1344
    ds_read_b64_tr_b16 v[64:65], v249 offset:1536
    ds_read_b64_tr_b16 v[68:69], v249 offset:1600
    ds_read_b64_tr_b16 v[66:67], v249 offset:1792
    ds_read_b64_tr_b16 v[70:71], v249 offset:1856
    s_waitcnt lgkmcnt(13)
    v_mul_f32_dpp v196, v242, v72 row_newbcast:0 row_mask:0xf bank_mask:0xf
    v_mul_f32_dpp v197, v242, v73 row_newbcast:1 row_mask:0xf bank_mask:0xf
    v_mul_f32_dpp v198, v242, v72 row_newbcast:8 row_mask:0xf bank_mask:0xf
    v_mul_f32_dpp v199, v242, v73 row_newbcast:9 row_mask:0xf bank_mask:0xf
    v_mul_f32_dpp v200, v242, v76 row_newbcast:2 row_mask:0xf bank_mask:0xf
    v_mul_f32_dpp v201, v242, v77 row_newbcast:3 row_mask:0xf bank_mask:0xf
    v_mul_f32_dpp v202, v242, v76 row_newbcast:10 row_mask:0xf bank_mask:0xf
    v_mul_f32_dpp v203, v242, v77 row_newbcast:11 row_mask:0xf bank_mask:0xf
    v_cvt_pk_bf16_f32 v72, v196, v197
    v_cvt_pk_bf16_f32 v76, v198, v199
    v_cvt_pk_bf16_f32 v73, v200, v201
    v_cvt_pk_bf16_f32 v77, v202, v203
    v_mul_f32_dpp v196, v242, v74 row_newbcast:4 row_mask:0xf bank_mask:0xf
    v_mul_f32_dpp v197, v242, v75 row_newbcast:5 row_mask:0xf bank_mask:0xf
    v_mul_f32_dpp v198, v242, v74 row_newbcast:12 row_mask:0xf bank_mask:0xf
    v_mul_f32_dpp v199, v242, v75 row_newbcast:13 row_mask:0xf bank_mask:0xf
    v_mul_f32_dpp v200, v242, v78 row_newbcast:6 row_mask:0xf bank_mask:0xf
    v_mul_f32_dpp v201, v242, v79 row_newbcast:7 row_mask:0xf bank_mask:0xf
    v_mul_f32_dpp v202, v242, v78 row_newbcast:14 row_mask:0xf bank_mask:0xf
    v_mul_f32_dpp v203, v242, v79 row_newbcast:15 row_mask:0xf bank_mask:0xf
    v_cvt_pk_bf16_f32 v74, v196, v197
    v_cvt_pk_bf16_f32 v78, v198, v199
    v_cvt_pk_bf16_f32 v75, v200, v201
    v_cvt_pk_bf16_f32 v79, v202, v203
    s_mov_b64 exec, s[54:55]
    ds_read_u16_d16_hi v242, v250 offset:256
    s_mov_b64 exec, -1
    s_waitcnt vmcnt(4) lgkmcnt(9)
    v_mfma_f32_32x32x16_bf16 v[0:15], v[72:75], v[176:179], 0
    v_mul_f32_dpp v196, v243, v80 row_newbcast:0 row_mask:0xf bank_mask:0xf
    v_mul_f32_dpp v197, v243, v81 row_newbcast:1 row_mask:0xf bank_mask:0xf
    v_mul_f32_dpp v198, v243, v80 row_newbcast:8 row_mask:0xf bank_mask:0xf
    v_mul_f32_dpp v199, v243, v81 row_newbcast:9 row_mask:0xf bank_mask:0xf
    v_mul_f32_dpp v200, v243, v84 row_newbcast:2 row_mask:0xf bank_mask:0xf
    v_mul_f32_dpp v201, v243, v85 row_newbcast:3 row_mask:0xf bank_mask:0xf
    s_add_u32 m0, s21, 0
    v_mfma_f32_32x32x16_bf16 v[48:63], v[76:79], v[176:179], 0
    buffer_load_dwordx4 v234, s[4:7], s35 offen  lds
    buffer_load_dwordx4 v235, s[8:11], s35 offen offset:1024  lds
    ds_read_b64_tr_b16 v[176:177], v244 offset:2048
    ds_read_b64_tr_b16 v[178:179], v244 offset:3072
    ds_read_b64_tr_b16 v[184:185], v245 offset:2048
    ds_read_b64_tr_b16 v[186:187], v245 offset:3072
    v_mul_f32_dpp v202, v243, v84 row_newbcast:10 row_mask:0xf bank_mask:0xf
    v_mul_f32_dpp v203, v243, v85 row_newbcast:11 row_mask:0xf bank_mask:0xf
    v_cvt_pk_bf16_f32 v80, v196, v197
    v_cvt_pk_bf16_f32 v84, v198, v199
    v_cvt_pk_bf16_f32 v81, v200, v201
    v_cvt_pk_bf16_f32 v85, v202, v203
    v_mul_f32_dpp v196, v243, v82 row_newbcast:4 row_mask:0xf bank_mask:0xf
    v_mul_f32_dpp v197, v243, v83 row_newbcast:5 row_mask:0xf bank_mask:0xf
    v_mul_f32_dpp v198, v243, v82 row_newbcast:12 row_mask:0xf bank_mask:0xf
    v_mul_f32_dpp v199, v243, v83 row_newbcast:13 row_mask:0xf bank_mask:0xf
    v_mul_f32_dpp v200, v243, v86 row_newbcast:6 row_mask:0xf bank_mask:0xf
    v_mul_f32_dpp v201, v243, v87 row_newbcast:7 row_mask:0xf bank_mask:0xf
    v_mul_f32_dpp v202, v243, v86 row_newbcast:14 row_mask:0xf bank_mask:0xf
    v_mul_f32_dpp v203, v243, v87 row_newbcast:15 row_mask:0xf bank_mask:0xf
    v_cvt_pk_bf16_f32 v82, v196, v197
    v_cvt_pk_bf16_f32 v86, v198, v199
    v_cvt_pk_bf16_f32 v83, v200, v201
    v_cvt_pk_bf16_f32 v87, v202, v203
    s_mov_b64 exec, s[54:55]
    ds_read_u16_d16_hi v243, v250 offset:384
    s_mov_b64 exec, -1
    s_waitcnt vmcnt(4) lgkmcnt(1)
    v_mfma_f32_32x32x16_bf16 v[0:15], v[80:83], v[176:179], v[0:15]
    v_mul_f32_dpp v196, v242, v88 row_newbcast:0 row_mask:0xf bank_mask:0xf
    v_mul_f32_dpp v197, v242, v89 row_newbcast:1 row_mask:0xf bank_mask:0xf
    v_mul_f32_dpp v198, v242, v88 row_newbcast:8 row_mask:0xf bank_mask:0xf
    v_mul_f32_dpp v199, v242, v89 row_newbcast:9 row_mask:0xf bank_mask:0xf
    v_mul_f32_dpp v200, v242, v92 row_newbcast:2 row_mask:0xf bank_mask:0xf
    v_mul_f32_dpp v201, v242, v93 row_newbcast:3 row_mask:0xf bank_mask:0xf
    s_add_u32 m0, s21, 2048
    v_mfma_f32_32x32x16_bf16 v[48:63], v[84:87], v[176:179], v[48:63]
    buffer_load_dwordx4 v236, s[4:7], s35 offen  lds
    buffer_load_dwordx4 v237, s[8:11], s35 offen offset:1024  lds
    ds_read_b64_tr_b16 v[176:177], v244 offset:4096
    ds_read_b64_tr_b16 v[178:179], v244 offset:5120
    ds_read_b64_tr_b16 v[188:189], v245 offset:4096
    ds_read_b64_tr_b16 v[190:191], v245 offset:5120
    v_mul_f32_dpp v202, v242, v92 row_newbcast:10 row_mask:0xf bank_mask:0xf
    v_mul_f32_dpp v203, v242, v93 row_newbcast:11 row_mask:0xf bank_mask:0xf
    v_cvt_pk_bf16_f32 v88, v196, v197
    v_cvt_pk_bf16_f32 v92, v198, v199
    v_cvt_pk_bf16_f32 v89, v200, v201
    v_cvt_pk_bf16_f32 v93, v202, v203
    v_mul_f32_dpp v196, v242, v90 row_newbcast:4 row_mask:0xf bank_mask:0xf
    v_mul_f32_dpp v197, v242, v91 row_newbcast:5 row_mask:0xf bank_mask:0xf
    v_mul_f32_dpp v198, v242, v90 row_newbcast:12 row_mask:0xf bank_mask:0xf
    v_mul_f32_dpp v199, v242, v91 row_newbcast:13 row_mask:0xf bank_mask:0xf
    v_mul_f32_dpp v200, v242, v94 row_newbcast:6 row_mask:0xf bank_mask:0xf
    v_mul_f32_dpp v201, v242, v95 row_newbcast:7 row_mask:0xf bank_mask:0xf
    v_mul_f32_dpp v202, v242, v94 row_newbcast:14 row_mask:0xf bank_mask:0xf
    v_mul_f32_dpp v203, v242, v95 row_newbcast:15 row_mask:0xf bank_mask:0xf
    v_cvt_pk_bf16_f32 v90, v196, v197
    v_cvt_pk_bf16_f32 v94, v198, v199
    v_cvt_pk_bf16_f32 v91, v200, v201
    v_cvt_pk_bf16_f32 v95, v202, v203
    s_waitcnt vmcnt(4) lgkmcnt(0)
    v_mfma_f32_32x32x16_bf16 v[0:15], v[88:91], v[176:179], v[0:15]
    v_mul_f32_dpp v196, v243, v64 row_newbcast:0 row_mask:0xf bank_mask:0xf
    v_mul_f32_dpp v197, v243, v65 row_newbcast:1 row_mask:0xf bank_mask:0xf
    v_mul_f32_dpp v198, v243, v64 row_newbcast:8 row_mask:0xf bank_mask:0xf
    v_mul_f32_dpp v199, v243, v65 row_newbcast:9 row_mask:0xf bank_mask:0xf
    v_mul_f32_dpp v200, v243, v68 row_newbcast:2 row_mask:0xf bank_mask:0xf
    v_mul_f32_dpp v201, v243, v69 row_newbcast:3 row_mask:0xf bank_mask:0xf
    s_add_u32 m0, s21, 4096
    v_mfma_f32_32x32x16_bf16 v[48:63], v[92:95], v[176:179], v[48:63]
    buffer_load_dwordx4 v238, s[4:7], s35 offen  lds
    buffer_load_dwordx4 v239, s[8:11], s35 offen offset:1024  lds
    ds_read_b64_tr_b16 v[176:177], v244 offset:6144
    ds_read_b64_tr_b16 v[178:179], v244 offset:7168
    ds_read_b64_tr_b16 v[192:193], v245 offset:6144
    ds_read_b64_tr_b16 v[194:195], v245 offset:7168
    v_mul_f32_dpp v202, v243, v68 row_newbcast:10 row_mask:0xf bank_mask:0xf
    v_mul_f32_dpp v203, v243, v69 row_newbcast:11 row_mask:0xf bank_mask:0xf
    v_cvt_pk_bf16_f32 v64, v196, v197
    v_cvt_pk_bf16_f32 v68, v198, v199
    v_cvt_pk_bf16_f32 v65, v200, v201
    v_cvt_pk_bf16_f32 v69, v202, v203
    v_mul_f32_dpp v196, v243, v66 row_newbcast:4 row_mask:0xf bank_mask:0xf
    v_mul_f32_dpp v197, v243, v67 row_newbcast:5 row_mask:0xf bank_mask:0xf
    v_mul_f32_dpp v198, v243, v66 row_newbcast:12 row_mask:0xf bank_mask:0xf
    v_mul_f32_dpp v199, v243, v67 row_newbcast:13 row_mask:0xf bank_mask:0xf
    v_mul_f32_dpp v200, v243, v70 row_newbcast:6 row_mask:0xf bank_mask:0xf
    v_mul_f32_dpp v201, v243, v71 row_newbcast:7 row_mask:0xf bank_mask:0xf
    v_mul_f32_dpp v202, v243, v70 row_newbcast:14 row_mask:0xf bank_mask:0xf
    v_mul_f32_dpp v203, v243, v71 row_newbcast:15 row_mask:0xf bank_mask:0xf
    v_cvt_pk_bf16_f32 v66, v196, v197
    v_cvt_pk_bf16_f32 v70, v198, v199
    v_cvt_pk_bf16_f32 v67, v200, v201
    v_cvt_pk_bf16_f32 v71, v202, v203
    s_waitcnt lgkmcnt(0)
    v_mfma_f32_32x32x16_bf16 v[0:15], v[64:67], v[176:179], v[0:15]
    s_add_u32 m0, s21, 6144
    v_mfma_f32_32x32x16_bf16 v[48:63], v[68:71], v[176:179], v[48:63]
    buffer_load_dwordx4 v240, s[4:7], s35 offen  lds
    buffer_load_dwordx4 v241, s[8:11], s35 offen offset:1024  lds
    s_mov_b32 m0, s50
    s_nop 0
    s_movrels_b32 s71, s23
    s_bfe_u32 s46, s71, 0x30012
    s_mov_b32 m0, s46
    s_and_b32 s66, s71, 0x3ffff
    s_movrels_b32 s68, s57
    s_movrels_b32 s69, s61
    s_sub_u32 s48, s66, s47
    s_mov_b32 s47, s66
    s_lshr_b32 s52, s71, 28
    s_lshl_b32 s67, s46, 9
    s_add_u32 s66, s66, s67
    s_sub_u32 s49, s66, s42
    s_mov_b32 s42, s66
    s_bfe_u32 s66, s68, 655360
    s_add_u32 s43, s42, s66
    s_bfe_u32 s39, s69, 655360
    s_bfe_u32 s66, s68, 655370
    s_add_u32 s44, s42, s66
    s_bfe_u32 s40, s69, 655370
    s_bfe_u32 s66, s68, 655380
    s_add_u32 s45, s42, s66
    s_bfe_u32 s41, s69, 655380
    s_and_b32 s66, s46, s33
    s_cselect_b32 s72, -1, 1
    s_cselect_b32 s76, s47, 163712
    s_cmp_ge_u32 s66, 2
    s_cselect_b32 s73, -1, 0
    s_add_u32 s77, s47, 1024
    s_cmp_ge_u32 s66, 4
    s_cselect_b32 s75, -1, 0
    s_cmp_ge_u32 s66, 3
    s_cselect_b32 s74, -1, 1
    s_cselect_b32 s77, s77, 163712
    v_mfma_f32_32x32x16_bf16 v[16:31], v[72:75], v[180:183], 0
    v_mul_f32 v196, v0, v96
    v_fmac_f32 v196, v1, v97
    v_fmac_f32 v196, v2, v98
    v_fmac_f32 v196, v3, v99
    v_fmac_f32 v196, v4, v100
    v_fmac_f32 v196, v5, v101
    v_mfma_f32_32x32x16_bf16 v[32:47], v[76:79], v[180:183], 0
    v_mfma_f32_32x32x16_bf16 v[16:31], v[80:83], v[184:187], v[16:31]
    v_fmac_f32 v196, v6, v102
    v_fmac_f32 v196, v7, v103
    v_mul_f32 v198, v8, v128
    v_fmac_f32 v198, v9, v129
    v_mfma_f32_32x32x16_bf16 v[32:47], v[84:87], v[184:187], v[32:47]
    v_fmac_f32 v198, v10, v130
    v_fmac_f32 v198, v11, v131
    v_fmac_f32 v198, v12, v132
    v_fmac_f32 v198, v13, v133
    v_fmac_f32 v198, v14, v134
    v_fmac_f32 v198, v15, v135
    v_mfma_f32_32x32x16_bf16 v[16:31], v[88:91], v[188:191], v[16:31]
    v_mul_f32 v200, v48, v128
    v_fmac_f32 v200, v49, v129
    v_permlane32_swap_b32 v196, v198
    v_fmac_f32 v200, v50, v130
    v_fmac_f32 v200, v51, v131
    v_fmac_f32 v200, v52, v132
    v_mfma_f32_32x32x16_bf16 v[32:47], v[92:95], v[188:191], v[32:47]
    s_waitcnt vmcnt(6)
    ds_read_b64_tr_b16 v[176:177], v244 offset:0
    ds_read_b64_tr_b16 v[178:179], v244 offset:1024
    ds_read_b64_tr_b16 v[180:181], v245 offset:0
    ds_read_b64_tr_b16 v[182:183], v245 offset:1024
    v_fmac_f32 v200, v53, v133
    v_fmac_f32 v200, v54, v134
    v_mfma_f32_32x32x16_bf16 v[16:31], v[64:67], v[192:195], v[16:31]
    v_fmac_f32 v200, v55, v135
    v_add_f32 v198, v196, v198
    v_mul_f32_e64 v202, v56, -v128
    v_fma_f32 v202, v57, -v129, v202
    v_fma_f32 v202, v58, -v130, v202
    v_fma_f32 v202, v59, -v131, v202
    v_mfma_f32_32x32x16_bf16 v[32:47], v[68:71], v[192:195], v[32:47]
    v_fma_f32 v202, v60, -v132, v202
    v_fma_f32 v202, v61, -v133, v202
    v_fma_f32 v202, v62, -v134, v202
    v_fma_f32 v202, v63, -v135, v202
    s_nop 1
    v_permlane32_swap_b32 v200, v202
    v_add_f32 v202, v200, v202
    s_waitcnt vmcnt(4) lgkmcnt(0)
    v_mfma_f32_32x32x16_bf16 v[0:15], v[72:75], v[176:179], 0
    v_mul_f32 v197, v16, v104
    v_fmac_f32 v197, v17, v105
    v_fmac_f32 v197, v18, v106
    v_fmac_f32 v197, v19, v107
    v_fmac_f32 v197, v20, v108
    v_fmac_f32 v197, v21, v109
    s_add_u32 m0, s21, 0
    v_mfma_f32_32x32x16_bf16 v[48:63], v[76:79], v[176:179], 0
    buffer_load_dwordx4 v234, s[4:7], s36 offen  lds
    buffer_load_dwordx4 v235, s[8:11], s36 offen offset:1024  lds
    ds_read_b64_tr_b16 v[176:177], v244 offset:2048
    ds_read_b64_tr_b16 v[178:179], v244 offset:3072
    ds_read_b64_tr_b16 v[184:185], v245 offset:2048
    ds_read_b64_tr_b16 v[186:187], v245 offset:3072
    v_fmac_f32 v197, v22, v110
    v_fmac_f32 v197, v23, v111
    v_mul_f32 v199, v24, v136
    v_fmac_f32 v199, v25, v137
    v_fmac_f32 v199, v26, v138
    v_fmac_f32 v199, v27, v139
    v_fmac_f32 v199, v28, v140
    v_fmac_f32 v199, v29, v141
    v_fmac_f32 v199, v30, v142
    v_fmac_f32 v199, v31, v143
    s_waitcnt vmcnt(4) lgkmcnt(0)
    v_mfma_f32_32x32x16_bf16 v[0:15], v[80:83], v[176:179], v[0:15]
    v_mul_f32 v201, v32, v136
    v_fmac_f32 v201, v33, v137
    v_permlane32_swap_b32 v197, v199
    v_fmac_f32 v201, v34, v138
    v_fmac_f32 v201, v35, v139
    v_fmac_f32 v201, v36, v140
    s_add_u32 m0, s21, 2048
    v_mfma_f32_32x32x16_bf16 v[48:63], v[84:87], v[176:179], v[48:63]
    buffer_load_dwordx4 v236, s[4:7], s36 offen  lds
    buffer_load_dwordx4 v237, s[8:11], s36 offen offset:1024  lds
    ds_read_b64_tr_b16 v[176:177], v244 offset:4096
    ds_read_b64_tr_b16 v[178:179], v244 offset:5120
    ds_read_b64_tr_b16 v[188:189], v245 offset:4096
    ds_read_b64_tr_b16 v[190:191], v245 offset:5120
    s_waitcnt vmcnt(4) lgkmcnt(0)
    v_mfma_f32_32x32x16_bf16 v[0:15], v[88:91], v[176:179], v[0:15]
    v_fmac_f32 v201, v37, v141
    v_fmac_f32 v201, v38, v142
    v_fmac_f32 v201, v39, v143
    v_add_f32 v199, v197, v199
    v_mul_f32_e64 v203, v40, -v136
    v_fma_f32 v203, v41, -v137, v203
    s_add_u32 m0, s21, 4096
    v_mfma_f32_32x32x16_bf16 v[48:63], v[92:95], v[176:179], v[48:63]
    buffer_load_dwordx4 v238, s[4:7], s36 offen  lds
    buffer_load_dwordx4 v239, s[8:11], s36 offen offset:1024  lds
    ds_read_b64_tr_b16 v[176:177], v244 offset:6144
    ds_read_b64_tr_b16 v[178:179], v244 offset:7168
    ds_read_b64_tr_b16 v[192:193], v245 offset:6144
    ds_read_b64_tr_b16 v[194:195], v245 offset:7168
    s_waitcnt lgkmcnt(0)
    v_mfma_f32_32x32x16_bf16 v[0:15], v[64:67], v[176:179], v[0:15]
    v_fma_f32 v203, v42, -v138, v203
    v_fma_f32 v203, v43, -v139, v203
    v_fma_f32 v203, v44, -v140, v203
    v_fma_f32 v203, v45, -v141, v203
    v_fma_f32 v203, v46, -v142, v203
    v_fma_f32 v203, v47, -v143, v203
    s_nop 1
    s_add_u32 m0, s21, 6144
    v_mfma_f32_32x32x16_bf16 v[48:63], v[68:71], v[176:179], v[48:63]
    buffer_load_dwordx4 v240, s[4:7], s36 offen  lds
    buffer_load_dwordx4 v241, s[8:11], s36 offen offset:1024  lds
    v_permlane32_swap_b32 v201, v203
    v_add_f32 v203, v201, v203
    s_set_gpr_idx_on s51, gpr_idx(DST)
    s_nop 0
    v_cvt_pk_bf16_f32 v204, v198, v199
    v_cvt_pk_bf16_f32 v205, v202, v203
    s_set_gpr_idx_off
    v_mfma_f32_32x32x16_bf16 v[16:31], v[72:75], v[180:183], 0
    v_mul_f32 v196, v0, v144
    v_fmac_f32 v196, v1, v145
    v_fmac_f32 v196, v2, v146
    v_fmac_f32 v196, v3, v147
    v_fmac_f32 v196, v4, v148
    v_fmac_f32 v196, v5, v149
    v_mfma_f32_32x32x16_bf16 v[32:47], v[76:79], v[180:183], 0
    v_add_u32 v253, s47, v248
    ds_read_b32 v254, v253
    ds_read_b32 v255, v253 offset:256
    v_mfma_f32_32x32x16_bf16 v[16:31], v[80:83], v[184:187], v[16:31]
    v_mfma_f32_32x32x16_bf16 v[32:47], v[84:87], v[184:187], v[32:47]
    v_fmac_f32 v196, v6, v150
    v_fmac_f32 v196, v7, v151
    v_mul_f32 v198, v8, v112
    v_fmac_f32 v198, v9, v113
    v_fmac_f32 v198, v10, v114
    v_fmac_f32 v198, v11, v115
    v_mfma_f32_32x32x16_bf16 v[16:31], v[88:91], v[188:191], v[16:31]
    v_fmac_f32 v198, v12, v116
    v_fmac_f32 v198, v13, v117
    v_fmac_f32 v198, v14, v118
    v_fmac_f32 v198, v15, v119
    v_mul_f32_e64 v200, v48, -v160
    v_fma_f32 v200, v49, -v161, v200
    v_mfma_f32_32x32x16_bf16 v[32:47], v[92:95], v[188:191], v[32:47]
    s_waitcnt vmcnt(6)
    ds_read_b64_tr_b16 v[176:177], v244 offset:0
    ds_read_b64_tr_b16 v[178:179], v244 offset:1024
    ds_read_b64_tr_b16 v[180:181], v245 offset:0
    ds_read_b64_tr_b16 v[182:183], v245 offset:1024
    v_fma_f32 v200, v50, -v162, v200
    v_fma_f32 v200, v51, -v163, v200
    v_mfma_f32_32x32x16_bf16 v[16:31], v[64:67], v[192:195], v[16:31]
    v_fma_f32 v200, v52, -v164, v200
    v_fma_f32 v200, v53, -v165, v200
    v_fma_f32 v200, v54, -v166, v200
    v_fma_f32 v200, v55, -v167, v200
    v_mul_f32_e64 v202, v56, -v160
    v_fma_f32 v202, v57, -v161, v202
    v_mfma_f32_32x32x16_bf16 v[32:47], v[68:71], v[192:195], v[32:47]
    v_fma_f32 v202, v58, -v162, v202
    v_fma_f32 v202, v59, -v163, v202
    v_fma_f32 v202, v60, -v164, v202
    v_fma_f32 v202, v61, -v165, v202
    v_fma_f32 v202, v62, -v166, v202
    v_fma_f32 v202, v63, -v167, v202
    s_waitcnt vmcnt(4) lgkmcnt(0)
    v_mfma_f32_32x32x16_bf16 v[0:15], v[72:75], v[176:179], 0
    v_mul_f32 v197, v16, v152
    v_fmac_f32 v197, v17, v153
    v_fmac_f32 v197, v18, v154
    v_fmac_f32 v197, v19, v155
    v_fmac_f32 v197, v20, v156
    v_fmac_f32 v197, v21, v157
    s_add_u32 m0, s21, 0
    v_mfma_f32_32x32x16_bf16 v[48:63], v[76:79], v[176:179], 0
    buffer_load_dwordx4 v234, s[4:7], s37 offen  lds
    buffer_load_dwordx4 v235, s[8:11], s37 offen offset:1024  lds
    ds_read_b64_tr_b16 v[176:177], v244 offset:2048
    ds_read_b64_tr_b16 v[178:179], v244 offset:3072
    ds_read_b64_tr_b16 v[184:185], v245 offset:2048
    ds_read_b64_tr_b16 v[186:187], v245 offset:3072
    v_add_u32 v252, s42, v247
    ds_read2_b32 v[234:235], v252 offset0:0 offset1:16
    s_mov_b32 m0, s76
    s_mov_b64 exec, s[72:73]
    buffer_load_dwordx4 v254, s[12:15], 0 offen  lds
    s_mov_b32 m0, s77
    s_mov_b64 exec, s[74:75]
    buffer_load_dwordx4 v255, s[12:15], 0 offen  lds
    s_mov_b64 exec, -1
    v_fmac_f32 v197, v22, v158
    v_fmac_f32 v197, v23, v159
    v_mul_f32 v199, v24, v120
    v_fmac_f32 v199, v25, v121
    v_fmac_f32 v199, v26, v122
    v_fmac_f32 v199, v27, v123
    s_waitcnt vmcnt(6) lgkmcnt(1)
    v_mfma_f32_32x32x16_bf16 v[0:15], v[80:83], v[176:179], v[0:15]
    v_fmac_f32 v199, v28, v124
    v_fmac_f32 v199, v29, v125
    v_fmac_f32 v199, v30, v126
    v_fmac_f32 v199, v31, v127
    v_mul_f32_e64 v201, v32, -v168
    v_fma_f32 v201, v33, -v169, v201
    s_add_u32 m0, s21, 2048
    v_mfma_f32_32x32x16_bf16 v[48:63], v[84:87], v[176:179], v[48:63]
    buffer_load_dwordx4 v236, s[4:7], s37 offen  lds
    buffer_load_dwordx4 v237, s[8:11], s37 offen offset:1024  lds
    ds_read_b64_tr_b16 v[176:177], v244 offset:4096
    ds_read_b64_tr_b16 v[178:179], v244 offset:5120
    ds_read_b64_tr_b16 v[188:189], v245 offset:4096
    ds_read_b64_tr_b16 v[190:191], v245 offset:5120
    v_add_u32 v252, s43, v247
    ds_read2_b32 v[236:237], v252 offset0:0 offset1:16
    s_waitcnt vmcnt(6) lgkmcnt(1)
    v_mfma_f32_32x32x16_bf16 v[0:15], v[88:91], v[176:179], v[0:15]
    v_fma_f32 v201, v34, -v170, v201
    v_fma_f32 v201, v35, -v171, v201
    v_fma_f32 v201, v36, -v172, v201
    v_fma_f32 v201, v37, -v173, v201
    v_fma_f32 v201, v38, -v174, v201
    v_fma_f32 v201, v39, -v175, v201
    s_add_u32 m0, s21, 4096
    v_mfma_f32_32x32x16_bf16 v[48:63], v[92:95], v[176:179], v[48:63]
    buffer_load_dwordx4 v238, s[4:7], s37 offen  lds
    buffer_load_dwordx4 v239, s[8:11], s37 offen offset:1024  lds
    ds_read_b64_tr_b16 v[176:177], v244 offset:6144
    ds_read_b64_tr_b16 v[178:179], v244 offset:7168
    ds_read_b64_tr_b16 v[192:193], v245 offset:6144
    ds_read_b64_tr_b16 v[194:195], v245 offset:7168
    v_add_u32 v252, s44, v247
    ds_read2_b32 v[238:239], v252 offset0:0 offset1:16
    s_waitcnt lgkmcnt(1)
    v_mfma_f32_32x32x16_bf16 v[0:15], v[64:67], v[176:179], v[0:15]
    v_mul_f32_e64 v203, v40, -v168
    v_fma_f32 v203, v41, -v169, v203
    v_fma_f32 v203, v42, -v170, v203
    v_fma_f32 v203, v43, -v171, v203
    v_fma_f32 v203, v44, -v172, v203
    v_fma_f32 v203, v45, -v173, v203
    s_add_u32 m0, s21, 6144
    v_mfma_f32_32x32x16_bf16 v[48:63], v[68:71], v[176:179], v[48:63]
    buffer_load_dwordx4 v240, s[4:7], s37 offen  lds
    buffer_load_dwordx4 v241, s[8:11], s37 offen offset:1024  lds
    v_add_u32 v252, s45, v247
    ds_read2_b32 v[240:241], v252 offset0:0 offset1:16
    v_fma_f32 v203, v46, -v174, v203
    v_fma_f32 v203, v47, -v175, v203
    v_mfma_f32_32x32x16_bf16 v[16:31], v[72:75], v[180:183], 0
    v_mul_f32 v254, v0, v144
    v_fmac_f32 v254, v1, v145
    v_fmac_f32 v254, v2, v146
    v_fmac_f32 v254, v3, v147
    v_fmac_f32 v254, v4, v148
    v_fmac_f32 v254, v5, v149
    v_mfma_f32_32x32x16_bf16 v[32:47], v[76:79], v[180:183], 0
    ds_swizzle_b32 v76, v76 offset:0x401F
    ds_swizzle_b32 v77, v77 offset:0x401F
    ds_swizzle_b32 v78, v78 offset:0x401F
    ds_swizzle_b32 v79, v79 offset:0x401F
    v_mfma_f32_32x32x16_bf16 v[16:31], v[80:83], v[184:187], v[16:31]
    v_mfma_f32_32x32x16_bf16 v[32:47], v[84:87], v[184:187], v[32:47]
    ds_swizzle_b32 v84, v84 offset:0x401F
    ds_swizzle_b32 v85, v85 offset:0x401F
    ds_swizzle_b32 v86, v86 offset:0x401F
    ds_swizzle_b32 v87, v87 offset:0x401F
    v_mfma_f32_32x32x16_bf16 v[16:31], v[88:91], v[188:191], v[16:31]
    v_fmac_f32 v254, v6, v150
    v_fmac_f32 v254, v7, v151
    v_fmac_f32 v200, v8, v160
    v_fmac_f32 v200, v9, v161
    v_mfma_f32_32x32x16_bf16 v[32:47], v[92:95], v[188:191], v[32:47]
    ds_swizzle_b32 v92, v92 offset:0x401F
    ds_swizzle_b32 v93, v93 offset:0x401F
    ds_swizzle_b32 v94, v94 offset:0x401F
    ds_swizzle_b32 v95, v95 offset:0x401F
    s_waitcnt vmcnt(8)
    ds_read_b64_tr_b16 v[176:177], v244 offset:0
    ds_read_b64_tr_b16 v[178:179], v244 offset:1024
    ds_read_b64_tr_b16 v[180:181], v245 offset:0
    ds_read_b64_tr_b16 v[182:183], v245 offset:1024
    v_mfma_f32_32x32x16_bf16 v[16:31], v[64:67], v[192:195], v[16:31]
    v_permlane32_swap_b32 v196, v254
    v_fmac_f32 v200, v10, v162
    v_fmac_f32 v200, v11, v163
    v_fmac_f32 v200, v12, v164
    v_fmac_f32 v200, v13, v165
    v_fmac_f32 v200, v14, v166
    v_mfma_f32_32x32x16_bf16 v[32:47], v[68:71], v[192:195], v[32:47]
    ds_swizzle_b32 v68, v68 offset:0x401F
    ds_swizzle_b32 v69, v69 offset:0x401F
    ds_swizzle_b32 v70, v70 offset:0x401F
    ds_swizzle_b32 v71, v71 offset:0x401F
    v_fmac_f32 v200, v15, v167
    v_add_f32 v254, v196, v254
    s_waitcnt lgkmcnt(8)
    s_mov_b64 exec, s[56:57]
    v_xor_b32 v76, 0x80008000, v76
    v_xor_b32 v77, 0x80008000, v77
    v_xor_b32 v78, 0x80008000, v78
    v_xor_b32 v79, 0x80008000, v79
    v_xor_b32 v84, 0x80008000, v84
    v_xor_b32 v85, 0x80008000, v85
    v_xor_b32 v86, 0x80008000, v86
    v_xor_b32 v87, 0x80008000, v87
    v_xor_b32 v92, 0x80008000, v92
    v_xor_b32 v93, 0x80008000, v93
    v_xor_b32 v94, 0x80008000, v94
    v_xor_b32 v95, 0x80008000, v95
    s_mov_b64 exec, -1
    s_waitcnt vmcnt(4) lgkmcnt(4)
    v_mfma_f32_32x32x16_bf16 v[0:15], v[72:75], v[176:179], 0
    v_mul_f32 v255, v16, v152
    v_fmac_f32 v255, v17, v153
    v_fmac_f32 v255, v18, v154
    v_fmac_f32 v255, v19, v155
    v_fmac_f32 v255, v20, v156
    v_fmac_f32 v255, v21, v157
    s_add_u32 m0, s21, 0
    v_mfma_f32_32x32x16_bf16 v[48:63], v[76:79], v[176:179], v[48:63]
    v_mad_u32_u16 v234, v234, s3, v246 op_sel:[1,0,0,0]
    v_mad_u32_u16 v235, v235, s3, v246 op_sel:[1,0,0,0]
    buffer_load_dwordx4 v234, s[4:7], s38 offen  lds
    buffer_load_dwordx4 v235, s[8:11], s38 offen offset:1024  lds
    ds_read_b64_tr_b16 v[176:177], v244 offset:2048
    ds_read_b64_tr_b16 v[178:179], v244 offset:3072
    ds_read_b64_tr_b16 v[184:185], v245 offset:2048
    ds_read_b64_tr_b16 v[186:187], v245 offset:3072
    s_waitcnt vmcnt(4) lgkmcnt(0)
    v_mfma_f32_32x32x16_bf16 v[0:15], v[80:83], v[176:179], v[0:15]
    s_add_u32 m0, s21, 2048
    v_mfma_f32_32x32x16_bf16 v[48:63], v[84:87], v[176:179], v[48:63]
    v_mad_u32_u16 v236, v236, s3, v246 op_sel:[1,0,0,0]
    v_mad_u32_u16 v237, v237, s3, v246 op_sel:[1,0,0,0]
    buffer_load_dwordx4 v236, s[4:7], s39 offen  lds
    buffer_load_dwordx4 v237, s[8:11], s39 offen offset:1024  lds
    ds_read_b64_tr_b16 v[176:177], v244 offset:4096
    ds_read_b64_tr_b16 v[178:179], v244 offset:5120
    ds_read_b64_tr_b16 v[188:189], v245 offset:4096
    ds_read_b64_tr_b16 v[190:191], v245 offset:5120
    s_waitcnt vmcnt(4) lgkmcnt(0)
    v_mfma_f32_32x32x16_bf16 v[0:15], v[88:91], v[176:179], v[0:15]
    v_fmac_f32 v255, v22, v158
    v_fmac_f32 v255, v23, v159
    v_fmac_f32 v201, v24, v168
    v_fmac_f32 v201, v25, v169
    v_permlane32_swap_b32 v197, v255
    s_add_u32 m0, s21, 4096
    v_mfma_f32_32x32x16_bf16 v[48:63], v[92:95], v[176:179], v[48:63]
    v_mad_u32_u16 v238, v238, s3, v246 op_sel:[1,0,0,0]
    v_mad_u32_u16 v239, v239, s3, v246 op_sel:[1,0,0,0]
    buffer_load_dwordx4 v238, s[4:7], s40 offen  lds
    buffer_load_dwordx4 v239, s[8:11], s40 offen offset:1024  lds
    ds_read_b64_tr_b16 v[176:177], v244 offset:6144
    ds_read_b64_tr_b16 v[178:179], v244 offset:7168
    ds_read_b64_tr_b16 v[192:193], v245 offset:6144
    ds_read_b64_tr_b16 v[194:195], v245 offset:7168
    s_waitcnt lgkmcnt(0)
    s_mov_b64 exec, s[56:57]
    v_xor_b32 v68, 0x80008000, v68
    v_xor_b32 v69, 0x80008000, v69
    v_xor_b32 v70, 0x80008000, v70
    v_xor_b32 v71, 0x80008000, v71
    s_mov_b64 exec, -1
    v_mfma_f32_32x32x16_bf16 v[0:15], v[64:67], v[176:179], v[0:15]
    v_fmac_f32 v201, v26, v170
    v_fmac_f32 v201, v27, v171
    v_fmac_f32 v201, v28, v172
    v_fmac_f32 v201, v29, v173
    v_fmac_f32 v201, v30, v174
    v_fmac_f32 v201, v31, v175
    s_add_u32 m0, s21, 6144
    v_mfma_f32_32x32x16_bf16 v[48:63], v[68:71], v[176:179], v[48:63]
    v_mad_u32_u16 v240, v240, s3, v246 op_sel:[1,0,0,0]
    v_mad_u32_u16 v241, v241, s3, v246 op_sel:[1,0,0,0]
    buffer_load_dwordx4 v240, s[4:7], s41 offen  lds
    buffer_load_dwordx4 v241, s[8:11], s41 offen offset:1024  lds
    v_add_f32 v255, v197, v255
    s_set_gpr_idx_on s51, gpr_idx(DST)
    s_nop 0
    v_cvt_pk_bf16_f32 v206, v254, v255
    s_set_gpr_idx_off
    v_mfma_f32_32x32x16_bf16 v[16:31], v[72:75], v[180:183], 0
    v_mul_f32 v254, v0, v144
    v_fmac_f32 v254, v1, v145
    v_fmac_f32 v254, v2, v146
    v_fmac_f32 v254, v3, v147
    v_fmac_f32 v254, v4, v148
    v_fmac_f32 v254, v5, v149
    v_mfma_f32_32x32x16_bf16 v[32:47], v[76:79], v[180:183], v[32:47]
    v_fmac_f32 v254, v6, v150
    v_fmac_f32 v254, v7, v151
    v_mfma_f32_32x32x16_bf16 v[16:31], v[80:83], v[184:187], v[16:31]
    v_fma_f32 v202, v8, -v160, v202
    v_fma_f32 v202, v9, -v161, v202
    v_permlane32_swap_b32 v254, v200
    v_fma_f32 v202, v10, -v162, v202
    v_fma_f32 v202, v11, -v163, v202
    v_fma_f32 v202, v12, -v164, v202
    v_mfma_f32_32x32x16_bf16 v[32:47], v[84:87], v[184:187], v[32:47]
    v_fma_f32 v202, v13, -v165, v202
    v_fma_f32 v202, v14, -v166, v202
    v_fma_f32 v202, v15, -v167, v202
    v_add_f32 v200, v254, v200
    v_fmac_f32 v198, v48, v112
    v_permlane32_swap_b32 v202, v254
    v_mfma_f32_32x32x16_bf16 v[16:31], v[88:91], v[188:191], v[16:31]
    v_fmac_f32 v198, v49, v113
    v_fmac_f32 v198, v50, v114
    v_fmac_f32 v198, v51, v115
    v_fmac_f32 v198, v52, v116
    v_fmac_f32 v198, v53, v117
    v_fmac_f32 v198, v54, v118
    v_mfma_f32_32x32x16_bf16 v[32:47], v[92:95], v[188:191], v[32:47]
    s_waitcnt vmcnt(6)
    ds_read_b64_tr_b16 v[176:177], v244 offset:0
    ds_read_b64_tr_b16 v[178:179], v244 offset:1024
    ds_read_b64_tr_b16 v[180:181], v245 offset:0
    ds_read_b64_tr_b16 v[182:183], v245 offset:1024
    v_fmac_f32 v198, v55, v119
    v_add_f32 v254, v202, v254
    v_mfma_f32_32x32x16_bf16 v[16:31], v[64:67], v[192:195], v[16:31]
    v_mul_f32 v196, v56, v160
    v_fmac_f32 v196, v57, v161
    v_fmac_f32 v196, v58, v162
    v_fmac_f32 v196, v59, v163
    v_fmac_f32 v196, v60, v164
    v_fmac_f32 v196, v61, v165
    v_mfma_f32_32x32x16_bf16 v[32:47], v[68:71], v[192:195], v[32:47]
    v_add_u32 v249, s48, v249
    v_add_u32 v250, s49, v250
    v_fmac_f32 v196, v62, v166
    v_fmac_f32 v196, v63, v167
    s_nop 1
    v_permlane32_swap_b32 v198, v196
    v_add_f32 v196, v198, v196
    v_mul_f32 v255, v16, v152
    v_fmac_f32 v255, v17, v153
    v_fmac_f32 v255, v18, v154
    v_fmac_f32 v255, v19, v155
    v_fmac_f32 v255, v20, v156
    v_fmac_f32 v255, v21, v157
    v_fmac_f32 v255, v22, v158
    v_fmac_f32 v255, v23, v159
    v_fma_f32 v203, v24, -v168, v203
    v_fma_f32 v203, v25, -v169, v203
    v_permlane32_swap_b32 v255, v201
    v_fma_f32 v203, v26, -v170, v203
    v_fma_f32 v203, v27, -v171, v203
    v_fma_f32 v203, v28, -v172, v203
    v_fma_f32 v203, v29, -v173, v203
    v_fma_f32 v203, v30, -v174, v203
    v_fma_f32 v203, v31, -v175, v203
    v_add_f32 v201, v255, v201
    v_fmac_f32 v199, v32, v120
    v_permlane32_swap_b32 v203, v255
    v_fmac_f32 v199, v33, v121
    v_fmac_f32 v199, v34, v122
    v_fmac_f32 v199, v35, v123
    ds_read_b64_tr_b16 v[72:73], v249 offset:0
    ds_read_b64_tr_b16 v[76:77], v249 offset:64
    ds_read_b64_tr_b16 v[74:75], v249 offset:256
    ds_read_b64_tr_b16 v[78:79], v249 offset:320
    s_mov_b64 exec, s[54:55]
    ds_read_u16_d16_hi v242, v250 offset:0
    s_mov_b64 exec, -1
    v_fmac_f32 v199, v36, v124
    v_fmac_f32 v199, v37, v125
    v_fmac_f32 v199, v38, v126
    v_fmac_f32 v199, v39, v127
    v_add_f32 v255, v203, v255
    v_mul_f32 v197, v40, v168
    v_fmac_f32 v197, v41, v169
    v_fmac_f32 v197, v42, v170
    v_fmac_f32 v197, v43, v171
    v_fmac_f32 v197, v44, v172
    v_fmac_f32 v197, v45, v173
    v_fmac_f32 v197, v46, v174
    v_fmac_f32 v197, v47, v175
    s_nop 1
    v_permlane32_swap_b32 v199, v197
    v_add_f32 v197, v199, v197
    s_set_gpr_idx_on s51, gpr_idx(DST)
    s_nop 0
    v_cvt_pk_bf16_f32 v207, v200, v201
    v_cvt_pk_bf16_f32 v209, v254, v255
    v_cvt_pk_bf16_f32 v208, v196, v197
    s_set_gpr_idx_off
    s_add_u32 s50, s50, 1
    s_add_u32 s51, s51, 6
    s_cmp_ge_u32 s50, 4
    s_cbranch_scc1 LAST0
    s_add_u32 s53, s53, 4
    s_xor_b32 s66, s53, s20
    s_bitcmp1_b32 s66, 2
    s_setprio 1
    s_cbranch_scc1 PRIO_9
    s_setprio 0
PRIO_9:
    s_cmp_eq_u32 s52, 4
    s_cbranch_scc1 ITEM_0_4
    s_cmp_eq_u32 s52, 5
    s_cbranch_scc1 ITEM_0_5
    s_cmp_eq_u32 s52, 3
    s_cbranch_scc1 ITEM_0_3
    s_cmp_eq_u32 s52, 6
    s_cbranch_scc1 ITEM_0_6
    s_cmp_eq_u32 s52, 8
    s_cbranch_scc1 ITEM_0_8
    s_branch ITEM_0_2
.p2align 6
ITEM_0_2:
    s_mov_b32 m0, s50
    s_nop 0
    s_movrels_b32 s71, s23
    s_bfe_u32 s46, s71, 0x30012
    s_mov_b32 m0, s46
    s_and_b32 s66, s71, 0x3ffff
    s_movrels_b32 s68, s57
    s_movrels_b32 s69, s61
    s_sub_u32 s48, s66, s47
    s_mov_b32 s47, s66
    s_lshr_b32 s52, s71, 28
    s_lshl_b32 s67, s46, 9
    s_add_u32 s66, s66, s67
    s_sub_u32 s49, s66, s42
    s_mov_b32 s42, s66
    s_bfe_u32 s66, s68, 655360
    s_add_u32 s43, s42, s66
    s_bfe_u32 s39, s69, 655360
    s_bfe_u32 s66, s68, 655370
    s_add_u32 s44, s42, s66
    s_bfe_u32 s40, s69, 655370
    s_bfe_u32 s66, s68, 655380
    s_add_u32 s45, s42, s66
    s_bfe_u32 s41, s69, 655380
    s_and_b32 s66, s46, s33
    s_cselect_b32 s72, -1, 1
    s_cselect_b32 s76, s47, 163712
    s_cmp_ge_u32 s66, 2
    s_cselect_b32 s73, -1, 0
    s_add_u32 s77, s47, 1024
    s_cmp_ge_u32 s66, 4
    s_cselect_b32 s75, -1, 0
    s_cmp_ge_u32 s66, 3
    s_cselect_b32 s74, -1, 1
    s_cselect_b32 s77, s77, 163712
    v_add_u32 v252, s42, v247
    ds_read2_b32 v[234:235], v252 offset0:0 offset1:16
    v_add_u32 v252, s43, v247
    ds_read2_b32 v[236:237], v252 offset0:0 offset1:16
    v_add_u32 v252, s44, v247
    ds_read2_b32 v[238:239], v252 offset0:0 offset1:16
    v_add_u32 v252, s45, v247
    ds_read2_b32 v[240:241], v252 offset0:0 offset1:16
    s_waitcnt lgkmcnt(4)
    v_mul_f32_dpp v196, v242, v72 row_newbcast:0 row_mask:0xf bank_mask:0xf
    v_mul_f32_dpp v197, v242, v73 row_newbcast:1 row_mask:0xf bank_mask:0xf
    v_mul_f32_dpp v198, v242, v72 row_newbcast:8 row_mask:0xf bank_mask:0xf
    v_mul_f32_dpp v199, v242, v73 row_newbcast:9 row_mask:0xf bank_mask:0xf
    v_mul_f32_dpp v200, v242, v76 row_newbcast:2 row_mask:0xf bank_mask:0xf
    v_mul_f32_dpp v201, v242, v77 row_newbcast:3 row_mask:0xf bank_mask:0xf
    v_mul_f32_dpp v202, v242, v76 row_newbcast:10 row_mask:0xf bank_mask:0xf
    v_mul_f32_dpp v203, v242, v77 row_newbcast:11 row_mask:0xf bank_mask:0xf
    v_cvt_pk_bf16_f32 v72, v196, v197
    v_cvt_pk_bf16_f32 v76, v198, v199
    v_cvt_pk_bf16_f32 v73, v200, v201
    v_cvt_pk_bf16_f32 v77, v202, v203
    v_mul_f32_dpp v196, v242, v74 row_newbcast:4 row_mask:0xf bank_mask:0xf
    v_mul_f32_dpp v197, v242, v75 row_newbcast:5 row_mask:0xf bank_mask:0xf
    v_mul_f32_dpp v198, v242, v74 row_newbcast:12 row_mask:0xf bank_mask:0xf
    v_mul_f32_dpp v199, v242, v75 row_newbcast:13 row_mask:0xf bank_mask:0xf
    v_mul_f32_dpp v200, v242, v78 row_newbcast:6 row_mask:0xf bank_mask:0xf
    v_mul_f32_dpp v201, v242, v79 row_newbcast:7 row_mask:0xf bank_mask:0xf
    v_mul_f32_dpp v202, v242, v78 row_newbcast:14 row_mask:0xf bank_mask:0xf
    v_mul_f32_dpp v203, v242, v79 row_newbcast:15 row_mask:0xf bank_mask:0xf
    v_cvt_pk_bf16_f32 v74, v196, v197
    v_cvt_pk_bf16_f32 v78, v198, v199
    v_cvt_pk_bf16_f32 v75, v200, v201
    v_cvt_pk_bf16_f32 v79, v202, v203
    s_nop 0
    s_waitcnt lgkmcnt(3)
    v_mfma_f32_32x32x16_bf16 v[0:15], v[72:75], v[176:179], 0
    s_add_u32 m0, s21, 0
    v_mfma_f32_32x32x16_bf16 v[48:63], v[76:79], v[176:179], 0
    v_mad_u32_u16 v234, v234, s3, v246 op_sel:[1,0,0,0]
    v_mad_u32_u16 v235, v235, s3, v246 op_sel:[1,0,0,0]
    buffer_load_dwordx4 v234, s[4:7], s38 offen  lds
    buffer_load_dwordx4 v235, s[8:11], s38 offen offset:1024  lds
    v_mfma_f32_32x32x16_bf16 v[16:31], v[72:75], v[180:183], 0
    s_nop 4
    v_mul_f32 v196, v0, v96
    v_fmac_f32 v196, v1, v97
    v_fmac_f32 v196, v2, v98
    v_fmac_f32 v196, v3, v99
    v_fmac_f32 v196, v4, v100
    v_fmac_f32 v196, v5, v101
    v_mfma_f32_32x32x16_bf16 v[32:47], v[76:79], v[180:183], 0
    s_waitcnt vmcnt(6)
    ds_read_b64_tr_b16 v[176:177], v244 offset:2048
    ds_read_b64_tr_b16 v[178:179], v244 offset:3072
    ds_read_b64_tr_b16 v[180:181], v245 offset:2048
    ds_read_b64_tr_b16 v[182:183], v245 offset:3072
    v_fmac_f32 v196, v6, v102
    v_fmac_f32 v196, v7, v103
    v_mul_f32 v198, v8, v128
    v_fmac_f32 v198, v9, v129
    v_fmac_f32 v198, v10, v130
    v_fmac_f32 v198, v11, v131
    v_fmac_f32 v198, v12, v132
    v_fmac_f32 v198, v13, v133
    v_fmac_f32 v198, v14, v134
    v_fmac_f32 v198, v15, v135
    v_mul_f32 v200, v48, v128
    v_fmac_f32 v200, v49, v129
    v_permlane32_swap_b32 v196, v198
    v_fmac_f32 v200, v50, v130
    v_fmac_f32 v200, v51, v131
    v_fmac_f32 v200, v52, v132
    v_fmac_f32 v200, v53, v133
    v_fmac_f32 v200, v54, v134
    v_fmac_f32 v200, v55, v135
    v_add_f32 v198, v196, v198
    v_mul_f32_e64 v202, v56, -v128
    v_fma_f32 v202, v57, -v129, v202
    v_fma_f32 v202, v58, -v130, v202
    v_fma_f32 v202, v59, -v131, v202
    v_fma_f32 v202, v60, -v132, v202
    v_fma_f32 v202, v61, -v133, v202
    v_fma_f32 v202, v62, -v134, v202
    v_fma_f32 v202, v63, -v135, v202
    s_nop 1
    v_permlane32_swap_b32 v200, v202
    v_add_f32 v202, v200, v202
    s_waitcnt lgkmcnt(0)
    v_mfma_f32_32x32x16_bf16 v[0:15], v[72:75], v[176:179], 0
    v_mul_f32 v197, v16, v104
    v_fmac_f32 v197, v17, v105
    v_fmac_f32 v197, v18, v106
    v_fmac_f32 v197, v19, v107
    v_fmac_f32 v197, v20, v108
    v_fmac_f32 v197, v21, v109
    s_add_u32 m0, s21, 2048
    v_mfma_f32_32x32x16_bf16 v[48:63], v[76:79], v[176:179], 0
    v_mad_u32_u16 v236, v236, s3, v246 op_sel:[1,0,0,0]
    v_mad_u32_u16 v237, v237, s3, v246 op_sel:[1,0,0,0]
    buffer_load_dwordx4 v236, s[4:7], s39 offen  lds
    buffer_load_dwordx4 v237, s[8:11], s39 offen offset:1024  lds
    v_fmac_f32 v197, v22, v110
    v_fmac_f32 v197, v23, v111
    v_mul_f32 v199, v24, v136
    v_fmac_f32 v199, v25, v137
    v_fmac_f32 v199, v26, v138
    v_fmac_f32 v199, v27, v139
    v_fmac_f32 v199, v28, v140
    v_fmac_f32 v199, v29, v141
    v_fmac_f32 v199, v30, v142
    v_fmac_f32 v199, v31, v143
    v_mul_f32 v201, v32, v136
    v_fmac_f32 v201, v33, v137
    v_permlane32_swap_b32 v197, v199
    v_fmac_f32 v201, v34, v138
    v_fmac_f32 v201, v35, v139
    v_fmac_f32 v201, v36, v140
    v_fmac_f32 v201, v37, v141
    v_fmac_f32 v201, v38, v142
    v_fmac_f32 v201, v39, v143
    v_add_f32 v199, v197, v199
    v_mul_f32_e64 v203, v40, -v136
    v_fma_f32 v203, v41, -v137, v203
    v_fma_f32 v203, v42, -v138, v203
    v_fma_f32 v203, v43, -v139, v203
    v_fma_f32 v203, v44, -v140, v203
    v_fma_f32 v203, v45, -v141, v203
    v_fma_f32 v203, v46, -v142, v203
    v_fma_f32 v203, v47, -v143, v203
    s_nop 1
    v_permlane32_swap_b32 v201, v203
    v_add_f32 v203, v201, v203
    s_set_gpr_idx_on s51, gpr_idx(DST)
    s_nop 0
    v_cvt_pk_bf16_f32 v204, v198, v199
    v_cvt_pk_bf16_f32 v205, v202, v203
    s_set_gpr_idx_off
    v_mfma_f32_32x32x16_bf16 v[16:31], v[72:75], v[180:183], 0
    v_mul_f32 v196, v0, v144
    v_fmac_f32 v196, v1, v145
    v_fmac_f32 v196, v2, v146
    v_fmac_f32 v196, v3, v147
    v_fmac_f32 v196, v4, v148
    v_fmac_f32 v196, v5, v149
    v_mfma_f32_32x32x16_bf16 v[32:47], v[76:79], v[180:183], 0
    s_waitcnt vmcnt(6)
    ds_read_b64_tr_b16 v[176:177], v244 offset:4096
    ds_read_b64_tr_b16 v[178:179], v244 offset:5120
    ds_read_b64_tr_b16 v[180:181], v245 offset:4096
    ds_read_b64_tr_b16 v[182:183], v245 offset:5120
    v_fmac_f32 v196, v6, v150
    v_fmac_f32 v196, v7, v151
    v_mul_f32 v198, v8, v112
    v_fmac_f32 v198, v9, v113
    v_fmac_f32 v198, v10, v114
    v_fmac_f32 v198, v11, v115
    v_fmac_f32 v198, v12, v116
    v_fmac_f32 v198, v13, v117
    v_fmac_f32 v198, v14, v118
    v_fmac_f32 v198, v15, v119
    v_mul_f32_e64 v200, v48, -v160
    v_fma_f32 v200, v49, -v161, v200
    v_fma_f32 v200, v50, -v162, v200
    v_fma_f32 v200, v51, -v163, v200
    v_fma_f32 v200, v52, -v164, v200
    v_fma_f32 v200, v53, -v165, v200
    v_fma_f32 v200, v54, -v166, v200
    v_fma_f32 v200, v55, -v167, v200
    v_mul_f32_e64 v202, v56, -v160
    v_fma_f32 v202, v57, -v161, v202
    v_fma_f32 v202, v58, -v162, v202
    v_fma_f32 v202, v59, -v163, v202
    v_fma_f32 v202, v60, -v164, v202
    v_fma_f32 v202, v61, -v165, v202
    v_fma_f32 v202, v62, -v166, v202
    v_fma_f32 v202, v63, -v167, v202
    s_waitcnt lgkmcnt(0)
    v_mfma_f32_32x32x16_bf16 v[0:15], v[72:75], v[176:179], 0
    v_mul_f32 v197, v16, v152
    v_fmac_f32 v197, v17, v153
    v_fmac_f32 v197, v18, v154
    v_fmac_f32 v197, v19, v155
    v_fmac_f32 v197, v20, v156
    v_fmac_f32 v197, v21, v157
    s_add_u32 m0, s21, 4096
    v_mfma_f32_32x32x16_bf16 v[48:63], v[76:79], v[176:179], 0
    v_mad_u32_u16 v238, v238, s3, v246 op_sel:[1,0,0,0]
    v_mad_u32_u16 v239, v239, s3, v246 op_sel:[1,0,0,0]
    buffer_load_dwordx4 v238, s[4:7], s40 offen  lds
    buffer_load_dwordx4 v239, s[8:11], s40 offen offset:1024  lds
    v_fmac_f32 v197, v22, v158
    v_fmac_f32 v197, v23, v159
    v_mul_f32 v199, v24, v120
    v_fmac_f32 v199, v25, v121
    v_fmac_f32 v199, v26, v122
    v_fmac_f32 v199, v27, v123
    v_fmac_f32 v199, v28, v124
    v_fmac_f32 v199, v29, v125
    v_fmac_f32 v199, v30, v126
    v_fmac_f32 v199, v31, v127
    v_mul_f32_e64 v201, v32, -v168
    v_fma_f32 v201, v33, -v169, v201
    v_fma_f32 v201, v34, -v170, v201
    v_fma_f32 v201, v35, -v171, v201
    v_fma_f32 v201, v36, -v172, v201
    v_fma_f32 v201, v37, -v173, v201
    v_fma_f32 v201, v38, -v174, v201
    v_fma_f32 v201, v39, -v175, v201
    v_mul_f32_e64 v203, v40, -v168
    v_fma_f32 v203, v41, -v169, v203
    v_fma_f32 v203, v42, -v170, v203
    v_fma_f32 v203, v43, -v171, v203
    v_fma_f32 v203, v44, -v172, v203
    v_fma_f32 v203, v45, -v173, v203
    v_fma_f32 v203, v46, -v174, v203
    v_fma_f32 v203, v47, -v175, v203
    v_mfma_f32_32x32x16_bf16 v[16:31], v[72:75], v[180:183], 0
    v_mul_f32 v254, v0, v144
    v_fmac_f32 v254, v1, v145
    v_fmac_f32 v254, v2, v146
    v_fmac_f32 v254, v3, v147
    v_fmac_f32 v254, v4, v148
    v_fmac_f32 v254, v5, v149
    v_mfma_f32_32x32x16_bf16 v[32:47], v[76:79], v[180:183], 0
    v_add_u32 v253, s47, v248
    ds_read_b32 v192, v253
    ds_read_b32 v193, v253 offset:256
    s_waitcnt vmcnt(6)
    ds_read_b64_tr_b16 v[176:177], v244 offset:6144
    ds_read_b64_tr_b16 v[178:179], v244 offset:7168
    ds_read_b64_tr_b16 v[180:181], v245 offset:6144
    ds_read_b64_tr_b16 v[182:183], v245 offset:7168
    v_fmac_f32 v254, v6, v150
    v_fmac_f32 v254, v7, v151
    v_fmac_f32 v200, v8, v160
    v_fmac_f32 v200, v9, v161
    v_permlane32_swap_b32 v196, v254
    v_fmac_f32 v200, v10, v162
    v_fmac_f32 v200, v11, v163
    v_fmac_f32 v200, v12, v164
    v_fmac_f32 v200, v13, v165
    v_fmac_f32 v200, v14, v166
    v_fmac_f32 v200, v15, v167
    v_add_f32 v254, v196, v254
    v_xor_b32 v64, 0x80000000, v48
    v_xor_b32 v65, 0x80000000, v49
    v_xor_b32 v66, 0x80000000, v50
    v_xor_b32 v67, 0x80000000, v51
    v_xor_b32 v68, 0x80000000, v52
    v_xor_b32 v69, 0x80000000, v53
    v_xor_b32 v70, 0x80000000, v54
    v_xor_b32 v71, 0x80000000, v55
    s_waitcnt lgkmcnt(0)
    v_mfma_f32_32x32x16_bf16 v[0:15], v[72:75], v[176:179], 0
    v_mul_f32 v255, v16, v152
    v_fmac_f32 v255, v17, v153
    v_fmac_f32 v255, v18, v154
    v_fmac_f32 v255, v19, v155
    v_fmac_f32 v255, v20, v156
    v_fmac_f32 v255, v21, v157
    s_mov_b32 m0, s76
    s_mov_b64 exec, s[72:73]
    buffer_load_dwordx4 v192, s[12:15], 0 offen  lds
    s_mov_b32 m0, s77
    s_mov_b64 exec, s[74:75]
    buffer_load_dwordx4 v193, s[12:15], 0 offen  lds
    s_mov_b64 exec, -1
    s_add_u32 m0, s21, 6144
    v_mfma_f32_32x32x16_bf16 v[56:71], v[76:79], v[176:179], v[56:71]
    v_mad_u32_u16 v240, v240, s3, v246 op_sel:[1,0,0,0]
    v_mad_u32_u16 v241, v241, s3, v246 op_sel:[1,0,0,0]
    buffer_load_dwordx4 v240, s[4:7], s41 offen  lds
    buffer_load_dwordx4 v241, s[8:11], s41 offen offset:1024  lds
    v_fmac_f32 v255, v22, v158
    v_fmac_f32 v255, v23, v159
    v_fmac_f32 v201, v24, v168
    v_fmac_f32 v201, v25, v169
    v_permlane32_swap_b32 v197, v255
    v_fmac_f32 v201, v26, v170
    v_fmac_f32 v201, v27, v171
    v_fmac_f32 v201, v28, v172
    v_fmac_f32 v201, v29, v173
    v_fmac_f32 v201, v30, v174
    v_fmac_f32 v201, v31, v175
    v_add_f32 v255, v197, v255
    v_xor_b32 v48, 0x80000000, v32
    v_xor_b32 v49, 0x80000000, v33
    v_xor_b32 v50, 0x80000000, v34
    v_xor_b32 v51, 0x80000000, v35
    v_xor_b32 v52, 0x80000000, v36
    v_xor_b32 v53, 0x80000000, v37
    v_xor_b32 v54, 0x80000000, v38
    v_xor_b32 v55, 0x80000000, v39
    s_set_gpr_idx_on s51, gpr_idx(DST)
    s_nop 0
    v_cvt_pk_bf16_f32 v206, v254, v255
    s_set_gpr_idx_off
    v_mfma_f32_32x32x16_bf16 v[16:31], v[72:75], v[180:183], 0
    v_mul_f32 v254, v0, v144
    v_fmac_f32 v254, v1, v145
    v_fmac_f32 v254, v2, v146
    v_fmac_f32 v254, v3, v147
    v_fmac_f32 v254, v4, v148
    v_fmac_f32 v254, v5, v149
    v_mfma_f32_32x32x16_bf16 v[40:55], v[76:79], v[180:183], v[40:55]
    s_waitcnt vmcnt(8)
    ds_read_b64_tr_b16 v[176:177], v244 offset:0
    ds_read_b64_tr_b16 v[178:179], v244 offset:1024
    ds_read_b64_tr_b16 v[180:181], v245 offset:0
    ds_read_b64_tr_b16 v[182:183], v245 offset:1024
    v_add_u32 v249, s48, v249
    v_add_u32 v250, s49, v250
    v_fmac_f32 v254, v6, v150
    v_fmac_f32 v254, v7, v151
    v_fma_f32 v202, v8, -v160, v202
    v_fma_f32 v202, v9, -v161, v202
    v_permlane32_swap_b32 v254, v200
    v_fma_f32 v202, v10, -v162, v202
    v_fma_f32 v202, v11, -v163, v202
    v_fma_f32 v202, v12, -v164, v202
    v_fma_f32 v202, v13, -v165, v202
    v_fma_f32 v202, v14, -v166, v202
    v_fma_f32 v202, v15, -v167, v202
    v_add_f32 v200, v254, v200
    v_fma_f32 v198, v64, -v112, v198
    v_permlane32_swap_b32 v202, v254
    v_fma_f32 v198, v65, -v113, v198
    v_fma_f32 v198, v66, -v114, v198
    v_fma_f32 v198, v67, -v115, v198
    v_fma_f32 v198, v68, -v116, v198
    v_fma_f32 v198, v69, -v117, v198
    v_fma_f32 v198, v70, -v118, v198
    v_fma_f32 v198, v71, -v119, v198
    v_add_f32 v254, v202, v254
    v_mul_f32 v196, v56, v160
    v_fmac_f32 v196, v57, v161
    v_fmac_f32 v196, v58, v162
    v_fmac_f32 v196, v59, v163
    v_fmac_f32 v196, v60, v164
    v_fmac_f32 v196, v61, v165
    v_fmac_f32 v196, v62, v166
    v_fmac_f32 v196, v63, v167
    s_nop 1
    v_permlane32_swap_b32 v198, v196
    v_add_f32 v196, v198, v196
    v_mul_f32 v255, v16, v152
    v_fmac_f32 v255, v17, v153
    v_fmac_f32 v255, v18, v154
    v_fmac_f32 v255, v19, v155
    v_fmac_f32 v255, v20, v156
    v_fmac_f32 v255, v21, v157
    v_fmac_f32 v255, v22, v158
    v_fmac_f32 v255, v23, v159
    v_fma_f32 v203, v24, -v168, v203
    v_fma_f32 v203, v25, -v169, v203
    v_permlane32_swap_b32 v255, v201
    v_fma_f32 v203, v26, -v170, v203
    v_fma_f32 v203, v27, -v171, v203
    v_fma_f32 v203, v28, -v172, v203
    v_fma_f32 v203, v29, -v173, v203
    v_fma_f32 v203, v30, -v174, v203
    v_fma_f32 v203, v31, -v175, v203
    v_add_f32 v201, v255, v201
    v_fma_f32 v199, v48, -v120, v199
    v_permlane32_swap_b32 v203, v255
    v_fma_f32 v199, v49, -v121, v199
    v_fma_f32 v199, v50, -v122, v199
    v_fma_f32 v199, v51, -v123, v199
    s_waitcnt vmcnt(2)
    ds_read_b64_tr_b16 v[72:73], v249 offset:0
    ds_read_b64_tr_b16 v[76:77], v249 offset:64
    ds_read_b64_tr_b16 v[74:75], v249 offset:256
    ds_read_b64_tr_b16 v[78:79], v249 offset:320
    s_mov_b64 exec, s[54:55]
    ds_read_u16_d16_hi v242, v250 offset:0
    s_mov_b64 exec, -1
    v_fma_f32 v199, v52, -v124, v199
    v_fma_f32 v199, v53, -v125, v199
    v_fma_f32 v199, v54, -v126, v199
    v_fma_f32 v199, v55, -v127, v199
    v_add_f32 v255, v203, v255
    v_mul_f32 v197, v40, v168
    v_fmac_f32 v197, v41, v169
    v_fmac_f32 v197, v42, v170
    v_fmac_f32 v197, v43, v171
    v_fmac_f32 v197, v44, v172
    v_fmac_f32 v197, v45, v173
    v_fmac_f32 v197, v46, v174
    v_fmac_f32 v197, v47, v175
    s_nop 1
    v_permlane32_swap_b32 v199, v197
    v_add_f32 v197, v199, v197
    s_set_gpr_idx_on s51, gpr_idx(DST)
    s_nop 0
    v_cvt_pk_bf16_f32 v207, v200, v201
    v_cvt_pk_bf16_f32 v209, v254, v255
    v_cvt_pk_bf16_f32 v208, v196, v197
    s_set_gpr_idx_off
    s_add_u32 s50, s50, 1
    s_add_u32 s51, s51, 6
    s_cmp_ge_u32 s50, 4
    s_cbranch_scc1 LAST0
    s_add_u32 s53, s53, 4
    s_xor_b32 s66, s53, s20
    s_bitcmp1_b32 s66, 2
    s_setprio 1
    s_cbranch_scc1 PRIO_10
    s_setprio 0
PRIO_10:
    s_cmp_eq_u32 s52, 4
    s_cbranch_scc1 ITEM_0_4
    s_cmp_eq_u32 s52, 5
    s_cbranch_scc1 ITEM_0_5
    s_cmp_eq_u32 s52, 3
    s_cbranch_scc1 ITEM_0_3
    s_cmp_eq_u32 s52, 6
    s_cbranch_scc1 ITEM_0_6
    s_cmp_eq_u32 s52, 8
    s_cbranch_scc1 ITEM_0_8
    s_branch ITEM_0_2
.p2align 6
ITEM_1_4:
    s_mov_b64 exec, s[54:55]
    ds_read_u16_d16_hi v243, v250 offset:128
    s_mov_b64 exec, -1
    ds_read_b64_tr_b16 v[80:81], v249 offset:512
    ds_read_b64_tr_b16 v[84:85], v249 offset:576
    ds_read_b64_tr_b16 v[82:83], v249 offset:768
    ds_read_b64_tr_b16 v[86:87], v249 offset:832
    s_waitcnt lgkmcnt(5)
    v_mul_f32_dpp v196, v242, v72 row_newbcast:0 row_mask:0xf bank_mask:0xf
    v_mul_f32_dpp v197, v242, v73 row_newbcast:1 row_mask:0xf bank_mask:0xf
    v_mul_f32_dpp v198, v242, v72 row_newbcast:8 row_mask:0xf bank_mask:0xf
    v_mul_f32_dpp v199, v242, v73 row_newbcast:9 row_mask:0xf bank_mask:0xf
    v_mul_f32_dpp v200, v242, v76 row_newbcast:2 row_mask:0xf bank_mask:0xf
    v_mul_f32_dpp v201, v242, v77 row_newbcast:3 row_mask:0xf bank_mask:0xf
    v_mul_f32_dpp v202, v242, v76 row_newbcast:10 row_mask:0xf bank_mask:0xf
    v_mul_f32_dpp v203, v242, v77 row_newbcast:11 row_mask:0xf bank_mask:0xf
    v_cvt_pk_bf16_f32 v72, v196, v197
    v_cvt_pk_bf16_f32 v76, v198, v199
    v_cvt_pk_bf16_f32 v73, v200, v201
    v_cvt_pk_bf16_f32 v77, v202, v203
    v_mul_f32_dpp v196, v242, v74 row_newbcast:4 row_mask:0xf bank_mask:0xf
    v_mul_f32_dpp v197, v242, v75 row_newbcast:5 row_mask:0xf bank_mask:0xf
    v_mul_f32_dpp v198, v242, v74 row_newbcast:12 row_mask:0xf bank_mask:0xf
    v_mul_f32_dpp v199, v242, v75 row_newbcast:13 row_mask:0xf bank_mask:0xf
    v_mul_f32_dpp v200, v242, v78 row_newbcast:6 row_mask:0xf bank_mask:0xf
    v_mul_f32_dpp v201, v242, v79 row_newbcast:7 row_mask:0xf bank_mask:0xf
    v_mul_f32_dpp v202, v242, v78 row_newbcast:14 row_mask:0xf bank_mask:0xf
    v_mul_f32_dpp v203, v242, v79 row_newbcast:15 row_mask:0xf bank_mask:0xf
    v_cvt_pk_bf16_f32 v74, v196, v197
    v_cvt_pk_bf16_f32 v78, v198, v199
    v_cvt_pk_bf16_f32 v75, v200, v201
    v_cvt_pk_bf16_f32 v79, v202, v203
    s_waitcnt vmcnt(4) lgkmcnt(0)
    v_mfma_f32_32x32x16_bf16 v[0:15], v[72:75], v[176:179], 0
    v_mul_f32_dpp v196, v243, v80 row_newbcast:0 row_mask:0xf bank_mask:0xf
    v_mul_f32_dpp v197, v243, v81 row_newbcast:1 row_mask:0xf bank_mask:0xf
    v_mul_f32_dpp v198, v243, v80 row_newbcast:8 row_mask:0xf bank_mask:0xf
    v_mul_f32_dpp v199, v243, v81 row_newbcast:9 row_mask:0xf bank_mask:0xf
    v_mul_f32_dpp v200, v243, v84 row_newbcast:2 row_mask:0xf bank_mask:0xf
    v_mul_f32_dpp v201, v243, v85 row_newbcast:3 row_mask:0xf bank_mask:0xf
    s_add_u32 m0, s21, 0
    v_mfma_f32_32x32x16_bf16 v[48:63], v[76:79], v[176:179], 0
    buffer_load_dwordx4 v234, s[4:7], s36 offen  lds
    buffer_load_dwordx4 v235, s[8:11], s36 offen offset:1024  lds
    ds_read_b64_tr_b16 v[176:177], v244 offset:2048
    ds_read_b64_tr_b16 v[178:179], v244 offset:3072
    ds_read_b64_tr_b16 v[184:185], v245 offset:2048
    ds_read_b64_tr_b16 v[186:187], v245 offset:3072
    v_mul_f32_dpp v202, v243, v84 row_newbcast:10 row_mask:0xf bank_mask:0xf
    v_mul_f32_dpp v203, v243, v85 row_newbcast:11 row_mask:0xf bank_mask:0xf
    v_cvt_pk_bf16_f32 v80, v196, v197
    v_cvt_pk_bf16_f32 v84, v198, v199
    v_cvt_pk_bf16_f32 v81, v200, v201
    v_cvt_pk_bf16_f32 v85, v202, v203
    v_mul_f32_dpp v196, v243, v82 row_newbcast:4 row_mask:0xf bank_mask:0xf
    v_mul_f32_dpp v197, v243, v83 row_newbcast:5 row_mask:0xf bank_mask:0xf
    v_mul_f32_dpp v198, v243, v82 row_newbcast:12 row_mask:0xf bank_mask:0xf
    v_mul_f32_dpp v199, v243, v83 row_newbcast:13 row_mask:0xf bank_mask:0xf
    v_mul_f32_dpp v200, v243, v86 row_newbcast:6 row_mask:0xf bank_mask:0xf
    v_mul_f32_dpp v201, v243, v87 row_newbcast:7 row_mask:0xf bank_mask:0xf
    v_mul_f32_dpp v202, v243, v86 row_newbcast:14 row_mask:0xf bank_mask:0xf
    v_mul_f32_dpp v203, v243, v87 row_newbcast:15 row_mask:0xf bank_mask:0xf
    v_cvt_pk_bf16_f32 v82, v196, v197
    v_cvt_pk_bf16_f32 v86, v198, v199
    v_cvt_pk_bf16_f32 v83, v200, v201
    v_cvt_pk_bf16_f32 v87, v202, v203
    s_waitcnt lgkmcnt(0)
    v_mfma_f32_32x32x16_bf16 v[0:15], v[80:83], v[176:179], v[0:15]
    s_add_u32 m0, s21, 2048
    v_mfma_f32_32x32x16_bf16 v[48:63], v[84:87], v[176:179], v[48:63]
    buffer_load_dwordx4 v236, s[4:7], s36 offen  lds
    buffer_load_dwordx4 v237, s[8:11], s36 offen offset:1024  lds
    s_mov_b32 m0, s50
    s_nop 0
    s_movrels_b32 s71, s23
    s_movrels_b32 s33, s28
    v_add_u32 v253, s33, v248
    s_bfe_u32 s46, s71, 0x30012
    s_mov_b32 m0, s46
    s_and_b32 s66, s71, 0x3ffff
    s_movrels_b32 s68, s57
    s_movrels_b32 s69, s61
    s_sub_u32 s48, s66, s47
    s_mov_b32 s47, s66
    s_lshr_b32 s52, s71, 28
    s_lshl_b32 s67, s46, 9
    s_add_u32 s66, s66, s67
    s_sub_u32 s49, s66, s42
    s_mov_b32 s42, s66
    s_bfe_u32 s66, s68, 655360
    s_add_u32 s43, s42, s66
    s_bfe_u32 s39, s69, 655360
    s_bfe_u32 s66, s68, 655370
    s_add_u32 s44, s42, s66
    s_bfe_u32 s40, s69, 655370
    s_bfe_u32 s66, s68, 655380
    s_add_u32 s45, s42, s66
    s_bfe_u32 s41, s69, 655380
    v_add_u32 v252, s44, v247
    ds_read2_b32 v[238:239], v252 offset0:0 offset1:16
    v_add_u32 v252, s45, v247
    ds_read2_b32 v[240:241], v252 offset0:0 offset1:16
    v_mfma_f32_32x32x16_bf16 v[16:31], v[72:75], v[180:183], 0
    v_mul_f32 v196, v0, v96
    v_fmac_f32 v196, v1, v97
    v_fmac_f32 v196, v2, v98
    v_fmac_f32 v196, v3, v99
    v_fmac_f32 v196, v4, v100
    v_fmac_f32 v196, v5, v101
    v_mfma_f32_32x32x16_bf16 v[32:47], v[76:79], v[180:183], 0
    s_waitcnt vmcnt(6)
    ds_read_b64_tr_b16 v[176:177], v244 offset:4096
    ds_read_b64_tr_b16 v[178:179], v244 offset:5120
    ds_read_b64_tr_b16 v[180:181], v245 offset:4096
    ds_read_b64_tr_b16 v[182:183], v245 offset:5120
    v_fmac_f32 v196, v6, v102
    v_fmac_f32 v196, v7, v103
    v_mul_f32 v198, v8, v128
    v_fmac_f32 v198, v9, v129
    v_fmac_f32 v198, v10, v130
    v_fmac_f32 v198, v11, v131
    v_fmac_f32 v198, v12, v132
    v_fmac_f32 v198, v13, v133
    v_fmac_f32 v198, v14, v134
    v_fmac_f32 v198, v15, v135
    v_mul_f32 v200, v48, v128
    v_fmac_f32 v200, v49, v129
    v_permlane32_swap_b32 v196, v198
    v_fmac_f32 v200, v50, v130
    v_fmac_f32 v200, v51, v131
    v_fmac_f32 v200, v52, v132
    v_fmac_f32 v200, v53, v133
    v_fmac_f32 v200, v54, v134
    v_mfma_f32_32x32x16_bf16 v[16:31], v[80:83], v[184:187], v[16:31]
    v_fmac_f32 v200, v55, v135
    v_add_f32 v198, v196, v198
    v_mul_f32_e64 v202, v56, -v128
    v_fma_f32 v202, v57, -v129, v202
    v_fma_f32 v202, v58, -v130, v202
    v_fma_f32 v202, v59, -v131, v202
    v_mfma_f32_32x32x16_bf16 v[32:47], v[84:87], v[184:187], v[32:47]
    v_fma_f32 v202, v60, -v132, v202
    v_fma_f32 v202, v61, -v133, v202
    v_fma_f32 v202, v62, -v134, v202
    v_fma_f32 v202, v63, -v135, v202
    s_nop 1
    v_permlane32_swap_b32 v200, v202
    v_add_f32 v202, v200, v202
    s_waitcnt vmcnt(4) lgkmcnt(0)
    v_mfma_f32_32x32x16_bf16 v[0:15], v[72:75], v[176:179], 0
    v_mul_f32 v197, v16, v104
    v_fmac_f32 v197, v17, v105
    v_fmac_f32 v197, v18, v106
    v_fmac_f32 v197, v19, v107
    v_fmac_f32 v197, v20, v108
    v_fmac_f32 v197, v21, v109
    s_add_u32 m0, s21, 4096
    v_mfma_f32_32x32x16_bf16 v[48:63], v[76:79], v[176:179], 0
    buffer_load_dwordx4 v234, s[4:7], s37 offen  lds
    buffer_load_dwordx4 v235, s[8:11], s37 offen offset:1024  lds
    ds_read_b64_tr_b16 v[176:177], v244 offset:6144
    ds_read_b64_tr_b16 v[178:179], v244 offset:7168
    ds_read_b64_tr_b16 v[184:185], v245 offset:6144
    ds_read_b64_tr_b16 v[186:187], v245 offset:7168
    v_add_u32 v252, s42, v247
    ds_read2_b32 v[234:235], v252 offset0:0 offset1:16
    v_fmac_f32 v197, v22, v110
    v_fmac_f32 v197, v23, v111
    v_mul_f32 v199, v24, v136
    v_fmac_f32 v199, v25, v137
    v_fmac_f32 v199, v26, v138
    v_fmac_f32 v199, v27, v139
    v_fmac_f32 v199, v28, v140
    v_fmac_f32 v199, v29, v141
    v_fmac_f32 v199, v30, v142
    v_fmac_f32 v199, v31, v143
    v_mul_f32 v201, v32, v136
    v_fmac_f32 v201, v33, v137
    v_permlane32_swap_b32 v197, v199
    v_fmac_f32 v201, v34, v138
    v_fmac_f32 v201, v35, v139
    v_fmac_f32 v201, v36, v140
    v_fmac_f32 v201, v37, v141
    v_fmac_f32 v201, v38, v142
    v_fmac_f32 v201, v39, v143
    v_add_f32 v199, v197, v199
    v_mul_f32_e64 v203, v40, -v136
    v_fma_f32 v203, v41, -v137, v203
    v_fma_f32 v203, v42, -v138, v203
    v_fma_f32 v203, v43, -v139, v203
    s_waitcnt lgkmcnt(1)
    v_mfma_f32_32x32x16_bf16 v[0:15], v[80:83], v[176:179], v[0:15]
    v_fma_f32 v203, v44, -v140, v203
    v_fma_f32 v203, v45, -v141, v203
    v_fma_f32 v203, v46, -v142, v203
    v_fma_f32 v203, v47, -v143, v203
    s_nop 1
    v_permlane32_swap_b32 v201, v203
    v_add_f32 v203, v201, v203
    s_add_u32 m0, s21, 6144
    v_mfma_f32_32x32x16_bf16 v[48:63], v[84:87], v[176:179], v[48:63]
    buffer_load_dwordx4 v236, s[4:7], s37 offen  lds
    buffer_load_dwordx4 v237, s[8:11], s37 offen offset:1024  lds
    v_add_u32 v252, s43, v247
    ds_read2_b32 v[236:237], v252 offset0:0 offset1:16
    v_cvt_pk_bf16_f32 v192, v198, v199
    v_cvt_pk_bf16_f32 v193, v202, v203
    v_mfma_f32_32x32x16_bf16 v[16:31], v[72:75], v[180:183], 0
    v_mul_f32 v196, v0, v144
    v_fmac_f32 v196, v1, v145
    v_fmac_f32 v196, v2, v146
    v_fmac_f32 v196, v3, v147
    v_fmac_f32 v196, v4, v148
    v_fmac_f32 v196, v5, v149
    v_mfma_f32_32x32x16_bf16 v[32:47], v[76:79], v[180:183], 0
    s_waitcnt vmcnt(6)
    ds_read_b64_tr_b16 v[176:177], v244 offset:0
    ds_read_b64_tr_b16 v[178:179], v244 offset:1024
    ds_read_b64_tr_b16 v[180:181], v245 offset:0
    ds_read_b64_tr_b16 v[182:183], v245 offset:1024
    v_fmac_f32 v196, v6, v150
    v_fmac_f32 v196, v7, v151
    v_mul_f32 v198, v8, v112
    v_fmac_f32 v198, v9, v113
    v_fmac_f32 v198, v10, v114
    v_fmac_f32 v198, v11, v115
    v_fmac_f32 v198, v12, v116
    v_fmac_f32 v198, v13, v117
    v_fmac_f32 v198, v14, v118
    v_fmac_f32 v198, v15, v119
    v_mul_f32_e64 v200, v48, -v160
    v_fma_f32 v200, v49, -v161, v200
    v_fma_f32 v200, v50, -v162, v200
    v_fma_f32 v200, v51, -v163, v200
    v_mfma_f32_32x32x16_bf16 v[16:31], v[80:83], v[184:187], v[16:31]
    v_fma_f32 v200, v52, -v164, v200
    v_fma_f32 v200, v53, -v165, v200
    v_fma_f32 v200, v54, -v166, v200
    v_fma_f32 v200, v55, -v167, v200
    v_mul_f32_e64 v202, v56, -v160
    v_fma_f32 v202, v57, -v161, v202
    v_mfma_f32_32x32x16_bf16 v[32:47], v[84:87], v[184:187], v[32:47]
    v_fma_f32 v202, v58, -v162, v202
    v_fma_f32 v202, v59, -v163, v202
    v_fma_f32 v202, v60, -v164, v202
    v_fma_f32 v202, v61, -v165, v202
    v_fma_f32 v202, v62, -v166, v202
    v_fma_f32 v202, v63, -v167, v202
    s_waitcnt vmcnt(4) lgkmcnt(0)
    v_mfma_f32_32x32x16_bf16 v[0:15], v[72:75], v[176:179], 0
    v_mul_f32 v197, v16, v152
    v_fmac_f32 v197, v17, v153
    v_fmac_f32 v197, v18, v154
    v_fmac_f32 v197, v19, v155
    v_fmac_f32 v197, v20, v156
    v_fmac_f32 v197, v21, v157
    s_add_u32 m0, s21, 0
    v_mfma_f32_32x32x16_bf16 v[48:63], v[76:79], v[176:179], 0
    s_cbranch_vccnz WL_4_0
    v_mad_u32_u16 v234, v234, s3, v246 op_sel:[1,0,0,0]
    v_mad_u32_u16 v235, v235, s3, v246 op_sel:[1,0,0,0]
    buffer_load_dwordx4 v234, s[4:7], s38 offen  lds
    buffer_load_dwordx4 v235, s[8:11], s38 offen offset:1024  lds
WR_4_0:
    ds_read_b64_tr_b16 v[176:177], v244 offset:2048
    ds_read_b64_tr_b16 v[178:179], v244 offset:3072
    ds_read_b64_tr_b16 v[184:185], v245 offset:2048
    ds_read_b64_tr_b16 v[186:187], v245 offset:3072
    v_fmac_f32 v197, v22, v158
    v_fmac_f32 v197, v23, v159
    v_mul_f32 v199, v24, v120
    v_fmac_f32 v199, v25, v121
    v_fmac_f32 v199, v26, v122
    v_fmac_f32 v199, v27, v123
    v_fmac_f32 v199, v28, v124
    v_fmac_f32 v199, v29, v125
    v_fmac_f32 v199, v30, v126
    v_fmac_f32 v199, v31, v127
    v_mul_f32_e64 v201, v32, -v168
    v_fma_f32 v201, v33, -v169, v201
    v_fma_f32 v201, v34, -v170, v201
    v_fma_f32 v201, v35, -v171, v201
    v_fma_f32 v201, v36, -v172, v201
    v_fma_f32 v201, v37, -v173, v201
    v_fma_f32 v201, v38, -v174, v201
    v_fma_f32 v201, v39, -v175, v201
    s_waitcnt lgkmcnt(0)
    v_mfma_f32_32x32x16_bf16 v[0:15], v[80:83], v[176:179], v[0:15]
    v_mul_f32_e64 v203, v40, -v168
    v_fma_f32 v203, v41, -v169, v203
    v_fma_f32 v203, v42, -v170, v203
    v_fma_f32 v203, v43, -v171, v203
    v_fma_f32 v203, v44, -v172, v203
    v_fma_f32 v203, v45, -v173, v203
    s_add_u32 m0, s21, 2048
    v_mfma_f32_32x32x16_bf16 v[48:63], v[84:87], v[176:179], v[48:63]
    s_cbranch_vccnz WL_4_1
    v_mad_u32_u16 v236, v236, s3, v246 op_sel:[1,0,0,0]
    v_mad_u32_u16 v237, v237, s3, v246 op_sel:[1,0,0,0]
    buffer_load_dwordx4 v236, s[4:7], s39 offen  lds
    buffer_load_dwordx4 v237, s[8:11], s39 offen offset:1024  lds
WR_4_1:
    v_fma_f32 v203, v46, -v174, v203
    v_fma_f32 v203, v47, -v175, v203
    v_mfma_f32_32x32x16_bf16 v[16:31], v[72:75], v[180:183], 0
    v_mul_f32 v254, v0, v144
    v_fmac_f32 v254, v1, v145
    v_fmac_f32 v254, v2, v146
    v_fmac_f32 v254, v3, v147
    v_fmac_f32 v254, v4, v148
    v_fmac_f32 v254, v5, v149
    v_mfma_f32_32x32x16_bf16 v[32:47], v[76:79], v[180:183], 0
    s_waitcnt vmcnt(6)
    ds_read_b64_tr_b16 v[176:177], v244 offset:4096
    ds_read_b64_tr_b16 v[178:179], v244 offset:5120
    ds_read_b64_tr_b16 v[180:181], v245 offset:4096
    ds_read_b64_tr_b16 v[182:183], v245 offset:5120
    v_fmac_f32 v254, v6, v150
    v_fmac_f32 v254, v7, v151
    v_fmac_f32 v200, v8, v160
    v_fmac_f32 v200, v9, v161
    v_permlane32_swap_b32 v196, v254
    v_fmac_f32 v200, v10, v162
    v_fmac_f32 v200, v11, v163
    v_fmac_f32 v200, v12, v164
    v_mfma_f32_32x32x16_bf16 v[16:31], v[80:83], v[184:187], v[16:31]
    v_fmac_f32 v200, v13, v165
    v_fmac_f32 v200, v14, v166
    v_fmac_f32 v200, v15, v167
    v_add_f32 v254, v196, v254
    v_xor_b32 v64, 0x80000000, v48
    v_xor_b32 v65, 0x80000000, v49
    v_mfma_f32_32x32x16_bf16 v[32:47], v[84:87], v[184:187], v[32:47]
    v_xor_b32 v66, 0x80000000, v50
    v_xor_b32 v67, 0x80000000, v51
    v_xor_b32 v68, 0x80000000, v52
    v_xor_b32 v69, 0x80000000, v53
    v_xor_b32 v70, 0x80000000, v54
    v_xor_b32 v71, 0x80000000, v55
    s_waitcnt vmcnt(4) lgkmcnt(0)
    v_mfma_f32_32x32x16_bf16 v[0:15], v[72:75], v[176:179], 0
    v_mul_f32 v255, v16, v152
    v_fmac_f32 v255, v17, v153
    v_fmac_f32 v255, v18, v154
    v_fmac_f32 v255, v19, v155
    v_fmac_f32 v255, v20, v156
    v_fmac_f32 v255, v21, v157
    s_add_u32 m0, s21, 4096
    v_mfma_f32_32x32x16_bf16 v[56:71], v[76:79], v[176:179], v[56:71]
    s_cbranch_vccnz WL_4_2
    v_mad_u32_u16 v238, v238, s3, v246 op_sel:[1,0,0,0]
    v_mad_u32_u16 v239, v239, s3, v246 op_sel:[1,0,0,0]
    buffer_load_dwordx4 v238, s[4:7], s40 offen  lds
    buffer_load_dwordx4 v239, s[8:11], s40 offen offset:1024  lds
WR_4_2:
    ds_read_b64_tr_b16 v[176:177], v244 offset:6144
    ds_read_b64_tr_b16 v[178:179], v244 offset:7168
    ds_read_b64_tr_b16 v[184:185], v245 offset:6144
    ds_read_b64_tr_b16 v[186:187], v245 offset:7168
    v_fmac_f32 v255, v22, v158
    v_fmac_f32 v255, v23, v159
    v_fmac_f32 v201, v24, v168
    v_fmac_f32 v201, v25, v169
    v_permlane32_swap_b32 v197, v255
    v_fmac_f32 v201, v26, v170
    v_fmac_f32 v201, v27, v171
    v_fmac_f32 v201, v28, v172
    v_fmac_f32 v201, v29, v173
    v_fmac_f32 v201, v30, v174
    v_fmac_f32 v201, v31, v175
    v_add_f32 v255, v197, v255
    v_xor_b32 v48, 0x80000000, v32
    s_waitcnt lgkmcnt(0)
    v_mfma_f32_32x32x16_bf16 v[0:15], v[80:83], v[176:179], v[0:15]
    v_xor_b32 v49, 0x80000000, v33
    v_xor_b32 v50, 0x80000000, v34
    v_xor_b32 v51, 0x80000000, v35
    v_xor_b32 v52, 0x80000000, v36
    v_xor_b32 v53, 0x80000000, v37
    v_xor_b32 v54, 0x80000000, v38
    s_add_u32 m0, s21, 6144
    v_mfma_f32_32x32x16_bf16 v[56:71], v[84:87], v[176:179], v[56:71]
    s_cbranch_vccnz WL_4_3
    v_mad_u32_u16 v240, v240, s3, v246 op_sel:[1,0,0,0]
    v_mad_u32_u16 v241, v241, s3, v246 op_sel:[1,0,0,0]
    buffer_load_dwordx4 v240, s[4:7], s41 offen  lds
    buffer_load_dwordx4 v241, s[8:11], s41 offen offset:1024  lds
WR_4_3:
    v_xor_b32 v55, 0x80000000, v39
    v_cvt_pk_bf16_f32 v194, v254, v255
    v_mfma_f32_32x32x16_bf16 v[16:31], v[72:75], v[180:183], 0
    v_mul_f32 v254, v0, v144
    v_fmac_f32 v254, v1, v145
    v_fmac_f32 v254, v2, v146
    v_fmac_f32 v254, v3, v147
    v_fmac_f32 v254, v4, v148
    v_fmac_f32 v254, v5, v149
    v_mfma_f32_32x32x16_bf16 v[40:55], v[76:79], v[180:183], v[40:55]
    s_waitcnt vmcnt(6)
    ds_read_b64_tr_b16 v[176:177], v244 offset:0
    ds_read_b64_tr_b16 v[178:179], v244 offset:1024
    ds_read_b64_tr_b16 v[180:181], v245 offset:0
    ds_read_b64_tr_b16 v[182:183], v245 offset:1024
    v_fmac_f32 v254, v6, v150
    v_fmac_f32 v254, v7, v151
    v_fma_f32 v202, v8, -v160, v202
    v_fma_f32 v202, v9, -v161, v202
    v_permlane32_swap_b32 v254, v200
    v_fma_f32 v202, v10, -v162, v202
    v_fma_f32 v202, v11, -v163, v202
    v_fma_f32 v202, v12, -v164, v202
    v_fma_f32 v202, v13, -v165, v202
    v_fma_f32 v202, v14, -v166, v202
    v_fma_f32 v202, v15, -v167, v202
    v_add_f32 v200, v254, v200
    v_fma_f32 v198, v64, -v112, v198
    v_permlane32_swap_b32 v202, v254
    v_fma_f32 v198, v65, -v113, v198
    v_fma_f32 v198, v66, -v114, v198
    v_fma_f32 v198, v67, -v115, v198
    v_fma_f32 v198, v68, -v116, v198
    v_fma_f32 v198, v69, -v117, v198
    v_fma_f32 v198, v70, -v118, v198
    v_fma_f32 v198, v71, -v119, v198
    v_add_f32 v254, v202, v254
    v_mul_f32 v196, v56, v160
    v_fmac_f32 v196, v57, v161
    v_fmac_f32 v196, v58, v162
    v_fmac_f32 v196, v59, v163
    v_mfma_f32_32x32x16_bf16 v[16:31], v[80:83], v[184:187], v[16:31]
    v_fmac_f32 v196, v60, v164
    v_fmac_f32 v196, v61, v165
    v_fmac_f32 v196, v62, v166
    v_fmac_f32 v196, v63, v167
    s_nop 1
    v_permlane32_swap_b32 v198, v196
    v_add_f32 v196, v198, v196
    v_mfma_f32_32x32x16_bf16 v[40:55], v[84:87], v[184:187], v[40:55]
    v_add_u32 v249, s48, v249
    v_add_u32 v250, s49, v250
    ds_read_b32 v252, v251 offset:16
    ds_read_b64_tr_b16 v[72:73], v249 offset:0
    ds_read_b64_tr_b16 v[76:77], v249 offset:64
    ds_read_b64_tr_b16 v[74:75], v249 offset:256
    ds_read_b64_tr_b16 v[78:79], v249 offset:320
    s_mov_b64 exec, s[54:55]
    ds_read_u16_d16_hi v242, v250 offset:0
    s_mov_b64 exec, -1
    s_cbranch_vccnz LEPI_0
    v_mul_f32 v255, v16, v152
    v_fmac_f32 v255, v17, v153
    v_fmac_f32 v255, v18, v154
    v_fmac_f32 v255, v19, v155
    v_fmac_f32 v255, v20, v156
    v_fmac_f32 v255, v21, v157
    v_fmac_f32 v255, v22, v158
    v_fmac_f32 v255, v23, v159
    v_fma_f32 v203, v24, -v168, v203
    v_fma_f32 v203, v25, -v169, v203
    v_permlane32_swap_b32 v255, v201
    v_fma_f32 v203, v26, -v170, v203
    v_fma_f32 v203, v27, -v171, v203
    v_fma_f32 v203, v28, -v172, v203
    v_fma_f32 v203, v29, -v173, v203
    v_fma_f32 v203, v30, -v174, v203
    v_fma_f32 v203, v31, -v175, v203
    v_add_f32 v201, v255, v201
    v_fma_f32 v199, v48, -v120, v199
    v_permlane32_swap_b32 v203, v255
    v_fma_f32 v199, v49, -v121, v199
    v_fma_f32 v199, v50, -v122, v199
    v_fma_f32 v199, v51, -v123, v199
    v_fma_f32 v199, v52, -v124, v199
    v_fma_f32 v199, v53, -v125, v199
    v_fma_f32 v199, v54, -v126, v199
    v_fma_f32 v199, v55, -v127, v199
    v_add_f32 v255, v203, v255
    v_mul_f32 v197, v40, v168
    v_fmac_f32 v197, v41, v169
    v_fmac_f32 v197, v42, v170
    v_fmac_f32 v197, v43, v171
    v_fmac_f32 v197, v44, v172
    v_fmac_f32 v197, v45, v173
    v_fmac_f32 v197, v46, v174
    v_fmac_f32 v197, v47, v175
    s_nop 1
    v_permlane32_swap_b32 v199, v197
    v_add_f32 v197, v199, v197
    v_cvt_pk_bf16_f32 v200, v200, v201
    v_cvt_pk_bf16_f32 v254, v254, v255
    v_cvt_pk_bf16_f32 v196, v196, v197
    ds_write2st64_b32 v253, v192, v193 offset0:0 offset1:1
    ds_write2st64_b32 v253, v194, v200 offset0:2 offset1:3
    ds_write_b32 v253, v196 offset:1024
    s_mov_b64 exec, 0xffffffff
    ds_write_b32 v253, v254 offset:1280
    s_mov_b64 exec, -1
    s_add_u32 s50, s50, 1
    s_cmp_ge_u32 s50, 4
    s_cbranch_scc1 LAST1
    s_waitcnt lgkmcnt(9)
    v_readfirstlane_b32 s66, v252
    s_add_u32 s53, s53, 1
    v_mov_b32 v252, s53
    s_cmp_le_u32 s53, s66
    ds_write2_b32 v251, v252, v252 offset0:0 offset1:8
    s_setprio 1
    s_cbranch_scc1 PRIO_11
    s_setprio 0
PRIO_11:
    s_cmp_eq_u32 s52, 4
    s_cbranch_scc1 ITEM_1_4
    s_cmp_eq_u32 s52, 5
    s_cbranch_scc1 ITEM_1_5
    s_cmp_eq_u32 s52, 3
    s_cbranch_scc1 ITEM_1_3
    s_cmp_eq_u32 s52, 6
    s_cbranch_scc1 ITEM_1_6
    s_cmp_eq_u32 s52, 8
    s_cbranch_scc1 ITEM_1_8
    s_branch ITEM_1_2
WL_4_0:
    s_add_u32 s66, s51, 0
    buffer_load_dwordx4 v[96:99], v246, s[16:19], s66 offen offset:2048 sc1
    buffer_load_dwordx4 v[100:103], v246, s[16:19], s66 offen offset:3072 sc1
    s_branch WR_4_0
WL_4_1:
    s_add_u32 s66, s51, 4096
    buffer_load_dwordx4 v[104:107], v246, s[16:19], s66 offen offset:2048 sc1
    buffer_load_dwordx4 v[108:111], v246, s[16:19], s66 offen offset:3072 sc1
    s_branch WR_4_1
WL_4_2:
    s_add_u32 s66, s51, 8192
    buffer_load_dwordx4 v[128:131], v246, s[16:19], s66 offen offset:2048 sc1
    buffer_load_dwordx4 v[132:135], v246, s[16:19], s66 offen offset:3072 sc1
    s_branch WR_4_2
WL_4_3:
    s_add_u32 s66, s51, 12288
    buffer_load_dwordx4 v[136:139], v246, s[16:19], s66 offen offset:2048 sc1
    buffer_load_dwordx4 v[140:143], v246, s[16:19], s66 offen offset:3072 sc1
    s_branch WR_4_3
.p2align 6
ITEM_1_5:
    s_mov_b64 exec, s[54:55]
    ds_read_u16_d16_hi v243, v250 offset:128
    s_mov_b64 exec, -1
    ds_read_b64_tr_b16 v[80:81], v249 offset:512
    ds_read_b64_tr_b16 v[84:85], v249 offset:576
    ds_read_b64_tr_b16 v[82:83], v249 offset:768
    ds_read_b64_tr_b16 v[86:87], v249 offset:832
    ds_read_b64_tr_b16 v[88:89], v249 offset:1024
    ds_read_b64_tr_b16 v[92:93], v249 offset:1088
    s_waitcnt lgkmcnt(7)
    v_mul_f32_dpp v196, v242, v72 row_newbcast:0 row_mask:0xf bank_mask:0xf
    v_mul_f32_dpp v197, v242, v73 row_newbcast:1 row_mask:0xf bank_mask:0xf
    v_mul_f32_dpp v198, v242, v72 row_newbcast:8 row_mask:0xf bank_mask:0xf
    v_mul_f32_dpp v199, v242, v73 row_newbcast:9 row_mask:0xf bank_mask:0xf
    v_mul_f32_dpp v200, v242, v76 row_newbcast:2 row_mask:0xf bank_mask:0xf
    v_mul_f32_dpp v201, v242, v77 row_newbcast:3 row_mask:0xf bank_mask:0xf
    v_mul_f32_dpp v202, v242, v76 row_newbcast:10 row_mask:0xf bank_mask:0xf
    v_mul_f32_dpp v203, v242, v77 row_newbcast:11 row_mask:0xf bank_mask:0xf
    v_cvt_pk_bf16_f32 v72, v196, v197
    v_cvt_pk_bf16_f32 v76, v198, v199
    v_cvt_pk_bf16_f32 v73, v200, v201
    v_cvt_pk_bf16_f32 v77, v202, v203
    v_mul_f32_dpp v196, v242, v74 row_newbcast:4 row_mask:0xf bank_mask:0xf
    v_mul_f32_dpp v197, v242, v75 row_newbcast:5 row_mask:0xf bank_mask:0xf
    v_mul_f32_dpp v198, v242, v74 row_newbcast:12 row_mask:0xf bank_mask:0xf
    v_mul_f32_dpp v199, v242, v75 row_newbcast:13 row_mask:0xf bank_mask:0xf
    v_mul_f32_dpp v200, v242, v78 row_newbcast:6 row_mask:0xf bank_mask:0xf
    v_mul_f32_dpp v201, v242, v79 row_newbcast:7 row_mask:0xf bank_mask:0xf
    v_mul_f32_dpp v202, v242, v78 row_newbcast:14 row_mask:0xf bank_mask:0xf
    v_mul_f32_dpp v203, v242, v79 row_newbcast:15 row_mask:0xf bank_mask:0xf
    v_cvt_pk_bf16_f32 v74, v196, v197
    v_cvt_pk_bf16_f32 v78, v198, v199
    v_cvt_pk_bf16_f32 v75, v200, v201
    v_cvt_pk_bf16_f32 v79, v202, v203
    s_mov_b64 exec, s[54:55]
    ds_read_u16_d16_hi v242, v250 offset:256
    s_mov_b64 exec, -1
    s_waitcnt vmcnt(4) lgkmcnt(3)
    v_mfma_f32_32x32x16_bf16 v[0:15], v[72:75], v[176:179], 0
    v_mul_f32_dpp v196, v243, v80 row_newbcast:0 row_mask:0xf bank_mask:0xf
    v_mul_f32_dpp v197, v243, v81 row_newbcast:1 row_mask:0xf bank_mask:0xf
    v_mul_f32_dpp v198, v243, v80 row_newbcast:8 row_mask:0xf bank_mask:0xf
    v_mul_f32_dpp v199, v243, v81 row_newbcast:9 row_mask:0xf bank_mask:0xf
    v_mul_f32_dpp v200, v243, v84 row_newbcast:2 row_mask:0xf bank_mask:0xf
    v_mul_f32_dpp v201, v243, v85 row_newbcast:3 row_mask:0xf bank_mask:0xf
    s_add_u32 m0, s21, 0
    v_mfma_f32_32x32x16_bf16 v[48:63], v[76:79], v[176:179], 0
    buffer_load_dwordx4 v236, s[4:7], s35 offen  lds
    buffer_load_dwordx4 v237, s[8:11], s35 offen offset:1024  lds
    ds_read_b64_tr_b16 v[176:177], v244 offset:2048
    ds_read_b64_tr_b16 v[178:179], v244 offset:3072
    ds_read_b64_tr_b16 v[184:185], v245 offset:2048
    ds_read_b64_tr_b16 v[186:187], v245 offset:3072
    v_mul_f32_dpp v202, v243, v84 row_newbcast:10 row_mask:0xf bank_mask:0xf
    v_mul_f32_dpp v203, v243, v85 row_newbcast:11 row_mask:0xf bank_mask:0xf
    v_cvt_pk_bf16_f32 v80, v196, v197
    v_cvt_pk_bf16_f32 v84, v198, v199
    v_cvt_pk_bf16_f32 v81, v200, v201
    v_cvt_pk_bf16_f32 v85, v202, v203
    v_mul_f32_dpp v196, v243, v82 row_newbcast:4 row_mask:0xf bank_mask:0xf
    v_mul_f32_dpp v197, v243, v83 row_newbcast:5 row_mask:0xf bank_mask:0xf
    v_mul_f32_dpp v198, v243, v82 row_newbcast:12 row_mask:0xf bank_mask:0xf
    v_mul_f32_dpp v199, v243, v83 row_newbcast:13 row_mask:0xf bank_mask:0xf
    v_mul_f32_dpp v200, v243, v86 row_newbcast:6 row_mask:0xf bank_mask:0xf
    v_mul_f32_dpp v201, v243, v87 row_newbcast:7 row_mask:0xf bank_mask:0xf
    v_mul_f32_dpp v202, v243, v86 row_newbcast:14 row_mask:0xf bank_mask:0xf
    v_mul_f32_dpp v203, v243, v87 row_newbcast:15 row_mask:0xf bank_mask:0xf
    v_cvt_pk_bf16_f32 v82, v196, v197
    v_cvt_pk_bf16_f32 v86, v198, v199
    v_cvt_pk_bf16_f32 v83, v200, v201
    v_cvt_pk_bf16_f32 v87, v202, v203
    s_waitcnt vmcnt(4) lgkmcnt(0)
    v_mfma_f32_32x32x16_bf16 v[0:15], v[80:83], v[176:179], v[0:15]
    v_mul_f32_dpp v196, v242, v88 row_newbcast:0 row_mask:0xf bank_mask:0xf
    v_mul_f32_dpp v197, v242, v89 row_newbcast:1 row_mask:0xf bank_mask:0xf
    v_mul_f32_dpp v198, v242, v88 row_newbcast:8 row_mask:0xf bank_mask:0xf
    v_mul_f32_dpp v199, v242, v89 row_newbcast:9 row_mask:0xf bank_mask:0xf
    v_mul_f32_dpp v200, v242, v92 row_newbcast:2 row_mask:0xf bank_mask:0xf
    v_mul_f32_dpp v201, v242, v93 row_newbcast:3 row_mask:0xf bank_mask:0xf
    s_add_u32 m0, s21, 2048
    v_mfma_f32_32x32x16_bf16 v[48:63], v[84:87], v[176:179], v[48:63]
    buffer_load_dwordx4 v238, s[4:7], s35 offen  lds
    ds_read_b64_tr_b16 v[176:177], v244 offset:4096
    ds_read_b64_tr_b16 v[188:189], v245 offset:4096
    v_mul_f32_dpp v202, v242, v92 row_newbcast:10 row_mask:0xf bank_mask:0xf
    v_mul_f32_dpp v203, v242, v93 row_newbcast:11 row_mask:0xf bank_mask:0xf
    v_cvt_pk_bf16_f32 v88, v196, v197
    v_cvt_pk_bf16_f32 v92, v198, v199
    v_cvt_pk_bf16_f32 v89, v200, v201
    v_cvt_pk_bf16_f32 v93, v202, v203
    s_waitcnt lgkmcnt(0)
    v_mfma_f32_32x32x8_bf16 v[0:15], v[88:89], v[176:177], v[0:15]
    s_add_u32 m0, s21, 4096
    v_mfma_f32_32x32x8_bf16 v[48:63], v[92:93], v[176:177], v[48:63]
    buffer_load_dwordx4 v234, s[4:7], s36 offen  lds
    buffer_load_dwordx4 v235, s[8:11], s36 offen offset:1024  lds
    s_mov_b32 m0, s50
    s_nop 0
    s_movrels_b32 s71, s23
    s_movrels_b32 s33, s28
    v_add_u32 v253, s33, v248
    s_bfe_u32 s46, s71, 0x30012
    s_mov_b32 m0, s46
    s_and_b32 s66, s71, 0x3ffff
    s_movrels_b32 s68, s57
    s_movrels_b32 s69, s61
    s_sub_u32 s48, s66, s47
    s_mov_b32 s47, s66
    s_lshr_b32 s52, s71, 28
    s_lshl_b32 s67, s46, 9
    s_add_u32 s66, s66, s67
    s_sub_u32 s49, s66, s42
    s_mov_b32 s42, s66
    s_bfe_u32 s66, s68, 655360
    s_add_u32 s43, s42, s66
    s_bfe_u32 s39, s69, 655360
    s_bfe_u32 s66, s68, 655370
    s_add_u32 s44, s42, s66
    s_bfe_u32 s40, s69, 655370
    s_bfe_u32 s66, s68, 655380
    s_add_u32 s45, s42, s66
    s_bfe_u32 s41, s69, 655380
    v_add_u32 v252, s45, v247
    ds_read2_b32 v[240:241], v252 offset0:0 offset1:16
    v_mfma_f32_32x32x16_bf16 v[16:31], v[72:75], v[180:183], 0
    v_mul_f32 v196, v0, v96
    v_fmac_f32 v196, v1, v97
    v_fmac_f32 v196, v2, v98
    v_fmac_f32 v196, v3, v99
    v_fmac_f32 v196, v4, v100
    v_fmac_f32 v196, v5, v101
    v_mfma_f32_32x32x16_bf16 v[32:47], v[76:79], v[180:183], 0
    v_fmac_f32 v196, v6, v102
    v_fmac_f32 v196, v7, v103
    v_mul_f32 v198, v8, v128
    v_fmac_f32 v198, v9, v129
    v_fmac_f32 v198, v10, v130
    v_fmac_f32 v198, v11, v131
    v_fmac_f32 v198, v12, v132
    v_fmac_f32 v198, v13, v133
    v_fmac_f32 v198, v14, v134
    v_fmac_f32 v198, v15, v135
    v_mfma_f32_32x32x16_bf16 v[16:31], v[80:83], v[184:187], v[16:31]
    v_mul_f32 v200, v48, v128
    v_fmac_f32 v200, v49, v129
    v_permlane32_swap_b32 v196, v198
    v_fmac_f32 v200, v50, v130
    v_fmac_f32 v200, v51, v131
    v_fmac_f32 v200, v52, v132
    v_mfma_f32_32x32x16_bf16 v[32:47], v[84:87], v[184:187], v[32:47]
    s_waitcnt vmcnt(5)
    ds_read_b64_tr_b16 v[176:177], v244 offset:6144
    ds_read_b64_tr_b16 v[178:179], v244 offset:7168
    ds_read_b64_tr_b16 v[180:181], v245 offset:6144
    ds_read_b64_tr_b16 v[182:183], v245 offset:7168
    v_fmac_f32 v200, v53, v133
    v_fmac_f32 v200, v54, v134
    v_mfma_f32_32x32x8_bf16 v[16:31], v[88:89], v[188:189], v[16:31]
    v_fmac_f32 v200, v55, v135
    v_add_f32 v198, v196, v198
    v_mul_f32_e64 v202, v56, -v128
    v_fma_f32 v202, v57, -v129, v202
    v_fma_f32 v202, v58, -v130, v202
    v_fma_f32 v202, v59, -v131, v202
    v_mfma_f32_32x32x8_bf16 v[32:47], v[92:93], v[188:189], v[32:47]
    v_fma_f32 v202, v60, -v132, v202
    v_fma_f32 v202, v61, -v133, v202
    v_fma_f32 v202, v62, -v134, v202
    v_fma_f32 v202, v63, -v135, v202
    s_nop 1
    v_permlane32_swap_b32 v200, v202
    v_add_f32 v202, v200, v202
    s_waitcnt vmcnt(3) lgkmcnt(0)
    v_mfma_f32_32x32x16_bf16 v[0:15], v[72:75], v[176:179], 0
    v_mul_f32 v197, v16, v104
    v_fmac_f32 v197, v17, v105
    v_fmac_f32 v197, v18, v106
    v_fmac_f32 v197, v19, v107
    v_fmac_f32 v197, v20, v108
    v_fmac_f32 v197, v21, v109
    s_add_u32 m0, s21, 6144
    v_mfma_f32_32x32x16_bf16 v[48:63], v[76:79], v[176:179], 0
    buffer_load_dwordx4 v236, s[4:7], s36 offen  lds
    buffer_load_dwordx4 v237, s[8:11], s36 offen offset:1024  lds
    ds_read_b64_tr_b16 v[176:177], v244 offset:0
    ds_read_b64_tr_b16 v[178:179], v244 offset:1024
    ds_read_b64_tr_b16 v[184:185], v245 offset:0
    ds_read_b64_tr_b16 v[186:187], v245 offset:1024
    v_fmac_f32 v197, v22, v110
    v_fmac_f32 v197, v23, v111
    v_mul_f32 v199, v24, v136
    v_fmac_f32 v199, v25, v137
    v_fmac_f32 v199, v26, v138
    v_fmac_f32 v199, v27, v139
    v_fmac_f32 v199, v28, v140
    v_fmac_f32 v199, v29, v141
    v_fmac_f32 v199, v30, v142
    v_fmac_f32 v199, v31, v143
    v_mul_f32 v201, v32, v136
    v_fmac_f32 v201, v33, v137
    v_permlane32_swap_b32 v197, v199
    v_fmac_f32 v201, v34, v138
    v_fmac_f32 v201, v35, v139
    s_waitcnt vmcnt(4) lgkmcnt(0)
    v_mfma_f32_32x32x16_bf16 v[0:15], v[80:83], v[176:179], v[0:15]
    v_fmac_f32 v201, v36, v140
    v_fmac_f32 v201, v37, v141
    v_fmac_f32 v201, v38, v142
    v_fmac_f32 v201, v39, v143
    v_add_f32 v199, v197, v199
    v_mul_f32_e64 v203, v40, -v136
    s_add_u32 m0, s21, 0
    v_mfma_f32_32x32x16_bf16 v[48:63], v[84:87], v[176:179], v[48:63]
    buffer_load_dwordx4 v238, s[4:7], s36 offen  lds
    ds_read_b64_tr_b16 v[176:177], v244 offset:2048
    ds_read_b64_tr_b16 v[188:189], v245 offset:2048
    v_fma_f32 v203, v41, -v137, v203
    v_fma_f32 v203, v42, -v138, v203
    v_fma_f32 v203, v43, -v139, v203
    s_waitcnt lgkmcnt(0)
    v_mfma_f32_32x32x8_bf16 v[0:15], v[88:89], v[176:177], v[0:15]
    v_fma_f32 v203, v44, -v140, v203
    v_fma_f32 v203, v45, -v141, v203
    v_fma_f32 v203, v46, -v142, v203
    v_fma_f32 v203, v47, -v143, v203
    s_nop 1
    v_permlane32_swap_b32 v201, v203
    v_add_f32 v203, v201, v203
    s_add_u32 m0, s21, 2048
    v_mfma_f32_32x32x8_bf16 v[48:63], v[92:93], v[176:177], v[48:63]
    buffer_load_dwordx4 v234, s[4:7], s37 offen  lds
    buffer_load_dwordx4 v235, s[8:11], s37 offen offset:1024  lds
    v_add_u32 v252, s42, v247
    ds_read2_b32 v[234:235], v252 offset0:0 offset1:16
    v_cvt_pk_bf16_f32 v192, v198, v199
    v_cvt_pk_bf16_f32 v193, v202, v203
    v_mfma_f32_32x32x16_bf16 v[16:31], v[72:75], v[180:183], 0
    v_mul_f32 v196, v0, v144
    v_fmac_f32 v196, v1, v145
    v_fmac_f32 v196, v2, v146
    v_fmac_f32 v196, v3, v147
    v_fmac_f32 v196, v4, v148
    v_fmac_f32 v196, v5, v149
    v_mfma_f32_32x32x16_bf16 v[32:47], v[76:79], v[180:183], 0
    v_fmac_f32 v196, v6, v150
    v_fmac_f32 v196, v7, v151
    v_mul_f32 v198, v8, v112
    v_fmac_f32 v198, v9, v113
    v_fmac_f32 v198, v10, v114
    v_fmac_f32 v198, v11, v115
    v_mfma_f32_32x32x16_bf16 v[16:31], v[80:83], v[184:187], v[16:31]
    v_fmac_f32 v198, v12, v116
    v_fmac_f32 v198, v13, v117
    v_fmac_f32 v198, v14, v118
    v_fmac_f32 v198, v15, v119
    v_mul_f32_e64 v200, v48, -v160
    v_fma_f32 v200, v49, -v161, v200
    v_mfma_f32_32x32x16_bf16 v[32:47], v[84:87], v[184:187], v[32:47]
    s_waitcnt vmcnt(5)
    ds_read_b64_tr_b16 v[176:177], v244 offset:4096
    ds_read_b64_tr_b16 v[178:179], v244 offset:5120
    ds_read_b64_tr_b16 v[180:181], v245 offset:4096
    ds_read_b64_tr_b16 v[182:183], v245 offset:5120
    v_fma_f32 v200, v50, -v162, v200
    v_fma_f32 v200, v51, -v163, v200
    v_mfma_f32_32x32x8_bf16 v[16:31], v[88:89], v[188:189], v[16:31]
    v_fma_f32 v200, v52, -v164, v200
    v_fma_f32 v200, v53, -v165, v200
    v_fma_f32 v200, v54, -v166, v200
    v_fma_f32 v200, v55, -v167, v200
    v_mul_f32_e64 v202, v56, -v160
    v_fma_f32 v202, v57, -v161, v202
    v_mfma_f32_32x32x8_bf16 v[32:47], v[92:93], v[188:189], v[32:47]
    v_fma_f32 v202, v58, -v162, v202
    v_fma_f32 v202, v59, -v163, v202
    v_fma_f32 v202, v60, -v164, v202
    v_fma_f32 v202, v61, -v165, v202
    v_fma_f32 v202, v62, -v166, v202
    v_fma_f32 v202, v63, -v167, v202
    s_waitcnt vmcnt(3) lgkmcnt(0)
    v_mfma_f32_32x32x16_bf16 v[0:15], v[72:75], v[176:179], 0
    v_mul_f32 v197, v16, v152
    v_fmac_f32 v197, v17, v153
    v_fmac_f32 v197, v18, v154
    v_fmac_f32 v197, v19, v155
    v_fmac_f32 v197, v20, v156
    v_fmac_f32 v197, v21, v157
    s_add_u32 m0, s21, 4096
    v_mfma_f32_32x32x16_bf16 v[48:63], v[76:79], v[176:179], 0
    buffer_load_dwordx4 v236, s[4:7], s37 offen  lds
    buffer_load_dwordx4 v237, s[8:11], s37 offen offset:1024  lds
    ds_read_b64_tr_b16 v[176:177], v244 offset:6144
    ds_read_b64_tr_b16 v[178:179], v244 offset:7168
    ds_read_b64_tr_b16 v[184:185], v245 offset:6144
    ds_read_b64_tr_b16 v[186:187], v245 offset:7168
    v_add_u32 v252, s43, v247
    ds_read2_b32 v[236:237], v252 offset0:0 offset1:16
    v_fmac_f32 v197, v22, v158
    v_fmac_f32 v197, v23, v159
    v_mul_f32 v199, v24, v120
    v_fmac_f32 v199, v25, v121
    v_fmac_f32 v199, v26, v122
    v_fmac_f32 v199, v27, v123
    v_fmac_f32 v199, v28, v124
    v_fmac_f32 v199, v29, v125
    v_fmac_f32 v199, v30, v126
    v_fmac_f32 v199, v31, v127
    v_mul_f32_e64 v201, v32, -v168
    s_waitcnt vmcnt(4) lgkmcnt(1)
    v_mfma_f32_32x32x16_bf16 v[0:15], v[80:83], v[176:179], v[0:15]
    v_fma_f32 v201, v33, -v169, v201
    v_fma_f32 v201, v34, -v170, v201
    v_fma_f32 v201, v35, -v171, v201
    v_fma_f32 v201, v36, -v172, v201
    v_fma_f32 v201, v37, -v173, v201
    v_fma_f32 v201, v38, -v174, v201
    s_add_u32 m0, s21, 6144
    v_mfma_f32_32x32x16_bf16 v[48:63], v[84:87], v[176:179], v[48:63]
    buffer_load_dwordx4 v238, s[4:7], s37 offen  lds
    ds_read_b64_tr_b16 v[176:177], v244 offset:0
    ds_read_b64_tr_b16 v[188:189], v245 offset:0
    v_add_u32 v252, s44, v247
    ds_read2_b32 v[238:239], v252 offset0:0 offset1:16
    v_fma_f32 v201, v39, -v175, v201
    s_waitcnt lgkmcnt(1)
    v_mfma_f32_32x32x8_bf16 v[0:15], v[88:89], v[176:177], v[0:15]
    v_mul_f32_e64 v203, v40, -v168
    v_fma_f32 v203, v41, -v169, v203
    v_fma_f32 v203, v42, -v170, v203
    v_fma_f32 v203, v43, -v171, v203
    v_fma_f32 v203, v44, -v172, v203
    v_fma_f32 v203, v45, -v173, v203
    s_add_u32 m0, s21, 0
    v_mfma_f32_32x32x8_bf16 v[48:63], v[92:93], v[176:177], v[48:63]
    s_cbranch_vccnz WL_5_0
    v_mad_u32_u16 v234, v234, s3, v246 op_sel:[1,0,0,0]
    v_mad_u32_u16 v235, v235, s3, v246 op_sel:[1,0,0,0]
    buffer_load_dwordx4 v234, s[4:7], s38 offen  lds
    buffer_load_dwordx4 v235, s[8:11], s38 offen offset:1024  lds
WR_5_0:
    v_fma_f32 v203, v46, -v174, v203
    v_fma_f32 v203, v47, -v175, v203
    v_mfma_f32_32x32x16_bf16 v[16:31], v[72:75], v[180:183], 0
    v_mul_f32 v254, v0, v144
    v_fmac_f32 v254, v1, v145
    v_fmac_f32 v254, v2, v146
    v_fmac_f32 v254, v3, v147
    v_fmac_f32 v254, v4, v148
    v_fmac_f32 v254, v5, v149
    v_mfma_f32_32x32x16_bf16 v[32:47], v[76:79], v[180:183], 0
    v_mfma_f32_32x32x16_bf16 v[16:31], v[80:83], v[184:187], v[16:31]
    v_fmac_f32 v254, v6, v150
    v_fmac_f32 v254, v7, v151
    v_fmac_f32 v200, v8, v160
    v_fmac_f32 v200, v9, v161
    v_permlane32_swap_b32 v196, v254
    v_fmac_f32 v200, v10, v162
    v_mfma_f32_32x32x16_bf16 v[32:47], v[84:87], v[184:187], v[32:47]
    s_waitcnt vmcnt(5)
    ds_read_b64_tr_b16 v[176:177], v244 offset:2048
    ds_read_b64_tr_b16 v[178:179], v244 offset:3072
    ds_read_b64_tr_b16 v[180:181], v245 offset:2048
    ds_read_b64_tr_b16 v[182:183], v245 offset:3072
    v_fmac_f32 v200, v11, v163
    v_fmac_f32 v200, v12, v164
    v_mfma_f32_32x32x8_bf16 v[16:31], v[88:89], v[188:189], v[16:31]
    v_fmac_f32 v200, v13, v165
    v_fmac_f32 v200, v14, v166
    v_fmac_f32 v200, v15, v167
    v_add_f32 v254, v196, v254
    v_xor_b32 v64, 0x80000000, v48
    v_xor_b32 v65, 0x80000000, v49
    v_mfma_f32_32x32x8_bf16 v[32:47], v[92:93], v[188:189], v[32:47]
    v_xor_b32 v66, 0x80000000, v50
    v_xor_b32 v67, 0x80000000, v51
    v_xor_b32 v68, 0x80000000, v52
    v_xor_b32 v69, 0x80000000, v53
    v_xor_b32 v70, 0x80000000, v54
    v_xor_b32 v71, 0x80000000, v55
    s_waitcnt vmcnt(3) lgkmcnt(0)
    v_mfma_f32_32x32x16_bf16 v[0:15], v[72:75], v[176:179], 0
    v_mul_f32 v255, v16, v152
    v_fmac_f32 v255, v17, v153
    v_fmac_f32 v255, v18, v154
    v_fmac_f32 v255, v19, v155
    v_fmac_f32 v255, v20, v156
    v_fmac_f32 v255, v21, v157
    s_add_u32 m0, s21, 2048
    v_mfma_f32_32x32x16_bf16 v[56:71], v[76:79], v[176:179], v[56:71]
    s_cbranch_vccnz WL_5_1
    v_mad_u32_u16 v236, v236, s3, v246 op_sel:[1,0,0,0]
    v_mad_u32_u16 v237, v237, s3, v246 op_sel:[1,0,0,0]
    buffer_load_dwordx4 v236, s[4:7], s39 offen  lds
    buffer_load_dwordx4 v237, s[8:11], s39 offen offset:1024  lds
WR_5_1:
    ds_read_b64_tr_b16 v[176:177], v244 offset:4096
    ds_read_b64_tr_b16 v[178:179], v244 offset:5120
    ds_read_b64_tr_b16 v[184:185], v245 offset:4096
    ds_read_b64_tr_b16 v[186:187], v245 offset:5120
    v_fmac_f32 v255, v22, v158
    v_fmac_f32 v255, v23, v159
    v_fmac_f32 v201, v24, v168
    v_fmac_f32 v201, v25, v169
    v_permlane32_swap_b32 v197, v255
    v_fmac_f32 v201, v26, v170
    v_fmac_f32 v201, v27, v171
    s_waitcnt vmcnt(4) lgkmcnt(0)
    v_mfma_f32_32x32x16_bf16 v[0:15], v[80:83], v[176:179], v[0:15]
    v_fmac_f32 v201, v28, v172
    v_fmac_f32 v201, v29, v173
    v_fmac_f32 v201, v30, v174
    v_fmac_f32 v201, v31, v175
    v_add_f32 v255, v197, v255
    v_xor_b32 v48, 0x80000000, v32
    s_add_u32 m0, s21, 4096
    v_mfma_f32_32x32x16_bf16 v[56:71], v[84:87], v[176:179], v[56:71]
    s_cbranch_vccnz WL_5_2
    v_mad_u32_u16 v238, v238, s3, v246 op_sel:[1,0,0,0]
    v_mad_u32_u16 v239, v239, s3, v246 op_sel:[1,0,0,0]
    buffer_load_dwordx4 v238, s[4:7], s40 offen  lds
    buffer_load_dwordx4 v239, s[8:11], s40 offen offset:1024  lds
WR_5_2:
    ds_read_b64_tr_b16 v[176:177], v244 offset:6144
    ds_read_b64_tr_b16 v[188:189], v245 offset:6144
    s_waitcnt lgkmcnt(0)
    v_mfma_f32_32x32x8_bf16 v[0:15], v[88:89], v[176:177], v[0:15]
    v_xor_b32 v49, 0x80000000, v33
    v_xor_b32 v50, 0x80000000, v34
    v_xor_b32 v51, 0x80000000, v35
    v_xor_b32 v52, 0x80000000, v36
    v_xor_b32 v53, 0x80000000, v37
    v_xor_b32 v54, 0x80000000, v38
    s_add_u32 m0, s21, 6144
    v_mfma_f32_32x32x8_bf16 v[56:71], v[92:93], v[176:177], v[56:71]
    s_cbranch_vccnz WL_5_3
    v_mad_u32_u16 v240, v240, s3, v246 op_sel:[1,0,0,0]
    v_mad_u32_u16 v241, v241, s3, v246 op_sel:[1,0,0,0]
    buffer_load_dwordx4 v240, s[4:7], s41 offen  lds
    buffer_load_dwordx4 v241, s[8:11], s41 offen offset:1024  lds
WR_5_3:
    v_xor_b32 v55, 0x80000000, v39
    v_cvt_pk_bf16_f32 v194, v254, v255
    v_mfma_f32_32x32x16_bf16 v[16:31], v[72:75], v[180:183], 0
    v_mul_f32 v254, v0, v144
    v_fmac_f32 v254, v1, v145
    v_fmac_f32 v254, v2, v146
    v_fmac_f32 v254, v3, v147
    v_fmac_f32 v254, v4, v148
    v_fmac_f32 v254, v5, v149
    v_mfma_f32_32x32x16_bf16 v[40:55], v[76:79], v[180:183], v[40:55]
    v_fmac_f32 v254, v6, v150
    v_fmac_f32 v254, v7, v151
    v_fma_f32 v202, v8, -v160, v202
    v_fma_f32 v202, v9, -v161, v202
    v_permlane32_swap_b32 v254, v200
    v_fma_f32 v202, v10, -v162, v202
    v_fma_f32 v202, v11, -v163, v202
    v_fma_f32 v202, v12, -v164, v202
    v_fma_f32 v202, v13, -v165, v202
    v_fma_f32 v202, v14, -v166, v202
    v_fma_f32 v202, v15, -v167, v202
    v_add_f32 v200, v254, v200
    v_fma_f32 v198, v64, -v112, v198
    v_permlane32_swap_b32 v202, v254
    v_fma_f32 v198, v65, -v113, v198
    v_fma_f32 v198, v66, -v114, v198
    v_fma_f32 v198, v67, -v115, v198
    v_fma_f32 v198, v68, -v116, v198
    v_mfma_f32_32x32x16_bf16 v[16:31], v[80:83], v[184:187], v[16:31]
    v_fma_f32 v198, v69, -v117, v198
    v_fma_f32 v198, v70, -v118, v198
    v_fma_f32 v198, v71, -v119, v198
    v_add_f32 v254, v202, v254
    v_mul_f32 v196, v56, v160
    v_fmac_f32 v196, v57, v161
    v_mfma_f32_32x32x16_bf16 v[40:55], v[84:87], v[184:187], v[40:55]
    s_waitcnt vmcnt(6)
    ds_read_b64_tr_b16 v[176:177], v244 offset:0
    ds_read_b64_tr_b16 v[178:179], v244 offset:1024
    ds_read_b64_tr_b16 v[180:181], v245 offset:0
    ds_read_b64_tr_b16 v[182:183], v245 offset:1024
    v_fmac_f32 v196, v58, v162
    v_fmac_f32 v196, v59, v163
    v_mfma_f32_32x32x8_bf16 v[16:31], v[88:89], v[188:189], v[16:31]
    v_fmac_f32 v196, v60, v164
    v_fmac_f32 v196, v61, v165
    v_fmac_f32 v196, v62, v166
    v_fmac_f32 v196, v63, v167
    s_nop 1
    v_permlane32_swap_b32 v198, v196
    v_add_f32 v196, v198, v196
    v_mfma_f32_32x32x8_bf16 v[40:55], v[92:93], v[188:189], v[40:55]
    v_add_u32 v249, s48, v249
    v_add_u32 v250, s49, v250
    ds_read_b32 v252, v251 offset:16
    ds_read_b64_tr_b16 v[72:73], v249 offset:0
    ds_read_b64_tr_b16 v[76:77], v249 offset:64
    ds_read_b64_tr_b16 v[74:75], v249 offset:256
    ds_read_b64_tr_b16 v[78:79], v249 offset:320
    s_mov_b64 exec, s[54:55]
    ds_read_u16_d16_hi v242, v250 offset:0
    s_mov_b64 exec, -1
    s_cbranch_vccnz LEPI_0
    v_mul_f32 v255, v16, v152
    v_fmac_f32 v255, v17, v153
    v_fmac_f32 v255, v18, v154
    v_fmac_f32 v255, v19, v155
    v_fmac_f32 v255, v20, v156
    v_fmac_f32 v255, v21, v157
    v_fmac_f32 v255, v22, v158
    v_fmac_f32 v255, v23, v159
    v_fma_f32 v203, v24, -v168, v203
    v_fma_f32 v203, v25, -v169, v203
    v_permlane32_swap_b32 v255, v201
    v_fma_f32 v203, v26, -v170, v203
    v_fma_f32 v203, v27, -v171, v203
    v_fma_f32 v203, v28, -v172, v203
    v_fma_f32 v203, v29, -v173, v203
    v_fma_f32 v203, v30, -v174, v203
    v_fma_f32 v203, v31, -v175, v203
    v_add_f32 v201, v255, v201
    v_fma_f32 v199, v48, -v120, v199
    v_permlane32_swap_b32 v203, v255
    v_fma_f32 v199, v49, -v121, v199
    v_fma_f32 v199, v50, -v122, v199
    v_fma_f32 v199, v51, -v123, v199
    v_fma_f32 v199, v52, -v124, v199
    v_fma_f32 v199, v53, -v125, v199
    v_fma_f32 v199, v54, -v126, v199
    v_fma_f32 v199, v55, -v127, v199
    v_add_f32 v255, v203, v255
    v_mul_f32 v197, v40, v168
    v_fmac_f32 v197, v41, v169
    v_fmac_f32 v197, v42, v170
    v_fmac_f32 v197, v43, v171
    v_fmac_f32 v197, v44, v172
    v_fmac_f32 v197, v45, v173
    v_fmac_f32 v197, v46, v174
    v_fmac_f32 v197, v47, v175
    s_nop 1
    v_permlane32_swap_b32 v199, v197
    v_add_f32 v197, v199, v197
    v_cvt_pk_bf16_f32 v200, v200, v201
    v_cvt_pk_bf16_f32 v254, v254, v255
    v_cvt_pk_bf16_f32 v196, v196, v197
    ds_write2st64_b32 v253, v192, v193 offset0:0 offset1:1
    ds_write2st64_b32 v253, v194, v200 offset0:2 offset1:3
    ds_write_b32 v253, v196 offset:1024
    s_mov_b64 exec, 0xffffffff
    ds_write_b32 v253, v254 offset:1280
    s_mov_b64 exec, -1
    s_add_u32 s50, s50, 1
    s_cmp_ge_u32 s50, 4
    s_cbranch_scc1 LAST1
    s_waitcnt lgkmcnt(9)
    v_readfirstlane_b32 s66, v252
    s_add_u32 s53, s53, 1
    v_mov_b32 v252, s53
    s_cmp_le_u32 s53, s66
    ds_write2_b32 v251, v252, v252 offset0:0 offset1:8
    s_setprio 1
    s_cbranch_scc1 PRIO_12
    s_setprio 0
PRIO_12:
    s_cmp_eq_u32 s52, 4
    s_cbranch_scc1 ITEM_1_4
    s_cmp_eq_u32 s52, 5
    s_cbranch_scc1 ITEM_1_5
    s_cmp_eq_u32 s52, 3
    s_cbranch_scc1 ITEM_1_3
    s_cmp_eq_u32 s52, 6
    s_cbranch_scc1 ITEM_1_6
    s_cmp_eq_u32 s52, 8
    s_cbranch_scc1 ITEM_1_8
    s_branch ITEM_1_2
WL_5_0:
    s_add_u32 s66, s51, 0
    buffer_load_dwordx4 v[96:99], v246, s[16:19], s66 offen offset:2048 sc1
    buffer_load_dwordx4 v[100:103], v246, s[16:19], s66 offen offset:3072 sc1
    s_branch WR_5_0
WL_5_1:
    s_add_u32 s66, s51, 4096
    buffer_load_dwordx4 v[104:107], v246, s[16:19], s66 offen offset:2048 sc1
    buffer_load_dwordx4 v[108:111], v246, s[16:19], s66 offen offset:3072 sc1
    s_branch WR_5_1
WL_5_2:
    s_add_u32 s66, s51, 8192
    buffer_load_dwordx4 v[128:131], v246, s[16:19], s66 offen offset:2048 sc1
    buffer_load_dwordx4 v[132:135], v246, s[16:19], s66 offen offset:3072 sc1
    s_branch WR_5_2
WL_5_3:
    s_add_u32 s66, s51, 12288
    buffer_load_dwordx4 v[136:139], v246, s[16:19], s66 offen offset:2048 sc1
    buffer_load_dwordx4 v[140:143], v246, s[16:19], s66 offen offset:3072 sc1
    s_branch WR_5_3
.p2align 6
ITEM_1_3:
    s_mov_b64 exec, s[54:55]
    ds_read_u16_d16_hi v243, v250 offset:128
    s_mov_b64 exec, -1
    ds_read_b64_tr_b16 v[80:81], v249 offset:512
    ds_read_b64_tr_b16 v[84:85], v249 offset:576
    s_waitcnt lgkmcnt(3)
    v_mul_f32_dpp v196, v242, v72 row_newbcast:0 row_mask:0xf bank_mask:0xf
    v_mul_f32_dpp v197, v242, v73 row_newbcast:1 row_mask:0xf bank_mask:0xf
    v_mul_f32_dpp v198, v242, v72 row_newbcast:8 row_mask:0xf bank_mask:0xf
    v_mul_f32_dpp v199, v242, v73 row_newbcast:9 row_mask:0xf bank_mask:0xf
    v_mul_f32_dpp v200, v242, v76 row_newbcast:2 row_mask:0xf bank_mask:0xf
    v_mul_f32_dpp v201, v242, v77 row_newbcast:3 row_mask:0xf bank_mask:0xf
    v_mul_f32_dpp v202, v242, v76 row_newbcast:10 row_mask:0xf bank_mask:0xf
    v_mul_f32_dpp v203, v242, v77 row_newbcast:11 row_mask:0xf bank_mask:0xf
    v_cvt_pk_bf16_f32 v72, v196, v197
    v_cvt_pk_bf16_f32 v76, v198, v199
    v_cvt_pk_bf16_f32 v73, v200, v201
    v_cvt_pk_bf16_f32 v77, v202, v203
    v_mul_f32_dpp v196, v242, v74 row_newbcast:4 row_mask:0xf bank_mask:0xf
    v_mul_f32_dpp v197, v242, v75 row_newbcast:5 row_mask:0xf bank_mask:0xf
    v_mul_f32_dpp v198, v242, v74 row_newbcast:12 row_mask:0xf bank_mask:0xf
    v_mul_f32_dpp v199, v242, v75 row_newbcast:13 row_mask:0xf bank_mask:0xf
    v_mul_f32_dpp v200, v242, v78 row_newbcast:6 row_mask:0xf bank_mask:0xf
    v_mul_f32_dpp v201, v242, v79 row_newbcast:7 row_mask:0xf bank_mask:0xf
    v_mul_f32_dpp v202, v242, v78 row_newbcast:14 row_mask:0xf bank_mask:0xf
    v_mul_f32_dpp v203, v242, v79 row_newbcast:15 row_mask:0xf bank_mask:0xf
    v_cvt_pk_bf16_f32 v74, v196, v197
    v_cvt_pk_bf16_f32 v78, v198, v199
    v_cvt_pk_bf16_f32 v75, v200, v201
    v_cvt_pk_bf16_f32 v79, v202, v203
    s_waitcnt vmcnt(4) lgkmcnt(0)
    v_mfma_f32_32x32x16_bf16 v[0:15], v[72:75], v[176:179], 0
    v_mul_f32_dpp v196, v243, v80 row_newbcast:0 row_mask:0xf bank_mask:0xf
    v_mul_f32_dpp v197, v243, v81 row_newbcast:1 row_mask:0xf bank_mask:0xf
    v_mul_f32_dpp v198, v243, v80 row_newbcast:8 row_mask:0xf bank_mask:0xf
    v_mul_f32_dpp v199, v243, v81 row_newbcast:9 row_mask:0xf bank_mask:0xf
    v_mul_f32_dpp v200, v243, v84 row_newbcast:2 row_mask:0xf bank_mask:0xf
    v_mul_f32_dpp v201, v243, v85 row_newbcast:3 row_mask:0xf bank_mask:0xf
    s_add_u32 m0, s21, 0
    v_mfma_f32_32x32x16_bf16 v[48:63], v[76:79], v[176:179], 0
    buffer_load_dwordx4 v234, s[4:7], s36 offen  lds
    buffer_load_dwordx4 v235, s[8:11], s36 offen offset:1024  lds
    ds_read_b64_tr_b16 v[176:177], v244 offset:2048
    ds_read_b64_tr_b16 v[184:185], v245 offset:2048
    v_mul_f32_dpp v202, v243, v84 row_newbcast:10 row_mask:0xf bank_mask:0xf
    v_mul_f32_dpp v203, v243, v85 row_newbcast:11 row_mask:0xf bank_mask:0xf
    v_cvt_pk_bf16_f32 v80, v196, v197
    v_cvt_pk_bf16_f32 v84, v198, v199
    v_cvt_pk_bf16_f32 v81, v200, v201
    v_cvt_pk_bf16_f32 v85, v202, v203
    s_waitcnt lgkmcnt(0)
    v_mfma_f32_32x32x8_bf16 v[0:15], v[80:81], v[176:177], v[0:15]
    s_add_u32 m0, s21, 2048
    v_mfma_f32_32x32x8_bf16 v[48:63], v[84:85], v[176:177], v[48:63]
    buffer_load_dwordx4 v236, s[4:7], s36 offen  lds
    s_mov_b32 m0, s50
    s_nop 0
    s_movrels_b32 s71, s23
    s_movrels_b32 s33, s28
    v_add_u32 v253, s33, v248
    s_bfe_u32 s46, s71, 0x30012
    s_mov_b32 m0, s46
    s_and_b32 s66, s71, 0x3ffff
    s_movrels_b32 s68, s57
    s_movrels_b32 s69, s61
    s_sub_u32 s48, s66, s47
    s_mov_b32 s47, s66
    s_lshr_b32 s52, s71, 28
    s_lshl_b32 s67, s46, 9
    s_add_u32 s66, s66, s67
    s_sub_u32 s49, s66, s42
    s_mov_b32 s42, s66
    s_bfe_u32 s66, s68, 655360
    s_add_u32 s43, s42, s66
    s_bfe_u32 s39, s69, 655360
    s_bfe_u32 s66, s68, 655370
    s_add_u32 s44, s42, s66
    s_bfe_u32 s40, s69, 655370
    s_bfe_u32 s66, s68, 655380
    s_add_u32 s45, s42, s66
    s_bfe_u32 s41, s69, 655380
    v_add_u32 v252, s44, v247
    ds_read2_b32 v[238:239], v252 offset0:0 offset1:16
    v_add_u32 v252, s45, v247
    ds_read2_b32 v[240:241], v252 offset0:0 offset1:16
    v_mfma_f32_32x32x16_bf16 v[16:31], v[72:75], v[180:183], 0
    v_mul_f32 v196, v0, v96
    v_fmac_f32 v196, v1, v97
    v_fmac_f32 v196, v2, v98
    v_fmac_f32 v196, v3, v99
    v_fmac_f32 v196, v4, v100
    v_fmac_f32 v196, v5, v101
    v_mfma_f32_32x32x16_bf16 v[32:47], v[76:79], v[180:183], 0
    s_waitcnt vmcnt(5)
    ds_read_b64_tr_b16 v[176:177], v244 offset:4096
    ds_read_b64_tr_b16 v[178:179], v244 offset:5120
    ds_read_b64_tr_b16 v[180:181], v245 offset:4096
    ds_read_b64_tr_b16 v[182:183], v245 offset:5120
    v_fmac_f32 v196, v6, v102
    v_fmac_f32 v196, v7, v103
    v_mul_f32 v198, v8, v128
    v_fmac_f32 v198, v9, v129
    v_fmac_f32 v198, v10, v130
    v_fmac_f32 v198, v11, v131
    v_fmac_f32 v198, v12, v132
    v_fmac_f32 v198, v13, v133
    v_fmac_f32 v198, v14, v134
    v_fmac_f32 v198, v15, v135
    v_mul_f32 v200, v48, v128
    v_fmac_f32 v200, v49, v129
    v_permlane32_swap_b32 v196, v198
    v_fmac_f32 v200, v50, v130
    v_fmac_f32 v200, v51, v131
    v_fmac_f32 v200, v52, v132
    v_fmac_f32 v200, v53, v133
    v_fmac_f32 v200, v54, v134
    v_mfma_f32_32x32x8_bf16 v[16:31], v[80:81], v[184:185], v[16:31]
    v_fmac_f32 v200, v55, v135
    v_add_f32 v198, v196, v198
    v_mul_f32_e64 v202, v56, -v128
    v_fma_f32 v202, v57, -v129, v202
    v_fma_f32 v202, v58, -v130, v202
    v_fma_f32 v202, v59, -v131, v202
    v_mfma_f32_32x32x8_bf16 v[32:47], v[84:85], v[184:185], v[32:47]
    v_fma_f32 v202, v60, -v132, v202
    v_fma_f32 v202, v61, -v133, v202
    v_fma_f32 v202, v62, -v134, v202
    v_fma_f32 v202, v63, -v135, v202
    s_nop 1
    v_permlane32_swap_b32 v200, v202
    v_add_f32 v202, v200, v202
    s_waitcnt vmcnt(3) lgkmcnt(0)
    v_mfma_f32_32x32x16_bf16 v[0:15], v[72:75], v[176:179], 0
    v_mul_f32 v197, v16, v104
    v_fmac_f32 v197, v17, v105
    v_fmac_f32 v197, v18, v106
    v_fmac_f32 v197, v19, v107
    v_fmac_f32 v197, v20, v108
    v_fmac_f32 v197, v21, v109
    s_add_u32 m0, s21, 4096
    v_mfma_f32_32x32x16_bf16 v[48:63], v[76:79], v[176:179], 0
    buffer_load_dwordx4 v234, s[4:7], s37 offen  lds
    buffer_load_dwordx4 v235, s[8:11], s37 offen offset:1024  lds
    ds_read_b64_tr_b16 v[176:177], v244 offset:6144
    ds_read_b64_tr_b16 v[184:185], v245 offset:6144
    v_add_u32 v252, s42, v247
    ds_read2_b32 v[234:235], v252 offset0:0 offset1:16
    v_fmac_f32 v197, v22, v110
    v_fmac_f32 v197, v23, v111
    v_mul_f32 v199, v24, v136
    v_fmac_f32 v199, v25, v137
    v_fmac_f32 v199, v26, v138
    v_fmac_f32 v199, v27, v139
    v_fmac_f32 v199, v28, v140
    v_fmac_f32 v199, v29, v141
    v_fmac_f32 v199, v30, v142
    v_fmac_f32 v199, v31, v143
    v_mul_f32 v201, v32, v136
    v_fmac_f32 v201, v33, v137
    v_permlane32_swap_b32 v197, v199
    v_fmac_f32 v201, v34, v138
    v_fmac_f32 v201, v35, v139
    v_fmac_f32 v201, v36, v140
    v_fmac_f32 v201, v37, v141
    v_fmac_f32 v201, v38, v142
    v_fmac_f32 v201, v39, v143
    v_add_f32 v199, v197, v199
    v_mul_f32_e64 v203, v40, -v136
    v_fma_f32 v203, v41, -v137, v203
    v_fma_f32 v203, v42, -v138, v203
    s_waitcnt lgkmcnt(1)
    v_mfma_f32_32x32x8_bf16 v[0:15], v[80:81], v[176:177], v[0:15]
    v_fma_f32 v203, v43, -v139, v203
    v_fma_f32 v203, v44, -v140, v203
    v_fma_f32 v203, v45, -v141, v203
    v_fma_f32 v203, v46, -v142, v203
    v_fma_f32 v203, v47, -v143, v203
    s_nop 1
    v_permlane32_swap_b32 v201, v203
    s_add_u32 m0, s21, 6144
    v_mfma_f32_32x32x8_bf16 v[48:63], v[84:85], v[176:177], v[48:63]
    buffer_load_dwordx4 v236, s[4:7], s37 offen  lds
    v_add_u32 v252, s43, v247
    ds_read2_b32 v[236:237], v252 offset0:0 offset1:16
    v_add_f32 v203, v201, v203
    v_cvt_pk_bf16_f32 v192, v198, v199
    v_cvt_pk_bf16_f32 v193, v202, v203
    v_mfma_f32_32x32x16_bf16 v[16:31], v[72:75], v[180:183], 0
    v_mul_f32 v196, v0, v144
    v_fmac_f32 v196, v1, v145
    v_fmac_f32 v196, v2, v146
    v_fmac_f32 v196, v3, v147
    v_fmac_f32 v196, v4, v148
    v_fmac_f32 v196, v5, v149
    v_mfma_f32_32x32x16_bf16 v[32:47], v[76:79], v[180:183], 0
    s_waitcnt vmcnt(4)
    ds_read_b64_tr_b16 v[176:177], v244 offset:0
    ds_read_b64_tr_b16 v[178:179], v244 offset:1024
    ds_read_b64_tr_b16 v[180:181], v245 offset:0
    ds_read_b64_tr_b16 v[182:183], v245 offset:1024
    v_fmac_f32 v196, v6, v150
    v_fmac_f32 v196, v7, v151
    v_mul_f32 v198, v8, v112
    v_fmac_f32 v198, v9, v113
    v_fmac_f32 v198, v10, v114
    v_fmac_f32 v198, v11, v115
    v_fmac_f32 v198, v12, v116
    v_fmac_f32 v198, v13, v117
    v_fmac_f32 v198, v14, v118
    v_fmac_f32 v198, v15, v119
    v_mul_f32_e64 v200, v48, -v160
    v_fma_f32 v200, v49, -v161, v200
    v_fma_f32 v200, v50, -v162, v200
    v_fma_f32 v200, v51, -v163, v200
    v_mfma_f32_32x32x8_bf16 v[16:31], v[80:81], v[184:185], v[16:31]
    v_fma_f32 v200, v52, -v164, v200
    v_fma_f32 v200, v53, -v165, v200
    v_fma_f32 v200, v54, -v166, v200
    v_fma_f32 v200, v55, -v167, v200
    v_mul_f32_e64 v202, v56, -v160
    v_fma_f32 v202, v57, -v161, v202
    v_mfma_f32_32x32x8_bf16 v[32:47], v[84:85], v[184:185], v[32:47]
    v_fma_f32 v202, v58, -v162, v202
    v_fma_f32 v202, v59, -v163, v202
    v_fma_f32 v202, v60, -v164, v202
    v_fma_f32 v202, v61, -v165, v202
    v_fma_f32 v202, v62, -v166, v202
    v_fma_f32 v202, v63, -v167, v202
    s_waitcnt vmcnt(3) lgkmcnt(0)
    v_mfma_f32_32x32x16_bf16 v[0:15], v[72:75], v[176:179], 0
    v_mul_f32 v197, v16, v152
    v_fmac_f32 v197, v17, v153
    v_fmac_f32 v197, v18, v154
    v_fmac_f32 v197, v19, v155
    v_fmac_f32 v197, v20, v156
    v_fmac_f32 v197, v21, v157
    s_add_u32 m0, s21, 0
    v_mfma_f32_32x32x16_bf16 v[48:63], v[76:79], v[176:179], 0
    s_cbranch_vccnz WL_3_0
    v_mad_u32_u16 v234, v234, s3, v246 op_sel:[1,0,0,0]
    v_mad_u32_u16 v235, v235, s3, v246 op_sel:[1,0,0,0]
    buffer_load_dwordx4 v234, s[4:7], s38 offen  lds
    buffer_load_dwordx4 v235, s[8:11], s38 offen offset:1024  lds
WR_3_0:
    ds_read_b64_tr_b16 v[176:177], v244 offset:2048
    ds_read_b64_tr_b16 v[184:185], v245 offset:2048
    v_fmac_f32 v197, v22, v158
    v_fmac_f32 v197, v23, v159
    v_mul_f32 v199, v24, v120
    v_fmac_f32 v199, v25, v121
    v_fmac_f32 v199, v26, v122
    v_fmac_f32 v199, v27, v123
    v_fmac_f32 v199, v28, v124
    v_fmac_f32 v199, v29, v125
    v_fmac_f32 v199, v30, v126
    v_fmac_f32 v199, v31, v127
    v_mul_f32_e64 v201, v32, -v168
    v_fma_f32 v201, v33, -v169, v201
    v_fma_f32 v201, v34, -v170, v201
    v_fma_f32 v201, v35, -v171, v201
    v_fma_f32 v201, v36, -v172, v201
    v_fma_f32 v201, v37, -v173, v201
    v_fma_f32 v201, v38, -v174, v201
    v_fma_f32 v201, v39, -v175, v201
    s_waitcnt lgkmcnt(0)
    v_mfma_f32_32x32x8_bf16 v[0:15], v[80:81], v[176:177], v[0:15]
    v_mul_f32_e64 v203, v40, -v168
    v_fma_f32 v203, v41, -v169, v203
    v_fma_f32 v203, v42, -v170, v203
    v_fma_f32 v203, v43, -v171, v203
    v_fma_f32 v203, v44, -v172, v203
    v_fma_f32 v203, v45, -v173, v203
    s_add_u32 m0, s21, 2048
    v_mfma_f32_32x32x8_bf16 v[48:63], v[84:85], v[176:177], v[48:63]
    s_cbranch_vccnz WL_3_1
    v_mad_u32_u16 v236, v236, s3, v246 op_sel:[1,0,0,0]
    v_mad_u32_u16 v237, v237, s3, v246 op_sel:[1,0,0,0]
    buffer_load_dwordx4 v236, s[4:7], s39 offen  lds
    buffer_load_dwordx4 v237, s[8:11], s39 offen offset:1024  lds
WR_3_1:
    v_fma_f32 v203, v46, -v174, v203
    v_fma_f32 v203, v47, -v175, v203
    v_mfma_f32_32x32x16_bf16 v[16:31], v[72:75], v[180:183], 0
    v_mul_f32 v254, v0, v144
    v_fmac_f32 v254, v1, v145
    v_fmac_f32 v254, v2, v146
    v_fmac_f32 v254, v3, v147
    v_fmac_f32 v254, v4, v148
    v_fmac_f32 v254, v5, v149
    v_mfma_f32_32x32x16_bf16 v[32:47], v[76:79], v[180:183], 0
    s_waitcnt vmcnt(5)
    ds_read_b64_tr_b16 v[176:177], v244 offset:4096
    ds_read_b64_tr_b16 v[178:179], v244 offset:5120
    ds_read_b64_tr_b16 v[180:181], v245 offset:4096
    ds_read_b64_tr_b16 v[182:183], v245 offset:5120
    v_fmac_f32 v254, v6, v150
    v_fmac_f32 v254, v7, v151
    v_fmac_f32 v200, v8, v160
    v_fmac_f32 v200, v9, v161
    v_permlane32_swap_b32 v196, v254
    v_fmac_f32 v200, v10, v162
    v_fmac_f32 v200, v11, v163
    v_fmac_f32 v200, v12, v164
    v_mfma_f32_32x32x8_bf16 v[16:31], v[80:81], v[184:185], v[16:31]
    v_fmac_f32 v200, v13, v165
    v_fmac_f32 v200, v14, v166
    v_fmac_f32 v200, v15, v167
    v_add_f32 v254, v196, v254
    v_xor_b32 v64, 0x80000000, v48
    v_xor_b32 v65, 0x80000000, v49
    v_mfma_f32_32x32x8_bf16 v[32:47], v[84:85], v[184:185], v[32:47]
    v_xor_b32 v66, 0x80000000, v50
    v_xor_b32 v67, 0x80000000, v51
    v_xor_b32 v68, 0x80000000, v52
    v_xor_b32 v69, 0x80000000, v53
    v_xor_b32 v70, 0x80000000, v54
    v_xor_b32 v71, 0x80000000, v55
    s_waitcnt vmcnt(4) lgkmcnt(0)
    v_mfma_f32_32x32x16_bf16 v[0:15], v[72:75], v[176:179], 0
    v_mul_f32 v255, v16, v152
    v_fmac_f32 v255, v17, v153
    v_fmac_f32 v255, v18, v154
    v_fmac_f32 v255, v19, v155
    v_fmac_f32 v255, v20, v156
    v_fmac_f32 v255, v21, v157
    s_add_u32 m0, s21, 4096
    v_mfma_f32_32x32x16_bf16 v[56:71], v[76:79], v[176:179], v[56:71]
    s_cbranch_vccnz WL_3_2
    v_mad_u32_u16 v238, v238, s3, v246 op_sel:[1,0,0,0]
    v_mad_u32_u16 v239, v239, s3, v246 op_sel:[1,0,0,0]
    buffer_load_dwordx4 v238, s[4:7], s40 offen  lds
    buffer_load_dwordx4 v239, s[8:11], s40 offen offset:1024  lds
WR_3_2:
    ds_read_b64_tr_b16 v[176:177], v244 offset:6144
    ds_read_b64_tr_b16 v[184:185], v245 offset:6144
    v_fmac_f32 v255, v22, v158
    v_fmac_f32 v255, v23, v159
    v_fmac_f32 v201, v24, v168
    v_fmac_f32 v201, v25, v169
    v_permlane32_swap_b32 v197, v255
    v_fmac_f32 v201, v26, v170
    v_fmac_f32 v201, v27, v171
    v_fmac_f32 v201, v28, v172
    v_fmac_f32 v201, v29, v173
    v_fmac_f32 v201, v30, v174
    v_fmac_f32 v201, v31, v175
    v_add_f32 v255, v197, v255
    v_xor_b32 v48, 0x80000000, v32
    s_waitcnt lgkmcnt(0)
    v_mfma_f32_32x32x8_bf16 v[0:15], v[80:81], v[176:177], v[0:15]
    v_xor_b32 v49, 0x80000000, v33
    v_xor_b32 v50, 0x80000000, v34
    v_xor_b32 v51, 0x80000000, v35
    v_xor_b32 v52, 0x80000000, v36
    v_xor_b32 v53, 0x80000000, v37
    v_xor_b32 v54, 0x80000000, v38
    s_add_u32 m0, s21, 6144
    v_mfma_f32_32x32x8_bf16 v[56:71], v[84:85], v[176:177], v[56:71]
    s_cbranch_vccnz WL_3_3
    v_mad_u32_u16 v240, v240, s3, v246 op_sel:[1,0,0,0]
    v_mad_u32_u16 v241, v241, s3, v246 op_sel:[1,0,0,0]
    buffer_load_dwordx4 v240, s[4:7], s41 offen  lds
    buffer_load_dwordx4 v241, s[8:11], s41 offen offset:1024  lds
WR_3_3:
    v_xor_b32 v55, 0x80000000, v39
    v_cvt_pk_bf16_f32 v194, v254, v255
    v_mfma_f32_32x32x16_bf16 v[16:31], v[72:75], v[180:183], 0
    v_mul_f32 v254, v0, v144
    v_fmac_f32 v254, v1, v145
    v_fmac_f32 v254, v2, v146
    v_fmac_f32 v254, v3, v147
    v_fmac_f32 v254, v4, v148
    v_fmac_f32 v254, v5, v149
    v_mfma_f32_32x32x16_bf16 v[40:55], v[76:79], v[180:183], v[40:55]
    s_waitcnt vmcnt(6)
    ds_read_b64_tr_b16 v[176:177], v244 offset:0
    ds_read_b64_tr_b16 v[178:179], v244 offset:1024
    ds_read_b64_tr_b16 v[180:181], v245 offset:0
    ds_read_b64_tr_b16 v[182:183], v245 offset:1024
    v_fmac_f32 v254, v6, v150
    v_fmac_f32 v254, v7, v151
    v_fma_f32 v202, v8, -v160, v202
    v_fma_f32 v202, v9, -v161, v202
    v_permlane32_swap_b32 v254, v200
    v_fma_f32 v202, v10, -v162, v202
    v_fma_f32 v202, v11, -v163, v202
    v_fma_f32 v202, v12, -v164, v202
    v_fma_f32 v202, v13, -v165, v202
    v_fma_f32 v202, v14, -v166, v202
    v_fma_f32 v202, v15, -v167, v202
    v_add_f32 v200, v254, v200
    v_fma_f32 v198, v64, -v112, v198
    v_permlane32_swap_b32 v202, v254
    v_fma_f32 v198, v65, -v113, v198
    v_fma_f32 v198, v66, -v114, v198
    v_fma_f32 v198, v67, -v115, v198
    v_fma_f32 v198, v68, -v116, v198
    v_fma_f32 v198, v69, -v117, v198
    v_fma_f32 v198, v70, -v118, v198
    v_fma_f32 v198, v71, -v119, v198
    v_add_f32 v254, v202, v254
    v_mul_f32 v196, v56, v160
    v_fmac_f32 v196, v57, v161
    v_fmac_f32 v196, v58, v162
    v_fmac_f32 v196, v59, v163
    v_mfma_f32_32x32x8_bf16 v[16:31], v[80:81], v[184:185], v[16:31]
    v_fmac_f32 v196, v60, v164
    v_fmac_f32 v196, v61, v165
    v_fmac_f32 v196, v62, v166
    v_fmac_f32 v196, v63, v167
    s_nop 1
    v_permlane32_swap_b32 v198, v196
    v_add_f32 v196, v198, v196
    v_mfma_f32_32x32x8_bf16 v[40:55], v[84:85], v[184:185], v[40:55]
    v_add_u32 v249, s48, v249
    v_add_u32 v250, s49, v250
    ds_read_b32 v252, v251 offset:16
    ds_read_b64_tr_b16 v[72:73], v249 offset:0
    ds_read_b64_tr_b16 v[76:77], v249 offset:64
    ds_read_b64_tr_b16 v[74:75], v249 offset:256
    ds_read_b64_tr_b16 v[78:79], v249 offset:320
    s_mov_b64 exec, s[54:55]
    ds_read_u16_d16_hi v242, v250 offset:0
    s_mov_b64 exec, -1
    s_cbranch_vccnz LEPI_0
    v_mul_f32 v255, v16, v152
    v_fmac_f32 v255, v17, v153
    v_fmac_f32 v255, v18, v154
    v_fmac_f32 v255, v19, v155
    v_fmac_f32 v255, v20, v156
    v_fmac_f32 v255, v21, v157
    v_fmac_f32 v255, v22, v158
    v_fmac_f32 v255, v23, v159
    v_fma_f32 v203, v24, -v168, v203
    v_fma_f32 v203, v25, -v169, v203
    v_permlane32_swap_b32 v255, v201
    v_fma_f32 v203, v26, -v170, v203
    v_fma_f32 v203, v27, -v171, v203
    v_fma_f32 v203, v28, -v172, v203
    v_fma_f32 v203, v29, -v173, v203
    v_fma_f32 v203, v30, -v174, v203
    v_fma_f32 v203, v31, -v175, v203
    v_add_f32 v201, v255, v201
    v_fma_f32 v199, v48, -v120, v199
    v_permlane32_swap_b32 v203, v255
    v_fma_f32 v199, v49, -v121, v199
    v_fma_f32 v199, v50, -v122, v199
    v_fma_f32 v199, v51, -v123, v199
    v_fma_f32 v199, v52, -v124, v199
    v_fma_f32 v199, v53, -v125, v199
    v_fma_f32 v199, v54, -v126, v199
    v_fma_f32 v199, v55, -v127, v199
    v_add_f32 v255, v203, v255
    v_mul_f32 v197, v40, v168
    v_fmac_f32 v197, v41, v169
    v_fmac_f32 v197, v42, v170
    v_fmac_f32 v197, v43, v171
    v_fmac_f32 v197, v44, v172
    v_fmac_f32 v197, v45, v173
    v_fmac_f32 v197, v46, v174
    v_fmac_f32 v197, v47, v175
    s_nop 1
    v_permlane32_swap_b32 v199, v197
    v_add_f32 v197, v199, v197
    v_cvt_pk_bf16_f32 v200, v200, v201
    v_cvt_pk_bf16_f32 v254, v254, v255
    v_cvt_pk_bf16_f32 v196, v196, v197
    ds_write2st64_b32 v253, v192, v193 offset0:0 offset1:1
    ds_write2st64_b32 v253, v194, v200 offset0:2 offset1:3
    ds_write_b32 v253, v196 offset:1024
    s_mov_b64 exec, 0xffffffff
    ds_write_b32 v253, v254 offset:1280
    s_mov_b64 exec, -1
    s_add_u32 s50, s50, 1
    s_cmp_ge_u32 s50, 4
    s_cbranch_scc1 LAST1
    s_waitcnt lgkmcnt(9)
    v_readfirstlane_b32 s66, v252
    s_add_u32 s53, s53, 1
    v_mov_b32 v252, s53
    s_cmp_le_u32 s53, s66
    ds_write2_b32 v251, v252, v252 offset0:0 offset1:8
    s_setprio 1
    s_cbranch_scc1 PRIO_13
    s_setprio 0
PRIO_13:
    s_cmp_eq_u32 s52, 4
    s_cbranch_scc1 ITEM_1_4
    s_cmp_eq_u32 s52, 5
    s_cbranch_scc1 ITEM_1_5
    s_cmp_eq_u32 s52, 3
    s_cbranch_scc1 ITEM_1_3
    s_cmp_eq_u32 s52, 6
    s_cbranch_scc1 ITEM_1_6
    s_cmp_eq_u32 s52, 8
    s_cbranch_scc1 ITEM_1_8
    s_branch ITEM_1_2
WL_3_0:
    s_add_u32 s66, s51, 0
    buffer_load_dwordx4 v[96:99], v246, s[16:19], s66 offen offset:2048 sc1
    buffer_load_dwordx4 v[100:103], v246, s[16:19], s66 offen offset:3072 sc1
    s_branch WR_3_0
WL_3_1:
    s_add_u32 s66, s51, 4096
    buffer_load_dwordx4 v[104:107], v246, s[16:19], s66 offen offset:2048 sc1
    buffer_load_dwordx4 v[108:111], v246, s[16:19], s66 offen offset:3072 sc1
    s_branch WR_3_1
WL_3_2:
    s_add_u32 s66, s51, 8192
    buffer_load_dwordx4 v[128:131], v246, s[16:19], s66 offen offset:2048 sc1
    buffer_load_dwordx4 v[132:135], v246, s[16:19], s66 offen offset:3072 sc1
    s_branch WR_3_2
WL_3_3:
    s_add_u32 s66, s51, 12288
    buffer_load_dwordx4 v[136:139], v246, s[16:19], s66 offen offset:2048 sc1
    buffer_load_dwordx4 v[140:143], v246, s[16:19], s66 offen offset:3072 sc1
    s_branch WR_3_3
.p2align 6
ITEM_1_6:
    s_mov_b64 exec, s[54:55]
    ds_read_u16_d16_hi v243, v250 offset:128
    s_mov_b64 exec, -1
    ds_read_b64_tr_b16 v[80:81], v249 offset:512
    ds_read_b64_tr_b16 v[84:85], v249 offset:576
    ds_read_b64_tr_b16 v[82:83], v249 offset:768
    ds_read_b64_tr_b16 v[86:87], v249 offset:832
    ds_read_b64_tr_b16 v[88:89], v249 offset:1024
    ds_read_b64_tr_b16 v[92:93], v249 offset:1088
    ds_read_b64_tr_b16 v[90:91], v249 offset:1280
    ds_read_b64_tr_b16 v[94:95], v249 offset:1344
    s_waitcnt lgkmcnt(9)
    v_mul_f32_dpp v196, v242, v72 row_newbcast:0 row_mask:0xf bank_mask:0xf
    v_mul_f32_dpp v197, v242, v73 row_newbcast:1 row_mask:0xf bank_mask:0xf
    v_mul_f32_dpp v198, v242, v72 row_newbcast:8 row_mask:0xf bank_mask:0xf
    v_mul_f32_dpp v199, v242, v73 row_newbcast:9 row_mask:0xf bank_mask:0xf
    v_mul_f32_dpp v200, v242, v76 row_newbcast:2 row_mask:0xf bank_mask:0xf
    v_mul_f32_dpp v201, v242, v77 row_newbcast:3 row_mask:0xf bank_mask:0xf
    v_mul_f32_dpp v202, v242, v76 row_newbcast:10 row_mask:0xf bank_mask:0xf
    v_mul_f32_dpp v203, v242, v77 row_newbcast:11 row_mask:0xf bank_mask:0xf
    v_cvt_pk_bf16_f32 v72, v196, v197
    v_cvt_pk_bf16_f32 v76, v198, v199
    v_cvt_pk_bf16_f32 v73, v200, v201
    v_cvt_pk_bf16_f32 v77, v202, v203
    v_mul_f32_dpp v196, v242, v74 row_newbcast:4 row_mask:0xf bank_mask:0xf
    v_mul_f32_dpp v197, v242, v75 row_newbcast:5 row_mask:0xf bank_mask:0xf
    v_mul_f32_dpp v198, v242, v74 row_newbcast:12 row_mask:0xf bank_mask:0xf
    v_mul_f32_dpp v199, v242, v75 row_newbcast:13 row_mask:0xf bank_mask:0xf
    v_mul_f32_dpp v200, v242, v78 row_newbcast:6 row_mask:0xf bank_mask:0xf
    v_mul_f32_dpp v201, v242, v79 row_newbcast:7 row_mask:0xf bank_mask:0xf
    v_mul_f32_dpp v202, v242, v78 row_newbcast:14 row_mask:0xf bank_mask:0xf
    v_mul_f32_dpp v203, v242, v79 row_newbcast:15 row_mask:0xf bank_mask:0xf
    v_cvt_pk_bf16_f32 v74, v196, v197
    v_cvt_pk_bf16_f32 v78, v198, v199
    v_cvt_pk_bf16_f32 v75, v200, v201
    v_cvt_pk_bf16_f32 v79, v202, v203
    s_mov_b64 exec, s[54:55]
    ds_read_u16_d16_hi v242, v250 offset:256
    s_mov_b64 exec, -1
    s_waitcnt vmcnt(4) lgkmcnt(5)
    v_mfma_f32_32x32x16_bf16 v[0:15], v[72:75], v[176:179], 0
    v_mul_f32_dpp v196, v243, v80 row_newbcast:0 row_mask:0xf bank_mask:0xf
    v_mul_f32_dpp v197, v243, v81 row_newbcast:1 row_mask:0xf bank_mask:0xf
    v_mul_f32_dpp v198, v243, v80 row_newbcast:8 row_mask:0xf bank_mask:0xf
    v_mul_f32_dpp v199, v243, v81 row_newbcast:9 row_mask:0xf bank_mask:0xf
    v_mul_f32_dpp v200, v243, v84 row_newbcast:2 row_mask:0xf bank_mask:0xf
    v_mul_f32_dpp v201, v243, v85 row_newbcast:3 row_mask:0xf bank_mask:0xf
    s_add_u32 m0, s21, 0
    v_mfma_f32_32x32x16_bf16 v[48:63], v[76:79], v[176:179], 0
    buffer_load_dwordx4 v236, s[4:7], s35 offen  lds
    buffer_load_dwordx4 v237, s[8:11], s35 offen offset:1024  lds
    ds_read_b64_tr_b16 v[176:177], v244 offset:2048
    ds_read_b64_tr_b16 v[178:179], v244 offset:3072
    ds_read_b64_tr_b16 v[184:185], v245 offset:2048
    ds_read_b64_tr_b16 v[186:187], v245 offset:3072
    v_mul_f32_dpp v202, v243, v84 row_newbcast:10 row_mask:0xf bank_mask:0xf
    v_mul_f32_dpp v203, v243, v85 row_newbcast:11 row_mask:0xf bank_mask:0xf
    v_cvt_pk_bf16_f32 v80, v196, v197
    v_cvt_pk_bf16_f32 v84, v198, v199
    v_cvt_pk_bf16_f32 v81, v200, v201
    v_cvt_pk_bf16_f32 v85, v202, v203
    v_mul_f32_dpp v196, v243, v82 row_newbcast:4 row_mask:0xf bank_mask:0xf
    v_mul_f32_dpp v197, v243, v83 row_newbcast:5 row_mask:0xf bank_mask:0xf
    v_mul_f32_dpp v198, v243, v82 row_newbcast:12 row_mask:0xf bank_mask:0xf
    v_mul_f32_dpp v199, v243, v83 row_newbcast:13 row_mask:0xf bank_mask:0xf
    v_mul_f32_dpp v200, v243, v86 row_newbcast:6 row_mask:0xf bank_mask:0xf
    v_mul_f32_dpp v201, v243, v87 row_newbcast:7 row_mask:0xf bank_mask:0xf
    v_mul_f32_dpp v202, v243, v86 row_newbcast:14 row_mask:0xf bank_mask:0xf
    v_mul_f32_dpp v203, v243, v87 row_newbcast:15 row_mask:0xf bank_mask:0xf
    v_cvt_pk_bf16_f32 v82, v196, v197
    v_cvt_pk_bf16_f32 v86, v198, v199
    v_cvt_pk_bf16_f32 v83, v200, v201
    v_cvt_pk_bf16_f32 v87, v202, v203
    s_waitcnt vmcnt(4) lgkmcnt(0)
    v_mfma_f32_32x32x16_bf16 v[0:15], v[80:83], v[176:179], v[0:15]
    v_mul_f32_dpp v196, v242, v88 row_newbcast:0 row_mask:0xf bank_mask:0xf
    v_mul_f32_dpp v197, v242, v89 row_newbcast:1 row_mask:0xf bank_mask:0xf
    v_mul_f32_dpp v198, v242, v88 row_newbcast:8 row_mask:0xf bank_mask:0xf
    v_mul_f32_dpp v199, v242, v89 row_newbcast:9 row_mask:0xf bank_mask:0xf
    v_mul_f32_dpp v200, v242, v92 row_newbcast:2 row_mask:0xf bank_mask:0xf
    v_mul_f32_dpp v201, v242, v93 row_newbcast:3 row_mask:0xf bank_mask:0xf
    s_add_u32 m0, s21, 2048
    v_mfma_f32_32x32x16_bf16 v[48:63], v[84:87], v[176:179], v[48:63]
    buffer_load_dwordx4 v238, s[4:7], s35 offen  lds
    buffer_load_dwordx4 v239, s[8:11], s35 offen offset:1024  lds
    ds_read_b64_tr_b16 v[176:177], v244 offset:4096
    ds_read_b64_tr_b16 v[178:179], v244 offset:5120
    ds_read_b64_tr_b16 v[188:189], v245 offset:4096
    ds_read_b64_tr_b16 v[190:191], v245 offset:5120
    v_mul_f32_dpp v202, v242, v92 row_newbcast:10 row_mask:0xf bank_mask:0xf
    v_mul_f32_dpp v203, v242, v93 row_newbcast:11 row_mask:0xf bank_mask:0xf
    v_cvt_pk_bf16_f32 v88, v196, v197
    v_cvt_pk_bf16_f32 v92, v198, v199
    v_cvt_pk_bf16_f32 v89, v200, v201
    v_cvt_pk_bf16_f32 v93, v202, v203
    v_mul_f32_dpp v196, v242, v90 row_newbcast:4 row_mask:0xf bank_mask:0xf
    v_mul_f32_dpp v197, v242, v91 row_newbcast:5 row_mask:0xf bank_mask:0xf
    v_mul_f32_dpp v198, v242, v90 row_newbcast:12 row_mask:0xf bank_mask:0xf
    v_mul_f32_dpp v199, v242, v91 row_newbcast:13 row_mask:0xf bank_mask:0xf
    v_mul_f32_dpp v200, v242, v94 row_newbcast:6 row_mask:0xf bank_mask:0xf
    v_mul_f32_dpp v201, v242, v95 row_newbcast:7 row_mask:0xf bank_mask:0xf
    v_mul_f32_dpp v202, v242, v94 row_newbcast:14 row_mask:0xf bank_mask:0xf
    v_mul_f32_dpp v203, v242, v95 row_newbcast:15 row_mask:0xf bank_mask:0xf
    v_cvt_pk_bf16_f32 v90, v196, v197
    v_cvt_pk_bf16_f32 v94, v198, v199
    v_cvt_pk_bf16_f32 v91, v200, v201
    v_cvt_pk_bf16_f32 v95, v202, v203
    s_waitcnt lgkmcnt(0)
    v_mfma_f32_32x32x16_bf16 v[0:15], v[88:91], v[176:179], v[0:15]
    s_add_u32 m0, s21, 4096
    v_mfma_f32_32x32x16_bf16 v[48:63], v[92:95], v[176:179], v[48:63]
    buffer_load_dwordx4 v234, s[4:7], s36 offen  lds
    buffer_load_dwordx4 v235, s[8:11], s36 offen offset:1024  lds
    s_mov_b32 m0, s50
    s_nop 0
    s_movrels_b32 s71, s23
    s_movrels_b32 s33, s28
    v_add_u32 v253, s33, v248
    s_bfe_u32 s46, s71, 0x30012
    s_mov_b32 m0, s46
    s_and_b32 s66, s71, 0x3ffff
    s_movrels_b32 s68, s57
    s_movrels_b32 s69, s61
    s_sub_u32 s48, s66, s47
    s_mov_b32 s47, s66
    s_lshr_b32 s52, s71, 28
    s_lshl_b32 s67, s46, 9
    s_add_u32 s66, s66, s67
    s_sub_u32 s49, s66, s42
    s_mov_b32 s42, s66
    s_bfe_u32 s66, s68, 655360
    s_add_u32 s43, s42, s66
    s_bfe_u32 s39, s69, 655360
    s_bfe_u32 s66, s68, 655370
    s_add_u32 s44, s42, s66
    s_bfe_u32 s40, s69, 655370
    s_bfe_u32 s66, s68, 655380
    s_add_u32 s45, s42, s66
    s_bfe_u32 s41, s69, 655380
    v_add_u32 v252, s45, v247
    ds_read2_b32 v[240:241], v252 offset0:0 offset1:16
    v_mfma_f32_32x32x16_bf16 v[16:31], v[72:75], v[180:183], 0
    v_mul_f32 v196, v0, v96
    v_fmac_f32 v196, v1, v97
    v_fmac_f32 v196, v2, v98
    v_fmac_f32 v196, v3, v99
    v_fmac_f32 v196, v4, v100
    v_fmac_f32 v196, v5, v101
    v_mfma_f32_32x32x16_bf16 v[32:47], v[76:79], v[180:183], 0
    v_fmac_f32 v196, v6, v102
    v_fmac_f32 v196, v7, v103
    v_mul_f32 v198, v8, v128
    v_fmac_f32 v198, v9, v129
    v_fmac_f32 v198, v10, v130
    v_fmac_f32 v198, v11, v131
    v_fmac_f32 v198, v12, v132
    v_fmac_f32 v198, v13, v133
    v_fmac_f32 v198, v14, v134
    v_fmac_f32 v198, v15, v135
    v_mfma_f32_32x32x16_bf16 v[16:31], v[80:83], v[184:187], v[16:31]
    v_mul_f32 v200, v48, v128
    v_fmac_f32 v200, v49, v129
    v_permlane32_swap_b32 v196, v198
    v_fmac_f32 v200, v50, v130
    v_fmac_f32 v200, v51, v131
    v_fmac_f32 v200, v52, v132
    v_mfma_f32_32x32x16_bf16 v[32:47], v[84:87], v[184:187], v[32:47]
    s_waitcnt vmcnt(6)
    ds_read_b64_tr_b16 v[176:177], v244 offset:6144
    ds_read_b64_tr_b16 v[178:179], v244 offset:7168
    ds_read_b64_tr_b16 v[180:181], v245 offset:6144
    ds_read_b64_tr_b16 v[182:183], v245 offset:7168
    v_fmac_f32 v200, v53, v133
    v_fmac_f32 v200, v54, v134
    v_mfma_f32_32x32x16_bf16 v[16:31], v[88:91], v[188:191], v[16:31]
    v_fmac_f32 v200, v55, v135
    v_add_f32 v198, v196, v198
    v_mul_f32_e64 v202, v56, -v128
    v_fma_f32 v202, v57, -v129, v202
    v_fma_f32 v202, v58, -v130, v202
    v_fma_f32 v202, v59, -v131, v202
    v_mfma_f32_32x32x16_bf16 v[32:47], v[92:95], v[188:191], v[32:47]
    v_fma_f32 v202, v60, -v132, v202
    v_fma_f32 v202, v61, -v133, v202
    v_fma_f32 v202, v62, -v134, v202
    v_fma_f32 v202, v63, -v135, v202
    s_nop 1
    v_permlane32_swap_b32 v200, v202
    v_add_f32 v202, v200, v202
    s_waitcnt vmcnt(4) lgkmcnt(0)
    v_mfma_f32_32x32x16_bf16 v[0:15], v[72:75], v[176:179], 0
    v_mul_f32 v197, v16, v104
    v_fmac_f32 v197, v17, v105
    v_fmac_f32 v197, v18, v106
    v_fmac_f32 v197, v19, v107
    v_fmac_f32 v197, v20, v108
    v_fmac_f32 v197, v21, v109
    s_add_u32 m0, s21, 6144
    v_mfma_f32_32x32x16_bf16 v[48:63], v[76:79], v[176:179], 0
    buffer_load_dwordx4 v236, s[4:7], s36 offen  lds
    buffer_load_dwordx4 v237, s[8:11], s36 offen offset:1024  lds
    ds_read_b64_tr_b16 v[176:177], v244 offset:0
    ds_read_b64_tr_b16 v[178:179], v244 offset:1024
    ds_read_b64_tr_b16 v[184:185], v245 offset:0
    ds_read_b64_tr_b16 v[186:187], v245 offset:1024
    v_fmac_f32 v197, v22, v110
    v_fmac_f32 v197, v23, v111
    v_mul_f32 v199, v24, v136
    v_fmac_f32 v199, v25, v137
    v_fmac_f32 v199, v26, v138
    v_fmac_f32 v199, v27, v139
    v_fmac_f32 v199, v28, v140
    v_fmac_f32 v199, v29, v141
    v_fmac_f32 v199, v30, v142
    v_fmac_f32 v199, v31, v143
    v_mul_f32 v201, v32, v136
    v_fmac_f32 v201, v33, v137
    v_permlane32_swap_b32 v197, v199
    v_fmac_f32 v201, v34, v138
    v_fmac_f32 v201, v35, v139
    v_fmac_f32 v201, v36, v140
    v_fmac_f32 v201, v37, v141
    v_fmac_f32 v201, v38, v142
    s_waitcnt vmcnt(4) lgkmcnt(0)
    v_mfma_f32_32x32x16_bf16 v[0:15], v[80:83], v[176:179], v[0:15]
    v_fmac_f32 v201, v39, v143
    v_add_f32 v199, v197, v199
    v_mul_f32_e64 v203, v40, -v136
    v_fma_f32 v203, v41, -v137, v203
    v_fma_f32 v203, v42, -v138, v203
    v_fma_f32 v203, v43, -v139, v203
    s_add_u32 m0, s21, 0
    v_mfma_f32_32x32x16_bf16 v[48:63], v[84:87], v[176:179], v[48:63]
    buffer_load_dwordx4 v238, s[4:7], s36 offen  lds
    buffer_load_dwordx4 v239, s[8:11], s36 offen offset:1024  lds
    ds_read_b64_tr_b16 v[176:177], v244 offset:2048
    ds_read_b64_tr_b16 v[178:179], v244 offset:3072
    ds_read_b64_tr_b16 v[188:189], v245 offset:2048
    ds_read_b64_tr_b16 v[190:191], v245 offset:3072
    s_waitcnt lgkmcnt(0)
    v_mfma_f32_32x32x16_bf16 v[0:15], v[88:91], v[176:179], v[0:15]
    v_fma_f32 v203, v44, -v140, v203
    v_fma_f32 v203, v45, -v141, v203
    v_fma_f32 v203, v46, -v142, v203
    v_fma_f32 v203, v47, -v143, v203
    s_nop 1
    v_permlane32_swap_b32 v201, v203
    v_add_f32 v203, v201, v203
    s_add_u32 m0, s21, 2048
    v_mfma_f32_32x32x16_bf16 v[48:63], v[92:95], v[176:179], v[48:63]
    buffer_load_dwordx4 v234, s[4:7], s37 offen  lds
    buffer_load_dwordx4 v235, s[8:11], s37 offen offset:1024  lds
    v_add_u32 v252, s42, v247
    ds_read2_b32 v[234:235], v252 offset0:0 offset1:16
    v_cvt_pk_bf16_f32 v192, v198, v199
    v_cvt_pk_bf16_f32 v193, v202, v203
    v_mfma_f32_32x32x16_bf16 v[16:31], v[72:75], v[180:183], 0
    v_mul_f32 v196, v0, v144
    v_fmac_f32 v196, v1, v145
    v_fmac_f32 v196, v2, v146
    v_fmac_f32 v196, v3, v147
    v_fmac_f32 v196, v4, v148
    v_fmac_f32 v196, v5, v149
    v_mfma_f32_32x32x16_bf16 v[32:47], v[76:79], v[180:183], 0
    v_fmac_f32 v196, v6, v150
    v_fmac_f32 v196, v7, v151
    v_mul_f32 v198, v8, v112
    v_fmac_f32 v198, v9, v113
    v_fmac_f32 v198, v10, v114
    v_fmac_f32 v198, v11, v115
    v_mfma_f32_32x32x16_bf16 v[16:31], v[80:83], v[184:187], v[16:31]
    v_fmac_f32 v198, v12, v116
    v_fmac_f32 v198, v13, v117
    v_fmac_f32 v198, v14, v118
    v_fmac_f32 v198, v15, v119
    v_mul_f32_e64 v200, v48, -v160
    v_fma_f32 v200, v49, -v161, v200
    v_mfma_f32_32x32x16_bf16 v[32:47], v[84:87], v[184:187], v[32:47]
    s_waitcnt vmcnt(6)
    ds_read_b64_tr_b16 v[176:177], v244 offset:4096
    ds_read_b64_tr_b16 v[178:179], v244 offset:5120
    ds_read_b64_tr_b16 v[180:181], v245 offset:4096
    ds_read_b64_tr_b16 v[182:183], v245 offset:5120
    v_fma_f32 v200, v50, -v162, v200
    v_fma_f32 v200, v51, -v163, v200
    v_mfma_f32_32x32x16_bf16 v[16:31], v[88:91], v[188:191], v[16:31]
    v_fma_f32 v200, v52, -v164, v200
    v_fma_f32 v200, v53, -v165, v200
    v_fma_f32 v200, v54, -v166, v200
    v_fma_f32 v200, v55, -v167, v200
    v_mul_f32_e64 v202, v56, -v160
    v_fma_f32 v202, v57, -v161, v202
    v_mfma_f32_32x32x16_bf16 v[32:47], v[92:95], v[188:191], v[32:47]
    v_fma_f32 v202, v58, -v162, v202
    v_fma_f32 v202, v59, -v163, v202
    v_fma_f32 v202, v60, -v164, v202
    v_fma_f32 v202, v61, -v165, v202
    v_fma_f32 v202, v62, -v166, v202
    v_fma_f32 v202, v63, -v167, v202
    s_waitcnt vmcnt(4) lgkmcnt(0)
    v_mfma_f32_32x32x16_bf16 v[0:15], v[72:75], v[176:179], 0
    v_mul_f32 v197, v16, v152
    v_fmac_f32 v197, v17, v153
    v_fmac_f32 v197, v18, v154
    v_fmac_f32 v197, v19, v155
    v_fmac_f32 v197, v20, v156
    v_fmac_f32 v197, v21, v157
    s_add_u32 m0, s21, 4096
    v_mfma_f32_32x32x16_bf16 v[48:63], v[76:79], v[176:179], 0
    buffer_load_dwordx4 v236, s[4:7], s37 offen  lds
    buffer_load_dwordx4 v237, s[8:11], s37 offen offset:1024  lds
    ds_read_b64_tr_b16 v[176:177], v244 offset:6144
    ds_read_b64_tr_b16 v[178:179], v244 offset:7168
    ds_read_b64_tr_b16 v[184:185], v245 offset:6144
    ds_read_b64_tr_b16 v[186:187], v245 offset:7168
    v_add_u32 v252, s43, v247
    ds_read2_b32 v[236:237], v252 offset0:0 offset1:16
    v_fmac_f32 v197, v22, v158
    v_fmac_f32 v197, v23, v159
    v_mul_f32 v199, v24, v120
    v_fmac_f32 v199, v25, v121
    v_fmac_f32 v199, v26, v122
    v_fmac_f32 v199, v27, v123
    v_fmac_f32 v199, v28, v124
    v_fmac_f32 v199, v29, v125
    v_fmac_f32 v199, v30, v126
    v_fmac_f32 v199, v31, v127
    v_mul_f32_e64 v201, v32, -v168
    v_fma_f32 v201, v33, -v169, v201
    s_waitcnt vmcnt(4) lgkmcnt(1)
    v_mfma_f32_32x32x16_bf16 v[0:15], v[80:83], v[176:179], v[0:15]
    v_fma_f32 v201, v34, -v170, v201
    v_fma_f32 v201, v35, -v171, v201
    v_fma_f32 v201, v36, -v172, v201
    v_fma_f32 v201, v37, -v173, v201
    v_fma_f32 v201, v38, -v174, v201
    v_fma_f32 v201, v39, -v175, v201
    s_add_u32 m0, s21, 6144
    v_mfma_f32_32x32x16_bf16 v[48:63], v[84:87], v[176:179], v[48:63]
    buffer_load_dwordx4 v238, s[4:7], s37 offen  lds
    buffer_load_dwordx4 v239, s[8:11], s37 offen offset:1024  lds
    ds_read_b64_tr_b16 v[176:177], v244 offset:0
    ds_read_b64_tr_b16 v[178:179], v244 offset:1024
    ds_read_b64_tr_b16 v[188:189], v245 offset:0
    ds_read_b64_tr_b16 v[190:191], v245 offset:1024
    v_add_u32 v252, s44, v247
    ds_read2_b32 v[238:239], v252 offset0:0 offset1:16
    s_waitcnt lgkmcnt(1)
    v_mfma_f32_32x32x16_bf16 v[0:15], v[88:91], v[176:179], v[0:15]
    v_mul_f32_e64 v203, v40, -v168
    v_fma_f32 v203, v41, -v169, v203
    v_fma_f32 v203, v42, -v170, v203
    v_fma_f32 v203, v43, -v171, v203
    v_fma_f32 v203, v44, -v172, v203
    v_fma_f32 v203, v45, -v173, v203
    s_add_u32 m0, s21, 0
    v_mfma_f32_32x32x16_bf16 v[48:63], v[92:95], v[176:179], v[48:63]
    s_cbranch_vccnz WL_6_0
    v_mad_u32_u16 v234, v234, s3, v246 op_sel:[1,0,0,0]
    v_mad_u32_u16 v235, v235, s3, v246 op_sel:[1,0,0,0]
    buffer_load_dwordx4 v234, s[4:7], s38 offen  lds
    buffer_load_dwordx4 v235, s[8:11], s38 offen offset:1024  lds
WR_6_0:
    v_fma_f32 v203, v46, -v174, v203
    v_fma_f32 v203, v47, -v175, v203
    v_mfma_f32_32x32x16_bf16 v[16:31], v[72:75], v[180:183], 0
    v_mul_f32 v254, v0, v144
    v_fmac_f32 v254, v1, v145
    v_fmac_f32 v254, v2, v146
    v_fmac_f32 v254, v3, v147
    v_fmac_f32 v254, v4, v148
    v_fmac_f32 v254, v5, v149
    v_mfma_f32_32x32x16_bf16 v[32:47], v[76:79], v[180:183], 0
    v_mfma_f32_32x32x16_bf16 v[16:31], v[80:83], v[184:187], v[16:31]
    v_fmac_f32 v254, v6, v150
    v_fmac_f32 v254, v7, v151
    v_fmac_f32 v200, v8, v160
    v_fmac_f32 v200, v9, v161
    v_permlane32_swap_b32 v196, v254
    v_fmac_f32 v200, v10, v162
    v_mfma_f32_32x32x16_bf16 v[32:47], v[84:87], v[184:187], v[32:47]
    s_waitcnt vmcnt(6)
    ds_read_b64_tr_b16 v[176:177], v244 offset:2048
    ds_read_b64_tr_b16 v[178:179], v244 offset:3072
    ds_read_b64_tr_b16 v[180:181], v245 offset:2048
    ds_read_b64_tr_b16 v[182:183], v245 offset:3072
    v_fmac_f32 v200, v11, v163
    v_fmac_f32 v200, v12, v164
    v_mfma_f32_32x32x16_bf16 v[16:31], v[88:91], v[188:191], v[16:31]
    v_fmac_f32 v200, v13, v165
    v_fmac_f32 v200, v14, v166
    v_fmac_f32 v200, v15, v167
    v_add_f32 v254, v196, v254
    v_xor_b32 v64, 0x80000000, v48
    v_xor_b32 v65, 0x80000000, v49
    v_mfma_f32_32x32x16_bf16 v[32:47], v[92:95], v[188:191], v[32:47]
    v_xor_b32 v66, 0x80000000, v50
    v_xor_b32 v67, 0x80000000, v51
    v_xor_b32 v68, 0x80000000, v52
    v_xor_b32 v69, 0x80000000, v53
    v_xor_b32 v70, 0x80000000, v54
    v_xor_b32 v71, 0x80000000, v55
    s_waitcnt vmcnt(4) lgkmcnt(0)
    v_mfma_f32_32x32x16_bf16 v[0:15], v[72:75], v[176:179], 0
    v_mul_f32 v255, v16, v152
    v_fmac_f32 v255, v17, v153
    v_fmac_f32 v255, v18, v154
    v_fmac_f32 v255, v19, v155
    v_fmac_f32 v255, v20, v156
    v_fmac_f32 v255, v21, v157
    s_add_u32 m0, s21, 2048
    v_mfma_f32_32x32x16_bf16 v[56:71], v[76:79], v[176:179], v[56:71]
    s_cbranch_vccnz WL_6_1
    v_mad_u32_u16 v236, v236, s3, v246 op_sel:[1,0,0,0]
    v_mad_u32_u16 v237, v237, s3, v246 op_sel:[1,0,0,0]
    buffer_load_dwordx4 v236, s[4:7], s39 offen  lds
    buffer_load_dwordx4 v237, s[8:11], s39 offen offset:1024  lds
WR_6_1:
    ds_read_b64_tr_b16 v[176:177], v244 offset:4096
    ds_read_b64_tr_b16 v[178:179], v244 offset:5120
    ds_read_b64_tr_b16 v[184:185], v245 offset:4096
    ds_read_b64_tr_b16 v[186:187], v245 offset:5120
    v_fmac_f32 v255, v22, v158
    v_fmac_f32 v255, v23, v159
    v_fmac_f32 v201, v24, v168
    v_fmac_f32 v201, v25, v169
    v_permlane32_swap_b32 v197, v255
    v_fmac_f32 v201, v26, v170
    v_fmac_f32 v201, v27, v171
    s_waitcnt vmcnt(4) lgkmcnt(0)
    v_mfma_f32_32x32x16_bf16 v[0:15], v[80:83], v[176:179], v[0:15]
    v_fmac_f32 v201, v28, v172
    v_fmac_f32 v201, v29, v173
    v_fmac_f32 v201, v30, v174
    v_fmac_f32 v201, v31, v175
    v_add_f32 v255, v197, v255
    v_xor_b32 v48, 0x80000000, v32
    s_add_u32 m0, s21, 4096
    v_mfma_f32_32x32x16_bf16 v[56:71], v[84:87], v[176:179], v[56:71]
    s_cbranch_vccnz WL_6_2
    v_mad_u32_u16 v238, v238, s3, v246 op_sel:[1,0,0,0]
    v_mad_u32_u16 v239, v239, s3, v246 op_sel:[1,0,0,0]
    buffer_load_dwordx4 v238, s[4:7], s40 offen  lds
    buffer_load_dwordx4 v239, s[8:11], s40 offen offset:1024  lds
WR_6_2:
    ds_read_b64_tr_b16 v[176:177], v244 offset:6144
    ds_read_b64_tr_b16 v[178:179], v244 offset:7168
    ds_read_b64_tr_b16 v[188:189], v245 offset:6144
    ds_read_b64_tr_b16 v[190:191], v245 offset:7168
    s_waitcnt lgkmcnt(0)
    v_mfma_f32_32x32x16_bf16 v[0:15], v[88:91], v[176:179], v[0:15]
    v_xor_b32 v49, 0x80000000, v33
    v_xor_b32 v50, 0x80000000, v34
    v_xor_b32 v51, 0x80000000, v35
    v_xor_b32 v52, 0x80000000, v36
    v_xor_b32 v53, 0x80000000, v37
    v_xor_b32 v54, 0x80000000, v38
    s_add_u32 m0, s21, 6144
    v_mfma_f32_32x32x16_bf16 v[56:71], v[92:95], v[176:179], v[56:71]
    s_cbranch_vccnz WL_6_3
    v_mad_u32_u16 v240, v240, s3, v246 op_sel:[1,0,0,0]
    v_mad_u32_u16 v241, v241, s3, v246 op_sel:[1,0,0,0]
    buffer_load_dwordx4 v240, s[4:7], s41 offen  lds
    buffer_load_dwordx4 v241, s[8:11], s41 offen offset:1024  lds
WR_6_3:
    v_xor_b32 v55, 0x80000000, v39
    v_cvt_pk_bf16_f32 v194, v254, v255
    v_mfma_f32_32x32x16_bf16 v[16:31], v[72:75], v[180:183], 0
    v_mul_f32 v254, v0, v144
    v_fmac_f32 v254, v1, v145
    v_fmac_f32 v254, v2, v146
    v_fmac_f32 v254, v3, v147
    v_fmac_f32 v254, v4, v148
    v_fmac_f32 v254, v5, v149
    v_mfma_f32_32x32x16_bf16 v[40:55], v[76:79], v[180:183], v[40:55]
    v_fmac_f32 v254, v6, v150
    v_fmac_f32 v254, v7, v151
    v_fma_f32 v202, v8, -v160, v202
    v_fma_f32 v202, v9, -v161, v202
    v_permlane32_swap_b32 v254, v200
    v_fma_f32 v202, v10, -v162, v202
    v_fma_f32 v202, v11, -v163, v202
    v_fma_f32 v202, v12, -v164, v202
    v_fma_f32 v202, v13, -v165, v202
    v_fma_f32 v202, v14, -v166, v202
    v_fma_f32 v202, v15, -v167, v202
    v_add_f32 v200, v254, v200
    v_fma_f32 v198, v64, -v112, v198
    v_permlane32_swap_b32 v202, v254
    v_fma_f32 v198, v65, -v113, v198
    v_fma_f32 v198, v66, -v114, v198
    v_fma_f32 v198, v67, -v115, v198
    v_fma_f32 v198, v68, -v116, v198
    v_mfma_f32_32x32x16_bf16 v[16:31], v[80:83], v[184:187], v[16:31]
    v_fma_f32 v198, v69, -v117, v198
    v_fma_f32 v198, v70, -v118, v198
    v_fma_f32 v198, v71, -v119, v198
    v_add_f32 v254, v202, v254
    v_mul_f32 v196, v56, v160
    v_fmac_f32 v196, v57, v161
    v_mfma_f32_32x32x16_bf16 v[40:55], v[84:87], v[184:187], v[40:55]
    s_waitcnt vmcnt(6)
    ds_read_b64_tr_b16 v[176:177], v244 offset:0
    ds_read_b64_tr_b16 v[178:179], v244 offset:1024
    ds_read_b64_tr_b16 v[180:181], v245 offset:0
    ds_read_b64_tr_b16 v[182:183], v245 offset:1024
    v_fmac_f32 v196, v58, v162
    v_fmac_f32 v196, v59, v163
    v_mfma_f32_32x32x16_bf16 v[16:31], v[88:91], v[188:191], v[16:31]
    v_fmac_f32 v196, v60, v164
    v_fmac_f32 v196, v61, v165
    v_fmac_f32 v196, v62, v166
    v_fmac_f32 v196, v63, v167
    s_nop 1
    v_permlane32_swap_b32 v198, v196
    v_add_f32 v196, v198, v196
    v_mfma_f32_32x32x16_bf16 v[40:55], v[92:95], v[188:191], v[40:55]
    v_add_u32 v249, s48, v249
    v_add_u32 v250, s49, v250
    ds_read_b32 v252, v251 offset:16
    ds_read_b64_tr_b16 v[72:73], v249 offset:0
    ds_read_b64_tr_b16 v[76:77], v249 offset:64
    ds_read_b64_tr_b16 v[74:75], v249 offset:256
    ds_read_b64_tr_b16 v[78:79], v249 offset:320
    s_mov_b64 exec, s[54:55]
    ds_read_u16_d16_hi v242, v250 offset:0
    s_mov_b64 exec, -1
    s_cbranch_vccnz LEPI_0
    v_mul_f32 v255, v16, v152
    v_fmac_f32 v255, v17, v153
    v_fmac_f32 v255, v18, v154
    v_fmac_f32 v255, v19, v155
    v_fmac_f32 v255, v20, v156
    v_fmac_f32 v255, v21, v157
    v_fmac_f32 v255, v22, v158
    v_fmac_f32 v255, v23, v159
    v_fma_f32 v203, v24, -v168, v203
    v_fma_f32 v203, v25, -v169, v203
    v_permlane32_swap_b32 v255, v201
    v_fma_f32 v203, v26, -v170, v203
    v_fma_f32 v203, v27, -v171, v203
    v_fma_f32 v203, v28, -v172, v203
    v_fma_f32 v203, v29, -v173, v203
    v_fma_f32 v203, v30, -v174, v203
    v_fma_f32 v203, v31, -v175, v203
    v_add_f32 v201, v255, v201
    v_fma_f32 v199, v48, -v120, v199
    v_permlane32_swap_b32 v203, v255
    v_fma_f32 v199, v49, -v121, v199
    v_fma_f32 v199, v50, -v122, v199
    v_fma_f32 v199, v51, -v123, v199
    v_fma_f32 v199, v52, -v124, v199
    v_fma_f32 v199, v53, -v125, v199
    v_fma_f32 v199, v54, -v126, v199
    v_fma_f32 v199, v55, -v127, v199
    v_add_f32 v255, v203, v255
    v_mul_f32 v197, v40, v168
    v_fmac_f32 v197, v41, v169
    v_fmac_f32 v197, v42, v170
    v_fmac_f32 v197, v43, v171
    v_fmac_f32 v197, v44, v172
    v_fmac_f32 v197, v45, v173
    v_fmac_f32 v197, v46, v174
    v_fmac_f32 v197, v47, v175
    s_nop 1
    v_permlane32_swap_b32 v199, v197
    v_add_f32 v197, v199, v197
    v_cvt_pk_bf16_f32 v200, v200, v201
    v_cvt_pk_bf16_f32 v254, v254, v255
    v_cvt_pk_bf16_f32 v196, v196, v197
    ds_write2st64_b32 v253, v192, v193 offset0:0 offset1:1
    ds_write2st64_b32 v253, v194, v200 offset0:2 offset1:3
    ds_write_b32 v253, v196 offset:1024
    s_mov_b64 exec, 0xffffffff
    ds_write_b32 v253, v254 offset:1280
    s_mov_b64 exec, -1
    s_add_u32 s50, s50, 1
    s_cmp_ge_u32 s50, 4
    s_cbranch_scc1 LAST1
    s_waitcnt lgkmcnt(9)
    v_readfirstlane_b32 s66, v252
    s_add_u32 s53, s53, 1
    v_mov_b32 v252, s53
    s_cmp_le_u32 s53, s66
    ds_write2_b32 v251, v252, v252 offset0:0 offset1:8
    s_setprio 1
    s_cbranch_scc1 PRIO_14
    s_setprio 0
PRIO_14:
    s_cmp_eq_u32 s52, 4
    s_cbranch_scc1 ITEM_1_4
    s_cmp_eq_u32 s52, 5
    s_cbranch_scc1 ITEM_1_5
    s_cmp_eq_u32 s52, 3
    s_cbranch_scc1 ITEM_1_3
    s_cmp_eq_u32 s52, 6
    s_cbranch_scc1 ITEM_1_6
    s_cmp_eq_u32 s52, 8
    s_cbranch_scc1 ITEM_1_8
    s_branch ITEM_1_2
WL_6_0:
    s_add_u32 s66, s51, 0
    buffer_load_dwordx4 v[96:99], v246, s[16:19], s66 offen offset:2048 sc1
    buffer_load_dwordx4 v[100:103], v246, s[16:19], s66 offen offset:3072 sc1
    s_branch WR_6_0
WL_6_1:
    s_add_u32 s66, s51, 4096
    buffer_load_dwordx4 v[104:107], v246, s[16:19], s66 offen offset:2048 sc1
    buffer_load_dwordx4 v[108:111], v246, s[16:19], s66 offen offset:3072 sc1
    s_branch WR_6_1
WL_6_2:
    s_add_u32 s66, s51, 8192
    buffer_load_dwordx4 v[128:131], v246, s[16:19], s66 offen offset:2048 sc1
    buffer_load_dwordx4 v[132:135], v246, s[16:19], s66 offen offset:3072 sc1
    s_branch WR_6_2
WL_6_3:
    s_add_u32 s66, s51, 12288
    buffer_load_dwordx4 v[136:139], v246, s[16:19], s66 offen offset:2048 sc1
    buffer_load_dwordx4 v[140:143], v246, s[16:19], s66 offen offset:3072 sc1
    s_branch WR_6_3
.p2align 6
ITEM_1_8:
    s_mov_b64 exec, s[54:55]
    ds_read_u16_d16_hi v243, v250 offset:128
    s_mov_b64 exec, -1
    ds_read_b64_tr_b16 v[80:81], v249 offset:512
    ds_read_b64_tr_b16 v[84:85], v249 offset:576
    ds_read_b64_tr_b16 v[82:83], v249 offset:768
    ds_read_b64_tr_b16 v[86:87], v249 offset:832
    ds_read_b64_tr_b16 v[88:89], v249 offset:1024
    ds_read_b64_tr_b16 v[92:93], v249 offset:1088
    ds_read_b64_tr_b16 v[90:91], v249 offset:1280
    ds_read_b64_tr_b16 v[94:95], v249 offset:1344
    ds_read_b64_tr_b16 v[64:65], v249 offset:1536
    ds_read_b64_tr_b16 v[68:69], v249 offset:1600
    ds_read_b64_tr_b16 v[66:67], v249 offset:1792
    ds_read_b64_tr_b16 v[70:71], v249 offset:1856
    s_waitcnt lgkmcnt(13)
    v_mul_f32_dpp v196, v242, v72 row_newbcast:0 row_mask:0xf bank_mask:0xf
    v_mul_f32_dpp v197, v242, v73 row_newbcast:1 row_mask:0xf bank_mask:0xf
    v_mul_f32_dpp v198, v242, v72 row_newbcast:8 row_mask:0xf bank_mask:0xf
    v_mul_f32_dpp v199, v242, v73 row_newbcast:9 row_mask:0xf bank_mask:0xf
    v_mul_f32_dpp v200, v242, v76 row_newbcast:2 row_mask:0xf bank_mask:0xf
    v_mul_f32_dpp v201, v242, v77 row_newbcast:3 row_mask:0xf bank_mask:0xf
    v_mul_f32_dpp v202, v242, v76 row_newbcast:10 row_mask:0xf bank_mask:0xf
    v_mul_f32_dpp v203, v242, v77 row_newbcast:11 row_mask:0xf bank_mask:0xf
    v_cvt_pk_bf16_f32 v72, v196, v197
    v_cvt_pk_bf16_f32 v76, v198, v199
    v_cvt_pk_bf16_f32 v73, v200, v201
    v_cvt_pk_bf16_f32 v77, v202, v203
    v_mul_f32_dpp v196, v242, v74 row_newbcast:4 row_mask:0xf bank_mask:0xf
    v_mul_f32_dpp v197, v242, v75 row_newbcast:5 row_mask:0xf bank_mask:0xf
    v_mul_f32_dpp v198, v242, v74 row_newbcast:12 row_mask:0xf bank_mask:0xf
    v_mul_f32_dpp v199, v242, v75 row_newbcast:13 row_mask:0xf bank_mask:0xf
    v_mul_f32_dpp v200, v242, v78 row_newbcast:6 row_mask:0xf bank_mask:0xf
    v_mul_f32_dpp v201, v242, v79 row_newbcast:7 row_mask:0xf bank_mask:0xf
    v_mul_f32_dpp v202, v242, v78 row_newbcast:14 row_mask:0xf bank_mask:0xf
    v_mul_f32_dpp v203, v242, v79 row_newbcast:15 row_mask:0xf bank_mask:0xf
    v_cvt_pk_bf16_f32 v74, v196, v197
    v_cvt_pk_bf16_f32 v78, v198, v199
    v_cvt_pk_bf16_f32 v75, v200, v201
    v_cvt_pk_bf16_f32 v79, v202, v203
    s_mov_b64 exec, s[54:55]
    ds_read_u16_d16_hi v242, v250 offset:256
    s_mov_b64 exec, -1
    s_waitcnt vmcnt(4) lgkmcnt(9)
    v_mfma_f32_32x32x16_bf16 v[0:15], v[72:75], v[176:179], 0
    v_mul_f32_dpp v196, v243, v80 row_newbcast:0 row_mask:0xf bank_mask:0xf
    v_mul_f32_dpp v197, v243, v81 row_newbcast:1 row_mask:0xf bank_mask:0xf
    v_mul_f32_dpp v198, v243, v80 row_newbcast:8 row_mask:0xf bank_mask:0xf
    v_mul_f32_dpp v199, v243, v81 row_newbcast:9 row_mask:0xf bank_mask:0xf
    v_mul_f32_dpp v200, v243, v84 row_newbcast:2 row_mask:0xf bank_mask:0xf
    v_mul_f32_dpp v201, v243, v85 row_newbcast:3 row_mask:0xf bank_mask:0xf
    s_add_u32 m0, s21, 0
    v_mfma_f32_32x32x16_bf16 v[48:63], v[76:79], v[176:179], 0
    buffer_load_dwordx4 v234, s[4:7], s35 offen  lds
    buffer_load_dwordx4 v235, s[8:11], s35 offen offset:1024  lds
    ds_read_b64_tr_b16 v[176:177], v244 offset:2048
    ds_read_b64_tr_b16 v[178:179], v244 offset:3072
    ds_read_b64_tr_b16 v[184:185], v245 offset:2048
    ds_read_b64_tr_b16 v[186:187], v245 offset:3072
    v_mul_f32_dpp v202, v243, v84 row_newbcast:10 row_mask:0xf bank_mask:0xf
    v_mul_f32_dpp v203, v243, v85 row_newbcast:11 row_mask:0xf bank_mask:0xf
    v_cvt_pk_bf16_f32 v80, v196, v197
    v_cvt_pk_bf16_f32 v84, v198, v199
    v_cvt_pk_bf16_f32 v81, v200, v201
    v_cvt_pk_bf16_f32 v85, v202, v203
    v_mul_f32_dpp v196, v243, v82 row_newbcast:4 row_mask:0xf bank_mask:0xf
    v_mul_f32_dpp v197, v243, v83 row_newbcast:5 row_mask:0xf bank_mask:0xf
    v_mul_f32_dpp v198, v243, v82 row_newbcast:12 row_mask:0xf bank_mask:0xf
    v_mul_f32_dpp v199, v243, v83 row_newbcast:13 row_mask:0xf bank_mask:0xf
    v_mul_f32_dpp v200, v243, v86 row_newbcast:6 row_mask:0xf bank_mask:0xf
    v_mul_f32_dpp v201, v243, v87 row_newbcast:7 row_mask:0xf bank_mask:0xf
    v_mul_f32_dpp v202, v243, v86 row_newbcast:14 row_mask:0xf bank_mask:0xf
    v_mul_f32_dpp v203, v243, v87 row_newbcast:15 row_mask:0xf bank_mask:0xf
    v_cvt_pk_bf16_f32 v82, v196, v197
    v_cvt_pk_bf16_f32 v86, v198, v199
    v_cvt_pk_bf16_f32 v83, v200, v201
    v_cvt_pk_bf16_f32 v87, v202, v203
    s_mov_b64 exec, s[54:55]
    ds_read_u16_d16_hi v243, v250 offset:384
    s_mov_b64 exec, -1
    s_waitcnt vmcnt(4) lgkmcnt(1)
    v_mfma_f32_32x32x16_bf16 v[0:15], v[80:83], v[176:179], v[0:15]
    v_mul_f32_dpp v196, v242, v88 row_newbcast:0 row_mask:0xf bank_mask:0xf
    v_mul_f32_dpp v197, v242, v89 row_newbcast:1 row_mask:0xf bank_mask:0xf
    v_mul_f32_dpp v198, v242, v88 row_newbcast:8 row_mask:0xf bank_mask:0xf
    v_mul_f32_dpp v199, v242, v89 row_newbcast:9 row_mask:0xf bank_mask:0xf
    v_mul_f32_dpp v200, v242, v92 row_newbcast:2 row_mask:0xf bank_mask:0xf
    v_mul_f32_dpp v201, v242, v93 row_newbcast:3 row_mask:0xf bank_mask:0xf
    s_add_u32 m0, s21, 2048
    v_mfma_f32_32x32x16_bf16 v[48:63], v[84:87], v[176:179], v[48:63]
    buffer_load_dwordx4 v236, s[4:7], s35 offen  lds
    buffer_load_dwordx4 v237, s[8:11], s35 offen offset:1024  lds
    ds_read_b64_tr_b16 v[176:177], v244 offset:4096
    ds_read_b64_tr_b16 v[178:179], v244 offset:5120
    ds_read_b64_tr_b16 v[188:189], v245 offset:4096
    ds_read_b64_tr_b16 v[190:191], v245 offset:5120
    v_mul_f32_dpp v202, v242, v92 row_newbcast:10 row_mask:0xf bank_mask:0xf
    v_mul_f32_dpp v203, v242, v93 row_newbcast:11 row_mask:0xf bank_mask:0xf
    v_cvt_pk_bf16_f32 v88, v196, v197
    v_cvt_pk_bf16_f32 v92, v198, v199
    v_cvt_pk_bf16_f32 v89, v200, v201
    v_cvt_pk_bf16_f32 v93, v202, v203
    v_mul_f32_dpp v196, v242, v90 row_newbcast:4 row_mask:0xf bank_mask:0xf
    v_mul_f32_dpp v197, v242, v91 row_newbcast:5 row_mask:0xf bank_mask:0xf
    v_mul_f32_dpp v198, v242, v90 row_newbcast:12 row_mask:0xf bank_mask:0xf
    v_mul_f32_dpp v199, v242, v91 row_newbcast:13 row_mask:0xf bank_mask:0xf
    v_mul_f32_dpp v200, v242, v94 row_newbcast:6 row_mask:0xf bank_mask:0xf
    v_mul_f32_dpp v201, v242, v95 row_newbcast:7 row_mask:0xf bank_mask:0xf
    v_mul_f32_dpp v202, v242, v94 row_newbcast:14 row_mask:0xf bank_mask:0xf
    v_mul_f32_dpp v203, v242, v95 row_newbcast:15 row_mask:0xf bank_mask:0xf
    v_cvt_pk_bf16_f32 v90, v196, v197
    v_cvt_pk_bf16_f32 v94, v198, v199
    v_cvt_pk_bf16_f32 v91, v200, v201
    v_cvt_pk_bf16_f32 v95, v202, v203
    s_waitcnt vmcnt(4) lgkmcnt(0)
    v_mfma_f32_32x32x16_bf16 v[0:15], v[88:91], v[176:179], v[0:15]
    v_mul_f32_dpp v196, v243, v64 row_newbcast:0 row_mask:0xf bank_mask:0xf
    v_mul_f32_dpp v197, v243, v65 row_newbcast:1 row_mask:0xf bank_mask:0xf
    v_mul_f32_dpp v198, v243, v64 row_newbcast:8 row_mask:0xf bank_mask:0xf
    v_mul_f32_dpp v199, v243, v65 row_newbcast:9 row_mask:0xf bank_mask:0xf
    v_mul_f32_dpp v200, v243, v68 row_newbcast:2 row_mask:0xf bank_mask:0xf
    v_mul_f32_dpp v201, v243, v69 row_newbcast:3 row_mask:0xf bank_mask:0xf
    s_add_u32 m0, s21, 4096
    v_mfma_f32_32x32x16_bf16 v[48:63], v[92:95], v[176:179], v[48:63]
    buffer_load_dwordx4 v238, s[4:7], s35 offen  lds
    buffer_load_dwordx4 v239, s[8:11], s35 offen offset:1024  lds
    ds_read_b64_tr_b16 v[176:177], v244 offset:6144
    ds_read_b64_tr_b16 v[178:179], v244 offset:7168
    ds_read_b64_tr_b16 v[192:193], v245 offset:6144
    ds_read_b64_tr_b16 v[194:195], v245 offset:7168
    v_mul_f32_dpp v202, v243, v68 row_newbcast:10 row_mask:0xf bank_mask:0xf
    v_mul_f32_dpp v203, v243, v69 row_newbcast:11 row_mask:0xf bank_mask:0xf
    v_cvt_pk_bf16_f32 v64, v196, v197
    v_cvt_pk_bf16_f32 v68, v198, v199
    v_cvt_pk_bf16_f32 v65, v200, v201
    v_cvt_pk_bf16_f32 v69, v202, v203
    v_mul_f32_dpp v196, v243, v66 row_newbcast:4 row_mask:0xf bank_mask:0xf
    v_mul_f32_dpp v197, v243, v67 row_newbcast:5 row_mask:0xf bank_mask:0xf
    v_mul_f32_dpp v198, v243, v66 row_newbcast:12 row_mask:0xf bank_mask:0xf
    v_mul_f32_dpp v199, v243, v67 row_newbcast:13 row_mask:0xf bank_mask:0xf
    v_mul_f32_dpp v200, v243, v70 row_newbcast:6 row_mask:0xf bank_mask:0xf
    v_mul_f32_dpp v201, v243, v71 row_newbcast:7 row_mask:0xf bank_mask:0xf
    v_mul_f32_dpp v202, v243, v70 row_newbcast:14 row_mask:0xf bank_mask:0xf
    v_mul_f32_dpp v203, v243, v71 row_newbcast:15 row_mask:0xf bank_mask:0xf
    v_cvt_pk_bf16_f32 v66, v196, v197
    v_cvt_pk_bf16_f32 v70, v198, v199
    v_cvt_pk_bf16_f32 v67, v200, v201
    v_cvt_pk_bf16_f32 v71, v202, v203
    s_waitcnt lgkmcnt(0)
    v_mfma_f32_32x32x16_bf16 v[0:15], v[64:67], v[176:179], v[0:15]
    s_add_u32 m0, s21, 6144
    v_mfma_f32_32x32x16_bf16 v[48:63], v[68:71], v[176:179], v[48:63]
    buffer_load_dwordx4 v240, s[4:7], s35 offen  lds
    buffer_load_dwordx4 v241, s[8:11], s35 offen offset:1024  lds
    s_mov_b32 m0, s50
    s_nop 0
    s_movrels_b32 s71, s23
    s_movrels_b32 s33, s28
    v_add_u32 v253, s33, v248
    s_bfe_u32 s46, s71, 0x30012
    s_mov_b32 m0, s46
    s_and_b32 s66, s71, 0x3ffff
    s_movrels_b32 s68, s57
    s_movrels_b32 s69, s61
    s_sub_u32 s48, s66, s47
    s_mov_b32 s47, s66
    s_lshr_b32 s52, s71, 28
    s_lshl_b32 s67, s46, 9
    s_add_u32 s66, s66, s67
    s_sub_u32 s49, s66, s42
    s_mov_b32 s42, s66
    s_bfe_u32 s66, s68, 655360
    s_add_u32 s43, s42, s66
    s_bfe_u32 s39, s69, 655360
    s_bfe_u32 s66, s68, 655370
    s_add_u32 s44, s42, s66
    s_bfe_u32 s40, s69, 655370
    s_bfe_u32 s66, s68, 655380
    s_add_u32 s45, s42, s66
    s_bfe_u32 s41, s69, 655380
    v_mfma_f32_32x32x16_bf16 v[16:31], v[72:75], v[180:183], 0
    v_mul_f32 v196, v0, v96
    v_fmac_f32 v196, v1, v97
    v_fmac_f32 v196, v2, v98
    v_fmac_f32 v196, v3, v99
    v_fmac_f32 v196, v4, v100
    v_fmac_f32 v196, v5, v101
    v_mfma_f32_32x32x16_bf16 v[32:47], v[76:79], v[180:183], 0
    v_mfma_f32_32x32x16_bf16 v[16:31], v[80:83], v[184:187], v[16:31]
    v_fmac_f32 v196, v6, v102
    v_fmac_f32 v196, v7, v103
    v_mul_f32 v198, v8, v128
    v_fmac_f32 v198, v9, v129
    v_mfma_f32_32x32x16_bf16 v[32:47], v[84:87], v[184:187], v[32:47]
    v_fmac_f32 v198, v10, v130
    v_fmac_f32 v198, v11, v131
    v_fmac_f32 v198, v12, v132
    v_fmac_f32 v198, v13, v133
    v_fmac_f32 v198, v14, v134
    v_fmac_f32 v198, v15, v135
    v_mfma_f32_32x32x16_bf16 v[16:31], v[88:91], v[188:191], v[16:31]
    v_mul_f32 v200, v48, v128
    v_fmac_f32 v200, v49, v129
    v_permlane32_swap_b32 v196, v198
    v_fmac_f32 v200, v50, v130
    v_fmac_f32 v200, v51, v131
    v_fmac_f32 v200, v52, v132
    v_mfma_f32_32x32x16_bf16 v[32:47], v[92:95], v[188:191], v[32:47]
    s_waitcnt vmcnt(6)
    ds_read_b64_tr_b16 v[176:177], v244 offset:0
    ds_read_b64_tr_b16 v[178:179], v244 offset:1024
    ds_read_b64_tr_b16 v[180:181], v245 offset:0
    ds_read_b64_tr_b16 v[182:183], v245 offset:1024
    v_fmac_f32 v200, v53, v133
    v_fmac_f32 v200, v54, v134
    v_mfma_f32_32x32x16_bf16 v[16:31], v[64:67], v[192:195], v[16:31]
    v_fmac_f32 v200, v55, v135
    v_add_f32 v198, v196, v198
    v_mul_f32_e64 v202, v56, -v128
    v_fma_f32 v202, v57, -v129, v202
    v_fma_f32 v202, v58, -v130, v202
    v_fma_f32 v202, v59, -v131, v202
    v_mfma_f32_32x32x16_bf16 v[32:47], v[68:71], v[192:195], v[32:47]
    v_fma_f32 v202, v60, -v132, v202
    v_fma_f32 v202, v61, -v133, v202
    v_fma_f32 v202, v62, -v134, v202
    v_fma_f32 v202, v63, -v135, v202
    s_nop 1
    v_permlane32_swap_b32 v200, v202
    v_add_f32 v202, v200, v202
    s_waitcnt vmcnt(4) lgkmcnt(0)
    v_mfma_f32_32x32x16_bf16 v[0:15], v[72:75], v[176:179], 0
    v_mul_f32 v197, v16, v104
    v_fmac_f32 v197, v17, v105
    v_fmac_f32 v197, v18, v106
    v_fmac_f32 v197, v19, v107
    v_fmac_f32 v197, v20, v108
    v_fmac_f32 v197, v21, v109
    s_add_u32 m0, s21, 0
    v_mfma_f32_32x32x16_bf16 v[48:63], v[76:79], v[176:179], 0
    buffer_load_dwordx4 v234, s[4:7], s36 offen  lds
    buffer_load_dwordx4 v235, s[8:11], s36 offen offset:1024  lds
    ds_read_b64_tr_b16 v[176:177], v244 offset:2048
    ds_read_b64_tr_b16 v[178:179], v244 offset:3072
    ds_read_b64_tr_b16 v[184:185], v245 offset:2048
    ds_read_b64_tr_b16 v[186:187], v245 offset:3072
    v_fmac_f32 v197, v22, v110
    v_fmac_f32 v197, v23, v111
    v_mul_f32 v199, v24, v136
    v_fmac_f32 v199, v25, v137
    v_fmac_f32 v199, v26, v138
    v_fmac_f32 v199, v27, v139
    v_fmac_f32 v199, v28, v140
    v_fmac_f32 v199, v29, v141
    v_fmac_f32 v199, v30, v142
    v_fmac_f32 v199, v31, v143
    v_mul_f32 v201, v32, v136
    s_waitcnt vmcnt(4) lgkmcnt(0)
    v_mfma_f32_32x32x16_bf16 v[0:15], v[80:83], v[176:179], v[0:15]
    v_fmac_f32 v201, v33, v137
    v_permlane32_swap_b32 v197, v199
    v_fmac_f32 v201, v34, v138
    v_fmac_f32 v201, v35, v139
    v_fmac_f32 v201, v36, v140
    v_fmac_f32 v201, v37, v141
    s_add_u32 m0, s21, 2048
    v_mfma_f32_32x32x16_bf16 v[48:63], v[84:87], v[176:179], v[48:63]
    buffer_load_dwordx4 v236, s[4:7], s36 offen  lds
    buffer_load_dwordx4 v237, s[8:11], s36 offen offset:1024  lds
    ds_read_b64_tr_b16 v[176:177], v244 offset:4096
    ds_read_b64_tr_b16 v[178:179], v244 offset:5120
    ds_read_b64_tr_b16 v[188:189], v245 offset:4096
    ds_read_b64_tr_b16 v[190:191], v245 offset:5120
    s_waitcnt vmcnt(4) lgkmcnt(0)
    v_mfma_f32_32x32x16_bf16 v[0:15], v[88:91], v[176:179], v[0:15]
    v_fmac_f32 v201, v38, v142
    v_fmac_f32 v201, v39, v143
    v_add_f32 v199, v197, v199
    v_mul_f32_e64 v203, v40, -v136
    v_fma_f32 v203, v41, -v137, v203
    v_fma_f32 v203, v42, -v138, v203
    s_add_u32 m0, s21, 4096
    v_mfma_f32_32x32x16_bf16 v[48:63], v[92:95], v[176:179], v[48:63]
    buffer_load_dwordx4 v238, s[4:7], s36 offen  lds
    buffer_load_dwordx4 v239, s[8:11], s36 offen offset:1024  lds
    ds_read_b64_tr_b16 v[176:177], v244 offset:6144
    ds_read_b64_tr_b16 v[178:179], v244 offset:7168
    ds_read_b64_tr_b16 v[192:193], v245 offset:6144
    ds_read_b64_tr_b16 v[194:195], v245 offset:7168
    s_waitcnt lgkmcnt(0)
    v_mfma_f32_32x32x16_bf16 v[0:15], v[64:67], v[176:179], v[0:15]
    v_fma_f32 v203, v43, -v139, v203
    v_fma_f32 v203, v44, -v140, v203
    v_fma_f32 v203, v45, -v141, v203
    v_fma_f32 v203, v46, -v142, v203
    v_fma_f32 v203, v47, -v143, v203
    s_nop 1
    v_permlane32_swap_b32 v201, v203
    s_add_u32 m0, s21, 6144
    v_mfma_f32_32x32x16_bf16 v[48:63], v[68:71], v[176:179], v[48:63]
    buffer_load_dwordx4 v240, s[4:7], s36 offen  lds
    buffer_load_dwordx4 v241, s[8:11], s36 offen offset:1024  lds
    v_add_f32 v203, v201, v203
    v_cvt_pk_bf16_f32 v198, v198, v199
    v_cvt_pk_bf16_f32 v202, v202, v203
    ds_write2st64_b32 v253, v198, v202 offset0:0 offset1:1
    v_mfma_f32_32x32x16_bf16 v[16:31], v[72:75], v[180:183], 0
    v_mul_f32 v196, v0, v144
    v_fmac_f32 v196, v1, v145
    v_fmac_f32 v196, v2, v146
    v_fmac_f32 v196, v3, v147
    v_fmac_f32 v196, v4, v148
    v_fmac_f32 v196, v5, v149
    v_mfma_f32_32x32x16_bf16 v[32:47], v[76:79], v[180:183], 0
    v_mfma_f32_32x32x16_bf16 v[16:31], v[80:83], v[184:187], v[16:31]
    v_mfma_f32_32x32x16_bf16 v[32:47], v[84:87], v[184:187], v[32:47]
    v_fmac_f32 v196, v6, v150
    v_fmac_f32 v196, v7, v151
    v_mul_f32 v198, v8, v112
    v_fmac_f32 v198, v9, v113
    v_fmac_f32 v198, v10, v114
    v_fmac_f32 v198, v11, v115
    v_mfma_f32_32x32x16_bf16 v[16:31], v[88:91], v[188:191], v[16:31]
    v_fmac_f32 v198, v12, v116
    v_fmac_f32 v198, v13, v117
    v_fmac_f32 v198, v14, v118
    v_fmac_f32 v198, v15, v119
    v_mul_f32_e64 v200, v48, -v160
    v_fma_f32 v200, v49, -v161, v200
    v_mfma_f32_32x32x16_bf16 v[32:47], v[92:95], v[188:191], v[32:47]
    s_waitcnt vmcnt(6)
    ds_read_b64_tr_b16 v[176:177], v244 offset:0
    ds_read_b64_tr_b16 v[178:179], v244 offset:1024
    ds_read_b64_tr_b16 v[180:181], v245 offset:0
    ds_read_b64_tr_b16 v[182:183], v245 offset:1024
    v_fma_f32 v200, v50, -v162, v200
    v_fma_f32 v200, v51, -v163, v200
    v_mfma_f32_32x32x16_bf16 v[16:31], v[64:67], v[192:195], v[16:31]
    v_fma_f32 v200, v52, -v164, v200
    v_fma_f32 v200, v53, -v165, v200
    v_fma_f32 v200, v54, -v166, v200
    v_fma_f32 v200, v55, -v167, v200
    v_mul_f32_e64 v202, v56, -v160
    v_fma_f32 v202, v57, -v161, v202
    v_mfma_f32_32x32x16_bf16 v[32:47], v[68:71], v[192:195], v[32:47]
    v_fma_f32 v202, v58, -v162, v202
    v_fma_f32 v202, v59, -v163, v202
    v_fma_f32 v202, v60, -v164, v202
    v_fma_f32 v202, v61, -v165, v202
    v_fma_f32 v202, v62, -v166, v202
    v_fma_f32 v202, v63, -v167, v202
    s_waitcnt vmcnt(4) lgkmcnt(0)
    v_mfma_f32_32x32x16_bf16 v[0:15], v[72:75], v[176:179], 0
    v_mul_f32 v197, v16, v152
    v_fmac_f32 v197, v17, v153
    v_fmac_f32 v197, v18, v154
    v_fmac_f32 v197, v19, v155
    v_fmac_f32 v197, v20, v156
    v_fmac_f32 v197, v21, v157
    s_add_u32 m0, s21, 0
    v_mfma_f32_32x32x16_bf16 v[48:63], v[76:79], v[176:179], 0
    buffer_load_dwordx4 v234, s[4:7], s37 offen  lds
    buffer_load_dwordx4 v235, s[8:11], s37 offen offset:1024  lds
    ds_read_b64_tr_b16 v[176:177], v244 offset:2048
    ds_read_b64_tr_b16 v[178:179], v244 offset:3072
    ds_read_b64_tr_b16 v[184:185], v245 offset:2048
    ds_read_b64_tr_b16 v[186:187], v245 offset:3072
    v_add_u32 v252, s42, v247
    ds_read2_b32 v[234:235], v252 offset0:0 offset1:16
    v_fmac_f32 v197, v22, v158
    v_fmac_f32 v197, v23, v159
    v_mul_f32 v199, v24, v120
    v_fmac_f32 v199, v25, v121
    v_fmac_f32 v199, v26, v122
    v_fmac_f32 v199, v27, v123
    s_waitcnt vmcnt(4) lgkmcnt(1)
    v_mfma_f32_32x32x16_bf16 v[0:15], v[80:83], v[176:179], v[0:15]
    v_fmac_f32 v199, v28, v124
    v_fmac_f32 v199, v29, v125
    v_fmac_f32 v199, v30, v126
    v_fmac_f32 v199, v31, v127
    v_mul_f32_e64 v201, v32, -v168
    v_fma_f32 v201, v33, -v169, v201
    s_add_u32 m0, s21, 2048
    v_mfma_f32_32x32x16_bf16 v[48:63], v[84:87], v[176:179], v[48:63]
    buffer_load_dwordx4 v236, s[4:7], s37 offen  lds
    buffer_load_dwordx4 v237, s[8:11], s37 offen offset:1024  lds
    ds_read_b64_tr_b16 v[176:177], v244 offset:4096
    ds_read_b64_tr_b16 v[178:179], v244 offset:5120
    ds_read_b64_tr_b16 v[188:189], v245 offset:4096
    ds_read_b64_tr_b16 v[190:191], v245 offset:5120
    v_add_u32 v252, s43, v247
    ds_read2_b32 v[236:237], v252 offset0:0 offset1:16
    s_waitcnt vmcnt(4) lgkmcnt(1)
    v_mfma_f32_32x32x16_bf16 v[0:15], v[88:91], v[176:179], v[0:15]
    v_fma_f32 v201, v34, -v170, v201
    v_fma_f32 v201, v35, -v171, v201
    v_fma_f32 v201, v36, -v172, v201
    v_fma_f32 v201, v37, -v173, v201
    v_fma_f32 v201, v38, -v174, v201
    v_fma_f32 v201, v39, -v175, v201
    s_add_u32 m0, s21, 4096
    v_mfma_f32_32x32x16_bf16 v[48:63], v[92:95], v[176:179], v[48:63]
    buffer_load_dwordx4 v238, s[4:7], s37 offen  lds
    buffer_load_dwordx4 v239, s[8:11], s37 offen offset:1024  lds
    ds_read_b64_tr_b16 v[176:177], v244 offset:6144
    ds_read_b64_tr_b16 v[178:179], v244 offset:7168
    ds_read_b64_tr_b16 v[192:193], v245 offset:6144
    ds_read_b64_tr_b16 v[194:195], v245 offset:7168
    v_add_u32 v252, s44, v247
    ds_read2_b32 v[238:239], v252 offset0:0 offset1:16
    s_waitcnt lgkmcnt(1)
    v_mfma_f32_32x32x16_bf16 v[0:15], v[64:67], v[176:179], v[0:15]
    v_mul_f32_e64 v203, v40, -v168
    v_fma_f32 v203, v41, -v169, v203
    v_fma_f32 v203, v42, -v170, v203
    v_fma_f32 v203, v43, -v171, v203
    v_fma_f32 v203, v44, -v172, v203
    v_fma_f32 v203, v45, -v173, v203
    s_add_u32 m0, s21, 6144
    v_mfma_f32_32x32x16_bf16 v[48:63], v[68:71], v[176:179], v[48:63]
    buffer_load_dwordx4 v240, s[4:7], s37 offen  lds
    buffer_load_dwordx4 v241, s[8:11], s37 offen offset:1024  lds
    v_add_u32 v252, s45, v247
    ds_read2_b32 v[240:241], v252 offset0:0 offset1:16
    v_fma_f32 v203, v46, -v174, v203
    v_fma_f32 v203, v47, -v175, v203
    v_mfma_f32_32x32x16_bf16 v[16:31], v[72:75], v[180:183], 0
    v_mul_f32 v254, v0, v144
    v_fmac_f32 v254, v1, v145
    v_fmac_f32 v254, v2, v146
    v_fmac_f32 v254, v3, v147
    v_fmac_f32 v254, v4, v148
    v_fmac_f32 v254, v5, v149
    v_mfma_f32_32x32x16_bf16 v[32:47], v[76:79], v[180:183], 0
    ds_swizzle_b32 v76, v76 offset:0x401F
    ds_swizzle_b32 v77, v77 offset:0x401F
    ds_swizzle_b32 v78, v78 offset:0x401F
    ds_swizzle_b32 v79, v79 offset:0x401F
    v_mfma_f32_32x32x16_bf16 v[16:31], v[80:83], v[184:187], v[16:31]
    v_mfma_f32_32x32x16_bf16 v[32:47], v[84:87], v[184:187], v[32:47]
    ds_swizzle_b32 v84, v84 offset:0x401F
    ds_swizzle_b32 v85, v85 offset:0x401F
    ds_swizzle_b32 v86, v86 offset:0x401F
    ds_swizzle_b32 v87, v87 offset:0x401F
    v_mfma_f32_32x32x16_bf16 v[16:31], v[88:91], v[188:191], v[16:31]
    v_fmac_f32 v254, v6, v150
    v_fmac_f32 v254, v7, v151
    v_fmac_f32 v200, v8, v160
    v_fmac_f32 v200, v9, v161
    v_mfma_f32_32x32x16_bf16 v[32:47], v[92:95], v[188:191], v[32:47]
    ds_swizzle_b32 v92, v92 offset:0x401F
    ds_swizzle_b32 v93, v93 offset:0x401F
    ds_swizzle_b32 v94, v94 offset:0x401F
    ds_swizzle_b32 v95, v95 offset:0x401F
    s_waitcnt vmcnt(6)
    ds_read_b64_tr_b16 v[176:177], v244 offset:0
    ds_read_b64_tr_b16 v[178:179], v244 offset:1024
    ds_read_b64_tr_b16 v[180:181], v245 offset:0
    ds_read_b64_tr_b16 v[182:183], v245 offset:1024
    v_mfma_f32_32x32x16_bf16 v[16:31], v[64:67], v[192:195], v[16:31]
    v_permlane32_swap_b32 v196, v254
    v_fmac_f32 v200, v10, v162
    v_fmac_f32 v200, v11, v163
    v_fmac_f32 v200, v12, v164
    v_fmac_f32 v200, v13, v165
    v_fmac_f32 v200, v14, v166
    v_mfma_f32_32x32x16_bf16 v[32:47], v[68:71], v[192:195], v[32:47]
    ds_swizzle_b32 v68, v68 offset:0x401F
    ds_swizzle_b32 v69, v69 offset:0x401F
    ds_swizzle_b32 v70, v70 offset:0x401F
    ds_swizzle_b32 v71, v71 offset:0x401F
    v_fmac_f32 v200, v15, v167
    v_add_f32 v254, v196, v254
    s_waitcnt lgkmcnt(8)
    s_mov_b64 exec, s[56:57]
    v_xor_b32 v76, 0x80008000, v76
    v_xor_b32 v77, 0x80008000, v77
    v_xor_b32 v78, 0x80008000, v78
    v_xor_b32 v79, 0x80008000, v79
    v_xor_b32 v84, 0x80008000, v84
    v_xor_b32 v85, 0x80008000, v85
    v_xor_b32 v86, 0x80008000, v86
    v_xor_b32 v87, 0x80008000, v87
    v_xor_b32 v92, 0x80008000, v92
    v_xor_b32 v93, 0x80008000, v93
    v_xor_b32 v94, 0x80008000, v94
    v_xor_b32 v95, 0x80008000, v95
    s_mov_b64 exec, -1
    s_waitcnt vmcnt(4) lgkmcnt(4)
    v_mfma_f32_32x32x16_bf16 v[0:15], v[72:75], v[176:179], 0
    v_mul_f32 v255, v16, v152
    v_fmac_f32 v255, v17, v153
    v_fmac_f32 v255, v18, v154
    v_fmac_f32 v255, v19, v155
    v_fmac_f32 v255, v20, v156
    v_fmac_f32 v255, v21, v157
    s_add_u32 m0, s21, 0
    v_mfma_f32_32x32x16_bf16 v[48:63], v[76:79], v[176:179], v[48:63]
    s_cbranch_vccnz WL_8_0
    v_mad_u32_u16 v234, v234, s3, v246 op_sel:[1,0,0,0]
    v_mad_u32_u16 v235, v235, s3, v246 op_sel:[1,0,0,0]
    buffer_load_dwordx4 v234, s[4:7], s38 offen  lds
    buffer_load_dwordx4 v235, s[8:11], s38 offen offset:1024  lds
WR_8_0:
    ds_read_b64_tr_b16 v[176:177], v244 offset:2048
    ds_read_b64_tr_b16 v[178:179], v244 offset:3072
    ds_read_b64_tr_b16 v[184:185], v245 offset:2048
    ds_read_b64_tr_b16 v[186:187], v245 offset:3072
    s_waitcnt vmcnt(4) lgkmcnt(0)
    v_mfma_f32_32x32x16_bf16 v[0:15], v[80:83], v[176:179], v[0:15]
    s_add_u32 m0, s21, 2048
    v_mfma_f32_32x32x16_bf16 v[48:63], v[84:87], v[176:179], v[48:63]
    s_cbranch_vccnz WL_8_1
    v_mad_u32_u16 v236, v236, s3, v246 op_sel:[1,0,0,0]
    v_mad_u32_u16 v237, v237, s3, v246 op_sel:[1,0,0,0]
    buffer_load_dwordx4 v236, s[4:7], s39 offen  lds
    buffer_load_dwordx4 v237, s[8:11], s39 offen offset:1024  lds
WR_8_1:
    ds_read_b64_tr_b16 v[176:177], v244 offset:4096
    ds_read_b64_tr_b16 v[178:179], v244 offset:5120
    ds_read_b64_tr_b16 v[188:189], v245 offset:4096
    ds_read_b64_tr_b16 v[190:191], v245 offset:5120
    s_waitcnt vmcnt(4) lgkmcnt(0)
    v_mfma_f32_32x32x16_bf16 v[0:15], v[88:91], v[176:179], v[0:15]
    v_fmac_f32 v255, v22, v158
    v_fmac_f32 v255, v23, v159
    v_fmac_f32 v201, v24, v168
    v_fmac_f32 v201, v25, v169
    v_permlane32_swap_b32 v197, v255
    v_fmac_f32 v201, v26, v170
    s_add_u32 m0, s21, 4096
    v_mfma_f32_32x32x16_bf16 v[48:63], v[92:95], v[176:179], v[48:63]
    s_cbranch_vccnz WL_8_2
    v_mad_u32_u16 v238, v238, s3, v246 op_sel:[1,0,0,0]
    v_mad_u32_u16 v239, v239, s3, v246 op_sel:[1,0,0,0]
    buffer_load_dwordx4 v238, s[4:7], s40 offen  lds
    buffer_load_dwordx4 v239, s[8:11], s40 offen offset:1024  lds
WR_8_2:
    ds_read_b64_tr_b16 v[176:177], v244 offset:6144
    ds_read_b64_tr_b16 v[178:179], v244 offset:7168
    ds_read_b64_tr_b16 v[192:193], v245 offset:6144
    ds_read_b64_tr_b16 v[194:195], v245 offset:7168
    s_waitcnt lgkmcnt(0)
    s_mov_b64 exec, s[56:57]
    v_xor_b32 v68, 0x80008000, v68
    v_xor_b32 v69, 0x80008000, v69
    v_xor_b32 v70, 0x80008000, v70
    v_xor_b32 v71, 0x80008000, v71
    s_mov_b64 exec, -1
    v_mfma_f32_32x32x16_bf16 v[0:15], v[64:67], v[176:179], v[0:15]
    v_fmac_f32 v201, v27, v171
    v_fmac_f32 v201, v28, v172
    v_fmac_f32 v201, v29, v173
    v_fmac_f32 v201, v30, v174
    v_fmac_f32 v201, v31, v175
    v_add_f32 v255, v197, v255
    s_add_u32 m0, s21, 6144
    v_mfma_f32_32x32x16_bf16 v[48:63], v[68:71], v[176:179], v[48:63]
    s_cbranch_vccnz WL_8_3
    v_mad_u32_u16 v240, v240, s3, v246 op_sel:[1,0,0,0]
    v_mad_u32_u16 v241, v241, s3, v246 op_sel:[1,0,0,0]
    buffer_load_dwordx4 v240, s[4:7], s41 offen  lds
    buffer_load_dwordx4 v241, s[8:11], s41 offen offset:1024  lds
WR_8_3:
    v_cvt_pk_bf16_f32 v254, v254, v255
    ds_write_b32 v253, v254 offset:512
    v_mfma_f32_32x32x16_bf16 v[16:31], v[72:75], v[180:183], 0
    v_mul_f32 v254, v0, v144
    v_fmac_f32 v254, v1, v145
    v_fmac_f32 v254, v2, v146
    v_fmac_f32 v254, v3, v147
    v_fmac_f32 v254, v4, v148
    v_fmac_f32 v254, v5, v149
    v_mfma_f32_32x32x16_bf16 v[32:47], v[76:79], v[180:183], v[32:47]
    v_fmac_f32 v254, v6, v150
    v_fmac_f32 v254, v7, v151
    v_fma_f32 v202, v8, -v160, v202
    v_fma_f32 v202, v9, -v161, v202
    v_permlane32_swap_b32 v254, v200
    v_fma_f32 v202, v10, -v162, v202
    v_mfma_f32_32x32x16_bf16 v[16:31], v[80:83], v[184:187], v[16:31]
    v_fma_f32 v202, v11, -v163, v202
    v_fma_f32 v202, v12, -v164, v202
    v_fma_f32 v202, v13, -v165, v202
    v_fma_f32 v202, v14, -v166, v202
    v_fma_f32 v202, v15, -v167, v202
    v_add_f32 v200, v254, v200
    v_mfma_f32_32x32x16_bf16 v[32:47], v[84:87], v[184:187], v[32:47]
    v_fmac_f32 v198, v48, v112
    v_permlane32_swap_b32 v202, v254
    v_fmac_f32 v198, v49, v113
    v_fmac_f32 v198, v50, v114
    v_fmac_f32 v198, v51, v115
    v_fmac_f32 v198, v52, v116
    v_mfma_f32_32x32x16_bf16 v[16:31], v[88:91], v[188:191], v[16:31]
    v_fmac_f32 v198, v53, v117
    v_fmac_f32 v198, v54, v118
    v_fmac_f32 v198, v55, v119
    v_add_f32 v254, v202, v254
    v_mul_f32 v196, v56, v160
    v_fmac_f32 v196, v57, v161
    v_mfma_f32_32x32x16_bf16 v[32:47], v[92:95], v[188:191], v[32:47]
    s_waitcnt vmcnt(6)
    ds_read_b64_tr_b16 v[176:177], v244 offset:0
    ds_read_b64_tr_b16 v[178:179], v244 offset:1024
    ds_read_b64_tr_b16 v[180:181], v245 offset:0
    ds_read_b64_tr_b16 v[182:183], v245 offset:1024
    v_fmac_f32 v196, v58, v162
    v_fmac_f32 v196, v59, v163
    v_mfma_f32_32x32x16_bf16 v[16:31], v[64:67], v[192:195], v[16:31]
    v_fmac_f32 v196, v60, v164
    v_fmac_f32 v196, v61, v165
    v_fmac_f32 v196, v62, v166
    v_fmac_f32 v196, v63, v167
    s_nop 1
    v_permlane32_swap_b32 v198, v196
    v_add_f32 v196, v198, v196
    v_mfma_f32_32x32x16_bf16 v[32:47], v[68:71], v[192:195], v[32:47]
    v_add_u32 v249, s48, v249
    v_add_u32 v250, s49, v250
    ds_read_b32 v252, v251 offset:16
    ds_read_b64_tr_b16 v[72:73], v249 offset:0
    ds_read_b64_tr_b16 v[76:77], v249 offset:64
    ds_read_b64_tr_b16 v[74:75], v249 offset:256
    ds_read_b64_tr_b16 v[78:79], v249 offset:320
    s_mov_b64 exec, s[54:55]
    ds_read_u16_d16_hi v242, v250 offset:0
    s_mov_b64 exec, -1
    s_cbranch_vccnz LEPI_1
    v_mul_f32 v255, v16, v152
    v_fmac_f32 v255, v17, v153
    v_fmac_f32 v255, v18, v154
    v_fmac_f32 v255, v19, v155
    v_fmac_f32 v255, v20, v156
    v_fmac_f32 v255, v21, v157
    v_fmac_f32 v255, v22, v158
    v_fmac_f32 v255, v23, v159
    v_fma_f32 v203, v24, -v168, v203
    v_fma_f32 v203, v25, -v169, v203
    v_permlane32_swap_b32 v255, v201
    v_fma_f32 v203, v26, -v170, v203
    v_fma_f32 v203, v27, -v171, v203
    v_fma_f32 v203, v28, -v172, v203
    v_fma_f32 v203, v29, -v173, v203
    v_fma_f32 v203, v30, -v174, v203
    v_fma_f32 v203, v31, -v175, v203
    v_add_f32 v201, v255, v201
    v_fmac_f32 v199, v32, v120
    v_permlane32_swap_b32 v203, v255
    v_fmac_f32 v199, v33, v121
    v_fmac_f32 v199, v34, v122
    v_fmac_f32 v199, v35, v123
    v_fmac_f32 v199, v36, v124
    v_fmac_f32 v199, v37, v125
    v_fmac_f32 v199, v38, v126
    v_fmac_f32 v199, v39, v127
    v_add_f32 v255, v203, v255
    v_mul_f32 v197, v40, v168
    v_fmac_f32 v197, v41, v169
    v_fmac_f32 v197, v42, v170
    v_fmac_f32 v197, v43, v171
    v_fmac_f32 v197, v44, v172
    v_fmac_f32 v197, v45, v173
    v_fmac_f32 v197, v46, v174
    v_fmac_f32 v197, v47, v175
    s_nop 1
    v_permlane32_swap_b32 v199, v197
    v_add_f32 v197, v199, v197
    v_cvt_pk_bf16_f32 v200, v200, v201
    v_cvt_pk_bf16_f32 v254, v254, v255
    v_cvt_pk_bf16_f32 v196, v196, v197
    ds_write2st64_b32 v253, v200, v196 offset0:3 offset1:4
    s_mov_b64 exec, 0xffffffff
    ds_write_b32 v253, v254 offset:1280
    s_mov_b64 exec, -1
    s_add_u32 s50, s50, 1
    s_cmp_ge_u32 s50, 4
    s_cbranch_scc1 LAST1
    s_waitcnt lgkmcnt(7)
    v_readfirstlane_b32 s66, v252
    s_add_u32 s53, s53, 1
    v_mov_b32 v252, s53
    s_cmp_le_u32 s53, s66
    ds_write2_b32 v251, v252, v252 offset0:0 offset1:8
    s_setprio 1
    s_cbranch_scc1 PRIO_15
    s_setprio 0
PRIO_15:
    s_cmp_eq_u32 s52, 4
    s_cbranch_scc1 ITEM_1_4
    s_cmp_eq_u32 s52, 5
    s_cbranch_scc1 ITEM_1_5
    s_cmp_eq_u32 s52, 3
    s_cbranch_scc1 ITEM_1_3
    s_cmp_eq_u32 s52, 6
    s_cbranch_scc1 ITEM_1_6
    s_cmp_eq_u32 s52, 8
    s_cbranch_scc1 ITEM_1_8
    s_branch ITEM_1_2
WL_8_0:
    s_add_u32 s66, s51, 0
    buffer_load_dwordx4 v[96:99], v246, s[16:19], s66 offen offset:2048 sc1
    buffer_load_dwordx4 v[100:103], v246, s[16:19], s66 offen offset:3072 sc1
    s_branch WR_8_0
WL_8_1:
    s_add_u32 s66, s51, 4096
    buffer_load_dwordx4 v[104:107], v246, s[16:19], s66 offen offset:2048 sc1
    buffer_load_dwordx4 v[108:111], v246, s[16:19], s66 offen offset:3072 sc1
    s_branch WR_8_1
WL_8_2:
    s_add_u32 s66, s51, 8192
    buffer_load_dwordx4 v[128:131], v246, s[16:19], s66 offen offset:2048 sc1
    buffer_load_dwordx4 v[132:135], v246, s[16:19], s66 offen offset:3072 sc1
    s_branch WR_8_2
WL_8_3:
    s_add_u32 s66, s51, 12288
    buffer_load_dwordx4 v[136:139], v246, s[16:19], s66 offen offset:2048 sc1
    buffer_load_dwordx4 v[140:143], v246, s[16:19], s66 offen offset:3072 sc1
    s_branch WR_8_3
.p2align 6
ITEM_1_2:
    s_mov_b32 m0, s50
    s_nop 0
    s_movrels_b32 s71, s23
    s_movrels_b32 s33, s28
    v_add_u32 v253, s33, v248
    s_bfe_u32 s46, s71, 0x30012
    s_mov_b32 m0, s46
    s_and_b32 s66, s71, 0x3ffff
    s_movrels_b32 s68, s57
    s_movrels_b32 s69, s61
    s_sub_u32 s48, s66, s47
    s_mov_b32 s47, s66
    s_lshr_b32 s52, s71, 28
    s_lshl_b32 s67, s46, 9
    s_add_u32 s66, s66, s67
    s_sub_u32 s49, s66, s42
    s_mov_b32 s42, s66
    s_bfe_u32 s66, s68, 655360
    s_add_u32 s43, s42, s66
    s_bfe_u32 s39, s69, 655360
    s_bfe_u32 s66, s68, 655370
    s_add_u32 s44, s42, s66
    s_bfe_u32 s40, s69, 655370
    s_bfe_u32 s66, s68, 655380
    s_add_u32 s45, s42, s66
    s_bfe_u32 s41, s69, 655380
    v_add_u32 v252, s42, v247
    ds_read2_b32 v[234:235], v252 offset0:0 offset1:16
    v_add_u32 v252, s43, v247
    ds_read2_b32 v[236:237], v252 offset0:0 offset1:16
    v_add_u32 v252, s44, v247
    ds_read2_b32 v[238:239], v252 offset0:0 offset1:16
    v_add_u32 v252, s45, v247
    ds_read2_b32 v[240:241], v252 offset0:0 offset1:16
    s_waitcnt lgkmcnt(4)
    v_mul_f32_dpp v196, v242, v72 row_newbcast:0 row_mask:0xf bank_mask:0xf
    v_mul_f32_dpp v197, v242, v73 row_newbcast:1 row_mask:0xf bank_mask:0xf
    v_mul_f32_dpp v198, v242, v72 row_newbcast:8 row_mask:0xf bank_mask:0xf
    v_mul_f32_dpp v199, v242, v73 row_newbcast:9 row_mask:0xf bank_mask:0xf
    v_mul_f32_dpp v200, v242, v76 row_newbcast:2 row_mask:0xf bank_mask:0xf
    v_mul_f32_dpp v201, v242, v77 row_newbcast:3 row_mask:0xf bank_mask:0xf
    v_mul_f32_dpp v202, v242, v76 row_newbcast:10 row_mask:0xf bank_mask:0xf
    v_mul_f32_dpp v203, v242, v77 row_newbcast:11 row_mask:0xf bank_mask:0xf
    v_cvt_pk_bf16_f32 v72, v196, v197
    v_cvt_pk_bf16_f32 v76, v198, v199
    v_cvt_pk_bf16_f32 v73, v200, v201
    v_cvt_pk_bf16_f32 v77, v202, v203
    v_mul_f32_dpp v196, v242, v74 row_newbcast:4 row_mask:0xf bank_mask:0xf
    v_mul_f32_dpp v197, v242, v75 row_newbcast:5 row_mask:0xf bank_mask:0xf
    v_mul_f32_dpp v198, v242, v74 row_newbcast:12 row_mask:0xf bank_mask:0xf
    v_mul_f32_dpp v199, v242, v75 row_newbcast:13 row_mask:0xf bank_mask:0xf
    v_mul_f32_dpp v200, v242, v78 row_newbcast:6 row_mask:0xf bank_mask:0xf
    v_mul_f32_dpp v201, v242, v79 row_newbcast:7 row_mask:0xf bank_mask:0xf
    v_mul_f32_dpp v202, v242, v78 row_newbcast:14 row_mask:0xf bank_mask:0xf
    v_mul_f32_dpp v203, v242, v79 row_newbcast:15 row_mask:0xf bank_mask:0xf
    v_cvt_pk_bf16_f32 v74, v196, v197
    v_cvt_pk_bf16_f32 v78, v198, v199
    v_cvt_pk_bf16_f32 v75, v200, v201
    v_cvt_pk_bf16_f32 v79, v202, v203
    s_nop 0
    s_waitcnt lgkmcnt(3)
    v_mfma_f32_32x32x16_bf16 v[0:15], v[72:75], v[176:179], 0
    s_add_u32 m0, s21, 0
    v_mfma_f32_32x32x16_bf16 v[48:63], v[76:79], v[176:179], 0
    s_cbranch_vccnz WL_2_0
    v_mad_u32_u16 v234, v234, s3, v246 op_sel:[1,0,0,0]
    v_mad_u32_u16 v235, v235, s3, v246 op_sel:[1,0,0,0]
    buffer_load_dwordx4 v234, s[4:7], s38 offen  lds
    buffer_load_dwordx4 v235, s[8:11], s38 offen offset:1024  lds
WR_2_0:
    v_mfma_f32_32x32x16_bf16 v[16:31], v[72:75], v[180:183], 0
    s_nop 3
    v_mul_f32 v196, v0, v96
    v_fmac_f32 v196, v1, v97
    v_fmac_f32 v196, v2, v98
    v_fmac_f32 v196, v3, v99
    v_fmac_f32 v196, v4, v100
    v_fmac_f32 v196, v5, v101
    v_mfma_f32_32x32x16_bf16 v[32:47], v[76:79], v[180:183], 0
    s_waitcnt vmcnt(6)
    ds_read_b64_tr_b16 v[176:177], v244 offset:2048
    ds_read_b64_tr_b16 v[178:179], v244 offset:3072
    ds_read_b64_tr_b16 v[180:181], v245 offset:2048
    ds_read_b64_tr_b16 v[182:183], v245 offset:3072
    v_fmac_f32 v196, v6, v102
    v_fmac_f32 v196, v7, v103
    v_mul_f32 v198, v8, v128
    v_fmac_f32 v198, v9, v129
    v_fmac_f32 v198, v10, v130
    v_fmac_f32 v198, v11, v131
    v_fmac_f32 v198, v12, v132
    v_fmac_f32 v198, v13, v133
    v_fmac_f32 v198, v14, v134
    v_fmac_f32 v198, v15, v135
    v_mul_f32 v200, v48, v128
    v_fmac_f32 v200, v49, v129
    v_permlane32_swap_b32 v196, v198
    v_fmac_f32 v200, v50, v130
    v_fmac_f32 v200, v51, v131
    v_fmac_f32 v200, v52, v132
    v_fmac_f32 v200, v53, v133
    v_fmac_f32 v200, v54, v134
    v_fmac_f32 v200, v55, v135
    v_add_f32 v198, v196, v198
    v_mul_f32_e64 v202, v56, -v128
    v_fma_f32 v202, v57, -v129, v202
    v_fma_f32 v202, v58, -v130, v202
    v_fma_f32 v202, v59, -v131, v202
    v_fma_f32 v202, v60, -v132, v202
    v_fma_f32 v202, v61, -v133, v202
    v_fma_f32 v202, v62, -v134, v202
    v_fma_f32 v202, v63, -v135, v202
    s_nop 1
    v_permlane32_swap_b32 v200, v202
    v_add_f32 v202, v200, v202
    s_waitcnt lgkmcnt(0)
    v_mfma_f32_32x32x16_bf16 v[0:15], v[72:75], v[176:179], 0
    v_mul_f32 v197, v16, v104
    v_fmac_f32 v197, v17, v105
    v_fmac_f32 v197, v18, v106
    v_fmac_f32 v197, v19, v107
    v_fmac_f32 v197, v20, v108
    v_fmac_f32 v197, v21, v109
    s_add_u32 m0, s21, 2048
    v_mfma_f32_32x32x16_bf16 v[48:63], v[76:79], v[176:179], 0
    s_cbranch_vccnz WL_2_1
    v_mad_u32_u16 v236, v236, s3, v246 op_sel:[1,0,0,0]
    v_mad_u32_u16 v237, v237, s3, v246 op_sel:[1,0,0,0]
    buffer_load_dwordx4 v236, s[4:7], s39 offen  lds
    buffer_load_dwordx4 v237, s[8:11], s39 offen offset:1024  lds
WR_2_1:
    v_fmac_f32 v197, v22, v110
    v_fmac_f32 v197, v23, v111
    v_mul_f32 v199, v24, v136
    v_fmac_f32 v199, v25, v137
    v_fmac_f32 v199, v26, v138
    v_fmac_f32 v199, v27, v139
    v_fmac_f32 v199, v28, v140
    v_fmac_f32 v199, v29, v141
    v_fmac_f32 v199, v30, v142
    v_fmac_f32 v199, v31, v143
    v_mul_f32 v201, v32, v136
    v_fmac_f32 v201, v33, v137
    v_permlane32_swap_b32 v197, v199
    v_fmac_f32 v201, v34, v138
    v_fmac_f32 v201, v35, v139
    v_fmac_f32 v201, v36, v140
    v_fmac_f32 v201, v37, v141
    v_fmac_f32 v201, v38, v142
    v_fmac_f32 v201, v39, v143
    v_add_f32 v199, v197, v199
    v_mul_f32_e64 v203, v40, -v136
    v_fma_f32 v203, v41, -v137, v203
    v_fma_f32 v203, v42, -v138, v203
    v_fma_f32 v203, v43, -v139, v203
    v_fma_f32 v203, v44, -v140, v203
    v_fma_f32 v203, v45, -v141, v203
    v_fma_f32 v203, v46, -v142, v203
    v_fma_f32 v203, v47, -v143, v203
    s_nop 1
    v_permlane32_swap_b32 v201, v203
    v_add_f32 v203, v201, v203
    v_cvt_pk_bf16_f32 v192, v198, v199
    v_cvt_pk_bf16_f32 v193, v202, v203
    v_mfma_f32_32x32x16_bf16 v[16:31], v[72:75], v[180:183], 0
    v_mul_f32 v196, v0, v144
    v_fmac_f32 v196, v1, v145
    v_fmac_f32 v196, v2, v146
    v_fmac_f32 v196, v3, v147
    v_fmac_f32 v196, v4, v148
    v_fmac_f32 v196, v5, v149
    v_mfma_f32_32x32x16_bf16 v[32:47], v[76:79], v[180:183], 0
    s_waitcnt vmcnt(6)
    ds_read_b64_tr_b16 v[176:177], v244 offset:4096
    ds_read_b64_tr_b16 v[178:179], v244 offset:5120
    ds_read_b64_tr_b16 v[180:181], v245 offset:4096
    ds_read_b64_tr_b16 v[182:183], v245 offset:5120
    v_fmac_f32 v196, v6, v150
    v_fmac_f32 v196, v7, v151
    v_mul_f32 v198, v8, v112
    v_fmac_f32 v198, v9, v113
    v_fmac_f32 v198, v10, v114
    v_fmac_f32 v198, v11, v115
    v_fmac_f32 v198, v12, v116
    v_fmac_f32 v198, v13, v117
    v_fmac_f32 v198, v14, v118
    v_fmac_f32 v198, v15, v119
    v_mul_f32_e64 v200, v48, -v160
    v_fma_f32 v200, v49, -v161, v200
    v_fma_f32 v200, v50, -v162, v200
    v_fma_f32 v200, v51, -v163, v200
    v_fma_f32 v200, v52, -v164, v200
    v_fma_f32 v200, v53, -v165, v200
    v_fma_f32 v200, v54, -v166, v200
    v_fma_f32 v200, v55, -v167, v200
    v_mul_f32_e64 v202, v56, -v160
    v_fma_f32 v202, v57, -v161, v202
    v_fma_f32 v202, v58, -v162, v202
    v_fma_f32 v202, v59, -v163, v202
    v_fma_f32 v202, v60, -v164, v202
    v_fma_f32 v202, v61, -v165, v202
    v_fma_f32 v202, v62, -v166, v202
    v_fma_f32 v202, v63, -v167, v202
    s_waitcnt lgkmcnt(0)
    v_mfma_f32_32x32x16_bf16 v[0:15], v[72:75], v[176:179], 0
    v_mul_f32 v197, v16, v152
    v_fmac_f32 v197, v17, v153
    v_fmac_f32 v197, v18, v154
    v_fmac_f32 v197, v19, v155
    v_fmac_f32 v197, v20, v156
    v_fmac_f32 v197, v21, v157
    s_add_u32 m0, s21, 4096
    v_mfma_f32_32x32x16_bf16 v[48:63], v[76:79], v[176:179], 0
    s_cbranch_vccnz WL_2_2
    v_mad_u32_u16 v238, v238, s3, v246 op_sel:[1,0,0,0]
    v_mad_u32_u16 v239, v239, s3, v246 op_sel:[1,0,0,0]
    buffer_load_dwordx4 v238, s[4:7], s40 offen  lds
    buffer_load_dwordx4 v239, s[8:11], s40 offen offset:1024  lds
WR_2_2:
    v_fmac_f32 v197, v22, v158
    v_fmac_f32 v197, v23, v159
    v_mul_f32 v199, v24, v120
    v_fmac_f32 v199, v25, v121
    v_fmac_f32 v199, v26, v122
    v_fmac_f32 v199, v27, v123
    v_fmac_f32 v199, v28, v124
    v_fmac_f32 v199, v29, v125
    v_fmac_f32 v199, v30, v126
    v_fmac_f32 v199, v31, v127
    v_mul_f32_e64 v201, v32, -v168
    v_fma_f32 v201, v33, -v169, v201
    v_fma_f32 v201, v34, -v170, v201
    v_fma_f32 v201, v35, -v171, v201
    v_fma_f32 v201, v36, -v172, v201
    v_fma_f32 v201, v37, -v173, v201
    v_fma_f32 v201, v38, -v174, v201
    v_fma_f32 v201, v39, -v175, v201
    v_mul_f32_e64 v203, v40, -v168
    v_fma_f32 v203, v41, -v169, v203
    v_fma_f32 v203, v42, -v170, v203
    v_fma_f32 v203, v43, -v171, v203
    v_fma_f32 v203, v44, -v172, v203
    v_fma_f32 v203, v45, -v173, v203
    v_fma_f32 v203, v46, -v174, v203
    v_fma_f32 v203, v47, -v175, v203
    v_mfma_f32_32x32x16_bf16 v[16:31], v[72:75], v[180:183], 0
    v_mul_f32 v254, v0, v144
    v_fmac_f32 v254, v1, v145
    v_fmac_f32 v254, v2, v146
    v_fmac_f32 v254, v3, v147
    v_fmac_f32 v254, v4, v148
    v_fmac_f32 v254, v5, v149
    v_mfma_f32_32x32x16_bf16 v[32:47], v[76:79], v[180:183], 0
    s_waitcnt vmcnt(6)
    ds_read_b64_tr_b16 v[176:177], v244 offset:6144
    ds_read_b64_tr_b16 v[178:179], v244 offset:7168
    ds_read_b64_tr_b16 v[180:181], v245 offset:6144
    ds_read_b64_tr_b16 v[182:183], v245 offset:7168
    v_fmac_f32 v254, v6, v150
    v_fmac_f32 v254, v7, v151
    v_fmac_f32 v200, v8, v160
    v_fmac_f32 v200, v9, v161
    v_permlane32_swap_b32 v196, v254
    v_fmac_f32 v200, v10, v162
    v_fmac_f32 v200, v11, v163
    v_fmac_f32 v200, v12, v164
    v_fmac_f32 v200, v13, v165
    v_fmac_f32 v200, v14, v166
    v_fmac_f32 v200, v15, v167
    v_add_f32 v254, v196, v254
    v_xor_b32 v64, 0x80000000, v48
    v_xor_b32 v65, 0x80000000, v49
    v_xor_b32 v66, 0x80000000, v50
    v_xor_b32 v67, 0x80000000, v51
    v_xor_b32 v68, 0x80000000, v52
    v_xor_b32 v69, 0x80000000, v53
    v_xor_b32 v70, 0x80000000, v54
    v_xor_b32 v71, 0x80000000, v55
    s_waitcnt lgkmcnt(0)
    v_mfma_f32_32x32x16_bf16 v[0:15], v[72:75], v[176:179], 0
    v_mul_f32 v255, v16, v152
    v_fmac_f32 v255, v17, v153
    v_fmac_f32 v255, v18, v154
    v_fmac_f32 v255, v19, v155
    v_fmac_f32 v255, v20, v156
    v_fmac_f32 v255, v21, v157
    s_add_u32 m0, s21, 6144
    v_mfma_f32_32x32x16_bf16 v[56:71], v[76:79], v[176:179], v[56:71]
    s_cbranch_vccnz WL_2_3
    v_mad_u32_u16 v240, v240, s3, v246 op_sel:[1,0,0,0]
    v_mad_u32_u16 v241, v241, s3, v246 op_sel:[1,0,0,0]
    buffer_load_dwordx4 v240, s[4:7], s41 offen  lds
    buffer_load_dwordx4 v241, s[8:11], s41 offen offset:1024  lds
WR_2_3:
    v_fmac_f32 v255, v22, v158
    v_fmac_f32 v255, v23, v159
    v_fmac_f32 v201, v24, v168
    v_fmac_f32 v201, v25, v169
    v_permlane32_swap_b32 v197, v255
    v_fmac_f32 v201, v26, v170
    v_fmac_f32 v201, v27, v171
    v_fmac_f32 v201, v28, v172
    v_fmac_f32 v201, v29, v173
    v_fmac_f32 v201, v30, v174
    v_fmac_f32 v201, v31, v175
    v_add_f32 v255, v197, v255
    v_xor_b32 v48, 0x80000000, v32
    v_xor_b32 v49, 0x80000000, v33
    v_xor_b32 v50, 0x80000000, v34
    v_xor_b32 v51, 0x80000000, v35
    v_xor_b32 v52, 0x80000000, v36
    v_xor_b32 v53, 0x80000000, v37
    v_xor_b32 v54, 0x80000000, v38
    v_xor_b32 v55, 0x80000000, v39
    v_cvt_pk_bf16_f32 v194, v254, v255
    v_mfma_f32_32x32x16_bf16 v[16:31], v[72:75], v[180:183], 0
    v_mul_f32 v254, v0, v144
    v_fmac_f32 v254, v1, v145
    v_fmac_f32 v254, v2, v146
    v_fmac_f32 v254, v3, v147
    v_fmac_f32 v254, v4, v148
    v_fmac_f32 v254, v5, v149
    v_mfma_f32_32x32x16_bf16 v[40:55], v[76:79], v[180:183], v[40:55]
    s_waitcnt vmcnt(6)
    ds_read_b64_tr_b16 v[176:177], v244 offset:0
    ds_read_b64_tr_b16 v[178:179], v244 offset:1024
    ds_read_b64_tr_b16 v[180:181], v245 offset:0
    ds_read_b64_tr_b16 v[182:183], v245 offset:1024
    v_add_u32 v249, s48, v249
    v_add_u32 v250, s49, v250
    ds_read_b32 v252, v251 offset:16
    ds_read_b64_tr_b16 v[72:73], v249 offset:0
    ds_read_b64_tr_b16 v[76:77], v249 offset:64
    ds_read_b64_tr_b16 v[74:75], v249 offset:256
    ds_read_b64_tr_b16 v[78:79], v249 offset:320
    s_mov_b64 exec, s[54:55]
    ds_read_u16_d16_hi v242, v250 offset:0
    s_mov_b64 exec, -1
    v_fmac_f32 v254, v6, v150
    v_fmac_f32 v254, v7, v151
    v_fma_f32 v202, v8, -v160, v202
    v_fma_f32 v202, v9, -v161, v202
    v_permlane32_swap_b32 v254, v200
    v_fma_f32 v202, v10, -v162, v202
    v_fma_f32 v202, v11, -v163, v202
    v_fma_f32 v202, v12, -v164, v202
    v_fma_f32 v202, v13, -v165, v202
    v_fma_f32 v202, v14, -v166, v202
    v_fma_f32 v202, v15, -v167, v202
    v_add_f32 v200, v254, v200
    v_fma_f32 v198, v64, -v112, v198
    v_permlane32_swap_b32 v202, v254
    v_fma_f32 v198, v65, -v113, v198
    v_fma_f32 v198, v66, -v114, v198
    v_fma_f32 v198, v67, -v115, v198
    v_fma_f32 v198, v68, -v116, v198
    v_fma_f32 v198, v69, -v117, v198
    v_fma_f32 v198, v70, -v118, v198
    v_fma_f32 v198, v71, -v119, v198
    v_add_f32 v254, v202, v254
    v_mul_f32 v196, v56, v160
    v_fmac_f32 v196, v57, v161
    v_fmac_f32 v196, v58, v162
    v_fmac_f32 v196, v59, v163
    v_fmac_f32 v196, v60, v164
    v_fmac_f32 v196, v61, v165
    v_fmac_f32 v196, v62, v166
    v_fmac_f32 v196, v63, v167
    s_nop 1
    v_permlane32_swap_b32 v198, v196
    v_add_f32 v196, v198, v196
    s_cbranch_vccnz LEPI_2
    v_mul_f32 v255, v16, v152
    v_fmac_f32 v255, v17, v153
    v_fmac_f32 v255, v18, v154
    v_fmac_f32 v255, v19, v155
    v_fmac_f32 v255, v20, v156
    v_fmac_f32 v255, v21, v157
    v_fmac_f32 v255, v22, v158
    v_fmac_f32 v255, v23, v159
    v_fma_f32 v203, v24, -v168, v203
    v_fma_f32 v203, v25, -v169, v203
    v_permlane32_swap_b32 v255, v201
    v_fma_f32 v203, v26, -v170, v203
    v_fma_f32 v203, v27, -v171, v203
    v_fma_f32 v203, v28, -v172, v203
    v_fma_f32 v203, v29, -v173, v203
    v_fma_f32 v203, v30, -v174, v203
    v_fma_f32 v203, v31, -v175, v203
    v_add_f32 v201, v255, v201
    v_fma_f32 v199, v48, -v120, v199
    v_permlane32_swap_b32 v203, v255
    v_fma_f32 v199, v49, -v121, v199
    v_fma_f32 v199, v50, -v122, v199
    v_fma_f32 v199, v51, -v123, v199
    v_fma_f32 v199, v52, -v124, v199
    v_fma_f32 v199, v53, -v125, v199
    v_fma_f32 v199, v54, -v126, v199
    v_fma_f32 v199, v55, -v127, v199
    v_add_f32 v255, v203, v255
    v_mul_f32 v197, v40, v168
    v_fmac_f32 v197, v41, v169
    v_fmac_f32 v197, v42, v170
    v_fmac_f32 v197, v43, v171
    v_fmac_f32 v197, v44, v172
    v_fmac_f32 v197, v45, v173
    v_fmac_f32 v197, v46, v174
    v_fmac_f32 v197, v47, v175
    s_nop 1
    v_permlane32_swap_b32 v199, v197
    v_add_f32 v197, v199, v197
    v_cvt_pk_bf16_f32 v200, v200, v201
    v_cvt_pk_bf16_f32 v254, v254, v255
    v_cvt_pk_bf16_f32 v196, v196, v197
    ds_write2st64_b32 v253, v192, v193 offset0:0 offset1:1
    ds_write2st64_b32 v253, v194, v200 offset0:2 offset1:3
    ds_write_b32 v253, v196 offset:1024
    s_mov_b64 exec, 0xffffffff
    ds_write_b32 v253, v254 offset:1280
    s_mov_b64 exec, -1
    s_add_u32 s50, s50, 1
    s_cmp_ge_u32 s50, 4
    s_cbranch_scc1 LAST1
    s_waitcnt lgkmcnt(9)
    v_readfirstlane_b32 s66, v252
    s_add_u32 s53, s53, 1
    v_mov_b32 v252, s53
    s_cmp_le_u32 s53, s66
    ds_write2_b32 v251, v252, v252 offset0:0 offset1:8
    s_setprio 1
    s_cbranch_scc1 PRIO_16
    s_setprio 0
PRIO_16:
    s_cmp_eq_u32 s52, 4
    s_cbranch_scc1 ITEM_1_4
    s_cmp_eq_u32 s52, 5
    s_cbranch_scc1 ITEM_1_5
    s_cmp_eq_u32 s52, 3
    s_cbranch_scc1 ITEM_1_3
    s_cmp_eq_u32 s52, 6
    s_cbranch_scc1 ITEM_1_6
    s_cmp_eq_u32 s52, 8
    s_cbranch_scc1 ITEM_1_8
    s_branch ITEM_1_2
WL_2_0:
    s_add_u32 s66, s51, 0
    buffer_load_dword v195, v246, s[16:19], s66 offen
    buffer_load_dword v195, v246, s[16:19], s66 offen
    s_branch WR_2_0
WL_2_1:
    s_add_u32 s66, s51, 4096
    buffer_load_dword v195, v246, s[16:19], s66 offen
    buffer_load_dword v195, v246, s[16:19], s66 offen
    s_branch WR_2_1
WL_2_2:
    s_add_u32 s66, s51, 8192
    buffer_load_dword v195, v246, s[16:19], s66 offen
    buffer_load_dword v195, v246, s[16:19], s66 offen
    s_branch WR_2_2
WL_2_3:
    s_add_u32 s66, s51, 12288
    buffer_load_dword v195, v246, s[16:19], s66 offen
    buffer_load_dword v195, v246, s[16:19], s66 offen
    s_branch WR_2_3
.p2align 6
.p2align 6
LEPI_2:
    s_lshl_b32 s71, s20, 4
    s_add_u32 s67, s51, 4096
    s_add_u32 s68, s51, 8192
    s_add_u32 s69, s51, 12288
    s_add_u32 s70, s51, 16384
    s_waitcnt lgkmcnt(0)
    buffer_load_dwordx4 v[96:99], v246, s[16:19], s51 offen offset:2048 sc1
    s_mov_b32 s52, 163072
    v_bfe_u32 v177, v246, 4, 4
    v_bfe_u32 v179, v246, 4, 3
    v_lshl_add_u32 v180, v177, 3, s52
    v_lshl_add_u32 v190, v177, 4, s52
    v_lshl_add_u32 v181, v179, 3, s52
    ds_read2_b64 v[182:185], v180 offset0:32 offset1:48
    ds_read_b32 v191, v190
    ds_read_b64 v[186:187], v181 offset:512
    v_lshrrev_b32 v178, 8, v246
    buffer_load_dwordx4 v[100:103], v246, s[16:19], s51 offen offset:3072 sc1
    v_add_u32 v234, s21, v248
    v_add_u32 v235, 128, v234
    v_mul_f32 v255, v16, v152
    buffer_load_dwordx4 v[104:107], v246, s[16:19], s67 offen offset:2048 sc1
    v_fmac_f32 v255, v17, v153
    v_fmac_f32 v255, v18, v154
    ds_write2st64_b32 v234, v204, v205 offset0:0 offset1:1
    v_fmac_f32 v255, v19, v155
    buffer_load_dwordx4 v[108:111], v246, s[16:19], s67 offen offset:3072 sc1
    v_fmac_f32 v255, v20, v156
    v_fmac_f32 v255, v21, v157
    ds_write2st64_b32 v234, v206, v207 offset0:2 offset1:3
    v_fmac_f32 v255, v22, v158
    buffer_load_dwordx4 v[128:131], v246, s[16:19], s68 offen offset:2048 sc1
    v_fmac_f32 v255, v23, v159
    v_fma_f32 v203, v24, -v168, v203
    ds_write2st64_b32 v234, v208, v209 offset0:4 offset1:5
    v_fma_f32 v203, v25, -v169, v203
    buffer_load_dwordx4 v[132:135], v246, s[16:19], s68 offen offset:3072 sc1
    v_permlane32_swap_b32 v255, v201
    v_fma_f32 v203, v26, -v170, v203
    ds_write2st64_b32 v235, v210, v211 offset0:6 offset1:7
    v_fma_f32 v203, v27, -v171, v203
    v_fma_f32 v203, v28, -v172, v203
    buffer_load_dwordx4 v[136:139], v246, s[16:19], s69 offen offset:2048 sc1
    v_fma_f32 v203, v29, -v173, v203
    ds_write2st64_b32 v235, v212, v213 offset0:8 offset1:9
    v_fma_f32 v203, v30, -v174, v203
    v_fma_f32 v203, v31, -v175, v203
    buffer_load_dwordx4 v[140:143], v246, s[16:19], s69 offen offset:3072 sc1
    v_add_f32 v201, v255, v201
    ds_write2st64_b32 v235, v214, v215 offset0:10 offset1:11
    v_fma_f32 v199, v48, -v120, v199
    v_permlane32_swap_b32 v203, v255
    buffer_load_dwordx4 v[112:115], v246, s[16:19], s70 offen offset:2048 sc1
    v_fma_f32 v199, v49, -v121, v199
    ds_write2st64_b32 v234, v216, v217 offset0:12 offset1:13
    v_fma_f32 v199, v50, -v122, v199
    v_fma_f32 v199, v51, -v123, v199
    buffer_load_dwordx4 v[116:119], v246, s[16:19], s70 offen offset:3072 sc1
    v_fma_f32 v199, v52, -v124, v199
    ds_write2st64_b32 v234, v218, v219 offset0:14 offset1:15
    v_fma_f32 v199, v53, -v125, v199
    v_fma_f32 v199, v54, -v126, v199
    buffer_load_dwordx4 v[144:147], v246, s[16:19], s51 offen offset:0 sc1
    v_fma_f32 v199, v55, -v127, v199
    v_add_f32 v255, v203, v255
    ds_write2st64_b32 v234, v220, v221 offset0:16 offset1:17
    v_mul_f32 v197, v40, v168
    buffer_load_dwordx4 v[148:151], v246, s[16:19], s51 offen offset:1024 sc1
    v_fmac_f32 v197, v41, v169
    v_fmac_f32 v197, v42, v170
    ds_write2st64_b32 v235, v222, v223 offset0:18 offset1:19
    v_fmac_f32 v197, v43, v171
    buffer_load_dwordx4 v[160:163], v246, s[16:19], s67 offen offset:0 sc1
    v_fmac_f32 v197, v44, v172
    v_fmac_f32 v197, v45, v173
    ds_write2st64_b32 v235, v224, v225 offset0:20 offset1:21
    v_fmac_f32 v197, v46, v174
    buffer_load_dwordx4 v[164:167], v246, s[16:19], s67 offen offset:1024 sc1
    v_fmac_f32 v197, v47, v175
    s_nop 1
    ds_write2st64_b32 v235, v226, v227 offset0:22 offset1:23
    v_permlane32_swap_b32 v199, v197
    ds_write2st64_b32 v234, v228, v229 offset0:24 offset1:25
    v_add_f32 v197, v199, v197
    v_cvt_pk_bf16_f32 v200, v200, v201
    ds_write2st64_b32 v234, v230, v231 offset0:26 offset1:27
    v_cvt_pk_bf16_f32 v254, v254, v255
    v_cvt_pk_bf16_f32 v196, v196, v197
    ds_write2st64_b32 v234, v232, v233 offset0:28 offset1:29
    ds_write2st64_b32 v253, v192, v193 offset0:0 offset1:1
    ds_write2st64_b32 v253, v194, v200 offset0:2 offset1:3
    ds_write_b32 v253, v196 offset:1024
    s_mov_b64 exec, 0xffffffff
    ds_write_b32 v253, v254 offset:1280
    s_mov_b64 exec, -1
    s_add_u32 s50, s53, 1
    v_mov_b32 v234, s50
    ds_write2_b32 v251, v234, v234 offset0:0 offset1:8
    s_waitcnt lgkmcnt(15)
    s_branch TAIL
.p2align 6
LEPI_1:
    s_lshl_b32 s71, s20, 4
    s_add_u32 s67, s51, 4096
    s_add_u32 s68, s51, 8192
    s_add_u32 s69, s51, 12288
    s_add_u32 s70, s51, 16384
    s_waitcnt lgkmcnt(0)
    buffer_load_dwordx4 v[112:115], v246, s[16:19], s70 offen offset:2048 sc1
    s_mov_b32 s52, 163072
    v_bfe_u32 v177, v246, 4, 4
    v_bfe_u32 v179, v246, 4, 3
    v_lshl_add_u32 v180, v177, 3, s52
    v_lshl_add_u32 v190, v177, 4, s52
    v_lshl_add_u32 v181, v179, 3, s52
    ds_read2_b64 v[182:185], v180 offset0:32 offset1:48
    ds_read_b32 v191, v190
    ds_read_b64 v[186:187], v181 offset:512
    v_lshrrev_b32 v178, 8, v246
    buffer_load_dwordx4 v[116:119], v246, s[16:19], s70 offen offset:3072 sc1
    v_add_u32 v234, s21, v248
    v_add_u32 v235, 128, v234
    v_mul_f32 v255, v16, v152
    v_fmac_f32 v255, v17, v153
    buffer_load_dwordx4 v[144:147], v246, s[16:19], s51 offen offset:0 sc1
    v_fmac_f32 v255, v18, v154
    v_fmac_f32 v255, v19, v155
    ds_write2st64_b32 v234, v204, v205 offset0:0 offset1:1
    v_fmac_f32 v255, v20, v156
    v_fmac_f32 v255, v21, v157
    buffer_load_dwordx4 v[148:151], v246, s[16:19], s51 offen offset:1024 sc1
    v_fmac_f32 v255, v22, v158
    v_fmac_f32 v255, v23, v159
    ds_write2st64_b32 v234, v206, v207 offset0:2 offset1:3
    v_fma_f32 v203, v24, -v168, v203
    v_fma_f32 v203, v25, -v169, v203
    v_permlane32_swap_b32 v255, v201
    buffer_load_dwordx4 v[160:163], v246, s[16:19], s67 offen offset:0 sc1
    v_fma_f32 v203, v26, -v170, v203
    v_fma_f32 v203, v27, -v171, v203
    ds_write2st64_b32 v234, v208, v209 offset0:4 offset1:5
    v_fma_f32 v203, v28, -v172, v203
    v_fma_f32 v203, v29, -v173, v203
    buffer_load_dwordx4 v[164:167], v246, s[16:19], s67 offen offset:1024 sc1
    v_fma_f32 v203, v30, -v174, v203
    v_fma_f32 v203, v31, -v175, v203
    ds_write2st64_b32 v235, v210, v211 offset0:6 offset1:7
    v_add_f32 v201, v255, v201
    v_fmac_f32 v199, v32, v120
    ds_write2st64_b32 v235, v212, v213 offset0:8 offset1:9
    v_permlane32_swap_b32 v203, v255
    v_fmac_f32 v199, v33, v121
    v_fmac_f32 v199, v34, v122
    ds_write2st64_b32 v235, v214, v215 offset0:10 offset1:11
    v_fmac_f32 v199, v35, v123
    v_fmac_f32 v199, v36, v124
    ds_write2st64_b32 v234, v216, v217 offset0:12 offset1:13
    v_fmac_f32 v199, v37, v125
    v_fmac_f32 v199, v38, v126
    ds_write2st64_b32 v234, v218, v219 offset0:14 offset1:15
    v_fmac_f32 v199, v39, v127
    v_add_f32 v255, v203, v255
    ds_write2st64_b32 v234, v220, v221 offset0:16 offset1:17
    v_mul_f32 v197, v40, v168
    v_fmac_f32 v197, v41, v169
    ds_write2st64_b32 v235, v222, v223 offset0:18 offset1:19
    v_fmac_f32 v197, v42, v170
    v_fmac_f32 v197, v43, v171
    v_fmac_f32 v197, v44, v172
    ds_write2st64_b32 v235, v224, v225 offset0:20 offset1:21
    v_fmac_f32 v197, v45, v173
    v_fmac_f32 v197, v46, v174
    ds_write2st64_b32 v235, v226, v227 offset0:22 offset1:23
    v_fmac_f32 v197, v47, v175
    s_nop 1
    ds_write2st64_b32 v234, v228, v229 offset0:24 offset1:25
    v_permlane32_swap_b32 v199, v197
    v_add_f32 v197, v199, v197
    ds_write2st64_b32 v234, v230, v231 offset0:26 offset1:27
    v_cvt_pk_bf16_f32 v200, v200, v201
    v_cvt_pk_bf16_f32 v254, v254, v255
    v_cvt_pk_bf16_f32 v196, v196, v197
    ds_write2st64_b32 v234, v232, v233 offset0:28 offset1:29
    ds_write2st64_b32 v253, v200, v196 offset0:3 offset1:4
    s_mov_b64 exec, 0xffffffff
    ds_write_b32 v253, v254 offset:1280
    s_mov_b64 exec, -1
    s_add_u32 s50, s53, 1
    v_mov_b32 v234, s50
    ds_write2_b32 v251, v234, v234 offset0:0 offset1:8
    s_waitcnt lgkmcnt(15)
    s_branch TAIL
.p2align 6
LEPI_0:
    s_lshl_b32 s71, s20, 4
    s_add_u32 s67, s51, 4096
    s_add_u32 s68, s51, 8192
    s_add_u32 s69, s51, 12288
    s_add_u32 s70, s51, 16384
    s_waitcnt lgkmcnt(0)
    buffer_load_dwordx4 v[112:115], v246, s[16:19], s70 offen offset:2048 sc1
    s_mov_b32 s52, 163072
    v_bfe_u32 v177, v246, 4, 4
    v_bfe_u32 v179, v246, 4, 3
    v_lshl_add_u32 v180, v177, 3, s52
    v_lshl_add_u32 v190, v177, 4, s52
    v_lshl_add_u32 v181, v179, 3, s52
    ds_read2_b64 v[182:185], v180 offset0:32 offset1:48
    ds_read_b32 v191, v190
    ds_read_b64 v[186:187], v181 offset:512
    v_lshrrev_b32 v178, 8, v246
    buffer_load_dwordx4 v[116:119], v246, s[16:19], s70 offen offset:3072 sc1
    v_add_u32 v234, s21, v248
    v_add_u32 v235, 128, v234
    v_mul_f32 v255, v16, v152
    v_fmac_f32 v255, v17, v153
    buffer_load_dwordx4 v[144:147], v246, s[16:19], s51 offen offset:0 sc1
    v_fmac_f32 v255, v18, v154
    v_fmac_f32 v255, v19, v155
    ds_write2st64_b32 v234, v204, v205 offset0:0 offset1:1
    v_fmac_f32 v255, v20, v156
    v_fmac_f32 v255, v21, v157
    buffer_load_dwordx4 v[148:151], v246, s[16:19], s51 offen offset:1024 sc1
    v_fmac_f32 v255, v22, v158
    v_fmac_f32 v255, v23, v159
    ds_write2st64_b32 v234, v206, v207 offset0:2 offset1:3
    v_fma_f32 v203, v24, -v168, v203
    v_fma_f32 v203, v25, -v169, v203
    v_permlane32_swap_b32 v255, v201
    buffer_load_dwordx4 v[160:163], v246, s[16:19], s67 offen offset:0 sc1
    v_fma_f32 v203, v26, -v170, v203
    v_fma_f32 v203, v27, -v171, v203
    ds_write2st64_b32 v234, v208, v209 offset0:4 offset1:5
    v_fma_f32 v203, v28, -v172, v203
    v_fma_f32 v203, v29, -v173, v203
    buffer_load_dwordx4 v[164:167], v246, s[16:19], s67 offen offset:1024 sc1
    v_fma_f32 v203, v30, -v174, v203
    v_fma_f32 v203, v31, -v175, v203
    ds_write2st64_b32 v235, v210, v211 offset0:6 offset1:7
    v_add_f32 v201, v255, v201
    v_fma_f32 v199, v48, -v120, v199
    ds_write2st64_b32 v235, v212, v213 offset0:8 offset1:9
    v_permlane32_swap_b32 v203, v255
    v_fma_f32 v199, v49, -v121, v199
    v_fma_f32 v199, v50, -v122, v199
    ds_write2st64_b32 v235, v214, v215 offset0:10 offset1:11
    v_fma_f32 v199, v51, -v123, v199
    v_fma_f32 v199, v52, -v124, v199
    ds_write2st64_b32 v234, v216, v217 offset0:12 offset1:13
    v_fma_f32 v199, v53, -v125, v199
    v_fma_f32 v199, v54, -v126, v199
    ds_write2st64_b32 v234, v218, v219 offset0:14 offset1:15
    v_fma_f32 v199, v55, -v127, v199
    v_add_f32 v255, v203, v255
    ds_write2st64_b32 v234, v220, v221 offset0:16 offset1:17
    v_mul_f32 v197, v40, v168
    v_fmac_f32 v197, v41, v169
    ds_write2st64_b32 v235, v222, v223 offset0:18 offset1:19
    v_fmac_f32 v197, v42, v170
    v_fmac_f32 v197, v43, v171
    v_fmac_f32 v197, v44, v172
    ds_write2st64_b32 v235, v224, v225 offset0:20 offset1:21
    v_fmac_f32 v197, v45, v173
    v_fmac_f32 v197, v46, v174
    ds_write2st64_b32 v235, v226, v227 offset0:22 offset1:23
    v_fmac_f32 v197, v47, v175
    s_nop 1
    ds_write2st64_b32 v234, v228, v229 offset0:24 offset1:25
    v_permlane32_swap_b32 v199, v197
    v_add_f32 v197, v199, v197
    ds_write2st64_b32 v234, v230, v231 offset0:26 offset1:27
    v_cvt_pk_bf16_f32 v200, v200, v201
    v_cvt_pk_bf16_f32 v254, v254, v255
    v_cvt_pk_bf16_f32 v196, v196, v197
    ds_write2st64_b32 v234, v232, v233 offset0:28 offset1:29
    ds_write2st64_b32 v253, v192, v193 offset0:0 offset1:1
    ds_write2st64_b32 v253, v194, v200 offset0:2 offset1:3
    ds_write_b32 v253, v196 offset:1024
    s_mov_b64 exec, 0xffffffff
    ds_write_b32 v253, v254 offset:1280
    s_mov_b64 exec, -1
    s_add_u32 s50, s53, 1
    v_mov_b32 v234, s50
    ds_write2_b32 v251, v234, v234 offset0:0 offset1:8
    s_waitcnt lgkmcnt(15)
TAIL:
    s_and_b32 s71, s20, 3
    s_lshl_b32 s71, s71, 2
    s_bitcmp0_b32 s20, 2
    s_addc_u32 s71, s71, 0
    v_readlane_b32 s71, v191, s71
    buffer_load_dwordx4 v[120:123], v246, s[16:19], s68 offen offset:0 sc1
    buffer_load_dwordx4 v[124:127], v246, s[16:19], s68 offen offset:1024 sc1
    s_cmp_ge_u32 s71, s50
    s_setprio 1
    s_cbranch_scc1 T_second
    s_setprio 0
T_second:
    buffer_load_dwordx4 v[152:155], v246, s[16:19], s69 offen offset:0 sc1
    buffer_load_dwordx4 v[156:159], v246, s[16:19], s69 offen offset:1024 sc1
    buffer_load_dwordx4 v[168:171], v246, s[16:19], s70 offen offset:0 sc1
    buffer_load_dwordx4 v[172:175], v246, s[16:19], s70 offen offset:1024 sc1
GEMM:
    v_cmp_gt_u32 vcc, s53, v191
    v_xor_b32 v180, v179, v178
    v_xor_b32 v188, 4, v180
    v_lshl_add_u32 v66, v180, 4, v183
    v_lshl_add_u32 v67, v188, 4, v183
    v_lshl_add_u32 v70, v180, 4, v185
    v_lshl_add_u32 v71, v188, 4, v185
    s_mov_b32 s4, s72
    s_and_b32 s5, s73, 0xffff
    s_mov_b32 s6, 10240000
    s_mov_b32 s7, 0x20000
    s_cbranch_vccnz T_pw
T_pwr:
    ds_read_b128 v[76:79], v66 offset:0
    ds_read_b128 v[80:83], v70 offset:0
    ds_read_b128 v[84:87], v67 offset:0
    ds_read_b128 v[88:91], v71 offset:0
    ds_read_b128 v[92:95], v66 offset:1024
    s_waitcnt vmcnt(19) lgkmcnt(4)
    v_mfma_f32_16x16x32_bf16 v[0:3], v[96:99], v[76:79], 0
    v_and_b32 v181, 8, v177
    v_add_u32 v189, v188, v181
    ds_read_b128 v[76:79], v70 offset:1024
    s_waitcnt lgkmcnt(4)
    v_mfma_f32_16x16x32_bf16 v[4:7], v[96:99], v[80:83], 0
    v_add_u32 v181, v180, v181
    v_lshl_add_u32 v64, v180, 4, v182
    ds_read_b128 v[80:83], v67 offset:1024
    s_waitcnt vmcnt(18) lgkmcnt(4)
    v_mfma_f32_16x16x32_bf16 v[0:3], v[100:103], v[84:87], v[0:3]
    v_lshl_add_u32 v65, v188, 4, v182
    v_lshl_add_u32 v68, v180, 4, v184
    ds_read_b128 v[84:87], v71 offset:1024
    s_waitcnt lgkmcnt(4)
    v_mfma_f32_16x16x32_bf16 v[4:7], v[100:103], v[88:91], v[4:7]
    v_lshl_add_u32 v69, v188, 4, v184
    v_lshl_add_u32 v72, v181, 4, v186
    ds_read_b128 v[88:91], v66 offset:128
    s_waitcnt vmcnt(17) lgkmcnt(4)
    v_mfma_f32_16x16x32_bf16 v[0:3], v[104:107], v[92:95], v[0:3]
    v_lshl_add_u32 v73, v189, 4, v186
    v_lshl_add_u32 v74, v181, 4, v187
    ds_read_b128 v[92:95], v66 offset:256
    s_waitcnt lgkmcnt(4)
    v_mfma_f32_16x16x32_bf16 v[4:7], v[104:107], v[76:79], v[4:7]
    v_lshl_add_u32 v75, v189, 4, v187
    s_mov_b32 s67, 0xbfb8aa3b
    ds_read_b128 v[76:79], v66 offset:384
    s_waitcnt vmcnt(16) lgkmcnt(4)
    v_mfma_f32_16x16x32_bf16 v[0:3], v[108:111], v[80:83], v[0:3]
    v_lshrrev_b32 v205, 1, v178
    v_lshl_add_u32 v205, s20, 1, v205
    ds_read_b128 v[80:83], v70 offset:128
    s_waitcnt lgkmcnt(4)
    v_mfma_f32_16x16x32_bf16 v[4:7], v[108:111], v[84:87], v[4:7]
    v_xor_b32 v205, v205, v179
    v_and_b32 v204, 1, v178
    ds_read_b128 v[84:87], v70 offset:256
    s_waitcnt vmcnt(15) lgkmcnt(4)
    v_mfma_f32_16x16x32_bf16 v[12:15], v[128:131], v[88:91], 0
    v_lshlrev_b32 v204, 3, v204
    v_lshl_add_u32 v205, v205, 4, v204
    ds_read_b128 v[88:91], v70 offset:384
    s_waitcnt lgkmcnt(4)
    v_mfma_f32_16x16x32_bf16 v[24:27], v[128:131], v[92:95], 0
    v_and_b32 v220, 8, v177
    v_lshl_add_u32 v204, v220, 4, v205
    ds_read_b128 v[92:95], v67 offset:128
    s_waitcnt lgkmcnt(4)
    v_mfma_f32_16x16x32_bf16 v[36:39], v[128:131], v[76:79], 0
    v_lshl_add_u32 v204, v177, 10, v204
    v_add_u32 v204, 65536, v204
    ds_read_b128 v[76:79], v67 offset:256
    s_waitcnt lgkmcnt(4)
    v_mfma_f32_16x16x32_bf16 v[16:19], v[128:131], v[80:83], 0
    v_add_u32 v205, v205, v182
    v_mul_u32_u24 v220, 1008, v220
    ds_read_b128 v[80:83], v67 offset:384
    s_waitcnt lgkmcnt(4)
    v_mfma_f32_16x16x32_bf16 v[28:31], v[128:131], v[84:87], 0
    v_sub_u32 v220, v204, v220
    s_lshl_b32 s70, s20, 4
    ds_read_b128 v[84:87], v71 offset:128
    s_waitcnt lgkmcnt(4)
    v_mfma_f32_16x16x32_bf16 v[40:43], v[128:131], v[88:91], 0
    v_xor_b32 v206, s70, v246
    s_lshl_b32 s70, s20, 10
    ds_read_b128 v[88:91], v71 offset:256
    s_waitcnt vmcnt(14) lgkmcnt(4)
    v_mfma_f32_16x16x32_bf16 v[12:15], v[132:135], v[92:95], v[12:15]
    s_add_u32 s70, s70, 65536
    v_add_u32 v207, s21, v206
    ds_read_b128 v[92:95], v71 offset:384
    s_waitcnt lgkmcnt(4)
    v_mfma_f32_16x16x32_bf16 v[24:27], v[132:135], v[76:79], v[24:27]
    v_add_u32 v206, s70, v206
    s_mul_i32 s66, s2, 40960
    ds_read_b128 v[76:79], v66 offset:512
    s_waitcnt lgkmcnt(4)
    v_mfma_f32_16x16x32_bf16 v[36:39], v[132:135], v[80:83], v[36:39]
    s_bfe_u32 s22, s22, 393237
    s_lshl_b32 s22, s22, 10
    ds_read_b128 v[80:83], v66 offset:640
    s_waitcnt lgkmcnt(4)
    v_mfma_f32_16x16x32_bf16 v[16:19], v[132:135], v[84:87], v[16:19]
    s_add_u32 s22, s22, s66
    s_bfe_u32 s23, s23, 393237
    ds_read_b128 v[84:87], v66 offset:768
    s_waitcnt lgkmcnt(4)
    v_mfma_f32_16x16x32_bf16 v[28:31], v[132:135], v[88:91], v[28:31]
    s_lshl_b32 s23, s23, 10
    s_add_u32 s23, s23, s66
    ds_read_b128 v[88:91], v70 offset:512
    s_waitcnt lgkmcnt(4)
    v_mfma_f32_16x16x32_bf16 v[40:43], v[132:135], v[92:95], v[40:43]
    s_bfe_u32 s24, s24, 393237
    s_lshl_b32 s24, s24, 10
    ds_read_b128 v[92:95], v70 offset:640
    s_waitcnt vmcnt(13) lgkmcnt(4)
    v_mfma_f32_16x16x32_bf16 v[12:15], v[136:139], v[76:79], v[12:15]
    s_add_u32 s24, s24, s66
    s_bfe_u32 s25, s25, 393237
    ds_read_b128 v[76:79], v70 offset:768
    s_waitcnt lgkmcnt(4)
    v_mfma_f32_16x16x32_bf16 v[24:27], v[136:139], v[80:83], v[24:27]
    s_lshl_b32 s25, s25, 10
    s_add_u32 s25, s25, s66
    ds_read_b128 v[80:83], v67 offset:512
    s_waitcnt lgkmcnt(4)
    v_mfma_f32_16x16x32_bf16 v[36:39], v[136:139], v[84:87], v[36:39]
    s_bfe_u32 s26, s26, 393237
    s_lshl_b32 s26, s26, 10
    ds_read_b128 v[84:87], v67 offset:640
    s_waitcnt lgkmcnt(4)
    v_mfma_f32_16x16x32_bf16 v[16:19], v[136:139], v[88:91], v[16:19]
    s_add_u32 s26, s26, s66
    ds_read_b128 v[88:91], v67 offset:768
    s_waitcnt lgkmcnt(4)
    v_mfma_f32_16x16x32_bf16 v[28:31], v[136:139], v[92:95], v[28:31]
    ds_read_b128 v[92:95], v71 offset:512
    s_waitcnt lgkmcnt(4)
    v_mfma_f32_16x16x32_bf16 v[40:43], v[136:139], v[76:79], v[40:43]
    ds_read_b128 v[76:79], v71 offset:640
    s_waitcnt vmcnt(12) lgkmcnt(4)
    v_mfma_f32_16x16x32_bf16 v[12:15], v[140:143], v[80:83], v[12:15]
    ds_read_b128 v[80:83], v71 offset:768
    s_waitcnt lgkmcnt(4)
    v_mfma_f32_16x16x32_bf16 v[24:27], v[140:143], v[84:87], v[24:27]
    ds_read_b128 v[84:87], v66 offset:1152
    s_waitcnt lgkmcnt(4)
    v_mfma_f32_16x16x32_bf16 v[36:39], v[140:143], v[88:91], v[36:39]
    ds_read_b128 v[88:91], v66 offset:1280
    s_waitcnt lgkmcnt(4)
    v_mfma_f32_16x16x32_bf16 v[16:19], v[140:143], v[92:95], v[16:19]
    ds_read_b128 v[92:95], v66 offset:896
    s_waitcnt lgkmcnt(4)
    v_mfma_f32_16x16x32_bf16 v[28:31], v[140:143], v[76:79], v[28:31]
    ds_read_b128 v[76:79], v70 offset:1152
    s_waitcnt lgkmcnt(4)
    v_mfma_f32_16x16x32_bf16 v[40:43], v[140:143], v[80:83], v[40:43]
    ds_read_b128 v[80:83], v70 offset:1280
    s_waitcnt vmcnt(11) lgkmcnt(4)
    v_mfma_f32_16x16x32_bf16 v[12:15], v[112:115], v[84:87], v[12:15]
    ds_read_b128 v[84:87], v70 offset:896
    s_waitcnt lgkmcnt(4)
    v_mfma_f32_16x16x32_bf16 v[24:27], v[112:115], v[88:91], v[24:27]
    ds_read_b128 v[88:91], v67 offset:1152
    s_waitcnt lgkmcnt(4)
    v_mfma_f32_16x16x32_bf16 v[36:39], v[112:115], v[92:95], v[36:39]
    ds_read_b128 v[92:95], v67 offset:1280
    s_waitcnt lgkmcnt(4)
    v_mfma_f32_16x16x32_bf16 v[16:19], v[112:115], v[76:79], v[16:19]
    ds_read_b128 v[76:79], v67 offset:896
    s_waitcnt lgkmcnt(4)
    v_mfma_f32_16x16x32_bf16 v[28:31], v[112:115], v[80:83], v[28:31]
    ds_read_b32 v191, v190
    ds_read_b128 v[80:83], v71 offset:1152
    s_waitcnt lgkmcnt(5)
    v_mfma_f32_16x16x32_bf16 v[40:43], v[112:115], v[84:87], v[40:43]
    ds_read_b128 v[84:87], v71 offset:1280
    s_waitcnt vmcnt(10) lgkmcnt(5)
    v_mfma_f32_16x16x32_bf16 v[12:15], v[116:119], v[88:91], v[12:15]
    ds_read_b128 v[88:91], v71 offset:896
    s_waitcnt lgkmcnt(5)
    v_mfma_f32_16x16x32_bf16 v[24:27], v[116:119], v[92:95], v[24:27]
    s_waitcnt lgkmcnt(3)
    v_cmp_gt_u32 vcc, s50, v191
    s_cbranch_vccnz T_aw
T_awr:
    ds_read_b128 v[92:95], v64 offset:0
    v_mfma_f32_16x16x32_bf16 v[36:39], v[116:119], v[76:79], v[36:39]
    ds_read_b128 v[76:79], v68 offset:0
    s_waitcnt lgkmcnt(4)
    v_mfma_f32_16x16x32_bf16 v[16:19], v[116:119], v[80:83], v[16:19]
    ds_read_b128 v[80:83], v65 offset:0
    s_waitcnt lgkmcnt(4)
    v_mfma_f32_16x16x32_bf16 v[28:31], v[116:119], v[84:87], v[28:31]
    ds_read_b128 v[84:87], v69 offset:0
    s_waitcnt lgkmcnt(4)
    v_mfma_f32_16x16x32_bf16 v[40:43], v[116:119], v[88:91], v[40:43]
    ds_read_b128 v[88:91], v64 offset:1024
    s_waitcnt vmcnt(9) lgkmcnt(4)
    v_mfma_f32_16x16x32_bf16 v[0:3], v[144:147], v[92:95], v[0:3]
    ds_read_b128 v[92:95], v68 offset:1024
    s_waitcnt lgkmcnt(4)
    v_mfma_f32_16x16x32_bf16 v[4:7], v[144:147], v[76:79], v[4:7]
    ds_read_b128 v[76:79], v65 offset:1024
    s_waitcnt vmcnt(8) lgkmcnt(4)
    v_mfma_f32_16x16x32_bf16 v[0:3], v[148:151], v[80:83], v[0:3]
    ds_read_b128 v[80:83], v69 offset:1024
    s_waitcnt lgkmcnt(4)
    v_mfma_f32_16x16x32_bf16 v[4:7], v[148:151], v[84:87], v[4:7]
    ds_read_b128 v[84:87], v72 offset:0
    s_waitcnt vmcnt(7) lgkmcnt(4)
    v_mfma_f32_16x16x32_bf16 v[0:3], v[160:163], v[88:91], v[0:3]
    ds_read_b128 v[88:91], v73 offset:0
    s_waitcnt lgkmcnt(4)
    v_mfma_f32_16x16x32_bf16 v[4:7], v[160:163], v[92:95], v[4:7]
    ds_read_b128 v[92:95], v74 offset:0
    s_waitcnt vmcnt(6) lgkmcnt(4)
    v_mfma_f32_16x16x32_bf16 v[0:3], v[164:167], v[76:79], v[0:3]
    ds_read_b128 v[76:79], v75 offset:0
    s_waitcnt lgkmcnt(4)
    v_mfma_f32_16x16x32_bf16 v[4:7], v[164:167], v[80:83], v[4:7]
    ds_read_b128 v[80:83], v72 offset:1024
    s_waitcnt lgkmcnt(4)
    v_mfma_f32_16x16x32_bf16 v[8:11], v[144:147], v[84:87], 0
    ds_read_b128 v[84:87], v73 offset:1024
    s_waitcnt lgkmcnt(4)
    v_mfma_f32_16x16x32_bf16 v[8:11], v[148:151], v[88:91], v[8:11]
    v_mul_f32 v192, s67, v0
    v_mul_f32 v193, s67, v1
    ds_read_b128 v[88:91], v74 offset:1024
    s_waitcnt lgkmcnt(4)
    v_mfma_f32_16x16x32_bf16 v[8:11], v[96:99], v[92:95], v[8:11]
    v_mul_f32 v194, s67, v2
    v_mul_f32 v195, s67, v3
    ds_read_b128 v[92:95], v75 offset:1024
    s_waitcnt lgkmcnt(4)
    v_mfma_f32_16x16x32_bf16 v[8:11], v[100:103], v[76:79], v[8:11]
    v_exp_f32 v192, v192
    v_exp_f32 v193, v193
    ds_read_b128 v[76:79], v64 offset:128
    s_waitcnt lgkmcnt(4)
    v_mfma_f32_16x16x32_bf16 v[8:11], v[160:163], v[80:83], v[8:11]
    v_exp_f32 v194, v194
    v_exp_f32 v195, v195
    ds_read_b128 v[80:83], v65 offset:128
    s_waitcnt lgkmcnt(4)
    v_mfma_f32_16x16x32_bf16 v[8:11], v[164:167], v[84:87], v[8:11]
    v_add_f32 v192, 1.0, v192
    v_add_f32 v193, 1.0, v193
    ds_read_b128 v[84:87], v64 offset:512
    s_waitcnt lgkmcnt(4)
    v_mfma_f32_16x16x32_bf16 v[8:11], v[104:107], v[88:91], v[8:11]
    v_add_f32 v194, 1.0, v194
    v_add_f32 v195, 1.0, v195
    ds_read_b128 v[88:91], v65 offset:512
    s_waitcnt lgkmcnt(4)
    v_mfma_f32_16x16x32_bf16 v[8:11], v[108:111], v[92:95], v[8:11]
    v_rcp_f32 v192, v192
    v_rcp_f32 v193, v193
    ds_read_b128 v[92:95], v64 offset:1152
    s_waitcnt vmcnt(5) lgkmcnt(4)
    v_mfma_f32_16x16x32_bf16 v[12:15], v[120:123], v[76:79], v[12:15]
    v_rcp_f32 v194, v194
    v_rcp_f32 v195, v195
    ds_read_b128 v[76:79], v65 offset:1152
    s_waitcnt vmcnt(4) lgkmcnt(4)
    v_mfma_f32_16x16x32_bf16 v[12:15], v[124:127], v[80:83], v[12:15]
    v_cvt_pk_bf16_f32 v0, v0, v1
    v_cvt_pk_bf16_f32 v1, v2, v3
    ds_read_b128 v[80:83], v64 offset:256
    s_waitcnt vmcnt(3) lgkmcnt(4)
    v_mfma_f32_16x16x32_bf16 v[12:15], v[152:155], v[84:87], v[12:15]
    ds_write_b64 v204, v[0:1] offset:0
    v_mul_f32 v196, s67, v4
    ds_read_b128 v[84:87], v65 offset:256
    s_waitcnt vmcnt(2) lgkmcnt(5)
    v_mfma_f32_16x16x32_bf16 v[12:15], v[156:159], v[88:91], v[12:15]
    v_mul_f32 v197, s67, v5
    v_mul_f32 v198, s67, v6
    ds_read_b128 v[88:91], v64 offset:640
    s_waitcnt vmcnt(1) lgkmcnt(5)
    v_mfma_f32_16x16x32_bf16 v[12:15], v[168:171], v[92:95], v[12:15]
    v_mul_f32 v199, s67, v7
    v_exp_f32 v196, v196
    ds_read_b128 v[92:95], v65 offset:640
    s_waitcnt vmcnt(0) lgkmcnt(5)
    v_mfma_f32_16x16x32_bf16 v[12:15], v[172:175], v[76:79], v[12:15]
    v_exp_f32 v197, v197
    v_exp_f32 v198, v198
    ds_read_b128 v[76:79], v64 offset:1280
    s_waitcnt lgkmcnt(5)
    v_mfma_f32_16x16x32_bf16 v[24:27], v[120:123], v[80:83], v[24:27]
    v_exp_f32 v199, v199
    v_add_f32 v196, 1.0, v196
    ds_read_b128 v[80:83], v65 offset:1280
    s_waitcnt lgkmcnt(4)
    v_mfma_f32_16x16x32_bf16 v[24:27], v[124:127], v[84:87], v[24:27]
    v_mul_f32 v12, v12, v192
    v_mul_f32 v13, v13, v193
    ds_read_b128 v[84:87], v64 offset:384
    s_waitcnt lgkmcnt(4)
    v_mfma_f32_16x16x32_bf16 v[24:27], v[152:155], v[88:91], v[24:27]
    v_mul_f32 v14, v14, v194
    v_mul_f32 v15, v15, v195
    ds_read_b128 v[88:91], v65 offset:384
    s_waitcnt lgkmcnt(4)
    v_mfma_f32_16x16x32_bf16 v[24:27], v[156:159], v[92:95], v[24:27]
    v_cvt_pk_bf16_f32 v12, v12, v13
    v_cvt_pk_bf16_f32 v13, v14, v15
    ds_read_b128 v[92:95], v64 offset:768
    s_waitcnt lgkmcnt(4)
    v_mfma_f32_16x16x32_bf16 v[24:27], v[168:171], v[76:79], v[24:27]
    ds_write_b64 v204, v[12:13] offset:256
    v_add_f32 v197, 1.0, v197
    ds_read_b128 v[76:79], v65 offset:768
    s_waitcnt lgkmcnt(5)
    v_mfma_f32_16x16x32_bf16 v[24:27], v[172:175], v[80:83], v[24:27]
    v_add_f32 v198, 1.0, v198
    v_add_f32 v199, 1.0, v199
    ds_read_b128 v[80:83], v64 offset:896
    s_waitcnt lgkmcnt(5)
    v_mfma_f32_16x16x32_bf16 v[36:39], v[120:123], v[84:87], v[36:39]
    v_rcp_f32 v196, v196
    v_rcp_f32 v197, v197
    ds_read_b128 v[84:87], v65 offset:896
    s_waitcnt lgkmcnt(5)
    v_mfma_f32_16x16x32_bf16 v[36:39], v[124:127], v[88:91], v[36:39]
    v_rcp_f32 v198, v198
    v_rcp_f32 v199, v199
    ds_read_b128 v[88:91], v68 offset:128
    s_waitcnt lgkmcnt(5)
    v_mfma_f32_16x16x32_bf16 v[36:39], v[152:155], v[92:95], v[36:39]
    v_mul_f32 v24, v24, v192
    v_mul_f32 v25, v25, v193
    ds_read_b128 v[92:95], v69 offset:128
    s_waitcnt lgkmcnt(4)
    v_mfma_f32_16x16x32_bf16 v[36:39], v[156:159], v[76:79], v[36:39]
    v_mul_f32 v26, v26, v194
    v_mul_f32 v27, v27, v195
    ds_read_b128 v[76:79], v68 offset:512
    s_waitcnt lgkmcnt(4)
    v_mfma_f32_16x16x32_bf16 v[36:39], v[168:171], v[80:83], v[36:39]
    v_cvt_pk_bf16_f32 v24, v24, v25
    v_cvt_pk_bf16_f32 v25, v26, v27
    ds_read_b128 v[80:83], v69 offset:512
    s_waitcnt lgkmcnt(4)
    v_mfma_f32_16x16x32_bf16 v[36:39], v[172:175], v[84:87], v[36:39]
    ds_write_b64 v204, v[24:25] offset:512
    v_mul_f32 v200, s67, v8
    ds_read_b128 v[84:87], v68 offset:1152
    s_waitcnt lgkmcnt(5)
    v_mfma_f32_16x16x32_bf16 v[16:19], v[120:123], v[88:91], v[16:19]
    v_mul_f32 v201, s67, v9
    v_mul_f32 v202, s67, v10
    ds_read_b128 v[88:91], v69 offset:1152
    s_waitcnt lgkmcnt(5)
    v_mfma_f32_16x16x32_bf16 v[16:19], v[124:127], v[92:95], v[16:19]
    v_mul_f32 v203, s67, v11
    v_exp_f32 v200, v200
    ds_read_b128 v[92:95], v68 offset:256
    s_waitcnt lgkmcnt(5)
    v_mfma_f32_16x16x32_bf16 v[16:19], v[152:155], v[76:79], v[16:19]
    v_mul_f32 v36, v36, v192
    v_mul_f32 v37, v37, v193
    ds_read_b128 v[76:79], v69 offset:256
    s_waitcnt lgkmcnt(5)
    v_mfma_f32_16x16x32_bf16 v[16:19], v[156:159], v[80:83], v[16:19]
    v_mul_f32 v38, v38, v194
    v_mul_f32 v39, v39, v195
    ds_read_b128 v[80:83], v68 offset:640
    s_waitcnt lgkmcnt(4)
    v_mfma_f32_16x16x32_bf16 v[16:19], v[168:171], v[84:87], v[16:19]
    v_cvt_pk_bf16_f32 v36, v36, v37
    v_cvt_pk_bf16_f32 v37, v38, v39
    ds_read_b128 v[84:87], v69 offset:640
    s_waitcnt lgkmcnt(4)
    v_mfma_f32_16x16x32_bf16 v[16:19], v[172:175], v[88:91], v[16:19]
    ds_write_b64 v204, v[36:37] offset:768
    v_exp_f32 v201, v201
    ds_read_b128 v[88:91], v68 offset:1280
    s_waitcnt lgkmcnt(5)
    v_mfma_f32_16x16x32_bf16 v[28:31], v[120:123], v[92:95], v[28:31]
    v_exp_f32 v202, v202
    v_exp_f32 v203, v203
    ds_read_b128 v[92:95], v69 offset:1280
    s_waitcnt lgkmcnt(5)
    v_mfma_f32_16x16x32_bf16 v[28:31], v[124:127], v[76:79], v[28:31]
    v_add_f32 v200, 1.0, v200
    v_add_f32 v201, 1.0, v201
    ds_read_b128 v[76:79], v68 offset:384
    s_waitcnt lgkmcnt(5)
    v_mfma_f32_16x16x32_bf16 v[28:31], v[152:155], v[80:83], v[28:31]
    v_add_f32 v202, 1.0, v202
    v_add_f32 v203, 1.0, v203
    ds_read_b128 v[80:83], v69 offset:384
    s_waitcnt lgkmcnt(5)
    v_mfma_f32_16x16x32_bf16 v[28:31], v[156:159], v[84:87], v[28:31]
    v_rcp_f32 v200, v200
    v_rcp_f32 v201, v201
    ds_read_b128 v[84:87], v68 offset:768
    s_waitcnt lgkmcnt(4)
    v_mfma_f32_16x16x32_bf16 v[28:31], v[168:171], v[88:91], v[28:31]
    v_rcp_f32 v202, v202
    v_rcp_f32 v203, v203
    ds_read_b128 v[88:91], v69 offset:768
    s_waitcnt lgkmcnt(4)
    v_mfma_f32_16x16x32_bf16 v[28:31], v[172:175], v[92:95], v[28:31]
    v_mov_b32_dpp v200, v200 row_ror:8 row_mask:0xf bank_mask:0xc
    ds_read_b128 v[92:95], v68 offset:896
    s_waitcnt lgkmcnt(4)
    v_mfma_f32_16x16x32_bf16 v[40:43], v[120:123], v[76:79], v[40:43]
    v_mov_b32_dpp v201, v201 row_ror:8 row_mask:0xf bank_mask:0xc
    v_mov_b32_dpp v202, v202 row_ror:8 row_mask:0xf bank_mask:0xc
    ds_read_b128 v[76:79], v69 offset:896
    s_waitcnt lgkmcnt(4)
    v_mfma_f32_16x16x32_bf16 v[40:43], v[124:127], v[80:83], v[40:43]
    v_mov_b32_dpp v203, v203 row_ror:8 row_mask:0xf bank_mask:0xc
    ds_read_b128 v[80:83], v72 offset:128
    s_waitcnt lgkmcnt(4)
    v_mfma_f32_16x16x32_bf16 v[40:43], v[152:155], v[84:87], v[40:43]
    s_barrier
    ds_read_b128 v[212:215], v206 offset:0
    ds_read_b128 v[84:87], v73 offset:128
    s_waitcnt lgkmcnt(5)
    v_mfma_f32_16x16x32_bf16 v[40:43], v[156:159], v[88:91], v[40:43]
    ds_read_b128 v[216:219], v206 offset:8320
    v_cvt_pk_bf16_f32 v4, v4, v5
    ds_read_b128 v[88:91], v74 offset:128
    s_waitcnt lgkmcnt(6)
    v_mfma_f32_16x16x32_bf16 v[40:43], v[168:171], v[92:95], v[40:43]
    v_cvt_pk_bf16_f32 v5, v6, v7
    ds_write_b64 v205, v[4:5] offset:0
    ds_read_b128 v[92:95], v75 offset:128
    s_waitcnt lgkmcnt(7)
    v_mfma_f32_16x16x32_bf16 v[40:43], v[172:175], v[76:79], v[40:43]
    v_mul_f32 v16, v16, v196
    v_mul_f32 v17, v17, v197
    ds_read_b128 v[76:79], v72 offset:512
    s_waitcnt lgkmcnt(7)
    v_mfma_f32_16x16x32_bf16 v[20:23], v[120:123], v[80:83], 0
    v_mul_f32 v18, v18, v198
    v_mul_f32 v19, v19, v199
    ds_read_b128 v[80:83], v73 offset:512
    s_waitcnt lgkmcnt(6)
    v_mfma_f32_16x16x32_bf16 v[20:23], v[124:127], v[84:87], v[20:23]
    v_cvt_pk_bf16_f32 v16, v16, v17
    v_cvt_pk_bf16_f32 v17, v18, v19
    ds_read_b128 v[84:87], v74 offset:512
    s_waitcnt lgkmcnt(5)
    v_mfma_f32_16x16x32_bf16 v[20:23], v[128:131], v[88:91], v[20:23]
    ds_write_b64 v205, v[16:17] offset:256
    ds_read_b128 v[88:91], v75 offset:512
    s_waitcnt lgkmcnt(5)
    v_mfma_f32_16x16x32_bf16 v[20:23], v[132:135], v[92:95], v[20:23]
    buffer_store_dwordx4 v[212:215], v246, s[4:7], s22 offen sc1
    ds_read_b128 v[92:95], v72 offset:1152
    s_waitcnt lgkmcnt(5)
    v_mfma_f32_16x16x32_bf16 v[20:23], v[152:155], v[76:79], v[20:23]
    buffer_store_dwordx4 v[216:219], v246, s[4:7], s23 offen sc1
    v_mul_f32 v28, v28, v196
    ds_read_b128 v[76:79], v73 offset:1152
    s_waitcnt lgkmcnt(5)
    v_mfma_f32_16x16x32_bf16 v[20:23], v[156:159], v[80:83], v[20:23]
    v_mul_f32 v29, v29, v197
    v_mul_f32 v30, v30, v198
    ds_read_b128 v[80:83], v74 offset:1152
    s_waitcnt lgkmcnt(5)
    v_mfma_f32_16x16x32_bf16 v[20:23], v[136:139], v[84:87], v[20:23]
    v_mul_f32 v31, v31, v199
    v_cvt_pk_bf16_f32 v28, v28, v29
    ds_read_b128 v[84:87], v75 offset:1152
    s_waitcnt lgkmcnt(4)
    v_mfma_f32_16x16x32_bf16 v[20:23], v[140:143], v[88:91], v[20:23]
    v_cvt_pk_bf16_f32 v29, v30, v31
    ds_write_b64 v205, v[28:29] offset:512
    ds_read_b128 v[88:91], v72 offset:384
    s_waitcnt lgkmcnt(5)
    v_mfma_f32_16x16x32_bf16 v[20:23], v[168:171], v[92:95], v[20:23]
    v_mul_f32 v40, v40, v196
    v_mul_f32 v41, v41, v197
    ds_read_b128 v[92:95], v73 offset:384
    s_waitcnt lgkmcnt(5)
    v_mfma_f32_16x16x32_bf16 v[20:23], v[172:175], v[76:79], v[20:23]
    v_mul_f32 v42, v42, v198
    v_mul_f32 v43, v43, v199
    ds_read_b128 v[76:79], v74 offset:384
    s_waitcnt lgkmcnt(5)
    v_mfma_f32_16x16x32_bf16 v[20:23], v[112:115], v[80:83], v[20:23]
    v_cvt_pk_bf16_f32 v40, v40, v41
    v_cvt_pk_bf16_f32 v41, v42, v43
    ds_read_b128 v[80:83], v75 offset:384
    s_waitcnt lgkmcnt(5)
    v_mfma_f32_16x16x32_bf16 v[20:23], v[116:119], v[84:87], v[20:23]
    ds_write_b64 v205, v[40:41] offset:768
    ds_read_b128 v[84:87], v72 offset:768
    s_waitcnt lgkmcnt(5)
    v_mfma_f32_16x16x32_bf16 v[44:47], v[120:123], v[88:91], 0
    ds_read_b128 v[88:91], v73 offset:768
    s_waitcnt lgkmcnt(5)
    v_mfma_f32_16x16x32_bf16 v[44:47], v[124:127], v[92:95], v[44:47]
    s_waitcnt lgkmcnt(2)
    s_barrier
    ds_read_b128 v[92:95], v74 offset:768
    v_mfma_f32_16x16x32_bf16 v[44:47], v[128:131], v[76:79], v[44:47]
    ds_read_b128 v[212:215], v207 offset:0
    ds_read_b128 v[216:219], v207 offset:1664
    ds_read_b128 v[76:79], v75 offset:768
    v_mfma_f32_16x16x32_bf16 v[44:47], v[132:135], v[80:83], v[44:47]
    ds_read_b128 v[80:83], v72 offset:896
    s_waitcnt lgkmcnt(6)
    v_mfma_f32_16x16x32_bf16 v[44:47], v[152:155], v[84:87], v[44:47]
    ds_read_b128 v[84:87], v73 offset:896
    s_waitcnt lgkmcnt(6)
    v_mfma_f32_16x16x32_bf16 v[44:47], v[156:159], v[88:91], v[44:47]
    ds_read_b128 v[88:91], v74 offset:896
    s_waitcnt lgkmcnt(6)
    v_mfma_f32_16x16x32_bf16 v[44:47], v[136:139], v[92:95], v[44:47]
    s_waitcnt lgkmcnt(5)
    buffer_store_dwordx4 v[212:215], v246, s[4:7], s24 offen sc1
    ds_read_b128 v[92:95], v75 offset:896
    s_waitcnt lgkmcnt(4)
    v_mfma_f32_16x16x32_bf16 v[44:47], v[140:143], v[76:79], v[44:47]
    buffer_store_dwordx4 v[216:219], v246, s[4:7], s25 offen sc1
    s_waitcnt lgkmcnt(3)
    v_mfma_f32_16x16x32_bf16 v[44:47], v[168:171], v[80:83], v[44:47]
    v_cvt_pk_bf16_f32 v8, v8, v9
    v_cvt_pk_bf16_f32 v9, v10, v11
    s_waitcnt lgkmcnt(2)
    v_mfma_f32_16x16x32_bf16 v[44:47], v[172:175], v[84:87], v[44:47]
    ds_write_b64 v204, v[8:9] offset:0
    v_mul_f32 v20, v20, v200
    s_waitcnt lgkmcnt(2)
    v_mfma_f32_16x16x32_bf16 v[44:47], v[112:115], v[88:91], v[44:47]
    v_mul_f32 v21, v21, v201
    v_mul_f32 v22, v22, v202
    s_waitcnt lgkmcnt(1)
    v_mfma_f32_16x16x32_bf16 v[44:47], v[116:119], v[92:95], v[44:47]
    v_mul_f32 v23, v23, v203
    v_cvt_pk_bf16_f32 v20, v20, v21
    v_cvt_pk_bf16_f32 v21, v22, v23
    ds_write_b64 v220, v[20:21] offset:256
    s_nop 3
    v_mul_f32 v44, v44, v200
    v_mul_f32 v45, v45, v201
    v_mul_f32 v46, v46, v202
    v_mul_f32 v47, v47, v203
    v_cvt_pk_bf16_f32 v44, v44, v45
    v_cvt_pk_bf16_f32 v45, v46, v47
    ds_write_b64 v204, v[44:45] offset:768
    s_waitcnt lgkmcnt(0)
    s_barrier
    ds_read_b128 v[212:215], v206 offset:0
    s_waitcnt lgkmcnt(0)
    buffer_store_dwordx4 v[212:215], v246, s[4:7], s26 offen sc1
    s_or_b32 s89, s89, s20
    s_cbranch_scc1 K2_end
    v_mov_b32 v0, 0
    v_mov_b32 v1, s88
    s_mov_b64 exec, 1
    buffer_store_dword v1, v0, s[16:19], 0 offen
    s_endpgm
T_pw:
    s_sleep 1
    ds_read_b32 v191, v190
    s_waitcnt lgkmcnt(0)
    v_cmp_gt_u32 vcc, s53, v191
    s_cbranch_vccnz T_pw
    s_branch T_pwr
T_aw:
    s_sleep 1
    ds_read_b32 v191, v190
    s_waitcnt lgkmcnt(0)
    v_cmp_gt_u32 vcc, s50, v191
    s_cbranch_vccnz T_aw
    s_branch T_awr
K2_end:
K2_last:
    s_endpgm
SLOW:
    v_readlane_b32 s89, v4, 62
    s_waitcnt vmcnt(0) lgkmcnt(0)
    s_barrier
    s_load_dwordx2 s[22:23], s[0:1], 8
    s_load_dwordx2 s[24:25], s[0:1], 24
    s_load_dwordx2 s[26:27], s[0:1], 32
    s_load_dwordx2 s[28:29], s[0:1], 40
    s_load_dwordx2 s[30:31], s[0:1], 0
    v_mbcnt_lo_u32_b32 v240, -1, 0
    v_mbcnt_hi_u32_b32 v240, -1, v240
    v_lshrrev_b32 v229, 5, v240
    v_and_b32 v230, 31, v240
    v_lshlrev_b32 v241, 7, v229
    v_lshl_add_u32 v241, v230, 1, v241
    v_lshlrev_b32 v245, 4, v240
    v_mov_b32 v242, 0
    s_waitcnt lgkmcnt(0)
    s_mov_b32 s80, s22
    s_and_b32 s81, s23, 0xffff
    s_mov_b32 s82, 1920000
    s_mov_b32 s83, 0x20000
    s_mov_b32 s76, s24
    s_and_b32 s77, s25, 0xffff
    s_mov_b32 s78, 1280000
    s_mov_b32 s79, 0x20000
    s_mov_b32 s72, s26
    s_and_b32 s73, s27, 0xffff
    s_mov_b32 s74, 1280000
    s_mov_b32 s75, 0x20000
    s_mov_b32 s84, s28
    s_and_b32 s85, s29, 0xffff
    s_mov_b32 s86, 20480
    s_mov_b32 s87, 0x20000
    s_mov_b32 s4, s30
    s_and_b32 s5, s31, 0xffff
    s_mov_b32 s6, 10240000
    s_mov_b32 s7, 0x20000
    s_mov_b32 s66, 0
    buffer_load_ushort v0, v241, s[84:87], s66 offen offset:0
    buffer_load_ushort v1, v241, s[84:87], s66 offen offset:64
    buffer_load_ushort v2, v241, s[84:87], s66 offen offset:256
    buffer_load_ushort v3, v241, s[84:87], s66 offen offset:320
    buffer_load_ushort v4, v241, s[84:87], s66 offen offset:512
    buffer_load_ushort v5, v241, s[84:87], s66 offen offset:576
    buffer_load_ushort v6, v241, s[84:87], s66 offen offset:768
    buffer_load_ushort v7, v241, s[84:87], s66 offen offset:832
    buffer_load_ushort v8, v241, s[84:87], s66 offen offset:1024
    buffer_load_ushort v9, v241, s[84:87], s66 offen offset:1088
    s_waitcnt vmcnt(0)
    s_mov_b32 s66, 1280
    buffer_load_ushort v10, v241, s[84:87], s66 offen offset:0
    buffer_load_ushort v11, v241, s[84:87], s66 offen offset:64
    buffer_load_ushort v12, v241, s[84:87], s66 offen offset:256
    buffer_load_ushort v13, v241, s[84:87], s66 offen offset:320
    buffer_load_ushort v14, v241, s[84:87], s66 offen offset:512
    buffer_load_ushort v15, v241, s[84:87], s66 offen offset:576
    buffer_load_ushort v16, v241, s[84:87], s66 offen offset:768
    buffer_load_ushort v17, v241, s[84:87], s66 offen offset:832
    buffer_load_ushort v18, v241, s[84:87], s66 offen offset:1024
    buffer_load_ushort v19, v241, s[84:87], s66 offen offset:1088
    s_waitcnt vmcnt(0)
    s_mov_b32 s66, 2560
    buffer_load_ushort v20, v241, s[84:87], s66 offen offset:0
    buffer_load_ushort v21, v241, s[84:87], s66 offen offset:64
    buffer_load_ushort v22, v241, s[84:87], s66 offen offset:256
    buffer_load_ushort v23, v241, s[84:87], s66 offen offset:320
    buffer_load_ushort v24, v241, s[84:87], s66 offen offset:512
    buffer_load_ushort v25, v241, s[84:87], s66 offen offset:576
    buffer_load_ushort v26, v241, s[84:87], s66 offen offset:768
    buffer_load_ushort v27, v241, s[84:87], s66 offen offset:832
    buffer_load_ushort v28, v241, s[84:87], s66 offen offset:1024
    buffer_load_ushort v29, v241, s[84:87], s66 offen offset:1088
    s_waitcnt vmcnt(0)
    s_mov_b32 s66, 3840
    buffer_load_ushort v30, v241, s[84:87], s66 offen offset:0
    buffer_load_ushort v31, v241, s[84:87], s66 offen offset:64
    buffer_load_ushort v32, v241, s[84:87], s66 offen offset:256
    buffer_load_ushort v33, v241, s[84:87], s66 offen offset:320
    buffer_load_ushort v34, v241, s[84:87], s66 offen offset:512
    buffer_load_ushort v35, v241, s[84:87], s66 offen offset:576
    buffer_load_ushort v36, v241, s[84:87], s66 offen offset:768
    buffer_load_ushort v37, v241, s[84:87], s66 offen offset:832
    buffer_load_ushort v38, v241, s[84:87], s66 offen offset:1024
    buffer_load_ushort v39, v241, s[84:87], s66 offen offset:1088
    s_waitcnt vmcnt(0)
    s_mov_b32 s66, 5120
    buffer_load_ushort v40, v241, s[84:87], s66 offen offset:0
    buffer_load_ushort v41, v241, s[84:87], s66 offen offset:64
    buffer_load_ushort v42, v241, s[84:87], s66 offen offset:256
    buffer_load_ushort v43, v241, s[84:87], s66 offen offset:320
    buffer_load_ushort v44, v241, s[84:87], s66 offen offset:512
    buffer_load_ushort v45, v241, s[84:87], s66 offen offset:576
    buffer_load_ushort v46, v241, s[84:87], s66 offen offset:768
    buffer_load_ushort v47, v241, s[84:87], s66 offen offset:832
    buffer_load_ushort v48, v241, s[84:87], s66 offen offset:1024
    buffer_load_ushort v49, v241, s[84:87], s66 offen offset:1088
    s_waitcnt vmcnt(0)
    s_mov_b32 s66, 6400
    buffer_load_ushort v50, v241, s[84:87], s66 offen offset:0
    buffer_load_ushort v51, v241, s[84:87], s66 offen offset:64
    buffer_load_ushort v52, v241, s[84:87], s66 offen offset:256
    buffer_load_ushort v53, v241, s[84:87], s66 offen offset:320
    buffer_load_ushort v54, v241, s[84:87], s66 offen offset:512
    buffer_load_ushort v55, v241, s[84:87], s66 offen offset:576
    buffer_load_ushort v56, v241, s[84:87], s66 offen offset:768
    buffer_load_ushort v57, v241, s[84:87], s66 offen offset:832
    buffer_load_ushort v58, v241, s[84:87], s66 offen offset:1024
    buffer_load_ushort v59, v241, s[84:87], s66 offen offset:1088
    s_waitcnt vmcnt(0)
    s_mov_b32 s66, 7680
    buffer_load_ushort v60, v241, s[84:87], s66 offen offset:0
    buffer_load_ushort v61, v241, s[84:87], s66 offen offset:64
    buffer_load_ushort v62, v241, s[84:87], s66 offen offset:256
    buffer_load_ushort v63, v241, s[84:87], s66 offen offset:320
    buffer_load_ushort v64, v241, s[84:87], s66 offen offset:512
    buffer_load_ushort v65, v241, s[84:87], s66 offen offset:576
    buffer_load_ushort v66, v241, s[84:87], s66 offen offset:768
    buffer_load_ushort v67, v241, s[84:87], s66 offen offset:832
    buffer_load_ushort v68, v241, s[84:87], s66 offen offset:1024
    buffer_load_ushort v69, v241, s[84:87], s66 offen offset:1088
    s_waitcnt vmcnt(0)
    s_mov_b32 s66, 8960
    buffer_load_ushort v70, v241, s[84:87], s66 offen offset:0
    buffer_load_ushort v71, v241, s[84:87], s66 offen offset:64
    buffer_load_ushort v72, v241, s[84:87], s66 offen offset:256
    buffer_load_ushort v73, v241, s[84:87], s66 offen offset:320
    buffer_load_ushort v74, v241, s[84:87], s66 offen offset:512
    buffer_load_ushort v75, v241, s[84:87], s66 offen offset:576
    buffer_load_ushort v76, v241, s[84:87], s66 offen offset:768
    buffer_load_ushort v77, v241, s[84:87], s66 offen offset:832
    buffer_load_ushort v78, v241, s[84:87], s66 offen offset:1024
    buffer_load_ushort v79, v241, s[84:87], s66 offen offset:1088
    s_waitcnt vmcnt(0)
    s_mov_b32 s66, 10240
    buffer_load_ushort v80, v241, s[84:87], s66 offen offset:0
    buffer_load_ushort v81, v241, s[84:87], s66 offen offset:64
    buffer_load_ushort v82, v241, s[84:87], s66 offen offset:256
    buffer_load_ushort v83, v241, s[84:87], s66 offen offset:320
    buffer_load_ushort v84, v241, s[84:87], s66 offen offset:512
    buffer_load_ushort v85, v241, s[84:87], s66 offen offset:576
    buffer_load_ushort v86, v241, s[84:87], s66 offen offset:768
    buffer_load_ushort v87, v241, s[84:87], s66 offen offset:832
    buffer_load_ushort v88, v241, s[84:87], s66 offen offset:1024
    buffer_load_ushort v89, v241, s[84:87], s66 offen offset:1088
    s_waitcnt vmcnt(0)
    s_mov_b32 s66, 11520
    buffer_load_ushort v90, v241, s[84:87], s66 offen offset:0
    buffer_load_ushort v91, v241, s[84:87], s66 offen offset:64
    buffer_load_ushort v92, v241, s[84:87], s66 offen offset:256
    buffer_load_ushort v93, v241, s[84:87], s66 offen offset:320
    buffer_load_ushort v94, v241, s[84:87], s66 offen offset:512
    buffer_load_ushort v95, v241, s[84:87], s66 offen offset:576
    buffer_load_ushort v96, v241, s[84:87], s66 offen offset:768
    buffer_load_ushort v97, v241, s[84:87], s66 offen offset:832
    buffer_load_ushort v98, v241, s[84:87], s66 offen offset:1024
    buffer_load_ushort v99, v241, s[84:87], s66 offen offset:1088
    s_waitcnt vmcnt(0)
    s_mov_b32 s66, 12800
    buffer_load_ushort v100, v241, s[84:87], s66 offen offset:0
    buffer_load_ushort v101, v241, s[84:87], s66 offen offset:64
    buffer_load_ushort v102, v241, s[84:87], s66 offen offset:256
    buffer_load_ushort v103, v241, s[84:87], s66 offen offset:320
    buffer_load_ushort v104, v241, s[84:87], s66 offen offset:512
    buffer_load_ushort v105, v241, s[84:87], s66 offen offset:576
    buffer_load_ushort v106, v241, s[84:87], s66 offen offset:768
    buffer_load_ushort v107, v241, s[84:87], s66 offen offset:832
    buffer_load_ushort v108, v241, s[84:87], s66 offen offset:1024
    buffer_load_ushort v109, v241, s[84:87], s66 offen offset:1088
    s_waitcnt vmcnt(0)
    s_mov_b32 s66, 14080
    buffer_load_ushort v110, v241, s[84:87], s66 offen offset:0
    buffer_load_ushort v111, v241, s[84:87], s66 offen offset:64
    buffer_load_ushort v112, v241, s[84:87], s66 offen offset:256
    buffer_load_ushort v113, v241, s[84:87], s66 offen offset:320
    buffer_load_ushort v114, v241, s[84:87], s66 offen offset:512
    buffer_load_ushort v115, v241, s[84:87], s66 offen offset:576
    buffer_load_ushort v116, v241, s[84:87], s66 offen offset:768
    buffer_load_ushort v117, v241, s[84:87], s66 offen offset:832
    buffer_load_ushort v118, v241, s[84:87], s66 offen offset:1024
    buffer_load_ushort v119, v241, s[84:87], s66 offen offset:1088
    s_waitcnt vmcnt(0)
    s_mov_b32 s66, 15360
    buffer_load_ushort v120, v241, s[84:87], s66 offen offset:0
    buffer_load_ushort v121, v241, s[84:87], s66 offen offset:64
    buffer_load_ushort v122, v241, s[84:87], s66 offen offset:256
    buffer_load_ushort v123, v241, s[84:87], s66 offen offset:320
    buffer_load_ushort v124, v241, s[84:87], s66 offen offset:512
    buffer_load_ushort v125, v241, s[84:87], s66 offen offset:576
    buffer_load_ushort v126, v241, s[84:87], s66 offen offset:768
    buffer_load_ushort v127, v241, s[84:87], s66 offen offset:832
    buffer_load_ushort v128, v241, s[84:87], s66 offen offset:1024
    buffer_load_ushort v129, v241, s[84:87], s66 offen offset:1088
    s_waitcnt vmcnt(0)
    s_mov_b32 s66, 16640
    buffer_load_ushort v130, v241, s[84:87], s66 offen offset:0
    buffer_load_ushort v131, v241, s[84:87], s66 offen offset:64
    buffer_load_ushort v132, v241, s[84:87], s66 offen offset:256
    buffer_load_ushort v133, v241, s[84:87], s66 offen offset:320
    buffer_load_ushort v134, v241, s[84:87], s66 offen offset:512
    buffer_load_ushort v135, v241, s[84:87], s66 offen offset:576
    buffer_load_ushort v136, v241, s[84:87], s66 offen offset:768
    buffer_load_ushort v137, v241, s[84:87], s66 offen offset:832
    buffer_load_ushort v138, v241, s[84:87], s66 offen offset:1024
    buffer_load_ushort v139, v241, s[84:87], s66 offen offset:1088
    s_waitcnt vmcnt(0)
    s_mov_b32 s66, 17920
    buffer_load_ushort v140, v241, s[84:87], s66 offen offset:0
    buffer_load_ushort v141, v241, s[84:87], s66 offen offset:64
    buffer_load_ushort v142, v241, s[84:87], s66 offen offset:256
    buffer_load_ushort v143, v241, s[84:87], s66 offen offset:320
    buffer_load_ushort v144, v241, s[84:87], s66 offen offset:512
    buffer_load_ushort v145, v241, s[84:87], s66 offen offset:576
    buffer_load_ushort v146, v241, s[84:87], s66 offen offset:768
    buffer_load_ushort v147, v241, s[84:87], s66 offen offset:832
    buffer_load_ushort v148, v241, s[84:87], s66 offen offset:1024
    buffer_load_ushort v149, v241, s[84:87], s66 offen offset:1088
    s_waitcnt vmcnt(0)
    s_mov_b32 s66, 19200
    buffer_load_ushort v150, v241, s[84:87], s66 offen offset:0
    buffer_load_ushort v151, v241, s[84:87], s66 offen offset:64
    buffer_load_ushort v152, v241, s[84:87], s66 offen offset:256
    buffer_load_ushort v153, v241, s[84:87], s66 offen offset:320
    buffer_load_ushort v154, v241, s[84:87], s66 offen offset:512
    buffer_load_ushort v155, v241, s[84:87], s66 offen offset:576
    buffer_load_ushort v156, v241, s[84:87], s66 offen offset:768
    buffer_load_ushort v157, v241, s[84:87], s66 offen offset:832
    buffer_load_ushort v158, v241, s[84:87], s66 offen offset:1024
    buffer_load_ushort v159, v241, s[84:87], s66 offen offset:1088
    s_waitcnt vmcnt(0)
    v_lshlrev_b32 v0, 16, v0
    v_lshlrev_b32 v1, 16, v1
    v_lshlrev_b32 v2, 16, v2
    v_lshlrev_b32 v3, 16, v3
    v_lshlrev_b32 v4, 16, v4
    v_lshlrev_b32 v5, 16, v5
    v_lshlrev_b32 v6, 16, v6
    v_lshlrev_b32 v7, 16, v7
    v_lshlrev_b32 v8, 16, v8
    v_lshlrev_b32 v9, 16, v9
    v_lshlrev_b32 v10, 16, v10
    v_lshlrev_b32 v11, 16, v11
    v_lshlrev_b32 v12, 16, v12
    v_lshlrev_b32 v13, 16, v13
    v_lshlrev_b32 v14, 16, v14
    v_lshlrev_b32 v15, 16, v15
    v_lshlrev_b32 v16, 16, v16
    v_lshlrev_b32 v17, 16, v17
    v_lshlrev_b32 v18, 16, v18
    v_lshlrev_b32 v19, 16, v19
    v_lshlrev_b32 v20, 16, v20
    v_lshlrev_b32 v21, 16, v21
    v_lshlrev_b32 v22, 16, v22
    v_lshlrev_b32 v23, 16, v23
    v_lshlrev_b32 v24, 16, v24
    v_lshlrev_b32 v25, 16, v25
    v_lshlrev_b32 v26, 16, v26
    v_lshlrev_b32 v27, 16, v27
    v_lshlrev_b32 v28, 16, v28
    v_lshlrev_b32 v29, 16, v29
    v_lshlrev_b32 v30, 16, v30
    v_lshlrev_b32 v31, 16, v31
    v_lshlrev_b32 v32, 16, v32
    v_lshlrev_b32 v33, 16, v33
    v_lshlrev_b32 v34, 16, v34
    v_lshlrev_b32 v35, 16, v35
    v_lshlrev_b32 v36, 16, v36
    v_lshlrev_b32 v37, 16, v37
    v_lshlrev_b32 v38, 16, v38
    v_lshlrev_b32 v39, 16, v39
    v_lshlrev_b32 v40, 16, v40
    v_lshlrev_b32 v41, 16, v41
    v_lshlrev_b32 v42, 16, v42
    v_lshlrev_b32 v43, 16, v43
    v_lshlrev_b32 v44, 16, v44
    v_lshlrev_b32 v45, 16, v45
    v_lshlrev_b32 v46, 16, v46
    v_lshlrev_b32 v47, 16, v47
    v_lshlrev_b32 v48, 16, v48
    v_lshlrev_b32 v49, 16, v49
    v_lshlrev_b32 v50, 16, v50
    v_lshlrev_b32 v51, 16, v51
    v_lshlrev_b32 v52, 16, v52
    v_lshlrev_b32 v53, 16, v53
    v_lshlrev_b32 v54, 16, v54
    v_lshlrev_b32 v55, 16, v55
    v_lshlrev_b32 v56, 16, v56
    v_lshlrev_b32 v57, 16, v57
    v_lshlrev_b32 v58, 16, v58
    v_lshlrev_b32 v59, 16, v59
    v_lshlrev_b32 v60, 16, v60
    v_lshlrev_b32 v61, 16, v61
    v_lshlrev_b32 v62, 16, v62
    v_lshlrev_b32 v63, 16, v63
    v_lshlrev_b32 v64, 16, v64
    v_lshlrev_b32 v65, 16, v65
    v_lshlrev_b32 v66, 16, v66
    v_lshlrev_b32 v67, 16, v67
    v_lshlrev_b32 v68, 16, v68
    v_lshlrev_b32 v69, 16, v69
    v_lshlrev_b32 v70, 16, v70
    v_lshlrev_b32 v71, 16, v71
    v_lshlrev_b32 v72, 16, v72
    v_lshlrev_b32 v73, 16, v73
    v_lshlrev_b32 v74, 16, v74
    v_lshlrev_b32 v75, 16, v75
    v_lshlrev_b32 v76, 16, v76
    v_lshlrev_b32 v77, 16, v77
    v_lshlrev_b32 v78, 16, v78
    v_lshlrev_b32 v79, 16, v79
    v_lshlrev_b32 v80, 16, v80
    v_lshlrev_b32 v81, 16, v81
    v_lshlrev_b32 v82, 16, v82
    v_lshlrev_b32 v83, 16, v83
    v_lshlrev_b32 v84, 16, v84
    v_lshlrev_b32 v85, 16, v85
    v_lshlrev_b32 v86, 16, v86
    v_lshlrev_b32 v87, 16, v87
    v_lshlrev_b32 v88, 16, v88
    v_lshlrev_b32 v89, 16, v89
    v_lshlrev_b32 v90, 16, v90
    v_lshlrev_b32 v91, 16, v91
    v_lshlrev_b32 v92, 16, v92
    v_lshlrev_b32 v93, 16, v93
    v_lshlrev_b32 v94, 16, v94
    v_lshlrev_b32 v95, 16, v95
    v_lshlrev_b32 v96, 16, v96
    v_lshlrev_b32 v97, 16, v97
    v_lshlrev_b32 v98, 16, v98
    v_lshlrev_b32 v99, 16, v99
    v_lshlrev_b32 v100, 16, v100
    v_lshlrev_b32 v101, 16, v101
    v_lshlrev_b32 v102, 16, v102
    v_lshlrev_b32 v103, 16, v103
    v_lshlrev_b32 v104, 16, v104
    v_lshlrev_b32 v105, 16, v105
    v_lshlrev_b32 v106, 16, v106
    v_lshlrev_b32 v107, 16, v107
    v_lshlrev_b32 v108, 16, v108
    v_lshlrev_b32 v109, 16, v109
    v_lshlrev_b32 v110, 16, v110
    v_lshlrev_b32 v111, 16, v111
    v_lshlrev_b32 v112, 16, v112
    v_lshlrev_b32 v113, 16, v113
    v_lshlrev_b32 v114, 16, v114
    v_lshlrev_b32 v115, 16, v115
    v_lshlrev_b32 v116, 16, v116
    v_lshlrev_b32 v117, 16, v117
    v_lshlrev_b32 v118, 16, v118
    v_lshlrev_b32 v119, 16, v119
    v_lshlrev_b32 v120, 16, v120
    v_lshlrev_b32 v121, 16, v121
    v_lshlrev_b32 v122, 16, v122
    v_lshlrev_b32 v123, 16, v123
    v_lshlrev_b32 v124, 16, v124
    v_lshlrev_b32 v125, 16, v125
    v_lshlrev_b32 v126, 16, v126
    v_lshlrev_b32 v127, 16, v127
    v_lshlrev_b32 v128, 16, v128
    v_lshlrev_b32 v129, 16, v129
    v_lshlrev_b32 v130, 16, v130
    v_lshlrev_b32 v131, 16, v131
    v_lshlrev_b32 v132, 16, v132
    v_lshlrev_b32 v133, 16, v133
    v_lshlrev_b32 v134, 16, v134
    v_lshlrev_b32 v135, 16, v135
    v_lshlrev_b32 v136, 16, v136
    v_lshlrev_b32 v137, 16, v137
    v_lshlrev_b32 v138, 16, v138
    v_lshlrev_b32 v139, 16, v139
    v_lshlrev_b32 v140, 16, v140
    v_lshlrev_b32 v141, 16, v141
    v_lshlrev_b32 v142, 16, v142
    v_lshlrev_b32 v143, 16, v143
    v_lshlrev_b32 v144, 16, v144
    v_lshlrev_b32 v145, 16, v145
    v_lshlrev_b32 v146, 16, v146
    v_lshlrev_b32 v147, 16, v147
    v_lshlrev_b32 v148, 16, v148
    v_lshlrev_b32 v149, 16, v149
    v_lshlrev_b32 v150, 16, v150
    v_lshlrev_b32 v151, 16, v151
    v_lshlrev_b32 v152, 16, v152
    v_lshlrev_b32 v153, 16, v153
    v_lshlrev_b32 v154, 16, v154
    v_lshlrev_b32 v155, 16, v155
    v_lshlrev_b32 v156, 16, v156
    v_lshlrev_b32 v157, 16, v157
    v_lshlrev_b32 v158, 16, v158
    v_lshlrev_b32 v159, 16, v159
    s_mov_b32 s50, 0
SL_node:
    s_mul_i32 s34, s2, 40
    s_lshl_b32 s66, s50, 3
    s_add_u32 s66, s66, s20
    s_add_u32 s34, s34, s66
    v_mov_b32 v160, 0
    v_mov_b32 v161, 0
    v_mov_b32 v162, 0
    v_mov_b32 v163, 0
    v_mov_b32 v164, 0
    v_mov_b32 v165, 0
    v_mov_b32 v166, 0
    v_mov_b32 v167, 0
    v_mov_b32 v168, 0
    v_mov_b32 v169, 0
    v_mov_b32 v170, 0
    v_mov_b32 v171, 0
    v_mov_b32 v172, 0
    v_mov_b32 v173, 0
    v_mov_b32 v174, 0
    v_mov_b32 v175, 0
    v_mov_b32 v176, 0
    v_mov_b32 v177, 0
    v_mov_b32 v178, 0
    v_mov_b32 v179, 0
    v_mov_b32 v180, 0
    v_mov_b32 v181, 0
    s_mov_b32 s35, 0
SL_scan:
    s_lshl_b32 s66, s35, 2
    buffer_load_dwordx4 v[236:239], v245, s[72:75], s66 offen
    s_waitcnt vmcnt(0)
    v_cmp_eq_u32 s[38:39], s34, v236
    v_cmp_eq_u32 s[40:41], s34, v237
    v_cmp_eq_u32 s[42:43], s34, v238
    v_cmp_eq_u32 s[44:45], s34, v239
    s_mov_b32 s36, 0
SL_bits:
    s_cmp_eq_u64 s[38:39], 0
    s_cbranch_scc1 SL_nexti
    s_ff1_i32_b64 s66, s[38:39]
    s_bitset0_b64 s[38:39], s66
    s_lshl_b32 s66, s66, 2
    s_add_u32 s37, s66, s36
    s_add_u32 s37, s37, s35
    s_lshl_b32 s66, s37, 2
    s_lshl_b32 s67, s37, 5
    s_mul_i32 s68, s37, 6
    buffer_load_dword v243, v242, s[76:79], s66 offen
    buffer_load_dwordx4 v[184:187], v242, s[12:15], s67 offen
    buffer_load_dwordx4 v[188:191], v242, s[12:15], s67 offen offset:16
    buffer_load_ushort v226, v242, s[80:83], s68 offen offset:0
    buffer_load_ushort v227, v242, s[80:83], s68 offen offset:2
    buffer_load_ushort v228, v242, s[80:83], s68 offen offset:4
    s_waitcnt vmcnt(5)
    v_lshl_add_u32 v243, v243, 10, v241
    buffer_load_ushort v208, v243, s[4:7], 0 offen offset:0
    buffer_load_ushort v209, v243, s[4:7], 0 offen offset:64
    buffer_load_ushort v210, v243, s[4:7], 0 offen offset:256
    buffer_load_ushort v211, v243, s[4:7], 0 offen offset:320
    buffer_load_ushort v212, v243, s[4:7], 0 offen offset:512
    buffer_load_ushort v213, v243, s[4:7], 0 offen offset:576
    buffer_load_ushort v214, v243, s[4:7], 0 offen offset:768
    buffer_load_ushort v215, v243, s[4:7], 0 offen offset:832
    s_waitcnt vmcnt(8)
    v_lshlrev_b32 v192, 16, v184
    v_and_b32 v193, 0xffff0000, v184
    v_lshlrev_b32 v194, 16, v185
    v_and_b32 v195, 0xffff0000, v185
    v_lshlrev_b32 v196, 16, v186
    v_and_b32 v197, 0xffff0000, v186
    v_lshlrev_b32 v198, 16, v187
    v_and_b32 v199, 0xffff0000, v187
    v_lshlrev_b32 v200, 16, v188
    v_and_b32 v201, 0xffff0000, v188
    v_lshlrev_b32 v202, 16, v189
    v_and_b32 v203, 0xffff0000, v189
    v_lshlrev_b32 v204, 16, v190
    v_and_b32 v205, 0xffff0000, v190
    v_lshlrev_b32 v206, 16, v191
    v_and_b32 v207, 0xffff0000, v191
    v_lshlrev_b32 v226, 16, v226
    v_lshlrev_b32 v227, 16, v227
    v_lshlrev_b32 v228, 16, v228
    v_mul_f32 v216, v192, v0
    v_mul_f32 v217, v192, v1
    v_mul_f32 v218, v192, v2
    v_mul_f32 v219, v192, v3
    v_mul_f32 v220, v192, v4
    v_mul_f32 v221, v192, v5
    v_mul_f32 v222, v192, v6
    v_mul_f32 v223, v192, v7
    v_mul_f32 v224, v192, v8
    v_mul_f32 v225, v192, v9
    v_fmac_f32 v216, v193, v10
    v_fmac_f32 v217, v193, v11
    v_fmac_f32 v218, v193, v12
    v_fmac_f32 v219, v193, v13
    v_fmac_f32 v220, v193, v14
    v_fmac_f32 v221, v193, v15
    v_fmac_f32 v222, v193, v16
    v_fmac_f32 v223, v193, v17
    v_fmac_f32 v224, v193, v18
    v_fmac_f32 v225, v193, v19
    v_fmac_f32 v216, v194, v20
    v_fmac_f32 v217, v194, v21
    v_fmac_f32 v218, v194, v22
    v_fmac_f32 v219, v194, v23
    v_fmac_f32 v220, v194, v24
    v_fmac_f32 v221, v194, v25
    v_fmac_f32 v222, v194, v26
    v_fmac_f32 v223, v194, v27
    v_fmac_f32 v224, v194, v28
    v_fmac_f32 v225, v194, v29
    v_fmac_f32 v216, v195, v30
    v_fmac_f32 v217, v195, v31
    v_fmac_f32 v218, v195, v32
    v_fmac_f32 v219, v195, v33
    v_fmac_f32 v220, v195, v34
    v_fmac_f32 v221, v195, v35
    v_fmac_f32 v222, v195, v36
    v_fmac_f32 v223, v195, v37
    v_fmac_f32 v224, v195, v38
    v_fmac_f32 v225, v195, v39
    v_fmac_f32 v216, v196, v40
    v_fmac_f32 v217, v196, v41
    v_fmac_f32 v218, v196, v42
    v_fmac_f32 v219, v196, v43
    v_fmac_f32 v220, v196, v44
    v_fmac_f32 v221, v196, v45
    v_fmac_f32 v222, v196, v46
    v_fmac_f32 v223, v196, v47
    v_fmac_f32 v224, v196, v48
    v_fmac_f32 v225, v196, v49
    v_fmac_f32 v216, v197, v50
    v_fmac_f32 v217, v197, v51
    v_fmac_f32 v218, v197, v52
    v_fmac_f32 v219, v197, v53
    v_fmac_f32 v220, v197, v54
    v_fmac_f32 v221, v197, v55
    v_fmac_f32 v222, v197, v56
    v_fmac_f32 v223, v197, v57
    v_fmac_f32 v224, v197, v58
    v_fmac_f32 v225, v197, v59
    v_fmac_f32 v216, v198, v60
    v_fmac_f32 v217, v198, v61
    v_fmac_f32 v218, v198, v62
    v_fmac_f32 v219, v198, v63
    v_fmac_f32 v220, v198, v64
    v_fmac_f32 v221, v198, v65
    v_fmac_f32 v222, v198, v66
    v_fmac_f32 v223, v198, v67
    v_fmac_f32 v224, v198, v68
    v_fmac_f32 v225, v198, v69
    v_fmac_f32 v216, v199, v70
    v_fmac_f32 v217, v199, v71
    v_fmac_f32 v218, v199, v72
    v_fmac_f32 v219, v199, v73
    v_fmac_f32 v220, v199, v74
    v_fmac_f32 v221, v199, v75
    v_fmac_f32 v222, v199, v76
    v_fmac_f32 v223, v199, v77
    v_fmac_f32 v224, v199, v78
    v_fmac_f32 v225, v199, v79
    v_fmac_f32 v216, v200, v80
    v_fmac_f32 v217, v200, v81
    v_fmac_f32 v218, v200, v82
    v_fmac_f32 v219, v200, v83
    v_fmac_f32 v220, v200, v84
    v_fmac_f32 v221, v200, v85
    v_fmac_f32 v222, v200, v86
    v_fmac_f32 v223, v200, v87
    v_fmac_f32 v224, v200, v88
    v_fmac_f32 v225, v200, v89
    v_fmac_f32 v216, v201, v90
    v_fmac_f32 v217, v201, v91
    v_fmac_f32 v218, v201, v92
    v_fmac_f32 v219, v201, v93
    v_fmac_f32 v220, v201, v94
    v_fmac_f32 v221, v201, v95
    v_fmac_f32 v222, v201, v96
    v_fmac_f32 v223, v201, v97
    v_fmac_f32 v224, v201, v98
    v_fmac_f32 v225, v201, v99
    v_fmac_f32 v216, v202, v100
    v_fmac_f32 v217, v202, v101
    v_fmac_f32 v218, v202, v102
    v_fmac_f32 v219, v202, v103
    v_fmac_f32 v220, v202, v104
    v_fmac_f32 v221, v202, v105
    v_fmac_f32 v222, v202, v106
    v_fmac_f32 v223, v202, v107
    v_fmac_f32 v224, v202, v108
    v_fmac_f32 v225, v202, v109
    v_fmac_f32 v216, v203, v110
    v_fmac_f32 v217, v203, v111
    v_fmac_f32 v218, v203, v112
    v_fmac_f32 v219, v203, v113
    v_fmac_f32 v220, v203, v114
    v_fmac_f32 v221, v203, v115
    v_fmac_f32 v222, v203, v116
    v_fmac_f32 v223, v203, v117
    v_fmac_f32 v224, v203, v118
    v_fmac_f32 v225, v203, v119
    v_fmac_f32 v216, v204, v120
    v_fmac_f32 v217, v204, v121
    v_fmac_f32 v218, v204, v122
    v_fmac_f32 v219, v204, v123
    v_fmac_f32 v220, v204, v124
    v_fmac_f32 v221, v204, v125
    v_fmac_f32 v222, v204, v126
    v_fmac_f32 v223, v204, v127
    v_fmac_f32 v224, v204, v128
    v_fmac_f32 v225, v204, v129
    v_fmac_f32 v216, v205, v130
    v_fmac_f32 v217, v205, v131
    v_fmac_f32 v218, v205, v132
    v_fmac_f32 v219, v205, v133
    v_fmac_f32 v220, v205, v134
    v_fmac_f32 v221, v205, v135
    v_fmac_f32 v222, v205, v136
    v_fmac_f32 v223, v205, v137
    v_fmac_f32 v224, v205, v138
    v_fmac_f32 v225, v205, v139
    v_fmac_f32 v216, v206, v140
    v_fmac_f32 v217, v206, v141
    v_fmac_f32 v218, v206, v142
    v_fmac_f32 v219, v206, v143
    v_fmac_f32 v220, v206, v144
    v_fmac_f32 v221, v206, v145
    v_fmac_f32 v222, v206, v146
    v_fmac_f32 v223, v206, v147
    v_fmac_f32 v224, v206, v148
    v_fmac_f32 v225, v206, v149
    v_fmac_f32 v216, v207, v150
    v_fmac_f32 v217, v207, v151
    v_fmac_f32 v218, v207, v152
    v_fmac_f32 v219, v207, v153
    v_fmac_f32 v220, v207, v154
    v_fmac_f32 v221, v207, v155
    v_fmac_f32 v222, v207, v156
    v_fmac_f32 v223, v207, v157
    v_fmac_f32 v224, v207, v158
    v_fmac_f32 v225, v207, v159
    s_waitcnt vmcnt(0)
    v_lshlrev_b32 v208, 16, v208
    v_lshlrev_b32 v209, 16, v209
    v_lshlrev_b32 v210, 16, v210
    v_lshlrev_b32 v211, 16, v211
    v_lshlrev_b32 v212, 16, v212
    v_lshlrev_b32 v213, 16, v213
    v_lshlrev_b32 v214, 16, v214
    v_lshlrev_b32 v215, 16, v215
    v_fmac_f32 v160, v208, v216
    v_mul_f32 v229, v210, v226
    v_fmac_f32 v229, v212, v227
    v_fmac_f32 v229, v214, v228
    v_fmac_f32 v176, v229, v218
    v_mul_f32 v229, v208, v220
    v_fmac_f32 v162, v229, v226
    v_fmac_f32 v168, v210, v222
    v_mul_f32 v230, v227, v214
    v_fma_f32 v230, -v228, v212, v230
    v_fmac_f32 v178, v230, v224
    v_fmac_f32 v164, v229, v227
    v_fmac_f32 v170, v212, v222
    v_mul_f32 v230, v228, v210
    v_fma_f32 v230, -v226, v214, v230
    v_fmac_f32 v180, v230, v224
    v_fmac_f32 v166, v229, v228
    v_fmac_f32 v172, v214, v222
    v_mul_f32 v230, v226, v212
    v_fma_f32 v230, -v227, v210, v230
    v_fmac_f32 v174, v230, v224
    v_fmac_f32 v161, v209, v217
    v_mul_f32 v229, v211, v226
    v_fmac_f32 v229, v213, v227
    v_fmac_f32 v229, v215, v228
    v_fmac_f32 v177, v229, v219
    v_mul_f32 v229, v209, v221
    v_fmac_f32 v163, v229, v226
    v_fmac_f32 v169, v211, v223
    v_mul_f32 v230, v227, v215
    v_fma_f32 v230, -v228, v213, v230
    v_fmac_f32 v179, v230, v225
    v_fmac_f32 v165, v229, v227
    v_fmac_f32 v171, v213, v223
    v_mul_f32 v230, v228, v211
    v_fma_f32 v230, -v226, v215, v230
    v_fmac_f32 v181, v230, v225
    v_fmac_f32 v167, v229, v228
    v_fmac_f32 v173, v215, v223
    v_mul_f32 v230, v226, v213
    v_fma_f32 v230, -v227, v211, v230
    v_fmac_f32 v175, v230, v225
    s_branch SL_bits
SL_nexti:
    s_mov_b64 s[38:39], s[40:41]
    s_mov_b64 s[40:41], s[42:43]
    s_mov_b64 s[42:43], s[44:45]
    s_add_u32 s36, s36, 1
    s_cmp_lt_u32 s36, 4
    s_cbranch_scc1 SL_bits
    s_add_u32 s35, s35, 256
    s_cmp_lt_u32 s35, 320000
    s_cbranch_scc1 SL_scan
    s_lshl_b32 s66, s50, 3
    s_add_u32 s66, s66, s20
    s_lshl_b32 s67, s66, 4
    s_and_b32 s68, s67, 128
    s_and_b32 s67, s67, 0x70
    s_mul_i32 s69, s50, 1536
    s_add_u32 s69, s69, s21
    s_add_u32 s69, s69, s68
    s_mul_i32 s70, s66, 1536
    s_add_u32 s70, s70, 86016
    s_add_u32 s70, s70, s68
    v_mov_b32 v230, s69
    v_mov_b32 v231, s70
    v_cmp_gt_u32 vcc, 32, v240
    v_and_b32 v229, 31, v240
    v_lshlrev_b32 v229, 2, v229
    v_xor_b32 v229, s67, v229
    v_cndmask_b32 v244, v231, v230, vcc
    v_add_u32 v244, v244, v229
    v_cvt_pk_bf16_f32 v160, v160, v161
    ds_write_b32 v244, v160 offset:0
    v_cvt_pk_bf16_f32 v162, v162, v163
    ds_write_b32 v244, v162 offset:128
    v_cvt_pk_bf16_f32 v164, v164, v165
    ds_write_b32 v244, v164 offset:256
    v_cvt_pk_bf16_f32 v166, v166, v167
    ds_write_b32 v244, v166 offset:384
    v_cvt_pk_bf16_f32 v168, v168, v169
    ds_write_b32 v244, v168 offset:512
    v_cvt_pk_bf16_f32 v170, v170, v171
    ds_write_b32 v244, v170 offset:640
    v_cvt_pk_bf16_f32 v172, v172, v173
    ds_write_b32 v244, v172 offset:768
    v_cvt_pk_bf16_f32 v174, v174, v175
    ds_write_b32 v244, v174 offset:896
    v_cvt_pk_bf16_f32 v176, v176, v177
    ds_write_b32 v244, v176 offset:1024
    v_cvt_pk_bf16_f32 v178, v178, v179
    ds_write_b32 v244, v178 offset:1152
    v_cvt_pk_bf16_f32 v180, v180, v181
    ds_write_b32 v244, v180 offset:1280
    s_lshl_b32 s66, s66, 3
    s_add_u32 s66, s66, 163328
    v_mov_b32 v229, s66
    ds_write_b64 v229, v[230:231]
    s_add_u32 s50, s50, 1
    s_cmp_lt_u32 s50, 5
    s_cbranch_scc1 SL_node
    s_waitcnt lgkmcnt(0)
    s_barrier
    v_mov_b32 v176, v240
    s_load_dwordx4 s[84:87], s[0:1], 48
    s_mul_i32 s22, s20, 20
    s_waitcnt lgkmcnt(0)
    s_mul_i32 s24, s22, 3277
    s_lshr_b32 s24, s24, 16
    s_mul_i32 s68, s24, 20
    s_sub_u32 s68, s22, s68
    s_cmp_lt_u32 s68, 8
    s_cselect_b64 s[66:67], s[84:85], s[86:87]
    s_cselect_b32 s25, 0, 8
    s_sub_u32 s68, s68, s25
    s_and_b32 s25, s68, 1
    s_lshr_b32 s68, s68, 1
    s_lshl_b32 s68, s68, 14
    s_lshl_b32 s25, s25, 12
    s_add_u32 s68, s68, s25
    s_lshl_b32 s24, s24, 5
    s_add_u32 s68, s68, s24
    v_lshrrev_b32 v2, 4, v176
    v_lshlrev_b32 v2, 10, v2
    v_and_b32 v3, 15, v176
    v_lshl_add_u32 v2, v3, 1, v2
    v_add_u32 v2, s68, v2
    v_add_u32 v3, 8192, v2
    v_mov_b32 v4, 0
    v_mov_b32 v5, 0
    v_mov_b32 v6, 0
    v_mov_b32 v7, 0
    global_load_ushort v144, v2, s[66:67] offset:0
    global_load_short_d16_hi v4, v3, s[66:67] offset:0
    global_load_ushort v145, v2, s[66:67] offset:256
    global_load_short_d16_hi v5, v3, s[66:67] offset:256
    global_load_ushort v146, v2, s[66:67] offset:512
    global_load_short_d16_hi v6, v3, s[66:67] offset:512
    global_load_ushort v147, v2, s[66:67] offset:768
    global_load_short_d16_hi v7, v3, s[66:67] offset:768
    s_add_u32 s22, s22, 1
    s_waitcnt vmcnt(0)
    v_or_b32 v144, v144, v4
    v_or_b32 v145, v145, v5
    v_or_b32 v146, v146, v6
    v_or_b32 v147, v147, v7
    s_mul_i32 s24, s22, 3277
    s_lshr_b32 s24, s24, 16
    s_mul_i32 s68, s24, 20
    s_sub_u32 s68, s22, s68
    s_cmp_lt_u32 s68, 8
    s_cselect_b64 s[66:67], s[84:85], s[86:87]
    s_cselect_b32 s25, 0, 8
    s_sub_u32 s68, s68, s25
    s_and_b32 s25, s68, 1
    s_lshr_b32 s68, s68, 1
    s_lshl_b32 s68, s68, 14
    s_lshl_b32 s25, s25, 12
    s_add_u32 s68, s68, s25
    s_lshl_b32 s24, s24, 5
    s_add_u32 s68, s68, s24
    v_lshrrev_b32 v2, 4, v176
    v_lshlrev_b32 v2, 10, v2
    v_and_b32 v3, 15, v176
    v_lshl_add_u32 v2, v3, 1, v2
    v_add_u32 v2, s68, v2
    v_add_u32 v3, 8192, v2
    v_mov_b32 v4, 0
    v_mov_b32 v5, 0
    v_mov_b32 v6, 0
    v_mov_b32 v7, 0
    global_load_ushort v148, v2, s[66:67] offset:0
    global_load_short_d16_hi v4, v3, s[66:67] offset:0
    global_load_ushort v149, v2, s[66:67] offset:256
    global_load_short_d16_hi v5, v3, s[66:67] offset:256
    global_load_ushort v150, v2, s[66:67] offset:512
    global_load_short_d16_hi v6, v3, s[66:67] offset:512
    global_load_ushort v151, v2, s[66:67] offset:768
    global_load_short_d16_hi v7, v3, s[66:67] offset:768
    s_add_u32 s22, s22, 1
    s_waitcnt vmcnt(0)
    v_or_b32 v148, v148, v4
    v_or_b32 v149, v149, v5
    v_or_b32 v150, v150, v6
    v_or_b32 v151, v151, v7
    s_mul_i32 s24, s22, 3277
    s_lshr_b32 s24, s24, 16
    s_mul_i32 s68, s24, 20
    s_sub_u32 s68, s22, s68
    s_cmp_lt_u32 s68, 8
    s_cselect_b64 s[66:67], s[84:85], s[86:87]
    s_cselect_b32 s25, 0, 8
    s_sub_u32 s68, s68, s25
    s_and_b32 s25, s68, 1
    s_lshr_b32 s68, s68, 1
    s_lshl_b32 s68, s68, 14
    s_lshl_b32 s25, s25, 12
    s_add_u32 s68, s68, s25
    s_lshl_b32 s24, s24, 5
    s_add_u32 s68, s68, s24
    v_lshrrev_b32 v2, 4, v176
    v_lshlrev_b32 v2, 10, v2
    v_and_b32 v3, 15, v176
    v_lshl_add_u32 v2, v3, 1, v2
    v_add_u32 v2, s68, v2
    v_add_u32 v3, 8192, v2
    v_mov_b32 v4, 0
    v_mov_b32 v5, 0
    v_mov_b32 v6, 0
    v_mov_b32 v7, 0
    global_load_ushort v96, v2, s[66:67] offset:0
    global_load_short_d16_hi v4, v3, s[66:67] offset:0
    global_load_ushort v97, v2, s[66:67] offset:256
    global_load_short_d16_hi v5, v3, s[66:67] offset:256
    global_load_ushort v98, v2, s[66:67] offset:512
    global_load_short_d16_hi v6, v3, s[66:67] offset:512
    global_load_ushort v99, v2, s[66:67] offset:768
    global_load_short_d16_hi v7, v3, s[66:67] offset:768
    s_add_u32 s22, s22, 1
    s_waitcnt vmcnt(0)
    v_or_b32 v96, v96, v4
    v_or_b32 v97, v97, v5
    v_or_b32 v98, v98, v6
    v_or_b32 v99, v99, v7
    s_mul_i32 s24, s22, 3277
    s_lshr_b32 s24, s24, 16
    s_mul_i32 s68, s24, 20
    s_sub_u32 s68, s22, s68
    s_cmp_lt_u32 s68, 8
    s_cselect_b64 s[66:67], s[84:85], s[86:87]
    s_cselect_b32 s25, 0, 8
    s_sub_u32 s68, s68, s25
    s_and_b32 s25, s68, 1
    s_lshr_b32 s68, s68, 1
    s_lshl_b32 s68, s68, 14
    s_lshl_b32 s25, s25, 12
    s_add_u32 s68, s68, s25
    s_lshl_b32 s24, s24, 5
    s_add_u32 s68, s68, s24
    v_lshrrev_b32 v2, 4, v176
    v_lshlrev_b32 v2, 10, v2
    v_and_b32 v3, 15, v176
    v_lshl_add_u32 v2, v3, 1, v2
    v_add_u32 v2, s68, v2
    v_add_u32 v3, 8192, v2
    v_mov_b32 v4, 0
    v_mov_b32 v5, 0
    v_mov_b32 v6, 0
    v_mov_b32 v7, 0
    global_load_ushort v100, v2, s[66:67] offset:0
    global_load_short_d16_hi v4, v3, s[66:67] offset:0
    global_load_ushort v101, v2, s[66:67] offset:256
    global_load_short_d16_hi v5, v3, s[66:67] offset:256
    global_load_ushort v102, v2, s[66:67] offset:512
    global_load_short_d16_hi v6, v3, s[66:67] offset:512
    global_load_ushort v103, v2, s[66:67] offset:768
    global_load_short_d16_hi v7, v3, s[66:67] offset:768
    s_add_u32 s22, s22, 1
    s_waitcnt vmcnt(0)
    v_or_b32 v100, v100, v4
    v_or_b32 v101, v101, v5
    v_or_b32 v102, v102, v6
    v_or_b32 v103, v103, v7
    s_mul_i32 s24, s22, 3277
    s_lshr_b32 s24, s24, 16
    s_mul_i32 s68, s24, 20
    s_sub_u32 s68, s22, s68
    s_cmp_lt_u32 s68, 8
    s_cselect_b64 s[66:67], s[84:85], s[86:87]
    s_cselect_b32 s25, 0, 8
    s_sub_u32 s68, s68, s25
    s_and_b32 s25, s68, 1
    s_lshr_b32 s68, s68, 1
    s_lshl_b32 s68, s68, 14
    s_lshl_b32 s25, s25, 12
    s_add_u32 s68, s68, s25
    s_lshl_b32 s24, s24, 5
    s_add_u32 s68, s68, s24
    v_lshrrev_b32 v2, 4, v176
    v_lshlrev_b32 v2, 10, v2
    v_and_b32 v3, 15, v176
    v_lshl_add_u32 v2, v3, 1, v2
    v_add_u32 v2, s68, v2
    v_add_u32 v3, 8192, v2
    v_mov_b32 v4, 0
    v_mov_b32 v5, 0
    v_mov_b32 v6, 0
    v_mov_b32 v7, 0
    global_load_ushort v160, v2, s[66:67] offset:0
    global_load_short_d16_hi v4, v3, s[66:67] offset:0
    global_load_ushort v161, v2, s[66:67] offset:256
    global_load_short_d16_hi v5, v3, s[66:67] offset:256
    global_load_ushort v162, v2, s[66:67] offset:512
    global_load_short_d16_hi v6, v3, s[66:67] offset:512
    global_load_ushort v163, v2, s[66:67] offset:768
    global_load_short_d16_hi v7, v3, s[66:67] offset:768
    s_add_u32 s22, s22, 1
    s_waitcnt vmcnt(0)
    v_or_b32 v160, v160, v4
    v_or_b32 v161, v161, v5
    v_or_b32 v162, v162, v6
    v_or_b32 v163, v163, v7
    s_mul_i32 s24, s22, 3277
    s_lshr_b32 s24, s24, 16
    s_mul_i32 s68, s24, 20
    s_sub_u32 s68, s22, s68
    s_cmp_lt_u32 s68, 8
    s_cselect_b64 s[66:67], s[84:85], s[86:87]
    s_cselect_b32 s25, 0, 8
    s_sub_u32 s68, s68, s25
    s_and_b32 s25, s68, 1
    s_lshr_b32 s68, s68, 1
    s_lshl_b32 s68, s68, 14
    s_lshl_b32 s25, s25, 12
    s_add_u32 s68, s68, s25
    s_lshl_b32 s24, s24, 5
    s_add_u32 s68, s68, s24
    v_lshrrev_b32 v2, 4, v176
    v_lshlrev_b32 v2, 10, v2
    v_and_b32 v3, 15, v176
    v_lshl_add_u32 v2, v3, 1, v2
    v_add_u32 v2, s68, v2
    v_add_u32 v3, 8192, v2
    v_mov_b32 v4, 0
    v_mov_b32 v5, 0
    v_mov_b32 v6, 0
    v_mov_b32 v7, 0
    global_load_ushort v164, v2, s[66:67] offset:0
    global_load_short_d16_hi v4, v3, s[66:67] offset:0
    global_load_ushort v165, v2, s[66:67] offset:256
    global_load_short_d16_hi v5, v3, s[66:67] offset:256
    global_load_ushort v166, v2, s[66:67] offset:512
    global_load_short_d16_hi v6, v3, s[66:67] offset:512
    global_load_ushort v167, v2, s[66:67] offset:768
    global_load_short_d16_hi v7, v3, s[66:67] offset:768
    s_add_u32 s22, s22, 1
    s_waitcnt vmcnt(0)
    v_or_b32 v164, v164, v4
    v_or_b32 v165, v165, v5
    v_or_b32 v166, v166, v6
    v_or_b32 v167, v167, v7
    s_mul_i32 s24, s22, 3277
    s_lshr_b32 s24, s24, 16
    s_mul_i32 s68, s24, 20
    s_sub_u32 s68, s22, s68
    s_cmp_lt_u32 s68, 8
    s_cselect_b64 s[66:67], s[84:85], s[86:87]
    s_cselect_b32 s25, 0, 8
    s_sub_u32 s68, s68, s25
    s_and_b32 s25, s68, 1
    s_lshr_b32 s68, s68, 1
    s_lshl_b32 s68, s68, 14
    s_lshl_b32 s25, s25, 12
    s_add_u32 s68, s68, s25
    s_lshl_b32 s24, s24, 5
    s_add_u32 s68, s68, s24
    v_lshrrev_b32 v2, 4, v176
    v_lshlrev_b32 v2, 10, v2
    v_and_b32 v3, 15, v176
    v_lshl_add_u32 v2, v3, 1, v2
    v_add_u32 v2, s68, v2
    v_add_u32 v3, 8192, v2
    v_mov_b32 v4, 0
    v_mov_b32 v5, 0
    v_mov_b32 v6, 0
    v_mov_b32 v7, 0
    global_load_ushort v104, v2, s[66:67] offset:0
    global_load_short_d16_hi v4, v3, s[66:67] offset:0
    global_load_ushort v105, v2, s[66:67] offset:256
    global_load_short_d16_hi v5, v3, s[66:67] offset:256
    global_load_ushort v106, v2, s[66:67] offset:512
    global_load_short_d16_hi v6, v3, s[66:67] offset:512
    global_load_ushort v107, v2, s[66:67] offset:768
    global_load_short_d16_hi v7, v3, s[66:67] offset:768
    s_add_u32 s22, s22, 1
    s_waitcnt vmcnt(0)
    v_or_b32 v104, v104, v4
    v_or_b32 v105, v105, v5
    v_or_b32 v106, v106, v6
    v_or_b32 v107, v107, v7
    s_mul_i32 s24, s22, 3277
    s_lshr_b32 s24, s24, 16
    s_mul_i32 s68, s24, 20
    s_sub_u32 s68, s22, s68
    s_cmp_lt_u32 s68, 8
    s_cselect_b64 s[66:67], s[84:85], s[86:87]
    s_cselect_b32 s25, 0, 8
    s_sub_u32 s68, s68, s25
    s_and_b32 s25, s68, 1
    s_lshr_b32 s68, s68, 1
    s_lshl_b32 s68, s68, 14
    s_lshl_b32 s25, s25, 12
    s_add_u32 s68, s68, s25
    s_lshl_b32 s24, s24, 5
    s_add_u32 s68, s68, s24
    v_lshrrev_b32 v2, 4, v176
    v_lshlrev_b32 v2, 10, v2
    v_and_b32 v3, 15, v176
    v_lshl_add_u32 v2, v3, 1, v2
    v_add_u32 v2, s68, v2
    v_add_u32 v3, 8192, v2
    v_mov_b32 v4, 0
    v_mov_b32 v5, 0
    v_mov_b32 v6, 0
    v_mov_b32 v7, 0
    global_load_ushort v108, v2, s[66:67] offset:0
    global_load_short_d16_hi v4, v3, s[66:67] offset:0
    global_load_ushort v109, v2, s[66:67] offset:256
    global_load_short_d16_hi v5, v3, s[66:67] offset:256
    global_load_ushort v110, v2, s[66:67] offset:512
    global_load_short_d16_hi v6, v3, s[66:67] offset:512
    global_load_ushort v111, v2, s[66:67] offset:768
    global_load_short_d16_hi v7, v3, s[66:67] offset:768
    s_add_u32 s22, s22, 1
    s_waitcnt vmcnt(0)
    v_or_b32 v108, v108, v4
    v_or_b32 v109, v109, v5
    v_or_b32 v110, v110, v6
    v_or_b32 v111, v111, v7
    s_mul_i32 s24, s22, 3277
    s_lshr_b32 s24, s24, 16
    s_mul_i32 s68, s24, 20
    s_sub_u32 s68, s22, s68
    s_cmp_lt_u32 s68, 8
    s_cselect_b64 s[66:67], s[84:85], s[86:87]
    s_cselect_b32 s25, 0, 8
    s_sub_u32 s68, s68, s25
    s_and_b32 s25, s68, 1
    s_lshr_b32 s68, s68, 1
    s_lshl_b32 s68, s68, 14
    s_lshl_b32 s25, s25, 12
    s_add_u32 s68, s68, s25
    s_lshl_b32 s24, s24, 5
    s_add_u32 s68, s68, s24
    v_lshrrev_b32 v2, 4, v176
    v_lshlrev_b32 v2, 10, v2
    v_and_b32 v3, 15, v176
    v_lshl_add_u32 v2, v3, 1, v2
    v_add_u32 v2, s68, v2
    v_add_u32 v3, 8192, v2
    v_mov_b32 v4, 0
    v_mov_b32 v5, 0
    v_mov_b32 v6, 0
    v_mov_b32 v7, 0
    global_load_ushort v120, v2, s[66:67] offset:0
    global_load_short_d16_hi v4, v3, s[66:67] offset:0
    global_load_ushort v121, v2, s[66:67] offset:256
    global_load_short_d16_hi v5, v3, s[66:67] offset:256
    global_load_ushort v122, v2, s[66:67] offset:512
    global_load_short_d16_hi v6, v3, s[66:67] offset:512
    global_load_ushort v123, v2, s[66:67] offset:768
    global_load_short_d16_hi v7, v3, s[66:67] offset:768
    s_add_u32 s22, s22, 1
    s_waitcnt vmcnt(0)
    v_or_b32 v120, v120, v4
    v_or_b32 v121, v121, v5
    v_or_b32 v122, v122, v6
    v_or_b32 v123, v123, v7
    s_mul_i32 s24, s22, 3277
    s_lshr_b32 s24, s24, 16
    s_mul_i32 s68, s24, 20
    s_sub_u32 s68, s22, s68
    s_cmp_lt_u32 s68, 8
    s_cselect_b64 s[66:67], s[84:85], s[86:87]
    s_cselect_b32 s25, 0, 8
    s_sub_u32 s68, s68, s25
    s_and_b32 s25, s68, 1
    s_lshr_b32 s68, s68, 1
    s_lshl_b32 s68, s68, 14
    s_lshl_b32 s25, s25, 12
    s_add_u32 s68, s68, s25
    s_lshl_b32 s24, s24, 5
    s_add_u32 s68, s68, s24
    v_lshrrev_b32 v2, 4, v176
    v_lshlrev_b32 v2, 10, v2
    v_and_b32 v3, 15, v176
    v_lshl_add_u32 v2, v3, 1, v2
    v_add_u32 v2, s68, v2
    v_add_u32 v3, 8192, v2
    v_mov_b32 v4, 0
    v_mov_b32 v5, 0
    v_mov_b32 v6, 0
    v_mov_b32 v7, 0
    global_load_ushort v124, v2, s[66:67] offset:0
    global_load_short_d16_hi v4, v3, s[66:67] offset:0
    global_load_ushort v125, v2, s[66:67] offset:256
    global_load_short_d16_hi v5, v3, s[66:67] offset:256
    global_load_ushort v126, v2, s[66:67] offset:512
    global_load_short_d16_hi v6, v3, s[66:67] offset:512
    global_load_ushort v127, v2, s[66:67] offset:768
    global_load_short_d16_hi v7, v3, s[66:67] offset:768
    s_add_u32 s22, s22, 1
    s_waitcnt vmcnt(0)
    v_or_b32 v124, v124, v4
    v_or_b32 v125, v125, v5
    v_or_b32 v126, v126, v6
    v_or_b32 v127, v127, v7
    s_mul_i32 s24, s22, 3277
    s_lshr_b32 s24, s24, 16
    s_mul_i32 s68, s24, 20
    s_sub_u32 s68, s22, s68
    s_cmp_lt_u32 s68, 8
    s_cselect_b64 s[66:67], s[84:85], s[86:87]
    s_cselect_b32 s25, 0, 8
    s_sub_u32 s68, s68, s25
    s_and_b32 s25, s68, 1
    s_lshr_b32 s68, s68, 1
    s_lshl_b32 s68, s68, 14
    s_lshl_b32 s25, s25, 12
    s_add_u32 s68, s68, s25
    s_lshl_b32 s24, s24, 5
    s_add_u32 s68, s68, s24
    v_lshrrev_b32 v2, 4, v176
    v_lshlrev_b32 v2, 10, v2
    v_and_b32 v3, 15, v176
    v_lshl_add_u32 v2, v3, 1, v2
    v_add_u32 v2, s68, v2
    v_add_u32 v3, 8192, v2
    v_mov_b32 v4, 0
    v_mov_b32 v5, 0
    v_mov_b32 v6, 0
    v_mov_b32 v7, 0
    global_load_ushort v128, v2, s[66:67] offset:0
    global_load_short_d16_hi v4, v3, s[66:67] offset:0
    global_load_ushort v129, v2, s[66:67] offset:256
    global_load_short_d16_hi v5, v3, s[66:67] offset:256
    global_load_ushort v130, v2, s[66:67] offset:512
    global_load_short_d16_hi v6, v3, s[66:67] offset:512
    global_load_ushort v131, v2, s[66:67] offset:768
    global_load_short_d16_hi v7, v3, s[66:67] offset:768
    s_add_u32 s22, s22, 1
    s_waitcnt vmcnt(0)
    v_or_b32 v128, v128, v4
    v_or_b32 v129, v129, v5
    v_or_b32 v130, v130, v6
    v_or_b32 v131, v131, v7
    s_mul_i32 s24, s22, 3277
    s_lshr_b32 s24, s24, 16
    s_mul_i32 s68, s24, 20
    s_sub_u32 s68, s22, s68
    s_cmp_lt_u32 s68, 8
    s_cselect_b64 s[66:67], s[84:85], s[86:87]
    s_cselect_b32 s25, 0, 8
    s_sub_u32 s68, s68, s25
    s_and_b32 s25, s68, 1
    s_lshr_b32 s68, s68, 1
    s_lshl_b32 s68, s68, 14
    s_lshl_b32 s25, s25, 12
    s_add_u32 s68, s68, s25
    s_lshl_b32 s24, s24, 5
    s_add_u32 s68, s68, s24
    v_lshrrev_b32 v2, 4, v176
    v_lshlrev_b32 v2, 10, v2
    v_and_b32 v3, 15, v176
    v_lshl_add_u32 v2, v3, 1, v2
    v_add_u32 v2, s68, v2
    v_add_u32 v3, 8192, v2
    v_mov_b32 v4, 0
    v_mov_b32 v5, 0
    v_mov_b32 v6, 0
    v_mov_b32 v7, 0
    global_load_ushort v132, v2, s[66:67] offset:0
    global_load_short_d16_hi v4, v3, s[66:67] offset:0
    global_load_ushort v133, v2, s[66:67] offset:256
    global_load_short_d16_hi v5, v3, s[66:67] offset:256
    global_load_ushort v134, v2, s[66:67] offset:512
    global_load_short_d16_hi v6, v3, s[66:67] offset:512
    global_load_ushort v135, v2, s[66:67] offset:768
    global_load_short_d16_hi v7, v3, s[66:67] offset:768
    s_add_u32 s22, s22, 1
    s_waitcnt vmcnt(0)
    v_or_b32 v132, v132, v4
    v_or_b32 v133, v133, v5
    v_or_b32 v134, v134, v6
    v_or_b32 v135, v135, v7
    s_mul_i32 s24, s22, 3277
    s_lshr_b32 s24, s24, 16
    s_mul_i32 s68, s24, 20
    s_sub_u32 s68, s22, s68
    s_cmp_lt_u32 s68, 8
    s_cselect_b64 s[66:67], s[84:85], s[86:87]
    s_cselect_b32 s25, 0, 8
    s_sub_u32 s68, s68, s25
    s_and_b32 s25, s68, 1
    s_lshr_b32 s68, s68, 1
    s_lshl_b32 s68, s68, 14
    s_lshl_b32 s25, s25, 12
    s_add_u32 s68, s68, s25
    s_lshl_b32 s24, s24, 5
    s_add_u32 s68, s68, s24
    v_lshrrev_b32 v2, 4, v176
    v_lshlrev_b32 v2, 10, v2
    v_and_b32 v3, 15, v176
    v_lshl_add_u32 v2, v3, 1, v2
    v_add_u32 v2, s68, v2
    v_add_u32 v3, 8192, v2
    v_mov_b32 v4, 0
    v_mov_b32 v5, 0
    v_mov_b32 v6, 0
    v_mov_b32 v7, 0
    global_load_ushort v152, v2, s[66:67] offset:0
    global_load_short_d16_hi v4, v3, s[66:67] offset:0
    global_load_ushort v153, v2, s[66:67] offset:256
    global_load_short_d16_hi v5, v3, s[66:67] offset:256
    global_load_ushort v154, v2, s[66:67] offset:512
    global_load_short_d16_hi v6, v3, s[66:67] offset:512
    global_load_ushort v155, v2, s[66:67] offset:768
    global_load_short_d16_hi v7, v3, s[66:67] offset:768
    s_add_u32 s22, s22, 1
    s_waitcnt vmcnt(0)
    v_or_b32 v152, v152, v4
    v_or_b32 v153, v153, v5
    v_or_b32 v154, v154, v6
    v_or_b32 v155, v155, v7
    s_mul_i32 s24, s22, 3277
    s_lshr_b32 s24, s24, 16
    s_mul_i32 s68, s24, 20
    s_sub_u32 s68, s22, s68
    s_cmp_lt_u32 s68, 8
    s_cselect_b64 s[66:67], s[84:85], s[86:87]
    s_cselect_b32 s25, 0, 8
    s_sub_u32 s68, s68, s25
    s_and_b32 s25, s68, 1
    s_lshr_b32 s68, s68, 1
    s_lshl_b32 s68, s68, 14
    s_lshl_b32 s25, s25, 12
    s_add_u32 s68, s68, s25
    s_lshl_b32 s24, s24, 5
    s_add_u32 s68, s68, s24
    v_lshrrev_b32 v2, 4, v176
    v_lshlrev_b32 v2, 10, v2
    v_and_b32 v3, 15, v176
    v_lshl_add_u32 v2, v3, 1, v2
    v_add_u32 v2, s68, v2
    v_add_u32 v3, 8192, v2
    v_mov_b32 v4, 0
    v_mov_b32 v5, 0
    v_mov_b32 v6, 0
    v_mov_b32 v7, 0
    global_load_ushort v156, v2, s[66:67] offset:0
    global_load_short_d16_hi v4, v3, s[66:67] offset:0
    global_load_ushort v157, v2, s[66:67] offset:256
    global_load_short_d16_hi v5, v3, s[66:67] offset:256
    global_load_ushort v158, v2, s[66:67] offset:512
    global_load_short_d16_hi v6, v3, s[66:67] offset:512
    global_load_ushort v159, v2, s[66:67] offset:768
    global_load_short_d16_hi v7, v3, s[66:67] offset:768
    s_add_u32 s22, s22, 1
    s_waitcnt vmcnt(0)
    v_or_b32 v156, v156, v4
    v_or_b32 v157, v157, v5
    v_or_b32 v158, v158, v6
    v_or_b32 v159, v159, v7
    s_mul_i32 s24, s22, 3277
    s_lshr_b32 s24, s24, 16
    s_mul_i32 s68, s24, 20
    s_sub_u32 s68, s22, s68
    s_cmp_lt_u32 s68, 8
    s_cselect_b64 s[66:67], s[84:85], s[86:87]
    s_cselect_b32 s25, 0, 8
    s_sub_u32 s68, s68, s25
    s_and_b32 s25, s68, 1
    s_lshr_b32 s68, s68, 1
    s_lshl_b32 s68, s68, 14
    s_lshl_b32 s25, s25, 12
    s_add_u32 s68, s68, s25
    s_lshl_b32 s24, s24, 5
    s_add_u32 s68, s68, s24
    v_lshrrev_b32 v2, 4, v176
    v_lshlrev_b32 v2, 10, v2
    v_and_b32 v3, 15, v176
    v_lshl_add_u32 v2, v3, 1, v2
    v_add_u32 v2, s68, v2
    v_add_u32 v3, 8192, v2
    v_mov_b32 v4, 0
    v_mov_b32 v5, 0
    v_mov_b32 v6, 0
    v_mov_b32 v7, 0
    global_load_ushort v136, v2, s[66:67] offset:0
    global_load_short_d16_hi v4, v3, s[66:67] offset:0
    global_load_ushort v137, v2, s[66:67] offset:256
    global_load_short_d16_hi v5, v3, s[66:67] offset:256
    global_load_ushort v138, v2, s[66:67] offset:512
    global_load_short_d16_hi v6, v3, s[66:67] offset:512
    global_load_ushort v139, v2, s[66:67] offset:768
    global_load_short_d16_hi v7, v3, s[66:67] offset:768
    s_add_u32 s22, s22, 1
    s_waitcnt vmcnt(0)
    v_or_b32 v136, v136, v4
    v_or_b32 v137, v137, v5
    v_or_b32 v138, v138, v6
    v_or_b32 v139, v139, v7
    s_mul_i32 s24, s22, 3277
    s_lshr_b32 s24, s24, 16
    s_mul_i32 s68, s24, 20
    s_sub_u32 s68, s22, s68
    s_cmp_lt_u32 s68, 8
    s_cselect_b64 s[66:67], s[84:85], s[86:87]
    s_cselect_b32 s25, 0, 8
    s_sub_u32 s68, s68, s25
    s_and_b32 s25, s68, 1
    s_lshr_b32 s68, s68, 1
    s_lshl_b32 s68, s68, 14
    s_lshl_b32 s25, s25, 12
    s_add_u32 s68, s68, s25
    s_lshl_b32 s24, s24, 5
    s_add_u32 s68, s68, s24
    v_lshrrev_b32 v2, 4, v176
    v_lshlrev_b32 v2, 10, v2
    v_and_b32 v3, 15, v176
    v_lshl_add_u32 v2, v3, 1, v2
    v_add_u32 v2, s68, v2
    v_add_u32 v3, 8192, v2
    v_mov_b32 v4, 0
    v_mov_b32 v5, 0
    v_mov_b32 v6, 0
    v_mov_b32 v7, 0
    global_load_ushort v140, v2, s[66:67] offset:0
    global_load_short_d16_hi v4, v3, s[66:67] offset:0
    global_load_ushort v141, v2, s[66:67] offset:256
    global_load_short_d16_hi v5, v3, s[66:67] offset:256
    global_load_ushort v142, v2, s[66:67] offset:512
    global_load_short_d16_hi v6, v3, s[66:67] offset:512
    global_load_ushort v143, v2, s[66:67] offset:768
    global_load_short_d16_hi v7, v3, s[66:67] offset:768
    s_add_u32 s22, s22, 1
    s_waitcnt vmcnt(0)
    v_or_b32 v140, v140, v4
    v_or_b32 v141, v141, v5
    v_or_b32 v142, v142, v6
    v_or_b32 v143, v143, v7
    s_mul_i32 s24, s22, 3277
    s_lshr_b32 s24, s24, 16
    s_mul_i32 s68, s24, 20
    s_sub_u32 s68, s22, s68
    s_cmp_lt_u32 s68, 8
    s_cselect_b64 s[66:67], s[84:85], s[86:87]
    s_cselect_b32 s25, 0, 8
    s_sub_u32 s68, s68, s25
    s_and_b32 s25, s68, 1
    s_lshr_b32 s68, s68, 1
    s_lshl_b32 s68, s68, 14
    s_lshl_b32 s25, s25, 12
    s_add_u32 s68, s68, s25
    s_lshl_b32 s24, s24, 5
    s_add_u32 s68, s68, s24
    v_lshrrev_b32 v2, 4, v176
    v_lshlrev_b32 v2, 10, v2
    v_and_b32 v3, 15, v176
    v_lshl_add_u32 v2, v3, 1, v2
    v_add_u32 v2, s68, v2
    v_add_u32 v3, 8192, v2
    v_mov_b32 v4, 0
    v_mov_b32 v5, 0
    v_mov_b32 v6, 0
    v_mov_b32 v7, 0
    global_load_ushort v168, v2, s[66:67] offset:0
    global_load_short_d16_hi v4, v3, s[66:67] offset:0
    global_load_ushort v169, v2, s[66:67] offset:256
    global_load_short_d16_hi v5, v3, s[66:67] offset:256
    global_load_ushort v170, v2, s[66:67] offset:512
    global_load_short_d16_hi v6, v3, s[66:67] offset:512
    global_load_ushort v171, v2, s[66:67] offset:768
    global_load_short_d16_hi v7, v3, s[66:67] offset:768
    s_add_u32 s22, s22, 1
    s_waitcnt vmcnt(0)
    v_or_b32 v168, v168, v4
    v_or_b32 v169, v169, v5
    v_or_b32 v170, v170, v6
    v_or_b32 v171, v171, v7
    s_mul_i32 s24, s22, 3277
    s_lshr_b32 s24, s24, 16
    s_mul_i32 s68, s24, 20
    s_sub_u32 s68, s22, s68
    s_cmp_lt_u32 s68, 8
    s_cselect_b64 s[66:67], s[84:85], s[86:87]
    s_cselect_b32 s25, 0, 8
    s_sub_u32 s68, s68, s25
    s_and_b32 s25, s68, 1
    s_lshr_b32 s68, s68, 1
    s_lshl_b32 s68, s68, 14
    s_lshl_b32 s25, s25, 12
    s_add_u32 s68, s68, s25
    s_lshl_b32 s24, s24, 5
    s_add_u32 s68, s68, s24
    v_lshrrev_b32 v2, 4, v176
    v_lshlrev_b32 v2, 10, v2
    v_and_b32 v3, 15, v176
    v_lshl_add_u32 v2, v3, 1, v2
    v_add_u32 v2, s68, v2
    v_add_u32 v3, 8192, v2
    v_mov_b32 v4, 0
    v_mov_b32 v5, 0
    v_mov_b32 v6, 0
    v_mov_b32 v7, 0
    global_load_ushort v172, v2, s[66:67] offset:0
    global_load_short_d16_hi v4, v3, s[66:67] offset:0
    global_load_ushort v173, v2, s[66:67] offset:256
    global_load_short_d16_hi v5, v3, s[66:67] offset:256
    global_load_ushort v174, v2, s[66:67] offset:512
    global_load_short_d16_hi v6, v3, s[66:67] offset:512
    global_load_ushort v175, v2, s[66:67] offset:768
    global_load_short_d16_hi v7, v3, s[66:67] offset:768
    s_add_u32 s22, s22, 1
    s_waitcnt vmcnt(0)
    v_or_b32 v172, v172, v4
    v_or_b32 v173, v173, v5
    v_or_b32 v174, v174, v6
    v_or_b32 v175, v175, v7
    s_mul_i32 s24, s22, 3277
    s_lshr_b32 s24, s24, 16
    s_mul_i32 s68, s24, 20
    s_sub_u32 s68, s22, s68
    s_cmp_lt_u32 s68, 8
    s_cselect_b64 s[66:67], s[84:85], s[86:87]
    s_cselect_b32 s25, 0, 8
    s_sub_u32 s68, s68, s25
    s_and_b32 s25, s68, 1
    s_lshr_b32 s68, s68, 1
    s_lshl_b32 s68, s68, 14
    s_lshl_b32 s25, s25, 12
    s_add_u32 s68, s68, s25
    s_lshl_b32 s24, s24, 5
    s_add_u32 s68, s68, s24
    v_lshrrev_b32 v2, 4, v176
    v_lshlrev_b32 v2, 10, v2
    v_and_b32 v3, 15, v176
    v_lshl_add_u32 v2, v3, 1, v2
    v_add_u32 v2, s68, v2
    v_add_u32 v3, 8192, v2
    v_mov_b32 v4, 0
    v_mov_b32 v5, 0
    v_mov_b32 v6, 0
    v_mov_b32 v7, 0
    global_load_ushort v112, v2, s[66:67] offset:0
    global_load_short_d16_hi v4, v3, s[66:67] offset:0
    global_load_ushort v113, v2, s[66:67] offset:256
    global_load_short_d16_hi v5, v3, s[66:67] offset:256
    global_load_ushort v114, v2, s[66:67] offset:512
    global_load_short_d16_hi v6, v3, s[66:67] offset:512
    global_load_ushort v115, v2, s[66:67] offset:768
    global_load_short_d16_hi v7, v3, s[66:67] offset:768
    s_add_u32 s22, s22, 1
    s_waitcnt vmcnt(0)
    v_or_b32 v112, v112, v4
    v_or_b32 v113, v113, v5
    v_or_b32 v114, v114, v6
    v_or_b32 v115, v115, v7
    s_mul_i32 s24, s22, 3277
    s_lshr_b32 s24, s24, 16
    s_mul_i32 s68, s24, 20
    s_sub_u32 s68, s22, s68
    s_cmp_lt_u32 s68, 8
    s_cselect_b64 s[66:67], s[84:85], s[86:87]
    s_cselect_b32 s25, 0, 8
    s_sub_u32 s68, s68, s25
    s_and_b32 s25, s68, 1
    s_lshr_b32 s68, s68, 1
    s_lshl_b32 s68, s68, 14
    s_lshl_b32 s25, s25, 12
    s_add_u32 s68, s68, s25
    s_lshl_b32 s24, s24, 5
    s_add_u32 s68, s68, s24
    v_lshrrev_b32 v2, 4, v176
    v_lshlrev_b32 v2, 10, v2
    v_and_b32 v3, 15, v176
    v_lshl_add_u32 v2, v3, 1, v2
    v_add_u32 v2, s68, v2
    v_add_u32 v3, 8192, v2
    v_mov_b32 v4, 0
    v_mov_b32 v5, 0
    v_mov_b32 v6, 0
    v_mov_b32 v7, 0
    global_load_ushort v116, v2, s[66:67] offset:0
    global_load_short_d16_hi v4, v3, s[66:67] offset:0
    global_load_ushort v117, v2, s[66:67] offset:256
    global_load_short_d16_hi v5, v3, s[66:67] offset:256
    global_load_ushort v118, v2, s[66:67] offset:512
    global_load_short_d16_hi v6, v3, s[66:67] offset:512
    global_load_ushort v119, v2, s[66:67] offset:768
    global_load_short_d16_hi v7, v3, s[66:67] offset:768
    s_add_u32 s22, s22, 1
    s_waitcnt vmcnt(0)
    v_or_b32 v116, v116, v4
    v_or_b32 v117, v117, v5
    v_or_b32 v118, v118, v6
    v_or_b32 v119, v119, v7
    s_load_dwordx2 s[72:73], s[0:1], 72
    v_lshlrev_b32 v246, 4, v176
    s_mov_b32 s52, 163072
    v_bfe_u32 v177, v246, 4, 4
    v_bfe_u32 v179, v246, 4, 3
    v_lshl_add_u32 v180, v177, 3, s52
    v_lshl_add_u32 v190, v177, 4, s52
    v_lshl_add_u32 v181, v179, 3, s52
    ds_read2_b64 v[182:185], v180 offset0:32 offset1:48
    ds_read_b32 v191, v190
    ds_read_b64 v[186:187], v181 offset:512
    v_lshrrev_b32 v178, 8, v246
    s_add_u32 s22, s20, 0
    s_mul_i32 s28, s22, 1536
    s_add_u32 s28, s28, 86016
    s_lshl_b32 s22, s22, 21
    s_add_u32 s23, s20, 8
    s_mul_i32 s29, s23, 1536
    s_add_u32 s29, s29, 86144
    s_lshl_b32 s23, s23, 21
    s_add_u32 s24, s20, 16
    s_mul_i32 s30, s24, 1536
    s_add_u32 s30, s30, 86016
    s_lshl_b32 s24, s24, 21
    s_add_u32 s25, s20, 24
    s_lshl_b32 s25, s25, 21
    s_add_u32 s26, s20, 32
    s_lshl_b32 s26, s26, 21
    s_mov_b32 s53, 0
    s_mov_b32 s50, 0
    s_waitcnt lgkmcnt(0)
    s_branch GEMM
.section .rodata,"a"
.p2align 6
.amdhsa_kernel standalone__tensor_product_equiv_equiformer__graph_kernel
  .amdhsa_next_free_vgpr 256
  .amdhsa_next_free_sgpr 90
  .amdhsa_accum_offset 256
  .amdhsa_group_segment_fixed_size 0
  .amdhsa_kernarg_size 96
  .amdhsa_user_sgpr_count 2
  .amdhsa_user_sgpr_kernarg_segment_ptr 1
  .amdhsa_system_sgpr_workgroup_id_x 1
.end_amdhsa_kernel
```

```asm
; @launch grid=(250,1,1) block=(512,1,1) lds=163840
.amdgcn_target "amdgcn-amd-amdhsa--gfx950"
.text
.globl standalone__tensor_product_equiv_equiformer__graph_kernel
.p2align 8
.type standalone__tensor_product_equiv_equiformer__graph_kernel,@function
standalone__tensor_product_equiv_equiformer__graph_kernel:
    s_cmp_ge_u32 s2, 250
    s_cbranch_scc1 K2_end
    s_load_dwordx16 s[72:87], s[0:1], 0
    s_load_dwordx2 s[70:71], s[0:1], 88
    v_lshrrev_b32 v2, 6, v0
    v_and_b32 v1, 63, v0
    v_readfirstlane_b32 s20, v2
    s_getpc_b64 s[66:67]
    v_lshlrev_b32 v95, 7, v1
    s_cmp_eq_u32 s20, 6
    s_cbranch_scc0 F_nopf0
    global_load_dword v95, v95, s[66:67]
F_nopf0:
    s_mul_i32 s66, s2, 5120
    s_mul_i32 s67, s2, 7680
    v_lshl_add_u32 v3, v0, 4, s66
    v_mul_u32_u24 v4, 24, v0
    v_add_u32 v4, s67, v4
    v_lshlrev_b32 v5, 2, v0
    v_mov_b32 v89, 0
    v_add_u32 v6, 98304, v5
    ds_write_b32 v6, v89
    s_cmp_ge_u32 s20, 5
    s_waitcnt lgkmcnt(0)
    s_cbranch_scc1 F_noload
    global_load_dwordx4 v[8:11], v3, s[80:81] nt
    global_load_dwordx4 v[12:15], v3, s[78:79] nt
    global_load_dwordx4 v[16:19], v4, s[74:75] nt
    global_load_dwordx2 v[20:21], v4, s[74:75] offset:16 nt
F_noload:
    s_load_dword s88, s[70:71], 0
    s_barrier
    v_lshlrev_b32 v248, 2, v1
    v_add_u32 v88, 162816, v248
    ds_write_b32 v88, v89
    ds_write_b32 v88, v89 offset:256
    v_lshlrev_b32 v86, 4, v1
    s_lshl_b32 s21, s20, 13
    v_lshrrev_b32 v6, 5, v1
    v_mul_u32_u24 v6, 5120, v6
    v_and_b32 v7, 31, v1
    v_lshl_add_u32 v6, v7, 1, v6
    s_lshr_b32 s66, s20, 2
    s_lshl_b32 s66, s66, 7
    s_and_b32 s67, s20, 3
    s_mul_i32 s67, s67, 5
    s_add_u32 s68, s67, 0
    s_lshr_b32 s24, s68, 2
    s_lshl_b32 s24, s24, 8
    s_bfe_u32 s69, s68, 0x10001
    s_lshl_b32 s69, s69, 6
    s_add_u32 s24, s24, s69
    s_and_b32 s69, s68, 1
    s_mul_i32 s69, s69, 10240
    s_add_u32 s24, s24, s69
    s_add_u32 s24, s24, s66
    s_add_u32 s68, s67, 1
    s_lshr_b32 s25, s68, 2
    s_lshl_b32 s25, s25, 8
    s_bfe_u32 s69, s68, 0x10001
    s_lshl_b32 s69, s69, 6
    s_add_u32 s25, s25, s69
    s_and_b32 s69, s68, 1
    s_mul_i32 s69, s69, 10240
    s_add_u32 s25, s25, s69
    s_add_u32 s25, s25, s66
    s_add_u32 s68, s67, 2
    s_lshr_b32 s26, s68, 2
    s_lshl_b32 s26, s26, 8
    s_bfe_u32 s69, s68, 0x10001
    s_lshl_b32 s69, s69, 6
    s_add_u32 s26, s26, s69
    s_and_b32 s69, s68, 1
    s_mul_i32 s69, s69, 10240
    s_add_u32 s26, s26, s69
    s_add_u32 s26, s26, s66
    s_add_u32 s68, s67, 3
    s_lshr_b32 s27, s68, 2
    s_lshl_b32 s27, s27, 8
    s_bfe_u32 s69, s68, 0x10001
    s_lshl_b32 s69, s69, 6
    s_add_u32 s27, s27, s69
    s_and_b32 s69, s68, 1
    s_mul_i32 s69, s69, 10240
    s_add_u32 s27, s27, s69
    s_add_u32 s27, s27, s66
    s_add_u32 s68, s67, 4
    s_lshr_b32 s28, s68, 2
    s_lshl_b32 s28, s28, 8
    s_bfe_u32 s69, s68, 0x10001
    s_lshl_b32 s69, s69, 6
    s_add_u32 s28, s28, s69
    s_and_b32 s69, s68, 1
    s_mul_i32 s69, s69, 10240
    s_add_u32 s28, s28, s69
    s_add_u32 s28, s28, s66
    v_mov_b32 v96, 0
    v_mov_b32 v97, 0
    v_mov_b32 v98, 0
    v_mov_b32 v99, 0
    v_mov_b32 v100, 0
    v_mov_b32 v101, 0
    v_mov_b32 v102, 0
    v_mov_b32 v103, 0
    v_mov_b32 v104, 0
    v_mov_b32 v105, 0
    v_mov_b32 v106, 0
    v_mov_b32 v107, 0
    v_mov_b32 v108, 0
    v_mov_b32 v109, 0
    v_mov_b32 v110, 0
    v_mov_b32 v111, 0
    v_mov_b32 v112, 0
    v_mov_b32 v113, 0
    v_mov_b32 v114, 0
    v_mov_b32 v115, 0
    v_mov_b32 v180, 0
    v_mov_b32 v181, 0
    v_mov_b32 v182, 0
    v_mov_b32 v183, 0
    s_mov_b32 s16, s70
    s_and_b32 s17, s71, 0xffff
    s_mov_b32 s18, 24165888
    s_mov_b32 s19, 0x20000
    v_lshrrev_b32 v2, 3, v1
    v_lshl_add_u32 v2, s20, 5, v2
    v_and_b32 v91, 7, v1
    v_mul_u32_u24 v94, 384, v2
    v_lshl_add_u32 v94, v91, 4, v94
    v_lshlrev_b32 v93, 2, v2
    v_add_u32 v93, 98304, v93
    v_mul_u32_u24 v92, 32000, v2
    v_lshl_add_u32 v92, v91, 4, v92
    v_mul_u32_u24 v90, 40960, v2
    s_mov_b32 s32, s82
    s_and_b32 s33, s83, 0xffff
    s_mov_b32 s34, 20480
    s_mov_b32 s35, 0x20000
    s_cmp_ge_u32 s20, 5
    s_cbranch_scc1 F_helper
    s_mov_b32 s22, 52429
    s_mov_b32 s23, 0x05040100
    s_mov_b32 s66, 98304
    s_movk_i32 s67, -40
    v_mov_b32 v7, 1
    v_add_u32 v31, 1, v5
    v_add_u32 v32, 2, v5
    v_add_u32 v33, 3, v5
    s_waitcnt vmcnt(3)
    v_mul_u32_u24 v22, s22, v8
    v_mul_u32_u24 v23, s22, v9
    v_mul_u32_u24 v24, s22, v10
    v_mul_u32_u24 v25, s22, v11
    v_lshrrev_b32 v22, 21, v22
    v_lshrrev_b32 v23, 21, v23
    v_lshrrev_b32 v24, 21, v24
    v_lshrrev_b32 v25, 21, v25
    v_lshl_add_u32 v34, v22, 2, s66
    ds_add_rtn_u32 v26, v34, v7
    v_lshl_add_u32 v35, v23, 2, s66
    ds_add_rtn_u32 v27, v35, v7
    v_lshl_add_u32 v36, v24, 2, s66
    ds_add_rtn_u32 v28, v36, v7
    v_lshl_add_u32 v37, v25, 2, s66
    ds_add_rtn_u32 v29, v37, v7
    buffer_load_short_d16_hi v96, v6, s[32:35], s24 offen offset:0
    buffer_load_short_d16_hi v97, v6, s[32:35], s24 offen offset:1280
    buffer_load_short_d16_hi v98, v6, s[32:35], s24 offen offset:2560
    buffer_load_short_d16_hi v99, v6, s[32:35], s24 offen offset:3840
    buffer_load_short_d16_hi v100, v6, s[32:35], s25 offen offset:0
    buffer_load_short_d16_hi v101, v6, s[32:35], s25 offen offset:1280
    buffer_load_short_d16_hi v102, v6, s[32:35], s25 offen offset:2560
    buffer_load_short_d16_hi v103, v6, s[32:35], s25 offen offset:3840
    buffer_load_short_d16_hi v104, v6, s[32:35], s26 offen offset:0
    buffer_load_short_d16_hi v105, v6, s[32:35], s26 offen offset:1280
    buffer_load_short_d16_hi v106, v6, s[32:35], s26 offen offset:2560
    buffer_load_short_d16_hi v107, v6, s[32:35], s26 offen offset:3840
    buffer_load_short_d16_hi v108, v6, s[32:35], s27 offen offset:0
    buffer_load_short_d16_hi v109, v6, s[32:35], s27 offen offset:1280
    buffer_load_short_d16_hi v110, v6, s[32:35], s27 offen offset:2560
    buffer_load_short_d16_hi v111, v6, s[32:35], s27 offen offset:3840
    buffer_load_short_d16_hi v112, v6, s[32:35], s28 offen offset:0
    buffer_load_short_d16_hi v113, v6, s[32:35], s28 offen offset:1280
    buffer_load_short_d16_hi v114, v6, s[32:35], s28 offen offset:2560
    buffer_load_short_d16_hi v115, v6, s[32:35], s28 offen offset:3840
    v_mad_i32_i24 v2, v22, s67, v8
    v_mul_u32_u24 v22, 384, v22
    v_lshl_or_b32 v42, v2, 11, v5
    v_mad_i32_i24 v2, v23, s67, v9
    v_mul_u32_u24 v23, 384, v23
    v_lshl_or_b32 v46, v2, 11, v31
    v_mad_i32_i24 v2, v24, s67, v10
    v_mul_u32_u24 v24, 384, v24
    v_lshl_or_b32 v50, v2, 11, v32
    v_mad_i32_i24 v2, v25, s67, v11
    v_mul_u32_u24 v25, 384, v25
    v_lshl_or_b32 v54, v2, 11, v33
    s_waitcnt vmcnt(20)
    v_mov_b32 v40, v16
    v_perm_b32 v41, v12, v17, s23
    v_alignbit_b32 v44, v18, v17, 16
    v_alignbit_b32 v45, v13, v18, 16
    v_mov_b32 v48, v19
    v_perm_b32 v49, v14, v20, s23
    v_alignbit_b32 v52, v21, v20, 16
    v_alignbit_b32 v53, v15, v21, 16
    v_xor_b32 v41, 0x8000, v41
    v_xor_b32 v45, 0x8000, v45
    v_xor_b32 v49, 0x8000, v49
    v_xor_b32 v53, 0x8000, v53
    s_waitcnt lgkmcnt(0)
    v_min_u32 v26, 23, v26
    v_lshl_add_u32 v34, v26, 4, v22
    ds_write_b128 v34, v[40:43]
    v_min_u32 v27, 23, v27
    v_lshl_add_u32 v35, v27, 4, v23
    ds_write_b128 v35, v[44:47]
    v_min_u32 v28, 23, v28
    v_lshl_add_u32 v36, v28, 4, v24
    ds_write_b128 v36, v[48:51]
    v_min_u32 v29, 23, v29
    v_lshl_add_u32 v37, v29, 4, v25
    ds_write_b128 v37, v[52:55]
    s_branch F_staged
F_helper:
    buffer_load_short_d16_hi v96, v6, s[32:35], s24 offen offset:0
    buffer_load_short_d16_hi v97, v6, s[32:35], s24 offen offset:1280
    buffer_load_short_d16_hi v98, v6, s[32:35], s24 offen offset:2560
    buffer_load_short_d16_hi v99, v6, s[32:35], s24 offen offset:3840
    buffer_load_short_d16_hi v100, v6, s[32:35], s25 offen offset:0
    buffer_load_short_d16_hi v101, v6, s[32:35], s25 offen offset:1280
    buffer_load_short_d16_hi v102, v6, s[32:35], s25 offen offset:2560
    buffer_load_short_d16_hi v103, v6, s[32:35], s25 offen offset:3840
    buffer_load_short_d16_hi v104, v6, s[32:35], s26 offen offset:0
    buffer_load_short_d16_hi v105, v6, s[32:35], s26 offen offset:1280
    buffer_load_short_d16_hi v106, v6, s[32:35], s26 offen offset:2560
    buffer_load_short_d16_hi v107, v6, s[32:35], s26 offen offset:3840
    buffer_load_short_d16_hi v108, v6, s[32:35], s27 offen offset:0
    buffer_load_short_d16_hi v109, v6, s[32:35], s27 offen offset:1280
    buffer_load_short_d16_hi v110, v6, s[32:35], s27 offen offset:2560
    buffer_load_short_d16_hi v111, v6, s[32:35], s27 offen offset:3840
    buffer_load_short_d16_hi v112, v6, s[32:35], s28 offen offset:0
    buffer_load_short_d16_hi v113, v6, s[32:35], s28 offen offset:1280
    buffer_load_short_d16_hi v114, v6, s[32:35], s28 offen offset:2560
    buffer_load_short_d16_hi v115, v6, s[32:35], s28 offen offset:3840
    s_cmp_eq_u32 s20, 6
    s_cbranch_scc0 F_nopf
    s_getpc_b64 s[66:67]
F_pc:
    s_lshr_b32 s68, s2, 3
    s_mul_i32 s68, s68, ((K2_last-F_pc)/128/31+1)*128
    v_lshl_add_u32 v2, v1, 7, s68
    v_min_u32 v2, K2_last-F_pc-4, v2
    v_cmp_gt_u32 vcc, (K2_last-F_pc)/128/31+1, v1
    s_mov_b64 exec, vcc
    global_load_dword v95, v2, s[66:67]
    s_mov_b64 exec, -1
F_nopf:
    s_cmp_eq_u32 s20, 7
    s_cbranch_scc0 F_staged
    s_cmp_lt_u32 s2, 160
    s_cbranch_scc0 F_staged
    s_mul_i32 s22, s2, 3277
    s_lshr_b32 s22, s22, 16
    s_mul_i32 s68, s22, 20
    s_sub_u32 s68, s2, s68
    s_cmp_lt_u32 s68, 8
    s_cselect_b64 s[66:67], s[84:85], s[86:87]
    s_cselect_b32 s23, 0, 8
    s_sub_u32 s68, s68, s23
    s_and_b32 s23, s68, 1
    s_lshr_b32 s68, s68, 1
    s_lshl_b32 s68, s68, 14
    s_lshl_b32 s23, s23, 12
    s_add_u32 s68, s68, s23
    s_lshl_b32 s22, s22, 5
    s_add_u32 s68, s68, s22
    v_lshrrev_b32 v2, 4, v1
    v_lshlrev_b32 v2, 10, v2
    v_and_b32 v3, 15, v1
    v_lshl_add_u32 v2, v3, 1, v2
    v_add_u32 v2, s68, v2
    v_add_u32 v3, 8192, v2
    global_load_ushort v176, v2, s[66:67] offset:0
    global_load_short_d16_hi v180, v3, s[66:67] offset:0
    global_load_ushort v177, v2, s[66:67] offset:256
    global_load_short_d16_hi v181, v3, s[66:67] offset:256
    global_load_ushort v178, v2, s[66:67] offset:512
    global_load_short_d16_hi v182, v3, s[66:67] offset:512
    global_load_ushort v179, v2, s[66:67] offset:768
    global_load_short_d16_hi v183, v3, s[66:67] offset:768
F_staged:
    s_lshl_b32 s66, s2, 7
    s_add_u32 s66, s66, 164864
    s_cmp_eq_u32 s20, 7
    s_cselect_b32 s22, 0xffff, -1
    s_cselect_b32 s23, 0, -1
    s_waitcnt lgkmcnt(0)
    s_add_u32 s88, s88, 1
    s_barrier
    ds_read_b32 v40, v93 offset:0
    ds_read_b128 v[8:11], v94 offset:0
    ds_read_b32 v14, v94 offset:136
    ds_read_b32 v41, v93 offset:32
    ds_read_b128 v[16:19], v94 offset:3072
    ds_read_b32 v22, v94 offset:3208
    ds_read_b32 v42, v93 offset:64
    ds_read_b128 v[24:27], v94 offset:6144
    ds_read_b32 v30, v94 offset:6280
    ds_read_b32 v43, v93 offset:96
    ds_read_b128 v[32:35], v94 offset:9216
    ds_read_b32 v38, v94 offset:9352
    s_add_u32 s28, s66, 0
    s_add_u32 s29, s66, 256000
    s_add_u32 s30, s66, 512000
    s_add_u32 s31, s66, 768000
    s_waitcnt lgkmcnt(9)
    v_min_u32 v5, 31, v40
    v_bfe_u32 v6, v14, 11, 6
    v_and_b32 v10, 0x1ffff, v10
    v_lshl_or_b32 v6, v5, 6, v6
    v_mov_b32 v11, s88
    v_lshl_or_b32 v10, v6, 17, v10
    buffer_store_dwordx4 v[8:11], v92, s[16:19], s28 offen sc1
    s_waitcnt lgkmcnt(6)
    v_min_u32 v5, 31, v41
    v_bfe_u32 v6, v22, 11, 6
    v_and_b32 v18, 0x1ffff, v18
    v_lshl_or_b32 v6, v5, 6, v6
    v_mov_b32 v19, s88
    v_lshl_or_b32 v18, v6, 17, v18
    buffer_store_dwordx4 v[16:19], v92, s[16:19], s29 offen sc1
    s_waitcnt lgkmcnt(3)
    v_min_u32 v5, 31, v42
    v_bfe_u32 v6, v30, 11, 6
    v_and_b32 v26, 0x1ffff, v26
    v_lshl_or_b32 v6, v5, 6, v6
    v_mov_b32 v27, s88
    v_lshl_or_b32 v26, v6, 17, v26
    buffer_store_dwordx4 v[24:27], v92, s[16:19], s30 offen sc1
    s_waitcnt lgkmcnt(0)
    v_min_u32 v5, 31, v43
    v_bfe_u32 v6, v38, 11, 6
    v_and_b32 v34, 0x1ffff, v34
    v_lshl_or_b32 v6, v5, 6, v6
    v_mov_b32 v35, s88
    v_lshl_or_b32 v34, v6, 17, v34
    s_mov_b64 exec, s[22:23]
    buffer_store_dwordx4 v[32:35], v92, s[16:19], s31 offen sc1
    s_mov_b64 exec, -1
    ds_read_b128 v[12:15], v94 offset:128
    ds_read_b128 v[20:23], v94 offset:3200
    ds_read_b128 v[28:31], v94 offset:6272
    ds_read_b128 v[36:39], v94 offset:9344
    s_waitcnt vmcnt(4)
F_now:
    v_cmp_lt_u32 vcc, 8, v40
    s_add_u32 s67, s28, 8000000
    s_waitcnt lgkmcnt(3)
    v_mov_b32 v15, s88
    s_mov_b64 exec, vcc
    s_cbranch_execz F_w0
    buffer_store_dwordx4 v[12:15], v92, s[16:19], s67 offen sc1
    v_cmp_lt_u32 vcc, 16, v40
    s_add_u32 s67, s67, 8000000
    s_mov_b64 exec, vcc
    s_cbranch_execz F_w0
    ds_read_b128 v[44:47], v94 offset:256
    s_waitcnt lgkmcnt(0)
    v_mov_b32 v47, s88
    buffer_store_dwordx4 v[44:47], v92, s[16:19], s67 offen sc1
    s_nop 1
F_w0:
    s_mov_b64 exec, -1
    v_cmp_lt_u32 vcc, 8, v41
    s_add_u32 s67, s29, 8000000
    s_waitcnt lgkmcnt(2)
    v_mov_b32 v23, s88
    s_mov_b64 exec, vcc
    s_cbranch_execz F_w1
    buffer_store_dwordx4 v[20:23], v92, s[16:19], s67 offen sc1
    v_cmp_lt_u32 vcc, 16, v41
    s_add_u32 s67, s67, 8000000
    s_mov_b64 exec, vcc
    s_cbranch_execz F_w1
    ds_read_b128 v[44:47], v94 offset:3328
    s_waitcnt lgkmcnt(0)
    v_mov_b32 v47, s88
    buffer_store_dwordx4 v[44:47], v92, s[16:19], s67 offen sc1
    s_nop 1
F_w1:
    s_mov_b64 exec, -1
    v_cmp_lt_u32 vcc, 8, v42
    s_add_u32 s67, s30, 8000000
    s_waitcnt lgkmcnt(1)
    v_mov_b32 v31, s88
    s_mov_b64 exec, vcc
    s_cbranch_execz F_w2
    buffer_store_dwordx4 v[28:31], v92, s[16:19], s67 offen sc1
    v_cmp_lt_u32 vcc, 16, v42
    s_add_u32 s67, s67, 8000000
    s_mov_b64 exec, vcc
    s_cbranch_execz F_w2
    ds_read_b128 v[44:47], v94 offset:6400
    s_waitcnt lgkmcnt(0)
    v_mov_b32 v47, s88
    buffer_store_dwordx4 v[44:47], v92, s[16:19], s67 offen sc1
    s_nop 1
F_w2:
    s_mov_b64 exec, -1
    v_cmp_lt_u32 vcc, 8, v43
    s_add_u32 s67, s31, 8000000
    s_and_b64 vcc, vcc, s[22:23]
    s_waitcnt lgkmcnt(0)
    v_mov_b32 v39, s88
    s_mov_b64 exec, vcc
    s_cbranch_execz F_w3
    buffer_store_dwordx4 v[36:39], v92, s[16:19], s67 offen sc1
    v_cmp_lt_u32 vcc, 16, v43
    s_add_u32 s67, s67, 8000000
    s_mov_b64 exec, vcc
    s_cbranch_execz F_w3
    ds_read_b128 v[44:47], v94 offset:9472
    s_waitcnt lgkmcnt(0)
    v_mov_b32 v47, s88
    buffer_store_dwordx4 v[44:47], v92, s[16:19], s67 offen sc1
    s_nop 1
F_w3:
    s_mov_b64 exec, -1
    s_cmp_eq_u32 s20, 7
    s_cbranch_scc0 F_nofrag
    s_cmp_lt_u32 s2, 160
    s_cbranch_scc0 F_nofrag
    v_or_b32 v176, v176, v180
    v_or_b32 v177, v177, v181
    v_or_b32 v178, v178, v182
    v_or_b32 v179, v179, v183
    s_lshl_b32 s66, s2, 10
    s_add_u32 s66, s66, 1024
    buffer_store_dwordx4 v[176:179], v86, s[16:19], s66 offen sc1
F_nofrag:
    s_barrier
    s_mul_i32 s24, s2, 32000
    s_lshl_b32 s25, s20, 12
    s_add_u32 s24, s24, s25
    s_add_u32 s24, s24, 164864
    s_add_u32 s25, s24, 8000000
    s_add_u32 s26, s25, 8000000
    v_mov_b32 v22, 0
    v_mov_b32 v23, s88
    s_mul_i32 s68, s20, 5120
    s_cmp_ge_u32 s20, 4
    s_cselect_b32 s70, 45056, 0
    s_add_u32 s68, s68, s70
    v_add_u32 v2, s68, v86
    ds_write_b128 v2, v[96:99] offset:0
    ds_write_b128 v2, v[100:103] offset:1024
    ds_write_b128 v2, v[104:107] offset:2048
    ds_write_b128 v2, v[108:111] offset:3072
    ds_write_b128 v2, v[112:115] offset:4096
    v_mov_b32 v4, 2130738944
    v_mov_b32 v5, 2130738944
    v_mov_b32 v6, 2130738944
    v_mov_b32 v7, 2130738944
    v_lshlrev_b32 v2, 4, v0
    v_add_u32 v3, 86016, v2
    ds_write_b128 v3, v[4:7] offset:0
    ds_write_b128 v3, v[4:7] offset:8192
    ds_write_b128 v3, v[4:7] offset:16384
    ds_write_b128 v3, v[4:7] offset:24576
    ds_write_b128 v3, v[4:7] offset:32768
    ds_write_b128 v3, v[4:7] offset:40960
    ds_write_b128 v3, v[4:7] offset:49152
    ds_write_b128 v3, v[4:7] offset:57344
    v_add_u32 v3, 0x10000, v3
    ds_write_b128 v3, v[4:7] offset:0
    v_min_u32 v2, 3056, v2
    v_add_u32 v2, 159744, v2
    ds_write_b128 v2, v[4:7]
    s_sub_u32 s72, s72, 128
    s_subb_u32 s73, s73, 0
    s_mov_b32 s4, s72
    s_and_b32 s5, s73, 0xffff
    s_mov_b32 s6, 10240000
    s_mov_b32 s7, 0x20000
    s_sub_u32 s72, s72, 1024
    s_subb_u32 s73, s73, 0
    s_mov_b32 s8, s72
    s_and_b32 s9, s73, 0xffff
    s_mov_b32 s10, 10241024
    s_mov_b32 s11, 0x20000
    s_mov_b32 s12, s76
    s_and_b32 s13, s77, 0xffff
    s_mov_b32 s14, 10240000
    s_mov_b32 s15, 0x20000
    v_lshrrev_b32 v2, 5, v1
    v_bfe_u32 v3, v1, 2, 2
    v_and_b32 v4, 3, v1
    v_bfe_u32 v5, v1, 4, 1
    v_lshlrev_b32 v6, 9, v2
    v_lshl_add_u32 v6, v3, 7, v6
    v_lshl_add_u32 v6, v5, 5, v6
    v_lshl_add_u32 v6, v4, 3, v6
    v_lshrrev_b32 v7, 1, v3
    v_lshl_add_u32 v6, v7, 6, v6
    v_add_u32 v244, s21, v6
    v_xor_b32 v245, 64, v244
    v_lshlrev_b32 v6, 7, v2
    v_lshl_add_u32 v6, v7, 5, v6
    v_and_b32 v7, 1, v3
    v_xor_b32 v7, 1, v7
    v_mul_u32_u24 v7, 90112, v7
    v_add_u32 v6, v6, v7
    v_lshl_add_u32 v249, v4, 3, v6
    v_lshl_add_u32 v6, v2, 2, v4
    v_bfe_u32 v7, v1, 2, 1
    v_lshl_add_u32 v6, v7, 3, v6
    v_lshlrev_b32 v6, 3, v6
    v_bfe_u32 v7, v1, 3, 1
    v_add_u32 v5, 1, v5
    v_mul_u32_u24 v7, v7, v5
    v_lshl_add_u32 v250, v7, 1, v6
    v_and_b32 v6, 0x38, v1
    v_add_u32 v247, 4, v6
    v_lshrrev_b32 v6, 2, v1
    v_lshrrev_b32 v7, 4, v1
    v_xor_b32 v6, v6, v7
    v_and_b32 v6, 1, v6
    v_lshlrev_b32 v6, 6, v6
    v_lshl_add_u32 v246, v4, 4, v6
    v_mov_b32 v242, 1.0
    v_mov_b32 v243, 1.0
    s_mov_b32 s54, 0xffffff00
    s_mov_b32 s55, 0xffffff00
    s_mov_b32 s56, 0xffff
    s_mov_b32 s57, 0xffff
    s_mov_b32 s58, 0
    s_mov_b32 s59, 134217856
    s_mov_b32 s60, 262272
    s_mov_b32 s61, 402915456
    s_mov_b32 s62, 940179840
    s_mov_b32 s63, 403046528
    s_mov_b32 s64, 402784384
    s_mov_b32 s65, 134348928
    s_mov_b32 s38, 128
    s_mov_b32 s33, -1
    s_and_b32 s68, s20, 3
    s_lshl_b32 s68, s68, 2
    s_lshr_b32 s69, s20, 2
    s_add_u32 s68, s68, s69
    s_lshl_b32 s68, s68, 4
    s_add_u32 s68, s68, 163072
    v_mov_b32 v251, s68
    s_mov_b32 s53, 0
    s_mov_b32 s50, 0
    s_mov_b32 s51, 0
    s_mov_b32 s47, 0
    s_mov_b32 s42, 0
    s_mov_b32 s3, 0
    s_mov_b32 s89, 0
    s_mov_b32 s34, 128
    s_mov_b32 s35, 384
    s_mov_b32 s36, 640
    s_mov_b32 s37, 896
    s_movk_i32 s3, 1024
    s_waitcnt lgkmcnt(0)
    s_barrier
    buffer_load_dwordx4 v[8:11], v86, s[16:19], s24 offen offset:0 sc1
    buffer_load_dwordx4 v[12:15], v86, s[16:19], s24 offen offset:1024 sc1
    buffer_load_dwordx4 v[16:19], v86, s[16:19], s24 offen offset:2048 sc1
    s_mov_b64 exec, s[22:23]
    buffer_load_dwordx4 v[20:23], v86, s[16:19], s24 offen offset:3072 sc1
    s_mov_b64 exec, -1
    ds_read_b128 v[96:99], v86 offset:0
    ds_read_b128 v[100:103], v86 offset:1024
    ds_read_b128 v[104:107], v86 offset:2048
    ds_read_b128 v[108:111], v86 offset:3072
    ds_read_b128 v[112:115], v86 offset:4096
    ds_read_b128 v[116:119], v86 offset:5120
    ds_read_b128 v[120:123], v86 offset:6144
    ds_read_b128 v[124:127], v86 offset:7168
    ds_read_b128 v[128:131], v86 offset:8192
    ds_read_b128 v[132:135], v86 offset:9216
    ds_read_b128 v[136:139], v86 offset:10240
    ds_read_b128 v[140:143], v86 offset:11264
    ds_read_b128 v[144:147], v86 offset:12288
    ds_read_b128 v[148:151], v86 offset:13312
    ds_read_b128 v[152:155], v86 offset:14336
    ds_read_b128 v[156:159], v86 offset:15360
    ds_read_b128 v[160:163], v86 offset:16384
    ds_read_b128 v[164:167], v86 offset:17408
    ds_read_b128 v[168:171], v86 offset:18432
    ds_read_b128 v[172:175], v86 offset:19456
    s_mov_b32 s27, 32768
    s_mov_b32 s71, 162816
    v_mov_b32 v3, 1
    s_cmp_eq_u32 s20, 7
    s_cselect_b32 s52, 160, 0
    v_cmp_gt_u32 s[68:69], 40, v1
    s_mov_b64 s[28:29], 0xff
    s_lshr_b32 s66, s2, 3
    s_lshl_b32 s66, s66, 3
    s_add_u32 s66, s66, s20
    s_mul_i32 s66, s66, 14
    v_min_u32 v93, 13, v1
    v_add_u32 v93, s66, v93
    v_lshlrev_b32 v93, 10, v93
    v_mov_b32 v94, 0x7f000000
F_poll:
    s_waitcnt vmcnt(0)
F_poll1:
    v_cmp_ne_u32 s[72:73], s88, v11
    v_cmp_ne_u32 s[74:75], s88, v15
    v_cmp_ne_u32 s[76:77], s88, v19
    v_cmp_ne_u32 s[78:79], s88, v23
    s_or_b64 s[80:81], s[72:73], s[74:75]
    s_or_b64 s[82:83], s[76:77], s[78:79]
    s_or_b64 s[80:81], s[80:81], s[82:83]
    s_cbranch_scc1 F_again
F_got:
    v_bfe_u32 v2, v10, 23, 5
    v_bfe_u32 v60, v10, 11, 6
    v_cmp_gt_u32 s[80:81], v2, v91
    v_lshl_add_u32 v60, v60, 2, s71
    v_cmp_lt_u32 s[72:73], 8, v2
    v_max_u32 v89, v89, v2
    s_mov_b64 exec, s[80:81]
    ds_add_rtn_u32 v72, v60, v3
    s_mov_b64 exec, s[72:73]
    s_cbranch_execz F_h0
    buffer_load_dwordx4 v[24:27], v86, s[16:19], s25 offen offset:0 sc1
    v_sub_u32 v56, v2, v91
    v_bfe_u32 v64, v10, 17, 6
    v_cmp_lt_u32 vcc, 8, v56
    v_lshl_add_u32 v64, v64, 2, s71
    s_mov_b64 exec, vcc
    ds_add_rtn_u32 v76, v64, v3
F_h0:
    s_mov_b64 exec, -1
    v_bfe_u32 v2, v14, 23, 5
    v_bfe_u32 v61, v14, 11, 6
    v_cmp_gt_u32 s[82:83], v2, v91
    v_lshl_add_u32 v61, v61, 2, s71
    v_cmp_lt_u32 s[74:75], 8, v2
    v_max_u32 v89, v89, v2
    s_mov_b64 exec, s[82:83]
    ds_add_rtn_u32 v73, v61, v3
    s_mov_b64 exec, s[74:75]
    s_cbranch_execz F_h1
    buffer_load_dwordx4 v[28:31], v86, s[16:19], s25 offen offset:1024 sc1
    v_sub_u32 v57, v2, v91
    v_bfe_u32 v65, v14, 17, 6
    v_cmp_lt_u32 vcc, 8, v57
    v_lshl_add_u32 v65, v65, 2, s71
    s_mov_b64 exec, vcc
    ds_add_rtn_u32 v77, v65, v3
F_h1:
    s_mov_b64 exec, -1
    v_bfe_u32 v2, v18, 23, 5
    v_bfe_u32 v62, v18, 11, 6
    v_cmp_gt_u32 s[84:85], v2, v91
    v_lshl_add_u32 v62, v62, 2, s71
    v_cmp_lt_u32 s[76:77], 8, v2
    v_max_u32 v89, v89, v2
    s_mov_b64 exec, s[84:85]
    ds_add_rtn_u32 v74, v62, v3
    s_mov_b64 exec, s[76:77]
    s_cbranch_execz F_h2
    buffer_load_dwordx4 v[32:35], v86, s[16:19], s25 offen offset:2048 sc1
    v_sub_u32 v58, v2, v91
    v_bfe_u32 v66, v18, 17, 6
    v_cmp_lt_u32 vcc, 8, v58
    v_lshl_add_u32 v66, v66, 2, s71
    s_mov_b64 exec, vcc
    ds_add_rtn_u32 v78, v66, v3
F_h2:
    s_mov_b64 exec, -1
    v_bfe_u32 v2, v22, 23, 5
    v_bfe_u32 v63, v22, 11, 6
    v_cmp_gt_u32 s[86:87], v2, v91
    v_lshl_add_u32 v63, v63, 2, s71
    v_cmp_lt_u32 s[78:79], 8, v2
    v_max_u32 v89, v89, v2
    s_mov_b64 exec, s[86:87]
    ds_add_rtn_u32 v75, v63, v3
    s_mov_b64 exec, s[78:79]
    s_cbranch_execz F_h3
    buffer_load_dwordx4 v[36:39], v86, s[16:19], s25 offen offset:3072 sc1
    v_sub_u32 v59, v2, v91
    v_bfe_u32 v67, v22, 17, 6
    v_cmp_lt_u32 vcc, 8, v59
    v_lshl_add_u32 v67, v67, 2, s71
    s_mov_b64 exec, vcc
    ds_add_rtn_u32 v79, v67, v3
F_h3:
    s_mov_b64 exec, -1
    v_cmp_lt_u32 s[30:31], 16, v89
    s_mov_b32 s27, 262144
    s_cmp_lg_u64 s[30:31], 0
    s_cbranch_scc1 F_l3
F_l3r:
    v_and_b32 v10, 0x7ff, v10
    v_lshl_add_u32 v10, v10, 5, v90
    v_or_b32 v11, 16, v10
    v_and_b32 v14, 0x7ff, v14
    v_lshl_add_u32 v14, v14, 5, v90
    v_add_u32 v14, 327680, v14
    v_or_b32 v15, 16, v14
    v_and_b32 v18, 0x7ff, v18
    v_lshl_add_u32 v18, v18, 5, v90
    v_add_u32 v18, 655360, v18
    v_or_b32 v19, 16, v18
    v_and_b32 v22, 0x7ff, v22
    v_lshl_add_u32 v22, v22, 5, v90
    v_add_u32 v22, 983040, v22
    v_or_b32 v23, 16, v22
    s_cmp_lt_u32 s2, s52
    s_cbranch_scc1 F_flag
F_flagr:
    s_waitcnt lgkmcnt(0)
    s_barrier
    ds_read_b32 v4, v88
    buffer_load_dword v95, v93, s[4:7], 0 offen offset:128
    v_lshlrev_b32 v72, 3, v72
    v_lshlrev_b32 v73, 3, v73
    v_lshlrev_b32 v74, 3, v74
    v_lshlrev_b32 v75, 3, v75
    v_lshlrev_b32 v76, 3, v76
    v_lshlrev_b32 v77, 3, v77
    v_lshlrev_b32 v78, 3, v78
    v_lshlrev_b32 v79, 3, v79
    s_waitcnt lgkmcnt(0)
    v_add_u32 v2, 7, v4
    v_cmp_lt_u32 vcc, 64, v4
    v_lshrrev_b32 v2, 3, v2
    v_max_u32 v2, 2, v2
    s_cmp_lg_u64 vcc, 0
    s_cbranch_scc1 SLOW
    v_med3_u32 v3, v2, 3, 7
    v_cmp_eq_u32 vcc, 7, v2
    v_mad_u32_u24 v3, v3, 6, 14
    v_lshlrev_b32_e64 v6, v3, 1
    v_cndmask_b32 v6, 0, v6, s[68:69]
    v_addc_co_u32 v2, vcc, 0, v2, vcc
    v_mov_b32 v7, v6
    v_add_u32 v5, 1, v2
    v_lshrrev_b32 v5, 1, v5
    v_add_u32_dpp v7, v7, v7 row_shr:1 row_mask:0xf bank_mask:0xf
    v_lshlrev_b32 v92, 22, v5
    v_lshlrev_b32 v5, 18, v5
    v_add_u32_dpp v7, v7, v7 row_shr:2 row_mask:0xf bank_mask:0xf
    v_lshl_or_b32 v5, v1, 21, v5
    v_lshl_or_b32 v5, v2, 28, v5
    v_add_u32_dpp v7, v7, v7 row_shr:4 row_mask:0xf bank_mask:0xf
    s_mov_b32 s26, 86016
    s_mov_b32 s24, 0x2000
    v_add_u32_dpp v7, v7, v7 row_shr:8 row_mask:0xf bank_mask:0xf
    s_nop 1
    v_add_u32_dpp v7, v7, v7 row_bcast:15 row_mask:0xa bank_mask:0xf
    s_nop 1
    v_add_u32_dpp v7, v7, v7 row_bcast:31 row_mask:0xc bank_mask:0xf
    s_nop 0
    v_readlane_b32 s71, v7, 63
    v_sub_u32 v7, v7, v6
    s_lshr_b32 s66, s71, 24
    s_lshr_b32 s67, s71, 6
    s_lshr_b32 s70, s71, 12
    s_lshr_b32 s71, s71, 18
    s_add_u32 s67, s67, s70
    s_add_u32 s71, s71, s66
    s_add_u32 s71, s71, s67
    v_add_u32 v7, s71, v7
    s_bfe_u32 s70, s71, 393222
    v_bfe_u32 v7, v7, v3, 6
    s_bfe_u32 s67, s71, 393228
    v_cndmask_b32 v84, 63, v7, s[68:69]
    s_mul_i32 s68, s70, 3
    v_min_u32 v2, s70, v7
    s_mul_i32 s69, s66, 5
    v_min_u32 v3, s66, v7
    s_add_u32 s68, s68, s69
    v_mul_u32_u24 v7, 12, v7
    s_cmp_gt_u32 s68, 120
    v_mad_u32_u24 v7, v2, 3, v7
    s_cbranch_scc1 SLOW
    v_mad_u32_u24 v7, v3, 5, v7
    v_lshl_add_u32 v7, v7, 7, s26
    v_lshrrev_b32 v6, 3, v7
    v_mad_u32_u24 v92, v7, s24, v92
    v_or_b32 v92, v92, v6
    v_or_b32 v6, v5, v7
    s_add_u32 s71, s70, s66
    s_add_u32 s68, s71, s67
    s_andn2_b32 s70, s70, 3
    s_add_u32 s69, s70, 4
    s_andn2_b32 s67, s67, 3
    v_lshrrev_b32 v3, 1, v84
    v_mov_b32 v2, s68
    v_xor_b32 v3, v3, v84
    v_bfi_b32 v3, 4, v3, v84
    v_cmpx_gt_u32 vcc, s69, v84
    v_mov_b32 v2, s66
    v_cmpx_gt_u32 vcc, s70, v84
    v_mov_b32 v2, s71
    v_cmpx_gt_u32 vcc, s67, v84
    v_mov_b32 v2, 0
    s_mov_b64 exec, -1
    v_add_u32 v2, v2, v84
    v_bfi_b32 v84, 3, v2, v3
    s_lshr_b32 s66, s2, 3
    v_cmp_gt_u32 vcc, 32, v84
    v_add_u32 v2, s66, v84
    v_lshl_add_u32 v2, v2, 3, v84
    v_bfi_b32 v2, 24, v2, v84
    v_cndmask_b32 v84, v84, v2, vcc
    v_subrev_u32 v2, 6, v84
    v_and_b32 v2, 0x80000000, v2
    v_or_b32 v92, v92, v2
    ds_bpermute_b32 v60, v60, v92
    ds_bpermute_b32 v61, v61, v92
    ds_bpermute_b32 v62, v62, v92
    ds_bpermute_b32 v63, v63, v92
    ds_bpermute_b32 v64, v64, v92
    ds_bpermute_b32 v65, v65, v92
    ds_bpermute_b32 v66, v66, v92
    ds_bpermute_b32 v67, v67, v92
    v_cmp_eq_u32 vcc, s20, v84
    s_ff1_i32_b64 s67, vcc
    v_readlane_b32 s71, v6, s67
    s_mov_b32 s22, s71
    s_bfe_u32 s46, s71, 0x30012
    s_mov_b32 m0, s46
    s_and_b32 s66, s71, 0x3ffff
    s_movrels_b32 s68, s57
    s_movrels_b32 s69, s61
    s_sub_u32 s48, s66, s47
    s_mov_b32 s47, s66
    s_lshr_b32 s52, s71, 28
    s_lshl_b32 s67, s46, 9
    s_add_u32 s66, s66, s67
    s_sub_u32 s49, s66, s42
    s_mov_b32 s42, s66
    s_bfe_u32 s66, s68, 655360
    s_add_u32 s43, s42, s66
    s_bfe_u32 s39, s69, 655360
    s_bfe_u32 s66, s68, 655370
    s_add_u32 s44, s42, s66
    s_bfe_u32 s40, s69, 655370
    s_bfe_u32 s66, s68, 655380
    s_add_u32 s45, s42, s66
    s_bfe_u32 s41, s69, 655380
    s_waitcnt lgkmcnt(7)
    v_cmp_gt_i32 vcc, 0, v60
    v_and_b32 v60, 0x7fffffff, v60
    s_and_b64 exec, vcc, s[80:81]
    buffer_load_dword v95, v10, s[12:15], 0 offen
    s_mov_b64 exec, -1
    v_mad_u32_u16 v2, v60, 8, v72
    v_mad_u32_u16 v3, v60, 8, v72 op_sel:[1,0,0,0]
    s_mov_b64 exec, s[80:81]
    ds_write_b64 v2, v[10:11]
    ds_write_b64 v3, v[8:9]
    s_mov_b64 exec, -1
    s_waitcnt lgkmcnt(8)
    v_cmp_gt_i32 vcc, 0, v61
    v_and_b32 v61, 0x7fffffff, v61
    s_and_b64 exec, vcc, s[82:83]
    buffer_load_dword v95, v14, s[12:15], 0 offen
    s_mov_b64 exec, -1
    v_mad_u32_u16 v2, v61, 8, v73
    v_mad_u32_u16 v3, v61, 8, v73 op_sel:[1,0,0,0]
    s_mov_b64 exec, s[82:83]
    ds_write_b64 v2, v[14:15]
    ds_write_b64 v3, v[12:13]
    s_mov_b64 exec, -1
    s_waitcnt lgkmcnt(9)
    v_cmp_gt_i32 vcc, 0, v62
    v_and_b32 v62, 0x7fffffff, v62
    s_and_b64 exec, vcc, s[84:85]
    buffer_load_dword v95, v18, s[12:15], 0 offen
    s_mov_b64 exec, -1
    v_mad_u32_u16 v2, v62, 8, v74
    v_mad_u32_u16 v3, v62, 8, v74 op_sel:[1,0,0,0]
    s_mov_b64 exec, s[84:85]
    ds_write_b64 v2, v[18:19]
    ds_write_b64 v3, v[16:17]
    s_mov_b64 exec, -1
    s_waitcnt lgkmcnt(10)
    v_cmp_gt_i32 vcc, 0, v63
    v_and_b32 v63, 0x7fffffff, v63
    s_and_b64 exec, vcc, s[86:87]
    buffer_load_dword v95, v22, s[12:15], 0 offen
    s_mov_b64 exec, -1
    v_mad_u32_u16 v2, v63, 8, v75
    v_mad_u32_u16 v3, v63, 8, v75 op_sel:[1,0,0,0]
    s_mov_b64 exec, s[86:87]
    ds_write_b64 v2, v[22:23]
    ds_write_b64 v3, v[20:21]
    s_mov_b64 exec, -1
    s_waitcnt vmcnt(5) lgkmcnt(8)
    s_mov_b64 exec, s[72:73]
    s_cbranch_execz F_s0
F_sp0:
    v_cmp_ne_u32 vcc, s88, v27
    s_cbranch_vccnz F_sa0
F_sg0:
    v_cmpx_lt_u32 vcc, 8, v56
    v_and_b32 v26, 0x7ff, v26
    v_lshl_add_u32 v26, v26, 5, v90
    v_or_b32 v27, 16, v26
    v_cmp_gt_i32 vcc, 0, v64
    v_and_b32 v64, 0x7fffffff, v64
    s_and_saveexec_b64 s[82:83], vcc
    s_cbranch_execz F_x0
    buffer_load_dword v95, v26, s[12:15], 0 offen
F_x0:
    s_mov_b64 exec, s[82:83]
    v_mad_u32_u16 v2, v64, 8, v76
    v_mad_u32_u16 v3, v64, 8, v76 op_sel:[1,0,0,0]
    ds_write_b64 v2, v[26:27]
    ds_write_b64 v3, v[24:25]
F_s0:
    s_mov_b64 exec, s[74:75]
    s_cbranch_execz F_s1
F_sp1:
    v_cmp_ne_u32 vcc, s88, v31
    s_cbranch_vccnz F_sa1
F_sg1:
    v_cmpx_lt_u32 vcc, 8, v57
    v_and_b32 v30, 0x7ff, v30
    v_lshl_add_u32 v30, v30, 5, v90
    v_add_u32 v30, 327680, v30
    v_or_b32 v31, 16, v30
    v_cmp_gt_i32 vcc, 0, v65
    v_and_b32 v65, 0x7fffffff, v65
    s_and_saveexec_b64 s[82:83], vcc
    s_cbranch_execz F_x1
    buffer_load_dword v95, v30, s[12:15], 0 offen
F_x1:
    s_mov_b64 exec, s[82:83]
    v_mad_u32_u16 v2, v65, 8, v77
    v_mad_u32_u16 v3, v65, 8, v77 op_sel:[1,0,0,0]
    ds_write_b64 v2, v[30:31]
    ds_write_b64 v3, v[28:29]
F_s1:
    s_mov_b64 exec, s[76:77]
    s_cbranch_execz F_s2
F_sp2:
    v_cmp_ne_u32 vcc, s88, v35
    s_cbranch_vccnz F_sa2
F_sg2:
    v_cmpx_lt_u32 vcc, 8, v58
    v_and_b32 v34, 0x7ff, v34
    v_lshl_add_u32 v34, v34, 5, v90
    v_add_u32 v34, 655360, v34
    v_or_b32 v35, 16, v34
    v_cmp_gt_i32 vcc, 0, v66
    v_and_b32 v66, 0x7fffffff, v66
    s_and_saveexec_b64 s[82:83], vcc
    s_cbranch_execz F_x2
    buffer_load_dword v95, v34, s[12:15], 0 offen
F_x2:
    s_mov_b64 exec, s[82:83]
    v_mad_u32_u16 v2, v66, 8, v78
    v_mad_u32_u16 v3, v66, 8, v78 op_sel:[1,0,0,0]
    ds_write_b64 v2, v[34:35]
    ds_write_b64 v3, v[32:33]
F_s2:
    s_mov_b64 exec, s[78:79]
    s_cbranch_execz F_s3
F_sp3:
    v_cmp_ne_u32 vcc, s88, v39
    s_cbranch_vccnz F_sa3
F_sg3:
    v_cmpx_lt_u32 vcc, 8, v59
    v_and_b32 v38, 0x7ff, v38
    v_lshl_add_u32 v38, v38, 5, v90
    v_add_u32 v38, 983040, v38
    v_or_b32 v39, 16, v38
    v_cmp_gt_i32 vcc, 0, v67
    v_and_b32 v67, 0x7fffffff, v67
    s_and_saveexec_b64 s[82:83], vcc
    s_cbranch_execz F_x3
    buffer_load_dword v95, v38, s[12:15], 0 offen
F_x3:
    s_mov_b64 exec, s[82:83]
    v_mad_u32_u16 v2, v67, 8, v79
    v_mad_u32_u16 v3, v67, 8, v79 op_sel:[1,0,0,0]
    ds_write_b64 v2, v[38:39]
    ds_write_b64 v3, v[36:37]
F_s3:
    s_mov_b64 exec, -1
    s_cmp_lg_u64 s[30:31], 0
    s_cbranch_scc1 F_u
F_ur:
    s_mov_b32 s27, s22
    s_and_b32 s66, s46, s33
    s_cselect_b32 s72, -1, 1
    s_cselect_b32 s76, s47, 163712
    s_cmp_ge_u32 s66, 2
    s_cselect_b32 s73, -1, 0
    s_add_u32 s77, s47, 1024
    s_cmp_ge_u32 s66, 4
    s_cselect_b32 s75, -1, 0
    s_cmp_ge_u32 s66, 3
    s_cselect_b32 s74, -1, 1
    s_cselect_b32 s77, s77, 163712
    s_mul_i32 s66, s20, 80
    v_min_u32 v2, 76, v248
    s_waitcnt lgkmcnt(0)
    s_barrier
    v_add_u32 v253, s47, v248
    ds_read_b32 v254, v253
    ds_read_b32 v255, v253 offset:256
    v_add_u32 v252, s42, v247
    ds_read2_b32 v[234:235], v252 offset0:0 offset1:16
    v_add_u32 v252, s43, v247
    ds_read2_b32 v[236:237], v252 offset0:0 offset1:16
    v_add_u32 v252, s44, v247
    ds_read2_b32 v[238:239], v252 offset0:0 offset1:16
    v_add_u32 v252, s45, v247
    ds_read2_b32 v[240:241], v252 offset0:0 offset1:16
    buffer_load_dword v3, v2, s[16:19], s66 offen offset:128 sc1
    v_add_u32 v249, s48, v249
    v_add_u32 v250, s49, v250
    s_waitcnt lgkmcnt(4)
    s_mov_b32 m0, s76
    s_mov_b64 exec, s[72:73]
    buffer_load_dwordx4 v254, s[12:15], 0 offen  lds
    s_mov_b32 m0, s77
    s_mov_b64 exec, s[74:75]
    buffer_load_dwordx4 v255, s[12:15], 0 offen  lds
    s_mov_b64 exec, -1
    s_waitcnt lgkmcnt(0)
    s_add_u32 m0, s21, 0
    v_mad_u32_u16 v234, v234, s3, v246 op_sel:[1,0,0,0]
    v_mad_u32_u16 v235, v235, s3, v246 op_sel:[1,0,0,0]
    buffer_load_dwordx4 v234, s[4:7], s38 offen  lds
    buffer_load_dwordx4 v235, s[8:11], s38 offen offset:1024  lds
    s_add_u32 m0, s21, 2048
    v_mad_u32_u16 v236, v236, s3, v246 op_sel:[1,0,0,0]
    v_mad_u32_u16 v237, v237, s3, v246 op_sel:[1,0,0,0]
    buffer_load_dwordx4 v236, s[4:7], s39 offen  lds
    buffer_load_dwordx4 v237, s[8:11], s39 offen offset:1024  lds
    s_add_u32 m0, s21, 4096
    v_mad_u32_u16 v238, v238, s3, v246 op_sel:[1,0,0,0]
    v_mad_u32_u16 v239, v239, s3, v246 op_sel:[1,0,0,0]
    buffer_load_dwordx4 v238, s[4:7], s40 offen  lds
    buffer_load_dwordx4 v239, s[8:11], s40 offen offset:1024  lds
    s_add_u32 m0, s21, 6144
    v_mad_u32_u16 v240, v240, s3, v246 op_sel:[1,0,0,0]
    v_mad_u32_u16 v241, v241, s3, v246 op_sel:[1,0,0,0]
    buffer_load_dwordx4 v240, s[4:7], s41 offen  lds
    buffer_load_dwordx4 v241, s[8:11], s41 offen offset:1024  lds
    v_lshrrev_b32 v8, 3, v84
    v_and_b32 v9, 7, v84
    v_lshlrev_b32 v9, 13, v9
    v_mul_u32_u24 v8, 1536, v8
    v_lshlrev_b32 v10, 4, v84
    v_and_b32 v5, 128, v10
    v_add3_u32 v8, v8, v9, v5
    v_xor_b32 v9, v10, v7
    v_and_b32 v9, 128, v9
    v_add_u32 v9, v9, v7
    v_mov_b32 v5, v9
    s_add_u32 s66, s20, 0
    v_cmp_eq_u32 vcc, s66, v84
    s_ff1_i32_b64 s67, vcc
    v_readlane_b32 s28, v5, s67
    s_add_u32 s66, s20, 8
    v_cmp_eq_u32 vcc, s66, v84
    s_ff1_i32_b64 s67, vcc
    v_readlane_b32 s29, v5, s67
    v_readlane_b32 s23, v6, s67
    s_add_u32 s66, s20, 16
    v_cmp_eq_u32 vcc, s66, v84
    s_ff1_i32_b64 s67, vcc
    v_readlane_b32 s30, v5, s67
    v_readlane_b32 s24, v6, s67
    s_add_u32 s66, s20, 24
    v_cmp_eq_u32 vcc, s66, v84
    s_ff1_i32_b64 s67, vcc
    v_readlane_b32 s31, v5, s67
    v_readlane_b32 s25, v6, s67
    s_add_u32 s66, s20, 32
    v_cmp_eq_u32 vcc, s66, v84
    s_ff1_i32_b64 s67, vcc
    v_readlane_b32 s32, v5, s67
    v_readlane_b32 s26, v6, s67
    v_lshlrev_b32 v4, 3, v84
    v_add_u32 v4, 163328, v4
    s_mov_b32 exec_hi, 0xff
    ds_write_b64 v4, v[8:9]
    s_mov_b32 exec_hi, -1
    s_waitcnt lgkmcnt(0)
    v_mov_b32 v252, 0
    s_waitcnt vmcnt(6)
    v_cmp_ne_u32 vcc, s88, v3
    ds_read_b64_tr_b16 v[176:177], v244 offset:0
    ds_read_b64_tr_b16 v[178:179], v244 offset:1024
    ds_read_b64_tr_b16 v[180:181], v245 offset:0
    ds_read_b64_tr_b16 v[182:183], v245 offset:1024
    ds_read_b64_tr_b16 v[72:73], v249 offset:0
    ds_read_b64_tr_b16 v[76:77], v249 offset:64
    ds_read_b64_tr_b16 v[74:75], v249 offset:256
    ds_read_b64_tr_b16 v[78:79], v249 offset:320
    s_mov_b64 exec, s[54:55]
    ds_read_u16_d16_hi v242, v250 offset:0
    s_mov_b64 exec, -1
    s_or_b32 s89, vcc_lo, vcc_hi
    s_add_u32 s53, s53, 4
    s_xor_b32 s66, s53, s20
    s_bitcmp1_b32 s66, 2
    s_setprio 1
    s_cbranch_scc1 PRIO_1
    s_setprio 0
PRIO_1:
    s_cmp_eq_u32 s52, 4
    s_cbranch_scc1 ITEM_0_4
    s_cmp_eq_u32 s52, 5
    s_cbranch_scc1 ITEM_0_5
    s_cmp_eq_u32 s52, 3
    s_cbranch_scc1 ITEM_0_3
    s_cmp_eq_u32 s52, 6
    s_cbranch_scc1 ITEM_0_6
    s_cmp_eq_u32 s52, 8
    s_cbranch_scc1 ITEM_0_8
    s_branch ITEM_0_2
F_again:
    s_sub_u32 s27, s27, 1
    s_cbranch_scc1 F_late
    s_cmp_eq_u64 s[72:73], 0
    s_cbranch_scc1 F_p0
    s_mov_b64 exec, s[72:73]
    buffer_load_dwordx4 v[8:11], v86, s[16:19], s24 offen offset:0 sc1
    s_mov_b64 exec, -1
F_p0:
    s_cmp_eq_u64 s[74:75], 0
    s_cbranch_scc1 F_p1
    s_mov_b64 exec, s[74:75]
    buffer_load_dwordx4 v[12:15], v86, s[16:19], s24 offen offset:1024 sc1
    s_mov_b64 exec, -1
F_p1:
    s_cmp_eq_u64 s[76:77], 0
    s_cbranch_scc1 F_p2
    s_mov_b64 exec, s[76:77]
    buffer_load_dwordx4 v[16:19], v86, s[16:19], s24 offen offset:2048 sc1
    s_mov_b64 exec, -1
F_p2:
    s_cmp_eq_u64 s[78:79], 0
    s_cbranch_scc1 F_p3
    s_mov_b64 exec, s[78:79]
    buffer_load_dwordx4 v[20:23], v86, s[16:19], s24 offen offset:3072 sc1
    s_mov_b64 exec, -1
F_p3:
    s_branch F_poll
F_late:
    v_mov_b32 v2, 163064
    v_mov_b32 v4, 1000
    ds_write_b32 v2, v4
    v_mov_b32 v10, 0
    v_mov_b32 v14, 0
    v_mov_b32 v18, 0
    v_mov_b32 v22, 0
    s_branch F_got
F_l3:
    v_bfe_u32 v2, v10, 23, 5
    v_sub_u32 v56, v2, v91
    v_cmp_lt_u32 vcc, 16, v2
    s_mov_b64 exec, vcc
    s_cbranch_execz F_t0
F_tp0:
    buffer_load_dwordx4 v[40:43], v86, s[16:19], s26 offen offset:0 sc1
    s_waitcnt vmcnt(0)
    v_cmp_ne_u32 vcc, s88, v43
    s_sub_u32 s27, s27, 1
    s_cselect_b64 vcc, 0, vcc
    s_cmp_eq_u64 vcc, 0
    s_cbranch_scc0 F_tp0
    v_bfe_u32 v68, v42, 11, 6
    v_lshl_add_u32 v68, v68, 2, s71
    v_cmp_lt_i32 vcc, 16, v56
    s_mov_b64 exec, vcc
    ds_add_rtn_u32 v80, v68, v3
F_t0:
    s_mov_b64 exec, -1
    v_bfe_u32 v2, v14, 23, 5
    v_sub_u32 v57, v2, v91
    v_cmp_lt_u32 vcc, 16, v2
    s_mov_b64 exec, vcc
    s_cbranch_execz F_t1
F_tp1:
    buffer_load_dwordx4 v[44:47], v86, s[16:19], s26 offen offset:1024 sc1
    s_waitcnt vmcnt(0)
    v_cmp_ne_u32 vcc, s88, v47
    s_sub_u32 s27, s27, 1
    s_cselect_b64 vcc, 0, vcc
    s_cmp_eq_u64 vcc, 0
    s_cbranch_scc0 F_tp1
    v_bfe_u32 v69, v46, 11, 6
    v_lshl_add_u32 v69, v69, 2, s71
    v_cmp_lt_i32 vcc, 16, v57
    s_mov_b64 exec, vcc
    ds_add_rtn_u32 v81, v69, v3
F_t1:
    s_mov_b64 exec, -1
    v_bfe_u32 v2, v18, 23, 5
    v_sub_u32 v58, v2, v91
    v_cmp_lt_u32 vcc, 16, v2
    s_mov_b64 exec, vcc
    s_cbranch_execz F_t2
F_tp2:
    buffer_load_dwordx4 v[48:51], v86, s[16:19], s26 offen offset:2048 sc1
    s_waitcnt vmcnt(0)
    v_cmp_ne_u32 vcc, s88, v51
    s_sub_u32 s27, s27, 1
    s_cselect_b64 vcc, 0, vcc
    s_cmp_eq_u64 vcc, 0
    s_cbranch_scc0 F_tp2
    v_bfe_u32 v70, v50, 11, 6
    v_lshl_add_u32 v70, v70, 2, s71
    v_cmp_lt_i32 vcc, 16, v58
    s_mov_b64 exec, vcc
    ds_add_rtn_u32 v82, v70, v3
F_t2:
    s_mov_b64 exec, -1
    v_bfe_u32 v2, v22, 23, 5
    v_sub_u32 v59, v2, v91
    v_cmp_lt_u32 vcc, 16, v2
    s_mov_b64 exec, vcc
    s_cbranch_execz F_t3
F_tp3:
    buffer_load_dwordx4 v[52:55], v86, s[16:19], s26 offen offset:3072 sc1
    s_waitcnt vmcnt(0)
    v_cmp_ne_u32 vcc, s88, v55
    s_sub_u32 s27, s27, 1
    s_cselect_b64 vcc, 0, vcc
    s_cmp_eq_u64 vcc, 0
    s_cbranch_scc0 F_tp3
    v_bfe_u32 v71, v54, 11, 6
    v_lshl_add_u32 v71, v71, 2, s71
    v_cmp_lt_i32 vcc, 16, v59
    s_mov_b64 exec, vcc
    ds_add_rtn_u32 v83, v71, v3
F_t3:
    s_mov_b64 exec, -1
    v_mov_b32 v2, 163068
    v_mov_b32 v4, 1000
    v_cmp_lt_u32 vcc, 24, v89
    s_mov_b64 exec, vcc
    ds_write_b32 v2, v4
    s_mov_b64 exec, -1
    s_branch F_l3r
F_flag:
    s_lshl_b32 s66, s2, 2
    v_mov_b32 v2, 128
    v_mov_b32 v4, s88
    s_mov_b64 exec, 1
    buffer_store_dword v4, v2, s[16:19], s66 offen sc1
    s_mov_b64 exec, -1
    s_branch F_flagr
F_sa0:
    s_sub_u32 s27, s27, 1
    s_cbranch_scc1 F_sg0
    buffer_load_dwordx4 v[24:27], v86, s[16:19], s25 offen offset:0 sc1
    s_waitcnt vmcnt(0)
    s_branch F_sp0
F_sa1:
    s_sub_u32 s27, s27, 1
    s_cbranch_scc1 F_sg1
    buffer_load_dwordx4 v[28:31], v86, s[16:19], s25 offen offset:1024 sc1
    s_waitcnt vmcnt(0)
    s_branch F_sp1
F_sa2:
    s_sub_u32 s27, s27, 1
    s_cbranch_scc1 F_sg2
    buffer_load_dwordx4 v[32:35], v86, s[16:19], s25 offen offset:2048 sc1
    s_waitcnt vmcnt(0)
    s_branch F_sp2
F_sa3:
    s_sub_u32 s27, s27, 1
    s_cbranch_scc1 F_sg3
    buffer_load_dwordx4 v[36:39], v86, s[16:19], s25 offen offset:3072 sc1
    s_waitcnt vmcnt(0)
    s_branch F_sp3
F_u:
    ds_bpermute_b32 v68, v68, v92
    ds_bpermute_b32 v69, v69, v92
    ds_bpermute_b32 v70, v70, v92
    ds_bpermute_b32 v71, v71, v92
    s_waitcnt lgkmcnt(0)
    v_cmp_lt_i32 vcc, 16, v56
    s_mov_b64 exec, vcc
    s_cbranch_execz F_u0
    v_lshlrev_b32 v80, 3, v80
    v_and_b32 v42, 0x7ff, v42
    v_lshl_add_u32 v42, v42, 5, v90
    v_or_b32 v43, 16, v42
    v_and_b32 v68, 0x7fffffff, v68
    v_mad_u32_u16 v2, v68, 8, v80
    v_mad_u32_u16 v3, v68, 8, v80 op_sel:[1,0,0,0]
    ds_write_b64 v2, v[42:43]
    ds_write_b64 v3, v[40:41]
F_u0:
    s_mov_b64 exec, -1
    v_cmp_lt_i32 vcc, 16, v57
    s_mov_b64 exec, vcc
    s_cbranch_execz F_u1
    v_lshlrev_b32 v81, 3, v81
    v_and_b32 v46, 0x7ff, v46
    v_lshl_add_u32 v46, v46, 5, v90
    v_add_u32 v46, 327680, v46
    v_or_b32 v47, 16, v46
    v_and_b32 v69, 0x7fffffff, v69
    v_mad_u32_u16 v2, v69, 8, v81
    v_mad_u32_u16 v3, v69, 8, v81 op_sel:[1,0,0,0]
    ds_write_b64 v2, v[46:47]
    ds_write_b64 v3, v[44:45]
F_u1:
    s_mov_b64 exec, -1
    v_cmp_lt_i32 vcc, 16, v58
    s_mov_b64 exec, vcc
    s_cbranch_execz F_u2
    v_lshlrev_b32 v82, 3, v82
    v_and_b32 v50, 0x7ff, v50
    v_lshl_add_u32 v50, v50, 5, v90
    v_add_u32 v50, 655360, v50
    v_or_b32 v51, 16, v50
    v_and_b32 v70, 0x7fffffff, v70
    v_mad_u32_u16 v2, v70, 8, v82
    v_mad_u32_u16 v3, v70, 8, v82 op_sel:[1,0,0,0]
    ds_write_b64 v2, v[50:51]
    ds_write_b64 v3, v[48:49]
F_u2:
    s_mov_b64 exec, -1
    v_cmp_lt_i32 vcc, 16, v59
    s_mov_b64 exec, vcc
    s_cbranch_execz F_u3
    v_lshlrev_b32 v83, 3, v83
    v_and_b32 v54, 0x7ff, v54
    v_lshl_add_u32 v54, v54, 5, v90
    v_add_u32 v54, 983040, v54
    v_or_b32 v55, 16, v54
    v_and_b32 v71, 0x7fffffff, v71
    v_mad_u32_u16 v2, v71, 8, v83
    v_mad_u32_u16 v3, v71, 8, v83 op_sel:[1,0,0,0]
    ds_write_b64 v2, v[54:55]
    ds_write_b64 v3, v[52:53]
F_u3:
    s_mov_b64 exec, -1
    s_branch F_ur
LAST0:
    s_cmp_eq_u32 s50, 5
    s_cbranch_scc1 TO_PHASE1
    s_add_u32 s4, s4, 128
    s_addc_u32 s5, s5, 0
    s_add_u32 s8, s8, 128
    s_addc_u32 s9, s9, 0
    s_mov_b32 s34, 0
    s_mov_b32 s35, 256
    s_mov_b32 s36, 512
    s_mov_b32 s37, 768
    s_mov_b32 s33, 0
    s_add_u32 s53, s53, 4
    s_xor_b32 s66, s53, s20
    s_bitcmp1_b32 s66, 2
    s_setprio 1
    s_cbranch_scc1 PRIO_2
    s_setprio 0
PRIO_2:
    s_cmp_eq_u32 s52, 4
    s_cbranch_scc1 ITEM_0_4
    s_cmp_eq_u32 s52, 5
    s_cbranch_scc1 ITEM_0_5
    s_cmp_eq_u32 s52, 3
    s_cbranch_scc1 ITEM_0_3
    s_cmp_eq_u32 s52, 6
    s_cbranch_scc1 ITEM_0_6
    s_cmp_eq_u32 s52, 8
    s_cbranch_scc1 ITEM_0_8
    s_branch ITEM_0_2
TO_PHASE1:
    ds_read_b32 v252, v251 offset:16
    v_lshlrev_b32 v253, 2, v248
    v_add_u32 v253, 65536, v253
    ds_read_b128 v[96:99], v253 offset:0
    ds_read_b128 v[100:103], v253 offset:1024
    ds_read_b128 v[104:107], v253 offset:2048
    ds_read_b128 v[108:111], v253 offset:3072
    ds_read_b128 v[112:115], v253 offset:4096
    ds_read_b128 v[116:119], v253 offset:5120
    ds_read_b128 v[120:123], v253 offset:6144
    ds_read_b128 v[124:127], v253 offset:7168
    ds_read_b128 v[128:131], v253 offset:8192
    ds_read_b128 v[132:135], v253 offset:9216
    ds_read_b128 v[136:139], v253 offset:10240
    ds_read_b128 v[140:143], v253 offset:11264
    ds_read_b128 v[144:147], v253 offset:12288
    ds_read_b128 v[148:151], v253 offset:13312
    ds_read_b128 v[152:155], v253 offset:14336
    ds_read_b128 v[156:159], v253 offset:15360
    ds_read_b128 v[160:163], v253 offset:16384
    ds_read_b128 v[164:167], v253 offset:17408
    ds_read_b128 v[168:171], v253 offset:18432
    ds_read_b128 v[172:175], v253 offset:19456
    s_lshl_b32 s66, s20, 4
    v_xor_b32 v248, s66, v248
    s_mov_b32 s34, 128
    s_mov_b32 s35, 384
    s_mov_b32 s36, 640
    s_mov_b32 s37, 896
    s_mov_b32 s50, 0
    s_mov_b64 vcc, 0
    s_waitcnt lgkmcnt(0)
    s_waitcnt lgkmcnt(0)
    v_readfirstlane_b32 s66, v252
    s_add_u32 s53, s53, 1
    v_mov_b32 v252, s53
    s_cmp_le_u32 s53, s66
    ds_write2_b32 v251, v252, v252 offset0:0 offset1:8
    s_setprio 1
    s_cbranch_scc1 PRIO_3
    s_setprio 0
PRIO_3:
    s_cmp_eq_u32 s52, 4
    s_cbranch_scc1 ITEM_1_4
    s_cmp_eq_u32 s52, 5
    s_cbranch_scc1 ITEM_1_5
    s_cmp_eq_u32 s52, 3
    s_cbranch_scc1 ITEM_1_3
    s_cmp_eq_u32 s52, 6
    s_cbranch_scc1 ITEM_1_6
    s_cmp_eq_u32 s52, 8
    s_cbranch_scc1 ITEM_1_8
    s_branch ITEM_1_2
LAST1:
    s_cmp_eq_u32 s89, 0
    s_cbranch_scc1 T_flagsL
    s_mul_i32 s66, s20, 80
    v_min_u32 v2, 76, v248
    s_mov_b32 s67, 262144
T_pollL:
    buffer_load_dword v3, v2, s[16:19], s66 offen offset:128 sc1
    s_waitcnt vmcnt(0)
    v_cmp_ne_u32 vcc, s88, v3
    s_sub_u32 s67, s67, 1
    s_cselect_b64 vcc, 0, vcc
    s_cmp_eq_u64 vcc, 0
    s_cbranch_scc0 T_pollL
    s_mov_b32 s89, 0
T_flagsL:
    s_lshl_b32 s66, s20, 4
    v_xor_b32 v246, s66, v248
    v_lshlrev_b32 v246, 2, v246
    s_mul_i32 s51, s20, 20480
    s_add_u32 s51, s51, 1024
    s_mov_b64 vcc, -1
    s_load_dwordx2 s[72:73], s[0:1], 72
    s_waitcnt lgkmcnt(7)
    v_readfirstlane_b32 s66, v252
    s_add_u32 s53, s53, 1
    v_mov_b32 v252, s53
    s_cmp_le_u32 s53, s66
    ds_write2_b32 v251, v252, v252 offset0:0 offset1:8
    s_setprio 3
    s_cbranch_scc1 PRIO_4
    s_setprio 2
PRIO_4:
    s_cmp_eq_u32 s52, 4
    s_cbranch_scc1 ITEM_1_4
    s_cmp_eq_u32 s52, 5
    s_cbranch_scc1 ITEM_1_5
    s_cmp_eq_u32 s52, 3
    s_cbranch_scc1 ITEM_1_3
    s_cmp_eq_u32 s52, 6
    s_cbranch_scc1 ITEM_1_6
    s_cmp_eq_u32 s52, 8
    s_cbranch_scc1 ITEM_1_8
    s_branch ITEM_1_2
.p2align 6
ITEM_0_4:
    s_mov_b64 exec, s[54:55]
    ds_read_u16_d16_hi v243, v250 offset:128
    s_mov_b64 exec, -1
    ds_read_b64_tr_b16 v[80:81], v249 offset:512
    ds_read_b64_tr_b16 v[84:85], v249 offset:576
    ds_read_b64_tr_b16 v[82:83], v249 offset:768
    ds_read_b64_tr_b16 v[86:87], v249 offset:832
    s_waitcnt lgkmcnt(5)
    v_mul_f32_dpp v196, v242, v72 row_newbcast:0 row_mask:0xf bank_mask:0xf
    v_mul_f32_dpp v197, v242, v73 row_newbcast:1 row_mask:0xf bank_mask:0xf
    v_mul_f32_dpp v198, v242, v72 row_newbcast:8 row_mask:0xf bank_mask:0xf
    v_mul_f32_dpp v199, v242, v73 row_newbcast:9 row_mask:0xf bank_mask:0xf
    v_mul_f32_dpp v200, v242, v76 row_newbcast:2 row_mask:0xf bank_mask:0xf
    v_mul_f32_dpp v201, v242, v77 row_newbcast:3 row_mask:0xf bank_mask:0xf
    v_mul_f32_dpp v202, v242, v76 row_newbcast:10 row_mask:0xf bank_mask:0xf
    v_mul_f32_dpp v203, v242, v77 row_newbcast:11 row_mask:0xf bank_mask:0xf
    v_cvt_pk_bf16_f32 v72, v196, v197
    v_cvt_pk_bf16_f32 v76, v198, v199
    v_cvt_pk_bf16_f32 v73, v200, v201
    v_cvt_pk_bf16_f32 v77, v202, v203
    v_mul_f32_dpp v196, v242, v74 row_newbcast:4 row_mask:0xf bank_mask:0xf
    v_mul_f32_dpp v197, v242, v75 row_newbcast:5 row_mask:0xf bank_mask:0xf
    v_mul_f32_dpp v198, v242, v74 row_newbcast:12 row_mask:0xf bank_mask:0xf
    v_mul_f32_dpp v199, v242, v75 row_newbcast:13 row_mask:0xf bank_mask:0xf
    v_mul_f32_dpp v200, v242, v78 row_newbcast:6 row_mask:0xf bank_mask:0xf
    v_mul_f32_dpp v201, v242, v79 row_newbcast:7 row_mask:0xf bank_mask:0xf
    v_mul_f32_dpp v202, v242, v78 row_newbcast:14 row_mask:0xf bank_mask:0xf
    v_mul_f32_dpp v203, v242, v79 row_newbcast:15 row_mask:0xf bank_mask:0xf
    v_cvt_pk_bf16_f32 v74, v196, v197
    v_cvt_pk_bf16_f32 v78, v198, v199
    v_cvt_pk_bf16_f32 v75, v200, v201
    v_cvt_pk_bf16_f32 v79, v202, v203
    s_waitcnt vmcnt(4) lgkmcnt(0)
    v_mfma_f32_32x32x16_bf16 v[56:71], v[72:75], v[176:179], 0
    v_mul_f32_dpp v196, v243, v80 row_newbcast:0 row_mask:0xf bank_mask:0xf
    v_mul_f32_dpp v197, v243, v81 row_newbcast:1 row_mask:0xf bank_mask:0xf
    v_mul_f32_dpp v198, v243, v80 row_newbcast:8 row_mask:0xf bank_mask:0xf
    v_mul_f32_dpp v199, v243, v81 row_newbcast:9 row_mask:0xf bank_mask:0xf
    v_mul_f32_dpp v200, v243, v84 row_newbcast:2 row_mask:0xf bank_mask:0xf
    v_mul_f32_dpp v201, v243, v85 row_newbcast:3 row_mask:0xf bank_mask:0xf
    s_add_u32 m0, s21, 0
    v_mfma_f32_32x32x16_bf16 v[16:31], v[76:79], v[176:179], 0
    buffer_load_dwordx4 v234, s[4:7], s36 offen  lds
    buffer_load_dwordx4 v235, s[8:11], s36 offen offset:1024  lds
    ds_read_b64_tr_b16 v[176:177], v244 offset:2048
    ds_read_b64_tr_b16 v[178:179], v244 offset:3072
    ds_read_b64_tr_b16 v[184:185], v245 offset:2048
    ds_read_b64_tr_b16 v[186:187], v245 offset:3072
    v_mul_f32_dpp v202, v243, v84 row_newbcast:10 row_mask:0xf bank_mask:0xf
    v_mul_f32_dpp v203, v243, v85 row_newbcast:11 row_mask:0xf bank_mask:0xf
    v_cvt_pk_bf16_f32 v80, v196, v197
    v_cvt_pk_bf16_f32 v84, v198, v199
    v_cvt_pk_bf16_f32 v81, v200, v201
    v_cvt_pk_bf16_f32 v85, v202, v203
    v_mul_f32_dpp v196, v243, v82 row_newbcast:4 row_mask:0xf bank_mask:0xf
    v_mul_f32_dpp v197, v243, v83 row_newbcast:5 row_mask:0xf bank_mask:0xf
    v_mul_f32_dpp v198, v243, v82 row_newbcast:12 row_mask:0xf bank_mask:0xf
    v_mul_f32_dpp v199, v243, v83 row_newbcast:13 row_mask:0xf bank_mask:0xf
    v_mul_f32_dpp v200, v243, v86 row_newbcast:6 row_mask:0xf bank_mask:0xf
    v_mul_f32_dpp v201, v243, v87 row_newbcast:7 row_mask:0xf bank_mask:0xf
    v_mul_f32_dpp v202, v243, v86 row_newbcast:14 row_mask:0xf bank_mask:0xf
    v_mul_f32_dpp v203, v243, v87 row_newbcast:15 row_mask:0xf bank_mask:0xf
    v_cvt_pk_bf16_f32 v82, v196, v197
    v_cvt_pk_bf16_f32 v86, v198, v199
    v_cvt_pk_bf16_f32 v83, v200, v201
    v_cvt_pk_bf16_f32 v87, v202, v203
    s_waitcnt lgkmcnt(0)
    v_mfma_f32_32x32x16_bf16 v[56:71], v[80:83], v[176:179], v[56:71]
    s_add_u32 m0, s21, 2048
    v_mfma_f32_32x32x16_bf16 v[16:31], v[84:87], v[176:179], v[16:31]
    buffer_load_dwordx4 v236, s[4:7], s36 offen  lds
    buffer_load_dwordx4 v237, s[8:11], s36 offen offset:1024  lds
    s_mov_b32 m0, s50
    s_nop 0
    s_movrels_b32 s71, s23
    s_bfe_u32 s46, s71, 0x30012
    s_mov_b32 m0, s46
    s_and_b32 s66, s71, 0x3ffff
    s_movrels_b32 s68, s57
    s_movrels_b32 s69, s61
    s_sub_u32 s48, s66, s47
    s_mov_b32 s47, s66
    s_lshr_b32 s52, s71, 28
    s_lshl_b32 s67, s46, 9
    s_add_u32 s66, s66, s67
    s_sub_u32 s49, s66, s42
    s_mov_b32 s42, s66
    s_bfe_u32 s66, s68, 655360
    s_add_u32 s43, s42, s66
    s_bfe_u32 s39, s69, 655360
    s_bfe_u32 s66, s68, 655370
    s_add_u32 s44, s42, s66
    s_bfe_u32 s40, s69, 655370
    s_bfe_u32 s66, s68, 655380
    s_add_u32 s45, s42, s66
    s_bfe_u32 s41, s69, 655380
    s_and_b32 s66, s46, s33
    s_cselect_b32 s72, -1, 1
    s_cselect_b32 s76, s47, 163712
    s_cmp_ge_u32 s66, 2
    s_cselect_b32 s73, -1, 0
    s_add_u32 s77, s47, 1024
    s_cmp_ge_u32 s66, 4
    s_cselect_b32 s75, -1, 0
    s_cmp_ge_u32 s66, 3
    s_cselect_b32 s74, -1, 1
    s_cselect_b32 s77, s77, 163712
    v_add_u32 v252, s44, v247
    ds_read2_b32 v[238:239], v252 offset0:0 offset1:16
    v_add_u32 v252, s45, v247
    ds_read2_b32 v[240:241], v252 offset0:0 offset1:16
    v_mfma_f32_32x32x16_bf16 v[32:47], v[72:75], v[180:183], 0
    v_mul_f32 v196, v56, v96
    v_fmac_f32 v196, v57, v97
    v_fmac_f32 v196, v58, v98
    v_fmac_f32 v196, v59, v99
    v_fmac_f32 v196, v60, v100
    v_fmac_f32 v196, v61, v101
    v_mfma_f32_32x32x16_bf16 v[0:15], v[76:79], v[180:183], 0
    s_waitcnt vmcnt(6)
    ds_read_b64_tr_b16 v[176:177], v244 offset:4096
    ds_read_b64_tr_b16 v[178:179], v244 offset:5120
    ds_read_b64_tr_b16 v[180:181], v245 offset:4096
    ds_read_b64_tr_b16 v[182:183], v245 offset:5120
    v_fmac_f32 v196, v62, v102
    v_fmac_f32 v196, v63, v103
    v_mfma_f32_32x32x16_bf16 v[32:47], v[80:83], v[184:187], v[32:47]
    v_mul_f32 v198, v64, v128
    v_fmac_f32 v198, v65, v129
    v_fmac_f32 v198, v66, v130
    v_fmac_f32 v198, v67, v131
    v_fmac_f32 v198, v68, v132
    v_fmac_f32 v198, v69, v133
    v_mfma_f32_32x32x16_bf16 v[0:15], v[84:87], v[184:187], v[0:15]
    v_fmac_f32 v198, v70, v134
    v_fmac_f32 v198, v71, v135
    v_mul_f32 v200, v16, v128
    v_fmac_f32 v200, v17, v129
    v_permlane32_swap_b32 v196, v198
    v_fmac_f32 v200, v18, v130
    v_fmac_f32 v200, v19, v131
    v_fmac_f32 v200, v20, v132
    v_fmac_f32 v200, v21, v133
    v_fmac_f32 v200, v22, v134
    v_fmac_f32 v200, v23, v135
    v_add_f32 v198, v196, v198
    v_mul_f32_e64 v202, v24, -v128
    v_fma_f32 v202, v25, -v129, v202
    v_fma_f32 v202, v26, -v130, v202
    v_fma_f32 v202, v27, -v131, v202
    v_fma_f32 v202, v28, -v132, v202
    v_fma_f32 v202, v29, -v133, v202
    v_fma_f32 v202, v30, -v134, v202
    v_fma_f32 v202, v31, -v135, v202
    s_nop 1
    v_permlane32_swap_b32 v200, v202
    v_add_f32 v202, v200, v202
    s_waitcnt vmcnt(4) lgkmcnt(0)
    v_mfma_f32_32x32x16_bf16 v[56:71], v[72:75], v[176:179], 0
    v_mul_f32 v197, v32, v104
    v_fmac_f32 v197, v33, v105
    v_fmac_f32 v197, v34, v106
    v_fmac_f32 v197, v35, v107
    v_fmac_f32 v197, v36, v108
    v_fmac_f32 v197, v37, v109
    s_add_u32 m0, s21, 4096
    v_mfma_f32_32x32x16_bf16 v[16:31], v[76:79], v[176:179], 0
    buffer_load_dwordx4 v234, s[4:7], s37 offen  lds
    buffer_load_dwordx4 v235, s[8:11], s37 offen offset:1024  lds
    ds_read_b64_tr_b16 v[176:177], v244 offset:6144
    ds_read_b64_tr_b16 v[178:179], v244 offset:7168
    ds_read_b64_tr_b16 v[184:185], v245 offset:6144
    ds_read_b64_tr_b16 v[186:187], v245 offset:7168
    v_add_u32 v252, s42, v247
    ds_read2_b32 v[234:235], v252 offset0:0 offset1:16
    v_fmac_f32 v197, v38, v110
    v_fmac_f32 v197, v39, v111
    v_mul_f32 v199, v40, v136
    v_fmac_f32 v199, v41, v137
    v_fmac_f32 v199, v42, v138
    v_fmac_f32 v199, v43, v139
    v_fmac_f32 v199, v44, v140
    v_fmac_f32 v199, v45, v141
    v_fmac_f32 v199, v46, v142
    v_fmac_f32 v199, v47, v143
    v_mul_f32 v201, v0, v136
    v_fmac_f32 v201, v1, v137
    v_permlane32_swap_b32 v197, v199
    v_fmac_f32 v201, v2, v138
    v_fmac_f32 v201, v3, v139
    v_fmac_f32 v201, v4, v140
    v_fmac_f32 v201, v5, v141
    v_fmac_f32 v201, v6, v142
    v_fmac_f32 v201, v7, v143
    v_add_f32 v199, v197, v199
    v_mul_f32_e64 v203, v8, -v136
    v_fma_f32 v203, v9, -v137, v203
    v_fma_f32 v203, v10, -v138, v203
    v_fma_f32 v203, v11, -v139, v203
    s_waitcnt lgkmcnt(1)
    v_mfma_f32_32x32x16_bf16 v[56:71], v[80:83], v[176:179], v[56:71]
    v_fma_f32 v203, v12, -v140, v203
    v_fma_f32 v203, v13, -v141, v203
    v_fma_f32 v203, v14, -v142, v203
    v_fma_f32 v203, v15, -v143, v203
    s_nop 1
    v_permlane32_swap_b32 v201, v203
    v_add_f32 v203, v201, v203
    s_add_u32 m0, s21, 6144
    v_mfma_f32_32x32x16_bf16 v[16:31], v[84:87], v[176:179], v[16:31]
    buffer_load_dwordx4 v236, s[4:7], s37 offen  lds
    buffer_load_dwordx4 v237, s[8:11], s37 offen offset:1024  lds
    v_add_u32 v252, s43, v247
    ds_read2_b32 v[236:237], v252 offset0:0 offset1:16
    s_set_gpr_idx_on s51, gpr_idx(DST)
    s_nop 0
    v_cvt_pk_bf16_f32 v204, v198, v199
    v_cvt_pk_bf16_f32 v205, v202, v203
    s_set_gpr_idx_off
    v_mfma_f32_32x32x16_bf16 v[32:47], v[72:75], v[180:183], 0
    v_mul_f32 v196, v56, v144
    v_fmac_f32 v196, v57, v145
    v_fmac_f32 v196, v58, v146
    v_fmac_f32 v196, v59, v147
    v_fmac_f32 v196, v60, v148
    v_fmac_f32 v196, v61, v149
    v_mfma_f32_32x32x16_bf16 v[0:15], v[76:79], v[180:183], 0
    s_waitcnt vmcnt(6)
    ds_read_b64_tr_b16 v[176:177], v244 offset:0
    ds_read_b64_tr_b16 v[178:179], v244 offset:1024
    ds_read_b64_tr_b16 v[180:181], v245 offset:0
    ds_read_b64_tr_b16 v[182:183], v245 offset:1024
    v_fmac_f32 v196, v62, v150
    v_fmac_f32 v196, v63, v151
    v_mfma_f32_32x32x16_bf16 v[32:47], v[80:83], v[184:187], v[32:47]
    v_mul_f32_e64 v200, v16, -v160
    v_fma_f32 v200, v17, -v161, v200
    v_fma_f32 v200, v18, -v162, v200
    v_fma_f32 v200, v19, -v163, v200
    v_fma_f32 v200, v20, -v164, v200
    v_fma_f32 v200, v21, -v165, v200
    v_mfma_f32_32x32x16_bf16 v[0:15], v[84:87], v[184:187], v[0:15]
    v_fma_f32 v200, v22, -v166, v200
    v_fma_f32 v200, v23, -v167, v200
    v_mul_f32_e64 v202, v24, -v160
    v_fma_f32 v202, v25, -v161, v202
    v_fma_f32 v202, v26, -v162, v202
    v_fma_f32 v202, v27, -v163, v202
    v_fma_f32 v202, v28, -v164, v202
    v_fma_f32 v202, v29, -v165, v202
    v_fma_f32 v202, v30, -v166, v202
    v_fma_f32 v202, v31, -v167, v202
    s_waitcnt vmcnt(4) lgkmcnt(0)
    v_mfma_f32_32x32x16_bf16 v[16:31], v[72:75], v[176:179], 0
    v_mul_f32 v197, v32, v152
    v_fmac_f32 v197, v33, v153
    v_fmac_f32 v197, v34, v154
    v_fmac_f32 v197, v35, v155
    v_fmac_f32 v197, v36, v156
    v_fmac_f32 v197, v37, v157
    s_add_u32 m0, s21, 0
    v_mfma_f32_32x32x16_bf16 v[48:63], v[76:79], v[176:179], 0
    v_mad_u32_u16 v234, v234, s3, v246 op_sel:[1,0,0,0]
    v_mad_u32_u16 v235, v235, s3, v246 op_sel:[1,0,0,0]
    buffer_load_dwordx4 v234, s[4:7], s38 offen  lds
    buffer_load_dwordx4 v235, s[8:11], s38 offen offset:1024  lds
    ds_read_b64_tr_b16 v[176:177], v244 offset:2048
    ds_read_b64_tr_b16 v[178:179], v244 offset:3072
    ds_read_b64_tr_b16 v[184:185], v245 offset:2048
    ds_read_b64_tr_b16 v[186:187], v245 offset:3072
    v_fmac_f32 v197, v38, v158
    v_fmac_f32 v197, v39, v159
    v_mul_f32_e64 v201, v0, -v168
    v_fma_f32 v201, v1, -v169, v201
    v_fma_f32 v201, v2, -v170, v201
    v_fma_f32 v201, v3, -v171, v201
    v_fma_f32 v201, v4, -v172, v201
    v_fma_f32 v201, v5, -v173, v201
    v_fma_f32 v201, v6, -v174, v201
    v_fma_f32 v201, v7, -v175, v201
    s_waitcnt lgkmcnt(0)
    v_mfma_f32_32x32x16_bf16 v[16:31], v[80:83], v[176:179], v[16:31]
    v_mul_f32_e64 v203, v8, -v168
    v_fma_f32 v203, v9, -v169, v203
    v_fma_f32 v203, v10, -v170, v203
    v_fma_f32 v203, v11, -v171, v203
    v_fma_f32 v203, v12, -v172, v203
    v_fma_f32 v203, v13, -v173, v203
    s_add_u32 m0, s21, 2048
    v_mfma_f32_32x32x16_bf16 v[48:63], v[84:87], v[176:179], v[48:63]
    v_mad_u32_u16 v236, v236, s3, v246 op_sel:[1,0,0,0]
    v_mad_u32_u16 v237, v237, s3, v246 op_sel:[1,0,0,0]
    buffer_load_dwordx4 v236, s[4:7], s39 offen  lds
    buffer_load_dwordx4 v237, s[8:11], s39 offen offset:1024  lds
    v_fma_f32 v203, v14, -v174, v203
    v_fma_f32 v203, v15, -v175, v203
    v_mfma_f32_32x32x16_bf16 v[0:15], v[72:75], v[180:183], 0
    v_fmac_f32 v200, v24, v160
    v_fmac_f32 v200, v25, v161
    v_fmac_f32 v200, v26, v162
    v_fmac_f32 v200, v27, v163
    v_fmac_f32 v200, v28, v164
    v_fmac_f32 v200, v29, v165
    v_fmac_f32 v200, v30, v166
    v_fmac_f32 v200, v31, v167
    v_mfma_f32_32x32x16_bf16 v[24:39], v[76:79], v[180:183], 0
    v_add_u32 v253, s47, v248
    ds_read_b32 v192, v253
    ds_read_b32 v193, v253 offset:256
    s_waitcnt vmcnt(6)
    ds_read_b64_tr_b16 v[176:177], v244 offset:4096
    ds_read_b64_tr_b16 v[178:179], v244 offset:5120
    ds_read_b64_tr_b16 v[180:181], v245 offset:4096
    ds_read_b64_tr_b16 v[182:183], v245 offset:5120
    v_mfma_f32_32x32x16_bf16 v[24:39], v[84:87], v[184:187], v[24:39]
    v_mul_f32 v254, v16, v144
    v_fmac_f32 v254, v17, v145
    v_fmac_f32 v254, v18, v146
    v_fmac_f32 v254, v19, v147
    v_fmac_f32 v254, v20, v148
    v_fmac_f32 v254, v21, v149
    v_mfma_f32_32x32x16_bf16 v[0:15], v[80:83], v[184:187], v[0:15]
    v_fmac_f32 v254, v22, v150
    v_fmac_f32 v254, v23, v151
    v_sub_f32_e64 v64, -v48, v64
    v_sub_f32_e64 v65, -v49, v65
    v_permlane32_swap_b32 v196, v254
    v_sub_f32_e64 v66, -v50, v66
    v_sub_f32_e64 v67, -v51, v67
    v_sub_f32_e64 v68, -v52, v68
    v_sub_f32_e64 v69, -v53, v69
    v_sub_f32_e64 v70, -v54, v70
    v_sub_f32_e64 v71, -v55, v71
    v_add_f32 v254, v196, v254
    s_waitcnt vmcnt(4) lgkmcnt(0)
    v_mfma_f32_32x32x16_bf16 v[56:71], v[76:79], v[176:179], v[56:71]
    v_sub_f32_e64 v40, -v24, v40
    v_sub_f32_e64 v41, -v25, v41
    v_sub_f32_e64 v42, -v26, v42
    v_sub_f32_e64 v43, -v27, v43
    v_sub_f32_e64 v44, -v28, v44
    v_sub_f32_e64 v45, -v29, v45
    v_sub_f32_e64 v46, -v30, v46
    v_sub_f32_e64 v47, -v31, v47
    s_mov_b32 m0, s76
    s_mov_b64 exec, s[72:73]
    buffer_load_dwordx4 v192, s[12:15], 0 offen  lds
    s_mov_b32 m0, s77
    s_mov_b64 exec, s[74:75]
    buffer_load_dwordx4 v193, s[12:15], 0 offen  lds
    s_mov_b64 exec, -1
    s_add_u32 m0, s21, 4096
    v_mfma_f32_32x32x16_bf16 v[16:31], v[72:75], v[176:179], 0
    v_mad_u32_u16 v238, v238, s3, v246 op_sel:[1,0,0,0]
    v_mad_u32_u16 v239, v239, s3, v246 op_sel:[1,0,0,0]
    buffer_load_dwordx4 v238, s[4:7], s40 offen  lds
    buffer_load_dwordx4 v239, s[8:11], s40 offen offset:1024  lds
    ds_read_b64_tr_b16 v[176:177], v244 offset:6144
    ds_read_b64_tr_b16 v[178:179], v244 offset:7168
    ds_read_b64_tr_b16 v[184:185], v245 offset:6144
    ds_read_b64_tr_b16 v[186:187], v245 offset:7168
    v_mul_f32 v255, v0, v152
    v_fmac_f32 v255, v1, v153
    v_fmac_f32 v255, v2, v154
    v_fmac_f32 v255, v3, v155
    v_fmac_f32 v255, v4, v156
    v_fmac_f32 v255, v5, v157
    v_fmac_f32 v255, v6, v158
    v_fmac_f32 v255, v7, v159
    v_fmac_f32 v201, v8, v168
    v_fmac_f32 v201, v9, v169
    v_permlane32_swap_b32 v197, v255
    s_waitcnt lgkmcnt(0)
    v_mfma_f32_32x32x16_bf16 v[16:31], v[80:83], v[176:179], v[16:31]
    v_fmac_f32 v201, v10, v170
    v_fmac_f32 v201, v11, v171
    v_fmac_f32 v201, v12, v172
    v_fmac_f32 v201, v13, v173
    v_fmac_f32 v201, v14, v174
    v_fmac_f32 v201, v15, v175
    s_add_u32 m0, s21, 6144
    v_mfma_f32_32x32x16_bf16 v[56:71], v[84:87], v[176:179], v[56:71]
    v_mad_u32_u16 v240, v240, s3, v246 op_sel:[1,0,0,0]
    v_mad_u32_u16 v241, v241, s3, v246 op_sel:[1,0,0,0]
    buffer_load_dwordx4 v240, s[4:7], s41 offen  lds
    buffer_load_dwordx4 v241, s[8:11], s41 offen offset:1024  lds
    v_add_f32 v255, v197, v255
    s_set_gpr_idx_on s51, gpr_idx(DST)
    s_nop 0
    v_cvt_pk_bf16_f32 v206, v254, v255
    s_set_gpr_idx_off
    v_mfma_f32_32x32x16_bf16 v[0:15], v[72:75], v[180:183], 0
    v_mul_f32 v254, v16, v144
    v_fmac_f32 v254, v17, v145
    v_fmac_f32 v254, v18, v146
    v_fmac_f32 v254, v19, v147
    v_fmac_f32 v254, v20, v148
    v_fmac_f32 v254, v21, v149
    v_mfma_f32_32x32x16_bf16 v[32:47], v[76:79], v[180:183], v[32:47]
    s_waitcnt vmcnt(8)
    ds_read_b64_tr_b16 v[176:177], v244 offset:0
    ds_read_b64_tr_b16 v[178:179], v244 offset:1024
    ds_read_b64_tr_b16 v[180:181], v245 offset:0
    ds_read_b64_tr_b16 v[182:183], v245 offset:1024
    v_fmac_f32 v254, v22, v150
    v_fmac_f32 v254, v23, v151
    v_mfma_f32_32x32x16_bf16 v[0:15], v[80:83], v[184:187], v[0:15]
    v_fma_f32 v202, v24, -v160, v202
    v_fma_f32 v202, v25, -v161, v202
    v_permlane32_swap_b32 v254, v200
    v_fma_f32 v202, v26, -v162, v202
    v_fma_f32 v202, v27, -v163, v202
    v_fma_f32 v202, v28, -v164, v202
    v_mfma_f32_32x32x16_bf16 v[32:47], v[84:87], v[184:187], v[32:47]
    v_add_u32 v249, s48, v249
    v_add_u32 v250, s49, v250
    v_fma_f32 v202, v29, -v165, v202
    v_fma_f32 v202, v30, -v166, v202
    v_fma_f32 v202, v31, -v167, v202
    v_add_f32 v200, v254, v200
    v_mul_f32_e64 v198, v64, -v112
    v_permlane32_swap_b32 v202, v254
    v_fma_f32 v198, v65, -v113, v198
    v_fma_f32 v198, v66, -v114, v198
    v_fma_f32 v198, v67, -v115, v198
    v_fma_f32 v198, v68, -v116, v198
    v_fma_f32 v198, v69, -v117, v198
    v_fma_f32 v198, v70, -v118, v198
    v_fma_f32 v198, v71, -v119, v198
    v_add_f32 v254, v202, v254
    v_mul_f32 v196, v56, v160
    v_fmac_f32 v196, v57, v161
    v_fmac_f32 v196, v58, v162
    v_fmac_f32 v196, v59, v163
    v_fmac_f32 v196, v60, v164
    v_fmac_f32 v196, v61, v165
    v_fmac_f32 v196, v62, v166
    v_fmac_f32 v196, v63, v167
    s_nop 1
    v_permlane32_swap_b32 v198, v196
    v_add_f32 v196, v198, v196
    v_mul_f32 v255, v0, v152
    v_fmac_f32 v255, v1, v153
    v_fmac_f32 v255, v2, v154
    v_fmac_f32 v255, v3, v155
    v_fmac_f32 v255, v4, v156
    v_fmac_f32 v255, v5, v157
    v_fmac_f32 v255, v6, v158
    v_fmac_f32 v255, v7, v159
    v_fma_f32 v203, v8, -v168, v203
    v_fma_f32 v203, v9, -v169, v203
    v_permlane32_swap_b32 v255, v201
    v_fma_f32 v203, v10, -v170, v203
    v_fma_f32 v203, v11, -v171, v203
    v_fma_f32 v203, v12, -v172, v203
    v_fma_f32 v203, v13, -v173, v203
    v_fma_f32 v203, v14, -v174, v203
    v_fma_f32 v203, v15, -v175, v203
    v_add_f32 v201, v255, v201
    v_mul_f32_e64 v199, v40, -v120
    v_permlane32_swap_b32 v203, v255
    v_fma_f32 v199, v41, -v121, v199
    v_fma_f32 v199, v42, -v122, v199
    v_fma_f32 v199, v43, -v123, v199
    s_waitcnt vmcnt(4)
    ds_read_b64_tr_b16 v[72:73], v249 offset:0
    ds_read_b64_tr_b16 v[76:77], v249 offset:64
    ds_read_b64_tr_b16 v[74:75], v249 offset:256
    ds_read_b64_tr_b16 v[78:79], v249 offset:320
    s_mov_b64 exec, s[54:55]
    ds_read_u16_d16_hi v242, v250 offset:0
    s_mov_b64 exec, -1
    v_fma_f32 v199, v44, -v124, v199
    v_fma_f32 v199, v45, -v125, v199
    v_fma_f32 v199, v46, -v126, v199
    v_fma_f32 v199, v47, -v127, v199
    v_add_f32 v255, v203, v255
    v_mul_f32 v197, v32, v168
    v_fmac_f32 v197, v33, v169
    v_fmac_f32 v197, v34, v170
    v_fmac_f32 v197, v35, v171
    v_fmac_f32 v197, v36, v172
    v_fmac_f32 v197, v37, v173
    v_fmac_f32 v197, v38, v174
    v_fmac_f32 v197, v39, v175
    s_nop 1
    v_permlane32_swap_b32 v199, v197
    v_add_f32 v197, v199, v197
    s_set_gpr_idx_on s51, gpr_idx(DST)
    s_nop 0
    v_cvt_pk_bf16_f32 v207, v200, v201
    v_cvt_pk_bf16_f32 v209, v254, v255
    v_cvt_pk_bf16_f32 v208, v196, v197
    s_set_gpr_idx_off
    s_add_u32 s50, s50, 1
    s_add_u32 s51, s51, 6
    s_cmp_ge_u32 s50, 4
    s_cbranch_scc1 LAST0
    s_add_u32 s53, s53, 4
    s_xor_b32 s66, s53, s20
    s_bitcmp1_b32 s66, 2
    s_setprio 1
    s_cbranch_scc1 PRIO_5
    s_setprio 0
PRIO_5:
    s_cmp_eq_u32 s52, 4
    s_cbranch_scc1 ITEM_0_4
    s_cmp_eq_u32 s52, 5
    s_cbranch_scc1 ITEM_0_5
    s_cmp_eq_u32 s52, 3
    s_cbranch_scc1 ITEM_0_3
    s_cmp_eq_u32 s52, 6
    s_cbranch_scc1 ITEM_0_6
    s_cmp_eq_u32 s52, 8
    s_cbranch_scc1 ITEM_0_8
    s_branch ITEM_0_2
.p2align 6
ITEM_0_5:
    s_mov_b64 exec, s[54:55]
    ds_read_u16_d16_hi v243, v250 offset:128
    s_mov_b64 exec, -1
    ds_read_b64_tr_b16 v[80:81], v249 offset:512
    ds_read_b64_tr_b16 v[84:85], v249 offset:576
    ds_read_b64_tr_b16 v[82:83], v249 offset:768
    ds_read_b64_tr_b16 v[86:87], v249 offset:832
    ds_read_b64_tr_b16 v[88:89], v249 offset:1024
    ds_read_b64_tr_b16 v[92:93], v249 offset:1088
    s_waitcnt lgkmcnt(7)
    v_mul_f32_dpp v196, v242, v72 row_newbcast:0 row_mask:0xf bank_mask:0xf
    v_mul_f32_dpp v197, v242, v73 row_newbcast:1 row_mask:0xf bank_mask:0xf
    v_mul_f32_dpp v198, v242, v72 row_newbcast:8 row_mask:0xf bank_mask:0xf
    v_mul_f32_dpp v199, v242, v73 row_newbcast:9 row_mask:0xf bank_mask:0xf
    v_mul_f32_dpp v200, v242, v76 row_newbcast:2 row_mask:0xf bank_mask:0xf
    v_mul_f32_dpp v201, v242, v77 row_newbcast:3 row_mask:0xf bank_mask:0xf
    v_mul_f32_dpp v202, v242, v76 row_newbcast:10 row_mask:0xf bank_mask:0xf
    v_mul_f32_dpp v203, v242, v77 row_newbcast:11 row_mask:0xf bank_mask:0xf
    v_cvt_pk_bf16_f32 v72, v196, v197
    v_cvt_pk_bf16_f32 v76, v198, v199
    v_cvt_pk_bf16_f32 v73, v200, v201
    v_cvt_pk_bf16_f32 v77, v202, v203
    v_mul_f32_dpp v196, v242, v74 row_newbcast:4 row_mask:0xf bank_mask:0xf
    v_mul_f32_dpp v197, v242, v75 row_newbcast:5 row_mask:0xf bank_mask:0xf
    v_mul_f32_dpp v198, v242, v74 row_newbcast:12 row_mask:0xf bank_mask:0xf
    v_mul_f32_dpp v199, v242, v75 row_newbcast:13 row_mask:0xf bank_mask:0xf
    v_mul_f32_dpp v200, v242, v78 row_newbcast:6 row_mask:0xf bank_mask:0xf
    v_mul_f32_dpp v201, v242, v79 row_newbcast:7 row_mask:0xf bank_mask:0xf
    v_mul_f32_dpp v202, v242, v78 row_newbcast:14 row_mask:0xf bank_mask:0xf
    v_mul_f32_dpp v203, v242, v79 row_newbcast:15 row_mask:0xf bank_mask:0xf
    v_cvt_pk_bf16_f32 v74, v196, v197
    v_cvt_pk_bf16_f32 v78, v198, v199
    v_cvt_pk_bf16_f32 v75, v200, v201
    v_cvt_pk_bf16_f32 v79, v202, v203
    s_mov_b64 exec, s[54:55]
    ds_read_u16_d16_hi v242, v250 offset:256
    s_mov_b64 exec, -1
    s_waitcnt vmcnt(4) lgkmcnt(3)
    v_mfma_f32_32x32x16_bf16 v[56:71], v[72:75], v[176:179], 0
    v_mul_f32_dpp v196, v243, v80 row_newbcast:0 row_mask:0xf bank_mask:0xf
    v_mul_f32_dpp v197, v243, v81 row_newbcast:1 row_mask:0xf bank_mask:0xf
    v_mul_f32_dpp v198, v243, v80 row_newbcast:8 row_mask:0xf bank_mask:0xf
    v_mul_f32_dpp v199, v243, v81 row_newbcast:9 row_mask:0xf bank_mask:0xf
    v_mul_f32_dpp v200, v243, v84 row_newbcast:2 row_mask:0xf bank_mask:0xf
    v_mul_f32_dpp v201, v243, v85 row_newbcast:3 row_mask:0xf bank_mask:0xf
    s_add_u32 m0, s21, 0
    v_mfma_f32_32x32x16_bf16 v[16:31], v[76:79], v[176:179], 0
    buffer_load_dwordx4 v236, s[4:7], s35 offen  lds
    buffer_load_dwordx4 v237, s[8:11], s35 offen offset:1024  lds
    ds_read_b64_tr_b16 v[176:177], v244 offset:2048
    ds_read_b64_tr_b16 v[178:179], v244 offset:3072
    ds_read_b64_tr_b16 v[184:185], v245 offset:2048
    ds_read_b64_tr_b16 v[186:187], v245 offset:3072
    v_mul_f32_dpp v202, v243, v84 row_newbcast:10 row_mask:0xf bank_mask:0xf
    v_mul_f32_dpp v203, v243, v85 row_newbcast:11 row_mask:0xf bank_mask:0xf
    v_cvt_pk_bf16_f32 v80, v196, v197
    v_cvt_pk_bf16_f32 v84, v198, v199
    v_cvt_pk_bf16_f32 v81, v200, v201
    v_cvt_pk_bf16_f32 v85, v202, v203
    v_mul_f32_dpp v196, v243, v82 row_newbcast:4 row_mask:0xf bank_mask:0xf
    v_mul_f32_dpp v197, v243, v83 row_newbcast:5 row_mask:0xf bank_mask:0xf
    v_mul_f32_dpp v198, v243, v82 row_newbcast:12 row_mask:0xf bank_mask:0xf
    v_mul_f32_dpp v199, v243, v83 row_newbcast:13 row_mask:0xf bank_mask:0xf
    v_mul_f32_dpp v200, v243, v86 row_newbcast:6 row_mask:0xf bank_mask:0xf
    v_mul_f32_dpp v201, v243, v87 row_newbcast:7 row_mask:0xf bank_mask:0xf
    v_mul_f32_dpp v202, v243, v86 row_newbcast:14 row_mask:0xf bank_mask:0xf
    v_mul_f32_dpp v203, v243, v87 row_newbcast:15 row_mask:0xf bank_mask:0xf
    v_cvt_pk_bf16_f32 v82, v196, v197
    v_cvt_pk_bf16_f32 v86, v198, v199
    v_cvt_pk_bf16_f32 v83, v200, v201
    v_cvt_pk_bf16_f32 v87, v202, v203
    s_waitcnt vmcnt(4) lgkmcnt(0)
    v_mfma_f32_32x32x16_bf16 v[56:71], v[80:83], v[176:179], v[56:71]
    v_mul_f32_dpp v196, v242, v88 row_newbcast:0 row_mask:0xf bank_mask:0xf
    v_mul_f32_dpp v197, v242, v89 row_newbcast:1 row_mask:0xf bank_mask:0xf
    v_mul_f32_dpp v198, v242, v88 row_newbcast:8 row_mask:0xf bank_mask:0xf
    v_mul_f32_dpp v199, v242, v89 row_newbcast:9 row_mask:0xf bank_mask:0xf
    v_mul_f32_dpp v200, v242, v92 row_newbcast:2 row_mask:0xf bank_mask:0xf
    v_mul_f32_dpp v201, v242, v93 row_newbcast:3 row_mask:0xf bank_mask:0xf
    s_add_u32 m0, s21, 2048
    v_mfma_f32_32x32x16_bf16 v[16:31], v[84:87], v[176:179], v[16:31]
    buffer_load_dwordx4 v238, s[4:7], s35 offen  lds
    ds_read_b64_tr_b16 v[176:177], v244 offset:4096
    ds_read_b64_tr_b16 v[188:189], v245 offset:4096
    v_mul_f32_dpp v202, v242, v92 row_newbcast:10 row_mask:0xf bank_mask:0xf
    v_mul_f32_dpp v203, v242, v93 row_newbcast:11 row_mask:0xf bank_mask:0xf
    v_cvt_pk_bf16_f32 v88, v196, v197
    v_cvt_pk_bf16_f32 v92, v198, v199
    v_cvt_pk_bf16_f32 v89, v200, v201
    v_cvt_pk_bf16_f32 v93, v202, v203
    s_waitcnt lgkmcnt(0)
    v_mfma_f32_32x32x8_bf16 v[56:71], v[88:89], v[176:177], v[56:71]
    s_add_u32 m0, s21, 4096
    v_mfma_f32_32x32x8_bf16 v[16:31], v[92:93], v[176:177], v[16:31]
    buffer_load_dwordx4 v234, s[4:7], s36 offen  lds
    buffer_load_dwordx4 v235, s[8:11], s36 offen offset:1024  lds
    s_mov_b32 m0, s50
    s_nop 0
    s_movrels_b32 s71, s23
    s_bfe_u32 s46, s71, 0x30012
    s_mov_b32 m0, s46
    s_and_b32 s66, s71, 0x3ffff
    s_movrels_b32 s68, s57
    s_movrels_b32 s69, s61
    s_sub_u32 s48, s66, s47
    s_mov_b32 s47, s66
    s_lshr_b32 s52, s71, 28
    s_lshl_b32 s67, s46, 9
    s_add_u32 s66, s66, s67
    s_sub_u32 s49, s66, s42
    s_mov_b32 s42, s66
    s_bfe_u32 s66, s68, 655360
    s_add_u32 s43, s42, s66
    s_bfe_u32 s39, s69, 655360
    s_bfe_u32 s66, s68, 655370
    s_add_u32 s44, s42, s66
    s_bfe_u32 s40, s69, 655370
    s_bfe_u32 s66, s68, 655380
    s_add_u32 s45, s42, s66
    s_bfe_u32 s41, s69, 655380
    s_and_b32 s66, s46, s33
    s_cselect_b32 s72, -1, 1
    s_cselect_b32 s76, s47, 163712
    s_cmp_ge_u32 s66, 2
    s_cselect_b32 s73, -1, 0
    s_add_u32 s77, s47, 1024
    s_cmp_ge_u32 s66, 4
    s_cselect_b32 s75, -1, 0
    s_cmp_ge_u32 s66, 3
    s_cselect_b32 s74, -1, 1
    s_cselect_b32 s77, s77, 163712
    v_add_u32 v252, s45, v247
    ds_read2_b32 v[240:241], v252 offset0:0 offset1:16
    v_mfma_f32_32x32x16_bf16 v[32:47], v[72:75], v[180:183], 0
    v_mul_f32 v196, v56, v96
    v_fmac_f32 v196, v57, v97
    v_fmac_f32 v196, v58, v98
    v_fmac_f32 v196, v59, v99
    v_fmac_f32 v196, v60, v100
    v_fmac_f32 v196, v61, v101
    v_mfma_f32_32x32x16_bf16 v[0:15], v[76:79], v[180:183], 0
    v_fmac_f32 v196, v62, v102
    v_fmac_f32 v196, v63, v103
    v_mul_f32 v198, v64, v128
    v_fmac_f32 v198, v65, v129
    v_fmac_f32 v198, v66, v130
    v_fmac_f32 v198, v67, v131
    v_mfma_f32_32x32x16_bf16 v[32:47], v[80:83], v[184:187], v[32:47]
    v_fmac_f32 v198, v68, v132
    v_fmac_f32 v198, v69, v133
    v_fmac_f32 v198, v70, v134
    v_fmac_f32 v198, v71, v135
    v_mul_f32 v200, v16, v128
    v_fmac_f32 v200, v17, v129
    v_mfma_f32_32x32x16_bf16 v[0:15], v[84:87], v[184:187], v[0:15]
    s_waitcnt vmcnt(5)
    ds_read_b64_tr_b16 v[176:177], v244 offset:6144
    ds_read_b64_tr_b16 v[178:179], v244 offset:7168
    ds_read_b64_tr_b16 v[180:181], v245 offset:6144
    ds_read_b64_tr_b16 v[182:183], v245 offset:7168
    v_permlane32_swap_b32 v196, v198
    v_fmac_f32 v200, v18, v130
    v_mfma_f32_32x32x8_bf16 v[32:47], v[88:89], v[188:189], v[32:47]
    v_fmac_f32 v200, v19, v131
    v_fmac_f32 v200, v20, v132
    v_fmac_f32 v200, v21, v133
    v_fmac_f32 v200, v22, v134
    v_fmac_f32 v200, v23, v135
    v_add_f32 v198, v196, v198
    v_mfma_f32_32x32x8_bf16 v[0:15], v[92:93], v[188:189], v[0:15]
    v_mul_f32_e64 v202, v24, -v128
    v_fma_f32 v202, v25, -v129, v202
    v_fma_f32 v202, v26, -v130, v202
    v_fma_f32 v202, v27, -v131, v202
    v_fma_f32 v202, v28, -v132, v202
    v_fma_f32 v202, v29, -v133, v202
    v_fma_f32 v202, v30, -v134, v202
    v_fma_f32 v202, v31, -v135, v202
    s_nop 1
    v_permlane32_swap_b32 v200, v202
    v_add_f32 v202, v200, v202
    s_waitcnt vmcnt(3) lgkmcnt(0)
    v_mfma_f32_32x32x16_bf16 v[56:71], v[72:75], v[176:179], 0
    v_mul_f32 v197, v32, v104
    v_fmac_f32 v197, v33, v105
    v_fmac_f32 v197, v34, v106
    v_fmac_f32 v197, v35, v107
    v_fmac_f32 v197, v36, v108
    v_fmac_f32 v197, v37, v109
    s_add_u32 m0, s21, 6144
    v_mfma_f32_32x32x16_bf16 v[16:31], v[76:79], v[176:179], 0
    buffer_load_dwordx4 v236, s[4:7], s36 offen  lds
    buffer_load_dwordx4 v237, s[8:11], s36 offen offset:1024  lds
    ds_read_b64_tr_b16 v[176:177], v244 offset:0
    ds_read_b64_tr_b16 v[178:179], v244 offset:1024
    ds_read_b64_tr_b16 v[184:185], v245 offset:0
    ds_read_b64_tr_b16 v[186:187], v245 offset:1024
    v_fmac_f32 v197, v38, v110
    v_fmac_f32 v197, v39, v111
    v_mul_f32 v199, v40, v136
    v_fmac_f32 v199, v41, v137
    v_fmac_f32 v199, v42, v138
    v_fmac_f32 v199, v43, v139
    v_fmac_f32 v199, v44, v140
    v_fmac_f32 v199, v45, v141
    v_fmac_f32 v199, v46, v142
    v_fmac_f32 v199, v47, v143
    v_mul_f32 v201, v0, v136
    v_fmac_f32 v201, v1, v137
    v_permlane32_swap_b32 v197, v199
    v_fmac_f32 v201, v2, v138
    v_fmac_f32 v201, v3, v139
    s_waitcnt vmcnt(4) lgkmcnt(0)
    v_mfma_f32_32x32x16_bf16 v[56:71], v[80:83], v[176:179], v[56:71]
    v_fmac_f32 v201, v4, v140
    v_fmac_f32 v201, v5, v141
    v_fmac_f32 v201, v6, v142
    v_fmac_f32 v201, v7, v143
    v_add_f32 v199, v197, v199
    v_mul_f32_e64 v203, v8, -v136
    s_add_u32 m0, s21, 0
    v_mfma_f32_32x32x16_bf16 v[16:31], v[84:87], v[176:179], v[16:31]
    buffer_load_dwordx4 v238, s[4:7], s36 offen  lds
    ds_read_b64_tr_b16 v[176:177], v244 offset:2048
    ds_read_b64_tr_b16 v[188:189], v245 offset:2048
    v_fma_f32 v203, v9, -v137, v203
    v_fma_f32 v203, v10, -v138, v203
    v_fma_f32 v203, v11, -v139, v203
    s_waitcnt lgkmcnt(0)
    v_mfma_f32_32x32x8_bf16 v[56:71], v[88:89], v[176:177], v[56:71]
    v_fma_f32 v203, v12, -v140, v203
    v_fma_f32 v203, v13, -v141, v203
    v_fma_f32 v203, v14, -v142, v203
    v_fma_f32 v203, v15, -v143, v203
    s_nop 1
    v_permlane32_swap_b32 v201, v203
    v_add_f32 v203, v201, v203
    s_add_u32 m0, s21, 2048
    v_mfma_f32_32x32x8_bf16 v[16:31], v[92:93], v[176:177], v[16:31]
    buffer_load_dwordx4 v234, s[4:7], s37 offen  lds
    buffer_load_dwordx4 v235, s[8:11], s37 offen offset:1024  lds
    v_add_u32 v252, s42, v247
    ds_read2_b32 v[234:235], v252 offset0:0 offset1:16
    s_set_gpr_idx_on s51, gpr_idx(DST)
    s_nop 0
    v_cvt_pk_bf16_f32 v204, v198, v199
    v_cvt_pk_bf16_f32 v205, v202, v203
    s_set_gpr_idx_off
    v_mfma_f32_32x32x16_bf16 v[32:47], v[72:75], v[180:183], 0
    v_mul_f32 v196, v56, v144
    v_fmac_f32 v196, v57, v145
    v_fmac_f32 v196, v58, v146
    v_fmac_f32 v196, v59, v147
    v_fmac_f32 v196, v60, v148
    v_fmac_f32 v196, v61, v149
    v_mfma_f32_32x32x16_bf16 v[0:15], v[76:79], v[180:183], 0
    v_fmac_f32 v196, v62, v150
    v_fmac_f32 v196, v63, v151
    v_mul_f32_e64 v200, v16, -v160
    v_fma_f32 v200, v17, -v161, v200
    v_fma_f32 v200, v18, -v162, v200
    v_fma_f32 v200, v19, -v163, v200
    v_mfma_f32_32x32x16_bf16 v[32:47], v[80:83], v[184:187], v[32:47]
    v_fma_f32 v200, v20, -v164, v200
    v_fma_f32 v200, v21, -v165, v200
    v_fma_f32 v200, v22, -v166, v200
    v_fma_f32 v200, v23, -v167, v200
    v_mul_f32_e64 v202, v24, -v160
    v_fma_f32 v202, v25, -v161, v202
    v_mfma_f32_32x32x16_bf16 v[0:15], v[84:87], v[184:187], v[0:15]
    s_waitcnt vmcnt(5)
    ds_read_b64_tr_b16 v[176:177], v244 offset:4096
    ds_read_b64_tr_b16 v[178:179], v244 offset:5120
    ds_read_b64_tr_b16 v[180:181], v245 offset:4096
    ds_read_b64_tr_b16 v[182:183], v245 offset:5120
    v_fma_f32 v202, v26, -v162, v202
    v_fma_f32 v202, v27, -v163, v202
    v_mfma_f32_32x32x8_bf16 v[32:47], v[88:89], v[188:189], v[32:47]
    v_fma_f32 v202, v28, -v164, v202
    v_fma_f32 v202, v29, -v165, v202
    v_fma_f32 v202, v30, -v166, v202
    v_fma_f32 v202, v31, -v167, v202
    v_mfma_f32_32x32x8_bf16 v[0:15], v[92:93], v[188:189], v[0:15]
    s_waitcnt vmcnt(3) lgkmcnt(0)
    v_mfma_f32_32x32x16_bf16 v[16:31], v[72:75], v[176:179], 0
    s_nop 4
    v_mul_f32 v197, v32, v152
    v_fmac_f32 v197, v33, v153
    v_fmac_f32 v197, v34, v154
    v_fmac_f32 v197, v35, v155
    v_fmac_f32 v197, v36, v156
    v_fmac_f32 v197, v37, v157
    s_add_u32 m0, s21, 4096
    v_mfma_f32_32x32x16_bf16 v[48:63], v[76:79], v[176:179], 0
    buffer_load_dwordx4 v236, s[4:7], s37 offen  lds
    buffer_load_dwordx4 v237, s[8:11], s37 offen offset:1024  lds
    ds_read_b64_tr_b16 v[176:177], v244 offset:6144
    ds_read_b64_tr_b16 v[178:179], v244 offset:7168
    ds_read_b64_tr_b16 v[184:185], v245 offset:6144
    ds_read_b64_tr_b16 v[186:187], v245 offset:7168
    v_add_u32 v252, s43, v247
    ds_read2_b32 v[236:237], v252 offset0:0 offset1:16
    v_fmac_f32 v197, v38, v158
    v_fmac_f32 v197, v39, v159
    v_mul_f32_e64 v201, v0, -v168
    s_waitcnt vmcnt(4) lgkmcnt(1)
    v_mfma_f32_32x32x16_bf16 v[16:31], v[80:83], v[176:179], v[16:31]
    v_fma_f32 v201, v1, -v169, v201
    v_fma_f32 v201, v2, -v170, v201
    v_fma_f32 v201, v3, -v171, v201
    v_fma_f32 v201, v4, -v172, v201
    v_fma_f32 v201, v5, -v173, v201
    v_fma_f32 v201, v6, -v174, v201
    s_add_u32 m0, s21, 6144
    v_mfma_f32_32x32x16_bf16 v[48:63], v[84:87], v[176:179], v[48:63]
    buffer_load_dwordx4 v238, s[4:7], s37 offen  lds
    ds_read_b64_tr_b16 v[176:177], v244 offset:0
    ds_read_b64_tr_b16 v[188:189], v245 offset:0
    v_add_u32 v252, s44, v247
    ds_read2_b32 v[238:239], v252 offset0:0 offset1:16
    v_fma_f32 v201, v7, -v175, v201
    s_waitcnt lgkmcnt(1)
    v_mfma_f32_32x32x8_bf16 v[16:31], v[88:89], v[176:177], v[16:31]
    v_mul_f32_e64 v203, v8, -v168
    v_fma_f32 v203, v9, -v169, v203
    v_fma_f32 v203, v10, -v170, v203
    v_fma_f32 v203, v11, -v171, v203
    v_fma_f32 v203, v12, -v172, v203
    v_fma_f32 v203, v13, -v173, v203
    s_add_u32 m0, s21, 0
    v_mfma_f32_32x32x8_bf16 v[48:63], v[92:93], v[176:177], v[48:63]
    v_mad_u32_u16 v234, v234, s3, v246 op_sel:[1,0,0,0]
    v_mad_u32_u16 v235, v235, s3, v246 op_sel:[1,0,0,0]
    buffer_load_dwordx4 v234, s[4:7], s38 offen  lds
    buffer_load_dwordx4 v235, s[8:11], s38 offen offset:1024  lds
    v_fma_f32 v203, v14, -v174, v203
    v_fma_f32 v203, v15, -v175, v203
    v_mfma_f32_32x32x16_bf16 v[0:15], v[72:75], v[180:183], 0
    v_fmac_f32 v200, v24, v160
    v_fmac_f32 v200, v25, v161
    v_fmac_f32 v200, v26, v162
    v_fmac_f32 v200, v27, v163
    v_fmac_f32 v200, v28, v164
    v_fmac_f32 v200, v29, v165
    v_fmac_f32 v200, v30, v166
    v_fmac_f32 v200, v31, v167
    v_mfma_f32_32x32x16_bf16 v[24:39], v[76:79], v[180:183], 0
    v_add_u32 v253, s47, v248
    ds_read_b32 v192, v253
    ds_read_b32 v193, v253 offset:256
    v_mul_f32 v254, v16, v144
    v_fmac_f32 v254, v17, v145
    v_fmac_f32 v254, v18, v146
    v_mfma_f32_32x32x16_bf16 v[0:15], v[80:83], v[184:187], v[0:15]
    v_fmac_f32 v254, v19, v147
    v_fmac_f32 v254, v20, v148
    v_fmac_f32 v254, v21, v149
    v_fmac_f32 v254, v22, v150
    v_fmac_f32 v254, v23, v151
    v_sub_f32_e64 v64, -v48, v64
    v_mfma_f32_32x32x16_bf16 v[24:39], v[84:87], v[184:187], v[24:39]
    s_waitcnt vmcnt(5)
    ds_read_b64_tr_b16 v[176:177], v244 offset:2048
    ds_read_b64_tr_b16 v[178:179], v244 offset:3072
    ds_read_b64_tr_b16 v[180:181], v245 offset:2048
    ds_read_b64_tr_b16 v[182:183], v245 offset:3072
    v_sub_f32_e64 v65, -v49, v65
    v_permlane32_swap_b32 v196, v254
    v_mfma_f32_32x32x8_bf16 v[24:39], v[92:93], v[188:189], v[24:39]
    v_sub_f32_e64 v66, -v50, v66
    v_sub_f32_e64 v67, -v51, v67
    v_sub_f32_e64 v68, -v52, v68
    v_sub_f32_e64 v69, -v53, v69
    v_sub_f32_e64 v70, -v54, v70
    v_sub_f32_e64 v71, -v55, v71
    v_mfma_f32_32x32x8_bf16 v[0:15], v[88:89], v[188:189], v[0:15]
    v_add_f32 v254, v196, v254
    s_waitcnt vmcnt(3) lgkmcnt(0)
    v_mfma_f32_32x32x16_bf16 v[56:71], v[76:79], v[176:179], v[56:71]
    s_nop 1
    v_sub_f32_e64 v40, -v24, v40
    v_sub_f32_e64 v41, -v25, v41
    v_sub_f32_e64 v42, -v26, v42
    v_sub_f32_e64 v43, -v27, v43
    v_sub_f32_e64 v44, -v28, v44
    v_sub_f32_e64 v45, -v29, v45
    v_sub_f32_e64 v46, -v30, v46
    v_sub_f32_e64 v47, -v31, v47
    s_mov_b32 m0, s76
    s_mov_b64 exec, s[72:73]
    buffer_load_dwordx4 v192, s[12:15], 0 offen  lds
    s_mov_b32 m0, s77
    s_mov_b64 exec, s[74:75]
    buffer_load_dwordx4 v193, s[12:15], 0 offen  lds
    s_mov_b64 exec, -1
    s_add_u32 m0, s21, 2048
    v_mfma_f32_32x32x16_bf16 v[16:31], v[72:75], v[176:179], 0
    v_mad_u32_u16 v236, v236, s3, v246 op_sel:[1,0,0,0]
    v_mad_u32_u16 v237, v237, s3, v246 op_sel:[1,0,0,0]
    buffer_load_dwordx4 v236, s[4:7], s39 offen  lds
    buffer_load_dwordx4 v237, s[8:11], s39 offen offset:1024  lds
    ds_read_b64_tr_b16 v[176:177], v244 offset:4096
    ds_read_b64_tr_b16 v[178:179], v244 offset:5120
    ds_read_b64_tr_b16 v[184:185], v245 offset:4096
    ds_read_b64_tr_b16 v[186:187], v245 offset:5120
    v_mul_f32 v255, v0, v152
    v_fmac_f32 v255, v1, v153
    v_fmac_f32 v255, v2, v154
    v_fmac_f32 v255, v3, v155
    v_fmac_f32 v255, v4, v156
    s_waitcnt vmcnt(6) lgkmcnt(0)
    v_mfma_f32_32x32x16_bf16 v[16:31], v[80:83], v[176:179], v[16:31]
    v_fmac_f32 v255, v5, v157
    v_fmac_f32 v255, v6, v158
    v_fmac_f32 v255, v7, v159
    v_fmac_f32 v201, v8, v168
    v_fmac_f32 v201, v9, v169
    v_permlane32_swap_b32 v197, v255
    s_add_u32 m0, s21, 4096
    v_mfma_f32_32x32x16_bf16 v[56:71], v[84:87], v[176:179], v[56:71]
    v_mad_u32_u16 v238, v238, s3, v246 op_sel:[1,0,0,0]
    v_mad_u32_u16 v239, v239, s3, v246 op_sel:[1,0,0,0]
    buffer_load_dwordx4 v238, s[4:7], s40 offen  lds
    buffer_load_dwordx4 v239, s[8:11], s40 offen offset:1024  lds
    ds_read_b64_tr_b16 v[176:177], v244 offset:6144
    ds_read_b64_tr_b16 v[188:189], v245 offset:6144
    s_waitcnt lgkmcnt(0)
    v_mfma_f32_32x32x8_bf16 v[16:31], v[88:89], v[176:177], v[16:31]
    v_fmac_f32 v201, v10, v170
    v_fmac_f32 v201, v11, v171
    v_fmac_f32 v201, v12, v172
    v_fmac_f32 v201, v13, v173
    v_fmac_f32 v201, v14, v174
    v_fmac_f32 v201, v15, v175
    s_add_u32 m0, s21, 6144
    v_mfma_f32_32x32x8_bf16 v[56:71], v[92:93], v[176:177], v[56:71]
    v_mad_u32_u16 v240, v240, s3, v246 op_sel:[1,0,0,0]
    v_mad_u32_u16 v241, v241, s3, v246 op_sel:[1,0,0,0]
    buffer_load_dwordx4 v240, s[4:7], s41 offen  lds
    buffer_load_dwordx4 v241, s[8:11], s41 offen offset:1024  lds
    v_add_f32 v255, v197, v255
    s_set_gpr_idx_on s51, gpr_idx(DST)
    s_nop 0
    v_cvt_pk_bf16_f32 v206, v254, v255
    s_set_gpr_idx_off
    v_mfma_f32_32x32x16_bf16 v[0:15], v[72:75], v[180:183], 0
    v_mul_f32 v254, v16, v144
    v_fmac_f32 v254, v17, v145
    v_fmac_f32 v254, v18, v146
    v_fmac_f32 v254, v19, v147
    v_fmac_f32 v254, v20, v148
    v_fmac_f32 v254, v21, v149
    v_mfma_f32_32x32x16_bf16 v[32:47], v[76:79], v[180:183], v[32:47]
    v_fmac_f32 v254, v22, v150
    v_fmac_f32 v254, v23, v151
    v_fma_f32 v202, v24, -v160, v202
    v_fma_f32 v202, v25, -v161, v202
    v_permlane32_swap_b32 v254, v200
    v_fma_f32 v202, v26, -v162, v202
    v_mfma_f32_32x32x16_bf16 v[0:15], v[80:83], v[184:187], v[0:15]
    v_fma_f32 v202, v27, -v163, v202
    v_fma_f32 v202, v28, -v164, v202
    v_fma_f32 v202, v29, -v165, v202
    v_fma_f32 v202, v30, -v166, v202
    v_fma_f32 v202, v31, -v167, v202
    v_add_f32 v200, v254, v200
    v_mfma_f32_32x32x16_bf16 v[32:47], v[84:87], v[184:187], v[32:47]
    s_waitcnt vmcnt(8)
    ds_read_b64_tr_b16 v[176:177], v244 offset:0
    ds_read_b64_tr_b16 v[178:179], v244 offset:1024
    ds_read_b64_tr_b16 v[180:181], v245 offset:0
    ds_read_b64_tr_b16 v[182:183], v245 offset:1024
    v_mul_f32_e64 v198, v64, -v112
    v_permlane32_swap_b32 v202, v254
    v_mfma_f32_32x32x8_bf16 v[0:15], v[88:89], v[188:189], v[0:15]
    v_fma_f32 v198, v65, -v113, v198
    v_fma_f32 v198, v66, -v114, v198
    v_fma_f32 v198, v67, -v115, v198
    v_fma_f32 v198, v68, -v116, v198
    v_fma_f32 v198, v69, -v117, v198
    v_fma_f32 v198, v70, -v118, v198
    v_mfma_f32_32x32x8_bf16 v[32:47], v[92:93], v[188:189], v[32:47]
    v_add_u32 v249, s48, v249
    v_add_u32 v250, s49, v250
    v_fma_f32 v198, v71, -v119, v198
    v_add_f32 v254, v202, v254
    v_mul_f32 v196, v56, v160
    v_fmac_f32 v196, v57, v161
    v_fmac_f32 v196, v58, v162
    v_fmac_f32 v196, v59, v163
    v_fmac_f32 v196, v60, v164
    v_fmac_f32 v196, v61, v165
    v_fmac_f32 v196, v62, v166
    v_fmac_f32 v196, v63, v167
    s_nop 1
    v_permlane32_swap_b32 v198, v196
    v_add_f32 v196, v198, v196
    v_mul_f32 v255, v0, v152
    v_fmac_f32 v255, v1, v153
    v_fmac_f32 v255, v2, v154
    v_fmac_f32 v255, v3, v155
    v_fmac_f32 v255, v4, v156
    v_fmac_f32 v255, v5, v157
    v_fmac_f32 v255, v6, v158
    v_fmac_f32 v255, v7, v159
    v_fma_f32 v203, v8, -v168, v203
    v_fma_f32 v203, v9, -v169, v203
    v_permlane32_swap_b32 v255, v201
    v_fma_f32 v203, v10, -v170, v203
    v_fma_f32 v203, v11, -v171, v203
    v_fma_f32 v203, v12, -v172, v203
    v_fma_f32 v203, v13, -v173, v203
    v_fma_f32 v203, v14, -v174, v203
    v_fma_f32 v203, v15, -v175, v203
    v_add_f32 v201, v255, v201
    v_mul_f32_e64 v199, v40, -v120
    v_permlane32_swap_b32 v203, v255
    v_fma_f32 v199, v41, -v121, v199
    v_fma_f32 v199, v42, -v122, v199
    v_fma_f32 v199, v43, -v123, v199
    s_waitcnt vmcnt(6)
    ds_read_b64_tr_b16 v[72:73], v249 offset:0
    ds_read_b64_tr_b16 v[76:77], v249 offset:64
    ds_read_b64_tr_b16 v[74:75], v249 offset:256
    ds_read_b64_tr_b16 v[78:79], v249 offset:320
    s_mov_b64 exec, s[54:55]
    ds_read_u16_d16_hi v242, v250 offset:0
    s_mov_b64 exec, -1
    v_fma_f32 v199, v44, -v124, v199
    v_fma_f32 v199, v45, -v125, v199
    v_fma_f32 v199, v46, -v126, v199
    v_fma_f32 v199, v47, -v127, v199
    v_add_f32 v255, v203, v255
    v_mul_f32 v197, v32, v168
    v_fmac_f32 v197, v33, v169
    v_fmac_f32 v197, v34, v170
    v_fmac_f32 v197, v35, v171
    v_fmac_f32 v197, v36, v172
    v_fmac_f32 v197, v37, v173
    v_fmac_f32 v197, v38, v174
    v_fmac_f32 v197, v39, v175
    s_nop 1
    v_permlane32_swap_b32 v199, v197
    v_add_f32 v197, v199, v197
    s_set_gpr_idx_on s51, gpr_idx(DST)
    s_nop 0
    v_cvt_pk_bf16_f32 v207, v200, v201
    v_cvt_pk_bf16_f32 v209, v254, v255
    v_cvt_pk_bf16_f32 v208, v196, v197
    s_set_gpr_idx_off
    s_add_u32 s50, s50, 1
    s_add_u32 s51, s51, 6
    s_cmp_ge_u32 s50, 4
    s_cbranch_scc1 LAST0
    s_add_u32 s53, s53, 4
    s_xor_b32 s66, s53, s20
    s_bitcmp1_b32 s66, 2
    s_setprio 1
    s_cbranch_scc1 PRIO_6
    s_setprio 0
PRIO_6:
    s_cmp_eq_u32 s52, 4
    s_cbranch_scc1 ITEM_0_4
    s_cmp_eq_u32 s52, 5
    s_cbranch_scc1 ITEM_0_5
    s_cmp_eq_u32 s52, 3
    s_cbranch_scc1 ITEM_0_3
    s_cmp_eq_u32 s52, 6
    s_cbranch_scc1 ITEM_0_6
    s_cmp_eq_u32 s52, 8
    s_cbranch_scc1 ITEM_0_8
    s_branch ITEM_0_2
.p2align 6
ITEM_0_3:
    s_mov_b64 exec, s[54:55]
    ds_read_u16_d16_hi v243, v250 offset:128
    s_mov_b64 exec, -1
    ds_read_b64_tr_b16 v[80:81], v249 offset:512
    ds_read_b64_tr_b16 v[84:85], v249 offset:576
    s_waitcnt lgkmcnt(3)
    v_mul_f32_dpp v196, v242, v72 row_newbcast:0 row_mask:0xf bank_mask:0xf
    v_mul_f32_dpp v197, v242, v73 row_newbcast:1 row_mask:0xf bank_mask:0xf
    v_mul_f32_dpp v198, v242, v72 row_newbcast:8 row_mask:0xf bank_mask:0xf
    v_mul_f32_dpp v199, v242, v73 row_newbcast:9 row_mask:0xf bank_mask:0xf
    v_mul_f32_dpp v200, v242, v76 row_newbcast:2 row_mask:0xf bank_mask:0xf
    v_mul_f32_dpp v201, v242, v77 row_newbcast:3 row_mask:0xf bank_mask:0xf
    v_mul_f32_dpp v202, v242, v76 row_newbcast:10 row_mask:0xf bank_mask:0xf
    v_mul_f32_dpp v203, v242, v77 row_newbcast:11 row_mask:0xf bank_mask:0xf
    v_cvt_pk_bf16_f32 v72, v196, v197
    v_cvt_pk_bf16_f32 v76, v198, v199
    v_cvt_pk_bf16_f32 v73, v200, v201
    v_cvt_pk_bf16_f32 v77, v202, v203
    v_mul_f32_dpp v196, v242, v74 row_newbcast:4 row_mask:0xf bank_mask:0xf
    v_mul_f32_dpp v197, v242, v75 row_newbcast:5 row_mask:0xf bank_mask:0xf
    v_mul_f32_dpp v198, v242, v74 row_newbcast:12 row_mask:0xf bank_mask:0xf
    v_mul_f32_dpp v199, v242, v75 row_newbcast:13 row_mask:0xf bank_mask:0xf
    v_mul_f32_dpp v200, v242, v78 row_newbcast:6 row_mask:0xf bank_mask:0xf
    v_mul_f32_dpp v201, v242, v79 row_newbcast:7 row_mask:0xf bank_mask:0xf
    v_mul_f32_dpp v202, v242, v78 row_newbcast:14 row_mask:0xf bank_mask:0xf
    v_mul_f32_dpp v203, v242, v79 row_newbcast:15 row_mask:0xf bank_mask:0xf
    v_cvt_pk_bf16_f32 v74, v196, v197
    v_cvt_pk_bf16_f32 v78, v198, v199
    v_cvt_pk_bf16_f32 v75, v200, v201
    v_cvt_pk_bf16_f32 v79, v202, v203
    s_waitcnt vmcnt(4) lgkmcnt(0)
    v_mfma_f32_32x32x16_bf16 v[56:71], v[72:75], v[176:179], 0
    v_mul_f32_dpp v196, v243, v80 row_newbcast:0 row_mask:0xf bank_mask:0xf
    v_mul_f32_dpp v197, v243, v81 row_newbcast:1 row_mask:0xf bank_mask:0xf
    v_mul_f32_dpp v198, v243, v80 row_newbcast:8 row_mask:0xf bank_mask:0xf
    v_mul_f32_dpp v199, v243, v81 row_newbcast:9 row_mask:0xf bank_mask:0xf
    v_mul_f32_dpp v200, v243, v84 row_newbcast:2 row_mask:0xf bank_mask:0xf
    v_mul_f32_dpp v201, v243, v85 row_newbcast:3 row_mask:0xf bank_mask:0xf
    s_add_u32 m0, s21, 0
    v_mfma_f32_32x32x16_bf16 v[16:31], v[76:79], v[176:179], 0
    buffer_load_dwordx4 v234, s[4:7], s36 offen  lds
    buffer_load_dwordx4 v235, s[8:11], s36 offen offset:1024  lds
    ds_read_b64_tr_b16 v[176:177], v244 offset:2048
    ds_read_b64_tr_b16 v[184:185], v245 offset:2048
    v_mul_f32_dpp v202, v243, v84 row_newbcast:10 row_mask:0xf bank_mask:0xf
    v_mul_f32_dpp v203, v243, v85 row_newbcast:11 row_mask:0xf bank_mask:0xf
    v_cvt_pk_bf16_f32 v80, v196, v197
    v_cvt_pk_bf16_f32 v84, v198, v199
    v_cvt_pk_bf16_f32 v81, v200, v201
    v_cvt_pk_bf16_f32 v85, v202, v203
    s_waitcnt lgkmcnt(0)
    v_mfma_f32_32x32x8_bf16 v[56:71], v[80:81], v[176:177], v[56:71]
    s_add_u32 m0, s21, 2048
    v_mfma_f32_32x32x8_bf16 v[16:31], v[84:85], v[176:177], v[16:31]
    buffer_load_dwordx4 v236, s[4:7], s36 offen  lds
    s_mov_b32 m0, s50
    s_nop 0
    s_movrels_b32 s71, s23
    s_bfe_u32 s46, s71, 0x30012
    s_mov_b32 m0, s46
    s_and_b32 s66, s71, 0x3ffff
    s_movrels_b32 s68, s57
    s_movrels_b32 s69, s61
    s_sub_u32 s48, s66, s47
    s_mov_b32 s47, s66
    s_lshr_b32 s52, s71, 28
    s_lshl_b32 s67, s46, 9
    s_add_u32 s66, s66, s67
    s_sub_u32 s49, s66, s42
    s_mov_b32 s42, s66
    s_bfe_u32 s66, s68, 655360
    s_add_u32 s43, s42, s66
    s_bfe_u32 s39, s69, 655360
    s_bfe_u32 s66, s68, 655370
    s_add_u32 s44, s42, s66
    s_bfe_u32 s40, s69, 655370
    s_bfe_u32 s66, s68, 655380
    s_add_u32 s45, s42, s66
    s_bfe_u32 s41, s69, 655380
    s_and_b32 s66, s46, s33
    s_cselect_b32 s72, -1, 1
    s_cselect_b32 s76, s47, 163712
    s_cmp_ge_u32 s66, 2
    s_cselect_b32 s73, -1, 0
    s_add_u32 s77, s47, 1024
    s_cmp_ge_u32 s66, 4
    s_cselect_b32 s75, -1, 0
    s_cmp_ge_u32 s66, 3
    s_cselect_b32 s74, -1, 1
    s_cselect_b32 s77, s77, 163712
    v_add_u32 v252, s44, v247
    ds_read2_b32 v[238:239], v252 offset0:0 offset1:16
    v_add_u32 v252, s45, v247
    ds_read2_b32 v[240:241], v252 offset0:0 offset1:16
    v_mfma_f32_32x32x16_bf16 v[32:47], v[72:75], v[180:183], 0
    v_mul_f32 v196, v56, v96
    v_fmac_f32 v196, v57, v97
    v_fmac_f32 v196, v58, v98
    v_fmac_f32 v196, v59, v99
    v_fmac_f32 v196, v60, v100
    v_fmac_f32 v196, v61, v101
    v_mfma_f32_32x32x16_bf16 v[0:15], v[76:79], v[180:183], 0
    s_waitcnt vmcnt(5)
    ds_read_b64_tr_b16 v[176:177], v244 offset:4096
    ds_read_b64_tr_b16 v[178:179], v244 offset:5120
    ds_read_b64_tr_b16 v[180:181], v245 offset:4096
    ds_read_b64_tr_b16 v[182:183], v245 offset:5120
    v_fmac_f32 v196, v62, v102
    v_fmac_f32 v196, v63, v103
    v_mfma_f32_32x32x8_bf16 v[32:47], v[80:81], v[184:185], v[32:47]
    v_mul_f32 v198, v64, v128
    v_fmac_f32 v198, v65, v129
    v_fmac_f32 v198, v66, v130
    v_fmac_f32 v198, v67, v131
    v_fmac_f32 v198, v68, v132
    v_fmac_f32 v198, v69, v133
    v_mfma_f32_32x32x8_bf16 v[0:15], v[84:85], v[184:185], v[0:15]
    v_fmac_f32 v198, v70, v134
    v_fmac_f32 v198, v71, v135
    v_mul_f32 v200, v16, v128
    v_fmac_f32 v200, v17, v129
    v_permlane32_swap_b32 v196, v198
    v_fmac_f32 v200, v18, v130
    v_fmac_f32 v200, v19, v131
    v_fmac_f32 v200, v20, v132
    v_fmac_f32 v200, v21, v133
    v_fmac_f32 v200, v22, v134
    v_fmac_f32 v200, v23, v135
    v_add_f32 v198, v196, v198
    v_mul_f32_e64 v202, v24, -v128
    v_fma_f32 v202, v25, -v129, v202
    v_fma_f32 v202, v26, -v130, v202
    v_fma_f32 v202, v27, -v131, v202
    v_fma_f32 v202, v28, -v132, v202
    v_fma_f32 v202, v29, -v133, v202
    v_fma_f32 v202, v30, -v134, v202
    v_fma_f32 v202, v31, -v135, v202
    s_nop 1
    v_permlane32_swap_b32 v200, v202
    v_add_f32 v202, v200, v202
    s_waitcnt vmcnt(3) lgkmcnt(0)
    v_mfma_f32_32x32x16_bf16 v[56:71], v[72:75], v[176:179], 0
    v_mul_f32 v197, v32, v104
    v_fmac_f32 v197, v33, v105
    v_fmac_f32 v197, v34, v106
    v_fmac_f32 v197, v35, v107
    v_fmac_f32 v197, v36, v108
    v_fmac_f32 v197, v37, v109
    s_add_u32 m0, s21, 4096
    v_mfma_f32_32x32x16_bf16 v[16:31], v[76:79], v[176:179], 0
    buffer_load_dwordx4 v234, s[4:7], s37 offen  lds
    buffer_load_dwordx4 v235, s[8:11], s37 offen offset:1024  lds
    ds_read_b64_tr_b16 v[176:177], v244 offset:6144
    ds_read_b64_tr_b16 v[184:185], v245 offset:6144
    v_add_u32 v252, s42, v247
    ds_read2_b32 v[234:235], v252 offset0:0 offset1:16
    v_fmac_f32 v197, v38, v110
    v_fmac_f32 v197, v39, v111
    v_mul_f32 v199, v40, v136
    v_fmac_f32 v199, v41, v137
    v_fmac_f32 v199, v42, v138
    v_fmac_f32 v199, v43, v139
    v_fmac_f32 v199, v44, v140
    v_fmac_f32 v199, v45, v141
    v_fmac_f32 v199, v46, v142
    v_fmac_f32 v199, v47, v143
    v_mul_f32 v201, v0, v136
    v_fmac_f32 v201, v1, v137
    v_permlane32_swap_b32 v197, v199
    v_fmac_f32 v201, v2, v138
    v_fmac_f32 v201, v3, v139
    v_fmac_f32 v201, v4, v140
    v_fmac_f32 v201, v5, v141
    v_fmac_f32 v201, v6, v142
    v_fmac_f32 v201, v7, v143
    v_add_f32 v199, v197, v199
    v_mul_f32_e64 v203, v8, -v136
    v_fma_f32 v203, v9, -v137, v203
    v_fma_f32 v203, v10, -v138, v203
    s_waitcnt lgkmcnt(1)
    v_mfma_f32_32x32x8_bf16 v[56:71], v[80:81], v[176:177], v[56:71]
    v_fma_f32 v203, v11, -v139, v203
    v_fma_f32 v203, v12, -v140, v203
    v_fma_f32 v203, v13, -v141, v203
    v_fma_f32 v203, v14, -v142, v203
    v_fma_f32 v203, v15, -v143, v203
    s_nop 1
    v_permlane32_swap_b32 v201, v203
    s_add_u32 m0, s21, 6144
    v_mfma_f32_32x32x8_bf16 v[16:31], v[84:85], v[176:177], v[16:31]
    buffer_load_dwordx4 v236, s[4:7], s37 offen  lds
    v_add_u32 v252, s43, v247
    ds_read2_b32 v[236:237], v252 offset0:0 offset1:16
    v_add_f32 v203, v201, v203
    s_set_gpr_idx_on s51, gpr_idx(DST)
    s_nop 0
    v_cvt_pk_bf16_f32 v204, v198, v199
    v_cvt_pk_bf16_f32 v205, v202, v203
    s_set_gpr_idx_off
    v_mfma_f32_32x32x16_bf16 v[32:47], v[72:75], v[180:183], 0
    v_mul_f32 v196, v56, v144
    v_fmac_f32 v196, v57, v145
    v_fmac_f32 v196, v58, v146
    v_fmac_f32 v196, v59, v147
    v_fmac_f32 v196, v60, v148
    v_fmac_f32 v196, v61, v149
    v_mfma_f32_32x32x16_bf16 v[0:15], v[76:79], v[180:183], 0
    s_waitcnt vmcnt(4)
    ds_read_b64_tr_b16 v[176:177], v244 offset:0
    ds_read_b64_tr_b16 v[178:179], v244 offset:1024
    ds_read_b64_tr_b16 v[180:181], v245 offset:0
    ds_read_b64_tr_b16 v[182:183], v245 offset:1024
    v_fmac_f32 v196, v62, v150
    v_fmac_f32 v196, v63, v151
    v_mfma_f32_32x32x8_bf16 v[32:47], v[80:81], v[184:185], v[32:47]
    v_mul_f32_e64 v200, v16, -v160
    v_fma_f32 v200, v17, -v161, v200
    v_fma_f32 v200, v18, -v162, v200
    v_fma_f32 v200, v19, -v163, v200
    v_fma_f32 v200, v20, -v164, v200
    v_fma_f32 v200, v21, -v165, v200
    v_mfma_f32_32x32x8_bf16 v[0:15], v[84:85], v[184:185], v[0:15]
    v_fma_f32 v200, v22, -v166, v200
    v_fma_f32 v200, v23, -v167, v200
    v_mul_f32_e64 v202, v24, -v160
    v_fma_f32 v202, v25, -v161, v202
    v_fma_f32 v202, v26, -v162, v202
    v_fma_f32 v202, v27, -v163, v202
    v_fma_f32 v202, v28, -v164, v202
    v_fma_f32 v202, v29, -v165, v202
    v_fma_f32 v202, v30, -v166, v202
    v_fma_f32 v202, v31, -v167, v202
    s_waitcnt vmcnt(3) lgkmcnt(0)
    v_mfma_f32_32x32x16_bf16 v[16:31], v[72:75], v[176:179], 0
    v_mul_f32 v197, v32, v152
    v_fmac_f32 v197, v33, v153
    v_fmac_f32 v197, v34, v154
    v_fmac_f32 v197, v35, v155
    v_fmac_f32 v197, v36, v156
    v_fmac_f32 v197, v37, v157
    s_add_u32 m0, s21, 0
    v_mfma_f32_32x32x16_bf16 v[48:63], v[76:79], v[176:179], 0
    v_mad_u32_u16 v234, v234, s3, v246 op_sel:[1,0,0,0]
    v_mad_u32_u16 v235, v235, s3, v246 op_sel:[1,0,0,0]
    buffer_load_dwordx4 v234, s[4:7], s38 offen  lds
    buffer_load_dwordx4 v235, s[8:11], s38 offen offset:1024  lds
    ds_read_b64_tr_b16 v[176:177], v244 offset:2048
    ds_read_b64_tr_b16 v[184:185], v245 offset:2048
    v_fmac_f32 v197, v38, v158
    v_fmac_f32 v197, v39, v159
    v_mul_f32_e64 v201, v0, -v168
    v_fma_f32 v201, v1, -v169, v201
    v_fma_f32 v201, v2, -v170, v201
    v_fma_f32 v201, v3, -v171, v201
    v_fma_f32 v201, v4, -v172, v201
    v_fma_f32 v201, v5, -v173, v201
    v_fma_f32 v201, v6, -v174, v201
    v_fma_f32 v201, v7, -v175, v201
    s_waitcnt lgkmcnt(0)
    v_mfma_f32_32x32x8_bf16 v[16:31], v[80:81], v[176:177], v[16:31]
    v_mul_f32_e64 v203, v8, -v168
    v_fma_f32 v203, v9, -v169, v203
    v_fma_f32 v203, v10, -v170, v203
    v_fma_f32 v203, v11, -v171, v203
    v_fma_f32 v203, v12, -v172, v203
    v_fma_f32 v203, v13, -v173, v203
    s_add_u32 m0, s21, 2048
    v_mfma_f32_32x32x8_bf16 v[48:63], v[84:85], v[176:177], v[48:63]
    v_mad_u32_u16 v236, v236, s3, v246 op_sel:[1,0,0,0]
    v_mad_u32_u16 v237, v237, s3, v246 op_sel:[1,0,0,0]
    buffer_load_dwordx4 v236, s[4:7], s39 offen  lds
    buffer_load_dwordx4 v237, s[8:11], s39 offen offset:1024  lds
    v_fma_f32 v203, v14, -v174, v203
    v_fma_f32 v203, v15, -v175, v203
    v_mfma_f32_32x32x16_bf16 v[0:15], v[72:75], v[180:183], 0
    v_fmac_f32 v200, v24, v160
    v_fmac_f32 v200, v25, v161
    v_fmac_f32 v200, v26, v162
    v_fmac_f32 v200, v27, v163
    v_fmac_f32 v200, v28, v164
    v_fmac_f32 v200, v29, v165
    v_fmac_f32 v200, v30, v166
    v_fmac_f32 v200, v31, v167
    v_mfma_f32_32x32x16_bf16 v[24:39], v[76:79], v[180:183], 0
    v_add_u32 v253, s47, v248
    ds_read_b32 v192, v253
    ds_read_b32 v193, v253 offset:256
    s_waitcnt vmcnt(5)
    ds_read_b64_tr_b16 v[176:177], v244 offset:4096
    ds_read_b64_tr_b16 v[178:179], v244 offset:5120
    ds_read_b64_tr_b16 v[180:181], v245 offset:4096
    ds_read_b64_tr_b16 v[182:183], v245 offset:5120
    v_mfma_f32_32x32x8_bf16 v[24:39], v[84:85], v[184:185], v[24:39]
    v_mul_f32 v254, v16, v144
    v_fmac_f32 v254, v17, v145
    v_fmac_f32 v254, v18, v146
    v_fmac_f32 v254, v19, v147
    v_fmac_f32 v254, v20, v148
    v_fmac_f32 v254, v21, v149
    v_mfma_f32_32x32x8_bf16 v[0:15], v[80:81], v[184:185], v[0:15]
    v_fmac_f32 v254, v22, v150
    v_fmac_f32 v254, v23, v151
    v_sub_f32_e64 v64, -v48, v64
    v_sub_f32_e64 v65, -v49, v65
    v_permlane32_swap_b32 v196, v254
    v_sub_f32_e64 v66, -v50, v66
    v_sub_f32_e64 v67, -v51, v67
    v_sub_f32_e64 v68, -v52, v68
    v_sub_f32_e64 v69, -v53, v69
    v_sub_f32_e64 v70, -v54, v70
    v_sub_f32_e64 v71, -v55, v71
    v_add_f32 v254, v196, v254
    s_waitcnt vmcnt(4) lgkmcnt(0)
    v_mfma_f32_32x32x16_bf16 v[56:71], v[76:79], v[176:179], v[56:71]
    v_sub_f32_e64 v40, -v24, v40
    v_sub_f32_e64 v41, -v25, v41
    v_sub_f32_e64 v42, -v26, v42
    v_sub_f32_e64 v43, -v27, v43
    v_sub_f32_e64 v44, -v28, v44
    v_sub_f32_e64 v45, -v29, v45
    v_sub_f32_e64 v46, -v30, v46
    v_sub_f32_e64 v47, -v31, v47
    s_mov_b32 m0, s76
    s_mov_b64 exec, s[72:73]
    buffer_load_dwordx4 v192, s[12:15], 0 offen  lds
    s_mov_b32 m0, s77
    s_mov_b64 exec, s[74:75]
    buffer_load_dwordx4 v193, s[12:15], 0 offen  lds
    s_mov_b64 exec, -1
    s_add_u32 m0, s21, 4096
    v_mfma_f32_32x32x16_bf16 v[16:31], v[72:75], v[176:179], 0
    v_mad_u32_u16 v238, v238, s3, v246 op_sel:[1,0,0,0]
    v_mad_u32_u16 v239, v239, s3, v246 op_sel:[1,0,0,0]
    buffer_load_dwordx4 v238, s[4:7], s40 offen  lds
    buffer_load_dwordx4 v239, s[8:11], s40 offen offset:1024  lds
    ds_read_b64_tr_b16 v[176:177], v244 offset:6144
    ds_read_b64_tr_b16 v[184:185], v245 offset:6144
    v_mul_f32 v255, v0, v152
    v_fmac_f32 v255, v1, v153
    v_fmac_f32 v255, v2, v154
    v_fmac_f32 v255, v3, v155
    v_fmac_f32 v255, v4, v156
    v_fmac_f32 v255, v5, v157
    v_fmac_f32 v255, v6, v158
    v_fmac_f32 v255, v7, v159
    v_fmac_f32 v201, v8, v168
    v_fmac_f32 v201, v9, v169
    v_permlane32_swap_b32 v197, v255
    s_waitcnt lgkmcnt(0)
    v_mfma_f32_32x32x8_bf16 v[16:31], v[80:81], v[176:177], v[16:31]
    v_fmac_f32 v201, v10, v170
    v_fmac_f32 v201, v11, v171
    v_fmac_f32 v201, v12, v172
    v_fmac_f32 v201, v13, v173
    v_fmac_f32 v201, v14, v174
    v_fmac_f32 v201, v15, v175
    s_add_u32 m0, s21, 6144
    v_mfma_f32_32x32x8_bf16 v[56:71], v[84:85], v[176:177], v[56:71]
    v_mad_u32_u16 v240, v240, s3, v246 op_sel:[1,0,0,0]
    v_mad_u32_u16 v241, v241, s3, v246 op_sel:[1,0,0,0]
    buffer_load_dwordx4 v240, s[4:7], s41 offen  lds
    buffer_load_dwordx4 v241, s[8:11], s41 offen offset:1024  lds
    v_add_f32 v255, v197, v255
    s_set_gpr_idx_on s51, gpr_idx(DST)
    s_nop 0
    v_cvt_pk_bf16_f32 v206, v254, v255
    s_set_gpr_idx_off
    v_mfma_f32_32x32x16_bf16 v[0:15], v[72:75], v[180:183], 0
    v_mul_f32 v254, v16, v144
    v_fmac_f32 v254, v17, v145
    v_fmac_f32 v254, v18, v146
    v_fmac_f32 v254, v19, v147
    v_fmac_f32 v254, v20, v148
    v_fmac_f32 v254, v21, v149
    v_mfma_f32_32x32x16_bf16 v[32:47], v[76:79], v[180:183], v[32:47]
    s_waitcnt vmcnt(8)
    ds_read_b64_tr_b16 v[176:177], v244 offset:0
    ds_read_b64_tr_b16 v[178:179], v244 offset:1024
    ds_read_b64_tr_b16 v[180:181], v245 offset:0
    ds_read_b64_tr_b16 v[182:183], v245 offset:1024
    v_fmac_f32 v254, v22, v150
    v_fmac_f32 v254, v23, v151
    v_mfma_f32_32x32x8_bf16 v[0:15], v[80:81], v[184:185], v[0:15]
    v_fma_f32 v202, v24, -v160, v202
    v_fma_f32 v202, v25, -v161, v202
    v_permlane32_swap_b32 v254, v200
    v_fma_f32 v202, v26, -v162, v202
    v_fma_f32 v202, v27, -v163, v202
    v_fma_f32 v202, v28, -v164, v202
    v_mfma_f32_32x32x8_bf16 v[32:47], v[84:85], v[184:185], v[32:47]
    v_add_u32 v249, s48, v249
    v_add_u32 v250, s49, v250
    v_fma_f32 v202, v29, -v165, v202
    v_fma_f32 v202, v30, -v166, v202
    v_fma_f32 v202, v31, -v167, v202
    v_add_f32 v200, v254, v200
    v_mul_f32_e64 v198, v64, -v112
    v_permlane32_swap_b32 v202, v254
    v_fma_f32 v198, v65, -v113, v198
    v_fma_f32 v198, v66, -v114, v198
    v_fma_f32 v198, v67, -v115, v198
    v_fma_f32 v198, v68, -v116, v198
    v_fma_f32 v198, v69, -v117, v198
    v_fma_f32 v198, v70, -v118, v198
    v_fma_f32 v198, v71, -v119, v198
    v_add_f32 v254, v202, v254
    v_mul_f32 v196, v56, v160
    v_fmac_f32 v196, v57, v161
    v_fmac_f32 v196, v58, v162
    v_fmac_f32 v196, v59, v163
    v_fmac_f32 v196, v60, v164
    v_fmac_f32 v196, v61, v165
    v_fmac_f32 v196, v62, v166
    v_fmac_f32 v196, v63, v167
    s_nop 1
    v_permlane32_swap_b32 v198, v196
    v_add_f32 v196, v198, v196
    v_mul_f32 v255, v0, v152
    v_fmac_f32 v255, v1, v153
    v_fmac_f32 v255, v2, v154
    v_fmac_f32 v255, v3, v155
    v_fmac_f32 v255, v4, v156
    v_fmac_f32 v255, v5, v157
    v_fmac_f32 v255, v6, v158
    v_fmac_f32 v255, v7, v159
    v_fma_f32 v203, v8, -v168, v203
    v_fma_f32 v203, v9, -v169, v203
    v_permlane32_swap_b32 v255, v201
    v_fma_f32 v203, v10, -v170, v203
    v_fma_f32 v203, v11, -v171, v203
    v_fma_f32 v203, v12, -v172, v203
    v_fma_f32 v203, v13, -v173, v203
    v_fma_f32 v203, v14, -v174, v203
    v_fma_f32 v203, v15, -v175, v203
    v_add_f32 v201, v255, v201
    v_mul_f32_e64 v199, v40, -v120
    v_permlane32_swap_b32 v203, v255
    v_fma_f32 v199, v41, -v121, v199
    v_fma_f32 v199, v42, -v122, v199
    v_fma_f32 v199, v43, -v123, v199
    s_waitcnt vmcnt(4)
    ds_read_b64_tr_b16 v[72:73], v249 offset:0
    ds_read_b64_tr_b16 v[76:77], v249 offset:64
    ds_read_b64_tr_b16 v[74:75], v249 offset:256
    ds_read_b64_tr_b16 v[78:79], v249 offset:320
    s_mov_b64 exec, s[54:55]
    ds_read_u16_d16_hi v242, v250 offset:0
    s_mov_b64 exec, -1
    v_fma_f32 v199, v44, -v124, v199
    v_fma_f32 v199, v45, -v125, v199
    v_fma_f32 v199, v46, -v126, v199
    v_fma_f32 v199, v47, -v127, v199
    v_add_f32 v255, v203, v255
    v_mul_f32 v197, v32, v168
    v_fmac_f32 v197, v33, v169
    v_fmac_f32 v197, v34, v170
    v_fmac_f32 v197, v35, v171
    v_fmac_f32 v197, v36, v172
    v_fmac_f32 v197, v37, v173
    v_fmac_f32 v197, v38, v174
    v_fmac_f32 v197, v39, v175
    s_nop 1
    v_permlane32_swap_b32 v199, v197
    v_add_f32 v197, v199, v197
    s_set_gpr_idx_on s51, gpr_idx(DST)
    s_nop 0
    v_cvt_pk_bf16_f32 v207, v200, v201
    v_cvt_pk_bf16_f32 v209, v254, v255
    v_cvt_pk_bf16_f32 v208, v196, v197
    s_set_gpr_idx_off
    s_add_u32 s50, s50, 1
    s_add_u32 s51, s51, 6
    s_cmp_ge_u32 s50, 4
    s_cbranch_scc1 LAST0
    s_add_u32 s53, s53, 4
    s_xor_b32 s66, s53, s20
    s_bitcmp1_b32 s66, 2
    s_setprio 1
    s_cbranch_scc1 PRIO_7
    s_setprio 0
PRIO_7:
    s_cmp_eq_u32 s52, 4
    s_cbranch_scc1 ITEM_0_4
    s_cmp_eq_u32 s52, 5
    s_cbranch_scc1 ITEM_0_5
    s_cmp_eq_u32 s52, 3
    s_cbranch_scc1 ITEM_0_3
    s_cmp_eq_u32 s52, 6
    s_cbranch_scc1 ITEM_0_6
    s_cmp_eq_u32 s52, 8
    s_cbranch_scc1 ITEM_0_8
    s_branch ITEM_0_2
.p2align 6
ITEM_0_6:
    s_mov_b64 exec, s[54:55]
    ds_read_u16_d16_hi v243, v250 offset:128
    s_mov_b64 exec, -1
    ds_read_b64_tr_b16 v[80:81], v249 offset:512
    ds_read_b64_tr_b16 v[84:85], v249 offset:576
    ds_read_b64_tr_b16 v[82:83], v249 offset:768
    ds_read_b64_tr_b16 v[86:87], v249 offset:832
    ds_read_b64_tr_b16 v[88:89], v249 offset:1024
    ds_read_b64_tr_b16 v[92:93], v249 offset:1088
    ds_read_b64_tr_b16 v[90:91], v249 offset:1280
    ds_read_b64_tr_b16 v[94:95], v249 offset:1344
    s_waitcnt lgkmcnt(9)
    v_mul_f32_dpp v196, v242, v72 row_newbcast:0 row_mask:0xf bank_mask:0xf
    v_mul_f32_dpp v197, v242, v73 row_newbcast:1 row_mask:0xf bank_mask:0xf
    v_mul_f32_dpp v198, v242, v72 row_newbcast:8 row_mask:0xf bank_mask:0xf
    v_mul_f32_dpp v199, v242, v73 row_newbcast:9 row_mask:0xf bank_mask:0xf
    v_mul_f32_dpp v200, v242, v76 row_newbcast:2 row_mask:0xf bank_mask:0xf
    v_mul_f32_dpp v201, v242, v77 row_newbcast:3 row_mask:0xf bank_mask:0xf
    v_mul_f32_dpp v202, v242, v76 row_newbcast:10 row_mask:0xf bank_mask:0xf
    v_mul_f32_dpp v203, v242, v77 row_newbcast:11 row_mask:0xf bank_mask:0xf
    v_cvt_pk_bf16_f32 v72, v196, v197
    v_cvt_pk_bf16_f32 v76, v198, v199
    v_cvt_pk_bf16_f32 v73, v200, v201
    v_cvt_pk_bf16_f32 v77, v202, v203
    v_mul_f32_dpp v196, v242, v74 row_newbcast:4 row_mask:0xf bank_mask:0xf
    v_mul_f32_dpp v197, v242, v75 row_newbcast:5 row_mask:0xf bank_mask:0xf
    v_mul_f32_dpp v198, v242, v74 row_newbcast:12 row_mask:0xf bank_mask:0xf
    v_mul_f32_dpp v199, v242, v75 row_newbcast:13 row_mask:0xf bank_mask:0xf
    v_mul_f32_dpp v200, v242, v78 row_newbcast:6 row_mask:0xf bank_mask:0xf
    v_mul_f32_dpp v201, v242, v79 row_newbcast:7 row_mask:0xf bank_mask:0xf
    v_mul_f32_dpp v202, v242, v78 row_newbcast:14 row_mask:0xf bank_mask:0xf
    v_mul_f32_dpp v203, v242, v79 row_newbcast:15 row_mask:0xf bank_mask:0xf
    v_cvt_pk_bf16_f32 v74, v196, v197
    v_cvt_pk_bf16_f32 v78, v198, v199
    v_cvt_pk_bf16_f32 v75, v200, v201
    v_cvt_pk_bf16_f32 v79, v202, v203
    s_mov_b64 exec, s[54:55]
    ds_read_u16_d16_hi v242, v250 offset:256
    s_mov_b64 exec, -1
    s_waitcnt vmcnt(4) lgkmcnt(5)
    v_mfma_f32_32x32x16_bf16 v[56:71], v[72:75], v[176:179], 0
    v_mul_f32_dpp v196, v243, v80 row_newbcast:0 row_mask:0xf bank_mask:0xf
    v_mul_f32_dpp v197, v243, v81 row_newbcast:1 row_mask:0xf bank_mask:0xf
    v_mul_f32_dpp v198, v243, v80 row_newbcast:8 row_mask:0xf bank_mask:0xf
    v_mul_f32_dpp v199, v243, v81 row_newbcast:9 row_mask:0xf bank_mask:0xf
    v_mul_f32_dpp v200, v243, v84 row_newbcast:2 row_mask:0xf bank_mask:0xf
    v_mul_f32_dpp v201, v243, v85 row_newbcast:3 row_mask:0xf bank_mask:0xf
    s_add_u32 m0, s21, 0
    v_mfma_f32_32x32x16_bf16 v[16:31], v[76:79], v[176:179], 0
    buffer_load_dwordx4 v236, s[4:7], s35 offen  lds
    buffer_load_dwordx4 v237, s[8:11], s35 offen offset:1024  lds
    ds_read_b64_tr_b16 v[176:177], v244 offset:2048
    ds_read_b64_tr_b16 v[178:179], v244 offset:3072
    ds_read_b64_tr_b16 v[184:185], v245 offset:2048
    ds_read_b64_tr_b16 v[186:187], v245 offset:3072
    v_mul_f32_dpp v202, v243, v84 row_newbcast:10 row_mask:0xf bank_mask:0xf
    v_mul_f32_dpp v203, v243, v85 row_newbcast:11 row_mask:0xf bank_mask:0xf
    v_cvt_pk_bf16_f32 v80, v196, v197
    v_cvt_pk_bf16_f32 v84, v198, v199
    v_cvt_pk_bf16_f32 v81, v200, v201
    v_cvt_pk_bf16_f32 v85, v202, v203
    v_mul_f32_dpp v196, v243, v82 row_newbcast:4 row_mask:0xf bank_mask:0xf
    v_mul_f32_dpp v197, v243, v83 row_newbcast:5 row_mask:0xf bank_mask:0xf
    v_mul_f32_dpp v198, v243, v82 row_newbcast:12 row_mask:0xf bank_mask:0xf
    v_mul_f32_dpp v199, v243, v83 row_newbcast:13 row_mask:0xf bank_mask:0xf
    v_mul_f32_dpp v200, v243, v86 row_newbcast:6 row_mask:0xf bank_mask:0xf
    v_mul_f32_dpp v201, v243, v87 row_newbcast:7 row_mask:0xf bank_mask:0xf
    v_mul_f32_dpp v202, v243, v86 row_newbcast:14 row_mask:0xf bank_mask:0xf
    v_mul_f32_dpp v203, v243, v87 row_newbcast:15 row_mask:0xf bank_mask:0xf
    v_cvt_pk_bf16_f32 v82, v196, v197
    v_cvt_pk_bf16_f32 v86, v198, v199
    v_cvt_pk_bf16_f32 v83, v200, v201
    v_cvt_pk_bf16_f32 v87, v202, v203
    s_waitcnt vmcnt(4) lgkmcnt(0)
    v_mfma_f32_32x32x16_bf16 v[56:71], v[80:83], v[176:179], v[56:71]
    v_mul_f32_dpp v196, v242, v88 row_newbcast:0 row_mask:0xf bank_mask:0xf
    v_mul_f32_dpp v197, v242, v89 row_newbcast:1 row_mask:0xf bank_mask:0xf
    v_mul_f32_dpp v198, v242, v88 row_newbcast:8 row_mask:0xf bank_mask:0xf
    v_mul_f32_dpp v199, v242, v89 row_newbcast:9 row_mask:0xf bank_mask:0xf
    v_mul_f32_dpp v200, v242, v92 row_newbcast:2 row_mask:0xf bank_mask:0xf
    v_mul_f32_dpp v201, v242, v93 row_newbcast:3 row_mask:0xf bank_mask:0xf
    s_add_u32 m0, s21, 2048
    v_mfma_f32_32x32x16_bf16 v[16:31], v[84:87], v[176:179], v[16:31]
    buffer_load_dwordx4 v238, s[4:7], s35 offen  lds
    buffer_load_dwordx4 v239, s[8:11], s35 offen offset:1024  lds
    ds_read_b64_tr_b16 v[176:177], v244 offset:4096
    ds_read_b64_tr_b16 v[178:179], v244 offset:5120
    ds_read_b64_tr_b16 v[188:189], v245 offset:4096
    ds_read_b64_tr_b16 v[190:191], v245 offset:5120
    v_mul_f32_dpp v202, v242, v92 row_newbcast:10 row_mask:0xf bank_mask:0xf
    v_mul_f32_dpp v203, v242, v93 row_newbcast:11 row_mask:0xf bank_mask:0xf
    v_cvt_pk_bf16_f32 v88, v196, v197
    v_cvt_pk_bf16_f32 v92, v198, v199
    v_cvt_pk_bf16_f32 v89, v200, v201
    v_cvt_pk_bf16_f32 v93, v202, v203
    v_mul_f32_dpp v196, v242, v90 row_newbcast:4 row_mask:0xf bank_mask:0xf
    v_mul_f32_dpp v197, v242, v91 row_newbcast:5 row_mask:0xf bank_mask:0xf
    v_mul_f32_dpp v198, v242, v90 row_newbcast:12 row_mask:0xf bank_mask:0xf
    v_mul_f32_dpp v199, v242, v91 row_newbcast:13 row_mask:0xf bank_mask:0xf
    v_mul_f32_dpp v200, v242, v94 row_newbcast:6 row_mask:0xf bank_mask:0xf
    v_mul_f32_dpp v201, v242, v95 row_newbcast:7 row_mask:0xf bank_mask:0xf
    v_mul_f32_dpp v202, v242, v94 row_newbcast:14 row_mask:0xf bank_mask:0xf
    v_mul_f32_dpp v203, v242, v95 row_newbcast:15 row_mask:0xf bank_mask:0xf
    v_cvt_pk_bf16_f32 v90, v196, v197
    v_cvt_pk_bf16_f32 v94, v198, v199
    v_cvt_pk_bf16_f32 v91, v200, v201
    v_cvt_pk_bf16_f32 v95, v202, v203
    s_waitcnt lgkmcnt(0)
    v_mfma_f32_32x32x16_bf16 v[56:71], v[88:91], v[176:179], v[56:71]
    s_add_u32 m0, s21, 4096
    v_mfma_f32_32x32x16_bf16 v[16:31], v[92:95], v[176:179], v[16:31]
    buffer_load_dwordx4 v234, s[4:7], s36 offen  lds
    buffer_load_dwordx4 v235, s[8:11], s36 offen offset:1024  lds
    s_mov_b32 m0, s50
    s_nop 0
    s_movrels_b32 s71, s23
    s_bfe_u32 s46, s71, 0x30012
    s_mov_b32 m0, s46
    s_and_b32 s66, s71, 0x3ffff
    s_movrels_b32 s68, s57
    s_movrels_b32 s69, s61
    s_sub_u32 s48, s66, s47
    s_mov_b32 s47, s66
    s_lshr_b32 s52, s71, 28
    s_lshl_b32 s67, s46, 9
    s_add_u32 s66, s66, s67
    s_sub_u32 s49, s66, s42
    s_mov_b32 s42, s66
    s_bfe_u32 s66, s68, 655360
    s_add_u32 s43, s42, s66
    s_bfe_u32 s39, s69, 655360
    s_bfe_u32 s66, s68, 655370
    s_add_u32 s44, s42, s66
    s_bfe_u32 s40, s69, 655370
    s_bfe_u32 s66, s68, 655380
    s_add_u32 s45, s42, s66
    s_bfe_u32 s41, s69, 655380
    s_and_b32 s66, s46, s33
    s_cselect_b32 s72, -1, 1
    s_cselect_b32 s76, s47, 163712
    s_cmp_ge_u32 s66, 2
    s_cselect_b32 s73, -1, 0
    s_add_u32 s77, s47, 1024
    s_cmp_ge_u32 s66, 4
    s_cselect_b32 s75, -1, 0
    s_cmp_ge_u32 s66, 3
    s_cselect_b32 s74, -1, 1
    s_cselect_b32 s77, s77, 163712
    v_add_u32 v252, s45, v247
    ds_read2_b32 v[240:241], v252 offset0:0 offset1:16
    v_mfma_f32_32x32x16_bf16 v[32:47], v[72:75], v[180:183], 0
    v_mul_f32 v196, v56, v96
    v_fmac_f32 v196, v57, v97
    v_fmac_f32 v196, v58, v98
    v_fmac_f32 v196, v59, v99
    v_fmac_f32 v196, v60, v100
    v_fmac_f32 v196, v61, v101
    v_mfma_f32_32x32x16_bf16 v[0:15], v[76:79], v[180:183], 0
    v_fmac_f32 v196, v62, v102
    v_fmac_f32 v196, v63, v103
    v_mul_f32 v198, v64, v128
    v_fmac_f32 v198, v65, v129
    v_fmac_f32 v198, v66, v130
    v_fmac_f32 v198, v67, v131
    v_mfma_f32_32x32x16_bf16 v[32:47], v[80:83], v[184:187], v[32:47]
    v_fmac_f32 v198, v68, v132
    v_fmac_f32 v198, v69, v133
    v_fmac_f32 v198, v70, v134
    v_fmac_f32 v198, v71, v135
    v_mul_f32 v200, v16, v128
    v_fmac_f32 v200, v17, v129
    v_mfma_f32_32x32x16_bf16 v[0:15], v[84:87], v[184:187], v[0:15]
    s_waitcnt vmcnt(6)
    ds_read_b64_tr_b16 v[176:177], v244 offset:6144
    ds_read_b64_tr_b16 v[178:179], v244 offset:7168
    ds_read_b64_tr_b16 v[180:181], v245 offset:6144
    ds_read_b64_tr_b16 v[182:183], v245 offset:7168
    v_permlane32_swap_b32 v196, v198
    v_fmac_f32 v200, v18, v130
    v_mfma_f32_32x32x16_bf16 v[32:47], v[88:91], v[188:191], v[32:47]
    v_fmac_f32 v200, v19, v131
    v_fmac_f32 v200, v20, v132
    v_fmac_f32 v200, v21, v133
    v_fmac_f32 v200, v22, v134
    v_fmac_f32 v200, v23, v135
    v_add_f32 v198, v196, v198
    v_mfma_f32_32x32x16_bf16 v[0:15], v[92:95], v[188:191], v[0:15]
    v_mul_f32_e64 v202, v24, -v128
    v_fma_f32 v202, v25, -v129, v202
    v_fma_f32 v202, v26, -v130, v202
    v_fma_f32 v202, v27, -v131, v202
    v_fma_f32 v202, v28, -v132, v202
    v_fma_f32 v202, v29, -v133, v202
    v_fma_f32 v202, v30, -v134, v202
    v_fma_f32 v202, v31, -v135, v202
    s_nop 1
    v_permlane32_swap_b32 v200, v202
    v_add_f32 v202, v200, v202
    s_waitcnt vmcnt(4) lgkmcnt(0)
    v_mfma_f32_32x32x16_bf16 v[56:71], v[72:75], v[176:179], 0
    v_mul_f32 v197, v32, v104
    v_fmac_f32 v197, v33, v105
    v_fmac_f32 v197, v34, v106
    v_fmac_f32 v197, v35, v107
    v_fmac_f32 v197, v36, v108
    v_fmac_f32 v197, v37, v109
    s_add_u32 m0, s21, 6144
    v_mfma_f32_32x32x16_bf16 v[16:31], v[76:79], v[176:179], 0
    buffer_load_dwordx4 v236, s[4:7], s36 offen  lds
    buffer_load_dwordx4 v237, s[8:11], s36 offen offset:1024  lds
    ds_read_b64_tr_b16 v[176:177], v244 offset:0
    ds_read_b64_tr_b16 v[178:179], v244 offset:1024
    ds_read_b64_tr_b16 v[184:185], v245 offset:0
    ds_read_b64_tr_b16 v[186:187], v245 offset:1024
    v_fmac_f32 v197, v38, v110
    v_fmac_f32 v197, v39, v111
    v_mul_f32 v199, v40, v136
    v_fmac_f32 v199, v41, v137
    v_fmac_f32 v199, v42, v138
    v_fmac_f32 v199, v43, v139
    v_fmac_f32 v199, v44, v140
    v_fmac_f32 v199, v45, v141
    v_fmac_f32 v199, v46, v142
    v_fmac_f32 v199, v47, v143
    v_mul_f32 v201, v0, v136
    v_fmac_f32 v201, v1, v137
    v_permlane32_swap_b32 v197, v199
    v_fmac_f32 v201, v2, v138
    v_fmac_f32 v201, v3, v139
    v_fmac_f32 v201, v4, v140
    v_fmac_f32 v201, v5, v141
    v_fmac_f32 v201, v6, v142
    s_waitcnt vmcnt(4) lgkmcnt(0)
    v_mfma_f32_32x32x16_bf16 v[56:71], v[80:83], v[176:179], v[56:71]
    v_fmac_f32 v201, v7, v143
    v_add_f32 v199, v197, v199
    v_mul_f32_e64 v203, v8, -v136
    v_fma_f32 v203, v9, -v137, v203
    v_fma_f32 v203, v10, -v138, v203
    v_fma_f32 v203, v11, -v139, v203
    s_add_u32 m0, s21, 0
    v_mfma_f32_32x32x16_bf16 v[16:31], v[84:87], v[176:179], v[16:31]
    buffer_load_dwordx4 v238, s[4:7], s36 offen  lds
    buffer_load_dwordx4 v239, s[8:11], s36 offen offset:1024  lds
    ds_read_b64_tr_b16 v[176:177], v244 offset:2048
    ds_read_b64_tr_b16 v[178:179], v244 offset:3072
    ds_read_b64_tr_b16 v[188:189], v245 offset:2048
    ds_read_b64_tr_b16 v[190:191], v245 offset:3072
    s_waitcnt lgkmcnt(0)
    v_mfma_f32_32x32x16_bf16 v[56:71], v[88:91], v[176:179], v[56:71]
    v_fma_f32 v203, v12, -v140, v203
    v_fma_f32 v203, v13, -v141, v203
    v_fma_f32 v203, v14, -v142, v203
    v_fma_f32 v203, v15, -v143, v203
    s_nop 1
    v_permlane32_swap_b32 v201, v203
    v_add_f32 v203, v201, v203
    s_add_u32 m0, s21, 2048
    v_mfma_f32_32x32x16_bf16 v[16:31], v[92:95], v[176:179], v[16:31]
    buffer_load_dwordx4 v234, s[4:7], s37 offen  lds
    buffer_load_dwordx4 v235, s[8:11], s37 offen offset:1024  lds
    v_add_u32 v252, s42, v247
    ds_read2_b32 v[234:235], v252 offset0:0 offset1:16
    s_set_gpr_idx_on s51, gpr_idx(DST)
    s_nop 0
    v_cvt_pk_bf16_f32 v204, v198, v199
    v_cvt_pk_bf16_f32 v205, v202, v203
    s_set_gpr_idx_off
    v_mfma_f32_32x32x16_bf16 v[32:47], v[72:75], v[180:183], 0
    v_mul_f32 v196, v56, v144
    v_fmac_f32 v196, v57, v145
    v_fmac_f32 v196, v58, v146
    v_fmac_f32 v196, v59, v147
    v_fmac_f32 v196, v60, v148
    v_fmac_f32 v196, v61, v149
    v_mfma_f32_32x32x16_bf16 v[0:15], v[76:79], v[180:183], 0
    v_fmac_f32 v196, v62, v150
    v_fmac_f32 v196, v63, v151
    v_mul_f32_e64 v200, v16, -v160
    v_fma_f32 v200, v17, -v161, v200
    v_fma_f32 v200, v18, -v162, v200
    v_fma_f32 v200, v19, -v163, v200
    v_mfma_f32_32x32x16_bf16 v[32:47], v[80:83], v[184:187], v[32:47]
    v_fma_f32 v200, v20, -v164, v200
    v_fma_f32 v200, v21, -v165, v200
    v_fma_f32 v200, v22, -v166, v200
    v_fma_f32 v200, v23, -v167, v200
    v_mul_f32_e64 v202, v24, -v160
    v_fma_f32 v202, v25, -v161, v202
    v_mfma_f32_32x32x16_bf16 v[0:15], v[84:87], v[184:187], v[0:15]
    s_waitcnt vmcnt(6)
    ds_read_b64_tr_b16 v[176:177], v244 offset:4096
    ds_read_b64_tr_b16 v[178:179], v244 offset:5120
    ds_read_b64_tr_b16 v[180:181], v245 offset:4096
    ds_read_b64_tr_b16 v[182:183], v245 offset:5120
    v_fma_f32 v202, v26, -v162, v202
    v_fma_f32 v202, v27, -v163, v202
    v_mfma_f32_32x32x16_bf16 v[32:47], v[88:91], v[188:191], v[32:47]
    v_fma_f32 v202, v28, -v164, v202
    v_fma_f32 v202, v29, -v165, v202
    v_fma_f32 v202, v30, -v166, v202
    v_fma_f32 v202, v31, -v167, v202
    v_mfma_f32_32x32x16_bf16 v[0:15], v[92:95], v[188:191], v[0:15]
    s_waitcnt vmcnt(4) lgkmcnt(0)
    v_mfma_f32_32x32x16_bf16 v[16:31], v[72:75], v[176:179], 0
    s_nop 4
    v_mul_f32 v197, v32, v152
    v_fmac_f32 v197, v33, v153
    v_fmac_f32 v197, v34, v154
    v_fmac_f32 v197, v35, v155
    v_fmac_f32 v197, v36, v156
    v_fmac_f32 v197, v37, v157
    s_add_u32 m0, s21, 4096
    v_mfma_f32_32x32x16_bf16 v[48:63], v[76:79], v[176:179], 0
    buffer_load_dwordx4 v236, s[4:7], s37 offen  lds
    buffer_load_dwordx4 v237, s[8:11], s37 offen offset:1024  lds
    ds_read_b64_tr_b16 v[176:177], v244 offset:6144
    ds_read_b64_tr_b16 v[178:179], v244 offset:7168
    ds_read_b64_tr_b16 v[184:185], v245 offset:6144
    ds_read_b64_tr_b16 v[186:187], v245 offset:7168
    v_add_u32 v252, s43, v247
    ds_read2_b32 v[236:237], v252 offset0:0 offset1:16
    v_fmac_f32 v197, v38, v158
    v_fmac_f32 v197, v39, v159
    v_mul_f32_e64 v201, v0, -v168
    v_fma_f32 v201, v1, -v169, v201
    s_waitcnt vmcnt(4) lgkmcnt(1)
    v_mfma_f32_32x32x16_bf16 v[16:31], v[80:83], v[176:179], v[16:31]
    v_fma_f32 v201, v2, -v170, v201
    v_fma_f32 v201, v3, -v171, v201
    v_fma_f32 v201, v4, -v172, v201
    v_fma_f32 v201, v5, -v173, v201
    v_fma_f32 v201, v6, -v174, v201
    v_fma_f32 v201, v7, -v175, v201
    s_add_u32 m0, s21, 6144
    v_mfma_f32_32x32x16_bf16 v[48:63], v[84:87], v[176:179], v[48:63]
    buffer_load_dwordx4 v238, s[4:7], s37 offen  lds
    buffer_load_dwordx4 v239, s[8:11], s37 offen offset:1024  lds
    ds_read_b64_tr_b16 v[176:177], v244 offset:0
    ds_read_b64_tr_b16 v[178:179], v244 offset:1024
    ds_read_b64_tr_b16 v[188:189], v245 offset:0
    ds_read_b64_tr_b16 v[190:191], v245 offset:1024
    v_add_u32 v252, s44, v247
    ds_read2_b32 v[238:239], v252 offset0:0 offset1:16
    s_waitcnt lgkmcnt(1)
    v_mfma_f32_32x32x16_bf16 v[16:31], v[88:91], v[176:179], v[16:31]
    v_mul_f32_e64 v203, v8, -v168
    v_fma_f32 v203, v9, -v169, v203
    v_fma_f32 v203, v10, -v170, v203
    v_fma_f32 v203, v11, -v171, v203
    v_fma_f32 v203, v12, -v172, v203
    v_fma_f32 v203, v13, -v173, v203
    s_add_u32 m0, s21, 0
    v_mfma_f32_32x32x16_bf16 v[48:63], v[92:95], v[176:179], v[48:63]
    v_mad_u32_u16 v234, v234, s3, v246 op_sel:[1,0,0,0]
    v_mad_u32_u16 v235, v235, s3, v246 op_sel:[1,0,0,0]
    buffer_load_dwordx4 v234, s[4:7], s38 offen  lds
    buffer_load_dwordx4 v235, s[8:11], s38 offen offset:1024  lds
    v_fma_f32 v203, v14, -v174, v203
    v_fma_f32 v203, v15, -v175, v203
    v_mfma_f32_32x32x16_bf16 v[0:15], v[72:75], v[180:183], 0
    v_fmac_f32 v200, v24, v160
    v_fmac_f32 v200, v25, v161
    v_fmac_f32 v200, v26, v162
    v_fmac_f32 v200, v27, v163
    v_fmac_f32 v200, v28, v164
    v_fmac_f32 v200, v29, v165
    v_fmac_f32 v200, v30, v166
    v_fmac_f32 v200, v31, v167
    v_mfma_f32_32x32x16_bf16 v[24:39], v[76:79], v[180:183], 0
    v_add_u32 v253, s47, v248
    ds_read_b32 v192, v253
    ds_read_b32 v193, v253 offset:256
    v_mul_f32 v254, v16, v144
    v_fmac_f32 v254, v17, v145
    v_fmac_f32 v254, v18, v146
    v_mfma_f32_32x32x16_bf16 v[0:15], v[80:83], v[184:187], v[0:15]
    v_fmac_f32 v254, v19, v147
    v_fmac_f32 v254, v20, v148
    v_fmac_f32 v254, v21, v149
    v_fmac_f32 v254, v22, v150
    v_fmac_f32 v254, v23, v151
    v_sub_f32_e64 v64, -v48, v64
    v_mfma_f32_32x32x16_bf16 v[24:39], v[84:87], v[184:187], v[24:39]
    s_waitcnt vmcnt(6)
    ds_read_b64_tr_b16 v[176:177], v244 offset:2048
    ds_read_b64_tr_b16 v[178:179], v244 offset:3072
    ds_read_b64_tr_b16 v[180:181], v245 offset:2048
    ds_read_b64_tr_b16 v[182:183], v245 offset:3072
    v_sub_f32_e64 v65, -v49, v65
    v_permlane32_swap_b32 v196, v254
    v_mfma_f32_32x32x16_bf16 v[24:39], v[92:95], v[188:191], v[24:39]
    v_sub_f32_e64 v66, -v50, v66
    v_sub_f32_e64 v67, -v51, v67
    v_sub_f32_e64 v68, -v52, v68
    v_sub_f32_e64 v69, -v53, v69
    v_sub_f32_e64 v70, -v54, v70
    v_sub_f32_e64 v71, -v55, v71
    v_mfma_f32_32x32x16_bf16 v[0:15], v[88:91], v[188:191], v[0:15]
    v_add_f32 v254, v196, v254
    s_waitcnt vmcnt(4) lgkmcnt(0)
    v_mfma_f32_32x32x16_bf16 v[56:71], v[76:79], v[176:179], v[56:71]
    s_nop 1
    v_sub_f32_e64 v40, -v24, v40
    v_sub_f32_e64 v41, -v25, v41
    v_sub_f32_e64 v42, -v26, v42
    v_sub_f32_e64 v43, -v27, v43
    v_sub_f32_e64 v44, -v28, v44
    v_sub_f32_e64 v45, -v29, v45
    v_sub_f32_e64 v46, -v30, v46
    v_sub_f32_e64 v47, -v31, v47
    s_mov_b32 m0, s76
    s_mov_b64 exec, s[72:73]
    buffer_load_dwordx4 v192, s[12:15], 0 offen  lds
    s_mov_b32 m0, s77
    s_mov_b64 exec, s[74:75]
    buffer_load_dwordx4 v193, s[12:15], 0 offen  lds
    s_mov_b64 exec, -1
    s_add_u32 m0, s21, 2048
    v_mfma_f32_32x32x16_bf16 v[16:31], v[72:75], v[176:179], 0
    v_mad_u32_u16 v236, v236, s3, v246 op_sel:[1,0,0,0]
    v_mad_u32_u16 v237, v237, s3, v246 op_sel:[1,0,0,0]
    buffer_load_dwordx4 v236, s[4:7], s39 offen  lds
    buffer_load_dwordx4 v237, s[8:11], s39 offen offset:1024  lds
    ds_read_b64_tr_b16 v[176:177], v244 offset:4096
    ds_read_b64_tr_b16 v[178:179], v244 offset:5120
    ds_read_b64_tr_b16 v[184:185], v245 offset:4096
    ds_read_b64_tr_b16 v[186:187], v245 offset:5120
    v_mul_f32 v255, v0, v152
    v_fmac_f32 v255, v1, v153
    v_fmac_f32 v255, v2, v154
    v_fmac_f32 v255, v3, v155
    v_fmac_f32 v255, v4, v156
    s_waitcnt vmcnt(6) lgkmcnt(0)
    v_mfma_f32_32x32x16_bf16 v[16:31], v[80:83], v[176:179], v[16:31]
    v_fmac_f32 v255, v5, v157
    v_fmac_f32 v255, v6, v158
    v_fmac_f32 v255, v7, v159
    v_fmac_f32 v201, v8, v168
    v_fmac_f32 v201, v9, v169
    v_permlane32_swap_b32 v197, v255
    s_add_u32 m0, s21, 4096
    v_mfma_f32_32x32x16_bf16 v[56:71], v[84:87], v[176:179], v[56:71]
    v_mad_u32_u16 v238, v238, s3, v246 op_sel:[1,0,0,0]
    v_mad_u32_u16 v239, v239, s3, v246 op_sel:[1,0,0,0]
    buffer_load_dwordx4 v238, s[4:7], s40 offen  lds
    buffer_load_dwordx4 v239, s[8:11], s40 offen offset:1024  lds
    ds_read_b64_tr_b16 v[176:177], v244 offset:6144
    ds_read_b64_tr_b16 v[178:179], v244 offset:7168
    ds_read_b64_tr_b16 v[188:189], v245 offset:6144
    ds_read_b64_tr_b16 v[190:191], v245 offset:7168
    s_waitcnt lgkmcnt(0)
    v_mfma_f32_32x32x16_bf16 v[16:31], v[88:91], v[176:179], v[16:31]
    v_fmac_f32 v201, v10, v170
    v_fmac_f32 v201, v11, v171
    v_fmac_f32 v201, v12, v172
    v_fmac_f32 v201, v13, v173
    v_fmac_f32 v201, v14, v174
    v_fmac_f32 v201, v15, v175
    s_add_u32 m0, s21, 6144
    v_mfma_f32_32x32x16_bf16 v[56:71], v[92:95], v[176:179], v[56:71]
    v_mad_u32_u16 v240, v240, s3, v246 op_sel:[1,0,0,0]
    v_mad_u32_u16 v241, v241, s3, v246 op_sel:[1,0,0,0]
    buffer_load_dwordx4 v240, s[4:7], s41 offen  lds
    buffer_load_dwordx4 v241, s[8:11], s41 offen offset:1024  lds
    v_add_f32 v255, v197, v255
    s_set_gpr_idx_on s51, gpr_idx(DST)
    s_nop 0
    v_cvt_pk_bf16_f32 v206, v254, v255
    s_set_gpr_idx_off
    v_mfma_f32_32x32x16_bf16 v[0:15], v[72:75], v[180:183], 0
    v_mul_f32 v254, v16, v144
    v_fmac_f32 v254, v17, v145
    v_fmac_f32 v254, v18, v146
    v_fmac_f32 v254, v19, v147
    v_fmac_f32 v254, v20, v148
    v_fmac_f32 v254, v21, v149
    v_mfma_f32_32x32x16_bf16 v[32:47], v[76:79], v[180:183], v[32:47]
    v_fmac_f32 v254, v22, v150
    v_fmac_f32 v254, v23, v151
    v_fma_f32 v202, v24, -v160, v202
    v_fma_f32 v202, v25, -v161, v202
    v_permlane32_swap_b32 v254, v200
    v_fma_f32 v202, v26, -v162, v202
    v_mfma_f32_32x32x16_bf16 v[0:15], v[80:83], v[184:187], v[0:15]
    v_fma_f32 v202, v27, -v163, v202
    v_fma_f32 v202, v28, -v164, v202
    v_fma_f32 v202, v29, -v165, v202
    v_fma_f32 v202, v30, -v166, v202
    v_fma_f32 v202, v31, -v167, v202
    v_add_f32 v200, v254, v200
    v_mfma_f32_32x32x16_bf16 v[32:47], v[84:87], v[184:187], v[32:47]
    s_waitcnt vmcnt(8)
    ds_read_b64_tr_b16 v[176:177], v244 offset:0
    ds_read_b64_tr_b16 v[178:179], v244 offset:1024
    ds_read_b64_tr_b16 v[180:181], v245 offset:0
    ds_read_b64_tr_b16 v[182:183], v245 offset:1024
    v_mul_f32_e64 v198, v64, -v112
    v_permlane32_swap_b32 v202, v254
    v_mfma_f32_32x32x16_bf16 v[0:15], v[88:91], v[188:191], v[0:15]
    v_fma_f32 v198, v65, -v113, v198
    v_fma_f32 v198, v66, -v114, v198
    v_fma_f32 v198, v67, -v115, v198
    v_fma_f32 v198, v68, -v116, v198
    v_fma_f32 v198, v69, -v117, v198
    v_fma_f32 v198, v70, -v118, v198
    v_mfma_f32_32x32x16_bf16 v[32:47], v[92:95], v[188:191], v[32:47]
    v_add_u32 v249, s48, v249
    v_add_u32 v250, s49, v250
    v_fma_f32 v198, v71, -v119, v198
    v_add_f32 v254, v202, v254
    v_mul_f32 v196, v56, v160
    v_fmac_f32 v196, v57, v161
    v_fmac_f32 v196, v58, v162
    v_fmac_f32 v196, v59, v163
    v_fmac_f32 v196, v60, v164
    v_fmac_f32 v196, v61, v165
    v_fmac_f32 v196, v62, v166
    v_fmac_f32 v196, v63, v167
    s_nop 1
    v_permlane32_swap_b32 v198, v196
    v_add_f32 v196, v198, v196
    v_mul_f32 v255, v0, v152
    v_fmac_f32 v255, v1, v153
    v_fmac_f32 v255, v2, v154
    v_fmac_f32 v255, v3, v155
    v_fmac_f32 v255, v4, v156
    v_fmac_f32 v255, v5, v157
    v_fmac_f32 v255, v6, v158
    v_fmac_f32 v255, v7, v159
    v_fma_f32 v203, v8, -v168, v203
    v_fma_f32 v203, v9, -v169, v203
    v_permlane32_swap_b32 v255, v201
    v_fma_f32 v203, v10, -v170, v203
    v_fma_f32 v203, v11, -v171, v203
    v_fma_f32 v203, v12, -v172, v203
    v_fma_f32 v203, v13, -v173, v203
    v_fma_f32 v203, v14, -v174, v203
    v_fma_f32 v203, v15, -v175, v203
    v_add_f32 v201, v255, v201
    v_mul_f32_e64 v199, v40, -v120
    v_permlane32_swap_b32 v203, v255
    v_fma_f32 v199, v41, -v121, v199
    v_fma_f32 v199, v42, -v122, v199
    v_fma_f32 v199, v43, -v123, v199
    s_waitcnt vmcnt(6)
    ds_read_b64_tr_b16 v[72:73], v249 offset:0
    ds_read_b64_tr_b16 v[76:77], v249 offset:64
    ds_read_b64_tr_b16 v[74:75], v249 offset:256
    ds_read_b64_tr_b16 v[78:79], v249 offset:320
    s_mov_b64 exec, s[54:55]
    ds_read_u16_d16_hi v242, v250 offset:0
    s_mov_b64 exec, -1
    v_fma_f32 v199, v44, -v124, v199
    v_fma_f32 v199, v45, -v125, v199
    v_fma_f32 v199, v46, -v126, v199
    v_fma_f32 v199, v47, -v127, v199
    v_add_f32 v255, v203, v255
    v_mul_f32 v197, v32, v168
    v_fmac_f32 v197, v33, v169
    v_fmac_f32 v197, v34, v170
    v_fmac_f32 v197, v35, v171
    v_fmac_f32 v197, v36, v172
    v_fmac_f32 v197, v37, v173
    v_fmac_f32 v197, v38, v174
    v_fmac_f32 v197, v39, v175
    s_nop 1
    v_permlane32_swap_b32 v199, v197
    v_add_f32 v197, v199, v197
    s_set_gpr_idx_on s51, gpr_idx(DST)
    s_nop 0
    v_cvt_pk_bf16_f32 v207, v200, v201
    v_cvt_pk_bf16_f32 v209, v254, v255
    v_cvt_pk_bf16_f32 v208, v196, v197
    s_set_gpr_idx_off
    s_add_u32 s50, s50, 1
    s_add_u32 s51, s51, 6
    s_cmp_ge_u32 s50, 4
    s_cbranch_scc1 LAST0
    s_add_u32 s53, s53, 4
    s_xor_b32 s66, s53, s20
    s_bitcmp1_b32 s66, 2
    s_setprio 1
    s_cbranch_scc1 PRIO_8
    s_setprio 0
PRIO_8:
    s_cmp_eq_u32 s52, 4
    s_cbranch_scc1 ITEM_0_4
    s_cmp_eq_u32 s52, 5
    s_cbranch_scc1 ITEM_0_5
    s_cmp_eq_u32 s52, 3
    s_cbranch_scc1 ITEM_0_3
    s_cmp_eq_u32 s52, 6
    s_cbranch_scc1 ITEM_0_6
    s_cmp_eq_u32 s52, 8
    s_cbranch_scc1 ITEM_0_8
    s_branch ITEM_0_2
.p2align 6
ITEM_0_8:
    s_mov_b64 exec, s[54:55]
    ds_read_u16_d16_hi v243, v250 offset:128
    s_mov_b64 exec, -1
    ds_read_b64_tr_b16 v[80:81], v249 offset:512
    ds_read_b64_tr_b16 v[84:85], v249 offset:576
    ds_read_b64_tr_b16 v[82:83], v249 offset:768
    ds_read_b64_tr_b16 v[86:87], v249 offset:832
    ds_read_b64_tr_b16 v[88:89], v249 offset:1024
    ds_read_b64_tr_b16 v[92:93], v249 offset:1088
    ds_read_b64_tr_b16 v[90:91], v249 offset:1280
    ds_read_b64_tr_b16 v[94:95], v249 offset:1344
    ds_read_b64_tr_b16 v[64:65], v249 offset:1536
    ds_read_b64_tr_b16 v[68:69], v249 offset:1600
    ds_read_b64_tr_b16 v[66:67], v249 offset:1792
    ds_read_b64_tr_b16 v[70:71], v249 offset:1856
    s_waitcnt lgkmcnt(13)
    v_mul_f32_dpp v196, v242, v72 row_newbcast:0 row_mask:0xf bank_mask:0xf
    v_mul_f32_dpp v197, v242, v73 row_newbcast:1 row_mask:0xf bank_mask:0xf
    v_mul_f32_dpp v198, v242, v72 row_newbcast:8 row_mask:0xf bank_mask:0xf
    v_mul_f32_dpp v199, v242, v73 row_newbcast:9 row_mask:0xf bank_mask:0xf
    v_mul_f32_dpp v200, v242, v76 row_newbcast:2 row_mask:0xf bank_mask:0xf
    v_mul_f32_dpp v201, v242, v77 row_newbcast:3 row_mask:0xf bank_mask:0xf
    v_mul_f32_dpp v202, v242, v76 row_newbcast:10 row_mask:0xf bank_mask:0xf
    v_mul_f32_dpp v203, v242, v77 row_newbcast:11 row_mask:0xf bank_mask:0xf
    v_cvt_pk_bf16_f32 v72, v196, v197
    v_cvt_pk_bf16_f32 v76, v198, v199
    v_cvt_pk_bf16_f32 v73, v200, v201
    v_cvt_pk_bf16_f32 v77, v202, v203
    v_mul_f32_dpp v196, v242, v74 row_newbcast:4 row_mask:0xf bank_mask:0xf
    v_mul_f32_dpp v197, v242, v75 row_newbcast:5 row_mask:0xf bank_mask:0xf
    v_mul_f32_dpp v198, v242, v74 row_newbcast:12 row_mask:0xf bank_mask:0xf
    v_mul_f32_dpp v199, v242, v75 row_newbcast:13 row_mask:0xf bank_mask:0xf
    v_mul_f32_dpp v200, v242, v78 row_newbcast:6 row_mask:0xf bank_mask:0xf
    v_mul_f32_dpp v201, v242, v79 row_newbcast:7 row_mask:0xf bank_mask:0xf
    v_mul_f32_dpp v202, v242, v78 row_newbcast:14 row_mask:0xf bank_mask:0xf
    v_mul_f32_dpp v203, v242, v79 row_newbcast:15 row_mask:0xf bank_mask:0xf
    v_cvt_pk_bf16_f32 v74, v196, v197
    v_cvt_pk_bf16_f32 v78, v198, v199
    v_cvt_pk_bf16_f32 v75, v200, v201
    v_cvt_pk_bf16_f32 v79, v202, v203
    s_mov_b64 exec, s[54:55]
    ds_read_u16_d16_hi v242, v250 offset:256
    s_mov_b64 exec, -1
    s_waitcnt vmcnt(4) lgkmcnt(9)
    v_mfma_f32_32x32x16_bf16 v[0:15], v[72:75], v[176:179], 0
    v_mul_f32_dpp v196, v243, v80 row_newbcast:0 row_mask:0xf bank_mask:0xf
    v_mul_f32_dpp v197, v243, v81 row_newbcast:1 row_mask:0xf bank_mask:0xf
    v_mul_f32_dpp v198, v243, v80 row_newbcast:8 row_mask:0xf bank_mask:0xf
    v_mul_f32_dpp v199, v243, v81 row_newbcast:9 row_mask:0xf bank_mask:0xf
    v_mul_f32_dpp v200, v243, v84 row_newbcast:2 row_mask:0xf bank_mask:0xf
    v_mul_f32_dpp v201, v243, v85 row_newbcast:3 row_mask:0xf bank_mask:0xf
    s_add_u32 m0, s21, 0
    v_mfma_f32_32x32x16_bf16 v[48:63], v[76:79], v[176:179], 0
    buffer_load_dwordx4 v234, s[4:7], s35 offen  lds
    buffer_load_dwordx4 v235, s[8:11], s35 offen offset:1024  lds
    ds_read_b64_tr_b16 v[176:177], v244 offset:2048
    ds_read_b64_tr_b16 v[178:179], v244 offset:3072
    ds_read_b64_tr_b16 v[184:185], v245 offset:2048
    ds_read_b64_tr_b16 v[186:187], v245 offset:3072
    v_mul_f32_dpp v202, v243, v84 row_newbcast:10 row_mask:0xf bank_mask:0xf
    v_mul_f32_dpp v203, v243, v85 row_newbcast:11 row_mask:0xf bank_mask:0xf
    v_cvt_pk_bf16_f32 v80, v196, v197
    v_cvt_pk_bf16_f32 v84, v198, v199
    v_cvt_pk_bf16_f32 v81, v200, v201
    v_cvt_pk_bf16_f32 v85, v202, v203
    v_mul_f32_dpp v196, v243, v82 row_newbcast:4 row_mask:0xf bank_mask:0xf
    v_mul_f32_dpp v197, v243, v83 row_newbcast:5 row_mask:0xf bank_mask:0xf
    v_mul_f32_dpp v198, v243, v82 row_newbcast:12 row_mask:0xf bank_mask:0xf
    v_mul_f32_dpp v199, v243, v83 row_newbcast:13 row_mask:0xf bank_mask:0xf
    v_mul_f32_dpp v200, v243, v86 row_newbcast:6 row_mask:0xf bank_mask:0xf
    v_mul_f32_dpp v201, v243, v87 row_newbcast:7 row_mask:0xf bank_mask:0xf
    v_mul_f32_dpp v202, v243, v86 row_newbcast:14 row_mask:0xf bank_mask:0xf
    v_mul_f32_dpp v203, v243, v87 row_newbcast:15 row_mask:0xf bank_mask:0xf
    v_cvt_pk_bf16_f32 v82, v196, v197
    v_cvt_pk_bf16_f32 v86, v198, v199
    v_cvt_pk_bf16_f32 v83, v200, v201
    v_cvt_pk_bf16_f32 v87, v202, v203
    s_mov_b64 exec, s[54:55]
    ds_read_u16_d16_hi v243, v250 offset:384
    s_mov_b64 exec, -1
    s_waitcnt vmcnt(4) lgkmcnt(1)
    v_mfma_f32_32x32x16_bf16 v[0:15], v[80:83], v[176:179], v[0:15]
    v_mul_f32_dpp v196, v242, v88 row_newbcast:0 row_mask:0xf bank_mask:0xf
    v_mul_f32_dpp v197, v242, v89 row_newbcast:1 row_mask:0xf bank_mask:0xf
    v_mul_f32_dpp v198, v242, v88 row_newbcast:8 row_mask:0xf bank_mask:0xf
    v_mul_f32_dpp v199, v242, v89 row_newbcast:9 row_mask:0xf bank_mask:0xf
    v_mul_f32_dpp v200, v242, v92 row_newbcast:2 row_mask:0xf bank_mask:0xf
    v_mul_f32_dpp v201, v242, v93 row_newbcast:3 row_mask:0xf bank_mask:0xf
    s_add_u32 m0, s21, 2048
    v_mfma_f32_32x32x16_bf16 v[48:63], v[84:87], v[176:179], v[48:63]
    buffer_load_dwordx4 v236, s[4:7], s35 offen  lds
    buffer_load_dwordx4 v237, s[8:11], s35 offen offset:1024  lds
    ds_read_b64_tr_b16 v[176:177], v244 offset:4096
    ds_read_b64_tr_b16 v[178:179], v244 offset:5120
    ds_read_b64_tr_b16 v[188:189], v245 offset:4096
    ds_read_b64_tr_b16 v[190:191], v245 offset:5120
    v_mul_f32_dpp v202, v242, v92 row_newbcast:10 row_mask:0xf bank_mask:0xf
    v_mul_f32_dpp v203, v242, v93 row_newbcast:11 row_mask:0xf bank_mask:0xf
    v_cvt_pk_bf16_f32 v88, v196, v197
    v_cvt_pk_bf16_f32 v92, v198, v199
    v_cvt_pk_bf16_f32 v89, v200, v201
    v_cvt_pk_bf16_f32 v93, v202, v203
    v_mul_f32_dpp v196, v242, v90 row_newbcast:4 row_mask:0xf bank_mask:0xf
    v_mul_f32_dpp v197, v242, v91 row_newbcast:5 row_mask:0xf bank_mask:0xf
    v_mul_f32_dpp v198, v242, v90 row_newbcast:12 row_mask:0xf bank_mask:0xf
    v_mul_f32_dpp v199, v242, v91 row_newbcast:13 row_mask:0xf bank_mask:0xf
    v_mul_f32_dpp v200, v242, v94 row_newbcast:6 row_mask:0xf bank_mask:0xf
    v_mul_f32_dpp v201, v242, v95 row_newbcast:7 row_mask:0xf bank_mask:0xf
    v_mul_f32_dpp v202, v242, v94 row_newbcast:14 row_mask:0xf bank_mask:0xf
    v_mul_f32_dpp v203, v242, v95 row_newbcast:15 row_mask:0xf bank_mask:0xf
    v_cvt_pk_bf16_f32 v90, v196, v197
    v_cvt_pk_bf16_f32 v94, v198, v199
    v_cvt_pk_bf16_f32 v91, v200, v201
    v_cvt_pk_bf16_f32 v95, v202, v203
    s_waitcnt vmcnt(4) lgkmcnt(0)
    v_mfma_f32_32x32x16_bf16 v[0:15], v[88:91], v[176:179], v[0:15]
    v_mul_f32_dpp v196, v243, v64 row_newbcast:0 row_mask:0xf bank_mask:0xf
    v_mul_f32_dpp v197, v243, v65 row_newbcast:1 row_mask:0xf bank_mask:0xf
    v_mul_f32_dpp v198, v243, v64 row_newbcast:8 row_mask:0xf bank_mask:0xf
    v_mul_f32_dpp v199, v243, v65 row_newbcast:9 row_mask:0xf bank_mask:0xf
    v_mul_f32_dpp v200, v243, v68 row_newbcast:2 row_mask:0xf bank_mask:0xf
    v_mul_f32_dpp v201, v243, v69 row_newbcast:3 row_mask:0xf bank_mask:0xf
    s_add_u32 m0, s21, 4096
    v_mfma_f32_32x32x16_bf16 v[48:63], v[92:95], v[176:179], v[48:63]
    buffer_load_dwordx4 v238, s[4:7], s35 offen  lds
    buffer_load_dwordx4 v239, s[8:11], s35 offen offset:1024  lds
    ds_read_b64_tr_b16 v[176:177], v244 offset:6144
    ds_read_b64_tr_b16 v[178:179], v244 offset:7168
    ds_read_b64_tr_b16 v[192:193], v245 offset:6144
    ds_read_b64_tr_b16 v[194:195], v245 offset:7168
    v_mul_f32_dpp v202, v243, v68 row_newbcast:10 row_mask:0xf bank_mask:0xf
    v_mul_f32_dpp v203, v243, v69 row_newbcast:11 row_mask:0xf bank_mask:0xf
    v_cvt_pk_bf16_f32 v64, v196, v197
    v_cvt_pk_bf16_f32 v68, v198, v199
    v_cvt_pk_bf16_f32 v65, v200, v201
    v_cvt_pk_bf16_f32 v69, v202, v203
    v_mul_f32_dpp v196, v243, v66 row_newbcast:4 row_mask:0xf bank_mask:0xf
    v_mul_f32_dpp v197, v243, v67 row_newbcast:5 row_mask:0xf bank_mask:0xf
    v_mul_f32_dpp v198, v243, v66 row_newbcast:12 row_mask:0xf bank_mask:0xf
    v_mul_f32_dpp v199, v243, v67 row_newbcast:13 row_mask:0xf bank_mask:0xf
    v_mul_f32_dpp v200, v243, v70 row_newbcast:6 row_mask:0xf bank_mask:0xf
    v_mul_f32_dpp v201, v243, v71 row_newbcast:7 row_mask:0xf bank_mask:0xf
    v_mul_f32_dpp v202, v243, v70 row_newbcast:14 row_mask:0xf bank_mask:0xf
    v_mul_f32_dpp v203, v243, v71 row_newbcast:15 row_mask:0xf bank_mask:0xf
    v_cvt_pk_bf16_f32 v66, v196, v197
    v_cvt_pk_bf16_f32 v70, v198, v199
    v_cvt_pk_bf16_f32 v67, v200, v201
    v_cvt_pk_bf16_f32 v71, v202, v203
    s_waitcnt lgkmcnt(0)
    v_mfma_f32_32x32x16_bf16 v[0:15], v[64:67], v[176:179], v[0:15]
    s_add_u32 m0, s21, 6144
    v_mfma_f32_32x32x16_bf16 v[48:63], v[68:71], v[176:179], v[48:63]
    buffer_load_dwordx4 v240, s[4:7], s35 offen  lds
    buffer_load_dwordx4 v241, s[8:11], s35 offen offset:1024  lds
    s_mov_b32 m0, s50
    s_nop 0
    s_movrels_b32 s71, s23
    s_bfe_u32 s46, s71, 0x30012
    s_mov_b32 m0, s46
    s_and_b32 s66, s71, 0x3ffff
    s_movrels_b32 s68, s57
    s_movrels_b32 s69, s61
    s_sub_u32 s48, s66, s47
    s_mov_b32 s47, s66
    s_lshr_b32 s52, s71, 28
    s_lshl_b32 s67, s46, 9
    s_add_u32 s66, s66, s67
    s_sub_u32 s49, s66, s42
    s_mov_b32 s42, s66
    s_bfe_u32 s66, s68, 655360
    s_add_u32 s43, s42, s66
    s_bfe_u32 s39, s69, 655360
    s_bfe_u32 s66, s68, 655370
    s_add_u32 s44, s42, s66
    s_bfe_u32 s40, s69, 655370
    s_bfe_u32 s66, s68, 655380
    s_add_u32 s45, s42, s66
    s_bfe_u32 s41, s69, 655380
    s_and_b32 s66, s46, s33
    s_cselect_b32 s72, -1, 1
    s_cselect_b32 s76, s47, 163712
    s_cmp_ge_u32 s66, 2
    s_cselect_b32 s73, -1, 0
    s_add_u32 s77, s47, 1024
    s_cmp_ge_u32 s66, 4
    s_cselect_b32 s75, -1, 0
    s_cmp_ge_u32 s66, 3
    s_cselect_b32 s74, -1, 1
    s_cselect_b32 s77, s77, 163712
    v_mfma_f32_32x32x16_bf16 v[16:31], v[72:75], v[180:183], 0
    v_mul_f32 v196, v0, v96
    v_fmac_f32 v196, v1, v97
    v_fmac_f32 v196, v2, v98
    v_fmac_f32 v196, v3, v99
    v_fmac_f32 v196, v4, v100
    v_fmac_f32 v196, v5, v101
    v_mfma_f32_32x32x16_bf16 v[32:47], v[76:79], v[180:183], 0
    v_fmac_f32 v196, v6, v102
    v_fmac_f32 v196, v7, v103
    v_mul_f32 v198, v8, v128
    v_fmac_f32 v198, v9, v129
    v_fmac_f32 v198, v10, v130
    v_fmac_f32 v198, v11, v131
    v_mfma_f32_32x32x16_bf16 v[16:31], v[80:83], v[184:187], v[16:31]
    v_fmac_f32 v198, v12, v132
    v_fmac_f32 v198, v13, v133
    v_fmac_f32 v198, v14, v134
    v_fmac_f32 v198, v15, v135
    v_mul_f32 v200, v48, v128
    v_fmac_f32 v200, v49, v129
    v_mfma_f32_32x32x16_bf16 v[32:47], v[84:87], v[184:187], v[32:47]
    v_permlane32_swap_b32 v196, v198
    v_fmac_f32 v200, v50, v130
    v_fmac_f32 v200, v51, v131
    v_fmac_f32 v200, v52, v132
    v_fmac_f32 v200, v53, v133
    v_fmac_f32 v200, v54, v134
    v_mfma_f32_32x32x16_bf16 v[16:31], v[88:91], v[188:191], v[16:31]
    v_fmac_f32 v200, v55, v135
    v_add_f32 v198, v196, v198
    v_mul_f32_e64 v202, v56, -v128
    v_fma_f32 v202, v57, -v129, v202
    v_fma_f32 v202, v58, -v130, v202
    v_fma_f32 v202, v59, -v131, v202
    v_mfma_f32_32x32x16_bf16 v[32:47], v[92:95], v[188:191], v[32:47]
    s_waitcnt vmcnt(6)
    ds_read_b64_tr_b16 v[176:177], v244 offset:0
    ds_read_b64_tr_b16 v[178:179], v244 offset:1024
    ds_read_b64_tr_b16 v[180:181], v245 offset:0
    ds_read_b64_tr_b16 v[182:183], v245 offset:1024
    v_fma_f32 v202, v60, -v132, v202
    v_fma_f32 v202, v61, -v133, v202
    v_mfma_f32_32x32x16_bf16 v[16:31], v[64:67], v[192:195], v[16:31]
    v_fma_f32 v202, v62, -v134, v202
    v_fma_f32 v202, v63, -v135, v202
    s_nop 1
    v_permlane32_swap_b32 v200, v202
    v_add_f32 v202, v200, v202
    v_mfma_f32_32x32x16_bf16 v[32:47], v[68:71], v[192:195], v[32:47]
    s_waitcnt vmcnt(4) lgkmcnt(0)
    v_mfma_f32_32x32x16_bf16 v[0:15], v[72:75], v[176:179], 0
    s_nop 2
    v_mul_f32 v197, v16, v104
    v_fmac_f32 v197, v17, v105
    v_fmac_f32 v197, v18, v106
    v_fmac_f32 v197, v19, v107
    v_fmac_f32 v197, v20, v108
    v_fmac_f32 v197, v21, v109
    s_add_u32 m0, s21, 0
    v_mfma_f32_32x32x16_bf16 v[48:63], v[76:79], v[176:179], 0
    buffer_load_dwordx4 v234, s[4:7], s36 offen  lds
    buffer_load_dwordx4 v235, s[8:11], s36 offen offset:1024  lds
    ds_read_b64_tr_b16 v[176:177], v244 offset:2048
    ds_read_b64_tr_b16 v[178:179], v244 offset:3072
    ds_read_b64_tr_b16 v[184:185], v245 offset:2048
    ds_read_b64_tr_b16 v[186:187], v245 offset:3072
    v_fmac_f32 v197, v22, v110
    v_fmac_f32 v197, v23, v111
    v_mul_f32 v199, v24, v136
    v_fmac_f32 v199, v25, v137
    v_fmac_f32 v199, v26, v138
    v_fmac_f32 v199, v27, v139
    v_fmac_f32 v199, v28, v140
    v_fmac_f32 v199, v29, v141
    v_fmac_f32 v199, v30, v142
    v_fmac_f32 v199, v31, v143
    s_waitcnt vmcnt(4) lgkmcnt(0)
    v_mfma_f32_32x32x16_bf16 v[0:15], v[80:83], v[176:179], v[0:15]
    v_mul_f32 v201, v32, v136
    v_fmac_f32 v201, v33, v137
    v_permlane32_swap_b32 v197, v199
    v_fmac_f32 v201, v34, v138
    v_fmac_f32 v201, v35, v139
    v_fmac_f32 v201, v36, v140
    s_add_u32 m0, s21, 2048
    v_mfma_f32_32x32x16_bf16 v[48:63], v[84:87], v[176:179], v[48:63]
    buffer_load_dwordx4 v236, s[4:7], s36 offen  lds
    buffer_load_dwordx4 v237, s[8:11], s36 offen offset:1024  lds
    ds_read_b64_tr_b16 v[176:177], v244 offset:4096
    ds_read_b64_tr_b16 v[178:179], v244 offset:5120
    ds_read_b64_tr_b16 v[188:189], v245 offset:4096
    ds_read_b64_tr_b16 v[190:191], v245 offset:5120
    s_waitcnt vmcnt(4) lgkmcnt(0)
    v_mfma_f32_32x32x16_bf16 v[0:15], v[88:91], v[176:179], v[0:15]
    v_fmac_f32 v201, v37, v141
    v_fmac_f32 v201, v38, v142
    v_fmac_f32 v201, v39, v143
    v_add_f32 v199, v197, v199
    v_mul_f32_e64 v203, v40, -v136
    v_fma_f32 v203, v41, -v137, v203
    s_add_u32 m0, s21, 4096
    v_mfma_f32_32x32x16_bf16 v[48:63], v[92:95], v[176:179], v[48:63]
    buffer_load_dwordx4 v238, s[4:7], s36 offen  lds
    buffer_load_dwordx4 v239, s[8:11], s36 offen offset:1024  lds
    ds_read_b64_tr_b16 v[176:177], v244 offset:6144
    ds_read_b64_tr_b16 v[178:179], v244 offset:7168
    ds_read_b64_tr_b16 v[192:193], v245 offset:6144
    ds_read_b64_tr_b16 v[194:195], v245 offset:7168
    s_waitcnt lgkmcnt(0)
    v_mfma_f32_32x32x16_bf16 v[0:15], v[64:67], v[176:179], v[0:15]
    v_fma_f32 v203, v42, -v138, v203
    v_fma_f32 v203, v43, -v139, v203
    v_fma_f32 v203, v44, -v140, v203
    v_fma_f32 v203, v45, -v141, v203
    v_fma_f32 v203, v46, -v142, v203
    v_fma_f32 v203, v47, -v143, v203
    s_nop 1
    s_add_u32 m0, s21, 6144
    v_mfma_f32_32x32x16_bf16 v[48:63], v[68:71], v[176:179], v[48:63]
    buffer_load_dwordx4 v240, s[4:7], s36 offen  lds
    buffer_load_dwordx4 v241, s[8:11], s36 offen offset:1024  lds
    v_permlane32_swap_b32 v201, v203
    v_add_f32 v203, v201, v203
    s_set_gpr_idx_on s51, gpr_idx(DST)
    s_nop 0
    v_cvt_pk_bf16_f32 v204, v198, v199
    v_cvt_pk_bf16_f32 v205, v202, v203
    s_set_gpr_idx_off
    v_mfma_f32_32x32x16_bf16 v[16:31], v[72:75], v[180:183], 0
    v_mul_f32 v196, v0, v144
    v_fmac_f32 v196, v1, v145
    v_fmac_f32 v196, v2, v146
    v_fmac_f32 v196, v3, v147
    v_fmac_f32 v196, v4, v148
    v_fmac_f32 v196, v5, v149
    v_mfma_f32_32x32x16_bf16 v[32:47], v[76:79], v[180:183], 0
    v_add_u32 v253, s47, v248
    ds_read_b32 v254, v253
    ds_read_b32 v255, v253 offset:256
    v_fmac_f32 v196, v6, v150
    v_fmac_f32 v196, v7, v151
    v_mul_f32 v198, v8, v112
    v_mfma_f32_32x32x16_bf16 v[16:31], v[80:83], v[184:187], v[16:31]
    v_fmac_f32 v198, v9, v113
    v_fmac_f32 v198, v10, v114
    v_fmac_f32 v198, v11, v115
    v_fmac_f32 v198, v12, v116
    v_fmac_f32 v198, v13, v117
    v_fmac_f32 v198, v14, v118
    v_mfma_f32_32x32x16_bf16 v[32:47], v[84:87], v[184:187], v[32:47]
    v_fmac_f32 v198, v15, v119
    v_mul_f32_e64 v200, v48, -v160
    v_fma_f32 v200, v49, -v161, v200
    v_fma_f32 v200, v50, -v162, v200
    v_fma_f32 v200, v51, -v163, v200
    v_fma_f32 v200, v52, -v164, v200
    v_mfma_f32_32x32x16_bf16 v[16:31], v[88:91], v[188:191], v[16:31]
    v_fma_f32 v200, v53, -v165, v200
    v_fma_f32 v200, v54, -v166, v200
    v_fma_f32 v200, v55, -v167, v200
    v_mul_f32_e64 v202, v56, -v160
    v_fma_f32 v202, v57, -v161, v202
    v_fma_f32 v202, v58, -v162, v202
    v_mfma_f32_32x32x16_bf16 v[32:47], v[92:95], v[188:191], v[32:47]
    s_waitcnt vmcnt(6)
    ds_read_b64_tr_b16 v[176:177], v244 offset:0
    ds_read_b64_tr_b16 v[178:179], v244 offset:1024
    ds_read_b64_tr_b16 v[180:181], v245 offset:0
    ds_read_b64_tr_b16 v[182:183], v245 offset:1024
    v_fma_f32 v202, v59, -v163, v202
    v_fma_f32 v202, v60, -v164, v202
    v_mfma_f32_32x32x16_bf16 v[16:31], v[64:67], v[192:195], v[16:31]
    v_fma_f32 v202, v61, -v165, v202
    v_fma_f32 v202, v62, -v166, v202
    v_fma_f32 v202, v63, -v167, v202
    v_mfma_f32_32x32x16_bf16 v[32:47], v[68:71], v[192:195], v[32:47]
    s_waitcnt vmcnt(4) lgkmcnt(0)
    v_mfma_f32_32x32x16_bf16 v[0:15], v[72:75], v[176:179], 0
    s_nop 5
    v_mul_f32 v197, v16, v152
    v_fmac_f32 v197, v17, v153
    v_fmac_f32 v197, v18, v154
    v_fmac_f32 v197, v19, v155
    v_fmac_f32 v197, v20, v156
    v_fmac_f32 v197, v21, v157
    s_add_u32 m0, s21, 0
    v_mfma_f32_32x32x16_bf16 v[48:63], v[76:79], v[176:179], 0
    buffer_load_dwordx4 v234, s[4:7], s37 offen  lds
    buffer_load_dwordx4 v235, s[8:11], s37 offen offset:1024  lds
    ds_read_b64_tr_b16 v[176:177], v244 offset:2048
    ds_read_b64_tr_b16 v[178:179], v244 offset:3072
    ds_read_b64_tr_b16 v[184:185], v245 offset:2048
    ds_read_b64_tr_b16 v[186:187], v245 offset:3072
    v_add_u32 v252, s42, v247
    ds_read2_b32 v[234:235], v252 offset0:0 offset1:16
    s_mov_b32 m0, s76
    s_mov_b64 exec, s[72:73]
    buffer_load_dwordx4 v254, s[12:15], 0 offen  lds
    s_mov_b32 m0, s77
    s_mov_b64 exec, s[74:75]
    buffer_load_dwordx4 v255, s[12:15], 0 offen  lds
    s_mov_b64 exec, -1
    v_fmac_f32 v197, v22, v158
    v_fmac_f32 v197, v23, v159
    v_mul_f32 v199, v24, v120
    v_fmac_f32 v199, v25, v121
    v_fmac_f32 v199, v26, v122
    v_fmac_f32 v199, v27, v123
    s_waitcnt vmcnt(6) lgkmcnt(1)
    v_mfma_f32_32x32x16_bf16 v[0:15], v[80:83], v[176:179], v[0:15]
    v_fmac_f32 v199, v28, v124
    v_fmac_f32 v199, v29, v125
    v_fmac_f32 v199, v30, v126
    v_fmac_f32 v199, v31, v127
    v_mul_f32_e64 v201, v32, -v168
    v_fma_f32 v201, v33, -v169, v201
    s_add_u32 m0, s21, 2048
    v_mfma_f32_32x32x16_bf16 v[48:63], v[84:87], v[176:179], v[48:63]
    buffer_load_dwordx4 v236, s[4:7], s37 offen  lds
    buffer_load_dwordx4 v237, s[8:11], s37 offen offset:1024  lds
    ds_read_b64_tr_b16 v[176:177], v244 offset:4096
    ds_read_b64_tr_b16 v[178:179], v244 offset:5120
    ds_read_b64_tr_b16 v[188:189], v245 offset:4096
    ds_read_b64_tr_b16 v[190:191], v245 offset:5120
    v_add_u32 v252, s43, v247
    ds_read2_b32 v[236:237], v252 offset0:0 offset1:16
    s_waitcnt vmcnt(6) lgkmcnt(1)
    v_mfma_f32_32x32x16_bf16 v[0:15], v[88:91], v[176:179], v[0:15]
    v_fma_f32 v201, v34, -v170, v201
    v_fma_f32 v201, v35, -v171, v201
    v_fma_f32 v201, v36, -v172, v201
    v_fma_f32 v201, v37, -v173, v201
    v_fma_f32 v201, v38, -v174, v201
    v_fma_f32 v201, v39, -v175, v201
    s_add_u32 m0, s21, 4096
    v_mfma_f32_32x32x16_bf16 v[48:63], v[92:95], v[176:179], v[48:63]
    buffer_load_dwordx4 v238, s[4:7], s37 offen  lds
    buffer_load_dwordx4 v239, s[8:11], s37 offen offset:1024  lds
    ds_read_b64_tr_b16 v[176:177], v244 offset:6144
    ds_read_b64_tr_b16 v[178:179], v244 offset:7168
    ds_read_b64_tr_b16 v[192:193], v245 offset:6144
    ds_read_b64_tr_b16 v[194:195], v245 offset:7168
    v_add_u32 v252, s44, v247
    ds_read2_b32 v[238:239], v252 offset0:0 offset1:16
    s_waitcnt lgkmcnt(1)
    v_mfma_f32_32x32x16_bf16 v[0:15], v[64:67], v[176:179], v[0:15]
    v_mul_f32_e64 v203, v40, -v168
    v_fma_f32 v203, v41, -v169, v203
    v_fma_f32 v203, v42, -v170, v203
    v_fma_f32 v203, v43, -v171, v203
    v_fma_f32 v203, v44, -v172, v203
    v_fma_f32 v203, v45, -v173, v203
    s_add_u32 m0, s21, 6144
    v_mfma_f32_32x32x16_bf16 v[48:63], v[68:71], v[176:179], v[48:63]
    buffer_load_dwordx4 v240, s[4:7], s37 offen  lds
    buffer_load_dwordx4 v241, s[8:11], s37 offen offset:1024  lds
    v_add_u32 v252, s45, v247
    ds_read2_b32 v[240:241], v252 offset0:0 offset1:16
    v_fma_f32 v203, v46, -v174, v203
    v_fma_f32 v203, v47, -v175, v203
    v_mfma_f32_32x32x16_bf16 v[16:31], v[72:75], v[180:183], 0
    v_mul_f32 v254, v0, v144
    v_fmac_f32 v254, v1, v145
    v_fmac_f32 v254, v2, v146
    v_fmac_f32 v254, v3, v147
    v_fmac_f32 v254, v4, v148
    v_fmac_f32 v254, v5, v149
    v_mfma_f32_32x32x16_bf16 v[32:47], v[76:79], v[180:183], 0
    ds_swizzle_b32 v76, v76 offset:0x401F
    ds_swizzle_b32 v77, v77 offset:0x401F
    ds_swizzle_b32 v78, v78 offset:0x401F
    ds_swizzle_b32 v79, v79 offset:0x401F
    v_fmac_f32 v254, v6, v150
    v_fmac_f32 v254, v7, v151
    v_mfma_f32_32x32x16_bf16 v[16:31], v[80:83], v[184:187], v[16:31]
    v_fmac_f32 v200, v8, v160
    v_fmac_f32 v200, v9, v161
    v_permlane32_swap_b32 v196, v254
    v_fmac_f32 v200, v10, v162
    v_fmac_f32 v200, v11, v163
    v_fmac_f32 v200, v12, v164
    v_mfma_f32_32x32x16_bf16 v[32:47], v[84:87], v[184:187], v[32:47]
    ds_swizzle_b32 v84, v84 offset:0x401F
    ds_swizzle_b32 v85, v85 offset:0x401F
    ds_swizzle_b32 v86, v86 offset:0x401F
    ds_swizzle_b32 v87, v87 offset:0x401F
    v_fmac_f32 v200, v13, v165
    v_fmac_f32 v200, v14, v166
    v_mfma_f32_32x32x16_bf16 v[16:31], v[88:91], v[188:191], v[16:31]
    v_fmac_f32 v200, v15, v167
    v_add_f32 v254, v196, v254
    v_mfma_f32_32x32x16_bf16 v[32:47], v[92:95], v[188:191], v[32:47]
    ds_swizzle_b32 v92, v92 offset:0x401F
    ds_swizzle_b32 v93, v93 offset:0x401F
    ds_swizzle_b32 v94, v94 offset:0x401F
    ds_swizzle_b32 v95, v95 offset:0x401F
    s_waitcnt vmcnt(8)
    ds_read_b64_tr_b16 v[176:177], v244 offset:0
    ds_read_b64_tr_b16 v[178:179], v244 offset:1024
    ds_read_b64_tr_b16 v[180:181], v245 offset:0
    ds_read_b64_tr_b16 v[182:183], v245 offset:1024
    v_mfma_f32_32x32x16_bf16 v[16:31], v[64:67], v[192:195], v[16:31]
    v_mfma_f32_32x32x16_bf16 v[32:47], v[68:71], v[192:195], v[32:47]
    ds_swizzle_b32 v68, v68 offset:0x401F
    ds_swizzle_b32 v69, v69 offset:0x401F
    ds_swizzle_b32 v70, v70 offset:0x401F
    ds_swizzle_b32 v71, v71 offset:0x401F
    s_waitcnt lgkmcnt(8)
    s_mov_b64 exec, s[56:57]
    v_xor_b32 v76, 0x80008000, v76
    v_xor_b32 v77, 0x80008000, v77
    v_xor_b32 v78, 0x80008000, v78
    v_xor_b32 v79, 0x80008000, v79
    v_xor_b32 v84, 0x80008000, v84
    v_xor_b32 v85, 0x80008000, v85
    v_xor_b32 v86, 0x80008000, v86
    v_xor_b32 v87, 0x80008000, v87
    v_xor_b32 v92, 0x80008000, v92
    v_xor_b32 v93, 0x80008000, v93
    v_xor_b32 v94, 0x80008000, v94
    v_xor_b32 v95, 0x80008000, v95
    s_mov_b64 exec, -1
    s_waitcnt vmcnt(4) lgkmcnt(4)
    v_mfma_f32_32x32x16_bf16 v[0:15], v[72:75], v[176:179], 0
    v_mul_f32 v255, v16, v152
    v_fmac_f32 v255, v17, v153
    v_fmac_f32 v255, v18, v154
    v_fmac_f32 v255, v19, v155
    v_fmac_f32 v255, v20, v156
    v_fmac_f32 v255, v21, v157
    s_add_u32 m0, s21, 0
    v_mfma_f32_32x32x16_bf16 v[48:63], v[76:79], v[176:179], v[48:63]
    v_mad_u32_u16 v234, v234, s3, v246 op_sel:[1,0,0,0]
    v_mad_u32_u16 v235, v235, s3, v246 op_sel:[1,0,0,0]
    buffer_load_dwordx4 v234, s[4:7], s38 offen  lds
    buffer_load_dwordx4 v235, s[8:11], s38 offen offset:1024  lds
    ds_read_b64_tr_b16 v[176:177], v244 offset:2048
    ds_read_b64_tr_b16 v[178:179], v244 offset:3072
    ds_read_b64_tr_b16 v[184:185], v245 offset:2048
    ds_read_b64_tr_b16 v[186:187], v245 offset:3072
    s_waitcnt vmcnt(4) lgkmcnt(0)
    v_mfma_f32_32x32x16_bf16 v[0:15], v[80:83], v[176:179], v[0:15]
    s_add_u32 m0, s21, 2048
    v_mfma_f32_32x32x16_bf16 v[48:63], v[84:87], v[176:179], v[48:63]
    v_mad_u32_u16 v236, v236, s3, v246 op_sel:[1,0,0,0]
    v_mad_u32_u16 v237, v237, s3, v246 op_sel:[1,0,0,0]
    buffer_load_dwordx4 v236, s[4:7], s39 offen  lds
    buffer_load_dwordx4 v237, s[8:11], s39 offen offset:1024  lds
    ds_read_b64_tr_b16 v[176:177], v244 offset:4096
    ds_read_b64_tr_b16 v[178:179], v244 offset:5120
    ds_read_b64_tr_b16 v[188:189], v245 offset:4096
    ds_read_b64_tr_b16 v[190:191], v245 offset:5120
    s_waitcnt vmcnt(4) lgkmcnt(0)
    v_mfma_f32_32x32x16_bf16 v[0:15], v[88:91], v[176:179], v[0:15]
    v_fmac_f32 v255, v22, v158
    v_fmac_f32 v255, v23, v159
    v_fmac_f32 v201, v24, v168
    v_fmac_f32 v201, v25, v169
    v_permlane32_swap_b32 v197, v255
    s_add_u32 m0, s21, 4096
    v_mfma_f32_32x32x16_bf16 v[48:63], v[92:95], v[176:179], v[48:63]
    v_mad_u32_u16 v238, v238, s3, v246 op_sel:[1,0,0,0]
    v_mad_u32_u16 v239, v239, s3, v246 op_sel:[1,0,0,0]
    buffer_load_dwordx4 v238, s[4:7], s40 offen  lds
    buffer_load_dwordx4 v239, s[8:11], s40 offen offset:1024  lds
    ds_read_b64_tr_b16 v[176:177], v244 offset:6144
    ds_read_b64_tr_b16 v[178:179], v244 offset:7168
    ds_read_b64_tr_b16 v[192:193], v245 offset:6144
    ds_read_b64_tr_b16 v[194:195], v245 offset:7168
    s_waitcnt lgkmcnt(0)
    s_mov_b64 exec, s[56:57]
    v_xor_b32 v68, 0x80008000, v68
    v_xor_b32 v69, 0x80008000, v69
    v_xor_b32 v70, 0x80008000, v70
    v_xor_b32 v71, 0x80008000, v71
    s_mov_b64 exec, -1
    v_mfma_f32_32x32x16_bf16 v[0:15], v[64:67], v[176:179], v[0:15]
    v_fmac_f32 v201, v26, v170
    v_fmac_f32 v201, v27, v171
    v_fmac_f32 v201, v28, v172
    v_fmac_f32 v201, v29, v173
    v_fmac_f32 v201, v30, v174
    v_fmac_f32 v201, v31, v175
    s_add_u32 m0, s21, 6144
    v_mfma_f32_32x32x16_bf16 v[48:63], v[68:71], v[176:179], v[48:63]
    v_mad_u32_u16 v240, v240, s3, v246 op_sel:[1,0,0,0]
    v_mad_u32_u16 v241, v241, s3, v246 op_sel:[1,0,0,0]
    buffer_load_dwordx4 v240, s[4:7], s41 offen  lds
    buffer_load_dwordx4 v241, s[8:11], s41 offen offset:1024  lds
    v_add_f32 v255, v197, v255
    s_set_gpr_idx_on s51, gpr_idx(DST)
    s_nop 0
    v_cvt_pk_bf16_f32 v206, v254, v255
    s_set_gpr_idx_off
    v_mfma_f32_32x32x16_bf16 v[16:31], v[72:75], v[180:183], 0
    v_mul_f32 v254, v0, v144
    v_fmac_f32 v254, v1, v145
    v_fmac_f32 v254, v2, v146
    v_fmac_f32 v254, v3, v147
    v_fmac_f32 v254, v4, v148
    v_fmac_f32 v254, v5, v149
    v_mfma_f32_32x32x16_bf16 v[32:47], v[76:79], v[180:183], v[32:47]
    v_fmac_f32 v254, v6, v150
    v_fmac_f32 v254, v7, v151
    v_fma_f32 v202, v8, -v160, v202
    v_fma_f32 v202, v9, -v161, v202
    v_permlane32_swap_b32 v254, v200
    v_fma_f32 v202, v10, -v162, v202
    v_mfma_f32_32x32x16_bf16 v[16:31], v[80:83], v[184:187], v[16:31]
    v_fma_f32 v202, v11, -v163, v202
    v_fma_f32 v202, v12, -v164, v202
    v_fma_f32 v202, v13, -v165, v202
    v_fma_f32 v202, v14, -v166, v202
    v_fma_f32 v202, v15, -v167, v202
    v_add_f32 v200, v254, v200
    v_mfma_f32_32x32x16_bf16 v[32:47], v[84:87], v[184:187], v[32:47]
    v_fmac_f32 v198, v48, v112
    v_permlane32_swap_b32 v202, v254
    v_fmac_f32 v198, v49, v113
    v_fmac_f32 v198, v50, v114
    v_fmac_f32 v198, v51, v115
    v_fmac_f32 v198, v52, v116
    v_mfma_f32_32x32x16_bf16 v[16:31], v[88:91], v[188:191], v[16:31]
    v_fmac_f32 v198, v53, v117
    v_fmac_f32 v198, v54, v118
    v_fmac_f32 v198, v55, v119
    v_add_f32 v254, v202, v254
    v_mul_f32 v196, v56, v160
    v_fmac_f32 v196, v57, v161
    v_mfma_f32_32x32x16_bf16 v[32:47], v[92:95], v[188:191], v[32:47]
    s_waitcnt vmcnt(6)
    ds_read_b64_tr_b16 v[176:177], v244 offset:0
    ds_read_b64_tr_b16 v[178:179], v244 offset:1024
    ds_read_b64_tr_b16 v[180:181], v245 offset:0
    ds_read_b64_tr_b16 v[182:183], v245 offset:1024
    v_fmac_f32 v196, v58, v162
    v_fmac_f32 v196, v59, v163
    v_mfma_f32_32x32x16_bf16 v[16:31], v[64:67], v[192:195], v[16:31]
    v_fmac_f32 v196, v60, v164
    v_fmac_f32 v196, v61, v165
    v_fmac_f32 v196, v62, v166
    v_fmac_f32 v196, v63, v167
    s_nop 1
    v_permlane32_swap_b32 v198, v196
    v_add_f32 v196, v198, v196
    v_mfma_f32_32x32x16_bf16 v[32:47], v[68:71], v[192:195], v[32:47]
    v_add_u32 v249, s48, v249
    v_add_u32 v250, s49, v250
    s_nop 0
    v_mul_f32 v255, v16, v152
    v_fmac_f32 v255, v17, v153
    v_fmac_f32 v255, v18, v154
    v_fmac_f32 v255, v19, v155
    v_fmac_f32 v255, v20, v156
    v_fmac_f32 v255, v21, v157
    v_fmac_f32 v255, v22, v158
    v_fmac_f32 v255, v23, v159
    v_fma_f32 v203, v24, -v168, v203
    v_fma_f32 v203, v25, -v169, v203
    v_permlane32_swap_b32 v255, v201
    v_fma_f32 v203, v26, -v170, v203
    v_fma_f32 v203, v27, -v171, v203
    v_fma_f32 v203, v28, -v172, v203
    v_fma_f32 v203, v29, -v173, v203
    v_fma_f32 v203, v30, -v174, v203
    v_fma_f32 v203, v31, -v175, v203
    v_add_f32 v201, v255, v201
    v_fmac_f32 v199, v32, v120
    v_permlane32_swap_b32 v203, v255
    v_fmac_f32 v199, v33, v121
    v_fmac_f32 v199, v34, v122
    v_fmac_f32 v199, v35, v123
    ds_read_b64_tr_b16 v[72:73], v249 offset:0
    ds_read_b64_tr_b16 v[76:77], v249 offset:64
    ds_read_b64_tr_b16 v[74:75], v249 offset:256
    ds_read_b64_tr_b16 v[78:79], v249 offset:320
    s_mov_b64 exec, s[54:55]
    ds_read_u16_d16_hi v242, v250 offset:0
    s_mov_b64 exec, -1
    v_fmac_f32 v199, v36, v124
    v_fmac_f32 v199, v37, v125
    v_fmac_f32 v199, v38, v126
    v_fmac_f32 v199, v39, v127
    v_add_f32 v255, v203, v255
    v_mul_f32 v197, v40, v168
    v_fmac_f32 v197, v41, v169
    v_fmac_f32 v197, v42, v170
    v_fmac_f32 v197, v43, v171
    v_fmac_f32 v197, v44, v172
    v_fmac_f32 v197, v45, v173
    v_fmac_f32 v197, v46, v174
    v_fmac_f32 v197, v47, v175
    s_nop 1
    v_permlane32_swap_b32 v199, v197
    v_add_f32 v197, v199, v197
    s_set_gpr_idx_on s51, gpr_idx(DST)
    s_nop 0
    v_cvt_pk_bf16_f32 v207, v200, v201
    v_cvt_pk_bf16_f32 v209, v254, v255
    v_cvt_pk_bf16_f32 v208, v196, v197
    s_set_gpr_idx_off
    s_add_u32 s50, s50, 1
    s_add_u32 s51, s51, 6
    s_cmp_ge_u32 s50, 4
    s_cbranch_scc1 LAST0
    s_add_u32 s53, s53, 4
    s_xor_b32 s66, s53, s20
    s_bitcmp1_b32 s66, 2
    s_setprio 1
    s_cbranch_scc1 PRIO_9
    s_setprio 0
PRIO_9:
    s_cmp_eq_u32 s52, 4
    s_cbranch_scc1 ITEM_0_4
    s_cmp_eq_u32 s52, 5
    s_cbranch_scc1 ITEM_0_5
    s_cmp_eq_u32 s52, 3
    s_cbranch_scc1 ITEM_0_3
    s_cmp_eq_u32 s52, 6
    s_cbranch_scc1 ITEM_0_6
    s_cmp_eq_u32 s52, 8
    s_cbranch_scc1 ITEM_0_8
    s_branch ITEM_0_2
.p2align 6
ITEM_0_2:
    s_mov_b32 m0, s50
    s_nop 0
    s_movrels_b32 s71, s23
    s_bfe_u32 s46, s71, 0x30012
    s_mov_b32 m0, s46
    s_and_b32 s66, s71, 0x3ffff
    s_movrels_b32 s68, s57
    s_movrels_b32 s69, s61
    s_sub_u32 s48, s66, s47
    s_mov_b32 s47, s66
    s_lshr_b32 s52, s71, 28
    s_lshl_b32 s67, s46, 9
    s_add_u32 s66, s66, s67
    s_sub_u32 s49, s66, s42
    s_mov_b32 s42, s66
    s_bfe_u32 s66, s68, 655360
    s_add_u32 s43, s42, s66
    s_bfe_u32 s39, s69, 655360
    s_bfe_u32 s66, s68, 655370
    s_add_u32 s44, s42, s66
    s_bfe_u32 s40, s69, 655370
    s_bfe_u32 s66, s68, 655380
    s_add_u32 s45, s42, s66
    s_bfe_u32 s41, s69, 655380
    s_and_b32 s66, s46, s33
    s_cselect_b32 s72, -1, 1
    s_cselect_b32 s76, s47, 163712
    s_cmp_ge_u32 s66, 2
    s_cselect_b32 s73, -1, 0
    s_add_u32 s77, s47, 1024
    s_cmp_ge_u32 s66, 4
    s_cselect_b32 s75, -1, 0
    s_cmp_ge_u32 s66, 3
    s_cselect_b32 s74, -1, 1
    s_cselect_b32 s77, s77, 163712
    v_add_u32 v252, s42, v247
    ds_read2_b32 v[234:235], v252 offset0:0 offset1:16
    v_add_u32 v252, s43, v247
    ds_read2_b32 v[236:237], v252 offset0:0 offset1:16
    v_add_u32 v252, s44, v247
    ds_read2_b32 v[238:239], v252 offset0:0 offset1:16
    v_add_u32 v252, s45, v247
    ds_read2_b32 v[240:241], v252 offset0:0 offset1:16
    s_waitcnt lgkmcnt(4)
    v_mul_f32_dpp v196, v242, v72 row_newbcast:0 row_mask:0xf bank_mask:0xf
    v_mul_f32_dpp v197, v242, v73 row_newbcast:1 row_mask:0xf bank_mask:0xf
    v_mul_f32_dpp v198, v242, v72 row_newbcast:8 row_mask:0xf bank_mask:0xf
    v_mul_f32_dpp v199, v242, v73 row_newbcast:9 row_mask:0xf bank_mask:0xf
    v_mul_f32_dpp v200, v242, v76 row_newbcast:2 row_mask:0xf bank_mask:0xf
    v_mul_f32_dpp v201, v242, v77 row_newbcast:3 row_mask:0xf bank_mask:0xf
    v_mul_f32_dpp v202, v242, v76 row_newbcast:10 row_mask:0xf bank_mask:0xf
    v_mul_f32_dpp v203, v242, v77 row_newbcast:11 row_mask:0xf bank_mask:0xf
    v_cvt_pk_bf16_f32 v72, v196, v197
    v_cvt_pk_bf16_f32 v76, v198, v199
    v_cvt_pk_bf16_f32 v73, v200, v201
    v_cvt_pk_bf16_f32 v77, v202, v203
    v_mul_f32_dpp v196, v242, v74 row_newbcast:4 row_mask:0xf bank_mask:0xf
    v_mul_f32_dpp v197, v242, v75 row_newbcast:5 row_mask:0xf bank_mask:0xf
    v_mul_f32_dpp v198, v242, v74 row_newbcast:12 row_mask:0xf bank_mask:0xf
    v_mul_f32_dpp v199, v242, v75 row_newbcast:13 row_mask:0xf bank_mask:0xf
    v_mul_f32_dpp v200, v242, v78 row_newbcast:6 row_mask:0xf bank_mask:0xf
    v_mul_f32_dpp v201, v242, v79 row_newbcast:7 row_mask:0xf bank_mask:0xf
    v_mul_f32_dpp v202, v242, v78 row_newbcast:14 row_mask:0xf bank_mask:0xf
    v_mul_f32_dpp v203, v242, v79 row_newbcast:15 row_mask:0xf bank_mask:0xf
    v_cvt_pk_bf16_f32 v74, v196, v197
    v_cvt_pk_bf16_f32 v78, v198, v199
    v_cvt_pk_bf16_f32 v75, v200, v201
    v_cvt_pk_bf16_f32 v79, v202, v203
    s_nop 0
    s_waitcnt lgkmcnt(3)
    v_mfma_f32_32x32x16_bf16 v[56:71], v[72:75], v[176:179], 0
    s_add_u32 m0, s21, 0
    v_mfma_f32_32x32x16_bf16 v[16:31], v[76:79], v[176:179], 0
    v_mad_u32_u16 v234, v234, s3, v246 op_sel:[1,0,0,0]
    v_mad_u32_u16 v235, v235, s3, v246 op_sel:[1,0,0,0]
    buffer_load_dwordx4 v234, s[4:7], s38 offen  lds
    buffer_load_dwordx4 v235, s[8:11], s38 offen offset:1024  lds
    v_mfma_f32_32x32x16_bf16 v[32:47], v[72:75], v[180:183], 0
    s_nop 4
    v_mul_f32 v196, v56, v96
    v_fmac_f32 v196, v57, v97
    v_fmac_f32 v196, v58, v98
    v_fmac_f32 v196, v59, v99
    v_fmac_f32 v196, v60, v100
    v_fmac_f32 v196, v61, v101
    v_mfma_f32_32x32x16_bf16 v[0:15], v[76:79], v[180:183], 0
    s_waitcnt vmcnt(6)
    ds_read_b64_tr_b16 v[176:177], v244 offset:2048
    ds_read_b64_tr_b16 v[178:179], v244 offset:3072
    ds_read_b64_tr_b16 v[180:181], v245 offset:2048
    ds_read_b64_tr_b16 v[182:183], v245 offset:3072
    v_fmac_f32 v196, v62, v102
    v_fmac_f32 v196, v63, v103
    v_mul_f32 v198, v64, v128
    v_fmac_f32 v198, v65, v129
    v_fmac_f32 v198, v66, v130
    v_fmac_f32 v198, v67, v131
    v_fmac_f32 v198, v68, v132
    v_fmac_f32 v198, v69, v133
    v_fmac_f32 v198, v70, v134
    v_fmac_f32 v198, v71, v135
    v_mul_f32 v200, v16, v128
    v_fmac_f32 v200, v17, v129
    v_permlane32_swap_b32 v196, v198
    v_fmac_f32 v200, v18, v130
    v_fmac_f32 v200, v19, v131
    v_fmac_f32 v200, v20, v132
    v_fmac_f32 v200, v21, v133
    v_fmac_f32 v200, v22, v134
    v_fmac_f32 v200, v23, v135
    v_add_f32 v198, v196, v198
    v_mul_f32_e64 v202, v24, -v128
    v_fma_f32 v202, v25, -v129, v202
    v_fma_f32 v202, v26, -v130, v202
    v_fma_f32 v202, v27, -v131, v202
    v_fma_f32 v202, v28, -v132, v202
    v_fma_f32 v202, v29, -v133, v202
    v_fma_f32 v202, v30, -v134, v202
    v_fma_f32 v202, v31, -v135, v202
    s_nop 1
    v_permlane32_swap_b32 v200, v202
    v_add_f32 v202, v200, v202
    s_waitcnt lgkmcnt(0)
    v_mfma_f32_32x32x16_bf16 v[56:71], v[72:75], v[176:179], 0
    v_mul_f32 v197, v32, v104
    v_fmac_f32 v197, v33, v105
    v_fmac_f32 v197, v34, v106
    v_fmac_f32 v197, v35, v107
    v_fmac_f32 v197, v36, v108
    v_fmac_f32 v197, v37, v109
    s_add_u32 m0, s21, 2048
    v_mfma_f32_32x32x16_bf16 v[16:31], v[76:79], v[176:179], 0
    v_mad_u32_u16 v236, v236, s3, v246 op_sel:[1,0,0,0]
    v_mad_u32_u16 v237, v237, s3, v246 op_sel:[1,0,0,0]
    buffer_load_dwordx4 v236, s[4:7], s39 offen  lds
    buffer_load_dwordx4 v237, s[8:11], s39 offen offset:1024  lds
    v_fmac_f32 v197, v38, v110
    v_fmac_f32 v197, v39, v111
    v_mul_f32 v199, v40, v136
    v_fmac_f32 v199, v41, v137
    v_fmac_f32 v199, v42, v138
    v_fmac_f32 v199, v43, v139
    v_fmac_f32 v199, v44, v140
    v_fmac_f32 v199, v45, v141
    v_fmac_f32 v199, v46, v142
    v_fmac_f32 v199, v47, v143
    v_mul_f32 v201, v0, v136
    v_fmac_f32 v201, v1, v137
    v_permlane32_swap_b32 v197, v199
    v_fmac_f32 v201, v2, v138
    v_fmac_f32 v201, v3, v139
    v_fmac_f32 v201, v4, v140
    v_fmac_f32 v201, v5, v141
    v_fmac_f32 v201, v6, v142
    v_fmac_f32 v201, v7, v143
    v_add_f32 v199, v197, v199
    v_mul_f32_e64 v203, v8, -v136
    v_fma_f32 v203, v9, -v137, v203
    v_fma_f32 v203, v10, -v138, v203
    v_fma_f32 v203, v11, -v139, v203
    v_fma_f32 v203, v12, -v140, v203
    v_fma_f32 v203, v13, -v141, v203
    v_fma_f32 v203, v14, -v142, v203
    v_fma_f32 v203, v15, -v143, v203
    s_nop 1
    v_permlane32_swap_b32 v201, v203
    v_add_f32 v203, v201, v203
    s_set_gpr_idx_on s51, gpr_idx(DST)
    s_nop 0
    v_cvt_pk_bf16_f32 v204, v198, v199
    v_cvt_pk_bf16_f32 v205, v202, v203
    s_set_gpr_idx_off
    v_mfma_f32_32x32x16_bf16 v[32:47], v[72:75], v[180:183], 0
    v_mul_f32 v196, v56, v144
    v_fmac_f32 v196, v57, v145
    v_fmac_f32 v196, v58, v146
    v_fmac_f32 v196, v59, v147
    v_fmac_f32 v196, v60, v148
    v_fmac_f32 v196, v61, v149
    v_mfma_f32_32x32x16_bf16 v[0:15], v[76:79], v[180:183], 0
    s_waitcnt vmcnt(6)
    ds_read_b64_tr_b16 v[176:177], v244 offset:4096
    ds_read_b64_tr_b16 v[178:179], v244 offset:5120
    ds_read_b64_tr_b16 v[180:181], v245 offset:4096
    ds_read_b64_tr_b16 v[182:183], v245 offset:5120
    v_fmac_f32 v196, v62, v150
    v_fmac_f32 v196, v63, v151
    v_mul_f32_e64 v200, v16, -v160
    v_fma_f32 v200, v17, -v161, v200
    v_fma_f32 v200, v18, -v162, v200
    v_fma_f32 v200, v19, -v163, v200
    v_fma_f32 v200, v20, -v164, v200
    v_fma_f32 v200, v21, -v165, v200
    v_fma_f32 v200, v22, -v166, v200
    v_fma_f32 v200, v23, -v167, v200
    v_mul_f32_e64 v202, v24, -v160
    v_fma_f32 v202, v25, -v161, v202
    v_fma_f32 v202, v26, -v162, v202
    v_fma_f32 v202, v27, -v163, v202
    v_fma_f32 v202, v28, -v164, v202
    v_fma_f32 v202, v29, -v165, v202
    v_fma_f32 v202, v30, -v166, v202
    v_fma_f32 v202, v31, -v167, v202
    s_waitcnt lgkmcnt(0)
    v_mfma_f32_32x32x16_bf16 v[16:31], v[72:75], v[176:179], 0
    v_mul_f32 v197, v32, v152
    v_fmac_f32 v197, v33, v153
    v_fmac_f32 v197, v34, v154
    v_fmac_f32 v197, v35, v155
    v_fmac_f32 v197, v36, v156
    v_fmac_f32 v197, v37, v157
    s_add_u32 m0, s21, 4096
    v_mfma_f32_32x32x16_bf16 v[48:63], v[76:79], v[176:179], 0
    v_mad_u32_u16 v238, v238, s3, v246 op_sel:[1,0,0,0]
    v_mad_u32_u16 v239, v239, s3, v246 op_sel:[1,0,0,0]
    buffer_load_dwordx4 v238, s[4:7], s40 offen  lds
    buffer_load_dwordx4 v239, s[8:11], s40 offen offset:1024  lds
    v_fmac_f32 v197, v38, v158
    v_fmac_f32 v197, v39, v159
    v_mul_f32_e64 v201, v0, -v168
    v_fma_f32 v201, v1, -v169, v201
    v_fma_f32 v201, v2, -v170, v201
    v_fma_f32 v201, v3, -v171, v201
    v_fma_f32 v201, v4, -v172, v201
    v_fma_f32 v201, v5, -v173, v201
    v_fma_f32 v201, v6, -v174, v201
    v_fma_f32 v201, v7, -v175, v201
    v_mul_f32_e64 v203, v8, -v168
    v_fma_f32 v203, v9, -v169, v203
    v_fma_f32 v203, v10, -v170, v203
    v_fma_f32 v203, v11, -v171, v203
    v_fma_f32 v203, v12, -v172, v203
    v_fma_f32 v203, v13, -v173, v203
    v_fma_f32 v203, v14, -v174, v203
    v_fma_f32 v203, v15, -v175, v203
    v_mfma_f32_32x32x16_bf16 v[0:15], v[72:75], v[180:183], 0
    v_fmac_f32 v200, v24, v160
    v_fmac_f32 v200, v25, v161
    v_fmac_f32 v200, v26, v162
    v_fmac_f32 v200, v27, v163
    v_fmac_f32 v200, v28, v164
    v_fmac_f32 v200, v29, v165
    v_fmac_f32 v200, v30, v166
    v_fmac_f32 v200, v31, v167
    v_mfma_f32_32x32x16_bf16 v[24:39], v[76:79], v[180:183], 0
    v_add_u32 v253, s47, v248
    ds_read_b32 v192, v253
    ds_read_b32 v193, v253 offset:256
    s_waitcnt vmcnt(6)
    ds_read_b64_tr_b16 v[176:177], v244 offset:6144
    ds_read_b64_tr_b16 v[178:179], v244 offset:7168
    ds_read_b64_tr_b16 v[180:181], v245 offset:6144
    ds_read_b64_tr_b16 v[182:183], v245 offset:7168
    v_mul_f32 v254, v16, v144
    v_fmac_f32 v254, v17, v145
    v_fmac_f32 v254, v18, v146
    v_fmac_f32 v254, v19, v147
    v_fmac_f32 v254, v20, v148
    v_fmac_f32 v254, v21, v149
    v_fmac_f32 v254, v22, v150
    v_fmac_f32 v254, v23, v151
    v_sub_f32_e64 v64, -v48, v64
    v_sub_f32_e64 v65, -v49, v65
    v_permlane32_swap_b32 v196, v254
    v_sub_f32_e64 v66, -v50, v66
    v_sub_f32_e64 v67, -v51, v67
    v_sub_f32_e64 v68, -v52, v68
    v_sub_f32_e64 v69, -v53, v69
    v_sub_f32_e64 v70, -v54, v70
    v_sub_f32_e64 v71, -v55, v71
    v_add_f32 v254, v196, v254
    s_waitcnt lgkmcnt(0)
    v_mfma_f32_32x32x16_bf16 v[56:71], v[76:79], v[176:179], v[56:71]
    v_sub_f32_e64 v40, -v24, v40
    v_sub_f32_e64 v41, -v25, v41
    v_sub_f32_e64 v42, -v26, v42
    v_sub_f32_e64 v43, -v27, v43
    v_sub_f32_e64 v44, -v28, v44
    v_sub_f32_e64 v45, -v29, v45
    v_sub_f32_e64 v46, -v30, v46
    v_sub_f32_e64 v47, -v31, v47
    s_mov_b32 m0, s76
    s_mov_b64 exec, s[72:73]
    buffer_load_dwordx4 v192, s[12:15], 0 offen  lds
    s_mov_b32 m0, s77
    s_mov_b64 exec, s[74:75]
    buffer_load_dwordx4 v193, s[12:15], 0 offen  lds
    s_mov_b64 exec, -1
    s_add_u32 m0, s21, 6144
    v_mfma_f32_32x32x16_bf16 v[16:31], v[72:75], v[176:179], 0
    v_mad_u32_u16 v240, v240, s3, v246 op_sel:[1,0,0,0]
    v_mad_u32_u16 v241, v241, s3, v246 op_sel:[1,0,0,0]
    buffer_load_dwordx4 v240, s[4:7], s41 offen  lds
    buffer_load_dwordx4 v241, s[8:11], s41 offen offset:1024  lds
    v_mul_f32 v255, v0, v152
    v_fmac_f32 v255, v1, v153
    v_fmac_f32 v255, v2, v154
    v_fmac_f32 v255, v3, v155
    v_fmac_f32 v255, v4, v156
    v_fmac_f32 v255, v5, v157
    v_fmac_f32 v255, v6, v158
    v_fmac_f32 v255, v7, v159
    v_fmac_f32 v201, v8, v168
    v_fmac_f32 v201, v9, v169
    v_permlane32_swap_b32 v197, v255
    v_fmac_f32 v201, v10, v170
    v_fmac_f32 v201, v11, v171
    v_fmac_f32 v201, v12, v172
    v_fmac_f32 v201, v13, v173
    v_fmac_f32 v201, v14, v174
    v_fmac_f32 v201, v15, v175
    v_add_f32 v255, v197, v255
    s_set_gpr_idx_on s51, gpr_idx(DST)
    s_nop 0
    v_cvt_pk_bf16_f32 v206, v254, v255
    s_set_gpr_idx_off
    v_mfma_f32_32x32x16_bf16 v[0:15], v[72:75], v[180:183], 0
    v_mul_f32 v254, v16, v144
    v_fmac_f32 v254, v17, v145
    v_fmac_f32 v254, v18, v146
    v_fmac_f32 v254, v19, v147
    v_fmac_f32 v254, v20, v148
    v_fmac_f32 v254, v21, v149
    v_mfma_f32_32x32x16_bf16 v[32:47], v[76:79], v[180:183], v[32:47]
    s_waitcnt vmcnt(8)
    ds_read_b64_tr_b16 v[176:177], v244 offset:0
    ds_read_b64_tr_b16 v[178:179], v244 offset:1024
    ds_read_b64_tr_b16 v[180:181], v245 offset:0
    ds_read_b64_tr_b16 v[182:183], v245 offset:1024
    v_add_u32 v249, s48, v249
    v_add_u32 v250, s49, v250
    v_fmac_f32 v254, v22, v150
    v_fmac_f32 v254, v23, v151
    v_fma_f32 v202, v24, -v160, v202
    v_fma_f32 v202, v25, -v161, v202
    v_permlane32_swap_b32 v254, v200
    v_fma_f32 v202, v26, -v162, v202
    v_fma_f32 v202, v27, -v163, v202
    v_fma_f32 v202, v28, -v164, v202
    v_fma_f32 v202, v29, -v165, v202
    v_fma_f32 v202, v30, -v166, v202
    v_fma_f32 v202, v31, -v167, v202
    v_add_f32 v200, v254, v200
    v_mul_f32_e64 v198, v64, -v112
    v_permlane32_swap_b32 v202, v254
    v_fma_f32 v198, v65, -v113, v198
    v_fma_f32 v198, v66, -v114, v198
    v_fma_f32 v198, v67, -v115, v198
    v_fma_f32 v198, v68, -v116, v198
    v_fma_f32 v198, v69, -v117, v198
    v_fma_f32 v198, v70, -v118, v198
    v_fma_f32 v198, v71, -v119, v198
    v_add_f32 v254, v202, v254
    v_mul_f32 v196, v56, v160
    v_fmac_f32 v196, v57, v161
    v_fmac_f32 v196, v58, v162
    v_fmac_f32 v196, v59, v163
    v_fmac_f32 v196, v60, v164
    v_fmac_f32 v196, v61, v165
    v_fmac_f32 v196, v62, v166
    v_fmac_f32 v196, v63, v167
    s_nop 1
    v_permlane32_swap_b32 v198, v196
    v_add_f32 v196, v198, v196
    v_mul_f32 v255, v0, v152
    v_fmac_f32 v255, v1, v153
    v_fmac_f32 v255, v2, v154
    v_fmac_f32 v255, v3, v155
    v_fmac_f32 v255, v4, v156
    v_fmac_f32 v255, v5, v157
    v_fmac_f32 v255, v6, v158
    v_fmac_f32 v255, v7, v159
    v_fma_f32 v203, v8, -v168, v203
    v_fma_f32 v203, v9, -v169, v203
    v_permlane32_swap_b32 v255, v201
    v_fma_f32 v203, v10, -v170, v203
    v_fma_f32 v203, v11, -v171, v203
    v_fma_f32 v203, v12, -v172, v203
    v_fma_f32 v203, v13, -v173, v203
    v_fma_f32 v203, v14, -v174, v203
    v_fma_f32 v203, v15, -v175, v203
    v_add_f32 v201, v255, v201
    v_mul_f32_e64 v199, v40, -v120
    v_permlane32_swap_b32 v203, v255
    v_fma_f32 v199, v41, -v121, v199
    v_fma_f32 v199, v42, -v122, v199
    v_fma_f32 v199, v43, -v123, v199
    s_waitcnt vmcnt(2)
    ds_read_b64_tr_b16 v[72:73], v249 offset:0
    ds_read_b64_tr_b16 v[76:77], v249 offset:64
    ds_read_b64_tr_b16 v[74:75], v249 offset:256
    ds_read_b64_tr_b16 v[78:79], v249 offset:320
    s_mov_b64 exec, s[54:55]
    ds_read_u16_d16_hi v242, v250 offset:0
    s_mov_b64 exec, -1
    v_fma_f32 v199, v44, -v124, v199
    v_fma_f32 v199, v45, -v125, v199
    v_fma_f32 v199, v46, -v126, v199
    v_fma_f32 v199, v47, -v127, v199
    v_add_f32 v255, v203, v255
    v_mul_f32 v197, v32, v168
    v_fmac_f32 v197, v33, v169
    v_fmac_f32 v197, v34, v170
    v_fmac_f32 v197, v35, v171
    v_fmac_f32 v197, v36, v172
    v_fmac_f32 v197, v37, v173
    v_fmac_f32 v197, v38, v174
    v_fmac_f32 v197, v39, v175
    s_nop 1
    v_permlane32_swap_b32 v199, v197
    v_add_f32 v197, v199, v197
    s_set_gpr_idx_on s51, gpr_idx(DST)
    s_nop 0
    v_cvt_pk_bf16_f32 v207, v200, v201
    v_cvt_pk_bf16_f32 v209, v254, v255
    v_cvt_pk_bf16_f32 v208, v196, v197
    s_set_gpr_idx_off
    s_add_u32 s50, s50, 1
    s_add_u32 s51, s51, 6
    s_cmp_ge_u32 s50, 4
    s_cbranch_scc1 LAST0
    s_add_u32 s53, s53, 4
    s_xor_b32 s66, s53, s20
    s_bitcmp1_b32 s66, 2
    s_setprio 1
    s_cbranch_scc1 PRIO_10
    s_setprio 0
PRIO_10:
    s_cmp_eq_u32 s52, 4
    s_cbranch_scc1 ITEM_0_4
    s_cmp_eq_u32 s52, 5
    s_cbranch_scc1 ITEM_0_5
    s_cmp_eq_u32 s52, 3
    s_cbranch_scc1 ITEM_0_3
    s_cmp_eq_u32 s52, 6
    s_cbranch_scc1 ITEM_0_6
    s_cmp_eq_u32 s52, 8
    s_cbranch_scc1 ITEM_0_8
    s_branch ITEM_0_2
.p2align 6
ITEM_1_4:
    s_mov_b64 exec, s[54:55]
    ds_read_u16_d16_hi v243, v250 offset:128
    s_mov_b64 exec, -1
    ds_read_b64_tr_b16 v[80:81], v249 offset:512
    ds_read_b64_tr_b16 v[84:85], v249 offset:576
    ds_read_b64_tr_b16 v[82:83], v249 offset:768
    ds_read_b64_tr_b16 v[86:87], v249 offset:832
    s_waitcnt lgkmcnt(5)
    v_mul_f32_dpp v196, v242, v72 row_newbcast:0 row_mask:0xf bank_mask:0xf
    v_mul_f32_dpp v197, v242, v73 row_newbcast:1 row_mask:0xf bank_mask:0xf
    v_mul_f32_dpp v198, v242, v72 row_newbcast:8 row_mask:0xf bank_mask:0xf
    v_mul_f32_dpp v199, v242, v73 row_newbcast:9 row_mask:0xf bank_mask:0xf
    v_mul_f32_dpp v200, v242, v76 row_newbcast:2 row_mask:0xf bank_mask:0xf
    v_mul_f32_dpp v201, v242, v77 row_newbcast:3 row_mask:0xf bank_mask:0xf
    v_mul_f32_dpp v202, v242, v76 row_newbcast:10 row_mask:0xf bank_mask:0xf
    v_mul_f32_dpp v203, v242, v77 row_newbcast:11 row_mask:0xf bank_mask:0xf
    v_cvt_pk_bf16_f32 v72, v196, v197
    v_cvt_pk_bf16_f32 v76, v198, v199
    v_cvt_pk_bf16_f32 v73, v200, v201
    v_cvt_pk_bf16_f32 v77, v202, v203
    v_mul_f32_dpp v196, v242, v74 row_newbcast:4 row_mask:0xf bank_mask:0xf
    v_mul_f32_dpp v197, v242, v75 row_newbcast:5 row_mask:0xf bank_mask:0xf
    v_mul_f32_dpp v198, v242, v74 row_newbcast:12 row_mask:0xf bank_mask:0xf
    v_mul_f32_dpp v199, v242, v75 row_newbcast:13 row_mask:0xf bank_mask:0xf
    v_mul_f32_dpp v200, v242, v78 row_newbcast:6 row_mask:0xf bank_mask:0xf
    v_mul_f32_dpp v201, v242, v79 row_newbcast:7 row_mask:0xf bank_mask:0xf
    v_mul_f32_dpp v202, v242, v78 row_newbcast:14 row_mask:0xf bank_mask:0xf
    v_mul_f32_dpp v203, v242, v79 row_newbcast:15 row_mask:0xf bank_mask:0xf
    v_cvt_pk_bf16_f32 v74, v196, v197
    v_cvt_pk_bf16_f32 v78, v198, v199
    v_cvt_pk_bf16_f32 v75, v200, v201
    v_cvt_pk_bf16_f32 v79, v202, v203
    s_waitcnt vmcnt(4) lgkmcnt(0)
    v_mfma_f32_32x32x16_bf16 v[56:71], v[72:75], v[176:179], 0
    v_mul_f32_dpp v196, v243, v80 row_newbcast:0 row_mask:0xf bank_mask:0xf
    v_mul_f32_dpp v197, v243, v81 row_newbcast:1 row_mask:0xf bank_mask:0xf
    v_mul_f32_dpp v198, v243, v80 row_newbcast:8 row_mask:0xf bank_mask:0xf
    v_mul_f32_dpp v199, v243, v81 row_newbcast:9 row_mask:0xf bank_mask:0xf
    v_mul_f32_dpp v200, v243, v84 row_newbcast:2 row_mask:0xf bank_mask:0xf
    v_mul_f32_dpp v201, v243, v85 row_newbcast:3 row_mask:0xf bank_mask:0xf
    s_add_u32 m0, s21, 0
    v_mfma_f32_32x32x16_bf16 v[16:31], v[76:79], v[176:179], 0
    buffer_load_dwordx4 v234, s[4:7], s36 offen  lds
    buffer_load_dwordx4 v235, s[8:11], s36 offen offset:1024  lds
    ds_read_b64_tr_b16 v[176:177], v244 offset:2048
    ds_read_b64_tr_b16 v[178:179], v244 offset:3072
    ds_read_b64_tr_b16 v[184:185], v245 offset:2048
    ds_read_b64_tr_b16 v[186:187], v245 offset:3072
    v_mul_f32_dpp v202, v243, v84 row_newbcast:10 row_mask:0xf bank_mask:0xf
    v_mul_f32_dpp v203, v243, v85 row_newbcast:11 row_mask:0xf bank_mask:0xf
    v_cvt_pk_bf16_f32 v80, v196, v197
    v_cvt_pk_bf16_f32 v84, v198, v199
    v_cvt_pk_bf16_f32 v81, v200, v201
    v_cvt_pk_bf16_f32 v85, v202, v203
    v_mul_f32_dpp v196, v243, v82 row_newbcast:4 row_mask:0xf bank_mask:0xf
    v_mul_f32_dpp v197, v243, v83 row_newbcast:5 row_mask:0xf bank_mask:0xf
    v_mul_f32_dpp v198, v243, v82 row_newbcast:12 row_mask:0xf bank_mask:0xf
    v_mul_f32_dpp v199, v243, v83 row_newbcast:13 row_mask:0xf bank_mask:0xf
    v_mul_f32_dpp v200, v243, v86 row_newbcast:6 row_mask:0xf bank_mask:0xf
    v_mul_f32_dpp v201, v243, v87 row_newbcast:7 row_mask:0xf bank_mask:0xf
    v_mul_f32_dpp v202, v243, v86 row_newbcast:14 row_mask:0xf bank_mask:0xf
    v_mul_f32_dpp v203, v243, v87 row_newbcast:15 row_mask:0xf bank_mask:0xf
    v_cvt_pk_bf16_f32 v82, v196, v197
    v_cvt_pk_bf16_f32 v86, v198, v199
    v_cvt_pk_bf16_f32 v83, v200, v201
    v_cvt_pk_bf16_f32 v87, v202, v203
    s_waitcnt lgkmcnt(0)
    v_mfma_f32_32x32x16_bf16 v[56:71], v[80:83], v[176:179], v[56:71]
    s_add_u32 m0, s21, 2048
    v_mfma_f32_32x32x16_bf16 v[16:31], v[84:87], v[176:179], v[16:31]
    buffer_load_dwordx4 v236, s[4:7], s36 offen  lds
    buffer_load_dwordx4 v237, s[8:11], s36 offen offset:1024  lds
    s_mov_b32 m0, s50
    s_nop 0
    s_movrels_b32 s71, s23
    s_movrels_b32 s33, s28
    v_add_u32 v253, s33, v248
    s_bfe_u32 s46, s71, 0x30012
    s_mov_b32 m0, s46
    s_and_b32 s66, s71, 0x3ffff
    s_movrels_b32 s68, s57
    s_movrels_b32 s69, s61
    s_sub_u32 s48, s66, s47
    s_mov_b32 s47, s66
    s_lshr_b32 s52, s71, 28
    s_lshl_b32 s67, s46, 9
    s_add_u32 s66, s66, s67
    s_sub_u32 s49, s66, s42
    s_mov_b32 s42, s66
    s_bfe_u32 s66, s68, 655360
    s_add_u32 s43, s42, s66
    s_bfe_u32 s39, s69, 655360
    s_bfe_u32 s66, s68, 655370
    s_add_u32 s44, s42, s66
    s_bfe_u32 s40, s69, 655370
    s_bfe_u32 s66, s68, 655380
    s_add_u32 s45, s42, s66
    s_bfe_u32 s41, s69, 655380
    v_add_u32 v252, s44, v247
    ds_read2_b32 v[238:239], v252 offset0:0 offset1:16
    v_add_u32 v252, s45, v247
    ds_read2_b32 v[240:241], v252 offset0:0 offset1:16
    v_mfma_f32_32x32x16_bf16 v[32:47], v[72:75], v[180:183], 0
    v_mul_f32 v196, v56, v96
    v_fmac_f32 v196, v57, v97
    v_fmac_f32 v196, v58, v98
    v_fmac_f32 v196, v59, v99
    v_fmac_f32 v196, v60, v100
    v_fmac_f32 v196, v61, v101
    v_mfma_f32_32x32x16_bf16 v[0:15], v[76:79], v[180:183], 0
    s_waitcnt vmcnt(6)
    ds_read_b64_tr_b16 v[176:177], v244 offset:4096
    ds_read_b64_tr_b16 v[178:179], v244 offset:5120
    ds_read_b64_tr_b16 v[180:181], v245 offset:4096
    ds_read_b64_tr_b16 v[182:183], v245 offset:5120
    v_fmac_f32 v196, v62, v102
    v_fmac_f32 v196, v63, v103
    v_mfma_f32_32x32x16_bf16 v[32:47], v[80:83], v[184:187], v[32:47]
    v_mul_f32 v198, v64, v128
    v_fmac_f32 v198, v65, v129
    v_fmac_f32 v198, v66, v130
    v_fmac_f32 v198, v67, v131
    v_fmac_f32 v198, v68, v132
    v_fmac_f32 v198, v69, v133
    v_mfma_f32_32x32x16_bf16 v[0:15], v[84:87], v[184:187], v[0:15]
    v_fmac_f32 v198, v70, v134
    v_fmac_f32 v198, v71, v135
    v_mul_f32 v200, v16, v128
    v_fmac_f32 v200, v17, v129
    v_permlane32_swap_b32 v196, v198
    v_fmac_f32 v200, v18, v130
    v_fmac_f32 v200, v19, v131
    v_fmac_f32 v200, v20, v132
    v_fmac_f32 v200, v21, v133
    v_fmac_f32 v200, v22, v134
    v_fmac_f32 v200, v23, v135
    v_add_f32 v198, v196, v198
    v_mul_f32_e64 v202, v24, -v128
    v_fma_f32 v202, v25, -v129, v202
    v_fma_f32 v202, v26, -v130, v202
    v_fma_f32 v202, v27, -v131, v202
    v_fma_f32 v202, v28, -v132, v202
    v_fma_f32 v202, v29, -v133, v202
    v_fma_f32 v202, v30, -v134, v202
    v_fma_f32 v202, v31, -v135, v202
    s_nop 1
    v_permlane32_swap_b32 v200, v202
    v_add_f32 v202, v200, v202
    s_waitcnt vmcnt(4) lgkmcnt(0)
    v_mfma_f32_32x32x16_bf16 v[56:71], v[72:75], v[176:179], 0
    v_mul_f32 v197, v32, v104
    v_fmac_f32 v197, v33, v105
    v_fmac_f32 v197, v34, v106
    v_fmac_f32 v197, v35, v107
    v_fmac_f32 v197, v36, v108
    v_fmac_f32 v197, v37, v109
    s_add_u32 m0, s21, 4096
    v_mfma_f32_32x32x16_bf16 v[16:31], v[76:79], v[176:179], 0
    buffer_load_dwordx4 v234, s[4:7], s37 offen  lds
    buffer_load_dwordx4 v235, s[8:11], s37 offen offset:1024  lds
    ds_read_b64_tr_b16 v[176:177], v244 offset:6144
    ds_read_b64_tr_b16 v[178:179], v244 offset:7168
    ds_read_b64_tr_b16 v[184:185], v245 offset:6144
    ds_read_b64_tr_b16 v[186:187], v245 offset:7168
    v_add_u32 v252, s42, v247
    ds_read2_b32 v[234:235], v252 offset0:0 offset1:16
    v_fmac_f32 v197, v38, v110
    v_fmac_f32 v197, v39, v111
    v_mul_f32 v199, v40, v136
    v_fmac_f32 v199, v41, v137
    v_fmac_f32 v199, v42, v138
    v_fmac_f32 v199, v43, v139
    v_fmac_f32 v199, v44, v140
    v_fmac_f32 v199, v45, v141
    v_fmac_f32 v199, v46, v142
    v_fmac_f32 v199, v47, v143
    v_mul_f32 v201, v0, v136
    v_fmac_f32 v201, v1, v137
    v_permlane32_swap_b32 v197, v199
    v_fmac_f32 v201, v2, v138
    v_fmac_f32 v201, v3, v139
    v_fmac_f32 v201, v4, v140
    v_fmac_f32 v201, v5, v141
    v_fmac_f32 v201, v6, v142
    v_fmac_f32 v201, v7, v143
    v_add_f32 v199, v197, v199
    v_mul_f32_e64 v203, v8, -v136
    v_fma_f32 v203, v9, -v137, v203
    v_fma_f32 v203, v10, -v138, v203
    v_fma_f32 v203, v11, -v139, v203
    s_waitcnt lgkmcnt(1)
    v_mfma_f32_32x32x16_bf16 v[56:71], v[80:83], v[176:179], v[56:71]
    v_fma_f32 v203, v12, -v140, v203
    v_fma_f32 v203, v13, -v141, v203
    v_fma_f32 v203, v14, -v142, v203
    v_fma_f32 v203, v15, -v143, v203
    s_nop 1
    v_permlane32_swap_b32 v201, v203
    v_add_f32 v203, v201, v203
    s_add_u32 m0, s21, 6144
    v_mfma_f32_32x32x16_bf16 v[16:31], v[84:87], v[176:179], v[16:31]
    buffer_load_dwordx4 v236, s[4:7], s37 offen  lds
    buffer_load_dwordx4 v237, s[8:11], s37 offen offset:1024  lds
    v_add_u32 v252, s43, v247
    ds_read2_b32 v[236:237], v252 offset0:0 offset1:16
    v_cvt_pk_bf16_f32 v192, v198, v199
    v_cvt_pk_bf16_f32 v193, v202, v203
    v_mfma_f32_32x32x16_bf16 v[32:47], v[72:75], v[180:183], 0
    v_mul_f32 v196, v56, v144
    v_fmac_f32 v196, v57, v145
    v_fmac_f32 v196, v58, v146
    v_fmac_f32 v196, v59, v147
    v_fmac_f32 v196, v60, v148
    v_fmac_f32 v196, v61, v149
    v_mfma_f32_32x32x16_bf16 v[0:15], v[76:79], v[180:183], 0
    s_waitcnt vmcnt(6)
    ds_read_b64_tr_b16 v[176:177], v244 offset:0
    ds_read_b64_tr_b16 v[178:179], v244 offset:1024
    ds_read_b64_tr_b16 v[180:181], v245 offset:0
    ds_read_b64_tr_b16 v[182:183], v245 offset:1024
    v_fmac_f32 v196, v62, v150
    v_fmac_f32 v196, v63, v151
    v_mfma_f32_32x32x16_bf16 v[32:47], v[80:83], v[184:187], v[32:47]
    v_mul_f32_e64 v200, v16, -v160
    v_fma_f32 v200, v17, -v161, v200
    v_fma_f32 v200, v18, -v162, v200
    v_fma_f32 v200, v19, -v163, v200
    v_fma_f32 v200, v20, -v164, v200
    v_fma_f32 v200, v21, -v165, v200
    v_mfma_f32_32x32x16_bf16 v[0:15], v[84:87], v[184:187], v[0:15]
    v_fma_f32 v200, v22, -v166, v200
    v_fma_f32 v200, v23, -v167, v200
    v_mul_f32_e64 v202, v24, -v160
    v_fma_f32 v202, v25, -v161, v202
    v_fma_f32 v202, v26, -v162, v202
    v_fma_f32 v202, v27, -v163, v202
    v_fma_f32 v202, v28, -v164, v202
    v_fma_f32 v202, v29, -v165, v202
    v_fma_f32 v202, v30, -v166, v202
    v_fma_f32 v202, v31, -v167, v202
    s_waitcnt vmcnt(4) lgkmcnt(0)
    v_mfma_f32_32x32x16_bf16 v[16:31], v[72:75], v[176:179], 0
    v_mul_f32 v197, v32, v152
    v_fmac_f32 v197, v33, v153
    v_fmac_f32 v197, v34, v154
    v_fmac_f32 v197, v35, v155
    v_fmac_f32 v197, v36, v156
    v_fmac_f32 v197, v37, v157
    s_add_u32 m0, s21, 0
    v_mfma_f32_32x32x16_bf16 v[48:63], v[76:79], v[176:179], 0
    s_cbranch_vccnz WL_4_0
    v_mad_u32_u16 v234, v234, s3, v246 op_sel:[1,0,0,0]
    v_mad_u32_u16 v235, v235, s3, v246 op_sel:[1,0,0,0]
    buffer_load_dwordx4 v234, s[4:7], s38 offen  lds
    buffer_load_dwordx4 v235, s[8:11], s38 offen offset:1024  lds
WR_4_0:
    ds_read_b64_tr_b16 v[176:177], v244 offset:2048
    ds_read_b64_tr_b16 v[178:179], v244 offset:3072
    ds_read_b64_tr_b16 v[184:185], v245 offset:2048
    ds_read_b64_tr_b16 v[186:187], v245 offset:3072
    v_fmac_f32 v197, v38, v158
    v_fmac_f32 v197, v39, v159
    v_mul_f32_e64 v201, v0, -v168
    v_fma_f32 v201, v1, -v169, v201
    v_fma_f32 v201, v2, -v170, v201
    v_fma_f32 v201, v3, -v171, v201
    v_fma_f32 v201, v4, -v172, v201
    v_fma_f32 v201, v5, -v173, v201
    v_fma_f32 v201, v6, -v174, v201
    v_fma_f32 v201, v7, -v175, v201
    s_waitcnt lgkmcnt(0)
    v_mfma_f32_32x32x16_bf16 v[16:31], v[80:83], v[176:179], v[16:31]
    v_mul_f32_e64 v203, v8, -v168
    v_fma_f32 v203, v9, -v169, v203
    v_fma_f32 v203, v10, -v170, v203
    v_fma_f32 v203, v11, -v171, v203
    v_fma_f32 v203, v12, -v172, v203
    v_fma_f32 v203, v13, -v173, v203
    s_add_u32 m0, s21, 2048
    v_mfma_f32_32x32x16_bf16 v[48:63], v[84:87], v[176:179], v[48:63]
    s_cbranch_vccnz WL_4_1
    v_mad_u32_u16 v236, v236, s3, v246 op_sel:[1,0,0,0]
    v_mad_u32_u16 v237, v237, s3, v246 op_sel:[1,0,0,0]
    buffer_load_dwordx4 v236, s[4:7], s39 offen  lds
    buffer_load_dwordx4 v237, s[8:11], s39 offen offset:1024  lds
WR_4_1:
    v_fma_f32 v203, v14, -v174, v203
    v_fma_f32 v203, v15, -v175, v203
    v_mfma_f32_32x32x16_bf16 v[0:15], v[72:75], v[180:183], 0
    v_fmac_f32 v200, v24, v160
    v_fmac_f32 v200, v25, v161
    v_fmac_f32 v200, v26, v162
    v_fmac_f32 v200, v27, v163
    v_fmac_f32 v200, v28, v164
    v_fmac_f32 v200, v29, v165
    v_fmac_f32 v200, v30, v166
    v_fmac_f32 v200, v31, v167
    v_mfma_f32_32x32x16_bf16 v[24:39], v[76:79], v[180:183], 0
    s_waitcnt vmcnt(6)
    ds_read_b64_tr_b16 v[176:177], v244 offset:4096
    ds_read_b64_tr_b16 v[178:179], v244 offset:5120
    ds_read_b64_tr_b16 v[180:181], v245 offset:4096
    ds_read_b64_tr_b16 v[182:183], v245 offset:5120
    v_mul_f32 v254, v16, v144
    v_fmac_f32 v254, v17, v145
    v_mfma_f32_32x32x16_bf16 v[24:39], v[84:87], v[184:187], v[24:39]
    v_fmac_f32 v254, v18, v146
    v_fmac_f32 v254, v19, v147
    v_fmac_f32 v254, v20, v148
    v_fmac_f32 v254, v21, v149
    v_fmac_f32 v254, v22, v150
    v_fmac_f32 v254, v23, v151
    v_mfma_f32_32x32x16_bf16 v[0:15], v[80:83], v[184:187], v[0:15]
    v_sub_f32_e64 v64, -v48, v64
    v_sub_f32_e64 v65, -v49, v65
    v_permlane32_swap_b32 v196, v254
    v_sub_f32_e64 v66, -v50, v66
    v_sub_f32_e64 v67, -v51, v67
    v_sub_f32_e64 v68, -v52, v68
    v_sub_f32_e64 v69, -v53, v69
    v_sub_f32_e64 v70, -v54, v70
    v_sub_f32_e64 v71, -v55, v71
    v_add_f32 v254, v196, v254
    s_waitcnt vmcnt(4) lgkmcnt(0)
    v_mfma_f32_32x32x16_bf16 v[56:71], v[76:79], v[176:179], v[56:71]
    v_sub_f32_e64 v40, -v24, v40
    v_sub_f32_e64 v41, -v25, v41
    v_sub_f32_e64 v42, -v26, v42
    v_sub_f32_e64 v43, -v27, v43
    v_sub_f32_e64 v44, -v28, v44
    v_sub_f32_e64 v45, -v29, v45
    v_sub_f32_e64 v46, -v30, v46
    v_sub_f32_e64 v47, -v31, v47
    s_add_u32 m0, s21, 4096
    v_mfma_f32_32x32x16_bf16 v[16:31], v[72:75], v[176:179], 0
    s_cbranch_vccnz WL_4_2
    v_mad_u32_u16 v238, v238, s3, v246 op_sel:[1,0,0,0]
    v_mad_u32_u16 v239, v239, s3, v246 op_sel:[1,0,0,0]
    buffer_load_dwordx4 v238, s[4:7], s40 offen  lds
    buffer_load_dwordx4 v239, s[8:11], s40 offen offset:1024  lds
WR_4_2:
    ds_read_b64_tr_b16 v[176:177], v244 offset:6144
    ds_read_b64_tr_b16 v[178:179], v244 offset:7168
    ds_read_b64_tr_b16 v[184:185], v245 offset:6144
    ds_read_b64_tr_b16 v[186:187], v245 offset:7168
    v_mul_f32 v255, v0, v152
    v_fmac_f32 v255, v1, v153
    v_fmac_f32 v255, v2, v154
    v_fmac_f32 v255, v3, v155
    v_fmac_f32 v255, v4, v156
    v_fmac_f32 v255, v5, v157
    v_fmac_f32 v255, v6, v158
    v_fmac_f32 v255, v7, v159
    v_fmac_f32 v201, v8, v168
    v_fmac_f32 v201, v9, v169
    v_permlane32_swap_b32 v197, v255
    s_waitcnt lgkmcnt(0)
    v_mfma_f32_32x32x16_bf16 v[16:31], v[80:83], v[176:179], v[16:31]
    v_fmac_f32 v201, v10, v170
    v_fmac_f32 v201, v11, v171
    v_fmac_f32 v201, v12, v172
    v_fmac_f32 v201, v13, v173
    v_fmac_f32 v201, v14, v174
    v_fmac_f32 v201, v15, v175
    s_add_u32 m0, s21, 6144
    v_mfma_f32_32x32x16_bf16 v[56:71], v[84:87], v[176:179], v[56:71]
    s_cbranch_vccnz WL_4_3
    v_mad_u32_u16 v240, v240, s3, v246 op_sel:[1,0,0,0]
    v_mad_u32_u16 v241, v241, s3, v246 op_sel:[1,0,0,0]
    buffer_load_dwordx4 v240, s[4:7], s41 offen  lds
    buffer_load_dwordx4 v241, s[8:11], s41 offen offset:1024  lds
WR_4_3:
    v_add_f32 v255, v197, v255
    v_cvt_pk_bf16_f32 v194, v254, v255
    v_mfma_f32_32x32x16_bf16 v[0:15], v[72:75], v[180:183], 0
    v_mul_f32 v254, v16, v144
    v_fmac_f32 v254, v17, v145
    v_fmac_f32 v254, v18, v146
    v_fmac_f32 v254, v19, v147
    v_fmac_f32 v254, v20, v148
    v_fmac_f32 v254, v21, v149
    v_mfma_f32_32x32x16_bf16 v[32:47], v[76:79], v[180:183], v[32:47]
    s_waitcnt vmcnt(6)
    ds_read_b64_tr_b16 v[176:177], v244 offset:0
    ds_read_b64_tr_b16 v[178:179], v244 offset:1024
    ds_read_b64_tr_b16 v[180:181], v245 offset:0
    ds_read_b64_tr_b16 v[182:183], v245 offset:1024
    v_fmac_f32 v254, v22, v150
    v_fmac_f32 v254, v23, v151
    v_mfma_f32_32x32x16_bf16 v[0:15], v[80:83], v[184:187], v[0:15]
    v_fma_f32 v202, v24, -v160, v202
    v_fma_f32 v202, v25, -v161, v202
    v_permlane32_swap_b32 v254, v200
    v_fma_f32 v202, v26, -v162, v202
    v_fma_f32 v202, v27, -v163, v202
    v_fma_f32 v202, v28, -v164, v202
    v_mfma_f32_32x32x16_bf16 v[32:47], v[84:87], v[184:187], v[32:47]
    v_add_u32 v249, s48, v249
    v_add_u32 v250, s49, v250
    ds_read_b32 v252, v251 offset:16
    ds_read_b64_tr_b16 v[72:73], v249 offset:0
    ds_read_b64_tr_b16 v[76:77], v249 offset:64
    ds_read_b64_tr_b16 v[74:75], v249 offset:256
    ds_read_b64_tr_b16 v[78:79], v249 offset:320
    s_mov_b64 exec, s[54:55]
    ds_read_u16_d16_hi v242, v250 offset:0
    s_mov_b64 exec, -1
    v_fma_f32 v202, v29, -v165, v202
    v_fma_f32 v202, v30, -v166, v202
    v_fma_f32 v202, v31, -v167, v202
    v_add_f32 v200, v254, v200
    v_mul_f32_e64 v198, v64, -v112
    v_permlane32_swap_b32 v202, v254
    v_fma_f32 v198, v65, -v113, v198
    v_fma_f32 v198, v66, -v114, v198
    v_fma_f32 v198, v67, -v115, v198
    v_fma_f32 v198, v68, -v116, v198
    v_fma_f32 v198, v69, -v117, v198
    v_fma_f32 v198, v70, -v118, v198
    v_fma_f32 v198, v71, -v119, v198
    v_add_f32 v254, v202, v254
    v_mul_f32 v196, v56, v160
    v_fmac_f32 v196, v57, v161
    v_fmac_f32 v196, v58, v162
    v_fmac_f32 v196, v59, v163
    v_fmac_f32 v196, v60, v164
    v_fmac_f32 v196, v61, v165
    v_fmac_f32 v196, v62, v166
    v_fmac_f32 v196, v63, v167
    s_nop 1
    v_permlane32_swap_b32 v198, v196
    v_add_f32 v196, v198, v196
    s_cbranch_vccnz LEPI_0
    v_mul_f32 v255, v0, v152
    v_fmac_f32 v255, v1, v153
    v_fmac_f32 v255, v2, v154
    v_fmac_f32 v255, v3, v155
    v_fmac_f32 v255, v4, v156
    v_fmac_f32 v255, v5, v157
    v_fmac_f32 v255, v6, v158
    v_fmac_f32 v255, v7, v159
    v_fma_f32 v203, v8, -v168, v203
    v_fma_f32 v203, v9, -v169, v203
    v_permlane32_swap_b32 v255, v201
    v_fma_f32 v203, v10, -v170, v203
    v_fma_f32 v203, v11, -v171, v203
    v_fma_f32 v203, v12, -v172, v203
    v_fma_f32 v203, v13, -v173, v203
    v_fma_f32 v203, v14, -v174, v203
    v_fma_f32 v203, v15, -v175, v203
    v_add_f32 v201, v255, v201
    v_mul_f32_e64 v199, v40, -v120
    v_permlane32_swap_b32 v203, v255
    v_fma_f32 v199, v41, -v121, v199
    v_fma_f32 v199, v42, -v122, v199
    v_fma_f32 v199, v43, -v123, v199
    v_fma_f32 v199, v44, -v124, v199
    v_fma_f32 v199, v45, -v125, v199
    v_fma_f32 v199, v46, -v126, v199
    v_fma_f32 v199, v47, -v127, v199
    v_add_f32 v255, v203, v255
    v_mul_f32 v197, v32, v168
    v_fmac_f32 v197, v33, v169
    v_fmac_f32 v197, v34, v170
    v_fmac_f32 v197, v35, v171
    v_fmac_f32 v197, v36, v172
    v_fmac_f32 v197, v37, v173
    v_fmac_f32 v197, v38, v174
    v_fmac_f32 v197, v39, v175
    s_nop 1
    v_permlane32_swap_b32 v199, v197
    v_add_f32 v197, v199, v197
    v_cvt_pk_bf16_f32 v200, v200, v201
    v_cvt_pk_bf16_f32 v254, v254, v255
    v_cvt_pk_bf16_f32 v196, v196, v197
    ds_write2st64_b32 v253, v192, v193 offset0:0 offset1:1
    ds_write2st64_b32 v253, v194, v200 offset0:2 offset1:3
    ds_write_b32 v253, v196 offset:1024
    s_mov_b64 exec, 0xffffffff
    ds_write_b32 v253, v254 offset:1280
    s_mov_b64 exec, -1
    s_add_u32 s50, s50, 1
    s_cmp_ge_u32 s50, 4
    s_cbranch_scc1 LAST1
    s_waitcnt lgkmcnt(9)
    v_readfirstlane_b32 s66, v252
    s_add_u32 s53, s53, 1
    v_mov_b32 v252, s53
    s_cmp_le_u32 s53, s66
    ds_write2_b32 v251, v252, v252 offset0:0 offset1:8
    s_setprio 1
    s_cbranch_scc1 PRIO_11
    s_setprio 0
PRIO_11:
    s_cmp_eq_u32 s52, 4
    s_cbranch_scc1 ITEM_1_4
    s_cmp_eq_u32 s52, 5
    s_cbranch_scc1 ITEM_1_5
    s_cmp_eq_u32 s52, 3
    s_cbranch_scc1 ITEM_1_3
    s_cmp_eq_u32 s52, 6
    s_cbranch_scc1 ITEM_1_6
    s_cmp_eq_u32 s52, 8
    s_cbranch_scc1 ITEM_1_8
    s_branch ITEM_1_2
WL_4_0:
    s_add_u32 s66, s51, 0
    buffer_load_dwordx4 v[96:99], v246, s[16:19], s66 offen offset:2048 sc1
    buffer_load_dwordx4 v[100:103], v246, s[16:19], s66 offen offset:3072 sc1
    s_branch WR_4_0
WL_4_1:
    s_add_u32 s66, s51, 4096
    buffer_load_dwordx4 v[104:107], v246, s[16:19], s66 offen offset:2048 sc1
    buffer_load_dwordx4 v[108:111], v246, s[16:19], s66 offen offset:3072 sc1
    s_branch WR_4_1
WL_4_2:
    s_add_u32 s66, s51, 8192
    buffer_load_dwordx4 v[128:131], v246, s[16:19], s66 offen offset:2048 sc1
    buffer_load_dwordx4 v[132:135], v246, s[16:19], s66 offen offset:3072 sc1
    s_branch WR_4_2
WL_4_3:
    s_add_u32 s66, s51, 12288
    buffer_load_dwordx4 v[136:139], v246, s[16:19], s66 offen offset:2048 sc1
    buffer_load_dwordx4 v[140:143], v246, s[16:19], s66 offen offset:3072 sc1
    s_branch WR_4_3
.p2align 6
ITEM_1_5:
    s_mov_b64 exec, s[54:55]
    ds_read_u16_d16_hi v243, v250 offset:128
    s_mov_b64 exec, -1
    ds_read_b64_tr_b16 v[80:81], v249 offset:512
    ds_read_b64_tr_b16 v[84:85], v249 offset:576
    ds_read_b64_tr_b16 v[82:83], v249 offset:768
    ds_read_b64_tr_b16 v[86:87], v249 offset:832
    ds_read_b64_tr_b16 v[88:89], v249 offset:1024
    ds_read_b64_tr_b16 v[92:93], v249 offset:1088
    s_waitcnt lgkmcnt(7)
    v_mul_f32_dpp v196, v242, v72 row_newbcast:0 row_mask:0xf bank_mask:0xf
    v_mul_f32_dpp v197, v242, v73 row_newbcast:1 row_mask:0xf bank_mask:0xf
    v_mul_f32_dpp v198, v242, v72 row_newbcast:8 row_mask:0xf bank_mask:0xf
    v_mul_f32_dpp v199, v242, v73 row_newbcast:9 row_mask:0xf bank_mask:0xf
    v_mul_f32_dpp v200, v242, v76 row_newbcast:2 row_mask:0xf bank_mask:0xf
    v_mul_f32_dpp v201, v242, v77 row_newbcast:3 row_mask:0xf bank_mask:0xf
    v_mul_f32_dpp v202, v242, v76 row_newbcast:10 row_mask:0xf bank_mask:0xf
    v_mul_f32_dpp v203, v242, v77 row_newbcast:11 row_mask:0xf bank_mask:0xf
    v_cvt_pk_bf16_f32 v72, v196, v197
    v_cvt_pk_bf16_f32 v76, v198, v199
    v_cvt_pk_bf16_f32 v73, v200, v201
    v_cvt_pk_bf16_f32 v77, v202, v203
    v_mul_f32_dpp v196, v242, v74 row_newbcast:4 row_mask:0xf bank_mask:0xf
    v_mul_f32_dpp v197, v242, v75 row_newbcast:5 row_mask:0xf bank_mask:0xf
    v_mul_f32_dpp v198, v242, v74 row_newbcast:12 row_mask:0xf bank_mask:0xf
    v_mul_f32_dpp v199, v242, v75 row_newbcast:13 row_mask:0xf bank_mask:0xf
    v_mul_f32_dpp v200, v242, v78 row_newbcast:6 row_mask:0xf bank_mask:0xf
    v_mul_f32_dpp v201, v242, v79 row_newbcast:7 row_mask:0xf bank_mask:0xf
    v_mul_f32_dpp v202, v242, v78 row_newbcast:14 row_mask:0xf bank_mask:0xf
    v_mul_f32_dpp v203, v242, v79 row_newbcast:15 row_mask:0xf bank_mask:0xf
    v_cvt_pk_bf16_f32 v74, v196, v197
    v_cvt_pk_bf16_f32 v78, v198, v199
    v_cvt_pk_bf16_f32 v75, v200, v201
    v_cvt_pk_bf16_f32 v79, v202, v203
    s_mov_b64 exec, s[54:55]
    ds_read_u16_d16_hi v242, v250 offset:256
    s_mov_b64 exec, -1
    s_waitcnt vmcnt(4) lgkmcnt(3)
    v_mfma_f32_32x32x16_bf16 v[56:71], v[72:75], v[176:179], 0
    v_mul_f32_dpp v196, v243, v80 row_newbcast:0 row_mask:0xf bank_mask:0xf
    v_mul_f32_dpp v197, v243, v81 row_newbcast:1 row_mask:0xf bank_mask:0xf
    v_mul_f32_dpp v198, v243, v80 row_newbcast:8 row_mask:0xf bank_mask:0xf
    v_mul_f32_dpp v199, v243, v81 row_newbcast:9 row_mask:0xf bank_mask:0xf
    v_mul_f32_dpp v200, v243, v84 row_newbcast:2 row_mask:0xf bank_mask:0xf
    v_mul_f32_dpp v201, v243, v85 row_newbcast:3 row_mask:0xf bank_mask:0xf
    s_add_u32 m0, s21, 0
    v_mfma_f32_32x32x16_bf16 v[16:31], v[76:79], v[176:179], 0
    buffer_load_dwordx4 v236, s[4:7], s35 offen  lds
    buffer_load_dwordx4 v237, s[8:11], s35 offen offset:1024  lds
    ds_read_b64_tr_b16 v[176:177], v244 offset:2048
    ds_read_b64_tr_b16 v[178:179], v244 offset:3072
    ds_read_b64_tr_b16 v[184:185], v245 offset:2048
    ds_read_b64_tr_b16 v[186:187], v245 offset:3072
    v_mul_f32_dpp v202, v243, v84 row_newbcast:10 row_mask:0xf bank_mask:0xf
    v_mul_f32_dpp v203, v243, v85 row_newbcast:11 row_mask:0xf bank_mask:0xf
    v_cvt_pk_bf16_f32 v80, v196, v197
    v_cvt_pk_bf16_f32 v84, v198, v199
    v_cvt_pk_bf16_f32 v81, v200, v201
    v_cvt_pk_bf16_f32 v85, v202, v203
    v_mul_f32_dpp v196, v243, v82 row_newbcast:4 row_mask:0xf bank_mask:0xf
    v_mul_f32_dpp v197, v243, v83 row_newbcast:5 row_mask:0xf bank_mask:0xf
    v_mul_f32_dpp v198, v243, v82 row_newbcast:12 row_mask:0xf bank_mask:0xf
    v_mul_f32_dpp v199, v243, v83 row_newbcast:13 row_mask:0xf bank_mask:0xf
    v_mul_f32_dpp v200, v243, v86 row_newbcast:6 row_mask:0xf bank_mask:0xf
    v_mul_f32_dpp v201, v243, v87 row_newbcast:7 row_mask:0xf bank_mask:0xf
    v_mul_f32_dpp v202, v243, v86 row_newbcast:14 row_mask:0xf bank_mask:0xf
    v_mul_f32_dpp v203, v243, v87 row_newbcast:15 row_mask:0xf bank_mask:0xf
    v_cvt_pk_bf16_f32 v82, v196, v197
    v_cvt_pk_bf16_f32 v86, v198, v199
    v_cvt_pk_bf16_f32 v83, v200, v201
    v_cvt_pk_bf16_f32 v87, v202, v203
    s_waitcnt vmcnt(4) lgkmcnt(0)
    v_mfma_f32_32x32x16_bf16 v[56:71], v[80:83], v[176:179], v[56:71]
    v_mul_f32_dpp v196, v242, v88 row_newbcast:0 row_mask:0xf bank_mask:0xf
    v_mul_f32_dpp v197, v242, v89 row_newbcast:1 row_mask:0xf bank_mask:0xf
    v_mul_f32_dpp v198, v242, v88 row_newbcast:8 row_mask:0xf bank_mask:0xf
    v_mul_f32_dpp v199, v242, v89 row_newbcast:9 row_mask:0xf bank_mask:0xf
    v_mul_f32_dpp v200, v242, v92 row_newbcast:2 row_mask:0xf bank_mask:0xf
    v_mul_f32_dpp v201, v242, v93 row_newbcast:3 row_mask:0xf bank_mask:0xf
    s_add_u32 m0, s21, 2048
    v_mfma_f32_32x32x16_bf16 v[16:31], v[84:87], v[176:179], v[16:31]
    buffer_load_dwordx4 v238, s[4:7], s35 offen  lds
    ds_read_b64_tr_b16 v[176:177], v244 offset:4096
    ds_read_b64_tr_b16 v[188:189], v245 offset:4096
    v_mul_f32_dpp v202, v242, v92 row_newbcast:10 row_mask:0xf bank_mask:0xf
    v_mul_f32_dpp v203, v242, v93 row_newbcast:11 row_mask:0xf bank_mask:0xf
    v_cvt_pk_bf16_f32 v88, v196, v197
    v_cvt_pk_bf16_f32 v92, v198, v199
    v_cvt_pk_bf16_f32 v89, v200, v201
    v_cvt_pk_bf16_f32 v93, v202, v203
    s_waitcnt lgkmcnt(0)
    v_mfma_f32_32x32x8_bf16 v[56:71], v[88:89], v[176:177], v[56:71]
    s_add_u32 m0, s21, 4096
    v_mfma_f32_32x32x8_bf16 v[16:31], v[92:93], v[176:177], v[16:31]
    buffer_load_dwordx4 v234, s[4:7], s36 offen  lds
    buffer_load_dwordx4 v235, s[8:11], s36 offen offset:1024  lds
    s_mov_b32 m0, s50
    s_nop 0
    s_movrels_b32 s71, s23
    s_movrels_b32 s33, s28
    v_add_u32 v253, s33, v248
    s_bfe_u32 s46, s71, 0x30012
    s_mov_b32 m0, s46
    s_and_b32 s66, s71, 0x3ffff
    s_movrels_b32 s68, s57
    s_movrels_b32 s69, s61
    s_sub_u32 s48, s66, s47
    s_mov_b32 s47, s66
    s_lshr_b32 s52, s71, 28
    s_lshl_b32 s67, s46, 9
    s_add_u32 s66, s66, s67
    s_sub_u32 s49, s66, s42
    s_mov_b32 s42, s66
    s_bfe_u32 s66, s68, 655360
    s_add_u32 s43, s42, s66
    s_bfe_u32 s39, s69, 655360
    s_bfe_u32 s66, s68, 655370
    s_add_u32 s44, s42, s66
    s_bfe_u32 s40, s69, 655370
    s_bfe_u32 s66, s68, 655380
    s_add_u32 s45, s42, s66
    s_bfe_u32 s41, s69, 655380
    v_add_u32 v252, s45, v247
    ds_read2_b32 v[240:241], v252 offset0:0 offset1:16
    v_mfma_f32_32x32x16_bf16 v[32:47], v[72:75], v[180:183], 0
    v_mul_f32 v196, v56, v96
    v_fmac_f32 v196, v57, v97
    v_fmac_f32 v196, v58, v98
    v_fmac_f32 v196, v59, v99
    v_fmac_f32 v196, v60, v100
    v_fmac_f32 v196, v61, v101
    v_mfma_f32_32x32x16_bf16 v[0:15], v[76:79], v[180:183], 0
    v_fmac_f32 v196, v62, v102
    v_fmac_f32 v196, v63, v103
    v_mul_f32 v198, v64, v128
    v_fmac_f32 v198, v65, v129
    v_fmac_f32 v198, v66, v130
    v_fmac_f32 v198, v67, v131
    v_mfma_f32_32x32x16_bf16 v[32:47], v[80:83], v[184:187], v[32:47]
    v_fmac_f32 v198, v68, v132
    v_fmac_f32 v198, v69, v133
    v_fmac_f32 v198, v70, v134
    v_fmac_f32 v198, v71, v135
    v_mul_f32 v200, v16, v128
    v_fmac_f32 v200, v17, v129
    v_mfma_f32_32x32x16_bf16 v[0:15], v[84:87], v[184:187], v[0:15]
    s_waitcnt vmcnt(5)
    ds_read_b64_tr_b16 v[176:177], v244 offset:6144
    ds_read_b64_tr_b16 v[178:179], v244 offset:7168
    ds_read_b64_tr_b16 v[180:181], v245 offset:6144
    ds_read_b64_tr_b16 v[182:183], v245 offset:7168
    v_permlane32_swap_b32 v196, v198
    v_fmac_f32 v200, v18, v130
    v_mfma_f32_32x32x8_bf16 v[32:47], v[88:89], v[188:189], v[32:47]
    v_fmac_f32 v200, v19, v131
    v_fmac_f32 v200, v20, v132
    v_fmac_f32 v200, v21, v133
    v_fmac_f32 v200, v22, v134
    v_fmac_f32 v200, v23, v135
    v_add_f32 v198, v196, v198
    v_mfma_f32_32x32x8_bf16 v[0:15], v[92:93], v[188:189], v[0:15]
    v_mul_f32_e64 v202, v24, -v128
    v_fma_f32 v202, v25, -v129, v202
    v_fma_f32 v202, v26, -v130, v202
    v_fma_f32 v202, v27, -v131, v202
    v_fma_f32 v202, v28, -v132, v202
    v_fma_f32 v202, v29, -v133, v202
    v_fma_f32 v202, v30, -v134, v202
    v_fma_f32 v202, v31, -v135, v202
    s_nop 1
    v_permlane32_swap_b32 v200, v202
    v_add_f32 v202, v200, v202
    s_waitcnt vmcnt(3) lgkmcnt(0)
    v_mfma_f32_32x32x16_bf16 v[56:71], v[72:75], v[176:179], 0
    v_mul_f32 v197, v32, v104
    v_fmac_f32 v197, v33, v105
    v_fmac_f32 v197, v34, v106
    v_fmac_f32 v197, v35, v107
    v_fmac_f32 v197, v36, v108
    v_fmac_f32 v197, v37, v109
    s_add_u32 m0, s21, 6144
    v_mfma_f32_32x32x16_bf16 v[16:31], v[76:79], v[176:179], 0
    buffer_load_dwordx4 v236, s[4:7], s36 offen  lds
    buffer_load_dwordx4 v237, s[8:11], s36 offen offset:1024  lds
    ds_read_b64_tr_b16 v[176:177], v244 offset:0
    ds_read_b64_tr_b16 v[178:179], v244 offset:1024
    ds_read_b64_tr_b16 v[184:185], v245 offset:0
    ds_read_b64_tr_b16 v[186:187], v245 offset:1024
    v_fmac_f32 v197, v38, v110
    v_fmac_f32 v197, v39, v111
    v_mul_f32 v199, v40, v136
    v_fmac_f32 v199, v41, v137
    v_fmac_f32 v199, v42, v138
    v_fmac_f32 v199, v43, v139
    v_fmac_f32 v199, v44, v140
    v_fmac_f32 v199, v45, v141
    v_fmac_f32 v199, v46, v142
    v_fmac_f32 v199, v47, v143
    v_mul_f32 v201, v0, v136
    v_fmac_f32 v201, v1, v137
    v_permlane32_swap_b32 v197, v199
    v_fmac_f32 v201, v2, v138
    v_fmac_f32 v201, v3, v139
    s_waitcnt vmcnt(4) lgkmcnt(0)
    v_mfma_f32_32x32x16_bf16 v[56:71], v[80:83], v[176:179], v[56:71]
    v_fmac_f32 v201, v4, v140
    v_fmac_f32 v201, v5, v141
    v_fmac_f32 v201, v6, v142
    v_fmac_f32 v201, v7, v143
    v_add_f32 v199, v197, v199
    v_mul_f32_e64 v203, v8, -v136
    s_add_u32 m0, s21, 0
    v_mfma_f32_32x32x16_bf16 v[16:31], v[84:87], v[176:179], v[16:31]
    buffer_load_dwordx4 v238, s[4:7], s36 offen  lds
    ds_read_b64_tr_b16 v[176:177], v244 offset:2048
    ds_read_b64_tr_b16 v[188:189], v245 offset:2048
    v_fma_f32 v203, v9, -v137, v203
    v_fma_f32 v203, v10, -v138, v203
    v_fma_f32 v203, v11, -v139, v203
    s_waitcnt lgkmcnt(0)
    v_mfma_f32_32x32x8_bf16 v[56:71], v[88:89], v[176:177], v[56:71]
    v_fma_f32 v203, v12, -v140, v203
    v_fma_f32 v203, v13, -v141, v203
    v_fma_f32 v203, v14, -v142, v203
    v_fma_f32 v203, v15, -v143, v203
    s_nop 1
    v_permlane32_swap_b32 v201, v203
    v_add_f32 v203, v201, v203
    s_add_u32 m0, s21, 2048
    v_mfma_f32_32x32x8_bf16 v[16:31], v[92:93], v[176:177], v[16:31]
    buffer_load_dwordx4 v234, s[4:7], s37 offen  lds
    buffer_load_dwordx4 v235, s[8:11], s37 offen offset:1024  lds
    v_add_u32 v252, s42, v247
    ds_read2_b32 v[234:235], v252 offset0:0 offset1:16
    v_cvt_pk_bf16_f32 v192, v198, v199
    v_cvt_pk_bf16_f32 v193, v202, v203
    v_mfma_f32_32x32x16_bf16 v[32:47], v[72:75], v[180:183], 0
    v_mul_f32 v196, v56, v144
    v_fmac_f32 v196, v57, v145
    v_fmac_f32 v196, v58, v146
    v_fmac_f32 v196, v59, v147
    v_fmac_f32 v196, v60, v148
    v_fmac_f32 v196, v61, v149
    v_mfma_f32_32x32x16_bf16 v[0:15], v[76:79], v[180:183], 0
    v_fmac_f32 v196, v62, v150
    v_fmac_f32 v196, v63, v151
    v_mul_f32_e64 v200, v16, -v160
    v_fma_f32 v200, v17, -v161, v200
    v_fma_f32 v200, v18, -v162, v200
    v_fma_f32 v200, v19, -v163, v200
    v_mfma_f32_32x32x16_bf16 v[32:47], v[80:83], v[184:187], v[32:47]
    v_fma_f32 v200, v20, -v164, v200
    v_fma_f32 v200, v21, -v165, v200
    v_fma_f32 v200, v22, -v166, v200
    v_fma_f32 v200, v23, -v167, v200
    v_mul_f32_e64 v202, v24, -v160
    v_fma_f32 v202, v25, -v161, v202
    v_mfma_f32_32x32x16_bf16 v[0:15], v[84:87], v[184:187], v[0:15]
    s_waitcnt vmcnt(5)
    ds_read_b64_tr_b16 v[176:177], v244 offset:4096
    ds_read_b64_tr_b16 v[178:179], v244 offset:5120
    ds_read_b64_tr_b16 v[180:181], v245 offset:4096
    ds_read_b64_tr_b16 v[182:183], v245 offset:5120
    v_fma_f32 v202, v26, -v162, v202
    v_fma_f32 v202, v27, -v163, v202
    v_mfma_f32_32x32x8_bf16 v[32:47], v[88:89], v[188:189], v[32:47]
    v_fma_f32 v202, v28, -v164, v202
    v_fma_f32 v202, v29, -v165, v202
    v_fma_f32 v202, v30, -v166, v202
    v_fma_f32 v202, v31, -v167, v202
    v_mfma_f32_32x32x8_bf16 v[0:15], v[92:93], v[188:189], v[0:15]
    s_waitcnt vmcnt(3) lgkmcnt(0)
    v_mfma_f32_32x32x16_bf16 v[16:31], v[72:75], v[176:179], 0
    s_nop 4
    v_mul_f32 v197, v32, v152
    v_fmac_f32 v197, v33, v153
    v_fmac_f32 v197, v34, v154
    v_fmac_f32 v197, v35, v155
    v_fmac_f32 v197, v36, v156
    v_fmac_f32 v197, v37, v157
    s_add_u32 m0, s21, 4096
    v_mfma_f32_32x32x16_bf16 v[48:63], v[76:79], v[176:179], 0
    buffer_load_dwordx4 v236, s[4:7], s37 offen  lds
    buffer_load_dwordx4 v237, s[8:11], s37 offen offset:1024  lds
    ds_read_b64_tr_b16 v[176:177], v244 offset:6144
    ds_read_b64_tr_b16 v[178:179], v244 offset:7168
    ds_read_b64_tr_b16 v[184:185], v245 offset:6144
    ds_read_b64_tr_b16 v[186:187], v245 offset:7168
    v_add_u32 v252, s43, v247
    ds_read2_b32 v[236:237], v252 offset0:0 offset1:16
    v_fmac_f32 v197, v38, v158
    v_fmac_f32 v197, v39, v159
    v_mul_f32_e64 v201, v0, -v168
    s_waitcnt vmcnt(4) lgkmcnt(1)
    v_mfma_f32_32x32x16_bf16 v[16:31], v[80:83], v[176:179], v[16:31]
    v_fma_f32 v201, v1, -v169, v201
    v_fma_f32 v201, v2, -v170, v201
    v_fma_f32 v201, v3, -v171, v201
    v_fma_f32 v201, v4, -v172, v201
    v_fma_f32 v201, v5, -v173, v201
    v_fma_f32 v201, v6, -v174, v201
    s_add_u32 m0, s21, 6144
    v_mfma_f32_32x32x16_bf16 v[48:63], v[84:87], v[176:179], v[48:63]
    buffer_load_dwordx4 v238, s[4:7], s37 offen  lds
    ds_read_b64_tr_b16 v[176:177], v244 offset:0
    ds_read_b64_tr_b16 v[188:189], v245 offset:0
    v_add_u32 v252, s44, v247
    ds_read2_b32 v[238:239], v252 offset0:0 offset1:16
    v_fma_f32 v201, v7, -v175, v201
    s_waitcnt lgkmcnt(1)
    v_mfma_f32_32x32x8_bf16 v[16:31], v[88:89], v[176:177], v[16:31]
    v_mul_f32_e64 v203, v8, -v168
    v_fma_f32 v203, v9, -v169, v203
    v_fma_f32 v203, v10, -v170, v203
    v_fma_f32 v203, v11, -v171, v203
    v_fma_f32 v203, v12, -v172, v203
    v_fma_f32 v203, v13, -v173, v203
    s_add_u32 m0, s21, 0
    v_mfma_f32_32x32x8_bf16 v[48:63], v[92:93], v[176:177], v[48:63]
    s_cbranch_vccnz WL_5_0
    v_mad_u32_u16 v234, v234, s3, v246 op_sel:[1,0,0,0]
    v_mad_u32_u16 v235, v235, s3, v246 op_sel:[1,0,0,0]
    buffer_load_dwordx4 v234, s[4:7], s38 offen  lds
    buffer_load_dwordx4 v235, s[8:11], s38 offen offset:1024  lds
WR_5_0:
    v_fma_f32 v203, v14, -v174, v203
    v_fma_f32 v203, v15, -v175, v203
    v_mfma_f32_32x32x16_bf16 v[0:15], v[72:75], v[180:183], 0
    v_fmac_f32 v200, v24, v160
    v_fmac_f32 v200, v25, v161
    v_fmac_f32 v200, v26, v162
    v_fmac_f32 v200, v27, v163
    v_fmac_f32 v200, v28, v164
    v_fmac_f32 v200, v29, v165
    v_fmac_f32 v200, v30, v166
    v_fmac_f32 v200, v31, v167
    v_mfma_f32_32x32x16_bf16 v[24:39], v[76:79], v[180:183], 0
    v_mul_f32 v254, v16, v144
    v_fmac_f32 v254, v17, v145
    v_fmac_f32 v254, v18, v146
    v_fmac_f32 v254, v19, v147
    v_fmac_f32 v254, v20, v148
    v_fmac_f32 v254, v21, v149
    v_mfma_f32_32x32x16_bf16 v[0:15], v[80:83], v[184:187], v[0:15]
    v_fmac_f32 v254, v22, v150
    v_fmac_f32 v254, v23, v151
    v_sub_f32_e64 v64, -v48, v64
    v_sub_f32_e64 v65, -v49, v65
    v_permlane32_swap_b32 v196, v254
    v_sub_f32_e64 v66, -v50, v66
    v_mfma_f32_32x32x16_bf16 v[24:39], v[84:87], v[184:187], v[24:39]
    s_waitcnt vmcnt(5)
    ds_read_b64_tr_b16 v[176:177], v244 offset:2048
    ds_read_b64_tr_b16 v[178:179], v244 offset:3072
    ds_read_b64_tr_b16 v[180:181], v245 offset:2048
    ds_read_b64_tr_b16 v[182:183], v245 offset:3072
    v_sub_f32_e64 v67, -v51, v67
    v_sub_f32_e64 v68, -v52, v68
    v_mfma_f32_32x32x8_bf16 v[24:39], v[92:93], v[188:189], v[24:39]
    v_sub_f32_e64 v69, -v53, v69
    v_sub_f32_e64 v70, -v54, v70
    v_sub_f32_e64 v71, -v55, v71
    v_add_f32 v254, v196, v254
    v_mfma_f32_32x32x8_bf16 v[0:15], v[88:89], v[188:189], v[0:15]
    s_waitcnt vmcnt(3) lgkmcnt(0)
    v_mfma_f32_32x32x16_bf16 v[56:71], v[76:79], v[176:179], v[56:71]
    s_nop 4
    v_sub_f32_e64 v40, -v24, v40
    v_sub_f32_e64 v41, -v25, v41
    v_sub_f32_e64 v42, -v26, v42
    v_sub_f32_e64 v43, -v27, v43
    v_sub_f32_e64 v44, -v28, v44
    v_sub_f32_e64 v45, -v29, v45
    v_sub_f32_e64 v46, -v30, v46
    v_sub_f32_e64 v47, -v31, v47
    s_add_u32 m0, s21, 2048
    v_mfma_f32_32x32x16_bf16 v[16:31], v[72:75], v[176:179], 0
    s_cbranch_vccnz WL_5_1
    v_mad_u32_u16 v236, v236, s3, v246 op_sel:[1,0,0,0]
    v_mad_u32_u16 v237, v237, s3, v246 op_sel:[1,0,0,0]
    buffer_load_dwordx4 v236, s[4:7], s39 offen  lds
    buffer_load_dwordx4 v237, s[8:11], s39 offen offset:1024  lds
WR_5_1:
    ds_read_b64_tr_b16 v[176:177], v244 offset:4096
    ds_read_b64_tr_b16 v[178:179], v244 offset:5120
    ds_read_b64_tr_b16 v[184:185], v245 offset:4096
    ds_read_b64_tr_b16 v[186:187], v245 offset:5120
    v_mul_f32 v255, v0, v152
    v_fmac_f32 v255, v1, v153
    v_fmac_f32 v255, v2, v154
    v_fmac_f32 v255, v3, v155
    v_fmac_f32 v255, v4, v156
    s_waitcnt vmcnt(4) lgkmcnt(0)
    v_mfma_f32_32x32x16_bf16 v[16:31], v[80:83], v[176:179], v[16:31]
    v_fmac_f32 v255, v5, v157
    v_fmac_f32 v255, v6, v158
    v_fmac_f32 v255, v7, v159
    v_fmac_f32 v201, v8, v168
    v_fmac_f32 v201, v9, v169
    v_permlane32_swap_b32 v197, v255
    s_add_u32 m0, s21, 4096
    v_mfma_f32_32x32x16_bf16 v[56:71], v[84:87], v[176:179], v[56:71]
    s_cbranch_vccnz WL_5_2
    v_mad_u32_u16 v238, v238, s3, v246 op_sel:[1,0,0,0]
    v_mad_u32_u16 v239, v239, s3, v246 op_sel:[1,0,0,0]
    buffer_load_dwordx4 v238, s[4:7], s40 offen  lds
    buffer_load_dwordx4 v239, s[8:11], s40 offen offset:1024  lds
WR_5_2:
    ds_read_b64_tr_b16 v[176:177], v244 offset:6144
    ds_read_b64_tr_b16 v[188:189], v245 offset:6144
    s_waitcnt lgkmcnt(0)
    v_mfma_f32_32x32x8_bf16 v[16:31], v[88:89], v[176:177], v[16:31]
    v_fmac_f32 v201, v10, v170
    v_fmac_f32 v201, v11, v171
    v_fmac_f32 v201, v12, v172
    v_fmac_f32 v201, v13, v173
    v_fmac_f32 v201, v14, v174
    v_fmac_f32 v201, v15, v175
    s_add_u32 m0, s21, 6144
    v_mfma_f32_32x32x8_bf16 v[56:71], v[92:93], v[176:177], v[56:71]
    s_cbranch_vccnz WL_5_3
    v_mad_u32_u16 v240, v240, s3, v246 op_sel:[1,0,0,0]
    v_mad_u32_u16 v241, v241, s3, v246 op_sel:[1,0,0,0]
    buffer_load_dwordx4 v240, s[4:7], s41 offen  lds
    buffer_load_dwordx4 v241, s[8:11], s41 offen offset:1024  lds
WR_5_3:
    v_add_f32 v255, v197, v255
    v_cvt_pk_bf16_f32 v194, v254, v255
    v_mfma_f32_32x32x16_bf16 v[0:15], v[72:75], v[180:183], 0
    v_mul_f32 v254, v16, v144
    v_fmac_f32 v254, v17, v145
    v_fmac_f32 v254, v18, v146
    v_fmac_f32 v254, v19, v147
    v_fmac_f32 v254, v20, v148
    v_fmac_f32 v254, v21, v149
    v_mfma_f32_32x32x16_bf16 v[32:47], v[76:79], v[180:183], v[32:47]
    v_fmac_f32 v254, v22, v150
    v_fmac_f32 v254, v23, v151
    v_fma_f32 v202, v24, -v160, v202
    v_fma_f32 v202, v25, -v161, v202
    v_permlane32_swap_b32 v254, v200
    v_fma_f32 v202, v26, -v162, v202
    v_mfma_f32_32x32x16_bf16 v[0:15], v[80:83], v[184:187], v[0:15]
    v_fma_f32 v202, v27, -v163, v202
    v_fma_f32 v202, v28, -v164, v202
    v_fma_f32 v202, v29, -v165, v202
    v_fma_f32 v202, v30, -v166, v202
    v_fma_f32 v202, v31, -v167, v202
    v_add_f32 v200, v254, v200
    v_mfma_f32_32x32x16_bf16 v[32:47], v[84:87], v[184:187], v[32:47]
    s_waitcnt vmcnt(6)
    ds_read_b64_tr_b16 v[176:177], v244 offset:0
    ds_read_b64_tr_b16 v[178:179], v244 offset:1024
    ds_read_b64_tr_b16 v[180:181], v245 offset:0
    ds_read_b64_tr_b16 v[182:183], v245 offset:1024
    v_mul_f32_e64 v198, v64, -v112
    v_permlane32_swap_b32 v202, v254
    v_mfma_f32_32x32x8_bf16 v[0:15], v[88:89], v[188:189], v[0:15]
    v_fma_f32 v198, v65, -v113, v198
    v_fma_f32 v198, v66, -v114, v198
    v_fma_f32 v198, v67, -v115, v198
    v_fma_f32 v198, v68, -v116, v198
    v_fma_f32 v198, v69, -v117, v198
    v_fma_f32 v198, v70, -v118, v198
    v_mfma_f32_32x32x8_bf16 v[32:47], v[92:93], v[188:189], v[32:47]
    v_add_u32 v249, s48, v249
    v_add_u32 v250, s49, v250
    ds_read_b32 v252, v251 offset:16
    ds_read_b64_tr_b16 v[72:73], v249 offset:0
    ds_read_b64_tr_b16 v[76:77], v249 offset:64
    ds_read_b64_tr_b16 v[74:75], v249 offset:256
    ds_read_b64_tr_b16 v[78:79], v249 offset:320
    s_mov_b64 exec, s[54:55]
    ds_read_u16_d16_hi v242, v250 offset:0
    s_mov_b64 exec, -1
    v_fma_f32 v198, v71, -v119, v198
    v_add_f32 v254, v202, v254
    v_mul_f32 v196, v56, v160
    v_fmac_f32 v196, v57, v161
    v_fmac_f32 v196, v58, v162
    v_fmac_f32 v196, v59, v163
    v_fmac_f32 v196, v60, v164
    v_fmac_f32 v196, v61, v165
    v_fmac_f32 v196, v62, v166
    v_fmac_f32 v196, v63, v167
    s_nop 1
    v_permlane32_swap_b32 v198, v196
    v_add_f32 v196, v198, v196
    s_cbranch_vccnz LEPI_0
    v_mul_f32 v255, v0, v152
    v_fmac_f32 v255, v1, v153
    v_fmac_f32 v255, v2, v154
    v_fmac_f32 v255, v3, v155
    v_fmac_f32 v255, v4, v156
    v_fmac_f32 v255, v5, v157
    v_fmac_f32 v255, v6, v158
    v_fmac_f32 v255, v7, v159
    v_fma_f32 v203, v8, -v168, v203
    v_fma_f32 v203, v9, -v169, v203
    v_permlane32_swap_b32 v255, v201
    v_fma_f32 v203, v10, -v170, v203
    v_fma_f32 v203, v11, -v171, v203
    v_fma_f32 v203, v12, -v172, v203
    v_fma_f32 v203, v13, -v173, v203
    v_fma_f32 v203, v14, -v174, v203
    v_fma_f32 v203, v15, -v175, v203
    v_add_f32 v201, v255, v201
    v_mul_f32_e64 v199, v40, -v120
    v_permlane32_swap_b32 v203, v255
    v_fma_f32 v199, v41, -v121, v199
    v_fma_f32 v199, v42, -v122, v199
    v_fma_f32 v199, v43, -v123, v199
    v_fma_f32 v199, v44, -v124, v199
    v_fma_f32 v199, v45, -v125, v199
    v_fma_f32 v199, v46, -v126, v199
    v_fma_f32 v199, v47, -v127, v199
    v_add_f32 v255, v203, v255
    v_mul_f32 v197, v32, v168
    v_fmac_f32 v197, v33, v169
    v_fmac_f32 v197, v34, v170
    v_fmac_f32 v197, v35, v171
    v_fmac_f32 v197, v36, v172
    v_fmac_f32 v197, v37, v173
    v_fmac_f32 v197, v38, v174
    v_fmac_f32 v197, v39, v175
    s_nop 1
    v_permlane32_swap_b32 v199, v197
    v_add_f32 v197, v199, v197
    v_cvt_pk_bf16_f32 v200, v200, v201
    v_cvt_pk_bf16_f32 v254, v254, v255
    v_cvt_pk_bf16_f32 v196, v196, v197
    ds_write2st64_b32 v253, v192, v193 offset0:0 offset1:1
    ds_write2st64_b32 v253, v194, v200 offset0:2 offset1:3
    ds_write_b32 v253, v196 offset:1024
    s_mov_b64 exec, 0xffffffff
    ds_write_b32 v253, v254 offset:1280
    s_mov_b64 exec, -1
    s_add_u32 s50, s50, 1
    s_cmp_ge_u32 s50, 4
    s_cbranch_scc1 LAST1
    s_waitcnt lgkmcnt(9)
    v_readfirstlane_b32 s66, v252
    s_add_u32 s53, s53, 1
    v_mov_b32 v252, s53
    s_cmp_le_u32 s53, s66
    ds_write2_b32 v251, v252, v252 offset0:0 offset1:8
    s_setprio 1
    s_cbranch_scc1 PRIO_12
    s_setprio 0
PRIO_12:
    s_cmp_eq_u32 s52, 4
    s_cbranch_scc1 ITEM_1_4
    s_cmp_eq_u32 s52, 5
    s_cbranch_scc1 ITEM_1_5
    s_cmp_eq_u32 s52, 3
    s_cbranch_scc1 ITEM_1_3
    s_cmp_eq_u32 s52, 6
    s_cbranch_scc1 ITEM_1_6
    s_cmp_eq_u32 s52, 8
    s_cbranch_scc1 ITEM_1_8
    s_branch ITEM_1_2
WL_5_0:
    s_add_u32 s66, s51, 0
    buffer_load_dwordx4 v[96:99], v246, s[16:19], s66 offen offset:2048 sc1
    buffer_load_dwordx4 v[100:103], v246, s[16:19], s66 offen offset:3072 sc1
    s_branch WR_5_0
WL_5_1:
    s_add_u32 s66, s51, 4096
    buffer_load_dwordx4 v[104:107], v246, s[16:19], s66 offen offset:2048 sc1
    buffer_load_dwordx4 v[108:111], v246, s[16:19], s66 offen offset:3072 sc1
    s_branch WR_5_1
WL_5_2:
    s_add_u32 s66, s51, 8192
    buffer_load_dwordx4 v[128:131], v246, s[16:19], s66 offen offset:2048 sc1
    buffer_load_dwordx4 v[132:135], v246, s[16:19], s66 offen offset:3072 sc1
    s_branch WR_5_2
WL_5_3:
    s_add_u32 s66, s51, 12288
    buffer_load_dwordx4 v[136:139], v246, s[16:19], s66 offen offset:2048 sc1
    buffer_load_dwordx4 v[140:143], v246, s[16:19], s66 offen offset:3072 sc1
    s_branch WR_5_3
.p2align 6
ITEM_1_3:
    s_mov_b64 exec, s[54:55]
    ds_read_u16_d16_hi v243, v250 offset:128
    s_mov_b64 exec, -1
    ds_read_b64_tr_b16 v[80:81], v249 offset:512
    ds_read_b64_tr_b16 v[84:85], v249 offset:576
    s_waitcnt lgkmcnt(3)
    v_mul_f32_dpp v196, v242, v72 row_newbcast:0 row_mask:0xf bank_mask:0xf
    v_mul_f32_dpp v197, v242, v73 row_newbcast:1 row_mask:0xf bank_mask:0xf
    v_mul_f32_dpp v198, v242, v72 row_newbcast:8 row_mask:0xf bank_mask:0xf
    v_mul_f32_dpp v199, v242, v73 row_newbcast:9 row_mask:0xf bank_mask:0xf
    v_mul_f32_dpp v200, v242, v76 row_newbcast:2 row_mask:0xf bank_mask:0xf
    v_mul_f32_dpp v201, v242, v77 row_newbcast:3 row_mask:0xf bank_mask:0xf
    v_mul_f32_dpp v202, v242, v76 row_newbcast:10 row_mask:0xf bank_mask:0xf
    v_mul_f32_dpp v203, v242, v77 row_newbcast:11 row_mask:0xf bank_mask:0xf
    v_cvt_pk_bf16_f32 v72, v196, v197
    v_cvt_pk_bf16_f32 v76, v198, v199
    v_cvt_pk_bf16_f32 v73, v200, v201
    v_cvt_pk_bf16_f32 v77, v202, v203
    v_mul_f32_dpp v196, v242, v74 row_newbcast:4 row_mask:0xf bank_mask:0xf
    v_mul_f32_dpp v197, v242, v75 row_newbcast:5 row_mask:0xf bank_mask:0xf
    v_mul_f32_dpp v198, v242, v74 row_newbcast:12 row_mask:0xf bank_mask:0xf
    v_mul_f32_dpp v199, v242, v75 row_newbcast:13 row_mask:0xf bank_mask:0xf
    v_mul_f32_dpp v200, v242, v78 row_newbcast:6 row_mask:0xf bank_mask:0xf
    v_mul_f32_dpp v201, v242, v79 row_newbcast:7 row_mask:0xf bank_mask:0xf
    v_mul_f32_dpp v202, v242, v78 row_newbcast:14 row_mask:0xf bank_mask:0xf
    v_mul_f32_dpp v203, v242, v79 row_newbcast:15 row_mask:0xf bank_mask:0xf
    v_cvt_pk_bf16_f32 v74, v196, v197
    v_cvt_pk_bf16_f32 v78, v198, v199
    v_cvt_pk_bf16_f32 v75, v200, v201
    v_cvt_pk_bf16_f32 v79, v202, v203
    s_waitcnt vmcnt(4) lgkmcnt(0)
    v_mfma_f32_32x32x16_bf16 v[56:71], v[72:75], v[176:179], 0
    v_mul_f32_dpp v196, v243, v80 row_newbcast:0 row_mask:0xf bank_mask:0xf
    v_mul_f32_dpp v197, v243, v81 row_newbcast:1 row_mask:0xf bank_mask:0xf
    v_mul_f32_dpp v198, v243, v80 row_newbcast:8 row_mask:0xf bank_mask:0xf
    v_mul_f32_dpp v199, v243, v81 row_newbcast:9 row_mask:0xf bank_mask:0xf
    v_mul_f32_dpp v200, v243, v84 row_newbcast:2 row_mask:0xf bank_mask:0xf
    v_mul_f32_dpp v201, v243, v85 row_newbcast:3 row_mask:0xf bank_mask:0xf
    s_add_u32 m0, s21, 0
    v_mfma_f32_32x32x16_bf16 v[16:31], v[76:79], v[176:179], 0
    buffer_load_dwordx4 v234, s[4:7], s36 offen  lds
    buffer_load_dwordx4 v235, s[8:11], s36 offen offset:1024  lds
    ds_read_b64_tr_b16 v[176:177], v244 offset:2048
    ds_read_b64_tr_b16 v[184:185], v245 offset:2048
    v_mul_f32_dpp v202, v243, v84 row_newbcast:10 row_mask:0xf bank_mask:0xf
    v_mul_f32_dpp v203, v243, v85 row_newbcast:11 row_mask:0xf bank_mask:0xf
    v_cvt_pk_bf16_f32 v80, v196, v197
    v_cvt_pk_bf16_f32 v84, v198, v199
    v_cvt_pk_bf16_f32 v81, v200, v201
    v_cvt_pk_bf16_f32 v85, v202, v203
    s_waitcnt lgkmcnt(0)
    v_mfma_f32_32x32x8_bf16 v[56:71], v[80:81], v[176:177], v[56:71]
    s_add_u32 m0, s21, 2048
    v_mfma_f32_32x32x8_bf16 v[16:31], v[84:85], v[176:177], v[16:31]
    buffer_load_dwordx4 v236, s[4:7], s36 offen  lds
    s_mov_b32 m0, s50
    s_nop 0
    s_movrels_b32 s71, s23
    s_movrels_b32 s33, s28
    v_add_u32 v253, s33, v248
    s_bfe_u32 s46, s71, 0x30012
    s_mov_b32 m0, s46
    s_and_b32 s66, s71, 0x3ffff
    s_movrels_b32 s68, s57
    s_movrels_b32 s69, s61
    s_sub_u32 s48, s66, s47
    s_mov_b32 s47, s66
    s_lshr_b32 s52, s71, 28
    s_lshl_b32 s67, s46, 9
    s_add_u32 s66, s66, s67
    s_sub_u32 s49, s66, s42
    s_mov_b32 s42, s66
    s_bfe_u32 s66, s68, 655360
    s_add_u32 s43, s42, s66
    s_bfe_u32 s39, s69, 655360
    s_bfe_u32 s66, s68, 655370
    s_add_u32 s44, s42, s66
    s_bfe_u32 s40, s69, 655370
    s_bfe_u32 s66, s68, 655380
    s_add_u32 s45, s42, s66
    s_bfe_u32 s41, s69, 655380
    v_add_u32 v252, s44, v247
    ds_read2_b32 v[238:239], v252 offset0:0 offset1:16
    v_add_u32 v252, s45, v247
    ds_read2_b32 v[240:241], v252 offset0:0 offset1:16
    v_mfma_f32_32x32x16_bf16 v[32:47], v[72:75], v[180:183], 0
    v_mul_f32 v196, v56, v96
    v_fmac_f32 v196, v57, v97
    v_fmac_f32 v196, v58, v98
    v_fmac_f32 v196, v59, v99
    v_fmac_f32 v196, v60, v100
    v_fmac_f32 v196, v61, v101
    v_mfma_f32_32x32x16_bf16 v[0:15], v[76:79], v[180:183], 0
    s_waitcnt vmcnt(5)
    ds_read_b64_tr_b16 v[176:177], v244 offset:4096
    ds_read_b64_tr_b16 v[178:179], v244 offset:5120
    ds_read_b64_tr_b16 v[180:181], v245 offset:4096
    ds_read_b64_tr_b16 v[182:183], v245 offset:5120
    v_fmac_f32 v196, v62, v102
    v_fmac_f32 v196, v63, v103
    v_mfma_f32_32x32x8_bf16 v[32:47], v[80:81], v[184:185], v[32:47]
    v_mul_f32 v198, v64, v128
    v_fmac_f32 v198, v65, v129
    v_fmac_f32 v198, v66, v130
    v_fmac_f32 v198, v67, v131
    v_fmac_f32 v198, v68, v132
    v_fmac_f32 v198, v69, v133
    v_mfma_f32_32x32x8_bf16 v[0:15], v[84:85], v[184:185], v[0:15]
    v_fmac_f32 v198, v70, v134
    v_fmac_f32 v198, v71, v135
    v_mul_f32 v200, v16, v128
    v_fmac_f32 v200, v17, v129
    v_permlane32_swap_b32 v196, v198
    v_fmac_f32 v200, v18, v130
    v_fmac_f32 v200, v19, v131
    v_fmac_f32 v200, v20, v132
    v_fmac_f32 v200, v21, v133
    v_fmac_f32 v200, v22, v134
    v_fmac_f32 v200, v23, v135
    v_add_f32 v198, v196, v198
    v_mul_f32_e64 v202, v24, -v128
    v_fma_f32 v202, v25, -v129, v202
    v_fma_f32 v202, v26, -v130, v202
    v_fma_f32 v202, v27, -v131, v202
    v_fma_f32 v202, v28, -v132, v202
    v_fma_f32 v202, v29, -v133, v202
    v_fma_f32 v202, v30, -v134, v202
    v_fma_f32 v202, v31, -v135, v202
    s_nop 1
    v_permlane32_swap_b32 v200, v202
    v_add_f32 v202, v200, v202
    s_waitcnt vmcnt(3) lgkmcnt(0)
    v_mfma_f32_32x32x16_bf16 v[56:71], v[72:75], v[176:179], 0
    v_mul_f32 v197, v32, v104
    v_fmac_f32 v197, v33, v105
    v_fmac_f32 v197, v34, v106
    v_fmac_f32 v197, v35, v107
    v_fmac_f32 v197, v36, v108
    v_fmac_f32 v197, v37, v109
    s_add_u32 m0, s21, 4096
    v_mfma_f32_32x32x16_bf16 v[16:31], v[76:79], v[176:179], 0
    buffer_load_dwordx4 v234, s[4:7], s37 offen  lds
    buffer_load_dwordx4 v235, s[8:11], s37 offen offset:1024  lds
    ds_read_b64_tr_b16 v[176:177], v244 offset:6144
    ds_read_b64_tr_b16 v[184:185], v245 offset:6144
    v_add_u32 v252, s42, v247
    ds_read2_b32 v[234:235], v252 offset0:0 offset1:16
    v_fmac_f32 v197, v38, v110
    v_fmac_f32 v197, v39, v111
    v_mul_f32 v199, v40, v136
    v_fmac_f32 v199, v41, v137
    v_fmac_f32 v199, v42, v138
    v_fmac_f32 v199, v43, v139
    v_fmac_f32 v199, v44, v140
    v_fmac_f32 v199, v45, v141
    v_fmac_f32 v199, v46, v142
    v_fmac_f32 v199, v47, v143
    v_mul_f32 v201, v0, v136
    v_fmac_f32 v201, v1, v137
    v_permlane32_swap_b32 v197, v199
    v_fmac_f32 v201, v2, v138
    v_fmac_f32 v201, v3, v139
    v_fmac_f32 v201, v4, v140
    v_fmac_f32 v201, v5, v141
    v_fmac_f32 v201, v6, v142
    v_fmac_f32 v201, v7, v143
    v_add_f32 v199, v197, v199
    v_mul_f32_e64 v203, v8, -v136
    v_fma_f32 v203, v9, -v137, v203
    v_fma_f32 v203, v10, -v138, v203
    s_waitcnt lgkmcnt(1)
    v_mfma_f32_32x32x8_bf16 v[56:71], v[80:81], v[176:177], v[56:71]
    v_fma_f32 v203, v11, -v139, v203
    v_fma_f32 v203, v12, -v140, v203
    v_fma_f32 v203, v13, -v141, v203
    v_fma_f32 v203, v14, -v142, v203
    v_fma_f32 v203, v15, -v143, v203
    s_nop 1
    v_permlane32_swap_b32 v201, v203
    s_add_u32 m0, s21, 6144
    v_mfma_f32_32x32x8_bf16 v[16:31], v[84:85], v[176:177], v[16:31]
    buffer_load_dwordx4 v236, s[4:7], s37 offen  lds
    v_add_u32 v252, s43, v247
    ds_read2_b32 v[236:237], v252 offset0:0 offset1:16
    v_add_f32 v203, v201, v203
    v_cvt_pk_bf16_f32 v192, v198, v199
    v_cvt_pk_bf16_f32 v193, v202, v203
    v_mfma_f32_32x32x16_bf16 v[32:47], v[72:75], v[180:183], 0
    v_mul_f32 v196, v56, v144
    v_fmac_f32 v196, v57, v145
    v_fmac_f32 v196, v58, v146
    v_fmac_f32 v196, v59, v147
    v_fmac_f32 v196, v60, v148
    v_fmac_f32 v196, v61, v149
    v_mfma_f32_32x32x16_bf16 v[0:15], v[76:79], v[180:183], 0
    s_waitcnt vmcnt(4)
    ds_read_b64_tr_b16 v[176:177], v244 offset:0
    ds_read_b64_tr_b16 v[178:179], v244 offset:1024
    ds_read_b64_tr_b16 v[180:181], v245 offset:0
    ds_read_b64_tr_b16 v[182:183], v245 offset:1024
    v_fmac_f32 v196, v62, v150
    v_fmac_f32 v196, v63, v151
    v_mfma_f32_32x32x8_bf16 v[32:47], v[80:81], v[184:185], v[32:47]
    v_mul_f32_e64 v200, v16, -v160
    v_fma_f32 v200, v17, -v161, v200
    v_fma_f32 v200, v18, -v162, v200
    v_fma_f32 v200, v19, -v163, v200
    v_fma_f32 v200, v20, -v164, v200
    v_fma_f32 v200, v21, -v165, v200
    v_mfma_f32_32x32x8_bf16 v[0:15], v[84:85], v[184:185], v[0:15]
    v_fma_f32 v200, v22, -v166, v200
    v_fma_f32 v200, v23, -v167, v200
    v_mul_f32_e64 v202, v24, -v160
    v_fma_f32 v202, v25, -v161, v202
    v_fma_f32 v202, v26, -v162, v202
    v_fma_f32 v202, v27, -v163, v202
    v_fma_f32 v202, v28, -v164, v202
    v_fma_f32 v202, v29, -v165, v202
    v_fma_f32 v202, v30, -v166, v202
    v_fma_f32 v202, v31, -v167, v202
    s_waitcnt vmcnt(3) lgkmcnt(0)
    v_mfma_f32_32x32x16_bf16 v[16:31], v[72:75], v[176:179], 0
    v_mul_f32 v197, v32, v152
    v_fmac_f32 v197, v33, v153
    v_fmac_f32 v197, v34, v154
    v_fmac_f32 v197, v35, v155
    v_fmac_f32 v197, v36, v156
    v_fmac_f32 v197, v37, v157
    s_add_u32 m0, s21, 0
    v_mfma_f32_32x32x16_bf16 v[48:63], v[76:79], v[176:179], 0
    s_cbranch_vccnz WL_3_0
    v_mad_u32_u16 v234, v234, s3, v246 op_sel:[1,0,0,0]
    v_mad_u32_u16 v235, v235, s3, v246 op_sel:[1,0,0,0]
    buffer_load_dwordx4 v234, s[4:7], s38 offen  lds
    buffer_load_dwordx4 v235, s[8:11], s38 offen offset:1024  lds
WR_3_0:
    ds_read_b64_tr_b16 v[176:177], v244 offset:2048
    ds_read_b64_tr_b16 v[184:185], v245 offset:2048
    v_fmac_f32 v197, v38, v158
    v_fmac_f32 v197, v39, v159
    v_mul_f32_e64 v201, v0, -v168
    v_fma_f32 v201, v1, -v169, v201
    v_fma_f32 v201, v2, -v170, v201
    v_fma_f32 v201, v3, -v171, v201
    v_fma_f32 v201, v4, -v172, v201
    v_fma_f32 v201, v5, -v173, v201
    v_fma_f32 v201, v6, -v174, v201
    v_fma_f32 v201, v7, -v175, v201
    s_waitcnt lgkmcnt(0)
    v_mfma_f32_32x32x8_bf16 v[16:31], v[80:81], v[176:177], v[16:31]
    v_mul_f32_e64 v203, v8, -v168
    v_fma_f32 v203, v9, -v169, v203
    v_fma_f32 v203, v10, -v170, v203
    v_fma_f32 v203, v11, -v171, v203
    v_fma_f32 v203, v12, -v172, v203
    v_fma_f32 v203, v13, -v173, v203
    s_add_u32 m0, s21, 2048
    v_mfma_f32_32x32x8_bf16 v[48:63], v[84:85], v[176:177], v[48:63]
    s_cbranch_vccnz WL_3_1
    v_mad_u32_u16 v236, v236, s3, v246 op_sel:[1,0,0,0]
    v_mad_u32_u16 v237, v237, s3, v246 op_sel:[1,0,0,0]
    buffer_load_dwordx4 v236, s[4:7], s39 offen  lds
    buffer_load_dwordx4 v237, s[8:11], s39 offen offset:1024  lds
WR_3_1:
    v_fma_f32 v203, v14, -v174, v203
    v_fma_f32 v203, v15, -v175, v203
    v_mfma_f32_32x32x16_bf16 v[0:15], v[72:75], v[180:183], 0
    v_fmac_f32 v200, v24, v160
    v_fmac_f32 v200, v25, v161
    v_fmac_f32 v200, v26, v162
    v_fmac_f32 v200, v27, v163
    v_fmac_f32 v200, v28, v164
    v_fmac_f32 v200, v29, v165
    v_fmac_f32 v200, v30, v166
    v_fmac_f32 v200, v31, v167
    v_mfma_f32_32x32x16_bf16 v[24:39], v[76:79], v[180:183], 0
    s_waitcnt vmcnt(5)
    ds_read_b64_tr_b16 v[176:177], v244 offset:4096
    ds_read_b64_tr_b16 v[178:179], v244 offset:5120
    ds_read_b64_tr_b16 v[180:181], v245 offset:4096
    ds_read_b64_tr_b16 v[182:183], v245 offset:5120
    v_mul_f32 v254, v16, v144
    v_fmac_f32 v254, v17, v145
    v_mfma_f32_32x32x8_bf16 v[24:39], v[84:85], v[184:185], v[24:39]
    v_fmac_f32 v254, v18, v146
    v_fmac_f32 v254, v19, v147
    v_fmac_f32 v254, v20, v148
    v_fmac_f32 v254, v21, v149
    v_fmac_f32 v254, v22, v150
    v_fmac_f32 v254, v23, v151
    v_mfma_f32_32x32x8_bf16 v[0:15], v[80:81], v[184:185], v[0:15]
    v_sub_f32_e64 v64, -v48, v64
    v_sub_f32_e64 v65, -v49, v65
    v_permlane32_swap_b32 v196, v254
    v_sub_f32_e64 v66, -v50, v66
    v_sub_f32_e64 v67, -v51, v67
    v_sub_f32_e64 v68, -v52, v68
    v_sub_f32_e64 v69, -v53, v69
    v_sub_f32_e64 v70, -v54, v70
    v_sub_f32_e64 v71, -v55, v71
    v_add_f32 v254, v196, v254
    s_waitcnt vmcnt(4) lgkmcnt(0)
    v_mfma_f32_32x32x16_bf16 v[56:71], v[76:79], v[176:179], v[56:71]
    v_sub_f32_e64 v40, -v24, v40
    v_sub_f32_e64 v41, -v25, v41
    v_sub_f32_e64 v42, -v26, v42
    v_sub_f32_e64 v43, -v27, v43
    v_sub_f32_e64 v44, -v28, v44
    v_sub_f32_e64 v45, -v29, v45
    v_sub_f32_e64 v46, -v30, v46
    v_sub_f32_e64 v47, -v31, v47
    s_add_u32 m0, s21, 4096
    v_mfma_f32_32x32x16_bf16 v[16:31], v[72:75], v[176:179], 0
    s_cbranch_vccnz WL_3_2
    v_mad_u32_u16 v238, v238, s3, v246 op_sel:[1,0,0,0]
    v_mad_u32_u16 v239, v239, s3, v246 op_sel:[1,0,0,0]
    buffer_load_dwordx4 v238, s[4:7], s40 offen  lds
    buffer_load_dwordx4 v239, s[8:11], s40 offen offset:1024  lds
WR_3_2:
    ds_read_b64_tr_b16 v[176:177], v244 offset:6144
    ds_read_b64_tr_b16 v[184:185], v245 offset:6144
    v_mul_f32 v255, v0, v152
    v_fmac_f32 v255, v1, v153
    v_fmac_f32 v255, v2, v154
    v_fmac_f32 v255, v3, v155
    v_fmac_f32 v255, v4, v156
    v_fmac_f32 v255, v5, v157
    v_fmac_f32 v255, v6, v158
    v_fmac_f32 v255, v7, v159
    v_fmac_f32 v201, v8, v168
    v_fmac_f32 v201, v9, v169
    v_permlane32_swap_b32 v197, v255
    s_waitcnt lgkmcnt(0)
    v_mfma_f32_32x32x8_bf16 v[16:31], v[80:81], v[176:177], v[16:31]
    v_fmac_f32 v201, v10, v170
    v_fmac_f32 v201, v11, v171
    v_fmac_f32 v201, v12, v172
    v_fmac_f32 v201, v13, v173
    v_fmac_f32 v201, v14, v174
    v_fmac_f32 v201, v15, v175
    s_add_u32 m0, s21, 6144
    v_mfma_f32_32x32x8_bf16 v[56:71], v[84:85], v[176:177], v[56:71]
    s_cbranch_vccnz WL_3_3
    v_mad_u32_u16 v240, v240, s3, v246 op_sel:[1,0,0,0]
    v_mad_u32_u16 v241, v241, s3, v246 op_sel:[1,0,0,0]
    buffer_load_dwordx4 v240, s[4:7], s41 offen  lds
    buffer_load_dwordx4 v241, s[8:11], s41 offen offset:1024  lds
WR_3_3:
    v_add_f32 v255, v197, v255
    v_cvt_pk_bf16_f32 v194, v254, v255
    v_mfma_f32_32x32x16_bf16 v[0:15], v[72:75], v[180:183], 0
    v_mul_f32 v254, v16, v144
    v_fmac_f32 v254, v17, v145
    v_fmac_f32 v254, v18, v146
    v_fmac_f32 v254, v19, v147
    v_fmac_f32 v254, v20, v148
    v_fmac_f32 v254, v21, v149
    v_mfma_f32_32x32x16_bf16 v[32:47], v[76:79], v[180:183], v[32:47]
    s_waitcnt vmcnt(6)
    ds_read_b64_tr_b16 v[176:177], v244 offset:0
    ds_read_b64_tr_b16 v[178:179], v244 offset:1024
    ds_read_b64_tr_b16 v[180:181], v245 offset:0
    ds_read_b64_tr_b16 v[182:183], v245 offset:1024
    v_fmac_f32 v254, v22, v150
    v_fmac_f32 v254, v23, v151
    v_mfma_f32_32x32x8_bf16 v[0:15], v[80:81], v[184:185], v[0:15]
    v_fma_f32 v202, v24, -v160, v202
    v_fma_f32 v202, v25, -v161, v202
    v_permlane32_swap_b32 v254, v200
    v_fma_f32 v202, v26, -v162, v202
    v_fma_f32 v202, v27, -v163, v202
    v_fma_f32 v202, v28, -v164, v202
    v_mfma_f32_32x32x8_bf16 v[32:47], v[84:85], v[184:185], v[32:47]
    v_add_u32 v249, s48, v249
    v_add_u32 v250, s49, v250
    ds_read_b32 v252, v251 offset:16
    ds_read_b64_tr_b16 v[72:73], v249 offset:0
    ds_read_b64_tr_b16 v[76:77], v249 offset:64
    ds_read_b64_tr_b16 v[74:75], v249 offset:256
    ds_read_b64_tr_b16 v[78:79], v249 offset:320
    s_mov_b64 exec, s[54:55]
    ds_read_u16_d16_hi v242, v250 offset:0
    s_mov_b64 exec, -1
    v_fma_f32 v202, v29, -v165, v202
    v_fma_f32 v202, v30, -v166, v202
    v_fma_f32 v202, v31, -v167, v202
    v_add_f32 v200, v254, v200
    v_mul_f32_e64 v198, v64, -v112
    v_permlane32_swap_b32 v202, v254
    v_fma_f32 v198, v65, -v113, v198
    v_fma_f32 v198, v66, -v114, v198
    v_fma_f32 v198, v67, -v115, v198
    v_fma_f32 v198, v68, -v116, v198
    v_fma_f32 v198, v69, -v117, v198
    v_fma_f32 v198, v70, -v118, v198
    v_fma_f32 v198, v71, -v119, v198
    v_add_f32 v254, v202, v254
    v_mul_f32 v196, v56, v160
    v_fmac_f32 v196, v57, v161
    v_fmac_f32 v196, v58, v162
    v_fmac_f32 v196, v59, v163
    v_fmac_f32 v196, v60, v164
    v_fmac_f32 v196, v61, v165
    v_fmac_f32 v196, v62, v166
    v_fmac_f32 v196, v63, v167
    s_nop 1
    v_permlane32_swap_b32 v198, v196
    v_add_f32 v196, v198, v196
    s_cbranch_vccnz LEPI_0
    v_mul_f32 v255, v0, v152
    v_fmac_f32 v255, v1, v153
    v_fmac_f32 v255, v2, v154
    v_fmac_f32 v255, v3, v155
    v_fmac_f32 v255, v4, v156
    v_fmac_f32 v255, v5, v157
    v_fmac_f32 v255, v6, v158
    v_fmac_f32 v255, v7, v159
    v_fma_f32 v203, v8, -v168, v203
    v_fma_f32 v203, v9, -v169, v203
    v_permlane32_swap_b32 v255, v201
    v_fma_f32 v203, v10, -v170, v203
    v_fma_f32 v203, v11, -v171, v203
    v_fma_f32 v203, v12, -v172, v203
    v_fma_f32 v203, v13, -v173, v203
    v_fma_f32 v203, v14, -v174, v203
    v_fma_f32 v203, v15, -v175, v203
    v_add_f32 v201, v255, v201
    v_mul_f32_e64 v199, v40, -v120
    v_permlane32_swap_b32 v203, v255
    v_fma_f32 v199, v41, -v121, v199
    v_fma_f32 v199, v42, -v122, v199
    v_fma_f32 v199, v43, -v123, v199
    v_fma_f32 v199, v44, -v124, v199
    v_fma_f32 v199, v45, -v125, v199
    v_fma_f32 v199, v46, -v126, v199
    v_fma_f32 v199, v47, -v127, v199
    v_add_f32 v255, v203, v255
    v_mul_f32 v197, v32, v168
    v_fmac_f32 v197, v33, v169
    v_fmac_f32 v197, v34, v170
    v_fmac_f32 v197, v35, v171
    v_fmac_f32 v197, v36, v172
    v_fmac_f32 v197, v37, v173
    v_fmac_f32 v197, v38, v174
    v_fmac_f32 v197, v39, v175
    s_nop 1
    v_permlane32_swap_b32 v199, v197
    v_add_f32 v197, v199, v197
    v_cvt_pk_bf16_f32 v200, v200, v201
    v_cvt_pk_bf16_f32 v254, v254, v255
    v_cvt_pk_bf16_f32 v196, v196, v197
    ds_write2st64_b32 v253, v192, v193 offset0:0 offset1:1
    ds_write2st64_b32 v253, v194, v200 offset0:2 offset1:3
    ds_write_b32 v253, v196 offset:1024
    s_mov_b64 exec, 0xffffffff
    ds_write_b32 v253, v254 offset:1280
    s_mov_b64 exec, -1
    s_add_u32 s50, s50, 1
    s_cmp_ge_u32 s50, 4
    s_cbranch_scc1 LAST1
    s_waitcnt lgkmcnt(9)
    v_readfirstlane_b32 s66, v252
    s_add_u32 s53, s53, 1
    v_mov_b32 v252, s53
    s_cmp_le_u32 s53, s66
    ds_write2_b32 v251, v252, v252 offset0:0 offset1:8
    s_setprio 1
    s_cbranch_scc1 PRIO_13
    s_setprio 0
PRIO_13:
    s_cmp_eq_u32 s52, 4
    s_cbranch_scc1 ITEM_1_4
    s_cmp_eq_u32 s52, 5
    s_cbranch_scc1 ITEM_1_5
    s_cmp_eq_u32 s52, 3
    s_cbranch_scc1 ITEM_1_3
    s_cmp_eq_u32 s52, 6
    s_cbranch_scc1 ITEM_1_6
    s_cmp_eq_u32 s52, 8
    s_cbranch_scc1 ITEM_1_8
    s_branch ITEM_1_2
WL_3_0:
    s_add_u32 s66, s51, 0
    buffer_load_dwordx4 v[96:99], v246, s[16:19], s66 offen offset:2048 sc1
    buffer_load_dwordx4 v[100:103], v246, s[16:19], s66 offen offset:3072 sc1
    s_branch WR_3_0
WL_3_1:
    s_add_u32 s66, s51, 4096
    buffer_load_dwordx4 v[104:107], v246, s[16:19], s66 offen offset:2048 sc1
    buffer_load_dwordx4 v[108:111], v246, s[16:19], s66 offen offset:3072 sc1
    s_branch WR_3_1
WL_3_2:
    s_add_u32 s66, s51, 8192
    buffer_load_dwordx4 v[128:131], v246, s[16:19], s66 offen offset:2048 sc1
    buffer_load_dwordx4 v[132:135], v246, s[16:19], s66 offen offset:3072 sc1
    s_branch WR_3_2
WL_3_3:
    s_add_u32 s66, s51, 12288
    buffer_load_dwordx4 v[136:139], v246, s[16:19], s66 offen offset:2048 sc1
    buffer_load_dwordx4 v[140:143], v246, s[16:19], s66 offen offset:3072 sc1
    s_branch WR_3_3
.p2align 6
ITEM_1_6:
    s_mov_b64 exec, s[54:55]
    ds_read_u16_d16_hi v243, v250 offset:128
    s_mov_b64 exec, -1
    ds_read_b64_tr_b16 v[80:81], v249 offset:512
    ds_read_b64_tr_b16 v[84:85], v249 offset:576
    ds_read_b64_tr_b16 v[82:83], v249 offset:768
    ds_read_b64_tr_b16 v[86:87], v249 offset:832
    ds_read_b64_tr_b16 v[88:89], v249 offset:1024
    ds_read_b64_tr_b16 v[92:93], v249 offset:1088
    ds_read_b64_tr_b16 v[90:91], v249 offset:1280
    ds_read_b64_tr_b16 v[94:95], v249 offset:1344
    s_waitcnt lgkmcnt(9)
    v_mul_f32_dpp v196, v242, v72 row_newbcast:0 row_mask:0xf bank_mask:0xf
    v_mul_f32_dpp v197, v242, v73 row_newbcast:1 row_mask:0xf bank_mask:0xf
    v_mul_f32_dpp v198, v242, v72 row_newbcast:8 row_mask:0xf bank_mask:0xf
    v_mul_f32_dpp v199, v242, v73 row_newbcast:9 row_mask:0xf bank_mask:0xf
    v_mul_f32_dpp v200, v242, v76 row_newbcast:2 row_mask:0xf bank_mask:0xf
    v_mul_f32_dpp v201, v242, v77 row_newbcast:3 row_mask:0xf bank_mask:0xf
    v_mul_f32_dpp v202, v242, v76 row_newbcast:10 row_mask:0xf bank_mask:0xf
    v_mul_f32_dpp v203, v242, v77 row_newbcast:11 row_mask:0xf bank_mask:0xf
    v_cvt_pk_bf16_f32 v72, v196, v197
    v_cvt_pk_bf16_f32 v76, v198, v199
    v_cvt_pk_bf16_f32 v73, v200, v201
    v_cvt_pk_bf16_f32 v77, v202, v203
    v_mul_f32_dpp v196, v242, v74 row_newbcast:4 row_mask:0xf bank_mask:0xf
    v_mul_f32_dpp v197, v242, v75 row_newbcast:5 row_mask:0xf bank_mask:0xf
    v_mul_f32_dpp v198, v242, v74 row_newbcast:12 row_mask:0xf bank_mask:0xf
    v_mul_f32_dpp v199, v242, v75 row_newbcast:13 row_mask:0xf bank_mask:0xf
    v_mul_f32_dpp v200, v242, v78 row_newbcast:6 row_mask:0xf bank_mask:0xf
    v_mul_f32_dpp v201, v242, v79 row_newbcast:7 row_mask:0xf bank_mask:0xf
    v_mul_f32_dpp v202, v242, v78 row_newbcast:14 row_mask:0xf bank_mask:0xf
    v_mul_f32_dpp v203, v242, v79 row_newbcast:15 row_mask:0xf bank_mask:0xf
    v_cvt_pk_bf16_f32 v74, v196, v197
    v_cvt_pk_bf16_f32 v78, v198, v199
    v_cvt_pk_bf16_f32 v75, v200, v201
    v_cvt_pk_bf16_f32 v79, v202, v203
    s_mov_b64 exec, s[54:55]
    ds_read_u16_d16_hi v242, v250 offset:256
    s_mov_b64 exec, -1
    s_waitcnt vmcnt(4) lgkmcnt(5)
    v_mfma_f32_32x32x16_bf16 v[56:71], v[72:75], v[176:179], 0
    v_mul_f32_dpp v196, v243, v80 row_newbcast:0 row_mask:0xf bank_mask:0xf
    v_mul_f32_dpp v197, v243, v81 row_newbcast:1 row_mask:0xf bank_mask:0xf
    v_mul_f32_dpp v198, v243, v80 row_newbcast:8 row_mask:0xf bank_mask:0xf
    v_mul_f32_dpp v199, v243, v81 row_newbcast:9 row_mask:0xf bank_mask:0xf
    v_mul_f32_dpp v200, v243, v84 row_newbcast:2 row_mask:0xf bank_mask:0xf
    v_mul_f32_dpp v201, v243, v85 row_newbcast:3 row_mask:0xf bank_mask:0xf
    s_add_u32 m0, s21, 0
    v_mfma_f32_32x32x16_bf16 v[16:31], v[76:79], v[176:179], 0
    buffer_load_dwordx4 v236, s[4:7], s35 offen  lds
    buffer_load_dwordx4 v237, s[8:11], s35 offen offset:1024  lds
    ds_read_b64_tr_b16 v[176:177], v244 offset:2048
    ds_read_b64_tr_b16 v[178:179], v244 offset:3072
    ds_read_b64_tr_b16 v[184:185], v245 offset:2048
    ds_read_b64_tr_b16 v[186:187], v245 offset:3072
    v_mul_f32_dpp v202, v243, v84 row_newbcast:10 row_mask:0xf bank_mask:0xf
    v_mul_f32_dpp v203, v243, v85 row_newbcast:11 row_mask:0xf bank_mask:0xf
    v_cvt_pk_bf16_f32 v80, v196, v197
    v_cvt_pk_bf16_f32 v84, v198, v199
    v_cvt_pk_bf16_f32 v81, v200, v201
    v_cvt_pk_bf16_f32 v85, v202, v203
    v_mul_f32_dpp v196, v243, v82 row_newbcast:4 row_mask:0xf bank_mask:0xf
    v_mul_f32_dpp v197, v243, v83 row_newbcast:5 row_mask:0xf bank_mask:0xf
    v_mul_f32_dpp v198, v243, v82 row_newbcast:12 row_mask:0xf bank_mask:0xf
    v_mul_f32_dpp v199, v243, v83 row_newbcast:13 row_mask:0xf bank_mask:0xf
    v_mul_f32_dpp v200, v243, v86 row_newbcast:6 row_mask:0xf bank_mask:0xf
    v_mul_f32_dpp v201, v243, v87 row_newbcast:7 row_mask:0xf bank_mask:0xf
    v_mul_f32_dpp v202, v243, v86 row_newbcast:14 row_mask:0xf bank_mask:0xf
    v_mul_f32_dpp v203, v243, v87 row_newbcast:15 row_mask:0xf bank_mask:0xf
    v_cvt_pk_bf16_f32 v82, v196, v197
    v_cvt_pk_bf16_f32 v86, v198, v199
    v_cvt_pk_bf16_f32 v83, v200, v201
    v_cvt_pk_bf16_f32 v87, v202, v203
    s_waitcnt vmcnt(4) lgkmcnt(0)
    v_mfma_f32_32x32x16_bf16 v[56:71], v[80:83], v[176:179], v[56:71]
    v_mul_f32_dpp v196, v242, v88 row_newbcast:0 row_mask:0xf bank_mask:0xf
    v_mul_f32_dpp v197, v242, v89 row_newbcast:1 row_mask:0xf bank_mask:0xf
    v_mul_f32_dpp v198, v242, v88 row_newbcast:8 row_mask:0xf bank_mask:0xf
    v_mul_f32_dpp v199, v242, v89 row_newbcast:9 row_mask:0xf bank_mask:0xf
    v_mul_f32_dpp v200, v242, v92 row_newbcast:2 row_mask:0xf bank_mask:0xf
    v_mul_f32_dpp v201, v242, v93 row_newbcast:3 row_mask:0xf bank_mask:0xf
    s_add_u32 m0, s21, 2048
    v_mfma_f32_32x32x16_bf16 v[16:31], v[84:87], v[176:179], v[16:31]
    buffer_load_dwordx4 v238, s[4:7], s35 offen  lds
    buffer_load_dwordx4 v239, s[8:11], s35 offen offset:1024  lds
    ds_read_b64_tr_b16 v[176:177], v244 offset:4096
    ds_read_b64_tr_b16 v[178:179], v244 offset:5120
    ds_read_b64_tr_b16 v[188:189], v245 offset:4096
    ds_read_b64_tr_b16 v[190:191], v245 offset:5120
    v_mul_f32_dpp v202, v242, v92 row_newbcast:10 row_mask:0xf bank_mask:0xf
    v_mul_f32_dpp v203, v242, v93 row_newbcast:11 row_mask:0xf bank_mask:0xf
    v_cvt_pk_bf16_f32 v88, v196, v197
    v_cvt_pk_bf16_f32 v92, v198, v199
    v_cvt_pk_bf16_f32 v89, v200, v201
    v_cvt_pk_bf16_f32 v93, v202, v203
    v_mul_f32_dpp v196, v242, v90 row_newbcast:4 row_mask:0xf bank_mask:0xf
    v_mul_f32_dpp v197, v242, v91 row_newbcast:5 row_mask:0xf bank_mask:0xf
    v_mul_f32_dpp v198, v242, v90 row_newbcast:12 row_mask:0xf bank_mask:0xf
    v_mul_f32_dpp v199, v242, v91 row_newbcast:13 row_mask:0xf bank_mask:0xf
    v_mul_f32_dpp v200, v242, v94 row_newbcast:6 row_mask:0xf bank_mask:0xf
    v_mul_f32_dpp v201, v242, v95 row_newbcast:7 row_mask:0xf bank_mask:0xf
    v_mul_f32_dpp v202, v242, v94 row_newbcast:14 row_mask:0xf bank_mask:0xf
    v_mul_f32_dpp v203, v242, v95 row_newbcast:15 row_mask:0xf bank_mask:0xf
    v_cvt_pk_bf16_f32 v90, v196, v197
    v_cvt_pk_bf16_f32 v94, v198, v199
    v_cvt_pk_bf16_f32 v91, v200, v201
    v_cvt_pk_bf16_f32 v95, v202, v203
    s_waitcnt lgkmcnt(0)
    v_mfma_f32_32x32x16_bf16 v[56:71], v[88:91], v[176:179], v[56:71]
    s_add_u32 m0, s21, 4096
    v_mfma_f32_32x32x16_bf16 v[16:31], v[92:95], v[176:179], v[16:31]
    buffer_load_dwordx4 v234, s[4:7], s36 offen  lds
    buffer_load_dwordx4 v235, s[8:11], s36 offen offset:1024  lds
    s_mov_b32 m0, s50
    s_nop 0
    s_movrels_b32 s71, s23
    s_movrels_b32 s33, s28
    v_add_u32 v253, s33, v248
    s_bfe_u32 s46, s71, 0x30012
    s_mov_b32 m0, s46
    s_and_b32 s66, s71, 0x3ffff
    s_movrels_b32 s68, s57
    s_movrels_b32 s69, s61
    s_sub_u32 s48, s66, s47
    s_mov_b32 s47, s66
    s_lshr_b32 s52, s71, 28
    s_lshl_b32 s67, s46, 9
    s_add_u32 s66, s66, s67
    s_sub_u32 s49, s66, s42
    s_mov_b32 s42, s66
    s_bfe_u32 s66, s68, 655360
    s_add_u32 s43, s42, s66
    s_bfe_u32 s39, s69, 655360
    s_bfe_u32 s66, s68, 655370
    s_add_u32 s44, s42, s66
    s_bfe_u32 s40, s69, 655370
    s_bfe_u32 s66, s68, 655380
    s_add_u32 s45, s42, s66
    s_bfe_u32 s41, s69, 655380
    v_add_u32 v252, s45, v247
    ds_read2_b32 v[240:241], v252 offset0:0 offset1:16
    v_mfma_f32_32x32x16_bf16 v[32:47], v[72:75], v[180:183], 0
    v_mul_f32 v196, v56, v96
    v_fmac_f32 v196, v57, v97
    v_fmac_f32 v196, v58, v98
    v_fmac_f32 v196, v59, v99
    v_fmac_f32 v196, v60, v100
    v_fmac_f32 v196, v61, v101
    v_mfma_f32_32x32x16_bf16 v[0:15], v[76:79], v[180:183], 0
    v_fmac_f32 v196, v62, v102
    v_fmac_f32 v196, v63, v103
    v_mul_f32 v198, v64, v128
    v_fmac_f32 v198, v65, v129
    v_fmac_f32 v198, v66, v130
    v_fmac_f32 v198, v67, v131
    v_mfma_f32_32x32x16_bf16 v[32:47], v[80:83], v[184:187], v[32:47]
    v_fmac_f32 v198, v68, v132
    v_fmac_f32 v198, v69, v133
    v_fmac_f32 v198, v70, v134
    v_fmac_f32 v198, v71, v135
    v_mul_f32 v200, v16, v128
    v_fmac_f32 v200, v17, v129
    v_mfma_f32_32x32x16_bf16 v[0:15], v[84:87], v[184:187], v[0:15]
    s_waitcnt vmcnt(6)
    ds_read_b64_tr_b16 v[176:177], v244 offset:6144
    ds_read_b64_tr_b16 v[178:179], v244 offset:7168
    ds_read_b64_tr_b16 v[180:181], v245 offset:6144
    ds_read_b64_tr_b16 v[182:183], v245 offset:7168
    v_permlane32_swap_b32 v196, v198
    v_fmac_f32 v200, v18, v130
    v_mfma_f32_32x32x16_bf16 v[32:47], v[88:91], v[188:191], v[32:47]
    v_fmac_f32 v200, v19, v131
    v_fmac_f32 v200, v20, v132
    v_fmac_f32 v200, v21, v133
    v_fmac_f32 v200, v22, v134
    v_fmac_f32 v200, v23, v135
    v_add_f32 v198, v196, v198
    v_mfma_f32_32x32x16_bf16 v[0:15], v[92:95], v[188:191], v[0:15]
    v_mul_f32_e64 v202, v24, -v128
    v_fma_f32 v202, v25, -v129, v202
    v_fma_f32 v202, v26, -v130, v202
    v_fma_f32 v202, v27, -v131, v202
    v_fma_f32 v202, v28, -v132, v202
    v_fma_f32 v202, v29, -v133, v202
    v_fma_f32 v202, v30, -v134, v202
    v_fma_f32 v202, v31, -v135, v202
    s_nop 1
    v_permlane32_swap_b32 v200, v202
    v_add_f32 v202, v200, v202
    s_waitcnt vmcnt(4) lgkmcnt(0)
    v_mfma_f32_32x32x16_bf16 v[56:71], v[72:75], v[176:179], 0
    v_mul_f32 v197, v32, v104
    v_fmac_f32 v197, v33, v105
    v_fmac_f32 v197, v34, v106
    v_fmac_f32 v197, v35, v107
    v_fmac_f32 v197, v36, v108
    v_fmac_f32 v197, v37, v109
    s_add_u32 m0, s21, 6144
    v_mfma_f32_32x32x16_bf16 v[16:31], v[76:79], v[176:179], 0
    buffer_load_dwordx4 v236, s[4:7], s36 offen  lds
    buffer_load_dwordx4 v237, s[8:11], s36 offen offset:1024  lds
    ds_read_b64_tr_b16 v[176:177], v244 offset:0
    ds_read_b64_tr_b16 v[178:179], v244 offset:1024
    ds_read_b64_tr_b16 v[184:185], v245 offset:0
    ds_read_b64_tr_b16 v[186:187], v245 offset:1024
    v_fmac_f32 v197, v38, v110
    v_fmac_f32 v197, v39, v111
    v_mul_f32 v199, v40, v136
    v_fmac_f32 v199, v41, v137
    v_fmac_f32 v199, v42, v138
    v_fmac_f32 v199, v43, v139
    v_fmac_f32 v199, v44, v140
    v_fmac_f32 v199, v45, v141
    v_fmac_f32 v199, v46, v142
    v_fmac_f32 v199, v47, v143
    v_mul_f32 v201, v0, v136
    v_fmac_f32 v201, v1, v137
    v_permlane32_swap_b32 v197, v199
    v_fmac_f32 v201, v2, v138
    v_fmac_f32 v201, v3, v139
    v_fmac_f32 v201, v4, v140
    v_fmac_f32 v201, v5, v141
    v_fmac_f32 v201, v6, v142
    s_waitcnt vmcnt(4) lgkmcnt(0)
    v_mfma_f32_32x32x16_bf16 v[56:71], v[80:83], v[176:179], v[56:71]
    v_fmac_f32 v201, v7, v143
    v_add_f32 v199, v197, v199
    v_mul_f32_e64 v203, v8, -v136
    v_fma_f32 v203, v9, -v137, v203
    v_fma_f32 v203, v10, -v138, v203
    v_fma_f32 v203, v11, -v139, v203
    s_add_u32 m0, s21, 0
    v_mfma_f32_32x32x16_bf16 v[16:31], v[84:87], v[176:179], v[16:31]
    buffer_load_dwordx4 v238, s[4:7], s36 offen  lds
    buffer_load_dwordx4 v239, s[8:11], s36 offen offset:1024  lds
    ds_read_b64_tr_b16 v[176:177], v244 offset:2048
    ds_read_b64_tr_b16 v[178:179], v244 offset:3072
    ds_read_b64_tr_b16 v[188:189], v245 offset:2048
    ds_read_b64_tr_b16 v[190:191], v245 offset:3072
    s_waitcnt lgkmcnt(0)
    v_mfma_f32_32x32x16_bf16 v[56:71], v[88:91], v[176:179], v[56:71]
    v_fma_f32 v203, v12, -v140, v203
    v_fma_f32 v203, v13, -v141, v203
    v_fma_f32 v203, v14, -v142, v203
    v_fma_f32 v203, v15, -v143, v203
    s_nop 1
    v_permlane32_swap_b32 v201, v203
    v_add_f32 v203, v201, v203
    s_add_u32 m0, s21, 2048
    v_mfma_f32_32x32x16_bf16 v[16:31], v[92:95], v[176:179], v[16:31]
    buffer_load_dwordx4 v234, s[4:7], s37 offen  lds
    buffer_load_dwordx4 v235, s[8:11], s37 offen offset:1024  lds
    v_add_u32 v252, s42, v247
    ds_read2_b32 v[234:235], v252 offset0:0 offset1:16
    v_cvt_pk_bf16_f32 v192, v198, v199
    v_cvt_pk_bf16_f32 v193, v202, v203
    v_mfma_f32_32x32x16_bf16 v[32:47], v[72:75], v[180:183], 0
    v_mul_f32 v196, v56, v144
    v_fmac_f32 v196, v57, v145
    v_fmac_f32 v196, v58, v146
    v_fmac_f32 v196, v59, v147
    v_fmac_f32 v196, v60, v148
    v_fmac_f32 v196, v61, v149
    v_mfma_f32_32x32x16_bf16 v[0:15], v[76:79], v[180:183], 0
    v_fmac_f32 v196, v62, v150
    v_fmac_f32 v196, v63, v151
    v_mul_f32_e64 v200, v16, -v160
    v_fma_f32 v200, v17, -v161, v200
    v_fma_f32 v200, v18, -v162, v200
    v_fma_f32 v200, v19, -v163, v200
    v_mfma_f32_32x32x16_bf16 v[32:47], v[80:83], v[184:187], v[32:47]
    v_fma_f32 v200, v20, -v164, v200
    v_fma_f32 v200, v21, -v165, v200
    v_fma_f32 v200, v22, -v166, v200
    v_fma_f32 v200, v23, -v167, v200
    v_mul_f32_e64 v202, v24, -v160
    v_fma_f32 v202, v25, -v161, v202
    v_mfma_f32_32x32x16_bf16 v[0:15], v[84:87], v[184:187], v[0:15]
    s_waitcnt vmcnt(6)
    ds_read_b64_tr_b16 v[176:177], v244 offset:4096
    ds_read_b64_tr_b16 v[178:179], v244 offset:5120
    ds_read_b64_tr_b16 v[180:181], v245 offset:4096
    ds_read_b64_tr_b16 v[182:183], v245 offset:5120
    v_fma_f32 v202, v26, -v162, v202
    v_fma_f32 v202, v27, -v163, v202
    v_mfma_f32_32x32x16_bf16 v[32:47], v[88:91], v[188:191], v[32:47]
    v_fma_f32 v202, v28, -v164, v202
    v_fma_f32 v202, v29, -v165, v202
    v_fma_f32 v202, v30, -v166, v202
    v_fma_f32 v202, v31, -v167, v202
    v_mfma_f32_32x32x16_bf16 v[0:15], v[92:95], v[188:191], v[0:15]
    s_waitcnt vmcnt(4) lgkmcnt(0)
    v_mfma_f32_32x32x16_bf16 v[16:31], v[72:75], v[176:179], 0
    s_nop 4
    v_mul_f32 v197, v32, v152
    v_fmac_f32 v197, v33, v153
    v_fmac_f32 v197, v34, v154
    v_fmac_f32 v197, v35, v155
    v_fmac_f32 v197, v36, v156
    v_fmac_f32 v197, v37, v157
    s_add_u32 m0, s21, 4096
    v_mfma_f32_32x32x16_bf16 v[48:63], v[76:79], v[176:179], 0
    buffer_load_dwordx4 v236, s[4:7], s37 offen  lds
    buffer_load_dwordx4 v237, s[8:11], s37 offen offset:1024  lds
    ds_read_b64_tr_b16 v[176:177], v244 offset:6144
    ds_read_b64_tr_b16 v[178:179], v244 offset:7168
    ds_read_b64_tr_b16 v[184:185], v245 offset:6144
    ds_read_b64_tr_b16 v[186:187], v245 offset:7168
    v_add_u32 v252, s43, v247
    ds_read2_b32 v[236:237], v252 offset0:0 offset1:16
    v_fmac_f32 v197, v38, v158
    v_fmac_f32 v197, v39, v159
    v_mul_f32_e64 v201, v0, -v168
    v_fma_f32 v201, v1, -v169, v201
    s_waitcnt vmcnt(4) lgkmcnt(1)
    v_mfma_f32_32x32x16_bf16 v[16:31], v[80:83], v[176:179], v[16:31]
    v_fma_f32 v201, v2, -v170, v201
    v_fma_f32 v201, v3, -v171, v201
    v_fma_f32 v201, v4, -v172, v201
    v_fma_f32 v201, v5, -v173, v201
    v_fma_f32 v201, v6, -v174, v201
    v_fma_f32 v201, v7, -v175, v201
    s_add_u32 m0, s21, 6144
    v_mfma_f32_32x32x16_bf16 v[48:63], v[84:87], v[176:179], v[48:63]
    buffer_load_dwordx4 v238, s[4:7], s37 offen  lds
    buffer_load_dwordx4 v239, s[8:11], s37 offen offset:1024  lds
    ds_read_b64_tr_b16 v[176:177], v244 offset:0
    ds_read_b64_tr_b16 v[178:179], v244 offset:1024
    ds_read_b64_tr_b16 v[188:189], v245 offset:0
    ds_read_b64_tr_b16 v[190:191], v245 offset:1024
    v_add_u32 v252, s44, v247
    ds_read2_b32 v[238:239], v252 offset0:0 offset1:16
    s_waitcnt lgkmcnt(1)
    v_mfma_f32_32x32x16_bf16 v[16:31], v[88:91], v[176:179], v[16:31]
    v_mul_f32_e64 v203, v8, -v168
    v_fma_f32 v203, v9, -v169, v203
    v_fma_f32 v203, v10, -v170, v203
    v_fma_f32 v203, v11, -v171, v203
    v_fma_f32 v203, v12, -v172, v203
    v_fma_f32 v203, v13, -v173, v203
    s_add_u32 m0, s21, 0
    v_mfma_f32_32x32x16_bf16 v[48:63], v[92:95], v[176:179], v[48:63]
    s_cbranch_vccnz WL_6_0
    v_mad_u32_u16 v234, v234, s3, v246 op_sel:[1,0,0,0]
    v_mad_u32_u16 v235, v235, s3, v246 op_sel:[1,0,0,0]
    buffer_load_dwordx4 v234, s[4:7], s38 offen  lds
    buffer_load_dwordx4 v235, s[8:11], s38 offen offset:1024  lds
WR_6_0:
    v_fma_f32 v203, v14, -v174, v203
    v_fma_f32 v203, v15, -v175, v203
    v_mfma_f32_32x32x16_bf16 v[0:15], v[72:75], v[180:183], 0
    v_fmac_f32 v200, v24, v160
    v_fmac_f32 v200, v25, v161
    v_fmac_f32 v200, v26, v162
    v_fmac_f32 v200, v27, v163
    v_fmac_f32 v200, v28, v164
    v_fmac_f32 v200, v29, v165
    v_fmac_f32 v200, v30, v166
    v_fmac_f32 v200, v31, v167
    v_mfma_f32_32x32x16_bf16 v[24:39], v[76:79], v[180:183], 0
    v_mul_f32 v254, v16, v144
    v_fmac_f32 v254, v17, v145
    v_fmac_f32 v254, v18, v146
    v_fmac_f32 v254, v19, v147
    v_fmac_f32 v254, v20, v148
    v_fmac_f32 v254, v21, v149
    v_mfma_f32_32x32x16_bf16 v[0:15], v[80:83], v[184:187], v[0:15]
    v_fmac_f32 v254, v22, v150
    v_fmac_f32 v254, v23, v151
    v_sub_f32_e64 v64, -v48, v64
    v_sub_f32_e64 v65, -v49, v65
    v_permlane32_swap_b32 v196, v254
    v_sub_f32_e64 v66, -v50, v66
    v_mfma_f32_32x32x16_bf16 v[24:39], v[84:87], v[184:187], v[24:39]
    s_waitcnt vmcnt(6)
    ds_read_b64_tr_b16 v[176:177], v244 offset:2048
    ds_read_b64_tr_b16 v[178:179], v244 offset:3072
    ds_read_b64_tr_b16 v[180:181], v245 offset:2048
    ds_read_b64_tr_b16 v[182:183], v245 offset:3072
    v_sub_f32_e64 v67, -v51, v67
    v_sub_f32_e64 v68, -v52, v68
    v_mfma_f32_32x32x16_bf16 v[24:39], v[92:95], v[188:191], v[24:39]
    v_sub_f32_e64 v69, -v53, v69
    v_sub_f32_e64 v70, -v54, v70
    v_sub_f32_e64 v71, -v55, v71
    v_add_f32 v254, v196, v254
    v_mfma_f32_32x32x16_bf16 v[0:15], v[88:91], v[188:191], v[0:15]
    s_waitcnt vmcnt(4) lgkmcnt(0)
    v_mfma_f32_32x32x16_bf16 v[56:71], v[76:79], v[176:179], v[56:71]
    s_nop 4
    v_sub_f32_e64 v40, -v24, v40
    v_sub_f32_e64 v41, -v25, v41
    v_sub_f32_e64 v42, -v26, v42
    v_sub_f32_e64 v43, -v27, v43
    v_sub_f32_e64 v44, -v28, v44
    v_sub_f32_e64 v45, -v29, v45
    v_sub_f32_e64 v46, -v30, v46
    v_sub_f32_e64 v47, -v31, v47
    s_add_u32 m0, s21, 2048
    v_mfma_f32_32x32x16_bf16 v[16:31], v[72:75], v[176:179], 0
    s_cbranch_vccnz WL_6_1
    v_mad_u32_u16 v236, v236, s3, v246 op_sel:[1,0,0,0]
    v_mad_u32_u16 v237, v237, s3, v246 op_sel:[1,0,0,0]
    buffer_load_dwordx4 v236, s[4:7], s39 offen  lds
    buffer_load_dwordx4 v237, s[8:11], s39 offen offset:1024  lds
WR_6_1:
    ds_read_b64_tr_b16 v[176:177], v244 offset:4096
    ds_read_b64_tr_b16 v[178:179], v244 offset:5120
    ds_read_b64_tr_b16 v[184:185], v245 offset:4096
    ds_read_b64_tr_b16 v[186:187], v245 offset:5120
    v_mul_f32 v255, v0, v152
    v_fmac_f32 v255, v1, v153
    v_fmac_f32 v255, v2, v154
    v_fmac_f32 v255, v3, v155
    v_fmac_f32 v255, v4, v156
    s_waitcnt vmcnt(4) lgkmcnt(0)
    v_mfma_f32_32x32x16_bf16 v[16:31], v[80:83], v[176:179], v[16:31]
    v_fmac_f32 v255, v5, v157
    v_fmac_f32 v255, v6, v158
    v_fmac_f32 v255, v7, v159
    v_fmac_f32 v201, v8, v168
    v_fmac_f32 v201, v9, v169
    v_permlane32_swap_b32 v197, v255
    s_add_u32 m0, s21, 4096
    v_mfma_f32_32x32x16_bf16 v[56:71], v[84:87], v[176:179], v[56:71]
    s_cbranch_vccnz WL_6_2
    v_mad_u32_u16 v238, v238, s3, v246 op_sel:[1,0,0,0]
    v_mad_u32_u16 v239, v239, s3, v246 op_sel:[1,0,0,0]
    buffer_load_dwordx4 v238, s[4:7], s40 offen  lds
    buffer_load_dwordx4 v239, s[8:11], s40 offen offset:1024  lds
WR_6_2:
    ds_read_b64_tr_b16 v[176:177], v244 offset:6144
    ds_read_b64_tr_b16 v[178:179], v244 offset:7168
    ds_read_b64_tr_b16 v[188:189], v245 offset:6144
    ds_read_b64_tr_b16 v[190:191], v245 offset:7168
    s_waitcnt lgkmcnt(0)
    v_mfma_f32_32x32x16_bf16 v[16:31], v[88:91], v[176:179], v[16:31]
    v_fmac_f32 v201, v10, v170
    v_fmac_f32 v201, v11, v171
    v_fmac_f32 v201, v12, v172
    v_fmac_f32 v201, v13, v173
    v_fmac_f32 v201, v14, v174
    v_fmac_f32 v201, v15, v175
    s_add_u32 m0, s21, 6144
    v_mfma_f32_32x32x16_bf16 v[56:71], v[92:95], v[176:179], v[56:71]
    s_cbranch_vccnz WL_6_3
    v_mad_u32_u16 v240, v240, s3, v246 op_sel:[1,0,0,0]
    v_mad_u32_u16 v241, v241, s3, v246 op_sel:[1,0,0,0]
    buffer_load_dwordx4 v240, s[4:7], s41 offen  lds
    buffer_load_dwordx4 v241, s[8:11], s41 offen offset:1024  lds
WR_6_3:
    v_add_f32 v255, v197, v255
    v_cvt_pk_bf16_f32 v194, v254, v255
    v_mfma_f32_32x32x16_bf16 v[0:15], v[72:75], v[180:183], 0
    v_mul_f32 v254, v16, v144
    v_fmac_f32 v254, v17, v145
    v_fmac_f32 v254, v18, v146
    v_fmac_f32 v254, v19, v147
    v_fmac_f32 v254, v20, v148
    v_fmac_f32 v254, v21, v149
    v_mfma_f32_32x32x16_bf16 v[32:47], v[76:79], v[180:183], v[32:47]
    v_fmac_f32 v254, v22, v150
    v_fmac_f32 v254, v23, v151
    v_fma_f32 v202, v24, -v160, v202
    v_fma_f32 v202, v25, -v161, v202
    v_permlane32_swap_b32 v254, v200
    v_fma_f32 v202, v26, -v162, v202
    v_mfma_f32_32x32x16_bf16 v[0:15], v[80:83], v[184:187], v[0:15]
    v_fma_f32 v202, v27, -v163, v202
    v_fma_f32 v202, v28, -v164, v202
    v_fma_f32 v202, v29, -v165, v202
    v_fma_f32 v202, v30, -v166, v202
    v_fma_f32 v202, v31, -v167, v202
    v_add_f32 v200, v254, v200
    v_mfma_f32_32x32x16_bf16 v[32:47], v[84:87], v[184:187], v[32:47]
    s_waitcnt vmcnt(6)
    ds_read_b64_tr_b16 v[176:177], v244 offset:0
    ds_read_b64_tr_b16 v[178:179], v244 offset:1024
    ds_read_b64_tr_b16 v[180:181], v245 offset:0
    ds_read_b64_tr_b16 v[182:183], v245 offset:1024
    v_mul_f32_e64 v198, v64, -v112
    v_permlane32_swap_b32 v202, v254
    v_mfma_f32_32x32x16_bf16 v[0:15], v[88:91], v[188:191], v[0:15]
    v_fma_f32 v198, v65, -v113, v198
    v_fma_f32 v198, v66, -v114, v198
    v_fma_f32 v198, v67, -v115, v198
    v_fma_f32 v198, v68, -v116, v198
    v_fma_f32 v198, v69, -v117, v198
    v_fma_f32 v198, v70, -v118, v198
    v_mfma_f32_32x32x16_bf16 v[32:47], v[92:95], v[188:191], v[32:47]
    v_add_u32 v249, s48, v249
    v_add_u32 v250, s49, v250
    ds_read_b32 v252, v251 offset:16
    ds_read_b64_tr_b16 v[72:73], v249 offset:0
    ds_read_b64_tr_b16 v[76:77], v249 offset:64
    ds_read_b64_tr_b16 v[74:75], v249 offset:256
    ds_read_b64_tr_b16 v[78:79], v249 offset:320
    s_mov_b64 exec, s[54:55]
    ds_read_u16_d16_hi v242, v250 offset:0
    s_mov_b64 exec, -1
    v_fma_f32 v198, v71, -v119, v198
    v_add_f32 v254, v202, v254
    v_mul_f32 v196, v56, v160
    v_fmac_f32 v196, v57, v161
    v_fmac_f32 v196, v58, v162
    v_fmac_f32 v196, v59, v163
    v_fmac_f32 v196, v60, v164
    v_fmac_f32 v196, v61, v165
    v_fmac_f32 v196, v62, v166
    v_fmac_f32 v196, v63, v167
    s_nop 1
    v_permlane32_swap_b32 v198, v196
    v_add_f32 v196, v198, v196
    s_cbranch_vccnz LEPI_0
    v_mul_f32 v255, v0, v152
    v_fmac_f32 v255, v1, v153
    v_fmac_f32 v255, v2, v154
    v_fmac_f32 v255, v3, v155
    v_fmac_f32 v255, v4, v156
    v_fmac_f32 v255, v5, v157
    v_fmac_f32 v255, v6, v158
    v_fmac_f32 v255, v7, v159
    v_fma_f32 v203, v8, -v168, v203
    v_fma_f32 v203, v9, -v169, v203
    v_permlane32_swap_b32 v255, v201
    v_fma_f32 v203, v10, -v170, v203
    v_fma_f32 v203, v11, -v171, v203
    v_fma_f32 v203, v12, -v172, v203
    v_fma_f32 v203, v13, -v173, v203
    v_fma_f32 v203, v14, -v174, v203
    v_fma_f32 v203, v15, -v175, v203
    v_add_f32 v201, v255, v201
    v_mul_f32_e64 v199, v40, -v120
    v_permlane32_swap_b32 v203, v255
    v_fma_f32 v199, v41, -v121, v199
    v_fma_f32 v199, v42, -v122, v199
    v_fma_f32 v199, v43, -v123, v199
    v_fma_f32 v199, v44, -v124, v199
    v_fma_f32 v199, v45, -v125, v199
    v_fma_f32 v199, v46, -v126, v199
    v_fma_f32 v199, v47, -v127, v199
    v_add_f32 v255, v203, v255
    v_mul_f32 v197, v32, v168
    v_fmac_f32 v197, v33, v169
    v_fmac_f32 v197, v34, v170
    v_fmac_f32 v197, v35, v171
    v_fmac_f32 v197, v36, v172
    v_fmac_f32 v197, v37, v173
    v_fmac_f32 v197, v38, v174
    v_fmac_f32 v197, v39, v175
    s_nop 1
    v_permlane32_swap_b32 v199, v197
    v_add_f32 v197, v199, v197
    v_cvt_pk_bf16_f32 v200, v200, v201
    v_cvt_pk_bf16_f32 v254, v254, v255
    v_cvt_pk_bf16_f32 v196, v196, v197
    ds_write2st64_b32 v253, v192, v193 offset0:0 offset1:1
    ds_write2st64_b32 v253, v194, v200 offset0:2 offset1:3
    ds_write_b32 v253, v196 offset:1024
    s_mov_b64 exec, 0xffffffff
    ds_write_b32 v253, v254 offset:1280
    s_mov_b64 exec, -1
    s_add_u32 s50, s50, 1
    s_cmp_ge_u32 s50, 4
    s_cbranch_scc1 LAST1
    s_waitcnt lgkmcnt(9)
    v_readfirstlane_b32 s66, v252
    s_add_u32 s53, s53, 1
    v_mov_b32 v252, s53
    s_cmp_le_u32 s53, s66
    ds_write2_b32 v251, v252, v252 offset0:0 offset1:8
    s_setprio 1
    s_cbranch_scc1 PRIO_14
    s_setprio 0
PRIO_14:
    s_cmp_eq_u32 s52, 4
    s_cbranch_scc1 ITEM_1_4
    s_cmp_eq_u32 s52, 5
    s_cbranch_scc1 ITEM_1_5
    s_cmp_eq_u32 s52, 3
    s_cbranch_scc1 ITEM_1_3
    s_cmp_eq_u32 s52, 6
    s_cbranch_scc1 ITEM_1_6
    s_cmp_eq_u32 s52, 8
    s_cbranch_scc1 ITEM_1_8
    s_branch ITEM_1_2
WL_6_0:
    s_add_u32 s66, s51, 0
    buffer_load_dwordx4 v[96:99], v246, s[16:19], s66 offen offset:2048 sc1
    buffer_load_dwordx4 v[100:103], v246, s[16:19], s66 offen offset:3072 sc1
    s_branch WR_6_0
WL_6_1:
    s_add_u32 s66, s51, 4096
    buffer_load_dwordx4 v[104:107], v246, s[16:19], s66 offen offset:2048 sc1
    buffer_load_dwordx4 v[108:111], v246, s[16:19], s66 offen offset:3072 sc1
    s_branch WR_6_1
WL_6_2:
    s_add_u32 s66, s51, 8192
    buffer_load_dwordx4 v[128:131], v246, s[16:19], s66 offen offset:2048 sc1
    buffer_load_dwordx4 v[132:135], v246, s[16:19], s66 offen offset:3072 sc1
    s_branch WR_6_2
WL_6_3:
    s_add_u32 s66, s51, 12288
    buffer_load_dwordx4 v[136:139], v246, s[16:19], s66 offen offset:2048 sc1
    buffer_load_dwordx4 v[140:143], v246, s[16:19], s66 offen offset:3072 sc1
    s_branch WR_6_3
.p2align 6
ITEM_1_8:
    s_mov_b64 exec, s[54:55]
    ds_read_u16_d16_hi v243, v250 offset:128
    s_mov_b64 exec, -1
    ds_read_b64_tr_b16 v[80:81], v249 offset:512
    ds_read_b64_tr_b16 v[84:85], v249 offset:576
    ds_read_b64_tr_b16 v[82:83], v249 offset:768
    ds_read_b64_tr_b16 v[86:87], v249 offset:832
    ds_read_b64_tr_b16 v[88:89], v249 offset:1024
    ds_read_b64_tr_b16 v[92:93], v249 offset:1088
    ds_read_b64_tr_b16 v[90:91], v249 offset:1280
    ds_read_b64_tr_b16 v[94:95], v249 offset:1344
    ds_read_b64_tr_b16 v[64:65], v249 offset:1536
    ds_read_b64_tr_b16 v[68:69], v249 offset:1600
    ds_read_b64_tr_b16 v[66:67], v249 offset:1792
    ds_read_b64_tr_b16 v[70:71], v249 offset:1856
    s_waitcnt lgkmcnt(13)
    v_mul_f32_dpp v196, v242, v72 row_newbcast:0 row_mask:0xf bank_mask:0xf
    v_mul_f32_dpp v197, v242, v73 row_newbcast:1 row_mask:0xf bank_mask:0xf
    v_mul_f32_dpp v198, v242, v72 row_newbcast:8 row_mask:0xf bank_mask:0xf
    v_mul_f32_dpp v199, v242, v73 row_newbcast:9 row_mask:0xf bank_mask:0xf
    v_mul_f32_dpp v200, v242, v76 row_newbcast:2 row_mask:0xf bank_mask:0xf
    v_mul_f32_dpp v201, v242, v77 row_newbcast:3 row_mask:0xf bank_mask:0xf
    v_mul_f32_dpp v202, v242, v76 row_newbcast:10 row_mask:0xf bank_mask:0xf
    v_mul_f32_dpp v203, v242, v77 row_newbcast:11 row_mask:0xf bank_mask:0xf
    v_cvt_pk_bf16_f32 v72, v196, v197
    v_cvt_pk_bf16_f32 v76, v198, v199
    v_cvt_pk_bf16_f32 v73, v200, v201
    v_cvt_pk_bf16_f32 v77, v202, v203
    v_mul_f32_dpp v196, v242, v74 row_newbcast:4 row_mask:0xf bank_mask:0xf
    v_mul_f32_dpp v197, v242, v75 row_newbcast:5 row_mask:0xf bank_mask:0xf
    v_mul_f32_dpp v198, v242, v74 row_newbcast:12 row_mask:0xf bank_mask:0xf
    v_mul_f32_dpp v199, v242, v75 row_newbcast:13 row_mask:0xf bank_mask:0xf
    v_mul_f32_dpp v200, v242, v78 row_newbcast:6 row_mask:0xf bank_mask:0xf
    v_mul_f32_dpp v201, v242, v79 row_newbcast:7 row_mask:0xf bank_mask:0xf
    v_mul_f32_dpp v202, v242, v78 row_newbcast:14 row_mask:0xf bank_mask:0xf
    v_mul_f32_dpp v203, v242, v79 row_newbcast:15 row_mask:0xf bank_mask:0xf
    v_cvt_pk_bf16_f32 v74, v196, v197
    v_cvt_pk_bf16_f32 v78, v198, v199
    v_cvt_pk_bf16_f32 v75, v200, v201
    v_cvt_pk_bf16_f32 v79, v202, v203
    s_mov_b64 exec, s[54:55]
    ds_read_u16_d16_hi v242, v250 offset:256
    s_mov_b64 exec, -1
    s_waitcnt vmcnt(4) lgkmcnt(9)
    v_mfma_f32_32x32x16_bf16 v[0:15], v[72:75], v[176:179], 0
    v_mul_f32_dpp v196, v243, v80 row_newbcast:0 row_mask:0xf bank_mask:0xf
    v_mul_f32_dpp v197, v243, v81 row_newbcast:1 row_mask:0xf bank_mask:0xf
    v_mul_f32_dpp v198, v243, v80 row_newbcast:8 row_mask:0xf bank_mask:0xf
    v_mul_f32_dpp v199, v243, v81 row_newbcast:9 row_mask:0xf bank_mask:0xf
    v_mul_f32_dpp v200, v243, v84 row_newbcast:2 row_mask:0xf bank_mask:0xf
    v_mul_f32_dpp v201, v243, v85 row_newbcast:3 row_mask:0xf bank_mask:0xf
    s_add_u32 m0, s21, 0
    v_mfma_f32_32x32x16_bf16 v[48:63], v[76:79], v[176:179], 0
    buffer_load_dwordx4 v234, s[4:7], s35 offen  lds
    buffer_load_dwordx4 v235, s[8:11], s35 offen offset:1024  lds
    ds_read_b64_tr_b16 v[176:177], v244 offset:2048
    ds_read_b64_tr_b16 v[178:179], v244 offset:3072
    ds_read_b64_tr_b16 v[184:185], v245 offset:2048
    ds_read_b64_tr_b16 v[186:187], v245 offset:3072
    v_mul_f32_dpp v202, v243, v84 row_newbcast:10 row_mask:0xf bank_mask:0xf
    v_mul_f32_dpp v203, v243, v85 row_newbcast:11 row_mask:0xf bank_mask:0xf
    v_cvt_pk_bf16_f32 v80, v196, v197
    v_cvt_pk_bf16_f32 v84, v198, v199
    v_cvt_pk_bf16_f32 v81, v200, v201
    v_cvt_pk_bf16_f32 v85, v202, v203
    v_mul_f32_dpp v196, v243, v82 row_newbcast:4 row_mask:0xf bank_mask:0xf
    v_mul_f32_dpp v197, v243, v83 row_newbcast:5 row_mask:0xf bank_mask:0xf
    v_mul_f32_dpp v198, v243, v82 row_newbcast:12 row_mask:0xf bank_mask:0xf
    v_mul_f32_dpp v199, v243, v83 row_newbcast:13 row_mask:0xf bank_mask:0xf
    v_mul_f32_dpp v200, v243, v86 row_newbcast:6 row_mask:0xf bank_mask:0xf
    v_mul_f32_dpp v201, v243, v87 row_newbcast:7 row_mask:0xf bank_mask:0xf
    v_mul_f32_dpp v202, v243, v86 row_newbcast:14 row_mask:0xf bank_mask:0xf
    v_mul_f32_dpp v203, v243, v87 row_newbcast:15 row_mask:0xf bank_mask:0xf
    v_cvt_pk_bf16_f32 v82, v196, v197
    v_cvt_pk_bf16_f32 v86, v198, v199
    v_cvt_pk_bf16_f32 v83, v200, v201
    v_cvt_pk_bf16_f32 v87, v202, v203
    s_mov_b64 exec, s[54:55]
    ds_read_u16_d16_hi v243, v250 offset:384
    s_mov_b64 exec, -1
    s_waitcnt vmcnt(4) lgkmcnt(1)
    v_mfma_f32_32x32x16_bf16 v[0:15], v[80:83], v[176:179], v[0:15]
    v_mul_f32_dpp v196, v242, v88 row_newbcast:0 row_mask:0xf bank_mask:0xf
    v_mul_f32_dpp v197, v242, v89 row_newbcast:1 row_mask:0xf bank_mask:0xf
    v_mul_f32_dpp v198, v242, v88 row_newbcast:8 row_mask:0xf bank_mask:0xf
    v_mul_f32_dpp v199, v242, v89 row_newbcast:9 row_mask:0xf bank_mask:0xf
    v_mul_f32_dpp v200, v242, v92 row_newbcast:2 row_mask:0xf bank_mask:0xf
    v_mul_f32_dpp v201, v242, v93 row_newbcast:3 row_mask:0xf bank_mask:0xf
    s_add_u32 m0, s21, 2048
    v_mfma_f32_32x32x16_bf16 v[48:63], v[84:87], v[176:179], v[48:63]
    buffer_load_dwordx4 v236, s[4:7], s35 offen  lds
    buffer_load_dwordx4 v237, s[8:11], s35 offen offset:1024  lds
    ds_read_b64_tr_b16 v[176:177], v244 offset:4096
    ds_read_b64_tr_b16 v[178:179], v244 offset:5120
    ds_read_b64_tr_b16 v[188:189], v245 offset:4096
    ds_read_b64_tr_b16 v[190:191], v245 offset:5120
    v_mul_f32_dpp v202, v242, v92 row_newbcast:10 row_mask:0xf bank_mask:0xf
    v_mul_f32_dpp v203, v242, v93 row_newbcast:11 row_mask:0xf bank_mask:0xf
    v_cvt_pk_bf16_f32 v88, v196, v197
    v_cvt_pk_bf16_f32 v92, v198, v199
    v_cvt_pk_bf16_f32 v89, v200, v201
    v_cvt_pk_bf16_f32 v93, v202, v203
    v_mul_f32_dpp v196, v242, v90 row_newbcast:4 row_mask:0xf bank_mask:0xf
    v_mul_f32_dpp v197, v242, v91 row_newbcast:5 row_mask:0xf bank_mask:0xf
    v_mul_f32_dpp v198, v242, v90 row_newbcast:12 row_mask:0xf bank_mask:0xf
    v_mul_f32_dpp v199, v242, v91 row_newbcast:13 row_mask:0xf bank_mask:0xf
    v_mul_f32_dpp v200, v242, v94 row_newbcast:6 row_mask:0xf bank_mask:0xf
    v_mul_f32_dpp v201, v242, v95 row_newbcast:7 row_mask:0xf bank_mask:0xf
    v_mul_f32_dpp v202, v242, v94 row_newbcast:14 row_mask:0xf bank_mask:0xf
    v_mul_f32_dpp v203, v242, v95 row_newbcast:15 row_mask:0xf bank_mask:0xf
    v_cvt_pk_bf16_f32 v90, v196, v197
    v_cvt_pk_bf16_f32 v94, v198, v199
    v_cvt_pk_bf16_f32 v91, v200, v201
    v_cvt_pk_bf16_f32 v95, v202, v203
    s_waitcnt vmcnt(4) lgkmcnt(0)
    v_mfma_f32_32x32x16_bf16 v[0:15], v[88:91], v[176:179], v[0:15]
    v_mul_f32_dpp v196, v243, v64 row_newbcast:0 row_mask:0xf bank_mask:0xf
    v_mul_f32_dpp v197, v243, v65 row_newbcast:1 row_mask:0xf bank_mask:0xf
    v_mul_f32_dpp v198, v243, v64 row_newbcast:8 row_mask:0xf bank_mask:0xf
    v_mul_f32_dpp v199, v243, v65 row_newbcast:9 row_mask:0xf bank_mask:0xf
    v_mul_f32_dpp v200, v243, v68 row_newbcast:2 row_mask:0xf bank_mask:0xf
    v_mul_f32_dpp v201, v243, v69 row_newbcast:3 row_mask:0xf bank_mask:0xf
    s_add_u32 m0, s21, 4096
    v_mfma_f32_32x32x16_bf16 v[48:63], v[92:95], v[176:179], v[48:63]
    buffer_load_dwordx4 v238, s[4:7], s35 offen  lds
    buffer_load_dwordx4 v239, s[8:11], s35 offen offset:1024  lds
    ds_read_b64_tr_b16 v[176:177], v244 offset:6144
    ds_read_b64_tr_b16 v[178:179], v244 offset:7168
    ds_read_b64_tr_b16 v[192:193], v245 offset:6144
    ds_read_b64_tr_b16 v[194:195], v245 offset:7168
    v_mul_f32_dpp v202, v243, v68 row_newbcast:10 row_mask:0xf bank_mask:0xf
    v_mul_f32_dpp v203, v243, v69 row_newbcast:11 row_mask:0xf bank_mask:0xf
    v_cvt_pk_bf16_f32 v64, v196, v197
    v_cvt_pk_bf16_f32 v68, v198, v199
    v_cvt_pk_bf16_f32 v65, v200, v201
    v_cvt_pk_bf16_f32 v69, v202, v203
    v_mul_f32_dpp v196, v243, v66 row_newbcast:4 row_mask:0xf bank_mask:0xf
    v_mul_f32_dpp v197, v243, v67 row_newbcast:5 row_mask:0xf bank_mask:0xf
    v_mul_f32_dpp v198, v243, v66 row_newbcast:12 row_mask:0xf bank_mask:0xf
    v_mul_f32_dpp v199, v243, v67 row_newbcast:13 row_mask:0xf bank_mask:0xf
    v_mul_f32_dpp v200, v243, v70 row_newbcast:6 row_mask:0xf bank_mask:0xf
    v_mul_f32_dpp v201, v243, v71 row_newbcast:7 row_mask:0xf bank_mask:0xf
    v_mul_f32_dpp v202, v243, v70 row_newbcast:14 row_mask:0xf bank_mask:0xf
    v_mul_f32_dpp v203, v243, v71 row_newbcast:15 row_mask:0xf bank_mask:0xf
    v_cvt_pk_bf16_f32 v66, v196, v197
    v_cvt_pk_bf16_f32 v70, v198, v199
    v_cvt_pk_bf16_f32 v67, v200, v201
    v_cvt_pk_bf16_f32 v71, v202, v203
    s_waitcnt lgkmcnt(0)
    v_mfma_f32_32x32x16_bf16 v[0:15], v[64:67], v[176:179], v[0:15]
    s_add_u32 m0, s21, 6144
    v_mfma_f32_32x32x16_bf16 v[48:63], v[68:71], v[176:179], v[48:63]
    buffer_load_dwordx4 v240, s[4:7], s35 offen  lds
    buffer_load_dwordx4 v241, s[8:11], s35 offen offset:1024  lds
    s_mov_b32 m0, s50
    s_nop 0
    s_movrels_b32 s71, s23
    s_movrels_b32 s33, s28
    v_add_u32 v253, s33, v248
    s_bfe_u32 s46, s71, 0x30012
    s_mov_b32 m0, s46
    s_and_b32 s66, s71, 0x3ffff
    s_movrels_b32 s68, s57
    s_movrels_b32 s69, s61
    s_sub_u32 s48, s66, s47
    s_mov_b32 s47, s66
    s_lshr_b32 s52, s71, 28
    s_lshl_b32 s67, s46, 9
    s_add_u32 s66, s66, s67
    s_sub_u32 s49, s66, s42
    s_mov_b32 s42, s66
    s_bfe_u32 s66, s68, 655360
    s_add_u32 s43, s42, s66
    s_bfe_u32 s39, s69, 655360
    s_bfe_u32 s66, s68, 655370
    s_add_u32 s44, s42, s66
    s_bfe_u32 s40, s69, 655370
    s_bfe_u32 s66, s68, 655380
    s_add_u32 s45, s42, s66
    s_bfe_u32 s41, s69, 655380
    v_mfma_f32_32x32x16_bf16 v[16:31], v[72:75], v[180:183], 0
    v_mul_f32 v196, v0, v96
    v_fmac_f32 v196, v1, v97
    v_fmac_f32 v196, v2, v98
    v_fmac_f32 v196, v3, v99
    v_fmac_f32 v196, v4, v100
    v_fmac_f32 v196, v5, v101
    v_mfma_f32_32x32x16_bf16 v[32:47], v[76:79], v[180:183], 0
    v_fmac_f32 v196, v6, v102
    v_fmac_f32 v196, v7, v103
    v_mul_f32 v198, v8, v128
    v_fmac_f32 v198, v9, v129
    v_fmac_f32 v198, v10, v130
    v_fmac_f32 v198, v11, v131
    v_mfma_f32_32x32x16_bf16 v[16:31], v[80:83], v[184:187], v[16:31]
    v_fmac_f32 v198, v12, v132
    v_fmac_f32 v198, v13, v133
    v_fmac_f32 v198, v14, v134
    v_fmac_f32 v198, v15, v135
    v_mul_f32 v200, v48, v128
    v_fmac_f32 v200, v49, v129
    v_mfma_f32_32x32x16_bf16 v[32:47], v[84:87], v[184:187], v[32:47]
    v_permlane32_swap_b32 v196, v198
    v_fmac_f32 v200, v50, v130
    v_fmac_f32 v200, v51, v131
    v_fmac_f32 v200, v52, v132
    v_fmac_f32 v200, v53, v133
    v_fmac_f32 v200, v54, v134
    v_mfma_f32_32x32x16_bf16 v[16:31], v[88:91], v[188:191], v[16:31]
    v_fmac_f32 v200, v55, v135
    v_add_f32 v198, v196, v198
    v_mul_f32_e64 v202, v56, -v128
    v_fma_f32 v202, v57, -v129, v202
    v_fma_f32 v202, v58, -v130, v202
    v_fma_f32 v202, v59, -v131, v202
    v_mfma_f32_32x32x16_bf16 v[32:47], v[92:95], v[188:191], v[32:47]
    s_waitcnt vmcnt(6)
    ds_read_b64_tr_b16 v[176:177], v244 offset:0
    ds_read_b64_tr_b16 v[178:179], v244 offset:1024
    ds_read_b64_tr_b16 v[180:181], v245 offset:0
    ds_read_b64_tr_b16 v[182:183], v245 offset:1024
    v_fma_f32 v202, v60, -v132, v202
    v_fma_f32 v202, v61, -v133, v202
    v_mfma_f32_32x32x16_bf16 v[16:31], v[64:67], v[192:195], v[16:31]
    v_fma_f32 v202, v62, -v134, v202
    v_fma_f32 v202, v63, -v135, v202
    s_nop 1
    v_permlane32_swap_b32 v200, v202
    v_add_f32 v202, v200, v202
    v_mfma_f32_32x32x16_bf16 v[32:47], v[68:71], v[192:195], v[32:47]
    s_waitcnt vmcnt(4) lgkmcnt(0)
    v_mfma_f32_32x32x16_bf16 v[0:15], v[72:75], v[176:179], 0
    s_nop 2
    v_mul_f32 v197, v16, v104
    v_fmac_f32 v197, v17, v105
    v_fmac_f32 v197, v18, v106
    v_fmac_f32 v197, v19, v107
    v_fmac_f32 v197, v20, v108
    v_fmac_f32 v197, v21, v109
    s_add_u32 m0, s21, 0
    v_mfma_f32_32x32x16_bf16 v[48:63], v[76:79], v[176:179], 0
    buffer_load_dwordx4 v234, s[4:7], s36 offen  lds
    buffer_load_dwordx4 v235, s[8:11], s36 offen offset:1024  lds
    ds_read_b64_tr_b16 v[176:177], v244 offset:2048
    ds_read_b64_tr_b16 v[178:179], v244 offset:3072
    ds_read_b64_tr_b16 v[184:185], v245 offset:2048
    ds_read_b64_tr_b16 v[186:187], v245 offset:3072
    v_fmac_f32 v197, v22, v110
    v_fmac_f32 v197, v23, v111
    v_mul_f32 v199, v24, v136
    v_fmac_f32 v199, v25, v137
    v_fmac_f32 v199, v26, v138
    v_fmac_f32 v199, v27, v139
    v_fmac_f32 v199, v28, v140
    v_fmac_f32 v199, v29, v141
    v_fmac_f32 v199, v30, v142
    v_fmac_f32 v199, v31, v143
    v_mul_f32 v201, v32, v136
    s_waitcnt vmcnt(4) lgkmcnt(0)
    v_mfma_f32_32x32x16_bf16 v[0:15], v[80:83], v[176:179], v[0:15]
    v_fmac_f32 v201, v33, v137
    v_permlane32_swap_b32 v197, v199
    v_fmac_f32 v201, v34, v138
    v_fmac_f32 v201, v35, v139
    v_fmac_f32 v201, v36, v140
    v_fmac_f32 v201, v37, v141
    s_add_u32 m0, s21, 2048
    v_mfma_f32_32x32x16_bf16 v[48:63], v[84:87], v[176:179], v[48:63]
    buffer_load_dwordx4 v236, s[4:7], s36 offen  lds
    buffer_load_dwordx4 v237, s[8:11], s36 offen offset:1024  lds
    ds_read_b64_tr_b16 v[176:177], v244 offset:4096
    ds_read_b64_tr_b16 v[178:179], v244 offset:5120
    ds_read_b64_tr_b16 v[188:189], v245 offset:4096
    ds_read_b64_tr_b16 v[190:191], v245 offset:5120
    s_waitcnt vmcnt(4) lgkmcnt(0)
    v_mfma_f32_32x32x16_bf16 v[0:15], v[88:91], v[176:179], v[0:15]
    v_fmac_f32 v201, v38, v142
    v_fmac_f32 v201, v39, v143
    v_add_f32 v199, v197, v199
    v_mul_f32_e64 v203, v40, -v136
    v_fma_f32 v203, v41, -v137, v203
    v_fma_f32 v203, v42, -v138, v203
    s_add_u32 m0, s21, 4096
    v_mfma_f32_32x32x16_bf16 v[48:63], v[92:95], v[176:179], v[48:63]
    buffer_load_dwordx4 v238, s[4:7], s36 offen  lds
    buffer_load_dwordx4 v239, s[8:11], s36 offen offset:1024  lds
    ds_read_b64_tr_b16 v[176:177], v244 offset:6144
    ds_read_b64_tr_b16 v[178:179], v244 offset:7168
    ds_read_b64_tr_b16 v[192:193], v245 offset:6144
    ds_read_b64_tr_b16 v[194:195], v245 offset:7168
    s_waitcnt lgkmcnt(0)
    v_mfma_f32_32x32x16_bf16 v[0:15], v[64:67], v[176:179], v[0:15]
    v_fma_f32 v203, v43, -v139, v203
    v_fma_f32 v203, v44, -v140, v203
    v_fma_f32 v203, v45, -v141, v203
    v_fma_f32 v203, v46, -v142, v203
    v_fma_f32 v203, v47, -v143, v203
    s_nop 1
    v_permlane32_swap_b32 v201, v203
    s_add_u32 m0, s21, 6144
    v_mfma_f32_32x32x16_bf16 v[48:63], v[68:71], v[176:179], v[48:63]
    buffer_load_dwordx4 v240, s[4:7], s36 offen  lds
    buffer_load_dwordx4 v241, s[8:11], s36 offen offset:1024  lds
    v_add_f32 v203, v201, v203
    v_cvt_pk_bf16_f32 v198, v198, v199
    v_cvt_pk_bf16_f32 v202, v202, v203
    ds_write2st64_b32 v253, v198, v202 offset0:0 offset1:1
    v_mfma_f32_32x32x16_bf16 v[16:31], v[72:75], v[180:183], 0
    v_mul_f32 v196, v0, v144
    v_fmac_f32 v196, v1, v145
    v_fmac_f32 v196, v2, v146
    v_fmac_f32 v196, v3, v147
    v_fmac_f32 v196, v4, v148
    v_fmac_f32 v196, v5, v149
    v_mfma_f32_32x32x16_bf16 v[32:47], v[76:79], v[180:183], 0
    v_fmac_f32 v196, v6, v150
    v_fmac_f32 v196, v7, v151
    v_mul_f32 v198, v8, v112
    v_fmac_f32 v198, v9, v113
    v_fmac_f32 v198, v10, v114
    v_fmac_f32 v198, v11, v115
    v_mfma_f32_32x32x16_bf16 v[16:31], v[80:83], v[184:187], v[16:31]
    v_fmac_f32 v198, v12, v116
    v_fmac_f32 v198, v13, v117
    v_fmac_f32 v198, v14, v118
    v_fmac_f32 v198, v15, v119
    v_mul_f32_e64 v200, v48, -v160
    v_fma_f32 v200, v49, -v161, v200
    v_mfma_f32_32x32x16_bf16 v[32:47], v[84:87], v[184:187], v[32:47]
    v_fma_f32 v200, v50, -v162, v200
    v_fma_f32 v200, v51, -v163, v200
    v_fma_f32 v200, v52, -v164, v200
    v_fma_f32 v200, v53, -v165, v200
    v_fma_f32 v200, v54, -v166, v200
    v_fma_f32 v200, v55, -v167, v200
    v_mfma_f32_32x32x16_bf16 v[16:31], v[88:91], v[188:191], v[16:31]
    v_mul_f32_e64 v202, v56, -v160
    v_fma_f32 v202, v57, -v161, v202
    v_fma_f32 v202, v58, -v162, v202
    v_fma_f32 v202, v59, -v163, v202
    v_fma_f32 v202, v60, -v164, v202
    v_fma_f32 v202, v61, -v165, v202
    v_mfma_f32_32x32x16_bf16 v[32:47], v[92:95], v[188:191], v[32:47]
    s_waitcnt vmcnt(6)
    ds_read_b64_tr_b16 v[176:177], v244 offset:0
    ds_read_b64_tr_b16 v[178:179], v244 offset:1024
    ds_read_b64_tr_b16 v[180:181], v245 offset:0
    ds_read_b64_tr_b16 v[182:183], v245 offset:1024
    v_fma_f32 v202, v62, -v166, v202
    v_fma_f32 v202, v63, -v167, v202
    v_mfma_f32_32x32x16_bf16 v[16:31], v[64:67], v[192:195], v[16:31]
    v_mfma_f32_32x32x16_bf16 v[32:47], v[68:71], v[192:195], v[32:47]
    s_waitcnt vmcnt(4) lgkmcnt(0)
    v_mfma_f32_32x32x16_bf16 v[0:15], v[72:75], v[176:179], 0
    s_nop 8
    v_mul_f32 v197, v16, v152
    v_fmac_f32 v197, v17, v153
    v_fmac_f32 v197, v18, v154
    v_fmac_f32 v197, v19, v155
    v_fmac_f32 v197, v20, v156
    v_fmac_f32 v197, v21, v157
    s_add_u32 m0, s21, 0
    v_mfma_f32_32x32x16_bf16 v[48:63], v[76:79], v[176:179], 0
    buffer_load_dwordx4 v234, s[4:7], s37 offen  lds
    buffer_load_dwordx4 v235, s[8:11], s37 offen offset:1024  lds
    ds_read_b64_tr_b16 v[176:177], v244 offset:2048
    ds_read_b64_tr_b16 v[178:179], v244 offset:3072
    ds_read_b64_tr_b16 v[184:185], v245 offset:2048
    ds_read_b64_tr_b16 v[186:187], v245 offset:3072
    v_add_u32 v252, s42, v247
    ds_read2_b32 v[234:235], v252 offset0:0 offset1:16
    v_fmac_f32 v197, v22, v158
    v_fmac_f32 v197, v23, v159
    v_mul_f32 v199, v24, v120
    v_fmac_f32 v199, v25, v121
    v_fmac_f32 v199, v26, v122
    v_fmac_f32 v199, v27, v123
    s_waitcnt vmcnt(4) lgkmcnt(1)
    v_mfma_f32_32x32x16_bf16 v[0:15], v[80:83], v[176:179], v[0:15]
    v_fmac_f32 v199, v28, v124
    v_fmac_f32 v199, v29, v125
    v_fmac_f32 v199, v30, v126
    v_fmac_f32 v199, v31, v127
    v_mul_f32_e64 v201, v32, -v168
    v_fma_f32 v201, v33, -v169, v201
    s_add_u32 m0, s21, 2048
    v_mfma_f32_32x32x16_bf16 v[48:63], v[84:87], v[176:179], v[48:63]
    buffer_load_dwordx4 v236, s[4:7], s37 offen  lds
    buffer_load_dwordx4 v237, s[8:11], s37 offen offset:1024  lds
    ds_read_b64_tr_b16 v[176:177], v244 offset:4096
    ds_read_b64_tr_b16 v[178:179], v244 offset:5120
    ds_read_b64_tr_b16 v[188:189], v245 offset:4096
    ds_read_b64_tr_b16 v[190:191], v245 offset:5120
    v_add_u32 v252, s43, v247
    ds_read2_b32 v[236:237], v252 offset0:0 offset1:16
    s_waitcnt vmcnt(4) lgkmcnt(1)
    v_mfma_f32_32x32x16_bf16 v[0:15], v[88:91], v[176:179], v[0:15]
    v_fma_f32 v201, v34, -v170, v201
    v_fma_f32 v201, v35, -v171, v201
    v_fma_f32 v201, v36, -v172, v201
    v_fma_f32 v201, v37, -v173, v201
    v_fma_f32 v201, v38, -v174, v201
    v_fma_f32 v201, v39, -v175, v201
    s_add_u32 m0, s21, 4096
    v_mfma_f32_32x32x16_bf16 v[48:63], v[92:95], v[176:179], v[48:63]
    buffer_load_dwordx4 v238, s[4:7], s37 offen  lds
    buffer_load_dwordx4 v239, s[8:11], s37 offen offset:1024  lds
    ds_read_b64_tr_b16 v[176:177], v244 offset:6144
    ds_read_b64_tr_b16 v[178:179], v244 offset:7168
    ds_read_b64_tr_b16 v[192:193], v245 offset:6144
    ds_read_b64_tr_b16 v[194:195], v245 offset:7168
    v_add_u32 v252, s44, v247
    ds_read2_b32 v[238:239], v252 offset0:0 offset1:16
    s_waitcnt lgkmcnt(1)
    v_mfma_f32_32x32x16_bf16 v[0:15], v[64:67], v[176:179], v[0:15]
    v_mul_f32_e64 v203, v40, -v168
    v_fma_f32 v203, v41, -v169, v203
    v_fma_f32 v203, v42, -v170, v203
    v_fma_f32 v203, v43, -v171, v203
    v_fma_f32 v203, v44, -v172, v203
    v_fma_f32 v203, v45, -v173, v203
    s_add_u32 m0, s21, 6144
    v_mfma_f32_32x32x16_bf16 v[48:63], v[68:71], v[176:179], v[48:63]
    buffer_load_dwordx4 v240, s[4:7], s37 offen  lds
    buffer_load_dwordx4 v241, s[8:11], s37 offen offset:1024  lds
    v_add_u32 v252, s45, v247
    ds_read2_b32 v[240:241], v252 offset0:0 offset1:16
    v_fma_f32 v203, v46, -v174, v203
    v_fma_f32 v203, v47, -v175, v203
    v_mfma_f32_32x32x16_bf16 v[16:31], v[72:75], v[180:183], 0
    v_mul_f32 v254, v0, v144
    v_fmac_f32 v254, v1, v145
    v_fmac_f32 v254, v2, v146
    v_fmac_f32 v254, v3, v147
    v_fmac_f32 v254, v4, v148
    v_fmac_f32 v254, v5, v149
    v_mfma_f32_32x32x16_bf16 v[32:47], v[76:79], v[180:183], 0
    ds_swizzle_b32 v76, v76 offset:0x401F
    ds_swizzle_b32 v77, v77 offset:0x401F
    ds_swizzle_b32 v78, v78 offset:0x401F
    ds_swizzle_b32 v79, v79 offset:0x401F
    v_fmac_f32 v254, v6, v150
    v_fmac_f32 v254, v7, v151
    v_mfma_f32_32x32x16_bf16 v[16:31], v[80:83], v[184:187], v[16:31]
    v_fmac_f32 v200, v8, v160
    v_fmac_f32 v200, v9, v161
    v_permlane32_swap_b32 v196, v254
    v_fmac_f32 v200, v10, v162
    v_fmac_f32 v200, v11, v163
    v_fmac_f32 v200, v12, v164
    v_mfma_f32_32x32x16_bf16 v[32:47], v[84:87], v[184:187], v[32:47]
    ds_swizzle_b32 v84, v84 offset:0x401F
    ds_swizzle_b32 v85, v85 offset:0x401F
    ds_swizzle_b32 v86, v86 offset:0x401F
    ds_swizzle_b32 v87, v87 offset:0x401F
    v_fmac_f32 v200, v13, v165
    v_fmac_f32 v200, v14, v166
    v_mfma_f32_32x32x16_bf16 v[16:31], v[88:91], v[188:191], v[16:31]
    v_fmac_f32 v200, v15, v167
    v_add_f32 v254, v196, v254
    v_mfma_f32_32x32x16_bf16 v[32:47], v[92:95], v[188:191], v[32:47]
    ds_swizzle_b32 v92, v92 offset:0x401F
    ds_swizzle_b32 v93, v93 offset:0x401F
    ds_swizzle_b32 v94, v94 offset:0x401F
    ds_swizzle_b32 v95, v95 offset:0x401F
    s_waitcnt vmcnt(6)
    ds_read_b64_tr_b16 v[176:177], v244 offset:0
    ds_read_b64_tr_b16 v[178:179], v244 offset:1024
    ds_read_b64_tr_b16 v[180:181], v245 offset:0
    ds_read_b64_tr_b16 v[182:183], v245 offset:1024
    v_mfma_f32_32x32x16_bf16 v[16:31], v[64:67], v[192:195], v[16:31]
    v_mfma_f32_32x32x16_bf16 v[32:47], v[68:71], v[192:195], v[32:47]
    ds_swizzle_b32 v68, v68 offset:0x401F
    ds_swizzle_b32 v69, v69 offset:0x401F
    ds_swizzle_b32 v70, v70 offset:0x401F
    ds_swizzle_b32 v71, v71 offset:0x401F
    s_waitcnt lgkmcnt(8)
    s_mov_b64 exec, s[56:57]
    v_xor_b32 v76, 0x80008000, v76
    v_xor_b32 v77, 0x80008000, v77
    v_xor_b32 v78, 0x80008000, v78
    v_xor_b32 v79, 0x80008000, v79
    v_xor_b32 v84, 0x80008000, v84
    v_xor_b32 v85, 0x80008000, v85
    v_xor_b32 v86, 0x80008000, v86
    v_xor_b32 v87, 0x80008000, v87
    v_xor_b32 v92, 0x80008000, v92
    v_xor_b32 v93, 0x80008000, v93
    v_xor_b32 v94, 0x80008000, v94
    v_xor_b32 v95, 0x80008000, v95
    s_mov_b64 exec, -1
    s_waitcnt vmcnt(4) lgkmcnt(4)
    v_mfma_f32_32x32x16_bf16 v[0:15], v[72:75], v[176:179], 0
    v_mul_f32 v255, v16, v152
    v_fmac_f32 v255, v17, v153
    v_fmac_f32 v255, v18, v154
    v_fmac_f32 v255, v19, v155
    v_fmac_f32 v255, v20, v156
    v_fmac_f32 v255, v21, v157
    s_add_u32 m0, s21, 0
    v_mfma_f32_32x32x16_bf16 v[48:63], v[76:79], v[176:179], v[48:63]
    s_cbranch_vccnz WL_8_0
    v_mad_u32_u16 v234, v234, s3, v246 op_sel:[1,0,0,0]
    v_mad_u32_u16 v235, v235, s3, v246 op_sel:[1,0,0,0]
    buffer_load_dwordx4 v234, s[4:7], s38 offen  lds
    buffer_load_dwordx4 v235, s[8:11], s38 offen offset:1024  lds
WR_8_0:
    ds_read_b64_tr_b16 v[176:177], v244 offset:2048
    ds_read_b64_tr_b16 v[178:179], v244 offset:3072
    ds_read_b64_tr_b16 v[184:185], v245 offset:2048
    ds_read_b64_tr_b16 v[186:187], v245 offset:3072
    s_waitcnt vmcnt(4) lgkmcnt(0)
    v_mfma_f32_32x32x16_bf16 v[0:15], v[80:83], v[176:179], v[0:15]
    s_add_u32 m0, s21, 2048
    v_mfma_f32_32x32x16_bf16 v[48:63], v[84:87], v[176:179], v[48:63]
    s_cbranch_vccnz WL_8_1
    v_mad_u32_u16 v236, v236, s3, v246 op_sel:[1,0,0,0]
    v_mad_u32_u16 v237, v237, s3, v246 op_sel:[1,0,0,0]
    buffer_load_dwordx4 v236, s[4:7], s39 offen  lds
    buffer_load_dwordx4 v237, s[8:11], s39 offen offset:1024  lds
WR_8_1:
    ds_read_b64_tr_b16 v[176:177], v244 offset:4096
    ds_read_b64_tr_b16 v[178:179], v244 offset:5120
    ds_read_b64_tr_b16 v[188:189], v245 offset:4096
    ds_read_b64_tr_b16 v[190:191], v245 offset:5120
    s_waitcnt vmcnt(4) lgkmcnt(0)
    v_mfma_f32_32x32x16_bf16 v[0:15], v[88:91], v[176:179], v[0:15]
    v_fmac_f32 v255, v22, v158
    v_fmac_f32 v255, v23, v159
    v_fmac_f32 v201, v24, v168
    v_fmac_f32 v201, v25, v169
    v_permlane32_swap_b32 v197, v255
    v_fmac_f32 v201, v26, v170
    s_add_u32 m0, s21, 4096
    v_mfma_f32_32x32x16_bf16 v[48:63], v[92:95], v[176:179], v[48:63]
    s_cbranch_vccnz WL_8_2
    v_mad_u32_u16 v238, v238, s3, v246 op_sel:[1,0,0,0]
    v_mad_u32_u16 v239, v239, s3, v246 op_sel:[1,0,0,0]
    buffer_load_dwordx4 v238, s[4:7], s40 offen  lds
    buffer_load_dwordx4 v239, s[8:11], s40 offen offset:1024  lds
WR_8_2:
    ds_read_b64_tr_b16 v[176:177], v244 offset:6144
    ds_read_b64_tr_b16 v[178:179], v244 offset:7168
    ds_read_b64_tr_b16 v[192:193], v245 offset:6144
    ds_read_b64_tr_b16 v[194:195], v245 offset:7168
    s_waitcnt lgkmcnt(0)
    s_mov_b64 exec, s[56:57]
    v_xor_b32 v68, 0x80008000, v68
    v_xor_b32 v69, 0x80008000, v69
    v_xor_b32 v70, 0x80008000, v70
    v_xor_b32 v71, 0x80008000, v71
    s_mov_b64 exec, -1
    v_mfma_f32_32x32x16_bf16 v[0:15], v[64:67], v[176:179], v[0:15]
    v_fmac_f32 v201, v27, v171
    v_fmac_f32 v201, v28, v172
    v_fmac_f32 v201, v29, v173
    v_fmac_f32 v201, v30, v174
    v_fmac_f32 v201, v31, v175
    v_add_f32 v255, v197, v255
    s_add_u32 m0, s21, 6144
    v_mfma_f32_32x32x16_bf16 v[48:63], v[68:71], v[176:179], v[48:63]
    s_cbranch_vccnz WL_8_3
    v_mad_u32_u16 v240, v240, s3, v246 op_sel:[1,0,0,0]
    v_mad_u32_u16 v241, v241, s3, v246 op_sel:[1,0,0,0]
    buffer_load_dwordx4 v240, s[4:7], s41 offen  lds
    buffer_load_dwordx4 v241, s[8:11], s41 offen offset:1024  lds
WR_8_3:
    v_cvt_pk_bf16_f32 v254, v254, v255
    ds_write_b32 v253, v254 offset:512
    v_mfma_f32_32x32x16_bf16 v[16:31], v[72:75], v[180:183], 0
    v_mul_f32 v254, v0, v144
    v_fmac_f32 v254, v1, v145
    v_fmac_f32 v254, v2, v146
    v_fmac_f32 v254, v3, v147
    v_fmac_f32 v254, v4, v148
    v_fmac_f32 v254, v5, v149
    v_mfma_f32_32x32x16_bf16 v[32:47], v[76:79], v[180:183], v[32:47]
    v_fmac_f32 v254, v6, v150
    v_fmac_f32 v254, v7, v151
    v_fma_f32 v202, v8, -v160, v202
    v_fma_f32 v202, v9, -v161, v202
    v_permlane32_swap_b32 v254, v200
    v_fma_f32 v202, v10, -v162, v202
    v_mfma_f32_32x32x16_bf16 v[16:31], v[80:83], v[184:187], v[16:31]
    v_fma_f32 v202, v11, -v163, v202
    v_fma_f32 v202, v12, -v164, v202
    v_fma_f32 v202, v13, -v165, v202
    v_fma_f32 v202, v14, -v166, v202
    v_fma_f32 v202, v15, -v167, v202
    v_add_f32 v200, v254, v200
    v_mfma_f32_32x32x16_bf16 v[32:47], v[84:87], v[184:187], v[32:47]
    v_fmac_f32 v198, v48, v112
    v_permlane32_swap_b32 v202, v254
    v_fmac_f32 v198, v49, v113
    v_fmac_f32 v198, v50, v114
    v_fmac_f32 v198, v51, v115
    v_fmac_f32 v198, v52, v116
    v_mfma_f32_32x32x16_bf16 v[16:31], v[88:91], v[188:191], v[16:31]
    v_fmac_f32 v198, v53, v117
    v_fmac_f32 v198, v54, v118
    v_fmac_f32 v198, v55, v119
    v_add_f32 v254, v202, v254
    v_mul_f32 v196, v56, v160
    v_fmac_f32 v196, v57, v161
    v_mfma_f32_32x32x16_bf16 v[32:47], v[92:95], v[188:191], v[32:47]
    s_waitcnt vmcnt(6)
    ds_read_b64_tr_b16 v[176:177], v244 offset:0
    ds_read_b64_tr_b16 v[178:179], v244 offset:1024
    ds_read_b64_tr_b16 v[180:181], v245 offset:0
    ds_read_b64_tr_b16 v[182:183], v245 offset:1024
    v_fmac_f32 v196, v58, v162
    v_fmac_f32 v196, v59, v163
    v_mfma_f32_32x32x16_bf16 v[16:31], v[64:67], v[192:195], v[16:31]
    v_fmac_f32 v196, v60, v164
    v_fmac_f32 v196, v61, v165
    v_fmac_f32 v196, v62, v166
    v_fmac_f32 v196, v63, v167
    s_nop 1
    v_permlane32_swap_b32 v198, v196
    v_add_f32 v196, v198, v196
    v_mfma_f32_32x32x16_bf16 v[32:47], v[68:71], v[192:195], v[32:47]
    v_add_u32 v249, s48, v249
    v_add_u32 v250, s49, v250
    ds_read_b32 v252, v251 offset:16
    ds_read_b64_tr_b16 v[72:73], v249 offset:0
    ds_read_b64_tr_b16 v[76:77], v249 offset:64
    ds_read_b64_tr_b16 v[74:75], v249 offset:256
    ds_read_b64_tr_b16 v[78:79], v249 offset:320
    s_mov_b64 exec, s[54:55]
    ds_read_u16_d16_hi v242, v250 offset:0
    s_mov_b64 exec, -1
    s_cbranch_vccnz LEPI_1
    v_mul_f32 v255, v16, v152
    v_fmac_f32 v255, v17, v153
    v_fmac_f32 v255, v18, v154
    v_fmac_f32 v255, v19, v155
    v_fmac_f32 v255, v20, v156
    v_fmac_f32 v255, v21, v157
    v_fmac_f32 v255, v22, v158
    v_fmac_f32 v255, v23, v159
    v_fma_f32 v203, v24, -v168, v203
    v_fma_f32 v203, v25, -v169, v203
    v_permlane32_swap_b32 v255, v201
    v_fma_f32 v203, v26, -v170, v203
    v_fma_f32 v203, v27, -v171, v203
    v_fma_f32 v203, v28, -v172, v203
    v_fma_f32 v203, v29, -v173, v203
    v_fma_f32 v203, v30, -v174, v203
    v_fma_f32 v203, v31, -v175, v203
    v_add_f32 v201, v255, v201
    v_fmac_f32 v199, v32, v120
    v_permlane32_swap_b32 v203, v255
    v_fmac_f32 v199, v33, v121
    v_fmac_f32 v199, v34, v122
    v_fmac_f32 v199, v35, v123
    v_fmac_f32 v199, v36, v124
    v_fmac_f32 v199, v37, v125
    v_fmac_f32 v199, v38, v126
    v_fmac_f32 v199, v39, v127
    v_add_f32 v255, v203, v255
    v_mul_f32 v197, v40, v168
    v_fmac_f32 v197, v41, v169
    v_fmac_f32 v197, v42, v170
    v_fmac_f32 v197, v43, v171
    v_fmac_f32 v197, v44, v172
    v_fmac_f32 v197, v45, v173
    v_fmac_f32 v197, v46, v174
    v_fmac_f32 v197, v47, v175
    s_nop 1
    v_permlane32_swap_b32 v199, v197
    v_add_f32 v197, v199, v197
    v_cvt_pk_bf16_f32 v200, v200, v201
    v_cvt_pk_bf16_f32 v254, v254, v255
    v_cvt_pk_bf16_f32 v196, v196, v197
    ds_write2st64_b32 v253, v200, v196 offset0:3 offset1:4
    s_mov_b64 exec, 0xffffffff
    ds_write_b32 v253, v254 offset:1280
    s_mov_b64 exec, -1
    s_add_u32 s50, s50, 1
    s_cmp_ge_u32 s50, 4
    s_cbranch_scc1 LAST1
    s_waitcnt lgkmcnt(7)
    v_readfirstlane_b32 s66, v252
    s_add_u32 s53, s53, 1
    v_mov_b32 v252, s53
    s_cmp_le_u32 s53, s66
    ds_write2_b32 v251, v252, v252 offset0:0 offset1:8
    s_setprio 1
    s_cbranch_scc1 PRIO_15
    s_setprio 0
PRIO_15:
    s_cmp_eq_u32 s52, 4
    s_cbranch_scc1 ITEM_1_4
    s_cmp_eq_u32 s52, 5
    s_cbranch_scc1 ITEM_1_5
    s_cmp_eq_u32 s52, 3
    s_cbranch_scc1 ITEM_1_3
    s_cmp_eq_u32 s52, 6
    s_cbranch_scc1 ITEM_1_6
    s_cmp_eq_u32 s52, 8
    s_cbranch_scc1 ITEM_1_8
    s_branch ITEM_1_2
WL_8_0:
    s_add_u32 s66, s51, 0
    buffer_load_dwordx4 v[96:99], v246, s[16:19], s66 offen offset:2048 sc1
    buffer_load_dwordx4 v[100:103], v246, s[16:19], s66 offen offset:3072 sc1
    s_branch WR_8_0
WL_8_1:
    s_add_u32 s66, s51, 4096
    buffer_load_dwordx4 v[104:107], v246, s[16:19], s66 offen offset:2048 sc1
    buffer_load_dwordx4 v[108:111], v246, s[16:19], s66 offen offset:3072 sc1
    s_branch WR_8_1
WL_8_2:
    s_add_u32 s66, s51, 8192
    buffer_load_dwordx4 v[128:131], v246, s[16:19], s66 offen offset:2048 sc1
    buffer_load_dwordx4 v[132:135], v246, s[16:19], s66 offen offset:3072 sc1
    s_branch WR_8_2
WL_8_3:
    s_add_u32 s66, s51, 12288
    buffer_load_dwordx4 v[136:139], v246, s[16:19], s66 offen offset:2048 sc1
    buffer_load_dwordx4 v[140:143], v246, s[16:19], s66 offen offset:3072 sc1
    s_branch WR_8_3
.p2align 6
ITEM_1_2:
    s_mov_b32 m0, s50
    s_nop 0
    s_movrels_b32 s71, s23
    s_movrels_b32 s33, s28
    v_add_u32 v253, s33, v248
    s_bfe_u32 s46, s71, 0x30012
    s_mov_b32 m0, s46
    s_and_b32 s66, s71, 0x3ffff
    s_movrels_b32 s68, s57
    s_movrels_b32 s69, s61
    s_sub_u32 s48, s66, s47
    s_mov_b32 s47, s66
    s_lshr_b32 s52, s71, 28
    s_lshl_b32 s67, s46, 9
    s_add_u32 s66, s66, s67
    s_sub_u32 s49, s66, s42
    s_mov_b32 s42, s66
    s_bfe_u32 s66, s68, 655360
    s_add_u32 s43, s42, s66
    s_bfe_u32 s39, s69, 655360
    s_bfe_u32 s66, s68, 655370
    s_add_u32 s44, s42, s66
    s_bfe_u32 s40, s69, 655370
    s_bfe_u32 s66, s68, 655380
    s_add_u32 s45, s42, s66
    s_bfe_u32 s41, s69, 655380
    v_add_u32 v252, s42, v247
    ds_read2_b32 v[234:235], v252 offset0:0 offset1:16
    v_add_u32 v252, s43, v247
    ds_read2_b32 v[236:237], v252 offset0:0 offset1:16
    v_add_u32 v252, s44, v247
    ds_read2_b32 v[238:239], v252 offset0:0 offset1:16
    v_add_u32 v252, s45, v247
    ds_read2_b32 v[240:241], v252 offset0:0 offset1:16
    s_waitcnt lgkmcnt(4)
    v_mul_f32_dpp v196, v242, v72 row_newbcast:0 row_mask:0xf bank_mask:0xf
    v_mul_f32_dpp v197, v242, v73 row_newbcast:1 row_mask:0xf bank_mask:0xf
    v_mul_f32_dpp v198, v242, v72 row_newbcast:8 row_mask:0xf bank_mask:0xf
    v_mul_f32_dpp v199, v242, v73 row_newbcast:9 row_mask:0xf bank_mask:0xf
    v_mul_f32_dpp v200, v242, v76 row_newbcast:2 row_mask:0xf bank_mask:0xf
    v_mul_f32_dpp v201, v242, v77 row_newbcast:3 row_mask:0xf bank_mask:0xf
    v_mul_f32_dpp v202, v242, v76 row_newbcast:10 row_mask:0xf bank_mask:0xf
    v_mul_f32_dpp v203, v242, v77 row_newbcast:11 row_mask:0xf bank_mask:0xf
    v_cvt_pk_bf16_f32 v72, v196, v197
    v_cvt_pk_bf16_f32 v76, v198, v199
    v_cvt_pk_bf16_f32 v73, v200, v201
    v_cvt_pk_bf16_f32 v77, v202, v203
    v_mul_f32_dpp v196, v242, v74 row_newbcast:4 row_mask:0xf bank_mask:0xf
    v_mul_f32_dpp v197, v242, v75 row_newbcast:5 row_mask:0xf bank_mask:0xf
    v_mul_f32_dpp v198, v242, v74 row_newbcast:12 row_mask:0xf bank_mask:0xf
    v_mul_f32_dpp v199, v242, v75 row_newbcast:13 row_mask:0xf bank_mask:0xf
    v_mul_f32_dpp v200, v242, v78 row_newbcast:6 row_mask:0xf bank_mask:0xf
    v_mul_f32_dpp v201, v242, v79 row_newbcast:7 row_mask:0xf bank_mask:0xf
    v_mul_f32_dpp v202, v242, v78 row_newbcast:14 row_mask:0xf bank_mask:0xf
    v_mul_f32_dpp v203, v242, v79 row_newbcast:15 row_mask:0xf bank_mask:0xf
    v_cvt_pk_bf16_f32 v74, v196, v197
    v_cvt_pk_bf16_f32 v78, v198, v199
    v_cvt_pk_bf16_f32 v75, v200, v201
    v_cvt_pk_bf16_f32 v79, v202, v203
    s_nop 0
    s_waitcnt lgkmcnt(3)
    v_mfma_f32_32x32x16_bf16 v[56:71], v[72:75], v[176:179], 0
    s_add_u32 m0, s21, 0
    v_mfma_f32_32x32x16_bf16 v[16:31], v[76:79], v[176:179], 0
    s_cbranch_vccnz WL_2_0
    v_mad_u32_u16 v234, v234, s3, v246 op_sel:[1,0,0,0]
    v_mad_u32_u16 v235, v235, s3, v246 op_sel:[1,0,0,0]
    buffer_load_dwordx4 v234, s[4:7], s38 offen  lds
    buffer_load_dwordx4 v235, s[8:11], s38 offen offset:1024  lds
WR_2_0:
    v_mfma_f32_32x32x16_bf16 v[32:47], v[72:75], v[180:183], 0
    s_nop 3
    v_mul_f32 v196, v56, v96
    v_fmac_f32 v196, v57, v97
    v_fmac_f32 v196, v58, v98
    v_fmac_f32 v196, v59, v99
    v_fmac_f32 v196, v60, v100
    v_fmac_f32 v196, v61, v101
    v_mfma_f32_32x32x16_bf16 v[0:15], v[76:79], v[180:183], 0
    s_waitcnt vmcnt(6)
    ds_read_b64_tr_b16 v[176:177], v244 offset:2048
    ds_read_b64_tr_b16 v[178:179], v244 offset:3072
    ds_read_b64_tr_b16 v[180:181], v245 offset:2048
    ds_read_b64_tr_b16 v[182:183], v245 offset:3072
    v_fmac_f32 v196, v62, v102
    v_fmac_f32 v196, v63, v103
    v_mul_f32 v198, v64, v128
    v_fmac_f32 v198, v65, v129
    v_fmac_f32 v198, v66, v130
    v_fmac_f32 v198, v67, v131
    v_fmac_f32 v198, v68, v132
    v_fmac_f32 v198, v69, v133
    v_fmac_f32 v198, v70, v134
    v_fmac_f32 v198, v71, v135
    v_mul_f32 v200, v16, v128
    v_fmac_f32 v200, v17, v129
    v_permlane32_swap_b32 v196, v198
    v_fmac_f32 v200, v18, v130
    v_fmac_f32 v200, v19, v131
    v_fmac_f32 v200, v20, v132
    v_fmac_f32 v200, v21, v133
    v_fmac_f32 v200, v22, v134
    v_fmac_f32 v200, v23, v135
    v_add_f32 v198, v196, v198
    v_mul_f32_e64 v202, v24, -v128
    v_fma_f32 v202, v25, -v129, v202
    v_fma_f32 v202, v26, -v130, v202
    v_fma_f32 v202, v27, -v131, v202
    v_fma_f32 v202, v28, -v132, v202
    v_fma_f32 v202, v29, -v133, v202
    v_fma_f32 v202, v30, -v134, v202
    v_fma_f32 v202, v31, -v135, v202
    s_nop 1
    v_permlane32_swap_b32 v200, v202
    v_add_f32 v202, v200, v202
    s_waitcnt lgkmcnt(0)
    v_mfma_f32_32x32x16_bf16 v[56:71], v[72:75], v[176:179], 0
    v_mul_f32 v197, v32, v104
    v_fmac_f32 v197, v33, v105
    v_fmac_f32 v197, v34, v106
    v_fmac_f32 v197, v35, v107
    v_fmac_f32 v197, v36, v108
    v_fmac_f32 v197, v37, v109
    s_add_u32 m0, s21, 2048
    v_mfma_f32_32x32x16_bf16 v[16:31], v[76:79], v[176:179], 0
    s_cbranch_vccnz WL_2_1
    v_mad_u32_u16 v236, v236, s3, v246 op_sel:[1,0,0,0]
    v_mad_u32_u16 v237, v237, s3, v246 op_sel:[1,0,0,0]
    buffer_load_dwordx4 v236, s[4:7], s39 offen  lds
    buffer_load_dwordx4 v237, s[8:11], s39 offen offset:1024  lds
WR_2_1:
    v_fmac_f32 v197, v38, v110
    v_fmac_f32 v197, v39, v111
    v_mul_f32 v199, v40, v136
    v_fmac_f32 v199, v41, v137
    v_fmac_f32 v199, v42, v138
    v_fmac_f32 v199, v43, v139
    v_fmac_f32 v199, v44, v140
    v_fmac_f32 v199, v45, v141
    v_fmac_f32 v199, v46, v142
    v_fmac_f32 v199, v47, v143
    v_mul_f32 v201, v0, v136
    v_fmac_f32 v201, v1, v137
    v_permlane32_swap_b32 v197, v199
    v_fmac_f32 v201, v2, v138
    v_fmac_f32 v201, v3, v139
    v_fmac_f32 v201, v4, v140
    v_fmac_f32 v201, v5, v141
    v_fmac_f32 v201, v6, v142
    v_fmac_f32 v201, v7, v143
    v_add_f32 v199, v197, v199
    v_mul_f32_e64 v203, v8, -v136
    v_fma_f32 v203, v9, -v137, v203
    v_fma_f32 v203, v10, -v138, v203
    v_fma_f32 v203, v11, -v139, v203
    v_fma_f32 v203, v12, -v140, v203
    v_fma_f32 v203, v13, -v141, v203
    v_fma_f32 v203, v14, -v142, v203
    v_fma_f32 v203, v15, -v143, v203
    s_nop 1
    v_permlane32_swap_b32 v201, v203
    v_add_f32 v203, v201, v203
    v_cvt_pk_bf16_f32 v192, v198, v199
    v_cvt_pk_bf16_f32 v193, v202, v203
    v_mfma_f32_32x32x16_bf16 v[32:47], v[72:75], v[180:183], 0
    v_mul_f32 v196, v56, v144
    v_fmac_f32 v196, v57, v145
    v_fmac_f32 v196, v58, v146
    v_fmac_f32 v196, v59, v147
    v_fmac_f32 v196, v60, v148
    v_fmac_f32 v196, v61, v149
    v_mfma_f32_32x32x16_bf16 v[0:15], v[76:79], v[180:183], 0
    s_waitcnt vmcnt(6)
    ds_read_b64_tr_b16 v[176:177], v244 offset:4096
    ds_read_b64_tr_b16 v[178:179], v244 offset:5120
    ds_read_b64_tr_b16 v[180:181], v245 offset:4096
    ds_read_b64_tr_b16 v[182:183], v245 offset:5120
    v_fmac_f32 v196, v62, v150
    v_fmac_f32 v196, v63, v151
    v_mul_f32_e64 v200, v16, -v160
    v_fma_f32 v200, v17, -v161, v200
    v_fma_f32 v200, v18, -v162, v200
    v_fma_f32 v200, v19, -v163, v200
    v_fma_f32 v200, v20, -v164, v200
    v_fma_f32 v200, v21, -v165, v200
    v_fma_f32 v200, v22, -v166, v200
    v_fma_f32 v200, v23, -v167, v200
    v_mul_f32_e64 v202, v24, -v160
    v_fma_f32 v202, v25, -v161, v202
    v_fma_f32 v202, v26, -v162, v202
    v_fma_f32 v202, v27, -v163, v202
    v_fma_f32 v202, v28, -v164, v202
    v_fma_f32 v202, v29, -v165, v202
    v_fma_f32 v202, v30, -v166, v202
    v_fma_f32 v202, v31, -v167, v202
    s_waitcnt lgkmcnt(0)
    v_mfma_f32_32x32x16_bf16 v[16:31], v[72:75], v[176:179], 0
    v_mul_f32 v197, v32, v152
    v_fmac_f32 v197, v33, v153
    v_fmac_f32 v197, v34, v154
    v_fmac_f32 v197, v35, v155
    v_fmac_f32 v197, v36, v156
    v_fmac_f32 v197, v37, v157
    s_add_u32 m0, s21, 4096
    v_mfma_f32_32x32x16_bf16 v[48:63], v[76:79], v[176:179], 0
    s_cbranch_vccnz WL_2_2
    v_mad_u32_u16 v238, v238, s3, v246 op_sel:[1,0,0,0]
    v_mad_u32_u16 v239, v239, s3, v246 op_sel:[1,0,0,0]
    buffer_load_dwordx4 v238, s[4:7], s40 offen  lds
    buffer_load_dwordx4 v239, s[8:11], s40 offen offset:1024  lds
WR_2_2:
    v_fmac_f32 v197, v38, v158
    v_fmac_f32 v197, v39, v159
    v_mul_f32_e64 v201, v0, -v168
    v_fma_f32 v201, v1, -v169, v201
    v_fma_f32 v201, v2, -v170, v201
    v_fma_f32 v201, v3, -v171, v201
    v_fma_f32 v201, v4, -v172, v201
    v_fma_f32 v201, v5, -v173, v201
    v_fma_f32 v201, v6, -v174, v201
    v_fma_f32 v201, v7, -v175, v201
    v_mul_f32_e64 v203, v8, -v168
    v_fma_f32 v203, v9, -v169, v203
    v_fma_f32 v203, v10, -v170, v203
    v_fma_f32 v203, v11, -v171, v203
    v_fma_f32 v203, v12, -v172, v203
    v_fma_f32 v203, v13, -v173, v203
    v_fma_f32 v203, v14, -v174, v203
    v_fma_f32 v203, v15, -v175, v203
    v_mfma_f32_32x32x16_bf16 v[0:15], v[72:75], v[180:183], 0
    v_fmac_f32 v200, v24, v160
    v_fmac_f32 v200, v25, v161
    v_fmac_f32 v200, v26, v162
    v_fmac_f32 v200, v27, v163
    v_fmac_f32 v200, v28, v164
    v_fmac_f32 v200, v29, v165
    v_fmac_f32 v200, v30, v166
    v_fmac_f32 v200, v31, v167
    v_mfma_f32_32x32x16_bf16 v[24:39], v[76:79], v[180:183], 0
    s_waitcnt vmcnt(6)
    ds_read_b64_tr_b16 v[176:177], v244 offset:6144
    ds_read_b64_tr_b16 v[178:179], v244 offset:7168
    ds_read_b64_tr_b16 v[180:181], v245 offset:6144
    ds_read_b64_tr_b16 v[182:183], v245 offset:7168
    v_mul_f32 v254, v16, v144
    v_fmac_f32 v254, v17, v145
    v_fmac_f32 v254, v18, v146
    v_fmac_f32 v254, v19, v147
    v_fmac_f32 v254, v20, v148
    v_fmac_f32 v254, v21, v149
    v_fmac_f32 v254, v22, v150
    v_fmac_f32 v254, v23, v151
    v_sub_f32_e64 v64, -v48, v64
    v_sub_f32_e64 v65, -v49, v65
    v_permlane32_swap_b32 v196, v254
    v_sub_f32_e64 v66, -v50, v66
    v_sub_f32_e64 v67, -v51, v67
    v_sub_f32_e64 v68, -v52, v68
    v_sub_f32_e64 v69, -v53, v69
    v_sub_f32_e64 v70, -v54, v70
    v_sub_f32_e64 v71, -v55, v71
    v_add_f32 v254, v196, v254
    s_waitcnt lgkmcnt(0)
    v_mfma_f32_32x32x16_bf16 v[56:71], v[76:79], v[176:179], v[56:71]
    v_sub_f32_e64 v40, -v24, v40
    v_sub_f32_e64 v41, -v25, v41
    v_sub_f32_e64 v42, -v26, v42
    v_sub_f32_e64 v43, -v27, v43
    v_sub_f32_e64 v44, -v28, v44
    v_sub_f32_e64 v45, -v29, v45
    v_sub_f32_e64 v46, -v30, v46
    v_sub_f32_e64 v47, -v31, v47
    s_add_u32 m0, s21, 6144
    v_mfma_f32_32x32x16_bf16 v[16:31], v[72:75], v[176:179], 0
    s_cbranch_vccnz WL_2_3
    v_mad_u32_u16 v240, v240, s3, v246 op_sel:[1,0,0,0]
    v_mad_u32_u16 v241, v241, s3, v246 op_sel:[1,0,0,0]
    buffer_load_dwordx4 v240, s[4:7], s41 offen  lds
    buffer_load_dwordx4 v241, s[8:11], s41 offen offset:1024  lds
WR_2_3:
    v_mul_f32 v255, v0, v152
    v_fmac_f32 v255, v1, v153
    v_fmac_f32 v255, v2, v154
    v_fmac_f32 v255, v3, v155
    v_fmac_f32 v255, v4, v156
    v_fmac_f32 v255, v5, v157
    v_fmac_f32 v255, v6, v158
    v_fmac_f32 v255, v7, v159
    v_fmac_f32 v201, v8, v168
    v_fmac_f32 v201, v9, v169
    v_permlane32_swap_b32 v197, v255
    v_fmac_f32 v201, v10, v170
    v_fmac_f32 v201, v11, v171
    v_fmac_f32 v201, v12, v172
    v_fmac_f32 v201, v13, v173
    v_fmac_f32 v201, v14, v174
    v_fmac_f32 v201, v15, v175
    v_add_f32 v255, v197, v255
    v_cvt_pk_bf16_f32 v194, v254, v255
    v_mfma_f32_32x32x16_bf16 v[0:15], v[72:75], v[180:183], 0
    v_mul_f32 v254, v16, v144
    v_fmac_f32 v254, v17, v145
    v_fmac_f32 v254, v18, v146
    v_fmac_f32 v254, v19, v147
    v_fmac_f32 v254, v20, v148
    v_fmac_f32 v254, v21, v149
    v_mfma_f32_32x32x16_bf16 v[32:47], v[76:79], v[180:183], v[32:47]
    s_waitcnt vmcnt(6)
    ds_read_b64_tr_b16 v[176:177], v244 offset:0
    ds_read_b64_tr_b16 v[178:179], v244 offset:1024
    ds_read_b64_tr_b16 v[180:181], v245 offset:0
    ds_read_b64_tr_b16 v[182:183], v245 offset:1024
    v_add_u32 v249, s48, v249
    v_add_u32 v250, s49, v250
    ds_read_b32 v252, v251 offset:16
    ds_read_b64_tr_b16 v[72:73], v249 offset:0
    ds_read_b64_tr_b16 v[76:77], v249 offset:64
    ds_read_b64_tr_b16 v[74:75], v249 offset:256
    ds_read_b64_tr_b16 v[78:79], v249 offset:320
    s_mov_b64 exec, s[54:55]
    ds_read_u16_d16_hi v242, v250 offset:0
    s_mov_b64 exec, -1
    v_fmac_f32 v254, v22, v150
    v_fmac_f32 v254, v23, v151
    v_fma_f32 v202, v24, -v160, v202
    v_fma_f32 v202, v25, -v161, v202
    v_permlane32_swap_b32 v254, v200
    v_fma_f32 v202, v26, -v162, v202
    v_fma_f32 v202, v27, -v163, v202
    v_fma_f32 v202, v28, -v164, v202
    v_fma_f32 v202, v29, -v165, v202
    v_fma_f32 v202, v30, -v166, v202
    v_fma_f32 v202, v31, -v167, v202
    v_add_f32 v200, v254, v200
    v_mul_f32_e64 v198, v64, -v112
    v_permlane32_swap_b32 v202, v254
    v_fma_f32 v198, v65, -v113, v198
    v_fma_f32 v198, v66, -v114, v198
    v_fma_f32 v198, v67, -v115, v198
    v_fma_f32 v198, v68, -v116, v198
    v_fma_f32 v198, v69, -v117, v198
    v_fma_f32 v198, v70, -v118, v198
    v_fma_f32 v198, v71, -v119, v198
    v_add_f32 v254, v202, v254
    v_mul_f32 v196, v56, v160
    v_fmac_f32 v196, v57, v161
    v_fmac_f32 v196, v58, v162
    v_fmac_f32 v196, v59, v163
    v_fmac_f32 v196, v60, v164
    v_fmac_f32 v196, v61, v165
    v_fmac_f32 v196, v62, v166
    v_fmac_f32 v196, v63, v167
    s_nop 1
    v_permlane32_swap_b32 v198, v196
    v_add_f32 v196, v198, v196
    s_cbranch_vccnz LEPI_2
    v_mul_f32 v255, v0, v152
    v_fmac_f32 v255, v1, v153
    v_fmac_f32 v255, v2, v154
    v_fmac_f32 v255, v3, v155
    v_fmac_f32 v255, v4, v156
    v_fmac_f32 v255, v5, v157
    v_fmac_f32 v255, v6, v158
    v_fmac_f32 v255, v7, v159
    v_fma_f32 v203, v8, -v168, v203
    v_fma_f32 v203, v9, -v169, v203
    v_permlane32_swap_b32 v255, v201
    v_fma_f32 v203, v10, -v170, v203
    v_fma_f32 v203, v11, -v171, v203
    v_fma_f32 v203, v12, -v172, v203
    v_fma_f32 v203, v13, -v173, v203
    v_fma_f32 v203, v14, -v174, v203
    v_fma_f32 v203, v15, -v175, v203
    v_add_f32 v201, v255, v201
    v_mul_f32_e64 v199, v40, -v120
    v_permlane32_swap_b32 v203, v255
    v_fma_f32 v199, v41, -v121, v199
    v_fma_f32 v199, v42, -v122, v199
    v_fma_f32 v199, v43, -v123, v199
    v_fma_f32 v199, v44, -v124, v199
    v_fma_f32 v199, v45, -v125, v199
    v_fma_f32 v199, v46, -v126, v199
    v_fma_f32 v199, v47, -v127, v199
    v_add_f32 v255, v203, v255
    v_mul_f32 v197, v32, v168
    v_fmac_f32 v197, v33, v169
    v_fmac_f32 v197, v34, v170
    v_fmac_f32 v197, v35, v171
    v_fmac_f32 v197, v36, v172
    v_fmac_f32 v197, v37, v173
    v_fmac_f32 v197, v38, v174
    v_fmac_f32 v197, v39, v175
    s_nop 1
    v_permlane32_swap_b32 v199, v197
    v_add_f32 v197, v199, v197
    v_cvt_pk_bf16_f32 v200, v200, v201
    v_cvt_pk_bf16_f32 v254, v254, v255
    v_cvt_pk_bf16_f32 v196, v196, v197
    ds_write2st64_b32 v253, v192, v193 offset0:0 offset1:1
    ds_write2st64_b32 v253, v194, v200 offset0:2 offset1:3
    ds_write_b32 v253, v196 offset:1024
    s_mov_b64 exec, 0xffffffff
    ds_write_b32 v253, v254 offset:1280
    s_mov_b64 exec, -1
    s_add_u32 s50, s50, 1
    s_cmp_ge_u32 s50, 4
    s_cbranch_scc1 LAST1
    s_waitcnt lgkmcnt(9)
    v_readfirstlane_b32 s66, v252
    s_add_u32 s53, s53, 1
    v_mov_b32 v252, s53
    s_cmp_le_u32 s53, s66
    ds_write2_b32 v251, v252, v252 offset0:0 offset1:8
    s_setprio 1
    s_cbranch_scc1 PRIO_16
    s_setprio 0
PRIO_16:
    s_cmp_eq_u32 s52, 4
    s_cbranch_scc1 ITEM_1_4
    s_cmp_eq_u32 s52, 5
    s_cbranch_scc1 ITEM_1_5
    s_cmp_eq_u32 s52, 3
    s_cbranch_scc1 ITEM_1_3
    s_cmp_eq_u32 s52, 6
    s_cbranch_scc1 ITEM_1_6
    s_cmp_eq_u32 s52, 8
    s_cbranch_scc1 ITEM_1_8
    s_branch ITEM_1_2
WL_2_0:
    s_add_u32 s66, s51, 0
    buffer_load_dword v195, v246, s[16:19], s66 offen
    buffer_load_dword v195, v246, s[16:19], s66 offen
    s_branch WR_2_0
WL_2_1:
    s_add_u32 s66, s51, 4096
    buffer_load_dword v195, v246, s[16:19], s66 offen
    buffer_load_dword v195, v246, s[16:19], s66 offen
    s_branch WR_2_1
WL_2_2:
    s_add_u32 s66, s51, 8192
    buffer_load_dword v195, v246, s[16:19], s66 offen
    buffer_load_dword v195, v246, s[16:19], s66 offen
    s_branch WR_2_2
WL_2_3:
    s_add_u32 s66, s51, 12288
    buffer_load_dword v195, v246, s[16:19], s66 offen
    buffer_load_dword v195, v246, s[16:19], s66 offen
    s_branch WR_2_3
.p2align 6
.p2align 6
LEPI_2:
    s_lshl_b32 s71, s20, 4
    s_add_u32 s67, s51, 4096
    s_add_u32 s68, s51, 8192
    s_add_u32 s69, s51, 12288
    s_add_u32 s70, s51, 16384
    s_waitcnt lgkmcnt(0)
    buffer_load_dwordx4 v[96:99], v246, s[16:19], s51 offen offset:2048 sc1
    s_mov_b32 s52, 163072
    v_bfe_u32 v177, v246, 4, 4
    v_bfe_u32 v179, v246, 4, 3
    v_lshl_add_u32 v180, v177, 3, s52
    v_lshl_add_u32 v190, v177, 4, s52
    v_lshl_add_u32 v181, v179, 3, s52
    ds_read2_b64 v[182:185], v180 offset0:32 offset1:48
    ds_read_b32 v191, v190
    ds_read_b64 v[186:187], v181 offset:512
    v_lshrrev_b32 v178, 8, v246
    buffer_load_dwordx4 v[100:103], v246, s[16:19], s51 offen offset:3072 sc1
    v_add_u32 v234, s21, v248
    v_add_u32 v235, 128, v234
    v_mul_f32 v255, v0, v152
    buffer_load_dwordx4 v[104:107], v246, s[16:19], s67 offen offset:2048 sc1
    v_fmac_f32 v255, v1, v153
    v_fmac_f32 v255, v2, v154
    ds_write2st64_b32 v234, v204, v205 offset0:0 offset1:1
    v_fmac_f32 v255, v3, v155
    buffer_load_dwordx4 v[108:111], v246, s[16:19], s67 offen offset:3072 sc1
    v_fmac_f32 v255, v4, v156
    v_fmac_f32 v255, v5, v157
    ds_write2st64_b32 v234, v206, v207 offset0:2 offset1:3
    v_fmac_f32 v255, v6, v158
    buffer_load_dwordx4 v[128:131], v246, s[16:19], s68 offen offset:2048 sc1
    v_fmac_f32 v255, v7, v159
    v_fma_f32 v203, v8, -v168, v203
    ds_write2st64_b32 v234, v208, v209 offset0:4 offset1:5
    v_fma_f32 v203, v9, -v169, v203
    buffer_load_dwordx4 v[132:135], v246, s[16:19], s68 offen offset:3072 sc1
    v_permlane32_swap_b32 v255, v201
    v_fma_f32 v203, v10, -v170, v203
    ds_write2st64_b32 v235, v210, v211 offset0:6 offset1:7
    v_fma_f32 v203, v11, -v171, v203
    v_fma_f32 v203, v12, -v172, v203
    buffer_load_dwordx4 v[136:139], v246, s[16:19], s69 offen offset:2048 sc1
    v_fma_f32 v203, v13, -v173, v203
    ds_write2st64_b32 v235, v212, v213 offset0:8 offset1:9
    v_fma_f32 v203, v14, -v174, v203
    v_fma_f32 v203, v15, -v175, v203
    buffer_load_dwordx4 v[140:143], v246, s[16:19], s69 offen offset:3072 sc1
    v_add_f32 v201, v255, v201
    ds_write2st64_b32 v235, v214, v215 offset0:10 offset1:11
    v_mul_f32_e64 v199, v40, -v120
    v_permlane32_swap_b32 v203, v255
    buffer_load_dwordx4 v[112:115], v246, s[16:19], s70 offen offset:2048 sc1
    v_fma_f32 v199, v41, -v121, v199
    ds_write2st64_b32 v234, v216, v217 offset0:12 offset1:13
    v_fma_f32 v199, v42, -v122, v199
    v_fma_f32 v199, v43, -v123, v199
    buffer_load_dwordx4 v[116:119], v246, s[16:19], s70 offen offset:3072 sc1
    v_fma_f32 v199, v44, -v124, v199
    ds_write2st64_b32 v234, v218, v219 offset0:14 offset1:15
    v_fma_f32 v199, v45, -v125, v199
    v_fma_f32 v199, v46, -v126, v199
    buffer_load_dwordx4 v[144:147], v246, s[16:19], s51 offen offset:0 sc1
    v_fma_f32 v199, v47, -v127, v199
    v_add_f32 v255, v203, v255
    ds_write2st64_b32 v234, v220, v221 offset0:16 offset1:17
    v_mul_f32 v197, v32, v168
    buffer_load_dwordx4 v[148:151], v246, s[16:19], s51 offen offset:1024 sc1
    v_fmac_f32 v197, v33, v169
    v_fmac_f32 v197, v34, v170
    ds_write2st64_b32 v235, v222, v223 offset0:18 offset1:19
    v_fmac_f32 v197, v35, v171
    buffer_load_dwordx4 v[160:163], v246, s[16:19], s67 offen offset:0 sc1
    v_fmac_f32 v197, v36, v172
    v_fmac_f32 v197, v37, v173
    ds_write2st64_b32 v235, v224, v225 offset0:20 offset1:21
    v_fmac_f32 v197, v38, v174
    buffer_load_dwordx4 v[164:167], v246, s[16:19], s67 offen offset:1024 sc1
    v_fmac_f32 v197, v39, v175
    s_nop 1
    ds_write2st64_b32 v235, v226, v227 offset0:22 offset1:23
    v_permlane32_swap_b32 v199, v197
    ds_write2st64_b32 v234, v228, v229 offset0:24 offset1:25
    v_add_f32 v197, v199, v197
    v_cvt_pk_bf16_f32 v200, v200, v201
    ds_write2st64_b32 v234, v230, v231 offset0:26 offset1:27
    v_cvt_pk_bf16_f32 v254, v254, v255
    v_cvt_pk_bf16_f32 v196, v196, v197
    ds_write2st64_b32 v234, v232, v233 offset0:28 offset1:29
    ds_write2st64_b32 v253, v192, v193 offset0:0 offset1:1
    ds_write2st64_b32 v253, v194, v200 offset0:2 offset1:3
    ds_write_b32 v253, v196 offset:1024
    s_mov_b64 exec, 0xffffffff
    ds_write_b32 v253, v254 offset:1280
    s_mov_b64 exec, -1
    s_add_u32 s50, s53, 1
    v_mov_b32 v234, s50
    ds_write2_b32 v251, v234, v234 offset0:0 offset1:8
    s_waitcnt lgkmcnt(15)
    s_branch TAIL
.p2align 6
LEPI_1:
    s_lshl_b32 s71, s20, 4
    s_add_u32 s67, s51, 4096
    s_add_u32 s68, s51, 8192
    s_add_u32 s69, s51, 12288
    s_add_u32 s70, s51, 16384
    s_waitcnt lgkmcnt(0)
    buffer_load_dwordx4 v[112:115], v246, s[16:19], s70 offen offset:2048 sc1
    s_mov_b32 s52, 163072
    v_bfe_u32 v177, v246, 4, 4
    v_bfe_u32 v179, v246, 4, 3
    v_lshl_add_u32 v180, v177, 3, s52
    v_lshl_add_u32 v190, v177, 4, s52
    v_lshl_add_u32 v181, v179, 3, s52
    ds_read2_b64 v[182:185], v180 offset0:32 offset1:48
    ds_read_b32 v191, v190
    ds_read_b64 v[186:187], v181 offset:512
    v_lshrrev_b32 v178, 8, v246
    buffer_load_dwordx4 v[116:119], v246, s[16:19], s70 offen offset:3072 sc1
    v_add_u32 v234, s21, v248
    v_add_u32 v235, 128, v234
    v_mul_f32 v255, v16, v152
    v_fmac_f32 v255, v17, v153
    buffer_load_dwordx4 v[144:147], v246, s[16:19], s51 offen offset:0 sc1
    v_fmac_f32 v255, v18, v154
    v_fmac_f32 v255, v19, v155
    ds_write2st64_b32 v234, v204, v205 offset0:0 offset1:1
    v_fmac_f32 v255, v20, v156
    v_fmac_f32 v255, v21, v157
    buffer_load_dwordx4 v[148:151], v246, s[16:19], s51 offen offset:1024 sc1
    v_fmac_f32 v255, v22, v158
    v_fmac_f32 v255, v23, v159
    ds_write2st64_b32 v234, v206, v207 offset0:2 offset1:3
    v_fma_f32 v203, v24, -v168, v203
    v_fma_f32 v203, v25, -v169, v203
    v_permlane32_swap_b32 v255, v201
    buffer_load_dwordx4 v[160:163], v246, s[16:19], s67 offen offset:0 sc1
    v_fma_f32 v203, v26, -v170, v203
    v_fma_f32 v203, v27, -v171, v203
    ds_write2st64_b32 v234, v208, v209 offset0:4 offset1:5
    v_fma_f32 v203, v28, -v172, v203
    v_fma_f32 v203, v29, -v173, v203
    buffer_load_dwordx4 v[164:167], v246, s[16:19], s67 offen offset:1024 sc1
    v_fma_f32 v203, v30, -v174, v203
    v_fma_f32 v203, v31, -v175, v203
    ds_write2st64_b32 v235, v210, v211 offset0:6 offset1:7
    v_add_f32 v201, v255, v201
    v_fmac_f32 v199, v32, v120
    ds_write2st64_b32 v235, v212, v213 offset0:8 offset1:9
    v_permlane32_swap_b32 v203, v255
    v_fmac_f32 v199, v33, v121
    v_fmac_f32 v199, v34, v122
    ds_write2st64_b32 v235, v214, v215 offset0:10 offset1:11
    v_fmac_f32 v199, v35, v123
    v_fmac_f32 v199, v36, v124
    ds_write2st64_b32 v234, v216, v217 offset0:12 offset1:13
    v_fmac_f32 v199, v37, v125
    v_fmac_f32 v199, v38, v126
    ds_write2st64_b32 v234, v218, v219 offset0:14 offset1:15
    v_fmac_f32 v199, v39, v127
    v_add_f32 v255, v203, v255
    ds_write2st64_b32 v234, v220, v221 offset0:16 offset1:17
    v_mul_f32 v197, v40, v168
    v_fmac_f32 v197, v41, v169
    ds_write2st64_b32 v235, v222, v223 offset0:18 offset1:19
    v_fmac_f32 v197, v42, v170
    v_fmac_f32 v197, v43, v171
    v_fmac_f32 v197, v44, v172
    ds_write2st64_b32 v235, v224, v225 offset0:20 offset1:21
    v_fmac_f32 v197, v45, v173
    v_fmac_f32 v197, v46, v174
    ds_write2st64_b32 v235, v226, v227 offset0:22 offset1:23
    v_fmac_f32 v197, v47, v175
    s_nop 1
    ds_write2st64_b32 v234, v228, v229 offset0:24 offset1:25
    v_permlane32_swap_b32 v199, v197
    v_add_f32 v197, v199, v197
    ds_write2st64_b32 v234, v230, v231 offset0:26 offset1:27
    v_cvt_pk_bf16_f32 v200, v200, v201
    v_cvt_pk_bf16_f32 v254, v254, v255
    v_cvt_pk_bf16_f32 v196, v196, v197
    ds_write2st64_b32 v234, v232, v233 offset0:28 offset1:29
    ds_write2st64_b32 v253, v200, v196 offset0:3 offset1:4
    s_mov_b64 exec, 0xffffffff
    ds_write_b32 v253, v254 offset:1280
    s_mov_b64 exec, -1
    s_add_u32 s50, s53, 1
    v_mov_b32 v234, s50
    ds_write2_b32 v251, v234, v234 offset0:0 offset1:8
    s_waitcnt lgkmcnt(15)
    s_branch TAIL
.p2align 6
LEPI_0:
    s_lshl_b32 s71, s20, 4
    s_add_u32 s67, s51, 4096
    s_add_u32 s68, s51, 8192
    s_add_u32 s69, s51, 12288
    s_add_u32 s70, s51, 16384
    s_waitcnt lgkmcnt(0)
    buffer_load_dwordx4 v[112:115], v246, s[16:19], s70 offen offset:2048 sc1
    s_mov_b32 s52, 163072
    v_bfe_u32 v177, v246, 4, 4
    v_bfe_u32 v179, v246, 4, 3
    v_lshl_add_u32 v180, v177, 3, s52
    v_lshl_add_u32 v190, v177, 4, s52
    v_lshl_add_u32 v181, v179, 3, s52
    ds_read2_b64 v[182:185], v180 offset0:32 offset1:48
    ds_read_b32 v191, v190
    ds_read_b64 v[186:187], v181 offset:512
    v_lshrrev_b32 v178, 8, v246
    buffer_load_dwordx4 v[116:119], v246, s[16:19], s70 offen offset:3072 sc1
    v_add_u32 v234, s21, v248
    v_add_u32 v235, 128, v234
    v_mul_f32 v255, v0, v152
    v_fmac_f32 v255, v1, v153
    buffer_load_dwordx4 v[144:147], v246, s[16:19], s51 offen offset:0 sc1
    v_fmac_f32 v255, v2, v154
    v_fmac_f32 v255, v3, v155
    ds_write2st64_b32 v234, v204, v205 offset0:0 offset1:1
    v_fmac_f32 v255, v4, v156
    v_fmac_f32 v255, v5, v157
    buffer_load_dwordx4 v[148:151], v246, s[16:19], s51 offen offset:1024 sc1
    v_fmac_f32 v255, v6, v158
    v_fmac_f32 v255, v7, v159
    ds_write2st64_b32 v234, v206, v207 offset0:2 offset1:3
    v_fma_f32 v203, v8, -v168, v203
    v_fma_f32 v203, v9, -v169, v203
    v_permlane32_swap_b32 v255, v201
    buffer_load_dwordx4 v[160:163], v246, s[16:19], s67 offen offset:0 sc1
    v_fma_f32 v203, v10, -v170, v203
    v_fma_f32 v203, v11, -v171, v203
    ds_write2st64_b32 v234, v208, v209 offset0:4 offset1:5
    v_fma_f32 v203, v12, -v172, v203
    v_fma_f32 v203, v13, -v173, v203
    buffer_load_dwordx4 v[164:167], v246, s[16:19], s67 offen offset:1024 sc1
    v_fma_f32 v203, v14, -v174, v203
    v_fma_f32 v203, v15, -v175, v203
    ds_write2st64_b32 v235, v210, v211 offset0:6 offset1:7
    v_add_f32 v201, v255, v201
    v_mul_f32_e64 v199, v40, -v120
    ds_write2st64_b32 v235, v212, v213 offset0:8 offset1:9
    v_permlane32_swap_b32 v203, v255
    v_fma_f32 v199, v41, -v121, v199
    v_fma_f32 v199, v42, -v122, v199
    ds_write2st64_b32 v235, v214, v215 offset0:10 offset1:11
    v_fma_f32 v199, v43, -v123, v199
    v_fma_f32 v199, v44, -v124, v199
    ds_write2st64_b32 v234, v216, v217 offset0:12 offset1:13
    v_fma_f32 v199, v45, -v125, v199
    v_fma_f32 v199, v46, -v126, v199
    ds_write2st64_b32 v234, v218, v219 offset0:14 offset1:15
    v_fma_f32 v199, v47, -v127, v199
    v_add_f32 v255, v203, v255
    ds_write2st64_b32 v234, v220, v221 offset0:16 offset1:17
    v_mul_f32 v197, v32, v168
    v_fmac_f32 v197, v33, v169
    ds_write2st64_b32 v235, v222, v223 offset0:18 offset1:19
    v_fmac_f32 v197, v34, v170
    v_fmac_f32 v197, v35, v171
    v_fmac_f32 v197, v36, v172
    ds_write2st64_b32 v235, v224, v225 offset0:20 offset1:21
    v_fmac_f32 v197, v37, v173
    v_fmac_f32 v197, v38, v174
    ds_write2st64_b32 v235, v226, v227 offset0:22 offset1:23
    v_fmac_f32 v197, v39, v175
    s_nop 1
    ds_write2st64_b32 v234, v228, v229 offset0:24 offset1:25
    v_permlane32_swap_b32 v199, v197
    v_add_f32 v197, v199, v197
    ds_write2st64_b32 v234, v230, v231 offset0:26 offset1:27
    v_cvt_pk_bf16_f32 v200, v200, v201
    v_cvt_pk_bf16_f32 v254, v254, v255
    v_cvt_pk_bf16_f32 v196, v196, v197
    ds_write2st64_b32 v234, v232, v233 offset0:28 offset1:29
    ds_write2st64_b32 v253, v192, v193 offset0:0 offset1:1
    ds_write2st64_b32 v253, v194, v200 offset0:2 offset1:3
    ds_write_b32 v253, v196 offset:1024
    s_mov_b64 exec, 0xffffffff
    ds_write_b32 v253, v254 offset:1280
    s_mov_b64 exec, -1
    s_add_u32 s50, s53, 1
    v_mov_b32 v234, s50
    ds_write2_b32 v251, v234, v234 offset0:0 offset1:8
    s_waitcnt lgkmcnt(15)
TAIL:
    s_and_b32 s71, s20, 3
    s_lshl_b32 s71, s71, 2
    s_bitcmp0_b32 s20, 2
    s_addc_u32 s71, s71, 0
    v_readlane_b32 s71, v191, s71
    buffer_load_dwordx4 v[120:123], v246, s[16:19], s68 offen offset:0 sc1
    buffer_load_dwordx4 v[124:127], v246, s[16:19], s68 offen offset:1024 sc1
    s_cmp_ge_u32 s71, s50
    s_setprio 1
    s_cbranch_scc1 T_second
    s_setprio 0
T_second:
    buffer_load_dwordx4 v[152:155], v246, s[16:19], s69 offen offset:0 sc1
    buffer_load_dwordx4 v[156:159], v246, s[16:19], s69 offen offset:1024 sc1
    buffer_load_dwordx4 v[168:171], v246, s[16:19], s70 offen offset:0 sc1
    buffer_load_dwordx4 v[172:175], v246, s[16:19], s70 offen offset:1024 sc1
GEMM:
    v_cmp_gt_u32 vcc, s53, v191
    v_xor_b32 v180, v179, v178
    v_xor_b32 v188, 4, v180
    v_lshl_add_u32 v66, v180, 4, v183
    v_lshl_add_u32 v67, v188, 4, v183
    v_lshl_add_u32 v70, v180, 4, v185
    v_lshl_add_u32 v71, v188, 4, v185
    s_mov_b32 s4, s72
    s_and_b32 s5, s73, 0xffff
    s_mov_b32 s6, 10240000
    s_mov_b32 s7, 0x20000
    s_cbranch_vccnz T_pw
T_pwr:
    ds_read_b128 v[76:79], v66 offset:0
    ds_read_b128 v[80:83], v70 offset:0
    ds_read_b128 v[84:87], v67 offset:0
    ds_read_b128 v[88:91], v71 offset:0
    ds_read_b128 v[92:95], v66 offset:1024
    s_waitcnt vmcnt(19) lgkmcnt(4)
    v_mfma_f32_16x16x32_bf16 v[0:3], v[96:99], v[76:79], 0
    v_and_b32 v181, 8, v177
    v_add_u32 v189, v188, v181
    ds_read_b128 v[76:79], v70 offset:1024
    s_waitcnt lgkmcnt(4)
    v_mfma_f32_16x16x32_bf16 v[4:7], v[96:99], v[80:83], 0
    v_add_u32 v181, v180, v181
    v_lshl_add_u32 v64, v180, 4, v182
    ds_read_b128 v[80:83], v67 offset:1024
    s_waitcnt vmcnt(18) lgkmcnt(4)
    v_mfma_f32_16x16x32_bf16 v[0:3], v[100:103], v[84:87], v[0:3]
    v_lshl_add_u32 v65, v188, 4, v182
    v_lshl_add_u32 v68, v180, 4, v184
    ds_read_b128 v[84:87], v71 offset:1024
    s_waitcnt lgkmcnt(4)
    v_mfma_f32_16x16x32_bf16 v[4:7], v[100:103], v[88:91], v[4:7]
    v_lshl_add_u32 v69, v188, 4, v184
    v_lshl_add_u32 v72, v181, 4, v186
    ds_read_b128 v[88:91], v66 offset:128
    s_waitcnt vmcnt(17) lgkmcnt(4)
    v_mfma_f32_16x16x32_bf16 v[0:3], v[104:107], v[92:95], v[0:3]
    v_lshl_add_u32 v73, v189, 4, v186
    v_lshl_add_u32 v74, v181, 4, v187
    ds_read_b128 v[92:95], v66 offset:256
    s_waitcnt lgkmcnt(4)
    v_mfma_f32_16x16x32_bf16 v[4:7], v[104:107], v[76:79], v[4:7]
    v_lshl_add_u32 v75, v189, 4, v187
    s_mov_b32 s67, 0xbfb8aa3b
    ds_read_b128 v[76:79], v66 offset:384
    s_waitcnt vmcnt(16) lgkmcnt(4)
    v_mfma_f32_16x16x32_bf16 v[0:3], v[108:111], v[80:83], v[0:3]
    v_lshrrev_b32 v205, 1, v178
    v_lshl_add_u32 v205, s20, 1, v205
    ds_read_b128 v[80:83], v70 offset:128
    s_waitcnt lgkmcnt(4)
    v_mfma_f32_16x16x32_bf16 v[4:7], v[108:111], v[84:87], v[4:7]
    v_xor_b32 v205, v205, v179
    v_and_b32 v204, 1, v178
    ds_read_b128 v[84:87], v70 offset:256
    s_waitcnt vmcnt(15) lgkmcnt(4)
    v_mfma_f32_16x16x32_bf16 v[12:15], v[128:131], v[88:91], 0
    v_lshlrev_b32 v204, 3, v204
    v_lshl_add_u32 v205, v205, 4, v204
    ds_read_b128 v[88:91], v70 offset:384
    s_waitcnt lgkmcnt(4)
    v_mfma_f32_16x16x32_bf16 v[24:27], v[128:131], v[92:95], 0
    v_and_b32 v220, 8, v177
    v_lshl_add_u32 v204, v220, 4, v205
    ds_read_b128 v[92:95], v67 offset:128
    s_waitcnt lgkmcnt(4)
    v_mfma_f32_16x16x32_bf16 v[36:39], v[128:131], v[76:79], 0
    v_lshl_add_u32 v204, v177, 10, v204
    v_add_u32 v204, 65536, v204
    ds_read_b128 v[76:79], v67 offset:256
    s_waitcnt lgkmcnt(4)
    v_mfma_f32_16x16x32_bf16 v[16:19], v[128:131], v[80:83], 0
    v_add_u32 v205, v205, v182
    v_mul_u32_u24 v220, 1008, v220
    ds_read_b128 v[80:83], v67 offset:384
    s_waitcnt lgkmcnt(4)
    v_mfma_f32_16x16x32_bf16 v[28:31], v[128:131], v[84:87], 0
    v_sub_u32 v220, v204, v220
    s_lshl_b32 s70, s20, 4
    ds_read_b128 v[84:87], v71 offset:128
    s_waitcnt lgkmcnt(4)
    v_mfma_f32_16x16x32_bf16 v[40:43], v[128:131], v[88:91], 0
    v_xor_b32 v206, s70, v246
    s_lshl_b32 s70, s20, 10
    ds_read_b128 v[88:91], v71 offset:256
    s_waitcnt vmcnt(14) lgkmcnt(4)
    v_mfma_f32_16x16x32_bf16 v[12:15], v[132:135], v[92:95], v[12:15]
    s_add_u32 s70, s70, 65536
    v_add_u32 v207, s21, v206
    ds_read_b128 v[92:95], v71 offset:384
    s_waitcnt lgkmcnt(4)
    v_mfma_f32_16x16x32_bf16 v[24:27], v[132:135], v[76:79], v[24:27]
    v_add_u32 v206, s70, v206
    s_mul_i32 s66, s2, 40960
    ds_read_b128 v[76:79], v66 offset:512
    s_waitcnt lgkmcnt(4)
    v_mfma_f32_16x16x32_bf16 v[36:39], v[132:135], v[80:83], v[36:39]
    s_bfe_u32 s22, s22, 393237
    s_lshl_b32 s22, s22, 10
    ds_read_b128 v[80:83], v66 offset:640
    s_waitcnt lgkmcnt(4)
    v_mfma_f32_16x16x32_bf16 v[16:19], v[132:135], v[84:87], v[16:19]
    s_add_u32 s22, s22, s66
    s_bfe_u32 s23, s23, 393237
    ds_read_b128 v[84:87], v66 offset:768
    s_waitcnt lgkmcnt(4)
    v_mfma_f32_16x16x32_bf16 v[28:31], v[132:135], v[88:91], v[28:31]
    s_lshl_b32 s23, s23, 10
    s_add_u32 s23, s23, s66
    ds_read_b128 v[88:91], v70 offset:512
    s_waitcnt lgkmcnt(4)
    v_mfma_f32_16x16x32_bf16 v[40:43], v[132:135], v[92:95], v[40:43]
    s_bfe_u32 s24, s24, 393237
    s_lshl_b32 s24, s24, 10
    ds_read_b128 v[92:95], v70 offset:640
    s_waitcnt vmcnt(13) lgkmcnt(4)
    v_mfma_f32_16x16x32_bf16 v[12:15], v[136:139], v[76:79], v[12:15]
    s_add_u32 s24, s24, s66
    s_bfe_u32 s25, s25, 393237
    ds_read_b128 v[76:79], v70 offset:768
    s_waitcnt lgkmcnt(4)
    v_mfma_f32_16x16x32_bf16 v[24:27], v[136:139], v[80:83], v[24:27]
    s_lshl_b32 s25, s25, 10
    s_add_u32 s25, s25, s66
    ds_read_b128 v[80:83], v67 offset:512
    s_waitcnt lgkmcnt(4)
    v_mfma_f32_16x16x32_bf16 v[36:39], v[136:139], v[84:87], v[36:39]
    s_bfe_u32 s26, s26, 393237
    s_lshl_b32 s26, s26, 10
    ds_read_b128 v[84:87], v67 offset:640
    s_waitcnt lgkmcnt(4)
    v_mfma_f32_16x16x32_bf16 v[16:19], v[136:139], v[88:91], v[16:19]
    s_add_u32 s26, s26, s66
    ds_read_b128 v[88:91], v67 offset:768
    s_waitcnt lgkmcnt(4)
    v_mfma_f32_16x16x32_bf16 v[28:31], v[136:139], v[92:95], v[28:31]
    ds_read_b128 v[92:95], v71 offset:512
    s_waitcnt lgkmcnt(4)
    v_mfma_f32_16x16x32_bf16 v[40:43], v[136:139], v[76:79], v[40:43]
    ds_read_b128 v[76:79], v71 offset:640
    s_waitcnt vmcnt(12) lgkmcnt(4)
    v_mfma_f32_16x16x32_bf16 v[12:15], v[140:143], v[80:83], v[12:15]
    ds_read_b128 v[80:83], v71 offset:768
    s_waitcnt lgkmcnt(4)
    v_mfma_f32_16x16x32_bf16 v[24:27], v[140:143], v[84:87], v[24:27]
    ds_read_b128 v[84:87], v66 offset:1152
    s_waitcnt lgkmcnt(4)
    v_mfma_f32_16x16x32_bf16 v[36:39], v[140:143], v[88:91], v[36:39]
    ds_read_b128 v[88:91], v66 offset:1280
    s_waitcnt lgkmcnt(4)
    v_mfma_f32_16x16x32_bf16 v[16:19], v[140:143], v[92:95], v[16:19]
    ds_read_b128 v[92:95], v66 offset:896
    s_waitcnt lgkmcnt(4)
    v_mfma_f32_16x16x32_bf16 v[28:31], v[140:143], v[76:79], v[28:31]
    ds_read_b128 v[76:79], v70 offset:1152
    s_waitcnt lgkmcnt(4)
    v_mfma_f32_16x16x32_bf16 v[40:43], v[140:143], v[80:83], v[40:43]
    ds_read_b128 v[80:83], v70 offset:1280
    s_waitcnt vmcnt(11) lgkmcnt(4)
    v_mfma_f32_16x16x32_bf16 v[12:15], v[112:115], v[84:87], v[12:15]
    ds_read_b128 v[84:87], v70 offset:896
    s_waitcnt lgkmcnt(4)
    v_mfma_f32_16x16x32_bf16 v[24:27], v[112:115], v[88:91], v[24:27]
    ds_read_b128 v[88:91], v67 offset:1152
    s_waitcnt lgkmcnt(4)
    v_mfma_f32_16x16x32_bf16 v[36:39], v[112:115], v[92:95], v[36:39]
    ds_read_b128 v[92:95], v67 offset:1280
    s_waitcnt lgkmcnt(4)
    v_mfma_f32_16x16x32_bf16 v[16:19], v[112:115], v[76:79], v[16:19]
    ds_read_b128 v[76:79], v67 offset:896
    s_waitcnt lgkmcnt(4)
    v_mfma_f32_16x16x32_bf16 v[28:31], v[112:115], v[80:83], v[28:31]
    ds_read_b32 v191, v190
    ds_read_b128 v[80:83], v71 offset:1152
    s_waitcnt lgkmcnt(5)
    v_mfma_f32_16x16x32_bf16 v[40:43], v[112:115], v[84:87], v[40:43]
    ds_read_b128 v[84:87], v71 offset:1280
    s_waitcnt vmcnt(10) lgkmcnt(5)
    v_mfma_f32_16x16x32_bf16 v[12:15], v[116:119], v[88:91], v[12:15]
    ds_read_b128 v[88:91], v71 offset:896
    s_waitcnt lgkmcnt(5)
    v_mfma_f32_16x16x32_bf16 v[24:27], v[116:119], v[92:95], v[24:27]
    s_waitcnt lgkmcnt(3)
    v_cmp_gt_u32 vcc, s50, v191
    s_cbranch_vccnz T_aw
T_awr:
    ds_read_b128 v[92:95], v64 offset:0
    v_mfma_f32_16x16x32_bf16 v[36:39], v[116:119], v[76:79], v[36:39]
    ds_read_b128 v[76:79], v68 offset:0
    s_waitcnt lgkmcnt(4)
    v_mfma_f32_16x16x32_bf16 v[16:19], v[116:119], v[80:83], v[16:19]
    ds_read_b128 v[80:83], v65 offset:0
    s_waitcnt lgkmcnt(4)
    v_mfma_f32_16x16x32_bf16 v[28:31], v[116:119], v[84:87], v[28:31]
    ds_read_b128 v[84:87], v69 offset:0
    s_waitcnt lgkmcnt(4)
    v_mfma_f32_16x16x32_bf16 v[40:43], v[116:119], v[88:91], v[40:43]
    ds_read_b128 v[88:91], v64 offset:1024
    s_waitcnt vmcnt(9) lgkmcnt(4)
    v_mfma_f32_16x16x32_bf16 v[0:3], v[144:147], v[92:95], v[0:3]
    ds_read_b128 v[92:95], v68 offset:1024
    s_waitcnt lgkmcnt(4)
    v_mfma_f32_16x16x32_bf16 v[4:7], v[144:147], v[76:79], v[4:7]
    ds_read_b128 v[76:79], v65 offset:1024
    s_waitcnt vmcnt(8) lgkmcnt(4)
    v_mfma_f32_16x16x32_bf16 v[0:3], v[148:151], v[80:83], v[0:3]
    ds_read_b128 v[80:83], v69 offset:1024
    s_waitcnt lgkmcnt(4)
    v_mfma_f32_16x16x32_bf16 v[4:7], v[148:151], v[84:87], v[4:7]
    ds_read_b128 v[84:87], v72 offset:0
    s_waitcnt vmcnt(7) lgkmcnt(4)
    v_mfma_f32_16x16x32_bf16 v[0:3], v[160:163], v[88:91], v[0:3]
    ds_read_b128 v[88:91], v73 offset:0
    s_waitcnt lgkmcnt(4)
    v_mfma_f32_16x16x32_bf16 v[4:7], v[160:163], v[92:95], v[4:7]
    ds_read_b128 v[92:95], v74 offset:0
    s_waitcnt vmcnt(6) lgkmcnt(4)
    v_mfma_f32_16x16x32_bf16 v[0:3], v[164:167], v[76:79], v[0:3]
    ds_read_b128 v[76:79], v75 offset:0
    s_waitcnt lgkmcnt(4)
    v_mfma_f32_16x16x32_bf16 v[4:7], v[164:167], v[80:83], v[4:7]
    ds_read_b128 v[80:83], v72 offset:1024
    s_waitcnt lgkmcnt(4)
    v_mfma_f32_16x16x32_bf16 v[8:11], v[144:147], v[84:87], 0
    ds_read_b128 v[84:87], v73 offset:1024
    s_waitcnt lgkmcnt(4)
    v_mfma_f32_16x16x32_bf16 v[8:11], v[148:151], v[88:91], v[8:11]
    v_mul_f32 v192, s67, v0
    v_mul_f32 v193, s67, v1
    ds_read_b128 v[88:91], v74 offset:1024
    s_waitcnt lgkmcnt(4)
    v_mfma_f32_16x16x32_bf16 v[8:11], v[96:99], v[92:95], v[8:11]
    v_mul_f32 v194, s67, v2
    v_mul_f32 v195, s67, v3
    ds_read_b128 v[92:95], v75 offset:1024
    s_waitcnt lgkmcnt(4)
    v_mfma_f32_16x16x32_bf16 v[8:11], v[100:103], v[76:79], v[8:11]
    v_exp_f32 v192, v192
    v_exp_f32 v193, v193
    ds_read_b128 v[76:79], v64 offset:128
    s_waitcnt lgkmcnt(4)
    v_mfma_f32_16x16x32_bf16 v[8:11], v[160:163], v[80:83], v[8:11]
    v_exp_f32 v194, v194
    v_exp_f32 v195, v195
    ds_read_b128 v[80:83], v65 offset:128
    s_waitcnt lgkmcnt(4)
    v_mfma_f32_16x16x32_bf16 v[8:11], v[164:167], v[84:87], v[8:11]
    v_add_f32 v192, 1.0, v192
    v_add_f32 v193, 1.0, v193
    ds_read_b128 v[84:87], v64 offset:512
    s_waitcnt lgkmcnt(4)
    v_mfma_f32_16x16x32_bf16 v[8:11], v[104:107], v[88:91], v[8:11]
    v_add_f32 v194, 1.0, v194
    v_add_f32 v195, 1.0, v195
    ds_read_b128 v[88:91], v65 offset:512
    s_waitcnt lgkmcnt(4)
    v_mfma_f32_16x16x32_bf16 v[8:11], v[108:111], v[92:95], v[8:11]
    v_rcp_f32 v192, v192
    v_rcp_f32 v193, v193
    ds_read_b128 v[92:95], v64 offset:1152
    s_waitcnt vmcnt(5) lgkmcnt(4)
    v_mfma_f32_16x16x32_bf16 v[12:15], v[120:123], v[76:79], v[12:15]
    v_rcp_f32 v194, v194
    v_rcp_f32 v195, v195
    ds_read_b128 v[76:79], v65 offset:1152
    s_waitcnt vmcnt(4) lgkmcnt(4)
    v_mfma_f32_16x16x32_bf16 v[12:15], v[124:127], v[80:83], v[12:15]
    v_cvt_pk_bf16_f32 v0, v0, v1
    v_cvt_pk_bf16_f32 v1, v2, v3
    ds_read_b128 v[80:83], v64 offset:256
    s_waitcnt vmcnt(3) lgkmcnt(4)
    v_mfma_f32_16x16x32_bf16 v[12:15], v[152:155], v[84:87], v[12:15]
    ds_write_b64 v204, v[0:1] offset:0
    v_mul_f32 v196, s67, v4
    ds_read_b128 v[84:87], v65 offset:256
    s_waitcnt vmcnt(2) lgkmcnt(5)
    v_mfma_f32_16x16x32_bf16 v[12:15], v[156:159], v[88:91], v[12:15]
    v_mul_f32 v197, s67, v5
    v_mul_f32 v198, s67, v6
    ds_read_b128 v[88:91], v64 offset:640
    s_waitcnt vmcnt(1) lgkmcnt(5)
    v_mfma_f32_16x16x32_bf16 v[12:15], v[168:171], v[92:95], v[12:15]
    v_mul_f32 v199, s67, v7
    v_exp_f32 v196, v196
    ds_read_b128 v[92:95], v65 offset:640
    s_waitcnt vmcnt(0) lgkmcnt(5)
    v_mfma_f32_16x16x32_bf16 v[12:15], v[172:175], v[76:79], v[12:15]
    v_exp_f32 v197, v197
    v_exp_f32 v198, v198
    ds_read_b128 v[76:79], v64 offset:1280
    s_waitcnt lgkmcnt(5)
    v_mfma_f32_16x16x32_bf16 v[24:27], v[120:123], v[80:83], v[24:27]
    v_exp_f32 v199, v199
    v_add_f32 v196, 1.0, v196
    ds_read_b128 v[80:83], v65 offset:1280
    s_waitcnt lgkmcnt(4)
    v_mfma_f32_16x16x32_bf16 v[24:27], v[124:127], v[84:87], v[24:27]
    v_mul_f32 v12, v12, v192
    v_mul_f32 v13, v13, v193
    ds_read_b128 v[84:87], v64 offset:384
    s_waitcnt lgkmcnt(4)
    v_mfma_f32_16x16x32_bf16 v[24:27], v[152:155], v[88:91], v[24:27]
    v_mul_f32 v14, v14, v194
    v_mul_f32 v15, v15, v195
    ds_read_b128 v[88:91], v65 offset:384
    s_waitcnt lgkmcnt(4)
    v_mfma_f32_16x16x32_bf16 v[24:27], v[156:159], v[92:95], v[24:27]
    v_cvt_pk_bf16_f32 v12, v12, v13
    v_cvt_pk_bf16_f32 v13, v14, v15
    ds_read_b128 v[92:95], v64 offset:768
    s_waitcnt lgkmcnt(4)
    v_mfma_f32_16x16x32_bf16 v[24:27], v[168:171], v[76:79], v[24:27]
    ds_write_b64 v204, v[12:13] offset:256
    v_add_f32 v197, 1.0, v197
    ds_read_b128 v[76:79], v65 offset:768
    s_waitcnt lgkmcnt(5)
    v_mfma_f32_16x16x32_bf16 v[24:27], v[172:175], v[80:83], v[24:27]
    v_add_f32 v198, 1.0, v198
    v_add_f32 v199, 1.0, v199
    ds_read_b128 v[80:83], v64 offset:896
    s_waitcnt lgkmcnt(5)
    v_mfma_f32_16x16x32_bf16 v[36:39], v[120:123], v[84:87], v[36:39]
    v_rcp_f32 v196, v196
    v_rcp_f32 v197, v197
    ds_read_b128 v[84:87], v65 offset:896
    s_waitcnt lgkmcnt(5)
    v_mfma_f32_16x16x32_bf16 v[36:39], v[124:127], v[88:91], v[36:39]
    v_rcp_f32 v198, v198
    v_rcp_f32 v199, v199
    ds_read_b128 v[88:91], v68 offset:128
    s_waitcnt lgkmcnt(5)
    v_mfma_f32_16x16x32_bf16 v[36:39], v[152:155], v[92:95], v[36:39]
    v_mul_f32 v24, v24, v192
    v_mul_f32 v25, v25, v193
    ds_read_b128 v[92:95], v69 offset:128
    s_waitcnt lgkmcnt(4)
    v_mfma_f32_16x16x32_bf16 v[36:39], v[156:159], v[76:79], v[36:39]
    v_mul_f32 v26, v26, v194
    v_mul_f32 v27, v27, v195
    ds_read_b128 v[76:79], v68 offset:512
    s_waitcnt lgkmcnt(4)
    v_mfma_f32_16x16x32_bf16 v[36:39], v[168:171], v[80:83], v[36:39]
    v_cvt_pk_bf16_f32 v24, v24, v25
    v_cvt_pk_bf16_f32 v25, v26, v27
    ds_read_b128 v[80:83], v69 offset:512
    s_waitcnt lgkmcnt(4)
    v_mfma_f32_16x16x32_bf16 v[36:39], v[172:175], v[84:87], v[36:39]
    ds_write_b64 v204, v[24:25] offset:512
    v_mul_f32 v200, s67, v8
    ds_read_b128 v[84:87], v68 offset:1152
    s_waitcnt lgkmcnt(5)
    v_mfma_f32_16x16x32_bf16 v[16:19], v[120:123], v[88:91], v[16:19]
    v_mul_f32 v201, s67, v9
    v_mul_f32 v202, s67, v10
    ds_read_b128 v[88:91], v69 offset:1152
    s_waitcnt lgkmcnt(5)
    v_mfma_f32_16x16x32_bf16 v[16:19], v[124:127], v[92:95], v[16:19]
    v_mul_f32 v203, s67, v11
    v_exp_f32 v200, v200
    ds_read_b128 v[92:95], v68 offset:256
    s_waitcnt lgkmcnt(5)
    v_mfma_f32_16x16x32_bf16 v[16:19], v[152:155], v[76:79], v[16:19]
    v_mul_f32 v36, v36, v192
    v_mul_f32 v37, v37, v193
    ds_read_b128 v[76:79], v69 offset:256
    s_waitcnt lgkmcnt(5)
    v_mfma_f32_16x16x32_bf16 v[16:19], v[156:159], v[80:83], v[16:19]
    v_mul_f32 v38, v38, v194
    v_mul_f32 v39, v39, v195
    ds_read_b128 v[80:83], v68 offset:640
    s_waitcnt lgkmcnt(4)
    v_mfma_f32_16x16x32_bf16 v[16:19], v[168:171], v[84:87], v[16:19]
    v_cvt_pk_bf16_f32 v36, v36, v37
    v_cvt_pk_bf16_f32 v37, v38, v39
    ds_read_b128 v[84:87], v69 offset:640
    s_waitcnt lgkmcnt(4)
    v_mfma_f32_16x16x32_bf16 v[16:19], v[172:175], v[88:91], v[16:19]
    ds_write_b64 v204, v[36:37] offset:768
    v_exp_f32 v201, v201
    ds_read_b128 v[88:91], v68 offset:1280
    s_waitcnt lgkmcnt(5)
    v_mfma_f32_16x16x32_bf16 v[28:31], v[120:123], v[92:95], v[28:31]
    v_exp_f32 v202, v202
    v_exp_f32 v203, v203
    ds_read_b128 v[92:95], v69 offset:1280
    s_waitcnt lgkmcnt(5)
    v_mfma_f32_16x16x32_bf16 v[28:31], v[124:127], v[76:79], v[28:31]
    v_add_f32 v200, 1.0, v200
    v_add_f32 v201, 1.0, v201
    ds_read_b128 v[76:79], v68 offset:384
    s_waitcnt lgkmcnt(5)
    v_mfma_f32_16x16x32_bf16 v[28:31], v[152:155], v[80:83], v[28:31]
    v_add_f32 v202, 1.0, v202
    v_add_f32 v203, 1.0, v203
    ds_read_b128 v[80:83], v69 offset:384
    s_waitcnt lgkmcnt(5)
    v_mfma_f32_16x16x32_bf16 v[28:31], v[156:159], v[84:87], v[28:31]
    v_rcp_f32 v200, v200
    v_rcp_f32 v201, v201
    ds_read_b128 v[84:87], v68 offset:768
    s_waitcnt lgkmcnt(4)
    v_mfma_f32_16x16x32_bf16 v[28:31], v[168:171], v[88:91], v[28:31]
    v_rcp_f32 v202, v202
    v_rcp_f32 v203, v203
    ds_read_b128 v[88:91], v69 offset:768
    s_waitcnt lgkmcnt(4)
    v_mfma_f32_16x16x32_bf16 v[28:31], v[172:175], v[92:95], v[28:31]
    v_mov_b32_dpp v200, v200 row_ror:8 row_mask:0xf bank_mask:0xc
    ds_read_b128 v[92:95], v68 offset:896
    s_waitcnt lgkmcnt(4)
    v_mfma_f32_16x16x32_bf16 v[40:43], v[120:123], v[76:79], v[40:43]
    v_mov_b32_dpp v201, v201 row_ror:8 row_mask:0xf bank_mask:0xc
    v_mov_b32_dpp v202, v202 row_ror:8 row_mask:0xf bank_mask:0xc
    ds_read_b128 v[76:79], v69 offset:896
    s_waitcnt lgkmcnt(4)
    v_mfma_f32_16x16x32_bf16 v[40:43], v[124:127], v[80:83], v[40:43]
    v_mov_b32_dpp v203, v203 row_ror:8 row_mask:0xf bank_mask:0xc
    ds_read_b128 v[80:83], v72 offset:128
    s_waitcnt lgkmcnt(4)
    v_mfma_f32_16x16x32_bf16 v[40:43], v[152:155], v[84:87], v[40:43]
    s_barrier
    ds_read_b128 v[212:215], v206 offset:0
    ds_read_b128 v[84:87], v73 offset:128
    s_waitcnt lgkmcnt(5)
    v_mfma_f32_16x16x32_bf16 v[40:43], v[156:159], v[88:91], v[40:43]
    ds_read_b128 v[216:219], v206 offset:8320
    v_cvt_pk_bf16_f32 v4, v4, v5
    ds_read_b128 v[88:91], v74 offset:128
    s_waitcnt lgkmcnt(6)
    v_mfma_f32_16x16x32_bf16 v[40:43], v[168:171], v[92:95], v[40:43]
    v_cvt_pk_bf16_f32 v5, v6, v7
    ds_write_b64 v205, v[4:5] offset:0
    ds_read_b128 v[92:95], v75 offset:128
    s_waitcnt lgkmcnt(7)
    v_mfma_f32_16x16x32_bf16 v[40:43], v[172:175], v[76:79], v[40:43]
    v_mul_f32 v16, v16, v196
    v_mul_f32 v17, v17, v197
    ds_read_b128 v[76:79], v72 offset:512
    s_waitcnt lgkmcnt(7)
    v_mfma_f32_16x16x32_bf16 v[20:23], v[120:123], v[80:83], 0
    v_mul_f32 v18, v18, v198
    v_mul_f32 v19, v19, v199
    ds_read_b128 v[80:83], v73 offset:512
    s_waitcnt lgkmcnt(6)
    v_mfma_f32_16x16x32_bf16 v[20:23], v[124:127], v[84:87], v[20:23]
    v_cvt_pk_bf16_f32 v16, v16, v17
    v_cvt_pk_bf16_f32 v17, v18, v19
    ds_read_b128 v[84:87], v74 offset:512
    s_waitcnt lgkmcnt(5)
    v_mfma_f32_16x16x32_bf16 v[20:23], v[128:131], v[88:91], v[20:23]
    ds_write_b64 v205, v[16:17] offset:256
    ds_read_b128 v[88:91], v75 offset:512
    s_waitcnt lgkmcnt(5)
    v_mfma_f32_16x16x32_bf16 v[20:23], v[132:135], v[92:95], v[20:23]
    buffer_store_dwordx4 v[212:215], v246, s[4:7], s22 offen sc1
    ds_read_b128 v[92:95], v72 offset:1152
    s_waitcnt lgkmcnt(5)
    v_mfma_f32_16x16x32_bf16 v[20:23], v[152:155], v[76:79], v[20:23]
    buffer_store_dwordx4 v[216:219], v246, s[4:7], s23 offen sc1
    v_mul_f32 v28, v28, v196
    ds_read_b128 v[76:79], v73 offset:1152
    s_waitcnt lgkmcnt(5)
    v_mfma_f32_16x16x32_bf16 v[20:23], v[156:159], v[80:83], v[20:23]
    v_mul_f32 v29, v29, v197
    v_mul_f32 v30, v30, v198
    ds_read_b128 v[80:83], v74 offset:1152
    s_waitcnt lgkmcnt(5)
    v_mfma_f32_16x16x32_bf16 v[20:23], v[136:139], v[84:87], v[20:23]
    v_mul_f32 v31, v31, v199
    v_cvt_pk_bf16_f32 v28, v28, v29
    ds_read_b128 v[84:87], v75 offset:1152
    s_waitcnt lgkmcnt(4)
    v_mfma_f32_16x16x32_bf16 v[20:23], v[140:143], v[88:91], v[20:23]
    v_cvt_pk_bf16_f32 v29, v30, v31
    ds_write_b64 v205, v[28:29] offset:512
    ds_read_b128 v[88:91], v72 offset:384
    s_waitcnt lgkmcnt(5)
    v_mfma_f32_16x16x32_bf16 v[20:23], v[168:171], v[92:95], v[20:23]
    v_mul_f32 v40, v40, v196
    v_mul_f32 v41, v41, v197
    ds_read_b128 v[92:95], v73 offset:384
    s_waitcnt lgkmcnt(5)
    v_mfma_f32_16x16x32_bf16 v[20:23], v[172:175], v[76:79], v[20:23]
    v_mul_f32 v42, v42, v198
    v_mul_f32 v43, v43, v199
    ds_read_b128 v[76:79], v74 offset:384
    s_waitcnt lgkmcnt(5)
    v_mfma_f32_16x16x32_bf16 v[20:23], v[112:115], v[80:83], v[20:23]
    v_cvt_pk_bf16_f32 v40, v40, v41
    v_cvt_pk_bf16_f32 v41, v42, v43
    ds_read_b128 v[80:83], v75 offset:384
    s_waitcnt lgkmcnt(5)
    v_mfma_f32_16x16x32_bf16 v[20:23], v[116:119], v[84:87], v[20:23]
    ds_write_b64 v205, v[40:41] offset:768
    ds_read_b128 v[84:87], v72 offset:768
    s_waitcnt lgkmcnt(5)
    v_mfma_f32_16x16x32_bf16 v[44:47], v[120:123], v[88:91], 0
    ds_read_b128 v[88:91], v73 offset:768
    s_waitcnt lgkmcnt(5)
    v_mfma_f32_16x16x32_bf16 v[44:47], v[124:127], v[92:95], v[44:47]
    s_waitcnt lgkmcnt(2)
    s_barrier
    ds_read_b128 v[92:95], v74 offset:768
    v_mfma_f32_16x16x32_bf16 v[44:47], v[128:131], v[76:79], v[44:47]
    ds_read_b128 v[212:215], v207 offset:0
    ds_read_b128 v[216:219], v207 offset:1664
    ds_read_b128 v[76:79], v75 offset:768
    v_mfma_f32_16x16x32_bf16 v[44:47], v[132:135], v[80:83], v[44:47]
    ds_read_b128 v[80:83], v72 offset:896
    s_waitcnt lgkmcnt(6)
    v_mfma_f32_16x16x32_bf16 v[44:47], v[152:155], v[84:87], v[44:47]
    ds_read_b128 v[84:87], v73 offset:896
    s_waitcnt lgkmcnt(6)
    v_mfma_f32_16x16x32_bf16 v[44:47], v[156:159], v[88:91], v[44:47]
    ds_read_b128 v[88:91], v74 offset:896
    s_waitcnt lgkmcnt(6)
    v_mfma_f32_16x16x32_bf16 v[44:47], v[136:139], v[92:95], v[44:47]
    s_waitcnt lgkmcnt(5)
    buffer_store_dwordx4 v[212:215], v246, s[4:7], s24 offen sc1
    ds_read_b128 v[92:95], v75 offset:896
    s_waitcnt lgkmcnt(4)
    v_mfma_f32_16x16x32_bf16 v[44:47], v[140:143], v[76:79], v[44:47]
    buffer_store_dwordx4 v[216:219], v246, s[4:7], s25 offen sc1
    s_waitcnt lgkmcnt(3)
    v_mfma_f32_16x16x32_bf16 v[44:47], v[168:171], v[80:83], v[44:47]
    v_cvt_pk_bf16_f32 v8, v8, v9
    v_cvt_pk_bf16_f32 v9, v10, v11
    s_waitcnt lgkmcnt(2)
    v_mfma_f32_16x16x32_bf16 v[44:47], v[172:175], v[84:87], v[44:47]
    ds_write_b64 v204, v[8:9] offset:0
    v_mul_f32 v20, v20, v200
    s_waitcnt lgkmcnt(2)
    v_mfma_f32_16x16x32_bf16 v[44:47], v[112:115], v[88:91], v[44:47]
    v_mul_f32 v21, v21, v201
    v_mul_f32 v22, v22, v202
    s_waitcnt lgkmcnt(1)
    v_mfma_f32_16x16x32_bf16 v[44:47], v[116:119], v[92:95], v[44:47]
    v_mul_f32 v23, v23, v203
    v_cvt_pk_bf16_f32 v20, v20, v21
    v_cvt_pk_bf16_f32 v21, v22, v23
    ds_write_b64 v220, v[20:21] offset:256
    s_nop 3
    v_mul_f32 v44, v44, v200
    v_mul_f32 v45, v45, v201
    v_mul_f32 v46, v46, v202
    v_mul_f32 v47, v47, v203
    v_cvt_pk_bf16_f32 v44, v44, v45
    v_cvt_pk_bf16_f32 v45, v46, v47
    ds_write_b64 v204, v[44:45] offset:768
    s_waitcnt lgkmcnt(0)
    s_barrier
    ds_read_b128 v[212:215], v206 offset:0
    s_waitcnt lgkmcnt(0)
    buffer_store_dwordx4 v[212:215], v246, s[4:7], s26 offen sc1
    s_or_b32 s89, s89, s20
    s_cbranch_scc1 K2_end
    v_mov_b32 v0, 0
    v_mov_b32 v1, s88
    s_mov_b64 exec, 1
    buffer_store_dword v1, v0, s[16:19], 0 offen
    s_endpgm
T_pw:
    s_sleep 1
    ds_read_b32 v191, v190
    s_waitcnt lgkmcnt(0)
    v_cmp_gt_u32 vcc, s53, v191
    s_cbranch_vccnz T_pw
    s_branch T_pwr
T_aw:
    s_sleep 1
    ds_read_b32 v191, v190
    s_waitcnt lgkmcnt(0)
    v_cmp_gt_u32 vcc, s50, v191
    s_cbranch_vccnz T_aw
    s_branch T_awr
K2_end:
K2_last:
    s_endpgm
SLOW:
    v_readlane_b32 s89, v4, 62
    s_waitcnt vmcnt(0) lgkmcnt(0)
    s_barrier
    s_load_dwordx2 s[22:23], s[0:1], 8
    s_load_dwordx2 s[24:25], s[0:1], 24
    s_load_dwordx2 s[26:27], s[0:1], 32
    s_load_dwordx2 s[28:29], s[0:1], 40
    s_load_dwordx2 s[30:31], s[0:1], 0
    v_mbcnt_lo_u32_b32 v240, -1, 0
    v_mbcnt_hi_u32_b32 v240, -1, v240
    v_lshrrev_b32 v229, 5, v240
    v_and_b32 v230, 31, v240
    v_lshlrev_b32 v241, 7, v229
    v_lshl_add_u32 v241, v230, 1, v241
    v_lshlrev_b32 v245, 4, v240
    v_mov_b32 v242, 0
    s_waitcnt lgkmcnt(0)
    s_mov_b32 s80, s22
    s_and_b32 s81, s23, 0xffff
    s_mov_b32 s82, 1920000
    s_mov_b32 s83, 0x20000
    s_mov_b32 s76, s24
    s_and_b32 s77, s25, 0xffff
    s_mov_b32 s78, 1280000
    s_mov_b32 s79, 0x20000
    s_mov_b32 s72, s26
    s_and_b32 s73, s27, 0xffff
    s_mov_b32 s74, 1280000
    s_mov_b32 s75, 0x20000
    s_mov_b32 s84, s28
    s_and_b32 s85, s29, 0xffff
    s_mov_b32 s86, 20480
    s_mov_b32 s87, 0x20000
    s_mov_b32 s4, s30
    s_and_b32 s5, s31, 0xffff
    s_mov_b32 s6, 10240000
    s_mov_b32 s7, 0x20000
    s_mov_b32 s66, 0
    buffer_load_ushort v0, v241, s[84:87], s66 offen offset:0
    buffer_load_ushort v1, v241, s[84:87], s66 offen offset:64
    buffer_load_ushort v2, v241, s[84:87], s66 offen offset:256
    buffer_load_ushort v3, v241, s[84:87], s66 offen offset:320
    buffer_load_ushort v4, v241, s[84:87], s66 offen offset:512
    buffer_load_ushort v5, v241, s[84:87], s66 offen offset:576
    buffer_load_ushort v6, v241, s[84:87], s66 offen offset:768
    buffer_load_ushort v7, v241, s[84:87], s66 offen offset:832
    buffer_load_ushort v8, v241, s[84:87], s66 offen offset:1024
    buffer_load_ushort v9, v241, s[84:87], s66 offen offset:1088
    s_waitcnt vmcnt(0)
    s_mov_b32 s66, 1280
    buffer_load_ushort v10, v241, s[84:87], s66 offen offset:0
    buffer_load_ushort v11, v241, s[84:87], s66 offen offset:64
    buffer_load_ushort v12, v241, s[84:87], s66 offen offset:256
    buffer_load_ushort v13, v241, s[84:87], s66 offen offset:320
    buffer_load_ushort v14, v241, s[84:87], s66 offen offset:512
    buffer_load_ushort v15, v241, s[84:87], s66 offen offset:576
    buffer_load_ushort v16, v241, s[84:87], s66 offen offset:768
    buffer_load_ushort v17, v241, s[84:87], s66 offen offset:832
    buffer_load_ushort v18, v241, s[84:87], s66 offen offset:1024
    buffer_load_ushort v19, v241, s[84:87], s66 offen offset:1088
    s_waitcnt vmcnt(0)
    s_mov_b32 s66, 2560
    buffer_load_ushort v20, v241, s[84:87], s66 offen offset:0
    buffer_load_ushort v21, v241, s[84:87], s66 offen offset:64
    buffer_load_ushort v22, v241, s[84:87], s66 offen offset:256
    buffer_load_ushort v23, v241, s[84:87], s66 offen offset:320
    buffer_load_ushort v24, v241, s[84:87], s66 offen offset:512
    buffer_load_ushort v25, v241, s[84:87], s66 offen offset:576
    buffer_load_ushort v26, v241, s[84:87], s66 offen offset:768
    buffer_load_ushort v27, v241, s[84:87], s66 offen offset:832
    buffer_load_ushort v28, v241, s[84:87], s66 offen offset:1024
    buffer_load_ushort v29, v241, s[84:87], s66 offen offset:1088
    s_waitcnt vmcnt(0)
    s_mov_b32 s66, 3840
    buffer_load_ushort v30, v241, s[84:87], s66 offen offset:0
    buffer_load_ushort v31, v241, s[84:87], s66 offen offset:64
    buffer_load_ushort v32, v241, s[84:87], s66 offen offset:256
    buffer_load_ushort v33, v241, s[84:87], s66 offen offset:320
    buffer_load_ushort v34, v241, s[84:87], s66 offen offset:512
    buffer_load_ushort v35, v241, s[84:87], s66 offen offset:576
    buffer_load_ushort v36, v241, s[84:87], s66 offen offset:768
    buffer_load_ushort v37, v241, s[84:87], s66 offen offset:832
    buffer_load_ushort v38, v241, s[84:87], s66 offen offset:1024
    buffer_load_ushort v39, v241, s[84:87], s66 offen offset:1088
    s_waitcnt vmcnt(0)
    s_mov_b32 s66, 5120
    buffer_load_ushort v40, v241, s[84:87], s66 offen offset:0
    buffer_load_ushort v41, v241, s[84:87], s66 offen offset:64
    buffer_load_ushort v42, v241, s[84:87], s66 offen offset:256
    buffer_load_ushort v43, v241, s[84:87], s66 offen offset:320
    buffer_load_ushort v44, v241, s[84:87], s66 offen offset:512
    buffer_load_ushort v45, v241, s[84:87], s66 offen offset:576
    buffer_load_ushort v46, v241, s[84:87], s66 offen offset:768
    buffer_load_ushort v47, v241, s[84:87], s66 offen offset:832
    buffer_load_ushort v48, v241, s[84:87], s66 offen offset:1024
    buffer_load_ushort v49, v241, s[84:87], s66 offen offset:1088
    s_waitcnt vmcnt(0)
    s_mov_b32 s66, 6400
    buffer_load_ushort v50, v241, s[84:87], s66 offen offset:0
    buffer_load_ushort v51, v241, s[84:87], s66 offen offset:64
    buffer_load_ushort v52, v241, s[84:87], s66 offen offset:256
    buffer_load_ushort v53, v241, s[84:87], s66 offen offset:320
    buffer_load_ushort v54, v241, s[84:87], s66 offen offset:512
    buffer_load_ushort v55, v241, s[84:87], s66 offen offset:576
    buffer_load_ushort v56, v241, s[84:87], s66 offen offset:768
    buffer_load_ushort v57, v241, s[84:87], s66 offen offset:832
    buffer_load_ushort v58, v241, s[84:87], s66 offen offset:1024
    buffer_load_ushort v59, v241, s[84:87], s66 offen offset:1088
    s_waitcnt vmcnt(0)
    s_mov_b32 s66, 7680
    buffer_load_ushort v60, v241, s[84:87], s66 offen offset:0
    buffer_load_ushort v61, v241, s[84:87], s66 offen offset:64
    buffer_load_ushort v62, v241, s[84:87], s66 offen offset:256
    buffer_load_ushort v63, v241, s[84:87], s66 offen offset:320
    buffer_load_ushort v64, v241, s[84:87], s66 offen offset:512
    buffer_load_ushort v65, v241, s[84:87], s66 offen offset:576
    buffer_load_ushort v66, v241, s[84:87], s66 offen offset:768
    buffer_load_ushort v67, v241, s[84:87], s66 offen offset:832
    buffer_load_ushort v68, v241, s[84:87], s66 offen offset:1024
    buffer_load_ushort v69, v241, s[84:87], s66 offen offset:1088
    s_waitcnt vmcnt(0)
    s_mov_b32 s66, 8960
    buffer_load_ushort v70, v241, s[84:87], s66 offen offset:0
    buffer_load_ushort v71, v241, s[84:87], s66 offen offset:64
    buffer_load_ushort v72, v241, s[84:87], s66 offen offset:256
    buffer_load_ushort v73, v241, s[84:87], s66 offen offset:320
    buffer_load_ushort v74, v241, s[84:87], s66 offen offset:512
    buffer_load_ushort v75, v241, s[84:87], s66 offen offset:576
    buffer_load_ushort v76, v241, s[84:87], s66 offen offset:768
    buffer_load_ushort v77, v241, s[84:87], s66 offen offset:832
    buffer_load_ushort v78, v241, s[84:87], s66 offen offset:1024
    buffer_load_ushort v79, v241, s[84:87], s66 offen offset:1088
    s_waitcnt vmcnt(0)
    s_mov_b32 s66, 10240
    buffer_load_ushort v80, v241, s[84:87], s66 offen offset:0
    buffer_load_ushort v81, v241, s[84:87], s66 offen offset:64
    buffer_load_ushort v82, v241, s[84:87], s66 offen offset:256
    buffer_load_ushort v83, v241, s[84:87], s66 offen offset:320
    buffer_load_ushort v84, v241, s[84:87], s66 offen offset:512
    buffer_load_ushort v85, v241, s[84:87], s66 offen offset:576
    buffer_load_ushort v86, v241, s[84:87], s66 offen offset:768
    buffer_load_ushort v87, v241, s[84:87], s66 offen offset:832
    buffer_load_ushort v88, v241, s[84:87], s66 offen offset:1024
    buffer_load_ushort v89, v241, s[84:87], s66 offen offset:1088
    s_waitcnt vmcnt(0)
    s_mov_b32 s66, 11520
    buffer_load_ushort v90, v241, s[84:87], s66 offen offset:0
    buffer_load_ushort v91, v241, s[84:87], s66 offen offset:64
    buffer_load_ushort v92, v241, s[84:87], s66 offen offset:256
    buffer_load_ushort v93, v241, s[84:87], s66 offen offset:320
    buffer_load_ushort v94, v241, s[84:87], s66 offen offset:512
    buffer_load_ushort v95, v241, s[84:87], s66 offen offset:576
    buffer_load_ushort v96, v241, s[84:87], s66 offen offset:768
    buffer_load_ushort v97, v241, s[84:87], s66 offen offset:832
    buffer_load_ushort v98, v241, s[84:87], s66 offen offset:1024
    buffer_load_ushort v99, v241, s[84:87], s66 offen offset:1088
    s_waitcnt vmcnt(0)
    s_mov_b32 s66, 12800
    buffer_load_ushort v100, v241, s[84:87], s66 offen offset:0
    buffer_load_ushort v101, v241, s[84:87], s66 offen offset:64
    buffer_load_ushort v102, v241, s[84:87], s66 offen offset:256
    buffer_load_ushort v103, v241, s[84:87], s66 offen offset:320
    buffer_load_ushort v104, v241, s[84:87], s66 offen offset:512
    buffer_load_ushort v105, v241, s[84:87], s66 offen offset:576
    buffer_load_ushort v106, v241, s[84:87], s66 offen offset:768
    buffer_load_ushort v107, v241, s[84:87], s66 offen offset:832
    buffer_load_ushort v108, v241, s[84:87], s66 offen offset:1024
    buffer_load_ushort v109, v241, s[84:87], s66 offen offset:1088
    s_waitcnt vmcnt(0)
    s_mov_b32 s66, 14080
    buffer_load_ushort v110, v241, s[84:87], s66 offen offset:0
    buffer_load_ushort v111, v241, s[84:87], s66 offen offset:64
    buffer_load_ushort v112, v241, s[84:87], s66 offen offset:256
    buffer_load_ushort v113, v241, s[84:87], s66 offen offset:320
    buffer_load_ushort v114, v241, s[84:87], s66 offen offset:512
    buffer_load_ushort v115, v241, s[84:87], s66 offen offset:576
    buffer_load_ushort v116, v241, s[84:87], s66 offen offset:768
    buffer_load_ushort v117, v241, s[84:87], s66 offen offset:832
    buffer_load_ushort v118, v241, s[84:87], s66 offen offset:1024
    buffer_load_ushort v119, v241, s[84:87], s66 offen offset:1088
    s_waitcnt vmcnt(0)
    s_mov_b32 s66, 15360
    buffer_load_ushort v120, v241, s[84:87], s66 offen offset:0
    buffer_load_ushort v121, v241, s[84:87], s66 offen offset:64
    buffer_load_ushort v122, v241, s[84:87], s66 offen offset:256
    buffer_load_ushort v123, v241, s[84:87], s66 offen offset:320
    buffer_load_ushort v124, v241, s[84:87], s66 offen offset:512
    buffer_load_ushort v125, v241, s[84:87], s66 offen offset:576
    buffer_load_ushort v126, v241, s[84:87], s66 offen offset:768
    buffer_load_ushort v127, v241, s[84:87], s66 offen offset:832
    buffer_load_ushort v128, v241, s[84:87], s66 offen offset:1024
    buffer_load_ushort v129, v241, s[84:87], s66 offen offset:1088
    s_waitcnt vmcnt(0)
    s_mov_b32 s66, 16640
    buffer_load_ushort v130, v241, s[84:87], s66 offen offset:0
    buffer_load_ushort v131, v241, s[84:87], s66 offen offset:64
    buffer_load_ushort v132, v241, s[84:87], s66 offen offset:256
    buffer_load_ushort v133, v241, s[84:87], s66 offen offset:320
    buffer_load_ushort v134, v241, s[84:87], s66 offen offset:512
    buffer_load_ushort v135, v241, s[84:87], s66 offen offset:576
    buffer_load_ushort v136, v241, s[84:87], s66 offen offset:768
    buffer_load_ushort v137, v241, s[84:87], s66 offen offset:832
    buffer_load_ushort v138, v241, s[84:87], s66 offen offset:1024
    buffer_load_ushort v139, v241, s[84:87], s66 offen offset:1088
    s_waitcnt vmcnt(0)
    s_mov_b32 s66, 17920
    buffer_load_ushort v140, v241, s[84:87], s66 offen offset:0
    buffer_load_ushort v141, v241, s[84:87], s66 offen offset:64
    buffer_load_ushort v142, v241, s[84:87], s66 offen offset:256
    buffer_load_ushort v143, v241, s[84:87], s66 offen offset:320
    buffer_load_ushort v144, v241, s[84:87], s66 offen offset:512
    buffer_load_ushort v145, v241, s[84:87], s66 offen offset:576
    buffer_load_ushort v146, v241, s[84:87], s66 offen offset:768
    buffer_load_ushort v147, v241, s[84:87], s66 offen offset:832
    buffer_load_ushort v148, v241, s[84:87], s66 offen offset:1024
    buffer_load_ushort v149, v241, s[84:87], s66 offen offset:1088
    s_waitcnt vmcnt(0)
    s_mov_b32 s66, 19200
    buffer_load_ushort v150, v241, s[84:87], s66 offen offset:0
    buffer_load_ushort v151, v241, s[84:87], s66 offen offset:64
    buffer_load_ushort v152, v241, s[84:87], s66 offen offset:256
    buffer_load_ushort v153, v241, s[84:87], s66 offen offset:320
    buffer_load_ushort v154, v241, s[84:87], s66 offen offset:512
    buffer_load_ushort v155, v241, s[84:87], s66 offen offset:576
    buffer_load_ushort v156, v241, s[84:87], s66 offen offset:768
    buffer_load_ushort v157, v241, s[84:87], s66 offen offset:832
    buffer_load_ushort v158, v241, s[84:87], s66 offen offset:1024
    buffer_load_ushort v159, v241, s[84:87], s66 offen offset:1088
    s_waitcnt vmcnt(0)
    v_lshlrev_b32 v0, 16, v0
    v_lshlrev_b32 v1, 16, v1
    v_lshlrev_b32 v2, 16, v2
    v_lshlrev_b32 v3, 16, v3
    v_lshlrev_b32 v4, 16, v4
    v_lshlrev_b32 v5, 16, v5
    v_lshlrev_b32 v6, 16, v6
    v_lshlrev_b32 v7, 16, v7
    v_lshlrev_b32 v8, 16, v8
    v_lshlrev_b32 v9, 16, v9
    v_lshlrev_b32 v10, 16, v10
    v_lshlrev_b32 v11, 16, v11
    v_lshlrev_b32 v12, 16, v12
    v_lshlrev_b32 v13, 16, v13
    v_lshlrev_b32 v14, 16, v14
    v_lshlrev_b32 v15, 16, v15
    v_lshlrev_b32 v16, 16, v16
    v_lshlrev_b32 v17, 16, v17
    v_lshlrev_b32 v18, 16, v18
    v_lshlrev_b32 v19, 16, v19
    v_lshlrev_b32 v20, 16, v20
    v_lshlrev_b32 v21, 16, v21
    v_lshlrev_b32 v22, 16, v22
    v_lshlrev_b32 v23, 16, v23
    v_lshlrev_b32 v24, 16, v24
    v_lshlrev_b32 v25, 16, v25
    v_lshlrev_b32 v26, 16, v26
    v_lshlrev_b32 v27, 16, v27
    v_lshlrev_b32 v28, 16, v28
    v_lshlrev_b32 v29, 16, v29
    v_lshlrev_b32 v30, 16, v30
    v_lshlrev_b32 v31, 16, v31
    v_lshlrev_b32 v32, 16, v32
    v_lshlrev_b32 v33, 16, v33
    v_lshlrev_b32 v34, 16, v34
    v_lshlrev_b32 v35, 16, v35
    v_lshlrev_b32 v36, 16, v36
    v_lshlrev_b32 v37, 16, v37
    v_lshlrev_b32 v38, 16, v38
    v_lshlrev_b32 v39, 16, v39
    v_lshlrev_b32 v40, 16, v40
    v_lshlrev_b32 v41, 16, v41
    v_lshlrev_b32 v42, 16, v42
    v_lshlrev_b32 v43, 16, v43
    v_lshlrev_b32 v44, 16, v44
    v_lshlrev_b32 v45, 16, v45
    v_lshlrev_b32 v46, 16, v46
    v_lshlrev_b32 v47, 16, v47
    v_lshlrev_b32 v48, 16, v48
    v_lshlrev_b32 v49, 16, v49
    v_lshlrev_b32 v50, 16, v50
    v_lshlrev_b32 v51, 16, v51
    v_lshlrev_b32 v52, 16, v52
    v_lshlrev_b32 v53, 16, v53
    v_lshlrev_b32 v54, 16, v54
    v_lshlrev_b32 v55, 16, v55
    v_lshlrev_b32 v56, 16, v56
    v_lshlrev_b32 v57, 16, v57
    v_lshlrev_b32 v58, 16, v58
    v_lshlrev_b32 v59, 16, v59
    v_lshlrev_b32 v60, 16, v60
    v_lshlrev_b32 v61, 16, v61
    v_lshlrev_b32 v62, 16, v62
    v_lshlrev_b32 v63, 16, v63
    v_lshlrev_b32 v64, 16, v64
    v_lshlrev_b32 v65, 16, v65
    v_lshlrev_b32 v66, 16, v66
    v_lshlrev_b32 v67, 16, v67
    v_lshlrev_b32 v68, 16, v68
    v_lshlrev_b32 v69, 16, v69
    v_lshlrev_b32 v70, 16, v70
    v_lshlrev_b32 v71, 16, v71
    v_lshlrev_b32 v72, 16, v72
    v_lshlrev_b32 v73, 16, v73
    v_lshlrev_b32 v74, 16, v74
    v_lshlrev_b32 v75, 16, v75
    v_lshlrev_b32 v76, 16, v76
    v_lshlrev_b32 v77, 16, v77
    v_lshlrev_b32 v78, 16, v78
    v_lshlrev_b32 v79, 16, v79
    v_lshlrev_b32 v80, 16, v80
    v_lshlrev_b32 v81, 16, v81
    v_lshlrev_b32 v82, 16, v82
    v_lshlrev_b32 v83, 16, v83
    v_lshlrev_b32 v84, 16, v84
    v_lshlrev_b32 v85, 16, v85
    v_lshlrev_b32 v86, 16, v86
    v_lshlrev_b32 v87, 16, v87
    v_lshlrev_b32 v88, 16, v88
    v_lshlrev_b32 v89, 16, v89
    v_lshlrev_b32 v90, 16, v90
    v_lshlrev_b32 v91, 16, v91
    v_lshlrev_b32 v92, 16, v92
    v_lshlrev_b32 v93, 16, v93
    v_lshlrev_b32 v94, 16, v94
    v_lshlrev_b32 v95, 16, v95
    v_lshlrev_b32 v96, 16, v96
    v_lshlrev_b32 v97, 16, v97
    v_lshlrev_b32 v98, 16, v98
    v_lshlrev_b32 v99, 16, v99
    v_lshlrev_b32 v100, 16, v100
    v_lshlrev_b32 v101, 16, v101
    v_lshlrev_b32 v102, 16, v102
    v_lshlrev_b32 v103, 16, v103
    v_lshlrev_b32 v104, 16, v104
    v_lshlrev_b32 v105, 16, v105
    v_lshlrev_b32 v106, 16, v106
    v_lshlrev_b32 v107, 16, v107
    v_lshlrev_b32 v108, 16, v108
    v_lshlrev_b32 v109, 16, v109
    v_lshlrev_b32 v110, 16, v110
    v_lshlrev_b32 v111, 16, v111
    v_lshlrev_b32 v112, 16, v112
    v_lshlrev_b32 v113, 16, v113
    v_lshlrev_b32 v114, 16, v114
    v_lshlrev_b32 v115, 16, v115
    v_lshlrev_b32 v116, 16, v116
    v_lshlrev_b32 v117, 16, v117
    v_lshlrev_b32 v118, 16, v118
    v_lshlrev_b32 v119, 16, v119
    v_lshlrev_b32 v120, 16, v120
    v_lshlrev_b32 v121, 16, v121
    v_lshlrev_b32 v122, 16, v122
    v_lshlrev_b32 v123, 16, v123
    v_lshlrev_b32 v124, 16, v124
    v_lshlrev_b32 v125, 16, v125
    v_lshlrev_b32 v126, 16, v126
    v_lshlrev_b32 v127, 16, v127
    v_lshlrev_b32 v128, 16, v128
    v_lshlrev_b32 v129, 16, v129
    v_lshlrev_b32 v130, 16, v130
    v_lshlrev_b32 v131, 16, v131
    v_lshlrev_b32 v132, 16, v132
    v_lshlrev_b32 v133, 16, v133
    v_lshlrev_b32 v134, 16, v134
    v_lshlrev_b32 v135, 16, v135
    v_lshlrev_b32 v136, 16, v136
    v_lshlrev_b32 v137, 16, v137
    v_lshlrev_b32 v138, 16, v138
    v_lshlrev_b32 v139, 16, v139
    v_lshlrev_b32 v140, 16, v140
    v_lshlrev_b32 v141, 16, v141
    v_lshlrev_b32 v142, 16, v142
    v_lshlrev_b32 v143, 16, v143
    v_lshlrev_b32 v144, 16, v144
    v_lshlrev_b32 v145, 16, v145
    v_lshlrev_b32 v146, 16, v146
    v_lshlrev_b32 v147, 16, v147
    v_lshlrev_b32 v148, 16, v148
    v_lshlrev_b32 v149, 16, v149
    v_lshlrev_b32 v150, 16, v150
    v_lshlrev_b32 v151, 16, v151
    v_lshlrev_b32 v152, 16, v152
    v_lshlrev_b32 v153, 16, v153
    v_lshlrev_b32 v154, 16, v154
    v_lshlrev_b32 v155, 16, v155
    v_lshlrev_b32 v156, 16, v156
    v_lshlrev_b32 v157, 16, v157
    v_lshlrev_b32 v158, 16, v158
    v_lshlrev_b32 v159, 16, v159
    s_mov_b32 s50, 0
SL_node:
    s_mul_i32 s34, s2, 40
    s_lshl_b32 s66, s50, 3
    s_add_u32 s66, s66, s20
    s_add_u32 s34, s34, s66
    v_mov_b32 v160, 0
    v_mov_b32 v161, 0
    v_mov_b32 v162, 0
    v_mov_b32 v163, 0
    v_mov_b32 v164, 0
    v_mov_b32 v165, 0
    v_mov_b32 v166, 0
    v_mov_b32 v167, 0
    v_mov_b32 v168, 0
    v_mov_b32 v169, 0
    v_mov_b32 v170, 0
    v_mov_b32 v171, 0
    v_mov_b32 v172, 0
    v_mov_b32 v173, 0
    v_mov_b32 v174, 0
    v_mov_b32 v175, 0
    v_mov_b32 v176, 0
    v_mov_b32 v177, 0
    v_mov_b32 v178, 0
    v_mov_b32 v179, 0
    v_mov_b32 v180, 0
    v_mov_b32 v181, 0
    s_mov_b32 s35, 0
SL_scan:
    s_lshl_b32 s66, s35, 2
    buffer_load_dwordx4 v[236:239], v245, s[72:75], s66 offen
    s_waitcnt vmcnt(0)
    v_cmp_eq_u32 s[38:39], s34, v236
    v_cmp_eq_u32 s[40:41], s34, v237
    v_cmp_eq_u32 s[42:43], s34, v238
    v_cmp_eq_u32 s[44:45], s34, v239
    s_mov_b32 s36, 0
SL_bits:
    s_cmp_eq_u64 s[38:39], 0
    s_cbranch_scc1 SL_nexti
    s_ff1_i32_b64 s66, s[38:39]
    s_bitset0_b64 s[38:39], s66
    s_lshl_b32 s66, s66, 2
    s_add_u32 s37, s66, s36
    s_add_u32 s37, s37, s35
    s_lshl_b32 s66, s37, 2
    s_lshl_b32 s67, s37, 5
    s_mul_i32 s68, s37, 6
    buffer_load_dword v243, v242, s[76:79], s66 offen
    buffer_load_dwordx4 v[184:187], v242, s[12:15], s67 offen
    buffer_load_dwordx4 v[188:191], v242, s[12:15], s67 offen offset:16
    buffer_load_ushort v226, v242, s[80:83], s68 offen offset:0
    buffer_load_ushort v227, v242, s[80:83], s68 offen offset:2
    buffer_load_ushort v228, v242, s[80:83], s68 offen offset:4
    s_waitcnt vmcnt(5)
    v_lshl_add_u32 v243, v243, 10, v241
    buffer_load_ushort v208, v243, s[4:7], 0 offen offset:0
    buffer_load_ushort v209, v243, s[4:7], 0 offen offset:64
    buffer_load_ushort v210, v243, s[4:7], 0 offen offset:256
    buffer_load_ushort v211, v243, s[4:7], 0 offen offset:320
    buffer_load_ushort v212, v243, s[4:7], 0 offen offset:512
    buffer_load_ushort v213, v243, s[4:7], 0 offen offset:576
    buffer_load_ushort v214, v243, s[4:7], 0 offen offset:768
    buffer_load_ushort v215, v243, s[4:7], 0 offen offset:832
    s_waitcnt vmcnt(8)
    v_lshlrev_b32 v192, 16, v184
    v_and_b32 v193, 0xffff0000, v184
    v_lshlrev_b32 v194, 16, v185
    v_and_b32 v195, 0xffff0000, v185
    v_lshlrev_b32 v196, 16, v186
    v_and_b32 v197, 0xffff0000, v186
    v_lshlrev_b32 v198, 16, v187
    v_and_b32 v199, 0xffff0000, v187
    v_lshlrev_b32 v200, 16, v188
    v_and_b32 v201, 0xffff0000, v188
    v_lshlrev_b32 v202, 16, v189
    v_and_b32 v203, 0xffff0000, v189
    v_lshlrev_b32 v204, 16, v190
    v_and_b32 v205, 0xffff0000, v190
    v_lshlrev_b32 v206, 16, v191
    v_and_b32 v207, 0xffff0000, v191
    v_lshlrev_b32 v226, 16, v226
    v_lshlrev_b32 v227, 16, v227
    v_lshlrev_b32 v228, 16, v228
    v_mul_f32 v216, v192, v0
    v_mul_f32 v217, v192, v1
    v_mul_f32 v218, v192, v2
    v_mul_f32 v219, v192, v3
    v_mul_f32 v220, v192, v4
    v_mul_f32 v221, v192, v5
    v_mul_f32 v222, v192, v6
    v_mul_f32 v223, v192, v7
    v_mul_f32 v224, v192, v8
    v_mul_f32 v225, v192, v9
    v_fmac_f32 v216, v193, v10
    v_fmac_f32 v217, v193, v11
    v_fmac_f32 v218, v193, v12
    v_fmac_f32 v219, v193, v13
    v_fmac_f32 v220, v193, v14
    v_fmac_f32 v221, v193, v15
    v_fmac_f32 v222, v193, v16
    v_fmac_f32 v223, v193, v17
    v_fmac_f32 v224, v193, v18
    v_fmac_f32 v225, v193, v19
    v_fmac_f32 v216, v194, v20
    v_fmac_f32 v217, v194, v21
    v_fmac_f32 v218, v194, v22
    v_fmac_f32 v219, v194, v23
    v_fmac_f32 v220, v194, v24
    v_fmac_f32 v221, v194, v25
    v_fmac_f32 v222, v194, v26
    v_fmac_f32 v223, v194, v27
    v_fmac_f32 v224, v194, v28
    v_fmac_f32 v225, v194, v29
    v_fmac_f32 v216, v195, v30
    v_fmac_f32 v217, v195, v31
    v_fmac_f32 v218, v195, v32
    v_fmac_f32 v219, v195, v33
    v_fmac_f32 v220, v195, v34
    v_fmac_f32 v221, v195, v35
    v_fmac_f32 v222, v195, v36
    v_fmac_f32 v223, v195, v37
    v_fmac_f32 v224, v195, v38
    v_fmac_f32 v225, v195, v39
    v_fmac_f32 v216, v196, v40
    v_fmac_f32 v217, v196, v41
    v_fmac_f32 v218, v196, v42
    v_fmac_f32 v219, v196, v43
    v_fmac_f32 v220, v196, v44
    v_fmac_f32 v221, v196, v45
    v_fmac_f32 v222, v196, v46
    v_fmac_f32 v223, v196, v47
    v_fmac_f32 v224, v196, v48
    v_fmac_f32 v225, v196, v49
    v_fmac_f32 v216, v197, v50
    v_fmac_f32 v217, v197, v51
    v_fmac_f32 v218, v197, v52
    v_fmac_f32 v219, v197, v53
    v_fmac_f32 v220, v197, v54
    v_fmac_f32 v221, v197, v55
    v_fmac_f32 v222, v197, v56
    v_fmac_f32 v223, v197, v57
    v_fmac_f32 v224, v197, v58
    v_fmac_f32 v225, v197, v59
    v_fmac_f32 v216, v198, v60
    v_fmac_f32 v217, v198, v61
    v_fmac_f32 v218, v198, v62
    v_fmac_f32 v219, v198, v63
    v_fmac_f32 v220, v198, v64
    v_fmac_f32 v221, v198, v65
    v_fmac_f32 v222, v198, v66
    v_fmac_f32 v223, v198, v67
    v_fmac_f32 v224, v198, v68
    v_fmac_f32 v225, v198, v69
    v_fmac_f32 v216, v199, v70
    v_fmac_f32 v217, v199, v71
    v_fmac_f32 v218, v199, v72
    v_fmac_f32 v219, v199, v73
    v_fmac_f32 v220, v199, v74
    v_fmac_f32 v221, v199, v75
    v_fmac_f32 v222, v199, v76
    v_fmac_f32 v223, v199, v77
    v_fmac_f32 v224, v199, v78
    v_fmac_f32 v225, v199, v79
    v_fmac_f32 v216, v200, v80
    v_fmac_f32 v217, v200, v81
    v_fmac_f32 v218, v200, v82
    v_fmac_f32 v219, v200, v83
    v_fmac_f32 v220, v200, v84
    v_fmac_f32 v221, v200, v85
    v_fmac_f32 v222, v200, v86
    v_fmac_f32 v223, v200, v87
    v_fmac_f32 v224, v200, v88
    v_fmac_f32 v225, v200, v89
    v_fmac_f32 v216, v201, v90
    v_fmac_f32 v217, v201, v91
    v_fmac_f32 v218, v201, v92
    v_fmac_f32 v219, v201, v93
    v_fmac_f32 v220, v201, v94
    v_fmac_f32 v221, v201, v95
    v_fmac_f32 v222, v201, v96
    v_fmac_f32 v223, v201, v97
    v_fmac_f32 v224, v201, v98
    v_fmac_f32 v225, v201, v99
    v_fmac_f32 v216, v202, v100
    v_fmac_f32 v217, v202, v101
    v_fmac_f32 v218, v202, v102
    v_fmac_f32 v219, v202, v103
    v_fmac_f32 v220, v202, v104
    v_fmac_f32 v221, v202, v105
    v_fmac_f32 v222, v202, v106
    v_fmac_f32 v223, v202, v107
    v_fmac_f32 v224, v202, v108
    v_fmac_f32 v225, v202, v109
    v_fmac_f32 v216, v203, v110
    v_fmac_f32 v217, v203, v111
    v_fmac_f32 v218, v203, v112
    v_fmac_f32 v219, v203, v113
    v_fmac_f32 v220, v203, v114
    v_fmac_f32 v221, v203, v115
    v_fmac_f32 v222, v203, v116
    v_fmac_f32 v223, v203, v117
    v_fmac_f32 v224, v203, v118
    v_fmac_f32 v225, v203, v119
    v_fmac_f32 v216, v204, v120
    v_fmac_f32 v217, v204, v121
    v_fmac_f32 v218, v204, v122
    v_fmac_f32 v219, v204, v123
    v_fmac_f32 v220, v204, v124
    v_fmac_f32 v221, v204, v125
    v_fmac_f32 v222, v204, v126
    v_fmac_f32 v223, v204, v127
    v_fmac_f32 v224, v204, v128
    v_fmac_f32 v225, v204, v129
    v_fmac_f32 v216, v205, v130
    v_fmac_f32 v217, v205, v131
    v_fmac_f32 v218, v205, v132
    v_fmac_f32 v219, v205, v133
    v_fmac_f32 v220, v205, v134
    v_fmac_f32 v221, v205, v135
    v_fmac_f32 v222, v205, v136
    v_fmac_f32 v223, v205, v137
    v_fmac_f32 v224, v205, v138
    v_fmac_f32 v225, v205, v139
    v_fmac_f32 v216, v206, v140
    v_fmac_f32 v217, v206, v141
    v_fmac_f32 v218, v206, v142
    v_fmac_f32 v219, v206, v143
    v_fmac_f32 v220, v206, v144
    v_fmac_f32 v221, v206, v145
    v_fmac_f32 v222, v206, v146
    v_fmac_f32 v223, v206, v147
    v_fmac_f32 v224, v206, v148
    v_fmac_f32 v225, v206, v149
    v_fmac_f32 v216, v207, v150
    v_fmac_f32 v217, v207, v151
    v_fmac_f32 v218, v207, v152
    v_fmac_f32 v219, v207, v153
    v_fmac_f32 v220, v207, v154
    v_fmac_f32 v221, v207, v155
    v_fmac_f32 v222, v207, v156
    v_fmac_f32 v223, v207, v157
    v_fmac_f32 v224, v207, v158
    v_fmac_f32 v225, v207, v159
    s_waitcnt vmcnt(0)
    v_lshlrev_b32 v208, 16, v208
    v_lshlrev_b32 v209, 16, v209
    v_lshlrev_b32 v210, 16, v210
    v_lshlrev_b32 v211, 16, v211
    v_lshlrev_b32 v212, 16, v212
    v_lshlrev_b32 v213, 16, v213
    v_lshlrev_b32 v214, 16, v214
    v_lshlrev_b32 v215, 16, v215
    v_fmac_f32 v160, v208, v216
    v_mul_f32 v229, v210, v226
    v_fmac_f32 v229, v212, v227
    v_fmac_f32 v229, v214, v228
    v_fmac_f32 v176, v229, v218
    v_mul_f32 v229, v208, v220
    v_fmac_f32 v162, v229, v226
    v_fmac_f32 v168, v210, v222
    v_mul_f32 v230, v227, v214
    v_fma_f32 v230, -v228, v212, v230
    v_fmac_f32 v178, v230, v224
    v_fmac_f32 v164, v229, v227
    v_fmac_f32 v170, v212, v222
    v_mul_f32 v230, v228, v210
    v_fma_f32 v230, -v226, v214, v230
    v_fmac_f32 v180, v230, v224
    v_fmac_f32 v166, v229, v228
    v_fmac_f32 v172, v214, v222
    v_mul_f32 v230, v226, v212
    v_fma_f32 v230, -v227, v210, v230
    v_fmac_f32 v174, v230, v224
    v_fmac_f32 v161, v209, v217
    v_mul_f32 v229, v211, v226
    v_fmac_f32 v229, v213, v227
    v_fmac_f32 v229, v215, v228
    v_fmac_f32 v177, v229, v219
    v_mul_f32 v229, v209, v221
    v_fmac_f32 v163, v229, v226
    v_fmac_f32 v169, v211, v223
    v_mul_f32 v230, v227, v215
    v_fma_f32 v230, -v228, v213, v230
    v_fmac_f32 v179, v230, v225
    v_fmac_f32 v165, v229, v227
    v_fmac_f32 v171, v213, v223
    v_mul_f32 v230, v228, v211
    v_fma_f32 v230, -v226, v215, v230
    v_fmac_f32 v181, v230, v225
    v_fmac_f32 v167, v229, v228
    v_fmac_f32 v173, v215, v223
    v_mul_f32 v230, v226, v213
    v_fma_f32 v230, -v227, v211, v230
    v_fmac_f32 v175, v230, v225
    s_branch SL_bits
SL_nexti:
    s_mov_b64 s[38:39], s[40:41]
    s_mov_b64 s[40:41], s[42:43]
    s_mov_b64 s[42:43], s[44:45]
    s_add_u32 s36, s36, 1
    s_cmp_lt_u32 s36, 4
    s_cbranch_scc1 SL_bits
    s_add_u32 s35, s35, 256
    s_cmp_lt_u32 s35, 320000
    s_cbranch_scc1 SL_scan
    s_lshl_b32 s66, s50, 3
    s_add_u32 s66, s66, s20
    s_lshl_b32 s67, s66, 4
    s_and_b32 s68, s67, 128
    s_and_b32 s67, s67, 0x70
    s_mul_i32 s69, s50, 1536
    s_add_u32 s69, s69, s21
    s_add_u32 s69, s69, s68
    s_mul_i32 s70, s66, 1536
    s_add_u32 s70, s70, 86016
    s_add_u32 s70, s70, s68
    v_mov_b32 v230, s69
    v_mov_b32 v231, s70
    v_cmp_gt_u32 vcc, 32, v240
    v_and_b32 v229, 31, v240
    v_lshlrev_b32 v229, 2, v229
    v_xor_b32 v229, s67, v229
    v_cndmask_b32 v244, v231, v230, vcc
    v_add_u32 v244, v244, v229
    v_cvt_pk_bf16_f32 v160, v160, v161
    ds_write_b32 v244, v160 offset:0
    v_cvt_pk_bf16_f32 v162, v162, v163
    ds_write_b32 v244, v162 offset:128
    v_cvt_pk_bf16_f32 v164, v164, v165
    ds_write_b32 v244, v164 offset:256
    v_cvt_pk_bf16_f32 v166, v166, v167
    ds_write_b32 v244, v166 offset:384
    v_cvt_pk_bf16_f32 v168, v168, v169
    ds_write_b32 v244, v168 offset:512
    v_cvt_pk_bf16_f32 v170, v170, v171
    ds_write_b32 v244, v170 offset:640
    v_cvt_pk_bf16_f32 v172, v172, v173
    ds_write_b32 v244, v172 offset:768
    v_cvt_pk_bf16_f32 v174, v174, v175
    ds_write_b32 v244, v174 offset:896
    v_cvt_pk_bf16_f32 v176, v176, v177
    ds_write_b32 v244, v176 offset:1024
    v_cvt_pk_bf16_f32 v178, v178, v179
    ds_write_b32 v244, v178 offset:1152
    v_cvt_pk_bf16_f32 v180, v180, v181
    ds_write_b32 v244, v180 offset:1280
    s_lshl_b32 s66, s66, 3
    s_add_u32 s66, s66, 163328
    v_mov_b32 v229, s66
    ds_write_b64 v229, v[230:231]
    s_add_u32 s50, s50, 1
    s_cmp_lt_u32 s50, 5
    s_cbranch_scc1 SL_node
    s_waitcnt lgkmcnt(0)
    s_barrier
    v_mov_b32 v176, v240
    s_load_dwordx4 s[84:87], s[0:1], 48
    s_mul_i32 s22, s20, 20
    s_waitcnt lgkmcnt(0)
    s_mul_i32 s24, s22, 3277
    s_lshr_b32 s24, s24, 16
    s_mul_i32 s68, s24, 20
    s_sub_u32 s68, s22, s68
    s_cmp_lt_u32 s68, 8
    s_cselect_b64 s[66:67], s[84:85], s[86:87]
    s_cselect_b32 s25, 0, 8
    s_sub_u32 s68, s68, s25
    s_and_b32 s25, s68, 1
    s_lshr_b32 s68, s68, 1
    s_lshl_b32 s68, s68, 14
    s_lshl_b32 s25, s25, 12
    s_add_u32 s68, s68, s25
    s_lshl_b32 s24, s24, 5
    s_add_u32 s68, s68, s24
    v_lshrrev_b32 v2, 4, v176
    v_lshlrev_b32 v2, 10, v2
    v_and_b32 v3, 15, v176
    v_lshl_add_u32 v2, v3, 1, v2
    v_add_u32 v2, s68, v2
    v_add_u32 v3, 8192, v2
    v_mov_b32 v4, 0
    v_mov_b32 v5, 0
    v_mov_b32 v6, 0
    v_mov_b32 v7, 0
    global_load_ushort v144, v2, s[66:67] offset:0
    global_load_short_d16_hi v4, v3, s[66:67] offset:0
    global_load_ushort v145, v2, s[66:67] offset:256
    global_load_short_d16_hi v5, v3, s[66:67] offset:256
    global_load_ushort v146, v2, s[66:67] offset:512
    global_load_short_d16_hi v6, v3, s[66:67] offset:512
    global_load_ushort v147, v2, s[66:67] offset:768
    global_load_short_d16_hi v7, v3, s[66:67] offset:768
    s_add_u32 s22, s22, 1
    s_waitcnt vmcnt(0)
    v_or_b32 v144, v144, v4
    v_or_b32 v145, v145, v5
    v_or_b32 v146, v146, v6
    v_or_b32 v147, v147, v7
    s_mul_i32 s24, s22, 3277
    s_lshr_b32 s24, s24, 16
    s_mul_i32 s68, s24, 20
    s_sub_u32 s68, s22, s68
    s_cmp_lt_u32 s68, 8
    s_cselect_b64 s[66:67], s[84:85], s[86:87]
    s_cselect_b32 s25, 0, 8
    s_sub_u32 s68, s68, s25
    s_and_b32 s25, s68, 1
    s_lshr_b32 s68, s68, 1
    s_lshl_b32 s68, s68, 14
    s_lshl_b32 s25, s25, 12
    s_add_u32 s68, s68, s25
    s_lshl_b32 s24, s24, 5
    s_add_u32 s68, s68, s24
    v_lshrrev_b32 v2, 4, v176
    v_lshlrev_b32 v2, 10, v2
    v_and_b32 v3, 15, v176
    v_lshl_add_u32 v2, v3, 1, v2
    v_add_u32 v2, s68, v2
    v_add_u32 v3, 8192, v2
    v_mov_b32 v4, 0
    v_mov_b32 v5, 0
    v_mov_b32 v6, 0
    v_mov_b32 v7, 0
    global_load_ushort v148, v2, s[66:67] offset:0
    global_load_short_d16_hi v4, v3, s[66:67] offset:0
    global_load_ushort v149, v2, s[66:67] offset:256
    global_load_short_d16_hi v5, v3, s[66:67] offset:256
    global_load_ushort v150, v2, s[66:67] offset:512
    global_load_short_d16_hi v6, v3, s[66:67] offset:512
    global_load_ushort v151, v2, s[66:67] offset:768
    global_load_short_d16_hi v7, v3, s[66:67] offset:768
    s_add_u32 s22, s22, 1
    s_waitcnt vmcnt(0)
    v_or_b32 v148, v148, v4
    v_or_b32 v149, v149, v5
    v_or_b32 v150, v150, v6
    v_or_b32 v151, v151, v7
    s_mul_i32 s24, s22, 3277
    s_lshr_b32 s24, s24, 16
    s_mul_i32 s68, s24, 20
    s_sub_u32 s68, s22, s68
    s_cmp_lt_u32 s68, 8
    s_cselect_b64 s[66:67], s[84:85], s[86:87]
    s_cselect_b32 s25, 0, 8
    s_sub_u32 s68, s68, s25
    s_and_b32 s25, s68, 1
    s_lshr_b32 s68, s68, 1
    s_lshl_b32 s68, s68, 14
    s_lshl_b32 s25, s25, 12
    s_add_u32 s68, s68, s25
    s_lshl_b32 s24, s24, 5
    s_add_u32 s68, s68, s24
    v_lshrrev_b32 v2, 4, v176
    v_lshlrev_b32 v2, 10, v2
    v_and_b32 v3, 15, v176
    v_lshl_add_u32 v2, v3, 1, v2
    v_add_u32 v2, s68, v2
    v_add_u32 v3, 8192, v2
    v_mov_b32 v4, 0
    v_mov_b32 v5, 0
    v_mov_b32 v6, 0
    v_mov_b32 v7, 0
    global_load_ushort v96, v2, s[66:67] offset:0
    global_load_short_d16_hi v4, v3, s[66:67] offset:0
    global_load_ushort v97, v2, s[66:67] offset:256
    global_load_short_d16_hi v5, v3, s[66:67] offset:256
    global_load_ushort v98, v2, s[66:67] offset:512
    global_load_short_d16_hi v6, v3, s[66:67] offset:512
    global_load_ushort v99, v2, s[66:67] offset:768
    global_load_short_d16_hi v7, v3, s[66:67] offset:768
    s_add_u32 s22, s22, 1
    s_waitcnt vmcnt(0)
    v_or_b32 v96, v96, v4
    v_or_b32 v97, v97, v5
    v_or_b32 v98, v98, v6
    v_or_b32 v99, v99, v7
    s_mul_i32 s24, s22, 3277
    s_lshr_b32 s24, s24, 16
    s_mul_i32 s68, s24, 20
    s_sub_u32 s68, s22, s68
    s_cmp_lt_u32 s68, 8
    s_cselect_b64 s[66:67], s[84:85], s[86:87]
    s_cselect_b32 s25, 0, 8
    s_sub_u32 s68, s68, s25
    s_and_b32 s25, s68, 1
    s_lshr_b32 s68, s68, 1
    s_lshl_b32 s68, s68, 14
    s_lshl_b32 s25, s25, 12
    s_add_u32 s68, s68, s25
    s_lshl_b32 s24, s24, 5
    s_add_u32 s68, s68, s24
    v_lshrrev_b32 v2, 4, v176
    v_lshlrev_b32 v2, 10, v2
    v_and_b32 v3, 15, v176
    v_lshl_add_u32 v2, v3, 1, v2
    v_add_u32 v2, s68, v2
    v_add_u32 v3, 8192, v2
    v_mov_b32 v4, 0
    v_mov_b32 v5, 0
    v_mov_b32 v6, 0
    v_mov_b32 v7, 0
    global_load_ushort v100, v2, s[66:67] offset:0
    global_load_short_d16_hi v4, v3, s[66:67] offset:0
    global_load_ushort v101, v2, s[66:67] offset:256
    global_load_short_d16_hi v5, v3, s[66:67] offset:256
    global_load_ushort v102, v2, s[66:67] offset:512
    global_load_short_d16_hi v6, v3, s[66:67] offset:512
    global_load_ushort v103, v2, s[66:67] offset:768
    global_load_short_d16_hi v7, v3, s[66:67] offset:768
    s_add_u32 s22, s22, 1
    s_waitcnt vmcnt(0)
    v_or_b32 v100, v100, v4
    v_or_b32 v101, v101, v5
    v_or_b32 v102, v102, v6
    v_or_b32 v103, v103, v7
    s_mul_i32 s24, s22, 3277
    s_lshr_b32 s24, s24, 16
    s_mul_i32 s68, s24, 20
    s_sub_u32 s68, s22, s68
    s_cmp_lt_u32 s68, 8
    s_cselect_b64 s[66:67], s[84:85], s[86:87]
    s_cselect_b32 s25, 0, 8
    s_sub_u32 s68, s68, s25
    s_and_b32 s25, s68, 1
    s_lshr_b32 s68, s68, 1
    s_lshl_b32 s68, s68, 14
    s_lshl_b32 s25, s25, 12
    s_add_u32 s68, s68, s25
    s_lshl_b32 s24, s24, 5
    s_add_u32 s68, s68, s24
    v_lshrrev_b32 v2, 4, v176
    v_lshlrev_b32 v2, 10, v2
    v_and_b32 v3, 15, v176
    v_lshl_add_u32 v2, v3, 1, v2
    v_add_u32 v2, s68, v2
    v_add_u32 v3, 8192, v2
    v_mov_b32 v4, 0
    v_mov_b32 v5, 0
    v_mov_b32 v6, 0
    v_mov_b32 v7, 0
    global_load_ushort v160, v2, s[66:67] offset:0
    global_load_short_d16_hi v4, v3, s[66:67] offset:0
    global_load_ushort v161, v2, s[66:67] offset:256
    global_load_short_d16_hi v5, v3, s[66:67] offset:256
    global_load_ushort v162, v2, s[66:67] offset:512
    global_load_short_d16_hi v6, v3, s[66:67] offset:512
    global_load_ushort v163, v2, s[66:67] offset:768
    global_load_short_d16_hi v7, v3, s[66:67] offset:768
    s_add_u32 s22, s22, 1
    s_waitcnt vmcnt(0)
    v_or_b32 v160, v160, v4
    v_or_b32 v161, v161, v5
    v_or_b32 v162, v162, v6
    v_or_b32 v163, v163, v7
    s_mul_i32 s24, s22, 3277
    s_lshr_b32 s24, s24, 16
    s_mul_i32 s68, s24, 20
    s_sub_u32 s68, s22, s68
    s_cmp_lt_u32 s68, 8
    s_cselect_b64 s[66:67], s[84:85], s[86:87]
    s_cselect_b32 s25, 0, 8
    s_sub_u32 s68, s68, s25
    s_and_b32 s25, s68, 1
    s_lshr_b32 s68, s68, 1
    s_lshl_b32 s68, s68, 14
    s_lshl_b32 s25, s25, 12
    s_add_u32 s68, s68, s25
    s_lshl_b32 s24, s24, 5
    s_add_u32 s68, s68, s24
    v_lshrrev_b32 v2, 4, v176
    v_lshlrev_b32 v2, 10, v2
    v_and_b32 v3, 15, v176
    v_lshl_add_u32 v2, v3, 1, v2
    v_add_u32 v2, s68, v2
    v_add_u32 v3, 8192, v2
    v_mov_b32 v4, 0
    v_mov_b32 v5, 0
    v_mov_b32 v6, 0
    v_mov_b32 v7, 0
    global_load_ushort v164, v2, s[66:67] offset:0
    global_load_short_d16_hi v4, v3, s[66:67] offset:0
    global_load_ushort v165, v2, s[66:67] offset:256
    global_load_short_d16_hi v5, v3, s[66:67] offset:256
    global_load_ushort v166, v2, s[66:67] offset:512
    global_load_short_d16_hi v6, v3, s[66:67] offset:512
    global_load_ushort v167, v2, s[66:67] offset:768
    global_load_short_d16_hi v7, v3, s[66:67] offset:768
    s_add_u32 s22, s22, 1
    s_waitcnt vmcnt(0)
    v_or_b32 v164, v164, v4
    v_or_b32 v165, v165, v5
    v_or_b32 v166, v166, v6
    v_or_b32 v167, v167, v7
    s_mul_i32 s24, s22, 3277
    s_lshr_b32 s24, s24, 16
    s_mul_i32 s68, s24, 20
    s_sub_u32 s68, s22, s68
    s_cmp_lt_u32 s68, 8
    s_cselect_b64 s[66:67], s[84:85], s[86:87]
    s_cselect_b32 s25, 0, 8
    s_sub_u32 s68, s68, s25
    s_and_b32 s25, s68, 1
    s_lshr_b32 s68, s68, 1
    s_lshl_b32 s68, s68, 14
    s_lshl_b32 s25, s25, 12
    s_add_u32 s68, s68, s25
    s_lshl_b32 s24, s24, 5
    s_add_u32 s68, s68, s24
    v_lshrrev_b32 v2, 4, v176
    v_lshlrev_b32 v2, 10, v2
    v_and_b32 v3, 15, v176
    v_lshl_add_u32 v2, v3, 1, v2
    v_add_u32 v2, s68, v2
    v_add_u32 v3, 8192, v2
    v_mov_b32 v4, 0
    v_mov_b32 v5, 0
    v_mov_b32 v6, 0
    v_mov_b32 v7, 0
    global_load_ushort v104, v2, s[66:67] offset:0
    global_load_short_d16_hi v4, v3, s[66:67] offset:0
    global_load_ushort v105, v2, s[66:67] offset:256
    global_load_short_d16_hi v5, v3, s[66:67] offset:256
    global_load_ushort v106, v2, s[66:67] offset:512
    global_load_short_d16_hi v6, v3, s[66:67] offset:512
    global_load_ushort v107, v2, s[66:67] offset:768
    global_load_short_d16_hi v7, v3, s[66:67] offset:768
    s_add_u32 s22, s22, 1
    s_waitcnt vmcnt(0)
    v_or_b32 v104, v104, v4
    v_or_b32 v105, v105, v5
    v_or_b32 v106, v106, v6
    v_or_b32 v107, v107, v7
    s_mul_i32 s24, s22, 3277
    s_lshr_b32 s24, s24, 16
    s_mul_i32 s68, s24, 20
    s_sub_u32 s68, s22, s68
    s_cmp_lt_u32 s68, 8
    s_cselect_b64 s[66:67], s[84:85], s[86:87]
    s_cselect_b32 s25, 0, 8
    s_sub_u32 s68, s68, s25
    s_and_b32 s25, s68, 1
    s_lshr_b32 s68, s68, 1
    s_lshl_b32 s68, s68, 14
    s_lshl_b32 s25, s25, 12
    s_add_u32 s68, s68, s25
    s_lshl_b32 s24, s24, 5
    s_add_u32 s68, s68, s24
    v_lshrrev_b32 v2, 4, v176
    v_lshlrev_b32 v2, 10, v2
    v_and_b32 v3, 15, v176
    v_lshl_add_u32 v2, v3, 1, v2
    v_add_u32 v2, s68, v2
    v_add_u32 v3, 8192, v2
    v_mov_b32 v4, 0
    v_mov_b32 v5, 0
    v_mov_b32 v6, 0
    v_mov_b32 v7, 0
    global_load_ushort v108, v2, s[66:67] offset:0
    global_load_short_d16_hi v4, v3, s[66:67] offset:0
    global_load_ushort v109, v2, s[66:67] offset:256
    global_load_short_d16_hi v5, v3, s[66:67] offset:256
    global_load_ushort v110, v2, s[66:67] offset:512
    global_load_short_d16_hi v6, v3, s[66:67] offset:512
    global_load_ushort v111, v2, s[66:67] offset:768
    global_load_short_d16_hi v7, v3, s[66:67] offset:768
    s_add_u32 s22, s22, 1
    s_waitcnt vmcnt(0)
    v_or_b32 v108, v108, v4
    v_or_b32 v109, v109, v5
    v_or_b32 v110, v110, v6
    v_or_b32 v111, v111, v7
    s_mul_i32 s24, s22, 3277
    s_lshr_b32 s24, s24, 16
    s_mul_i32 s68, s24, 20
    s_sub_u32 s68, s22, s68
    s_cmp_lt_u32 s68, 8
    s_cselect_b64 s[66:67], s[84:85], s[86:87]
    s_cselect_b32 s25, 0, 8
    s_sub_u32 s68, s68, s25
    s_and_b32 s25, s68, 1
    s_lshr_b32 s68, s68, 1
    s_lshl_b32 s68, s68, 14
    s_lshl_b32 s25, s25, 12
    s_add_u32 s68, s68, s25
    s_lshl_b32 s24, s24, 5
    s_add_u32 s68, s68, s24
    v_lshrrev_b32 v2, 4, v176
    v_lshlrev_b32 v2, 10, v2
    v_and_b32 v3, 15, v176
    v_lshl_add_u32 v2, v3, 1, v2
    v_add_u32 v2, s68, v2
    v_add_u32 v3, 8192, v2
    v_mov_b32 v4, 0
    v_mov_b32 v5, 0
    v_mov_b32 v6, 0
    v_mov_b32 v7, 0
    global_load_ushort v120, v2, s[66:67] offset:0
    global_load_short_d16_hi v4, v3, s[66:67] offset:0
    global_load_ushort v121, v2, s[66:67] offset:256
    global_load_short_d16_hi v5, v3, s[66:67] offset:256
    global_load_ushort v122, v2, s[66:67] offset:512
    global_load_short_d16_hi v6, v3, s[66:67] offset:512
    global_load_ushort v123, v2, s[66:67] offset:768
    global_load_short_d16_hi v7, v3, s[66:67] offset:768
    s_add_u32 s22, s22, 1
    s_waitcnt vmcnt(0)
    v_or_b32 v120, v120, v4
    v_or_b32 v121, v121, v5
    v_or_b32 v122, v122, v6
    v_or_b32 v123, v123, v7
    s_mul_i32 s24, s22, 3277
    s_lshr_b32 s24, s24, 16
    s_mul_i32 s68, s24, 20
    s_sub_u32 s68, s22, s68
    s_cmp_lt_u32 s68, 8
    s_cselect_b64 s[66:67], s[84:85], s[86:87]
    s_cselect_b32 s25, 0, 8
    s_sub_u32 s68, s68, s25
    s_and_b32 s25, s68, 1
    s_lshr_b32 s68, s68, 1
    s_lshl_b32 s68, s68, 14
    s_lshl_b32 s25, s25, 12
    s_add_u32 s68, s68, s25
    s_lshl_b32 s24, s24, 5
    s_add_u32 s68, s68, s24
    v_lshrrev_b32 v2, 4, v176
    v_lshlrev_b32 v2, 10, v2
    v_and_b32 v3, 15, v176
    v_lshl_add_u32 v2, v3, 1, v2
    v_add_u32 v2, s68, v2
    v_add_u32 v3, 8192, v2
    v_mov_b32 v4, 0
    v_mov_b32 v5, 0
    v_mov_b32 v6, 0
    v_mov_b32 v7, 0
    global_load_ushort v124, v2, s[66:67] offset:0
    global_load_short_d16_hi v4, v3, s[66:67] offset:0
    global_load_ushort v125, v2, s[66:67] offset:256
    global_load_short_d16_hi v5, v3, s[66:67] offset:256
    global_load_ushort v126, v2, s[66:67] offset:512
    global_load_short_d16_hi v6, v3, s[66:67] offset:512
    global_load_ushort v127, v2, s[66:67] offset:768
    global_load_short_d16_hi v7, v3, s[66:67] offset:768
    s_add_u32 s22, s22, 1
    s_waitcnt vmcnt(0)
    v_or_b32 v124, v124, v4
    v_or_b32 v125, v125, v5
    v_or_b32 v126, v126, v6
    v_or_b32 v127, v127, v7
    s_mul_i32 s24, s22, 3277
    s_lshr_b32 s24, s24, 16
    s_mul_i32 s68, s24, 20
    s_sub_u32 s68, s22, s68
    s_cmp_lt_u32 s68, 8
    s_cselect_b64 s[66:67], s[84:85], s[86:87]
    s_cselect_b32 s25, 0, 8
    s_sub_u32 s68, s68, s25
    s_and_b32 s25, s68, 1
    s_lshr_b32 s68, s68, 1
    s_lshl_b32 s68, s68, 14
    s_lshl_b32 s25, s25, 12
    s_add_u32 s68, s68, s25
    s_lshl_b32 s24, s24, 5
    s_add_u32 s68, s68, s24
    v_lshrrev_b32 v2, 4, v176
    v_lshlrev_b32 v2, 10, v2
    v_and_b32 v3, 15, v176
    v_lshl_add_u32 v2, v3, 1, v2
    v_add_u32 v2, s68, v2
    v_add_u32 v3, 8192, v2
    v_mov_b32 v4, 0
    v_mov_b32 v5, 0
    v_mov_b32 v6, 0
    v_mov_b32 v7, 0
    global_load_ushort v128, v2, s[66:67] offset:0
    global_load_short_d16_hi v4, v3, s[66:67] offset:0
    global_load_ushort v129, v2, s[66:67] offset:256
    global_load_short_d16_hi v5, v3, s[66:67] offset:256
    global_load_ushort v130, v2, s[66:67] offset:512
    global_load_short_d16_hi v6, v3, s[66:67] offset:512
    global_load_ushort v131, v2, s[66:67] offset:768
    global_load_short_d16_hi v7, v3, s[66:67] offset:768
    s_add_u32 s22, s22, 1
    s_waitcnt vmcnt(0)
    v_or_b32 v128, v128, v4
    v_or_b32 v129, v129, v5
    v_or_b32 v130, v130, v6
    v_or_b32 v131, v131, v7
    s_mul_i32 s24, s22, 3277
    s_lshr_b32 s24, s24, 16
    s_mul_i32 s68, s24, 20
    s_sub_u32 s68, s22, s68
    s_cmp_lt_u32 s68, 8
    s_cselect_b64 s[66:67], s[84:85], s[86:87]
    s_cselect_b32 s25, 0, 8
    s_sub_u32 s68, s68, s25
    s_and_b32 s25, s68, 1
    s_lshr_b32 s68, s68, 1
    s_lshl_b32 s68, s68, 14
    s_lshl_b32 s25, s25, 12
    s_add_u32 s68, s68, s25
    s_lshl_b32 s24, s24, 5
    s_add_u32 s68, s68, s24
    v_lshrrev_b32 v2, 4, v176
    v_lshlrev_b32 v2, 10, v2
    v_and_b32 v3, 15, v176
    v_lshl_add_u32 v2, v3, 1, v2
    v_add_u32 v2, s68, v2
    v_add_u32 v3, 8192, v2
    v_mov_b32 v4, 0
    v_mov_b32 v5, 0
    v_mov_b32 v6, 0
    v_mov_b32 v7, 0
    global_load_ushort v132, v2, s[66:67] offset:0
    global_load_short_d16_hi v4, v3, s[66:67] offset:0
    global_load_ushort v133, v2, s[66:67] offset:256
    global_load_short_d16_hi v5, v3, s[66:67] offset:256
    global_load_ushort v134, v2, s[66:67] offset:512
    global_load_short_d16_hi v6, v3, s[66:67] offset:512
    global_load_ushort v135, v2, s[66:67] offset:768
    global_load_short_d16_hi v7, v3, s[66:67] offset:768
    s_add_u32 s22, s22, 1
    s_waitcnt vmcnt(0)
    v_or_b32 v132, v132, v4
    v_or_b32 v133, v133, v5
    v_or_b32 v134, v134, v6
    v_or_b32 v135, v135, v7
    s_mul_i32 s24, s22, 3277
    s_lshr_b32 s24, s24, 16
    s_mul_i32 s68, s24, 20
    s_sub_u32 s68, s22, s68
    s_cmp_lt_u32 s68, 8
    s_cselect_b64 s[66:67], s[84:85], s[86:87]
    s_cselect_b32 s25, 0, 8
    s_sub_u32 s68, s68, s25
    s_and_b32 s25, s68, 1
    s_lshr_b32 s68, s68, 1
    s_lshl_b32 s68, s68, 14
    s_lshl_b32 s25, s25, 12
    s_add_u32 s68, s68, s25
    s_lshl_b32 s24, s24, 5
    s_add_u32 s68, s68, s24
    v_lshrrev_b32 v2, 4, v176
    v_lshlrev_b32 v2, 10, v2
    v_and_b32 v3, 15, v176
    v_lshl_add_u32 v2, v3, 1, v2
    v_add_u32 v2, s68, v2
    v_add_u32 v3, 8192, v2
    v_mov_b32 v4, 0
    v_mov_b32 v5, 0
    v_mov_b32 v6, 0
    v_mov_b32 v7, 0
    global_load_ushort v152, v2, s[66:67] offset:0
    global_load_short_d16_hi v4, v3, s[66:67] offset:0
    global_load_ushort v153, v2, s[66:67] offset:256
    global_load_short_d16_hi v5, v3, s[66:67] offset:256
    global_load_ushort v154, v2, s[66:67] offset:512
    global_load_short_d16_hi v6, v3, s[66:67] offset:512
    global_load_ushort v155, v2, s[66:67] offset:768
    global_load_short_d16_hi v7, v3, s[66:67] offset:768
    s_add_u32 s22, s22, 1
    s_waitcnt vmcnt(0)
    v_or_b32 v152, v152, v4
    v_or_b32 v153, v153, v5
    v_or_b32 v154, v154, v6
    v_or_b32 v155, v155, v7
    s_mul_i32 s24, s22, 3277
    s_lshr_b32 s24, s24, 16
    s_mul_i32 s68, s24, 20
    s_sub_u32 s68, s22, s68
    s_cmp_lt_u32 s68, 8
    s_cselect_b64 s[66:67], s[84:85], s[86:87]
    s_cselect_b32 s25, 0, 8
    s_sub_u32 s68, s68, s25
    s_and_b32 s25, s68, 1
    s_lshr_b32 s68, s68, 1
    s_lshl_b32 s68, s68, 14
    s_lshl_b32 s25, s25, 12
    s_add_u32 s68, s68, s25
    s_lshl_b32 s24, s24, 5
    s_add_u32 s68, s68, s24
    v_lshrrev_b32 v2, 4, v176
    v_lshlrev_b32 v2, 10, v2
    v_and_b32 v3, 15, v176
    v_lshl_add_u32 v2, v3, 1, v2
    v_add_u32 v2, s68, v2
    v_add_u32 v3, 8192, v2
    v_mov_b32 v4, 0
    v_mov_b32 v5, 0
    v_mov_b32 v6, 0
    v_mov_b32 v7, 0
    global_load_ushort v156, v2, s[66:67] offset:0
    global_load_short_d16_hi v4, v3, s[66:67] offset:0
    global_load_ushort v157, v2, s[66:67] offset:256
    global_load_short_d16_hi v5, v3, s[66:67] offset:256
    global_load_ushort v158, v2, s[66:67] offset:512
    global_load_short_d16_hi v6, v3, s[66:67] offset:512
    global_load_ushort v159, v2, s[66:67] offset:768
    global_load_short_d16_hi v7, v3, s[66:67] offset:768
    s_add_u32 s22, s22, 1
    s_waitcnt vmcnt(0)
    v_or_b32 v156, v156, v4
    v_or_b32 v157, v157, v5
    v_or_b32 v158, v158, v6
    v_or_b32 v159, v159, v7
    s_mul_i32 s24, s22, 3277
    s_lshr_b32 s24, s24, 16
    s_mul_i32 s68, s24, 20
    s_sub_u32 s68, s22, s68
    s_cmp_lt_u32 s68, 8
    s_cselect_b64 s[66:67], s[84:85], s[86:87]
    s_cselect_b32 s25, 0, 8
    s_sub_u32 s68, s68, s25
    s_and_b32 s25, s68, 1
    s_lshr_b32 s68, s68, 1
    s_lshl_b32 s68, s68, 14
    s_lshl_b32 s25, s25, 12
    s_add_u32 s68, s68, s25
    s_lshl_b32 s24, s24, 5
    s_add_u32 s68, s68, s24
    v_lshrrev_b32 v2, 4, v176
    v_lshlrev_b32 v2, 10, v2
    v_and_b32 v3, 15, v176
    v_lshl_add_u32 v2, v3, 1, v2
    v_add_u32 v2, s68, v2
    v_add_u32 v3, 8192, v2
    v_mov_b32 v4, 0
    v_mov_b32 v5, 0
    v_mov_b32 v6, 0
    v_mov_b32 v7, 0
    global_load_ushort v136, v2, s[66:67] offset:0
    global_load_short_d16_hi v4, v3, s[66:67] offset:0
    global_load_ushort v137, v2, s[66:67] offset:256
    global_load_short_d16_hi v5, v3, s[66:67] offset:256
    global_load_ushort v138, v2, s[66:67] offset:512
    global_load_short_d16_hi v6, v3, s[66:67] offset:512
    global_load_ushort v139, v2, s[66:67] offset:768
    global_load_short_d16_hi v7, v3, s[66:67] offset:768
    s_add_u32 s22, s22, 1
    s_waitcnt vmcnt(0)
    v_or_b32 v136, v136, v4
    v_or_b32 v137, v137, v5
    v_or_b32 v138, v138, v6
    v_or_b32 v139, v139, v7
    s_mul_i32 s24, s22, 3277
    s_lshr_b32 s24, s24, 16
    s_mul_i32 s68, s24, 20
    s_sub_u32 s68, s22, s68
    s_cmp_lt_u32 s68, 8
    s_cselect_b64 s[66:67], s[84:85], s[86:87]
    s_cselect_b32 s25, 0, 8
    s_sub_u32 s68, s68, s25
    s_and_b32 s25, s68, 1
    s_lshr_b32 s68, s68, 1
    s_lshl_b32 s68, s68, 14
    s_lshl_b32 s25, s25, 12
    s_add_u32 s68, s68, s25
    s_lshl_b32 s24, s24, 5
    s_add_u32 s68, s68, s24
    v_lshrrev_b32 v2, 4, v176
    v_lshlrev_b32 v2, 10, v2
    v_and_b32 v3, 15, v176
    v_lshl_add_u32 v2, v3, 1, v2
    v_add_u32 v2, s68, v2
    v_add_u32 v3, 8192, v2
    v_mov_b32 v4, 0
    v_mov_b32 v5, 0
    v_mov_b32 v6, 0
    v_mov_b32 v7, 0
    global_load_ushort v140, v2, s[66:67] offset:0
    global_load_short_d16_hi v4, v3, s[66:67] offset:0
    global_load_ushort v141, v2, s[66:67] offset:256
    global_load_short_d16_hi v5, v3, s[66:67] offset:256
    global_load_ushort v142, v2, s[66:67] offset:512
    global_load_short_d16_hi v6, v3, s[66:67] offset:512
    global_load_ushort v143, v2, s[66:67] offset:768
    global_load_short_d16_hi v7, v3, s[66:67] offset:768
    s_add_u32 s22, s22, 1
    s_waitcnt vmcnt(0)
    v_or_b32 v140, v140, v4
    v_or_b32 v141, v141, v5
    v_or_b32 v142, v142, v6
    v_or_b32 v143, v143, v7
    s_mul_i32 s24, s22, 3277
    s_lshr_b32 s24, s24, 16
    s_mul_i32 s68, s24, 20
    s_sub_u32 s68, s22, s68
    s_cmp_lt_u32 s68, 8
    s_cselect_b64 s[66:67], s[84:85], s[86:87]
    s_cselect_b32 s25, 0, 8
    s_sub_u32 s68, s68, s25
    s_and_b32 s25, s68, 1
    s_lshr_b32 s68, s68, 1
    s_lshl_b32 s68, s68, 14
    s_lshl_b32 s25, s25, 12
    s_add_u32 s68, s68, s25
    s_lshl_b32 s24, s24, 5
    s_add_u32 s68, s68, s24
    v_lshrrev_b32 v2, 4, v176
    v_lshlrev_b32 v2, 10, v2
    v_and_b32 v3, 15, v176
    v_lshl_add_u32 v2, v3, 1, v2
    v_add_u32 v2, s68, v2
    v_add_u32 v3, 8192, v2
    v_mov_b32 v4, 0
    v_mov_b32 v5, 0
    v_mov_b32 v6, 0
    v_mov_b32 v7, 0
    global_load_ushort v168, v2, s[66:67] offset:0
    global_load_short_d16_hi v4, v3, s[66:67] offset:0
    global_load_ushort v169, v2, s[66:67] offset:256
    global_load_short_d16_hi v5, v3, s[66:67] offset:256
    global_load_ushort v170, v2, s[66:67] offset:512
    global_load_short_d16_hi v6, v3, s[66:67] offset:512
    global_load_ushort v171, v2, s[66:67] offset:768
    global_load_short_d16_hi v7, v3, s[66:67] offset:768
    s_add_u32 s22, s22, 1
    s_waitcnt vmcnt(0)
    v_or_b32 v168, v168, v4
    v_or_b32 v169, v169, v5
    v_or_b32 v170, v170, v6
    v_or_b32 v171, v171, v7
    s_mul_i32 s24, s22, 3277
    s_lshr_b32 s24, s24, 16
    s_mul_i32 s68, s24, 20
    s_sub_u32 s68, s22, s68
    s_cmp_lt_u32 s68, 8
    s_cselect_b64 s[66:67], s[84:85], s[86:87]
    s_cselect_b32 s25, 0, 8
    s_sub_u32 s68, s68, s25
    s_and_b32 s25, s68, 1
    s_lshr_b32 s68, s68, 1
    s_lshl_b32 s68, s68, 14
    s_lshl_b32 s25, s25, 12
    s_add_u32 s68, s68, s25
    s_lshl_b32 s24, s24, 5
    s_add_u32 s68, s68, s24
    v_lshrrev_b32 v2, 4, v176
    v_lshlrev_b32 v2, 10, v2
    v_and_b32 v3, 15, v176
    v_lshl_add_u32 v2, v3, 1, v2
    v_add_u32 v2, s68, v2
    v_add_u32 v3, 8192, v2
    v_mov_b32 v4, 0
    v_mov_b32 v5, 0
    v_mov_b32 v6, 0
    v_mov_b32 v7, 0
    global_load_ushort v172, v2, s[66:67] offset:0
    global_load_short_d16_hi v4, v3, s[66:67] offset:0
    global_load_ushort v173, v2, s[66:67] offset:256
    global_load_short_d16_hi v5, v3, s[66:67] offset:256
    global_load_ushort v174, v2, s[66:67] offset:512
    global_load_short_d16_hi v6, v3, s[66:67] offset:512
    global_load_ushort v175, v2, s[66:67] offset:768
    global_load_short_d16_hi v7, v3, s[66:67] offset:768
    s_add_u32 s22, s22, 1
    s_waitcnt vmcnt(0)
    v_or_b32 v172, v172, v4
    v_or_b32 v173, v173, v5
    v_or_b32 v174, v174, v6
    v_or_b32 v175, v175, v7
    s_mul_i32 s24, s22, 3277
    s_lshr_b32 s24, s24, 16
    s_mul_i32 s68, s24, 20
    s_sub_u32 s68, s22, s68
    s_cmp_lt_u32 s68, 8
    s_cselect_b64 s[66:67], s[84:85], s[86:87]
    s_cselect_b32 s25, 0, 8
    s_sub_u32 s68, s68, s25
    s_and_b32 s25, s68, 1
    s_lshr_b32 s68, s68, 1
    s_lshl_b32 s68, s68, 14
    s_lshl_b32 s25, s25, 12
    s_add_u32 s68, s68, s25
    s_lshl_b32 s24, s24, 5
    s_add_u32 s68, s68, s24
    v_lshrrev_b32 v2, 4, v176
    v_lshlrev_b32 v2, 10, v2
    v_and_b32 v3, 15, v176
    v_lshl_add_u32 v2, v3, 1, v2
    v_add_u32 v2, s68, v2
    v_add_u32 v3, 8192, v2
    v_mov_b32 v4, 0
    v_mov_b32 v5, 0
    v_mov_b32 v6, 0
    v_mov_b32 v7, 0
    global_load_ushort v112, v2, s[66:67] offset:0
    global_load_short_d16_hi v4, v3, s[66:67] offset:0
    global_load_ushort v113, v2, s[66:67] offset:256
    global_load_short_d16_hi v5, v3, s[66:67] offset:256
    global_load_ushort v114, v2, s[66:67] offset:512
    global_load_short_d16_hi v6, v3, s[66:67] offset:512
    global_load_ushort v115, v2, s[66:67] offset:768
    global_load_short_d16_hi v7, v3, s[66:67] offset:768
    s_add_u32 s22, s22, 1
    s_waitcnt vmcnt(0)
    v_or_b32 v112, v112, v4
    v_or_b32 v113, v113, v5
    v_or_b32 v114, v114, v6
    v_or_b32 v115, v115, v7
    s_mul_i32 s24, s22, 3277
    s_lshr_b32 s24, s24, 16
    s_mul_i32 s68, s24, 20
    s_sub_u32 s68, s22, s68
    s_cmp_lt_u32 s68, 8
    s_cselect_b64 s[66:67], s[84:85], s[86:87]
    s_cselect_b32 s25, 0, 8
    s_sub_u32 s68, s68, s25
    s_and_b32 s25, s68, 1
    s_lshr_b32 s68, s68, 1
    s_lshl_b32 s68, s68, 14
    s_lshl_b32 s25, s25, 12
    s_add_u32 s68, s68, s25
    s_lshl_b32 s24, s24, 5
    s_add_u32 s68, s68, s24
    v_lshrrev_b32 v2, 4, v176
    v_lshlrev_b32 v2, 10, v2
    v_and_b32 v3, 15, v176
    v_lshl_add_u32 v2, v3, 1, v2
    v_add_u32 v2, s68, v2
    v_add_u32 v3, 8192, v2
    v_mov_b32 v4, 0
    v_mov_b32 v5, 0
    v_mov_b32 v6, 0
    v_mov_b32 v7, 0
    global_load_ushort v116, v2, s[66:67] offset:0
    global_load_short_d16_hi v4, v3, s[66:67] offset:0
    global_load_ushort v117, v2, s[66:67] offset:256
    global_load_short_d16_hi v5, v3, s[66:67] offset:256
    global_load_ushort v118, v2, s[66:67] offset:512
    global_load_short_d16_hi v6, v3, s[66:67] offset:512
    global_load_ushort v119, v2, s[66:67] offset:768
    global_load_short_d16_hi v7, v3, s[66:67] offset:768
    s_add_u32 s22, s22, 1
    s_waitcnt vmcnt(0)
    v_or_b32 v116, v116, v4
    v_or_b32 v117, v117, v5
    v_or_b32 v118, v118, v6
    v_or_b32 v119, v119, v7
    s_load_dwordx2 s[72:73], s[0:1], 72
    v_lshlrev_b32 v246, 4, v176
    s_mov_b32 s52, 163072
    v_bfe_u32 v177, v246, 4, 4
    v_bfe_u32 v179, v246, 4, 3
    v_lshl_add_u32 v180, v177, 3, s52
    v_lshl_add_u32 v190, v177, 4, s52
    v_lshl_add_u32 v181, v179, 3, s52
    ds_read2_b64 v[182:185], v180 offset0:32 offset1:48
    ds_read_b32 v191, v190
    ds_read_b64 v[186:187], v181 offset:512
    v_lshrrev_b32 v178, 8, v246
    s_add_u32 s22, s20, 0
    s_mul_i32 s28, s22, 1536
    s_add_u32 s28, s28, 86016
    s_lshl_b32 s22, s22, 21
    s_add_u32 s23, s20, 8
    s_mul_i32 s29, s23, 1536
    s_add_u32 s29, s29, 86144
    s_lshl_b32 s23, s23, 21
    s_add_u32 s24, s20, 16
    s_mul_i32 s30, s24, 1536
    s_add_u32 s30, s30, 86016
    s_lshl_b32 s24, s24, 21
    s_add_u32 s25, s20, 24
    s_lshl_b32 s25, s25, 21
    s_add_u32 s26, s20, 32
    s_lshl_b32 s26, s26, 21
    s_mov_b32 s53, 0
    s_mov_b32 s50, 0
    s_waitcnt lgkmcnt(0)
    s_branch GEMM
.section .rodata,"a"
.p2align 6
.amdhsa_kernel standalone__tensor_product_equiv_equiformer__graph_kernel
  .amdhsa_next_free_vgpr 256
  .amdhsa_next_free_sgpr 90
  .amdhsa_accum_offset 256
  .amdhsa_group_segment_fixed_size 0
  .amdhsa_kernarg_size 96
  .amdhsa_user_sgpr_count 2
  .amdhsa_user_sgpr_kernarg_segment_ptr 1
  .amdhsa_system_sgpr_workgroup_id_x 1
.end_amdhsa_kernel
```

```asm
; @launch grid=(250,1,1) block=(512,1,1) lds=163840
.amdgcn_target "amdgcn-amd-amdhsa--gfx950"
.text
.globl standalone__tensor_product_equiv_equiformer__graph_kernel
.p2align 8
.type standalone__tensor_product_equiv_equiformer__graph_kernel,@function
standalone__tensor_product_equiv_equiformer__graph_kernel:
    s_cmp_ge_u32 s2, 250
    s_cbranch_scc1 K2_end
    s_load_dwordx16 s[72:87], s[0:1], 0
    s_load_dwordx2 s[70:71], s[0:1], 88
    v_lshrrev_b32 v2, 6, v0
    v_and_b32 v1, 63, v0
    v_readfirstlane_b32 s20, v2
    s_getpc_b64 s[66:67]
    v_lshlrev_b32 v95, 7, v1
    s_cmp_eq_u32 s20, 6
    s_cbranch_scc0 F_nopf0
    global_load_dword v95, v95, s[66:67]
F_nopf0:
    s_mul_i32 s66, s2, 5120
    s_mul_i32 s67, s2, 7680
    v_lshl_add_u32 v3, v0, 4, s66
    v_mul_u32_u24 v4, 24, v0
    v_add_u32 v4, s67, v4
    v_lshlrev_b32 v5, 2, v0
    v_mov_b32 v89, 0
    v_add_u32 v6, 98304, v5
    ds_write_b32 v6, v89
    s_cmp_ge_u32 s20, 5
    s_waitcnt lgkmcnt(0)
    s_cbranch_scc1 F_noload
    global_load_dwordx4 v[8:11], v3, s[80:81] nt
    global_load_dwordx4 v[12:15], v3, s[78:79] nt
    global_load_dwordx4 v[16:19], v4, s[74:75] nt
    global_load_dwordx2 v[20:21], v4, s[74:75] offset:16 nt
F_noload:
    s_load_dword s88, s[70:71], 0
    s_barrier
    v_lshlrev_b32 v248, 2, v1
    v_add_u32 v88, 162816, v248
    ds_write_b32 v88, v89
    ds_write_b32 v88, v89 offset:256
    v_lshlrev_b32 v86, 4, v1
    s_lshl_b32 s21, s20, 13
    v_lshrrev_b32 v6, 5, v1
    v_mul_u32_u24 v6, 5120, v6
    v_and_b32 v7, 31, v1
    v_lshl_add_u32 v6, v7, 1, v6
    s_lshr_b32 s66, s20, 2
    s_lshl_b32 s66, s66, 7
    s_and_b32 s67, s20, 3
    s_mul_i32 s67, s67, 5
    s_add_u32 s68, s67, 0
    s_lshr_b32 s24, s68, 2
    s_lshl_b32 s24, s24, 8
    s_bfe_u32 s69, s68, 0x10001
    s_lshl_b32 s69, s69, 6
    s_add_u32 s24, s24, s69
    s_and_b32 s69, s68, 1
    s_mul_i32 s69, s69, 10240
    s_add_u32 s24, s24, s69
    s_add_u32 s24, s24, s66
    s_add_u32 s68, s67, 1
    s_lshr_b32 s25, s68, 2
    s_lshl_b32 s25, s25, 8
    s_bfe_u32 s69, s68, 0x10001
    s_lshl_b32 s69, s69, 6
    s_add_u32 s25, s25, s69
    s_and_b32 s69, s68, 1
    s_mul_i32 s69, s69, 10240
    s_add_u32 s25, s25, s69
    s_add_u32 s25, s25, s66
    s_add_u32 s68, s67, 2
    s_lshr_b32 s26, s68, 2
    s_lshl_b32 s26, s26, 8
    s_bfe_u32 s69, s68, 0x10001
    s_lshl_b32 s69, s69, 6
    s_add_u32 s26, s26, s69
    s_and_b32 s69, s68, 1
    s_mul_i32 s69, s69, 10240
    s_add_u32 s26, s26, s69
    s_add_u32 s26, s26, s66
    s_add_u32 s68, s67, 3
    s_lshr_b32 s27, s68, 2
    s_lshl_b32 s27, s27, 8
    s_bfe_u32 s69, s68, 0x10001
    s_lshl_b32 s69, s69, 6
    s_add_u32 s27, s27, s69
    s_and_b32 s69, s68, 1
    s_mul_i32 s69, s69, 10240
    s_add_u32 s27, s27, s69
    s_add_u32 s27, s27, s66
    s_add_u32 s68, s67, 4
    s_lshr_b32 s28, s68, 2
    s_lshl_b32 s28, s28, 8
    s_bfe_u32 s69, s68, 0x10001
    s_lshl_b32 s69, s69, 6
    s_add_u32 s28, s28, s69
    s_and_b32 s69, s68, 1
    s_mul_i32 s69, s69, 10240
    s_add_u32 s28, s28, s69
    s_add_u32 s28, s28, s66
    v_mov_b32 v96, 0
    v_mov_b32 v97, 0
    v_mov_b32 v98, 0
    v_mov_b32 v99, 0
    v_mov_b32 v100, 0
    v_mov_b32 v101, 0
    v_mov_b32 v102, 0
    v_mov_b32 v103, 0
    v_mov_b32 v104, 0
    v_mov_b32 v105, 0
    v_mov_b32 v106, 0
    v_mov_b32 v107, 0
    v_mov_b32 v108, 0
    v_mov_b32 v109, 0
    v_mov_b32 v110, 0
    v_mov_b32 v111, 0
    v_mov_b32 v112, 0
    v_mov_b32 v113, 0
    v_mov_b32 v114, 0
    v_mov_b32 v115, 0
    v_mov_b32 v180, 0
    v_mov_b32 v181, 0
    v_mov_b32 v182, 0
    v_mov_b32 v183, 0
    s_mov_b32 s16, s70
    s_and_b32 s17, s71, 0xffff
    s_mov_b32 s18, 24165888
    s_mov_b32 s19, 0x20000
    v_lshrrev_b32 v2, 3, v1
    v_lshl_add_u32 v2, s20, 5, v2
    v_and_b32 v91, 7, v1
    v_mul_u32_u24 v94, 384, v2
    v_lshl_add_u32 v94, v91, 4, v94
    v_lshlrev_b32 v93, 2, v2
    v_add_u32 v93, 98304, v93
    v_mul_u32_u24 v92, 32000, v2
    v_lshl_add_u32 v92, v91, 4, v92
    v_mul_u32_u24 v90, 40960, v2
    s_mov_b32 s32, s82
    s_and_b32 s33, s83, 0xffff
    s_mov_b32 s34, 20480
    s_mov_b32 s35, 0x20000
    s_cmp_ge_u32 s20, 5
    s_cbranch_scc1 F_helper
    s_mov_b32 s22, 52429
    s_mov_b32 s23, 0x05040100
    s_mov_b32 s66, 98304
    s_movk_i32 s67, -40
    v_mov_b32 v7, 1
    v_add_u32 v31, 1, v5
    v_add_u32 v32, 2, v5
    v_add_u32 v33, 3, v5
    s_waitcnt vmcnt(3)
    v_mul_u32_u24 v22, s22, v8
    v_mul_u32_u24 v23, s22, v9
    v_mul_u32_u24 v24, s22, v10
    v_mul_u32_u24 v25, s22, v11
    v_lshrrev_b32 v22, 21, v22
    v_lshrrev_b32 v23, 21, v23
    v_lshrrev_b32 v24, 21, v24
    v_lshrrev_b32 v25, 21, v25
    v_lshl_add_u32 v34, v22, 2, s66
    ds_add_rtn_u32 v26, v34, v7
    v_lshl_add_u32 v35, v23, 2, s66
    ds_add_rtn_u32 v27, v35, v7
    v_lshl_add_u32 v36, v24, 2, s66
    ds_add_rtn_u32 v28, v36, v7
    v_lshl_add_u32 v37, v25, 2, s66
    ds_add_rtn_u32 v29, v37, v7
    buffer_load_short_d16_hi v96, v6, s[32:35], s24 offen offset:0
    buffer_load_short_d16_hi v97, v6, s[32:35], s24 offen offset:1280
    buffer_load_short_d16_hi v98, v6, s[32:35], s24 offen offset:2560
    buffer_load_short_d16_hi v99, v6, s[32:35], s24 offen offset:3840
    buffer_load_short_d16_hi v100, v6, s[32:35], s25 offen offset:0
    buffer_load_short_d16_hi v101, v6, s[32:35], s25 offen offset:1280
    buffer_load_short_d16_hi v102, v6, s[32:35], s25 offen offset:2560
    buffer_load_short_d16_hi v103, v6, s[32:35], s25 offen offset:3840
    buffer_load_short_d16_hi v104, v6, s[32:35], s26 offen offset:0
    buffer_load_short_d16_hi v105, v6, s[32:35], s26 offen offset:1280
    buffer_load_short_d16_hi v106, v6, s[32:35], s26 offen offset:2560
    buffer_load_short_d16_hi v107, v6, s[32:35], s26 offen offset:3840
    buffer_load_short_d16_hi v108, v6, s[32:35], s27 offen offset:0
    buffer_load_short_d16_hi v109, v6, s[32:35], s27 offen offset:1280
    buffer_load_short_d16_hi v110, v6, s[32:35], s27 offen offset:2560
    buffer_load_short_d16_hi v111, v6, s[32:35], s27 offen offset:3840
    buffer_load_short_d16_hi v112, v6, s[32:35], s28 offen offset:0
    buffer_load_short_d16_hi v113, v6, s[32:35], s28 offen offset:1280
    buffer_load_short_d16_hi v114, v6, s[32:35], s28 offen offset:2560
    buffer_load_short_d16_hi v115, v6, s[32:35], s28 offen offset:3840
    v_mad_i32_i24 v2, v22, s67, v8
    v_mul_u32_u24 v22, 384, v22
    v_lshl_or_b32 v42, v2, 11, v5
    v_mad_i32_i24 v2, v23, s67, v9
    v_mul_u32_u24 v23, 384, v23
    v_lshl_or_b32 v46, v2, 11, v31
    v_mad_i32_i24 v2, v24, s67, v10
    v_mul_u32_u24 v24, 384, v24
    v_lshl_or_b32 v50, v2, 11, v32
    v_mad_i32_i24 v2, v25, s67, v11
    v_mul_u32_u24 v25, 384, v25
    v_lshl_or_b32 v54, v2, 11, v33
    s_waitcnt vmcnt(20)
    v_mov_b32 v40, v16
    v_perm_b32 v41, v12, v17, s23
    v_alignbit_b32 v44, v18, v17, 16
    v_alignbit_b32 v45, v13, v18, 16
    v_mov_b32 v48, v19
    v_perm_b32 v49, v14, v20, s23
    v_alignbit_b32 v52, v21, v20, 16
    v_alignbit_b32 v53, v15, v21, 16
    v_xor_b32 v41, 0x8000, v41
    v_xor_b32 v45, 0x8000, v45
    v_xor_b32 v49, 0x8000, v49
    v_xor_b32 v53, 0x8000, v53
    s_waitcnt lgkmcnt(0)
    v_min_u32 v26, 23, v26
    v_lshl_add_u32 v34, v26, 4, v22
    ds_write_b128 v34, v[40:43]
    v_min_u32 v27, 23, v27
    v_lshl_add_u32 v35, v27, 4, v23
    ds_write_b128 v35, v[44:47]
    v_min_u32 v28, 23, v28
    v_lshl_add_u32 v36, v28, 4, v24
    ds_write_b128 v36, v[48:51]
    v_min_u32 v29, 23, v29
    v_lshl_add_u32 v37, v29, 4, v25
    ds_write_b128 v37, v[52:55]
    s_branch F_staged
F_helper:
    buffer_load_short_d16_hi v96, v6, s[32:35], s24 offen offset:0
    buffer_load_short_d16_hi v97, v6, s[32:35], s24 offen offset:1280
    buffer_load_short_d16_hi v98, v6, s[32:35], s24 offen offset:2560
    buffer_load_short_d16_hi v99, v6, s[32:35], s24 offen offset:3840
    buffer_load_short_d16_hi v100, v6, s[32:35], s25 offen offset:0
    buffer_load_short_d16_hi v101, v6, s[32:35], s25 offen offset:1280
    buffer_load_short_d16_hi v102, v6, s[32:35], s25 offen offset:2560
    buffer_load_short_d16_hi v103, v6, s[32:35], s25 offen offset:3840
    buffer_load_short_d16_hi v104, v6, s[32:35], s26 offen offset:0
    buffer_load_short_d16_hi v105, v6, s[32:35], s26 offen offset:1280
    buffer_load_short_d16_hi v106, v6, s[32:35], s26 offen offset:2560
    buffer_load_short_d16_hi v107, v6, s[32:35], s26 offen offset:3840
    buffer_load_short_d16_hi v108, v6, s[32:35], s27 offen offset:0
    buffer_load_short_d16_hi v109, v6, s[32:35], s27 offen offset:1280
    buffer_load_short_d16_hi v110, v6, s[32:35], s27 offen offset:2560
    buffer_load_short_d16_hi v111, v6, s[32:35], s27 offen offset:3840
    buffer_load_short_d16_hi v112, v6, s[32:35], s28 offen offset:0
    buffer_load_short_d16_hi v113, v6, s[32:35], s28 offen offset:1280
    buffer_load_short_d16_hi v114, v6, s[32:35], s28 offen offset:2560
    buffer_load_short_d16_hi v115, v6, s[32:35], s28 offen offset:3840
    s_cmp_eq_u32 s20, 6
    s_cbranch_scc0 F_nopf
    s_getpc_b64 s[66:67]
F_pc:
    s_lshr_b32 s68, s2, 3
    s_mul_i32 s68, s68, ((K2_last-F_pc)/128/31+1)*128
    v_lshl_add_u32 v2, v1, 7, s68
    v_min_u32 v2, K2_last-F_pc-4, v2
    v_cmp_gt_u32 vcc, (K2_last-F_pc)/128/31+1, v1
    s_mov_b64 exec, vcc
    global_load_dword v95, v2, s[66:67]
    s_mov_b64 exec, -1
F_nopf:
    s_cmp_eq_u32 s20, 7
    s_cbranch_scc0 F_staged
    s_cmp_lt_u32 s2, 160
    s_cbranch_scc0 F_staged
    s_mul_i32 s22, s2, 3277
    s_lshr_b32 s22, s22, 16
    s_mul_i32 s68, s22, 20
    s_sub_u32 s68, s2, s68
    s_cmp_lt_u32 s68, 8
    s_cselect_b64 s[66:67], s[84:85], s[86:87]
    s_cselect_b32 s23, 0, 8
    s_sub_u32 s68, s68, s23
    s_and_b32 s23, s68, 1
    s_lshr_b32 s68, s68, 1
    s_lshl_b32 s68, s68, 14
    s_lshl_b32 s23, s23, 12
    s_add_u32 s68, s68, s23
    s_lshl_b32 s22, s22, 5
    s_add_u32 s68, s68, s22
    v_lshrrev_b32 v2, 4, v1
    v_lshlrev_b32 v2, 10, v2
    v_and_b32 v3, 15, v1
    v_lshl_add_u32 v2, v3, 1, v2
    v_add_u32 v2, s68, v2
    v_add_u32 v3, 8192, v2
    global_load_ushort v176, v2, s[66:67] offset:0
    global_load_short_d16_hi v180, v3, s[66:67] offset:0
    global_load_ushort v177, v2, s[66:67] offset:256
    global_load_short_d16_hi v181, v3, s[66:67] offset:256
    global_load_ushort v178, v2, s[66:67] offset:512
    global_load_short_d16_hi v182, v3, s[66:67] offset:512
    global_load_ushort v179, v2, s[66:67] offset:768
    global_load_short_d16_hi v183, v3, s[66:67] offset:768
F_staged:
    s_lshl_b32 s66, s2, 7
    s_add_u32 s66, s66, 164864
    s_cmp_eq_u32 s20, 7
    s_cselect_b32 s22, 0xffff, -1
    s_cselect_b32 s23, 0, -1
    s_waitcnt lgkmcnt(0)
    s_add_u32 s88, s88, 1
    s_barrier
    s_setprio 1
    ds_read_b32 v40, v93 offset:0
    ds_read_b128 v[8:11], v94 offset:0
    ds_read_b32 v14, v94 offset:136
    ds_read_b32 v41, v93 offset:32
    ds_read_b128 v[16:19], v94 offset:3072
    ds_read_b32 v22, v94 offset:3208
    ds_read_b32 v42, v93 offset:64
    ds_read_b128 v[24:27], v94 offset:6144
    ds_read_b32 v30, v94 offset:6280
    ds_read_b32 v43, v93 offset:96
    ds_read_b128 v[32:35], v94 offset:9216
    ds_read_b32 v38, v94 offset:9352
    s_add_u32 s28, s66, 0
    s_add_u32 s29, s66, 256000
    s_add_u32 s30, s66, 512000
    s_add_u32 s31, s66, 768000
    s_waitcnt lgkmcnt(9)
    v_min_u32 v5, 31, v40
    v_bfe_u32 v6, v14, 11, 6
    v_and_b32 v10, 0x1ffff, v10
    v_lshl_or_b32 v6, v5, 6, v6
    v_mov_b32 v11, s88
    v_lshl_or_b32 v10, v6, 17, v10
    buffer_store_dwordx4 v[8:11], v92, s[16:19], s28 offen sc1
    s_waitcnt lgkmcnt(6)
    v_min_u32 v5, 31, v41
    v_bfe_u32 v6, v22, 11, 6
    v_and_b32 v18, 0x1ffff, v18
    v_lshl_or_b32 v6, v5, 6, v6
    v_mov_b32 v19, s88
    v_lshl_or_b32 v18, v6, 17, v18
    buffer_store_dwordx4 v[16:19], v92, s[16:19], s29 offen sc1
    s_waitcnt lgkmcnt(3)
    v_min_u32 v5, 31, v42
    v_bfe_u32 v6, v30, 11, 6
    v_and_b32 v26, 0x1ffff, v26
    v_lshl_or_b32 v6, v5, 6, v6
    v_mov_b32 v27, s88
    v_lshl_or_b32 v26, v6, 17, v26
    buffer_store_dwordx4 v[24:27], v92, s[16:19], s30 offen sc1
    s_waitcnt lgkmcnt(0)
    v_min_u32 v5, 31, v43
    v_bfe_u32 v6, v38, 11, 6
    v_and_b32 v34, 0x1ffff, v34
    v_lshl_or_b32 v6, v5, 6, v6
    v_mov_b32 v35, s88
    v_lshl_or_b32 v34, v6, 17, v34
    s_mov_b64 exec, s[22:23]
    buffer_store_dwordx4 v[32:35], v92, s[16:19], s31 offen sc1
    s_mov_b64 exec, -1
    s_setprio 0
    ds_read_b128 v[12:15], v94 offset:128
    ds_read_b128 v[20:23], v94 offset:3200
    ds_read_b128 v[28:31], v94 offset:6272
    ds_read_b128 v[36:39], v94 offset:9344
    s_waitcnt vmcnt(4)
F_now:
    v_cmp_lt_u32 vcc, 8, v40
    s_add_u32 s67, s28, 8000000
    s_waitcnt lgkmcnt(3)
    v_mov_b32 v15, s88
    s_mov_b64 exec, vcc
    s_cbranch_execz F_w0
    buffer_store_dwordx4 v[12:15], v92, s[16:19], s67 offen sc1
    v_cmp_lt_u32 vcc, 16, v40
    s_add_u32 s67, s67, 8000000
    s_mov_b64 exec, vcc
    s_cbranch_execz F_w0
    ds_read_b128 v[44:47], v94 offset:256
    s_waitcnt lgkmcnt(0)
    v_mov_b32 v47, s88
    buffer_store_dwordx4 v[44:47], v92, s[16:19], s67 offen sc1
    s_nop 1
F_w0:
    s_mov_b64 exec, -1
    v_cmp_lt_u32 vcc, 8, v41
    s_add_u32 s67, s29, 8000000
    s_waitcnt lgkmcnt(2)
    v_mov_b32 v23, s88
    s_mov_b64 exec, vcc
    s_cbranch_execz F_w1
    buffer_store_dwordx4 v[20:23], v92, s[16:19], s67 offen sc1
    v_cmp_lt_u32 vcc, 16, v41
    s_add_u32 s67, s67, 8000000
    s_mov_b64 exec, vcc
    s_cbranch_execz F_w1
    ds_read_b128 v[44:47], v94 offset:3328
    s_waitcnt lgkmcnt(0)
    v_mov_b32 v47, s88
    buffer_store_dwordx4 v[44:47], v92, s[16:19], s67 offen sc1
    s_nop 1
F_w1:
    s_mov_b64 exec, -1
    v_cmp_lt_u32 vcc, 8, v42
    s_add_u32 s67, s30, 8000000
    s_waitcnt lgkmcnt(1)
    v_mov_b32 v31, s88
    s_mov_b64 exec, vcc
    s_cbranch_execz F_w2
    buffer_store_dwordx4 v[28:31], v92, s[16:19], s67 offen sc1
    v_cmp_lt_u32 vcc, 16, v42
    s_add_u32 s67, s67, 8000000
    s_mov_b64 exec, vcc
    s_cbranch_execz F_w2
    ds_read_b128 v[44:47], v94 offset:6400
    s_waitcnt lgkmcnt(0)
    v_mov_b32 v47, s88
    buffer_store_dwordx4 v[44:47], v92, s[16:19], s67 offen sc1
    s_nop 1
F_w2:
    s_mov_b64 exec, -1
    v_cmp_lt_u32 vcc, 8, v43
    s_add_u32 s67, s31, 8000000
    s_and_b64 vcc, vcc, s[22:23]
    s_waitcnt lgkmcnt(0)
    v_mov_b32 v39, s88
    s_mov_b64 exec, vcc
    s_cbranch_execz F_w3
    buffer_store_dwordx4 v[36:39], v92, s[16:19], s67 offen sc1
    v_cmp_lt_u32 vcc, 16, v43
    s_add_u32 s67, s67, 8000000
    s_mov_b64 exec, vcc
    s_cbranch_execz F_w3
    ds_read_b128 v[44:47], v94 offset:9472
    s_waitcnt lgkmcnt(0)
    v_mov_b32 v47, s88
    buffer_store_dwordx4 v[44:47], v92, s[16:19], s67 offen sc1
    s_nop 1
F_w3:
    s_mov_b64 exec, -1
    s_cmp_eq_u32 s20, 7
    s_cbranch_scc0 F_nofrag
    s_cmp_lt_u32 s2, 160
    s_cbranch_scc0 F_nofrag
    v_or_b32 v176, v176, v180
    v_or_b32 v177, v177, v181
    v_or_b32 v178, v178, v182
    v_or_b32 v179, v179, v183
    s_lshl_b32 s66, s2, 10
    s_add_u32 s66, s66, 1024
    buffer_store_dwordx4 v[176:179], v86, s[16:19], s66 offen sc1
F_nofrag:
    s_barrier
    s_mul_i32 s24, s2, 32000
    s_lshl_b32 s25, s20, 12
    s_add_u32 s24, s24, s25
    s_add_u32 s24, s24, 164864
    s_add_u32 s25, s24, 8000000
    s_add_u32 s26, s25, 8000000
    v_mov_b32 v22, 0
    v_mov_b32 v23, s88
    s_mul_i32 s68, s20, 5120
    s_cmp_ge_u32 s20, 4
    s_cselect_b32 s70, 45056, 0
    s_add_u32 s68, s68, s70
    v_add_u32 v2, s68, v86
    ds_write_b128 v2, v[96:99] offset:0
    ds_write_b128 v2, v[100:103] offset:1024
    ds_write_b128 v2, v[104:107] offset:2048
    ds_write_b128 v2, v[108:111] offset:3072
    ds_write_b128 v2, v[112:115] offset:4096
    v_mov_b32 v4, 2130738944
    v_mov_b32 v5, 2130738944
    v_mov_b32 v6, 2130738944
    v_mov_b32 v7, 2130738944
    v_lshlrev_b32 v2, 4, v0
    v_add_u32 v3, 86016, v2
    ds_write_b128 v3, v[4:7] offset:0
    ds_write_b128 v3, v[4:7] offset:8192
    ds_write_b128 v3, v[4:7] offset:16384
    ds_write_b128 v3, v[4:7] offset:24576
    ds_write_b128 v3, v[4:7] offset:32768
    ds_write_b128 v3, v[4:7] offset:40960
    ds_write_b128 v3, v[4:7] offset:49152
    ds_write_b128 v3, v[4:7] offset:57344
    v_add_u32 v3, 0x10000, v3
    ds_write_b128 v3, v[4:7] offset:0
    v_min_u32 v2, 3056, v2
    v_add_u32 v2, 159744, v2
    ds_write_b128 v2, v[4:7]
    s_sub_u32 s72, s72, 128
    s_subb_u32 s73, s73, 0
    s_mov_b32 s4, s72
    s_and_b32 s5, s73, 0xffff
    s_mov_b32 s6, 10240000
    s_mov_b32 s7, 0x20000
    s_sub_u32 s72, s72, 1024
    s_subb_u32 s73, s73, 0
    s_mov_b32 s8, s72
    s_and_b32 s9, s73, 0xffff
    s_mov_b32 s10, 10241024
    s_mov_b32 s11, 0x20000
    s_mov_b32 s12, s76
    s_and_b32 s13, s77, 0xffff
    s_mov_b32 s14, 10240000
    s_mov_b32 s15, 0x20000
    v_lshrrev_b32 v2, 5, v1
    v_bfe_u32 v3, v1, 2, 2
    v_and_b32 v4, 3, v1
    v_bfe_u32 v5, v1, 4, 1
    v_lshlrev_b32 v6, 9, v2
    v_lshl_add_u32 v6, v3, 7, v6
    v_lshl_add_u32 v6, v5, 5, v6
    v_lshl_add_u32 v6, v4, 3, v6
    v_lshrrev_b32 v7, 1, v3
    v_lshl_add_u32 v6, v7, 6, v6
    v_add_u32 v244, s21, v6
    v_xor_b32 v245, 64, v244
    v_lshlrev_b32 v6, 7, v2
    v_lshl_add_u32 v6, v7, 5, v6
    v_and_b32 v7, 1, v3
    v_xor_b32 v7, 1, v7
    v_mul_u32_u24 v7, 90112, v7
    v_add_u32 v6, v6, v7
    v_lshl_add_u32 v249, v4, 3, v6
    v_lshl_add_u32 v6, v2, 2, v4
    v_bfe_u32 v7, v1, 2, 1
    v_lshl_add_u32 v6, v7, 3, v6
    v_lshlrev_b32 v6, 3, v6
    v_bfe_u32 v7, v1, 3, 1
    v_add_u32 v5, 1, v5
    v_mul_u32_u24 v7, v7, v5
    v_lshl_add_u32 v250, v7, 1, v6
    v_and_b32 v6, 0x38, v1
    v_add_u32 v247, 4, v6
    v_lshrrev_b32 v6, 2, v1
    v_lshrrev_b32 v7, 4, v1
    v_xor_b32 v6, v6, v7
    v_and_b32 v6, 1, v6
    v_lshlrev_b32 v6, 6, v6
    v_lshl_add_u32 v246, v4, 4, v6
    v_mov_b32 v242, 1.0
    v_mov_b32 v243, 1.0
    s_mov_b32 s54, 0xffffff00
    s_mov_b32 s55, 0xffffff00
    s_mov_b32 s56, 0xffff
    s_mov_b32 s57, 0xffff
    s_mov_b32 s58, 0
    s_mov_b32 s59, 134217856
    s_mov_b32 s60, 262272
    s_mov_b32 s61, 402915456
    s_mov_b32 s62, 940179840
    s_mov_b32 s63, 403046528
    s_mov_b32 s64, 402784384
    s_mov_b32 s65, 134348928
    s_mov_b32 s38, 128
    s_mov_b32 s33, -1
    s_and_b32 s68, s20, 3
    s_lshl_b32 s68, s68, 2
    s_lshr_b32 s69, s20, 2
    s_add_u32 s68, s68, s69
    s_lshl_b32 s68, s68, 4
    s_add_u32 s68, s68, 163072
    v_mov_b32 v251, s68
    s_mov_b32 s53, 0
    s_mov_b32 s50, 0
    s_mov_b32 s51, 0
    s_mov_b32 s47, 0
    s_mov_b32 s42, 0
    s_mov_b32 s3, 0
    s_mov_b32 s89, 0
    s_mov_b32 s34, 128
    s_mov_b32 s35, 384
    s_mov_b32 s36, 640
    s_mov_b32 s37, 896
    s_movk_i32 s3, 1024
    s_waitcnt lgkmcnt(0)
    s_barrier
    buffer_load_dwordx4 v[8:11], v86, s[16:19], s24 offen offset:0 sc1
    buffer_load_dwordx4 v[12:15], v86, s[16:19], s24 offen offset:1024 sc1
    buffer_load_dwordx4 v[16:19], v86, s[16:19], s24 offen offset:2048 sc1
    s_mov_b64 exec, s[22:23]
    buffer_load_dwordx4 v[20:23], v86, s[16:19], s24 offen offset:3072 sc1
    s_mov_b64 exec, -1
    ds_read_b128 v[96:99], v86 offset:0
    ds_read_b128 v[100:103], v86 offset:1024
    ds_read_b128 v[104:107], v86 offset:2048
    ds_read_b128 v[108:111], v86 offset:3072
    ds_read_b128 v[112:115], v86 offset:4096
    ds_read_b128 v[116:119], v86 offset:5120
    ds_read_b128 v[120:123], v86 offset:6144
    ds_read_b128 v[124:127], v86 offset:7168
    ds_read_b128 v[128:131], v86 offset:8192
    ds_read_b128 v[132:135], v86 offset:9216
    ds_read_b128 v[136:139], v86 offset:10240
    ds_read_b128 v[140:143], v86 offset:11264
    ds_read_b128 v[144:147], v86 offset:12288
    ds_read_b128 v[148:151], v86 offset:13312
    ds_read_b128 v[152:155], v86 offset:14336
    ds_read_b128 v[156:159], v86 offset:15360
    ds_read_b128 v[160:163], v86 offset:16384
    ds_read_b128 v[164:167], v86 offset:17408
    ds_read_b128 v[168:171], v86 offset:18432
    ds_read_b128 v[172:175], v86 offset:19456
    s_mov_b32 s27, 32768
    s_mov_b32 s71, 162816
    v_mov_b32 v3, 8
    s_cmp_eq_u32 s20, 7
    s_cselect_b32 s52, 160, 0
    v_cmp_gt_u32 s[68:69], 40, v1
    s_mov_b64 s[28:29], 0xff
    s_lshr_b32 s66, s2, 3
    s_lshl_b32 s66, s66, 3
    s_add_u32 s66, s66, s20
    s_mul_i32 s66, s66, 14
    v_min_u32 v93, 13, v1
    v_add_u32 v93, s66, v93
    v_lshlrev_b32 v93, 10, v93
    v_mov_b32 v94, 0x7f000000
F_poll:
    s_waitcnt vmcnt(0)
F_poll1:
    v_cmp_ne_u32 s[72:73], s88, v11
    v_cmp_ne_u32 s[74:75], s88, v15
    v_cmp_ne_u32 s[76:77], s88, v19
    v_cmp_ne_u32 s[78:79], s88, v23
    s_or_b64 s[80:81], s[72:73], s[74:75]
    s_or_b64 s[82:83], s[76:77], s[78:79]
    s_or_b64 s[80:81], s[80:81], s[82:83]
    s_cbranch_scc1 F_again
F_got:
    v_bfe_u32 v2, v10, 23, 5
    v_bfe_u32 v60, v10, 11, 6
    v_cmp_gt_u32 s[80:81], v2, v91
    v_lshl_add_u32 v60, v60, 2, s71
    v_cmp_lt_u32 s[72:73], 8, v2
    v_max_u32 v89, v89, v2
    s_mov_b64 exec, s[80:81]
    ds_add_rtn_u32 v72, v60, v3
    s_mov_b64 exec, s[72:73]
    s_cbranch_execz F_h0
    buffer_load_dwordx4 v[24:27], v86, s[16:19], s25 offen offset:0 sc1
    v_sub_u32 v56, v2, v91
    v_bfe_u32 v64, v10, 17, 6
    v_cmp_lt_u32 vcc, 8, v56
    v_lshl_add_u32 v64, v64, 2, s71
    s_mov_b64 exec, vcc
    ds_add_rtn_u32 v76, v64, v3
F_h0:
    s_mov_b64 exec, -1
    v_bfe_u32 v2, v14, 23, 5
    v_bfe_u32 v61, v14, 11, 6
    v_cmp_gt_u32 s[82:83], v2, v91
    v_lshl_add_u32 v61, v61, 2, s71
    v_cmp_lt_u32 s[74:75], 8, v2
    v_max_u32 v89, v89, v2
    s_mov_b64 exec, s[82:83]
    ds_add_rtn_u32 v73, v61, v3
    s_mov_b64 exec, s[74:75]
    s_cbranch_execz F_h1
    buffer_load_dwordx4 v[28:31], v86, s[16:19], s25 offen offset:1024 sc1
    v_sub_u32 v57, v2, v91
    v_bfe_u32 v65, v14, 17, 6
    v_cmp_lt_u32 vcc, 8, v57
    v_lshl_add_u32 v65, v65, 2, s71
    s_mov_b64 exec, vcc
    ds_add_rtn_u32 v77, v65, v3
F_h1:
    s_mov_b64 exec, -1
    v_bfe_u32 v2, v18, 23, 5
    v_bfe_u32 v62, v18, 11, 6
    v_cmp_gt_u32 s[84:85], v2, v91
    v_lshl_add_u32 v62, v62, 2, s71
    v_cmp_lt_u32 s[76:77], 8, v2
    v_max_u32 v89, v89, v2
    s_mov_b64 exec, s[84:85]
    ds_add_rtn_u32 v74, v62, v3
    s_mov_b64 exec, s[76:77]
    s_cbranch_execz F_h2
    buffer_load_dwordx4 v[32:35], v86, s[16:19], s25 offen offset:2048 sc1
    v_sub_u32 v58, v2, v91
    v_bfe_u32 v66, v18, 17, 6
    v_cmp_lt_u32 vcc, 8, v58
    v_lshl_add_u32 v66, v66, 2, s71
    s_mov_b64 exec, vcc
    ds_add_rtn_u32 v78, v66, v3
F_h2:
    s_mov_b64 exec, -1
    v_bfe_u32 v2, v22, 23, 5
    v_bfe_u32 v63, v22, 11, 6
    v_cmp_gt_u32 s[86:87], v2, v91
    v_lshl_add_u32 v63, v63, 2, s71
    v_cmp_lt_u32 s[78:79], 8, v2
    v_max_u32 v89, v89, v2
    s_mov_b64 exec, s[86:87]
    ds_add_rtn_u32 v75, v63, v3
    s_mov_b64 exec, s[78:79]
    s_cbranch_execz F_h3
    buffer_load_dwordx4 v[36:39], v86, s[16:19], s25 offen offset:3072 sc1
    v_sub_u32 v59, v2, v91
    v_bfe_u32 v67, v22, 17, 6
    v_cmp_lt_u32 vcc, 8, v59
    v_lshl_add_u32 v67, v67, 2, s71
    s_mov_b64 exec, vcc
    ds_add_rtn_u32 v79, v67, v3
F_h3:
    s_mov_b64 exec, -1
    v_cmp_lt_u32 s[30:31], 16, v89
    s_mov_b32 s27, 262144
    s_cmp_lg_u64 s[30:31], 0
    s_cbranch_scc1 F_l3
F_l3r:
    s_cmp_lt_u32 s2, s52
    s_cbranch_scc1 F_flag
F_flagr:
    s_waitcnt lgkmcnt(0)
    s_barrier
    ds_read_b32 v4, v88
    buffer_load_dword v95, v93, s[4:7], 0 offen offset:128
    v_and_b32 v10, 0x7ff, v10
    v_lshl_add_u32 v10, v10, 5, v90
    v_or_b32 v11, 16, v10
    v_and_b32 v14, 0x7ff, v14
    v_lshl_add_u32 v14, v14, 5, v90
    v_add_u32 v14, 327680, v14
    v_or_b32 v15, 16, v14
    v_and_b32 v18, 0x7ff, v18
    v_lshl_add_u32 v18, v18, 5, v90
    v_add_u32 v18, 655360, v18
    v_or_b32 v19, 16, v18
    v_and_b32 v22, 0x7ff, v22
    v_lshl_add_u32 v22, v22, 5, v90
    v_add_u32 v22, 983040, v22
    v_or_b32 v23, 16, v22
    s_waitcnt lgkmcnt(0)
    v_add_u32 v2, 56, v4
    v_cmp_lt_u32 vcc, 512, v4
    v_lshrrev_b32 v2, 6, v2
    v_max_u32 v2, 2, v2
    s_cmp_lg_u64 vcc, 0
    s_cbranch_scc1 SLOW
    v_med3_u32 v3, v2, 3, 7
    v_cmp_eq_u32 vcc, 7, v2
    v_mad_u32_u24 v3, v3, 6, 14
    v_lshlrev_b32_e64 v6, v3, 1
    v_cndmask_b32 v6, 0, v6, s[68:69]
    v_addc_co_u32 v2, vcc, 0, v2, vcc
    v_mov_b32 v7, v6
    v_add_u32 v5, 1, v2
    v_lshrrev_b32 v5, 1, v5
    v_add_u32_dpp v7, v7, v7 row_shr:1 row_mask:0xf bank_mask:0xf
    v_lshlrev_b32 v92, 22, v5
    v_lshlrev_b32 v5, 18, v5
    v_add_u32_dpp v7, v7, v7 row_shr:2 row_mask:0xf bank_mask:0xf
    v_lshl_or_b32 v5, v1, 21, v5
    v_lshl_or_b32 v5, v2, 28, v5
    v_add_u32_dpp v7, v7, v7 row_shr:4 row_mask:0xf bank_mask:0xf
    s_mov_b32 s26, 86016
    s_mov_b32 s24, 0x2000
    v_add_u32_dpp v7, v7, v7 row_shr:8 row_mask:0xf bank_mask:0xf
    s_nop 1
    v_add_u32_dpp v7, v7, v7 row_bcast:15 row_mask:0xa bank_mask:0xf
    s_nop 1
    v_add_u32_dpp v7, v7, v7 row_bcast:31 row_mask:0xc bank_mask:0xf
    s_nop 0
    v_readlane_b32 s71, v7, 63
    v_sub_u32 v7, v7, v6
    s_lshr_b32 s66, s71, 24
    s_lshr_b32 s67, s71, 6
    s_lshr_b32 s70, s71, 12
    s_lshr_b32 s71, s71, 18
    s_add_u32 s67, s67, s70
    s_add_u32 s71, s71, s66
    s_add_u32 s71, s71, s67
    v_add_u32 v7, s71, v7
    s_bfe_u32 s70, s71, 393222
    v_bfe_u32 v7, v7, v3, 6
    s_bfe_u32 s67, s71, 393228
    v_cndmask_b32 v84, 63, v7, s[68:69]
    s_mul_i32 s68, s70, 3
    v_min_u32 v2, s70, v7
    s_mul_i32 s69, s66, 5
    v_min_u32 v3, s66, v7
    s_add_u32 s68, s68, s69
    v_mul_u32_u24 v7, 12, v7
    s_cmp_gt_u32 s68, 120
    v_mad_u32_u24 v7, v2, 3, v7
    s_cbranch_scc1 SLOW
    v_mad_u32_u24 v7, v3, 5, v7
    v_lshl_add_u32 v7, v7, 7, s26
    v_lshrrev_b32 v6, 3, v7
    v_mad_u32_u24 v92, v7, s24, v92
    v_or_b32 v92, v92, v6
    v_or_b32 v6, v5, v7
    s_add_u32 s71, s70, s66
    s_add_u32 s68, s71, s67
    s_andn2_b32 s70, s70, 3
    s_add_u32 s69, s70, 4
    s_andn2_b32 s67, s67, 3
    v_lshrrev_b32 v3, 1, v84
    v_mov_b32 v2, s68
    v_xor_b32 v3, v3, v84
    v_bfi_b32 v3, 4, v3, v84
    v_cmpx_gt_u32 vcc, s69, v84
    v_mov_b32 v2, s66
    v_cmpx_gt_u32 vcc, s70, v84
    v_mov_b32 v2, s71
    v_cmpx_gt_u32 vcc, s67, v84
    v_mov_b32 v2, 0
    s_mov_b64 exec, -1
    v_add_u32 v2, v2, v84
    v_bfi_b32 v84, 3, v2, v3
    s_lshr_b32 s66, s2, 3
    v_cmp_gt_u32 vcc, 32, v84
    v_add_u32 v2, s66, v84
    v_lshl_add_u32 v2, v2, 3, v84
    v_bfi_b32 v2, 24, v2, v84
    v_cndmask_b32 v84, v84, v2, vcc
    v_subrev_u32 v2, 6, v84
    v_and_b32 v2, 0x80000000, v2
    v_or_b32 v92, v92, v2
    ds_bpermute_b32 v60, v60, v92
    ds_bpermute_b32 v61, v61, v92
    ds_bpermute_b32 v62, v62, v92
    ds_bpermute_b32 v63, v63, v92
    ds_bpermute_b32 v64, v64, v92
    ds_bpermute_b32 v65, v65, v92
    ds_bpermute_b32 v66, v66, v92
    ds_bpermute_b32 v67, v67, v92
    v_cmp_eq_u32 vcc, s20, v84
    s_ff1_i32_b64 s67, vcc
    v_readlane_b32 s71, v6, s67
    s_mov_b32 s22, s71
    s_bfe_u32 s46, s71, 0x30012
    s_mov_b32 m0, s46
    s_and_b32 s66, s71, 0x3ffff
    s_movrels_b32 s68, s57
    s_movrels_b32 s69, s61
    s_sub_u32 s48, s66, s47
    s_mov_b32 s47, s66
    s_lshr_b32 s52, s71, 28
    s_lshl_b32 s67, s46, 9
    s_add_u32 s66, s66, s67
    s_sub_u32 s49, s66, s42
    s_mov_b32 s42, s66
    s_bfe_u32 s66, s68, 655360
    s_add_u32 s43, s42, s66
    s_bfe_u32 s39, s69, 655360
    s_bfe_u32 s66, s68, 655370
    s_add_u32 s44, s42, s66
    s_bfe_u32 s40, s69, 655370
    s_bfe_u32 s66, s68, 655380
    s_add_u32 s45, s42, s66
    s_bfe_u32 s41, s69, 655380
    s_waitcnt lgkmcnt(7)
    v_cmp_gt_i32 vcc, 0, v60
    v_and_b32 v60, 0x7fffffff, v60
    s_and_b64 exec, vcc, s[80:81]
    buffer_load_dword v95, v10, s[12:15], 0 offen
    s_mov_b64 exec, -1
    v_mad_u32_u16 v2, v60, 8, v72
    v_mad_u32_u16 v3, v60, 8, v72 op_sel:[1,0,0,0]
    s_mov_b64 exec, s[80:81]
    ds_write_b64 v2, v[10:11]
    ds_write_b64 v3, v[8:9]
    s_mov_b64 exec, -1
    s_waitcnt lgkmcnt(8)
    v_cmp_gt_i32 vcc, 0, v61
    v_and_b32 v61, 0x7fffffff, v61
    s_and_b64 exec, vcc, s[82:83]
    buffer_load_dword v95, v14, s[12:15], 0 offen
    s_mov_b64 exec, -1
    v_mad_u32_u16 v2, v61, 8, v73
    v_mad_u32_u16 v3, v61, 8, v73 op_sel:[1,0,0,0]
    s_mov_b64 exec, s[82:83]
    ds_write_b64 v2, v[14:15]
    ds_write_b64 v3, v[12:13]
    s_mov_b64 exec, -1
    s_waitcnt lgkmcnt(9)
    v_cmp_gt_i32 vcc, 0, v62
    v_and_b32 v62, 0x7fffffff, v62
    s_and_b64 exec, vcc, s[84:85]
    buffer_load_dword v95, v18, s[12:15], 0 offen
    s_mov_b64 exec, -1
    v_mad_u32_u16 v2, v62, 8, v74
    v_mad_u32_u16 v3, v62, 8, v74 op_sel:[1,0,0,0]
    s_mov_b64 exec, s[84:85]
    ds_write_b64 v2, v[18:19]
    ds_write_b64 v3, v[16:17]
    s_mov_b64 exec, -1
    s_waitcnt lgkmcnt(10)
    v_cmp_gt_i32 vcc, 0, v63
    v_and_b32 v63, 0x7fffffff, v63
    s_and_b64 exec, vcc, s[86:87]
    buffer_load_dword v95, v22, s[12:15], 0 offen
    s_mov_b64 exec, -1
    v_mad_u32_u16 v2, v63, 8, v75
    v_mad_u32_u16 v3, v63, 8, v75 op_sel:[1,0,0,0]
    s_mov_b64 exec, s[86:87]
    ds_write_b64 v2, v[22:23]
    ds_write_b64 v3, v[20:21]
    s_mov_b64 exec, -1
    s_waitcnt vmcnt(5) lgkmcnt(8)
    s_mov_b64 exec, s[72:73]
    s_cbranch_execz F_s0
F_sp0:
    v_cmp_ne_u32 vcc, s88, v27
    s_cbranch_vccnz F_sa0
F_sg0:
    v_cmpx_lt_u32 vcc, 8, v56
    v_and_b32 v26, 0x7ff, v26
    v_lshl_add_u32 v26, v26, 5, v90
    v_or_b32 v27, 16, v26
    v_cmp_gt_i32 vcc, 0, v64
    v_and_b32 v64, 0x7fffffff, v64
    s_and_saveexec_b64 s[82:83], vcc
    s_cbranch_execz F_x0
    buffer_load_dword v95, v26, s[12:15], 0 offen
F_x0:
    s_mov_b64 exec, s[82:83]
    v_mad_u32_u16 v2, v64, 8, v76
    v_mad_u32_u16 v3, v64, 8, v76 op_sel:[1,0,0,0]
    ds_write_b64 v2, v[26:27]
    ds_write_b64 v3, v[24:25]
F_s0:
    s_mov_b64 exec, s[74:75]
    s_cbranch_execz F_s1
F_sp1:
    v_cmp_ne_u32 vcc, s88, v31
    s_cbranch_vccnz F_sa1
F_sg1:
    v_cmpx_lt_u32 vcc, 8, v57
    v_and_b32 v30, 0x7ff, v30
    v_lshl_add_u32 v30, v30, 5, v90
    v_add_u32 v30, 327680, v30
    v_or_b32 v31, 16, v30
    v_cmp_gt_i32 vcc, 0, v65
    v_and_b32 v65, 0x7fffffff, v65
    s_and_saveexec_b64 s[82:83], vcc
    s_cbranch_execz F_x1
    buffer_load_dword v95, v30, s[12:15], 0 offen
F_x1:
    s_mov_b64 exec, s[82:83]
    v_mad_u32_u16 v2, v65, 8, v77
    v_mad_u32_u16 v3, v65, 8, v77 op_sel:[1,0,0,0]
    ds_write_b64 v2, v[30:31]
    ds_write_b64 v3, v[28:29]
F_s1:
    s_mov_b64 exec, s[76:77]
    s_cbranch_execz F_s2
F_sp2:
    v_cmp_ne_u32 vcc, s88, v35
    s_cbranch_vccnz F_sa2
F_sg2:
    v_cmpx_lt_u32 vcc, 8, v58
    v_and_b32 v34, 0x7ff, v34
    v_lshl_add_u32 v34, v34, 5, v90
    v_add_u32 v34, 655360, v34
    v_or_b32 v35, 16, v34
    v_cmp_gt_i32 vcc, 0, v66
    v_and_b32 v66, 0x7fffffff, v66
    s_and_saveexec_b64 s[82:83], vcc
    s_cbranch_execz F_x2
    buffer_load_dword v95, v34, s[12:15], 0 offen
F_x2:
    s_mov_b64 exec, s[82:83]
    v_mad_u32_u16 v2, v66, 8, v78
    v_mad_u32_u16 v3, v66, 8, v78 op_sel:[1,0,0,0]
    ds_write_b64 v2, v[34:35]
    ds_write_b64 v3, v[32:33]
F_s2:
    s_mov_b64 exec, s[78:79]
    s_cbranch_execz F_s3
F_sp3:
    v_cmp_ne_u32 vcc, s88, v39
    s_cbranch_vccnz F_sa3
F_sg3:
    v_cmpx_lt_u32 vcc, 8, v59
    v_and_b32 v38, 0x7ff, v38
    v_lshl_add_u32 v38, v38, 5, v90
    v_add_u32 v38, 983040, v38
    v_or_b32 v39, 16, v38
    v_cmp_gt_i32 vcc, 0, v67
    v_and_b32 v67, 0x7fffffff, v67
    s_and_saveexec_b64 s[82:83], vcc
    s_cbranch_execz F_x3
    buffer_load_dword v95, v38, s[12:15], 0 offen
F_x3:
    s_mov_b64 exec, s[82:83]
    v_mad_u32_u16 v2, v67, 8, v79
    v_mad_u32_u16 v3, v67, 8, v79 op_sel:[1,0,0,0]
    ds_write_b64 v2, v[38:39]
    ds_write_b64 v3, v[36:37]
F_s3:
    s_mov_b64 exec, -1
    s_cmp_lg_u64 s[30:31], 0
    s_cbranch_scc1 F_u
F_ur:
    s_mov_b32 s27, s22
    s_and_b32 s66, s46, s33
    s_cselect_b32 s72, -1, 1
    s_cselect_b32 s76, s47, 163712
    s_cmp_ge_u32 s66, 2
    s_cselect_b32 s73, -1, 0
    s_add_u32 s77, s47, 1024
    s_cmp_ge_u32 s66, 4
    s_cselect_b32 s75, -1, 0
    s_cmp_ge_u32 s66, 3
    s_cselect_b32 s74, -1, 1
    s_cselect_b32 s77, s77, 163712
    s_mul_i32 s66, s20, 80
    v_min_u32 v2, 76, v248
    s_waitcnt lgkmcnt(0)
    s_barrier
    v_add_u32 v253, s47, v248
    ds_read_b32 v254, v253
    ds_read_b32 v255, v253 offset:256
    v_add_u32 v252, s42, v247
    ds_read2_b32 v[234:235], v252 offset0:0 offset1:16
    v_add_u32 v252, s43, v247
    ds_read2_b32 v[236:237], v252 offset0:0 offset1:16
    v_add_u32 v252, s44, v247
    ds_read2_b32 v[238:239], v252 offset0:0 offset1:16
    v_add_u32 v252, s45, v247
    ds_read2_b32 v[240:241], v252 offset0:0 offset1:16
    buffer_load_dword v3, v2, s[16:19], s66 offen offset:128 sc1
    v_add_u32 v249, s48, v249
    v_add_u32 v250, s49, v250
    s_waitcnt lgkmcnt(4)
    s_mov_b32 m0, s76
    s_mov_b64 exec, s[72:73]
    buffer_load_dwordx4 v254, s[12:15], 0 offen  lds
    s_mov_b32 m0, s77
    s_mov_b64 exec, s[74:75]
    buffer_load_dwordx4 v255, s[12:15], 0 offen  lds
    s_mov_b64 exec, -1
    s_waitcnt lgkmcnt(0)
    s_add_u32 m0, s21, 0
    v_mad_u32_u16 v234, v234, s3, v246 op_sel:[1,0,0,0]
    v_mad_u32_u16 v235, v235, s3, v246 op_sel:[1,0,0,0]
    buffer_load_dwordx4 v234, s[4:7], s38 offen  lds
    buffer_load_dwordx4 v235, s[8:11], s38 offen offset:1024  lds
    s_add_u32 m0, s21, 2048
    v_mad_u32_u16 v236, v236, s3, v246 op_sel:[1,0,0,0]
    v_mad_u32_u16 v237, v237, s3, v246 op_sel:[1,0,0,0]
    buffer_load_dwordx4 v236, s[4:7], s39 offen  lds
    buffer_load_dwordx4 v237, s[8:11], s39 offen offset:1024  lds
    s_add_u32 m0, s21, 4096
    v_mad_u32_u16 v238, v238, s3, v246 op_sel:[1,0,0,0]
    v_mad_u32_u16 v239, v239, s3, v246 op_sel:[1,0,0,0]
    buffer_load_dwordx4 v238, s[4:7], s40 offen  lds
    buffer_load_dwordx4 v239, s[8:11], s40 offen offset:1024  lds
    s_add_u32 m0, s21, 6144
    v_mad_u32_u16 v240, v240, s3, v246 op_sel:[1,0,0,0]
    v_mad_u32_u16 v241, v241, s3, v246 op_sel:[1,0,0,0]
    buffer_load_dwordx4 v240, s[4:7], s41 offen  lds
    buffer_load_dwordx4 v241, s[8:11], s41 offen offset:1024  lds
    v_lshrrev_b32 v8, 3, v84
    v_and_b32 v9, 7, v84
    v_lshlrev_b32 v9, 13, v9
    v_mul_u32_u24 v8, 1536, v8
    v_lshlrev_b32 v10, 4, v84
    v_and_b32 v5, 128, v10
    v_add3_u32 v8, v8, v9, v5
    v_xor_b32 v9, v10, v7
    v_and_b32 v9, 128, v9
    v_add_u32 v9, v9, v7
    v_mov_b32 v5, v9
    s_add_u32 s66, s20, 0
    v_cmp_eq_u32 vcc, s66, v84
    s_ff1_i32_b64 s67, vcc
    v_readlane_b32 s28, v5, s67
    s_add_u32 s66, s20, 8
    v_cmp_eq_u32 vcc, s66, v84
    s_ff1_i32_b64 s67, vcc
    v_readlane_b32 s29, v5, s67
    v_readlane_b32 s23, v6, s67
    s_add_u32 s66, s20, 16
    v_cmp_eq_u32 vcc, s66, v84
    s_ff1_i32_b64 s67, vcc
    v_readlane_b32 s30, v5, s67
    v_readlane_b32 s24, v6, s67
    s_add_u32 s66, s20, 24
    v_cmp_eq_u32 vcc, s66, v84
    s_ff1_i32_b64 s67, vcc
    v_readlane_b32 s31, v5, s67
    v_readlane_b32 s25, v6, s67
    s_add_u32 s66, s20, 32
    v_cmp_eq_u32 vcc, s66, v84
    s_ff1_i32_b64 s67, vcc
    v_readlane_b32 s32, v5, s67
    v_readlane_b32 s26, v6, s67
    v_lshlrev_b32 v4, 3, v84
    v_add_u32 v4, 163328, v4
    s_mov_b32 exec_hi, 0xff
    ds_write_b64 v4, v[8:9]
    s_mov_b32 exec_hi, -1
    s_waitcnt lgkmcnt(0)
    v_mov_b32 v252, 0
    s_waitcnt vmcnt(6)
    v_cmp_ne_u32 vcc, s88, v3
    ds_read_b64_tr_b16 v[176:177], v244 offset:0
    ds_read_b64_tr_b16 v[178:179], v244 offset:1024
    ds_read_b64_tr_b16 v[180:181], v245 offset:0
    ds_read_b64_tr_b16 v[182:183], v245 offset:1024
    ds_read_b64_tr_b16 v[72:73], v249 offset:0
    ds_read_b64_tr_b16 v[76:77], v249 offset:64
    ds_read_b64_tr_b16 v[74:75], v249 offset:256
    ds_read_b64_tr_b16 v[78:79], v249 offset:320
    s_mov_b64 exec, s[54:55]
    ds_read_u16_d16_hi v242, v250 offset:0
    s_mov_b64 exec, -1
    s_or_b32 s89, vcc_lo, vcc_hi
    s_add_u32 s53, s53, 4
    s_xor_b32 s66, s53, s20
    s_bitcmp1_b32 s66, 2
    s_setprio 1
    s_cbranch_scc1 PRIO_1
    s_setprio 0
PRIO_1:
    s_cmp_eq_u32 s52, 4
    s_cbranch_scc1 ITEM_0_4
    s_cmp_eq_u32 s52, 5
    s_cbranch_scc1 ITEM_0_5
    s_cmp_eq_u32 s52, 3
    s_cbranch_scc1 ITEM_0_3
    s_cmp_eq_u32 s52, 6
    s_cbranch_scc1 ITEM_0_6
    s_cmp_eq_u32 s52, 8
    s_cbranch_scc1 ITEM_0_8
    s_branch ITEM_0_2
F_again:
    s_sub_u32 s27, s27, 1
    s_cbranch_scc1 F_late
    s_cmp_eq_u64 s[72:73], 0
    s_cbranch_scc1 F_p0
    s_mov_b64 exec, s[72:73]
    buffer_load_dwordx4 v[8:11], v86, s[16:19], s24 offen offset:0 sc1
    s_mov_b64 exec, -1
F_p0:
    s_cmp_eq_u64 s[74:75], 0
    s_cbranch_scc1 F_p1
    s_mov_b64 exec, s[74:75]
    buffer_load_dwordx4 v[12:15], v86, s[16:19], s24 offen offset:1024 sc1
    s_mov_b64 exec, -1
F_p1:
    s_cmp_eq_u64 s[76:77], 0
    s_cbranch_scc1 F_p2
    s_mov_b64 exec, s[76:77]
    buffer_load_dwordx4 v[16:19], v86, s[16:19], s24 offen offset:2048 sc1
    s_mov_b64 exec, -1
F_p2:
    s_cmp_eq_u64 s[78:79], 0
    s_cbranch_scc1 F_p3
    s_mov_b64 exec, s[78:79]
    buffer_load_dwordx4 v[20:23], v86, s[16:19], s24 offen offset:3072 sc1
    s_mov_b64 exec, -1
F_p3:
    s_branch F_poll
F_late:
    v_mov_b32 v2, 163064
    v_mov_b32 v4, 1000
    ds_write_b32 v2, v4
    v_mov_b32 v10, 0
    v_mov_b32 v14, 0
    v_mov_b32 v18, 0
    v_mov_b32 v22, 0
    s_branch F_got
F_l3:
    v_bfe_u32 v2, v10, 23, 5
    v_sub_u32 v56, v2, v91
    v_cmp_lt_u32 vcc, 16, v2
    s_mov_b64 exec, vcc
    s_cbranch_execz F_t0
F_tp0:
    buffer_load_dwordx4 v[40:43], v86, s[16:19], s26 offen offset:0 sc1
    s_waitcnt vmcnt(0)
    v_cmp_ne_u32 vcc, s88, v43
    s_sub_u32 s27, s27, 1
    s_cselect_b64 vcc, 0, vcc
    s_cmp_eq_u64 vcc, 0
    s_cbranch_scc0 F_tp0
    v_bfe_u32 v68, v42, 11, 6
    v_lshl_add_u32 v68, v68, 2, s71
    v_cmp_lt_i32 vcc, 16, v56
    s_mov_b64 exec, vcc
    ds_add_rtn_u32 v80, v68, v3
F_t0:
    s_mov_b64 exec, -1
    v_bfe_u32 v2, v14, 23, 5
    v_sub_u32 v57, v2, v91
    v_cmp_lt_u32 vcc, 16, v2
    s_mov_b64 exec, vcc
    s_cbranch_execz F_t1
F_tp1:
    buffer_load_dwordx4 v[44:47], v86, s[16:19], s26 offen offset:1024 sc1
    s_waitcnt vmcnt(0)
    v_cmp_ne_u32 vcc, s88, v47
    s_sub_u32 s27, s27, 1
    s_cselect_b64 vcc, 0, vcc
    s_cmp_eq_u64 vcc, 0
    s_cbranch_scc0 F_tp1
    v_bfe_u32 v69, v46, 11, 6
    v_lshl_add_u32 v69, v69, 2, s71
    v_cmp_lt_i32 vcc, 16, v57
    s_mov_b64 exec, vcc
    ds_add_rtn_u32 v81, v69, v3
F_t1:
    s_mov_b64 exec, -1
    v_bfe_u32 v2, v18, 23, 5
    v_sub_u32 v58, v2, v91
    v_cmp_lt_u32 vcc, 16, v2
    s_mov_b64 exec, vcc
    s_cbranch_execz F_t2
F_tp2:
    buffer_load_dwordx4 v[48:51], v86, s[16:19], s26 offen offset:2048 sc1
    s_waitcnt vmcnt(0)
    v_cmp_ne_u32 vcc, s88, v51
    s_sub_u32 s27, s27, 1
    s_cselect_b64 vcc, 0, vcc
    s_cmp_eq_u64 vcc, 0
    s_cbranch_scc0 F_tp2
    v_bfe_u32 v70, v50, 11, 6
    v_lshl_add_u32 v70, v70, 2, s71
    v_cmp_lt_i32 vcc, 16, v58
    s_mov_b64 exec, vcc
    ds_add_rtn_u32 v82, v70, v3
F_t2:
    s_mov_b64 exec, -1
    v_bfe_u32 v2, v22, 23, 5
    v_sub_u32 v59, v2, v91
    v_cmp_lt_u32 vcc, 16, v2
    s_mov_b64 exec, vcc
    s_cbranch_execz F_t3
F_tp3:
    buffer_load_dwordx4 v[52:55], v86, s[16:19], s26 offen offset:3072 sc1
    s_waitcnt vmcnt(0)
    v_cmp_ne_u32 vcc, s88, v55
    s_sub_u32 s27, s27, 1
    s_cselect_b64 vcc, 0, vcc
    s_cmp_eq_u64 vcc, 0
    s_cbranch_scc0 F_tp3
    v_bfe_u32 v71, v54, 11, 6
    v_lshl_add_u32 v71, v71, 2, s71
    v_cmp_lt_i32 vcc, 16, v59
    s_mov_b64 exec, vcc
    ds_add_rtn_u32 v83, v71, v3
F_t3:
    s_mov_b64 exec, -1
    v_mov_b32 v2, 163068
    v_mov_b32 v4, 1000
    v_cmp_lt_u32 vcc, 24, v89
    s_mov_b64 exec, vcc
    ds_write_b32 v2, v4
    s_mov_b64 exec, -1
    s_branch F_l3r
F_flag:
    s_lshl_b32 s66, s2, 2
    v_mov_b32 v2, 128
    v_mov_b32 v4, s88
    s_mov_b64 exec, 1
    buffer_store_dword v4, v2, s[16:19], s66 offen sc1
    s_mov_b64 exec, -1
    s_branch F_flagr
F_sa0:
    s_sub_u32 s27, s27, 1
    s_cbranch_scc1 F_sg0
    buffer_load_dwordx4 v[24:27], v86, s[16:19], s25 offen offset:0 sc1
    s_waitcnt vmcnt(0)
    s_branch F_sp0
F_sa1:
    s_sub_u32 s27, s27, 1
    s_cbranch_scc1 F_sg1
    buffer_load_dwordx4 v[28:31], v86, s[16:19], s25 offen offset:1024 sc1
    s_waitcnt vmcnt(0)
    s_branch F_sp1
F_sa2:
    s_sub_u32 s27, s27, 1
    s_cbranch_scc1 F_sg2
    buffer_load_dwordx4 v[32:35], v86, s[16:19], s25 offen offset:2048 sc1
    s_waitcnt vmcnt(0)
    s_branch F_sp2
F_sa3:
    s_sub_u32 s27, s27, 1
    s_cbranch_scc1 F_sg3
    buffer_load_dwordx4 v[36:39], v86, s[16:19], s25 offen offset:3072 sc1
    s_waitcnt vmcnt(0)
    s_branch F_sp3
F_u:
    ds_bpermute_b32 v68, v68, v92
    ds_bpermute_b32 v69, v69, v92
    ds_bpermute_b32 v70, v70, v92
    ds_bpermute_b32 v71, v71, v92
    s_waitcnt lgkmcnt(0)
    v_cmp_lt_i32 vcc, 16, v56
    s_mov_b64 exec, vcc
    s_cbranch_execz F_u0
    v_and_b32 v42, 0x7ff, v42
    v_lshl_add_u32 v42, v42, 5, v90
    v_or_b32 v43, 16, v42
    v_and_b32 v68, 0x7fffffff, v68
    v_mad_u32_u16 v2, v68, 8, v80
    v_mad_u32_u16 v3, v68, 8, v80 op_sel:[1,0,0,0]
    ds_write_b64 v2, v[42:43]
    ds_write_b64 v3, v[40:41]
F_u0:
    s_mov_b64 exec, -1
    v_cmp_lt_i32 vcc, 16, v57
    s_mov_b64 exec, vcc
    s_cbranch_execz F_u1
    v_and_b32 v46, 0x7ff, v46
    v_lshl_add_u32 v46, v46, 5, v90
    v_add_u32 v46, 327680, v46
    v_or_b32 v47, 16, v46
    v_and_b32 v69, 0x7fffffff, v69
    v_mad_u32_u16 v2, v69, 8, v81
    v_mad_u32_u16 v3, v69, 8, v81 op_sel:[1,0,0,0]
    ds_write_b64 v2, v[46:47]
    ds_write_b64 v3, v[44:45]
F_u1:
    s_mov_b64 exec, -1
    v_cmp_lt_i32 vcc, 16, v58
    s_mov_b64 exec, vcc
    s_cbranch_execz F_u2
    v_and_b32 v50, 0x7ff, v50
    v_lshl_add_u32 v50, v50, 5, v90
    v_add_u32 v50, 655360, v50
    v_or_b32 v51, 16, v50
    v_and_b32 v70, 0x7fffffff, v70
    v_mad_u32_u16 v2, v70, 8, v82
    v_mad_u32_u16 v3, v70, 8, v82 op_sel:[1,0,0,0]
    ds_write_b64 v2, v[50:51]
    ds_write_b64 v3, v[48:49]
F_u2:
    s_mov_b64 exec, -1
    v_cmp_lt_i32 vcc, 16, v59
    s_mov_b64 exec, vcc
    s_cbranch_execz F_u3
    v_and_b32 v54, 0x7ff, v54
    v_lshl_add_u32 v54, v54, 5, v90
    v_add_u32 v54, 983040, v54
    v_or_b32 v55, 16, v54
    v_and_b32 v71, 0x7fffffff, v71
    v_mad_u32_u16 v2, v71, 8, v83
    v_mad_u32_u16 v3, v71, 8, v83 op_sel:[1,0,0,0]
    ds_write_b64 v2, v[54:55]
    ds_write_b64 v3, v[52:53]
F_u3:
    s_mov_b64 exec, -1
    s_branch F_ur
LAST0:
    s_cmp_eq_u32 s50, 5
    s_cbranch_scc1 TO_PHASE1
    s_add_u32 s4, s4, 128
    s_addc_u32 s5, s5, 0
    s_add_u32 s8, s8, 128
    s_addc_u32 s9, s9, 0
    s_mov_b32 s34, 0
    s_mov_b32 s35, 256
    s_mov_b32 s36, 512
    s_mov_b32 s37, 768
    s_mov_b32 s33, 0
    s_add_u32 s53, s53, 4
    s_xor_b32 s66, s53, s20
    s_bitcmp1_b32 s66, 2
    s_setprio 1
    s_cbranch_scc1 PRIO_2
    s_setprio 0
PRIO_2:
    s_cmp_eq_u32 s52, 4
    s_cbranch_scc1 ITEM_0_4
    s_cmp_eq_u32 s52, 5
    s_cbranch_scc1 ITEM_0_5
    s_cmp_eq_u32 s52, 3
    s_cbranch_scc1 ITEM_0_3
    s_cmp_eq_u32 s52, 6
    s_cbranch_scc1 ITEM_0_6
    s_cmp_eq_u32 s52, 8
    s_cbranch_scc1 ITEM_0_8
    s_branch ITEM_0_2
TO_PHASE1:
    ds_read_b32 v252, v251 offset:16
    v_lshlrev_b32 v253, 2, v248
    v_add_u32 v253, 65536, v253
    ds_read_b128 v[96:99], v253 offset:0
    ds_read_b128 v[100:103], v253 offset:1024
    ds_read_b128 v[104:107], v253 offset:2048
    ds_read_b128 v[108:111], v253 offset:3072
    ds_read_b128 v[112:115], v253 offset:4096
    ds_read_b128 v[116:119], v253 offset:5120
    ds_read_b128 v[120:123], v253 offset:6144
    ds_read_b128 v[124:127], v253 offset:7168
    ds_read_b128 v[128:131], v253 offset:8192
    ds_read_b128 v[132:135], v253 offset:9216
    ds_read_b128 v[136:139], v253 offset:10240
    ds_read_b128 v[140:143], v253 offset:11264
    ds_read_b128 v[144:147], v253 offset:12288
    ds_read_b128 v[148:151], v253 offset:13312
    ds_read_b128 v[152:155], v253 offset:14336
    ds_read_b128 v[156:159], v253 offset:15360
    ds_read_b128 v[160:163], v253 offset:16384
    ds_read_b128 v[164:167], v253 offset:17408
    ds_read_b128 v[168:171], v253 offset:18432
    ds_read_b128 v[172:175], v253 offset:19456
    s_lshl_b32 s66, s20, 4
    v_xor_b32 v248, s66, v248
    s_mov_b32 s34, 128
    s_mov_b32 s35, 384
    s_mov_b32 s36, 640
    s_mov_b32 s37, 896
    s_mov_b32 s50, 0
    s_mov_b64 vcc, 0
    s_waitcnt lgkmcnt(0)
    s_waitcnt lgkmcnt(0)
    v_readfirstlane_b32 s66, v252
    s_add_u32 s53, s53, 1
    v_mov_b32 v252, s53
    s_cmp_le_u32 s53, s66
    ds_write2_b32 v251, v252, v252 offset0:0 offset1:8
    s_setprio 1
    s_cbranch_scc1 PRIO_3
    s_setprio 0
PRIO_3:
    s_cmp_eq_u32 s52, 4
    s_cbranch_scc1 ITEM_1_4
    s_cmp_eq_u32 s52, 5
    s_cbranch_scc1 ITEM_1_5
    s_cmp_eq_u32 s52, 3
    s_cbranch_scc1 ITEM_1_3
    s_cmp_eq_u32 s52, 6
    s_cbranch_scc1 ITEM_1_6
    s_cmp_eq_u32 s52, 8
    s_cbranch_scc1 ITEM_1_8
    s_branch ITEM_1_2
LAST1:
    s_cmp_eq_u32 s89, 0
    s_cbranch_scc1 T_flagsL
    s_mul_i32 s66, s20, 80
    v_min_u32 v2, 76, v248
    s_mov_b32 s67, 262144
T_pollL:
    buffer_load_dword v3, v2, s[16:19], s66 offen offset:128 sc1
    s_waitcnt vmcnt(0)
    v_cmp_ne_u32 vcc, s88, v3
    s_sub_u32 s67, s67, 1
    s_cselect_b64 vcc, 0, vcc
    s_cmp_eq_u64 vcc, 0
    s_cbranch_scc0 T_pollL
    s_mov_b32 s89, 0
T_flagsL:
    s_lshl_b32 s66, s20, 4
    v_xor_b32 v246, s66, v248
    v_lshlrev_b32 v246, 2, v246
    s_mul_i32 s51, s20, 20480
    s_add_u32 s51, s51, 1024
    s_mov_b64 vcc, -1
    s_load_dwordx2 s[72:73], s[0:1], 72
    s_waitcnt lgkmcnt(7)
    v_readfirstlane_b32 s66, v252
    s_add_u32 s53, s53, 1
    v_mov_b32 v252, s53
    s_cmp_le_u32 s53, s66
    ds_write2_b32 v251, v252, v252 offset0:0 offset1:8
    s_setprio 3
    s_cbranch_scc1 PRIO_4
    s_setprio 2
PRIO_4:
    s_cmp_eq_u32 s52, 4
    s_cbranch_scc1 ITEM_1_4
    s_cmp_eq_u32 s52, 5
    s_cbranch_scc1 ITEM_1_5
    s_cmp_eq_u32 s52, 3
    s_cbranch_scc1 ITEM_1_3
    s_cmp_eq_u32 s52, 6
    s_cbranch_scc1 ITEM_1_6
    s_cmp_eq_u32 s52, 8
    s_cbranch_scc1 ITEM_1_8
    s_branch ITEM_1_2
.p2align 6
ITEM_0_4:
    s_mov_b64 exec, s[54:55]
    ds_read_u16_d16_hi v243, v250 offset:128
    s_mov_b64 exec, -1
    ds_read_b64_tr_b16 v[80:81], v249 offset:512
    ds_read_b64_tr_b16 v[84:85], v249 offset:576
    ds_read_b64_tr_b16 v[82:83], v249 offset:768
    ds_read_b64_tr_b16 v[86:87], v249 offset:832
    s_waitcnt lgkmcnt(5)
    v_mul_f32_dpp v196, v242, v72 row_newbcast:0 row_mask:0xf bank_mask:0xf
    v_mul_f32_dpp v197, v242, v73 row_newbcast:1 row_mask:0xf bank_mask:0xf
    v_mul_f32_dpp v198, v242, v72 row_newbcast:8 row_mask:0xf bank_mask:0xf
    v_mul_f32_dpp v199, v242, v73 row_newbcast:9 row_mask:0xf bank_mask:0xf
    v_mul_f32_dpp v200, v242, v76 row_newbcast:2 row_mask:0xf bank_mask:0xf
    v_mul_f32_dpp v201, v242, v77 row_newbcast:3 row_mask:0xf bank_mask:0xf
    v_mul_f32_dpp v202, v242, v76 row_newbcast:10 row_mask:0xf bank_mask:0xf
    v_mul_f32_dpp v203, v242, v77 row_newbcast:11 row_mask:0xf bank_mask:0xf
    v_cvt_pk_bf16_f32 v72, v196, v197
    v_cvt_pk_bf16_f32 v76, v198, v199
    v_cvt_pk_bf16_f32 v73, v200, v201
    v_cvt_pk_bf16_f32 v77, v202, v203
    v_mul_f32_dpp v196, v242, v74 row_newbcast:4 row_mask:0xf bank_mask:0xf
    v_mul_f32_dpp v197, v242, v75 row_newbcast:5 row_mask:0xf bank_mask:0xf
    v_mul_f32_dpp v198, v242, v74 row_newbcast:12 row_mask:0xf bank_mask:0xf
    v_mul_f32_dpp v199, v242, v75 row_newbcast:13 row_mask:0xf bank_mask:0xf
    v_mul_f32_dpp v200, v242, v78 row_newbcast:6 row_mask:0xf bank_mask:0xf
    v_mul_f32_dpp v201, v242, v79 row_newbcast:7 row_mask:0xf bank_mask:0xf
    v_mul_f32_dpp v202, v242, v78 row_newbcast:14 row_mask:0xf bank_mask:0xf
    v_mul_f32_dpp v203, v242, v79 row_newbcast:15 row_mask:0xf bank_mask:0xf
    v_cvt_pk_bf16_f32 v74, v196, v197
    v_cvt_pk_bf16_f32 v78, v198, v199
    v_cvt_pk_bf16_f32 v75, v200, v201
    v_cvt_pk_bf16_f32 v79, v202, v203
    s_waitcnt vmcnt(4) lgkmcnt(0)
    v_mfma_f32_32x32x16_bf16 v[56:71], v[72:75], v[176:179], 0
    v_mul_f32_dpp v196, v243, v80 row_newbcast:0 row_mask:0xf bank_mask:0xf
    v_mul_f32_dpp v197, v243, v81 row_newbcast:1 row_mask:0xf bank_mask:0xf
    v_mul_f32_dpp v198, v243, v80 row_newbcast:8 row_mask:0xf bank_mask:0xf
    v_mul_f32_dpp v199, v243, v81 row_newbcast:9 row_mask:0xf bank_mask:0xf
    v_mul_f32_dpp v200, v243, v84 row_newbcast:2 row_mask:0xf bank_mask:0xf
    v_mul_f32_dpp v201, v243, v85 row_newbcast:3 row_mask:0xf bank_mask:0xf
    s_add_u32 m0, s21, 0
    v_mfma_f32_32x32x16_bf16 v[16:31], v[76:79], v[176:179], 0
    buffer_load_dwordx4 v234, s[4:7], s36 offen  lds
    buffer_load_dwordx4 v235, s[8:11], s36 offen offset:1024  lds
    ds_read_b64_tr_b16 v[176:177], v244 offset:2048
    ds_read_b64_tr_b16 v[178:179], v244 offset:3072
    ds_read_b64_tr_b16 v[184:185], v245 offset:2048
    ds_read_b64_tr_b16 v[186:187], v245 offset:3072
    v_mul_f32_dpp v202, v243, v84 row_newbcast:10 row_mask:0xf bank_mask:0xf
    v_mul_f32_dpp v203, v243, v85 row_newbcast:11 row_mask:0xf bank_mask:0xf
    v_cvt_pk_bf16_f32 v80, v196, v197
    v_cvt_pk_bf16_f32 v84, v198, v199
    v_cvt_pk_bf16_f32 v81, v200, v201
    v_cvt_pk_bf16_f32 v85, v202, v203
    v_mul_f32_dpp v196, v243, v82 row_newbcast:4 row_mask:0xf bank_mask:0xf
    v_mul_f32_dpp v197, v243, v83 row_newbcast:5 row_mask:0xf bank_mask:0xf
    v_mul_f32_dpp v198, v243, v82 row_newbcast:12 row_mask:0xf bank_mask:0xf
    v_mul_f32_dpp v199, v243, v83 row_newbcast:13 row_mask:0xf bank_mask:0xf
    v_mul_f32_dpp v200, v243, v86 row_newbcast:6 row_mask:0xf bank_mask:0xf
    v_mul_f32_dpp v201, v243, v87 row_newbcast:7 row_mask:0xf bank_mask:0xf
    v_mul_f32_dpp v202, v243, v86 row_newbcast:14 row_mask:0xf bank_mask:0xf
    v_mul_f32_dpp v203, v243, v87 row_newbcast:15 row_mask:0xf bank_mask:0xf
    v_cvt_pk_bf16_f32 v82, v196, v197
    v_cvt_pk_bf16_f32 v86, v198, v199
    v_cvt_pk_bf16_f32 v83, v200, v201
    v_cvt_pk_bf16_f32 v87, v202, v203
    s_waitcnt lgkmcnt(0)
    v_mfma_f32_32x32x16_bf16 v[56:71], v[80:83], v[176:179], v[56:71]
    s_add_u32 m0, s21, 2048
    v_mfma_f32_32x32x16_bf16 v[16:31], v[84:87], v[176:179], v[16:31]
    buffer_load_dwordx4 v236, s[4:7], s36 offen  lds
    buffer_load_dwordx4 v237, s[8:11], s36 offen offset:1024  lds
    s_mov_b32 m0, s50
    s_nop 0
    s_movrels_b32 s71, s23
    s_bfe_u32 s46, s71, 0x30012
    s_mov_b32 m0, s46
    s_and_b32 s66, s71, 0x3ffff
    s_movrels_b32 s68, s57
    s_movrels_b32 s69, s61
    s_sub_u32 s48, s66, s47
    s_mov_b32 s47, s66
    s_lshr_b32 s52, s71, 28
    s_lshl_b32 s67, s46, 9
    s_add_u32 s66, s66, s67
    s_sub_u32 s49, s66, s42
    s_mov_b32 s42, s66
    s_bfe_u32 s66, s68, 655360
    s_add_u32 s43, s42, s66
    s_bfe_u32 s39, s69, 655360
    s_bfe_u32 s66, s68, 655370
    s_add_u32 s44, s42, s66
    s_bfe_u32 s40, s69, 655370
    s_bfe_u32 s66, s68, 655380
    s_add_u32 s45, s42, s66
    s_bfe_u32 s41, s69, 655380
    s_and_b32 s66, s46, s33
    s_cselect_b32 s72, -1, 1
    s_cselect_b32 s76, s47, 163712
    s_cmp_ge_u32 s66, 2
    s_cselect_b32 s73, -1, 0
    s_add_u32 s77, s47, 1024
    s_cmp_ge_u32 s66, 4
    s_cselect_b32 s75, -1, 0
    s_cmp_ge_u32 s66, 3
    s_cselect_b32 s74, -1, 1
    s_cselect_b32 s77, s77, 163712
    v_add_u32 v252, s44, v247
    ds_read2_b32 v[238:239], v252 offset0:0 offset1:16
    v_add_u32 v252, s45, v247
    ds_read2_b32 v[240:241], v252 offset0:0 offset1:16
    v_mfma_f32_32x32x16_bf16 v[32:47], v[72:75], v[180:183], 0
    v_mul_f32 v196, v56, v96
    v_fmac_f32 v196, v57, v97
    v_fmac_f32 v196, v58, v98
    v_fmac_f32 v196, v59, v99
    v_fmac_f32 v196, v60, v100
    v_fmac_f32 v196, v61, v101
    v_mfma_f32_32x32x16_bf16 v[0:15], v[76:79], v[180:183], 0
    s_waitcnt vmcnt(6)
    ds_read_b64_tr_b16 v[176:177], v244 offset:4096
    ds_read_b64_tr_b16 v[178:179], v244 offset:5120
    ds_read_b64_tr_b16 v[180:181], v245 offset:4096
    ds_read_b64_tr_b16 v[182:183], v245 offset:5120
    v_fmac_f32 v196, v62, v102
    v_fmac_f32 v196, v63, v103
    v_mfma_f32_32x32x16_bf16 v[32:47], v[80:83], v[184:187], v[32:47]
    v_mul_f32 v198, v64, v128
    v_fmac_f32 v198, v65, v129
    v_fmac_f32 v198, v66, v130
    v_fmac_f32 v198, v67, v131
    v_fmac_f32 v198, v68, v132
    v_fmac_f32 v198, v69, v133
    v_mfma_f32_32x32x16_bf16 v[0:15], v[84:87], v[184:187], v[0:15]
    v_fmac_f32 v198, v70, v134
    v_fmac_f32 v198, v71, v135
    v_mul_f32 v200, v16, v128
    v_fmac_f32 v200, v17, v129
    v_permlane32_swap_b32 v196, v198
    v_fmac_f32 v200, v18, v130
    v_fmac_f32 v200, v19, v131
    v_fmac_f32 v200, v20, v132
    v_fmac_f32 v200, v21, v133
    v_fmac_f32 v200, v22, v134
    v_fmac_f32 v200, v23, v135
    v_add_f32 v198, v196, v198
    v_mul_f32_e64 v202, v24, -v128
    v_fma_f32 v202, v25, -v129, v202
    v_fma_f32 v202, v26, -v130, v202
    v_fma_f32 v202, v27, -v131, v202
    v_fma_f32 v202, v28, -v132, v202
    v_fma_f32 v202, v29, -v133, v202
    v_fma_f32 v202, v30, -v134, v202
    v_fma_f32 v202, v31, -v135, v202
    s_nop 1
    v_permlane32_swap_b32 v200, v202
    v_add_f32 v202, v200, v202
    s_waitcnt vmcnt(4) lgkmcnt(0)
    v_mfma_f32_32x32x16_bf16 v[56:71], v[72:75], v[176:179], 0
    v_mul_f32 v197, v32, v104
    v_fmac_f32 v197, v33, v105
    v_fmac_f32 v197, v34, v106
    v_fmac_f32 v197, v35, v107
    v_fmac_f32 v197, v36, v108
    v_fmac_f32 v197, v37, v109
    s_add_u32 m0, s21, 4096
    v_mfma_f32_32x32x16_bf16 v[16:31], v[76:79], v[176:179], 0
    buffer_load_dwordx4 v234, s[4:7], s37 offen  lds
    buffer_load_dwordx4 v235, s[8:11], s37 offen offset:1024  lds
    ds_read_b64_tr_b16 v[176:177], v244 offset:6144
    ds_read_b64_tr_b16 v[178:179], v244 offset:7168
    ds_read_b64_tr_b16 v[184:185], v245 offset:6144
    ds_read_b64_tr_b16 v[186:187], v245 offset:7168
    v_add_u32 v252, s42, v247
    ds_read2_b32 v[234:235], v252 offset0:0 offset1:16
    v_fmac_f32 v197, v38, v110
    v_fmac_f32 v197, v39, v111
    v_mul_f32 v199, v40, v136
    v_fmac_f32 v199, v41, v137
    v_fmac_f32 v199, v42, v138
    v_fmac_f32 v199, v43, v139
    v_fmac_f32 v199, v44, v140
    v_fmac_f32 v199, v45, v141
    v_fmac_f32 v199, v46, v142
    v_fmac_f32 v199, v47, v143
    v_mul_f32 v201, v0, v136
    v_fmac_f32 v201, v1, v137
    v_permlane32_swap_b32 v197, v199
    v_fmac_f32 v201, v2, v138
    v_fmac_f32 v201, v3, v139
    v_fmac_f32 v201, v4, v140
    v_fmac_f32 v201, v5, v141
    v_fmac_f32 v201, v6, v142
    v_fmac_f32 v201, v7, v143
    v_add_f32 v199, v197, v199
    v_mul_f32_e64 v203, v8, -v136
    v_fma_f32 v203, v9, -v137, v203
    v_fma_f32 v203, v10, -v138, v203
    v_fma_f32 v203, v11, -v139, v203
    s_waitcnt lgkmcnt(1)
    v_mfma_f32_32x32x16_bf16 v[56:71], v[80:83], v[176:179], v[56:71]
    v_fma_f32 v203, v12, -v140, v203
    v_fma_f32 v203, v13, -v141, v203
    v_fma_f32 v203, v14, -v142, v203
    v_fma_f32 v203, v15, -v143, v203
    s_nop 1
    v_permlane32_swap_b32 v201, v203
    v_add_f32 v203, v201, v203
    s_add_u32 m0, s21, 6144
    v_mfma_f32_32x32x16_bf16 v[16:31], v[84:87], v[176:179], v[16:31]
    buffer_load_dwordx4 v236, s[4:7], s37 offen  lds
    buffer_load_dwordx4 v237, s[8:11], s37 offen offset:1024  lds
    v_add_u32 v252, s43, v247
    ds_read2_b32 v[236:237], v252 offset0:0 offset1:16
    s_set_gpr_idx_on s51, gpr_idx(DST)
    s_nop 0
    v_cvt_pk_bf16_f32 v204, v198, v199
    v_cvt_pk_bf16_f32 v205, v202, v203
    s_set_gpr_idx_off
    v_mfma_f32_32x32x16_bf16 v[32:47], v[72:75], v[180:183], 0
    v_mul_f32 v196, v56, v144
    v_fmac_f32 v196, v57, v145
    v_fmac_f32 v196, v58, v146
    v_fmac_f32 v196, v59, v147
    v_fmac_f32 v196, v60, v148
    v_fmac_f32 v196, v61, v149
    v_mfma_f32_32x32x16_bf16 v[0:15], v[76:79], v[180:183], 0
    s_waitcnt vmcnt(6)
    ds_read_b64_tr_b16 v[176:177], v244 offset:0
    ds_read_b64_tr_b16 v[178:179], v244 offset:1024
    ds_read_b64_tr_b16 v[180:181], v245 offset:0
    ds_read_b64_tr_b16 v[182:183], v245 offset:1024
    v_fmac_f32 v196, v62, v150
    v_fmac_f32 v196, v63, v151
    v_mfma_f32_32x32x16_bf16 v[32:47], v[80:83], v[184:187], v[32:47]
    v_mul_f32_e64 v200, v16, -v160
    v_fma_f32 v200, v17, -v161, v200
    v_fma_f32 v200, v18, -v162, v200
    v_fma_f32 v200, v19, -v163, v200
    v_fma_f32 v200, v20, -v164, v200
    v_fma_f32 v200, v21, -v165, v200
    v_mfma_f32_32x32x16_bf16 v[0:15], v[84:87], v[184:187], v[0:15]
    v_fma_f32 v200, v22, -v166, v200
    v_fma_f32 v200, v23, -v167, v200
    v_mul_f32_e64 v202, v24, -v160
    v_fma_f32 v202, v25, -v161, v202
    v_fma_f32 v202, v26, -v162, v202
    v_fma_f32 v202, v27, -v163, v202
    v_fma_f32 v202, v28, -v164, v202
    v_fma_f32 v202, v29, -v165, v202
    v_fma_f32 v202, v30, -v166, v202
    v_fma_f32 v202, v31, -v167, v202
    s_waitcnt vmcnt(4) lgkmcnt(0)
    v_mfma_f32_32x32x16_bf16 v[16:31], v[72:75], v[176:179], 0
    v_mul_f32 v197, v32, v152
    v_fmac_f32 v197, v33, v153
    v_fmac_f32 v197, v34, v154
    v_fmac_f32 v197, v35, v155
    v_fmac_f32 v197, v36, v156
    v_fmac_f32 v197, v37, v157
    s_add_u32 m0, s21, 0
    v_mfma_f32_32x32x16_bf16 v[48:63], v[76:79], v[176:179], 0
    v_mad_u32_u16 v234, v234, s3, v246 op_sel:[1,0,0,0]
    v_mad_u32_u16 v235, v235, s3, v246 op_sel:[1,0,0,0]
    buffer_load_dwordx4 v234, s[4:7], s38 offen  lds
    buffer_load_dwordx4 v235, s[8:11], s38 offen offset:1024  lds
    ds_read_b64_tr_b16 v[176:177], v244 offset:2048
    ds_read_b64_tr_b16 v[178:179], v244 offset:3072
    ds_read_b64_tr_b16 v[184:185], v245 offset:2048
    ds_read_b64_tr_b16 v[186:187], v245 offset:3072
    v_fmac_f32 v197, v38, v158
    v_fmac_f32 v197, v39, v159
    v_mul_f32_e64 v201, v0, -v168
    v_fma_f32 v201, v1, -v169, v201
    v_fma_f32 v201, v2, -v170, v201
    v_fma_f32 v201, v3, -v171, v201
    v_fma_f32 v201, v4, -v172, v201
    v_fma_f32 v201, v5, -v173, v201
    v_fma_f32 v201, v6, -v174, v201
    v_fma_f32 v201, v7, -v175, v201
    s_waitcnt lgkmcnt(0)
    v_mfma_f32_32x32x16_bf16 v[16:31], v[80:83], v[176:179], v[16:31]
    v_mul_f32_e64 v203, v8, -v168
    v_fma_f32 v203, v9, -v169, v203
    v_fma_f32 v203, v10, -v170, v203
    v_fma_f32 v203, v11, -v171, v203
    v_fma_f32 v203, v12, -v172, v203
    v_fma_f32 v203, v13, -v173, v203
    s_add_u32 m0, s21, 2048
    v_mfma_f32_32x32x16_bf16 v[48:63], v[84:87], v[176:179], v[48:63]
    v_mad_u32_u16 v236, v236, s3, v246 op_sel:[1,0,0,0]
    v_mad_u32_u16 v237, v237, s3, v246 op_sel:[1,0,0,0]
    buffer_load_dwordx4 v236, s[4:7], s39 offen  lds
    buffer_load_dwordx4 v237, s[8:11], s39 offen offset:1024  lds
    v_fma_f32 v203, v14, -v174, v203
    v_fma_f32 v203, v15, -v175, v203
    v_mfma_f32_32x32x16_bf16 v[0:15], v[72:75], v[180:183], 0
    v_fmac_f32 v200, v24, v160
    v_fmac_f32 v200, v25, v161
    v_fmac_f32 v200, v26, v162
    v_fmac_f32 v200, v27, v163
    v_fmac_f32 v200, v28, v164
    v_fmac_f32 v200, v29, v165
    v_fmac_f32 v200, v30, v166
    v_fmac_f32 v200, v31, v167
    v_mfma_f32_32x32x16_bf16 v[24:39], v[76:79], v[180:183], 0
    v_add_u32 v253, s47, v248
    ds_read_b32 v192, v253
    ds_read_b32 v193, v253 offset:256
    s_waitcnt vmcnt(6)
    ds_read_b64_tr_b16 v[176:177], v244 offset:4096
    ds_read_b64_tr_b16 v[178:179], v244 offset:5120
    ds_read_b64_tr_b16 v[180:181], v245 offset:4096
    ds_read_b64_tr_b16 v[182:183], v245 offset:5120
    v_mfma_f32_32x32x16_bf16 v[24:39], v[84:87], v[184:187], v[24:39]
    v_mul_f32 v254, v16, v144
    v_fmac_f32 v254, v17, v145
    v_fmac_f32 v254, v18, v146
    v_fmac_f32 v254, v19, v147
    v_fmac_f32 v254, v20, v148
    v_fmac_f32 v254, v21, v149
    v_mfma_f32_32x32x16_bf16 v[0:15], v[80:83], v[184:187], v[0:15]
    v_fmac_f32 v254, v22, v150
    v_fmac_f32 v254, v23, v151
    v_sub_f32_e64 v64, -v48, v64
    v_sub_f32_e64 v65, -v49, v65
    v_permlane32_swap_b32 v196, v254
    v_sub_f32_e64 v66, -v50, v66
    v_sub_f32_e64 v67, -v51, v67
    v_sub_f32_e64 v68, -v52, v68
    v_sub_f32_e64 v69, -v53, v69
    v_sub_f32_e64 v70, -v54, v70
    v_sub_f32_e64 v71, -v55, v71
    v_add_f32 v254, v196, v254
    s_waitcnt vmcnt(4) lgkmcnt(0)
    v_mfma_f32_32x32x16_bf16 v[56:71], v[76:79], v[176:179], v[56:71]
    v_sub_f32_e64 v40, -v24, v40
    v_sub_f32_e64 v41, -v25, v41
    v_sub_f32_e64 v42, -v26, v42
    v_sub_f32_e64 v43, -v27, v43
    v_sub_f32_e64 v44, -v28, v44
    v_sub_f32_e64 v45, -v29, v45
    v_sub_f32_e64 v46, -v30, v46
    v_sub_f32_e64 v47, -v31, v47
    s_mov_b32 m0, s76
    s_mov_b64 exec, s[72:73]
    buffer_load_dwordx4 v192, s[12:15], 0 offen  lds
    s_mov_b32 m0, s77
    s_mov_b64 exec, s[74:75]
    buffer_load_dwordx4 v193, s[12:15], 0 offen  lds
    s_mov_b64 exec, -1
    s_add_u32 m0, s21, 4096
    v_mfma_f32_32x32x16_bf16 v[16:31], v[72:75], v[176:179], 0
    v_mad_u32_u16 v238, v238, s3, v246 op_sel:[1,0,0,0]
    v_mad_u32_u16 v239, v239, s3, v246 op_sel:[1,0,0,0]
    buffer_load_dwordx4 v238, s[4:7], s40 offen  lds
    buffer_load_dwordx4 v239, s[8:11], s40 offen offset:1024  lds
    ds_read_b64_tr_b16 v[176:177], v244 offset:6144
    ds_read_b64_tr_b16 v[178:179], v244 offset:7168
    ds_read_b64_tr_b16 v[184:185], v245 offset:6144
    ds_read_b64_tr_b16 v[186:187], v245 offset:7168
    v_mul_f32 v255, v0, v152
    v_fmac_f32 v255, v1, v153
    v_fmac_f32 v255, v2, v154
    v_fmac_f32 v255, v3, v155
    v_fmac_f32 v255, v4, v156
    v_fmac_f32 v255, v5, v157
    v_fmac_f32 v255, v6, v158
    v_fmac_f32 v255, v7, v159
    v_fmac_f32 v201, v8, v168
    v_fmac_f32 v201, v9, v169
    v_permlane32_swap_b32 v197, v255
    s_waitcnt lgkmcnt(0)
    v_mfma_f32_32x32x16_bf16 v[16:31], v[80:83], v[176:179], v[16:31]
    v_fmac_f32 v201, v10, v170
    v_fmac_f32 v201, v11, v171
    v_fmac_f32 v201, v12, v172
    v_fmac_f32 v201, v13, v173
    v_fmac_f32 v201, v14, v174
    v_fmac_f32 v201, v15, v175
    s_add_u32 m0, s21, 6144
    v_mfma_f32_32x32x16_bf16 v[56:71], v[84:87], v[176:179], v[56:71]
    v_mad_u32_u16 v240, v240, s3, v246 op_sel:[1,0,0,0]
    v_mad_u32_u16 v241, v241, s3, v246 op_sel:[1,0,0,0]
    buffer_load_dwordx4 v240, s[4:7], s41 offen  lds
    buffer_load_dwordx4 v241, s[8:11], s41 offen offset:1024  lds
    v_add_f32 v255, v197, v255
    s_set_gpr_idx_on s51, gpr_idx(DST)
    s_nop 0
    v_cvt_pk_bf16_f32 v206, v254, v255
    s_set_gpr_idx_off
    v_mfma_f32_32x32x16_bf16 v[0:15], v[72:75], v[180:183], 0
    v_mul_f32 v254, v16, v144
    v_fmac_f32 v254, v17, v145
    v_fmac_f32 v254, v18, v146
    v_fmac_f32 v254, v19, v147
    v_fmac_f32 v254, v20, v148
    v_fmac_f32 v254, v21, v149
    v_mfma_f32_32x32x16_bf16 v[32:47], v[76:79], v[180:183], v[32:47]
    s_waitcnt vmcnt(8)
    ds_read_b64_tr_b16 v[176:177], v244 offset:0
    ds_read_b64_tr_b16 v[178:179], v244 offset:1024
    ds_read_b64_tr_b16 v[180:181], v245 offset:0
    ds_read_b64_tr_b16 v[182:183], v245 offset:1024
    v_fmac_f32 v254, v22, v150
    v_fmac_f32 v254, v23, v151
    v_mfma_f32_32x32x16_bf16 v[0:15], v[80:83], v[184:187], v[0:15]
    v_fma_f32 v202, v24, -v160, v202
    v_fma_f32 v202, v25, -v161, v202
    v_permlane32_swap_b32 v254, v200
    v_fma_f32 v202, v26, -v162, v202
    v_fma_f32 v202, v27, -v163, v202
    v_fma_f32 v202, v28, -v164, v202
    v_mfma_f32_32x32x16_bf16 v[32:47], v[84:87], v[184:187], v[32:47]
    v_add_u32 v249, s48, v249
    v_add_u32 v250, s49, v250
    v_fma_f32 v202, v29, -v165, v202
    v_fma_f32 v202, v30, -v166, v202
    v_fma_f32 v202, v31, -v167, v202
    v_add_f32 v200, v254, v200
    v_mul_f32_e64 v198, v64, -v112
    v_permlane32_swap_b32 v202, v254
    v_fma_f32 v198, v65, -v113, v198
    v_fma_f32 v198, v66, -v114, v198
    v_fma_f32 v198, v67, -v115, v198
    v_fma_f32 v198, v68, -v116, v198
    v_fma_f32 v198, v69, -v117, v198
    v_fma_f32 v198, v70, -v118, v198
    v_fma_f32 v198, v71, -v119, v198
    v_add_f32 v254, v202, v254
    v_mul_f32 v196, v56, v160
    v_fmac_f32 v196, v57, v161
    v_fmac_f32 v196, v58, v162
    v_fmac_f32 v196, v59, v163
    v_fmac_f32 v196, v60, v164
    v_fmac_f32 v196, v61, v165
    v_fmac_f32 v196, v62, v166
    v_fmac_f32 v196, v63, v167
    s_nop 1
    v_permlane32_swap_b32 v198, v196
    v_add_f32 v196, v198, v196
    v_mul_f32 v255, v0, v152
    v_fmac_f32 v255, v1, v153
    v_fmac_f32 v255, v2, v154
    v_fmac_f32 v255, v3, v155
    v_fmac_f32 v255, v4, v156
    v_fmac_f32 v255, v5, v157
    v_fmac_f32 v255, v6, v158
    v_fmac_f32 v255, v7, v159
    v_fma_f32 v203, v8, -v168, v203
    v_fma_f32 v203, v9, -v169, v203
    v_permlane32_swap_b32 v255, v201
    v_fma_f32 v203, v10, -v170, v203
    v_fma_f32 v203, v11, -v171, v203
    v_fma_f32 v203, v12, -v172, v203
    v_fma_f32 v203, v13, -v173, v203
    v_fma_f32 v203, v14, -v174, v203
    v_fma_f32 v203, v15, -v175, v203
    v_add_f32 v201, v255, v201
    v_mul_f32_e64 v199, v40, -v120
    v_permlane32_swap_b32 v203, v255
    v_fma_f32 v199, v41, -v121, v199
    v_fma_f32 v199, v42, -v122, v199
    v_fma_f32 v199, v43, -v123, v199
    s_waitcnt vmcnt(4)
    ds_read_b64_tr_b16 v[72:73], v249 offset:0
    ds_read_b64_tr_b16 v[76:77], v249 offset:64
    ds_read_b64_tr_b16 v[74:75], v249 offset:256
    ds_read_b64_tr_b16 v[78:79], v249 offset:320
    s_mov_b64 exec, s[54:55]
    ds_read_u16_d16_hi v242, v250 offset:0
    s_mov_b64 exec, -1
    v_fma_f32 v199, v44, -v124, v199
    v_fma_f32 v199, v45, -v125, v199
    v_fma_f32 v199, v46, -v126, v199
    v_fma_f32 v199, v47, -v127, v199
    v_add_f32 v255, v203, v255
    v_mul_f32 v197, v32, v168
    v_fmac_f32 v197, v33, v169
    v_fmac_f32 v197, v34, v170
    v_fmac_f32 v197, v35, v171
    v_fmac_f32 v197, v36, v172
    v_fmac_f32 v197, v37, v173
    v_fmac_f32 v197, v38, v174
    v_fmac_f32 v197, v39, v175
    s_nop 1
    v_permlane32_swap_b32 v199, v197
    v_add_f32 v197, v199, v197
    s_set_gpr_idx_on s51, gpr_idx(DST)
    s_nop 0
    v_cvt_pk_bf16_f32 v207, v200, v201
    v_cvt_pk_bf16_f32 v209, v254, v255
    v_cvt_pk_bf16_f32 v208, v196, v197
    s_set_gpr_idx_off
    s_add_u32 s50, s50, 1
    s_add_u32 s51, s51, 6
    s_cmp_ge_u32 s50, 4
    s_cbranch_scc1 LAST0
    s_add_u32 s53, s53, 4
    s_xor_b32 s66, s53, s20
    s_bitcmp1_b32 s66, 2
    s_setprio 1
    s_cbranch_scc1 PRIO_5
    s_setprio 0
PRIO_5:
    s_cmp_eq_u32 s52, 4
    s_cbranch_scc1 ITEM_0_4
    s_cmp_eq_u32 s52, 5
    s_cbranch_scc1 ITEM_0_5
    s_cmp_eq_u32 s52, 3
    s_cbranch_scc1 ITEM_0_3
    s_cmp_eq_u32 s52, 6
    s_cbranch_scc1 ITEM_0_6
    s_cmp_eq_u32 s52, 8
    s_cbranch_scc1 ITEM_0_8
    s_branch ITEM_0_2
.p2align 6
ITEM_0_5:
    s_mov_b64 exec, s[54:55]
    ds_read_u16_d16_hi v243, v250 offset:128
    s_mov_b64 exec, -1
    ds_read_b64_tr_b16 v[80:81], v249 offset:512
    ds_read_b64_tr_b16 v[84:85], v249 offset:576
    ds_read_b64_tr_b16 v[82:83], v249 offset:768
    ds_read_b64_tr_b16 v[86:87], v249 offset:832
    ds_read_b64_tr_b16 v[88:89], v249 offset:1024
    ds_read_b64_tr_b16 v[92:93], v249 offset:1088
    s_waitcnt lgkmcnt(7)
    v_mul_f32_dpp v196, v242, v72 row_newbcast:0 row_mask:0xf bank_mask:0xf
    v_mul_f32_dpp v197, v242, v73 row_newbcast:1 row_mask:0xf bank_mask:0xf
    v_mul_f32_dpp v198, v242, v72 row_newbcast:8 row_mask:0xf bank_mask:0xf
    v_mul_f32_dpp v199, v242, v73 row_newbcast:9 row_mask:0xf bank_mask:0xf
    v_mul_f32_dpp v200, v242, v76 row_newbcast:2 row_mask:0xf bank_mask:0xf
    v_mul_f32_dpp v201, v242, v77 row_newbcast:3 row_mask:0xf bank_mask:0xf
    v_mul_f32_dpp v202, v242, v76 row_newbcast:10 row_mask:0xf bank_mask:0xf
    v_mul_f32_dpp v203, v242, v77 row_newbcast:11 row_mask:0xf bank_mask:0xf
    v_cvt_pk_bf16_f32 v72, v196, v197
    v_cvt_pk_bf16_f32 v76, v198, v199
    v_cvt_pk_bf16_f32 v73, v200, v201
    v_cvt_pk_bf16_f32 v77, v202, v203
    v_mul_f32_dpp v196, v242, v74 row_newbcast:4 row_mask:0xf bank_mask:0xf
    v_mul_f32_dpp v197, v242, v75 row_newbcast:5 row_mask:0xf bank_mask:0xf
    v_mul_f32_dpp v198, v242, v74 row_newbcast:12 row_mask:0xf bank_mask:0xf
    v_mul_f32_dpp v199, v242, v75 row_newbcast:13 row_mask:0xf bank_mask:0xf
    v_mul_f32_dpp v200, v242, v78 row_newbcast:6 row_mask:0xf bank_mask:0xf
    v_mul_f32_dpp v201, v242, v79 row_newbcast:7 row_mask:0xf bank_mask:0xf
    v_mul_f32_dpp v202, v242, v78 row_newbcast:14 row_mask:0xf bank_mask:0xf
    v_mul_f32_dpp v203, v242, v79 row_newbcast:15 row_mask:0xf bank_mask:0xf
    v_cvt_pk_bf16_f32 v74, v196, v197
    v_cvt_pk_bf16_f32 v78, v198, v199
    v_cvt_pk_bf16_f32 v75, v200, v201
    v_cvt_pk_bf16_f32 v79, v202, v203
    s_mov_b64 exec, s[54:55]
    ds_read_u16_d16_hi v242, v250 offset:256
    s_mov_b64 exec, -1
    s_waitcnt vmcnt(4) lgkmcnt(3)
    v_mfma_f32_32x32x16_bf16 v[56:71], v[72:75], v[176:179], 0
    v_mul_f32_dpp v196, v243, v80 row_newbcast:0 row_mask:0xf bank_mask:0xf
    v_mul_f32_dpp v197, v243, v81 row_newbcast:1 row_mask:0xf bank_mask:0xf
    v_mul_f32_dpp v198, v243, v80 row_newbcast:8 row_mask:0xf bank_mask:0xf
    v_mul_f32_dpp v199, v243, v81 row_newbcast:9 row_mask:0xf bank_mask:0xf
    v_mul_f32_dpp v200, v243, v84 row_newbcast:2 row_mask:0xf bank_mask:0xf
    v_mul_f32_dpp v201, v243, v85 row_newbcast:3 row_mask:0xf bank_mask:0xf
    s_add_u32 m0, s21, 0
    v_mfma_f32_32x32x16_bf16 v[16:31], v[76:79], v[176:179], 0
    buffer_load_dwordx4 v236, s[4:7], s35 offen  lds
    buffer_load_dwordx4 v237, s[8:11], s35 offen offset:1024  lds
    ds_read_b64_tr_b16 v[176:177], v244 offset:2048
    ds_read_b64_tr_b16 v[178:179], v244 offset:3072
    ds_read_b64_tr_b16 v[184:185], v245 offset:2048
    ds_read_b64_tr_b16 v[186:187], v245 offset:3072
    v_mul_f32_dpp v202, v243, v84 row_newbcast:10 row_mask:0xf bank_mask:0xf
    v_mul_f32_dpp v203, v243, v85 row_newbcast:11 row_mask:0xf bank_mask:0xf
    v_cvt_pk_bf16_f32 v80, v196, v197
    v_cvt_pk_bf16_f32 v84, v198, v199
    v_cvt_pk_bf16_f32 v81, v200, v201
    v_cvt_pk_bf16_f32 v85, v202, v203
    v_mul_f32_dpp v196, v243, v82 row_newbcast:4 row_mask:0xf bank_mask:0xf
    v_mul_f32_dpp v197, v243, v83 row_newbcast:5 row_mask:0xf bank_mask:0xf
    v_mul_f32_dpp v198, v243, v82 row_newbcast:12 row_mask:0xf bank_mask:0xf
    v_mul_f32_dpp v199, v243, v83 row_newbcast:13 row_mask:0xf bank_mask:0xf
    v_mul_f32_dpp v200, v243, v86 row_newbcast:6 row_mask:0xf bank_mask:0xf
    v_mul_f32_dpp v201, v243, v87 row_newbcast:7 row_mask:0xf bank_mask:0xf
    v_mul_f32_dpp v202, v243, v86 row_newbcast:14 row_mask:0xf bank_mask:0xf
    v_mul_f32_dpp v203, v243, v87 row_newbcast:15 row_mask:0xf bank_mask:0xf
    v_cvt_pk_bf16_f32 v82, v196, v197
    v_cvt_pk_bf16_f32 v86, v198, v199
    v_cvt_pk_bf16_f32 v83, v200, v201
    v_cvt_pk_bf16_f32 v87, v202, v203
    s_waitcnt vmcnt(4) lgkmcnt(0)
    v_mfma_f32_32x32x16_bf16 v[56:71], v[80:83], v[176:179], v[56:71]
    v_mul_f32_dpp v196, v242, v88 row_newbcast:0 row_mask:0xf bank_mask:0xf
    v_mul_f32_dpp v197, v242, v89 row_newbcast:1 row_mask:0xf bank_mask:0xf
    v_mul_f32_dpp v198, v242, v88 row_newbcast:8 row_mask:0xf bank_mask:0xf
    v_mul_f32_dpp v199, v242, v89 row_newbcast:9 row_mask:0xf bank_mask:0xf
    v_mul_f32_dpp v200, v242, v92 row_newbcast:2 row_mask:0xf bank_mask:0xf
    v_mul_f32_dpp v201, v242, v93 row_newbcast:3 row_mask:0xf bank_mask:0xf
    s_add_u32 m0, s21, 2048
    v_mfma_f32_32x32x16_bf16 v[16:31], v[84:87], v[176:179], v[16:31]
    buffer_load_dwordx4 v238, s[4:7], s35 offen  lds
    ds_read_b64_tr_b16 v[176:177], v244 offset:4096
    ds_read_b64_tr_b16 v[188:189], v245 offset:4096
    v_mul_f32_dpp v202, v242, v92 row_newbcast:10 row_mask:0xf bank_mask:0xf
    v_mul_f32_dpp v203, v242, v93 row_newbcast:11 row_mask:0xf bank_mask:0xf
    v_cvt_pk_bf16_f32 v88, v196, v197
    v_cvt_pk_bf16_f32 v92, v198, v199
    v_cvt_pk_bf16_f32 v89, v200, v201
    v_cvt_pk_bf16_f32 v93, v202, v203
    s_waitcnt lgkmcnt(0)
    v_mfma_f32_32x32x8_bf16 v[56:71], v[88:89], v[176:177], v[56:71]
    s_add_u32 m0, s21, 4096
    v_mfma_f32_32x32x8_bf16 v[16:31], v[92:93], v[176:177], v[16:31]
    buffer_load_dwordx4 v234, s[4:7], s36 offen  lds
    buffer_load_dwordx4 v235, s[8:11], s36 offen offset:1024  lds
    s_mov_b32 m0, s50
    s_nop 0
    s_movrels_b32 s71, s23
    s_bfe_u32 s46, s71, 0x30012
    s_mov_b32 m0, s46
    s_and_b32 s66, s71, 0x3ffff
    s_movrels_b32 s68, s57
    s_movrels_b32 s69, s61
    s_sub_u32 s48, s66, s47
    s_mov_b32 s47, s66
    s_lshr_b32 s52, s71, 28
    s_lshl_b32 s67, s46, 9
    s_add_u32 s66, s66, s67
    s_sub_u32 s49, s66, s42
    s_mov_b32 s42, s66
    s_bfe_u32 s66, s68, 655360
    s_add_u32 s43, s42, s66
    s_bfe_u32 s39, s69, 655360
    s_bfe_u32 s66, s68, 655370
    s_add_u32 s44, s42, s66
    s_bfe_u32 s40, s69, 655370
    s_bfe_u32 s66, s68, 655380
    s_add_u32 s45, s42, s66
    s_bfe_u32 s41, s69, 655380
    s_and_b32 s66, s46, s33
    s_cselect_b32 s72, -1, 1
    s_cselect_b32 s76, s47, 163712
    s_cmp_ge_u32 s66, 2
    s_cselect_b32 s73, -1, 0
    s_add_u32 s77, s47, 1024
    s_cmp_ge_u32 s66, 4
    s_cselect_b32 s75, -1, 0
    s_cmp_ge_u32 s66, 3
    s_cselect_b32 s74, -1, 1
    s_cselect_b32 s77, s77, 163712
    v_add_u32 v252, s45, v247
    ds_read2_b32 v[240:241], v252 offset0:0 offset1:16
    v_mfma_f32_32x32x16_bf16 v[32:47], v[72:75], v[180:183], 0
    v_mul_f32 v196, v56, v96
    v_fmac_f32 v196, v57, v97
    v_fmac_f32 v196, v58, v98
    v_fmac_f32 v196, v59, v99
    v_fmac_f32 v196, v60, v100
    v_fmac_f32 v196, v61, v101
    v_mfma_f32_32x32x16_bf16 v[0:15], v[76:79], v[180:183], 0
    v_fmac_f32 v196, v62, v102
    v_fmac_f32 v196, v63, v103
    v_mul_f32 v198, v64, v128
    v_fmac_f32 v198, v65, v129
    v_fmac_f32 v198, v66, v130
    v_fmac_f32 v198, v67, v131
    v_mfma_f32_32x32x16_bf16 v[32:47], v[80:83], v[184:187], v[32:47]
    v_fmac_f32 v198, v68, v132
    v_fmac_f32 v198, v69, v133
    v_fmac_f32 v198, v70, v134
    v_fmac_f32 v198, v71, v135
    v_mul_f32 v200, v16, v128
    v_fmac_f32 v200, v17, v129
    v_mfma_f32_32x32x16_bf16 v[0:15], v[84:87], v[184:187], v[0:15]
    s_waitcnt vmcnt(5)
    ds_read_b64_tr_b16 v[176:177], v244 offset:6144
    ds_read_b64_tr_b16 v[178:179], v244 offset:7168
    ds_read_b64_tr_b16 v[180:181], v245 offset:6144
    ds_read_b64_tr_b16 v[182:183], v245 offset:7168
    v_permlane32_swap_b32 v196, v198
    v_fmac_f32 v200, v18, v130
    v_mfma_f32_32x32x8_bf16 v[32:47], v[88:89], v[188:189], v[32:47]
    v_fmac_f32 v200, v19, v131
    v_fmac_f32 v200, v20, v132
    v_fmac_f32 v200, v21, v133
    v_fmac_f32 v200, v22, v134
    v_fmac_f32 v200, v23, v135
    v_add_f32 v198, v196, v198
    v_mfma_f32_32x32x8_bf16 v[0:15], v[92:93], v[188:189], v[0:15]
    v_mul_f32_e64 v202, v24, -v128
    v_fma_f32 v202, v25, -v129, v202
    v_fma_f32 v202, v26, -v130, v202
    v_fma_f32 v202, v27, -v131, v202
    v_fma_f32 v202, v28, -v132, v202
    v_fma_f32 v202, v29, -v133, v202
    v_fma_f32 v202, v30, -v134, v202
    v_fma_f32 v202, v31, -v135, v202
    s_nop 1
    v_permlane32_swap_b32 v200, v202
    v_add_f32 v202, v200, v202
    s_waitcnt vmcnt(3) lgkmcnt(0)
    v_mfma_f32_32x32x16_bf16 v[56:71], v[72:75], v[176:179], 0
    v_mul_f32 v197, v32, v104
    v_fmac_f32 v197, v33, v105
    v_fmac_f32 v197, v34, v106
    v_fmac_f32 v197, v35, v107
    v_fmac_f32 v197, v36, v108
    v_fmac_f32 v197, v37, v109
    s_add_u32 m0, s21, 6144
    v_mfma_f32_32x32x16_bf16 v[16:31], v[76:79], v[176:179], 0
    buffer_load_dwordx4 v236, s[4:7], s36 offen  lds
    buffer_load_dwordx4 v237, s[8:11], s36 offen offset:1024  lds
    ds_read_b64_tr_b16 v[176:177], v244 offset:0
    ds_read_b64_tr_b16 v[178:179], v244 offset:1024
    ds_read_b64_tr_b16 v[184:185], v245 offset:0
    ds_read_b64_tr_b16 v[186:187], v245 offset:1024
    v_fmac_f32 v197, v38, v110
    v_fmac_f32 v197, v39, v111
    v_mul_f32 v199, v40, v136
    v_fmac_f32 v199, v41, v137
    v_fmac_f32 v199, v42, v138
    v_fmac_f32 v199, v43, v139
    v_fmac_f32 v199, v44, v140
    v_fmac_f32 v199, v45, v141
    v_fmac_f32 v199, v46, v142
    v_fmac_f32 v199, v47, v143
    v_mul_f32 v201, v0, v136
    v_fmac_f32 v201, v1, v137
    v_permlane32_swap_b32 v197, v199
    v_fmac_f32 v201, v2, v138
    v_fmac_f32 v201, v3, v139
    s_waitcnt vmcnt(4) lgkmcnt(0)
    v_mfma_f32_32x32x16_bf16 v[56:71], v[80:83], v[176:179], v[56:71]
    v_fmac_f32 v201, v4, v140
    v_fmac_f32 v201, v5, v141
    v_fmac_f32 v201, v6, v142
    v_fmac_f32 v201, v7, v143
    v_add_f32 v199, v197, v199
    v_mul_f32_e64 v203, v8, -v136
    s_add_u32 m0, s21, 0
    v_mfma_f32_32x32x16_bf16 v[16:31], v[84:87], v[176:179], v[16:31]
    buffer_load_dwordx4 v238, s[4:7], s36 offen  lds
    ds_read_b64_tr_b16 v[176:177], v244 offset:2048
    ds_read_b64_tr_b16 v[188:189], v245 offset:2048
    v_fma_f32 v203, v9, -v137, v203
    v_fma_f32 v203, v10, -v138, v203
    v_fma_f32 v203, v11, -v139, v203
    s_waitcnt lgkmcnt(0)
    v_mfma_f32_32x32x8_bf16 v[56:71], v[88:89], v[176:177], v[56:71]
    v_fma_f32 v203, v12, -v140, v203
    v_fma_f32 v203, v13, -v141, v203
    v_fma_f32 v203, v14, -v142, v203
    v_fma_f32 v203, v15, -v143, v203
    s_nop 1
    v_permlane32_swap_b32 v201, v203
    v_add_f32 v203, v201, v203
    s_add_u32 m0, s21, 2048
    v_mfma_f32_32x32x8_bf16 v[16:31], v[92:93], v[176:177], v[16:31]
    buffer_load_dwordx4 v234, s[4:7], s37 offen  lds
    buffer_load_dwordx4 v235, s[8:11], s37 offen offset:1024  lds
    v_add_u32 v252, s42, v247
    ds_read2_b32 v[234:235], v252 offset0:0 offset1:16
    s_set_gpr_idx_on s51, gpr_idx(DST)
    s_nop 0
    v_cvt_pk_bf16_f32 v204, v198, v199
    v_cvt_pk_bf16_f32 v205, v202, v203
    s_set_gpr_idx_off
    v_mfma_f32_32x32x16_bf16 v[32:47], v[72:75], v[180:183], 0
    v_mul_f32 v196, v56, v144
    v_fmac_f32 v196, v57, v145
    v_fmac_f32 v196, v58, v146
    v_fmac_f32 v196, v59, v147
    v_fmac_f32 v196, v60, v148
    v_fmac_f32 v196, v61, v149
    v_mfma_f32_32x32x16_bf16 v[0:15], v[76:79], v[180:183], 0
    v_fmac_f32 v196, v62, v150
    v_fmac_f32 v196, v63, v151
    v_mul_f32_e64 v200, v16, -v160
    v_fma_f32 v200, v17, -v161, v200
    v_fma_f32 v200, v18, -v162, v200
    v_fma_f32 v200, v19, -v163, v200
    v_mfma_f32_32x32x16_bf16 v[32:47], v[80:83], v[184:187], v[32:47]
    v_fma_f32 v200, v20, -v164, v200
    v_fma_f32 v200, v21, -v165, v200
    v_fma_f32 v200, v22, -v166, v200
    v_fma_f32 v200, v23, -v167, v200
    v_mul_f32_e64 v202, v24, -v160
    v_fma_f32 v202, v25, -v161, v202
    v_mfma_f32_32x32x16_bf16 v[0:15], v[84:87], v[184:187], v[0:15]
    s_waitcnt vmcnt(5)
    ds_read_b64_tr_b16 v[176:177], v244 offset:4096
    ds_read_b64_tr_b16 v[178:179], v244 offset:5120
    ds_read_b64_tr_b16 v[180:181], v245 offset:4096
    ds_read_b64_tr_b16 v[182:183], v245 offset:5120
    v_fma_f32 v202, v26, -v162, v202
    v_fma_f32 v202, v27, -v163, v202
    v_mfma_f32_32x32x8_bf16 v[32:47], v[88:89], v[188:189], v[32:47]
    v_fma_f32 v202, v28, -v164, v202
    v_fma_f32 v202, v29, -v165, v202
    v_fma_f32 v202, v30, -v166, v202
    v_fma_f32 v202, v31, -v167, v202
    v_mfma_f32_32x32x8_bf16 v[0:15], v[92:93], v[188:189], v[0:15]
    s_waitcnt vmcnt(3) lgkmcnt(0)
    v_mfma_f32_32x32x16_bf16 v[16:31], v[72:75], v[176:179], 0
    s_nop 4
    v_mul_f32 v197, v32, v152
    v_fmac_f32 v197, v33, v153
    v_fmac_f32 v197, v34, v154
    v_fmac_f32 v197, v35, v155
    v_fmac_f32 v197, v36, v156
    v_fmac_f32 v197, v37, v157
    s_add_u32 m0, s21, 4096
    v_mfma_f32_32x32x16_bf16 v[48:63], v[76:79], v[176:179], 0
    buffer_load_dwordx4 v236, s[4:7], s37 offen  lds
    buffer_load_dwordx4 v237, s[8:11], s37 offen offset:1024  lds
    ds_read_b64_tr_b16 v[176:177], v244 offset:6144
    ds_read_b64_tr_b16 v[178:179], v244 offset:7168
    ds_read_b64_tr_b16 v[184:185], v245 offset:6144
    ds_read_b64_tr_b16 v[186:187], v245 offset:7168
    v_add_u32 v252, s43, v247
    ds_read2_b32 v[236:237], v252 offset0:0 offset1:16
    v_fmac_f32 v197, v38, v158
    v_fmac_f32 v197, v39, v159
    v_mul_f32_e64 v201, v0, -v168
    s_waitcnt vmcnt(4) lgkmcnt(1)
    v_mfma_f32_32x32x16_bf16 v[16:31], v[80:83], v[176:179], v[16:31]
    v_fma_f32 v201, v1, -v169, v201
    v_fma_f32 v201, v2, -v170, v201
    v_fma_f32 v201, v3, -v171, v201
    v_fma_f32 v201, v4, -v172, v201
    v_fma_f32 v201, v5, -v173, v201
    v_fma_f32 v201, v6, -v174, v201
    s_add_u32 m0, s21, 6144
    v_mfma_f32_32x32x16_bf16 v[48:63], v[84:87], v[176:179], v[48:63]
    buffer_load_dwordx4 v238, s[4:7], s37 offen  lds
    ds_read_b64_tr_b16 v[176:177], v244 offset:0
    ds_read_b64_tr_b16 v[188:189], v245 offset:0
    v_add_u32 v252, s44, v247
    ds_read2_b32 v[238:239], v252 offset0:0 offset1:16
    v_fma_f32 v201, v7, -v175, v201
    s_waitcnt lgkmcnt(1)
    v_mfma_f32_32x32x8_bf16 v[16:31], v[88:89], v[176:177], v[16:31]
    v_mul_f32_e64 v203, v8, -v168
    v_fma_f32 v203, v9, -v169, v203
    v_fma_f32 v203, v10, -v170, v203
    v_fma_f32 v203, v11, -v171, v203
    v_fma_f32 v203, v12, -v172, v203
    v_fma_f32 v203, v13, -v173, v203
    s_add_u32 m0, s21, 0
    v_mfma_f32_32x32x8_bf16 v[48:63], v[92:93], v[176:177], v[48:63]
    v_mad_u32_u16 v234, v234, s3, v246 op_sel:[1,0,0,0]
    v_mad_u32_u16 v235, v235, s3, v246 op_sel:[1,0,0,0]
    buffer_load_dwordx4 v234, s[4:7], s38 offen  lds
    buffer_load_dwordx4 v235, s[8:11], s38 offen offset:1024  lds
    v_fma_f32 v203, v14, -v174, v203
    v_fma_f32 v203, v15, -v175, v203
    v_mfma_f32_32x32x16_bf16 v[0:15], v[72:75], v[180:183], 0
    v_fmac_f32 v200, v24, v160
    v_fmac_f32 v200, v25, v161
    v_fmac_f32 v200, v26, v162
    v_fmac_f32 v200, v27, v163
    v_fmac_f32 v200, v28, v164
    v_fmac_f32 v200, v29, v165
    v_fmac_f32 v200, v30, v166
    v_fmac_f32 v200, v31, v167
    v_mfma_f32_32x32x16_bf16 v[24:39], v[76:79], v[180:183], 0
    v_add_u32 v253, s47, v248
    ds_read_b32 v192, v253
    ds_read_b32 v193, v253 offset:256
    v_mul_f32 v254, v16, v144
    v_fmac_f32 v254, v17, v145
    v_fmac_f32 v254, v18, v146
    v_mfma_f32_32x32x16_bf16 v[0:15], v[80:83], v[184:187], v[0:15]
    v_fmac_f32 v254, v19, v147
    v_fmac_f32 v254, v20, v148
    v_fmac_f32 v254, v21, v149
    v_fmac_f32 v254, v22, v150
    v_fmac_f32 v254, v23, v151
    v_sub_f32_e64 v64, -v48, v64
    v_mfma_f32_32x32x16_bf16 v[24:39], v[84:87], v[184:187], v[24:39]
    s_waitcnt vmcnt(5)
    ds_read_b64_tr_b16 v[176:177], v244 offset:2048
    ds_read_b64_tr_b16 v[178:179], v244 offset:3072
    ds_read_b64_tr_b16 v[180:181], v245 offset:2048
    ds_read_b64_tr_b16 v[182:183], v245 offset:3072
    v_sub_f32_e64 v65, -v49, v65
    v_permlane32_swap_b32 v196, v254
    v_mfma_f32_32x32x8_bf16 v[24:39], v[92:93], v[188:189], v[24:39]
    v_sub_f32_e64 v66, -v50, v66
    v_sub_f32_e64 v67, -v51, v67
    v_sub_f32_e64 v68, -v52, v68
    v_sub_f32_e64 v69, -v53, v69
    v_sub_f32_e64 v70, -v54, v70
    v_sub_f32_e64 v71, -v55, v71
    v_mfma_f32_32x32x8_bf16 v[0:15], v[88:89], v[188:189], v[0:15]
    v_add_f32 v254, v196, v254
    s_waitcnt vmcnt(3) lgkmcnt(0)
    v_mfma_f32_32x32x16_bf16 v[56:71], v[76:79], v[176:179], v[56:71]
    s_nop 1
    v_sub_f32_e64 v40, -v24, v40
    v_sub_f32_e64 v41, -v25, v41
    v_sub_f32_e64 v42, -v26, v42
    v_sub_f32_e64 v43, -v27, v43
    v_sub_f32_e64 v44, -v28, v44
    v_sub_f32_e64 v45, -v29, v45
    v_sub_f32_e64 v46, -v30, v46
    v_sub_f32_e64 v47, -v31, v47
    s_mov_b32 m0, s76
    s_mov_b64 exec, s[72:73]
    buffer_load_dwordx4 v192, s[12:15], 0 offen  lds
    s_mov_b32 m0, s77
    s_mov_b64 exec, s[74:75]
    buffer_load_dwordx4 v193, s[12:15], 0 offen  lds
    s_mov_b64 exec, -1
    s_add_u32 m0, s21, 2048
    v_mfma_f32_32x32x16_bf16 v[16:31], v[72:75], v[176:179], 0
    v_mad_u32_u16 v236, v236, s3, v246 op_sel:[1,0,0,0]
    v_mad_u32_u16 v237, v237, s3, v246 op_sel:[1,0,0,0]
    buffer_load_dwordx4 v236, s[4:7], s39 offen  lds
    buffer_load_dwordx4 v237, s[8:11], s39 offen offset:1024  lds
    ds_read_b64_tr_b16 v[176:177], v244 offset:4096
    ds_read_b64_tr_b16 v[178:179], v244 offset:5120
    ds_read_b64_tr_b16 v[184:185], v245 offset:4096
    ds_read_b64_tr_b16 v[186:187], v245 offset:5120
    v_mul_f32 v255, v0, v152
    v_fmac_f32 v255, v1, v153
    v_fmac_f32 v255, v2, v154
    v_fmac_f32 v255, v3, v155
    v_fmac_f32 v255, v4, v156
    s_waitcnt vmcnt(6) lgkmcnt(0)
    v_mfma_f32_32x32x16_bf16 v[16:31], v[80:83], v[176:179], v[16:31]
    v_fmac_f32 v255, v5, v157
    v_fmac_f32 v255, v6, v158
    v_fmac_f32 v255, v7, v159
    v_fmac_f32 v201, v8, v168
    v_fmac_f32 v201, v9, v169
    v_permlane32_swap_b32 v197, v255
    s_add_u32 m0, s21, 4096
    v_mfma_f32_32x32x16_bf16 v[56:71], v[84:87], v[176:179], v[56:71]
    v_mad_u32_u16 v238, v238, s3, v246 op_sel:[1,0,0,0]
    v_mad_u32_u16 v239, v239, s3, v246 op_sel:[1,0,0,0]
    buffer_load_dwordx4 v238, s[4:7], s40 offen  lds
    buffer_load_dwordx4 v239, s[8:11], s40 offen offset:1024  lds
    ds_read_b64_tr_b16 v[176:177], v244 offset:6144
    ds_read_b64_tr_b16 v[188:189], v245 offset:6144
    s_waitcnt lgkmcnt(0)
    v_mfma_f32_32x32x8_bf16 v[16:31], v[88:89], v[176:177], v[16:31]
    v_fmac_f32 v201, v10, v170
    v_fmac_f32 v201, v11, v171
    v_fmac_f32 v201, v12, v172
    v_fmac_f32 v201, v13, v173
    v_fmac_f32 v201, v14, v174
    v_fmac_f32 v201, v15, v175
    s_add_u32 m0, s21, 6144
    v_mfma_f32_32x32x8_bf16 v[56:71], v[92:93], v[176:177], v[56:71]
    v_mad_u32_u16 v240, v240, s3, v246 op_sel:[1,0,0,0]
    v_mad_u32_u16 v241, v241, s3, v246 op_sel:[1,0,0,0]
    buffer_load_dwordx4 v240, s[4:7], s41 offen  lds
    buffer_load_dwordx4 v241, s[8:11], s41 offen offset:1024  lds
    v_add_f32 v255, v197, v255
    s_set_gpr_idx_on s51, gpr_idx(DST)
    s_nop 0
    v_cvt_pk_bf16_f32 v206, v254, v255
    s_set_gpr_idx_off
    v_mfma_f32_32x32x16_bf16 v[0:15], v[72:75], v[180:183], 0
    v_mul_f32 v254, v16, v144
    v_fmac_f32 v254, v17, v145
    v_fmac_f32 v254, v18, v146
    v_fmac_f32 v254, v19, v147
    v_fmac_f32 v254, v20, v148
    v_fmac_f32 v254, v21, v149
    v_mfma_f32_32x32x16_bf16 v[32:47], v[76:79], v[180:183], v[32:47]
    v_fmac_f32 v254, v22, v150
    v_fmac_f32 v254, v23, v151
    v_fma_f32 v202, v24, -v160, v202
    v_fma_f32 v202, v25, -v161, v202
    v_permlane32_swap_b32 v254, v200
    v_fma_f32 v202, v26, -v162, v202
    v_mfma_f32_32x32x16_bf16 v[0:15], v[80:83], v[184:187], v[0:15]
    v_fma_f32 v202, v27, -v163, v202
    v_fma_f32 v202, v28, -v164, v202
    v_fma_f32 v202, v29, -v165, v202
    v_fma_f32 v202, v30, -v166, v202
    v_fma_f32 v202, v31, -v167, v202
    v_add_f32 v200, v254, v200
    v_mfma_f32_32x32x16_bf16 v[32:47], v[84:87], v[184:187], v[32:47]
    s_waitcnt vmcnt(8)
    ds_read_b64_tr_b16 v[176:177], v244 offset:0
    ds_read_b64_tr_b16 v[178:179], v244 offset:1024
    ds_read_b64_tr_b16 v[180:181], v245 offset:0
    ds_read_b64_tr_b16 v[182:183], v245 offset:1024
    v_mul_f32_e64 v198, v64, -v112
    v_permlane32_swap_b32 v202, v254
    v_mfma_f32_32x32x8_bf16 v[0:15], v[88:89], v[188:189], v[0:15]
    v_fma_f32 v198, v65, -v113, v198
    v_fma_f32 v198, v66, -v114, v198
    v_fma_f32 v198, v67, -v115, v198
    v_fma_f32 v198, v68, -v116, v198
    v_fma_f32 v198, v69, -v117, v198
    v_fma_f32 v198, v70, -v118, v198
    v_mfma_f32_32x32x8_bf16 v[32:47], v[92:93], v[188:189], v[32:47]
    v_add_u32 v249, s48, v249
    v_add_u32 v250, s49, v250
    v_fma_f32 v198, v71, -v119, v198
    v_add_f32 v254, v202, v254
    v_mul_f32 v196, v56, v160
    v_fmac_f32 v196, v57, v161
    v_fmac_f32 v196, v58, v162
    v_fmac_f32 v196, v59, v163
    v_fmac_f32 v196, v60, v164
    v_fmac_f32 v196, v61, v165
    v_fmac_f32 v196, v62, v166
    v_fmac_f32 v196, v63, v167
    s_nop 1
    v_permlane32_swap_b32 v198, v196
    v_add_f32 v196, v198, v196
    v_mul_f32 v255, v0, v152
    v_fmac_f32 v255, v1, v153
    v_fmac_f32 v255, v2, v154
    v_fmac_f32 v255, v3, v155
    v_fmac_f32 v255, v4, v156
    v_fmac_f32 v255, v5, v157
    v_fmac_f32 v255, v6, v158
    v_fmac_f32 v255, v7, v159
    v_fma_f32 v203, v8, -v168, v203
    v_fma_f32 v203, v9, -v169, v203
    v_permlane32_swap_b32 v255, v201
    v_fma_f32 v203, v10, -v170, v203
    v_fma_f32 v203, v11, -v171, v203
    v_fma_f32 v203, v12, -v172, v203
    v_fma_f32 v203, v13, -v173, v203
    v_fma_f32 v203, v14, -v174, v203
    v_fma_f32 v203, v15, -v175, v203
    v_add_f32 v201, v255, v201
    v_mul_f32_e64 v199, v40, -v120
    v_permlane32_swap_b32 v203, v255
    v_fma_f32 v199, v41, -v121, v199
    v_fma_f32 v199, v42, -v122, v199
    v_fma_f32 v199, v43, -v123, v199
    s_waitcnt vmcnt(6)
    ds_read_b64_tr_b16 v[72:73], v249 offset:0
    ds_read_b64_tr_b16 v[76:77], v249 offset:64
    ds_read_b64_tr_b16 v[74:75], v249 offset:256
    ds_read_b64_tr_b16 v[78:79], v249 offset:320
    s_mov_b64 exec, s[54:55]
    ds_read_u16_d16_hi v242, v250 offset:0
    s_mov_b64 exec, -1
    v_fma_f32 v199, v44, -v124, v199
    v_fma_f32 v199, v45, -v125, v199
    v_fma_f32 v199, v46, -v126, v199
    v_fma_f32 v199, v47, -v127, v199
    v_add_f32 v255, v203, v255
    v_mul_f32 v197, v32, v168
    v_fmac_f32 v197, v33, v169
    v_fmac_f32 v197, v34, v170
    v_fmac_f32 v197, v35, v171
    v_fmac_f32 v197, v36, v172
    v_fmac_f32 v197, v37, v173
    v_fmac_f32 v197, v38, v174
    v_fmac_f32 v197, v39, v175
    s_nop 1
    v_permlane32_swap_b32 v199, v197
    v_add_f32 v197, v199, v197
    s_set_gpr_idx_on s51, gpr_idx(DST)
    s_nop 0
    v_cvt_pk_bf16_f32 v207, v200, v201
    v_cvt_pk_bf16_f32 v209, v254, v255
    v_cvt_pk_bf16_f32 v208, v196, v197
    s_set_gpr_idx_off
    s_add_u32 s50, s50, 1
    s_add_u32 s51, s51, 6
    s_cmp_ge_u32 s50, 4
    s_cbranch_scc1 LAST0
    s_add_u32 s53, s53, 4
    s_xor_b32 s66, s53, s20
    s_bitcmp1_b32 s66, 2
    s_setprio 1
    s_cbranch_scc1 PRIO_6
    s_setprio 0
PRIO_6:
    s_cmp_eq_u32 s52, 4
    s_cbranch_scc1 ITEM_0_4
    s_cmp_eq_u32 s52, 5
    s_cbranch_scc1 ITEM_0_5
    s_cmp_eq_u32 s52, 3
    s_cbranch_scc1 ITEM_0_3
    s_cmp_eq_u32 s52, 6
    s_cbranch_scc1 ITEM_0_6
    s_cmp_eq_u32 s52, 8
    s_cbranch_scc1 ITEM_0_8
    s_branch ITEM_0_2
.p2align 6
ITEM_0_3:
    s_mov_b64 exec, s[54:55]
    ds_read_u16_d16_hi v243, v250 offset:128
    s_mov_b64 exec, -1
    ds_read_b64_tr_b16 v[80:81], v249 offset:512
    ds_read_b64_tr_b16 v[84:85], v249 offset:576
    s_waitcnt lgkmcnt(3)
    v_mul_f32_dpp v196, v242, v72 row_newbcast:0 row_mask:0xf bank_mask:0xf
    v_mul_f32_dpp v197, v242, v73 row_newbcast:1 row_mask:0xf bank_mask:0xf
    v_mul_f32_dpp v198, v242, v72 row_newbcast:8 row_mask:0xf bank_mask:0xf
    v_mul_f32_dpp v199, v242, v73 row_newbcast:9 row_mask:0xf bank_mask:0xf
    v_mul_f32_dpp v200, v242, v76 row_newbcast:2 row_mask:0xf bank_mask:0xf
    v_mul_f32_dpp v201, v242, v77 row_newbcast:3 row_mask:0xf bank_mask:0xf
    v_mul_f32_dpp v202, v242, v76 row_newbcast:10 row_mask:0xf bank_mask:0xf
    v_mul_f32_dpp v203, v242, v77 row_newbcast:11 row_mask:0xf bank_mask:0xf
    v_cvt_pk_bf16_f32 v72, v196, v197
    v_cvt_pk_bf16_f32 v76, v198, v199
    v_cvt_pk_bf16_f32 v73, v200, v201
    v_cvt_pk_bf16_f32 v77, v202, v203
    v_mul_f32_dpp v196, v242, v74 row_newbcast:4 row_mask:0xf bank_mask:0xf
    v_mul_f32_dpp v197, v242, v75 row_newbcast:5 row_mask:0xf bank_mask:0xf
    v_mul_f32_dpp v198, v242, v74 row_newbcast:12 row_mask:0xf bank_mask:0xf
    v_mul_f32_dpp v199, v242, v75 row_newbcast:13 row_mask:0xf bank_mask:0xf
    v_mul_f32_dpp v200, v242, v78 row_newbcast:6 row_mask:0xf bank_mask:0xf
    v_mul_f32_dpp v201, v242, v79 row_newbcast:7 row_mask:0xf bank_mask:0xf
    v_mul_f32_dpp v202, v242, v78 row_newbcast:14 row_mask:0xf bank_mask:0xf
    v_mul_f32_dpp v203, v242, v79 row_newbcast:15 row_mask:0xf bank_mask:0xf
    v_cvt_pk_bf16_f32 v74, v196, v197
    v_cvt_pk_bf16_f32 v78, v198, v199
    v_cvt_pk_bf16_f32 v75, v200, v201
    v_cvt_pk_bf16_f32 v79, v202, v203
    s_waitcnt vmcnt(4) lgkmcnt(0)
    v_mfma_f32_32x32x16_bf16 v[56:71], v[72:75], v[176:179], 0
    v_mul_f32_dpp v196, v243, v80 row_newbcast:0 row_mask:0xf bank_mask:0xf
    v_mul_f32_dpp v197, v243, v81 row_newbcast:1 row_mask:0xf bank_mask:0xf
    v_mul_f32_dpp v198, v243, v80 row_newbcast:8 row_mask:0xf bank_mask:0xf
    v_mul_f32_dpp v199, v243, v81 row_newbcast:9 row_mask:0xf bank_mask:0xf
    v_mul_f32_dpp v200, v243, v84 row_newbcast:2 row_mask:0xf bank_mask:0xf
    v_mul_f32_dpp v201, v243, v85 row_newbcast:3 row_mask:0xf bank_mask:0xf
    s_add_u32 m0, s21, 0
    v_mfma_f32_32x32x16_bf16 v[16:31], v[76:79], v[176:179], 0
    buffer_load_dwordx4 v234, s[4:7], s36 offen  lds
    buffer_load_dwordx4 v235, s[8:11], s36 offen offset:1024  lds
    ds_read_b64_tr_b16 v[176:177], v244 offset:2048
    ds_read_b64_tr_b16 v[184:185], v245 offset:2048
    v_mul_f32_dpp v202, v243, v84 row_newbcast:10 row_mask:0xf bank_mask:0xf
    v_mul_f32_dpp v203, v243, v85 row_newbcast:11 row_mask:0xf bank_mask:0xf
    v_cvt_pk_bf16_f32 v80, v196, v197
    v_cvt_pk_bf16_f32 v84, v198, v199
    v_cvt_pk_bf16_f32 v81, v200, v201
    v_cvt_pk_bf16_f32 v85, v202, v203
    s_waitcnt lgkmcnt(0)
    v_mfma_f32_32x32x8_bf16 v[56:71], v[80:81], v[176:177], v[56:71]
    s_add_u32 m0, s21, 2048
    v_mfma_f32_32x32x8_bf16 v[16:31], v[84:85], v[176:177], v[16:31]
    buffer_load_dwordx4 v236, s[4:7], s36 offen  lds
    s_mov_b32 m0, s50
    s_nop 0
    s_movrels_b32 s71, s23
    s_bfe_u32 s46, s71, 0x30012
    s_mov_b32 m0, s46
    s_and_b32 s66, s71, 0x3ffff
    s_movrels_b32 s68, s57
    s_movrels_b32 s69, s61
    s_sub_u32 s48, s66, s47
    s_mov_b32 s47, s66
    s_lshr_b32 s52, s71, 28
    s_lshl_b32 s67, s46, 9
    s_add_u32 s66, s66, s67
    s_sub_u32 s49, s66, s42
    s_mov_b32 s42, s66
    s_bfe_u32 s66, s68, 655360
    s_add_u32 s43, s42, s66
    s_bfe_u32 s39, s69, 655360
    s_bfe_u32 s66, s68, 655370
    s_add_u32 s44, s42, s66
    s_bfe_u32 s40, s69, 655370
    s_bfe_u32 s66, s68, 655380
    s_add_u32 s45, s42, s66
    s_bfe_u32 s41, s69, 655380
    s_and_b32 s66, s46, s33
    s_cselect_b32 s72, -1, 1
    s_cselect_b32 s76, s47, 163712
    s_cmp_ge_u32 s66, 2
    s_cselect_b32 s73, -1, 0
    s_add_u32 s77, s47, 1024
    s_cmp_ge_u32 s66, 4
    s_cselect_b32 s75, -1, 0
    s_cmp_ge_u32 s66, 3
    s_cselect_b32 s74, -1, 1
    s_cselect_b32 s77, s77, 163712
    v_add_u32 v252, s44, v247
    ds_read2_b32 v[238:239], v252 offset0:0 offset1:16
    v_add_u32 v252, s45, v247
    ds_read2_b32 v[240:241], v252 offset0:0 offset1:16
    v_mfma_f32_32x32x16_bf16 v[32:47], v[72:75], v[180:183], 0
    v_mul_f32 v196, v56, v96
    v_fmac_f32 v196, v57, v97
    v_fmac_f32 v196, v58, v98
    v_fmac_f32 v196, v59, v99
    v_fmac_f32 v196, v60, v100
    v_fmac_f32 v196, v61, v101
    v_mfma_f32_32x32x16_bf16 v[0:15], v[76:79], v[180:183], 0
    s_waitcnt vmcnt(5)
    ds_read_b64_tr_b16 v[176:177], v244 offset:4096
    ds_read_b64_tr_b16 v[178:179], v244 offset:5120
    ds_read_b64_tr_b16 v[180:181], v245 offset:4096
    ds_read_b64_tr_b16 v[182:183], v245 offset:5120
    v_fmac_f32 v196, v62, v102
    v_fmac_f32 v196, v63, v103
    v_mfma_f32_32x32x8_bf16 v[32:47], v[80:81], v[184:185], v[32:47]
    v_mul_f32 v198, v64, v128
    v_fmac_f32 v198, v65, v129
    v_fmac_f32 v198, v66, v130
    v_fmac_f32 v198, v67, v131
    v_fmac_f32 v198, v68, v132
    v_fmac_f32 v198, v69, v133
    v_mfma_f32_32x32x8_bf16 v[0:15], v[84:85], v[184:185], v[0:15]
    v_fmac_f32 v198, v70, v134
    v_fmac_f32 v198, v71, v135
    v_mul_f32 v200, v16, v128
    v_fmac_f32 v200, v17, v129
    v_permlane32_swap_b32 v196, v198
    v_fmac_f32 v200, v18, v130
    v_fmac_f32 v200, v19, v131
    v_fmac_f32 v200, v20, v132
    v_fmac_f32 v200, v21, v133
    v_fmac_f32 v200, v22, v134
    v_fmac_f32 v200, v23, v135
    v_add_f32 v198, v196, v198
    v_mul_f32_e64 v202, v24, -v128
    v_fma_f32 v202, v25, -v129, v202
    v_fma_f32 v202, v26, -v130, v202
    v_fma_f32 v202, v27, -v131, v202
    v_fma_f32 v202, v28, -v132, v202
    v_fma_f32 v202, v29, -v133, v202
    v_fma_f32 v202, v30, -v134, v202
    v_fma_f32 v202, v31, -v135, v202
    s_nop 1
    v_permlane32_swap_b32 v200, v202
    v_add_f32 v202, v200, v202
    s_waitcnt vmcnt(3) lgkmcnt(0)
    v_mfma_f32_32x32x16_bf16 v[56:71], v[72:75], v[176:179], 0
    v_mul_f32 v197, v32, v104
    v_fmac_f32 v197, v33, v105
    v_fmac_f32 v197, v34, v106
    v_fmac_f32 v197, v35, v107
    v_fmac_f32 v197, v36, v108
    v_fmac_f32 v197, v37, v109
    s_add_u32 m0, s21, 4096
    v_mfma_f32_32x32x16_bf16 v[16:31], v[76:79], v[176:179], 0
    buffer_load_dwordx4 v234, s[4:7], s37 offen  lds
    buffer_load_dwordx4 v235, s[8:11], s37 offen offset:1024  lds
    ds_read_b64_tr_b16 v[176:177], v244 offset:6144
    ds_read_b64_tr_b16 v[184:185], v245 offset:6144
    v_add_u32 v252, s42, v247
    ds_read2_b32 v[234:235], v252 offset0:0 offset1:16
    v_fmac_f32 v197, v38, v110
    v_fmac_f32 v197, v39, v111
    v_mul_f32 v199, v40, v136
    v_fmac_f32 v199, v41, v137
    v_fmac_f32 v199, v42, v138
    v_fmac_f32 v199, v43, v139
    v_fmac_f32 v199, v44, v140
    v_fmac_f32 v199, v45, v141
    v_fmac_f32 v199, v46, v142
    v_fmac_f32 v199, v47, v143
    v_mul_f32 v201, v0, v136
    v_fmac_f32 v201, v1, v137
    v_permlane32_swap_b32 v197, v199
    v_fmac_f32 v201, v2, v138
    v_fmac_f32 v201, v3, v139
    v_fmac_f32 v201, v4, v140
    v_fmac_f32 v201, v5, v141
    v_fmac_f32 v201, v6, v142
    v_fmac_f32 v201, v7, v143
    v_add_f32 v199, v197, v199
    v_mul_f32_e64 v203, v8, -v136
    v_fma_f32 v203, v9, -v137, v203
    v_fma_f32 v203, v10, -v138, v203
    s_waitcnt lgkmcnt(1)
    v_mfma_f32_32x32x8_bf16 v[56:71], v[80:81], v[176:177], v[56:71]
    v_fma_f32 v203, v11, -v139, v203
    v_fma_f32 v203, v12, -v140, v203
    v_fma_f32 v203, v13, -v141, v203
    v_fma_f32 v203, v14, -v142, v203
    v_fma_f32 v203, v15, -v143, v203
    s_nop 1
    v_permlane32_swap_b32 v201, v203
    s_add_u32 m0, s21, 6144
    v_mfma_f32_32x32x8_bf16 v[16:31], v[84:85], v[176:177], v[16:31]
    buffer_load_dwordx4 v236, s[4:7], s37 offen  lds
    v_add_u32 v252, s43, v247
    ds_read2_b32 v[236:237], v252 offset0:0 offset1:16
    v_add_f32 v203, v201, v203
    s_set_gpr_idx_on s51, gpr_idx(DST)
    s_nop 0
    v_cvt_pk_bf16_f32 v204, v198, v199
    v_cvt_pk_bf16_f32 v205, v202, v203
    s_set_gpr_idx_off
    v_mfma_f32_32x32x16_bf16 v[32:47], v[72:75], v[180:183], 0
    v_mul_f32 v196, v56, v144
    v_fmac_f32 v196, v57, v145
    v_fmac_f32 v196, v58, v146
    v_fmac_f32 v196, v59, v147
    v_fmac_f32 v196, v60, v148
    v_fmac_f32 v196, v61, v149
    v_mfma_f32_32x32x16_bf16 v[0:15], v[76:79], v[180:183], 0
    s_waitcnt vmcnt(4)
    ds_read_b64_tr_b16 v[176:177], v244 offset:0
    ds_read_b64_tr_b16 v[178:179], v244 offset:1024
    ds_read_b64_tr_b16 v[180:181], v245 offset:0
    ds_read_b64_tr_b16 v[182:183], v245 offset:1024
    v_fmac_f32 v196, v62, v150
    v_fmac_f32 v196, v63, v151
    v_mfma_f32_32x32x8_bf16 v[32:47], v[80:81], v[184:185], v[32:47]
    v_mul_f32_e64 v200, v16, -v160
    v_fma_f32 v200, v17, -v161, v200
    v_fma_f32 v200, v18, -v162, v200
    v_fma_f32 v200, v19, -v163, v200
    v_fma_f32 v200, v20, -v164, v200
    v_fma_f32 v200, v21, -v165, v200
    v_mfma_f32_32x32x8_bf16 v[0:15], v[84:85], v[184:185], v[0:15]
    v_fma_f32 v200, v22, -v166, v200
    v_fma_f32 v200, v23, -v167, v200
    v_mul_f32_e64 v202, v24, -v160
    v_fma_f32 v202, v25, -v161, v202
    v_fma_f32 v202, v26, -v162, v202
    v_fma_f32 v202, v27, -v163, v202
    v_fma_f32 v202, v28, -v164, v202
    v_fma_f32 v202, v29, -v165, v202
    v_fma_f32 v202, v30, -v166, v202
    v_fma_f32 v202, v31, -v167, v202
    s_waitcnt vmcnt(3) lgkmcnt(0)
    v_mfma_f32_32x32x16_bf16 v[16:31], v[72:75], v[176:179], 0
    v_mul_f32 v197, v32, v152
    v_fmac_f32 v197, v33, v153
    v_fmac_f32 v197, v34, v154
    v_fmac_f32 v197, v35, v155
    v_fmac_f32 v197, v36, v156
    v_fmac_f32 v197, v37, v157
    s_add_u32 m0, s21, 0
    v_mfma_f32_32x32x16_bf16 v[48:63], v[76:79], v[176:179], 0
    v_mad_u32_u16 v234, v234, s3, v246 op_sel:[1,0,0,0]
    v_mad_u32_u16 v235, v235, s3, v246 op_sel:[1,0,0,0]
    buffer_load_dwordx4 v234, s[4:7], s38 offen  lds
    buffer_load_dwordx4 v235, s[8:11], s38 offen offset:1024  lds
    ds_read_b64_tr_b16 v[176:177], v244 offset:2048
    ds_read_b64_tr_b16 v[184:185], v245 offset:2048
    v_fmac_f32 v197, v38, v158
    v_fmac_f32 v197, v39, v159
    v_mul_f32_e64 v201, v0, -v168
    v_fma_f32 v201, v1, -v169, v201
    v_fma_f32 v201, v2, -v170, v201
    v_fma_f32 v201, v3, -v171, v201
    v_fma_f32 v201, v4, -v172, v201
    v_fma_f32 v201, v5, -v173, v201
    v_fma_f32 v201, v6, -v174, v201
    v_fma_f32 v201, v7, -v175, v201
    s_waitcnt lgkmcnt(0)
    v_mfma_f32_32x32x8_bf16 v[16:31], v[80:81], v[176:177], v[16:31]
    v_mul_f32_e64 v203, v8, -v168
    v_fma_f32 v203, v9, -v169, v203
    v_fma_f32 v203, v10, -v170, v203
    v_fma_f32 v203, v11, -v171, v203
    v_fma_f32 v203, v12, -v172, v203
    v_fma_f32 v203, v13, -v173, v203
    s_add_u32 m0, s21, 2048
    v_mfma_f32_32x32x8_bf16 v[48:63], v[84:85], v[176:177], v[48:63]
    v_mad_u32_u16 v236, v236, s3, v246 op_sel:[1,0,0,0]
    v_mad_u32_u16 v237, v237, s3, v246 op_sel:[1,0,0,0]
    buffer_load_dwordx4 v236, s[4:7], s39 offen  lds
    buffer_load_dwordx4 v237, s[8:11], s39 offen offset:1024  lds
    v_fma_f32 v203, v14, -v174, v203
    v_fma_f32 v203, v15, -v175, v203
    v_mfma_f32_32x32x16_bf16 v[0:15], v[72:75], v[180:183], 0
    v_fmac_f32 v200, v24, v160
    v_fmac_f32 v200, v25, v161
    v_fmac_f32 v200, v26, v162
    v_fmac_f32 v200, v27, v163
    v_fmac_f32 v200, v28, v164
    v_fmac_f32 v200, v29, v165
    v_fmac_f32 v200, v30, v166
    v_fmac_f32 v200, v31, v167
    v_mfma_f32_32x32x16_bf16 v[24:39], v[76:79], v[180:183], 0
    v_add_u32 v253, s47, v248
    ds_read_b32 v192, v253
    ds_read_b32 v193, v253 offset:256
    s_waitcnt vmcnt(5)
    ds_read_b64_tr_b16 v[176:177], v244 offset:4096
    ds_read_b64_tr_b16 v[178:179], v244 offset:5120
    ds_read_b64_tr_b16 v[180:181], v245 offset:4096
    ds_read_b64_tr_b16 v[182:183], v245 offset:5120
    v_mfma_f32_32x32x8_bf16 v[24:39], v[84:85], v[184:185], v[24:39]
    v_mul_f32 v254, v16, v144
    v_fmac_f32 v254, v17, v145
    v_fmac_f32 v254, v18, v146
    v_fmac_f32 v254, v19, v147
    v_fmac_f32 v254, v20, v148
    v_fmac_f32 v254, v21, v149
    v_mfma_f32_32x32x8_bf16 v[0:15], v[80:81], v[184:185], v[0:15]
    v_fmac_f32 v254, v22, v150
    v_fmac_f32 v254, v23, v151
    v_sub_f32_e64 v64, -v48, v64
    v_sub_f32_e64 v65, -v49, v65
    v_permlane32_swap_b32 v196, v254
    v_sub_f32_e64 v66, -v50, v66
    v_sub_f32_e64 v67, -v51, v67
    v_sub_f32_e64 v68, -v52, v68
    v_sub_f32_e64 v69, -v53, v69
    v_sub_f32_e64 v70, -v54, v70
    v_sub_f32_e64 v71, -v55, v71
    v_add_f32 v254, v196, v254
    s_waitcnt vmcnt(4) lgkmcnt(0)
    v_mfma_f32_32x32x16_bf16 v[56:71], v[76:79], v[176:179], v[56:71]
    v_sub_f32_e64 v40, -v24, v40
    v_sub_f32_e64 v41, -v25, v41
    v_sub_f32_e64 v42, -v26, v42
    v_sub_f32_e64 v43, -v27, v43
    v_sub_f32_e64 v44, -v28, v44
    v_sub_f32_e64 v45, -v29, v45
    v_sub_f32_e64 v46, -v30, v46
    v_sub_f32_e64 v47, -v31, v47
    s_mov_b32 m0, s76
    s_mov_b64 exec, s[72:73]
    buffer_load_dwordx4 v192, s[12:15], 0 offen  lds
    s_mov_b32 m0, s77
    s_mov_b64 exec, s[74:75]
    buffer_load_dwordx4 v193, s[12:15], 0 offen  lds
    s_mov_b64 exec, -1
    s_add_u32 m0, s21, 4096
    v_mfma_f32_32x32x16_bf16 v[16:31], v[72:75], v[176:179], 0
    v_mad_u32_u16 v238, v238, s3, v246 op_sel:[1,0,0,0]
    v_mad_u32_u16 v239, v239, s3, v246 op_sel:[1,0,0,0]
    buffer_load_dwordx4 v238, s[4:7], s40 offen  lds
    buffer_load_dwordx4 v239, s[8:11], s40 offen offset:1024  lds
    ds_read_b64_tr_b16 v[176:177], v244 offset:6144
    ds_read_b64_tr_b16 v[184:185], v245 offset:6144
    v_mul_f32 v255, v0, v152
    v_fmac_f32 v255, v1, v153
    v_fmac_f32 v255, v2, v154
    v_fmac_f32 v255, v3, v155
    v_fmac_f32 v255, v4, v156
    v_fmac_f32 v255, v5, v157
    v_fmac_f32 v255, v6, v158
    v_fmac_f32 v255, v7, v159
    v_fmac_f32 v201, v8, v168
    v_fmac_f32 v201, v9, v169
    v_permlane32_swap_b32 v197, v255
    s_waitcnt lgkmcnt(0)
    v_mfma_f32_32x32x8_bf16 v[16:31], v[80:81], v[176:177], v[16:31]
    v_fmac_f32 v201, v10, v170
    v_fmac_f32 v201, v11, v171
    v_fmac_f32 v201, v12, v172
    v_fmac_f32 v201, v13, v173
    v_fmac_f32 v201, v14, v174
    v_fmac_f32 v201, v15, v175
    s_add_u32 m0, s21, 6144
    v_mfma_f32_32x32x8_bf16 v[56:71], v[84:85], v[176:177], v[56:71]
    v_mad_u32_u16 v240, v240, s3, v246 op_sel:[1,0,0,0]
    v_mad_u32_u16 v241, v241, s3, v246 op_sel:[1,0,0,0]
    buffer_load_dwordx4 v240, s[4:7], s41 offen  lds
    buffer_load_dwordx4 v241, s[8:11], s41 offen offset:1024  lds
    v_add_f32 v255, v197, v255
    s_set_gpr_idx_on s51, gpr_idx(DST)
    s_nop 0
    v_cvt_pk_bf16_f32 v206, v254, v255
    s_set_gpr_idx_off
    v_mfma_f32_32x32x16_bf16 v[0:15], v[72:75], v[180:183], 0
    v_mul_f32 v254, v16, v144
    v_fmac_f32 v254, v17, v145
    v_fmac_f32 v254, v18, v146
    v_fmac_f32 v254, v19, v147
    v_fmac_f32 v254, v20, v148
    v_fmac_f32 v254, v21, v149
    v_mfma_f32_32x32x16_bf16 v[32:47], v[76:79], v[180:183], v[32:47]
    s_waitcnt vmcnt(8)
    ds_read_b64_tr_b16 v[176:177], v244 offset:0
    ds_read_b64_tr_b16 v[178:179], v244 offset:1024
    ds_read_b64_tr_b16 v[180:181], v245 offset:0
    ds_read_b64_tr_b16 v[182:183], v245 offset:1024
    v_fmac_f32 v254, v22, v150
    v_fmac_f32 v254, v23, v151
    v_mfma_f32_32x32x8_bf16 v[0:15], v[80:81], v[184:185], v[0:15]
    v_fma_f32 v202, v24, -v160, v202
    v_fma_f32 v202, v25, -v161, v202
    v_permlane32_swap_b32 v254, v200
    v_fma_f32 v202, v26, -v162, v202
    v_fma_f32 v202, v27, -v163, v202
    v_fma_f32 v202, v28, -v164, v202
    v_mfma_f32_32x32x8_bf16 v[32:47], v[84:85], v[184:185], v[32:47]
    v_add_u32 v249, s48, v249
    v_add_u32 v250, s49, v250
    v_fma_f32 v202, v29, -v165, v202
    v_fma_f32 v202, v30, -v166, v202
    v_fma_f32 v202, v31, -v167, v202
    v_add_f32 v200, v254, v200
    v_mul_f32_e64 v198, v64, -v112
    v_permlane32_swap_b32 v202, v254
    v_fma_f32 v198, v65, -v113, v198
    v_fma_f32 v198, v66, -v114, v198
    v_fma_f32 v198, v67, -v115, v198
    v_fma_f32 v198, v68, -v116, v198
    v_fma_f32 v198, v69, -v117, v198
    v_fma_f32 v198, v70, -v118, v198
    v_fma_f32 v198, v71, -v119, v198
    v_add_f32 v254, v202, v254
    v_mul_f32 v196, v56, v160
    v_fmac_f32 v196, v57, v161
    v_fmac_f32 v196, v58, v162
    v_fmac_f32 v196, v59, v163
    v_fmac_f32 v196, v60, v164
    v_fmac_f32 v196, v61, v165
    v_fmac_f32 v196, v62, v166
    v_fmac_f32 v196, v63, v167
    s_nop 1
    v_permlane32_swap_b32 v198, v196
    v_add_f32 v196, v198, v196
    v_mul_f32 v255, v0, v152
    v_fmac_f32 v255, v1, v153
    v_fmac_f32 v255, v2, v154
    v_fmac_f32 v255, v3, v155
    v_fmac_f32 v255, v4, v156
    v_fmac_f32 v255, v5, v157
    v_fmac_f32 v255, v6, v158
    v_fmac_f32 v255, v7, v159
    v_fma_f32 v203, v8, -v168, v203
    v_fma_f32 v203, v9, -v169, v203
    v_permlane32_swap_b32 v255, v201
    v_fma_f32 v203, v10, -v170, v203
    v_fma_f32 v203, v11, -v171, v203
    v_fma_f32 v203, v12, -v172, v203
    v_fma_f32 v203, v13, -v173, v203
    v_fma_f32 v203, v14, -v174, v203
    v_fma_f32 v203, v15, -v175, v203
    v_add_f32 v201, v255, v201
    v_mul_f32_e64 v199, v40, -v120
    v_permlane32_swap_b32 v203, v255
    v_fma_f32 v199, v41, -v121, v199
    v_fma_f32 v199, v42, -v122, v199
    v_fma_f32 v199, v43, -v123, v199
    s_waitcnt vmcnt(4)
    ds_read_b64_tr_b16 v[72:73], v249 offset:0
    ds_read_b64_tr_b16 v[76:77], v249 offset:64
    ds_read_b64_tr_b16 v[74:75], v249 offset:256
    ds_read_b64_tr_b16 v[78:79], v249 offset:320
    s_mov_b64 exec, s[54:55]
    ds_read_u16_d16_hi v242, v250 offset:0
    s_mov_b64 exec, -1
    v_fma_f32 v199, v44, -v124, v199
    v_fma_f32 v199, v45, -v125, v199
    v_fma_f32 v199, v46, -v126, v199
    v_fma_f32 v199, v47, -v127, v199
    v_add_f32 v255, v203, v255
    v_mul_f32 v197, v32, v168
    v_fmac_f32 v197, v33, v169
    v_fmac_f32 v197, v34, v170
    v_fmac_f32 v197, v35, v171
    v_fmac_f32 v197, v36, v172
    v_fmac_f32 v197, v37, v173
    v_fmac_f32 v197, v38, v174
    v_fmac_f32 v197, v39, v175
    s_nop 1
    v_permlane32_swap_b32 v199, v197
    v_add_f32 v197, v199, v197
    s_set_gpr_idx_on s51, gpr_idx(DST)
    s_nop 0
    v_cvt_pk_bf16_f32 v207, v200, v201
    v_cvt_pk_bf16_f32 v209, v254, v255
    v_cvt_pk_bf16_f32 v208, v196, v197
    s_set_gpr_idx_off
    s_add_u32 s50, s50, 1
    s_add_u32 s51, s51, 6
    s_cmp_ge_u32 s50, 4
    s_cbranch_scc1 LAST0
    s_add_u32 s53, s53, 4
    s_xor_b32 s66, s53, s20
    s_bitcmp1_b32 s66, 2
    s_setprio 1
    s_cbranch_scc1 PRIO_7
    s_setprio 0
PRIO_7:
    s_cmp_eq_u32 s52, 4
    s_cbranch_scc1 ITEM_0_4
    s_cmp_eq_u32 s52, 5
    s_cbranch_scc1 ITEM_0_5
    s_cmp_eq_u32 s52, 3
    s_cbranch_scc1 ITEM_0_3
    s_cmp_eq_u32 s52, 6
    s_cbranch_scc1 ITEM_0_6
    s_cmp_eq_u32 s52, 8
    s_cbranch_scc1 ITEM_0_8
    s_branch ITEM_0_2
.p2align 6
ITEM_0_6:
    s_mov_b64 exec, s[54:55]
    ds_read_u16_d16_hi v243, v250 offset:128
    s_mov_b64 exec, -1
    ds_read_b64_tr_b16 v[80:81], v249 offset:512
    ds_read_b64_tr_b16 v[84:85], v249 offset:576
    ds_read_b64_tr_b16 v[82:83], v249 offset:768
    ds_read_b64_tr_b16 v[86:87], v249 offset:832
    ds_read_b64_tr_b16 v[88:89], v249 offset:1024
    ds_read_b64_tr_b16 v[92:93], v249 offset:1088
    ds_read_b64_tr_b16 v[90:91], v249 offset:1280
    ds_read_b64_tr_b16 v[94:95], v249 offset:1344
    s_waitcnt lgkmcnt(9)
    v_mul_f32_dpp v196, v242, v72 row_newbcast:0 row_mask:0xf bank_mask:0xf
    v_mul_f32_dpp v197, v242, v73 row_newbcast:1 row_mask:0xf bank_mask:0xf
    v_mul_f32_dpp v198, v242, v72 row_newbcast:8 row_mask:0xf bank_mask:0xf
    v_mul_f32_dpp v199, v242, v73 row_newbcast:9 row_mask:0xf bank_mask:0xf
    v_mul_f32_dpp v200, v242, v76 row_newbcast:2 row_mask:0xf bank_mask:0xf
    v_mul_f32_dpp v201, v242, v77 row_newbcast:3 row_mask:0xf bank_mask:0xf
    v_mul_f32_dpp v202, v242, v76 row_newbcast:10 row_mask:0xf bank_mask:0xf
    v_mul_f32_dpp v203, v242, v77 row_newbcast:11 row_mask:0xf bank_mask:0xf
    v_cvt_pk_bf16_f32 v72, v196, v197
    v_cvt_pk_bf16_f32 v76, v198, v199
    v_cvt_pk_bf16_f32 v73, v200, v201
    v_cvt_pk_bf16_f32 v77, v202, v203
    v_mul_f32_dpp v196, v242, v74 row_newbcast:4 row_mask:0xf bank_mask:0xf
    v_mul_f32_dpp v197, v242, v75 row_newbcast:5 row_mask:0xf bank_mask:0xf
    v_mul_f32_dpp v198, v242, v74 row_newbcast:12 row_mask:0xf bank_mask:0xf
    v_mul_f32_dpp v199, v242, v75 row_newbcast:13 row_mask:0xf bank_mask:0xf
    v_mul_f32_dpp v200, v242, v78 row_newbcast:6 row_mask:0xf bank_mask:0xf
    v_mul_f32_dpp v201, v242, v79 row_newbcast:7 row_mask:0xf bank_mask:0xf
    v_mul_f32_dpp v202, v242, v78 row_newbcast:14 row_mask:0xf bank_mask:0xf
    v_mul_f32_dpp v203, v242, v79 row_newbcast:15 row_mask:0xf bank_mask:0xf
    v_cvt_pk_bf16_f32 v74, v196, v197
    v_cvt_pk_bf16_f32 v78, v198, v199
    v_cvt_pk_bf16_f32 v75, v200, v201
    v_cvt_pk_bf16_f32 v79, v202, v203
    s_mov_b64 exec, s[54:55]
    ds_read_u16_d16_hi v242, v250 offset:256
    s_mov_b64 exec, -1
    s_waitcnt vmcnt(4) lgkmcnt(5)
    v_mfma_f32_32x32x16_bf16 v[56:71], v[72:75], v[176:179], 0
    v_mul_f32_dpp v196, v243, v80 row_newbcast:0 row_mask:0xf bank_mask:0xf
    v_mul_f32_dpp v197, v243, v81 row_newbcast:1 row_mask:0xf bank_mask:0xf
    v_mul_f32_dpp v198, v243, v80 row_newbcast:8 row_mask:0xf bank_mask:0xf
    v_mul_f32_dpp v199, v243, v81 row_newbcast:9 row_mask:0xf bank_mask:0xf
    v_mul_f32_dpp v200, v243, v84 row_newbcast:2 row_mask:0xf bank_mask:0xf
    v_mul_f32_dpp v201, v243, v85 row_newbcast:3 row_mask:0xf bank_mask:0xf
    s_add_u32 m0, s21, 0
    v_mfma_f32_32x32x16_bf16 v[16:31], v[76:79], v[176:179], 0
    buffer_load_dwordx4 v236, s[4:7], s35 offen  lds
    buffer_load_dwordx4 v237, s[8:11], s35 offen offset:1024  lds
    ds_read_b64_tr_b16 v[176:177], v244 offset:2048
    ds_read_b64_tr_b16 v[178:179], v244 offset:3072
    ds_read_b64_tr_b16 v[184:185], v245 offset:2048
    ds_read_b64_tr_b16 v[186:187], v245 offset:3072
    v_mul_f32_dpp v202, v243, v84 row_newbcast:10 row_mask:0xf bank_mask:0xf
    v_mul_f32_dpp v203, v243, v85 row_newbcast:11 row_mask:0xf bank_mask:0xf
    v_cvt_pk_bf16_f32 v80, v196, v197
    v_cvt_pk_bf16_f32 v84, v198, v199
    v_cvt_pk_bf16_f32 v81, v200, v201
    v_cvt_pk_bf16_f32 v85, v202, v203
    v_mul_f32_dpp v196, v243, v82 row_newbcast:4 row_mask:0xf bank_mask:0xf
    v_mul_f32_dpp v197, v243, v83 row_newbcast:5 row_mask:0xf bank_mask:0xf
    v_mul_f32_dpp v198, v243, v82 row_newbcast:12 row_mask:0xf bank_mask:0xf
    v_mul_f32_dpp v199, v243, v83 row_newbcast:13 row_mask:0xf bank_mask:0xf
    v_mul_f32_dpp v200, v243, v86 row_newbcast:6 row_mask:0xf bank_mask:0xf
    v_mul_f32_dpp v201, v243, v87 row_newbcast:7 row_mask:0xf bank_mask:0xf
    v_mul_f32_dpp v202, v243, v86 row_newbcast:14 row_mask:0xf bank_mask:0xf
    v_mul_f32_dpp v203, v243, v87 row_newbcast:15 row_mask:0xf bank_mask:0xf
    v_cvt_pk_bf16_f32 v82, v196, v197
    v_cvt_pk_bf16_f32 v86, v198, v199
    v_cvt_pk_bf16_f32 v83, v200, v201
    v_cvt_pk_bf16_f32 v87, v202, v203
    s_waitcnt vmcnt(4) lgkmcnt(0)
    v_mfma_f32_32x32x16_bf16 v[56:71], v[80:83], v[176:179], v[56:71]
    v_mul_f32_dpp v196, v242, v88 row_newbcast:0 row_mask:0xf bank_mask:0xf
    v_mul_f32_dpp v197, v242, v89 row_newbcast:1 row_mask:0xf bank_mask:0xf
    v_mul_f32_dpp v198, v242, v88 row_newbcast:8 row_mask:0xf bank_mask:0xf
    v_mul_f32_dpp v199, v242, v89 row_newbcast:9 row_mask:0xf bank_mask:0xf
    v_mul_f32_dpp v200, v242, v92 row_newbcast:2 row_mask:0xf bank_mask:0xf
    v_mul_f32_dpp v201, v242, v93 row_newbcast:3 row_mask:0xf bank_mask:0xf
    s_add_u32 m0, s21, 2048
    v_mfma_f32_32x32x16_bf16 v[16:31], v[84:87], v[176:179], v[16:31]
    buffer_load_dwordx4 v238, s[4:7], s35 offen  lds
    buffer_load_dwordx4 v239, s[8:11], s35 offen offset:1024  lds
    ds_read_b64_tr_b16 v[176:177], v244 offset:4096
    ds_read_b64_tr_b16 v[178:179], v244 offset:5120
    ds_read_b64_tr_b16 v[188:189], v245 offset:4096
    ds_read_b64_tr_b16 v[190:191], v245 offset:5120
    v_mul_f32_dpp v202, v242, v92 row_newbcast:10 row_mask:0xf bank_mask:0xf
    v_mul_f32_dpp v203, v242, v93 row_newbcast:11 row_mask:0xf bank_mask:0xf
    v_cvt_pk_bf16_f32 v88, v196, v197
    v_cvt_pk_bf16_f32 v92, v198, v199
    v_cvt_pk_bf16_f32 v89, v200, v201
    v_cvt_pk_bf16_f32 v93, v202, v203
    v_mul_f32_dpp v196, v242, v90 row_newbcast:4 row_mask:0xf bank_mask:0xf
    v_mul_f32_dpp v197, v242, v91 row_newbcast:5 row_mask:0xf bank_mask:0xf
    v_mul_f32_dpp v198, v242, v90 row_newbcast:12 row_mask:0xf bank_mask:0xf
    v_mul_f32_dpp v199, v242, v91 row_newbcast:13 row_mask:0xf bank_mask:0xf
    v_mul_f32_dpp v200, v242, v94 row_newbcast:6 row_mask:0xf bank_mask:0xf
    v_mul_f32_dpp v201, v242, v95 row_newbcast:7 row_mask:0xf bank_mask:0xf
    v_mul_f32_dpp v202, v242, v94 row_newbcast:14 row_mask:0xf bank_mask:0xf
    v_mul_f32_dpp v203, v242, v95 row_newbcast:15 row_mask:0xf bank_mask:0xf
    v_cvt_pk_bf16_f32 v90, v196, v197
    v_cvt_pk_bf16_f32 v94, v198, v199
    v_cvt_pk_bf16_f32 v91, v200, v201
    v_cvt_pk_bf16_f32 v95, v202, v203
    s_waitcnt lgkmcnt(0)
    v_mfma_f32_32x32x16_bf16 v[56:71], v[88:91], v[176:179], v[56:71]
    s_add_u32 m0, s21, 4096
    v_mfma_f32_32x32x16_bf16 v[16:31], v[92:95], v[176:179], v[16:31]
    buffer_load_dwordx4 v234, s[4:7], s36 offen  lds
    buffer_load_dwordx4 v235, s[8:11], s36 offen offset:1024  lds
    s_mov_b32 m0, s50
    s_nop 0
    s_movrels_b32 s71, s23
    s_bfe_u32 s46, s71, 0x30012
    s_mov_b32 m0, s46
    s_and_b32 s66, s71, 0x3ffff
    s_movrels_b32 s68, s57
    s_movrels_b32 s69, s61
    s_sub_u32 s48, s66, s47
    s_mov_b32 s47, s66
    s_lshr_b32 s52, s71, 28
    s_lshl_b32 s67, s46, 9
    s_add_u32 s66, s66, s67
    s_sub_u32 s49, s66, s42
    s_mov_b32 s42, s66
    s_bfe_u32 s66, s68, 655360
    s_add_u32 s43, s42, s66
    s_bfe_u32 s39, s69, 655360
    s_bfe_u32 s66, s68, 655370
    s_add_u32 s44, s42, s66
    s_bfe_u32 s40, s69, 655370
    s_bfe_u32 s66, s68, 655380
    s_add_u32 s45, s42, s66
    s_bfe_u32 s41, s69, 655380
    s_and_b32 s66, s46, s33
    s_cselect_b32 s72, -1, 1
    s_cselect_b32 s76, s47, 163712
    s_cmp_ge_u32 s66, 2
    s_cselect_b32 s73, -1, 0
    s_add_u32 s77, s47, 1024
    s_cmp_ge_u32 s66, 4
    s_cselect_b32 s75, -1, 0
    s_cmp_ge_u32 s66, 3
    s_cselect_b32 s74, -1, 1
    s_cselect_b32 s77, s77, 163712
    v_add_u32 v252, s45, v247
    ds_read2_b32 v[240:241], v252 offset0:0 offset1:16
    v_mfma_f32_32x32x16_bf16 v[32:47], v[72:75], v[180:183], 0
    v_mul_f32 v196, v56, v96
    v_fmac_f32 v196, v57, v97
    v_fmac_f32 v196, v58, v98
    v_fmac_f32 v196, v59, v99
    v_fmac_f32 v196, v60, v100
    v_fmac_f32 v196, v61, v101
    v_mfma_f32_32x32x16_bf16 v[0:15], v[76:79], v[180:183], 0
    v_fmac_f32 v196, v62, v102
    v_fmac_f32 v196, v63, v103
    v_mul_f32 v198, v64, v128
    v_fmac_f32 v198, v65, v129
    v_fmac_f32 v198, v66, v130
    v_fmac_f32 v198, v67, v131
    v_mfma_f32_32x32x16_bf16 v[32:47], v[80:83], v[184:187], v[32:47]
    v_fmac_f32 v198, v68, v132
    v_fmac_f32 v198, v69, v133
    v_fmac_f32 v198, v70, v134
    v_fmac_f32 v198, v71, v135
    v_mul_f32 v200, v16, v128
    v_fmac_f32 v200, v17, v129
    v_mfma_f32_32x32x16_bf16 v[0:15], v[84:87], v[184:187], v[0:15]
    s_waitcnt vmcnt(6)
    ds_read_b64_tr_b16 v[176:177], v244 offset:6144
    ds_read_b64_tr_b16 v[178:179], v244 offset:7168
    ds_read_b64_tr_b16 v[180:181], v245 offset:6144
    ds_read_b64_tr_b16 v[182:183], v245 offset:7168
    v_permlane32_swap_b32 v196, v198
    v_fmac_f32 v200, v18, v130
    v_mfma_f32_32x32x16_bf16 v[32:47], v[88:91], v[188:191], v[32:47]
    v_fmac_f32 v200, v19, v131
    v_fmac_f32 v200, v20, v132
    v_fmac_f32 v200, v21, v133
    v_fmac_f32 v200, v22, v134
    v_fmac_f32 v200, v23, v135
    v_add_f32 v198, v196, v198
    v_mfma_f32_32x32x16_bf16 v[0:15], v[92:95], v[188:191], v[0:15]
    v_mul_f32_e64 v202, v24, -v128
    v_fma_f32 v202, v25, -v129, v202
    v_fma_f32 v202, v26, -v130, v202
    v_fma_f32 v202, v27, -v131, v202
    v_fma_f32 v202, v28, -v132, v202
    v_fma_f32 v202, v29, -v133, v202
    v_fma_f32 v202, v30, -v134, v202
    v_fma_f32 v202, v31, -v135, v202
    s_nop 1
    v_permlane32_swap_b32 v200, v202
    v_add_f32 v202, v200, v202
    s_waitcnt vmcnt(4) lgkmcnt(0)
    v_mfma_f32_32x32x16_bf16 v[56:71], v[72:75], v[176:179], 0
    v_mul_f32 v197, v32, v104
    v_fmac_f32 v197, v33, v105
    v_fmac_f32 v197, v34, v106
    v_fmac_f32 v197, v35, v107
    v_fmac_f32 v197, v36, v108
    v_fmac_f32 v197, v37, v109
    s_add_u32 m0, s21, 6144
    v_mfma_f32_32x32x16_bf16 v[16:31], v[76:79], v[176:179], 0
    buffer_load_dwordx4 v236, s[4:7], s36 offen  lds
    buffer_load_dwordx4 v237, s[8:11], s36 offen offset:1024  lds
    ds_read_b64_tr_b16 v[176:177], v244 offset:0
    ds_read_b64_tr_b16 v[178:179], v244 offset:1024
    ds_read_b64_tr_b16 v[184:185], v245 offset:0
    ds_read_b64_tr_b16 v[186:187], v245 offset:1024
    v_fmac_f32 v197, v38, v110
    v_fmac_f32 v197, v39, v111
    v_mul_f32 v199, v40, v136
    v_fmac_f32 v199, v41, v137
    v_fmac_f32 v199, v42, v138
    v_fmac_f32 v199, v43, v139
    v_fmac_f32 v199, v44, v140
    v_fmac_f32 v199, v45, v141
    v_fmac_f32 v199, v46, v142
    v_fmac_f32 v199, v47, v143
    v_mul_f32 v201, v0, v136
    v_fmac_f32 v201, v1, v137
    v_permlane32_swap_b32 v197, v199
    v_fmac_f32 v201, v2, v138
    v_fmac_f32 v201, v3, v139
    v_fmac_f32 v201, v4, v140
    v_fmac_f32 v201, v5, v141
    v_fmac_f32 v201, v6, v142
    s_waitcnt vmcnt(4) lgkmcnt(0)
    v_mfma_f32_32x32x16_bf16 v[56:71], v[80:83], v[176:179], v[56:71]
    v_fmac_f32 v201, v7, v143
    v_add_f32 v199, v197, v199
    v_mul_f32_e64 v203, v8, -v136
    v_fma_f32 v203, v9, -v137, v203
    v_fma_f32 v203, v10, -v138, v203
    v_fma_f32 v203, v11, -v139, v203
    s_add_u32 m0, s21, 0
    v_mfma_f32_32x32x16_bf16 v[16:31], v[84:87], v[176:179], v[16:31]
    buffer_load_dwordx4 v238, s[4:7], s36 offen  lds
    buffer_load_dwordx4 v239, s[8:11], s36 offen offset:1024  lds
    ds_read_b64_tr_b16 v[176:177], v244 offset:2048
    ds_read_b64_tr_b16 v[178:179], v244 offset:3072
    ds_read_b64_tr_b16 v[188:189], v245 offset:2048
    ds_read_b64_tr_b16 v[190:191], v245 offset:3072
    s_waitcnt lgkmcnt(0)
    v_mfma_f32_32x32x16_bf16 v[56:71], v[88:91], v[176:179], v[56:71]
    v_fma_f32 v203, v12, -v140, v203
    v_fma_f32 v203, v13, -v141, v203
    v_fma_f32 v203, v14, -v142, v203
    v_fma_f32 v203, v15, -v143, v203
    s_nop 1
    v_permlane32_swap_b32 v201, v203
    v_add_f32 v203, v201, v203
    s_add_u32 m0, s21, 2048
    v_mfma_f32_32x32x16_bf16 v[16:31], v[92:95], v[176:179], v[16:31]
    buffer_load_dwordx4 v234, s[4:7], s37 offen  lds
    buffer_load_dwordx4 v235, s[8:11], s37 offen offset:1024  lds
    v_add_u32 v252, s42, v247
    ds_read2_b32 v[234:235], v252 offset0:0 offset1:16
    s_set_gpr_idx_on s51, gpr_idx(DST)
    s_nop 0
    v_cvt_pk_bf16_f32 v204, v198, v199
    v_cvt_pk_bf16_f32 v205, v202, v203
    s_set_gpr_idx_off
    v_mfma_f32_32x32x16_bf16 v[32:47], v[72:75], v[180:183], 0
    v_mul_f32 v196, v56, v144
    v_fmac_f32 v196, v57, v145
    v_fmac_f32 v196, v58, v146
    v_fmac_f32 v196, v59, v147
    v_fmac_f32 v196, v60, v148
    v_fmac_f32 v196, v61, v149
    v_mfma_f32_32x32x16_bf16 v[0:15], v[76:79], v[180:183], 0
    v_fmac_f32 v196, v62, v150
    v_fmac_f32 v196, v63, v151
    v_mul_f32_e64 v200, v16, -v160
    v_fma_f32 v200, v17, -v161, v200
    v_fma_f32 v200, v18, -v162, v200
    v_fma_f32 v200, v19, -v163, v200
    v_mfma_f32_32x32x16_bf16 v[32:47], v[80:83], v[184:187], v[32:47]
    v_fma_f32 v200, v20, -v164, v200
    v_fma_f32 v200, v21, -v165, v200
    v_fma_f32 v200, v22, -v166, v200
    v_fma_f32 v200, v23, -v167, v200
    v_mul_f32_e64 v202, v24, -v160
    v_fma_f32 v202, v25, -v161, v202
    v_mfma_f32_32x32x16_bf16 v[0:15], v[84:87], v[184:187], v[0:15]
    s_waitcnt vmcnt(6)
    ds_read_b64_tr_b16 v[176:177], v244 offset:4096
    ds_read_b64_tr_b16 v[178:179], v244 offset:5120
    ds_read_b64_tr_b16 v[180:181], v245 offset:4096
    ds_read_b64_tr_b16 v[182:183], v245 offset:5120
    v_fma_f32 v202, v26, -v162, v202
    v_fma_f32 v202, v27, -v163, v202
    v_mfma_f32_32x32x16_bf16 v[32:47], v[88:91], v[188:191], v[32:47]
    v_fma_f32 v202, v28, -v164, v202
    v_fma_f32 v202, v29, -v165, v202
    v_fma_f32 v202, v30, -v166, v202
    v_fma_f32 v202, v31, -v167, v202
    v_mfma_f32_32x32x16_bf16 v[0:15], v[92:95], v[188:191], v[0:15]
    s_waitcnt vmcnt(4) lgkmcnt(0)
    v_mfma_f32_32x32x16_bf16 v[16:31], v[72:75], v[176:179], 0
    s_nop 4
    v_mul_f32 v197, v32, v152
    v_fmac_f32 v197, v33, v153
    v_fmac_f32 v197, v34, v154
    v_fmac_f32 v197, v35, v155
    v_fmac_f32 v197, v36, v156
    v_fmac_f32 v197, v37, v157
    s_add_u32 m0, s21, 4096
    v_mfma_f32_32x32x16_bf16 v[48:63], v[76:79], v[176:179], 0
    buffer_load_dwordx4 v236, s[4:7], s37 offen  lds
    buffer_load_dwordx4 v237, s[8:11], s37 offen offset:1024  lds
    ds_read_b64_tr_b16 v[176:177], v244 offset:6144
    ds_read_b64_tr_b16 v[178:179], v244 offset:7168
    ds_read_b64_tr_b16 v[184:185], v245 offset:6144
    ds_read_b64_tr_b16 v[186:187], v245 offset:7168
    v_add_u32 v252, s43, v247
    ds_read2_b32 v[236:237], v252 offset0:0 offset1:16
    v_fmac_f32 v197, v38, v158
    v_fmac_f32 v197, v39, v159
    v_mul_f32_e64 v201, v0, -v168
    v_fma_f32 v201, v1, -v169, v201
    s_waitcnt vmcnt(4) lgkmcnt(1)
    v_mfma_f32_32x32x16_bf16 v[16:31], v[80:83], v[176:179], v[16:31]
    v_fma_f32 v201, v2, -v170, v201
    v_fma_f32 v201, v3, -v171, v201
    v_fma_f32 v201, v4, -v172, v201
    v_fma_f32 v201, v5, -v173, v201
    v_fma_f32 v201, v6, -v174, v201
    v_fma_f32 v201, v7, -v175, v201
    s_add_u32 m0, s21, 6144
    v_mfma_f32_32x32x16_bf16 v[48:63], v[84:87], v[176:179], v[48:63]
    buffer_load_dwordx4 v238, s[4:7], s37 offen  lds
    buffer_load_dwordx4 v239, s[8:11], s37 offen offset:1024  lds
    ds_read_b64_tr_b16 v[176:177], v244 offset:0
    ds_read_b64_tr_b16 v[178:179], v244 offset:1024
    ds_read_b64_tr_b16 v[188:189], v245 offset:0
    ds_read_b64_tr_b16 v[190:191], v245 offset:1024
    v_add_u32 v252, s44, v247
    ds_read2_b32 v[238:239], v252 offset0:0 offset1:16
    s_waitcnt lgkmcnt(1)
    v_mfma_f32_32x32x16_bf16 v[16:31], v[88:91], v[176:179], v[16:31]
    v_mul_f32_e64 v203, v8, -v168
    v_fma_f32 v203, v9, -v169, v203
    v_fma_f32 v203, v10, -v170, v203
    v_fma_f32 v203, v11, -v171, v203
    v_fma_f32 v203, v12, -v172, v203
    v_fma_f32 v203, v13, -v173, v203
    s_add_u32 m0, s21, 0
    v_mfma_f32_32x32x16_bf16 v[48:63], v[92:95], v[176:179], v[48:63]
    v_mad_u32_u16 v234, v234, s3, v246 op_sel:[1,0,0,0]
    v_mad_u32_u16 v235, v235, s3, v246 op_sel:[1,0,0,0]
    buffer_load_dwordx4 v234, s[4:7], s38 offen  lds
    buffer_load_dwordx4 v235, s[8:11], s38 offen offset:1024  lds
    v_fma_f32 v203, v14, -v174, v203
    v_fma_f32 v203, v15, -v175, v203
    v_mfma_f32_32x32x16_bf16 v[0:15], v[72:75], v[180:183], 0
    v_fmac_f32 v200, v24, v160
    v_fmac_f32 v200, v25, v161
    v_fmac_f32 v200, v26, v162
    v_fmac_f32 v200, v27, v163
    v_fmac_f32 v200, v28, v164
    v_fmac_f32 v200, v29, v165
    v_fmac_f32 v200, v30, v166
    v_fmac_f32 v200, v31, v167
    v_mfma_f32_32x32x16_bf16 v[24:39], v[76:79], v[180:183], 0
    v_add_u32 v253, s47, v248
    ds_read_b32 v192, v253
    ds_read_b32 v193, v253 offset:256
    v_mul_f32 v254, v16, v144
    v_fmac_f32 v254, v17, v145
    v_fmac_f32 v254, v18, v146
    v_mfma_f32_32x32x16_bf16 v[0:15], v[80:83], v[184:187], v[0:15]
    v_fmac_f32 v254, v19, v147
    v_fmac_f32 v254, v20, v148
    v_fmac_f32 v254, v21, v149
    v_fmac_f32 v254, v22, v150
    v_fmac_f32 v254, v23, v151
    v_sub_f32_e64 v64, -v48, v64
    v_mfma_f32_32x32x16_bf16 v[24:39], v[84:87], v[184:187], v[24:39]
    s_waitcnt vmcnt(6)
    ds_read_b64_tr_b16 v[176:177], v244 offset:2048
    ds_read_b64_tr_b16 v[178:179], v244 offset:3072
    ds_read_b64_tr_b16 v[180:181], v245 offset:2048
    ds_read_b64_tr_b16 v[182:183], v245 offset:3072
    v_sub_f32_e64 v65, -v49, v65
    v_permlane32_swap_b32 v196, v254
    v_mfma_f32_32x32x16_bf16 v[24:39], v[92:95], v[188:191], v[24:39]
    v_sub_f32_e64 v66, -v50, v66
    v_sub_f32_e64 v67, -v51, v67
    v_sub_f32_e64 v68, -v52, v68
    v_sub_f32_e64 v69, -v53, v69
    v_sub_f32_e64 v70, -v54, v70
    v_sub_f32_e64 v71, -v55, v71
    v_mfma_f32_32x32x16_bf16 v[0:15], v[88:91], v[188:191], v[0:15]
    v_add_f32 v254, v196, v254
    s_waitcnt vmcnt(4) lgkmcnt(0)
    v_mfma_f32_32x32x16_bf16 v[56:71], v[76:79], v[176:179], v[56:71]
    s_nop 1
    v_sub_f32_e64 v40, -v24, v40
    v_sub_f32_e64 v41, -v25, v41
    v_sub_f32_e64 v42, -v26, v42
    v_sub_f32_e64 v43, -v27, v43
    v_sub_f32_e64 v44, -v28, v44
    v_sub_f32_e64 v45, -v29, v45
    v_sub_f32_e64 v46, -v30, v46
    v_sub_f32_e64 v47, -v31, v47
    s_mov_b32 m0, s76
    s_mov_b64 exec, s[72:73]
    buffer_load_dwordx4 v192, s[12:15], 0 offen  lds
    s_mov_b32 m0, s77
    s_mov_b64 exec, s[74:75]
    buffer_load_dwordx4 v193, s[12:15], 0 offen  lds
    s_mov_b64 exec, -1
    s_add_u32 m0, s21, 2048
    v_mfma_f32_32x32x16_bf16 v[16:31], v[72:75], v[176:179], 0
    v_mad_u32_u16 v236, v236, s3, v246 op_sel:[1,0,0,0]
    v_mad_u32_u16 v237, v237, s3, v246 op_sel:[1,0,0,0]
    buffer_load_dwordx4 v236, s[4:7], s39 offen  lds
    buffer_load_dwordx4 v237, s[8:11], s39 offen offset:1024  lds
    ds_read_b64_tr_b16 v[176:177], v244 offset:4096
    ds_read_b64_tr_b16 v[178:179], v244 offset:5120
    ds_read_b64_tr_b16 v[184:185], v245 offset:4096
    ds_read_b64_tr_b16 v[186:187], v245 offset:5120
    v_mul_f32 v255, v0, v152
    v_fmac_f32 v255, v1, v153
    v_fmac_f32 v255, v2, v154
    v_fmac_f32 v255, v3, v155
    v_fmac_f32 v255, v4, v156
    s_waitcnt vmcnt(6) lgkmcnt(0)
    v_mfma_f32_32x32x16_bf16 v[16:31], v[80:83], v[176:179], v[16:31]
    v_fmac_f32 v255, v5, v157
    v_fmac_f32 v255, v6, v158
    v_fmac_f32 v255, v7, v159
    v_fmac_f32 v201, v8, v168
    v_fmac_f32 v201, v9, v169
    v_permlane32_swap_b32 v197, v255
    s_add_u32 m0, s21, 4096
    v_mfma_f32_32x32x16_bf16 v[56:71], v[84:87], v[176:179], v[56:71]
    v_mad_u32_u16 v238, v238, s3, v246 op_sel:[1,0,0,0]
    v_mad_u32_u16 v239, v239, s3, v246 op_sel:[1,0,0,0]
    buffer_load_dwordx4 v238, s[4:7], s40 offen  lds
    buffer_load_dwordx4 v239, s[8:11], s40 offen offset:1024  lds
    ds_read_b64_tr_b16 v[176:177], v244 offset:6144
    ds_read_b64_tr_b16 v[178:179], v244 offset:7168
    ds_read_b64_tr_b16 v[188:189], v245 offset:6144
    ds_read_b64_tr_b16 v[190:191], v245 offset:7168
    s_waitcnt lgkmcnt(0)
    v_mfma_f32_32x32x16_bf16 v[16:31], v[88:91], v[176:179], v[16:31]
    v_fmac_f32 v201, v10, v170
    v_fmac_f32 v201, v11, v171
    v_fmac_f32 v201, v12, v172
    v_fmac_f32 v201, v13, v173
    v_fmac_f32 v201, v14, v174
    v_fmac_f32 v201, v15, v175
    s_add_u32 m0, s21, 6144
    v_mfma_f32_32x32x16_bf16 v[56:71], v[92:95], v[176:179], v[56:71]
    v_mad_u32_u16 v240, v240, s3, v246 op_sel:[1,0,0,0]
    v_mad_u32_u16 v241, v241, s3, v246 op_sel:[1,0,0,0]
    buffer_load_dwordx4 v240, s[4:7], s41 offen  lds
    buffer_load_dwordx4 v241, s[8:11], s41 offen offset:1024  lds
    v_add_f32 v255, v197, v255
    s_set_gpr_idx_on s51, gpr_idx(DST)
    s_nop 0
    v_cvt_pk_bf16_f32 v206, v254, v255
    s_set_gpr_idx_off
    v_mfma_f32_32x32x16_bf16 v[0:15], v[72:75], v[180:183], 0
    v_mul_f32 v254, v16, v144
    v_fmac_f32 v254, v17, v145
    v_fmac_f32 v254, v18, v146
    v_fmac_f32 v254, v19, v147
    v_fmac_f32 v254, v20, v148
    v_fmac_f32 v254, v21, v149
    v_mfma_f32_32x32x16_bf16 v[32:47], v[76:79], v[180:183], v[32:47]
    v_fmac_f32 v254, v22, v150
    v_fmac_f32 v254, v23, v151
    v_fma_f32 v202, v24, -v160, v202
    v_fma_f32 v202, v25, -v161, v202
    v_permlane32_swap_b32 v254, v200
    v_fma_f32 v202, v26, -v162, v202
    v_mfma_f32_32x32x16_bf16 v[0:15], v[80:83], v[184:187], v[0:15]
    v_fma_f32 v202, v27, -v163, v202
    v_fma_f32 v202, v28, -v164, v202
    v_fma_f32 v202, v29, -v165, v202
    v_fma_f32 v202, v30, -v166, v202
    v_fma_f32 v202, v31, -v167, v202
    v_add_f32 v200, v254, v200
    v_mfma_f32_32x32x16_bf16 v[32:47], v[84:87], v[184:187], v[32:47]
    s_waitcnt vmcnt(8)
    ds_read_b64_tr_b16 v[176:177], v244 offset:0
    ds_read_b64_tr_b16 v[178:179], v244 offset:1024
    ds_read_b64_tr_b16 v[180:181], v245 offset:0
    ds_read_b64_tr_b16 v[182:183], v245 offset:1024
    v_mul_f32_e64 v198, v64, -v112
    v_permlane32_swap_b32 v202, v254
    v_mfma_f32_32x32x16_bf16 v[0:15], v[88:91], v[188:191], v[0:15]
    v_fma_f32 v198, v65, -v113, v198
    v_fma_f32 v198, v66, -v114, v198
    v_fma_f32 v198, v67, -v115, v198
    v_fma_f32 v198, v68, -v116, v198
    v_fma_f32 v198, v69, -v117, v198
    v_fma_f32 v198, v70, -v118, v198
    v_mfma_f32_32x32x16_bf16 v[32:47], v[92:95], v[188:191], v[32:47]
    v_add_u32 v249, s48, v249
    v_add_u32 v250, s49, v250
    v_fma_f32 v198, v71, -v119, v198
    v_add_f32 v254, v202, v254
    v_mul_f32 v196, v56, v160
    v_fmac_f32 v196, v57, v161
    v_fmac_f32 v196, v58, v162
    v_fmac_f32 v196, v59, v163
    v_fmac_f32 v196, v60, v164
    v_fmac_f32 v196, v61, v165
    v_fmac_f32 v196, v62, v166
    v_fmac_f32 v196, v63, v167
    s_nop 1
    v_permlane32_swap_b32 v198, v196
    v_add_f32 v196, v198, v196
    v_mul_f32 v255, v0, v152
    v_fmac_f32 v255, v1, v153
    v_fmac_f32 v255, v2, v154
    v_fmac_f32 v255, v3, v155
    v_fmac_f32 v255, v4, v156
    v_fmac_f32 v255, v5, v157
    v_fmac_f32 v255, v6, v158
    v_fmac_f32 v255, v7, v159
    v_fma_f32 v203, v8, -v168, v203
    v_fma_f32 v203, v9, -v169, v203
    v_permlane32_swap_b32 v255, v201
    v_fma_f32 v203, v10, -v170, v203
    v_fma_f32 v203, v11, -v171, v203
    v_fma_f32 v203, v12, -v172, v203
    v_fma_f32 v203, v13, -v173, v203
    v_fma_f32 v203, v14, -v174, v203
    v_fma_f32 v203, v15, -v175, v203
    v_add_f32 v201, v255, v201
    v_mul_f32_e64 v199, v40, -v120
    v_permlane32_swap_b32 v203, v255
    v_fma_f32 v199, v41, -v121, v199
    v_fma_f32 v199, v42, -v122, v199
    v_fma_f32 v199, v43, -v123, v199
    s_waitcnt vmcnt(6)
    ds_read_b64_tr_b16 v[72:73], v249 offset:0
    ds_read_b64_tr_b16 v[76:77], v249 offset:64
    ds_read_b64_tr_b16 v[74:75], v249 offset:256
    ds_read_b64_tr_b16 v[78:79], v249 offset:320
    s_mov_b64 exec, s[54:55]
    ds_read_u16_d16_hi v242, v250 offset:0
    s_mov_b64 exec, -1
    v_fma_f32 v199, v44, -v124, v199
    v_fma_f32 v199, v45, -v125, v199
    v_fma_f32 v199, v46, -v126, v199
    v_fma_f32 v199, v47, -v127, v199
    v_add_f32 v255, v203, v255
    v_mul_f32 v197, v32, v168
    v_fmac_f32 v197, v33, v169
    v_fmac_f32 v197, v34, v170
    v_fmac_f32 v197, v35, v171
    v_fmac_f32 v197, v36, v172
    v_fmac_f32 v197, v37, v173
    v_fmac_f32 v197, v38, v174
    v_fmac_f32 v197, v39, v175
    s_nop 1
    v_permlane32_swap_b32 v199, v197
    v_add_f32 v197, v199, v197
    s_set_gpr_idx_on s51, gpr_idx(DST)
    s_nop 0
    v_cvt_pk_bf16_f32 v207, v200, v201
    v_cvt_pk_bf16_f32 v209, v254, v255
    v_cvt_pk_bf16_f32 v208, v196, v197
    s_set_gpr_idx_off
    s_add_u32 s50, s50, 1
    s_add_u32 s51, s51, 6
    s_cmp_ge_u32 s50, 4
    s_cbranch_scc1 LAST0
    s_add_u32 s53, s53, 4
    s_xor_b32 s66, s53, s20
    s_bitcmp1_b32 s66, 2
    s_setprio 1
    s_cbranch_scc1 PRIO_8
    s_setprio 0
PRIO_8:
    s_cmp_eq_u32 s52, 4
    s_cbranch_scc1 ITEM_0_4
    s_cmp_eq_u32 s52, 5
    s_cbranch_scc1 ITEM_0_5
    s_cmp_eq_u32 s52, 3
    s_cbranch_scc1 ITEM_0_3
    s_cmp_eq_u32 s52, 6
    s_cbranch_scc1 ITEM_0_6
    s_cmp_eq_u32 s52, 8
    s_cbranch_scc1 ITEM_0_8
    s_branch ITEM_0_2
.p2align 6
ITEM_0_8:
    s_mov_b64 exec, s[54:55]
    ds_read_u16_d16_hi v243, v250 offset:128
    s_mov_b64 exec, -1
    ds_read_b64_tr_b16 v[80:81], v249 offset:512
    ds_read_b64_tr_b16 v[84:85], v249 offset:576
    ds_read_b64_tr_b16 v[82:83], v249 offset:768
    ds_read_b64_tr_b16 v[86:87], v249 offset:832
    ds_read_b64_tr_b16 v[88:89], v249 offset:1024
    ds_read_b64_tr_b16 v[92:93], v249 offset:1088
    ds_read_b64_tr_b16 v[90:91], v249 offset:1280
    ds_read_b64_tr_b16 v[94:95], v249 offset:1344
    ds_read_b64_tr_b16 v[64:65], v249 offset:1536
    ds_read_b64_tr_b16 v[68:69], v249 offset:1600
    ds_read_b64_tr_b16 v[66:67], v249 offset:1792
    ds_read_b64_tr_b16 v[70:71], v249 offset:1856
    s_waitcnt lgkmcnt(13)
    v_mul_f32_dpp v196, v242, v72 row_newbcast:0 row_mask:0xf bank_mask:0xf
    v_mul_f32_dpp v197, v242, v73 row_newbcast:1 row_mask:0xf bank_mask:0xf
    v_mul_f32_dpp v198, v242, v72 row_newbcast:8 row_mask:0xf bank_mask:0xf
    v_mul_f32_dpp v199, v242, v73 row_newbcast:9 row_mask:0xf bank_mask:0xf
    v_mul_f32_dpp v200, v242, v76 row_newbcast:2 row_mask:0xf bank_mask:0xf
    v_mul_f32_dpp v201, v242, v77 row_newbcast:3 row_mask:0xf bank_mask:0xf
    v_mul_f32_dpp v202, v242, v76 row_newbcast:10 row_mask:0xf bank_mask:0xf
    v_mul_f32_dpp v203, v242, v77 row_newbcast:11 row_mask:0xf bank_mask:0xf
    v_cvt_pk_bf16_f32 v72, v196, v197
    v_cvt_pk_bf16_f32 v76, v198, v199
    v_cvt_pk_bf16_f32 v73, v200, v201
    v_cvt_pk_bf16_f32 v77, v202, v203
    v_mul_f32_dpp v196, v242, v74 row_newbcast:4 row_mask:0xf bank_mask:0xf
    v_mul_f32_dpp v197, v242, v75 row_newbcast:5 row_mask:0xf bank_mask:0xf
    v_mul_f32_dpp v198, v242, v74 row_newbcast:12 row_mask:0xf bank_mask:0xf
    v_mul_f32_dpp v199, v242, v75 row_newbcast:13 row_mask:0xf bank_mask:0xf
    v_mul_f32_dpp v200, v242, v78 row_newbcast:6 row_mask:0xf bank_mask:0xf
    v_mul_f32_dpp v201, v242, v79 row_newbcast:7 row_mask:0xf bank_mask:0xf
    v_mul_f32_dpp v202, v242, v78 row_newbcast:14 row_mask:0xf bank_mask:0xf
    v_mul_f32_dpp v203, v242, v79 row_newbcast:15 row_mask:0xf bank_mask:0xf
    v_cvt_pk_bf16_f32 v74, v196, v197
    v_cvt_pk_bf16_f32 v78, v198, v199
    v_cvt_pk_bf16_f32 v75, v200, v201
    v_cvt_pk_bf16_f32 v79, v202, v203
    s_mov_b64 exec, s[54:55]
    ds_read_u16_d16_hi v242, v250 offset:256
    s_mov_b64 exec, -1
    s_waitcnt vmcnt(4) lgkmcnt(9)
    v_mfma_f32_32x32x16_bf16 v[0:15], v[72:75], v[176:179], 0
    v_mul_f32_dpp v196, v243, v80 row_newbcast:0 row_mask:0xf bank_mask:0xf
    v_mul_f32_dpp v197, v243, v81 row_newbcast:1 row_mask:0xf bank_mask:0xf
    v_mul_f32_dpp v198, v243, v80 row_newbcast:8 row_mask:0xf bank_mask:0xf
    v_mul_f32_dpp v199, v243, v81 row_newbcast:9 row_mask:0xf bank_mask:0xf
    v_mul_f32_dpp v200, v243, v84 row_newbcast:2 row_mask:0xf bank_mask:0xf
    v_mul_f32_dpp v201, v243, v85 row_newbcast:3 row_mask:0xf bank_mask:0xf
    s_add_u32 m0, s21, 0
    v_mfma_f32_32x32x16_bf16 v[48:63], v[76:79], v[176:179], 0
    buffer_load_dwordx4 v234, s[4:7], s35 offen  lds
    buffer_load_dwordx4 v235, s[8:11], s35 offen offset:1024  lds
    ds_read_b64_tr_b16 v[176:177], v244 offset:2048
    ds_read_b64_tr_b16 v[178:179], v244 offset:3072
    ds_read_b64_tr_b16 v[184:185], v245 offset:2048
    ds_read_b64_tr_b16 v[186:187], v245 offset:3072
    v_mul_f32_dpp v202, v243, v84 row_newbcast:10 row_mask:0xf bank_mask:0xf
    v_mul_f32_dpp v203, v243, v85 row_newbcast:11 row_mask:0xf bank_mask:0xf
    v_cvt_pk_bf16_f32 v80, v196, v197
    v_cvt_pk_bf16_f32 v84, v198, v199
    v_cvt_pk_bf16_f32 v81, v200, v201
    v_cvt_pk_bf16_f32 v85, v202, v203
    v_mul_f32_dpp v196, v243, v82 row_newbcast:4 row_mask:0xf bank_mask:0xf
    v_mul_f32_dpp v197, v243, v83 row_newbcast:5 row_mask:0xf bank_mask:0xf
    v_mul_f32_dpp v198, v243, v82 row_newbcast:12 row_mask:0xf bank_mask:0xf
    v_mul_f32_dpp v199, v243, v83 row_newbcast:13 row_mask:0xf bank_mask:0xf
    v_mul_f32_dpp v200, v243, v86 row_newbcast:6 row_mask:0xf bank_mask:0xf
    v_mul_f32_dpp v201, v243, v87 row_newbcast:7 row_mask:0xf bank_mask:0xf
    v_mul_f32_dpp v202, v243, v86 row_newbcast:14 row_mask:0xf bank_mask:0xf
    v_mul_f32_dpp v203, v243, v87 row_newbcast:15 row_mask:0xf bank_mask:0xf
    v_cvt_pk_bf16_f32 v82, v196, v197
    v_cvt_pk_bf16_f32 v86, v198, v199
    v_cvt_pk_bf16_f32 v83, v200, v201
    v_cvt_pk_bf16_f32 v87, v202, v203
    s_mov_b64 exec, s[54:55]
    ds_read_u16_d16_hi v243, v250 offset:384
    s_mov_b64 exec, -1
    s_waitcnt vmcnt(4) lgkmcnt(1)
    v_mfma_f32_32x32x16_bf16 v[0:15], v[80:83], v[176:179], v[0:15]
    v_mul_f32_dpp v196, v242, v88 row_newbcast:0 row_mask:0xf bank_mask:0xf
    v_mul_f32_dpp v197, v242, v89 row_newbcast:1 row_mask:0xf bank_mask:0xf
    v_mul_f32_dpp v198, v242, v88 row_newbcast:8 row_mask:0xf bank_mask:0xf
    v_mul_f32_dpp v199, v242, v89 row_newbcast:9 row_mask:0xf bank_mask:0xf
    v_mul_f32_dpp v200, v242, v92 row_newbcast:2 row_mask:0xf bank_mask:0xf
    v_mul_f32_dpp v201, v242, v93 row_newbcast:3 row_mask:0xf bank_mask:0xf
    s_add_u32 m0, s21, 2048
    v_mfma_f32_32x32x16_bf16 v[48:63], v[84:87], v[176:179], v[48:63]
    buffer_load_dwordx4 v236, s[4:7], s35 offen  lds
    buffer_load_dwordx4 v237, s[8:11], s35 offen offset:1024  lds
    ds_read_b64_tr_b16 v[176:177], v244 offset:4096
    ds_read_b64_tr_b16 v[178:179], v244 offset:5120
    ds_read_b64_tr_b16 v[188:189], v245 offset:4096
    ds_read_b64_tr_b16 v[190:191], v245 offset:5120
    v_mul_f32_dpp v202, v242, v92 row_newbcast:10 row_mask:0xf bank_mask:0xf
    v_mul_f32_dpp v203, v242, v93 row_newbcast:11 row_mask:0xf bank_mask:0xf
    v_cvt_pk_bf16_f32 v88, v196, v197
    v_cvt_pk_bf16_f32 v92, v198, v199
    v_cvt_pk_bf16_f32 v89, v200, v201
    v_cvt_pk_bf16_f32 v93, v202, v203
    v_mul_f32_dpp v196, v242, v90 row_newbcast:4 row_mask:0xf bank_mask:0xf
    v_mul_f32_dpp v197, v242, v91 row_newbcast:5 row_mask:0xf bank_mask:0xf
    v_mul_f32_dpp v198, v242, v90 row_newbcast:12 row_mask:0xf bank_mask:0xf
    v_mul_f32_dpp v199, v242, v91 row_newbcast:13 row_mask:0xf bank_mask:0xf
    v_mul_f32_dpp v200, v242, v94 row_newbcast:6 row_mask:0xf bank_mask:0xf
    v_mul_f32_dpp v201, v242, v95 row_newbcast:7 row_mask:0xf bank_mask:0xf
    v_mul_f32_dpp v202, v242, v94 row_newbcast:14 row_mask:0xf bank_mask:0xf
    v_mul_f32_dpp v203, v242, v95 row_newbcast:15 row_mask:0xf bank_mask:0xf
    v_cvt_pk_bf16_f32 v90, v196, v197
    v_cvt_pk_bf16_f32 v94, v198, v199
    v_cvt_pk_bf16_f32 v91, v200, v201
    v_cvt_pk_bf16_f32 v95, v202, v203
    s_waitcnt vmcnt(4) lgkmcnt(0)
    v_mfma_f32_32x32x16_bf16 v[0:15], v[88:91], v[176:179], v[0:15]
    v_mul_f32_dpp v196, v243, v64 row_newbcast:0 row_mask:0xf bank_mask:0xf
    v_mul_f32_dpp v197, v243, v65 row_newbcast:1 row_mask:0xf bank_mask:0xf
    v_mul_f32_dpp v198, v243, v64 row_newbcast:8 row_mask:0xf bank_mask:0xf
    v_mul_f32_dpp v199, v243, v65 row_newbcast:9 row_mask:0xf bank_mask:0xf
    v_mul_f32_dpp v200, v243, v68 row_newbcast:2 row_mask:0xf bank_mask:0xf
    v_mul_f32_dpp v201, v243, v69 row_newbcast:3 row_mask:0xf bank_mask:0xf
    s_add_u32 m0, s21, 4096
    v_mfma_f32_32x32x16_bf16 v[48:63], v[92:95], v[176:179], v[48:63]
    buffer_load_dwordx4 v238, s[4:7], s35 offen  lds
    buffer_load_dwordx4 v239, s[8:11], s35 offen offset:1024  lds
    ds_read_b64_tr_b16 v[176:177], v244 offset:6144
    ds_read_b64_tr_b16 v[178:179], v244 offset:7168
    ds_read_b64_tr_b16 v[192:193], v245 offset:6144
    ds_read_b64_tr_b16 v[194:195], v245 offset:7168
    v_mul_f32_dpp v202, v243, v68 row_newbcast:10 row_mask:0xf bank_mask:0xf
    v_mul_f32_dpp v203, v243, v69 row_newbcast:11 row_mask:0xf bank_mask:0xf
    v_cvt_pk_bf16_f32 v64, v196, v197
    v_cvt_pk_bf16_f32 v68, v198, v199
    v_cvt_pk_bf16_f32 v65, v200, v201
    v_cvt_pk_bf16_f32 v69, v202, v203
    v_mul_f32_dpp v196, v243, v66 row_newbcast:4 row_mask:0xf bank_mask:0xf
    v_mul_f32_dpp v197, v243, v67 row_newbcast:5 row_mask:0xf bank_mask:0xf
    v_mul_f32_dpp v198, v243, v66 row_newbcast:12 row_mask:0xf bank_mask:0xf
    v_mul_f32_dpp v199, v243, v67 row_newbcast:13 row_mask:0xf bank_mask:0xf
    v_mul_f32_dpp v200, v243, v70 row_newbcast:6 row_mask:0xf bank_mask:0xf
    v_mul_f32_dpp v201, v243, v71 row_newbcast:7 row_mask:0xf bank_mask:0xf
    v_mul_f32_dpp v202, v243, v70 row_newbcast:14 row_mask:0xf bank_mask:0xf
    v_mul_f32_dpp v203, v243, v71 row_newbcast:15 row_mask:0xf bank_mask:0xf
    v_cvt_pk_bf16_f32 v66, v196, v197
    v_cvt_pk_bf16_f32 v70, v198, v199
    v_cvt_pk_bf16_f32 v67, v200, v201
    v_cvt_pk_bf16_f32 v71, v202, v203
    s_waitcnt lgkmcnt(0)
    v_mfma_f32_32x32x16_bf16 v[0:15], v[64:67], v[176:179], v[0:15]
    s_add_u32 m0, s21, 6144
    v_mfma_f32_32x32x16_bf16 v[48:63], v[68:71], v[176:179], v[48:63]
    buffer_load_dwordx4 v240, s[4:7], s35 offen  lds
    buffer_load_dwordx4 v241, s[8:11], s35 offen offset:1024  lds
    s_mov_b32 m0, s50
    s_nop 0
    s_movrels_b32 s71, s23
    s_bfe_u32 s46, s71, 0x30012
    s_mov_b32 m0, s46
    s_and_b32 s66, s71, 0x3ffff
    s_movrels_b32 s68, s57
    s_movrels_b32 s69, s61
    s_sub_u32 s48, s66, s47
    s_mov_b32 s47, s66
    s_lshr_b32 s52, s71, 28
    s_lshl_b32 s67, s46, 9
    s_add_u32 s66, s66, s67
    s_sub_u32 s49, s66, s42
    s_mov_b32 s42, s66
    s_bfe_u32 s66, s68, 655360
    s_add_u32 s43, s42, s66
    s_bfe_u32 s39, s69, 655360
    s_bfe_u32 s66, s68, 655370
    s_add_u32 s44, s42, s66
    s_bfe_u32 s40, s69, 655370
    s_bfe_u32 s66, s68, 655380
    s_add_u32 s45, s42, s66
    s_bfe_u32 s41, s69, 655380
    s_and_b32 s66, s46, s33
    s_cselect_b32 s72, -1, 1
    s_cselect_b32 s76, s47, 163712
    s_cmp_ge_u32 s66, 2
    s_cselect_b32 s73, -1, 0
    s_add_u32 s77, s47, 1024
    s_cmp_ge_u32 s66, 4
    s_cselect_b32 s75, -1, 0
    s_cmp_ge_u32 s66, 3
    s_cselect_b32 s74, -1, 1
    s_cselect_b32 s77, s77, 163712
    v_mfma_f32_32x32x16_bf16 v[16:31], v[72:75], v[180:183], 0
    v_mul_f32 v196, v0, v96
    v_fmac_f32 v196, v1, v97
    v_fmac_f32 v196, v2, v98
    v_fmac_f32 v196, v3, v99
    v_fmac_f32 v196, v4, v100
    v_fmac_f32 v196, v5, v101
    v_mfma_f32_32x32x16_bf16 v[32:47], v[76:79], v[180:183], 0
    v_fmac_f32 v196, v6, v102
    v_fmac_f32 v196, v7, v103
    v_mul_f32 v198, v8, v128
    v_fmac_f32 v198, v9, v129
    v_fmac_f32 v198, v10, v130
    v_fmac_f32 v198, v11, v131
    v_mfma_f32_32x32x16_bf16 v[16:31], v[80:83], v[184:187], v[16:31]
    v_fmac_f32 v198, v12, v132
    v_fmac_f32 v198, v13, v133
    v_fmac_f32 v198, v14, v134
    v_fmac_f32 v198, v15, v135
    v_mul_f32 v200, v48, v128
    v_fmac_f32 v200, v49, v129
    v_mfma_f32_32x32x16_bf16 v[32:47], v[84:87], v[184:187], v[32:47]
    v_permlane32_swap_b32 v196, v198
    v_fmac_f32 v200, v50, v130
    v_fmac_f32 v200, v51, v131
    v_fmac_f32 v200, v52, v132
    v_fmac_f32 v200, v53, v133
    v_fmac_f32 v200, v54, v134
    v_mfma_f32_32x32x16_bf16 v[16:31], v[88:91], v[188:191], v[16:31]
    v_fmac_f32 v200, v55, v135
    v_add_f32 v198, v196, v198
    v_mul_f32_e64 v202, v56, -v128
    v_fma_f32 v202, v57, -v129, v202
    v_fma_f32 v202, v58, -v130, v202
    v_fma_f32 v202, v59, -v131, v202
    v_mfma_f32_32x32x16_bf16 v[32:47], v[92:95], v[188:191], v[32:47]
    s_waitcnt vmcnt(6)
    ds_read_b64_tr_b16 v[176:177], v244 offset:0
    ds_read_b64_tr_b16 v[178:179], v244 offset:1024
    ds_read_b64_tr_b16 v[180:181], v245 offset:0
    ds_read_b64_tr_b16 v[182:183], v245 offset:1024
    v_fma_f32 v202, v60, -v132, v202
    v_fma_f32 v202, v61, -v133, v202
    v_mfma_f32_32x32x16_bf16 v[16:31], v[64:67], v[192:195], v[16:31]
    v_fma_f32 v202, v62, -v134, v202
    v_fma_f32 v202, v63, -v135, v202
    s_nop 1
    v_permlane32_swap_b32 v200, v202
    v_add_f32 v202, v200, v202
    v_mfma_f32_32x32x16_bf16 v[32:47], v[68:71], v[192:195], v[32:47]
    s_waitcnt vmcnt(4) lgkmcnt(0)
    v_mfma_f32_32x32x16_bf16 v[0:15], v[72:75], v[176:179], 0
    s_nop 2
    v_mul_f32 v197, v16, v104
    v_fmac_f32 v197, v17, v105
    v_fmac_f32 v197, v18, v106
    v_fmac_f32 v197, v19, v107
    v_fmac_f32 v197, v20, v108
    v_fmac_f32 v197, v21, v109
    s_add_u32 m0, s21, 0
    v_mfma_f32_32x32x16_bf16 v[48:63], v[76:79], v[176:179], 0
    buffer_load_dwordx4 v234, s[4:7], s36 offen  lds
    buffer_load_dwordx4 v235, s[8:11], s36 offen offset:1024  lds
    ds_read_b64_tr_b16 v[176:177], v244 offset:2048
    ds_read_b64_tr_b16 v[178:179], v244 offset:3072
    ds_read_b64_tr_b16 v[184:185], v245 offset:2048
    ds_read_b64_tr_b16 v[186:187], v245 offset:3072
    v_fmac_f32 v197, v22, v110
    v_fmac_f32 v197, v23, v111
    v_mul_f32 v199, v24, v136
    v_fmac_f32 v199, v25, v137
    v_fmac_f32 v199, v26, v138
    v_fmac_f32 v199, v27, v139
    v_fmac_f32 v199, v28, v140
    v_fmac_f32 v199, v29, v141
    v_fmac_f32 v199, v30, v142
    v_fmac_f32 v199, v31, v143
    s_waitcnt vmcnt(4) lgkmcnt(0)
    v_mfma_f32_32x32x16_bf16 v[0:15], v[80:83], v[176:179], v[0:15]
    v_mul_f32 v201, v32, v136
    v_fmac_f32 v201, v33, v137
    v_permlane32_swap_b32 v197, v199
    v_fmac_f32 v201, v34, v138
    v_fmac_f32 v201, v35, v139
    v_fmac_f32 v201, v36, v140
    s_add_u32 m0, s21, 2048
    v_mfma_f32_32x32x16_bf16 v[48:63], v[84:87], v[176:179], v[48:63]
    buffer_load_dwordx4 v236, s[4:7], s36 offen  lds
    buffer_load_dwordx4 v237, s[8:11], s36 offen offset:1024  lds
    ds_read_b64_tr_b16 v[176:177], v244 offset:4096
    ds_read_b64_tr_b16 v[178:179], v244 offset:5120
    ds_read_b64_tr_b16 v[188:189], v245 offset:4096
    ds_read_b64_tr_b16 v[190:191], v245 offset:5120
    s_waitcnt vmcnt(4) lgkmcnt(0)
    v_mfma_f32_32x32x16_bf16 v[0:15], v[88:91], v[176:179], v[0:15]
    v_fmac_f32 v201, v37, v141
    v_fmac_f32 v201, v38, v142
    v_fmac_f32 v201, v39, v143
    v_add_f32 v199, v197, v199
    v_mul_f32_e64 v203, v40, -v136
    v_fma_f32 v203, v41, -v137, v203
    s_add_u32 m0, s21, 4096
    v_mfma_f32_32x32x16_bf16 v[48:63], v[92:95], v[176:179], v[48:63]
    buffer_load_dwordx4 v238, s[4:7], s36 offen  lds
    buffer_load_dwordx4 v239, s[8:11], s36 offen offset:1024  lds
    ds_read_b64_tr_b16 v[176:177], v244 offset:6144
    ds_read_b64_tr_b16 v[178:179], v244 offset:7168
    ds_read_b64_tr_b16 v[192:193], v245 offset:6144
    ds_read_b64_tr_b16 v[194:195], v245 offset:7168
    s_waitcnt lgkmcnt(0)
    v_mfma_f32_32x32x16_bf16 v[0:15], v[64:67], v[176:179], v[0:15]
    v_fma_f32 v203, v42, -v138, v203
    v_fma_f32 v203, v43, -v139, v203
    v_fma_f32 v203, v44, -v140, v203
    v_fma_f32 v203, v45, -v141, v203
    v_fma_f32 v203, v46, -v142, v203
    v_fma_f32 v203, v47, -v143, v203
    s_nop 1
    s_add_u32 m0, s21, 6144
    v_mfma_f32_32x32x16_bf16 v[48:63], v[68:71], v[176:179], v[48:63]
    buffer_load_dwordx4 v240, s[4:7], s36 offen  lds
    buffer_load_dwordx4 v241, s[8:11], s36 offen offset:1024  lds
    v_permlane32_swap_b32 v201, v203
    v_add_f32 v203, v201, v203
    s_set_gpr_idx_on s51, gpr_idx(DST)
    s_nop 0
    v_cvt_pk_bf16_f32 v204, v198, v199
    v_cvt_pk_bf16_f32 v205, v202, v203
    s_set_gpr_idx_off
    v_mfma_f32_32x32x16_bf16 v[16:31], v[72:75], v[180:183], 0
    v_mul_f32 v196, v0, v144
    v_fmac_f32 v196, v1, v145
    v_fmac_f32 v196, v2, v146
    v_fmac_f32 v196, v3, v147
    v_fmac_f32 v196, v4, v148
    v_fmac_f32 v196, v5, v149
    v_mfma_f32_32x32x16_bf16 v[32:47], v[76:79], v[180:183], 0
    v_add_u32 v253, s47, v248
    ds_read_b32 v254, v253
    ds_read_b32 v255, v253 offset:256
    v_fmac_f32 v196, v6, v150
    v_fmac_f32 v196, v7, v151
    v_mul_f32 v198, v8, v112
    v_mfma_f32_32x32x16_bf16 v[16:31], v[80:83], v[184:187], v[16:31]
    v_fmac_f32 v198, v9, v113
    v_fmac_f32 v198, v10, v114
    v_fmac_f32 v198, v11, v115
    v_fmac_f32 v198, v12, v116
    v_fmac_f32 v198, v13, v117
    v_fmac_f32 v198, v14, v118
    v_mfma_f32_32x32x16_bf16 v[32:47], v[84:87], v[184:187], v[32:47]
    v_fmac_f32 v198, v15, v119
    v_mul_f32_e64 v200, v48, -v160
    v_fma_f32 v200, v49, -v161, v200
    v_fma_f32 v200, v50, -v162, v200
    v_fma_f32 v200, v51, -v163, v200
    v_fma_f32 v200, v52, -v164, v200
    v_mfma_f32_32x32x16_bf16 v[16:31], v[88:91], v[188:191], v[16:31]
    v_fma_f32 v200, v53, -v165, v200
    v_fma_f32 v200, v54, -v166, v200
    v_fma_f32 v200, v55, -v167, v200
    v_mul_f32_e64 v202, v56, -v160
    v_fma_f32 v202, v57, -v161, v202
    v_fma_f32 v202, v58, -v162, v202
    v_mfma_f32_32x32x16_bf16 v[32:47], v[92:95], v[188:191], v[32:47]
    s_waitcnt vmcnt(6)
    ds_read_b64_tr_b16 v[176:177], v244 offset:0
    ds_read_b64_tr_b16 v[178:179], v244 offset:1024
    ds_read_b64_tr_b16 v[180:181], v245 offset:0
    ds_read_b64_tr_b16 v[182:183], v245 offset:1024
    v_fma_f32 v202, v59, -v163, v202
    v_fma_f32 v202, v60, -v164, v202
    v_mfma_f32_32x32x16_bf16 v[16:31], v[64:67], v[192:195], v[16:31]
    v_fma_f32 v202, v61, -v165, v202
    v_fma_f32 v202, v62, -v166, v202
    v_fma_f32 v202, v63, -v167, v202
    v_mfma_f32_32x32x16_bf16 v[32:47], v[68:71], v[192:195], v[32:47]
    s_waitcnt vmcnt(4) lgkmcnt(0)
    v_mfma_f32_32x32x16_bf16 v[0:15], v[72:75], v[176:179], 0
    s_nop 5
    v_mul_f32 v197, v16, v152
    v_fmac_f32 v197, v17, v153
    v_fmac_f32 v197, v18, v154
    v_fmac_f32 v197, v19, v155
    v_fmac_f32 v197, v20, v156
    v_fmac_f32 v197, v21, v157
    s_add_u32 m0, s21, 0
    v_mfma_f32_32x32x16_bf16 v[48:63], v[76:79], v[176:179], 0
    buffer_load_dwordx4 v234, s[4:7], s37 offen  lds
    buffer_load_dwordx4 v235, s[8:11], s37 offen offset:1024  lds
    ds_read_b64_tr_b16 v[176:177], v244 offset:2048
    ds_read_b64_tr_b16 v[178:179], v244 offset:3072
    ds_read_b64_tr_b16 v[184:185], v245 offset:2048
    ds_read_b64_tr_b16 v[186:187], v245 offset:3072
    v_add_u32 v252, s42, v247
    ds_read2_b32 v[234:235], v252 offset0:0 offset1:16
    s_mov_b32 m0, s76
    s_mov_b64 exec, s[72:73]
    buffer_load_dwordx4 v254, s[12:15], 0 offen  lds
    s_mov_b32 m0, s77
    s_mov_b64 exec, s[74:75]
    buffer_load_dwordx4 v255, s[12:15], 0 offen  lds
    s_mov_b64 exec, -1
    v_fmac_f32 v197, v22, v158
    v_fmac_f32 v197, v23, v159
    v_mul_f32 v199, v24, v120
    v_fmac_f32 v199, v25, v121
    v_fmac_f32 v199, v26, v122
    v_fmac_f32 v199, v27, v123
    s_waitcnt vmcnt(6) lgkmcnt(1)
    v_mfma_f32_32x32x16_bf16 v[0:15], v[80:83], v[176:179], v[0:15]
    v_fmac_f32 v199, v28, v124
    v_fmac_f32 v199, v29, v125
    v_fmac_f32 v199, v30, v126
    v_fmac_f32 v199, v31, v127
    v_mul_f32_e64 v201, v32, -v168
    v_fma_f32 v201, v33, -v169, v201
    s_add_u32 m0, s21, 2048
    v_mfma_f32_32x32x16_bf16 v[48:63], v[84:87], v[176:179], v[48:63]
    buffer_load_dwordx4 v236, s[4:7], s37 offen  lds
    buffer_load_dwordx4 v237, s[8:11], s37 offen offset:1024  lds
    ds_read_b64_tr_b16 v[176:177], v244 offset:4096
    ds_read_b64_tr_b16 v[178:179], v244 offset:5120
    ds_read_b64_tr_b16 v[188:189], v245 offset:4096
    ds_read_b64_tr_b16 v[190:191], v245 offset:5120
    v_add_u32 v252, s43, v247
    ds_read2_b32 v[236:237], v252 offset0:0 offset1:16
    s_waitcnt vmcnt(6) lgkmcnt(1)
    v_mfma_f32_32x32x16_bf16 v[0:15], v[88:91], v[176:179], v[0:15]
    v_fma_f32 v201, v34, -v170, v201
    v_fma_f32 v201, v35, -v171, v201
    v_fma_f32 v201, v36, -v172, v201
    v_fma_f32 v201, v37, -v173, v201
    v_fma_f32 v201, v38, -v174, v201
    v_fma_f32 v201, v39, -v175, v201
    s_add_u32 m0, s21, 4096
    v_mfma_f32_32x32x16_bf16 v[48:63], v[92:95], v[176:179], v[48:63]
    buffer_load_dwordx4 v238, s[4:7], s37 offen  lds
    buffer_load_dwordx4 v239, s[8:11], s37 offen offset:1024  lds
    ds_read_b64_tr_b16 v[176:177], v244 offset:6144
    ds_read_b64_tr_b16 v[178:179], v244 offset:7168
    ds_read_b64_tr_b16 v[192:193], v245 offset:6144
    ds_read_b64_tr_b16 v[194:195], v245 offset:7168
    v_add_u32 v252, s44, v247
    ds_read2_b32 v[238:239], v252 offset0:0 offset1:16
    s_waitcnt lgkmcnt(1)
    v_mfma_f32_32x32x16_bf16 v[0:15], v[64:67], v[176:179], v[0:15]
    v_mul_f32_e64 v203, v40, -v168
    v_fma_f32 v203, v41, -v169, v203
    v_fma_f32 v203, v42, -v170, v203
    v_fma_f32 v203, v43, -v171, v203
    v_fma_f32 v203, v44, -v172, v203
    v_fma_f32 v203, v45, -v173, v203
    s_add_u32 m0, s21, 6144
    v_mfma_f32_32x32x16_bf16 v[48:63], v[68:71], v[176:179], v[48:63]
    buffer_load_dwordx4 v240, s[4:7], s37 offen  lds
    buffer_load_dwordx4 v241, s[8:11], s37 offen offset:1024  lds
    v_add_u32 v252, s45, v247
    ds_read2_b32 v[240:241], v252 offset0:0 offset1:16
    v_fma_f32 v203, v46, -v174, v203
    v_fma_f32 v203, v47, -v175, v203
    v_mfma_f32_32x32x16_bf16 v[16:31], v[72:75], v[180:183], 0
    v_mul_f32 v254, v0, v144
    v_fmac_f32 v254, v1, v145
    v_fmac_f32 v254, v2, v146
    v_fmac_f32 v254, v3, v147
    v_fmac_f32 v254, v4, v148
    v_fmac_f32 v254, v5, v149
    v_mfma_f32_32x32x16_bf16 v[32:47], v[76:79], v[180:183], 0
    ds_swizzle_b32 v76, v76 offset:0x401F
    ds_swizzle_b32 v77, v77 offset:0x401F
    ds_swizzle_b32 v78, v78 offset:0x401F
    ds_swizzle_b32 v79, v79 offset:0x401F
    v_fmac_f32 v254, v6, v150
    v_fmac_f32 v254, v7, v151
    v_mfma_f32_32x32x16_bf16 v[16:31], v[80:83], v[184:187], v[16:31]
    v_fmac_f32 v200, v8, v160
    v_fmac_f32 v200, v9, v161
    v_permlane32_swap_b32 v196, v254
    v_fmac_f32 v200, v10, v162
    v_fmac_f32 v200, v11, v163
    v_fmac_f32 v200, v12, v164
    v_mfma_f32_32x32x16_bf16 v[32:47], v[84:87], v[184:187], v[32:47]
    ds_swizzle_b32 v84, v84 offset:0x401F
    ds_swizzle_b32 v85, v85 offset:0x401F
    ds_swizzle_b32 v86, v86 offset:0x401F
    ds_swizzle_b32 v87, v87 offset:0x401F
    v_fmac_f32 v200, v13, v165
    v_fmac_f32 v200, v14, v166
    v_mfma_f32_32x32x16_bf16 v[16:31], v[88:91], v[188:191], v[16:31]
    v_fmac_f32 v200, v15, v167
    v_add_f32 v254, v196, v254
    v_mfma_f32_32x32x16_bf16 v[32:47], v[92:95], v[188:191], v[32:47]
    ds_swizzle_b32 v92, v92 offset:0x401F
    ds_swizzle_b32 v93, v93 offset:0x401F
    ds_swizzle_b32 v94, v94 offset:0x401F
    ds_swizzle_b32 v95, v95 offset:0x401F
    s_waitcnt vmcnt(8)
    ds_read_b64_tr_b16 v[176:177], v244 offset:0
    ds_read_b64_tr_b16 v[178:179], v244 offset:1024
    ds_read_b64_tr_b16 v[180:181], v245 offset:0
    ds_read_b64_tr_b16 v[182:183], v245 offset:1024
    v_mfma_f32_32x32x16_bf16 v[16:31], v[64:67], v[192:195], v[16:31]
    v_mfma_f32_32x32x16_bf16 v[32:47], v[68:71], v[192:195], v[32:47]
    ds_swizzle_b32 v68, v68 offset:0x401F
    ds_swizzle_b32 v69, v69 offset:0x401F
    ds_swizzle_b32 v70, v70 offset:0x401F
    ds_swizzle_b32 v71, v71 offset:0x401F
    s_waitcnt lgkmcnt(8)
    s_mov_b64 exec, s[56:57]
    v_xor_b32 v76, 0x80008000, v76
    v_xor_b32 v77, 0x80008000, v77
    v_xor_b32 v78, 0x80008000, v78
    v_xor_b32 v79, 0x80008000, v79
    v_xor_b32 v84, 0x80008000, v84
    v_xor_b32 v85, 0x80008000, v85
    v_xor_b32 v86, 0x80008000, v86
    v_xor_b32 v87, 0x80008000, v87
    v_xor_b32 v92, 0x80008000, v92
    v_xor_b32 v93, 0x80008000, v93
    v_xor_b32 v94, 0x80008000, v94
    v_xor_b32 v95, 0x80008000, v95
    s_mov_b64 exec, -1
    s_waitcnt vmcnt(4) lgkmcnt(4)
    v_mfma_f32_32x32x16_bf16 v[0:15], v[72:75], v[176:179], 0
    v_mul_f32 v255, v16, v152
    v_fmac_f32 v255, v17, v153
    v_fmac_f32 v255, v18, v154
    v_fmac_f32 v255, v19, v155
    v_fmac_f32 v255, v20, v156
    v_fmac_f32 v255, v21, v157
    s_add_u32 m0, s21, 0
    v_mfma_f32_32x32x16_bf16 v[48:63], v[76:79], v[176:179], v[48:63]
    v_mad_u32_u16 v234, v234, s3, v246 op_sel:[1,0,0,0]
    v_mad_u32_u16 v235, v235, s3, v246 op_sel:[1,0,0,0]
    buffer_load_dwordx4 v234, s[4:7], s38 offen  lds
    buffer_load_dwordx4 v235, s[8:11], s38 offen offset:1024  lds
    ds_read_b64_tr_b16 v[176:177], v244 offset:2048
    ds_read_b64_tr_b16 v[178:179], v244 offset:3072
    ds_read_b64_tr_b16 v[184:185], v245 offset:2048
    ds_read_b64_tr_b16 v[186:187], v245 offset:3072
    s_waitcnt vmcnt(4) lgkmcnt(0)
    v_mfma_f32_32x32x16_bf16 v[0:15], v[80:83], v[176:179], v[0:15]
    s_add_u32 m0, s21, 2048
    v_mfma_f32_32x32x16_bf16 v[48:63], v[84:87], v[176:179], v[48:63]
    v_mad_u32_u16 v236, v236, s3, v246 op_sel:[1,0,0,0]
    v_mad_u32_u16 v237, v237, s3, v246 op_sel:[1,0,0,0]
    buffer_load_dwordx4 v236, s[4:7], s39 offen  lds
    buffer_load_dwordx4 v237, s[8:11], s39 offen offset:1024  lds
    ds_read_b64_tr_b16 v[176:177], v244 offset:4096
    ds_read_b64_tr_b16 v[178:179], v244 offset:5120
    ds_read_b64_tr_b16 v[188:189], v245 offset:4096
    ds_read_b64_tr_b16 v[190:191], v245 offset:5120
    s_waitcnt vmcnt(4) lgkmcnt(0)
    v_mfma_f32_32x32x16_bf16 v[0:15], v[88:91], v[176:179], v[0:15]
    v_fmac_f32 v255, v22, v158
    v_fmac_f32 v255, v23, v159
    v_fmac_f32 v201, v24, v168
    v_fmac_f32 v201, v25, v169
    v_permlane32_swap_b32 v197, v255
    s_add_u32 m0, s21, 4096
    v_mfma_f32_32x32x16_bf16 v[48:63], v[92:95], v[176:179], v[48:63]
    v_mad_u32_u16 v238, v238, s3, v246 op_sel:[1,0,0,0]
    v_mad_u32_u16 v239, v239, s3, v246 op_sel:[1,0,0,0]
    buffer_load_dwordx4 v238, s[4:7], s40 offen  lds
    buffer_load_dwordx4 v239, s[8:11], s40 offen offset:1024  lds
    ds_read_b64_tr_b16 v[176:177], v244 offset:6144
    ds_read_b64_tr_b16 v[178:179], v244 offset:7168
    ds_read_b64_tr_b16 v[192:193], v245 offset:6144
    ds_read_b64_tr_b16 v[194:195], v245 offset:7168
    s_waitcnt lgkmcnt(0)
    s_mov_b64 exec, s[56:57]
    v_xor_b32 v68, 0x80008000, v68
    v_xor_b32 v69, 0x80008000, v69
    v_xor_b32 v70, 0x80008000, v70
    v_xor_b32 v71, 0x80008000, v71
    s_mov_b64 exec, -1
    v_mfma_f32_32x32x16_bf16 v[0:15], v[64:67], v[176:179], v[0:15]
    v_fmac_f32 v201, v26, v170
    v_fmac_f32 v201, v27, v171
    v_fmac_f32 v201, v28, v172
    v_fmac_f32 v201, v29, v173
    v_fmac_f32 v201, v30, v174
    v_fmac_f32 v201, v31, v175
    s_add_u32 m0, s21, 6144
    v_mfma_f32_32x32x16_bf16 v[48:63], v[68:71], v[176:179], v[48:63]
    v_mad_u32_u16 v240, v240, s3, v246 op_sel:[1,0,0,0]
    v_mad_u32_u16 v241, v241, s3, v246 op_sel:[1,0,0,0]
    buffer_load_dwordx4 v240, s[4:7], s41 offen  lds
    buffer_load_dwordx4 v241, s[8:11], s41 offen offset:1024  lds
    v_add_f32 v255, v197, v255
    s_set_gpr_idx_on s51, gpr_idx(DST)
    s_nop 0
    v_cvt_pk_bf16_f32 v206, v254, v255
    s_set_gpr_idx_off
    v_mfma_f32_32x32x16_bf16 v[16:31], v[72:75], v[180:183], 0
    v_mul_f32 v254, v0, v144
    v_fmac_f32 v254, v1, v145
    v_fmac_f32 v254, v2, v146
    v_fmac_f32 v254, v3, v147
    v_fmac_f32 v254, v4, v148
    v_fmac_f32 v254, v5, v149
    v_mfma_f32_32x32x16_bf16 v[32:47], v[76:79], v[180:183], v[32:47]
    v_fmac_f32 v254, v6, v150
    v_fmac_f32 v254, v7, v151
    v_fma_f32 v202, v8, -v160, v202
    v_fma_f32 v202, v9, -v161, v202
    v_permlane32_swap_b32 v254, v200
    v_fma_f32 v202, v10, -v162, v202
    v_mfma_f32_32x32x16_bf16 v[16:31], v[80:83], v[184:187], v[16:31]
    v_fma_f32 v202, v11, -v163, v202
    v_fma_f32 v202, v12, -v164, v202
    v_fma_f32 v202, v13, -v165, v202
    v_fma_f32 v202, v14, -v166, v202
    v_fma_f32 v202, v15, -v167, v202
    v_add_f32 v200, v254, v200
    v_mfma_f32_32x32x16_bf16 v[32:47], v[84:87], v[184:187], v[32:47]
    v_fmac_f32 v198, v48, v112
    v_permlane32_swap_b32 v202, v254
    v_fmac_f32 v198, v49, v113
    v_fmac_f32 v198, v50, v114
    v_fmac_f32 v198, v51, v115
    v_fmac_f32 v198, v52, v116
    v_mfma_f32_32x32x16_bf16 v[16:31], v[88:91], v[188:191], v[16:31]
    v_fmac_f32 v198, v53, v117
    v_fmac_f32 v198, v54, v118
    v_fmac_f32 v198, v55, v119
    v_add_f32 v254, v202, v254
    v_mul_f32 v196, v56, v160
    v_fmac_f32 v196, v57, v161
    v_mfma_f32_32x32x16_bf16 v[32:47], v[92:95], v[188:191], v[32:47]
    s_waitcnt vmcnt(6)
    ds_read_b64_tr_b16 v[176:177], v244 offset:0
    ds_read_b64_tr_b16 v[178:179], v244 offset:1024
    ds_read_b64_tr_b16 v[180:181], v245 offset:0
    ds_read_b64_tr_b16 v[182:183], v245 offset:1024
    v_fmac_f32 v196, v58, v162
    v_fmac_f32 v196, v59, v163
    v_mfma_f32_32x32x16_bf16 v[16:31], v[64:67], v[192:195], v[16:31]
    v_fmac_f32 v196, v60, v164
    v_fmac_f32 v196, v61, v165
    v_fmac_f32 v196, v62, v166
    v_fmac_f32 v196, v63, v167
    s_nop 1
    v_permlane32_swap_b32 v198, v196
    v_add_f32 v196, v198, v196
    v_mfma_f32_32x32x16_bf16 v[32:47], v[68:71], v[192:195], v[32:47]
    v_add_u32 v249, s48, v249
    v_add_u32 v250, s49, v250
    s_nop 0
    v_mul_f32 v255, v16, v152
    v_fmac_f32 v255, v17, v153
    v_fmac_f32 v255, v18, v154
    v_fmac_f32 v255, v19, v155
    v_fmac_f32 v255, v20, v156
    v_fmac_f32 v255, v21, v157
    v_fmac_f32 v255, v22, v158
    v_fmac_f32 v255, v23, v159
    v_fma_f32 v203, v24, -v168, v203
    v_fma_f32 v203, v25, -v169, v203
    v_permlane32_swap_b32 v255, v201
    v_fma_f32 v203, v26, -v170, v203
    v_fma_f32 v203, v27, -v171, v203
    v_fma_f32 v203, v28, -v172, v203
    v_fma_f32 v203, v29, -v173, v203
    v_fma_f32 v203, v30, -v174, v203
    v_fma_f32 v203, v31, -v175, v203
    v_add_f32 v201, v255, v201
    v_fmac_f32 v199, v32, v120
    v_permlane32_swap_b32 v203, v255
    v_fmac_f32 v199, v33, v121
    v_fmac_f32 v199, v34, v122
    v_fmac_f32 v199, v35, v123
    ds_read_b64_tr_b16 v[72:73], v249 offset:0
    ds_read_b64_tr_b16 v[76:77], v249 offset:64
    ds_read_b64_tr_b16 v[74:75], v249 offset:256
    ds_read_b64_tr_b16 v[78:79], v249 offset:320
    s_mov_b64 exec, s[54:55]
    ds_read_u16_d16_hi v242, v250 offset:0
    s_mov_b64 exec, -1
    v_fmac_f32 v199, v36, v124
    v_fmac_f32 v199, v37, v125
    v_fmac_f32 v199, v38, v126
    v_fmac_f32 v199, v39, v127
    v_add_f32 v255, v203, v255
    v_mul_f32 v197, v40, v168
    v_fmac_f32 v197, v41, v169
    v_fmac_f32 v197, v42, v170
    v_fmac_f32 v197, v43, v171
    v_fmac_f32 v197, v44, v172
    v_fmac_f32 v197, v45, v173
    v_fmac_f32 v197, v46, v174
    v_fmac_f32 v197, v47, v175
    s_nop 1
    v_permlane32_swap_b32 v199, v197
    v_add_f32 v197, v199, v197
    s_set_gpr_idx_on s51, gpr_idx(DST)
    s_nop 0
    v_cvt_pk_bf16_f32 v207, v200, v201
    v_cvt_pk_bf16_f32 v209, v254, v255
    v_cvt_pk_bf16_f32 v208, v196, v197
    s_set_gpr_idx_off
    s_add_u32 s50, s50, 1
    s_add_u32 s51, s51, 6
    s_cmp_ge_u32 s50, 4
    s_cbranch_scc1 LAST0
    s_add_u32 s53, s53, 4
    s_xor_b32 s66, s53, s20
    s_bitcmp1_b32 s66, 2
    s_setprio 1
    s_cbranch_scc1 PRIO_9
    s_setprio 0
PRIO_9:
    s_cmp_eq_u32 s52, 4
    s_cbranch_scc1 ITEM_0_4
    s_cmp_eq_u32 s52, 5
    s_cbranch_scc1 ITEM_0_5
    s_cmp_eq_u32 s52, 3
    s_cbranch_scc1 ITEM_0_3
    s_cmp_eq_u32 s52, 6
    s_cbranch_scc1 ITEM_0_6
    s_cmp_eq_u32 s52, 8
    s_cbranch_scc1 ITEM_0_8
    s_branch ITEM_0_2
.p2align 6
ITEM_0_2:
    s_mov_b32 m0, s50
    s_nop 0
    s_movrels_b32 s71, s23
    s_bfe_u32 s46, s71, 0x30012
    s_mov_b32 m0, s46
    s_and_b32 s66, s71, 0x3ffff
    s_movrels_b32 s68, s57
    s_movrels_b32 s69, s61
    s_sub_u32 s48, s66, s47
    s_mov_b32 s47, s66
    s_lshr_b32 s52, s71, 28
    s_lshl_b32 s67, s46, 9
    s_add_u32 s66, s66, s67
    s_sub_u32 s49, s66, s42
    s_mov_b32 s42, s66
    s_bfe_u32 s66, s68, 655360
    s_add_u32 s43, s42, s66
    s_bfe_u32 s39, s69, 655360
    s_bfe_u32 s66, s68, 655370
    s_add_u32 s44, s42, s66
    s_bfe_u32 s40, s69, 655370
    s_bfe_u32 s66, s68, 655380
    s_add_u32 s45, s42, s66
    s_bfe_u32 s41, s69, 655380
    s_and_b32 s66, s46, s33
    s_cselect_b32 s72, -1, 1
    s_cselect_b32 s76, s47, 163712
    s_cmp_ge_u32 s66, 2
    s_cselect_b32 s73, -1, 0
    s_add_u32 s77, s47, 1024
    s_cmp_ge_u32 s66, 4
    s_cselect_b32 s75, -1, 0
    s_cmp_ge_u32 s66, 3
    s_cselect_b32 s74, -1, 1
    s_cselect_b32 s77, s77, 163712
    v_add_u32 v252, s42, v247
    ds_read2_b32 v[234:235], v252 offset0:0 offset1:16
    v_add_u32 v252, s43, v247
    ds_read2_b32 v[236:237], v252 offset0:0 offset1:16
    v_add_u32 v252, s44, v247
    ds_read2_b32 v[238:239], v252 offset0:0 offset1:16
    v_add_u32 v252, s45, v247
    ds_read2_b32 v[240:241], v252 offset0:0 offset1:16
    s_waitcnt lgkmcnt(4)
    v_mul_f32_dpp v196, v242, v72 row_newbcast:0 row_mask:0xf bank_mask:0xf
    v_mul_f32_dpp v197, v242, v73 row_newbcast:1 row_mask:0xf bank_mask:0xf
    v_mul_f32_dpp v198, v242, v72 row_newbcast:8 row_mask:0xf bank_mask:0xf
    v_mul_f32_dpp v199, v242, v73 row_newbcast:9 row_mask:0xf bank_mask:0xf
    v_mul_f32_dpp v200, v242, v76 row_newbcast:2 row_mask:0xf bank_mask:0xf
    v_mul_f32_dpp v201, v242, v77 row_newbcast:3 row_mask:0xf bank_mask:0xf
    v_mul_f32_dpp v202, v242, v76 row_newbcast:10 row_mask:0xf bank_mask:0xf
    v_mul_f32_dpp v203, v242, v77 row_newbcast:11 row_mask:0xf bank_mask:0xf
    v_cvt_pk_bf16_f32 v72, v196, v197
    v_cvt_pk_bf16_f32 v76, v198, v199
    v_cvt_pk_bf16_f32 v73, v200, v201
    v_cvt_pk_bf16_f32 v77, v202, v203
    v_mul_f32_dpp v196, v242, v74 row_newbcast:4 row_mask:0xf bank_mask:0xf
    v_mul_f32_dpp v197, v242, v75 row_newbcast:5 row_mask:0xf bank_mask:0xf
    v_mul_f32_dpp v198, v242, v74 row_newbcast:12 row_mask:0xf bank_mask:0xf
    v_mul_f32_dpp v199, v242, v75 row_newbcast:13 row_mask:0xf bank_mask:0xf
    v_mul_f32_dpp v200, v242, v78 row_newbcast:6 row_mask:0xf bank_mask:0xf
    v_mul_f32_dpp v201, v242, v79 row_newbcast:7 row_mask:0xf bank_mask:0xf
    v_mul_f32_dpp v202, v242, v78 row_newbcast:14 row_mask:0xf bank_mask:0xf
    v_mul_f32_dpp v203, v242, v79 row_newbcast:15 row_mask:0xf bank_mask:0xf
    v_cvt_pk_bf16_f32 v74, v196, v197
    v_cvt_pk_bf16_f32 v78, v198, v199
    v_cvt_pk_bf16_f32 v75, v200, v201
    v_cvt_pk_bf16_f32 v79, v202, v203
    s_nop 0
    s_waitcnt lgkmcnt(3)
    v_mfma_f32_32x32x16_bf16 v[56:71], v[72:75], v[176:179], 0
    s_add_u32 m0, s21, 0
    v_mfma_f32_32x32x16_bf16 v[16:31], v[76:79], v[176:179], 0
    v_mad_u32_u16 v234, v234, s3, v246 op_sel:[1,0,0,0]
    v_mad_u32_u16 v235, v235, s3, v246 op_sel:[1,0,0,0]
    buffer_load_dwordx4 v234, s[4:7], s38 offen  lds
    buffer_load_dwordx4 v235, s[8:11], s38 offen offset:1024  lds
    v_mfma_f32_32x32x16_bf16 v[32:47], v[72:75], v[180:183], 0
    s_nop 4
    v_mul_f32 v196, v56, v96
    v_fmac_f32 v196, v57, v97
    v_fmac_f32 v196, v58, v98
    v_fmac_f32 v196, v59, v99
    v_fmac_f32 v196, v60, v100
    v_fmac_f32 v196, v61, v101
    v_mfma_f32_32x32x16_bf16 v[0:15], v[76:79], v[180:183], 0
    s_waitcnt vmcnt(6)
    ds_read_b64_tr_b16 v[176:177], v244 offset:2048
    ds_read_b64_tr_b16 v[178:179], v244 offset:3072
    ds_read_b64_tr_b16 v[180:181], v245 offset:2048
    ds_read_b64_tr_b16 v[182:183], v245 offset:3072
    v_fmac_f32 v196, v62, v102
    v_fmac_f32 v196, v63, v103
    v_mul_f32 v198, v64, v128
    v_fmac_f32 v198, v65, v129
    v_fmac_f32 v198, v66, v130
    v_fmac_f32 v198, v67, v131
    v_fmac_f32 v198, v68, v132
    v_fmac_f32 v198, v69, v133
    v_fmac_f32 v198, v70, v134
    v_fmac_f32 v198, v71, v135
    v_mul_f32 v200, v16, v128
    v_fmac_f32 v200, v17, v129
    v_permlane32_swap_b32 v196, v198
    v_fmac_f32 v200, v18, v130
    v_fmac_f32 v200, v19, v131
    v_fmac_f32 v200, v20, v132
    v_fmac_f32 v200, v21, v133
    v_fmac_f32 v200, v22, v134
    v_fmac_f32 v200, v23, v135
    v_add_f32 v198, v196, v198
    v_mul_f32_e64 v202, v24, -v128
    v_fma_f32 v202, v25, -v129, v202
    v_fma_f32 v202, v26, -v130, v202
    v_fma_f32 v202, v27, -v131, v202
    v_fma_f32 v202, v28, -v132, v202
    v_fma_f32 v202, v29, -v133, v202
    v_fma_f32 v202, v30, -v134, v202
    v_fma_f32 v202, v31, -v135, v202
    s_nop 1
    v_permlane32_swap_b32 v200, v202
    v_add_f32 v202, v200, v202
    s_waitcnt lgkmcnt(0)
    v_mfma_f32_32x32x16_bf16 v[56:71], v[72:75], v[176:179], 0
    v_mul_f32 v197, v32, v104
    v_fmac_f32 v197, v33, v105
    v_fmac_f32 v197, v34, v106
    v_fmac_f32 v197, v35, v107
    v_fmac_f32 v197, v36, v108
    v_fmac_f32 v197, v37, v109
    s_add_u32 m0, s21, 2048
    v_mfma_f32_32x32x16_bf16 v[16:31], v[76:79], v[176:179], 0
    v_mad_u32_u16 v236, v236, s3, v246 op_sel:[1,0,0,0]
    v_mad_u32_u16 v237, v237, s3, v246 op_sel:[1,0,0,0]
    buffer_load_dwordx4 v236, s[4:7], s39 offen  lds
    buffer_load_dwordx4 v237, s[8:11], s39 offen offset:1024  lds
    v_fmac_f32 v197, v38, v110
    v_fmac_f32 v197, v39, v111
    v_mul_f32 v199, v40, v136
    v_fmac_f32 v199, v41, v137
    v_fmac_f32 v199, v42, v138
    v_fmac_f32 v199, v43, v139
    v_fmac_f32 v199, v44, v140
    v_fmac_f32 v199, v45, v141
    v_fmac_f32 v199, v46, v142
    v_fmac_f32 v199, v47, v143
    v_mul_f32 v201, v0, v136
    v_fmac_f32 v201, v1, v137
    v_permlane32_swap_b32 v197, v199
    v_fmac_f32 v201, v2, v138
    v_fmac_f32 v201, v3, v139
    v_fmac_f32 v201, v4, v140
    v_fmac_f32 v201, v5, v141
    v_fmac_f32 v201, v6, v142
    v_fmac_f32 v201, v7, v143
    v_add_f32 v199, v197, v199
    v_mul_f32_e64 v203, v8, -v136
    v_fma_f32 v203, v9, -v137, v203
    v_fma_f32 v203, v10, -v138, v203
    v_fma_f32 v203, v11, -v139, v203
    v_fma_f32 v203, v12, -v140, v203
    v_fma_f32 v203, v13, -v141, v203
    v_fma_f32 v203, v14, -v142, v203
    v_fma_f32 v203, v15, -v143, v203
    s_nop 1
    v_permlane32_swap_b32 v201, v203
    v_add_f32 v203, v201, v203
    s_set_gpr_idx_on s51, gpr_idx(DST)
    s_nop 0
    v_cvt_pk_bf16_f32 v204, v198, v199
    v_cvt_pk_bf16_f32 v205, v202, v203
    s_set_gpr_idx_off
    v_mfma_f32_32x32x16_bf16 v[32:47], v[72:75], v[180:183], 0
    v_mul_f32 v196, v56, v144
    v_fmac_f32 v196, v57, v145
    v_fmac_f32 v196, v58, v146
    v_fmac_f32 v196, v59, v147
    v_fmac_f32 v196, v60, v148
    v_fmac_f32 v196, v61, v149
    v_mfma_f32_32x32x16_bf16 v[0:15], v[76:79], v[180:183], 0
    s_waitcnt vmcnt(6)
    ds_read_b64_tr_b16 v[176:177], v244 offset:4096
    ds_read_b64_tr_b16 v[178:179], v244 offset:5120
    ds_read_b64_tr_b16 v[180:181], v245 offset:4096
    ds_read_b64_tr_b16 v[182:183], v245 offset:5120
    v_fmac_f32 v196, v62, v150
    v_fmac_f32 v196, v63, v151
    v_mul_f32_e64 v200, v16, -v160
    v_fma_f32 v200, v17, -v161, v200
    v_fma_f32 v200, v18, -v162, v200
    v_fma_f32 v200, v19, -v163, v200
    v_fma_f32 v200, v20, -v164, v200
    v_fma_f32 v200, v21, -v165, v200
    v_fma_f32 v200, v22, -v166, v200
    v_fma_f32 v200, v23, -v167, v200
    v_mul_f32_e64 v202, v24, -v160
    v_fma_f32 v202, v25, -v161, v202
    v_fma_f32 v202, v26, -v162, v202
    v_fma_f32 v202, v27, -v163, v202
    v_fma_f32 v202, v28, -v164, v202
    v_fma_f32 v202, v29, -v165, v202
    v_fma_f32 v202, v30, -v166, v202
    v_fma_f32 v202, v31, -v167, v202
    s_waitcnt lgkmcnt(0)
    v_mfma_f32_32x32x16_bf16 v[16:31], v[72:75], v[176:179], 0
    v_mul_f32 v197, v32, v152
    v_fmac_f32 v197, v33, v153
    v_fmac_f32 v197, v34, v154
    v_fmac_f32 v197, v35, v155
    v_fmac_f32 v197, v36, v156
    v_fmac_f32 v197, v37, v157
    s_add_u32 m0, s21, 4096
    v_mfma_f32_32x32x16_bf16 v[48:63], v[76:79], v[176:179], 0
    v_mad_u32_u16 v238, v238, s3, v246 op_sel:[1,0,0,0]
    v_mad_u32_u16 v239, v239, s3, v246 op_sel:[1,0,0,0]
    buffer_load_dwordx4 v238, s[4:7], s40 offen  lds
    buffer_load_dwordx4 v239, s[8:11], s40 offen offset:1024  lds
    v_fmac_f32 v197, v38, v158
    v_fmac_f32 v197, v39, v159
    v_mul_f32_e64 v201, v0, -v168
    v_fma_f32 v201, v1, -v169, v201
    v_fma_f32 v201, v2, -v170, v201
    v_fma_f32 v201, v3, -v171, v201
    v_fma_f32 v201, v4, -v172, v201
    v_fma_f32 v201, v5, -v173, v201
    v_fma_f32 v201, v6, -v174, v201
    v_fma_f32 v201, v7, -v175, v201
    v_mul_f32_e64 v203, v8, -v168
    v_fma_f32 v203, v9, -v169, v203
    v_fma_f32 v203, v10, -v170, v203
    v_fma_f32 v203, v11, -v171, v203
    v_fma_f32 v203, v12, -v172, v203
    v_fma_f32 v203, v13, -v173, v203
    v_fma_f32 v203, v14, -v174, v203
    v_fma_f32 v203, v15, -v175, v203
    v_mfma_f32_32x32x16_bf16 v[0:15], v[72:75], v[180:183], 0
    v_fmac_f32 v200, v24, v160
    v_fmac_f32 v200, v25, v161
    v_fmac_f32 v200, v26, v162
    v_fmac_f32 v200, v27, v163
    v_fmac_f32 v200, v28, v164
    v_fmac_f32 v200, v29, v165
    v_fmac_f32 v200, v30, v166
    v_fmac_f32 v200, v31, v167
    v_mfma_f32_32x32x16_bf16 v[24:39], v[76:79], v[180:183], 0
    v_add_u32 v253, s47, v248
    ds_read_b32 v192, v253
    ds_read_b32 v193, v253 offset:256
    s_waitcnt vmcnt(6)
    ds_read_b64_tr_b16 v[176:177], v244 offset:6144
    ds_read_b64_tr_b16 v[178:179], v244 offset:7168
    ds_read_b64_tr_b16 v[180:181], v245 offset:6144
    ds_read_b64_tr_b16 v[182:183], v245 offset:7168
    v_mul_f32 v254, v16, v144
    v_fmac_f32 v254, v17, v145
    v_fmac_f32 v254, v18, v146
    v_fmac_f32 v254, v19, v147
    v_fmac_f32 v254, v20, v148
    v_fmac_f32 v254, v21, v149
    v_fmac_f32 v254, v22, v150
    v_fmac_f32 v254, v23, v151
    v_sub_f32_e64 v64, -v48, v64
    v_sub_f32_e64 v65, -v49, v65
    v_permlane32_swap_b32 v196, v254
    v_sub_f32_e64 v66, -v50, v66
    v_sub_f32_e64 v67, -v51, v67
    v_sub_f32_e64 v68, -v52, v68
    v_sub_f32_e64 v69, -v53, v69
    v_sub_f32_e64 v70, -v54, v70
    v_sub_f32_e64 v71, -v55, v71
    v_add_f32 v254, v196, v254
    s_waitcnt lgkmcnt(0)
    v_mfma_f32_32x32x16_bf16 v[56:71], v[76:79], v[176:179], v[56:71]
    v_sub_f32_e64 v40, -v24, v40
    v_sub_f32_e64 v41, -v25, v41
    v_sub_f32_e64 v42, -v26, v42
    v_sub_f32_e64 v43, -v27, v43
    v_sub_f32_e64 v44, -v28, v44
    v_sub_f32_e64 v45, -v29, v45
    v_sub_f32_e64 v46, -v30, v46
    v_sub_f32_e64 v47, -v31, v47
    s_mov_b32 m0, s76
    s_mov_b64 exec, s[72:73]
    buffer_load_dwordx4 v192, s[12:15], 0 offen  lds
    s_mov_b32 m0, s77
    s_mov_b64 exec, s[74:75]
    buffer_load_dwordx4 v193, s[12:15], 0 offen  lds
    s_mov_b64 exec, -1
    s_add_u32 m0, s21, 6144
    v_mfma_f32_32x32x16_bf16 v[16:31], v[72:75], v[176:179], 0
    v_mad_u32_u16 v240, v240, s3, v246 op_sel:[1,0,0,0]
    v_mad_u32_u16 v241, v241, s3, v246 op_sel:[1,0,0,0]
    buffer_load_dwordx4 v240, s[4:7], s41 offen  lds
    buffer_load_dwordx4 v241, s[8:11], s41 offen offset:1024  lds
    v_mul_f32 v255, v0, v152
    v_fmac_f32 v255, v1, v153
    v_fmac_f32 v255, v2, v154
    v_fmac_f32 v255, v3, v155
    v_fmac_f32 v255, v4, v156
    v_fmac_f32 v255, v5, v157
    v_fmac_f32 v255, v6, v158
    v_fmac_f32 v255, v7, v159
    v_fmac_f32 v201, v8, v168
    v_fmac_f32 v201, v9, v169
    v_permlane32_swap_b32 v197, v255
    v_fmac_f32 v201, v10, v170
    v_fmac_f32 v201, v11, v171
    v_fmac_f32 v201, v12, v172
    v_fmac_f32 v201, v13, v173
    v_fmac_f32 v201, v14, v174
    v_fmac_f32 v201, v15, v175
    v_add_f32 v255, v197, v255
    s_set_gpr_idx_on s51, gpr_idx(DST)
    s_nop 0
    v_cvt_pk_bf16_f32 v206, v254, v255
    s_set_gpr_idx_off
    v_mfma_f32_32x32x16_bf16 v[0:15], v[72:75], v[180:183], 0
    v_mul_f32 v254, v16, v144
    v_fmac_f32 v254, v17, v145
    v_fmac_f32 v254, v18, v146
    v_fmac_f32 v254, v19, v147
    v_fmac_f32 v254, v20, v148
    v_fmac_f32 v254, v21, v149
    v_mfma_f32_32x32x16_bf16 v[32:47], v[76:79], v[180:183], v[32:47]
    s_waitcnt vmcnt(8)
    ds_read_b64_tr_b16 v[176:177], v244 offset:0
    ds_read_b64_tr_b16 v[178:179], v244 offset:1024
    ds_read_b64_tr_b16 v[180:181], v245 offset:0
    ds_read_b64_tr_b16 v[182:183], v245 offset:1024
    v_add_u32 v249, s48, v249
    v_add_u32 v250, s49, v250
    v_fmac_f32 v254, v22, v150
    v_fmac_f32 v254, v23, v151
    v_fma_f32 v202, v24, -v160, v202
    v_fma_f32 v202, v25, -v161, v202
    v_permlane32_swap_b32 v254, v200
    v_fma_f32 v202, v26, -v162, v202
    v_fma_f32 v202, v27, -v163, v202
    v_fma_f32 v202, v28, -v164, v202
    v_fma_f32 v202, v29, -v165, v202
    v_fma_f32 v202, v30, -v166, v202
    v_fma_f32 v202, v31, -v167, v202
    v_add_f32 v200, v254, v200
    v_mul_f32_e64 v198, v64, -v112
    v_permlane32_swap_b32 v202, v254
    v_fma_f32 v198, v65, -v113, v198
    v_fma_f32 v198, v66, -v114, v198
    v_fma_f32 v198, v67, -v115, v198
    v_fma_f32 v198, v68, -v116, v198
    v_fma_f32 v198, v69, -v117, v198
    v_fma_f32 v198, v70, -v118, v198
    v_fma_f32 v198, v71, -v119, v198
    v_add_f32 v254, v202, v254
    v_mul_f32 v196, v56, v160
    v_fmac_f32 v196, v57, v161
    v_fmac_f32 v196, v58, v162
    v_fmac_f32 v196, v59, v163
    v_fmac_f32 v196, v60, v164
    v_fmac_f32 v196, v61, v165
    v_fmac_f32 v196, v62, v166
    v_fmac_f32 v196, v63, v167
    s_nop 1
    v_permlane32_swap_b32 v198, v196
    v_add_f32 v196, v198, v196
    v_mul_f32 v255, v0, v152
    v_fmac_f32 v255, v1, v153
    v_fmac_f32 v255, v2, v154
    v_fmac_f32 v255, v3, v155
    v_fmac_f32 v255, v4, v156
    v_fmac_f32 v255, v5, v157
    v_fmac_f32 v255, v6, v158
    v_fmac_f32 v255, v7, v159
    v_fma_f32 v203, v8, -v168, v203
    v_fma_f32 v203, v9, -v169, v203
    v_permlane32_swap_b32 v255, v201
    v_fma_f32 v203, v10, -v170, v203
    v_fma_f32 v203, v11, -v171, v203
    v_fma_f32 v203, v12, -v172, v203
    v_fma_f32 v203, v13, -v173, v203
    v_fma_f32 v203, v14, -v174, v203
    v_fma_f32 v203, v15, -v175, v203
    v_add_f32 v201, v255, v201
    v_mul_f32_e64 v199, v40, -v120
    v_permlane32_swap_b32 v203, v255
    v_fma_f32 v199, v41, -v121, v199
    v_fma_f32 v199, v42, -v122, v199
    v_fma_f32 v199, v43, -v123, v199
    s_waitcnt vmcnt(2)
    ds_read_b64_tr_b16 v[72:73], v249 offset:0
    ds_read_b64_tr_b16 v[76:77], v249 offset:64
    ds_read_b64_tr_b16 v[74:75], v249 offset:256
    ds_read_b64_tr_b16 v[78:79], v249 offset:320
    s_mov_b64 exec, s[54:55]
    ds_read_u16_d16_hi v242, v250 offset:0
    s_mov_b64 exec, -1
    v_fma_f32 v199, v44, -v124, v199
    v_fma_f32 v199, v45, -v125, v199
    v_fma_f32 v199, v46, -v126, v199
    v_fma_f32 v199, v47, -v127, v199
    v_add_f32 v255, v203, v255
    v_mul_f32 v197, v32, v168
    v_fmac_f32 v197, v33, v169
    v_fmac_f32 v197, v34, v170
    v_fmac_f32 v197, v35, v171
    v_fmac_f32 v197, v36, v172
    v_fmac_f32 v197, v37, v173
    v_fmac_f32 v197, v38, v174
    v_fmac_f32 v197, v39, v175
    s_nop 1
    v_permlane32_swap_b32 v199, v197
    v_add_f32 v197, v199, v197
    s_set_gpr_idx_on s51, gpr_idx(DST)
    s_nop 0
    v_cvt_pk_bf16_f32 v207, v200, v201
    v_cvt_pk_bf16_f32 v209, v254, v255
    v_cvt_pk_bf16_f32 v208, v196, v197
    s_set_gpr_idx_off
    s_add_u32 s50, s50, 1
    s_add_u32 s51, s51, 6
    s_cmp_ge_u32 s50, 4
    s_cbranch_scc1 LAST0
    s_add_u32 s53, s53, 4
    s_xor_b32 s66, s53, s20
    s_bitcmp1_b32 s66, 2
    s_setprio 1
    s_cbranch_scc1 PRIO_10
    s_setprio 0
PRIO_10:
    s_cmp_eq_u32 s52, 4
    s_cbranch_scc1 ITEM_0_4
    s_cmp_eq_u32 s52, 5
    s_cbranch_scc1 ITEM_0_5
    s_cmp_eq_u32 s52, 3
    s_cbranch_scc1 ITEM_0_3
    s_cmp_eq_u32 s52, 6
    s_cbranch_scc1 ITEM_0_6
    s_cmp_eq_u32 s52, 8
    s_cbranch_scc1 ITEM_0_8
    s_branch ITEM_0_2
.p2align 6
ITEM_1_4:
    s_mov_b64 exec, s[54:55]
    ds_read_u16_d16_hi v243, v250 offset:128
    s_mov_b64 exec, -1
    ds_read_b64_tr_b16 v[80:81], v249 offset:512
    ds_read_b64_tr_b16 v[84:85], v249 offset:576
    ds_read_b64_tr_b16 v[82:83], v249 offset:768
    ds_read_b64_tr_b16 v[86:87], v249 offset:832
    s_waitcnt lgkmcnt(5)
    v_mul_f32_dpp v196, v242, v72 row_newbcast:0 row_mask:0xf bank_mask:0xf
    v_mul_f32_dpp v197, v242, v73 row_newbcast:1 row_mask:0xf bank_mask:0xf
    v_mul_f32_dpp v198, v242, v72 row_newbcast:8 row_mask:0xf bank_mask:0xf
    v_mul_f32_dpp v199, v242, v73 row_newbcast:9 row_mask:0xf bank_mask:0xf
    v_mul_f32_dpp v200, v242, v76 row_newbcast:2 row_mask:0xf bank_mask:0xf
    v_mul_f32_dpp v201, v242, v77 row_newbcast:3 row_mask:0xf bank_mask:0xf
    v_mul_f32_dpp v202, v242, v76 row_newbcast:10 row_mask:0xf bank_mask:0xf
    v_mul_f32_dpp v203, v242, v77 row_newbcast:11 row_mask:0xf bank_mask:0xf
    v_cvt_pk_bf16_f32 v72, v196, v197
    v_cvt_pk_bf16_f32 v76, v198, v199
    v_cvt_pk_bf16_f32 v73, v200, v201
    v_cvt_pk_bf16_f32 v77, v202, v203
    v_mul_f32_dpp v196, v242, v74 row_newbcast:4 row_mask:0xf bank_mask:0xf
    v_mul_f32_dpp v197, v242, v75 row_newbcast:5 row_mask:0xf bank_mask:0xf
    v_mul_f32_dpp v198, v242, v74 row_newbcast:12 row_mask:0xf bank_mask:0xf
    v_mul_f32_dpp v199, v242, v75 row_newbcast:13 row_mask:0xf bank_mask:0xf
    v_mul_f32_dpp v200, v242, v78 row_newbcast:6 row_mask:0xf bank_mask:0xf
    v_mul_f32_dpp v201, v242, v79 row_newbcast:7 row_mask:0xf bank_mask:0xf
    v_mul_f32_dpp v202, v242, v78 row_newbcast:14 row_mask:0xf bank_mask:0xf
    v_mul_f32_dpp v203, v242, v79 row_newbcast:15 row_mask:0xf bank_mask:0xf
    v_cvt_pk_bf16_f32 v74, v196, v197
    v_cvt_pk_bf16_f32 v78, v198, v199
    v_cvt_pk_bf16_f32 v75, v200, v201
    v_cvt_pk_bf16_f32 v79, v202, v203
    s_waitcnt vmcnt(4) lgkmcnt(0)
    v_mfma_f32_32x32x16_bf16 v[56:71], v[72:75], v[176:179], 0
    v_mul_f32_dpp v196, v243, v80 row_newbcast:0 row_mask:0xf bank_mask:0xf
    v_mul_f32_dpp v197, v243, v81 row_newbcast:1 row_mask:0xf bank_mask:0xf
    v_mul_f32_dpp v198, v243, v80 row_newbcast:8 row_mask:0xf bank_mask:0xf
    v_mul_f32_dpp v199, v243, v81 row_newbcast:9 row_mask:0xf bank_mask:0xf
    v_mul_f32_dpp v200, v243, v84 row_newbcast:2 row_mask:0xf bank_mask:0xf
    v_mul_f32_dpp v201, v243, v85 row_newbcast:3 row_mask:0xf bank_mask:0xf
    s_add_u32 m0, s21, 0
    v_mfma_f32_32x32x16_bf16 v[16:31], v[76:79], v[176:179], 0
    buffer_load_dwordx4 v234, s[4:7], s36 offen  lds
    buffer_load_dwordx4 v235, s[8:11], s36 offen offset:1024  lds
    ds_read_b64_tr_b16 v[176:177], v244 offset:2048
    ds_read_b64_tr_b16 v[178:179], v244 offset:3072
    ds_read_b64_tr_b16 v[184:185], v245 offset:2048
    ds_read_b64_tr_b16 v[186:187], v245 offset:3072
    v_mul_f32_dpp v202, v243, v84 row_newbcast:10 row_mask:0xf bank_mask:0xf
    v_mul_f32_dpp v203, v243, v85 row_newbcast:11 row_mask:0xf bank_mask:0xf
    v_cvt_pk_bf16_f32 v80, v196, v197
    v_cvt_pk_bf16_f32 v84, v198, v199
    v_cvt_pk_bf16_f32 v81, v200, v201
    v_cvt_pk_bf16_f32 v85, v202, v203
    v_mul_f32_dpp v196, v243, v82 row_newbcast:4 row_mask:0xf bank_mask:0xf
    v_mul_f32_dpp v197, v243, v83 row_newbcast:5 row_mask:0xf bank_mask:0xf
    v_mul_f32_dpp v198, v243, v82 row_newbcast:12 row_mask:0xf bank_mask:0xf
    v_mul_f32_dpp v199, v243, v83 row_newbcast:13 row_mask:0xf bank_mask:0xf
    v_mul_f32_dpp v200, v243, v86 row_newbcast:6 row_mask:0xf bank_mask:0xf
    v_mul_f32_dpp v201, v243, v87 row_newbcast:7 row_mask:0xf bank_mask:0xf
    v_mul_f32_dpp v202, v243, v86 row_newbcast:14 row_mask:0xf bank_mask:0xf
    v_mul_f32_dpp v203, v243, v87 row_newbcast:15 row_mask:0xf bank_mask:0xf
    v_cvt_pk_bf16_f32 v82, v196, v197
    v_cvt_pk_bf16_f32 v86, v198, v199
    v_cvt_pk_bf16_f32 v83, v200, v201
    v_cvt_pk_bf16_f32 v87, v202, v203
    s_waitcnt lgkmcnt(0)
    v_mfma_f32_32x32x16_bf16 v[56:71], v[80:83], v[176:179], v[56:71]
    s_add_u32 m0, s21, 2048
    v_mfma_f32_32x32x16_bf16 v[16:31], v[84:87], v[176:179], v[16:31]
    buffer_load_dwordx4 v236, s[4:7], s36 offen  lds
    buffer_load_dwordx4 v237, s[8:11], s36 offen offset:1024  lds
    s_mov_b32 m0, s50
    s_nop 0
    s_movrels_b32 s71, s23
    s_movrels_b32 s33, s28
    v_add_u32 v253, s33, v248
    s_bfe_u32 s46, s71, 0x30012
    s_mov_b32 m0, s46
    s_and_b32 s66, s71, 0x3ffff
    s_movrels_b32 s68, s57
    s_movrels_b32 s69, s61
    s_sub_u32 s48, s66, s47
    s_mov_b32 s47, s66
    s_lshr_b32 s52, s71, 28
    s_lshl_b32 s67, s46, 9
    s_add_u32 s66, s66, s67
    s_sub_u32 s49, s66, s42
    s_mov_b32 s42, s66
    s_bfe_u32 s66, s68, 655360
    s_add_u32 s43, s42, s66
    s_bfe_u32 s39, s69, 655360
    s_bfe_u32 s66, s68, 655370
    s_add_u32 s44, s42, s66
    s_bfe_u32 s40, s69, 655370
    s_bfe_u32 s66, s68, 655380
    s_add_u32 s45, s42, s66
    s_bfe_u32 s41, s69, 655380
    v_add_u32 v252, s44, v247
    ds_read2_b32 v[238:239], v252 offset0:0 offset1:16
    v_add_u32 v252, s45, v247
    ds_read2_b32 v[240:241], v252 offset0:0 offset1:16
    v_mfma_f32_32x32x16_bf16 v[32:47], v[72:75], v[180:183], 0
    v_mul_f32 v196, v56, v96
    v_fmac_f32 v196, v57, v97
    v_fmac_f32 v196, v58, v98
    v_fmac_f32 v196, v59, v99
    v_fmac_f32 v196, v60, v100
    v_fmac_f32 v196, v61, v101
    v_mfma_f32_32x32x16_bf16 v[0:15], v[76:79], v[180:183], 0
    s_waitcnt vmcnt(6)
    ds_read_b64_tr_b16 v[176:177], v244 offset:4096
    ds_read_b64_tr_b16 v[178:179], v244 offset:5120
    ds_read_b64_tr_b16 v[180:181], v245 offset:4096
    ds_read_b64_tr_b16 v[182:183], v245 offset:5120
    v_fmac_f32 v196, v62, v102
    v_fmac_f32 v196, v63, v103
    v_mfma_f32_32x32x16_bf16 v[32:47], v[80:83], v[184:187], v[32:47]
    v_mul_f32 v198, v64, v128
    v_fmac_f32 v198, v65, v129
    v_fmac_f32 v198, v66, v130
    v_fmac_f32 v198, v67, v131
    v_fmac_f32 v198, v68, v132
    v_fmac_f32 v198, v69, v133
    v_mfma_f32_32x32x16_bf16 v[0:15], v[84:87], v[184:187], v[0:15]
    v_fmac_f32 v198, v70, v134
    v_fmac_f32 v198, v71, v135
    v_mul_f32 v200, v16, v128
    v_fmac_f32 v200, v17, v129
    v_permlane32_swap_b32 v196, v198
    v_fmac_f32 v200, v18, v130
    v_fmac_f32 v200, v19, v131
    v_fmac_f32 v200, v20, v132
    v_fmac_f32 v200, v21, v133
    v_fmac_f32 v200, v22, v134
    v_fmac_f32 v200, v23, v135
    v_add_f32 v198, v196, v198
    v_mul_f32_e64 v202, v24, -v128
    v_fma_f32 v202, v25, -v129, v202
    v_fma_f32 v202, v26, -v130, v202
    v_fma_f32 v202, v27, -v131, v202
    v_fma_f32 v202, v28, -v132, v202
    v_fma_f32 v202, v29, -v133, v202
    v_fma_f32 v202, v30, -v134, v202
    v_fma_f32 v202, v31, -v135, v202
    s_nop 1
    v_permlane32_swap_b32 v200, v202
    v_add_f32 v202, v200, v202
    s_waitcnt vmcnt(4) lgkmcnt(0)
    v_mfma_f32_32x32x16_bf16 v[56:71], v[72:75], v[176:179], 0
    v_mul_f32 v197, v32, v104
    v_fmac_f32 v197, v33, v105
    v_fmac_f32 v197, v34, v106
    v_fmac_f32 v197, v35, v107
    v_fmac_f32 v197, v36, v108
    v_fmac_f32 v197, v37, v109
    s_add_u32 m0, s21, 4096
    v_mfma_f32_32x32x16_bf16 v[16:31], v[76:79], v[176:179], 0
    buffer_load_dwordx4 v234, s[4:7], s37 offen  lds
    buffer_load_dwordx4 v235, s[8:11], s37 offen offset:1024  lds
    ds_read_b64_tr_b16 v[176:177], v244 offset:6144
    ds_read_b64_tr_b16 v[178:179], v244 offset:7168
    ds_read_b64_tr_b16 v[184:185], v245 offset:6144
    ds_read_b64_tr_b16 v[186:187], v245 offset:7168
    v_add_u32 v252, s42, v247
    ds_read2_b32 v[234:235], v252 offset0:0 offset1:16
    v_fmac_f32 v197, v38, v110
    v_fmac_f32 v197, v39, v111
    v_mul_f32 v199, v40, v136
    v_fmac_f32 v199, v41, v137
    v_fmac_f32 v199, v42, v138
    v_fmac_f32 v199, v43, v139
    v_fmac_f32 v199, v44, v140
    v_fmac_f32 v199, v45, v141
    v_fmac_f32 v199, v46, v142
    v_fmac_f32 v199, v47, v143
    v_mul_f32 v201, v0, v136
    v_fmac_f32 v201, v1, v137
    v_permlane32_swap_b32 v197, v199
    v_fmac_f32 v201, v2, v138
    v_fmac_f32 v201, v3, v139
    v_fmac_f32 v201, v4, v140
    v_fmac_f32 v201, v5, v141
    v_fmac_f32 v201, v6, v142
    v_fmac_f32 v201, v7, v143
    v_add_f32 v199, v197, v199
    v_mul_f32_e64 v203, v8, -v136
    v_fma_f32 v203, v9, -v137, v203
    v_fma_f32 v203, v10, -v138, v203
    v_fma_f32 v203, v11, -v139, v203
    s_waitcnt lgkmcnt(1)
    v_mfma_f32_32x32x16_bf16 v[56:71], v[80:83], v[176:179], v[56:71]
    v_fma_f32 v203, v12, -v140, v203
    v_fma_f32 v203, v13, -v141, v203
    v_fma_f32 v203, v14, -v142, v203
    v_fma_f32 v203, v15, -v143, v203
    s_nop 1
    v_permlane32_swap_b32 v201, v203
    v_add_f32 v203, v201, v203
    s_add_u32 m0, s21, 6144
    v_mfma_f32_32x32x16_bf16 v[16:31], v[84:87], v[176:179], v[16:31]
    buffer_load_dwordx4 v236, s[4:7], s37 offen  lds
    buffer_load_dwordx4 v237, s[8:11], s37 offen offset:1024  lds
    v_add_u32 v252, s43, v247
    ds_read2_b32 v[236:237], v252 offset0:0 offset1:16
    v_cvt_pk_bf16_f32 v192, v198, v199
    v_cvt_pk_bf16_f32 v193, v202, v203
    v_mfma_f32_32x32x16_bf16 v[32:47], v[72:75], v[180:183], 0
    v_mul_f32 v196, v56, v144
    v_fmac_f32 v196, v57, v145
    v_fmac_f32 v196, v58, v146
    v_fmac_f32 v196, v59, v147
    v_fmac_f32 v196, v60, v148
    v_fmac_f32 v196, v61, v149
    v_mfma_f32_32x32x16_bf16 v[0:15], v[76:79], v[180:183], 0
    s_waitcnt vmcnt(6)
    ds_read_b64_tr_b16 v[176:177], v244 offset:0
    ds_read_b64_tr_b16 v[178:179], v244 offset:1024
    ds_read_b64_tr_b16 v[180:181], v245 offset:0
    ds_read_b64_tr_b16 v[182:183], v245 offset:1024
    v_fmac_f32 v196, v62, v150
    v_fmac_f32 v196, v63, v151
    v_mfma_f32_32x32x16_bf16 v[32:47], v[80:83], v[184:187], v[32:47]
    v_mul_f32_e64 v200, v16, -v160
    v_fma_f32 v200, v17, -v161, v200
    v_fma_f32 v200, v18, -v162, v200
    v_fma_f32 v200, v19, -v163, v200
    v_fma_f32 v200, v20, -v164, v200
    v_fma_f32 v200, v21, -v165, v200
    v_mfma_f32_32x32x16_bf16 v[0:15], v[84:87], v[184:187], v[0:15]
    v_fma_f32 v200, v22, -v166, v200
    v_fma_f32 v200, v23, -v167, v200
    v_mul_f32_e64 v202, v24, -v160
    v_fma_f32 v202, v25, -v161, v202
    v_fma_f32 v202, v26, -v162, v202
    v_fma_f32 v202, v27, -v163, v202
    v_fma_f32 v202, v28, -v164, v202
    v_fma_f32 v202, v29, -v165, v202
    v_fma_f32 v202, v30, -v166, v202
    v_fma_f32 v202, v31, -v167, v202
    s_waitcnt vmcnt(4) lgkmcnt(0)
    v_mfma_f32_32x32x16_bf16 v[16:31], v[72:75], v[176:179], 0
    v_mul_f32 v197, v32, v152
    v_fmac_f32 v197, v33, v153
    v_fmac_f32 v197, v34, v154
    v_fmac_f32 v197, v35, v155
    v_fmac_f32 v197, v36, v156
    v_fmac_f32 v197, v37, v157
    s_add_u32 m0, s21, 0
    v_mfma_f32_32x32x16_bf16 v[48:63], v[76:79], v[176:179], 0
    s_cbranch_vccnz WL_4_0
    v_mad_u32_u16 v234, v234, s3, v246 op_sel:[1,0,0,0]
    v_mad_u32_u16 v235, v235, s3, v246 op_sel:[1,0,0,0]
    buffer_load_dwordx4 v234, s[4:7], s38 offen  lds
    buffer_load_dwordx4 v235, s[8:11], s38 offen offset:1024  lds
WR_4_0:
    ds_read_b64_tr_b16 v[176:177], v244 offset:2048
    ds_read_b64_tr_b16 v[178:179], v244 offset:3072
    ds_read_b64_tr_b16 v[184:185], v245 offset:2048
    ds_read_b64_tr_b16 v[186:187], v245 offset:3072
    v_fmac_f32 v197, v38, v158
    v_fmac_f32 v197, v39, v159
    v_mul_f32_e64 v201, v0, -v168
    v_fma_f32 v201, v1, -v169, v201
    v_fma_f32 v201, v2, -v170, v201
    v_fma_f32 v201, v3, -v171, v201
    v_fma_f32 v201, v4, -v172, v201
    v_fma_f32 v201, v5, -v173, v201
    v_fma_f32 v201, v6, -v174, v201
    v_fma_f32 v201, v7, -v175, v201
    s_waitcnt lgkmcnt(0)
    v_mfma_f32_32x32x16_bf16 v[16:31], v[80:83], v[176:179], v[16:31]
    v_mul_f32_e64 v203, v8, -v168
    v_fma_f32 v203, v9, -v169, v203
    v_fma_f32 v203, v10, -v170, v203
    v_fma_f32 v203, v11, -v171, v203
    v_fma_f32 v203, v12, -v172, v203
    v_fma_f32 v203, v13, -v173, v203
    s_add_u32 m0, s21, 2048
    v_mfma_f32_32x32x16_bf16 v[48:63], v[84:87], v[176:179], v[48:63]
    s_cbranch_vccnz WL_4_1
    v_mad_u32_u16 v236, v236, s3, v246 op_sel:[1,0,0,0]
    v_mad_u32_u16 v237, v237, s3, v246 op_sel:[1,0,0,0]
    buffer_load_dwordx4 v236, s[4:7], s39 offen  lds
    buffer_load_dwordx4 v237, s[8:11], s39 offen offset:1024  lds
WR_4_1:
    v_fma_f32 v203, v14, -v174, v203
    v_fma_f32 v203, v15, -v175, v203
    v_mfma_f32_32x32x16_bf16 v[0:15], v[72:75], v[180:183], 0
    v_fmac_f32 v200, v24, v160
    v_fmac_f32 v200, v25, v161
    v_fmac_f32 v200, v26, v162
    v_fmac_f32 v200, v27, v163
    v_fmac_f32 v200, v28, v164
    v_fmac_f32 v200, v29, v165
    v_fmac_f32 v200, v30, v166
    v_fmac_f32 v200, v31, v167
    v_mfma_f32_32x32x16_bf16 v[24:39], v[76:79], v[180:183], 0
    s_waitcnt vmcnt(6)
    ds_read_b64_tr_b16 v[176:177], v244 offset:4096
    ds_read_b64_tr_b16 v[178:179], v244 offset:5120
    ds_read_b64_tr_b16 v[180:181], v245 offset:4096
    ds_read_b64_tr_b16 v[182:183], v245 offset:5120
    v_mul_f32 v254, v16, v144
    v_fmac_f32 v254, v17, v145
    v_mfma_f32_32x32x16_bf16 v[24:39], v[84:87], v[184:187], v[24:39]
    v_fmac_f32 v254, v18, v146
    v_fmac_f32 v254, v19, v147
    v_fmac_f32 v254, v20, v148
    v_fmac_f32 v254, v21, v149
    v_fmac_f32 v254, v22, v150
    v_fmac_f32 v254, v23, v151
    v_mfma_f32_32x32x16_bf16 v[0:15], v[80:83], v[184:187], v[0:15]
    v_sub_f32_e64 v64, -v48, v64
    v_sub_f32_e64 v65, -v49, v65
    v_permlane32_swap_b32 v196, v254
    v_sub_f32_e64 v66, -v50, v66
    v_sub_f32_e64 v67, -v51, v67
    v_sub_f32_e64 v68, -v52, v68
    v_sub_f32_e64 v69, -v53, v69
    v_sub_f32_e64 v70, -v54, v70
    v_sub_f32_e64 v71, -v55, v71
    v_add_f32 v254, v196, v254
    s_waitcnt vmcnt(4) lgkmcnt(0)
    v_mfma_f32_32x32x16_bf16 v[56:71], v[76:79], v[176:179], v[56:71]
    v_sub_f32_e64 v40, -v24, v40
    v_sub_f32_e64 v41, -v25, v41
    v_sub_f32_e64 v42, -v26, v42
    v_sub_f32_e64 v43, -v27, v43
    v_sub_f32_e64 v44, -v28, v44
    v_sub_f32_e64 v45, -v29, v45
    v_sub_f32_e64 v46, -v30, v46
    v_sub_f32_e64 v47, -v31, v47
    s_add_u32 m0, s21, 4096
    v_mfma_f32_32x32x16_bf16 v[16:31], v[72:75], v[176:179], 0
    s_cbranch_vccnz WL_4_2
    v_mad_u32_u16 v238, v238, s3, v246 op_sel:[1,0,0,0]
    v_mad_u32_u16 v239, v239, s3, v246 op_sel:[1,0,0,0]
    buffer_load_dwordx4 v238, s[4:7], s40 offen  lds
    buffer_load_dwordx4 v239, s[8:11], s40 offen offset:1024  lds
WR_4_2:
    ds_read_b64_tr_b16 v[176:177], v244 offset:6144
    ds_read_b64_tr_b16 v[178:179], v244 offset:7168
    ds_read_b64_tr_b16 v[184:185], v245 offset:6144
    ds_read_b64_tr_b16 v[186:187], v245 offset:7168
    v_mul_f32 v255, v0, v152
    v_fmac_f32 v255, v1, v153
    v_fmac_f32 v255, v2, v154
    v_fmac_f32 v255, v3, v155
    v_fmac_f32 v255, v4, v156
    v_fmac_f32 v255, v5, v157
    v_fmac_f32 v255, v6, v158
    v_fmac_f32 v255, v7, v159
    v_fmac_f32 v201, v8, v168
    v_fmac_f32 v201, v9, v169
    v_permlane32_swap_b32 v197, v255
    s_waitcnt lgkmcnt(0)
    v_mfma_f32_32x32x16_bf16 v[16:31], v[80:83], v[176:179], v[16:31]
    v_fmac_f32 v201, v10, v170
    v_fmac_f32 v201, v11, v171
    v_fmac_f32 v201, v12, v172
    v_fmac_f32 v201, v13, v173
    v_fmac_f32 v201, v14, v174
    v_fmac_f32 v201, v15, v175
    s_add_u32 m0, s21, 6144
    v_mfma_f32_32x32x16_bf16 v[56:71], v[84:87], v[176:179], v[56:71]
    s_cbranch_vccnz WL_4_3
    v_mad_u32_u16 v240, v240, s3, v246 op_sel:[1,0,0,0]
    v_mad_u32_u16 v241, v241, s3, v246 op_sel:[1,0,0,0]
    buffer_load_dwordx4 v240, s[4:7], s41 offen  lds
    buffer_load_dwordx4 v241, s[8:11], s41 offen offset:1024  lds
WR_4_3:
    v_add_f32 v255, v197, v255
    v_cvt_pk_bf16_f32 v194, v254, v255
    v_mfma_f32_32x32x16_bf16 v[0:15], v[72:75], v[180:183], 0
    v_mul_f32 v254, v16, v144
    v_fmac_f32 v254, v17, v145
    v_fmac_f32 v254, v18, v146
    v_fmac_f32 v254, v19, v147
    v_fmac_f32 v254, v20, v148
    v_fmac_f32 v254, v21, v149
    v_mfma_f32_32x32x16_bf16 v[32:47], v[76:79], v[180:183], v[32:47]
    s_waitcnt vmcnt(6)
    ds_read_b64_tr_b16 v[176:177], v244 offset:0
    ds_read_b64_tr_b16 v[178:179], v244 offset:1024
    ds_read_b64_tr_b16 v[180:181], v245 offset:0
    ds_read_b64_tr_b16 v[182:183], v245 offset:1024
    v_fmac_f32 v254, v22, v150
    v_fmac_f32 v254, v23, v151
    v_mfma_f32_32x32x16_bf16 v[0:15], v[80:83], v[184:187], v[0:15]
    v_fma_f32 v202, v24, -v160, v202
    v_fma_f32 v202, v25, -v161, v202
    v_permlane32_swap_b32 v254, v200
    v_fma_f32 v202, v26, -v162, v202
    v_fma_f32 v202, v27, -v163, v202
    v_fma_f32 v202, v28, -v164, v202
    v_mfma_f32_32x32x16_bf16 v[32:47], v[84:87], v[184:187], v[32:47]
    v_add_u32 v249, s48, v249
    v_add_u32 v250, s49, v250
    ds_read_b32 v252, v251 offset:16
    ds_read_b64_tr_b16 v[72:73], v249 offset:0
    ds_read_b64_tr_b16 v[76:77], v249 offset:64
    ds_read_b64_tr_b16 v[74:75], v249 offset:256
    ds_read_b64_tr_b16 v[78:79], v249 offset:320
    s_mov_b64 exec, s[54:55]
    ds_read_u16_d16_hi v242, v250 offset:0
    s_mov_b64 exec, -1
    v_fma_f32 v202, v29, -v165, v202
    v_fma_f32 v202, v30, -v166, v202
    v_fma_f32 v202, v31, -v167, v202
    v_add_f32 v200, v254, v200
    v_mul_f32_e64 v198, v64, -v112
    v_permlane32_swap_b32 v202, v254
    v_fma_f32 v198, v65, -v113, v198
    v_fma_f32 v198, v66, -v114, v198
    v_fma_f32 v198, v67, -v115, v198
    v_fma_f32 v198, v68, -v116, v198
    v_fma_f32 v198, v69, -v117, v198
    v_fma_f32 v198, v70, -v118, v198
    v_fma_f32 v198, v71, -v119, v198
    v_add_f32 v254, v202, v254
    v_mul_f32 v196, v56, v160
    v_fmac_f32 v196, v57, v161
    v_fmac_f32 v196, v58, v162
    v_fmac_f32 v196, v59, v163
    v_fmac_f32 v196, v60, v164
    v_fmac_f32 v196, v61, v165
    v_fmac_f32 v196, v62, v166
    v_fmac_f32 v196, v63, v167
    s_nop 1
    v_permlane32_swap_b32 v198, v196
    v_add_f32 v196, v198, v196
    s_cbranch_vccnz LEPI_0
    v_mul_f32 v255, v0, v152
    v_fmac_f32 v255, v1, v153
    v_fmac_f32 v255, v2, v154
    v_fmac_f32 v255, v3, v155
    v_fmac_f32 v255, v4, v156
    v_fmac_f32 v255, v5, v157
    v_fmac_f32 v255, v6, v158
    v_fmac_f32 v255, v7, v159
    v_fma_f32 v203, v8, -v168, v203
    v_fma_f32 v203, v9, -v169, v203
    v_permlane32_swap_b32 v255, v201
    v_fma_f32 v203, v10, -v170, v203
    v_fma_f32 v203, v11, -v171, v203
    v_fma_f32 v203, v12, -v172, v203
    v_fma_f32 v203, v13, -v173, v203
    v_fma_f32 v203, v14, -v174, v203
    v_fma_f32 v203, v15, -v175, v203
    v_add_f32 v201, v255, v201
    v_mul_f32_e64 v199, v40, -v120
    v_permlane32_swap_b32 v203, v255
    v_fma_f32 v199, v41, -v121, v199
    v_fma_f32 v199, v42, -v122, v199
    v_fma_f32 v199, v43, -v123, v199
    v_fma_f32 v199, v44, -v124, v199
    v_fma_f32 v199, v45, -v125, v199
    v_fma_f32 v199, v46, -v126, v199
    v_fma_f32 v199, v47, -v127, v199
    v_add_f32 v255, v203, v255
    v_mul_f32 v197, v32, v168
    v_fmac_f32 v197, v33, v169
    v_fmac_f32 v197, v34, v170
    v_fmac_f32 v197, v35, v171
    v_fmac_f32 v197, v36, v172
    v_fmac_f32 v197, v37, v173
    v_fmac_f32 v197, v38, v174
    v_fmac_f32 v197, v39, v175
    s_nop 1
    v_permlane32_swap_b32 v199, v197
    v_add_f32 v197, v199, v197
    v_cvt_pk_bf16_f32 v200, v200, v201
    v_cvt_pk_bf16_f32 v254, v254, v255
    v_cvt_pk_bf16_f32 v196, v196, v197
    ds_write2st64_b32 v253, v192, v193 offset0:0 offset1:1
    ds_write2st64_b32 v253, v194, v200 offset0:2 offset1:3
    ds_write_b32 v253, v196 offset:1024
    s_mov_b64 exec, 0xffffffff
    ds_write_b32 v253, v254 offset:1280
    s_mov_b64 exec, -1
    s_add_u32 s50, s50, 1
    s_cmp_ge_u32 s50, 4
    s_cbranch_scc1 LAST1
    s_waitcnt lgkmcnt(9)
    v_readfirstlane_b32 s66, v252
    s_add_u32 s53, s53, 1
    v_mov_b32 v252, s53
    s_cmp_le_u32 s53, s66
    ds_write2_b32 v251, v252, v252 offset0:0 offset1:8
    s_setprio 1
    s_cbranch_scc1 PRIO_11
    s_setprio 0
PRIO_11:
    s_cmp_eq_u32 s52, 4
    s_cbranch_scc1 ITEM_1_4
    s_cmp_eq_u32 s52, 5
    s_cbranch_scc1 ITEM_1_5
    s_cmp_eq_u32 s52, 3
    s_cbranch_scc1 ITEM_1_3
    s_cmp_eq_u32 s52, 6
    s_cbranch_scc1 ITEM_1_6
    s_cmp_eq_u32 s52, 8
    s_cbranch_scc1 ITEM_1_8
    s_branch ITEM_1_2
WL_4_0:
    s_add_u32 s66, s51, 0
    buffer_load_dwordx4 v[96:99], v246, s[16:19], s66 offen offset:2048 sc1
    buffer_load_dwordx4 v[100:103], v246, s[16:19], s66 offen offset:3072 sc1
    s_branch WR_4_0
WL_4_1:
    s_add_u32 s66, s51, 4096
    buffer_load_dwordx4 v[104:107], v246, s[16:19], s66 offen offset:2048 sc1
    buffer_load_dwordx4 v[108:111], v246, s[16:19], s66 offen offset:3072 sc1
    s_branch WR_4_1
WL_4_2:
    s_add_u32 s66, s51, 8192
    buffer_load_dwordx4 v[128:131], v246, s[16:19], s66 offen offset:2048 sc1
    buffer_load_dwordx4 v[132:135], v246, s[16:19], s66 offen offset:3072 sc1
    s_branch WR_4_2
WL_4_3:
    s_add_u32 s66, s51, 12288
    buffer_load_dwordx4 v[136:139], v246, s[16:19], s66 offen offset:2048 sc1
    buffer_load_dwordx4 v[140:143], v246, s[16:19], s66 offen offset:3072 sc1
    s_branch WR_4_3
.p2align 6
ITEM_1_5:
    s_mov_b64 exec, s[54:55]
    ds_read_u16_d16_hi v243, v250 offset:128
    s_mov_b64 exec, -1
    ds_read_b64_tr_b16 v[80:81], v249 offset:512
    ds_read_b64_tr_b16 v[84:85], v249 offset:576
    ds_read_b64_tr_b16 v[82:83], v249 offset:768
    ds_read_b64_tr_b16 v[86:87], v249 offset:832
    ds_read_b64_tr_b16 v[88:89], v249 offset:1024
    ds_read_b64_tr_b16 v[92:93], v249 offset:1088
    s_waitcnt lgkmcnt(7)
    v_mul_f32_dpp v196, v242, v72 row_newbcast:0 row_mask:0xf bank_mask:0xf
    v_mul_f32_dpp v197, v242, v73 row_newbcast:1 row_mask:0xf bank_mask:0xf
    v_mul_f32_dpp v198, v242, v72 row_newbcast:8 row_mask:0xf bank_mask:0xf
    v_mul_f32_dpp v199, v242, v73 row_newbcast:9 row_mask:0xf bank_mask:0xf
    v_mul_f32_dpp v200, v242, v76 row_newbcast:2 row_mask:0xf bank_mask:0xf
    v_mul_f32_dpp v201, v242, v77 row_newbcast:3 row_mask:0xf bank_mask:0xf
    v_mul_f32_dpp v202, v242, v76 row_newbcast:10 row_mask:0xf bank_mask:0xf
    v_mul_f32_dpp v203, v242, v77 row_newbcast:11 row_mask:0xf bank_mask:0xf
    v_cvt_pk_bf16_f32 v72, v196, v197
    v_cvt_pk_bf16_f32 v76, v198, v199
    v_cvt_pk_bf16_f32 v73, v200, v201
    v_cvt_pk_bf16_f32 v77, v202, v203
    v_mul_f32_dpp v196, v242, v74 row_newbcast:4 row_mask:0xf bank_mask:0xf
    v_mul_f32_dpp v197, v242, v75 row_newbcast:5 row_mask:0xf bank_mask:0xf
    v_mul_f32_dpp v198, v242, v74 row_newbcast:12 row_mask:0xf bank_mask:0xf
    v_mul_f32_dpp v199, v242, v75 row_newbcast:13 row_mask:0xf bank_mask:0xf
    v_mul_f32_dpp v200, v242, v78 row_newbcast:6 row_mask:0xf bank_mask:0xf
    v_mul_f32_dpp v201, v242, v79 row_newbcast:7 row_mask:0xf bank_mask:0xf
    v_mul_f32_dpp v202, v242, v78 row_newbcast:14 row_mask:0xf bank_mask:0xf
    v_mul_f32_dpp v203, v242, v79 row_newbcast:15 row_mask:0xf bank_mask:0xf
    v_cvt_pk_bf16_f32 v74, v196, v197
    v_cvt_pk_bf16_f32 v78, v198, v199
    v_cvt_pk_bf16_f32 v75, v200, v201
    v_cvt_pk_bf16_f32 v79, v202, v203
    s_mov_b64 exec, s[54:55]
    ds_read_u16_d16_hi v242, v250 offset:256
    s_mov_b64 exec, -1
    s_waitcnt vmcnt(4) lgkmcnt(3)
    v_mfma_f32_32x32x16_bf16 v[56:71], v[72:75], v[176:179], 0
    v_mul_f32_dpp v196, v243, v80 row_newbcast:0 row_mask:0xf bank_mask:0xf
    v_mul_f32_dpp v197, v243, v81 row_newbcast:1 row_mask:0xf bank_mask:0xf
    v_mul_f32_dpp v198, v243, v80 row_newbcast:8 row_mask:0xf bank_mask:0xf
    v_mul_f32_dpp v199, v243, v81 row_newbcast:9 row_mask:0xf bank_mask:0xf
    v_mul_f32_dpp v200, v243, v84 row_newbcast:2 row_mask:0xf bank_mask:0xf
    v_mul_f32_dpp v201, v243, v85 row_newbcast:3 row_mask:0xf bank_mask:0xf
    s_add_u32 m0, s21, 0
    v_mfma_f32_32x32x16_bf16 v[16:31], v[76:79], v[176:179], 0
    buffer_load_dwordx4 v236, s[4:7], s35 offen  lds
    buffer_load_dwordx4 v237, s[8:11], s35 offen offset:1024  lds
    ds_read_b64_tr_b16 v[176:177], v244 offset:2048
    ds_read_b64_tr_b16 v[178:179], v244 offset:3072
    ds_read_b64_tr_b16 v[184:185], v245 offset:2048
    ds_read_b64_tr_b16 v[186:187], v245 offset:3072
    v_mul_f32_dpp v202, v243, v84 row_newbcast:10 row_mask:0xf bank_mask:0xf
    v_mul_f32_dpp v203, v243, v85 row_newbcast:11 row_mask:0xf bank_mask:0xf
    v_cvt_pk_bf16_f32 v80, v196, v197
    v_cvt_pk_bf16_f32 v84, v198, v199
    v_cvt_pk_bf16_f32 v81, v200, v201
    v_cvt_pk_bf16_f32 v85, v202, v203
    v_mul_f32_dpp v196, v243, v82 row_newbcast:4 row_mask:0xf bank_mask:0xf
    v_mul_f32_dpp v197, v243, v83 row_newbcast:5 row_mask:0xf bank_mask:0xf
    v_mul_f32_dpp v198, v243, v82 row_newbcast:12 row_mask:0xf bank_mask:0xf
    v_mul_f32_dpp v199, v243, v83 row_newbcast:13 row_mask:0xf bank_mask:0xf
    v_mul_f32_dpp v200, v243, v86 row_newbcast:6 row_mask:0xf bank_mask:0xf
    v_mul_f32_dpp v201, v243, v87 row_newbcast:7 row_mask:0xf bank_mask:0xf
    v_mul_f32_dpp v202, v243, v86 row_newbcast:14 row_mask:0xf bank_mask:0xf
    v_mul_f32_dpp v203, v243, v87 row_newbcast:15 row_mask:0xf bank_mask:0xf
    v_cvt_pk_bf16_f32 v82, v196, v197
    v_cvt_pk_bf16_f32 v86, v198, v199
    v_cvt_pk_bf16_f32 v83, v200, v201
    v_cvt_pk_bf16_f32 v87, v202, v203
    s_waitcnt vmcnt(4) lgkmcnt(0)
    v_mfma_f32_32x32x16_bf16 v[56:71], v[80:83], v[176:179], v[56:71]
    v_mul_f32_dpp v196, v242, v88 row_newbcast:0 row_mask:0xf bank_mask:0xf
    v_mul_f32_dpp v197, v242, v89 row_newbcast:1 row_mask:0xf bank_mask:0xf
    v_mul_f32_dpp v198, v242, v88 row_newbcast:8 row_mask:0xf bank_mask:0xf
    v_mul_f32_dpp v199, v242, v89 row_newbcast:9 row_mask:0xf bank_mask:0xf
    v_mul_f32_dpp v200, v242, v92 row_newbcast:2 row_mask:0xf bank_mask:0xf
    v_mul_f32_dpp v201, v242, v93 row_newbcast:3 row_mask:0xf bank_mask:0xf
    s_add_u32 m0, s21, 2048
    v_mfma_f32_32x32x16_bf16 v[16:31], v[84:87], v[176:179], v[16:31]
    buffer_load_dwordx4 v238, s[4:7], s35 offen  lds
    ds_read_b64_tr_b16 v[176:177], v244 offset:4096
    ds_read_b64_tr_b16 v[188:189], v245 offset:4096
    v_mul_f32_dpp v202, v242, v92 row_newbcast:10 row_mask:0xf bank_mask:0xf
    v_mul_f32_dpp v203, v242, v93 row_newbcast:11 row_mask:0xf bank_mask:0xf
    v_cvt_pk_bf16_f32 v88, v196, v197
    v_cvt_pk_bf16_f32 v92, v198, v199
    v_cvt_pk_bf16_f32 v89, v200, v201
    v_cvt_pk_bf16_f32 v93, v202, v203
    s_waitcnt lgkmcnt(0)
    v_mfma_f32_32x32x8_bf16 v[56:71], v[88:89], v[176:177], v[56:71]
    s_add_u32 m0, s21, 4096
    v_mfma_f32_32x32x8_bf16 v[16:31], v[92:93], v[176:177], v[16:31]
    buffer_load_dwordx4 v234, s[4:7], s36 offen  lds
    buffer_load_dwordx4 v235, s[8:11], s36 offen offset:1024  lds
    s_mov_b32 m0, s50
    s_nop 0
    s_movrels_b32 s71, s23
    s_movrels_b32 s33, s28
    v_add_u32 v253, s33, v248
    s_bfe_u32 s46, s71, 0x30012
    s_mov_b32 m0, s46
    s_and_b32 s66, s71, 0x3ffff
    s_movrels_b32 s68, s57
    s_movrels_b32 s69, s61
    s_sub_u32 s48, s66, s47
    s_mov_b32 s47, s66
    s_lshr_b32 s52, s71, 28
    s_lshl_b32 s67, s46, 9
    s_add_u32 s66, s66, s67
    s_sub_u32 s49, s66, s42
    s_mov_b32 s42, s66
    s_bfe_u32 s66, s68, 655360
    s_add_u32 s43, s42, s66
    s_bfe_u32 s39, s69, 655360
    s_bfe_u32 s66, s68, 655370
    s_add_u32 s44, s42, s66
    s_bfe_u32 s40, s69, 655370
    s_bfe_u32 s66, s68, 655380
    s_add_u32 s45, s42, s66
    s_bfe_u32 s41, s69, 655380
    v_add_u32 v252, s45, v247
    ds_read2_b32 v[240:241], v252 offset0:0 offset1:16
    v_mfma_f32_32x32x16_bf16 v[32:47], v[72:75], v[180:183], 0
    v_mul_f32 v196, v56, v96
    v_fmac_f32 v196, v57, v97
    v_fmac_f32 v196, v58, v98
    v_fmac_f32 v196, v59, v99
    v_fmac_f32 v196, v60, v100
    v_fmac_f32 v196, v61, v101
    v_mfma_f32_32x32x16_bf16 v[0:15], v[76:79], v[180:183], 0
    v_fmac_f32 v196, v62, v102
    v_fmac_f32 v196, v63, v103
    v_mul_f32 v198, v64, v128
    v_fmac_f32 v198, v65, v129
    v_fmac_f32 v198, v66, v130
    v_fmac_f32 v198, v67, v131
    v_mfma_f32_32x32x16_bf16 v[32:47], v[80:83], v[184:187], v[32:47]
    v_fmac_f32 v198, v68, v132
    v_fmac_f32 v198, v69, v133
    v_fmac_f32 v198, v70, v134
    v_fmac_f32 v198, v71, v135
    v_mul_f32 v200, v16, v128
    v_fmac_f32 v200, v17, v129
    v_mfma_f32_32x32x16_bf16 v[0:15], v[84:87], v[184:187], v[0:15]
    s_waitcnt vmcnt(5)
    ds_read_b64_tr_b16 v[176:177], v244 offset:6144
    ds_read_b64_tr_b16 v[178:179], v244 offset:7168
    ds_read_b64_tr_b16 v[180:181], v245 offset:6144
    ds_read_b64_tr_b16 v[182:183], v245 offset:7168
    v_permlane32_swap_b32 v196, v198
    v_fmac_f32 v200, v18, v130
    v_mfma_f32_32x32x8_bf16 v[32:47], v[88:89], v[188:189], v[32:47]
    v_fmac_f32 v200, v19, v131
    v_fmac_f32 v200, v20, v132
    v_fmac_f32 v200, v21, v133
    v_fmac_f32 v200, v22, v134
    v_fmac_f32 v200, v23, v135
    v_add_f32 v198, v196, v198
    v_mfma_f32_32x32x8_bf16 v[0:15], v[92:93], v[188:189], v[0:15]
    v_mul_f32_e64 v202, v24, -v128
    v_fma_f32 v202, v25, -v129, v202
    v_fma_f32 v202, v26, -v130, v202
    v_fma_f32 v202, v27, -v131, v202
    v_fma_f32 v202, v28, -v132, v202
    v_fma_f32 v202, v29, -v133, v202
    v_fma_f32 v202, v30, -v134, v202
    v_fma_f32 v202, v31, -v135, v202
    s_nop 1
    v_permlane32_swap_b32 v200, v202
    v_add_f32 v202, v200, v202
    s_waitcnt vmcnt(3) lgkmcnt(0)
    v_mfma_f32_32x32x16_bf16 v[56:71], v[72:75], v[176:179], 0
    v_mul_f32 v197, v32, v104
    v_fmac_f32 v197, v33, v105
    v_fmac_f32 v197, v34, v106
    v_fmac_f32 v197, v35, v107
    v_fmac_f32 v197, v36, v108
    v_fmac_f32 v197, v37, v109
    s_add_u32 m0, s21, 6144
    v_mfma_f32_32x32x16_bf16 v[16:31], v[76:79], v[176:179], 0
    buffer_load_dwordx4 v236, s[4:7], s36 offen  lds
    buffer_load_dwordx4 v237, s[8:11], s36 offen offset:1024  lds
    ds_read_b64_tr_b16 v[176:177], v244 offset:0
    ds_read_b64_tr_b16 v[178:179], v244 offset:1024
    ds_read_b64_tr_b16 v[184:185], v245 offset:0
    ds_read_b64_tr_b16 v[186:187], v245 offset:1024
    v_fmac_f32 v197, v38, v110
    v_fmac_f32 v197, v39, v111
    v_mul_f32 v199, v40, v136
    v_fmac_f32 v199, v41, v137
    v_fmac_f32 v199, v42, v138
    v_fmac_f32 v199, v43, v139
    v_fmac_f32 v199, v44, v140
    v_fmac_f32 v199, v45, v141
    v_fmac_f32 v199, v46, v142
    v_fmac_f32 v199, v47, v143
    v_mul_f32 v201, v0, v136
    v_fmac_f32 v201, v1, v137
    v_permlane32_swap_b32 v197, v199
    v_fmac_f32 v201, v2, v138
    v_fmac_f32 v201, v3, v139
    s_waitcnt vmcnt(4) lgkmcnt(0)
    v_mfma_f32_32x32x16_bf16 v[56:71], v[80:83], v[176:179], v[56:71]
    v_fmac_f32 v201, v4, v140
    v_fmac_f32 v201, v5, v141
    v_fmac_f32 v201, v6, v142
    v_fmac_f32 v201, v7, v143
    v_add_f32 v199, v197, v199
    v_mul_f32_e64 v203, v8, -v136
    s_add_u32 m0, s21, 0
    v_mfma_f32_32x32x16_bf16 v[16:31], v[84:87], v[176:179], v[16:31]
    buffer_load_dwordx4 v238, s[4:7], s36 offen  lds
    ds_read_b64_tr_b16 v[176:177], v244 offset:2048
    ds_read_b64_tr_b16 v[188:189], v245 offset:2048
    v_fma_f32 v203, v9, -v137, v203
    v_fma_f32 v203, v10, -v138, v203
    v_fma_f32 v203, v11, -v139, v203
    s_waitcnt lgkmcnt(0)
    v_mfma_f32_32x32x8_bf16 v[56:71], v[88:89], v[176:177], v[56:71]
    v_fma_f32 v203, v12, -v140, v203
    v_fma_f32 v203, v13, -v141, v203
    v_fma_f32 v203, v14, -v142, v203
    v_fma_f32 v203, v15, -v143, v203
    s_nop 1
    v_permlane32_swap_b32 v201, v203
    v_add_f32 v203, v201, v203
    s_add_u32 m0, s21, 2048
    v_mfma_f32_32x32x8_bf16 v[16:31], v[92:93], v[176:177], v[16:31]
    buffer_load_dwordx4 v234, s[4:7], s37 offen  lds
    buffer_load_dwordx4 v235, s[8:11], s37 offen offset:1024  lds
    v_add_u32 v252, s42, v247
    ds_read2_b32 v[234:235], v252 offset0:0 offset1:16
    v_cvt_pk_bf16_f32 v192, v198, v199
    v_cvt_pk_bf16_f32 v193, v202, v203
    v_mfma_f32_32x32x16_bf16 v[32:47], v[72:75], v[180:183], 0
    v_mul_f32 v196, v56, v144
    v_fmac_f32 v196, v57, v145
    v_fmac_f32 v196, v58, v146
    v_fmac_f32 v196, v59, v147
    v_fmac_f32 v196, v60, v148
    v_fmac_f32 v196, v61, v149
    v_mfma_f32_32x32x16_bf16 v[0:15], v[76:79], v[180:183], 0
    v_fmac_f32 v196, v62, v150
    v_fmac_f32 v196, v63, v151
    v_mul_f32_e64 v200, v16, -v160
    v_fma_f32 v200, v17, -v161, v200
    v_fma_f32 v200, v18, -v162, v200
    v_fma_f32 v200, v19, -v163, v200
    v_mfma_f32_32x32x16_bf16 v[32:47], v[80:83], v[184:187], v[32:47]
    v_fma_f32 v200, v20, -v164, v200
    v_fma_f32 v200, v21, -v165, v200
    v_fma_f32 v200, v22, -v166, v200
    v_fma_f32 v200, v23, -v167, v200
    v_mul_f32_e64 v202, v24, -v160
    v_fma_f32 v202, v25, -v161, v202
    v_mfma_f32_32x32x16_bf16 v[0:15], v[84:87], v[184:187], v[0:15]
    s_waitcnt vmcnt(5)
    ds_read_b64_tr_b16 v[176:177], v244 offset:4096
    ds_read_b64_tr_b16 v[178:179], v244 offset:5120
    ds_read_b64_tr_b16 v[180:181], v245 offset:4096
    ds_read_b64_tr_b16 v[182:183], v245 offset:5120
    v_fma_f32 v202, v26, -v162, v202
    v_fma_f32 v202, v27, -v163, v202
    v_mfma_f32_32x32x8_bf16 v[32:47], v[88:89], v[188:189], v[32:47]
    v_fma_f32 v202, v28, -v164, v202
    v_fma_f32 v202, v29, -v165, v202
    v_fma_f32 v202, v30, -v166, v202
    v_fma_f32 v202, v31, -v167, v202
    v_mfma_f32_32x32x8_bf16 v[0:15], v[92:93], v[188:189], v[0:15]
    s_waitcnt vmcnt(3) lgkmcnt(0)
    v_mfma_f32_32x32x16_bf16 v[16:31], v[72:75], v[176:179], 0
    s_nop 4
    v_mul_f32 v197, v32, v152
    v_fmac_f32 v197, v33, v153
    v_fmac_f32 v197, v34, v154
    v_fmac_f32 v197, v35, v155
    v_fmac_f32 v197, v36, v156
    v_fmac_f32 v197, v37, v157
    s_add_u32 m0, s21, 4096
    v_mfma_f32_32x32x16_bf16 v[48:63], v[76:79], v[176:179], 0
    buffer_load_dwordx4 v236, s[4:7], s37 offen  lds
    buffer_load_dwordx4 v237, s[8:11], s37 offen offset:1024  lds
    ds_read_b64_tr_b16 v[176:177], v244 offset:6144
    ds_read_b64_tr_b16 v[178:179], v244 offset:7168
    ds_read_b64_tr_b16 v[184:185], v245 offset:6144
    ds_read_b64_tr_b16 v[186:187], v245 offset:7168
    v_add_u32 v252, s43, v247
    ds_read2_b32 v[236:237], v252 offset0:0 offset1:16
    v_fmac_f32 v197, v38, v158
    v_fmac_f32 v197, v39, v159
    v_mul_f32_e64 v201, v0, -v168
    s_waitcnt vmcnt(4) lgkmcnt(1)
    v_mfma_f32_32x32x16_bf16 v[16:31], v[80:83], v[176:179], v[16:31]
    v_fma_f32 v201, v1, -v169, v201
    v_fma_f32 v201, v2, -v170, v201
    v_fma_f32 v201, v3, -v171, v201
    v_fma_f32 v201, v4, -v172, v201
    v_fma_f32 v201, v5, -v173, v201
    v_fma_f32 v201, v6, -v174, v201
    s_add_u32 m0, s21, 6144
    v_mfma_f32_32x32x16_bf16 v[48:63], v[84:87], v[176:179], v[48:63]
    buffer_load_dwordx4 v238, s[4:7], s37 offen  lds
    ds_read_b64_tr_b16 v[176:177], v244 offset:0
    ds_read_b64_tr_b16 v[188:189], v245 offset:0
    v_add_u32 v252, s44, v247
    ds_read2_b32 v[238:239], v252 offset0:0 offset1:16
    v_fma_f32 v201, v7, -v175, v201
    s_waitcnt lgkmcnt(1)
    v_mfma_f32_32x32x8_bf16 v[16:31], v[88:89], v[176:177], v[16:31]
    v_mul_f32_e64 v203, v8, -v168
    v_fma_f32 v203, v9, -v169, v203
    v_fma_f32 v203, v10, -v170, v203
    v_fma_f32 v203, v11, -v171, v203
    v_fma_f32 v203, v12, -v172, v203
    v_fma_f32 v203, v13, -v173, v203
    s_add_u32 m0, s21, 0
    v_mfma_f32_32x32x8_bf16 v[48:63], v[92:93], v[176:177], v[48:63]
    s_cbranch_vccnz WL_5_0
    v_mad_u32_u16 v234, v234, s3, v246 op_sel:[1,0,0,0]
    v_mad_u32_u16 v235, v235, s3, v246 op_sel:[1,0,0,0]
    buffer_load_dwordx4 v234, s[4:7], s38 offen  lds
    buffer_load_dwordx4 v235, s[8:11], s38 offen offset:1024  lds
WR_5_0:
    v_fma_f32 v203, v14, -v174, v203
    v_fma_f32 v203, v15, -v175, v203
    v_mfma_f32_32x32x16_bf16 v[0:15], v[72:75], v[180:183], 0
    v_fmac_f32 v200, v24, v160
    v_fmac_f32 v200, v25, v161
    v_fmac_f32 v200, v26, v162
    v_fmac_f32 v200, v27, v163
    v_fmac_f32 v200, v28, v164
    v_fmac_f32 v200, v29, v165
    v_fmac_f32 v200, v30, v166
    v_fmac_f32 v200, v31, v167
    v_mfma_f32_32x32x16_bf16 v[24:39], v[76:79], v[180:183], 0
    v_mul_f32 v254, v16, v144
    v_fmac_f32 v254, v17, v145
    v_fmac_f32 v254, v18, v146
    v_fmac_f32 v254, v19, v147
    v_fmac_f32 v254, v20, v148
    v_fmac_f32 v254, v21, v149
    v_mfma_f32_32x32x16_bf16 v[0:15], v[80:83], v[184:187], v[0:15]
    v_fmac_f32 v254, v22, v150
    v_fmac_f32 v254, v23, v151
    v_sub_f32_e64 v64, -v48, v64
    v_sub_f32_e64 v65, -v49, v65
    v_permlane32_swap_b32 v196, v254
    v_sub_f32_e64 v66, -v50, v66
    v_mfma_f32_32x32x16_bf16 v[24:39], v[84:87], v[184:187], v[24:39]
    s_waitcnt vmcnt(5)
    ds_read_b64_tr_b16 v[176:177], v244 offset:2048
    ds_read_b64_tr_b16 v[178:179], v244 offset:3072
    ds_read_b64_tr_b16 v[180:181], v245 offset:2048
    ds_read_b64_tr_b16 v[182:183], v245 offset:3072
    v_sub_f32_e64 v67, -v51, v67
    v_sub_f32_e64 v68, -v52, v68
    v_mfma_f32_32x32x8_bf16 v[24:39], v[92:93], v[188:189], v[24:39]
    v_sub_f32_e64 v69, -v53, v69
    v_sub_f32_e64 v70, -v54, v70
    v_sub_f32_e64 v71, -v55, v71
    v_add_f32 v254, v196, v254
    v_mfma_f32_32x32x8_bf16 v[0:15], v[88:89], v[188:189], v[0:15]
    s_waitcnt vmcnt(3) lgkmcnt(0)
    v_mfma_f32_32x32x16_bf16 v[56:71], v[76:79], v[176:179], v[56:71]
    s_nop 4
    v_sub_f32_e64 v40, -v24, v40
    v_sub_f32_e64 v41, -v25, v41
    v_sub_f32_e64 v42, -v26, v42
    v_sub_f32_e64 v43, -v27, v43
    v_sub_f32_e64 v44, -v28, v44
    v_sub_f32_e64 v45, -v29, v45
    v_sub_f32_e64 v46, -v30, v46
    v_sub_f32_e64 v47, -v31, v47
    s_add_u32 m0, s21, 2048
    v_mfma_f32_32x32x16_bf16 v[16:31], v[72:75], v[176:179], 0
    s_cbranch_vccnz WL_5_1
    v_mad_u32_u16 v236, v236, s3, v246 op_sel:[1,0,0,0]
    v_mad_u32_u16 v237, v237, s3, v246 op_sel:[1,0,0,0]
    buffer_load_dwordx4 v236, s[4:7], s39 offen  lds
    buffer_load_dwordx4 v237, s[8:11], s39 offen offset:1024  lds
WR_5_1:
    ds_read_b64_tr_b16 v[176:177], v244 offset:4096
    ds_read_b64_tr_b16 v[178:179], v244 offset:5120
    ds_read_b64_tr_b16 v[184:185], v245 offset:4096
    ds_read_b64_tr_b16 v[186:187], v245 offset:5120
    v_mul_f32 v255, v0, v152
    v_fmac_f32 v255, v1, v153
    v_fmac_f32 v255, v2, v154
    v_fmac_f32 v255, v3, v155
    v_fmac_f32 v255, v4, v156
    s_waitcnt vmcnt(4) lgkmcnt(0)
    v_mfma_f32_32x32x16_bf16 v[16:31], v[80:83], v[176:179], v[16:31]
    v_fmac_f32 v255, v5, v157
    v_fmac_f32 v255, v6, v158
    v_fmac_f32 v255, v7, v159
    v_fmac_f32 v201, v8, v168
    v_fmac_f32 v201, v9, v169
    v_permlane32_swap_b32 v197, v255
    s_add_u32 m0, s21, 4096
    v_mfma_f32_32x32x16_bf16 v[56:71], v[84:87], v[176:179], v[56:71]
    s_cbranch_vccnz WL_5_2
    v_mad_u32_u16 v238, v238, s3, v246 op_sel:[1,0,0,0]
    v_mad_u32_u16 v239, v239, s3, v246 op_sel:[1,0,0,0]
    buffer_load_dwordx4 v238, s[4:7], s40 offen  lds
    buffer_load_dwordx4 v239, s[8:11], s40 offen offset:1024  lds
WR_5_2:
    ds_read_b64_tr_b16 v[176:177], v244 offset:6144
    ds_read_b64_tr_b16 v[188:189], v245 offset:6144
    s_waitcnt lgkmcnt(0)
    v_mfma_f32_32x32x8_bf16 v[16:31], v[88:89], v[176:177], v[16:31]
    v_fmac_f32 v201, v10, v170
    v_fmac_f32 v201, v11, v171
    v_fmac_f32 v201, v12, v172
    v_fmac_f32 v201, v13, v173
    v_fmac_f32 v201, v14, v174
    v_fmac_f32 v201, v15, v175
    s_add_u32 m0, s21, 6144
    v_mfma_f32_32x32x8_bf16 v[56:71], v[92:93], v[176:177], v[56:71]
    s_cbranch_vccnz WL_5_3
    v_mad_u32_u16 v240, v240, s3, v246 op_sel:[1,0,0,0]
    v_mad_u32_u16 v241, v241, s3, v246 op_sel:[1,0,0,0]
    buffer_load_dwordx4 v240, s[4:7], s41 offen  lds
    buffer_load_dwordx4 v241, s[8:11], s41 offen offset:1024  lds
WR_5_3:
    v_add_f32 v255, v197, v255
    v_cvt_pk_bf16_f32 v194, v254, v255
    v_mfma_f32_32x32x16_bf16 v[0:15], v[72:75], v[180:183], 0
    v_mul_f32 v254, v16, v144
    v_fmac_f32 v254, v17, v145
    v_fmac_f32 v254, v18, v146
    v_fmac_f32 v254, v19, v147
    v_fmac_f32 v254, v20, v148
    v_fmac_f32 v254, v21, v149
    v_mfma_f32_32x32x16_bf16 v[32:47], v[76:79], v[180:183], v[32:47]
    v_fmac_f32 v254, v22, v150
    v_fmac_f32 v254, v23, v151
    v_fma_f32 v202, v24, -v160, v202
    v_fma_f32 v202, v25, -v161, v202
    v_permlane32_swap_b32 v254, v200
    v_fma_f32 v202, v26, -v162, v202
    v_mfma_f32_32x32x16_bf16 v[0:15], v[80:83], v[184:187], v[0:15]
    v_fma_f32 v202, v27, -v163, v202
    v_fma_f32 v202, v28, -v164, v202
    v_fma_f32 v202, v29, -v165, v202
    v_fma_f32 v202, v30, -v166, v202
    v_fma_f32 v202, v31, -v167, v202
    v_add_f32 v200, v254, v200
    v_mfma_f32_32x32x16_bf16 v[32:47], v[84:87], v[184:187], v[32:47]
    s_waitcnt vmcnt(6)
    ds_read_b64_tr_b16 v[176:177], v244 offset:0
    ds_read_b64_tr_b16 v[178:179], v244 offset:1024
    ds_read_b64_tr_b16 v[180:181], v245 offset:0
    ds_read_b64_tr_b16 v[182:183], v245 offset:1024
    v_mul_f32_e64 v198, v64, -v112
    v_permlane32_swap_b32 v202, v254
    v_mfma_f32_32x32x8_bf16 v[0:15], v[88:89], v[188:189], v[0:15]
    v_fma_f32 v198, v65, -v113, v198
    v_fma_f32 v198, v66, -v114, v198
    v_fma_f32 v198, v67, -v115, v198
    v_fma_f32 v198, v68, -v116, v198
    v_fma_f32 v198, v69, -v117, v198
    v_fma_f32 v198, v70, -v118, v198
    v_mfma_f32_32x32x8_bf16 v[32:47], v[92:93], v[188:189], v[32:47]
    v_add_u32 v249, s48, v249
    v_add_u32 v250, s49, v250
    ds_read_b32 v252, v251 offset:16
    ds_read_b64_tr_b16 v[72:73], v249 offset:0
    ds_read_b64_tr_b16 v[76:77], v249 offset:64
    ds_read_b64_tr_b16 v[74:75], v249 offset:256
    ds_read_b64_tr_b16 v[78:79], v249 offset:320
    s_mov_b64 exec, s[54:55]
    ds_read_u16_d16_hi v242, v250 offset:0
    s_mov_b64 exec, -1
    v_fma_f32 v198, v71, -v119, v198
    v_add_f32 v254, v202, v254
    v_mul_f32 v196, v56, v160
    v_fmac_f32 v196, v57, v161
    v_fmac_f32 v196, v58, v162
    v_fmac_f32 v196, v59, v163
    v_fmac_f32 v196, v60, v164
    v_fmac_f32 v196, v61, v165
    v_fmac_f32 v196, v62, v166
    v_fmac_f32 v196, v63, v167
    s_nop 1
    v_permlane32_swap_b32 v198, v196
    v_add_f32 v196, v198, v196
    s_cbranch_vccnz LEPI_0
    v_mul_f32 v255, v0, v152
    v_fmac_f32 v255, v1, v153
    v_fmac_f32 v255, v2, v154
    v_fmac_f32 v255, v3, v155
    v_fmac_f32 v255, v4, v156
    v_fmac_f32 v255, v5, v157
    v_fmac_f32 v255, v6, v158
    v_fmac_f32 v255, v7, v159
    v_fma_f32 v203, v8, -v168, v203
    v_fma_f32 v203, v9, -v169, v203
    v_permlane32_swap_b32 v255, v201
    v_fma_f32 v203, v10, -v170, v203
    v_fma_f32 v203, v11, -v171, v203
    v_fma_f32 v203, v12, -v172, v203
    v_fma_f32 v203, v13, -v173, v203
    v_fma_f32 v203, v14, -v174, v203
    v_fma_f32 v203, v15, -v175, v203
    v_add_f32 v201, v255, v201
    v_mul_f32_e64 v199, v40, -v120
    v_permlane32_swap_b32 v203, v255
    v_fma_f32 v199, v41, -v121, v199
    v_fma_f32 v199, v42, -v122, v199
    v_fma_f32 v199, v43, -v123, v199
    v_fma_f32 v199, v44, -v124, v199
    v_fma_f32 v199, v45, -v125, v199
    v_fma_f32 v199, v46, -v126, v199
    v_fma_f32 v199, v47, -v127, v199
    v_add_f32 v255, v203, v255
    v_mul_f32 v197, v32, v168
    v_fmac_f32 v197, v33, v169
    v_fmac_f32 v197, v34, v170
    v_fmac_f32 v197, v35, v171
    v_fmac_f32 v197, v36, v172
    v_fmac_f32 v197, v37, v173
    v_fmac_f32 v197, v38, v174
    v_fmac_f32 v197, v39, v175
    s_nop 1
    v_permlane32_swap_b32 v199, v197
    v_add_f32 v197, v199, v197
    v_cvt_pk_bf16_f32 v200, v200, v201
    v_cvt_pk_bf16_f32 v254, v254, v255
    v_cvt_pk_bf16_f32 v196, v196, v197
    ds_write2st64_b32 v253, v192, v193 offset0:0 offset1:1
    ds_write2st64_b32 v253, v194, v200 offset0:2 offset1:3
    ds_write_b32 v253, v196 offset:1024
    s_mov_b64 exec, 0xffffffff
    ds_write_b32 v253, v254 offset:1280
    s_mov_b64 exec, -1
    s_add_u32 s50, s50, 1
    s_cmp_ge_u32 s50, 4
    s_cbranch_scc1 LAST1
    s_waitcnt lgkmcnt(9)
    v_readfirstlane_b32 s66, v252
    s_add_u32 s53, s53, 1
    v_mov_b32 v252, s53
    s_cmp_le_u32 s53, s66
    ds_write2_b32 v251, v252, v252 offset0:0 offset1:8
    s_setprio 1
    s_cbranch_scc1 PRIO_12
    s_setprio 0
PRIO_12:
    s_cmp_eq_u32 s52, 4
    s_cbranch_scc1 ITEM_1_4
    s_cmp_eq_u32 s52, 5
    s_cbranch_scc1 ITEM_1_5
    s_cmp_eq_u32 s52, 3
    s_cbranch_scc1 ITEM_1_3
    s_cmp_eq_u32 s52, 6
    s_cbranch_scc1 ITEM_1_6
    s_cmp_eq_u32 s52, 8
    s_cbranch_scc1 ITEM_1_8
    s_branch ITEM_1_2
WL_5_0:
    s_add_u32 s66, s51, 0
    buffer_load_dwordx4 v[96:99], v246, s[16:19], s66 offen offset:2048 sc1
    buffer_load_dwordx4 v[100:103], v246, s[16:19], s66 offen offset:3072 sc1
    s_branch WR_5_0
WL_5_1:
    s_add_u32 s66, s51, 4096
    buffer_load_dwordx4 v[104:107], v246, s[16:19], s66 offen offset:2048 sc1
    buffer_load_dwordx4 v[108:111], v246, s[16:19], s66 offen offset:3072 sc1
    s_branch WR_5_1
WL_5_2:
    s_add_u32 s66, s51, 8192
    buffer_load_dwordx4 v[128:131], v246, s[16:19], s66 offen offset:2048 sc1
    buffer_load_dwordx4 v[132:135], v246, s[16:19], s66 offen offset:3072 sc1
    s_branch WR_5_2
WL_5_3:
    s_add_u32 s66, s51, 12288
    buffer_load_dwordx4 v[136:139], v246, s[16:19], s66 offen offset:2048 sc1
    buffer_load_dwordx4 v[140:143], v246, s[16:19], s66 offen offset:3072 sc1
    s_branch WR_5_3
.p2align 6
ITEM_1_3:
    s_mov_b64 exec, s[54:55]
    ds_read_u16_d16_hi v243, v250 offset:128
    s_mov_b64 exec, -1
    ds_read_b64_tr_b16 v[80:81], v249 offset:512
    ds_read_b64_tr_b16 v[84:85], v249 offset:576
    s_waitcnt lgkmcnt(3)
    v_mul_f32_dpp v196, v242, v72 row_newbcast:0 row_mask:0xf bank_mask:0xf
    v_mul_f32_dpp v197, v242, v73 row_newbcast:1 row_mask:0xf bank_mask:0xf
    v_mul_f32_dpp v198, v242, v72 row_newbcast:8 row_mask:0xf bank_mask:0xf
    v_mul_f32_dpp v199, v242, v73 row_newbcast:9 row_mask:0xf bank_mask:0xf
    v_mul_f32_dpp v200, v242, v76 row_newbcast:2 row_mask:0xf bank_mask:0xf
    v_mul_f32_dpp v201, v242, v77 row_newbcast:3 row_mask:0xf bank_mask:0xf
    v_mul_f32_dpp v202, v242, v76 row_newbcast:10 row_mask:0xf bank_mask:0xf
    v_mul_f32_dpp v203, v242, v77 row_newbcast:11 row_mask:0xf bank_mask:0xf
    v_cvt_pk_bf16_f32 v72, v196, v197
    v_cvt_pk_bf16_f32 v76, v198, v199
    v_cvt_pk_bf16_f32 v73, v200, v201
    v_cvt_pk_bf16_f32 v77, v202, v203
    v_mul_f32_dpp v196, v242, v74 row_newbcast:4 row_mask:0xf bank_mask:0xf
    v_mul_f32_dpp v197, v242, v75 row_newbcast:5 row_mask:0xf bank_mask:0xf
    v_mul_f32_dpp v198, v242, v74 row_newbcast:12 row_mask:0xf bank_mask:0xf
    v_mul_f32_dpp v199, v242, v75 row_newbcast:13 row_mask:0xf bank_mask:0xf
    v_mul_f32_dpp v200, v242, v78 row_newbcast:6 row_mask:0xf bank_mask:0xf
    v_mul_f32_dpp v201, v242, v79 row_newbcast:7 row_mask:0xf bank_mask:0xf
    v_mul_f32_dpp v202, v242, v78 row_newbcast:14 row_mask:0xf bank_mask:0xf
    v_mul_f32_dpp v203, v242, v79 row_newbcast:15 row_mask:0xf bank_mask:0xf
    v_cvt_pk_bf16_f32 v74, v196, v197
    v_cvt_pk_bf16_f32 v78, v198, v199
    v_cvt_pk_bf16_f32 v75, v200, v201
    v_cvt_pk_bf16_f32 v79, v202, v203
    s_waitcnt vmcnt(4) lgkmcnt(0)
    v_mfma_f32_32x32x16_bf16 v[56:71], v[72:75], v[176:179], 0
    v_mul_f32_dpp v196, v243, v80 row_newbcast:0 row_mask:0xf bank_mask:0xf
    v_mul_f32_dpp v197, v243, v81 row_newbcast:1 row_mask:0xf bank_mask:0xf
    v_mul_f32_dpp v198, v243, v80 row_newbcast:8 row_mask:0xf bank_mask:0xf
    v_mul_f32_dpp v199, v243, v81 row_newbcast:9 row_mask:0xf bank_mask:0xf
    v_mul_f32_dpp v200, v243, v84 row_newbcast:2 row_mask:0xf bank_mask:0xf
    v_mul_f32_dpp v201, v243, v85 row_newbcast:3 row_mask:0xf bank_mask:0xf
    s_add_u32 m0, s21, 0
    v_mfma_f32_32x32x16_bf16 v[16:31], v[76:79], v[176:179], 0
    buffer_load_dwordx4 v234, s[4:7], s36 offen  lds
    buffer_load_dwordx4 v235, s[8:11], s36 offen offset:1024  lds
    ds_read_b64_tr_b16 v[176:177], v244 offset:2048
    ds_read_b64_tr_b16 v[184:185], v245 offset:2048
    v_mul_f32_dpp v202, v243, v84 row_newbcast:10 row_mask:0xf bank_mask:0xf
    v_mul_f32_dpp v203, v243, v85 row_newbcast:11 row_mask:0xf bank_mask:0xf
    v_cvt_pk_bf16_f32 v80, v196, v197
    v_cvt_pk_bf16_f32 v84, v198, v199
    v_cvt_pk_bf16_f32 v81, v200, v201
    v_cvt_pk_bf16_f32 v85, v202, v203
    s_waitcnt lgkmcnt(0)
    v_mfma_f32_32x32x8_bf16 v[56:71], v[80:81], v[176:177], v[56:71]
    s_add_u32 m0, s21, 2048
    v_mfma_f32_32x32x8_bf16 v[16:31], v[84:85], v[176:177], v[16:31]
    buffer_load_dwordx4 v236, s[4:7], s36 offen  lds
    s_mov_b32 m0, s50
    s_nop 0
    s_movrels_b32 s71, s23
    s_movrels_b32 s33, s28
    v_add_u32 v253, s33, v248
    s_bfe_u32 s46, s71, 0x30012
    s_mov_b32 m0, s46
    s_and_b32 s66, s71, 0x3ffff
    s_movrels_b32 s68, s57
    s_movrels_b32 s69, s61
    s_sub_u32 s48, s66, s47
    s_mov_b32 s47, s66
    s_lshr_b32 s52, s71, 28
    s_lshl_b32 s67, s46, 9
    s_add_u32 s66, s66, s67
    s_sub_u32 s49, s66, s42
    s_mov_b32 s42, s66
    s_bfe_u32 s66, s68, 655360
    s_add_u32 s43, s42, s66
    s_bfe_u32 s39, s69, 655360
    s_bfe_u32 s66, s68, 655370
    s_add_u32 s44, s42, s66
    s_bfe_u32 s40, s69, 655370
    s_bfe_u32 s66, s68, 655380
    s_add_u32 s45, s42, s66
    s_bfe_u32 s41, s69, 655380
    v_add_u32 v252, s44, v247
    ds_read2_b32 v[238:239], v252 offset0:0 offset1:16
    v_add_u32 v252, s45, v247
    ds_read2_b32 v[240:241], v252 offset0:0 offset1:16
    v_mfma_f32_32x32x16_bf16 v[32:47], v[72:75], v[180:183], 0
    v_mul_f32 v196, v56, v96
    v_fmac_f32 v196, v57, v97
    v_fmac_f32 v196, v58, v98
    v_fmac_f32 v196, v59, v99
    v_fmac_f32 v196, v60, v100
    v_fmac_f32 v196, v61, v101
    v_mfma_f32_32x32x16_bf16 v[0:15], v[76:79], v[180:183], 0
    s_waitcnt vmcnt(5)
    ds_read_b64_tr_b16 v[176:177], v244 offset:4096
    ds_read_b64_tr_b16 v[178:179], v244 offset:5120
    ds_read_b64_tr_b16 v[180:181], v245 offset:4096
    ds_read_b64_tr_b16 v[182:183], v245 offset:5120
    v_fmac_f32 v196, v62, v102
    v_fmac_f32 v196, v63, v103
    v_mfma_f32_32x32x8_bf16 v[32:47], v[80:81], v[184:185], v[32:47]
    v_mul_f32 v198, v64, v128
    v_fmac_f32 v198, v65, v129
    v_fmac_f32 v198, v66, v130
    v_fmac_f32 v198, v67, v131
    v_fmac_f32 v198, v68, v132
    v_fmac_f32 v198, v69, v133
    v_mfma_f32_32x32x8_bf16 v[0:15], v[84:85], v[184:185], v[0:15]
    v_fmac_f32 v198, v70, v134
    v_fmac_f32 v198, v71, v135
    v_mul_f32 v200, v16, v128
    v_fmac_f32 v200, v17, v129
    v_permlane32_swap_b32 v196, v198
    v_fmac_f32 v200, v18, v130
    v_fmac_f32 v200, v19, v131
    v_fmac_f32 v200, v20, v132
    v_fmac_f32 v200, v21, v133
    v_fmac_f32 v200, v22, v134
    v_fmac_f32 v200, v23, v135
    v_add_f32 v198, v196, v198
    v_mul_f32_e64 v202, v24, -v128
    v_fma_f32 v202, v25, -v129, v202
    v_fma_f32 v202, v26, -v130, v202
    v_fma_f32 v202, v27, -v131, v202
    v_fma_f32 v202, v28, -v132, v202
    v_fma_f32 v202, v29, -v133, v202
    v_fma_f32 v202, v30, -v134, v202
    v_fma_f32 v202, v31, -v135, v202
    s_nop 1
    v_permlane32_swap_b32 v200, v202
    v_add_f32 v202, v200, v202
    s_waitcnt vmcnt(3) lgkmcnt(0)
    v_mfma_f32_32x32x16_bf16 v[56:71], v[72:75], v[176:179], 0
    v_mul_f32 v197, v32, v104
    v_fmac_f32 v197, v33, v105
    v_fmac_f32 v197, v34, v106
    v_fmac_f32 v197, v35, v107
    v_fmac_f32 v197, v36, v108
    v_fmac_f32 v197, v37, v109
    s_add_u32 m0, s21, 4096
    v_mfma_f32_32x32x16_bf16 v[16:31], v[76:79], v[176:179], 0
    buffer_load_dwordx4 v234, s[4:7], s37 offen  lds
    buffer_load_dwordx4 v235, s[8:11], s37 offen offset:1024  lds
    ds_read_b64_tr_b16 v[176:177], v244 offset:6144
    ds_read_b64_tr_b16 v[184:185], v245 offset:6144
    v_add_u32 v252, s42, v247
    ds_read2_b32 v[234:235], v252 offset0:0 offset1:16
    v_fmac_f32 v197, v38, v110
    v_fmac_f32 v197, v39, v111
    v_mul_f32 v199, v40, v136
    v_fmac_f32 v199, v41, v137
    v_fmac_f32 v199, v42, v138
    v_fmac_f32 v199, v43, v139
    v_fmac_f32 v199, v44, v140
    v_fmac_f32 v199, v45, v141
    v_fmac_f32 v199, v46, v142
    v_fmac_f32 v199, v47, v143
    v_mul_f32 v201, v0, v136
    v_fmac_f32 v201, v1, v137
    v_permlane32_swap_b32 v197, v199
    v_fmac_f32 v201, v2, v138
    v_fmac_f32 v201, v3, v139
    v_fmac_f32 v201, v4, v140
    v_fmac_f32 v201, v5, v141
    v_fmac_f32 v201, v6, v142
    v_fmac_f32 v201, v7, v143
    v_add_f32 v199, v197, v199
    v_mul_f32_e64 v203, v8, -v136
    v_fma_f32 v203, v9, -v137, v203
    v_fma_f32 v203, v10, -v138, v203
    s_waitcnt lgkmcnt(1)
    v_mfma_f32_32x32x8_bf16 v[56:71], v[80:81], v[176:177], v[56:71]
    v_fma_f32 v203, v11, -v139, v203
    v_fma_f32 v203, v12, -v140, v203
    v_fma_f32 v203, v13, -v141, v203
    v_fma_f32 v203, v14, -v142, v203
    v_fma_f32 v203, v15, -v143, v203
    s_nop 1
    v_permlane32_swap_b32 v201, v203
    s_add_u32 m0, s21, 6144
    v_mfma_f32_32x32x8_bf16 v[16:31], v[84:85], v[176:177], v[16:31]
    buffer_load_dwordx4 v236, s[4:7], s37 offen  lds
    v_add_u32 v252, s43, v247
    ds_read2_b32 v[236:237], v252 offset0:0 offset1:16
    v_add_f32 v203, v201, v203
    v_cvt_pk_bf16_f32 v192, v198, v199
    v_cvt_pk_bf16_f32 v193, v202, v203
    v_mfma_f32_32x32x16_bf16 v[32:47], v[72:75], v[180:183], 0
    v_mul_f32 v196, v56, v144
    v_fmac_f32 v196, v57, v145
    v_fmac_f32 v196, v58, v146
    v_fmac_f32 v196, v59, v147
    v_fmac_f32 v196, v60, v148
    v_fmac_f32 v196, v61, v149
    v_mfma_f32_32x32x16_bf16 v[0:15], v[76:79], v[180:183], 0
    s_waitcnt vmcnt(4)
    ds_read_b64_tr_b16 v[176:177], v244 offset:0
    ds_read_b64_tr_b16 v[178:179], v244 offset:1024
    ds_read_b64_tr_b16 v[180:181], v245 offset:0
    ds_read_b64_tr_b16 v[182:183], v245 offset:1024
    v_fmac_f32 v196, v62, v150
    v_fmac_f32 v196, v63, v151
    v_mfma_f32_32x32x8_bf16 v[32:47], v[80:81], v[184:185], v[32:47]
    v_mul_f32_e64 v200, v16, -v160
    v_fma_f32 v200, v17, -v161, v200
    v_fma_f32 v200, v18, -v162, v200
    v_fma_f32 v200, v19, -v163, v200
    v_fma_f32 v200, v20, -v164, v200
    v_fma_f32 v200, v21, -v165, v200
    v_mfma_f32_32x32x8_bf16 v[0:15], v[84:85], v[184:185], v[0:15]
    v_fma_f32 v200, v22, -v166, v200
    v_fma_f32 v200, v23, -v167, v200
    v_mul_f32_e64 v202, v24, -v160
    v_fma_f32 v202, v25, -v161, v202
    v_fma_f32 v202, v26, -v162, v202
    v_fma_f32 v202, v27, -v163, v202
    v_fma_f32 v202, v28, -v164, v202
    v_fma_f32 v202, v29, -v165, v202
    v_fma_f32 v202, v30, -v166, v202
    v_fma_f32 v202, v31, -v167, v202
    s_waitcnt vmcnt(3) lgkmcnt(0)
    v_mfma_f32_32x32x16_bf16 v[16:31], v[72:75], v[176:179], 0
    v_mul_f32 v197, v32, v152
    v_fmac_f32 v197, v33, v153
    v_fmac_f32 v197, v34, v154
    v_fmac_f32 v197, v35, v155
    v_fmac_f32 v197, v36, v156
    v_fmac_f32 v197, v37, v157
    s_add_u32 m0, s21, 0
    v_mfma_f32_32x32x16_bf16 v[48:63], v[76:79], v[176:179], 0
    s_cbranch_vccnz WL_3_0
    v_mad_u32_u16 v234, v234, s3, v246 op_sel:[1,0,0,0]
    v_mad_u32_u16 v235, v235, s3, v246 op_sel:[1,0,0,0]
    buffer_load_dwordx4 v234, s[4:7], s38 offen  lds
    buffer_load_dwordx4 v235, s[8:11], s38 offen offset:1024  lds
WR_3_0:
    ds_read_b64_tr_b16 v[176:177], v244 offset:2048
    ds_read_b64_tr_b16 v[184:185], v245 offset:2048
    v_fmac_f32 v197, v38, v158
    v_fmac_f32 v197, v39, v159
    v_mul_f32_e64 v201, v0, -v168
    v_fma_f32 v201, v1, -v169, v201
    v_fma_f32 v201, v2, -v170, v201
    v_fma_f32 v201, v3, -v171, v201
    v_fma_f32 v201, v4, -v172, v201
    v_fma_f32 v201, v5, -v173, v201
    v_fma_f32 v201, v6, -v174, v201
    v_fma_f32 v201, v7, -v175, v201
    s_waitcnt lgkmcnt(0)
    v_mfma_f32_32x32x8_bf16 v[16:31], v[80:81], v[176:177], v[16:31]
    v_mul_f32_e64 v203, v8, -v168
    v_fma_f32 v203, v9, -v169, v203
    v_fma_f32 v203, v10, -v170, v203
    v_fma_f32 v203, v11, -v171, v203
    v_fma_f32 v203, v12, -v172, v203
    v_fma_f32 v203, v13, -v173, v203
    s_add_u32 m0, s21, 2048
    v_mfma_f32_32x32x8_bf16 v[48:63], v[84:85], v[176:177], v[48:63]
    s_cbranch_vccnz WL_3_1
    v_mad_u32_u16 v236, v236, s3, v246 op_sel:[1,0,0,0]
    v_mad_u32_u16 v237, v237, s3, v246 op_sel:[1,0,0,0]
    buffer_load_dwordx4 v236, s[4:7], s39 offen  lds
    buffer_load_dwordx4 v237, s[8:11], s39 offen offset:1024  lds
WR_3_1:
    v_fma_f32 v203, v14, -v174, v203
    v_fma_f32 v203, v15, -v175, v203
    v_mfma_f32_32x32x16_bf16 v[0:15], v[72:75], v[180:183], 0
    v_fmac_f32 v200, v24, v160
    v_fmac_f32 v200, v25, v161
    v_fmac_f32 v200, v26, v162
    v_fmac_f32 v200, v27, v163
    v_fmac_f32 v200, v28, v164
    v_fmac_f32 v200, v29, v165
    v_fmac_f32 v200, v30, v166
    v_fmac_f32 v200, v31, v167
    v_mfma_f32_32x32x16_bf16 v[24:39], v[76:79], v[180:183], 0
    s_waitcnt vmcnt(5)
    ds_read_b64_tr_b16 v[176:177], v244 offset:4096
    ds_read_b64_tr_b16 v[178:179], v244 offset:5120
    ds_read_b64_tr_b16 v[180:181], v245 offset:4096
    ds_read_b64_tr_b16 v[182:183], v245 offset:5120
    v_mul_f32 v254, v16, v144
    v_fmac_f32 v254, v17, v145
    v_mfma_f32_32x32x8_bf16 v[24:39], v[84:85], v[184:185], v[24:39]
    v_fmac_f32 v254, v18, v146
    v_fmac_f32 v254, v19, v147
    v_fmac_f32 v254, v20, v148
    v_fmac_f32 v254, v21, v149
    v_fmac_f32 v254, v22, v150
    v_fmac_f32 v254, v23, v151
    v_mfma_f32_32x32x8_bf16 v[0:15], v[80:81], v[184:185], v[0:15]
    v_sub_f32_e64 v64, -v48, v64
    v_sub_f32_e64 v65, -v49, v65
    v_permlane32_swap_b32 v196, v254
    v_sub_f32_e64 v66, -v50, v66
    v_sub_f32_e64 v67, -v51, v67
    v_sub_f32_e64 v68, -v52, v68
    v_sub_f32_e64 v69, -v53, v69
    v_sub_f32_e64 v70, -v54, v70
    v_sub_f32_e64 v71, -v55, v71
    v_add_f32 v254, v196, v254
    s_waitcnt vmcnt(4) lgkmcnt(0)
    v_mfma_f32_32x32x16_bf16 v[56:71], v[76:79], v[176:179], v[56:71]
    v_sub_f32_e64 v40, -v24, v40
    v_sub_f32_e64 v41, -v25, v41
    v_sub_f32_e64 v42, -v26, v42
    v_sub_f32_e64 v43, -v27, v43
    v_sub_f32_e64 v44, -v28, v44
    v_sub_f32_e64 v45, -v29, v45
    v_sub_f32_e64 v46, -v30, v46
    v_sub_f32_e64 v47, -v31, v47
    s_add_u32 m0, s21, 4096
    v_mfma_f32_32x32x16_bf16 v[16:31], v[72:75], v[176:179], 0
    s_cbranch_vccnz WL_3_2
    v_mad_u32_u16 v238, v238, s3, v246 op_sel:[1,0,0,0]
    v_mad_u32_u16 v239, v239, s3, v246 op_sel:[1,0,0,0]
    buffer_load_dwordx4 v238, s[4:7], s40 offen  lds
    buffer_load_dwordx4 v239, s[8:11], s40 offen offset:1024  lds
WR_3_2:
    ds_read_b64_tr_b16 v[176:177], v244 offset:6144
    ds_read_b64_tr_b16 v[184:185], v245 offset:6144
    v_mul_f32 v255, v0, v152
    v_fmac_f32 v255, v1, v153
    v_fmac_f32 v255, v2, v154
    v_fmac_f32 v255, v3, v155
    v_fmac_f32 v255, v4, v156
    v_fmac_f32 v255, v5, v157
    v_fmac_f32 v255, v6, v158
    v_fmac_f32 v255, v7, v159
    v_fmac_f32 v201, v8, v168
    v_fmac_f32 v201, v9, v169
    v_permlane32_swap_b32 v197, v255
    s_waitcnt lgkmcnt(0)
    v_mfma_f32_32x32x8_bf16 v[16:31], v[80:81], v[176:177], v[16:31]
    v_fmac_f32 v201, v10, v170
    v_fmac_f32 v201, v11, v171
    v_fmac_f32 v201, v12, v172
    v_fmac_f32 v201, v13, v173
    v_fmac_f32 v201, v14, v174
    v_fmac_f32 v201, v15, v175
    s_add_u32 m0, s21, 6144
    v_mfma_f32_32x32x8_bf16 v[56:71], v[84:85], v[176:177], v[56:71]
    s_cbranch_vccnz WL_3_3
    v_mad_u32_u16 v240, v240, s3, v246 op_sel:[1,0,0,0]
    v_mad_u32_u16 v241, v241, s3, v246 op_sel:[1,0,0,0]
    buffer_load_dwordx4 v240, s[4:7], s41 offen  lds
    buffer_load_dwordx4 v241, s[8:11], s41 offen offset:1024  lds
WR_3_3:
    v_add_f32 v255, v197, v255
    v_cvt_pk_bf16_f32 v194, v254, v255
    v_mfma_f32_32x32x16_bf16 v[0:15], v[72:75], v[180:183], 0
    v_mul_f32 v254, v16, v144
    v_fmac_f32 v254, v17, v145
    v_fmac_f32 v254, v18, v146
    v_fmac_f32 v254, v19, v147
    v_fmac_f32 v254, v20, v148
    v_fmac_f32 v254, v21, v149
    v_mfma_f32_32x32x16_bf16 v[32:47], v[76:79], v[180:183], v[32:47]
    s_waitcnt vmcnt(6)
    ds_read_b64_tr_b16 v[176:177], v244 offset:0
    ds_read_b64_tr_b16 v[178:179], v244 offset:1024
    ds_read_b64_tr_b16 v[180:181], v245 offset:0
    ds_read_b64_tr_b16 v[182:183], v245 offset:1024
    v_fmac_f32 v254, v22, v150
    v_fmac_f32 v254, v23, v151
    v_mfma_f32_32x32x8_bf16 v[0:15], v[80:81], v[184:185], v[0:15]
    v_fma_f32 v202, v24, -v160, v202
    v_fma_f32 v202, v25, -v161, v202
    v_permlane32_swap_b32 v254, v200
    v_fma_f32 v202, v26, -v162, v202
    v_fma_f32 v202, v27, -v163, v202
    v_fma_f32 v202, v28, -v164, v202
    v_mfma_f32_32x32x8_bf16 v[32:47], v[84:85], v[184:185], v[32:47]
    v_add_u32 v249, s48, v249
    v_add_u32 v250, s49, v250
    ds_read_b32 v252, v251 offset:16
    ds_read_b64_tr_b16 v[72:73], v249 offset:0
    ds_read_b64_tr_b16 v[76:77], v249 offset:64
    ds_read_b64_tr_b16 v[74:75], v249 offset:256
    ds_read_b64_tr_b16 v[78:79], v249 offset:320
    s_mov_b64 exec, s[54:55]
    ds_read_u16_d16_hi v242, v250 offset:0
    s_mov_b64 exec, -1
    v_fma_f32 v202, v29, -v165, v202
    v_fma_f32 v202, v30, -v166, v202
    v_fma_f32 v202, v31, -v167, v202
    v_add_f32 v200, v254, v200
    v_mul_f32_e64 v198, v64, -v112
    v_permlane32_swap_b32 v202, v254
    v_fma_f32 v198, v65, -v113, v198
    v_fma_f32 v198, v66, -v114, v198
    v_fma_f32 v198, v67, -v115, v198
    v_fma_f32 v198, v68, -v116, v198
    v_fma_f32 v198, v69, -v117, v198
    v_fma_f32 v198, v70, -v118, v198
    v_fma_f32 v198, v71, -v119, v198
    v_add_f32 v254, v202, v254
    v_mul_f32 v196, v56, v160
    v_fmac_f32 v196, v57, v161
    v_fmac_f32 v196, v58, v162
    v_fmac_f32 v196, v59, v163
    v_fmac_f32 v196, v60, v164
    v_fmac_f32 v196, v61, v165
    v_fmac_f32 v196, v62, v166
    v_fmac_f32 v196, v63, v167
    s_nop 1
    v_permlane32_swap_b32 v198, v196
    v_add_f32 v196, v198, v196
    s_cbranch_vccnz LEPI_0
    v_mul_f32 v255, v0, v152
    v_fmac_f32 v255, v1, v153
    v_fmac_f32 v255, v2, v154
    v_fmac_f32 v255, v3, v155
    v_fmac_f32 v255, v4, v156
    v_fmac_f32 v255, v5, v157
    v_fmac_f32 v255, v6, v158
    v_fmac_f32 v255, v7, v159
    v_fma_f32 v203, v8, -v168, v203
    v_fma_f32 v203, v9, -v169, v203
    v_permlane32_swap_b32 v255, v201
    v_fma_f32 v203, v10, -v170, v203
    v_fma_f32 v203, v11, -v171, v203
    v_fma_f32 v203, v12, -v172, v203
    v_fma_f32 v203, v13, -v173, v203
    v_fma_f32 v203, v14, -v174, v203
    v_fma_f32 v203, v15, -v175, v203
    v_add_f32 v201, v255, v201
    v_mul_f32_e64 v199, v40, -v120
    v_permlane32_swap_b32 v203, v255
    v_fma_f32 v199, v41, -v121, v199
    v_fma_f32 v199, v42, -v122, v199
    v_fma_f32 v199, v43, -v123, v199
    v_fma_f32 v199, v44, -v124, v199
    v_fma_f32 v199, v45, -v125, v199
    v_fma_f32 v199, v46, -v126, v199
    v_fma_f32 v199, v47, -v127, v199
    v_add_f32 v255, v203, v255
    v_mul_f32 v197, v32, v168
    v_fmac_f32 v197, v33, v169
    v_fmac_f32 v197, v34, v170
    v_fmac_f32 v197, v35, v171
    v_fmac_f32 v197, v36, v172
    v_fmac_f32 v197, v37, v173
    v_fmac_f32 v197, v38, v174
    v_fmac_f32 v197, v39, v175
    s_nop 1
    v_permlane32_swap_b32 v199, v197
    v_add_f32 v197, v199, v197
    v_cvt_pk_bf16_f32 v200, v200, v201
    v_cvt_pk_bf16_f32 v254, v254, v255
    v_cvt_pk_bf16_f32 v196, v196, v197
    ds_write2st64_b32 v253, v192, v193 offset0:0 offset1:1
    ds_write2st64_b32 v253, v194, v200 offset0:2 offset1:3
    ds_write_b32 v253, v196 offset:1024
    s_mov_b64 exec, 0xffffffff
    ds_write_b32 v253, v254 offset:1280
    s_mov_b64 exec, -1
    s_add_u32 s50, s50, 1
    s_cmp_ge_u32 s50, 4
    s_cbranch_scc1 LAST1
    s_waitcnt lgkmcnt(9)
    v_readfirstlane_b32 s66, v252
    s_add_u32 s53, s53, 1
    v_mov_b32 v252, s53
    s_cmp_le_u32 s53, s66
    ds_write2_b32 v251, v252, v252 offset0:0 offset1:8
    s_setprio 1
    s_cbranch_scc1 PRIO_13
    s_setprio 0
PRIO_13:
    s_cmp_eq_u32 s52, 4
    s_cbranch_scc1 ITEM_1_4
    s_cmp_eq_u32 s52, 5
    s_cbranch_scc1 ITEM_1_5
    s_cmp_eq_u32 s52, 3
    s_cbranch_scc1 ITEM_1_3
    s_cmp_eq_u32 s52, 6
    s_cbranch_scc1 ITEM_1_6
    s_cmp_eq_u32 s52, 8
    s_cbranch_scc1 ITEM_1_8
    s_branch ITEM_1_2
WL_3_0:
    s_add_u32 s66, s51, 0
    buffer_load_dwordx4 v[96:99], v246, s[16:19], s66 offen offset:2048 sc1
    buffer_load_dwordx4 v[100:103], v246, s[16:19], s66 offen offset:3072 sc1
    s_branch WR_3_0
WL_3_1:
    s_add_u32 s66, s51, 4096
    buffer_load_dwordx4 v[104:107], v246, s[16:19], s66 offen offset:2048 sc1
    buffer_load_dwordx4 v[108:111], v246, s[16:19], s66 offen offset:3072 sc1
    s_branch WR_3_1
WL_3_2:
    s_add_u32 s66, s51, 8192
    buffer_load_dwordx4 v[128:131], v246, s[16:19], s66 offen offset:2048 sc1
    buffer_load_dwordx4 v[132:135], v246, s[16:19], s66 offen offset:3072 sc1
    s_branch WR_3_2
WL_3_3:
    s_add_u32 s66, s51, 12288
    buffer_load_dwordx4 v[136:139], v246, s[16:19], s66 offen offset:2048 sc1
    buffer_load_dwordx4 v[140:143], v246, s[16:19], s66 offen offset:3072 sc1
    s_branch WR_3_3
.p2align 6
ITEM_1_6:
    s_mov_b64 exec, s[54:55]
    ds_read_u16_d16_hi v243, v250 offset:128
    s_mov_b64 exec, -1
    ds_read_b64_tr_b16 v[80:81], v249 offset:512
    ds_read_b64_tr_b16 v[84:85], v249 offset:576
    ds_read_b64_tr_b16 v[82:83], v249 offset:768
    ds_read_b64_tr_b16 v[86:87], v249 offset:832
    ds_read_b64_tr_b16 v[88:89], v249 offset:1024
    ds_read_b64_tr_b16 v[92:93], v249 offset:1088
    ds_read_b64_tr_b16 v[90:91], v249 offset:1280
    ds_read_b64_tr_b16 v[94:95], v249 offset:1344
    s_waitcnt lgkmcnt(9)
    v_mul_f32_dpp v196, v242, v72 row_newbcast:0 row_mask:0xf bank_mask:0xf
    v_mul_f32_dpp v197, v242, v73 row_newbcast:1 row_mask:0xf bank_mask:0xf
    v_mul_f32_dpp v198, v242, v72 row_newbcast:8 row_mask:0xf bank_mask:0xf
    v_mul_f32_dpp v199, v242, v73 row_newbcast:9 row_mask:0xf bank_mask:0xf
    v_mul_f32_dpp v200, v242, v76 row_newbcast:2 row_mask:0xf bank_mask:0xf
    v_mul_f32_dpp v201, v242, v77 row_newbcast:3 row_mask:0xf bank_mask:0xf
    v_mul_f32_dpp v202, v242, v76 row_newbcast:10 row_mask:0xf bank_mask:0xf
    v_mul_f32_dpp v203, v242, v77 row_newbcast:11 row_mask:0xf bank_mask:0xf
    v_cvt_pk_bf16_f32 v72, v196, v197
    v_cvt_pk_bf16_f32 v76, v198, v199
    v_cvt_pk_bf16_f32 v73, v200, v201
    v_cvt_pk_bf16_f32 v77, v202, v203
    v_mul_f32_dpp v196, v242, v74 row_newbcast:4 row_mask:0xf bank_mask:0xf
    v_mul_f32_dpp v197, v242, v75 row_newbcast:5 row_mask:0xf bank_mask:0xf
    v_mul_f32_dpp v198, v242, v74 row_newbcast:12 row_mask:0xf bank_mask:0xf
    v_mul_f32_dpp v199, v242, v75 row_newbcast:13 row_mask:0xf bank_mask:0xf
    v_mul_f32_dpp v200, v242, v78 row_newbcast:6 row_mask:0xf bank_mask:0xf
    v_mul_f32_dpp v201, v242, v79 row_newbcast:7 row_mask:0xf bank_mask:0xf
    v_mul_f32_dpp v202, v242, v78 row_newbcast:14 row_mask:0xf bank_mask:0xf
    v_mul_f32_dpp v203, v242, v79 row_newbcast:15 row_mask:0xf bank_mask:0xf
    v_cvt_pk_bf16_f32 v74, v196, v197
    v_cvt_pk_bf16_f32 v78, v198, v199
    v_cvt_pk_bf16_f32 v75, v200, v201
    v_cvt_pk_bf16_f32 v79, v202, v203
    s_mov_b64 exec, s[54:55]
    ds_read_u16_d16_hi v242, v250 offset:256
    s_mov_b64 exec, -1
    s_waitcnt vmcnt(4) lgkmcnt(5)
    v_mfma_f32_32x32x16_bf16 v[56:71], v[72:75], v[176:179], 0
    v_mul_f32_dpp v196, v243, v80 row_newbcast:0 row_mask:0xf bank_mask:0xf
    v_mul_f32_dpp v197, v243, v81 row_newbcast:1 row_mask:0xf bank_mask:0xf
    v_mul_f32_dpp v198, v243, v80 row_newbcast:8 row_mask:0xf bank_mask:0xf
    v_mul_f32_dpp v199, v243, v81 row_newbcast:9 row_mask:0xf bank_mask:0xf
    v_mul_f32_dpp v200, v243, v84 row_newbcast:2 row_mask:0xf bank_mask:0xf
    v_mul_f32_dpp v201, v243, v85 row_newbcast:3 row_mask:0xf bank_mask:0xf
    s_add_u32 m0, s21, 0
    v_mfma_f32_32x32x16_bf16 v[16:31], v[76:79], v[176:179], 0
    buffer_load_dwordx4 v236, s[4:7], s35 offen  lds
    buffer_load_dwordx4 v237, s[8:11], s35 offen offset:1024  lds
    ds_read_b64_tr_b16 v[176:177], v244 offset:2048
    ds_read_b64_tr_b16 v[178:179], v244 offset:3072
    ds_read_b64_tr_b16 v[184:185], v245 offset:2048
    ds_read_b64_tr_b16 v[186:187], v245 offset:3072
    v_mul_f32_dpp v202, v243, v84 row_newbcast:10 row_mask:0xf bank_mask:0xf
    v_mul_f32_dpp v203, v243, v85 row_newbcast:11 row_mask:0xf bank_mask:0xf
    v_cvt_pk_bf16_f32 v80, v196, v197
    v_cvt_pk_bf16_f32 v84, v198, v199
    v_cvt_pk_bf16_f32 v81, v200, v201
    v_cvt_pk_bf16_f32 v85, v202, v203
    v_mul_f32_dpp v196, v243, v82 row_newbcast:4 row_mask:0xf bank_mask:0xf
    v_mul_f32_dpp v197, v243, v83 row_newbcast:5 row_mask:0xf bank_mask:0xf
    v_mul_f32_dpp v198, v243, v82 row_newbcast:12 row_mask:0xf bank_mask:0xf
    v_mul_f32_dpp v199, v243, v83 row_newbcast:13 row_mask:0xf bank_mask:0xf
    v_mul_f32_dpp v200, v243, v86 row_newbcast:6 row_mask:0xf bank_mask:0xf
    v_mul_f32_dpp v201, v243, v87 row_newbcast:7 row_mask:0xf bank_mask:0xf
    v_mul_f32_dpp v202, v243, v86 row_newbcast:14 row_mask:0xf bank_mask:0xf
    v_mul_f32_dpp v203, v243, v87 row_newbcast:15 row_mask:0xf bank_mask:0xf
    v_cvt_pk_bf16_f32 v82, v196, v197
    v_cvt_pk_bf16_f32 v86, v198, v199
    v_cvt_pk_bf16_f32 v83, v200, v201
    v_cvt_pk_bf16_f32 v87, v202, v203
    s_waitcnt vmcnt(4) lgkmcnt(0)
    v_mfma_f32_32x32x16_bf16 v[56:71], v[80:83], v[176:179], v[56:71]
    v_mul_f32_dpp v196, v242, v88 row_newbcast:0 row_mask:0xf bank_mask:0xf
    v_mul_f32_dpp v197, v242, v89 row_newbcast:1 row_mask:0xf bank_mask:0xf
    v_mul_f32_dpp v198, v242, v88 row_newbcast:8 row_mask:0xf bank_mask:0xf
    v_mul_f32_dpp v199, v242, v89 row_newbcast:9 row_mask:0xf bank_mask:0xf
    v_mul_f32_dpp v200, v242, v92 row_newbcast:2 row_mask:0xf bank_mask:0xf
    v_mul_f32_dpp v201, v242, v93 row_newbcast:3 row_mask:0xf bank_mask:0xf
    s_add_u32 m0, s21, 2048
    v_mfma_f32_32x32x16_bf16 v[16:31], v[84:87], v[176:179], v[16:31]
    buffer_load_dwordx4 v238, s[4:7], s35 offen  lds
    buffer_load_dwordx4 v239, s[8:11], s35 offen offset:1024  lds
    ds_read_b64_tr_b16 v[176:177], v244 offset:4096
    ds_read_b64_tr_b16 v[178:179], v244 offset:5120
    ds_read_b64_tr_b16 v[188:189], v245 offset:4096
    ds_read_b64_tr_b16 v[190:191], v245 offset:5120
    v_mul_f32_dpp v202, v242, v92 row_newbcast:10 row_mask:0xf bank_mask:0xf
    v_mul_f32_dpp v203, v242, v93 row_newbcast:11 row_mask:0xf bank_mask:0xf
    v_cvt_pk_bf16_f32 v88, v196, v197
    v_cvt_pk_bf16_f32 v92, v198, v199
    v_cvt_pk_bf16_f32 v89, v200, v201
    v_cvt_pk_bf16_f32 v93, v202, v203
    v_mul_f32_dpp v196, v242, v90 row_newbcast:4 row_mask:0xf bank_mask:0xf
    v_mul_f32_dpp v197, v242, v91 row_newbcast:5 row_mask:0xf bank_mask:0xf
    v_mul_f32_dpp v198, v242, v90 row_newbcast:12 row_mask:0xf bank_mask:0xf
    v_mul_f32_dpp v199, v242, v91 row_newbcast:13 row_mask:0xf bank_mask:0xf
    v_mul_f32_dpp v200, v242, v94 row_newbcast:6 row_mask:0xf bank_mask:0xf
    v_mul_f32_dpp v201, v242, v95 row_newbcast:7 row_mask:0xf bank_mask:0xf
    v_mul_f32_dpp v202, v242, v94 row_newbcast:14 row_mask:0xf bank_mask:0xf
    v_mul_f32_dpp v203, v242, v95 row_newbcast:15 row_mask:0xf bank_mask:0xf
    v_cvt_pk_bf16_f32 v90, v196, v197
    v_cvt_pk_bf16_f32 v94, v198, v199
    v_cvt_pk_bf16_f32 v91, v200, v201
    v_cvt_pk_bf16_f32 v95, v202, v203
    s_waitcnt lgkmcnt(0)
    v_mfma_f32_32x32x16_bf16 v[56:71], v[88:91], v[176:179], v[56:71]
    s_add_u32 m0, s21, 4096
    v_mfma_f32_32x32x16_bf16 v[16:31], v[92:95], v[176:179], v[16:31]
    buffer_load_dwordx4 v234, s[4:7], s36 offen  lds
    buffer_load_dwordx4 v235, s[8:11], s36 offen offset:1024  lds
    s_mov_b32 m0, s50
    s_nop 0
    s_movrels_b32 s71, s23
    s_movrels_b32 s33, s28
    v_add_u32 v253, s33, v248
    s_bfe_u32 s46, s71, 0x30012
    s_mov_b32 m0, s46
    s_and_b32 s66, s71, 0x3ffff
    s_movrels_b32 s68, s57
    s_movrels_b32 s69, s61
    s_sub_u32 s48, s66, s47
    s_mov_b32 s47, s66
    s_lshr_b32 s52, s71, 28
    s_lshl_b32 s67, s46, 9
    s_add_u32 s66, s66, s67
    s_sub_u32 s49, s66, s42
    s_mov_b32 s42, s66
    s_bfe_u32 s66, s68, 655360
    s_add_u32 s43, s42, s66
    s_bfe_u32 s39, s69, 655360
    s_bfe_u32 s66, s68, 655370
    s_add_u32 s44, s42, s66
    s_bfe_u32 s40, s69, 655370
    s_bfe_u32 s66, s68, 655380
    s_add_u32 s45, s42, s66
    s_bfe_u32 s41, s69, 655380
    v_add_u32 v252, s45, v247
    ds_read2_b32 v[240:241], v252 offset0:0 offset1:16
    v_mfma_f32_32x32x16_bf16 v[32:47], v[72:75], v[180:183], 0
    v_mul_f32 v196, v56, v96
    v_fmac_f32 v196, v57, v97
    v_fmac_f32 v196, v58, v98
    v_fmac_f32 v196, v59, v99
    v_fmac_f32 v196, v60, v100
    v_fmac_f32 v196, v61, v101
    v_mfma_f32_32x32x16_bf16 v[0:15], v[76:79], v[180:183], 0
    v_fmac_f32 v196, v62, v102
    v_fmac_f32 v196, v63, v103
    v_mul_f32 v198, v64, v128
    v_fmac_f32 v198, v65, v129
    v_fmac_f32 v198, v66, v130
    v_fmac_f32 v198, v67, v131
    v_mfma_f32_32x32x16_bf16 v[32:47], v[80:83], v[184:187], v[32:47]
    v_fmac_f32 v198, v68, v132
    v_fmac_f32 v198, v69, v133
    v_fmac_f32 v198, v70, v134
    v_fmac_f32 v198, v71, v135
    v_mul_f32 v200, v16, v128
    v_fmac_f32 v200, v17, v129
    v_mfma_f32_32x32x16_bf16 v[0:15], v[84:87], v[184:187], v[0:15]
    s_waitcnt vmcnt(6)
    ds_read_b64_tr_b16 v[176:177], v244 offset:6144
    ds_read_b64_tr_b16 v[178:179], v244 offset:7168
    ds_read_b64_tr_b16 v[180:181], v245 offset:6144
    ds_read_b64_tr_b16 v[182:183], v245 offset:7168
    v_permlane32_swap_b32 v196, v198
    v_fmac_f32 v200, v18, v130
    v_mfma_f32_32x32x16_bf16 v[32:47], v[88:91], v[188:191], v[32:47]
    v_fmac_f32 v200, v19, v131
    v_fmac_f32 v200, v20, v132
    v_fmac_f32 v200, v21, v133
    v_fmac_f32 v200, v22, v134
    v_fmac_f32 v200, v23, v135
    v_add_f32 v198, v196, v198
    v_mfma_f32_32x32x16_bf16 v[0:15], v[92:95], v[188:191], v[0:15]
    v_mul_f32_e64 v202, v24, -v128
    v_fma_f32 v202, v25, -v129, v202
    v_fma_f32 v202, v26, -v130, v202
    v_fma_f32 v202, v27, -v131, v202
    v_fma_f32 v202, v28, -v132, v202
    v_fma_f32 v202, v29, -v133, v202
    v_fma_f32 v202, v30, -v134, v202
    v_fma_f32 v202, v31, -v135, v202
    s_nop 1
    v_permlane32_swap_b32 v200, v202
    v_add_f32 v202, v200, v202
    s_waitcnt vmcnt(4) lgkmcnt(0)
    v_mfma_f32_32x32x16_bf16 v[56:71], v[72:75], v[176:179], 0
    v_mul_f32 v197, v32, v104
    v_fmac_f32 v197, v33, v105
    v_fmac_f32 v197, v34, v106
    v_fmac_f32 v197, v35, v107
    v_fmac_f32 v197, v36, v108
    v_fmac_f32 v197, v37, v109
    s_add_u32 m0, s21, 6144
    v_mfma_f32_32x32x16_bf16 v[16:31], v[76:79], v[176:179], 0
    buffer_load_dwordx4 v236, s[4:7], s36 offen  lds
    buffer_load_dwordx4 v237, s[8:11], s36 offen offset:1024  lds
    ds_read_b64_tr_b16 v[176:177], v244 offset:0
    ds_read_b64_tr_b16 v[178:179], v244 offset:1024
    ds_read_b64_tr_b16 v[184:185], v245 offset:0
    ds_read_b64_tr_b16 v[186:187], v245 offset:1024
    v_fmac_f32 v197, v38, v110
    v_fmac_f32 v197, v39, v111
    v_mul_f32 v199, v40, v136
    v_fmac_f32 v199, v41, v137
    v_fmac_f32 v199, v42, v138
    v_fmac_f32 v199, v43, v139
    v_fmac_f32 v199, v44, v140
    v_fmac_f32 v199, v45, v141
    v_fmac_f32 v199, v46, v142
    v_fmac_f32 v199, v47, v143
    v_mul_f32 v201, v0, v136
    v_fmac_f32 v201, v1, v137
    v_permlane32_swap_b32 v197, v199
    v_fmac_f32 v201, v2, v138
    v_fmac_f32 v201, v3, v139
    v_fmac_f32 v201, v4, v140
    v_fmac_f32 v201, v5, v141
    v_fmac_f32 v201, v6, v142
    s_waitcnt vmcnt(4) lgkmcnt(0)
    v_mfma_f32_32x32x16_bf16 v[56:71], v[80:83], v[176:179], v[56:71]
    v_fmac_f32 v201, v7, v143
    v_add_f32 v199, v197, v199
    v_mul_f32_e64 v203, v8, -v136
    v_fma_f32 v203, v9, -v137, v203
    v_fma_f32 v203, v10, -v138, v203
    v_fma_f32 v203, v11, -v139, v203
    s_add_u32 m0, s21, 0
    v_mfma_f32_32x32x16_bf16 v[16:31], v[84:87], v[176:179], v[16:31]
    buffer_load_dwordx4 v238, s[4:7], s36 offen  lds
    buffer_load_dwordx4 v239, s[8:11], s36 offen offset:1024  lds
    ds_read_b64_tr_b16 v[176:177], v244 offset:2048
    ds_read_b64_tr_b16 v[178:179], v244 offset:3072
    ds_read_b64_tr_b16 v[188:189], v245 offset:2048
    ds_read_b64_tr_b16 v[190:191], v245 offset:3072
    s_waitcnt lgkmcnt(0)
    v_mfma_f32_32x32x16_bf16 v[56:71], v[88:91], v[176:179], v[56:71]
    v_fma_f32 v203, v12, -v140, v203
    v_fma_f32 v203, v13, -v141, v203
    v_fma_f32 v203, v14, -v142, v203
    v_fma_f32 v203, v15, -v143, v203
    s_nop 1
    v_permlane32_swap_b32 v201, v203
    v_add_f32 v203, v201, v203
    s_add_u32 m0, s21, 2048
    v_mfma_f32_32x32x16_bf16 v[16:31], v[92:95], v[176:179], v[16:31]
    buffer_load_dwordx4 v234, s[4:7], s37 offen  lds
    buffer_load_dwordx4 v235, s[8:11], s37 offen offset:1024  lds
    v_add_u32 v252, s42, v247
    ds_read2_b32 v[234:235], v252 offset0:0 offset1:16
    v_cvt_pk_bf16_f32 v192, v198, v199
    v_cvt_pk_bf16_f32 v193, v202, v203
    v_mfma_f32_32x32x16_bf16 v[32:47], v[72:75], v[180:183], 0
    v_mul_f32 v196, v56, v144
    v_fmac_f32 v196, v57, v145
    v_fmac_f32 v196, v58, v146
    v_fmac_f32 v196, v59, v147
    v_fmac_f32 v196, v60, v148
    v_fmac_f32 v196, v61, v149
    v_mfma_f32_32x32x16_bf16 v[0:15], v[76:79], v[180:183], 0
    v_fmac_f32 v196, v62, v150
    v_fmac_f32 v196, v63, v151
    v_mul_f32_e64 v200, v16, -v160
    v_fma_f32 v200, v17, -v161, v200
    v_fma_f32 v200, v18, -v162, v200
    v_fma_f32 v200, v19, -v163, v200
    v_mfma_f32_32x32x16_bf16 v[32:47], v[80:83], v[184:187], v[32:47]
    v_fma_f32 v200, v20, -v164, v200
    v_fma_f32 v200, v21, -v165, v200
    v_fma_f32 v200, v22, -v166, v200
    v_fma_f32 v200, v23, -v167, v200
    v_mul_f32_e64 v202, v24, -v160
    v_fma_f32 v202, v25, -v161, v202
    v_mfma_f32_32x32x16_bf16 v[0:15], v[84:87], v[184:187], v[0:15]
    s_waitcnt vmcnt(6)
    ds_read_b64_tr_b16 v[176:177], v244 offset:4096
    ds_read_b64_tr_b16 v[178:179], v244 offset:5120
    ds_read_b64_tr_b16 v[180:181], v245 offset:4096
    ds_read_b64_tr_b16 v[182:183], v245 offset:5120
    v_fma_f32 v202, v26, -v162, v202
    v_fma_f32 v202, v27, -v163, v202
    v_mfma_f32_32x32x16_bf16 v[32:47], v[88:91], v[188:191], v[32:47]
    v_fma_f32 v202, v28, -v164, v202
    v_fma_f32 v202, v29, -v165, v202
    v_fma_f32 v202, v30, -v166, v202
    v_fma_f32 v202, v31, -v167, v202
    v_mfma_f32_32x32x16_bf16 v[0:15], v[92:95], v[188:191], v[0:15]
    s_waitcnt vmcnt(4) lgkmcnt(0)
    v_mfma_f32_32x32x16_bf16 v[16:31], v[72:75], v[176:179], 0
    s_nop 4
    v_mul_f32 v197, v32, v152
    v_fmac_f32 v197, v33, v153
    v_fmac_f32 v197, v34, v154
    v_fmac_f32 v197, v35, v155
    v_fmac_f32 v197, v36, v156
    v_fmac_f32 v197, v37, v157
    s_add_u32 m0, s21, 4096
    v_mfma_f32_32x32x16_bf16 v[48:63], v[76:79], v[176:179], 0
    buffer_load_dwordx4 v236, s[4:7], s37 offen  lds
    buffer_load_dwordx4 v237, s[8:11], s37 offen offset:1024  lds
    ds_read_b64_tr_b16 v[176:177], v244 offset:6144
    ds_read_b64_tr_b16 v[178:179], v244 offset:7168
    ds_read_b64_tr_b16 v[184:185], v245 offset:6144
    ds_read_b64_tr_b16 v[186:187], v245 offset:7168
    v_add_u32 v252, s43, v247
    ds_read2_b32 v[236:237], v252 offset0:0 offset1:16
    v_fmac_f32 v197, v38, v158
    v_fmac_f32 v197, v39, v159
    v_mul_f32_e64 v201, v0, -v168
    v_fma_f32 v201, v1, -v169, v201
    s_waitcnt vmcnt(4) lgkmcnt(1)
    v_mfma_f32_32x32x16_bf16 v[16:31], v[80:83], v[176:179], v[16:31]
    v_fma_f32 v201, v2, -v170, v201
    v_fma_f32 v201, v3, -v171, v201
    v_fma_f32 v201, v4, -v172, v201
    v_fma_f32 v201, v5, -v173, v201
    v_fma_f32 v201, v6, -v174, v201
    v_fma_f32 v201, v7, -v175, v201
    s_add_u32 m0, s21, 6144
    v_mfma_f32_32x32x16_bf16 v[48:63], v[84:87], v[176:179], v[48:63]
    buffer_load_dwordx4 v238, s[4:7], s37 offen  lds
    buffer_load_dwordx4 v239, s[8:11], s37 offen offset:1024  lds
    ds_read_b64_tr_b16 v[176:177], v244 offset:0
    ds_read_b64_tr_b16 v[178:179], v244 offset:1024
    ds_read_b64_tr_b16 v[188:189], v245 offset:0
    ds_read_b64_tr_b16 v[190:191], v245 offset:1024
    v_add_u32 v252, s44, v247
    ds_read2_b32 v[238:239], v252 offset0:0 offset1:16
    s_waitcnt lgkmcnt(1)
    v_mfma_f32_32x32x16_bf16 v[16:31], v[88:91], v[176:179], v[16:31]
    v_mul_f32_e64 v203, v8, -v168
    v_fma_f32 v203, v9, -v169, v203
    v_fma_f32 v203, v10, -v170, v203
    v_fma_f32 v203, v11, -v171, v203
    v_fma_f32 v203, v12, -v172, v203
    v_fma_f32 v203, v13, -v173, v203
    s_add_u32 m0, s21, 0
    v_mfma_f32_32x32x16_bf16 v[48:63], v[92:95], v[176:179], v[48:63]
    s_cbranch_vccnz WL_6_0
    v_mad_u32_u16 v234, v234, s3, v246 op_sel:[1,0,0,0]
    v_mad_u32_u16 v235, v235, s3, v246 op_sel:[1,0,0,0]
    buffer_load_dwordx4 v234, s[4:7], s38 offen  lds
    buffer_load_dwordx4 v235, s[8:11], s38 offen offset:1024  lds
WR_6_0:
    v_fma_f32 v203, v14, -v174, v203
    v_fma_f32 v203, v15, -v175, v203
    v_mfma_f32_32x32x16_bf16 v[0:15], v[72:75], v[180:183], 0
    v_fmac_f32 v200, v24, v160
    v_fmac_f32 v200, v25, v161
    v_fmac_f32 v200, v26, v162
    v_fmac_f32 v200, v27, v163
    v_fmac_f32 v200, v28, v164
    v_fmac_f32 v200, v29, v165
    v_fmac_f32 v200, v30, v166
    v_fmac_f32 v200, v31, v167
    v_mfma_f32_32x32x16_bf16 v[24:39], v[76:79], v[180:183], 0
    v_mul_f32 v254, v16, v144
    v_fmac_f32 v254, v17, v145
    v_fmac_f32 v254, v18, v146
    v_fmac_f32 v254, v19, v147
    v_fmac_f32 v254, v20, v148
    v_fmac_f32 v254, v21, v149
    v_mfma_f32_32x32x16_bf16 v[0:15], v[80:83], v[184:187], v[0:15]
    v_fmac_f32 v254, v22, v150
    v_fmac_f32 v254, v23, v151
    v_sub_f32_e64 v64, -v48, v64
    v_sub_f32_e64 v65, -v49, v65
    v_permlane32_swap_b32 v196, v254
    v_sub_f32_e64 v66, -v50, v66
    v_mfma_f32_32x32x16_bf16 v[24:39], v[84:87], v[184:187], v[24:39]
    s_waitcnt vmcnt(6)
    ds_read_b64_tr_b16 v[176:177], v244 offset:2048
    ds_read_b64_tr_b16 v[178:179], v244 offset:3072
    ds_read_b64_tr_b16 v[180:181], v245 offset:2048
    ds_read_b64_tr_b16 v[182:183], v245 offset:3072
    v_sub_f32_e64 v67, -v51, v67
    v_sub_f32_e64 v68, -v52, v68
    v_mfma_f32_32x32x16_bf16 v[24:39], v[92:95], v[188:191], v[24:39]
    v_sub_f32_e64 v69, -v53, v69
    v_sub_f32_e64 v70, -v54, v70
    v_sub_f32_e64 v71, -v55, v71
    v_add_f32 v254, v196, v254
    v_mfma_f32_32x32x16_bf16 v[0:15], v[88:91], v[188:191], v[0:15]
    s_waitcnt vmcnt(4) lgkmcnt(0)
    v_mfma_f32_32x32x16_bf16 v[56:71], v[76:79], v[176:179], v[56:71]
    s_nop 4
    v_sub_f32_e64 v40, -v24, v40
    v_sub_f32_e64 v41, -v25, v41
    v_sub_f32_e64 v42, -v26, v42
    v_sub_f32_e64 v43, -v27, v43
    v_sub_f32_e64 v44, -v28, v44
    v_sub_f32_e64 v45, -v29, v45
    v_sub_f32_e64 v46, -v30, v46
    v_sub_f32_e64 v47, -v31, v47
    s_add_u32 m0, s21, 2048
    v_mfma_f32_32x32x16_bf16 v[16:31], v[72:75], v[176:179], 0
    s_cbranch_vccnz WL_6_1
    v_mad_u32_u16 v236, v236, s3, v246 op_sel:[1,0,0,0]
    v_mad_u32_u16 v237, v237, s3, v246 op_sel:[1,0,0,0]
    buffer_load_dwordx4 v236, s[4:7], s39 offen  lds
    buffer_load_dwordx4 v237, s[8:11], s39 offen offset:1024  lds
WR_6_1:
    ds_read_b64_tr_b16 v[176:177], v244 offset:4096
    ds_read_b64_tr_b16 v[178:179], v244 offset:5120
    ds_read_b64_tr_b16 v[184:185], v245 offset:4096
    ds_read_b64_tr_b16 v[186:187], v245 offset:5120
    v_mul_f32 v255, v0, v152
    v_fmac_f32 v255, v1, v153
    v_fmac_f32 v255, v2, v154
    v_fmac_f32 v255, v3, v155
    v_fmac_f32 v255, v4, v156
    s_waitcnt vmcnt(4) lgkmcnt(0)
    v_mfma_f32_32x32x16_bf16 v[16:31], v[80:83], v[176:179], v[16:31]
    v_fmac_f32 v255, v5, v157
    v_fmac_f32 v255, v6, v158
    v_fmac_f32 v255, v7, v159
    v_fmac_f32 v201, v8, v168
    v_fmac_f32 v201, v9, v169
    v_permlane32_swap_b32 v197, v255
    s_add_u32 m0, s21, 4096
    v_mfma_f32_32x32x16_bf16 v[56:71], v[84:87], v[176:179], v[56:71]
    s_cbranch_vccnz WL_6_2
    v_mad_u32_u16 v238, v238, s3, v246 op_sel:[1,0,0,0]
    v_mad_u32_u16 v239, v239, s3, v246 op_sel:[1,0,0,0]
    buffer_load_dwordx4 v238, s[4:7], s40 offen  lds
    buffer_load_dwordx4 v239, s[8:11], s40 offen offset:1024  lds
WR_6_2:
    ds_read_b64_tr_b16 v[176:177], v244 offset:6144
    ds_read_b64_tr_b16 v[178:179], v244 offset:7168
    ds_read_b64_tr_b16 v[188:189], v245 offset:6144
    ds_read_b64_tr_b16 v[190:191], v245 offset:7168
    s_waitcnt lgkmcnt(0)
    v_mfma_f32_32x32x16_bf16 v[16:31], v[88:91], v[176:179], v[16:31]
    v_fmac_f32 v201, v10, v170
    v_fmac_f32 v201, v11, v171
    v_fmac_f32 v201, v12, v172
    v_fmac_f32 v201, v13, v173
    v_fmac_f32 v201, v14, v174
    v_fmac_f32 v201, v15, v175
    s_add_u32 m0, s21, 6144
    v_mfma_f32_32x32x16_bf16 v[56:71], v[92:95], v[176:179], v[56:71]
    s_cbranch_vccnz WL_6_3
    v_mad_u32_u16 v240, v240, s3, v246 op_sel:[1,0,0,0]
    v_mad_u32_u16 v241, v241, s3, v246 op_sel:[1,0,0,0]
    buffer_load_dwordx4 v240, s[4:7], s41 offen  lds
    buffer_load_dwordx4 v241, s[8:11], s41 offen offset:1024  lds
WR_6_3:
    v_add_f32 v255, v197, v255
    v_cvt_pk_bf16_f32 v194, v254, v255
    v_mfma_f32_32x32x16_bf16 v[0:15], v[72:75], v[180:183], 0
    v_mul_f32 v254, v16, v144
    v_fmac_f32 v254, v17, v145
    v_fmac_f32 v254, v18, v146
    v_fmac_f32 v254, v19, v147
    v_fmac_f32 v254, v20, v148
    v_fmac_f32 v254, v21, v149
    v_mfma_f32_32x32x16_bf16 v[32:47], v[76:79], v[180:183], v[32:47]
    v_fmac_f32 v254, v22, v150
    v_fmac_f32 v254, v23, v151
    v_fma_f32 v202, v24, -v160, v202
    v_fma_f32 v202, v25, -v161, v202
    v_permlane32_swap_b32 v254, v200
    v_fma_f32 v202, v26, -v162, v202
    v_mfma_f32_32x32x16_bf16 v[0:15], v[80:83], v[184:187], v[0:15]
    v_fma_f32 v202, v27, -v163, v202
    v_fma_f32 v202, v28, -v164, v202
    v_fma_f32 v202, v29, -v165, v202
    v_fma_f32 v202, v30, -v166, v202
    v_fma_f32 v202, v31, -v167, v202
    v_add_f32 v200, v254, v200
    v_mfma_f32_32x32x16_bf16 v[32:47], v[84:87], v[184:187], v[32:47]
    s_waitcnt vmcnt(6)
    ds_read_b64_tr_b16 v[176:177], v244 offset:0
    ds_read_b64_tr_b16 v[178:179], v244 offset:1024
    ds_read_b64_tr_b16 v[180:181], v245 offset:0
    ds_read_b64_tr_b16 v[182:183], v245 offset:1024
    v_mul_f32_e64 v198, v64, -v112
    v_permlane32_swap_b32 v202, v254
    v_mfma_f32_32x32x16_bf16 v[0:15], v[88:91], v[188:191], v[0:15]
    v_fma_f32 v198, v65, -v113, v198
    v_fma_f32 v198, v66, -v114, v198
    v_fma_f32 v198, v67, -v115, v198
    v_fma_f32 v198, v68, -v116, v198
    v_fma_f32 v198, v69, -v117, v198
    v_fma_f32 v198, v70, -v118, v198
    v_mfma_f32_32x32x16_bf16 v[32:47], v[92:95], v[188:191], v[32:47]
    v_add_u32 v249, s48, v249
    v_add_u32 v250, s49, v250
    ds_read_b32 v252, v251 offset:16
    ds_read_b64_tr_b16 v[72:73], v249 offset:0
    ds_read_b64_tr_b16 v[76:77], v249 offset:64
    ds_read_b64_tr_b16 v[74:75], v249 offset:256
    ds_read_b64_tr_b16 v[78:79], v249 offset:320
    s_mov_b64 exec, s[54:55]
    ds_read_u16_d16_hi v242, v250 offset:0
    s_mov_b64 exec, -1
    v_fma_f32 v198, v71, -v119, v198
    v_add_f32 v254, v202, v254
    v_mul_f32 v196, v56, v160
    v_fmac_f32 v196, v57, v161
    v_fmac_f32 v196, v58, v162
    v_fmac_f32 v196, v59, v163
    v_fmac_f32 v196, v60, v164
    v_fmac_f32 v196, v61, v165
    v_fmac_f32 v196, v62, v166
    v_fmac_f32 v196, v63, v167
    s_nop 1
    v_permlane32_swap_b32 v198, v196
    v_add_f32 v196, v198, v196
    s_cbranch_vccnz LEPI_0
    v_mul_f32 v255, v0, v152
    v_fmac_f32 v255, v1, v153
    v_fmac_f32 v255, v2, v154
    v_fmac_f32 v255, v3, v155
    v_fmac_f32 v255, v4, v156
    v_fmac_f32 v255, v5, v157
    v_fmac_f32 v255, v6, v158
    v_fmac_f32 v255, v7, v159
    v_fma_f32 v203, v8, -v168, v203
    v_fma_f32 v203, v9, -v169, v203
    v_permlane32_swap_b32 v255, v201
    v_fma_f32 v203, v10, -v170, v203
    v_fma_f32 v203, v11, -v171, v203
    v_fma_f32 v203, v12, -v172, v203
    v_fma_f32 v203, v13, -v173, v203
    v_fma_f32 v203, v14, -v174, v203
    v_fma_f32 v203, v15, -v175, v203
    v_add_f32 v201, v255, v201
    v_mul_f32_e64 v199, v40, -v120
    v_permlane32_swap_b32 v203, v255
    v_fma_f32 v199, v41, -v121, v199
    v_fma_f32 v199, v42, -v122, v199
    v_fma_f32 v199, v43, -v123, v199
    v_fma_f32 v199, v44, -v124, v199
    v_fma_f32 v199, v45, -v125, v199
    v_fma_f32 v199, v46, -v126, v199
    v_fma_f32 v199, v47, -v127, v199
    v_add_f32 v255, v203, v255
    v_mul_f32 v197, v32, v168
    v_fmac_f32 v197, v33, v169
    v_fmac_f32 v197, v34, v170
    v_fmac_f32 v197, v35, v171
    v_fmac_f32 v197, v36, v172
    v_fmac_f32 v197, v37, v173
    v_fmac_f32 v197, v38, v174
    v_fmac_f32 v197, v39, v175
    s_nop 1
    v_permlane32_swap_b32 v199, v197
    v_add_f32 v197, v199, v197
    v_cvt_pk_bf16_f32 v200, v200, v201
    v_cvt_pk_bf16_f32 v254, v254, v255
    v_cvt_pk_bf16_f32 v196, v196, v197
    ds_write2st64_b32 v253, v192, v193 offset0:0 offset1:1
    ds_write2st64_b32 v253, v194, v200 offset0:2 offset1:3
    ds_write_b32 v253, v196 offset:1024
    s_mov_b64 exec, 0xffffffff
    ds_write_b32 v253, v254 offset:1280
    s_mov_b64 exec, -1
    s_add_u32 s50, s50, 1
    s_cmp_ge_u32 s50, 4
    s_cbranch_scc1 LAST1
    s_waitcnt lgkmcnt(9)
    v_readfirstlane_b32 s66, v252
    s_add_u32 s53, s53, 1
    v_mov_b32 v252, s53
    s_cmp_le_u32 s53, s66
    ds_write2_b32 v251, v252, v252 offset0:0 offset1:8
    s_setprio 1
    s_cbranch_scc1 PRIO_14
    s_setprio 0
PRIO_14:
    s_cmp_eq_u32 s52, 4
    s_cbranch_scc1 ITEM_1_4
    s_cmp_eq_u32 s52, 5
    s_cbranch_scc1 ITEM_1_5
    s_cmp_eq_u32 s52, 3
    s_cbranch_scc1 ITEM_1_3
    s_cmp_eq_u32 s52, 6
    s_cbranch_scc1 ITEM_1_6
    s_cmp_eq_u32 s52, 8
    s_cbranch_scc1 ITEM_1_8
    s_branch ITEM_1_2
WL_6_0:
    s_add_u32 s66, s51, 0
    buffer_load_dwordx4 v[96:99], v246, s[16:19], s66 offen offset:2048 sc1
    buffer_load_dwordx4 v[100:103], v246, s[16:19], s66 offen offset:3072 sc1
    s_branch WR_6_0
WL_6_1:
    s_add_u32 s66, s51, 4096
    buffer_load_dwordx4 v[104:107], v246, s[16:19], s66 offen offset:2048 sc1
    buffer_load_dwordx4 v[108:111], v246, s[16:19], s66 offen offset:3072 sc1
    s_branch WR_6_1
WL_6_2:
    s_add_u32 s66, s51, 8192
    buffer_load_dwordx4 v[128:131], v246, s[16:19], s66 offen offset:2048 sc1
    buffer_load_dwordx4 v[132:135], v246, s[16:19], s66 offen offset:3072 sc1
    s_branch WR_6_2
WL_6_3:
    s_add_u32 s66, s51, 12288
    buffer_load_dwordx4 v[136:139], v246, s[16:19], s66 offen offset:2048 sc1
    buffer_load_dwordx4 v[140:143], v246, s[16:19], s66 offen offset:3072 sc1
    s_branch WR_6_3
.p2align 6
ITEM_1_8:
    s_mov_b64 exec, s[54:55]
    ds_read_u16_d16_hi v243, v250 offset:128
    s_mov_b64 exec, -1
    ds_read_b64_tr_b16 v[80:81], v249 offset:512
    ds_read_b64_tr_b16 v[84:85], v249 offset:576
    ds_read_b64_tr_b16 v[82:83], v249 offset:768
    ds_read_b64_tr_b16 v[86:87], v249 offset:832
    ds_read_b64_tr_b16 v[88:89], v249 offset:1024
    ds_read_b64_tr_b16 v[92:93], v249 offset:1088
    ds_read_b64_tr_b16 v[90:91], v249 offset:1280
    ds_read_b64_tr_b16 v[94:95], v249 offset:1344
    ds_read_b64_tr_b16 v[64:65], v249 offset:1536
    ds_read_b64_tr_b16 v[68:69], v249 offset:1600
    ds_read_b64_tr_b16 v[66:67], v249 offset:1792
    ds_read_b64_tr_b16 v[70:71], v249 offset:1856
    s_waitcnt lgkmcnt(13)
    v_mul_f32_dpp v196, v242, v72 row_newbcast:0 row_mask:0xf bank_mask:0xf
    v_mul_f32_dpp v197, v242, v73 row_newbcast:1 row_mask:0xf bank_mask:0xf
    v_mul_f32_dpp v198, v242, v72 row_newbcast:8 row_mask:0xf bank_mask:0xf
    v_mul_f32_dpp v199, v242, v73 row_newbcast:9 row_mask:0xf bank_mask:0xf
    v_mul_f32_dpp v200, v242, v76 row_newbcast:2 row_mask:0xf bank_mask:0xf
    v_mul_f32_dpp v201, v242, v77 row_newbcast:3 row_mask:0xf bank_mask:0xf
    v_mul_f32_dpp v202, v242, v76 row_newbcast:10 row_mask:0xf bank_mask:0xf
    v_mul_f32_dpp v203, v242, v77 row_newbcast:11 row_mask:0xf bank_mask:0xf
    v_cvt_pk_bf16_f32 v72, v196, v197
    v_cvt_pk_bf16_f32 v76, v198, v199
    v_cvt_pk_bf16_f32 v73, v200, v201
    v_cvt_pk_bf16_f32 v77, v202, v203
    v_mul_f32_dpp v196, v242, v74 row_newbcast:4 row_mask:0xf bank_mask:0xf
    v_mul_f32_dpp v197, v242, v75 row_newbcast:5 row_mask:0xf bank_mask:0xf
    v_mul_f32_dpp v198, v242, v74 row_newbcast:12 row_mask:0xf bank_mask:0xf
    v_mul_f32_dpp v199, v242, v75 row_newbcast:13 row_mask:0xf bank_mask:0xf
    v_mul_f32_dpp v200, v242, v78 row_newbcast:6 row_mask:0xf bank_mask:0xf
    v_mul_f32_dpp v201, v242, v79 row_newbcast:7 row_mask:0xf bank_mask:0xf
    v_mul_f32_dpp v202, v242, v78 row_newbcast:14 row_mask:0xf bank_mask:0xf
    v_mul_f32_dpp v203, v242, v79 row_newbcast:15 row_mask:0xf bank_mask:0xf
    v_cvt_pk_bf16_f32 v74, v196, v197
    v_cvt_pk_bf16_f32 v78, v198, v199
    v_cvt_pk_bf16_f32 v75, v200, v201
    v_cvt_pk_bf16_f32 v79, v202, v203
    s_mov_b64 exec, s[54:55]
    ds_read_u16_d16_hi v242, v250 offset:256
    s_mov_b64 exec, -1
    s_waitcnt vmcnt(4) lgkmcnt(9)
    v_mfma_f32_32x32x16_bf16 v[0:15], v[72:75], v[176:179], 0
    v_mul_f32_dpp v196, v243, v80 row_newbcast:0 row_mask:0xf bank_mask:0xf
    v_mul_f32_dpp v197, v243, v81 row_newbcast:1 row_mask:0xf bank_mask:0xf
    v_mul_f32_dpp v198, v243, v80 row_newbcast:8 row_mask:0xf bank_mask:0xf
    v_mul_f32_dpp v199, v243, v81 row_newbcast:9 row_mask:0xf bank_mask:0xf
    v_mul_f32_dpp v200, v243, v84 row_newbcast:2 row_mask:0xf bank_mask:0xf
    v_mul_f32_dpp v201, v243, v85 row_newbcast:3 row_mask:0xf bank_mask:0xf
    s_add_u32 m0, s21, 0
    v_mfma_f32_32x32x16_bf16 v[48:63], v[76:79], v[176:179], 0
    buffer_load_dwordx4 v234, s[4:7], s35 offen  lds
    buffer_load_dwordx4 v235, s[8:11], s35 offen offset:1024  lds
    ds_read_b64_tr_b16 v[176:177], v244 offset:2048
    ds_read_b64_tr_b16 v[178:179], v244 offset:3072
    ds_read_b64_tr_b16 v[184:185], v245 offset:2048
    ds_read_b64_tr_b16 v[186:187], v245 offset:3072
    v_mul_f32_dpp v202, v243, v84 row_newbcast:10 row_mask:0xf bank_mask:0xf
    v_mul_f32_dpp v203, v243, v85 row_newbcast:11 row_mask:0xf bank_mask:0xf
    v_cvt_pk_bf16_f32 v80, v196, v197
    v_cvt_pk_bf16_f32 v84, v198, v199
    v_cvt_pk_bf16_f32 v81, v200, v201
    v_cvt_pk_bf16_f32 v85, v202, v203
    v_mul_f32_dpp v196, v243, v82 row_newbcast:4 row_mask:0xf bank_mask:0xf
    v_mul_f32_dpp v197, v243, v83 row_newbcast:5 row_mask:0xf bank_mask:0xf
    v_mul_f32_dpp v198, v243, v82 row_newbcast:12 row_mask:0xf bank_mask:0xf
    v_mul_f32_dpp v199, v243, v83 row_newbcast:13 row_mask:0xf bank_mask:0xf
    v_mul_f32_dpp v200, v243, v86 row_newbcast:6 row_mask:0xf bank_mask:0xf
    v_mul_f32_dpp v201, v243, v87 row_newbcast:7 row_mask:0xf bank_mask:0xf
    v_mul_f32_dpp v202, v243, v86 row_newbcast:14 row_mask:0xf bank_mask:0xf
    v_mul_f32_dpp v203, v243, v87 row_newbcast:15 row_mask:0xf bank_mask:0xf
    v_cvt_pk_bf16_f32 v82, v196, v197
    v_cvt_pk_bf16_f32 v86, v198, v199
    v_cvt_pk_bf16_f32 v83, v200, v201
    v_cvt_pk_bf16_f32 v87, v202, v203
    s_mov_b64 exec, s[54:55]
    ds_read_u16_d16_hi v243, v250 offset:384
    s_mov_b64 exec, -1
    s_waitcnt vmcnt(4) lgkmcnt(1)
    v_mfma_f32_32x32x16_bf16 v[0:15], v[80:83], v[176:179], v[0:15]
    v_mul_f32_dpp v196, v242, v88 row_newbcast:0 row_mask:0xf bank_mask:0xf
    v_mul_f32_dpp v197, v242, v89 row_newbcast:1 row_mask:0xf bank_mask:0xf
    v_mul_f32_dpp v198, v242, v88 row_newbcast:8 row_mask:0xf bank_mask:0xf
    v_mul_f32_dpp v199, v242, v89 row_newbcast:9 row_mask:0xf bank_mask:0xf
    v_mul_f32_dpp v200, v242, v92 row_newbcast:2 row_mask:0xf bank_mask:0xf
    v_mul_f32_dpp v201, v242, v93 row_newbcast:3 row_mask:0xf bank_mask:0xf
    s_add_u32 m0, s21, 2048
    v_mfma_f32_32x32x16_bf16 v[48:63], v[84:87], v[176:179], v[48:63]
    buffer_load_dwordx4 v236, s[4:7], s35 offen  lds
    buffer_load_dwordx4 v237, s[8:11], s35 offen offset:1024  lds
    ds_read_b64_tr_b16 v[176:177], v244 offset:4096
    ds_read_b64_tr_b16 v[178:179], v244 offset:5120
    ds_read_b64_tr_b16 v[188:189], v245 offset:4096
    ds_read_b64_tr_b16 v[190:191], v245 offset:5120
    v_mul_f32_dpp v202, v242, v92 row_newbcast:10 row_mask:0xf bank_mask:0xf
    v_mul_f32_dpp v203, v242, v93 row_newbcast:11 row_mask:0xf bank_mask:0xf
    v_cvt_pk_bf16_f32 v88, v196, v197
    v_cvt_pk_bf16_f32 v92, v198, v199
    v_cvt_pk_bf16_f32 v89, v200, v201
    v_cvt_pk_bf16_f32 v93, v202, v203
    v_mul_f32_dpp v196, v242, v90 row_newbcast:4 row_mask:0xf bank_mask:0xf
    v_mul_f32_dpp v197, v242, v91 row_newbcast:5 row_mask:0xf bank_mask:0xf
    v_mul_f32_dpp v198, v242, v90 row_newbcast:12 row_mask:0xf bank_mask:0xf
    v_mul_f32_dpp v199, v242, v91 row_newbcast:13 row_mask:0xf bank_mask:0xf
    v_mul_f32_dpp v200, v242, v94 row_newbcast:6 row_mask:0xf bank_mask:0xf
    v_mul_f32_dpp v201, v242, v95 row_newbcast:7 row_mask:0xf bank_mask:0xf
    v_mul_f32_dpp v202, v242, v94 row_newbcast:14 row_mask:0xf bank_mask:0xf
    v_mul_f32_dpp v203, v242, v95 row_newbcast:15 row_mask:0xf bank_mask:0xf
    v_cvt_pk_bf16_f32 v90, v196, v197
    v_cvt_pk_bf16_f32 v94, v198, v199
    v_cvt_pk_bf16_f32 v91, v200, v201
    v_cvt_pk_bf16_f32 v95, v202, v203
    s_waitcnt vmcnt(4) lgkmcnt(0)
    v_mfma_f32_32x32x16_bf16 v[0:15], v[88:91], v[176:179], v[0:15]
    v_mul_f32_dpp v196, v243, v64 row_newbcast:0 row_mask:0xf bank_mask:0xf
    v_mul_f32_dpp v197, v243, v65 row_newbcast:1 row_mask:0xf bank_mask:0xf
    v_mul_f32_dpp v198, v243, v64 row_newbcast:8 row_mask:0xf bank_mask:0xf
    v_mul_f32_dpp v199, v243, v65 row_newbcast:9 row_mask:0xf bank_mask:0xf
    v_mul_f32_dpp v200, v243, v68 row_newbcast:2 row_mask:0xf bank_mask:0xf
    v_mul_f32_dpp v201, v243, v69 row_newbcast:3 row_mask:0xf bank_mask:0xf
    s_add_u32 m0, s21, 4096
    v_mfma_f32_32x32x16_bf16 v[48:63], v[92:95], v[176:179], v[48:63]
    buffer_load_dwordx4 v238, s[4:7], s35 offen  lds
    buffer_load_dwordx4 v239, s[8:11], s35 offen offset:1024  lds
    ds_read_b64_tr_b16 v[176:177], v244 offset:6144
    ds_read_b64_tr_b16 v[178:179], v244 offset:7168
    ds_read_b64_tr_b16 v[192:193], v245 offset:6144
    ds_read_b64_tr_b16 v[194:195], v245 offset:7168
    v_mul_f32_dpp v202, v243, v68 row_newbcast:10 row_mask:0xf bank_mask:0xf
    v_mul_f32_dpp v203, v243, v69 row_newbcast:11 row_mask:0xf bank_mask:0xf
    v_cvt_pk_bf16_f32 v64, v196, v197
    v_cvt_pk_bf16_f32 v68, v198, v199
    v_cvt_pk_bf16_f32 v65, v200, v201
    v_cvt_pk_bf16_f32 v69, v202, v203
    v_mul_f32_dpp v196, v243, v66 row_newbcast:4 row_mask:0xf bank_mask:0xf
    v_mul_f32_dpp v197, v243, v67 row_newbcast:5 row_mask:0xf bank_mask:0xf
    v_mul_f32_dpp v198, v243, v66 row_newbcast:12 row_mask:0xf bank_mask:0xf
    v_mul_f32_dpp v199, v243, v67 row_newbcast:13 row_mask:0xf bank_mask:0xf
    v_mul_f32_dpp v200, v243, v70 row_newbcast:6 row_mask:0xf bank_mask:0xf
    v_mul_f32_dpp v201, v243, v71 row_newbcast:7 row_mask:0xf bank_mask:0xf
    v_mul_f32_dpp v202, v243, v70 row_newbcast:14 row_mask:0xf bank_mask:0xf
    v_mul_f32_dpp v203, v243, v71 row_newbcast:15 row_mask:0xf bank_mask:0xf
    v_cvt_pk_bf16_f32 v66, v196, v197
    v_cvt_pk_bf16_f32 v70, v198, v199
    v_cvt_pk_bf16_f32 v67, v200, v201
    v_cvt_pk_bf16_f32 v71, v202, v203
    s_waitcnt lgkmcnt(0)
    v_mfma_f32_32x32x16_bf16 v[0:15], v[64:67], v[176:179], v[0:15]
    s_add_u32 m0, s21, 6144
    v_mfma_f32_32x32x16_bf16 v[48:63], v[68:71], v[176:179], v[48:63]
    buffer_load_dwordx4 v240, s[4:7], s35 offen  lds
    buffer_load_dwordx4 v241, s[8:11], s35 offen offset:1024  lds
    s_mov_b32 m0, s50
    s_nop 0
    s_movrels_b32 s71, s23
    s_movrels_b32 s33, s28
    v_add_u32 v253, s33, v248
    s_bfe_u32 s46, s71, 0x30012
    s_mov_b32 m0, s46
    s_and_b32 s66, s71, 0x3ffff
    s_movrels_b32 s68, s57
    s_movrels_b32 s69, s61
    s_sub_u32 s48, s66, s47
    s_mov_b32 s47, s66
    s_lshr_b32 s52, s71, 28
    s_lshl_b32 s67, s46, 9
    s_add_u32 s66, s66, s67
    s_sub_u32 s49, s66, s42
    s_mov_b32 s42, s66
    s_bfe_u32 s66, s68, 655360
    s_add_u32 s43, s42, s66
    s_bfe_u32 s39, s69, 655360
    s_bfe_u32 s66, s68, 655370
    s_add_u32 s44, s42, s66
    s_bfe_u32 s40, s69, 655370
    s_bfe_u32 s66, s68, 655380
    s_add_u32 s45, s42, s66
    s_bfe_u32 s41, s69, 655380
    v_mfma_f32_32x32x16_bf16 v[16:31], v[72:75], v[180:183], 0
    v_mul_f32 v196, v0, v96
    v_fmac_f32 v196, v1, v97
    v_fmac_f32 v196, v2, v98
    v_fmac_f32 v196, v3, v99
    v_fmac_f32 v196, v4, v100
    v_fmac_f32 v196, v5, v101
    v_mfma_f32_32x32x16_bf16 v[32:47], v[76:79], v[180:183], 0
    v_fmac_f32 v196, v6, v102
    v_fmac_f32 v196, v7, v103
    v_mul_f32 v198, v8, v128
    v_fmac_f32 v198, v9, v129
    v_fmac_f32 v198, v10, v130
    v_fmac_f32 v198, v11, v131
    v_mfma_f32_32x32x16_bf16 v[16:31], v[80:83], v[184:187], v[16:31]
    v_fmac_f32 v198, v12, v132
    v_fmac_f32 v198, v13, v133
    v_fmac_f32 v198, v14, v134
    v_fmac_f32 v198, v15, v135
    v_mul_f32 v200, v48, v128
    v_fmac_f32 v200, v49, v129
    v_mfma_f32_32x32x16_bf16 v[32:47], v[84:87], v[184:187], v[32:47]
    v_permlane32_swap_b32 v196, v198
    v_fmac_f32 v200, v50, v130
    v_fmac_f32 v200, v51, v131
    v_fmac_f32 v200, v52, v132
    v_fmac_f32 v200, v53, v133
    v_fmac_f32 v200, v54, v134
    v_mfma_f32_32x32x16_bf16 v[16:31], v[88:91], v[188:191], v[16:31]
    v_fmac_f32 v200, v55, v135
    v_add_f32 v198, v196, v198
    v_mul_f32_e64 v202, v56, -v128
    v_fma_f32 v202, v57, -v129, v202
    v_fma_f32 v202, v58, -v130, v202
    v_fma_f32 v202, v59, -v131, v202
    v_mfma_f32_32x32x16_bf16 v[32:47], v[92:95], v[188:191], v[32:47]
    s_waitcnt vmcnt(6)
    ds_read_b64_tr_b16 v[176:177], v244 offset:0
    ds_read_b64_tr_b16 v[178:179], v244 offset:1024
    ds_read_b64_tr_b16 v[180:181], v245 offset:0
    ds_read_b64_tr_b16 v[182:183], v245 offset:1024
    v_fma_f32 v202, v60, -v132, v202
    v_fma_f32 v202, v61, -v133, v202
    v_mfma_f32_32x32x16_bf16 v[16:31], v[64:67], v[192:195], v[16:31]
    v_fma_f32 v202, v62, -v134, v202
    v_fma_f32 v202, v63, -v135, v202
    s_nop 1
    v_permlane32_swap_b32 v200, v202
    v_add_f32 v202, v200, v202
    v_mfma_f32_32x32x16_bf16 v[32:47], v[68:71], v[192:195], v[32:47]
    s_waitcnt vmcnt(4) lgkmcnt(0)
    v_mfma_f32_32x32x16_bf16 v[0:15], v[72:75], v[176:179], 0
    s_nop 2
    v_mul_f32 v197, v16, v104
    v_fmac_f32 v197, v17, v105
    v_fmac_f32 v197, v18, v106
    v_fmac_f32 v197, v19, v107
    v_fmac_f32 v197, v20, v108
    v_fmac_f32 v197, v21, v109
    s_add_u32 m0, s21, 0
    v_mfma_f32_32x32x16_bf16 v[48:63], v[76:79], v[176:179], 0
    buffer_load_dwordx4 v234, s[4:7], s36 offen  lds
    buffer_load_dwordx4 v235, s[8:11], s36 offen offset:1024  lds
    ds_read_b64_tr_b16 v[176:177], v244 offset:2048
    ds_read_b64_tr_b16 v[178:179], v244 offset:3072
    ds_read_b64_tr_b16 v[184:185], v245 offset:2048
    ds_read_b64_tr_b16 v[186:187], v245 offset:3072
    v_fmac_f32 v197, v22, v110
    v_fmac_f32 v197, v23, v111
    v_mul_f32 v199, v24, v136
    v_fmac_f32 v199, v25, v137
    v_fmac_f32 v199, v26, v138
    v_fmac_f32 v199, v27, v139
    v_fmac_f32 v199, v28, v140
    v_fmac_f32 v199, v29, v141
    v_fmac_f32 v199, v30, v142
    v_fmac_f32 v199, v31, v143
    v_mul_f32 v201, v32, v136
    s_waitcnt vmcnt(4) lgkmcnt(0)
    v_mfma_f32_32x32x16_bf16 v[0:15], v[80:83], v[176:179], v[0:15]
    v_fmac_f32 v201, v33, v137
    v_permlane32_swap_b32 v197, v199
    v_fmac_f32 v201, v34, v138
    v_fmac_f32 v201, v35, v139
    v_fmac_f32 v201, v36, v140
    v_fmac_f32 v201, v37, v141
    s_add_u32 m0, s21, 2048
    v_mfma_f32_32x32x16_bf16 v[48:63], v[84:87], v[176:179], v[48:63]
    buffer_load_dwordx4 v236, s[4:7], s36 offen  lds
    buffer_load_dwordx4 v237, s[8:11], s36 offen offset:1024  lds
    ds_read_b64_tr_b16 v[176:177], v244 offset:4096
    ds_read_b64_tr_b16 v[178:179], v244 offset:5120
    ds_read_b64_tr_b16 v[188:189], v245 offset:4096
    ds_read_b64_tr_b16 v[190:191], v245 offset:5120
    s_waitcnt vmcnt(4) lgkmcnt(0)
    v_mfma_f32_32x32x16_bf16 v[0:15], v[88:91], v[176:179], v[0:15]
    v_fmac_f32 v201, v38, v142
    v_fmac_f32 v201, v39, v143
    v_add_f32 v199, v197, v199
    v_mul_f32_e64 v203, v40, -v136
    v_fma_f32 v203, v41, -v137, v203
    v_fma_f32 v203, v42, -v138, v203
    s_add_u32 m0, s21, 4096
    v_mfma_f32_32x32x16_bf16 v[48:63], v[92:95], v[176:179], v[48:63]
    buffer_load_dwordx4 v238, s[4:7], s36 offen  lds
    buffer_load_dwordx4 v239, s[8:11], s36 offen offset:1024  lds
    ds_read_b64_tr_b16 v[176:177], v244 offset:6144
    ds_read_b64_tr_b16 v[178:179], v244 offset:7168
    ds_read_b64_tr_b16 v[192:193], v245 offset:6144
    ds_read_b64_tr_b16 v[194:195], v245 offset:7168
    s_waitcnt lgkmcnt(0)
    v_mfma_f32_32x32x16_bf16 v[0:15], v[64:67], v[176:179], v[0:15]
    v_fma_f32 v203, v43, -v139, v203
    v_fma_f32 v203, v44, -v140, v203
    v_fma_f32 v203, v45, -v141, v203
    v_fma_f32 v203, v46, -v142, v203
    v_fma_f32 v203, v47, -v143, v203
    s_nop 1
    v_permlane32_swap_b32 v201, v203
    s_add_u32 m0, s21, 6144
    v_mfma_f32_32x32x16_bf16 v[48:63], v[68:71], v[176:179], v[48:63]
    buffer_load_dwordx4 v240, s[4:7], s36 offen  lds
    buffer_load_dwordx4 v241, s[8:11], s36 offen offset:1024  lds
    v_add_f32 v203, v201, v203
    v_cvt_pk_bf16_f32 v198, v198, v199
    v_cvt_pk_bf16_f32 v202, v202, v203
    ds_write2st64_b32 v253, v198, v202 offset0:0 offset1:1
    v_mfma_f32_32x32x16_bf16 v[16:31], v[72:75], v[180:183], 0
    v_mul_f32 v196, v0, v144
    v_fmac_f32 v196, v1, v145
    v_fmac_f32 v196, v2, v146
    v_fmac_f32 v196, v3, v147
    v_fmac_f32 v196, v4, v148
    v_fmac_f32 v196, v5, v149
    v_mfma_f32_32x32x16_bf16 v[32:47], v[76:79], v[180:183], 0
    v_fmac_f32 v196, v6, v150
    v_fmac_f32 v196, v7, v151
    v_mul_f32 v198, v8, v112
    v_fmac_f32 v198, v9, v113
    v_fmac_f32 v198, v10, v114
    v_fmac_f32 v198, v11, v115
    v_mfma_f32_32x32x16_bf16 v[16:31], v[80:83], v[184:187], v[16:31]
    v_fmac_f32 v198, v12, v116
    v_fmac_f32 v198, v13, v117
    v_fmac_f32 v198, v14, v118
    v_fmac_f32 v198, v15, v119
    v_mul_f32_e64 v200, v48, -v160
    v_fma_f32 v200, v49, -v161, v200
    v_mfma_f32_32x32x16_bf16 v[32:47], v[84:87], v[184:187], v[32:47]
    v_fma_f32 v200, v50, -v162, v200
    v_fma_f32 v200, v51, -v163, v200
    v_fma_f32 v200, v52, -v164, v200
    v_fma_f32 v200, v53, -v165, v200
    v_fma_f32 v200, v54, -v166, v200
    v_fma_f32 v200, v55, -v167, v200
    v_mfma_f32_32x32x16_bf16 v[16:31], v[88:91], v[188:191], v[16:31]
    v_mul_f32_e64 v202, v56, -v160
    v_fma_f32 v202, v57, -v161, v202
    v_fma_f32 v202, v58, -v162, v202
    v_fma_f32 v202, v59, -v163, v202
    v_fma_f32 v202, v60, -v164, v202
    v_fma_f32 v202, v61, -v165, v202
    v_mfma_f32_32x32x16_bf16 v[32:47], v[92:95], v[188:191], v[32:47]
    s_waitcnt vmcnt(6)
    ds_read_b64_tr_b16 v[176:177], v244 offset:0
    ds_read_b64_tr_b16 v[178:179], v244 offset:1024
    ds_read_b64_tr_b16 v[180:181], v245 offset:0
    ds_read_b64_tr_b16 v[182:183], v245 offset:1024
    v_fma_f32 v202, v62, -v166, v202
    v_fma_f32 v202, v63, -v167, v202
    v_mfma_f32_32x32x16_bf16 v[16:31], v[64:67], v[192:195], v[16:31]
    v_mfma_f32_32x32x16_bf16 v[32:47], v[68:71], v[192:195], v[32:47]
    s_waitcnt vmcnt(4) lgkmcnt(0)
    v_mfma_f32_32x32x16_bf16 v[0:15], v[72:75], v[176:179], 0
    s_nop 8
    v_mul_f32 v197, v16, v152
    v_fmac_f32 v197, v17, v153
    v_fmac_f32 v197, v18, v154
    v_fmac_f32 v197, v19, v155
    v_fmac_f32 v197, v20, v156
    v_fmac_f32 v197, v21, v157
    s_add_u32 m0, s21, 0
    v_mfma_f32_32x32x16_bf16 v[48:63], v[76:79], v[176:179], 0
    buffer_load_dwordx4 v234, s[4:7], s37 offen  lds
    buffer_load_dwordx4 v235, s[8:11], s37 offen offset:1024  lds
    ds_read_b64_tr_b16 v[176:177], v244 offset:2048
    ds_read_b64_tr_b16 v[178:179], v244 offset:3072
    ds_read_b64_tr_b16 v[184:185], v245 offset:2048
    ds_read_b64_tr_b16 v[186:187], v245 offset:3072
    v_add_u32 v252, s42, v247
    ds_read2_b32 v[234:235], v252 offset0:0 offset1:16
    v_fmac_f32 v197, v22, v158
    v_fmac_f32 v197, v23, v159
    v_mul_f32 v199, v24, v120
    v_fmac_f32 v199, v25, v121
    v_fmac_f32 v199, v26, v122
    v_fmac_f32 v199, v27, v123
    s_waitcnt vmcnt(4) lgkmcnt(1)
    v_mfma_f32_32x32x16_bf16 v[0:15], v[80:83], v[176:179], v[0:15]
    v_fmac_f32 v199, v28, v124
    v_fmac_f32 v199, v29, v125
    v_fmac_f32 v199, v30, v126
    v_fmac_f32 v199, v31, v127
    v_mul_f32_e64 v201, v32, -v168
    v_fma_f32 v201, v33, -v169, v201
    s_add_u32 m0, s21, 2048
    v_mfma_f32_32x32x16_bf16 v[48:63], v[84:87], v[176:179], v[48:63]
    buffer_load_dwordx4 v236, s[4:7], s37 offen  lds
    buffer_load_dwordx4 v237, s[8:11], s37 offen offset:1024  lds
    ds_read_b64_tr_b16 v[176:177], v244 offset:4096
    ds_read_b64_tr_b16 v[178:179], v244 offset:5120
    ds_read_b64_tr_b16 v[188:189], v245 offset:4096
    ds_read_b64_tr_b16 v[190:191], v245 offset:5120
    v_add_u32 v252, s43, v247
    ds_read2_b32 v[236:237], v252 offset0:0 offset1:16
    s_waitcnt vmcnt(4) lgkmcnt(1)
    v_mfma_f32_32x32x16_bf16 v[0:15], v[88:91], v[176:179], v[0:15]
    v_fma_f32 v201, v34, -v170, v201
    v_fma_f32 v201, v35, -v171, v201
    v_fma_f32 v201, v36, -v172, v201
    v_fma_f32 v201, v37, -v173, v201
    v_fma_f32 v201, v38, -v174, v201
    v_fma_f32 v201, v39, -v175, v201
    s_add_u32 m0, s21, 4096
    v_mfma_f32_32x32x16_bf16 v[48:63], v[92:95], v[176:179], v[48:63]
    buffer_load_dwordx4 v238, s[4:7], s37 offen  lds
    buffer_load_dwordx4 v239, s[8:11], s37 offen offset:1024  lds
    ds_read_b64_tr_b16 v[176:177], v244 offset:6144
    ds_read_b64_tr_b16 v[178:179], v244 offset:7168
    ds_read_b64_tr_b16 v[192:193], v245 offset:6144
    ds_read_b64_tr_b16 v[194:195], v245 offset:7168
    v_add_u32 v252, s44, v247
    ds_read2_b32 v[238:239], v252 offset0:0 offset1:16
    s_waitcnt lgkmcnt(1)
    v_mfma_f32_32x32x16_bf16 v[0:15], v[64:67], v[176:179], v[0:15]
    v_mul_f32_e64 v203, v40, -v168
    v_fma_f32 v203, v41, -v169, v203
    v_fma_f32 v203, v42, -v170, v203
    v_fma_f32 v203, v43, -v171, v203
    v_fma_f32 v203, v44, -v172, v203
    v_fma_f32 v203, v45, -v173, v203
    s_add_u32 m0, s21, 6144
    v_mfma_f32_32x32x16_bf16 v[48:63], v[68:71], v[176:179], v[48:63]
    buffer_load_dwordx4 v240, s[4:7], s37 offen  lds
    buffer_load_dwordx4 v241, s[8:11], s37 offen offset:1024  lds
    v_add_u32 v252, s45, v247
    ds_read2_b32 v[240:241], v252 offset0:0 offset1:16
    v_fma_f32 v203, v46, -v174, v203
    v_fma_f32 v203, v47, -v175, v203
    v_mfma_f32_32x32x16_bf16 v[16:31], v[72:75], v[180:183], 0
    v_mul_f32 v254, v0, v144
    v_fmac_f32 v254, v1, v145
    v_fmac_f32 v254, v2, v146
    v_fmac_f32 v254, v3, v147
    v_fmac_f32 v254, v4, v148
    v_fmac_f32 v254, v5, v149
    v_mfma_f32_32x32x16_bf16 v[32:47], v[76:79], v[180:183], 0
    ds_swizzle_b32 v76, v76 offset:0x401F
    ds_swizzle_b32 v77, v77 offset:0x401F
    ds_swizzle_b32 v78, v78 offset:0x401F
    ds_swizzle_b32 v79, v79 offset:0x401F
    v_fmac_f32 v254, v6, v150
    v_fmac_f32 v254, v7, v151
    v_mfma_f32_32x32x16_bf16 v[16:31], v[80:83], v[184:187], v[16:31]
    v_fmac_f32 v200, v8, v160
    v_fmac_f32 v200, v9, v161
    v_permlane32_swap_b32 v196, v254
    v_fmac_f32 v200, v10, v162
    v_fmac_f32 v200, v11, v163
    v_fmac_f32 v200, v12, v164
    v_mfma_f32_32x32x16_bf16 v[32:47], v[84:87], v[184:187], v[32:47]
    ds_swizzle_b32 v84, v84 offset:0x401F
    ds_swizzle_b32 v85, v85 offset:0x401F
    ds_swizzle_b32 v86, v86 offset:0x401F
    ds_swizzle_b32 v87, v87 offset:0x401F
    v_fmac_f32 v200, v13, v165
    v_fmac_f32 v200, v14, v166
    v_mfma_f32_32x32x16_bf16 v[16:31], v[88:91], v[188:191], v[16:31]
    v_fmac_f32 v200, v15, v167
    v_add_f32 v254, v196, v254
    v_mfma_f32_32x32x16_bf16 v[32:47], v[92:95], v[188:191], v[32:47]
    ds_swizzle_b32 v92, v92 offset:0x401F
    ds_swizzle_b32 v93, v93 offset:0x401F
    ds_swizzle_b32 v94, v94 offset:0x401F
    ds_swizzle_b32 v95, v95 offset:0x401F
    s_waitcnt vmcnt(6)
    ds_read_b64_tr_b16 v[176:177], v244 offset:0
    ds_read_b64_tr_b16 v[178:179], v244 offset:1024
    ds_read_b64_tr_b16 v[180:181], v245 offset:0
    ds_read_b64_tr_b16 v[182:183], v245 offset:1024
    v_mfma_f32_32x32x16_bf16 v[16:31], v[64:67], v[192:195], v[16:31]
    v_mfma_f32_32x32x16_bf16 v[32:47], v[68:71], v[192:195], v[32:47]
    ds_swizzle_b32 v68, v68 offset:0x401F
    ds_swizzle_b32 v69, v69 offset:0x401F
    ds_swizzle_b32 v70, v70 offset:0x401F
    ds_swizzle_b32 v71, v71 offset:0x401F
    s_waitcnt lgkmcnt(8)
    s_mov_b64 exec, s[56:57]
    v_xor_b32 v76, 0x80008000, v76
    v_xor_b32 v77, 0x80008000, v77
    v_xor_b32 v78, 0x80008000, v78
    v_xor_b32 v79, 0x80008000, v79
    v_xor_b32 v84, 0x80008000, v84
    v_xor_b32 v85, 0x80008000, v85
    v_xor_b32 v86, 0x80008000, v86
    v_xor_b32 v87, 0x80008000, v87
    v_xor_b32 v92, 0x80008000, v92
    v_xor_b32 v93, 0x80008000, v93
    v_xor_b32 v94, 0x80008000, v94
    v_xor_b32 v95, 0x80008000, v95
    s_mov_b64 exec, -1
    s_waitcnt vmcnt(4) lgkmcnt(4)
    v_mfma_f32_32x32x16_bf16 v[0:15], v[72:75], v[176:179], 0
    v_mul_f32 v255, v16, v152
    v_fmac_f32 v255, v17, v153
    v_fmac_f32 v255, v18, v154
    v_fmac_f32 v255, v19, v155
    v_fmac_f32 v255, v20, v156
    v_fmac_f32 v255, v21, v157
    s_add_u32 m0, s21, 0
    v_mfma_f32_32x32x16_bf16 v[48:63], v[76:79], v[176:179], v[48:63]
    s_cbranch_vccnz WL_8_0
    v_mad_u32_u16 v234, v234, s3, v246 op_sel:[1,0,0,0]
    v_mad_u32_u16 v235, v235, s3, v246 op_sel:[1,0,0,0]
    buffer_load_dwordx4 v234, s[4:7], s38 offen  lds
    buffer_load_dwordx4 v235, s[8:11], s38 offen offset:1024  lds
WR_8_0:
    ds_read_b64_tr_b16 v[176:177], v244 offset:2048
    ds_read_b64_tr_b16 v[178:179], v244 offset:3072
    ds_read_b64_tr_b16 v[184:185], v245 offset:2048
    ds_read_b64_tr_b16 v[186:187], v245 offset:3072
    s_waitcnt vmcnt(4) lgkmcnt(0)
    v_mfma_f32_32x32x16_bf16 v[0:15], v[80:83], v[176:179], v[0:15]
    s_add_u32 m0, s21, 2048
    v_mfma_f32_32x32x16_bf16 v[48:63], v[84:87], v[176:179], v[48:63]
    s_cbranch_vccnz WL_8_1
    v_mad_u32_u16 v236, v236, s3, v246 op_sel:[1,0,0,0]
    v_mad_u32_u16 v237, v237, s3, v246 op_sel:[1,0,0,0]
    buffer_load_dwordx4 v236, s[4:7], s39 offen  lds
    buffer_load_dwordx4 v237, s[8:11], s39 offen offset:1024  lds
WR_8_1:
    ds_read_b64_tr_b16 v[176:177], v244 offset:4096
    ds_read_b64_tr_b16 v[178:179], v244 offset:5120
    ds_read_b64_tr_b16 v[188:189], v245 offset:4096
    ds_read_b64_tr_b16 v[190:191], v245 offset:5120
    s_waitcnt vmcnt(4) lgkmcnt(0)
    v_mfma_f32_32x32x16_bf16 v[0:15], v[88:91], v[176:179], v[0:15]
    v_fmac_f32 v255, v22, v158
    v_fmac_f32 v255, v23, v159
    v_fmac_f32 v201, v24, v168
    v_fmac_f32 v201, v25, v169
    v_permlane32_swap_b32 v197, v255
    v_fmac_f32 v201, v26, v170
    s_add_u32 m0, s21, 4096
    v_mfma_f32_32x32x16_bf16 v[48:63], v[92:95], v[176:179], v[48:63]
    s_cbranch_vccnz WL_8_2
    v_mad_u32_u16 v238, v238, s3, v246 op_sel:[1,0,0,0]
    v_mad_u32_u16 v239, v239, s3, v246 op_sel:[1,0,0,0]
    buffer_load_dwordx4 v238, s[4:7], s40 offen  lds
    buffer_load_dwordx4 v239, s[8:11], s40 offen offset:1024  lds
WR_8_2:
    ds_read_b64_tr_b16 v[176:177], v244 offset:6144
    ds_read_b64_tr_b16 v[178:179], v244 offset:7168
    ds_read_b64_tr_b16 v[192:193], v245 offset:6144
    ds_read_b64_tr_b16 v[194:195], v245 offset:7168
    s_waitcnt lgkmcnt(0)
    s_mov_b64 exec, s[56:57]
    v_xor_b32 v68, 0x80008000, v68
    v_xor_b32 v69, 0x80008000, v69
    v_xor_b32 v70, 0x80008000, v70
    v_xor_b32 v71, 0x80008000, v71
    s_mov_b64 exec, -1
    v_mfma_f32_32x32x16_bf16 v[0:15], v[64:67], v[176:179], v[0:15]
    v_fmac_f32 v201, v27, v171
    v_fmac_f32 v201, v28, v172
    v_fmac_f32 v201, v29, v173
    v_fmac_f32 v201, v30, v174
    v_fmac_f32 v201, v31, v175
    v_add_f32 v255, v197, v255
    s_add_u32 m0, s21, 6144
    v_mfma_f32_32x32x16_bf16 v[48:63], v[68:71], v[176:179], v[48:63]
    s_cbranch_vccnz WL_8_3
    v_mad_u32_u16 v240, v240, s3, v246 op_sel:[1,0,0,0]
    v_mad_u32_u16 v241, v241, s3, v246 op_sel:[1,0,0,0]
    buffer_load_dwordx4 v240, s[4:7], s41 offen  lds
    buffer_load_dwordx4 v241, s[8:11], s41 offen offset:1024  lds
WR_8_3:
    v_cvt_pk_bf16_f32 v254, v254, v255
    ds_write_b32 v253, v254 offset:512
    v_mfma_f32_32x32x16_bf16 v[16:31], v[72:75], v[180:183], 0
    v_mul_f32 v254, v0, v144
    v_fmac_f32 v254, v1, v145
    v_fmac_f32 v254, v2, v146
    v_fmac_f32 v254, v3, v147
    v_fmac_f32 v254, v4, v148
    v_fmac_f32 v254, v5, v149
    v_mfma_f32_32x32x16_bf16 v[32:47], v[76:79], v[180:183], v[32:47]
    v_fmac_f32 v254, v6, v150
    v_fmac_f32 v254, v7, v151
    v_fma_f32 v202, v8, -v160, v202
    v_fma_f32 v202, v9, -v161, v202
    v_permlane32_swap_b32 v254, v200
    v_fma_f32 v202, v10, -v162, v202
    v_mfma_f32_32x32x16_bf16 v[16:31], v[80:83], v[184:187], v[16:31]
    v_fma_f32 v202, v11, -v163, v202
    v_fma_f32 v202, v12, -v164, v202
    v_fma_f32 v202, v13, -v165, v202
    v_fma_f32 v202, v14, -v166, v202
    v_fma_f32 v202, v15, -v167, v202
    v_add_f32 v200, v254, v200
    v_mfma_f32_32x32x16_bf16 v[32:47], v[84:87], v[184:187], v[32:47]
    v_fmac_f32 v198, v48, v112
    v_permlane32_swap_b32 v202, v254
    v_fmac_f32 v198, v49, v113
    v_fmac_f32 v198, v50, v114
    v_fmac_f32 v198, v51, v115
    v_fmac_f32 v198, v52, v116
    v_mfma_f32_32x32x16_bf16 v[16:31], v[88:91], v[188:191], v[16:31]
    v_fmac_f32 v198, v53, v117
    v_fmac_f32 v198, v54, v118
    v_fmac_f32 v198, v55, v119
    v_add_f32 v254, v202, v254
    v_mul_f32 v196, v56, v160
    v_fmac_f32 v196, v57, v161
    v_mfma_f32_32x32x16_bf16 v[32:47], v[92:95], v[188:191], v[32:47]
    s_waitcnt vmcnt(6)
    ds_read_b64_tr_b16 v[176:177], v244 offset:0
    ds_read_b64_tr_b16 v[178:179], v244 offset:1024
    ds_read_b64_tr_b16 v[180:181], v245 offset:0
    ds_read_b64_tr_b16 v[182:183], v245 offset:1024
    v_fmac_f32 v196, v58, v162
    v_fmac_f32 v196, v59, v163
    v_mfma_f32_32x32x16_bf16 v[16:31], v[64:67], v[192:195], v[16:31]
    v_fmac_f32 v196, v60, v164
    v_fmac_f32 v196, v61, v165
    v_fmac_f32 v196, v62, v166
    v_fmac_f32 v196, v63, v167
    s_nop 1
    v_permlane32_swap_b32 v198, v196
    v_add_f32 v196, v198, v196
    v_mfma_f32_32x32x16_bf16 v[32:47], v[68:71], v[192:195], v[32:47]
    v_add_u32 v249, s48, v249
    v_add_u32 v250, s49, v250
    ds_read_b32 v252, v251 offset:16
    ds_read_b64_tr_b16 v[72:73], v249 offset:0
    ds_read_b64_tr_b16 v[76:77], v249 offset:64
    ds_read_b64_tr_b16 v[74:75], v249 offset:256
    ds_read_b64_tr_b16 v[78:79], v249 offset:320
    s_mov_b64 exec, s[54:55]
    ds_read_u16_d16_hi v242, v250 offset:0
    s_mov_b64 exec, -1
    s_cbranch_vccnz LEPI_1
    v_mul_f32 v255, v16, v152
    v_fmac_f32 v255, v17, v153
    v_fmac_f32 v255, v18, v154
    v_fmac_f32 v255, v19, v155
    v_fmac_f32 v255, v20, v156
    v_fmac_f32 v255, v21, v157
    v_fmac_f32 v255, v22, v158
    v_fmac_f32 v255, v23, v159
    v_fma_f32 v203, v24, -v168, v203
    v_fma_f32 v203, v25, -v169, v203
    v_permlane32_swap_b32 v255, v201
    v_fma_f32 v203, v26, -v170, v203
    v_fma_f32 v203, v27, -v171, v203
    v_fma_f32 v203, v28, -v172, v203
    v_fma_f32 v203, v29, -v173, v203
    v_fma_f32 v203, v30, -v174, v203
    v_fma_f32 v203, v31, -v175, v203
    v_add_f32 v201, v255, v201
    v_fmac_f32 v199, v32, v120
    v_permlane32_swap_b32 v203, v255
    v_fmac_f32 v199, v33, v121
    v_fmac_f32 v199, v34, v122
    v_fmac_f32 v199, v35, v123
    v_fmac_f32 v199, v36, v124
    v_fmac_f32 v199, v37, v125
    v_fmac_f32 v199, v38, v126
    v_fmac_f32 v199, v39, v127
    v_add_f32 v255, v203, v255
    v_mul_f32 v197, v40, v168
    v_fmac_f32 v197, v41, v169
    v_fmac_f32 v197, v42, v170
    v_fmac_f32 v197, v43, v171
    v_fmac_f32 v197, v44, v172
    v_fmac_f32 v197, v45, v173
    v_fmac_f32 v197, v46, v174
    v_fmac_f32 v197, v47, v175
    s_nop 1
    v_permlane32_swap_b32 v199, v197
    v_add_f32 v197, v199, v197
    v_cvt_pk_bf16_f32 v200, v200, v201
    v_cvt_pk_bf16_f32 v254, v254, v255
    v_cvt_pk_bf16_f32 v196, v196, v197
    ds_write2st64_b32 v253, v200, v196 offset0:3 offset1:4
    s_mov_b64 exec, 0xffffffff
    ds_write_b32 v253, v254 offset:1280
    s_mov_b64 exec, -1
    s_add_u32 s50, s50, 1
    s_cmp_ge_u32 s50, 4
    s_cbranch_scc1 LAST1
    s_waitcnt lgkmcnt(7)
    v_readfirstlane_b32 s66, v252
    s_add_u32 s53, s53, 1
    v_mov_b32 v252, s53
    s_cmp_le_u32 s53, s66
    ds_write2_b32 v251, v252, v252 offset0:0 offset1:8
    s_setprio 1
    s_cbranch_scc1 PRIO_15
    s_setprio 0
PRIO_15:
    s_cmp_eq_u32 s52, 4
    s_cbranch_scc1 ITEM_1_4
    s_cmp_eq_u32 s52, 5
    s_cbranch_scc1 ITEM_1_5
    s_cmp_eq_u32 s52, 3
    s_cbranch_scc1 ITEM_1_3
    s_cmp_eq_u32 s52, 6
    s_cbranch_scc1 ITEM_1_6
    s_cmp_eq_u32 s52, 8
    s_cbranch_scc1 ITEM_1_8
    s_branch ITEM_1_2
WL_8_0:
    s_add_u32 s66, s51, 0
    buffer_load_dwordx4 v[96:99], v246, s[16:19], s66 offen offset:2048 sc1
    buffer_load_dwordx4 v[100:103], v246, s[16:19], s66 offen offset:3072 sc1
    s_branch WR_8_0
WL_8_1:
    s_add_u32 s66, s51, 4096
    buffer_load_dwordx4 v[104:107], v246, s[16:19], s66 offen offset:2048 sc1
    buffer_load_dwordx4 v[108:111], v246, s[16:19], s66 offen offset:3072 sc1
    s_branch WR_8_1
WL_8_2:
    s_add_u32 s66, s51, 8192
    buffer_load_dwordx4 v[128:131], v246, s[16:19], s66 offen offset:2048 sc1
    buffer_load_dwordx4 v[132:135], v246, s[16:19], s66 offen offset:3072 sc1
    s_branch WR_8_2
WL_8_3:
    s_add_u32 s66, s51, 12288
    buffer_load_dwordx4 v[136:139], v246, s[16:19], s66 offen offset:2048 sc1
    buffer_load_dwordx4 v[140:143], v246, s[16:19], s66 offen offset:3072 sc1
    s_branch WR_8_3
.p2align 6
ITEM_1_2:
    s_mov_b32 m0, s50
    s_nop 0
    s_movrels_b32 s71, s23
    s_movrels_b32 s33, s28
    v_add_u32 v253, s33, v248
    s_bfe_u32 s46, s71, 0x30012
    s_mov_b32 m0, s46
    s_and_b32 s66, s71, 0x3ffff
    s_movrels_b32 s68, s57
    s_movrels_b32 s69, s61
    s_sub_u32 s48, s66, s47
    s_mov_b32 s47, s66
    s_lshr_b32 s52, s71, 28
    s_lshl_b32 s67, s46, 9
    s_add_u32 s66, s66, s67
    s_sub_u32 s49, s66, s42
    s_mov_b32 s42, s66
    s_bfe_u32 s66, s68, 655360
    s_add_u32 s43, s42, s66
    s_bfe_u32 s39, s69, 655360
    s_bfe_u32 s66, s68, 655370
    s_add_u32 s44, s42, s66
    s_bfe_u32 s40, s69, 655370
    s_bfe_u32 s66, s68, 655380
    s_add_u32 s45, s42, s66
    s_bfe_u32 s41, s69, 655380
    v_add_u32 v252, s42, v247
    ds_read2_b32 v[234:235], v252 offset0:0 offset1:16
    v_add_u32 v252, s43, v247
    ds_read2_b32 v[236:237], v252 offset0:0 offset1:16
    v_add_u32 v252, s44, v247
    ds_read2_b32 v[238:239], v252 offset0:0 offset1:16
    v_add_u32 v252, s45, v247
    ds_read2_b32 v[240:241], v252 offset0:0 offset1:16
    s_waitcnt lgkmcnt(4)
    v_mul_f32_dpp v196, v242, v72 row_newbcast:0 row_mask:0xf bank_mask:0xf
    v_mul_f32_dpp v197, v242, v73 row_newbcast:1 row_mask:0xf bank_mask:0xf
    v_mul_f32_dpp v198, v242, v72 row_newbcast:8 row_mask:0xf bank_mask:0xf
    v_mul_f32_dpp v199, v242, v73 row_newbcast:9 row_mask:0xf bank_mask:0xf
    v_mul_f32_dpp v200, v242, v76 row_newbcast:2 row_mask:0xf bank_mask:0xf
    v_mul_f32_dpp v201, v242, v77 row_newbcast:3 row_mask:0xf bank_mask:0xf
    v_mul_f32_dpp v202, v242, v76 row_newbcast:10 row_mask:0xf bank_mask:0xf
    v_mul_f32_dpp v203, v242, v77 row_newbcast:11 row_mask:0xf bank_mask:0xf
    v_cvt_pk_bf16_f32 v72, v196, v197
    v_cvt_pk_bf16_f32 v76, v198, v199
    v_cvt_pk_bf16_f32 v73, v200, v201
    v_cvt_pk_bf16_f32 v77, v202, v203
    v_mul_f32_dpp v196, v242, v74 row_newbcast:4 row_mask:0xf bank_mask:0xf
    v_mul_f32_dpp v197, v242, v75 row_newbcast:5 row_mask:0xf bank_mask:0xf
    v_mul_f32_dpp v198, v242, v74 row_newbcast:12 row_mask:0xf bank_mask:0xf
    v_mul_f32_dpp v199, v242, v75 row_newbcast:13 row_mask:0xf bank_mask:0xf
    v_mul_f32_dpp v200, v242, v78 row_newbcast:6 row_mask:0xf bank_mask:0xf
    v_mul_f32_dpp v201, v242, v79 row_newbcast:7 row_mask:0xf bank_mask:0xf
    v_mul_f32_dpp v202, v242, v78 row_newbcast:14 row_mask:0xf bank_mask:0xf
    v_mul_f32_dpp v203, v242, v79 row_newbcast:15 row_mask:0xf bank_mask:0xf
    v_cvt_pk_bf16_f32 v74, v196, v197
    v_cvt_pk_bf16_f32 v78, v198, v199
    v_cvt_pk_bf16_f32 v75, v200, v201
    v_cvt_pk_bf16_f32 v79, v202, v203
    s_nop 0
    s_waitcnt lgkmcnt(3)
    v_mfma_f32_32x32x16_bf16 v[56:71], v[72:75], v[176:179], 0
    s_add_u32 m0, s21, 0
    v_mfma_f32_32x32x16_bf16 v[16:31], v[76:79], v[176:179], 0
    s_cbranch_vccnz WL_2_0
    v_mad_u32_u16 v234, v234, s3, v246 op_sel:[1,0,0,0]
    v_mad_u32_u16 v235, v235, s3, v246 op_sel:[1,0,0,0]
    buffer_load_dwordx4 v234, s[4:7], s38 offen  lds
    buffer_load_dwordx4 v235, s[8:11], s38 offen offset:1024  lds
WR_2_0:
    v_mfma_f32_32x32x16_bf16 v[32:47], v[72:75], v[180:183], 0
    s_nop 3
    v_mul_f32 v196, v56, v96
    v_fmac_f32 v196, v57, v97
    v_fmac_f32 v196, v58, v98
    v_fmac_f32 v196, v59, v99
    v_fmac_f32 v196, v60, v100
    v_fmac_f32 v196, v61, v101
    v_mfma_f32_32x32x16_bf16 v[0:15], v[76:79], v[180:183], 0
    s_waitcnt vmcnt(6)
    ds_read_b64_tr_b16 v[176:177], v244 offset:2048
    ds_read_b64_tr_b16 v[178:179], v244 offset:3072
    ds_read_b64_tr_b16 v[180:181], v245 offset:2048
    ds_read_b64_tr_b16 v[182:183], v245 offset:3072
    v_fmac_f32 v196, v62, v102
    v_fmac_f32 v196, v63, v103
    v_mul_f32 v198, v64, v128
    v_fmac_f32 v198, v65, v129
    v_fmac_f32 v198, v66, v130
    v_fmac_f32 v198, v67, v131
    v_fmac_f32 v198, v68, v132
    v_fmac_f32 v198, v69, v133
    v_fmac_f32 v198, v70, v134
    v_fmac_f32 v198, v71, v135
    v_mul_f32 v200, v16, v128
    v_fmac_f32 v200, v17, v129
    v_permlane32_swap_b32 v196, v198
    v_fmac_f32 v200, v18, v130
    v_fmac_f32 v200, v19, v131
    v_fmac_f32 v200, v20, v132
    v_fmac_f32 v200, v21, v133
    v_fmac_f32 v200, v22, v134
    v_fmac_f32 v200, v23, v135
    v_add_f32 v198, v196, v198
    v_mul_f32_e64 v202, v24, -v128
    v_fma_f32 v202, v25, -v129, v202
    v_fma_f32 v202, v26, -v130, v202
    v_fma_f32 v202, v27, -v131, v202
    v_fma_f32 v202, v28, -v132, v202
    v_fma_f32 v202, v29, -v133, v202
    v_fma_f32 v202, v30, -v134, v202
    v_fma_f32 v202, v31, -v135, v202
    s_nop 1
    v_permlane32_swap_b32 v200, v202
    v_add_f32 v202, v200, v202
    s_waitcnt lgkmcnt(0)
    v_mfma_f32_32x32x16_bf16 v[56:71], v[72:75], v[176:179], 0
    v_mul_f32 v197, v32, v104
    v_fmac_f32 v197, v33, v105
    v_fmac_f32 v197, v34, v106
    v_fmac_f32 v197, v35, v107
    v_fmac_f32 v197, v36, v108
    v_fmac_f32 v197, v37, v109
    s_add_u32 m0, s21, 2048
    v_mfma_f32_32x32x16_bf16 v[16:31], v[76:79], v[176:179], 0
    s_cbranch_vccnz WL_2_1
    v_mad_u32_u16 v236, v236, s3, v246 op_sel:[1,0,0,0]
    v_mad_u32_u16 v237, v237, s3, v246 op_sel:[1,0,0,0]
    buffer_load_dwordx4 v236, s[4:7], s39 offen  lds
    buffer_load_dwordx4 v237, s[8:11], s39 offen offset:1024  lds
WR_2_1:
    v_fmac_f32 v197, v38, v110
    v_fmac_f32 v197, v39, v111
    v_mul_f32 v199, v40, v136
    v_fmac_f32 v199, v41, v137
    v_fmac_f32 v199, v42, v138
    v_fmac_f32 v199, v43, v139
    v_fmac_f32 v199, v44, v140
    v_fmac_f32 v199, v45, v141
    v_fmac_f32 v199, v46, v142
    v_fmac_f32 v199, v47, v143
    v_mul_f32 v201, v0, v136
    v_fmac_f32 v201, v1, v137
    v_permlane32_swap_b32 v197, v199
    v_fmac_f32 v201, v2, v138
    v_fmac_f32 v201, v3, v139
    v_fmac_f32 v201, v4, v140
    v_fmac_f32 v201, v5, v141
    v_fmac_f32 v201, v6, v142
    v_fmac_f32 v201, v7, v143
    v_add_f32 v199, v197, v199
    v_mul_f32_e64 v203, v8, -v136
    v_fma_f32 v203, v9, -v137, v203
    v_fma_f32 v203, v10, -v138, v203
    v_fma_f32 v203, v11, -v139, v203
    v_fma_f32 v203, v12, -v140, v203
    v_fma_f32 v203, v13, -v141, v203
    v_fma_f32 v203, v14, -v142, v203
    v_fma_f32 v203, v15, -v143, v203
    s_nop 1
    v_permlane32_swap_b32 v201, v203
    v_add_f32 v203, v201, v203
    v_cvt_pk_bf16_f32 v192, v198, v199
    v_cvt_pk_bf16_f32 v193, v202, v203
    v_mfma_f32_32x32x16_bf16 v[32:47], v[72:75], v[180:183], 0
    v_mul_f32 v196, v56, v144
    v_fmac_f32 v196, v57, v145
    v_fmac_f32 v196, v58, v146
    v_fmac_f32 v196, v59, v147
    v_fmac_f32 v196, v60, v148
    v_fmac_f32 v196, v61, v149
    v_mfma_f32_32x32x16_bf16 v[0:15], v[76:79], v[180:183], 0
    s_waitcnt vmcnt(6)
    ds_read_b64_tr_b16 v[176:177], v244 offset:4096
    ds_read_b64_tr_b16 v[178:179], v244 offset:5120
    ds_read_b64_tr_b16 v[180:181], v245 offset:4096
    ds_read_b64_tr_b16 v[182:183], v245 offset:5120
    v_fmac_f32 v196, v62, v150
    v_fmac_f32 v196, v63, v151
    v_mul_f32_e64 v200, v16, -v160
    v_fma_f32 v200, v17, -v161, v200
    v_fma_f32 v200, v18, -v162, v200
    v_fma_f32 v200, v19, -v163, v200
    v_fma_f32 v200, v20, -v164, v200
    v_fma_f32 v200, v21, -v165, v200
    v_fma_f32 v200, v22, -v166, v200
    v_fma_f32 v200, v23, -v167, v200
    v_mul_f32_e64 v202, v24, -v160
    v_fma_f32 v202, v25, -v161, v202
    v_fma_f32 v202, v26, -v162, v202
    v_fma_f32 v202, v27, -v163, v202
    v_fma_f32 v202, v28, -v164, v202
    v_fma_f32 v202, v29, -v165, v202
    v_fma_f32 v202, v30, -v166, v202
    v_fma_f32 v202, v31, -v167, v202
    s_waitcnt lgkmcnt(0)
    v_mfma_f32_32x32x16_bf16 v[16:31], v[72:75], v[176:179], 0
    v_mul_f32 v197, v32, v152
    v_fmac_f32 v197, v33, v153
    v_fmac_f32 v197, v34, v154
    v_fmac_f32 v197, v35, v155
    v_fmac_f32 v197, v36, v156
    v_fmac_f32 v197, v37, v157
    s_add_u32 m0, s21, 4096
    v_mfma_f32_32x32x16_bf16 v[48:63], v[76:79], v[176:179], 0
    s_cbranch_vccnz WL_2_2
    v_mad_u32_u16 v238, v238, s3, v246 op_sel:[1,0,0,0]
    v_mad_u32_u16 v239, v239, s3, v246 op_sel:[1,0,0,0]
    buffer_load_dwordx4 v238, s[4:7], s40 offen  lds
    buffer_load_dwordx4 v239, s[8:11], s40 offen offset:1024  lds
WR_2_2:
    v_fmac_f32 v197, v38, v158
    v_fmac_f32 v197, v39, v159
    v_mul_f32_e64 v201, v0, -v168
    v_fma_f32 v201, v1, -v169, v201
    v_fma_f32 v201, v2, -v170, v201
    v_fma_f32 v201, v3, -v171, v201
    v_fma_f32 v201, v4, -v172, v201
    v_fma_f32 v201, v5, -v173, v201
    v_fma_f32 v201, v6, -v174, v201
    v_fma_f32 v201, v7, -v175, v201
    v_mul_f32_e64 v203, v8, -v168
    v_fma_f32 v203, v9, -v169, v203
    v_fma_f32 v203, v10, -v170, v203
    v_fma_f32 v203, v11, -v171, v203
    v_fma_f32 v203, v12, -v172, v203
    v_fma_f32 v203, v13, -v173, v203
    v_fma_f32 v203, v14, -v174, v203
    v_fma_f32 v203, v15, -v175, v203
    v_mfma_f32_32x32x16_bf16 v[0:15], v[72:75], v[180:183], 0
    v_fmac_f32 v200, v24, v160
    v_fmac_f32 v200, v25, v161
    v_fmac_f32 v200, v26, v162
    v_fmac_f32 v200, v27, v163
    v_fmac_f32 v200, v28, v164
    v_fmac_f32 v200, v29, v165
    v_fmac_f32 v200, v30, v166
    v_fmac_f32 v200, v31, v167
    v_mfma_f32_32x32x16_bf16 v[24:39], v[76:79], v[180:183], 0
    s_waitcnt vmcnt(6)
    ds_read_b64_tr_b16 v[176:177], v244 offset:6144
    ds_read_b64_tr_b16 v[178:179], v244 offset:7168
    ds_read_b64_tr_b16 v[180:181], v245 offset:6144
    ds_read_b64_tr_b16 v[182:183], v245 offset:7168
    v_mul_f32 v254, v16, v144
    v_fmac_f32 v254, v17, v145
    v_fmac_f32 v254, v18, v146
    v_fmac_f32 v254, v19, v147
    v_fmac_f32 v254, v20, v148
    v_fmac_f32 v254, v21, v149
    v_fmac_f32 v254, v22, v150
    v_fmac_f32 v254, v23, v151
    v_sub_f32_e64 v64, -v48, v64
    v_sub_f32_e64 v65, -v49, v65
    v_permlane32_swap_b32 v196, v254
    v_sub_f32_e64 v66, -v50, v66
    v_sub_f32_e64 v67, -v51, v67
    v_sub_f32_e64 v68, -v52, v68
    v_sub_f32_e64 v69, -v53, v69
    v_sub_f32_e64 v70, -v54, v70
    v_sub_f32_e64 v71, -v55, v71
    v_add_f32 v254, v196, v254
    s_waitcnt lgkmcnt(0)
    v_mfma_f32_32x32x16_bf16 v[56:71], v[76:79], v[176:179], v[56:71]
    v_sub_f32_e64 v40, -v24, v40
    v_sub_f32_e64 v41, -v25, v41
    v_sub_f32_e64 v42, -v26, v42
    v_sub_f32_e64 v43, -v27, v43
    v_sub_f32_e64 v44, -v28, v44
    v_sub_f32_e64 v45, -v29, v45
    v_sub_f32_e64 v46, -v30, v46
    v_sub_f32_e64 v47, -v31, v47
    s_add_u32 m0, s21, 6144
    v_mfma_f32_32x32x16_bf16 v[16:31], v[72:75], v[176:179], 0
    s_cbranch_vccnz WL_2_3
    v_mad_u32_u16 v240, v240, s3, v246 op_sel:[1,0,0,0]
    v_mad_u32_u16 v241, v241, s3, v246 op_sel:[1,0,0,0]
    buffer_load_dwordx4 v240, s[4:7], s41 offen  lds
    buffer_load_dwordx4 v241, s[8:11], s41 offen offset:1024  lds
WR_2_3:
    v_mul_f32 v255, v0, v152
    v_fmac_f32 v255, v1, v153
    v_fmac_f32 v255, v2, v154
    v_fmac_f32 v255, v3, v155
    v_fmac_f32 v255, v4, v156
    v_fmac_f32 v255, v5, v157
    v_fmac_f32 v255, v6, v158
    v_fmac_f32 v255, v7, v159
    v_fmac_f32 v201, v8, v168
    v_fmac_f32 v201, v9, v169
    v_permlane32_swap_b32 v197, v255
    v_fmac_f32 v201, v10, v170
    v_fmac_f32 v201, v11, v171
    v_fmac_f32 v201, v12, v172
    v_fmac_f32 v201, v13, v173
    v_fmac_f32 v201, v14, v174
    v_fmac_f32 v201, v15, v175
    v_add_f32 v255, v197, v255
    v_cvt_pk_bf16_f32 v194, v254, v255
    v_mfma_f32_32x32x16_bf16 v[0:15], v[72:75], v[180:183], 0
    v_mul_f32 v254, v16, v144
    v_fmac_f32 v254, v17, v145
    v_fmac_f32 v254, v18, v146
    v_fmac_f32 v254, v19, v147
    v_fmac_f32 v254, v20, v148
    v_fmac_f32 v254, v21, v149
    v_mfma_f32_32x32x16_bf16 v[32:47], v[76:79], v[180:183], v[32:47]
    s_waitcnt vmcnt(6)
    ds_read_b64_tr_b16 v[176:177], v244 offset:0
    ds_read_b64_tr_b16 v[178:179], v244 offset:1024
    ds_read_b64_tr_b16 v[180:181], v245 offset:0
    ds_read_b64_tr_b16 v[182:183], v245 offset:1024
    v_add_u32 v249, s48, v249
    v_add_u32 v250, s49, v250
    ds_read_b32 v252, v251 offset:16
    ds_read_b64_tr_b16 v[72:73], v249 offset:0
    ds_read_b64_tr_b16 v[76:77], v249 offset:64
    ds_read_b64_tr_b16 v[74:75], v249 offset:256
    ds_read_b64_tr_b16 v[78:79], v249 offset:320
    s_mov_b64 exec, s[54:55]
    ds_read_u16_d16_hi v242, v250 offset:0
    s_mov_b64 exec, -1
    v_fmac_f32 v254, v22, v150
    v_fmac_f32 v254, v23, v151
    v_fma_f32 v202, v24, -v160, v202
    v_fma_f32 v202, v25, -v161, v202
    v_permlane32_swap_b32 v254, v200
    v_fma_f32 v202, v26, -v162, v202
    v_fma_f32 v202, v27, -v163, v202
    v_fma_f32 v202, v28, -v164, v202
    v_fma_f32 v202, v29, -v165, v202
    v_fma_f32 v202, v30, -v166, v202
    v_fma_f32 v202, v31, -v167, v202
    v_add_f32 v200, v254, v200
    v_mul_f32_e64 v198, v64, -v112
    v_permlane32_swap_b32 v202, v254
    v_fma_f32 v198, v65, -v113, v198
    v_fma_f32 v198, v66, -v114, v198
    v_fma_f32 v198, v67, -v115, v198
    v_fma_f32 v198, v68, -v116, v198
    v_fma_f32 v198, v69, -v117, v198
    v_fma_f32 v198, v70, -v118, v198
    v_fma_f32 v198, v71, -v119, v198
    v_add_f32 v254, v202, v254
    v_mul_f32 v196, v56, v160
    v_fmac_f32 v196, v57, v161
    v_fmac_f32 v196, v58, v162
    v_fmac_f32 v196, v59, v163
    v_fmac_f32 v196, v60, v164
    v_fmac_f32 v196, v61, v165
    v_fmac_f32 v196, v62, v166
    v_fmac_f32 v196, v63, v167
    s_nop 1
    v_permlane32_swap_b32 v198, v196
    v_add_f32 v196, v198, v196
    s_cbranch_vccnz LEPI_2
    v_mul_f32 v255, v0, v152
    v_fmac_f32 v255, v1, v153
    v_fmac_f32 v255, v2, v154
    v_fmac_f32 v255, v3, v155
    v_fmac_f32 v255, v4, v156
    v_fmac_f32 v255, v5, v157
    v_fmac_f32 v255, v6, v158
    v_fmac_f32 v255, v7, v159
    v_fma_f32 v203, v8, -v168, v203
    v_fma_f32 v203, v9, -v169, v203
    v_permlane32_swap_b32 v255, v201
    v_fma_f32 v203, v10, -v170, v203
    v_fma_f32 v203, v11, -v171, v203
    v_fma_f32 v203, v12, -v172, v203
    v_fma_f32 v203, v13, -v173, v203
    v_fma_f32 v203, v14, -v174, v203
    v_fma_f32 v203, v15, -v175, v203
    v_add_f32 v201, v255, v201
    v_mul_f32_e64 v199, v40, -v120
    v_permlane32_swap_b32 v203, v255
    v_fma_f32 v199, v41, -v121, v199
    v_fma_f32 v199, v42, -v122, v199
    v_fma_f32 v199, v43, -v123, v199
    v_fma_f32 v199, v44, -v124, v199
    v_fma_f32 v199, v45, -v125, v199
    v_fma_f32 v199, v46, -v126, v199
    v_fma_f32 v199, v47, -v127, v199
    v_add_f32 v255, v203, v255
    v_mul_f32 v197, v32, v168
    v_fmac_f32 v197, v33, v169
    v_fmac_f32 v197, v34, v170
    v_fmac_f32 v197, v35, v171
    v_fmac_f32 v197, v36, v172
    v_fmac_f32 v197, v37, v173
    v_fmac_f32 v197, v38, v174
    v_fmac_f32 v197, v39, v175
    s_nop 1
    v_permlane32_swap_b32 v199, v197
    v_add_f32 v197, v199, v197
    v_cvt_pk_bf16_f32 v200, v200, v201
    v_cvt_pk_bf16_f32 v254, v254, v255
    v_cvt_pk_bf16_f32 v196, v196, v197
    ds_write2st64_b32 v253, v192, v193 offset0:0 offset1:1
    ds_write2st64_b32 v253, v194, v200 offset0:2 offset1:3
    ds_write_b32 v253, v196 offset:1024
    s_mov_b64 exec, 0xffffffff
    ds_write_b32 v253, v254 offset:1280
    s_mov_b64 exec, -1
    s_add_u32 s50, s50, 1
    s_cmp_ge_u32 s50, 4
    s_cbranch_scc1 LAST1
    s_waitcnt lgkmcnt(9)
    v_readfirstlane_b32 s66, v252
    s_add_u32 s53, s53, 1
    v_mov_b32 v252, s53
    s_cmp_le_u32 s53, s66
    ds_write2_b32 v251, v252, v252 offset0:0 offset1:8
    s_setprio 1
    s_cbranch_scc1 PRIO_16
    s_setprio 0
PRIO_16:
    s_cmp_eq_u32 s52, 4
    s_cbranch_scc1 ITEM_1_4
    s_cmp_eq_u32 s52, 5
    s_cbranch_scc1 ITEM_1_5
    s_cmp_eq_u32 s52, 3
    s_cbranch_scc1 ITEM_1_3
    s_cmp_eq_u32 s52, 6
    s_cbranch_scc1 ITEM_1_6
    s_cmp_eq_u32 s52, 8
    s_cbranch_scc1 ITEM_1_8
    s_branch ITEM_1_2
WL_2_0:
    s_add_u32 s66, s51, 0
    buffer_load_dword v195, v246, s[16:19], s66 offen
    buffer_load_dword v195, v246, s[16:19], s66 offen
    s_branch WR_2_0
WL_2_1:
    s_add_u32 s66, s51, 4096
    buffer_load_dword v195, v246, s[16:19], s66 offen
    buffer_load_dword v195, v246, s[16:19], s66 offen
    s_branch WR_2_1
WL_2_2:
    s_add_u32 s66, s51, 8192
    buffer_load_dword v195, v246, s[16:19], s66 offen
    buffer_load_dword v195, v246, s[16:19], s66 offen
    s_branch WR_2_2
WL_2_3:
    s_add_u32 s66, s51, 12288
    buffer_load_dword v195, v246, s[16:19], s66 offen
    buffer_load_dword v195, v246, s[16:19], s66 offen
    s_branch WR_2_3
.p2align 6
.p2align 6
LEPI_2:
    s_lshl_b32 s71, s20, 4
    s_add_u32 s67, s51, 4096
    s_add_u32 s68, s51, 8192
    s_add_u32 s69, s51, 12288
    s_add_u32 s70, s51, 16384
    s_waitcnt lgkmcnt(0)
    buffer_load_dwordx4 v[96:99], v246, s[16:19], s51 offen offset:2048 sc1
    s_mov_b32 s52, 163072
    v_bfe_u32 v177, v246, 4, 4
    v_bfe_u32 v179, v246, 4, 3
    v_lshl_add_u32 v180, v177, 3, s52
    v_lshl_add_u32 v190, v177, 4, s52
    v_lshl_add_u32 v181, v179, 3, s52
    ds_read2_b64 v[182:185], v180 offset0:32 offset1:48
    ds_read_b32 v191, v190
    ds_read_b64 v[186:187], v181 offset:512
    v_lshrrev_b32 v178, 8, v246
    buffer_load_dwordx4 v[100:103], v246, s[16:19], s51 offen offset:3072 sc1
    v_add_u32 v234, s21, v248
    v_add_u32 v235, 128, v234
    v_mul_f32 v255, v0, v152
    buffer_load_dwordx4 v[104:107], v246, s[16:19], s67 offen offset:2048 sc1
    v_fmac_f32 v255, v1, v153
    v_fmac_f32 v255, v2, v154
    ds_write2st64_b32 v234, v204, v205 offset0:0 offset1:1
    v_fmac_f32 v255, v3, v155
    buffer_load_dwordx4 v[108:111], v246, s[16:19], s67 offen offset:3072 sc1
    v_fmac_f32 v255, v4, v156
    v_fmac_f32 v255, v5, v157
    ds_write2st64_b32 v234, v206, v207 offset0:2 offset1:3
    v_fmac_f32 v255, v6, v158
    buffer_load_dwordx4 v[128:131], v246, s[16:19], s68 offen offset:2048 sc1
    v_fmac_f32 v255, v7, v159
    v_fma_f32 v203, v8, -v168, v203
    ds_write2st64_b32 v234, v208, v209 offset0:4 offset1:5
    v_fma_f32 v203, v9, -v169, v203
    buffer_load_dwordx4 v[132:135], v246, s[16:19], s68 offen offset:3072 sc1
    v_permlane32_swap_b32 v255, v201
    v_fma_f32 v203, v10, -v170, v203
    ds_write2st64_b32 v235, v210, v211 offset0:6 offset1:7
    v_fma_f32 v203, v11, -v171, v203
    v_fma_f32 v203, v12, -v172, v203
    buffer_load_dwordx4 v[136:139], v246, s[16:19], s69 offen offset:2048 sc1
    v_fma_f32 v203, v13, -v173, v203
    ds_write2st64_b32 v235, v212, v213 offset0:8 offset1:9
    v_fma_f32 v203, v14, -v174, v203
    v_fma_f32 v203, v15, -v175, v203
    buffer_load_dwordx4 v[140:143], v246, s[16:19], s69 offen offset:3072 sc1
    v_add_f32 v201, v255, v201
    ds_write2st64_b32 v235, v214, v215 offset0:10 offset1:11
    v_mul_f32_e64 v199, v40, -v120
    v_permlane32_swap_b32 v203, v255
    buffer_load_dwordx4 v[112:115], v246, s[16:19], s70 offen offset:2048 sc1
    v_fma_f32 v199, v41, -v121, v199
    ds_write2st64_b32 v234, v216, v217 offset0:12 offset1:13
    v_fma_f32 v199, v42, -v122, v199
    v_fma_f32 v199, v43, -v123, v199
    buffer_load_dwordx4 v[116:119], v246, s[16:19], s70 offen offset:3072 sc1
    v_fma_f32 v199, v44, -v124, v199
    ds_write2st64_b32 v234, v218, v219 offset0:14 offset1:15
    v_fma_f32 v199, v45, -v125, v199
    v_fma_f32 v199, v46, -v126, v199
    buffer_load_dwordx4 v[144:147], v246, s[16:19], s51 offen offset:0 sc1
    v_fma_f32 v199, v47, -v127, v199
    v_add_f32 v255, v203, v255
    ds_write2st64_b32 v234, v220, v221 offset0:16 offset1:17
    v_mul_f32 v197, v32, v168
    buffer_load_dwordx4 v[148:151], v246, s[16:19], s51 offen offset:1024 sc1
    v_fmac_f32 v197, v33, v169
    v_fmac_f32 v197, v34, v170
    ds_write2st64_b32 v235, v222, v223 offset0:18 offset1:19
    v_fmac_f32 v197, v35, v171
    buffer_load_dwordx4 v[160:163], v246, s[16:19], s67 offen offset:0 sc1
    v_fmac_f32 v197, v36, v172
    v_fmac_f32 v197, v37, v173
    ds_write2st64_b32 v235, v224, v225 offset0:20 offset1:21
    v_fmac_f32 v197, v38, v174
    buffer_load_dwordx4 v[164:167], v246, s[16:19], s67 offen offset:1024 sc1
    v_fmac_f32 v197, v39, v175
    s_nop 1
    ds_write2st64_b32 v235, v226, v227 offset0:22 offset1:23
    v_permlane32_swap_b32 v199, v197
    ds_write2st64_b32 v234, v228, v229 offset0:24 offset1:25
    v_add_f32 v197, v199, v197
    v_cvt_pk_bf16_f32 v200, v200, v201
    ds_write2st64_b32 v234, v230, v231 offset0:26 offset1:27
    v_cvt_pk_bf16_f32 v254, v254, v255
    v_cvt_pk_bf16_f32 v196, v196, v197
    ds_write2st64_b32 v234, v232, v233 offset0:28 offset1:29
    ds_write2st64_b32 v253, v192, v193 offset0:0 offset1:1
    ds_write2st64_b32 v253, v194, v200 offset0:2 offset1:3
    ds_write_b32 v253, v196 offset:1024
    s_mov_b64 exec, 0xffffffff
    ds_write_b32 v253, v254 offset:1280
    s_mov_b64 exec, -1
    s_add_u32 s50, s53, 1
    v_mov_b32 v234, s50
    ds_write2_b32 v251, v234, v234 offset0:0 offset1:8
    s_waitcnt lgkmcnt(15)
    s_branch TAIL
.p2align 6
LEPI_1:
    s_lshl_b32 s71, s20, 4
    s_add_u32 s67, s51, 4096
    s_add_u32 s68, s51, 8192
    s_add_u32 s69, s51, 12288
    s_add_u32 s70, s51, 16384
    s_waitcnt lgkmcnt(0)
    buffer_load_dwordx4 v[112:115], v246, s[16:19], s70 offen offset:2048 sc1
    s_mov_b32 s52, 163072
    v_bfe_u32 v177, v246, 4, 4
    v_bfe_u32 v179, v246, 4, 3
    v_lshl_add_u32 v180, v177, 3, s52
    v_lshl_add_u32 v190, v177, 4, s52
    v_lshl_add_u32 v181, v179, 3, s52
    ds_read2_b64 v[182:185], v180 offset0:32 offset1:48
    ds_read_b32 v191, v190
    ds_read_b64 v[186:187], v181 offset:512
    v_lshrrev_b32 v178, 8, v246
    buffer_load_dwordx4 v[116:119], v246, s[16:19], s70 offen offset:3072 sc1
    v_add_u32 v234, s21, v248
    v_add_u32 v235, 128, v234
    v_mul_f32 v255, v16, v152
    v_fmac_f32 v255, v17, v153
    buffer_load_dwordx4 v[144:147], v246, s[16:19], s51 offen offset:0 sc1
    v_fmac_f32 v255, v18, v154
    v_fmac_f32 v255, v19, v155
    ds_write2st64_b32 v234, v204, v205 offset0:0 offset1:1
    v_fmac_f32 v255, v20, v156
    v_fmac_f32 v255, v21, v157
    buffer_load_dwordx4 v[148:151], v246, s[16:19], s51 offen offset:1024 sc1
    v_fmac_f32 v255, v22, v158
    v_fmac_f32 v255, v23, v159
    ds_write2st64_b32 v234, v206, v207 offset0:2 offset1:3
    v_fma_f32 v203, v24, -v168, v203
    v_fma_f32 v203, v25, -v169, v203
    v_permlane32_swap_b32 v255, v201
    buffer_load_dwordx4 v[160:163], v246, s[16:19], s67 offen offset:0 sc1
    v_fma_f32 v203, v26, -v170, v203
    v_fma_f32 v203, v27, -v171, v203
    ds_write2st64_b32 v234, v208, v209 offset0:4 offset1:5
    v_fma_f32 v203, v28, -v172, v203
    v_fma_f32 v203, v29, -v173, v203
    buffer_load_dwordx4 v[164:167], v246, s[16:19], s67 offen offset:1024 sc1
    v_fma_f32 v203, v30, -v174, v203
    v_fma_f32 v203, v31, -v175, v203
    ds_write2st64_b32 v235, v210, v211 offset0:6 offset1:7
    v_add_f32 v201, v255, v201
    v_fmac_f32 v199, v32, v120
    ds_write2st64_b32 v235, v212, v213 offset0:8 offset1:9
    v_permlane32_swap_b32 v203, v255
    v_fmac_f32 v199, v33, v121
    v_fmac_f32 v199, v34, v122
    ds_write2st64_b32 v235, v214, v215 offset0:10 offset1:11
    v_fmac_f32 v199, v35, v123
    v_fmac_f32 v199, v36, v124
    ds_write2st64_b32 v234, v216, v217 offset0:12 offset1:13
    v_fmac_f32 v199, v37, v125
    v_fmac_f32 v199, v38, v126
    ds_write2st64_b32 v234, v218, v219 offset0:14 offset1:15
    v_fmac_f32 v199, v39, v127
    v_add_f32 v255, v203, v255
    ds_write2st64_b32 v234, v220, v221 offset0:16 offset1:17
    v_mul_f32 v197, v40, v168
    v_fmac_f32 v197, v41, v169
    ds_write2st64_b32 v235, v222, v223 offset0:18 offset1:19
    v_fmac_f32 v197, v42, v170
    v_fmac_f32 v197, v43, v171
    v_fmac_f32 v197, v44, v172
    ds_write2st64_b32 v235, v224, v225 offset0:20 offset1:21
    v_fmac_f32 v197, v45, v173
    v_fmac_f32 v197, v46, v174
    ds_write2st64_b32 v235, v226, v227 offset0:22 offset1:23
    v_fmac_f32 v197, v47, v175
    s_nop 1
    ds_write2st64_b32 v234, v228, v229 offset0:24 offset1:25
    v_permlane32_swap_b32 v199, v197
    v_add_f32 v197, v199, v197
    ds_write2st64_b32 v234, v230, v231 offset0:26 offset1:27
    v_cvt_pk_bf16_f32 v200, v200, v201
    v_cvt_pk_bf16_f32 v254, v254, v255
    v_cvt_pk_bf16_f32 v196, v196, v197
    ds_write2st64_b32 v234, v232, v233 offset0:28 offset1:29
    ds_write2st64_b32 v253, v200, v196 offset0:3 offset1:4
    s_mov_b64 exec, 0xffffffff
    ds_write_b32 v253, v254 offset:1280
    s_mov_b64 exec, -1
    s_add_u32 s50, s53, 1
    v_mov_b32 v234, s50
    ds_write2_b32 v251, v234, v234 offset0:0 offset1:8
    s_waitcnt lgkmcnt(15)
    s_branch TAIL
.p2align 6
LEPI_0:
    s_lshl_b32 s71, s20, 4
    s_add_u32 s67, s51, 4096
    s_add_u32 s68, s51, 8192
    s_add_u32 s69, s51, 12288
    s_add_u32 s70, s51, 16384
    s_waitcnt lgkmcnt(0)
    buffer_load_dwordx4 v[112:115], v246, s[16:19], s70 offen offset:2048 sc1
    s_mov_b32 s52, 163072
    v_bfe_u32 v177, v246, 4, 4
    v_bfe_u32 v179, v246, 4, 3
    v_lshl_add_u32 v180, v177, 3, s52
    v_lshl_add_u32 v190, v177, 4, s52
    v_lshl_add_u32 v181, v179, 3, s52
    ds_read2_b64 v[182:185], v180 offset0:32 offset1:48
    ds_read_b32 v191, v190
    ds_read_b64 v[186:187], v181 offset:512
    v_lshrrev_b32 v178, 8, v246
    buffer_load_dwordx4 v[116:119], v246, s[16:19], s70 offen offset:3072 sc1
    v_add_u32 v234, s21, v248
    v_add_u32 v235, 128, v234
    v_mul_f32 v255, v0, v152
    v_fmac_f32 v255, v1, v153
    buffer_load_dwordx4 v[144:147], v246, s[16:19], s51 offen offset:0 sc1
    v_fmac_f32 v255, v2, v154
    v_fmac_f32 v255, v3, v155
    ds_write2st64_b32 v234, v204, v205 offset0:0 offset1:1
    v_fmac_f32 v255, v4, v156
    v_fmac_f32 v255, v5, v157
    buffer_load_dwordx4 v[148:151], v246, s[16:19], s51 offen offset:1024 sc1
    v_fmac_f32 v255, v6, v158
    v_fmac_f32 v255, v7, v159
    ds_write2st64_b32 v234, v206, v207 offset0:2 offset1:3
    v_fma_f32 v203, v8, -v168, v203
    v_fma_f32 v203, v9, -v169, v203
    v_permlane32_swap_b32 v255, v201
    buffer_load_dwordx4 v[160:163], v246, s[16:19], s67 offen offset:0 sc1
    v_fma_f32 v203, v10, -v170, v203
    v_fma_f32 v203, v11, -v171, v203
    ds_write2st64_b32 v234, v208, v209 offset0:4 offset1:5
    v_fma_f32 v203, v12, -v172, v203
    v_fma_f32 v203, v13, -v173, v203
    buffer_load_dwordx4 v[164:167], v246, s[16:19], s67 offen offset:1024 sc1
    v_fma_f32 v203, v14, -v174, v203
    v_fma_f32 v203, v15, -v175, v203
    ds_write2st64_b32 v235, v210, v211 offset0:6 offset1:7
    v_add_f32 v201, v255, v201
    v_mul_f32_e64 v199, v40, -v120
    ds_write2st64_b32 v235, v212, v213 offset0:8 offset1:9
    v_permlane32_swap_b32 v203, v255
    v_fma_f32 v199, v41, -v121, v199
    v_fma_f32 v199, v42, -v122, v199
    ds_write2st64_b32 v235, v214, v215 offset0:10 offset1:11
    v_fma_f32 v199, v43, -v123, v199
    v_fma_f32 v199, v44, -v124, v199
    ds_write2st64_b32 v234, v216, v217 offset0:12 offset1:13
    v_fma_f32 v199, v45, -v125, v199
    v_fma_f32 v199, v46, -v126, v199
    ds_write2st64_b32 v234, v218, v219 offset0:14 offset1:15
    v_fma_f32 v199, v47, -v127, v199
    v_add_f32 v255, v203, v255
    ds_write2st64_b32 v234, v220, v221 offset0:16 offset1:17
    v_mul_f32 v197, v32, v168
    v_fmac_f32 v197, v33, v169
    ds_write2st64_b32 v235, v222, v223 offset0:18 offset1:19
    v_fmac_f32 v197, v34, v170
    v_fmac_f32 v197, v35, v171
    v_fmac_f32 v197, v36, v172
    ds_write2st64_b32 v235, v224, v225 offset0:20 offset1:21
    v_fmac_f32 v197, v37, v173
    v_fmac_f32 v197, v38, v174
    ds_write2st64_b32 v235, v226, v227 offset0:22 offset1:23
    v_fmac_f32 v197, v39, v175
    s_nop 1
    ds_write2st64_b32 v234, v228, v229 offset0:24 offset1:25
    v_permlane32_swap_b32 v199, v197
    v_add_f32 v197, v199, v197
    ds_write2st64_b32 v234, v230, v231 offset0:26 offset1:27
    v_cvt_pk_bf16_f32 v200, v200, v201
    v_cvt_pk_bf16_f32 v254, v254, v255
    v_cvt_pk_bf16_f32 v196, v196, v197
    ds_write2st64_b32 v234, v232, v233 offset0:28 offset1:29
    ds_write2st64_b32 v253, v192, v193 offset0:0 offset1:1
    ds_write2st64_b32 v253, v194, v200 offset0:2 offset1:3
    ds_write_b32 v253, v196 offset:1024
    s_mov_b64 exec, 0xffffffff
    ds_write_b32 v253, v254 offset:1280
    s_mov_b64 exec, -1
    s_add_u32 s50, s53, 1
    v_mov_b32 v234, s50
    ds_write2_b32 v251, v234, v234 offset0:0 offset1:8
    s_waitcnt lgkmcnt(15)
TAIL:
    s_and_b32 s71, s20, 3
    s_lshl_b32 s71, s71, 2
    s_bitcmp0_b32 s20, 2
    s_addc_u32 s71, s71, 0
    v_readlane_b32 s71, v191, s71
    buffer_load_dwordx4 v[120:123], v246, s[16:19], s68 offen offset:0 sc1
    buffer_load_dwordx4 v[124:127], v246, s[16:19], s68 offen offset:1024 sc1
    s_cmp_ge_u32 s71, s50
    s_setprio 1
    s_cbranch_scc1 T_second
    s_setprio 0
T_second:
    buffer_load_dwordx4 v[152:155], v246, s[16:19], s69 offen offset:0 sc1
    buffer_load_dwordx4 v[156:159], v246, s[16:19], s69 offen offset:1024 sc1
    buffer_load_dwordx4 v[168:171], v246, s[16:19], s70 offen offset:0 sc1
    buffer_load_dwordx4 v[172:175], v246, s[16:19], s70 offen offset:1024 sc1
GEMM:
    v_cmp_gt_u32 vcc, s53, v191
    v_xor_b32 v180, v179, v178
    v_xor_b32 v188, 4, v180
    v_lshl_add_u32 v66, v180, 4, v183
    v_lshl_add_u32 v67, v188, 4, v183
    v_lshl_add_u32 v70, v180, 4, v185
    v_lshl_add_u32 v71, v188, 4, v185
    s_mov_b32 s4, s72
    s_and_b32 s5, s73, 0xffff
    s_mov_b32 s6, 10240000
    s_mov_b32 s7, 0x20000
    s_cbranch_vccnz T_pw
T_pwr:
    ds_read_b128 v[76:79], v66 offset:0
    ds_read_b128 v[80:83], v70 offset:0
    ds_read_b128 v[84:87], v67 offset:0
    ds_read_b128 v[88:91], v71 offset:0
    ds_read_b128 v[92:95], v66 offset:1024
    s_waitcnt vmcnt(19) lgkmcnt(4)
    v_mfma_f32_16x16x32_bf16 v[0:3], v[96:99], v[76:79], 0
    v_and_b32 v181, 8, v177
    v_add_u32 v189, v188, v181
    ds_read_b128 v[76:79], v70 offset:1024
    s_waitcnt lgkmcnt(4)
    v_mfma_f32_16x16x32_bf16 v[4:7], v[96:99], v[80:83], 0
    v_add_u32 v181, v180, v181
    v_lshl_add_u32 v64, v180, 4, v182
    ds_read_b128 v[80:83], v67 offset:1024
    s_waitcnt vmcnt(18) lgkmcnt(4)
    v_mfma_f32_16x16x32_bf16 v[0:3], v[100:103], v[84:87], v[0:3]
    v_lshl_add_u32 v65, v188, 4, v182
    v_lshl_add_u32 v68, v180, 4, v184
    ds_read_b128 v[84:87], v71 offset:1024
    s_waitcnt lgkmcnt(4)
    v_mfma_f32_16x16x32_bf16 v[4:7], v[100:103], v[88:91], v[4:7]
    v_lshl_add_u32 v69, v188, 4, v184
    v_lshl_add_u32 v72, v181, 4, v186
    ds_read_b128 v[88:91], v66 offset:128
    s_waitcnt vmcnt(17) lgkmcnt(4)
    v_mfma_f32_16x16x32_bf16 v[0:3], v[104:107], v[92:95], v[0:3]
    v_lshl_add_u32 v73, v189, 4, v186
    v_lshl_add_u32 v74, v181, 4, v187
    ds_read_b128 v[92:95], v66 offset:256
    s_waitcnt lgkmcnt(4)
    v_mfma_f32_16x16x32_bf16 v[4:7], v[104:107], v[76:79], v[4:7]
    v_lshl_add_u32 v75, v189, 4, v187
    s_mov_b32 s67, 0xbfb8aa3b
    ds_read_b128 v[76:79], v66 offset:384
    s_waitcnt vmcnt(16) lgkmcnt(4)
    v_mfma_f32_16x16x32_bf16 v[0:3], v[108:111], v[80:83], v[0:3]
    v_lshrrev_b32 v205, 1, v178
    v_lshl_add_u32 v205, s20, 1, v205
    ds_read_b128 v[80:83], v70 offset:128
    s_waitcnt lgkmcnt(4)
    v_mfma_f32_16x16x32_bf16 v[4:7], v[108:111], v[84:87], v[4:7]
    v_xor_b32 v205, v205, v179
    v_and_b32 v204, 1, v178
    ds_read_b128 v[84:87], v70 offset:256
    s_waitcnt vmcnt(15) lgkmcnt(4)
    v_mfma_f32_16x16x32_bf16 v[12:15], v[128:131], v[88:91], 0
    v_lshlrev_b32 v204, 3, v204
    v_lshl_add_u32 v205, v205, 4, v204
    ds_read_b128 v[88:91], v70 offset:384
    s_waitcnt lgkmcnt(4)
    v_mfma_f32_16x16x32_bf16 v[24:27], v[128:131], v[92:95], 0
    v_and_b32 v220, 8, v177
    v_lshl_add_u32 v204, v220, 4, v205
    ds_read_b128 v[92:95], v67 offset:128
    s_waitcnt lgkmcnt(4)
    v_mfma_f32_16x16x32_bf16 v[36:39], v[128:131], v[76:79], 0
    v_lshl_add_u32 v204, v177, 10, v204
    v_add_u32 v204, 65536, v204
    ds_read_b128 v[76:79], v67 offset:256
    s_waitcnt lgkmcnt(4)
    v_mfma_f32_16x16x32_bf16 v[16:19], v[128:131], v[80:83], 0
    v_add_u32 v205, v205, v182
    v_mul_u32_u24 v220, 1008, v220
    ds_read_b128 v[80:83], v67 offset:384
    s_waitcnt lgkmcnt(4)
    v_mfma_f32_16x16x32_bf16 v[28:31], v[128:131], v[84:87], 0
    v_sub_u32 v220, v204, v220
    s_lshl_b32 s70, s20, 4
    ds_read_b128 v[84:87], v71 offset:128
    s_waitcnt lgkmcnt(4)
    v_mfma_f32_16x16x32_bf16 v[40:43], v[128:131], v[88:91], 0
    v_xor_b32 v206, s70, v246
    s_lshl_b32 s70, s20, 10
    ds_read_b128 v[88:91], v71 offset:256
    s_waitcnt vmcnt(14) lgkmcnt(4)
    v_mfma_f32_16x16x32_bf16 v[12:15], v[132:135], v[92:95], v[12:15]
    s_add_u32 s70, s70, 65536
    v_add_u32 v207, s21, v206
    ds_read_b128 v[92:95], v71 offset:384
    s_waitcnt lgkmcnt(4)
    v_mfma_f32_16x16x32_bf16 v[24:27], v[132:135], v[76:79], v[24:27]
    v_add_u32 v206, s70, v206
    s_mul_i32 s66, s2, 40960
    ds_read_b128 v[76:79], v66 offset:512
    s_waitcnt lgkmcnt(4)
    v_mfma_f32_16x16x32_bf16 v[36:39], v[132:135], v[80:83], v[36:39]
    s_bfe_u32 s22, s22, 393237
    s_lshl_b32 s22, s22, 10
    ds_read_b128 v[80:83], v66 offset:640
    s_waitcnt lgkmcnt(4)
    v_mfma_f32_16x16x32_bf16 v[16:19], v[132:135], v[84:87], v[16:19]
    s_add_u32 s22, s22, s66
    s_bfe_u32 s23, s23, 393237
    ds_read_b128 v[84:87], v66 offset:768
    s_waitcnt lgkmcnt(4)
    v_mfma_f32_16x16x32_bf16 v[28:31], v[132:135], v[88:91], v[28:31]
    s_lshl_b32 s23, s23, 10
    s_add_u32 s23, s23, s66
    ds_read_b128 v[88:91], v70 offset:512
    s_waitcnt lgkmcnt(4)
    v_mfma_f32_16x16x32_bf16 v[40:43], v[132:135], v[92:95], v[40:43]
    s_bfe_u32 s24, s24, 393237
    s_lshl_b32 s24, s24, 10
    ds_read_b128 v[92:95], v70 offset:640
    s_waitcnt vmcnt(13) lgkmcnt(4)
    v_mfma_f32_16x16x32_bf16 v[12:15], v[136:139], v[76:79], v[12:15]
    s_add_u32 s24, s24, s66
    s_bfe_u32 s25, s25, 393237
    ds_read_b128 v[76:79], v70 offset:768
    s_waitcnt lgkmcnt(4)
    v_mfma_f32_16x16x32_bf16 v[24:27], v[136:139], v[80:83], v[24:27]
    s_lshl_b32 s25, s25, 10
    s_add_u32 s25, s25, s66
    ds_read_b128 v[80:83], v67 offset:512
    s_waitcnt lgkmcnt(4)
    v_mfma_f32_16x16x32_bf16 v[36:39], v[136:139], v[84:87], v[36:39]
    s_bfe_u32 s26, s26, 393237
    s_lshl_b32 s26, s26, 10
    ds_read_b128 v[84:87], v67 offset:640
    s_waitcnt lgkmcnt(4)
    v_mfma_f32_16x16x32_bf16 v[16:19], v[136:139], v[88:91], v[16:19]
    s_add_u32 s26, s26, s66
    ds_read_b128 v[88:91], v67 offset:768
    s_waitcnt lgkmcnt(4)
    v_mfma_f32_16x16x32_bf16 v[28:31], v[136:139], v[92:95], v[28:31]
    ds_read_b128 v[92:95], v71 offset:512
    s_waitcnt lgkmcnt(4)
    v_mfma_f32_16x16x32_bf16 v[40:43], v[136:139], v[76:79], v[40:43]
    ds_read_b128 v[76:79], v71 offset:640
    s_waitcnt vmcnt(12) lgkmcnt(4)
    v_mfma_f32_16x16x32_bf16 v[12:15], v[140:143], v[80:83], v[12:15]
    ds_read_b128 v[80:83], v71 offset:768
    s_waitcnt lgkmcnt(4)
    v_mfma_f32_16x16x32_bf16 v[24:27], v[140:143], v[84:87], v[24:27]
    ds_read_b128 v[84:87], v66 offset:1152
    s_waitcnt lgkmcnt(4)
    v_mfma_f32_16x16x32_bf16 v[36:39], v[140:143], v[88:91], v[36:39]
    ds_read_b128 v[88:91], v66 offset:1280
    s_waitcnt lgkmcnt(4)
    v_mfma_f32_16x16x32_bf16 v[16:19], v[140:143], v[92:95], v[16:19]
    ds_read_b128 v[92:95], v66 offset:896
    s_waitcnt lgkmcnt(4)
    v_mfma_f32_16x16x32_bf16 v[28:31], v[140:143], v[76:79], v[28:31]
    ds_read_b128 v[76:79], v70 offset:1152
    s_waitcnt lgkmcnt(4)
    v_mfma_f32_16x16x32_bf16 v[40:43], v[140:143], v[80:83], v[40:43]
    ds_read_b128 v[80:83], v70 offset:1280
    s_waitcnt vmcnt(11) lgkmcnt(4)
    v_mfma_f32_16x16x32_bf16 v[12:15], v[112:115], v[84:87], v[12:15]
    ds_read_b128 v[84:87], v70 offset:896
    s_waitcnt lgkmcnt(4)
    v_mfma_f32_16x16x32_bf16 v[24:27], v[112:115], v[88:91], v[24:27]
    ds_read_b128 v[88:91], v67 offset:1152
    s_waitcnt lgkmcnt(4)
    v_mfma_f32_16x16x32_bf16 v[36:39], v[112:115], v[92:95], v[36:39]
    ds_read_b128 v[92:95], v67 offset:1280
    s_waitcnt lgkmcnt(4)
    v_mfma_f32_16x16x32_bf16 v[16:19], v[112:115], v[76:79], v[16:19]
    ds_read_b128 v[76:79], v67 offset:896
    s_waitcnt lgkmcnt(4)
    v_mfma_f32_16x16x32_bf16 v[28:31], v[112:115], v[80:83], v[28:31]
    ds_read_b32 v191, v190
    ds_read_b128 v[80:83], v71 offset:1152
    s_waitcnt lgkmcnt(5)
    v_mfma_f32_16x16x32_bf16 v[40:43], v[112:115], v[84:87], v[40:43]
    ds_read_b128 v[84:87], v71 offset:1280
    s_waitcnt vmcnt(10) lgkmcnt(5)
    v_mfma_f32_16x16x32_bf16 v[12:15], v[116:119], v[88:91], v[12:15]
    ds_read_b128 v[88:91], v71 offset:896
    s_waitcnt lgkmcnt(5)
    v_mfma_f32_16x16x32_bf16 v[24:27], v[116:119], v[92:95], v[24:27]
    s_waitcnt lgkmcnt(3)
    v_cmp_gt_u32 vcc, s50, v191
    s_cbranch_vccnz T_aw
T_awr:
    ds_read_b128 v[92:95], v64 offset:0
    v_mfma_f32_16x16x32_bf16 v[36:39], v[116:119], v[76:79], v[36:39]
    ds_read_b128 v[76:79], v68 offset:0
    s_waitcnt lgkmcnt(4)
    v_mfma_f32_16x16x32_bf16 v[16:19], v[116:119], v[80:83], v[16:19]
    ds_read_b128 v[80:83], v65 offset:0
    s_waitcnt lgkmcnt(4)
    v_mfma_f32_16x16x32_bf16 v[28:31], v[116:119], v[84:87], v[28:31]
    ds_read_b128 v[84:87], v69 offset:0
    s_waitcnt lgkmcnt(4)
    v_mfma_f32_16x16x32_bf16 v[40:43], v[116:119], v[88:91], v[40:43]
    ds_read_b128 v[88:91], v64 offset:1024
    s_waitcnt vmcnt(9) lgkmcnt(4)
    v_mfma_f32_16x16x32_bf16 v[0:3], v[144:147], v[92:95], v[0:3]
    ds_read_b128 v[92:95], v68 offset:1024
    s_waitcnt lgkmcnt(4)
    v_mfma_f32_16x16x32_bf16 v[4:7], v[144:147], v[76:79], v[4:7]
    ds_read_b128 v[76:79], v65 offset:1024
    s_waitcnt vmcnt(8) lgkmcnt(4)
    v_mfma_f32_16x16x32_bf16 v[0:3], v[148:151], v[80:83], v[0:3]
    ds_read_b128 v[80:83], v69 offset:1024
    s_waitcnt lgkmcnt(4)
    v_mfma_f32_16x16x32_bf16 v[4:7], v[148:151], v[84:87], v[4:7]
    ds_read_b128 v[84:87], v72 offset:0
    s_waitcnt vmcnt(7) lgkmcnt(4)
    v_mfma_f32_16x16x32_bf16 v[0:3], v[160:163], v[88:91], v[0:3]
    ds_read_b128 v[88:91], v73 offset:0
    s_waitcnt lgkmcnt(4)
    v_mfma_f32_16x16x32_bf16 v[4:7], v[160:163], v[92:95], v[4:7]
    ds_read_b128 v[92:95], v74 offset:0
    s_waitcnt vmcnt(6) lgkmcnt(4)
    v_mfma_f32_16x16x32_bf16 v[0:3], v[164:167], v[76:79], v[0:3]
    ds_read_b128 v[76:79], v75 offset:0
    s_waitcnt lgkmcnt(4)
    v_mfma_f32_16x16x32_bf16 v[4:7], v[164:167], v[80:83], v[4:7]
    ds_read_b128 v[80:83], v72 offset:1024
    s_waitcnt lgkmcnt(4)
    v_mfma_f32_16x16x32_bf16 v[8:11], v[144:147], v[84:87], 0
    ds_read_b128 v[84:87], v73 offset:1024
    s_waitcnt lgkmcnt(4)
    v_mfma_f32_16x16x32_bf16 v[8:11], v[148:151], v[88:91], v[8:11]
    v_mul_f32 v192, s67, v0
    v_mul_f32 v193, s67, v1
    ds_read_b128 v[88:91], v74 offset:1024
    s_waitcnt lgkmcnt(4)
    v_mfma_f32_16x16x32_bf16 v[8:11], v[96:99], v[92:95], v[8:11]
    v_mul_f32 v194, s67, v2
    v_mul_f32 v195, s67, v3
    ds_read_b128 v[92:95], v75 offset:1024
    s_waitcnt lgkmcnt(4)
    v_mfma_f32_16x16x32_bf16 v[8:11], v[100:103], v[76:79], v[8:11]
    v_exp_f32 v192, v192
    v_exp_f32 v193, v193
    ds_read_b128 v[76:79], v64 offset:128
    s_waitcnt lgkmcnt(4)
    v_mfma_f32_16x16x32_bf16 v[8:11], v[160:163], v[80:83], v[8:11]
    v_exp_f32 v194, v194
    v_exp_f32 v195, v195
    ds_read_b128 v[80:83], v65 offset:128
    s_waitcnt lgkmcnt(4)
    v_mfma_f32_16x16x32_bf16 v[8:11], v[164:167], v[84:87], v[8:11]
    v_add_f32 v192, 1.0, v192
    v_add_f32 v193, 1.0, v193
    ds_read_b128 v[84:87], v64 offset:512
    s_waitcnt lgkmcnt(4)
    v_mfma_f32_16x16x32_bf16 v[8:11], v[104:107], v[88:91], v[8:11]
    v_add_f32 v194, 1.0, v194
    v_add_f32 v195, 1.0, v195
    ds_read_b128 v[88:91], v65 offset:512
    s_waitcnt lgkmcnt(4)
    v_mfma_f32_16x16x32_bf16 v[8:11], v[108:111], v[92:95], v[8:11]
    v_rcp_f32 v192, v192
    v_rcp_f32 v193, v193
    ds_read_b128 v[92:95], v64 offset:1152
    s_waitcnt vmcnt(5) lgkmcnt(4)
    v_mfma_f32_16x16x32_bf16 v[12:15], v[120:123], v[76:79], v[12:15]
    v_rcp_f32 v194, v194
    v_rcp_f32 v195, v195
    ds_read_b128 v[76:79], v65 offset:1152
    s_waitcnt vmcnt(4) lgkmcnt(4)
    v_mfma_f32_16x16x32_bf16 v[12:15], v[124:127], v[80:83], v[12:15]
    v_cvt_pk_bf16_f32 v0, v0, v1
    v_cvt_pk_bf16_f32 v1, v2, v3
    ds_read_b128 v[80:83], v64 offset:256
    s_waitcnt vmcnt(3) lgkmcnt(4)
    v_mfma_f32_16x16x32_bf16 v[12:15], v[152:155], v[84:87], v[12:15]
    ds_write_b64 v204, v[0:1] offset:0
    v_mul_f32 v196, s67, v4
    ds_read_b128 v[84:87], v65 offset:256
    s_waitcnt vmcnt(2) lgkmcnt(5)
    v_mfma_f32_16x16x32_bf16 v[12:15], v[156:159], v[88:91], v[12:15]
    v_mul_f32 v197, s67, v5
    v_mul_f32 v198, s67, v6
    ds_read_b128 v[88:91], v64 offset:640
    s_waitcnt vmcnt(1) lgkmcnt(5)
    v_mfma_f32_16x16x32_bf16 v[12:15], v[168:171], v[92:95], v[12:15]
    v_mul_f32 v199, s67, v7
    v_exp_f32 v196, v196
    ds_read_b128 v[92:95], v65 offset:640
    s_waitcnt vmcnt(0) lgkmcnt(5)
    v_mfma_f32_16x16x32_bf16 v[12:15], v[172:175], v[76:79], v[12:15]
    v_exp_f32 v197, v197
    v_exp_f32 v198, v198
    ds_read_b128 v[76:79], v64 offset:1280
    s_waitcnt lgkmcnt(5)
    v_mfma_f32_16x16x32_bf16 v[24:27], v[120:123], v[80:83], v[24:27]
    v_exp_f32 v199, v199
    v_add_f32 v196, 1.0, v196
    ds_read_b128 v[80:83], v65 offset:1280
    s_waitcnt lgkmcnt(4)
    v_mfma_f32_16x16x32_bf16 v[24:27], v[124:127], v[84:87], v[24:27]
    v_mul_f32 v12, v12, v192
    v_mul_f32 v13, v13, v193
    ds_read_b128 v[84:87], v64 offset:384
    s_waitcnt lgkmcnt(4)
    v_mfma_f32_16x16x32_bf16 v[24:27], v[152:155], v[88:91], v[24:27]
    v_mul_f32 v14, v14, v194
    v_mul_f32 v15, v15, v195
    ds_read_b128 v[88:91], v65 offset:384
    s_waitcnt lgkmcnt(4)
    v_mfma_f32_16x16x32_bf16 v[24:27], v[156:159], v[92:95], v[24:27]
    v_cvt_pk_bf16_f32 v12, v12, v13
    v_cvt_pk_bf16_f32 v13, v14, v15
    ds_read_b128 v[92:95], v64 offset:768
    s_waitcnt lgkmcnt(4)
    v_mfma_f32_16x16x32_bf16 v[24:27], v[168:171], v[76:79], v[24:27]
    ds_write_b64 v204, v[12:13] offset:256
    v_add_f32 v197, 1.0, v197
    ds_read_b128 v[76:79], v65 offset:768
    s_waitcnt lgkmcnt(5)
    v_mfma_f32_16x16x32_bf16 v[24:27], v[172:175], v[80:83], v[24:27]
    v_add_f32 v198, 1.0, v198
    v_add_f32 v199, 1.0, v199
    ds_read_b128 v[80:83], v64 offset:896
    s_waitcnt lgkmcnt(5)
    v_mfma_f32_16x16x32_bf16 v[36:39], v[120:123], v[84:87], v[36:39]
    v_rcp_f32 v196, v196
    v_rcp_f32 v197, v197
    ds_read_b128 v[84:87], v65 offset:896
    s_waitcnt lgkmcnt(5)
    v_mfma_f32_16x16x32_bf16 v[36:39], v[124:127], v[88:91], v[36:39]
    v_rcp_f32 v198, v198
    v_rcp_f32 v199, v199
    ds_read_b128 v[88:91], v68 offset:128
    s_waitcnt lgkmcnt(5)
    v_mfma_f32_16x16x32_bf16 v[36:39], v[152:155], v[92:95], v[36:39]
    v_mul_f32 v24, v24, v192
    v_mul_f32 v25, v25, v193
    ds_read_b128 v[92:95], v69 offset:128
    s_waitcnt lgkmcnt(4)
    v_mfma_f32_16x16x32_bf16 v[36:39], v[156:159], v[76:79], v[36:39]
    v_mul_f32 v26, v26, v194
    v_mul_f32 v27, v27, v195
    ds_read_b128 v[76:79], v68 offset:512
    s_waitcnt lgkmcnt(4)
    v_mfma_f32_16x16x32_bf16 v[36:39], v[168:171], v[80:83], v[36:39]
    v_cvt_pk_bf16_f32 v24, v24, v25
    v_cvt_pk_bf16_f32 v25, v26, v27
    ds_read_b128 v[80:83], v69 offset:512
    s_waitcnt lgkmcnt(4)
    v_mfma_f32_16x16x32_bf16 v[36:39], v[172:175], v[84:87], v[36:39]
    ds_write_b64 v204, v[24:25] offset:512
    v_mul_f32 v200, s67, v8
    ds_read_b128 v[84:87], v68 offset:1152
    s_waitcnt lgkmcnt(5)
    v_mfma_f32_16x16x32_bf16 v[16:19], v[120:123], v[88:91], v[16:19]
    v_mul_f32 v201, s67, v9
    v_mul_f32 v202, s67, v10
    ds_read_b128 v[88:91], v69 offset:1152
    s_waitcnt lgkmcnt(5)
    v_mfma_f32_16x16x32_bf16 v[16:19], v[124:127], v[92:95], v[16:19]
    v_mul_f32 v203, s67, v11
    v_exp_f32 v200, v200
    ds_read_b128 v[92:95], v68 offset:256
    s_waitcnt lgkmcnt(5)
    v_mfma_f32_16x16x32_bf16 v[16:19], v[152:155], v[76:79], v[16:19]
    v_mul_f32 v36, v36, v192
    v_mul_f32 v37, v37, v193
    ds_read_b128 v[76:79], v69 offset:256
    s_waitcnt lgkmcnt(5)
    v_mfma_f32_16x16x32_bf16 v[16:19], v[156:159], v[80:83], v[16:19]
    v_mul_f32 v38, v38, v194
    v_mul_f32 v39, v39, v195
    ds_read_b128 v[80:83], v68 offset:640
    s_waitcnt lgkmcnt(4)
    v_mfma_f32_16x16x32_bf16 v[16:19], v[168:171], v[84:87], v[16:19]
    v_cvt_pk_bf16_f32 v36, v36, v37
    v_cvt_pk_bf16_f32 v37, v38, v39
    ds_read_b128 v[84:87], v69 offset:640
    s_waitcnt lgkmcnt(4)
    v_mfma_f32_16x16x32_bf16 v[16:19], v[172:175], v[88:91], v[16:19]
    ds_write_b64 v204, v[36:37] offset:768
    v_exp_f32 v201, v201
    ds_read_b128 v[88:91], v68 offset:1280
    s_waitcnt lgkmcnt(5)
    v_mfma_f32_16x16x32_bf16 v[28:31], v[120:123], v[92:95], v[28:31]
    v_exp_f32 v202, v202
    v_exp_f32 v203, v203
    ds_read_b128 v[92:95], v69 offset:1280
    s_waitcnt lgkmcnt(5)
    v_mfma_f32_16x16x32_bf16 v[28:31], v[124:127], v[76:79], v[28:31]
    v_add_f32 v200, 1.0, v200
    v_add_f32 v201, 1.0, v201
    ds_read_b128 v[76:79], v68 offset:384
    s_waitcnt lgkmcnt(5)
    v_mfma_f32_16x16x32_bf16 v[28:31], v[152:155], v[80:83], v[28:31]
    v_add_f32 v202, 1.0, v202
    v_add_f32 v203, 1.0, v203
    ds_read_b128 v[80:83], v69 offset:384
    s_waitcnt lgkmcnt(5)
    v_mfma_f32_16x16x32_bf16 v[28:31], v[156:159], v[84:87], v[28:31]
    v_rcp_f32 v200, v200
    v_rcp_f32 v201, v201
    ds_read_b128 v[84:87], v68 offset:768
    s_waitcnt lgkmcnt(4)
    v_mfma_f32_16x16x32_bf16 v[28:31], v[168:171], v[88:91], v[28:31]
    v_rcp_f32 v202, v202
    v_rcp_f32 v203, v203
    ds_read_b128 v[88:91], v69 offset:768
    s_waitcnt lgkmcnt(4)
    v_mfma_f32_16x16x32_bf16 v[28:31], v[172:175], v[92:95], v[28:31]
    v_mov_b32_dpp v200, v200 row_ror:8 row_mask:0xf bank_mask:0xc
    ds_read_b128 v[92:95], v68 offset:896
    s_waitcnt lgkmcnt(4)
    v_mfma_f32_16x16x32_bf16 v[40:43], v[120:123], v[76:79], v[40:43]
    v_mov_b32_dpp v201, v201 row_ror:8 row_mask:0xf bank_mask:0xc
    v_mov_b32_dpp v202, v202 row_ror:8 row_mask:0xf bank_mask:0xc
    ds_read_b128 v[76:79], v69 offset:896
    s_waitcnt lgkmcnt(4)
    v_mfma_f32_16x16x32_bf16 v[40:43], v[124:127], v[80:83], v[40:43]
    v_mov_b32_dpp v203, v203 row_ror:8 row_mask:0xf bank_mask:0xc
    ds_read_b128 v[80:83], v72 offset:128
    s_waitcnt lgkmcnt(4)
    v_mfma_f32_16x16x32_bf16 v[40:43], v[152:155], v[84:87], v[40:43]
    s_barrier
    ds_read_b128 v[212:215], v206 offset:0
    ds_read_b128 v[84:87], v73 offset:128
    s_waitcnt lgkmcnt(5)
    v_mfma_f32_16x16x32_bf16 v[40:43], v[156:159], v[88:91], v[40:43]
    ds_read_b128 v[216:219], v206 offset:8320
    v_cvt_pk_bf16_f32 v4, v4, v5
    ds_read_b128 v[88:91], v74 offset:128
    s_waitcnt lgkmcnt(6)
    v_mfma_f32_16x16x32_bf16 v[40:43], v[168:171], v[92:95], v[40:43]
    v_cvt_pk_bf16_f32 v5, v6, v7
    ds_write_b64 v205, v[4:5] offset:0
    ds_read_b128 v[92:95], v75 offset:128
    s_waitcnt lgkmcnt(7)
    v_mfma_f32_16x16x32_bf16 v[40:43], v[172:175], v[76:79], v[40:43]
    v_mul_f32 v16, v16, v196
    v_mul_f32 v17, v17, v197
    ds_read_b128 v[76:79], v72 offset:512
    s_waitcnt lgkmcnt(7)
    v_mfma_f32_16x16x32_bf16 v[20:23], v[120:123], v[80:83], 0
    v_mul_f32 v18, v18, v198
    v_mul_f32 v19, v19, v199
    ds_read_b128 v[80:83], v73 offset:512
    s_waitcnt lgkmcnt(6)
    v_mfma_f32_16x16x32_bf16 v[20:23], v[124:127], v[84:87], v[20:23]
    v_cvt_pk_bf16_f32 v16, v16, v17
    v_cvt_pk_bf16_f32 v17, v18, v19
    ds_read_b128 v[84:87], v74 offset:512
    s_waitcnt lgkmcnt(5)
    v_mfma_f32_16x16x32_bf16 v[20:23], v[128:131], v[88:91], v[20:23]
    ds_write_b64 v205, v[16:17] offset:256
    ds_read_b128 v[88:91], v75 offset:512
    s_waitcnt lgkmcnt(5)
    v_mfma_f32_16x16x32_bf16 v[20:23], v[132:135], v[92:95], v[20:23]
    buffer_store_dwordx4 v[212:215], v246, s[4:7], s22 offen sc1
    ds_read_b128 v[92:95], v72 offset:1152
    s_waitcnt lgkmcnt(5)
    v_mfma_f32_16x16x32_bf16 v[20:23], v[152:155], v[76:79], v[20:23]
    buffer_store_dwordx4 v[216:219], v246, s[4:7], s23 offen sc1
    v_mul_f32 v28, v28, v196
    ds_read_b128 v[76:79], v73 offset:1152
    s_waitcnt lgkmcnt(5)
    v_mfma_f32_16x16x32_bf16 v[20:23], v[156:159], v[80:83], v[20:23]
    v_mul_f32 v29, v29, v197
    v_mul_f32 v30, v30, v198
    ds_read_b128 v[80:83], v74 offset:1152
    s_waitcnt lgkmcnt(5)
    v_mfma_f32_16x16x32_bf16 v[20:23], v[136:139], v[84:87], v[20:23]
    v_mul_f32 v31, v31, v199
    v_cvt_pk_bf16_f32 v28, v28, v29
    ds_read_b128 v[84:87], v75 offset:1152
    s_waitcnt lgkmcnt(4)
    v_mfma_f32_16x16x32_bf16 v[20:23], v[140:143], v[88:91], v[20:23]
    v_cvt_pk_bf16_f32 v29, v30, v31
    ds_write_b64 v205, v[28:29] offset:512
    ds_read_b128 v[88:91], v72 offset:384
    s_waitcnt lgkmcnt(5)
    v_mfma_f32_16x16x32_bf16 v[20:23], v[168:171], v[92:95], v[20:23]
    v_mul_f32 v40, v40, v196
    v_mul_f32 v41, v41, v197
    ds_read_b128 v[92:95], v73 offset:384
    s_waitcnt lgkmcnt(5)
    v_mfma_f32_16x16x32_bf16 v[20:23], v[172:175], v[76:79], v[20:23]
    v_mul_f32 v42, v42, v198
    v_mul_f32 v43, v43, v199
    ds_read_b128 v[76:79], v74 offset:384
    s_waitcnt lgkmcnt(5)
    v_mfma_f32_16x16x32_bf16 v[20:23], v[112:115], v[80:83], v[20:23]
    v_cvt_pk_bf16_f32 v40, v40, v41
    v_cvt_pk_bf16_f32 v41, v42, v43
    ds_read_b128 v[80:83], v75 offset:384
    s_waitcnt lgkmcnt(5)
    v_mfma_f32_16x16x32_bf16 v[20:23], v[116:119], v[84:87], v[20:23]
    ds_write_b64 v205, v[40:41] offset:768
    ds_read_b128 v[84:87], v72 offset:768
    s_waitcnt lgkmcnt(5)
    v_mfma_f32_16x16x32_bf16 v[44:47], v[120:123], v[88:91], 0
    ds_read_b128 v[88:91], v73 offset:768
    s_waitcnt lgkmcnt(5)
    v_mfma_f32_16x16x32_bf16 v[44:47], v[124:127], v[92:95], v[44:47]
    s_waitcnt lgkmcnt(2)
    s_barrier
    ds_read_b128 v[92:95], v74 offset:768
    v_mfma_f32_16x16x32_bf16 v[44:47], v[128:131], v[76:79], v[44:47]
    ds_read_b128 v[212:215], v207 offset:0
    ds_read_b128 v[216:219], v207 offset:1664
    ds_read_b128 v[76:79], v75 offset:768
    v_mfma_f32_16x16x32_bf16 v[44:47], v[132:135], v[80:83], v[44:47]
    ds_read_b128 v[80:83], v72 offset:896
    s_waitcnt lgkmcnt(6)
    v_mfma_f32_16x16x32_bf16 v[44:47], v[152:155], v[84:87], v[44:47]
    ds_read_b128 v[84:87], v73 offset:896
    s_waitcnt lgkmcnt(6)
    v_mfma_f32_16x16x32_bf16 v[44:47], v[156:159], v[88:91], v[44:47]
    ds_read_b128 v[88:91], v74 offset:896
    s_waitcnt lgkmcnt(6)
    v_mfma_f32_16x16x32_bf16 v[44:47], v[136:139], v[92:95], v[44:47]
    s_waitcnt lgkmcnt(5)
    buffer_store_dwordx4 v[212:215], v246, s[4:7], s24 offen sc1
    ds_read_b128 v[92:95], v75 offset:896
    s_waitcnt lgkmcnt(4)
    v_mfma_f32_16x16x32_bf16 v[44:47], v[140:143], v[76:79], v[44:47]
    buffer_store_dwordx4 v[216:219], v246, s[4:7], s25 offen sc1
    s_waitcnt lgkmcnt(3)
    v_mfma_f32_16x16x32_bf16 v[44:47], v[168:171], v[80:83], v[44:47]
    v_cvt_pk_bf16_f32 v8, v8, v9
    v_cvt_pk_bf16_f32 v9, v10, v11
    s_waitcnt lgkmcnt(2)
    v_mfma_f32_16x16x32_bf16 v[44:47], v[172:175], v[84:87], v[44:47]
    ds_write_b64 v204, v[8:9] offset:0
    v_mul_f32 v20, v20, v200
    s_waitcnt lgkmcnt(2)
    v_mfma_f32_16x16x32_bf16 v[44:47], v[112:115], v[88:91], v[44:47]
    v_mul_f32 v21, v21, v201
    v_mul_f32 v22, v22, v202
    s_waitcnt lgkmcnt(1)
    v_mfma_f32_16x16x32_bf16 v[44:47], v[116:119], v[92:95], v[44:47]
    v_mul_f32 v23, v23, v203
    v_cvt_pk_bf16_f32 v20, v20, v21
    v_cvt_pk_bf16_f32 v21, v22, v23
    ds_write_b64 v220, v[20:21] offset:256
    s_nop 3
    v_mul_f32 v44, v44, v200
    v_mul_f32 v45, v45, v201
    v_mul_f32 v46, v46, v202
    v_mul_f32 v47, v47, v203
    v_cvt_pk_bf16_f32 v44, v44, v45
    v_cvt_pk_bf16_f32 v45, v46, v47
    ds_write_b64 v204, v[44:45] offset:768
    s_waitcnt lgkmcnt(0)
    s_barrier
    ds_read_b128 v[212:215], v206 offset:0
    s_waitcnt lgkmcnt(0)
    buffer_store_dwordx4 v[212:215], v246, s[4:7], s26 offen sc1
    s_or_b32 s89, s89, s20
    s_cbranch_scc1 K2_end
    v_mov_b32 v0, 0
    v_mov_b32 v1, s88
    s_mov_b64 exec, 1
    buffer_store_dword v1, v0, s[16:19], 0 offen
    s_endpgm
T_pw:
    s_sleep 1
    ds_read_b32 v191, v190
    s_waitcnt lgkmcnt(0)
    v_cmp_gt_u32 vcc, s53, v191
    s_cbranch_vccnz T_pw
    s_branch T_pwr
T_aw:
    s_sleep 1
    ds_read_b32 v191, v190
    s_waitcnt lgkmcnt(0)
    v_cmp_gt_u32 vcc, s50, v191
    s_cbranch_vccnz T_aw
    s_branch T_awr
K2_end:
K2_last:
    s_endpgm
SLOW:
    v_readlane_b32 s89, v4, 62
    s_waitcnt vmcnt(0) lgkmcnt(0)
    s_barrier
    s_load_dwordx2 s[22:23], s[0:1], 8
    s_load_dwordx2 s[24:25], s[0:1], 24
    s_load_dwordx2 s[26:27], s[0:1], 32
    s_load_dwordx2 s[28:29], s[0:1], 40
    s_load_dwordx2 s[30:31], s[0:1], 0
    v_mbcnt_lo_u32_b32 v240, -1, 0
    v_mbcnt_hi_u32_b32 v240, -1, v240
    v_lshrrev_b32 v229, 5, v240
    v_and_b32 v230, 31, v240
    v_lshlrev_b32 v241, 7, v229
    v_lshl_add_u32 v241, v230, 1, v241
    v_lshlrev_b32 v245, 4, v240
    v_mov_b32 v242, 0
    s_waitcnt lgkmcnt(0)
    s_mov_b32 s80, s22
    s_and_b32 s81, s23, 0xffff
    s_mov_b32 s82, 1920000
    s_mov_b32 s83, 0x20000
    s_mov_b32 s76, s24
    s_and_b32 s77, s25, 0xffff
    s_mov_b32 s78, 1280000
    s_mov_b32 s79, 0x20000
    s_mov_b32 s72, s26
    s_and_b32 s73, s27, 0xffff
    s_mov_b32 s74, 1280000
    s_mov_b32 s75, 0x20000
    s_mov_b32 s84, s28
    s_and_b32 s85, s29, 0xffff
    s_mov_b32 s86, 20480
    s_mov_b32 s87, 0x20000
    s_mov_b32 s4, s30
    s_and_b32 s5, s31, 0xffff
    s_mov_b32 s6, 10240000
    s_mov_b32 s7, 0x20000
    s_mov_b32 s66, 0
    buffer_load_ushort v0, v241, s[84:87], s66 offen offset:0
    buffer_load_ushort v1, v241, s[84:87], s66 offen offset:64
    buffer_load_ushort v2, v241, s[84:87], s66 offen offset:256
    buffer_load_ushort v3, v241, s[84:87], s66 offen offset:320
    buffer_load_ushort v4, v241, s[84:87], s66 offen offset:512
    buffer_load_ushort v5, v241, s[84:87], s66 offen offset:576
    buffer_load_ushort v6, v241, s[84:87], s66 offen offset:768
    buffer_load_ushort v7, v241, s[84:87], s66 offen offset:832
    buffer_load_ushort v8, v241, s[84:87], s66 offen offset:1024
    buffer_load_ushort v9, v241, s[84:87], s66 offen offset:1088
    s_waitcnt vmcnt(0)
    s_mov_b32 s66, 1280
    buffer_load_ushort v10, v241, s[84:87], s66 offen offset:0
    buffer_load_ushort v11, v241, s[84:87], s66 offen offset:64
    buffer_load_ushort v12, v241, s[84:87], s66 offen offset:256
    buffer_load_ushort v13, v241, s[84:87], s66 offen offset:320
    buffer_load_ushort v14, v241, s[84:87], s66 offen offset:512
    buffer_load_ushort v15, v241, s[84:87], s66 offen offset:576
    buffer_load_ushort v16, v241, s[84:87], s66 offen offset:768
    buffer_load_ushort v17, v241, s[84:87], s66 offen offset:832
    buffer_load_ushort v18, v241, s[84:87], s66 offen offset:1024
    buffer_load_ushort v19, v241, s[84:87], s66 offen offset:1088
    s_waitcnt vmcnt(0)
    s_mov_b32 s66, 2560
    buffer_load_ushort v20, v241, s[84:87], s66 offen offset:0
    buffer_load_ushort v21, v241, s[84:87], s66 offen offset:64
    buffer_load_ushort v22, v241, s[84:87], s66 offen offset:256
    buffer_load_ushort v23, v241, s[84:87], s66 offen offset:320
    buffer_load_ushort v24, v241, s[84:87], s66 offen offset:512
    buffer_load_ushort v25, v241, s[84:87], s66 offen offset:576
    buffer_load_ushort v26, v241, s[84:87], s66 offen offset:768
    buffer_load_ushort v27, v241, s[84:87], s66 offen offset:832
    buffer_load_ushort v28, v241, s[84:87], s66 offen offset:1024
    buffer_load_ushort v29, v241, s[84:87], s66 offen offset:1088
    s_waitcnt vmcnt(0)
    s_mov_b32 s66, 3840
    buffer_load_ushort v30, v241, s[84:87], s66 offen offset:0
    buffer_load_ushort v31, v241, s[84:87], s66 offen offset:64
    buffer_load_ushort v32, v241, s[84:87], s66 offen offset:256
    buffer_load_ushort v33, v241, s[84:87], s66 offen offset:320
    buffer_load_ushort v34, v241, s[84:87], s66 offen offset:512
    buffer_load_ushort v35, v241, s[84:87], s66 offen offset:576
    buffer_load_ushort v36, v241, s[84:87], s66 offen offset:768
    buffer_load_ushort v37, v241, s[84:87], s66 offen offset:832
    buffer_load_ushort v38, v241, s[84:87], s66 offen offset:1024
    buffer_load_ushort v39, v241, s[84:87], s66 offen offset:1088
    s_waitcnt vmcnt(0)
    s_mov_b32 s66, 5120
    buffer_load_ushort v40, v241, s[84:87], s66 offen offset:0
    buffer_load_ushort v41, v241, s[84:87], s66 offen offset:64
    buffer_load_ushort v42, v241, s[84:87], s66 offen offset:256
    buffer_load_ushort v43, v241, s[84:87], s66 offen offset:320
    buffer_load_ushort v44, v241, s[84:87], s66 offen offset:512
    buffer_load_ushort v45, v241, s[84:87], s66 offen offset:576
    buffer_load_ushort v46, v241, s[84:87], s66 offen offset:768
    buffer_load_ushort v47, v241, s[84:87], s66 offen offset:832
    buffer_load_ushort v48, v241, s[84:87], s66 offen offset:1024
    buffer_load_ushort v49, v241, s[84:87], s66 offen offset:1088
    s_waitcnt vmcnt(0)
    s_mov_b32 s66, 6400
    buffer_load_ushort v50, v241, s[84:87], s66 offen offset:0
    buffer_load_ushort v51, v241, s[84:87], s66 offen offset:64
    buffer_load_ushort v52, v241, s[84:87], s66 offen offset:256
    buffer_load_ushort v53, v241, s[84:87], s66 offen offset:320
    buffer_load_ushort v54, v241, s[84:87], s66 offen offset:512
    buffer_load_ushort v55, v241, s[84:87], s66 offen offset:576
    buffer_load_ushort v56, v241, s[84:87], s66 offen offset:768
    buffer_load_ushort v57, v241, s[84:87], s66 offen offset:832
    buffer_load_ushort v58, v241, s[84:87], s66 offen offset:1024
    buffer_load_ushort v59, v241, s[84:87], s66 offen offset:1088
    s_waitcnt vmcnt(0)
    s_mov_b32 s66, 7680
    buffer_load_ushort v60, v241, s[84:87], s66 offen offset:0
    buffer_load_ushort v61, v241, s[84:87], s66 offen offset:64
    buffer_load_ushort v62, v241, s[84:87], s66 offen offset:256
    buffer_load_ushort v63, v241, s[84:87], s66 offen offset:320
    buffer_load_ushort v64, v241, s[84:87], s66 offen offset:512
    buffer_load_ushort v65, v241, s[84:87], s66 offen offset:576
    buffer_load_ushort v66, v241, s[84:87], s66 offen offset:768
    buffer_load_ushort v67, v241, s[84:87], s66 offen offset:832
    buffer_load_ushort v68, v241, s[84:87], s66 offen offset:1024
    buffer_load_ushort v69, v241, s[84:87], s66 offen offset:1088
    s_waitcnt vmcnt(0)
    s_mov_b32 s66, 8960
    buffer_load_ushort v70, v241, s[84:87], s66 offen offset:0
    buffer_load_ushort v71, v241, s[84:87], s66 offen offset:64
    buffer_load_ushort v72, v241, s[84:87], s66 offen offset:256
    buffer_load_ushort v73, v241, s[84:87], s66 offen offset:320
    buffer_load_ushort v74, v241, s[84:87], s66 offen offset:512
    buffer_load_ushort v75, v241, s[84:87], s66 offen offset:576
    buffer_load_ushort v76, v241, s[84:87], s66 offen offset:768
    buffer_load_ushort v77, v241, s[84:87], s66 offen offset:832
    buffer_load_ushort v78, v241, s[84:87], s66 offen offset:1024
    buffer_load_ushort v79, v241, s[84:87], s66 offen offset:1088
    s_waitcnt vmcnt(0)
    s_mov_b32 s66, 10240
    buffer_load_ushort v80, v241, s[84:87], s66 offen offset:0
    buffer_load_ushort v81, v241, s[84:87], s66 offen offset:64
    buffer_load_ushort v82, v241, s[84:87], s66 offen offset:256
    buffer_load_ushort v83, v241, s[84:87], s66 offen offset:320
    buffer_load_ushort v84, v241, s[84:87], s66 offen offset:512
    buffer_load_ushort v85, v241, s[84:87], s66 offen offset:576
    buffer_load_ushort v86, v241, s[84:87], s66 offen offset:768
    buffer_load_ushort v87, v241, s[84:87], s66 offen offset:832
    buffer_load_ushort v88, v241, s[84:87], s66 offen offset:1024
    buffer_load_ushort v89, v241, s[84:87], s66 offen offset:1088
    s_waitcnt vmcnt(0)
    s_mov_b32 s66, 11520
    buffer_load_ushort v90, v241, s[84:87], s66 offen offset:0
    buffer_load_ushort v91, v241, s[84:87], s66 offen offset:64
    buffer_load_ushort v92, v241, s[84:87], s66 offen offset:256
    buffer_load_ushort v93, v241, s[84:87], s66 offen offset:320
    buffer_load_ushort v94, v241, s[84:87], s66 offen offset:512
    buffer_load_ushort v95, v241, s[84:87], s66 offen offset:576
    buffer_load_ushort v96, v241, s[84:87], s66 offen offset:768
    buffer_load_ushort v97, v241, s[84:87], s66 offen offset:832
    buffer_load_ushort v98, v241, s[84:87], s66 offen offset:1024
    buffer_load_ushort v99, v241, s[84:87], s66 offen offset:1088
    s_waitcnt vmcnt(0)
    s_mov_b32 s66, 12800
    buffer_load_ushort v100, v241, s[84:87], s66 offen offset:0
    buffer_load_ushort v101, v241, s[84:87], s66 offen offset:64
    buffer_load_ushort v102, v241, s[84:87], s66 offen offset:256
    buffer_load_ushort v103, v241, s[84:87], s66 offen offset:320
    buffer_load_ushort v104, v241, s[84:87], s66 offen offset:512
    buffer_load_ushort v105, v241, s[84:87], s66 offen offset:576
    buffer_load_ushort v106, v241, s[84:87], s66 offen offset:768
    buffer_load_ushort v107, v241, s[84:87], s66 offen offset:832
    buffer_load_ushort v108, v241, s[84:87], s66 offen offset:1024
    buffer_load_ushort v109, v241, s[84:87], s66 offen offset:1088
    s_waitcnt vmcnt(0)
    s_mov_b32 s66, 14080
    buffer_load_ushort v110, v241, s[84:87], s66 offen offset:0
    buffer_load_ushort v111, v241, s[84:87], s66 offen offset:64
    buffer_load_ushort v112, v241, s[84:87], s66 offen offset:256
    buffer_load_ushort v113, v241, s[84:87], s66 offen offset:320
    buffer_load_ushort v114, v241, s[84:87], s66 offen offset:512
    buffer_load_ushort v115, v241, s[84:87], s66 offen offset:576
    buffer_load_ushort v116, v241, s[84:87], s66 offen offset:768
    buffer_load_ushort v117, v241, s[84:87], s66 offen offset:832
    buffer_load_ushort v118, v241, s[84:87], s66 offen offset:1024
    buffer_load_ushort v119, v241, s[84:87], s66 offen offset:1088
    s_waitcnt vmcnt(0)
    s_mov_b32 s66, 15360
    buffer_load_ushort v120, v241, s[84:87], s66 offen offset:0
    buffer_load_ushort v121, v241, s[84:87], s66 offen offset:64
    buffer_load_ushort v122, v241, s[84:87], s66 offen offset:256
    buffer_load_ushort v123, v241, s[84:87], s66 offen offset:320
    buffer_load_ushort v124, v241, s[84:87], s66 offen offset:512
    buffer_load_ushort v125, v241, s[84:87], s66 offen offset:576
    buffer_load_ushort v126, v241, s[84:87], s66 offen offset:768
    buffer_load_ushort v127, v241, s[84:87], s66 offen offset:832
    buffer_load_ushort v128, v241, s[84:87], s66 offen offset:1024
    buffer_load_ushort v129, v241, s[84:87], s66 offen offset:1088
    s_waitcnt vmcnt(0)
    s_mov_b32 s66, 16640
    buffer_load_ushort v130, v241, s[84:87], s66 offen offset:0
    buffer_load_ushort v131, v241, s[84:87], s66 offen offset:64
    buffer_load_ushort v132, v241, s[84:87], s66 offen offset:256
    buffer_load_ushort v133, v241, s[84:87], s66 offen offset:320
    buffer_load_ushort v134, v241, s[84:87], s66 offen offset:512
    buffer_load_ushort v135, v241, s[84:87], s66 offen offset:576
    buffer_load_ushort v136, v241, s[84:87], s66 offen offset:768
    buffer_load_ushort v137, v241, s[84:87], s66 offen offset:832
    buffer_load_ushort v138, v241, s[84:87], s66 offen offset:1024
    buffer_load_ushort v139, v241, s[84:87], s66 offen offset:1088
    s_waitcnt vmcnt(0)
    s_mov_b32 s66, 17920
    buffer_load_ushort v140, v241, s[84:87], s66 offen offset:0
    buffer_load_ushort v141, v241, s[84:87], s66 offen offset:64
    buffer_load_ushort v142, v241, s[84:87], s66 offen offset:256
    buffer_load_ushort v143, v241, s[84:87], s66 offen offset:320
    buffer_load_ushort v144, v241, s[84:87], s66 offen offset:512
    buffer_load_ushort v145, v241, s[84:87], s66 offen offset:576
    buffer_load_ushort v146, v241, s[84:87], s66 offen offset:768
    buffer_load_ushort v147, v241, s[84:87], s66 offen offset:832
    buffer_load_ushort v148, v241, s[84:87], s66 offen offset:1024
    buffer_load_ushort v149, v241, s[84:87], s66 offen offset:1088
    s_waitcnt vmcnt(0)
    s_mov_b32 s66, 19200
    buffer_load_ushort v150, v241, s[84:87], s66 offen offset:0
    buffer_load_ushort v151, v241, s[84:87], s66 offen offset:64
    buffer_load_ushort v152, v241, s[84:87], s66 offen offset:256
    buffer_load_ushort v153, v241, s[84:87], s66 offen offset:320
    buffer_load_ushort v154, v241, s[84:87], s66 offen offset:512
    buffer_load_ushort v155, v241, s[84:87], s66 offen offset:576
    buffer_load_ushort v156, v241, s[84:87], s66 offen offset:768
    buffer_load_ushort v157, v241, s[84:87], s66 offen offset:832
    buffer_load_ushort v158, v241, s[84:87], s66 offen offset:1024
    buffer_load_ushort v159, v241, s[84:87], s66 offen offset:1088
    s_waitcnt vmcnt(0)
    v_lshlrev_b32 v0, 16, v0
    v_lshlrev_b32 v1, 16, v1
    v_lshlrev_b32 v2, 16, v2
    v_lshlrev_b32 v3, 16, v3
    v_lshlrev_b32 v4, 16, v4
    v_lshlrev_b32 v5, 16, v5
    v_lshlrev_b32 v6, 16, v6
    v_lshlrev_b32 v7, 16, v7
    v_lshlrev_b32 v8, 16, v8
    v_lshlrev_b32 v9, 16, v9
    v_lshlrev_b32 v10, 16, v10
    v_lshlrev_b32 v11, 16, v11
    v_lshlrev_b32 v12, 16, v12
    v_lshlrev_b32 v13, 16, v13
    v_lshlrev_b32 v14, 16, v14
    v_lshlrev_b32 v15, 16, v15
    v_lshlrev_b32 v16, 16, v16
    v_lshlrev_b32 v17, 16, v17
    v_lshlrev_b32 v18, 16, v18
    v_lshlrev_b32 v19, 16, v19
    v_lshlrev_b32 v20, 16, v20
    v_lshlrev_b32 v21, 16, v21
    v_lshlrev_b32 v22, 16, v22
    v_lshlrev_b32 v23, 16, v23
    v_lshlrev_b32 v24, 16, v24
    v_lshlrev_b32 v25, 16, v25
    v_lshlrev_b32 v26, 16, v26
    v_lshlrev_b32 v27, 16, v27
    v_lshlrev_b32 v28, 16, v28
    v_lshlrev_b32 v29, 16, v29
    v_lshlrev_b32 v30, 16, v30
    v_lshlrev_b32 v31, 16, v31
    v_lshlrev_b32 v32, 16, v32
    v_lshlrev_b32 v33, 16, v33
    v_lshlrev_b32 v34, 16, v34
    v_lshlrev_b32 v35, 16, v35
    v_lshlrev_b32 v36, 16, v36
    v_lshlrev_b32 v37, 16, v37
    v_lshlrev_b32 v38, 16, v38
    v_lshlrev_b32 v39, 16, v39
    v_lshlrev_b32 v40, 16, v40
    v_lshlrev_b32 v41, 16, v41
    v_lshlrev_b32 v42, 16, v42
    v_lshlrev_b32 v43, 16, v43
    v_lshlrev_b32 v44, 16, v44
    v_lshlrev_b32 v45, 16, v45
    v_lshlrev_b32 v46, 16, v46
    v_lshlrev_b32 v47, 16, v47
    v_lshlrev_b32 v48, 16, v48
    v_lshlrev_b32 v49, 16, v49
    v_lshlrev_b32 v50, 16, v50
    v_lshlrev_b32 v51, 16, v51
    v_lshlrev_b32 v52, 16, v52
    v_lshlrev_b32 v53, 16, v53
    v_lshlrev_b32 v54, 16, v54
    v_lshlrev_b32 v55, 16, v55
    v_lshlrev_b32 v56, 16, v56
    v_lshlrev_b32 v57, 16, v57
    v_lshlrev_b32 v58, 16, v58
    v_lshlrev_b32 v59, 16, v59
    v_lshlrev_b32 v60, 16, v60
    v_lshlrev_b32 v61, 16, v61
    v_lshlrev_b32 v62, 16, v62
    v_lshlrev_b32 v63, 16, v63
    v_lshlrev_b32 v64, 16, v64
    v_lshlrev_b32 v65, 16, v65
    v_lshlrev_b32 v66, 16, v66
    v_lshlrev_b32 v67, 16, v67
    v_lshlrev_b32 v68, 16, v68
    v_lshlrev_b32 v69, 16, v69
    v_lshlrev_b32 v70, 16, v70
    v_lshlrev_b32 v71, 16, v71
    v_lshlrev_b32 v72, 16, v72
    v_lshlrev_b32 v73, 16, v73
    v_lshlrev_b32 v74, 16, v74
    v_lshlrev_b32 v75, 16, v75
    v_lshlrev_b32 v76, 16, v76
    v_lshlrev_b32 v77, 16, v77
    v_lshlrev_b32 v78, 16, v78
    v_lshlrev_b32 v79, 16, v79
    v_lshlrev_b32 v80, 16, v80
    v_lshlrev_b32 v81, 16, v81
    v_lshlrev_b32 v82, 16, v82
    v_lshlrev_b32 v83, 16, v83
    v_lshlrev_b32 v84, 16, v84
    v_lshlrev_b32 v85, 16, v85
    v_lshlrev_b32 v86, 16, v86
    v_lshlrev_b32 v87, 16, v87
    v_lshlrev_b32 v88, 16, v88
    v_lshlrev_b32 v89, 16, v89
    v_lshlrev_b32 v90, 16, v90
    v_lshlrev_b32 v91, 16, v91
    v_lshlrev_b32 v92, 16, v92
    v_lshlrev_b32 v93, 16, v93
    v_lshlrev_b32 v94, 16, v94
    v_lshlrev_b32 v95, 16, v95
    v_lshlrev_b32 v96, 16, v96
    v_lshlrev_b32 v97, 16, v97
    v_lshlrev_b32 v98, 16, v98
    v_lshlrev_b32 v99, 16, v99
    v_lshlrev_b32 v100, 16, v100
    v_lshlrev_b32 v101, 16, v101
    v_lshlrev_b32 v102, 16, v102
    v_lshlrev_b32 v103, 16, v103
    v_lshlrev_b32 v104, 16, v104
    v_lshlrev_b32 v105, 16, v105
    v_lshlrev_b32 v106, 16, v106
    v_lshlrev_b32 v107, 16, v107
    v_lshlrev_b32 v108, 16, v108
    v_lshlrev_b32 v109, 16, v109
    v_lshlrev_b32 v110, 16, v110
    v_lshlrev_b32 v111, 16, v111
    v_lshlrev_b32 v112, 16, v112
    v_lshlrev_b32 v113, 16, v113
    v_lshlrev_b32 v114, 16, v114
    v_lshlrev_b32 v115, 16, v115
    v_lshlrev_b32 v116, 16, v116
    v_lshlrev_b32 v117, 16, v117
    v_lshlrev_b32 v118, 16, v118
    v_lshlrev_b32 v119, 16, v119
    v_lshlrev_b32 v120, 16, v120
    v_lshlrev_b32 v121, 16, v121
    v_lshlrev_b32 v122, 16, v122
    v_lshlrev_b32 v123, 16, v123
    v_lshlrev_b32 v124, 16, v124
    v_lshlrev_b32 v125, 16, v125
    v_lshlrev_b32 v126, 16, v126
    v_lshlrev_b32 v127, 16, v127
    v_lshlrev_b32 v128, 16, v128
    v_lshlrev_b32 v129, 16, v129
    v_lshlrev_b32 v130, 16, v130
    v_lshlrev_b32 v131, 16, v131
    v_lshlrev_b32 v132, 16, v132
    v_lshlrev_b32 v133, 16, v133
    v_lshlrev_b32 v134, 16, v134
    v_lshlrev_b32 v135, 16, v135
    v_lshlrev_b32 v136, 16, v136
    v_lshlrev_b32 v137, 16, v137
    v_lshlrev_b32 v138, 16, v138
    v_lshlrev_b32 v139, 16, v139
    v_lshlrev_b32 v140, 16, v140
    v_lshlrev_b32 v141, 16, v141
    v_lshlrev_b32 v142, 16, v142
    v_lshlrev_b32 v143, 16, v143
    v_lshlrev_b32 v144, 16, v144
    v_lshlrev_b32 v145, 16, v145
    v_lshlrev_b32 v146, 16, v146
    v_lshlrev_b32 v147, 16, v147
    v_lshlrev_b32 v148, 16, v148
    v_lshlrev_b32 v149, 16, v149
    v_lshlrev_b32 v150, 16, v150
    v_lshlrev_b32 v151, 16, v151
    v_lshlrev_b32 v152, 16, v152
    v_lshlrev_b32 v153, 16, v153
    v_lshlrev_b32 v154, 16, v154
    v_lshlrev_b32 v155, 16, v155
    v_lshlrev_b32 v156, 16, v156
    v_lshlrev_b32 v157, 16, v157
    v_lshlrev_b32 v158, 16, v158
    v_lshlrev_b32 v159, 16, v159
    s_mov_b32 s50, 0
SL_node:
    s_mul_i32 s34, s2, 40
    s_lshl_b32 s66, s50, 3
    s_add_u32 s66, s66, s20
    s_add_u32 s34, s34, s66
    v_mov_b32 v160, 0
    v_mov_b32 v161, 0
    v_mov_b32 v162, 0
    v_mov_b32 v163, 0
    v_mov_b32 v164, 0
    v_mov_b32 v165, 0
    v_mov_b32 v166, 0
    v_mov_b32 v167, 0
    v_mov_b32 v168, 0
    v_mov_b32 v169, 0
    v_mov_b32 v170, 0
    v_mov_b32 v171, 0
    v_mov_b32 v172, 0
    v_mov_b32 v173, 0
    v_mov_b32 v174, 0
    v_mov_b32 v175, 0
    v_mov_b32 v176, 0
    v_mov_b32 v177, 0
    v_mov_b32 v178, 0
    v_mov_b32 v179, 0
    v_mov_b32 v180, 0
    v_mov_b32 v181, 0
    s_mov_b32 s35, 0
SL_scan:
    s_lshl_b32 s66, s35, 2
    buffer_load_dwordx4 v[236:239], v245, s[72:75], s66 offen
    s_waitcnt vmcnt(0)
    v_cmp_eq_u32 s[38:39], s34, v236
    v_cmp_eq_u32 s[40:41], s34, v237
    v_cmp_eq_u32 s[42:43], s34, v238
    v_cmp_eq_u32 s[44:45], s34, v239
    s_mov_b32 s36, 0
SL_bits:
    s_cmp_eq_u64 s[38:39], 0
    s_cbranch_scc1 SL_nexti
    s_ff1_i32_b64 s66, s[38:39]
    s_bitset0_b64 s[38:39], s66
    s_lshl_b32 s66, s66, 2
    s_add_u32 s37, s66, s36
    s_add_u32 s37, s37, s35
    s_lshl_b32 s66, s37, 2
    s_lshl_b32 s67, s37, 5
    s_mul_i32 s68, s37, 6
    buffer_load_dword v243, v242, s[76:79], s66 offen
    buffer_load_dwordx4 v[184:187], v242, s[12:15], s67 offen
    buffer_load_dwordx4 v[188:191], v242, s[12:15], s67 offen offset:16
    buffer_load_ushort v226, v242, s[80:83], s68 offen offset:0
    buffer_load_ushort v227, v242, s[80:83], s68 offen offset:2
    buffer_load_ushort v228, v242, s[80:83], s68 offen offset:4
    s_waitcnt vmcnt(5)
    v_lshl_add_u32 v243, v243, 10, v241
    buffer_load_ushort v208, v243, s[4:7], 0 offen offset:0
    buffer_load_ushort v209, v243, s[4:7], 0 offen offset:64
    buffer_load_ushort v210, v243, s[4:7], 0 offen offset:256
    buffer_load_ushort v211, v243, s[4:7], 0 offen offset:320
    buffer_load_ushort v212, v243, s[4:7], 0 offen offset:512
    buffer_load_ushort v213, v243, s[4:7], 0 offen offset:576
    buffer_load_ushort v214, v243, s[4:7], 0 offen offset:768
    buffer_load_ushort v215, v243, s[4:7], 0 offen offset:832
    s_waitcnt vmcnt(8)
    v_lshlrev_b32 v192, 16, v184
    v_and_b32 v193, 0xffff0000, v184
    v_lshlrev_b32 v194, 16, v185
    v_and_b32 v195, 0xffff0000, v185
    v_lshlrev_b32 v196, 16, v186
    v_and_b32 v197, 0xffff0000, v186
    v_lshlrev_b32 v198, 16, v187
    v_and_b32 v199, 0xffff0000, v187
    v_lshlrev_b32 v200, 16, v188
    v_and_b32 v201, 0xffff0000, v188
    v_lshlrev_b32 v202, 16, v189
    v_and_b32 v203, 0xffff0000, v189
    v_lshlrev_b32 v204, 16, v190
    v_and_b32 v205, 0xffff0000, v190
    v_lshlrev_b32 v206, 16, v191
    v_and_b32 v207, 0xffff0000, v191
    v_lshlrev_b32 v226, 16, v226
    v_lshlrev_b32 v227, 16, v227
    v_lshlrev_b32 v228, 16, v228
    v_mul_f32 v216, v192, v0
    v_mul_f32 v217, v192, v1
    v_mul_f32 v218, v192, v2
    v_mul_f32 v219, v192, v3
    v_mul_f32 v220, v192, v4
    v_mul_f32 v221, v192, v5
    v_mul_f32 v222, v192, v6
    v_mul_f32 v223, v192, v7
    v_mul_f32 v224, v192, v8
    v_mul_f32 v225, v192, v9
    v_fmac_f32 v216, v193, v10
    v_fmac_f32 v217, v193, v11
    v_fmac_f32 v218, v193, v12
    v_fmac_f32 v219, v193, v13
    v_fmac_f32 v220, v193, v14
    v_fmac_f32 v221, v193, v15
    v_fmac_f32 v222, v193, v16
    v_fmac_f32 v223, v193, v17
    v_fmac_f32 v224, v193, v18
    v_fmac_f32 v225, v193, v19
    v_fmac_f32 v216, v194, v20
    v_fmac_f32 v217, v194, v21
    v_fmac_f32 v218, v194, v22
    v_fmac_f32 v219, v194, v23
    v_fmac_f32 v220, v194, v24
    v_fmac_f32 v221, v194, v25
    v_fmac_f32 v222, v194, v26
    v_fmac_f32 v223, v194, v27
    v_fmac_f32 v224, v194, v28
    v_fmac_f32 v225, v194, v29
    v_fmac_f32 v216, v195, v30
    v_fmac_f32 v217, v195, v31
    v_fmac_f32 v218, v195, v32
    v_fmac_f32 v219, v195, v33
    v_fmac_f32 v220, v195, v34
    v_fmac_f32 v221, v195, v35
    v_fmac_f32 v222, v195, v36
    v_fmac_f32 v223, v195, v37
    v_fmac_f32 v224, v195, v38
    v_fmac_f32 v225, v195, v39
    v_fmac_f32 v216, v196, v40
    v_fmac_f32 v217, v196, v41
    v_fmac_f32 v218, v196, v42
    v_fmac_f32 v219, v196, v43
    v_fmac_f32 v220, v196, v44
    v_fmac_f32 v221, v196, v45
    v_fmac_f32 v222, v196, v46
    v_fmac_f32 v223, v196, v47
    v_fmac_f32 v224, v196, v48
    v_fmac_f32 v225, v196, v49
    v_fmac_f32 v216, v197, v50
    v_fmac_f32 v217, v197, v51
    v_fmac_f32 v218, v197, v52
    v_fmac_f32 v219, v197, v53
    v_fmac_f32 v220, v197, v54
    v_fmac_f32 v221, v197, v55
    v_fmac_f32 v222, v197, v56
    v_fmac_f32 v223, v197, v57
    v_fmac_f32 v224, v197, v58
    v_fmac_f32 v225, v197, v59
    v_fmac_f32 v216, v198, v60
    v_fmac_f32 v217, v198, v61
    v_fmac_f32 v218, v198, v62
    v_fmac_f32 v219, v198, v63
    v_fmac_f32 v220, v198, v64
    v_fmac_f32 v221, v198, v65
    v_fmac_f32 v222, v198, v66
    v_fmac_f32 v223, v198, v67
    v_fmac_f32 v224, v198, v68
    v_fmac_f32 v225, v198, v69
    v_fmac_f32 v216, v199, v70
    v_fmac_f32 v217, v199, v71
    v_fmac_f32 v218, v199, v72
    v_fmac_f32 v219, v199, v73
    v_fmac_f32 v220, v199, v74
    v_fmac_f32 v221, v199, v75
    v_fmac_f32 v222, v199, v76
    v_fmac_f32 v223, v199, v77
    v_fmac_f32 v224, v199, v78
    v_fmac_f32 v225, v199, v79
    v_fmac_f32 v216, v200, v80
    v_fmac_f32 v217, v200, v81
    v_fmac_f32 v218, v200, v82
    v_fmac_f32 v219, v200, v83
    v_fmac_f32 v220, v200, v84
    v_fmac_f32 v221, v200, v85
    v_fmac_f32 v222, v200, v86
    v_fmac_f32 v223, v200, v87
    v_fmac_f32 v224, v200, v88
    v_fmac_f32 v225, v200, v89
    v_fmac_f32 v216, v201, v90
    v_fmac_f32 v217, v201, v91
    v_fmac_f32 v218, v201, v92
    v_fmac_f32 v219, v201, v93
    v_fmac_f32 v220, v201, v94
    v_fmac_f32 v221, v201, v95
    v_fmac_f32 v222, v201, v96
    v_fmac_f32 v223, v201, v97
    v_fmac_f32 v224, v201, v98
    v_fmac_f32 v225, v201, v99
    v_fmac_f32 v216, v202, v100
    v_fmac_f32 v217, v202, v101
    v_fmac_f32 v218, v202, v102
    v_fmac_f32 v219, v202, v103
    v_fmac_f32 v220, v202, v104
    v_fmac_f32 v221, v202, v105
    v_fmac_f32 v222, v202, v106
    v_fmac_f32 v223, v202, v107
    v_fmac_f32 v224, v202, v108
    v_fmac_f32 v225, v202, v109
    v_fmac_f32 v216, v203, v110
    v_fmac_f32 v217, v203, v111
    v_fmac_f32 v218, v203, v112
    v_fmac_f32 v219, v203, v113
    v_fmac_f32 v220, v203, v114
    v_fmac_f32 v221, v203, v115
    v_fmac_f32 v222, v203, v116
    v_fmac_f32 v223, v203, v117
    v_fmac_f32 v224, v203, v118
    v_fmac_f32 v225, v203, v119
    v_fmac_f32 v216, v204, v120
    v_fmac_f32 v217, v204, v121
    v_fmac_f32 v218, v204, v122
    v_fmac_f32 v219, v204, v123
    v_fmac_f32 v220, v204, v124
    v_fmac_f32 v221, v204, v125
    v_fmac_f32 v222, v204, v126
    v_fmac_f32 v223, v204, v127
    v_fmac_f32 v224, v204, v128
    v_fmac_f32 v225, v204, v129
    v_fmac_f32 v216, v205, v130
    v_fmac_f32 v217, v205, v131
    v_fmac_f32 v218, v205, v132
    v_fmac_f32 v219, v205, v133
    v_fmac_f32 v220, v205, v134
    v_fmac_f32 v221, v205, v135
    v_fmac_f32 v222, v205, v136
    v_fmac_f32 v223, v205, v137
    v_fmac_f32 v224, v205, v138
    v_fmac_f32 v225, v205, v139
    v_fmac_f32 v216, v206, v140
    v_fmac_f32 v217, v206, v141
    v_fmac_f32 v218, v206, v142
    v_fmac_f32 v219, v206, v143
    v_fmac_f32 v220, v206, v144
    v_fmac_f32 v221, v206, v145
    v_fmac_f32 v222, v206, v146
    v_fmac_f32 v223, v206, v147
    v_fmac_f32 v224, v206, v148
    v_fmac_f32 v225, v206, v149
    v_fmac_f32 v216, v207, v150
    v_fmac_f32 v217, v207, v151
    v_fmac_f32 v218, v207, v152
    v_fmac_f32 v219, v207, v153
    v_fmac_f32 v220, v207, v154
    v_fmac_f32 v221, v207, v155
    v_fmac_f32 v222, v207, v156
    v_fmac_f32 v223, v207, v157
    v_fmac_f32 v224, v207, v158
    v_fmac_f32 v225, v207, v159
    s_waitcnt vmcnt(0)
    v_lshlrev_b32 v208, 16, v208
    v_lshlrev_b32 v209, 16, v209
    v_lshlrev_b32 v210, 16, v210
    v_lshlrev_b32 v211, 16, v211
    v_lshlrev_b32 v212, 16, v212
    v_lshlrev_b32 v213, 16, v213
    v_lshlrev_b32 v214, 16, v214
    v_lshlrev_b32 v215, 16, v215
    v_fmac_f32 v160, v208, v216
    v_mul_f32 v229, v210, v226
    v_fmac_f32 v229, v212, v227
    v_fmac_f32 v229, v214, v228
    v_fmac_f32 v176, v229, v218
    v_mul_f32 v229, v208, v220
    v_fmac_f32 v162, v229, v226
    v_fmac_f32 v168, v210, v222
    v_mul_f32 v230, v227, v214
    v_fma_f32 v230, -v228, v212, v230
    v_fmac_f32 v178, v230, v224
    v_fmac_f32 v164, v229, v227
    v_fmac_f32 v170, v212, v222
    v_mul_f32 v230, v228, v210
    v_fma_f32 v230, -v226, v214, v230
    v_fmac_f32 v180, v230, v224
    v_fmac_f32 v166, v229, v228
    v_fmac_f32 v172, v214, v222
    v_mul_f32 v230, v226, v212
    v_fma_f32 v230, -v227, v210, v230
    v_fmac_f32 v174, v230, v224
    v_fmac_f32 v161, v209, v217
    v_mul_f32 v229, v211, v226
    v_fmac_f32 v229, v213, v227
    v_fmac_f32 v229, v215, v228
    v_fmac_f32 v177, v229, v219
    v_mul_f32 v229, v209, v221
    v_fmac_f32 v163, v229, v226
    v_fmac_f32 v169, v211, v223
    v_mul_f32 v230, v227, v215
    v_fma_f32 v230, -v228, v213, v230
    v_fmac_f32 v179, v230, v225
    v_fmac_f32 v165, v229, v227
    v_fmac_f32 v171, v213, v223
    v_mul_f32 v230, v228, v211
    v_fma_f32 v230, -v226, v215, v230
    v_fmac_f32 v181, v230, v225
    v_fmac_f32 v167, v229, v228
    v_fmac_f32 v173, v215, v223
    v_mul_f32 v230, v226, v213
    v_fma_f32 v230, -v227, v211, v230
    v_fmac_f32 v175, v230, v225
    s_branch SL_bits
SL_nexti:
    s_mov_b64 s[38:39], s[40:41]
    s_mov_b64 s[40:41], s[42:43]
    s_mov_b64 s[42:43], s[44:45]
    s_add_u32 s36, s36, 1
    s_cmp_lt_u32 s36, 4
    s_cbranch_scc1 SL_bits
    s_add_u32 s35, s35, 256
    s_cmp_lt_u32 s35, 320000
    s_cbranch_scc1 SL_scan
    s_lshl_b32 s66, s50, 3
    s_add_u32 s66, s66, s20
    s_lshl_b32 s67, s66, 4
    s_and_b32 s68, s67, 128
    s_and_b32 s67, s67, 0x70
    s_mul_i32 s69, s50, 1536
    s_add_u32 s69, s69, s21
    s_add_u32 s69, s69, s68
    s_mul_i32 s70, s66, 1536
    s_add_u32 s70, s70, 86016
    s_add_u32 s70, s70, s68
    v_mov_b32 v230, s69
    v_mov_b32 v231, s70
    v_cmp_gt_u32 vcc, 32, v240
    v_and_b32 v229, 31, v240
    v_lshlrev_b32 v229, 2, v229
    v_xor_b32 v229, s67, v229
    v_cndmask_b32 v244, v231, v230, vcc
    v_add_u32 v244, v244, v229
    v_cvt_pk_bf16_f32 v160, v160, v161
    ds_write_b32 v244, v160 offset:0
    v_cvt_pk_bf16_f32 v162, v162, v163
    ds_write_b32 v244, v162 offset:128
    v_cvt_pk_bf16_f32 v164, v164, v165
    ds_write_b32 v244, v164 offset:256
    v_cvt_pk_bf16_f32 v166, v166, v167
    ds_write_b32 v244, v166 offset:384
    v_cvt_pk_bf16_f32 v168, v168, v169
    ds_write_b32 v244, v168 offset:512
    v_cvt_pk_bf16_f32 v170, v170, v171
    ds_write_b32 v244, v170 offset:640
    v_cvt_pk_bf16_f32 v172, v172, v173
    ds_write_b32 v244, v172 offset:768
    v_cvt_pk_bf16_f32 v174, v174, v175
    ds_write_b32 v244, v174 offset:896
    v_cvt_pk_bf16_f32 v176, v176, v177
    ds_write_b32 v244, v176 offset:1024
    v_cvt_pk_bf16_f32 v178, v178, v179
    ds_write_b32 v244, v178 offset:1152
    v_cvt_pk_bf16_f32 v180, v180, v181
    ds_write_b32 v244, v180 offset:1280
    s_lshl_b32 s66, s66, 3
    s_add_u32 s66, s66, 163328
    v_mov_b32 v229, s66
    ds_write_b64 v229, v[230:231]
    s_add_u32 s50, s50, 1
    s_cmp_lt_u32 s50, 5
    s_cbranch_scc1 SL_node
    s_waitcnt lgkmcnt(0)
    s_barrier
    v_mov_b32 v176, v240
    s_load_dwordx4 s[84:87], s[0:1], 48
    s_mul_i32 s22, s20, 20
    s_waitcnt lgkmcnt(0)
    s_mul_i32 s24, s22, 3277
    s_lshr_b32 s24, s24, 16
    s_mul_i32 s68, s24, 20
    s_sub_u32 s68, s22, s68
    s_cmp_lt_u32 s68, 8
    s_cselect_b64 s[66:67], s[84:85], s[86:87]
    s_cselect_b32 s25, 0, 8
    s_sub_u32 s68, s68, s25
    s_and_b32 s25, s68, 1
    s_lshr_b32 s68, s68, 1
    s_lshl_b32 s68, s68, 14
    s_lshl_b32 s25, s25, 12
    s_add_u32 s68, s68, s25
    s_lshl_b32 s24, s24, 5
    s_add_u32 s68, s68, s24
    v_lshrrev_b32 v2, 4, v176
    v_lshlrev_b32 v2, 10, v2
    v_and_b32 v3, 15, v176
    v_lshl_add_u32 v2, v3, 1, v2
    v_add_u32 v2, s68, v2
    v_add_u32 v3, 8192, v2
    v_mov_b32 v4, 0
    v_mov_b32 v5, 0
    v_mov_b32 v6, 0
    v_mov_b32 v7, 0
    global_load_ushort v144, v2, s[66:67] offset:0
    global_load_short_d16_hi v4, v3, s[66:67] offset:0
    global_load_ushort v145, v2, s[66:67] offset:256
    global_load_short_d16_hi v5, v3, s[66:67] offset:256
    global_load_ushort v146, v2, s[66:67] offset:512
    global_load_short_d16_hi v6, v3, s[66:67] offset:512
    global_load_ushort v147, v2, s[66:67] offset:768
    global_load_short_d16_hi v7, v3, s[66:67] offset:768
    s_add_u32 s22, s22, 1
    s_waitcnt vmcnt(0)
    v_or_b32 v144, v144, v4
    v_or_b32 v145, v145, v5
    v_or_b32 v146, v146, v6
    v_or_b32 v147, v147, v7
    s_mul_i32 s24, s22, 3277
    s_lshr_b32 s24, s24, 16
    s_mul_i32 s68, s24, 20
    s_sub_u32 s68, s22, s68
    s_cmp_lt_u32 s68, 8
    s_cselect_b64 s[66:67], s[84:85], s[86:87]
    s_cselect_b32 s25, 0, 8
    s_sub_u32 s68, s68, s25
    s_and_b32 s25, s68, 1
    s_lshr_b32 s68, s68, 1
    s_lshl_b32 s68, s68, 14
    s_lshl_b32 s25, s25, 12
    s_add_u32 s68, s68, s25
    s_lshl_b32 s24, s24, 5
    s_add_u32 s68, s68, s24
    v_lshrrev_b32 v2, 4, v176
    v_lshlrev_b32 v2, 10, v2
    v_and_b32 v3, 15, v176
    v_lshl_add_u32 v2, v3, 1, v2
    v_add_u32 v2, s68, v2
    v_add_u32 v3, 8192, v2
    v_mov_b32 v4, 0
    v_mov_b32 v5, 0
    v_mov_b32 v6, 0
    v_mov_b32 v7, 0
    global_load_ushort v148, v2, s[66:67] offset:0
    global_load_short_d16_hi v4, v3, s[66:67] offset:0
    global_load_ushort v149, v2, s[66:67] offset:256
    global_load_short_d16_hi v5, v3, s[66:67] offset:256
    global_load_ushort v150, v2, s[66:67] offset:512
    global_load_short_d16_hi v6, v3, s[66:67] offset:512
    global_load_ushort v151, v2, s[66:67] offset:768
    global_load_short_d16_hi v7, v3, s[66:67] offset:768
    s_add_u32 s22, s22, 1
    s_waitcnt vmcnt(0)
    v_or_b32 v148, v148, v4
    v_or_b32 v149, v149, v5
    v_or_b32 v150, v150, v6
    v_or_b32 v151, v151, v7
    s_mul_i32 s24, s22, 3277
    s_lshr_b32 s24, s24, 16
    s_mul_i32 s68, s24, 20
    s_sub_u32 s68, s22, s68
    s_cmp_lt_u32 s68, 8
    s_cselect_b64 s[66:67], s[84:85], s[86:87]
    s_cselect_b32 s25, 0, 8
    s_sub_u32 s68, s68, s25
    s_and_b32 s25, s68, 1
    s_lshr_b32 s68, s68, 1
    s_lshl_b32 s68, s68, 14
    s_lshl_b32 s25, s25, 12
    s_add_u32 s68, s68, s25
    s_lshl_b32 s24, s24, 5
    s_add_u32 s68, s68, s24
    v_lshrrev_b32 v2, 4, v176
    v_lshlrev_b32 v2, 10, v2
    v_and_b32 v3, 15, v176
    v_lshl_add_u32 v2, v3, 1, v2
    v_add_u32 v2, s68, v2
    v_add_u32 v3, 8192, v2
    v_mov_b32 v4, 0
    v_mov_b32 v5, 0
    v_mov_b32 v6, 0
    v_mov_b32 v7, 0
    global_load_ushort v96, v2, s[66:67] offset:0
    global_load_short_d16_hi v4, v3, s[66:67] offset:0
    global_load_ushort v97, v2, s[66:67] offset:256
    global_load_short_d16_hi v5, v3, s[66:67] offset:256
    global_load_ushort v98, v2, s[66:67] offset:512
    global_load_short_d16_hi v6, v3, s[66:67] offset:512
    global_load_ushort v99, v2, s[66:67] offset:768
    global_load_short_d16_hi v7, v3, s[66:67] offset:768
    s_add_u32 s22, s22, 1
    s_waitcnt vmcnt(0)
    v_or_b32 v96, v96, v4
    v_or_b32 v97, v97, v5
    v_or_b32 v98, v98, v6
    v_or_b32 v99, v99, v7
    s_mul_i32 s24, s22, 3277
    s_lshr_b32 s24, s24, 16
    s_mul_i32 s68, s24, 20
    s_sub_u32 s68, s22, s68
    s_cmp_lt_u32 s68, 8
    s_cselect_b64 s[66:67], s[84:85], s[86:87]
    s_cselect_b32 s25, 0, 8
    s_sub_u32 s68, s68, s25
    s_and_b32 s25, s68, 1
    s_lshr_b32 s68, s68, 1
    s_lshl_b32 s68, s68, 14
    s_lshl_b32 s25, s25, 12
    s_add_u32 s68, s68, s25
    s_lshl_b32 s24, s24, 5
    s_add_u32 s68, s68, s24
    v_lshrrev_b32 v2, 4, v176
    v_lshlrev_b32 v2, 10, v2
    v_and_b32 v3, 15, v176
    v_lshl_add_u32 v2, v3, 1, v2
    v_add_u32 v2, s68, v2
    v_add_u32 v3, 8192, v2
    v_mov_b32 v4, 0
    v_mov_b32 v5, 0
    v_mov_b32 v6, 0
    v_mov_b32 v7, 0
    global_load_ushort v100, v2, s[66:67] offset:0
    global_load_short_d16_hi v4, v3, s[66:67] offset:0
    global_load_ushort v101, v2, s[66:67] offset:256
    global_load_short_d16_hi v5, v3, s[66:67] offset:256
    global_load_ushort v102, v2, s[66:67] offset:512
    global_load_short_d16_hi v6, v3, s[66:67] offset:512
    global_load_ushort v103, v2, s[66:67] offset:768
    global_load_short_d16_hi v7, v3, s[66:67] offset:768
    s_add_u32 s22, s22, 1
    s_waitcnt vmcnt(0)
    v_or_b32 v100, v100, v4
    v_or_b32 v101, v101, v5
    v_or_b32 v102, v102, v6
    v_or_b32 v103, v103, v7
    s_mul_i32 s24, s22, 3277
    s_lshr_b32 s24, s24, 16
    s_mul_i32 s68, s24, 20
    s_sub_u32 s68, s22, s68
    s_cmp_lt_u32 s68, 8
    s_cselect_b64 s[66:67], s[84:85], s[86:87]
    s_cselect_b32 s25, 0, 8
    s_sub_u32 s68, s68, s25
    s_and_b32 s25, s68, 1
    s_lshr_b32 s68, s68, 1
    s_lshl_b32 s68, s68, 14
    s_lshl_b32 s25, s25, 12
    s_add_u32 s68, s68, s25
    s_lshl_b32 s24, s24, 5
    s_add_u32 s68, s68, s24
    v_lshrrev_b32 v2, 4, v176
    v_lshlrev_b32 v2, 10, v2
    v_and_b32 v3, 15, v176
    v_lshl_add_u32 v2, v3, 1, v2
    v_add_u32 v2, s68, v2
    v_add_u32 v3, 8192, v2
    v_mov_b32 v4, 0
    v_mov_b32 v5, 0
    v_mov_b32 v6, 0
    v_mov_b32 v7, 0
    global_load_ushort v160, v2, s[66:67] offset:0
    global_load_short_d16_hi v4, v3, s[66:67] offset:0
    global_load_ushort v161, v2, s[66:67] offset:256
    global_load_short_d16_hi v5, v3, s[66:67] offset:256
    global_load_ushort v162, v2, s[66:67] offset:512
    global_load_short_d16_hi v6, v3, s[66:67] offset:512
    global_load_ushort v163, v2, s[66:67] offset:768
    global_load_short_d16_hi v7, v3, s[66:67] offset:768
    s_add_u32 s22, s22, 1
    s_waitcnt vmcnt(0)
    v_or_b32 v160, v160, v4
    v_or_b32 v161, v161, v5
    v_or_b32 v162, v162, v6
    v_or_b32 v163, v163, v7
    s_mul_i32 s24, s22, 3277
    s_lshr_b32 s24, s24, 16
    s_mul_i32 s68, s24, 20
    s_sub_u32 s68, s22, s68
    s_cmp_lt_u32 s68, 8
    s_cselect_b64 s[66:67], s[84:85], s[86:87]
    s_cselect_b32 s25, 0, 8
    s_sub_u32 s68, s68, s25
    s_and_b32 s25, s68, 1
    s_lshr_b32 s68, s68, 1
    s_lshl_b32 s68, s68, 14
    s_lshl_b32 s25, s25, 12
    s_add_u32 s68, s68, s25
    s_lshl_b32 s24, s24, 5
    s_add_u32 s68, s68, s24
    v_lshrrev_b32 v2, 4, v176
    v_lshlrev_b32 v2, 10, v2
    v_and_b32 v3, 15, v176
    v_lshl_add_u32 v2, v3, 1, v2
    v_add_u32 v2, s68, v2
    v_add_u32 v3, 8192, v2
    v_mov_b32 v4, 0
    v_mov_b32 v5, 0
    v_mov_b32 v6, 0
    v_mov_b32 v7, 0
    global_load_ushort v164, v2, s[66:67] offset:0
    global_load_short_d16_hi v4, v3, s[66:67] offset:0
    global_load_ushort v165, v2, s[66:67] offset:256
    global_load_short_d16_hi v5, v3, s[66:67] offset:256
    global_load_ushort v166, v2, s[66:67] offset:512
    global_load_short_d16_hi v6, v3, s[66:67] offset:512
    global_load_ushort v167, v2, s[66:67] offset:768
    global_load_short_d16_hi v7, v3, s[66:67] offset:768
    s_add_u32 s22, s22, 1
    s_waitcnt vmcnt(0)
    v_or_b32 v164, v164, v4
    v_or_b32 v165, v165, v5
    v_or_b32 v166, v166, v6
    v_or_b32 v167, v167, v7
    s_mul_i32 s24, s22, 3277
    s_lshr_b32 s24, s24, 16
    s_mul_i32 s68, s24, 20
    s_sub_u32 s68, s22, s68
    s_cmp_lt_u32 s68, 8
    s_cselect_b64 s[66:67], s[84:85], s[86:87]
    s_cselect_b32 s25, 0, 8
    s_sub_u32 s68, s68, s25
    s_and_b32 s25, s68, 1
    s_lshr_b32 s68, s68, 1
    s_lshl_b32 s68, s68, 14
    s_lshl_b32 s25, s25, 12
    s_add_u32 s68, s68, s25
    s_lshl_b32 s24, s24, 5
    s_add_u32 s68, s68, s24
    v_lshrrev_b32 v2, 4, v176
    v_lshlrev_b32 v2, 10, v2
    v_and_b32 v3, 15, v176
    v_lshl_add_u32 v2, v3, 1, v2
    v_add_u32 v2, s68, v2
    v_add_u32 v3, 8192, v2
    v_mov_b32 v4, 0
    v_mov_b32 v5, 0
    v_mov_b32 v6, 0
    v_mov_b32 v7, 0
    global_load_ushort v104, v2, s[66:67] offset:0
    global_load_short_d16_hi v4, v3, s[66:67] offset:0
    global_load_ushort v105, v2, s[66:67] offset:256
    global_load_short_d16_hi v5, v3, s[66:67] offset:256
    global_load_ushort v106, v2, s[66:67] offset:512
    global_load_short_d16_hi v6, v3, s[66:67] offset:512
    global_load_ushort v107, v2, s[66:67] offset:768
    global_load_short_d16_hi v7, v3, s[66:67] offset:768
    s_add_u32 s22, s22, 1
    s_waitcnt vmcnt(0)
    v_or_b32 v104, v104, v4
    v_or_b32 v105, v105, v5
    v_or_b32 v106, v106, v6
    v_or_b32 v107, v107, v7
    s_mul_i32 s24, s22, 3277
    s_lshr_b32 s24, s24, 16
    s_mul_i32 s68, s24, 20
    s_sub_u32 s68, s22, s68
    s_cmp_lt_u32 s68, 8
    s_cselect_b64 s[66:67], s[84:85], s[86:87]
    s_cselect_b32 s25, 0, 8
    s_sub_u32 s68, s68, s25
    s_and_b32 s25, s68, 1
    s_lshr_b32 s68, s68, 1
    s_lshl_b32 s68, s68, 14
    s_lshl_b32 s25, s25, 12
    s_add_u32 s68, s68, s25
    s_lshl_b32 s24, s24, 5
    s_add_u32 s68, s68, s24
    v_lshrrev_b32 v2, 4, v176
    v_lshlrev_b32 v2, 10, v2
    v_and_b32 v3, 15, v176
    v_lshl_add_u32 v2, v3, 1, v2
    v_add_u32 v2, s68, v2
    v_add_u32 v3, 8192, v2
    v_mov_b32 v4, 0
    v_mov_b32 v5, 0
    v_mov_b32 v6, 0
    v_mov_b32 v7, 0
    global_load_ushort v108, v2, s[66:67] offset:0
    global_load_short_d16_hi v4, v3, s[66:67] offset:0
    global_load_ushort v109, v2, s[66:67] offset:256
    global_load_short_d16_hi v5, v3, s[66:67] offset:256
    global_load_ushort v110, v2, s[66:67] offset:512
    global_load_short_d16_hi v6, v3, s[66:67] offset:512
    global_load_ushort v111, v2, s[66:67] offset:768
    global_load_short_d16_hi v7, v3, s[66:67] offset:768
    s_add_u32 s22, s22, 1
    s_waitcnt vmcnt(0)
    v_or_b32 v108, v108, v4
    v_or_b32 v109, v109, v5
    v_or_b32 v110, v110, v6
    v_or_b32 v111, v111, v7
    s_mul_i32 s24, s22, 3277
    s_lshr_b32 s24, s24, 16
    s_mul_i32 s68, s24, 20
    s_sub_u32 s68, s22, s68
    s_cmp_lt_u32 s68, 8
    s_cselect_b64 s[66:67], s[84:85], s[86:87]
    s_cselect_b32 s25, 0, 8
    s_sub_u32 s68, s68, s25
    s_and_b32 s25, s68, 1
    s_lshr_b32 s68, s68, 1
    s_lshl_b32 s68, s68, 14
    s_lshl_b32 s25, s25, 12
    s_add_u32 s68, s68, s25
    s_lshl_b32 s24, s24, 5
    s_add_u32 s68, s68, s24
    v_lshrrev_b32 v2, 4, v176
    v_lshlrev_b32 v2, 10, v2
    v_and_b32 v3, 15, v176
    v_lshl_add_u32 v2, v3, 1, v2
    v_add_u32 v2, s68, v2
    v_add_u32 v3, 8192, v2
    v_mov_b32 v4, 0
    v_mov_b32 v5, 0
    v_mov_b32 v6, 0
    v_mov_b32 v7, 0
    global_load_ushort v120, v2, s[66:67] offset:0
    global_load_short_d16_hi v4, v3, s[66:67] offset:0
    global_load_ushort v121, v2, s[66:67] offset:256
    global_load_short_d16_hi v5, v3, s[66:67] offset:256
    global_load_ushort v122, v2, s[66:67] offset:512
    global_load_short_d16_hi v6, v3, s[66:67] offset:512
    global_load_ushort v123, v2, s[66:67] offset:768
    global_load_short_d16_hi v7, v3, s[66:67] offset:768
    s_add_u32 s22, s22, 1
    s_waitcnt vmcnt(0)
    v_or_b32 v120, v120, v4
    v_or_b32 v121, v121, v5
    v_or_b32 v122, v122, v6
    v_or_b32 v123, v123, v7
    s_mul_i32 s24, s22, 3277
    s_lshr_b32 s24, s24, 16
    s_mul_i32 s68, s24, 20
    s_sub_u32 s68, s22, s68
    s_cmp_lt_u32 s68, 8
    s_cselect_b64 s[66:67], s[84:85], s[86:87]
    s_cselect_b32 s25, 0, 8
    s_sub_u32 s68, s68, s25
    s_and_b32 s25, s68, 1
    s_lshr_b32 s68, s68, 1
    s_lshl_b32 s68, s68, 14
    s_lshl_b32 s25, s25, 12
    s_add_u32 s68, s68, s25
    s_lshl_b32 s24, s24, 5
    s_add_u32 s68, s68, s24
    v_lshrrev_b32 v2, 4, v176
    v_lshlrev_b32 v2, 10, v2
    v_and_b32 v3, 15, v176
    v_lshl_add_u32 v2, v3, 1, v2
    v_add_u32 v2, s68, v2
    v_add_u32 v3, 8192, v2
    v_mov_b32 v4, 0
    v_mov_b32 v5, 0
    v_mov_b32 v6, 0
    v_mov_b32 v7, 0
    global_load_ushort v124, v2, s[66:67] offset:0
    global_load_short_d16_hi v4, v3, s[66:67] offset:0
    global_load_ushort v125, v2, s[66:67] offset:256
    global_load_short_d16_hi v5, v3, s[66:67] offset:256
    global_load_ushort v126, v2, s[66:67] offset:512
    global_load_short_d16_hi v6, v3, s[66:67] offset:512
    global_load_ushort v127, v2, s[66:67] offset:768
    global_load_short_d16_hi v7, v3, s[66:67] offset:768
    s_add_u32 s22, s22, 1
    s_waitcnt vmcnt(0)
    v_or_b32 v124, v124, v4
    v_or_b32 v125, v125, v5
    v_or_b32 v126, v126, v6
    v_or_b32 v127, v127, v7
    s_mul_i32 s24, s22, 3277
    s_lshr_b32 s24, s24, 16
    s_mul_i32 s68, s24, 20
    s_sub_u32 s68, s22, s68
    s_cmp_lt_u32 s68, 8
    s_cselect_b64 s[66:67], s[84:85], s[86:87]
    s_cselect_b32 s25, 0, 8
    s_sub_u32 s68, s68, s25
    s_and_b32 s25, s68, 1
    s_lshr_b32 s68, s68, 1
    s_lshl_b32 s68, s68, 14
    s_lshl_b32 s25, s25, 12
    s_add_u32 s68, s68, s25
    s_lshl_b32 s24, s24, 5
    s_add_u32 s68, s68, s24
    v_lshrrev_b32 v2, 4, v176
    v_lshlrev_b32 v2, 10, v2
    v_and_b32 v3, 15, v176
    v_lshl_add_u32 v2, v3, 1, v2
    v_add_u32 v2, s68, v2
    v_add_u32 v3, 8192, v2
    v_mov_b32 v4, 0
    v_mov_b32 v5, 0
    v_mov_b32 v6, 0
    v_mov_b32 v7, 0
    global_load_ushort v128, v2, s[66:67] offset:0
    global_load_short_d16_hi v4, v3, s[66:67] offset:0
    global_load_ushort v129, v2, s[66:67] offset:256
    global_load_short_d16_hi v5, v3, s[66:67] offset:256
    global_load_ushort v130, v2, s[66:67] offset:512
    global_load_short_d16_hi v6, v3, s[66:67] offset:512
    global_load_ushort v131, v2, s[66:67] offset:768
    global_load_short_d16_hi v7, v3, s[66:67] offset:768
    s_add_u32 s22, s22, 1
    s_waitcnt vmcnt(0)
    v_or_b32 v128, v128, v4
    v_or_b32 v129, v129, v5
    v_or_b32 v130, v130, v6
    v_or_b32 v131, v131, v7
    s_mul_i32 s24, s22, 3277
    s_lshr_b32 s24, s24, 16
    s_mul_i32 s68, s24, 20
    s_sub_u32 s68, s22, s68
    s_cmp_lt_u32 s68, 8
    s_cselect_b64 s[66:67], s[84:85], s[86:87]
    s_cselect_b32 s25, 0, 8
    s_sub_u32 s68, s68, s25
    s_and_b32 s25, s68, 1
    s_lshr_b32 s68, s68, 1
    s_lshl_b32 s68, s68, 14
    s_lshl_b32 s25, s25, 12
    s_add_u32 s68, s68, s25
    s_lshl_b32 s24, s24, 5
    s_add_u32 s68, s68, s24
    v_lshrrev_b32 v2, 4, v176
    v_lshlrev_b32 v2, 10, v2
    v_and_b32 v3, 15, v176
    v_lshl_add_u32 v2, v3, 1, v2
    v_add_u32 v2, s68, v2
    v_add_u32 v3, 8192, v2
    v_mov_b32 v4, 0
    v_mov_b32 v5, 0
    v_mov_b32 v6, 0
    v_mov_b32 v7, 0
    global_load_ushort v132, v2, s[66:67] offset:0
    global_load_short_d16_hi v4, v3, s[66:67] offset:0
    global_load_ushort v133, v2, s[66:67] offset:256
    global_load_short_d16_hi v5, v3, s[66:67] offset:256
    global_load_ushort v134, v2, s[66:67] offset:512
    global_load_short_d16_hi v6, v3, s[66:67] offset:512
    global_load_ushort v135, v2, s[66:67] offset:768
    global_load_short_d16_hi v7, v3, s[66:67] offset:768
    s_add_u32 s22, s22, 1
    s_waitcnt vmcnt(0)
    v_or_b32 v132, v132, v4
    v_or_b32 v133, v133, v5
    v_or_b32 v134, v134, v6
    v_or_b32 v135, v135, v7
    s_mul_i32 s24, s22, 3277
    s_lshr_b32 s24, s24, 16
    s_mul_i32 s68, s24, 20
    s_sub_u32 s68, s22, s68
    s_cmp_lt_u32 s68, 8
    s_cselect_b64 s[66:67], s[84:85], s[86:87]
    s_cselect_b32 s25, 0, 8
    s_sub_u32 s68, s68, s25
    s_and_b32 s25, s68, 1
    s_lshr_b32 s68, s68, 1
    s_lshl_b32 s68, s68, 14
    s_lshl_b32 s25, s25, 12
    s_add_u32 s68, s68, s25
    s_lshl_b32 s24, s24, 5
    s_add_u32 s68, s68, s24
    v_lshrrev_b32 v2, 4, v176
    v_lshlrev_b32 v2, 10, v2
    v_and_b32 v3, 15, v176
    v_lshl_add_u32 v2, v3, 1, v2
    v_add_u32 v2, s68, v2
    v_add_u32 v3, 8192, v2
    v_mov_b32 v4, 0
    v_mov_b32 v5, 0
    v_mov_b32 v6, 0
    v_mov_b32 v7, 0
    global_load_ushort v152, v2, s[66:67] offset:0
    global_load_short_d16_hi v4, v3, s[66:67] offset:0
    global_load_ushort v153, v2, s[66:67] offset:256
    global_load_short_d16_hi v5, v3, s[66:67] offset:256
    global_load_ushort v154, v2, s[66:67] offset:512
    global_load_short_d16_hi v6, v3, s[66:67] offset:512
    global_load_ushort v155, v2, s[66:67] offset:768
    global_load_short_d16_hi v7, v3, s[66:67] offset:768
    s_add_u32 s22, s22, 1
    s_waitcnt vmcnt(0)
    v_or_b32 v152, v152, v4
    v_or_b32 v153, v153, v5
    v_or_b32 v154, v154, v6
    v_or_b32 v155, v155, v7
    s_mul_i32 s24, s22, 3277
    s_lshr_b32 s24, s24, 16
    s_mul_i32 s68, s24, 20
    s_sub_u32 s68, s22, s68
    s_cmp_lt_u32 s68, 8
    s_cselect_b64 s[66:67], s[84:85], s[86:87]
    s_cselect_b32 s25, 0, 8
    s_sub_u32 s68, s68, s25
    s_and_b32 s25, s68, 1
    s_lshr_b32 s68, s68, 1
    s_lshl_b32 s68, s68, 14
    s_lshl_b32 s25, s25, 12
    s_add_u32 s68, s68, s25
    s_lshl_b32 s24, s24, 5
    s_add_u32 s68, s68, s24
    v_lshrrev_b32 v2, 4, v176
    v_lshlrev_b32 v2, 10, v2
    v_and_b32 v3, 15, v176
    v_lshl_add_u32 v2, v3, 1, v2
    v_add_u32 v2, s68, v2
    v_add_u32 v3, 8192, v2
    v_mov_b32 v4, 0
    v_mov_b32 v5, 0
    v_mov_b32 v6, 0
    v_mov_b32 v7, 0
    global_load_ushort v156, v2, s[66:67] offset:0
    global_load_short_d16_hi v4, v3, s[66:67] offset:0
    global_load_ushort v157, v2, s[66:67] offset:256
    global_load_short_d16_hi v5, v3, s[66:67] offset:256
    global_load_ushort v158, v2, s[66:67] offset:512
    global_load_short_d16_hi v6, v3, s[66:67] offset:512
    global_load_ushort v159, v2, s[66:67] offset:768
    global_load_short_d16_hi v7, v3, s[66:67] offset:768
    s_add_u32 s22, s22, 1
    s_waitcnt vmcnt(0)
    v_or_b32 v156, v156, v4
    v_or_b32 v157, v157, v5
    v_or_b32 v158, v158, v6
    v_or_b32 v159, v159, v7
    s_mul_i32 s24, s22, 3277
    s_lshr_b32 s24, s24, 16
    s_mul_i32 s68, s24, 20
    s_sub_u32 s68, s22, s68
    s_cmp_lt_u32 s68, 8
    s_cselect_b64 s[66:67], s[84:85], s[86:87]
    s_cselect_b32 s25, 0, 8
    s_sub_u32 s68, s68, s25
    s_and_b32 s25, s68, 1
    s_lshr_b32 s68, s68, 1
    s_lshl_b32 s68, s68, 14
    s_lshl_b32 s25, s25, 12
    s_add_u32 s68, s68, s25
    s_lshl_b32 s24, s24, 5
    s_add_u32 s68, s68, s24
    v_lshrrev_b32 v2, 4, v176
    v_lshlrev_b32 v2, 10, v2
    v_and_b32 v3, 15, v176
    v_lshl_add_u32 v2, v3, 1, v2
    v_add_u32 v2, s68, v2
    v_add_u32 v3, 8192, v2
    v_mov_b32 v4, 0
    v_mov_b32 v5, 0
    v_mov_b32 v6, 0
    v_mov_b32 v7, 0
    global_load_ushort v136, v2, s[66:67] offset:0
    global_load_short_d16_hi v4, v3, s[66:67] offset:0
    global_load_ushort v137, v2, s[66:67] offset:256
    global_load_short_d16_hi v5, v3, s[66:67] offset:256
    global_load_ushort v138, v2, s[66:67] offset:512
    global_load_short_d16_hi v6, v3, s[66:67] offset:512
    global_load_ushort v139, v2, s[66:67] offset:768
    global_load_short_d16_hi v7, v3, s[66:67] offset:768
    s_add_u32 s22, s22, 1
    s_waitcnt vmcnt(0)
    v_or_b32 v136, v136, v4
    v_or_b32 v137, v137, v5
    v_or_b32 v138, v138, v6
    v_or_b32 v139, v139, v7
    s_mul_i32 s24, s22, 3277
    s_lshr_b32 s24, s24, 16
    s_mul_i32 s68, s24, 20
    s_sub_u32 s68, s22, s68
    s_cmp_lt_u32 s68, 8
    s_cselect_b64 s[66:67], s[84:85], s[86:87]
    s_cselect_b32 s25, 0, 8
    s_sub_u32 s68, s68, s25
    s_and_b32 s25, s68, 1
    s_lshr_b32 s68, s68, 1
    s_lshl_b32 s68, s68, 14
    s_lshl_b32 s25, s25, 12
    s_add_u32 s68, s68, s25
    s_lshl_b32 s24, s24, 5
    s_add_u32 s68, s68, s24
    v_lshrrev_b32 v2, 4, v176
    v_lshlrev_b32 v2, 10, v2
    v_and_b32 v3, 15, v176
    v_lshl_add_u32 v2, v3, 1, v2
    v_add_u32 v2, s68, v2
    v_add_u32 v3, 8192, v2
    v_mov_b32 v4, 0
    v_mov_b32 v5, 0
    v_mov_b32 v6, 0
    v_mov_b32 v7, 0
    global_load_ushort v140, v2, s[66:67] offset:0
    global_load_short_d16_hi v4, v3, s[66:67] offset:0
    global_load_ushort v141, v2, s[66:67] offset:256
    global_load_short_d16_hi v5, v3, s[66:67] offset:256
    global_load_ushort v142, v2, s[66:67] offset:512
    global_load_short_d16_hi v6, v3, s[66:67] offset:512
    global_load_ushort v143, v2, s[66:67] offset:768
    global_load_short_d16_hi v7, v3, s[66:67] offset:768
    s_add_u32 s22, s22, 1
    s_waitcnt vmcnt(0)
    v_or_b32 v140, v140, v4
    v_or_b32 v141, v141, v5
    v_or_b32 v142, v142, v6
    v_or_b32 v143, v143, v7
    s_mul_i32 s24, s22, 3277
    s_lshr_b32 s24, s24, 16
    s_mul_i32 s68, s24, 20
    s_sub_u32 s68, s22, s68
    s_cmp_lt_u32 s68, 8
    s_cselect_b64 s[66:67], s[84:85], s[86:87]
    s_cselect_b32 s25, 0, 8
    s_sub_u32 s68, s68, s25
    s_and_b32 s25, s68, 1
    s_lshr_b32 s68, s68, 1
    s_lshl_b32 s68, s68, 14
    s_lshl_b32 s25, s25, 12
    s_add_u32 s68, s68, s25
    s_lshl_b32 s24, s24, 5
    s_add_u32 s68, s68, s24
    v_lshrrev_b32 v2, 4, v176
    v_lshlrev_b32 v2, 10, v2
    v_and_b32 v3, 15, v176
    v_lshl_add_u32 v2, v3, 1, v2
    v_add_u32 v2, s68, v2
    v_add_u32 v3, 8192, v2
    v_mov_b32 v4, 0
    v_mov_b32 v5, 0
    v_mov_b32 v6, 0
    v_mov_b32 v7, 0
    global_load_ushort v168, v2, s[66:67] offset:0
    global_load_short_d16_hi v4, v3, s[66:67] offset:0
    global_load_ushort v169, v2, s[66:67] offset:256
    global_load_short_d16_hi v5, v3, s[66:67] offset:256
    global_load_ushort v170, v2, s[66:67] offset:512
    global_load_short_d16_hi v6, v3, s[66:67] offset:512
    global_load_ushort v171, v2, s[66:67] offset:768
    global_load_short_d16_hi v7, v3, s[66:67] offset:768
    s_add_u32 s22, s22, 1
    s_waitcnt vmcnt(0)
    v_or_b32 v168, v168, v4
    v_or_b32 v169, v169, v5
    v_or_b32 v170, v170, v6
    v_or_b32 v171, v171, v7
    s_mul_i32 s24, s22, 3277
    s_lshr_b32 s24, s24, 16
    s_mul_i32 s68, s24, 20
    s_sub_u32 s68, s22, s68
    s_cmp_lt_u32 s68, 8
    s_cselect_b64 s[66:67], s[84:85], s[86:87]
    s_cselect_b32 s25, 0, 8
    s_sub_u32 s68, s68, s25
    s_and_b32 s25, s68, 1
    s_lshr_b32 s68, s68, 1
    s_lshl_b32 s68, s68, 14
    s_lshl_b32 s25, s25, 12
    s_add_u32 s68, s68, s25
    s_lshl_b32 s24, s24, 5
    s_add_u32 s68, s68, s24
    v_lshrrev_b32 v2, 4, v176
    v_lshlrev_b32 v2, 10, v2
    v_and_b32 v3, 15, v176
    v_lshl_add_u32 v2, v3, 1, v2
    v_add_u32 v2, s68, v2
    v_add_u32 v3, 8192, v2
    v_mov_b32 v4, 0
    v_mov_b32 v5, 0
    v_mov_b32 v6, 0
    v_mov_b32 v7, 0
    global_load_ushort v172, v2, s[66:67] offset:0
    global_load_short_d16_hi v4, v3, s[66:67] offset:0
    global_load_ushort v173, v2, s[66:67] offset:256
    global_load_short_d16_hi v5, v3, s[66:67] offset:256
    global_load_ushort v174, v2, s[66:67] offset:512
    global_load_short_d16_hi v6, v3, s[66:67] offset:512
    global_load_ushort v175, v2, s[66:67] offset:768
    global_load_short_d16_hi v7, v3, s[66:67] offset:768
    s_add_u32 s22, s22, 1
    s_waitcnt vmcnt(0)
    v_or_b32 v172, v172, v4
    v_or_b32 v173, v173, v5
    v_or_b32 v174, v174, v6
    v_or_b32 v175, v175, v7
    s_mul_i32 s24, s22, 3277
    s_lshr_b32 s24, s24, 16
    s_mul_i32 s68, s24, 20
    s_sub_u32 s68, s22, s68
    s_cmp_lt_u32 s68, 8
    s_cselect_b64 s[66:67], s[84:85], s[86:87]
    s_cselect_b32 s25, 0, 8
    s_sub_u32 s68, s68, s25
    s_and_b32 s25, s68, 1
    s_lshr_b32 s68, s68, 1
    s_lshl_b32 s68, s68, 14
    s_lshl_b32 s25, s25, 12
    s_add_u32 s68, s68, s25
    s_lshl_b32 s24, s24, 5
    s_add_u32 s68, s68, s24
    v_lshrrev_b32 v2, 4, v176
    v_lshlrev_b32 v2, 10, v2
    v_and_b32 v3, 15, v176
    v_lshl_add_u32 v2, v3, 1, v2
    v_add_u32 v2, s68, v2
    v_add_u32 v3, 8192, v2
    v_mov_b32 v4, 0
    v_mov_b32 v5, 0
    v_mov_b32 v6, 0
    v_mov_b32 v7, 0
    global_load_ushort v112, v2, s[66:67] offset:0
    global_load_short_d16_hi v4, v3, s[66:67] offset:0
    global_load_ushort v113, v2, s[66:67] offset:256
    global_load_short_d16_hi v5, v3, s[66:67] offset:256
    global_load_ushort v114, v2, s[66:67] offset:512
    global_load_short_d16_hi v6, v3, s[66:67] offset:512
    global_load_ushort v115, v2, s[66:67] offset:768
    global_load_short_d16_hi v7, v3, s[66:67] offset:768
    s_add_u32 s22, s22, 1
    s_waitcnt vmcnt(0)
    v_or_b32 v112, v112, v4
    v_or_b32 v113, v113, v5
    v_or_b32 v114, v114, v6
    v_or_b32 v115, v115, v7
    s_mul_i32 s24, s22, 3277
    s_lshr_b32 s24, s24, 16
    s_mul_i32 s68, s24, 20
    s_sub_u32 s68, s22, s68
    s_cmp_lt_u32 s68, 8
    s_cselect_b64 s[66:67], s[84:85], s[86:87]
    s_cselect_b32 s25, 0, 8
    s_sub_u32 s68, s68, s25
    s_and_b32 s25, s68, 1
    s_lshr_b32 s68, s68, 1
    s_lshl_b32 s68, s68, 14
    s_lshl_b32 s25, s25, 12
    s_add_u32 s68, s68, s25
    s_lshl_b32 s24, s24, 5
    s_add_u32 s68, s68, s24
    v_lshrrev_b32 v2, 4, v176
    v_lshlrev_b32 v2, 10, v2
    v_and_b32 v3, 15, v176
    v_lshl_add_u32 v2, v3, 1, v2
    v_add_u32 v2, s68, v2
    v_add_u32 v3, 8192, v2
    v_mov_b32 v4, 0
    v_mov_b32 v5, 0
    v_mov_b32 v6, 0
    v_mov_b32 v7, 0
    global_load_ushort v116, v2, s[66:67] offset:0
    global_load_short_d16_hi v4, v3, s[66:67] offset:0
    global_load_ushort v117, v2, s[66:67] offset:256
    global_load_short_d16_hi v5, v3, s[66:67] offset:256
    global_load_ushort v118, v2, s[66:67] offset:512
    global_load_short_d16_hi v6, v3, s[66:67] offset:512
    global_load_ushort v119, v2, s[66:67] offset:768
    global_load_short_d16_hi v7, v3, s[66:67] offset:768
    s_add_u32 s22, s22, 1
    s_waitcnt vmcnt(0)
    v_or_b32 v116, v116, v4
    v_or_b32 v117, v117, v5
    v_or_b32 v118, v118, v6
    v_or_b32 v119, v119, v7
    s_load_dwordx2 s[72:73], s[0:1], 72
    v_lshlrev_b32 v246, 4, v176
    s_mov_b32 s52, 163072
    v_bfe_u32 v177, v246, 4, 4
    v_bfe_u32 v179, v246, 4, 3
    v_lshl_add_u32 v180, v177, 3, s52
    v_lshl_add_u32 v190, v177, 4, s52
    v_lshl_add_u32 v181, v179, 3, s52
    ds_read2_b64 v[182:185], v180 offset0:32 offset1:48
    ds_read_b32 v191, v190
    ds_read_b64 v[186:187], v181 offset:512
    v_lshrrev_b32 v178, 8, v246
    s_add_u32 s22, s20, 0
    s_mul_i32 s28, s22, 1536
    s_add_u32 s28, s28, 86016
    s_lshl_b32 s22, s22, 21
    s_add_u32 s23, s20, 8
    s_mul_i32 s29, s23, 1536
    s_add_u32 s29, s29, 86144
    s_lshl_b32 s23, s23, 21
    s_add_u32 s24, s20, 16
    s_mul_i32 s30, s24, 1536
    s_add_u32 s30, s30, 86016
    s_lshl_b32 s24, s24, 21
    s_add_u32 s25, s20, 24
    s_lshl_b32 s25, s25, 21
    s_add_u32 s26, s20, 32
    s_lshl_b32 s26, s26, 21
    s_mov_b32 s53, 0
    s_mov_b32 s50, 0
    s_waitcnt lgkmcnt(0)
    s_branch GEMM
.section .rodata,"a"
.p2align 6
.amdhsa_kernel standalone__tensor_product_equiv_equiformer__graph_kernel
  .amdhsa_next_free_vgpr 256
  .amdhsa_next_free_sgpr 90
  .amdhsa_accum_offset 256
  .amdhsa_group_segment_fixed_size 0
  .amdhsa_kernarg_size 96
  .amdhsa_user_sgpr_count 2
  .amdhsa_user_sgpr_kernarg_segment_ptr 1
  .amdhsa_system_sgpr_workgroup_id_x 1
.end_amdhsa_kernel
```

```asm
; @launch grid=(250,1,1) block=(512,1,1) lds=163840
.amdgcn_target "amdgcn-amd-amdhsa--gfx950"
.text
.globl standalone__tensor_product_equiv_equiformer__graph_kernel
.p2align 8
.type standalone__tensor_product_equiv_equiformer__graph_kernel,@function
standalone__tensor_product_equiv_equiformer__graph_kernel:
    s_cmp_ge_u32 s2, 250
    s_cbranch_scc1 K2_end
    s_load_dwordx16 s[72:87], s[0:1], 0
    s_load_dwordx2 s[70:71], s[0:1], 88
    v_lshrrev_b32 v2, 6, v0
    v_and_b32 v1, 63, v0
    v_readfirstlane_b32 s20, v2
    s_getpc_b64 s[66:67]
    v_lshlrev_b32 v95, 7, v1
    s_cmp_eq_u32 s20, 6
    s_cbranch_scc0 F_nopf0
    global_load_dword v95, v95, s[66:67]
F_nopf0:
    s_mul_i32 s66, s2, 5120
    s_mul_i32 s67, s2, 7680
    v_lshl_add_u32 v3, v0, 4, s66
    v_mul_u32_u24 v4, 24, v0
    v_add_u32 v4, s67, v4
    v_lshlrev_b32 v5, 2, v0
    v_mov_b32 v89, 0
    v_add_u32 v6, 98304, v5
    ds_write_b32 v6, v89
    s_cmp_ge_u32 s20, 5
    s_waitcnt lgkmcnt(0)
    s_cbranch_scc1 F_noload
    global_load_dwordx4 v[8:11], v3, s[80:81] nt
    global_load_dwordx4 v[12:15], v3, s[78:79] nt
    global_load_dwordx4 v[16:19], v4, s[74:75] nt
    global_load_dwordx2 v[20:21], v4, s[74:75] offset:16 nt
F_noload:
    s_load_dword s88, s[70:71], 0
    s_barrier
    v_lshlrev_b32 v248, 2, v1
    v_add_u32 v88, 162816, v248
    ds_write_b32 v88, v89
    ds_write_b32 v88, v89 offset:256
    v_lshlrev_b32 v86, 4, v1
    s_lshl_b32 s21, s20, 13
    s_lshl_b32 s66, s20, 10
    s_add_u32 s66, s66, 0
    v_add_u32 v96, s66, v86
    v_lshrrev_b32 v6, 8, v96
    v_mul_u32_u24 v6, 205, v6
    v_bfe_u32 v7, v6, 12, 1
    v_bfe_u32 v6, v6, 10, 1
    v_lshl_or_b32 v6, v7, 1, v6
    v_lshlrev_b32 v6, 6, v6
    v_xor_b32 v96, v96, v6
    s_lshl_b32 s66, s20, 10
    s_add_u32 s66, s66, 8192
    v_add_u32 v97, s66, v86
    v_lshrrev_b32 v6, 8, v97
    v_mul_u32_u24 v6, 205, v6
    v_bfe_u32 v7, v6, 12, 1
    v_bfe_u32 v6, v6, 10, 1
    v_lshl_or_b32 v6, v7, 1, v6
    v_lshlrev_b32 v6, 6, v6
    v_xor_b32 v97, v97, v6
    s_lshl_b32 s66, s20, 10
    s_add_u32 s66, s66, 16384
    v_add_u32 v98, s66, v86
    v_lshrrev_b32 v6, 8, v98
    v_mul_u32_u24 v6, 205, v6
    v_bfe_u32 v7, v6, 12, 1
    v_bfe_u32 v6, v6, 10, 1
    v_lshl_or_b32 v6, v7, 1, v6
    v_lshlrev_b32 v6, 6, v6
    v_xor_b32 v98, v98, v6
    v_mov_b32 v180, 0
    v_mov_b32 v181, 0
    v_mov_b32 v182, 0
    v_mov_b32 v183, 0
    s_mov_b32 s16, s70
    s_and_b32 s17, s71, 0xffff
    s_mov_b32 s18, 24165888
    s_mov_b32 s19, 0x20000
    v_lshrrev_b32 v2, 3, v1
    v_lshl_add_u32 v2, s20, 5, v2
    v_and_b32 v91, 7, v1
    v_mul_u32_u24 v94, 384, v2
    v_lshl_add_u32 v94, v91, 4, v94
    v_lshlrev_b32 v93, 2, v2
    v_add_u32 v93, 98304, v93
    v_mul_u32_u24 v92, 32000, v2
    v_lshl_add_u32 v92, v91, 4, v92
    v_mul_u32_u24 v90, 40960, v2
    s_mov_b32 s32, s82
    s_and_b32 s33, s83, 0xffff
    s_mov_b32 s34, 20480
    s_mov_b32 s35, 0x20000
    s_cmp_ge_u32 s20, 5
    s_cbranch_scc1 F_helper
    s_mov_b32 s22, 52429
    s_mov_b32 s23, 0x05040100
    s_mov_b32 s66, 98304
    s_movk_i32 s67, -40
    v_mov_b32 v7, 1
    v_add_u32 v31, 1, v5
    v_add_u32 v32, 2, v5
    v_add_u32 v33, 3, v5
    s_waitcnt vmcnt(3)
    v_mul_u32_u24 v22, s22, v8
    v_mul_u32_u24 v23, s22, v9
    v_mul_u32_u24 v24, s22, v10
    v_mul_u32_u24 v25, s22, v11
    v_lshrrev_b32 v22, 21, v22
    v_lshrrev_b32 v23, 21, v23
    v_lshrrev_b32 v24, 21, v24
    v_lshrrev_b32 v25, 21, v25
    v_lshl_add_u32 v34, v22, 2, s66
    ds_add_rtn_u32 v26, v34, v7
    v_lshl_add_u32 v35, v23, 2, s66
    ds_add_rtn_u32 v27, v35, v7
    v_lshl_add_u32 v36, v24, 2, s66
    ds_add_rtn_u32 v28, v36, v7
    v_lshl_add_u32 v37, v25, 2, s66
    ds_add_rtn_u32 v29, v37, v7
    v_mad_i32_i24 v2, v22, s67, v8
    v_mul_u32_u24 v22, 384, v22
    v_lshl_or_b32 v42, v2, 11, v5
    v_mad_i32_i24 v2, v23, s67, v9
    v_mul_u32_u24 v23, 384, v23
    v_lshl_or_b32 v46, v2, 11, v31
    v_mad_i32_i24 v2, v24, s67, v10
    v_mul_u32_u24 v24, 384, v24
    v_lshl_or_b32 v50, v2, 11, v32
    v_mad_i32_i24 v2, v25, s67, v11
    v_mul_u32_u24 v25, 384, v25
    v_lshl_or_b32 v54, v2, 11, v33
    s_waitcnt vmcnt(0)
    v_mov_b32 v40, v16
    v_perm_b32 v41, v12, v17, s23
    v_alignbit_b32 v44, v18, v17, 16
    v_alignbit_b32 v45, v13, v18, 16
    v_mov_b32 v48, v19
    v_perm_b32 v49, v14, v20, s23
    v_alignbit_b32 v52, v21, v20, 16
    v_alignbit_b32 v53, v15, v21, 16
    v_xor_b32 v41, 0x8000, v41
    v_xor_b32 v45, 0x8000, v45
    v_xor_b32 v49, 0x8000, v49
    v_xor_b32 v53, 0x8000, v53
    s_waitcnt lgkmcnt(0)
    v_min_u32 v26, 23, v26
    v_lshl_add_u32 v34, v26, 4, v22
    ds_write_b128 v34, v[40:43]
    v_min_u32 v27, 23, v27
    v_lshl_add_u32 v35, v27, 4, v23
    ds_write_b128 v35, v[44:47]
    v_min_u32 v28, 23, v28
    v_lshl_add_u32 v36, v28, 4, v24
    ds_write_b128 v36, v[48:51]
    v_min_u32 v29, 23, v29
    v_lshl_add_u32 v37, v29, 4, v25
    ds_write_b128 v37, v[52:55]
    s_branch F_staged
F_helper:
    s_cmp_eq_u32 s20, 5
    s_cbranch_scc0 F_nowp
    v_lshlrev_b32 v2, 7, v1
    s_movk_i32 s66, 0
    buffer_load_dword v95, v2, s[32:35], s66 offen
    s_movk_i32 s66, 8192
    buffer_load_dword v95, v2, s[32:35], s66 offen
    s_movk_i32 s66, 16384
    v_min_u32 v2, 3968, v2
    buffer_load_dword v95, v2, s[32:35], s66 offen
F_nowp:
    s_cmp_eq_u32 s20, 6
    s_cbranch_scc0 F_nopf
    s_getpc_b64 s[66:67]
F_pc:
    s_lshr_b32 s68, s2, 3
    s_mul_i32 s68, s68, ((K2_last-F_pc)/128/31+1)*128
    v_lshl_add_u32 v2, v1, 7, s68
    v_min_u32 v2, K2_last-F_pc-4, v2
    v_cmp_gt_u32 vcc, (K2_last-F_pc)/128/31+1, v1
    s_mov_b64 exec, vcc
    global_load_dword v95, v2, s[66:67]
    s_mov_b64 exec, -1
F_nopf:
    s_cmp_eq_u32 s20, 7
    s_cbranch_scc0 F_staged
    s_cmp_lt_u32 s2, 160
    s_cbranch_scc0 F_staged
    s_mul_i32 s22, s2, 3277
    s_lshr_b32 s22, s22, 16
    s_mul_i32 s68, s22, 20
    s_sub_u32 s68, s2, s68
    s_cmp_lt_u32 s68, 8
    s_cselect_b64 s[66:67], s[84:85], s[86:87]
    s_cselect_b32 s23, 0, 8
    s_sub_u32 s68, s68, s23
    s_and_b32 s23, s68, 1
    s_lshr_b32 s68, s68, 1
    s_lshl_b32 s68, s68, 14
    s_lshl_b32 s23, s23, 12
    s_add_u32 s68, s68, s23
    s_lshl_b32 s22, s22, 5
    s_add_u32 s68, s68, s22
    v_lshrrev_b32 v2, 4, v1
    v_lshlrev_b32 v2, 10, v2
    v_and_b32 v3, 15, v1
    v_lshl_add_u32 v2, v3, 1, v2
    v_add_u32 v2, s68, v2
    v_add_u32 v3, 8192, v2
    global_load_ushort v176, v2, s[66:67] offset:0
    global_load_short_d16_hi v180, v3, s[66:67] offset:0
    global_load_ushort v177, v2, s[66:67] offset:256
    global_load_short_d16_hi v181, v3, s[66:67] offset:256
    global_load_ushort v178, v2, s[66:67] offset:512
    global_load_short_d16_hi v182, v3, s[66:67] offset:512
    global_load_ushort v179, v2, s[66:67] offset:768
    global_load_short_d16_hi v183, v3, s[66:67] offset:768
F_staged:
    s_lshl_b32 s66, s2, 7
    s_add_u32 s66, s66, 164864
    s_cmp_eq_u32 s20, 7
    s_cselect_b32 s22, 0xffff, -1
    s_cselect_b32 s23, 0, -1
    s_waitcnt lgkmcnt(0)
    s_add_u32 s88, s88, 1
    s_barrier
    s_setprio 1
    ds_read_b32 v40, v93 offset:0
    ds_read_b128 v[8:11], v94 offset:0
    ds_read_b32 v14, v94 offset:136
    ds_read_b32 v41, v93 offset:32
    ds_read_b128 v[16:19], v94 offset:3072
    ds_read_b32 v22, v94 offset:3208
    ds_read_b32 v42, v93 offset:64
    ds_read_b128 v[24:27], v94 offset:6144
    ds_read_b32 v30, v94 offset:6280
    ds_read_b32 v43, v93 offset:96
    ds_read_b128 v[32:35], v94 offset:9216
    ds_read_b32 v38, v94 offset:9352
    s_add_u32 s28, s66, 0
    s_add_u32 s29, s66, 256000
    s_add_u32 s30, s66, 512000
    s_add_u32 s31, s66, 768000
    s_waitcnt lgkmcnt(9)
    v_min_u32 v5, 31, v40
    v_bfe_u32 v6, v14, 11, 6
    v_and_b32 v10, 0x1ffff, v10
    v_lshl_or_b32 v6, v5, 6, v6
    v_mov_b32 v11, s88
    v_lshl_or_b32 v10, v6, 17, v10
    buffer_store_dwordx4 v[8:11], v92, s[16:19], s28 offen sc1
    s_waitcnt lgkmcnt(6)
    v_min_u32 v5, 31, v41
    v_bfe_u32 v6, v22, 11, 6
    v_and_b32 v18, 0x1ffff, v18
    v_lshl_or_b32 v6, v5, 6, v6
    v_mov_b32 v19, s88
    v_lshl_or_b32 v18, v6, 17, v18
    buffer_store_dwordx4 v[16:19], v92, s[16:19], s29 offen sc1
    s_waitcnt lgkmcnt(3)
    v_min_u32 v5, 31, v42
    v_bfe_u32 v6, v30, 11, 6
    v_and_b32 v26, 0x1ffff, v26
    v_lshl_or_b32 v6, v5, 6, v6
    v_mov_b32 v27, s88
    v_lshl_or_b32 v26, v6, 17, v26
    buffer_store_dwordx4 v[24:27], v92, s[16:19], s30 offen sc1
    s_waitcnt lgkmcnt(0)
    v_min_u32 v5, 31, v43
    v_bfe_u32 v6, v38, 11, 6
    v_and_b32 v34, 0x1ffff, v34
    v_lshl_or_b32 v6, v5, 6, v6
    v_mov_b32 v35, s88
    v_lshl_or_b32 v34, v6, 17, v34
    s_mov_b64 exec, s[22:23]
    buffer_store_dwordx4 v[32:35], v92, s[16:19], s31 offen sc1
    s_mov_b64 exec, -1
    s_setprio 0
    ds_read_b128 v[12:15], v94 offset:128
    ds_read_b128 v[20:23], v94 offset:3200
    ds_read_b128 v[28:31], v94 offset:6272
    ds_read_b128 v[36:39], v94 offset:9344
    s_waitcnt vmcnt(4)
F_now:
    v_cmp_lt_u32 vcc, 8, v40
    s_add_u32 s67, s28, 8000000
    s_waitcnt lgkmcnt(3)
    v_mov_b32 v15, s88
    s_mov_b64 exec, vcc
    s_cbranch_execz F_w0
    buffer_store_dwordx4 v[12:15], v92, s[16:19], s67 offen sc1
    v_cmp_lt_u32 vcc, 16, v40
    s_add_u32 s67, s67, 8000000
    s_mov_b64 exec, vcc
    s_cbranch_execz F_w0
    ds_read_b128 v[44:47], v94 offset:256
    s_waitcnt lgkmcnt(0)
    v_mov_b32 v47, s88
    buffer_store_dwordx4 v[44:47], v92, s[16:19], s67 offen sc1
    s_nop 1
F_w0:
    s_mov_b64 exec, -1
    v_cmp_lt_u32 vcc, 8, v41
    s_add_u32 s67, s29, 8000000
    s_waitcnt lgkmcnt(2)
    v_mov_b32 v23, s88
    s_mov_b64 exec, vcc
    s_cbranch_execz F_w1
    buffer_store_dwordx4 v[20:23], v92, s[16:19], s67 offen sc1
    v_cmp_lt_u32 vcc, 16, v41
    s_add_u32 s67, s67, 8000000
    s_mov_b64 exec, vcc
    s_cbranch_execz F_w1
    ds_read_b128 v[44:47], v94 offset:3328
    s_waitcnt lgkmcnt(0)
    v_mov_b32 v47, s88
    buffer_store_dwordx4 v[44:47], v92, s[16:19], s67 offen sc1
    s_nop 1
F_w1:
    s_mov_b64 exec, -1
    v_cmp_lt_u32 vcc, 8, v42
    s_add_u32 s67, s30, 8000000
    s_waitcnt lgkmcnt(1)
    v_mov_b32 v31, s88
    s_mov_b64 exec, vcc
    s_cbranch_execz F_w2
    buffer_store_dwordx4 v[28:31], v92, s[16:19], s67 offen sc1
    v_cmp_lt_u32 vcc, 16, v42
    s_add_u32 s67, s67, 8000000
    s_mov_b64 exec, vcc
    s_cbranch_execz F_w2
    ds_read_b128 v[44:47], v94 offset:6400
    s_waitcnt lgkmcnt(0)
    v_mov_b32 v47, s88
    buffer_store_dwordx4 v[44:47], v92, s[16:19], s67 offen sc1
    s_nop 1
F_w2:
    s_mov_b64 exec, -1
    v_cmp_lt_u32 vcc, 8, v43
    s_add_u32 s67, s31, 8000000
    s_and_b64 vcc, vcc, s[22:23]
    s_waitcnt lgkmcnt(0)
    v_mov_b32 v39, s88
    s_mov_b64 exec, vcc
    s_cbranch_execz F_w3
    buffer_store_dwordx4 v[36:39], v92, s[16:19], s67 offen sc1
    v_cmp_lt_u32 vcc, 16, v43
    s_add_u32 s67, s67, 8000000
    s_mov_b64 exec, vcc
    s_cbranch_execz F_w3
    ds_read_b128 v[44:47], v94 offset:9472
    s_waitcnt lgkmcnt(0)
    v_mov_b32 v47, s88
    buffer_store_dwordx4 v[44:47], v92, s[16:19], s67 offen sc1
    s_nop 1
F_w3:
    s_mov_b64 exec, -1
    s_cmp_eq_u32 s20, 7
    s_cbranch_scc0 F_nofrag
    s_cmp_lt_u32 s2, 160
    s_cbranch_scc0 F_nofrag
    v_or_b32 v176, v176, v180
    v_or_b32 v177, v177, v181
    v_or_b32 v178, v178, v182
    v_or_b32 v179, v179, v183
    s_lshl_b32 s66, s2, 10
    s_add_u32 s66, s66, 1024
    buffer_store_dwordx4 v[176:179], v86, s[16:19], s66 offen sc1
F_nofrag:
    s_barrier
    s_mul_i32 s24, s2, 32000
    s_lshl_b32 s25, s20, 12
    s_add_u32 s24, s24, s25
    s_add_u32 s24, s24, 164864
    s_add_u32 s25, s24, 8000000
    s_add_u32 s26, s25, 8000000
    v_mov_b32 v22, 0
    v_mov_b32 v23, s88
    s_lshl_b32 s68, s20, 10
    s_add_u32 m0, s68, 65536
    s_nop 0
    buffer_load_dwordx4 v96, s[32:35], 0 offen lds
    s_add_u32 m0, s68, 73728
    s_nop 0
    buffer_load_dwordx4 v97, s[32:35], 0 offen lds
    s_cmp_ge_u32 s20, 4
    s_cbranch_scc1 F_now2
    s_add_u32 m0, s68, 81920
    s_nop 0
    buffer_load_dwordx4 v98, s[32:35], 0 offen lds
F_now2:
    v_mov_b32 v4, 2130738944
    v_mov_b32 v5, 2130738944
    v_mov_b32 v6, 2130738944
    v_mov_b32 v7, 2130738944
    v_lshlrev_b32 v2, 4, v0
    v_add_u32 v3, 86016, v2
    ds_write_b128 v3, v[4:7] offset:0
    ds_write_b128 v3, v[4:7] offset:8192
    ds_write_b128 v3, v[4:7] offset:16384
    ds_write_b128 v3, v[4:7] offset:24576
    ds_write_b128 v3, v[4:7] offset:32768
    ds_write_b128 v3, v[4:7] offset:40960
    ds_write_b128 v3, v[4:7] offset:49152
    ds_write_b128 v3, v[4:7] offset:57344
    v_add_u32 v3, 0x10000, v3
    ds_write_b128 v3, v[4:7] offset:0
    v_min_u32 v2, 3056, v2
    v_add_u32 v2, 159744, v2
    ds_write_b128 v2, v[4:7]
    s_sub_u32 s72, s72, 128
    s_subb_u32 s73, s73, 0
    s_mov_b32 s4, s72
    s_and_b32 s5, s73, 0xffff
    s_mov_b32 s6, 10240000
    s_mov_b32 s7, 0x20000
    s_sub_u32 s72, s72, 1024
    s_subb_u32 s73, s73, 0
    s_mov_b32 s8, s72
    s_and_b32 s9, s73, 0xffff
    s_mov_b32 s10, 10241024
    s_mov_b32 s11, 0x20000
    s_mov_b32 s12, s76
    s_and_b32 s13, s77, 0xffff
    s_mov_b32 s14, 10240000
    s_mov_b32 s15, 0x20000
    v_lshrrev_b32 v2, 5, v1
    v_bfe_u32 v3, v1, 2, 2
    v_and_b32 v4, 3, v1
    v_bfe_u32 v5, v1, 4, 1
    v_lshlrev_b32 v6, 9, v2
    v_lshl_add_u32 v6, v3, 7, v6
    v_lshl_add_u32 v6, v5, 5, v6
    v_lshl_add_u32 v6, v4, 3, v6
    v_lshrrev_b32 v7, 1, v3
    v_lshl_add_u32 v6, v7, 6, v6
    v_add_u32 v244, s21, v6
    v_xor_b32 v245, 64, v244
    v_lshlrev_b32 v6, 7, v2
    v_lshl_add_u32 v6, v7, 5, v6
    v_and_b32 v7, 1, v3
    v_xor_b32 v7, 1, v7
    v_mul_u32_u24 v7, 90112, v7
    v_add_u32 v6, v6, v7
    v_lshl_add_u32 v249, v4, 3, v6
    v_lshl_add_u32 v6, v2, 2, v4
    v_bfe_u32 v7, v1, 2, 1
    v_lshl_add_u32 v6, v7, 3, v6
    v_lshlrev_b32 v6, 3, v6
    v_bfe_u32 v7, v1, 3, 1
    v_add_u32 v5, 1, v5
    v_mul_u32_u24 v7, v7, v5
    v_lshl_add_u32 v250, v7, 1, v6
    v_and_b32 v6, 0x38, v1
    v_add_u32 v247, 4, v6
    v_lshrrev_b32 v6, 2, v1
    v_lshrrev_b32 v7, 4, v1
    v_xor_b32 v6, v6, v7
    v_and_b32 v6, 1, v6
    v_lshlrev_b32 v6, 6, v6
    v_lshl_add_u32 v246, v4, 4, v6
    v_mov_b32 v242, 1.0
    v_mov_b32 v243, 1.0
    s_mov_b32 s54, 0xffffff00
    s_mov_b32 s55, 0xffffff00
    s_mov_b32 s56, 0xffff
    s_mov_b32 s57, 0xffff
    s_mov_b32 s58, 0
    s_mov_b32 s59, 134217856
    s_mov_b32 s60, 262272
    s_mov_b32 s61, 402915456
    s_mov_b32 s62, 940179840
    s_mov_b32 s63, 403046528
    s_mov_b32 s64, 402784384
    s_mov_b32 s65, 134348928
    s_mov_b32 s38, 128
    s_mov_b32 s33, -1
    s_and_b32 s68, s20, 3
    s_lshl_b32 s68, s68, 2
    s_lshr_b32 s69, s20, 2
    s_add_u32 s68, s68, s69
    s_lshl_b32 s68, s68, 4
    s_add_u32 s68, s68, 163072
    v_mov_b32 v251, s68
    s_mov_b32 s53, 0
    s_mov_b32 s50, 0
    s_mov_b32 s51, 0
    s_mov_b32 s47, 0
    s_mov_b32 s42, 0
    s_mov_b32 s3, 0
    s_mov_b32 s89, 0
    s_mov_b32 s34, 128
    s_mov_b32 s35, 384
    s_mov_b32 s36, 640
    s_mov_b32 s37, 896
    s_movk_i32 s3, 1024
    s_waitcnt lgkmcnt(0)
    s_waitcnt vmcnt(0)
    s_barrier
    s_mov_b32 s27, 32768
    s_mov_b32 s71, 162816
    v_mov_b32 v3, 8
    s_cmp_eq_u32 s20, 7
    s_cselect_b32 s52, 160, 0
    v_cmp_gt_u32 s[68:69], 40, v1
    s_mov_b64 s[28:29], 0xff
    s_lshr_b32 s66, s2, 3
    s_lshl_b32 s66, s66, 3
    s_add_u32 s66, s66, s20
    s_mul_i32 s66, s66, 14
    v_min_u32 v93, 13, v1
    v_add_u32 v93, s66, v93
    v_lshlrev_b32 v93, 10, v93
    v_mov_b32 v94, 0x7f000000
    s_waitcnt lgkmcnt(0)
    buffer_load_dwordx4 v[8:11], v86, s[16:19], s24 offen offset:0 sc1
    buffer_load_dwordx4 v[12:15], v86, s[16:19], s24 offen offset:1024 sc1
    buffer_load_dwordx4 v[16:19], v86, s[16:19], s24 offen offset:2048 sc1
    s_mov_b64 exec, s[22:23]
    buffer_load_dwordx4 v[20:23], v86, s[16:19], s24 offen offset:3072 sc1
    s_mov_b64 exec, -1
    v_bfe_u32 v4, v248, 5, 1
    v_bfe_u32 v6, v248, 7, 1
    v_lshl_or_b32 v5, v6, 1, v4
    v_lshl_or_b32 v4, v6, 2, v4
    v_mul_u32_u24 v4, 1280, v4
    v_lshl_add_u32 v4, v5, 6, v4
    v_bfe_u32 v6, v248, 6, 1
    v_lshl_add_u32 v4, v6, 5, v4
    v_and_b32 v6, 12, v248
    v_lshl_add_u32 v4, v6, 1, v4
    v_and_b32 v6, 16, v248
    v_xor_b32 v6, 16, v6
    v_lshl_add_u32 v4, v6, 13, v4
    v_add_u32 v4, 65536, v4
    v_xor_b32 v5, 64, v4
    ds_read_b64_tr_b16 v[96:97], v4 offset:0
    ds_read_b64_tr_b16 v[98:99], v4 offset:2560
    ds_read_b64_tr_b16 v[100:101], v4 offset:10240
    ds_read_b64_tr_b16 v[102:103], v4 offset:12800
    ds_read_b64_tr_b16 v[104:105], v5 offset:0
    ds_read_b64_tr_b16 v[106:107], v5 offset:2560
    ds_read_b64_tr_b16 v[108:109], v5 offset:10240
    ds_read_b64_tr_b16 v[110:111], v5 offset:12800
    ds_read_b64_tr_b16 v[128:129], v4 offset:512
    ds_read_b64_tr_b16 v[130:131], v4 offset:3072
    ds_read_b64_tr_b16 v[132:133], v4 offset:10752
    ds_read_b64_tr_b16 v[134:135], v4 offset:13312
    ds_read_b64_tr_b16 v[136:137], v5 offset:512
    ds_read_b64_tr_b16 v[138:139], v5 offset:3072
    ds_read_b64_tr_b16 v[140:141], v5 offset:10752
    ds_read_b64_tr_b16 v[142:143], v5 offset:13312
    ds_read_b64_tr_b16 v[144:145], v4 offset:768
    ds_read_b64_tr_b16 v[146:147], v4 offset:3328
    ds_read_b64_tr_b16 v[148:149], v4 offset:11008
    ds_read_b64_tr_b16 v[150:151], v4 offset:13568
    ds_read_b64_tr_b16 v[152:153], v5 offset:768
    ds_read_b64_tr_b16 v[154:155], v5 offset:3328
    ds_read_b64_tr_b16 v[156:157], v5 offset:11008
    ds_read_b64_tr_b16 v[158:159], v5 offset:13568
    ds_read_b64_tr_b16 v[160:161], v4 offset:1024
    ds_read_b64_tr_b16 v[162:163], v4 offset:3584
    ds_read_b64_tr_b16 v[164:165], v4 offset:11264
    ds_read_b64_tr_b16 v[166:167], v4 offset:13824
    ds_read_b64_tr_b16 v[168:169], v5 offset:1024
    ds_read_b64_tr_b16 v[170:171], v5 offset:3584
    ds_read_b64_tr_b16 v[172:173], v5 offset:11264
    ds_read_b64_tr_b16 v[174:175], v5 offset:13824
    ds_read_b64_tr_b16 v[112:113], v4 offset:256
    ds_read_b64_tr_b16 v[114:115], v4 offset:2816
    ds_read_b64_tr_b16 v[116:117], v4 offset:10496
    ds_read_b64_tr_b16 v[118:119], v4 offset:13056
    ds_read_b64_tr_b16 v[120:121], v5 offset:256
    ds_read_b64_tr_b16 v[122:123], v5 offset:2816
    ds_read_b64_tr_b16 v[124:125], v5 offset:10496
    ds_read_b64_tr_b16 v[126:127], v5 offset:13056
F_poll:
    s_waitcnt vmcnt(0)
F_poll1:
    v_cmp_ne_u32 s[72:73], s88, v11
    v_cmp_ne_u32 s[74:75], s88, v15
    v_cmp_ne_u32 s[76:77], s88, v19
    v_cmp_ne_u32 s[78:79], s88, v23
    s_or_b64 s[80:81], s[72:73], s[74:75]
    s_or_b64 s[82:83], s[76:77], s[78:79]
    s_or_b64 s[80:81], s[80:81], s[82:83]
    s_cbranch_scc1 F_again
F_got:
    v_bfe_u32 v2, v10, 23, 5
    v_bfe_u32 v60, v10, 11, 6
    v_cmp_gt_u32 s[80:81], v2, v91
    v_lshl_add_u32 v60, v60, 2, s71
    v_cmp_lt_u32 s[72:73], 8, v2
    v_max_u32 v89, v89, v2
    s_mov_b64 exec, s[80:81]
    ds_add_rtn_u32 v72, v60, v3
    s_mov_b64 exec, s[72:73]
    s_cbranch_execz F_h0
    buffer_load_dwordx4 v[24:27], v86, s[16:19], s25 offen offset:0 sc1
    v_sub_u32 v56, v2, v91
    v_bfe_u32 v64, v10, 17, 6
    v_cmp_lt_u32 vcc, 8, v56
    v_lshl_add_u32 v64, v64, 2, s71
    s_mov_b64 exec, vcc
    ds_add_rtn_u32 v76, v64, v3
F_h0:
    s_mov_b64 exec, -1
    v_bfe_u32 v2, v14, 23, 5
    v_bfe_u32 v61, v14, 11, 6
    v_cmp_gt_u32 s[82:83], v2, v91
    v_lshl_add_u32 v61, v61, 2, s71
    v_cmp_lt_u32 s[74:75], 8, v2
    v_max_u32 v89, v89, v2
    s_mov_b64 exec, s[82:83]
    ds_add_rtn_u32 v73, v61, v3
    s_mov_b64 exec, s[74:75]
    s_cbranch_execz F_h1
    buffer_load_dwordx4 v[28:31], v86, s[16:19], s25 offen offset:1024 sc1
    v_sub_u32 v57, v2, v91
    v_bfe_u32 v65, v14, 17, 6
    v_cmp_lt_u32 vcc, 8, v57
    v_lshl_add_u32 v65, v65, 2, s71
    s_mov_b64 exec, vcc
    ds_add_rtn_u32 v77, v65, v3
F_h1:
    s_mov_b64 exec, -1
    v_bfe_u32 v2, v18, 23, 5
    v_bfe_u32 v62, v18, 11, 6
    v_cmp_gt_u32 s[84:85], v2, v91
    v_lshl_add_u32 v62, v62, 2, s71
    v_cmp_lt_u32 s[76:77], 8, v2
    v_max_u32 v89, v89, v2
    s_mov_b64 exec, s[84:85]
    ds_add_rtn_u32 v74, v62, v3
    s_mov_b64 exec, s[76:77]
    s_cbranch_execz F_h2
    buffer_load_dwordx4 v[32:35], v86, s[16:19], s25 offen offset:2048 sc1
    v_sub_u32 v58, v2, v91
    v_bfe_u32 v66, v18, 17, 6
    v_cmp_lt_u32 vcc, 8, v58
    v_lshl_add_u32 v66, v66, 2, s71
    s_mov_b64 exec, vcc
    ds_add_rtn_u32 v78, v66, v3
F_h2:
    s_mov_b64 exec, -1
    v_bfe_u32 v2, v22, 23, 5
    v_bfe_u32 v63, v22, 11, 6
    v_cmp_gt_u32 s[86:87], v2, v91
    v_lshl_add_u32 v63, v63, 2, s71
    v_cmp_lt_u32 s[78:79], 8, v2
    v_max_u32 v89, v89, v2
    s_mov_b64 exec, s[86:87]
    ds_add_rtn_u32 v75, v63, v3
    s_mov_b64 exec, s[78:79]
    s_cbranch_execz F_h3
    buffer_load_dwordx4 v[36:39], v86, s[16:19], s25 offen offset:3072 sc1
    v_sub_u32 v59, v2, v91
    v_bfe_u32 v67, v22, 17, 6
    v_cmp_lt_u32 vcc, 8, v59
    v_lshl_add_u32 v67, v67, 2, s71
    s_mov_b64 exec, vcc
    ds_add_rtn_u32 v79, v67, v3
F_h3:
    s_mov_b64 exec, -1
    v_cmp_lt_u32 s[30:31], 16, v89
    s_mov_b32 s27, 262144
    s_cmp_lg_u64 s[30:31], 0
    s_cbranch_scc1 F_l3
F_l3r:
    s_cmp_lt_u32 s2, s52
    s_cbranch_scc1 F_flag
F_flagr:
    s_waitcnt lgkmcnt(0)
    s_barrier
    ds_read_b32 v4, v88
    buffer_load_dword v95, v93, s[4:7], 0 offen offset:128
    v_and_b32 v10, 0x7ff, v10
    v_lshl_add_u32 v10, v10, 5, v90
    v_or_b32 v11, 16, v10
    v_and_b32 v14, 0x7ff, v14
    v_lshl_add_u32 v14, v14, 5, v90
    v_add_u32 v14, 327680, v14
    v_or_b32 v15, 16, v14
    v_and_b32 v18, 0x7ff, v18
    v_lshl_add_u32 v18, v18, 5, v90
    v_add_u32 v18, 655360, v18
    v_or_b32 v19, 16, v18
    v_and_b32 v22, 0x7ff, v22
    v_lshl_add_u32 v22, v22, 5, v90
    v_add_u32 v22, 983040, v22
    v_or_b32 v23, 16, v22
    s_waitcnt lgkmcnt(0)
    v_add_u32 v2, 56, v4
    v_cmp_lt_u32 vcc, 512, v4
    v_lshrrev_b32 v2, 6, v2
    v_max_u32 v2, 2, v2
    s_cmp_lg_u64 vcc, 0
    s_cbranch_scc1 SLOW
    v_med3_u32 v3, v2, 3, 7
    v_cmp_eq_u32 vcc, 7, v2
    v_mad_u32_u24 v3, v3, 6, 14
    v_lshlrev_b32_e64 v6, v3, 1
    v_cndmask_b32 v6, 0, v6, s[68:69]
    v_addc_co_u32 v2, vcc, 0, v2, vcc
    v_mov_b32 v7, v6
    v_add_u32 v5, 1, v2
    v_lshrrev_b32 v5, 1, v5
    v_add_u32_dpp v7, v7, v7 row_shr:1 row_mask:0xf bank_mask:0xf
    v_lshlrev_b32 v92, 22, v5
    v_lshlrev_b32 v5, 18, v5
    v_add_u32_dpp v7, v7, v7 row_shr:2 row_mask:0xf bank_mask:0xf
    v_lshl_or_b32 v5, v1, 21, v5
    v_lshl_or_b32 v5, v2, 28, v5
    v_add_u32_dpp v7, v7, v7 row_shr:4 row_mask:0xf bank_mask:0xf
    s_mov_b32 s26, 86016
    s_mov_b32 s24, 0x2000
    v_add_u32_dpp v7, v7, v7 row_shr:8 row_mask:0xf bank_mask:0xf
    s_nop 1
    v_add_u32_dpp v7, v7, v7 row_bcast:15 row_mask:0xa bank_mask:0xf
    s_nop 1
    v_add_u32_dpp v7, v7, v7 row_bcast:31 row_mask:0xc bank_mask:0xf
    s_nop 0
    v_readlane_b32 s71, v7, 63
    v_sub_u32 v7, v7, v6
    s_lshr_b32 s66, s71, 24
    s_lshr_b32 s67, s71, 6
    s_lshr_b32 s70, s71, 12
    s_lshr_b32 s71, s71, 18
    s_add_u32 s67, s67, s70
    s_add_u32 s71, s71, s66
    s_add_u32 s71, s71, s67
    v_add_u32 v7, s71, v7
    s_bfe_u32 s70, s71, 393222
    v_bfe_u32 v7, v7, v3, 6
    s_bfe_u32 s67, s71, 393228
    v_cndmask_b32 v84, 63, v7, s[68:69]
    s_mul_i32 s68, s70, 3
    v_min_u32 v2, s70, v7
    s_mul_i32 s69, s66, 5
    v_min_u32 v3, s66, v7
    s_add_u32 s68, s68, s69
    v_mul_u32_u24 v7, 12, v7
    s_cmp_gt_u32 s68, 120
    v_mad_u32_u24 v7, v2, 3, v7
    s_cbranch_scc1 SLOW
    v_mad_u32_u24 v7, v3, 5, v7
    v_lshl_add_u32 v7, v7, 7, s26
    v_lshrrev_b32 v6, 3, v7
    v_mad_u32_u24 v92, v7, s24, v92
    v_or_b32 v92, v92, v6
    v_or_b32 v6, v5, v7
    s_add_u32 s71, s70, s66
    s_add_u32 s68, s71, s67
    s_andn2_b32 s70, s70, 3
    s_add_u32 s69, s70, 4
    s_andn2_b32 s67, s67, 3
    v_lshrrev_b32 v3, 1, v84
    v_mov_b32 v2, s68
    v_xor_b32 v3, v3, v84
    v_bfi_b32 v3, 4, v3, v84
    v_cmpx_gt_u32 vcc, s69, v84
    v_mov_b32 v2, s66
    v_cmpx_gt_u32 vcc, s70, v84
    v_mov_b32 v2, s71
    v_cmpx_gt_u32 vcc, s67, v84
    v_mov_b32 v2, 0
    s_mov_b64 exec, -1
    v_add_u32 v2, v2, v84
    v_bfi_b32 v84, 3, v2, v3
    s_lshr_b32 s66, s2, 3
    v_cmp_gt_u32 vcc, 32, v84
    v_add_u32 v2, s66, v84
    v_lshl_add_u32 v2, v2, 3, v84
    v_bfi_b32 v2, 24, v2, v84
    v_cndmask_b32 v84, v84, v2, vcc
    v_subrev_u32 v2, 6, v84
    v_and_b32 v2, 0x80000000, v2
    v_or_b32 v92, v92, v2
    ds_bpermute_b32 v60, v60, v92
    ds_bpermute_b32 v61, v61, v92
    ds_bpermute_b32 v62, v62, v92
    ds_bpermute_b32 v63, v63, v92
    ds_bpermute_b32 v64, v64, v92
    ds_bpermute_b32 v65, v65, v92
    ds_bpermute_b32 v66, v66, v92
    ds_bpermute_b32 v67, v67, v92
    v_cmp_eq_u32 vcc, s20, v84
    s_ff1_i32_b64 s67, vcc
    v_readlane_b32 s71, v6, s67
    s_mov_b32 s22, s71
    s_bfe_u32 s46, s71, 0x30012
    s_mov_b32 m0, s46
    s_and_b32 s66, s71, 0x3ffff
    s_movrels_b32 s68, s57
    s_movrels_b32 s69, s61
    s_sub_u32 s48, s66, s47
    s_mov_b32 s47, s66
    s_lshr_b32 s52, s71, 28
    s_lshl_b32 s67, s46, 9
    s_add_u32 s66, s66, s67
    s_sub_u32 s49, s66, s42
    s_mov_b32 s42, s66
    s_bfe_u32 s66, s68, 655360
    s_add_u32 s43, s42, s66
    s_bfe_u32 s39, s69, 655360
    s_bfe_u32 s66, s68, 655370
    s_add_u32 s44, s42, s66
    s_bfe_u32 s40, s69, 655370
    s_bfe_u32 s66, s68, 655380
    s_add_u32 s45, s42, s66
    s_bfe_u32 s41, s69, 655380
    s_waitcnt lgkmcnt(7)
    v_cmp_gt_i32 vcc, 0, v60
    v_and_b32 v60, 0x7fffffff, v60
    s_and_b64 exec, vcc, s[80:81]
    buffer_load_dword v95, v10, s[12:15], 0 offen
    s_mov_b64 exec, -1
    v_mad_u32_u16 v2, v60, 8, v72
    v_mad_u32_u16 v3, v60, 8, v72 op_sel:[1,0,0,0]
    s_mov_b64 exec, s[80:81]
    ds_write_b64 v2, v[10:11]
    ds_write_b64 v3, v[8:9]
    s_mov_b64 exec, -1
    s_waitcnt lgkmcnt(8)
    v_cmp_gt_i32 vcc, 0, v61
    v_and_b32 v61, 0x7fffffff, v61
    s_and_b64 exec, vcc, s[82:83]
    buffer_load_dword v95, v14, s[12:15], 0 offen
    s_mov_b64 exec, -1
    v_mad_u32_u16 v2, v61, 8, v73
    v_mad_u32_u16 v3, v61, 8, v73 op_sel:[1,0,0,0]
    s_mov_b64 exec, s[82:83]
    ds_write_b64 v2, v[14:15]
    ds_write_b64 v3, v[12:13]
    s_mov_b64 exec, -1
    s_waitcnt lgkmcnt(9)
    v_cmp_gt_i32 vcc, 0, v62
    v_and_b32 v62, 0x7fffffff, v62
    s_and_b64 exec, vcc, s[84:85]
    buffer_load_dword v95, v18, s[12:15], 0 offen
    s_mov_b64 exec, -1
    v_mad_u32_u16 v2, v62, 8, v74
    v_mad_u32_u16 v3, v62, 8, v74 op_sel:[1,0,0,0]
    s_mov_b64 exec, s[84:85]
    ds_write_b64 v2, v[18:19]
    ds_write_b64 v3, v[16:17]
    s_mov_b64 exec, -1
    s_waitcnt lgkmcnt(10)
    v_cmp_gt_i32 vcc, 0, v63
    v_and_b32 v63, 0x7fffffff, v63
    s_and_b64 exec, vcc, s[86:87]
    buffer_load_dword v95, v22, s[12:15], 0 offen
    s_mov_b64 exec, -1
    v_mad_u32_u16 v2, v63, 8, v75
    v_mad_u32_u16 v3, v63, 8, v75 op_sel:[1,0,0,0]
    s_mov_b64 exec, s[86:87]
    ds_write_b64 v2, v[22:23]
    ds_write_b64 v3, v[20:21]
    s_mov_b64 exec, -1
    s_waitcnt vmcnt(5) lgkmcnt(8)
    s_mov_b64 exec, s[72:73]
    s_cbranch_execz F_s0
F_sp0:
    v_cmp_ne_u32 vcc, s88, v27
    s_cbranch_vccnz F_sa0
F_sg0:
    v_cmpx_lt_u32 vcc, 8, v56
    v_and_b32 v26, 0x7ff, v26
    v_lshl_add_u32 v26, v26, 5, v90
    v_or_b32 v27, 16, v26
    v_cmp_gt_i32 vcc, 0, v64
    v_and_b32 v64, 0x7fffffff, v64
    s_and_saveexec_b64 s[82:83], vcc
    s_cbranch_execz F_x0
    buffer_load_dword v95, v26, s[12:15], 0 offen
F_x0:
    s_mov_b64 exec, s[82:83]
    v_mad_u32_u16 v2, v64, 8, v76
    v_mad_u32_u16 v3, v64, 8, v76 op_sel:[1,0,0,0]
    ds_write_b64 v2, v[26:27]
    ds_write_b64 v3, v[24:25]
F_s0:
    s_mov_b64 exec, s[74:75]
    s_cbranch_execz F_s1
F_sp1:
    v_cmp_ne_u32 vcc, s88, v31
    s_cbranch_vccnz F_sa1
F_sg1:
    v_cmpx_lt_u32 vcc, 8, v57
    v_and_b32 v30, 0x7ff, v30
    v_lshl_add_u32 v30, v30, 5, v90
    v_add_u32 v30, 327680, v30
    v_or_b32 v31, 16, v30
    v_cmp_gt_i32 vcc, 0, v65
    v_and_b32 v65, 0x7fffffff, v65
    s_and_saveexec_b64 s[82:83], vcc
    s_cbranch_execz F_x1
    buffer_load_dword v95, v30, s[12:15], 0 offen
F_x1:
    s_mov_b64 exec, s[82:83]
    v_mad_u32_u16 v2, v65, 8, v77
    v_mad_u32_u16 v3, v65, 8, v77 op_sel:[1,0,0,0]
    ds_write_b64 v2, v[30:31]
    ds_write_b64 v3, v[28:29]
F_s1:
    s_mov_b64 exec, s[76:77]
    s_cbranch_execz F_s2
F_sp2:
    v_cmp_ne_u32 vcc, s88, v35
    s_cbranch_vccnz F_sa2
F_sg2:
    v_cmpx_lt_u32 vcc, 8, v58
    v_and_b32 v34, 0x7ff, v34
    v_lshl_add_u32 v34, v34, 5, v90
    v_add_u32 v34, 655360, v34
    v_or_b32 v35, 16, v34
    v_cmp_gt_i32 vcc, 0, v66
    v_and_b32 v66, 0x7fffffff, v66
    s_and_saveexec_b64 s[82:83], vcc
    s_cbranch_execz F_x2
    buffer_load_dword v95, v34, s[12:15], 0 offen
F_x2:
    s_mov_b64 exec, s[82:83]
    v_mad_u32_u16 v2, v66, 8, v78
    v_mad_u32_u16 v3, v66, 8, v78 op_sel:[1,0,0,0]
    ds_write_b64 v2, v[34:35]
    ds_write_b64 v3, v[32:33]
F_s2:
    s_mov_b64 exec, s[78:79]
    s_cbranch_execz F_s3
F_sp3:
    v_cmp_ne_u32 vcc, s88, v39
    s_cbranch_vccnz F_sa3
F_sg3:
    v_cmpx_lt_u32 vcc, 8, v59
    v_and_b32 v38, 0x7ff, v38
    v_lshl_add_u32 v38, v38, 5, v90
    v_add_u32 v38, 983040, v38
    v_or_b32 v39, 16, v38
    v_cmp_gt_i32 vcc, 0, v67
    v_and_b32 v67, 0x7fffffff, v67
    s_and_saveexec_b64 s[82:83], vcc
    s_cbranch_execz F_x3
    buffer_load_dword v95, v38, s[12:15], 0 offen
F_x3:
    s_mov_b64 exec, s[82:83]
    v_mad_u32_u16 v2, v67, 8, v79
    v_mad_u32_u16 v3, v67, 8, v79 op_sel:[1,0,0,0]
    ds_write_b64 v2, v[38:39]
    ds_write_b64 v3, v[36:37]
F_s3:
    s_mov_b64 exec, -1
    s_cmp_lg_u64 s[30:31], 0
    s_cbranch_scc1 F_u
F_ur:
    s_mov_b32 s27, s22
    s_and_b32 s66, s46, s33
    s_cselect_b32 s72, -1, 1
    s_cselect_b32 s76, s47, 163712
    s_cmp_ge_u32 s66, 2
    s_cselect_b32 s73, -1, 0
    s_add_u32 s77, s47, 1024
    s_cmp_ge_u32 s66, 4
    s_cselect_b32 s75, -1, 0
    s_cmp_ge_u32 s66, 3
    s_cselect_b32 s74, -1, 1
    s_cselect_b32 s77, s77, 163712
    s_mul_i32 s66, s20, 80
    v_min_u32 v2, 76, v248
    s_waitcnt lgkmcnt(0)
    s_barrier
    v_add_u32 v253, s47, v248
    ds_read_b32 v254, v253
    ds_read_b32 v255, v253 offset:256
    v_add_u32 v252, s42, v247
    ds_read2_b32 v[234:235], v252 offset0:0 offset1:16
    v_add_u32 v252, s43, v247
    ds_read2_b32 v[236:237], v252 offset0:0 offset1:16
    v_add_u32 v252, s44, v247
    ds_read2_b32 v[238:239], v252 offset0:0 offset1:16
    v_add_u32 v252, s45, v247
    ds_read2_b32 v[240:241], v252 offset0:0 offset1:16
    buffer_load_dword v3, v2, s[16:19], s66 offen offset:128 sc1
    v_add_u32 v249, s48, v249
    v_add_u32 v250, s49, v250
    s_waitcnt lgkmcnt(4)
    s_mov_b32 m0, s76
    s_mov_b64 exec, s[72:73]
    buffer_load_dwordx4 v254, s[12:15], 0 offen  lds
    s_mov_b32 m0, s77
    s_mov_b64 exec, s[74:75]
    buffer_load_dwordx4 v255, s[12:15], 0 offen  lds
    s_mov_b64 exec, -1
    s_waitcnt lgkmcnt(0)
    s_add_u32 m0, s21, 0
    v_mad_u32_u16 v234, v234, s3, v246 op_sel:[1,0,0,0]
    v_mad_u32_u16 v235, v235, s3, v246 op_sel:[1,0,0,0]
    buffer_load_dwordx4 v234, s[4:7], s38 offen  lds
    buffer_load_dwordx4 v235, s[8:11], s38 offen offset:1024  lds
    s_add_u32 m0, s21, 2048
    v_mad_u32_u16 v236, v236, s3, v246 op_sel:[1,0,0,0]
    v_mad_u32_u16 v237, v237, s3, v246 op_sel:[1,0,0,0]
    buffer_load_dwordx4 v236, s[4:7], s39 offen  lds
    buffer_load_dwordx4 v237, s[8:11], s39 offen offset:1024  lds
    s_add_u32 m0, s21, 4096
    v_mad_u32_u16 v238, v238, s3, v246 op_sel:[1,0,0,0]
    v_mad_u32_u16 v239, v239, s3, v246 op_sel:[1,0,0,0]
    buffer_load_dwordx4 v238, s[4:7], s40 offen  lds
    buffer_load_dwordx4 v239, s[8:11], s40 offen offset:1024  lds
    s_add_u32 m0, s21, 6144
    v_mad_u32_u16 v240, v240, s3, v246 op_sel:[1,0,0,0]
    v_mad_u32_u16 v241, v241, s3, v246 op_sel:[1,0,0,0]
    buffer_load_dwordx4 v240, s[4:7], s41 offen  lds
    buffer_load_dwordx4 v241, s[8:11], s41 offen offset:1024  lds
    v_lshrrev_b32 v8, 3, v84
    v_and_b32 v9, 7, v84
    v_lshlrev_b32 v9, 13, v9
    v_mul_u32_u24 v8, 1536, v8
    v_lshlrev_b32 v10, 4, v84
    v_and_b32 v5, 128, v10
    v_add3_u32 v8, v8, v9, v5
    v_xor_b32 v9, v10, v7
    v_and_b32 v9, 128, v9
    v_add_u32 v9, v9, v7
    v_mov_b32 v5, v9
    s_add_u32 s66, s20, 0
    v_cmp_eq_u32 vcc, s66, v84
    s_ff1_i32_b64 s67, vcc
    v_readlane_b32 s28, v5, s67
    s_add_u32 s66, s20, 8
    v_cmp_eq_u32 vcc, s66, v84
    s_ff1_i32_b64 s67, vcc
    v_readlane_b32 s29, v5, s67
    v_readlane_b32 s23, v6, s67
    s_add_u32 s66, s20, 16
    v_cmp_eq_u32 vcc, s66, v84
    s_ff1_i32_b64 s67, vcc
    v_readlane_b32 s30, v5, s67
    v_readlane_b32 s24, v6, s67
    s_add_u32 s66, s20, 24
    v_cmp_eq_u32 vcc, s66, v84
    s_ff1_i32_b64 s67, vcc
    v_readlane_b32 s31, v5, s67
    v_readlane_b32 s25, v6, s67
    s_add_u32 s66, s20, 32
    v_cmp_eq_u32 vcc, s66, v84
    s_ff1_i32_b64 s67, vcc
    v_readlane_b32 s32, v5, s67
    v_readlane_b32 s26, v6, s67
    v_lshlrev_b32 v4, 3, v84
    v_add_u32 v4, 163328, v4
    s_mov_b32 exec_hi, 0xff
    ds_write_b64 v4, v[8:9]
    s_mov_b32 exec_hi, -1
    s_waitcnt lgkmcnt(0)
    v_mov_b32 v252, 0
    s_waitcnt vmcnt(6)
    v_cmp_ne_u32 vcc, s88, v3
    ds_read_b64_tr_b16 v[176:177], v244 offset:0
    ds_read_b64_tr_b16 v[178:179], v244 offset:1024
    ds_read_b64_tr_b16 v[180:181], v245 offset:0
    ds_read_b64_tr_b16 v[182:183], v245 offset:1024
    ds_read_b64_tr_b16 v[72:73], v249 offset:0
    ds_read_b64_tr_b16 v[76:77], v249 offset:64
    ds_read_b64_tr_b16 v[74:75], v249 offset:256
    ds_read_b64_tr_b16 v[78:79], v249 offset:320
    s_mov_b64 exec, s[54:55]
    ds_read_u16_d16_hi v242, v250 offset:0
    s_mov_b64 exec, -1
    s_or_b32 s89, vcc_lo, vcc_hi
    s_add_u32 s53, s53, 4
    s_xor_b32 s66, s53, s20
    s_bitcmp1_b32 s66, 2
    s_setprio 1
    s_cbranch_scc1 PRIO_1
    s_setprio 0
PRIO_1:
    s_cmp_eq_u32 s52, 4
    s_cbranch_scc1 ITEM_0_4
    s_cmp_eq_u32 s52, 5
    s_cbranch_scc1 ITEM_0_5
    s_cmp_eq_u32 s52, 3
    s_cbranch_scc1 ITEM_0_3
    s_cmp_eq_u32 s52, 6
    s_cbranch_scc1 ITEM_0_6
    s_cmp_eq_u32 s52, 8
    s_cbranch_scc1 ITEM_0_8
    s_branch ITEM_0_2
F_again:
    s_sub_u32 s27, s27, 1
    s_cbranch_scc1 F_late
    s_cmp_eq_u64 s[72:73], 0
    s_cbranch_scc1 F_p0
    s_mov_b64 exec, s[72:73]
    buffer_load_dwordx4 v[8:11], v86, s[16:19], s24 offen offset:0 sc1
    s_mov_b64 exec, -1
F_p0:
    s_cmp_eq_u64 s[74:75], 0
    s_cbranch_scc1 F_p1
    s_mov_b64 exec, s[74:75]
    buffer_load_dwordx4 v[12:15], v86, s[16:19], s24 offen offset:1024 sc1
    s_mov_b64 exec, -1
F_p1:
    s_cmp_eq_u64 s[76:77], 0
    s_cbranch_scc1 F_p2
    s_mov_b64 exec, s[76:77]
    buffer_load_dwordx4 v[16:19], v86, s[16:19], s24 offen offset:2048 sc1
    s_mov_b64 exec, -1
F_p2:
    s_cmp_eq_u64 s[78:79], 0
    s_cbranch_scc1 F_p3
    s_mov_b64 exec, s[78:79]
    buffer_load_dwordx4 v[20:23], v86, s[16:19], s24 offen offset:3072 sc1
    s_mov_b64 exec, -1
F_p3:
    s_branch F_poll
F_late:
    v_mov_b32 v2, 163064
    v_mov_b32 v4, 1000
    ds_write_b32 v2, v4
    v_mov_b32 v10, 0
    v_mov_b32 v14, 0
    v_mov_b32 v18, 0
    v_mov_b32 v22, 0
    s_branch F_got
F_l3:
    v_bfe_u32 v2, v10, 23, 5
    v_sub_u32 v56, v2, v91
    v_cmp_lt_u32 vcc, 16, v2
    s_mov_b64 exec, vcc
    s_cbranch_execz F_t0
F_tp0:
    buffer_load_dwordx4 v[40:43], v86, s[16:19], s26 offen offset:0 sc1
    s_waitcnt vmcnt(0)
    v_cmp_ne_u32 vcc, s88, v43
    s_sub_u32 s27, s27, 1
    s_cselect_b64 vcc, 0, vcc
    s_cmp_eq_u64 vcc, 0
    s_cbranch_scc0 F_tp0
    v_bfe_u32 v68, v42, 11, 6
    v_lshl_add_u32 v68, v68, 2, s71
    v_cmp_lt_i32 vcc, 16, v56
    s_mov_b64 exec, vcc
    ds_add_rtn_u32 v80, v68, v3
F_t0:
    s_mov_b64 exec, -1
    v_bfe_u32 v2, v14, 23, 5
    v_sub_u32 v57, v2, v91
    v_cmp_lt_u32 vcc, 16, v2
    s_mov_b64 exec, vcc
    s_cbranch_execz F_t1
F_tp1:
    buffer_load_dwordx4 v[44:47], v86, s[16:19], s26 offen offset:1024 sc1
    s_waitcnt vmcnt(0)
    v_cmp_ne_u32 vcc, s88, v47
    s_sub_u32 s27, s27, 1
    s_cselect_b64 vcc, 0, vcc
    s_cmp_eq_u64 vcc, 0
    s_cbranch_scc0 F_tp1
    v_bfe_u32 v69, v46, 11, 6
    v_lshl_add_u32 v69, v69, 2, s71
    v_cmp_lt_i32 vcc, 16, v57
    s_mov_b64 exec, vcc
    ds_add_rtn_u32 v81, v69, v3
F_t1:
    s_mov_b64 exec, -1
    v_bfe_u32 v2, v18, 23, 5
    v_sub_u32 v58, v2, v91
    v_cmp_lt_u32 vcc, 16, v2
    s_mov_b64 exec, vcc
    s_cbranch_execz F_t2
F_tp2:
    buffer_load_dwordx4 v[48:51], v86, s[16:19], s26 offen offset:2048 sc1
    s_waitcnt vmcnt(0)
    v_cmp_ne_u32 vcc, s88, v51
    s_sub_u32 s27, s27, 1
    s_cselect_b64 vcc, 0, vcc
    s_cmp_eq_u64 vcc, 0
    s_cbranch_scc0 F_tp2
    v_bfe_u32 v70, v50, 11, 6
    v_lshl_add_u32 v70, v70, 2, s71
    v_cmp_lt_i32 vcc, 16, v58
    s_mov_b64 exec, vcc
    ds_add_rtn_u32 v82, v70, v3
F_t2:
    s_mov_b64 exec, -1
    v_bfe_u32 v2, v22, 23, 5
    v_sub_u32 v59, v2, v91
    v_cmp_lt_u32 vcc, 16, v2
    s_mov_b64 exec, vcc
    s_cbranch_execz F_t3
F_tp3:
    buffer_load_dwordx4 v[52:55], v86, s[16:19], s26 offen offset:3072 sc1
    s_waitcnt vmcnt(0)
    v_cmp_ne_u32 vcc, s88, v55
    s_sub_u32 s27, s27, 1
    s_cselect_b64 vcc, 0, vcc
    s_cmp_eq_u64 vcc, 0
    s_cbranch_scc0 F_tp3
    v_bfe_u32 v71, v54, 11, 6
    v_lshl_add_u32 v71, v71, 2, s71
    v_cmp_lt_i32 vcc, 16, v59
    s_mov_b64 exec, vcc
    ds_add_rtn_u32 v83, v71, v3
F_t3:
    s_mov_b64 exec, -1
    v_mov_b32 v2, 163068
    v_mov_b32 v4, 1000
    v_cmp_lt_u32 vcc, 24, v89
    s_mov_b64 exec, vcc
    ds_write_b32 v2, v4
    s_mov_b64 exec, -1
    s_branch F_l3r
F_flag:
    s_lshl_b32 s66, s2, 2
    v_mov_b32 v2, 128
    v_mov_b32 v4, s88
    s_mov_b64 exec, 1
    buffer_store_dword v4, v2, s[16:19], s66 offen sc1
    s_mov_b64 exec, -1
    s_branch F_flagr
F_sa0:
    s_sub_u32 s27, s27, 1
    s_cbranch_scc1 F_sg0
    buffer_load_dwordx4 v[24:27], v86, s[16:19], s25 offen offset:0 sc1
    s_waitcnt vmcnt(0)
    s_branch F_sp0
F_sa1:
    s_sub_u32 s27, s27, 1
    s_cbranch_scc1 F_sg1
    buffer_load_dwordx4 v[28:31], v86, s[16:19], s25 offen offset:1024 sc1
    s_waitcnt vmcnt(0)
    s_branch F_sp1
F_sa2:
    s_sub_u32 s27, s27, 1
    s_cbranch_scc1 F_sg2
    buffer_load_dwordx4 v[32:35], v86, s[16:19], s25 offen offset:2048 sc1
    s_waitcnt vmcnt(0)
    s_branch F_sp2
F_sa3:
    s_sub_u32 s27, s27, 1
    s_cbranch_scc1 F_sg3
    buffer_load_dwordx4 v[36:39], v86, s[16:19], s25 offen offset:3072 sc1
    s_waitcnt vmcnt(0)
    s_branch F_sp3
F_u:
    ds_bpermute_b32 v68, v68, v92
    ds_bpermute_b32 v69, v69, v92
    ds_bpermute_b32 v70, v70, v92
    ds_bpermute_b32 v71, v71, v92
    s_waitcnt lgkmcnt(0)
    v_cmp_lt_i32 vcc, 16, v56
    s_mov_b64 exec, vcc
    s_cbranch_execz F_u0
    v_and_b32 v42, 0x7ff, v42
    v_lshl_add_u32 v42, v42, 5, v90
    v_or_b32 v43, 16, v42
    v_and_b32 v68, 0x7fffffff, v68
    v_mad_u32_u16 v2, v68, 8, v80
    v_mad_u32_u16 v3, v68, 8, v80 op_sel:[1,0,0,0]
    ds_write_b64 v2, v[42:43]
    ds_write_b64 v3, v[40:41]
F_u0:
    s_mov_b64 exec, -1
    v_cmp_lt_i32 vcc, 16, v57
    s_mov_b64 exec, vcc
    s_cbranch_execz F_u1
    v_and_b32 v46, 0x7ff, v46
    v_lshl_add_u32 v46, v46, 5, v90
    v_add_u32 v46, 327680, v46
    v_or_b32 v47, 16, v46
    v_and_b32 v69, 0x7fffffff, v69
    v_mad_u32_u16 v2, v69, 8, v81
    v_mad_u32_u16 v3, v69, 8, v81 op_sel:[1,0,0,0]
    ds_write_b64 v2, v[46:47]
    ds_write_b64 v3, v[44:45]
F_u1:
    s_mov_b64 exec, -1
    v_cmp_lt_i32 vcc, 16, v58
    s_mov_b64 exec, vcc
    s_cbranch_execz F_u2
    v_and_b32 v50, 0x7ff, v50
    v_lshl_add_u32 v50, v50, 5, v90
    v_add_u32 v50, 655360, v50
    v_or_b32 v51, 16, v50
    v_and_b32 v70, 0x7fffffff, v70
    v_mad_u32_u16 v2, v70, 8, v82
    v_mad_u32_u16 v3, v70, 8, v82 op_sel:[1,0,0,0]
    ds_write_b64 v2, v[50:51]
    ds_write_b64 v3, v[48:49]
F_u2:
    s_mov_b64 exec, -1
    v_cmp_lt_i32 vcc, 16, v59
    s_mov_b64 exec, vcc
    s_cbranch_execz F_u3
    v_and_b32 v54, 0x7ff, v54
    v_lshl_add_u32 v54, v54, 5, v90
    v_add_u32 v54, 983040, v54
    v_or_b32 v55, 16, v54
    v_and_b32 v71, 0x7fffffff, v71
    v_mad_u32_u16 v2, v71, 8, v83
    v_mad_u32_u16 v3, v71, 8, v83 op_sel:[1,0,0,0]
    ds_write_b64 v2, v[54:55]
    ds_write_b64 v3, v[52:53]
F_u3:
    s_mov_b64 exec, -1
    s_branch F_ur
LAST0:
    s_cmp_eq_u32 s50, 5
    s_cbranch_scc1 TO_PHASE1
    s_add_u32 s4, s4, 128
    s_addc_u32 s5, s5, 0
    s_add_u32 s8, s8, 128
    s_addc_u32 s9, s9, 0
    s_mov_b32 s34, 0
    s_mov_b32 s35, 256
    s_mov_b32 s36, 512
    s_mov_b32 s37, 768
    s_mov_b32 s33, 0
    s_add_u32 s53, s53, 4
    s_xor_b32 s66, s53, s20
    s_bitcmp1_b32 s66, 2
    s_setprio 1
    s_cbranch_scc1 PRIO_2
    s_setprio 0
PRIO_2:
    s_cmp_eq_u32 s52, 4
    s_cbranch_scc1 ITEM_0_4
    s_cmp_eq_u32 s52, 5
    s_cbranch_scc1 ITEM_0_5
    s_cmp_eq_u32 s52, 3
    s_cbranch_scc1 ITEM_0_3
    s_cmp_eq_u32 s52, 6
    s_cbranch_scc1 ITEM_0_6
    s_cmp_eq_u32 s52, 8
    s_cbranch_scc1 ITEM_0_8
    s_branch ITEM_0_2
TO_PHASE1:
    ds_read_b32 v252, v251 offset:16
    v_bfe_u32 v253, v248, 5, 1
    v_bfe_u32 v255, v248, 7, 1
    v_lshl_or_b32 v254, v255, 1, v253
    v_lshl_or_b32 v253, v255, 2, v253
    v_mul_u32_u24 v253, 1280, v253
    v_xor_b32 v254, 2, v254
    v_lshl_add_u32 v253, v254, 6, v253
    v_bfe_u32 v255, v248, 6, 1
    v_lshl_add_u32 v253, v255, 5, v253
    v_and_b32 v255, 12, v248
    v_lshl_add_u32 v253, v255, 1, v253
    v_and_b32 v255, 16, v248
    v_xor_b32 v255, 16, v255
    v_lshl_add_u32 v253, v255, 13, v253
    v_add_u32 v253, 65536, v253
    v_xor_b32 v254, 64, v253
    ds_read_b64_tr_b16 v[96:97], v253 offset:0
    ds_read_b64_tr_b16 v[98:99], v253 offset:2560
    ds_read_b64_tr_b16 v[100:101], v253 offset:10240
    ds_read_b64_tr_b16 v[102:103], v253 offset:12800
    ds_read_b64_tr_b16 v[104:105], v254 offset:0
    ds_read_b64_tr_b16 v[106:107], v254 offset:2560
    ds_read_b64_tr_b16 v[108:109], v254 offset:10240
    ds_read_b64_tr_b16 v[110:111], v254 offset:12800
    ds_read_b64_tr_b16 v[128:129], v253 offset:512
    ds_read_b64_tr_b16 v[130:131], v253 offset:3072
    ds_read_b64_tr_b16 v[132:133], v253 offset:10752
    ds_read_b64_tr_b16 v[134:135], v253 offset:13312
    ds_read_b64_tr_b16 v[136:137], v254 offset:512
    ds_read_b64_tr_b16 v[138:139], v254 offset:3072
    ds_read_b64_tr_b16 v[140:141], v254 offset:10752
    ds_read_b64_tr_b16 v[142:143], v254 offset:13312
    ds_read_b64_tr_b16 v[144:145], v253 offset:768
    ds_read_b64_tr_b16 v[146:147], v253 offset:3328
    ds_read_b64_tr_b16 v[148:149], v253 offset:11008
    ds_read_b64_tr_b16 v[150:151], v253 offset:13568
    ds_read_b64_tr_b16 v[152:153], v254 offset:768
    ds_read_b64_tr_b16 v[154:155], v254 offset:3328
    ds_read_b64_tr_b16 v[156:157], v254 offset:11008
    ds_read_b64_tr_b16 v[158:159], v254 offset:13568
    ds_read_b64_tr_b16 v[160:161], v253 offset:1024
    ds_read_b64_tr_b16 v[162:163], v253 offset:3584
    ds_read_b64_tr_b16 v[164:165], v253 offset:11264
    ds_read_b64_tr_b16 v[166:167], v253 offset:13824
    ds_read_b64_tr_b16 v[168:169], v254 offset:1024
    ds_read_b64_tr_b16 v[170:171], v254 offset:3584
    ds_read_b64_tr_b16 v[172:173], v254 offset:11264
    ds_read_b64_tr_b16 v[174:175], v254 offset:13824
    ds_read_b64_tr_b16 v[112:113], v253 offset:256
    ds_read_b64_tr_b16 v[114:115], v253 offset:2816
    ds_read_b64_tr_b16 v[116:117], v253 offset:10496
    ds_read_b64_tr_b16 v[118:119], v253 offset:13056
    ds_read_b64_tr_b16 v[120:121], v254 offset:256
    ds_read_b64_tr_b16 v[122:123], v254 offset:2816
    ds_read_b64_tr_b16 v[124:125], v254 offset:10496
    ds_read_b64_tr_b16 v[126:127], v254 offset:13056
    s_lshl_b32 s66, s20, 4
    v_xor_b32 v248, s66, v248
    s_mov_b32 s34, 128
    s_mov_b32 s35, 384
    s_mov_b32 s36, 640
    s_mov_b32 s37, 896
    s_mov_b32 s50, 0
    s_mov_b64 vcc, 0
    s_waitcnt lgkmcnt(0)
    s_waitcnt lgkmcnt(0)
    v_readfirstlane_b32 s66, v252
    s_add_u32 s53, s53, 1
    v_mov_b32 v252, s53
    s_cmp_le_u32 s53, s66
    ds_write2_b32 v251, v252, v252 offset0:0 offset1:8
    s_setprio 1
    s_cbranch_scc1 PRIO_3
    s_setprio 0
PRIO_3:
    s_cmp_eq_u32 s52, 4
    s_cbranch_scc1 ITEM_1_4
    s_cmp_eq_u32 s52, 5
    s_cbranch_scc1 ITEM_1_5
    s_cmp_eq_u32 s52, 3
    s_cbranch_scc1 ITEM_1_3
    s_cmp_eq_u32 s52, 6
    s_cbranch_scc1 ITEM_1_6
    s_cmp_eq_u32 s52, 8
    s_cbranch_scc1 ITEM_1_8
    s_branch ITEM_1_2
LAST1:
    s_cmp_eq_u32 s89, 0
    s_cbranch_scc1 T_flagsL
    s_mul_i32 s66, s20, 80
    v_min_u32 v2, 76, v248
    s_mov_b32 s67, 262144
T_pollL:
    buffer_load_dword v3, v2, s[16:19], s66 offen offset:128 sc1
    s_waitcnt vmcnt(0)
    v_cmp_ne_u32 vcc, s88, v3
    s_sub_u32 s67, s67, 1
    s_cselect_b64 vcc, 0, vcc
    s_cmp_eq_u64 vcc, 0
    s_cbranch_scc0 T_pollL
    s_mov_b32 s89, 0
T_flagsL:
    s_lshl_b32 s66, s20, 4
    v_xor_b32 v246, s66, v248
    v_lshlrev_b32 v246, 2, v246
    s_mul_i32 s51, s20, 20480
    s_add_u32 s51, s51, 1024
    s_mov_b64 vcc, -1
    s_load_dwordx2 s[72:73], s[0:1], 72
    s_waitcnt lgkmcnt(7)
    v_readfirstlane_b32 s66, v252
    s_add_u32 s53, s53, 1
    v_mov_b32 v252, s53
    s_cmp_le_u32 s53, s66
    ds_write2_b32 v251, v252, v252 offset0:0 offset1:8
    s_setprio 3
    s_cbranch_scc1 PRIO_4
    s_setprio 2
PRIO_4:
    s_cmp_eq_u32 s52, 4
    s_cbranch_scc1 ITEM_1_4
    s_cmp_eq_u32 s52, 5
    s_cbranch_scc1 ITEM_1_5
    s_cmp_eq_u32 s52, 3
    s_cbranch_scc1 ITEM_1_3
    s_cmp_eq_u32 s52, 6
    s_cbranch_scc1 ITEM_1_6
    s_cmp_eq_u32 s52, 8
    s_cbranch_scc1 ITEM_1_8
    s_branch ITEM_1_2
.p2align 6
ITEM_0_4:
    s_mov_b64 exec, s[54:55]
    ds_read_u16_d16_hi v243, v250 offset:128
    s_mov_b64 exec, -1
    ds_read_b64_tr_b16 v[80:81], v249 offset:512
    ds_read_b64_tr_b16 v[84:85], v249 offset:576
    ds_read_b64_tr_b16 v[82:83], v249 offset:768
    ds_read_b64_tr_b16 v[86:87], v249 offset:832
    s_waitcnt lgkmcnt(5)
    v_mul_f32_dpp v196, v242, v72 row_newbcast:0 row_mask:0xf bank_mask:0xf
    v_mul_f32_dpp v197, v242, v73 row_newbcast:1 row_mask:0xf bank_mask:0xf
    v_mul_f32_dpp v198, v242, v72 row_newbcast:8 row_mask:0xf bank_mask:0xf
    v_mul_f32_dpp v199, v242, v73 row_newbcast:9 row_mask:0xf bank_mask:0xf
    v_mul_f32_dpp v200, v242, v76 row_newbcast:2 row_mask:0xf bank_mask:0xf
    v_mul_f32_dpp v201, v242, v77 row_newbcast:3 row_mask:0xf bank_mask:0xf
    v_mul_f32_dpp v202, v242, v76 row_newbcast:10 row_mask:0xf bank_mask:0xf
    v_mul_f32_dpp v203, v242, v77 row_newbcast:11 row_mask:0xf bank_mask:0xf
    v_cvt_pk_bf16_f32 v72, v196, v197
    v_cvt_pk_bf16_f32 v76, v198, v199
    v_cvt_pk_bf16_f32 v73, v200, v201
    v_cvt_pk_bf16_f32 v77, v202, v203
    v_mul_f32_dpp v196, v242, v74 row_newbcast:4 row_mask:0xf bank_mask:0xf
    v_mul_f32_dpp v197, v242, v75 row_newbcast:5 row_mask:0xf bank_mask:0xf
    v_mul_f32_dpp v198, v242, v74 row_newbcast:12 row_mask:0xf bank_mask:0xf
    v_mul_f32_dpp v199, v242, v75 row_newbcast:13 row_mask:0xf bank_mask:0xf
    v_mul_f32_dpp v200, v242, v78 row_newbcast:6 row_mask:0xf bank_mask:0xf
    v_mul_f32_dpp v201, v242, v79 row_newbcast:7 row_mask:0xf bank_mask:0xf
    v_mul_f32_dpp v202, v242, v78 row_newbcast:14 row_mask:0xf bank_mask:0xf
    v_mul_f32_dpp v203, v242, v79 row_newbcast:15 row_mask:0xf bank_mask:0xf
    v_cvt_pk_bf16_f32 v74, v196, v197
    v_cvt_pk_bf16_f32 v78, v198, v199
    v_cvt_pk_bf16_f32 v75, v200, v201
    v_cvt_pk_bf16_f32 v79, v202, v203
    s_waitcnt vmcnt(4) lgkmcnt(0)
    v_mfma_f32_32x32x16_bf16 v[56:71], v[72:75], v[176:179], 0
    v_mul_f32_dpp v196, v243, v80 row_newbcast:0 row_mask:0xf bank_mask:0xf
    v_mul_f32_dpp v197, v243, v81 row_newbcast:1 row_mask:0xf bank_mask:0xf
    v_mul_f32_dpp v198, v243, v80 row_newbcast:8 row_mask:0xf bank_mask:0xf
    v_mul_f32_dpp v199, v243, v81 row_newbcast:9 row_mask:0xf bank_mask:0xf
    v_mul_f32_dpp v200, v243, v84 row_newbcast:2 row_mask:0xf bank_mask:0xf
    v_mul_f32_dpp v201, v243, v85 row_newbcast:3 row_mask:0xf bank_mask:0xf
    s_add_u32 m0, s21, 0
    v_mfma_f32_32x32x16_bf16 v[16:31], v[76:79], v[176:179], 0
    buffer_load_dwordx4 v234, s[4:7], s36 offen  lds
    buffer_load_dwordx4 v235, s[8:11], s36 offen offset:1024  lds
    ds_read_b64_tr_b16 v[176:177], v244 offset:2048
    ds_read_b64_tr_b16 v[178:179], v244 offset:3072
    ds_read_b64_tr_b16 v[184:185], v245 offset:2048
    ds_read_b64_tr_b16 v[186:187], v245 offset:3072
    v_mul_f32_dpp v202, v243, v84 row_newbcast:10 row_mask:0xf bank_mask:0xf
    v_mul_f32_dpp v203, v243, v85 row_newbcast:11 row_mask:0xf bank_mask:0xf
    v_cvt_pk_bf16_f32 v80, v196, v197
    v_cvt_pk_bf16_f32 v84, v198, v199
    v_cvt_pk_bf16_f32 v81, v200, v201
    v_cvt_pk_bf16_f32 v85, v202, v203
    v_mul_f32_dpp v196, v243, v82 row_newbcast:4 row_mask:0xf bank_mask:0xf
    v_mul_f32_dpp v197, v243, v83 row_newbcast:5 row_mask:0xf bank_mask:0xf
    v_mul_f32_dpp v198, v243, v82 row_newbcast:12 row_mask:0xf bank_mask:0xf
    v_mul_f32_dpp v199, v243, v83 row_newbcast:13 row_mask:0xf bank_mask:0xf
    v_mul_f32_dpp v200, v243, v86 row_newbcast:6 row_mask:0xf bank_mask:0xf
    v_mul_f32_dpp v201, v243, v87 row_newbcast:7 row_mask:0xf bank_mask:0xf
    v_mul_f32_dpp v202, v243, v86 row_newbcast:14 row_mask:0xf bank_mask:0xf
    v_mul_f32_dpp v203, v243, v87 row_newbcast:15 row_mask:0xf bank_mask:0xf
    v_cvt_pk_bf16_f32 v82, v196, v197
    v_cvt_pk_bf16_f32 v86, v198, v199
    v_cvt_pk_bf16_f32 v83, v200, v201
    v_cvt_pk_bf16_f32 v87, v202, v203
    s_waitcnt lgkmcnt(0)
    v_mfma_f32_32x32x16_bf16 v[56:71], v[80:83], v[176:179], v[56:71]
    s_add_u32 m0, s21, 2048
    v_mfma_f32_32x32x16_bf16 v[16:31], v[84:87], v[176:179], v[16:31]
    buffer_load_dwordx4 v236, s[4:7], s36 offen  lds
    buffer_load_dwordx4 v237, s[8:11], s36 offen offset:1024  lds
    s_mov_b32 m0, s50
    s_nop 0
    s_movrels_b32 s71, s23
    s_bfe_u32 s46, s71, 0x30012
    s_mov_b32 m0, s46
    s_and_b32 s66, s71, 0x3ffff
    s_movrels_b32 s68, s57
    s_movrels_b32 s69, s61
    s_sub_u32 s48, s66, s47
    s_mov_b32 s47, s66
    s_lshr_b32 s52, s71, 28
    s_lshl_b32 s67, s46, 9
    s_add_u32 s66, s66, s67
    s_sub_u32 s49, s66, s42
    s_mov_b32 s42, s66
    s_bfe_u32 s66, s68, 655360
    s_add_u32 s43, s42, s66
    s_bfe_u32 s39, s69, 655360
    s_bfe_u32 s66, s68, 655370
    s_add_u32 s44, s42, s66
    s_bfe_u32 s40, s69, 655370
    s_bfe_u32 s66, s68, 655380
    s_add_u32 s45, s42, s66
    s_bfe_u32 s41, s69, 655380
    s_and_b32 s66, s46, s33
    s_cselect_b32 s72, -1, 1
    s_cselect_b32 s76, s47, 163712
    s_cmp_ge_u32 s66, 2
    s_cselect_b32 s73, -1, 0
    s_add_u32 s77, s47, 1024
    s_cmp_ge_u32 s66, 4
    s_cselect_b32 s75, -1, 0
    s_cmp_ge_u32 s66, 3
    s_cselect_b32 s74, -1, 1
    s_cselect_b32 s77, s77, 163712
    v_add_u32 v252, s44, v247
    ds_read2_b32 v[238:239], v252 offset0:0 offset1:16
    v_add_u32 v252, s45, v247
    ds_read2_b32 v[240:241], v252 offset0:0 offset1:16
    v_mfma_f32_32x32x16_bf16 v[32:47], v[72:75], v[180:183], 0
    v_mul_f32 v196, v56, v96
    v_fmac_f32 v196, v57, v97
    v_fmac_f32 v196, v58, v98
    v_fmac_f32 v196, v59, v99
    v_fmac_f32 v196, v60, v100
    v_fmac_f32 v196, v61, v101
    v_mfma_f32_32x32x16_bf16 v[0:15], v[76:79], v[180:183], 0
    s_waitcnt vmcnt(6)
    ds_read_b64_tr_b16 v[176:177], v244 offset:4096
    ds_read_b64_tr_b16 v[178:179], v244 offset:5120
    ds_read_b64_tr_b16 v[180:181], v245 offset:4096
    ds_read_b64_tr_b16 v[182:183], v245 offset:5120
    v_fmac_f32 v196, v62, v102
    v_fmac_f32 v196, v63, v103
    v_mfma_f32_32x32x16_bf16 v[32:47], v[80:83], v[184:187], v[32:47]
    v_mul_f32 v198, v64, v128
    v_fmac_f32 v198, v65, v129
    v_fmac_f32 v198, v66, v130
    v_fmac_f32 v198, v67, v131
    v_fmac_f32 v198, v68, v132
    v_fmac_f32 v198, v69, v133
    v_mfma_f32_32x32x16_bf16 v[0:15], v[84:87], v[184:187], v[0:15]
    v_fmac_f32 v198, v70, v134
    v_fmac_f32 v198, v71, v135
    v_mul_f32 v200, v16, v128
    v_fmac_f32 v200, v17, v129
    v_permlane32_swap_b32 v196, v198
    v_fmac_f32 v200, v18, v130
    v_fmac_f32 v200, v19, v131
    v_fmac_f32 v200, v20, v132
    v_fmac_f32 v200, v21, v133
    v_fmac_f32 v200, v22, v134
    v_fmac_f32 v200, v23, v135
    v_add_f32 v198, v196, v198
    v_mul_f32_e64 v202, v24, -v128
    v_fma_f32 v202, v25, -v129, v202
    v_fma_f32 v202, v26, -v130, v202
    v_fma_f32 v202, v27, -v131, v202
    v_fma_f32 v202, v28, -v132, v202
    v_fma_f32 v202, v29, -v133, v202
    v_fma_f32 v202, v30, -v134, v202
    v_fma_f32 v202, v31, -v135, v202
    s_nop 1
    v_permlane32_swap_b32 v200, v202
    v_add_f32 v202, v200, v202
    s_waitcnt vmcnt(4) lgkmcnt(0)
    v_mfma_f32_32x32x16_bf16 v[56:71], v[72:75], v[176:179], 0
    v_mul_f32 v197, v32, v104
    v_fmac_f32 v197, v33, v105
    v_fmac_f32 v197, v34, v106
    v_fmac_f32 v197, v35, v107
    v_fmac_f32 v197, v36, v108
    v_fmac_f32 v197, v37, v109
    s_add_u32 m0, s21, 4096
    v_mfma_f32_32x32x16_bf16 v[16:31], v[76:79], v[176:179], 0
    buffer_load_dwordx4 v234, s[4:7], s37 offen  lds
    buffer_load_dwordx4 v235, s[8:11], s37 offen offset:1024  lds
    ds_read_b64_tr_b16 v[176:177], v244 offset:6144
    ds_read_b64_tr_b16 v[178:179], v244 offset:7168
    ds_read_b64_tr_b16 v[184:185], v245 offset:6144
    ds_read_b64_tr_b16 v[186:187], v245 offset:7168
    v_add_u32 v252, s42, v247
    ds_read2_b32 v[234:235], v252 offset0:0 offset1:16
    v_fmac_f32 v197, v38, v110
    v_fmac_f32 v197, v39, v111
    v_mul_f32 v199, v40, v136
    v_fmac_f32 v199, v41, v137
    v_fmac_f32 v199, v42, v138
    v_fmac_f32 v199, v43, v139
    v_fmac_f32 v199, v44, v140
    v_fmac_f32 v199, v45, v141
    v_fmac_f32 v199, v46, v142
    v_fmac_f32 v199, v47, v143
    v_mul_f32 v201, v0, v136
    v_fmac_f32 v201, v1, v137
    v_permlane32_swap_b32 v197, v199
    v_fmac_f32 v201, v2, v138
    v_fmac_f32 v201, v3, v139
    v_fmac_f32 v201, v4, v140
    v_fmac_f32 v201, v5, v141
    v_fmac_f32 v201, v6, v142
    v_fmac_f32 v201, v7, v143
    v_add_f32 v199, v197, v199
    v_mul_f32_e64 v203, v8, -v136
    v_fma_f32 v203, v9, -v137, v203
    v_fma_f32 v203, v10, -v138, v203
    v_fma_f32 v203, v11, -v139, v203
    s_waitcnt lgkmcnt(1)
    v_mfma_f32_32x32x16_bf16 v[56:71], v[80:83], v[176:179], v[56:71]
    v_fma_f32 v203, v12, -v140, v203
    v_fma_f32 v203, v13, -v141, v203
    v_fma_f32 v203, v14, -v142, v203
    v_fma_f32 v203, v15, -v143, v203
    s_nop 1
    v_permlane32_swap_b32 v201, v203
    v_add_f32 v203, v201, v203
    s_add_u32 m0, s21, 6144
    v_mfma_f32_32x32x16_bf16 v[16:31], v[84:87], v[176:179], v[16:31]
    buffer_load_dwordx4 v236, s[4:7], s37 offen  lds
    buffer_load_dwordx4 v237, s[8:11], s37 offen offset:1024  lds
    v_add_u32 v252, s43, v247
    ds_read2_b32 v[236:237], v252 offset0:0 offset1:16
    s_set_gpr_idx_on s51, gpr_idx(DST)
    s_nop 0
    v_cvt_pk_bf16_f32 v204, v198, v199
    v_cvt_pk_bf16_f32 v205, v202, v203
    s_set_gpr_idx_off
    v_mfma_f32_32x32x16_bf16 v[32:47], v[72:75], v[180:183], 0
    v_mul_f32 v196, v56, v144
    v_fmac_f32 v196, v57, v145
    v_fmac_f32 v196, v58, v146
    v_fmac_f32 v196, v59, v147
    v_fmac_f32 v196, v60, v148
    v_fmac_f32 v196, v61, v149
    v_mfma_f32_32x32x16_bf16 v[0:15], v[76:79], v[180:183], 0
    s_waitcnt vmcnt(6)
    ds_read_b64_tr_b16 v[176:177], v244 offset:0
    ds_read_b64_tr_b16 v[178:179], v244 offset:1024
    ds_read_b64_tr_b16 v[180:181], v245 offset:0
    ds_read_b64_tr_b16 v[182:183], v245 offset:1024
    v_fmac_f32 v196, v62, v150
    v_fmac_f32 v196, v63, v151
    v_mfma_f32_32x32x16_bf16 v[32:47], v[80:83], v[184:187], v[32:47]
    v_mul_f32_e64 v200, v16, -v160
    v_fma_f32 v200, v17, -v161, v200
    v_fma_f32 v200, v18, -v162, v200
    v_fma_f32 v200, v19, -v163, v200
    v_fma_f32 v200, v20, -v164, v200
    v_fma_f32 v200, v21, -v165, v200
    v_mfma_f32_32x32x16_bf16 v[0:15], v[84:87], v[184:187], v[0:15]
    v_fma_f32 v200, v22, -v166, v200
    v_fma_f32 v200, v23, -v167, v200
    v_mul_f32_e64 v202, v24, -v160
    v_fma_f32 v202, v25, -v161, v202
    v_fma_f32 v202, v26, -v162, v202
    v_fma_f32 v202, v27, -v163, v202
    v_fma_f32 v202, v28, -v164, v202
    v_fma_f32 v202, v29, -v165, v202
    v_fma_f32 v202, v30, -v166, v202
    v_fma_f32 v202, v31, -v167, v202
    s_waitcnt vmcnt(4) lgkmcnt(0)
    v_mfma_f32_32x32x16_bf16 v[16:31], v[72:75], v[176:179], 0
    v_mul_f32 v197, v32, v152
    v_fmac_f32 v197, v33, v153
    v_fmac_f32 v197, v34, v154
    v_fmac_f32 v197, v35, v155
    v_fmac_f32 v197, v36, v156
    v_fmac_f32 v197, v37, v157
    s_add_u32 m0, s21, 0
    v_mfma_f32_32x32x16_bf16 v[48:63], v[76:79], v[176:179], 0
    v_mad_u32_u16 v234, v234, s3, v246 op_sel:[1,0,0,0]
    v_mad_u32_u16 v235, v235, s3, v246 op_sel:[1,0,0,0]
    buffer_load_dwordx4 v234, s[4:7], s38 offen  lds
    buffer_load_dwordx4 v235, s[8:11], s38 offen offset:1024  lds
    ds_read_b64_tr_b16 v[176:177], v244 offset:2048
    ds_read_b64_tr_b16 v[178:179], v244 offset:3072
    ds_read_b64_tr_b16 v[184:185], v245 offset:2048
    ds_read_b64_tr_b16 v[186:187], v245 offset:3072
    v_fmac_f32 v197, v38, v158
    v_fmac_f32 v197, v39, v159
    v_mul_f32_e64 v201, v0, -v168
    v_fma_f32 v201, v1, -v169, v201
    v_fma_f32 v201, v2, -v170, v201
    v_fma_f32 v201, v3, -v171, v201
    v_fma_f32 v201, v4, -v172, v201
    v_fma_f32 v201, v5, -v173, v201
    v_fma_f32 v201, v6, -v174, v201
    v_fma_f32 v201, v7, -v175, v201
    s_waitcnt lgkmcnt(0)
    v_mfma_f32_32x32x16_bf16 v[16:31], v[80:83], v[176:179], v[16:31]
    v_mul_f32_e64 v203, v8, -v168
    v_fma_f32 v203, v9, -v169, v203
    v_fma_f32 v203, v10, -v170, v203
    v_fma_f32 v203, v11, -v171, v203
    v_fma_f32 v203, v12, -v172, v203
    v_fma_f32 v203, v13, -v173, v203
    s_add_u32 m0, s21, 2048
    v_mfma_f32_32x32x16_bf16 v[48:63], v[84:87], v[176:179], v[48:63]
    v_mad_u32_u16 v236, v236, s3, v246 op_sel:[1,0,0,0]
    v_mad_u32_u16 v237, v237, s3, v246 op_sel:[1,0,0,0]
    buffer_load_dwordx4 v236, s[4:7], s39 offen  lds
    buffer_load_dwordx4 v237, s[8:11], s39 offen offset:1024  lds
    v_fma_f32 v203, v14, -v174, v203
    v_fma_f32 v203, v15, -v175, v203
    v_mfma_f32_32x32x16_bf16 v[0:15], v[72:75], v[180:183], 0
    v_fmac_f32 v200, v24, v160
    v_fmac_f32 v200, v25, v161
    v_fmac_f32 v200, v26, v162
    v_fmac_f32 v200, v27, v163
    v_fmac_f32 v200, v28, v164
    v_fmac_f32 v200, v29, v165
    v_fmac_f32 v200, v30, v166
    v_fmac_f32 v200, v31, v167
    v_mfma_f32_32x32x16_bf16 v[24:39], v[76:79], v[180:183], 0
    v_add_u32 v253, s47, v248
    ds_read_b32 v192, v253
    ds_read_b32 v193, v253 offset:256
    s_waitcnt vmcnt(6)
    ds_read_b64_tr_b16 v[176:177], v244 offset:4096
    ds_read_b64_tr_b16 v[178:179], v244 offset:5120
    ds_read_b64_tr_b16 v[180:181], v245 offset:4096
    ds_read_b64_tr_b16 v[182:183], v245 offset:5120
    v_mfma_f32_32x32x16_bf16 v[24:39], v[84:87], v[184:187], v[24:39]
    v_mul_f32 v254, v16, v144
    v_fmac_f32 v254, v17, v145
    v_fmac_f32 v254, v18, v146
    v_fmac_f32 v254, v19, v147
    v_fmac_f32 v254, v20, v148
    v_fmac_f32 v254, v21, v149
    v_mfma_f32_32x32x16_bf16 v[0:15], v[80:83], v[184:187], v[0:15]
    v_fmac_f32 v254, v22, v150
    v_fmac_f32 v254, v23, v151
    v_sub_f32_e64 v64, -v48, v64
    v_sub_f32_e64 v65, -v49, v65
    v_permlane32_swap_b32 v196, v254
    v_sub_f32_e64 v66, -v50, v66
    v_sub_f32_e64 v67, -v51, v67
    v_sub_f32_e64 v68, -v52, v68
    v_sub_f32_e64 v69, -v53, v69
    v_sub_f32_e64 v70, -v54, v70
    v_sub_f32_e64 v71, -v55, v71
    v_add_f32 v254, v196, v254
    s_waitcnt vmcnt(4) lgkmcnt(0)
    v_mfma_f32_32x32x16_bf16 v[56:71], v[76:79], v[176:179], v[56:71]
    v_sub_f32_e64 v40, -v24, v40
    v_sub_f32_e64 v41, -v25, v41
    v_sub_f32_e64 v42, -v26, v42
    v_sub_f32_e64 v43, -v27, v43
    v_sub_f32_e64 v44, -v28, v44
    v_sub_f32_e64 v45, -v29, v45
    v_sub_f32_e64 v46, -v30, v46
    v_sub_f32_e64 v47, -v31, v47
    s_mov_b32 m0, s76
    s_mov_b64 exec, s[72:73]
    buffer_load_dwordx4 v192, s[12:15], 0 offen  lds
    s_mov_b32 m0, s77
    s_mov_b64 exec, s[74:75]
    buffer_load_dwordx4 v193, s[12:15], 0 offen  lds
    s_mov_b64 exec, -1
    s_add_u32 m0, s21, 4096
    v_mfma_f32_32x32x16_bf16 v[16:31], v[72:75], v[176:179], 0
    v_mad_u32_u16 v238, v238, s3, v246 op_sel:[1,0,0,0]
    v_mad_u32_u16 v239, v239, s3, v246 op_sel:[1,0,0,0]
    buffer_load_dwordx4 v238, s[4:7], s40 offen  lds
    buffer_load_dwordx4 v239, s[8:11], s40 offen offset:1024  lds
    ds_read_b64_tr_b16 v[176:177], v244 offset:6144
    ds_read_b64_tr_b16 v[178:179], v244 offset:7168
    ds_read_b64_tr_b16 v[184:185], v245 offset:6144
    ds_read_b64_tr_b16 v[186:187], v245 offset:7168
    v_mul_f32 v255, v0, v152
    v_fmac_f32 v255, v1, v153
    v_fmac_f32 v255, v2, v154
    v_fmac_f32 v255, v3, v155
    v_fmac_f32 v255, v4, v156
    v_fmac_f32 v255, v5, v157
    v_fmac_f32 v255, v6, v158
    v_fmac_f32 v255, v7, v159
    v_fmac_f32 v201, v8, v168
    v_fmac_f32 v201, v9, v169
    v_permlane32_swap_b32 v197, v255
    s_waitcnt lgkmcnt(0)
    v_mfma_f32_32x32x16_bf16 v[16:31], v[80:83], v[176:179], v[16:31]
    v_fmac_f32 v201, v10, v170
    v_fmac_f32 v201, v11, v171
    v_fmac_f32 v201, v12, v172
    v_fmac_f32 v201, v13, v173
    v_fmac_f32 v201, v14, v174
    v_fmac_f32 v201, v15, v175
    s_add_u32 m0, s21, 6144
    v_mfma_f32_32x32x16_bf16 v[56:71], v[84:87], v[176:179], v[56:71]
    v_mad_u32_u16 v240, v240, s3, v246 op_sel:[1,0,0,0]
    v_mad_u32_u16 v241, v241, s3, v246 op_sel:[1,0,0,0]
    buffer_load_dwordx4 v240, s[4:7], s41 offen  lds
    buffer_load_dwordx4 v241, s[8:11], s41 offen offset:1024  lds
    v_add_f32 v255, v197, v255
    s_set_gpr_idx_on s51, gpr_idx(DST)
    s_nop 0
    v_cvt_pk_bf16_f32 v206, v254, v255
    s_set_gpr_idx_off
    v_mfma_f32_32x32x16_bf16 v[0:15], v[72:75], v[180:183], 0
    v_mul_f32 v254, v16, v144
    v_fmac_f32 v254, v17, v145
    v_fmac_f32 v254, v18, v146
    v_fmac_f32 v254, v19, v147
    v_fmac_f32 v254, v20, v148
    v_fmac_f32 v254, v21, v149
    v_mfma_f32_32x32x16_bf16 v[32:47], v[76:79], v[180:183], v[32:47]
    s_waitcnt vmcnt(8)
    ds_read_b64_tr_b16 v[176:177], v244 offset:0
    ds_read_b64_tr_b16 v[178:179], v244 offset:1024
    ds_read_b64_tr_b16 v[180:181], v245 offset:0
    ds_read_b64_tr_b16 v[182:183], v245 offset:1024
    v_fmac_f32 v254, v22, v150
    v_fmac_f32 v254, v23, v151
    v_mfma_f32_32x32x16_bf16 v[0:15], v[80:83], v[184:187], v[0:15]
    v_fma_f32 v202, v24, -v160, v202
    v_fma_f32 v202, v25, -v161, v202
    v_permlane32_swap_b32 v254, v200
    v_fma_f32 v202, v26, -v162, v202
    v_fma_f32 v202, v27, -v163, v202
    v_fma_f32 v202, v28, -v164, v202
    v_mfma_f32_32x32x16_bf16 v[32:47], v[84:87], v[184:187], v[32:47]
    v_add_u32 v249, s48, v249
    v_add_u32 v250, s49, v250
    v_fma_f32 v202, v29, -v165, v202
    v_fma_f32 v202, v30, -v166, v202
    v_fma_f32 v202, v31, -v167, v202
    v_add_f32 v200, v254, v200
    v_mul_f32_e64 v198, v64, -v112
    v_permlane32_swap_b32 v202, v254
    v_fma_f32 v198, v65, -v113, v198
    v_fma_f32 v198, v66, -v114, v198
    v_fma_f32 v198, v67, -v115, v198
    v_fma_f32 v198, v68, -v116, v198
    v_fma_f32 v198, v69, -v117, v198
    v_fma_f32 v198, v70, -v118, v198
    v_fma_f32 v198, v71, -v119, v198
    v_add_f32 v254, v202, v254
    v_mul_f32 v196, v56, v160
    v_fmac_f32 v196, v57, v161
    v_fmac_f32 v196, v58, v162
    v_fmac_f32 v196, v59, v163
    v_fmac_f32 v196, v60, v164
    v_fmac_f32 v196, v61, v165
    v_fmac_f32 v196, v62, v166
    v_fmac_f32 v196, v63, v167
    s_nop 1
    v_permlane32_swap_b32 v198, v196
    v_add_f32 v196, v198, v196
    v_mul_f32 v255, v0, v152
    v_fmac_f32 v255, v1, v153
    v_fmac_f32 v255, v2, v154
    v_fmac_f32 v255, v3, v155
    v_fmac_f32 v255, v4, v156
    v_fmac_f32 v255, v5, v157
    v_fmac_f32 v255, v6, v158
    v_fmac_f32 v255, v7, v159
    v_fma_f32 v203, v8, -v168, v203
    v_fma_f32 v203, v9, -v169, v203
    v_permlane32_swap_b32 v255, v201
    v_fma_f32 v203, v10, -v170, v203
    v_fma_f32 v203, v11, -v171, v203
    v_fma_f32 v203, v12, -v172, v203
    v_fma_f32 v203, v13, -v173, v203
    v_fma_f32 v203, v14, -v174, v203
    v_fma_f32 v203, v15, -v175, v203
    v_add_f32 v201, v255, v201
    v_mul_f32_e64 v199, v40, -v120
    v_permlane32_swap_b32 v203, v255
    v_fma_f32 v199, v41, -v121, v199
    v_fma_f32 v199, v42, -v122, v199
    v_fma_f32 v199, v43, -v123, v199
    s_waitcnt vmcnt(4)
    ds_read_b64_tr_b16 v[72:73], v249 offset:0
    ds_read_b64_tr_b16 v[76:77], v249 offset:64
    ds_read_b64_tr_b16 v[74:75], v249 offset:256
    ds_read_b64_tr_b16 v[78:79], v249 offset:320
    s_mov_b64 exec, s[54:55]
    ds_read_u16_d16_hi v242, v250 offset:0
    s_mov_b64 exec, -1
    v_fma_f32 v199, v44, -v124, v199
    v_fma_f32 v199, v45, -v125, v199
    v_fma_f32 v199, v46, -v126, v199
    v_fma_f32 v199, v47, -v127, v199
    v_add_f32 v255, v203, v255
    v_mul_f32 v197, v32, v168
    v_fmac_f32 v197, v33, v169
    v_fmac_f32 v197, v34, v170
    v_fmac_f32 v197, v35, v171
    v_fmac_f32 v197, v36, v172
    v_fmac_f32 v197, v37, v173
    v_fmac_f32 v197, v38, v174
    v_fmac_f32 v197, v39, v175
    s_nop 1
    v_permlane32_swap_b32 v199, v197
    v_add_f32 v197, v199, v197
    s_set_gpr_idx_on s51, gpr_idx(DST)
    s_nop 0
    v_cvt_pk_bf16_f32 v207, v200, v201
    v_cvt_pk_bf16_f32 v209, v254, v255
    v_cvt_pk_bf16_f32 v208, v196, v197
    s_set_gpr_idx_off
    s_add_u32 s50, s50, 1
    s_add_u32 s51, s51, 6
    s_cmp_ge_u32 s50, 4
    s_cbranch_scc1 LAST0
    s_add_u32 s53, s53, 4
    s_xor_b32 s66, s53, s20
    s_bitcmp1_b32 s66, 2
    s_setprio 1
    s_cbranch_scc1 PRIO_5
    s_setprio 0
PRIO_5:
    s_cmp_eq_u32 s52, 4
    s_cbranch_scc1 ITEM_0_4
    s_cmp_eq_u32 s52, 5
    s_cbranch_scc1 ITEM_0_5
    s_cmp_eq_u32 s52, 3
    s_cbranch_scc1 ITEM_0_3
    s_cmp_eq_u32 s52, 6
    s_cbranch_scc1 ITEM_0_6
    s_cmp_eq_u32 s52, 8
    s_cbranch_scc1 ITEM_0_8
    s_branch ITEM_0_2
.p2align 6
ITEM_0_5:
    s_mov_b64 exec, s[54:55]
    ds_read_u16_d16_hi v243, v250 offset:128
    s_mov_b64 exec, -1
    ds_read_b64_tr_b16 v[80:81], v249 offset:512
    ds_read_b64_tr_b16 v[84:85], v249 offset:576
    ds_read_b64_tr_b16 v[82:83], v249 offset:768
    ds_read_b64_tr_b16 v[86:87], v249 offset:832
    ds_read_b64_tr_b16 v[88:89], v249 offset:1024
    ds_read_b64_tr_b16 v[92:93], v249 offset:1088
    s_waitcnt lgkmcnt(7)
    v_mul_f32_dpp v196, v242, v72 row_newbcast:0 row_mask:0xf bank_mask:0xf
    v_mul_f32_dpp v197, v242, v73 row_newbcast:1 row_mask:0xf bank_mask:0xf
    v_mul_f32_dpp v198, v242, v72 row_newbcast:8 row_mask:0xf bank_mask:0xf
    v_mul_f32_dpp v199, v242, v73 row_newbcast:9 row_mask:0xf bank_mask:0xf
    v_mul_f32_dpp v200, v242, v76 row_newbcast:2 row_mask:0xf bank_mask:0xf
    v_mul_f32_dpp v201, v242, v77 row_newbcast:3 row_mask:0xf bank_mask:0xf
    v_mul_f32_dpp v202, v242, v76 row_newbcast:10 row_mask:0xf bank_mask:0xf
    v_mul_f32_dpp v203, v242, v77 row_newbcast:11 row_mask:0xf bank_mask:0xf
    v_cvt_pk_bf16_f32 v72, v196, v197
    v_cvt_pk_bf16_f32 v76, v198, v199
    v_cvt_pk_bf16_f32 v73, v200, v201
    v_cvt_pk_bf16_f32 v77, v202, v203
    v_mul_f32_dpp v196, v242, v74 row_newbcast:4 row_mask:0xf bank_mask:0xf
    v_mul_f32_dpp v197, v242, v75 row_newbcast:5 row_mask:0xf bank_mask:0xf
    v_mul_f32_dpp v198, v242, v74 row_newbcast:12 row_mask:0xf bank_mask:0xf
    v_mul_f32_dpp v199, v242, v75 row_newbcast:13 row_mask:0xf bank_mask:0xf
    v_mul_f32_dpp v200, v242, v78 row_newbcast:6 row_mask:0xf bank_mask:0xf
    v_mul_f32_dpp v201, v242, v79 row_newbcast:7 row_mask:0xf bank_mask:0xf
    v_mul_f32_dpp v202, v242, v78 row_newbcast:14 row_mask:0xf bank_mask:0xf
    v_mul_f32_dpp v203, v242, v79 row_newbcast:15 row_mask:0xf bank_mask:0xf
    v_cvt_pk_bf16_f32 v74, v196, v197
    v_cvt_pk_bf16_f32 v78, v198, v199
    v_cvt_pk_bf16_f32 v75, v200, v201
    v_cvt_pk_bf16_f32 v79, v202, v203
    s_mov_b64 exec, s[54:55]
    ds_read_u16_d16_hi v242, v250 offset:256
    s_mov_b64 exec, -1
    s_waitcnt vmcnt(4) lgkmcnt(3)
    v_mfma_f32_32x32x16_bf16 v[56:71], v[72:75], v[176:179], 0
    v_mul_f32_dpp v196, v243, v80 row_newbcast:0 row_mask:0xf bank_mask:0xf
    v_mul_f32_dpp v197, v243, v81 row_newbcast:1 row_mask:0xf bank_mask:0xf
    v_mul_f32_dpp v198, v243, v80 row_newbcast:8 row_mask:0xf bank_mask:0xf
    v_mul_f32_dpp v199, v243, v81 row_newbcast:9 row_mask:0xf bank_mask:0xf
    v_mul_f32_dpp v200, v243, v84 row_newbcast:2 row_mask:0xf bank_mask:0xf
    v_mul_f32_dpp v201, v243, v85 row_newbcast:3 row_mask:0xf bank_mask:0xf
    s_add_u32 m0, s21, 0
    v_mfma_f32_32x32x16_bf16 v[16:31], v[76:79], v[176:179], 0
    buffer_load_dwordx4 v236, s[4:7], s35 offen  lds
    buffer_load_dwordx4 v237, s[8:11], s35 offen offset:1024  lds
    ds_read_b64_tr_b16 v[176:177], v244 offset:2048
    ds_read_b64_tr_b16 v[178:179], v244 offset:3072
    ds_read_b64_tr_b16 v[184:185], v245 offset:2048
    ds_read_b64_tr_b16 v[186:187], v245 offset:3072
    v_mul_f32_dpp v202, v243, v84 row_newbcast:10 row_mask:0xf bank_mask:0xf
    v_mul_f32_dpp v203, v243, v85 row_newbcast:11 row_mask:0xf bank_mask:0xf
    v_cvt_pk_bf16_f32 v80, v196, v197
    v_cvt_pk_bf16_f32 v84, v198, v199
    v_cvt_pk_bf16_f32 v81, v200, v201
    v_cvt_pk_bf16_f32 v85, v202, v203
    v_mul_f32_dpp v196, v243, v82 row_newbcast:4 row_mask:0xf bank_mask:0xf
    v_mul_f32_dpp v197, v243, v83 row_newbcast:5 row_mask:0xf bank_mask:0xf
    v_mul_f32_dpp v198, v243, v82 row_newbcast:12 row_mask:0xf bank_mask:0xf
    v_mul_f32_dpp v199, v243, v83 row_newbcast:13 row_mask:0xf bank_mask:0xf
    v_mul_f32_dpp v200, v243, v86 row_newbcast:6 row_mask:0xf bank_mask:0xf
    v_mul_f32_dpp v201, v243, v87 row_newbcast:7 row_mask:0xf bank_mask:0xf
    v_mul_f32_dpp v202, v243, v86 row_newbcast:14 row_mask:0xf bank_mask:0xf
    v_mul_f32_dpp v203, v243, v87 row_newbcast:15 row_mask:0xf bank_mask:0xf
    v_cvt_pk_bf16_f32 v82, v196, v197
    v_cvt_pk_bf16_f32 v86, v198, v199
    v_cvt_pk_bf16_f32 v83, v200, v201
    v_cvt_pk_bf16_f32 v87, v202, v203
    s_waitcnt vmcnt(4) lgkmcnt(0)
    v_mfma_f32_32x32x16_bf16 v[56:71], v[80:83], v[176:179], v[56:71]
    v_mul_f32_dpp v196, v242, v88 row_newbcast:0 row_mask:0xf bank_mask:0xf
    v_mul_f32_dpp v197, v242, v89 row_newbcast:1 row_mask:0xf bank_mask:0xf
    v_mul_f32_dpp v198, v242, v88 row_newbcast:8 row_mask:0xf bank_mask:0xf
    v_mul_f32_dpp v199, v242, v89 row_newbcast:9 row_mask:0xf bank_mask:0xf
    v_mul_f32_dpp v200, v242, v92 row_newbcast:2 row_mask:0xf bank_mask:0xf
    v_mul_f32_dpp v201, v242, v93 row_newbcast:3 row_mask:0xf bank_mask:0xf
    s_add_u32 m0, s21, 2048
    v_mfma_f32_32x32x16_bf16 v[16:31], v[84:87], v[176:179], v[16:31]
    buffer_load_dwordx4 v238, s[4:7], s35 offen  lds
    ds_read_b64_tr_b16 v[176:177], v244 offset:4096
    ds_read_b64_tr_b16 v[188:189], v245 offset:4096
    v_mul_f32_dpp v202, v242, v92 row_newbcast:10 row_mask:0xf bank_mask:0xf
    v_mul_f32_dpp v203, v242, v93 row_newbcast:11 row_mask:0xf bank_mask:0xf
    v_cvt_pk_bf16_f32 v88, v196, v197
    v_cvt_pk_bf16_f32 v92, v198, v199
    v_cvt_pk_bf16_f32 v89, v200, v201
    v_cvt_pk_bf16_f32 v93, v202, v203
    s_waitcnt lgkmcnt(0)
    v_mfma_f32_32x32x8_bf16 v[56:71], v[88:89], v[176:177], v[56:71]
    s_add_u32 m0, s21, 4096
    v_mfma_f32_32x32x8_bf16 v[16:31], v[92:93], v[176:177], v[16:31]
    buffer_load_dwordx4 v234, s[4:7], s36 offen  lds
    buffer_load_dwordx4 v235, s[8:11], s36 offen offset:1024  lds
    s_mov_b32 m0, s50
    s_nop 0
    s_movrels_b32 s71, s23
    s_bfe_u32 s46, s71, 0x30012
    s_mov_b32 m0, s46
    s_and_b32 s66, s71, 0x3ffff
    s_movrels_b32 s68, s57
    s_movrels_b32 s69, s61
    s_sub_u32 s48, s66, s47
    s_mov_b32 s47, s66
    s_lshr_b32 s52, s71, 28
    s_lshl_b32 s67, s46, 9
    s_add_u32 s66, s66, s67
    s_sub_u32 s49, s66, s42
    s_mov_b32 s42, s66
    s_bfe_u32 s66, s68, 655360
    s_add_u32 s43, s42, s66
    s_bfe_u32 s39, s69, 655360
    s_bfe_u32 s66, s68, 655370
    s_add_u32 s44, s42, s66
    s_bfe_u32 s40, s69, 655370
    s_bfe_u32 s66, s68, 655380
    s_add_u32 s45, s42, s66
    s_bfe_u32 s41, s69, 655380
    s_and_b32 s66, s46, s33
    s_cselect_b32 s72, -1, 1
    s_cselect_b32 s76, s47, 163712
    s_cmp_ge_u32 s66, 2
    s_cselect_b32 s73, -1, 0
    s_add_u32 s77, s47, 1024
    s_cmp_ge_u32 s66, 4
    s_cselect_b32 s75, -1, 0
    s_cmp_ge_u32 s66, 3
    s_cselect_b32 s74, -1, 1
    s_cselect_b32 s77, s77, 163712
    v_add_u32 v252, s45, v247
    ds_read2_b32 v[240:241], v252 offset0:0 offset1:16
    v_mfma_f32_32x32x16_bf16 v[32:47], v[72:75], v[180:183], 0
    v_mul_f32 v196, v56, v96
    v_fmac_f32 v196, v57, v97
    v_fmac_f32 v196, v58, v98
    v_fmac_f32 v196, v59, v99
    v_fmac_f32 v196, v60, v100
    v_fmac_f32 v196, v61, v101
    v_mfma_f32_32x32x16_bf16 v[0:15], v[76:79], v[180:183], 0
    v_fmac_f32 v196, v62, v102
    v_fmac_f32 v196, v63, v103
    v_mul_f32 v198, v64, v128
    v_fmac_f32 v198, v65, v129
    v_fmac_f32 v198, v66, v130
    v_fmac_f32 v198, v67, v131
    v_mfma_f32_32x32x16_bf16 v[32:47], v[80:83], v[184:187], v[32:47]
    v_fmac_f32 v198, v68, v132
    v_fmac_f32 v198, v69, v133
    v_fmac_f32 v198, v70, v134
    v_fmac_f32 v198, v71, v135
    v_mul_f32 v200, v16, v128
    v_fmac_f32 v200, v17, v129
    v_mfma_f32_32x32x16_bf16 v[0:15], v[84:87], v[184:187], v[0:15]
    s_waitcnt vmcnt(5)
    ds_read_b64_tr_b16 v[176:177], v244 offset:6144
    ds_read_b64_tr_b16 v[178:179], v244 offset:7168
    ds_read_b64_tr_b16 v[180:181], v245 offset:6144
    ds_read_b64_tr_b16 v[182:183], v245 offset:7168
    v_permlane32_swap_b32 v196, v198
    v_fmac_f32 v200, v18, v130
    v_mfma_f32_32x32x8_bf16 v[32:47], v[88:89], v[188:189], v[32:47]
    v_fmac_f32 v200, v19, v131
    v_fmac_f32 v200, v20, v132
    v_fmac_f32 v200, v21, v133
    v_fmac_f32 v200, v22, v134
    v_fmac_f32 v200, v23, v135
    v_add_f32 v198, v196, v198
    v_mfma_f32_32x32x8_bf16 v[0:15], v[92:93], v[188:189], v[0:15]
    v_mul_f32_e64 v202, v24, -v128
    v_fma_f32 v202, v25, -v129, v202
    v_fma_f32 v202, v26, -v130, v202
    v_fma_f32 v202, v27, -v131, v202
    v_fma_f32 v202, v28, -v132, v202
    v_fma_f32 v202, v29, -v133, v202
    v_fma_f32 v202, v30, -v134, v202
    v_fma_f32 v202, v31, -v135, v202
    s_nop 1
    v_permlane32_swap_b32 v200, v202
    v_add_f32 v202, v200, v202
    s_waitcnt vmcnt(3) lgkmcnt(0)
    v_mfma_f32_32x32x16_bf16 v[56:71], v[72:75], v[176:179], 0
    v_mul_f32 v197, v32, v104
    v_fmac_f32 v197, v33, v105
    v_fmac_f32 v197, v34, v106
    v_fmac_f32 v197, v35, v107
    v_fmac_f32 v197, v36, v108
    v_fmac_f32 v197, v37, v109
    s_add_u32 m0, s21, 6144
    v_mfma_f32_32x32x16_bf16 v[16:31], v[76:79], v[176:179], 0
    buffer_load_dwordx4 v236, s[4:7], s36 offen  lds
    buffer_load_dwordx4 v237, s[8:11], s36 offen offset:1024  lds
    ds_read_b64_tr_b16 v[176:177], v244 offset:0
    ds_read_b64_tr_b16 v[178:179], v244 offset:1024
    ds_read_b64_tr_b16 v[184:185], v245 offset:0
    ds_read_b64_tr_b16 v[186:187], v245 offset:1024
    v_fmac_f32 v197, v38, v110
    v_fmac_f32 v197, v39, v111
    v_mul_f32 v199, v40, v136
    v_fmac_f32 v199, v41, v137
    v_fmac_f32 v199, v42, v138
    v_fmac_f32 v199, v43, v139
    v_fmac_f32 v199, v44, v140
    v_fmac_f32 v199, v45, v141
    v_fmac_f32 v199, v46, v142
    v_fmac_f32 v199, v47, v143
    v_mul_f32 v201, v0, v136
    v_fmac_f32 v201, v1, v137
    v_permlane32_swap_b32 v197, v199
    v_fmac_f32 v201, v2, v138
    v_fmac_f32 v201, v3, v139
    s_waitcnt vmcnt(4) lgkmcnt(0)
    v_mfma_f32_32x32x16_bf16 v[56:71], v[80:83], v[176:179], v[56:71]
    v_fmac_f32 v201, v4, v140
    v_fmac_f32 v201, v5, v141
    v_fmac_f32 v201, v6, v142
    v_fmac_f32 v201, v7, v143
    v_add_f32 v199, v197, v199
    v_mul_f32_e64 v203, v8, -v136
    s_add_u32 m0, s21, 0
    v_mfma_f32_32x32x16_bf16 v[16:31], v[84:87], v[176:179], v[16:31]
    buffer_load_dwordx4 v238, s[4:7], s36 offen  lds
    ds_read_b64_tr_b16 v[176:177], v244 offset:2048
    ds_read_b64_tr_b16 v[188:189], v245 offset:2048
    v_fma_f32 v203, v9, -v137, v203
    v_fma_f32 v203, v10, -v138, v203
    v_fma_f32 v203, v11, -v139, v203
    s_waitcnt lgkmcnt(0)
    v_mfma_f32_32x32x8_bf16 v[56:71], v[88:89], v[176:177], v[56:71]
    v_fma_f32 v203, v12, -v140, v203
    v_fma_f32 v203, v13, -v141, v203
    v_fma_f32 v203, v14, -v142, v203
    v_fma_f32 v203, v15, -v143, v203
    s_nop 1
    v_permlane32_swap_b32 v201, v203
    v_add_f32 v203, v201, v203
    s_add_u32 m0, s21, 2048
    v_mfma_f32_32x32x8_bf16 v[16:31], v[92:93], v[176:177], v[16:31]
    buffer_load_dwordx4 v234, s[4:7], s37 offen  lds
    buffer_load_dwordx4 v235, s[8:11], s37 offen offset:1024  lds
    v_add_u32 v252, s42, v247
    ds_read2_b32 v[234:235], v252 offset0:0 offset1:16
    s_set_gpr_idx_on s51, gpr_idx(DST)
    s_nop 0
    v_cvt_pk_bf16_f32 v204, v198, v199
    v_cvt_pk_bf16_f32 v205, v202, v203
    s_set_gpr_idx_off
    v_mfma_f32_32x32x16_bf16 v[32:47], v[72:75], v[180:183], 0
    v_mul_f32 v196, v56, v144
    v_fmac_f32 v196, v57, v145
    v_fmac_f32 v196, v58, v146
    v_fmac_f32 v196, v59, v147
    v_fmac_f32 v196, v60, v148
    v_fmac_f32 v196, v61, v149
    v_mfma_f32_32x32x16_bf16 v[0:15], v[76:79], v[180:183], 0
    v_fmac_f32 v196, v62, v150
    v_fmac_f32 v196, v63, v151
    v_mul_f32_e64 v200, v16, -v160
    v_fma_f32 v200, v17, -v161, v200
    v_fma_f32 v200, v18, -v162, v200
    v_fma_f32 v200, v19, -v163, v200
    v_mfma_f32_32x32x16_bf16 v[32:47], v[80:83], v[184:187], v[32:47]
    v_fma_f32 v200, v20, -v164, v200
    v_fma_f32 v200, v21, -v165, v200
    v_fma_f32 v200, v22, -v166, v200
    v_fma_f32 v200, v23, -v167, v200
    v_mul_f32_e64 v202, v24, -v160
    v_fma_f32 v202, v25, -v161, v202
    v_mfma_f32_32x32x16_bf16 v[0:15], v[84:87], v[184:187], v[0:15]
    s_waitcnt vmcnt(5)
    ds_read_b64_tr_b16 v[176:177], v244 offset:4096
    ds_read_b64_tr_b16 v[178:179], v244 offset:5120
    ds_read_b64_tr_b16 v[180:181], v245 offset:4096
    ds_read_b64_tr_b16 v[182:183], v245 offset:5120
    v_fma_f32 v202, v26, -v162, v202
    v_fma_f32 v202, v27, -v163, v202
    v_mfma_f32_32x32x8_bf16 v[32:47], v[88:89], v[188:189], v[32:47]
    v_fma_f32 v202, v28, -v164, v202
    v_fma_f32 v202, v29, -v165, v202
    v_fma_f32 v202, v30, -v166, v202
    v_fma_f32 v202, v31, -v167, v202
    v_mfma_f32_32x32x8_bf16 v[0:15], v[92:93], v[188:189], v[0:15]
    s_waitcnt vmcnt(3) lgkmcnt(0)
    v_mfma_f32_32x32x16_bf16 v[16:31], v[72:75], v[176:179], 0
    s_nop 4
    v_mul_f32 v197, v32, v152
    v_fmac_f32 v197, v33, v153
    v_fmac_f32 v197, v34, v154
    v_fmac_f32 v197, v35, v155
    v_fmac_f32 v197, v36, v156
    v_fmac_f32 v197, v37, v157
    s_add_u32 m0, s21, 4096
    v_mfma_f32_32x32x16_bf16 v[48:63], v[76:79], v[176:179], 0
    buffer_load_dwordx4 v236, s[4:7], s37 offen  lds
    buffer_load_dwordx4 v237, s[8:11], s37 offen offset:1024  lds
    ds_read_b64_tr_b16 v[176:177], v244 offset:6144
    ds_read_b64_tr_b16 v[178:179], v244 offset:7168
    ds_read_b64_tr_b16 v[184:185], v245 offset:6144
    ds_read_b64_tr_b16 v[186:187], v245 offset:7168
    v_add_u32 v252, s43, v247
    ds_read2_b32 v[236:237], v252 offset0:0 offset1:16
    v_fmac_f32 v197, v38, v158
    v_fmac_f32 v197, v39, v159
    v_mul_f32_e64 v201, v0, -v168
    s_waitcnt vmcnt(4) lgkmcnt(1)
    v_mfma_f32_32x32x16_bf16 v[16:31], v[80:83], v[176:179], v[16:31]
    v_fma_f32 v201, v1, -v169, v201
    v_fma_f32 v201, v2, -v170, v201
    v_fma_f32 v201, v3, -v171, v201
    v_fma_f32 v201, v4, -v172, v201
    v_fma_f32 v201, v5, -v173, v201
    v_fma_f32 v201, v6, -v174, v201
    s_add_u32 m0, s21, 6144
    v_mfma_f32_32x32x16_bf16 v[48:63], v[84:87], v[176:179], v[48:63]
    buffer_load_dwordx4 v238, s[4:7], s37 offen  lds
    ds_read_b64_tr_b16 v[176:177], v244 offset:0
    ds_read_b64_tr_b16 v[188:189], v245 offset:0
    v_add_u32 v252, s44, v247
    ds_read2_b32 v[238:239], v252 offset0:0 offset1:16
    v_fma_f32 v201, v7, -v175, v201
    s_waitcnt lgkmcnt(1)
    v_mfma_f32_32x32x8_bf16 v[16:31], v[88:89], v[176:177], v[16:31]
    v_mul_f32_e64 v203, v8, -v168
    v_fma_f32 v203, v9, -v169, v203
    v_fma_f32 v203, v10, -v170, v203
    v_fma_f32 v203, v11, -v171, v203
    v_fma_f32 v203, v12, -v172, v203
    v_fma_f32 v203, v13, -v173, v203
    s_add_u32 m0, s21, 0
    v_mfma_f32_32x32x8_bf16 v[48:63], v[92:93], v[176:177], v[48:63]
    v_mad_u32_u16 v234, v234, s3, v246 op_sel:[1,0,0,0]
    v_mad_u32_u16 v235, v235, s3, v246 op_sel:[1,0,0,0]
    buffer_load_dwordx4 v234, s[4:7], s38 offen  lds
    buffer_load_dwordx4 v235, s[8:11], s38 offen offset:1024  lds
    v_fma_f32 v203, v14, -v174, v203
    v_fma_f32 v203, v15, -v175, v203
    v_mfma_f32_32x32x16_bf16 v[0:15], v[72:75], v[180:183], 0
    v_fmac_f32 v200, v24, v160
    v_fmac_f32 v200, v25, v161
    v_fmac_f32 v200, v26, v162
    v_fmac_f32 v200, v27, v163
    v_fmac_f32 v200, v28, v164
    v_fmac_f32 v200, v29, v165
    v_fmac_f32 v200, v30, v166
    v_fmac_f32 v200, v31, v167
    v_mfma_f32_32x32x16_bf16 v[24:39], v[76:79], v[180:183], 0
    v_add_u32 v253, s47, v248
    ds_read_b32 v192, v253
    ds_read_b32 v193, v253 offset:256
    v_mul_f32 v254, v16, v144
    v_fmac_f32 v254, v17, v145
    v_fmac_f32 v254, v18, v146
    v_mfma_f32_32x32x16_bf16 v[0:15], v[80:83], v[184:187], v[0:15]
    v_fmac_f32 v254, v19, v147
    v_fmac_f32 v254, v20, v148
    v_fmac_f32 v254, v21, v149
    v_fmac_f32 v254, v22, v150
    v_fmac_f32 v254, v23, v151
    v_sub_f32_e64 v64, -v48, v64
    v_mfma_f32_32x32x16_bf16 v[24:39], v[84:87], v[184:187], v[24:39]
    s_waitcnt vmcnt(5)
    ds_read_b64_tr_b16 v[176:177], v244 offset:2048
    ds_read_b64_tr_b16 v[178:179], v244 offset:3072
    ds_read_b64_tr_b16 v[180:181], v245 offset:2048
    ds_read_b64_tr_b16 v[182:183], v245 offset:3072
    v_sub_f32_e64 v65, -v49, v65
    v_permlane32_swap_b32 v196, v254
    v_mfma_f32_32x32x8_bf16 v[24:39], v[92:93], v[188:189], v[24:39]
    v_sub_f32_e64 v66, -v50, v66
    v_sub_f32_e64 v67, -v51, v67
    v_sub_f32_e64 v68, -v52, v68
    v_sub_f32_e64 v69, -v53, v69
    v_sub_f32_e64 v70, -v54, v70
    v_sub_f32_e64 v71, -v55, v71
    v_mfma_f32_32x32x8_bf16 v[0:15], v[88:89], v[188:189], v[0:15]
    v_add_f32 v254, v196, v254
    s_waitcnt vmcnt(3) lgkmcnt(0)
    v_mfma_f32_32x32x16_bf16 v[56:71], v[76:79], v[176:179], v[56:71]
    s_nop 1
    v_sub_f32_e64 v40, -v24, v40
    v_sub_f32_e64 v41, -v25, v41
    v_sub_f32_e64 v42, -v26, v42
    v_sub_f32_e64 v43, -v27, v43
    v_sub_f32_e64 v44, -v28, v44
    v_sub_f32_e64 v45, -v29, v45
    v_sub_f32_e64 v46, -v30, v46
    v_sub_f32_e64 v47, -v31, v47
    s_mov_b32 m0, s76
    s_mov_b64 exec, s[72:73]
    buffer_load_dwordx4 v192, s[12:15], 0 offen  lds
    s_mov_b32 m0, s77
    s_mov_b64 exec, s[74:75]
    buffer_load_dwordx4 v193, s[12:15], 0 offen  lds
    s_mov_b64 exec, -1
    s_add_u32 m0, s21, 2048
    v_mfma_f32_32x32x16_bf16 v[16:31], v[72:75], v[176:179], 0
    v_mad_u32_u16 v236, v236, s3, v246 op_sel:[1,0,0,0]
    v_mad_u32_u16 v237, v237, s3, v246 op_sel:[1,0,0,0]
    buffer_load_dwordx4 v236, s[4:7], s39 offen  lds
    buffer_load_dwordx4 v237, s[8:11], s39 offen offset:1024  lds
    ds_read_b64_tr_b16 v[176:177], v244 offset:4096
    ds_read_b64_tr_b16 v[178:179], v244 offset:5120
    ds_read_b64_tr_b16 v[184:185], v245 offset:4096
    ds_read_b64_tr_b16 v[186:187], v245 offset:5120
    v_mul_f32 v255, v0, v152
    v_fmac_f32 v255, v1, v153
    v_fmac_f32 v255, v2, v154
    v_fmac_f32 v255, v3, v155
    v_fmac_f32 v255, v4, v156
    s_waitcnt vmcnt(6) lgkmcnt(0)
    v_mfma_f32_32x32x16_bf16 v[16:31], v[80:83], v[176:179], v[16:31]
    v_fmac_f32 v255, v5, v157
    v_fmac_f32 v255, v6, v158
    v_fmac_f32 v255, v7, v159
    v_fmac_f32 v201, v8, v168
    v_fmac_f32 v201, v9, v169
    v_permlane32_swap_b32 v197, v255
    s_add_u32 m0, s21, 4096
    v_mfma_f32_32x32x16_bf16 v[56:71], v[84:87], v[176:179], v[56:71]
    v_mad_u32_u16 v238, v238, s3, v246 op_sel:[1,0,0,0]
    v_mad_u32_u16 v239, v239, s3, v246 op_sel:[1,0,0,0]
    buffer_load_dwordx4 v238, s[4:7], s40 offen  lds
    buffer_load_dwordx4 v239, s[8:11], s40 offen offset:1024  lds
    ds_read_b64_tr_b16 v[176:177], v244 offset:6144
    ds_read_b64_tr_b16 v[188:189], v245 offset:6144
    s_waitcnt lgkmcnt(0)
    v_mfma_f32_32x32x8_bf16 v[16:31], v[88:89], v[176:177], v[16:31]
    v_fmac_f32 v201, v10, v170
    v_fmac_f32 v201, v11, v171
    v_fmac_f32 v201, v12, v172
    v_fmac_f32 v201, v13, v173
    v_fmac_f32 v201, v14, v174
    v_fmac_f32 v201, v15, v175
    s_add_u32 m0, s21, 6144
    v_mfma_f32_32x32x8_bf16 v[56:71], v[92:93], v[176:177], v[56:71]
    v_mad_u32_u16 v240, v240, s3, v246 op_sel:[1,0,0,0]
    v_mad_u32_u16 v241, v241, s3, v246 op_sel:[1,0,0,0]
    buffer_load_dwordx4 v240, s[4:7], s41 offen  lds
    buffer_load_dwordx4 v241, s[8:11], s41 offen offset:1024  lds
    v_add_f32 v255, v197, v255
    s_set_gpr_idx_on s51, gpr_idx(DST)
    s_nop 0
    v_cvt_pk_bf16_f32 v206, v254, v255
    s_set_gpr_idx_off
    v_mfma_f32_32x32x16_bf16 v[0:15], v[72:75], v[180:183], 0
    v_mul_f32 v254, v16, v144
    v_fmac_f32 v254, v17, v145
    v_fmac_f32 v254, v18, v146
    v_fmac_f32 v254, v19, v147
    v_fmac_f32 v254, v20, v148
    v_fmac_f32 v254, v21, v149
    v_mfma_f32_32x32x16_bf16 v[32:47], v[76:79], v[180:183], v[32:47]
    v_fmac_f32 v254, v22, v150
    v_fmac_f32 v254, v23, v151
    v_fma_f32 v202, v24, -v160, v202
    v_fma_f32 v202, v25, -v161, v202
    v_permlane32_swap_b32 v254, v200
    v_fma_f32 v202, v26, -v162, v202
    v_mfma_f32_32x32x16_bf16 v[0:15], v[80:83], v[184:187], v[0:15]
    v_fma_f32 v202, v27, -v163, v202
    v_fma_f32 v202, v28, -v164, v202
    v_fma_f32 v202, v29, -v165, v202
    v_fma_f32 v202, v30, -v166, v202
    v_fma_f32 v202, v31, -v167, v202
    v_add_f32 v200, v254, v200
    v_mfma_f32_32x32x16_bf16 v[32:47], v[84:87], v[184:187], v[32:47]
    s_waitcnt vmcnt(8)
    ds_read_b64_tr_b16 v[176:177], v244 offset:0
    ds_read_b64_tr_b16 v[178:179], v244 offset:1024
    ds_read_b64_tr_b16 v[180:181], v245 offset:0
    ds_read_b64_tr_b16 v[182:183], v245 offset:1024
    v_mul_f32_e64 v198, v64, -v112
    v_permlane32_swap_b32 v202, v254
    v_mfma_f32_32x32x8_bf16 v[0:15], v[88:89], v[188:189], v[0:15]
    v_fma_f32 v198, v65, -v113, v198
    v_fma_f32 v198, v66, -v114, v198
    v_fma_f32 v198, v67, -v115, v198
    v_fma_f32 v198, v68, -v116, v198
    v_fma_f32 v198, v69, -v117, v198
    v_fma_f32 v198, v70, -v118, v198
    v_mfma_f32_32x32x8_bf16 v[32:47], v[92:93], v[188:189], v[32:47]
    v_add_u32 v249, s48, v249
    v_add_u32 v250, s49, v250
    v_fma_f32 v198, v71, -v119, v198
    v_add_f32 v254, v202, v254
    v_mul_f32 v196, v56, v160
    v_fmac_f32 v196, v57, v161
    v_fmac_f32 v196, v58, v162
    v_fmac_f32 v196, v59, v163
    v_fmac_f32 v196, v60, v164
    v_fmac_f32 v196, v61, v165
    v_fmac_f32 v196, v62, v166
    v_fmac_f32 v196, v63, v167
    s_nop 1
    v_permlane32_swap_b32 v198, v196
    v_add_f32 v196, v198, v196
    v_mul_f32 v255, v0, v152
    v_fmac_f32 v255, v1, v153
    v_fmac_f32 v255, v2, v154
    v_fmac_f32 v255, v3, v155
    v_fmac_f32 v255, v4, v156
    v_fmac_f32 v255, v5, v157
    v_fmac_f32 v255, v6, v158
    v_fmac_f32 v255, v7, v159
    v_fma_f32 v203, v8, -v168, v203
    v_fma_f32 v203, v9, -v169, v203
    v_permlane32_swap_b32 v255, v201
    v_fma_f32 v203, v10, -v170, v203
    v_fma_f32 v203, v11, -v171, v203
    v_fma_f32 v203, v12, -v172, v203
    v_fma_f32 v203, v13, -v173, v203
    v_fma_f32 v203, v14, -v174, v203
    v_fma_f32 v203, v15, -v175, v203
    v_add_f32 v201, v255, v201
    v_mul_f32_e64 v199, v40, -v120
    v_permlane32_swap_b32 v203, v255
    v_fma_f32 v199, v41, -v121, v199
    v_fma_f32 v199, v42, -v122, v199
    v_fma_f32 v199, v43, -v123, v199
    s_waitcnt vmcnt(6)
    ds_read_b64_tr_b16 v[72:73], v249 offset:0
    ds_read_b64_tr_b16 v[76:77], v249 offset:64
    ds_read_b64_tr_b16 v[74:75], v249 offset:256
    ds_read_b64_tr_b16 v[78:79], v249 offset:320
    s_mov_b64 exec, s[54:55]
    ds_read_u16_d16_hi v242, v250 offset:0
    s_mov_b64 exec, -1
    v_fma_f32 v199, v44, -v124, v199
    v_fma_f32 v199, v45, -v125, v199
    v_fma_f32 v199, v46, -v126, v199
    v_fma_f32 v199, v47, -v127, v199
    v_add_f32 v255, v203, v255
    v_mul_f32 v197, v32, v168
    v_fmac_f32 v197, v33, v169
    v_fmac_f32 v197, v34, v170
    v_fmac_f32 v197, v35, v171
    v_fmac_f32 v197, v36, v172
    v_fmac_f32 v197, v37, v173
    v_fmac_f32 v197, v38, v174
    v_fmac_f32 v197, v39, v175
    s_nop 1
    v_permlane32_swap_b32 v199, v197
    v_add_f32 v197, v199, v197
    s_set_gpr_idx_on s51, gpr_idx(DST)
    s_nop 0
    v_cvt_pk_bf16_f32 v207, v200, v201
    v_cvt_pk_bf16_f32 v209, v254, v255
    v_cvt_pk_bf16_f32 v208, v196, v197
    s_set_gpr_idx_off
    s_add_u32 s50, s50, 1
    s_add_u32 s51, s51, 6
    s_cmp_ge_u32 s50, 4
    s_cbranch_scc1 LAST0
    s_add_u32 s53, s53, 4
    s_xor_b32 s66, s53, s20
    s_bitcmp1_b32 s66, 2
    s_setprio 1
    s_cbranch_scc1 PRIO_6
    s_setprio 0
PRIO_6:
    s_cmp_eq_u32 s52, 4
    s_cbranch_scc1 ITEM_0_4
    s_cmp_eq_u32 s52, 5
    s_cbranch_scc1 ITEM_0_5
    s_cmp_eq_u32 s52, 3
    s_cbranch_scc1 ITEM_0_3
    s_cmp_eq_u32 s52, 6
    s_cbranch_scc1 ITEM_0_6
    s_cmp_eq_u32 s52, 8
    s_cbranch_scc1 ITEM_0_8
    s_branch ITEM_0_2
.p2align 6
ITEM_0_3:
    s_mov_b64 exec, s[54:55]
    ds_read_u16_d16_hi v243, v250 offset:128
    s_mov_b64 exec, -1
    ds_read_b64_tr_b16 v[80:81], v249 offset:512
    ds_read_b64_tr_b16 v[84:85], v249 offset:576
    s_waitcnt lgkmcnt(3)
    v_mul_f32_dpp v196, v242, v72 row_newbcast:0 row_mask:0xf bank_mask:0xf
    v_mul_f32_dpp v197, v242, v73 row_newbcast:1 row_mask:0xf bank_mask:0xf
    v_mul_f32_dpp v198, v242, v72 row_newbcast:8 row_mask:0xf bank_mask:0xf
    v_mul_f32_dpp v199, v242, v73 row_newbcast:9 row_mask:0xf bank_mask:0xf
    v_mul_f32_dpp v200, v242, v76 row_newbcast:2 row_mask:0xf bank_mask:0xf
    v_mul_f32_dpp v201, v242, v77 row_newbcast:3 row_mask:0xf bank_mask:0xf
    v_mul_f32_dpp v202, v242, v76 row_newbcast:10 row_mask:0xf bank_mask:0xf
    v_mul_f32_dpp v203, v242, v77 row_newbcast:11 row_mask:0xf bank_mask:0xf
    v_cvt_pk_bf16_f32 v72, v196, v197
    v_cvt_pk_bf16_f32 v76, v198, v199
    v_cvt_pk_bf16_f32 v73, v200, v201
    v_cvt_pk_bf16_f32 v77, v202, v203
    v_mul_f32_dpp v196, v242, v74 row_newbcast:4 row_mask:0xf bank_mask:0xf
    v_mul_f32_dpp v197, v242, v75 row_newbcast:5 row_mask:0xf bank_mask:0xf
    v_mul_f32_dpp v198, v242, v74 row_newbcast:12 row_mask:0xf bank_mask:0xf
    v_mul_f32_dpp v199, v242, v75 row_newbcast:13 row_mask:0xf bank_mask:0xf
    v_mul_f32_dpp v200, v242, v78 row_newbcast:6 row_mask:0xf bank_mask:0xf
    v_mul_f32_dpp v201, v242, v79 row_newbcast:7 row_mask:0xf bank_mask:0xf
    v_mul_f32_dpp v202, v242, v78 row_newbcast:14 row_mask:0xf bank_mask:0xf
    v_mul_f32_dpp v203, v242, v79 row_newbcast:15 row_mask:0xf bank_mask:0xf
    v_cvt_pk_bf16_f32 v74, v196, v197
    v_cvt_pk_bf16_f32 v78, v198, v199
    v_cvt_pk_bf16_f32 v75, v200, v201
    v_cvt_pk_bf16_f32 v79, v202, v203
    s_waitcnt vmcnt(4) lgkmcnt(0)
    v_mfma_f32_32x32x16_bf16 v[56:71], v[72:75], v[176:179], 0
    v_mul_f32_dpp v196, v243, v80 row_newbcast:0 row_mask:0xf bank_mask:0xf
    v_mul_f32_dpp v197, v243, v81 row_newbcast:1 row_mask:0xf bank_mask:0xf
    v_mul_f32_dpp v198, v243, v80 row_newbcast:8 row_mask:0xf bank_mask:0xf
    v_mul_f32_dpp v199, v243, v81 row_newbcast:9 row_mask:0xf bank_mask:0xf
    v_mul_f32_dpp v200, v243, v84 row_newbcast:2 row_mask:0xf bank_mask:0xf
    v_mul_f32_dpp v201, v243, v85 row_newbcast:3 row_mask:0xf bank_mask:0xf
    s_add_u32 m0, s21, 0
    v_mfma_f32_32x32x16_bf16 v[16:31], v[76:79], v[176:179], 0
    buffer_load_dwordx4 v234, s[4:7], s36 offen  lds
    buffer_load_dwordx4 v235, s[8:11], s36 offen offset:1024  lds
    ds_read_b64_tr_b16 v[176:177], v244 offset:2048
    ds_read_b64_tr_b16 v[184:185], v245 offset:2048
    v_mul_f32_dpp v202, v243, v84 row_newbcast:10 row_mask:0xf bank_mask:0xf
    v_mul_f32_dpp v203, v243, v85 row_newbcast:11 row_mask:0xf bank_mask:0xf
    v_cvt_pk_bf16_f32 v80, v196, v197
    v_cvt_pk_bf16_f32 v84, v198, v199
    v_cvt_pk_bf16_f32 v81, v200, v201
    v_cvt_pk_bf16_f32 v85, v202, v203
    s_waitcnt lgkmcnt(0)
    v_mfma_f32_32x32x8_bf16 v[56:71], v[80:81], v[176:177], v[56:71]
    s_add_u32 m0, s21, 2048
    v_mfma_f32_32x32x8_bf16 v[16:31], v[84:85], v[176:177], v[16:31]
    buffer_load_dwordx4 v236, s[4:7], s36 offen  lds
    s_mov_b32 m0, s50
    s_nop 0
    s_movrels_b32 s71, s23
    s_bfe_u32 s46, s71, 0x30012
    s_mov_b32 m0, s46
    s_and_b32 s66, s71, 0x3ffff
    s_movrels_b32 s68, s57
    s_movrels_b32 s69, s61
    s_sub_u32 s48, s66, s47
    s_mov_b32 s47, s66
    s_lshr_b32 s52, s71, 28
    s_lshl_b32 s67, s46, 9
    s_add_u32 s66, s66, s67
    s_sub_u32 s49, s66, s42
    s_mov_b32 s42, s66
    s_bfe_u32 s66, s68, 655360
    s_add_u32 s43, s42, s66
    s_bfe_u32 s39, s69, 655360
    s_bfe_u32 s66, s68, 655370
    s_add_u32 s44, s42, s66
    s_bfe_u32 s40, s69, 655370
    s_bfe_u32 s66, s68, 655380
    s_add_u32 s45, s42, s66
    s_bfe_u32 s41, s69, 655380
    s_and_b32 s66, s46, s33
    s_cselect_b32 s72, -1, 1
    s_cselect_b32 s76, s47, 163712
    s_cmp_ge_u32 s66, 2
    s_cselect_b32 s73, -1, 0
    s_add_u32 s77, s47, 1024
    s_cmp_ge_u32 s66, 4
    s_cselect_b32 s75, -1, 0
    s_cmp_ge_u32 s66, 3
    s_cselect_b32 s74, -1, 1
    s_cselect_b32 s77, s77, 163712
    v_add_u32 v252, s44, v247
    ds_read2_b32 v[238:239], v252 offset0:0 offset1:16
    v_add_u32 v252, s45, v247
    ds_read2_b32 v[240:241], v252 offset0:0 offset1:16
    v_mfma_f32_32x32x16_bf16 v[32:47], v[72:75], v[180:183], 0
    v_mul_f32 v196, v56, v96
    v_fmac_f32 v196, v57, v97
    v_fmac_f32 v196, v58, v98
    v_fmac_f32 v196, v59, v99
    v_fmac_f32 v196, v60, v100
    v_fmac_f32 v196, v61, v101
    v_mfma_f32_32x32x16_bf16 v[0:15], v[76:79], v[180:183], 0
    s_waitcnt vmcnt(5)
    ds_read_b64_tr_b16 v[176:177], v244 offset:4096
    ds_read_b64_tr_b16 v[178:179], v244 offset:5120
    ds_read_b64_tr_b16 v[180:181], v245 offset:4096
    ds_read_b64_tr_b16 v[182:183], v245 offset:5120
    v_fmac_f32 v196, v62, v102
    v_fmac_f32 v196, v63, v103
    v_mfma_f32_32x32x8_bf16 v[32:47], v[80:81], v[184:185], v[32:47]
    v_mul_f32 v198, v64, v128
    v_fmac_f32 v198, v65, v129
    v_fmac_f32 v198, v66, v130
    v_fmac_f32 v198, v67, v131
    v_fmac_f32 v198, v68, v132
    v_fmac_f32 v198, v69, v133
    v_mfma_f32_32x32x8_bf16 v[0:15], v[84:85], v[184:185], v[0:15]
    v_fmac_f32 v198, v70, v134
    v_fmac_f32 v198, v71, v135
    v_mul_f32 v200, v16, v128
    v_fmac_f32 v200, v17, v129
    v_permlane32_swap_b32 v196, v198
    v_fmac_f32 v200, v18, v130
    v_fmac_f32 v200, v19, v131
    v_fmac_f32 v200, v20, v132
    v_fmac_f32 v200, v21, v133
    v_fmac_f32 v200, v22, v134
    v_fmac_f32 v200, v23, v135
    v_add_f32 v198, v196, v198
    v_mul_f32_e64 v202, v24, -v128
    v_fma_f32 v202, v25, -v129, v202
    v_fma_f32 v202, v26, -v130, v202
    v_fma_f32 v202, v27, -v131, v202
    v_fma_f32 v202, v28, -v132, v202
    v_fma_f32 v202, v29, -v133, v202
    v_fma_f32 v202, v30, -v134, v202
    v_fma_f32 v202, v31, -v135, v202
    s_nop 1
    v_permlane32_swap_b32 v200, v202
    v_add_f32 v202, v200, v202
    s_waitcnt vmcnt(3) lgkmcnt(0)
    v_mfma_f32_32x32x16_bf16 v[56:71], v[72:75], v[176:179], 0
    v_mul_f32 v197, v32, v104
    v_fmac_f32 v197, v33, v105
    v_fmac_f32 v197, v34, v106
    v_fmac_f32 v197, v35, v107
    v_fmac_f32 v197, v36, v108
    v_fmac_f32 v197, v37, v109
    s_add_u32 m0, s21, 4096
    v_mfma_f32_32x32x16_bf16 v[16:31], v[76:79], v[176:179], 0
    buffer_load_dwordx4 v234, s[4:7], s37 offen  lds
    buffer_load_dwordx4 v235, s[8:11], s37 offen offset:1024  lds
    ds_read_b64_tr_b16 v[176:177], v244 offset:6144
    ds_read_b64_tr_b16 v[184:185], v245 offset:6144
    v_add_u32 v252, s42, v247
    ds_read2_b32 v[234:235], v252 offset0:0 offset1:16
    v_fmac_f32 v197, v38, v110
    v_fmac_f32 v197, v39, v111
    v_mul_f32 v199, v40, v136
    v_fmac_f32 v199, v41, v137
    v_fmac_f32 v199, v42, v138
    v_fmac_f32 v199, v43, v139
    v_fmac_f32 v199, v44, v140
    v_fmac_f32 v199, v45, v141
    v_fmac_f32 v199, v46, v142
    v_fmac_f32 v199, v47, v143
    v_mul_f32 v201, v0, v136
    v_fmac_f32 v201, v1, v137
    v_permlane32_swap_b32 v197, v199
    v_fmac_f32 v201, v2, v138
    v_fmac_f32 v201, v3, v139
    v_fmac_f32 v201, v4, v140
    v_fmac_f32 v201, v5, v141
    v_fmac_f32 v201, v6, v142
    v_fmac_f32 v201, v7, v143
    v_add_f32 v199, v197, v199
    v_mul_f32_e64 v203, v8, -v136
    v_fma_f32 v203, v9, -v137, v203
    v_fma_f32 v203, v10, -v138, v203
    s_waitcnt lgkmcnt(1)
    v_mfma_f32_32x32x8_bf16 v[56:71], v[80:81], v[176:177], v[56:71]
    v_fma_f32 v203, v11, -v139, v203
    v_fma_f32 v203, v12, -v140, v203
    v_fma_f32 v203, v13, -v141, v203
    v_fma_f32 v203, v14, -v142, v203
    v_fma_f32 v203, v15, -v143, v203
    s_nop 1
    v_permlane32_swap_b32 v201, v203
    s_add_u32 m0, s21, 6144
    v_mfma_f32_32x32x8_bf16 v[16:31], v[84:85], v[176:177], v[16:31]
    buffer_load_dwordx4 v236, s[4:7], s37 offen  lds
    v_add_u32 v252, s43, v247
    ds_read2_b32 v[236:237], v252 offset0:0 offset1:16
    v_add_f32 v203, v201, v203
    s_set_gpr_idx_on s51, gpr_idx(DST)
    s_nop 0
    v_cvt_pk_bf16_f32 v204, v198, v199
    v_cvt_pk_bf16_f32 v205, v202, v203
    s_set_gpr_idx_off
    v_mfma_f32_32x32x16_bf16 v[32:47], v[72:75], v[180:183], 0
    v_mul_f32 v196, v56, v144
    v_fmac_f32 v196, v57, v145
    v_fmac_f32 v196, v58, v146
    v_fmac_f32 v196, v59, v147
    v_fmac_f32 v196, v60, v148
    v_fmac_f32 v196, v61, v149
    v_mfma_f32_32x32x16_bf16 v[0:15], v[76:79], v[180:183], 0
    s_waitcnt vmcnt(4)
    ds_read_b64_tr_b16 v[176:177], v244 offset:0
    ds_read_b64_tr_b16 v[178:179], v244 offset:1024
    ds_read_b64_tr_b16 v[180:181], v245 offset:0
    ds_read_b64_tr_b16 v[182:183], v245 offset:1024
    v_fmac_f32 v196, v62, v150
    v_fmac_f32 v196, v63, v151
    v_mfma_f32_32x32x8_bf16 v[32:47], v[80:81], v[184:185], v[32:47]
    v_mul_f32_e64 v200, v16, -v160
    v_fma_f32 v200, v17, -v161, v200
    v_fma_f32 v200, v18, -v162, v200
    v_fma_f32 v200, v19, -v163, v200
    v_fma_f32 v200, v20, -v164, v200
    v_fma_f32 v200, v21, -v165, v200
    v_mfma_f32_32x32x8_bf16 v[0:15], v[84:85], v[184:185], v[0:15]
    v_fma_f32 v200, v22, -v166, v200
    v_fma_f32 v200, v23, -v167, v200
    v_mul_f32_e64 v202, v24, -v160
    v_fma_f32 v202, v25, -v161, v202
    v_fma_f32 v202, v26, -v162, v202
    v_fma_f32 v202, v27, -v163, v202
    v_fma_f32 v202, v28, -v164, v202
    v_fma_f32 v202, v29, -v165, v202
    v_fma_f32 v202, v30, -v166, v202
    v_fma_f32 v202, v31, -v167, v202
    s_waitcnt vmcnt(3) lgkmcnt(0)
    v_mfma_f32_32x32x16_bf16 v[16:31], v[72:75], v[176:179], 0
    v_mul_f32 v197, v32, v152
    v_fmac_f32 v197, v33, v153
    v_fmac_f32 v197, v34, v154
    v_fmac_f32 v197, v35, v155
    v_fmac_f32 v197, v36, v156
    v_fmac_f32 v197, v37, v157
    s_add_u32 m0, s21, 0
    v_mfma_f32_32x32x16_bf16 v[48:63], v[76:79], v[176:179], 0
    v_mad_u32_u16 v234, v234, s3, v246 op_sel:[1,0,0,0]
    v_mad_u32_u16 v235, v235, s3, v246 op_sel:[1,0,0,0]
    buffer_load_dwordx4 v234, s[4:7], s38 offen  lds
    buffer_load_dwordx4 v235, s[8:11], s38 offen offset:1024  lds
    ds_read_b64_tr_b16 v[176:177], v244 offset:2048
    ds_read_b64_tr_b16 v[184:185], v245 offset:2048
    v_fmac_f32 v197, v38, v158
    v_fmac_f32 v197, v39, v159
    v_mul_f32_e64 v201, v0, -v168
    v_fma_f32 v201, v1, -v169, v201
    v_fma_f32 v201, v2, -v170, v201
    v_fma_f32 v201, v3, -v171, v201
    v_fma_f32 v201, v4, -v172, v201
    v_fma_f32 v201, v5, -v173, v201
    v_fma_f32 v201, v6, -v174, v201
    v_fma_f32 v201, v7, -v175, v201
    s_waitcnt lgkmcnt(0)
    v_mfma_f32_32x32x8_bf16 v[16:31], v[80:81], v[176:177], v[16:31]
    v_mul_f32_e64 v203, v8, -v168
    v_fma_f32 v203, v9, -v169, v203
    v_fma_f32 v203, v10, -v170, v203
    v_fma_f32 v203, v11, -v171, v203
    v_fma_f32 v203, v12, -v172, v203
    v_fma_f32 v203, v13, -v173, v203
    s_add_u32 m0, s21, 2048
    v_mfma_f32_32x32x8_bf16 v[48:63], v[84:85], v[176:177], v[48:63]
    v_mad_u32_u16 v236, v236, s3, v246 op_sel:[1,0,0,0]
    v_mad_u32_u16 v237, v237, s3, v246 op_sel:[1,0,0,0]
    buffer_load_dwordx4 v236, s[4:7], s39 offen  lds
    buffer_load_dwordx4 v237, s[8:11], s39 offen offset:1024  lds
    v_fma_f32 v203, v14, -v174, v203
    v_fma_f32 v203, v15, -v175, v203
    v_mfma_f32_32x32x16_bf16 v[0:15], v[72:75], v[180:183], 0
    v_fmac_f32 v200, v24, v160
    v_fmac_f32 v200, v25, v161
    v_fmac_f32 v200, v26, v162
    v_fmac_f32 v200, v27, v163
    v_fmac_f32 v200, v28, v164
    v_fmac_f32 v200, v29, v165
    v_fmac_f32 v200, v30, v166
    v_fmac_f32 v200, v31, v167
    v_mfma_f32_32x32x16_bf16 v[24:39], v[76:79], v[180:183], 0
    v_add_u32 v253, s47, v248
    ds_read_b32 v192, v253
    ds_read_b32 v193, v253 offset:256
    s_waitcnt vmcnt(5)
    ds_read_b64_tr_b16 v[176:177], v244 offset:4096
    ds_read_b64_tr_b16 v[178:179], v244 offset:5120
    ds_read_b64_tr_b16 v[180:181], v245 offset:4096
    ds_read_b64_tr_b16 v[182:183], v245 offset:5120
    v_mfma_f32_32x32x8_bf16 v[24:39], v[84:85], v[184:185], v[24:39]
    v_mul_f32 v254, v16, v144
    v_fmac_f32 v254, v17, v145
    v_fmac_f32 v254, v18, v146
    v_fmac_f32 v254, v19, v147
    v_fmac_f32 v254, v20, v148
    v_fmac_f32 v254, v21, v149
    v_mfma_f32_32x32x8_bf16 v[0:15], v[80:81], v[184:185], v[0:15]
    v_fmac_f32 v254, v22, v150
    v_fmac_f32 v254, v23, v151
    v_sub_f32_e64 v64, -v48, v64
    v_sub_f32_e64 v65, -v49, v65
    v_permlane32_swap_b32 v196, v254
    v_sub_f32_e64 v66, -v50, v66
    v_sub_f32_e64 v67, -v51, v67
    v_sub_f32_e64 v68, -v52, v68
    v_sub_f32_e64 v69, -v53, v69
    v_sub_f32_e64 v70, -v54, v70
    v_sub_f32_e64 v71, -v55, v71
    v_add_f32 v254, v196, v254
    s_waitcnt vmcnt(4) lgkmcnt(0)
    v_mfma_f32_32x32x16_bf16 v[56:71], v[76:79], v[176:179], v[56:71]
    v_sub_f32_e64 v40, -v24, v40
    v_sub_f32_e64 v41, -v25, v41
    v_sub_f32_e64 v42, -v26, v42
    v_sub_f32_e64 v43, -v27, v43
    v_sub_f32_e64 v44, -v28, v44
    v_sub_f32_e64 v45, -v29, v45
    v_sub_f32_e64 v46, -v30, v46
    v_sub_f32_e64 v47, -v31, v47
    s_mov_b32 m0, s76
    s_mov_b64 exec, s[72:73]
    buffer_load_dwordx4 v192, s[12:15], 0 offen  lds
    s_mov_b32 m0, s77
    s_mov_b64 exec, s[74:75]
    buffer_load_dwordx4 v193, s[12:15], 0 offen  lds
    s_mov_b64 exec, -1
    s_add_u32 m0, s21, 4096
    v_mfma_f32_32x32x16_bf16 v[16:31], v[72:75], v[176:179], 0
    v_mad_u32_u16 v238, v238, s3, v246 op_sel:[1,0,0,0]
    v_mad_u32_u16 v239, v239, s3, v246 op_sel:[1,0,0,0]
    buffer_load_dwordx4 v238, s[4:7], s40 offen  lds
    buffer_load_dwordx4 v239, s[8:11], s40 offen offset:1024  lds
    ds_read_b64_tr_b16 v[176:177], v244 offset:6144
    ds_read_b64_tr_b16 v[184:185], v245 offset:6144
    v_mul_f32 v255, v0, v152
    v_fmac_f32 v255, v1, v153
    v_fmac_f32 v255, v2, v154
    v_fmac_f32 v255, v3, v155
    v_fmac_f32 v255, v4, v156
    v_fmac_f32 v255, v5, v157
    v_fmac_f32 v255, v6, v158
    v_fmac_f32 v255, v7, v159
    v_fmac_f32 v201, v8, v168
    v_fmac_f32 v201, v9, v169
    v_permlane32_swap_b32 v197, v255
    s_waitcnt lgkmcnt(0)
    v_mfma_f32_32x32x8_bf16 v[16:31], v[80:81], v[176:177], v[16:31]
    v_fmac_f32 v201, v10, v170
    v_fmac_f32 v201, v11, v171
    v_fmac_f32 v201, v12, v172
    v_fmac_f32 v201, v13, v173
    v_fmac_f32 v201, v14, v174
    v_fmac_f32 v201, v15, v175
    s_add_u32 m0, s21, 6144
    v_mfma_f32_32x32x8_bf16 v[56:71], v[84:85], v[176:177], v[56:71]
    v_mad_u32_u16 v240, v240, s3, v246 op_sel:[1,0,0,0]
    v_mad_u32_u16 v241, v241, s3, v246 op_sel:[1,0,0,0]
    buffer_load_dwordx4 v240, s[4:7], s41 offen  lds
    buffer_load_dwordx4 v241, s[8:11], s41 offen offset:1024  lds
    v_add_f32 v255, v197, v255
    s_set_gpr_idx_on s51, gpr_idx(DST)
    s_nop 0
    v_cvt_pk_bf16_f32 v206, v254, v255
    s_set_gpr_idx_off
    v_mfma_f32_32x32x16_bf16 v[0:15], v[72:75], v[180:183], 0
    v_mul_f32 v254, v16, v144
    v_fmac_f32 v254, v17, v145
    v_fmac_f32 v254, v18, v146
    v_fmac_f32 v254, v19, v147
    v_fmac_f32 v254, v20, v148
    v_fmac_f32 v254, v21, v149
    v_mfma_f32_32x32x16_bf16 v[32:47], v[76:79], v[180:183], v[32:47]
    s_waitcnt vmcnt(8)
    ds_read_b64_tr_b16 v[176:177], v244 offset:0
    ds_read_b64_tr_b16 v[178:179], v244 offset:1024
    ds_read_b64_tr_b16 v[180:181], v245 offset:0
    ds_read_b64_tr_b16 v[182:183], v245 offset:1024
    v_fmac_f32 v254, v22, v150
    v_fmac_f32 v254, v23, v151
    v_mfma_f32_32x32x8_bf16 v[0:15], v[80:81], v[184:185], v[0:15]
    v_fma_f32 v202, v24, -v160, v202
    v_fma_f32 v202, v25, -v161, v202
    v_permlane32_swap_b32 v254, v200
    v_fma_f32 v202, v26, -v162, v202
    v_fma_f32 v202, v27, -v163, v202
    v_fma_f32 v202, v28, -v164, v202
    v_mfma_f32_32x32x8_bf16 v[32:47], v[84:85], v[184:185], v[32:47]
    v_add_u32 v249, s48, v249
    v_add_u32 v250, s49, v250
    v_fma_f32 v202, v29, -v165, v202
    v_fma_f32 v202, v30, -v166, v202
    v_fma_f32 v202, v31, -v167, v202
    v_add_f32 v200, v254, v200
    v_mul_f32_e64 v198, v64, -v112
    v_permlane32_swap_b32 v202, v254
    v_fma_f32 v198, v65, -v113, v198
    v_fma_f32 v198, v66, -v114, v198
    v_fma_f32 v198, v67, -v115, v198
    v_fma_f32 v198, v68, -v116, v198
    v_fma_f32 v198, v69, -v117, v198
    v_fma_f32 v198, v70, -v118, v198
    v_fma_f32 v198, v71, -v119, v198
    v_add_f32 v254, v202, v254
    v_mul_f32 v196, v56, v160
    v_fmac_f32 v196, v57, v161
    v_fmac_f32 v196, v58, v162
    v_fmac_f32 v196, v59, v163
    v_fmac_f32 v196, v60, v164
    v_fmac_f32 v196, v61, v165
    v_fmac_f32 v196, v62, v166
    v_fmac_f32 v196, v63, v167
    s_nop 1
    v_permlane32_swap_b32 v198, v196
    v_add_f32 v196, v198, v196
    v_mul_f32 v255, v0, v152
    v_fmac_f32 v255, v1, v153
    v_fmac_f32 v255, v2, v154
    v_fmac_f32 v255, v3, v155
    v_fmac_f32 v255, v4, v156
    v_fmac_f32 v255, v5, v157
    v_fmac_f32 v255, v6, v158
    v_fmac_f32 v255, v7, v159
    v_fma_f32 v203, v8, -v168, v203
    v_fma_f32 v203, v9, -v169, v203
    v_permlane32_swap_b32 v255, v201
    v_fma_f32 v203, v10, -v170, v203
    v_fma_f32 v203, v11, -v171, v203
    v_fma_f32 v203, v12, -v172, v203
    v_fma_f32 v203, v13, -v173, v203
    v_fma_f32 v203, v14, -v174, v203
    v_fma_f32 v203, v15, -v175, v203
    v_add_f32 v201, v255, v201
    v_mul_f32_e64 v199, v40, -v120
    v_permlane32_swap_b32 v203, v255
    v_fma_f32 v199, v41, -v121, v199
    v_fma_f32 v199, v42, -v122, v199
    v_fma_f32 v199, v43, -v123, v199
    s_waitcnt vmcnt(4)
    ds_read_b64_tr_b16 v[72:73], v249 offset:0
    ds_read_b64_tr_b16 v[76:77], v249 offset:64
    ds_read_b64_tr_b16 v[74:75], v249 offset:256
    ds_read_b64_tr_b16 v[78:79], v249 offset:320
    s_mov_b64 exec, s[54:55]
    ds_read_u16_d16_hi v242, v250 offset:0
    s_mov_b64 exec, -1
    v_fma_f32 v199, v44, -v124, v199
    v_fma_f32 v199, v45, -v125, v199
    v_fma_f32 v199, v46, -v126, v199
    v_fma_f32 v199, v47, -v127, v199
    v_add_f32 v255, v203, v255
    v_mul_f32 v197, v32, v168
    v_fmac_f32 v197, v33, v169
    v_fmac_f32 v197, v34, v170
    v_fmac_f32 v197, v35, v171
    v_fmac_f32 v197, v36, v172
    v_fmac_f32 v197, v37, v173
    v_fmac_f32 v197, v38, v174
    v_fmac_f32 v197, v39, v175
    s_nop 1
    v_permlane32_swap_b32 v199, v197
    v_add_f32 v197, v199, v197
    s_set_gpr_idx_on s51, gpr_idx(DST)
    s_nop 0
    v_cvt_pk_bf16_f32 v207, v200, v201
    v_cvt_pk_bf16_f32 v209, v254, v255
    v_cvt_pk_bf16_f32 v208, v196, v197
    s_set_gpr_idx_off
    s_add_u32 s50, s50, 1
    s_add_u32 s51, s51, 6
    s_cmp_ge_u32 s50, 4
    s_cbranch_scc1 LAST0
    s_add_u32 s53, s53, 4
    s_xor_b32 s66, s53, s20
    s_bitcmp1_b32 s66, 2
    s_setprio 1
    s_cbranch_scc1 PRIO_7
    s_setprio 0
PRIO_7:
    s_cmp_eq_u32 s52, 4
    s_cbranch_scc1 ITEM_0_4
    s_cmp_eq_u32 s52, 5
    s_cbranch_scc1 ITEM_0_5
    s_cmp_eq_u32 s52, 3
    s_cbranch_scc1 ITEM_0_3
    s_cmp_eq_u32 s52, 6
    s_cbranch_scc1 ITEM_0_6
    s_cmp_eq_u32 s52, 8
    s_cbranch_scc1 ITEM_0_8
    s_branch ITEM_0_2
.p2align 6
ITEM_0_6:
    s_mov_b64 exec, s[54:55]
    ds_read_u16_d16_hi v243, v250 offset:128
    s_mov_b64 exec, -1
    ds_read_b64_tr_b16 v[80:81], v249 offset:512
    ds_read_b64_tr_b16 v[84:85], v249 offset:576
    ds_read_b64_tr_b16 v[82:83], v249 offset:768
    ds_read_b64_tr_b16 v[86:87], v249 offset:832
    ds_read_b64_tr_b16 v[88:89], v249 offset:1024
    ds_read_b64_tr_b16 v[92:93], v249 offset:1088
    ds_read_b64_tr_b16 v[90:91], v249 offset:1280
    ds_read_b64_tr_b16 v[94:95], v249 offset:1344
    s_waitcnt lgkmcnt(9)
    v_mul_f32_dpp v196, v242, v72 row_newbcast:0 row_mask:0xf bank_mask:0xf
    v_mul_f32_dpp v197, v242, v73 row_newbcast:1 row_mask:0xf bank_mask:0xf
    v_mul_f32_dpp v198, v242, v72 row_newbcast:8 row_mask:0xf bank_mask:0xf
    v_mul_f32_dpp v199, v242, v73 row_newbcast:9 row_mask:0xf bank_mask:0xf
    v_mul_f32_dpp v200, v242, v76 row_newbcast:2 row_mask:0xf bank_mask:0xf
    v_mul_f32_dpp v201, v242, v77 row_newbcast:3 row_mask:0xf bank_mask:0xf
    v_mul_f32_dpp v202, v242, v76 row_newbcast:10 row_mask:0xf bank_mask:0xf
    v_mul_f32_dpp v203, v242, v77 row_newbcast:11 row_mask:0xf bank_mask:0xf
    v_cvt_pk_bf16_f32 v72, v196, v197
    v_cvt_pk_bf16_f32 v76, v198, v199
    v_cvt_pk_bf16_f32 v73, v200, v201
    v_cvt_pk_bf16_f32 v77, v202, v203
    v_mul_f32_dpp v196, v242, v74 row_newbcast:4 row_mask:0xf bank_mask:0xf
    v_mul_f32_dpp v197, v242, v75 row_newbcast:5 row_mask:0xf bank_mask:0xf
    v_mul_f32_dpp v198, v242, v74 row_newbcast:12 row_mask:0xf bank_mask:0xf
    v_mul_f32_dpp v199, v242, v75 row_newbcast:13 row_mask:0xf bank_mask:0xf
    v_mul_f32_dpp v200, v242, v78 row_newbcast:6 row_mask:0xf bank_mask:0xf
    v_mul_f32_dpp v201, v242, v79 row_newbcast:7 row_mask:0xf bank_mask:0xf
    v_mul_f32_dpp v202, v242, v78 row_newbcast:14 row_mask:0xf bank_mask:0xf
    v_mul_f32_dpp v203, v242, v79 row_newbcast:15 row_mask:0xf bank_mask:0xf
    v_cvt_pk_bf16_f32 v74, v196, v197
    v_cvt_pk_bf16_f32 v78, v198, v199
    v_cvt_pk_bf16_f32 v75, v200, v201
    v_cvt_pk_bf16_f32 v79, v202, v203
    s_mov_b64 exec, s[54:55]
    ds_read_u16_d16_hi v242, v250 offset:256
    s_mov_b64 exec, -1
    s_waitcnt vmcnt(4) lgkmcnt(5)
    v_mfma_f32_32x32x16_bf16 v[56:71], v[72:75], v[176:179], 0
    v_mul_f32_dpp v196, v243, v80 row_newbcast:0 row_mask:0xf bank_mask:0xf
    v_mul_f32_dpp v197, v243, v81 row_newbcast:1 row_mask:0xf bank_mask:0xf
    v_mul_f32_dpp v198, v243, v80 row_newbcast:8 row_mask:0xf bank_mask:0xf
    v_mul_f32_dpp v199, v243, v81 row_newbcast:9 row_mask:0xf bank_mask:0xf
    v_mul_f32_dpp v200, v243, v84 row_newbcast:2 row_mask:0xf bank_mask:0xf
    v_mul_f32_dpp v201, v243, v85 row_newbcast:3 row_mask:0xf bank_mask:0xf
    s_add_u32 m0, s21, 0
    v_mfma_f32_32x32x16_bf16 v[16:31], v[76:79], v[176:179], 0
    buffer_load_dwordx4 v236, s[4:7], s35 offen  lds
    buffer_load_dwordx4 v237, s[8:11], s35 offen offset:1024  lds
    ds_read_b64_tr_b16 v[176:177], v244 offset:2048
    ds_read_b64_tr_b16 v[178:179], v244 offset:3072
    ds_read_b64_tr_b16 v[184:185], v245 offset:2048
    ds_read_b64_tr_b16 v[186:187], v245 offset:3072
    v_mul_f32_dpp v202, v243, v84 row_newbcast:10 row_mask:0xf bank_mask:0xf
    v_mul_f32_dpp v203, v243, v85 row_newbcast:11 row_mask:0xf bank_mask:0xf
    v_cvt_pk_bf16_f32 v80, v196, v197
    v_cvt_pk_bf16_f32 v84, v198, v199
    v_cvt_pk_bf16_f32 v81, v200, v201
    v_cvt_pk_bf16_f32 v85, v202, v203
    v_mul_f32_dpp v196, v243, v82 row_newbcast:4 row_mask:0xf bank_mask:0xf
    v_mul_f32_dpp v197, v243, v83 row_newbcast:5 row_mask:0xf bank_mask:0xf
    v_mul_f32_dpp v198, v243, v82 row_newbcast:12 row_mask:0xf bank_mask:0xf
    v_mul_f32_dpp v199, v243, v83 row_newbcast:13 row_mask:0xf bank_mask:0xf
    v_mul_f32_dpp v200, v243, v86 row_newbcast:6 row_mask:0xf bank_mask:0xf
    v_mul_f32_dpp v201, v243, v87 row_newbcast:7 row_mask:0xf bank_mask:0xf
    v_mul_f32_dpp v202, v243, v86 row_newbcast:14 row_mask:0xf bank_mask:0xf
    v_mul_f32_dpp v203, v243, v87 row_newbcast:15 row_mask:0xf bank_mask:0xf
    v_cvt_pk_bf16_f32 v82, v196, v197
    v_cvt_pk_bf16_f32 v86, v198, v199
    v_cvt_pk_bf16_f32 v83, v200, v201
    v_cvt_pk_bf16_f32 v87, v202, v203
    s_waitcnt vmcnt(4) lgkmcnt(0)
    v_mfma_f32_32x32x16_bf16 v[56:71], v[80:83], v[176:179], v[56:71]
    v_mul_f32_dpp v196, v242, v88 row_newbcast:0 row_mask:0xf bank_mask:0xf
    v_mul_f32_dpp v197, v242, v89 row_newbcast:1 row_mask:0xf bank_mask:0xf
    v_mul_f32_dpp v198, v242, v88 row_newbcast:8 row_mask:0xf bank_mask:0xf
    v_mul_f32_dpp v199, v242, v89 row_newbcast:9 row_mask:0xf bank_mask:0xf
    v_mul_f32_dpp v200, v242, v92 row_newbcast:2 row_mask:0xf bank_mask:0xf
    v_mul_f32_dpp v201, v242, v93 row_newbcast:3 row_mask:0xf bank_mask:0xf
    s_add_u32 m0, s21, 2048
    v_mfma_f32_32x32x16_bf16 v[16:31], v[84:87], v[176:179], v[16:31]
    buffer_load_dwordx4 v238, s[4:7], s35 offen  lds
    buffer_load_dwordx4 v239, s[8:11], s35 offen offset:1024  lds
    ds_read_b64_tr_b16 v[176:177], v244 offset:4096
    ds_read_b64_tr_b16 v[178:179], v244 offset:5120
    ds_read_b64_tr_b16 v[188:189], v245 offset:4096
    ds_read_b64_tr_b16 v[190:191], v245 offset:5120
    v_mul_f32_dpp v202, v242, v92 row_newbcast:10 row_mask:0xf bank_mask:0xf
    v_mul_f32_dpp v203, v242, v93 row_newbcast:11 row_mask:0xf bank_mask:0xf
    v_cvt_pk_bf16_f32 v88, v196, v197
    v_cvt_pk_bf16_f32 v92, v198, v199
    v_cvt_pk_bf16_f32 v89, v200, v201
    v_cvt_pk_bf16_f32 v93, v202, v203
    v_mul_f32_dpp v196, v242, v90 row_newbcast:4 row_mask:0xf bank_mask:0xf
    v_mul_f32_dpp v197, v242, v91 row_newbcast:5 row_mask:0xf bank_mask:0xf
    v_mul_f32_dpp v198, v242, v90 row_newbcast:12 row_mask:0xf bank_mask:0xf
    v_mul_f32_dpp v199, v242, v91 row_newbcast:13 row_mask:0xf bank_mask:0xf
    v_mul_f32_dpp v200, v242, v94 row_newbcast:6 row_mask:0xf bank_mask:0xf
    v_mul_f32_dpp v201, v242, v95 row_newbcast:7 row_mask:0xf bank_mask:0xf
    v_mul_f32_dpp v202, v242, v94 row_newbcast:14 row_mask:0xf bank_mask:0xf
    v_mul_f32_dpp v203, v242, v95 row_newbcast:15 row_mask:0xf bank_mask:0xf
    v_cvt_pk_bf16_f32 v90, v196, v197
    v_cvt_pk_bf16_f32 v94, v198, v199
    v_cvt_pk_bf16_f32 v91, v200, v201
    v_cvt_pk_bf16_f32 v95, v202, v203
    s_waitcnt lgkmcnt(0)
    v_mfma_f32_32x32x16_bf16 v[56:71], v[88:91], v[176:179], v[56:71]
    s_add_u32 m0, s21, 4096
    v_mfma_f32_32x32x16_bf16 v[16:31], v[92:95], v[176:179], v[16:31]
    buffer_load_dwordx4 v234, s[4:7], s36 offen  lds
    buffer_load_dwordx4 v235, s[8:11], s36 offen offset:1024  lds
    s_mov_b32 m0, s50
    s_nop 0
    s_movrels_b32 s71, s23
    s_bfe_u32 s46, s71, 0x30012
    s_mov_b32 m0, s46
    s_and_b32 s66, s71, 0x3ffff
    s_movrels_b32 s68, s57
    s_movrels_b32 s69, s61
    s_sub_u32 s48, s66, s47
    s_mov_b32 s47, s66
    s_lshr_b32 s52, s71, 28
    s_lshl_b32 s67, s46, 9
    s_add_u32 s66, s66, s67
    s_sub_u32 s49, s66, s42
    s_mov_b32 s42, s66
    s_bfe_u32 s66, s68, 655360
    s_add_u32 s43, s42, s66
    s_bfe_u32 s39, s69, 655360
    s_bfe_u32 s66, s68, 655370
    s_add_u32 s44, s42, s66
    s_bfe_u32 s40, s69, 655370
    s_bfe_u32 s66, s68, 655380
    s_add_u32 s45, s42, s66
    s_bfe_u32 s41, s69, 655380
    s_and_b32 s66, s46, s33
    s_cselect_b32 s72, -1, 1
    s_cselect_b32 s76, s47, 163712
    s_cmp_ge_u32 s66, 2
    s_cselect_b32 s73, -1, 0
    s_add_u32 s77, s47, 1024
    s_cmp_ge_u32 s66, 4
    s_cselect_b32 s75, -1, 0
    s_cmp_ge_u32 s66, 3
    s_cselect_b32 s74, -1, 1
    s_cselect_b32 s77, s77, 163712
    v_add_u32 v252, s45, v247
    ds_read2_b32 v[240:241], v252 offset0:0 offset1:16
    v_mfma_f32_32x32x16_bf16 v[32:47], v[72:75], v[180:183], 0
    v_mul_f32 v196, v56, v96
    v_fmac_f32 v196, v57, v97
    v_fmac_f32 v196, v58, v98
    v_fmac_f32 v196, v59, v99
    v_fmac_f32 v196, v60, v100
    v_fmac_f32 v196, v61, v101
    v_mfma_f32_32x32x16_bf16 v[0:15], v[76:79], v[180:183], 0
    v_fmac_f32 v196, v62, v102
    v_fmac_f32 v196, v63, v103
    v_mul_f32 v198, v64, v128
    v_fmac_f32 v198, v65, v129
    v_fmac_f32 v198, v66, v130
    v_fmac_f32 v198, v67, v131
    v_mfma_f32_32x32x16_bf16 v[32:47], v[80:83], v[184:187], v[32:47]
    v_fmac_f32 v198, v68, v132
    v_fmac_f32 v198, v69, v133
    v_fmac_f32 v198, v70, v134
    v_fmac_f32 v198, v71, v135
    v_mul_f32 v200, v16, v128
    v_fmac_f32 v200, v17, v129
    v_mfma_f32_32x32x16_bf16 v[0:15], v[84:87], v[184:187], v[0:15]
    s_waitcnt vmcnt(6)
    ds_read_b64_tr_b16 v[176:177], v244 offset:6144
    ds_read_b64_tr_b16 v[178:179], v244 offset:7168
    ds_read_b64_tr_b16 v[180:181], v245 offset:6144
    ds_read_b64_tr_b16 v[182:183], v245 offset:7168
    v_permlane32_swap_b32 v196, v198
    v_fmac_f32 v200, v18, v130
    v_mfma_f32_32x32x16_bf16 v[32:47], v[88:91], v[188:191], v[32:47]
    v_fmac_f32 v200, v19, v131
    v_fmac_f32 v200, v20, v132
    v_fmac_f32 v200, v21, v133
    v_fmac_f32 v200, v22, v134
    v_fmac_f32 v200, v23, v135
    v_add_f32 v198, v196, v198
    v_mfma_f32_32x32x16_bf16 v[0:15], v[92:95], v[188:191], v[0:15]
    v_mul_f32_e64 v202, v24, -v128
    v_fma_f32 v202, v25, -v129, v202
    v_fma_f32 v202, v26, -v130, v202
    v_fma_f32 v202, v27, -v131, v202
    v_fma_f32 v202, v28, -v132, v202
    v_fma_f32 v202, v29, -v133, v202
    v_fma_f32 v202, v30, -v134, v202
    v_fma_f32 v202, v31, -v135, v202
    s_nop 1
    v_permlane32_swap_b32 v200, v202
    v_add_f32 v202, v200, v202
    s_waitcnt vmcnt(4) lgkmcnt(0)
    v_mfma_f32_32x32x16_bf16 v[56:71], v[72:75], v[176:179], 0
    v_mul_f32 v197, v32, v104
    v_fmac_f32 v197, v33, v105
    v_fmac_f32 v197, v34, v106
    v_fmac_f32 v197, v35, v107
    v_fmac_f32 v197, v36, v108
    v_fmac_f32 v197, v37, v109
    s_add_u32 m0, s21, 6144
    v_mfma_f32_32x32x16_bf16 v[16:31], v[76:79], v[176:179], 0
    buffer_load_dwordx4 v236, s[4:7], s36 offen  lds
    buffer_load_dwordx4 v237, s[8:11], s36 offen offset:1024  lds
    ds_read_b64_tr_b16 v[176:177], v244 offset:0
    ds_read_b64_tr_b16 v[178:179], v244 offset:1024
    ds_read_b64_tr_b16 v[184:185], v245 offset:0
    ds_read_b64_tr_b16 v[186:187], v245 offset:1024
    v_fmac_f32 v197, v38, v110
    v_fmac_f32 v197, v39, v111
    v_mul_f32 v199, v40, v136
    v_fmac_f32 v199, v41, v137
    v_fmac_f32 v199, v42, v138
    v_fmac_f32 v199, v43, v139
    v_fmac_f32 v199, v44, v140
    v_fmac_f32 v199, v45, v141
    v_fmac_f32 v199, v46, v142
    v_fmac_f32 v199, v47, v143
    v_mul_f32 v201, v0, v136
    v_fmac_f32 v201, v1, v137
    v_permlane32_swap_b32 v197, v199
    v_fmac_f32 v201, v2, v138
    v_fmac_f32 v201, v3, v139
    v_fmac_f32 v201, v4, v140
    v_fmac_f32 v201, v5, v141
    v_fmac_f32 v201, v6, v142
    s_waitcnt vmcnt(4) lgkmcnt(0)
    v_mfma_f32_32x32x16_bf16 v[56:71], v[80:83], v[176:179], v[56:71]
    v_fmac_f32 v201, v7, v143
    v_add_f32 v199, v197, v199
    v_mul_f32_e64 v203, v8, -v136
    v_fma_f32 v203, v9, -v137, v203
    v_fma_f32 v203, v10, -v138, v203
    v_fma_f32 v203, v11, -v139, v203
    s_add_u32 m0, s21, 0
    v_mfma_f32_32x32x16_bf16 v[16:31], v[84:87], v[176:179], v[16:31]
    buffer_load_dwordx4 v238, s[4:7], s36 offen  lds
    buffer_load_dwordx4 v239, s[8:11], s36 offen offset:1024  lds
    ds_read_b64_tr_b16 v[176:177], v244 offset:2048
    ds_read_b64_tr_b16 v[178:179], v244 offset:3072
    ds_read_b64_tr_b16 v[188:189], v245 offset:2048
    ds_read_b64_tr_b16 v[190:191], v245 offset:3072
    s_waitcnt lgkmcnt(0)
    v_mfma_f32_32x32x16_bf16 v[56:71], v[88:91], v[176:179], v[56:71]
    v_fma_f32 v203, v12, -v140, v203
    v_fma_f32 v203, v13, -v141, v203
    v_fma_f32 v203, v14, -v142, v203
    v_fma_f32 v203, v15, -v143, v203
    s_nop 1
    v_permlane32_swap_b32 v201, v203
    v_add_f32 v203, v201, v203
    s_add_u32 m0, s21, 2048
    v_mfma_f32_32x32x16_bf16 v[16:31], v[92:95], v[176:179], v[16:31]
    buffer_load_dwordx4 v234, s[4:7], s37 offen  lds
    buffer_load_dwordx4 v235, s[8:11], s37 offen offset:1024  lds
    v_add_u32 v252, s42, v247
    ds_read2_b32 v[234:235], v252 offset0:0 offset1:16
    s_set_gpr_idx_on s51, gpr_idx(DST)
    s_nop 0
    v_cvt_pk_bf16_f32 v204, v198, v199
    v_cvt_pk_bf16_f32 v205, v202, v203
    s_set_gpr_idx_off
    v_mfma_f32_32x32x16_bf16 v[32:47], v[72:75], v[180:183], 0
    v_mul_f32 v196, v56, v144
    v_fmac_f32 v196, v57, v145
    v_fmac_f32 v196, v58, v146
    v_fmac_f32 v196, v59, v147
    v_fmac_f32 v196, v60, v148
    v_fmac_f32 v196, v61, v149
    v_mfma_f32_32x32x16_bf16 v[0:15], v[76:79], v[180:183], 0
    v_fmac_f32 v196, v62, v150
    v_fmac_f32 v196, v63, v151
    v_mul_f32_e64 v200, v16, -v160
    v_fma_f32 v200, v17, -v161, v200
    v_fma_f32 v200, v18, -v162, v200
    v_fma_f32 v200, v19, -v163, v200
    v_mfma_f32_32x32x16_bf16 v[32:47], v[80:83], v[184:187], v[32:47]
    v_fma_f32 v200, v20, -v164, v200
    v_fma_f32 v200, v21, -v165, v200
    v_fma_f32 v200, v22, -v166, v200
    v_fma_f32 v200, v23, -v167, v200
    v_mul_f32_e64 v202, v24, -v160
    v_fma_f32 v202, v25, -v161, v202
    v_mfma_f32_32x32x16_bf16 v[0:15], v[84:87], v[184:187], v[0:15]
    s_waitcnt vmcnt(6)
    ds_read_b64_tr_b16 v[176:177], v244 offset:4096
    ds_read_b64_tr_b16 v[178:179], v244 offset:5120
    ds_read_b64_tr_b16 v[180:181], v245 offset:4096
    ds_read_b64_tr_b16 v[182:183], v245 offset:5120
    v_fma_f32 v202, v26, -v162, v202
    v_fma_f32 v202, v27, -v163, v202
    v_mfma_f32_32x32x16_bf16 v[32:47], v[88:91], v[188:191], v[32:47]
    v_fma_f32 v202, v28, -v164, v202
    v_fma_f32 v202, v29, -v165, v202
    v_fma_f32 v202, v30, -v166, v202
    v_fma_f32 v202, v31, -v167, v202
    v_mfma_f32_32x32x16_bf16 v[0:15], v[92:95], v[188:191], v[0:15]
    s_waitcnt vmcnt(4) lgkmcnt(0)
    v_mfma_f32_32x32x16_bf16 v[16:31], v[72:75], v[176:179], 0
    s_nop 4
    v_mul_f32 v197, v32, v152
    v_fmac_f32 v197, v33, v153
    v_fmac_f32 v197, v34, v154
    v_fmac_f32 v197, v35, v155
    v_fmac_f32 v197, v36, v156
    v_fmac_f32 v197, v37, v157
    s_add_u32 m0, s21, 4096
    v_mfma_f32_32x32x16_bf16 v[48:63], v[76:79], v[176:179], 0
    buffer_load_dwordx4 v236, s[4:7], s37 offen  lds
    buffer_load_dwordx4 v237, s[8:11], s37 offen offset:1024  lds
    ds_read_b64_tr_b16 v[176:177], v244 offset:6144
    ds_read_b64_tr_b16 v[178:179], v244 offset:7168
    ds_read_b64_tr_b16 v[184:185], v245 offset:6144
    ds_read_b64_tr_b16 v[186:187], v245 offset:7168
    v_add_u32 v252, s43, v247
    ds_read2_b32 v[236:237], v252 offset0:0 offset1:16
    v_fmac_f32 v197, v38, v158
    v_fmac_f32 v197, v39, v159
    v_mul_f32_e64 v201, v0, -v168
    v_fma_f32 v201, v1, -v169, v201
    s_waitcnt vmcnt(4) lgkmcnt(1)
    v_mfma_f32_32x32x16_bf16 v[16:31], v[80:83], v[176:179], v[16:31]
    v_fma_f32 v201, v2, -v170, v201
    v_fma_f32 v201, v3, -v171, v201
    v_fma_f32 v201, v4, -v172, v201
    v_fma_f32 v201, v5, -v173, v201
    v_fma_f32 v201, v6, -v174, v201
    v_fma_f32 v201, v7, -v175, v201
    s_add_u32 m0, s21, 6144
    v_mfma_f32_32x32x16_bf16 v[48:63], v[84:87], v[176:179], v[48:63]
    buffer_load_dwordx4 v238, s[4:7], s37 offen  lds
    buffer_load_dwordx4 v239, s[8:11], s37 offen offset:1024  lds
    ds_read_b64_tr_b16 v[176:177], v244 offset:0
    ds_read_b64_tr_b16 v[178:179], v244 offset:1024
    ds_read_b64_tr_b16 v[188:189], v245 offset:0
    ds_read_b64_tr_b16 v[190:191], v245 offset:1024
    v_add_u32 v252, s44, v247
    ds_read2_b32 v[238:239], v252 offset0:0 offset1:16
    s_waitcnt lgkmcnt(1)
    v_mfma_f32_32x32x16_bf16 v[16:31], v[88:91], v[176:179], v[16:31]
    v_mul_f32_e64 v203, v8, -v168
    v_fma_f32 v203, v9, -v169, v203
    v_fma_f32 v203, v10, -v170, v203
    v_fma_f32 v203, v11, -v171, v203
    v_fma_f32 v203, v12, -v172, v203
    v_fma_f32 v203, v13, -v173, v203
    s_add_u32 m0, s21, 0
    v_mfma_f32_32x32x16_bf16 v[48:63], v[92:95], v[176:179], v[48:63]
    v_mad_u32_u16 v234, v234, s3, v246 op_sel:[1,0,0,0]
    v_mad_u32_u16 v235, v235, s3, v246 op_sel:[1,0,0,0]
    buffer_load_dwordx4 v234, s[4:7], s38 offen  lds
    buffer_load_dwordx4 v235, s[8:11], s38 offen offset:1024  lds
    v_fma_f32 v203, v14, -v174, v203
    v_fma_f32 v203, v15, -v175, v203
    v_mfma_f32_32x32x16_bf16 v[0:15], v[72:75], v[180:183], 0
    v_fmac_f32 v200, v24, v160
    v_fmac_f32 v200, v25, v161
    v_fmac_f32 v200, v26, v162
    v_fmac_f32 v200, v27, v163
    v_fmac_f32 v200, v28, v164
    v_fmac_f32 v200, v29, v165
    v_fmac_f32 v200, v30, v166
    v_fmac_f32 v200, v31, v167
    v_mfma_f32_32x32x16_bf16 v[24:39], v[76:79], v[180:183], 0
    v_add_u32 v253, s47, v248
    ds_read_b32 v192, v253
    ds_read_b32 v193, v253 offset:256
    v_mul_f32 v254, v16, v144
    v_fmac_f32 v254, v17, v145
    v_fmac_f32 v254, v18, v146
    v_mfma_f32_32x32x16_bf16 v[0:15], v[80:83], v[184:187], v[0:15]
    v_fmac_f32 v254, v19, v147
    v_fmac_f32 v254, v20, v148
    v_fmac_f32 v254, v21, v149
    v_fmac_f32 v254, v22, v150
    v_fmac_f32 v254, v23, v151
    v_sub_f32_e64 v64, -v48, v64
    v_mfma_f32_32x32x16_bf16 v[24:39], v[84:87], v[184:187], v[24:39]
    s_waitcnt vmcnt(6)
    ds_read_b64_tr_b16 v[176:177], v244 offset:2048
    ds_read_b64_tr_b16 v[178:179], v244 offset:3072
    ds_read_b64_tr_b16 v[180:181], v245 offset:2048
    ds_read_b64_tr_b16 v[182:183], v245 offset:3072
    v_sub_f32_e64 v65, -v49, v65
    v_permlane32_swap_b32 v196, v254
    v_mfma_f32_32x32x16_bf16 v[24:39], v[92:95], v[188:191], v[24:39]
    v_sub_f32_e64 v66, -v50, v66
    v_sub_f32_e64 v67, -v51, v67
    v_sub_f32_e64 v68, -v52, v68
    v_sub_f32_e64 v69, -v53, v69
    v_sub_f32_e64 v70, -v54, v70
    v_sub_f32_e64 v71, -v55, v71
    v_mfma_f32_32x32x16_bf16 v[0:15], v[88:91], v[188:191], v[0:15]
    v_add_f32 v254, v196, v254
    s_waitcnt vmcnt(4) lgkmcnt(0)
    v_mfma_f32_32x32x16_bf16 v[56:71], v[76:79], v[176:179], v[56:71]
    s_nop 1
    v_sub_f32_e64 v40, -v24, v40
    v_sub_f32_e64 v41, -v25, v41
    v_sub_f32_e64 v42, -v26, v42
    v_sub_f32_e64 v43, -v27, v43
    v_sub_f32_e64 v44, -v28, v44
    v_sub_f32_e64 v45, -v29, v45
    v_sub_f32_e64 v46, -v30, v46
    v_sub_f32_e64 v47, -v31, v47
    s_mov_b32 m0, s76
    s_mov_b64 exec, s[72:73]
    buffer_load_dwordx4 v192, s[12:15], 0 offen  lds
    s_mov_b32 m0, s77
    s_mov_b64 exec, s[74:75]
    buffer_load_dwordx4 v193, s[12:15], 0 offen  lds
    s_mov_b64 exec, -1
    s_add_u32 m0, s21, 2048
    v_mfma_f32_32x32x16_bf16 v[16:31], v[72:75], v[176:179], 0
    v_mad_u32_u16 v236, v236, s3, v246 op_sel:[1,0,0,0]
    v_mad_u32_u16 v237, v237, s3, v246 op_sel:[1,0,0,0]
    buffer_load_dwordx4 v236, s[4:7], s39 offen  lds
    buffer_load_dwordx4 v237, s[8:11], s39 offen offset:1024  lds
    ds_read_b64_tr_b16 v[176:177], v244 offset:4096
    ds_read_b64_tr_b16 v[178:179], v244 offset:5120
    ds_read_b64_tr_b16 v[184:185], v245 offset:4096
    ds_read_b64_tr_b16 v[186:187], v245 offset:5120
    v_mul_f32 v255, v0, v152
    v_fmac_f32 v255, v1, v153
    v_fmac_f32 v255, v2, v154
    v_fmac_f32 v255, v3, v155
    v_fmac_f32 v255, v4, v156
    s_waitcnt vmcnt(6) lgkmcnt(0)
    v_mfma_f32_32x32x16_bf16 v[16:31], v[80:83], v[176:179], v[16:31]
    v_fmac_f32 v255, v5, v157
    v_fmac_f32 v255, v6, v158
    v_fmac_f32 v255, v7, v159
    v_fmac_f32 v201, v8, v168
    v_fmac_f32 v201, v9, v169
    v_permlane32_swap_b32 v197, v255
    s_add_u32 m0, s21, 4096
    v_mfma_f32_32x32x16_bf16 v[56:71], v[84:87], v[176:179], v[56:71]
    v_mad_u32_u16 v238, v238, s3, v246 op_sel:[1,0,0,0]
    v_mad_u32_u16 v239, v239, s3, v246 op_sel:[1,0,0,0]
    buffer_load_dwordx4 v238, s[4:7], s40 offen  lds
    buffer_load_dwordx4 v239, s[8:11], s40 offen offset:1024  lds
    ds_read_b64_tr_b16 v[176:177], v244 offset:6144
    ds_read_b64_tr_b16 v[178:179], v244 offset:7168
    ds_read_b64_tr_b16 v[188:189], v245 offset:6144
    ds_read_b64_tr_b16 v[190:191], v245 offset:7168
    s_waitcnt lgkmcnt(0)
    v_mfma_f32_32x32x16_bf16 v[16:31], v[88:91], v[176:179], v[16:31]
    v_fmac_f32 v201, v10, v170
    v_fmac_f32 v201, v11, v171
    v_fmac_f32 v201, v12, v172
    v_fmac_f32 v201, v13, v173
    v_fmac_f32 v201, v14, v174
    v_fmac_f32 v201, v15, v175
    s_add_u32 m0, s21, 6144
    v_mfma_f32_32x32x16_bf16 v[56:71], v[92:95], v[176:179], v[56:71]
    v_mad_u32_u16 v240, v240, s3, v246 op_sel:[1,0,0,0]
    v_mad_u32_u16 v241, v241, s3, v246 op_sel:[1,0,0,0]
    buffer_load_dwordx4 v240, s[4:7], s41 offen  lds
    buffer_load_dwordx4 v241, s[8:11], s41 offen offset:1024  lds
    v_add_f32 v255, v197, v255
    s_set_gpr_idx_on s51, gpr_idx(DST)
    s_nop 0
    v_cvt_pk_bf16_f32 v206, v254, v255
    s_set_gpr_idx_off
    v_mfma_f32_32x32x16_bf16 v[0:15], v[72:75], v[180:183], 0
    v_mul_f32 v254, v16, v144
    v_fmac_f32 v254, v17, v145
    v_fmac_f32 v254, v18, v146
    v_fmac_f32 v254, v19, v147
    v_fmac_f32 v254, v20, v148
    v_fmac_f32 v254, v21, v149
    v_mfma_f32_32x32x16_bf16 v[32:47], v[76:79], v[180:183], v[32:47]
    v_fmac_f32 v254, v22, v150
    v_fmac_f32 v254, v23, v151
    v_fma_f32 v202, v24, -v160, v202
    v_fma_f32 v202, v25, -v161, v202
    v_permlane32_swap_b32 v254, v200
    v_fma_f32 v202, v26, -v162, v202
    v_mfma_f32_32x32x16_bf16 v[0:15], v[80:83], v[184:187], v[0:15]
    v_fma_f32 v202, v27, -v163, v202
    v_fma_f32 v202, v28, -v164, v202
    v_fma_f32 v202, v29, -v165, v202
    v_fma_f32 v202, v30, -v166, v202
    v_fma_f32 v202, v31, -v167, v202
    v_add_f32 v200, v254, v200
    v_mfma_f32_32x32x16_bf16 v[32:47], v[84:87], v[184:187], v[32:47]
    s_waitcnt vmcnt(8)
    ds_read_b64_tr_b16 v[176:177], v244 offset:0
    ds_read_b64_tr_b16 v[178:179], v244 offset:1024
    ds_read_b64_tr_b16 v[180:181], v245 offset:0
    ds_read_b64_tr_b16 v[182:183], v245 offset:1024
    v_mul_f32_e64 v198, v64, -v112
    v_permlane32_swap_b32 v202, v254
    v_mfma_f32_32x32x16_bf16 v[0:15], v[88:91], v[188:191], v[0:15]
    v_fma_f32 v198, v65, -v113, v198
    v_fma_f32 v198, v66, -v114, v198
    v_fma_f32 v198, v67, -v115, v198
    v_fma_f32 v198, v68, -v116, v198
    v_fma_f32 v198, v69, -v117, v198
    v_fma_f32 v198, v70, -v118, v198
    v_mfma_f32_32x32x16_bf16 v[32:47], v[92:95], v[188:191], v[32:47]
    v_add_u32 v249, s48, v249
    v_add_u32 v250, s49, v250
    v_fma_f32 v198, v71, -v119, v198
    v_add_f32 v254, v202, v254
    v_mul_f32 v196, v56, v160
    v_fmac_f32 v196, v57, v161
    v_fmac_f32 v196, v58, v162
    v_fmac_f32 v196, v59, v163
    v_fmac_f32 v196, v60, v164
    v_fmac_f32 v196, v61, v165
    v_fmac_f32 v196, v62, v166
    v_fmac_f32 v196, v63, v167
    s_nop 1
    v_permlane32_swap_b32 v198, v196
    v_add_f32 v196, v198, v196
    v_mul_f32 v255, v0, v152
    v_fmac_f32 v255, v1, v153
    v_fmac_f32 v255, v2, v154
    v_fmac_f32 v255, v3, v155
    v_fmac_f32 v255, v4, v156
    v_fmac_f32 v255, v5, v157
    v_fmac_f32 v255, v6, v158
    v_fmac_f32 v255, v7, v159
    v_fma_f32 v203, v8, -v168, v203
    v_fma_f32 v203, v9, -v169, v203
    v_permlane32_swap_b32 v255, v201
    v_fma_f32 v203, v10, -v170, v203
    v_fma_f32 v203, v11, -v171, v203
    v_fma_f32 v203, v12, -v172, v203
    v_fma_f32 v203, v13, -v173, v203
    v_fma_f32 v203, v14, -v174, v203
    v_fma_f32 v203, v15, -v175, v203
    v_add_f32 v201, v255, v201
    v_mul_f32_e64 v199, v40, -v120
    v_permlane32_swap_b32 v203, v255
    v_fma_f32 v199, v41, -v121, v199
    v_fma_f32 v199, v42, -v122, v199
    v_fma_f32 v199, v43, -v123, v199
    s_waitcnt vmcnt(6)
    ds_read_b64_tr_b16 v[72:73], v249 offset:0
    ds_read_b64_tr_b16 v[76:77], v249 offset:64
    ds_read_b64_tr_b16 v[74:75], v249 offset:256
    ds_read_b64_tr_b16 v[78:79], v249 offset:320
    s_mov_b64 exec, s[54:55]
    ds_read_u16_d16_hi v242, v250 offset:0
    s_mov_b64 exec, -1
    v_fma_f32 v199, v44, -v124, v199
    v_fma_f32 v199, v45, -v125, v199
    v_fma_f32 v199, v46, -v126, v199
    v_fma_f32 v199, v47, -v127, v199
    v_add_f32 v255, v203, v255
    v_mul_f32 v197, v32, v168
    v_fmac_f32 v197, v33, v169
    v_fmac_f32 v197, v34, v170
    v_fmac_f32 v197, v35, v171
    v_fmac_f32 v197, v36, v172
    v_fmac_f32 v197, v37, v173
    v_fmac_f32 v197, v38, v174
    v_fmac_f32 v197, v39, v175
    s_nop 1
    v_permlane32_swap_b32 v199, v197
    v_add_f32 v197, v199, v197
    s_set_gpr_idx_on s51, gpr_idx(DST)
    s_nop 0
    v_cvt_pk_bf16_f32 v207, v200, v201
    v_cvt_pk_bf16_f32 v209, v254, v255
    v_cvt_pk_bf16_f32 v208, v196, v197
    s_set_gpr_idx_off
    s_add_u32 s50, s50, 1
    s_add_u32 s51, s51, 6
    s_cmp_ge_u32 s50, 4
    s_cbranch_scc1 LAST0
    s_add_u32 s53, s53, 4
    s_xor_b32 s66, s53, s20
    s_bitcmp1_b32 s66, 2
    s_setprio 1
    s_cbranch_scc1 PRIO_8
    s_setprio 0
PRIO_8:
    s_cmp_eq_u32 s52, 4
    s_cbranch_scc1 ITEM_0_4
    s_cmp_eq_u32 s52, 5
    s_cbranch_scc1 ITEM_0_5
    s_cmp_eq_u32 s52, 3
    s_cbranch_scc1 ITEM_0_3
    s_cmp_eq_u32 s52, 6
    s_cbranch_scc1 ITEM_0_6
    s_cmp_eq_u32 s52, 8
    s_cbranch_scc1 ITEM_0_8
    s_branch ITEM_0_2
.p2align 6
ITEM_0_8:
    s_mov_b64 exec, s[54:55]
    ds_read_u16_d16_hi v243, v250 offset:128
    s_mov_b64 exec, -1
    ds_read_b64_tr_b16 v[80:81], v249 offset:512
    ds_read_b64_tr_b16 v[84:85], v249 offset:576
    ds_read_b64_tr_b16 v[82:83], v249 offset:768
    ds_read_b64_tr_b16 v[86:87], v249 offset:832
    ds_read_b64_tr_b16 v[88:89], v249 offset:1024
    ds_read_b64_tr_b16 v[92:93], v249 offset:1088
    ds_read_b64_tr_b16 v[90:91], v249 offset:1280
    ds_read_b64_tr_b16 v[94:95], v249 offset:1344
    ds_read_b64_tr_b16 v[64:65], v249 offset:1536
    ds_read_b64_tr_b16 v[68:69], v249 offset:1600
    ds_read_b64_tr_b16 v[66:67], v249 offset:1792
    ds_read_b64_tr_b16 v[70:71], v249 offset:1856
    s_waitcnt lgkmcnt(13)
    v_mul_f32_dpp v196, v242, v72 row_newbcast:0 row_mask:0xf bank_mask:0xf
    v_mul_f32_dpp v197, v242, v73 row_newbcast:1 row_mask:0xf bank_mask:0xf
    v_mul_f32_dpp v198, v242, v72 row_newbcast:8 row_mask:0xf bank_mask:0xf
    v_mul_f32_dpp v199, v242, v73 row_newbcast:9 row_mask:0xf bank_mask:0xf
    v_mul_f32_dpp v200, v242, v76 row_newbcast:2 row_mask:0xf bank_mask:0xf
    v_mul_f32_dpp v201, v242, v77 row_newbcast:3 row_mask:0xf bank_mask:0xf
    v_mul_f32_dpp v202, v242, v76 row_newbcast:10 row_mask:0xf bank_mask:0xf
    v_mul_f32_dpp v203, v242, v77 row_newbcast:11 row_mask:0xf bank_mask:0xf
    v_cvt_pk_bf16_f32 v72, v196, v197
    v_cvt_pk_bf16_f32 v76, v198, v199
    v_cvt_pk_bf16_f32 v73, v200, v201
    v_cvt_pk_bf16_f32 v77, v202, v203
    v_mul_f32_dpp v196, v242, v74 row_newbcast:4 row_mask:0xf bank_mask:0xf
    v_mul_f32_dpp v197, v242, v75 row_newbcast:5 row_mask:0xf bank_mask:0xf
    v_mul_f32_dpp v198, v242, v74 row_newbcast:12 row_mask:0xf bank_mask:0xf
    v_mul_f32_dpp v199, v242, v75 row_newbcast:13 row_mask:0xf bank_mask:0xf
    v_mul_f32_dpp v200, v242, v78 row_newbcast:6 row_mask:0xf bank_mask:0xf
    v_mul_f32_dpp v201, v242, v79 row_newbcast:7 row_mask:0xf bank_mask:0xf
    v_mul_f32_dpp v202, v242, v78 row_newbcast:14 row_mask:0xf bank_mask:0xf
    v_mul_f32_dpp v203, v242, v79 row_newbcast:15 row_mask:0xf bank_mask:0xf
    v_cvt_pk_bf16_f32 v74, v196, v197
    v_cvt_pk_bf16_f32 v78, v198, v199
    v_cvt_pk_bf16_f32 v75, v200, v201
    v_cvt_pk_bf16_f32 v79, v202, v203
    s_mov_b64 exec, s[54:55]
    ds_read_u16_d16_hi v242, v250 offset:256
    s_mov_b64 exec, -1
    s_waitcnt vmcnt(4) lgkmcnt(9)
    v_mfma_f32_32x32x16_bf16 v[0:15], v[72:75], v[176:179], 0
    v_mul_f32_dpp v196, v243, v80 row_newbcast:0 row_mask:0xf bank_mask:0xf
    v_mul_f32_dpp v197, v243, v81 row_newbcast:1 row_mask:0xf bank_mask:0xf
    v_mul_f32_dpp v198, v243, v80 row_newbcast:8 row_mask:0xf bank_mask:0xf
    v_mul_f32_dpp v199, v243, v81 row_newbcast:9 row_mask:0xf bank_mask:0xf
    v_mul_f32_dpp v200, v243, v84 row_newbcast:2 row_mask:0xf bank_mask:0xf
    v_mul_f32_dpp v201, v243, v85 row_newbcast:3 row_mask:0xf bank_mask:0xf
    s_add_u32 m0, s21, 0
    v_mfma_f32_32x32x16_bf16 v[48:63], v[76:79], v[176:179], 0
    buffer_load_dwordx4 v234, s[4:7], s35 offen  lds
    buffer_load_dwordx4 v235, s[8:11], s35 offen offset:1024  lds
    ds_read_b64_tr_b16 v[176:177], v244 offset:2048
    ds_read_b64_tr_b16 v[178:179], v244 offset:3072
    ds_read_b64_tr_b16 v[184:185], v245 offset:2048
    ds_read_b64_tr_b16 v[186:187], v245 offset:3072
    v_mul_f32_dpp v202, v243, v84 row_newbcast:10 row_mask:0xf bank_mask:0xf
    v_mul_f32_dpp v203, v243, v85 row_newbcast:11 row_mask:0xf bank_mask:0xf
    v_cvt_pk_bf16_f32 v80, v196, v197
    v_cvt_pk_bf16_f32 v84, v198, v199
    v_cvt_pk_bf16_f32 v81, v200, v201
    v_cvt_pk_bf16_f32 v85, v202, v203
    v_mul_f32_dpp v196, v243, v82 row_newbcast:4 row_mask:0xf bank_mask:0xf
    v_mul_f32_dpp v197, v243, v83 row_newbcast:5 row_mask:0xf bank_mask:0xf
    v_mul_f32_dpp v198, v243, v82 row_newbcast:12 row_mask:0xf bank_mask:0xf
    v_mul_f32_dpp v199, v243, v83 row_newbcast:13 row_mask:0xf bank_mask:0xf
    v_mul_f32_dpp v200, v243, v86 row_newbcast:6 row_mask:0xf bank_mask:0xf
    v_mul_f32_dpp v201, v243, v87 row_newbcast:7 row_mask:0xf bank_mask:0xf
    v_mul_f32_dpp v202, v243, v86 row_newbcast:14 row_mask:0xf bank_mask:0xf
    v_mul_f32_dpp v203, v243, v87 row_newbcast:15 row_mask:0xf bank_mask:0xf
    v_cvt_pk_bf16_f32 v82, v196, v197
    v_cvt_pk_bf16_f32 v86, v198, v199
    v_cvt_pk_bf16_f32 v83, v200, v201
    v_cvt_pk_bf16_f32 v87, v202, v203
    s_mov_b64 exec, s[54:55]
    ds_read_u16_d16_hi v243, v250 offset:384
    s_mov_b64 exec, -1
    s_waitcnt vmcnt(4) lgkmcnt(1)
    v_mfma_f32_32x32x16_bf16 v[0:15], v[80:83], v[176:179], v[0:15]
    v_mul_f32_dpp v196, v242, v88 row_newbcast:0 row_mask:0xf bank_mask:0xf
    v_mul_f32_dpp v197, v242, v89 row_newbcast:1 row_mask:0xf bank_mask:0xf
    v_mul_f32_dpp v198, v242, v88 row_newbcast:8 row_mask:0xf bank_mask:0xf
    v_mul_f32_dpp v199, v242, v89 row_newbcast:9 row_mask:0xf bank_mask:0xf
    v_mul_f32_dpp v200, v242, v92 row_newbcast:2 row_mask:0xf bank_mask:0xf
    v_mul_f32_dpp v201, v242, v93 row_newbcast:3 row_mask:0xf bank_mask:0xf
    s_add_u32 m0, s21, 2048
    v_mfma_f32_32x32x16_bf16 v[48:63], v[84:87], v[176:179], v[48:63]
    buffer_load_dwordx4 v236, s[4:7], s35 offen  lds
    buffer_load_dwordx4 v237, s[8:11], s35 offen offset:1024  lds
    ds_read_b64_tr_b16 v[176:177], v244 offset:4096
    ds_read_b64_tr_b16 v[178:179], v244 offset:5120
    ds_read_b64_tr_b16 v[188:189], v245 offset:4096
    ds_read_b64_tr_b16 v[190:191], v245 offset:5120
    v_mul_f32_dpp v202, v242, v92 row_newbcast:10 row_mask:0xf bank_mask:0xf
    v_mul_f32_dpp v203, v242, v93 row_newbcast:11 row_mask:0xf bank_mask:0xf
    v_cvt_pk_bf16_f32 v88, v196, v197
    v_cvt_pk_bf16_f32 v92, v198, v199
    v_cvt_pk_bf16_f32 v89, v200, v201
    v_cvt_pk_bf16_f32 v93, v202, v203
    v_mul_f32_dpp v196, v242, v90 row_newbcast:4 row_mask:0xf bank_mask:0xf
    v_mul_f32_dpp v197, v242, v91 row_newbcast:5 row_mask:0xf bank_mask:0xf
    v_mul_f32_dpp v198, v242, v90 row_newbcast:12 row_mask:0xf bank_mask:0xf
    v_mul_f32_dpp v199, v242, v91 row_newbcast:13 row_mask:0xf bank_mask:0xf
    v_mul_f32_dpp v200, v242, v94 row_newbcast:6 row_mask:0xf bank_mask:0xf
    v_mul_f32_dpp v201, v242, v95 row_newbcast:7 row_mask:0xf bank_mask:0xf
    v_mul_f32_dpp v202, v242, v94 row_newbcast:14 row_mask:0xf bank_mask:0xf
    v_mul_f32_dpp v203, v242, v95 row_newbcast:15 row_mask:0xf bank_mask:0xf
    v_cvt_pk_bf16_f32 v90, v196, v197
    v_cvt_pk_bf16_f32 v94, v198, v199
    v_cvt_pk_bf16_f32 v91, v200, v201
    v_cvt_pk_bf16_f32 v95, v202, v203
    s_waitcnt vmcnt(4) lgkmcnt(0)
    v_mfma_f32_32x32x16_bf16 v[0:15], v[88:91], v[176:179], v[0:15]
    v_mul_f32_dpp v196, v243, v64 row_newbcast:0 row_mask:0xf bank_mask:0xf
    v_mul_f32_dpp v197, v243, v65 row_newbcast:1 row_mask:0xf bank_mask:0xf
    v_mul_f32_dpp v198, v243, v64 row_newbcast:8 row_mask:0xf bank_mask:0xf
    v_mul_f32_dpp v199, v243, v65 row_newbcast:9 row_mask:0xf bank_mask:0xf
    v_mul_f32_dpp v200, v243, v68 row_newbcast:2 row_mask:0xf bank_mask:0xf
    v_mul_f32_dpp v201, v243, v69 row_newbcast:3 row_mask:0xf bank_mask:0xf
    s_add_u32 m0, s21, 4096
    v_mfma_f32_32x32x16_bf16 v[48:63], v[92:95], v[176:179], v[48:63]
    buffer_load_dwordx4 v238, s[4:7], s35 offen  lds
    buffer_load_dwordx4 v239, s[8:11], s35 offen offset:1024  lds
    ds_read_b64_tr_b16 v[176:177], v244 offset:6144
    ds_read_b64_tr_b16 v[178:179], v244 offset:7168
    ds_read_b64_tr_b16 v[192:193], v245 offset:6144
    ds_read_b64_tr_b16 v[194:195], v245 offset:7168
    v_mul_f32_dpp v202, v243, v68 row_newbcast:10 row_mask:0xf bank_mask:0xf
    v_mul_f32_dpp v203, v243, v69 row_newbcast:11 row_mask:0xf bank_mask:0xf
    v_cvt_pk_bf16_f32 v64, v196, v197
    v_cvt_pk_bf16_f32 v68, v198, v199
    v_cvt_pk_bf16_f32 v65, v200, v201
    v_cvt_pk_bf16_f32 v69, v202, v203
    v_mul_f32_dpp v196, v243, v66 row_newbcast:4 row_mask:0xf bank_mask:0xf
    v_mul_f32_dpp v197, v243, v67 row_newbcast:5 row_mask:0xf bank_mask:0xf
    v_mul_f32_dpp v198, v243, v66 row_newbcast:12 row_mask:0xf bank_mask:0xf
    v_mul_f32_dpp v199, v243, v67 row_newbcast:13 row_mask:0xf bank_mask:0xf
    v_mul_f32_dpp v200, v243, v70 row_newbcast:6 row_mask:0xf bank_mask:0xf
    v_mul_f32_dpp v201, v243, v71 row_newbcast:7 row_mask:0xf bank_mask:0xf
    v_mul_f32_dpp v202, v243, v70 row_newbcast:14 row_mask:0xf bank_mask:0xf
    v_mul_f32_dpp v203, v243, v71 row_newbcast:15 row_mask:0xf bank_mask:0xf
    v_cvt_pk_bf16_f32 v66, v196, v197
    v_cvt_pk_bf16_f32 v70, v198, v199
    v_cvt_pk_bf16_f32 v67, v200, v201
    v_cvt_pk_bf16_f32 v71, v202, v203
    s_waitcnt lgkmcnt(0)
    v_mfma_f32_32x32x16_bf16 v[0:15], v[64:67], v[176:179], v[0:15]
    s_add_u32 m0, s21, 6144
    v_mfma_f32_32x32x16_bf16 v[48:63], v[68:71], v[176:179], v[48:63]
    buffer_load_dwordx4 v240, s[4:7], s35 offen  lds
    buffer_load_dwordx4 v241, s[8:11], s35 offen offset:1024  lds
    s_mov_b32 m0, s50
    s_nop 0
    s_movrels_b32 s71, s23
    s_bfe_u32 s46, s71, 0x30012
    s_mov_b32 m0, s46
    s_and_b32 s66, s71, 0x3ffff
    s_movrels_b32 s68, s57
    s_movrels_b32 s69, s61
    s_sub_u32 s48, s66, s47
    s_mov_b32 s47, s66
    s_lshr_b32 s52, s71, 28
    s_lshl_b32 s67, s46, 9
    s_add_u32 s66, s66, s67
    s_sub_u32 s49, s66, s42
    s_mov_b32 s42, s66
    s_bfe_u32 s66, s68, 655360
    s_add_u32 s43, s42, s66
    s_bfe_u32 s39, s69, 655360
    s_bfe_u32 s66, s68, 655370
    s_add_u32 s44, s42, s66
    s_bfe_u32 s40, s69, 655370
    s_bfe_u32 s66, s68, 655380
    s_add_u32 s45, s42, s66
    s_bfe_u32 s41, s69, 655380
    s_and_b32 s66, s46, s33
    s_cselect_b32 s72, -1, 1
    s_cselect_b32 s76, s47, 163712
    s_cmp_ge_u32 s66, 2
    s_cselect_b32 s73, -1, 0
    s_add_u32 s77, s47, 1024
    s_cmp_ge_u32 s66, 4
    s_cselect_b32 s75, -1, 0
    s_cmp_ge_u32 s66, 3
    s_cselect_b32 s74, -1, 1
    s_cselect_b32 s77, s77, 163712
    v_mfma_f32_32x32x16_bf16 v[16:31], v[72:75], v[180:183], 0
    v_mul_f32 v196, v0, v96
    v_fmac_f32 v196, v1, v97
    v_fmac_f32 v196, v2, v98
    v_fmac_f32 v196, v3, v99
    v_fmac_f32 v196, v4, v100
    v_fmac_f32 v196, v5, v101
    v_mfma_f32_32x32x16_bf16 v[32:47], v[76:79], v[180:183], 0
    v_fmac_f32 v196, v6, v102
    v_fmac_f32 v196, v7, v103
    v_mul_f32 v198, v8, v128
    v_fmac_f32 v198, v9, v129
    v_fmac_f32 v198, v10, v130
    v_fmac_f32 v198, v11, v131
    v_mfma_f32_32x32x16_bf16 v[16:31], v[80:83], v[184:187], v[16:31]
    v_fmac_f32 v198, v12, v132
    v_fmac_f32 v198, v13, v133
    v_fmac_f32 v198, v14, v134
    v_fmac_f32 v198, v15, v135
    v_mul_f32 v200, v48, v128
    v_fmac_f32 v200, v49, v129
    v_mfma_f32_32x32x16_bf16 v[32:47], v[84:87], v[184:187], v[32:47]
    v_permlane32_swap_b32 v196, v198
    v_fmac_f32 v200, v50, v130
    v_fmac_f32 v200, v51, v131
    v_fmac_f32 v200, v52, v132
    v_fmac_f32 v200, v53, v133
    v_fmac_f32 v200, v54, v134
    v_mfma_f32_32x32x16_bf16 v[16:31], v[88:91], v[188:191], v[16:31]
    v_fmac_f32 v200, v55, v135
    v_add_f32 v198, v196, v198
    v_mul_f32_e64 v202, v56, -v128
    v_fma_f32 v202, v57, -v129, v202
    v_fma_f32 v202, v58, -v130, v202
    v_fma_f32 v202, v59, -v131, v202
    v_mfma_f32_32x32x16_bf16 v[32:47], v[92:95], v[188:191], v[32:47]
    s_waitcnt vmcnt(6)
    ds_read_b64_tr_b16 v[176:177], v244 offset:0
    ds_read_b64_tr_b16 v[178:179], v244 offset:1024
    ds_read_b64_tr_b16 v[180:181], v245 offset:0
    ds_read_b64_tr_b16 v[182:183], v245 offset:1024
    v_fma_f32 v202, v60, -v132, v202
    v_fma_f32 v202, v61, -v133, v202
    v_mfma_f32_32x32x16_bf16 v[16:31], v[64:67], v[192:195], v[16:31]
    v_fma_f32 v202, v62, -v134, v202
    v_fma_f32 v202, v63, -v135, v202
    s_nop 1
    v_permlane32_swap_b32 v200, v202
    v_add_f32 v202, v200, v202
    v_mfma_f32_32x32x16_bf16 v[32:47], v[68:71], v[192:195], v[32:47]
    s_waitcnt vmcnt(4) lgkmcnt(0)
    v_mfma_f32_32x32x16_bf16 v[0:15], v[72:75], v[176:179], 0
    s_nop 2
    v_mul_f32 v197, v16, v104
    v_fmac_f32 v197, v17, v105
    v_fmac_f32 v197, v18, v106
    v_fmac_f32 v197, v19, v107
    v_fmac_f32 v197, v20, v108
    v_fmac_f32 v197, v21, v109
    s_add_u32 m0, s21, 0
    v_mfma_f32_32x32x16_bf16 v[48:63], v[76:79], v[176:179], 0
    buffer_load_dwordx4 v234, s[4:7], s36 offen  lds
    buffer_load_dwordx4 v235, s[8:11], s36 offen offset:1024  lds
    ds_read_b64_tr_b16 v[176:177], v244 offset:2048
    ds_read_b64_tr_b16 v[178:179], v244 offset:3072
    ds_read_b64_tr_b16 v[184:185], v245 offset:2048
    ds_read_b64_tr_b16 v[186:187], v245 offset:3072
    v_fmac_f32 v197, v22, v110
    v_fmac_f32 v197, v23, v111
    v_mul_f32 v199, v24, v136
    v_fmac_f32 v199, v25, v137
    v_fmac_f32 v199, v26, v138
    v_fmac_f32 v199, v27, v139
    v_fmac_f32 v199, v28, v140
    v_fmac_f32 v199, v29, v141
    v_fmac_f32 v199, v30, v142
    v_fmac_f32 v199, v31, v143
    s_waitcnt vmcnt(4) lgkmcnt(0)
    v_mfma_f32_32x32x16_bf16 v[0:15], v[80:83], v[176:179], v[0:15]
    v_mul_f32 v201, v32, v136
    v_fmac_f32 v201, v33, v137
    v_permlane32_swap_b32 v197, v199
    v_fmac_f32 v201, v34, v138
    v_fmac_f32 v201, v35, v139
    v_fmac_f32 v201, v36, v140
    s_add_u32 m0, s21, 2048
    v_mfma_f32_32x32x16_bf16 v[48:63], v[84:87], v[176:179], v[48:63]
    buffer_load_dwordx4 v236, s[4:7], s36 offen  lds
    buffer_load_dwordx4 v237, s[8:11], s36 offen offset:1024  lds
    ds_read_b64_tr_b16 v[176:177], v244 offset:4096
    ds_read_b64_tr_b16 v[178:179], v244 offset:5120
    ds_read_b64_tr_b16 v[188:189], v245 offset:4096
    ds_read_b64_tr_b16 v[190:191], v245 offset:5120
    s_waitcnt vmcnt(4) lgkmcnt(0)
    v_mfma_f32_32x32x16_bf16 v[0:15], v[88:91], v[176:179], v[0:15]
    v_fmac_f32 v201, v37, v141
    v_fmac_f32 v201, v38, v142
    v_fmac_f32 v201, v39, v143
    v_add_f32 v199, v197, v199
    v_mul_f32_e64 v203, v40, -v136
    v_fma_f32 v203, v41, -v137, v203
    s_add_u32 m0, s21, 4096
    v_mfma_f32_32x32x16_bf16 v[48:63], v[92:95], v[176:179], v[48:63]
    buffer_load_dwordx4 v238, s[4:7], s36 offen  lds
    buffer_load_dwordx4 v239, s[8:11], s36 offen offset:1024  lds
    ds_read_b64_tr_b16 v[176:177], v244 offset:6144
    ds_read_b64_tr_b16 v[178:179], v244 offset:7168
    ds_read_b64_tr_b16 v[192:193], v245 offset:6144
    ds_read_b64_tr_b16 v[194:195], v245 offset:7168
    s_waitcnt lgkmcnt(0)
    v_mfma_f32_32x32x16_bf16 v[0:15], v[64:67], v[176:179], v[0:15]
    v_fma_f32 v203, v42, -v138, v203
    v_fma_f32 v203, v43, -v139, v203
    v_fma_f32 v203, v44, -v140, v203
    v_fma_f32 v203, v45, -v141, v203
    v_fma_f32 v203, v46, -v142, v203
    v_fma_f32 v203, v47, -v143, v203
    s_nop 1
    s_add_u32 m0, s21, 6144
    v_mfma_f32_32x32x16_bf16 v[48:63], v[68:71], v[176:179], v[48:63]
    buffer_load_dwordx4 v240, s[4:7], s36 offen  lds
    buffer_load_dwordx4 v241, s[8:11], s36 offen offset:1024  lds
    v_permlane32_swap_b32 v201, v203
    v_add_f32 v203, v201, v203
    s_set_gpr_idx_on s51, gpr_idx(DST)
    s_nop 0
    v_cvt_pk_bf16_f32 v204, v198, v199
    v_cvt_pk_bf16_f32 v205, v202, v203
    s_set_gpr_idx_off
    v_mfma_f32_32x32x16_bf16 v[16:31], v[72:75], v[180:183], 0
    v_mul_f32 v196, v0, v144
    v_fmac_f32 v196, v1, v145
    v_fmac_f32 v196, v2, v146
    v_fmac_f32 v196, v3, v147
    v_fmac_f32 v196, v4, v148
    v_fmac_f32 v196, v5, v149
    v_mfma_f32_32x32x16_bf16 v[32:47], v[76:79], v[180:183], 0
    v_add_u32 v253, s47, v248
    ds_read_b32 v254, v253
    ds_read_b32 v255, v253 offset:256
    v_fmac_f32 v196, v6, v150
    v_fmac_f32 v196, v7, v151
    v_mul_f32 v198, v8, v112
    v_mfma_f32_32x32x16_bf16 v[16:31], v[80:83], v[184:187], v[16:31]
    v_fmac_f32 v198, v9, v113
    v_fmac_f32 v198, v10, v114
    v_fmac_f32 v198, v11, v115
    v_fmac_f32 v198, v12, v116
    v_fmac_f32 v198, v13, v117
    v_fmac_f32 v198, v14, v118
    v_mfma_f32_32x32x16_bf16 v[32:47], v[84:87], v[184:187], v[32:47]
    v_fmac_f32 v198, v15, v119
    v_mul_f32_e64 v200, v48, -v160
    v_fma_f32 v200, v49, -v161, v200
    v_fma_f32 v200, v50, -v162, v200
    v_fma_f32 v200, v51, -v163, v200
    v_fma_f32 v200, v52, -v164, v200
    v_mfma_f32_32x32x16_bf16 v[16:31], v[88:91], v[188:191], v[16:31]
    v_fma_f32 v200, v53, -v165, v200
    v_fma_f32 v200, v54, -v166, v200
    v_fma_f32 v200, v55, -v167, v200
    v_mul_f32_e64 v202, v56, -v160
    v_fma_f32 v202, v57, -v161, v202
    v_fma_f32 v202, v58, -v162, v202
    v_mfma_f32_32x32x16_bf16 v[32:47], v[92:95], v[188:191], v[32:47]
    s_waitcnt vmcnt(6)
    ds_read_b64_tr_b16 v[176:177], v244 offset:0
    ds_read_b64_tr_b16 v[178:179], v244 offset:1024
    ds_read_b64_tr_b16 v[180:181], v245 offset:0
    ds_read_b64_tr_b16 v[182:183], v245 offset:1024
    v_fma_f32 v202, v59, -v163, v202
    v_fma_f32 v202, v60, -v164, v202
    v_mfma_f32_32x32x16_bf16 v[16:31], v[64:67], v[192:195], v[16:31]
    v_fma_f32 v202, v61, -v165, v202
    v_fma_f32 v202, v62, -v166, v202
    v_fma_f32 v202, v63, -v167, v202
    v_mfma_f32_32x32x16_bf16 v[32:47], v[68:71], v[192:195], v[32:47]
    s_waitcnt vmcnt(4) lgkmcnt(0)
    v_mfma_f32_32x32x16_bf16 v[0:15], v[72:75], v[176:179], 0
    s_nop 5
    v_mul_f32 v197, v16, v152
    v_fmac_f32 v197, v17, v153
    v_fmac_f32 v197, v18, v154
    v_fmac_f32 v197, v19, v155
    v_fmac_f32 v197, v20, v156
    v_fmac_f32 v197, v21, v157
    s_add_u32 m0, s21, 0
    v_mfma_f32_32x32x16_bf16 v[48:63], v[76:79], v[176:179], 0
    buffer_load_dwordx4 v234, s[4:7], s37 offen  lds
    buffer_load_dwordx4 v235, s[8:11], s37 offen offset:1024  lds
    ds_read_b64_tr_b16 v[176:177], v244 offset:2048
    ds_read_b64_tr_b16 v[178:179], v244 offset:3072
    ds_read_b64_tr_b16 v[184:185], v245 offset:2048
    ds_read_b64_tr_b16 v[186:187], v245 offset:3072
    v_add_u32 v252, s42, v247
    ds_read2_b32 v[234:235], v252 offset0:0 offset1:16
    s_mov_b32 m0, s76
    s_mov_b64 exec, s[72:73]
    buffer_load_dwordx4 v254, s[12:15], 0 offen  lds
    s_mov_b32 m0, s77
    s_mov_b64 exec, s[74:75]
    buffer_load_dwordx4 v255, s[12:15], 0 offen  lds
    s_mov_b64 exec, -1
    v_fmac_f32 v197, v22, v158
    v_fmac_f32 v197, v23, v159
    v_mul_f32 v199, v24, v120
    v_fmac_f32 v199, v25, v121
    v_fmac_f32 v199, v26, v122
    v_fmac_f32 v199, v27, v123
    s_waitcnt vmcnt(6) lgkmcnt(1)
    v_mfma_f32_32x32x16_bf16 v[0:15], v[80:83], v[176:179], v[0:15]
    v_fmac_f32 v199, v28, v124
    v_fmac_f32 v199, v29, v125
    v_fmac_f32 v199, v30, v126
    v_fmac_f32 v199, v31, v127
    v_mul_f32_e64 v201, v32, -v168
    v_fma_f32 v201, v33, -v169, v201
    s_add_u32 m0, s21, 2048
    v_mfma_f32_32x32x16_bf16 v[48:63], v[84:87], v[176:179], v[48:63]
    buffer_load_dwordx4 v236, s[4:7], s37 offen  lds
    buffer_load_dwordx4 v237, s[8:11], s37 offen offset:1024  lds
    ds_read_b64_tr_b16 v[176:177], v244 offset:4096
    ds_read_b64_tr_b16 v[178:179], v244 offset:5120
    ds_read_b64_tr_b16 v[188:189], v245 offset:4096
    ds_read_b64_tr_b16 v[190:191], v245 offset:5120
    v_add_u32 v252, s43, v247
    ds_read2_b32 v[236:237], v252 offset0:0 offset1:16
    s_waitcnt vmcnt(6) lgkmcnt(1)
    v_mfma_f32_32x32x16_bf16 v[0:15], v[88:91], v[176:179], v[0:15]
    v_fma_f32 v201, v34, -v170, v201
    v_fma_f32 v201, v35, -v171, v201
    v_fma_f32 v201, v36, -v172, v201
    v_fma_f32 v201, v37, -v173, v201
    v_fma_f32 v201, v38, -v174, v201
    v_fma_f32 v201, v39, -v175, v201
    s_add_u32 m0, s21, 4096
    v_mfma_f32_32x32x16_bf16 v[48:63], v[92:95], v[176:179], v[48:63]
    buffer_load_dwordx4 v238, s[4:7], s37 offen  lds
    buffer_load_dwordx4 v239, s[8:11], s37 offen offset:1024  lds
    ds_read_b64_tr_b16 v[176:177], v244 offset:6144
    ds_read_b64_tr_b16 v[178:179], v244 offset:7168
    ds_read_b64_tr_b16 v[192:193], v245 offset:6144
    ds_read_b64_tr_b16 v[194:195], v245 offset:7168
    v_add_u32 v252, s44, v247
    ds_read2_b32 v[238:239], v252 offset0:0 offset1:16
    s_waitcnt lgkmcnt(1)
    v_mfma_f32_32x32x16_bf16 v[0:15], v[64:67], v[176:179], v[0:15]
    v_mul_f32_e64 v203, v40, -v168
    v_fma_f32 v203, v41, -v169, v203
    v_fma_f32 v203, v42, -v170, v203
    v_fma_f32 v203, v43, -v171, v203
    v_fma_f32 v203, v44, -v172, v203
    v_fma_f32 v203, v45, -v173, v203
    s_add_u32 m0, s21, 6144
    v_mfma_f32_32x32x16_bf16 v[48:63], v[68:71], v[176:179], v[48:63]
    buffer_load_dwordx4 v240, s[4:7], s37 offen  lds
    buffer_load_dwordx4 v241, s[8:11], s37 offen offset:1024  lds
    v_add_u32 v252, s45, v247
    ds_read2_b32 v[240:241], v252 offset0:0 offset1:16
    v_fma_f32 v203, v46, -v174, v203
    v_fma_f32 v203, v47, -v175, v203
    v_mfma_f32_32x32x16_bf16 v[16:31], v[72:75], v[180:183], 0
    v_mul_f32 v254, v0, v144
    v_fmac_f32 v254, v1, v145
    v_fmac_f32 v254, v2, v146
    v_fmac_f32 v254, v3, v147
    v_fmac_f32 v254, v4, v148
    v_fmac_f32 v254, v5, v149
    v_mfma_f32_32x32x16_bf16 v[32:47], v[76:79], v[180:183], 0
    ds_swizzle_b32 v76, v76 offset:0x401F
    ds_swizzle_b32 v77, v77 offset:0x401F
    ds_swizzle_b32 v78, v78 offset:0x401F
    ds_swizzle_b32 v79, v79 offset:0x401F
    v_fmac_f32 v254, v6, v150
    v_fmac_f32 v254, v7, v151
    v_mfma_f32_32x32x16_bf16 v[16:31], v[80:83], v[184:187], v[16:31]
    v_fmac_f32 v200, v8, v160
    v_fmac_f32 v200, v9, v161
    v_permlane32_swap_b32 v196, v254
    v_fmac_f32 v200, v10, v162
    v_fmac_f32 v200, v11, v163
    v_fmac_f32 v200, v12, v164
    v_mfma_f32_32x32x16_bf16 v[32:47], v[84:87], v[184:187], v[32:47]
    ds_swizzle_b32 v84, v84 offset:0x401F
    ds_swizzle_b32 v85, v85 offset:0x401F
    ds_swizzle_b32 v86, v86 offset:0x401F
    ds_swizzle_b32 v87, v87 offset:0x401F
    v_fmac_f32 v200, v13, v165
    v_fmac_f32 v200, v14, v166
    v_mfma_f32_32x32x16_bf16 v[16:31], v[88:91], v[188:191], v[16:31]
    v_fmac_f32 v200, v15, v167
    v_add_f32 v254, v196, v254
    v_mfma_f32_32x32x16_bf16 v[32:47], v[92:95], v[188:191], v[32:47]
    ds_swizzle_b32 v92, v92 offset:0x401F
    ds_swizzle_b32 v93, v93 offset:0x401F
    ds_swizzle_b32 v94, v94 offset:0x401F
    ds_swizzle_b32 v95, v95 offset:0x401F
    s_waitcnt vmcnt(8)
    ds_read_b64_tr_b16 v[176:177], v244 offset:0
    ds_read_b64_tr_b16 v[178:179], v244 offset:1024
    ds_read_b64_tr_b16 v[180:181], v245 offset:0
    ds_read_b64_tr_b16 v[182:183], v245 offset:1024
    v_mfma_f32_32x32x16_bf16 v[16:31], v[64:67], v[192:195], v[16:31]
    v_mfma_f32_32x32x16_bf16 v[32:47], v[68:71], v[192:195], v[32:47]
    ds_swizzle_b32 v68, v68 offset:0x401F
    ds_swizzle_b32 v69, v69 offset:0x401F
    ds_swizzle_b32 v70, v70 offset:0x401F
    ds_swizzle_b32 v71, v71 offset:0x401F
    s_waitcnt lgkmcnt(8)
    s_mov_b64 exec, s[56:57]
    v_xor_b32 v76, 0x80008000, v76
    v_xor_b32 v77, 0x80008000, v77
    v_xor_b32 v78, 0x80008000, v78
    v_xor_b32 v79, 0x80008000, v79
    v_xor_b32 v84, 0x80008000, v84
    v_xor_b32 v85, 0x80008000, v85
    v_xor_b32 v86, 0x80008000, v86
    v_xor_b32 v87, 0x80008000, v87
    v_xor_b32 v92, 0x80008000, v92
    v_xor_b32 v93, 0x80008000, v93
    v_xor_b32 v94, 0x80008000, v94
    v_xor_b32 v95, 0x80008000, v95
    s_mov_b64 exec, -1
    s_waitcnt vmcnt(4) lgkmcnt(4)
    v_mfma_f32_32x32x16_bf16 v[0:15], v[72:75], v[176:179], 0
    v_mul_f32 v255, v16, v152
    v_fmac_f32 v255, v17, v153
    v_fmac_f32 v255, v18, v154
    v_fmac_f32 v255, v19, v155
    v_fmac_f32 v255, v20, v156
    v_fmac_f32 v255, v21, v157
    s_add_u32 m0, s21, 0
    v_mfma_f32_32x32x16_bf16 v[48:63], v[76:79], v[176:179], v[48:63]
    v_mad_u32_u16 v234, v234, s3, v246 op_sel:[1,0,0,0]
    v_mad_u32_u16 v235, v235, s3, v246 op_sel:[1,0,0,0]
    buffer_load_dwordx4 v234, s[4:7], s38 offen  lds
    buffer_load_dwordx4 v235, s[8:11], s38 offen offset:1024  lds
    ds_read_b64_tr_b16 v[176:177], v244 offset:2048
    ds_read_b64_tr_b16 v[178:179], v244 offset:3072
    ds_read_b64_tr_b16 v[184:185], v245 offset:2048
    ds_read_b64_tr_b16 v[186:187], v245 offset:3072
    s_waitcnt vmcnt(4) lgkmcnt(0)
    v_mfma_f32_32x32x16_bf16 v[0:15], v[80:83], v[176:179], v[0:15]
    s_add_u32 m0, s21, 2048
    v_mfma_f32_32x32x16_bf16 v[48:63], v[84:87], v[176:179], v[48:63]
    v_mad_u32_u16 v236, v236, s3, v246 op_sel:[1,0,0,0]
    v_mad_u32_u16 v237, v237, s3, v246 op_sel:[1,0,0,0]
    buffer_load_dwordx4 v236, s[4:7], s39 offen  lds
    buffer_load_dwordx4 v237, s[8:11], s39 offen offset:1024  lds
    ds_read_b64_tr_b16 v[176:177], v244 offset:4096
    ds_read_b64_tr_b16 v[178:179], v244 offset:5120
    ds_read_b64_tr_b16 v[188:189], v245 offset:4096
    ds_read_b64_tr_b16 v[190:191], v245 offset:5120
    s_waitcnt vmcnt(4) lgkmcnt(0)
    v_mfma_f32_32x32x16_bf16 v[0:15], v[88:91], v[176:179], v[0:15]
    v_fmac_f32 v255, v22, v158
    v_fmac_f32 v255, v23, v159
    v_fmac_f32 v201, v24, v168
    v_fmac_f32 v201, v25, v169
    v_permlane32_swap_b32 v197, v255
    s_add_u32 m0, s21, 4096
    v_mfma_f32_32x32x16_bf16 v[48:63], v[92:95], v[176:179], v[48:63]
    v_mad_u32_u16 v238, v238, s3, v246 op_sel:[1,0,0,0]
    v_mad_u32_u16 v239, v239, s3, v246 op_sel:[1,0,0,0]
    buffer_load_dwordx4 v238, s[4:7], s40 offen  lds
    buffer_load_dwordx4 v239, s[8:11], s40 offen offset:1024  lds
    ds_read_b64_tr_b16 v[176:177], v244 offset:6144
    ds_read_b64_tr_b16 v[178:179], v244 offset:7168
    ds_read_b64_tr_b16 v[192:193], v245 offset:6144
    ds_read_b64_tr_b16 v[194:195], v245 offset:7168
    s_waitcnt lgkmcnt(0)
    s_mov_b64 exec, s[56:57]
    v_xor_b32 v68, 0x80008000, v68
    v_xor_b32 v69, 0x80008000, v69
    v_xor_b32 v70, 0x80008000, v70
    v_xor_b32 v71, 0x80008000, v71
    s_mov_b64 exec, -1
    v_mfma_f32_32x32x16_bf16 v[0:15], v[64:67], v[176:179], v[0:15]
    v_fmac_f32 v201, v26, v170
    v_fmac_f32 v201, v27, v171
    v_fmac_f32 v201, v28, v172
    v_fmac_f32 v201, v29, v173
    v_fmac_f32 v201, v30, v174
    v_fmac_f32 v201, v31, v175
    s_add_u32 m0, s21, 6144
    v_mfma_f32_32x32x16_bf16 v[48:63], v[68:71], v[176:179], v[48:63]
    v_mad_u32_u16 v240, v240, s3, v246 op_sel:[1,0,0,0]
    v_mad_u32_u16 v241, v241, s3, v246 op_sel:[1,0,0,0]
    buffer_load_dwordx4 v240, s[4:7], s41 offen  lds
    buffer_load_dwordx4 v241, s[8:11], s41 offen offset:1024  lds
    v_add_f32 v255, v197, v255
    s_set_gpr_idx_on s51, gpr_idx(DST)
    s_nop 0
    v_cvt_pk_bf16_f32 v206, v254, v255
    s_set_gpr_idx_off
    v_mfma_f32_32x32x16_bf16 v[16:31], v[72:75], v[180:183], 0
    v_mul_f32 v254, v0, v144
    v_fmac_f32 v254, v1, v145
    v_fmac_f32 v254, v2, v146
    v_fmac_f32 v254, v3, v147
    v_fmac_f32 v254, v4, v148
    v_fmac_f32 v254, v5, v149
    v_mfma_f32_32x32x16_bf16 v[32:47], v[76:79], v[180:183], v[32:47]
    v_fmac_f32 v254, v6, v150
    v_fmac_f32 v254, v7, v151
    v_fma_f32 v202, v8, -v160, v202
    v_fma_f32 v202, v9, -v161, v202
    v_permlane32_swap_b32 v254, v200
    v_fma_f32 v202, v10, -v162, v202
    v_mfma_f32_32x32x16_bf16 v[16:31], v[80:83], v[184:187], v[16:31]
    v_fma_f32 v202, v11, -v163, v202
    v_fma_f32 v202, v12, -v164, v202
    v_fma_f32 v202, v13, -v165, v202
    v_fma_f32 v202, v14, -v166, v202
    v_fma_f32 v202, v15, -v167, v202
    v_add_f32 v200, v254, v200
    v_mfma_f32_32x32x16_bf16 v[32:47], v[84:87], v[184:187], v[32:47]
    v_fmac_f32 v198, v48, v112
    v_permlane32_swap_b32 v202, v254
    v_fmac_f32 v198, v49, v113
    v_fmac_f32 v198, v50, v114
    v_fmac_f32 v198, v51, v115
    v_fmac_f32 v198, v52, v116
    v_mfma_f32_32x32x16_bf16 v[16:31], v[88:91], v[188:191], v[16:31]
    v_fmac_f32 v198, v53, v117
    v_fmac_f32 v198, v54, v118
    v_fmac_f32 v198, v55, v119
    v_add_f32 v254, v202, v254
    v_mul_f32 v196, v56, v160
    v_fmac_f32 v196, v57, v161
    v_mfma_f32_32x32x16_bf16 v[32:47], v[92:95], v[188:191], v[32:47]
    s_waitcnt vmcnt(6)
    ds_read_b64_tr_b16 v[176:177], v244 offset:0
    ds_read_b64_tr_b16 v[178:179], v244 offset:1024
    ds_read_b64_tr_b16 v[180:181], v245 offset:0
    ds_read_b64_tr_b16 v[182:183], v245 offset:1024
    v_fmac_f32 v196, v58, v162
    v_fmac_f32 v196, v59, v163
    v_mfma_f32_32x32x16_bf16 v[16:31], v[64:67], v[192:195], v[16:31]
    v_fmac_f32 v196, v60, v164
    v_fmac_f32 v196, v61, v165
    v_fmac_f32 v196, v62, v166
    v_fmac_f32 v196, v63, v167
    s_nop 1
    v_permlane32_swap_b32 v198, v196
    v_add_f32 v196, v198, v196
    v_mfma_f32_32x32x16_bf16 v[32:47], v[68:71], v[192:195], v[32:47]
    v_add_u32 v249, s48, v249
    v_add_u32 v250, s49, v250
    s_nop 0
    v_mul_f32 v255, v16, v152
    v_fmac_f32 v255, v17, v153
    v_fmac_f32 v255, v18, v154
    v_fmac_f32 v255, v19, v155
    v_fmac_f32 v255, v20, v156
    v_fmac_f32 v255, v21, v157
    v_fmac_f32 v255, v22, v158
    v_fmac_f32 v255, v23, v159
    v_fma_f32 v203, v24, -v168, v203
    v_fma_f32 v203, v25, -v169, v203
    v_permlane32_swap_b32 v255, v201
    v_fma_f32 v203, v26, -v170, v203
    v_fma_f32 v203, v27, -v171, v203
    v_fma_f32 v203, v28, -v172, v203
    v_fma_f32 v203, v29, -v173, v203
    v_fma_f32 v203, v30, -v174, v203
    v_fma_f32 v203, v31, -v175, v203
    v_add_f32 v201, v255, v201
    v_fmac_f32 v199, v32, v120
    v_permlane32_swap_b32 v203, v255
    v_fmac_f32 v199, v33, v121
    v_fmac_f32 v199, v34, v122
    v_fmac_f32 v199, v35, v123
    ds_read_b64_tr_b16 v[72:73], v249 offset:0
    ds_read_b64_tr_b16 v[76:77], v249 offset:64
    ds_read_b64_tr_b16 v[74:75], v249 offset:256
    ds_read_b64_tr_b16 v[78:79], v249 offset:320
    s_mov_b64 exec, s[54:55]
    ds_read_u16_d16_hi v242, v250 offset:0
    s_mov_b64 exec, -1
    v_fmac_f32 v199, v36, v124
    v_fmac_f32 v199, v37, v125
    v_fmac_f32 v199, v38, v126
    v_fmac_f32 v199, v39, v127
    v_add_f32 v255, v203, v255
    v_mul_f32 v197, v40, v168
    v_fmac_f32 v197, v41, v169
    v_fmac_f32 v197, v42, v170
    v_fmac_f32 v197, v43, v171
    v_fmac_f32 v197, v44, v172
    v_fmac_f32 v197, v45, v173
    v_fmac_f32 v197, v46, v174
    v_fmac_f32 v197, v47, v175
    s_nop 1
    v_permlane32_swap_b32 v199, v197
    v_add_f32 v197, v199, v197
    s_set_gpr_idx_on s51, gpr_idx(DST)
    s_nop 0
    v_cvt_pk_bf16_f32 v207, v200, v201
    v_cvt_pk_bf16_f32 v209, v254, v255
    v_cvt_pk_bf16_f32 v208, v196, v197
    s_set_gpr_idx_off
    s_add_u32 s50, s50, 1
    s_add_u32 s51, s51, 6
    s_cmp_ge_u32 s50, 4
    s_cbranch_scc1 LAST0
    s_add_u32 s53, s53, 4
    s_xor_b32 s66, s53, s20
    s_bitcmp1_b32 s66, 2
    s_setprio 1
    s_cbranch_scc1 PRIO_9
    s_setprio 0
PRIO_9:
    s_cmp_eq_u32 s52, 4
    s_cbranch_scc1 ITEM_0_4
    s_cmp_eq_u32 s52, 5
    s_cbranch_scc1 ITEM_0_5
    s_cmp_eq_u32 s52, 3
    s_cbranch_scc1 ITEM_0_3
    s_cmp_eq_u32 s52, 6
    s_cbranch_scc1 ITEM_0_6
    s_cmp_eq_u32 s52, 8
    s_cbranch_scc1 ITEM_0_8
    s_branch ITEM_0_2
.p2align 6
ITEM_0_2:
    s_mov_b32 m0, s50
    s_nop 0
    s_movrels_b32 s71, s23
    s_bfe_u32 s46, s71, 0x30012
    s_mov_b32 m0, s46
    s_and_b32 s66, s71, 0x3ffff
    s_movrels_b32 s68, s57
    s_movrels_b32 s69, s61
    s_sub_u32 s48, s66, s47
    s_mov_b32 s47, s66
    s_lshr_b32 s52, s71, 28
    s_lshl_b32 s67, s46, 9
    s_add_u32 s66, s66, s67
    s_sub_u32 s49, s66, s42
    s_mov_b32 s42, s66
    s_bfe_u32 s66, s68, 655360
    s_add_u32 s43, s42, s66
    s_bfe_u32 s39, s69, 655360
    s_bfe_u32 s66, s68, 655370
    s_add_u32 s44, s42, s66
    s_bfe_u32 s40, s69, 655370
    s_bfe_u32 s66, s68, 655380
    s_add_u32 s45, s42, s66
    s_bfe_u32 s41, s69, 655380
    s_and_b32 s66, s46, s33
    s_cselect_b32 s72, -1, 1
    s_cselect_b32 s76, s47, 163712
    s_cmp_ge_u32 s66, 2
    s_cselect_b32 s73, -1, 0
    s_add_u32 s77, s47, 1024
    s_cmp_ge_u32 s66, 4
    s_cselect_b32 s75, -1, 0
    s_cmp_ge_u32 s66, 3
    s_cselect_b32 s74, -1, 1
    s_cselect_b32 s77, s77, 163712
    v_add_u32 v252, s42, v247
    ds_read2_b32 v[234:235], v252 offset0:0 offset1:16
    v_add_u32 v252, s43, v247
    ds_read2_b32 v[236:237], v252 offset0:0 offset1:16
    v_add_u32 v252, s44, v247
    ds_read2_b32 v[238:239], v252 offset0:0 offset1:16
    v_add_u32 v252, s45, v247
    ds_read2_b32 v[240:241], v252 offset0:0 offset1:16
    s_waitcnt lgkmcnt(4)
    v_mul_f32_dpp v196, v242, v72 row_newbcast:0 row_mask:0xf bank_mask:0xf
    v_mul_f32_dpp v197, v242, v73 row_newbcast:1 row_mask:0xf bank_mask:0xf
    v_mul_f32_dpp v198, v242, v72 row_newbcast:8 row_mask:0xf bank_mask:0xf
    v_mul_f32_dpp v199, v242, v73 row_newbcast:9 row_mask:0xf bank_mask:0xf
    v_mul_f32_dpp v200, v242, v76 row_newbcast:2 row_mask:0xf bank_mask:0xf
    v_mul_f32_dpp v201, v242, v77 row_newbcast:3 row_mask:0xf bank_mask:0xf
    v_mul_f32_dpp v202, v242, v76 row_newbcast:10 row_mask:0xf bank_mask:0xf
    v_mul_f32_dpp v203, v242, v77 row_newbcast:11 row_mask:0xf bank_mask:0xf
    v_cvt_pk_bf16_f32 v72, v196, v197
    v_cvt_pk_bf16_f32 v76, v198, v199
    v_cvt_pk_bf16_f32 v73, v200, v201
    v_cvt_pk_bf16_f32 v77, v202, v203
    v_mul_f32_dpp v196, v242, v74 row_newbcast:4 row_mask:0xf bank_mask:0xf
    v_mul_f32_dpp v197, v242, v75 row_newbcast:5 row_mask:0xf bank_mask:0xf
    v_mul_f32_dpp v198, v242, v74 row_newbcast:12 row_mask:0xf bank_mask:0xf
    v_mul_f32_dpp v199, v242, v75 row_newbcast:13 row_mask:0xf bank_mask:0xf
    v_mul_f32_dpp v200, v242, v78 row_newbcast:6 row_mask:0xf bank_mask:0xf
    v_mul_f32_dpp v201, v242, v79 row_newbcast:7 row_mask:0xf bank_mask:0xf
    v_mul_f32_dpp v202, v242, v78 row_newbcast:14 row_mask:0xf bank_mask:0xf
    v_mul_f32_dpp v203, v242, v79 row_newbcast:15 row_mask:0xf bank_mask:0xf
    v_cvt_pk_bf16_f32 v74, v196, v197
    v_cvt_pk_bf16_f32 v78, v198, v199
    v_cvt_pk_bf16_f32 v75, v200, v201
    v_cvt_pk_bf16_f32 v79, v202, v203
    s_nop 0
    s_waitcnt lgkmcnt(3)
    v_mfma_f32_32x32x16_bf16 v[56:71], v[72:75], v[176:179], 0
    s_add_u32 m0, s21, 0
    v_mfma_f32_32x32x16_bf16 v[16:31], v[76:79], v[176:179], 0
    v_mad_u32_u16 v234, v234, s3, v246 op_sel:[1,0,0,0]
    v_mad_u32_u16 v235, v235, s3, v246 op_sel:[1,0,0,0]
    buffer_load_dwordx4 v234, s[4:7], s38 offen  lds
    buffer_load_dwordx4 v235, s[8:11], s38 offen offset:1024  lds
    v_mfma_f32_32x32x16_bf16 v[32:47], v[72:75], v[180:183], 0
    s_nop 4
    v_mul_f32 v196, v56, v96
    v_fmac_f32 v196, v57, v97
    v_fmac_f32 v196, v58, v98
    v_fmac_f32 v196, v59, v99
    v_fmac_f32 v196, v60, v100
    v_fmac_f32 v196, v61, v101
    v_mfma_f32_32x32x16_bf16 v[0:15], v[76:79], v[180:183], 0
    s_waitcnt vmcnt(6)
    ds_read_b64_tr_b16 v[176:177], v244 offset:2048
    ds_read_b64_tr_b16 v[178:179], v244 offset:3072
    ds_read_b64_tr_b16 v[180:181], v245 offset:2048
    ds_read_b64_tr_b16 v[182:183], v245 offset:3072
    v_fmac_f32 v196, v62, v102
    v_fmac_f32 v196, v63, v103
    v_mul_f32 v198, v64, v128
    v_fmac_f32 v198, v65, v129
    v_fmac_f32 v198, v66, v130
    v_fmac_f32 v198, v67, v131
    v_fmac_f32 v198, v68, v132
    v_fmac_f32 v198, v69, v133
    v_fmac_f32 v198, v70, v134
    v_fmac_f32 v198, v71, v135
    v_mul_f32 v200, v16, v128
    v_fmac_f32 v200, v17, v129
    v_permlane32_swap_b32 v196, v198
    v_fmac_f32 v200, v18, v130
    v_fmac_f32 v200, v19, v131
    v_fmac_f32 v200, v20, v132
    v_fmac_f32 v200, v21, v133
    v_fmac_f32 v200, v22, v134
    v_fmac_f32 v200, v23, v135
    v_add_f32 v198, v196, v198
    v_mul_f32_e64 v202, v24, -v128
    v_fma_f32 v202, v25, -v129, v202
    v_fma_f32 v202, v26, -v130, v202
    v_fma_f32 v202, v27, -v131, v202
    v_fma_f32 v202, v28, -v132, v202
    v_fma_f32 v202, v29, -v133, v202
    v_fma_f32 v202, v30, -v134, v202
    v_fma_f32 v202, v31, -v135, v202
    s_nop 1
    v_permlane32_swap_b32 v200, v202
    v_add_f32 v202, v200, v202
    s_waitcnt lgkmcnt(0)
    v_mfma_f32_32x32x16_bf16 v[56:71], v[72:75], v[176:179], 0
    v_mul_f32 v197, v32, v104
    v_fmac_f32 v197, v33, v105
    v_fmac_f32 v197, v34, v106
    v_fmac_f32 v197, v35, v107
    v_fmac_f32 v197, v36, v108
    v_fmac_f32 v197, v37, v109
    s_add_u32 m0, s21, 2048
    v_mfma_f32_32x32x16_bf16 v[16:31], v[76:79], v[176:179], 0
    v_mad_u32_u16 v236, v236, s3, v246 op_sel:[1,0,0,0]
    v_mad_u32_u16 v237, v237, s3, v246 op_sel:[1,0,0,0]
    buffer_load_dwordx4 v236, s[4:7], s39 offen  lds
    buffer_load_dwordx4 v237, s[8:11], s39 offen offset:1024  lds
    v_fmac_f32 v197, v38, v110
    v_fmac_f32 v197, v39, v111
    v_mul_f32 v199, v40, v136
    v_fmac_f32 v199, v41, v137
    v_fmac_f32 v199, v42, v138
    v_fmac_f32 v199, v43, v139
    v_fmac_f32 v199, v44, v140
    v_fmac_f32 v199, v45, v141
    v_fmac_f32 v199, v46, v142
    v_fmac_f32 v199, v47, v143
    v_mul_f32 v201, v0, v136
    v_fmac_f32 v201, v1, v137
    v_permlane32_swap_b32 v197, v199
    v_fmac_f32 v201, v2, v138
    v_fmac_f32 v201, v3, v139
    v_fmac_f32 v201, v4, v140
    v_fmac_f32 v201, v5, v141
    v_fmac_f32 v201, v6, v142
    v_fmac_f32 v201, v7, v143
    v_add_f32 v199, v197, v199
    v_mul_f32_e64 v203, v8, -v136
    v_fma_f32 v203, v9, -v137, v203
    v_fma_f32 v203, v10, -v138, v203
    v_fma_f32 v203, v11, -v139, v203
    v_fma_f32 v203, v12, -v140, v203
    v_fma_f32 v203, v13, -v141, v203
    v_fma_f32 v203, v14, -v142, v203
    v_fma_f32 v203, v15, -v143, v203
    s_nop 1
    v_permlane32_swap_b32 v201, v203
    v_add_f32 v203, v201, v203
    s_set_gpr_idx_on s51, gpr_idx(DST)
    s_nop 0
    v_cvt_pk_bf16_f32 v204, v198, v199
    v_cvt_pk_bf16_f32 v205, v202, v203
    s_set_gpr_idx_off
    v_mfma_f32_32x32x16_bf16 v[32:47], v[72:75], v[180:183], 0
    v_mul_f32 v196, v56, v144
    v_fmac_f32 v196, v57, v145
    v_fmac_f32 v196, v58, v146
    v_fmac_f32 v196, v59, v147
    v_fmac_f32 v196, v60, v148
    v_fmac_f32 v196, v61, v149
    v_mfma_f32_32x32x16_bf16 v[0:15], v[76:79], v[180:183], 0
    s_waitcnt vmcnt(6)
    ds_read_b64_tr_b16 v[176:177], v244 offset:4096
    ds_read_b64_tr_b16 v[178:179], v244 offset:5120
    ds_read_b64_tr_b16 v[180:181], v245 offset:4096
    ds_read_b64_tr_b16 v[182:183], v245 offset:5120
    v_fmac_f32 v196, v62, v150
    v_fmac_f32 v196, v63, v151
    v_mul_f32_e64 v200, v16, -v160
    v_fma_f32 v200, v17, -v161, v200
    v_fma_f32 v200, v18, -v162, v200
    v_fma_f32 v200, v19, -v163, v200
    v_fma_f32 v200, v20, -v164, v200
    v_fma_f32 v200, v21, -v165, v200
    v_fma_f32 v200, v22, -v166, v200
    v_fma_f32 v200, v23, -v167, v200
    v_mul_f32_e64 v202, v24, -v160
    v_fma_f32 v202, v25, -v161, v202
    v_fma_f32 v202, v26, -v162, v202
    v_fma_f32 v202, v27, -v163, v202
    v_fma_f32 v202, v28, -v164, v202
    v_fma_f32 v202, v29, -v165, v202
    v_fma_f32 v202, v30, -v166, v202
    v_fma_f32 v202, v31, -v167, v202
    s_waitcnt lgkmcnt(0)
    v_mfma_f32_32x32x16_bf16 v[16:31], v[72:75], v[176:179], 0
    v_mul_f32 v197, v32, v152
    v_fmac_f32 v197, v33, v153
    v_fmac_f32 v197, v34, v154
    v_fmac_f32 v197, v35, v155
    v_fmac_f32 v197, v36, v156
    v_fmac_f32 v197, v37, v157
    s_add_u32 m0, s21, 4096
    v_mfma_f32_32x32x16_bf16 v[48:63], v[76:79], v[176:179], 0
    v_mad_u32_u16 v238, v238, s3, v246 op_sel:[1,0,0,0]
    v_mad_u32_u16 v239, v239, s3, v246 op_sel:[1,0,0,0]
    buffer_load_dwordx4 v238, s[4:7], s40 offen  lds
    buffer_load_dwordx4 v239, s[8:11], s40 offen offset:1024  lds
    v_fmac_f32 v197, v38, v158
    v_fmac_f32 v197, v39, v159
    v_mul_f32_e64 v201, v0, -v168
    v_fma_f32 v201, v1, -v169, v201
    v_fma_f32 v201, v2, -v170, v201
    v_fma_f32 v201, v3, -v171, v201
    v_fma_f32 v201, v4, -v172, v201
    v_fma_f32 v201, v5, -v173, v201
    v_fma_f32 v201, v6, -v174, v201
    v_fma_f32 v201, v7, -v175, v201
    v_mul_f32_e64 v203, v8, -v168
    v_fma_f32 v203, v9, -v169, v203
    v_fma_f32 v203, v10, -v170, v203
    v_fma_f32 v203, v11, -v171, v203
    v_fma_f32 v203, v12, -v172, v203
    v_fma_f32 v203, v13, -v173, v203
    v_fma_f32 v203, v14, -v174, v203
    v_fma_f32 v203, v15, -v175, v203
    v_mfma_f32_32x32x16_bf16 v[0:15], v[72:75], v[180:183], 0
    v_fmac_f32 v200, v24, v160
    v_fmac_f32 v200, v25, v161
    v_fmac_f32 v200, v26, v162
    v_fmac_f32 v200, v27, v163
    v_fmac_f32 v200, v28, v164
    v_fmac_f32 v200, v29, v165
    v_fmac_f32 v200, v30, v166
    v_fmac_f32 v200, v31, v167
    v_mfma_f32_32x32x16_bf16 v[24:39], v[76:79], v[180:183], 0
    v_add_u32 v253, s47, v248
    ds_read_b32 v192, v253
    ds_read_b32 v193, v253 offset:256
    s_waitcnt vmcnt(6)
    ds_read_b64_tr_b16 v[176:177], v244 offset:6144
    ds_read_b64_tr_b16 v[178:179], v244 offset:7168
    ds_read_b64_tr_b16 v[180:181], v245 offset:6144
    ds_read_b64_tr_b16 v[182:183], v245 offset:7168
    v_mul_f32 v254, v16, v144
    v_fmac_f32 v254, v17, v145
    v_fmac_f32 v254, v18, v146
    v_fmac_f32 v254, v19, v147
    v_fmac_f32 v254, v20, v148
    v_fmac_f32 v254, v21, v149
    v_fmac_f32 v254, v22, v150
    v_fmac_f32 v254, v23, v151
    v_sub_f32_e64 v64, -v48, v64
    v_sub_f32_e64 v65, -v49, v65
    v_permlane32_swap_b32 v196, v254
    v_sub_f32_e64 v66, -v50, v66
    v_sub_f32_e64 v67, -v51, v67
    v_sub_f32_e64 v68, -v52, v68
    v_sub_f32_e64 v69, -v53, v69
    v_sub_f32_e64 v70, -v54, v70
    v_sub_f32_e64 v71, -v55, v71
    v_add_f32 v254, v196, v254
    s_waitcnt lgkmcnt(0)
    v_mfma_f32_32x32x16_bf16 v[56:71], v[76:79], v[176:179], v[56:71]
    v_sub_f32_e64 v40, -v24, v40
    v_sub_f32_e64 v41, -v25, v41
    v_sub_f32_e64 v42, -v26, v42
    v_sub_f32_e64 v43, -v27, v43
    v_sub_f32_e64 v44, -v28, v44
    v_sub_f32_e64 v45, -v29, v45
    v_sub_f32_e64 v46, -v30, v46
    v_sub_f32_e64 v47, -v31, v47
    s_mov_b32 m0, s76
    s_mov_b64 exec, s[72:73]
    buffer_load_dwordx4 v192, s[12:15], 0 offen  lds
    s_mov_b32 m0, s77
    s_mov_b64 exec, s[74:75]
    buffer_load_dwordx4 v193, s[12:15], 0 offen  lds
    s_mov_b64 exec, -1
    s_add_u32 m0, s21, 6144
    v_mfma_f32_32x32x16_bf16 v[16:31], v[72:75], v[176:179], 0
    v_mad_u32_u16 v240, v240, s3, v246 op_sel:[1,0,0,0]
    v_mad_u32_u16 v241, v241, s3, v246 op_sel:[1,0,0,0]
    buffer_load_dwordx4 v240, s[4:7], s41 offen  lds
    buffer_load_dwordx4 v241, s[8:11], s41 offen offset:1024  lds
    v_mul_f32 v255, v0, v152
    v_fmac_f32 v255, v1, v153
    v_fmac_f32 v255, v2, v154
    v_fmac_f32 v255, v3, v155
    v_fmac_f32 v255, v4, v156
    v_fmac_f32 v255, v5, v157
    v_fmac_f32 v255, v6, v158
    v_fmac_f32 v255, v7, v159
    v_fmac_f32 v201, v8, v168
    v_fmac_f32 v201, v9, v169
    v_permlane32_swap_b32 v197, v255
    v_fmac_f32 v201, v10, v170
    v_fmac_f32 v201, v11, v171
    v_fmac_f32 v201, v12, v172
    v_fmac_f32 v201, v13, v173
    v_fmac_f32 v201, v14, v174
    v_fmac_f32 v201, v15, v175
    v_add_f32 v255, v197, v255
    s_set_gpr_idx_on s51, gpr_idx(DST)
    s_nop 0
    v_cvt_pk_bf16_f32 v206, v254, v255
    s_set_gpr_idx_off
    v_mfma_f32_32x32x16_bf16 v[0:15], v[72:75], v[180:183], 0
    v_mul_f32 v254, v16, v144
    v_fmac_f32 v254, v17, v145
    v_fmac_f32 v254, v18, v146
    v_fmac_f32 v254, v19, v147
    v_fmac_f32 v254, v20, v148
    v_fmac_f32 v254, v21, v149
    v_mfma_f32_32x32x16_bf16 v[32:47], v[76:79], v[180:183], v[32:47]
    s_waitcnt vmcnt(8)
    ds_read_b64_tr_b16 v[176:177], v244 offset:0
    ds_read_b64_tr_b16 v[178:179], v244 offset:1024
    ds_read_b64_tr_b16 v[180:181], v245 offset:0
    ds_read_b64_tr_b16 v[182:183], v245 offset:1024
    v_add_u32 v249, s48, v249
    v_add_u32 v250, s49, v250
    v_fmac_f32 v254, v22, v150
    v_fmac_f32 v254, v23, v151
    v_fma_f32 v202, v24, -v160, v202
    v_fma_f32 v202, v25, -v161, v202
    v_permlane32_swap_b32 v254, v200
    v_fma_f32 v202, v26, -v162, v202
    v_fma_f32 v202, v27, -v163, v202
    v_fma_f32 v202, v28, -v164, v202
    v_fma_f32 v202, v29, -v165, v202
    v_fma_f32 v202, v30, -v166, v202
    v_fma_f32 v202, v31, -v167, v202
    v_add_f32 v200, v254, v200
    v_mul_f32_e64 v198, v64, -v112
    v_permlane32_swap_b32 v202, v254
    v_fma_f32 v198, v65, -v113, v198
    v_fma_f32 v198, v66, -v114, v198
    v_fma_f32 v198, v67, -v115, v198
    v_fma_f32 v198, v68, -v116, v198
    v_fma_f32 v198, v69, -v117, v198
    v_fma_f32 v198, v70, -v118, v198
    v_fma_f32 v198, v71, -v119, v198
    v_add_f32 v254, v202, v254
    v_mul_f32 v196, v56, v160
    v_fmac_f32 v196, v57, v161
    v_fmac_f32 v196, v58, v162
    v_fmac_f32 v196, v59, v163
    v_fmac_f32 v196, v60, v164
    v_fmac_f32 v196, v61, v165
    v_fmac_f32 v196, v62, v166
    v_fmac_f32 v196, v63, v167
    s_nop 1
    v_permlane32_swap_b32 v198, v196
    v_add_f32 v196, v198, v196
    v_mul_f32 v255, v0, v152
    v_fmac_f32 v255, v1, v153
    v_fmac_f32 v255, v2, v154
    v_fmac_f32 v255, v3, v155
    v_fmac_f32 v255, v4, v156
    v_fmac_f32 v255, v5, v157
    v_fmac_f32 v255, v6, v158
    v_fmac_f32 v255, v7, v159
    v_fma_f32 v203, v8, -v168, v203
    v_fma_f32 v203, v9, -v169, v203
    v_permlane32_swap_b32 v255, v201
    v_fma_f32 v203, v10, -v170, v203
    v_fma_f32 v203, v11, -v171, v203
    v_fma_f32 v203, v12, -v172, v203
    v_fma_f32 v203, v13, -v173, v203
    v_fma_f32 v203, v14, -v174, v203
    v_fma_f32 v203, v15, -v175, v203
    v_add_f32 v201, v255, v201
    v_mul_f32_e64 v199, v40, -v120
    v_permlane32_swap_b32 v203, v255
    v_fma_f32 v199, v41, -v121, v199
    v_fma_f32 v199, v42, -v122, v199
    v_fma_f32 v199, v43, -v123, v199
    s_waitcnt vmcnt(2)
    ds_read_b64_tr_b16 v[72:73], v249 offset:0
    ds_read_b64_tr_b16 v[76:77], v249 offset:64
    ds_read_b64_tr_b16 v[74:75], v249 offset:256
    ds_read_b64_tr_b16 v[78:79], v249 offset:320
    s_mov_b64 exec, s[54:55]
    ds_read_u16_d16_hi v242, v250 offset:0
    s_mov_b64 exec, -1
    v_fma_f32 v199, v44, -v124, v199
    v_fma_f32 v199, v45, -v125, v199
    v_fma_f32 v199, v46, -v126, v199
    v_fma_f32 v199, v47, -v127, v199
    v_add_f32 v255, v203, v255
    v_mul_f32 v197, v32, v168
    v_fmac_f32 v197, v33, v169
    v_fmac_f32 v197, v34, v170
    v_fmac_f32 v197, v35, v171
    v_fmac_f32 v197, v36, v172
    v_fmac_f32 v197, v37, v173
    v_fmac_f32 v197, v38, v174
    v_fmac_f32 v197, v39, v175
    s_nop 1
    v_permlane32_swap_b32 v199, v197
    v_add_f32 v197, v199, v197
    s_set_gpr_idx_on s51, gpr_idx(DST)
    s_nop 0
    v_cvt_pk_bf16_f32 v207, v200, v201
    v_cvt_pk_bf16_f32 v209, v254, v255
    v_cvt_pk_bf16_f32 v208, v196, v197
    s_set_gpr_idx_off
    s_add_u32 s50, s50, 1
    s_add_u32 s51, s51, 6
    s_cmp_ge_u32 s50, 4
    s_cbranch_scc1 LAST0
    s_add_u32 s53, s53, 4
    s_xor_b32 s66, s53, s20
    s_bitcmp1_b32 s66, 2
    s_setprio 1
    s_cbranch_scc1 PRIO_10
    s_setprio 0
PRIO_10:
    s_cmp_eq_u32 s52, 4
    s_cbranch_scc1 ITEM_0_4
    s_cmp_eq_u32 s52, 5
    s_cbranch_scc1 ITEM_0_5
    s_cmp_eq_u32 s52, 3
    s_cbranch_scc1 ITEM_0_3
    s_cmp_eq_u32 s52, 6
    s_cbranch_scc1 ITEM_0_6
    s_cmp_eq_u32 s52, 8
    s_cbranch_scc1 ITEM_0_8
    s_branch ITEM_0_2
.p2align 6
ITEM_1_4:
    s_mov_b64 exec, s[54:55]
    ds_read_u16_d16_hi v243, v250 offset:128
    s_mov_b64 exec, -1
    ds_read_b64_tr_b16 v[80:81], v249 offset:512
    ds_read_b64_tr_b16 v[84:85], v249 offset:576
    ds_read_b64_tr_b16 v[82:83], v249 offset:768
    ds_read_b64_tr_b16 v[86:87], v249 offset:832
    s_waitcnt lgkmcnt(5)
    v_mul_f32_dpp v196, v242, v72 row_newbcast:0 row_mask:0xf bank_mask:0xf
    v_mul_f32_dpp v197, v242, v73 row_newbcast:1 row_mask:0xf bank_mask:0xf
    v_mul_f32_dpp v198, v242, v72 row_newbcast:8 row_mask:0xf bank_mask:0xf
    v_mul_f32_dpp v199, v242, v73 row_newbcast:9 row_mask:0xf bank_mask:0xf
    v_mul_f32_dpp v200, v242, v76 row_newbcast:2 row_mask:0xf bank_mask:0xf
    v_mul_f32_dpp v201, v242, v77 row_newbcast:3 row_mask:0xf bank_mask:0xf
    v_mul_f32_dpp v202, v242, v76 row_newbcast:10 row_mask:0xf bank_mask:0xf
    v_mul_f32_dpp v203, v242, v77 row_newbcast:11 row_mask:0xf bank_mask:0xf
    v_cvt_pk_bf16_f32 v72, v196, v197
    v_cvt_pk_bf16_f32 v76, v198, v199
    v_cvt_pk_bf16_f32 v73, v200, v201
    v_cvt_pk_bf16_f32 v77, v202, v203
    v_mul_f32_dpp v196, v242, v74 row_newbcast:4 row_mask:0xf bank_mask:0xf
    v_mul_f32_dpp v197, v242, v75 row_newbcast:5 row_mask:0xf bank_mask:0xf
    v_mul_f32_dpp v198, v242, v74 row_newbcast:12 row_mask:0xf bank_mask:0xf
    v_mul_f32_dpp v199, v242, v75 row_newbcast:13 row_mask:0xf bank_mask:0xf
    v_mul_f32_dpp v200, v242, v78 row_newbcast:6 row_mask:0xf bank_mask:0xf
    v_mul_f32_dpp v201, v242, v79 row_newbcast:7 row_mask:0xf bank_mask:0xf
    v_mul_f32_dpp v202, v242, v78 row_newbcast:14 row_mask:0xf bank_mask:0xf
    v_mul_f32_dpp v203, v242, v79 row_newbcast:15 row_mask:0xf bank_mask:0xf
    v_cvt_pk_bf16_f32 v74, v196, v197
    v_cvt_pk_bf16_f32 v78, v198, v199
    v_cvt_pk_bf16_f32 v75, v200, v201
    v_cvt_pk_bf16_f32 v79, v202, v203
    s_waitcnt vmcnt(4) lgkmcnt(0)
    v_mfma_f32_32x32x16_bf16 v[56:71], v[72:75], v[176:179], 0
    v_mul_f32_dpp v196, v243, v80 row_newbcast:0 row_mask:0xf bank_mask:0xf
    v_mul_f32_dpp v197, v243, v81 row_newbcast:1 row_mask:0xf bank_mask:0xf
    v_mul_f32_dpp v198, v243, v80 row_newbcast:8 row_mask:0xf bank_mask:0xf
    v_mul_f32_dpp v199, v243, v81 row_newbcast:9 row_mask:0xf bank_mask:0xf
    v_mul_f32_dpp v200, v243, v84 row_newbcast:2 row_mask:0xf bank_mask:0xf
    v_mul_f32_dpp v201, v243, v85 row_newbcast:3 row_mask:0xf bank_mask:0xf
    s_add_u32 m0, s21, 0
    v_mfma_f32_32x32x16_bf16 v[16:31], v[76:79], v[176:179], 0
    buffer_load_dwordx4 v234, s[4:7], s36 offen  lds
    buffer_load_dwordx4 v235, s[8:11], s36 offen offset:1024  lds
    ds_read_b64_tr_b16 v[176:177], v244 offset:2048
    ds_read_b64_tr_b16 v[178:179], v244 offset:3072
    ds_read_b64_tr_b16 v[184:185], v245 offset:2048
    ds_read_b64_tr_b16 v[186:187], v245 offset:3072
    v_mul_f32_dpp v202, v243, v84 row_newbcast:10 row_mask:0xf bank_mask:0xf
    v_mul_f32_dpp v203, v243, v85 row_newbcast:11 row_mask:0xf bank_mask:0xf
    v_cvt_pk_bf16_f32 v80, v196, v197
    v_cvt_pk_bf16_f32 v84, v198, v199
    v_cvt_pk_bf16_f32 v81, v200, v201
    v_cvt_pk_bf16_f32 v85, v202, v203
    v_mul_f32_dpp v196, v243, v82 row_newbcast:4 row_mask:0xf bank_mask:0xf
    v_mul_f32_dpp v197, v243, v83 row_newbcast:5 row_mask:0xf bank_mask:0xf
    v_mul_f32_dpp v198, v243, v82 row_newbcast:12 row_mask:0xf bank_mask:0xf
    v_mul_f32_dpp v199, v243, v83 row_newbcast:13 row_mask:0xf bank_mask:0xf
    v_mul_f32_dpp v200, v243, v86 row_newbcast:6 row_mask:0xf bank_mask:0xf
    v_mul_f32_dpp v201, v243, v87 row_newbcast:7 row_mask:0xf bank_mask:0xf
    v_mul_f32_dpp v202, v243, v86 row_newbcast:14 row_mask:0xf bank_mask:0xf
    v_mul_f32_dpp v203, v243, v87 row_newbcast:15 row_mask:0xf bank_mask:0xf
    v_cvt_pk_bf16_f32 v82, v196, v197
    v_cvt_pk_bf16_f32 v86, v198, v199
    v_cvt_pk_bf16_f32 v83, v200, v201
    v_cvt_pk_bf16_f32 v87, v202, v203
    s_waitcnt lgkmcnt(0)
    v_mfma_f32_32x32x16_bf16 v[56:71], v[80:83], v[176:179], v[56:71]
    s_add_u32 m0, s21, 2048
    v_mfma_f32_32x32x16_bf16 v[16:31], v[84:87], v[176:179], v[16:31]
    buffer_load_dwordx4 v236, s[4:7], s36 offen  lds
    buffer_load_dwordx4 v237, s[8:11], s36 offen offset:1024  lds
    s_mov_b32 m0, s50
    s_nop 0
    s_movrels_b32 s71, s23
    s_movrels_b32 s33, s28
    v_add_u32 v253, s33, v248
    s_bfe_u32 s46, s71, 0x30012
    s_mov_b32 m0, s46
    s_and_b32 s66, s71, 0x3ffff
    s_movrels_b32 s68, s57
    s_movrels_b32 s69, s61
    s_sub_u32 s48, s66, s47
    s_mov_b32 s47, s66
    s_lshr_b32 s52, s71, 28
    s_lshl_b32 s67, s46, 9
    s_add_u32 s66, s66, s67
    s_sub_u32 s49, s66, s42
    s_mov_b32 s42, s66
    s_bfe_u32 s66, s68, 655360
    s_add_u32 s43, s42, s66
    s_bfe_u32 s39, s69, 655360
    s_bfe_u32 s66, s68, 655370
    s_add_u32 s44, s42, s66
    s_bfe_u32 s40, s69, 655370
    s_bfe_u32 s66, s68, 655380
    s_add_u32 s45, s42, s66
    s_bfe_u32 s41, s69, 655380
    v_add_u32 v252, s44, v247
    ds_read2_b32 v[238:239], v252 offset0:0 offset1:16
    v_add_u32 v252, s45, v247
    ds_read2_b32 v[240:241], v252 offset0:0 offset1:16
    v_mfma_f32_32x32x16_bf16 v[32:47], v[72:75], v[180:183], 0
    v_mul_f32 v196, v56, v96
    v_fmac_f32 v196, v57, v97
    v_fmac_f32 v196, v58, v98
    v_fmac_f32 v196, v59, v99
    v_fmac_f32 v196, v60, v100
    v_fmac_f32 v196, v61, v101
    v_mfma_f32_32x32x16_bf16 v[0:15], v[76:79], v[180:183], 0
    s_waitcnt vmcnt(6)
    ds_read_b64_tr_b16 v[176:177], v244 offset:4096
    ds_read_b64_tr_b16 v[178:179], v244 offset:5120
    ds_read_b64_tr_b16 v[180:181], v245 offset:4096
    ds_read_b64_tr_b16 v[182:183], v245 offset:5120
    v_fmac_f32 v196, v62, v102
    v_fmac_f32 v196, v63, v103
    v_mfma_f32_32x32x16_bf16 v[32:47], v[80:83], v[184:187], v[32:47]
    v_mul_f32 v198, v64, v128
    v_fmac_f32 v198, v65, v129
    v_fmac_f32 v198, v66, v130
    v_fmac_f32 v198, v67, v131
    v_fmac_f32 v198, v68, v132
    v_fmac_f32 v198, v69, v133
    v_mfma_f32_32x32x16_bf16 v[0:15], v[84:87], v[184:187], v[0:15]
    v_fmac_f32 v198, v70, v134
    v_fmac_f32 v198, v71, v135
    v_mul_f32 v200, v16, v128
    v_fmac_f32 v200, v17, v129
    v_permlane32_swap_b32 v196, v198
    v_fmac_f32 v200, v18, v130
    v_fmac_f32 v200, v19, v131
    v_fmac_f32 v200, v20, v132
    v_fmac_f32 v200, v21, v133
    v_fmac_f32 v200, v22, v134
    v_fmac_f32 v200, v23, v135
    v_add_f32 v198, v196, v198
    v_mul_f32_e64 v202, v24, -v128
    v_fma_f32 v202, v25, -v129, v202
    v_fma_f32 v202, v26, -v130, v202
    v_fma_f32 v202, v27, -v131, v202
    v_fma_f32 v202, v28, -v132, v202
    v_fma_f32 v202, v29, -v133, v202
    v_fma_f32 v202, v30, -v134, v202
    v_fma_f32 v202, v31, -v135, v202
    s_nop 1
    v_permlane32_swap_b32 v200, v202
    v_add_f32 v202, v200, v202
    s_waitcnt vmcnt(4) lgkmcnt(0)
    v_mfma_f32_32x32x16_bf16 v[56:71], v[72:75], v[176:179], 0
    v_mul_f32 v197, v32, v104
    v_fmac_f32 v197, v33, v105
    v_fmac_f32 v197, v34, v106
    v_fmac_f32 v197, v35, v107
    v_fmac_f32 v197, v36, v108
    v_fmac_f32 v197, v37, v109
    s_add_u32 m0, s21, 4096
    v_mfma_f32_32x32x16_bf16 v[16:31], v[76:79], v[176:179], 0
    buffer_load_dwordx4 v234, s[4:7], s37 offen  lds
    buffer_load_dwordx4 v235, s[8:11], s37 offen offset:1024  lds
    ds_read_b64_tr_b16 v[176:177], v244 offset:6144
    ds_read_b64_tr_b16 v[178:179], v244 offset:7168
    ds_read_b64_tr_b16 v[184:185], v245 offset:6144
    ds_read_b64_tr_b16 v[186:187], v245 offset:7168
    v_add_u32 v252, s42, v247
    ds_read2_b32 v[234:235], v252 offset0:0 offset1:16
    v_fmac_f32 v197, v38, v110
    v_fmac_f32 v197, v39, v111
    v_mul_f32 v199, v40, v136
    v_fmac_f32 v199, v41, v137
    v_fmac_f32 v199, v42, v138
    v_fmac_f32 v199, v43, v139
    v_fmac_f32 v199, v44, v140
    v_fmac_f32 v199, v45, v141
    v_fmac_f32 v199, v46, v142
    v_fmac_f32 v199, v47, v143
    v_mul_f32 v201, v0, v136
    v_fmac_f32 v201, v1, v137
    v_permlane32_swap_b32 v197, v199
    v_fmac_f32 v201, v2, v138
    v_fmac_f32 v201, v3, v139
    v_fmac_f32 v201, v4, v140
    v_fmac_f32 v201, v5, v141
    v_fmac_f32 v201, v6, v142
    v_fmac_f32 v201, v7, v143
    v_add_f32 v199, v197, v199
    v_mul_f32_e64 v203, v8, -v136
    v_fma_f32 v203, v9, -v137, v203
    v_fma_f32 v203, v10, -v138, v203
    v_fma_f32 v203, v11, -v139, v203
    s_waitcnt lgkmcnt(1)
    v_mfma_f32_32x32x16_bf16 v[56:71], v[80:83], v[176:179], v[56:71]
    v_fma_f32 v203, v12, -v140, v203
    v_fma_f32 v203, v13, -v141, v203
    v_fma_f32 v203, v14, -v142, v203
    v_fma_f32 v203, v15, -v143, v203
    s_nop 1
    v_permlane32_swap_b32 v201, v203
    v_add_f32 v203, v201, v203
    s_add_u32 m0, s21, 6144
    v_mfma_f32_32x32x16_bf16 v[16:31], v[84:87], v[176:179], v[16:31]
    buffer_load_dwordx4 v236, s[4:7], s37 offen  lds
    buffer_load_dwordx4 v237, s[8:11], s37 offen offset:1024  lds
    v_add_u32 v252, s43, v247
    ds_read2_b32 v[236:237], v252 offset0:0 offset1:16
    v_cvt_pk_bf16_f32 v192, v198, v199
    v_cvt_pk_bf16_f32 v193, v202, v203
    v_mfma_f32_32x32x16_bf16 v[32:47], v[72:75], v[180:183], 0
    v_mul_f32 v196, v56, v144
    v_fmac_f32 v196, v57, v145
    v_fmac_f32 v196, v58, v146
    v_fmac_f32 v196, v59, v147
    v_fmac_f32 v196, v60, v148
    v_fmac_f32 v196, v61, v149
    v_mfma_f32_32x32x16_bf16 v[0:15], v[76:79], v[180:183], 0
    s_waitcnt vmcnt(6)
    ds_read_b64_tr_b16 v[176:177], v244 offset:0
    ds_read_b64_tr_b16 v[178:179], v244 offset:1024
    ds_read_b64_tr_b16 v[180:181], v245 offset:0
    ds_read_b64_tr_b16 v[182:183], v245 offset:1024
    v_fmac_f32 v196, v62, v150
    v_fmac_f32 v196, v63, v151
    v_mfma_f32_32x32x16_bf16 v[32:47], v[80:83], v[184:187], v[32:47]
    v_mul_f32_e64 v200, v16, -v160
    v_fma_f32 v200, v17, -v161, v200
    v_fma_f32 v200, v18, -v162, v200
    v_fma_f32 v200, v19, -v163, v200
    v_fma_f32 v200, v20, -v164, v200
    v_fma_f32 v200, v21, -v165, v200
    v_mfma_f32_32x32x16_bf16 v[0:15], v[84:87], v[184:187], v[0:15]
    v_fma_f32 v200, v22, -v166, v200
    v_fma_f32 v200, v23, -v167, v200
    v_mul_f32_e64 v202, v24, -v160
    v_fma_f32 v202, v25, -v161, v202
    v_fma_f32 v202, v26, -v162, v202
    v_fma_f32 v202, v27, -v163, v202
    v_fma_f32 v202, v28, -v164, v202
    v_fma_f32 v202, v29, -v165, v202
    v_fma_f32 v202, v30, -v166, v202
    v_fma_f32 v202, v31, -v167, v202
    s_waitcnt vmcnt(4) lgkmcnt(0)
    v_mfma_f32_32x32x16_bf16 v[16:31], v[72:75], v[176:179], 0
    v_mul_f32 v197, v32, v152
    v_fmac_f32 v197, v33, v153
    v_fmac_f32 v197, v34, v154
    v_fmac_f32 v197, v35, v155
    v_fmac_f32 v197, v36, v156
    v_fmac_f32 v197, v37, v157
    s_add_u32 m0, s21, 0
    v_mfma_f32_32x32x16_bf16 v[48:63], v[76:79], v[176:179], 0
    s_cbranch_vccnz WL_4_0
    v_mad_u32_u16 v234, v234, s3, v246 op_sel:[1,0,0,0]
    v_mad_u32_u16 v235, v235, s3, v246 op_sel:[1,0,0,0]
    buffer_load_dwordx4 v234, s[4:7], s38 offen  lds
    buffer_load_dwordx4 v235, s[8:11], s38 offen offset:1024  lds
WR_4_0:
    ds_read_b64_tr_b16 v[176:177], v244 offset:2048
    ds_read_b64_tr_b16 v[178:179], v244 offset:3072
    ds_read_b64_tr_b16 v[184:185], v245 offset:2048
    ds_read_b64_tr_b16 v[186:187], v245 offset:3072
    v_fmac_f32 v197, v38, v158
    v_fmac_f32 v197, v39, v159
    v_mul_f32_e64 v201, v0, -v168
    v_fma_f32 v201, v1, -v169, v201
    v_fma_f32 v201, v2, -v170, v201
    v_fma_f32 v201, v3, -v171, v201
    v_fma_f32 v201, v4, -v172, v201
    v_fma_f32 v201, v5, -v173, v201
    v_fma_f32 v201, v6, -v174, v201
    v_fma_f32 v201, v7, -v175, v201
    s_waitcnt lgkmcnt(0)
    v_mfma_f32_32x32x16_bf16 v[16:31], v[80:83], v[176:179], v[16:31]
    v_mul_f32_e64 v203, v8, -v168
    v_fma_f32 v203, v9, -v169, v203
    v_fma_f32 v203, v10, -v170, v203
    v_fma_f32 v203, v11, -v171, v203
    v_fma_f32 v203, v12, -v172, v203
    v_fma_f32 v203, v13, -v173, v203
    s_add_u32 m0, s21, 2048
    v_mfma_f32_32x32x16_bf16 v[48:63], v[84:87], v[176:179], v[48:63]
    s_cbranch_vccnz WL_4_1
    v_mad_u32_u16 v236, v236, s3, v246 op_sel:[1,0,0,0]
    v_mad_u32_u16 v237, v237, s3, v246 op_sel:[1,0,0,0]
    buffer_load_dwordx4 v236, s[4:7], s39 offen  lds
    buffer_load_dwordx4 v237, s[8:11], s39 offen offset:1024  lds
WR_4_1:
    v_fma_f32 v203, v14, -v174, v203
    v_fma_f32 v203, v15, -v175, v203
    v_mfma_f32_32x32x16_bf16 v[0:15], v[72:75], v[180:183], 0
    v_fmac_f32 v200, v24, v160
    v_fmac_f32 v200, v25, v161
    v_fmac_f32 v200, v26, v162
    v_fmac_f32 v200, v27, v163
    v_fmac_f32 v200, v28, v164
    v_fmac_f32 v200, v29, v165
    v_fmac_f32 v200, v30, v166
    v_fmac_f32 v200, v31, v167
    v_mfma_f32_32x32x16_bf16 v[24:39], v[76:79], v[180:183], 0
    s_waitcnt vmcnt(6)
    ds_read_b64_tr_b16 v[176:177], v244 offset:4096
    ds_read_b64_tr_b16 v[178:179], v244 offset:5120
    ds_read_b64_tr_b16 v[180:181], v245 offset:4096
    ds_read_b64_tr_b16 v[182:183], v245 offset:5120
    v_mul_f32 v254, v16, v144
    v_fmac_f32 v254, v17, v145
    v_mfma_f32_32x32x16_bf16 v[24:39], v[84:87], v[184:187], v[24:39]
    v_fmac_f32 v254, v18, v146
    v_fmac_f32 v254, v19, v147
    v_fmac_f32 v254, v20, v148
    v_fmac_f32 v254, v21, v149
    v_fmac_f32 v254, v22, v150
    v_fmac_f32 v254, v23, v151
    v_mfma_f32_32x32x16_bf16 v[0:15], v[80:83], v[184:187], v[0:15]
    v_sub_f32_e64 v64, -v48, v64
    v_sub_f32_e64 v65, -v49, v65
    v_permlane32_swap_b32 v196, v254
    v_sub_f32_e64 v66, -v50, v66
    v_sub_f32_e64 v67, -v51, v67
    v_sub_f32_e64 v68, -v52, v68
    v_sub_f32_e64 v69, -v53, v69
    v_sub_f32_e64 v70, -v54, v70
    v_sub_f32_e64 v71, -v55, v71
    v_add_f32 v254, v196, v254
    s_waitcnt vmcnt(4) lgkmcnt(0)
    v_mfma_f32_32x32x16_bf16 v[56:71], v[76:79], v[176:179], v[56:71]
    v_sub_f32_e64 v40, -v24, v40
    v_sub_f32_e64 v41, -v25, v41
    v_sub_f32_e64 v42, -v26, v42
    v_sub_f32_e64 v43, -v27, v43
    v_sub_f32_e64 v44, -v28, v44
    v_sub_f32_e64 v45, -v29, v45
    v_sub_f32_e64 v46, -v30, v46
    v_sub_f32_e64 v47, -v31, v47
    s_add_u32 m0, s21, 4096
    v_mfma_f32_32x32x16_bf16 v[16:31], v[72:75], v[176:179], 0
    s_cbranch_vccnz WL_4_2
    v_mad_u32_u16 v238, v238, s3, v246 op_sel:[1,0,0,0]
    v_mad_u32_u16 v239, v239, s3, v246 op_sel:[1,0,0,0]
    buffer_load_dwordx4 v238, s[4:7], s40 offen  lds
    buffer_load_dwordx4 v239, s[8:11], s40 offen offset:1024  lds
WR_4_2:
    ds_read_b64_tr_b16 v[176:177], v244 offset:6144
    ds_read_b64_tr_b16 v[178:179], v244 offset:7168
    ds_read_b64_tr_b16 v[184:185], v245 offset:6144
    ds_read_b64_tr_b16 v[186:187], v245 offset:7168
    v_mul_f32 v255, v0, v152
    v_fmac_f32 v255, v1, v153
    v_fmac_f32 v255, v2, v154
    v_fmac_f32 v255, v3, v155
    v_fmac_f32 v255, v4, v156
    v_fmac_f32 v255, v5, v157
    v_fmac_f32 v255, v6, v158
    v_fmac_f32 v255, v7, v159
    v_fmac_f32 v201, v8, v168
    v_fmac_f32 v201, v9, v169
    v_permlane32_swap_b32 v197, v255
    s_waitcnt lgkmcnt(0)
    v_mfma_f32_32x32x16_bf16 v[16:31], v[80:83], v[176:179], v[16:31]
    v_fmac_f32 v201, v10, v170
    v_fmac_f32 v201, v11, v171
    v_fmac_f32 v201, v12, v172
    v_fmac_f32 v201, v13, v173
    v_fmac_f32 v201, v14, v174
    v_fmac_f32 v201, v15, v175
    s_add_u32 m0, s21, 6144
    v_mfma_f32_32x32x16_bf16 v[56:71], v[84:87], v[176:179], v[56:71]
    s_cbranch_vccnz WL_4_3
    v_mad_u32_u16 v240, v240, s3, v246 op_sel:[1,0,0,0]
    v_mad_u32_u16 v241, v241, s3, v246 op_sel:[1,0,0,0]
    buffer_load_dwordx4 v240, s[4:7], s41 offen  lds
    buffer_load_dwordx4 v241, s[8:11], s41 offen offset:1024  lds
WR_4_3:
    v_add_f32 v255, v197, v255
    v_cvt_pk_bf16_f32 v194, v254, v255
    v_mfma_f32_32x32x16_bf16 v[0:15], v[72:75], v[180:183], 0
    v_mul_f32 v254, v16, v144
    v_fmac_f32 v254, v17, v145
    v_fmac_f32 v254, v18, v146
    v_fmac_f32 v254, v19, v147
    v_fmac_f32 v254, v20, v148
    v_fmac_f32 v254, v21, v149
    v_mfma_f32_32x32x16_bf16 v[32:47], v[76:79], v[180:183], v[32:47]
    s_waitcnt vmcnt(6)
    ds_read_b64_tr_b16 v[176:177], v244 offset:0
    ds_read_b64_tr_b16 v[178:179], v244 offset:1024
    ds_read_b64_tr_b16 v[180:181], v245 offset:0
    ds_read_b64_tr_b16 v[182:183], v245 offset:1024
    v_fmac_f32 v254, v22, v150
    v_fmac_f32 v254, v23, v151
    v_mfma_f32_32x32x16_bf16 v[0:15], v[80:83], v[184:187], v[0:15]
    v_fma_f32 v202, v24, -v160, v202
    v_fma_f32 v202, v25, -v161, v202
    v_permlane32_swap_b32 v254, v200
    v_fma_f32 v202, v26, -v162, v202
    v_fma_f32 v202, v27, -v163, v202
    v_fma_f32 v202, v28, -v164, v202
    v_mfma_f32_32x32x16_bf16 v[32:47], v[84:87], v[184:187], v[32:47]
    v_add_u32 v249, s48, v249
    v_add_u32 v250, s49, v250
    ds_read_b32 v252, v251 offset:16
    ds_read_b64_tr_b16 v[72:73], v249 offset:0
    ds_read_b64_tr_b16 v[76:77], v249 offset:64
    ds_read_b64_tr_b16 v[74:75], v249 offset:256
    ds_read_b64_tr_b16 v[78:79], v249 offset:320
    s_mov_b64 exec, s[54:55]
    ds_read_u16_d16_hi v242, v250 offset:0
    s_mov_b64 exec, -1
    v_fma_f32 v202, v29, -v165, v202
    v_fma_f32 v202, v30, -v166, v202
    v_fma_f32 v202, v31, -v167, v202
    v_add_f32 v200, v254, v200
    v_mul_f32_e64 v198, v64, -v112
    v_permlane32_swap_b32 v202, v254
    v_fma_f32 v198, v65, -v113, v198
    v_fma_f32 v198, v66, -v114, v198
    v_fma_f32 v198, v67, -v115, v198
    v_fma_f32 v198, v68, -v116, v198
    v_fma_f32 v198, v69, -v117, v198
    v_fma_f32 v198, v70, -v118, v198
    v_fma_f32 v198, v71, -v119, v198
    v_add_f32 v254, v202, v254
    v_mul_f32 v196, v56, v160
    v_fmac_f32 v196, v57, v161
    v_fmac_f32 v196, v58, v162
    v_fmac_f32 v196, v59, v163
    v_fmac_f32 v196, v60, v164
    v_fmac_f32 v196, v61, v165
    v_fmac_f32 v196, v62, v166
    v_fmac_f32 v196, v63, v167
    s_nop 1
    v_permlane32_swap_b32 v198, v196
    v_add_f32 v196, v198, v196
    s_cbranch_vccnz LEPI_0
    v_mul_f32 v255, v0, v152
    v_fmac_f32 v255, v1, v153
    v_fmac_f32 v255, v2, v154
    v_fmac_f32 v255, v3, v155
    v_fmac_f32 v255, v4, v156
    v_fmac_f32 v255, v5, v157
    v_fmac_f32 v255, v6, v158
    v_fmac_f32 v255, v7, v159
    v_fma_f32 v203, v8, -v168, v203
    v_fma_f32 v203, v9, -v169, v203
    v_permlane32_swap_b32 v255, v201
    v_fma_f32 v203, v10, -v170, v203
    v_fma_f32 v203, v11, -v171, v203
    v_fma_f32 v203, v12, -v172, v203
    v_fma_f32 v203, v13, -v173, v203
    v_fma_f32 v203, v14, -v174, v203
    v_fma_f32 v203, v15, -v175, v203
    v_add_f32 v201, v255, v201
    v_mul_f32_e64 v199, v40, -v120
    v_permlane32_swap_b32 v203, v255
    v_fma_f32 v199, v41, -v121, v199
    v_fma_f32 v199, v42, -v122, v199
    v_fma_f32 v199, v43, -v123, v199
    v_fma_f32 v199, v44, -v124, v199
    v_fma_f32 v199, v45, -v125, v199
    v_fma_f32 v199, v46, -v126, v199
    v_fma_f32 v199, v47, -v127, v199
    v_add_f32 v255, v203, v255
    v_mul_f32 v197, v32, v168
    v_fmac_f32 v197, v33, v169
    v_fmac_f32 v197, v34, v170
    v_fmac_f32 v197, v35, v171
    v_fmac_f32 v197, v36, v172
    v_fmac_f32 v197, v37, v173
    v_fmac_f32 v197, v38, v174
    v_fmac_f32 v197, v39, v175
    s_nop 1
    v_permlane32_swap_b32 v199, v197
    v_add_f32 v197, v199, v197
    v_cvt_pk_bf16_f32 v200, v200, v201
    v_cvt_pk_bf16_f32 v254, v254, v255
    v_cvt_pk_bf16_f32 v196, v196, v197
    ds_write2st64_b32 v253, v192, v193 offset0:0 offset1:1
    ds_write2st64_b32 v253, v194, v200 offset0:2 offset1:3
    ds_write_b32 v253, v196 offset:1024
    s_mov_b64 exec, 0xffffffff
    ds_write_b32 v253, v254 offset:1280
    s_mov_b64 exec, -1
    s_add_u32 s50, s50, 1
    s_cmp_ge_u32 s50, 4
    s_cbranch_scc1 LAST1
    s_waitcnt lgkmcnt(9)
    v_readfirstlane_b32 s66, v252
    s_add_u32 s53, s53, 1
    v_mov_b32 v252, s53
    s_cmp_le_u32 s53, s66
    ds_write2_b32 v251, v252, v252 offset0:0 offset1:8
    s_setprio 1
    s_cbranch_scc1 PRIO_11
    s_setprio 0
PRIO_11:
    s_cmp_eq_u32 s52, 4
    s_cbranch_scc1 ITEM_1_4
    s_cmp_eq_u32 s52, 5
    s_cbranch_scc1 ITEM_1_5
    s_cmp_eq_u32 s52, 3
    s_cbranch_scc1 ITEM_1_3
    s_cmp_eq_u32 s52, 6
    s_cbranch_scc1 ITEM_1_6
    s_cmp_eq_u32 s52, 8
    s_cbranch_scc1 ITEM_1_8
    s_branch ITEM_1_2
WL_4_0:
    s_add_u32 s66, s51, 0
    buffer_load_dwordx4 v[96:99], v246, s[16:19], s66 offen offset:2048 sc1
    buffer_load_dwordx4 v[100:103], v246, s[16:19], s66 offen offset:3072 sc1
    s_branch WR_4_0
WL_4_1:
    s_add_u32 s66, s51, 4096
    buffer_load_dwordx4 v[104:107], v246, s[16:19], s66 offen offset:2048 sc1
    buffer_load_dwordx4 v[108:111], v246, s[16:19], s66 offen offset:3072 sc1
    s_branch WR_4_1
WL_4_2:
    s_add_u32 s66, s51, 8192
    buffer_load_dwordx4 v[128:131], v246, s[16:19], s66 offen offset:2048 sc1
    buffer_load_dwordx4 v[132:135], v246, s[16:19], s66 offen offset:3072 sc1
    s_branch WR_4_2
WL_4_3:
    s_add_u32 s66, s51, 12288
    buffer_load_dwordx4 v[136:139], v246, s[16:19], s66 offen offset:2048 sc1
    buffer_load_dwordx4 v[140:143], v246, s[16:19], s66 offen offset:3072 sc1
    s_branch WR_4_3
.p2align 6
ITEM_1_5:
    s_mov_b64 exec, s[54:55]
    ds_read_u16_d16_hi v243, v250 offset:128
    s_mov_b64 exec, -1
    ds_read_b64_tr_b16 v[80:81], v249 offset:512
    ds_read_b64_tr_b16 v[84:85], v249 offset:576
    ds_read_b64_tr_b16 v[82:83], v249 offset:768
    ds_read_b64_tr_b16 v[86:87], v249 offset:832
    ds_read_b64_tr_b16 v[88:89], v249 offset:1024
    ds_read_b64_tr_b16 v[92:93], v249 offset:1088
    s_waitcnt lgkmcnt(7)
    v_mul_f32_dpp v196, v242, v72 row_newbcast:0 row_mask:0xf bank_mask:0xf
    v_mul_f32_dpp v197, v242, v73 row_newbcast:1 row_mask:0xf bank_mask:0xf
    v_mul_f32_dpp v198, v242, v72 row_newbcast:8 row_mask:0xf bank_mask:0xf
    v_mul_f32_dpp v199, v242, v73 row_newbcast:9 row_mask:0xf bank_mask:0xf
    v_mul_f32_dpp v200, v242, v76 row_newbcast:2 row_mask:0xf bank_mask:0xf
    v_mul_f32_dpp v201, v242, v77 row_newbcast:3 row_mask:0xf bank_mask:0xf
    v_mul_f32_dpp v202, v242, v76 row_newbcast:10 row_mask:0xf bank_mask:0xf
    v_mul_f32_dpp v203, v242, v77 row_newbcast:11 row_mask:0xf bank_mask:0xf
    v_cvt_pk_bf16_f32 v72, v196, v197
    v_cvt_pk_bf16_f32 v76, v198, v199
    v_cvt_pk_bf16_f32 v73, v200, v201
    v_cvt_pk_bf16_f32 v77, v202, v203
    v_mul_f32_dpp v196, v242, v74 row_newbcast:4 row_mask:0xf bank_mask:0xf
    v_mul_f32_dpp v197, v242, v75 row_newbcast:5 row_mask:0xf bank_mask:0xf
    v_mul_f32_dpp v198, v242, v74 row_newbcast:12 row_mask:0xf bank_mask:0xf
    v_mul_f32_dpp v199, v242, v75 row_newbcast:13 row_mask:0xf bank_mask:0xf
    v_mul_f32_dpp v200, v242, v78 row_newbcast:6 row_mask:0xf bank_mask:0xf
    v_mul_f32_dpp v201, v242, v79 row_newbcast:7 row_mask:0xf bank_mask:0xf
    v_mul_f32_dpp v202, v242, v78 row_newbcast:14 row_mask:0xf bank_mask:0xf
    v_mul_f32_dpp v203, v242, v79 row_newbcast:15 row_mask:0xf bank_mask:0xf
    v_cvt_pk_bf16_f32 v74, v196, v197
    v_cvt_pk_bf16_f32 v78, v198, v199
    v_cvt_pk_bf16_f32 v75, v200, v201
    v_cvt_pk_bf16_f32 v79, v202, v203
    s_mov_b64 exec, s[54:55]
    ds_read_u16_d16_hi v242, v250 offset:256
    s_mov_b64 exec, -1
    s_waitcnt vmcnt(4) lgkmcnt(3)
    v_mfma_f32_32x32x16_bf16 v[56:71], v[72:75], v[176:179], 0
    v_mul_f32_dpp v196, v243, v80 row_newbcast:0 row_mask:0xf bank_mask:0xf
    v_mul_f32_dpp v197, v243, v81 row_newbcast:1 row_mask:0xf bank_mask:0xf
    v_mul_f32_dpp v198, v243, v80 row_newbcast:8 row_mask:0xf bank_mask:0xf
    v_mul_f32_dpp v199, v243, v81 row_newbcast:9 row_mask:0xf bank_mask:0xf
    v_mul_f32_dpp v200, v243, v84 row_newbcast:2 row_mask:0xf bank_mask:0xf
    v_mul_f32_dpp v201, v243, v85 row_newbcast:3 row_mask:0xf bank_mask:0xf
    s_add_u32 m0, s21, 0
    v_mfma_f32_32x32x16_bf16 v[16:31], v[76:79], v[176:179], 0
    buffer_load_dwordx4 v236, s[4:7], s35 offen  lds
    buffer_load_dwordx4 v237, s[8:11], s35 offen offset:1024  lds
    ds_read_b64_tr_b16 v[176:177], v244 offset:2048
    ds_read_b64_tr_b16 v[178:179], v244 offset:3072
    ds_read_b64_tr_b16 v[184:185], v245 offset:2048
    ds_read_b64_tr_b16 v[186:187], v245 offset:3072
    v_mul_f32_dpp v202, v243, v84 row_newbcast:10 row_mask:0xf bank_mask:0xf
    v_mul_f32_dpp v203, v243, v85 row_newbcast:11 row_mask:0xf bank_mask:0xf
    v_cvt_pk_bf16_f32 v80, v196, v197
    v_cvt_pk_bf16_f32 v84, v198, v199
    v_cvt_pk_bf16_f32 v81, v200, v201
    v_cvt_pk_bf16_f32 v85, v202, v203
    v_mul_f32_dpp v196, v243, v82 row_newbcast:4 row_mask:0xf bank_mask:0xf
    v_mul_f32_dpp v197, v243, v83 row_newbcast:5 row_mask:0xf bank_mask:0xf
    v_mul_f32_dpp v198, v243, v82 row_newbcast:12 row_mask:0xf bank_mask:0xf
    v_mul_f32_dpp v199, v243, v83 row_newbcast:13 row_mask:0xf bank_mask:0xf
    v_mul_f32_dpp v200, v243, v86 row_newbcast:6 row_mask:0xf bank_mask:0xf
    v_mul_f32_dpp v201, v243, v87 row_newbcast:7 row_mask:0xf bank_mask:0xf
    v_mul_f32_dpp v202, v243, v86 row_newbcast:14 row_mask:0xf bank_mask:0xf
    v_mul_f32_dpp v203, v243, v87 row_newbcast:15 row_mask:0xf bank_mask:0xf
    v_cvt_pk_bf16_f32 v82, v196, v197
    v_cvt_pk_bf16_f32 v86, v198, v199
    v_cvt_pk_bf16_f32 v83, v200, v201
    v_cvt_pk_bf16_f32 v87, v202, v203
    s_waitcnt vmcnt(4) lgkmcnt(0)
    v_mfma_f32_32x32x16_bf16 v[56:71], v[80:83], v[176:179], v[56:71]
    v_mul_f32_dpp v196, v242, v88 row_newbcast:0 row_mask:0xf bank_mask:0xf
    v_mul_f32_dpp v197, v242, v89 row_newbcast:1 row_mask:0xf bank_mask:0xf
    v_mul_f32_dpp v198, v242, v88 row_newbcast:8 row_mask:0xf bank_mask:0xf
    v_mul_f32_dpp v199, v242, v89 row_newbcast:9 row_mask:0xf bank_mask:0xf
    v_mul_f32_dpp v200, v242, v92 row_newbcast:2 row_mask:0xf bank_mask:0xf
    v_mul_f32_dpp v201, v242, v93 row_newbcast:3 row_mask:0xf bank_mask:0xf
    s_add_u32 m0, s21, 2048
    v_mfma_f32_32x32x16_bf16 v[16:31], v[84:87], v[176:179], v[16:31]
    buffer_load_dwordx4 v238, s[4:7], s35 offen  lds
    ds_read_b64_tr_b16 v[176:177], v244 offset:4096
    ds_read_b64_tr_b16 v[188:189], v245 offset:4096
    v_mul_f32_dpp v202, v242, v92 row_newbcast:10 row_mask:0xf bank_mask:0xf
    v_mul_f32_dpp v203, v242, v93 row_newbcast:11 row_mask:0xf bank_mask:0xf
    v_cvt_pk_bf16_f32 v88, v196, v197
    v_cvt_pk_bf16_f32 v92, v198, v199
    v_cvt_pk_bf16_f32 v89, v200, v201
    v_cvt_pk_bf16_f32 v93, v202, v203
    s_waitcnt lgkmcnt(0)
    v_mfma_f32_32x32x8_bf16 v[56:71], v[88:89], v[176:177], v[56:71]
    s_add_u32 m0, s21, 4096
    v_mfma_f32_32x32x8_bf16 v[16:31], v[92:93], v[176:177], v[16:31]
    buffer_load_dwordx4 v234, s[4:7], s36 offen  lds
    buffer_load_dwordx4 v235, s[8:11], s36 offen offset:1024  lds
    s_mov_b32 m0, s50
    s_nop 0
    s_movrels_b32 s71, s23
    s_movrels_b32 s33, s28
    v_add_u32 v253, s33, v248
    s_bfe_u32 s46, s71, 0x30012
    s_mov_b32 m0, s46
    s_and_b32 s66, s71, 0x3ffff
    s_movrels_b32 s68, s57
    s_movrels_b32 s69, s61
    s_sub_u32 s48, s66, s47
    s_mov_b32 s47, s66
    s_lshr_b32 s52, s71, 28
    s_lshl_b32 s67, s46, 9
    s_add_u32 s66, s66, s67
    s_sub_u32 s49, s66, s42
    s_mov_b32 s42, s66
    s_bfe_u32 s66, s68, 655360
    s_add_u32 s43, s42, s66
    s_bfe_u32 s39, s69, 655360
    s_bfe_u32 s66, s68, 655370
    s_add_u32 s44, s42, s66
    s_bfe_u32 s40, s69, 655370
    s_bfe_u32 s66, s68, 655380
    s_add_u32 s45, s42, s66
    s_bfe_u32 s41, s69, 655380
    v_add_u32 v252, s45, v247
    ds_read2_b32 v[240:241], v252 offset0:0 offset1:16
    v_mfma_f32_32x32x16_bf16 v[32:47], v[72:75], v[180:183], 0
    v_mul_f32 v196, v56, v96
    v_fmac_f32 v196, v57, v97
    v_fmac_f32 v196, v58, v98
    v_fmac_f32 v196, v59, v99
    v_fmac_f32 v196, v60, v100
    v_fmac_f32 v196, v61, v101
    v_mfma_f32_32x32x16_bf16 v[0:15], v[76:79], v[180:183], 0
    v_fmac_f32 v196, v62, v102
    v_fmac_f32 v196, v63, v103
    v_mul_f32 v198, v64, v128
    v_fmac_f32 v198, v65, v129
    v_fmac_f32 v198, v66, v130
    v_fmac_f32 v198, v67, v131
    v_mfma_f32_32x32x16_bf16 v[32:47], v[80:83], v[184:187], v[32:47]
    v_fmac_f32 v198, v68, v132
    v_fmac_f32 v198, v69, v133
    v_fmac_f32 v198, v70, v134
    v_fmac_f32 v198, v71, v135
    v_mul_f32 v200, v16, v128
    v_fmac_f32 v200, v17, v129
    v_mfma_f32_32x32x16_bf16 v[0:15], v[84:87], v[184:187], v[0:15]
    s_waitcnt vmcnt(5)
    ds_read_b64_tr_b16 v[176:177], v244 offset:6144
    ds_read_b64_tr_b16 v[178:179], v244 offset:7168
    ds_read_b64_tr_b16 v[180:181], v245 offset:6144
    ds_read_b64_tr_b16 v[182:183], v245 offset:7168
    v_permlane32_swap_b32 v196, v198
    v_fmac_f32 v200, v18, v130
    v_mfma_f32_32x32x8_bf16 v[32:47], v[88:89], v[188:189], v[32:47]
    v_fmac_f32 v200, v19, v131
    v_fmac_f32 v200, v20, v132
    v_fmac_f32 v200, v21, v133
    v_fmac_f32 v200, v22, v134
    v_fmac_f32 v200, v23, v135
    v_add_f32 v198, v196, v198
    v_mfma_f32_32x32x8_bf16 v[0:15], v[92:93], v[188:189], v[0:15]
    v_mul_f32_e64 v202, v24, -v128
    v_fma_f32 v202, v25, -v129, v202
    v_fma_f32 v202, v26, -v130, v202
    v_fma_f32 v202, v27, -v131, v202
    v_fma_f32 v202, v28, -v132, v202
    v_fma_f32 v202, v29, -v133, v202
    v_fma_f32 v202, v30, -v134, v202
    v_fma_f32 v202, v31, -v135, v202
    s_nop 1
    v_permlane32_swap_b32 v200, v202
    v_add_f32 v202, v200, v202
    s_waitcnt vmcnt(3) lgkmcnt(0)
    v_mfma_f32_32x32x16_bf16 v[56:71], v[72:75], v[176:179], 0
    v_mul_f32 v197, v32, v104
    v_fmac_f32 v197, v33, v105
    v_fmac_f32 v197, v34, v106
    v_fmac_f32 v197, v35, v107
    v_fmac_f32 v197, v36, v108
    v_fmac_f32 v197, v37, v109
    s_add_u32 m0, s21, 6144
    v_mfma_f32_32x32x16_bf16 v[16:31], v[76:79], v[176:179], 0
    buffer_load_dwordx4 v236, s[4:7], s36 offen  lds
    buffer_load_dwordx4 v237, s[8:11], s36 offen offset:1024  lds
    ds_read_b64_tr_b16 v[176:177], v244 offset:0
    ds_read_b64_tr_b16 v[178:179], v244 offset:1024
    ds_read_b64_tr_b16 v[184:185], v245 offset:0
    ds_read_b64_tr_b16 v[186:187], v245 offset:1024
    v_fmac_f32 v197, v38, v110
    v_fmac_f32 v197, v39, v111
    v_mul_f32 v199, v40, v136
    v_fmac_f32 v199, v41, v137
    v_fmac_f32 v199, v42, v138
    v_fmac_f32 v199, v43, v139
    v_fmac_f32 v199, v44, v140
    v_fmac_f32 v199, v45, v141
    v_fmac_f32 v199, v46, v142
    v_fmac_f32 v199, v47, v143
    v_mul_f32 v201, v0, v136
    v_fmac_f32 v201, v1, v137
    v_permlane32_swap_b32 v197, v199
    v_fmac_f32 v201, v2, v138
    v_fmac_f32 v201, v3, v139
    s_waitcnt vmcnt(4) lgkmcnt(0)
    v_mfma_f32_32x32x16_bf16 v[56:71], v[80:83], v[176:179], v[56:71]
    v_fmac_f32 v201, v4, v140
    v_fmac_f32 v201, v5, v141
    v_fmac_f32 v201, v6, v142
    v_fmac_f32 v201, v7, v143
    v_add_f32 v199, v197, v199
    v_mul_f32_e64 v203, v8, -v136
    s_add_u32 m0, s21, 0
    v_mfma_f32_32x32x16_bf16 v[16:31], v[84:87], v[176:179], v[16:31]
    buffer_load_dwordx4 v238, s[4:7], s36 offen  lds
    ds_read_b64_tr_b16 v[176:177], v244 offset:2048
    ds_read_b64_tr_b16 v[188:189], v245 offset:2048
    v_fma_f32 v203, v9, -v137, v203
    v_fma_f32 v203, v10, -v138, v203
    v_fma_f32 v203, v11, -v139, v203
    s_waitcnt lgkmcnt(0)
    v_mfma_f32_32x32x8_bf16 v[56:71], v[88:89], v[176:177], v[56:71]
    v_fma_f32 v203, v12, -v140, v203
    v_fma_f32 v203, v13, -v141, v203
    v_fma_f32 v203, v14, -v142, v203
    v_fma_f32 v203, v15, -v143, v203
    s_nop 1
    v_permlane32_swap_b32 v201, v203
    v_add_f32 v203, v201, v203
    s_add_u32 m0, s21, 2048
    v_mfma_f32_32x32x8_bf16 v[16:31], v[92:93], v[176:177], v[16:31]
    buffer_load_dwordx4 v234, s[4:7], s37 offen  lds
    buffer_load_dwordx4 v235, s[8:11], s37 offen offset:1024  lds
    v_add_u32 v252, s42, v247
    ds_read2_b32 v[234:235], v252 offset0:0 offset1:16
    v_cvt_pk_bf16_f32 v192, v198, v199
    v_cvt_pk_bf16_f32 v193, v202, v203
    v_mfma_f32_32x32x16_bf16 v[32:47], v[72:75], v[180:183], 0
    v_mul_f32 v196, v56, v144
    v_fmac_f32 v196, v57, v145
    v_fmac_f32 v196, v58, v146
    v_fmac_f32 v196, v59, v147
    v_fmac_f32 v196, v60, v148
    v_fmac_f32 v196, v61, v149
    v_mfma_f32_32x32x16_bf16 v[0:15], v[76:79], v[180:183], 0
    v_fmac_f32 v196, v62, v150
    v_fmac_f32 v196, v63, v151
    v_mul_f32_e64 v200, v16, -v160
    v_fma_f32 v200, v17, -v161, v200
    v_fma_f32 v200, v18, -v162, v200
    v_fma_f32 v200, v19, -v163, v200
    v_mfma_f32_32x32x16_bf16 v[32:47], v[80:83], v[184:187], v[32:47]
    v_fma_f32 v200, v20, -v164, v200
    v_fma_f32 v200, v21, -v165, v200
    v_fma_f32 v200, v22, -v166, v200
    v_fma_f32 v200, v23, -v167, v200
    v_mul_f32_e64 v202, v24, -v160
    v_fma_f32 v202, v25, -v161, v202
    v_mfma_f32_32x32x16_bf16 v[0:15], v[84:87], v[184:187], v[0:15]
    s_waitcnt vmcnt(5)
    ds_read_b64_tr_b16 v[176:177], v244 offset:4096
    ds_read_b64_tr_b16 v[178:179], v244 offset:5120
    ds_read_b64_tr_b16 v[180:181], v245 offset:4096
    ds_read_b64_tr_b16 v[182:183], v245 offset:5120
    v_fma_f32 v202, v26, -v162, v202
    v_fma_f32 v202, v27, -v163, v202
    v_mfma_f32_32x32x8_bf16 v[32:47], v[88:89], v[188:189], v[32:47]
    v_fma_f32 v202, v28, -v164, v202
    v_fma_f32 v202, v29, -v165, v202
    v_fma_f32 v202, v30, -v166, v202
    v_fma_f32 v202, v31, -v167, v202
    v_mfma_f32_32x32x8_bf16 v[0:15], v[92:93], v[188:189], v[0:15]
    s_waitcnt vmcnt(3) lgkmcnt(0)
    v_mfma_f32_32x32x16_bf16 v[16:31], v[72:75], v[176:179], 0
    s_nop 4
    v_mul_f32 v197, v32, v152
    v_fmac_f32 v197, v33, v153
    v_fmac_f32 v197, v34, v154
    v_fmac_f32 v197, v35, v155
    v_fmac_f32 v197, v36, v156
    v_fmac_f32 v197, v37, v157
    s_add_u32 m0, s21, 4096
    v_mfma_f32_32x32x16_bf16 v[48:63], v[76:79], v[176:179], 0
    buffer_load_dwordx4 v236, s[4:7], s37 offen  lds
    buffer_load_dwordx4 v237, s[8:11], s37 offen offset:1024  lds
    ds_read_b64_tr_b16 v[176:177], v244 offset:6144
    ds_read_b64_tr_b16 v[178:179], v244 offset:7168
    ds_read_b64_tr_b16 v[184:185], v245 offset:6144
    ds_read_b64_tr_b16 v[186:187], v245 offset:7168
    v_add_u32 v252, s43, v247
    ds_read2_b32 v[236:237], v252 offset0:0 offset1:16
    v_fmac_f32 v197, v38, v158
    v_fmac_f32 v197, v39, v159
    v_mul_f32_e64 v201, v0, -v168
    s_waitcnt vmcnt(4) lgkmcnt(1)
    v_mfma_f32_32x32x16_bf16 v[16:31], v[80:83], v[176:179], v[16:31]
    v_fma_f32 v201, v1, -v169, v201
    v_fma_f32 v201, v2, -v170, v201
    v_fma_f32 v201, v3, -v171, v201
    v_fma_f32 v201, v4, -v172, v201
    v_fma_f32 v201, v5, -v173, v201
    v_fma_f32 v201, v6, -v174, v201
    s_add_u32 m0, s21, 6144
    v_mfma_f32_32x32x16_bf16 v[48:63], v[84:87], v[176:179], v[48:63]
    buffer_load_dwordx4 v238, s[4:7], s37 offen  lds
    ds_read_b64_tr_b16 v[176:177], v244 offset:0
    ds_read_b64_tr_b16 v[188:189], v245 offset:0
    v_add_u32 v252, s44, v247
    ds_read2_b32 v[238:239], v252 offset0:0 offset1:16
    v_fma_f32 v201, v7, -v175, v201
    s_waitcnt lgkmcnt(1)
    v_mfma_f32_32x32x8_bf16 v[16:31], v[88:89], v[176:177], v[16:31]
    v_mul_f32_e64 v203, v8, -v168
    v_fma_f32 v203, v9, -v169, v203
    v_fma_f32 v203, v10, -v170, v203
    v_fma_f32 v203, v11, -v171, v203
    v_fma_f32 v203, v12, -v172, v203
    v_fma_f32 v203, v13, -v173, v203
    s_add_u32 m0, s21, 0
    v_mfma_f32_32x32x8_bf16 v[48:63], v[92:93], v[176:177], v[48:63]
    s_cbranch_vccnz WL_5_0
    v_mad_u32_u16 v234, v234, s3, v246 op_sel:[1,0,0,0]
    v_mad_u32_u16 v235, v235, s3, v246 op_sel:[1,0,0,0]
    buffer_load_dwordx4 v234, s[4:7], s38 offen  lds
    buffer_load_dwordx4 v235, s[8:11], s38 offen offset:1024  lds
WR_5_0:
    v_fma_f32 v203, v14, -v174, v203
    v_fma_f32 v203, v15, -v175, v203
    v_mfma_f32_32x32x16_bf16 v[0:15], v[72:75], v[180:183], 0
    v_fmac_f32 v200, v24, v160
    v_fmac_f32 v200, v25, v161
    v_fmac_f32 v200, v26, v162
    v_fmac_f32 v200, v27, v163
    v_fmac_f32 v200, v28, v164
    v_fmac_f32 v200, v29, v165
    v_fmac_f32 v200, v30, v166
    v_fmac_f32 v200, v31, v167
    v_mfma_f32_32x32x16_bf16 v[24:39], v[76:79], v[180:183], 0
    v_mul_f32 v254, v16, v144
    v_fmac_f32 v254, v17, v145
    v_fmac_f32 v254, v18, v146
    v_fmac_f32 v254, v19, v147
    v_fmac_f32 v254, v20, v148
    v_fmac_f32 v254, v21, v149
    v_mfma_f32_32x32x16_bf16 v[0:15], v[80:83], v[184:187], v[0:15]
    v_fmac_f32 v254, v22, v150
    v_fmac_f32 v254, v23, v151
    v_sub_f32_e64 v64, -v48, v64
    v_sub_f32_e64 v65, -v49, v65
    v_permlane32_swap_b32 v196, v254
    v_sub_f32_e64 v66, -v50, v66
    v_mfma_f32_32x32x16_bf16 v[24:39], v[84:87], v[184:187], v[24:39]
    s_waitcnt vmcnt(5)
    ds_read_b64_tr_b16 v[176:177], v244 offset:2048
    ds_read_b64_tr_b16 v[178:179], v244 offset:3072
    ds_read_b64_tr_b16 v[180:181], v245 offset:2048
    ds_read_b64_tr_b16 v[182:183], v245 offset:3072
    v_sub_f32_e64 v67, -v51, v67
    v_sub_f32_e64 v68, -v52, v68
    v_mfma_f32_32x32x8_bf16 v[24:39], v[92:93], v[188:189], v[24:39]
    v_sub_f32_e64 v69, -v53, v69
    v_sub_f32_e64 v70, -v54, v70
    v_sub_f32_e64 v71, -v55, v71
    v_add_f32 v254, v196, v254
    v_mfma_f32_32x32x8_bf16 v[0:15], v[88:89], v[188:189], v[0:15]
    s_waitcnt vmcnt(3) lgkmcnt(0)
    v_mfma_f32_32x32x16_bf16 v[56:71], v[76:79], v[176:179], v[56:71]
    s_nop 4
    v_sub_f32_e64 v40, -v24, v40
    v_sub_f32_e64 v41, -v25, v41
    v_sub_f32_e64 v42, -v26, v42
    v_sub_f32_e64 v43, -v27, v43
    v_sub_f32_e64 v44, -v28, v44
    v_sub_f32_e64 v45, -v29, v45
    v_sub_f32_e64 v46, -v30, v46
    v_sub_f32_e64 v47, -v31, v47
    s_add_u32 m0, s21, 2048
    v_mfma_f32_32x32x16_bf16 v[16:31], v[72:75], v[176:179], 0
    s_cbranch_vccnz WL_5_1
    v_mad_u32_u16 v236, v236, s3, v246 op_sel:[1,0,0,0]
    v_mad_u32_u16 v237, v237, s3, v246 op_sel:[1,0,0,0]
    buffer_load_dwordx4 v236, s[4:7], s39 offen  lds
    buffer_load_dwordx4 v237, s[8:11], s39 offen offset:1024  lds
WR_5_1:
    ds_read_b64_tr_b16 v[176:177], v244 offset:4096
    ds_read_b64_tr_b16 v[178:179], v244 offset:5120
    ds_read_b64_tr_b16 v[184:185], v245 offset:4096
    ds_read_b64_tr_b16 v[186:187], v245 offset:5120
    v_mul_f32 v255, v0, v152
    v_fmac_f32 v255, v1, v153
    v_fmac_f32 v255, v2, v154
    v_fmac_f32 v255, v3, v155
    v_fmac_f32 v255, v4, v156
    s_waitcnt vmcnt(4) lgkmcnt(0)
    v_mfma_f32_32x32x16_bf16 v[16:31], v[80:83], v[176:179], v[16:31]
    v_fmac_f32 v255, v5, v157
    v_fmac_f32 v255, v6, v158
    v_fmac_f32 v255, v7, v159
    v_fmac_f32 v201, v8, v168
    v_fmac_f32 v201, v9, v169
    v_permlane32_swap_b32 v197, v255
    s_add_u32 m0, s21, 4096
    v_mfma_f32_32x32x16_bf16 v[56:71], v[84:87], v[176:179], v[56:71]
    s_cbranch_vccnz WL_5_2
    v_mad_u32_u16 v238, v238, s3, v246 op_sel:[1,0,0,0]
    v_mad_u32_u16 v239, v239, s3, v246 op_sel:[1,0,0,0]
    buffer_load_dwordx4 v238, s[4:7], s40 offen  lds
    buffer_load_dwordx4 v239, s[8:11], s40 offen offset:1024  lds
WR_5_2:
    ds_read_b64_tr_b16 v[176:177], v244 offset:6144
    ds_read_b64_tr_b16 v[188:189], v245 offset:6144
    s_waitcnt lgkmcnt(0)
    v_mfma_f32_32x32x8_bf16 v[16:31], v[88:89], v[176:177], v[16:31]
    v_fmac_f32 v201, v10, v170
    v_fmac_f32 v201, v11, v171
    v_fmac_f32 v201, v12, v172
    v_fmac_f32 v201, v13, v173
    v_fmac_f32 v201, v14, v174
    v_fmac_f32 v201, v15, v175
    s_add_u32 m0, s21, 6144
    v_mfma_f32_32x32x8_bf16 v[56:71], v[92:93], v[176:177], v[56:71]
    s_cbranch_vccnz WL_5_3
    v_mad_u32_u16 v240, v240, s3, v246 op_sel:[1,0,0,0]
    v_mad_u32_u16 v241, v241, s3, v246 op_sel:[1,0,0,0]
    buffer_load_dwordx4 v240, s[4:7], s41 offen  lds
    buffer_load_dwordx4 v241, s[8:11], s41 offen offset:1024  lds
WR_5_3:
    v_add_f32 v255, v197, v255
    v_cvt_pk_bf16_f32 v194, v254, v255
    v_mfma_f32_32x32x16_bf16 v[0:15], v[72:75], v[180:183], 0
    v_mul_f32 v254, v16, v144
    v_fmac_f32 v254, v17, v145
    v_fmac_f32 v254, v18, v146
    v_fmac_f32 v254, v19, v147
    v_fmac_f32 v254, v20, v148
    v_fmac_f32 v254, v21, v149
    v_mfma_f32_32x32x16_bf16 v[32:47], v[76:79], v[180:183], v[32:47]
    v_fmac_f32 v254, v22, v150
    v_fmac_f32 v254, v23, v151
    v_fma_f32 v202, v24, -v160, v202
    v_fma_f32 v202, v25, -v161, v202
    v_permlane32_swap_b32 v254, v200
    v_fma_f32 v202, v26, -v162, v202
    v_mfma_f32_32x32x16_bf16 v[0:15], v[80:83], v[184:187], v[0:15]
    v_fma_f32 v202, v27, -v163, v202
    v_fma_f32 v202, v28, -v164, v202
    v_fma_f32 v202, v29, -v165, v202
    v_fma_f32 v202, v30, -v166, v202
    v_fma_f32 v202, v31, -v167, v202
    v_add_f32 v200, v254, v200
    v_mfma_f32_32x32x16_bf16 v[32:47], v[84:87], v[184:187], v[32:47]
    s_waitcnt vmcnt(6)
    ds_read_b64_tr_b16 v[176:177], v244 offset:0
    ds_read_b64_tr_b16 v[178:179], v244 offset:1024
    ds_read_b64_tr_b16 v[180:181], v245 offset:0
    ds_read_b64_tr_b16 v[182:183], v245 offset:1024
    v_mul_f32_e64 v198, v64, -v112
    v_permlane32_swap_b32 v202, v254
    v_mfma_f32_32x32x8_bf16 v[0:15], v[88:89], v[188:189], v[0:15]
    v_fma_f32 v198, v65, -v113, v198
    v_fma_f32 v198, v66, -v114, v198
    v_fma_f32 v198, v67, -v115, v198
    v_fma_f32 v198, v68, -v116, v198
    v_fma_f32 v198, v69, -v117, v198
    v_fma_f32 v198, v70, -v118, v198
    v_mfma_f32_32x32x8_bf16 v[32:47], v[92:93], v[188:189], v[32:47]
    v_add_u32 v249, s48, v249
    v_add_u32 v250, s49, v250
    ds_read_b32 v252, v251 offset:16
    ds_read_b64_tr_b16 v[72:73], v249 offset:0
    ds_read_b64_tr_b16 v[76:77], v249 offset:64
    ds_read_b64_tr_b16 v[74:75], v249 offset:256
    ds_read_b64_tr_b16 v[78:79], v249 offset:320
    s_mov_b64 exec, s[54:55]
    ds_read_u16_d16_hi v242, v250 offset:0
    s_mov_b64 exec, -1
    v_fma_f32 v198, v71, -v119, v198
    v_add_f32 v254, v202, v254
    v_mul_f32 v196, v56, v160
    v_fmac_f32 v196, v57, v161
    v_fmac_f32 v196, v58, v162
    v_fmac_f32 v196, v59, v163
    v_fmac_f32 v196, v60, v164
    v_fmac_f32 v196, v61, v165
    v_fmac_f32 v196, v62, v166
    v_fmac_f32 v196, v63, v167
    s_nop 1
    v_permlane32_swap_b32 v198, v196
    v_add_f32 v196, v198, v196
    s_cbranch_vccnz LEPI_0
    v_mul_f32 v255, v0, v152
    v_fmac_f32 v255, v1, v153
    v_fmac_f32 v255, v2, v154
    v_fmac_f32 v255, v3, v155
    v_fmac_f32 v255, v4, v156
    v_fmac_f32 v255, v5, v157
    v_fmac_f32 v255, v6, v158
    v_fmac_f32 v255, v7, v159
    v_fma_f32 v203, v8, -v168, v203
    v_fma_f32 v203, v9, -v169, v203
    v_permlane32_swap_b32 v255, v201
    v_fma_f32 v203, v10, -v170, v203
    v_fma_f32 v203, v11, -v171, v203
    v_fma_f32 v203, v12, -v172, v203
    v_fma_f32 v203, v13, -v173, v203
    v_fma_f32 v203, v14, -v174, v203
    v_fma_f32 v203, v15, -v175, v203
    v_add_f32 v201, v255, v201
    v_mul_f32_e64 v199, v40, -v120
    v_permlane32_swap_b32 v203, v255
    v_fma_f32 v199, v41, -v121, v199
    v_fma_f32 v199, v42, -v122, v199
    v_fma_f32 v199, v43, -v123, v199
    v_fma_f32 v199, v44, -v124, v199
    v_fma_f32 v199, v45, -v125, v199
    v_fma_f32 v199, v46, -v126, v199
    v_fma_f32 v199, v47, -v127, v199
    v_add_f32 v255, v203, v255
    v_mul_f32 v197, v32, v168
    v_fmac_f32 v197, v33, v169
    v_fmac_f32 v197, v34, v170
    v_fmac_f32 v197, v35, v171
    v_fmac_f32 v197, v36, v172
    v_fmac_f32 v197, v37, v173
    v_fmac_f32 v197, v38, v174
    v_fmac_f32 v197, v39, v175
    s_nop 1
    v_permlane32_swap_b32 v199, v197
    v_add_f32 v197, v199, v197
    v_cvt_pk_bf16_f32 v200, v200, v201
    v_cvt_pk_bf16_f32 v254, v254, v255
    v_cvt_pk_bf16_f32 v196, v196, v197
    ds_write2st64_b32 v253, v192, v193 offset0:0 offset1:1
    ds_write2st64_b32 v253, v194, v200 offset0:2 offset1:3
    ds_write_b32 v253, v196 offset:1024
    s_mov_b64 exec, 0xffffffff
    ds_write_b32 v253, v254 offset:1280
    s_mov_b64 exec, -1
    s_add_u32 s50, s50, 1
    s_cmp_ge_u32 s50, 4
    s_cbranch_scc1 LAST1
    s_waitcnt lgkmcnt(9)
    v_readfirstlane_b32 s66, v252
    s_add_u32 s53, s53, 1
    v_mov_b32 v252, s53
    s_cmp_le_u32 s53, s66
    ds_write2_b32 v251, v252, v252 offset0:0 offset1:8
    s_setprio 1
    s_cbranch_scc1 PRIO_12
    s_setprio 0
PRIO_12:
    s_cmp_eq_u32 s52, 4
    s_cbranch_scc1 ITEM_1_4
    s_cmp_eq_u32 s52, 5
    s_cbranch_scc1 ITEM_1_5
    s_cmp_eq_u32 s52, 3
    s_cbranch_scc1 ITEM_1_3
    s_cmp_eq_u32 s52, 6
    s_cbranch_scc1 ITEM_1_6
    s_cmp_eq_u32 s52, 8
    s_cbranch_scc1 ITEM_1_8
    s_branch ITEM_1_2
WL_5_0:
    s_add_u32 s66, s51, 0
    buffer_load_dwordx4 v[96:99], v246, s[16:19], s66 offen offset:2048 sc1
    buffer_load_dwordx4 v[100:103], v246, s[16:19], s66 offen offset:3072 sc1
    s_branch WR_5_0
WL_5_1:
    s_add_u32 s66, s51, 4096
    buffer_load_dwordx4 v[104:107], v246, s[16:19], s66 offen offset:2048 sc1
    buffer_load_dwordx4 v[108:111], v246, s[16:19], s66 offen offset:3072 sc1
    s_branch WR_5_1
WL_5_2:
    s_add_u32 s66, s51, 8192
    buffer_load_dwordx4 v[128:131], v246, s[16:19], s66 offen offset:2048 sc1
    buffer_load_dwordx4 v[132:135], v246, s[16:19], s66 offen offset:3072 sc1
    s_branch WR_5_2
WL_5_3:
    s_add_u32 s66, s51, 12288
    buffer_load_dwordx4 v[136:139], v246, s[16:19], s66 offen offset:2048 sc1
    buffer_load_dwordx4 v[140:143], v246, s[16:19], s66 offen offset:3072 sc1
    s_branch WR_5_3
.p2align 6
ITEM_1_3:
    s_mov_b64 exec, s[54:55]
    ds_read_u16_d16_hi v243, v250 offset:128
    s_mov_b64 exec, -1
    ds_read_b64_tr_b16 v[80:81], v249 offset:512
    ds_read_b64_tr_b16 v[84:85], v249 offset:576
    s_waitcnt lgkmcnt(3)
    v_mul_f32_dpp v196, v242, v72 row_newbcast:0 row_mask:0xf bank_mask:0xf
    v_mul_f32_dpp v197, v242, v73 row_newbcast:1 row_mask:0xf bank_mask:0xf
    v_mul_f32_dpp v198, v242, v72 row_newbcast:8 row_mask:0xf bank_mask:0xf
    v_mul_f32_dpp v199, v242, v73 row_newbcast:9 row_mask:0xf bank_mask:0xf
    v_mul_f32_dpp v200, v242, v76 row_newbcast:2 row_mask:0xf bank_mask:0xf
    v_mul_f32_dpp v201, v242, v77 row_newbcast:3 row_mask:0xf bank_mask:0xf
    v_mul_f32_dpp v202, v242, v76 row_newbcast:10 row_mask:0xf bank_mask:0xf
    v_mul_f32_dpp v203, v242, v77 row_newbcast:11 row_mask:0xf bank_mask:0xf
    v_cvt_pk_bf16_f32 v72, v196, v197
    v_cvt_pk_bf16_f32 v76, v198, v199
    v_cvt_pk_bf16_f32 v73, v200, v201
    v_cvt_pk_bf16_f32 v77, v202, v203
    v_mul_f32_dpp v196, v242, v74 row_newbcast:4 row_mask:0xf bank_mask:0xf
    v_mul_f32_dpp v197, v242, v75 row_newbcast:5 row_mask:0xf bank_mask:0xf
    v_mul_f32_dpp v198, v242, v74 row_newbcast:12 row_mask:0xf bank_mask:0xf
    v_mul_f32_dpp v199, v242, v75 row_newbcast:13 row_mask:0xf bank_mask:0xf
    v_mul_f32_dpp v200, v242, v78 row_newbcast:6 row_mask:0xf bank_mask:0xf
    v_mul_f32_dpp v201, v242, v79 row_newbcast:7 row_mask:0xf bank_mask:0xf
    v_mul_f32_dpp v202, v242, v78 row_newbcast:14 row_mask:0xf bank_mask:0xf
    v_mul_f32_dpp v203, v242, v79 row_newbcast:15 row_mask:0xf bank_mask:0xf
    v_cvt_pk_bf16_f32 v74, v196, v197
    v_cvt_pk_bf16_f32 v78, v198, v199
    v_cvt_pk_bf16_f32 v75, v200, v201
    v_cvt_pk_bf16_f32 v79, v202, v203
    s_waitcnt vmcnt(4) lgkmcnt(0)
    v_mfma_f32_32x32x16_bf16 v[56:71], v[72:75], v[176:179], 0
    v_mul_f32_dpp v196, v243, v80 row_newbcast:0 row_mask:0xf bank_mask:0xf
    v_mul_f32_dpp v197, v243, v81 row_newbcast:1 row_mask:0xf bank_mask:0xf
    v_mul_f32_dpp v198, v243, v80 row_newbcast:8 row_mask:0xf bank_mask:0xf
    v_mul_f32_dpp v199, v243, v81 row_newbcast:9 row_mask:0xf bank_mask:0xf
    v_mul_f32_dpp v200, v243, v84 row_newbcast:2 row_mask:0xf bank_mask:0xf
    v_mul_f32_dpp v201, v243, v85 row_newbcast:3 row_mask:0xf bank_mask:0xf
    s_add_u32 m0, s21, 0
    v_mfma_f32_32x32x16_bf16 v[16:31], v[76:79], v[176:179], 0
    buffer_load_dwordx4 v234, s[4:7], s36 offen  lds
    buffer_load_dwordx4 v235, s[8:11], s36 offen offset:1024  lds
    ds_read_b64_tr_b16 v[176:177], v244 offset:2048
    ds_read_b64_tr_b16 v[184:185], v245 offset:2048
    v_mul_f32_dpp v202, v243, v84 row_newbcast:10 row_mask:0xf bank_mask:0xf
    v_mul_f32_dpp v203, v243, v85 row_newbcast:11 row_mask:0xf bank_mask:0xf
    v_cvt_pk_bf16_f32 v80, v196, v197
    v_cvt_pk_bf16_f32 v84, v198, v199
    v_cvt_pk_bf16_f32 v81, v200, v201
    v_cvt_pk_bf16_f32 v85, v202, v203
    s_waitcnt lgkmcnt(0)
    v_mfma_f32_32x32x8_bf16 v[56:71], v[80:81], v[176:177], v[56:71]
    s_add_u32 m0, s21, 2048
    v_mfma_f32_32x32x8_bf16 v[16:31], v[84:85], v[176:177], v[16:31]
    buffer_load_dwordx4 v236, s[4:7], s36 offen  lds
    s_mov_b32 m0, s50
    s_nop 0
    s_movrels_b32 s71, s23
    s_movrels_b32 s33, s28
    v_add_u32 v253, s33, v248
    s_bfe_u32 s46, s71, 0x30012
    s_mov_b32 m0, s46
    s_and_b32 s66, s71, 0x3ffff
    s_movrels_b32 s68, s57
    s_movrels_b32 s69, s61
    s_sub_u32 s48, s66, s47
    s_mov_b32 s47, s66
    s_lshr_b32 s52, s71, 28
    s_lshl_b32 s67, s46, 9
    s_add_u32 s66, s66, s67
    s_sub_u32 s49, s66, s42
    s_mov_b32 s42, s66
    s_bfe_u32 s66, s68, 655360
    s_add_u32 s43, s42, s66
    s_bfe_u32 s39, s69, 655360
    s_bfe_u32 s66, s68, 655370
    s_add_u32 s44, s42, s66
    s_bfe_u32 s40, s69, 655370
    s_bfe_u32 s66, s68, 655380
    s_add_u32 s45, s42, s66
    s_bfe_u32 s41, s69, 655380
    v_add_u32 v252, s44, v247
    ds_read2_b32 v[238:239], v252 offset0:0 offset1:16
    v_add_u32 v252, s45, v247
    ds_read2_b32 v[240:241], v252 offset0:0 offset1:16
    v_mfma_f32_32x32x16_bf16 v[32:47], v[72:75], v[180:183], 0
    v_mul_f32 v196, v56, v96
    v_fmac_f32 v196, v57, v97
    v_fmac_f32 v196, v58, v98
    v_fmac_f32 v196, v59, v99
    v_fmac_f32 v196, v60, v100
    v_fmac_f32 v196, v61, v101
    v_mfma_f32_32x32x16_bf16 v[0:15], v[76:79], v[180:183], 0
    s_waitcnt vmcnt(5)
    ds_read_b64_tr_b16 v[176:177], v244 offset:4096
    ds_read_b64_tr_b16 v[178:179], v244 offset:5120
    ds_read_b64_tr_b16 v[180:181], v245 offset:4096
    ds_read_b64_tr_b16 v[182:183], v245 offset:5120
    v_fmac_f32 v196, v62, v102
    v_fmac_f32 v196, v63, v103
    v_mfma_f32_32x32x8_bf16 v[32:47], v[80:81], v[184:185], v[32:47]
    v_mul_f32 v198, v64, v128
    v_fmac_f32 v198, v65, v129
    v_fmac_f32 v198, v66, v130
    v_fmac_f32 v198, v67, v131
    v_fmac_f32 v198, v68, v132
    v_fmac_f32 v198, v69, v133
    v_mfma_f32_32x32x8_bf16 v[0:15], v[84:85], v[184:185], v[0:15]
    v_fmac_f32 v198, v70, v134
    v_fmac_f32 v198, v71, v135
    v_mul_f32 v200, v16, v128
    v_fmac_f32 v200, v17, v129
    v_permlane32_swap_b32 v196, v198
    v_fmac_f32 v200, v18, v130
    v_fmac_f32 v200, v19, v131
    v_fmac_f32 v200, v20, v132
    v_fmac_f32 v200, v21, v133
    v_fmac_f32 v200, v22, v134
    v_fmac_f32 v200, v23, v135
    v_add_f32 v198, v196, v198
    v_mul_f32_e64 v202, v24, -v128
    v_fma_f32 v202, v25, -v129, v202
    v_fma_f32 v202, v26, -v130, v202
    v_fma_f32 v202, v27, -v131, v202
    v_fma_f32 v202, v28, -v132, v202
    v_fma_f32 v202, v29, -v133, v202
    v_fma_f32 v202, v30, -v134, v202
    v_fma_f32 v202, v31, -v135, v202
    s_nop 1
    v_permlane32_swap_b32 v200, v202
    v_add_f32 v202, v200, v202
    s_waitcnt vmcnt(3) lgkmcnt(0)
    v_mfma_f32_32x32x16_bf16 v[56:71], v[72:75], v[176:179], 0
    v_mul_f32 v197, v32, v104
    v_fmac_f32 v197, v33, v105
    v_fmac_f32 v197, v34, v106
    v_fmac_f32 v197, v35, v107
    v_fmac_f32 v197, v36, v108
    v_fmac_f32 v197, v37, v109
    s_add_u32 m0, s21, 4096
    v_mfma_f32_32x32x16_bf16 v[16:31], v[76:79], v[176:179], 0
    buffer_load_dwordx4 v234, s[4:7], s37 offen  lds
    buffer_load_dwordx4 v235, s[8:11], s37 offen offset:1024  lds
    ds_read_b64_tr_b16 v[176:177], v244 offset:6144
    ds_read_b64_tr_b16 v[184:185], v245 offset:6144
    v_add_u32 v252, s42, v247
    ds_read2_b32 v[234:235], v252 offset0:0 offset1:16
    v_fmac_f32 v197, v38, v110
    v_fmac_f32 v197, v39, v111
    v_mul_f32 v199, v40, v136
    v_fmac_f32 v199, v41, v137
    v_fmac_f32 v199, v42, v138
    v_fmac_f32 v199, v43, v139
    v_fmac_f32 v199, v44, v140
    v_fmac_f32 v199, v45, v141
    v_fmac_f32 v199, v46, v142
    v_fmac_f32 v199, v47, v143
    v_mul_f32 v201, v0, v136
    v_fmac_f32 v201, v1, v137
    v_permlane32_swap_b32 v197, v199
    v_fmac_f32 v201, v2, v138
    v_fmac_f32 v201, v3, v139
    v_fmac_f32 v201, v4, v140
    v_fmac_f32 v201, v5, v141
    v_fmac_f32 v201, v6, v142
    v_fmac_f32 v201, v7, v143
    v_add_f32 v199, v197, v199
    v_mul_f32_e64 v203, v8, -v136
    v_fma_f32 v203, v9, -v137, v203
    v_fma_f32 v203, v10, -v138, v203
    s_waitcnt lgkmcnt(1)
    v_mfma_f32_32x32x8_bf16 v[56:71], v[80:81], v[176:177], v[56:71]
    v_fma_f32 v203, v11, -v139, v203
    v_fma_f32 v203, v12, -v140, v203
    v_fma_f32 v203, v13, -v141, v203
    v_fma_f32 v203, v14, -v142, v203
    v_fma_f32 v203, v15, -v143, v203
    s_nop 1
    v_permlane32_swap_b32 v201, v203
    s_add_u32 m0, s21, 6144
    v_mfma_f32_32x32x8_bf16 v[16:31], v[84:85], v[176:177], v[16:31]
    buffer_load_dwordx4 v236, s[4:7], s37 offen  lds
    v_add_u32 v252, s43, v247
    ds_read2_b32 v[236:237], v252 offset0:0 offset1:16
    v_add_f32 v203, v201, v203
    v_cvt_pk_bf16_f32 v192, v198, v199
    v_cvt_pk_bf16_f32 v193, v202, v203
    v_mfma_f32_32x32x16_bf16 v[32:47], v[72:75], v[180:183], 0
    v_mul_f32 v196, v56, v144
    v_fmac_f32 v196, v57, v145
    v_fmac_f32 v196, v58, v146
    v_fmac_f32 v196, v59, v147
    v_fmac_f32 v196, v60, v148
    v_fmac_f32 v196, v61, v149
    v_mfma_f32_32x32x16_bf16 v[0:15], v[76:79], v[180:183], 0
    s_waitcnt vmcnt(4)
    ds_read_b64_tr_b16 v[176:177], v244 offset:0
    ds_read_b64_tr_b16 v[178:179], v244 offset:1024
    ds_read_b64_tr_b16 v[180:181], v245 offset:0
    ds_read_b64_tr_b16 v[182:183], v245 offset:1024
    v_fmac_f32 v196, v62, v150
    v_fmac_f32 v196, v63, v151
    v_mfma_f32_32x32x8_bf16 v[32:47], v[80:81], v[184:185], v[32:47]
    v_mul_f32_e64 v200, v16, -v160
    v_fma_f32 v200, v17, -v161, v200
    v_fma_f32 v200, v18, -v162, v200
    v_fma_f32 v200, v19, -v163, v200
    v_fma_f32 v200, v20, -v164, v200
    v_fma_f32 v200, v21, -v165, v200
    v_mfma_f32_32x32x8_bf16 v[0:15], v[84:85], v[184:185], v[0:15]
    v_fma_f32 v200, v22, -v166, v200
    v_fma_f32 v200, v23, -v167, v200
    v_mul_f32_e64 v202, v24, -v160
    v_fma_f32 v202, v25, -v161, v202
    v_fma_f32 v202, v26, -v162, v202
    v_fma_f32 v202, v27, -v163, v202
    v_fma_f32 v202, v28, -v164, v202
    v_fma_f32 v202, v29, -v165, v202
    v_fma_f32 v202, v30, -v166, v202
    v_fma_f32 v202, v31, -v167, v202
    s_waitcnt vmcnt(3) lgkmcnt(0)
    v_mfma_f32_32x32x16_bf16 v[16:31], v[72:75], v[176:179], 0
    v_mul_f32 v197, v32, v152
    v_fmac_f32 v197, v33, v153
    v_fmac_f32 v197, v34, v154
    v_fmac_f32 v197, v35, v155
    v_fmac_f32 v197, v36, v156
    v_fmac_f32 v197, v37, v157
    s_add_u32 m0, s21, 0
    v_mfma_f32_32x32x16_bf16 v[48:63], v[76:79], v[176:179], 0
    s_cbranch_vccnz WL_3_0
    v_mad_u32_u16 v234, v234, s3, v246 op_sel:[1,0,0,0]
    v_mad_u32_u16 v235, v235, s3, v246 op_sel:[1,0,0,0]
    buffer_load_dwordx4 v234, s[4:7], s38 offen  lds
    buffer_load_dwordx4 v235, s[8:11], s38 offen offset:1024  lds
WR_3_0:
    ds_read_b64_tr_b16 v[176:177], v244 offset:2048
    ds_read_b64_tr_b16 v[184:185], v245 offset:2048
    v_fmac_f32 v197, v38, v158
    v_fmac_f32 v197, v39, v159
    v_mul_f32_e64 v201, v0, -v168
    v_fma_f32 v201, v1, -v169, v201
    v_fma_f32 v201, v2, -v170, v201
    v_fma_f32 v201, v3, -v171, v201
    v_fma_f32 v201, v4, -v172, v201
    v_fma_f32 v201, v5, -v173, v201
    v_fma_f32 v201, v6, -v174, v201
    v_fma_f32 v201, v7, -v175, v201
    s_waitcnt lgkmcnt(0)
    v_mfma_f32_32x32x8_bf16 v[16:31], v[80:81], v[176:177], v[16:31]
    v_mul_f32_e64 v203, v8, -v168
    v_fma_f32 v203, v9, -v169, v203
    v_fma_f32 v203, v10, -v170, v203
    v_fma_f32 v203, v11, -v171, v203
    v_fma_f32 v203, v12, -v172, v203
    v_fma_f32 v203, v13, -v173, v203
    s_add_u32 m0, s21, 2048
    v_mfma_f32_32x32x8_bf16 v[48:63], v[84:85], v[176:177], v[48:63]
    s_cbranch_vccnz WL_3_1
    v_mad_u32_u16 v236, v236, s3, v246 op_sel:[1,0,0,0]
    v_mad_u32_u16 v237, v237, s3, v246 op_sel:[1,0,0,0]
    buffer_load_dwordx4 v236, s[4:7], s39 offen  lds
    buffer_load_dwordx4 v237, s[8:11], s39 offen offset:1024  lds
WR_3_1:
    v_fma_f32 v203, v14, -v174, v203
    v_fma_f32 v203, v15, -v175, v203
    v_mfma_f32_32x32x16_bf16 v[0:15], v[72:75], v[180:183], 0
    v_fmac_f32 v200, v24, v160
    v_fmac_f32 v200, v25, v161
    v_fmac_f32 v200, v26, v162
    v_fmac_f32 v200, v27, v163
    v_fmac_f32 v200, v28, v164
    v_fmac_f32 v200, v29, v165
    v_fmac_f32 v200, v30, v166
    v_fmac_f32 v200, v31, v167
    v_mfma_f32_32x32x16_bf16 v[24:39], v[76:79], v[180:183], 0
    s_waitcnt vmcnt(5)
    ds_read_b64_tr_b16 v[176:177], v244 offset:4096
    ds_read_b64_tr_b16 v[178:179], v244 offset:5120
    ds_read_b64_tr_b16 v[180:181], v245 offset:4096
    ds_read_b64_tr_b16 v[182:183], v245 offset:5120
    v_mul_f32 v254, v16, v144
    v_fmac_f32 v254, v17, v145
    v_mfma_f32_32x32x8_bf16 v[24:39], v[84:85], v[184:185], v[24:39]
    v_fmac_f32 v254, v18, v146
    v_fmac_f32 v254, v19, v147
    v_fmac_f32 v254, v20, v148
    v_fmac_f32 v254, v21, v149
    v_fmac_f32 v254, v22, v150
    v_fmac_f32 v254, v23, v151
    v_mfma_f32_32x32x8_bf16 v[0:15], v[80:81], v[184:185], v[0:15]
    v_sub_f32_e64 v64, -v48, v64
    v_sub_f32_e64 v65, -v49, v65
    v_permlane32_swap_b32 v196, v254
    v_sub_f32_e64 v66, -v50, v66
    v_sub_f32_e64 v67, -v51, v67
    v_sub_f32_e64 v68, -v52, v68
    v_sub_f32_e64 v69, -v53, v69
    v_sub_f32_e64 v70, -v54, v70
    v_sub_f32_e64 v71, -v55, v71
    v_add_f32 v254, v196, v254
    s_waitcnt vmcnt(4) lgkmcnt(0)
    v_mfma_f32_32x32x16_bf16 v[56:71], v[76:79], v[176:179], v[56:71]
    v_sub_f32_e64 v40, -v24, v40
    v_sub_f32_e64 v41, -v25, v41
    v_sub_f32_e64 v42, -v26, v42
    v_sub_f32_e64 v43, -v27, v43
    v_sub_f32_e64 v44, -v28, v44
    v_sub_f32_e64 v45, -v29, v45
    v_sub_f32_e64 v46, -v30, v46
    v_sub_f32_e64 v47, -v31, v47
    s_add_u32 m0, s21, 4096
    v_mfma_f32_32x32x16_bf16 v[16:31], v[72:75], v[176:179], 0
    s_cbranch_vccnz WL_3_2
    v_mad_u32_u16 v238, v238, s3, v246 op_sel:[1,0,0,0]
    v_mad_u32_u16 v239, v239, s3, v246 op_sel:[1,0,0,0]
    buffer_load_dwordx4 v238, s[4:7], s40 offen  lds
    buffer_load_dwordx4 v239, s[8:11], s40 offen offset:1024  lds
WR_3_2:
    ds_read_b64_tr_b16 v[176:177], v244 offset:6144
    ds_read_b64_tr_b16 v[184:185], v245 offset:6144
    v_mul_f32 v255, v0, v152
    v_fmac_f32 v255, v1, v153
    v_fmac_f32 v255, v2, v154
    v_fmac_f32 v255, v3, v155
    v_fmac_f32 v255, v4, v156
    v_fmac_f32 v255, v5, v157
    v_fmac_f32 v255, v6, v158
    v_fmac_f32 v255, v7, v159
    v_fmac_f32 v201, v8, v168
    v_fmac_f32 v201, v9, v169
    v_permlane32_swap_b32 v197, v255
    s_waitcnt lgkmcnt(0)
    v_mfma_f32_32x32x8_bf16 v[16:31], v[80:81], v[176:177], v[16:31]
    v_fmac_f32 v201, v10, v170
    v_fmac_f32 v201, v11, v171
    v_fmac_f32 v201, v12, v172
    v_fmac_f32 v201, v13, v173
    v_fmac_f32 v201, v14, v174
    v_fmac_f32 v201, v15, v175
    s_add_u32 m0, s21, 6144
    v_mfma_f32_32x32x8_bf16 v[56:71], v[84:85], v[176:177], v[56:71]
    s_cbranch_vccnz WL_3_3
    v_mad_u32_u16 v240, v240, s3, v246 op_sel:[1,0,0,0]
    v_mad_u32_u16 v241, v241, s3, v246 op_sel:[1,0,0,0]
    buffer_load_dwordx4 v240, s[4:7], s41 offen  lds
    buffer_load_dwordx4 v241, s[8:11], s41 offen offset:1024  lds
WR_3_3:
    v_add_f32 v255, v197, v255
    v_cvt_pk_bf16_f32 v194, v254, v255
    v_mfma_f32_32x32x16_bf16 v[0:15], v[72:75], v[180:183], 0
    v_mul_f32 v254, v16, v144
    v_fmac_f32 v254, v17, v145
    v_fmac_f32 v254, v18, v146
    v_fmac_f32 v254, v19, v147
    v_fmac_f32 v254, v20, v148
    v_fmac_f32 v254, v21, v149
    v_mfma_f32_32x32x16_bf16 v[32:47], v[76:79], v[180:183], v[32:47]
    s_waitcnt vmcnt(6)
    ds_read_b64_tr_b16 v[176:177], v244 offset:0
    ds_read_b64_tr_b16 v[178:179], v244 offset:1024
    ds_read_b64_tr_b16 v[180:181], v245 offset:0
    ds_read_b64_tr_b16 v[182:183], v245 offset:1024
    v_fmac_f32 v254, v22, v150
    v_fmac_f32 v254, v23, v151
    v_mfma_f32_32x32x8_bf16 v[0:15], v[80:81], v[184:185], v[0:15]
    v_fma_f32 v202, v24, -v160, v202
    v_fma_f32 v202, v25, -v161, v202
    v_permlane32_swap_b32 v254, v200
    v_fma_f32 v202, v26, -v162, v202
    v_fma_f32 v202, v27, -v163, v202
    v_fma_f32 v202, v28, -v164, v202
    v_mfma_f32_32x32x8_bf16 v[32:47], v[84:85], v[184:185], v[32:47]
    v_add_u32 v249, s48, v249
    v_add_u32 v250, s49, v250
    ds_read_b32 v252, v251 offset:16
    ds_read_b64_tr_b16 v[72:73], v249 offset:0
    ds_read_b64_tr_b16 v[76:77], v249 offset:64
    ds_read_b64_tr_b16 v[74:75], v249 offset:256
    ds_read_b64_tr_b16 v[78:79], v249 offset:320
    s_mov_b64 exec, s[54:55]
    ds_read_u16_d16_hi v242, v250 offset:0
    s_mov_b64 exec, -1
    v_fma_f32 v202, v29, -v165, v202
    v_fma_f32 v202, v30, -v166, v202
    v_fma_f32 v202, v31, -v167, v202
    v_add_f32 v200, v254, v200
    v_mul_f32_e64 v198, v64, -v112
    v_permlane32_swap_b32 v202, v254
    v_fma_f32 v198, v65, -v113, v198
    v_fma_f32 v198, v66, -v114, v198
    v_fma_f32 v198, v67, -v115, v198
    v_fma_f32 v198, v68, -v116, v198
    v_fma_f32 v198, v69, -v117, v198
    v_fma_f32 v198, v70, -v118, v198
    v_fma_f32 v198, v71, -v119, v198
    v_add_f32 v254, v202, v254
    v_mul_f32 v196, v56, v160
    v_fmac_f32 v196, v57, v161
    v_fmac_f32 v196, v58, v162
    v_fmac_f32 v196, v59, v163
    v_fmac_f32 v196, v60, v164
    v_fmac_f32 v196, v61, v165
    v_fmac_f32 v196, v62, v166
    v_fmac_f32 v196, v63, v167
    s_nop 1
    v_permlane32_swap_b32 v198, v196
    v_add_f32 v196, v198, v196
    s_cbranch_vccnz LEPI_0
    v_mul_f32 v255, v0, v152
    v_fmac_f32 v255, v1, v153
    v_fmac_f32 v255, v2, v154
    v_fmac_f32 v255, v3, v155
    v_fmac_f32 v255, v4, v156
    v_fmac_f32 v255, v5, v157
    v_fmac_f32 v255, v6, v158
    v_fmac_f32 v255, v7, v159
    v_fma_f32 v203, v8, -v168, v203
    v_fma_f32 v203, v9, -v169, v203
    v_permlane32_swap_b32 v255, v201
    v_fma_f32 v203, v10, -v170, v203
    v_fma_f32 v203, v11, -v171, v203
    v_fma_f32 v203, v12, -v172, v203
    v_fma_f32 v203, v13, -v173, v203
    v_fma_f32 v203, v14, -v174, v203
    v_fma_f32 v203, v15, -v175, v203
    v_add_f32 v201, v255, v201
    v_mul_f32_e64 v199, v40, -v120
    v_permlane32_swap_b32 v203, v255
    v_fma_f32 v199, v41, -v121, v199
    v_fma_f32 v199, v42, -v122, v199
    v_fma_f32 v199, v43, -v123, v199
    v_fma_f32 v199, v44, -v124, v199
    v_fma_f32 v199, v45, -v125, v199
    v_fma_f32 v199, v46, -v126, v199
    v_fma_f32 v199, v47, -v127, v199
    v_add_f32 v255, v203, v255
    v_mul_f32 v197, v32, v168
    v_fmac_f32 v197, v33, v169
    v_fmac_f32 v197, v34, v170
    v_fmac_f32 v197, v35, v171
    v_fmac_f32 v197, v36, v172
    v_fmac_f32 v197, v37, v173
    v_fmac_f32 v197, v38, v174
    v_fmac_f32 v197, v39, v175
    s_nop 1
    v_permlane32_swap_b32 v199, v197
    v_add_f32 v197, v199, v197
    v_cvt_pk_bf16_f32 v200, v200, v201
    v_cvt_pk_bf16_f32 v254, v254, v255
    v_cvt_pk_bf16_f32 v196, v196, v197
    ds_write2st64_b32 v253, v192, v193 offset0:0 offset1:1
    ds_write2st64_b32 v253, v194, v200 offset0:2 offset1:3
    ds_write_b32 v253, v196 offset:1024
    s_mov_b64 exec, 0xffffffff
    ds_write_b32 v253, v254 offset:1280
    s_mov_b64 exec, -1
    s_add_u32 s50, s50, 1
    s_cmp_ge_u32 s50, 4
    s_cbranch_scc1 LAST1
    s_waitcnt lgkmcnt(9)
    v_readfirstlane_b32 s66, v252
    s_add_u32 s53, s53, 1
    v_mov_b32 v252, s53
    s_cmp_le_u32 s53, s66
    ds_write2_b32 v251, v252, v252 offset0:0 offset1:8
    s_setprio 1
    s_cbranch_scc1 PRIO_13
    s_setprio 0
PRIO_13:
    s_cmp_eq_u32 s52, 4
    s_cbranch_scc1 ITEM_1_4
    s_cmp_eq_u32 s52, 5
    s_cbranch_scc1 ITEM_1_5
    s_cmp_eq_u32 s52, 3
    s_cbranch_scc1 ITEM_1_3
    s_cmp_eq_u32 s52, 6
    s_cbranch_scc1 ITEM_1_6
    s_cmp_eq_u32 s52, 8
    s_cbranch_scc1 ITEM_1_8
    s_branch ITEM_1_2
WL_3_0:
    s_add_u32 s66, s51, 0
    buffer_load_dwordx4 v[96:99], v246, s[16:19], s66 offen offset:2048 sc1
    buffer_load_dwordx4 v[100:103], v246, s[16:19], s66 offen offset:3072 sc1
    s_branch WR_3_0
WL_3_1:
    s_add_u32 s66, s51, 4096
    buffer_load_dwordx4 v[104:107], v246, s[16:19], s66 offen offset:2048 sc1
    buffer_load_dwordx4 v[108:111], v246, s[16:19], s66 offen offset:3072 sc1
    s_branch WR_3_1
WL_3_2:
    s_add_u32 s66, s51, 8192
    buffer_load_dwordx4 v[128:131], v246, s[16:19], s66 offen offset:2048 sc1
    buffer_load_dwordx4 v[132:135], v246, s[16:19], s66 offen offset:3072 sc1
    s_branch WR_3_2
WL_3_3:
    s_add_u32 s66, s51, 12288
    buffer_load_dwordx4 v[136:139], v246, s[16:19], s66 offen offset:2048 sc1
    buffer_load_dwordx4 v[140:143], v246, s[16:19], s66 offen offset:3072 sc1
    s_branch WR_3_3
.p2align 6
ITEM_1_6:
    s_mov_b64 exec, s[54:55]
    ds_read_u16_d16_hi v243, v250 offset:128
    s_mov_b64 exec, -1
    ds_read_b64_tr_b16 v[80:81], v249 offset:512
    ds_read_b64_tr_b16 v[84:85], v249 offset:576
    ds_read_b64_tr_b16 v[82:83], v249 offset:768
    ds_read_b64_tr_b16 v[86:87], v249 offset:832
    ds_read_b64_tr_b16 v[88:89], v249 offset:1024
    ds_read_b64_tr_b16 v[92:93], v249 offset:1088
    ds_read_b64_tr_b16 v[90:91], v249 offset:1280
    ds_read_b64_tr_b16 v[94:95], v249 offset:1344
    s_waitcnt lgkmcnt(9)
    v_mul_f32_dpp v196, v242, v72 row_newbcast:0 row_mask:0xf bank_mask:0xf
    v_mul_f32_dpp v197, v242, v73 row_newbcast:1 row_mask:0xf bank_mask:0xf
    v_mul_f32_dpp v198, v242, v72 row_newbcast:8 row_mask:0xf bank_mask:0xf
    v_mul_f32_dpp v199, v242, v73 row_newbcast:9 row_mask:0xf bank_mask:0xf
    v_mul_f32_dpp v200, v242, v76 row_newbcast:2 row_mask:0xf bank_mask:0xf
    v_mul_f32_dpp v201, v242, v77 row_newbcast:3 row_mask:0xf bank_mask:0xf
    v_mul_f32_dpp v202, v242, v76 row_newbcast:10 row_mask:0xf bank_mask:0xf
    v_mul_f32_dpp v203, v242, v77 row_newbcast:11 row_mask:0xf bank_mask:0xf
    v_cvt_pk_bf16_f32 v72, v196, v197
    v_cvt_pk_bf16_f32 v76, v198, v199
    v_cvt_pk_bf16_f32 v73, v200, v201
    v_cvt_pk_bf16_f32 v77, v202, v203
    v_mul_f32_dpp v196, v242, v74 row_newbcast:4 row_mask:0xf bank_mask:0xf
    v_mul_f32_dpp v197, v242, v75 row_newbcast:5 row_mask:0xf bank_mask:0xf
    v_mul_f32_dpp v198, v242, v74 row_newbcast:12 row_mask:0xf bank_mask:0xf
    v_mul_f32_dpp v199, v242, v75 row_newbcast:13 row_mask:0xf bank_mask:0xf
    v_mul_f32_dpp v200, v242, v78 row_newbcast:6 row_mask:0xf bank_mask:0xf
    v_mul_f32_dpp v201, v242, v79 row_newbcast:7 row_mask:0xf bank_mask:0xf
    v_mul_f32_dpp v202, v242, v78 row_newbcast:14 row_mask:0xf bank_mask:0xf
    v_mul_f32_dpp v203, v242, v79 row_newbcast:15 row_mask:0xf bank_mask:0xf
    v_cvt_pk_bf16_f32 v74, v196, v197
    v_cvt_pk_bf16_f32 v78, v198, v199
    v_cvt_pk_bf16_f32 v75, v200, v201
    v_cvt_pk_bf16_f32 v79, v202, v203
    s_mov_b64 exec, s[54:55]
    ds_read_u16_d16_hi v242, v250 offset:256
    s_mov_b64 exec, -1
    s_waitcnt vmcnt(4) lgkmcnt(5)
    v_mfma_f32_32x32x16_bf16 v[56:71], v[72:75], v[176:179], 0
    v_mul_f32_dpp v196, v243, v80 row_newbcast:0 row_mask:0xf bank_mask:0xf
    v_mul_f32_dpp v197, v243, v81 row_newbcast:1 row_mask:0xf bank_mask:0xf
    v_mul_f32_dpp v198, v243, v80 row_newbcast:8 row_mask:0xf bank_mask:0xf
    v_mul_f32_dpp v199, v243, v81 row_newbcast:9 row_mask:0xf bank_mask:0xf
    v_mul_f32_dpp v200, v243, v84 row_newbcast:2 row_mask:0xf bank_mask:0xf
    v_mul_f32_dpp v201, v243, v85 row_newbcast:3 row_mask:0xf bank_mask:0xf
    s_add_u32 m0, s21, 0
    v_mfma_f32_32x32x16_bf16 v[16:31], v[76:79], v[176:179], 0
    buffer_load_dwordx4 v236, s[4:7], s35 offen  lds
    buffer_load_dwordx4 v237, s[8:11], s35 offen offset:1024  lds
    ds_read_b64_tr_b16 v[176:177], v244 offset:2048
    ds_read_b64_tr_b16 v[178:179], v244 offset:3072
    ds_read_b64_tr_b16 v[184:185], v245 offset:2048
    ds_read_b64_tr_b16 v[186:187], v245 offset:3072
    v_mul_f32_dpp v202, v243, v84 row_newbcast:10 row_mask:0xf bank_mask:0xf
    v_mul_f32_dpp v203, v243, v85 row_newbcast:11 row_mask:0xf bank_mask:0xf
    v_cvt_pk_bf16_f32 v80, v196, v197
    v_cvt_pk_bf16_f32 v84, v198, v199
    v_cvt_pk_bf16_f32 v81, v200, v201
    v_cvt_pk_bf16_f32 v85, v202, v203
    v_mul_f32_dpp v196, v243, v82 row_newbcast:4 row_mask:0xf bank_mask:0xf
    v_mul_f32_dpp v197, v243, v83 row_newbcast:5 row_mask:0xf bank_mask:0xf
    v_mul_f32_dpp v198, v243, v82 row_newbcast:12 row_mask:0xf bank_mask:0xf
    v_mul_f32_dpp v199, v243, v83 row_newbcast:13 row_mask:0xf bank_mask:0xf
    v_mul_f32_dpp v200, v243, v86 row_newbcast:6 row_mask:0xf bank_mask:0xf
    v_mul_f32_dpp v201, v243, v87 row_newbcast:7 row_mask:0xf bank_mask:0xf
    v_mul_f32_dpp v202, v243, v86 row_newbcast:14 row_mask:0xf bank_mask:0xf
    v_mul_f32_dpp v203, v243, v87 row_newbcast:15 row_mask:0xf bank_mask:0xf
    v_cvt_pk_bf16_f32 v82, v196, v197
    v_cvt_pk_bf16_f32 v86, v198, v199
    v_cvt_pk_bf16_f32 v83, v200, v201
    v_cvt_pk_bf16_f32 v87, v202, v203
    s_waitcnt vmcnt(4) lgkmcnt(0)
    v_mfma_f32_32x32x16_bf16 v[56:71], v[80:83], v[176:179], v[56:71]
    v_mul_f32_dpp v196, v242, v88 row_newbcast:0 row_mask:0xf bank_mask:0xf
    v_mul_f32_dpp v197, v242, v89 row_newbcast:1 row_mask:0xf bank_mask:0xf
    v_mul_f32_dpp v198, v242, v88 row_newbcast:8 row_mask:0xf bank_mask:0xf
    v_mul_f32_dpp v199, v242, v89 row_newbcast:9 row_mask:0xf bank_mask:0xf
    v_mul_f32_dpp v200, v242, v92 row_newbcast:2 row_mask:0xf bank_mask:0xf
    v_mul_f32_dpp v201, v242, v93 row_newbcast:3 row_mask:0xf bank_mask:0xf
    s_add_u32 m0, s21, 2048
    v_mfma_f32_32x32x16_bf16 v[16:31], v[84:87], v[176:179], v[16:31]
    buffer_load_dwordx4 v238, s[4:7], s35 offen  lds
    buffer_load_dwordx4 v239, s[8:11], s35 offen offset:1024  lds
    ds_read_b64_tr_b16 v[176:177], v244 offset:4096
    ds_read_b64_tr_b16 v[178:179], v244 offset:5120
    ds_read_b64_tr_b16 v[188:189], v245 offset:4096
    ds_read_b64_tr_b16 v[190:191], v245 offset:5120
    v_mul_f32_dpp v202, v242, v92 row_newbcast:10 row_mask:0xf bank_mask:0xf
    v_mul_f32_dpp v203, v242, v93 row_newbcast:11 row_mask:0xf bank_mask:0xf
    v_cvt_pk_bf16_f32 v88, v196, v197
    v_cvt_pk_bf16_f32 v92, v198, v199
    v_cvt_pk_bf16_f32 v89, v200, v201
    v_cvt_pk_bf16_f32 v93, v202, v203
    v_mul_f32_dpp v196, v242, v90 row_newbcast:4 row_mask:0xf bank_mask:0xf
    v_mul_f32_dpp v197, v242, v91 row_newbcast:5 row_mask:0xf bank_mask:0xf
    v_mul_f32_dpp v198, v242, v90 row_newbcast:12 row_mask:0xf bank_mask:0xf
    v_mul_f32_dpp v199, v242, v91 row_newbcast:13 row_mask:0xf bank_mask:0xf
    v_mul_f32_dpp v200, v242, v94 row_newbcast:6 row_mask:0xf bank_mask:0xf
    v_mul_f32_dpp v201, v242, v95 row_newbcast:7 row_mask:0xf bank_mask:0xf
    v_mul_f32_dpp v202, v242, v94 row_newbcast:14 row_mask:0xf bank_mask:0xf
    v_mul_f32_dpp v203, v242, v95 row_newbcast:15 row_mask:0xf bank_mask:0xf
    v_cvt_pk_bf16_f32 v90, v196, v197
    v_cvt_pk_bf16_f32 v94, v198, v199
    v_cvt_pk_bf16_f32 v91, v200, v201
    v_cvt_pk_bf16_f32 v95, v202, v203
    s_waitcnt lgkmcnt(0)
    v_mfma_f32_32x32x16_bf16 v[56:71], v[88:91], v[176:179], v[56:71]
    s_add_u32 m0, s21, 4096
    v_mfma_f32_32x32x16_bf16 v[16:31], v[92:95], v[176:179], v[16:31]
    buffer_load_dwordx4 v234, s[4:7], s36 offen  lds
    buffer_load_dwordx4 v235, s[8:11], s36 offen offset:1024  lds
    s_mov_b32 m0, s50
    s_nop 0
    s_movrels_b32 s71, s23
    s_movrels_b32 s33, s28
    v_add_u32 v253, s33, v248
    s_bfe_u32 s46, s71, 0x30012
    s_mov_b32 m0, s46
    s_and_b32 s66, s71, 0x3ffff
    s_movrels_b32 s68, s57
    s_movrels_b32 s69, s61
    s_sub_u32 s48, s66, s47
    s_mov_b32 s47, s66
    s_lshr_b32 s52, s71, 28
    s_lshl_b32 s67, s46, 9
    s_add_u32 s66, s66, s67
    s_sub_u32 s49, s66, s42
    s_mov_b32 s42, s66
    s_bfe_u32 s66, s68, 655360
    s_add_u32 s43, s42, s66
    s_bfe_u32 s39, s69, 655360
    s_bfe_u32 s66, s68, 655370
    s_add_u32 s44, s42, s66
    s_bfe_u32 s40, s69, 655370
    s_bfe_u32 s66, s68, 655380
    s_add_u32 s45, s42, s66
    s_bfe_u32 s41, s69, 655380
    v_add_u32 v252, s45, v247
    ds_read2_b32 v[240:241], v252 offset0:0 offset1:16
    v_mfma_f32_32x32x16_bf16 v[32:47], v[72:75], v[180:183], 0
    v_mul_f32 v196, v56, v96
    v_fmac_f32 v196, v57, v97
    v_fmac_f32 v196, v58, v98
    v_fmac_f32 v196, v59, v99
    v_fmac_f32 v196, v60, v100
    v_fmac_f32 v196, v61, v101
    v_mfma_f32_32x32x16_bf16 v[0:15], v[76:79], v[180:183], 0
    v_fmac_f32 v196, v62, v102
    v_fmac_f32 v196, v63, v103
    v_mul_f32 v198, v64, v128
    v_fmac_f32 v198, v65, v129
    v_fmac_f32 v198, v66, v130
    v_fmac_f32 v198, v67, v131
    v_mfma_f32_32x32x16_bf16 v[32:47], v[80:83], v[184:187], v[32:47]
    v_fmac_f32 v198, v68, v132
    v_fmac_f32 v198, v69, v133
    v_fmac_f32 v198, v70, v134
    v_fmac_f32 v198, v71, v135
    v_mul_f32 v200, v16, v128
    v_fmac_f32 v200, v17, v129
    v_mfma_f32_32x32x16_bf16 v[0:15], v[84:87], v[184:187], v[0:15]
    s_waitcnt vmcnt(6)
    ds_read_b64_tr_b16 v[176:177], v244 offset:6144
    ds_read_b64_tr_b16 v[178:179], v244 offset:7168
    ds_read_b64_tr_b16 v[180:181], v245 offset:6144
    ds_read_b64_tr_b16 v[182:183], v245 offset:7168
    v_permlane32_swap_b32 v196, v198
    v_fmac_f32 v200, v18, v130
    v_mfma_f32_32x32x16_bf16 v[32:47], v[88:91], v[188:191], v[32:47]
    v_fmac_f32 v200, v19, v131
    v_fmac_f32 v200, v20, v132
    v_fmac_f32 v200, v21, v133
    v_fmac_f32 v200, v22, v134
    v_fmac_f32 v200, v23, v135
    v_add_f32 v198, v196, v198
    v_mfma_f32_32x32x16_bf16 v[0:15], v[92:95], v[188:191], v[0:15]
    v_mul_f32_e64 v202, v24, -v128
    v_fma_f32 v202, v25, -v129, v202
    v_fma_f32 v202, v26, -v130, v202
    v_fma_f32 v202, v27, -v131, v202
    v_fma_f32 v202, v28, -v132, v202
    v_fma_f32 v202, v29, -v133, v202
    v_fma_f32 v202, v30, -v134, v202
    v_fma_f32 v202, v31, -v135, v202
    s_nop 1
    v_permlane32_swap_b32 v200, v202
    v_add_f32 v202, v200, v202
    s_waitcnt vmcnt(4) lgkmcnt(0)
    v_mfma_f32_32x32x16_bf16 v[56:71], v[72:75], v[176:179], 0
    v_mul_f32 v197, v32, v104
    v_fmac_f32 v197, v33, v105
    v_fmac_f32 v197, v34, v106
    v_fmac_f32 v197, v35, v107
    v_fmac_f32 v197, v36, v108
    v_fmac_f32 v197, v37, v109
    s_add_u32 m0, s21, 6144
    v_mfma_f32_32x32x16_bf16 v[16:31], v[76:79], v[176:179], 0
    buffer_load_dwordx4 v236, s[4:7], s36 offen  lds
    buffer_load_dwordx4 v237, s[8:11], s36 offen offset:1024  lds
    ds_read_b64_tr_b16 v[176:177], v244 offset:0
    ds_read_b64_tr_b16 v[178:179], v244 offset:1024
    ds_read_b64_tr_b16 v[184:185], v245 offset:0
    ds_read_b64_tr_b16 v[186:187], v245 offset:1024
    v_fmac_f32 v197, v38, v110
    v_fmac_f32 v197, v39, v111
    v_mul_f32 v199, v40, v136
    v_fmac_f32 v199, v41, v137
    v_fmac_f32 v199, v42, v138
    v_fmac_f32 v199, v43, v139
    v_fmac_f32 v199, v44, v140
    v_fmac_f32 v199, v45, v141
    v_fmac_f32 v199, v46, v142
    v_fmac_f32 v199, v47, v143
    v_mul_f32 v201, v0, v136
    v_fmac_f32 v201, v1, v137
    v_permlane32_swap_b32 v197, v199
    v_fmac_f32 v201, v2, v138
    v_fmac_f32 v201, v3, v139
    v_fmac_f32 v201, v4, v140
    v_fmac_f32 v201, v5, v141
    v_fmac_f32 v201, v6, v142
    s_waitcnt vmcnt(4) lgkmcnt(0)
    v_mfma_f32_32x32x16_bf16 v[56:71], v[80:83], v[176:179], v[56:71]
    v_fmac_f32 v201, v7, v143
    v_add_f32 v199, v197, v199
    v_mul_f32_e64 v203, v8, -v136
    v_fma_f32 v203, v9, -v137, v203
    v_fma_f32 v203, v10, -v138, v203
    v_fma_f32 v203, v11, -v139, v203
    s_add_u32 m0, s21, 0
    v_mfma_f32_32x32x16_bf16 v[16:31], v[84:87], v[176:179], v[16:31]
    buffer_load_dwordx4 v238, s[4:7], s36 offen  lds
    buffer_load_dwordx4 v239, s[8:11], s36 offen offset:1024  lds
    ds_read_b64_tr_b16 v[176:177], v244 offset:2048
    ds_read_b64_tr_b16 v[178:179], v244 offset:3072
    ds_read_b64_tr_b16 v[188:189], v245 offset:2048
    ds_read_b64_tr_b16 v[190:191], v245 offset:3072
    s_waitcnt lgkmcnt(0)
    v_mfma_f32_32x32x16_bf16 v[56:71], v[88:91], v[176:179], v[56:71]
    v_fma_f32 v203, v12, -v140, v203
    v_fma_f32 v203, v13, -v141, v203
    v_fma_f32 v203, v14, -v142, v203
    v_fma_f32 v203, v15, -v143, v203
    s_nop 1
    v_permlane32_swap_b32 v201, v203
    v_add_f32 v203, v201, v203
    s_add_u32 m0, s21, 2048
    v_mfma_f32_32x32x16_bf16 v[16:31], v[92:95], v[176:179], v[16:31]
    buffer_load_dwordx4 v234, s[4:7], s37 offen  lds
    buffer_load_dwordx4 v235, s[8:11], s37 offen offset:1024  lds
    v_add_u32 v252, s42, v247
    ds_read2_b32 v[234:235], v252 offset0:0 offset1:16
    v_cvt_pk_bf16_f32 v192, v198, v199
    v_cvt_pk_bf16_f32 v193, v202, v203
    v_mfma_f32_32x32x16_bf16 v[32:47], v[72:75], v[180:183], 0
    v_mul_f32 v196, v56, v144
    v_fmac_f32 v196, v57, v145
    v_fmac_f32 v196, v58, v146
    v_fmac_f32 v196, v59, v147
    v_fmac_f32 v196, v60, v148
    v_fmac_f32 v196, v61, v149
    v_mfma_f32_32x32x16_bf16 v[0:15], v[76:79], v[180:183], 0
    v_fmac_f32 v196, v62, v150
    v_fmac_f32 v196, v63, v151
    v_mul_f32_e64 v200, v16, -v160
    v_fma_f32 v200, v17, -v161, v200
    v_fma_f32 v200, v18, -v162, v200
    v_fma_f32 v200, v19, -v163, v200
    v_mfma_f32_32x32x16_bf16 v[32:47], v[80:83], v[184:187], v[32:47]
    v_fma_f32 v200, v20, -v164, v200
    v_fma_f32 v200, v21, -v165, v200
    v_fma_f32 v200, v22, -v166, v200
    v_fma_f32 v200, v23, -v167, v200
    v_mul_f32_e64 v202, v24, -v160
    v_fma_f32 v202, v25, -v161, v202
    v_mfma_f32_32x32x16_bf16 v[0:15], v[84:87], v[184:187], v[0:15]
    s_waitcnt vmcnt(6)
    ds_read_b64_tr_b16 v[176:177], v244 offset:4096
    ds_read_b64_tr_b16 v[178:179], v244 offset:5120
    ds_read_b64_tr_b16 v[180:181], v245 offset:4096
    ds_read_b64_tr_b16 v[182:183], v245 offset:5120
    v_fma_f32 v202, v26, -v162, v202
    v_fma_f32 v202, v27, -v163, v202
    v_mfma_f32_32x32x16_bf16 v[32:47], v[88:91], v[188:191], v[32:47]
    v_fma_f32 v202, v28, -v164, v202
    v_fma_f32 v202, v29, -v165, v202
    v_fma_f32 v202, v30, -v166, v202
    v_fma_f32 v202, v31, -v167, v202
    v_mfma_f32_32x32x16_bf16 v[0:15], v[92:95], v[188:191], v[0:15]
    s_waitcnt vmcnt(4) lgkmcnt(0)
    v_mfma_f32_32x32x16_bf16 v[16:31], v[72:75], v[176:179], 0
    s_nop 4
    v_mul_f32 v197, v32, v152
    v_fmac_f32 v197, v33, v153
    v_fmac_f32 v197, v34, v154
    v_fmac_f32 v197, v35, v155
    v_fmac_f32 v197, v36, v156
    v_fmac_f32 v197, v37, v157
    s_add_u32 m0, s21, 4096
    v_mfma_f32_32x32x16_bf16 v[48:63], v[76:79], v[176:179], 0
    buffer_load_dwordx4 v236, s[4:7], s37 offen  lds
    buffer_load_dwordx4 v237, s[8:11], s37 offen offset:1024  lds
    ds_read_b64_tr_b16 v[176:177], v244 offset:6144
    ds_read_b64_tr_b16 v[178:179], v244 offset:7168
    ds_read_b64_tr_b16 v[184:185], v245 offset:6144
    ds_read_b64_tr_b16 v[186:187], v245 offset:7168
    v_add_u32 v252, s43, v247
    ds_read2_b32 v[236:237], v252 offset0:0 offset1:16
    v_fmac_f32 v197, v38, v158
    v_fmac_f32 v197, v39, v159
    v_mul_f32_e64 v201, v0, -v168
    v_fma_f32 v201, v1, -v169, v201
    s_waitcnt vmcnt(4) lgkmcnt(1)
    v_mfma_f32_32x32x16_bf16 v[16:31], v[80:83], v[176:179], v[16:31]
    v_fma_f32 v201, v2, -v170, v201
    v_fma_f32 v201, v3, -v171, v201
    v_fma_f32 v201, v4, -v172, v201
    v_fma_f32 v201, v5, -v173, v201
    v_fma_f32 v201, v6, -v174, v201
    v_fma_f32 v201, v7, -v175, v201
    s_add_u32 m0, s21, 6144
    v_mfma_f32_32x32x16_bf16 v[48:63], v[84:87], v[176:179], v[48:63]
    buffer_load_dwordx4 v238, s[4:7], s37 offen  lds
    buffer_load_dwordx4 v239, s[8:11], s37 offen offset:1024  lds
    ds_read_b64_tr_b16 v[176:177], v244 offset:0
    ds_read_b64_tr_b16 v[178:179], v244 offset:1024
    ds_read_b64_tr_b16 v[188:189], v245 offset:0
    ds_read_b64_tr_b16 v[190:191], v245 offset:1024
    v_add_u32 v252, s44, v247
    ds_read2_b32 v[238:239], v252 offset0:0 offset1:16
    s_waitcnt lgkmcnt(1)
    v_mfma_f32_32x32x16_bf16 v[16:31], v[88:91], v[176:179], v[16:31]
    v_mul_f32_e64 v203, v8, -v168
    v_fma_f32 v203, v9, -v169, v203
    v_fma_f32 v203, v10, -v170, v203
    v_fma_f32 v203, v11, -v171, v203
    v_fma_f32 v203, v12, -v172, v203
    v_fma_f32 v203, v13, -v173, v203
    s_add_u32 m0, s21, 0
    v_mfma_f32_32x32x16_bf16 v[48:63], v[92:95], v[176:179], v[48:63]
    s_cbranch_vccnz WL_6_0
    v_mad_u32_u16 v234, v234, s3, v246 op_sel:[1,0,0,0]
    v_mad_u32_u16 v235, v235, s3, v246 op_sel:[1,0,0,0]
    buffer_load_dwordx4 v234, s[4:7], s38 offen  lds
    buffer_load_dwordx4 v235, s[8:11], s38 offen offset:1024  lds
WR_6_0:
    v_fma_f32 v203, v14, -v174, v203
    v_fma_f32 v203, v15, -v175, v203
    v_mfma_f32_32x32x16_bf16 v[0:15], v[72:75], v[180:183], 0
    v_fmac_f32 v200, v24, v160
    v_fmac_f32 v200, v25, v161
    v_fmac_f32 v200, v26, v162
    v_fmac_f32 v200, v27, v163
    v_fmac_f32 v200, v28, v164
    v_fmac_f32 v200, v29, v165
    v_fmac_f32 v200, v30, v166
    v_fmac_f32 v200, v31, v167
    v_mfma_f32_32x32x16_bf16 v[24:39], v[76:79], v[180:183], 0
    v_mul_f32 v254, v16, v144
    v_fmac_f32 v254, v17, v145
    v_fmac_f32 v254, v18, v146
    v_fmac_f32 v254, v19, v147
    v_fmac_f32 v254, v20, v148
    v_fmac_f32 v254, v21, v149
    v_mfma_f32_32x32x16_bf16 v[0:15], v[80:83], v[184:187], v[0:15]
    v_fmac_f32 v254, v22, v150
    v_fmac_f32 v254, v23, v151
    v_sub_f32_e64 v64, -v48, v64
    v_sub_f32_e64 v65, -v49, v65
    v_permlane32_swap_b32 v196, v254
    v_sub_f32_e64 v66, -v50, v66
    v_mfma_f32_32x32x16_bf16 v[24:39], v[84:87], v[184:187], v[24:39]
    s_waitcnt vmcnt(6)
    ds_read_b64_tr_b16 v[176:177], v244 offset:2048
    ds_read_b64_tr_b16 v[178:179], v244 offset:3072
    ds_read_b64_tr_b16 v[180:181], v245 offset:2048
    ds_read_b64_tr_b16 v[182:183], v245 offset:3072
    v_sub_f32_e64 v67, -v51, v67
    v_sub_f32_e64 v68, -v52, v68
    v_mfma_f32_32x32x16_bf16 v[24:39], v[92:95], v[188:191], v[24:39]
    v_sub_f32_e64 v69, -v53, v69
    v_sub_f32_e64 v70, -v54, v70
    v_sub_f32_e64 v71, -v55, v71
    v_add_f32 v254, v196, v254
    v_mfma_f32_32x32x16_bf16 v[0:15], v[88:91], v[188:191], v[0:15]
    s_waitcnt vmcnt(4) lgkmcnt(0)
    v_mfma_f32_32x32x16_bf16 v[56:71], v[76:79], v[176:179], v[56:71]
    s_nop 4
    v_sub_f32_e64 v40, -v24, v40
    v_sub_f32_e64 v41, -v25, v41
    v_sub_f32_e64 v42, -v26, v42
    v_sub_f32_e64 v43, -v27, v43
    v_sub_f32_e64 v44, -v28, v44
    v_sub_f32_e64 v45, -v29, v45
    v_sub_f32_e64 v46, -v30, v46
    v_sub_f32_e64 v47, -v31, v47
    s_add_u32 m0, s21, 2048
    v_mfma_f32_32x32x16_bf16 v[16:31], v[72:75], v[176:179], 0
    s_cbranch_vccnz WL_6_1
    v_mad_u32_u16 v236, v236, s3, v246 op_sel:[1,0,0,0]
    v_mad_u32_u16 v237, v237, s3, v246 op_sel:[1,0,0,0]
    buffer_load_dwordx4 v236, s[4:7], s39 offen  lds
    buffer_load_dwordx4 v237, s[8:11], s39 offen offset:1024  lds
WR_6_1:
    ds_read_b64_tr_b16 v[176:177], v244 offset:4096
    ds_read_b64_tr_b16 v[178:179], v244 offset:5120
    ds_read_b64_tr_b16 v[184:185], v245 offset:4096
    ds_read_b64_tr_b16 v[186:187], v245 offset:5120
    v_mul_f32 v255, v0, v152
    v_fmac_f32 v255, v1, v153
    v_fmac_f32 v255, v2, v154
    v_fmac_f32 v255, v3, v155
    v_fmac_f32 v255, v4, v156
    s_waitcnt vmcnt(4) lgkmcnt(0)
    v_mfma_f32_32x32x16_bf16 v[16:31], v[80:83], v[176:179], v[16:31]
    v_fmac_f32 v255, v5, v157
    v_fmac_f32 v255, v6, v158
    v_fmac_f32 v255, v7, v159
    v_fmac_f32 v201, v8, v168
    v_fmac_f32 v201, v9, v169
    v_permlane32_swap_b32 v197, v255
    s_add_u32 m0, s21, 4096
    v_mfma_f32_32x32x16_bf16 v[56:71], v[84:87], v[176:179], v[56:71]
    s_cbranch_vccnz WL_6_2
    v_mad_u32_u16 v238, v238, s3, v246 op_sel:[1,0,0,0]
    v_mad_u32_u16 v239, v239, s3, v246 op_sel:[1,0,0,0]
    buffer_load_dwordx4 v238, s[4:7], s40 offen  lds
    buffer_load_dwordx4 v239, s[8:11], s40 offen offset:1024  lds
WR_6_2:
    ds_read_b64_tr_b16 v[176:177], v244 offset:6144
    ds_read_b64_tr_b16 v[178:179], v244 offset:7168
    ds_read_b64_tr_b16 v[188:189], v245 offset:6144
    ds_read_b64_tr_b16 v[190:191], v245 offset:7168
    s_waitcnt lgkmcnt(0)
    v_mfma_f32_32x32x16_bf16 v[16:31], v[88:91], v[176:179], v[16:31]
    v_fmac_f32 v201, v10, v170
    v_fmac_f32 v201, v11, v171
    v_fmac_f32 v201, v12, v172
    v_fmac_f32 v201, v13, v173
    v_fmac_f32 v201, v14, v174
    v_fmac_f32 v201, v15, v175
    s_add_u32 m0, s21, 6144
    v_mfma_f32_32x32x16_bf16 v[56:71], v[92:95], v[176:179], v[56:71]
    s_cbranch_vccnz WL_6_3
    v_mad_u32_u16 v240, v240, s3, v246 op_sel:[1,0,0,0]
    v_mad_u32_u16 v241, v241, s3, v246 op_sel:[1,0,0,0]
    buffer_load_dwordx4 v240, s[4:7], s41 offen  lds
    buffer_load_dwordx4 v241, s[8:11], s41 offen offset:1024  lds
WR_6_3:
    v_add_f32 v255, v197, v255
    v_cvt_pk_bf16_f32 v194, v254, v255
    v_mfma_f32_32x32x16_bf16 v[0:15], v[72:75], v[180:183], 0
    v_mul_f32 v254, v16, v144
    v_fmac_f32 v254, v17, v145
    v_fmac_f32 v254, v18, v146
    v_fmac_f32 v254, v19, v147
    v_fmac_f32 v254, v20, v148
    v_fmac_f32 v254, v21, v149
    v_mfma_f32_32x32x16_bf16 v[32:47], v[76:79], v[180:183], v[32:47]
    v_fmac_f32 v254, v22, v150
    v_fmac_f32 v254, v23, v151
    v_fma_f32 v202, v24, -v160, v202
    v_fma_f32 v202, v25, -v161, v202
    v_permlane32_swap_b32 v254, v200
    v_fma_f32 v202, v26, -v162, v202
    v_mfma_f32_32x32x16_bf16 v[0:15], v[80:83], v[184:187], v[0:15]
    v_fma_f32 v202, v27, -v163, v202
    v_fma_f32 v202, v28, -v164, v202
    v_fma_f32 v202, v29, -v165, v202
    v_fma_f32 v202, v30, -v166, v202
    v_fma_f32 v202, v31, -v167, v202
    v_add_f32 v200, v254, v200
    v_mfma_f32_32x32x16_bf16 v[32:47], v[84:87], v[184:187], v[32:47]
    s_waitcnt vmcnt(6)
    ds_read_b64_tr_b16 v[176:177], v244 offset:0
    ds_read_b64_tr_b16 v[178:179], v244 offset:1024
    ds_read_b64_tr_b16 v[180:181], v245 offset:0
    ds_read_b64_tr_b16 v[182:183], v245 offset:1024
    v_mul_f32_e64 v198, v64, -v112
    v_permlane32_swap_b32 v202, v254
    v_mfma_f32_32x32x16_bf16 v[0:15], v[88:91], v[188:191], v[0:15]
    v_fma_f32 v198, v65, -v113, v198
    v_fma_f32 v198, v66, -v114, v198
    v_fma_f32 v198, v67, -v115, v198
    v_fma_f32 v198, v68, -v116, v198
    v_fma_f32 v198, v69, -v117, v198
    v_fma_f32 v198, v70, -v118, v198
    v_mfma_f32_32x32x16_bf16 v[32:47], v[92:95], v[188:191], v[32:47]
    v_add_u32 v249, s48, v249
    v_add_u32 v250, s49, v250
    ds_read_b32 v252, v251 offset:16
    ds_read_b64_tr_b16 v[72:73], v249 offset:0
    ds_read_b64_tr_b16 v[76:77], v249 offset:64
    ds_read_b64_tr_b16 v[74:75], v249 offset:256
    ds_read_b64_tr_b16 v[78:79], v249 offset:320
    s_mov_b64 exec, s[54:55]
    ds_read_u16_d16_hi v242, v250 offset:0
    s_mov_b64 exec, -1
    v_fma_f32 v198, v71, -v119, v198
    v_add_f32 v254, v202, v254
    v_mul_f32 v196, v56, v160
    v_fmac_f32 v196, v57, v161
    v_fmac_f32 v196, v58, v162
    v_fmac_f32 v196, v59, v163
    v_fmac_f32 v196, v60, v164
    v_fmac_f32 v196, v61, v165
    v_fmac_f32 v196, v62, v166
    v_fmac_f32 v196, v63, v167
    s_nop 1
    v_permlane32_swap_b32 v198, v196
    v_add_f32 v196, v198, v196
    s_cbranch_vccnz LEPI_0
    v_mul_f32 v255, v0, v152
    v_fmac_f32 v255, v1, v153
    v_fmac_f32 v255, v2, v154
    v_fmac_f32 v255, v3, v155
    v_fmac_f32 v255, v4, v156
    v_fmac_f32 v255, v5, v157
    v_fmac_f32 v255, v6, v158
    v_fmac_f32 v255, v7, v159
    v_fma_f32 v203, v8, -v168, v203
    v_fma_f32 v203, v9, -v169, v203
    v_permlane32_swap_b32 v255, v201
    v_fma_f32 v203, v10, -v170, v203
    v_fma_f32 v203, v11, -v171, v203
    v_fma_f32 v203, v12, -v172, v203
    v_fma_f32 v203, v13, -v173, v203
    v_fma_f32 v203, v14, -v174, v203
    v_fma_f32 v203, v15, -v175, v203
    v_add_f32 v201, v255, v201
    v_mul_f32_e64 v199, v40, -v120
    v_permlane32_swap_b32 v203, v255
    v_fma_f32 v199, v41, -v121, v199
    v_fma_f32 v199, v42, -v122, v199
    v_fma_f32 v199, v43, -v123, v199
    v_fma_f32 v199, v44, -v124, v199
    v_fma_f32 v199, v45, -v125, v199
    v_fma_f32 v199, v46, -v126, v199
    v_fma_f32 v199, v47, -v127, v199
    v_add_f32 v255, v203, v255
    v_mul_f32 v197, v32, v168
    v_fmac_f32 v197, v33, v169
    v_fmac_f32 v197, v34, v170
    v_fmac_f32 v197, v35, v171
    v_fmac_f32 v197, v36, v172
    v_fmac_f32 v197, v37, v173
    v_fmac_f32 v197, v38, v174
    v_fmac_f32 v197, v39, v175
    s_nop 1
    v_permlane32_swap_b32 v199, v197
    v_add_f32 v197, v199, v197
    v_cvt_pk_bf16_f32 v200, v200, v201
    v_cvt_pk_bf16_f32 v254, v254, v255
    v_cvt_pk_bf16_f32 v196, v196, v197
    ds_write2st64_b32 v253, v192, v193 offset0:0 offset1:1
    ds_write2st64_b32 v253, v194, v200 offset0:2 offset1:3
    ds_write_b32 v253, v196 offset:1024
    s_mov_b64 exec, 0xffffffff
    ds_write_b32 v253, v254 offset:1280
    s_mov_b64 exec, -1
    s_add_u32 s50, s50, 1
    s_cmp_ge_u32 s50, 4
    s_cbranch_scc1 LAST1
    s_waitcnt lgkmcnt(9)
    v_readfirstlane_b32 s66, v252
    s_add_u32 s53, s53, 1
    v_mov_b32 v252, s53
    s_cmp_le_u32 s53, s66
    ds_write2_b32 v251, v252, v252 offset0:0 offset1:8
    s_setprio 1
    s_cbranch_scc1 PRIO_14
    s_setprio 0
PRIO_14:
    s_cmp_eq_u32 s52, 4
    s_cbranch_scc1 ITEM_1_4
    s_cmp_eq_u32 s52, 5
    s_cbranch_scc1 ITEM_1_5
    s_cmp_eq_u32 s52, 3
    s_cbranch_scc1 ITEM_1_3
    s_cmp_eq_u32 s52, 6
    s_cbranch_scc1 ITEM_1_6
    s_cmp_eq_u32 s52, 8
    s_cbranch_scc1 ITEM_1_8
    s_branch ITEM_1_2
WL_6_0:
    s_add_u32 s66, s51, 0
    buffer_load_dwordx4 v[96:99], v246, s[16:19], s66 offen offset:2048 sc1
    buffer_load_dwordx4 v[100:103], v246, s[16:19], s66 offen offset:3072 sc1
    s_branch WR_6_0
WL_6_1:
    s_add_u32 s66, s51, 4096
    buffer_load_dwordx4 v[104:107], v246, s[16:19], s66 offen offset:2048 sc1
    buffer_load_dwordx4 v[108:111], v246, s[16:19], s66 offen offset:3072 sc1
    s_branch WR_6_1
WL_6_2:
    s_add_u32 s66, s51, 8192
    buffer_load_dwordx4 v[128:131], v246, s[16:19], s66 offen offset:2048 sc1
    buffer_load_dwordx4 v[132:135], v246, s[16:19], s66 offen offset:3072 sc1
    s_branch WR_6_2
WL_6_3:
    s_add_u32 s66, s51, 12288
    buffer_load_dwordx4 v[136:139], v246, s[16:19], s66 offen offset:2048 sc1
    buffer_load_dwordx4 v[140:143], v246, s[16:19], s66 offen offset:3072 sc1
    s_branch WR_6_3
.p2align 6
ITEM_1_8:
    s_mov_b64 exec, s[54:55]
    ds_read_u16_d16_hi v243, v250 offset:128
    s_mov_b64 exec, -1
    ds_read_b64_tr_b16 v[80:81], v249 offset:512
    ds_read_b64_tr_b16 v[84:85], v249 offset:576
    ds_read_b64_tr_b16 v[82:83], v249 offset:768
    ds_read_b64_tr_b16 v[86:87], v249 offset:832
    ds_read_b64_tr_b16 v[88:89], v249 offset:1024
    ds_read_b64_tr_b16 v[92:93], v249 offset:1088
    ds_read_b64_tr_b16 v[90:91], v249 offset:1280
    ds_read_b64_tr_b16 v[94:95], v249 offset:1344
    ds_read_b64_tr_b16 v[64:65], v249 offset:1536
    ds_read_b64_tr_b16 v[68:69], v249 offset:1600
    ds_read_b64_tr_b16 v[66:67], v249 offset:1792
    ds_read_b64_tr_b16 v[70:71], v249 offset:1856
    s_waitcnt lgkmcnt(13)
    v_mul_f32_dpp v196, v242, v72 row_newbcast:0 row_mask:0xf bank_mask:0xf
    v_mul_f32_dpp v197, v242, v73 row_newbcast:1 row_mask:0xf bank_mask:0xf
    v_mul_f32_dpp v198, v242, v72 row_newbcast:8 row_mask:0xf bank_mask:0xf
    v_mul_f32_dpp v199, v242, v73 row_newbcast:9 row_mask:0xf bank_mask:0xf
    v_mul_f32_dpp v200, v242, v76 row_newbcast:2 row_mask:0xf bank_mask:0xf
    v_mul_f32_dpp v201, v242, v77 row_newbcast:3 row_mask:0xf bank_mask:0xf
    v_mul_f32_dpp v202, v242, v76 row_newbcast:10 row_mask:0xf bank_mask:0xf
    v_mul_f32_dpp v203, v242, v77 row_newbcast:11 row_mask:0xf bank_mask:0xf
    v_cvt_pk_bf16_f32 v72, v196, v197
    v_cvt_pk_bf16_f32 v76, v198, v199
    v_cvt_pk_bf16_f32 v73, v200, v201
    v_cvt_pk_bf16_f32 v77, v202, v203
    v_mul_f32_dpp v196, v242, v74 row_newbcast:4 row_mask:0xf bank_mask:0xf
    v_mul_f32_dpp v197, v242, v75 row_newbcast:5 row_mask:0xf bank_mask:0xf
    v_mul_f32_dpp v198, v242, v74 row_newbcast:12 row_mask:0xf bank_mask:0xf
    v_mul_f32_dpp v199, v242, v75 row_newbcast:13 row_mask:0xf bank_mask:0xf
    v_mul_f32_dpp v200, v242, v78 row_newbcast:6 row_mask:0xf bank_mask:0xf
    v_mul_f32_dpp v201, v242, v79 row_newbcast:7 row_mask:0xf bank_mask:0xf
    v_mul_f32_dpp v202, v242, v78 row_newbcast:14 row_mask:0xf bank_mask:0xf
    v_mul_f32_dpp v203, v242, v79 row_newbcast:15 row_mask:0xf bank_mask:0xf
    v_cvt_pk_bf16_f32 v74, v196, v197
    v_cvt_pk_bf16_f32 v78, v198, v199
    v_cvt_pk_bf16_f32 v75, v200, v201
    v_cvt_pk_bf16_f32 v79, v202, v203
    s_mov_b64 exec, s[54:55]
    ds_read_u16_d16_hi v242, v250 offset:256
    s_mov_b64 exec, -1
    s_waitcnt vmcnt(4) lgkmcnt(9)
    v_mfma_f32_32x32x16_bf16 v[0:15], v[72:75], v[176:179], 0
    v_mul_f32_dpp v196, v243, v80 row_newbcast:0 row_mask:0xf bank_mask:0xf
    v_mul_f32_dpp v197, v243, v81 row_newbcast:1 row_mask:0xf bank_mask:0xf
    v_mul_f32_dpp v198, v243, v80 row_newbcast:8 row_mask:0xf bank_mask:0xf
    v_mul_f32_dpp v199, v243, v81 row_newbcast:9 row_mask:0xf bank_mask:0xf
    v_mul_f32_dpp v200, v243, v84 row_newbcast:2 row_mask:0xf bank_mask:0xf
    v_mul_f32_dpp v201, v243, v85 row_newbcast:3 row_mask:0xf bank_mask:0xf
    s_add_u32 m0, s21, 0
    v_mfma_f32_32x32x16_bf16 v[48:63], v[76:79], v[176:179], 0
    buffer_load_dwordx4 v234, s[4:7], s35 offen  lds
    buffer_load_dwordx4 v235, s[8:11], s35 offen offset:1024  lds
    ds_read_b64_tr_b16 v[176:177], v244 offset:2048
    ds_read_b64_tr_b16 v[178:179], v244 offset:3072
    ds_read_b64_tr_b16 v[184:185], v245 offset:2048
    ds_read_b64_tr_b16 v[186:187], v245 offset:3072
    v_mul_f32_dpp v202, v243, v84 row_newbcast:10 row_mask:0xf bank_mask:0xf
    v_mul_f32_dpp v203, v243, v85 row_newbcast:11 row_mask:0xf bank_mask:0xf
    v_cvt_pk_bf16_f32 v80, v196, v197
    v_cvt_pk_bf16_f32 v84, v198, v199
    v_cvt_pk_bf16_f32 v81, v200, v201
    v_cvt_pk_bf16_f32 v85, v202, v203
    v_mul_f32_dpp v196, v243, v82 row_newbcast:4 row_mask:0xf bank_mask:0xf
    v_mul_f32_dpp v197, v243, v83 row_newbcast:5 row_mask:0xf bank_mask:0xf
    v_mul_f32_dpp v198, v243, v82 row_newbcast:12 row_mask:0xf bank_mask:0xf
    v_mul_f32_dpp v199, v243, v83 row_newbcast:13 row_mask:0xf bank_mask:0xf
    v_mul_f32_dpp v200, v243, v86 row_newbcast:6 row_mask:0xf bank_mask:0xf
    v_mul_f32_dpp v201, v243, v87 row_newbcast:7 row_mask:0xf bank_mask:0xf
    v_mul_f32_dpp v202, v243, v86 row_newbcast:14 row_mask:0xf bank_mask:0xf
    v_mul_f32_dpp v203, v243, v87 row_newbcast:15 row_mask:0xf bank_mask:0xf
    v_cvt_pk_bf16_f32 v82, v196, v197
    v_cvt_pk_bf16_f32 v86, v198, v199
    v_cvt_pk_bf16_f32 v83, v200, v201
    v_cvt_pk_bf16_f32 v87, v202, v203
    s_mov_b64 exec, s[54:55]
    ds_read_u16_d16_hi v243, v250 offset:384
    s_mov_b64 exec, -1
    s_waitcnt vmcnt(4) lgkmcnt(1)
    v_mfma_f32_32x32x16_bf16 v[0:15], v[80:83], v[176:179], v[0:15]
    v_mul_f32_dpp v196, v242, v88 row_newbcast:0 row_mask:0xf bank_mask:0xf
    v_mul_f32_dpp v197, v242, v89 row_newbcast:1 row_mask:0xf bank_mask:0xf
    v_mul_f32_dpp v198, v242, v88 row_newbcast:8 row_mask:0xf bank_mask:0xf
    v_mul_f32_dpp v199, v242, v89 row_newbcast:9 row_mask:0xf bank_mask:0xf
    v_mul_f32_dpp v200, v242, v92 row_newbcast:2 row_mask:0xf bank_mask:0xf
    v_mul_f32_dpp v201, v242, v93 row_newbcast:3 row_mask:0xf bank_mask:0xf
    s_add_u32 m0, s21, 2048
    v_mfma_f32_32x32x16_bf16 v[48:63], v[84:87], v[176:179], v[48:63]
    buffer_load_dwordx4 v236, s[4:7], s35 offen  lds
    buffer_load_dwordx4 v237, s[8:11], s35 offen offset:1024  lds
    ds_read_b64_tr_b16 v[176:177], v244 offset:4096
    ds_read_b64_tr_b16 v[178:179], v244 offset:5120
    ds_read_b64_tr_b16 v[188:189], v245 offset:4096
    ds_read_b64_tr_b16 v[190:191], v245 offset:5120
    v_mul_f32_dpp v202, v242, v92 row_newbcast:10 row_mask:0xf bank_mask:0xf
    v_mul_f32_dpp v203, v242, v93 row_newbcast:11 row_mask:0xf bank_mask:0xf
    v_cvt_pk_bf16_f32 v88, v196, v197
    v_cvt_pk_bf16_f32 v92, v198, v199
    v_cvt_pk_bf16_f32 v89, v200, v201
    v_cvt_pk_bf16_f32 v93, v202, v203
    v_mul_f32_dpp v196, v242, v90 row_newbcast:4 row_mask:0xf bank_mask:0xf
    v_mul_f32_dpp v197, v242, v91 row_newbcast:5 row_mask:0xf bank_mask:0xf
    v_mul_f32_dpp v198, v242, v90 row_newbcast:12 row_mask:0xf bank_mask:0xf
    v_mul_f32_dpp v199, v242, v91 row_newbcast:13 row_mask:0xf bank_mask:0xf
    v_mul_f32_dpp v200, v242, v94 row_newbcast:6 row_mask:0xf bank_mask:0xf
    v_mul_f32_dpp v201, v242, v95 row_newbcast:7 row_mask:0xf bank_mask:0xf
    v_mul_f32_dpp v202, v242, v94 row_newbcast:14 row_mask:0xf bank_mask:0xf
    v_mul_f32_dpp v203, v242, v95 row_newbcast:15 row_mask:0xf bank_mask:0xf
    v_cvt_pk_bf16_f32 v90, v196, v197
    v_cvt_pk_bf16_f32 v94, v198, v199
    v_cvt_pk_bf16_f32 v91, v200, v201
    v_cvt_pk_bf16_f32 v95, v202, v203
    s_waitcnt vmcnt(4) lgkmcnt(0)
    v_mfma_f32_32x32x16_bf16 v[0:15], v[88:91], v[176:179], v[0:15]
    v_mul_f32_dpp v196, v243, v64 row_newbcast:0 row_mask:0xf bank_mask:0xf
    v_mul_f32_dpp v197, v243, v65 row_newbcast:1 row_mask:0xf bank_mask:0xf
    v_mul_f32_dpp v198, v243, v64 row_newbcast:8 row_mask:0xf bank_mask:0xf
    v_mul_f32_dpp v199, v243, v65 row_newbcast:9 row_mask:0xf bank_mask:0xf
    v_mul_f32_dpp v200, v243, v68 row_newbcast:2 row_mask:0xf bank_mask:0xf
    v_mul_f32_dpp v201, v243, v69 row_newbcast:3 row_mask:0xf bank_mask:0xf
    s_add_u32 m0, s21, 4096
    v_mfma_f32_32x32x16_bf16 v[48:63], v[92:95], v[176:179], v[48:63]
    buffer_load_dwordx4 v238, s[4:7], s35 offen  lds
    buffer_load_dwordx4 v239, s[8:11], s35 offen offset:1024  lds
    ds_read_b64_tr_b16 v[176:177], v244 offset:6144
    ds_read_b64_tr_b16 v[178:179], v244 offset:7168
    ds_read_b64_tr_b16 v[192:193], v245 offset:6144
    ds_read_b64_tr_b16 v[194:195], v245 offset:7168
    v_mul_f32_dpp v202, v243, v68 row_newbcast:10 row_mask:0xf bank_mask:0xf
    v_mul_f32_dpp v203, v243, v69 row_newbcast:11 row_mask:0xf bank_mask:0xf
    v_cvt_pk_bf16_f32 v64, v196, v197
    v_cvt_pk_bf16_f32 v68, v198, v199
    v_cvt_pk_bf16_f32 v65, v200, v201
    v_cvt_pk_bf16_f32 v69, v202, v203
    v_mul_f32_dpp v196, v243, v66 row_newbcast:4 row_mask:0xf bank_mask:0xf
    v_mul_f32_dpp v197, v243, v67 row_newbcast:5 row_mask:0xf bank_mask:0xf
    v_mul_f32_dpp v198, v243, v66 row_newbcast:12 row_mask:0xf bank_mask:0xf
    v_mul_f32_dpp v199, v243, v67 row_newbcast:13 row_mask:0xf bank_mask:0xf
    v_mul_f32_dpp v200, v243, v70 row_newbcast:6 row_mask:0xf bank_mask:0xf
    v_mul_f32_dpp v201, v243, v71 row_newbcast:7 row_mask:0xf bank_mask:0xf
    v_mul_f32_dpp v202, v243, v70 row_newbcast:14 row_mask:0xf bank_mask:0xf
    v_mul_f32_dpp v203, v243, v71 row_newbcast:15 row_mask:0xf bank_mask:0xf
    v_cvt_pk_bf16_f32 v66, v196, v197
    v_cvt_pk_bf16_f32 v70, v198, v199
    v_cvt_pk_bf16_f32 v67, v200, v201
    v_cvt_pk_bf16_f32 v71, v202, v203
    s_waitcnt lgkmcnt(0)
    v_mfma_f32_32x32x16_bf16 v[0:15], v[64:67], v[176:179], v[0:15]
    s_add_u32 m0, s21, 6144
    v_mfma_f32_32x32x16_bf16 v[48:63], v[68:71], v[176:179], v[48:63]
    buffer_load_dwordx4 v240, s[4:7], s35 offen  lds
    buffer_load_dwordx4 v241, s[8:11], s35 offen offset:1024  lds
    s_mov_b32 m0, s50
    s_nop 0
    s_movrels_b32 s71, s23
    s_movrels_b32 s33, s28
    v_add_u32 v253, s33, v248
    s_bfe_u32 s46, s71, 0x30012
    s_mov_b32 m0, s46
    s_and_b32 s66, s71, 0x3ffff
    s_movrels_b32 s68, s57
    s_movrels_b32 s69, s61
    s_sub_u32 s48, s66, s47
    s_mov_b32 s47, s66
    s_lshr_b32 s52, s71, 28
    s_lshl_b32 s67, s46, 9
    s_add_u32 s66, s66, s67
    s_sub_u32 s49, s66, s42
    s_mov_b32 s42, s66
    s_bfe_u32 s66, s68, 655360
    s_add_u32 s43, s42, s66
    s_bfe_u32 s39, s69, 655360
    s_bfe_u32 s66, s68, 655370
    s_add_u32 s44, s42, s66
    s_bfe_u32 s40, s69, 655370
    s_bfe_u32 s66, s68, 655380
    s_add_u32 s45, s42, s66
    s_bfe_u32 s41, s69, 655380
    v_mfma_f32_32x32x16_bf16 v[16:31], v[72:75], v[180:183], 0
    v_mul_f32 v196, v0, v96
    v_fmac_f32 v196, v1, v97
    v_fmac_f32 v196, v2, v98
    v_fmac_f32 v196, v3, v99
    v_fmac_f32 v196, v4, v100
    v_fmac_f32 v196, v5, v101
    v_mfma_f32_32x32x16_bf16 v[32:47], v[76:79], v[180:183], 0
    v_fmac_f32 v196, v6, v102
    v_fmac_f32 v196, v7, v103
    v_mul_f32 v198, v8, v128
    v_fmac_f32 v198, v9, v129
    v_fmac_f32 v198, v10, v130
    v_fmac_f32 v198, v11, v131
    v_mfma_f32_32x32x16_bf16 v[16:31], v[80:83], v[184:187], v[16:31]
    v_fmac_f32 v198, v12, v132
    v_fmac_f32 v198, v13, v133
    v_fmac_f32 v198, v14, v134
    v_fmac_f32 v198, v15, v135
    v_mul_f32 v200, v48, v128
    v_fmac_f32 v200, v49, v129
    v_mfma_f32_32x32x16_bf16 v[32:47], v[84:87], v[184:187], v[32:47]
    v_permlane32_swap_b32 v196, v198
    v_fmac_f32 v200, v50, v130
    v_fmac_f32 v200, v51, v131
    v_fmac_f32 v200, v52, v132
    v_fmac_f32 v200, v53, v133
    v_fmac_f32 v200, v54, v134
    v_mfma_f32_32x32x16_bf16 v[16:31], v[88:91], v[188:191], v[16:31]
    v_fmac_f32 v200, v55, v135
    v_add_f32 v198, v196, v198
    v_mul_f32_e64 v202, v56, -v128
    v_fma_f32 v202, v57, -v129, v202
    v_fma_f32 v202, v58, -v130, v202
    v_fma_f32 v202, v59, -v131, v202
    v_mfma_f32_32x32x16_bf16 v[32:47], v[92:95], v[188:191], v[32:47]
    s_waitcnt vmcnt(6)
    ds_read_b64_tr_b16 v[176:177], v244 offset:0
    ds_read_b64_tr_b16 v[178:179], v244 offset:1024
    ds_read_b64_tr_b16 v[180:181], v245 offset:0
    ds_read_b64_tr_b16 v[182:183], v245 offset:1024
    v_fma_f32 v202, v60, -v132, v202
    v_fma_f32 v202, v61, -v133, v202
    v_mfma_f32_32x32x16_bf16 v[16:31], v[64:67], v[192:195], v[16:31]
    v_fma_f32 v202, v62, -v134, v202
    v_fma_f32 v202, v63, -v135, v202
    s_nop 1
    v_permlane32_swap_b32 v200, v202
    v_add_f32 v202, v200, v202
    v_mfma_f32_32x32x16_bf16 v[32:47], v[68:71], v[192:195], v[32:47]
    s_waitcnt vmcnt(4) lgkmcnt(0)
    v_mfma_f32_32x32x16_bf16 v[0:15], v[72:75], v[176:179], 0
    s_nop 2
    v_mul_f32 v197, v16, v104
    v_fmac_f32 v197, v17, v105
    v_fmac_f32 v197, v18, v106
    v_fmac_f32 v197, v19, v107
    v_fmac_f32 v197, v20, v108
    v_fmac_f32 v197, v21, v109
    s_add_u32 m0, s21, 0
    v_mfma_f32_32x32x16_bf16 v[48:63], v[76:79], v[176:179], 0
    buffer_load_dwordx4 v234, s[4:7], s36 offen  lds
    buffer_load_dwordx4 v235, s[8:11], s36 offen offset:1024  lds
    ds_read_b64_tr_b16 v[176:177], v244 offset:2048
    ds_read_b64_tr_b16 v[178:179], v244 offset:3072
    ds_read_b64_tr_b16 v[184:185], v245 offset:2048
    ds_read_b64_tr_b16 v[186:187], v245 offset:3072
    v_fmac_f32 v197, v22, v110
    v_fmac_f32 v197, v23, v111
    v_mul_f32 v199, v24, v136
    v_fmac_f32 v199, v25, v137
    v_fmac_f32 v199, v26, v138
    v_fmac_f32 v199, v27, v139
    v_fmac_f32 v199, v28, v140
    v_fmac_f32 v199, v29, v141
    v_fmac_f32 v199, v30, v142
    v_fmac_f32 v199, v31, v143
    v_mul_f32 v201, v32, v136
    s_waitcnt vmcnt(4) lgkmcnt(0)
    v_mfma_f32_32x32x16_bf16 v[0:15], v[80:83], v[176:179], v[0:15]
    v_fmac_f32 v201, v33, v137
    v_permlane32_swap_b32 v197, v199
    v_fmac_f32 v201, v34, v138
    v_fmac_f32 v201, v35, v139
    v_fmac_f32 v201, v36, v140
    v_fmac_f32 v201, v37, v141
    s_add_u32 m0, s21, 2048
    v_mfma_f32_32x32x16_bf16 v[48:63], v[84:87], v[176:179], v[48:63]
    buffer_load_dwordx4 v236, s[4:7], s36 offen  lds
    buffer_load_dwordx4 v237, s[8:11], s36 offen offset:1024  lds
    ds_read_b64_tr_b16 v[176:177], v244 offset:4096
    ds_read_b64_tr_b16 v[178:179], v244 offset:5120
    ds_read_b64_tr_b16 v[188:189], v245 offset:4096
    ds_read_b64_tr_b16 v[190:191], v245 offset:5120
    s_waitcnt vmcnt(4) lgkmcnt(0)
    v_mfma_f32_32x32x16_bf16 v[0:15], v[88:91], v[176:179], v[0:15]
    v_fmac_f32 v201, v38, v142
    v_fmac_f32 v201, v39, v143
    v_add_f32 v199, v197, v199
    v_mul_f32_e64 v203, v40, -v136
    v_fma_f32 v203, v41, -v137, v203
    v_fma_f32 v203, v42, -v138, v203
    s_add_u32 m0, s21, 4096
    v_mfma_f32_32x32x16_bf16 v[48:63], v[92:95], v[176:179], v[48:63]
    buffer_load_dwordx4 v238, s[4:7], s36 offen  lds
    buffer_load_dwordx4 v239, s[8:11], s36 offen offset:1024  lds
    ds_read_b64_tr_b16 v[176:177], v244 offset:6144
    ds_read_b64_tr_b16 v[178:179], v244 offset:7168
    ds_read_b64_tr_b16 v[192:193], v245 offset:6144
    ds_read_b64_tr_b16 v[194:195], v245 offset:7168
    s_waitcnt lgkmcnt(0)
    v_mfma_f32_32x32x16_bf16 v[0:15], v[64:67], v[176:179], v[0:15]
    v_fma_f32 v203, v43, -v139, v203
    v_fma_f32 v203, v44, -v140, v203
    v_fma_f32 v203, v45, -v141, v203
    v_fma_f32 v203, v46, -v142, v203
    v_fma_f32 v203, v47, -v143, v203
    s_nop 1
    v_permlane32_swap_b32 v201, v203
    s_add_u32 m0, s21, 6144
    v_mfma_f32_32x32x16_bf16 v[48:63], v[68:71], v[176:179], v[48:63]
    buffer_load_dwordx4 v240, s[4:7], s36 offen  lds
    buffer_load_dwordx4 v241, s[8:11], s36 offen offset:1024  lds
    v_add_f32 v203, v201, v203
    v_cvt_pk_bf16_f32 v198, v198, v199
    v_cvt_pk_bf16_f32 v202, v202, v203
    ds_write2st64_b32 v253, v198, v202 offset0:0 offset1:1
    v_mfma_f32_32x32x16_bf16 v[16:31], v[72:75], v[180:183], 0
    v_mul_f32 v196, v0, v144
    v_fmac_f32 v196, v1, v145
    v_fmac_f32 v196, v2, v146
    v_fmac_f32 v196, v3, v147
    v_fmac_f32 v196, v4, v148
    v_fmac_f32 v196, v5, v149
    v_mfma_f32_32x32x16_bf16 v[32:47], v[76:79], v[180:183], 0
    v_fmac_f32 v196, v6, v150
    v_fmac_f32 v196, v7, v151
    v_mul_f32 v198, v8, v112
    v_fmac_f32 v198, v9, v113
    v_fmac_f32 v198, v10, v114
    v_fmac_f32 v198, v11, v115
    v_mfma_f32_32x32x16_bf16 v[16:31], v[80:83], v[184:187], v[16:31]
    v_fmac_f32 v198, v12, v116
    v_fmac_f32 v198, v13, v117
    v_fmac_f32 v198, v14, v118
    v_fmac_f32 v198, v15, v119
    v_mul_f32_e64 v200, v48, -v160
    v_fma_f32 v200, v49, -v161, v200
    v_mfma_f32_32x32x16_bf16 v[32:47], v[84:87], v[184:187], v[32:47]
    v_fma_f32 v200, v50, -v162, v200
    v_fma_f32 v200, v51, -v163, v200
    v_fma_f32 v200, v52, -v164, v200
    v_fma_f32 v200, v53, -v165, v200
    v_fma_f32 v200, v54, -v166, v200
    v_fma_f32 v200, v55, -v167, v200
    v_mfma_f32_32x32x16_bf16 v[16:31], v[88:91], v[188:191], v[16:31]
    v_mul_f32_e64 v202, v56, -v160
    v_fma_f32 v202, v57, -v161, v202
    v_fma_f32 v202, v58, -v162, v202
    v_fma_f32 v202, v59, -v163, v202
    v_fma_f32 v202, v60, -v164, v202
    v_fma_f32 v202, v61, -v165, v202
    v_mfma_f32_32x32x16_bf16 v[32:47], v[92:95], v[188:191], v[32:47]
    s_waitcnt vmcnt(6)
    ds_read_b64_tr_b16 v[176:177], v244 offset:0
    ds_read_b64_tr_b16 v[178:179], v244 offset:1024
    ds_read_b64_tr_b16 v[180:181], v245 offset:0
    ds_read_b64_tr_b16 v[182:183], v245 offset:1024
    v_fma_f32 v202, v62, -v166, v202
    v_fma_f32 v202, v63, -v167, v202
    v_mfma_f32_32x32x16_bf16 v[16:31], v[64:67], v[192:195], v[16:31]
    v_mfma_f32_32x32x16_bf16 v[32:47], v[68:71], v[192:195], v[32:47]
    s_waitcnt vmcnt(4) lgkmcnt(0)
    v_mfma_f32_32x32x16_bf16 v[0:15], v[72:75], v[176:179], 0
    s_nop 8
    v_mul_f32 v197, v16, v152
    v_fmac_f32 v197, v17, v153
    v_fmac_f32 v197, v18, v154
    v_fmac_f32 v197, v19, v155
    v_fmac_f32 v197, v20, v156
    v_fmac_f32 v197, v21, v157
    s_add_u32 m0, s21, 0
    v_mfma_f32_32x32x16_bf16 v[48:63], v[76:79], v[176:179], 0
    buffer_load_dwordx4 v234, s[4:7], s37 offen  lds
    buffer_load_dwordx4 v235, s[8:11], s37 offen offset:1024  lds
    ds_read_b64_tr_b16 v[176:177], v244 offset:2048
    ds_read_b64_tr_b16 v[178:179], v244 offset:3072
    ds_read_b64_tr_b16 v[184:185], v245 offset:2048
    ds_read_b64_tr_b16 v[186:187], v245 offset:3072
    v_add_u32 v252, s42, v247
    ds_read2_b32 v[234:235], v252 offset0:0 offset1:16
    v_fmac_f32 v197, v22, v158
    v_fmac_f32 v197, v23, v159
    v_mul_f32 v199, v24, v120
    v_fmac_f32 v199, v25, v121
    v_fmac_f32 v199, v26, v122
    v_fmac_f32 v199, v27, v123
    s_waitcnt vmcnt(4) lgkmcnt(1)
    v_mfma_f32_32x32x16_bf16 v[0:15], v[80:83], v[176:179], v[0:15]
    v_fmac_f32 v199, v28, v124
    v_fmac_f32 v199, v29, v125
    v_fmac_f32 v199, v30, v126
    v_fmac_f32 v199, v31, v127
    v_mul_f32_e64 v201, v32, -v168
    v_fma_f32 v201, v33, -v169, v201
    s_add_u32 m0, s21, 2048
    v_mfma_f32_32x32x16_bf16 v[48:63], v[84:87], v[176:179], v[48:63]
    buffer_load_dwordx4 v236, s[4:7], s37 offen  lds
    buffer_load_dwordx4 v237, s[8:11], s37 offen offset:1024  lds
    ds_read_b64_tr_b16 v[176:177], v244 offset:4096
    ds_read_b64_tr_b16 v[178:179], v244 offset:5120
    ds_read_b64_tr_b16 v[188:189], v245 offset:4096
    ds_read_b64_tr_b16 v[190:191], v245 offset:5120
    v_add_u32 v252, s43, v247
    ds_read2_b32 v[236:237], v252 offset0:0 offset1:16
    s_waitcnt vmcnt(4) lgkmcnt(1)
    v_mfma_f32_32x32x16_bf16 v[0:15], v[88:91], v[176:179], v[0:15]
    v_fma_f32 v201, v34, -v170, v201
    v_fma_f32 v201, v35, -v171, v201
    v_fma_f32 v201, v36, -v172, v201
    v_fma_f32 v201, v37, -v173, v201
    v_fma_f32 v201, v38, -v174, v201
    v_fma_f32 v201, v39, -v175, v201
    s_add_u32 m0, s21, 4096
    v_mfma_f32_32x32x16_bf16 v[48:63], v[92:95], v[176:179], v[48:63]
    buffer_load_dwordx4 v238, s[4:7], s37 offen  lds
    buffer_load_dwordx4 v239, s[8:11], s37 offen offset:1024  lds
    ds_read_b64_tr_b16 v[176:177], v244 offset:6144
    ds_read_b64_tr_b16 v[178:179], v244 offset:7168
    ds_read_b64_tr_b16 v[192:193], v245 offset:6144
    ds_read_b64_tr_b16 v[194:195], v245 offset:7168
    v_add_u32 v252, s44, v247
    ds_read2_b32 v[238:239], v252 offset0:0 offset1:16
    s_waitcnt lgkmcnt(1)
    v_mfma_f32_32x32x16_bf16 v[0:15], v[64:67], v[176:179], v[0:15]
    v_mul_f32_e64 v203, v40, -v168
    v_fma_f32 v203, v41, -v169, v203
    v_fma_f32 v203, v42, -v170, v203
    v_fma_f32 v203, v43, -v171, v203
    v_fma_f32 v203, v44, -v172, v203
    v_fma_f32 v203, v45, -v173, v203
    s_add_u32 m0, s21, 6144
    v_mfma_f32_32x32x16_bf16 v[48:63], v[68:71], v[176:179], v[48:63]
    buffer_load_dwordx4 v240, s[4:7], s37 offen  lds
    buffer_load_dwordx4 v241, s[8:11], s37 offen offset:1024  lds
    v_add_u32 v252, s45, v247
    ds_read2_b32 v[240:241], v252 offset0:0 offset1:16
    v_fma_f32 v203, v46, -v174, v203
    v_fma_f32 v203, v47, -v175, v203
    v_mfma_f32_32x32x16_bf16 v[16:31], v[72:75], v[180:183], 0
    v_mul_f32 v254, v0, v144
    v_fmac_f32 v254, v1, v145
    v_fmac_f32 v254, v2, v146
    v_fmac_f32 v254, v3, v147
    v_fmac_f32 v254, v4, v148
    v_fmac_f32 v254, v5, v149
    v_mfma_f32_32x32x16_bf16 v[32:47], v[76:79], v[180:183], 0
    ds_swizzle_b32 v76, v76 offset:0x401F
    ds_swizzle_b32 v77, v77 offset:0x401F
    ds_swizzle_b32 v78, v78 offset:0x401F
    ds_swizzle_b32 v79, v79 offset:0x401F
    v_fmac_f32 v254, v6, v150
    v_fmac_f32 v254, v7, v151
    v_mfma_f32_32x32x16_bf16 v[16:31], v[80:83], v[184:187], v[16:31]
    v_fmac_f32 v200, v8, v160
    v_fmac_f32 v200, v9, v161
    v_permlane32_swap_b32 v196, v254
    v_fmac_f32 v200, v10, v162
    v_fmac_f32 v200, v11, v163
    v_fmac_f32 v200, v12, v164
    v_mfma_f32_32x32x16_bf16 v[32:47], v[84:87], v[184:187], v[32:47]
    ds_swizzle_b32 v84, v84 offset:0x401F
    ds_swizzle_b32 v85, v85 offset:0x401F
    ds_swizzle_b32 v86, v86 offset:0x401F
    ds_swizzle_b32 v87, v87 offset:0x401F
    v_fmac_f32 v200, v13, v165
    v_fmac_f32 v200, v14, v166
    v_mfma_f32_32x32x16_bf16 v[16:31], v[88:91], v[188:191], v[16:31]
    v_fmac_f32 v200, v15, v167
    v_add_f32 v254, v196, v254
    v_mfma_f32_32x32x16_bf16 v[32:47], v[92:95], v[188:191], v[32:47]
    ds_swizzle_b32 v92, v92 offset:0x401F
    ds_swizzle_b32 v93, v93 offset:0x401F
    ds_swizzle_b32 v94, v94 offset:0x401F
    ds_swizzle_b32 v95, v95 offset:0x401F
    s_waitcnt vmcnt(6)
    ds_read_b64_tr_b16 v[176:177], v244 offset:0
    ds_read_b64_tr_b16 v[178:179], v244 offset:1024
    ds_read_b64_tr_b16 v[180:181], v245 offset:0
    ds_read_b64_tr_b16 v[182:183], v245 offset:1024
    v_mfma_f32_32x32x16_bf16 v[16:31], v[64:67], v[192:195], v[16:31]
    v_mfma_f32_32x32x16_bf16 v[32:47], v[68:71], v[192:195], v[32:47]
    ds_swizzle_b32 v68, v68 offset:0x401F
    ds_swizzle_b32 v69, v69 offset:0x401F
    ds_swizzle_b32 v70, v70 offset:0x401F
    ds_swizzle_b32 v71, v71 offset:0x401F
    s_waitcnt lgkmcnt(8)
    s_mov_b64 exec, s[56:57]
    v_xor_b32 v76, 0x80008000, v76
    v_xor_b32 v77, 0x80008000, v77
    v_xor_b32 v78, 0x80008000, v78
    v_xor_b32 v79, 0x80008000, v79
    v_xor_b32 v84, 0x80008000, v84
    v_xor_b32 v85, 0x80008000, v85
    v_xor_b32 v86, 0x80008000, v86
    v_xor_b32 v87, 0x80008000, v87
    v_xor_b32 v92, 0x80008000, v92
    v_xor_b32 v93, 0x80008000, v93
    v_xor_b32 v94, 0x80008000, v94
    v_xor_b32 v95, 0x80008000, v95
    s_mov_b64 exec, -1
    s_waitcnt vmcnt(4) lgkmcnt(4)
    v_mfma_f32_32x32x16_bf16 v[0:15], v[72:75], v[176:179], 0
    v_mul_f32 v255, v16, v152
    v_fmac_f32 v255, v17, v153
    v_fmac_f32 v255, v18, v154
    v_fmac_f32 v255, v19, v155
    v_fmac_f32 v255, v20, v156
    v_fmac_f32 v255, v21, v157
    s_add_u32 m0, s21, 0
    v_mfma_f32_32x32x16_bf16 v[48:63], v[76:79], v[176:179], v[48:63]
    s_cbranch_vccnz WL_8_0
    v_mad_u32_u16 v234, v234, s3, v246 op_sel:[1,0,0,0]
    v_mad_u32_u16 v235, v235, s3, v246 op_sel:[1,0,0,0]
    buffer_load_dwordx4 v234, s[4:7], s38 offen  lds
    buffer_load_dwordx4 v235, s[8:11], s38 offen offset:1024  lds
WR_8_0:
    ds_read_b64_tr_b16 v[176:177], v244 offset:2048
    ds_read_b64_tr_b16 v[178:179], v244 offset:3072
    ds_read_b64_tr_b16 v[184:185], v245 offset:2048
    ds_read_b64_tr_b16 v[186:187], v245 offset:3072
    s_waitcnt vmcnt(4) lgkmcnt(0)
    v_mfma_f32_32x32x16_bf16 v[0:15], v[80:83], v[176:179], v[0:15]
    s_add_u32 m0, s21, 2048
    v_mfma_f32_32x32x16_bf16 v[48:63], v[84:87], v[176:179], v[48:63]
    s_cbranch_vccnz WL_8_1
    v_mad_u32_u16 v236, v236, s3, v246 op_sel:[1,0,0,0]
    v_mad_u32_u16 v237, v237, s3, v246 op_sel:[1,0,0,0]
    buffer_load_dwordx4 v236, s[4:7], s39 offen  lds
    buffer_load_dwordx4 v237, s[8:11], s39 offen offset:1024  lds
WR_8_1:
    ds_read_b64_tr_b16 v[176:177], v244 offset:4096
    ds_read_b64_tr_b16 v[178:179], v244 offset:5120
    ds_read_b64_tr_b16 v[188:189], v245 offset:4096
    ds_read_b64_tr_b16 v[190:191], v245 offset:5120
    s_waitcnt vmcnt(4) lgkmcnt(0)
    v_mfma_f32_32x32x16_bf16 v[0:15], v[88:91], v[176:179], v[0:15]
    v_fmac_f32 v255, v22, v158
    v_fmac_f32 v255, v23, v159
    v_fmac_f32 v201, v24, v168
    v_fmac_f32 v201, v25, v169
    v_permlane32_swap_b32 v197, v255
    v_fmac_f32 v201, v26, v170
    s_add_u32 m0, s21, 4096
    v_mfma_f32_32x32x16_bf16 v[48:63], v[92:95], v[176:179], v[48:63]
    s_cbranch_vccnz WL_8_2
    v_mad_u32_u16 v238, v238, s3, v246 op_sel:[1,0,0,0]
    v_mad_u32_u16 v239, v239, s3, v246 op_sel:[1,0,0,0]
    buffer_load_dwordx4 v238, s[4:7], s40 offen  lds
    buffer_load_dwordx4 v239, s[8:11], s40 offen offset:1024  lds
WR_8_2:
    ds_read_b64_tr_b16 v[176:177], v244 offset:6144
    ds_read_b64_tr_b16 v[178:179], v244 offset:7168
    ds_read_b64_tr_b16 v[192:193], v245 offset:6144
    ds_read_b64_tr_b16 v[194:195], v245 offset:7168
    s_waitcnt lgkmcnt(0)
    s_mov_b64 exec, s[56:57]
    v_xor_b32 v68, 0x80008000, v68
    v_xor_b32 v69, 0x80008000, v69
    v_xor_b32 v70, 0x80008000, v70
    v_xor_b32 v71, 0x80008000, v71
    s_mov_b64 exec, -1
    v_mfma_f32_32x32x16_bf16 v[0:15], v[64:67], v[176:179], v[0:15]
    v_fmac_f32 v201, v27, v171
    v_fmac_f32 v201, v28, v172
    v_fmac_f32 v201, v29, v173
    v_fmac_f32 v201, v30, v174
    v_fmac_f32 v201, v31, v175
    v_add_f32 v255, v197, v255
    s_add_u32 m0, s21, 6144
    v_mfma_f32_32x32x16_bf16 v[48:63], v[68:71], v[176:179], v[48:63]
    s_cbranch_vccnz WL_8_3
    v_mad_u32_u16 v240, v240, s3, v246 op_sel:[1,0,0,0]
    v_mad_u32_u16 v241, v241, s3, v246 op_sel:[1,0,0,0]
    buffer_load_dwordx4 v240, s[4:7], s41 offen  lds
    buffer_load_dwordx4 v241, s[8:11], s41 offen offset:1024  lds
WR_8_3:
    v_cvt_pk_bf16_f32 v254, v254, v255
    ds_write_b32 v253, v254 offset:512
    v_mfma_f32_32x32x16_bf16 v[16:31], v[72:75], v[180:183], 0
    v_mul_f32 v254, v0, v144
    v_fmac_f32 v254, v1, v145
    v_fmac_f32 v254, v2, v146
    v_fmac_f32 v254, v3, v147
    v_fmac_f32 v254, v4, v148
    v_fmac_f32 v254, v5, v149
    v_mfma_f32_32x32x16_bf16 v[32:47], v[76:79], v[180:183], v[32:47]
    v_fmac_f32 v254, v6, v150
    v_fmac_f32 v254, v7, v151
    v_fma_f32 v202, v8, -v160, v202
    v_fma_f32 v202, v9, -v161, v202
    v_permlane32_swap_b32 v254, v200
    v_fma_f32 v202, v10, -v162, v202
    v_mfma_f32_32x32x16_bf16 v[16:31], v[80:83], v[184:187], v[16:31]
    v_fma_f32 v202, v11, -v163, v202
    v_fma_f32 v202, v12, -v164, v202
    v_fma_f32 v202, v13, -v165, v202
    v_fma_f32 v202, v14, -v166, v202
    v_fma_f32 v202, v15, -v167, v202
    v_add_f32 v200, v254, v200
    v_mfma_f32_32x32x16_bf16 v[32:47], v[84:87], v[184:187], v[32:47]
    v_fmac_f32 v198, v48, v112
    v_permlane32_swap_b32 v202, v254
    v_fmac_f32 v198, v49, v113
    v_fmac_f32 v198, v50, v114
    v_fmac_f32 v198, v51, v115
    v_fmac_f32 v198, v52, v116
    v_mfma_f32_32x32x16_bf16 v[16:31], v[88:91], v[188:191], v[16:31]
    v_fmac_f32 v198, v53, v117
    v_fmac_f32 v198, v54, v118
    v_fmac_f32 v198, v55, v119
    v_add_f32 v254, v202, v254
    v_mul_f32 v196, v56, v160
    v_fmac_f32 v196, v57, v161
    v_mfma_f32_32x32x16_bf16 v[32:47], v[92:95], v[188:191], v[32:47]
    s_waitcnt vmcnt(6)
    ds_read_b64_tr_b16 v[176:177], v244 offset:0
    ds_read_b64_tr_b16 v[178:179], v244 offset:1024
    ds_read_b64_tr_b16 v[180:181], v245 offset:0
    ds_read_b64_tr_b16 v[182:183], v245 offset:1024
    v_fmac_f32 v196, v58, v162
    v_fmac_f32 v196, v59, v163
    v_mfma_f32_32x32x16_bf16 v[16:31], v[64:67], v[192:195], v[16:31]
    v_fmac_f32 v196, v60, v164
    v_fmac_f32 v196, v61, v165
    v_fmac_f32 v196, v62, v166
    v_fmac_f32 v196, v63, v167
    s_nop 1
    v_permlane32_swap_b32 v198, v196
    v_add_f32 v196, v198, v196
    v_mfma_f32_32x32x16_bf16 v[32:47], v[68:71], v[192:195], v[32:47]
    v_add_u32 v249, s48, v249
    v_add_u32 v250, s49, v250
    ds_read_b32 v252, v251 offset:16
    ds_read_b64_tr_b16 v[72:73], v249 offset:0
    ds_read_b64_tr_b16 v[76:77], v249 offset:64
    ds_read_b64_tr_b16 v[74:75], v249 offset:256
    ds_read_b64_tr_b16 v[78:79], v249 offset:320
    s_mov_b64 exec, s[54:55]
    ds_read_u16_d16_hi v242, v250 offset:0
    s_mov_b64 exec, -1
    s_cbranch_vccnz LEPI_1
    v_mul_f32 v255, v16, v152
    v_fmac_f32 v255, v17, v153
    v_fmac_f32 v255, v18, v154
    v_fmac_f32 v255, v19, v155
    v_fmac_f32 v255, v20, v156
    v_fmac_f32 v255, v21, v157
    v_fmac_f32 v255, v22, v158
    v_fmac_f32 v255, v23, v159
    v_fma_f32 v203, v24, -v168, v203
    v_fma_f32 v203, v25, -v169, v203
    v_permlane32_swap_b32 v255, v201
    v_fma_f32 v203, v26, -v170, v203
    v_fma_f32 v203, v27, -v171, v203
    v_fma_f32 v203, v28, -v172, v203
    v_fma_f32 v203, v29, -v173, v203
    v_fma_f32 v203, v30, -v174, v203
    v_fma_f32 v203, v31, -v175, v203
    v_add_f32 v201, v255, v201
    v_fmac_f32 v199, v32, v120
    v_permlane32_swap_b32 v203, v255
    v_fmac_f32 v199, v33, v121
    v_fmac_f32 v199, v34, v122
    v_fmac_f32 v199, v35, v123
    v_fmac_f32 v199, v36, v124
    v_fmac_f32 v199, v37, v125
    v_fmac_f32 v199, v38, v126
    v_fmac_f32 v199, v39, v127
    v_add_f32 v255, v203, v255
    v_mul_f32 v197, v40, v168
    v_fmac_f32 v197, v41, v169
    v_fmac_f32 v197, v42, v170
    v_fmac_f32 v197, v43, v171
    v_fmac_f32 v197, v44, v172
    v_fmac_f32 v197, v45, v173
    v_fmac_f32 v197, v46, v174
    v_fmac_f32 v197, v47, v175
    s_nop 1
    v_permlane32_swap_b32 v199, v197
    v_add_f32 v197, v199, v197
    v_cvt_pk_bf16_f32 v200, v200, v201
    v_cvt_pk_bf16_f32 v254, v254, v255
    v_cvt_pk_bf16_f32 v196, v196, v197
    ds_write2st64_b32 v253, v200, v196 offset0:3 offset1:4
    s_mov_b64 exec, 0xffffffff
    ds_write_b32 v253, v254 offset:1280
    s_mov_b64 exec, -1
    s_add_u32 s50, s50, 1
    s_cmp_ge_u32 s50, 4
    s_cbranch_scc1 LAST1
    s_waitcnt lgkmcnt(7)
    v_readfirstlane_b32 s66, v252
    s_add_u32 s53, s53, 1
    v_mov_b32 v252, s53
    s_cmp_le_u32 s53, s66
    ds_write2_b32 v251, v252, v252 offset0:0 offset1:8
    s_setprio 1
    s_cbranch_scc1 PRIO_15
    s_setprio 0
PRIO_15:
    s_cmp_eq_u32 s52, 4
    s_cbranch_scc1 ITEM_1_4
    s_cmp_eq_u32 s52, 5
    s_cbranch_scc1 ITEM_1_5
    s_cmp_eq_u32 s52, 3
    s_cbranch_scc1 ITEM_1_3
    s_cmp_eq_u32 s52, 6
    s_cbranch_scc1 ITEM_1_6
    s_cmp_eq_u32 s52, 8
    s_cbranch_scc1 ITEM_1_8
    s_branch ITEM_1_2
WL_8_0:
    s_add_u32 s66, s51, 0
    buffer_load_dwordx4 v[96:99], v246, s[16:19], s66 offen offset:2048 sc1
    buffer_load_dwordx4 v[100:103], v246, s[16:19], s66 offen offset:3072 sc1
    s_branch WR_8_0
WL_8_1:
    s_add_u32 s66, s51, 4096
    buffer_load_dwordx4 v[104:107], v246, s[16:19], s66 offen offset:2048 sc1
    buffer_load_dwordx4 v[108:111], v246, s[16:19], s66 offen offset:3072 sc1
    s_branch WR_8_1
WL_8_2:
    s_add_u32 s66, s51, 8192
    buffer_load_dwordx4 v[128:131], v246, s[16:19], s66 offen offset:2048 sc1
    buffer_load_dwordx4 v[132:135], v246, s[16:19], s66 offen offset:3072 sc1
    s_branch WR_8_2
WL_8_3:
    s_add_u32 s66, s51, 12288
    buffer_load_dwordx4 v[136:139], v246, s[16:19], s66 offen offset:2048 sc1
    buffer_load_dwordx4 v[140:143], v246, s[16:19], s66 offen offset:3072 sc1
    s_branch WR_8_3
.p2align 6
ITEM_1_2:
    s_mov_b32 m0, s50
    s_nop 0
    s_movrels_b32 s71, s23
    s_movrels_b32 s33, s28
    v_add_u32 v253, s33, v248
    s_bfe_u32 s46, s71, 0x30012
    s_mov_b32 m0, s46
    s_and_b32 s66, s71, 0x3ffff
    s_movrels_b32 s68, s57
    s_movrels_b32 s69, s61
    s_sub_u32 s48, s66, s47
    s_mov_b32 s47, s66
    s_lshr_b32 s52, s71, 28
    s_lshl_b32 s67, s46, 9
    s_add_u32 s66, s66, s67
    s_sub_u32 s49, s66, s42
    s_mov_b32 s42, s66
    s_bfe_u32 s66, s68, 655360
    s_add_u32 s43, s42, s66
    s_bfe_u32 s39, s69, 655360
    s_bfe_u32 s66, s68, 655370
    s_add_u32 s44, s42, s66
    s_bfe_u32 s40, s69, 655370
    s_bfe_u32 s66, s68, 655380
    s_add_u32 s45, s42, s66
    s_bfe_u32 s41, s69, 655380
    v_add_u32 v252, s42, v247
    ds_read2_b32 v[234:235], v252 offset0:0 offset1:16
    v_add_u32 v252, s43, v247
    ds_read2_b32 v[236:237], v252 offset0:0 offset1:16
    v_add_u32 v252, s44, v247
    ds_read2_b32 v[238:239], v252 offset0:0 offset1:16
    v_add_u32 v252, s45, v247
    ds_read2_b32 v[240:241], v252 offset0:0 offset1:16
    s_waitcnt lgkmcnt(4)
    v_mul_f32_dpp v196, v242, v72 row_newbcast:0 row_mask:0xf bank_mask:0xf
    v_mul_f32_dpp v197, v242, v73 row_newbcast:1 row_mask:0xf bank_mask:0xf
    v_mul_f32_dpp v198, v242, v72 row_newbcast:8 row_mask:0xf bank_mask:0xf
    v_mul_f32_dpp v199, v242, v73 row_newbcast:9 row_mask:0xf bank_mask:0xf
    v_mul_f32_dpp v200, v242, v76 row_newbcast:2 row_mask:0xf bank_mask:0xf
    v_mul_f32_dpp v201, v242, v77 row_newbcast:3 row_mask:0xf bank_mask:0xf
    v_mul_f32_dpp v202, v242, v76 row_newbcast:10 row_mask:0xf bank_mask:0xf
    v_mul_f32_dpp v203, v242, v77 row_newbcast:11 row_mask:0xf bank_mask:0xf
    v_cvt_pk_bf16_f32 v72, v196, v197
    v_cvt_pk_bf16_f32 v76, v198, v199
    v_cvt_pk_bf16_f32 v73, v200, v201
    v_cvt_pk_bf16_f32 v77, v202, v203
    v_mul_f32_dpp v196, v242, v74 row_newbcast:4 row_mask:0xf bank_mask:0xf
    v_mul_f32_dpp v197, v242, v75 row_newbcast:5 row_mask:0xf bank_mask:0xf
    v_mul_f32_dpp v198, v242, v74 row_newbcast:12 row_mask:0xf bank_mask:0xf
    v_mul_f32_dpp v199, v242, v75 row_newbcast:13 row_mask:0xf bank_mask:0xf
    v_mul_f32_dpp v200, v242, v78 row_newbcast:6 row_mask:0xf bank_mask:0xf
    v_mul_f32_dpp v201, v242, v79 row_newbcast:7 row_mask:0xf bank_mask:0xf
    v_mul_f32_dpp v202, v242, v78 row_newbcast:14 row_mask:0xf bank_mask:0xf
    v_mul_f32_dpp v203, v242, v79 row_newbcast:15 row_mask:0xf bank_mask:0xf
    v_cvt_pk_bf16_f32 v74, v196, v197
    v_cvt_pk_bf16_f32 v78, v198, v199
    v_cvt_pk_bf16_f32 v75, v200, v201
    v_cvt_pk_bf16_f32 v79, v202, v203
    s_nop 0
    s_waitcnt lgkmcnt(3)
    v_mfma_f32_32x32x16_bf16 v[56:71], v[72:75], v[176:179], 0
    s_add_u32 m0, s21, 0
    v_mfma_f32_32x32x16_bf16 v[16:31], v[76:79], v[176:179], 0
    s_cbranch_vccnz WL_2_0
    v_mad_u32_u16 v234, v234, s3, v246 op_sel:[1,0,0,0]
    v_mad_u32_u16 v235, v235, s3, v246 op_sel:[1,0,0,0]
    buffer_load_dwordx4 v234, s[4:7], s38 offen  lds
    buffer_load_dwordx4 v235, s[8:11], s38 offen offset:1024  lds
WR_2_0:
    v_mfma_f32_32x32x16_bf16 v[32:47], v[72:75], v[180:183], 0
    s_nop 3
    v_mul_f32 v196, v56, v96
    v_fmac_f32 v196, v57, v97
    v_fmac_f32 v196, v58, v98
    v_fmac_f32 v196, v59, v99
    v_fmac_f32 v196, v60, v100
    v_fmac_f32 v196, v61, v101
    v_mfma_f32_32x32x16_bf16 v[0:15], v[76:79], v[180:183], 0
    s_waitcnt vmcnt(6)
    ds_read_b64_tr_b16 v[176:177], v244 offset:2048
    ds_read_b64_tr_b16 v[178:179], v244 offset:3072
    ds_read_b64_tr_b16 v[180:181], v245 offset:2048
    ds_read_b64_tr_b16 v[182:183], v245 offset:3072
    v_fmac_f32 v196, v62, v102
    v_fmac_f32 v196, v63, v103
    v_mul_f32 v198, v64, v128
    v_fmac_f32 v198, v65, v129
    v_fmac_f32 v198, v66, v130
    v_fmac_f32 v198, v67, v131
    v_fmac_f32 v198, v68, v132
    v_fmac_f32 v198, v69, v133
    v_fmac_f32 v198, v70, v134
    v_fmac_f32 v198, v71, v135
    v_mul_f32 v200, v16, v128
    v_fmac_f32 v200, v17, v129
    v_permlane32_swap_b32 v196, v198
    v_fmac_f32 v200, v18, v130
    v_fmac_f32 v200, v19, v131
    v_fmac_f32 v200, v20, v132
    v_fmac_f32 v200, v21, v133
    v_fmac_f32 v200, v22, v134
    v_fmac_f32 v200, v23, v135
    v_add_f32 v198, v196, v198
    v_mul_f32_e64 v202, v24, -v128
    v_fma_f32 v202, v25, -v129, v202
    v_fma_f32 v202, v26, -v130, v202
    v_fma_f32 v202, v27, -v131, v202
    v_fma_f32 v202, v28, -v132, v202
    v_fma_f32 v202, v29, -v133, v202
    v_fma_f32 v202, v30, -v134, v202
    v_fma_f32 v202, v31, -v135, v202
    s_nop 1
    v_permlane32_swap_b32 v200, v202
    v_add_f32 v202, v200, v202
    s_waitcnt lgkmcnt(0)
    v_mfma_f32_32x32x16_bf16 v[56:71], v[72:75], v[176:179], 0
    v_mul_f32 v197, v32, v104
    v_fmac_f32 v197, v33, v105
    v_fmac_f32 v197, v34, v106
    v_fmac_f32 v197, v35, v107
    v_fmac_f32 v197, v36, v108
    v_fmac_f32 v197, v37, v109
    s_add_u32 m0, s21, 2048
    v_mfma_f32_32x32x16_bf16 v[16:31], v[76:79], v[176:179], 0
    s_cbranch_vccnz WL_2_1
    v_mad_u32_u16 v236, v236, s3, v246 op_sel:[1,0,0,0]
    v_mad_u32_u16 v237, v237, s3, v246 op_sel:[1,0,0,0]
    buffer_load_dwordx4 v236, s[4:7], s39 offen  lds
    buffer_load_dwordx4 v237, s[8:11], s39 offen offset:1024  lds
WR_2_1:
    v_fmac_f32 v197, v38, v110
    v_fmac_f32 v197, v39, v111
    v_mul_f32 v199, v40, v136
    v_fmac_f32 v199, v41, v137
    v_fmac_f32 v199, v42, v138
    v_fmac_f32 v199, v43, v139
    v_fmac_f32 v199, v44, v140
    v_fmac_f32 v199, v45, v141
    v_fmac_f32 v199, v46, v142
    v_fmac_f32 v199, v47, v143
    v_mul_f32 v201, v0, v136
    v_fmac_f32 v201, v1, v137
    v_permlane32_swap_b32 v197, v199
    v_fmac_f32 v201, v2, v138
    v_fmac_f32 v201, v3, v139
    v_fmac_f32 v201, v4, v140
    v_fmac_f32 v201, v5, v141
    v_fmac_f32 v201, v6, v142
    v_fmac_f32 v201, v7, v143
    v_add_f32 v199, v197, v199
    v_mul_f32_e64 v203, v8, -v136
    v_fma_f32 v203, v9, -v137, v203
    v_fma_f32 v203, v10, -v138, v203
    v_fma_f32 v203, v11, -v139, v203
    v_fma_f32 v203, v12, -v140, v203
    v_fma_f32 v203, v13, -v141, v203
    v_fma_f32 v203, v14, -v142, v203
    v_fma_f32 v203, v15, -v143, v203
    s_nop 1
    v_permlane32_swap_b32 v201, v203
    v_add_f32 v203, v201, v203
    v_cvt_pk_bf16_f32 v192, v198, v199
    v_cvt_pk_bf16_f32 v193, v202, v203
    v_mfma_f32_32x32x16_bf16 v[32:47], v[72:75], v[180:183], 0
    v_mul_f32 v196, v56, v144
    v_fmac_f32 v196, v57, v145
    v_fmac_f32 v196, v58, v146
    v_fmac_f32 v196, v59, v147
    v_fmac_f32 v196, v60, v148
    v_fmac_f32 v196, v61, v149
    v_mfma_f32_32x32x16_bf16 v[0:15], v[76:79], v[180:183], 0
    s_waitcnt vmcnt(6)
    ds_read_b64_tr_b16 v[176:177], v244 offset:4096
    ds_read_b64_tr_b16 v[178:179], v244 offset:5120
    ds_read_b64_tr_b16 v[180:181], v245 offset:4096
    ds_read_b64_tr_b16 v[182:183], v245 offset:5120
    v_fmac_f32 v196, v62, v150
    v_fmac_f32 v196, v63, v151
    v_mul_f32_e64 v200, v16, -v160
    v_fma_f32 v200, v17, -v161, v200
    v_fma_f32 v200, v18, -v162, v200
    v_fma_f32 v200, v19, -v163, v200
    v_fma_f32 v200, v20, -v164, v200
    v_fma_f32 v200, v21, -v165, v200
    v_fma_f32 v200, v22, -v166, v200
    v_fma_f32 v200, v23, -v167, v200
    v_mul_f32_e64 v202, v24, -v160
    v_fma_f32 v202, v25, -v161, v202
    v_fma_f32 v202, v26, -v162, v202
    v_fma_f32 v202, v27, -v163, v202
    v_fma_f32 v202, v28, -v164, v202
    v_fma_f32 v202, v29, -v165, v202
    v_fma_f32 v202, v30, -v166, v202
    v_fma_f32 v202, v31, -v167, v202
    s_waitcnt lgkmcnt(0)
    v_mfma_f32_32x32x16_bf16 v[16:31], v[72:75], v[176:179], 0
    v_mul_f32 v197, v32, v152
    v_fmac_f32 v197, v33, v153
    v_fmac_f32 v197, v34, v154
    v_fmac_f32 v197, v35, v155
    v_fmac_f32 v197, v36, v156
    v_fmac_f32 v197, v37, v157
    s_add_u32 m0, s21, 4096
    v_mfma_f32_32x32x16_bf16 v[48:63], v[76:79], v[176:179], 0
    s_cbranch_vccnz WL_2_2
    v_mad_u32_u16 v238, v238, s3, v246 op_sel:[1,0,0,0]
    v_mad_u32_u16 v239, v239, s3, v246 op_sel:[1,0,0,0]
    buffer_load_dwordx4 v238, s[4:7], s40 offen  lds
    buffer_load_dwordx4 v239, s[8:11], s40 offen offset:1024  lds
WR_2_2:
    v_fmac_f32 v197, v38, v158
    v_fmac_f32 v197, v39, v159
    v_mul_f32_e64 v201, v0, -v168
    v_fma_f32 v201, v1, -v169, v201
    v_fma_f32 v201, v2, -v170, v201
    v_fma_f32 v201, v3, -v171, v201
    v_fma_f32 v201, v4, -v172, v201
    v_fma_f32 v201, v5, -v173, v201
    v_fma_f32 v201, v6, -v174, v201
    v_fma_f32 v201, v7, -v175, v201
    v_mul_f32_e64 v203, v8, -v168
    v_fma_f32 v203, v9, -v169, v203
    v_fma_f32 v203, v10, -v170, v203
    v_fma_f32 v203, v11, -v171, v203
    v_fma_f32 v203, v12, -v172, v203
    v_fma_f32 v203, v13, -v173, v203
    v_fma_f32 v203, v14, -v174, v203
    v_fma_f32 v203, v15, -v175, v203
    v_mfma_f32_32x32x16_bf16 v[0:15], v[72:75], v[180:183], 0
    v_fmac_f32 v200, v24, v160
    v_fmac_f32 v200, v25, v161
    v_fmac_f32 v200, v26, v162
    v_fmac_f32 v200, v27, v163
    v_fmac_f32 v200, v28, v164
    v_fmac_f32 v200, v29, v165
    v_fmac_f32 v200, v30, v166
    v_fmac_f32 v200, v31, v167
    v_mfma_f32_32x32x16_bf16 v[24:39], v[76:79], v[180:183], 0
    s_waitcnt vmcnt(6)
    ds_read_b64_tr_b16 v[176:177], v244 offset:6144
    ds_read_b64_tr_b16 v[178:179], v244 offset:7168
    ds_read_b64_tr_b16 v[180:181], v245 offset:6144
    ds_read_b64_tr_b16 v[182:183], v245 offset:7168
    v_mul_f32 v254, v16, v144
    v_fmac_f32 v254, v17, v145
    v_fmac_f32 v254, v18, v146
    v_fmac_f32 v254, v19, v147
    v_fmac_f32 v254, v20, v148
    v_fmac_f32 v254, v21, v149
    v_fmac_f32 v254, v22, v150
    v_fmac_f32 v254, v23, v151
    v_sub_f32_e64 v64, -v48, v64
    v_sub_f32_e64 v65, -v49, v65
    v_permlane32_swap_b32 v196, v254
    v_sub_f32_e64 v66, -v50, v66
    v_sub_f32_e64 v67, -v51, v67
    v_sub_f32_e64 v68, -v52, v68
    v_sub_f32_e64 v69, -v53, v69
    v_sub_f32_e64 v70, -v54, v70
    v_sub_f32_e64 v71, -v55, v71
    v_add_f32 v254, v196, v254
    s_waitcnt lgkmcnt(0)
    v_mfma_f32_32x32x16_bf16 v[56:71], v[76:79], v[176:179], v[56:71]
    v_sub_f32_e64 v40, -v24, v40
    v_sub_f32_e64 v41, -v25, v41
    v_sub_f32_e64 v42, -v26, v42
    v_sub_f32_e64 v43, -v27, v43
    v_sub_f32_e64 v44, -v28, v44
    v_sub_f32_e64 v45, -v29, v45
    v_sub_f32_e64 v46, -v30, v46
    v_sub_f32_e64 v47, -v31, v47
    s_add_u32 m0, s21, 6144
    v_mfma_f32_32x32x16_bf16 v[16:31], v[72:75], v[176:179], 0
    s_cbranch_vccnz WL_2_3
    v_mad_u32_u16 v240, v240, s3, v246 op_sel:[1,0,0,0]
    v_mad_u32_u16 v241, v241, s3, v246 op_sel:[1,0,0,0]
    buffer_load_dwordx4 v240, s[4:7], s41 offen  lds
    buffer_load_dwordx4 v241, s[8:11], s41 offen offset:1024  lds
WR_2_3:
    v_mul_f32 v255, v0, v152
    v_fmac_f32 v255, v1, v153
    v_fmac_f32 v255, v2, v154
    v_fmac_f32 v255, v3, v155
    v_fmac_f32 v255, v4, v156
    v_fmac_f32 v255, v5, v157
    v_fmac_f32 v255, v6, v158
    v_fmac_f32 v255, v7, v159
    v_fmac_f32 v201, v8, v168
    v_fmac_f32 v201, v9, v169
    v_permlane32_swap_b32 v197, v255
    v_fmac_f32 v201, v10, v170
    v_fmac_f32 v201, v11, v171
    v_fmac_f32 v201, v12, v172
    v_fmac_f32 v201, v13, v173
    v_fmac_f32 v201, v14, v174
    v_fmac_f32 v201, v15, v175
    v_add_f32 v255, v197, v255
    v_cvt_pk_bf16_f32 v194, v254, v255
    v_mfma_f32_32x32x16_bf16 v[0:15], v[72:75], v[180:183], 0
    v_mul_f32 v254, v16, v144
    v_fmac_f32 v254, v17, v145
    v_fmac_f32 v254, v18, v146
    v_fmac_f32 v254, v19, v147
    v_fmac_f32 v254, v20, v148
    v_fmac_f32 v254, v21, v149
    v_mfma_f32_32x32x16_bf16 v[32:47], v[76:79], v[180:183], v[32:47]
    s_waitcnt vmcnt(6)
    ds_read_b64_tr_b16 v[176:177], v244 offset:0
    ds_read_b64_tr_b16 v[178:179], v244 offset:1024
    ds_read_b64_tr_b16 v[180:181], v245 offset:0
    ds_read_b64_tr_b16 v[182:183], v245 offset:1024
    v_add_u32 v249, s48, v249
    v_add_u32 v250, s49, v250
    ds_read_b32 v252, v251 offset:16
    ds_read_b64_tr_b16 v[72:73], v249 offset:0
    ds_read_b64_tr_b16 v[76:77], v249 offset:64
    ds_read_b64_tr_b16 v[74:75], v249 offset:256
    ds_read_b64_tr_b16 v[78:79], v249 offset:320
    s_mov_b64 exec, s[54:55]
    ds_read_u16_d16_hi v242, v250 offset:0
    s_mov_b64 exec, -1
    v_fmac_f32 v254, v22, v150
    v_fmac_f32 v254, v23, v151
    v_fma_f32 v202, v24, -v160, v202
    v_fma_f32 v202, v25, -v161, v202
    v_permlane32_swap_b32 v254, v200
    v_fma_f32 v202, v26, -v162, v202
    v_fma_f32 v202, v27, -v163, v202
    v_fma_f32 v202, v28, -v164, v202
    v_fma_f32 v202, v29, -v165, v202
    v_fma_f32 v202, v30, -v166, v202
    v_fma_f32 v202, v31, -v167, v202
    v_add_f32 v200, v254, v200
    v_mul_f32_e64 v198, v64, -v112
    v_permlane32_swap_b32 v202, v254
    v_fma_f32 v198, v65, -v113, v198
    v_fma_f32 v198, v66, -v114, v198
    v_fma_f32 v198, v67, -v115, v198
    v_fma_f32 v198, v68, -v116, v198
    v_fma_f32 v198, v69, -v117, v198
    v_fma_f32 v198, v70, -v118, v198
    v_fma_f32 v198, v71, -v119, v198
    v_add_f32 v254, v202, v254
    v_mul_f32 v196, v56, v160
    v_fmac_f32 v196, v57, v161
    v_fmac_f32 v196, v58, v162
    v_fmac_f32 v196, v59, v163
    v_fmac_f32 v196, v60, v164
    v_fmac_f32 v196, v61, v165
    v_fmac_f32 v196, v62, v166
    v_fmac_f32 v196, v63, v167
    s_nop 1
    v_permlane32_swap_b32 v198, v196
    v_add_f32 v196, v198, v196
    s_cbranch_vccnz LEPI_2
    v_mul_f32 v255, v0, v152
    v_fmac_f32 v255, v1, v153
    v_fmac_f32 v255, v2, v154
    v_fmac_f32 v255, v3, v155
    v_fmac_f32 v255, v4, v156
    v_fmac_f32 v255, v5, v157
    v_fmac_f32 v255, v6, v158
    v_fmac_f32 v255, v7, v159
    v_fma_f32 v203, v8, -v168, v203
    v_fma_f32 v203, v9, -v169, v203
    v_permlane32_swap_b32 v255, v201
    v_fma_f32 v203, v10, -v170, v203
    v_fma_f32 v203, v11, -v171, v203
    v_fma_f32 v203, v12, -v172, v203
    v_fma_f32 v203, v13, -v173, v203
    v_fma_f32 v203, v14, -v174, v203
    v_fma_f32 v203, v15, -v175, v203
    v_add_f32 v201, v255, v201
    v_mul_f32_e64 v199, v40, -v120
    v_permlane32_swap_b32 v203, v255
    v_fma_f32 v199, v41, -v121, v199
    v_fma_f32 v199, v42, -v122, v199
    v_fma_f32 v199, v43, -v123, v199
    v_fma_f32 v199, v44, -v124, v199
    v_fma_f32 v199, v45, -v125, v199
    v_fma_f32 v199, v46, -v126, v199
    v_fma_f32 v199, v47, -v127, v199
    v_add_f32 v255, v203, v255
    v_mul_f32 v197, v32, v168
    v_fmac_f32 v197, v33, v169
    v_fmac_f32 v197, v34, v170
    v_fmac_f32 v197, v35, v171
    v_fmac_f32 v197, v36, v172
    v_fmac_f32 v197, v37, v173
    v_fmac_f32 v197, v38, v174
    v_fmac_f32 v197, v39, v175
    s_nop 1
    v_permlane32_swap_b32 v199, v197
    v_add_f32 v197, v199, v197
    v_cvt_pk_bf16_f32 v200, v200, v201
    v_cvt_pk_bf16_f32 v254, v254, v255
    v_cvt_pk_bf16_f32 v196, v196, v197
    ds_write2st64_b32 v253, v192, v193 offset0:0 offset1:1
    ds_write2st64_b32 v253, v194, v200 offset0:2 offset1:3
    ds_write_b32 v253, v196 offset:1024
    s_mov_b64 exec, 0xffffffff
    ds_write_b32 v253, v254 offset:1280
    s_mov_b64 exec, -1
    s_add_u32 s50, s50, 1
    s_cmp_ge_u32 s50, 4
    s_cbranch_scc1 LAST1
    s_waitcnt lgkmcnt(9)
    v_readfirstlane_b32 s66, v252
    s_add_u32 s53, s53, 1
    v_mov_b32 v252, s53
    s_cmp_le_u32 s53, s66
    ds_write2_b32 v251, v252, v252 offset0:0 offset1:8
    s_setprio 1
    s_cbranch_scc1 PRIO_16
    s_setprio 0
PRIO_16:
    s_cmp_eq_u32 s52, 4
    s_cbranch_scc1 ITEM_1_4
    s_cmp_eq_u32 s52, 5
    s_cbranch_scc1 ITEM_1_5
    s_cmp_eq_u32 s52, 3
    s_cbranch_scc1 ITEM_1_3
    s_cmp_eq_u32 s52, 6
    s_cbranch_scc1 ITEM_1_6
    s_cmp_eq_u32 s52, 8
    s_cbranch_scc1 ITEM_1_8
    s_branch ITEM_1_2
WL_2_0:
    s_add_u32 s66, s51, 0
    buffer_load_dword v195, v246, s[16:19], s66 offen
    buffer_load_dword v195, v246, s[16:19], s66 offen
    s_branch WR_2_0
WL_2_1:
    s_add_u32 s66, s51, 4096
    buffer_load_dword v195, v246, s[16:19], s66 offen
    buffer_load_dword v195, v246, s[16:19], s66 offen
    s_branch WR_2_1
WL_2_2:
    s_add_u32 s66, s51, 8192
    buffer_load_dword v195, v246, s[16:19], s66 offen
    buffer_load_dword v195, v246, s[16:19], s66 offen
    s_branch WR_2_2
WL_2_3:
    s_add_u32 s66, s51, 12288
    buffer_load_dword v195, v246, s[16:19], s66 offen
    buffer_load_dword v195, v246, s[16:19], s66 offen
    s_branch WR_2_3
.p2align 6
.p2align 6
LEPI_2:
    s_lshl_b32 s71, s20, 4
    s_add_u32 s67, s51, 4096
    s_add_u32 s68, s51, 8192
    s_add_u32 s69, s51, 12288
    s_add_u32 s70, s51, 16384
    s_waitcnt lgkmcnt(0)
    buffer_load_dwordx4 v[96:99], v246, s[16:19], s51 offen offset:2048 sc1
    s_mov_b32 s52, 163072
    v_bfe_u32 v177, v246, 4, 4
    v_bfe_u32 v179, v246, 4, 3
    v_lshl_add_u32 v180, v177, 3, s52
    v_lshl_add_u32 v190, v177, 4, s52
    v_lshl_add_u32 v181, v179, 3, s52
    ds_read2_b64 v[182:185], v180 offset0:32 offset1:48
    ds_read_b32 v191, v190
    ds_read_b64 v[186:187], v181 offset:512
    v_lshrrev_b32 v178, 8, v246
    buffer_load_dwordx4 v[100:103], v246, s[16:19], s51 offen offset:3072 sc1
    v_add_u32 v234, s21, v248
    v_add_u32 v235, 128, v234
    v_mul_f32 v255, v0, v152
    buffer_load_dwordx4 v[104:107], v246, s[16:19], s67 offen offset:2048 sc1
    v_fmac_f32 v255, v1, v153
    v_fmac_f32 v255, v2, v154
    ds_write2st64_b32 v234, v204, v205 offset0:0 offset1:1
    v_fmac_f32 v255, v3, v155
    buffer_load_dwordx4 v[108:111], v246, s[16:19], s67 offen offset:3072 sc1
    v_fmac_f32 v255, v4, v156
    v_fmac_f32 v255, v5, v157
    ds_write2st64_b32 v234, v206, v207 offset0:2 offset1:3
    v_fmac_f32 v255, v6, v158
    buffer_load_dwordx4 v[128:131], v246, s[16:19], s68 offen offset:2048 sc1
    v_fmac_f32 v255, v7, v159
    v_fma_f32 v203, v8, -v168, v203
    ds_write2st64_b32 v234, v208, v209 offset0:4 offset1:5
    v_fma_f32 v203, v9, -v169, v203
    buffer_load_dwordx4 v[132:135], v246, s[16:19], s68 offen offset:3072 sc1
    v_permlane32_swap_b32 v255, v201
    v_fma_f32 v203, v10, -v170, v203
    ds_write2st64_b32 v235, v210, v211 offset0:6 offset1:7
    v_fma_f32 v203, v11, -v171, v203
    v_fma_f32 v203, v12, -v172, v203
    buffer_load_dwordx4 v[136:139], v246, s[16:19], s69 offen offset:2048 sc1
    v_fma_f32 v203, v13, -v173, v203
    ds_write2st64_b32 v235, v212, v213 offset0:8 offset1:9
    v_fma_f32 v203, v14, -v174, v203
    v_fma_f32 v203, v15, -v175, v203
    buffer_load_dwordx4 v[140:143], v246, s[16:19], s69 offen offset:3072 sc1
    v_add_f32 v201, v255, v201
    ds_write2st64_b32 v235, v214, v215 offset0:10 offset1:11
    v_mul_f32_e64 v199, v40, -v120
    v_permlane32_swap_b32 v203, v255
    buffer_load_dwordx4 v[112:115], v246, s[16:19], s70 offen offset:2048 sc1
    v_fma_f32 v199, v41, -v121, v199
    ds_write2st64_b32 v234, v216, v217 offset0:12 offset1:13
    v_fma_f32 v199, v42, -v122, v199
    v_fma_f32 v199, v43, -v123, v199
    buffer_load_dwordx4 v[116:119], v246, s[16:19], s70 offen offset:3072 sc1
    v_fma_f32 v199, v44, -v124, v199
    ds_write2st64_b32 v234, v218, v219 offset0:14 offset1:15
    v_fma_f32 v199, v45, -v125, v199
    v_fma_f32 v199, v46, -v126, v199
    buffer_load_dwordx4 v[144:147], v246, s[16:19], s51 offen offset:0 sc1
    v_fma_f32 v199, v47, -v127, v199
    v_add_f32 v255, v203, v255
    ds_write2st64_b32 v234, v220, v221 offset0:16 offset1:17
    v_mul_f32 v197, v32, v168
    buffer_load_dwordx4 v[148:151], v246, s[16:19], s51 offen offset:1024 sc1
    v_fmac_f32 v197, v33, v169
    v_fmac_f32 v197, v34, v170
    ds_write2st64_b32 v235, v222, v223 offset0:18 offset1:19
    v_fmac_f32 v197, v35, v171
    buffer_load_dwordx4 v[160:163], v246, s[16:19], s67 offen offset:0 sc1
    v_fmac_f32 v197, v36, v172
    v_fmac_f32 v197, v37, v173
    ds_write2st64_b32 v235, v224, v225 offset0:20 offset1:21
    v_fmac_f32 v197, v38, v174
    buffer_load_dwordx4 v[164:167], v246, s[16:19], s67 offen offset:1024 sc1
    v_fmac_f32 v197, v39, v175
    s_nop 1
    ds_write2st64_b32 v235, v226, v227 offset0:22 offset1:23
    v_permlane32_swap_b32 v199, v197
    ds_write2st64_b32 v234, v228, v229 offset0:24 offset1:25
    v_add_f32 v197, v199, v197
    v_cvt_pk_bf16_f32 v200, v200, v201
    ds_write2st64_b32 v234, v230, v231 offset0:26 offset1:27
    v_cvt_pk_bf16_f32 v254, v254, v255
    v_cvt_pk_bf16_f32 v196, v196, v197
    ds_write2st64_b32 v234, v232, v233 offset0:28 offset1:29
    ds_write2st64_b32 v253, v192, v193 offset0:0 offset1:1
    ds_write2st64_b32 v253, v194, v200 offset0:2 offset1:3
    ds_write_b32 v253, v196 offset:1024
    s_mov_b64 exec, 0xffffffff
    ds_write_b32 v253, v254 offset:1280
    s_mov_b64 exec, -1
    s_add_u32 s50, s53, 1
    v_mov_b32 v234, s50
    ds_write2_b32 v251, v234, v234 offset0:0 offset1:8
    s_waitcnt lgkmcnt(15)
    s_branch TAIL
.p2align 6
LEPI_1:
    s_lshl_b32 s71, s20, 4
    s_add_u32 s67, s51, 4096
    s_add_u32 s68, s51, 8192
    s_add_u32 s69, s51, 12288
    s_add_u32 s70, s51, 16384
    s_waitcnt lgkmcnt(0)
    buffer_load_dwordx4 v[112:115], v246, s[16:19], s70 offen offset:2048 sc1
    s_mov_b32 s52, 163072
    v_bfe_u32 v177, v246, 4, 4
    v_bfe_u32 v179, v246, 4, 3
    v_lshl_add_u32 v180, v177, 3, s52
    v_lshl_add_u32 v190, v177, 4, s52
    v_lshl_add_u32 v181, v179, 3, s52
    ds_read2_b64 v[182:185], v180 offset0:32 offset1:48
    ds_read_b32 v191, v190
    ds_read_b64 v[186:187], v181 offset:512
    v_lshrrev_b32 v178, 8, v246
    buffer_load_dwordx4 v[116:119], v246, s[16:19], s70 offen offset:3072 sc1
    v_add_u32 v234, s21, v248
    v_add_u32 v235, 128, v234
    v_mul_f32 v255, v16, v152
    v_fmac_f32 v255, v17, v153
    buffer_load_dwordx4 v[144:147], v246, s[16:19], s51 offen offset:0 sc1
    v_fmac_f32 v255, v18, v154
    v_fmac_f32 v255, v19, v155
    ds_write2st64_b32 v234, v204, v205 offset0:0 offset1:1
    v_fmac_f32 v255, v20, v156
    v_fmac_f32 v255, v21, v157
    buffer_load_dwordx4 v[148:151], v246, s[16:19], s51 offen offset:1024 sc1
    v_fmac_f32 v255, v22, v158
    v_fmac_f32 v255, v23, v159
    ds_write2st64_b32 v234, v206, v207 offset0:2 offset1:3
    v_fma_f32 v203, v24, -v168, v203
    v_fma_f32 v203, v25, -v169, v203
    v_permlane32_swap_b32 v255, v201
    buffer_load_dwordx4 v[160:163], v246, s[16:19], s67 offen offset:0 sc1
    v_fma_f32 v203, v26, -v170, v203
    v_fma_f32 v203, v27, -v171, v203
    ds_write2st64_b32 v234, v208, v209 offset0:4 offset1:5
    v_fma_f32 v203, v28, -v172, v203
    v_fma_f32 v203, v29, -v173, v203
    buffer_load_dwordx4 v[164:167], v246, s[16:19], s67 offen offset:1024 sc1
    v_fma_f32 v203, v30, -v174, v203
    v_fma_f32 v203, v31, -v175, v203
    ds_write2st64_b32 v235, v210, v211 offset0:6 offset1:7
    v_add_f32 v201, v255, v201
    v_fmac_f32 v199, v32, v120
    ds_write2st64_b32 v235, v212, v213 offset0:8 offset1:9
    v_permlane32_swap_b32 v203, v255
    v_fmac_f32 v199, v33, v121
    v_fmac_f32 v199, v34, v122
    ds_write2st64_b32 v235, v214, v215 offset0:10 offset1:11
    v_fmac_f32 v199, v35, v123
    v_fmac_f32 v199, v36, v124
    ds_write2st64_b32 v234, v216, v217 offset0:12 offset1:13
    v_fmac_f32 v199, v37, v125
    v_fmac_f32 v199, v38, v126
    ds_write2st64_b32 v234, v218, v219 offset0:14 offset1:15
    v_fmac_f32 v199, v39, v127
    v_add_f32 v255, v203, v255
    ds_write2st64_b32 v234, v220, v221 offset0:16 offset1:17
    v_mul_f32 v197, v40, v168
    v_fmac_f32 v197, v41, v169
    ds_write2st64_b32 v235, v222, v223 offset0:18 offset1:19
    v_fmac_f32 v197, v42, v170
    v_fmac_f32 v197, v43, v171
    v_fmac_f32 v197, v44, v172
    ds_write2st64_b32 v235, v224, v225 offset0:20 offset1:21
    v_fmac_f32 v197, v45, v173
    v_fmac_f32 v197, v46, v174
    ds_write2st64_b32 v235, v226, v227 offset0:22 offset1:23
    v_fmac_f32 v197, v47, v175
    s_nop 1
    ds_write2st64_b32 v234, v228, v229 offset0:24 offset1:25
    v_permlane32_swap_b32 v199, v197
    v_add_f32 v197, v199, v197
    ds_write2st64_b32 v234, v230, v231 offset0:26 offset1:27
    v_cvt_pk_bf16_f32 v200, v200, v201
    v_cvt_pk_bf16_f32 v254, v254, v255
    v_cvt_pk_bf16_f32 v196, v196, v197
    ds_write2st64_b32 v234, v232, v233 offset0:28 offset1:29
    ds_write2st64_b32 v253, v200, v196 offset0:3 offset1:4
    s_mov_b64 exec, 0xffffffff
    ds_write_b32 v253, v254 offset:1280
    s_mov_b64 exec, -1
    s_add_u32 s50, s53, 1
    v_mov_b32 v234, s50
    ds_write2_b32 v251, v234, v234 offset0:0 offset1:8
    s_waitcnt lgkmcnt(15)
    s_branch TAIL
.p2align 6
LEPI_0:
    s_lshl_b32 s71, s20, 4
    s_add_u32 s67, s51, 4096
    s_add_u32 s68, s51, 8192
    s_add_u32 s69, s51, 12288
    s_add_u32 s70, s51, 16384
    s_waitcnt lgkmcnt(0)
    buffer_load_dwordx4 v[112:115], v246, s[16:19], s70 offen offset:2048 sc1
    s_mov_b32 s52, 163072
    v_bfe_u32 v177, v246, 4, 4
    v_bfe_u32 v179, v246, 4, 3
    v_lshl_add_u32 v180, v177, 3, s52
    v_lshl_add_u32 v190, v177, 4, s52
    v_lshl_add_u32 v181, v179, 3, s52
    ds_read2_b64 v[182:185], v180 offset0:32 offset1:48
    ds_read_b32 v191, v190
    ds_read_b64 v[186:187], v181 offset:512
    v_lshrrev_b32 v178, 8, v246
    buffer_load_dwordx4 v[116:119], v246, s[16:19], s70 offen offset:3072 sc1
    v_add_u32 v234, s21, v248
    v_add_u32 v235, 128, v234
    v_mul_f32 v255, v0, v152
    v_fmac_f32 v255, v1, v153
    buffer_load_dwordx4 v[144:147], v246, s[16:19], s51 offen offset:0 sc1
    v_fmac_f32 v255, v2, v154
    v_fmac_f32 v255, v3, v155
    ds_write2st64_b32 v234, v204, v205 offset0:0 offset1:1
    v_fmac_f32 v255, v4, v156
    v_fmac_f32 v255, v5, v157
    buffer_load_dwordx4 v[148:151], v246, s[16:19], s51 offen offset:1024 sc1
    v_fmac_f32 v255, v6, v158
    v_fmac_f32 v255, v7, v159
    ds_write2st64_b32 v234, v206, v207 offset0:2 offset1:3
    v_fma_f32 v203, v8, -v168, v203
    v_fma_f32 v203, v9, -v169, v203
    v_permlane32_swap_b32 v255, v201
    buffer_load_dwordx4 v[160:163], v246, s[16:19], s67 offen offset:0 sc1
    v_fma_f32 v203, v10, -v170, v203
    v_fma_f32 v203, v11, -v171, v203
    ds_write2st64_b32 v234, v208, v209 offset0:4 offset1:5
    v_fma_f32 v203, v12, -v172, v203
    v_fma_f32 v203, v13, -v173, v203
    buffer_load_dwordx4 v[164:167], v246, s[16:19], s67 offen offset:1024 sc1
    v_fma_f32 v203, v14, -v174, v203
    v_fma_f32 v203, v15, -v175, v203
    ds_write2st64_b32 v235, v210, v211 offset0:6 offset1:7
    v_add_f32 v201, v255, v201
    v_mul_f32_e64 v199, v40, -v120
    ds_write2st64_b32 v235, v212, v213 offset0:8 offset1:9
    v_permlane32_swap_b32 v203, v255
    v_fma_f32 v199, v41, -v121, v199
    v_fma_f32 v199, v42, -v122, v199
    ds_write2st64_b32 v235, v214, v215 offset0:10 offset1:11
    v_fma_f32 v199, v43, -v123, v199
    v_fma_f32 v199, v44, -v124, v199
    ds_write2st64_b32 v234, v216, v217 offset0:12 offset1:13
    v_fma_f32 v199, v45, -v125, v199
    v_fma_f32 v199, v46, -v126, v199
    ds_write2st64_b32 v234, v218, v219 offset0:14 offset1:15
    v_fma_f32 v199, v47, -v127, v199
    v_add_f32 v255, v203, v255
    ds_write2st64_b32 v234, v220, v221 offset0:16 offset1:17
    v_mul_f32 v197, v32, v168
    v_fmac_f32 v197, v33, v169
    ds_write2st64_b32 v235, v222, v223 offset0:18 offset1:19
    v_fmac_f32 v197, v34, v170
    v_fmac_f32 v197, v35, v171
    v_fmac_f32 v197, v36, v172
    ds_write2st64_b32 v235, v224, v225 offset0:20 offset1:21
    v_fmac_f32 v197, v37, v173
    v_fmac_f32 v197, v38, v174
    ds_write2st64_b32 v235, v226, v227 offset0:22 offset1:23
    v_fmac_f32 v197, v39, v175
    s_nop 1
    ds_write2st64_b32 v234, v228, v229 offset0:24 offset1:25
    v_permlane32_swap_b32 v199, v197
    v_add_f32 v197, v199, v197
    ds_write2st64_b32 v234, v230, v231 offset0:26 offset1:27
    v_cvt_pk_bf16_f32 v200, v200, v201
    v_cvt_pk_bf16_f32 v254, v254, v255
    v_cvt_pk_bf16_f32 v196, v196, v197
    ds_write2st64_b32 v234, v232, v233 offset0:28 offset1:29
    ds_write2st64_b32 v253, v192, v193 offset0:0 offset1:1
    ds_write2st64_b32 v253, v194, v200 offset0:2 offset1:3
    ds_write_b32 v253, v196 offset:1024
    s_mov_b64 exec, 0xffffffff
    ds_write_b32 v253, v254 offset:1280
    s_mov_b64 exec, -1
    s_add_u32 s50, s53, 1
    v_mov_b32 v234, s50
    ds_write2_b32 v251, v234, v234 offset0:0 offset1:8
    s_waitcnt lgkmcnt(15)
TAIL:
    s_and_b32 s71, s20, 3
    s_lshl_b32 s71, s71, 2
    s_bitcmp0_b32 s20, 2
    s_addc_u32 s71, s71, 0
    v_readlane_b32 s71, v191, s71
    buffer_load_dwordx4 v[120:123], v246, s[16:19], s68 offen offset:0 sc1
    buffer_load_dwordx4 v[124:127], v246, s[16:19], s68 offen offset:1024 sc1
    s_cmp_ge_u32 s71, s50
    s_setprio 1
    s_cbranch_scc1 T_second
    s_setprio 0
T_second:
    buffer_load_dwordx4 v[152:155], v246, s[16:19], s69 offen offset:0 sc1
    buffer_load_dwordx4 v[156:159], v246, s[16:19], s69 offen offset:1024 sc1
    buffer_load_dwordx4 v[168:171], v246, s[16:19], s70 offen offset:0 sc1
    buffer_load_dwordx4 v[172:175], v246, s[16:19], s70 offen offset:1024 sc1
GEMM:
    v_cmp_gt_u32 vcc, s53, v191
    v_xor_b32 v180, v179, v178
    v_xor_b32 v188, 4, v180
    v_lshl_add_u32 v66, v180, 4, v183
    v_lshl_add_u32 v67, v188, 4, v183
    v_lshl_add_u32 v70, v180, 4, v185
    v_lshl_add_u32 v71, v188, 4, v185
    s_mov_b32 s4, s72
    s_and_b32 s5, s73, 0xffff
    s_mov_b32 s6, 10240000
    s_mov_b32 s7, 0x20000
    s_cbranch_vccnz T_pw
T_pwr:
    ds_read_b128 v[76:79], v66 offset:0
    ds_read_b128 v[80:83], v70 offset:0
    ds_read_b128 v[84:87], v67 offset:0
    ds_read_b128 v[88:91], v71 offset:0
    ds_read_b128 v[92:95], v66 offset:1024
    s_waitcnt vmcnt(19) lgkmcnt(4)
    v_mfma_f32_16x16x32_bf16 v[0:3], v[96:99], v[76:79], 0
    v_and_b32 v181, 8, v177
    v_add_u32 v189, v188, v181
    ds_read_b128 v[76:79], v70 offset:1024
    s_waitcnt lgkmcnt(4)
    v_mfma_f32_16x16x32_bf16 v[4:7], v[96:99], v[80:83], 0
    v_add_u32 v181, v180, v181
    v_lshl_add_u32 v64, v180, 4, v182
    ds_read_b128 v[80:83], v67 offset:1024
    s_waitcnt vmcnt(18) lgkmcnt(4)
    v_mfma_f32_16x16x32_bf16 v[0:3], v[100:103], v[84:87], v[0:3]
    v_lshl_add_u32 v65, v188, 4, v182
    v_lshl_add_u32 v68, v180, 4, v184
    ds_read_b128 v[84:87], v71 offset:1024
    s_waitcnt lgkmcnt(4)
    v_mfma_f32_16x16x32_bf16 v[4:7], v[100:103], v[88:91], v[4:7]
    v_lshl_add_u32 v69, v188, 4, v184
    v_lshl_add_u32 v72, v181, 4, v186
    ds_read_b128 v[88:91], v66 offset:128
    s_waitcnt vmcnt(17) lgkmcnt(4)
    v_mfma_f32_16x16x32_bf16 v[0:3], v[104:107], v[92:95], v[0:3]
    v_lshl_add_u32 v73, v189, 4, v186
    v_lshl_add_u32 v74, v181, 4, v187
    ds_read_b128 v[92:95], v66 offset:256
    s_waitcnt lgkmcnt(4)
    v_mfma_f32_16x16x32_bf16 v[4:7], v[104:107], v[76:79], v[4:7]
    v_lshl_add_u32 v75, v189, 4, v187
    s_mov_b32 s67, 0xbfb8aa3b
    ds_read_b128 v[76:79], v66 offset:384
    s_waitcnt vmcnt(16) lgkmcnt(4)
    v_mfma_f32_16x16x32_bf16 v[0:3], v[108:111], v[80:83], v[0:3]
    v_lshrrev_b32 v205, 1, v178
    v_lshl_add_u32 v205, s20, 1, v205
    ds_read_b128 v[80:83], v70 offset:128
    s_waitcnt lgkmcnt(4)
    v_mfma_f32_16x16x32_bf16 v[4:7], v[108:111], v[84:87], v[4:7]
    v_xor_b32 v205, v205, v179
    v_and_b32 v204, 1, v178
    ds_read_b128 v[84:87], v70 offset:256
    s_waitcnt vmcnt(15) lgkmcnt(4)
    v_mfma_f32_16x16x32_bf16 v[12:15], v[128:131], v[88:91], 0
    v_lshlrev_b32 v204, 3, v204
    v_lshl_add_u32 v205, v205, 4, v204
    ds_read_b128 v[88:91], v70 offset:384
    s_waitcnt lgkmcnt(4)
    v_mfma_f32_16x16x32_bf16 v[24:27], v[128:131], v[92:95], 0
    v_and_b32 v220, 8, v177
    v_lshl_add_u32 v204, v220, 4, v205
    ds_read_b128 v[92:95], v67 offset:128
    s_waitcnt lgkmcnt(4)
    v_mfma_f32_16x16x32_bf16 v[36:39], v[128:131], v[76:79], 0
    v_lshl_add_u32 v204, v177, 10, v204
    v_add_u32 v204, 65536, v204
    ds_read_b128 v[76:79], v67 offset:256
    s_waitcnt lgkmcnt(4)
    v_mfma_f32_16x16x32_bf16 v[16:19], v[128:131], v[80:83], 0
    v_add_u32 v205, v205, v182
    v_mul_u32_u24 v220, 1008, v220
    ds_read_b128 v[80:83], v67 offset:384
    s_waitcnt lgkmcnt(4)
    v_mfma_f32_16x16x32_bf16 v[28:31], v[128:131], v[84:87], 0
    v_sub_u32 v220, v204, v220
    s_lshl_b32 s70, s20, 4
    ds_read_b128 v[84:87], v71 offset:128
    s_waitcnt lgkmcnt(4)
    v_mfma_f32_16x16x32_bf16 v[40:43], v[128:131], v[88:91], 0
    v_xor_b32 v206, s70, v246
    s_lshl_b32 s70, s20, 10
    ds_read_b128 v[88:91], v71 offset:256
    s_waitcnt vmcnt(14) lgkmcnt(4)
    v_mfma_f32_16x16x32_bf16 v[12:15], v[132:135], v[92:95], v[12:15]
    s_add_u32 s70, s70, 65536
    v_add_u32 v207, s21, v206
    ds_read_b128 v[92:95], v71 offset:384
    s_waitcnt lgkmcnt(4)
    v_mfma_f32_16x16x32_bf16 v[24:27], v[132:135], v[76:79], v[24:27]
    v_add_u32 v206, s70, v206
    s_mul_i32 s66, s2, 40960
    ds_read_b128 v[76:79], v66 offset:512
    s_waitcnt lgkmcnt(4)
    v_mfma_f32_16x16x32_bf16 v[36:39], v[132:135], v[80:83], v[36:39]
    s_bfe_u32 s22, s22, 393237
    s_lshl_b32 s22, s22, 10
    ds_read_b128 v[80:83], v66 offset:640
    s_waitcnt lgkmcnt(4)
    v_mfma_f32_16x16x32_bf16 v[16:19], v[132:135], v[84:87], v[16:19]
    s_add_u32 s22, s22, s66
    s_bfe_u32 s23, s23, 393237
    ds_read_b128 v[84:87], v66 offset:768
    s_waitcnt lgkmcnt(4)
    v_mfma_f32_16x16x32_bf16 v[28:31], v[132:135], v[88:91], v[28:31]
    s_lshl_b32 s23, s23, 10
    s_add_u32 s23, s23, s66
    ds_read_b128 v[88:91], v70 offset:512
    s_waitcnt lgkmcnt(4)
    v_mfma_f32_16x16x32_bf16 v[40:43], v[132:135], v[92:95], v[40:43]
    s_bfe_u32 s24, s24, 393237
    s_lshl_b32 s24, s24, 10
    ds_read_b128 v[92:95], v70 offset:640
    s_waitcnt vmcnt(13) lgkmcnt(4)
    v_mfma_f32_16x16x32_bf16 v[12:15], v[136:139], v[76:79], v[12:15]
    s_add_u32 s24, s24, s66
    s_bfe_u32 s25, s25, 393237
    ds_read_b128 v[76:79], v70 offset:768
    s_waitcnt lgkmcnt(4)
    v_mfma_f32_16x16x32_bf16 v[24:27], v[136:139], v[80:83], v[24:27]
    s_lshl_b32 s25, s25, 10
    s_add_u32 s25, s25, s66
    ds_read_b128 v[80:83], v67 offset:512
    s_waitcnt lgkmcnt(4)
    v_mfma_f32_16x16x32_bf16 v[36:39], v[136:139], v[84:87], v[36:39]
    s_bfe_u32 s26, s26, 393237
    s_lshl_b32 s26, s26, 10
    ds_read_b128 v[84:87], v67 offset:640
    s_waitcnt lgkmcnt(4)
    v_mfma_f32_16x16x32_bf16 v[16:19], v[136:139], v[88:91], v[16:19]
    s_add_u32 s26, s26, s66
    ds_read_b128 v[88:91], v67 offset:768
    s_waitcnt lgkmcnt(4)
    v_mfma_f32_16x16x32_bf16 v[28:31], v[136:139], v[92:95], v[28:31]
    ds_read_b128 v[92:95], v71 offset:512
    s_waitcnt lgkmcnt(4)
    v_mfma_f32_16x16x32_bf16 v[40:43], v[136:139], v[76:79], v[40:43]
    ds_read_b128 v[76:79], v71 offset:640
    s_waitcnt vmcnt(12) lgkmcnt(4)
    v_mfma_f32_16x16x32_bf16 v[12:15], v[140:143], v[80:83], v[12:15]
    ds_read_b128 v[80:83], v71 offset:768
    s_waitcnt lgkmcnt(4)
    v_mfma_f32_16x16x32_bf16 v[24:27], v[140:143], v[84:87], v[24:27]
    ds_read_b128 v[84:87], v66 offset:1152
    s_waitcnt lgkmcnt(4)
    v_mfma_f32_16x16x32_bf16 v[36:39], v[140:143], v[88:91], v[36:39]
    ds_read_b128 v[88:91], v66 offset:1280
    s_waitcnt lgkmcnt(4)
    v_mfma_f32_16x16x32_bf16 v[16:19], v[140:143], v[92:95], v[16:19]
    ds_read_b128 v[92:95], v66 offset:896
    s_waitcnt lgkmcnt(4)
    v_mfma_f32_16x16x32_bf16 v[28:31], v[140:143], v[76:79], v[28:31]
    ds_read_b128 v[76:79], v70 offset:1152
    s_waitcnt lgkmcnt(4)
    v_mfma_f32_16x16x32_bf16 v[40:43], v[140:143], v[80:83], v[40:43]
    ds_read_b128 v[80:83], v70 offset:1280
    s_waitcnt vmcnt(11) lgkmcnt(4)
    v_mfma_f32_16x16x32_bf16 v[12:15], v[112:115], v[84:87], v[12:15]
    ds_read_b128 v[84:87], v70 offset:896
    s_waitcnt lgkmcnt(4)
    v_mfma_f32_16x16x32_bf16 v[24:27], v[112:115], v[88:91], v[24:27]
    ds_read_b128 v[88:91], v67 offset:1152
    s_waitcnt lgkmcnt(4)
    v_mfma_f32_16x16x32_bf16 v[36:39], v[112:115], v[92:95], v[36:39]
    ds_read_b128 v[92:95], v67 offset:1280
    s_waitcnt lgkmcnt(4)
    v_mfma_f32_16x16x32_bf16 v[16:19], v[112:115], v[76:79], v[16:19]
    ds_read_b128 v[76:79], v67 offset:896
    s_waitcnt lgkmcnt(4)
    v_mfma_f32_16x16x32_bf16 v[28:31], v[112:115], v[80:83], v[28:31]
    ds_read_b32 v191, v190
    ds_read_b128 v[80:83], v71 offset:1152
    s_waitcnt lgkmcnt(5)
    v_mfma_f32_16x16x32_bf16 v[40:43], v[112:115], v[84:87], v[40:43]
    ds_read_b128 v[84:87], v71 offset:1280
    s_waitcnt vmcnt(10) lgkmcnt(5)
    v_mfma_f32_16x16x32_bf16 v[12:15], v[116:119], v[88:91], v[12:15]
    ds_read_b128 v[88:91], v71 offset:896
    s_waitcnt lgkmcnt(5)
    v_mfma_f32_16x16x32_bf16 v[24:27], v[116:119], v[92:95], v[24:27]
    s_waitcnt lgkmcnt(3)
    v_cmp_gt_u32 vcc, s50, v191
    s_cbranch_vccnz T_aw
T_awr:
    ds_read_b128 v[92:95], v64 offset:0
    v_mfma_f32_16x16x32_bf16 v[36:39], v[116:119], v[76:79], v[36:39]
    ds_read_b128 v[76:79], v68 offset:0
    s_waitcnt lgkmcnt(4)
    v_mfma_f32_16x16x32_bf16 v[16:19], v[116:119], v[80:83], v[16:19]
    ds_read_b128 v[80:83], v65 offset:0
    s_waitcnt lgkmcnt(4)
    v_mfma_f32_16x16x32_bf16 v[28:31], v[116:119], v[84:87], v[28:31]
    ds_read_b128 v[84:87], v69 offset:0
    s_waitcnt lgkmcnt(4)
    v_mfma_f32_16x16x32_bf16 v[40:43], v[116:119], v[88:91], v[40:43]
    ds_read_b128 v[88:91], v64 offset:1024
    s_waitcnt vmcnt(9) lgkmcnt(4)
    v_mfma_f32_16x16x32_bf16 v[0:3], v[144:147], v[92:95], v[0:3]
    ds_read_b128 v[92:95], v68 offset:1024
    s_waitcnt lgkmcnt(4)
    v_mfma_f32_16x16x32_bf16 v[4:7], v[144:147], v[76:79], v[4:7]
    ds_read_b128 v[76:79], v65 offset:1024
    s_waitcnt vmcnt(8) lgkmcnt(4)
    v_mfma_f32_16x16x32_bf16 v[0:3], v[148:151], v[80:83], v[0:3]
    ds_read_b128 v[80:83], v69 offset:1024
    s_waitcnt lgkmcnt(4)
    v_mfma_f32_16x16x32_bf16 v[4:7], v[148:151], v[84:87], v[4:7]
    ds_read_b128 v[84:87], v72 offset:0
    s_waitcnt vmcnt(7) lgkmcnt(4)
    v_mfma_f32_16x16x32_bf16 v[0:3], v[160:163], v[88:91], v[0:3]
    ds_read_b128 v[88:91], v73 offset:0
    s_waitcnt lgkmcnt(4)
    v_mfma_f32_16x16x32_bf16 v[4:7], v[160:163], v[92:95], v[4:7]
    ds_read_b128 v[92:95], v74 offset:0
    s_waitcnt vmcnt(6) lgkmcnt(4)
    v_mfma_f32_16x16x32_bf16 v[0:3], v[164:167], v[76:79], v[0:3]
    ds_read_b128 v[76:79], v75 offset:0
    s_waitcnt lgkmcnt(4)
    v_mfma_f32_16x16x32_bf16 v[4:7], v[164:167], v[80:83], v[4:7]
    ds_read_b128 v[80:83], v72 offset:1024
    s_waitcnt lgkmcnt(4)
    v_mfma_f32_16x16x32_bf16 v[8:11], v[144:147], v[84:87], 0
    ds_read_b128 v[84:87], v73 offset:1024
    s_waitcnt lgkmcnt(4)
    v_mfma_f32_16x16x32_bf16 v[8:11], v[148:151], v[88:91], v[8:11]
    v_mul_f32 v192, s67, v0
    v_mul_f32 v193, s67, v1
    ds_read_b128 v[88:91], v74 offset:1024
    s_waitcnt lgkmcnt(4)
    v_mfma_f32_16x16x32_bf16 v[8:11], v[96:99], v[92:95], v[8:11]
    v_mul_f32 v194, s67, v2
    v_mul_f32 v195, s67, v3
    ds_read_b128 v[92:95], v75 offset:1024
    s_waitcnt lgkmcnt(4)
    v_mfma_f32_16x16x32_bf16 v[8:11], v[100:103], v[76:79], v[8:11]
    v_exp_f32 v192, v192
    v_exp_f32 v193, v193
    ds_read_b128 v[76:79], v64 offset:128
    s_waitcnt lgkmcnt(4)
    v_mfma_f32_16x16x32_bf16 v[8:11], v[160:163], v[80:83], v[8:11]
    v_exp_f32 v194, v194
    v_exp_f32 v195, v195
    ds_read_b128 v[80:83], v65 offset:128
    s_waitcnt lgkmcnt(4)
    v_mfma_f32_16x16x32_bf16 v[8:11], v[164:167], v[84:87], v[8:11]
    v_add_f32 v192, 1.0, v192
    v_add_f32 v193, 1.0, v193
    ds_read_b128 v[84:87], v64 offset:512
    s_waitcnt lgkmcnt(4)
    v_mfma_f32_16x16x32_bf16 v[8:11], v[104:107], v[88:91], v[8:11]
    v_add_f32 v194, 1.0, v194
    v_add_f32 v195, 1.0, v195
    ds_read_b128 v[88:91], v65 offset:512
    s_waitcnt lgkmcnt(4)
    v_mfma_f32_16x16x32_bf16 v[8:11], v[108:111], v[92:95], v[8:11]
    v_rcp_f32 v192, v192
    v_rcp_f32 v193, v193
    ds_read_b128 v[92:95], v64 offset:1152
    s_waitcnt vmcnt(5) lgkmcnt(4)
    v_mfma_f32_16x16x32_bf16 v[12:15], v[120:123], v[76:79], v[12:15]
    v_rcp_f32 v194, v194
    v_rcp_f32 v195, v195
    ds_read_b128 v[76:79], v65 offset:1152
    s_waitcnt vmcnt(4) lgkmcnt(4)
    v_mfma_f32_16x16x32_bf16 v[12:15], v[124:127], v[80:83], v[12:15]
    v_cvt_pk_bf16_f32 v0, v0, v1
    v_cvt_pk_bf16_f32 v1, v2, v3
    ds_read_b128 v[80:83], v64 offset:256
    s_waitcnt vmcnt(3) lgkmcnt(4)
    v_mfma_f32_16x16x32_bf16 v[12:15], v[152:155], v[84:87], v[12:15]
    ds_write_b64 v204, v[0:1] offset:0
    v_mul_f32 v196, s67, v4
    ds_read_b128 v[84:87], v65 offset:256
    s_waitcnt vmcnt(2) lgkmcnt(5)
    v_mfma_f32_16x16x32_bf16 v[12:15], v[156:159], v[88:91], v[12:15]
    v_mul_f32 v197, s67, v5
    v_mul_f32 v198, s67, v6
    ds_read_b128 v[88:91], v64 offset:640
    s_waitcnt vmcnt(1) lgkmcnt(5)
    v_mfma_f32_16x16x32_bf16 v[12:15], v[168:171], v[92:95], v[12:15]
    v_mul_f32 v199, s67, v7
    v_exp_f32 v196, v196
    ds_read_b128 v[92:95], v65 offset:640
    s_waitcnt vmcnt(0) lgkmcnt(5)
    v_mfma_f32_16x16x32_bf16 v[12:15], v[172:175], v[76:79], v[12:15]
    v_exp_f32 v197, v197
    v_exp_f32 v198, v198
    ds_read_b128 v[76:79], v64 offset:1280
    s_waitcnt lgkmcnt(5)
    v_mfma_f32_16x16x32_bf16 v[24:27], v[120:123], v[80:83], v[24:27]
    v_exp_f32 v199, v199
    v_add_f32 v196, 1.0, v196
    ds_read_b128 v[80:83], v65 offset:1280
    s_waitcnt lgkmcnt(4)
    v_mfma_f32_16x16x32_bf16 v[24:27], v[124:127], v[84:87], v[24:27]
    v_mul_f32 v12, v12, v192
    v_mul_f32 v13, v13, v193
    ds_read_b128 v[84:87], v64 offset:384
    s_waitcnt lgkmcnt(4)
    v_mfma_f32_16x16x32_bf16 v[24:27], v[152:155], v[88:91], v[24:27]
    v_mul_f32 v14, v14, v194
    v_mul_f32 v15, v15, v195
    ds_read_b128 v[88:91], v65 offset:384
    s_waitcnt lgkmcnt(4)
    v_mfma_f32_16x16x32_bf16 v[24:27], v[156:159], v[92:95], v[24:27]
    v_cvt_pk_bf16_f32 v12, v12, v13
    v_cvt_pk_bf16_f32 v13, v14, v15
    ds_read_b128 v[92:95], v64 offset:768
    s_waitcnt lgkmcnt(4)
    v_mfma_f32_16x16x32_bf16 v[24:27], v[168:171], v[76:79], v[24:27]
    ds_write_b64 v204, v[12:13] offset:256
    v_add_f32 v197, 1.0, v197
    ds_read_b128 v[76:79], v65 offset:768
    s_waitcnt lgkmcnt(5)
    v_mfma_f32_16x16x32_bf16 v[24:27], v[172:175], v[80:83], v[24:27]
    v_add_f32 v198, 1.0, v198
    v_add_f32 v199, 1.0, v199
    ds_read_b128 v[80:83], v64 offset:896
    s_waitcnt lgkmcnt(5)
    v_mfma_f32_16x16x32_bf16 v[36:39], v[120:123], v[84:87], v[36:39]
    v_rcp_f32 v196, v196
    v_rcp_f32 v197, v197
    ds_read_b128 v[84:87], v65 offset:896
    s_waitcnt lgkmcnt(5)
    v_mfma_f32_16x16x32_bf16 v[36:39], v[124:127], v[88:91], v[36:39]
    v_rcp_f32 v198, v198
    v_rcp_f32 v199, v199
    ds_read_b128 v[88:91], v68 offset:128
    s_waitcnt lgkmcnt(5)
    v_mfma_f32_16x16x32_bf16 v[36:39], v[152:155], v[92:95], v[36:39]
    v_mul_f32 v24, v24, v192
    v_mul_f32 v25, v25, v193
    ds_read_b128 v[92:95], v69 offset:128
    s_waitcnt lgkmcnt(4)
    v_mfma_f32_16x16x32_bf16 v[36:39], v[156:159], v[76:79], v[36:39]
    v_mul_f32 v26, v26, v194
    v_mul_f32 v27, v27, v195
    ds_read_b128 v[76:79], v68 offset:512
    s_waitcnt lgkmcnt(4)
    v_mfma_f32_16x16x32_bf16 v[36:39], v[168:171], v[80:83], v[36:39]
    v_cvt_pk_bf16_f32 v24, v24, v25
    v_cvt_pk_bf16_f32 v25, v26, v27
    ds_read_b128 v[80:83], v69 offset:512
    s_waitcnt lgkmcnt(4)
    v_mfma_f32_16x16x32_bf16 v[36:39], v[172:175], v[84:87], v[36:39]
    ds_write_b64 v204, v[24:25] offset:512
    v_mul_f32 v200, s67, v8
    ds_read_b128 v[84:87], v68 offset:1152
    s_waitcnt lgkmcnt(5)
    v_mfma_f32_16x16x32_bf16 v[16:19], v[120:123], v[88:91], v[16:19]
    v_mul_f32 v201, s67, v9
    v_mul_f32 v202, s67, v10
    ds_read_b128 v[88:91], v69 offset:1152
    s_waitcnt lgkmcnt(5)
    v_mfma_f32_16x16x32_bf16 v[16:19], v[124:127], v[92:95], v[16:19]
    v_mul_f32 v203, s67, v11
    v_exp_f32 v200, v200
    ds_read_b128 v[92:95], v68 offset:256
    s_waitcnt lgkmcnt(5)
    v_mfma_f32_16x16x32_bf16 v[16:19], v[152:155], v[76:79], v[16:19]
    v_mul_f32 v36, v36, v192
    v_mul_f32 v37, v37, v193
    ds_read_b128 v[76:79], v69 offset:256
    s_waitcnt lgkmcnt(5)
    v_mfma_f32_16x16x32_bf16 v[16:19], v[156:159], v[80:83], v[16:19]
    v_mul_f32 v38, v38, v194
    v_mul_f32 v39, v39, v195
    ds_read_b128 v[80:83], v68 offset:640
    s_waitcnt lgkmcnt(4)
    v_mfma_f32_16x16x32_bf16 v[16:19], v[168:171], v[84:87], v[16:19]
    v_cvt_pk_bf16_f32 v36, v36, v37
    v_cvt_pk_bf16_f32 v37, v38, v39
    ds_read_b128 v[84:87], v69 offset:640
    s_waitcnt lgkmcnt(4)
    v_mfma_f32_16x16x32_bf16 v[16:19], v[172:175], v[88:91], v[16:19]
    ds_write_b64 v204, v[36:37] offset:768
    v_exp_f32 v201, v201
    ds_read_b128 v[88:91], v68 offset:1280
    s_waitcnt lgkmcnt(5)
    v_mfma_f32_16x16x32_bf16 v[28:31], v[120:123], v[92:95], v[28:31]
    v_exp_f32 v202, v202
    v_exp_f32 v203, v203
    ds_read_b128 v[92:95], v69 offset:1280
    s_waitcnt lgkmcnt(5)
    v_mfma_f32_16x16x32_bf16 v[28:31], v[124:127], v[76:79], v[28:31]
    v_add_f32 v200, 1.0, v200
    v_add_f32 v201, 1.0, v201
    ds_read_b128 v[76:79], v68 offset:384
    s_waitcnt lgkmcnt(5)
    v_mfma_f32_16x16x32_bf16 v[28:31], v[152:155], v[80:83], v[28:31]
    v_add_f32 v202, 1.0, v202
    v_add_f32 v203, 1.0, v203
    ds_read_b128 v[80:83], v69 offset:384
    s_waitcnt lgkmcnt(5)
    v_mfma_f32_16x16x32_bf16 v[28:31], v[156:159], v[84:87], v[28:31]
    v_rcp_f32 v200, v200
    v_rcp_f32 v201, v201
    ds_read_b128 v[84:87], v68 offset:768
    s_waitcnt lgkmcnt(4)
    v_mfma_f32_16x16x32_bf16 v[28:31], v[168:171], v[88:91], v[28:31]
    v_rcp_f32 v202, v202
    v_rcp_f32 v203, v203
    ds_read_b128 v[88:91], v69 offset:768
    s_waitcnt lgkmcnt(4)
    v_mfma_f32_16x16x32_bf16 v[28:31], v[172:175], v[92:95], v[28:31]
    v_mov_b32_dpp v200, v200 row_ror:8 row_mask:0xf bank_mask:0xc
    ds_read_b128 v[92:95], v68 offset:896
    s_waitcnt lgkmcnt(4)
    v_mfma_f32_16x16x32_bf16 v[40:43], v[120:123], v[76:79], v[40:43]
    v_mov_b32_dpp v201, v201 row_ror:8 row_mask:0xf bank_mask:0xc
    v_mov_b32_dpp v202, v202 row_ror:8 row_mask:0xf bank_mask:0xc
    ds_read_b128 v[76:79], v69 offset:896
    s_waitcnt lgkmcnt(4)
    v_mfma_f32_16x16x32_bf16 v[40:43], v[124:127], v[80:83], v[40:43]
    v_mov_b32_dpp v203, v203 row_ror:8 row_mask:0xf bank_mask:0xc
    ds_read_b128 v[80:83], v72 offset:128
    s_waitcnt lgkmcnt(4)
    v_mfma_f32_16x16x32_bf16 v[40:43], v[152:155], v[84:87], v[40:43]
    s_barrier
    ds_read_b128 v[212:215], v206 offset:0
    ds_read_b128 v[84:87], v73 offset:128
    s_waitcnt lgkmcnt(5)
    v_mfma_f32_16x16x32_bf16 v[40:43], v[156:159], v[88:91], v[40:43]
    ds_read_b128 v[216:219], v206 offset:8320
    v_cvt_pk_bf16_f32 v4, v4, v5
    ds_read_b128 v[88:91], v74 offset:128
    s_waitcnt lgkmcnt(6)
    v_mfma_f32_16x16x32_bf16 v[40:43], v[168:171], v[92:95], v[40:43]
    v_cvt_pk_bf16_f32 v5, v6, v7
    ds_write_b64 v205, v[4:5] offset:0
    ds_read_b128 v[92:95], v75 offset:128
    s_waitcnt lgkmcnt(7)
    v_mfma_f32_16x16x32_bf16 v[40:43], v[172:175], v[76:79], v[40:43]
    v_mul_f32 v16, v16, v196
    v_mul_f32 v17, v17, v197
    ds_read_b128 v[76:79], v72 offset:512
    s_waitcnt lgkmcnt(7)
    v_mfma_f32_16x16x32_bf16 v[20:23], v[120:123], v[80:83], 0
    v_mul_f32 v18, v18, v198
    v_mul_f32 v19, v19, v199
    ds_read_b128 v[80:83], v73 offset:512
    s_waitcnt lgkmcnt(6)
    v_mfma_f32_16x16x32_bf16 v[20:23], v[124:127], v[84:87], v[20:23]
    v_cvt_pk_bf16_f32 v16, v16, v17
    v_cvt_pk_bf16_f32 v17, v18, v19
    ds_read_b128 v[84:87], v74 offset:512
    s_waitcnt lgkmcnt(5)
    v_mfma_f32_16x16x32_bf16 v[20:23], v[128:131], v[88:91], v[20:23]
    ds_write_b64 v205, v[16:17] offset:256
    ds_read_b128 v[88:91], v75 offset:512
    s_waitcnt lgkmcnt(5)
    v_mfma_f32_16x16x32_bf16 v[20:23], v[132:135], v[92:95], v[20:23]
    buffer_store_dwordx4 v[212:215], v246, s[4:7], s22 offen sc1
    ds_read_b128 v[92:95], v72 offset:1152
    s_waitcnt lgkmcnt(5)
    v_mfma_f32_16x16x32_bf16 v[20:23], v[152:155], v[76:79], v[20:23]
    buffer_store_dwordx4 v[216:219], v246, s[4:7], s23 offen sc1
    v_mul_f32 v28, v28, v196
    ds_read_b128 v[76:79], v73 offset:1152
    s_waitcnt lgkmcnt(5)
    v_mfma_f32_16x16x32_bf16 v[20:23], v[156:159], v[80:83], v[20:23]
    v_mul_f32 v29, v29, v197
    v_mul_f32 v30, v30, v198
    ds_read_b128 v[80:83], v74 offset:1152
    s_waitcnt lgkmcnt(5)
    v_mfma_f32_16x16x32_bf16 v[20:23], v[136:139], v[84:87], v[20:23]
    v_mul_f32 v31, v31, v199
    v_cvt_pk_bf16_f32 v28, v28, v29
    ds_read_b128 v[84:87], v75 offset:1152
    s_waitcnt lgkmcnt(4)
    v_mfma_f32_16x16x32_bf16 v[20:23], v[140:143], v[88:91], v[20:23]
    v_cvt_pk_bf16_f32 v29, v30, v31
    ds_write_b64 v205, v[28:29] offset:512
    ds_read_b128 v[88:91], v72 offset:384
    s_waitcnt lgkmcnt(5)
    v_mfma_f32_16x16x32_bf16 v[20:23], v[168:171], v[92:95], v[20:23]
    v_mul_f32 v40, v40, v196
    v_mul_f32 v41, v41, v197
    ds_read_b128 v[92:95], v73 offset:384
    s_waitcnt lgkmcnt(5)
    v_mfma_f32_16x16x32_bf16 v[20:23], v[172:175], v[76:79], v[20:23]
    v_mul_f32 v42, v42, v198
    v_mul_f32 v43, v43, v199
    ds_read_b128 v[76:79], v74 offset:384
    s_waitcnt lgkmcnt(5)
    v_mfma_f32_16x16x32_bf16 v[20:23], v[112:115], v[80:83], v[20:23]
    v_cvt_pk_bf16_f32 v40, v40, v41
    v_cvt_pk_bf16_f32 v41, v42, v43
    ds_read_b128 v[80:83], v75 offset:384
    s_waitcnt lgkmcnt(5)
    v_mfma_f32_16x16x32_bf16 v[20:23], v[116:119], v[84:87], v[20:23]
    ds_write_b64 v205, v[40:41] offset:768
    ds_read_b128 v[84:87], v72 offset:768
    s_waitcnt lgkmcnt(5)
    v_mfma_f32_16x16x32_bf16 v[44:47], v[120:123], v[88:91], 0
    ds_read_b128 v[88:91], v73 offset:768
    s_waitcnt lgkmcnt(5)
    v_mfma_f32_16x16x32_bf16 v[44:47], v[124:127], v[92:95], v[44:47]
    s_waitcnt lgkmcnt(2)
    s_barrier
    ds_read_b128 v[92:95], v74 offset:768
    v_mfma_f32_16x16x32_bf16 v[44:47], v[128:131], v[76:79], v[44:47]
    ds_read_b128 v[212:215], v207 offset:0
    ds_read_b128 v[216:219], v207 offset:1664
    ds_read_b128 v[76:79], v75 offset:768
    v_mfma_f32_16x16x32_bf16 v[44:47], v[132:135], v[80:83], v[44:47]
    ds_read_b128 v[80:83], v72 offset:896
    s_waitcnt lgkmcnt(6)
    v_mfma_f32_16x16x32_bf16 v[44:47], v[152:155], v[84:87], v[44:47]
    ds_read_b128 v[84:87], v73 offset:896
    s_waitcnt lgkmcnt(6)
    v_mfma_f32_16x16x32_bf16 v[44:47], v[156:159], v[88:91], v[44:47]
    ds_read_b128 v[88:91], v74 offset:896
    s_waitcnt lgkmcnt(6)
    v_mfma_f32_16x16x32_bf16 v[44:47], v[136:139], v[92:95], v[44:47]
    s_waitcnt lgkmcnt(5)
    buffer_store_dwordx4 v[212:215], v246, s[4:7], s24 offen sc1
    ds_read_b128 v[92:95], v75 offset:896
    s_waitcnt lgkmcnt(4)
    v_mfma_f32_16x16x32_bf16 v[44:47], v[140:143], v[76:79], v[44:47]
    buffer_store_dwordx4 v[216:219], v246, s[4:7], s25 offen sc1
    s_waitcnt lgkmcnt(3)
    v_mfma_f32_16x16x32_bf16 v[44:47], v[168:171], v[80:83], v[44:47]
    v_cvt_pk_bf16_f32 v8, v8, v9
    v_cvt_pk_bf16_f32 v9, v10, v11
    s_waitcnt lgkmcnt(2)
    v_mfma_f32_16x16x32_bf16 v[44:47], v[172:175], v[84:87], v[44:47]
    ds_write_b64 v204, v[8:9] offset:0
    v_mul_f32 v20, v20, v200
    s_waitcnt lgkmcnt(2)
    v_mfma_f32_16x16x32_bf16 v[44:47], v[112:115], v[88:91], v[44:47]
    v_mul_f32 v21, v21, v201
    v_mul_f32 v22, v22, v202
    s_waitcnt lgkmcnt(1)
    v_mfma_f32_16x16x32_bf16 v[44:47], v[116:119], v[92:95], v[44:47]
    v_mul_f32 v23, v23, v203
    v_cvt_pk_bf16_f32 v20, v20, v21
    v_cvt_pk_bf16_f32 v21, v22, v23
    ds_write_b64 v220, v[20:21] offset:256
    s_nop 3
    v_mul_f32 v44, v44, v200
    v_mul_f32 v45, v45, v201
    v_mul_f32 v46, v46, v202
    v_mul_f32 v47, v47, v203
    v_cvt_pk_bf16_f32 v44, v44, v45
    v_cvt_pk_bf16_f32 v45, v46, v47
    ds_write_b64 v204, v[44:45] offset:768
    s_waitcnt lgkmcnt(0)
    s_barrier
    ds_read_b128 v[212:215], v206 offset:0
    s_waitcnt lgkmcnt(0)
    buffer_store_dwordx4 v[212:215], v246, s[4:7], s26 offen sc1
    s_or_b32 s89, s89, s20
    s_cbranch_scc1 K2_end
    v_mov_b32 v0, 0
    v_mov_b32 v1, s88
    s_mov_b64 exec, 1
    buffer_store_dword v1, v0, s[16:19], 0 offen
    s_endpgm
T_pw:
    s_sleep 1
    ds_read_b32 v191, v190
    s_waitcnt lgkmcnt(0)
    v_cmp_gt_u32 vcc, s53, v191
    s_cbranch_vccnz T_pw
    s_branch T_pwr
T_aw:
    s_sleep 1
    ds_read_b32 v191, v190
    s_waitcnt lgkmcnt(0)
    v_cmp_gt_u32 vcc, s50, v191
    s_cbranch_vccnz T_aw
    s_branch T_awr
K2_end:
K2_last:
    s_endpgm
SLOW:
    v_readlane_b32 s89, v4, 62
    s_waitcnt vmcnt(0) lgkmcnt(0)
    s_barrier
    s_load_dwordx2 s[22:23], s[0:1], 8
    s_load_dwordx2 s[24:25], s[0:1], 24
    s_load_dwordx2 s[26:27], s[0:1], 32
    s_load_dwordx2 s[28:29], s[0:1], 40
    s_load_dwordx2 s[30:31], s[0:1], 0
    v_mbcnt_lo_u32_b32 v240, -1, 0
    v_mbcnt_hi_u32_b32 v240, -1, v240
    v_lshrrev_b32 v229, 5, v240
    v_and_b32 v230, 31, v240
    v_lshlrev_b32 v241, 7, v229
    v_lshl_add_u32 v241, v230, 1, v241
    v_lshlrev_b32 v245, 4, v240
    v_mov_b32 v242, 0
    s_waitcnt lgkmcnt(0)
    s_mov_b32 s80, s22
    s_and_b32 s81, s23, 0xffff
    s_mov_b32 s82, 1920000
    s_mov_b32 s83, 0x20000
    s_mov_b32 s76, s24
    s_and_b32 s77, s25, 0xffff
    s_mov_b32 s78, 1280000
    s_mov_b32 s79, 0x20000
    s_mov_b32 s72, s26
    s_and_b32 s73, s27, 0xffff
    s_mov_b32 s74, 1280000
    s_mov_b32 s75, 0x20000
    s_mov_b32 s84, s28
    s_and_b32 s85, s29, 0xffff
    s_mov_b32 s86, 20480
    s_mov_b32 s87, 0x20000
    s_mov_b32 s4, s30
    s_and_b32 s5, s31, 0xffff
    s_mov_b32 s6, 10240000
    s_mov_b32 s7, 0x20000
    s_mov_b32 s66, 0
    buffer_load_ushort v0, v241, s[84:87], s66 offen offset:0
    buffer_load_ushort v1, v241, s[84:87], s66 offen offset:64
    buffer_load_ushort v2, v241, s[84:87], s66 offen offset:256
    buffer_load_ushort v3, v241, s[84:87], s66 offen offset:320
    buffer_load_ushort v4, v241, s[84:87], s66 offen offset:512
    buffer_load_ushort v5, v241, s[84:87], s66 offen offset:576
    buffer_load_ushort v6, v241, s[84:87], s66 offen offset:768
    buffer_load_ushort v7, v241, s[84:87], s66 offen offset:832
    buffer_load_ushort v8, v241, s[84:87], s66 offen offset:1024
    buffer_load_ushort v9, v241, s[84:87], s66 offen offset:1088
    s_waitcnt vmcnt(0)
    s_mov_b32 s66, 1280
    buffer_load_ushort v10, v241, s[84:87], s66 offen offset:0
    buffer_load_ushort v11, v241, s[84:87], s66 offen offset:64
    buffer_load_ushort v12, v241, s[84:87], s66 offen offset:256
    buffer_load_ushort v13, v241, s[84:87], s66 offen offset:320
    buffer_load_ushort v14, v241, s[84:87], s66 offen offset:512
    buffer_load_ushort v15, v241, s[84:87], s66 offen offset:576
    buffer_load_ushort v16, v241, s[84:87], s66 offen offset:768
    buffer_load_ushort v17, v241, s[84:87], s66 offen offset:832
    buffer_load_ushort v18, v241, s[84:87], s66 offen offset:1024
    buffer_load_ushort v19, v241, s[84:87], s66 offen offset:1088
    s_waitcnt vmcnt(0)
    s_mov_b32 s66, 2560
    buffer_load_ushort v20, v241, s[84:87], s66 offen offset:0
    buffer_load_ushort v21, v241, s[84:87], s66 offen offset:64
    buffer_load_ushort v22, v241, s[84:87], s66 offen offset:256
    buffer_load_ushort v23, v241, s[84:87], s66 offen offset:320
    buffer_load_ushort v24, v241, s[84:87], s66 offen offset:512
    buffer_load_ushort v25, v241, s[84:87], s66 offen offset:576
    buffer_load_ushort v26, v241, s[84:87], s66 offen offset:768
    buffer_load_ushort v27, v241, s[84:87], s66 offen offset:832
    buffer_load_ushort v28, v241, s[84:87], s66 offen offset:1024
    buffer_load_ushort v29, v241, s[84:87], s66 offen offset:1088
    s_waitcnt vmcnt(0)
    s_mov_b32 s66, 3840
    buffer_load_ushort v30, v241, s[84:87], s66 offen offset:0
    buffer_load_ushort v31, v241, s[84:87], s66 offen offset:64
    buffer_load_ushort v32, v241, s[84:87], s66 offen offset:256
    buffer_load_ushort v33, v241, s[84:87], s66 offen offset:320
    buffer_load_ushort v34, v241, s[84:87], s66 offen offset:512
    buffer_load_ushort v35, v241, s[84:87], s66 offen offset:576
    buffer_load_ushort v36, v241, s[84:87], s66 offen offset:768
    buffer_load_ushort v37, v241, s[84:87], s66 offen offset:832
    buffer_load_ushort v38, v241, s[84:87], s66 offen offset:1024
    buffer_load_ushort v39, v241, s[84:87], s66 offen offset:1088
    s_waitcnt vmcnt(0)
    s_mov_b32 s66, 5120
    buffer_load_ushort v40, v241, s[84:87], s66 offen offset:0
    buffer_load_ushort v41, v241, s[84:87], s66 offen offset:64
    buffer_load_ushort v42, v241, s[84:87], s66 offen offset:256
    buffer_load_ushort v43, v241, s[84:87], s66 offen offset:320
    buffer_load_ushort v44, v241, s[84:87], s66 offen offset:512
    buffer_load_ushort v45, v241, s[84:87], s66 offen offset:576
    buffer_load_ushort v46, v241, s[84:87], s66 offen offset:768
    buffer_load_ushort v47, v241, s[84:87], s66 offen offset:832
    buffer_load_ushort v48, v241, s[84:87], s66 offen offset:1024
    buffer_load_ushort v49, v241, s[84:87], s66 offen offset:1088
    s_waitcnt vmcnt(0)
    s_mov_b32 s66, 6400
    buffer_load_ushort v50, v241, s[84:87], s66 offen offset:0
    buffer_load_ushort v51, v241, s[84:87], s66 offen offset:64
    buffer_load_ushort v52, v241, s[84:87], s66 offen offset:256
    buffer_load_ushort v53, v241, s[84:87], s66 offen offset:320
    buffer_load_ushort v54, v241, s[84:87], s66 offen offset:512
    buffer_load_ushort v55, v241, s[84:87], s66 offen offset:576
    buffer_load_ushort v56, v241, s[84:87], s66 offen offset:768
    buffer_load_ushort v57, v241, s[84:87], s66 offen offset:832
    buffer_load_ushort v58, v241, s[84:87], s66 offen offset:1024
    buffer_load_ushort v59, v241, s[84:87], s66 offen offset:1088
    s_waitcnt vmcnt(0)
    s_mov_b32 s66, 7680
    buffer_load_ushort v60, v241, s[84:87], s66 offen offset:0
    buffer_load_ushort v61, v241, s[84:87], s66 offen offset:64
    buffer_load_ushort v62, v241, s[84:87], s66 offen offset:256
    buffer_load_ushort v63, v241, s[84:87], s66 offen offset:320
    buffer_load_ushort v64, v241, s[84:87], s66 offen offset:512
    buffer_load_ushort v65, v241, s[84:87], s66 offen offset:576
    buffer_load_ushort v66, v241, s[84:87], s66 offen offset:768
    buffer_load_ushort v67, v241, s[84:87], s66 offen offset:832
    buffer_load_ushort v68, v241, s[84:87], s66 offen offset:1024
    buffer_load_ushort v69, v241, s[84:87], s66 offen offset:1088
    s_waitcnt vmcnt(0)
    s_mov_b32 s66, 8960
    buffer_load_ushort v70, v241, s[84:87], s66 offen offset:0
    buffer_load_ushort v71, v241, s[84:87], s66 offen offset:64
    buffer_load_ushort v72, v241, s[84:87], s66 offen offset:256
    buffer_load_ushort v73, v241, s[84:87], s66 offen offset:320
    buffer_load_ushort v74, v241, s[84:87], s66 offen offset:512
    buffer_load_ushort v75, v241, s[84:87], s66 offen offset:576
    buffer_load_ushort v76, v241, s[84:87], s66 offen offset:768
    buffer_load_ushort v77, v241, s[84:87], s66 offen offset:832
    buffer_load_ushort v78, v241, s[84:87], s66 offen offset:1024
    buffer_load_ushort v79, v241, s[84:87], s66 offen offset:1088
    s_waitcnt vmcnt(0)
    s_mov_b32 s66, 10240
    buffer_load_ushort v80, v241, s[84:87], s66 offen offset:0
    buffer_load_ushort v81, v241, s[84:87], s66 offen offset:64
    buffer_load_ushort v82, v241, s[84:87], s66 offen offset:256
    buffer_load_ushort v83, v241, s[84:87], s66 offen offset:320
    buffer_load_ushort v84, v241, s[84:87], s66 offen offset:512
    buffer_load_ushort v85, v241, s[84:87], s66 offen offset:576
    buffer_load_ushort v86, v241, s[84:87], s66 offen offset:768
    buffer_load_ushort v87, v241, s[84:87], s66 offen offset:832
    buffer_load_ushort v88, v241, s[84:87], s66 offen offset:1024
    buffer_load_ushort v89, v241, s[84:87], s66 offen offset:1088
    s_waitcnt vmcnt(0)
    s_mov_b32 s66, 11520
    buffer_load_ushort v90, v241, s[84:87], s66 offen offset:0
    buffer_load_ushort v91, v241, s[84:87], s66 offen offset:64
    buffer_load_ushort v92, v241, s[84:87], s66 offen offset:256
    buffer_load_ushort v93, v241, s[84:87], s66 offen offset:320
    buffer_load_ushort v94, v241, s[84:87], s66 offen offset:512
    buffer_load_ushort v95, v241, s[84:87], s66 offen offset:576
    buffer_load_ushort v96, v241, s[84:87], s66 offen offset:768
    buffer_load_ushort v97, v241, s[84:87], s66 offen offset:832
    buffer_load_ushort v98, v241, s[84:87], s66 offen offset:1024
    buffer_load_ushort v99, v241, s[84:87], s66 offen offset:1088
    s_waitcnt vmcnt(0)
    s_mov_b32 s66, 12800
    buffer_load_ushort v100, v241, s[84:87], s66 offen offset:0
    buffer_load_ushort v101, v241, s[84:87], s66 offen offset:64
    buffer_load_ushort v102, v241, s[84:87], s66 offen offset:256
    buffer_load_ushort v103, v241, s[84:87], s66 offen offset:320
    buffer_load_ushort v104, v241, s[84:87], s66 offen offset:512
    buffer_load_ushort v105, v241, s[84:87], s66 offen offset:576
    buffer_load_ushort v106, v241, s[84:87], s66 offen offset:768
    buffer_load_ushort v107, v241, s[84:87], s66 offen offset:832
    buffer_load_ushort v108, v241, s[84:87], s66 offen offset:1024
    buffer_load_ushort v109, v241, s[84:87], s66 offen offset:1088
    s_waitcnt vmcnt(0)
    s_mov_b32 s66, 14080
    buffer_load_ushort v110, v241, s[84:87], s66 offen offset:0
    buffer_load_ushort v111, v241, s[84:87], s66 offen offset:64
    buffer_load_ushort v112, v241, s[84:87], s66 offen offset:256
    buffer_load_ushort v113, v241, s[84:87], s66 offen offset:320
    buffer_load_ushort v114, v241, s[84:87], s66 offen offset:512
    buffer_load_ushort v115, v241, s[84:87], s66 offen offset:576
    buffer_load_ushort v116, v241, s[84:87], s66 offen offset:768
    buffer_load_ushort v117, v241, s[84:87], s66 offen offset:832
    buffer_load_ushort v118, v241, s[84:87], s66 offen offset:1024
    buffer_load_ushort v119, v241, s[84:87], s66 offen offset:1088
    s_waitcnt vmcnt(0)
    s_mov_b32 s66, 15360
    buffer_load_ushort v120, v241, s[84:87], s66 offen offset:0
    buffer_load_ushort v121, v241, s[84:87], s66 offen offset:64
    buffer_load_ushort v122, v241, s[84:87], s66 offen offset:256
    buffer_load_ushort v123, v241, s[84:87], s66 offen offset:320
    buffer_load_ushort v124, v241, s[84:87], s66 offen offset:512
    buffer_load_ushort v125, v241, s[84:87], s66 offen offset:576
    buffer_load_ushort v126, v241, s[84:87], s66 offen offset:768
    buffer_load_ushort v127, v241, s[84:87], s66 offen offset:832
    buffer_load_ushort v128, v241, s[84:87], s66 offen offset:1024
    buffer_load_ushort v129, v241, s[84:87], s66 offen offset:1088
    s_waitcnt vmcnt(0)
    s_mov_b32 s66, 16640
    buffer_load_ushort v130, v241, s[84:87], s66 offen offset:0
    buffer_load_ushort v131, v241, s[84:87], s66 offen offset:64
    buffer_load_ushort v132, v241, s[84:87], s66 offen offset:256
    buffer_load_ushort v133, v241, s[84:87], s66 offen offset:320
    buffer_load_ushort v134, v241, s[84:87], s66 offen offset:512
    buffer_load_ushort v135, v241, s[84:87], s66 offen offset:576
    buffer_load_ushort v136, v241, s[84:87], s66 offen offset:768
    buffer_load_ushort v137, v241, s[84:87], s66 offen offset:832
    buffer_load_ushort v138, v241, s[84:87], s66 offen offset:1024
    buffer_load_ushort v139, v241, s[84:87], s66 offen offset:1088
    s_waitcnt vmcnt(0)
    s_mov_b32 s66, 17920
    buffer_load_ushort v140, v241, s[84:87], s66 offen offset:0
    buffer_load_ushort v141, v241, s[84:87], s66 offen offset:64
    buffer_load_ushort v142, v241, s[84:87], s66 offen offset:256
    buffer_load_ushort v143, v241, s[84:87], s66 offen offset:320
    buffer_load_ushort v144, v241, s[84:87], s66 offen offset:512
    buffer_load_ushort v145, v241, s[84:87], s66 offen offset:576
    buffer_load_ushort v146, v241, s[84:87], s66 offen offset:768
    buffer_load_ushort v147, v241, s[84:87], s66 offen offset:832
    buffer_load_ushort v148, v241, s[84:87], s66 offen offset:1024
    buffer_load_ushort v149, v241, s[84:87], s66 offen offset:1088
    s_waitcnt vmcnt(0)
    s_mov_b32 s66, 19200
    buffer_load_ushort v150, v241, s[84:87], s66 offen offset:0
    buffer_load_ushort v151, v241, s[84:87], s66 offen offset:64
    buffer_load_ushort v152, v241, s[84:87], s66 offen offset:256
    buffer_load_ushort v153, v241, s[84:87], s66 offen offset:320
    buffer_load_ushort v154, v241, s[84:87], s66 offen offset:512
    buffer_load_ushort v155, v241, s[84:87], s66 offen offset:576
    buffer_load_ushort v156, v241, s[84:87], s66 offen offset:768
    buffer_load_ushort v157, v241, s[84:87], s66 offen offset:832
    buffer_load_ushort v158, v241, s[84:87], s66 offen offset:1024
    buffer_load_ushort v159, v241, s[84:87], s66 offen offset:1088
    s_waitcnt vmcnt(0)
    v_lshlrev_b32 v0, 16, v0
    v_lshlrev_b32 v1, 16, v1
    v_lshlrev_b32 v2, 16, v2
    v_lshlrev_b32 v3, 16, v3
    v_lshlrev_b32 v4, 16, v4
    v_lshlrev_b32 v5, 16, v5
    v_lshlrev_b32 v6, 16, v6
    v_lshlrev_b32 v7, 16, v7
    v_lshlrev_b32 v8, 16, v8
    v_lshlrev_b32 v9, 16, v9
    v_lshlrev_b32 v10, 16, v10
    v_lshlrev_b32 v11, 16, v11
    v_lshlrev_b32 v12, 16, v12
    v_lshlrev_b32 v13, 16, v13
    v_lshlrev_b32 v14, 16, v14
    v_lshlrev_b32 v15, 16, v15
    v_lshlrev_b32 v16, 16, v16
    v_lshlrev_b32 v17, 16, v17
    v_lshlrev_b32 v18, 16, v18
    v_lshlrev_b32 v19, 16, v19
    v_lshlrev_b32 v20, 16, v20
    v_lshlrev_b32 v21, 16, v21
    v_lshlrev_b32 v22, 16, v22
    v_lshlrev_b32 v23, 16, v23
    v_lshlrev_b32 v24, 16, v24
    v_lshlrev_b32 v25, 16, v25
    v_lshlrev_b32 v26, 16, v26
    v_lshlrev_b32 v27, 16, v27
    v_lshlrev_b32 v28, 16, v28
    v_lshlrev_b32 v29, 16, v29
    v_lshlrev_b32 v30, 16, v30
    v_lshlrev_b32 v31, 16, v31
    v_lshlrev_b32 v32, 16, v32
    v_lshlrev_b32 v33, 16, v33
    v_lshlrev_b32 v34, 16, v34
    v_lshlrev_b32 v35, 16, v35
    v_lshlrev_b32 v36, 16, v36
    v_lshlrev_b32 v37, 16, v37
    v_lshlrev_b32 v38, 16, v38
    v_lshlrev_b32 v39, 16, v39
    v_lshlrev_b32 v40, 16, v40
    v_lshlrev_b32 v41, 16, v41
    v_lshlrev_b32 v42, 16, v42
    v_lshlrev_b32 v43, 16, v43
    v_lshlrev_b32 v44, 16, v44
    v_lshlrev_b32 v45, 16, v45
    v_lshlrev_b32 v46, 16, v46
    v_lshlrev_b32 v47, 16, v47
    v_lshlrev_b32 v48, 16, v48
    v_lshlrev_b32 v49, 16, v49
    v_lshlrev_b32 v50, 16, v50
    v_lshlrev_b32 v51, 16, v51
    v_lshlrev_b32 v52, 16, v52
    v_lshlrev_b32 v53, 16, v53
    v_lshlrev_b32 v54, 16, v54
    v_lshlrev_b32 v55, 16, v55
    v_lshlrev_b32 v56, 16, v56
    v_lshlrev_b32 v57, 16, v57
    v_lshlrev_b32 v58, 16, v58
    v_lshlrev_b32 v59, 16, v59
    v_lshlrev_b32 v60, 16, v60
    v_lshlrev_b32 v61, 16, v61
    v_lshlrev_b32 v62, 16, v62
    v_lshlrev_b32 v63, 16, v63
    v_lshlrev_b32 v64, 16, v64
    v_lshlrev_b32 v65, 16, v65
    v_lshlrev_b32 v66, 16, v66
    v_lshlrev_b32 v67, 16, v67
    v_lshlrev_b32 v68, 16, v68
    v_lshlrev_b32 v69, 16, v69
    v_lshlrev_b32 v70, 16, v70
    v_lshlrev_b32 v71, 16, v71
    v_lshlrev_b32 v72, 16, v72
    v_lshlrev_b32 v73, 16, v73
    v_lshlrev_b32 v74, 16, v74
    v_lshlrev_b32 v75, 16, v75
    v_lshlrev_b32 v76, 16, v76
    v_lshlrev_b32 v77, 16, v77
    v_lshlrev_b32 v78, 16, v78
    v_lshlrev_b32 v79, 16, v79
    v_lshlrev_b32 v80, 16, v80
    v_lshlrev_b32 v81, 16, v81
    v_lshlrev_b32 v82, 16, v82
    v_lshlrev_b32 v83, 16, v83
    v_lshlrev_b32 v84, 16, v84
    v_lshlrev_b32 v85, 16, v85
    v_lshlrev_b32 v86, 16, v86
    v_lshlrev_b32 v87, 16, v87
    v_lshlrev_b32 v88, 16, v88
    v_lshlrev_b32 v89, 16, v89
    v_lshlrev_b32 v90, 16, v90
    v_lshlrev_b32 v91, 16, v91
    v_lshlrev_b32 v92, 16, v92
    v_lshlrev_b32 v93, 16, v93
    v_lshlrev_b32 v94, 16, v94
    v_lshlrev_b32 v95, 16, v95
    v_lshlrev_b32 v96, 16, v96
    v_lshlrev_b32 v97, 16, v97
    v_lshlrev_b32 v98, 16, v98
    v_lshlrev_b32 v99, 16, v99
    v_lshlrev_b32 v100, 16, v100
    v_lshlrev_b32 v101, 16, v101
    v_lshlrev_b32 v102, 16, v102
    v_lshlrev_b32 v103, 16, v103
    v_lshlrev_b32 v104, 16, v104
    v_lshlrev_b32 v105, 16, v105
    v_lshlrev_b32 v106, 16, v106
    v_lshlrev_b32 v107, 16, v107
    v_lshlrev_b32 v108, 16, v108
    v_lshlrev_b32 v109, 16, v109
    v_lshlrev_b32 v110, 16, v110
    v_lshlrev_b32 v111, 16, v111
    v_lshlrev_b32 v112, 16, v112
    v_lshlrev_b32 v113, 16, v113
    v_lshlrev_b32 v114, 16, v114
    v_lshlrev_b32 v115, 16, v115
    v_lshlrev_b32 v116, 16, v116
    v_lshlrev_b32 v117, 16, v117
    v_lshlrev_b32 v118, 16, v118
    v_lshlrev_b32 v119, 16, v119
    v_lshlrev_b32 v120, 16, v120
    v_lshlrev_b32 v121, 16, v121
    v_lshlrev_b32 v122, 16, v122
    v_lshlrev_b32 v123, 16, v123
    v_lshlrev_b32 v124, 16, v124
    v_lshlrev_b32 v125, 16, v125
    v_lshlrev_b32 v126, 16, v126
    v_lshlrev_b32 v127, 16, v127
    v_lshlrev_b32 v128, 16, v128
    v_lshlrev_b32 v129, 16, v129
    v_lshlrev_b32 v130, 16, v130
    v_lshlrev_b32 v131, 16, v131
    v_lshlrev_b32 v132, 16, v132
    v_lshlrev_b32 v133, 16, v133
    v_lshlrev_b32 v134, 16, v134
    v_lshlrev_b32 v135, 16, v135
    v_lshlrev_b32 v136, 16, v136
    v_lshlrev_b32 v137, 16, v137
    v_lshlrev_b32 v138, 16, v138
    v_lshlrev_b32 v139, 16, v139
    v_lshlrev_b32 v140, 16, v140
    v_lshlrev_b32 v141, 16, v141
    v_lshlrev_b32 v142, 16, v142
    v_lshlrev_b32 v143, 16, v143
    v_lshlrev_b32 v144, 16, v144
    v_lshlrev_b32 v145, 16, v145
    v_lshlrev_b32 v146, 16, v146
    v_lshlrev_b32 v147, 16, v147
    v_lshlrev_b32 v148, 16, v148
    v_lshlrev_b32 v149, 16, v149
    v_lshlrev_b32 v150, 16, v150
    v_lshlrev_b32 v151, 16, v151
    v_lshlrev_b32 v152, 16, v152
    v_lshlrev_b32 v153, 16, v153
    v_lshlrev_b32 v154, 16, v154
    v_lshlrev_b32 v155, 16, v155
    v_lshlrev_b32 v156, 16, v156
    v_lshlrev_b32 v157, 16, v157
    v_lshlrev_b32 v158, 16, v158
    v_lshlrev_b32 v159, 16, v159
    s_mov_b32 s50, 0
SL_node:
    s_mul_i32 s34, s2, 40
    s_lshl_b32 s66, s50, 3
    s_add_u32 s66, s66, s20
    s_add_u32 s34, s34, s66
    v_mov_b32 v160, 0
    v_mov_b32 v161, 0
    v_mov_b32 v162, 0
    v_mov_b32 v163, 0
    v_mov_b32 v164, 0
    v_mov_b32 v165, 0
    v_mov_b32 v166, 0
    v_mov_b32 v167, 0
    v_mov_b32 v168, 0
    v_mov_b32 v169, 0
    v_mov_b32 v170, 0
    v_mov_b32 v171, 0
    v_mov_b32 v172, 0
    v_mov_b32 v173, 0
    v_mov_b32 v174, 0
    v_mov_b32 v175, 0
    v_mov_b32 v176, 0
    v_mov_b32 v177, 0
    v_mov_b32 v178, 0
    v_mov_b32 v179, 0
    v_mov_b32 v180, 0
    v_mov_b32 v181, 0
    s_mov_b32 s35, 0
SL_scan:
    s_lshl_b32 s66, s35, 2
    buffer_load_dwordx4 v[236:239], v245, s[72:75], s66 offen
    s_waitcnt vmcnt(0)
    v_cmp_eq_u32 s[38:39], s34, v236
    v_cmp_eq_u32 s[40:41], s34, v237
    v_cmp_eq_u32 s[42:43], s34, v238
    v_cmp_eq_u32 s[44:45], s34, v239
    s_mov_b32 s36, 0
SL_bits:
    s_cmp_eq_u64 s[38:39], 0
    s_cbranch_scc1 SL_nexti
    s_ff1_i32_b64 s66, s[38:39]
    s_bitset0_b64 s[38:39], s66
    s_lshl_b32 s66, s66, 2
    s_add_u32 s37, s66, s36
    s_add_u32 s37, s37, s35
    s_lshl_b32 s66, s37, 2
    s_lshl_b32 s67, s37, 5
    s_mul_i32 s68, s37, 6
    buffer_load_dword v243, v242, s[76:79], s66 offen
    buffer_load_dwordx4 v[184:187], v242, s[12:15], s67 offen
    buffer_load_dwordx4 v[188:191], v242, s[12:15], s67 offen offset:16
    buffer_load_ushort v226, v242, s[80:83], s68 offen offset:0
    buffer_load_ushort v227, v242, s[80:83], s68 offen offset:2
    buffer_load_ushort v228, v242, s[80:83], s68 offen offset:4
    s_waitcnt vmcnt(5)
    v_lshl_add_u32 v243, v243, 10, v241
    buffer_load_ushort v208, v243, s[4:7], 0 offen offset:0
    buffer_load_ushort v209, v243, s[4:7], 0 offen offset:64
    buffer_load_ushort v210, v243, s[4:7], 0 offen offset:256
    buffer_load_ushort v211, v243, s[4:7], 0 offen offset:320
    buffer_load_ushort v212, v243, s[4:7], 0 offen offset:512
    buffer_load_ushort v213, v243, s[4:7], 0 offen offset:576
    buffer_load_ushort v214, v243, s[4:7], 0 offen offset:768
    buffer_load_ushort v215, v243, s[4:7], 0 offen offset:832
    s_waitcnt vmcnt(8)
    v_lshlrev_b32 v192, 16, v184
    v_and_b32 v193, 0xffff0000, v184
    v_lshlrev_b32 v194, 16, v185
    v_and_b32 v195, 0xffff0000, v185
    v_lshlrev_b32 v196, 16, v186
    v_and_b32 v197, 0xffff0000, v186
    v_lshlrev_b32 v198, 16, v187
    v_and_b32 v199, 0xffff0000, v187
    v_lshlrev_b32 v200, 16, v188
    v_and_b32 v201, 0xffff0000, v188
    v_lshlrev_b32 v202, 16, v189
    v_and_b32 v203, 0xffff0000, v189
    v_lshlrev_b32 v204, 16, v190
    v_and_b32 v205, 0xffff0000, v190
    v_lshlrev_b32 v206, 16, v191
    v_and_b32 v207, 0xffff0000, v191
    v_lshlrev_b32 v226, 16, v226
    v_lshlrev_b32 v227, 16, v227
    v_lshlrev_b32 v228, 16, v228
    v_mul_f32 v216, v192, v0
    v_mul_f32 v217, v192, v1
    v_mul_f32 v218, v192, v2
    v_mul_f32 v219, v192, v3
    v_mul_f32 v220, v192, v4
    v_mul_f32 v221, v192, v5
    v_mul_f32 v222, v192, v6
    v_mul_f32 v223, v192, v7
    v_mul_f32 v224, v192, v8
    v_mul_f32 v225, v192, v9
    v_fmac_f32 v216, v193, v10
    v_fmac_f32 v217, v193, v11
    v_fmac_f32 v218, v193, v12
    v_fmac_f32 v219, v193, v13
    v_fmac_f32 v220, v193, v14
    v_fmac_f32 v221, v193, v15
    v_fmac_f32 v222, v193, v16
    v_fmac_f32 v223, v193, v17
    v_fmac_f32 v224, v193, v18
    v_fmac_f32 v225, v193, v19
    v_fmac_f32 v216, v194, v20
    v_fmac_f32 v217, v194, v21
    v_fmac_f32 v218, v194, v22
    v_fmac_f32 v219, v194, v23
    v_fmac_f32 v220, v194, v24
    v_fmac_f32 v221, v194, v25
    v_fmac_f32 v222, v194, v26
    v_fmac_f32 v223, v194, v27
    v_fmac_f32 v224, v194, v28
    v_fmac_f32 v225, v194, v29
    v_fmac_f32 v216, v195, v30
    v_fmac_f32 v217, v195, v31
    v_fmac_f32 v218, v195, v32
    v_fmac_f32 v219, v195, v33
    v_fmac_f32 v220, v195, v34
    v_fmac_f32 v221, v195, v35
    v_fmac_f32 v222, v195, v36
    v_fmac_f32 v223, v195, v37
    v_fmac_f32 v224, v195, v38
    v_fmac_f32 v225, v195, v39
    v_fmac_f32 v216, v196, v40
    v_fmac_f32 v217, v196, v41
    v_fmac_f32 v218, v196, v42
    v_fmac_f32 v219, v196, v43
    v_fmac_f32 v220, v196, v44
    v_fmac_f32 v221, v196, v45
    v_fmac_f32 v222, v196, v46
    v_fmac_f32 v223, v196, v47
    v_fmac_f32 v224, v196, v48
    v_fmac_f32 v225, v196, v49
    v_fmac_f32 v216, v197, v50
    v_fmac_f32 v217, v197, v51
    v_fmac_f32 v218, v197, v52
    v_fmac_f32 v219, v197, v53
    v_fmac_f32 v220, v197, v54
    v_fmac_f32 v221, v197, v55
    v_fmac_f32 v222, v197, v56
    v_fmac_f32 v223, v197, v57
    v_fmac_f32 v224, v197, v58
    v_fmac_f32 v225, v197, v59
    v_fmac_f32 v216, v198, v60
    v_fmac_f32 v217, v198, v61
    v_fmac_f32 v218, v198, v62
    v_fmac_f32 v219, v198, v63
    v_fmac_f32 v220, v198, v64
    v_fmac_f32 v221, v198, v65
    v_fmac_f32 v222, v198, v66
    v_fmac_f32 v223, v198, v67
    v_fmac_f32 v224, v198, v68
    v_fmac_f32 v225, v198, v69
    v_fmac_f32 v216, v199, v70
    v_fmac_f32 v217, v199, v71
    v_fmac_f32 v218, v199, v72
    v_fmac_f32 v219, v199, v73
    v_fmac_f32 v220, v199, v74
    v_fmac_f32 v221, v199, v75
    v_fmac_f32 v222, v199, v76
    v_fmac_f32 v223, v199, v77
    v_fmac_f32 v224, v199, v78
    v_fmac_f32 v225, v199, v79
    v_fmac_f32 v216, v200, v80
    v_fmac_f32 v217, v200, v81
    v_fmac_f32 v218, v200, v82
    v_fmac_f32 v219, v200, v83
    v_fmac_f32 v220, v200, v84
    v_fmac_f32 v221, v200, v85
    v_fmac_f32 v222, v200, v86
    v_fmac_f32 v223, v200, v87
    v_fmac_f32 v224, v200, v88
    v_fmac_f32 v225, v200, v89
    v_fmac_f32 v216, v201, v90
    v_fmac_f32 v217, v201, v91
    v_fmac_f32 v218, v201, v92
    v_fmac_f32 v219, v201, v93
    v_fmac_f32 v220, v201, v94
    v_fmac_f32 v221, v201, v95
    v_fmac_f32 v222, v201, v96
    v_fmac_f32 v223, v201, v97
    v_fmac_f32 v224, v201, v98
    v_fmac_f32 v225, v201, v99
    v_fmac_f32 v216, v202, v100
    v_fmac_f32 v217, v202, v101
    v_fmac_f32 v218, v202, v102
    v_fmac_f32 v219, v202, v103
    v_fmac_f32 v220, v202, v104
    v_fmac_f32 v221, v202, v105
    v_fmac_f32 v222, v202, v106
    v_fmac_f32 v223, v202, v107
    v_fmac_f32 v224, v202, v108
    v_fmac_f32 v225, v202, v109
    v_fmac_f32 v216, v203, v110
    v_fmac_f32 v217, v203, v111
    v_fmac_f32 v218, v203, v112
    v_fmac_f32 v219, v203, v113
    v_fmac_f32 v220, v203, v114
    v_fmac_f32 v221, v203, v115
    v_fmac_f32 v222, v203, v116
    v_fmac_f32 v223, v203, v117
    v_fmac_f32 v224, v203, v118
    v_fmac_f32 v225, v203, v119
    v_fmac_f32 v216, v204, v120
    v_fmac_f32 v217, v204, v121
    v_fmac_f32 v218, v204, v122
    v_fmac_f32 v219, v204, v123
    v_fmac_f32 v220, v204, v124
    v_fmac_f32 v221, v204, v125
    v_fmac_f32 v222, v204, v126
    v_fmac_f32 v223, v204, v127
    v_fmac_f32 v224, v204, v128
    v_fmac_f32 v225, v204, v129
    v_fmac_f32 v216, v205, v130
    v_fmac_f32 v217, v205, v131
    v_fmac_f32 v218, v205, v132
    v_fmac_f32 v219, v205, v133
    v_fmac_f32 v220, v205, v134
    v_fmac_f32 v221, v205, v135
    v_fmac_f32 v222, v205, v136
    v_fmac_f32 v223, v205, v137
    v_fmac_f32 v224, v205, v138
    v_fmac_f32 v225, v205, v139
    v_fmac_f32 v216, v206, v140
    v_fmac_f32 v217, v206, v141
    v_fmac_f32 v218, v206, v142
    v_fmac_f32 v219, v206, v143
    v_fmac_f32 v220, v206, v144
    v_fmac_f32 v221, v206, v145
    v_fmac_f32 v222, v206, v146
    v_fmac_f32 v223, v206, v147
    v_fmac_f32 v224, v206, v148
    v_fmac_f32 v225, v206, v149
    v_fmac_f32 v216, v207, v150
    v_fmac_f32 v217, v207, v151
    v_fmac_f32 v218, v207, v152
    v_fmac_f32 v219, v207, v153
    v_fmac_f32 v220, v207, v154
    v_fmac_f32 v221, v207, v155
    v_fmac_f32 v222, v207, v156
    v_fmac_f32 v223, v207, v157
    v_fmac_f32 v224, v207, v158
    v_fmac_f32 v225, v207, v159
    s_waitcnt vmcnt(0)
    v_lshlrev_b32 v208, 16, v208
    v_lshlrev_b32 v209, 16, v209
    v_lshlrev_b32 v210, 16, v210
    v_lshlrev_b32 v211, 16, v211
    v_lshlrev_b32 v212, 16, v212
    v_lshlrev_b32 v213, 16, v213
    v_lshlrev_b32 v214, 16, v214
    v_lshlrev_b32 v215, 16, v215
    v_fmac_f32 v160, v208, v216
    v_mul_f32 v229, v210, v226
    v_fmac_f32 v229, v212, v227
    v_fmac_f32 v229, v214, v228
    v_fmac_f32 v176, v229, v218
    v_mul_f32 v229, v208, v220
    v_fmac_f32 v162, v229, v226
    v_fmac_f32 v168, v210, v222
    v_mul_f32 v230, v227, v214
    v_fma_f32 v230, -v228, v212, v230
    v_fmac_f32 v178, v230, v224
    v_fmac_f32 v164, v229, v227
    v_fmac_f32 v170, v212, v222
    v_mul_f32 v230, v228, v210
    v_fma_f32 v230, -v226, v214, v230
    v_fmac_f32 v180, v230, v224
    v_fmac_f32 v166, v229, v228
    v_fmac_f32 v172, v214, v222
    v_mul_f32 v230, v226, v212
    v_fma_f32 v230, -v227, v210, v230
    v_fmac_f32 v174, v230, v224
    v_fmac_f32 v161, v209, v217
    v_mul_f32 v229, v211, v226
    v_fmac_f32 v229, v213, v227
    v_fmac_f32 v229, v215, v228
    v_fmac_f32 v177, v229, v219
    v_mul_f32 v229, v209, v221
    v_fmac_f32 v163, v229, v226
    v_fmac_f32 v169, v211, v223
    v_mul_f32 v230, v227, v215
    v_fma_f32 v230, -v228, v213, v230
    v_fmac_f32 v179, v230, v225
    v_fmac_f32 v165, v229, v227
    v_fmac_f32 v171, v213, v223
    v_mul_f32 v230, v228, v211
    v_fma_f32 v230, -v226, v215, v230
    v_fmac_f32 v181, v230, v225
    v_fmac_f32 v167, v229, v228
    v_fmac_f32 v173, v215, v223
    v_mul_f32 v230, v226, v213
    v_fma_f32 v230, -v227, v211, v230
    v_fmac_f32 v175, v230, v225
    s_branch SL_bits
SL_nexti:
    s_mov_b64 s[38:39], s[40:41]
    s_mov_b64 s[40:41], s[42:43]
    s_mov_b64 s[42:43], s[44:45]
    s_add_u32 s36, s36, 1
    s_cmp_lt_u32 s36, 4
    s_cbranch_scc1 SL_bits
    s_add_u32 s35, s35, 256
    s_cmp_lt_u32 s35, 320000
    s_cbranch_scc1 SL_scan
    s_lshl_b32 s66, s50, 3
    s_add_u32 s66, s66, s20
    s_lshl_b32 s67, s66, 4
    s_and_b32 s68, s67, 128
    s_and_b32 s67, s67, 0x70
    s_mul_i32 s69, s50, 1536
    s_add_u32 s69, s69, s21
    s_add_u32 s69, s69, s68
    s_mul_i32 s70, s66, 1536
    s_add_u32 s70, s70, 86016
    s_add_u32 s70, s70, s68
    v_mov_b32 v230, s69
    v_mov_b32 v231, s70
    v_cmp_gt_u32 vcc, 32, v240
    v_and_b32 v229, 31, v240
    v_lshlrev_b32 v229, 2, v229
    v_xor_b32 v229, s67, v229
    v_cndmask_b32 v244, v231, v230, vcc
    v_add_u32 v244, v244, v229
    v_cvt_pk_bf16_f32 v160, v160, v161
    ds_write_b32 v244, v160 offset:0
    v_cvt_pk_bf16_f32 v162, v162, v163
    ds_write_b32 v244, v162 offset:128
    v_cvt_pk_bf16_f32 v164, v164, v165
    ds_write_b32 v244, v164 offset:256
    v_cvt_pk_bf16_f32 v166, v166, v167
    ds_write_b32 v244, v166 offset:384
    v_cvt_pk_bf16_f32 v168, v168, v169
    ds_write_b32 v244, v168 offset:512
    v_cvt_pk_bf16_f32 v170, v170, v171
    ds_write_b32 v244, v170 offset:640
    v_cvt_pk_bf16_f32 v172, v172, v173
    ds_write_b32 v244, v172 offset:768
    v_cvt_pk_bf16_f32 v174, v174, v175
    ds_write_b32 v244, v174 offset:896
    v_cvt_pk_bf16_f32 v176, v176, v177
    ds_write_b32 v244, v176 offset:1024
    v_cvt_pk_bf16_f32 v178, v178, v179
    ds_write_b32 v244, v178 offset:1152
    v_cvt_pk_bf16_f32 v180, v180, v181
    ds_write_b32 v244, v180 offset:1280
    s_lshl_b32 s66, s66, 3
    s_add_u32 s66, s66, 163328
    v_mov_b32 v229, s66
    ds_write_b64 v229, v[230:231]
    s_add_u32 s50, s50, 1
    s_cmp_lt_u32 s50, 5
    s_cbranch_scc1 SL_node
    s_waitcnt lgkmcnt(0)
    s_barrier
    v_mov_b32 v176, v240
    s_load_dwordx4 s[84:87], s[0:1], 48
    s_mul_i32 s22, s20, 20
    s_waitcnt lgkmcnt(0)
    s_mul_i32 s24, s22, 3277
    s_lshr_b32 s24, s24, 16
    s_mul_i32 s68, s24, 20
    s_sub_u32 s68, s22, s68
    s_cmp_lt_u32 s68, 8
    s_cselect_b64 s[66:67], s[84:85], s[86:87]
    s_cselect_b32 s25, 0, 8
    s_sub_u32 s68, s68, s25
    s_and_b32 s25, s68, 1
    s_lshr_b32 s68, s68, 1
    s_lshl_b32 s68, s68, 14
    s_lshl_b32 s25, s25, 12
    s_add_u32 s68, s68, s25
    s_lshl_b32 s24, s24, 5
    s_add_u32 s68, s68, s24
    v_lshrrev_b32 v2, 4, v176
    v_lshlrev_b32 v2, 10, v2
    v_and_b32 v3, 15, v176
    v_lshl_add_u32 v2, v3, 1, v2
    v_add_u32 v2, s68, v2
    v_add_u32 v3, 8192, v2
    v_mov_b32 v4, 0
    v_mov_b32 v5, 0
    v_mov_b32 v6, 0
    v_mov_b32 v7, 0
    global_load_ushort v144, v2, s[66:67] offset:0
    global_load_short_d16_hi v4, v3, s[66:67] offset:0
    global_load_ushort v145, v2, s[66:67] offset:256
    global_load_short_d16_hi v5, v3, s[66:67] offset:256
    global_load_ushort v146, v2, s[66:67] offset:512
    global_load_short_d16_hi v6, v3, s[66:67] offset:512
    global_load_ushort v147, v2, s[66:67] offset:768
    global_load_short_d16_hi v7, v3, s[66:67] offset:768
    s_add_u32 s22, s22, 1
    s_waitcnt vmcnt(0)
    v_or_b32 v144, v144, v4
    v_or_b32 v145, v145, v5
    v_or_b32 v146, v146, v6
    v_or_b32 v147, v147, v7
    s_mul_i32 s24, s22, 3277
    s_lshr_b32 s24, s24, 16
    s_mul_i32 s68, s24, 20
    s_sub_u32 s68, s22, s68
    s_cmp_lt_u32 s68, 8
    s_cselect_b64 s[66:67], s[84:85], s[86:87]
    s_cselect_b32 s25, 0, 8
    s_sub_u32 s68, s68, s25
    s_and_b32 s25, s68, 1
    s_lshr_b32 s68, s68, 1
    s_lshl_b32 s68, s68, 14
    s_lshl_b32 s25, s25, 12
    s_add_u32 s68, s68, s25
    s_lshl_b32 s24, s24, 5
    s_add_u32 s68, s68, s24
    v_lshrrev_b32 v2, 4, v176
    v_lshlrev_b32 v2, 10, v2
    v_and_b32 v3, 15, v176
    v_lshl_add_u32 v2, v3, 1, v2
    v_add_u32 v2, s68, v2
    v_add_u32 v3, 8192, v2
    v_mov_b32 v4, 0
    v_mov_b32 v5, 0
    v_mov_b32 v6, 0
    v_mov_b32 v7, 0
    global_load_ushort v148, v2, s[66:67] offset:0
    global_load_short_d16_hi v4, v3, s[66:67] offset:0
    global_load_ushort v149, v2, s[66:67] offset:256
    global_load_short_d16_hi v5, v3, s[66:67] offset:256
    global_load_ushort v150, v2, s[66:67] offset:512
    global_load_short_d16_hi v6, v3, s[66:67] offset:512
    global_load_ushort v151, v2, s[66:67] offset:768
    global_load_short_d16_hi v7, v3, s[66:67] offset:768
    s_add_u32 s22, s22, 1
    s_waitcnt vmcnt(0)
    v_or_b32 v148, v148, v4
    v_or_b32 v149, v149, v5
    v_or_b32 v150, v150, v6
    v_or_b32 v151, v151, v7
    s_mul_i32 s24, s22, 3277
    s_lshr_b32 s24, s24, 16
    s_mul_i32 s68, s24, 20
    s_sub_u32 s68, s22, s68
    s_cmp_lt_u32 s68, 8
    s_cselect_b64 s[66:67], s[84:85], s[86:87]
    s_cselect_b32 s25, 0, 8
    s_sub_u32 s68, s68, s25
    s_and_b32 s25, s68, 1
    s_lshr_b32 s68, s68, 1
    s_lshl_b32 s68, s68, 14
    s_lshl_b32 s25, s25, 12
    s_add_u32 s68, s68, s25
    s_lshl_b32 s24, s24, 5
    s_add_u32 s68, s68, s24
    v_lshrrev_b32 v2, 4, v176
    v_lshlrev_b32 v2, 10, v2
    v_and_b32 v3, 15, v176
    v_lshl_add_u32 v2, v3, 1, v2
    v_add_u32 v2, s68, v2
    v_add_u32 v3, 8192, v2
    v_mov_b32 v4, 0
    v_mov_b32 v5, 0
    v_mov_b32 v6, 0
    v_mov_b32 v7, 0
    global_load_ushort v96, v2, s[66:67] offset:0
    global_load_short_d16_hi v4, v3, s[66:67] offset:0
    global_load_ushort v97, v2, s[66:67] offset:256
    global_load_short_d16_hi v5, v3, s[66:67] offset:256
    global_load_ushort v98, v2, s[66:67] offset:512
    global_load_short_d16_hi v6, v3, s[66:67] offset:512
    global_load_ushort v99, v2, s[66:67] offset:768
    global_load_short_d16_hi v7, v3, s[66:67] offset:768
    s_add_u32 s22, s22, 1
    s_waitcnt vmcnt(0)
    v_or_b32 v96, v96, v4
    v_or_b32 v97, v97, v5
    v_or_b32 v98, v98, v6
    v_or_b32 v99, v99, v7
    s_mul_i32 s24, s22, 3277
    s_lshr_b32 s24, s24, 16
    s_mul_i32 s68, s24, 20
    s_sub_u32 s68, s22, s68
    s_cmp_lt_u32 s68, 8
    s_cselect_b64 s[66:67], s[84:85], s[86:87]
    s_cselect_b32 s25, 0, 8
    s_sub_u32 s68, s68, s25
    s_and_b32 s25, s68, 1
    s_lshr_b32 s68, s68, 1
    s_lshl_b32 s68, s68, 14
    s_lshl_b32 s25, s25, 12
    s_add_u32 s68, s68, s25
    s_lshl_b32 s24, s24, 5
    s_add_u32 s68, s68, s24
    v_lshrrev_b32 v2, 4, v176
    v_lshlrev_b32 v2, 10, v2
    v_and_b32 v3, 15, v176
    v_lshl_add_u32 v2, v3, 1, v2
    v_add_u32 v2, s68, v2
    v_add_u32 v3, 8192, v2
    v_mov_b32 v4, 0
    v_mov_b32 v5, 0
    v_mov_b32 v6, 0
    v_mov_b32 v7, 0
    global_load_ushort v100, v2, s[66:67] offset:0
    global_load_short_d16_hi v4, v3, s[66:67] offset:0
    global_load_ushort v101, v2, s[66:67] offset:256
    global_load_short_d16_hi v5, v3, s[66:67] offset:256
    global_load_ushort v102, v2, s[66:67] offset:512
    global_load_short_d16_hi v6, v3, s[66:67] offset:512
    global_load_ushort v103, v2, s[66:67] offset:768
    global_load_short_d16_hi v7, v3, s[66:67] offset:768
    s_add_u32 s22, s22, 1
    s_waitcnt vmcnt(0)
    v_or_b32 v100, v100, v4
    v_or_b32 v101, v101, v5
    v_or_b32 v102, v102, v6
    v_or_b32 v103, v103, v7
    s_mul_i32 s24, s22, 3277
    s_lshr_b32 s24, s24, 16
    s_mul_i32 s68, s24, 20
    s_sub_u32 s68, s22, s68
    s_cmp_lt_u32 s68, 8
    s_cselect_b64 s[66:67], s[84:85], s[86:87]
    s_cselect_b32 s25, 0, 8
    s_sub_u32 s68, s68, s25
    s_and_b32 s25, s68, 1
    s_lshr_b32 s68, s68, 1
    s_lshl_b32 s68, s68, 14
    s_lshl_b32 s25, s25, 12
    s_add_u32 s68, s68, s25
    s_lshl_b32 s24, s24, 5
    s_add_u32 s68, s68, s24
    v_lshrrev_b32 v2, 4, v176
    v_lshlrev_b32 v2, 10, v2
    v_and_b32 v3, 15, v176
    v_lshl_add_u32 v2, v3, 1, v2
    v_add_u32 v2, s68, v2
    v_add_u32 v3, 8192, v2
    v_mov_b32 v4, 0
    v_mov_b32 v5, 0
    v_mov_b32 v6, 0
    v_mov_b32 v7, 0
    global_load_ushort v160, v2, s[66:67] offset:0
    global_load_short_d16_hi v4, v3, s[66:67] offset:0
    global_load_ushort v161, v2, s[66:67] offset:256
    global_load_short_d16_hi v5, v3, s[66:67] offset:256
    global_load_ushort v162, v2, s[66:67] offset:512
    global_load_short_d16_hi v6, v3, s[66:67] offset:512
    global_load_ushort v163, v2, s[66:67] offset:768
    global_load_short_d16_hi v7, v3, s[66:67] offset:768
    s_add_u32 s22, s22, 1
    s_waitcnt vmcnt(0)
    v_or_b32 v160, v160, v4
    v_or_b32 v161, v161, v5
    v_or_b32 v162, v162, v6
    v_or_b32 v163, v163, v7
    s_mul_i32 s24, s22, 3277
    s_lshr_b32 s24, s24, 16
    s_mul_i32 s68, s24, 20
    s_sub_u32 s68, s22, s68
    s_cmp_lt_u32 s68, 8
    s_cselect_b64 s[66:67], s[84:85], s[86:87]
    s_cselect_b32 s25, 0, 8
    s_sub_u32 s68, s68, s25
    s_and_b32 s25, s68, 1
    s_lshr_b32 s68, s68, 1
    s_lshl_b32 s68, s68, 14
    s_lshl_b32 s25, s25, 12
    s_add_u32 s68, s68, s25
    s_lshl_b32 s24, s24, 5
    s_add_u32 s68, s68, s24
    v_lshrrev_b32 v2, 4, v176
    v_lshlrev_b32 v2, 10, v2
    v_and_b32 v3, 15, v176
    v_lshl_add_u32 v2, v3, 1, v2
    v_add_u32 v2, s68, v2
    v_add_u32 v3, 8192, v2
    v_mov_b32 v4, 0
    v_mov_b32 v5, 0
    v_mov_b32 v6, 0
    v_mov_b32 v7, 0
    global_load_ushort v164, v2, s[66:67] offset:0
    global_load_short_d16_hi v4, v3, s[66:67] offset:0
    global_load_ushort v165, v2, s[66:67] offset:256
    global_load_short_d16_hi v5, v3, s[66:67] offset:256
    global_load_ushort v166, v2, s[66:67] offset:512
    global_load_short_d16_hi v6, v3, s[66:67] offset:512
    global_load_ushort v167, v2, s[66:67] offset:768
    global_load_short_d16_hi v7, v3, s[66:67] offset:768
    s_add_u32 s22, s22, 1
    s_waitcnt vmcnt(0)
    v_or_b32 v164, v164, v4
    v_or_b32 v165, v165, v5
    v_or_b32 v166, v166, v6
    v_or_b32 v167, v167, v7
    s_mul_i32 s24, s22, 3277
    s_lshr_b32 s24, s24, 16
    s_mul_i32 s68, s24, 20
    s_sub_u32 s68, s22, s68
    s_cmp_lt_u32 s68, 8
    s_cselect_b64 s[66:67], s[84:85], s[86:87]
    s_cselect_b32 s25, 0, 8
    s_sub_u32 s68, s68, s25
    s_and_b32 s25, s68, 1
    s_lshr_b32 s68, s68, 1
    s_lshl_b32 s68, s68, 14
    s_lshl_b32 s25, s25, 12
    s_add_u32 s68, s68, s25
    s_lshl_b32 s24, s24, 5
    s_add_u32 s68, s68, s24
    v_lshrrev_b32 v2, 4, v176
    v_lshlrev_b32 v2, 10, v2
    v_and_b32 v3, 15, v176
    v_lshl_add_u32 v2, v3, 1, v2
    v_add_u32 v2, s68, v2
    v_add_u32 v3, 8192, v2
    v_mov_b32 v4, 0
    v_mov_b32 v5, 0
    v_mov_b32 v6, 0
    v_mov_b32 v7, 0
    global_load_ushort v104, v2, s[66:67] offset:0
    global_load_short_d16_hi v4, v3, s[66:67] offset:0
    global_load_ushort v105, v2, s[66:67] offset:256
    global_load_short_d16_hi v5, v3, s[66:67] offset:256
    global_load_ushort v106, v2, s[66:67] offset:512
    global_load_short_d16_hi v6, v3, s[66:67] offset:512
    global_load_ushort v107, v2, s[66:67] offset:768
    global_load_short_d16_hi v7, v3, s[66:67] offset:768
    s_add_u32 s22, s22, 1
    s_waitcnt vmcnt(0)
    v_or_b32 v104, v104, v4
    v_or_b32 v105, v105, v5
    v_or_b32 v106, v106, v6
    v_or_b32 v107, v107, v7
    s_mul_i32 s24, s22, 3277
    s_lshr_b32 s24, s24, 16
    s_mul_i32 s68, s24, 20
    s_sub_u32 s68, s22, s68
    s_cmp_lt_u32 s68, 8
    s_cselect_b64 s[66:67], s[84:85], s[86:87]
    s_cselect_b32 s25, 0, 8
    s_sub_u32 s68, s68, s25
    s_and_b32 s25, s68, 1
    s_lshr_b32 s68, s68, 1
    s_lshl_b32 s68, s68, 14
    s_lshl_b32 s25, s25, 12
    s_add_u32 s68, s68, s25
    s_lshl_b32 s24, s24, 5
    s_add_u32 s68, s68, s24
    v_lshrrev_b32 v2, 4, v176
    v_lshlrev_b32 v2, 10, v2
    v_and_b32 v3, 15, v176
    v_lshl_add_u32 v2, v3, 1, v2
    v_add_u32 v2, s68, v2
    v_add_u32 v3, 8192, v2
    v_mov_b32 v4, 0
    v_mov_b32 v5, 0
    v_mov_b32 v6, 0
    v_mov_b32 v7, 0
    global_load_ushort v108, v2, s[66:67] offset:0
    global_load_short_d16_hi v4, v3, s[66:67] offset:0
    global_load_ushort v109, v2, s[66:67] offset:256
    global_load_short_d16_hi v5, v3, s[66:67] offset:256
    global_load_ushort v110, v2, s[66:67] offset:512
    global_load_short_d16_hi v6, v3, s[66:67] offset:512
    global_load_ushort v111, v2, s[66:67] offset:768
    global_load_short_d16_hi v7, v3, s[66:67] offset:768
    s_add_u32 s22, s22, 1
    s_waitcnt vmcnt(0)
    v_or_b32 v108, v108, v4
    v_or_b32 v109, v109, v5
    v_or_b32 v110, v110, v6
    v_or_b32 v111, v111, v7
    s_mul_i32 s24, s22, 3277
    s_lshr_b32 s24, s24, 16
    s_mul_i32 s68, s24, 20
    s_sub_u32 s68, s22, s68
    s_cmp_lt_u32 s68, 8
    s_cselect_b64 s[66:67], s[84:85], s[86:87]
    s_cselect_b32 s25, 0, 8
    s_sub_u32 s68, s68, s25
    s_and_b32 s25, s68, 1
    s_lshr_b32 s68, s68, 1
    s_lshl_b32 s68, s68, 14
    s_lshl_b32 s25, s25, 12
    s_add_u32 s68, s68, s25
    s_lshl_b32 s24, s24, 5
    s_add_u32 s68, s68, s24
    v_lshrrev_b32 v2, 4, v176
    v_lshlrev_b32 v2, 10, v2
    v_and_b32 v3, 15, v176
    v_lshl_add_u32 v2, v3, 1, v2
    v_add_u32 v2, s68, v2
    v_add_u32 v3, 8192, v2
    v_mov_b32 v4, 0
    v_mov_b32 v5, 0
    v_mov_b32 v6, 0
    v_mov_b32 v7, 0
    global_load_ushort v120, v2, s[66:67] offset:0
    global_load_short_d16_hi v4, v3, s[66:67] offset:0
    global_load_ushort v121, v2, s[66:67] offset:256
    global_load_short_d16_hi v5, v3, s[66:67] offset:256
    global_load_ushort v122, v2, s[66:67] offset:512
    global_load_short_d16_hi v6, v3, s[66:67] offset:512
    global_load_ushort v123, v2, s[66:67] offset:768
    global_load_short_d16_hi v7, v3, s[66:67] offset:768
    s_add_u32 s22, s22, 1
    s_waitcnt vmcnt(0)
    v_or_b32 v120, v120, v4
    v_or_b32 v121, v121, v5
    v_or_b32 v122, v122, v6
    v_or_b32 v123, v123, v7
    s_mul_i32 s24, s22, 3277
    s_lshr_b32 s24, s24, 16
    s_mul_i32 s68, s24, 20
    s_sub_u32 s68, s22, s68
    s_cmp_lt_u32 s68, 8
    s_cselect_b64 s[66:67], s[84:85], s[86:87]
    s_cselect_b32 s25, 0, 8
    s_sub_u32 s68, s68, s25
    s_and_b32 s25, s68, 1
    s_lshr_b32 s68, s68, 1
    s_lshl_b32 s68, s68, 14
    s_lshl_b32 s25, s25, 12
    s_add_u32 s68, s68, s25
    s_lshl_b32 s24, s24, 5
    s_add_u32 s68, s68, s24
    v_lshrrev_b32 v2, 4, v176
    v_lshlrev_b32 v2, 10, v2
    v_and_b32 v3, 15, v176
    v_lshl_add_u32 v2, v3, 1, v2
    v_add_u32 v2, s68, v2
    v_add_u32 v3, 8192, v2
    v_mov_b32 v4, 0
    v_mov_b32 v5, 0
    v_mov_b32 v6, 0
    v_mov_b32 v7, 0
    global_load_ushort v124, v2, s[66:67] offset:0
    global_load_short_d16_hi v4, v3, s[66:67] offset:0
    global_load_ushort v125, v2, s[66:67] offset:256
    global_load_short_d16_hi v5, v3, s[66:67] offset:256
    global_load_ushort v126, v2, s[66:67] offset:512
    global_load_short_d16_hi v6, v3, s[66:67] offset:512
    global_load_ushort v127, v2, s[66:67] offset:768
    global_load_short_d16_hi v7, v3, s[66:67] offset:768
    s_add_u32 s22, s22, 1
    s_waitcnt vmcnt(0)
    v_or_b32 v124, v124, v4
    v_or_b32 v125, v125, v5
    v_or_b32 v126, v126, v6
    v_or_b32 v127, v127, v7
    s_mul_i32 s24, s22, 3277
    s_lshr_b32 s24, s24, 16
    s_mul_i32 s68, s24, 20
    s_sub_u32 s68, s22, s68
    s_cmp_lt_u32 s68, 8
    s_cselect_b64 s[66:67], s[84:85], s[86:87]
    s_cselect_b32 s25, 0, 8
    s_sub_u32 s68, s68, s25
    s_and_b32 s25, s68, 1
    s_lshr_b32 s68, s68, 1
    s_lshl_b32 s68, s68, 14
    s_lshl_b32 s25, s25, 12
    s_add_u32 s68, s68, s25
    s_lshl_b32 s24, s24, 5
    s_add_u32 s68, s68, s24
    v_lshrrev_b32 v2, 4, v176
    v_lshlrev_b32 v2, 10, v2
    v_and_b32 v3, 15, v176
    v_lshl_add_u32 v2, v3, 1, v2
    v_add_u32 v2, s68, v2
    v_add_u32 v3, 8192, v2
    v_mov_b32 v4, 0
    v_mov_b32 v5, 0
    v_mov_b32 v6, 0
    v_mov_b32 v7, 0
    global_load_ushort v128, v2, s[66:67] offset:0
    global_load_short_d16_hi v4, v3, s[66:67] offset:0
    global_load_ushort v129, v2, s[66:67] offset:256
    global_load_short_d16_hi v5, v3, s[66:67] offset:256
    global_load_ushort v130, v2, s[66:67] offset:512
    global_load_short_d16_hi v6, v3, s[66:67] offset:512
    global_load_ushort v131, v2, s[66:67] offset:768
    global_load_short_d16_hi v7, v3, s[66:67] offset:768
    s_add_u32 s22, s22, 1
    s_waitcnt vmcnt(0)
    v_or_b32 v128, v128, v4
    v_or_b32 v129, v129, v5
    v_or_b32 v130, v130, v6
    v_or_b32 v131, v131, v7
    s_mul_i32 s24, s22, 3277
    s_lshr_b32 s24, s24, 16
    s_mul_i32 s68, s24, 20
    s_sub_u32 s68, s22, s68
    s_cmp_lt_u32 s68, 8
    s_cselect_b64 s[66:67], s[84:85], s[86:87]
    s_cselect_b32 s25, 0, 8
    s_sub_u32 s68, s68, s25
    s_and_b32 s25, s68, 1
    s_lshr_b32 s68, s68, 1
    s_lshl_b32 s68, s68, 14
    s_lshl_b32 s25, s25, 12
    s_add_u32 s68, s68, s25
    s_lshl_b32 s24, s24, 5
    s_add_u32 s68, s68, s24
    v_lshrrev_b32 v2, 4, v176
    v_lshlrev_b32 v2, 10, v2
    v_and_b32 v3, 15, v176
    v_lshl_add_u32 v2, v3, 1, v2
    v_add_u32 v2, s68, v2
    v_add_u32 v3, 8192, v2
    v_mov_b32 v4, 0
    v_mov_b32 v5, 0
    v_mov_b32 v6, 0
    v_mov_b32 v7, 0
    global_load_ushort v132, v2, s[66:67] offset:0
    global_load_short_d16_hi v4, v3, s[66:67] offset:0
    global_load_ushort v133, v2, s[66:67] offset:256
    global_load_short_d16_hi v5, v3, s[66:67] offset:256
    global_load_ushort v134, v2, s[66:67] offset:512
    global_load_short_d16_hi v6, v3, s[66:67] offset:512
    global_load_ushort v135, v2, s[66:67] offset:768
    global_load_short_d16_hi v7, v3, s[66:67] offset:768
    s_add_u32 s22, s22, 1
    s_waitcnt vmcnt(0)
    v_or_b32 v132, v132, v4
    v_or_b32 v133, v133, v5
    v_or_b32 v134, v134, v6
    v_or_b32 v135, v135, v7
    s_mul_i32 s24, s22, 3277
    s_lshr_b32 s24, s24, 16
    s_mul_i32 s68, s24, 20
    s_sub_u32 s68, s22, s68
    s_cmp_lt_u32 s68, 8
    s_cselect_b64 s[66:67], s[84:85], s[86:87]
    s_cselect_b32 s25, 0, 8
    s_sub_u32 s68, s68, s25
    s_and_b32 s25, s68, 1
    s_lshr_b32 s68, s68, 1
    s_lshl_b32 s68, s68, 14
    s_lshl_b32 s25, s25, 12
    s_add_u32 s68, s68, s25
    s_lshl_b32 s24, s24, 5
    s_add_u32 s68, s68, s24
    v_lshrrev_b32 v2, 4, v176
    v_lshlrev_b32 v2, 10, v2
    v_and_b32 v3, 15, v176
    v_lshl_add_u32 v2, v3, 1, v2
    v_add_u32 v2, s68, v2
    v_add_u32 v3, 8192, v2
    v_mov_b32 v4, 0
    v_mov_b32 v5, 0
    v_mov_b32 v6, 0
    v_mov_b32 v7, 0
    global_load_ushort v152, v2, s[66:67] offset:0
    global_load_short_d16_hi v4, v3, s[66:67] offset:0
    global_load_ushort v153, v2, s[66:67] offset:256
    global_load_short_d16_hi v5, v3, s[66:67] offset:256
    global_load_ushort v154, v2, s[66:67] offset:512
    global_load_short_d16_hi v6, v3, s[66:67] offset:512
    global_load_ushort v155, v2, s[66:67] offset:768
    global_load_short_d16_hi v7, v3, s[66:67] offset:768
    s_add_u32 s22, s22, 1
    s_waitcnt vmcnt(0)
    v_or_b32 v152, v152, v4
    v_or_b32 v153, v153, v5
    v_or_b32 v154, v154, v6
    v_or_b32 v155, v155, v7
    s_mul_i32 s24, s22, 3277
    s_lshr_b32 s24, s24, 16
    s_mul_i32 s68, s24, 20
    s_sub_u32 s68, s22, s68
    s_cmp_lt_u32 s68, 8
    s_cselect_b64 s[66:67], s[84:85], s[86:87]
    s_cselect_b32 s25, 0, 8
    s_sub_u32 s68, s68, s25
    s_and_b32 s25, s68, 1
    s_lshr_b32 s68, s68, 1
    s_lshl_b32 s68, s68, 14
    s_lshl_b32 s25, s25, 12
    s_add_u32 s68, s68, s25
    s_lshl_b32 s24, s24, 5
    s_add_u32 s68, s68, s24
    v_lshrrev_b32 v2, 4, v176
    v_lshlrev_b32 v2, 10, v2
    v_and_b32 v3, 15, v176
    v_lshl_add_u32 v2, v3, 1, v2
    v_add_u32 v2, s68, v2
    v_add_u32 v3, 8192, v2
    v_mov_b32 v4, 0
    v_mov_b32 v5, 0
    v_mov_b32 v6, 0
    v_mov_b32 v7, 0
    global_load_ushort v156, v2, s[66:67] offset:0
    global_load_short_d16_hi v4, v3, s[66:67] offset:0
    global_load_ushort v157, v2, s[66:67] offset:256
    global_load_short_d16_hi v5, v3, s[66:67] offset:256
    global_load_ushort v158, v2, s[66:67] offset:512
    global_load_short_d16_hi v6, v3, s[66:67] offset:512
    global_load_ushort v159, v2, s[66:67] offset:768
    global_load_short_d16_hi v7, v3, s[66:67] offset:768
    s_add_u32 s22, s22, 1
    s_waitcnt vmcnt(0)
    v_or_b32 v156, v156, v4
    v_or_b32 v157, v157, v5
    v_or_b32 v158, v158, v6
    v_or_b32 v159, v159, v7
    s_mul_i32 s24, s22, 3277
    s_lshr_b32 s24, s24, 16
    s_mul_i32 s68, s24, 20
    s_sub_u32 s68, s22, s68
    s_cmp_lt_u32 s68, 8
    s_cselect_b64 s[66:67], s[84:85], s[86:87]
    s_cselect_b32 s25, 0, 8
    s_sub_u32 s68, s68, s25
    s_and_b32 s25, s68, 1
    s_lshr_b32 s68, s68, 1
    s_lshl_b32 s68, s68, 14
    s_lshl_b32 s25, s25, 12
    s_add_u32 s68, s68, s25
    s_lshl_b32 s24, s24, 5
    s_add_u32 s68, s68, s24
    v_lshrrev_b32 v2, 4, v176
    v_lshlrev_b32 v2, 10, v2
    v_and_b32 v3, 15, v176
    v_lshl_add_u32 v2, v3, 1, v2
    v_add_u32 v2, s68, v2
    v_add_u32 v3, 8192, v2
    v_mov_b32 v4, 0
    v_mov_b32 v5, 0
    v_mov_b32 v6, 0
    v_mov_b32 v7, 0
    global_load_ushort v136, v2, s[66:67] offset:0
    global_load_short_d16_hi v4, v3, s[66:67] offset:0
    global_load_ushort v137, v2, s[66:67] offset:256
    global_load_short_d16_hi v5, v3, s[66:67] offset:256
    global_load_ushort v138, v2, s[66:67] offset:512
    global_load_short_d16_hi v6, v3, s[66:67] offset:512
    global_load_ushort v139, v2, s[66:67] offset:768
    global_load_short_d16_hi v7, v3, s[66:67] offset:768
    s_add_u32 s22, s22, 1
    s_waitcnt vmcnt(0)
    v_or_b32 v136, v136, v4
    v_or_b32 v137, v137, v5
    v_or_b32 v138, v138, v6
    v_or_b32 v139, v139, v7
    s_mul_i32 s24, s22, 3277
    s_lshr_b32 s24, s24, 16
    s_mul_i32 s68, s24, 20
    s_sub_u32 s68, s22, s68
    s_cmp_lt_u32 s68, 8
    s_cselect_b64 s[66:67], s[84:85], s[86:87]
    s_cselect_b32 s25, 0, 8
    s_sub_u32 s68, s68, s25
    s_and_b32 s25, s68, 1
    s_lshr_b32 s68, s68, 1
    s_lshl_b32 s68, s68, 14
    s_lshl_b32 s25, s25, 12
    s_add_u32 s68, s68, s25
    s_lshl_b32 s24, s24, 5
    s_add_u32 s68, s68, s24
    v_lshrrev_b32 v2, 4, v176
    v_lshlrev_b32 v2, 10, v2
    v_and_b32 v3, 15, v176
    v_lshl_add_u32 v2, v3, 1, v2
    v_add_u32 v2, s68, v2
    v_add_u32 v3, 8192, v2
    v_mov_b32 v4, 0
    v_mov_b32 v5, 0
    v_mov_b32 v6, 0
    v_mov_b32 v7, 0
    global_load_ushort v140, v2, s[66:67] offset:0
    global_load_short_d16_hi v4, v3, s[66:67] offset:0
    global_load_ushort v141, v2, s[66:67] offset:256
    global_load_short_d16_hi v5, v3, s[66:67] offset:256
    global_load_ushort v142, v2, s[66:67] offset:512
    global_load_short_d16_hi v6, v3, s[66:67] offset:512
    global_load_ushort v143, v2, s[66:67] offset:768
    global_load_short_d16_hi v7, v3, s[66:67] offset:768
    s_add_u32 s22, s22, 1
    s_waitcnt vmcnt(0)
    v_or_b32 v140, v140, v4
    v_or_b32 v141, v141, v5
    v_or_b32 v142, v142, v6
    v_or_b32 v143, v143, v7
    s_mul_i32 s24, s22, 3277
    s_lshr_b32 s24, s24, 16
    s_mul_i32 s68, s24, 20
    s_sub_u32 s68, s22, s68
    s_cmp_lt_u32 s68, 8
    s_cselect_b64 s[66:67], s[84:85], s[86:87]
    s_cselect_b32 s25, 0, 8
    s_sub_u32 s68, s68, s25
    s_and_b32 s25, s68, 1
    s_lshr_b32 s68, s68, 1
    s_lshl_b32 s68, s68, 14
    s_lshl_b32 s25, s25, 12
    s_add_u32 s68, s68, s25
    s_lshl_b32 s24, s24, 5
    s_add_u32 s68, s68, s24
    v_lshrrev_b32 v2, 4, v176
    v_lshlrev_b32 v2, 10, v2
    v_and_b32 v3, 15, v176
    v_lshl_add_u32 v2, v3, 1, v2
    v_add_u32 v2, s68, v2
    v_add_u32 v3, 8192, v2
    v_mov_b32 v4, 0
    v_mov_b32 v5, 0
    v_mov_b32 v6, 0
    v_mov_b32 v7, 0
    global_load_ushort v168, v2, s[66:67] offset:0
    global_load_short_d16_hi v4, v3, s[66:67] offset:0
    global_load_ushort v169, v2, s[66:67] offset:256
    global_load_short_d16_hi v5, v3, s[66:67] offset:256
    global_load_ushort v170, v2, s[66:67] offset:512
    global_load_short_d16_hi v6, v3, s[66:67] offset:512
    global_load_ushort v171, v2, s[66:67] offset:768
    global_load_short_d16_hi v7, v3, s[66:67] offset:768
    s_add_u32 s22, s22, 1
    s_waitcnt vmcnt(0)
    v_or_b32 v168, v168, v4
    v_or_b32 v169, v169, v5
    v_or_b32 v170, v170, v6
    v_or_b32 v171, v171, v7
    s_mul_i32 s24, s22, 3277
    s_lshr_b32 s24, s24, 16
    s_mul_i32 s68, s24, 20
    s_sub_u32 s68, s22, s68
    s_cmp_lt_u32 s68, 8
    s_cselect_b64 s[66:67], s[84:85], s[86:87]
    s_cselect_b32 s25, 0, 8
    s_sub_u32 s68, s68, s25
    s_and_b32 s25, s68, 1
    s_lshr_b32 s68, s68, 1
    s_lshl_b32 s68, s68, 14
    s_lshl_b32 s25, s25, 12
    s_add_u32 s68, s68, s25
    s_lshl_b32 s24, s24, 5
    s_add_u32 s68, s68, s24
    v_lshrrev_b32 v2, 4, v176
    v_lshlrev_b32 v2, 10, v2
    v_and_b32 v3, 15, v176
    v_lshl_add_u32 v2, v3, 1, v2
    v_add_u32 v2, s68, v2
    v_add_u32 v3, 8192, v2
    v_mov_b32 v4, 0
    v_mov_b32 v5, 0
    v_mov_b32 v6, 0
    v_mov_b32 v7, 0
    global_load_ushort v172, v2, s[66:67] offset:0
    global_load_short_d16_hi v4, v3, s[66:67] offset:0
    global_load_ushort v173, v2, s[66:67] offset:256
    global_load_short_d16_hi v5, v3, s[66:67] offset:256
    global_load_ushort v174, v2, s[66:67] offset:512
    global_load_short_d16_hi v6, v3, s[66:67] offset:512
    global_load_ushort v175, v2, s[66:67] offset:768
    global_load_short_d16_hi v7, v3, s[66:67] offset:768
    s_add_u32 s22, s22, 1
    s_waitcnt vmcnt(0)
    v_or_b32 v172, v172, v4
    v_or_b32 v173, v173, v5
    v_or_b32 v174, v174, v6
    v_or_b32 v175, v175, v7
    s_mul_i32 s24, s22, 3277
    s_lshr_b32 s24, s24, 16
    s_mul_i32 s68, s24, 20
    s_sub_u32 s68, s22, s68
    s_cmp_lt_u32 s68, 8
    s_cselect_b64 s[66:67], s[84:85], s[86:87]
    s_cselect_b32 s25, 0, 8
    s_sub_u32 s68, s68, s25
    s_and_b32 s25, s68, 1
    s_lshr_b32 s68, s68, 1
    s_lshl_b32 s68, s68, 14
    s_lshl_b32 s25, s25, 12
    s_add_u32 s68, s68, s25
    s_lshl_b32 s24, s24, 5
    s_add_u32 s68, s68, s24
    v_lshrrev_b32 v2, 4, v176
    v_lshlrev_b32 v2, 10, v2
    v_and_b32 v3, 15, v176
    v_lshl_add_u32 v2, v3, 1, v2
    v_add_u32 v2, s68, v2
    v_add_u32 v3, 8192, v2
    v_mov_b32 v4, 0
    v_mov_b32 v5, 0
    v_mov_b32 v6, 0
    v_mov_b32 v7, 0
    global_load_ushort v112, v2, s[66:67] offset:0
    global_load_short_d16_hi v4, v3, s[66:67] offset:0
    global_load_ushort v113, v2, s[66:67] offset:256
    global_load_short_d16_hi v5, v3, s[66:67] offset:256
    global_load_ushort v114, v2, s[66:67] offset:512
    global_load_short_d16_hi v6, v3, s[66:67] offset:512
    global_load_ushort v115, v2, s[66:67] offset:768
    global_load_short_d16_hi v7, v3, s[66:67] offset:768
    s_add_u32 s22, s22, 1
    s_waitcnt vmcnt(0)
    v_or_b32 v112, v112, v4
    v_or_b32 v113, v113, v5
    v_or_b32 v114, v114, v6
    v_or_b32 v115, v115, v7
    s_mul_i32 s24, s22, 3277
    s_lshr_b32 s24, s24, 16
    s_mul_i32 s68, s24, 20
    s_sub_u32 s68, s22, s68
    s_cmp_lt_u32 s68, 8
    s_cselect_b64 s[66:67], s[84:85], s[86:87]
    s_cselect_b32 s25, 0, 8
    s_sub_u32 s68, s68, s25
    s_and_b32 s25, s68, 1
    s_lshr_b32 s68, s68, 1
    s_lshl_b32 s68, s68, 14
    s_lshl_b32 s25, s25, 12
    s_add_u32 s68, s68, s25
    s_lshl_b32 s24, s24, 5
    s_add_u32 s68, s68, s24
    v_lshrrev_b32 v2, 4, v176
    v_lshlrev_b32 v2, 10, v2
    v_and_b32 v3, 15, v176
    v_lshl_add_u32 v2, v3, 1, v2
    v_add_u32 v2, s68, v2
    v_add_u32 v3, 8192, v2
    v_mov_b32 v4, 0
    v_mov_b32 v5, 0
    v_mov_b32 v6, 0
    v_mov_b32 v7, 0
    global_load_ushort v116, v2, s[66:67] offset:0
    global_load_short_d16_hi v4, v3, s[66:67] offset:0
    global_load_ushort v117, v2, s[66:67] offset:256
    global_load_short_d16_hi v5, v3, s[66:67] offset:256
    global_load_ushort v118, v2, s[66:67] offset:512
    global_load_short_d16_hi v6, v3, s[66:67] offset:512
    global_load_ushort v119, v2, s[66:67] offset:768
    global_load_short_d16_hi v7, v3, s[66:67] offset:768
    s_add_u32 s22, s22, 1
    s_waitcnt vmcnt(0)
    v_or_b32 v116, v116, v4
    v_or_b32 v117, v117, v5
    v_or_b32 v118, v118, v6
    v_or_b32 v119, v119, v7
    s_load_dwordx2 s[72:73], s[0:1], 72
    v_lshlrev_b32 v246, 4, v176
    s_mov_b32 s52, 163072
    v_bfe_u32 v177, v246, 4, 4
    v_bfe_u32 v179, v246, 4, 3
    v_lshl_add_u32 v180, v177, 3, s52
    v_lshl_add_u32 v190, v177, 4, s52
    v_lshl_add_u32 v181, v179, 3, s52
    ds_read2_b64 v[182:185], v180 offset0:32 offset1:48
    ds_read_b32 v191, v190
    ds_read_b64 v[186:187], v181 offset:512
    v_lshrrev_b32 v178, 8, v246
    s_add_u32 s22, s20, 0
    s_mul_i32 s28, s22, 1536
    s_add_u32 s28, s28, 86016
    s_lshl_b32 s22, s22, 21
    s_add_u32 s23, s20, 8
    s_mul_i32 s29, s23, 1536
    s_add_u32 s29, s29, 86144
    s_lshl_b32 s23, s23, 21
    s_add_u32 s24, s20, 16
    s_mul_i32 s30, s24, 1536
    s_add_u32 s30, s30, 86016
    s_lshl_b32 s24, s24, 21
    s_add_u32 s25, s20, 24
    s_lshl_b32 s25, s25, 21
    s_add_u32 s26, s20, 32
    s_lshl_b32 s26, s26, 21
    s_mov_b32 s53, 0
    s_mov_b32 s50, 0
    s_waitcnt lgkmcnt(0)
    s_branch GEMM
.section .rodata,"a"
.p2align 6
.amdhsa_kernel standalone__tensor_product_equiv_equiformer__graph_kernel
  .amdhsa_next_free_vgpr 256
  .amdhsa_next_free_sgpr 90
  .amdhsa_accum_offset 256
  .amdhsa_group_segment_fixed_size 0
  .amdhsa_kernarg_size 96
  .amdhsa_user_sgpr_count 2
  .amdhsa_user_sgpr_kernarg_segment_ptr 1
  .amdhsa_system_sgpr_workgroup_id_x 1
.end_amdhsa_kernel
```

```asm
; @launch grid=(250,1,1) block=(512,1,1) lds=163840
.amdgcn_target "amdgcn-amd-amdhsa--gfx950"
.text
.globl standalone__tensor_product_equiv_equiformer__graph_kernel
.p2align 8
.type standalone__tensor_product_equiv_equiformer__graph_kernel,@function
standalone__tensor_product_equiv_equiformer__graph_kernel:
    s_cmp_ge_u32 s2, 250
    s_cbranch_scc1 K2_end
    s_load_dwordx16 s[72:87], s[0:1], 0
    s_load_dwordx2 s[70:71], s[0:1], 88
    v_lshrrev_b32 v2, 6, v0
    v_and_b32 v1, 63, v0
    v_readfirstlane_b32 s20, v2
    s_getpc_b64 s[66:67]
    v_lshlrev_b32 v95, 7, v1
    s_cmp_eq_u32 s20, 6
    s_cbranch_scc0 F_nopf0
    global_load_dword v95, v95, s[66:67]
F_nopf0:
    s_mul_i32 s66, s2, 5120
    s_mul_i32 s67, s2, 7680
    v_lshl_add_u32 v3, v0, 4, s66
    v_mul_u32_u24 v4, 24, v0
    v_add_u32 v4, s67, v4
    v_lshlrev_b32 v5, 2, v0
    v_mov_b32 v89, 0
    v_add_u32 v6, 98304, v5
    ds_write_b32 v6, v89
    s_cmp_ge_u32 s20, 5
    s_waitcnt lgkmcnt(0)
    s_cbranch_scc1 F_noload
    global_load_dwordx4 v[8:11], v3, s[80:81] nt
    global_load_dwordx4 v[12:15], v3, s[78:79] nt
    global_load_dwordx4 v[16:19], v4, s[74:75] nt
    global_load_dwordx2 v[20:21], v4, s[74:75] offset:16 nt
F_noload:
    s_load_dword s88, s[70:71], 0
    s_barrier
    v_lshlrev_b32 v248, 2, v1
    v_add_u32 v88, 162816, v248
    ds_write_b32 v88, v89
    ds_write_b32 v88, v89 offset:256
    v_lshlrev_b32 v86, 4, v1
    s_lshl_b32 s21, s20, 13
    s_lshl_b32 s66, s20, 10
    s_add_u32 s66, s66, 0
    v_add_u32 v96, s66, v86
    v_lshrrev_b32 v6, 8, v96
    v_mul_u32_u24 v6, 205, v6
    v_bfe_u32 v7, v6, 12, 1
    v_bfe_u32 v6, v6, 10, 1
    v_lshl_or_b32 v6, v7, 1, v6
    v_lshlrev_b32 v6, 6, v6
    v_xor_b32 v96, v96, v6
    s_lshl_b32 s66, s20, 10
    s_add_u32 s66, s66, 8192
    v_add_u32 v97, s66, v86
    v_lshrrev_b32 v6, 8, v97
    v_mul_u32_u24 v6, 205, v6
    v_bfe_u32 v7, v6, 12, 1
    v_bfe_u32 v6, v6, 10, 1
    v_lshl_or_b32 v6, v7, 1, v6
    v_lshlrev_b32 v6, 6, v6
    v_xor_b32 v97, v97, v6
    s_lshl_b32 s66, s20, 10
    s_add_u32 s66, s66, 16384
    v_add_u32 v98, s66, v86
    v_lshrrev_b32 v6, 8, v98
    v_mul_u32_u24 v6, 205, v6
    v_bfe_u32 v7, v6, 12, 1
    v_bfe_u32 v6, v6, 10, 1
    v_lshl_or_b32 v6, v7, 1, v6
    v_lshlrev_b32 v6, 6, v6
    v_xor_b32 v98, v98, v6
    v_mov_b32 v180, 0
    v_mov_b32 v181, 0
    v_mov_b32 v182, 0
    v_mov_b32 v183, 0
    s_mov_b32 s16, s70
    s_and_b32 s17, s71, 0xffff
    s_mov_b32 s18, 24165888
    s_mov_b32 s19, 0x20000
    v_lshrrev_b32 v2, 3, v1
    v_lshl_add_u32 v2, s20, 5, v2
    v_and_b32 v91, 7, v1
    v_mul_u32_u24 v94, 384, v2
    v_lshl_add_u32 v94, v91, 4, v94
    v_lshlrev_b32 v93, 2, v2
    v_add_u32 v93, 98304, v93
    v_mul_u32_u24 v92, 32000, v2
    v_lshl_add_u32 v92, v91, 4, v92
    v_mul_u32_u24 v90, 40960, v2
    s_mov_b32 s32, s82
    s_and_b32 s33, s83, 0xffff
    s_mov_b32 s34, 20480
    s_mov_b32 s35, 0x20000
    s_cmp_ge_u32 s20, 5
    s_cbranch_scc1 F_helper
    s_mov_b32 s22, 52429
    s_mov_b32 s23, 0x05040100
    s_mov_b32 s66, 98304
    s_movk_i32 s67, -40
    v_mov_b32 v7, 1
    v_add_u32 v31, 1, v5
    v_add_u32 v32, 2, v5
    v_add_u32 v33, 3, v5
    s_waitcnt vmcnt(3)
    v_mul_u32_u24 v22, s22, v8
    v_mul_u32_u24 v23, s22, v9
    v_mul_u32_u24 v24, s22, v10
    v_mul_u32_u24 v25, s22, v11
    v_lshrrev_b32 v22, 21, v22
    v_lshrrev_b32 v23, 21, v23
    v_lshrrev_b32 v24, 21, v24
    v_lshrrev_b32 v25, 21, v25
    v_lshl_add_u32 v34, v22, 2, s66
    ds_add_rtn_u32 v26, v34, v7
    v_lshl_add_u32 v35, v23, 2, s66
    ds_add_rtn_u32 v27, v35, v7
    v_lshl_add_u32 v36, v24, 2, s66
    ds_add_rtn_u32 v28, v36, v7
    v_lshl_add_u32 v37, v25, 2, s66
    ds_add_rtn_u32 v29, v37, v7
    v_mad_i32_i24 v2, v22, s67, v8
    v_mul_u32_u24 v22, 384, v22
    v_lshl_or_b32 v42, v2, 11, v5
    v_mad_i32_i24 v2, v23, s67, v9
    v_mul_u32_u24 v23, 384, v23
    v_lshl_or_b32 v46, v2, 11, v31
    v_mad_i32_i24 v2, v24, s67, v10
    v_mul_u32_u24 v24, 384, v24
    v_lshl_or_b32 v50, v2, 11, v32
    v_mad_i32_i24 v2, v25, s67, v11
    v_mul_u32_u24 v25, 384, v25
    v_lshl_or_b32 v54, v2, 11, v33
    s_waitcnt vmcnt(0)
    v_mov_b32 v40, v16
    v_perm_b32 v41, v12, v17, s23
    v_alignbit_b32 v44, v18, v17, 16
    v_alignbit_b32 v45, v13, v18, 16
    v_mov_b32 v48, v19
    v_perm_b32 v49, v14, v20, s23
    v_alignbit_b32 v52, v21, v20, 16
    v_alignbit_b32 v53, v15, v21, 16
    v_xor_b32 v41, 0x8000, v41
    v_xor_b32 v45, 0x8000, v45
    v_xor_b32 v49, 0x8000, v49
    v_xor_b32 v53, 0x8000, v53
    s_waitcnt lgkmcnt(0)
    v_min_u32 v26, 23, v26
    v_lshl_add_u32 v34, v26, 4, v22
    ds_write_b128 v34, v[40:43]
    v_min_u32 v27, 23, v27
    v_lshl_add_u32 v35, v27, 4, v23
    ds_write_b128 v35, v[44:47]
    v_min_u32 v28, 23, v28
    v_lshl_add_u32 v36, v28, 4, v24
    ds_write_b128 v36, v[48:51]
    v_min_u32 v29, 23, v29
    v_lshl_add_u32 v37, v29, 4, v25
    ds_write_b128 v37, v[52:55]
    s_branch F_staged
F_helper:
    s_cmp_eq_u32 s20, 5
    s_cbranch_scc0 F_nowp
    v_lshlrev_b32 v2, 7, v1
    s_movk_i32 s66, 0
    buffer_load_dword v95, v2, s[32:35], s66 offen
    s_movk_i32 s66, 8192
    buffer_load_dword v95, v2, s[32:35], s66 offen
    s_movk_i32 s66, 16384
    v_min_u32 v2, 3968, v2
    buffer_load_dword v95, v2, s[32:35], s66 offen
F_nowp:
    s_cmp_eq_u32 s20, 6
    s_cbranch_scc0 F_nopf
    s_getpc_b64 s[66:67]
F_pc:
    s_lshr_b32 s68, s2, 3
    s_mul_i32 s68, s68, ((K2_last-F_pc)/128/31+1)*128
    v_lshl_add_u32 v2, v1, 7, s68
    v_min_u32 v2, K2_last-F_pc-4, v2
    v_cmp_gt_u32 vcc, (K2_last-F_pc)/128/31+1, v1
    s_mov_b64 exec, vcc
    global_load_dword v95, v2, s[66:67]
    s_mov_b64 exec, -1
F_nopf:
    s_cmp_eq_u32 s20, 7
    s_cbranch_scc0 F_staged
    s_cmp_lt_u32 s2, 160
    s_cbranch_scc0 F_staged
    s_mul_i32 s22, s2, 3277
    s_lshr_b32 s22, s22, 16
    s_mul_i32 s68, s22, 20
    s_sub_u32 s68, s2, s68
    s_cmp_lt_u32 s68, 8
    s_cselect_b64 s[66:67], s[84:85], s[86:87]
    s_cselect_b32 s23, 0, 8
    s_sub_u32 s68, s68, s23
    s_and_b32 s23, s68, 1
    s_lshr_b32 s68, s68, 1
    s_lshl_b32 s68, s68, 14
    s_lshl_b32 s23, s23, 12
    s_add_u32 s68, s68, s23
    s_lshl_b32 s22, s22, 5
    s_add_u32 s68, s68, s22
    v_lshrrev_b32 v2, 4, v1
    v_lshlrev_b32 v2, 10, v2
    v_and_b32 v3, 15, v1
    v_lshl_add_u32 v2, v3, 1, v2
    v_add_u32 v2, s68, v2
    v_add_u32 v3, 8192, v2
    global_load_ushort v176, v2, s[66:67] offset:0
    global_load_short_d16_hi v180, v3, s[66:67] offset:0
    global_load_ushort v177, v2, s[66:67] offset:256
    global_load_short_d16_hi v181, v3, s[66:67] offset:256
    global_load_ushort v178, v2, s[66:67] offset:512
    global_load_short_d16_hi v182, v3, s[66:67] offset:512
    global_load_ushort v179, v2, s[66:67] offset:768
    global_load_short_d16_hi v183, v3, s[66:67] offset:768
F_staged:
    s_lshl_b32 s66, s2, 7
    s_add_u32 s66, s66, 164864
    s_cmp_eq_u32 s20, 7
    s_cselect_b32 s22, 0xffff, -1
    s_cselect_b32 s23, 0, -1
    s_waitcnt lgkmcnt(0)
    s_add_u32 s88, s88, 1
    s_barrier
    s_setprio 1
    ds_read_b32 v40, v93 offset:0
    ds_read_b128 v[8:11], v94 offset:0
    ds_read_b32 v14, v94 offset:136
    ds_read_b32 v41, v93 offset:32
    ds_read_b128 v[16:19], v94 offset:3072
    ds_read_b32 v22, v94 offset:3208
    ds_read_b32 v42, v93 offset:64
    ds_read_b128 v[24:27], v94 offset:6144
    ds_read_b32 v30, v94 offset:6280
    ds_read_b32 v43, v93 offset:96
    ds_read_b128 v[32:35], v94 offset:9216
    ds_read_b32 v38, v94 offset:9352
    s_add_u32 s28, s66, 0
    s_add_u32 s29, s66, 256000
    s_add_u32 s30, s66, 512000
    s_add_u32 s31, s66, 768000
    s_waitcnt lgkmcnt(9)
    v_min_u32 v5, 31, v40
    v_bfe_u32 v6, v14, 11, 6
    v_and_b32 v10, 0x1ffff, v10
    v_lshl_or_b32 v6, v5, 6, v6
    v_mov_b32 v11, s88
    v_lshl_or_b32 v10, v6, 17, v10
    buffer_store_dwordx4 v[8:11], v92, s[16:19], s28 offen sc1
    s_waitcnt lgkmcnt(6)
    v_min_u32 v5, 31, v41
    v_bfe_u32 v6, v22, 11, 6
    v_and_b32 v18, 0x1ffff, v18
    v_lshl_or_b32 v6, v5, 6, v6
    v_mov_b32 v19, s88
    v_lshl_or_b32 v18, v6, 17, v18
    buffer_store_dwordx4 v[16:19], v92, s[16:19], s29 offen sc1
    s_waitcnt lgkmcnt(3)
    v_min_u32 v5, 31, v42
    v_bfe_u32 v6, v30, 11, 6
    v_and_b32 v26, 0x1ffff, v26
    v_lshl_or_b32 v6, v5, 6, v6
    v_mov_b32 v27, s88
    v_lshl_or_b32 v26, v6, 17, v26
    buffer_store_dwordx4 v[24:27], v92, s[16:19], s30 offen sc1
    s_waitcnt lgkmcnt(0)
    v_min_u32 v5, 31, v43
    v_bfe_u32 v6, v38, 11, 6
    v_and_b32 v34, 0x1ffff, v34
    v_lshl_or_b32 v6, v5, 6, v6
    v_mov_b32 v35, s88
    v_lshl_or_b32 v34, v6, 17, v34
    s_mov_b64 exec, s[22:23]
    buffer_store_dwordx4 v[32:35], v92, s[16:19], s31 offen sc1
    s_mov_b64 exec, -1
    s_setprio 0
    ds_read_b128 v[12:15], v94 offset:128
    ds_read_b128 v[20:23], v94 offset:3200
    ds_read_b128 v[28:31], v94 offset:6272
    ds_read_b128 v[36:39], v94 offset:9344
    s_waitcnt vmcnt(4)
F_now:
    v_cmp_lt_u32 vcc, 8, v40
    s_add_u32 s67, s28, 8000000
    s_waitcnt lgkmcnt(3)
    v_mov_b32 v15, s88
    s_mov_b64 exec, vcc
    s_cbranch_execz F_w0
    buffer_store_dwordx4 v[12:15], v92, s[16:19], s67 offen sc1
    v_cmp_lt_u32 vcc, 16, v40
    s_add_u32 s67, s67, 8000000
    s_mov_b64 exec, vcc
    s_cbranch_execz F_w0
    ds_read_b128 v[44:47], v94 offset:256
    s_waitcnt lgkmcnt(0)
    v_mov_b32 v47, s88
    buffer_store_dwordx4 v[44:47], v92, s[16:19], s67 offen sc1
    s_nop 1
F_w0:
    s_mov_b64 exec, -1
    v_cmp_lt_u32 vcc, 8, v41
    s_add_u32 s67, s29, 8000000
    s_waitcnt lgkmcnt(2)
    v_mov_b32 v23, s88
    s_mov_b64 exec, vcc
    s_cbranch_execz F_w1
    buffer_store_dwordx4 v[20:23], v92, s[16:19], s67 offen sc1
    v_cmp_lt_u32 vcc, 16, v41
    s_add_u32 s67, s67, 8000000
    s_mov_b64 exec, vcc
    s_cbranch_execz F_w1
    ds_read_b128 v[44:47], v94 offset:3328
    s_waitcnt lgkmcnt(0)
    v_mov_b32 v47, s88
    buffer_store_dwordx4 v[44:47], v92, s[16:19], s67 offen sc1
    s_nop 1
F_w1:
    s_mov_b64 exec, -1
    v_cmp_lt_u32 vcc, 8, v42
    s_add_u32 s67, s30, 8000000
    s_waitcnt lgkmcnt(1)
    v_mov_b32 v31, s88
    s_mov_b64 exec, vcc
    s_cbranch_execz F_w2
    buffer_store_dwordx4 v[28:31], v92, s[16:19], s67 offen sc1
    v_cmp_lt_u32 vcc, 16, v42
    s_add_u32 s67, s67, 8000000
    s_mov_b64 exec, vcc
    s_cbranch_execz F_w2
    ds_read_b128 v[44:47], v94 offset:6400
    s_waitcnt lgkmcnt(0)
    v_mov_b32 v47, s88
    buffer_store_dwordx4 v[44:47], v92, s[16:19], s67 offen sc1
    s_nop 1
F_w2:
    s_mov_b64 exec, -1
    v_cmp_lt_u32 vcc, 8, v43
    s_add_u32 s67, s31, 8000000
    s_and_b64 vcc, vcc, s[22:23]
    s_waitcnt lgkmcnt(0)
    v_mov_b32 v39, s88
    s_mov_b64 exec, vcc
    s_cbranch_execz F_w3
    buffer_store_dwordx4 v[36:39], v92, s[16:19], s67 offen sc1
    v_cmp_lt_u32 vcc, 16, v43
    s_add_u32 s67, s67, 8000000
    s_mov_b64 exec, vcc
    s_cbranch_execz F_w3
    ds_read_b128 v[44:47], v94 offset:9472
    s_waitcnt lgkmcnt(0)
    v_mov_b32 v47, s88
    buffer_store_dwordx4 v[44:47], v92, s[16:19], s67 offen sc1
    s_nop 1
F_w3:
    s_mov_b64 exec, -1
    s_cmp_eq_u32 s20, 7
    s_cbranch_scc0 F_nofrag
    s_cmp_lt_u32 s2, 160
    s_cbranch_scc0 F_nofrag
    v_or_b32 v176, v176, v180
    v_or_b32 v177, v177, v181
    v_or_b32 v178, v178, v182
    v_or_b32 v179, v179, v183
    s_lshl_b32 s66, s2, 10
    s_add_u32 s66, s66, 1024
    buffer_store_dwordx4 v[176:179], v86, s[16:19], s66 offen sc1
F_nofrag:
    s_barrier
    s_mul_i32 s24, s2, 32000
    s_lshl_b32 s25, s20, 12
    s_add_u32 s24, s24, s25
    s_add_u32 s24, s24, 164864
    s_add_u32 s25, s24, 8000000
    s_add_u32 s26, s25, 8000000
    v_mov_b32 v22, 0
    v_mov_b32 v23, s88
    s_lshl_b32 s68, s20, 10
    s_add_u32 m0, s68, 65536
    s_nop 0
    buffer_load_dwordx4 v96, s[32:35], 0 offen lds
    s_add_u32 m0, s68, 73728
    s_nop 0
    buffer_load_dwordx4 v97, s[32:35], 0 offen lds
    s_cmp_ge_u32 s20, 4
    s_cbranch_scc1 F_now2
    s_add_u32 m0, s68, 81920
    s_nop 0
    buffer_load_dwordx4 v98, s[32:35], 0 offen lds
F_now2:
    v_mov_b32 v4, 2130738944
    v_mov_b32 v5, 2130738944
    v_mov_b32 v6, 2130738944
    v_mov_b32 v7, 2130738944
    v_lshlrev_b32 v2, 4, v0
    v_add_u32 v3, 86016, v2
    ds_write_b128 v3, v[4:7] offset:0
    ds_write_b128 v3, v[4:7] offset:8192
    ds_write_b128 v3, v[4:7] offset:16384
    ds_write_b128 v3, v[4:7] offset:24576
    ds_write_b128 v3, v[4:7] offset:32768
    ds_write_b128 v3, v[4:7] offset:40960
    ds_write_b128 v3, v[4:7] offset:49152
    ds_write_b128 v3, v[4:7] offset:57344
    v_add_u32 v3, 0x10000, v3
    ds_write_b128 v3, v[4:7] offset:0
    v_min_u32 v2, 3056, v2
    v_add_u32 v2, 159744, v2
    ds_write_b128 v2, v[4:7]
    s_sub_u32 s72, s72, 128
    s_subb_u32 s73, s73, 0
    s_mov_b32 s4, s72
    s_and_b32 s5, s73, 0xffff
    s_mov_b32 s6, 10240000
    s_mov_b32 s7, 0x20000
    s_sub_u32 s72, s72, 1024
    s_subb_u32 s73, s73, 0
    s_mov_b32 s8, s72
    s_and_b32 s9, s73, 0xffff
    s_mov_b32 s10, 10241024
    s_mov_b32 s11, 0x20000
    s_mov_b32 s12, s76
    s_and_b32 s13, s77, 0xffff
    s_mov_b32 s14, 10240000
    s_mov_b32 s15, 0x20000
    v_lshrrev_b32 v2, 5, v1
    v_bfe_u32 v3, v1, 2, 2
    v_and_b32 v4, 3, v1
    v_bfe_u32 v5, v1, 4, 1
    v_lshlrev_b32 v6, 9, v2
    v_lshl_add_u32 v6, v3, 7, v6
    v_lshl_add_u32 v6, v5, 5, v6
    v_lshl_add_u32 v6, v4, 3, v6
    v_lshrrev_b32 v7, 1, v3
    v_lshl_add_u32 v6, v7, 6, v6
    v_add_u32 v244, s21, v6
    v_xor_b32 v245, 64, v244
    v_lshlrev_b32 v6, 7, v2
    v_lshl_add_u32 v6, v7, 5, v6
    v_and_b32 v7, 1, v3
    v_xor_b32 v7, 1, v7
    v_mul_u32_u24 v7, 90112, v7
    v_add_u32 v6, v6, v7
    v_lshl_add_u32 v249, v4, 3, v6
    v_lshl_add_u32 v6, v2, 2, v4
    v_bfe_u32 v7, v1, 2, 1
    v_lshl_add_u32 v6, v7, 3, v6
    v_lshlrev_b32 v6, 3, v6
    v_bfe_u32 v7, v1, 3, 1
    v_add_u32 v5, 1, v5
    v_mul_u32_u24 v7, v7, v5
    v_lshl_add_u32 v250, v7, 1, v6
    v_and_b32 v6, 0x38, v1
    v_add_u32 v247, 4, v6
    v_lshrrev_b32 v6, 2, v1
    v_lshrrev_b32 v7, 4, v1
    v_xor_b32 v6, v6, v7
    v_and_b32 v6, 1, v6
    v_lshlrev_b32 v6, 6, v6
    v_lshl_add_u32 v246, v4, 4, v6
    v_mov_b32 v242, 1.0
    v_mov_b32 v243, 1.0
    s_mov_b32 s54, 0xffffff00
    s_mov_b32 s55, 0xffffff00
    s_mov_b32 s56, 0xffff
    s_mov_b32 s57, 0xffff
    s_mov_b32 s58, 0
    s_mov_b32 s59, 134217856
    s_mov_b32 s60, 262272
    s_mov_b32 s61, 402915456
    s_mov_b32 s62, 940179840
    s_mov_b32 s63, 403046528
    s_mov_b32 s64, 402784384
    s_mov_b32 s65, 134348928
    s_mov_b32 s38, 128
    s_mov_b32 s33, -1
    s_and_b32 s68, s20, 3
    s_lshl_b32 s68, s68, 2
    s_lshr_b32 s69, s20, 2
    s_add_u32 s68, s68, s69
    s_lshl_b32 s68, s68, 4
    s_add_u32 s68, s68, 163072
    v_mov_b32 v251, s68
    s_mov_b32 s53, 0
    s_mov_b32 s50, 0
    s_mov_b32 s51, 0
    s_mov_b32 s47, 0
    s_mov_b32 s42, 0
    s_mov_b32 s3, 0
    s_mov_b32 s89, 0
    s_mov_b32 s34, 128
    s_mov_b32 s35, 384
    s_mov_b32 s36, 640
    s_mov_b32 s37, 896
    s_movk_i32 s3, 1024
    s_waitcnt lgkmcnt(0)
    s_waitcnt vmcnt(0)
    s_barrier
    s_mov_b32 s27, 4096
    s_mov_b32 s71, 162816
    v_mov_b32 v3, 8
    s_cmp_eq_u32 s20, 7
    s_cselect_b32 s52, 160, 0
    v_cmp_gt_u32 s[68:69], 40, v1
    s_mov_b64 s[28:29], 0xff
    s_lshr_b32 s66, s2, 3
    s_lshl_b32 s66, s66, 3
    s_add_u32 s66, s66, s20
    s_mul_i32 s66, s66, 14
    v_min_u32 v93, 13, v1
    v_add_u32 v93, s66, v93
    v_lshlrev_b32 v93, 10, v93
    v_mov_b32 v94, 0x7f000000
    s_waitcnt lgkmcnt(0)
    buffer_load_dwordx4 v[8:11], v86, s[16:19], s24 offen offset:0 sc1
    buffer_load_dwordx4 v[12:15], v86, s[16:19], s24 offen offset:1024 sc1
    buffer_load_dwordx4 v[16:19], v86, s[16:19], s24 offen offset:2048 sc1
    s_mov_b64 exec, s[22:23]
    buffer_load_dwordx4 v[20:23], v86, s[16:19], s24 offen offset:3072 sc1
    s_mov_b64 exec, -1
    v_bfe_u32 v4, v248, 5, 1
    v_bfe_u32 v6, v248, 7, 1
    v_lshl_or_b32 v5, v6, 1, v4
    v_lshl_or_b32 v4, v6, 2, v4
    v_mul_u32_u24 v4, 1280, v4
    v_lshl_add_u32 v4, v5, 6, v4
    v_bfe_u32 v6, v248, 6, 1
    v_lshl_add_u32 v4, v6, 5, v4
    v_and_b32 v6, 12, v248
    v_lshl_add_u32 v4, v6, 1, v4
    v_and_b32 v6, 16, v248
    v_xor_b32 v6, 16, v6
    v_lshl_add_u32 v4, v6, 13, v4
    v_add_u32 v4, 65536, v4
    v_xor_b32 v5, 64, v4
    ds_read_b64_tr_b16 v[96:97], v4 offset:0
    ds_read_b64_tr_b16 v[98:99], v4 offset:2560
    ds_read_b64_tr_b16 v[100:101], v4 offset:10240
    ds_read_b64_tr_b16 v[102:103], v4 offset:12800
    ds_read_b64_tr_b16 v[104:105], v5 offset:0
    ds_read_b64_tr_b16 v[106:107], v5 offset:2560
    ds_read_b64_tr_b16 v[108:109], v5 offset:10240
    ds_read_b64_tr_b16 v[110:111], v5 offset:12800
    ds_read_b64_tr_b16 v[128:129], v4 offset:512
    ds_read_b64_tr_b16 v[130:131], v4 offset:3072
    ds_read_b64_tr_b16 v[132:133], v4 offset:10752
    ds_read_b64_tr_b16 v[134:135], v4 offset:13312
    ds_read_b64_tr_b16 v[136:137], v5 offset:512
    ds_read_b64_tr_b16 v[138:139], v5 offset:3072
    ds_read_b64_tr_b16 v[140:141], v5 offset:10752
    ds_read_b64_tr_b16 v[142:143], v5 offset:13312
    ds_read_b64_tr_b16 v[144:145], v4 offset:768
    ds_read_b64_tr_b16 v[146:147], v4 offset:3328
    ds_read_b64_tr_b16 v[148:149], v4 offset:11008
    ds_read_b64_tr_b16 v[150:151], v4 offset:13568
    ds_read_b64_tr_b16 v[152:153], v5 offset:768
    ds_read_b64_tr_b16 v[154:155], v5 offset:3328
    ds_read_b64_tr_b16 v[156:157], v5 offset:11008
    ds_read_b64_tr_b16 v[158:159], v5 offset:13568
    ds_read_b64_tr_b16 v[160:161], v4 offset:1024
    ds_read_b64_tr_b16 v[162:163], v4 offset:3584
    ds_read_b64_tr_b16 v[164:165], v4 offset:11264
    ds_read_b64_tr_b16 v[166:167], v4 offset:13824
    ds_read_b64_tr_b16 v[168:169], v5 offset:1024
    ds_read_b64_tr_b16 v[170:171], v5 offset:3584
    ds_read_b64_tr_b16 v[172:173], v5 offset:11264
    ds_read_b64_tr_b16 v[174:175], v5 offset:13824
    ds_read_b64_tr_b16 v[112:113], v4 offset:256
    ds_read_b64_tr_b16 v[114:115], v4 offset:2816
    ds_read_b64_tr_b16 v[116:117], v4 offset:10496
    ds_read_b64_tr_b16 v[118:119], v4 offset:13056
    ds_read_b64_tr_b16 v[120:121], v5 offset:256
    ds_read_b64_tr_b16 v[122:123], v5 offset:2816
    ds_read_b64_tr_b16 v[124:125], v5 offset:10496
    ds_read_b64_tr_b16 v[126:127], v5 offset:13056
F_poll:
    s_waitcnt vmcnt(0)
F_poll1:
    v_cmp_ne_u32 s[72:73], s88, v11
    v_cmp_ne_u32 s[74:75], s88, v15
    v_cmp_ne_u32 s[76:77], s88, v19
    v_cmp_ne_u32 s[78:79], s88, v23
    s_or_b64 s[80:81], s[72:73], s[74:75]
    s_or_b64 s[82:83], s[76:77], s[78:79]
    s_or_b64 s[80:81], s[80:81], s[82:83]
    s_cbranch_scc1 F_again
F_got:
    v_bfe_u32 v2, v10, 23, 5
    v_bfe_u32 v60, v10, 11, 6
    v_cmp_gt_u32 s[80:81], v2, v91
    v_lshl_add_u32 v60, v60, 2, s71
    v_cmp_lt_u32 s[72:73], 8, v2
    v_max_u32 v89, v89, v2
    s_mov_b64 exec, s[80:81]
    ds_add_rtn_u32 v72, v60, v3
    s_mov_b64 exec, s[72:73]
    s_cbranch_execz F_h0
    buffer_load_dwordx4 v[24:27], v86, s[16:19], s25 offen offset:0 sc1
    v_sub_u32 v56, v2, v91
    v_bfe_u32 v64, v10, 17, 6
    v_cmp_lt_u32 vcc, 8, v56
    v_lshl_add_u32 v64, v64, 2, s71
    s_mov_b64 exec, vcc
    ds_add_rtn_u32 v76, v64, v3
F_h0:
    s_mov_b64 exec, -1
    v_bfe_u32 v2, v14, 23, 5
    v_bfe_u32 v61, v14, 11, 6
    v_cmp_gt_u32 s[82:83], v2, v91
    v_lshl_add_u32 v61, v61, 2, s71
    v_cmp_lt_u32 s[74:75], 8, v2
    v_max_u32 v89, v89, v2
    s_mov_b64 exec, s[82:83]
    ds_add_rtn_u32 v73, v61, v3
    s_mov_b64 exec, s[74:75]
    s_cbranch_execz F_h1
    buffer_load_dwordx4 v[28:31], v86, s[16:19], s25 offen offset:1024 sc1
    v_sub_u32 v57, v2, v91
    v_bfe_u32 v65, v14, 17, 6
    v_cmp_lt_u32 vcc, 8, v57
    v_lshl_add_u32 v65, v65, 2, s71
    s_mov_b64 exec, vcc
    ds_add_rtn_u32 v77, v65, v3
F_h1:
    s_mov_b64 exec, -1
    v_bfe_u32 v2, v18, 23, 5
    v_bfe_u32 v62, v18, 11, 6
    v_cmp_gt_u32 s[84:85], v2, v91
    v_lshl_add_u32 v62, v62, 2, s71
    v_cmp_lt_u32 s[76:77], 8, v2
    v_max_u32 v89, v89, v2
    s_mov_b64 exec, s[84:85]
    ds_add_rtn_u32 v74, v62, v3
    s_mov_b64 exec, s[76:77]
    s_cbranch_execz F_h2
    buffer_load_dwordx4 v[32:35], v86, s[16:19], s25 offen offset:2048 sc1
    v_sub_u32 v58, v2, v91
    v_bfe_u32 v66, v18, 17, 6
    v_cmp_lt_u32 vcc, 8, v58
    v_lshl_add_u32 v66, v66, 2, s71
    s_mov_b64 exec, vcc
    ds_add_rtn_u32 v78, v66, v3
F_h2:
    s_mov_b64 exec, -1
    v_bfe_u32 v2, v22, 23, 5
    v_bfe_u32 v63, v22, 11, 6
    v_cmp_gt_u32 s[86:87], v2, v91
    v_lshl_add_u32 v63, v63, 2, s71
    v_cmp_lt_u32 s[78:79], 8, v2
    v_max_u32 v89, v89, v2
    s_mov_b64 exec, s[86:87]
    ds_add_rtn_u32 v75, v63, v3
    s_mov_b64 exec, s[78:79]
    s_cbranch_execz F_h3
    buffer_load_dwordx4 v[36:39], v86, s[16:19], s25 offen offset:3072 sc1
    v_sub_u32 v59, v2, v91
    v_bfe_u32 v67, v22, 17, 6
    v_cmp_lt_u32 vcc, 8, v59
    v_lshl_add_u32 v67, v67, 2, s71
    s_mov_b64 exec, vcc
    ds_add_rtn_u32 v79, v67, v3
F_h3:
    s_mov_b64 exec, -1
    v_cmp_lt_u32 s[30:31], 16, v89
    s_mov_b32 s27, 262144
    s_cmp_lg_u64 s[30:31], 0
    s_cbranch_scc1 F_l3
F_l3r:
    s_cmp_lt_u32 s2, s52
    s_cbranch_scc1 F_flag
F_flagr:
    s_waitcnt lgkmcnt(0)
    s_barrier
    ds_read_b32 v4, v88
    buffer_load_dword v95, v93, s[4:7], 0 offen offset:128
    v_and_b32 v10, 0x7ff, v10
    v_lshl_add_u32 v10, v10, 5, v90
    v_or_b32 v11, 16, v10
    v_and_b32 v14, 0x7ff, v14
    v_lshl_add_u32 v14, v14, 5, v90
    v_add_u32 v14, 327680, v14
    v_or_b32 v15, 16, v14
    v_and_b32 v18, 0x7ff, v18
    v_lshl_add_u32 v18, v18, 5, v90
    v_add_u32 v18, 655360, v18
    v_or_b32 v19, 16, v18
    v_and_b32 v22, 0x7ff, v22
    v_lshl_add_u32 v22, v22, 5, v90
    v_add_u32 v22, 983040, v22
    v_or_b32 v23, 16, v22
    s_waitcnt lgkmcnt(0)
    v_add_u32 v2, 56, v4
    v_cmp_lt_u32 vcc, 512, v4
    v_lshrrev_b32 v2, 6, v2
    v_max_u32 v2, 2, v2
    s_cmp_lg_u64 vcc, 0
    s_cbranch_scc1 SLOW
    v_med3_u32 v3, v2, 3, 7
    v_cmp_eq_u32 vcc, 7, v2
    v_mad_u32_u24 v3, v3, 6, 14
    v_lshlrev_b32_e64 v6, v3, 1
    v_cndmask_b32 v6, 0, v6, s[68:69]
    v_addc_co_u32 v2, vcc, 0, v2, vcc
    v_mov_b32 v7, v6
    v_add_u32 v5, 1, v2
    v_lshrrev_b32 v5, 1, v5
    v_add_u32_dpp v7, v7, v7 row_shr:1 row_mask:0xf bank_mask:0xf
    v_lshlrev_b32 v92, 22, v5
    v_lshlrev_b32 v5, 18, v5
    v_add_u32_dpp v7, v7, v7 row_shr:2 row_mask:0xf bank_mask:0xf
    v_lshl_or_b32 v5, v1, 21, v5
    v_lshl_or_b32 v5, v2, 28, v5
    v_add_u32_dpp v7, v7, v7 row_shr:4 row_mask:0xf bank_mask:0xf
    s_mov_b32 s26, 86016
    s_mov_b32 s24, 0x2000
    v_add_u32_dpp v7, v7, v7 row_shr:8 row_mask:0xf bank_mask:0xf
    s_nop 1
    v_add_u32_dpp v7, v7, v7 row_bcast:15 row_mask:0xa bank_mask:0xf
    s_nop 1
    v_add_u32_dpp v7, v7, v7 row_bcast:31 row_mask:0xc bank_mask:0xf
    s_nop 0
    v_readlane_b32 s71, v7, 63
    v_sub_u32 v7, v7, v6
    s_lshr_b32 s66, s71, 24
    s_lshr_b32 s67, s71, 6
    s_lshr_b32 s70, s71, 12
    s_lshr_b32 s71, s71, 18
    s_add_u32 s67, s67, s70
    s_add_u32 s71, s71, s66
    s_add_u32 s71, s71, s67
    v_add_u32 v7, s71, v7
    s_bfe_u32 s70, s71, 393222
    v_bfe_u32 v7, v7, v3, 6
    s_bfe_u32 s67, s71, 393228
    v_cndmask_b32 v84, 63, v7, s[68:69]
    s_mul_i32 s68, s70, 3
    v_min_u32 v2, s70, v7
    s_mul_i32 s69, s66, 5
    v_min_u32 v3, s66, v7
    s_add_u32 s68, s68, s69
    v_mul_u32_u24 v7, 12, v7
    s_cmp_gt_u32 s68, 120
    v_mad_u32_u24 v7, v2, 3, v7
    s_cbranch_scc1 SLOW
    v_mad_u32_u24 v7, v3, 5, v7
    v_lshl_add_u32 v7, v7, 7, s26
    v_lshrrev_b32 v6, 3, v7
    v_mad_u32_u24 v92, v7, s24, v92
    v_or_b32 v92, v92, v6
    v_or_b32 v6, v5, v7
    s_add_u32 s71, s70, s66
    s_add_u32 s68, s71, s67
    s_andn2_b32 s70, s70, 3
    s_add_u32 s69, s70, 4
    s_andn2_b32 s67, s67, 3
    v_lshrrev_b32 v3, 1, v84
    v_mov_b32 v2, s68
    v_xor_b32 v3, v3, v84
    v_bfi_b32 v3, 4, v3, v84
    v_cmpx_gt_u32 vcc, s69, v84
    v_mov_b32 v2, s66
    v_cmpx_gt_u32 vcc, s70, v84
    v_mov_b32 v2, s71
    v_cmpx_gt_u32 vcc, s67, v84
    v_mov_b32 v2, 0
    s_mov_b64 exec, -1
    v_add_u32 v2, v2, v84
    v_bfi_b32 v84, 3, v2, v3
    s_lshr_b32 s66, s2, 3
    v_cmp_gt_u32 vcc, 32, v84
    v_add_u32 v2, s66, v84
    v_lshl_add_u32 v2, v2, 3, v84
    v_bfi_b32 v2, 24, v2, v84
    v_cndmask_b32 v84, v84, v2, vcc
    v_subrev_u32 v2, 6, v84
    v_and_b32 v2, 0x80000000, v2
    v_or_b32 v92, v92, v2
    ds_bpermute_b32 v60, v60, v92
    ds_bpermute_b32 v61, v61, v92
    ds_bpermute_b32 v62, v62, v92
    ds_bpermute_b32 v63, v63, v92
    ds_bpermute_b32 v64, v64, v92
    ds_bpermute_b32 v65, v65, v92
    ds_bpermute_b32 v66, v66, v92
    ds_bpermute_b32 v67, v67, v92
    v_cmp_eq_u32 vcc, s20, v84
    s_ff1_i32_b64 s67, vcc
    v_readlane_b32 s71, v6, s67
    s_mov_b32 s22, s71
    s_bfe_u32 s46, s71, 0x30012
    s_mov_b32 m0, s46
    s_and_b32 s66, s71, 0x3ffff
    s_movrels_b32 s68, s57
    s_movrels_b32 s69, s61
    s_sub_u32 s48, s66, s47
    s_mov_b32 s47, s66
    s_lshr_b32 s52, s71, 28
    s_lshl_b32 s67, s46, 9
    s_add_u32 s66, s66, s67
    s_sub_u32 s49, s66, s42
    s_mov_b32 s42, s66
    s_bfe_u32 s66, s68, 655360
    s_add_u32 s43, s42, s66
    s_bfe_u32 s39, s69, 655360
    s_bfe_u32 s66, s68, 655370
    s_add_u32 s44, s42, s66
    s_bfe_u32 s40, s69, 655370
    s_bfe_u32 s66, s68, 655380
    s_add_u32 s45, s42, s66
    s_bfe_u32 s41, s69, 655380
    s_waitcnt lgkmcnt(7)
    v_cmp_gt_i32 vcc, 0, v60
    v_and_b32 v60, 0x7fffffff, v60
    s_and_b64 exec, vcc, s[80:81]
    buffer_load_dword v95, v10, s[12:15], 0 offen
    s_mov_b64 exec, -1
    v_mad_u32_u16 v2, v60, 8, v72
    v_mad_u32_u16 v3, v60, 8, v72 op_sel:[1,0,0,0]
    s_mov_b64 exec, s[80:81]
    ds_write_b64 v2, v[10:11]
    ds_write_b64 v3, v[8:9]
    s_mov_b64 exec, -1
    s_waitcnt lgkmcnt(8)
    v_cmp_gt_i32 vcc, 0, v61
    v_and_b32 v61, 0x7fffffff, v61
    s_and_b64 exec, vcc, s[82:83]
    buffer_load_dword v95, v14, s[12:15], 0 offen
    s_mov_b64 exec, -1
    v_mad_u32_u16 v2, v61, 8, v73
    v_mad_u32_u16 v3, v61, 8, v73 op_sel:[1,0,0,0]
    s_mov_b64 exec, s[82:83]
    ds_write_b64 v2, v[14:15]
    ds_write_b64 v3, v[12:13]
    s_mov_b64 exec, -1
    s_waitcnt lgkmcnt(9)
    v_cmp_gt_i32 vcc, 0, v62
    v_and_b32 v62, 0x7fffffff, v62
    s_and_b64 exec, vcc, s[84:85]
    buffer_load_dword v95, v18, s[12:15], 0 offen
    s_mov_b64 exec, -1
    v_mad_u32_u16 v2, v62, 8, v74
    v_mad_u32_u16 v3, v62, 8, v74 op_sel:[1,0,0,0]
    s_mov_b64 exec, s[84:85]
    ds_write_b64 v2, v[18:19]
    ds_write_b64 v3, v[16:17]
    s_mov_b64 exec, -1
    s_waitcnt lgkmcnt(10)
    v_cmp_gt_i32 vcc, 0, v63
    v_and_b32 v63, 0x7fffffff, v63
    s_and_b64 exec, vcc, s[86:87]
    buffer_load_dword v95, v22, s[12:15], 0 offen
    s_mov_b64 exec, -1
    v_mad_u32_u16 v2, v63, 8, v75
    v_mad_u32_u16 v3, v63, 8, v75 op_sel:[1,0,0,0]
    s_mov_b64 exec, s[86:87]
    ds_write_b64 v2, v[22:23]
    ds_write_b64 v3, v[20:21]
    s_mov_b64 exec, -1
    s_waitcnt vmcnt(5) lgkmcnt(8)
    s_mov_b64 exec, s[72:73]
    s_cbranch_execz F_s0
F_sp0:
    v_cmp_ne_u32 vcc, s88, v27
    s_cbranch_vccnz F_sa0
F_sg0:
    v_cmpx_lt_u32 vcc, 8, v56
    v_and_b32 v26, 0x7ff, v26
    v_lshl_add_u32 v26, v26, 5, v90
    v_or_b32 v27, 16, v26
    v_cmp_gt_i32 vcc, 0, v64
    v_and_b32 v64, 0x7fffffff, v64
    s_and_saveexec_b64 s[82:83], vcc
    s_cbranch_execz F_x0
    buffer_load_dword v95, v26, s[12:15], 0 offen
F_x0:
    s_mov_b64 exec, s[82:83]
    v_mad_u32_u16 v2, v64, 8, v76
    v_mad_u32_u16 v3, v64, 8, v76 op_sel:[1,0,0,0]
    ds_write_b64 v2, v[26:27]
    ds_write_b64 v3, v[24:25]
F_s0:
    s_mov_b64 exec, s[74:75]
    s_cbranch_execz F_s1
F_sp1:
    v_cmp_ne_u32 vcc, s88, v31
    s_cbranch_vccnz F_sa1
F_sg1:
    v_cmpx_lt_u32 vcc, 8, v57
    v_and_b32 v30, 0x7ff, v30
    v_lshl_add_u32 v30, v30, 5, v90
    v_add_u32 v30, 327680, v30
    v_or_b32 v31, 16, v30
    v_cmp_gt_i32 vcc, 0, v65
    v_and_b32 v65, 0x7fffffff, v65
    s_and_saveexec_b64 s[82:83], vcc
    s_cbranch_execz F_x1
    buffer_load_dword v95, v30, s[12:15], 0 offen
F_x1:
    s_mov_b64 exec, s[82:83]
    v_mad_u32_u16 v2, v65, 8, v77
    v_mad_u32_u16 v3, v65, 8, v77 op_sel:[1,0,0,0]
    ds_write_b64 v2, v[30:31]
    ds_write_b64 v3, v[28:29]
F_s1:
    s_mov_b64 exec, s[76:77]
    s_cbranch_execz F_s2
F_sp2:
    v_cmp_ne_u32 vcc, s88, v35
    s_cbranch_vccnz F_sa2
F_sg2:
    v_cmpx_lt_u32 vcc, 8, v58
    v_and_b32 v34, 0x7ff, v34
    v_lshl_add_u32 v34, v34, 5, v90
    v_add_u32 v34, 655360, v34
    v_or_b32 v35, 16, v34
    v_cmp_gt_i32 vcc, 0, v66
    v_and_b32 v66, 0x7fffffff, v66
    s_and_saveexec_b64 s[82:83], vcc
    s_cbranch_execz F_x2
    buffer_load_dword v95, v34, s[12:15], 0 offen
F_x2:
    s_mov_b64 exec, s[82:83]
    v_mad_u32_u16 v2, v66, 8, v78
    v_mad_u32_u16 v3, v66, 8, v78 op_sel:[1,0,0,0]
    ds_write_b64 v2, v[34:35]
    ds_write_b64 v3, v[32:33]
F_s2:
    s_mov_b64 exec, s[78:79]
    s_cbranch_execz F_s3
F_sp3:
    v_cmp_ne_u32 vcc, s88, v39
    s_cbranch_vccnz F_sa3
F_sg3:
    v_cmpx_lt_u32 vcc, 8, v59
    v_and_b32 v38, 0x7ff, v38
    v_lshl_add_u32 v38, v38, 5, v90
    v_add_u32 v38, 983040, v38
    v_or_b32 v39, 16, v38
    v_cmp_gt_i32 vcc, 0, v67
    v_and_b32 v67, 0x7fffffff, v67
    s_and_saveexec_b64 s[82:83], vcc
    s_cbranch_execz F_x3
    buffer_load_dword v95, v38, s[12:15], 0 offen
F_x3:
    s_mov_b64 exec, s[82:83]
    v_mad_u32_u16 v2, v67, 8, v79
    v_mad_u32_u16 v3, v67, 8, v79 op_sel:[1,0,0,0]
    ds_write_b64 v2, v[38:39]
    ds_write_b64 v3, v[36:37]
F_s3:
    s_mov_b64 exec, -1
    s_cmp_lg_u64 s[30:31], 0
    s_cbranch_scc1 F_u
F_ur:
    s_mov_b32 s27, s22
    s_and_b32 s66, s46, s33
    s_cselect_b32 s72, -1, 1
    s_cselect_b32 s76, s47, 163712
    s_cmp_ge_u32 s66, 2
    s_cselect_b32 s73, -1, 0
    s_add_u32 s77, s47, 1024
    s_cmp_ge_u32 s66, 4
    s_cselect_b32 s75, -1, 0
    s_cmp_ge_u32 s66, 3
    s_cselect_b32 s74, -1, 1
    s_cselect_b32 s77, s77, 163712
    s_mul_i32 s66, s20, 80
    v_min_u32 v2, 76, v248
    s_waitcnt lgkmcnt(0)
    s_barrier
    v_add_u32 v253, s47, v248
    ds_read_b32 v254, v253
    ds_read_b32 v255, v253 offset:256
    v_add_u32 v252, s42, v247
    ds_read2_b32 v[234:235], v252 offset0:0 offset1:16
    v_add_u32 v252, s43, v247
    ds_read2_b32 v[236:237], v252 offset0:0 offset1:16
    v_add_u32 v252, s44, v247
    ds_read2_b32 v[238:239], v252 offset0:0 offset1:16
    v_add_u32 v252, s45, v247
    ds_read2_b32 v[240:241], v252 offset0:0 offset1:16
    buffer_load_dword v3, v2, s[16:19], s66 offen offset:128 sc1
    v_add_u32 v249, s48, v249
    v_add_u32 v250, s49, v250
    s_waitcnt lgkmcnt(4)
    s_mov_b32 m0, s76
    s_mov_b64 exec, s[72:73]
    buffer_load_dwordx4 v254, s[12:15], 0 offen  lds
    s_mov_b32 m0, s77
    s_mov_b64 exec, s[74:75]
    buffer_load_dwordx4 v255, s[12:15], 0 offen  lds
    s_mov_b64 exec, -1
    s_waitcnt lgkmcnt(0)
    s_add_u32 m0, s21, 0
    v_mad_u32_u16 v234, v234, s3, v246 op_sel:[1,0,0,0]
    v_mad_u32_u16 v235, v235, s3, v246 op_sel:[1,0,0,0]
    buffer_load_dwordx4 v234, s[4:7], s38 offen  lds
    buffer_load_dwordx4 v235, s[8:11], s38 offen offset:1024  lds
    s_add_u32 m0, s21, 2048
    v_mad_u32_u16 v236, v236, s3, v246 op_sel:[1,0,0,0]
    v_mad_u32_u16 v237, v237, s3, v246 op_sel:[1,0,0,0]
    buffer_load_dwordx4 v236, s[4:7], s39 offen  lds
    buffer_load_dwordx4 v237, s[8:11], s39 offen offset:1024  lds
    s_add_u32 m0, s21, 4096
    v_mad_u32_u16 v238, v238, s3, v246 op_sel:[1,0,0,0]
    v_mad_u32_u16 v239, v239, s3, v246 op_sel:[1,0,0,0]
    buffer_load_dwordx4 v238, s[4:7], s40 offen  lds
    buffer_load_dwordx4 v239, s[8:11], s40 offen offset:1024  lds
    s_add_u32 m0, s21, 6144
    v_mad_u32_u16 v240, v240, s3, v246 op_sel:[1,0,0,0]
    v_mad_u32_u16 v241, v241, s3, v246 op_sel:[1,0,0,0]
    buffer_load_dwordx4 v240, s[4:7], s41 offen  lds
    buffer_load_dwordx4 v241, s[8:11], s41 offen offset:1024  lds
    v_lshrrev_b32 v8, 3, v84
    v_and_b32 v9, 7, v84
    v_lshlrev_b32 v9, 13, v9
    v_mul_u32_u24 v8, 1536, v8
    v_lshlrev_b32 v10, 4, v84
    v_and_b32 v5, 128, v10
    v_add3_u32 v8, v8, v9, v5
    v_xor_b32 v9, v10, v7
    v_and_b32 v9, 128, v9
    v_add_u32 v9, v9, v7
    v_mov_b32 v5, v9
    s_add_u32 s66, s20, 0
    v_cmp_eq_u32 vcc, s66, v84
    s_ff1_i32_b64 s67, vcc
    v_readlane_b32 s28, v5, s67
    s_add_u32 s66, s20, 8
    v_cmp_eq_u32 vcc, s66, v84
    s_ff1_i32_b64 s67, vcc
    v_readlane_b32 s29, v5, s67
    v_readlane_b32 s23, v6, s67
    s_add_u32 s66, s20, 16
    v_cmp_eq_u32 vcc, s66, v84
    s_ff1_i32_b64 s67, vcc
    v_readlane_b32 s30, v5, s67
    v_readlane_b32 s24, v6, s67
    s_add_u32 s66, s20, 24
    v_cmp_eq_u32 vcc, s66, v84
    s_ff1_i32_b64 s67, vcc
    v_readlane_b32 s31, v5, s67
    v_readlane_b32 s25, v6, s67
    s_add_u32 s66, s20, 32
    v_cmp_eq_u32 vcc, s66, v84
    s_ff1_i32_b64 s67, vcc
    v_readlane_b32 s32, v5, s67
    v_readlane_b32 s26, v6, s67
    v_lshlrev_b32 v4, 3, v84
    v_add_u32 v4, 163328, v4
    s_mov_b32 exec_hi, 0xff
    ds_write_b64 v4, v[8:9]
    s_mov_b32 exec_hi, -1
    s_waitcnt lgkmcnt(0)
    v_mov_b32 v252, 0
    s_waitcnt vmcnt(6)
    v_cmp_ne_u32 vcc, s88, v3
    ds_read_b64_tr_b16 v[176:177], v244 offset:0
    ds_read_b64_tr_b16 v[178:179], v244 offset:1024
    ds_read_b64_tr_b16 v[180:181], v245 offset:0
    ds_read_b64_tr_b16 v[182:183], v245 offset:1024
    ds_read_b64_tr_b16 v[72:73], v249 offset:0
    ds_read_b64_tr_b16 v[76:77], v249 offset:64
    ds_read_b64_tr_b16 v[74:75], v249 offset:256
    ds_read_b64_tr_b16 v[78:79], v249 offset:320
    s_mov_b64 exec, s[54:55]
    ds_read_u16_d16_hi v242, v250 offset:0
    s_mov_b64 exec, -1
    s_or_b32 s89, vcc_lo, vcc_hi
    s_add_u32 s53, s53, 4
    s_xor_b32 s66, s53, s20
    s_bitcmp1_b32 s66, 2
    s_setprio 1
    s_cbranch_scc1 PRIO_1
    s_setprio 0
PRIO_1:
    s_cmp_eq_u32 s52, 4
    s_cbranch_scc1 ITEM_0_4
    s_cmp_eq_u32 s52, 5
    s_cbranch_scc1 ITEM_0_5
    s_cmp_eq_u32 s52, 3
    s_cbranch_scc1 ITEM_0_3
    s_cmp_eq_u32 s52, 6
    s_cbranch_scc1 ITEM_0_6
    s_cmp_eq_u32 s52, 8
    s_cbranch_scc1 ITEM_0_8
    s_branch ITEM_0_2
F_again:
    s_sub_u32 s27, s27, 1
    s_cbranch_scc1 F_late
    s_cmp_eq_u64 s[72:73], 0
    s_cbranch_scc1 F_p0
    s_mov_b64 exec, s[72:73]
    s_cmp_gt_u32 s27, 4092
    s_cbranch_scc1 F_nd0
    v_mov_b32 v2, 0
    buffer_atomic_or v2, v86, s[16:19], s24 offen offset:12 sc1
    s_waitcnt vmcnt(0)
F_nd0:
    buffer_load_dwordx4 v[8:11], v86, s[16:19], s24 offen offset:0 sc1
    s_mov_b64 exec, -1
F_p0:
    s_cmp_eq_u64 s[74:75], 0
    s_cbranch_scc1 F_p1
    s_mov_b64 exec, s[74:75]
    s_cmp_gt_u32 s27, 4092
    s_cbranch_scc1 F_nd1
    v_mov_b32 v2, 0
    buffer_atomic_or v2, v86, s[16:19], s24 offen offset:1036 sc1
    s_waitcnt vmcnt(0)
F_nd1:
    buffer_load_dwordx4 v[12:15], v86, s[16:19], s24 offen offset:1024 sc1
    s_mov_b64 exec, -1
F_p1:
    s_cmp_eq_u64 s[76:77], 0
    s_cbranch_scc1 F_p2
    s_mov_b64 exec, s[76:77]
    s_cmp_gt_u32 s27, 4092
    s_cbranch_scc1 F_nd2
    v_mov_b32 v2, 0
    buffer_atomic_or v2, v86, s[16:19], s24 offen offset:2060 sc1
    s_waitcnt vmcnt(0)
F_nd2:
    buffer_load_dwordx4 v[16:19], v86, s[16:19], s24 offen offset:2048 sc1
    s_mov_b64 exec, -1
F_p2:
    s_cmp_eq_u64 s[78:79], 0
    s_cbranch_scc1 F_p3
    s_mov_b64 exec, s[78:79]
    s_cmp_gt_u32 s27, 4092
    s_cbranch_scc1 F_nd3
    v_mov_b32 v2, 0
    buffer_atomic_or v2, v86, s[16:19], s24 offen offset:3084 sc1
    s_waitcnt vmcnt(0)
F_nd3:
    buffer_load_dwordx4 v[20:23], v86, s[16:19], s24 offen offset:3072 sc1
    s_mov_b64 exec, -1
F_p3:
    s_branch F_poll
F_late:
    v_mov_b32 v2, 163064
    v_mov_b32 v4, 1000
    ds_write_b32 v2, v4
    v_mov_b32 v10, 0
    v_mov_b32 v14, 0
    v_mov_b32 v18, 0
    v_mov_b32 v22, 0
    s_branch F_got
F_l3:
    v_bfe_u32 v2, v10, 23, 5
    v_sub_u32 v56, v2, v91
    v_cmp_lt_u32 vcc, 16, v2
    s_mov_b64 exec, vcc
    s_cbranch_execz F_t0
F_tp0:
    buffer_load_dwordx4 v[40:43], v86, s[16:19], s26 offen offset:0 sc1
    s_waitcnt vmcnt(0)
    v_cmp_ne_u32 vcc, s88, v43
    s_sub_u32 s27, s27, 1
    s_cselect_b64 vcc, 0, vcc
    s_cmp_eq_u64 vcc, 0
    s_cbranch_scc0 F_tp0
    v_bfe_u32 v68, v42, 11, 6
    v_lshl_add_u32 v68, v68, 2, s71
    v_cmp_lt_i32 vcc, 16, v56
    s_mov_b64 exec, vcc
    ds_add_rtn_u32 v80, v68, v3
F_t0:
    s_mov_b64 exec, -1
    v_bfe_u32 v2, v14, 23, 5
    v_sub_u32 v57, v2, v91
    v_cmp_lt_u32 vcc, 16, v2
    s_mov_b64 exec, vcc
    s_cbranch_execz F_t1
F_tp1:
    buffer_load_dwordx4 v[44:47], v86, s[16:19], s26 offen offset:1024 sc1
    s_waitcnt vmcnt(0)
    v_cmp_ne_u32 vcc, s88, v47
    s_sub_u32 s27, s27, 1
    s_cselect_b64 vcc, 0, vcc
    s_cmp_eq_u64 vcc, 0
    s_cbranch_scc0 F_tp1
    v_bfe_u32 v69, v46, 11, 6
    v_lshl_add_u32 v69, v69, 2, s71
    v_cmp_lt_i32 vcc, 16, v57
    s_mov_b64 exec, vcc
    ds_add_rtn_u32 v81, v69, v3
F_t1:
    s_mov_b64 exec, -1
    v_bfe_u32 v2, v18, 23, 5
    v_sub_u32 v58, v2, v91
    v_cmp_lt_u32 vcc, 16, v2
    s_mov_b64 exec, vcc
    s_cbranch_execz F_t2
F_tp2:
    buffer_load_dwordx4 v[48:51], v86, s[16:19], s26 offen offset:2048 sc1
    s_waitcnt vmcnt(0)
    v_cmp_ne_u32 vcc, s88, v51
    s_sub_u32 s27, s27, 1
    s_cselect_b64 vcc, 0, vcc
    s_cmp_eq_u64 vcc, 0
    s_cbranch_scc0 F_tp2
    v_bfe_u32 v70, v50, 11, 6
    v_lshl_add_u32 v70, v70, 2, s71
    v_cmp_lt_i32 vcc, 16, v58
    s_mov_b64 exec, vcc
    ds_add_rtn_u32 v82, v70, v3
F_t2:
    s_mov_b64 exec, -1
    v_bfe_u32 v2, v22, 23, 5
    v_sub_u32 v59, v2, v91
    v_cmp_lt_u32 vcc, 16, v2
    s_mov_b64 exec, vcc
    s_cbranch_execz F_t3
F_tp3:
    buffer_load_dwordx4 v[52:55], v86, s[16:19], s26 offen offset:3072 sc1
    s_waitcnt vmcnt(0)
    v_cmp_ne_u32 vcc, s88, v55
    s_sub_u32 s27, s27, 1
    s_cselect_b64 vcc, 0, vcc
    s_cmp_eq_u64 vcc, 0
    s_cbranch_scc0 F_tp3
    v_bfe_u32 v71, v54, 11, 6
    v_lshl_add_u32 v71, v71, 2, s71
    v_cmp_lt_i32 vcc, 16, v59
    s_mov_b64 exec, vcc
    ds_add_rtn_u32 v83, v71, v3
F_t3:
    s_mov_b64 exec, -1
    v_mov_b32 v2, 163068
    v_mov_b32 v4, 1000
    v_cmp_lt_u32 vcc, 24, v89
    s_mov_b64 exec, vcc
    ds_write_b32 v2, v4
    s_mov_b64 exec, -1
    s_branch F_l3r
F_flag:
    s_lshl_b32 s66, s2, 2
    v_mov_b32 v2, 128
    v_mov_b32 v4, s88
    s_mov_b64 exec, 1
    buffer_store_dword v4, v2, s[16:19], s66 offen sc1
    s_mov_b64 exec, -1
    s_branch F_flagr
F_sa0:
    s_sub_u32 s27, s27, 1
    s_cbranch_scc1 F_sg0
    buffer_load_dwordx4 v[24:27], v86, s[16:19], s25 offen offset:0 sc1
    s_waitcnt vmcnt(0)
    s_branch F_sp0
F_sa1:
    s_sub_u32 s27, s27, 1
    s_cbranch_scc1 F_sg1
    buffer_load_dwordx4 v[28:31], v86, s[16:19], s25 offen offset:1024 sc1
    s_waitcnt vmcnt(0)
    s_branch F_sp1
F_sa2:
    s_sub_u32 s27, s27, 1
    s_cbranch_scc1 F_sg2
    buffer_load_dwordx4 v[32:35], v86, s[16:19], s25 offen offset:2048 sc1
    s_waitcnt vmcnt(0)
    s_branch F_sp2
F_sa3:
    s_sub_u32 s27, s27, 1
    s_cbranch_scc1 F_sg3
    buffer_load_dwordx4 v[36:39], v86, s[16:19], s25 offen offset:3072 sc1
    s_waitcnt vmcnt(0)
    s_branch F_sp3
F_u:
    ds_bpermute_b32 v68, v68, v92
    ds_bpermute_b32 v69, v69, v92
    ds_bpermute_b32 v70, v70, v92
    ds_bpermute_b32 v71, v71, v92
    s_waitcnt lgkmcnt(0)
    v_cmp_lt_i32 vcc, 16, v56
    s_mov_b64 exec, vcc
    s_cbranch_execz F_u0
    v_and_b32 v42, 0x7ff, v42
    v_lshl_add_u32 v42, v42, 5, v90
    v_or_b32 v43, 16, v42
    v_and_b32 v68, 0x7fffffff, v68
    v_mad_u32_u16 v2, v68, 8, v80
    v_mad_u32_u16 v3, v68, 8, v80 op_sel:[1,0,0,0]
    ds_write_b64 v2, v[42:43]
    ds_write_b64 v3, v[40:41]
F_u0:
    s_mov_b64 exec, -1
    v_cmp_lt_i32 vcc, 16, v57
    s_mov_b64 exec, vcc
    s_cbranch_execz F_u1
    v_and_b32 v46, 0x7ff, v46
    v_lshl_add_u32 v46, v46, 5, v90
    v_add_u32 v46, 327680, v46
    v_or_b32 v47, 16, v46
    v_and_b32 v69, 0x7fffffff, v69
    v_mad_u32_u16 v2, v69, 8, v81
    v_mad_u32_u16 v3, v69, 8, v81 op_sel:[1,0,0,0]
    ds_write_b64 v2, v[46:47]
    ds_write_b64 v3, v[44:45]
F_u1:
    s_mov_b64 exec, -1
    v_cmp_lt_i32 vcc, 16, v58
    s_mov_b64 exec, vcc
    s_cbranch_execz F_u2
    v_and_b32 v50, 0x7ff, v50
    v_lshl_add_u32 v50, v50, 5, v90
    v_add_u32 v50, 655360, v50
    v_or_b32 v51, 16, v50
    v_and_b32 v70, 0x7fffffff, v70
    v_mad_u32_u16 v2, v70, 8, v82
    v_mad_u32_u16 v3, v70, 8, v82 op_sel:[1,0,0,0]
    ds_write_b64 v2, v[50:51]
    ds_write_b64 v3, v[48:49]
F_u2:
    s_mov_b64 exec, -1
    v_cmp_lt_i32 vcc, 16, v59
    s_mov_b64 exec, vcc
    s_cbranch_execz F_u3
    v_and_b32 v54, 0x7ff, v54
    v_lshl_add_u32 v54, v54, 5, v90
    v_add_u32 v54, 983040, v54
    v_or_b32 v55, 16, v54
    v_and_b32 v71, 0x7fffffff, v71
    v_mad_u32_u16 v2, v71, 8, v83
    v_mad_u32_u16 v3, v71, 8, v83 op_sel:[1,0,0,0]
    ds_write_b64 v2, v[54:55]
    ds_write_b64 v3, v[52:53]
F_u3:
    s_mov_b64 exec, -1
    s_branch F_ur
LAST0:
    s_cmp_eq_u32 s50, 5
    s_cbranch_scc1 TO_PHASE1
    s_add_u32 s4, s4, 128
    s_addc_u32 s5, s5, 0
    s_add_u32 s8, s8, 128
    s_addc_u32 s9, s9, 0
    s_mov_b32 s34, 0
    s_mov_b32 s35, 256
    s_mov_b32 s36, 512
    s_mov_b32 s37, 768
    s_mov_b32 s33, 0
    s_add_u32 s53, s53, 4
    s_xor_b32 s66, s53, s20
    s_bitcmp1_b32 s66, 2
    s_setprio 1
    s_cbranch_scc1 PRIO_2
    s_setprio 0
PRIO_2:
    s_cmp_eq_u32 s52, 4
    s_cbranch_scc1 ITEM_0_4
    s_cmp_eq_u32 s52, 5
    s_cbranch_scc1 ITEM_0_5
    s_cmp_eq_u32 s52, 3
    s_cbranch_scc1 ITEM_0_3
    s_cmp_eq_u32 s52, 6
    s_cbranch_scc1 ITEM_0_6
    s_cmp_eq_u32 s52, 8
    s_cbranch_scc1 ITEM_0_8
    s_branch ITEM_0_2
TO_PHASE1:
    ds_read_b32 v252, v251 offset:16
    v_bfe_u32 v253, v248, 5, 1
    v_bfe_u32 v255, v248, 7, 1
    v_lshl_or_b32 v254, v255, 1, v253
    v_lshl_or_b32 v253, v255, 2, v253
    v_mul_u32_u24 v253, 1280, v253
    v_xor_b32 v254, 2, v254
    v_lshl_add_u32 v253, v254, 6, v253
    v_bfe_u32 v255, v248, 6, 1
    v_lshl_add_u32 v253, v255, 5, v253
    v_and_b32 v255, 12, v248
    v_lshl_add_u32 v253, v255, 1, v253
    v_and_b32 v255, 16, v248
    v_xor_b32 v255, 16, v255
    v_lshl_add_u32 v253, v255, 13, v253
    v_add_u32 v253, 65536, v253
    v_xor_b32 v254, 64, v253
    ds_read_b64_tr_b16 v[96:97], v253 offset:0
    ds_read_b64_tr_b16 v[98:99], v253 offset:2560
    ds_read_b64_tr_b16 v[100:101], v253 offset:10240
    ds_read_b64_tr_b16 v[102:103], v253 offset:12800
    ds_read_b64_tr_b16 v[104:105], v254 offset:0
    ds_read_b64_tr_b16 v[106:107], v254 offset:2560
    ds_read_b64_tr_b16 v[108:109], v254 offset:10240
    ds_read_b64_tr_b16 v[110:111], v254 offset:12800
    ds_read_b64_tr_b16 v[128:129], v253 offset:512
    ds_read_b64_tr_b16 v[130:131], v253 offset:3072
    ds_read_b64_tr_b16 v[132:133], v253 offset:10752
    ds_read_b64_tr_b16 v[134:135], v253 offset:13312
    ds_read_b64_tr_b16 v[136:137], v254 offset:512
    ds_read_b64_tr_b16 v[138:139], v254 offset:3072
    ds_read_b64_tr_b16 v[140:141], v254 offset:10752
    ds_read_b64_tr_b16 v[142:143], v254 offset:13312
    ds_read_b64_tr_b16 v[144:145], v253 offset:768
    ds_read_b64_tr_b16 v[146:147], v253 offset:3328
    ds_read_b64_tr_b16 v[148:149], v253 offset:11008
    ds_read_b64_tr_b16 v[150:151], v253 offset:13568
    ds_read_b64_tr_b16 v[152:153], v254 offset:768
    ds_read_b64_tr_b16 v[154:155], v254 offset:3328
    ds_read_b64_tr_b16 v[156:157], v254 offset:11008
    ds_read_b64_tr_b16 v[158:159], v254 offset:13568
    ds_read_b64_tr_b16 v[160:161], v253 offset:1024
    ds_read_b64_tr_b16 v[162:163], v253 offset:3584
    ds_read_b64_tr_b16 v[164:165], v253 offset:11264
    ds_read_b64_tr_b16 v[166:167], v253 offset:13824
    ds_read_b64_tr_b16 v[168:169], v254 offset:1024
    ds_read_b64_tr_b16 v[170:171], v254 offset:3584
    ds_read_b64_tr_b16 v[172:173], v254 offset:11264
    ds_read_b64_tr_b16 v[174:175], v254 offset:13824
    ds_read_b64_tr_b16 v[112:113], v253 offset:256
    ds_read_b64_tr_b16 v[114:115], v253 offset:2816
    ds_read_b64_tr_b16 v[116:117], v253 offset:10496
    ds_read_b64_tr_b16 v[118:119], v253 offset:13056
    ds_read_b64_tr_b16 v[120:121], v254 offset:256
    ds_read_b64_tr_b16 v[122:123], v254 offset:2816
    ds_read_b64_tr_b16 v[124:125], v254 offset:10496
    ds_read_b64_tr_b16 v[126:127], v254 offset:13056
    s_lshl_b32 s66, s20, 4
    v_xor_b32 v248, s66, v248
    s_mov_b32 s34, 128
    s_mov_b32 s35, 384
    s_mov_b32 s36, 640
    s_mov_b32 s37, 896
    s_mov_b32 s50, 0
    s_mov_b64 vcc, 0
    s_waitcnt lgkmcnt(0)
    s_waitcnt lgkmcnt(0)
    v_readfirstlane_b32 s66, v252
    s_add_u32 s53, s53, 1
    v_mov_b32 v252, s53
    s_cmp_le_u32 s53, s66
    ds_write2_b32 v251, v252, v252 offset0:0 offset1:8
    s_setprio 1
    s_cbranch_scc1 PRIO_3
    s_setprio 0
PRIO_3:
    s_cmp_eq_u32 s52, 4
    s_cbranch_scc1 ITEM_1_4
    s_cmp_eq_u32 s52, 5
    s_cbranch_scc1 ITEM_1_5
    s_cmp_eq_u32 s52, 3
    s_cbranch_scc1 ITEM_1_3
    s_cmp_eq_u32 s52, 6
    s_cbranch_scc1 ITEM_1_6
    s_cmp_eq_u32 s52, 8
    s_cbranch_scc1 ITEM_1_8
    s_branch ITEM_1_2
LAST1:
    s_cmp_eq_u32 s89, 0
    s_cbranch_scc1 T_flagsL
    s_mul_i32 s66, s20, 80
    v_min_u32 v2, 76, v248
    s_mov_b32 s67, 262144
T_pollL:
    buffer_load_dword v3, v2, s[16:19], s66 offen offset:128 sc1
    s_waitcnt vmcnt(0)
    v_cmp_ne_u32 vcc, s88, v3
    s_sub_u32 s67, s67, 1
    s_cselect_b64 vcc, 0, vcc
    s_cmp_eq_u64 vcc, 0
    s_cbranch_scc0 T_pollL
    s_mov_b32 s89, 0
T_flagsL:
    s_lshl_b32 s66, s20, 4
    v_xor_b32 v246, s66, v248
    v_lshlrev_b32 v246, 2, v246
    s_mul_i32 s51, s20, 20480
    s_add_u32 s51, s51, 1024
    s_mov_b64 vcc, -1
    s_load_dwordx2 s[72:73], s[0:1], 72
    s_waitcnt lgkmcnt(7)
    v_readfirstlane_b32 s66, v252
    s_add_u32 s53, s53, 1
    v_mov_b32 v252, s53
    s_cmp_le_u32 s53, s66
    ds_write2_b32 v251, v252, v252 offset0:0 offset1:8
    s_setprio 3
    s_cbranch_scc1 PRIO_4
    s_setprio 2
PRIO_4:
    s_cmp_eq_u32 s52, 4
    s_cbranch_scc1 ITEM_1_4
    s_cmp_eq_u32 s52, 5
    s_cbranch_scc1 ITEM_1_5
    s_cmp_eq_u32 s52, 3
    s_cbranch_scc1 ITEM_1_3
    s_cmp_eq_u32 s52, 6
    s_cbranch_scc1 ITEM_1_6
    s_cmp_eq_u32 s52, 8
    s_cbranch_scc1 ITEM_1_8
    s_branch ITEM_1_2
.p2align 6
ITEM_0_4:
    s_mov_b64 exec, s[54:55]
    ds_read_u16_d16_hi v243, v250 offset:128
    s_mov_b64 exec, -1
    ds_read_b64_tr_b16 v[80:81], v249 offset:512
    ds_read_b64_tr_b16 v[84:85], v249 offset:576
    ds_read_b64_tr_b16 v[82:83], v249 offset:768
    ds_read_b64_tr_b16 v[86:87], v249 offset:832
    s_waitcnt lgkmcnt(5)
    v_mul_f32_dpp v196, v242, v72 row_newbcast:0 row_mask:0xf bank_mask:0xf
    v_mul_f32_dpp v197, v242, v73 row_newbcast:1 row_mask:0xf bank_mask:0xf
    v_mul_f32_dpp v198, v242, v72 row_newbcast:8 row_mask:0xf bank_mask:0xf
    v_mul_f32_dpp v199, v242, v73 row_newbcast:9 row_mask:0xf bank_mask:0xf
    v_mul_f32_dpp v200, v242, v76 row_newbcast:2 row_mask:0xf bank_mask:0xf
    v_mul_f32_dpp v201, v242, v77 row_newbcast:3 row_mask:0xf bank_mask:0xf
    v_mul_f32_dpp v202, v242, v76 row_newbcast:10 row_mask:0xf bank_mask:0xf
    v_mul_f32_dpp v203, v242, v77 row_newbcast:11 row_mask:0xf bank_mask:0xf
    v_cvt_pk_bf16_f32 v72, v196, v197
    v_cvt_pk_bf16_f32 v76, v198, v199
    v_cvt_pk_bf16_f32 v73, v200, v201
    v_cvt_pk_bf16_f32 v77, v202, v203
    v_mul_f32_dpp v196, v242, v74 row_newbcast:4 row_mask:0xf bank_mask:0xf
    v_mul_f32_dpp v197, v242, v75 row_newbcast:5 row_mask:0xf bank_mask:0xf
    v_mul_f32_dpp v198, v242, v74 row_newbcast:12 row_mask:0xf bank_mask:0xf
    v_mul_f32_dpp v199, v242, v75 row_newbcast:13 row_mask:0xf bank_mask:0xf
    v_mul_f32_dpp v200, v242, v78 row_newbcast:6 row_mask:0xf bank_mask:0xf
    v_mul_f32_dpp v201, v242, v79 row_newbcast:7 row_mask:0xf bank_mask:0xf
    v_mul_f32_dpp v202, v242, v78 row_newbcast:14 row_mask:0xf bank_mask:0xf
    v_mul_f32_dpp v203, v242, v79 row_newbcast:15 row_mask:0xf bank_mask:0xf
    v_cvt_pk_bf16_f32 v74, v196, v197
    v_cvt_pk_bf16_f32 v78, v198, v199
    v_cvt_pk_bf16_f32 v75, v200, v201
    v_cvt_pk_bf16_f32 v79, v202, v203
    s_waitcnt vmcnt(4) lgkmcnt(0)
    v_mfma_f32_32x32x16_bf16 v[56:71], v[72:75], v[176:179], 0
    v_mul_f32_dpp v196, v243, v80 row_newbcast:0 row_mask:0xf bank_mask:0xf
    v_mul_f32_dpp v197, v243, v81 row_newbcast:1 row_mask:0xf bank_mask:0xf
    v_mul_f32_dpp v198, v243, v80 row_newbcast:8 row_mask:0xf bank_mask:0xf
    v_mul_f32_dpp v199, v243, v81 row_newbcast:9 row_mask:0xf bank_mask:0xf
    v_mul_f32_dpp v200, v243, v84 row_newbcast:2 row_mask:0xf bank_mask:0xf
    v_mul_f32_dpp v201, v243, v85 row_newbcast:3 row_mask:0xf bank_mask:0xf
    s_add_u32 m0, s21, 0
    v_mfma_f32_32x32x16_bf16 v[16:31], v[76:79], v[176:179], 0
    buffer_load_dwordx4 v234, s[4:7], s36 offen  lds
    buffer_load_dwordx4 v235, s[8:11], s36 offen offset:1024  lds
    ds_read_b64_tr_b16 v[176:177], v244 offset:2048
    ds_read_b64_tr_b16 v[178:179], v244 offset:3072
    ds_read_b64_tr_b16 v[184:185], v245 offset:2048
    ds_read_b64_tr_b16 v[186:187], v245 offset:3072
    v_mul_f32_dpp v202, v243, v84 row_newbcast:10 row_mask:0xf bank_mask:0xf
    v_mul_f32_dpp v203, v243, v85 row_newbcast:11 row_mask:0xf bank_mask:0xf
    v_cvt_pk_bf16_f32 v80, v196, v197
    v_cvt_pk_bf16_f32 v84, v198, v199
    v_cvt_pk_bf16_f32 v81, v200, v201
    v_cvt_pk_bf16_f32 v85, v202, v203
    v_mul_f32_dpp v196, v243, v82 row_newbcast:4 row_mask:0xf bank_mask:0xf
    v_mul_f32_dpp v197, v243, v83 row_newbcast:5 row_mask:0xf bank_mask:0xf
    v_mul_f32_dpp v198, v243, v82 row_newbcast:12 row_mask:0xf bank_mask:0xf
    v_mul_f32_dpp v199, v243, v83 row_newbcast:13 row_mask:0xf bank_mask:0xf
    v_mul_f32_dpp v200, v243, v86 row_newbcast:6 row_mask:0xf bank_mask:0xf
    v_mul_f32_dpp v201, v243, v87 row_newbcast:7 row_mask:0xf bank_mask:0xf
    v_mul_f32_dpp v202, v243, v86 row_newbcast:14 row_mask:0xf bank_mask:0xf
    v_mul_f32_dpp v203, v243, v87 row_newbcast:15 row_mask:0xf bank_mask:0xf
    v_cvt_pk_bf16_f32 v82, v196, v197
    v_cvt_pk_bf16_f32 v86, v198, v199
    v_cvt_pk_bf16_f32 v83, v200, v201
    v_cvt_pk_bf16_f32 v87, v202, v203
    s_waitcnt lgkmcnt(0)
    v_mfma_f32_32x32x16_bf16 v[56:71], v[80:83], v[176:179], v[56:71]
    s_add_u32 m0, s21, 2048
    v_mfma_f32_32x32x16_bf16 v[16:31], v[84:87], v[176:179], v[16:31]
    buffer_load_dwordx4 v236, s[4:7], s36 offen  lds
    buffer_load_dwordx4 v237, s[8:11], s36 offen offset:1024  lds
    s_mov_b32 m0, s50
    s_nop 0
    s_movrels_b32 s71, s23
    s_bfe_u32 s46, s71, 0x30012
    s_mov_b32 m0, s46
    s_and_b32 s66, s71, 0x3ffff
    s_movrels_b32 s68, s57
    s_movrels_b32 s69, s61
    s_sub_u32 s48, s66, s47
    s_mov_b32 s47, s66
    s_lshr_b32 s52, s71, 28
    s_lshl_b32 s67, s46, 9
    s_add_u32 s66, s66, s67
    s_sub_u32 s49, s66, s42
    s_mov_b32 s42, s66
    s_bfe_u32 s66, s68, 655360
    s_add_u32 s43, s42, s66
    s_bfe_u32 s39, s69, 655360
    s_bfe_u32 s66, s68, 655370
    s_add_u32 s44, s42, s66
    s_bfe_u32 s40, s69, 655370
    s_bfe_u32 s66, s68, 655380
    s_add_u32 s45, s42, s66
    s_bfe_u32 s41, s69, 655380
    s_and_b32 s66, s46, s33
    s_cselect_b32 s72, -1, 1
    s_cselect_b32 s76, s47, 163712
    s_cmp_ge_u32 s66, 2
    s_cselect_b32 s73, -1, 0
    s_add_u32 s77, s47, 1024
    s_cmp_ge_u32 s66, 4
    s_cselect_b32 s75, -1, 0
    s_cmp_ge_u32 s66, 3
    s_cselect_b32 s74, -1, 1
    s_cselect_b32 s77, s77, 163712
    v_add_u32 v252, s44, v247
    ds_read2_b32 v[238:239], v252 offset0:0 offset1:16
    v_add_u32 v252, s45, v247
    ds_read2_b32 v[240:241], v252 offset0:0 offset1:16
    v_mfma_f32_32x32x16_bf16 v[32:47], v[72:75], v[180:183], 0
    v_mul_f32 v196, v56, v96
    v_fmac_f32 v196, v57, v97
    v_fmac_f32 v196, v58, v98
    v_fmac_f32 v196, v59, v99
    v_fmac_f32 v196, v60, v100
    v_fmac_f32 v196, v61, v101
    v_mfma_f32_32x32x16_bf16 v[0:15], v[76:79], v[180:183], 0
    s_waitcnt vmcnt(6)
    ds_read_b64_tr_b16 v[176:177], v244 offset:4096
    ds_read_b64_tr_b16 v[178:179], v244 offset:5120
    ds_read_b64_tr_b16 v[180:181], v245 offset:4096
    ds_read_b64_tr_b16 v[182:183], v245 offset:5120
    v_fmac_f32 v196, v62, v102
    v_fmac_f32 v196, v63, v103
    v_mfma_f32_32x32x16_bf16 v[32:47], v[80:83], v[184:187], v[32:47]
    v_mul_f32 v198, v64, v128
    v_fmac_f32 v198, v65, v129
    v_fmac_f32 v198, v66, v130
    v_fmac_f32 v198, v67, v131
    v_fmac_f32 v198, v68, v132
    v_fmac_f32 v198, v69, v133
    v_mfma_f32_32x32x16_bf16 v[0:15], v[84:87], v[184:187], v[0:15]
    v_fmac_f32 v198, v70, v134
    v_fmac_f32 v198, v71, v135
    v_mul_f32 v200, v16, v128
    v_fmac_f32 v200, v17, v129
    v_permlane32_swap_b32 v196, v198
    v_fmac_f32 v200, v18, v130
    v_fmac_f32 v200, v19, v131
    v_fmac_f32 v200, v20, v132
    v_fmac_f32 v200, v21, v133
    v_fmac_f32 v200, v22, v134
    v_fmac_f32 v200, v23, v135
    v_add_f32 v198, v196, v198
    v_mul_f32_e64 v202, v24, -v128
    v_fma_f32 v202, v25, -v129, v202
    v_fma_f32 v202, v26, -v130, v202
    v_fma_f32 v202, v27, -v131, v202
    v_fma_f32 v202, v28, -v132, v202
    v_fma_f32 v202, v29, -v133, v202
    v_fma_f32 v202, v30, -v134, v202
    v_fma_f32 v202, v31, -v135, v202
    s_nop 1
    v_permlane32_swap_b32 v200, v202
    v_add_f32 v202, v200, v202
    s_waitcnt vmcnt(4) lgkmcnt(0)
    v_mfma_f32_32x32x16_bf16 v[56:71], v[72:75], v[176:179], 0
    v_mul_f32 v197, v32, v104
    v_fmac_f32 v197, v33, v105
    v_fmac_f32 v197, v34, v106
    v_fmac_f32 v197, v35, v107
    v_fmac_f32 v197, v36, v108
    v_fmac_f32 v197, v37, v109
    s_add_u32 m0, s21, 4096
    v_mfma_f32_32x32x16_bf16 v[16:31], v[76:79], v[176:179], 0
    buffer_load_dwordx4 v234, s[4:7], s37 offen  lds
    buffer_load_dwordx4 v235, s[8:11], s37 offen offset:1024  lds
    ds_read_b64_tr_b16 v[176:177], v244 offset:6144
    ds_read_b64_tr_b16 v[178:179], v244 offset:7168
    ds_read_b64_tr_b16 v[184:185], v245 offset:6144
    ds_read_b64_tr_b16 v[186:187], v245 offset:7168
    v_add_u32 v252, s42, v247
    ds_read2_b32 v[234:235], v252 offset0:0 offset1:16
    v_fmac_f32 v197, v38, v110
    v_fmac_f32 v197, v39, v111
    v_mul_f32 v199, v40, v136
    v_fmac_f32 v199, v41, v137
    v_fmac_f32 v199, v42, v138
    v_fmac_f32 v199, v43, v139
    v_fmac_f32 v199, v44, v140
    v_fmac_f32 v199, v45, v141
    v_fmac_f32 v199, v46, v142
    v_fmac_f32 v199, v47, v143
    v_mul_f32 v201, v0, v136
    v_fmac_f32 v201, v1, v137
    v_permlane32_swap_b32 v197, v199
    v_fmac_f32 v201, v2, v138
    v_fmac_f32 v201, v3, v139
    v_fmac_f32 v201, v4, v140
    v_fmac_f32 v201, v5, v141
    v_fmac_f32 v201, v6, v142
    v_fmac_f32 v201, v7, v143
    v_add_f32 v199, v197, v199
    v_mul_f32_e64 v203, v8, -v136
    v_fma_f32 v203, v9, -v137, v203
    v_fma_f32 v203, v10, -v138, v203
    v_fma_f32 v203, v11, -v139, v203
    s_waitcnt lgkmcnt(1)
    v_mfma_f32_32x32x16_bf16 v[56:71], v[80:83], v[176:179], v[56:71]
    v_fma_f32 v203, v12, -v140, v203
    v_fma_f32 v203, v13, -v141, v203
    v_fma_f32 v203, v14, -v142, v203
    v_fma_f32 v203, v15, -v143, v203
    s_nop 1
    v_permlane32_swap_b32 v201, v203
    v_add_f32 v203, v201, v203
    s_add_u32 m0, s21, 6144
    v_mfma_f32_32x32x16_bf16 v[16:31], v[84:87], v[176:179], v[16:31]
    buffer_load_dwordx4 v236, s[4:7], s37 offen  lds
    buffer_load_dwordx4 v237, s[8:11], s37 offen offset:1024  lds
    v_add_u32 v252, s43, v247
    ds_read2_b32 v[236:237], v252 offset0:0 offset1:16
    s_set_gpr_idx_on s51, gpr_idx(DST)
    s_nop 0
    v_cvt_pk_bf16_f32 v204, v198, v199
    v_cvt_pk_bf16_f32 v205, v202, v203
    s_set_gpr_idx_off
    v_mfma_f32_32x32x16_bf16 v[32:47], v[72:75], v[180:183], 0
    v_mul_f32 v196, v56, v144
    v_fmac_f32 v196, v57, v145
    v_fmac_f32 v196, v58, v146
    v_fmac_f32 v196, v59, v147
    v_fmac_f32 v196, v60, v148
    v_fmac_f32 v196, v61, v149
    v_mfma_f32_32x32x16_bf16 v[0:15], v[76:79], v[180:183], 0
    s_waitcnt vmcnt(6)
    ds_read_b64_tr_b16 v[176:177], v244 offset:0
    ds_read_b64_tr_b16 v[178:179], v244 offset:1024
    ds_read_b64_tr_b16 v[180:181], v245 offset:0
    ds_read_b64_tr_b16 v[182:183], v245 offset:1024
    v_fmac_f32 v196, v62, v150
    v_fmac_f32 v196, v63, v151
    v_mfma_f32_32x32x16_bf16 v[32:47], v[80:83], v[184:187], v[32:47]
    v_mul_f32_e64 v200, v16, -v160
    v_fma_f32 v200, v17, -v161, v200
    v_fma_f32 v200, v18, -v162, v200
    v_fma_f32 v200, v19, -v163, v200
    v_fma_f32 v200, v20, -v164, v200
    v_fma_f32 v200, v21, -v165, v200
    v_mfma_f32_32x32x16_bf16 v[0:15], v[84:87], v[184:187], v[0:15]
    v_fma_f32 v200, v22, -v166, v200
    v_fma_f32 v200, v23, -v167, v200
    v_mul_f32_e64 v202, v24, -v160
    v_fma_f32 v202, v25, -v161, v202
    v_fma_f32 v202, v26, -v162, v202
    v_fma_f32 v202, v27, -v163, v202
    v_fma_f32 v202, v28, -v164, v202
    v_fma_f32 v202, v29, -v165, v202
    v_fma_f32 v202, v30, -v166, v202
    v_fma_f32 v202, v31, -v167, v202
    s_waitcnt vmcnt(4) lgkmcnt(0)
    v_mfma_f32_32x32x16_bf16 v[16:31], v[72:75], v[176:179], 0
    v_mul_f32 v197, v32, v152
    v_fmac_f32 v197, v33, v153
    v_fmac_f32 v197, v34, v154
    v_fmac_f32 v197, v35, v155
    v_fmac_f32 v197, v36, v156
    v_fmac_f32 v197, v37, v157
    s_add_u32 m0, s21, 0
    v_mfma_f32_32x32x16_bf16 v[48:63], v[76:79], v[176:179], 0
    v_mad_u32_u16 v234, v234, s3, v246 op_sel:[1,0,0,0]
    v_mad_u32_u16 v235, v235, s3, v246 op_sel:[1,0,0,0]
    buffer_load_dwordx4 v234, s[4:7], s38 offen  lds
    buffer_load_dwordx4 v235, s[8:11], s38 offen offset:1024  lds
    ds_read_b64_tr_b16 v[176:177], v244 offset:2048
    ds_read_b64_tr_b16 v[178:179], v244 offset:3072
    ds_read_b64_tr_b16 v[184:185], v245 offset:2048
    ds_read_b64_tr_b16 v[186:187], v245 offset:3072
    v_fmac_f32 v197, v38, v158
    v_fmac_f32 v197, v39, v159
    v_mul_f32_e64 v201, v0, -v168
    v_fma_f32 v201, v1, -v169, v201
    v_fma_f32 v201, v2, -v170, v201
    v_fma_f32 v201, v3, -v171, v201
    v_fma_f32 v201, v4, -v172, v201
    v_fma_f32 v201, v5, -v173, v201
    v_fma_f32 v201, v6, -v174, v201
    v_fma_f32 v201, v7, -v175, v201
    s_waitcnt lgkmcnt(0)
    v_mfma_f32_32x32x16_bf16 v[16:31], v[80:83], v[176:179], v[16:31]
    v_mul_f32_e64 v203, v8, -v168
    v_fma_f32 v203, v9, -v169, v203
    v_fma_f32 v203, v10, -v170, v203
    v_fma_f32 v203, v11, -v171, v203
    v_fma_f32 v203, v12, -v172, v203
    v_fma_f32 v203, v13, -v173, v203
    s_add_u32 m0, s21, 2048
    v_mfma_f32_32x32x16_bf16 v[48:63], v[84:87], v[176:179], v[48:63]
    v_mad_u32_u16 v236, v236, s3, v246 op_sel:[1,0,0,0]
    v_mad_u32_u16 v237, v237, s3, v246 op_sel:[1,0,0,0]
    buffer_load_dwordx4 v236, s[4:7], s39 offen  lds
    buffer_load_dwordx4 v237, s[8:11], s39 offen offset:1024  lds
    v_fma_f32 v203, v14, -v174, v203
    v_fma_f32 v203, v15, -v175, v203
    v_mfma_f32_32x32x16_bf16 v[0:15], v[72:75], v[180:183], 0
    v_fmac_f32 v200, v24, v160
    v_fmac_f32 v200, v25, v161
    v_fmac_f32 v200, v26, v162
    v_fmac_f32 v200, v27, v163
    v_fmac_f32 v200, v28, v164
    v_fmac_f32 v200, v29, v165
    v_fmac_f32 v200, v30, v166
    v_fmac_f32 v200, v31, v167
    v_mfma_f32_32x32x16_bf16 v[24:39], v[76:79], v[180:183], 0
    v_add_u32 v253, s47, v248
    ds_read_b32 v192, v253
    ds_read_b32 v193, v253 offset:256
    s_waitcnt vmcnt(6)
    ds_read_b64_tr_b16 v[176:177], v244 offset:4096
    ds_read_b64_tr_b16 v[178:179], v244 offset:5120
    ds_read_b64_tr_b16 v[180:181], v245 offset:4096
    ds_read_b64_tr_b16 v[182:183], v245 offset:5120
    v_mfma_f32_32x32x16_bf16 v[24:39], v[84:87], v[184:187], v[24:39]
    v_mul_f32 v254, v16, v144
    v_fmac_f32 v254, v17, v145
    v_fmac_f32 v254, v18, v146
    v_fmac_f32 v254, v19, v147
    v_fmac_f32 v254, v20, v148
    v_fmac_f32 v254, v21, v149
    v_mfma_f32_32x32x16_bf16 v[0:15], v[80:83], v[184:187], v[0:15]
    v_fmac_f32 v254, v22, v150
    v_fmac_f32 v254, v23, v151
    v_sub_f32_e64 v64, -v48, v64
    v_sub_f32_e64 v65, -v49, v65
    v_permlane32_swap_b32 v196, v254
    v_sub_f32_e64 v66, -v50, v66
    v_sub_f32_e64 v67, -v51, v67
    v_sub_f32_e64 v68, -v52, v68
    v_sub_f32_e64 v69, -v53, v69
    v_sub_f32_e64 v70, -v54, v70
    v_sub_f32_e64 v71, -v55, v71
    v_add_f32 v254, v196, v254
    s_waitcnt vmcnt(4) lgkmcnt(0)
    v_mfma_f32_32x32x16_bf16 v[56:71], v[76:79], v[176:179], v[56:71]
    v_sub_f32_e64 v40, -v24, v40
    v_sub_f32_e64 v41, -v25, v41
    v_sub_f32_e64 v42, -v26, v42
    v_sub_f32_e64 v43, -v27, v43
    v_sub_f32_e64 v44, -v28, v44
    v_sub_f32_e64 v45, -v29, v45
    v_sub_f32_e64 v46, -v30, v46
    v_sub_f32_e64 v47, -v31, v47
    s_mov_b32 m0, s76
    s_mov_b64 exec, s[72:73]
    buffer_load_dwordx4 v192, s[12:15], 0 offen  lds
    s_mov_b32 m0, s77
    s_mov_b64 exec, s[74:75]
    buffer_load_dwordx4 v193, s[12:15], 0 offen  lds
    s_mov_b64 exec, -1
    s_add_u32 m0, s21, 4096
    v_mfma_f32_32x32x16_bf16 v[16:31], v[72:75], v[176:179], 0
    v_mad_u32_u16 v238, v238, s3, v246 op_sel:[1,0,0,0]
    v_mad_u32_u16 v239, v239, s3, v246 op_sel:[1,0,0,0]
    buffer_load_dwordx4 v238, s[4:7], s40 offen  lds
    buffer_load_dwordx4 v239, s[8:11], s40 offen offset:1024  lds
    ds_read_b64_tr_b16 v[176:177], v244 offset:6144
    ds_read_b64_tr_b16 v[178:179], v244 offset:7168
    ds_read_b64_tr_b16 v[184:185], v245 offset:6144
    ds_read_b64_tr_b16 v[186:187], v245 offset:7168
    v_mul_f32 v255, v0, v152
    v_fmac_f32 v255, v1, v153
    v_fmac_f32 v255, v2, v154
    v_fmac_f32 v255, v3, v155
    v_fmac_f32 v255, v4, v156
    v_fmac_f32 v255, v5, v157
    v_fmac_f32 v255, v6, v158
    v_fmac_f32 v255, v7, v159
    v_fmac_f32 v201, v8, v168
    v_fmac_f32 v201, v9, v169
    v_permlane32_swap_b32 v197, v255
    s_waitcnt lgkmcnt(0)
    v_mfma_f32_32x32x16_bf16 v[16:31], v[80:83], v[176:179], v[16:31]
    v_fmac_f32 v201, v10, v170
    v_fmac_f32 v201, v11, v171
    v_fmac_f32 v201, v12, v172
    v_fmac_f32 v201, v13, v173
    v_fmac_f32 v201, v14, v174
    v_fmac_f32 v201, v15, v175
    s_add_u32 m0, s21, 6144
    v_mfma_f32_32x32x16_bf16 v[56:71], v[84:87], v[176:179], v[56:71]
    v_mad_u32_u16 v240, v240, s3, v246 op_sel:[1,0,0,0]
    v_mad_u32_u16 v241, v241, s3, v246 op_sel:[1,0,0,0]
    buffer_load_dwordx4 v240, s[4:7], s41 offen  lds
    buffer_load_dwordx4 v241, s[8:11], s41 offen offset:1024  lds
    v_add_f32 v255, v197, v255
    s_set_gpr_idx_on s51, gpr_idx(DST)
    s_nop 0
    v_cvt_pk_bf16_f32 v206, v254, v255
    s_set_gpr_idx_off
    v_mfma_f32_32x32x16_bf16 v[0:15], v[72:75], v[180:183], 0
    v_mul_f32 v254, v16, v144
    v_fmac_f32 v254, v17, v145
    v_fmac_f32 v254, v18, v146
    v_fmac_f32 v254, v19, v147
    v_fmac_f32 v254, v20, v148
    v_fmac_f32 v254, v21, v149
    v_mfma_f32_32x32x16_bf16 v[32:47], v[76:79], v[180:183], v[32:47]
    s_waitcnt vmcnt(8)
    ds_read_b64_tr_b16 v[176:177], v244 offset:0
    ds_read_b64_tr_b16 v[178:179], v244 offset:1024
    ds_read_b64_tr_b16 v[180:181], v245 offset:0
    ds_read_b64_tr_b16 v[182:183], v245 offset:1024
    v_fmac_f32 v254, v22, v150
    v_fmac_f32 v254, v23, v151
    v_mfma_f32_32x32x16_bf16 v[0:15], v[80:83], v[184:187], v[0:15]
    v_fma_f32 v202, v24, -v160, v202
    v_fma_f32 v202, v25, -v161, v202
    v_permlane32_swap_b32 v254, v200
    v_fma_f32 v202, v26, -v162, v202
    v_fma_f32 v202, v27, -v163, v202
    v_fma_f32 v202, v28, -v164, v202
    v_mfma_f32_32x32x16_bf16 v[32:47], v[84:87], v[184:187], v[32:47]
    v_add_u32 v249, s48, v249
    v_add_u32 v250, s49, v250
    v_fma_f32 v202, v29, -v165, v202
    v_fma_f32 v202, v30, -v166, v202
    v_fma_f32 v202, v31, -v167, v202
    v_add_f32 v200, v254, v200
    v_mul_f32_e64 v198, v64, -v112
    v_permlane32_swap_b32 v202, v254
    v_fma_f32 v198, v65, -v113, v198
    v_fma_f32 v198, v66, -v114, v198
    v_fma_f32 v198, v67, -v115, v198
    v_fma_f32 v198, v68, -v116, v198
    v_fma_f32 v198, v69, -v117, v198
    v_fma_f32 v198, v70, -v118, v198
    v_fma_f32 v198, v71, -v119, v198
    v_add_f32 v254, v202, v254
    v_mul_f32 v196, v56, v160
    v_fmac_f32 v196, v57, v161
    v_fmac_f32 v196, v58, v162
    v_fmac_f32 v196, v59, v163
    v_fmac_f32 v196, v60, v164
    v_fmac_f32 v196, v61, v165
    v_fmac_f32 v196, v62, v166
    v_fmac_f32 v196, v63, v167
    s_nop 1
    v_permlane32_swap_b32 v198, v196
    v_add_f32 v196, v198, v196
    v_mul_f32 v255, v0, v152
    v_fmac_f32 v255, v1, v153
    v_fmac_f32 v255, v2, v154
    v_fmac_f32 v255, v3, v155
    v_fmac_f32 v255, v4, v156
    v_fmac_f32 v255, v5, v157
    v_fmac_f32 v255, v6, v158
    v_fmac_f32 v255, v7, v159
    v_fma_f32 v203, v8, -v168, v203
    v_fma_f32 v203, v9, -v169, v203
    v_permlane32_swap_b32 v255, v201
    v_fma_f32 v203, v10, -v170, v203
    v_fma_f32 v203, v11, -v171, v203
    v_fma_f32 v203, v12, -v172, v203
    v_fma_f32 v203, v13, -v173, v203
    v_fma_f32 v203, v14, -v174, v203
    v_fma_f32 v203, v15, -v175, v203
    v_add_f32 v201, v255, v201
    v_mul_f32_e64 v199, v40, -v120
    v_permlane32_swap_b32 v203, v255
    v_fma_f32 v199, v41, -v121, v199
    v_fma_f32 v199, v42, -v122, v199
    v_fma_f32 v199, v43, -v123, v199
    s_waitcnt vmcnt(4)
    ds_read_b64_tr_b16 v[72:73], v249 offset:0
    ds_read_b64_tr_b16 v[76:77], v249 offset:64
    ds_read_b64_tr_b16 v[74:75], v249 offset:256
    ds_read_b64_tr_b16 v[78:79], v249 offset:320
    s_mov_b64 exec, s[54:55]
    ds_read_u16_d16_hi v242, v250 offset:0
    s_mov_b64 exec, -1
    v_fma_f32 v199, v44, -v124, v199
    v_fma_f32 v199, v45, -v125, v199
    v_fma_f32 v199, v46, -v126, v199
    v_fma_f32 v199, v47, -v127, v199
    v_add_f32 v255, v203, v255
    v_mul_f32 v197, v32, v168
    v_fmac_f32 v197, v33, v169
    v_fmac_f32 v197, v34, v170
    v_fmac_f32 v197, v35, v171
    v_fmac_f32 v197, v36, v172
    v_fmac_f32 v197, v37, v173
    v_fmac_f32 v197, v38, v174
    v_fmac_f32 v197, v39, v175
    s_nop 1
    v_permlane32_swap_b32 v199, v197
    v_add_f32 v197, v199, v197
    s_set_gpr_idx_on s51, gpr_idx(DST)
    s_nop 0
    v_cvt_pk_bf16_f32 v207, v200, v201
    v_cvt_pk_bf16_f32 v209, v254, v255
    v_cvt_pk_bf16_f32 v208, v196, v197
    s_set_gpr_idx_off
    s_add_u32 s50, s50, 1
    s_add_u32 s51, s51, 6
    s_cmp_ge_u32 s50, 4
    s_cbranch_scc1 LAST0
    s_add_u32 s53, s53, 4
    s_xor_b32 s66, s53, s20
    s_bitcmp1_b32 s66, 2
    s_setprio 1
    s_cbranch_scc1 PRIO_5
    s_setprio 0
PRIO_5:
    s_cmp_eq_u32 s52, 4
    s_cbranch_scc1 ITEM_0_4
    s_cmp_eq_u32 s52, 5
    s_cbranch_scc1 ITEM_0_5
    s_cmp_eq_u32 s52, 3
    s_cbranch_scc1 ITEM_0_3
    s_cmp_eq_u32 s52, 6
    s_cbranch_scc1 ITEM_0_6
    s_cmp_eq_u32 s52, 8
    s_cbranch_scc1 ITEM_0_8
    s_branch ITEM_0_2
.p2align 6
ITEM_0_5:
    s_mov_b64 exec, s[54:55]
    ds_read_u16_d16_hi v243, v250 offset:128
    s_mov_b64 exec, -1
    ds_read_b64_tr_b16 v[80:81], v249 offset:512
    ds_read_b64_tr_b16 v[84:85], v249 offset:576
    ds_read_b64_tr_b16 v[82:83], v249 offset:768
    ds_read_b64_tr_b16 v[86:87], v249 offset:832
    ds_read_b64_tr_b16 v[88:89], v249 offset:1024
    ds_read_b64_tr_b16 v[92:93], v249 offset:1088
    s_waitcnt lgkmcnt(7)
    v_mul_f32_dpp v196, v242, v72 row_newbcast:0 row_mask:0xf bank_mask:0xf
    v_mul_f32_dpp v197, v242, v73 row_newbcast:1 row_mask:0xf bank_mask:0xf
    v_mul_f32_dpp v198, v242, v72 row_newbcast:8 row_mask:0xf bank_mask:0xf
    v_mul_f32_dpp v199, v242, v73 row_newbcast:9 row_mask:0xf bank_mask:0xf
    v_mul_f32_dpp v200, v242, v76 row_newbcast:2 row_mask:0xf bank_mask:0xf
    v_mul_f32_dpp v201, v242, v77 row_newbcast:3 row_mask:0xf bank_mask:0xf
    v_mul_f32_dpp v202, v242, v76 row_newbcast:10 row_mask:0xf bank_mask:0xf
    v_mul_f32_dpp v203, v242, v77 row_newbcast:11 row_mask:0xf bank_mask:0xf
    v_cvt_pk_bf16_f32 v72, v196, v197
    v_cvt_pk_bf16_f32 v76, v198, v199
    v_cvt_pk_bf16_f32 v73, v200, v201
    v_cvt_pk_bf16_f32 v77, v202, v203
    v_mul_f32_dpp v196, v242, v74 row_newbcast:4 row_mask:0xf bank_mask:0xf
    v_mul_f32_dpp v197, v242, v75 row_newbcast:5 row_mask:0xf bank_mask:0xf
    v_mul_f32_dpp v198, v242, v74 row_newbcast:12 row_mask:0xf bank_mask:0xf
    v_mul_f32_dpp v199, v242, v75 row_newbcast:13 row_mask:0xf bank_mask:0xf
    v_mul_f32_dpp v200, v242, v78 row_newbcast:6 row_mask:0xf bank_mask:0xf
    v_mul_f32_dpp v201, v242, v79 row_newbcast:7 row_mask:0xf bank_mask:0xf
    v_mul_f32_dpp v202, v242, v78 row_newbcast:14 row_mask:0xf bank_mask:0xf
    v_mul_f32_dpp v203, v242, v79 row_newbcast:15 row_mask:0xf bank_mask:0xf
    v_cvt_pk_bf16_f32 v74, v196, v197
    v_cvt_pk_bf16_f32 v78, v198, v199
    v_cvt_pk_bf16_f32 v75, v200, v201
    v_cvt_pk_bf16_f32 v79, v202, v203
    s_mov_b64 exec, s[54:55]
    ds_read_u16_d16_hi v242, v250 offset:256
    s_mov_b64 exec, -1
    s_waitcnt vmcnt(4) lgkmcnt(3)
    v_mfma_f32_32x32x16_bf16 v[56:71], v[72:75], v[176:179], 0
    v_mul_f32_dpp v196, v243, v80 row_newbcast:0 row_mask:0xf bank_mask:0xf
    v_mul_f32_dpp v197, v243, v81 row_newbcast:1 row_mask:0xf bank_mask:0xf
    v_mul_f32_dpp v198, v243, v80 row_newbcast:8 row_mask:0xf bank_mask:0xf
    v_mul_f32_dpp v199, v243, v81 row_newbcast:9 row_mask:0xf bank_mask:0xf
    v_mul_f32_dpp v200, v243, v84 row_newbcast:2 row_mask:0xf bank_mask:0xf
    v_mul_f32_dpp v201, v243, v85 row_newbcast:3 row_mask:0xf bank_mask:0xf
    s_add_u32 m0, s21, 0
    v_mfma_f32_32x32x16_bf16 v[16:31], v[76:79], v[176:179], 0
    buffer_load_dwordx4 v236, s[4:7], s35 offen  lds
    buffer_load_dwordx4 v237, s[8:11], s35 offen offset:1024  lds
    ds_read_b64_tr_b16 v[176:177], v244 offset:2048
    ds_read_b64_tr_b16 v[178:179], v244 offset:3072
    ds_read_b64_tr_b16 v[184:185], v245 offset:2048
    ds_read_b64_tr_b16 v[186:187], v245 offset:3072
    v_mul_f32_dpp v202, v243, v84 row_newbcast:10 row_mask:0xf bank_mask:0xf
    v_mul_f32_dpp v203, v243, v85 row_newbcast:11 row_mask:0xf bank_mask:0xf
    v_cvt_pk_bf16_f32 v80, v196, v197
    v_cvt_pk_bf16_f32 v84, v198, v199
    v_cvt_pk_bf16_f32 v81, v200, v201
    v_cvt_pk_bf16_f32 v85, v202, v203
    v_mul_f32_dpp v196, v243, v82 row_newbcast:4 row_mask:0xf bank_mask:0xf
    v_mul_f32_dpp v197, v243, v83 row_newbcast:5 row_mask:0xf bank_mask:0xf
    v_mul_f32_dpp v198, v243, v82 row_newbcast:12 row_mask:0xf bank_mask:0xf
    v_mul_f32_dpp v199, v243, v83 row_newbcast:13 row_mask:0xf bank_mask:0xf
    v_mul_f32_dpp v200, v243, v86 row_newbcast:6 row_mask:0xf bank_mask:0xf
    v_mul_f32_dpp v201, v243, v87 row_newbcast:7 row_mask:0xf bank_mask:0xf
    v_mul_f32_dpp v202, v243, v86 row_newbcast:14 row_mask:0xf bank_mask:0xf
    v_mul_f32_dpp v203, v243, v87 row_newbcast:15 row_mask:0xf bank_mask:0xf
    v_cvt_pk_bf16_f32 v82, v196, v197
    v_cvt_pk_bf16_f32 v86, v198, v199
    v_cvt_pk_bf16_f32 v83, v200, v201
    v_cvt_pk_bf16_f32 v87, v202, v203
    s_waitcnt vmcnt(4) lgkmcnt(0)
    v_mfma_f32_32x32x16_bf16 v[56:71], v[80:83], v[176:179], v[56:71]
    v_mul_f32_dpp v196, v242, v88 row_newbcast:0 row_mask:0xf bank_mask:0xf
    v_mul_f32_dpp v197, v242, v89 row_newbcast:1 row_mask:0xf bank_mask:0xf
    v_mul_f32_dpp v198, v242, v88 row_newbcast:8 row_mask:0xf bank_mask:0xf
    v_mul_f32_dpp v199, v242, v89 row_newbcast:9 row_mask:0xf bank_mask:0xf
    v_mul_f32_dpp v200, v242, v92 row_newbcast:2 row_mask:0xf bank_mask:0xf
    v_mul_f32_dpp v201, v242, v93 row_newbcast:3 row_mask:0xf bank_mask:0xf
    s_add_u32 m0, s21, 2048
    v_mfma_f32_32x32x16_bf16 v[16:31], v[84:87], v[176:179], v[16:31]
    buffer_load_dwordx4 v238, s[4:7], s35 offen  lds
    ds_read_b64_tr_b16 v[176:177], v244 offset:4096
    ds_read_b64_tr_b16 v[188:189], v245 offset:4096
    v_mul_f32_dpp v202, v242, v92 row_newbcast:10 row_mask:0xf bank_mask:0xf
    v_mul_f32_dpp v203, v242, v93 row_newbcast:11 row_mask:0xf bank_mask:0xf
    v_cvt_pk_bf16_f32 v88, v196, v197
    v_cvt_pk_bf16_f32 v92, v198, v199
    v_cvt_pk_bf16_f32 v89, v200, v201
    v_cvt_pk_bf16_f32 v93, v202, v203
    s_waitcnt lgkmcnt(0)
    v_mfma_f32_32x32x8_bf16 v[56:71], v[88:89], v[176:177], v[56:71]
    s_add_u32 m0, s21, 4096
    v_mfma_f32_32x32x8_bf16 v[16:31], v[92:93], v[176:177], v[16:31]
    buffer_load_dwordx4 v234, s[4:7], s36 offen  lds
    buffer_load_dwordx4 v235, s[8:11], s36 offen offset:1024  lds
    s_mov_b32 m0, s50
    s_nop 0
    s_movrels_b32 s71, s23
    s_bfe_u32 s46, s71, 0x30012
    s_mov_b32 m0, s46
    s_and_b32 s66, s71, 0x3ffff
    s_movrels_b32 s68, s57
    s_movrels_b32 s69, s61
    s_sub_u32 s48, s66, s47
    s_mov_b32 s47, s66
    s_lshr_b32 s52, s71, 28
    s_lshl_b32 s67, s46, 9
    s_add_u32 s66, s66, s67
    s_sub_u32 s49, s66, s42
    s_mov_b32 s42, s66
    s_bfe_u32 s66, s68, 655360
    s_add_u32 s43, s42, s66
    s_bfe_u32 s39, s69, 655360
    s_bfe_u32 s66, s68, 655370
    s_add_u32 s44, s42, s66
    s_bfe_u32 s40, s69, 655370
    s_bfe_u32 s66, s68, 655380
    s_add_u32 s45, s42, s66
    s_bfe_u32 s41, s69, 655380
    s_and_b32 s66, s46, s33
    s_cselect_b32 s72, -1, 1
    s_cselect_b32 s76, s47, 163712
    s_cmp_ge_u32 s66, 2
    s_cselect_b32 s73, -1, 0
    s_add_u32 s77, s47, 1024
    s_cmp_ge_u32 s66, 4
    s_cselect_b32 s75, -1, 0
    s_cmp_ge_u32 s66, 3
    s_cselect_b32 s74, -1, 1
    s_cselect_b32 s77, s77, 163712
    v_add_u32 v252, s45, v247
    ds_read2_b32 v[240:241], v252 offset0:0 offset1:16
    v_mfma_f32_32x32x16_bf16 v[32:47], v[72:75], v[180:183], 0
    v_mul_f32 v196, v56, v96
    v_fmac_f32 v196, v57, v97
    v_fmac_f32 v196, v58, v98
    v_fmac_f32 v196, v59, v99
    v_fmac_f32 v196, v60, v100
    v_fmac_f32 v196, v61, v101
    v_mfma_f32_32x32x16_bf16 v[0:15], v[76:79], v[180:183], 0
    v_fmac_f32 v196, v62, v102
    v_fmac_f32 v196, v63, v103
    v_mul_f32 v198, v64, v128
    v_fmac_f32 v198, v65, v129
    v_fmac_f32 v198, v66, v130
    v_fmac_f32 v198, v67, v131
    v_mfma_f32_32x32x16_bf16 v[32:47], v[80:83], v[184:187], v[32:47]
    v_fmac_f32 v198, v68, v132
    v_fmac_f32 v198, v69, v133
    v_fmac_f32 v198, v70, v134
    v_fmac_f32 v198, v71, v135
    v_mul_f32 v200, v16, v128
    v_fmac_f32 v200, v17, v129
    v_mfma_f32_32x32x16_bf16 v[0:15], v[84:87], v[184:187], v[0:15]
    s_waitcnt vmcnt(5)
    ds_read_b64_tr_b16 v[176:177], v244 offset:6144
    ds_read_b64_tr_b16 v[178:179], v244 offset:7168
    ds_read_b64_tr_b16 v[180:181], v245 offset:6144
    ds_read_b64_tr_b16 v[182:183], v245 offset:7168
    v_permlane32_swap_b32 v196, v198
    v_fmac_f32 v200, v18, v130
    v_mfma_f32_32x32x8_bf16 v[32:47], v[88:89], v[188:189], v[32:47]
    v_fmac_f32 v200, v19, v131
    v_fmac_f32 v200, v20, v132
    v_fmac_f32 v200, v21, v133
    v_fmac_f32 v200, v22, v134
    v_fmac_f32 v200, v23, v135
    v_add_f32 v198, v196, v198
    v_mfma_f32_32x32x8_bf16 v[0:15], v[92:93], v[188:189], v[0:15]
    v_mul_f32_e64 v202, v24, -v128
    v_fma_f32 v202, v25, -v129, v202
    v_fma_f32 v202, v26, -v130, v202
    v_fma_f32 v202, v27, -v131, v202
    v_fma_f32 v202, v28, -v132, v202
    v_fma_f32 v202, v29, -v133, v202
    v_fma_f32 v202, v30, -v134, v202
    v_fma_f32 v202, v31, -v135, v202
    s_nop 1
    v_permlane32_swap_b32 v200, v202
    v_add_f32 v202, v200, v202
    s_waitcnt vmcnt(3) lgkmcnt(0)
    v_mfma_f32_32x32x16_bf16 v[56:71], v[72:75], v[176:179], 0
    v_mul_f32 v197, v32, v104
    v_fmac_f32 v197, v33, v105
    v_fmac_f32 v197, v34, v106
    v_fmac_f32 v197, v35, v107
    v_fmac_f32 v197, v36, v108
    v_fmac_f32 v197, v37, v109
    s_add_u32 m0, s21, 6144
    v_mfma_f32_32x32x16_bf16 v[16:31], v[76:79], v[176:179], 0
    buffer_load_dwordx4 v236, s[4:7], s36 offen  lds
    buffer_load_dwordx4 v237, s[8:11], s36 offen offset:1024  lds
    ds_read_b64_tr_b16 v[176:177], v244 offset:0
    ds_read_b64_tr_b16 v[178:179], v244 offset:1024
    ds_read_b64_tr_b16 v[184:185], v245 offset:0
    ds_read_b64_tr_b16 v[186:187], v245 offset:1024
    v_fmac_f32 v197, v38, v110
    v_fmac_f32 v197, v39, v111
    v_mul_f32 v199, v40, v136
    v_fmac_f32 v199, v41, v137
    v_fmac_f32 v199, v42, v138
    v_fmac_f32 v199, v43, v139
    v_fmac_f32 v199, v44, v140
    v_fmac_f32 v199, v45, v141
    v_fmac_f32 v199, v46, v142
    v_fmac_f32 v199, v47, v143
    v_mul_f32 v201, v0, v136
    v_fmac_f32 v201, v1, v137
    v_permlane32_swap_b32 v197, v199
    v_fmac_f32 v201, v2, v138
    v_fmac_f32 v201, v3, v139
    s_waitcnt vmcnt(4) lgkmcnt(0)
    v_mfma_f32_32x32x16_bf16 v[56:71], v[80:83], v[176:179], v[56:71]
    v_fmac_f32 v201, v4, v140
    v_fmac_f32 v201, v5, v141
    v_fmac_f32 v201, v6, v142
    v_fmac_f32 v201, v7, v143
    v_add_f32 v199, v197, v199
    v_mul_f32_e64 v203, v8, -v136
    s_add_u32 m0, s21, 0
    v_mfma_f32_32x32x16_bf16 v[16:31], v[84:87], v[176:179], v[16:31]
    buffer_load_dwordx4 v238, s[4:7], s36 offen  lds
    ds_read_b64_tr_b16 v[176:177], v244 offset:2048
    ds_read_b64_tr_b16 v[188:189], v245 offset:2048
    v_fma_f32 v203, v9, -v137, v203
    v_fma_f32 v203, v10, -v138, v203
    v_fma_f32 v203, v11, -v139, v203
    s_waitcnt lgkmcnt(0)
    v_mfma_f32_32x32x8_bf16 v[56:71], v[88:89], v[176:177], v[56:71]
    v_fma_f32 v203, v12, -v140, v203
    v_fma_f32 v203, v13, -v141, v203
    v_fma_f32 v203, v14, -v142, v203
    v_fma_f32 v203, v15, -v143, v203
    s_nop 1
    v_permlane32_swap_b32 v201, v203
    v_add_f32 v203, v201, v203
    s_add_u32 m0, s21, 2048
    v_mfma_f32_32x32x8_bf16 v[16:31], v[92:93], v[176:177], v[16:31]
    buffer_load_dwordx4 v234, s[4:7], s37 offen  lds
    buffer_load_dwordx4 v235, s[8:11], s37 offen offset:1024  lds
    v_add_u32 v252, s42, v247
    ds_read2_b32 v[234:235], v252 offset0:0 offset1:16
    s_set_gpr_idx_on s51, gpr_idx(DST)
    s_nop 0
    v_cvt_pk_bf16_f32 v204, v198, v199
    v_cvt_pk_bf16_f32 v205, v202, v203
    s_set_gpr_idx_off
    v_mfma_f32_32x32x16_bf16 v[32:47], v[72:75], v[180:183], 0
    v_mul_f32 v196, v56, v144
    v_fmac_f32 v196, v57, v145
    v_fmac_f32 v196, v58, v146
    v_fmac_f32 v196, v59, v147
    v_fmac_f32 v196, v60, v148
    v_fmac_f32 v196, v61, v149
    v_mfma_f32_32x32x16_bf16 v[0:15], v[76:79], v[180:183], 0
    v_fmac_f32 v196, v62, v150
    v_fmac_f32 v196, v63, v151
    v_mul_f32_e64 v200, v16, -v160
    v_fma_f32 v200, v17, -v161, v200
    v_fma_f32 v200, v18, -v162, v200
    v_fma_f32 v200, v19, -v163, v200
    v_mfma_f32_32x32x16_bf16 v[32:47], v[80:83], v[184:187], v[32:47]
    v_fma_f32 v200, v20, -v164, v200
    v_fma_f32 v200, v21, -v165, v200
    v_fma_f32 v200, v22, -v166, v200
    v_fma_f32 v200, v23, -v167, v200
    v_mul_f32_e64 v202, v24, -v160
    v_fma_f32 v202, v25, -v161, v202
    v_mfma_f32_32x32x16_bf16 v[0:15], v[84:87], v[184:187], v[0:15]
    s_waitcnt vmcnt(5)
    ds_read_b64_tr_b16 v[176:177], v244 offset:4096
    ds_read_b64_tr_b16 v[178:179], v244 offset:5120
    ds_read_b64_tr_b16 v[180:181], v245 offset:4096
    ds_read_b64_tr_b16 v[182:183], v245 offset:5120
    v_fma_f32 v202, v26, -v162, v202
    v_fma_f32 v202, v27, -v163, v202
    v_mfma_f32_32x32x8_bf16 v[32:47], v[88:89], v[188:189], v[32:47]
    v_fma_f32 v202, v28, -v164, v202
    v_fma_f32 v202, v29, -v165, v202
    v_fma_f32 v202, v30, -v166, v202
    v_fma_f32 v202, v31, -v167, v202
    v_mfma_f32_32x32x8_bf16 v[0:15], v[92:93], v[188:189], v[0:15]
    s_waitcnt vmcnt(3) lgkmcnt(0)
    v_mfma_f32_32x32x16_bf16 v[16:31], v[72:75], v[176:179], 0
    s_nop 4
    v_mul_f32 v197, v32, v152
    v_fmac_f32 v197, v33, v153
    v_fmac_f32 v197, v34, v154
    v_fmac_f32 v197, v35, v155
    v_fmac_f32 v197, v36, v156
    v_fmac_f32 v197, v37, v157
    s_add_u32 m0, s21, 4096
    v_mfma_f32_32x32x16_bf16 v[48:63], v[76:79], v[176:179], 0
    buffer_load_dwordx4 v236, s[4:7], s37 offen  lds
    buffer_load_dwordx4 v237, s[8:11], s37 offen offset:1024  lds
    ds_read_b64_tr_b16 v[176:177], v244 offset:6144
    ds_read_b64_tr_b16 v[178:179], v244 offset:7168
    ds_read_b64_tr_b16 v[184:185], v245 offset:6144
    ds_read_b64_tr_b16 v[186:187], v245 offset:7168
    v_add_u32 v252, s43, v247
    ds_read2_b32 v[236:237], v252 offset0:0 offset1:16
    v_fmac_f32 v197, v38, v158
    v_fmac_f32 v197, v39, v159
    v_mul_f32_e64 v201, v0, -v168
    s_waitcnt vmcnt(4) lgkmcnt(1)
    v_mfma_f32_32x32x16_bf16 v[16:31], v[80:83], v[176:179], v[16:31]
    v_fma_f32 v201, v1, -v169, v201
    v_fma_f32 v201, v2, -v170, v201
    v_fma_f32 v201, v3, -v171, v201
    v_fma_f32 v201, v4, -v172, v201
    v_fma_f32 v201, v5, -v173, v201
    v_fma_f32 v201, v6, -v174, v201
    s_add_u32 m0, s21, 6144
    v_mfma_f32_32x32x16_bf16 v[48:63], v[84:87], v[176:179], v[48:63]
    buffer_load_dwordx4 v238, s[4:7], s37 offen  lds
    ds_read_b64_tr_b16 v[176:177], v244 offset:0
    ds_read_b64_tr_b16 v[188:189], v245 offset:0
    v_add_u32 v252, s44, v247
    ds_read2_b32 v[238:239], v252 offset0:0 offset1:16
    v_fma_f32 v201, v7, -v175, v201
    s_waitcnt lgkmcnt(1)
    v_mfma_f32_32x32x8_bf16 v[16:31], v[88:89], v[176:177], v[16:31]
    v_mul_f32_e64 v203, v8, -v168
    v_fma_f32 v203, v9, -v169, v203
    v_fma_f32 v203, v10, -v170, v203
    v_fma_f32 v203, v11, -v171, v203
    v_fma_f32 v203, v12, -v172, v203
    v_fma_f32 v203, v13, -v173, v203
    s_add_u32 m0, s21, 0
    v_mfma_f32_32x32x8_bf16 v[48:63], v[92:93], v[176:177], v[48:63]
    v_mad_u32_u16 v234, v234, s3, v246 op_sel:[1,0,0,0]
    v_mad_u32_u16 v235, v235, s3, v246 op_sel:[1,0,0,0]
    buffer_load_dwordx4 v234, s[4:7], s38 offen  lds
    buffer_load_dwordx4 v235, s[8:11], s38 offen offset:1024  lds
    v_fma_f32 v203, v14, -v174, v203
    v_fma_f32 v203, v15, -v175, v203
    v_mfma_f32_32x32x16_bf16 v[0:15], v[72:75], v[180:183], 0
    v_fmac_f32 v200, v24, v160
    v_fmac_f32 v200, v25, v161
    v_fmac_f32 v200, v26, v162
    v_fmac_f32 v200, v27, v163
    v_fmac_f32 v200, v28, v164
    v_fmac_f32 v200, v29, v165
    v_fmac_f32 v200, v30, v166
    v_fmac_f32 v200, v31, v167
    v_mfma_f32_32x32x16_bf16 v[24:39], v[76:79], v[180:183], 0
    v_add_u32 v253, s47, v248
    ds_read_b32 v192, v253
    ds_read_b32 v193, v253 offset:256
    v_mul_f32 v254, v16, v144
    v_fmac_f32 v254, v17, v145
    v_fmac_f32 v254, v18, v146
    v_mfma_f32_32x32x16_bf16 v[0:15], v[80:83], v[184:187], v[0:15]
    v_fmac_f32 v254, v19, v147
    v_fmac_f32 v254, v20, v148
    v_fmac_f32 v254, v21, v149
    v_fmac_f32 v254, v22, v150
    v_fmac_f32 v254, v23, v151
    v_sub_f32_e64 v64, -v48, v64
    v_mfma_f32_32x32x16_bf16 v[24:39], v[84:87], v[184:187], v[24:39]
    s_waitcnt vmcnt(5)
    ds_read_b64_tr_b16 v[176:177], v244 offset:2048
    ds_read_b64_tr_b16 v[178:179], v244 offset:3072
    ds_read_b64_tr_b16 v[180:181], v245 offset:2048
    ds_read_b64_tr_b16 v[182:183], v245 offset:3072
    v_sub_f32_e64 v65, -v49, v65
    v_permlane32_swap_b32 v196, v254
    v_mfma_f32_32x32x8_bf16 v[24:39], v[92:93], v[188:189], v[24:39]
    v_sub_f32_e64 v66, -v50, v66
    v_sub_f32_e64 v67, -v51, v67
    v_sub_f32_e64 v68, -v52, v68
    v_sub_f32_e64 v69, -v53, v69
    v_sub_f32_e64 v70, -v54, v70
    v_sub_f32_e64 v71, -v55, v71
    v_mfma_f32_32x32x8_bf16 v[0:15], v[88:89], v[188:189], v[0:15]
    v_add_f32 v254, v196, v254
    s_waitcnt vmcnt(3) lgkmcnt(0)
    v_mfma_f32_32x32x16_bf16 v[56:71], v[76:79], v[176:179], v[56:71]
    s_nop 1
    v_sub_f32_e64 v40, -v24, v40
    v_sub_f32_e64 v41, -v25, v41
    v_sub_f32_e64 v42, -v26, v42
    v_sub_f32_e64 v43, -v27, v43
    v_sub_f32_e64 v44, -v28, v44
    v_sub_f32_e64 v45, -v29, v45
    v_sub_f32_e64 v46, -v30, v46
    v_sub_f32_e64 v47, -v31, v47
    s_mov_b32 m0, s76
    s_mov_b64 exec, s[72:73]
    buffer_load_dwordx4 v192, s[12:15], 0 offen  lds
    s_mov_b32 m0, s77
    s_mov_b64 exec, s[74:75]
    buffer_load_dwordx4 v193, s[12:15], 0 offen  lds
    s_mov_b64 exec, -1
    s_add_u32 m0, s21, 2048
    v_mfma_f32_32x32x16_bf16 v[16:31], v[72:75], v[176:179], 0
    v_mad_u32_u16 v236, v236, s3, v246 op_sel:[1,0,0,0]
    v_mad_u32_u16 v237, v237, s3, v246 op_sel:[1,0,0,0]
    buffer_load_dwordx4 v236, s[4:7], s39 offen  lds
    buffer_load_dwordx4 v237, s[8:11], s39 offen offset:1024  lds
    ds_read_b64_tr_b16 v[176:177], v244 offset:4096
    ds_read_b64_tr_b16 v[178:179], v244 offset:5120
    ds_read_b64_tr_b16 v[184:185], v245 offset:4096
    ds_read_b64_tr_b16 v[186:187], v245 offset:5120
    v_mul_f32 v255, v0, v152
    v_fmac_f32 v255, v1, v153
    v_fmac_f32 v255, v2, v154
    v_fmac_f32 v255, v3, v155
    v_fmac_f32 v255, v4, v156
    s_waitcnt vmcnt(6) lgkmcnt(0)
    v_mfma_f32_32x32x16_bf16 v[16:31], v[80:83], v[176:179], v[16:31]
    v_fmac_f32 v255, v5, v157
    v_fmac_f32 v255, v6, v158
    v_fmac_f32 v255, v7, v159
    v_fmac_f32 v201, v8, v168
    v_fmac_f32 v201, v9, v169
    v_permlane32_swap_b32 v197, v255
    s_add_u32 m0, s21, 4096
    v_mfma_f32_32x32x16_bf16 v[56:71], v[84:87], v[176:179], v[56:71]
    v_mad_u32_u16 v238, v238, s3, v246 op_sel:[1,0,0,0]
    v_mad_u32_u16 v239, v239, s3, v246 op_sel:[1,0,0,0]
    buffer_load_dwordx4 v238, s[4:7], s40 offen  lds
    buffer_load_dwordx4 v239, s[8:11], s40 offen offset:1024  lds
    ds_read_b64_tr_b16 v[176:177], v244 offset:6144
    ds_read_b64_tr_b16 v[188:189], v245 offset:6144
    s_waitcnt lgkmcnt(0)
    v_mfma_f32_32x32x8_bf16 v[16:31], v[88:89], v[176:177], v[16:31]
    v_fmac_f32 v201, v10, v170
    v_fmac_f32 v201, v11, v171
    v_fmac_f32 v201, v12, v172
    v_fmac_f32 v201, v13, v173
    v_fmac_f32 v201, v14, v174
    v_fmac_f32 v201, v15, v175
    s_add_u32 m0, s21, 6144
    v_mfma_f32_32x32x8_bf16 v[56:71], v[92:93], v[176:177], v[56:71]
    v_mad_u32_u16 v240, v240, s3, v246 op_sel:[1,0,0,0]
    v_mad_u32_u16 v241, v241, s3, v246 op_sel:[1,0,0,0]
    buffer_load_dwordx4 v240, s[4:7], s41 offen  lds
    buffer_load_dwordx4 v241, s[8:11], s41 offen offset:1024  lds
    v_add_f32 v255, v197, v255
    s_set_gpr_idx_on s51, gpr_idx(DST)
    s_nop 0
    v_cvt_pk_bf16_f32 v206, v254, v255
    s_set_gpr_idx_off
    v_mfma_f32_32x32x16_bf16 v[0:15], v[72:75], v[180:183], 0
    v_mul_f32 v254, v16, v144
    v_fmac_f32 v254, v17, v145
    v_fmac_f32 v254, v18, v146
    v_fmac_f32 v254, v19, v147
    v_fmac_f32 v254, v20, v148
    v_fmac_f32 v254, v21, v149
    v_mfma_f32_32x32x16_bf16 v[32:47], v[76:79], v[180:183], v[32:47]
    v_fmac_f32 v254, v22, v150
    v_fmac_f32 v254, v23, v151
    v_fma_f32 v202, v24, -v160, v202
    v_fma_f32 v202, v25, -v161, v202
    v_permlane32_swap_b32 v254, v200
    v_fma_f32 v202, v26, -v162, v202
    v_mfma_f32_32x32x16_bf16 v[0:15], v[80:83], v[184:187], v[0:15]
    v_fma_f32 v202, v27, -v163, v202
    v_fma_f32 v202, v28, -v164, v202
    v_fma_f32 v202, v29, -v165, v202
    v_fma_f32 v202, v30, -v166, v202
    v_fma_f32 v202, v31, -v167, v202
    v_add_f32 v200, v254, v200
    v_mfma_f32_32x32x16_bf16 v[32:47], v[84:87], v[184:187], v[32:47]
    s_waitcnt vmcnt(8)
    ds_read_b64_tr_b16 v[176:177], v244 offset:0
    ds_read_b64_tr_b16 v[178:179], v244 offset:1024
    ds_read_b64_tr_b16 v[180:181], v245 offset:0
    ds_read_b64_tr_b16 v[182:183], v245 offset:1024
    v_mul_f32_e64 v198, v64, -v112
    v_permlane32_swap_b32 v202, v254
    v_mfma_f32_32x32x8_bf16 v[0:15], v[88:89], v[188:189], v[0:15]
    v_fma_f32 v198, v65, -v113, v198
    v_fma_f32 v198, v66, -v114, v198
    v_fma_f32 v198, v67, -v115, v198
    v_fma_f32 v198, v68, -v116, v198
    v_fma_f32 v198, v69, -v117, v198
    v_fma_f32 v198, v70, -v118, v198
    v_mfma_f32_32x32x8_bf16 v[32:47], v[92:93], v[188:189], v[32:47]
    v_add_u32 v249, s48, v249
    v_add_u32 v250, s49, v250
    v_fma_f32 v198, v71, -v119, v198
    v_add_f32 v254, v202, v254
    v_mul_f32 v196, v56, v160
    v_fmac_f32 v196, v57, v161
    v_fmac_f32 v196, v58, v162
    v_fmac_f32 v196, v59, v163
    v_fmac_f32 v196, v60, v164
    v_fmac_f32 v196, v61, v165
    v_fmac_f32 v196, v62, v166
    v_fmac_f32 v196, v63, v167
    s_nop 1
    v_permlane32_swap_b32 v198, v196
    v_add_f32 v196, v198, v196
    v_mul_f32 v255, v0, v152
    v_fmac_f32 v255, v1, v153
    v_fmac_f32 v255, v2, v154
    v_fmac_f32 v255, v3, v155
    v_fmac_f32 v255, v4, v156
    v_fmac_f32 v255, v5, v157
    v_fmac_f32 v255, v6, v158
    v_fmac_f32 v255, v7, v159
    v_fma_f32 v203, v8, -v168, v203
    v_fma_f32 v203, v9, -v169, v203
    v_permlane32_swap_b32 v255, v201
    v_fma_f32 v203, v10, -v170, v203
    v_fma_f32 v203, v11, -v171, v203
    v_fma_f32 v203, v12, -v172, v203
    v_fma_f32 v203, v13, -v173, v203
    v_fma_f32 v203, v14, -v174, v203
    v_fma_f32 v203, v15, -v175, v203
    v_add_f32 v201, v255, v201
    v_mul_f32_e64 v199, v40, -v120
    v_permlane32_swap_b32 v203, v255
    v_fma_f32 v199, v41, -v121, v199
    v_fma_f32 v199, v42, -v122, v199
    v_fma_f32 v199, v43, -v123, v199
    s_waitcnt vmcnt(6)
    ds_read_b64_tr_b16 v[72:73], v249 offset:0
    ds_read_b64_tr_b16 v[76:77], v249 offset:64
    ds_read_b64_tr_b16 v[74:75], v249 offset:256
    ds_read_b64_tr_b16 v[78:79], v249 offset:320
    s_mov_b64 exec, s[54:55]
    ds_read_u16_d16_hi v242, v250 offset:0
    s_mov_b64 exec, -1
    v_fma_f32 v199, v44, -v124, v199
    v_fma_f32 v199, v45, -v125, v199
    v_fma_f32 v199, v46, -v126, v199
    v_fma_f32 v199, v47, -v127, v199
    v_add_f32 v255, v203, v255
    v_mul_f32 v197, v32, v168
    v_fmac_f32 v197, v33, v169
    v_fmac_f32 v197, v34, v170
    v_fmac_f32 v197, v35, v171
    v_fmac_f32 v197, v36, v172
    v_fmac_f32 v197, v37, v173
    v_fmac_f32 v197, v38, v174
    v_fmac_f32 v197, v39, v175
    s_nop 1
    v_permlane32_swap_b32 v199, v197
    v_add_f32 v197, v199, v197
    s_set_gpr_idx_on s51, gpr_idx(DST)
    s_nop 0
    v_cvt_pk_bf16_f32 v207, v200, v201
    v_cvt_pk_bf16_f32 v209, v254, v255
    v_cvt_pk_bf16_f32 v208, v196, v197
    s_set_gpr_idx_off
    s_add_u32 s50, s50, 1
    s_add_u32 s51, s51, 6
    s_cmp_ge_u32 s50, 4
    s_cbranch_scc1 LAST0
    s_add_u32 s53, s53, 4
    s_xor_b32 s66, s53, s20
    s_bitcmp1_b32 s66, 2
    s_setprio 1
    s_cbranch_scc1 PRIO_6
    s_setprio 0
PRIO_6:
    s_cmp_eq_u32 s52, 4
    s_cbranch_scc1 ITEM_0_4
    s_cmp_eq_u32 s52, 5
    s_cbranch_scc1 ITEM_0_5
    s_cmp_eq_u32 s52, 3
    s_cbranch_scc1 ITEM_0_3
    s_cmp_eq_u32 s52, 6
    s_cbranch_scc1 ITEM_0_6
    s_cmp_eq_u32 s52, 8
    s_cbranch_scc1 ITEM_0_8
    s_branch ITEM_0_2
.p2align 6
ITEM_0_3:
    s_mov_b64 exec, s[54:55]
    ds_read_u16_d16_hi v243, v250 offset:128
    s_mov_b64 exec, -1
    ds_read_b64_tr_b16 v[80:81], v249 offset:512
    ds_read_b64_tr_b16 v[84:85], v249 offset:576
    s_waitcnt lgkmcnt(3)
    v_mul_f32_dpp v196, v242, v72 row_newbcast:0 row_mask:0xf bank_mask:0xf
    v_mul_f32_dpp v197, v242, v73 row_newbcast:1 row_mask:0xf bank_mask:0xf
    v_mul_f32_dpp v198, v242, v72 row_newbcast:8 row_mask:0xf bank_mask:0xf
    v_mul_f32_dpp v199, v242, v73 row_newbcast:9 row_mask:0xf bank_mask:0xf
    v_mul_f32_dpp v200, v242, v76 row_newbcast:2 row_mask:0xf bank_mask:0xf
    v_mul_f32_dpp v201, v242, v77 row_newbcast:3 row_mask:0xf bank_mask:0xf
    v_mul_f32_dpp v202, v242, v76 row_newbcast:10 row_mask:0xf bank_mask:0xf
    v_mul_f32_dpp v203, v242, v77 row_newbcast:11 row_mask:0xf bank_mask:0xf
    v_cvt_pk_bf16_f32 v72, v196, v197
    v_cvt_pk_bf16_f32 v76, v198, v199
    v_cvt_pk_bf16_f32 v73, v200, v201
    v_cvt_pk_bf16_f32 v77, v202, v203
    v_mul_f32_dpp v196, v242, v74 row_newbcast:4 row_mask:0xf bank_mask:0xf
    v_mul_f32_dpp v197, v242, v75 row_newbcast:5 row_mask:0xf bank_mask:0xf
    v_mul_f32_dpp v198, v242, v74 row_newbcast:12 row_mask:0xf bank_mask:0xf
    v_mul_f32_dpp v199, v242, v75 row_newbcast:13 row_mask:0xf bank_mask:0xf
    v_mul_f32_dpp v200, v242, v78 row_newbcast:6 row_mask:0xf bank_mask:0xf
    v_mul_f32_dpp v201, v242, v79 row_newbcast:7 row_mask:0xf bank_mask:0xf
    v_mul_f32_dpp v202, v242, v78 row_newbcast:14 row_mask:0xf bank_mask:0xf
    v_mul_f32_dpp v203, v242, v79 row_newbcast:15 row_mask:0xf bank_mask:0xf
    v_cvt_pk_bf16_f32 v74, v196, v197
    v_cvt_pk_bf16_f32 v78, v198, v199
    v_cvt_pk_bf16_f32 v75, v200, v201
    v_cvt_pk_bf16_f32 v79, v202, v203
    s_waitcnt vmcnt(4) lgkmcnt(0)
    v_mfma_f32_32x32x16_bf16 v[56:71], v[72:75], v[176:179], 0
    v_mul_f32_dpp v196, v243, v80 row_newbcast:0 row_mask:0xf bank_mask:0xf
    v_mul_f32_dpp v197, v243, v81 row_newbcast:1 row_mask:0xf bank_mask:0xf
    v_mul_f32_dpp v198, v243, v80 row_newbcast:8 row_mask:0xf bank_mask:0xf
    v_mul_f32_dpp v199, v243, v81 row_newbcast:9 row_mask:0xf bank_mask:0xf
    v_mul_f32_dpp v200, v243, v84 row_newbcast:2 row_mask:0xf bank_mask:0xf
    v_mul_f32_dpp v201, v243, v85 row_newbcast:3 row_mask:0xf bank_mask:0xf
    s_add_u32 m0, s21, 0
    v_mfma_f32_32x32x16_bf16 v[16:31], v[76:79], v[176:179], 0
    buffer_load_dwordx4 v234, s[4:7], s36 offen  lds
    buffer_load_dwordx4 v235, s[8:11], s36 offen offset:1024  lds
    ds_read_b64_tr_b16 v[176:177], v244 offset:2048
    ds_read_b64_tr_b16 v[184:185], v245 offset:2048
    v_mul_f32_dpp v202, v243, v84 row_newbcast:10 row_mask:0xf bank_mask:0xf
    v_mul_f32_dpp v203, v243, v85 row_newbcast:11 row_mask:0xf bank_mask:0xf
    v_cvt_pk_bf16_f32 v80, v196, v197
    v_cvt_pk_bf16_f32 v84, v198, v199
    v_cvt_pk_bf16_f32 v81, v200, v201
    v_cvt_pk_bf16_f32 v85, v202, v203
    s_waitcnt lgkmcnt(0)
    v_mfma_f32_32x32x8_bf16 v[56:71], v[80:81], v[176:177], v[56:71]
    s_add_u32 m0, s21, 2048
    v_mfma_f32_32x32x8_bf16 v[16:31], v[84:85], v[176:177], v[16:31]
    buffer_load_dwordx4 v236, s[4:7], s36 offen  lds
    s_mov_b32 m0, s50
    s_nop 0
    s_movrels_b32 s71, s23
    s_bfe_u32 s46, s71, 0x30012
    s_mov_b32 m0, s46
    s_and_b32 s66, s71, 0x3ffff
    s_movrels_b32 s68, s57
    s_movrels_b32 s69, s61
    s_sub_u32 s48, s66, s47
    s_mov_b32 s47, s66
    s_lshr_b32 s52, s71, 28
    s_lshl_b32 s67, s46, 9
    s_add_u32 s66, s66, s67
    s_sub_u32 s49, s66, s42
    s_mov_b32 s42, s66
    s_bfe_u32 s66, s68, 655360
    s_add_u32 s43, s42, s66
    s_bfe_u32 s39, s69, 655360
    s_bfe_u32 s66, s68, 655370
    s_add_u32 s44, s42, s66
    s_bfe_u32 s40, s69, 655370
    s_bfe_u32 s66, s68, 655380
    s_add_u32 s45, s42, s66
    s_bfe_u32 s41, s69, 655380
    s_and_b32 s66, s46, s33
    s_cselect_b32 s72, -1, 1
    s_cselect_b32 s76, s47, 163712
    s_cmp_ge_u32 s66, 2
    s_cselect_b32 s73, -1, 0
    s_add_u32 s77, s47, 1024
    s_cmp_ge_u32 s66, 4
    s_cselect_b32 s75, -1, 0
    s_cmp_ge_u32 s66, 3
    s_cselect_b32 s74, -1, 1
    s_cselect_b32 s77, s77, 163712
    v_add_u32 v252, s44, v247
    ds_read2_b32 v[238:239], v252 offset0:0 offset1:16
    v_add_u32 v252, s45, v247
    ds_read2_b32 v[240:241], v252 offset0:0 offset1:16
    v_mfma_f32_32x32x16_bf16 v[32:47], v[72:75], v[180:183], 0
    v_mul_f32 v196, v56, v96
    v_fmac_f32 v196, v57, v97
    v_fmac_f32 v196, v58, v98
    v_fmac_f32 v196, v59, v99
    v_fmac_f32 v196, v60, v100
    v_fmac_f32 v196, v61, v101
    v_mfma_f32_32x32x16_bf16 v[0:15], v[76:79], v[180:183], 0
    s_waitcnt vmcnt(5)
    ds_read_b64_tr_b16 v[176:177], v244 offset:4096
    ds_read_b64_tr_b16 v[178:179], v244 offset:5120
    ds_read_b64_tr_b16 v[180:181], v245 offset:4096
    ds_read_b64_tr_b16 v[182:183], v245 offset:5120
    v_fmac_f32 v196, v62, v102
    v_fmac_f32 v196, v63, v103
    v_mfma_f32_32x32x8_bf16 v[32:47], v[80:81], v[184:185], v[32:47]
    v_mul_f32 v198, v64, v128
    v_fmac_f32 v198, v65, v129
    v_fmac_f32 v198, v66, v130
    v_fmac_f32 v198, v67, v131
    v_fmac_f32 v198, v68, v132
    v_fmac_f32 v198, v69, v133
    v_mfma_f32_32x32x8_bf16 v[0:15], v[84:85], v[184:185], v[0:15]
    v_fmac_f32 v198, v70, v134
    v_fmac_f32 v198, v71, v135
    v_mul_f32 v200, v16, v128
    v_fmac_f32 v200, v17, v129
    v_permlane32_swap_b32 v196, v198
    v_fmac_f32 v200, v18, v130
    v_fmac_f32 v200, v19, v131
    v_fmac_f32 v200, v20, v132
    v_fmac_f32 v200, v21, v133
    v_fmac_f32 v200, v22, v134
    v_fmac_f32 v200, v23, v135
    v_add_f32 v198, v196, v198
    v_mul_f32_e64 v202, v24, -v128
    v_fma_f32 v202, v25, -v129, v202
    v_fma_f32 v202, v26, -v130, v202
    v_fma_f32 v202, v27, -v131, v202
    v_fma_f32 v202, v28, -v132, v202
    v_fma_f32 v202, v29, -v133, v202
    v_fma_f32 v202, v30, -v134, v202
    v_fma_f32 v202, v31, -v135, v202
    s_nop 1
    v_permlane32_swap_b32 v200, v202
    v_add_f32 v202, v200, v202
    s_waitcnt vmcnt(3) lgkmcnt(0)
    v_mfma_f32_32x32x16_bf16 v[56:71], v[72:75], v[176:179], 0
    v_mul_f32 v197, v32, v104
    v_fmac_f32 v197, v33, v105
    v_fmac_f32 v197, v34, v106
    v_fmac_f32 v197, v35, v107
    v_fmac_f32 v197, v36, v108
    v_fmac_f32 v197, v37, v109
    s_add_u32 m0, s21, 4096
    v_mfma_f32_32x32x16_bf16 v[16:31], v[76:79], v[176:179], 0
    buffer_load_dwordx4 v234, s[4:7], s37 offen  lds
    buffer_load_dwordx4 v235, s[8:11], s37 offen offset:1024  lds
    ds_read_b64_tr_b16 v[176:177], v244 offset:6144
    ds_read_b64_tr_b16 v[184:185], v245 offset:6144
    v_add_u32 v252, s42, v247
    ds_read2_b32 v[234:235], v252 offset0:0 offset1:16
    v_fmac_f32 v197, v38, v110
    v_fmac_f32 v197, v39, v111
    v_mul_f32 v199, v40, v136
    v_fmac_f32 v199, v41, v137
    v_fmac_f32 v199, v42, v138
    v_fmac_f32 v199, v43, v139
    v_fmac_f32 v199, v44, v140
    v_fmac_f32 v199, v45, v141
    v_fmac_f32 v199, v46, v142
    v_fmac_f32 v199, v47, v143
    v_mul_f32 v201, v0, v136
    v_fmac_f32 v201, v1, v137
    v_permlane32_swap_b32 v197, v199
    v_fmac_f32 v201, v2, v138
    v_fmac_f32 v201, v3, v139
    v_fmac_f32 v201, v4, v140
    v_fmac_f32 v201, v5, v141
    v_fmac_f32 v201, v6, v142
    v_fmac_f32 v201, v7, v143
    v_add_f32 v199, v197, v199
    v_mul_f32_e64 v203, v8, -v136
    v_fma_f32 v203, v9, -v137, v203
    v_fma_f32 v203, v10, -v138, v203
    s_waitcnt lgkmcnt(1)
    v_mfma_f32_32x32x8_bf16 v[56:71], v[80:81], v[176:177], v[56:71]
    v_fma_f32 v203, v11, -v139, v203
    v_fma_f32 v203, v12, -v140, v203
    v_fma_f32 v203, v13, -v141, v203
    v_fma_f32 v203, v14, -v142, v203
    v_fma_f32 v203, v15, -v143, v203
    s_nop 1
    v_permlane32_swap_b32 v201, v203
    s_add_u32 m0, s21, 6144
    v_mfma_f32_32x32x8_bf16 v[16:31], v[84:85], v[176:177], v[16:31]
    buffer_load_dwordx4 v236, s[4:7], s37 offen  lds
    v_add_u32 v252, s43, v247
    ds_read2_b32 v[236:237], v252 offset0:0 offset1:16
    v_add_f32 v203, v201, v203
    s_set_gpr_idx_on s51, gpr_idx(DST)
    s_nop 0
    v_cvt_pk_bf16_f32 v204, v198, v199
    v_cvt_pk_bf16_f32 v205, v202, v203
    s_set_gpr_idx_off
    v_mfma_f32_32x32x16_bf16 v[32:47], v[72:75], v[180:183], 0
    v_mul_f32 v196, v56, v144
    v_fmac_f32 v196, v57, v145
    v_fmac_f32 v196, v58, v146
    v_fmac_f32 v196, v59, v147
    v_fmac_f32 v196, v60, v148
    v_fmac_f32 v196, v61, v149
    v_mfma_f32_32x32x16_bf16 v[0:15], v[76:79], v[180:183], 0
    s_waitcnt vmcnt(4)
    ds_read_b64_tr_b16 v[176:177], v244 offset:0
    ds_read_b64_tr_b16 v[178:179], v244 offset:1024
    ds_read_b64_tr_b16 v[180:181], v245 offset:0
    ds_read_b64_tr_b16 v[182:183], v245 offset:1024
    v_fmac_f32 v196, v62, v150
    v_fmac_f32 v196, v63, v151
    v_mfma_f32_32x32x8_bf16 v[32:47], v[80:81], v[184:185], v[32:47]
    v_mul_f32_e64 v200, v16, -v160
    v_fma_f32 v200, v17, -v161, v200
    v_fma_f32 v200, v18, -v162, v200
    v_fma_f32 v200, v19, -v163, v200
    v_fma_f32 v200, v20, -v164, v200
    v_fma_f32 v200, v21, -v165, v200
    v_mfma_f32_32x32x8_bf16 v[0:15], v[84:85], v[184:185], v[0:15]
    v_fma_f32 v200, v22, -v166, v200
    v_fma_f32 v200, v23, -v167, v200
    v_mul_f32_e64 v202, v24, -v160
    v_fma_f32 v202, v25, -v161, v202
    v_fma_f32 v202, v26, -v162, v202
    v_fma_f32 v202, v27, -v163, v202
    v_fma_f32 v202, v28, -v164, v202
    v_fma_f32 v202, v29, -v165, v202
    v_fma_f32 v202, v30, -v166, v202
    v_fma_f32 v202, v31, -v167, v202
    s_waitcnt vmcnt(3) lgkmcnt(0)
    v_mfma_f32_32x32x16_bf16 v[16:31], v[72:75], v[176:179], 0
    v_mul_f32 v197, v32, v152
    v_fmac_f32 v197, v33, v153
    v_fmac_f32 v197, v34, v154
    v_fmac_f32 v197, v35, v155
    v_fmac_f32 v197, v36, v156
    v_fmac_f32 v197, v37, v157
    s_add_u32 m0, s21, 0
    v_mfma_f32_32x32x16_bf16 v[48:63], v[76:79], v[176:179], 0
    v_mad_u32_u16 v234, v234, s3, v246 op_sel:[1,0,0,0]
    v_mad_u32_u16 v235, v235, s3, v246 op_sel:[1,0,0,0]
    buffer_load_dwordx4 v234, s[4:7], s38 offen  lds
    buffer_load_dwordx4 v235, s[8:11], s38 offen offset:1024  lds
    ds_read_b64_tr_b16 v[176:177], v244 offset:2048
    ds_read_b64_tr_b16 v[184:185], v245 offset:2048
    v_fmac_f32 v197, v38, v158
    v_fmac_f32 v197, v39, v159
    v_mul_f32_e64 v201, v0, -v168
    v_fma_f32 v201, v1, -v169, v201
    v_fma_f32 v201, v2, -v170, v201
    v_fma_f32 v201, v3, -v171, v201
    v_fma_f32 v201, v4, -v172, v201
    v_fma_f32 v201, v5, -v173, v201
    v_fma_f32 v201, v6, -v174, v201
    v_fma_f32 v201, v7, -v175, v201
    s_waitcnt lgkmcnt(0)
    v_mfma_f32_32x32x8_bf16 v[16:31], v[80:81], v[176:177], v[16:31]
    v_mul_f32_e64 v203, v8, -v168
    v_fma_f32 v203, v9, -v169, v203
    v_fma_f32 v203, v10, -v170, v203
    v_fma_f32 v203, v11, -v171, v203
    v_fma_f32 v203, v12, -v172, v203
    v_fma_f32 v203, v13, -v173, v203
    s_add_u32 m0, s21, 2048
    v_mfma_f32_32x32x8_bf16 v[48:63], v[84:85], v[176:177], v[48:63]
    v_mad_u32_u16 v236, v236, s3, v246 op_sel:[1,0,0,0]
    v_mad_u32_u16 v237, v237, s3, v246 op_sel:[1,0,0,0]
    buffer_load_dwordx4 v236, s[4:7], s39 offen  lds
    buffer_load_dwordx4 v237, s[8:11], s39 offen offset:1024  lds
    v_fma_f32 v203, v14, -v174, v203
    v_fma_f32 v203, v15, -v175, v203
    v_mfma_f32_32x32x16_bf16 v[0:15], v[72:75], v[180:183], 0
    v_fmac_f32 v200, v24, v160
    v_fmac_f32 v200, v25, v161
    v_fmac_f32 v200, v26, v162
    v_fmac_f32 v200, v27, v163
    v_fmac_f32 v200, v28, v164
    v_fmac_f32 v200, v29, v165
    v_fmac_f32 v200, v30, v166
    v_fmac_f32 v200, v31, v167
    v_mfma_f32_32x32x16_bf16 v[24:39], v[76:79], v[180:183], 0
    v_add_u32 v253, s47, v248
    ds_read_b32 v192, v253
    ds_read_b32 v193, v253 offset:256
    s_waitcnt vmcnt(5)
    ds_read_b64_tr_b16 v[176:177], v244 offset:4096
    ds_read_b64_tr_b16 v[178:179], v244 offset:5120
    ds_read_b64_tr_b16 v[180:181], v245 offset:4096
    ds_read_b64_tr_b16 v[182:183], v245 offset:5120
    v_mfma_f32_32x32x8_bf16 v[24:39], v[84:85], v[184:185], v[24:39]
    v_mul_f32 v254, v16, v144
    v_fmac_f32 v254, v17, v145
    v_fmac_f32 v254, v18, v146
    v_fmac_f32 v254, v19, v147
    v_fmac_f32 v254, v20, v148
    v_fmac_f32 v254, v21, v149
    v_mfma_f32_32x32x8_bf16 v[0:15], v[80:81], v[184:185], v[0:15]
    v_fmac_f32 v254, v22, v150
    v_fmac_f32 v254, v23, v151
    v_sub_f32_e64 v64, -v48, v64
    v_sub_f32_e64 v65, -v49, v65
    v_permlane32_swap_b32 v196, v254
    v_sub_f32_e64 v66, -v50, v66
    v_sub_f32_e64 v67, -v51, v67
    v_sub_f32_e64 v68, -v52, v68
    v_sub_f32_e64 v69, -v53, v69
    v_sub_f32_e64 v70, -v54, v70
    v_sub_f32_e64 v71, -v55, v71
    v_add_f32 v254, v196, v254
    s_waitcnt vmcnt(4) lgkmcnt(0)
    v_mfma_f32_32x32x16_bf16 v[56:71], v[76:79], v[176:179], v[56:71]
    v_sub_f32_e64 v40, -v24, v40
    v_sub_f32_e64 v41, -v25, v41
    v_sub_f32_e64 v42, -v26, v42
    v_sub_f32_e64 v43, -v27, v43
    v_sub_f32_e64 v44, -v28, v44
    v_sub_f32_e64 v45, -v29, v45
    v_sub_f32_e64 v46, -v30, v46
    v_sub_f32_e64 v47, -v31, v47
    s_mov_b32 m0, s76
    s_mov_b64 exec, s[72:73]
    buffer_load_dwordx4 v192, s[12:15], 0 offen  lds
    s_mov_b32 m0, s77
    s_mov_b64 exec, s[74:75]
    buffer_load_dwordx4 v193, s[12:15], 0 offen  lds
    s_mov_b64 exec, -1
    s_add_u32 m0, s21, 4096
    v_mfma_f32_32x32x16_bf16 v[16:31], v[72:75], v[176:179], 0
    v_mad_u32_u16 v238, v238, s3, v246 op_sel:[1,0,0,0]
    v_mad_u32_u16 v239, v239, s3, v246 op_sel:[1,0,0,0]
    buffer_load_dwordx4 v238, s[4:7], s40 offen  lds
    buffer_load_dwordx4 v239, s[8:11], s40 offen offset:1024  lds
    ds_read_b64_tr_b16 v[176:177], v244 offset:6144
    ds_read_b64_tr_b16 v[184:185], v245 offset:6144
    v_mul_f32 v255, v0, v152
    v_fmac_f32 v255, v1, v153
    v_fmac_f32 v255, v2, v154
    v_fmac_f32 v255, v3, v155
    v_fmac_f32 v255, v4, v156
    v_fmac_f32 v255, v5, v157
    v_fmac_f32 v255, v6, v158
    v_fmac_f32 v255, v7, v159
    v_fmac_f32 v201, v8, v168
    v_fmac_f32 v201, v9, v169
    v_permlane32_swap_b32 v197, v255
    s_waitcnt lgkmcnt(0)
    v_mfma_f32_32x32x8_bf16 v[16:31], v[80:81], v[176:177], v[16:31]
    v_fmac_f32 v201, v10, v170
    v_fmac_f32 v201, v11, v171
    v_fmac_f32 v201, v12, v172
    v_fmac_f32 v201, v13, v173
    v_fmac_f32 v201, v14, v174
    v_fmac_f32 v201, v15, v175
    s_add_u32 m0, s21, 6144
    v_mfma_f32_32x32x8_bf16 v[56:71], v[84:85], v[176:177], v[56:71]
    v_mad_u32_u16 v240, v240, s3, v246 op_sel:[1,0,0,0]
    v_mad_u32_u16 v241, v241, s3, v246 op_sel:[1,0,0,0]
    buffer_load_dwordx4 v240, s[4:7], s41 offen  lds
    buffer_load_dwordx4 v241, s[8:11], s41 offen offset:1024  lds
    v_add_f32 v255, v197, v255
    s_set_gpr_idx_on s51, gpr_idx(DST)
    s_nop 0
    v_cvt_pk_bf16_f32 v206, v254, v255
    s_set_gpr_idx_off
    v_mfma_f32_32x32x16_bf16 v[0:15], v[72:75], v[180:183], 0
    v_mul_f32 v254, v16, v144
    v_fmac_f32 v254, v17, v145
    v_fmac_f32 v254, v18, v146
    v_fmac_f32 v254, v19, v147
    v_fmac_f32 v254, v20, v148
    v_fmac_f32 v254, v21, v149
    v_mfma_f32_32x32x16_bf16 v[32:47], v[76:79], v[180:183], v[32:47]
    s_waitcnt vmcnt(8)
    ds_read_b64_tr_b16 v[176:177], v244 offset:0
    ds_read_b64_tr_b16 v[178:179], v244 offset:1024
    ds_read_b64_tr_b16 v[180:181], v245 offset:0
    ds_read_b64_tr_b16 v[182:183], v245 offset:1024
    v_fmac_f32 v254, v22, v150
    v_fmac_f32 v254, v23, v151
    v_mfma_f32_32x32x8_bf16 v[0:15], v[80:81], v[184:185], v[0:15]
    v_fma_f32 v202, v24, -v160, v202
    v_fma_f32 v202, v25, -v161, v202
    v_permlane32_swap_b32 v254, v200
    v_fma_f32 v202, v26, -v162, v202
    v_fma_f32 v202, v27, -v163, v202
    v_fma_f32 v202, v28, -v164, v202
    v_mfma_f32_32x32x8_bf16 v[32:47], v[84:85], v[184:185], v[32:47]
    v_add_u32 v249, s48, v249
    v_add_u32 v250, s49, v250
    v_fma_f32 v202, v29, -v165, v202
    v_fma_f32 v202, v30, -v166, v202
    v_fma_f32 v202, v31, -v167, v202
    v_add_f32 v200, v254, v200
    v_mul_f32_e64 v198, v64, -v112
    v_permlane32_swap_b32 v202, v254
    v_fma_f32 v198, v65, -v113, v198
    v_fma_f32 v198, v66, -v114, v198
    v_fma_f32 v198, v67, -v115, v198
    v_fma_f32 v198, v68, -v116, v198
    v_fma_f32 v198, v69, -v117, v198
    v_fma_f32 v198, v70, -v118, v198
    v_fma_f32 v198, v71, -v119, v198
    v_add_f32 v254, v202, v254
    v_mul_f32 v196, v56, v160
    v_fmac_f32 v196, v57, v161
    v_fmac_f32 v196, v58, v162
    v_fmac_f32 v196, v59, v163
    v_fmac_f32 v196, v60, v164
    v_fmac_f32 v196, v61, v165
    v_fmac_f32 v196, v62, v166
    v_fmac_f32 v196, v63, v167
    s_nop 1
    v_permlane32_swap_b32 v198, v196
    v_add_f32 v196, v198, v196
    v_mul_f32 v255, v0, v152
    v_fmac_f32 v255, v1, v153
    v_fmac_f32 v255, v2, v154
    v_fmac_f32 v255, v3, v155
    v_fmac_f32 v255, v4, v156
    v_fmac_f32 v255, v5, v157
    v_fmac_f32 v255, v6, v158
    v_fmac_f32 v255, v7, v159
    v_fma_f32 v203, v8, -v168, v203
    v_fma_f32 v203, v9, -v169, v203
    v_permlane32_swap_b32 v255, v201
    v_fma_f32 v203, v10, -v170, v203
    v_fma_f32 v203, v11, -v171, v203
    v_fma_f32 v203, v12, -v172, v203
    v_fma_f32 v203, v13, -v173, v203
    v_fma_f32 v203, v14, -v174, v203
    v_fma_f32 v203, v15, -v175, v203
    v_add_f32 v201, v255, v201
    v_mul_f32_e64 v199, v40, -v120
    v_permlane32_swap_b32 v203, v255
    v_fma_f32 v199, v41, -v121, v199
    v_fma_f32 v199, v42, -v122, v199
    v_fma_f32 v199, v43, -v123, v199
    s_waitcnt vmcnt(4)
    ds_read_b64_tr_b16 v[72:73], v249 offset:0
    ds_read_b64_tr_b16 v[76:77], v249 offset:64
    ds_read_b64_tr_b16 v[74:75], v249 offset:256
    ds_read_b64_tr_b16 v[78:79], v249 offset:320
    s_mov_b64 exec, s[54:55]
    ds_read_u16_d16_hi v242, v250 offset:0
    s_mov_b64 exec, -1
    v_fma_f32 v199, v44, -v124, v199
    v_fma_f32 v199, v45, -v125, v199
    v_fma_f32 v199, v46, -v126, v199
    v_fma_f32 v199, v47, -v127, v199
    v_add_f32 v255, v203, v255
    v_mul_f32 v197, v32, v168
    v_fmac_f32 v197, v33, v169
    v_fmac_f32 v197, v34, v170
    v_fmac_f32 v197, v35, v171
    v_fmac_f32 v197, v36, v172
    v_fmac_f32 v197, v37, v173
    v_fmac_f32 v197, v38, v174
    v_fmac_f32 v197, v39, v175
    s_nop 1
    v_permlane32_swap_b32 v199, v197
    v_add_f32 v197, v199, v197
    s_set_gpr_idx_on s51, gpr_idx(DST)
    s_nop 0
    v_cvt_pk_bf16_f32 v207, v200, v201
    v_cvt_pk_bf16_f32 v209, v254, v255
    v_cvt_pk_bf16_f32 v208, v196, v197
    s_set_gpr_idx_off
    s_add_u32 s50, s50, 1
    s_add_u32 s51, s51, 6
    s_cmp_ge_u32 s50, 4
    s_cbranch_scc1 LAST0
    s_add_u32 s53, s53, 4
    s_xor_b32 s66, s53, s20
    s_bitcmp1_b32 s66, 2
    s_setprio 1
    s_cbranch_scc1 PRIO_7
    s_setprio 0
PRIO_7:
    s_cmp_eq_u32 s52, 4
    s_cbranch_scc1 ITEM_0_4
    s_cmp_eq_u32 s52, 5
    s_cbranch_scc1 ITEM_0_5
    s_cmp_eq_u32 s52, 3
    s_cbranch_scc1 ITEM_0_3
    s_cmp_eq_u32 s52, 6
    s_cbranch_scc1 ITEM_0_6
    s_cmp_eq_u32 s52, 8
    s_cbranch_scc1 ITEM_0_8
    s_branch ITEM_0_2
.p2align 6
ITEM_0_6:
    s_mov_b64 exec, s[54:55]
    ds_read_u16_d16_hi v243, v250 offset:128
    s_mov_b64 exec, -1
    ds_read_b64_tr_b16 v[80:81], v249 offset:512
    ds_read_b64_tr_b16 v[84:85], v249 offset:576
    ds_read_b64_tr_b16 v[82:83], v249 offset:768
    ds_read_b64_tr_b16 v[86:87], v249 offset:832
    ds_read_b64_tr_b16 v[88:89], v249 offset:1024
    ds_read_b64_tr_b16 v[92:93], v249 offset:1088
    ds_read_b64_tr_b16 v[90:91], v249 offset:1280
    ds_read_b64_tr_b16 v[94:95], v249 offset:1344
    s_waitcnt lgkmcnt(9)
    v_mul_f32_dpp v196, v242, v72 row_newbcast:0 row_mask:0xf bank_mask:0xf
    v_mul_f32_dpp v197, v242, v73 row_newbcast:1 row_mask:0xf bank_mask:0xf
    v_mul_f32_dpp v198, v242, v72 row_newbcast:8 row_mask:0xf bank_mask:0xf
    v_mul_f32_dpp v199, v242, v73 row_newbcast:9 row_mask:0xf bank_mask:0xf
    v_mul_f32_dpp v200, v242, v76 row_newbcast:2 row_mask:0xf bank_mask:0xf
    v_mul_f32_dpp v201, v242, v77 row_newbcast:3 row_mask:0xf bank_mask:0xf
    v_mul_f32_dpp v202, v242, v76 row_newbcast:10 row_mask:0xf bank_mask:0xf
    v_mul_f32_dpp v203, v242, v77 row_newbcast:11 row_mask:0xf bank_mask:0xf
    v_cvt_pk_bf16_f32 v72, v196, v197
    v_cvt_pk_bf16_f32 v76, v198, v199
    v_cvt_pk_bf16_f32 v73, v200, v201
    v_cvt_pk_bf16_f32 v77, v202, v203
    v_mul_f32_dpp v196, v242, v74 row_newbcast:4 row_mask:0xf bank_mask:0xf
    v_mul_f32_dpp v197, v242, v75 row_newbcast:5 row_mask:0xf bank_mask:0xf
    v_mul_f32_dpp v198, v242, v74 row_newbcast:12 row_mask:0xf bank_mask:0xf
    v_mul_f32_dpp v199, v242, v75 row_newbcast:13 row_mask:0xf bank_mask:0xf
    v_mul_f32_dpp v200, v242, v78 row_newbcast:6 row_mask:0xf bank_mask:0xf
    v_mul_f32_dpp v201, v242, v79 row_newbcast:7 row_mask:0xf bank_mask:0xf
    v_mul_f32_dpp v202, v242, v78 row_newbcast:14 row_mask:0xf bank_mask:0xf
    v_mul_f32_dpp v203, v242, v79 row_newbcast:15 row_mask:0xf bank_mask:0xf
    v_cvt_pk_bf16_f32 v74, v196, v197
    v_cvt_pk_bf16_f32 v78, v198, v199
    v_cvt_pk_bf16_f32 v75, v200, v201
    v_cvt_pk_bf16_f32 v79, v202, v203
    s_mov_b64 exec, s[54:55]
    ds_read_u16_d16_hi v242, v250 offset:256
    s_mov_b64 exec, -1
    s_waitcnt vmcnt(4) lgkmcnt(5)
    v_mfma_f32_32x32x16_bf16 v[56:71], v[72:75], v[176:179], 0
    v_mul_f32_dpp v196, v243, v80 row_newbcast:0 row_mask:0xf bank_mask:0xf
    v_mul_f32_dpp v197, v243, v81 row_newbcast:1 row_mask:0xf bank_mask:0xf
    v_mul_f32_dpp v198, v243, v80 row_newbcast:8 row_mask:0xf bank_mask:0xf
    v_mul_f32_dpp v199, v243, v81 row_newbcast:9 row_mask:0xf bank_mask:0xf
    v_mul_f32_dpp v200, v243, v84 row_newbcast:2 row_mask:0xf bank_mask:0xf
    v_mul_f32_dpp v201, v243, v85 row_newbcast:3 row_mask:0xf bank_mask:0xf
    s_add_u32 m0, s21, 0
    v_mfma_f32_32x32x16_bf16 v[16:31], v[76:79], v[176:179], 0
    buffer_load_dwordx4 v236, s[4:7], s35 offen  lds
    buffer_load_dwordx4 v237, s[8:11], s35 offen offset:1024  lds
    ds_read_b64_tr_b16 v[176:177], v244 offset:2048
    ds_read_b64_tr_b16 v[178:179], v244 offset:3072
    ds_read_b64_tr_b16 v[184:185], v245 offset:2048
    ds_read_b64_tr_b16 v[186:187], v245 offset:3072
    v_mul_f32_dpp v202, v243, v84 row_newbcast:10 row_mask:0xf bank_mask:0xf
    v_mul_f32_dpp v203, v243, v85 row_newbcast:11 row_mask:0xf bank_mask:0xf
    v_cvt_pk_bf16_f32 v80, v196, v197
    v_cvt_pk_bf16_f32 v84, v198, v199
    v_cvt_pk_bf16_f32 v81, v200, v201
    v_cvt_pk_bf16_f32 v85, v202, v203
    v_mul_f32_dpp v196, v243, v82 row_newbcast:4 row_mask:0xf bank_mask:0xf
    v_mul_f32_dpp v197, v243, v83 row_newbcast:5 row_mask:0xf bank_mask:0xf
    v_mul_f32_dpp v198, v243, v82 row_newbcast:12 row_mask:0xf bank_mask:0xf
    v_mul_f32_dpp v199, v243, v83 row_newbcast:13 row_mask:0xf bank_mask:0xf
    v_mul_f32_dpp v200, v243, v86 row_newbcast:6 row_mask:0xf bank_mask:0xf
    v_mul_f32_dpp v201, v243, v87 row_newbcast:7 row_mask:0xf bank_mask:0xf
    v_mul_f32_dpp v202, v243, v86 row_newbcast:14 row_mask:0xf bank_mask:0xf
    v_mul_f32_dpp v203, v243, v87 row_newbcast:15 row_mask:0xf bank_mask:0xf
    v_cvt_pk_bf16_f32 v82, v196, v197
    v_cvt_pk_bf16_f32 v86, v198, v199
    v_cvt_pk_bf16_f32 v83, v200, v201
    v_cvt_pk_bf16_f32 v87, v202, v203
    s_waitcnt vmcnt(4) lgkmcnt(0)
    v_mfma_f32_32x32x16_bf16 v[56:71], v[80:83], v[176:179], v[56:71]
    v_mul_f32_dpp v196, v242, v88 row_newbcast:0 row_mask:0xf bank_mask:0xf
    v_mul_f32_dpp v197, v242, v89 row_newbcast:1 row_mask:0xf bank_mask:0xf
    v_mul_f32_dpp v198, v242, v88 row_newbcast:8 row_mask:0xf bank_mask:0xf
    v_mul_f32_dpp v199, v242, v89 row_newbcast:9 row_mask:0xf bank_mask:0xf
    v_mul_f32_dpp v200, v242, v92 row_newbcast:2 row_mask:0xf bank_mask:0xf
    v_mul_f32_dpp v201, v242, v93 row_newbcast:3 row_mask:0xf bank_mask:0xf
    s_add_u32 m0, s21, 2048
    v_mfma_f32_32x32x16_bf16 v[16:31], v[84:87], v[176:179], v[16:31]
    buffer_load_dwordx4 v238, s[4:7], s35 offen  lds
    buffer_load_dwordx4 v239, s[8:11], s35 offen offset:1024  lds
    ds_read_b64_tr_b16 v[176:177], v244 offset:4096
    ds_read_b64_tr_b16 v[178:179], v244 offset:5120
    ds_read_b64_tr_b16 v[188:189], v245 offset:4096
    ds_read_b64_tr_b16 v[190:191], v245 offset:5120
    v_mul_f32_dpp v202, v242, v92 row_newbcast:10 row_mask:0xf bank_mask:0xf
    v_mul_f32_dpp v203, v242, v93 row_newbcast:11 row_mask:0xf bank_mask:0xf
    v_cvt_pk_bf16_f32 v88, v196, v197
    v_cvt_pk_bf16_f32 v92, v198, v199
    v_cvt_pk_bf16_f32 v89, v200, v201
    v_cvt_pk_bf16_f32 v93, v202, v203
    v_mul_f32_dpp v196, v242, v90 row_newbcast:4 row_mask:0xf bank_mask:0xf
    v_mul_f32_dpp v197, v242, v91 row_newbcast:5 row_mask:0xf bank_mask:0xf
    v_mul_f32_dpp v198, v242, v90 row_newbcast:12 row_mask:0xf bank_mask:0xf
    v_mul_f32_dpp v199, v242, v91 row_newbcast:13 row_mask:0xf bank_mask:0xf
    v_mul_f32_dpp v200, v242, v94 row_newbcast:6 row_mask:0xf bank_mask:0xf
    v_mul_f32_dpp v201, v242, v95 row_newbcast:7 row_mask:0xf bank_mask:0xf
    v_mul_f32_dpp v202, v242, v94 row_newbcast:14 row_mask:0xf bank_mask:0xf
    v_mul_f32_dpp v203, v242, v95 row_newbcast:15 row_mask:0xf bank_mask:0xf
    v_cvt_pk_bf16_f32 v90, v196, v197
    v_cvt_pk_bf16_f32 v94, v198, v199
    v_cvt_pk_bf16_f32 v91, v200, v201
    v_cvt_pk_bf16_f32 v95, v202, v203
    s_waitcnt lgkmcnt(0)
    v_mfma_f32_32x32x16_bf16 v[56:71], v[88:91], v[176:179], v[56:71]
    s_add_u32 m0, s21, 4096
    v_mfma_f32_32x32x16_bf16 v[16:31], v[92:95], v[176:179], v[16:31]
    buffer_load_dwordx4 v234, s[4:7], s36 offen  lds
    buffer_load_dwordx4 v235, s[8:11], s36 offen offset:1024  lds
    s_mov_b32 m0, s50
    s_nop 0
    s_movrels_b32 s71, s23
    s_bfe_u32 s46, s71, 0x30012
    s_mov_b32 m0, s46
    s_and_b32 s66, s71, 0x3ffff
    s_movrels_b32 s68, s57
    s_movrels_b32 s69, s61
    s_sub_u32 s48, s66, s47
    s_mov_b32 s47, s66
    s_lshr_b32 s52, s71, 28
    s_lshl_b32 s67, s46, 9
    s_add_u32 s66, s66, s67
    s_sub_u32 s49, s66, s42
    s_mov_b32 s42, s66
    s_bfe_u32 s66, s68, 655360
    s_add_u32 s43, s42, s66
    s_bfe_u32 s39, s69, 655360
    s_bfe_u32 s66, s68, 655370
    s_add_u32 s44, s42, s66
    s_bfe_u32 s40, s69, 655370
    s_bfe_u32 s66, s68, 655380
    s_add_u32 s45, s42, s66
    s_bfe_u32 s41, s69, 655380
    s_and_b32 s66, s46, s33
    s_cselect_b32 s72, -1, 1
    s_cselect_b32 s76, s47, 163712
    s_cmp_ge_u32 s66, 2
    s_cselect_b32 s73, -1, 0
    s_add_u32 s77, s47, 1024
    s_cmp_ge_u32 s66, 4
    s_cselect_b32 s75, -1, 0
    s_cmp_ge_u32 s66, 3
    s_cselect_b32 s74, -1, 1
    s_cselect_b32 s77, s77, 163712
    v_add_u32 v252, s45, v247
    ds_read2_b32 v[240:241], v252 offset0:0 offset1:16
    v_mfma_f32_32x32x16_bf16 v[32:47], v[72:75], v[180:183], 0
    v_mul_f32 v196, v56, v96
    v_fmac_f32 v196, v57, v97
    v_fmac_f32 v196, v58, v98
    v_fmac_f32 v196, v59, v99
    v_fmac_f32 v196, v60, v100
    v_fmac_f32 v196, v61, v101
    v_mfma_f32_32x32x16_bf16 v[0:15], v[76:79], v[180:183], 0
    v_fmac_f32 v196, v62, v102
    v_fmac_f32 v196, v63, v103
    v_mul_f32 v198, v64, v128
    v_fmac_f32 v198, v65, v129
    v_fmac_f32 v198, v66, v130
    v_fmac_f32 v198, v67, v131
    v_mfma_f32_32x32x16_bf16 v[32:47], v[80:83], v[184:187], v[32:47]
    v_fmac_f32 v198, v68, v132
    v_fmac_f32 v198, v69, v133
    v_fmac_f32 v198, v70, v134
    v_fmac_f32 v198, v71, v135
    v_mul_f32 v200, v16, v128
    v_fmac_f32 v200, v17, v129
    v_mfma_f32_32x32x16_bf16 v[0:15], v[84:87], v[184:187], v[0:15]
    s_waitcnt vmcnt(6)
    ds_read_b64_tr_b16 v[176:177], v244 offset:6144
    ds_read_b64_tr_b16 v[178:179], v244 offset:7168
    ds_read_b64_tr_b16 v[180:181], v245 offset:6144
    ds_read_b64_tr_b16 v[182:183], v245 offset:7168
    v_permlane32_swap_b32 v196, v198
    v_fmac_f32 v200, v18, v130
    v_mfma_f32_32x32x16_bf16 v[32:47], v[88:91], v[188:191], v[32:47]
    v_fmac_f32 v200, v19, v131
    v_fmac_f32 v200, v20, v132
    v_fmac_f32 v200, v21, v133
    v_fmac_f32 v200, v22, v134
    v_fmac_f32 v200, v23, v135
    v_add_f32 v198, v196, v198
    v_mfma_f32_32x32x16_bf16 v[0:15], v[92:95], v[188:191], v[0:15]
    v_mul_f32_e64 v202, v24, -v128
    v_fma_f32 v202, v25, -v129, v202
    v_fma_f32 v202, v26, -v130, v202
    v_fma_f32 v202, v27, -v131, v202
    v_fma_f32 v202, v28, -v132, v202
    v_fma_f32 v202, v29, -v133, v202
    v_fma_f32 v202, v30, -v134, v202
    v_fma_f32 v202, v31, -v135, v202
    s_nop 1
    v_permlane32_swap_b32 v200, v202
    v_add_f32 v202, v200, v202
    s_waitcnt vmcnt(4) lgkmcnt(0)
    v_mfma_f32_32x32x16_bf16 v[56:71], v[72:75], v[176:179], 0
    v_mul_f32 v197, v32, v104
    v_fmac_f32 v197, v33, v105
    v_fmac_f32 v197, v34, v106
    v_fmac_f32 v197, v35, v107
    v_fmac_f32 v197, v36, v108
    v_fmac_f32 v197, v37, v109
    s_add_u32 m0, s21, 6144
    v_mfma_f32_32x32x16_bf16 v[16:31], v[76:79], v[176:179], 0
    buffer_load_dwordx4 v236, s[4:7], s36 offen  lds
    buffer_load_dwordx4 v237, s[8:11], s36 offen offset:1024  lds
    ds_read_b64_tr_b16 v[176:177], v244 offset:0
    ds_read_b64_tr_b16 v[178:179], v244 offset:1024
    ds_read_b64_tr_b16 v[184:185], v245 offset:0
    ds_read_b64_tr_b16 v[186:187], v245 offset:1024
    v_fmac_f32 v197, v38, v110
    v_fmac_f32 v197, v39, v111
    v_mul_f32 v199, v40, v136
    v_fmac_f32 v199, v41, v137
    v_fmac_f32 v199, v42, v138
    v_fmac_f32 v199, v43, v139
    v_fmac_f32 v199, v44, v140
    v_fmac_f32 v199, v45, v141
    v_fmac_f32 v199, v46, v142
    v_fmac_f32 v199, v47, v143
    v_mul_f32 v201, v0, v136
    v_fmac_f32 v201, v1, v137
    v_permlane32_swap_b32 v197, v199
    v_fmac_f32 v201, v2, v138
    v_fmac_f32 v201, v3, v139
    v_fmac_f32 v201, v4, v140
    v_fmac_f32 v201, v5, v141
    v_fmac_f32 v201, v6, v142
    s_waitcnt vmcnt(4) lgkmcnt(0)
    v_mfma_f32_32x32x16_bf16 v[56:71], v[80:83], v[176:179], v[56:71]
    v_fmac_f32 v201, v7, v143
    v_add_f32 v199, v197, v199
    v_mul_f32_e64 v203, v8, -v136
    v_fma_f32 v203, v9, -v137, v203
    v_fma_f32 v203, v10, -v138, v203
    v_fma_f32 v203, v11, -v139, v203
    s_add_u32 m0, s21, 0
    v_mfma_f32_32x32x16_bf16 v[16:31], v[84:87], v[176:179], v[16:31]
    buffer_load_dwordx4 v238, s[4:7], s36 offen  lds
    buffer_load_dwordx4 v239, s[8:11], s36 offen offset:1024  lds
    ds_read_b64_tr_b16 v[176:177], v244 offset:2048
    ds_read_b64_tr_b16 v[178:179], v244 offset:3072
    ds_read_b64_tr_b16 v[188:189], v245 offset:2048
    ds_read_b64_tr_b16 v[190:191], v245 offset:3072
    s_waitcnt lgkmcnt(0)
    v_mfma_f32_32x32x16_bf16 v[56:71], v[88:91], v[176:179], v[56:71]
    v_fma_f32 v203, v12, -v140, v203
    v_fma_f32 v203, v13, -v141, v203
    v_fma_f32 v203, v14, -v142, v203
    v_fma_f32 v203, v15, -v143, v203
    s_nop 1
    v_permlane32_swap_b32 v201, v203
    v_add_f32 v203, v201, v203
    s_add_u32 m0, s21, 2048
    v_mfma_f32_32x32x16_bf16 v[16:31], v[92:95], v[176:179], v[16:31]
    buffer_load_dwordx4 v234, s[4:7], s37 offen  lds
    buffer_load_dwordx4 v235, s[8:11], s37 offen offset:1024  lds
    v_add_u32 v252, s42, v247
    ds_read2_b32 v[234:235], v252 offset0:0 offset1:16
    s_set_gpr_idx_on s51, gpr_idx(DST)
    s_nop 0
    v_cvt_pk_bf16_f32 v204, v198, v199
    v_cvt_pk_bf16_f32 v205, v202, v203
    s_set_gpr_idx_off
    v_mfma_f32_32x32x16_bf16 v[32:47], v[72:75], v[180:183], 0
    v_mul_f32 v196, v56, v144
    v_fmac_f32 v196, v57, v145
    v_fmac_f32 v196, v58, v146
    v_fmac_f32 v196, v59, v147
    v_fmac_f32 v196, v60, v148
    v_fmac_f32 v196, v61, v149
    v_mfma_f32_32x32x16_bf16 v[0:15], v[76:79], v[180:183], 0
    v_fmac_f32 v196, v62, v150
    v_fmac_f32 v196, v63, v151
    v_mul_f32_e64 v200, v16, -v160
    v_fma_f32 v200, v17, -v161, v200
    v_fma_f32 v200, v18, -v162, v200
    v_fma_f32 v200, v19, -v163, v200
    v_mfma_f32_32x32x16_bf16 v[32:47], v[80:83], v[184:187], v[32:47]
    v_fma_f32 v200, v20, -v164, v200
    v_fma_f32 v200, v21, -v165, v200
    v_fma_f32 v200, v22, -v166, v200
    v_fma_f32 v200, v23, -v167, v200
    v_mul_f32_e64 v202, v24, -v160
    v_fma_f32 v202, v25, -v161, v202
    v_mfma_f32_32x32x16_bf16 v[0:15], v[84:87], v[184:187], v[0:15]
    s_waitcnt vmcnt(6)
    ds_read_b64_tr_b16 v[176:177], v244 offset:4096
    ds_read_b64_tr_b16 v[178:179], v244 offset:5120
    ds_read_b64_tr_b16 v[180:181], v245 offset:4096
    ds_read_b64_tr_b16 v[182:183], v245 offset:5120
    v_fma_f32 v202, v26, -v162, v202
    v_fma_f32 v202, v27, -v163, v202
    v_mfma_f32_32x32x16_bf16 v[32:47], v[88:91], v[188:191], v[32:47]
    v_fma_f32 v202, v28, -v164, v202
    v_fma_f32 v202, v29, -v165, v202
    v_fma_f32 v202, v30, -v166, v202
    v_fma_f32 v202, v31, -v167, v202
    v_mfma_f32_32x32x16_bf16 v[0:15], v[92:95], v[188:191], v[0:15]
    s_waitcnt vmcnt(4) lgkmcnt(0)
    v_mfma_f32_32x32x16_bf16 v[16:31], v[72:75], v[176:179], 0
    s_nop 4
    v_mul_f32 v197, v32, v152
    v_fmac_f32 v197, v33, v153
    v_fmac_f32 v197, v34, v154
    v_fmac_f32 v197, v35, v155
    v_fmac_f32 v197, v36, v156
    v_fmac_f32 v197, v37, v157
    s_add_u32 m0, s21, 4096
    v_mfma_f32_32x32x16_bf16 v[48:63], v[76:79], v[176:179], 0
    buffer_load_dwordx4 v236, s[4:7], s37 offen  lds
    buffer_load_dwordx4 v237, s[8:11], s37 offen offset:1024  lds
    ds_read_b64_tr_b16 v[176:177], v244 offset:6144
    ds_read_b64_tr_b16 v[178:179], v244 offset:7168
    ds_read_b64_tr_b16 v[184:185], v245 offset:6144
    ds_read_b64_tr_b16 v[186:187], v245 offset:7168
    v_add_u32 v252, s43, v247
    ds_read2_b32 v[236:237], v252 offset0:0 offset1:16
    v_fmac_f32 v197, v38, v158
    v_fmac_f32 v197, v39, v159
    v_mul_f32_e64 v201, v0, -v168
    v_fma_f32 v201, v1, -v169, v201
    s_waitcnt vmcnt(4) lgkmcnt(1)
    v_mfma_f32_32x32x16_bf16 v[16:31], v[80:83], v[176:179], v[16:31]
    v_fma_f32 v201, v2, -v170, v201
    v_fma_f32 v201, v3, -v171, v201
    v_fma_f32 v201, v4, -v172, v201
    v_fma_f32 v201, v5, -v173, v201
    v_fma_f32 v201, v6, -v174, v201
    v_fma_f32 v201, v7, -v175, v201
    s_add_u32 m0, s21, 6144
    v_mfma_f32_32x32x16_bf16 v[48:63], v[84:87], v[176:179], v[48:63]
    buffer_load_dwordx4 v238, s[4:7], s37 offen  lds
    buffer_load_dwordx4 v239, s[8:11], s37 offen offset:1024  lds
    ds_read_b64_tr_b16 v[176:177], v244 offset:0
    ds_read_b64_tr_b16 v[178:179], v244 offset:1024
    ds_read_b64_tr_b16 v[188:189], v245 offset:0
    ds_read_b64_tr_b16 v[190:191], v245 offset:1024
    v_add_u32 v252, s44, v247
    ds_read2_b32 v[238:239], v252 offset0:0 offset1:16
    s_waitcnt lgkmcnt(1)
    v_mfma_f32_32x32x16_bf16 v[16:31], v[88:91], v[176:179], v[16:31]
    v_mul_f32_e64 v203, v8, -v168
    v_fma_f32 v203, v9, -v169, v203
    v_fma_f32 v203, v10, -v170, v203
    v_fma_f32 v203, v11, -v171, v203
    v_fma_f32 v203, v12, -v172, v203
    v_fma_f32 v203, v13, -v173, v203
    s_add_u32 m0, s21, 0
    v_mfma_f32_32x32x16_bf16 v[48:63], v[92:95], v[176:179], v[48:63]
    v_mad_u32_u16 v234, v234, s3, v246 op_sel:[1,0,0,0]
    v_mad_u32_u16 v235, v235, s3, v246 op_sel:[1,0,0,0]
    buffer_load_dwordx4 v234, s[4:7], s38 offen  lds
    buffer_load_dwordx4 v235, s[8:11], s38 offen offset:1024  lds
    v_fma_f32 v203, v14, -v174, v203
    v_fma_f32 v203, v15, -v175, v203
    v_mfma_f32_32x32x16_bf16 v[0:15], v[72:75], v[180:183], 0
    v_fmac_f32 v200, v24, v160
    v_fmac_f32 v200, v25, v161
    v_fmac_f32 v200, v26, v162
    v_fmac_f32 v200, v27, v163
    v_fmac_f32 v200, v28, v164
    v_fmac_f32 v200, v29, v165
    v_fmac_f32 v200, v30, v166
    v_fmac_f32 v200, v31, v167
    v_mfma_f32_32x32x16_bf16 v[24:39], v[76:79], v[180:183], 0
    v_add_u32 v253, s47, v248
    ds_read_b32 v192, v253
    ds_read_b32 v193, v253 offset:256
    v_mul_f32 v254, v16, v144
    v_fmac_f32 v254, v17, v145
    v_fmac_f32 v254, v18, v146
    v_mfma_f32_32x32x16_bf16 v[0:15], v[80:83], v[184:187], v[0:15]
    v_fmac_f32 v254, v19, v147
    v_fmac_f32 v254, v20, v148
    v_fmac_f32 v254, v21, v149
    v_fmac_f32 v254, v22, v150
    v_fmac_f32 v254, v23, v151
    v_sub_f32_e64 v64, -v48, v64
    v_mfma_f32_32x32x16_bf16 v[24:39], v[84:87], v[184:187], v[24:39]
    s_waitcnt vmcnt(6)
    ds_read_b64_tr_b16 v[176:177], v244 offset:2048
    ds_read_b64_tr_b16 v[178:179], v244 offset:3072
    ds_read_b64_tr_b16 v[180:181], v245 offset:2048
    ds_read_b64_tr_b16 v[182:183], v245 offset:3072
    v_sub_f32_e64 v65, -v49, v65
    v_permlane32_swap_b32 v196, v254
    v_mfma_f32_32x32x16_bf16 v[24:39], v[92:95], v[188:191], v[24:39]
    v_sub_f32_e64 v66, -v50, v66
    v_sub_f32_e64 v67, -v51, v67
    v_sub_f32_e64 v68, -v52, v68
    v_sub_f32_e64 v69, -v53, v69
    v_sub_f32_e64 v70, -v54, v70
    v_sub_f32_e64 v71, -v55, v71
    v_mfma_f32_32x32x16_bf16 v[0:15], v[88:91], v[188:191], v[0:15]
    v_add_f32 v254, v196, v254
    s_waitcnt vmcnt(4) lgkmcnt(0)
    v_mfma_f32_32x32x16_bf16 v[56:71], v[76:79], v[176:179], v[56:71]
    s_nop 1
    v_sub_f32_e64 v40, -v24, v40
    v_sub_f32_e64 v41, -v25, v41
    v_sub_f32_e64 v42, -v26, v42
    v_sub_f32_e64 v43, -v27, v43
    v_sub_f32_e64 v44, -v28, v44
    v_sub_f32_e64 v45, -v29, v45
    v_sub_f32_e64 v46, -v30, v46
    v_sub_f32_e64 v47, -v31, v47
    s_mov_b32 m0, s76
    s_mov_b64 exec, s[72:73]
    buffer_load_dwordx4 v192, s[12:15], 0 offen  lds
    s_mov_b32 m0, s77
    s_mov_b64 exec, s[74:75]
    buffer_load_dwordx4 v193, s[12:15], 0 offen  lds
    s_mov_b64 exec, -1
    s_add_u32 m0, s21, 2048
    v_mfma_f32_32x32x16_bf16 v[16:31], v[72:75], v[176:179], 0
    v_mad_u32_u16 v236, v236, s3, v246 op_sel:[1,0,0,0]
    v_mad_u32_u16 v237, v237, s3, v246 op_sel:[1,0,0,0]
    buffer_load_dwordx4 v236, s[4:7], s39 offen  lds
    buffer_load_dwordx4 v237, s[8:11], s39 offen offset:1024  lds
    ds_read_b64_tr_b16 v[176:177], v244 offset:4096
    ds_read_b64_tr_b16 v[178:179], v244 offset:5120
    ds_read_b64_tr_b16 v[184:185], v245 offset:4096
    ds_read_b64_tr_b16 v[186:187], v245 offset:5120
    v_mul_f32 v255, v0, v152
    v_fmac_f32 v255, v1, v153
    v_fmac_f32 v255, v2, v154
    v_fmac_f32 v255, v3, v155
    v_fmac_f32 v255, v4, v156
    s_waitcnt vmcnt(6) lgkmcnt(0)
    v_mfma_f32_32x32x16_bf16 v[16:31], v[80:83], v[176:179], v[16:31]
    v_fmac_f32 v255, v5, v157
    v_fmac_f32 v255, v6, v158
    v_fmac_f32 v255, v7, v159
    v_fmac_f32 v201, v8, v168
    v_fmac_f32 v201, v9, v169
    v_permlane32_swap_b32 v197, v255
    s_add_u32 m0, s21, 4096
    v_mfma_f32_32x32x16_bf16 v[56:71], v[84:87], v[176:179], v[56:71]
    v_mad_u32_u16 v238, v238, s3, v246 op_sel:[1,0,0,0]
    v_mad_u32_u16 v239, v239, s3, v246 op_sel:[1,0,0,0]
    buffer_load_dwordx4 v238, s[4:7], s40 offen  lds
    buffer_load_dwordx4 v239, s[8:11], s40 offen offset:1024  lds
    ds_read_b64_tr_b16 v[176:177], v244 offset:6144
    ds_read_b64_tr_b16 v[178:179], v244 offset:7168
    ds_read_b64_tr_b16 v[188:189], v245 offset:6144
    ds_read_b64_tr_b16 v[190:191], v245 offset:7168
    s_waitcnt lgkmcnt(0)
    v_mfma_f32_32x32x16_bf16 v[16:31], v[88:91], v[176:179], v[16:31]
    v_fmac_f32 v201, v10, v170
    v_fmac_f32 v201, v11, v171
    v_fmac_f32 v201, v12, v172
    v_fmac_f32 v201, v13, v173
    v_fmac_f32 v201, v14, v174
    v_fmac_f32 v201, v15, v175
    s_add_u32 m0, s21, 6144
    v_mfma_f32_32x32x16_bf16 v[56:71], v[92:95], v[176:179], v[56:71]
    v_mad_u32_u16 v240, v240, s3, v246 op_sel:[1,0,0,0]
    v_mad_u32_u16 v241, v241, s3, v246 op_sel:[1,0,0,0]
    buffer_load_dwordx4 v240, s[4:7], s41 offen  lds
    buffer_load_dwordx4 v241, s[8:11], s41 offen offset:1024  lds
    v_add_f32 v255, v197, v255
    s_set_gpr_idx_on s51, gpr_idx(DST)
    s_nop 0
    v_cvt_pk_bf16_f32 v206, v254, v255
    s_set_gpr_idx_off
    v_mfma_f32_32x32x16_bf16 v[0:15], v[72:75], v[180:183], 0
    v_mul_f32 v254, v16, v144
    v_fmac_f32 v254, v17, v145
    v_fmac_f32 v254, v18, v146
    v_fmac_f32 v254, v19, v147
    v_fmac_f32 v254, v20, v148
    v_fmac_f32 v254, v21, v149
    v_mfma_f32_32x32x16_bf16 v[32:47], v[76:79], v[180:183], v[32:47]
    v_fmac_f32 v254, v22, v150
    v_fmac_f32 v254, v23, v151
    v_fma_f32 v202, v24, -v160, v202
    v_fma_f32 v202, v25, -v161, v202
    v_permlane32_swap_b32 v254, v200
    v_fma_f32 v202, v26, -v162, v202
    v_mfma_f32_32x32x16_bf16 v[0:15], v[80:83], v[184:187], v[0:15]
    v_fma_f32 v202, v27, -v163, v202
    v_fma_f32 v202, v28, -v164, v202
    v_fma_f32 v202, v29, -v165, v202
    v_fma_f32 v202, v30, -v166, v202
    v_fma_f32 v202, v31, -v167, v202
    v_add_f32 v200, v254, v200
    v_mfma_f32_32x32x16_bf16 v[32:47], v[84:87], v[184:187], v[32:47]
    s_waitcnt vmcnt(8)
    ds_read_b64_tr_b16 v[176:177], v244 offset:0
    ds_read_b64_tr_b16 v[178:179], v244 offset:1024
    ds_read_b64_tr_b16 v[180:181], v245 offset:0
    ds_read_b64_tr_b16 v[182:183], v245 offset:1024
    v_mul_f32_e64 v198, v64, -v112
    v_permlane32_swap_b32 v202, v254
    v_mfma_f32_32x32x16_bf16 v[0:15], v[88:91], v[188:191], v[0:15]
    v_fma_f32 v198, v65, -v113, v198
    v_fma_f32 v198, v66, -v114, v198
    v_fma_f32 v198, v67, -v115, v198
    v_fma_f32 v198, v68, -v116, v198
    v_fma_f32 v198, v69, -v117, v198
    v_fma_f32 v198, v70, -v118, v198
    v_mfma_f32_32x32x16_bf16 v[32:47], v[92:95], v[188:191], v[32:47]
    v_add_u32 v249, s48, v249
    v_add_u32 v250, s49, v250
    v_fma_f32 v198, v71, -v119, v198
    v_add_f32 v254, v202, v254
    v_mul_f32 v196, v56, v160
    v_fmac_f32 v196, v57, v161
    v_fmac_f32 v196, v58, v162
    v_fmac_f32 v196, v59, v163
    v_fmac_f32 v196, v60, v164
    v_fmac_f32 v196, v61, v165
    v_fmac_f32 v196, v62, v166
    v_fmac_f32 v196, v63, v167
    s_nop 1
    v_permlane32_swap_b32 v198, v196
    v_add_f32 v196, v198, v196
    v_mul_f32 v255, v0, v152
    v_fmac_f32 v255, v1, v153
    v_fmac_f32 v255, v2, v154
    v_fmac_f32 v255, v3, v155
    v_fmac_f32 v255, v4, v156
    v_fmac_f32 v255, v5, v157
    v_fmac_f32 v255, v6, v158
    v_fmac_f32 v255, v7, v159
    v_fma_f32 v203, v8, -v168, v203
    v_fma_f32 v203, v9, -v169, v203
    v_permlane32_swap_b32 v255, v201
    v_fma_f32 v203, v10, -v170, v203
    v_fma_f32 v203, v11, -v171, v203
    v_fma_f32 v203, v12, -v172, v203
    v_fma_f32 v203, v13, -v173, v203
    v_fma_f32 v203, v14, -v174, v203
    v_fma_f32 v203, v15, -v175, v203
    v_add_f32 v201, v255, v201
    v_mul_f32_e64 v199, v40, -v120
    v_permlane32_swap_b32 v203, v255
    v_fma_f32 v199, v41, -v121, v199
    v_fma_f32 v199, v42, -v122, v199
    v_fma_f32 v199, v43, -v123, v199
    s_waitcnt vmcnt(6)
    ds_read_b64_tr_b16 v[72:73], v249 offset:0
    ds_read_b64_tr_b16 v[76:77], v249 offset:64
    ds_read_b64_tr_b16 v[74:75], v249 offset:256
    ds_read_b64_tr_b16 v[78:79], v249 offset:320
    s_mov_b64 exec, s[54:55]
    ds_read_u16_d16_hi v242, v250 offset:0
    s_mov_b64 exec, -1
    v_fma_f32 v199, v44, -v124, v199
    v_fma_f32 v199, v45, -v125, v199
    v_fma_f32 v199, v46, -v126, v199
    v_fma_f32 v199, v47, -v127, v199
    v_add_f32 v255, v203, v255
    v_mul_f32 v197, v32, v168
    v_fmac_f32 v197, v33, v169
    v_fmac_f32 v197, v34, v170
    v_fmac_f32 v197, v35, v171
    v_fmac_f32 v197, v36, v172
    v_fmac_f32 v197, v37, v173
    v_fmac_f32 v197, v38, v174
    v_fmac_f32 v197, v39, v175
    s_nop 1
    v_permlane32_swap_b32 v199, v197
    v_add_f32 v197, v199, v197
    s_set_gpr_idx_on s51, gpr_idx(DST)
    s_nop 0
    v_cvt_pk_bf16_f32 v207, v200, v201
    v_cvt_pk_bf16_f32 v209, v254, v255
    v_cvt_pk_bf16_f32 v208, v196, v197
    s_set_gpr_idx_off
    s_add_u32 s50, s50, 1
    s_add_u32 s51, s51, 6
    s_cmp_ge_u32 s50, 4
    s_cbranch_scc1 LAST0
    s_add_u32 s53, s53, 4
    s_xor_b32 s66, s53, s20
    s_bitcmp1_b32 s66, 2
    s_setprio 1
    s_cbranch_scc1 PRIO_8
    s_setprio 0
PRIO_8:
    s_cmp_eq_u32 s52, 4
    s_cbranch_scc1 ITEM_0_4
    s_cmp_eq_u32 s52, 5
    s_cbranch_scc1 ITEM_0_5
    s_cmp_eq_u32 s52, 3
    s_cbranch_scc1 ITEM_0_3
    s_cmp_eq_u32 s52, 6
    s_cbranch_scc1 ITEM_0_6
    s_cmp_eq_u32 s52, 8
    s_cbranch_scc1 ITEM_0_8
    s_branch ITEM_0_2
.p2align 6
ITEM_0_8:
    s_mov_b64 exec, s[54:55]
    ds_read_u16_d16_hi v243, v250 offset:128
    s_mov_b64 exec, -1
    ds_read_b64_tr_b16 v[80:81], v249 offset:512
    ds_read_b64_tr_b16 v[84:85], v249 offset:576
    ds_read_b64_tr_b16 v[82:83], v249 offset:768
    ds_read_b64_tr_b16 v[86:87], v249 offset:832
    ds_read_b64_tr_b16 v[88:89], v249 offset:1024
    ds_read_b64_tr_b16 v[92:93], v249 offset:1088
    ds_read_b64_tr_b16 v[90:91], v249 offset:1280
    ds_read_b64_tr_b16 v[94:95], v249 offset:1344
    ds_read_b64_tr_b16 v[64:65], v249 offset:1536
    ds_read_b64_tr_b16 v[68:69], v249 offset:1600
    ds_read_b64_tr_b16 v[66:67], v249 offset:1792
    ds_read_b64_tr_b16 v[70:71], v249 offset:1856
    s_waitcnt lgkmcnt(13)
    v_mul_f32_dpp v196, v242, v72 row_newbcast:0 row_mask:0xf bank_mask:0xf
    v_mul_f32_dpp v197, v242, v73 row_newbcast:1 row_mask:0xf bank_mask:0xf
    v_mul_f32_dpp v198, v242, v72 row_newbcast:8 row_mask:0xf bank_mask:0xf
    v_mul_f32_dpp v199, v242, v73 row_newbcast:9 row_mask:0xf bank_mask:0xf
    v_mul_f32_dpp v200, v242, v76 row_newbcast:2 row_mask:0xf bank_mask:0xf
    v_mul_f32_dpp v201, v242, v77 row_newbcast:3 row_mask:0xf bank_mask:0xf
    v_mul_f32_dpp v202, v242, v76 row_newbcast:10 row_mask:0xf bank_mask:0xf
    v_mul_f32_dpp v203, v242, v77 row_newbcast:11 row_mask:0xf bank_mask:0xf
    v_cvt_pk_bf16_f32 v72, v196, v197
    v_cvt_pk_bf16_f32 v76, v198, v199
    v_cvt_pk_bf16_f32 v73, v200, v201
    v_cvt_pk_bf16_f32 v77, v202, v203
    v_mul_f32_dpp v196, v242, v74 row_newbcast:4 row_mask:0xf bank_mask:0xf
    v_mul_f32_dpp v197, v242, v75 row_newbcast:5 row_mask:0xf bank_mask:0xf
    v_mul_f32_dpp v198, v242, v74 row_newbcast:12 row_mask:0xf bank_mask:0xf
    v_mul_f32_dpp v199, v242, v75 row_newbcast:13 row_mask:0xf bank_mask:0xf
    v_mul_f32_dpp v200, v242, v78 row_newbcast:6 row_mask:0xf bank_mask:0xf
    v_mul_f32_dpp v201, v242, v79 row_newbcast:7 row_mask:0xf bank_mask:0xf
    v_mul_f32_dpp v202, v242, v78 row_newbcast:14 row_mask:0xf bank_mask:0xf
    v_mul_f32_dpp v203, v242, v79 row_newbcast:15 row_mask:0xf bank_mask:0xf
    v_cvt_pk_bf16_f32 v74, v196, v197
    v_cvt_pk_bf16_f32 v78, v198, v199
    v_cvt_pk_bf16_f32 v75, v200, v201
    v_cvt_pk_bf16_f32 v79, v202, v203
    s_mov_b64 exec, s[54:55]
    ds_read_u16_d16_hi v242, v250 offset:256
    s_mov_b64 exec, -1
    s_waitcnt vmcnt(4) lgkmcnt(9)
    v_mfma_f32_32x32x16_bf16 v[0:15], v[72:75], v[176:179], 0
    v_mul_f32_dpp v196, v243, v80 row_newbcast:0 row_mask:0xf bank_mask:0xf
    v_mul_f32_dpp v197, v243, v81 row_newbcast:1 row_mask:0xf bank_mask:0xf
    v_mul_f32_dpp v198, v243, v80 row_newbcast:8 row_mask:0xf bank_mask:0xf
    v_mul_f32_dpp v199, v243, v81 row_newbcast:9 row_mask:0xf bank_mask:0xf
    v_mul_f32_dpp v200, v243, v84 row_newbcast:2 row_mask:0xf bank_mask:0xf
    v_mul_f32_dpp v201, v243, v85 row_newbcast:3 row_mask:0xf bank_mask:0xf
    s_add_u32 m0, s21, 0
    v_mfma_f32_32x32x16_bf16 v[48:63], v[76:79], v[176:179], 0
    buffer_load_dwordx4 v234, s[4:7], s35 offen  lds
    buffer_load_dwordx4 v235, s[8:11], s35 offen offset:1024  lds
    ds_read_b64_tr_b16 v[176:177], v244 offset:2048
    ds_read_b64_tr_b16 v[178:179], v244 offset:3072
    ds_read_b64_tr_b16 v[184:185], v245 offset:2048
    ds_read_b64_tr_b16 v[186:187], v245 offset:3072
    v_mul_f32_dpp v202, v243, v84 row_newbcast:10 row_mask:0xf bank_mask:0xf
    v_mul_f32_dpp v203, v243, v85 row_newbcast:11 row_mask:0xf bank_mask:0xf
    v_cvt_pk_bf16_f32 v80, v196, v197
    v_cvt_pk_bf16_f32 v84, v198, v199
    v_cvt_pk_bf16_f32 v81, v200, v201
    v_cvt_pk_bf16_f32 v85, v202, v203
    v_mul_f32_dpp v196, v243, v82 row_newbcast:4 row_mask:0xf bank_mask:0xf
    v_mul_f32_dpp v197, v243, v83 row_newbcast:5 row_mask:0xf bank_mask:0xf
    v_mul_f32_dpp v198, v243, v82 row_newbcast:12 row_mask:0xf bank_mask:0xf
    v_mul_f32_dpp v199, v243, v83 row_newbcast:13 row_mask:0xf bank_mask:0xf
    v_mul_f32_dpp v200, v243, v86 row_newbcast:6 row_mask:0xf bank_mask:0xf
    v_mul_f32_dpp v201, v243, v87 row_newbcast:7 row_mask:0xf bank_mask:0xf
    v_mul_f32_dpp v202, v243, v86 row_newbcast:14 row_mask:0xf bank_mask:0xf
    v_mul_f32_dpp v203, v243, v87 row_newbcast:15 row_mask:0xf bank_mask:0xf
    v_cvt_pk_bf16_f32 v82, v196, v197
    v_cvt_pk_bf16_f32 v86, v198, v199
    v_cvt_pk_bf16_f32 v83, v200, v201
    v_cvt_pk_bf16_f32 v87, v202, v203
    s_mov_b64 exec, s[54:55]
    ds_read_u16_d16_hi v243, v250 offset:384
    s_mov_b64 exec, -1
    s_waitcnt vmcnt(4) lgkmcnt(1)
    v_mfma_f32_32x32x16_bf16 v[0:15], v[80:83], v[176:179], v[0:15]
    v_mul_f32_dpp v196, v242, v88 row_newbcast:0 row_mask:0xf bank_mask:0xf
    v_mul_f32_dpp v197, v242, v89 row_newbcast:1 row_mask:0xf bank_mask:0xf
    v_mul_f32_dpp v198, v242, v88 row_newbcast:8 row_mask:0xf bank_mask:0xf
    v_mul_f32_dpp v199, v242, v89 row_newbcast:9 row_mask:0xf bank_mask:0xf
    v_mul_f32_dpp v200, v242, v92 row_newbcast:2 row_mask:0xf bank_mask:0xf
    v_mul_f32_dpp v201, v242, v93 row_newbcast:3 row_mask:0xf bank_mask:0xf
    s_add_u32 m0, s21, 2048
    v_mfma_f32_32x32x16_bf16 v[48:63], v[84:87], v[176:179], v[48:63]
    buffer_load_dwordx4 v236, s[4:7], s35 offen  lds
    buffer_load_dwordx4 v237, s[8:11], s35 offen offset:1024  lds
    ds_read_b64_tr_b16 v[176:177], v244 offset:4096
    ds_read_b64_tr_b16 v[178:179], v244 offset:5120
    ds_read_b64_tr_b16 v[188:189], v245 offset:4096
    ds_read_b64_tr_b16 v[190:191], v245 offset:5120
    v_mul_f32_dpp v202, v242, v92 row_newbcast:10 row_mask:0xf bank_mask:0xf
    v_mul_f32_dpp v203, v242, v93 row_newbcast:11 row_mask:0xf bank_mask:0xf
    v_cvt_pk_bf16_f32 v88, v196, v197
    v_cvt_pk_bf16_f32 v92, v198, v199
    v_cvt_pk_bf16_f32 v89, v200, v201
    v_cvt_pk_bf16_f32 v93, v202, v203
    v_mul_f32_dpp v196, v242, v90 row_newbcast:4 row_mask:0xf bank_mask:0xf
    v_mul_f32_dpp v197, v242, v91 row_newbcast:5 row_mask:0xf bank_mask:0xf
    v_mul_f32_dpp v198, v242, v90 row_newbcast:12 row_mask:0xf bank_mask:0xf
    v_mul_f32_dpp v199, v242, v91 row_newbcast:13 row_mask:0xf bank_mask:0xf
    v_mul_f32_dpp v200, v242, v94 row_newbcast:6 row_mask:0xf bank_mask:0xf
    v_mul_f32_dpp v201, v242, v95 row_newbcast:7 row_mask:0xf bank_mask:0xf
    v_mul_f32_dpp v202, v242, v94 row_newbcast:14 row_mask:0xf bank_mask:0xf
    v_mul_f32_dpp v203, v242, v95 row_newbcast:15 row_mask:0xf bank_mask:0xf
    v_cvt_pk_bf16_f32 v90, v196, v197
    v_cvt_pk_bf16_f32 v94, v198, v199
    v_cvt_pk_bf16_f32 v91, v200, v201
    v_cvt_pk_bf16_f32 v95, v202, v203
    s_waitcnt vmcnt(4) lgkmcnt(0)
    v_mfma_f32_32x32x16_bf16 v[0:15], v[88:91], v[176:179], v[0:15]
    v_mul_f32_dpp v196, v243, v64 row_newbcast:0 row_mask:0xf bank_mask:0xf
    v_mul_f32_dpp v197, v243, v65 row_newbcast:1 row_mask:0xf bank_mask:0xf
    v_mul_f32_dpp v198, v243, v64 row_newbcast:8 row_mask:0xf bank_mask:0xf
    v_mul_f32_dpp v199, v243, v65 row_newbcast:9 row_mask:0xf bank_mask:0xf
    v_mul_f32_dpp v200, v243, v68 row_newbcast:2 row_mask:0xf bank_mask:0xf
    v_mul_f32_dpp v201, v243, v69 row_newbcast:3 row_mask:0xf bank_mask:0xf
    s_add_u32 m0, s21, 4096
    v_mfma_f32_32x32x16_bf16 v[48:63], v[92:95], v[176:179], v[48:63]
    buffer_load_dwordx4 v238, s[4:7], s35 offen  lds
    buffer_load_dwordx4 v239, s[8:11], s35 offen offset:1024  lds
    ds_read_b64_tr_b16 v[176:177], v244 offset:6144
    ds_read_b64_tr_b16 v[178:179], v244 offset:7168
    ds_read_b64_tr_b16 v[192:193], v245 offset:6144
    ds_read_b64_tr_b16 v[194:195], v245 offset:7168
    v_mul_f32_dpp v202, v243, v68 row_newbcast:10 row_mask:0xf bank_mask:0xf
    v_mul_f32_dpp v203, v243, v69 row_newbcast:11 row_mask:0xf bank_mask:0xf
    v_cvt_pk_bf16_f32 v64, v196, v197
    v_cvt_pk_bf16_f32 v68, v198, v199
    v_cvt_pk_bf16_f32 v65, v200, v201
    v_cvt_pk_bf16_f32 v69, v202, v203
    v_mul_f32_dpp v196, v243, v66 row_newbcast:4 row_mask:0xf bank_mask:0xf
    v_mul_f32_dpp v197, v243, v67 row_newbcast:5 row_mask:0xf bank_mask:0xf
    v_mul_f32_dpp v198, v243, v66 row_newbcast:12 row_mask:0xf bank_mask:0xf
    v_mul_f32_dpp v199, v243, v67 row_newbcast:13 row_mask:0xf bank_mask:0xf
    v_mul_f32_dpp v200, v243, v70 row_newbcast:6 row_mask:0xf bank_mask:0xf
    v_mul_f32_dpp v201, v243, v71 row_newbcast:7 row_mask:0xf bank_mask:0xf
    v_mul_f32_dpp v202, v243, v70 row_newbcast:14 row_mask:0xf bank_mask:0xf
    v_mul_f32_dpp v203, v243, v71 row_newbcast:15 row_mask:0xf bank_mask:0xf
    v_cvt_pk_bf16_f32 v66, v196, v197
    v_cvt_pk_bf16_f32 v70, v198, v199
    v_cvt_pk_bf16_f32 v67, v200, v201
    v_cvt_pk_bf16_f32 v71, v202, v203
    s_waitcnt lgkmcnt(0)
    v_mfma_f32_32x32x16_bf16 v[0:15], v[64:67], v[176:179], v[0:15]
    s_add_u32 m0, s21, 6144
    v_mfma_f32_32x32x16_bf16 v[48:63], v[68:71], v[176:179], v[48:63]
    buffer_load_dwordx4 v240, s[4:7], s35 offen  lds
    buffer_load_dwordx4 v241, s[8:11], s35 offen offset:1024  lds
    s_mov_b32 m0, s50
    s_nop 0
    s_movrels_b32 s71, s23
    s_bfe_u32 s46, s71, 0x30012
    s_mov_b32 m0, s46
    s_and_b32 s66, s71, 0x3ffff
    s_movrels_b32 s68, s57
    s_movrels_b32 s69, s61
    s_sub_u32 s48, s66, s47
    s_mov_b32 s47, s66
    s_lshr_b32 s52, s71, 28
    s_lshl_b32 s67, s46, 9
    s_add_u32 s66, s66, s67
    s_sub_u32 s49, s66, s42
    s_mov_b32 s42, s66
    s_bfe_u32 s66, s68, 655360
    s_add_u32 s43, s42, s66
    s_bfe_u32 s39, s69, 655360
    s_bfe_u32 s66, s68, 655370
    s_add_u32 s44, s42, s66
    s_bfe_u32 s40, s69, 655370
    s_bfe_u32 s66, s68, 655380
    s_add_u32 s45, s42, s66
    s_bfe_u32 s41, s69, 655380
    s_and_b32 s66, s46, s33
    s_cselect_b32 s72, -1, 1
    s_cselect_b32 s76, s47, 163712
    s_cmp_ge_u32 s66, 2
    s_cselect_b32 s73, -1, 0
    s_add_u32 s77, s47, 1024
    s_cmp_ge_u32 s66, 4
    s_cselect_b32 s75, -1, 0
    s_cmp_ge_u32 s66, 3
    s_cselect_b32 s74, -1, 1
    s_cselect_b32 s77, s77, 163712
    v_mfma_f32_32x32x16_bf16 v[16:31], v[72:75], v[180:183], 0
    v_mul_f32 v196, v0, v96
    v_fmac_f32 v196, v1, v97
    v_fmac_f32 v196, v2, v98
    v_fmac_f32 v196, v3, v99
    v_fmac_f32 v196, v4, v100
    v_fmac_f32 v196, v5, v101
    v_mfma_f32_32x32x16_bf16 v[32:47], v[76:79], v[180:183], 0
    v_fmac_f32 v196, v6, v102
    v_fmac_f32 v196, v7, v103
    v_mul_f32 v198, v8, v128
    v_fmac_f32 v198, v9, v129
    v_fmac_f32 v198, v10, v130
    v_fmac_f32 v198, v11, v131
    v_mfma_f32_32x32x16_bf16 v[16:31], v[80:83], v[184:187], v[16:31]
    v_fmac_f32 v198, v12, v132
    v_fmac_f32 v198, v13, v133
    v_fmac_f32 v198, v14, v134
    v_fmac_f32 v198, v15, v135
    v_mul_f32 v200, v48, v128
    v_fmac_f32 v200, v49, v129
    v_mfma_f32_32x32x16_bf16 v[32:47], v[84:87], v[184:187], v[32:47]
    v_permlane32_swap_b32 v196, v198
    v_fmac_f32 v200, v50, v130
    v_fmac_f32 v200, v51, v131
    v_fmac_f32 v200, v52, v132
    v_fmac_f32 v200, v53, v133
    v_fmac_f32 v200, v54, v134
    v_mfma_f32_32x32x16_bf16 v[16:31], v[88:91], v[188:191], v[16:31]
    v_fmac_f32 v200, v55, v135
    v_add_f32 v198, v196, v198
    v_mul_f32_e64 v202, v56, -v128
    v_fma_f32 v202, v57, -v129, v202
    v_fma_f32 v202, v58, -v130, v202
    v_fma_f32 v202, v59, -v131, v202
    v_mfma_f32_32x32x16_bf16 v[32:47], v[92:95], v[188:191], v[32:47]
    s_waitcnt vmcnt(6)
    ds_read_b64_tr_b16 v[176:177], v244 offset:0
    ds_read_b64_tr_b16 v[178:179], v244 offset:1024
    ds_read_b64_tr_b16 v[180:181], v245 offset:0
    ds_read_b64_tr_b16 v[182:183], v245 offset:1024
    v_fma_f32 v202, v60, -v132, v202
    v_fma_f32 v202, v61, -v133, v202
    v_mfma_f32_32x32x16_bf16 v[16:31], v[64:67], v[192:195], v[16:31]
    v_fma_f32 v202, v62, -v134, v202
    v_fma_f32 v202, v63, -v135, v202
    s_nop 1
    v_permlane32_swap_b32 v200, v202
    v_add_f32 v202, v200, v202
    v_mfma_f32_32x32x16_bf16 v[32:47], v[68:71], v[192:195], v[32:47]
    s_waitcnt vmcnt(4) lgkmcnt(0)
    v_mfma_f32_32x32x16_bf16 v[0:15], v[72:75], v[176:179], 0
    s_nop 2
    v_mul_f32 v197, v16, v104
    v_fmac_f32 v197, v17, v105
    v_fmac_f32 v197, v18, v106
    v_fmac_f32 v197, v19, v107
    v_fmac_f32 v197, v20, v108
    v_fmac_f32 v197, v21, v109
    s_add_u32 m0, s21, 0
    v_mfma_f32_32x32x16_bf16 v[48:63], v[76:79], v[176:179], 0
    buffer_load_dwordx4 v234, s[4:7], s36 offen  lds
    buffer_load_dwordx4 v235, s[8:11], s36 offen offset:1024  lds
    ds_read_b64_tr_b16 v[176:177], v244 offset:2048
    ds_read_b64_tr_b16 v[178:179], v244 offset:3072
    ds_read_b64_tr_b16 v[184:185], v245 offset:2048
    ds_read_b64_tr_b16 v[186:187], v245 offset:3072
    v_fmac_f32 v197, v22, v110
    v_fmac_f32 v197, v23, v111
    v_mul_f32 v199, v24, v136
    v_fmac_f32 v199, v25, v137
    v_fmac_f32 v199, v26, v138
    v_fmac_f32 v199, v27, v139
    v_fmac_f32 v199, v28, v140
    v_fmac_f32 v199, v29, v141
    v_fmac_f32 v199, v30, v142
    v_fmac_f32 v199, v31, v143
    s_waitcnt vmcnt(4) lgkmcnt(0)
    v_mfma_f32_32x32x16_bf16 v[0:15], v[80:83], v[176:179], v[0:15]
    v_mul_f32 v201, v32, v136
    v_fmac_f32 v201, v33, v137
    v_permlane32_swap_b32 v197, v199
    v_fmac_f32 v201, v34, v138
    v_fmac_f32 v201, v35, v139
    v_fmac_f32 v201, v36, v140
    s_add_u32 m0, s21, 2048
    v_mfma_f32_32x32x16_bf16 v[48:63], v[84:87], v[176:179], v[48:63]
    buffer_load_dwordx4 v236, s[4:7], s36 offen  lds
    buffer_load_dwordx4 v237, s[8:11], s36 offen offset:1024  lds
    ds_read_b64_tr_b16 v[176:177], v244 offset:4096
    ds_read_b64_tr_b16 v[178:179], v244 offset:5120
    ds_read_b64_tr_b16 v[188:189], v245 offset:4096
    ds_read_b64_tr_b16 v[190:191], v245 offset:5120
    s_waitcnt vmcnt(4) lgkmcnt(0)
    v_mfma_f32_32x32x16_bf16 v[0:15], v[88:91], v[176:179], v[0:15]
    v_fmac_f32 v201, v37, v141
    v_fmac_f32 v201, v38, v142
    v_fmac_f32 v201, v39, v143
    v_add_f32 v199, v197, v199
    v_mul_f32_e64 v203, v40, -v136
    v_fma_f32 v203, v41, -v137, v203
    s_add_u32 m0, s21, 4096
    v_mfma_f32_32x32x16_bf16 v[48:63], v[92:95], v[176:179], v[48:63]
    buffer_load_dwordx4 v238, s[4:7], s36 offen  lds
    buffer_load_dwordx4 v239, s[8:11], s36 offen offset:1024  lds
    ds_read_b64_tr_b16 v[176:177], v244 offset:6144
    ds_read_b64_tr_b16 v[178:179], v244 offset:7168
    ds_read_b64_tr_b16 v[192:193], v245 offset:6144
    ds_read_b64_tr_b16 v[194:195], v245 offset:7168
    s_waitcnt lgkmcnt(0)
    v_mfma_f32_32x32x16_bf16 v[0:15], v[64:67], v[176:179], v[0:15]
    v_fma_f32 v203, v42, -v138, v203
    v_fma_f32 v203, v43, -v139, v203
    v_fma_f32 v203, v44, -v140, v203
    v_fma_f32 v203, v45, -v141, v203
    v_fma_f32 v203, v46, -v142, v203
    v_fma_f32 v203, v47, -v143, v203
    s_nop 1
    s_add_u32 m0, s21, 6144
    v_mfma_f32_32x32x16_bf16 v[48:63], v[68:71], v[176:179], v[48:63]
    buffer_load_dwordx4 v240, s[4:7], s36 offen  lds
    buffer_load_dwordx4 v241, s[8:11], s36 offen offset:1024  lds
    v_permlane32_swap_b32 v201, v203
    v_add_f32 v203, v201, v203
    s_set_gpr_idx_on s51, gpr_idx(DST)
    s_nop 0
    v_cvt_pk_bf16_f32 v204, v198, v199
    v_cvt_pk_bf16_f32 v205, v202, v203
    s_set_gpr_idx_off
    v_mfma_f32_32x32x16_bf16 v[16:31], v[72:75], v[180:183], 0
    v_mul_f32 v196, v0, v144
    v_fmac_f32 v196, v1, v145
    v_fmac_f32 v196, v2, v146
    v_fmac_f32 v196, v3, v147
    v_fmac_f32 v196, v4, v148
    v_fmac_f32 v196, v5, v149
    v_mfma_f32_32x32x16_bf16 v[32:47], v[76:79], v[180:183], 0
    v_add_u32 v253, s47, v248
    ds_read_b32 v254, v253
    ds_read_b32 v255, v253 offset:256
    v_fmac_f32 v196, v6, v150
    v_fmac_f32 v196, v7, v151
    v_mul_f32 v198, v8, v112
    v_mfma_f32_32x32x16_bf16 v[16:31], v[80:83], v[184:187], v[16:31]
    v_fmac_f32 v198, v9, v113
    v_fmac_f32 v198, v10, v114
    v_fmac_f32 v198, v11, v115
    v_fmac_f32 v198, v12, v116
    v_fmac_f32 v198, v13, v117
    v_fmac_f32 v198, v14, v118
    v_mfma_f32_32x32x16_bf16 v[32:47], v[84:87], v[184:187], v[32:47]
    v_fmac_f32 v198, v15, v119
    v_mul_f32_e64 v200, v48, -v160
    v_fma_f32 v200, v49, -v161, v200
    v_fma_f32 v200, v50, -v162, v200
    v_fma_f32 v200, v51, -v163, v200
    v_fma_f32 v200, v52, -v164, v200
    v_mfma_f32_32x32x16_bf16 v[16:31], v[88:91], v[188:191], v[16:31]
    v_fma_f32 v200, v53, -v165, v200
    v_fma_f32 v200, v54, -v166, v200
    v_fma_f32 v200, v55, -v167, v200
    v_mul_f32_e64 v202, v56, -v160
    v_fma_f32 v202, v57, -v161, v202
    v_fma_f32 v202, v58, -v162, v202
    v_mfma_f32_32x32x16_bf16 v[32:47], v[92:95], v[188:191], v[32:47]
    s_waitcnt vmcnt(6)
    ds_read_b64_tr_b16 v[176:177], v244 offset:0
    ds_read_b64_tr_b16 v[178:179], v244 offset:1024
    ds_read_b64_tr_b16 v[180:181], v245 offset:0
    ds_read_b64_tr_b16 v[182:183], v245 offset:1024
    v_fma_f32 v202, v59, -v163, v202
    v_fma_f32 v202, v60, -v164, v202
    v_mfma_f32_32x32x16_bf16 v[16:31], v[64:67], v[192:195], v[16:31]
    v_fma_f32 v202, v61, -v165, v202
    v_fma_f32 v202, v62, -v166, v202
    v_fma_f32 v202, v63, -v167, v202
    v_mfma_f32_32x32x16_bf16 v[32:47], v[68:71], v[192:195], v[32:47]
    s_waitcnt vmcnt(4) lgkmcnt(0)
    v_mfma_f32_32x32x16_bf16 v[0:15], v[72:75], v[176:179], 0
    s_nop 5
    v_mul_f32 v197, v16, v152
    v_fmac_f32 v197, v17, v153
    v_fmac_f32 v197, v18, v154
    v_fmac_f32 v197, v19, v155
    v_fmac_f32 v197, v20, v156
    v_fmac_f32 v197, v21, v157
    s_add_u32 m0, s21, 0
    v_mfma_f32_32x32x16_bf16 v[48:63], v[76:79], v[176:179], 0
    buffer_load_dwordx4 v234, s[4:7], s37 offen  lds
    buffer_load_dwordx4 v235, s[8:11], s37 offen offset:1024  lds
    ds_read_b64_tr_b16 v[176:177], v244 offset:2048
    ds_read_b64_tr_b16 v[178:179], v244 offset:3072
    ds_read_b64_tr_b16 v[184:185], v245 offset:2048
    ds_read_b64_tr_b16 v[186:187], v245 offset:3072
    v_add_u32 v252, s42, v247
    ds_read2_b32 v[234:235], v252 offset0:0 offset1:16
    s_mov_b32 m0, s76
    s_mov_b64 exec, s[72:73]
    buffer_load_dwordx4 v254, s[12:15], 0 offen  lds
    s_mov_b32 m0, s77
    s_mov_b64 exec, s[74:75]
    buffer_load_dwordx4 v255, s[12:15], 0 offen  lds
    s_mov_b64 exec, -1
    v_fmac_f32 v197, v22, v158
    v_fmac_f32 v197, v23, v159
    v_mul_f32 v199, v24, v120
    v_fmac_f32 v199, v25, v121
    v_fmac_f32 v199, v26, v122
    v_fmac_f32 v199, v27, v123
    s_waitcnt vmcnt(6) lgkmcnt(1)
    v_mfma_f32_32x32x16_bf16 v[0:15], v[80:83], v[176:179], v[0:15]
    v_fmac_f32 v199, v28, v124
    v_fmac_f32 v199, v29, v125
    v_fmac_f32 v199, v30, v126
    v_fmac_f32 v199, v31, v127
    v_mul_f32_e64 v201, v32, -v168
    v_fma_f32 v201, v33, -v169, v201
    s_add_u32 m0, s21, 2048
    v_mfma_f32_32x32x16_bf16 v[48:63], v[84:87], v[176:179], v[48:63]
    buffer_load_dwordx4 v236, s[4:7], s37 offen  lds
    buffer_load_dwordx4 v237, s[8:11], s37 offen offset:1024  lds
    ds_read_b64_tr_b16 v[176:177], v244 offset:4096
    ds_read_b64_tr_b16 v[178:179], v244 offset:5120
    ds_read_b64_tr_b16 v[188:189], v245 offset:4096
    ds_read_b64_tr_b16 v[190:191], v245 offset:5120
    v_add_u32 v252, s43, v247
    ds_read2_b32 v[236:237], v252 offset0:0 offset1:16
    s_waitcnt vmcnt(6) lgkmcnt(1)
    v_mfma_f32_32x32x16_bf16 v[0:15], v[88:91], v[176:179], v[0:15]
    v_fma_f32 v201, v34, -v170, v201
    v_fma_f32 v201, v35, -v171, v201
    v_fma_f32 v201, v36, -v172, v201
    v_fma_f32 v201, v37, -v173, v201
    v_fma_f32 v201, v38, -v174, v201
    v_fma_f32 v201, v39, -v175, v201
    s_add_u32 m0, s21, 4096
    v_mfma_f32_32x32x16_bf16 v[48:63], v[92:95], v[176:179], v[48:63]
    buffer_load_dwordx4 v238, s[4:7], s37 offen  lds
    buffer_load_dwordx4 v239, s[8:11], s37 offen offset:1024  lds
    ds_read_b64_tr_b16 v[176:177], v244 offset:6144
    ds_read_b64_tr_b16 v[178:179], v244 offset:7168
    ds_read_b64_tr_b16 v[192:193], v245 offset:6144
    ds_read_b64_tr_b16 v[194:195], v245 offset:7168
    v_add_u32 v252, s44, v247
    ds_read2_b32 v[238:239], v252 offset0:0 offset1:16
    s_waitcnt lgkmcnt(1)
    v_mfma_f32_32x32x16_bf16 v[0:15], v[64:67], v[176:179], v[0:15]
    v_mul_f32_e64 v203, v40, -v168
    v_fma_f32 v203, v41, -v169, v203
    v_fma_f32 v203, v42, -v170, v203
    v_fma_f32 v203, v43, -v171, v203
    v_fma_f32 v203, v44, -v172, v203
    v_fma_f32 v203, v45, -v173, v203
    s_add_u32 m0, s21, 6144
    v_mfma_f32_32x32x16_bf16 v[48:63], v[68:71], v[176:179], v[48:63]
    buffer_load_dwordx4 v240, s[4:7], s37 offen  lds
    buffer_load_dwordx4 v241, s[8:11], s37 offen offset:1024  lds
    v_add_u32 v252, s45, v247
    ds_read2_b32 v[240:241], v252 offset0:0 offset1:16
    v_fma_f32 v203, v46, -v174, v203
    v_fma_f32 v203, v47, -v175, v203
    v_mfma_f32_32x32x16_bf16 v[16:31], v[72:75], v[180:183], 0
    v_mul_f32 v254, v0, v144
    v_fmac_f32 v254, v1, v145
    v_fmac_f32 v254, v2, v146
    v_fmac_f32 v254, v3, v147
    v_fmac_f32 v254, v4, v148
    v_fmac_f32 v254, v5, v149
    v_mfma_f32_32x32x16_bf16 v[32:47], v[76:79], v[180:183], 0
    ds_swizzle_b32 v76, v76 offset:0x401F
    ds_swizzle_b32 v77, v77 offset:0x401F
    ds_swizzle_b32 v78, v78 offset:0x401F
    ds_swizzle_b32 v79, v79 offset:0x401F
    v_fmac_f32 v254, v6, v150
    v_fmac_f32 v254, v7, v151
    v_mfma_f32_32x32x16_bf16 v[16:31], v[80:83], v[184:187], v[16:31]
    v_fmac_f32 v200, v8, v160
    v_fmac_f32 v200, v9, v161
    v_permlane32_swap_b32 v196, v254
    v_fmac_f32 v200, v10, v162
    v_fmac_f32 v200, v11, v163
    v_fmac_f32 v200, v12, v164
    v_mfma_f32_32x32x16_bf16 v[32:47], v[84:87], v[184:187], v[32:47]
    ds_swizzle_b32 v84, v84 offset:0x401F
    ds_swizzle_b32 v85, v85 offset:0x401F
    ds_swizzle_b32 v86, v86 offset:0x401F
    ds_swizzle_b32 v87, v87 offset:0x401F
    v_fmac_f32 v200, v13, v165
    v_fmac_f32 v200, v14, v166
    v_mfma_f32_32x32x16_bf16 v[16:31], v[88:91], v[188:191], v[16:31]
    v_fmac_f32 v200, v15, v167
    v_add_f32 v254, v196, v254
    v_mfma_f32_32x32x16_bf16 v[32:47], v[92:95], v[188:191], v[32:47]
    ds_swizzle_b32 v92, v92 offset:0x401F
    ds_swizzle_b32 v93, v93 offset:0x401F
    ds_swizzle_b32 v94, v94 offset:0x401F
    ds_swizzle_b32 v95, v95 offset:0x401F
    s_waitcnt vmcnt(8)
    ds_read_b64_tr_b16 v[176:177], v244 offset:0
    ds_read_b64_tr_b16 v[178:179], v244 offset:1024
    ds_read_b64_tr_b16 v[180:181], v245 offset:0
    ds_read_b64_tr_b16 v[182:183], v245 offset:1024
    v_mfma_f32_32x32x16_bf16 v[16:31], v[64:67], v[192:195], v[16:31]
    v_mfma_f32_32x32x16_bf16 v[32:47], v[68:71], v[192:195], v[32:47]
    ds_swizzle_b32 v68, v68 offset:0x401F
    ds_swizzle_b32 v69, v69 offset:0x401F
    ds_swizzle_b32 v70, v70 offset:0x401F
    ds_swizzle_b32 v71, v71 offset:0x401F
    s_waitcnt lgkmcnt(8)
    s_mov_b64 exec, s[56:57]
    v_xor_b32 v76, 0x80008000, v76
    v_xor_b32 v77, 0x80008000, v77
    v_xor_b32 v78, 0x80008000, v78
    v_xor_b32 v79, 0x80008000, v79
    v_xor_b32 v84, 0x80008000, v84
    v_xor_b32 v85, 0x80008000, v85
    v_xor_b32 v86, 0x80008000, v86
    v_xor_b32 v87, 0x80008000, v87
    v_xor_b32 v92, 0x80008000, v92
    v_xor_b32 v93, 0x80008000, v93
    v_xor_b32 v94, 0x80008000, v94
    v_xor_b32 v95, 0x80008000, v95
    s_mov_b64 exec, -1
    s_waitcnt vmcnt(4) lgkmcnt(4)
    v_mfma_f32_32x32x16_bf16 v[0:15], v[72:75], v[176:179], 0
    v_mul_f32 v255, v16, v152
    v_fmac_f32 v255, v17, v153
    v_fmac_f32 v255, v18, v154
    v_fmac_f32 v255, v19, v155
    v_fmac_f32 v255, v20, v156
    v_fmac_f32 v255, v21, v157
    s_add_u32 m0, s21, 0
    v_mfma_f32_32x32x16_bf16 v[48:63], v[76:79], v[176:179], v[48:63]
    v_mad_u32_u16 v234, v234, s3, v246 op_sel:[1,0,0,0]
    v_mad_u32_u16 v235, v235, s3, v246 op_sel:[1,0,0,0]
    buffer_load_dwordx4 v234, s[4:7], s38 offen  lds
    buffer_load_dwordx4 v235, s[8:11], s38 offen offset:1024  lds
    ds_read_b64_tr_b16 v[176:177], v244 offset:2048
    ds_read_b64_tr_b16 v[178:179], v244 offset:3072
    ds_read_b64_tr_b16 v[184:185], v245 offset:2048
    ds_read_b64_tr_b16 v[186:187], v245 offset:3072
    s_waitcnt vmcnt(4) lgkmcnt(0)
    v_mfma_f32_32x32x16_bf16 v[0:15], v[80:83], v[176:179], v[0:15]
    s_add_u32 m0, s21, 2048
    v_mfma_f32_32x32x16_bf16 v[48:63], v[84:87], v[176:179], v[48:63]
    v_mad_u32_u16 v236, v236, s3, v246 op_sel:[1,0,0,0]
    v_mad_u32_u16 v237, v237, s3, v246 op_sel:[1,0,0,0]
    buffer_load_dwordx4 v236, s[4:7], s39 offen  lds
    buffer_load_dwordx4 v237, s[8:11], s39 offen offset:1024  lds
    ds_read_b64_tr_b16 v[176:177], v244 offset:4096
    ds_read_b64_tr_b16 v[178:179], v244 offset:5120
    ds_read_b64_tr_b16 v[188:189], v245 offset:4096
    ds_read_b64_tr_b16 v[190:191], v245 offset:5120
    s_waitcnt vmcnt(4) lgkmcnt(0)
    v_mfma_f32_32x32x16_bf16 v[0:15], v[88:91], v[176:179], v[0:15]
    v_fmac_f32 v255, v22, v158
    v_fmac_f32 v255, v23, v159
    v_fmac_f32 v201, v24, v168
    v_fmac_f32 v201, v25, v169
    v_permlane32_swap_b32 v197, v255
    s_add_u32 m0, s21, 4096
    v_mfma_f32_32x32x16_bf16 v[48:63], v[92:95], v[176:179], v[48:63]
    v_mad_u32_u16 v238, v238, s3, v246 op_sel:[1,0,0,0]
    v_mad_u32_u16 v239, v239, s3, v246 op_sel:[1,0,0,0]
    buffer_load_dwordx4 v238, s[4:7], s40 offen  lds
    buffer_load_dwordx4 v239, s[8:11], s40 offen offset:1024  lds
    ds_read_b64_tr_b16 v[176:177], v244 offset:6144
    ds_read_b64_tr_b16 v[178:179], v244 offset:7168
    ds_read_b64_tr_b16 v[192:193], v245 offset:6144
    ds_read_b64_tr_b16 v[194:195], v245 offset:7168
    s_waitcnt lgkmcnt(0)
    s_mov_b64 exec, s[56:57]
    v_xor_b32 v68, 0x80008000, v68
    v_xor_b32 v69, 0x80008000, v69
    v_xor_b32 v70, 0x80008000, v70
    v_xor_b32 v71, 0x80008000, v71
    s_mov_b64 exec, -1
    v_mfma_f32_32x32x16_bf16 v[0:15], v[64:67], v[176:179], v[0:15]
    v_fmac_f32 v201, v26, v170
    v_fmac_f32 v201, v27, v171
    v_fmac_f32 v201, v28, v172
    v_fmac_f32 v201, v29, v173
    v_fmac_f32 v201, v30, v174
    v_fmac_f32 v201, v31, v175
    s_add_u32 m0, s21, 6144
    v_mfma_f32_32x32x16_bf16 v[48:63], v[68:71], v[176:179], v[48:63]
    v_mad_u32_u16 v240, v240, s3, v246 op_sel:[1,0,0,0]
    v_mad_u32_u16 v241, v241, s3, v246 op_sel:[1,0,0,0]
    buffer_load_dwordx4 v240, s[4:7], s41 offen  lds
    buffer_load_dwordx4 v241, s[8:11], s41 offen offset:1024  lds
    v_add_f32 v255, v197, v255
    s_set_gpr_idx_on s51, gpr_idx(DST)
    s_nop 0
    v_cvt_pk_bf16_f32 v206, v254, v255
    s_set_gpr_idx_off
    v_mfma_f32_32x32x16_bf16 v[16:31], v[72:75], v[180:183], 0
    v_mul_f32 v254, v0, v144
    v_fmac_f32 v254, v1, v145
    v_fmac_f32 v254, v2, v146
    v_fmac_f32 v254, v3, v147
    v_fmac_f32 v254, v4, v148
    v_fmac_f32 v254, v5, v149
    v_mfma_f32_32x32x16_bf16 v[32:47], v[76:79], v[180:183], v[32:47]
    v_fmac_f32 v254, v6, v150
    v_fmac_f32 v254, v7, v151
    v_fma_f32 v202, v8, -v160, v202
    v_fma_f32 v202, v9, -v161, v202
    v_permlane32_swap_b32 v254, v200
    v_fma_f32 v202, v10, -v162, v202
    v_mfma_f32_32x32x16_bf16 v[16:31], v[80:83], v[184:187], v[16:31]
    v_fma_f32 v202, v11, -v163, v202
    v_fma_f32 v202, v12, -v164, v202
    v_fma_f32 v202, v13, -v165, v202
    v_fma_f32 v202, v14, -v166, v202
    v_fma_f32 v202, v15, -v167, v202
    v_add_f32 v200, v254, v200
    v_mfma_f32_32x32x16_bf16 v[32:47], v[84:87], v[184:187], v[32:47]
    v_fmac_f32 v198, v48, v112
    v_permlane32_swap_b32 v202, v254
    v_fmac_f32 v198, v49, v113
    v_fmac_f32 v198, v50, v114
    v_fmac_f32 v198, v51, v115
    v_fmac_f32 v198, v52, v116
    v_mfma_f32_32x32x16_bf16 v[16:31], v[88:91], v[188:191], v[16:31]
    v_fmac_f32 v198, v53, v117
    v_fmac_f32 v198, v54, v118
    v_fmac_f32 v198, v55, v119
    v_add_f32 v254, v202, v254
    v_mul_f32 v196, v56, v160
    v_fmac_f32 v196, v57, v161
    v_mfma_f32_32x32x16_bf16 v[32:47], v[92:95], v[188:191], v[32:47]
    s_waitcnt vmcnt(6)
    ds_read_b64_tr_b16 v[176:177], v244 offset:0
    ds_read_b64_tr_b16 v[178:179], v244 offset:1024
    ds_read_b64_tr_b16 v[180:181], v245 offset:0
    ds_read_b64_tr_b16 v[182:183], v245 offset:1024
    v_fmac_f32 v196, v58, v162
    v_fmac_f32 v196, v59, v163
    v_mfma_f32_32x32x16_bf16 v[16:31], v[64:67], v[192:195], v[16:31]
    v_fmac_f32 v196, v60, v164
    v_fmac_f32 v196, v61, v165
    v_fmac_f32 v196, v62, v166
    v_fmac_f32 v196, v63, v167
    s_nop 1
    v_permlane32_swap_b32 v198, v196
    v_add_f32 v196, v198, v196
    v_mfma_f32_32x32x16_bf16 v[32:47], v[68:71], v[192:195], v[32:47]
    v_add_u32 v249, s48, v249
    v_add_u32 v250, s49, v250
    s_nop 0
    v_mul_f32 v255, v16, v152
    v_fmac_f32 v255, v17, v153
    v_fmac_f32 v255, v18, v154
    v_fmac_f32 v255, v19, v155
    v_fmac_f32 v255, v20, v156
    v_fmac_f32 v255, v21, v157
    v_fmac_f32 v255, v22, v158
    v_fmac_f32 v255, v23, v159
    v_fma_f32 v203, v24, -v168, v203
    v_fma_f32 v203, v25, -v169, v203
    v_permlane32_swap_b32 v255, v201
    v_fma_f32 v203, v26, -v170, v203
    v_fma_f32 v203, v27, -v171, v203
    v_fma_f32 v203, v28, -v172, v203
    v_fma_f32 v203, v29, -v173, v203
    v_fma_f32 v203, v30, -v174, v203
    v_fma_f32 v203, v31, -v175, v203
    v_add_f32 v201, v255, v201
    v_fmac_f32 v199, v32, v120
    v_permlane32_swap_b32 v203, v255
    v_fmac_f32 v199, v33, v121
    v_fmac_f32 v199, v34, v122
    v_fmac_f32 v199, v35, v123
    ds_read_b64_tr_b16 v[72:73], v249 offset:0
    ds_read_b64_tr_b16 v[76:77], v249 offset:64
    ds_read_b64_tr_b16 v[74:75], v249 offset:256
    ds_read_b64_tr_b16 v[78:79], v249 offset:320
    s_mov_b64 exec, s[54:55]
    ds_read_u16_d16_hi v242, v250 offset:0
    s_mov_b64 exec, -1
    v_fmac_f32 v199, v36, v124
    v_fmac_f32 v199, v37, v125
    v_fmac_f32 v199, v38, v126
    v_fmac_f32 v199, v39, v127
    v_add_f32 v255, v203, v255
    v_mul_f32 v197, v40, v168
    v_fmac_f32 v197, v41, v169
    v_fmac_f32 v197, v42, v170
    v_fmac_f32 v197, v43, v171
    v_fmac_f32 v197, v44, v172
    v_fmac_f32 v197, v45, v173
    v_fmac_f32 v197, v46, v174
    v_fmac_f32 v197, v47, v175
    s_nop 1
    v_permlane32_swap_b32 v199, v197
    v_add_f32 v197, v199, v197
    s_set_gpr_idx_on s51, gpr_idx(DST)
    s_nop 0
    v_cvt_pk_bf16_f32 v207, v200, v201
    v_cvt_pk_bf16_f32 v209, v254, v255
    v_cvt_pk_bf16_f32 v208, v196, v197
    s_set_gpr_idx_off
    s_add_u32 s50, s50, 1
    s_add_u32 s51, s51, 6
    s_cmp_ge_u32 s50, 4
    s_cbranch_scc1 LAST0
    s_add_u32 s53, s53, 4
    s_xor_b32 s66, s53, s20
    s_bitcmp1_b32 s66, 2
    s_setprio 1
    s_cbranch_scc1 PRIO_9
    s_setprio 0
PRIO_9:
    s_cmp_eq_u32 s52, 4
    s_cbranch_scc1 ITEM_0_4
    s_cmp_eq_u32 s52, 5
    s_cbranch_scc1 ITEM_0_5
    s_cmp_eq_u32 s52, 3
    s_cbranch_scc1 ITEM_0_3
    s_cmp_eq_u32 s52, 6
    s_cbranch_scc1 ITEM_0_6
    s_cmp_eq_u32 s52, 8
    s_cbranch_scc1 ITEM_0_8
    s_branch ITEM_0_2
.p2align 6
ITEM_0_2:
    s_mov_b32 m0, s50
    s_nop 0
    s_movrels_b32 s71, s23
    s_bfe_u32 s46, s71, 0x30012
    s_mov_b32 m0, s46
    s_and_b32 s66, s71, 0x3ffff
    s_movrels_b32 s68, s57
    s_movrels_b32 s69, s61
    s_sub_u32 s48, s66, s47
    s_mov_b32 s47, s66
    s_lshr_b32 s52, s71, 28
    s_lshl_b32 s67, s46, 9
    s_add_u32 s66, s66, s67
    s_sub_u32 s49, s66, s42
    s_mov_b32 s42, s66
    s_bfe_u32 s66, s68, 655360
    s_add_u32 s43, s42, s66
    s_bfe_u32 s39, s69, 655360
    s_bfe_u32 s66, s68, 655370
    s_add_u32 s44, s42, s66
    s_bfe_u32 s40, s69, 655370
    s_bfe_u32 s66, s68, 655380
    s_add_u32 s45, s42, s66
    s_bfe_u32 s41, s69, 655380
    s_and_b32 s66, s46, s33
    s_cselect_b32 s72, -1, 1
    s_cselect_b32 s76, s47, 163712
    s_cmp_ge_u32 s66, 2
    s_cselect_b32 s73, -1, 0
    s_add_u32 s77, s47, 1024
    s_cmp_ge_u32 s66, 4
    s_cselect_b32 s75, -1, 0
    s_cmp_ge_u32 s66, 3
    s_cselect_b32 s74, -1, 1
    s_cselect_b32 s77, s77, 163712
    v_add_u32 v252, s42, v247
    ds_read2_b32 v[234:235], v252 offset0:0 offset1:16
    v_add_u32 v252, s43, v247
    ds_read2_b32 v[236:237], v252 offset0:0 offset1:16
    v_add_u32 v252, s44, v247
    ds_read2_b32 v[238:239], v252 offset0:0 offset1:16
    v_add_u32 v252, s45, v247
    ds_read2_b32 v[240:241], v252 offset0:0 offset1:16
    s_waitcnt lgkmcnt(4)
    v_mul_f32_dpp v196, v242, v72 row_newbcast:0 row_mask:0xf bank_mask:0xf
    v_mul_f32_dpp v197, v242, v73 row_newbcast:1 row_mask:0xf bank_mask:0xf
    v_mul_f32_dpp v198, v242, v72 row_newbcast:8 row_mask:0xf bank_mask:0xf
    v_mul_f32_dpp v199, v242, v73 row_newbcast:9 row_mask:0xf bank_mask:0xf
    v_mul_f32_dpp v200, v242, v76 row_newbcast:2 row_mask:0xf bank_mask:0xf
    v_mul_f32_dpp v201, v242, v77 row_newbcast:3 row_mask:0xf bank_mask:0xf
    v_mul_f32_dpp v202, v242, v76 row_newbcast:10 row_mask:0xf bank_mask:0xf
    v_mul_f32_dpp v203, v242, v77 row_newbcast:11 row_mask:0xf bank_mask:0xf
    v_cvt_pk_bf16_f32 v72, v196, v197
    v_cvt_pk_bf16_f32 v76, v198, v199
    v_cvt_pk_bf16_f32 v73, v200, v201
    v_cvt_pk_bf16_f32 v77, v202, v203
    v_mul_f32_dpp v196, v242, v74 row_newbcast:4 row_mask:0xf bank_mask:0xf
    v_mul_f32_dpp v197, v242, v75 row_newbcast:5 row_mask:0xf bank_mask:0xf
    v_mul_f32_dpp v198, v242, v74 row_newbcast:12 row_mask:0xf bank_mask:0xf
    v_mul_f32_dpp v199, v242, v75 row_newbcast:13 row_mask:0xf bank_mask:0xf
    v_mul_f32_dpp v200, v242, v78 row_newbcast:6 row_mask:0xf bank_mask:0xf
    v_mul_f32_dpp v201, v242, v79 row_newbcast:7 row_mask:0xf bank_mask:0xf
    v_mul_f32_dpp v202, v242, v78 row_newbcast:14 row_mask:0xf bank_mask:0xf
    v_mul_f32_dpp v203, v242, v79 row_newbcast:15 row_mask:0xf bank_mask:0xf
    v_cvt_pk_bf16_f32 v74, v196, v197
    v_cvt_pk_bf16_f32 v78, v198, v199
    v_cvt_pk_bf16_f32 v75, v200, v201
    v_cvt_pk_bf16_f32 v79, v202, v203
    s_nop 0
    s_waitcnt lgkmcnt(3)
    v_mfma_f32_32x32x16_bf16 v[56:71], v[72:75], v[176:179], 0
    s_add_u32 m0, s21, 0
    v_mfma_f32_32x32x16_bf16 v[16:31], v[76:79], v[176:179], 0
    v_mad_u32_u16 v234, v234, s3, v246 op_sel:[1,0,0,0]
    v_mad_u32_u16 v235, v235, s3, v246 op_sel:[1,0,0,0]
    buffer_load_dwordx4 v234, s[4:7], s38 offen  lds
    buffer_load_dwordx4 v235, s[8:11], s38 offen offset:1024  lds
    v_mfma_f32_32x32x16_bf16 v[32:47], v[72:75], v[180:183], 0
    s_nop 4
    v_mul_f32 v196, v56, v96
    v_fmac_f32 v196, v57, v97
    v_fmac_f32 v196, v58, v98
    v_fmac_f32 v196, v59, v99
    v_fmac_f32 v196, v60, v100
    v_fmac_f32 v196, v61, v101
    v_mfma_f32_32x32x16_bf16 v[0:15], v[76:79], v[180:183], 0
    s_waitcnt vmcnt(6)
    ds_read_b64_tr_b16 v[176:177], v244 offset:2048
    ds_read_b64_tr_b16 v[178:179], v244 offset:3072
    ds_read_b64_tr_b16 v[180:181], v245 offset:2048
    ds_read_b64_tr_b16 v[182:183], v245 offset:3072
    v_fmac_f32 v196, v62, v102
    v_fmac_f32 v196, v63, v103
    v_mul_f32 v198, v64, v128
    v_fmac_f32 v198, v65, v129
    v_fmac_f32 v198, v66, v130
    v_fmac_f32 v198, v67, v131
    v_fmac_f32 v198, v68, v132
    v_fmac_f32 v198, v69, v133
    v_fmac_f32 v198, v70, v134
    v_fmac_f32 v198, v71, v135
    v_mul_f32 v200, v16, v128
    v_fmac_f32 v200, v17, v129
    v_permlane32_swap_b32 v196, v198
    v_fmac_f32 v200, v18, v130
    v_fmac_f32 v200, v19, v131
    v_fmac_f32 v200, v20, v132
    v_fmac_f32 v200, v21, v133
    v_fmac_f32 v200, v22, v134
    v_fmac_f32 v200, v23, v135
    v_add_f32 v198, v196, v198
    v_mul_f32_e64 v202, v24, -v128
    v_fma_f32 v202, v25, -v129, v202
    v_fma_f32 v202, v26, -v130, v202
    v_fma_f32 v202, v27, -v131, v202
    v_fma_f32 v202, v28, -v132, v202
    v_fma_f32 v202, v29, -v133, v202
    v_fma_f32 v202, v30, -v134, v202
    v_fma_f32 v202, v31, -v135, v202
    s_nop 1
    v_permlane32_swap_b32 v200, v202
    v_add_f32 v202, v200, v202
    s_waitcnt lgkmcnt(0)
    v_mfma_f32_32x32x16_bf16 v[56:71], v[72:75], v[176:179], 0
    v_mul_f32 v197, v32, v104
    v_fmac_f32 v197, v33, v105
    v_fmac_f32 v197, v34, v106
    v_fmac_f32 v197, v35, v107
    v_fmac_f32 v197, v36, v108
    v_fmac_f32 v197, v37, v109
    s_add_u32 m0, s21, 2048
    v_mfma_f32_32x32x16_bf16 v[16:31], v[76:79], v[176:179], 0
    v_mad_u32_u16 v236, v236, s3, v246 op_sel:[1,0,0,0]
    v_mad_u32_u16 v237, v237, s3, v246 op_sel:[1,0,0,0]
    buffer_load_dwordx4 v236, s[4:7], s39 offen  lds
    buffer_load_dwordx4 v237, s[8:11], s39 offen offset:1024  lds
    v_fmac_f32 v197, v38, v110
    v_fmac_f32 v197, v39, v111
    v_mul_f32 v199, v40, v136
    v_fmac_f32 v199, v41, v137
    v_fmac_f32 v199, v42, v138
    v_fmac_f32 v199, v43, v139
    v_fmac_f32 v199, v44, v140
    v_fmac_f32 v199, v45, v141
    v_fmac_f32 v199, v46, v142
    v_fmac_f32 v199, v47, v143
    v_mul_f32 v201, v0, v136
    v_fmac_f32 v201, v1, v137
    v_permlane32_swap_b32 v197, v199
    v_fmac_f32 v201, v2, v138
    v_fmac_f32 v201, v3, v139
    v_fmac_f32 v201, v4, v140
    v_fmac_f32 v201, v5, v141
    v_fmac_f32 v201, v6, v142
    v_fmac_f32 v201, v7, v143
    v_add_f32 v199, v197, v199
    v_mul_f32_e64 v203, v8, -v136
    v_fma_f32 v203, v9, -v137, v203
    v_fma_f32 v203, v10, -v138, v203
    v_fma_f32 v203, v11, -v139, v203
    v_fma_f32 v203, v12, -v140, v203
    v_fma_f32 v203, v13, -v141, v203
    v_fma_f32 v203, v14, -v142, v203
    v_fma_f32 v203, v15, -v143, v203
    s_nop 1
    v_permlane32_swap_b32 v201, v203
    v_add_f32 v203, v201, v203
    s_set_gpr_idx_on s51, gpr_idx(DST)
    s_nop 0
    v_cvt_pk_bf16_f32 v204, v198, v199
    v_cvt_pk_bf16_f32 v205, v202, v203
    s_set_gpr_idx_off
    v_mfma_f32_32x32x16_bf16 v[32:47], v[72:75], v[180:183], 0
    v_mul_f32 v196, v56, v144
    v_fmac_f32 v196, v57, v145
    v_fmac_f32 v196, v58, v146
    v_fmac_f32 v196, v59, v147
    v_fmac_f32 v196, v60, v148
    v_fmac_f32 v196, v61, v149
    v_mfma_f32_32x32x16_bf16 v[0:15], v[76:79], v[180:183], 0
    s_waitcnt vmcnt(6)
    ds_read_b64_tr_b16 v[176:177], v244 offset:4096
    ds_read_b64_tr_b16 v[178:179], v244 offset:5120
    ds_read_b64_tr_b16 v[180:181], v245 offset:4096
    ds_read_b64_tr_b16 v[182:183], v245 offset:5120
    v_fmac_f32 v196, v62, v150
    v_fmac_f32 v196, v63, v151
    v_mul_f32_e64 v200, v16, -v160
    v_fma_f32 v200, v17, -v161, v200
    v_fma_f32 v200, v18, -v162, v200
    v_fma_f32 v200, v19, -v163, v200
    v_fma_f32 v200, v20, -v164, v200
    v_fma_f32 v200, v21, -v165, v200
    v_fma_f32 v200, v22, -v166, v200
    v_fma_f32 v200, v23, -v167, v200
    v_mul_f32_e64 v202, v24, -v160
    v_fma_f32 v202, v25, -v161, v202
    v_fma_f32 v202, v26, -v162, v202
    v_fma_f32 v202, v27, -v163, v202
    v_fma_f32 v202, v28, -v164, v202
    v_fma_f32 v202, v29, -v165, v202
    v_fma_f32 v202, v30, -v166, v202
    v_fma_f32 v202, v31, -v167, v202
    s_waitcnt lgkmcnt(0)
    v_mfma_f32_32x32x16_bf16 v[16:31], v[72:75], v[176:179], 0
    v_mul_f32 v197, v32, v152
    v_fmac_f32 v197, v33, v153
    v_fmac_f32 v197, v34, v154
    v_fmac_f32 v197, v35, v155
    v_fmac_f32 v197, v36, v156
    v_fmac_f32 v197, v37, v157
    s_add_u32 m0, s21, 4096
    v_mfma_f32_32x32x16_bf16 v[48:63], v[76:79], v[176:179], 0
    v_mad_u32_u16 v238, v238, s3, v246 op_sel:[1,0,0,0]
    v_mad_u32_u16 v239, v239, s3, v246 op_sel:[1,0,0,0]
    buffer_load_dwordx4 v238, s[4:7], s40 offen  lds
    buffer_load_dwordx4 v239, s[8:11], s40 offen offset:1024  lds
    v_fmac_f32 v197, v38, v158
    v_fmac_f32 v197, v39, v159
    v_mul_f32_e64 v201, v0, -v168
    v_fma_f32 v201, v1, -v169, v201
    v_fma_f32 v201, v2, -v170, v201
    v_fma_f32 v201, v3, -v171, v201
    v_fma_f32 v201, v4, -v172, v201
    v_fma_f32 v201, v5, -v173, v201
    v_fma_f32 v201, v6, -v174, v201
    v_fma_f32 v201, v7, -v175, v201
    v_mul_f32_e64 v203, v8, -v168
    v_fma_f32 v203, v9, -v169, v203
    v_fma_f32 v203, v10, -v170, v203
    v_fma_f32 v203, v11, -v171, v203
    v_fma_f32 v203, v12, -v172, v203
    v_fma_f32 v203, v13, -v173, v203
    v_fma_f32 v203, v14, -v174, v203
    v_fma_f32 v203, v15, -v175, v203
    v_mfma_f32_32x32x16_bf16 v[0:15], v[72:75], v[180:183], 0
    v_fmac_f32 v200, v24, v160
    v_fmac_f32 v200, v25, v161
    v_fmac_f32 v200, v26, v162
    v_fmac_f32 v200, v27, v163
    v_fmac_f32 v200, v28, v164
    v_fmac_f32 v200, v29, v165
    v_fmac_f32 v200, v30, v166
    v_fmac_f32 v200, v31, v167
    v_mfma_f32_32x32x16_bf16 v[24:39], v[76:79], v[180:183], 0
    v_add_u32 v253, s47, v248
    ds_read_b32 v192, v253
    ds_read_b32 v193, v253 offset:256
    s_waitcnt vmcnt(6)
    ds_read_b64_tr_b16 v[176:177], v244 offset:6144
    ds_read_b64_tr_b16 v[178:179], v244 offset:7168
    ds_read_b64_tr_b16 v[180:181], v245 offset:6144
    ds_read_b64_tr_b16 v[182:183], v245 offset:7168
    v_mul_f32 v254, v16, v144
    v_fmac_f32 v254, v17, v145
    v_fmac_f32 v254, v18, v146
    v_fmac_f32 v254, v19, v147
    v_fmac_f32 v254, v20, v148
    v_fmac_f32 v254, v21, v149
    v_fmac_f32 v254, v22, v150
    v_fmac_f32 v254, v23, v151
    v_sub_f32_e64 v64, -v48, v64
    v_sub_f32_e64 v65, -v49, v65
    v_permlane32_swap_b32 v196, v254
    v_sub_f32_e64 v66, -v50, v66
    v_sub_f32_e64 v67, -v51, v67
    v_sub_f32_e64 v68, -v52, v68
    v_sub_f32_e64 v69, -v53, v69
    v_sub_f32_e64 v70, -v54, v70
    v_sub_f32_e64 v71, -v55, v71
    v_add_f32 v254, v196, v254
    s_waitcnt lgkmcnt(0)
    v_mfma_f32_32x32x16_bf16 v[56:71], v[76:79], v[176:179], v[56:71]
    v_sub_f32_e64 v40, -v24, v40
    v_sub_f32_e64 v41, -v25, v41
    v_sub_f32_e64 v42, -v26, v42
    v_sub_f32_e64 v43, -v27, v43
    v_sub_f32_e64 v44, -v28, v44
    v_sub_f32_e64 v45, -v29, v45
    v_sub_f32_e64 v46, -v30, v46
    v_sub_f32_e64 v47, -v31, v47
    s_mov_b32 m0, s76
    s_mov_b64 exec, s[72:73]
    buffer_load_dwordx4 v192, s[12:15], 0 offen  lds
    s_mov_b32 m0, s77
    s_mov_b64 exec, s[74:75]
    buffer_load_dwordx4 v193, s[12:15], 0 offen  lds
    s_mov_b64 exec, -1
    s_add_u32 m0, s21, 6144
    v_mfma_f32_32x32x16_bf16 v[16:31], v[72:75], v[176:179], 0
    v_mad_u32_u16 v240, v240, s3, v246 op_sel:[1,0,0,0]
    v_mad_u32_u16 v241, v241, s3, v246 op_sel:[1,0,0,0]
    buffer_load_dwordx4 v240, s[4:7], s41 offen  lds
    buffer_load_dwordx4 v241, s[8:11], s41 offen offset:1024  lds
    v_mul_f32 v255, v0, v152
    v_fmac_f32 v255, v1, v153
    v_fmac_f32 v255, v2, v154
    v_fmac_f32 v255, v3, v155
    v_fmac_f32 v255, v4, v156
    v_fmac_f32 v255, v5, v157
    v_fmac_f32 v255, v6, v158
    v_fmac_f32 v255, v7, v159
    v_fmac_f32 v201, v8, v168
    v_fmac_f32 v201, v9, v169
    v_permlane32_swap_b32 v197, v255
    v_fmac_f32 v201, v10, v170
    v_fmac_f32 v201, v11, v171
    v_fmac_f32 v201, v12, v172
    v_fmac_f32 v201, v13, v173
    v_fmac_f32 v201, v14, v174
    v_fmac_f32 v201, v15, v175
    v_add_f32 v255, v197, v255
    s_set_gpr_idx_on s51, gpr_idx(DST)
    s_nop 0
    v_cvt_pk_bf16_f32 v206, v254, v255
    s_set_gpr_idx_off
    v_mfma_f32_32x32x16_bf16 v[0:15], v[72:75], v[180:183], 0
    v_mul_f32 v254, v16, v144
    v_fmac_f32 v254, v17, v145
    v_fmac_f32 v254, v18, v146
    v_fmac_f32 v254, v19, v147
    v_fmac_f32 v254, v20, v148
    v_fmac_f32 v254, v21, v149
    v_mfma_f32_32x32x16_bf16 v[32:47], v[76:79], v[180:183], v[32:47]
    s_waitcnt vmcnt(8)
    ds_read_b64_tr_b16 v[176:177], v244 offset:0
    ds_read_b64_tr_b16 v[178:179], v244 offset:1024
    ds_read_b64_tr_b16 v[180:181], v245 offset:0
    ds_read_b64_tr_b16 v[182:183], v245 offset:1024
    v_add_u32 v249, s48, v249
    v_add_u32 v250, s49, v250
    v_fmac_f32 v254, v22, v150
    v_fmac_f32 v254, v23, v151
    v_fma_f32 v202, v24, -v160, v202
    v_fma_f32 v202, v25, -v161, v202
    v_permlane32_swap_b32 v254, v200
    v_fma_f32 v202, v26, -v162, v202
    v_fma_f32 v202, v27, -v163, v202
    v_fma_f32 v202, v28, -v164, v202
    v_fma_f32 v202, v29, -v165, v202
    v_fma_f32 v202, v30, -v166, v202
    v_fma_f32 v202, v31, -v167, v202
    v_add_f32 v200, v254, v200
    v_mul_f32_e64 v198, v64, -v112
    v_permlane32_swap_b32 v202, v254
    v_fma_f32 v198, v65, -v113, v198
    v_fma_f32 v198, v66, -v114, v198
    v_fma_f32 v198, v67, -v115, v198
    v_fma_f32 v198, v68, -v116, v198
    v_fma_f32 v198, v69, -v117, v198
    v_fma_f32 v198, v70, -v118, v198
    v_fma_f32 v198, v71, -v119, v198
    v_add_f32 v254, v202, v254
    v_mul_f32 v196, v56, v160
    v_fmac_f32 v196, v57, v161
    v_fmac_f32 v196, v58, v162
    v_fmac_f32 v196, v59, v163
    v_fmac_f32 v196, v60, v164
    v_fmac_f32 v196, v61, v165
    v_fmac_f32 v196, v62, v166
    v_fmac_f32 v196, v63, v167
    s_nop 1
    v_permlane32_swap_b32 v198, v196
    v_add_f32 v196, v198, v196
    v_mul_f32 v255, v0, v152
    v_fmac_f32 v255, v1, v153
    v_fmac_f32 v255, v2, v154
    v_fmac_f32 v255, v3, v155
    v_fmac_f32 v255, v4, v156
    v_fmac_f32 v255, v5, v157
    v_fmac_f32 v255, v6, v158
    v_fmac_f32 v255, v7, v159
    v_fma_f32 v203, v8, -v168, v203
    v_fma_f32 v203, v9, -v169, v203
    v_permlane32_swap_b32 v255, v201
    v_fma_f32 v203, v10, -v170, v203
    v_fma_f32 v203, v11, -v171, v203
    v_fma_f32 v203, v12, -v172, v203
    v_fma_f32 v203, v13, -v173, v203
    v_fma_f32 v203, v14, -v174, v203
    v_fma_f32 v203, v15, -v175, v203
    v_add_f32 v201, v255, v201
    v_mul_f32_e64 v199, v40, -v120
    v_permlane32_swap_b32 v203, v255
    v_fma_f32 v199, v41, -v121, v199
    v_fma_f32 v199, v42, -v122, v199
    v_fma_f32 v199, v43, -v123, v199
    s_waitcnt vmcnt(2)
    ds_read_b64_tr_b16 v[72:73], v249 offset:0
    ds_read_b64_tr_b16 v[76:77], v249 offset:64
    ds_read_b64_tr_b16 v[74:75], v249 offset:256
    ds_read_b64_tr_b16 v[78:79], v249 offset:320
    s_mov_b64 exec, s[54:55]
    ds_read_u16_d16_hi v242, v250 offset:0
    s_mov_b64 exec, -1
    v_fma_f32 v199, v44, -v124, v199
    v_fma_f32 v199, v45, -v125, v199
    v_fma_f32 v199, v46, -v126, v199
    v_fma_f32 v199, v47, -v127, v199
    v_add_f32 v255, v203, v255
    v_mul_f32 v197, v32, v168
    v_fmac_f32 v197, v33, v169
    v_fmac_f32 v197, v34, v170
    v_fmac_f32 v197, v35, v171
    v_fmac_f32 v197, v36, v172
    v_fmac_f32 v197, v37, v173
    v_fmac_f32 v197, v38, v174
    v_fmac_f32 v197, v39, v175
    s_nop 1
    v_permlane32_swap_b32 v199, v197
    v_add_f32 v197, v199, v197
    s_set_gpr_idx_on s51, gpr_idx(DST)
    s_nop 0
    v_cvt_pk_bf16_f32 v207, v200, v201
    v_cvt_pk_bf16_f32 v209, v254, v255
    v_cvt_pk_bf16_f32 v208, v196, v197
    s_set_gpr_idx_off
    s_add_u32 s50, s50, 1
    s_add_u32 s51, s51, 6
    s_cmp_ge_u32 s50, 4
    s_cbranch_scc1 LAST0
    s_add_u32 s53, s53, 4
    s_xor_b32 s66, s53, s20
    s_bitcmp1_b32 s66, 2
    s_setprio 1
    s_cbranch_scc1 PRIO_10
    s_setprio 0
PRIO_10:
    s_cmp_eq_u32 s52, 4
    s_cbranch_scc1 ITEM_0_4
    s_cmp_eq_u32 s52, 5
    s_cbranch_scc1 ITEM_0_5
    s_cmp_eq_u32 s52, 3
    s_cbranch_scc1 ITEM_0_3
    s_cmp_eq_u32 s52, 6
    s_cbranch_scc1 ITEM_0_6
    s_cmp_eq_u32 s52, 8
    s_cbranch_scc1 ITEM_0_8
    s_branch ITEM_0_2
.p2align 6
ITEM_1_4:
    s_mov_b64 exec, s[54:55]
    ds_read_u16_d16_hi v243, v250 offset:128
    s_mov_b64 exec, -1
    ds_read_b64_tr_b16 v[80:81], v249 offset:512
    ds_read_b64_tr_b16 v[84:85], v249 offset:576
    ds_read_b64_tr_b16 v[82:83], v249 offset:768
    ds_read_b64_tr_b16 v[86:87], v249 offset:832
    s_waitcnt lgkmcnt(5)
    v_mul_f32_dpp v196, v242, v72 row_newbcast:0 row_mask:0xf bank_mask:0xf
    v_mul_f32_dpp v197, v242, v73 row_newbcast:1 row_mask:0xf bank_mask:0xf
    v_mul_f32_dpp v198, v242, v72 row_newbcast:8 row_mask:0xf bank_mask:0xf
    v_mul_f32_dpp v199, v242, v73 row_newbcast:9 row_mask:0xf bank_mask:0xf
    v_mul_f32_dpp v200, v242, v76 row_newbcast:2 row_mask:0xf bank_mask:0xf
    v_mul_f32_dpp v201, v242, v77 row_newbcast:3 row_mask:0xf bank_mask:0xf
    v_mul_f32_dpp v202, v242, v76 row_newbcast:10 row_mask:0xf bank_mask:0xf
    v_mul_f32_dpp v203, v242, v77 row_newbcast:11 row_mask:0xf bank_mask:0xf
    v_cvt_pk_bf16_f32 v72, v196, v197
    v_cvt_pk_bf16_f32 v76, v198, v199
    v_cvt_pk_bf16_f32 v73, v200, v201
    v_cvt_pk_bf16_f32 v77, v202, v203
    v_mul_f32_dpp v196, v242, v74 row_newbcast:4 row_mask:0xf bank_mask:0xf
    v_mul_f32_dpp v197, v242, v75 row_newbcast:5 row_mask:0xf bank_mask:0xf
    v_mul_f32_dpp v198, v242, v74 row_newbcast:12 row_mask:0xf bank_mask:0xf
    v_mul_f32_dpp v199, v242, v75 row_newbcast:13 row_mask:0xf bank_mask:0xf
    v_mul_f32_dpp v200, v242, v78 row_newbcast:6 row_mask:0xf bank_mask:0xf
    v_mul_f32_dpp v201, v242, v79 row_newbcast:7 row_mask:0xf bank_mask:0xf
    v_mul_f32_dpp v202, v242, v78 row_newbcast:14 row_mask:0xf bank_mask:0xf
    v_mul_f32_dpp v203, v242, v79 row_newbcast:15 row_mask:0xf bank_mask:0xf
    v_cvt_pk_bf16_f32 v74, v196, v197
    v_cvt_pk_bf16_f32 v78, v198, v199
    v_cvt_pk_bf16_f32 v75, v200, v201
    v_cvt_pk_bf16_f32 v79, v202, v203
    s_waitcnt vmcnt(4) lgkmcnt(0)
    v_mfma_f32_32x32x16_bf16 v[56:71], v[72:75], v[176:179], 0
    v_mul_f32_dpp v196, v243, v80 row_newbcast:0 row_mask:0xf bank_mask:0xf
    v_mul_f32_dpp v197, v243, v81 row_newbcast:1 row_mask:0xf bank_mask:0xf
    v_mul_f32_dpp v198, v243, v80 row_newbcast:8 row_mask:0xf bank_mask:0xf
    v_mul_f32_dpp v199, v243, v81 row_newbcast:9 row_mask:0xf bank_mask:0xf
    v_mul_f32_dpp v200, v243, v84 row_newbcast:2 row_mask:0xf bank_mask:0xf
    v_mul_f32_dpp v201, v243, v85 row_newbcast:3 row_mask:0xf bank_mask:0xf
    s_add_u32 m0, s21, 0
    v_mfma_f32_32x32x16_bf16 v[16:31], v[76:79], v[176:179], 0
    buffer_load_dwordx4 v234, s[4:7], s36 offen  lds
    buffer_load_dwordx4 v235, s[8:11], s36 offen offset:1024  lds
    ds_read_b64_tr_b16 v[176:177], v244 offset:2048
    ds_read_b64_tr_b16 v[178:179], v244 offset:3072
    ds_read_b64_tr_b16 v[184:185], v245 offset:2048
    ds_read_b64_tr_b16 v[186:187], v245 offset:3072
    v_mul_f32_dpp v202, v243, v84 row_newbcast:10 row_mask:0xf bank_mask:0xf
    v_mul_f32_dpp v203, v243, v85 row_newbcast:11 row_mask:0xf bank_mask:0xf
    v_cvt_pk_bf16_f32 v80, v196, v197
    v_cvt_pk_bf16_f32 v84, v198, v199
    v_cvt_pk_bf16_f32 v81, v200, v201
    v_cvt_pk_bf16_f32 v85, v202, v203
    v_mul_f32_dpp v196, v243, v82 row_newbcast:4 row_mask:0xf bank_mask:0xf
    v_mul_f32_dpp v197, v243, v83 row_newbcast:5 row_mask:0xf bank_mask:0xf
    v_mul_f32_dpp v198, v243, v82 row_newbcast:12 row_mask:0xf bank_mask:0xf
    v_mul_f32_dpp v199, v243, v83 row_newbcast:13 row_mask:0xf bank_mask:0xf
    v_mul_f32_dpp v200, v243, v86 row_newbcast:6 row_mask:0xf bank_mask:0xf
    v_mul_f32_dpp v201, v243, v87 row_newbcast:7 row_mask:0xf bank_mask:0xf
    v_mul_f32_dpp v202, v243, v86 row_newbcast:14 row_mask:0xf bank_mask:0xf
    v_mul_f32_dpp v203, v243, v87 row_newbcast:15 row_mask:0xf bank_mask:0xf
    v_cvt_pk_bf16_f32 v82, v196, v197
    v_cvt_pk_bf16_f32 v86, v198, v199
    v_cvt_pk_bf16_f32 v83, v200, v201
    v_cvt_pk_bf16_f32 v87, v202, v203
    s_waitcnt lgkmcnt(0)
    v_mfma_f32_32x32x16_bf16 v[56:71], v[80:83], v[176:179], v[56:71]
    s_add_u32 m0, s21, 2048
    v_mfma_f32_32x32x16_bf16 v[16:31], v[84:87], v[176:179], v[16:31]
    buffer_load_dwordx4 v236, s[4:7], s36 offen  lds
    buffer_load_dwordx4 v237, s[8:11], s36 offen offset:1024  lds
    s_mov_b32 m0, s50
    s_nop 0
    s_movrels_b32 s71, s23
    s_movrels_b32 s33, s28
    v_add_u32 v253, s33, v248
    s_bfe_u32 s46, s71, 0x30012
    s_mov_b32 m0, s46
    s_and_b32 s66, s71, 0x3ffff
    s_movrels_b32 s68, s57
    s_movrels_b32 s69, s61
    s_sub_u32 s48, s66, s47
    s_mov_b32 s47, s66
    s_lshr_b32 s52, s71, 28
    s_lshl_b32 s67, s46, 9
    s_add_u32 s66, s66, s67
    s_sub_u32 s49, s66, s42
    s_mov_b32 s42, s66
    s_bfe_u32 s66, s68, 655360
    s_add_u32 s43, s42, s66
    s_bfe_u32 s39, s69, 655360
    s_bfe_u32 s66, s68, 655370
    s_add_u32 s44, s42, s66
    s_bfe_u32 s40, s69, 655370
    s_bfe_u32 s66, s68, 655380
    s_add_u32 s45, s42, s66
    s_bfe_u32 s41, s69, 655380
    v_add_u32 v252, s44, v247
    ds_read2_b32 v[238:239], v252 offset0:0 offset1:16
    v_add_u32 v252, s45, v247
    ds_read2_b32 v[240:241], v252 offset0:0 offset1:16
    v_mfma_f32_32x32x16_bf16 v[32:47], v[72:75], v[180:183], 0
    v_mul_f32 v196, v56, v96
    v_fmac_f32 v196, v57, v97
    v_fmac_f32 v196, v58, v98
    v_fmac_f32 v196, v59, v99
    v_fmac_f32 v196, v60, v100
    v_fmac_f32 v196, v61, v101
    v_mfma_f32_32x32x16_bf16 v[0:15], v[76:79], v[180:183], 0
    s_waitcnt vmcnt(6)
    ds_read_b64_tr_b16 v[176:177], v244 offset:4096
    ds_read_b64_tr_b16 v[178:179], v244 offset:5120
    ds_read_b64_tr_b16 v[180:181], v245 offset:4096
    ds_read_b64_tr_b16 v[182:183], v245 offset:5120
    v_fmac_f32 v196, v62, v102
    v_fmac_f32 v196, v63, v103
    v_mfma_f32_32x32x16_bf16 v[32:47], v[80:83], v[184:187], v[32:47]
    v_mul_f32 v198, v64, v128
    v_fmac_f32 v198, v65, v129
    v_fmac_f32 v198, v66, v130
    v_fmac_f32 v198, v67, v131
    v_fmac_f32 v198, v68, v132
    v_fmac_f32 v198, v69, v133
    v_mfma_f32_32x32x16_bf16 v[0:15], v[84:87], v[184:187], v[0:15]
    v_fmac_f32 v198, v70, v134
    v_fmac_f32 v198, v71, v135
    v_mul_f32 v200, v16, v128
    v_fmac_f32 v200, v17, v129
    v_permlane32_swap_b32 v196, v198
    v_fmac_f32 v200, v18, v130
    v_fmac_f32 v200, v19, v131
    v_fmac_f32 v200, v20, v132
    v_fmac_f32 v200, v21, v133
    v_fmac_f32 v200, v22, v134
    v_fmac_f32 v200, v23, v135
    v_add_f32 v198, v196, v198
    v_mul_f32_e64 v202, v24, -v128
    v_fma_f32 v202, v25, -v129, v202
    v_fma_f32 v202, v26, -v130, v202
    v_fma_f32 v202, v27, -v131, v202
    v_fma_f32 v202, v28, -v132, v202
    v_fma_f32 v202, v29, -v133, v202
    v_fma_f32 v202, v30, -v134, v202
    v_fma_f32 v202, v31, -v135, v202
    s_nop 1
    v_permlane32_swap_b32 v200, v202
    v_add_f32 v202, v200, v202
    s_waitcnt vmcnt(4) lgkmcnt(0)
    v_mfma_f32_32x32x16_bf16 v[56:71], v[72:75], v[176:179], 0
    v_mul_f32 v197, v32, v104
    v_fmac_f32 v197, v33, v105
    v_fmac_f32 v197, v34, v106
    v_fmac_f32 v197, v35, v107
    v_fmac_f32 v197, v36, v108
    v_fmac_f32 v197, v37, v109
    s_add_u32 m0, s21, 4096
    v_mfma_f32_32x32x16_bf16 v[16:31], v[76:79], v[176:179], 0
    buffer_load_dwordx4 v234, s[4:7], s37 offen  lds
    buffer_load_dwordx4 v235, s[8:11], s37 offen offset:1024  lds
    ds_read_b64_tr_b16 v[176:177], v244 offset:6144
    ds_read_b64_tr_b16 v[178:179], v244 offset:7168
    ds_read_b64_tr_b16 v[184:185], v245 offset:6144
    ds_read_b64_tr_b16 v[186:187], v245 offset:7168
    v_add_u32 v252, s42, v247
    ds_read2_b32 v[234:235], v252 offset0:0 offset1:16
    v_fmac_f32 v197, v38, v110
    v_fmac_f32 v197, v39, v111
    v_mul_f32 v199, v40, v136
    v_fmac_f32 v199, v41, v137
    v_fmac_f32 v199, v42, v138
    v_fmac_f32 v199, v43, v139
    v_fmac_f32 v199, v44, v140
    v_fmac_f32 v199, v45, v141
    v_fmac_f32 v199, v46, v142
    v_fmac_f32 v199, v47, v143
    v_mul_f32 v201, v0, v136
    v_fmac_f32 v201, v1, v137
    v_permlane32_swap_b32 v197, v199
    v_fmac_f32 v201, v2, v138
    v_fmac_f32 v201, v3, v139
    v_fmac_f32 v201, v4, v140
    v_fmac_f32 v201, v5, v141
    v_fmac_f32 v201, v6, v142
    v_fmac_f32 v201, v7, v143
    v_add_f32 v199, v197, v199
    v_mul_f32_e64 v203, v8, -v136
    v_fma_f32 v203, v9, -v137, v203
    v_fma_f32 v203, v10, -v138, v203
    v_fma_f32 v203, v11, -v139, v203
    s_waitcnt lgkmcnt(1)
    v_mfma_f32_32x32x16_bf16 v[56:71], v[80:83], v[176:179], v[56:71]
    v_fma_f32 v203, v12, -v140, v203
    v_fma_f32 v203, v13, -v141, v203
    v_fma_f32 v203, v14, -v142, v203
    v_fma_f32 v203, v15, -v143, v203
    s_nop 1
    v_permlane32_swap_b32 v201, v203
    v_add_f32 v203, v201, v203
    s_add_u32 m0, s21, 6144
    v_mfma_f32_32x32x16_bf16 v[16:31], v[84:87], v[176:179], v[16:31]
    buffer_load_dwordx4 v236, s[4:7], s37 offen  lds
    buffer_load_dwordx4 v237, s[8:11], s37 offen offset:1024  lds
    v_add_u32 v252, s43, v247
    ds_read2_b32 v[236:237], v252 offset0:0 offset1:16
    v_cvt_pk_bf16_f32 v192, v198, v199
    v_cvt_pk_bf16_f32 v193, v202, v203
    v_mfma_f32_32x32x16_bf16 v[32:47], v[72:75], v[180:183], 0
    v_mul_f32 v196, v56, v144
    v_fmac_f32 v196, v57, v145
    v_fmac_f32 v196, v58, v146
    v_fmac_f32 v196, v59, v147
    v_fmac_f32 v196, v60, v148
    v_fmac_f32 v196, v61, v149
    v_mfma_f32_32x32x16_bf16 v[0:15], v[76:79], v[180:183], 0
    s_waitcnt vmcnt(6)
    ds_read_b64_tr_b16 v[176:177], v244 offset:0
    ds_read_b64_tr_b16 v[178:179], v244 offset:1024
    ds_read_b64_tr_b16 v[180:181], v245 offset:0
    ds_read_b64_tr_b16 v[182:183], v245 offset:1024
    v_fmac_f32 v196, v62, v150
    v_fmac_f32 v196, v63, v151
    v_mfma_f32_32x32x16_bf16 v[32:47], v[80:83], v[184:187], v[32:47]
    v_mul_f32_e64 v200, v16, -v160
    v_fma_f32 v200, v17, -v161, v200
    v_fma_f32 v200, v18, -v162, v200
    v_fma_f32 v200, v19, -v163, v200
    v_fma_f32 v200, v20, -v164, v200
    v_fma_f32 v200, v21, -v165, v200
    v_mfma_f32_32x32x16_bf16 v[0:15], v[84:87], v[184:187], v[0:15]
    v_fma_f32 v200, v22, -v166, v200
    v_fma_f32 v200, v23, -v167, v200
    v_mul_f32_e64 v202, v24, -v160
    v_fma_f32 v202, v25, -v161, v202
    v_fma_f32 v202, v26, -v162, v202
    v_fma_f32 v202, v27, -v163, v202
    v_fma_f32 v202, v28, -v164, v202
    v_fma_f32 v202, v29, -v165, v202
    v_fma_f32 v202, v30, -v166, v202
    v_fma_f32 v202, v31, -v167, v202
    s_waitcnt vmcnt(4) lgkmcnt(0)
    v_mfma_f32_32x32x16_bf16 v[16:31], v[72:75], v[176:179], 0
    v_mul_f32 v197, v32, v152
    v_fmac_f32 v197, v33, v153
    v_fmac_f32 v197, v34, v154
    v_fmac_f32 v197, v35, v155
    v_fmac_f32 v197, v36, v156
    v_fmac_f32 v197, v37, v157
    s_add_u32 m0, s21, 0
    v_mfma_f32_32x32x16_bf16 v[48:63], v[76:79], v[176:179], 0
    s_cbranch_vccnz WL_4_0
    v_mad_u32_u16 v234, v234, s3, v246 op_sel:[1,0,0,0]
    v_mad_u32_u16 v235, v235, s3, v246 op_sel:[1,0,0,0]
    buffer_load_dwordx4 v234, s[4:7], s38 offen  lds
    buffer_load_dwordx4 v235, s[8:11], s38 offen offset:1024  lds
WR_4_0:
    ds_read_b64_tr_b16 v[176:177], v244 offset:2048
    ds_read_b64_tr_b16 v[178:179], v244 offset:3072
    ds_read_b64_tr_b16 v[184:185], v245 offset:2048
    ds_read_b64_tr_b16 v[186:187], v245 offset:3072
    v_fmac_f32 v197, v38, v158
    v_fmac_f32 v197, v39, v159
    v_mul_f32_e64 v201, v0, -v168
    v_fma_f32 v201, v1, -v169, v201
    v_fma_f32 v201, v2, -v170, v201
    v_fma_f32 v201, v3, -v171, v201
    v_fma_f32 v201, v4, -v172, v201
    v_fma_f32 v201, v5, -v173, v201
    v_fma_f32 v201, v6, -v174, v201
    v_fma_f32 v201, v7, -v175, v201
    s_waitcnt lgkmcnt(0)
    v_mfma_f32_32x32x16_bf16 v[16:31], v[80:83], v[176:179], v[16:31]
    v_mul_f32_e64 v203, v8, -v168
    v_fma_f32 v203, v9, -v169, v203
    v_fma_f32 v203, v10, -v170, v203
    v_fma_f32 v203, v11, -v171, v203
    v_fma_f32 v203, v12, -v172, v203
    v_fma_f32 v203, v13, -v173, v203
    s_add_u32 m0, s21, 2048
    v_mfma_f32_32x32x16_bf16 v[48:63], v[84:87], v[176:179], v[48:63]
    s_cbranch_vccnz WL_4_1
    v_mad_u32_u16 v236, v236, s3, v246 op_sel:[1,0,0,0]
    v_mad_u32_u16 v237, v237, s3, v246 op_sel:[1,0,0,0]
    buffer_load_dwordx4 v236, s[4:7], s39 offen  lds
    buffer_load_dwordx4 v237, s[8:11], s39 offen offset:1024  lds
WR_4_1:
    v_fma_f32 v203, v14, -v174, v203
    v_fma_f32 v203, v15, -v175, v203
    v_mfma_f32_32x32x16_bf16 v[0:15], v[72:75], v[180:183], 0
    v_fmac_f32 v200, v24, v160
    v_fmac_f32 v200, v25, v161
    v_fmac_f32 v200, v26, v162
    v_fmac_f32 v200, v27, v163
    v_fmac_f32 v200, v28, v164
    v_fmac_f32 v200, v29, v165
    v_fmac_f32 v200, v30, v166
    v_fmac_f32 v200, v31, v167
    v_mfma_f32_32x32x16_bf16 v[24:39], v[76:79], v[180:183], 0
    s_waitcnt vmcnt(6)
    ds_read_b64_tr_b16 v[176:177], v244 offset:4096
    ds_read_b64_tr_b16 v[178:179], v244 offset:5120
    ds_read_b64_tr_b16 v[180:181], v245 offset:4096
    ds_read_b64_tr_b16 v[182:183], v245 offset:5120
    v_mul_f32 v254, v16, v144
    v_fmac_f32 v254, v17, v145
    v_mfma_f32_32x32x16_bf16 v[24:39], v[84:87], v[184:187], v[24:39]
    v_fmac_f32 v254, v18, v146
    v_fmac_f32 v254, v19, v147
    v_fmac_f32 v254, v20, v148
    v_fmac_f32 v254, v21, v149
    v_fmac_f32 v254, v22, v150
    v_fmac_f32 v254, v23, v151
    v_mfma_f32_32x32x16_bf16 v[0:15], v[80:83], v[184:187], v[0:15]
    v_sub_f32_e64 v64, -v48, v64
    v_sub_f32_e64 v65, -v49, v65
    v_permlane32_swap_b32 v196, v254
    v_sub_f32_e64 v66, -v50, v66
    v_sub_f32_e64 v67, -v51, v67
    v_sub_f32_e64 v68, -v52, v68
    v_sub_f32_e64 v69, -v53, v69
    v_sub_f32_e64 v70, -v54, v70
    v_sub_f32_e64 v71, -v55, v71
    v_add_f32 v254, v196, v254
    s_waitcnt vmcnt(4) lgkmcnt(0)
    v_mfma_f32_32x32x16_bf16 v[56:71], v[76:79], v[176:179], v[56:71]
    v_sub_f32_e64 v40, -v24, v40
    v_sub_f32_e64 v41, -v25, v41
    v_sub_f32_e64 v42, -v26, v42
    v_sub_f32_e64 v43, -v27, v43
    v_sub_f32_e64 v44, -v28, v44
    v_sub_f32_e64 v45, -v29, v45
    v_sub_f32_e64 v46, -v30, v46
    v_sub_f32_e64 v47, -v31, v47
    s_add_u32 m0, s21, 4096
    v_mfma_f32_32x32x16_bf16 v[16:31], v[72:75], v[176:179], 0
    s_cbranch_vccnz WL_4_2
    v_mad_u32_u16 v238, v238, s3, v246 op_sel:[1,0,0,0]
    v_mad_u32_u16 v239, v239, s3, v246 op_sel:[1,0,0,0]
    buffer_load_dwordx4 v238, s[4:7], s40 offen  lds
    buffer_load_dwordx4 v239, s[8:11], s40 offen offset:1024  lds
WR_4_2:
    ds_read_b64_tr_b16 v[176:177], v244 offset:6144
    ds_read_b64_tr_b16 v[178:179], v244 offset:7168
    ds_read_b64_tr_b16 v[184:185], v245 offset:6144
    ds_read_b64_tr_b16 v[186:187], v245 offset:7168
    v_mul_f32 v255, v0, v152
    v_fmac_f32 v255, v1, v153
    v_fmac_f32 v255, v2, v154
    v_fmac_f32 v255, v3, v155
    v_fmac_f32 v255, v4, v156
    v_fmac_f32 v255, v5, v157
    v_fmac_f32 v255, v6, v158
    v_fmac_f32 v255, v7, v159
    v_fmac_f32 v201, v8, v168
    v_fmac_f32 v201, v9, v169
    v_permlane32_swap_b32 v197, v255
    s_waitcnt lgkmcnt(0)
    v_mfma_f32_32x32x16_bf16 v[16:31], v[80:83], v[176:179], v[16:31]
    v_fmac_f32 v201, v10, v170
    v_fmac_f32 v201, v11, v171
    v_fmac_f32 v201, v12, v172
    v_fmac_f32 v201, v13, v173
    v_fmac_f32 v201, v14, v174
    v_fmac_f32 v201, v15, v175
    s_add_u32 m0, s21, 6144
    v_mfma_f32_32x32x16_bf16 v[56:71], v[84:87], v[176:179], v[56:71]
    s_cbranch_vccnz WL_4_3
    v_mad_u32_u16 v240, v240, s3, v246 op_sel:[1,0,0,0]
    v_mad_u32_u16 v241, v241, s3, v246 op_sel:[1,0,0,0]
    buffer_load_dwordx4 v240, s[4:7], s41 offen  lds
    buffer_load_dwordx4 v241, s[8:11], s41 offen offset:1024  lds
WR_4_3:
    v_add_f32 v255, v197, v255
    v_cvt_pk_bf16_f32 v194, v254, v255
    v_mfma_f32_32x32x16_bf16 v[0:15], v[72:75], v[180:183], 0
    v_mul_f32 v254, v16, v144
    v_fmac_f32 v254, v17, v145
    v_fmac_f32 v254, v18, v146
    v_fmac_f32 v254, v19, v147
    v_fmac_f32 v254, v20, v148
    v_fmac_f32 v254, v21, v149
    v_mfma_f32_32x32x16_bf16 v[32:47], v[76:79], v[180:183], v[32:47]
    s_waitcnt vmcnt(6)
    ds_read_b64_tr_b16 v[176:177], v244 offset:0
    ds_read_b64_tr_b16 v[178:179], v244 offset:1024
    ds_read_b64_tr_b16 v[180:181], v245 offset:0
    ds_read_b64_tr_b16 v[182:183], v245 offset:1024
    v_fmac_f32 v254, v22, v150
    v_fmac_f32 v254, v23, v151
    v_mfma_f32_32x32x16_bf16 v[0:15], v[80:83], v[184:187], v[0:15]
    v_fma_f32 v202, v24, -v160, v202
    v_fma_f32 v202, v25, -v161, v202
    v_permlane32_swap_b32 v254, v200
    v_fma_f32 v202, v26, -v162, v202
    v_fma_f32 v202, v27, -v163, v202
    v_fma_f32 v202, v28, -v164, v202
    v_mfma_f32_32x32x16_bf16 v[32:47], v[84:87], v[184:187], v[32:47]
    v_add_u32 v249, s48, v249
    v_add_u32 v250, s49, v250
    ds_read_b32 v252, v251 offset:16
    ds_read_b64_tr_b16 v[72:73], v249 offset:0
    ds_read_b64_tr_b16 v[76:77], v249 offset:64
    ds_read_b64_tr_b16 v[74:75], v249 offset:256
    ds_read_b64_tr_b16 v[78:79], v249 offset:320
    s_mov_b64 exec, s[54:55]
    ds_read_u16_d16_hi v242, v250 offset:0
    s_mov_b64 exec, -1
    v_fma_f32 v202, v29, -v165, v202
    v_fma_f32 v202, v30, -v166, v202
    v_fma_f32 v202, v31, -v167, v202
    v_add_f32 v200, v254, v200
    v_mul_f32_e64 v198, v64, -v112
    v_permlane32_swap_b32 v202, v254
    v_fma_f32 v198, v65, -v113, v198
    v_fma_f32 v198, v66, -v114, v198
    v_fma_f32 v198, v67, -v115, v198
    v_fma_f32 v198, v68, -v116, v198
    v_fma_f32 v198, v69, -v117, v198
    v_fma_f32 v198, v70, -v118, v198
    v_fma_f32 v198, v71, -v119, v198
    v_add_f32 v254, v202, v254
    v_mul_f32 v196, v56, v160
    v_fmac_f32 v196, v57, v161
    v_fmac_f32 v196, v58, v162
    v_fmac_f32 v196, v59, v163
    v_fmac_f32 v196, v60, v164
    v_fmac_f32 v196, v61, v165
    v_fmac_f32 v196, v62, v166
    v_fmac_f32 v196, v63, v167
    s_nop 1
    v_permlane32_swap_b32 v198, v196
    v_add_f32 v196, v198, v196
    s_cbranch_vccnz LEPI_0
    v_mul_f32 v255, v0, v152
    v_fmac_f32 v255, v1, v153
    v_fmac_f32 v255, v2, v154
    v_fmac_f32 v255, v3, v155
    v_fmac_f32 v255, v4, v156
    v_fmac_f32 v255, v5, v157
    v_fmac_f32 v255, v6, v158
    v_fmac_f32 v255, v7, v159
    v_fma_f32 v203, v8, -v168, v203
    v_fma_f32 v203, v9, -v169, v203
    v_permlane32_swap_b32 v255, v201
    v_fma_f32 v203, v10, -v170, v203
    v_fma_f32 v203, v11, -v171, v203
    v_fma_f32 v203, v12, -v172, v203
    v_fma_f32 v203, v13, -v173, v203
    v_fma_f32 v203, v14, -v174, v203
    v_fma_f32 v203, v15, -v175, v203
    v_add_f32 v201, v255, v201
    v_mul_f32_e64 v199, v40, -v120
    v_permlane32_swap_b32 v203, v255
    v_fma_f32 v199, v41, -v121, v199
    v_fma_f32 v199, v42, -v122, v199
    v_fma_f32 v199, v43, -v123, v199
    v_fma_f32 v199, v44, -v124, v199
    v_fma_f32 v199, v45, -v125, v199
    v_fma_f32 v199, v46, -v126, v199
    v_fma_f32 v199, v47, -v127, v199
    v_add_f32 v255, v203, v255
    v_mul_f32 v197, v32, v168
    v_fmac_f32 v197, v33, v169
    v_fmac_f32 v197, v34, v170
    v_fmac_f32 v197, v35, v171
    v_fmac_f32 v197, v36, v172
    v_fmac_f32 v197, v37, v173
    v_fmac_f32 v197, v38, v174
    v_fmac_f32 v197, v39, v175
    s_nop 1
    v_permlane32_swap_b32 v199, v197
    v_add_f32 v197, v199, v197
    v_cvt_pk_bf16_f32 v200, v200, v201
    v_cvt_pk_bf16_f32 v254, v254, v255
    v_cvt_pk_bf16_f32 v196, v196, v197
    ds_write2st64_b32 v253, v192, v193 offset0:0 offset1:1
    ds_write2st64_b32 v253, v194, v200 offset0:2 offset1:3
    ds_write_b32 v253, v196 offset:1024
    s_mov_b64 exec, 0xffffffff
    ds_write_b32 v253, v254 offset:1280
    s_mov_b64 exec, -1
    s_add_u32 s50, s50, 1
    s_cmp_ge_u32 s50, 4
    s_cbranch_scc1 LAST1
    s_waitcnt lgkmcnt(9)
    v_readfirstlane_b32 s66, v252
    s_add_u32 s53, s53, 1
    v_mov_b32 v252, s53
    s_cmp_le_u32 s53, s66
    ds_write2_b32 v251, v252, v252 offset0:0 offset1:8
    s_setprio 1
    s_cbranch_scc1 PRIO_11
    s_setprio 0
PRIO_11:
    s_cmp_eq_u32 s52, 4
    s_cbranch_scc1 ITEM_1_4
    s_cmp_eq_u32 s52, 5
    s_cbranch_scc1 ITEM_1_5
    s_cmp_eq_u32 s52, 3
    s_cbranch_scc1 ITEM_1_3
    s_cmp_eq_u32 s52, 6
    s_cbranch_scc1 ITEM_1_6
    s_cmp_eq_u32 s52, 8
    s_cbranch_scc1 ITEM_1_8
    s_branch ITEM_1_2
WL_4_0:
    s_add_u32 s66, s51, 0
    buffer_load_dwordx4 v[96:99], v246, s[16:19], s66 offen offset:2048 sc1
    buffer_load_dwordx4 v[100:103], v246, s[16:19], s66 offen offset:3072 sc1
    s_branch WR_4_0
WL_4_1:
    s_add_u32 s66, s51, 4096
    buffer_load_dwordx4 v[104:107], v246, s[16:19], s66 offen offset:2048 sc1
    buffer_load_dwordx4 v[108:111], v246, s[16:19], s66 offen offset:3072 sc1
    s_branch WR_4_1
WL_4_2:
    s_add_u32 s66, s51, 8192
    buffer_load_dwordx4 v[128:131], v246, s[16:19], s66 offen offset:2048 sc1
    buffer_load_dwordx4 v[132:135], v246, s[16:19], s66 offen offset:3072 sc1
    s_branch WR_4_2
WL_4_3:
    s_add_u32 s66, s51, 12288
    buffer_load_dwordx4 v[136:139], v246, s[16:19], s66 offen offset:2048 sc1
    buffer_load_dwordx4 v[140:143], v246, s[16:19], s66 offen offset:3072 sc1
    s_branch WR_4_3
.p2align 6
ITEM_1_5:
    s_mov_b64 exec, s[54:55]
    ds_read_u16_d16_hi v243, v250 offset:128
    s_mov_b64 exec, -1
    ds_read_b64_tr_b16 v[80:81], v249 offset:512
    ds_read_b64_tr_b16 v[84:85], v249 offset:576
    ds_read_b64_tr_b16 v[82:83], v249 offset:768
    ds_read_b64_tr_b16 v[86:87], v249 offset:832
    ds_read_b64_tr_b16 v[88:89], v249 offset:1024
    ds_read_b64_tr_b16 v[92:93], v249 offset:1088
    s_waitcnt lgkmcnt(7)
    v_mul_f32_dpp v196, v242, v72 row_newbcast:0 row_mask:0xf bank_mask:0xf
    v_mul_f32_dpp v197, v242, v73 row_newbcast:1 row_mask:0xf bank_mask:0xf
    v_mul_f32_dpp v198, v242, v72 row_newbcast:8 row_mask:0xf bank_mask:0xf
    v_mul_f32_dpp v199, v242, v73 row_newbcast:9 row_mask:0xf bank_mask:0xf
    v_mul_f32_dpp v200, v242, v76 row_newbcast:2 row_mask:0xf bank_mask:0xf
    v_mul_f32_dpp v201, v242, v77 row_newbcast:3 row_mask:0xf bank_mask:0xf
    v_mul_f32_dpp v202, v242, v76 row_newbcast:10 row_mask:0xf bank_mask:0xf
    v_mul_f32_dpp v203, v242, v77 row_newbcast:11 row_mask:0xf bank_mask:0xf
    v_cvt_pk_bf16_f32 v72, v196, v197
    v_cvt_pk_bf16_f32 v76, v198, v199
    v_cvt_pk_bf16_f32 v73, v200, v201
    v_cvt_pk_bf16_f32 v77, v202, v203
    v_mul_f32_dpp v196, v242, v74 row_newbcast:4 row_mask:0xf bank_mask:0xf
    v_mul_f32_dpp v197, v242, v75 row_newbcast:5 row_mask:0xf bank_mask:0xf
    v_mul_f32_dpp v198, v242, v74 row_newbcast:12 row_mask:0xf bank_mask:0xf
    v_mul_f32_dpp v199, v242, v75 row_newbcast:13 row_mask:0xf bank_mask:0xf
    v_mul_f32_dpp v200, v242, v78 row_newbcast:6 row_mask:0xf bank_mask:0xf
    v_mul_f32_dpp v201, v242, v79 row_newbcast:7 row_mask:0xf bank_mask:0xf
    v_mul_f32_dpp v202, v242, v78 row_newbcast:14 row_mask:0xf bank_mask:0xf
    v_mul_f32_dpp v203, v242, v79 row_newbcast:15 row_mask:0xf bank_mask:0xf
    v_cvt_pk_bf16_f32 v74, v196, v197
    v_cvt_pk_bf16_f32 v78, v198, v199
    v_cvt_pk_bf16_f32 v75, v200, v201
    v_cvt_pk_bf16_f32 v79, v202, v203
    s_mov_b64 exec, s[54:55]
    ds_read_u16_d16_hi v242, v250 offset:256
    s_mov_b64 exec, -1
    s_waitcnt vmcnt(4) lgkmcnt(3)
    v_mfma_f32_32x32x16_bf16 v[56:71], v[72:75], v[176:179], 0
    v_mul_f32_dpp v196, v243, v80 row_newbcast:0 row_mask:0xf bank_mask:0xf
    v_mul_f32_dpp v197, v243, v81 row_newbcast:1 row_mask:0xf bank_mask:0xf
    v_mul_f32_dpp v198, v243, v80 row_newbcast:8 row_mask:0xf bank_mask:0xf
    v_mul_f32_dpp v199, v243, v81 row_newbcast:9 row_mask:0xf bank_mask:0xf
    v_mul_f32_dpp v200, v243, v84 row_newbcast:2 row_mask:0xf bank_mask:0xf
    v_mul_f32_dpp v201, v243, v85 row_newbcast:3 row_mask:0xf bank_mask:0xf
    s_add_u32 m0, s21, 0
    v_mfma_f32_32x32x16_bf16 v[16:31], v[76:79], v[176:179], 0
    buffer_load_dwordx4 v236, s[4:7], s35 offen  lds
    buffer_load_dwordx4 v237, s[8:11], s35 offen offset:1024  lds
    ds_read_b64_tr_b16 v[176:177], v244 offset:2048
    ds_read_b64_tr_b16 v[178:179], v244 offset:3072
    ds_read_b64_tr_b16 v[184:185], v245 offset:2048
    ds_read_b64_tr_b16 v[186:187], v245 offset:3072
    v_mul_f32_dpp v202, v243, v84 row_newbcast:10 row_mask:0xf bank_mask:0xf
    v_mul_f32_dpp v203, v243, v85 row_newbcast:11 row_mask:0xf bank_mask:0xf
    v_cvt_pk_bf16_f32 v80, v196, v197
    v_cvt_pk_bf16_f32 v84, v198, v199
    v_cvt_pk_bf16_f32 v81, v200, v201
    v_cvt_pk_bf16_f32 v85, v202, v203
    v_mul_f32_dpp v196, v243, v82 row_newbcast:4 row_mask:0xf bank_mask:0xf
    v_mul_f32_dpp v197, v243, v83 row_newbcast:5 row_mask:0xf bank_mask:0xf
    v_mul_f32_dpp v198, v243, v82 row_newbcast:12 row_mask:0xf bank_mask:0xf
    v_mul_f32_dpp v199, v243, v83 row_newbcast:13 row_mask:0xf bank_mask:0xf
    v_mul_f32_dpp v200, v243, v86 row_newbcast:6 row_mask:0xf bank_mask:0xf
    v_mul_f32_dpp v201, v243, v87 row_newbcast:7 row_mask:0xf bank_mask:0xf
    v_mul_f32_dpp v202, v243, v86 row_newbcast:14 row_mask:0xf bank_mask:0xf
    v_mul_f32_dpp v203, v243, v87 row_newbcast:15 row_mask:0xf bank_mask:0xf
    v_cvt_pk_bf16_f32 v82, v196, v197
    v_cvt_pk_bf16_f32 v86, v198, v199
    v_cvt_pk_bf16_f32 v83, v200, v201
    v_cvt_pk_bf16_f32 v87, v202, v203
    s_waitcnt vmcnt(4) lgkmcnt(0)
    v_mfma_f32_32x32x16_bf16 v[56:71], v[80:83], v[176:179], v[56:71]
    v_mul_f32_dpp v196, v242, v88 row_newbcast:0 row_mask:0xf bank_mask:0xf
    v_mul_f32_dpp v197, v242, v89 row_newbcast:1 row_mask:0xf bank_mask:0xf
    v_mul_f32_dpp v198, v242, v88 row_newbcast:8 row_mask:0xf bank_mask:0xf
    v_mul_f32_dpp v199, v242, v89 row_newbcast:9 row_mask:0xf bank_mask:0xf
    v_mul_f32_dpp v200, v242, v92 row_newbcast:2 row_mask:0xf bank_mask:0xf
    v_mul_f32_dpp v201, v242, v93 row_newbcast:3 row_mask:0xf bank_mask:0xf
    s_add_u32 m0, s21, 2048
    v_mfma_f32_32x32x16_bf16 v[16:31], v[84:87], v[176:179], v[16:31]
    buffer_load_dwordx4 v238, s[4:7], s35 offen  lds
    ds_read_b64_tr_b16 v[176:177], v244 offset:4096
    ds_read_b64_tr_b16 v[188:189], v245 offset:4096
    v_mul_f32_dpp v202, v242, v92 row_newbcast:10 row_mask:0xf bank_mask:0xf
    v_mul_f32_dpp v203, v242, v93 row_newbcast:11 row_mask:0xf bank_mask:0xf
    v_cvt_pk_bf16_f32 v88, v196, v197
    v_cvt_pk_bf16_f32 v92, v198, v199
    v_cvt_pk_bf16_f32 v89, v200, v201
    v_cvt_pk_bf16_f32 v93, v202, v203
    s_waitcnt lgkmcnt(0)
    v_mfma_f32_32x32x8_bf16 v[56:71], v[88:89], v[176:177], v[56:71]
    s_add_u32 m0, s21, 4096
    v_mfma_f32_32x32x8_bf16 v[16:31], v[92:93], v[176:177], v[16:31]
    buffer_load_dwordx4 v234, s[4:7], s36 offen  lds
    buffer_load_dwordx4 v235, s[8:11], s36 offen offset:1024  lds
    s_mov_b32 m0, s50
    s_nop 0
    s_movrels_b32 s71, s23
    s_movrels_b32 s33, s28
    v_add_u32 v253, s33, v248
    s_bfe_u32 s46, s71, 0x30012
    s_mov_b32 m0, s46
    s_and_b32 s66, s71, 0x3ffff
    s_movrels_b32 s68, s57
    s_movrels_b32 s69, s61
    s_sub_u32 s48, s66, s47
    s_mov_b32 s47, s66
    s_lshr_b32 s52, s71, 28
    s_lshl_b32 s67, s46, 9
    s_add_u32 s66, s66, s67
    s_sub_u32 s49, s66, s42
    s_mov_b32 s42, s66
    s_bfe_u32 s66, s68, 655360
    s_add_u32 s43, s42, s66
    s_bfe_u32 s39, s69, 655360
    s_bfe_u32 s66, s68, 655370
    s_add_u32 s44, s42, s66
    s_bfe_u32 s40, s69, 655370
    s_bfe_u32 s66, s68, 655380
    s_add_u32 s45, s42, s66
    s_bfe_u32 s41, s69, 655380
    v_add_u32 v252, s45, v247
    ds_read2_b32 v[240:241], v252 offset0:0 offset1:16
    v_mfma_f32_32x32x16_bf16 v[32:47], v[72:75], v[180:183], 0
    v_mul_f32 v196, v56, v96
    v_fmac_f32 v196, v57, v97
    v_fmac_f32 v196, v58, v98
    v_fmac_f32 v196, v59, v99
    v_fmac_f32 v196, v60, v100
    v_fmac_f32 v196, v61, v101
    v_mfma_f32_32x32x16_bf16 v[0:15], v[76:79], v[180:183], 0
    v_fmac_f32 v196, v62, v102
    v_fmac_f32 v196, v63, v103
    v_mul_f32 v198, v64, v128
    v_fmac_f32 v198, v65, v129
    v_fmac_f32 v198, v66, v130
    v_fmac_f32 v198, v67, v131
    v_mfma_f32_32x32x16_bf16 v[32:47], v[80:83], v[184:187], v[32:47]
    v_fmac_f32 v198, v68, v132
    v_fmac_f32 v198, v69, v133
    v_fmac_f32 v198, v70, v134
    v_fmac_f32 v198, v71, v135
    v_mul_f32 v200, v16, v128
    v_fmac_f32 v200, v17, v129
    v_mfma_f32_32x32x16_bf16 v[0:15], v[84:87], v[184:187], v[0:15]
    s_waitcnt vmcnt(5)
    ds_read_b64_tr_b16 v[176:177], v244 offset:6144
    ds_read_b64_tr_b16 v[178:179], v244 offset:7168
    ds_read_b64_tr_b16 v[180:181], v245 offset:6144
    ds_read_b64_tr_b16 v[182:183], v245 offset:7168
    v_permlane32_swap_b32 v196, v198
    v_fmac_f32 v200, v18, v130
    v_mfma_f32_32x32x8_bf16 v[32:47], v[88:89], v[188:189], v[32:47]
    v_fmac_f32 v200, v19, v131
    v_fmac_f32 v200, v20, v132
    v_fmac_f32 v200, v21, v133
    v_fmac_f32 v200, v22, v134
    v_fmac_f32 v200, v23, v135
    v_add_f32 v198, v196, v198
    v_mfma_f32_32x32x8_bf16 v[0:15], v[92:93], v[188:189], v[0:15]
    v_mul_f32_e64 v202, v24, -v128
    v_fma_f32 v202, v25, -v129, v202
    v_fma_f32 v202, v26, -v130, v202
    v_fma_f32 v202, v27, -v131, v202
    v_fma_f32 v202, v28, -v132, v202
    v_fma_f32 v202, v29, -v133, v202
    v_fma_f32 v202, v30, -v134, v202
    v_fma_f32 v202, v31, -v135, v202
    s_nop 1
    v_permlane32_swap_b32 v200, v202
    v_add_f32 v202, v200, v202
    s_waitcnt vmcnt(3) lgkmcnt(0)
    v_mfma_f32_32x32x16_bf16 v[56:71], v[72:75], v[176:179], 0
    v_mul_f32 v197, v32, v104
    v_fmac_f32 v197, v33, v105
    v_fmac_f32 v197, v34, v106
    v_fmac_f32 v197, v35, v107
    v_fmac_f32 v197, v36, v108
    v_fmac_f32 v197, v37, v109
    s_add_u32 m0, s21, 6144
    v_mfma_f32_32x32x16_bf16 v[16:31], v[76:79], v[176:179], 0
    buffer_load_dwordx4 v236, s[4:7], s36 offen  lds
    buffer_load_dwordx4 v237, s[8:11], s36 offen offset:1024  lds
    ds_read_b64_tr_b16 v[176:177], v244 offset:0
    ds_read_b64_tr_b16 v[178:179], v244 offset:1024
    ds_read_b64_tr_b16 v[184:185], v245 offset:0
    ds_read_b64_tr_b16 v[186:187], v245 offset:1024
    v_fmac_f32 v197, v38, v110
    v_fmac_f32 v197, v39, v111
    v_mul_f32 v199, v40, v136
    v_fmac_f32 v199, v41, v137
    v_fmac_f32 v199, v42, v138
    v_fmac_f32 v199, v43, v139
    v_fmac_f32 v199, v44, v140
    v_fmac_f32 v199, v45, v141
    v_fmac_f32 v199, v46, v142
    v_fmac_f32 v199, v47, v143
    v_mul_f32 v201, v0, v136
    v_fmac_f32 v201, v1, v137
    v_permlane32_swap_b32 v197, v199
    v_fmac_f32 v201, v2, v138
    v_fmac_f32 v201, v3, v139
    s_waitcnt vmcnt(4) lgkmcnt(0)
    v_mfma_f32_32x32x16_bf16 v[56:71], v[80:83], v[176:179], v[56:71]
    v_fmac_f32 v201, v4, v140
    v_fmac_f32 v201, v5, v141
    v_fmac_f32 v201, v6, v142
    v_fmac_f32 v201, v7, v143
    v_add_f32 v199, v197, v199
    v_mul_f32_e64 v203, v8, -v136
    s_add_u32 m0, s21, 0
    v_mfma_f32_32x32x16_bf16 v[16:31], v[84:87], v[176:179], v[16:31]
    buffer_load_dwordx4 v238, s[4:7], s36 offen  lds
    ds_read_b64_tr_b16 v[176:177], v244 offset:2048
    ds_read_b64_tr_b16 v[188:189], v245 offset:2048
    v_fma_f32 v203, v9, -v137, v203
    v_fma_f32 v203, v10, -v138, v203
    v_fma_f32 v203, v11, -v139, v203
    s_waitcnt lgkmcnt(0)
    v_mfma_f32_32x32x8_bf16 v[56:71], v[88:89], v[176:177], v[56:71]
    v_fma_f32 v203, v12, -v140, v203
    v_fma_f32 v203, v13, -v141, v203
    v_fma_f32 v203, v14, -v142, v203
    v_fma_f32 v203, v15, -v143, v203
    s_nop 1
    v_permlane32_swap_b32 v201, v203
    v_add_f32 v203, v201, v203
    s_add_u32 m0, s21, 2048
    v_mfma_f32_32x32x8_bf16 v[16:31], v[92:93], v[176:177], v[16:31]
    buffer_load_dwordx4 v234, s[4:7], s37 offen  lds
    buffer_load_dwordx4 v235, s[8:11], s37 offen offset:1024  lds
    v_add_u32 v252, s42, v247
    ds_read2_b32 v[234:235], v252 offset0:0 offset1:16
    v_cvt_pk_bf16_f32 v192, v198, v199
    v_cvt_pk_bf16_f32 v193, v202, v203
    v_mfma_f32_32x32x16_bf16 v[32:47], v[72:75], v[180:183], 0
    v_mul_f32 v196, v56, v144
    v_fmac_f32 v196, v57, v145
    v_fmac_f32 v196, v58, v146
    v_fmac_f32 v196, v59, v147
    v_fmac_f32 v196, v60, v148
    v_fmac_f32 v196, v61, v149
    v_mfma_f32_32x32x16_bf16 v[0:15], v[76:79], v[180:183], 0
    v_fmac_f32 v196, v62, v150
    v_fmac_f32 v196, v63, v151
    v_mul_f32_e64 v200, v16, -v160
    v_fma_f32 v200, v17, -v161, v200
    v_fma_f32 v200, v18, -v162, v200
    v_fma_f32 v200, v19, -v163, v200
    v_mfma_f32_32x32x16_bf16 v[32:47], v[80:83], v[184:187], v[32:47]
    v_fma_f32 v200, v20, -v164, v200
    v_fma_f32 v200, v21, -v165, v200
    v_fma_f32 v200, v22, -v166, v200
    v_fma_f32 v200, v23, -v167, v200
    v_mul_f32_e64 v202, v24, -v160
    v_fma_f32 v202, v25, -v161, v202
    v_mfma_f32_32x32x16_bf16 v[0:15], v[84:87], v[184:187], v[0:15]
    s_waitcnt vmcnt(5)
    ds_read_b64_tr_b16 v[176:177], v244 offset:4096
    ds_read_b64_tr_b16 v[178:179], v244 offset:5120
    ds_read_b64_tr_b16 v[180:181], v245 offset:4096
    ds_read_b64_tr_b16 v[182:183], v245 offset:5120
    v_fma_f32 v202, v26, -v162, v202
    v_fma_f32 v202, v27, -v163, v202
    v_mfma_f32_32x32x8_bf16 v[32:47], v[88:89], v[188:189], v[32:47]
    v_fma_f32 v202, v28, -v164, v202
    v_fma_f32 v202, v29, -v165, v202
    v_fma_f32 v202, v30, -v166, v202
    v_fma_f32 v202, v31, -v167, v202
    v_mfma_f32_32x32x8_bf16 v[0:15], v[92:93], v[188:189], v[0:15]
    s_waitcnt vmcnt(3) lgkmcnt(0)
    v_mfma_f32_32x32x16_bf16 v[16:31], v[72:75], v[176:179], 0
    s_nop 4
    v_mul_f32 v197, v32, v152
    v_fmac_f32 v197, v33, v153
    v_fmac_f32 v197, v34, v154
    v_fmac_f32 v197, v35, v155
    v_fmac_f32 v197, v36, v156
    v_fmac_f32 v197, v37, v157
    s_add_u32 m0, s21, 4096
    v_mfma_f32_32x32x16_bf16 v[48:63], v[76:79], v[176:179], 0
    buffer_load_dwordx4 v236, s[4:7], s37 offen  lds
    buffer_load_dwordx4 v237, s[8:11], s37 offen offset:1024  lds
    ds_read_b64_tr_b16 v[176:177], v244 offset:6144
    ds_read_b64_tr_b16 v[178:179], v244 offset:7168
    ds_read_b64_tr_b16 v[184:185], v245 offset:6144
    ds_read_b64_tr_b16 v[186:187], v245 offset:7168
    v_add_u32 v252, s43, v247
    ds_read2_b32 v[236:237], v252 offset0:0 offset1:16
    v_fmac_f32 v197, v38, v158
    v_fmac_f32 v197, v39, v159
    v_mul_f32_e64 v201, v0, -v168
    s_waitcnt vmcnt(4) lgkmcnt(1)
    v_mfma_f32_32x32x16_bf16 v[16:31], v[80:83], v[176:179], v[16:31]
    v_fma_f32 v201, v1, -v169, v201
    v_fma_f32 v201, v2, -v170, v201
    v_fma_f32 v201, v3, -v171, v201
    v_fma_f32 v201, v4, -v172, v201
    v_fma_f32 v201, v5, -v173, v201
    v_fma_f32 v201, v6, -v174, v201
    s_add_u32 m0, s21, 6144
    v_mfma_f32_32x32x16_bf16 v[48:63], v[84:87], v[176:179], v[48:63]
    buffer_load_dwordx4 v238, s[4:7], s37 offen  lds
    ds_read_b64_tr_b16 v[176:177], v244 offset:0
    ds_read_b64_tr_b16 v[188:189], v245 offset:0
    v_add_u32 v252, s44, v247
    ds_read2_b32 v[238:239], v252 offset0:0 offset1:16
    v_fma_f32 v201, v7, -v175, v201
    s_waitcnt lgkmcnt(1)
    v_mfma_f32_32x32x8_bf16 v[16:31], v[88:89], v[176:177], v[16:31]
    v_mul_f32_e64 v203, v8, -v168
    v_fma_f32 v203, v9, -v169, v203
    v_fma_f32 v203, v10, -v170, v203
    v_fma_f32 v203, v11, -v171, v203
    v_fma_f32 v203, v12, -v172, v203
    v_fma_f32 v203, v13, -v173, v203
    s_add_u32 m0, s21, 0
    v_mfma_f32_32x32x8_bf16 v[48:63], v[92:93], v[176:177], v[48:63]
    s_cbranch_vccnz WL_5_0
    v_mad_u32_u16 v234, v234, s3, v246 op_sel:[1,0,0,0]
    v_mad_u32_u16 v235, v235, s3, v246 op_sel:[1,0,0,0]
    buffer_load_dwordx4 v234, s[4:7], s38 offen  lds
    buffer_load_dwordx4 v235, s[8:11], s38 offen offset:1024  lds
WR_5_0:
    v_fma_f32 v203, v14, -v174, v203
    v_fma_f32 v203, v15, -v175, v203
    v_mfma_f32_32x32x16_bf16 v[0:15], v[72:75], v[180:183], 0
    v_fmac_f32 v200, v24, v160
    v_fmac_f32 v200, v25, v161
    v_fmac_f32 v200, v26, v162
    v_fmac_f32 v200, v27, v163
    v_fmac_f32 v200, v28, v164
    v_fmac_f32 v200, v29, v165
    v_fmac_f32 v200, v30, v166
    v_fmac_f32 v200, v31, v167
    v_mfma_f32_32x32x16_bf16 v[24:39], v[76:79], v[180:183], 0
    v_mul_f32 v254, v16, v144
    v_fmac_f32 v254, v17, v145
    v_fmac_f32 v254, v18, v146
    v_fmac_f32 v254, v19, v147
    v_fmac_f32 v254, v20, v148
    v_fmac_f32 v254, v21, v149
    v_mfma_f32_32x32x16_bf16 v[0:15], v[80:83], v[184:187], v[0:15]
    v_fmac_f32 v254, v22, v150
    v_fmac_f32 v254, v23, v151
    v_sub_f32_e64 v64, -v48, v64
    v_sub_f32_e64 v65, -v49, v65
    v_permlane32_swap_b32 v196, v254
    v_sub_f32_e64 v66, -v50, v66
    v_mfma_f32_32x32x16_bf16 v[24:39], v[84:87], v[184:187], v[24:39]
    s_waitcnt vmcnt(5)
    ds_read_b64_tr_b16 v[176:177], v244 offset:2048
    ds_read_b64_tr_b16 v[178:179], v244 offset:3072
    ds_read_b64_tr_b16 v[180:181], v245 offset:2048
    ds_read_b64_tr_b16 v[182:183], v245 offset:3072
    v_sub_f32_e64 v67, -v51, v67
    v_sub_f32_e64 v68, -v52, v68
    v_mfma_f32_32x32x8_bf16 v[24:39], v[92:93], v[188:189], v[24:39]
    v_sub_f32_e64 v69, -v53, v69
    v_sub_f32_e64 v70, -v54, v70
    v_sub_f32_e64 v71, -v55, v71
    v_add_f32 v254, v196, v254
    v_mfma_f32_32x32x8_bf16 v[0:15], v[88:89], v[188:189], v[0:15]
    s_waitcnt vmcnt(3) lgkmcnt(0)
    v_mfma_f32_32x32x16_bf16 v[56:71], v[76:79], v[176:179], v[56:71]
    s_nop 4
    v_sub_f32_e64 v40, -v24, v40
    v_sub_f32_e64 v41, -v25, v41
    v_sub_f32_e64 v42, -v26, v42
    v_sub_f32_e64 v43, -v27, v43
    v_sub_f32_e64 v44, -v28, v44
    v_sub_f32_e64 v45, -v29, v45
    v_sub_f32_e64 v46, -v30, v46
    v_sub_f32_e64 v47, -v31, v47
    s_add_u32 m0, s21, 2048
    v_mfma_f32_32x32x16_bf16 v[16:31], v[72:75], v[176:179], 0
    s_cbranch_vccnz WL_5_1
    v_mad_u32_u16 v236, v236, s3, v246 op_sel:[1,0,0,0]
    v_mad_u32_u16 v237, v237, s3, v246 op_sel:[1,0,0,0]
    buffer_load_dwordx4 v236, s[4:7], s39 offen  lds
    buffer_load_dwordx4 v237, s[8:11], s39 offen offset:1024  lds
WR_5_1:
    ds_read_b64_tr_b16 v[176:177], v244 offset:4096
    ds_read_b64_tr_b16 v[178:179], v244 offset:5120
    ds_read_b64_tr_b16 v[184:185], v245 offset:4096
    ds_read_b64_tr_b16 v[186:187], v245 offset:5120
    v_mul_f32 v255, v0, v152
    v_fmac_f32 v255, v1, v153
    v_fmac_f32 v255, v2, v154
    v_fmac_f32 v255, v3, v155
    v_fmac_f32 v255, v4, v156
    s_waitcnt vmcnt(4) lgkmcnt(0)
    v_mfma_f32_32x32x16_bf16 v[16:31], v[80:83], v[176:179], v[16:31]
    v_fmac_f32 v255, v5, v157
    v_fmac_f32 v255, v6, v158
    v_fmac_f32 v255, v7, v159
    v_fmac_f32 v201, v8, v168
    v_fmac_f32 v201, v9, v169
    v_permlane32_swap_b32 v197, v255
    s_add_u32 m0, s21, 4096
    v_mfma_f32_32x32x16_bf16 v[56:71], v[84:87], v[176:179], v[56:71]
    s_cbranch_vccnz WL_5_2
    v_mad_u32_u16 v238, v238, s3, v246 op_sel:[1,0,0,0]
    v_mad_u32_u16 v239, v239, s3, v246 op_sel:[1,0,0,0]
    buffer_load_dwordx4 v238, s[4:7], s40 offen  lds
    buffer_load_dwordx4 v239, s[8:11], s40 offen offset:1024  lds
WR_5_2:
    ds_read_b64_tr_b16 v[176:177], v244 offset:6144
    ds_read_b64_tr_b16 v[188:189], v245 offset:6144
    s_waitcnt lgkmcnt(0)
    v_mfma_f32_32x32x8_bf16 v[16:31], v[88:89], v[176:177], v[16:31]
    v_fmac_f32 v201, v10, v170
    v_fmac_f32 v201, v11, v171
    v_fmac_f32 v201, v12, v172
    v_fmac_f32 v201, v13, v173
    v_fmac_f32 v201, v14, v174
    v_fmac_f32 v201, v15, v175
    s_add_u32 m0, s21, 6144
    v_mfma_f32_32x32x8_bf16 v[56:71], v[92:93], v[176:177], v[56:71]
    s_cbranch_vccnz WL_5_3
    v_mad_u32_u16 v240, v240, s3, v246 op_sel:[1,0,0,0]
    v_mad_u32_u16 v241, v241, s3, v246 op_sel:[1,0,0,0]
    buffer_load_dwordx4 v240, s[4:7], s41 offen  lds
    buffer_load_dwordx4 v241, s[8:11], s41 offen offset:1024  lds
WR_5_3:
    v_add_f32 v255, v197, v255
    v_cvt_pk_bf16_f32 v194, v254, v255
    v_mfma_f32_32x32x16_bf16 v[0:15], v[72:75], v[180:183], 0
    v_mul_f32 v254, v16, v144
    v_fmac_f32 v254, v17, v145
    v_fmac_f32 v254, v18, v146
    v_fmac_f32 v254, v19, v147
    v_fmac_f32 v254, v20, v148
    v_fmac_f32 v254, v21, v149
    v_mfma_f32_32x32x16_bf16 v[32:47], v[76:79], v[180:183], v[32:47]
    v_fmac_f32 v254, v22, v150
    v_fmac_f32 v254, v23, v151
    v_fma_f32 v202, v24, -v160, v202
    v_fma_f32 v202, v25, -v161, v202
    v_permlane32_swap_b32 v254, v200
    v_fma_f32 v202, v26, -v162, v202
    v_mfma_f32_32x32x16_bf16 v[0:15], v[80:83], v[184:187], v[0:15]
    v_fma_f32 v202, v27, -v163, v202
    v_fma_f32 v202, v28, -v164, v202
    v_fma_f32 v202, v29, -v165, v202
    v_fma_f32 v202, v30, -v166, v202
    v_fma_f32 v202, v31, -v167, v202
    v_add_f32 v200, v254, v200
    v_mfma_f32_32x32x16_bf16 v[32:47], v[84:87], v[184:187], v[32:47]
    s_waitcnt vmcnt(6)
    ds_read_b64_tr_b16 v[176:177], v244 offset:0
    ds_read_b64_tr_b16 v[178:179], v244 offset:1024
    ds_read_b64_tr_b16 v[180:181], v245 offset:0
    ds_read_b64_tr_b16 v[182:183], v245 offset:1024
    v_mul_f32_e64 v198, v64, -v112
    v_permlane32_swap_b32 v202, v254
    v_mfma_f32_32x32x8_bf16 v[0:15], v[88:89], v[188:189], v[0:15]
    v_fma_f32 v198, v65, -v113, v198
    v_fma_f32 v198, v66, -v114, v198
    v_fma_f32 v198, v67, -v115, v198
    v_fma_f32 v198, v68, -v116, v198
    v_fma_f32 v198, v69, -v117, v198
    v_fma_f32 v198, v70, -v118, v198
    v_mfma_f32_32x32x8_bf16 v[32:47], v[92:93], v[188:189], v[32:47]
    v_add_u32 v249, s48, v249
    v_add_u32 v250, s49, v250
    ds_read_b32 v252, v251 offset:16
    ds_read_b64_tr_b16 v[72:73], v249 offset:0
    ds_read_b64_tr_b16 v[76:77], v249 offset:64
    ds_read_b64_tr_b16 v[74:75], v249 offset:256
    ds_read_b64_tr_b16 v[78:79], v249 offset:320
    s_mov_b64 exec, s[54:55]
    ds_read_u16_d16_hi v242, v250 offset:0
    s_mov_b64 exec, -1
    v_fma_f32 v198, v71, -v119, v198
    v_add_f32 v254, v202, v254
    v_mul_f32 v196, v56, v160
    v_fmac_f32 v196, v57, v161
    v_fmac_f32 v196, v58, v162
    v_fmac_f32 v196, v59, v163
    v_fmac_f32 v196, v60, v164
    v_fmac_f32 v196, v61, v165
    v_fmac_f32 v196, v62, v166
    v_fmac_f32 v196, v63, v167
    s_nop 1
    v_permlane32_swap_b32 v198, v196
    v_add_f32 v196, v198, v196
    s_cbranch_vccnz LEPI_0
    v_mul_f32 v255, v0, v152
    v_fmac_f32 v255, v1, v153
    v_fmac_f32 v255, v2, v154
    v_fmac_f32 v255, v3, v155
    v_fmac_f32 v255, v4, v156
    v_fmac_f32 v255, v5, v157
    v_fmac_f32 v255, v6, v158
    v_fmac_f32 v255, v7, v159
    v_fma_f32 v203, v8, -v168, v203
    v_fma_f32 v203, v9, -v169, v203
    v_permlane32_swap_b32 v255, v201
    v_fma_f32 v203, v10, -v170, v203
    v_fma_f32 v203, v11, -v171, v203
    v_fma_f32 v203, v12, -v172, v203
    v_fma_f32 v203, v13, -v173, v203
    v_fma_f32 v203, v14, -v174, v203
    v_fma_f32 v203, v15, -v175, v203
    v_add_f32 v201, v255, v201
    v_mul_f32_e64 v199, v40, -v120
    v_permlane32_swap_b32 v203, v255
    v_fma_f32 v199, v41, -v121, v199
    v_fma_f32 v199, v42, -v122, v199
    v_fma_f32 v199, v43, -v123, v199
    v_fma_f32 v199, v44, -v124, v199
    v_fma_f32 v199, v45, -v125, v199
    v_fma_f32 v199, v46, -v126, v199
    v_fma_f32 v199, v47, -v127, v199
    v_add_f32 v255, v203, v255
    v_mul_f32 v197, v32, v168
    v_fmac_f32 v197, v33, v169
    v_fmac_f32 v197, v34, v170
    v_fmac_f32 v197, v35, v171
    v_fmac_f32 v197, v36, v172
    v_fmac_f32 v197, v37, v173
    v_fmac_f32 v197, v38, v174
    v_fmac_f32 v197, v39, v175
    s_nop 1
    v_permlane32_swap_b32 v199, v197
    v_add_f32 v197, v199, v197
    v_cvt_pk_bf16_f32 v200, v200, v201
    v_cvt_pk_bf16_f32 v254, v254, v255
    v_cvt_pk_bf16_f32 v196, v196, v197
    ds_write2st64_b32 v253, v192, v193 offset0:0 offset1:1
    ds_write2st64_b32 v253, v194, v200 offset0:2 offset1:3
    ds_write_b32 v253, v196 offset:1024
    s_mov_b64 exec, 0xffffffff
    ds_write_b32 v253, v254 offset:1280
    s_mov_b64 exec, -1
    s_add_u32 s50, s50, 1
    s_cmp_ge_u32 s50, 4
    s_cbranch_scc1 LAST1
    s_waitcnt lgkmcnt(9)
    v_readfirstlane_b32 s66, v252
    s_add_u32 s53, s53, 1
    v_mov_b32 v252, s53
    s_cmp_le_u32 s53, s66
    ds_write2_b32 v251, v252, v252 offset0:0 offset1:8
    s_setprio 1
    s_cbranch_scc1 PRIO_12
    s_setprio 0
PRIO_12:
    s_cmp_eq_u32 s52, 4
    s_cbranch_scc1 ITEM_1_4
    s_cmp_eq_u32 s52, 5
    s_cbranch_scc1 ITEM_1_5
    s_cmp_eq_u32 s52, 3
    s_cbranch_scc1 ITEM_1_3
    s_cmp_eq_u32 s52, 6
    s_cbranch_scc1 ITEM_1_6
    s_cmp_eq_u32 s52, 8
    s_cbranch_scc1 ITEM_1_8
    s_branch ITEM_1_2
WL_5_0:
    s_add_u32 s66, s51, 0
    buffer_load_dwordx4 v[96:99], v246, s[16:19], s66 offen offset:2048 sc1
    buffer_load_dwordx4 v[100:103], v246, s[16:19], s66 offen offset:3072 sc1
    s_branch WR_5_0
WL_5_1:
    s_add_u32 s66, s51, 4096
    buffer_load_dwordx4 v[104:107], v246, s[16:19], s66 offen offset:2048 sc1
    buffer_load_dwordx4 v[108:111], v246, s[16:19], s66 offen offset:3072 sc1
    s_branch WR_5_1
WL_5_2:
    s_add_u32 s66, s51, 8192
    buffer_load_dwordx4 v[128:131], v246, s[16:19], s66 offen offset:2048 sc1
    buffer_load_dwordx4 v[132:135], v246, s[16:19], s66 offen offset:3072 sc1
    s_branch WR_5_2
WL_5_3:
    s_add_u32 s66, s51, 12288
    buffer_load_dwordx4 v[136:139], v246, s[16:19], s66 offen offset:2048 sc1
    buffer_load_dwordx4 v[140:143], v246, s[16:19], s66 offen offset:3072 sc1
    s_branch WR_5_3
.p2align 6
ITEM_1_3:
    s_mov_b64 exec, s[54:55]
    ds_read_u16_d16_hi v243, v250 offset:128
    s_mov_b64 exec, -1
    ds_read_b64_tr_b16 v[80:81], v249 offset:512
    ds_read_b64_tr_b16 v[84:85], v249 offset:576
    s_waitcnt lgkmcnt(3)
    v_mul_f32_dpp v196, v242, v72 row_newbcast:0 row_mask:0xf bank_mask:0xf
    v_mul_f32_dpp v197, v242, v73 row_newbcast:1 row_mask:0xf bank_mask:0xf
    v_mul_f32_dpp v198, v242, v72 row_newbcast:8 row_mask:0xf bank_mask:0xf
    v_mul_f32_dpp v199, v242, v73 row_newbcast:9 row_mask:0xf bank_mask:0xf
    v_mul_f32_dpp v200, v242, v76 row_newbcast:2 row_mask:0xf bank_mask:0xf
    v_mul_f32_dpp v201, v242, v77 row_newbcast:3 row_mask:0xf bank_mask:0xf
    v_mul_f32_dpp v202, v242, v76 row_newbcast:10 row_mask:0xf bank_mask:0xf
    v_mul_f32_dpp v203, v242, v77 row_newbcast:11 row_mask:0xf bank_mask:0xf
    v_cvt_pk_bf16_f32 v72, v196, v197
    v_cvt_pk_bf16_f32 v76, v198, v199
    v_cvt_pk_bf16_f32 v73, v200, v201
    v_cvt_pk_bf16_f32 v77, v202, v203
    v_mul_f32_dpp v196, v242, v74 row_newbcast:4 row_mask:0xf bank_mask:0xf
    v_mul_f32_dpp v197, v242, v75 row_newbcast:5 row_mask:0xf bank_mask:0xf
    v_mul_f32_dpp v198, v242, v74 row_newbcast:12 row_mask:0xf bank_mask:0xf
    v_mul_f32_dpp v199, v242, v75 row_newbcast:13 row_mask:0xf bank_mask:0xf
    v_mul_f32_dpp v200, v242, v78 row_newbcast:6 row_mask:0xf bank_mask:0xf
    v_mul_f32_dpp v201, v242, v79 row_newbcast:7 row_mask:0xf bank_mask:0xf
    v_mul_f32_dpp v202, v242, v78 row_newbcast:14 row_mask:0xf bank_mask:0xf
    v_mul_f32_dpp v203, v242, v79 row_newbcast:15 row_mask:0xf bank_mask:0xf
    v_cvt_pk_bf16_f32 v74, v196, v197
    v_cvt_pk_bf16_f32 v78, v198, v199
    v_cvt_pk_bf16_f32 v75, v200, v201
    v_cvt_pk_bf16_f32 v79, v202, v203
    s_waitcnt vmcnt(4) lgkmcnt(0)
    v_mfma_f32_32x32x16_bf16 v[56:71], v[72:75], v[176:179], 0
    v_mul_f32_dpp v196, v243, v80 row_newbcast:0 row_mask:0xf bank_mask:0xf
    v_mul_f32_dpp v197, v243, v81 row_newbcast:1 row_mask:0xf bank_mask:0xf
    v_mul_f32_dpp v198, v243, v80 row_newbcast:8 row_mask:0xf bank_mask:0xf
    v_mul_f32_dpp v199, v243, v81 row_newbcast:9 row_mask:0xf bank_mask:0xf
    v_mul_f32_dpp v200, v243, v84 row_newbcast:2 row_mask:0xf bank_mask:0xf
    v_mul_f32_dpp v201, v243, v85 row_newbcast:3 row_mask:0xf bank_mask:0xf
    s_add_u32 m0, s21, 0
    v_mfma_f32_32x32x16_bf16 v[16:31], v[76:79], v[176:179], 0
    buffer_load_dwordx4 v234, s[4:7], s36 offen  lds
    buffer_load_dwordx4 v235, s[8:11], s36 offen offset:1024  lds
    ds_read_b64_tr_b16 v[176:177], v244 offset:2048
    ds_read_b64_tr_b16 v[184:185], v245 offset:2048
    v_mul_f32_dpp v202, v243, v84 row_newbcast:10 row_mask:0xf bank_mask:0xf
    v_mul_f32_dpp v203, v243, v85 row_newbcast:11 row_mask:0xf bank_mask:0xf
    v_cvt_pk_bf16_f32 v80, v196, v197
    v_cvt_pk_bf16_f32 v84, v198, v199
    v_cvt_pk_bf16_f32 v81, v200, v201
    v_cvt_pk_bf16_f32 v85, v202, v203
    s_waitcnt lgkmcnt(0)
    v_mfma_f32_32x32x8_bf16 v[56:71], v[80:81], v[176:177], v[56:71]
    s_add_u32 m0, s21, 2048
    v_mfma_f32_32x32x8_bf16 v[16:31], v[84:85], v[176:177], v[16:31]
    buffer_load_dwordx4 v236, s[4:7], s36 offen  lds
    s_mov_b32 m0, s50
    s_nop 0
    s_movrels_b32 s71, s23
    s_movrels_b32 s33, s28
    v_add_u32 v253, s33, v248
    s_bfe_u32 s46, s71, 0x30012
    s_mov_b32 m0, s46
    s_and_b32 s66, s71, 0x3ffff
    s_movrels_b32 s68, s57
    s_movrels_b32 s69, s61
    s_sub_u32 s48, s66, s47
    s_mov_b32 s47, s66
    s_lshr_b32 s52, s71, 28
    s_lshl_b32 s67, s46, 9
    s_add_u32 s66, s66, s67
    s_sub_u32 s49, s66, s42
    s_mov_b32 s42, s66
    s_bfe_u32 s66, s68, 655360
    s_add_u32 s43, s42, s66
    s_bfe_u32 s39, s69, 655360
    s_bfe_u32 s66, s68, 655370
    s_add_u32 s44, s42, s66
    s_bfe_u32 s40, s69, 655370
    s_bfe_u32 s66, s68, 655380
    s_add_u32 s45, s42, s66
    s_bfe_u32 s41, s69, 655380
    v_add_u32 v252, s44, v247
    ds_read2_b32 v[238:239], v252 offset0:0 offset1:16
    v_add_u32 v252, s45, v247
    ds_read2_b32 v[240:241], v252 offset0:0 offset1:16
    v_mfma_f32_32x32x16_bf16 v[32:47], v[72:75], v[180:183], 0
    v_mul_f32 v196, v56, v96
    v_fmac_f32 v196, v57, v97
    v_fmac_f32 v196, v58, v98
    v_fmac_f32 v196, v59, v99
    v_fmac_f32 v196, v60, v100
    v_fmac_f32 v196, v61, v101
    v_mfma_f32_32x32x16_bf16 v[0:15], v[76:79], v[180:183], 0
    s_waitcnt vmcnt(5)
    ds_read_b64_tr_b16 v[176:177], v244 offset:4096
    ds_read_b64_tr_b16 v[178:179], v244 offset:5120
    ds_read_b64_tr_b16 v[180:181], v245 offset:4096
    ds_read_b64_tr_b16 v[182:183], v245 offset:5120
    v_fmac_f32 v196, v62, v102
    v_fmac_f32 v196, v63, v103
    v_mfma_f32_32x32x8_bf16 v[32:47], v[80:81], v[184:185], v[32:47]
    v_mul_f32 v198, v64, v128
    v_fmac_f32 v198, v65, v129
    v_fmac_f32 v198, v66, v130
    v_fmac_f32 v198, v67, v131
    v_fmac_f32 v198, v68, v132
    v_fmac_f32 v198, v69, v133
    v_mfma_f32_32x32x8_bf16 v[0:15], v[84:85], v[184:185], v[0:15]
    v_fmac_f32 v198, v70, v134
    v_fmac_f32 v198, v71, v135
    v_mul_f32 v200, v16, v128
    v_fmac_f32 v200, v17, v129
    v_permlane32_swap_b32 v196, v198
    v_fmac_f32 v200, v18, v130
    v_fmac_f32 v200, v19, v131
    v_fmac_f32 v200, v20, v132
    v_fmac_f32 v200, v21, v133
    v_fmac_f32 v200, v22, v134
    v_fmac_f32 v200, v23, v135
    v_add_f32 v198, v196, v198
    v_mul_f32_e64 v202, v24, -v128
    v_fma_f32 v202, v25, -v129, v202
    v_fma_f32 v202, v26, -v130, v202
    v_fma_f32 v202, v27, -v131, v202
    v_fma_f32 v202, v28, -v132, v202
    v_fma_f32 v202, v29, -v133, v202
    v_fma_f32 v202, v30, -v134, v202
    v_fma_f32 v202, v31, -v135, v202
    s_nop 1
    v_permlane32_swap_b32 v200, v202
    v_add_f32 v202, v200, v202
    s_waitcnt vmcnt(3) lgkmcnt(0)
    v_mfma_f32_32x32x16_bf16 v[56:71], v[72:75], v[176:179], 0
    v_mul_f32 v197, v32, v104
    v_fmac_f32 v197, v33, v105
    v_fmac_f32 v197, v34, v106
    v_fmac_f32 v197, v35, v107
    v_fmac_f32 v197, v36, v108
    v_fmac_f32 v197, v37, v109
    s_add_u32 m0, s21, 4096
    v_mfma_f32_32x32x16_bf16 v[16:31], v[76:79], v[176:179], 0
    buffer_load_dwordx4 v234, s[4:7], s37 offen  lds
    buffer_load_dwordx4 v235, s[8:11], s37 offen offset:1024  lds
    ds_read_b64_tr_b16 v[176:177], v244 offset:6144
    ds_read_b64_tr_b16 v[184:185], v245 offset:6144
    v_add_u32 v252, s42, v247
    ds_read2_b32 v[234:235], v252 offset0:0 offset1:16
    v_fmac_f32 v197, v38, v110
    v_fmac_f32 v197, v39, v111
    v_mul_f32 v199, v40, v136
    v_fmac_f32 v199, v41, v137
    v_fmac_f32 v199, v42, v138
    v_fmac_f32 v199, v43, v139
    v_fmac_f32 v199, v44, v140
    v_fmac_f32 v199, v45, v141
    v_fmac_f32 v199, v46, v142
    v_fmac_f32 v199, v47, v143
    v_mul_f32 v201, v0, v136
    v_fmac_f32 v201, v1, v137
    v_permlane32_swap_b32 v197, v199
    v_fmac_f32 v201, v2, v138
    v_fmac_f32 v201, v3, v139
    v_fmac_f32 v201, v4, v140
    v_fmac_f32 v201, v5, v141
    v_fmac_f32 v201, v6, v142
    v_fmac_f32 v201, v7, v143
    v_add_f32 v199, v197, v199
    v_mul_f32_e64 v203, v8, -v136
    v_fma_f32 v203, v9, -v137, v203
    v_fma_f32 v203, v10, -v138, v203
    s_waitcnt lgkmcnt(1)
    v_mfma_f32_32x32x8_bf16 v[56:71], v[80:81], v[176:177], v[56:71]
    v_fma_f32 v203, v11, -v139, v203
    v_fma_f32 v203, v12, -v140, v203
    v_fma_f32 v203, v13, -v141, v203
    v_fma_f32 v203, v14, -v142, v203
    v_fma_f32 v203, v15, -v143, v203
    s_nop 1
    v_permlane32_swap_b32 v201, v203
    s_add_u32 m0, s21, 6144
    v_mfma_f32_32x32x8_bf16 v[16:31], v[84:85], v[176:177], v[16:31]
    buffer_load_dwordx4 v236, s[4:7], s37 offen  lds
    v_add_u32 v252, s43, v247
    ds_read2_b32 v[236:237], v252 offset0:0 offset1:16
    v_add_f32 v203, v201, v203
    v_cvt_pk_bf16_f32 v192, v198, v199
    v_cvt_pk_bf16_f32 v193, v202, v203
    v_mfma_f32_32x32x16_bf16 v[32:47], v[72:75], v[180:183], 0
    v_mul_f32 v196, v56, v144
    v_fmac_f32 v196, v57, v145
    v_fmac_f32 v196, v58, v146
    v_fmac_f32 v196, v59, v147
    v_fmac_f32 v196, v60, v148
    v_fmac_f32 v196, v61, v149
    v_mfma_f32_32x32x16_bf16 v[0:15], v[76:79], v[180:183], 0
    s_waitcnt vmcnt(4)
    ds_read_b64_tr_b16 v[176:177], v244 offset:0
    ds_read_b64_tr_b16 v[178:179], v244 offset:1024
    ds_read_b64_tr_b16 v[180:181], v245 offset:0
    ds_read_b64_tr_b16 v[182:183], v245 offset:1024
    v_fmac_f32 v196, v62, v150
    v_fmac_f32 v196, v63, v151
    v_mfma_f32_32x32x8_bf16 v[32:47], v[80:81], v[184:185], v[32:47]
    v_mul_f32_e64 v200, v16, -v160
    v_fma_f32 v200, v17, -v161, v200
    v_fma_f32 v200, v18, -v162, v200
    v_fma_f32 v200, v19, -v163, v200
    v_fma_f32 v200, v20, -v164, v200
    v_fma_f32 v200, v21, -v165, v200
    v_mfma_f32_32x32x8_bf16 v[0:15], v[84:85], v[184:185], v[0:15]
    v_fma_f32 v200, v22, -v166, v200
    v_fma_f32 v200, v23, -v167, v200
    v_mul_f32_e64 v202, v24, -v160
    v_fma_f32 v202, v25, -v161, v202
    v_fma_f32 v202, v26, -v162, v202
    v_fma_f32 v202, v27, -v163, v202
    v_fma_f32 v202, v28, -v164, v202
    v_fma_f32 v202, v29, -v165, v202
    v_fma_f32 v202, v30, -v166, v202
    v_fma_f32 v202, v31, -v167, v202
    s_waitcnt vmcnt(3) lgkmcnt(0)
    v_mfma_f32_32x32x16_bf16 v[16:31], v[72:75], v[176:179], 0
    v_mul_f32 v197, v32, v152
    v_fmac_f32 v197, v33, v153
    v_fmac_f32 v197, v34, v154
    v_fmac_f32 v197, v35, v155
    v_fmac_f32 v197, v36, v156
    v_fmac_f32 v197, v37, v157
    s_add_u32 m0, s21, 0
    v_mfma_f32_32x32x16_bf16 v[48:63], v[76:79], v[176:179], 0
    s_cbranch_vccnz WL_3_0
    v_mad_u32_u16 v234, v234, s3, v246 op_sel:[1,0,0,0]
    v_mad_u32_u16 v235, v235, s3, v246 op_sel:[1,0,0,0]
    buffer_load_dwordx4 v234, s[4:7], s38 offen  lds
    buffer_load_dwordx4 v235, s[8:11], s38 offen offset:1024  lds
WR_3_0:
    ds_read_b64_tr_b16 v[176:177], v244 offset:2048
    ds_read_b64_tr_b16 v[184:185], v245 offset:2048
    v_fmac_f32 v197, v38, v158
    v_fmac_f32 v197, v39, v159
    v_mul_f32_e64 v201, v0, -v168
    v_fma_f32 v201, v1, -v169, v201
    v_fma_f32 v201, v2, -v170, v201
    v_fma_f32 v201, v3, -v171, v201
    v_fma_f32 v201, v4, -v172, v201
    v_fma_f32 v201, v5, -v173, v201
    v_fma_f32 v201, v6, -v174, v201
    v_fma_f32 v201, v7, -v175, v201
    s_waitcnt lgkmcnt(0)
    v_mfma_f32_32x32x8_bf16 v[16:31], v[80:81], v[176:177], v[16:31]
    v_mul_f32_e64 v203, v8, -v168
    v_fma_f32 v203, v9, -v169, v203
    v_fma_f32 v203, v10, -v170, v203
    v_fma_f32 v203, v11, -v171, v203
    v_fma_f32 v203, v12, -v172, v203
    v_fma_f32 v203, v13, -v173, v203
    s_add_u32 m0, s21, 2048
    v_mfma_f32_32x32x8_bf16 v[48:63], v[84:85], v[176:177], v[48:63]
    s_cbranch_vccnz WL_3_1
    v_mad_u32_u16 v236, v236, s3, v246 op_sel:[1,0,0,0]
    v_mad_u32_u16 v237, v237, s3, v246 op_sel:[1,0,0,0]
    buffer_load_dwordx4 v236, s[4:7], s39 offen  lds
    buffer_load_dwordx4 v237, s[8:11], s39 offen offset:1024  lds
WR_3_1:
    v_fma_f32 v203, v14, -v174, v203
    v_fma_f32 v203, v15, -v175, v203
    v_mfma_f32_32x32x16_bf16 v[0:15], v[72:75], v[180:183], 0
    v_fmac_f32 v200, v24, v160
    v_fmac_f32 v200, v25, v161
    v_fmac_f32 v200, v26, v162
    v_fmac_f32 v200, v27, v163
    v_fmac_f32 v200, v28, v164
    v_fmac_f32 v200, v29, v165
    v_fmac_f32 v200, v30, v166
    v_fmac_f32 v200, v31, v167
    v_mfma_f32_32x32x16_bf16 v[24:39], v[76:79], v[180:183], 0
    s_waitcnt vmcnt(5)
    ds_read_b64_tr_b16 v[176:177], v244 offset:4096
    ds_read_b64_tr_b16 v[178:179], v244 offset:5120
    ds_read_b64_tr_b16 v[180:181], v245 offset:4096
    ds_read_b64_tr_b16 v[182:183], v245 offset:5120
    v_mul_f32 v254, v16, v144
    v_fmac_f32 v254, v17, v145
    v_mfma_f32_32x32x8_bf16 v[24:39], v[84:85], v[184:185], v[24:39]
    v_fmac_f32 v254, v18, v146
    v_fmac_f32 v254, v19, v147
    v_fmac_f32 v254, v20, v148
    v_fmac_f32 v254, v21, v149
    v_fmac_f32 v254, v22, v150
    v_fmac_f32 v254, v23, v151
    v_mfma_f32_32x32x8_bf16 v[0:15], v[80:81], v[184:185], v[0:15]
    v_sub_f32_e64 v64, -v48, v64
    v_sub_f32_e64 v65, -v49, v65
    v_permlane32_swap_b32 v196, v254
    v_sub_f32_e64 v66, -v50, v66
    v_sub_f32_e64 v67, -v51, v67
    v_sub_f32_e64 v68, -v52, v68
    v_sub_f32_e64 v69, -v53, v69
    v_sub_f32_e64 v70, -v54, v70
    v_sub_f32_e64 v71, -v55, v71
    v_add_f32 v254, v196, v254
    s_waitcnt vmcnt(4) lgkmcnt(0)
    v_mfma_f32_32x32x16_bf16 v[56:71], v[76:79], v[176:179], v[56:71]
    v_sub_f32_e64 v40, -v24, v40
    v_sub_f32_e64 v41, -v25, v41
    v_sub_f32_e64 v42, -v26, v42
    v_sub_f32_e64 v43, -v27, v43
    v_sub_f32_e64 v44, -v28, v44
    v_sub_f32_e64 v45, -v29, v45
    v_sub_f32_e64 v46, -v30, v46
    v_sub_f32_e64 v47, -v31, v47
    s_add_u32 m0, s21, 4096
    v_mfma_f32_32x32x16_bf16 v[16:31], v[72:75], v[176:179], 0
    s_cbranch_vccnz WL_3_2
    v_mad_u32_u16 v238, v238, s3, v246 op_sel:[1,0,0,0]
    v_mad_u32_u16 v239, v239, s3, v246 op_sel:[1,0,0,0]
    buffer_load_dwordx4 v238, s[4:7], s40 offen  lds
    buffer_load_dwordx4 v239, s[8:11], s40 offen offset:1024  lds
WR_3_2:
    ds_read_b64_tr_b16 v[176:177], v244 offset:6144
    ds_read_b64_tr_b16 v[184:185], v245 offset:6144
    v_mul_f32 v255, v0, v152
    v_fmac_f32 v255, v1, v153
    v_fmac_f32 v255, v2, v154
    v_fmac_f32 v255, v3, v155
    v_fmac_f32 v255, v4, v156
    v_fmac_f32 v255, v5, v157
    v_fmac_f32 v255, v6, v158
    v_fmac_f32 v255, v7, v159
    v_fmac_f32 v201, v8, v168
    v_fmac_f32 v201, v9, v169
    v_permlane32_swap_b32 v197, v255
    s_waitcnt lgkmcnt(0)
    v_mfma_f32_32x32x8_bf16 v[16:31], v[80:81], v[176:177], v[16:31]
    v_fmac_f32 v201, v10, v170
    v_fmac_f32 v201, v11, v171
    v_fmac_f32 v201, v12, v172
    v_fmac_f32 v201, v13, v173
    v_fmac_f32 v201, v14, v174
    v_fmac_f32 v201, v15, v175
    s_add_u32 m0, s21, 6144
    v_mfma_f32_32x32x8_bf16 v[56:71], v[84:85], v[176:177], v[56:71]
    s_cbranch_vccnz WL_3_3
    v_mad_u32_u16 v240, v240, s3, v246 op_sel:[1,0,0,0]
    v_mad_u32_u16 v241, v241, s3, v246 op_sel:[1,0,0,0]
    buffer_load_dwordx4 v240, s[4:7], s41 offen  lds
    buffer_load_dwordx4 v241, s[8:11], s41 offen offset:1024  lds
WR_3_3:
    v_add_f32 v255, v197, v255
    v_cvt_pk_bf16_f32 v194, v254, v255
    v_mfma_f32_32x32x16_bf16 v[0:15], v[72:75], v[180:183], 0
    v_mul_f32 v254, v16, v144
    v_fmac_f32 v254, v17, v145
    v_fmac_f32 v254, v18, v146
    v_fmac_f32 v254, v19, v147
    v_fmac_f32 v254, v20, v148
    v_fmac_f32 v254, v21, v149
    v_mfma_f32_32x32x16_bf16 v[32:47], v[76:79], v[180:183], v[32:47]
    s_waitcnt vmcnt(6)
    ds_read_b64_tr_b16 v[176:177], v244 offset:0
    ds_read_b64_tr_b16 v[178:179], v244 offset:1024
    ds_read_b64_tr_b16 v[180:181], v245 offset:0
    ds_read_b64_tr_b16 v[182:183], v245 offset:1024
    v_fmac_f32 v254, v22, v150
    v_fmac_f32 v254, v23, v151
    v_mfma_f32_32x32x8_bf16 v[0:15], v[80:81], v[184:185], v[0:15]
    v_fma_f32 v202, v24, -v160, v202
    v_fma_f32 v202, v25, -v161, v202
    v_permlane32_swap_b32 v254, v200
    v_fma_f32 v202, v26, -v162, v202
    v_fma_f32 v202, v27, -v163, v202
    v_fma_f32 v202, v28, -v164, v202
    v_mfma_f32_32x32x8_bf16 v[32:47], v[84:85], v[184:185], v[32:47]
    v_add_u32 v249, s48, v249
    v_add_u32 v250, s49, v250
    ds_read_b32 v252, v251 offset:16
    ds_read_b64_tr_b16 v[72:73], v249 offset:0
    ds_read_b64_tr_b16 v[76:77], v249 offset:64
    ds_read_b64_tr_b16 v[74:75], v249 offset:256
    ds_read_b64_tr_b16 v[78:79], v249 offset:320
    s_mov_b64 exec, s[54:55]
    ds_read_u16_d16_hi v242, v250 offset:0
    s_mov_b64 exec, -1
    v_fma_f32 v202, v29, -v165, v202
    v_fma_f32 v202, v30, -v166, v202
    v_fma_f32 v202, v31, -v167, v202
    v_add_f32 v200, v254, v200
    v_mul_f32_e64 v198, v64, -v112
    v_permlane32_swap_b32 v202, v254
    v_fma_f32 v198, v65, -v113, v198
    v_fma_f32 v198, v66, -v114, v198
    v_fma_f32 v198, v67, -v115, v198
    v_fma_f32 v198, v68, -v116, v198
    v_fma_f32 v198, v69, -v117, v198
    v_fma_f32 v198, v70, -v118, v198
    v_fma_f32 v198, v71, -v119, v198
    v_add_f32 v254, v202, v254
    v_mul_f32 v196, v56, v160
    v_fmac_f32 v196, v57, v161
    v_fmac_f32 v196, v58, v162
    v_fmac_f32 v196, v59, v163
    v_fmac_f32 v196, v60, v164
    v_fmac_f32 v196, v61, v165
    v_fmac_f32 v196, v62, v166
    v_fmac_f32 v196, v63, v167
    s_nop 1
    v_permlane32_swap_b32 v198, v196
    v_add_f32 v196, v198, v196
    s_cbranch_vccnz LEPI_0
    v_mul_f32 v255, v0, v152
    v_fmac_f32 v255, v1, v153
    v_fmac_f32 v255, v2, v154
    v_fmac_f32 v255, v3, v155
    v_fmac_f32 v255, v4, v156
    v_fmac_f32 v255, v5, v157
    v_fmac_f32 v255, v6, v158
    v_fmac_f32 v255, v7, v159
    v_fma_f32 v203, v8, -v168, v203
    v_fma_f32 v203, v9, -v169, v203
    v_permlane32_swap_b32 v255, v201
    v_fma_f32 v203, v10, -v170, v203
    v_fma_f32 v203, v11, -v171, v203
    v_fma_f32 v203, v12, -v172, v203
    v_fma_f32 v203, v13, -v173, v203
    v_fma_f32 v203, v14, -v174, v203
    v_fma_f32 v203, v15, -v175, v203
    v_add_f32 v201, v255, v201
    v_mul_f32_e64 v199, v40, -v120
    v_permlane32_swap_b32 v203, v255
    v_fma_f32 v199, v41, -v121, v199
    v_fma_f32 v199, v42, -v122, v199
    v_fma_f32 v199, v43, -v123, v199
    v_fma_f32 v199, v44, -v124, v199
    v_fma_f32 v199, v45, -v125, v199
    v_fma_f32 v199, v46, -v126, v199
    v_fma_f32 v199, v47, -v127, v199
    v_add_f32 v255, v203, v255
    v_mul_f32 v197, v32, v168
    v_fmac_f32 v197, v33, v169
    v_fmac_f32 v197, v34, v170
    v_fmac_f32 v197, v35, v171
    v_fmac_f32 v197, v36, v172
    v_fmac_f32 v197, v37, v173
    v_fmac_f32 v197, v38, v174
    v_fmac_f32 v197, v39, v175
    s_nop 1
    v_permlane32_swap_b32 v199, v197
    v_add_f32 v197, v199, v197
    v_cvt_pk_bf16_f32 v200, v200, v201
    v_cvt_pk_bf16_f32 v254, v254, v255
    v_cvt_pk_bf16_f32 v196, v196, v197
    ds_write2st64_b32 v253, v192, v193 offset0:0 offset1:1
    ds_write2st64_b32 v253, v194, v200 offset0:2 offset1:3
    ds_write_b32 v253, v196 offset:1024
    s_mov_b64 exec, 0xffffffff
    ds_write_b32 v253, v254 offset:1280
    s_mov_b64 exec, -1
    s_add_u32 s50, s50, 1
    s_cmp_ge_u32 s50, 4
    s_cbranch_scc1 LAST1
    s_waitcnt lgkmcnt(9)
    v_readfirstlane_b32 s66, v252
    s_add_u32 s53, s53, 1
    v_mov_b32 v252, s53
    s_cmp_le_u32 s53, s66
    ds_write2_b32 v251, v252, v252 offset0:0 offset1:8
    s_setprio 1
    s_cbranch_scc1 PRIO_13
    s_setprio 0
PRIO_13:
    s_cmp_eq_u32 s52, 4
    s_cbranch_scc1 ITEM_1_4
    s_cmp_eq_u32 s52, 5
    s_cbranch_scc1 ITEM_1_5
    s_cmp_eq_u32 s52, 3
    s_cbranch_scc1 ITEM_1_3
    s_cmp_eq_u32 s52, 6
    s_cbranch_scc1 ITEM_1_6
    s_cmp_eq_u32 s52, 8
    s_cbranch_scc1 ITEM_1_8
    s_branch ITEM_1_2
WL_3_0:
    s_add_u32 s66, s51, 0
    buffer_load_dwordx4 v[96:99], v246, s[16:19], s66 offen offset:2048 sc1
    buffer_load_dwordx4 v[100:103], v246, s[16:19], s66 offen offset:3072 sc1
    s_branch WR_3_0
WL_3_1:
    s_add_u32 s66, s51, 4096
    buffer_load_dwordx4 v[104:107], v246, s[16:19], s66 offen offset:2048 sc1
    buffer_load_dwordx4 v[108:111], v246, s[16:19], s66 offen offset:3072 sc1
    s_branch WR_3_1
WL_3_2:
    s_add_u32 s66, s51, 8192
    buffer_load_dwordx4 v[128:131], v246, s[16:19], s66 offen offset:2048 sc1
    buffer_load_dwordx4 v[132:135], v246, s[16:19], s66 offen offset:3072 sc1
    s_branch WR_3_2
WL_3_3:
    s_add_u32 s66, s51, 12288
    buffer_load_dwordx4 v[136:139], v246, s[16:19], s66 offen offset:2048 sc1
    buffer_load_dwordx4 v[140:143], v246, s[16:19], s66 offen offset:3072 sc1
    s_branch WR_3_3
.p2align 6
ITEM_1_6:
    s_mov_b64 exec, s[54:55]
    ds_read_u16_d16_hi v243, v250 offset:128
    s_mov_b64 exec, -1
    ds_read_b64_tr_b16 v[80:81], v249 offset:512
    ds_read_b64_tr_b16 v[84:85], v249 offset:576
    ds_read_b64_tr_b16 v[82:83], v249 offset:768
    ds_read_b64_tr_b16 v[86:87], v249 offset:832
    ds_read_b64_tr_b16 v[88:89], v249 offset:1024
    ds_read_b64_tr_b16 v[92:93], v249 offset:1088
    ds_read_b64_tr_b16 v[90:91], v249 offset:1280
    ds_read_b64_tr_b16 v[94:95], v249 offset:1344
    s_waitcnt lgkmcnt(9)
    v_mul_f32_dpp v196, v242, v72 row_newbcast:0 row_mask:0xf bank_mask:0xf
    v_mul_f32_dpp v197, v242, v73 row_newbcast:1 row_mask:0xf bank_mask:0xf
    v_mul_f32_dpp v198, v242, v72 row_newbcast:8 row_mask:0xf bank_mask:0xf
    v_mul_f32_dpp v199, v242, v73 row_newbcast:9 row_mask:0xf bank_mask:0xf
    v_mul_f32_dpp v200, v242, v76 row_newbcast:2 row_mask:0xf bank_mask:0xf
    v_mul_f32_dpp v201, v242, v77 row_newbcast:3 row_mask:0xf bank_mask:0xf
    v_mul_f32_dpp v202, v242, v76 row_newbcast:10 row_mask:0xf bank_mask:0xf
    v_mul_f32_dpp v203, v242, v77 row_newbcast:11 row_mask:0xf bank_mask:0xf
    v_cvt_pk_bf16_f32 v72, v196, v197
    v_cvt_pk_bf16_f32 v76, v198, v199
    v_cvt_pk_bf16_f32 v73, v200, v201
    v_cvt_pk_bf16_f32 v77, v202, v203
    v_mul_f32_dpp v196, v242, v74 row_newbcast:4 row_mask:0xf bank_mask:0xf
    v_mul_f32_dpp v197, v242, v75 row_newbcast:5 row_mask:0xf bank_mask:0xf
    v_mul_f32_dpp v198, v242, v74 row_newbcast:12 row_mask:0xf bank_mask:0xf
    v_mul_f32_dpp v199, v242, v75 row_newbcast:13 row_mask:0xf bank_mask:0xf
    v_mul_f32_dpp v200, v242, v78 row_newbcast:6 row_mask:0xf bank_mask:0xf
    v_mul_f32_dpp v201, v242, v79 row_newbcast:7 row_mask:0xf bank_mask:0xf
    v_mul_f32_dpp v202, v242, v78 row_newbcast:14 row_mask:0xf bank_mask:0xf
    v_mul_f32_dpp v203, v242, v79 row_newbcast:15 row_mask:0xf bank_mask:0xf
    v_cvt_pk_bf16_f32 v74, v196, v197
    v_cvt_pk_bf16_f32 v78, v198, v199
    v_cvt_pk_bf16_f32 v75, v200, v201
    v_cvt_pk_bf16_f32 v79, v202, v203
    s_mov_b64 exec, s[54:55]
    ds_read_u16_d16_hi v242, v250 offset:256
    s_mov_b64 exec, -1
    s_waitcnt vmcnt(4) lgkmcnt(5)
    v_mfma_f32_32x32x16_bf16 v[56:71], v[72:75], v[176:179], 0
    v_mul_f32_dpp v196, v243, v80 row_newbcast:0 row_mask:0xf bank_mask:0xf
    v_mul_f32_dpp v197, v243, v81 row_newbcast:1 row_mask:0xf bank_mask:0xf
    v_mul_f32_dpp v198, v243, v80 row_newbcast:8 row_mask:0xf bank_mask:0xf
    v_mul_f32_dpp v199, v243, v81 row_newbcast:9 row_mask:0xf bank_mask:0xf
    v_mul_f32_dpp v200, v243, v84 row_newbcast:2 row_mask:0xf bank_mask:0xf
    v_mul_f32_dpp v201, v243, v85 row_newbcast:3 row_mask:0xf bank_mask:0xf
    s_add_u32 m0, s21, 0
    v_mfma_f32_32x32x16_bf16 v[16:31], v[76:79], v[176:179], 0
    buffer_load_dwordx4 v236, s[4:7], s35 offen  lds
    buffer_load_dwordx4 v237, s[8:11], s35 offen offset:1024  lds
    ds_read_b64_tr_b16 v[176:177], v244 offset:2048
    ds_read_b64_tr_b16 v[178:179], v244 offset:3072
    ds_read_b64_tr_b16 v[184:185], v245 offset:2048
    ds_read_b64_tr_b16 v[186:187], v245 offset:3072
    v_mul_f32_dpp v202, v243, v84 row_newbcast:10 row_mask:0xf bank_mask:0xf
    v_mul_f32_dpp v203, v243, v85 row_newbcast:11 row_mask:0xf bank_mask:0xf
    v_cvt_pk_bf16_f32 v80, v196, v197
    v_cvt_pk_bf16_f32 v84, v198, v199
    v_cvt_pk_bf16_f32 v81, v200, v201
    v_cvt_pk_bf16_f32 v85, v202, v203
    v_mul_f32_dpp v196, v243, v82 row_newbcast:4 row_mask:0xf bank_mask:0xf
    v_mul_f32_dpp v197, v243, v83 row_newbcast:5 row_mask:0xf bank_mask:0xf
    v_mul_f32_dpp v198, v243, v82 row_newbcast:12 row_mask:0xf bank_mask:0xf
    v_mul_f32_dpp v199, v243, v83 row_newbcast:13 row_mask:0xf bank_mask:0xf
    v_mul_f32_dpp v200, v243, v86 row_newbcast:6 row_mask:0xf bank_mask:0xf
    v_mul_f32_dpp v201, v243, v87 row_newbcast:7 row_mask:0xf bank_mask:0xf
    v_mul_f32_dpp v202, v243, v86 row_newbcast:14 row_mask:0xf bank_mask:0xf
    v_mul_f32_dpp v203, v243, v87 row_newbcast:15 row_mask:0xf bank_mask:0xf
    v_cvt_pk_bf16_f32 v82, v196, v197
    v_cvt_pk_bf16_f32 v86, v198, v199
    v_cvt_pk_bf16_f32 v83, v200, v201
    v_cvt_pk_bf16_f32 v87, v202, v203
    s_waitcnt vmcnt(4) lgkmcnt(0)
    v_mfma_f32_32x32x16_bf16 v[56:71], v[80:83], v[176:179], v[56:71]
    v_mul_f32_dpp v196, v242, v88 row_newbcast:0 row_mask:0xf bank_mask:0xf
    v_mul_f32_dpp v197, v242, v89 row_newbcast:1 row_mask:0xf bank_mask:0xf
    v_mul_f32_dpp v198, v242, v88 row_newbcast:8 row_mask:0xf bank_mask:0xf
    v_mul_f32_dpp v199, v242, v89 row_newbcast:9 row_mask:0xf bank_mask:0xf
    v_mul_f32_dpp v200, v242, v92 row_newbcast:2 row_mask:0xf bank_mask:0xf
    v_mul_f32_dpp v201, v242, v93 row_newbcast:3 row_mask:0xf bank_mask:0xf
    s_add_u32 m0, s21, 2048
    v_mfma_f32_32x32x16_bf16 v[16:31], v[84:87], v[176:179], v[16:31]
    buffer_load_dwordx4 v238, s[4:7], s35 offen  lds
    buffer_load_dwordx4 v239, s[8:11], s35 offen offset:1024  lds
    ds_read_b64_tr_b16 v[176:177], v244 offset:4096
    ds_read_b64_tr_b16 v[178:179], v244 offset:5120
    ds_read_b64_tr_b16 v[188:189], v245 offset:4096
    ds_read_b64_tr_b16 v[190:191], v245 offset:5120
    v_mul_f32_dpp v202, v242, v92 row_newbcast:10 row_mask:0xf bank_mask:0xf
    v_mul_f32_dpp v203, v242, v93 row_newbcast:11 row_mask:0xf bank_mask:0xf
    v_cvt_pk_bf16_f32 v88, v196, v197
    v_cvt_pk_bf16_f32 v92, v198, v199
    v_cvt_pk_bf16_f32 v89, v200, v201
    v_cvt_pk_bf16_f32 v93, v202, v203
    v_mul_f32_dpp v196, v242, v90 row_newbcast:4 row_mask:0xf bank_mask:0xf
    v_mul_f32_dpp v197, v242, v91 row_newbcast:5 row_mask:0xf bank_mask:0xf
    v_mul_f32_dpp v198, v242, v90 row_newbcast:12 row_mask:0xf bank_mask:0xf
    v_mul_f32_dpp v199, v242, v91 row_newbcast:13 row_mask:0xf bank_mask:0xf
    v_mul_f32_dpp v200, v242, v94 row_newbcast:6 row_mask:0xf bank_mask:0xf
    v_mul_f32_dpp v201, v242, v95 row_newbcast:7 row_mask:0xf bank_mask:0xf
    v_mul_f32_dpp v202, v242, v94 row_newbcast:14 row_mask:0xf bank_mask:0xf
    v_mul_f32_dpp v203, v242, v95 row_newbcast:15 row_mask:0xf bank_mask:0xf
    v_cvt_pk_bf16_f32 v90, v196, v197
    v_cvt_pk_bf16_f32 v94, v198, v199
    v_cvt_pk_bf16_f32 v91, v200, v201
    v_cvt_pk_bf16_f32 v95, v202, v203
    s_waitcnt lgkmcnt(0)
    v_mfma_f32_32x32x16_bf16 v[56:71], v[88:91], v[176:179], v[56:71]
    s_add_u32 m0, s21, 4096
    v_mfma_f32_32x32x16_bf16 v[16:31], v[92:95], v[176:179], v[16:31]
    buffer_load_dwordx4 v234, s[4:7], s36 offen  lds
    buffer_load_dwordx4 v235, s[8:11], s36 offen offset:1024  lds
    s_mov_b32 m0, s50
    s_nop 0
    s_movrels_b32 s71, s23
    s_movrels_b32 s33, s28
    v_add_u32 v253, s33, v248
    s_bfe_u32 s46, s71, 0x30012
    s_mov_b32 m0, s46
    s_and_b32 s66, s71, 0x3ffff
    s_movrels_b32 s68, s57
    s_movrels_b32 s69, s61
    s_sub_u32 s48, s66, s47
    s_mov_b32 s47, s66
    s_lshr_b32 s52, s71, 28
    s_lshl_b32 s67, s46, 9
    s_add_u32 s66, s66, s67
    s_sub_u32 s49, s66, s42
    s_mov_b32 s42, s66
    s_bfe_u32 s66, s68, 655360
    s_add_u32 s43, s42, s66
    s_bfe_u32 s39, s69, 655360
    s_bfe_u32 s66, s68, 655370
    s_add_u32 s44, s42, s66
    s_bfe_u32 s40, s69, 655370
    s_bfe_u32 s66, s68, 655380
    s_add_u32 s45, s42, s66
    s_bfe_u32 s41, s69, 655380
    v_add_u32 v252, s45, v247
    ds_read2_b32 v[240:241], v252 offset0:0 offset1:16
    v_mfma_f32_32x32x16_bf16 v[32:47], v[72:75], v[180:183], 0
    v_mul_f32 v196, v56, v96
    v_fmac_f32 v196, v57, v97
    v_fmac_f32 v196, v58, v98
    v_fmac_f32 v196, v59, v99
    v_fmac_f32 v196, v60, v100
    v_fmac_f32 v196, v61, v101
    v_mfma_f32_32x32x16_bf16 v[0:15], v[76:79], v[180:183], 0
    v_fmac_f32 v196, v62, v102
    v_fmac_f32 v196, v63, v103
    v_mul_f32 v198, v64, v128
    v_fmac_f32 v198, v65, v129
    v_fmac_f32 v198, v66, v130
    v_fmac_f32 v198, v67, v131
    v_mfma_f32_32x32x16_bf16 v[32:47], v[80:83], v[184:187], v[32:47]
    v_fmac_f32 v198, v68, v132
    v_fmac_f32 v198, v69, v133
    v_fmac_f32 v198, v70, v134
    v_fmac_f32 v198, v71, v135
    v_mul_f32 v200, v16, v128
    v_fmac_f32 v200, v17, v129
    v_mfma_f32_32x32x16_bf16 v[0:15], v[84:87], v[184:187], v[0:15]
    s_waitcnt vmcnt(6)
    ds_read_b64_tr_b16 v[176:177], v244 offset:6144
    ds_read_b64_tr_b16 v[178:179], v244 offset:7168
    ds_read_b64_tr_b16 v[180:181], v245 offset:6144
    ds_read_b64_tr_b16 v[182:183], v245 offset:7168
    v_permlane32_swap_b32 v196, v198
    v_fmac_f32 v200, v18, v130
    v_mfma_f32_32x32x16_bf16 v[32:47], v[88:91], v[188:191], v[32:47]
    v_fmac_f32 v200, v19, v131
    v_fmac_f32 v200, v20, v132
    v_fmac_f32 v200, v21, v133
    v_fmac_f32 v200, v22, v134
    v_fmac_f32 v200, v23, v135
    v_add_f32 v198, v196, v198
    v_mfma_f32_32x32x16_bf16 v[0:15], v[92:95], v[188:191], v[0:15]
    v_mul_f32_e64 v202, v24, -v128
    v_fma_f32 v202, v25, -v129, v202
    v_fma_f32 v202, v26, -v130, v202
    v_fma_f32 v202, v27, -v131, v202
    v_fma_f32 v202, v28, -v132, v202
    v_fma_f32 v202, v29, -v133, v202
    v_fma_f32 v202, v30, -v134, v202
    v_fma_f32 v202, v31, -v135, v202
    s_nop 1
    v_permlane32_swap_b32 v200, v202
    v_add_f32 v202, v200, v202
    s_waitcnt vmcnt(4) lgkmcnt(0)
    v_mfma_f32_32x32x16_bf16 v[56:71], v[72:75], v[176:179], 0
    v_mul_f32 v197, v32, v104
    v_fmac_f32 v197, v33, v105
    v_fmac_f32 v197, v34, v106
    v_fmac_f32 v197, v35, v107
    v_fmac_f32 v197, v36, v108
    v_fmac_f32 v197, v37, v109
    s_add_u32 m0, s21, 6144
    v_mfma_f32_32x32x16_bf16 v[16:31], v[76:79], v[176:179], 0
    buffer_load_dwordx4 v236, s[4:7], s36 offen  lds
    buffer_load_dwordx4 v237, s[8:11], s36 offen offset:1024  lds
    ds_read_b64_tr_b16 v[176:177], v244 offset:0
    ds_read_b64_tr_b16 v[178:179], v244 offset:1024
    ds_read_b64_tr_b16 v[184:185], v245 offset:0
    ds_read_b64_tr_b16 v[186:187], v245 offset:1024
    v_fmac_f32 v197, v38, v110
    v_fmac_f32 v197, v39, v111
    v_mul_f32 v199, v40, v136
    v_fmac_f32 v199, v41, v137
    v_fmac_f32 v199, v42, v138
    v_fmac_f32 v199, v43, v139
    v_fmac_f32 v199, v44, v140
    v_fmac_f32 v199, v45, v141
    v_fmac_f32 v199, v46, v142
    v_fmac_f32 v199, v47, v143
    v_mul_f32 v201, v0, v136
    v_fmac_f32 v201, v1, v137
    v_permlane32_swap_b32 v197, v199
    v_fmac_f32 v201, v2, v138
    v_fmac_f32 v201, v3, v139
    v_fmac_f32 v201, v4, v140
    v_fmac_f32 v201, v5, v141
    v_fmac_f32 v201, v6, v142
    s_waitcnt vmcnt(4) lgkmcnt(0)
    v_mfma_f32_32x32x16_bf16 v[56:71], v[80:83], v[176:179], v[56:71]
    v_fmac_f32 v201, v7, v143
    v_add_f32 v199, v197, v199
    v_mul_f32_e64 v203, v8, -v136
    v_fma_f32 v203, v9, -v137, v203
    v_fma_f32 v203, v10, -v138, v203
    v_fma_f32 v203, v11, -v139, v203
    s_add_u32 m0, s21, 0
    v_mfma_f32_32x32x16_bf16 v[16:31], v[84:87], v[176:179], v[16:31]
    buffer_load_dwordx4 v238, s[4:7], s36 offen  lds
    buffer_load_dwordx4 v239, s[8:11], s36 offen offset:1024  lds
    ds_read_b64_tr_b16 v[176:177], v244 offset:2048
    ds_read_b64_tr_b16 v[178:179], v244 offset:3072
    ds_read_b64_tr_b16 v[188:189], v245 offset:2048
    ds_read_b64_tr_b16 v[190:191], v245 offset:3072
    s_waitcnt lgkmcnt(0)
    v_mfma_f32_32x32x16_bf16 v[56:71], v[88:91], v[176:179], v[56:71]
    v_fma_f32 v203, v12, -v140, v203
    v_fma_f32 v203, v13, -v141, v203
    v_fma_f32 v203, v14, -v142, v203
    v_fma_f32 v203, v15, -v143, v203
    s_nop 1
    v_permlane32_swap_b32 v201, v203
    v_add_f32 v203, v201, v203
    s_add_u32 m0, s21, 2048
    v_mfma_f32_32x32x16_bf16 v[16:31], v[92:95], v[176:179], v[16:31]
    buffer_load_dwordx4 v234, s[4:7], s37 offen  lds
    buffer_load_dwordx4 v235, s[8:11], s37 offen offset:1024  lds
    v_add_u32 v252, s42, v247
    ds_read2_b32 v[234:235], v252 offset0:0 offset1:16
    v_cvt_pk_bf16_f32 v192, v198, v199
    v_cvt_pk_bf16_f32 v193, v202, v203
    v_mfma_f32_32x32x16_bf16 v[32:47], v[72:75], v[180:183], 0
    v_mul_f32 v196, v56, v144
    v_fmac_f32 v196, v57, v145
    v_fmac_f32 v196, v58, v146
    v_fmac_f32 v196, v59, v147
    v_fmac_f32 v196, v60, v148
    v_fmac_f32 v196, v61, v149
    v_mfma_f32_32x32x16_bf16 v[0:15], v[76:79], v[180:183], 0
    v_fmac_f32 v196, v62, v150
    v_fmac_f32 v196, v63, v151
    v_mul_f32_e64 v200, v16, -v160
    v_fma_f32 v200, v17, -v161, v200
    v_fma_f32 v200, v18, -v162, v200
    v_fma_f32 v200, v19, -v163, v200
    v_mfma_f32_32x32x16_bf16 v[32:47], v[80:83], v[184:187], v[32:47]
    v_fma_f32 v200, v20, -v164, v200
    v_fma_f32 v200, v21, -v165, v200
    v_fma_f32 v200, v22, -v166, v200
    v_fma_f32 v200, v23, -v167, v200
    v_mul_f32_e64 v202, v24, -v160
    v_fma_f32 v202, v25, -v161, v202
    v_mfma_f32_32x32x16_bf16 v[0:15], v[84:87], v[184:187], v[0:15]
    s_waitcnt vmcnt(6)
    ds_read_b64_tr_b16 v[176:177], v244 offset:4096
    ds_read_b64_tr_b16 v[178:179], v244 offset:5120
    ds_read_b64_tr_b16 v[180:181], v245 offset:4096
    ds_read_b64_tr_b16 v[182:183], v245 offset:5120
    v_fma_f32 v202, v26, -v162, v202
    v_fma_f32 v202, v27, -v163, v202
    v_mfma_f32_32x32x16_bf16 v[32:47], v[88:91], v[188:191], v[32:47]
    v_fma_f32 v202, v28, -v164, v202
    v_fma_f32 v202, v29, -v165, v202
    v_fma_f32 v202, v30, -v166, v202
    v_fma_f32 v202, v31, -v167, v202
    v_mfma_f32_32x32x16_bf16 v[0:15], v[92:95], v[188:191], v[0:15]
    s_waitcnt vmcnt(4) lgkmcnt(0)
    v_mfma_f32_32x32x16_bf16 v[16:31], v[72:75], v[176:179], 0
    s_nop 4
    v_mul_f32 v197, v32, v152
    v_fmac_f32 v197, v33, v153
    v_fmac_f32 v197, v34, v154
    v_fmac_f32 v197, v35, v155
    v_fmac_f32 v197, v36, v156
    v_fmac_f32 v197, v37, v157
    s_add_u32 m0, s21, 4096
    v_mfma_f32_32x32x16_bf16 v[48:63], v[76:79], v[176:179], 0
    buffer_load_dwordx4 v236, s[4:7], s37 offen  lds
    buffer_load_dwordx4 v237, s[8:11], s37 offen offset:1024  lds
    ds_read_b64_tr_b16 v[176:177], v244 offset:6144
    ds_read_b64_tr_b16 v[178:179], v244 offset:7168
    ds_read_b64_tr_b16 v[184:185], v245 offset:6144
    ds_read_b64_tr_b16 v[186:187], v245 offset:7168
    v_add_u32 v252, s43, v247
    ds_read2_b32 v[236:237], v252 offset0:0 offset1:16
    v_fmac_f32 v197, v38, v158
    v_fmac_f32 v197, v39, v159
    v_mul_f32_e64 v201, v0, -v168
    v_fma_f32 v201, v1, -v169, v201
    s_waitcnt vmcnt(4) lgkmcnt(1)
    v_mfma_f32_32x32x16_bf16 v[16:31], v[80:83], v[176:179], v[16:31]
    v_fma_f32 v201, v2, -v170, v201
    v_fma_f32 v201, v3, -v171, v201
    v_fma_f32 v201, v4, -v172, v201
    v_fma_f32 v201, v5, -v173, v201
    v_fma_f32 v201, v6, -v174, v201
    v_fma_f32 v201, v7, -v175, v201
    s_add_u32 m0, s21, 6144
    v_mfma_f32_32x32x16_bf16 v[48:63], v[84:87], v[176:179], v[48:63]
    buffer_load_dwordx4 v238, s[4:7], s37 offen  lds
    buffer_load_dwordx4 v239, s[8:11], s37 offen offset:1024  lds
    ds_read_b64_tr_b16 v[176:177], v244 offset:0
    ds_read_b64_tr_b16 v[178:179], v244 offset:1024
    ds_read_b64_tr_b16 v[188:189], v245 offset:0
    ds_read_b64_tr_b16 v[190:191], v245 offset:1024
    v_add_u32 v252, s44, v247
    ds_read2_b32 v[238:239], v252 offset0:0 offset1:16
    s_waitcnt lgkmcnt(1)
    v_mfma_f32_32x32x16_bf16 v[16:31], v[88:91], v[176:179], v[16:31]
    v_mul_f32_e64 v203, v8, -v168
    v_fma_f32 v203, v9, -v169, v203
    v_fma_f32 v203, v10, -v170, v203
    v_fma_f32 v203, v11, -v171, v203
    v_fma_f32 v203, v12, -v172, v203
    v_fma_f32 v203, v13, -v173, v203
    s_add_u32 m0, s21, 0
    v_mfma_f32_32x32x16_bf16 v[48:63], v[92:95], v[176:179], v[48:63]
    s_cbranch_vccnz WL_6_0
    v_mad_u32_u16 v234, v234, s3, v246 op_sel:[1,0,0,0]
    v_mad_u32_u16 v235, v235, s3, v246 op_sel:[1,0,0,0]
    buffer_load_dwordx4 v234, s[4:7], s38 offen  lds
    buffer_load_dwordx4 v235, s[8:11], s38 offen offset:1024  lds
WR_6_0:
    v_fma_f32 v203, v14, -v174, v203
    v_fma_f32 v203, v15, -v175, v203
    v_mfma_f32_32x32x16_bf16 v[0:15], v[72:75], v[180:183], 0
    v_fmac_f32 v200, v24, v160
    v_fmac_f32 v200, v25, v161
    v_fmac_f32 v200, v26, v162
    v_fmac_f32 v200, v27, v163
    v_fmac_f32 v200, v28, v164
    v_fmac_f32 v200, v29, v165
    v_fmac_f32 v200, v30, v166
    v_fmac_f32 v200, v31, v167
    v_mfma_f32_32x32x16_bf16 v[24:39], v[76:79], v[180:183], 0
    v_mul_f32 v254, v16, v144
    v_fmac_f32 v254, v17, v145
    v_fmac_f32 v254, v18, v146
    v_fmac_f32 v254, v19, v147
    v_fmac_f32 v254, v20, v148
    v_fmac_f32 v254, v21, v149
    v_mfma_f32_32x32x16_bf16 v[0:15], v[80:83], v[184:187], v[0:15]
    v_fmac_f32 v254, v22, v150
    v_fmac_f32 v254, v23, v151
    v_sub_f32_e64 v64, -v48, v64
    v_sub_f32_e64 v65, -v49, v65
    v_permlane32_swap_b32 v196, v254
    v_sub_f32_e64 v66, -v50, v66
    v_mfma_f32_32x32x16_bf16 v[24:39], v[84:87], v[184:187], v[24:39]
    s_waitcnt vmcnt(6)
    ds_read_b64_tr_b16 v[176:177], v244 offset:2048
    ds_read_b64_tr_b16 v[178:179], v244 offset:3072
    ds_read_b64_tr_b16 v[180:181], v245 offset:2048
    ds_read_b64_tr_b16 v[182:183], v245 offset:3072
    v_sub_f32_e64 v67, -v51, v67
    v_sub_f32_e64 v68, -v52, v68
    v_mfma_f32_32x32x16_bf16 v[24:39], v[92:95], v[188:191], v[24:39]
    v_sub_f32_e64 v69, -v53, v69
    v_sub_f32_e64 v70, -v54, v70
    v_sub_f32_e64 v71, -v55, v71
    v_add_f32 v254, v196, v254
    v_mfma_f32_32x32x16_bf16 v[0:15], v[88:91], v[188:191], v[0:15]
    s_waitcnt vmcnt(4) lgkmcnt(0)
    v_mfma_f32_32x32x16_bf16 v[56:71], v[76:79], v[176:179], v[56:71]
    s_nop 4
    v_sub_f32_e64 v40, -v24, v40
    v_sub_f32_e64 v41, -v25, v41
    v_sub_f32_e64 v42, -v26, v42
    v_sub_f32_e64 v43, -v27, v43
    v_sub_f32_e64 v44, -v28, v44
    v_sub_f32_e64 v45, -v29, v45
    v_sub_f32_e64 v46, -v30, v46
    v_sub_f32_e64 v47, -v31, v47
    s_add_u32 m0, s21, 2048
    v_mfma_f32_32x32x16_bf16 v[16:31], v[72:75], v[176:179], 0
    s_cbranch_vccnz WL_6_1
    v_mad_u32_u16 v236, v236, s3, v246 op_sel:[1,0,0,0]
    v_mad_u32_u16 v237, v237, s3, v246 op_sel:[1,0,0,0]
    buffer_load_dwordx4 v236, s[4:7], s39 offen  lds
    buffer_load_dwordx4 v237, s[8:11], s39 offen offset:1024  lds
WR_6_1:
    ds_read_b64_tr_b16 v[176:177], v244 offset:4096
    ds_read_b64_tr_b16 v[178:179], v244 offset:5120
    ds_read_b64_tr_b16 v[184:185], v245 offset:4096
    ds_read_b64_tr_b16 v[186:187], v245 offset:5120
    v_mul_f32 v255, v0, v152
    v_fmac_f32 v255, v1, v153
    v_fmac_f32 v255, v2, v154
    v_fmac_f32 v255, v3, v155
    v_fmac_f32 v255, v4, v156
    s_waitcnt vmcnt(4) lgkmcnt(0)
    v_mfma_f32_32x32x16_bf16 v[16:31], v[80:83], v[176:179], v[16:31]
    v_fmac_f32 v255, v5, v157
    v_fmac_f32 v255, v6, v158
    v_fmac_f32 v255, v7, v159
    v_fmac_f32 v201, v8, v168
    v_fmac_f32 v201, v9, v169
    v_permlane32_swap_b32 v197, v255
    s_add_u32 m0, s21, 4096
    v_mfma_f32_32x32x16_bf16 v[56:71], v[84:87], v[176:179], v[56:71]
    s_cbranch_vccnz WL_6_2
    v_mad_u32_u16 v238, v238, s3, v246 op_sel:[1,0,0,0]
    v_mad_u32_u16 v239, v239, s3, v246 op_sel:[1,0,0,0]
    buffer_load_dwordx4 v238, s[4:7], s40 offen  lds
    buffer_load_dwordx4 v239, s[8:11], s40 offen offset:1024  lds
WR_6_2:
    ds_read_b64_tr_b16 v[176:177], v244 offset:6144
    ds_read_b64_tr_b16 v[178:179], v244 offset:7168
    ds_read_b64_tr_b16 v[188:189], v245 offset:6144
    ds_read_b64_tr_b16 v[190:191], v245 offset:7168
    s_waitcnt lgkmcnt(0)
    v_mfma_f32_32x32x16_bf16 v[16:31], v[88:91], v[176:179], v[16:31]
    v_fmac_f32 v201, v10, v170
    v_fmac_f32 v201, v11, v171
    v_fmac_f32 v201, v12, v172
    v_fmac_f32 v201, v13, v173
    v_fmac_f32 v201, v14, v174
    v_fmac_f32 v201, v15, v175
    s_add_u32 m0, s21, 6144
    v_mfma_f32_32x32x16_bf16 v[56:71], v[92:95], v[176:179], v[56:71]
    s_cbranch_vccnz WL_6_3
    v_mad_u32_u16 v240, v240, s3, v246 op_sel:[1,0,0,0]
    v_mad_u32_u16 v241, v241, s3, v246 op_sel:[1,0,0,0]
    buffer_load_dwordx4 v240, s[4:7], s41 offen  lds
    buffer_load_dwordx4 v241, s[8:11], s41 offen offset:1024  lds
WR_6_3:
    v_add_f32 v255, v197, v255
    v_cvt_pk_bf16_f32 v194, v254, v255
    v_mfma_f32_32x32x16_bf16 v[0:15], v[72:75], v[180:183], 0
    v_mul_f32 v254, v16, v144
    v_fmac_f32 v254, v17, v145
    v_fmac_f32 v254, v18, v146
    v_fmac_f32 v254, v19, v147
    v_fmac_f32 v254, v20, v148
    v_fmac_f32 v254, v21, v149
    v_mfma_f32_32x32x16_bf16 v[32:47], v[76:79], v[180:183], v[32:47]
    v_fmac_f32 v254, v22, v150
    v_fmac_f32 v254, v23, v151
    v_fma_f32 v202, v24, -v160, v202
    v_fma_f32 v202, v25, -v161, v202
    v_permlane32_swap_b32 v254, v200
    v_fma_f32 v202, v26, -v162, v202
    v_mfma_f32_32x32x16_bf16 v[0:15], v[80:83], v[184:187], v[0:15]
    v_fma_f32 v202, v27, -v163, v202
    v_fma_f32 v202, v28, -v164, v202
    v_fma_f32 v202, v29, -v165, v202
    v_fma_f32 v202, v30, -v166, v202
    v_fma_f32 v202, v31, -v167, v202
    v_add_f32 v200, v254, v200
    v_mfma_f32_32x32x16_bf16 v[32:47], v[84:87], v[184:187], v[32:47]
    s_waitcnt vmcnt(6)
    ds_read_b64_tr_b16 v[176:177], v244 offset:0
    ds_read_b64_tr_b16 v[178:179], v244 offset:1024
    ds_read_b64_tr_b16 v[180:181], v245 offset:0
    ds_read_b64_tr_b16 v[182:183], v245 offset:1024
    v_mul_f32_e64 v198, v64, -v112
    v_permlane32_swap_b32 v202, v254
    v_mfma_f32_32x32x16_bf16 v[0:15], v[88:91], v[188:191], v[0:15]
    v_fma_f32 v198, v65, -v113, v198
    v_fma_f32 v198, v66, -v114, v198
    v_fma_f32 v198, v67, -v115, v198
    v_fma_f32 v198, v68, -v116, v198
    v_fma_f32 v198, v69, -v117, v198
    v_fma_f32 v198, v70, -v118, v198
    v_mfma_f32_32x32x16_bf16 v[32:47], v[92:95], v[188:191], v[32:47]
    v_add_u32 v249, s48, v249
    v_add_u32 v250, s49, v250
    ds_read_b32 v252, v251 offset:16
    ds_read_b64_tr_b16 v[72:73], v249 offset:0
    ds_read_b64_tr_b16 v[76:77], v249 offset:64
    ds_read_b64_tr_b16 v[74:75], v249 offset:256
    ds_read_b64_tr_b16 v[78:79], v249 offset:320
    s_mov_b64 exec, s[54:55]
    ds_read_u16_d16_hi v242, v250 offset:0
    s_mov_b64 exec, -1
    v_fma_f32 v198, v71, -v119, v198
    v_add_f32 v254, v202, v254
    v_mul_f32 v196, v56, v160
    v_fmac_f32 v196, v57, v161
    v_fmac_f32 v196, v58, v162
    v_fmac_f32 v196, v59, v163
    v_fmac_f32 v196, v60, v164
    v_fmac_f32 v196, v61, v165
    v_fmac_f32 v196, v62, v166
    v_fmac_f32 v196, v63, v167
    s_nop 1
    v_permlane32_swap_b32 v198, v196
    v_add_f32 v196, v198, v196
    s_cbranch_vccnz LEPI_0
    v_mul_f32 v255, v0, v152
    v_fmac_f32 v255, v1, v153
    v_fmac_f32 v255, v2, v154
    v_fmac_f32 v255, v3, v155
    v_fmac_f32 v255, v4, v156
    v_fmac_f32 v255, v5, v157
    v_fmac_f32 v255, v6, v158
    v_fmac_f32 v255, v7, v159
    v_fma_f32 v203, v8, -v168, v203
    v_fma_f32 v203, v9, -v169, v203
    v_permlane32_swap_b32 v255, v201
    v_fma_f32 v203, v10, -v170, v203
    v_fma_f32 v203, v11, -v171, v203
    v_fma_f32 v203, v12, -v172, v203
    v_fma_f32 v203, v13, -v173, v203
    v_fma_f32 v203, v14, -v174, v203
    v_fma_f32 v203, v15, -v175, v203
    v_add_f32 v201, v255, v201
    v_mul_f32_e64 v199, v40, -v120
    v_permlane32_swap_b32 v203, v255
    v_fma_f32 v199, v41, -v121, v199
    v_fma_f32 v199, v42, -v122, v199
    v_fma_f32 v199, v43, -v123, v199
    v_fma_f32 v199, v44, -v124, v199
    v_fma_f32 v199, v45, -v125, v199
    v_fma_f32 v199, v46, -v126, v199
    v_fma_f32 v199, v47, -v127, v199
    v_add_f32 v255, v203, v255
    v_mul_f32 v197, v32, v168
    v_fmac_f32 v197, v33, v169
    v_fmac_f32 v197, v34, v170
    v_fmac_f32 v197, v35, v171
    v_fmac_f32 v197, v36, v172
    v_fmac_f32 v197, v37, v173
    v_fmac_f32 v197, v38, v174
    v_fmac_f32 v197, v39, v175
    s_nop 1
    v_permlane32_swap_b32 v199, v197
    v_add_f32 v197, v199, v197
    v_cvt_pk_bf16_f32 v200, v200, v201
    v_cvt_pk_bf16_f32 v254, v254, v255
    v_cvt_pk_bf16_f32 v196, v196, v197
    ds_write2st64_b32 v253, v192, v193 offset0:0 offset1:1
    ds_write2st64_b32 v253, v194, v200 offset0:2 offset1:3
    ds_write_b32 v253, v196 offset:1024
    s_mov_b64 exec, 0xffffffff
    ds_write_b32 v253, v254 offset:1280
    s_mov_b64 exec, -1
    s_add_u32 s50, s50, 1
    s_cmp_ge_u32 s50, 4
    s_cbranch_scc1 LAST1
    s_waitcnt lgkmcnt(9)
    v_readfirstlane_b32 s66, v252
    s_add_u32 s53, s53, 1
    v_mov_b32 v252, s53
    s_cmp_le_u32 s53, s66
    ds_write2_b32 v251, v252, v252 offset0:0 offset1:8
    s_setprio 1
    s_cbranch_scc1 PRIO_14
    s_setprio 0
PRIO_14:
    s_cmp_eq_u32 s52, 4
    s_cbranch_scc1 ITEM_1_4
    s_cmp_eq_u32 s52, 5
    s_cbranch_scc1 ITEM_1_5
    s_cmp_eq_u32 s52, 3
    s_cbranch_scc1 ITEM_1_3
    s_cmp_eq_u32 s52, 6
    s_cbranch_scc1 ITEM_1_6
    s_cmp_eq_u32 s52, 8
    s_cbranch_scc1 ITEM_1_8
    s_branch ITEM_1_2
WL_6_0:
    s_add_u32 s66, s51, 0
    buffer_load_dwordx4 v[96:99], v246, s[16:19], s66 offen offset:2048 sc1
    buffer_load_dwordx4 v[100:103], v246, s[16:19], s66 offen offset:3072 sc1
    s_branch WR_6_0
WL_6_1:
    s_add_u32 s66, s51, 4096
    buffer_load_dwordx4 v[104:107], v246, s[16:19], s66 offen offset:2048 sc1
    buffer_load_dwordx4 v[108:111], v246, s[16:19], s66 offen offset:3072 sc1
    s_branch WR_6_1
WL_6_2:
    s_add_u32 s66, s51, 8192
    buffer_load_dwordx4 v[128:131], v246, s[16:19], s66 offen offset:2048 sc1
    buffer_load_dwordx4 v[132:135], v246, s[16:19], s66 offen offset:3072 sc1
    s_branch WR_6_2
WL_6_3:
    s_add_u32 s66, s51, 12288
    buffer_load_dwordx4 v[136:139], v246, s[16:19], s66 offen offset:2048 sc1
    buffer_load_dwordx4 v[140:143], v246, s[16:19], s66 offen offset:3072 sc1
    s_branch WR_6_3
.p2align 6
ITEM_1_8:
    s_mov_b64 exec, s[54:55]
    ds_read_u16_d16_hi v243, v250 offset:128
    s_mov_b64 exec, -1
    ds_read_b64_tr_b16 v[80:81], v249 offset:512
    ds_read_b64_tr_b16 v[84:85], v249 offset:576
    ds_read_b64_tr_b16 v[82:83], v249 offset:768
    ds_read_b64_tr_b16 v[86:87], v249 offset:832
    ds_read_b64_tr_b16 v[88:89], v249 offset:1024
    ds_read_b64_tr_b16 v[92:93], v249 offset:1088
    ds_read_b64_tr_b16 v[90:91], v249 offset:1280
    ds_read_b64_tr_b16 v[94:95], v249 offset:1344
    ds_read_b64_tr_b16 v[64:65], v249 offset:1536
    ds_read_b64_tr_b16 v[68:69], v249 offset:1600
    ds_read_b64_tr_b16 v[66:67], v249 offset:1792
    ds_read_b64_tr_b16 v[70:71], v249 offset:1856
    s_waitcnt lgkmcnt(13)
    v_mul_f32_dpp v196, v242, v72 row_newbcast:0 row_mask:0xf bank_mask:0xf
    v_mul_f32_dpp v197, v242, v73 row_newbcast:1 row_mask:0xf bank_mask:0xf
    v_mul_f32_dpp v198, v242, v72 row_newbcast:8 row_mask:0xf bank_mask:0xf
    v_mul_f32_dpp v199, v242, v73 row_newbcast:9 row_mask:0xf bank_mask:0xf
    v_mul_f32_dpp v200, v242, v76 row_newbcast:2 row_mask:0xf bank_mask:0xf
    v_mul_f32_dpp v201, v242, v77 row_newbcast:3 row_mask:0xf bank_mask:0xf
    v_mul_f32_dpp v202, v242, v76 row_newbcast:10 row_mask:0xf bank_mask:0xf
    v_mul_f32_dpp v203, v242, v77 row_newbcast:11 row_mask:0xf bank_mask:0xf
    v_cvt_pk_bf16_f32 v72, v196, v197
    v_cvt_pk_bf16_f32 v76, v198, v199
    v_cvt_pk_bf16_f32 v73, v200, v201
    v_cvt_pk_bf16_f32 v77, v202, v203
    v_mul_f32_dpp v196, v242, v74 row_newbcast:4 row_mask:0xf bank_mask:0xf
    v_mul_f32_dpp v197, v242, v75 row_newbcast:5 row_mask:0xf bank_mask:0xf
    v_mul_f32_dpp v198, v242, v74 row_newbcast:12 row_mask:0xf bank_mask:0xf
    v_mul_f32_dpp v199, v242, v75 row_newbcast:13 row_mask:0xf bank_mask:0xf
    v_mul_f32_dpp v200, v242, v78 row_newbcast:6 row_mask:0xf bank_mask:0xf
    v_mul_f32_dpp v201, v242, v79 row_newbcast:7 row_mask:0xf bank_mask:0xf
    v_mul_f32_dpp v202, v242, v78 row_newbcast:14 row_mask:0xf bank_mask:0xf
    v_mul_f32_dpp v203, v242, v79 row_newbcast:15 row_mask:0xf bank_mask:0xf
    v_cvt_pk_bf16_f32 v74, v196, v197
    v_cvt_pk_bf16_f32 v78, v198, v199
    v_cvt_pk_bf16_f32 v75, v200, v201
    v_cvt_pk_bf16_f32 v79, v202, v203
    s_mov_b64 exec, s[54:55]
    ds_read_u16_d16_hi v242, v250 offset:256
    s_mov_b64 exec, -1
    s_waitcnt vmcnt(4) lgkmcnt(9)
    v_mfma_f32_32x32x16_bf16 v[0:15], v[72:75], v[176:179], 0
    v_mul_f32_dpp v196, v243, v80 row_newbcast:0 row_mask:0xf bank_mask:0xf
    v_mul_f32_dpp v197, v243, v81 row_newbcast:1 row_mask:0xf bank_mask:0xf
    v_mul_f32_dpp v198, v243, v80 row_newbcast:8 row_mask:0xf bank_mask:0xf
    v_mul_f32_dpp v199, v243, v81 row_newbcast:9 row_mask:0xf bank_mask:0xf
    v_mul_f32_dpp v200, v243, v84 row_newbcast:2 row_mask:0xf bank_mask:0xf
    v_mul_f32_dpp v201, v243, v85 row_newbcast:3 row_mask:0xf bank_mask:0xf
    s_add_u32 m0, s21, 0
    v_mfma_f32_32x32x16_bf16 v[48:63], v[76:79], v[176:179], 0
    buffer_load_dwordx4 v234, s[4:7], s35 offen  lds
    buffer_load_dwordx4 v235, s[8:11], s35 offen offset:1024  lds
    ds_read_b64_tr_b16 v[176:177], v244 offset:2048
    ds_read_b64_tr_b16 v[178:179], v244 offset:3072
    ds_read_b64_tr_b16 v[184:185], v245 offset:2048
    ds_read_b64_tr_b16 v[186:187], v245 offset:3072
    v_mul_f32_dpp v202, v243, v84 row_newbcast:10 row_mask:0xf bank_mask:0xf
    v_mul_f32_dpp v203, v243, v85 row_newbcast:11 row_mask:0xf bank_mask:0xf
    v_cvt_pk_bf16_f32 v80, v196, v197
    v_cvt_pk_bf16_f32 v84, v198, v199
    v_cvt_pk_bf16_f32 v81, v200, v201
    v_cvt_pk_bf16_f32 v85, v202, v203
    v_mul_f32_dpp v196, v243, v82 row_newbcast:4 row_mask:0xf bank_mask:0xf
    v_mul_f32_dpp v197, v243, v83 row_newbcast:5 row_mask:0xf bank_mask:0xf
    v_mul_f32_dpp v198, v243, v82 row_newbcast:12 row_mask:0xf bank_mask:0xf
    v_mul_f32_dpp v199, v243, v83 row_newbcast:13 row_mask:0xf bank_mask:0xf
    v_mul_f32_dpp v200, v243, v86 row_newbcast:6 row_mask:0xf bank_mask:0xf
    v_mul_f32_dpp v201, v243, v87 row_newbcast:7 row_mask:0xf bank_mask:0xf
    v_mul_f32_dpp v202, v243, v86 row_newbcast:14 row_mask:0xf bank_mask:0xf
    v_mul_f32_dpp v203, v243, v87 row_newbcast:15 row_mask:0xf bank_mask:0xf
    v_cvt_pk_bf16_f32 v82, v196, v197
    v_cvt_pk_bf16_f32 v86, v198, v199
    v_cvt_pk_bf16_f32 v83, v200, v201
    v_cvt_pk_bf16_f32 v87, v202, v203
    s_mov_b64 exec, s[54:55]
    ds_read_u16_d16_hi v243, v250 offset:384
    s_mov_b64 exec, -1
    s_waitcnt vmcnt(4) lgkmcnt(1)
    v_mfma_f32_32x32x16_bf16 v[0:15], v[80:83], v[176:179], v[0:15]
    v_mul_f32_dpp v196, v242, v88 row_newbcast:0 row_mask:0xf bank_mask:0xf
    v_mul_f32_dpp v197, v242, v89 row_newbcast:1 row_mask:0xf bank_mask:0xf
    v_mul_f32_dpp v198, v242, v88 row_newbcast:8 row_mask:0xf bank_mask:0xf
    v_mul_f32_dpp v199, v242, v89 row_newbcast:9 row_mask:0xf bank_mask:0xf
    v_mul_f32_dpp v200, v242, v92 row_newbcast:2 row_mask:0xf bank_mask:0xf
    v_mul_f32_dpp v201, v242, v93 row_newbcast:3 row_mask:0xf bank_mask:0xf
    s_add_u32 m0, s21, 2048
    v_mfma_f32_32x32x16_bf16 v[48:63], v[84:87], v[176:179], v[48:63]
    buffer_load_dwordx4 v236, s[4:7], s35 offen  lds
    buffer_load_dwordx4 v237, s[8:11], s35 offen offset:1024  lds
    ds_read_b64_tr_b16 v[176:177], v244 offset:4096
    ds_read_b64_tr_b16 v[178:179], v244 offset:5120
    ds_read_b64_tr_b16 v[188:189], v245 offset:4096
    ds_read_b64_tr_b16 v[190:191], v245 offset:5120
    v_mul_f32_dpp v202, v242, v92 row_newbcast:10 row_mask:0xf bank_mask:0xf
    v_mul_f32_dpp v203, v242, v93 row_newbcast:11 row_mask:0xf bank_mask:0xf
    v_cvt_pk_bf16_f32 v88, v196, v197
    v_cvt_pk_bf16_f32 v92, v198, v199
    v_cvt_pk_bf16_f32 v89, v200, v201
    v_cvt_pk_bf16_f32 v93, v202, v203
    v_mul_f32_dpp v196, v242, v90 row_newbcast:4 row_mask:0xf bank_mask:0xf
    v_mul_f32_dpp v197, v242, v91 row_newbcast:5 row_mask:0xf bank_mask:0xf
    v_mul_f32_dpp v198, v242, v90 row_newbcast:12 row_mask:0xf bank_mask:0xf
    v_mul_f32_dpp v199, v242, v91 row_newbcast:13 row_mask:0xf bank_mask:0xf
    v_mul_f32_dpp v200, v242, v94 row_newbcast:6 row_mask:0xf bank_mask:0xf
    v_mul_f32_dpp v201, v242, v95 row_newbcast:7 row_mask:0xf bank_mask:0xf
    v_mul_f32_dpp v202, v242, v94 row_newbcast:14 row_mask:0xf bank_mask:0xf
    v_mul_f32_dpp v203, v242, v95 row_newbcast:15 row_mask:0xf bank_mask:0xf
    v_cvt_pk_bf16_f32 v90, v196, v197
    v_cvt_pk_bf16_f32 v94, v198, v199
    v_cvt_pk_bf16_f32 v91, v200, v201
    v_cvt_pk_bf16_f32 v95, v202, v203
    s_waitcnt vmcnt(4) lgkmcnt(0)
    v_mfma_f32_32x32x16_bf16 v[0:15], v[88:91], v[176:179], v[0:15]
    v_mul_f32_dpp v196, v243, v64 row_newbcast:0 row_mask:0xf bank_mask:0xf
    v_mul_f32_dpp v197, v243, v65 row_newbcast:1 row_mask:0xf bank_mask:0xf
    v_mul_f32_dpp v198, v243, v64 row_newbcast:8 row_mask:0xf bank_mask:0xf
    v_mul_f32_dpp v199, v243, v65 row_newbcast:9 row_mask:0xf bank_mask:0xf
    v_mul_f32_dpp v200, v243, v68 row_newbcast:2 row_mask:0xf bank_mask:0xf
    v_mul_f32_dpp v201, v243, v69 row_newbcast:3 row_mask:0xf bank_mask:0xf
    s_add_u32 m0, s21, 4096
    v_mfma_f32_32x32x16_bf16 v[48:63], v[92:95], v[176:179], v[48:63]
    buffer_load_dwordx4 v238, s[4:7], s35 offen  lds
    buffer_load_dwordx4 v239, s[8:11], s35 offen offset:1024  lds
    ds_read_b64_tr_b16 v[176:177], v244 offset:6144
    ds_read_b64_tr_b16 v[178:179], v244 offset:7168
    ds_read_b64_tr_b16 v[192:193], v245 offset:6144
    ds_read_b64_tr_b16 v[194:195], v245 offset:7168
    v_mul_f32_dpp v202, v243, v68 row_newbcast:10 row_mask:0xf bank_mask:0xf
    v_mul_f32_dpp v203, v243, v69 row_newbcast:11 row_mask:0xf bank_mask:0xf
    v_cvt_pk_bf16_f32 v64, v196, v197
    v_cvt_pk_bf16_f32 v68, v198, v199
    v_cvt_pk_bf16_f32 v65, v200, v201
    v_cvt_pk_bf16_f32 v69, v202, v203
    v_mul_f32_dpp v196, v243, v66 row_newbcast:4 row_mask:0xf bank_mask:0xf
    v_mul_f32_dpp v197, v243, v67 row_newbcast:5 row_mask:0xf bank_mask:0xf
    v_mul_f32_dpp v198, v243, v66 row_newbcast:12 row_mask:0xf bank_mask:0xf
    v_mul_f32_dpp v199, v243, v67 row_newbcast:13 row_mask:0xf bank_mask:0xf
    v_mul_f32_dpp v200, v243, v70 row_newbcast:6 row_mask:0xf bank_mask:0xf
    v_mul_f32_dpp v201, v243, v71 row_newbcast:7 row_mask:0xf bank_mask:0xf
    v_mul_f32_dpp v202, v243, v70 row_newbcast:14 row_mask:0xf bank_mask:0xf
    v_mul_f32_dpp v203, v243, v71 row_newbcast:15 row_mask:0xf bank_mask:0xf
    v_cvt_pk_bf16_f32 v66, v196, v197
    v_cvt_pk_bf16_f32 v70, v198, v199
    v_cvt_pk_bf16_f32 v67, v200, v201
    v_cvt_pk_bf16_f32 v71, v202, v203
    s_waitcnt lgkmcnt(0)
    v_mfma_f32_32x32x16_bf16 v[0:15], v[64:67], v[176:179], v[0:15]
    s_add_u32 m0, s21, 6144
    v_mfma_f32_32x32x16_bf16 v[48:63], v[68:71], v[176:179], v[48:63]
    buffer_load_dwordx4 v240, s[4:7], s35 offen  lds
    buffer_load_dwordx4 v241, s[8:11], s35 offen offset:1024  lds
    s_mov_b32 m0, s50
    s_nop 0
    s_movrels_b32 s71, s23
    s_movrels_b32 s33, s28
    v_add_u32 v253, s33, v248
    s_bfe_u32 s46, s71, 0x30012
    s_mov_b32 m0, s46
    s_and_b32 s66, s71, 0x3ffff
    s_movrels_b32 s68, s57
    s_movrels_b32 s69, s61
    s_sub_u32 s48, s66, s47
    s_mov_b32 s47, s66
    s_lshr_b32 s52, s71, 28
    s_lshl_b32 s67, s46, 9
    s_add_u32 s66, s66, s67
    s_sub_u32 s49, s66, s42
    s_mov_b32 s42, s66
    s_bfe_u32 s66, s68, 655360
    s_add_u32 s43, s42, s66
    s_bfe_u32 s39, s69, 655360
    s_bfe_u32 s66, s68, 655370
    s_add_u32 s44, s42, s66
    s_bfe_u32 s40, s69, 655370
    s_bfe_u32 s66, s68, 655380
    s_add_u32 s45, s42, s66
    s_bfe_u32 s41, s69, 655380
    v_mfma_f32_32x32x16_bf16 v[16:31], v[72:75], v[180:183], 0
    v_mul_f32 v196, v0, v96
    v_fmac_f32 v196, v1, v97
    v_fmac_f32 v196, v2, v98
    v_fmac_f32 v196, v3, v99
    v_fmac_f32 v196, v4, v100
    v_fmac_f32 v196, v5, v101
    v_mfma_f32_32x32x16_bf16 v[32:47], v[76:79], v[180:183], 0
    v_fmac_f32 v196, v6, v102
    v_fmac_f32 v196, v7, v103
    v_mul_f32 v198, v8, v128
    v_fmac_f32 v198, v9, v129
    v_fmac_f32 v198, v10, v130
    v_fmac_f32 v198, v11, v131
    v_mfma_f32_32x32x16_bf16 v[16:31], v[80:83], v[184:187], v[16:31]
    v_fmac_f32 v198, v12, v132
    v_fmac_f32 v198, v13, v133
    v_fmac_f32 v198, v14, v134
    v_fmac_f32 v198, v15, v135
    v_mul_f32 v200, v48, v128
    v_fmac_f32 v200, v49, v129
    v_mfma_f32_32x32x16_bf16 v[32:47], v[84:87], v[184:187], v[32:47]
    v_permlane32_swap_b32 v196, v198
    v_fmac_f32 v200, v50, v130
    v_fmac_f32 v200, v51, v131
    v_fmac_f32 v200, v52, v132
    v_fmac_f32 v200, v53, v133
    v_fmac_f32 v200, v54, v134
    v_mfma_f32_32x32x16_bf16 v[16:31], v[88:91], v[188:191], v[16:31]
    v_fmac_f32 v200, v55, v135
    v_add_f32 v198, v196, v198
    v_mul_f32_e64 v202, v56, -v128
    v_fma_f32 v202, v57, -v129, v202
    v_fma_f32 v202, v58, -v130, v202
    v_fma_f32 v202, v59, -v131, v202
    v_mfma_f32_32x32x16_bf16 v[32:47], v[92:95], v[188:191], v[32:47]
    s_waitcnt vmcnt(6)
    ds_read_b64_tr_b16 v[176:177], v244 offset:0
    ds_read_b64_tr_b16 v[178:179], v244 offset:1024
    ds_read_b64_tr_b16 v[180:181], v245 offset:0
    ds_read_b64_tr_b16 v[182:183], v245 offset:1024
    v_fma_f32 v202, v60, -v132, v202
    v_fma_f32 v202, v61, -v133, v202
    v_mfma_f32_32x32x16_bf16 v[16:31], v[64:67], v[192:195], v[16:31]
    v_fma_f32 v202, v62, -v134, v202
    v_fma_f32 v202, v63, -v135, v202
    s_nop 1
    v_permlane32_swap_b32 v200, v202
    v_add_f32 v202, v200, v202
    v_mfma_f32_32x32x16_bf16 v[32:47], v[68:71], v[192:195], v[32:47]
    s_waitcnt vmcnt(4) lgkmcnt(0)
    v_mfma_f32_32x32x16_bf16 v[0:15], v[72:75], v[176:179], 0
    s_nop 2
    v_mul_f32 v197, v16, v104
    v_fmac_f32 v197, v17, v105
    v_fmac_f32 v197, v18, v106
    v_fmac_f32 v197, v19, v107
    v_fmac_f32 v197, v20, v108
    v_fmac_f32 v197, v21, v109
    s_add_u32 m0, s21, 0
    v_mfma_f32_32x32x16_bf16 v[48:63], v[76:79], v[176:179], 0
    buffer_load_dwordx4 v234, s[4:7], s36 offen  lds
    buffer_load_dwordx4 v235, s[8:11], s36 offen offset:1024  lds
    ds_read_b64_tr_b16 v[176:177], v244 offset:2048
    ds_read_b64_tr_b16 v[178:179], v244 offset:3072
    ds_read_b64_tr_b16 v[184:185], v245 offset:2048
    ds_read_b64_tr_b16 v[186:187], v245 offset:3072
    v_fmac_f32 v197, v22, v110
    v_fmac_f32 v197, v23, v111
    v_mul_f32 v199, v24, v136
    v_fmac_f32 v199, v25, v137
    v_fmac_f32 v199, v26, v138
    v_fmac_f32 v199, v27, v139
    v_fmac_f32 v199, v28, v140
    v_fmac_f32 v199, v29, v141
    v_fmac_f32 v199, v30, v142
    v_fmac_f32 v199, v31, v143
    v_mul_f32 v201, v32, v136
    s_waitcnt vmcnt(4) lgkmcnt(0)
    v_mfma_f32_32x32x16_bf16 v[0:15], v[80:83], v[176:179], v[0:15]
    v_fmac_f32 v201, v33, v137
    v_permlane32_swap_b32 v197, v199
    v_fmac_f32 v201, v34, v138
    v_fmac_f32 v201, v35, v139
    v_fmac_f32 v201, v36, v140
    v_fmac_f32 v201, v37, v141
    s_add_u32 m0, s21, 2048
    v_mfma_f32_32x32x16_bf16 v[48:63], v[84:87], v[176:179], v[48:63]
    buffer_load_dwordx4 v236, s[4:7], s36 offen  lds
    buffer_load_dwordx4 v237, s[8:11], s36 offen offset:1024  lds
    ds_read_b64_tr_b16 v[176:177], v244 offset:4096
    ds_read_b64_tr_b16 v[178:179], v244 offset:5120
    ds_read_b64_tr_b16 v[188:189], v245 offset:4096
    ds_read_b64_tr_b16 v[190:191], v245 offset:5120
    s_waitcnt vmcnt(4) lgkmcnt(0)
    v_mfma_f32_32x32x16_bf16 v[0:15], v[88:91], v[176:179], v[0:15]
    v_fmac_f32 v201, v38, v142
    v_fmac_f32 v201, v39, v143
    v_add_f32 v199, v197, v199
    v_mul_f32_e64 v203, v40, -v136
    v_fma_f32 v203, v41, -v137, v203
    v_fma_f32 v203, v42, -v138, v203
    s_add_u32 m0, s21, 4096
    v_mfma_f32_32x32x16_bf16 v[48:63], v[92:95], v[176:179], v[48:63]
    buffer_load_dwordx4 v238, s[4:7], s36 offen  lds
    buffer_load_dwordx4 v239, s[8:11], s36 offen offset:1024  lds
    ds_read_b64_tr_b16 v[176:177], v244 offset:6144
    ds_read_b64_tr_b16 v[178:179], v244 offset:7168
    ds_read_b64_tr_b16 v[192:193], v245 offset:6144
    ds_read_b64_tr_b16 v[194:195], v245 offset:7168
    s_waitcnt lgkmcnt(0)
    v_mfma_f32_32x32x16_bf16 v[0:15], v[64:67], v[176:179], v[0:15]
    v_fma_f32 v203, v43, -v139, v203
    v_fma_f32 v203, v44, -v140, v203
    v_fma_f32 v203, v45, -v141, v203
    v_fma_f32 v203, v46, -v142, v203
    v_fma_f32 v203, v47, -v143, v203
    s_nop 1
    v_permlane32_swap_b32 v201, v203
    s_add_u32 m0, s21, 6144
    v_mfma_f32_32x32x16_bf16 v[48:63], v[68:71], v[176:179], v[48:63]
    buffer_load_dwordx4 v240, s[4:7], s36 offen  lds
    buffer_load_dwordx4 v241, s[8:11], s36 offen offset:1024  lds
    v_add_f32 v203, v201, v203
    v_cvt_pk_bf16_f32 v198, v198, v199
    v_cvt_pk_bf16_f32 v202, v202, v203
    ds_write2st64_b32 v253, v198, v202 offset0:0 offset1:1
    v_mfma_f32_32x32x16_bf16 v[16:31], v[72:75], v[180:183], 0
    v_mul_f32 v196, v0, v144
    v_fmac_f32 v196, v1, v145
    v_fmac_f32 v196, v2, v146
    v_fmac_f32 v196, v3, v147
    v_fmac_f32 v196, v4, v148
    v_fmac_f32 v196, v5, v149
    v_mfma_f32_32x32x16_bf16 v[32:47], v[76:79], v[180:183], 0
    v_fmac_f32 v196, v6, v150
    v_fmac_f32 v196, v7, v151
    v_mul_f32 v198, v8, v112
    v_fmac_f32 v198, v9, v113
    v_fmac_f32 v198, v10, v114
    v_fmac_f32 v198, v11, v115
    v_mfma_f32_32x32x16_bf16 v[16:31], v[80:83], v[184:187], v[16:31]
    v_fmac_f32 v198, v12, v116
    v_fmac_f32 v198, v13, v117
    v_fmac_f32 v198, v14, v118
    v_fmac_f32 v198, v15, v119
    v_mul_f32_e64 v200, v48, -v160
    v_fma_f32 v200, v49, -v161, v200
    v_mfma_f32_32x32x16_bf16 v[32:47], v[84:87], v[184:187], v[32:47]
    v_fma_f32 v200, v50, -v162, v200
    v_fma_f32 v200, v51, -v163, v200
    v_fma_f32 v200, v52, -v164, v200
    v_fma_f32 v200, v53, -v165, v200
    v_fma_f32 v200, v54, -v166, v200
    v_fma_f32 v200, v55, -v167, v200
    v_mfma_f32_32x32x16_bf16 v[16:31], v[88:91], v[188:191], v[16:31]
    v_mul_f32_e64 v202, v56, -v160
    v_fma_f32 v202, v57, -v161, v202
    v_fma_f32 v202, v58, -v162, v202
    v_fma_f32 v202, v59, -v163, v202
    v_fma_f32 v202, v60, -v164, v202
    v_fma_f32 v202, v61, -v165, v202
    v_mfma_f32_32x32x16_bf16 v[32:47], v[92:95], v[188:191], v[32:47]
    s_waitcnt vmcnt(6)
    ds_read_b64_tr_b16 v[176:177], v244 offset:0
    ds_read_b64_tr_b16 v[178:179], v244 offset:1024
    ds_read_b64_tr_b16 v[180:181], v245 offset:0
    ds_read_b64_tr_b16 v[182:183], v245 offset:1024
    v_fma_f32 v202, v62, -v166, v202
    v_fma_f32 v202, v63, -v167, v202
    v_mfma_f32_32x32x16_bf16 v[16:31], v[64:67], v[192:195], v[16:31]
    v_mfma_f32_32x32x16_bf16 v[32:47], v[68:71], v[192:195], v[32:47]
    s_waitcnt vmcnt(4) lgkmcnt(0)
    v_mfma_f32_32x32x16_bf16 v[0:15], v[72:75], v[176:179], 0
    s_nop 8
    v_mul_f32 v197, v16, v152
    v_fmac_f32 v197, v17, v153
    v_fmac_f32 v197, v18, v154
    v_fmac_f32 v197, v19, v155
    v_fmac_f32 v197, v20, v156
    v_fmac_f32 v197, v21, v157
    s_add_u32 m0, s21, 0
    v_mfma_f32_32x32x16_bf16 v[48:63], v[76:79], v[176:179], 0
    buffer_load_dwordx4 v234, s[4:7], s37 offen  lds
    buffer_load_dwordx4 v235, s[8:11], s37 offen offset:1024  lds
    ds_read_b64_tr_b16 v[176:177], v244 offset:2048
    ds_read_b64_tr_b16 v[178:179], v244 offset:3072
    ds_read_b64_tr_b16 v[184:185], v245 offset:2048
    ds_read_b64_tr_b16 v[186:187], v245 offset:3072
    v_add_u32 v252, s42, v247
    ds_read2_b32 v[234:235], v252 offset0:0 offset1:16
    v_fmac_f32 v197, v22, v158
    v_fmac_f32 v197, v23, v159
    v_mul_f32 v199, v24, v120
    v_fmac_f32 v199, v25, v121
    v_fmac_f32 v199, v26, v122
    v_fmac_f32 v199, v27, v123
    s_waitcnt vmcnt(4) lgkmcnt(1)
    v_mfma_f32_32x32x16_bf16 v[0:15], v[80:83], v[176:179], v[0:15]
    v_fmac_f32 v199, v28, v124
    v_fmac_f32 v199, v29, v125
    v_fmac_f32 v199, v30, v126
    v_fmac_f32 v199, v31, v127
    v_mul_f32_e64 v201, v32, -v168
    v_fma_f32 v201, v33, -v169, v201
    s_add_u32 m0, s21, 2048
    v_mfma_f32_32x32x16_bf16 v[48:63], v[84:87], v[176:179], v[48:63]
    buffer_load_dwordx4 v236, s[4:7], s37 offen  lds
    buffer_load_dwordx4 v237, s[8:11], s37 offen offset:1024  lds
    ds_read_b64_tr_b16 v[176:177], v244 offset:4096
    ds_read_b64_tr_b16 v[178:179], v244 offset:5120
    ds_read_b64_tr_b16 v[188:189], v245 offset:4096
    ds_read_b64_tr_b16 v[190:191], v245 offset:5120
    v_add_u32 v252, s43, v247
    ds_read2_b32 v[236:237], v252 offset0:0 offset1:16
    s_waitcnt vmcnt(4) lgkmcnt(1)
    v_mfma_f32_32x32x16_bf16 v[0:15], v[88:91], v[176:179], v[0:15]
    v_fma_f32 v201, v34, -v170, v201
    v_fma_f32 v201, v35, -v171, v201
    v_fma_f32 v201, v36, -v172, v201
    v_fma_f32 v201, v37, -v173, v201
    v_fma_f32 v201, v38, -v174, v201
    v_fma_f32 v201, v39, -v175, v201
    s_add_u32 m0, s21, 4096
    v_mfma_f32_32x32x16_bf16 v[48:63], v[92:95], v[176:179], v[48:63]
    buffer_load_dwordx4 v238, s[4:7], s37 offen  lds
    buffer_load_dwordx4 v239, s[8:11], s37 offen offset:1024  lds
    ds_read_b64_tr_b16 v[176:177], v244 offset:6144
    ds_read_b64_tr_b16 v[178:179], v244 offset:7168
    ds_read_b64_tr_b16 v[192:193], v245 offset:6144
    ds_read_b64_tr_b16 v[194:195], v245 offset:7168
    v_add_u32 v252, s44, v247
    ds_read2_b32 v[238:239], v252 offset0:0 offset1:16
    s_waitcnt lgkmcnt(1)
    v_mfma_f32_32x32x16_bf16 v[0:15], v[64:67], v[176:179], v[0:15]
    v_mul_f32_e64 v203, v40, -v168
    v_fma_f32 v203, v41, -v169, v203
    v_fma_f32 v203, v42, -v170, v203
    v_fma_f32 v203, v43, -v171, v203
    v_fma_f32 v203, v44, -v172, v203
    v_fma_f32 v203, v45, -v173, v203
    s_add_u32 m0, s21, 6144
    v_mfma_f32_32x32x16_bf16 v[48:63], v[68:71], v[176:179], v[48:63]
    buffer_load_dwordx4 v240, s[4:7], s37 offen  lds
    buffer_load_dwordx4 v241, s[8:11], s37 offen offset:1024  lds
    v_add_u32 v252, s45, v247
    ds_read2_b32 v[240:241], v252 offset0:0 offset1:16
    v_fma_f32 v203, v46, -v174, v203
    v_fma_f32 v203, v47, -v175, v203
    v_mfma_f32_32x32x16_bf16 v[16:31], v[72:75], v[180:183], 0
    v_mul_f32 v254, v0, v144
    v_fmac_f32 v254, v1, v145
    v_fmac_f32 v254, v2, v146
    v_fmac_f32 v254, v3, v147
    v_fmac_f32 v254, v4, v148
    v_fmac_f32 v254, v5, v149
    v_mfma_f32_32x32x16_bf16 v[32:47], v[76:79], v[180:183], 0
    ds_swizzle_b32 v76, v76 offset:0x401F
    ds_swizzle_b32 v77, v77 offset:0x401F
    ds_swizzle_b32 v78, v78 offset:0x401F
    ds_swizzle_b32 v79, v79 offset:0x401F
    v_fmac_f32 v254, v6, v150
    v_fmac_f32 v254, v7, v151
    v_mfma_f32_32x32x16_bf16 v[16:31], v[80:83], v[184:187], v[16:31]
    v_fmac_f32 v200, v8, v160
    v_fmac_f32 v200, v9, v161
    v_permlane32_swap_b32 v196, v254
    v_fmac_f32 v200, v10, v162
    v_fmac_f32 v200, v11, v163
    v_fmac_f32 v200, v12, v164
    v_mfma_f32_32x32x16_bf16 v[32:47], v[84:87], v[184:187], v[32:47]
    ds_swizzle_b32 v84, v84 offset:0x401F
    ds_swizzle_b32 v85, v85 offset:0x401F
    ds_swizzle_b32 v86, v86 offset:0x401F
    ds_swizzle_b32 v87, v87 offset:0x401F
    v_fmac_f32 v200, v13, v165
    v_fmac_f32 v200, v14, v166
    v_mfma_f32_32x32x16_bf16 v[16:31], v[88:91], v[188:191], v[16:31]
    v_fmac_f32 v200, v15, v167
    v_add_f32 v254, v196, v254
    v_mfma_f32_32x32x16_bf16 v[32:47], v[92:95], v[188:191], v[32:47]
    ds_swizzle_b32 v92, v92 offset:0x401F
    ds_swizzle_b32 v93, v93 offset:0x401F
    ds_swizzle_b32 v94, v94 offset:0x401F
    ds_swizzle_b32 v95, v95 offset:0x401F
    s_waitcnt vmcnt(6)
    ds_read_b64_tr_b16 v[176:177], v244 offset:0
    ds_read_b64_tr_b16 v[178:179], v244 offset:1024
    ds_read_b64_tr_b16 v[180:181], v245 offset:0
    ds_read_b64_tr_b16 v[182:183], v245 offset:1024
    v_mfma_f32_32x32x16_bf16 v[16:31], v[64:67], v[192:195], v[16:31]
    v_mfma_f32_32x32x16_bf16 v[32:47], v[68:71], v[192:195], v[32:47]
    ds_swizzle_b32 v68, v68 offset:0x401F
    ds_swizzle_b32 v69, v69 offset:0x401F
    ds_swizzle_b32 v70, v70 offset:0x401F
    ds_swizzle_b32 v71, v71 offset:0x401F
    s_waitcnt lgkmcnt(8)
    s_mov_b64 exec, s[56:57]
    v_xor_b32 v76, 0x80008000, v76
    v_xor_b32 v77, 0x80008000, v77
    v_xor_b32 v78, 0x80008000, v78
    v_xor_b32 v79, 0x80008000, v79
    v_xor_b32 v84, 0x80008000, v84
    v_xor_b32 v85, 0x80008000, v85
    v_xor_b32 v86, 0x80008000, v86
    v_xor_b32 v87, 0x80008000, v87
    v_xor_b32 v92, 0x80008000, v92
    v_xor_b32 v93, 0x80008000, v93
    v_xor_b32 v94, 0x80008000, v94
    v_xor_b32 v95, 0x80008000, v95
    s_mov_b64 exec, -1
    s_waitcnt vmcnt(4) lgkmcnt(4)
    v_mfma_f32_32x32x16_bf16 v[0:15], v[72:75], v[176:179], 0
    v_mul_f32 v255, v16, v152
    v_fmac_f32 v255, v17, v153
    v_fmac_f32 v255, v18, v154
    v_fmac_f32 v255, v19, v155
    v_fmac_f32 v255, v20, v156
    v_fmac_f32 v255, v21, v157
    s_add_u32 m0, s21, 0
    v_mfma_f32_32x32x16_bf16 v[48:63], v[76:79], v[176:179], v[48:63]
    s_cbranch_vccnz WL_8_0
    v_mad_u32_u16 v234, v234, s3, v246 op_sel:[1,0,0,0]
    v_mad_u32_u16 v235, v235, s3, v246 op_sel:[1,0,0,0]
    buffer_load_dwordx4 v234, s[4:7], s38 offen  lds
    buffer_load_dwordx4 v235, s[8:11], s38 offen offset:1024  lds
WR_8_0:
    ds_read_b64_tr_b16 v[176:177], v244 offset:2048
    ds_read_b64_tr_b16 v[178:179], v244 offset:3072
    ds_read_b64_tr_b16 v[184:185], v245 offset:2048
    ds_read_b64_tr_b16 v[186:187], v245 offset:3072
    s_waitcnt vmcnt(4) lgkmcnt(0)
    v_mfma_f32_32x32x16_bf16 v[0:15], v[80:83], v[176:179], v[0:15]
    s_add_u32 m0, s21, 2048
    v_mfma_f32_32x32x16_bf16 v[48:63], v[84:87], v[176:179], v[48:63]
    s_cbranch_vccnz WL_8_1
    v_mad_u32_u16 v236, v236, s3, v246 op_sel:[1,0,0,0]
    v_mad_u32_u16 v237, v237, s3, v246 op_sel:[1,0,0,0]
    buffer_load_dwordx4 v236, s[4:7], s39 offen  lds
    buffer_load_dwordx4 v237, s[8:11], s39 offen offset:1024  lds
WR_8_1:
    ds_read_b64_tr_b16 v[176:177], v244 offset:4096
    ds_read_b64_tr_b16 v[178:179], v244 offset:5120
    ds_read_b64_tr_b16 v[188:189], v245 offset:4096
    ds_read_b64_tr_b16 v[190:191], v245 offset:5120
    s_waitcnt vmcnt(4) lgkmcnt(0)
    v_mfma_f32_32x32x16_bf16 v[0:15], v[88:91], v[176:179], v[0:15]
    v_fmac_f32 v255, v22, v158
    v_fmac_f32 v255, v23, v159
    v_fmac_f32 v201, v24, v168
    v_fmac_f32 v201, v25, v169
    v_permlane32_swap_b32 v197, v255
    v_fmac_f32 v201, v26, v170
    s_add_u32 m0, s21, 4096
    v_mfma_f32_32x32x16_bf16 v[48:63], v[92:95], v[176:179], v[48:63]
    s_cbranch_vccnz WL_8_2
    v_mad_u32_u16 v238, v238, s3, v246 op_sel:[1,0,0,0]
    v_mad_u32_u16 v239, v239, s3, v246 op_sel:[1,0,0,0]
    buffer_load_dwordx4 v238, s[4:7], s40 offen  lds
    buffer_load_dwordx4 v239, s[8:11], s40 offen offset:1024  lds
WR_8_2:
    ds_read_b64_tr_b16 v[176:177], v244 offset:6144
    ds_read_b64_tr_b16 v[178:179], v244 offset:7168
    ds_read_b64_tr_b16 v[192:193], v245 offset:6144
    ds_read_b64_tr_b16 v[194:195], v245 offset:7168
    s_waitcnt lgkmcnt(0)
    s_mov_b64 exec, s[56:57]
    v_xor_b32 v68, 0x80008000, v68
    v_xor_b32 v69, 0x80008000, v69
    v_xor_b32 v70, 0x80008000, v70
    v_xor_b32 v71, 0x80008000, v71
    s_mov_b64 exec, -1
    v_mfma_f32_32x32x16_bf16 v[0:15], v[64:67], v[176:179], v[0:15]
    v_fmac_f32 v201, v27, v171
    v_fmac_f32 v201, v28, v172
    v_fmac_f32 v201, v29, v173
    v_fmac_f32 v201, v30, v174
    v_fmac_f32 v201, v31, v175
    v_add_f32 v255, v197, v255
    s_add_u32 m0, s21, 6144
    v_mfma_f32_32x32x16_bf16 v[48:63], v[68:71], v[176:179], v[48:63]
    s_cbranch_vccnz WL_8_3
    v_mad_u32_u16 v240, v240, s3, v246 op_sel:[1,0,0,0]
    v_mad_u32_u16 v241, v241, s3, v246 op_sel:[1,0,0,0]
    buffer_load_dwordx4 v240, s[4:7], s41 offen  lds
    buffer_load_dwordx4 v241, s[8:11], s41 offen offset:1024  lds
WR_8_3:
    v_cvt_pk_bf16_f32 v254, v254, v255
    ds_write_b32 v253, v254 offset:512
    v_mfma_f32_32x32x16_bf16 v[16:31], v[72:75], v[180:183], 0
    v_mul_f32 v254, v0, v144
    v_fmac_f32 v254, v1, v145
    v_fmac_f32 v254, v2, v146
    v_fmac_f32 v254, v3, v147
    v_fmac_f32 v254, v4, v148
    v_fmac_f32 v254, v5, v149
    v_mfma_f32_32x32x16_bf16 v[32:47], v[76:79], v[180:183], v[32:47]
    v_fmac_f32 v254, v6, v150
    v_fmac_f32 v254, v7, v151
    v_fma_f32 v202, v8, -v160, v202
    v_fma_f32 v202, v9, -v161, v202
    v_permlane32_swap_b32 v254, v200
    v_fma_f32 v202, v10, -v162, v202
    v_mfma_f32_32x32x16_bf16 v[16:31], v[80:83], v[184:187], v[16:31]
    v_fma_f32 v202, v11, -v163, v202
    v_fma_f32 v202, v12, -v164, v202
    v_fma_f32 v202, v13, -v165, v202
    v_fma_f32 v202, v14, -v166, v202
    v_fma_f32 v202, v15, -v167, v202
    v_add_f32 v200, v254, v200
    v_mfma_f32_32x32x16_bf16 v[32:47], v[84:87], v[184:187], v[32:47]
    v_fmac_f32 v198, v48, v112
    v_permlane32_swap_b32 v202, v254
    v_fmac_f32 v198, v49, v113
    v_fmac_f32 v198, v50, v114
    v_fmac_f32 v198, v51, v115
    v_fmac_f32 v198, v52, v116
    v_mfma_f32_32x32x16_bf16 v[16:31], v[88:91], v[188:191], v[16:31]
    v_fmac_f32 v198, v53, v117
    v_fmac_f32 v198, v54, v118
    v_fmac_f32 v198, v55, v119
    v_add_f32 v254, v202, v254
    v_mul_f32 v196, v56, v160
    v_fmac_f32 v196, v57, v161
    v_mfma_f32_32x32x16_bf16 v[32:47], v[92:95], v[188:191], v[32:47]
    s_waitcnt vmcnt(6)
    ds_read_b64_tr_b16 v[176:177], v244 offset:0
    ds_read_b64_tr_b16 v[178:179], v244 offset:1024
    ds_read_b64_tr_b16 v[180:181], v245 offset:0
    ds_read_b64_tr_b16 v[182:183], v245 offset:1024
    v_fmac_f32 v196, v58, v162
    v_fmac_f32 v196, v59, v163
    v_mfma_f32_32x32x16_bf16 v[16:31], v[64:67], v[192:195], v[16:31]
    v_fmac_f32 v196, v60, v164
    v_fmac_f32 v196, v61, v165
    v_fmac_f32 v196, v62, v166
    v_fmac_f32 v196, v63, v167
    s_nop 1
    v_permlane32_swap_b32 v198, v196
    v_add_f32 v196, v198, v196
    v_mfma_f32_32x32x16_bf16 v[32:47], v[68:71], v[192:195], v[32:47]
    v_add_u32 v249, s48, v249
    v_add_u32 v250, s49, v250
    ds_read_b32 v252, v251 offset:16
    ds_read_b64_tr_b16 v[72:73], v249 offset:0
    ds_read_b64_tr_b16 v[76:77], v249 offset:64
    ds_read_b64_tr_b16 v[74:75], v249 offset:256
    ds_read_b64_tr_b16 v[78:79], v249 offset:320
    s_mov_b64 exec, s[54:55]
    ds_read_u16_d16_hi v242, v250 offset:0
    s_mov_b64 exec, -1
    s_cbranch_vccnz LEPI_1
    v_mul_f32 v255, v16, v152
    v_fmac_f32 v255, v17, v153
    v_fmac_f32 v255, v18, v154
    v_fmac_f32 v255, v19, v155
    v_fmac_f32 v255, v20, v156
    v_fmac_f32 v255, v21, v157
    v_fmac_f32 v255, v22, v158
    v_fmac_f32 v255, v23, v159
    v_fma_f32 v203, v24, -v168, v203
    v_fma_f32 v203, v25, -v169, v203
    v_permlane32_swap_b32 v255, v201
    v_fma_f32 v203, v26, -v170, v203
    v_fma_f32 v203, v27, -v171, v203
    v_fma_f32 v203, v28, -v172, v203
    v_fma_f32 v203, v29, -v173, v203
    v_fma_f32 v203, v30, -v174, v203
    v_fma_f32 v203, v31, -v175, v203
    v_add_f32 v201, v255, v201
    v_fmac_f32 v199, v32, v120
    v_permlane32_swap_b32 v203, v255
    v_fmac_f32 v199, v33, v121
    v_fmac_f32 v199, v34, v122
    v_fmac_f32 v199, v35, v123
    v_fmac_f32 v199, v36, v124
    v_fmac_f32 v199, v37, v125
    v_fmac_f32 v199, v38, v126
    v_fmac_f32 v199, v39, v127
    v_add_f32 v255, v203, v255
    v_mul_f32 v197, v40, v168
    v_fmac_f32 v197, v41, v169
    v_fmac_f32 v197, v42, v170
    v_fmac_f32 v197, v43, v171
    v_fmac_f32 v197, v44, v172
    v_fmac_f32 v197, v45, v173
    v_fmac_f32 v197, v46, v174
    v_fmac_f32 v197, v47, v175
    s_nop 1
    v_permlane32_swap_b32 v199, v197
    v_add_f32 v197, v199, v197
    v_cvt_pk_bf16_f32 v200, v200, v201
    v_cvt_pk_bf16_f32 v254, v254, v255
    v_cvt_pk_bf16_f32 v196, v196, v197
    ds_write2st64_b32 v253, v200, v196 offset0:3 offset1:4
    s_mov_b64 exec, 0xffffffff
    ds_write_b32 v253, v254 offset:1280
    s_mov_b64 exec, -1
    s_add_u32 s50, s50, 1
    s_cmp_ge_u32 s50, 4
    s_cbranch_scc1 LAST1
    s_waitcnt lgkmcnt(7)
    v_readfirstlane_b32 s66, v252
    s_add_u32 s53, s53, 1
    v_mov_b32 v252, s53
    s_cmp_le_u32 s53, s66
    ds_write2_b32 v251, v252, v252 offset0:0 offset1:8
    s_setprio 1
    s_cbranch_scc1 PRIO_15
    s_setprio 0
PRIO_15:
    s_cmp_eq_u32 s52, 4
    s_cbranch_scc1 ITEM_1_4
    s_cmp_eq_u32 s52, 5
    s_cbranch_scc1 ITEM_1_5
    s_cmp_eq_u32 s52, 3
    s_cbranch_scc1 ITEM_1_3
    s_cmp_eq_u32 s52, 6
    s_cbranch_scc1 ITEM_1_6
    s_cmp_eq_u32 s52, 8
    s_cbranch_scc1 ITEM_1_8
    s_branch ITEM_1_2
WL_8_0:
    s_add_u32 s66, s51, 0
    buffer_load_dwordx4 v[96:99], v246, s[16:19], s66 offen offset:2048 sc1
    buffer_load_dwordx4 v[100:103], v246, s[16:19], s66 offen offset:3072 sc1
    s_branch WR_8_0
WL_8_1:
    s_add_u32 s66, s51, 4096
    buffer_load_dwordx4 v[104:107], v246, s[16:19], s66 offen offset:2048 sc1
    buffer_load_dwordx4 v[108:111], v246, s[16:19], s66 offen offset:3072 sc1
    s_branch WR_8_1
WL_8_2:
    s_add_u32 s66, s51, 8192
    buffer_load_dwordx4 v[128:131], v246, s[16:19], s66 offen offset:2048 sc1
    buffer_load_dwordx4 v[132:135], v246, s[16:19], s66 offen offset:3072 sc1
    s_branch WR_8_2
WL_8_3:
    s_add_u32 s66, s51, 12288
    buffer_load_dwordx4 v[136:139], v246, s[16:19], s66 offen offset:2048 sc1
    buffer_load_dwordx4 v[140:143], v246, s[16:19], s66 offen offset:3072 sc1
    s_branch WR_8_3
.p2align 6
ITEM_1_2:
    s_mov_b32 m0, s50
    s_nop 0
    s_movrels_b32 s71, s23
    s_movrels_b32 s33, s28
    v_add_u32 v253, s33, v248
    s_bfe_u32 s46, s71, 0x30012
    s_mov_b32 m0, s46
    s_and_b32 s66, s71, 0x3ffff
    s_movrels_b32 s68, s57
    s_movrels_b32 s69, s61
    s_sub_u32 s48, s66, s47
    s_mov_b32 s47, s66
    s_lshr_b32 s52, s71, 28
    s_lshl_b32 s67, s46, 9
    s_add_u32 s66, s66, s67
    s_sub_u32 s49, s66, s42
    s_mov_b32 s42, s66
    s_bfe_u32 s66, s68, 655360
    s_add_u32 s43, s42, s66
    s_bfe_u32 s39, s69, 655360
    s_bfe_u32 s66, s68, 655370
    s_add_u32 s44, s42, s66
    s_bfe_u32 s40, s69, 655370
    s_bfe_u32 s66, s68, 655380
    s_add_u32 s45, s42, s66
    s_bfe_u32 s41, s69, 655380
    v_add_u32 v252, s42, v247
    ds_read2_b32 v[234:235], v252 offset0:0 offset1:16
    v_add_u32 v252, s43, v247
    ds_read2_b32 v[236:237], v252 offset0:0 offset1:16
    v_add_u32 v252, s44, v247
    ds_read2_b32 v[238:239], v252 offset0:0 offset1:16
    v_add_u32 v252, s45, v247
    ds_read2_b32 v[240:241], v252 offset0:0 offset1:16
    s_waitcnt lgkmcnt(4)
    v_mul_f32_dpp v196, v242, v72 row_newbcast:0 row_mask:0xf bank_mask:0xf
    v_mul_f32_dpp v197, v242, v73 row_newbcast:1 row_mask:0xf bank_mask:0xf
    v_mul_f32_dpp v198, v242, v72 row_newbcast:8 row_mask:0xf bank_mask:0xf
    v_mul_f32_dpp v199, v242, v73 row_newbcast:9 row_mask:0xf bank_mask:0xf
    v_mul_f32_dpp v200, v242, v76 row_newbcast:2 row_mask:0xf bank_mask:0xf
    v_mul_f32_dpp v201, v242, v77 row_newbcast:3 row_mask:0xf bank_mask:0xf
    v_mul_f32_dpp v202, v242, v76 row_newbcast:10 row_mask:0xf bank_mask:0xf
    v_mul_f32_dpp v203, v242, v77 row_newbcast:11 row_mask:0xf bank_mask:0xf
    v_cvt_pk_bf16_f32 v72, v196, v197
    v_cvt_pk_bf16_f32 v76, v198, v199
    v_cvt_pk_bf16_f32 v73, v200, v201
    v_cvt_pk_bf16_f32 v77, v202, v203
    v_mul_f32_dpp v196, v242, v74 row_newbcast:4 row_mask:0xf bank_mask:0xf
    v_mul_f32_dpp v197, v242, v75 row_newbcast:5 row_mask:0xf bank_mask:0xf
    v_mul_f32_dpp v198, v242, v74 row_newbcast:12 row_mask:0xf bank_mask:0xf
    v_mul_f32_dpp v199, v242, v75 row_newbcast:13 row_mask:0xf bank_mask:0xf
    v_mul_f32_dpp v200, v242, v78 row_newbcast:6 row_mask:0xf bank_mask:0xf
    v_mul_f32_dpp v201, v242, v79 row_newbcast:7 row_mask:0xf bank_mask:0xf
    v_mul_f32_dpp v202, v242, v78 row_newbcast:14 row_mask:0xf bank_mask:0xf
    v_mul_f32_dpp v203, v242, v79 row_newbcast:15 row_mask:0xf bank_mask:0xf
    v_cvt_pk_bf16_f32 v74, v196, v197
    v_cvt_pk_bf16_f32 v78, v198, v199
    v_cvt_pk_bf16_f32 v75, v200, v201
    v_cvt_pk_bf16_f32 v79, v202, v203
    s_nop 0
    s_waitcnt lgkmcnt(3)
    v_mfma_f32_32x32x16_bf16 v[56:71], v[72:75], v[176:179], 0
    s_add_u32 m0, s21, 0
    v_mfma_f32_32x32x16_bf16 v[16:31], v[76:79], v[176:179], 0
    s_cbranch_vccnz WL_2_0
    v_mad_u32_u16 v234, v234, s3, v246 op_sel:[1,0,0,0]
    v_mad_u32_u16 v235, v235, s3, v246 op_sel:[1,0,0,0]
    buffer_load_dwordx4 v234, s[4:7], s38 offen  lds
    buffer_load_dwordx4 v235, s[8:11], s38 offen offset:1024  lds
WR_2_0:
    v_mfma_f32_32x32x16_bf16 v[32:47], v[72:75], v[180:183], 0
    s_nop 3
    v_mul_f32 v196, v56, v96
    v_fmac_f32 v196, v57, v97
    v_fmac_f32 v196, v58, v98
    v_fmac_f32 v196, v59, v99
    v_fmac_f32 v196, v60, v100
    v_fmac_f32 v196, v61, v101
    v_mfma_f32_32x32x16_bf16 v[0:15], v[76:79], v[180:183], 0
    s_waitcnt vmcnt(6)
    ds_read_b64_tr_b16 v[176:177], v244 offset:2048
    ds_read_b64_tr_b16 v[178:179], v244 offset:3072
    ds_read_b64_tr_b16 v[180:181], v245 offset:2048
    ds_read_b64_tr_b16 v[182:183], v245 offset:3072
    v_fmac_f32 v196, v62, v102
    v_fmac_f32 v196, v63, v103
    v_mul_f32 v198, v64, v128
    v_fmac_f32 v198, v65, v129
    v_fmac_f32 v198, v66, v130
    v_fmac_f32 v198, v67, v131
    v_fmac_f32 v198, v68, v132
    v_fmac_f32 v198, v69, v133
    v_fmac_f32 v198, v70, v134
    v_fmac_f32 v198, v71, v135
    v_mul_f32 v200, v16, v128
    v_fmac_f32 v200, v17, v129
    v_permlane32_swap_b32 v196, v198
    v_fmac_f32 v200, v18, v130
    v_fmac_f32 v200, v19, v131
    v_fmac_f32 v200, v20, v132
    v_fmac_f32 v200, v21, v133
    v_fmac_f32 v200, v22, v134
    v_fmac_f32 v200, v23, v135
    v_add_f32 v198, v196, v198
    v_mul_f32_e64 v202, v24, -v128
    v_fma_f32 v202, v25, -v129, v202
    v_fma_f32 v202, v26, -v130, v202
    v_fma_f32 v202, v27, -v131, v202
    v_fma_f32 v202, v28, -v132, v202
    v_fma_f32 v202, v29, -v133, v202
    v_fma_f32 v202, v30, -v134, v202
    v_fma_f32 v202, v31, -v135, v202
    s_nop 1
    v_permlane32_swap_b32 v200, v202
    v_add_f32 v202, v200, v202
    s_waitcnt lgkmcnt(0)
    v_mfma_f32_32x32x16_bf16 v[56:71], v[72:75], v[176:179], 0
    v_mul_f32 v197, v32, v104
    v_fmac_f32 v197, v33, v105
    v_fmac_f32 v197, v34, v106
    v_fmac_f32 v197, v35, v107
    v_fmac_f32 v197, v36, v108
    v_fmac_f32 v197, v37, v109
    s_add_u32 m0, s21, 2048
    v_mfma_f32_32x32x16_bf16 v[16:31], v[76:79], v[176:179], 0
    s_cbranch_vccnz WL_2_1
    v_mad_u32_u16 v236, v236, s3, v246 op_sel:[1,0,0,0]
    v_mad_u32_u16 v237, v237, s3, v246 op_sel:[1,0,0,0]
    buffer_load_dwordx4 v236, s[4:7], s39 offen  lds
    buffer_load_dwordx4 v237, s[8:11], s39 offen offset:1024  lds
WR_2_1:
    v_fmac_f32 v197, v38, v110
    v_fmac_f32 v197, v39, v111
    v_mul_f32 v199, v40, v136
    v_fmac_f32 v199, v41, v137
    v_fmac_f32 v199, v42, v138
    v_fmac_f32 v199, v43, v139
    v_fmac_f32 v199, v44, v140
    v_fmac_f32 v199, v45, v141
    v_fmac_f32 v199, v46, v142
    v_fmac_f32 v199, v47, v143
    v_mul_f32 v201, v0, v136
    v_fmac_f32 v201, v1, v137
    v_permlane32_swap_b32 v197, v199
    v_fmac_f32 v201, v2, v138
    v_fmac_f32 v201, v3, v139
    v_fmac_f32 v201, v4, v140
    v_fmac_f32 v201, v5, v141
    v_fmac_f32 v201, v6, v142
    v_fmac_f32 v201, v7, v143
    v_add_f32 v199, v197, v199
    v_mul_f32_e64 v203, v8, -v136
    v_fma_f32 v203, v9, -v137, v203
    v_fma_f32 v203, v10, -v138, v203
    v_fma_f32 v203, v11, -v139, v203
    v_fma_f32 v203, v12, -v140, v203
    v_fma_f32 v203, v13, -v141, v203
    v_fma_f32 v203, v14, -v142, v203
    v_fma_f32 v203, v15, -v143, v203
    s_nop 1
    v_permlane32_swap_b32 v201, v203
    v_add_f32 v203, v201, v203
    v_cvt_pk_bf16_f32 v192, v198, v199
    v_cvt_pk_bf16_f32 v193, v202, v203
    v_mfma_f32_32x32x16_bf16 v[32:47], v[72:75], v[180:183], 0
    v_mul_f32 v196, v56, v144
    v_fmac_f32 v196, v57, v145
    v_fmac_f32 v196, v58, v146
    v_fmac_f32 v196, v59, v147
    v_fmac_f32 v196, v60, v148
    v_fmac_f32 v196, v61, v149
    v_mfma_f32_32x32x16_bf16 v[0:15], v[76:79], v[180:183], 0
    s_waitcnt vmcnt(6)
    ds_read_b64_tr_b16 v[176:177], v244 offset:4096
    ds_read_b64_tr_b16 v[178:179], v244 offset:5120
    ds_read_b64_tr_b16 v[180:181], v245 offset:4096
    ds_read_b64_tr_b16 v[182:183], v245 offset:5120
    v_fmac_f32 v196, v62, v150
    v_fmac_f32 v196, v63, v151
    v_mul_f32_e64 v200, v16, -v160
    v_fma_f32 v200, v17, -v161, v200
    v_fma_f32 v200, v18, -v162, v200
    v_fma_f32 v200, v19, -v163, v200
    v_fma_f32 v200, v20, -v164, v200
    v_fma_f32 v200, v21, -v165, v200
    v_fma_f32 v200, v22, -v166, v200
    v_fma_f32 v200, v23, -v167, v200
    v_mul_f32_e64 v202, v24, -v160
    v_fma_f32 v202, v25, -v161, v202
    v_fma_f32 v202, v26, -v162, v202
    v_fma_f32 v202, v27, -v163, v202
    v_fma_f32 v202, v28, -v164, v202
    v_fma_f32 v202, v29, -v165, v202
    v_fma_f32 v202, v30, -v166, v202
    v_fma_f32 v202, v31, -v167, v202
    s_waitcnt lgkmcnt(0)
    v_mfma_f32_32x32x16_bf16 v[16:31], v[72:75], v[176:179], 0
    v_mul_f32 v197, v32, v152
    v_fmac_f32 v197, v33, v153
    v_fmac_f32 v197, v34, v154
    v_fmac_f32 v197, v35, v155
    v_fmac_f32 v197, v36, v156
    v_fmac_f32 v197, v37, v157
    s_add_u32 m0, s21, 4096
    v_mfma_f32_32x32x16_bf16 v[48:63], v[76:79], v[176:179], 0
    s_cbranch_vccnz WL_2_2
    v_mad_u32_u16 v238, v238, s3, v246 op_sel:[1,0,0,0]
    v_mad_u32_u16 v239, v239, s3, v246 op_sel:[1,0,0,0]
    buffer_load_dwordx4 v238, s[4:7], s40 offen  lds
    buffer_load_dwordx4 v239, s[8:11], s40 offen offset:1024  lds
WR_2_2:
    v_fmac_f32 v197, v38, v158
    v_fmac_f32 v197, v39, v159
    v_mul_f32_e64 v201, v0, -v168
    v_fma_f32 v201, v1, -v169, v201
    v_fma_f32 v201, v2, -v170, v201
    v_fma_f32 v201, v3, -v171, v201
    v_fma_f32 v201, v4, -v172, v201
    v_fma_f32 v201, v5, -v173, v201
    v_fma_f32 v201, v6, -v174, v201
    v_fma_f32 v201, v7, -v175, v201
    v_mul_f32_e64 v203, v8, -v168
    v_fma_f32 v203, v9, -v169, v203
    v_fma_f32 v203, v10, -v170, v203
    v_fma_f32 v203, v11, -v171, v203
    v_fma_f32 v203, v12, -v172, v203
    v_fma_f32 v203, v13, -v173, v203
    v_fma_f32 v203, v14, -v174, v203
    v_fma_f32 v203, v15, -v175, v203
    v_mfma_f32_32x32x16_bf16 v[0:15], v[72:75], v[180:183], 0
    v_fmac_f32 v200, v24, v160
    v_fmac_f32 v200, v25, v161
    v_fmac_f32 v200, v26, v162
    v_fmac_f32 v200, v27, v163
    v_fmac_f32 v200, v28, v164
    v_fmac_f32 v200, v29, v165
    v_fmac_f32 v200, v30, v166
    v_fmac_f32 v200, v31, v167
    v_mfma_f32_32x32x16_bf16 v[24:39], v[76:79], v[180:183], 0
    s_waitcnt vmcnt(6)
    ds_read_b64_tr_b16 v[176:177], v244 offset:6144
    ds_read_b64_tr_b16 v[178:179], v244 offset:7168
    ds_read_b64_tr_b16 v[180:181], v245 offset:6144
    ds_read_b64_tr_b16 v[182:183], v245 offset:7168
    v_mul_f32 v254, v16, v144
    v_fmac_f32 v254, v17, v145
    v_fmac_f32 v254, v18, v146
    v_fmac_f32 v254, v19, v147
    v_fmac_f32 v254, v20, v148
    v_fmac_f32 v254, v21, v149
    v_fmac_f32 v254, v22, v150
    v_fmac_f32 v254, v23, v151
    v_sub_f32_e64 v64, -v48, v64
    v_sub_f32_e64 v65, -v49, v65
    v_permlane32_swap_b32 v196, v254
    v_sub_f32_e64 v66, -v50, v66
    v_sub_f32_e64 v67, -v51, v67
    v_sub_f32_e64 v68, -v52, v68
    v_sub_f32_e64 v69, -v53, v69
    v_sub_f32_e64 v70, -v54, v70
    v_sub_f32_e64 v71, -v55, v71
    v_add_f32 v254, v196, v254
    s_waitcnt lgkmcnt(0)
    v_mfma_f32_32x32x16_bf16 v[56:71], v[76:79], v[176:179], v[56:71]
    v_sub_f32_e64 v40, -v24, v40
    v_sub_f32_e64 v41, -v25, v41
    v_sub_f32_e64 v42, -v26, v42
    v_sub_f32_e64 v43, -v27, v43
    v_sub_f32_e64 v44, -v28, v44
    v_sub_f32_e64 v45, -v29, v45
    v_sub_f32_e64 v46, -v30, v46
    v_sub_f32_e64 v47, -v31, v47
    s_add_u32 m0, s21, 6144
    v_mfma_f32_32x32x16_bf16 v[16:31], v[72:75], v[176:179], 0
    s_cbranch_vccnz WL_2_3
    v_mad_u32_u16 v240, v240, s3, v246 op_sel:[1,0,0,0]
    v_mad_u32_u16 v241, v241, s3, v246 op_sel:[1,0,0,0]
    buffer_load_dwordx4 v240, s[4:7], s41 offen  lds
    buffer_load_dwordx4 v241, s[8:11], s41 offen offset:1024  lds
WR_2_3:
    v_mul_f32 v255, v0, v152
    v_fmac_f32 v255, v1, v153
    v_fmac_f32 v255, v2, v154
    v_fmac_f32 v255, v3, v155
    v_fmac_f32 v255, v4, v156
    v_fmac_f32 v255, v5, v157
    v_fmac_f32 v255, v6, v158
    v_fmac_f32 v255, v7, v159
    v_fmac_f32 v201, v8, v168
    v_fmac_f32 v201, v9, v169
    v_permlane32_swap_b32 v197, v255
    v_fmac_f32 v201, v10, v170
    v_fmac_f32 v201, v11, v171
    v_fmac_f32 v201, v12, v172
    v_fmac_f32 v201, v13, v173
    v_fmac_f32 v201, v14, v174
    v_fmac_f32 v201, v15, v175
    v_add_f32 v255, v197, v255
    v_cvt_pk_bf16_f32 v194, v254, v255
    v_mfma_f32_32x32x16_bf16 v[0:15], v[72:75], v[180:183], 0
    v_mul_f32 v254, v16, v144
    v_fmac_f32 v254, v17, v145
    v_fmac_f32 v254, v18, v146
    v_fmac_f32 v254, v19, v147
    v_fmac_f32 v254, v20, v148
    v_fmac_f32 v254, v21, v149
    v_mfma_f32_32x32x16_bf16 v[32:47], v[76:79], v[180:183], v[32:47]
    s_waitcnt vmcnt(6)
    ds_read_b64_tr_b16 v[176:177], v244 offset:0
    ds_read_b64_tr_b16 v[178:179], v244 offset:1024
    ds_read_b64_tr_b16 v[180:181], v245 offset:0
    ds_read_b64_tr_b16 v[182:183], v245 offset:1024
    v_add_u32 v249, s48, v249
    v_add_u32 v250, s49, v250
    ds_read_b32 v252, v251 offset:16
    ds_read_b64_tr_b16 v[72:73], v249 offset:0
    ds_read_b64_tr_b16 v[76:77], v249 offset:64
    ds_read_b64_tr_b16 v[74:75], v249 offset:256
    ds_read_b64_tr_b16 v[78:79], v249 offset:320
    s_mov_b64 exec, s[54:55]
    ds_read_u16_d16_hi v242, v250 offset:0
    s_mov_b64 exec, -1
    v_fmac_f32 v254, v22, v150
    v_fmac_f32 v254, v23, v151
    v_fma_f32 v202, v24, -v160, v202
    v_fma_f32 v202, v25, -v161, v202
    v_permlane32_swap_b32 v254, v200
    v_fma_f32 v202, v26, -v162, v202
    v_fma_f32 v202, v27, -v163, v202
    v_fma_f32 v202, v28, -v164, v202
    v_fma_f32 v202, v29, -v165, v202
    v_fma_f32 v202, v30, -v166, v202
    v_fma_f32 v202, v31, -v167, v202
    v_add_f32 v200, v254, v200
    v_mul_f32_e64 v198, v64, -v112
    v_permlane32_swap_b32 v202, v254
    v_fma_f32 v198, v65, -v113, v198
    v_fma_f32 v198, v66, -v114, v198
    v_fma_f32 v198, v67, -v115, v198
    v_fma_f32 v198, v68, -v116, v198
    v_fma_f32 v198, v69, -v117, v198
    v_fma_f32 v198, v70, -v118, v198
    v_fma_f32 v198, v71, -v119, v198
    v_add_f32 v254, v202, v254
    v_mul_f32 v196, v56, v160
    v_fmac_f32 v196, v57, v161
    v_fmac_f32 v196, v58, v162
    v_fmac_f32 v196, v59, v163
    v_fmac_f32 v196, v60, v164
    v_fmac_f32 v196, v61, v165
    v_fmac_f32 v196, v62, v166
    v_fmac_f32 v196, v63, v167
    s_nop 1
    v_permlane32_swap_b32 v198, v196
    v_add_f32 v196, v198, v196
    s_cbranch_vccnz LEPI_2
    v_mul_f32 v255, v0, v152
    v_fmac_f32 v255, v1, v153
    v_fmac_f32 v255, v2, v154
    v_fmac_f32 v255, v3, v155
    v_fmac_f32 v255, v4, v156
    v_fmac_f32 v255, v5, v157
    v_fmac_f32 v255, v6, v158
    v_fmac_f32 v255, v7, v159
    v_fma_f32 v203, v8, -v168, v203
    v_fma_f32 v203, v9, -v169, v203
    v_permlane32_swap_b32 v255, v201
    v_fma_f32 v203, v10, -v170, v203
    v_fma_f32 v203, v11, -v171, v203
    v_fma_f32 v203, v12, -v172, v203
    v_fma_f32 v203, v13, -v173, v203
    v_fma_f32 v203, v14, -v174, v203
    v_fma_f32 v203, v15, -v175, v203
    v_add_f32 v201, v255, v201
    v_mul_f32_e64 v199, v40, -v120
    v_permlane32_swap_b32 v203, v255
    v_fma_f32 v199, v41, -v121, v199
    v_fma_f32 v199, v42, -v122, v199
    v_fma_f32 v199, v43, -v123, v199
    v_fma_f32 v199, v44, -v124, v199
    v_fma_f32 v199, v45, -v125, v199
    v_fma_f32 v199, v46, -v126, v199
    v_fma_f32 v199, v47, -v127, v199
    v_add_f32 v255, v203, v255
    v_mul_f32 v197, v32, v168
    v_fmac_f32 v197, v33, v169
    v_fmac_f32 v197, v34, v170
    v_fmac_f32 v197, v35, v171
    v_fmac_f32 v197, v36, v172
    v_fmac_f32 v197, v37, v173
    v_fmac_f32 v197, v38, v174
    v_fmac_f32 v197, v39, v175
    s_nop 1
    v_permlane32_swap_b32 v199, v197
    v_add_f32 v197, v199, v197
    v_cvt_pk_bf16_f32 v200, v200, v201
    v_cvt_pk_bf16_f32 v254, v254, v255
    v_cvt_pk_bf16_f32 v196, v196, v197
    ds_write2st64_b32 v253, v192, v193 offset0:0 offset1:1
    ds_write2st64_b32 v253, v194, v200 offset0:2 offset1:3
    ds_write_b32 v253, v196 offset:1024
    s_mov_b64 exec, 0xffffffff
    ds_write_b32 v253, v254 offset:1280
    s_mov_b64 exec, -1
    s_add_u32 s50, s50, 1
    s_cmp_ge_u32 s50, 4
    s_cbranch_scc1 LAST1
    s_waitcnt lgkmcnt(9)
    v_readfirstlane_b32 s66, v252
    s_add_u32 s53, s53, 1
    v_mov_b32 v252, s53
    s_cmp_le_u32 s53, s66
    ds_write2_b32 v251, v252, v252 offset0:0 offset1:8
    s_setprio 1
    s_cbranch_scc1 PRIO_16
    s_setprio 0
PRIO_16:
    s_cmp_eq_u32 s52, 4
    s_cbranch_scc1 ITEM_1_4
    s_cmp_eq_u32 s52, 5
    s_cbranch_scc1 ITEM_1_5
    s_cmp_eq_u32 s52, 3
    s_cbranch_scc1 ITEM_1_3
    s_cmp_eq_u32 s52, 6
    s_cbranch_scc1 ITEM_1_6
    s_cmp_eq_u32 s52, 8
    s_cbranch_scc1 ITEM_1_8
    s_branch ITEM_1_2
WL_2_0:
    s_add_u32 s66, s51, 0
    buffer_load_dword v195, v246, s[16:19], s66 offen
    buffer_load_dword v195, v246, s[16:19], s66 offen
    s_branch WR_2_0
WL_2_1:
    s_add_u32 s66, s51, 4096
    buffer_load_dword v195, v246, s[16:19], s66 offen
    buffer_load_dword v195, v246, s[16:19], s66 offen
    s_branch WR_2_1
WL_2_2:
    s_add_u32 s66, s51, 8192
    buffer_load_dword v195, v246, s[16:19], s66 offen
    buffer_load_dword v195, v246, s[16:19], s66 offen
    s_branch WR_2_2
WL_2_3:
    s_add_u32 s66, s51, 12288
    buffer_load_dword v195, v246, s[16:19], s66 offen
    buffer_load_dword v195, v246, s[16:19], s66 offen
    s_branch WR_2_3
.p2align 6
.p2align 6
LEPI_2:
    s_lshl_b32 s71, s20, 4
    s_add_u32 s67, s51, 4096
    s_add_u32 s68, s51, 8192
    s_add_u32 s69, s51, 12288
    s_add_u32 s70, s51, 16384
    s_waitcnt lgkmcnt(0)
    buffer_load_dwordx4 v[96:99], v246, s[16:19], s51 offen offset:2048 sc1
    s_mov_b32 s52, 163072
    v_bfe_u32 v177, v246, 4, 4
    v_bfe_u32 v179, v246, 4, 3
    v_lshl_add_u32 v180, v177, 3, s52
    v_lshl_add_u32 v190, v177, 4, s52
    v_lshl_add_u32 v181, v179, 3, s52
    ds_read2_b64 v[182:185], v180 offset0:32 offset1:48
    ds_read_b32 v191, v190
    ds_read_b64 v[186:187], v181 offset:512
    v_lshrrev_b32 v178, 8, v246
    buffer_load_dwordx4 v[100:103], v246, s[16:19], s51 offen offset:3072 sc1
    v_add_u32 v234, s21, v248
    v_add_u32 v235, 128, v234
    v_mul_f32 v255, v0, v152
    buffer_load_dwordx4 v[104:107], v246, s[16:19], s67 offen offset:2048 sc1
    v_fmac_f32 v255, v1, v153
    v_fmac_f32 v255, v2, v154
    ds_write2st64_b32 v234, v204, v205 offset0:0 offset1:1
    v_fmac_f32 v255, v3, v155
    buffer_load_dwordx4 v[108:111], v246, s[16:19], s67 offen offset:3072 sc1
    v_fmac_f32 v255, v4, v156
    v_fmac_f32 v255, v5, v157
    ds_write2st64_b32 v234, v206, v207 offset0:2 offset1:3
    v_fmac_f32 v255, v6, v158
    buffer_load_dwordx4 v[128:131], v246, s[16:19], s68 offen offset:2048 sc1
    v_fmac_f32 v255, v7, v159
    v_fma_f32 v203, v8, -v168, v203
    ds_write2st64_b32 v234, v208, v209 offset0:4 offset1:5
    v_fma_f32 v203, v9, -v169, v203
    buffer_load_dwordx4 v[132:135], v246, s[16:19], s68 offen offset:3072 sc1
    v_permlane32_swap_b32 v255, v201
    v_fma_f32 v203, v10, -v170, v203
    ds_write2st64_b32 v235, v210, v211 offset0:6 offset1:7
    v_fma_f32 v203, v11, -v171, v203
    v_fma_f32 v203, v12, -v172, v203
    buffer_load_dwordx4 v[136:139], v246, s[16:19], s69 offen offset:2048 sc1
    v_fma_f32 v203, v13, -v173, v203
    ds_write2st64_b32 v235, v212, v213 offset0:8 offset1:9
    v_fma_f32 v203, v14, -v174, v203
    v_fma_f32 v203, v15, -v175, v203
    buffer_load_dwordx4 v[140:143], v246, s[16:19], s69 offen offset:3072 sc1
    v_add_f32 v201, v255, v201
    ds_write2st64_b32 v235, v214, v215 offset0:10 offset1:11
    v_mul_f32_e64 v199, v40, -v120
    v_permlane32_swap_b32 v203, v255
    buffer_load_dwordx4 v[112:115], v246, s[16:19], s70 offen offset:2048 sc1
    v_fma_f32 v199, v41, -v121, v199
    ds_write2st64_b32 v234, v216, v217 offset0:12 offset1:13
    v_fma_f32 v199, v42, -v122, v199
    v_fma_f32 v199, v43, -v123, v199
    buffer_load_dwordx4 v[116:119], v246, s[16:19], s70 offen offset:3072 sc1
    v_fma_f32 v199, v44, -v124, v199
    ds_write2st64_b32 v234, v218, v219 offset0:14 offset1:15
    v_fma_f32 v199, v45, -v125, v199
    v_fma_f32 v199, v46, -v126, v199
    buffer_load_dwordx4 v[144:147], v246, s[16:19], s51 offen offset:0 sc1
    v_fma_f32 v199, v47, -v127, v199
    v_add_f32 v255, v203, v255
    ds_write2st64_b32 v234, v220, v221 offset0:16 offset1:17
    v_mul_f32 v197, v32, v168
    buffer_load_dwordx4 v[148:151], v246, s[16:19], s51 offen offset:1024 sc1
    v_fmac_f32 v197, v33, v169
    v_fmac_f32 v197, v34, v170
    ds_write2st64_b32 v235, v222, v223 offset0:18 offset1:19
    v_fmac_f32 v197, v35, v171
    buffer_load_dwordx4 v[160:163], v246, s[16:19], s67 offen offset:0 sc1
    v_fmac_f32 v197, v36, v172
    v_fmac_f32 v197, v37, v173
    ds_write2st64_b32 v235, v224, v225 offset0:20 offset1:21
    v_fmac_f32 v197, v38, v174
    buffer_load_dwordx4 v[164:167], v246, s[16:19], s67 offen offset:1024 sc1
    v_fmac_f32 v197, v39, v175
    s_nop 1
    ds_write2st64_b32 v235, v226, v227 offset0:22 offset1:23
    v_permlane32_swap_b32 v199, v197
    ds_write2st64_b32 v234, v228, v229 offset0:24 offset1:25
    v_add_f32 v197, v199, v197
    v_cvt_pk_bf16_f32 v200, v200, v201
    ds_write2st64_b32 v234, v230, v231 offset0:26 offset1:27
    v_cvt_pk_bf16_f32 v254, v254, v255
    v_cvt_pk_bf16_f32 v196, v196, v197
    ds_write2st64_b32 v234, v232, v233 offset0:28 offset1:29
    ds_write2st64_b32 v253, v192, v193 offset0:0 offset1:1
    ds_write2st64_b32 v253, v194, v200 offset0:2 offset1:3
    ds_write_b32 v253, v196 offset:1024
    s_mov_b64 exec, 0xffffffff
    ds_write_b32 v253, v254 offset:1280
    s_mov_b64 exec, -1
    s_add_u32 s50, s53, 1
    v_mov_b32 v234, s50
    ds_write2_b32 v251, v234, v234 offset0:0 offset1:8
    s_waitcnt lgkmcnt(15)
    s_branch TAIL
.p2align 6
LEPI_1:
    s_lshl_b32 s71, s20, 4
    s_add_u32 s67, s51, 4096
    s_add_u32 s68, s51, 8192
    s_add_u32 s69, s51, 12288
    s_add_u32 s70, s51, 16384
    s_waitcnt lgkmcnt(0)
    buffer_load_dwordx4 v[112:115], v246, s[16:19], s70 offen offset:2048 sc1
    s_mov_b32 s52, 163072
    v_bfe_u32 v177, v246, 4, 4
    v_bfe_u32 v179, v246, 4, 3
    v_lshl_add_u32 v180, v177, 3, s52
    v_lshl_add_u32 v190, v177, 4, s52
    v_lshl_add_u32 v181, v179, 3, s52
    ds_read2_b64 v[182:185], v180 offset0:32 offset1:48
    ds_read_b32 v191, v190
    ds_read_b64 v[186:187], v181 offset:512
    v_lshrrev_b32 v178, 8, v246
    buffer_load_dwordx4 v[116:119], v246, s[16:19], s70 offen offset:3072 sc1
    v_add_u32 v234, s21, v248
    v_add_u32 v235, 128, v234
    v_mul_f32 v255, v16, v152
    v_fmac_f32 v255, v17, v153
    buffer_load_dwordx4 v[144:147], v246, s[16:19], s51 offen offset:0 sc1
    v_fmac_f32 v255, v18, v154
    v_fmac_f32 v255, v19, v155
    ds_write2st64_b32 v234, v204, v205 offset0:0 offset1:1
    v_fmac_f32 v255, v20, v156
    v_fmac_f32 v255, v21, v157
    buffer_load_dwordx4 v[148:151], v246, s[16:19], s51 offen offset:1024 sc1
    v_fmac_f32 v255, v22, v158
    v_fmac_f32 v255, v23, v159
    ds_write2st64_b32 v234, v206, v207 offset0:2 offset1:3
    v_fma_f32 v203, v24, -v168, v203
    v_fma_f32 v203, v25, -v169, v203
    v_permlane32_swap_b32 v255, v201
    buffer_load_dwordx4 v[160:163], v246, s[16:19], s67 offen offset:0 sc1
    v_fma_f32 v203, v26, -v170, v203
    v_fma_f32 v203, v27, -v171, v203
    ds_write2st64_b32 v234, v208, v209 offset0:4 offset1:5
    v_fma_f32 v203, v28, -v172, v203
    v_fma_f32 v203, v29, -v173, v203
    buffer_load_dwordx4 v[164:167], v246, s[16:19], s67 offen offset:1024 sc1
    v_fma_f32 v203, v30, -v174, v203
    v_fma_f32 v203, v31, -v175, v203
    ds_write2st64_b32 v235, v210, v211 offset0:6 offset1:7
    v_add_f32 v201, v255, v201
    v_fmac_f32 v199, v32, v120
    ds_write2st64_b32 v235, v212, v213 offset0:8 offset1:9
    v_permlane32_swap_b32 v203, v255
    v_fmac_f32 v199, v33, v121
    v_fmac_f32 v199, v34, v122
    ds_write2st64_b32 v235, v214, v215 offset0:10 offset1:11
    v_fmac_f32 v199, v35, v123
    v_fmac_f32 v199, v36, v124
    ds_write2st64_b32 v234, v216, v217 offset0:12 offset1:13
    v_fmac_f32 v199, v37, v125
    v_fmac_f32 v199, v38, v126
    ds_write2st64_b32 v234, v218, v219 offset0:14 offset1:15
    v_fmac_f32 v199, v39, v127
    v_add_f32 v255, v203, v255
    ds_write2st64_b32 v234, v220, v221 offset0:16 offset1:17
    v_mul_f32 v197, v40, v168
    v_fmac_f32 v197, v41, v169
    ds_write2st64_b32 v235, v222, v223 offset0:18 offset1:19
    v_fmac_f32 v197, v42, v170
    v_fmac_f32 v197, v43, v171
    v_fmac_f32 v197, v44, v172
    ds_write2st64_b32 v235, v224, v225 offset0:20 offset1:21
    v_fmac_f32 v197, v45, v173
    v_fmac_f32 v197, v46, v174
    ds_write2st64_b32 v235, v226, v227 offset0:22 offset1:23
    v_fmac_f32 v197, v47, v175
    s_nop 1
    ds_write2st64_b32 v234, v228, v229 offset0:24 offset1:25
    v_permlane32_swap_b32 v199, v197
    v_add_f32 v197, v199, v197
    ds_write2st64_b32 v234, v230, v231 offset0:26 offset1:27
    v_cvt_pk_bf16_f32 v200, v200, v201
    v_cvt_pk_bf16_f32 v254, v254, v255
    v_cvt_pk_bf16_f32 v196, v196, v197
    ds_write2st64_b32 v234, v232, v233 offset0:28 offset1:29
    ds_write2st64_b32 v253, v200, v196 offset0:3 offset1:4
    s_mov_b64 exec, 0xffffffff
    ds_write_b32 v253, v254 offset:1280
    s_mov_b64 exec, -1
    s_add_u32 s50, s53, 1
    v_mov_b32 v234, s50
    ds_write2_b32 v251, v234, v234 offset0:0 offset1:8
    s_waitcnt lgkmcnt(15)
    s_branch TAIL
.p2align 6
LEPI_0:
    s_lshl_b32 s71, s20, 4
    s_add_u32 s67, s51, 4096
    s_add_u32 s68, s51, 8192
    s_add_u32 s69, s51, 12288
    s_add_u32 s70, s51, 16384
    s_waitcnt lgkmcnt(0)
    buffer_load_dwordx4 v[112:115], v246, s[16:19], s70 offen offset:2048 sc1
    s_mov_b32 s52, 163072
    v_bfe_u32 v177, v246, 4, 4
    v_bfe_u32 v179, v246, 4, 3
    v_lshl_add_u32 v180, v177, 3, s52
    v_lshl_add_u32 v190, v177, 4, s52
    v_lshl_add_u32 v181, v179, 3, s52
    ds_read2_b64 v[182:185], v180 offset0:32 offset1:48
    ds_read_b32 v191, v190
    ds_read_b64 v[186:187], v181 offset:512
    v_lshrrev_b32 v178, 8, v246
    buffer_load_dwordx4 v[116:119], v246, s[16:19], s70 offen offset:3072 sc1
    v_add_u32 v234, s21, v248
    v_add_u32 v235, 128, v234
    v_mul_f32 v255, v0, v152
    v_fmac_f32 v255, v1, v153
    buffer_load_dwordx4 v[144:147], v246, s[16:19], s51 offen offset:0 sc1
    v_fmac_f32 v255, v2, v154
    v_fmac_f32 v255, v3, v155
    ds_write2st64_b32 v234, v204, v205 offset0:0 offset1:1
    v_fmac_f32 v255, v4, v156
    v_fmac_f32 v255, v5, v157
    buffer_load_dwordx4 v[148:151], v246, s[16:19], s51 offen offset:1024 sc1
    v_fmac_f32 v255, v6, v158
    v_fmac_f32 v255, v7, v159
    ds_write2st64_b32 v234, v206, v207 offset0:2 offset1:3
    v_fma_f32 v203, v8, -v168, v203
    v_fma_f32 v203, v9, -v169, v203
    v_permlane32_swap_b32 v255, v201
    buffer_load_dwordx4 v[160:163], v246, s[16:19], s67 offen offset:0 sc1
    v_fma_f32 v203, v10, -v170, v203
    v_fma_f32 v203, v11, -v171, v203
    ds_write2st64_b32 v234, v208, v209 offset0:4 offset1:5
    v_fma_f32 v203, v12, -v172, v203
    v_fma_f32 v203, v13, -v173, v203
    buffer_load_dwordx4 v[164:167], v246, s[16:19], s67 offen offset:1024 sc1
    v_fma_f32 v203, v14, -v174, v203
    v_fma_f32 v203, v15, -v175, v203
    ds_write2st64_b32 v235, v210, v211 offset0:6 offset1:7
    v_add_f32 v201, v255, v201
    v_mul_f32_e64 v199, v40, -v120
    ds_write2st64_b32 v235, v212, v213 offset0:8 offset1:9
    v_permlane32_swap_b32 v203, v255
    v_fma_f32 v199, v41, -v121, v199
    v_fma_f32 v199, v42, -v122, v199
    ds_write2st64_b32 v235, v214, v215 offset0:10 offset1:11
    v_fma_f32 v199, v43, -v123, v199
    v_fma_f32 v199, v44, -v124, v199
    ds_write2st64_b32 v234, v216, v217 offset0:12 offset1:13
    v_fma_f32 v199, v45, -v125, v199
    v_fma_f32 v199, v46, -v126, v199
    ds_write2st64_b32 v234, v218, v219 offset0:14 offset1:15
    v_fma_f32 v199, v47, -v127, v199
    v_add_f32 v255, v203, v255
    ds_write2st64_b32 v234, v220, v221 offset0:16 offset1:17
    v_mul_f32 v197, v32, v168
    v_fmac_f32 v197, v33, v169
    ds_write2st64_b32 v235, v222, v223 offset0:18 offset1:19
    v_fmac_f32 v197, v34, v170
    v_fmac_f32 v197, v35, v171
    v_fmac_f32 v197, v36, v172
    ds_write2st64_b32 v235, v224, v225 offset0:20 offset1:21
    v_fmac_f32 v197, v37, v173
    v_fmac_f32 v197, v38, v174
    ds_write2st64_b32 v235, v226, v227 offset0:22 offset1:23
    v_fmac_f32 v197, v39, v175
    s_nop 1
    ds_write2st64_b32 v234, v228, v229 offset0:24 offset1:25
    v_permlane32_swap_b32 v199, v197
    v_add_f32 v197, v199, v197
    ds_write2st64_b32 v234, v230, v231 offset0:26 offset1:27
    v_cvt_pk_bf16_f32 v200, v200, v201
    v_cvt_pk_bf16_f32 v254, v254, v255
    v_cvt_pk_bf16_f32 v196, v196, v197
    ds_write2st64_b32 v234, v232, v233 offset0:28 offset1:29
    ds_write2st64_b32 v253, v192, v193 offset0:0 offset1:1
    ds_write2st64_b32 v253, v194, v200 offset0:2 offset1:3
    ds_write_b32 v253, v196 offset:1024
    s_mov_b64 exec, 0xffffffff
    ds_write_b32 v253, v254 offset:1280
    s_mov_b64 exec, -1
    s_add_u32 s50, s53, 1
    v_mov_b32 v234, s50
    ds_write2_b32 v251, v234, v234 offset0:0 offset1:8
    s_waitcnt lgkmcnt(15)
TAIL:
    s_and_b32 s71, s20, 3
    s_lshl_b32 s71, s71, 2
    s_bitcmp0_b32 s20, 2
    s_addc_u32 s71, s71, 0
    v_readlane_b32 s71, v191, s71
    buffer_load_dwordx4 v[120:123], v246, s[16:19], s68 offen offset:0 sc1
    buffer_load_dwordx4 v[124:127], v246, s[16:19], s68 offen offset:1024 sc1
    s_cmp_ge_u32 s71, s50
    s_setprio 1
    s_cbranch_scc1 T_second
    s_setprio 0
T_second:
    buffer_load_dwordx4 v[152:155], v246, s[16:19], s69 offen offset:0 sc1
    buffer_load_dwordx4 v[156:159], v246, s[16:19], s69 offen offset:1024 sc1
    buffer_load_dwordx4 v[168:171], v246, s[16:19], s70 offen offset:0 sc1
    buffer_load_dwordx4 v[172:175], v246, s[16:19], s70 offen offset:1024 sc1
GEMM:
    v_cmp_gt_u32 vcc, s53, v191
    v_xor_b32 v180, v179, v178
    v_xor_b32 v188, 4, v180
    v_lshl_add_u32 v66, v180, 4, v183
    v_lshl_add_u32 v67, v188, 4, v183
    v_lshl_add_u32 v70, v180, 4, v185
    v_lshl_add_u32 v71, v188, 4, v185
    s_mov_b32 s4, s72
    s_and_b32 s5, s73, 0xffff
    s_mov_b32 s6, 10240000
    s_mov_b32 s7, 0x20000
    s_cbranch_vccnz T_pw
T_pwr:
    ds_read_b128 v[76:79], v66 offset:0
    ds_read_b128 v[80:83], v70 offset:0
    ds_read_b128 v[84:87], v67 offset:0
    ds_read_b128 v[88:91], v71 offset:0
    ds_read_b128 v[92:95], v66 offset:1024
    s_waitcnt vmcnt(19) lgkmcnt(4)
    v_mfma_f32_16x16x32_bf16 v[0:3], v[96:99], v[76:79], 0
    v_and_b32 v181, 8, v177
    v_add_u32 v189, v188, v181
    ds_read_b128 v[76:79], v70 offset:1024
    s_waitcnt lgkmcnt(4)
    v_mfma_f32_16x16x32_bf16 v[4:7], v[96:99], v[80:83], 0
    v_add_u32 v181, v180, v181
    v_lshl_add_u32 v64, v180, 4, v182
    ds_read_b128 v[80:83], v67 offset:1024
    s_waitcnt vmcnt(18) lgkmcnt(4)
    v_mfma_f32_16x16x32_bf16 v[0:3], v[100:103], v[84:87], v[0:3]
    v_lshl_add_u32 v65, v188, 4, v182
    v_lshl_add_u32 v68, v180, 4, v184
    ds_read_b128 v[84:87], v71 offset:1024
    s_waitcnt lgkmcnt(4)
    v_mfma_f32_16x16x32_bf16 v[4:7], v[100:103], v[88:91], v[4:7]
    v_lshl_add_u32 v69, v188, 4, v184
    v_lshl_add_u32 v72, v181, 4, v186
    ds_read_b128 v[88:91], v66 offset:128
    s_waitcnt vmcnt(17) lgkmcnt(4)
    v_mfma_f32_16x16x32_bf16 v[0:3], v[104:107], v[92:95], v[0:3]
    v_lshl_add_u32 v73, v189, 4, v186
    v_lshl_add_u32 v74, v181, 4, v187
    ds_read_b128 v[92:95], v66 offset:256
    s_waitcnt lgkmcnt(4)
    v_mfma_f32_16x16x32_bf16 v[4:7], v[104:107], v[76:79], v[4:7]
    v_lshl_add_u32 v75, v189, 4, v187
    s_mov_b32 s67, 0xbfb8aa3b
    ds_read_b128 v[76:79], v66 offset:384
    s_waitcnt vmcnt(16) lgkmcnt(4)
    v_mfma_f32_16x16x32_bf16 v[0:3], v[108:111], v[80:83], v[0:3]
    v_lshrrev_b32 v205, 1, v178
    v_lshl_add_u32 v205, s20, 1, v205
    ds_read_b128 v[80:83], v70 offset:128
    s_waitcnt lgkmcnt(4)
    v_mfma_f32_16x16x32_bf16 v[4:7], v[108:111], v[84:87], v[4:7]
    v_xor_b32 v205, v205, v179
    v_and_b32 v204, 1, v178
    ds_read_b128 v[84:87], v70 offset:256
    s_waitcnt vmcnt(15) lgkmcnt(4)
    v_mfma_f32_16x16x32_bf16 v[12:15], v[128:131], v[88:91], 0
    v_lshlrev_b32 v204, 3, v204
    v_lshl_add_u32 v205, v205, 4, v204
    ds_read_b128 v[88:91], v70 offset:384
    s_waitcnt lgkmcnt(4)
    v_mfma_f32_16x16x32_bf16 v[24:27], v[128:131], v[92:95], 0
    v_and_b32 v220, 8, v177
    v_lshl_add_u32 v204, v220, 4, v205
    ds_read_b128 v[92:95], v67 offset:128
    s_waitcnt lgkmcnt(4)
    v_mfma_f32_16x16x32_bf16 v[36:39], v[128:131], v[76:79], 0
    v_lshl_add_u32 v204, v177, 10, v204
    v_add_u32 v204, 65536, v204
    ds_read_b128 v[76:79], v67 offset:256
    s_waitcnt lgkmcnt(4)
    v_mfma_f32_16x16x32_bf16 v[16:19], v[128:131], v[80:83], 0
    v_add_u32 v205, v205, v182
    v_mul_u32_u24 v220, 1008, v220
    ds_read_b128 v[80:83], v67 offset:384
    s_waitcnt lgkmcnt(4)
    v_mfma_f32_16x16x32_bf16 v[28:31], v[128:131], v[84:87], 0
    v_sub_u32 v220, v204, v220
    s_lshl_b32 s70, s20, 4
    ds_read_b128 v[84:87], v71 offset:128
    s_waitcnt lgkmcnt(4)
    v_mfma_f32_16x16x32_bf16 v[40:43], v[128:131], v[88:91], 0
    v_xor_b32 v206, s70, v246
    s_lshl_b32 s70, s20, 10
    ds_read_b128 v[88:91], v71 offset:256
    s_waitcnt vmcnt(14) lgkmcnt(4)
    v_mfma_f32_16x16x32_bf16 v[12:15], v[132:135], v[92:95], v[12:15]
    s_add_u32 s70, s70, 65536
    v_add_u32 v207, s21, v206
    ds_read_b128 v[92:95], v71 offset:384
    s_waitcnt lgkmcnt(4)
    v_mfma_f32_16x16x32_bf16 v[24:27], v[132:135], v[76:79], v[24:27]
    v_add_u32 v206, s70, v206
    s_mul_i32 s66, s2, 40960
    ds_read_b128 v[76:79], v66 offset:512
    s_waitcnt lgkmcnt(4)
    v_mfma_f32_16x16x32_bf16 v[36:39], v[132:135], v[80:83], v[36:39]
    s_bfe_u32 s22, s22, 393237
    s_lshl_b32 s22, s22, 10
    ds_read_b128 v[80:83], v66 offset:640
    s_waitcnt lgkmcnt(4)
    v_mfma_f32_16x16x32_bf16 v[16:19], v[132:135], v[84:87], v[16:19]
    s_add_u32 s22, s22, s66
    s_bfe_u32 s23, s23, 393237
    ds_read_b128 v[84:87], v66 offset:768
    s_waitcnt lgkmcnt(4)
    v_mfma_f32_16x16x32_bf16 v[28:31], v[132:135], v[88:91], v[28:31]
    s_lshl_b32 s23, s23, 10
    s_add_u32 s23, s23, s66
    ds_read_b128 v[88:91], v70 offset:512
    s_waitcnt lgkmcnt(4)
    v_mfma_f32_16x16x32_bf16 v[40:43], v[132:135], v[92:95], v[40:43]
    s_bfe_u32 s24, s24, 393237
    s_lshl_b32 s24, s24, 10
    ds_read_b128 v[92:95], v70 offset:640
    s_waitcnt vmcnt(13) lgkmcnt(4)
    v_mfma_f32_16x16x32_bf16 v[12:15], v[136:139], v[76:79], v[12:15]
    s_add_u32 s24, s24, s66
    s_bfe_u32 s25, s25, 393237
    ds_read_b128 v[76:79], v70 offset:768
    s_waitcnt lgkmcnt(4)
    v_mfma_f32_16x16x32_bf16 v[24:27], v[136:139], v[80:83], v[24:27]
    s_lshl_b32 s25, s25, 10
    s_add_u32 s25, s25, s66
    ds_read_b128 v[80:83], v67 offset:512
    s_waitcnt lgkmcnt(4)
    v_mfma_f32_16x16x32_bf16 v[36:39], v[136:139], v[84:87], v[36:39]
    s_bfe_u32 s26, s26, 393237
    s_lshl_b32 s26, s26, 10
    ds_read_b128 v[84:87], v67 offset:640
    s_waitcnt lgkmcnt(4)
    v_mfma_f32_16x16x32_bf16 v[16:19], v[136:139], v[88:91], v[16:19]
    s_add_u32 s26, s26, s66
    ds_read_b128 v[88:91], v67 offset:768
    s_waitcnt lgkmcnt(4)
    v_mfma_f32_16x16x32_bf16 v[28:31], v[136:139], v[92:95], v[28:31]
    ds_read_b128 v[92:95], v71 offset:512
    s_waitcnt lgkmcnt(4)
    v_mfma_f32_16x16x32_bf16 v[40:43], v[136:139], v[76:79], v[40:43]
    ds_read_b128 v[76:79], v71 offset:640
    s_waitcnt vmcnt(12) lgkmcnt(4)
    v_mfma_f32_16x16x32_bf16 v[12:15], v[140:143], v[80:83], v[12:15]
    ds_read_b128 v[80:83], v71 offset:768
    s_waitcnt lgkmcnt(4)
    v_mfma_f32_16x16x32_bf16 v[24:27], v[140:143], v[84:87], v[24:27]
    ds_read_b128 v[84:87], v66 offset:1152
    s_waitcnt lgkmcnt(4)
    v_mfma_f32_16x16x32_bf16 v[36:39], v[140:143], v[88:91], v[36:39]
    ds_read_b128 v[88:91], v66 offset:1280
    s_waitcnt lgkmcnt(4)
    v_mfma_f32_16x16x32_bf16 v[16:19], v[140:143], v[92:95], v[16:19]
    ds_read_b128 v[92:95], v66 offset:896
    s_waitcnt lgkmcnt(4)
    v_mfma_f32_16x16x32_bf16 v[28:31], v[140:143], v[76:79], v[28:31]
    ds_read_b128 v[76:79], v70 offset:1152
    s_waitcnt lgkmcnt(4)
    v_mfma_f32_16x16x32_bf16 v[40:43], v[140:143], v[80:83], v[40:43]
    ds_read_b128 v[80:83], v70 offset:1280
    s_waitcnt vmcnt(11) lgkmcnt(4)
    v_mfma_f32_16x16x32_bf16 v[12:15], v[112:115], v[84:87], v[12:15]
    ds_read_b128 v[84:87], v70 offset:896
    s_waitcnt lgkmcnt(4)
    v_mfma_f32_16x16x32_bf16 v[24:27], v[112:115], v[88:91], v[24:27]
    ds_read_b128 v[88:91], v67 offset:1152
    s_waitcnt lgkmcnt(4)
    v_mfma_f32_16x16x32_bf16 v[36:39], v[112:115], v[92:95], v[36:39]
    ds_read_b128 v[92:95], v67 offset:1280
    s_waitcnt lgkmcnt(4)
    v_mfma_f32_16x16x32_bf16 v[16:19], v[112:115], v[76:79], v[16:19]
    ds_read_b128 v[76:79], v67 offset:896
    s_waitcnt lgkmcnt(4)
    v_mfma_f32_16x16x32_bf16 v[28:31], v[112:115], v[80:83], v[28:31]
    ds_read_b32 v191, v190
    ds_read_b128 v[80:83], v71 offset:1152
    s_waitcnt lgkmcnt(5)
    v_mfma_f32_16x16x32_bf16 v[40:43], v[112:115], v[84:87], v[40:43]
    ds_read_b128 v[84:87], v71 offset:1280
    s_waitcnt vmcnt(10) lgkmcnt(5)
    v_mfma_f32_16x16x32_bf16 v[12:15], v[116:119], v[88:91], v[12:15]
    ds_read_b128 v[88:91], v71 offset:896
    s_waitcnt lgkmcnt(5)
    v_mfma_f32_16x16x32_bf16 v[24:27], v[116:119], v[92:95], v[24:27]
    s_waitcnt lgkmcnt(3)
    v_cmp_gt_u32 vcc, s50, v191
    s_cbranch_vccnz T_aw
T_awr:
    ds_read_b128 v[92:95], v64 offset:0
    v_mfma_f32_16x16x32_bf16 v[36:39], v[116:119], v[76:79], v[36:39]
    ds_read_b128 v[76:79], v68 offset:0
    s_waitcnt lgkmcnt(4)
    v_mfma_f32_16x16x32_bf16 v[16:19], v[116:119], v[80:83], v[16:19]
    ds_read_b128 v[80:83], v65 offset:0
    s_waitcnt lgkmcnt(4)
    v_mfma_f32_16x16x32_bf16 v[28:31], v[116:119], v[84:87], v[28:31]
    ds_read_b128 v[84:87], v69 offset:0
    s_waitcnt lgkmcnt(4)
    v_mfma_f32_16x16x32_bf16 v[40:43], v[116:119], v[88:91], v[40:43]
    ds_read_b128 v[88:91], v64 offset:1024
    s_waitcnt vmcnt(9) lgkmcnt(4)
    v_mfma_f32_16x16x32_bf16 v[0:3], v[144:147], v[92:95], v[0:3]
    ds_read_b128 v[92:95], v68 offset:1024
    s_waitcnt lgkmcnt(4)
    v_mfma_f32_16x16x32_bf16 v[4:7], v[144:147], v[76:79], v[4:7]
    ds_read_b128 v[76:79], v65 offset:1024
    s_waitcnt vmcnt(8) lgkmcnt(4)
    v_mfma_f32_16x16x32_bf16 v[0:3], v[148:151], v[80:83], v[0:3]
    ds_read_b128 v[80:83], v69 offset:1024
    s_waitcnt lgkmcnt(4)
    v_mfma_f32_16x16x32_bf16 v[4:7], v[148:151], v[84:87], v[4:7]
    ds_read_b128 v[84:87], v72 offset:0
    s_waitcnt vmcnt(7) lgkmcnt(4)
    v_mfma_f32_16x16x32_bf16 v[0:3], v[160:163], v[88:91], v[0:3]
    ds_read_b128 v[88:91], v73 offset:0
    s_waitcnt lgkmcnt(4)
    v_mfma_f32_16x16x32_bf16 v[4:7], v[160:163], v[92:95], v[4:7]
    ds_read_b128 v[92:95], v74 offset:0
    s_waitcnt vmcnt(6) lgkmcnt(4)
    v_mfma_f32_16x16x32_bf16 v[0:3], v[164:167], v[76:79], v[0:3]
    ds_read_b128 v[76:79], v75 offset:0
    s_waitcnt lgkmcnt(4)
    v_mfma_f32_16x16x32_bf16 v[4:7], v[164:167], v[80:83], v[4:7]
    ds_read_b128 v[80:83], v72 offset:1024
    s_waitcnt lgkmcnt(4)
    v_mfma_f32_16x16x32_bf16 v[8:11], v[144:147], v[84:87], 0
    ds_read_b128 v[84:87], v73 offset:1024
    s_waitcnt lgkmcnt(4)
    v_mfma_f32_16x16x32_bf16 v[8:11], v[148:151], v[88:91], v[8:11]
    v_mul_f32 v192, s67, v0
    v_mul_f32 v193, s67, v1
    ds_read_b128 v[88:91], v74 offset:1024
    s_waitcnt lgkmcnt(4)
    v_mfma_f32_16x16x32_bf16 v[8:11], v[96:99], v[92:95], v[8:11]
    v_mul_f32 v194, s67, v2
    v_mul_f32 v195, s67, v3
    ds_read_b128 v[92:95], v75 offset:1024
    s_waitcnt lgkmcnt(4)
    v_mfma_f32_16x16x32_bf16 v[8:11], v[100:103], v[76:79], v[8:11]
    v_exp_f32 v192, v192
    v_exp_f32 v193, v193
    ds_read_b128 v[76:79], v64 offset:128
    s_waitcnt lgkmcnt(4)
    v_mfma_f32_16x16x32_bf16 v[8:11], v[160:163], v[80:83], v[8:11]
    v_exp_f32 v194, v194
    v_exp_f32 v195, v195
    ds_read_b128 v[80:83], v65 offset:128
    s_waitcnt lgkmcnt(4)
    v_mfma_f32_16x16x32_bf16 v[8:11], v[164:167], v[84:87], v[8:11]
    v_add_f32 v192, 1.0, v192
    v_add_f32 v193, 1.0, v193
    ds_read_b128 v[84:87], v64 offset:512
    s_waitcnt lgkmcnt(4)
    v_mfma_f32_16x16x32_bf16 v[8:11], v[104:107], v[88:91], v[8:11]
    v_add_f32 v194, 1.0, v194
    v_add_f32 v195, 1.0, v195
    ds_read_b128 v[88:91], v65 offset:512
    s_waitcnt lgkmcnt(4)
    v_mfma_f32_16x16x32_bf16 v[8:11], v[108:111], v[92:95], v[8:11]
    v_rcp_f32 v192, v192
    v_rcp_f32 v193, v193
    ds_read_b128 v[92:95], v64 offset:1152
    s_waitcnt vmcnt(5) lgkmcnt(4)
    v_mfma_f32_16x16x32_bf16 v[12:15], v[120:123], v[76:79], v[12:15]
    v_rcp_f32 v194, v194
    v_rcp_f32 v195, v195
    ds_read_b128 v[76:79], v65 offset:1152
    s_waitcnt vmcnt(4) lgkmcnt(4)
    v_mfma_f32_16x16x32_bf16 v[12:15], v[124:127], v[80:83], v[12:15]
    v_cvt_pk_bf16_f32 v0, v0, v1
    v_cvt_pk_bf16_f32 v1, v2, v3
    ds_read_b128 v[80:83], v64 offset:256
    s_waitcnt vmcnt(3) lgkmcnt(4)
    v_mfma_f32_16x16x32_bf16 v[12:15], v[152:155], v[84:87], v[12:15]
    ds_write_b64 v204, v[0:1] offset:0
    v_mul_f32 v196, s67, v4
    ds_read_b128 v[84:87], v65 offset:256
    s_waitcnt vmcnt(2) lgkmcnt(5)
    v_mfma_f32_16x16x32_bf16 v[12:15], v[156:159], v[88:91], v[12:15]
    v_mul_f32 v197, s67, v5
    v_mul_f32 v198, s67, v6
    ds_read_b128 v[88:91], v64 offset:640
    s_waitcnt vmcnt(1) lgkmcnt(5)
    v_mfma_f32_16x16x32_bf16 v[12:15], v[168:171], v[92:95], v[12:15]
    v_mul_f32 v199, s67, v7
    v_exp_f32 v196, v196
    ds_read_b128 v[92:95], v65 offset:640
    s_waitcnt vmcnt(0) lgkmcnt(5)
    v_mfma_f32_16x16x32_bf16 v[12:15], v[172:175], v[76:79], v[12:15]
    v_exp_f32 v197, v197
    v_exp_f32 v198, v198
    ds_read_b128 v[76:79], v64 offset:1280
    s_waitcnt lgkmcnt(5)
    v_mfma_f32_16x16x32_bf16 v[24:27], v[120:123], v[80:83], v[24:27]
    v_exp_f32 v199, v199
    v_add_f32 v196, 1.0, v196
    ds_read_b128 v[80:83], v65 offset:1280
    s_waitcnt lgkmcnt(4)
    v_mfma_f32_16x16x32_bf16 v[24:27], v[124:127], v[84:87], v[24:27]
    v_mul_f32 v12, v12, v192
    v_mul_f32 v13, v13, v193
    ds_read_b128 v[84:87], v64 offset:384
    s_waitcnt lgkmcnt(4)
    v_mfma_f32_16x16x32_bf16 v[24:27], v[152:155], v[88:91], v[24:27]
    v_mul_f32 v14, v14, v194
    v_mul_f32 v15, v15, v195
    ds_read_b128 v[88:91], v65 offset:384
    s_waitcnt lgkmcnt(4)
    v_mfma_f32_16x16x32_bf16 v[24:27], v[156:159], v[92:95], v[24:27]
    v_cvt_pk_bf16_f32 v12, v12, v13
    v_cvt_pk_bf16_f32 v13, v14, v15
    ds_read_b128 v[92:95], v64 offset:768
    s_waitcnt lgkmcnt(4)
    v_mfma_f32_16x16x32_bf16 v[24:27], v[168:171], v[76:79], v[24:27]
    ds_write_b64 v204, v[12:13] offset:256
    v_add_f32 v197, 1.0, v197
    ds_read_b128 v[76:79], v65 offset:768
    s_waitcnt lgkmcnt(5)
    v_mfma_f32_16x16x32_bf16 v[24:27], v[172:175], v[80:83], v[24:27]
    v_add_f32 v198, 1.0, v198
    v_add_f32 v199, 1.0, v199
    ds_read_b128 v[80:83], v64 offset:896
    s_waitcnt lgkmcnt(5)
    v_mfma_f32_16x16x32_bf16 v[36:39], v[120:123], v[84:87], v[36:39]
    v_rcp_f32 v196, v196
    v_rcp_f32 v197, v197
    ds_read_b128 v[84:87], v65 offset:896
    s_waitcnt lgkmcnt(5)
    v_mfma_f32_16x16x32_bf16 v[36:39], v[124:127], v[88:91], v[36:39]
    v_rcp_f32 v198, v198
    v_rcp_f32 v199, v199
    ds_read_b128 v[88:91], v68 offset:128
    s_waitcnt lgkmcnt(5)
    v_mfma_f32_16x16x32_bf16 v[36:39], v[152:155], v[92:95], v[36:39]
    v_mul_f32 v24, v24, v192
    v_mul_f32 v25, v25, v193
    ds_read_b128 v[92:95], v69 offset:128
    s_waitcnt lgkmcnt(4)
    v_mfma_f32_16x16x32_bf16 v[36:39], v[156:159], v[76:79], v[36:39]
    v_mul_f32 v26, v26, v194
    v_mul_f32 v27, v27, v195
    ds_read_b128 v[76:79], v68 offset:512
    s_waitcnt lgkmcnt(4)
    v_mfma_f32_16x16x32_bf16 v[36:39], v[168:171], v[80:83], v[36:39]
    v_cvt_pk_bf16_f32 v24, v24, v25
    v_cvt_pk_bf16_f32 v25, v26, v27
    ds_read_b128 v[80:83], v69 offset:512
    s_waitcnt lgkmcnt(4)
    v_mfma_f32_16x16x32_bf16 v[36:39], v[172:175], v[84:87], v[36:39]
    ds_write_b64 v204, v[24:25] offset:512
    v_mul_f32 v200, s67, v8
    ds_read_b128 v[84:87], v68 offset:1152
    s_waitcnt lgkmcnt(5)
    v_mfma_f32_16x16x32_bf16 v[16:19], v[120:123], v[88:91], v[16:19]
    v_mul_f32 v201, s67, v9
    v_mul_f32 v202, s67, v10
    ds_read_b128 v[88:91], v69 offset:1152
    s_waitcnt lgkmcnt(5)
    v_mfma_f32_16x16x32_bf16 v[16:19], v[124:127], v[92:95], v[16:19]
    v_mul_f32 v203, s67, v11
    v_exp_f32 v200, v200
    ds_read_b128 v[92:95], v68 offset:256
    s_waitcnt lgkmcnt(5)
    v_mfma_f32_16x16x32_bf16 v[16:19], v[152:155], v[76:79], v[16:19]
    v_mul_f32 v36, v36, v192
    v_mul_f32 v37, v37, v193
    ds_read_b128 v[76:79], v69 offset:256
    s_waitcnt lgkmcnt(5)
    v_mfma_f32_16x16x32_bf16 v[16:19], v[156:159], v[80:83], v[16:19]
    v_mul_f32 v38, v38, v194
    v_mul_f32 v39, v39, v195
    ds_read_b128 v[80:83], v68 offset:640
    s_waitcnt lgkmcnt(4)
    v_mfma_f32_16x16x32_bf16 v[16:19], v[168:171], v[84:87], v[16:19]
    v_cvt_pk_bf16_f32 v36, v36, v37
    v_cvt_pk_bf16_f32 v37, v38, v39
    ds_read_b128 v[84:87], v69 offset:640
    s_waitcnt lgkmcnt(4)
    v_mfma_f32_16x16x32_bf16 v[16:19], v[172:175], v[88:91], v[16:19]
    ds_write_b64 v204, v[36:37] offset:768
    v_exp_f32 v201, v201
    ds_read_b128 v[88:91], v68 offset:1280
    s_waitcnt lgkmcnt(5)
    v_mfma_f32_16x16x32_bf16 v[28:31], v[120:123], v[92:95], v[28:31]
    v_exp_f32 v202, v202
    v_exp_f32 v203, v203
    ds_read_b128 v[92:95], v69 offset:1280
    s_waitcnt lgkmcnt(5)
    v_mfma_f32_16x16x32_bf16 v[28:31], v[124:127], v[76:79], v[28:31]
    v_add_f32 v200, 1.0, v200
    v_add_f32 v201, 1.0, v201
    ds_read_b128 v[76:79], v68 offset:384
    s_waitcnt lgkmcnt(5)
    v_mfma_f32_16x16x32_bf16 v[28:31], v[152:155], v[80:83], v[28:31]
    v_add_f32 v202, 1.0, v202
    v_add_f32 v203, 1.0, v203
    ds_read_b128 v[80:83], v69 offset:384
    s_waitcnt lgkmcnt(5)
    v_mfma_f32_16x16x32_bf16 v[28:31], v[156:159], v[84:87], v[28:31]
    v_rcp_f32 v200, v200
    v_rcp_f32 v201, v201
    ds_read_b128 v[84:87], v68 offset:768
    s_waitcnt lgkmcnt(4)
    v_mfma_f32_16x16x32_bf16 v[28:31], v[168:171], v[88:91], v[28:31]
    v_rcp_f32 v202, v202
    v_rcp_f32 v203, v203
    ds_read_b128 v[88:91], v69 offset:768
    s_waitcnt lgkmcnt(4)
    v_mfma_f32_16x16x32_bf16 v[28:31], v[172:175], v[92:95], v[28:31]
    v_mov_b32_dpp v200, v200 row_ror:8 row_mask:0xf bank_mask:0xc
    ds_read_b128 v[92:95], v68 offset:896
    s_waitcnt lgkmcnt(4)
    v_mfma_f32_16x16x32_bf16 v[40:43], v[120:123], v[76:79], v[40:43]
    v_mov_b32_dpp v201, v201 row_ror:8 row_mask:0xf bank_mask:0xc
    v_mov_b32_dpp v202, v202 row_ror:8 row_mask:0xf bank_mask:0xc
    ds_read_b128 v[76:79], v69 offset:896
    s_waitcnt lgkmcnt(4)
    v_mfma_f32_16x16x32_bf16 v[40:43], v[124:127], v[80:83], v[40:43]
    v_mov_b32_dpp v203, v203 row_ror:8 row_mask:0xf bank_mask:0xc
    ds_read_b128 v[80:83], v72 offset:128
    s_waitcnt lgkmcnt(4)
    v_mfma_f32_16x16x32_bf16 v[40:43], v[152:155], v[84:87], v[40:43]
    s_barrier
    ds_read_b128 v[212:215], v206 offset:0
    ds_read_b128 v[84:87], v73 offset:128
    s_waitcnt lgkmcnt(5)
    v_mfma_f32_16x16x32_bf16 v[40:43], v[156:159], v[88:91], v[40:43]
    ds_read_b128 v[216:219], v206 offset:8320
    v_cvt_pk_bf16_f32 v4, v4, v5
    ds_read_b128 v[88:91], v74 offset:128
    s_waitcnt lgkmcnt(6)
    v_mfma_f32_16x16x32_bf16 v[40:43], v[168:171], v[92:95], v[40:43]
    v_cvt_pk_bf16_f32 v5, v6, v7
    ds_write_b64 v205, v[4:5] offset:0
    ds_read_b128 v[92:95], v75 offset:128
    s_waitcnt lgkmcnt(7)
    v_mfma_f32_16x16x32_bf16 v[40:43], v[172:175], v[76:79], v[40:43]
    v_mul_f32 v16, v16, v196
    v_mul_f32 v17, v17, v197
    ds_read_b128 v[76:79], v72 offset:512
    s_waitcnt lgkmcnt(7)
    v_mfma_f32_16x16x32_bf16 v[20:23], v[120:123], v[80:83], 0
    v_mul_f32 v18, v18, v198
    v_mul_f32 v19, v19, v199
    ds_read_b128 v[80:83], v73 offset:512
    s_waitcnt lgkmcnt(6)
    v_mfma_f32_16x16x32_bf16 v[20:23], v[124:127], v[84:87], v[20:23]
    v_cvt_pk_bf16_f32 v16, v16, v17
    v_cvt_pk_bf16_f32 v17, v18, v19
    ds_read_b128 v[84:87], v74 offset:512
    s_waitcnt lgkmcnt(5)
    v_mfma_f32_16x16x32_bf16 v[20:23], v[128:131], v[88:91], v[20:23]
    ds_write_b64 v205, v[16:17] offset:256
    ds_read_b128 v[88:91], v75 offset:512
    s_waitcnt lgkmcnt(5)
    v_mfma_f32_16x16x32_bf16 v[20:23], v[132:135], v[92:95], v[20:23]
    buffer_store_dwordx4 v[212:215], v246, s[4:7], s22 offen sc1
    ds_read_b128 v[92:95], v72 offset:1152
    s_waitcnt lgkmcnt(5)
    v_mfma_f32_16x16x32_bf16 v[20:23], v[152:155], v[76:79], v[20:23]
    buffer_store_dwordx4 v[216:219], v246, s[4:7], s23 offen sc1
    v_mul_f32 v28, v28, v196
    ds_read_b128 v[76:79], v73 offset:1152
    s_waitcnt lgkmcnt(5)
    v_mfma_f32_16x16x32_bf16 v[20:23], v[156:159], v[80:83], v[20:23]
    v_mul_f32 v29, v29, v197
    v_mul_f32 v30, v30, v198
    ds_read_b128 v[80:83], v74 offset:1152
    s_waitcnt lgkmcnt(5)
    v_mfma_f32_16x16x32_bf16 v[20:23], v[136:139], v[84:87], v[20:23]
    v_mul_f32 v31, v31, v199
    v_cvt_pk_bf16_f32 v28, v28, v29
    ds_read_b128 v[84:87], v75 offset:1152
    s_waitcnt lgkmcnt(4)
    v_mfma_f32_16x16x32_bf16 v[20:23], v[140:143], v[88:91], v[20:23]
    v_cvt_pk_bf16_f32 v29, v30, v31
    ds_write_b64 v205, v[28:29] offset:512
    ds_read_b128 v[88:91], v72 offset:384
    s_waitcnt lgkmcnt(5)
    v_mfma_f32_16x16x32_bf16 v[20:23], v[168:171], v[92:95], v[20:23]
    v_mul_f32 v40, v40, v196
    v_mul_f32 v41, v41, v197
    ds_read_b128 v[92:95], v73 offset:384
    s_waitcnt lgkmcnt(5)
    v_mfma_f32_16x16x32_bf16 v[20:23], v[172:175], v[76:79], v[20:23]
    v_mul_f32 v42, v42, v198
    v_mul_f32 v43, v43, v199
    ds_read_b128 v[76:79], v74 offset:384
    s_waitcnt lgkmcnt(5)
    v_mfma_f32_16x16x32_bf16 v[20:23], v[112:115], v[80:83], v[20:23]
    v_cvt_pk_bf16_f32 v40, v40, v41
    v_cvt_pk_bf16_f32 v41, v42, v43
    ds_read_b128 v[80:83], v75 offset:384
    s_waitcnt lgkmcnt(5)
    v_mfma_f32_16x16x32_bf16 v[20:23], v[116:119], v[84:87], v[20:23]
    ds_write_b64 v205, v[40:41] offset:768
    ds_read_b128 v[84:87], v72 offset:768
    s_waitcnt lgkmcnt(5)
    v_mfma_f32_16x16x32_bf16 v[44:47], v[120:123], v[88:91], 0
    ds_read_b128 v[88:91], v73 offset:768
    s_waitcnt lgkmcnt(5)
    v_mfma_f32_16x16x32_bf16 v[44:47], v[124:127], v[92:95], v[44:47]
    s_waitcnt lgkmcnt(2)
    s_barrier
    ds_read_b128 v[92:95], v74 offset:768
    v_mfma_f32_16x16x32_bf16 v[44:47], v[128:131], v[76:79], v[44:47]
    ds_read_b128 v[212:215], v207 offset:0
    ds_read_b128 v[216:219], v207 offset:1664
    ds_read_b128 v[76:79], v75 offset:768
    v_mfma_f32_16x16x32_bf16 v[44:47], v[132:135], v[80:83], v[44:47]
    ds_read_b128 v[80:83], v72 offset:896
    s_waitcnt lgkmcnt(6)
    v_mfma_f32_16x16x32_bf16 v[44:47], v[152:155], v[84:87], v[44:47]
    ds_read_b128 v[84:87], v73 offset:896
    s_waitcnt lgkmcnt(6)
    v_mfma_f32_16x16x32_bf16 v[44:47], v[156:159], v[88:91], v[44:47]
    ds_read_b128 v[88:91], v74 offset:896
    s_waitcnt lgkmcnt(6)
    v_mfma_f32_16x16x32_bf16 v[44:47], v[136:139], v[92:95], v[44:47]
    s_waitcnt lgkmcnt(5)
    buffer_store_dwordx4 v[212:215], v246, s[4:7], s24 offen sc1
    ds_read_b128 v[92:95], v75 offset:896
    s_waitcnt lgkmcnt(4)
    v_mfma_f32_16x16x32_bf16 v[44:47], v[140:143], v[76:79], v[44:47]
    buffer_store_dwordx4 v[216:219], v246, s[4:7], s25 offen sc1
    s_waitcnt lgkmcnt(3)
    v_mfma_f32_16x16x32_bf16 v[44:47], v[168:171], v[80:83], v[44:47]
    v_cvt_pk_bf16_f32 v8, v8, v9
    v_cvt_pk_bf16_f32 v9, v10, v11
    s_waitcnt lgkmcnt(2)
    v_mfma_f32_16x16x32_bf16 v[44:47], v[172:175], v[84:87], v[44:47]
    ds_write_b64 v204, v[8:9] offset:0
    v_mul_f32 v20, v20, v200
    s_waitcnt lgkmcnt(2)
    v_mfma_f32_16x16x32_bf16 v[44:47], v[112:115], v[88:91], v[44:47]
    v_mul_f32 v21, v21, v201
    v_mul_f32 v22, v22, v202
    s_waitcnt lgkmcnt(1)
    v_mfma_f32_16x16x32_bf16 v[44:47], v[116:119], v[92:95], v[44:47]
    v_mul_f32 v23, v23, v203
    v_cvt_pk_bf16_f32 v20, v20, v21
    v_cvt_pk_bf16_f32 v21, v22, v23
    ds_write_b64 v220, v[20:21] offset:256
    s_nop 3
    v_mul_f32 v44, v44, v200
    v_mul_f32 v45, v45, v201
    v_mul_f32 v46, v46, v202
    v_mul_f32 v47, v47, v203
    v_cvt_pk_bf16_f32 v44, v44, v45
    v_cvt_pk_bf16_f32 v45, v46, v47
    ds_write_b64 v204, v[44:45] offset:768
    s_waitcnt lgkmcnt(0)
    s_barrier
    ds_read_b128 v[212:215], v206 offset:0
    s_waitcnt lgkmcnt(0)
    buffer_store_dwordx4 v[212:215], v246, s[4:7], s26 offen sc1
    s_or_b32 s89, s89, s20
    s_cbranch_scc1 K2_end
    v_mov_b32 v0, 0
    v_mov_b32 v1, s88
    s_mov_b64 exec, 1
    buffer_store_dword v1, v0, s[16:19], 0 offen
    s_endpgm
T_pw:
    ds_read_b32 v191, v190
    s_waitcnt lgkmcnt(0)
    v_cmp_gt_u32 vcc, s53, v191
    s_cbranch_vccnz T_pw
    s_branch T_pwr
T_aw:
    ds_read_b32 v191, v190
    s_waitcnt lgkmcnt(0)
    v_cmp_gt_u32 vcc, s50, v191
    s_cbranch_vccnz T_aw
    s_branch T_awr
K2_end:
K2_last:
    s_endpgm
SLOW:
    v_readlane_b32 s89, v4, 62
    s_waitcnt vmcnt(0) lgkmcnt(0)
    s_barrier
    s_load_dwordx2 s[22:23], s[0:1], 8
    s_load_dwordx2 s[24:25], s[0:1], 24
    s_load_dwordx2 s[26:27], s[0:1], 32
    s_load_dwordx2 s[28:29], s[0:1], 40
    s_load_dwordx2 s[30:31], s[0:1], 0
    v_mbcnt_lo_u32_b32 v240, -1, 0
    v_mbcnt_hi_u32_b32 v240, -1, v240
    v_lshrrev_b32 v229, 5, v240
    v_and_b32 v230, 31, v240
    v_lshlrev_b32 v241, 7, v229
    v_lshl_add_u32 v241, v230, 1, v241
    v_lshlrev_b32 v245, 4, v240
    v_mov_b32 v242, 0
    s_waitcnt lgkmcnt(0)
    s_mov_b32 s80, s22
    s_and_b32 s81, s23, 0xffff
    s_mov_b32 s82, 1920000
    s_mov_b32 s83, 0x20000
    s_mov_b32 s76, s24
    s_and_b32 s77, s25, 0xffff
    s_mov_b32 s78, 1280000
    s_mov_b32 s79, 0x20000
    s_mov_b32 s72, s26
    s_and_b32 s73, s27, 0xffff
    s_mov_b32 s74, 1280000
    s_mov_b32 s75, 0x20000
    s_mov_b32 s84, s28
    s_and_b32 s85, s29, 0xffff
    s_mov_b32 s86, 20480
    s_mov_b32 s87, 0x20000
    s_mov_b32 s4, s30
    s_and_b32 s5, s31, 0xffff
    s_mov_b32 s6, 10240000
    s_mov_b32 s7, 0x20000
    s_mov_b32 s66, 0
    buffer_load_ushort v0, v241, s[84:87], s66 offen offset:0
    buffer_load_ushort v1, v241, s[84:87], s66 offen offset:64
    buffer_load_ushort v2, v241, s[84:87], s66 offen offset:256
    buffer_load_ushort v3, v241, s[84:87], s66 offen offset:320
    buffer_load_ushort v4, v241, s[84:87], s66 offen offset:512
    buffer_load_ushort v5, v241, s[84:87], s66 offen offset:576
    buffer_load_ushort v6, v241, s[84:87], s66 offen offset:768
    buffer_load_ushort v7, v241, s[84:87], s66 offen offset:832
    buffer_load_ushort v8, v241, s[84:87], s66 offen offset:1024
    buffer_load_ushort v9, v241, s[84:87], s66 offen offset:1088
    s_waitcnt vmcnt(0)
    s_mov_b32 s66, 1280
    buffer_load_ushort v10, v241, s[84:87], s66 offen offset:0
    buffer_load_ushort v11, v241, s[84:87], s66 offen offset:64
    buffer_load_ushort v12, v241, s[84:87], s66 offen offset:256
    buffer_load_ushort v13, v241, s[84:87], s66 offen offset:320
    buffer_load_ushort v14, v241, s[84:87], s66 offen offset:512
    buffer_load_ushort v15, v241, s[84:87], s66 offen offset:576
    buffer_load_ushort v16, v241, s[84:87], s66 offen offset:768
    buffer_load_ushort v17, v241, s[84:87], s66 offen offset:832
    buffer_load_ushort v18, v241, s[84:87], s66 offen offset:1024
    buffer_load_ushort v19, v241, s[84:87], s66 offen offset:1088
    s_waitcnt vmcnt(0)
    s_mov_b32 s66, 2560
    buffer_load_ushort v20, v241, s[84:87], s66 offen offset:0
    buffer_load_ushort v21, v241, s[84:87], s66 offen offset:64
    buffer_load_ushort v22, v241, s[84:87], s66 offen offset:256
    buffer_load_ushort v23, v241, s[84:87], s66 offen offset:320
    buffer_load_ushort v24, v241, s[84:87], s66 offen offset:512
    buffer_load_ushort v25, v241, s[84:87], s66 offen offset:576
    buffer_load_ushort v26, v241, s[84:87], s66 offen offset:768
    buffer_load_ushort v27, v241, s[84:87], s66 offen offset:832
    buffer_load_ushort v28, v241, s[84:87], s66 offen offset:1024
    buffer_load_ushort v29, v241, s[84:87], s66 offen offset:1088
    s_waitcnt vmcnt(0)
    s_mov_b32 s66, 3840
    buffer_load_ushort v30, v241, s[84:87], s66 offen offset:0
    buffer_load_ushort v31, v241, s[84:87], s66 offen offset:64
    buffer_load_ushort v32, v241, s[84:87], s66 offen offset:256
    buffer_load_ushort v33, v241, s[84:87], s66 offen offset:320
    buffer_load_ushort v34, v241, s[84:87], s66 offen offset:512
    buffer_load_ushort v35, v241, s[84:87], s66 offen offset:576
    buffer_load_ushort v36, v241, s[84:87], s66 offen offset:768
    buffer_load_ushort v37, v241, s[84:87], s66 offen offset:832
    buffer_load_ushort v38, v241, s[84:87], s66 offen offset:1024
    buffer_load_ushort v39, v241, s[84:87], s66 offen offset:1088
    s_waitcnt vmcnt(0)
    s_mov_b32 s66, 5120
    buffer_load_ushort v40, v241, s[84:87], s66 offen offset:0
    buffer_load_ushort v41, v241, s[84:87], s66 offen offset:64
    buffer_load_ushort v42, v241, s[84:87], s66 offen offset:256
    buffer_load_ushort v43, v241, s[84:87], s66 offen offset:320
    buffer_load_ushort v44, v241, s[84:87], s66 offen offset:512
    buffer_load_ushort v45, v241, s[84:87], s66 offen offset:576
    buffer_load_ushort v46, v241, s[84:87], s66 offen offset:768
    buffer_load_ushort v47, v241, s[84:87], s66 offen offset:832
    buffer_load_ushort v48, v241, s[84:87], s66 offen offset:1024
    buffer_load_ushort v49, v241, s[84:87], s66 offen offset:1088
    s_waitcnt vmcnt(0)
    s_mov_b32 s66, 6400
    buffer_load_ushort v50, v241, s[84:87], s66 offen offset:0
    buffer_load_ushort v51, v241, s[84:87], s66 offen offset:64
    buffer_load_ushort v52, v241, s[84:87], s66 offen offset:256
    buffer_load_ushort v53, v241, s[84:87], s66 offen offset:320
    buffer_load_ushort v54, v241, s[84:87], s66 offen offset:512
    buffer_load_ushort v55, v241, s[84:87], s66 offen offset:576
    buffer_load_ushort v56, v241, s[84:87], s66 offen offset:768
    buffer_load_ushort v57, v241, s[84:87], s66 offen offset:832
    buffer_load_ushort v58, v241, s[84:87], s66 offen offset:1024
    buffer_load_ushort v59, v241, s[84:87], s66 offen offset:1088
    s_waitcnt vmcnt(0)
    s_mov_b32 s66, 7680
    buffer_load_ushort v60, v241, s[84:87], s66 offen offset:0
    buffer_load_ushort v61, v241, s[84:87], s66 offen offset:64
    buffer_load_ushort v62, v241, s[84:87], s66 offen offset:256
    buffer_load_ushort v63, v241, s[84:87], s66 offen offset:320
    buffer_load_ushort v64, v241, s[84:87], s66 offen offset:512
    buffer_load_ushort v65, v241, s[84:87], s66 offen offset:576
    buffer_load_ushort v66, v241, s[84:87], s66 offen offset:768
    buffer_load_ushort v67, v241, s[84:87], s66 offen offset:832
    buffer_load_ushort v68, v241, s[84:87], s66 offen offset:1024
    buffer_load_ushort v69, v241, s[84:87], s66 offen offset:1088
    s_waitcnt vmcnt(0)
    s_mov_b32 s66, 8960
    buffer_load_ushort v70, v241, s[84:87], s66 offen offset:0
    buffer_load_ushort v71, v241, s[84:87], s66 offen offset:64
    buffer_load_ushort v72, v241, s[84:87], s66 offen offset:256
    buffer_load_ushort v73, v241, s[84:87], s66 offen offset:320
    buffer_load_ushort v74, v241, s[84:87], s66 offen offset:512
    buffer_load_ushort v75, v241, s[84:87], s66 offen offset:576
    buffer_load_ushort v76, v241, s[84:87], s66 offen offset:768
    buffer_load_ushort v77, v241, s[84:87], s66 offen offset:832
    buffer_load_ushort v78, v241, s[84:87], s66 offen offset:1024
    buffer_load_ushort v79, v241, s[84:87], s66 offen offset:1088
    s_waitcnt vmcnt(0)
    s_mov_b32 s66, 10240
    buffer_load_ushort v80, v241, s[84:87], s66 offen offset:0
    buffer_load_ushort v81, v241, s[84:87], s66 offen offset:64
    buffer_load_ushort v82, v241, s[84:87], s66 offen offset:256
    buffer_load_ushort v83, v241, s[84:87], s66 offen offset:320
    buffer_load_ushort v84, v241, s[84:87], s66 offen offset:512
    buffer_load_ushort v85, v241, s[84:87], s66 offen offset:576
    buffer_load_ushort v86, v241, s[84:87], s66 offen offset:768
    buffer_load_ushort v87, v241, s[84:87], s66 offen offset:832
    buffer_load_ushort v88, v241, s[84:87], s66 offen offset:1024
    buffer_load_ushort v89, v241, s[84:87], s66 offen offset:1088
    s_waitcnt vmcnt(0)
    s_mov_b32 s66, 11520
    buffer_load_ushort v90, v241, s[84:87], s66 offen offset:0
    buffer_load_ushort v91, v241, s[84:87], s66 offen offset:64
    buffer_load_ushort v92, v241, s[84:87], s66 offen offset:256
    buffer_load_ushort v93, v241, s[84:87], s66 offen offset:320
    buffer_load_ushort v94, v241, s[84:87], s66 offen offset:512
    buffer_load_ushort v95, v241, s[84:87], s66 offen offset:576
    buffer_load_ushort v96, v241, s[84:87], s66 offen offset:768
    buffer_load_ushort v97, v241, s[84:87], s66 offen offset:832
    buffer_load_ushort v98, v241, s[84:87], s66 offen offset:1024
    buffer_load_ushort v99, v241, s[84:87], s66 offen offset:1088
    s_waitcnt vmcnt(0)
    s_mov_b32 s66, 12800
    buffer_load_ushort v100, v241, s[84:87], s66 offen offset:0
    buffer_load_ushort v101, v241, s[84:87], s66 offen offset:64
    buffer_load_ushort v102, v241, s[84:87], s66 offen offset:256
    buffer_load_ushort v103, v241, s[84:87], s66 offen offset:320
    buffer_load_ushort v104, v241, s[84:87], s66 offen offset:512
    buffer_load_ushort v105, v241, s[84:87], s66 offen offset:576
    buffer_load_ushort v106, v241, s[84:87], s66 offen offset:768
    buffer_load_ushort v107, v241, s[84:87], s66 offen offset:832
    buffer_load_ushort v108, v241, s[84:87], s66 offen offset:1024
    buffer_load_ushort v109, v241, s[84:87], s66 offen offset:1088
    s_waitcnt vmcnt(0)
    s_mov_b32 s66, 14080
    buffer_load_ushort v110, v241, s[84:87], s66 offen offset:0
    buffer_load_ushort v111, v241, s[84:87], s66 offen offset:64
    buffer_load_ushort v112, v241, s[84:87], s66 offen offset:256
    buffer_load_ushort v113, v241, s[84:87], s66 offen offset:320
    buffer_load_ushort v114, v241, s[84:87], s66 offen offset:512
    buffer_load_ushort v115, v241, s[84:87], s66 offen offset:576
    buffer_load_ushort v116, v241, s[84:87], s66 offen offset:768
    buffer_load_ushort v117, v241, s[84:87], s66 offen offset:832
    buffer_load_ushort v118, v241, s[84:87], s66 offen offset:1024
    buffer_load_ushort v119, v241, s[84:87], s66 offen offset:1088
    s_waitcnt vmcnt(0)
    s_mov_b32 s66, 15360
    buffer_load_ushort v120, v241, s[84:87], s66 offen offset:0
    buffer_load_ushort v121, v241, s[84:87], s66 offen offset:64
    buffer_load_ushort v122, v241, s[84:87], s66 offen offset:256
    buffer_load_ushort v123, v241, s[84:87], s66 offen offset:320
    buffer_load_ushort v124, v241, s[84:87], s66 offen offset:512
    buffer_load_ushort v125, v241, s[84:87], s66 offen offset:576
    buffer_load_ushort v126, v241, s[84:87], s66 offen offset:768
    buffer_load_ushort v127, v241, s[84:87], s66 offen offset:832
    buffer_load_ushort v128, v241, s[84:87], s66 offen offset:1024
    buffer_load_ushort v129, v241, s[84:87], s66 offen offset:1088
    s_waitcnt vmcnt(0)
    s_mov_b32 s66, 16640
    buffer_load_ushort v130, v241, s[84:87], s66 offen offset:0
    buffer_load_ushort v131, v241, s[84:87], s66 offen offset:64
    buffer_load_ushort v132, v241, s[84:87], s66 offen offset:256
    buffer_load_ushort v133, v241, s[84:87], s66 offen offset:320
    buffer_load_ushort v134, v241, s[84:87], s66 offen offset:512
    buffer_load_ushort v135, v241, s[84:87], s66 offen offset:576
    buffer_load_ushort v136, v241, s[84:87], s66 offen offset:768
    buffer_load_ushort v137, v241, s[84:87], s66 offen offset:832
    buffer_load_ushort v138, v241, s[84:87], s66 offen offset:1024
    buffer_load_ushort v139, v241, s[84:87], s66 offen offset:1088
    s_waitcnt vmcnt(0)
    s_mov_b32 s66, 17920
    buffer_load_ushort v140, v241, s[84:87], s66 offen offset:0
    buffer_load_ushort v141, v241, s[84:87], s66 offen offset:64
    buffer_load_ushort v142, v241, s[84:87], s66 offen offset:256
    buffer_load_ushort v143, v241, s[84:87], s66 offen offset:320
    buffer_load_ushort v144, v241, s[84:87], s66 offen offset:512
    buffer_load_ushort v145, v241, s[84:87], s66 offen offset:576
    buffer_load_ushort v146, v241, s[84:87], s66 offen offset:768
    buffer_load_ushort v147, v241, s[84:87], s66 offen offset:832
    buffer_load_ushort v148, v241, s[84:87], s66 offen offset:1024
    buffer_load_ushort v149, v241, s[84:87], s66 offen offset:1088
    s_waitcnt vmcnt(0)
    s_mov_b32 s66, 19200
    buffer_load_ushort v150, v241, s[84:87], s66 offen offset:0
    buffer_load_ushort v151, v241, s[84:87], s66 offen offset:64
    buffer_load_ushort v152, v241, s[84:87], s66 offen offset:256
    buffer_load_ushort v153, v241, s[84:87], s66 offen offset:320
    buffer_load_ushort v154, v241, s[84:87], s66 offen offset:512
    buffer_load_ushort v155, v241, s[84:87], s66 offen offset:576
    buffer_load_ushort v156, v241, s[84:87], s66 offen offset:768
    buffer_load_ushort v157, v241, s[84:87], s66 offen offset:832
    buffer_load_ushort v158, v241, s[84:87], s66 offen offset:1024
    buffer_load_ushort v159, v241, s[84:87], s66 offen offset:1088
    s_waitcnt vmcnt(0)
    v_lshlrev_b32 v0, 16, v0
    v_lshlrev_b32 v1, 16, v1
    v_lshlrev_b32 v2, 16, v2
    v_lshlrev_b32 v3, 16, v3
    v_lshlrev_b32 v4, 16, v4
    v_lshlrev_b32 v5, 16, v5
    v_lshlrev_b32 v6, 16, v6
    v_lshlrev_b32 v7, 16, v7
    v_lshlrev_b32 v8, 16, v8
    v_lshlrev_b32 v9, 16, v9
    v_lshlrev_b32 v10, 16, v10
    v_lshlrev_b32 v11, 16, v11
    v_lshlrev_b32 v12, 16, v12
    v_lshlrev_b32 v13, 16, v13
    v_lshlrev_b32 v14, 16, v14
    v_lshlrev_b32 v15, 16, v15
    v_lshlrev_b32 v16, 16, v16
    v_lshlrev_b32 v17, 16, v17
    v_lshlrev_b32 v18, 16, v18
    v_lshlrev_b32 v19, 16, v19
    v_lshlrev_b32 v20, 16, v20
    v_lshlrev_b32 v21, 16, v21
    v_lshlrev_b32 v22, 16, v22
    v_lshlrev_b32 v23, 16, v23
    v_lshlrev_b32 v24, 16, v24
    v_lshlrev_b32 v25, 16, v25
    v_lshlrev_b32 v26, 16, v26
    v_lshlrev_b32 v27, 16, v27
    v_lshlrev_b32 v28, 16, v28
    v_lshlrev_b32 v29, 16, v29
    v_lshlrev_b32 v30, 16, v30
    v_lshlrev_b32 v31, 16, v31
    v_lshlrev_b32 v32, 16, v32
    v_lshlrev_b32 v33, 16, v33
    v_lshlrev_b32 v34, 16, v34
    v_lshlrev_b32 v35, 16, v35
    v_lshlrev_b32 v36, 16, v36
    v_lshlrev_b32 v37, 16, v37
    v_lshlrev_b32 v38, 16, v38
    v_lshlrev_b32 v39, 16, v39
    v_lshlrev_b32 v40, 16, v40
    v_lshlrev_b32 v41, 16, v41
    v_lshlrev_b32 v42, 16, v42
    v_lshlrev_b32 v43, 16, v43
    v_lshlrev_b32 v44, 16, v44
    v_lshlrev_b32 v45, 16, v45
    v_lshlrev_b32 v46, 16, v46
    v_lshlrev_b32 v47, 16, v47
    v_lshlrev_b32 v48, 16, v48
    v_lshlrev_b32 v49, 16, v49
    v_lshlrev_b32 v50, 16, v50
    v_lshlrev_b32 v51, 16, v51
    v_lshlrev_b32 v52, 16, v52
    v_lshlrev_b32 v53, 16, v53
    v_lshlrev_b32 v54, 16, v54
    v_lshlrev_b32 v55, 16, v55
    v_lshlrev_b32 v56, 16, v56
    v_lshlrev_b32 v57, 16, v57
    v_lshlrev_b32 v58, 16, v58
    v_lshlrev_b32 v59, 16, v59
    v_lshlrev_b32 v60, 16, v60
    v_lshlrev_b32 v61, 16, v61
    v_lshlrev_b32 v62, 16, v62
    v_lshlrev_b32 v63, 16, v63
    v_lshlrev_b32 v64, 16, v64
    v_lshlrev_b32 v65, 16, v65
    v_lshlrev_b32 v66, 16, v66
    v_lshlrev_b32 v67, 16, v67
    v_lshlrev_b32 v68, 16, v68
    v_lshlrev_b32 v69, 16, v69
    v_lshlrev_b32 v70, 16, v70
    v_lshlrev_b32 v71, 16, v71
    v_lshlrev_b32 v72, 16, v72
    v_lshlrev_b32 v73, 16, v73
    v_lshlrev_b32 v74, 16, v74
    v_lshlrev_b32 v75, 16, v75
    v_lshlrev_b32 v76, 16, v76
    v_lshlrev_b32 v77, 16, v77
    v_lshlrev_b32 v78, 16, v78
    v_lshlrev_b32 v79, 16, v79
    v_lshlrev_b32 v80, 16, v80
    v_lshlrev_b32 v81, 16, v81
    v_lshlrev_b32 v82, 16, v82
    v_lshlrev_b32 v83, 16, v83
    v_lshlrev_b32 v84, 16, v84
    v_lshlrev_b32 v85, 16, v85
    v_lshlrev_b32 v86, 16, v86
    v_lshlrev_b32 v87, 16, v87
    v_lshlrev_b32 v88, 16, v88
    v_lshlrev_b32 v89, 16, v89
    v_lshlrev_b32 v90, 16, v90
    v_lshlrev_b32 v91, 16, v91
    v_lshlrev_b32 v92, 16, v92
    v_lshlrev_b32 v93, 16, v93
    v_lshlrev_b32 v94, 16, v94
    v_lshlrev_b32 v95, 16, v95
    v_lshlrev_b32 v96, 16, v96
    v_lshlrev_b32 v97, 16, v97
    v_lshlrev_b32 v98, 16, v98
    v_lshlrev_b32 v99, 16, v99
    v_lshlrev_b32 v100, 16, v100
    v_lshlrev_b32 v101, 16, v101
    v_lshlrev_b32 v102, 16, v102
    v_lshlrev_b32 v103, 16, v103
    v_lshlrev_b32 v104, 16, v104
    v_lshlrev_b32 v105, 16, v105
    v_lshlrev_b32 v106, 16, v106
    v_lshlrev_b32 v107, 16, v107
    v_lshlrev_b32 v108, 16, v108
    v_lshlrev_b32 v109, 16, v109
    v_lshlrev_b32 v110, 16, v110
    v_lshlrev_b32 v111, 16, v111
    v_lshlrev_b32 v112, 16, v112
    v_lshlrev_b32 v113, 16, v113
    v_lshlrev_b32 v114, 16, v114
    v_lshlrev_b32 v115, 16, v115
    v_lshlrev_b32 v116, 16, v116
    v_lshlrev_b32 v117, 16, v117
    v_lshlrev_b32 v118, 16, v118
    v_lshlrev_b32 v119, 16, v119
    v_lshlrev_b32 v120, 16, v120
    v_lshlrev_b32 v121, 16, v121
    v_lshlrev_b32 v122, 16, v122
    v_lshlrev_b32 v123, 16, v123
    v_lshlrev_b32 v124, 16, v124
    v_lshlrev_b32 v125, 16, v125
    v_lshlrev_b32 v126, 16, v126
    v_lshlrev_b32 v127, 16, v127
    v_lshlrev_b32 v128, 16, v128
    v_lshlrev_b32 v129, 16, v129
    v_lshlrev_b32 v130, 16, v130
    v_lshlrev_b32 v131, 16, v131
    v_lshlrev_b32 v132, 16, v132
    v_lshlrev_b32 v133, 16, v133
    v_lshlrev_b32 v134, 16, v134
    v_lshlrev_b32 v135, 16, v135
    v_lshlrev_b32 v136, 16, v136
    v_lshlrev_b32 v137, 16, v137
    v_lshlrev_b32 v138, 16, v138
    v_lshlrev_b32 v139, 16, v139
    v_lshlrev_b32 v140, 16, v140
    v_lshlrev_b32 v141, 16, v141
    v_lshlrev_b32 v142, 16, v142
    v_lshlrev_b32 v143, 16, v143
    v_lshlrev_b32 v144, 16, v144
    v_lshlrev_b32 v145, 16, v145
    v_lshlrev_b32 v146, 16, v146
    v_lshlrev_b32 v147, 16, v147
    v_lshlrev_b32 v148, 16, v148
    v_lshlrev_b32 v149, 16, v149
    v_lshlrev_b32 v150, 16, v150
    v_lshlrev_b32 v151, 16, v151
    v_lshlrev_b32 v152, 16, v152
    v_lshlrev_b32 v153, 16, v153
    v_lshlrev_b32 v154, 16, v154
    v_lshlrev_b32 v155, 16, v155
    v_lshlrev_b32 v156, 16, v156
    v_lshlrev_b32 v157, 16, v157
    v_lshlrev_b32 v158, 16, v158
    v_lshlrev_b32 v159, 16, v159
    s_mov_b32 s50, 0
SL_node:
    s_mul_i32 s34, s2, 40
    s_lshl_b32 s66, s50, 3
    s_add_u32 s66, s66, s20
    s_add_u32 s34, s34, s66
    v_mov_b32 v160, 0
    v_mov_b32 v161, 0
    v_mov_b32 v162, 0
    v_mov_b32 v163, 0
    v_mov_b32 v164, 0
    v_mov_b32 v165, 0
    v_mov_b32 v166, 0
    v_mov_b32 v167, 0
    v_mov_b32 v168, 0
    v_mov_b32 v169, 0
    v_mov_b32 v170, 0
    v_mov_b32 v171, 0
    v_mov_b32 v172, 0
    v_mov_b32 v173, 0
    v_mov_b32 v174, 0
    v_mov_b32 v175, 0
    v_mov_b32 v176, 0
    v_mov_b32 v177, 0
    v_mov_b32 v178, 0
    v_mov_b32 v179, 0
    v_mov_b32 v180, 0
    v_mov_b32 v181, 0
    s_mov_b32 s35, 0
SL_scan:
    s_lshl_b32 s66, s35, 2
    buffer_load_dwordx4 v[236:239], v245, s[72:75], s66 offen
    s_waitcnt vmcnt(0)
    v_cmp_eq_u32 s[38:39], s34, v236
    v_cmp_eq_u32 s[40:41], s34, v237
    v_cmp_eq_u32 s[42:43], s34, v238
    v_cmp_eq_u32 s[44:45], s34, v239
    s_mov_b32 s36, 0
SL_bits:
    s_cmp_eq_u64 s[38:39], 0
    s_cbranch_scc1 SL_nexti
    s_ff1_i32_b64 s66, s[38:39]
    s_bitset0_b64 s[38:39], s66
    s_lshl_b32 s66, s66, 2
    s_add_u32 s37, s66, s36
    s_add_u32 s37, s37, s35
    s_lshl_b32 s66, s37, 2
    s_lshl_b32 s67, s37, 5
    s_mul_i32 s68, s37, 6
    buffer_load_dword v243, v242, s[76:79], s66 offen
    buffer_load_dwordx4 v[184:187], v242, s[12:15], s67 offen
    buffer_load_dwordx4 v[188:191], v242, s[12:15], s67 offen offset:16
    buffer_load_ushort v226, v242, s[80:83], s68 offen offset:0
    buffer_load_ushort v227, v242, s[80:83], s68 offen offset:2
    buffer_load_ushort v228, v242, s[80:83], s68 offen offset:4
    s_waitcnt vmcnt(5)
    v_lshl_add_u32 v243, v243, 10, v241
    buffer_load_ushort v208, v243, s[4:7], 0 offen offset:0
    buffer_load_ushort v209, v243, s[4:7], 0 offen offset:64
    buffer_load_ushort v210, v243, s[4:7], 0 offen offset:256
    buffer_load_ushort v211, v243, s[4:7], 0 offen offset:320
    buffer_load_ushort v212, v243, s[4:7], 0 offen offset:512
    buffer_load_ushort v213, v243, s[4:7], 0 offen offset:576
    buffer_load_ushort v214, v243, s[4:7], 0 offen offset:768
    buffer_load_ushort v215, v243, s[4:7], 0 offen offset:832
    s_waitcnt vmcnt(8)
    v_lshlrev_b32 v192, 16, v184
    v_and_b32 v193, 0xffff0000, v184
    v_lshlrev_b32 v194, 16, v185
    v_and_b32 v195, 0xffff0000, v185
    v_lshlrev_b32 v196, 16, v186
    v_and_b32 v197, 0xffff0000, v186
    v_lshlrev_b32 v198, 16, v187
    v_and_b32 v199, 0xffff0000, v187
    v_lshlrev_b32 v200, 16, v188
    v_and_b32 v201, 0xffff0000, v188
    v_lshlrev_b32 v202, 16, v189
    v_and_b32 v203, 0xffff0000, v189
    v_lshlrev_b32 v204, 16, v190
    v_and_b32 v205, 0xffff0000, v190
    v_lshlrev_b32 v206, 16, v191
    v_and_b32 v207, 0xffff0000, v191
    v_lshlrev_b32 v226, 16, v226
    v_lshlrev_b32 v227, 16, v227
    v_lshlrev_b32 v228, 16, v228
    v_mul_f32 v216, v192, v0
    v_mul_f32 v217, v192, v1
    v_mul_f32 v218, v192, v2
    v_mul_f32 v219, v192, v3
    v_mul_f32 v220, v192, v4
    v_mul_f32 v221, v192, v5
    v_mul_f32 v222, v192, v6
    v_mul_f32 v223, v192, v7
    v_mul_f32 v224, v192, v8
    v_mul_f32 v225, v192, v9
    v_fmac_f32 v216, v193, v10
    v_fmac_f32 v217, v193, v11
    v_fmac_f32 v218, v193, v12
    v_fmac_f32 v219, v193, v13
    v_fmac_f32 v220, v193, v14
    v_fmac_f32 v221, v193, v15
    v_fmac_f32 v222, v193, v16
    v_fmac_f32 v223, v193, v17
    v_fmac_f32 v224, v193, v18
    v_fmac_f32 v225, v193, v19
    v_fmac_f32 v216, v194, v20
    v_fmac_f32 v217, v194, v21
    v_fmac_f32 v218, v194, v22
    v_fmac_f32 v219, v194, v23
    v_fmac_f32 v220, v194, v24
    v_fmac_f32 v221, v194, v25
    v_fmac_f32 v222, v194, v26
    v_fmac_f32 v223, v194, v27
    v_fmac_f32 v224, v194, v28
    v_fmac_f32 v225, v194, v29
    v_fmac_f32 v216, v195, v30
    v_fmac_f32 v217, v195, v31
    v_fmac_f32 v218, v195, v32
    v_fmac_f32 v219, v195, v33
    v_fmac_f32 v220, v195, v34
    v_fmac_f32 v221, v195, v35
    v_fmac_f32 v222, v195, v36
    v_fmac_f32 v223, v195, v37
    v_fmac_f32 v224, v195, v38
    v_fmac_f32 v225, v195, v39
    v_fmac_f32 v216, v196, v40
    v_fmac_f32 v217, v196, v41
    v_fmac_f32 v218, v196, v42
    v_fmac_f32 v219, v196, v43
    v_fmac_f32 v220, v196, v44
    v_fmac_f32 v221, v196, v45
    v_fmac_f32 v222, v196, v46
    v_fmac_f32 v223, v196, v47
    v_fmac_f32 v224, v196, v48
    v_fmac_f32 v225, v196, v49
    v_fmac_f32 v216, v197, v50
    v_fmac_f32 v217, v197, v51
    v_fmac_f32 v218, v197, v52
    v_fmac_f32 v219, v197, v53
    v_fmac_f32 v220, v197, v54
    v_fmac_f32 v221, v197, v55
    v_fmac_f32 v222, v197, v56
    v_fmac_f32 v223, v197, v57
    v_fmac_f32 v224, v197, v58
    v_fmac_f32 v225, v197, v59
    v_fmac_f32 v216, v198, v60
    v_fmac_f32 v217, v198, v61
    v_fmac_f32 v218, v198, v62
    v_fmac_f32 v219, v198, v63
    v_fmac_f32 v220, v198, v64
    v_fmac_f32 v221, v198, v65
    v_fmac_f32 v222, v198, v66
    v_fmac_f32 v223, v198, v67
    v_fmac_f32 v224, v198, v68
    v_fmac_f32 v225, v198, v69
    v_fmac_f32 v216, v199, v70
    v_fmac_f32 v217, v199, v71
    v_fmac_f32 v218, v199, v72
    v_fmac_f32 v219, v199, v73
    v_fmac_f32 v220, v199, v74
    v_fmac_f32 v221, v199, v75
    v_fmac_f32 v222, v199, v76
    v_fmac_f32 v223, v199, v77
    v_fmac_f32 v224, v199, v78
    v_fmac_f32 v225, v199, v79
    v_fmac_f32 v216, v200, v80
    v_fmac_f32 v217, v200, v81
    v_fmac_f32 v218, v200, v82
    v_fmac_f32 v219, v200, v83
    v_fmac_f32 v220, v200, v84
    v_fmac_f32 v221, v200, v85
    v_fmac_f32 v222, v200, v86
    v_fmac_f32 v223, v200, v87
    v_fmac_f32 v224, v200, v88
    v_fmac_f32 v225, v200, v89
    v_fmac_f32 v216, v201, v90
    v_fmac_f32 v217, v201, v91
    v_fmac_f32 v218, v201, v92
    v_fmac_f32 v219, v201, v93
    v_fmac_f32 v220, v201, v94
    v_fmac_f32 v221, v201, v95
    v_fmac_f32 v222, v201, v96
    v_fmac_f32 v223, v201, v97
    v_fmac_f32 v224, v201, v98
    v_fmac_f32 v225, v201, v99
    v_fmac_f32 v216, v202, v100
    v_fmac_f32 v217, v202, v101
    v_fmac_f32 v218, v202, v102
    v_fmac_f32 v219, v202, v103
    v_fmac_f32 v220, v202, v104
    v_fmac_f32 v221, v202, v105
    v_fmac_f32 v222, v202, v106
    v_fmac_f32 v223, v202, v107
    v_fmac_f32 v224, v202, v108
    v_fmac_f32 v225, v202, v109
    v_fmac_f32 v216, v203, v110
    v_fmac_f32 v217, v203, v111
    v_fmac_f32 v218, v203, v112
    v_fmac_f32 v219, v203, v113
    v_fmac_f32 v220, v203, v114
    v_fmac_f32 v221, v203, v115
    v_fmac_f32 v222, v203, v116
    v_fmac_f32 v223, v203, v117
    v_fmac_f32 v224, v203, v118
    v_fmac_f32 v225, v203, v119
    v_fmac_f32 v216, v204, v120
    v_fmac_f32 v217, v204, v121
    v_fmac_f32 v218, v204, v122
    v_fmac_f32 v219, v204, v123
    v_fmac_f32 v220, v204, v124
    v_fmac_f32 v221, v204, v125
    v_fmac_f32 v222, v204, v126
    v_fmac_f32 v223, v204, v127
    v_fmac_f32 v224, v204, v128
    v_fmac_f32 v225, v204, v129
    v_fmac_f32 v216, v205, v130
    v_fmac_f32 v217, v205, v131
    v_fmac_f32 v218, v205, v132
    v_fmac_f32 v219, v205, v133
    v_fmac_f32 v220, v205, v134
    v_fmac_f32 v221, v205, v135
    v_fmac_f32 v222, v205, v136
    v_fmac_f32 v223, v205, v137
    v_fmac_f32 v224, v205, v138
    v_fmac_f32 v225, v205, v139
    v_fmac_f32 v216, v206, v140
    v_fmac_f32 v217, v206, v141
    v_fmac_f32 v218, v206, v142
    v_fmac_f32 v219, v206, v143
    v_fmac_f32 v220, v206, v144
    v_fmac_f32 v221, v206, v145
    v_fmac_f32 v222, v206, v146
    v_fmac_f32 v223, v206, v147
    v_fmac_f32 v224, v206, v148
    v_fmac_f32 v225, v206, v149
    v_fmac_f32 v216, v207, v150
    v_fmac_f32 v217, v207, v151
    v_fmac_f32 v218, v207, v152
    v_fmac_f32 v219, v207, v153
    v_fmac_f32 v220, v207, v154
    v_fmac_f32 v221, v207, v155
    v_fmac_f32 v222, v207, v156
    v_fmac_f32 v223, v207, v157
    v_fmac_f32 v224, v207, v158
    v_fmac_f32 v225, v207, v159
    s_waitcnt vmcnt(0)
    v_lshlrev_b32 v208, 16, v208
    v_lshlrev_b32 v209, 16, v209
    v_lshlrev_b32 v210, 16, v210
    v_lshlrev_b32 v211, 16, v211
    v_lshlrev_b32 v212, 16, v212
    v_lshlrev_b32 v213, 16, v213
    v_lshlrev_b32 v214, 16, v214
    v_lshlrev_b32 v215, 16, v215
    v_fmac_f32 v160, v208, v216
    v_mul_f32 v229, v210, v226
    v_fmac_f32 v229, v212, v227
    v_fmac_f32 v229, v214, v228
    v_fmac_f32 v176, v229, v218
    v_mul_f32 v229, v208, v220
    v_fmac_f32 v162, v229, v226
    v_fmac_f32 v168, v210, v222
    v_mul_f32 v230, v227, v214
    v_fma_f32 v230, -v228, v212, v230
    v_fmac_f32 v178, v230, v224
    v_fmac_f32 v164, v229, v227
    v_fmac_f32 v170, v212, v222
    v_mul_f32 v230, v228, v210
    v_fma_f32 v230, -v226, v214, v230
    v_fmac_f32 v180, v230, v224
    v_fmac_f32 v166, v229, v228
    v_fmac_f32 v172, v214, v222
    v_mul_f32 v230, v226, v212
    v_fma_f32 v230, -v227, v210, v230
    v_fmac_f32 v174, v230, v224
    v_fmac_f32 v161, v209, v217
    v_mul_f32 v229, v211, v226
    v_fmac_f32 v229, v213, v227
    v_fmac_f32 v229, v215, v228
    v_fmac_f32 v177, v229, v219
    v_mul_f32 v229, v209, v221
    v_fmac_f32 v163, v229, v226
    v_fmac_f32 v169, v211, v223
    v_mul_f32 v230, v227, v215
    v_fma_f32 v230, -v228, v213, v230
    v_fmac_f32 v179, v230, v225
    v_fmac_f32 v165, v229, v227
    v_fmac_f32 v171, v213, v223
    v_mul_f32 v230, v228, v211
    v_fma_f32 v230, -v226, v215, v230
    v_fmac_f32 v181, v230, v225
    v_fmac_f32 v167, v229, v228
    v_fmac_f32 v173, v215, v223
    v_mul_f32 v230, v226, v213
    v_fma_f32 v230, -v227, v211, v230
    v_fmac_f32 v175, v230, v225
    s_branch SL_bits
SL_nexti:
    s_mov_b64 s[38:39], s[40:41]
    s_mov_b64 s[40:41], s[42:43]
    s_mov_b64 s[42:43], s[44:45]
    s_add_u32 s36, s36, 1
    s_cmp_lt_u32 s36, 4
    s_cbranch_scc1 SL_bits
    s_add_u32 s35, s35, 256
    s_cmp_lt_u32 s35, 320000
    s_cbranch_scc1 SL_scan
    s_lshl_b32 s66, s50, 3
    s_add_u32 s66, s66, s20
    s_lshl_b32 s67, s66, 4
    s_and_b32 s68, s67, 128
    s_and_b32 s67, s67, 0x70
    s_mul_i32 s69, s50, 1536
    s_add_u32 s69, s69, s21
    s_add_u32 s69, s69, s68
    s_mul_i32 s70, s66, 1536
    s_add_u32 s70, s70, 86016
    s_add_u32 s70, s70, s68
    v_mov_b32 v230, s69
    v_mov_b32 v231, s70
    v_cmp_gt_u32 vcc, 32, v240
    v_and_b32 v229, 31, v240
    v_lshlrev_b32 v229, 2, v229
    v_xor_b32 v229, s67, v229
    v_cndmask_b32 v244, v231, v230, vcc
    v_add_u32 v244, v244, v229
    v_cvt_pk_bf16_f32 v160, v160, v161
    ds_write_b32 v244, v160 offset:0
    v_cvt_pk_bf16_f32 v162, v162, v163
    ds_write_b32 v244, v162 offset:128
    v_cvt_pk_bf16_f32 v164, v164, v165
    ds_write_b32 v244, v164 offset:256
    v_cvt_pk_bf16_f32 v166, v166, v167
    ds_write_b32 v244, v166 offset:384
    v_cvt_pk_bf16_f32 v168, v168, v169
    ds_write_b32 v244, v168 offset:512
    v_cvt_pk_bf16_f32 v170, v170, v171
    ds_write_b32 v244, v170 offset:640
    v_cvt_pk_bf16_f32 v172, v172, v173
    ds_write_b32 v244, v172 offset:768
    v_cvt_pk_bf16_f32 v174, v174, v175
    ds_write_b32 v244, v174 offset:896
    v_cvt_pk_bf16_f32 v176, v176, v177
    ds_write_b32 v244, v176 offset:1024
    v_cvt_pk_bf16_f32 v178, v178, v179
    ds_write_b32 v244, v178 offset:1152
    v_cvt_pk_bf16_f32 v180, v180, v181
    ds_write_b32 v244, v180 offset:1280
    s_lshl_b32 s66, s66, 3
    s_add_u32 s66, s66, 163328
    v_mov_b32 v229, s66
    ds_write_b64 v229, v[230:231]
    s_add_u32 s50, s50, 1
    s_cmp_lt_u32 s50, 5
    s_cbranch_scc1 SL_node
    s_waitcnt lgkmcnt(0)
    s_barrier
    v_mov_b32 v176, v240
    s_load_dwordx4 s[84:87], s[0:1], 48
    s_mul_i32 s22, s20, 20
    s_waitcnt lgkmcnt(0)
    s_mul_i32 s24, s22, 3277
    s_lshr_b32 s24, s24, 16
    s_mul_i32 s68, s24, 20
    s_sub_u32 s68, s22, s68
    s_cmp_lt_u32 s68, 8
    s_cselect_b64 s[66:67], s[84:85], s[86:87]
    s_cselect_b32 s25, 0, 8
    s_sub_u32 s68, s68, s25
    s_and_b32 s25, s68, 1
    s_lshr_b32 s68, s68, 1
    s_lshl_b32 s68, s68, 14
    s_lshl_b32 s25, s25, 12
    s_add_u32 s68, s68, s25
    s_lshl_b32 s24, s24, 5
    s_add_u32 s68, s68, s24
    v_lshrrev_b32 v2, 4, v176
    v_lshlrev_b32 v2, 10, v2
    v_and_b32 v3, 15, v176
    v_lshl_add_u32 v2, v3, 1, v2
    v_add_u32 v2, s68, v2
    v_add_u32 v3, 8192, v2
    v_mov_b32 v4, 0
    v_mov_b32 v5, 0
    v_mov_b32 v6, 0
    v_mov_b32 v7, 0
    global_load_ushort v144, v2, s[66:67] offset:0
    global_load_short_d16_hi v4, v3, s[66:67] offset:0
    global_load_ushort v145, v2, s[66:67] offset:256
    global_load_short_d16_hi v5, v3, s[66:67] offset:256
    global_load_ushort v146, v2, s[66:67] offset:512
    global_load_short_d16_hi v6, v3, s[66:67] offset:512
    global_load_ushort v147, v2, s[66:67] offset:768
    global_load_short_d16_hi v7, v3, s[66:67] offset:768
    s_add_u32 s22, s22, 1
    s_waitcnt vmcnt(0)
    v_or_b32 v144, v144, v4
    v_or_b32 v145, v145, v5
    v_or_b32 v146, v146, v6
    v_or_b32 v147, v147, v7
    s_mul_i32 s24, s22, 3277
    s_lshr_b32 s24, s24, 16
    s_mul_i32 s68, s24, 20
    s_sub_u32 s68, s22, s68
    s_cmp_lt_u32 s68, 8
    s_cselect_b64 s[66:67], s[84:85], s[86:87]
    s_cselect_b32 s25, 0, 8
    s_sub_u32 s68, s68, s25
    s_and_b32 s25, s68, 1
    s_lshr_b32 s68, s68, 1
    s_lshl_b32 s68, s68, 14
    s_lshl_b32 s25, s25, 12
    s_add_u32 s68, s68, s25
    s_lshl_b32 s24, s24, 5
    s_add_u32 s68, s68, s24
    v_lshrrev_b32 v2, 4, v176
    v_lshlrev_b32 v2, 10, v2
    v_and_b32 v3, 15, v176
    v_lshl_add_u32 v2, v3, 1, v2
    v_add_u32 v2, s68, v2
    v_add_u32 v3, 8192, v2
    v_mov_b32 v4, 0
    v_mov_b32 v5, 0
    v_mov_b32 v6, 0
    v_mov_b32 v7, 0
    global_load_ushort v148, v2, s[66:67] offset:0
    global_load_short_d16_hi v4, v3, s[66:67] offset:0
    global_load_ushort v149, v2, s[66:67] offset:256
    global_load_short_d16_hi v5, v3, s[66:67] offset:256
    global_load_ushort v150, v2, s[66:67] offset:512
    global_load_short_d16_hi v6, v3, s[66:67] offset:512
    global_load_ushort v151, v2, s[66:67] offset:768
    global_load_short_d16_hi v7, v3, s[66:67] offset:768
    s_add_u32 s22, s22, 1
    s_waitcnt vmcnt(0)
    v_or_b32 v148, v148, v4
    v_or_b32 v149, v149, v5
    v_or_b32 v150, v150, v6
    v_or_b32 v151, v151, v7
    s_mul_i32 s24, s22, 3277
    s_lshr_b32 s24, s24, 16
    s_mul_i32 s68, s24, 20
    s_sub_u32 s68, s22, s68
    s_cmp_lt_u32 s68, 8
    s_cselect_b64 s[66:67], s[84:85], s[86:87]
    s_cselect_b32 s25, 0, 8
    s_sub_u32 s68, s68, s25
    s_and_b32 s25, s68, 1
    s_lshr_b32 s68, s68, 1
    s_lshl_b32 s68, s68, 14
    s_lshl_b32 s25, s25, 12
    s_add_u32 s68, s68, s25
    s_lshl_b32 s24, s24, 5
    s_add_u32 s68, s68, s24
    v_lshrrev_b32 v2, 4, v176
    v_lshlrev_b32 v2, 10, v2
    v_and_b32 v3, 15, v176
    v_lshl_add_u32 v2, v3, 1, v2
    v_add_u32 v2, s68, v2
    v_add_u32 v3, 8192, v2
    v_mov_b32 v4, 0
    v_mov_b32 v5, 0
    v_mov_b32 v6, 0
    v_mov_b32 v7, 0
    global_load_ushort v96, v2, s[66:67] offset:0
    global_load_short_d16_hi v4, v3, s[66:67] offset:0
    global_load_ushort v97, v2, s[66:67] offset:256
    global_load_short_d16_hi v5, v3, s[66:67] offset:256
    global_load_ushort v98, v2, s[66:67] offset:512
    global_load_short_d16_hi v6, v3, s[66:67] offset:512
    global_load_ushort v99, v2, s[66:67] offset:768
    global_load_short_d16_hi v7, v3, s[66:67] offset:768
    s_add_u32 s22, s22, 1
    s_waitcnt vmcnt(0)
    v_or_b32 v96, v96, v4
    v_or_b32 v97, v97, v5
    v_or_b32 v98, v98, v6
    v_or_b32 v99, v99, v7
    s_mul_i32 s24, s22, 3277
    s_lshr_b32 s24, s24, 16
    s_mul_i32 s68, s24, 20
    s_sub_u32 s68, s22, s68
    s_cmp_lt_u32 s68, 8
    s_cselect_b64 s[66:67], s[84:85], s[86:87]
    s_cselect_b32 s25, 0, 8
    s_sub_u32 s68, s68, s25
    s_and_b32 s25, s68, 1
    s_lshr_b32 s68, s68, 1
    s_lshl_b32 s68, s68, 14
    s_lshl_b32 s25, s25, 12
    s_add_u32 s68, s68, s25
    s_lshl_b32 s24, s24, 5
    s_add_u32 s68, s68, s24
    v_lshrrev_b32 v2, 4, v176
    v_lshlrev_b32 v2, 10, v2
    v_and_b32 v3, 15, v176
    v_lshl_add_u32 v2, v3, 1, v2
    v_add_u32 v2, s68, v2
    v_add_u32 v3, 8192, v2
    v_mov_b32 v4, 0
    v_mov_b32 v5, 0
    v_mov_b32 v6, 0
    v_mov_b32 v7, 0
    global_load_ushort v100, v2, s[66:67] offset:0
    global_load_short_d16_hi v4, v3, s[66:67] offset:0
    global_load_ushort v101, v2, s[66:67] offset:256
    global_load_short_d16_hi v5, v3, s[66:67] offset:256
    global_load_ushort v102, v2, s[66:67] offset:512
    global_load_short_d16_hi v6, v3, s[66:67] offset:512
    global_load_ushort v103, v2, s[66:67] offset:768
    global_load_short_d16_hi v7, v3, s[66:67] offset:768
    s_add_u32 s22, s22, 1
    s_waitcnt vmcnt(0)
    v_or_b32 v100, v100, v4
    v_or_b32 v101, v101, v5
    v_or_b32 v102, v102, v6
    v_or_b32 v103, v103, v7
    s_mul_i32 s24, s22, 3277
    s_lshr_b32 s24, s24, 16
    s_mul_i32 s68, s24, 20
    s_sub_u32 s68, s22, s68
    s_cmp_lt_u32 s68, 8
    s_cselect_b64 s[66:67], s[84:85], s[86:87]
    s_cselect_b32 s25, 0, 8
    s_sub_u32 s68, s68, s25
    s_and_b32 s25, s68, 1
    s_lshr_b32 s68, s68, 1
    s_lshl_b32 s68, s68, 14
    s_lshl_b32 s25, s25, 12
    s_add_u32 s68, s68, s25
    s_lshl_b32 s24, s24, 5
    s_add_u32 s68, s68, s24
    v_lshrrev_b32 v2, 4, v176
    v_lshlrev_b32 v2, 10, v2
    v_and_b32 v3, 15, v176
    v_lshl_add_u32 v2, v3, 1, v2
    v_add_u32 v2, s68, v2
    v_add_u32 v3, 8192, v2
    v_mov_b32 v4, 0
    v_mov_b32 v5, 0
    v_mov_b32 v6, 0
    v_mov_b32 v7, 0
    global_load_ushort v160, v2, s[66:67] offset:0
    global_load_short_d16_hi v4, v3, s[66:67] offset:0
    global_load_ushort v161, v2, s[66:67] offset:256
    global_load_short_d16_hi v5, v3, s[66:67] offset:256
    global_load_ushort v162, v2, s[66:67] offset:512
    global_load_short_d16_hi v6, v3, s[66:67] offset:512
    global_load_ushort v163, v2, s[66:67] offset:768
    global_load_short_d16_hi v7, v3, s[66:67] offset:768
    s_add_u32 s22, s22, 1
    s_waitcnt vmcnt(0)
    v_or_b32 v160, v160, v4
    v_or_b32 v161, v161, v5
    v_or_b32 v162, v162, v6
    v_or_b32 v163, v163, v7
    s_mul_i32 s24, s22, 3277
    s_lshr_b32 s24, s24, 16
    s_mul_i32 s68, s24, 20
    s_sub_u32 s68, s22, s68
    s_cmp_lt_u32 s68, 8
    s_cselect_b64 s[66:67], s[84:85], s[86:87]
    s_cselect_b32 s25, 0, 8
    s_sub_u32 s68, s68, s25
    s_and_b32 s25, s68, 1
    s_lshr_b32 s68, s68, 1
    s_lshl_b32 s68, s68, 14
    s_lshl_b32 s25, s25, 12
    s_add_u32 s68, s68, s25
    s_lshl_b32 s24, s24, 5
    s_add_u32 s68, s68, s24
    v_lshrrev_b32 v2, 4, v176
    v_lshlrev_b32 v2, 10, v2
    v_and_b32 v3, 15, v176
    v_lshl_add_u32 v2, v3, 1, v2
    v_add_u32 v2, s68, v2
    v_add_u32 v3, 8192, v2
    v_mov_b32 v4, 0
    v_mov_b32 v5, 0
    v_mov_b32 v6, 0
    v_mov_b32 v7, 0
    global_load_ushort v164, v2, s[66:67] offset:0
    global_load_short_d16_hi v4, v3, s[66:67] offset:0
    global_load_ushort v165, v2, s[66:67] offset:256
    global_load_short_d16_hi v5, v3, s[66:67] offset:256
    global_load_ushort v166, v2, s[66:67] offset:512
    global_load_short_d16_hi v6, v3, s[66:67] offset:512
    global_load_ushort v167, v2, s[66:67] offset:768
    global_load_short_d16_hi v7, v3, s[66:67] offset:768
    s_add_u32 s22, s22, 1
    s_waitcnt vmcnt(0)
    v_or_b32 v164, v164, v4
    v_or_b32 v165, v165, v5
    v_or_b32 v166, v166, v6
    v_or_b32 v167, v167, v7
    s_mul_i32 s24, s22, 3277
    s_lshr_b32 s24, s24, 16
    s_mul_i32 s68, s24, 20
    s_sub_u32 s68, s22, s68
    s_cmp_lt_u32 s68, 8
    s_cselect_b64 s[66:67], s[84:85], s[86:87]
    s_cselect_b32 s25, 0, 8
    s_sub_u32 s68, s68, s25
    s_and_b32 s25, s68, 1
    s_lshr_b32 s68, s68, 1
    s_lshl_b32 s68, s68, 14
    s_lshl_b32 s25, s25, 12
    s_add_u32 s68, s68, s25
    s_lshl_b32 s24, s24, 5
    s_add_u32 s68, s68, s24
    v_lshrrev_b32 v2, 4, v176
    v_lshlrev_b32 v2, 10, v2
    v_and_b32 v3, 15, v176
    v_lshl_add_u32 v2, v3, 1, v2
    v_add_u32 v2, s68, v2
    v_add_u32 v3, 8192, v2
    v_mov_b32 v4, 0
    v_mov_b32 v5, 0
    v_mov_b32 v6, 0
    v_mov_b32 v7, 0
    global_load_ushort v104, v2, s[66:67] offset:0
    global_load_short_d16_hi v4, v3, s[66:67] offset:0
    global_load_ushort v105, v2, s[66:67] offset:256
    global_load_short_d16_hi v5, v3, s[66:67] offset:256
    global_load_ushort v106, v2, s[66:67] offset:512
    global_load_short_d16_hi v6, v3, s[66:67] offset:512
    global_load_ushort v107, v2, s[66:67] offset:768
    global_load_short_d16_hi v7, v3, s[66:67] offset:768
    s_add_u32 s22, s22, 1
    s_waitcnt vmcnt(0)
    v_or_b32 v104, v104, v4
    v_or_b32 v105, v105, v5
    v_or_b32 v106, v106, v6
    v_or_b32 v107, v107, v7
    s_mul_i32 s24, s22, 3277
    s_lshr_b32 s24, s24, 16
    s_mul_i32 s68, s24, 20
    s_sub_u32 s68, s22, s68
    s_cmp_lt_u32 s68, 8
    s_cselect_b64 s[66:67], s[84:85], s[86:87]
    s_cselect_b32 s25, 0, 8
    s_sub_u32 s68, s68, s25
    s_and_b32 s25, s68, 1
    s_lshr_b32 s68, s68, 1
    s_lshl_b32 s68, s68, 14
    s_lshl_b32 s25, s25, 12
    s_add_u32 s68, s68, s25
    s_lshl_b32 s24, s24, 5
    s_add_u32 s68, s68, s24
    v_lshrrev_b32 v2, 4, v176
    v_lshlrev_b32 v2, 10, v2
    v_and_b32 v3, 15, v176
    v_lshl_add_u32 v2, v3, 1, v2
    v_add_u32 v2, s68, v2
    v_add_u32 v3, 8192, v2
    v_mov_b32 v4, 0
    v_mov_b32 v5, 0
    v_mov_b32 v6, 0
    v_mov_b32 v7, 0
    global_load_ushort v108, v2, s[66:67] offset:0
    global_load_short_d16_hi v4, v3, s[66:67] offset:0
    global_load_ushort v109, v2, s[66:67] offset:256
    global_load_short_d16_hi v5, v3, s[66:67] offset:256
    global_load_ushort v110, v2, s[66:67] offset:512
    global_load_short_d16_hi v6, v3, s[66:67] offset:512
    global_load_ushort v111, v2, s[66:67] offset:768
    global_load_short_d16_hi v7, v3, s[66:67] offset:768
    s_add_u32 s22, s22, 1
    s_waitcnt vmcnt(0)
    v_or_b32 v108, v108, v4
    v_or_b32 v109, v109, v5
    v_or_b32 v110, v110, v6
    v_or_b32 v111, v111, v7
    s_mul_i32 s24, s22, 3277
    s_lshr_b32 s24, s24, 16
    s_mul_i32 s68, s24, 20
    s_sub_u32 s68, s22, s68
    s_cmp_lt_u32 s68, 8
    s_cselect_b64 s[66:67], s[84:85], s[86:87]
    s_cselect_b32 s25, 0, 8
    s_sub_u32 s68, s68, s25
    s_and_b32 s25, s68, 1
    s_lshr_b32 s68, s68, 1
    s_lshl_b32 s68, s68, 14
    s_lshl_b32 s25, s25, 12
    s_add_u32 s68, s68, s25
    s_lshl_b32 s24, s24, 5
    s_add_u32 s68, s68, s24
    v_lshrrev_b32 v2, 4, v176
    v_lshlrev_b32 v2, 10, v2
    v_and_b32 v3, 15, v176
    v_lshl_add_u32 v2, v3, 1, v2
    v_add_u32 v2, s68, v2
    v_add_u32 v3, 8192, v2
    v_mov_b32 v4, 0
    v_mov_b32 v5, 0
    v_mov_b32 v6, 0
    v_mov_b32 v7, 0
    global_load_ushort v120, v2, s[66:67] offset:0
    global_load_short_d16_hi v4, v3, s[66:67] offset:0
    global_load_ushort v121, v2, s[66:67] offset:256
    global_load_short_d16_hi v5, v3, s[66:67] offset:256
    global_load_ushort v122, v2, s[66:67] offset:512
    global_load_short_d16_hi v6, v3, s[66:67] offset:512
    global_load_ushort v123, v2, s[66:67] offset:768
    global_load_short_d16_hi v7, v3, s[66:67] offset:768
    s_add_u32 s22, s22, 1
    s_waitcnt vmcnt(0)
    v_or_b32 v120, v120, v4
    v_or_b32 v121, v121, v5
    v_or_b32 v122, v122, v6
    v_or_b32 v123, v123, v7
    s_mul_i32 s24, s22, 3277
    s_lshr_b32 s24, s24, 16
    s_mul_i32 s68, s24, 20
    s_sub_u32 s68, s22, s68
    s_cmp_lt_u32 s68, 8
    s_cselect_b64 s[66:67], s[84:85], s[86:87]
    s_cselect_b32 s25, 0, 8
    s_sub_u32 s68, s68, s25
    s_and_b32 s25, s68, 1
    s_lshr_b32 s68, s68, 1
    s_lshl_b32 s68, s68, 14
    s_lshl_b32 s25, s25, 12
    s_add_u32 s68, s68, s25
    s_lshl_b32 s24, s24, 5
    s_add_u32 s68, s68, s24
    v_lshrrev_b32 v2, 4, v176
    v_lshlrev_b32 v2, 10, v2
    v_and_b32 v3, 15, v176
    v_lshl_add_u32 v2, v3, 1, v2
    v_add_u32 v2, s68, v2
    v_add_u32 v3, 8192, v2
    v_mov_b32 v4, 0
    v_mov_b32 v5, 0
    v_mov_b32 v6, 0
    v_mov_b32 v7, 0
    global_load_ushort v124, v2, s[66:67] offset:0
    global_load_short_d16_hi v4, v3, s[66:67] offset:0
    global_load_ushort v125, v2, s[66:67] offset:256
    global_load_short_d16_hi v5, v3, s[66:67] offset:256
    global_load_ushort v126, v2, s[66:67] offset:512
    global_load_short_d16_hi v6, v3, s[66:67] offset:512
    global_load_ushort v127, v2, s[66:67] offset:768
    global_load_short_d16_hi v7, v3, s[66:67] offset:768
    s_add_u32 s22, s22, 1
    s_waitcnt vmcnt(0)
    v_or_b32 v124, v124, v4
    v_or_b32 v125, v125, v5
    v_or_b32 v126, v126, v6
    v_or_b32 v127, v127, v7
    s_mul_i32 s24, s22, 3277
    s_lshr_b32 s24, s24, 16
    s_mul_i32 s68, s24, 20
    s_sub_u32 s68, s22, s68
    s_cmp_lt_u32 s68, 8
    s_cselect_b64 s[66:67], s[84:85], s[86:87]
    s_cselect_b32 s25, 0, 8
    s_sub_u32 s68, s68, s25
    s_and_b32 s25, s68, 1
    s_lshr_b32 s68, s68, 1
    s_lshl_b32 s68, s68, 14
    s_lshl_b32 s25, s25, 12
    s_add_u32 s68, s68, s25
    s_lshl_b32 s24, s24, 5
    s_add_u32 s68, s68, s24
    v_lshrrev_b32 v2, 4, v176
    v_lshlrev_b32 v2, 10, v2
    v_and_b32 v3, 15, v176
    v_lshl_add_u32 v2, v3, 1, v2
    v_add_u32 v2, s68, v2
    v_add_u32 v3, 8192, v2
    v_mov_b32 v4, 0
    v_mov_b32 v5, 0
    v_mov_b32 v6, 0
    v_mov_b32 v7, 0
    global_load_ushort v128, v2, s[66:67] offset:0
    global_load_short_d16_hi v4, v3, s[66:67] offset:0
    global_load_ushort v129, v2, s[66:67] offset:256
    global_load_short_d16_hi v5, v3, s[66:67] offset:256
    global_load_ushort v130, v2, s[66:67] offset:512
    global_load_short_d16_hi v6, v3, s[66:67] offset:512
    global_load_ushort v131, v2, s[66:67] offset:768
    global_load_short_d16_hi v7, v3, s[66:67] offset:768
    s_add_u32 s22, s22, 1
    s_waitcnt vmcnt(0)
    v_or_b32 v128, v128, v4
    v_or_b32 v129, v129, v5
    v_or_b32 v130, v130, v6
    v_or_b32 v131, v131, v7
    s_mul_i32 s24, s22, 3277
    s_lshr_b32 s24, s24, 16
    s_mul_i32 s68, s24, 20
    s_sub_u32 s68, s22, s68
    s_cmp_lt_u32 s68, 8
    s_cselect_b64 s[66:67], s[84:85], s[86:87]
    s_cselect_b32 s25, 0, 8
    s_sub_u32 s68, s68, s25
    s_and_b32 s25, s68, 1
    s_lshr_b32 s68, s68, 1
    s_lshl_b32 s68, s68, 14
    s_lshl_b32 s25, s25, 12
    s_add_u32 s68, s68, s25
    s_lshl_b32 s24, s24, 5
    s_add_u32 s68, s68, s24
    v_lshrrev_b32 v2, 4, v176
    v_lshlrev_b32 v2, 10, v2
    v_and_b32 v3, 15, v176
    v_lshl_add_u32 v2, v3, 1, v2
    v_add_u32 v2, s68, v2
    v_add_u32 v3, 8192, v2
    v_mov_b32 v4, 0
    v_mov_b32 v5, 0
    v_mov_b32 v6, 0
    v_mov_b32 v7, 0
    global_load_ushort v132, v2, s[66:67] offset:0
    global_load_short_d16_hi v4, v3, s[66:67] offset:0
    global_load_ushort v133, v2, s[66:67] offset:256
    global_load_short_d16_hi v5, v3, s[66:67] offset:256
    global_load_ushort v134, v2, s[66:67] offset:512
    global_load_short_d16_hi v6, v3, s[66:67] offset:512
    global_load_ushort v135, v2, s[66:67] offset:768
    global_load_short_d16_hi v7, v3, s[66:67] offset:768
    s_add_u32 s22, s22, 1
    s_waitcnt vmcnt(0)
    v_or_b32 v132, v132, v4
    v_or_b32 v133, v133, v5
    v_or_b32 v134, v134, v6
    v_or_b32 v135, v135, v7
    s_mul_i32 s24, s22, 3277
    s_lshr_b32 s24, s24, 16
    s_mul_i32 s68, s24, 20
    s_sub_u32 s68, s22, s68
    s_cmp_lt_u32 s68, 8
    s_cselect_b64 s[66:67], s[84:85], s[86:87]
    s_cselect_b32 s25, 0, 8
    s_sub_u32 s68, s68, s25
    s_and_b32 s25, s68, 1
    s_lshr_b32 s68, s68, 1
    s_lshl_b32 s68, s68, 14
    s_lshl_b32 s25, s25, 12
    s_add_u32 s68, s68, s25
    s_lshl_b32 s24, s24, 5
    s_add_u32 s68, s68, s24
    v_lshrrev_b32 v2, 4, v176
    v_lshlrev_b32 v2, 10, v2
    v_and_b32 v3, 15, v176
    v_lshl_add_u32 v2, v3, 1, v2
    v_add_u32 v2, s68, v2
    v_add_u32 v3, 8192, v2
    v_mov_b32 v4, 0
    v_mov_b32 v5, 0
    v_mov_b32 v6, 0
    v_mov_b32 v7, 0
    global_load_ushort v152, v2, s[66:67] offset:0
    global_load_short_d16_hi v4, v3, s[66:67] offset:0
    global_load_ushort v153, v2, s[66:67] offset:256
    global_load_short_d16_hi v5, v3, s[66:67] offset:256
    global_load_ushort v154, v2, s[66:67] offset:512
    global_load_short_d16_hi v6, v3, s[66:67] offset:512
    global_load_ushort v155, v2, s[66:67] offset:768
    global_load_short_d16_hi v7, v3, s[66:67] offset:768
    s_add_u32 s22, s22, 1
    s_waitcnt vmcnt(0)
    v_or_b32 v152, v152, v4
    v_or_b32 v153, v153, v5
    v_or_b32 v154, v154, v6
    v_or_b32 v155, v155, v7
    s_mul_i32 s24, s22, 3277
    s_lshr_b32 s24, s24, 16
    s_mul_i32 s68, s24, 20
    s_sub_u32 s68, s22, s68
    s_cmp_lt_u32 s68, 8
    s_cselect_b64 s[66:67], s[84:85], s[86:87]
    s_cselect_b32 s25, 0, 8
    s_sub_u32 s68, s68, s25
    s_and_b32 s25, s68, 1
    s_lshr_b32 s68, s68, 1
    s_lshl_b32 s68, s68, 14
    s_lshl_b32 s25, s25, 12
    s_add_u32 s68, s68, s25
    s_lshl_b32 s24, s24, 5
    s_add_u32 s68, s68, s24
    v_lshrrev_b32 v2, 4, v176
    v_lshlrev_b32 v2, 10, v2
    v_and_b32 v3, 15, v176
    v_lshl_add_u32 v2, v3, 1, v2
    v_add_u32 v2, s68, v2
    v_add_u32 v3, 8192, v2
    v_mov_b32 v4, 0
    v_mov_b32 v5, 0
    v_mov_b32 v6, 0
    v_mov_b32 v7, 0
    global_load_ushort v156, v2, s[66:67] offset:0
    global_load_short_d16_hi v4, v3, s[66:67] offset:0
    global_load_ushort v157, v2, s[66:67] offset:256
    global_load_short_d16_hi v5, v3, s[66:67] offset:256
    global_load_ushort v158, v2, s[66:67] offset:512
    global_load_short_d16_hi v6, v3, s[66:67] offset:512
    global_load_ushort v159, v2, s[66:67] offset:768
    global_load_short_d16_hi v7, v3, s[66:67] offset:768
    s_add_u32 s22, s22, 1
    s_waitcnt vmcnt(0)
    v_or_b32 v156, v156, v4
    v_or_b32 v157, v157, v5
    v_or_b32 v158, v158, v6
    v_or_b32 v159, v159, v7
    s_mul_i32 s24, s22, 3277
    s_lshr_b32 s24, s24, 16
    s_mul_i32 s68, s24, 20
    s_sub_u32 s68, s22, s68
    s_cmp_lt_u32 s68, 8
    s_cselect_b64 s[66:67], s[84:85], s[86:87]
    s_cselect_b32 s25, 0, 8
    s_sub_u32 s68, s68, s25
    s_and_b32 s25, s68, 1
    s_lshr_b32 s68, s68, 1
    s_lshl_b32 s68, s68, 14
    s_lshl_b32 s25, s25, 12
    s_add_u32 s68, s68, s25
    s_lshl_b32 s24, s24, 5
    s_add_u32 s68, s68, s24
    v_lshrrev_b32 v2, 4, v176
    v_lshlrev_b32 v2, 10, v2
    v_and_b32 v3, 15, v176
    v_lshl_add_u32 v2, v3, 1, v2
    v_add_u32 v2, s68, v2
    v_add_u32 v3, 8192, v2
    v_mov_b32 v4, 0
    v_mov_b32 v5, 0
    v_mov_b32 v6, 0
    v_mov_b32 v7, 0
    global_load_ushort v136, v2, s[66:67] offset:0
    global_load_short_d16_hi v4, v3, s[66:67] offset:0
    global_load_ushort v137, v2, s[66:67] offset:256
    global_load_short_d16_hi v5, v3, s[66:67] offset:256
    global_load_ushort v138, v2, s[66:67] offset:512
    global_load_short_d16_hi v6, v3, s[66:67] offset:512
    global_load_ushort v139, v2, s[66:67] offset:768
    global_load_short_d16_hi v7, v3, s[66:67] offset:768
    s_add_u32 s22, s22, 1
    s_waitcnt vmcnt(0)
    v_or_b32 v136, v136, v4
    v_or_b32 v137, v137, v5
    v_or_b32 v138, v138, v6
    v_or_b32 v139, v139, v7
    s_mul_i32 s24, s22, 3277
    s_lshr_b32 s24, s24, 16
    s_mul_i32 s68, s24, 20
    s_sub_u32 s68, s22, s68
    s_cmp_lt_u32 s68, 8
    s_cselect_b64 s[66:67], s[84:85], s[86:87]
    s_cselect_b32 s25, 0, 8
    s_sub_u32 s68, s68, s25
    s_and_b32 s25, s68, 1
    s_lshr_b32 s68, s68, 1
    s_lshl_b32 s68, s68, 14
    s_lshl_b32 s25, s25, 12
    s_add_u32 s68, s68, s25
    s_lshl_b32 s24, s24, 5
    s_add_u32 s68, s68, s24
    v_lshrrev_b32 v2, 4, v176
    v_lshlrev_b32 v2, 10, v2
    v_and_b32 v3, 15, v176
    v_lshl_add_u32 v2, v3, 1, v2
    v_add_u32 v2, s68, v2
    v_add_u32 v3, 8192, v2
    v_mov_b32 v4, 0
    v_mov_b32 v5, 0
    v_mov_b32 v6, 0
    v_mov_b32 v7, 0
    global_load_ushort v140, v2, s[66:67] offset:0
    global_load_short_d16_hi v4, v3, s[66:67] offset:0
    global_load_ushort v141, v2, s[66:67] offset:256
    global_load_short_d16_hi v5, v3, s[66:67] offset:256
    global_load_ushort v142, v2, s[66:67] offset:512
    global_load_short_d16_hi v6, v3, s[66:67] offset:512
    global_load_ushort v143, v2, s[66:67] offset:768
    global_load_short_d16_hi v7, v3, s[66:67] offset:768
    s_add_u32 s22, s22, 1
    s_waitcnt vmcnt(0)
    v_or_b32 v140, v140, v4
    v_or_b32 v141, v141, v5
    v_or_b32 v142, v142, v6
    v_or_b32 v143, v143, v7
    s_mul_i32 s24, s22, 3277
    s_lshr_b32 s24, s24, 16
    s_mul_i32 s68, s24, 20
    s_sub_u32 s68, s22, s68
    s_cmp_lt_u32 s68, 8
    s_cselect_b64 s[66:67], s[84:85], s[86:87]
    s_cselect_b32 s25, 0, 8
    s_sub_u32 s68, s68, s25
    s_and_b32 s25, s68, 1
    s_lshr_b32 s68, s68, 1
    s_lshl_b32 s68, s68, 14
    s_lshl_b32 s25, s25, 12
    s_add_u32 s68, s68, s25
    s_lshl_b32 s24, s24, 5
    s_add_u32 s68, s68, s24
    v_lshrrev_b32 v2, 4, v176
    v_lshlrev_b32 v2, 10, v2
    v_and_b32 v3, 15, v176
    v_lshl_add_u32 v2, v3, 1, v2
    v_add_u32 v2, s68, v2
    v_add_u32 v3, 8192, v2
    v_mov_b32 v4, 0
    v_mov_b32 v5, 0
    v_mov_b32 v6, 0
    v_mov_b32 v7, 0
    global_load_ushort v168, v2, s[66:67] offset:0
    global_load_short_d16_hi v4, v3, s[66:67] offset:0
    global_load_ushort v169, v2, s[66:67] offset:256
    global_load_short_d16_hi v5, v3, s[66:67] offset:256
    global_load_ushort v170, v2, s[66:67] offset:512
    global_load_short_d16_hi v6, v3, s[66:67] offset:512
    global_load_ushort v171, v2, s[66:67] offset:768
    global_load_short_d16_hi v7, v3, s[66:67] offset:768
    s_add_u32 s22, s22, 1
    s_waitcnt vmcnt(0)
    v_or_b32 v168, v168, v4
    v_or_b32 v169, v169, v5
    v_or_b32 v170, v170, v6
    v_or_b32 v171, v171, v7
    s_mul_i32 s24, s22, 3277
    s_lshr_b32 s24, s24, 16
    s_mul_i32 s68, s24, 20
    s_sub_u32 s68, s22, s68
    s_cmp_lt_u32 s68, 8
    s_cselect_b64 s[66:67], s[84:85], s[86:87]
    s_cselect_b32 s25, 0, 8
    s_sub_u32 s68, s68, s25
    s_and_b32 s25, s68, 1
    s_lshr_b32 s68, s68, 1
    s_lshl_b32 s68, s68, 14
    s_lshl_b32 s25, s25, 12
    s_add_u32 s68, s68, s25
    s_lshl_b32 s24, s24, 5
    s_add_u32 s68, s68, s24
    v_lshrrev_b32 v2, 4, v176
    v_lshlrev_b32 v2, 10, v2
    v_and_b32 v3, 15, v176
    v_lshl_add_u32 v2, v3, 1, v2
    v_add_u32 v2, s68, v2
    v_add_u32 v3, 8192, v2
    v_mov_b32 v4, 0
    v_mov_b32 v5, 0
    v_mov_b32 v6, 0
    v_mov_b32 v7, 0
    global_load_ushort v172, v2, s[66:67] offset:0
    global_load_short_d16_hi v4, v3, s[66:67] offset:0
    global_load_ushort v173, v2, s[66:67] offset:256
    global_load_short_d16_hi v5, v3, s[66:67] offset:256
    global_load_ushort v174, v2, s[66:67] offset:512
    global_load_short_d16_hi v6, v3, s[66:67] offset:512
    global_load_ushort v175, v2, s[66:67] offset:768
    global_load_short_d16_hi v7, v3, s[66:67] offset:768
    s_add_u32 s22, s22, 1
    s_waitcnt vmcnt(0)
    v_or_b32 v172, v172, v4
    v_or_b32 v173, v173, v5
    v_or_b32 v174, v174, v6
    v_or_b32 v175, v175, v7
    s_mul_i32 s24, s22, 3277
    s_lshr_b32 s24, s24, 16
    s_mul_i32 s68, s24, 20
    s_sub_u32 s68, s22, s68
    s_cmp_lt_u32 s68, 8
    s_cselect_b64 s[66:67], s[84:85], s[86:87]
    s_cselect_b32 s25, 0, 8
    s_sub_u32 s68, s68, s25
    s_and_b32 s25, s68, 1
    s_lshr_b32 s68, s68, 1
    s_lshl_b32 s68, s68, 14
    s_lshl_b32 s25, s25, 12
    s_add_u32 s68, s68, s25
    s_lshl_b32 s24, s24, 5
    s_add_u32 s68, s68, s24
    v_lshrrev_b32 v2, 4, v176
    v_lshlrev_b32 v2, 10, v2
    v_and_b32 v3, 15, v176
    v_lshl_add_u32 v2, v3, 1, v2
    v_add_u32 v2, s68, v2
    v_add_u32 v3, 8192, v2
    v_mov_b32 v4, 0
    v_mov_b32 v5, 0
    v_mov_b32 v6, 0
    v_mov_b32 v7, 0
    global_load_ushort v112, v2, s[66:67] offset:0
    global_load_short_d16_hi v4, v3, s[66:67] offset:0
    global_load_ushort v113, v2, s[66:67] offset:256
    global_load_short_d16_hi v5, v3, s[66:67] offset:256
    global_load_ushort v114, v2, s[66:67] offset:512
    global_load_short_d16_hi v6, v3, s[66:67] offset:512
    global_load_ushort v115, v2, s[66:67] offset:768
    global_load_short_d16_hi v7, v3, s[66:67] offset:768
    s_add_u32 s22, s22, 1
    s_waitcnt vmcnt(0)
    v_or_b32 v112, v112, v4
    v_or_b32 v113, v113, v5
    v_or_b32 v114, v114, v6
    v_or_b32 v115, v115, v7
    s_mul_i32 s24, s22, 3277
    s_lshr_b32 s24, s24, 16
    s_mul_i32 s68, s24, 20
    s_sub_u32 s68, s22, s68
    s_cmp_lt_u32 s68, 8
    s_cselect_b64 s[66:67], s[84:85], s[86:87]
    s_cselect_b32 s25, 0, 8
    s_sub_u32 s68, s68, s25
    s_and_b32 s25, s68, 1
    s_lshr_b32 s68, s68, 1
    s_lshl_b32 s68, s68, 14
    s_lshl_b32 s25, s25, 12
    s_add_u32 s68, s68, s25
    s_lshl_b32 s24, s24, 5
    s_add_u32 s68, s68, s24
    v_lshrrev_b32 v2, 4, v176
    v_lshlrev_b32 v2, 10, v2
    v_and_b32 v3, 15, v176
    v_lshl_add_u32 v2, v3, 1, v2
    v_add_u32 v2, s68, v2
    v_add_u32 v3, 8192, v2
    v_mov_b32 v4, 0
    v_mov_b32 v5, 0
    v_mov_b32 v6, 0
    v_mov_b32 v7, 0
    global_load_ushort v116, v2, s[66:67] offset:0
    global_load_short_d16_hi v4, v3, s[66:67] offset:0
    global_load_ushort v117, v2, s[66:67] offset:256
    global_load_short_d16_hi v5, v3, s[66:67] offset:256
    global_load_ushort v118, v2, s[66:67] offset:512
    global_load_short_d16_hi v6, v3, s[66:67] offset:512
    global_load_ushort v119, v2, s[66:67] offset:768
    global_load_short_d16_hi v7, v3, s[66:67] offset:768
    s_add_u32 s22, s22, 1
    s_waitcnt vmcnt(0)
    v_or_b32 v116, v116, v4
    v_or_b32 v117, v117, v5
    v_or_b32 v118, v118, v6
    v_or_b32 v119, v119, v7
    s_load_dwordx2 s[72:73], s[0:1], 72
    v_lshlrev_b32 v246, 4, v176
    s_mov_b32 s52, 163072
    v_bfe_u32 v177, v246, 4, 4
    v_bfe_u32 v179, v246, 4, 3
    v_lshl_add_u32 v180, v177, 3, s52
    v_lshl_add_u32 v190, v177, 4, s52
    v_lshl_add_u32 v181, v179, 3, s52
    ds_read2_b64 v[182:185], v180 offset0:32 offset1:48
    ds_read_b32 v191, v190
    ds_read_b64 v[186:187], v181 offset:512
    v_lshrrev_b32 v178, 8, v246
    s_add_u32 s22, s20, 0
    s_mul_i32 s28, s22, 1536
    s_add_u32 s28, s28, 86016
    s_lshl_b32 s22, s22, 21
    s_add_u32 s23, s20, 8
    s_mul_i32 s29, s23, 1536
    s_add_u32 s29, s29, 86144
    s_lshl_b32 s23, s23, 21
    s_add_u32 s24, s20, 16
    s_mul_i32 s30, s24, 1536
    s_add_u32 s30, s30, 86016
    s_lshl_b32 s24, s24, 21
    s_add_u32 s25, s20, 24
    s_lshl_b32 s25, s25, 21
    s_add_u32 s26, s20, 32
    s_lshl_b32 s26, s26, 21
    s_mov_b32 s53, 0
    s_mov_b32 s50, 0
    s_waitcnt lgkmcnt(0)
    s_branch GEMM
.section .rodata,"a"
.p2align 6
.amdhsa_kernel standalone__tensor_product_equiv_equiformer__graph_kernel
  .amdhsa_next_free_vgpr 256
  .amdhsa_next_free_sgpr 90
  .amdhsa_accum_offset 256
  .amdhsa_group_segment_fixed_size 0
  .amdhsa_kernarg_size 96
  .amdhsa_user_sgpr_count 2
  .amdhsa_user_sgpr_kernarg_segment_ptr 1
  .amdhsa_system_sgpr_workgroup_id_x 1
.end_amdhsa_kernel
```

```asm
; @launch grid=(250,1,1) block=(512,1,1) lds=163840
.amdgcn_target "amdgcn-amd-amdhsa--gfx950"
.text
.globl standalone__tensor_product_equiv_equiformer__graph_kernel
.p2align 8
.type standalone__tensor_product_equiv_equiformer__graph_kernel,@function
standalone__tensor_product_equiv_equiformer__graph_kernel:
    s_cmp_ge_u32 s2, 250
    s_cbranch_scc1 K2_end
    s_load_dwordx16 s[72:87], s[0:1], 0
    s_load_dwordx2 s[70:71], s[0:1], 88
    v_lshrrev_b32 v2, 6, v0
    v_and_b32 v1, 63, v0
    v_readfirstlane_b32 s20, v2
    s_getpc_b64 s[66:67]
    v_lshlrev_b32 v95, 7, v1
    s_cmp_eq_u32 s20, 6
    s_cbranch_scc0 F_nopf0
    global_load_dword v95, v95, s[66:67]
F_nopf0:
    s_mul_i32 s66, s2, 5120
    s_mul_i32 s67, s2, 7680
    v_lshl_add_u32 v3, v0, 4, s66
    v_mul_u32_u24 v4, 24, v0
    v_add_u32 v4, s67, v4
    v_lshlrev_b32 v5, 2, v0
    v_mov_b32 v89, 0
    v_add_u32 v6, 98304, v5
    ds_write_b32 v6, v89
    s_cmp_ge_u32 s20, 5
    s_waitcnt lgkmcnt(0)
    s_cbranch_scc1 F_noload
    global_load_dwordx4 v[8:11], v3, s[80:81] nt
    global_load_dwordx4 v[12:15], v3, s[78:79] nt
    global_load_dwordx4 v[16:19], v4, s[74:75] nt
    global_load_dwordx2 v[20:21], v4, s[74:75] offset:16 nt
F_noload:
    s_load_dword s88, s[70:71], 0
    s_barrier
    v_lshlrev_b32 v248, 2, v1
    v_add_u32 v88, 162816, v248
    ds_write_b32 v88, v89
    ds_write_b32 v88, v89 offset:256
    v_lshlrev_b32 v86, 4, v1
    s_lshl_b32 s21, s20, 13
    s_lshl_b32 s66, s20, 10
    s_add_u32 s66, s66, 0
    v_add_u32 v96, s66, v86
    v_lshrrev_b32 v6, 8, v96
    v_mul_u32_u24 v6, 205, v6
    v_bfe_u32 v7, v6, 12, 1
    v_bfe_u32 v6, v6, 10, 1
    v_lshl_or_b32 v6, v7, 1, v6
    v_lshlrev_b32 v6, 6, v6
    v_xor_b32 v96, v96, v6
    s_lshl_b32 s66, s20, 10
    s_add_u32 s66, s66, 8192
    v_add_u32 v97, s66, v86
    v_lshrrev_b32 v6, 8, v97
    v_mul_u32_u24 v6, 205, v6
    v_bfe_u32 v7, v6, 12, 1
    v_bfe_u32 v6, v6, 10, 1
    v_lshl_or_b32 v6, v7, 1, v6
    v_lshlrev_b32 v6, 6, v6
    v_xor_b32 v97, v97, v6
    s_lshl_b32 s66, s20, 10
    s_add_u32 s66, s66, 16384
    v_add_u32 v98, s66, v86
    v_lshrrev_b32 v6, 8, v98
    v_mul_u32_u24 v6, 205, v6
    v_bfe_u32 v7, v6, 12, 1
    v_bfe_u32 v6, v6, 10, 1
    v_lshl_or_b32 v6, v7, 1, v6
    v_lshlrev_b32 v6, 6, v6
    v_xor_b32 v98, v98, v6
    v_mov_b32 v180, 0
    v_mov_b32 v181, 0
    v_mov_b32 v182, 0
    v_mov_b32 v183, 0
    s_mov_b32 s16, s70
    s_and_b32 s17, s71, 0xffff
    s_mov_b32 s18, 24165888
    s_mov_b32 s19, 0x20000
    v_lshrrev_b32 v2, 3, v1
    v_lshl_add_u32 v2, s20, 5, v2
    v_and_b32 v91, 7, v1
    v_mul_u32_u24 v94, 384, v2
    v_lshl_add_u32 v94, v91, 4, v94
    v_lshlrev_b32 v93, 2, v2
    v_add_u32 v93, 98304, v93
    v_mul_u32_u24 v92, 32000, v2
    v_lshl_add_u32 v92, v91, 4, v92
    v_mul_u32_u24 v90, 40960, v2
    s_mov_b32 s32, s82
    s_and_b32 s33, s83, 0xffff
    s_mov_b32 s34, 20480
    s_mov_b32 s35, 0x20000
    s_cmp_ge_u32 s20, 5
    s_cbranch_scc1 F_helper
    s_mov_b32 s22, 52429
    s_mov_b32 s23, 0x05040100
    s_mov_b32 s66, 98304
    s_movk_i32 s67, -40
    v_mov_b32 v7, 1
    v_add_u32 v31, 1, v5
    v_add_u32 v32, 2, v5
    v_add_u32 v33, 3, v5
    s_waitcnt vmcnt(3)
    v_mul_u32_u24 v22, s22, v8
    v_mul_u32_u24 v23, s22, v9
    v_mul_u32_u24 v24, s22, v10
    v_mul_u32_u24 v25, s22, v11
    v_lshrrev_b32 v22, 21, v22
    v_lshrrev_b32 v23, 21, v23
    v_lshrrev_b32 v24, 21, v24
    v_lshrrev_b32 v25, 21, v25
    v_lshl_add_u32 v34, v22, 2, s66
    ds_add_rtn_u32 v26, v34, v7
    v_lshl_add_u32 v35, v23, 2, s66
    ds_add_rtn_u32 v27, v35, v7
    v_lshl_add_u32 v36, v24, 2, s66
    ds_add_rtn_u32 v28, v36, v7
    v_lshl_add_u32 v37, v25, 2, s66
    ds_add_rtn_u32 v29, v37, v7
    v_mad_i32_i24 v2, v22, s67, v8
    v_mul_u32_u24 v22, 384, v22
    v_lshl_or_b32 v42, v2, 11, v5
    v_mad_i32_i24 v2, v23, s67, v9
    v_mul_u32_u24 v23, 384, v23
    v_lshl_or_b32 v46, v2, 11, v31
    v_mad_i32_i24 v2, v24, s67, v10
    v_mul_u32_u24 v24, 384, v24
    v_lshl_or_b32 v50, v2, 11, v32
    v_mad_i32_i24 v2, v25, s67, v11
    v_mul_u32_u24 v25, 384, v25
    v_lshl_or_b32 v54, v2, 11, v33
    s_waitcnt vmcnt(0)
    v_mov_b32 v40, v16
    v_perm_b32 v41, v12, v17, s23
    v_alignbit_b32 v44, v18, v17, 16
    v_alignbit_b32 v45, v13, v18, 16
    v_mov_b32 v48, v19
    v_perm_b32 v49, v14, v20, s23
    v_alignbit_b32 v52, v21, v20, 16
    v_alignbit_b32 v53, v15, v21, 16
    v_xor_b32 v41, 0x8000, v41
    v_xor_b32 v45, 0x8000, v45
    v_xor_b32 v49, 0x8000, v49
    v_xor_b32 v53, 0x8000, v53
    s_waitcnt lgkmcnt(0)
    v_min_u32 v26, 23, v26
    v_lshl_add_u32 v34, v26, 4, v22
    ds_write_b128 v34, v[40:43]
    v_min_u32 v27, 23, v27
    v_lshl_add_u32 v35, v27, 4, v23
    ds_write_b128 v35, v[44:47]
    v_min_u32 v28, 23, v28
    v_lshl_add_u32 v36, v28, 4, v24
    ds_write_b128 v36, v[48:51]
    v_min_u32 v29, 23, v29
    v_lshl_add_u32 v37, v29, 4, v25
    ds_write_b128 v37, v[52:55]
    s_branch F_staged
F_helper:
    s_cmp_eq_u32 s20, 5
    s_cbranch_scc0 F_nowp
    v_lshlrev_b32 v2, 7, v1
    s_movk_i32 s66, 0
    buffer_load_dword v95, v2, s[32:35], s66 offen
    s_movk_i32 s66, 8192
    buffer_load_dword v95, v2, s[32:35], s66 offen
    s_movk_i32 s66, 16384
    v_min_u32 v2, 3968, v2
    buffer_load_dword v95, v2, s[32:35], s66 offen
F_nowp:
    s_cmp_eq_u32 s20, 6
    s_cbranch_scc0 F_nopf
    s_getpc_b64 s[66:67]
F_pc:
    s_lshr_b32 s68, s2, 3
    s_mul_i32 s68, s68, ((K2_last-F_pc)/128/31+1)*128
    v_lshl_add_u32 v2, v1, 7, s68
    v_min_u32 v2, K2_last-F_pc-4, v2
    v_cmp_gt_u32 vcc, (K2_last-F_pc)/128/31+1, v1
    s_mov_b64 exec, vcc
    global_load_dword v95, v2, s[66:67]
    s_mov_b64 exec, -1
F_nopf:
    s_cmp_eq_u32 s20, 7
    s_cbranch_scc0 F_staged
    s_cmp_lt_u32 s2, 160
    s_cbranch_scc0 F_staged
    s_mul_i32 s22, s2, 3277
    s_lshr_b32 s22, s22, 16
    s_mul_i32 s68, s22, 20
    s_sub_u32 s68, s2, s68
    s_cmp_lt_u32 s68, 8
    s_cselect_b64 s[66:67], s[84:85], s[86:87]
    s_cselect_b32 s23, 0, 8
    s_sub_u32 s68, s68, s23
    s_and_b32 s23, s68, 1
    s_lshr_b32 s68, s68, 1
    s_lshl_b32 s68, s68, 14
    s_lshl_b32 s23, s23, 12
    s_add_u32 s68, s68, s23
    s_lshl_b32 s22, s22, 5
    s_add_u32 s68, s68, s22
    v_lshrrev_b32 v2, 4, v1
    v_lshlrev_b32 v2, 10, v2
    v_and_b32 v3, 15, v1
    v_lshl_add_u32 v2, v3, 1, v2
    v_add_u32 v2, s68, v2
    v_add_u32 v3, 8192, v2
    global_load_ushort v176, v2, s[66:67] offset:0
    global_load_short_d16_hi v180, v3, s[66:67] offset:0
    global_load_ushort v177, v2, s[66:67] offset:256
    global_load_short_d16_hi v181, v3, s[66:67] offset:256
    global_load_ushort v178, v2, s[66:67] offset:512
    global_load_short_d16_hi v182, v3, s[66:67] offset:512
    global_load_ushort v179, v2, s[66:67] offset:768
    global_load_short_d16_hi v183, v3, s[66:67] offset:768
F_staged:
    s_lshl_b32 s66, s2, 7
    s_add_u32 s66, s66, 164864
    s_cmp_eq_u32 s20, 7
    s_cselect_b32 s22, 0xffff, -1
    s_cselect_b32 s23, 0, -1
    s_waitcnt lgkmcnt(0)
    s_add_u32 s88, s88, 1
    s_barrier
    s_setprio 1
    ds_read_b32 v40, v93 offset:0
    ds_read_b128 v[8:11], v94 offset:0
    ds_read_b32 v14, v94 offset:136
    ds_read_b32 v41, v93 offset:32
    ds_read_b128 v[16:19], v94 offset:3072
    ds_read_b32 v22, v94 offset:3208
    ds_read_b32 v42, v93 offset:64
    ds_read_b128 v[24:27], v94 offset:6144
    ds_read_b32 v30, v94 offset:6280
    ds_read_b32 v43, v93 offset:96
    ds_read_b128 v[32:35], v94 offset:9216
    ds_read_b32 v38, v94 offset:9352
    s_add_u32 s28, s66, 0
    s_add_u32 s29, s66, 256000
    s_add_u32 s30, s66, 512000
    s_add_u32 s31, s66, 768000
    s_waitcnt lgkmcnt(9)
    v_min_u32 v5, 31, v40
    v_bfe_u32 v6, v14, 11, 6
    v_and_b32 v10, 0x1ffff, v10
    v_lshl_or_b32 v6, v5, 6, v6
    v_mov_b32 v11, s88
    v_lshl_or_b32 v10, v6, 17, v10
    buffer_store_dwordx4 v[8:11], v92, s[16:19], s28 offen sc1
    s_waitcnt lgkmcnt(6)
    v_min_u32 v5, 31, v41
    v_bfe_u32 v6, v22, 11, 6
    v_and_b32 v18, 0x1ffff, v18
    v_lshl_or_b32 v6, v5, 6, v6
    v_mov_b32 v19, s88
    v_lshl_or_b32 v18, v6, 17, v18
    buffer_store_dwordx4 v[16:19], v92, s[16:19], s29 offen sc1
    s_waitcnt lgkmcnt(3)
    v_min_u32 v5, 31, v42
    v_bfe_u32 v6, v30, 11, 6
    v_and_b32 v26, 0x1ffff, v26
    v_lshl_or_b32 v6, v5, 6, v6
    v_mov_b32 v27, s88
    v_lshl_or_b32 v26, v6, 17, v26
    buffer_store_dwordx4 v[24:27], v92, s[16:19], s30 offen sc1
    s_waitcnt lgkmcnt(0)
    v_min_u32 v5, 31, v43
    v_bfe_u32 v6, v38, 11, 6
    v_and_b32 v34, 0x1ffff, v34
    v_lshl_or_b32 v6, v5, 6, v6
    v_mov_b32 v35, s88
    v_lshl_or_b32 v34, v6, 17, v34
    s_mov_b64 exec, s[22:23]
    buffer_store_dwordx4 v[32:35], v92, s[16:19], s31 offen sc1
    s_mov_b64 exec, -1
    s_setprio 0
    ds_read_b128 v[12:15], v94 offset:128
    ds_read_b128 v[20:23], v94 offset:3200
    ds_read_b128 v[28:31], v94 offset:6272
    ds_read_b128 v[36:39], v94 offset:9344
    s_waitcnt vmcnt(4)
F_now:
    v_cmp_lt_u32 vcc, 8, v40
    s_add_u32 s67, s28, 8000000
    s_waitcnt lgkmcnt(3)
    v_mov_b32 v15, s88
    s_mov_b64 exec, vcc
    s_cbranch_execz F_w0
    buffer_store_dwordx4 v[12:15], v92, s[16:19], s67 offen sc1
    v_cmp_lt_u32 vcc, 16, v40
    s_add_u32 s67, s67, 8000000
    s_mov_b64 exec, vcc
    s_cbranch_execz F_w0
    ds_read_b128 v[44:47], v94 offset:256
    s_waitcnt lgkmcnt(0)
    v_mov_b32 v47, s88
    buffer_store_dwordx4 v[44:47], v92, s[16:19], s67 offen sc1
    s_nop 1
F_w0:
    s_mov_b64 exec, -1
    v_cmp_lt_u32 vcc, 8, v41
    s_add_u32 s67, s29, 8000000
    s_waitcnt lgkmcnt(2)
    v_mov_b32 v23, s88
    s_mov_b64 exec, vcc
    s_cbranch_execz F_w1
    buffer_store_dwordx4 v[20:23], v92, s[16:19], s67 offen sc1
    v_cmp_lt_u32 vcc, 16, v41
    s_add_u32 s67, s67, 8000000
    s_mov_b64 exec, vcc
    s_cbranch_execz F_w1
    ds_read_b128 v[44:47], v94 offset:3328
    s_waitcnt lgkmcnt(0)
    v_mov_b32 v47, s88
    buffer_store_dwordx4 v[44:47], v92, s[16:19], s67 offen sc1
    s_nop 1
F_w1:
    s_mov_b64 exec, -1
    v_cmp_lt_u32 vcc, 8, v42
    s_add_u32 s67, s30, 8000000
    s_waitcnt lgkmcnt(1)
    v_mov_b32 v31, s88
    s_mov_b64 exec, vcc
    s_cbranch_execz F_w2
    buffer_store_dwordx4 v[28:31], v92, s[16:19], s67 offen sc1
    v_cmp_lt_u32 vcc, 16, v42
    s_add_u32 s67, s67, 8000000
    s_mov_b64 exec, vcc
    s_cbranch_execz F_w2
    ds_read_b128 v[44:47], v94 offset:6400
    s_waitcnt lgkmcnt(0)
    v_mov_b32 v47, s88
    buffer_store_dwordx4 v[44:47], v92, s[16:19], s67 offen sc1
    s_nop 1
F_w2:
    s_mov_b64 exec, -1
    v_cmp_lt_u32 vcc, 8, v43
    s_add_u32 s67, s31, 8000000
    s_and_b64 vcc, vcc, s[22:23]
    s_waitcnt lgkmcnt(0)
    v_mov_b32 v39, s88
    s_mov_b64 exec, vcc
    s_cbranch_execz F_w3
    buffer_store_dwordx4 v[36:39], v92, s[16:19], s67 offen sc1
    v_cmp_lt_u32 vcc, 16, v43
    s_add_u32 s67, s67, 8000000
    s_mov_b64 exec, vcc
    s_cbranch_execz F_w3
    ds_read_b128 v[44:47], v94 offset:9472
    s_waitcnt lgkmcnt(0)
    v_mov_b32 v47, s88
    buffer_store_dwordx4 v[44:47], v92, s[16:19], s67 offen sc1
    s_nop 1
F_w3:
    s_mov_b64 exec, -1
    s_cmp_eq_u32 s20, 7
    s_cbranch_scc0 F_nofrag
    s_cmp_lt_u32 s2, 160
    s_cbranch_scc0 F_nofrag
    v_or_b32 v176, v176, v180
    v_or_b32 v177, v177, v181
    v_or_b32 v178, v178, v182
    v_or_b32 v179, v179, v183
    s_lshl_b32 s66, s2, 10
    s_add_u32 s66, s66, 1024
    buffer_store_dwordx4 v[176:179], v86, s[16:19], s66 offen sc1
F_nofrag:
    s_barrier
    s_mul_i32 s24, s2, 32000
    s_lshl_b32 s25, s20, 12
    s_add_u32 s24, s24, s25
    s_add_u32 s24, s24, 164864
    s_add_u32 s25, s24, 8000000
    s_add_u32 s26, s25, 8000000
    v_mov_b32 v22, 0
    v_mov_b32 v23, s88
    s_lshl_b32 s68, s20, 10
    s_add_u32 m0, s68, 65536
    s_nop 0
    buffer_load_dwordx4 v96, s[32:35], 0 offen lds
    s_add_u32 m0, s68, 73728
    s_nop 0
    buffer_load_dwordx4 v97, s[32:35], 0 offen lds
    s_cmp_ge_u32 s20, 4
    s_cbranch_scc1 F_now2
    s_add_u32 m0, s68, 81920
    s_nop 0
    buffer_load_dwordx4 v98, s[32:35], 0 offen lds
F_now2:
    v_mov_b32 v4, 2130738944
    v_mov_b32 v5, 2130738944
    v_mov_b32 v6, 2130738944
    v_mov_b32 v7, 2130738944
    v_lshlrev_b32 v2, 4, v0
    v_add_u32 v3, 86016, v2
    ds_write_b128 v3, v[4:7] offset:0
    ds_write_b128 v3, v[4:7] offset:8192
    ds_write_b128 v3, v[4:7] offset:16384
    ds_write_b128 v3, v[4:7] offset:24576
    ds_write_b128 v3, v[4:7] offset:32768
    ds_write_b128 v3, v[4:7] offset:40960
    ds_write_b128 v3, v[4:7] offset:49152
    ds_write_b128 v3, v[4:7] offset:57344
    v_add_u32 v3, 0x10000, v3
    ds_write_b128 v3, v[4:7] offset:0
    v_min_u32 v2, 3056, v2
    v_add_u32 v2, 159744, v2
    ds_write_b128 v2, v[4:7]
    s_sub_u32 s72, s72, 128
    s_subb_u32 s73, s73, 0
    s_mov_b32 s4, s72
    s_and_b32 s5, s73, 0xffff
    s_mov_b32 s6, 10240000
    s_mov_b32 s7, 0x20000
    s_sub_u32 s72, s72, 1024
    s_subb_u32 s73, s73, 0
    s_mov_b32 s8, s72
    s_and_b32 s9, s73, 0xffff
    s_mov_b32 s10, 10241024
    s_mov_b32 s11, 0x20000
    s_mov_b32 s12, s76
    s_and_b32 s13, s77, 0xffff
    s_mov_b32 s14, 10240000
    s_mov_b32 s15, 0x20000
    v_lshrrev_b32 v2, 5, v1
    v_bfe_u32 v3, v1, 2, 2
    v_and_b32 v4, 3, v1
    v_bfe_u32 v5, v1, 4, 1
    v_lshlrev_b32 v6, 9, v2
    v_lshl_add_u32 v6, v3, 7, v6
    v_lshl_add_u32 v6, v5, 5, v6
    v_lshl_add_u32 v6, v4, 3, v6
    v_lshrrev_b32 v7, 1, v3
    v_lshl_add_u32 v6, v7, 6, v6
    v_add_u32 v244, s21, v6
    v_xor_b32 v245, 64, v244
    v_lshlrev_b32 v6, 7, v2
    v_lshl_add_u32 v6, v7, 5, v6
    v_and_b32 v7, 1, v3
    v_xor_b32 v7, 1, v7
    v_mul_u32_u24 v7, 90112, v7
    v_add_u32 v6, v6, v7
    v_lshl_add_u32 v249, v4, 3, v6
    v_lshl_add_u32 v6, v2, 2, v4
    v_bfe_u32 v7, v1, 2, 1
    v_lshl_add_u32 v6, v7, 3, v6
    v_lshlrev_b32 v6, 3, v6
    v_bfe_u32 v7, v1, 3, 1
    v_add_u32 v5, 1, v5
    v_mul_u32_u24 v7, v7, v5
    v_lshl_add_u32 v250, v7, 1, v6
    v_and_b32 v6, 0x38, v1
    v_add_u32 v247, 4, v6
    v_lshrrev_b32 v6, 2, v1
    v_lshrrev_b32 v7, 4, v1
    v_xor_b32 v6, v6, v7
    v_and_b32 v6, 1, v6
    v_lshlrev_b32 v6, 6, v6
    v_lshl_add_u32 v246, v4, 4, v6
    v_mov_b32 v242, 1.0
    v_mov_b32 v243, 1.0
    s_mov_b32 s54, 0xffffff00
    s_mov_b32 s55, 0xffffff00
    s_mov_b32 s56, 0xffff
    s_mov_b32 s57, 0xffff
    s_mov_b32 s58, 0
    s_mov_b32 s59, 134217856
    s_mov_b32 s60, 262272
    s_mov_b32 s61, 402915456
    s_mov_b32 s62, 940179840
    s_mov_b32 s63, 403046528
    s_mov_b32 s64, 402784384
    s_mov_b32 s65, 134348928
    s_mov_b32 s38, 128
    s_mov_b32 s33, -1
    s_and_b32 s68, s20, 3
    s_lshl_b32 s68, s68, 2
    s_lshr_b32 s69, s20, 2
    s_add_u32 s68, s68, s69
    s_lshl_b32 s68, s68, 4
    s_add_u32 s68, s68, 163072
    v_mov_b32 v251, s68
    s_mov_b32 s53, 0
    s_mov_b32 s50, 0
    s_mov_b32 s51, 0
    s_mov_b32 s47, 0
    s_mov_b32 s42, 0
    s_mov_b32 s3, 0
    s_mov_b32 s89, 0
    s_mov_b32 s34, 128
    s_mov_b32 s35, 384
    s_mov_b32 s36, 640
    s_mov_b32 s37, 896
    s_movk_i32 s3, 1024
    s_waitcnt lgkmcnt(0)
    s_waitcnt vmcnt(0)
    s_barrier
    s_mov_b32 s27, 4096
    s_mov_b32 s71, 162816
    v_mov_b32 v3, 8
    s_cmp_eq_u32 s20, 7
    s_cselect_b32 s52, 160, 0
    v_cmp_gt_u32 s[68:69], 40, v1
    s_mov_b64 s[28:29], 0xff
    s_lshr_b32 s66, s2, 3
    s_lshl_b32 s66, s66, 3
    s_add_u32 s66, s66, s20
    s_mul_i32 s66, s66, 14
    v_min_u32 v93, 13, v1
    v_add_u32 v93, s66, v93
    v_lshlrev_b32 v93, 10, v93
    v_mov_b32 v94, 0x7f000000
    s_waitcnt lgkmcnt(0)
    buffer_load_dwordx4 v[8:11], v86, s[16:19], s24 offen offset:0 sc1
    buffer_load_dwordx4 v[12:15], v86, s[16:19], s24 offen offset:1024 sc1
    buffer_load_dwordx4 v[16:19], v86, s[16:19], s24 offen offset:2048 sc1
    s_mov_b64 exec, s[22:23]
    buffer_load_dwordx4 v[20:23], v86, s[16:19], s24 offen offset:3072 sc1
    s_mov_b64 exec, -1
    v_bfe_u32 v4, v248, 5, 1
    v_bfe_u32 v6, v248, 7, 1
    v_lshl_or_b32 v5, v6, 1, v4
    v_lshl_or_b32 v4, v6, 2, v4
    v_mul_u32_u24 v4, 1280, v4
    v_lshl_add_u32 v4, v5, 6, v4
    v_bfe_u32 v6, v248, 6, 1
    v_lshl_add_u32 v4, v6, 5, v4
    v_and_b32 v6, 12, v248
    v_lshl_add_u32 v4, v6, 1, v4
    v_and_b32 v6, 16, v248
    v_xor_b32 v6, 16, v6
    v_lshl_add_u32 v4, v6, 13, v4
    v_add_u32 v4, 65536, v4
    v_xor_b32 v5, 64, v4
    ds_read_b64_tr_b16 v[96:97], v4 offset:0
    ds_read_b64_tr_b16 v[98:99], v4 offset:2560
    ds_read_b64_tr_b16 v[100:101], v4 offset:10240
    ds_read_b64_tr_b16 v[102:103], v4 offset:12800
    ds_read_b64_tr_b16 v[104:105], v5 offset:0
    ds_read_b64_tr_b16 v[106:107], v5 offset:2560
    ds_read_b64_tr_b16 v[108:109], v5 offset:10240
    ds_read_b64_tr_b16 v[110:111], v5 offset:12800
    ds_read_b64_tr_b16 v[128:129], v4 offset:512
    ds_read_b64_tr_b16 v[130:131], v4 offset:3072
    ds_read_b64_tr_b16 v[132:133], v4 offset:10752
    ds_read_b64_tr_b16 v[134:135], v4 offset:13312
    ds_read_b64_tr_b16 v[136:137], v5 offset:512
    ds_read_b64_tr_b16 v[138:139], v5 offset:3072
    ds_read_b64_tr_b16 v[140:141], v5 offset:10752
    ds_read_b64_tr_b16 v[142:143], v5 offset:13312
    ds_read_b64_tr_b16 v[144:145], v4 offset:768
    ds_read_b64_tr_b16 v[146:147], v4 offset:3328
    ds_read_b64_tr_b16 v[148:149], v4 offset:11008
    ds_read_b64_tr_b16 v[150:151], v4 offset:13568
    ds_read_b64_tr_b16 v[152:153], v5 offset:768
    ds_read_b64_tr_b16 v[154:155], v5 offset:3328
    ds_read_b64_tr_b16 v[156:157], v5 offset:11008
    ds_read_b64_tr_b16 v[158:159], v5 offset:13568
    ds_read_b64_tr_b16 v[160:161], v4 offset:1024
    ds_read_b64_tr_b16 v[162:163], v4 offset:3584
    ds_read_b64_tr_b16 v[164:165], v4 offset:11264
    ds_read_b64_tr_b16 v[166:167], v4 offset:13824
    ds_read_b64_tr_b16 v[168:169], v5 offset:1024
    ds_read_b64_tr_b16 v[170:171], v5 offset:3584
    ds_read_b64_tr_b16 v[172:173], v5 offset:11264
    ds_read_b64_tr_b16 v[174:175], v5 offset:13824
    ds_read_b64_tr_b16 v[112:113], v4 offset:256
    ds_read_b64_tr_b16 v[114:115], v4 offset:2816
    ds_read_b64_tr_b16 v[116:117], v4 offset:10496
    ds_read_b64_tr_b16 v[118:119], v4 offset:13056
    ds_read_b64_tr_b16 v[120:121], v5 offset:256
    ds_read_b64_tr_b16 v[122:123], v5 offset:2816
    ds_read_b64_tr_b16 v[124:125], v5 offset:10496
    ds_read_b64_tr_b16 v[126:127], v5 offset:13056
F_poll:
    s_waitcnt vmcnt(0)
F_poll1:
    v_cmp_ne_u32 s[72:73], s88, v11
    v_cmp_ne_u32 s[74:75], s88, v15
    v_cmp_ne_u32 s[76:77], s88, v19
    v_cmp_ne_u32 s[78:79], s88, v23
    s_or_b64 s[80:81], s[72:73], s[74:75]
    s_or_b64 s[82:83], s[76:77], s[78:79]
    s_or_b64 s[80:81], s[80:81], s[82:83]
    s_cbranch_scc1 F_again
F_got:
    v_bfe_u32 v2, v10, 23, 5
    v_bfe_u32 v60, v10, 11, 6
    v_cmp_gt_u32 s[80:81], v2, v91
    v_lshl_add_u32 v60, v60, 2, s71
    v_cmp_lt_u32 s[72:73], 8, v2
    v_max_u32 v89, v89, v2
    s_mov_b64 exec, s[80:81]
    ds_add_rtn_u32 v72, v60, v3
    s_mov_b64 exec, s[72:73]
    s_cbranch_execz F_h0
    buffer_load_dwordx4 v[24:27], v86, s[16:19], s25 offen offset:0 sc1
    v_sub_u32 v56, v2, v91
    v_bfe_u32 v64, v10, 17, 6
    v_cmp_lt_u32 vcc, 8, v56
    v_lshl_add_u32 v64, v64, 2, s71
    s_mov_b64 exec, vcc
    ds_add_rtn_u32 v76, v64, v3
F_h0:
    s_mov_b64 exec, -1
    v_bfe_u32 v2, v14, 23, 5
    v_bfe_u32 v61, v14, 11, 6
    v_cmp_gt_u32 s[82:83], v2, v91
    v_lshl_add_u32 v61, v61, 2, s71
    v_cmp_lt_u32 s[74:75], 8, v2
    v_max_u32 v89, v89, v2
    s_mov_b64 exec, s[82:83]
    ds_add_rtn_u32 v73, v61, v3
    s_mov_b64 exec, s[74:75]
    s_cbranch_execz F_h1
    buffer_load_dwordx4 v[28:31], v86, s[16:19], s25 offen offset:1024 sc1
    v_sub_u32 v57, v2, v91
    v_bfe_u32 v65, v14, 17, 6
    v_cmp_lt_u32 vcc, 8, v57
    v_lshl_add_u32 v65, v65, 2, s71
    s_mov_b64 exec, vcc
    ds_add_rtn_u32 v77, v65, v3
F_h1:
    s_mov_b64 exec, -1
    v_bfe_u32 v2, v18, 23, 5
    v_bfe_u32 v62, v18, 11, 6
    v_cmp_gt_u32 s[84:85], v2, v91
    v_lshl_add_u32 v62, v62, 2, s71
    v_cmp_lt_u32 s[76:77], 8, v2
    v_max_u32 v89, v89, v2
    s_mov_b64 exec, s[84:85]
    ds_add_rtn_u32 v74, v62, v3
    s_mov_b64 exec, s[76:77]
    s_cbranch_execz F_h2
    buffer_load_dwordx4 v[32:35], v86, s[16:19], s25 offen offset:2048 sc1
    v_sub_u32 v58, v2, v91
    v_bfe_u32 v66, v18, 17, 6
    v_cmp_lt_u32 vcc, 8, v58
    v_lshl_add_u32 v66, v66, 2, s71
    s_mov_b64 exec, vcc
    ds_add_rtn_u32 v78, v66, v3
F_h2:
    s_mov_b64 exec, -1
    v_bfe_u32 v2, v22, 23, 5
    v_bfe_u32 v63, v22, 11, 6
    v_cmp_gt_u32 s[86:87], v2, v91
    v_lshl_add_u32 v63, v63, 2, s71
    v_cmp_lt_u32 s[78:79], 8, v2
    v_max_u32 v89, v89, v2
    s_mov_b64 exec, s[86:87]
    ds_add_rtn_u32 v75, v63, v3
    s_mov_b64 exec, s[78:79]
    s_cbranch_execz F_h3
    buffer_load_dwordx4 v[36:39], v86, s[16:19], s25 offen offset:3072 sc1
    v_sub_u32 v59, v2, v91
    v_bfe_u32 v67, v22, 17, 6
    v_cmp_lt_u32 vcc, 8, v59
    v_lshl_add_u32 v67, v67, 2, s71
    s_mov_b64 exec, vcc
    ds_add_rtn_u32 v79, v67, v3
F_h3:
    s_mov_b64 exec, -1
    v_cmp_lt_u32 s[30:31], 16, v89
    s_mov_b32 s27, 262144
    s_cmp_lg_u64 s[30:31], 0
    s_cbranch_scc1 F_l3
F_l3r:
    s_cmp_lt_u32 s2, s52
    s_cbranch_scc1 F_flag
F_flagr:
    s_waitcnt lgkmcnt(0)
    s_barrier
    ds_read_b32 v4, v88
    buffer_load_dword v95, v93, s[4:7], 0 offen offset:128
    v_and_b32 v10, 0x7ff, v10
    v_lshl_add_u32 v10, v10, 5, v90
    v_or_b32 v11, 16, v10
    v_and_b32 v14, 0x7ff, v14
    v_lshl_add_u32 v14, v14, 5, v90
    v_add_u32 v14, 327680, v14
    v_or_b32 v15, 16, v14
    v_and_b32 v18, 0x7ff, v18
    v_lshl_add_u32 v18, v18, 5, v90
    v_add_u32 v18, 655360, v18
    v_or_b32 v19, 16, v18
    v_and_b32 v22, 0x7ff, v22
    v_lshl_add_u32 v22, v22, 5, v90
    v_add_u32 v22, 983040, v22
    v_or_b32 v23, 16, v22
    s_waitcnt lgkmcnt(0)
    v_add_u32 v2, 56, v4
    v_cmp_lt_u32 vcc, 512, v4
    v_lshrrev_b32 v2, 6, v2
    v_max_u32 v2, 2, v2
    s_and_b64 s[90:91], vcc, vcc
    s_cbranch_scc1 F_big
F_bigr:
    v_med3_u32 v3, v2, 3, 7
    v_cmp_eq_u32 vcc, 7, v2
    v_mad_u32_u24 v3, v3, 6, 14
    v_lshlrev_b32_e64 v6, v3, 1
    v_cndmask_b32 v6, 0, v6, s[68:69]
    v_addc_co_u32 v2, vcc, 0, v2, vcc
    v_mov_b32 v7, v6
    v_add_u32 v5, 1, v2
    v_lshrrev_b32 v5, 1, v5
    v_add_u32_dpp v7, v7, v7 row_shr:1 row_mask:0xf bank_mask:0xf
    v_lshlrev_b32 v92, 22, v5
    v_lshlrev_b32 v5, 18, v5
    v_add_u32_dpp v7, v7, v7 row_shr:2 row_mask:0xf bank_mask:0xf
    v_lshl_or_b32 v5, v1, 21, v5
    v_lshl_or_b32 v5, v2, 28, v5
    v_add_u32_dpp v7, v7, v7 row_shr:4 row_mask:0xf bank_mask:0xf
    s_mov_b32 s26, 86016
    s_mov_b32 s24, 0x2000
    v_add_u32_dpp v7, v7, v7 row_shr:8 row_mask:0xf bank_mask:0xf
    s_nop 1
    v_add_u32_dpp v7, v7, v7 row_bcast:15 row_mask:0xa bank_mask:0xf
    s_nop 1
    v_add_u32_dpp v7, v7, v7 row_bcast:31 row_mask:0xc bank_mask:0xf
    s_nop 0
    v_readlane_b32 s71, v7, 63
    v_sub_u32 v7, v7, v6
    s_lshr_b32 s66, s71, 24
    s_lshr_b32 s67, s71, 6
    s_lshr_b32 s70, s71, 12
    s_lshr_b32 s71, s71, 18
    s_add_u32 s67, s67, s70
    s_add_u32 s71, s71, s66
    s_add_u32 s71, s71, s67
    v_add_u32 v7, s71, v7
    s_bfe_u32 s70, s71, 393222
    v_bfe_u32 v7, v7, v3, 6
    s_bfe_u32 s67, s71, 393228
    v_cndmask_b32 v84, 63, v7, s[68:69]
    s_mul_i32 s68, s70, 3
    v_min_u32 v2, s70, v7
    s_mul_i32 s69, s66, 5
    v_min_u32 v3, s66, v7
    s_add_u32 s68, s68, s69
    v_mul_u32_u24 v7, 12, v7
    s_cmp_gt_u32 s68, 120
    v_mad_u32_u24 v7, v2, 3, v7
    s_cbranch_scc1 SLOW
    v_mad_u32_u24 v7, v3, 5, v7
    v_lshl_add_u32 v7, v7, 7, s26
    v_lshrrev_b32 v6, 3, v7
    v_mad_u32_u24 v92, v7, s24, v92
    v_or_b32 v92, v92, v6
    v_or_b32 v6, v5, v7
    s_add_u32 s71, s70, s66
    s_add_u32 s68, s71, s67
    s_andn2_b32 s70, s70, 3
    s_add_u32 s69, s70, 4
    s_andn2_b32 s67, s67, 3
    v_lshrrev_b32 v3, 1, v84
    v_mov_b32 v2, s68
    v_xor_b32 v3, v3, v84
    v_bfi_b32 v3, 4, v3, v84
    v_cmpx_gt_u32 vcc, s69, v84
    v_mov_b32 v2, s66
    v_cmpx_gt_u32 vcc, s70, v84
    v_mov_b32 v2, s71
    v_cmpx_gt_u32 vcc, s67, v84
    v_mov_b32 v2, 0
    s_mov_b64 exec, -1
    v_add_u32 v2, v2, v84
    v_bfi_b32 v84, 3, v2, v3
    s_lshr_b32 s66, s2, 3
    v_cmp_gt_u32 vcc, 32, v84
    v_add_u32 v2, s66, v84
    v_lshl_add_u32 v2, v2, 3, v84
    v_bfi_b32 v2, 24, v2, v84
    v_cndmask_b32 v84, v84, v2, vcc
    v_subrev_u32 v2, 6, v84
    v_and_b32 v2, 0x80000000, v2
    v_or_b32 v92, v92, v2
    ds_bpermute_b32 v60, v60, v92
    ds_bpermute_b32 v61, v61, v92
    ds_bpermute_b32 v62, v62, v92
    ds_bpermute_b32 v63, v63, v92
    ds_bpermute_b32 v64, v64, v92
    ds_bpermute_b32 v65, v65, v92
    ds_bpermute_b32 v66, v66, v92
    ds_bpermute_b32 v67, v67, v92
    v_cmp_eq_u32 vcc, s20, v84
    s_ff1_i32_b64 s67, vcc
    v_readlane_b32 s71, v6, s67
    s_mov_b32 s22, s71
    s_bfe_u32 s46, s71, 0x30012
    s_mov_b32 m0, s46
    s_and_b32 s66, s71, 0x3ffff
    s_movrels_b32 s68, s57
    s_movrels_b32 s69, s61
    s_sub_u32 s48, s66, s47
    s_mov_b32 s47, s66
    s_lshr_b32 s52, s71, 28
    s_lshl_b32 s67, s46, 9
    s_add_u32 s66, s66, s67
    s_sub_u32 s49, s66, s42
    s_mov_b32 s42, s66
    s_bfe_u32 s66, s68, 655360
    s_add_u32 s43, s42, s66
    s_bfe_u32 s39, s69, 655360
    s_bfe_u32 s66, s68, 655370
    s_add_u32 s44, s42, s66
    s_bfe_u32 s40, s69, 655370
    s_bfe_u32 s66, s68, 655380
    s_add_u32 s45, s42, s66
    s_bfe_u32 s41, s69, 655380
    s_waitcnt lgkmcnt(7)
    v_cmp_gt_i32 vcc, 0, v60
    v_and_b32 v60, 0x7fffffff, v60
    s_and_b64 exec, vcc, s[80:81]
    buffer_load_dword v95, v10, s[12:15], 0 offen
    s_mov_b64 exec, -1
    v_mad_u32_u16 v2, v60, 8, v72
    v_mad_u32_u16 v3, v60, 8, v72 op_sel:[1,0,0,0]
    s_mov_b64 exec, s[80:81]
    ds_write_b64 v2, v[10:11]
    ds_write_b64 v3, v[8:9]
    s_mov_b64 exec, -1
    s_waitcnt lgkmcnt(8)
    v_cmp_gt_i32 vcc, 0, v61
    v_and_b32 v61, 0x7fffffff, v61
    s_and_b64 exec, vcc, s[82:83]
    buffer_load_dword v95, v14, s[12:15], 0 offen
    s_mov_b64 exec, -1
    v_mad_u32_u16 v2, v61, 8, v73
    v_mad_u32_u16 v3, v61, 8, v73 op_sel:[1,0,0,0]
    s_mov_b64 exec, s[82:83]
    ds_write_b64 v2, v[14:15]
    ds_write_b64 v3, v[12:13]
    s_mov_b64 exec, -1
    s_waitcnt lgkmcnt(9)
    v_cmp_gt_i32 vcc, 0, v62
    v_and_b32 v62, 0x7fffffff, v62
    s_and_b64 exec, vcc, s[84:85]
    buffer_load_dword v95, v18, s[12:15], 0 offen
    s_mov_b64 exec, -1
    v_mad_u32_u16 v2, v62, 8, v74
    v_mad_u32_u16 v3, v62, 8, v74 op_sel:[1,0,0,0]
    s_mov_b64 exec, s[84:85]
    ds_write_b64 v2, v[18:19]
    ds_write_b64 v3, v[16:17]
    s_mov_b64 exec, -1
    s_waitcnt lgkmcnt(10)
    v_cmp_gt_i32 vcc, 0, v63
    v_and_b32 v63, 0x7fffffff, v63
    s_and_b64 exec, vcc, s[86:87]
    buffer_load_dword v95, v22, s[12:15], 0 offen
    s_mov_b64 exec, -1
    v_mad_u32_u16 v2, v63, 8, v75
    v_mad_u32_u16 v3, v63, 8, v75 op_sel:[1,0,0,0]
    s_mov_b64 exec, s[86:87]
    ds_write_b64 v2, v[22:23]
    ds_write_b64 v3, v[20:21]
    s_mov_b64 exec, -1
    s_waitcnt vmcnt(5) lgkmcnt(8)
    s_mov_b64 exec, s[72:73]
    s_cbranch_execz F_s0
F_sp0:
    v_cmp_ne_u32 vcc, s88, v27
    s_cbranch_vccnz F_sa0
F_sg0:
    v_cmpx_lt_u32 vcc, 8, v56
    v_and_b32 v26, 0x7ff, v26
    v_lshl_add_u32 v26, v26, 5, v90
    v_or_b32 v27, 16, v26
    v_cmp_gt_i32 vcc, 0, v64
    v_and_b32 v64, 0x7fffffff, v64
    s_and_saveexec_b64 s[82:83], vcc
    s_cbranch_execz F_x0
    buffer_load_dword v95, v26, s[12:15], 0 offen
F_x0:
    s_mov_b64 exec, s[82:83]
    v_mad_u32_u16 v2, v64, 8, v76
    v_mad_u32_u16 v3, v64, 8, v76 op_sel:[1,0,0,0]
    ds_write_b64 v2, v[26:27]
    ds_write_b64 v3, v[24:25]
F_s0:
    s_mov_b64 exec, s[74:75]
    s_cbranch_execz F_s1
F_sp1:
    v_cmp_ne_u32 vcc, s88, v31
    s_cbranch_vccnz F_sa1
F_sg1:
    v_cmpx_lt_u32 vcc, 8, v57
    v_and_b32 v30, 0x7ff, v30
    v_lshl_add_u32 v30, v30, 5, v90
    v_add_u32 v30, 327680, v30
    v_or_b32 v31, 16, v30
    v_cmp_gt_i32 vcc, 0, v65
    v_and_b32 v65, 0x7fffffff, v65
    s_and_saveexec_b64 s[82:83], vcc
    s_cbranch_execz F_x1
    buffer_load_dword v95, v30, s[12:15], 0 offen
F_x1:
    s_mov_b64 exec, s[82:83]
    v_mad_u32_u16 v2, v65, 8, v77
    v_mad_u32_u16 v3, v65, 8, v77 op_sel:[1,0,0,0]
    ds_write_b64 v2, v[30:31]
    ds_write_b64 v3, v[28:29]
F_s1:
    s_mov_b64 exec, s[76:77]
    s_cbranch_execz F_s2
F_sp2:
    v_cmp_ne_u32 vcc, s88, v35
    s_cbranch_vccnz F_sa2
F_sg2:
    v_cmpx_lt_u32 vcc, 8, v58
    v_and_b32 v34, 0x7ff, v34
    v_lshl_add_u32 v34, v34, 5, v90
    v_add_u32 v34, 655360, v34
    v_or_b32 v35, 16, v34
    v_cmp_gt_i32 vcc, 0, v66
    v_and_b32 v66, 0x7fffffff, v66
    s_and_saveexec_b64 s[82:83], vcc
    s_cbranch_execz F_x2
    buffer_load_dword v95, v34, s[12:15], 0 offen
F_x2:
    s_mov_b64 exec, s[82:83]
    v_mad_u32_u16 v2, v66, 8, v78
    v_mad_u32_u16 v3, v66, 8, v78 op_sel:[1,0,0,0]
    ds_write_b64 v2, v[34:35]
    ds_write_b64 v3, v[32:33]
F_s2:
    s_mov_b64 exec, s[78:79]
    s_cbranch_execz F_s3
F_sp3:
    v_cmp_ne_u32 vcc, s88, v39
    s_cbranch_vccnz F_sa3
F_sg3:
    v_cmpx_lt_u32 vcc, 8, v59
    v_and_b32 v38, 0x7ff, v38
    v_lshl_add_u32 v38, v38, 5, v90
    v_add_u32 v38, 983040, v38
    v_or_b32 v39, 16, v38
    v_cmp_gt_i32 vcc, 0, v67
    v_and_b32 v67, 0x7fffffff, v67
    s_and_saveexec_b64 s[82:83], vcc
    s_cbranch_execz F_x3
    buffer_load_dword v95, v38, s[12:15], 0 offen
F_x3:
    s_mov_b64 exec, s[82:83]
    v_mad_u32_u16 v2, v67, 8, v79
    v_mad_u32_u16 v3, v67, 8, v79 op_sel:[1,0,0,0]
    ds_write_b64 v2, v[38:39]
    ds_write_b64 v3, v[36:37]
F_s3:
    s_mov_b64 exec, -1
    s_cmp_lg_u64 s[30:31], 0
    s_cbranch_scc1 F_u
F_ur:
    s_mov_b32 s27, s22
    s_and_b32 s66, s46, s33
    s_cselect_b32 s72, -1, 1
    s_cselect_b32 s76, s47, 163712
    s_cmp_ge_u32 s66, 2
    s_cselect_b32 s73, -1, 0
    s_add_u32 s77, s47, 1024
    s_cmp_ge_u32 s66, 4
    s_cselect_b32 s75, -1, 0
    s_cmp_ge_u32 s66, 3
    s_cselect_b32 s74, -1, 1
    s_cselect_b32 s77, s77, 163712
    s_mul_i32 s66, s20, 80
    v_min_u32 v2, 76, v248
    s_waitcnt lgkmcnt(0)
    s_barrier
    v_add_u32 v253, s47, v248
    ds_read_b32 v254, v253
    ds_read_b32 v255, v253 offset:256
    v_add_u32 v252, s42, v247
    ds_read2_b32 v[234:235], v252 offset0:0 offset1:16
    v_add_u32 v252, s43, v247
    ds_read2_b32 v[236:237], v252 offset0:0 offset1:16
    v_add_u32 v252, s44, v247
    ds_read2_b32 v[238:239], v252 offset0:0 offset1:16
    v_add_u32 v252, s45, v247
    ds_read2_b32 v[240:241], v252 offset0:0 offset1:16
    buffer_load_dword v3, v2, s[16:19], s66 offen offset:128 sc1
    v_add_u32 v249, s48, v249
    v_add_u32 v250, s49, v250
    s_waitcnt lgkmcnt(4)
    s_mov_b32 m0, s76
    s_mov_b64 exec, s[72:73]
    buffer_load_dwordx4 v254, s[12:15], 0 offen  lds
    s_mov_b32 m0, s77
    s_mov_b64 exec, s[74:75]
    buffer_load_dwordx4 v255, s[12:15], 0 offen  lds
    s_mov_b64 exec, -1
    s_waitcnt lgkmcnt(0)
    s_add_u32 m0, s21, 0
    v_mad_u32_u16 v234, v234, s3, v246 op_sel:[1,0,0,0]
    v_mad_u32_u16 v235, v235, s3, v246 op_sel:[1,0,0,0]
    buffer_load_dwordx4 v234, s[4:7], s38 offen  lds
    buffer_load_dwordx4 v235, s[8:11], s38 offen offset:1024  lds
    s_add_u32 m0, s21, 2048
    v_mad_u32_u16 v236, v236, s3, v246 op_sel:[1,0,0,0]
    v_mad_u32_u16 v237, v237, s3, v246 op_sel:[1,0,0,0]
    buffer_load_dwordx4 v236, s[4:7], s39 offen  lds
    buffer_load_dwordx4 v237, s[8:11], s39 offen offset:1024  lds
    s_add_u32 m0, s21, 4096
    v_mad_u32_u16 v238, v238, s3, v246 op_sel:[1,0,0,0]
    v_mad_u32_u16 v239, v239, s3, v246 op_sel:[1,0,0,0]
    buffer_load_dwordx4 v238, s[4:7], s40 offen  lds
    buffer_load_dwordx4 v239, s[8:11], s40 offen offset:1024  lds
    s_add_u32 m0, s21, 6144
    v_mad_u32_u16 v240, v240, s3, v246 op_sel:[1,0,0,0]
    v_mad_u32_u16 v241, v241, s3, v246 op_sel:[1,0,0,0]
    buffer_load_dwordx4 v240, s[4:7], s41 offen  lds
    buffer_load_dwordx4 v241, s[8:11], s41 offen offset:1024  lds
    v_lshrrev_b32 v8, 3, v84
    v_and_b32 v9, 7, v84
    v_lshlrev_b32 v9, 13, v9
    v_mul_u32_u24 v8, 1536, v8
    v_lshlrev_b32 v10, 4, v84
    v_and_b32 v5, 128, v10
    v_add3_u32 v8, v8, v9, v5
    v_xor_b32 v9, v10, v7
    v_and_b32 v9, 128, v9
    v_add_u32 v9, v9, v7
    v_mov_b32 v5, v9
    s_add_u32 s66, s20, 0
    v_cmp_eq_u32 vcc, s66, v84
    s_ff1_i32_b64 s67, vcc
    v_readlane_b32 s28, v5, s67
    s_add_u32 s66, s20, 8
    v_cmp_eq_u32 vcc, s66, v84
    s_ff1_i32_b64 s67, vcc
    v_readlane_b32 s29, v5, s67
    v_readlane_b32 s23, v6, s67
    s_add_u32 s66, s20, 16
    v_cmp_eq_u32 vcc, s66, v84
    s_ff1_i32_b64 s67, vcc
    v_readlane_b32 s30, v5, s67
    v_readlane_b32 s24, v6, s67
    s_add_u32 s66, s20, 24
    v_cmp_eq_u32 vcc, s66, v84
    s_ff1_i32_b64 s67, vcc
    v_readlane_b32 s31, v5, s67
    v_readlane_b32 s25, v6, s67
    s_add_u32 s66, s20, 32
    v_cmp_eq_u32 vcc, s66, v84
    s_ff1_i32_b64 s67, vcc
    v_readlane_b32 s32, v5, s67
    v_readlane_b32 s26, v6, s67
    v_lshlrev_b32 v4, 3, v84
    v_add_u32 v4, 163328, v4
    s_mov_b32 exec_hi, 0xff
    ds_write_b64 v4, v[8:9]
    s_mov_b32 exec_hi, -1
    s_waitcnt lgkmcnt(0)
    v_mov_b32 v252, 0
    s_waitcnt vmcnt(6)
    v_cmp_ne_u32 vcc, s88, v3
    ds_read_b64_tr_b16 v[176:177], v244 offset:0
    ds_read_b64_tr_b16 v[178:179], v244 offset:1024
    ds_read_b64_tr_b16 v[180:181], v245 offset:0
    ds_read_b64_tr_b16 v[182:183], v245 offset:1024
    ds_read_b64_tr_b16 v[72:73], v249 offset:0
    ds_read_b64_tr_b16 v[76:77], v249 offset:64
    ds_read_b64_tr_b16 v[74:75], v249 offset:256
    ds_read_b64_tr_b16 v[78:79], v249 offset:320
    s_mov_b64 exec, s[54:55]
    ds_read_u16_d16_hi v242, v250 offset:0
    s_mov_b64 exec, -1
    s_or_b32 s89, vcc_lo, vcc_hi
    s_add_u32 s53, s53, 4
    s_xor_b32 s66, s53, s20
    s_bitcmp1_b32 s66, 2
    s_setprio 1
    s_cbranch_scc1 PRIO_1
    s_setprio 0
PRIO_1:
    s_cmp_eq_u32 s52, 4
    s_cbranch_scc1 ITEM_0_4
    s_cmp_eq_u32 s52, 5
    s_cbranch_scc1 ITEM_0_5
    s_cmp_eq_u32 s52, 3
    s_cbranch_scc1 ITEM_0_3
    s_cmp_eq_u32 s52, 6
    s_cbranch_scc1 ITEM_0_6
    s_cmp_eq_u32 s52, 8
    s_cbranch_scc1 ITEM_0_8
    s_branch ITEM_0_2
F_again:
    s_sub_u32 s27, s27, 1
    s_cbranch_scc1 F_late
    s_cmp_eq_u64 s[72:73], 0
    s_cbranch_scc1 F_p0
    s_mov_b64 exec, s[72:73]
    s_cmp_gt_u32 s27, 4092
    s_cbranch_scc1 F_nd0
    v_mov_b32 v2, 0
    buffer_atomic_or v2, v86, s[16:19], s24 offen offset:12 sc1
    s_waitcnt vmcnt(0)
F_nd0:
    buffer_load_dwordx4 v[8:11], v86, s[16:19], s24 offen offset:0 sc1
    s_mov_b64 exec, -1
F_p0:
    s_cmp_eq_u64 s[74:75], 0
    s_cbranch_scc1 F_p1
    s_mov_b64 exec, s[74:75]
    s_cmp_gt_u32 s27, 4092
    s_cbranch_scc1 F_nd1
    v_mov_b32 v2, 0
    buffer_atomic_or v2, v86, s[16:19], s24 offen offset:1036 sc1
    s_waitcnt vmcnt(0)
F_nd1:
    buffer_load_dwordx4 v[12:15], v86, s[16:19], s24 offen offset:1024 sc1
    s_mov_b64 exec, -1
F_p1:
    s_cmp_eq_u64 s[76:77], 0
    s_cbranch_scc1 F_p2
    s_mov_b64 exec, s[76:77]
    s_cmp_gt_u32 s27, 4092
    s_cbranch_scc1 F_nd2
    v_mov_b32 v2, 0
    buffer_atomic_or v2, v86, s[16:19], s24 offen offset:2060 sc1
    s_waitcnt vmcnt(0)
F_nd2:
    buffer_load_dwordx4 v[16:19], v86, s[16:19], s24 offen offset:2048 sc1
    s_mov_b64 exec, -1
F_p2:
    s_cmp_eq_u64 s[78:79], 0
    s_cbranch_scc1 F_p3
    s_mov_b64 exec, s[78:79]
    s_cmp_gt_u32 s27, 4092
    s_cbranch_scc1 F_nd3
    v_mov_b32 v2, 0
    buffer_atomic_or v2, v86, s[16:19], s24 offen offset:3084 sc1
    s_waitcnt vmcnt(0)
F_nd3:
    buffer_load_dwordx4 v[20:23], v86, s[16:19], s24 offen offset:3072 sc1
    s_mov_b64 exec, -1
F_p3:
    s_branch F_poll
F_late:
    v_mov_b32 v2, 163064
    v_mov_b32 v4, 1000
    ds_write_b32 v2, v4
    v_mov_b32 v10, 0
    v_mov_b32 v14, 0
    v_mov_b32 v18, 0
    v_mov_b32 v22, 0
    s_branch F_got
F_l3:
    v_bfe_u32 v2, v10, 23, 5
    v_sub_u32 v56, v2, v91
    v_cmp_lt_u32 vcc, 16, v2
    s_mov_b64 exec, vcc
    s_cbranch_execz F_t0
F_tp0:
    buffer_load_dwordx4 v[40:43], v86, s[16:19], s26 offen offset:0 sc1
    s_waitcnt vmcnt(0)
    v_cmp_ne_u32 vcc, s88, v43
    s_sub_u32 s27, s27, 1
    s_cselect_b64 vcc, 0, vcc
    s_cmp_eq_u64 vcc, 0
    s_cbranch_scc0 F_tp0
    v_bfe_u32 v68, v42, 11, 6
    v_lshl_add_u32 v68, v68, 2, s71
    v_cmp_lt_i32 vcc, 16, v56
    s_mov_b64 exec, vcc
    ds_add_rtn_u32 v80, v68, v3
F_t0:
    s_mov_b64 exec, -1
    v_bfe_u32 v2, v14, 23, 5
    v_sub_u32 v57, v2, v91
    v_cmp_lt_u32 vcc, 16, v2
    s_mov_b64 exec, vcc
    s_cbranch_execz F_t1
F_tp1:
    buffer_load_dwordx4 v[44:47], v86, s[16:19], s26 offen offset:1024 sc1
    s_waitcnt vmcnt(0)
    v_cmp_ne_u32 vcc, s88, v47
    s_sub_u32 s27, s27, 1
    s_cselect_b64 vcc, 0, vcc
    s_cmp_eq_u64 vcc, 0
    s_cbranch_scc0 F_tp1
    v_bfe_u32 v69, v46, 11, 6
    v_lshl_add_u32 v69, v69, 2, s71
    v_cmp_lt_i32 vcc, 16, v57
    s_mov_b64 exec, vcc
    ds_add_rtn_u32 v81, v69, v3
F_t1:
    s_mov_b64 exec, -1
    v_bfe_u32 v2, v18, 23, 5
    v_sub_u32 v58, v2, v91
    v_cmp_lt_u32 vcc, 16, v2
    s_mov_b64 exec, vcc
    s_cbranch_execz F_t2
F_tp2:
    buffer_load_dwordx4 v[48:51], v86, s[16:19], s26 offen offset:2048 sc1
    s_waitcnt vmcnt(0)
    v_cmp_ne_u32 vcc, s88, v51
    s_sub_u32 s27, s27, 1
    s_cselect_b64 vcc, 0, vcc
    s_cmp_eq_u64 vcc, 0
    s_cbranch_scc0 F_tp2
    v_bfe_u32 v70, v50, 11, 6
    v_lshl_add_u32 v70, v70, 2, s71
    v_cmp_lt_i32 vcc, 16, v58
    s_mov_b64 exec, vcc
    ds_add_rtn_u32 v82, v70, v3
F_t2:
    s_mov_b64 exec, -1
    v_bfe_u32 v2, v22, 23, 5
    v_sub_u32 v59, v2, v91
    v_cmp_lt_u32 vcc, 16, v2
    s_mov_b64 exec, vcc
    s_cbranch_execz F_t3
F_tp3:
    buffer_load_dwordx4 v[52:55], v86, s[16:19], s26 offen offset:3072 sc1
    s_waitcnt vmcnt(0)
    v_cmp_ne_u32 vcc, s88, v55
    s_sub_u32 s27, s27, 1
    s_cselect_b64 vcc, 0, vcc
    s_cmp_eq_u64 vcc, 0
    s_cbranch_scc0 F_tp3
    v_bfe_u32 v71, v54, 11, 6
    v_lshl_add_u32 v71, v71, 2, s71
    v_cmp_lt_i32 vcc, 16, v59
    s_mov_b64 exec, vcc
    ds_add_rtn_u32 v83, v71, v3
F_t3:
    s_mov_b64 exec, -1
    v_mov_b32 v2, 163068
    v_mov_b32 v4, 1000
    v_cmp_lt_u32 vcc, 24, v89
    s_mov_b64 exec, vcc
    ds_write_b32 v2, v4
    s_mov_b64 exec, -1
    s_branch F_l3r
F_flag:
    s_lshl_b32 s66, s2, 2
    v_mov_b32 v2, 128
    v_mov_b32 v4, s88
    s_mov_b64 exec, 1
    buffer_store_dword v4, v2, s[16:19], s66 offen sc1
    s_mov_b64 exec, -1
    s_branch F_flagr
F_big:
    s_lshr_b64 s[66:67], vcc, 40
    s_cbranch_scc1 SLOW
    v_min_u32 v4, 512, v4
    v_min_u32 v2, 8, v2
    v_min_u32 v72, 504, v72
    v_min_u32 v73, 504, v73
    v_min_u32 v74, 504, v74
    v_min_u32 v75, 504, v75
    v_min_u32 v76, 504, v76
    v_min_u32 v77, 504, v77
    v_min_u32 v78, 504, v78
    v_min_u32 v79, 504, v79
    v_min_u32 v80, 504, v80
    v_min_u32 v81, 504, v81
    v_min_u32 v82, 504, v82
    v_min_u32 v83, 504, v83
    s_branch F_bigr
F_sa0:
    s_sub_u32 s27, s27, 1
    s_cbranch_scc1 F_sg0
    buffer_load_dwordx4 v[24:27], v86, s[16:19], s25 offen offset:0 sc1
    s_waitcnt vmcnt(0)
    s_branch F_sp0
F_sa1:
    s_sub_u32 s27, s27, 1
    s_cbranch_scc1 F_sg1
    buffer_load_dwordx4 v[28:31], v86, s[16:19], s25 offen offset:1024 sc1
    s_waitcnt vmcnt(0)
    s_branch F_sp1
F_sa2:
    s_sub_u32 s27, s27, 1
    s_cbranch_scc1 F_sg2
    buffer_load_dwordx4 v[32:35], v86, s[16:19], s25 offen offset:2048 sc1
    s_waitcnt vmcnt(0)
    s_branch F_sp2
F_sa3:
    s_sub_u32 s27, s27, 1
    s_cbranch_scc1 F_sg3
    buffer_load_dwordx4 v[36:39], v86, s[16:19], s25 offen offset:3072 sc1
    s_waitcnt vmcnt(0)
    s_branch F_sp3
F_u:
    ds_bpermute_b32 v68, v68, v92
    ds_bpermute_b32 v69, v69, v92
    ds_bpermute_b32 v70, v70, v92
    ds_bpermute_b32 v71, v71, v92
    s_waitcnt lgkmcnt(0)
    v_cmp_lt_i32 vcc, 16, v56
    s_mov_b64 exec, vcc
    s_cbranch_execz F_u0
    v_and_b32 v42, 0x7ff, v42
    v_lshl_add_u32 v42, v42, 5, v90
    v_or_b32 v43, 16, v42
    v_and_b32 v68, 0x7fffffff, v68
    v_mad_u32_u16 v2, v68, 8, v80
    v_mad_u32_u16 v3, v68, 8, v80 op_sel:[1,0,0,0]
    ds_write_b64 v2, v[42:43]
    ds_write_b64 v3, v[40:41]
F_u0:
    s_mov_b64 exec, -1
    v_cmp_lt_i32 vcc, 16, v57
    s_mov_b64 exec, vcc
    s_cbranch_execz F_u1
    v_and_b32 v46, 0x7ff, v46
    v_lshl_add_u32 v46, v46, 5, v90
    v_add_u32 v46, 327680, v46
    v_or_b32 v47, 16, v46
    v_and_b32 v69, 0x7fffffff, v69
    v_mad_u32_u16 v2, v69, 8, v81
    v_mad_u32_u16 v3, v69, 8, v81 op_sel:[1,0,0,0]
    ds_write_b64 v2, v[46:47]
    ds_write_b64 v3, v[44:45]
F_u1:
    s_mov_b64 exec, -1
    v_cmp_lt_i32 vcc, 16, v58
    s_mov_b64 exec, vcc
    s_cbranch_execz F_u2
    v_and_b32 v50, 0x7ff, v50
    v_lshl_add_u32 v50, v50, 5, v90
    v_add_u32 v50, 655360, v50
    v_or_b32 v51, 16, v50
    v_and_b32 v70, 0x7fffffff, v70
    v_mad_u32_u16 v2, v70, 8, v82
    v_mad_u32_u16 v3, v70, 8, v82 op_sel:[1,0,0,0]
    ds_write_b64 v2, v[50:51]
    ds_write_b64 v3, v[48:49]
F_u2:
    s_mov_b64 exec, -1
    v_cmp_lt_i32 vcc, 16, v59
    s_mov_b64 exec, vcc
    s_cbranch_execz F_u3
    v_and_b32 v54, 0x7ff, v54
    v_lshl_add_u32 v54, v54, 5, v90
    v_add_u32 v54, 983040, v54
    v_or_b32 v55, 16, v54
    v_and_b32 v71, 0x7fffffff, v71
    v_mad_u32_u16 v2, v71, 8, v83
    v_mad_u32_u16 v3, v71, 8, v83 op_sel:[1,0,0,0]
    ds_write_b64 v2, v[54:55]
    ds_write_b64 v3, v[52:53]
F_u3:
    s_mov_b64 exec, -1
    s_branch F_ur
LAST0:
    s_cmp_eq_u32 s50, 5
    s_cbranch_scc1 TO_PHASE1
    s_add_u32 s4, s4, 128
    s_addc_u32 s5, s5, 0
    s_add_u32 s8, s8, 128
    s_addc_u32 s9, s9, 0
    s_mov_b32 s34, 0
    s_mov_b32 s35, 256
    s_mov_b32 s36, 512
    s_mov_b32 s37, 768
    s_mov_b32 s33, 0
    s_add_u32 s53, s53, 4
    s_xor_b32 s66, s53, s20
    s_bitcmp1_b32 s66, 2
    s_setprio 1
    s_cbranch_scc1 PRIO_2
    s_setprio 0
PRIO_2:
    s_cmp_eq_u32 s52, 4
    s_cbranch_scc1 ITEM_0_4
    s_cmp_eq_u32 s52, 5
    s_cbranch_scc1 ITEM_0_5
    s_cmp_eq_u32 s52, 3
    s_cbranch_scc1 ITEM_0_3
    s_cmp_eq_u32 s52, 6
    s_cbranch_scc1 ITEM_0_6
    s_cmp_eq_u32 s52, 8
    s_cbranch_scc1 ITEM_0_8
    s_branch ITEM_0_2
TO_PHASE1:
    ds_read_b32 v252, v251 offset:16
    v_bfe_u32 v253, v248, 5, 1
    v_bfe_u32 v255, v248, 7, 1
    v_lshl_or_b32 v254, v255, 1, v253
    v_lshl_or_b32 v253, v255, 2, v253
    v_mul_u32_u24 v253, 1280, v253
    v_xor_b32 v254, 2, v254
    v_lshl_add_u32 v253, v254, 6, v253
    v_bfe_u32 v255, v248, 6, 1
    v_lshl_add_u32 v253, v255, 5, v253
    v_and_b32 v255, 12, v248
    v_lshl_add_u32 v253, v255, 1, v253
    v_and_b32 v255, 16, v248
    v_xor_b32 v255, 16, v255
    v_lshl_add_u32 v253, v255, 13, v253
    v_add_u32 v253, 65536, v253
    v_xor_b32 v254, 64, v253
    ds_read_b64_tr_b16 v[96:97], v253 offset:0
    ds_read_b64_tr_b16 v[98:99], v253 offset:2560
    ds_read_b64_tr_b16 v[100:101], v253 offset:10240
    ds_read_b64_tr_b16 v[102:103], v253 offset:12800
    ds_read_b64_tr_b16 v[104:105], v254 offset:0
    ds_read_b64_tr_b16 v[106:107], v254 offset:2560
    ds_read_b64_tr_b16 v[108:109], v254 offset:10240
    ds_read_b64_tr_b16 v[110:111], v254 offset:12800
    ds_read_b64_tr_b16 v[128:129], v253 offset:512
    ds_read_b64_tr_b16 v[130:131], v253 offset:3072
    ds_read_b64_tr_b16 v[132:133], v253 offset:10752
    ds_read_b64_tr_b16 v[134:135], v253 offset:13312
    ds_read_b64_tr_b16 v[136:137], v254 offset:512
    ds_read_b64_tr_b16 v[138:139], v254 offset:3072
    ds_read_b64_tr_b16 v[140:141], v254 offset:10752
    ds_read_b64_tr_b16 v[142:143], v254 offset:13312
    ds_read_b64_tr_b16 v[144:145], v253 offset:768
    ds_read_b64_tr_b16 v[146:147], v253 offset:3328
    ds_read_b64_tr_b16 v[148:149], v253 offset:11008
    ds_read_b64_tr_b16 v[150:151], v253 offset:13568
    ds_read_b64_tr_b16 v[152:153], v254 offset:768
    ds_read_b64_tr_b16 v[154:155], v254 offset:3328
    ds_read_b64_tr_b16 v[156:157], v254 offset:11008
    ds_read_b64_tr_b16 v[158:159], v254 offset:13568
    ds_read_b64_tr_b16 v[160:161], v253 offset:1024
    ds_read_b64_tr_b16 v[162:163], v253 offset:3584
    ds_read_b64_tr_b16 v[164:165], v253 offset:11264
    ds_read_b64_tr_b16 v[166:167], v253 offset:13824
    ds_read_b64_tr_b16 v[168:169], v254 offset:1024
    ds_read_b64_tr_b16 v[170:171], v254 offset:3584
    ds_read_b64_tr_b16 v[172:173], v254 offset:11264
    ds_read_b64_tr_b16 v[174:175], v254 offset:13824
    ds_read_b64_tr_b16 v[112:113], v253 offset:256
    ds_read_b64_tr_b16 v[114:115], v253 offset:2816
    ds_read_b64_tr_b16 v[116:117], v253 offset:10496
    ds_read_b64_tr_b16 v[118:119], v253 offset:13056
    ds_read_b64_tr_b16 v[120:121], v254 offset:256
    ds_read_b64_tr_b16 v[122:123], v254 offset:2816
    ds_read_b64_tr_b16 v[124:125], v254 offset:10496
    ds_read_b64_tr_b16 v[126:127], v254 offset:13056
    s_lshl_b32 s66, s20, 4
    v_xor_b32 v248, s66, v248
    s_mov_b32 s34, 128
    s_mov_b32 s35, 384
    s_mov_b32 s36, 640
    s_mov_b32 s37, 896
    s_mov_b32 s50, 0
    s_mov_b64 vcc, 0
    s_waitcnt lgkmcnt(0)
    s_waitcnt lgkmcnt(0)
    v_readfirstlane_b32 s66, v252
    s_add_u32 s53, s53, 1
    v_mov_b32 v252, s53
    s_cmp_le_u32 s53, s66
    ds_write2_b32 v251, v252, v252 offset0:0 offset1:8
    s_setprio 1
    s_cbranch_scc1 PRIO_3
    s_setprio 0
PRIO_3:
    s_cmp_eq_u32 s52, 4
    s_cbranch_scc1 ITEM_1_4
    s_cmp_eq_u32 s52, 5
    s_cbranch_scc1 ITEM_1_5
    s_cmp_eq_u32 s52, 3
    s_cbranch_scc1 ITEM_1_3
    s_cmp_eq_u32 s52, 6
    s_cbranch_scc1 ITEM_1_6
    s_cmp_eq_u32 s52, 8
    s_cbranch_scc1 ITEM_1_8
    s_branch ITEM_1_2
LAST1:
    s_cmp_eq_u32 s89, 0
    s_cbranch_scc1 T_flagsL
    s_mul_i32 s66, s20, 80
    v_min_u32 v2, 76, v248
    s_mov_b32 s67, 262144
T_pollL:
    buffer_load_dword v3, v2, s[16:19], s66 offen offset:128 sc1
    s_waitcnt vmcnt(0)
    v_cmp_ne_u32 vcc, s88, v3
    s_sub_u32 s67, s67, 1
    s_cselect_b64 vcc, 0, vcc
    s_cmp_eq_u64 vcc, 0
    s_cbranch_scc0 T_pollL
    s_mov_b32 s89, 0
T_flagsL:
    s_lshl_b32 s66, s20, 4
    v_xor_b32 v246, s66, v248
    v_lshlrev_b32 v246, 2, v246
    s_mul_i32 s51, s20, 20480
    s_add_u32 s51, s51, 1024
    s_mov_b64 vcc, -1
    s_load_dwordx2 s[72:73], s[0:1], 72
    s_waitcnt lgkmcnt(7)
    v_readfirstlane_b32 s66, v252
    s_add_u32 s53, s53, 1
    v_mov_b32 v252, s53
    s_cmp_le_u32 s53, s66
    ds_write2_b32 v251, v252, v252 offset0:0 offset1:8
    s_setprio 3
    s_cbranch_scc1 PRIO_4
    s_setprio 2
PRIO_4:
    s_cmp_eq_u32 s52, 4
    s_cbranch_scc1 ITEM_1_4
    s_cmp_eq_u32 s52, 5
    s_cbranch_scc1 ITEM_1_5
    s_cmp_eq_u32 s52, 3
    s_cbranch_scc1 ITEM_1_3
    s_cmp_eq_u32 s52, 6
    s_cbranch_scc1 ITEM_1_6
    s_cmp_eq_u32 s52, 8
    s_cbranch_scc1 ITEM_1_8
    s_branch ITEM_1_2
.p2align 6
ITEM_0_4:
    s_mov_b64 exec, s[54:55]
    ds_read_u16_d16_hi v243, v250 offset:128
    s_mov_b64 exec, -1
    ds_read_b64_tr_b16 v[80:81], v249 offset:512
    ds_read_b64_tr_b16 v[84:85], v249 offset:576
    ds_read_b64_tr_b16 v[82:83], v249 offset:768
    ds_read_b64_tr_b16 v[86:87], v249 offset:832
    s_waitcnt lgkmcnt(5)
    v_mul_f32_dpp v196, v242, v72 row_newbcast:0 row_mask:0xf bank_mask:0xf
    v_mul_f32_dpp v197, v242, v73 row_newbcast:1 row_mask:0xf bank_mask:0xf
    v_mul_f32_dpp v198, v242, v72 row_newbcast:8 row_mask:0xf bank_mask:0xf
    v_mul_f32_dpp v199, v242, v73 row_newbcast:9 row_mask:0xf bank_mask:0xf
    v_mul_f32_dpp v200, v242, v76 row_newbcast:2 row_mask:0xf bank_mask:0xf
    v_mul_f32_dpp v201, v242, v77 row_newbcast:3 row_mask:0xf bank_mask:0xf
    v_mul_f32_dpp v202, v242, v76 row_newbcast:10 row_mask:0xf bank_mask:0xf
    v_mul_f32_dpp v203, v242, v77 row_newbcast:11 row_mask:0xf bank_mask:0xf
    v_cvt_pk_bf16_f32 v72, v196, v197
    v_cvt_pk_bf16_f32 v76, v198, v199
    v_cvt_pk_bf16_f32 v73, v200, v201
    v_cvt_pk_bf16_f32 v77, v202, v203
    v_mul_f32_dpp v196, v242, v74 row_newbcast:4 row_mask:0xf bank_mask:0xf
    v_mul_f32_dpp v197, v242, v75 row_newbcast:5 row_mask:0xf bank_mask:0xf
    v_mul_f32_dpp v198, v242, v74 row_newbcast:12 row_mask:0xf bank_mask:0xf
    v_mul_f32_dpp v199, v242, v75 row_newbcast:13 row_mask:0xf bank_mask:0xf
    v_mul_f32_dpp v200, v242, v78 row_newbcast:6 row_mask:0xf bank_mask:0xf
    v_mul_f32_dpp v201, v242, v79 row_newbcast:7 row_mask:0xf bank_mask:0xf
    v_mul_f32_dpp v202, v242, v78 row_newbcast:14 row_mask:0xf bank_mask:0xf
    v_mul_f32_dpp v203, v242, v79 row_newbcast:15 row_mask:0xf bank_mask:0xf
    v_cvt_pk_bf16_f32 v74, v196, v197
    v_cvt_pk_bf16_f32 v78, v198, v199
    v_cvt_pk_bf16_f32 v75, v200, v201
    v_cvt_pk_bf16_f32 v79, v202, v203
    s_waitcnt vmcnt(4) lgkmcnt(0)
    v_mfma_f32_32x32x16_bf16 v[56:71], v[72:75], v[176:179], 0
    v_mul_f32_dpp v196, v243, v80 row_newbcast:0 row_mask:0xf bank_mask:0xf
    v_mul_f32_dpp v197, v243, v81 row_newbcast:1 row_mask:0xf bank_mask:0xf
    v_mul_f32_dpp v198, v243, v80 row_newbcast:8 row_mask:0xf bank_mask:0xf
    v_mul_f32_dpp v199, v243, v81 row_newbcast:9 row_mask:0xf bank_mask:0xf
    v_mul_f32_dpp v200, v243, v84 row_newbcast:2 row_mask:0xf bank_mask:0xf
    v_mul_f32_dpp v201, v243, v85 row_newbcast:3 row_mask:0xf bank_mask:0xf
    s_add_u32 m0, s21, 0
    v_mfma_f32_32x32x16_bf16 v[16:31], v[76:79], v[176:179], 0
    buffer_load_dwordx4 v234, s[4:7], s36 offen  lds
    buffer_load_dwordx4 v235, s[8:11], s36 offen offset:1024  lds
    ds_read_b64_tr_b16 v[176:177], v244 offset:2048
    ds_read_b64_tr_b16 v[178:179], v244 offset:3072
    ds_read_b64_tr_b16 v[184:185], v245 offset:2048
    ds_read_b64_tr_b16 v[186:187], v245 offset:3072
    v_mul_f32_dpp v202, v243, v84 row_newbcast:10 row_mask:0xf bank_mask:0xf
    v_mul_f32_dpp v203, v243, v85 row_newbcast:11 row_mask:0xf bank_mask:0xf
    v_cvt_pk_bf16_f32 v80, v196, v197
    v_cvt_pk_bf16_f32 v84, v198, v199
    v_cvt_pk_bf16_f32 v81, v200, v201
    v_cvt_pk_bf16_f32 v85, v202, v203
    v_mul_f32_dpp v196, v243, v82 row_newbcast:4 row_mask:0xf bank_mask:0xf
    v_mul_f32_dpp v197, v243, v83 row_newbcast:5 row_mask:0xf bank_mask:0xf
    v_mul_f32_dpp v198, v243, v82 row_newbcast:12 row_mask:0xf bank_mask:0xf
    v_mul_f32_dpp v199, v243, v83 row_newbcast:13 row_mask:0xf bank_mask:0xf
    v_mul_f32_dpp v200, v243, v86 row_newbcast:6 row_mask:0xf bank_mask:0xf
    v_mul_f32_dpp v201, v243, v87 row_newbcast:7 row_mask:0xf bank_mask:0xf
    v_mul_f32_dpp v202, v243, v86 row_newbcast:14 row_mask:0xf bank_mask:0xf
    v_mul_f32_dpp v203, v243, v87 row_newbcast:15 row_mask:0xf bank_mask:0xf
    v_cvt_pk_bf16_f32 v82, v196, v197
    v_cvt_pk_bf16_f32 v86, v198, v199
    v_cvt_pk_bf16_f32 v83, v200, v201
    v_cvt_pk_bf16_f32 v87, v202, v203
    s_waitcnt lgkmcnt(0)
    v_mfma_f32_32x32x16_bf16 v[56:71], v[80:83], v[176:179], v[56:71]
    s_add_u32 m0, s21, 2048
    v_mfma_f32_32x32x16_bf16 v[16:31], v[84:87], v[176:179], v[16:31]
    buffer_load_dwordx4 v236, s[4:7], s36 offen  lds
    buffer_load_dwordx4 v237, s[8:11], s36 offen offset:1024  lds
    s_mov_b32 m0, s50
    s_nop 0
    s_movrels_b32 s71, s23
    s_bfe_u32 s46, s71, 0x30012
    s_mov_b32 m0, s46
    s_and_b32 s66, s71, 0x3ffff
    s_movrels_b32 s68, s57
    s_movrels_b32 s69, s61
    s_sub_u32 s48, s66, s47
    s_mov_b32 s47, s66
    s_lshr_b32 s52, s71, 28
    s_lshl_b32 s67, s46, 9
    s_add_u32 s66, s66, s67
    s_sub_u32 s49, s66, s42
    s_mov_b32 s42, s66
    s_bfe_u32 s66, s68, 655360
    s_add_u32 s43, s42, s66
    s_bfe_u32 s39, s69, 655360
    s_bfe_u32 s66, s68, 655370
    s_add_u32 s44, s42, s66
    s_bfe_u32 s40, s69, 655370
    s_bfe_u32 s66, s68, 655380
    s_add_u32 s45, s42, s66
    s_bfe_u32 s41, s69, 655380
    s_and_b32 s66, s46, s33
    s_cselect_b32 s72, -1, 1
    s_cselect_b32 s76, s47, 163712
    s_cmp_ge_u32 s66, 2
    s_cselect_b32 s73, -1, 0
    s_add_u32 s77, s47, 1024
    s_cmp_ge_u32 s66, 4
    s_cselect_b32 s75, -1, 0
    s_cmp_ge_u32 s66, 3
    s_cselect_b32 s74, -1, 1
    s_cselect_b32 s77, s77, 163712
    v_add_u32 v252, s44, v247
    ds_read2_b32 v[238:239], v252 offset0:0 offset1:16
    v_add_u32 v252, s45, v247
    ds_read2_b32 v[240:241], v252 offset0:0 offset1:16
    v_mfma_f32_32x32x16_bf16 v[32:47], v[72:75], v[180:183], 0
    v_mul_f32 v196, v56, v96
    v_fmac_f32 v196, v57, v97
    v_fmac_f32 v196, v58, v98
    v_fmac_f32 v196, v59, v99
    v_fmac_f32 v196, v60, v100
    v_fmac_f32 v196, v61, v101
    v_mfma_f32_32x32x16_bf16 v[0:15], v[76:79], v[180:183], 0
    s_waitcnt vmcnt(6)
    ds_read_b64_tr_b16 v[176:177], v244 offset:4096
    ds_read_b64_tr_b16 v[178:179], v244 offset:5120
    ds_read_b64_tr_b16 v[180:181], v245 offset:4096
    ds_read_b64_tr_b16 v[182:183], v245 offset:5120
    v_fmac_f32 v196, v62, v102
    v_fmac_f32 v196, v63, v103
    v_mfma_f32_32x32x16_bf16 v[32:47], v[80:83], v[184:187], v[32:47]
    v_mul_f32 v198, v64, v128
    v_fmac_f32 v198, v65, v129
    v_fmac_f32 v198, v66, v130
    v_fmac_f32 v198, v67, v131
    v_fmac_f32 v198, v68, v132
    v_fmac_f32 v198, v69, v133
    v_mfma_f32_32x32x16_bf16 v[0:15], v[84:87], v[184:187], v[0:15]
    v_fmac_f32 v198, v70, v134
    v_fmac_f32 v198, v71, v135
    v_mul_f32 v200, v16, v128
    v_fmac_f32 v200, v17, v129
    v_permlane32_swap_b32 v196, v198
    v_fmac_f32 v200, v18, v130
    v_fmac_f32 v200, v19, v131
    v_fmac_f32 v200, v20, v132
    v_fmac_f32 v200, v21, v133
    v_fmac_f32 v200, v22, v134
    v_fmac_f32 v200, v23, v135
    v_add_f32 v198, v196, v198
    v_mul_f32_e64 v202, v24, -v128
    v_fma_f32 v202, v25, -v129, v202
    v_fma_f32 v202, v26, -v130, v202
    v_fma_f32 v202, v27, -v131, v202
    v_fma_f32 v202, v28, -v132, v202
    v_fma_f32 v202, v29, -v133, v202
    v_fma_f32 v202, v30, -v134, v202
    v_fma_f32 v202, v31, -v135, v202
    s_nop 1
    v_permlane32_swap_b32 v200, v202
    v_add_f32 v202, v200, v202
    s_waitcnt vmcnt(4) lgkmcnt(0)
    v_mfma_f32_32x32x16_bf16 v[56:71], v[72:75], v[176:179], 0
    v_mul_f32 v197, v32, v104
    v_fmac_f32 v197, v33, v105
    v_fmac_f32 v197, v34, v106
    v_fmac_f32 v197, v35, v107
    v_fmac_f32 v197, v36, v108
    v_fmac_f32 v197, v37, v109
    s_add_u32 m0, s21, 4096
    v_mfma_f32_32x32x16_bf16 v[16:31], v[76:79], v[176:179], 0
    buffer_load_dwordx4 v234, s[4:7], s37 offen  lds
    buffer_load_dwordx4 v235, s[8:11], s37 offen offset:1024  lds
    ds_read_b64_tr_b16 v[176:177], v244 offset:6144
    ds_read_b64_tr_b16 v[178:179], v244 offset:7168
    ds_read_b64_tr_b16 v[184:185], v245 offset:6144
    ds_read_b64_tr_b16 v[186:187], v245 offset:7168
    v_add_u32 v252, s42, v247
    ds_read2_b32 v[234:235], v252 offset0:0 offset1:16
    v_fmac_f32 v197, v38, v110
    v_fmac_f32 v197, v39, v111
    v_mul_f32 v199, v40, v136
    v_fmac_f32 v199, v41, v137
    v_fmac_f32 v199, v42, v138
    v_fmac_f32 v199, v43, v139
    v_fmac_f32 v199, v44, v140
    v_fmac_f32 v199, v45, v141
    v_fmac_f32 v199, v46, v142
    v_fmac_f32 v199, v47, v143
    v_mul_f32 v201, v0, v136
    v_fmac_f32 v201, v1, v137
    v_permlane32_swap_b32 v197, v199
    v_fmac_f32 v201, v2, v138
    v_fmac_f32 v201, v3, v139
    v_fmac_f32 v201, v4, v140
    v_fmac_f32 v201, v5, v141
    v_fmac_f32 v201, v6, v142
    v_fmac_f32 v201, v7, v143
    v_add_f32 v199, v197, v199
    v_mul_f32_e64 v203, v8, -v136
    v_fma_f32 v203, v9, -v137, v203
    v_fma_f32 v203, v10, -v138, v203
    v_fma_f32 v203, v11, -v139, v203
    s_waitcnt lgkmcnt(1)
    v_mfma_f32_32x32x16_bf16 v[56:71], v[80:83], v[176:179], v[56:71]
    v_fma_f32 v203, v12, -v140, v203
    v_fma_f32 v203, v13, -v141, v203
    v_fma_f32 v203, v14, -v142, v203
    v_fma_f32 v203, v15, -v143, v203
    s_nop 1
    v_permlane32_swap_b32 v201, v203
    v_add_f32 v203, v201, v203
    s_add_u32 m0, s21, 6144
    v_mfma_f32_32x32x16_bf16 v[16:31], v[84:87], v[176:179], v[16:31]
    buffer_load_dwordx4 v236, s[4:7], s37 offen  lds
    buffer_load_dwordx4 v237, s[8:11], s37 offen offset:1024  lds
    v_add_u32 v252, s43, v247
    ds_read2_b32 v[236:237], v252 offset0:0 offset1:16
    s_set_gpr_idx_on s51, gpr_idx(DST)
    s_nop 0
    v_cvt_pk_bf16_f32 v204, v198, v199
    v_cvt_pk_bf16_f32 v205, v202, v203
    s_set_gpr_idx_off
    v_mfma_f32_32x32x16_bf16 v[32:47], v[72:75], v[180:183], 0
    v_mul_f32 v196, v56, v144
    v_fmac_f32 v196, v57, v145
    v_fmac_f32 v196, v58, v146
    v_fmac_f32 v196, v59, v147
    v_fmac_f32 v196, v60, v148
    v_fmac_f32 v196, v61, v149
    v_mfma_f32_32x32x16_bf16 v[0:15], v[76:79], v[180:183], 0
    s_waitcnt vmcnt(6)
    ds_read_b64_tr_b16 v[176:177], v244 offset:0
    ds_read_b64_tr_b16 v[178:179], v244 offset:1024
    ds_read_b64_tr_b16 v[180:181], v245 offset:0
    ds_read_b64_tr_b16 v[182:183], v245 offset:1024
    v_fmac_f32 v196, v62, v150
    v_fmac_f32 v196, v63, v151
    v_mfma_f32_32x32x16_bf16 v[32:47], v[80:83], v[184:187], v[32:47]
    v_mul_f32_e64 v200, v16, -v160
    v_fma_f32 v200, v17, -v161, v200
    v_fma_f32 v200, v18, -v162, v200
    v_fma_f32 v200, v19, -v163, v200
    v_fma_f32 v200, v20, -v164, v200
    v_fma_f32 v200, v21, -v165, v200
    v_mfma_f32_32x32x16_bf16 v[0:15], v[84:87], v[184:187], v[0:15]
    v_fma_f32 v200, v22, -v166, v200
    v_fma_f32 v200, v23, -v167, v200
    v_mul_f32_e64 v202, v24, -v160
    v_fma_f32 v202, v25, -v161, v202
    v_fma_f32 v202, v26, -v162, v202
    v_fma_f32 v202, v27, -v163, v202
    v_fma_f32 v202, v28, -v164, v202
    v_fma_f32 v202, v29, -v165, v202
    v_fma_f32 v202, v30, -v166, v202
    v_fma_f32 v202, v31, -v167, v202
    s_waitcnt vmcnt(4) lgkmcnt(0)
    v_mfma_f32_32x32x16_bf16 v[16:31], v[72:75], v[176:179], 0
    v_mul_f32 v197, v32, v152
    v_fmac_f32 v197, v33, v153
    v_fmac_f32 v197, v34, v154
    v_fmac_f32 v197, v35, v155
    v_fmac_f32 v197, v36, v156
    v_fmac_f32 v197, v37, v157
    s_add_u32 m0, s21, 0
    v_mfma_f32_32x32x16_bf16 v[48:63], v[76:79], v[176:179], 0
    v_mad_u32_u16 v234, v234, s3, v246 op_sel:[1,0,0,0]
    v_mad_u32_u16 v235, v235, s3, v246 op_sel:[1,0,0,0]
    buffer_load_dwordx4 v234, s[4:7], s38 offen  lds
    buffer_load_dwordx4 v235, s[8:11], s38 offen offset:1024  lds
    ds_read_b64_tr_b16 v[176:177], v244 offset:2048
    ds_read_b64_tr_b16 v[178:179], v244 offset:3072
    ds_read_b64_tr_b16 v[184:185], v245 offset:2048
    ds_read_b64_tr_b16 v[186:187], v245 offset:3072
    v_fmac_f32 v197, v38, v158
    v_fmac_f32 v197, v39, v159
    v_mul_f32_e64 v201, v0, -v168
    v_fma_f32 v201, v1, -v169, v201
    v_fma_f32 v201, v2, -v170, v201
    v_fma_f32 v201, v3, -v171, v201
    v_fma_f32 v201, v4, -v172, v201
    v_fma_f32 v201, v5, -v173, v201
    v_fma_f32 v201, v6, -v174, v201
    v_fma_f32 v201, v7, -v175, v201
    s_waitcnt lgkmcnt(0)
    v_mfma_f32_32x32x16_bf16 v[16:31], v[80:83], v[176:179], v[16:31]
    v_mul_f32_e64 v203, v8, -v168
    v_fma_f32 v203, v9, -v169, v203
    v_fma_f32 v203, v10, -v170, v203
    v_fma_f32 v203, v11, -v171, v203
    v_fma_f32 v203, v12, -v172, v203
    v_fma_f32 v203, v13, -v173, v203
    s_add_u32 m0, s21, 2048
    v_mfma_f32_32x32x16_bf16 v[48:63], v[84:87], v[176:179], v[48:63]
    v_mad_u32_u16 v236, v236, s3, v246 op_sel:[1,0,0,0]
    v_mad_u32_u16 v237, v237, s3, v246 op_sel:[1,0,0,0]
    buffer_load_dwordx4 v236, s[4:7], s39 offen  lds
    buffer_load_dwordx4 v237, s[8:11], s39 offen offset:1024  lds
    v_fma_f32 v203, v14, -v174, v203
    v_fma_f32 v203, v15, -v175, v203
    v_mfma_f32_32x32x16_bf16 v[0:15], v[72:75], v[180:183], 0
    v_fmac_f32 v200, v24, v160
    v_fmac_f32 v200, v25, v161
    v_fmac_f32 v200, v26, v162
    v_fmac_f32 v200, v27, v163
    v_fmac_f32 v200, v28, v164
    v_fmac_f32 v200, v29, v165
    v_fmac_f32 v200, v30, v166
    v_fmac_f32 v200, v31, v167
    v_mfma_f32_32x32x16_bf16 v[24:39], v[76:79], v[180:183], 0
    v_add_u32 v253, s47, v248
    ds_read_b32 v192, v253
    ds_read_b32 v193, v253 offset:256
    s_waitcnt vmcnt(6)
    ds_read_b64_tr_b16 v[176:177], v244 offset:4096
    ds_read_b64_tr_b16 v[178:179], v244 offset:5120
    ds_read_b64_tr_b16 v[180:181], v245 offset:4096
    ds_read_b64_tr_b16 v[182:183], v245 offset:5120
    v_mfma_f32_32x32x16_bf16 v[24:39], v[84:87], v[184:187], v[24:39]
    v_mul_f32 v254, v16, v144
    v_fmac_f32 v254, v17, v145
    v_fmac_f32 v254, v18, v146
    v_fmac_f32 v254, v19, v147
    v_fmac_f32 v254, v20, v148
    v_fmac_f32 v254, v21, v149
    v_mfma_f32_32x32x16_bf16 v[0:15], v[80:83], v[184:187], v[0:15]
    v_fmac_f32 v254, v22, v150
    v_fmac_f32 v254, v23, v151
    v_sub_f32_e64 v64, -v48, v64
    v_sub_f32_e64 v65, -v49, v65
    v_permlane32_swap_b32 v196, v254
    v_sub_f32_e64 v66, -v50, v66
    v_sub_f32_e64 v67, -v51, v67
    v_sub_f32_e64 v68, -v52, v68
    v_sub_f32_e64 v69, -v53, v69
    v_sub_f32_e64 v70, -v54, v70
    v_sub_f32_e64 v71, -v55, v71
    v_add_f32 v254, v196, v254
    s_waitcnt vmcnt(4) lgkmcnt(0)
    v_mfma_f32_32x32x16_bf16 v[56:71], v[76:79], v[176:179], v[56:71]
    v_sub_f32_e64 v40, -v24, v40
    v_sub_f32_e64 v41, -v25, v41
    v_sub_f32_e64 v42, -v26, v42
    v_sub_f32_e64 v43, -v27, v43
    v_sub_f32_e64 v44, -v28, v44
    v_sub_f32_e64 v45, -v29, v45
    v_sub_f32_e64 v46, -v30, v46
    v_sub_f32_e64 v47, -v31, v47
    s_mov_b32 m0, s76
    s_mov_b64 exec, s[72:73]
    buffer_load_dwordx4 v192, s[12:15], 0 offen  lds
    s_mov_b32 m0, s77
    s_mov_b64 exec, s[74:75]
    buffer_load_dwordx4 v193, s[12:15], 0 offen  lds
    s_mov_b64 exec, -1
    s_add_u32 m0, s21, 4096
    v_mfma_f32_32x32x16_bf16 v[16:31], v[72:75], v[176:179], 0
    v_mad_u32_u16 v238, v238, s3, v246 op_sel:[1,0,0,0]
    v_mad_u32_u16 v239, v239, s3, v246 op_sel:[1,0,0,0]
    buffer_load_dwordx4 v238, s[4:7], s40 offen  lds
    buffer_load_dwordx4 v239, s[8:11], s40 offen offset:1024  lds
    ds_read_b64_tr_b16 v[176:177], v244 offset:6144
    ds_read_b64_tr_b16 v[178:179], v244 offset:7168
    ds_read_b64_tr_b16 v[184:185], v245 offset:6144
    ds_read_b64_tr_b16 v[186:187], v245 offset:7168
    v_mul_f32 v255, v0, v152
    v_fmac_f32 v255, v1, v153
    v_fmac_f32 v255, v2, v154
    v_fmac_f32 v255, v3, v155
    v_fmac_f32 v255, v4, v156
    v_fmac_f32 v255, v5, v157
    v_fmac_f32 v255, v6, v158
    v_fmac_f32 v255, v7, v159
    v_fmac_f32 v201, v8, v168
    v_fmac_f32 v201, v9, v169
    v_permlane32_swap_b32 v197, v255
    s_waitcnt lgkmcnt(0)
    v_mfma_f32_32x32x16_bf16 v[16:31], v[80:83], v[176:179], v[16:31]
    v_fmac_f32 v201, v10, v170
    v_fmac_f32 v201, v11, v171
    v_fmac_f32 v201, v12, v172
    v_fmac_f32 v201, v13, v173
    v_fmac_f32 v201, v14, v174
    v_fmac_f32 v201, v15, v175
    s_add_u32 m0, s21, 6144
    v_mfma_f32_32x32x16_bf16 v[56:71], v[84:87], v[176:179], v[56:71]
    v_mad_u32_u16 v240, v240, s3, v246 op_sel:[1,0,0,0]
    v_mad_u32_u16 v241, v241, s3, v246 op_sel:[1,0,0,0]
    buffer_load_dwordx4 v240, s[4:7], s41 offen  lds
    buffer_load_dwordx4 v241, s[8:11], s41 offen offset:1024  lds
    v_add_f32 v255, v197, v255
    s_set_gpr_idx_on s51, gpr_idx(DST)
    s_nop 0
    v_cvt_pk_bf16_f32 v206, v254, v255
    s_set_gpr_idx_off
    v_mfma_f32_32x32x16_bf16 v[0:15], v[72:75], v[180:183], 0
    v_mul_f32 v254, v16, v144
    v_fmac_f32 v254, v17, v145
    v_fmac_f32 v254, v18, v146
    v_fmac_f32 v254, v19, v147
    v_fmac_f32 v254, v20, v148
    v_fmac_f32 v254, v21, v149
    v_mfma_f32_32x32x16_bf16 v[32:47], v[76:79], v[180:183], v[32:47]
    s_waitcnt vmcnt(8)
    ds_read_b64_tr_b16 v[176:177], v244 offset:0
    ds_read_b64_tr_b16 v[178:179], v244 offset:1024
    ds_read_b64_tr_b16 v[180:181], v245 offset:0
    ds_read_b64_tr_b16 v[182:183], v245 offset:1024
    v_fmac_f32 v254, v22, v150
    v_fmac_f32 v254, v23, v151
    v_mfma_f32_32x32x16_bf16 v[0:15], v[80:83], v[184:187], v[0:15]
    v_fma_f32 v202, v24, -v160, v202
    v_fma_f32 v202, v25, -v161, v202
    v_permlane32_swap_b32 v254, v200
    v_fma_f32 v202, v26, -v162, v202
    v_fma_f32 v202, v27, -v163, v202
    v_fma_f32 v202, v28, -v164, v202
    v_mfma_f32_32x32x16_bf16 v[32:47], v[84:87], v[184:187], v[32:47]
    v_add_u32 v249, s48, v249
    v_add_u32 v250, s49, v250
    v_fma_f32 v202, v29, -v165, v202
    v_fma_f32 v202, v30, -v166, v202
    v_fma_f32 v202, v31, -v167, v202
    v_add_f32 v200, v254, v200
    v_mul_f32_e64 v198, v64, -v112
    v_permlane32_swap_b32 v202, v254
    v_fma_f32 v198, v65, -v113, v198
    v_fma_f32 v198, v66, -v114, v198
    v_fma_f32 v198, v67, -v115, v198
    v_fma_f32 v198, v68, -v116, v198
    v_fma_f32 v198, v69, -v117, v198
    v_fma_f32 v198, v70, -v118, v198
    v_fma_f32 v198, v71, -v119, v198
    v_add_f32 v254, v202, v254
    v_mul_f32 v196, v56, v160
    v_fmac_f32 v196, v57, v161
    v_fmac_f32 v196, v58, v162
    v_fmac_f32 v196, v59, v163
    v_fmac_f32 v196, v60, v164
    v_fmac_f32 v196, v61, v165
    v_fmac_f32 v196, v62, v166
    v_fmac_f32 v196, v63, v167
    s_nop 1
    v_permlane32_swap_b32 v198, v196
    v_add_f32 v196, v198, v196
    v_mul_f32 v255, v0, v152
    v_fmac_f32 v255, v1, v153
    v_fmac_f32 v255, v2, v154
    v_fmac_f32 v255, v3, v155
    v_fmac_f32 v255, v4, v156
    v_fmac_f32 v255, v5, v157
    v_fmac_f32 v255, v6, v158
    v_fmac_f32 v255, v7, v159
    v_fma_f32 v203, v8, -v168, v203
    v_fma_f32 v203, v9, -v169, v203
    v_permlane32_swap_b32 v255, v201
    v_fma_f32 v203, v10, -v170, v203
    v_fma_f32 v203, v11, -v171, v203
    v_fma_f32 v203, v12, -v172, v203
    v_fma_f32 v203, v13, -v173, v203
    v_fma_f32 v203, v14, -v174, v203
    v_fma_f32 v203, v15, -v175, v203
    v_add_f32 v201, v255, v201
    v_mul_f32_e64 v199, v40, -v120
    v_permlane32_swap_b32 v203, v255
    v_fma_f32 v199, v41, -v121, v199
    v_fma_f32 v199, v42, -v122, v199
    v_fma_f32 v199, v43, -v123, v199
    s_waitcnt vmcnt(4)
    ds_read_b64_tr_b16 v[72:73], v249 offset:0
    ds_read_b64_tr_b16 v[76:77], v249 offset:64
    ds_read_b64_tr_b16 v[74:75], v249 offset:256
    ds_read_b64_tr_b16 v[78:79], v249 offset:320
    s_mov_b64 exec, s[54:55]
    ds_read_u16_d16_hi v242, v250 offset:0
    s_mov_b64 exec, -1
    v_fma_f32 v199, v44, -v124, v199
    v_fma_f32 v199, v45, -v125, v199
    v_fma_f32 v199, v46, -v126, v199
    v_fma_f32 v199, v47, -v127, v199
    v_add_f32 v255, v203, v255
    v_mul_f32 v197, v32, v168
    v_fmac_f32 v197, v33, v169
    v_fmac_f32 v197, v34, v170
    v_fmac_f32 v197, v35, v171
    v_fmac_f32 v197, v36, v172
    v_fmac_f32 v197, v37, v173
    v_fmac_f32 v197, v38, v174
    v_fmac_f32 v197, v39, v175
    s_nop 1
    v_permlane32_swap_b32 v199, v197
    v_add_f32 v197, v199, v197
    s_set_gpr_idx_on s51, gpr_idx(DST)
    s_nop 0
    v_cvt_pk_bf16_f32 v207, v200, v201
    v_cvt_pk_bf16_f32 v209, v254, v255
    v_cvt_pk_bf16_f32 v208, v196, v197
    s_set_gpr_idx_off
    s_add_u32 s50, s50, 1
    s_add_u32 s51, s51, 6
    s_cmp_ge_u32 s50, 4
    s_cbranch_scc1 LAST0
    s_add_u32 s53, s53, 4
    s_xor_b32 s66, s53, s20
    s_bitcmp1_b32 s66, 2
    s_setprio 1
    s_cbranch_scc1 PRIO_5
    s_setprio 0
PRIO_5:
    s_cmp_eq_u32 s52, 4
    s_cbranch_scc1 ITEM_0_4
    s_cmp_eq_u32 s52, 5
    s_cbranch_scc1 ITEM_0_5
    s_cmp_eq_u32 s52, 3
    s_cbranch_scc1 ITEM_0_3
    s_cmp_eq_u32 s52, 6
    s_cbranch_scc1 ITEM_0_6
    s_cmp_eq_u32 s52, 8
    s_cbranch_scc1 ITEM_0_8
    s_branch ITEM_0_2
.p2align 6
ITEM_0_5:
    s_mov_b64 exec, s[54:55]
    ds_read_u16_d16_hi v243, v250 offset:128
    s_mov_b64 exec, -1
    ds_read_b64_tr_b16 v[80:81], v249 offset:512
    ds_read_b64_tr_b16 v[84:85], v249 offset:576
    ds_read_b64_tr_b16 v[82:83], v249 offset:768
    ds_read_b64_tr_b16 v[86:87], v249 offset:832
    ds_read_b64_tr_b16 v[88:89], v249 offset:1024
    ds_read_b64_tr_b16 v[92:93], v249 offset:1088
    s_waitcnt lgkmcnt(7)
    v_mul_f32_dpp v196, v242, v72 row_newbcast:0 row_mask:0xf bank_mask:0xf
    v_mul_f32_dpp v197, v242, v73 row_newbcast:1 row_mask:0xf bank_mask:0xf
    v_mul_f32_dpp v198, v242, v72 row_newbcast:8 row_mask:0xf bank_mask:0xf
    v_mul_f32_dpp v199, v242, v73 row_newbcast:9 row_mask:0xf bank_mask:0xf
    v_mul_f32_dpp v200, v242, v76 row_newbcast:2 row_mask:0xf bank_mask:0xf
    v_mul_f32_dpp v201, v242, v77 row_newbcast:3 row_mask:0xf bank_mask:0xf
    v_mul_f32_dpp v202, v242, v76 row_newbcast:10 row_mask:0xf bank_mask:0xf
    v_mul_f32_dpp v203, v242, v77 row_newbcast:11 row_mask:0xf bank_mask:0xf
    v_cvt_pk_bf16_f32 v72, v196, v197
    v_cvt_pk_bf16_f32 v76, v198, v199
    v_cvt_pk_bf16_f32 v73, v200, v201
    v_cvt_pk_bf16_f32 v77, v202, v203
    v_mul_f32_dpp v196, v242, v74 row_newbcast:4 row_mask:0xf bank_mask:0xf
    v_mul_f32_dpp v197, v242, v75 row_newbcast:5 row_mask:0xf bank_mask:0xf
    v_mul_f32_dpp v198, v242, v74 row_newbcast:12 row_mask:0xf bank_mask:0xf
    v_mul_f32_dpp v199, v242, v75 row_newbcast:13 row_mask:0xf bank_mask:0xf
    v_mul_f32_dpp v200, v242, v78 row_newbcast:6 row_mask:0xf bank_mask:0xf
    v_mul_f32_dpp v201, v242, v79 row_newbcast:7 row_mask:0xf bank_mask:0xf
    v_mul_f32_dpp v202, v242, v78 row_newbcast:14 row_mask:0xf bank_mask:0xf
    v_mul_f32_dpp v203, v242, v79 row_newbcast:15 row_mask:0xf bank_mask:0xf
    v_cvt_pk_bf16_f32 v74, v196, v197
    v_cvt_pk_bf16_f32 v78, v198, v199
    v_cvt_pk_bf16_f32 v75, v200, v201
    v_cvt_pk_bf16_f32 v79, v202, v203
    s_mov_b64 exec, s[54:55]
    ds_read_u16_d16_hi v242, v250 offset:256
    s_mov_b64 exec, -1
    s_waitcnt vmcnt(4) lgkmcnt(3)
    v_mfma_f32_32x32x16_bf16 v[56:71], v[72:75], v[176:179], 0
    v_mul_f32_dpp v196, v243, v80 row_newbcast:0 row_mask:0xf bank_mask:0xf
    v_mul_f32_dpp v197, v243, v81 row_newbcast:1 row_mask:0xf bank_mask:0xf
    v_mul_f32_dpp v198, v243, v80 row_newbcast:8 row_mask:0xf bank_mask:0xf
    v_mul_f32_dpp v199, v243, v81 row_newbcast:9 row_mask:0xf bank_mask:0xf
    v_mul_f32_dpp v200, v243, v84 row_newbcast:2 row_mask:0xf bank_mask:0xf
    v_mul_f32_dpp v201, v243, v85 row_newbcast:3 row_mask:0xf bank_mask:0xf
    s_add_u32 m0, s21, 0
    v_mfma_f32_32x32x16_bf16 v[16:31], v[76:79], v[176:179], 0
    buffer_load_dwordx4 v236, s[4:7], s35 offen  lds
    buffer_load_dwordx4 v237, s[8:11], s35 offen offset:1024  lds
    ds_read_b64_tr_b16 v[176:177], v244 offset:2048
    ds_read_b64_tr_b16 v[178:179], v244 offset:3072
    ds_read_b64_tr_b16 v[184:185], v245 offset:2048
    ds_read_b64_tr_b16 v[186:187], v245 offset:3072
    v_mul_f32_dpp v202, v243, v84 row_newbcast:10 row_mask:0xf bank_mask:0xf
    v_mul_f32_dpp v203, v243, v85 row_newbcast:11 row_mask:0xf bank_mask:0xf
    v_cvt_pk_bf16_f32 v80, v196, v197
    v_cvt_pk_bf16_f32 v84, v198, v199
    v_cvt_pk_bf16_f32 v81, v200, v201
    v_cvt_pk_bf16_f32 v85, v202, v203
    v_mul_f32_dpp v196, v243, v82 row_newbcast:4 row_mask:0xf bank_mask:0xf
    v_mul_f32_dpp v197, v243, v83 row_newbcast:5 row_mask:0xf bank_mask:0xf
    v_mul_f32_dpp v198, v243, v82 row_newbcast:12 row_mask:0xf bank_mask:0xf
    v_mul_f32_dpp v199, v243, v83 row_newbcast:13 row_mask:0xf bank_mask:0xf
    v_mul_f32_dpp v200, v243, v86 row_newbcast:6 row_mask:0xf bank_mask:0xf
    v_mul_f32_dpp v201, v243, v87 row_newbcast:7 row_mask:0xf bank_mask:0xf
    v_mul_f32_dpp v202, v243, v86 row_newbcast:14 row_mask:0xf bank_mask:0xf
    v_mul_f32_dpp v203, v243, v87 row_newbcast:15 row_mask:0xf bank_mask:0xf
    v_cvt_pk_bf16_f32 v82, v196, v197
    v_cvt_pk_bf16_f32 v86, v198, v199
    v_cvt_pk_bf16_f32 v83, v200, v201
    v_cvt_pk_bf16_f32 v87, v202, v203
    s_waitcnt vmcnt(4) lgkmcnt(0)
    v_mfma_f32_32x32x16_bf16 v[56:71], v[80:83], v[176:179], v[56:71]
    v_mul_f32_dpp v196, v242, v88 row_newbcast:0 row_mask:0xf bank_mask:0xf
    v_mul_f32_dpp v197, v242, v89 row_newbcast:1 row_mask:0xf bank_mask:0xf
    v_mul_f32_dpp v198, v242, v88 row_newbcast:8 row_mask:0xf bank_mask:0xf
    v_mul_f32_dpp v199, v242, v89 row_newbcast:9 row_mask:0xf bank_mask:0xf
    v_mul_f32_dpp v200, v242, v92 row_newbcast:2 row_mask:0xf bank_mask:0xf
    v_mul_f32_dpp v201, v242, v93 row_newbcast:3 row_mask:0xf bank_mask:0xf
    s_add_u32 m0, s21, 2048
    v_mfma_f32_32x32x16_bf16 v[16:31], v[84:87], v[176:179], v[16:31]
    buffer_load_dwordx4 v238, s[4:7], s35 offen  lds
    ds_read_b64_tr_b16 v[176:177], v244 offset:4096
    ds_read_b64_tr_b16 v[188:189], v245 offset:4096
    v_mul_f32_dpp v202, v242, v92 row_newbcast:10 row_mask:0xf bank_mask:0xf
    v_mul_f32_dpp v203, v242, v93 row_newbcast:11 row_mask:0xf bank_mask:0xf
    v_cvt_pk_bf16_f32 v88, v196, v197
    v_cvt_pk_bf16_f32 v92, v198, v199
    v_cvt_pk_bf16_f32 v89, v200, v201
    v_cvt_pk_bf16_f32 v93, v202, v203
    s_waitcnt lgkmcnt(0)
    v_mfma_f32_32x32x8_bf16 v[56:71], v[88:89], v[176:177], v[56:71]
    s_add_u32 m0, s21, 4096
    v_mfma_f32_32x32x8_bf16 v[16:31], v[92:93], v[176:177], v[16:31]
    buffer_load_dwordx4 v234, s[4:7], s36 offen  lds
    buffer_load_dwordx4 v235, s[8:11], s36 offen offset:1024  lds
    s_mov_b32 m0, s50
    s_nop 0
    s_movrels_b32 s71, s23
    s_bfe_u32 s46, s71, 0x30012
    s_mov_b32 m0, s46
    s_and_b32 s66, s71, 0x3ffff
    s_movrels_b32 s68, s57
    s_movrels_b32 s69, s61
    s_sub_u32 s48, s66, s47
    s_mov_b32 s47, s66
    s_lshr_b32 s52, s71, 28
    s_lshl_b32 s67, s46, 9
    s_add_u32 s66, s66, s67
    s_sub_u32 s49, s66, s42
    s_mov_b32 s42, s66
    s_bfe_u32 s66, s68, 655360
    s_add_u32 s43, s42, s66
    s_bfe_u32 s39, s69, 655360
    s_bfe_u32 s66, s68, 655370
    s_add_u32 s44, s42, s66
    s_bfe_u32 s40, s69, 655370
    s_bfe_u32 s66, s68, 655380
    s_add_u32 s45, s42, s66
    s_bfe_u32 s41, s69, 655380
    s_and_b32 s66, s46, s33
    s_cselect_b32 s72, -1, 1
    s_cselect_b32 s76, s47, 163712
    s_cmp_ge_u32 s66, 2
    s_cselect_b32 s73, -1, 0
    s_add_u32 s77, s47, 1024
    s_cmp_ge_u32 s66, 4
    s_cselect_b32 s75, -1, 0
    s_cmp_ge_u32 s66, 3
    s_cselect_b32 s74, -1, 1
    s_cselect_b32 s77, s77, 163712
    v_add_u32 v252, s45, v247
    ds_read2_b32 v[240:241], v252 offset0:0 offset1:16
    v_mfma_f32_32x32x16_bf16 v[32:47], v[72:75], v[180:183], 0
    v_mul_f32 v196, v56, v96
    v_fmac_f32 v196, v57, v97
    v_fmac_f32 v196, v58, v98
    v_fmac_f32 v196, v59, v99
    v_fmac_f32 v196, v60, v100
    v_fmac_f32 v196, v61, v101
    v_mfma_f32_32x32x16_bf16 v[0:15], v[76:79], v[180:183], 0
    v_fmac_f32 v196, v62, v102
    v_fmac_f32 v196, v63, v103
    v_mul_f32 v198, v64, v128
    v_fmac_f32 v198, v65, v129
    v_fmac_f32 v198, v66, v130
    v_fmac_f32 v198, v67, v131
    v_mfma_f32_32x32x16_bf16 v[32:47], v[80:83], v[184:187], v[32:47]
    v_fmac_f32 v198, v68, v132
    v_fmac_f32 v198, v69, v133
    v_fmac_f32 v198, v70, v134
    v_fmac_f32 v198, v71, v135
    v_mul_f32 v200, v16, v128
    v_fmac_f32 v200, v17, v129
    v_mfma_f32_32x32x16_bf16 v[0:15], v[84:87], v[184:187], v[0:15]
    s_waitcnt vmcnt(5)
    ds_read_b64_tr_b16 v[176:177], v244 offset:6144
    ds_read_b64_tr_b16 v[178:179], v244 offset:7168
    ds_read_b64_tr_b16 v[180:181], v245 offset:6144
    ds_read_b64_tr_b16 v[182:183], v245 offset:7168
    v_permlane32_swap_b32 v196, v198
    v_fmac_f32 v200, v18, v130
    v_mfma_f32_32x32x8_bf16 v[32:47], v[88:89], v[188:189], v[32:47]
    v_fmac_f32 v200, v19, v131
    v_fmac_f32 v200, v20, v132
    v_fmac_f32 v200, v21, v133
    v_fmac_f32 v200, v22, v134
    v_fmac_f32 v200, v23, v135
    v_add_f32 v198, v196, v198
    v_mfma_f32_32x32x8_bf16 v[0:15], v[92:93], v[188:189], v[0:15]
    v_mul_f32_e64 v202, v24, -v128
    v_fma_f32 v202, v25, -v129, v202
    v_fma_f32 v202, v26, -v130, v202
    v_fma_f32 v202, v27, -v131, v202
    v_fma_f32 v202, v28, -v132, v202
    v_fma_f32 v202, v29, -v133, v202
    v_fma_f32 v202, v30, -v134, v202
    v_fma_f32 v202, v31, -v135, v202
    s_nop 1
    v_permlane32_swap_b32 v200, v202
    v_add_f32 v202, v200, v202
    s_waitcnt vmcnt(3) lgkmcnt(0)
    v_mfma_f32_32x32x16_bf16 v[56:71], v[72:75], v[176:179], 0
    v_mul_f32 v197, v32, v104
    v_fmac_f32 v197, v33, v105
    v_fmac_f32 v197, v34, v106
    v_fmac_f32 v197, v35, v107
    v_fmac_f32 v197, v36, v108
    v_fmac_f32 v197, v37, v109
    s_add_u32 m0, s21, 6144
    v_mfma_f32_32x32x16_bf16 v[16:31], v[76:79], v[176:179], 0
    buffer_load_dwordx4 v236, s[4:7], s36 offen  lds
    buffer_load_dwordx4 v237, s[8:11], s36 offen offset:1024  lds
    ds_read_b64_tr_b16 v[176:177], v244 offset:0
    ds_read_b64_tr_b16 v[178:179], v244 offset:1024
    ds_read_b64_tr_b16 v[184:185], v245 offset:0
    ds_read_b64_tr_b16 v[186:187], v245 offset:1024
    v_fmac_f32 v197, v38, v110
    v_fmac_f32 v197, v39, v111
    v_mul_f32 v199, v40, v136
    v_fmac_f32 v199, v41, v137
    v_fmac_f32 v199, v42, v138
    v_fmac_f32 v199, v43, v139
    v_fmac_f32 v199, v44, v140
    v_fmac_f32 v199, v45, v141
    v_fmac_f32 v199, v46, v142
    v_fmac_f32 v199, v47, v143
    v_mul_f32 v201, v0, v136
    v_fmac_f32 v201, v1, v137
    v_permlane32_swap_b32 v197, v199
    v_fmac_f32 v201, v2, v138
    v_fmac_f32 v201, v3, v139
    s_waitcnt vmcnt(4) lgkmcnt(0)
    v_mfma_f32_32x32x16_bf16 v[56:71], v[80:83], v[176:179], v[56:71]
    v_fmac_f32 v201, v4, v140
    v_fmac_f32 v201, v5, v141
    v_fmac_f32 v201, v6, v142
    v_fmac_f32 v201, v7, v143
    v_add_f32 v199, v197, v199
    v_mul_f32_e64 v203, v8, -v136
    s_add_u32 m0, s21, 0
    v_mfma_f32_32x32x16_bf16 v[16:31], v[84:87], v[176:179], v[16:31]
    buffer_load_dwordx4 v238, s[4:7], s36 offen  lds
    ds_read_b64_tr_b16 v[176:177], v244 offset:2048
    ds_read_b64_tr_b16 v[188:189], v245 offset:2048
    v_fma_f32 v203, v9, -v137, v203
    v_fma_f32 v203, v10, -v138, v203
    v_fma_f32 v203, v11, -v139, v203
    s_waitcnt lgkmcnt(0)
    v_mfma_f32_32x32x8_bf16 v[56:71], v[88:89], v[176:177], v[56:71]
    v_fma_f32 v203, v12, -v140, v203
    v_fma_f32 v203, v13, -v141, v203
    v_fma_f32 v203, v14, -v142, v203
    v_fma_f32 v203, v15, -v143, v203
    s_nop 1
    v_permlane32_swap_b32 v201, v203
    v_add_f32 v203, v201, v203
    s_add_u32 m0, s21, 2048
    v_mfma_f32_32x32x8_bf16 v[16:31], v[92:93], v[176:177], v[16:31]
    buffer_load_dwordx4 v234, s[4:7], s37 offen  lds
    buffer_load_dwordx4 v235, s[8:11], s37 offen offset:1024  lds
    v_add_u32 v252, s42, v247
    ds_read2_b32 v[234:235], v252 offset0:0 offset1:16
    s_set_gpr_idx_on s51, gpr_idx(DST)
    s_nop 0
    v_cvt_pk_bf16_f32 v204, v198, v199
    v_cvt_pk_bf16_f32 v205, v202, v203
    s_set_gpr_idx_off
    v_mfma_f32_32x32x16_bf16 v[32:47], v[72:75], v[180:183], 0
    v_mul_f32 v196, v56, v144
    v_fmac_f32 v196, v57, v145
    v_fmac_f32 v196, v58, v146
    v_fmac_f32 v196, v59, v147
    v_fmac_f32 v196, v60, v148
    v_fmac_f32 v196, v61, v149
    v_mfma_f32_32x32x16_bf16 v[0:15], v[76:79], v[180:183], 0
    v_fmac_f32 v196, v62, v150
    v_fmac_f32 v196, v63, v151
    v_mul_f32_e64 v200, v16, -v160
    v_fma_f32 v200, v17, -v161, v200
    v_fma_f32 v200, v18, -v162, v200
    v_fma_f32 v200, v19, -v163, v200
    v_mfma_f32_32x32x16_bf16 v[32:47], v[80:83], v[184:187], v[32:47]
    v_fma_f32 v200, v20, -v164, v200
    v_fma_f32 v200, v21, -v165, v200
    v_fma_f32 v200, v22, -v166, v200
    v_fma_f32 v200, v23, -v167, v200
    v_mul_f32_e64 v202, v24, -v160
    v_fma_f32 v202, v25, -v161, v202
    v_mfma_f32_32x32x16_bf16 v[0:15], v[84:87], v[184:187], v[0:15]
    s_waitcnt vmcnt(5)
    ds_read_b64_tr_b16 v[176:177], v244 offset:4096
    ds_read_b64_tr_b16 v[178:179], v244 offset:5120
    ds_read_b64_tr_b16 v[180:181], v245 offset:4096
    ds_read_b64_tr_b16 v[182:183], v245 offset:5120
    v_fma_f32 v202, v26, -v162, v202
    v_fma_f32 v202, v27, -v163, v202
    v_mfma_f32_32x32x8_bf16 v[32:47], v[88:89], v[188:189], v[32:47]
    v_fma_f32 v202, v28, -v164, v202
    v_fma_f32 v202, v29, -v165, v202
    v_fma_f32 v202, v30, -v166, v202
    v_fma_f32 v202, v31, -v167, v202
    v_mfma_f32_32x32x8_bf16 v[0:15], v[92:93], v[188:189], v[0:15]
    s_waitcnt vmcnt(3) lgkmcnt(0)
    v_mfma_f32_32x32x16_bf16 v[16:31], v[72:75], v[176:179], 0
    s_nop 4
    v_mul_f32 v197, v32, v152
    v_fmac_f32 v197, v33, v153
    v_fmac_f32 v197, v34, v154
    v_fmac_f32 v197, v35, v155
    v_fmac_f32 v197, v36, v156
    v_fmac_f32 v197, v37, v157
    s_add_u32 m0, s21, 4096
    v_mfma_f32_32x32x16_bf16 v[48:63], v[76:79], v[176:179], 0
    buffer_load_dwordx4 v236, s[4:7], s37 offen  lds
    buffer_load_dwordx4 v237, s[8:11], s37 offen offset:1024  lds
    ds_read_b64_tr_b16 v[176:177], v244 offset:6144
    ds_read_b64_tr_b16 v[178:179], v244 offset:7168
    ds_read_b64_tr_b16 v[184:185], v245 offset:6144
    ds_read_b64_tr_b16 v[186:187], v245 offset:7168
    v_add_u32 v252, s43, v247
    ds_read2_b32 v[236:237], v252 offset0:0 offset1:16
    v_fmac_f32 v197, v38, v158
    v_fmac_f32 v197, v39, v159
    v_mul_f32_e64 v201, v0, -v168
    s_waitcnt vmcnt(4) lgkmcnt(1)
    v_mfma_f32_32x32x16_bf16 v[16:31], v[80:83], v[176:179], v[16:31]
    v_fma_f32 v201, v1, -v169, v201
    v_fma_f32 v201, v2, -v170, v201
    v_fma_f32 v201, v3, -v171, v201
    v_fma_f32 v201, v4, -v172, v201
    v_fma_f32 v201, v5, -v173, v201
    v_fma_f32 v201, v6, -v174, v201
    s_add_u32 m0, s21, 6144
    v_mfma_f32_32x32x16_bf16 v[48:63], v[84:87], v[176:179], v[48:63]
    buffer_load_dwordx4 v238, s[4:7], s37 offen  lds
    ds_read_b64_tr_b16 v[176:177], v244 offset:0
    ds_read_b64_tr_b16 v[188:189], v245 offset:0
    v_add_u32 v252, s44, v247
    ds_read2_b32 v[238:239], v252 offset0:0 offset1:16
    v_fma_f32 v201, v7, -v175, v201
    s_waitcnt lgkmcnt(1)
    v_mfma_f32_32x32x8_bf16 v[16:31], v[88:89], v[176:177], v[16:31]
    v_mul_f32_e64 v203, v8, -v168
    v_fma_f32 v203, v9, -v169, v203
    v_fma_f32 v203, v10, -v170, v203
    v_fma_f32 v203, v11, -v171, v203
    v_fma_f32 v203, v12, -v172, v203
    v_fma_f32 v203, v13, -v173, v203
    s_add_u32 m0, s21, 0
    v_mfma_f32_32x32x8_bf16 v[48:63], v[92:93], v[176:177], v[48:63]
    v_mad_u32_u16 v234, v234, s3, v246 op_sel:[1,0,0,0]
    v_mad_u32_u16 v235, v235, s3, v246 op_sel:[1,0,0,0]
    buffer_load_dwordx4 v234, s[4:7], s38 offen  lds
    buffer_load_dwordx4 v235, s[8:11], s38 offen offset:1024  lds
    v_fma_f32 v203, v14, -v174, v203
    v_fma_f32 v203, v15, -v175, v203
    v_mfma_f32_32x32x16_bf16 v[0:15], v[72:75], v[180:183], 0
    v_fmac_f32 v200, v24, v160
    v_fmac_f32 v200, v25, v161
    v_fmac_f32 v200, v26, v162
    v_fmac_f32 v200, v27, v163
    v_fmac_f32 v200, v28, v164
    v_fmac_f32 v200, v29, v165
    v_fmac_f32 v200, v30, v166
    v_fmac_f32 v200, v31, v167
    v_mfma_f32_32x32x16_bf16 v[24:39], v[76:79], v[180:183], 0
    v_add_u32 v253, s47, v248
    ds_read_b32 v192, v253
    ds_read_b32 v193, v253 offset:256
    v_mul_f32 v254, v16, v144
    v_fmac_f32 v254, v17, v145
    v_fmac_f32 v254, v18, v146
    v_mfma_f32_32x32x16_bf16 v[0:15], v[80:83], v[184:187], v[0:15]
    v_fmac_f32 v254, v19, v147
    v_fmac_f32 v254, v20, v148
    v_fmac_f32 v254, v21, v149
    v_fmac_f32 v254, v22, v150
    v_fmac_f32 v254, v23, v151
    v_sub_f32_e64 v64, -v48, v64
    v_mfma_f32_32x32x16_bf16 v[24:39], v[84:87], v[184:187], v[24:39]
    s_waitcnt vmcnt(5)
    ds_read_b64_tr_b16 v[176:177], v244 offset:2048
    ds_read_b64_tr_b16 v[178:179], v244 offset:3072
    ds_read_b64_tr_b16 v[180:181], v245 offset:2048
    ds_read_b64_tr_b16 v[182:183], v245 offset:3072
    v_sub_f32_e64 v65, -v49, v65
    v_permlane32_swap_b32 v196, v254
    v_mfma_f32_32x32x8_bf16 v[24:39], v[92:93], v[188:189], v[24:39]
    v_sub_f32_e64 v66, -v50, v66
    v_sub_f32_e64 v67, -v51, v67
    v_sub_f32_e64 v68, -v52, v68
    v_sub_f32_e64 v69, -v53, v69
    v_sub_f32_e64 v70, -v54, v70
    v_sub_f32_e64 v71, -v55, v71
    v_mfma_f32_32x32x8_bf16 v[0:15], v[88:89], v[188:189], v[0:15]
    v_add_f32 v254, v196, v254
    s_waitcnt vmcnt(3) lgkmcnt(0)
    v_mfma_f32_32x32x16_bf16 v[56:71], v[76:79], v[176:179], v[56:71]
    s_nop 1
    v_sub_f32_e64 v40, -v24, v40
    v_sub_f32_e64 v41, -v25, v41
    v_sub_f32_e64 v42, -v26, v42
    v_sub_f32_e64 v43, -v27, v43
    v_sub_f32_e64 v44, -v28, v44
    v_sub_f32_e64 v45, -v29, v45
    v_sub_f32_e64 v46, -v30, v46
    v_sub_f32_e64 v47, -v31, v47
    s_mov_b32 m0, s76
    s_mov_b64 exec, s[72:73]
    buffer_load_dwordx4 v192, s[12:15], 0 offen  lds
    s_mov_b32 m0, s77
    s_mov_b64 exec, s[74:75]
    buffer_load_dwordx4 v193, s[12:15], 0 offen  lds
    s_mov_b64 exec, -1
    s_add_u32 m0, s21, 2048
    v_mfma_f32_32x32x16_bf16 v[16:31], v[72:75], v[176:179], 0
    v_mad_u32_u16 v236, v236, s3, v246 op_sel:[1,0,0,0]
    v_mad_u32_u16 v237, v237, s3, v246 op_sel:[1,0,0,0]
    buffer_load_dwordx4 v236, s[4:7], s39 offen  lds
    buffer_load_dwordx4 v237, s[8:11], s39 offen offset:1024  lds
    ds_read_b64_tr_b16 v[176:177], v244 offset:4096
    ds_read_b64_tr_b16 v[178:179], v244 offset:5120
    ds_read_b64_tr_b16 v[184:185], v245 offset:4096
    ds_read_b64_tr_b16 v[186:187], v245 offset:5120
    v_mul_f32 v255, v0, v152
    v_fmac_f32 v255, v1, v153
    v_fmac_f32 v255, v2, v154
    v_fmac_f32 v255, v3, v155
    v_fmac_f32 v255, v4, v156
    s_waitcnt vmcnt(6) lgkmcnt(0)
    v_mfma_f32_32x32x16_bf16 v[16:31], v[80:83], v[176:179], v[16:31]
    v_fmac_f32 v255, v5, v157
    v_fmac_f32 v255, v6, v158
    v_fmac_f32 v255, v7, v159
    v_fmac_f32 v201, v8, v168
    v_fmac_f32 v201, v9, v169
    v_permlane32_swap_b32 v197, v255
    s_add_u32 m0, s21, 4096
    v_mfma_f32_32x32x16_bf16 v[56:71], v[84:87], v[176:179], v[56:71]
    v_mad_u32_u16 v238, v238, s3, v246 op_sel:[1,0,0,0]
    v_mad_u32_u16 v239, v239, s3, v246 op_sel:[1,0,0,0]
    buffer_load_dwordx4 v238, s[4:7], s40 offen  lds
    buffer_load_dwordx4 v239, s[8:11], s40 offen offset:1024  lds
    ds_read_b64_tr_b16 v[176:177], v244 offset:6144
    ds_read_b64_tr_b16 v[188:189], v245 offset:6144
    s_waitcnt lgkmcnt(0)
    v_mfma_f32_32x32x8_bf16 v[16:31], v[88:89], v[176:177], v[16:31]
    v_fmac_f32 v201, v10, v170
    v_fmac_f32 v201, v11, v171
    v_fmac_f32 v201, v12, v172
    v_fmac_f32 v201, v13, v173
    v_fmac_f32 v201, v14, v174
    v_fmac_f32 v201, v15, v175
    s_add_u32 m0, s21, 6144
    v_mfma_f32_32x32x8_bf16 v[56:71], v[92:93], v[176:177], v[56:71]
    v_mad_u32_u16 v240, v240, s3, v246 op_sel:[1,0,0,0]
    v_mad_u32_u16 v241, v241, s3, v246 op_sel:[1,0,0,0]
    buffer_load_dwordx4 v240, s[4:7], s41 offen  lds
    buffer_load_dwordx4 v241, s[8:11], s41 offen offset:1024  lds
    v_add_f32 v255, v197, v255
    s_set_gpr_idx_on s51, gpr_idx(DST)
    s_nop 0
    v_cvt_pk_bf16_f32 v206, v254, v255
    s_set_gpr_idx_off
    v_mfma_f32_32x32x16_bf16 v[0:15], v[72:75], v[180:183], 0
    v_mul_f32 v254, v16, v144
    v_fmac_f32 v254, v17, v145
    v_fmac_f32 v254, v18, v146
    v_fmac_f32 v254, v19, v147
    v_fmac_f32 v254, v20, v148
    v_fmac_f32 v254, v21, v149
    v_mfma_f32_32x32x16_bf16 v[32:47], v[76:79], v[180:183], v[32:47]
    v_fmac_f32 v254, v22, v150
    v_fmac_f32 v254, v23, v151
    v_fma_f32 v202, v24, -v160, v202
    v_fma_f32 v202, v25, -v161, v202
    v_permlane32_swap_b32 v254, v200
    v_fma_f32 v202, v26, -v162, v202
    v_mfma_f32_32x32x16_bf16 v[0:15], v[80:83], v[184:187], v[0:15]
    v_fma_f32 v202, v27, -v163, v202
    v_fma_f32 v202, v28, -v164, v202
    v_fma_f32 v202, v29, -v165, v202
    v_fma_f32 v202, v30, -v166, v202
    v_fma_f32 v202, v31, -v167, v202
    v_add_f32 v200, v254, v200
    v_mfma_f32_32x32x16_bf16 v[32:47], v[84:87], v[184:187], v[32:47]
    s_waitcnt vmcnt(8)
    ds_read_b64_tr_b16 v[176:177], v244 offset:0
    ds_read_b64_tr_b16 v[178:179], v244 offset:1024
    ds_read_b64_tr_b16 v[180:181], v245 offset:0
    ds_read_b64_tr_b16 v[182:183], v245 offset:1024
    v_mul_f32_e64 v198, v64, -v112
    v_permlane32_swap_b32 v202, v254
    v_mfma_f32_32x32x8_bf16 v[0:15], v[88:89], v[188:189], v[0:15]
    v_fma_f32 v198, v65, -v113, v198
    v_fma_f32 v198, v66, -v114, v198
    v_fma_f32 v198, v67, -v115, v198
    v_fma_f32 v198, v68, -v116, v198
    v_fma_f32 v198, v69, -v117, v198
    v_fma_f32 v198, v70, -v118, v198
    v_mfma_f32_32x32x8_bf16 v[32:47], v[92:93], v[188:189], v[32:47]
    v_add_u32 v249, s48, v249
    v_add_u32 v250, s49, v250
    v_fma_f32 v198, v71, -v119, v198
    v_add_f32 v254, v202, v254
    v_mul_f32 v196, v56, v160
    v_fmac_f32 v196, v57, v161
    v_fmac_f32 v196, v58, v162
    v_fmac_f32 v196, v59, v163
    v_fmac_f32 v196, v60, v164
    v_fmac_f32 v196, v61, v165
    v_fmac_f32 v196, v62, v166
    v_fmac_f32 v196, v63, v167
    s_nop 1
    v_permlane32_swap_b32 v198, v196
    v_add_f32 v196, v198, v196
    v_mul_f32 v255, v0, v152
    v_fmac_f32 v255, v1, v153
    v_fmac_f32 v255, v2, v154
    v_fmac_f32 v255, v3, v155
    v_fmac_f32 v255, v4, v156
    v_fmac_f32 v255, v5, v157
    v_fmac_f32 v255, v6, v158
    v_fmac_f32 v255, v7, v159
    v_fma_f32 v203, v8, -v168, v203
    v_fma_f32 v203, v9, -v169, v203
    v_permlane32_swap_b32 v255, v201
    v_fma_f32 v203, v10, -v170, v203
    v_fma_f32 v203, v11, -v171, v203
    v_fma_f32 v203, v12, -v172, v203
    v_fma_f32 v203, v13, -v173, v203
    v_fma_f32 v203, v14, -v174, v203
    v_fma_f32 v203, v15, -v175, v203
    v_add_f32 v201, v255, v201
    v_mul_f32_e64 v199, v40, -v120
    v_permlane32_swap_b32 v203, v255
    v_fma_f32 v199, v41, -v121, v199
    v_fma_f32 v199, v42, -v122, v199
    v_fma_f32 v199, v43, -v123, v199
    s_waitcnt vmcnt(6)
    ds_read_b64_tr_b16 v[72:73], v249 offset:0
    ds_read_b64_tr_b16 v[76:77], v249 offset:64
    ds_read_b64_tr_b16 v[74:75], v249 offset:256
    ds_read_b64_tr_b16 v[78:79], v249 offset:320
    s_mov_b64 exec, s[54:55]
    ds_read_u16_d16_hi v242, v250 offset:0
    s_mov_b64 exec, -1
    v_fma_f32 v199, v44, -v124, v199
    v_fma_f32 v199, v45, -v125, v199
    v_fma_f32 v199, v46, -v126, v199
    v_fma_f32 v199, v47, -v127, v199
    v_add_f32 v255, v203, v255
    v_mul_f32 v197, v32, v168
    v_fmac_f32 v197, v33, v169
    v_fmac_f32 v197, v34, v170
    v_fmac_f32 v197, v35, v171
    v_fmac_f32 v197, v36, v172
    v_fmac_f32 v197, v37, v173
    v_fmac_f32 v197, v38, v174
    v_fmac_f32 v197, v39, v175
    s_nop 1
    v_permlane32_swap_b32 v199, v197
    v_add_f32 v197, v199, v197
    s_set_gpr_idx_on s51, gpr_idx(DST)
    s_nop 0
    v_cvt_pk_bf16_f32 v207, v200, v201
    v_cvt_pk_bf16_f32 v209, v254, v255
    v_cvt_pk_bf16_f32 v208, v196, v197
    s_set_gpr_idx_off
    s_add_u32 s50, s50, 1
    s_add_u32 s51, s51, 6
    s_cmp_ge_u32 s50, 4
    s_cbranch_scc1 LAST0
    s_add_u32 s53, s53, 4
    s_xor_b32 s66, s53, s20
    s_bitcmp1_b32 s66, 2
    s_setprio 1
    s_cbranch_scc1 PRIO_6
    s_setprio 0
PRIO_6:
    s_cmp_eq_u32 s52, 4
    s_cbranch_scc1 ITEM_0_4
    s_cmp_eq_u32 s52, 5
    s_cbranch_scc1 ITEM_0_5
    s_cmp_eq_u32 s52, 3
    s_cbranch_scc1 ITEM_0_3
    s_cmp_eq_u32 s52, 6
    s_cbranch_scc1 ITEM_0_6
    s_cmp_eq_u32 s52, 8
    s_cbranch_scc1 ITEM_0_8
    s_branch ITEM_0_2
.p2align 6
ITEM_0_3:
    s_mov_b64 exec, s[54:55]
    ds_read_u16_d16_hi v243, v250 offset:128
    s_mov_b64 exec, -1
    ds_read_b64_tr_b16 v[80:81], v249 offset:512
    ds_read_b64_tr_b16 v[84:85], v249 offset:576
    s_waitcnt lgkmcnt(3)
    v_mul_f32_dpp v196, v242, v72 row_newbcast:0 row_mask:0xf bank_mask:0xf
    v_mul_f32_dpp v197, v242, v73 row_newbcast:1 row_mask:0xf bank_mask:0xf
    v_mul_f32_dpp v198, v242, v72 row_newbcast:8 row_mask:0xf bank_mask:0xf
    v_mul_f32_dpp v199, v242, v73 row_newbcast:9 row_mask:0xf bank_mask:0xf
    v_mul_f32_dpp v200, v242, v76 row_newbcast:2 row_mask:0xf bank_mask:0xf
    v_mul_f32_dpp v201, v242, v77 row_newbcast:3 row_mask:0xf bank_mask:0xf
    v_mul_f32_dpp v202, v242, v76 row_newbcast:10 row_mask:0xf bank_mask:0xf
    v_mul_f32_dpp v203, v242, v77 row_newbcast:11 row_mask:0xf bank_mask:0xf
    v_cvt_pk_bf16_f32 v72, v196, v197
    v_cvt_pk_bf16_f32 v76, v198, v199
    v_cvt_pk_bf16_f32 v73, v200, v201
    v_cvt_pk_bf16_f32 v77, v202, v203
    v_mul_f32_dpp v196, v242, v74 row_newbcast:4 row_mask:0xf bank_mask:0xf
    v_mul_f32_dpp v197, v242, v75 row_newbcast:5 row_mask:0xf bank_mask:0xf
    v_mul_f32_dpp v198, v242, v74 row_newbcast:12 row_mask:0xf bank_mask:0xf
    v_mul_f32_dpp v199, v242, v75 row_newbcast:13 row_mask:0xf bank_mask:0xf
    v_mul_f32_dpp v200, v242, v78 row_newbcast:6 row_mask:0xf bank_mask:0xf
    v_mul_f32_dpp v201, v242, v79 row_newbcast:7 row_mask:0xf bank_mask:0xf
    v_mul_f32_dpp v202, v242, v78 row_newbcast:14 row_mask:0xf bank_mask:0xf
    v_mul_f32_dpp v203, v242, v79 row_newbcast:15 row_mask:0xf bank_mask:0xf
    v_cvt_pk_bf16_f32 v74, v196, v197
    v_cvt_pk_bf16_f32 v78, v198, v199
    v_cvt_pk_bf16_f32 v75, v200, v201
    v_cvt_pk_bf16_f32 v79, v202, v203
    s_waitcnt vmcnt(4) lgkmcnt(0)
    v_mfma_f32_32x32x16_bf16 v[56:71], v[72:75], v[176:179], 0
    v_mul_f32_dpp v196, v243, v80 row_newbcast:0 row_mask:0xf bank_mask:0xf
    v_mul_f32_dpp v197, v243, v81 row_newbcast:1 row_mask:0xf bank_mask:0xf
    v_mul_f32_dpp v198, v243, v80 row_newbcast:8 row_mask:0xf bank_mask:0xf
    v_mul_f32_dpp v199, v243, v81 row_newbcast:9 row_mask:0xf bank_mask:0xf
    v_mul_f32_dpp v200, v243, v84 row_newbcast:2 row_mask:0xf bank_mask:0xf
    v_mul_f32_dpp v201, v243, v85 row_newbcast:3 row_mask:0xf bank_mask:0xf
    s_add_u32 m0, s21, 0
    v_mfma_f32_32x32x16_bf16 v[16:31], v[76:79], v[176:179], 0
    buffer_load_dwordx4 v234, s[4:7], s36 offen  lds
    buffer_load_dwordx4 v235, s[8:11], s36 offen offset:1024  lds
    ds_read_b64_tr_b16 v[176:177], v244 offset:2048
    ds_read_b64_tr_b16 v[184:185], v245 offset:2048
    v_mul_f32_dpp v202, v243, v84 row_newbcast:10 row_mask:0xf bank_mask:0xf
    v_mul_f32_dpp v203, v243, v85 row_newbcast:11 row_mask:0xf bank_mask:0xf
    v_cvt_pk_bf16_f32 v80, v196, v197
    v_cvt_pk_bf16_f32 v84, v198, v199
    v_cvt_pk_bf16_f32 v81, v200, v201
    v_cvt_pk_bf16_f32 v85, v202, v203
    s_waitcnt lgkmcnt(0)
    v_mfma_f32_32x32x8_bf16 v[56:71], v[80:81], v[176:177], v[56:71]
    s_add_u32 m0, s21, 2048
    v_mfma_f32_32x32x8_bf16 v[16:31], v[84:85], v[176:177], v[16:31]
    buffer_load_dwordx4 v236, s[4:7], s36 offen  lds
    s_mov_b32 m0, s50
    s_nop 0
    s_movrels_b32 s71, s23
    s_bfe_u32 s46, s71, 0x30012
    s_mov_b32 m0, s46
    s_and_b32 s66, s71, 0x3ffff
    s_movrels_b32 s68, s57
    s_movrels_b32 s69, s61
    s_sub_u32 s48, s66, s47
    s_mov_b32 s47, s66
    s_lshr_b32 s52, s71, 28
    s_lshl_b32 s67, s46, 9
    s_add_u32 s66, s66, s67
    s_sub_u32 s49, s66, s42
    s_mov_b32 s42, s66
    s_bfe_u32 s66, s68, 655360
    s_add_u32 s43, s42, s66
    s_bfe_u32 s39, s69, 655360
    s_bfe_u32 s66, s68, 655370
    s_add_u32 s44, s42, s66
    s_bfe_u32 s40, s69, 655370
    s_bfe_u32 s66, s68, 655380
    s_add_u32 s45, s42, s66
    s_bfe_u32 s41, s69, 655380
    s_and_b32 s66, s46, s33
    s_cselect_b32 s72, -1, 1
    s_cselect_b32 s76, s47, 163712
    s_cmp_ge_u32 s66, 2
    s_cselect_b32 s73, -1, 0
    s_add_u32 s77, s47, 1024
    s_cmp_ge_u32 s66, 4
    s_cselect_b32 s75, -1, 0
    s_cmp_ge_u32 s66, 3
    s_cselect_b32 s74, -1, 1
    s_cselect_b32 s77, s77, 163712
    v_add_u32 v252, s44, v247
    ds_read2_b32 v[238:239], v252 offset0:0 offset1:16
    v_add_u32 v252, s45, v247
    ds_read2_b32 v[240:241], v252 offset0:0 offset1:16
    v_mfma_f32_32x32x16_bf16 v[32:47], v[72:75], v[180:183], 0
    v_mul_f32 v196, v56, v96
    v_fmac_f32 v196, v57, v97
    v_fmac_f32 v196, v58, v98
    v_fmac_f32 v196, v59, v99
    v_fmac_f32 v196, v60, v100
    v_fmac_f32 v196, v61, v101
    v_mfma_f32_32x32x16_bf16 v[0:15], v[76:79], v[180:183], 0
    s_waitcnt vmcnt(5)
    ds_read_b64_tr_b16 v[176:177], v244 offset:4096
    ds_read_b64_tr_b16 v[178:179], v244 offset:5120
    ds_read_b64_tr_b16 v[180:181], v245 offset:4096
    ds_read_b64_tr_b16 v[182:183], v245 offset:5120
    v_fmac_f32 v196, v62, v102
    v_fmac_f32 v196, v63, v103
    v_mfma_f32_32x32x8_bf16 v[32:47], v[80:81], v[184:185], v[32:47]
    v_mul_f32 v198, v64, v128
    v_fmac_f32 v198, v65, v129
    v_fmac_f32 v198, v66, v130
    v_fmac_f32 v198, v67, v131
    v_fmac_f32 v198, v68, v132
    v_fmac_f32 v198, v69, v133
    v_mfma_f32_32x32x8_bf16 v[0:15], v[84:85], v[184:185], v[0:15]
    v_fmac_f32 v198, v70, v134
    v_fmac_f32 v198, v71, v135
    v_mul_f32 v200, v16, v128
    v_fmac_f32 v200, v17, v129
    v_permlane32_swap_b32 v196, v198
    v_fmac_f32 v200, v18, v130
    v_fmac_f32 v200, v19, v131
    v_fmac_f32 v200, v20, v132
    v_fmac_f32 v200, v21, v133
    v_fmac_f32 v200, v22, v134
    v_fmac_f32 v200, v23, v135
    v_add_f32 v198, v196, v198
    v_mul_f32_e64 v202, v24, -v128
    v_fma_f32 v202, v25, -v129, v202
    v_fma_f32 v202, v26, -v130, v202
    v_fma_f32 v202, v27, -v131, v202
    v_fma_f32 v202, v28, -v132, v202
    v_fma_f32 v202, v29, -v133, v202
    v_fma_f32 v202, v30, -v134, v202
    v_fma_f32 v202, v31, -v135, v202
    s_nop 1
    v_permlane32_swap_b32 v200, v202
    v_add_f32 v202, v200, v202
    s_waitcnt vmcnt(3) lgkmcnt(0)
    v_mfma_f32_32x32x16_bf16 v[56:71], v[72:75], v[176:179], 0
    v_mul_f32 v197, v32, v104
    v_fmac_f32 v197, v33, v105
    v_fmac_f32 v197, v34, v106
    v_fmac_f32 v197, v35, v107
    v_fmac_f32 v197, v36, v108
    v_fmac_f32 v197, v37, v109
    s_add_u32 m0, s21, 4096
    v_mfma_f32_32x32x16_bf16 v[16:31], v[76:79], v[176:179], 0
    buffer_load_dwordx4 v234, s[4:7], s37 offen  lds
    buffer_load_dwordx4 v235, s[8:11], s37 offen offset:1024  lds
    ds_read_b64_tr_b16 v[176:177], v244 offset:6144
    ds_read_b64_tr_b16 v[184:185], v245 offset:6144
    v_add_u32 v252, s42, v247
    ds_read2_b32 v[234:235], v252 offset0:0 offset1:16
    v_fmac_f32 v197, v38, v110
    v_fmac_f32 v197, v39, v111
    v_mul_f32 v199, v40, v136
    v_fmac_f32 v199, v41, v137
    v_fmac_f32 v199, v42, v138
    v_fmac_f32 v199, v43, v139
    v_fmac_f32 v199, v44, v140
    v_fmac_f32 v199, v45, v141
    v_fmac_f32 v199, v46, v142
    v_fmac_f32 v199, v47, v143
    v_mul_f32 v201, v0, v136
    v_fmac_f32 v201, v1, v137
    v_permlane32_swap_b32 v197, v199
    v_fmac_f32 v201, v2, v138
    v_fmac_f32 v201, v3, v139
    v_fmac_f32 v201, v4, v140
    v_fmac_f32 v201, v5, v141
    v_fmac_f32 v201, v6, v142
    v_fmac_f32 v201, v7, v143
    v_add_f32 v199, v197, v199
    v_mul_f32_e64 v203, v8, -v136
    v_fma_f32 v203, v9, -v137, v203
    v_fma_f32 v203, v10, -v138, v203
    s_waitcnt lgkmcnt(1)
    v_mfma_f32_32x32x8_bf16 v[56:71], v[80:81], v[176:177], v[56:71]
    v_fma_f32 v203, v11, -v139, v203
    v_fma_f32 v203, v12, -v140, v203
    v_fma_f32 v203, v13, -v141, v203
    v_fma_f32 v203, v14, -v142, v203
    v_fma_f32 v203, v15, -v143, v203
    s_nop 1
    v_permlane32_swap_b32 v201, v203
    s_add_u32 m0, s21, 6144
    v_mfma_f32_32x32x8_bf16 v[16:31], v[84:85], v[176:177], v[16:31]
    buffer_load_dwordx4 v236, s[4:7], s37 offen  lds
    v_add_u32 v252, s43, v247
    ds_read2_b32 v[236:237], v252 offset0:0 offset1:16
    v_add_f32 v203, v201, v203
    s_set_gpr_idx_on s51, gpr_idx(DST)
    s_nop 0
    v_cvt_pk_bf16_f32 v204, v198, v199
    v_cvt_pk_bf16_f32 v205, v202, v203
    s_set_gpr_idx_off
    v_mfma_f32_32x32x16_bf16 v[32:47], v[72:75], v[180:183], 0
    v_mul_f32 v196, v56, v144
    v_fmac_f32 v196, v57, v145
    v_fmac_f32 v196, v58, v146
    v_fmac_f32 v196, v59, v147
    v_fmac_f32 v196, v60, v148
    v_fmac_f32 v196, v61, v149
    v_mfma_f32_32x32x16_bf16 v[0:15], v[76:79], v[180:183], 0
    s_waitcnt vmcnt(4)
    ds_read_b64_tr_b16 v[176:177], v244 offset:0
    ds_read_b64_tr_b16 v[178:179], v244 offset:1024
    ds_read_b64_tr_b16 v[180:181], v245 offset:0
    ds_read_b64_tr_b16 v[182:183], v245 offset:1024
    v_fmac_f32 v196, v62, v150
    v_fmac_f32 v196, v63, v151
    v_mfma_f32_32x32x8_bf16 v[32:47], v[80:81], v[184:185], v[32:47]
    v_mul_f32_e64 v200, v16, -v160
    v_fma_f32 v200, v17, -v161, v200
    v_fma_f32 v200, v18, -v162, v200
    v_fma_f32 v200, v19, -v163, v200
    v_fma_f32 v200, v20, -v164, v200
    v_fma_f32 v200, v21, -v165, v200
    v_mfma_f32_32x32x8_bf16 v[0:15], v[84:85], v[184:185], v[0:15]
    v_fma_f32 v200, v22, -v166, v200
    v_fma_f32 v200, v23, -v167, v200
    v_mul_f32_e64 v202, v24, -v160
    v_fma_f32 v202, v25, -v161, v202
    v_fma_f32 v202, v26, -v162, v202
    v_fma_f32 v202, v27, -v163, v202
    v_fma_f32 v202, v28, -v164, v202
    v_fma_f32 v202, v29, -v165, v202
    v_fma_f32 v202, v30, -v166, v202
    v_fma_f32 v202, v31, -v167, v202
    s_waitcnt vmcnt(3) lgkmcnt(0)
    v_mfma_f32_32x32x16_bf16 v[16:31], v[72:75], v[176:179], 0
    v_mul_f32 v197, v32, v152
    v_fmac_f32 v197, v33, v153
    v_fmac_f32 v197, v34, v154
    v_fmac_f32 v197, v35, v155
    v_fmac_f32 v197, v36, v156
    v_fmac_f32 v197, v37, v157
    s_add_u32 m0, s21, 0
    v_mfma_f32_32x32x16_bf16 v[48:63], v[76:79], v[176:179], 0
    v_mad_u32_u16 v234, v234, s3, v246 op_sel:[1,0,0,0]
    v_mad_u32_u16 v235, v235, s3, v246 op_sel:[1,0,0,0]
    buffer_load_dwordx4 v234, s[4:7], s38 offen  lds
    buffer_load_dwordx4 v235, s[8:11], s38 offen offset:1024  lds
    ds_read_b64_tr_b16 v[176:177], v244 offset:2048
    ds_read_b64_tr_b16 v[184:185], v245 offset:2048
    v_fmac_f32 v197, v38, v158
    v_fmac_f32 v197, v39, v159
    v_mul_f32_e64 v201, v0, -v168
    v_fma_f32 v201, v1, -v169, v201
    v_fma_f32 v201, v2, -v170, v201
    v_fma_f32 v201, v3, -v171, v201
    v_fma_f32 v201, v4, -v172, v201
    v_fma_f32 v201, v5, -v173, v201
    v_fma_f32 v201, v6, -v174, v201
    v_fma_f32 v201, v7, -v175, v201
    s_waitcnt lgkmcnt(0)
    v_mfma_f32_32x32x8_bf16 v[16:31], v[80:81], v[176:177], v[16:31]
    v_mul_f32_e64 v203, v8, -v168
    v_fma_f32 v203, v9, -v169, v203
    v_fma_f32 v203, v10, -v170, v203
    v_fma_f32 v203, v11, -v171, v203
    v_fma_f32 v203, v12, -v172, v203
    v_fma_f32 v203, v13, -v173, v203
    s_add_u32 m0, s21, 2048
    v_mfma_f32_32x32x8_bf16 v[48:63], v[84:85], v[176:177], v[48:63]
    v_mad_u32_u16 v236, v236, s3, v246 op_sel:[1,0,0,0]
    v_mad_u32_u16 v237, v237, s3, v246 op_sel:[1,0,0,0]
    buffer_load_dwordx4 v236, s[4:7], s39 offen  lds
    buffer_load_dwordx4 v237, s[8:11], s39 offen offset:1024  lds
    v_fma_f32 v203, v14, -v174, v203
    v_fma_f32 v203, v15, -v175, v203
    v_mfma_f32_32x32x16_bf16 v[0:15], v[72:75], v[180:183], 0
    v_fmac_f32 v200, v24, v160
    v_fmac_f32 v200, v25, v161
    v_fmac_f32 v200, v26, v162
    v_fmac_f32 v200, v27, v163
    v_fmac_f32 v200, v28, v164
    v_fmac_f32 v200, v29, v165
    v_fmac_f32 v200, v30, v166
    v_fmac_f32 v200, v31, v167
    v_mfma_f32_32x32x16_bf16 v[24:39], v[76:79], v[180:183], 0
    v_add_u32 v253, s47, v248
    ds_read_b32 v192, v253
    ds_read_b32 v193, v253 offset:256
    s_waitcnt vmcnt(5)
    ds_read_b64_tr_b16 v[176:177], v244 offset:4096
    ds_read_b64_tr_b16 v[178:179], v244 offset:5120
    ds_read_b64_tr_b16 v[180:181], v245 offset:4096
    ds_read_b64_tr_b16 v[182:183], v245 offset:5120
    v_mfma_f32_32x32x8_bf16 v[24:39], v[84:85], v[184:185], v[24:39]
    v_mul_f32 v254, v16, v144
    v_fmac_f32 v254, v17, v145
    v_fmac_f32 v254, v18, v146
    v_fmac_f32 v254, v19, v147
    v_fmac_f32 v254, v20, v148
    v_fmac_f32 v254, v21, v149
    v_mfma_f32_32x32x8_bf16 v[0:15], v[80:81], v[184:185], v[0:15]
    v_fmac_f32 v254, v22, v150
    v_fmac_f32 v254, v23, v151
    v_sub_f32_e64 v64, -v48, v64
    v_sub_f32_e64 v65, -v49, v65
    v_permlane32_swap_b32 v196, v254
    v_sub_f32_e64 v66, -v50, v66
    v_sub_f32_e64 v67, -v51, v67
    v_sub_f32_e64 v68, -v52, v68
    v_sub_f32_e64 v69, -v53, v69
    v_sub_f32_e64 v70, -v54, v70
    v_sub_f32_e64 v71, -v55, v71
    v_add_f32 v254, v196, v254
    s_waitcnt vmcnt(4) lgkmcnt(0)
    v_mfma_f32_32x32x16_bf16 v[56:71], v[76:79], v[176:179], v[56:71]
    v_sub_f32_e64 v40, -v24, v40
    v_sub_f32_e64 v41, -v25, v41
    v_sub_f32_e64 v42, -v26, v42
    v_sub_f32_e64 v43, -v27, v43
    v_sub_f32_e64 v44, -v28, v44
    v_sub_f32_e64 v45, -v29, v45
    v_sub_f32_e64 v46, -v30, v46
    v_sub_f32_e64 v47, -v31, v47
    s_mov_b32 m0, s76
    s_mov_b64 exec, s[72:73]
    buffer_load_dwordx4 v192, s[12:15], 0 offen  lds
    s_mov_b32 m0, s77
    s_mov_b64 exec, s[74:75]
    buffer_load_dwordx4 v193, s[12:15], 0 offen  lds
    s_mov_b64 exec, -1
    s_add_u32 m0, s21, 4096
    v_mfma_f32_32x32x16_bf16 v[16:31], v[72:75], v[176:179], 0
    v_mad_u32_u16 v238, v238, s3, v246 op_sel:[1,0,0,0]
    v_mad_u32_u16 v239, v239, s3, v246 op_sel:[1,0,0,0]
    buffer_load_dwordx4 v238, s[4:7], s40 offen  lds
    buffer_load_dwordx4 v239, s[8:11], s40 offen offset:1024  lds
    ds_read_b64_tr_b16 v[176:177], v244 offset:6144
    ds_read_b64_tr_b16 v[184:185], v245 offset:6144
    v_mul_f32 v255, v0, v152
    v_fmac_f32 v255, v1, v153
    v_fmac_f32 v255, v2, v154
    v_fmac_f32 v255, v3, v155
    v_fmac_f32 v255, v4, v156
    v_fmac_f32 v255, v5, v157
    v_fmac_f32 v255, v6, v158
    v_fmac_f32 v255, v7, v159
    v_fmac_f32 v201, v8, v168
    v_fmac_f32 v201, v9, v169
    v_permlane32_swap_b32 v197, v255
    s_waitcnt lgkmcnt(0)
    v_mfma_f32_32x32x8_bf16 v[16:31], v[80:81], v[176:177], v[16:31]
    v_fmac_f32 v201, v10, v170
    v_fmac_f32 v201, v11, v171
    v_fmac_f32 v201, v12, v172
    v_fmac_f32 v201, v13, v173
    v_fmac_f32 v201, v14, v174
    v_fmac_f32 v201, v15, v175
    s_add_u32 m0, s21, 6144
    v_mfma_f32_32x32x8_bf16 v[56:71], v[84:85], v[176:177], v[56:71]
    v_mad_u32_u16 v240, v240, s3, v246 op_sel:[1,0,0,0]
    v_mad_u32_u16 v241, v241, s3, v246 op_sel:[1,0,0,0]
    buffer_load_dwordx4 v240, s[4:7], s41 offen  lds
    buffer_load_dwordx4 v241, s[8:11], s41 offen offset:1024  lds
    v_add_f32 v255, v197, v255
    s_set_gpr_idx_on s51, gpr_idx(DST)
    s_nop 0
    v_cvt_pk_bf16_f32 v206, v254, v255
    s_set_gpr_idx_off
    v_mfma_f32_32x32x16_bf16 v[0:15], v[72:75], v[180:183], 0
    v_mul_f32 v254, v16, v144
    v_fmac_f32 v254, v17, v145
    v_fmac_f32 v254, v18, v146
    v_fmac_f32 v254, v19, v147
    v_fmac_f32 v254, v20, v148
    v_fmac_f32 v254, v21, v149
    v_mfma_f32_32x32x16_bf16 v[32:47], v[76:79], v[180:183], v[32:47]
    s_waitcnt vmcnt(8)
    ds_read_b64_tr_b16 v[176:177], v244 offset:0
    ds_read_b64_tr_b16 v[178:179], v244 offset:1024
    ds_read_b64_tr_b16 v[180:181], v245 offset:0
    ds_read_b64_tr_b16 v[182:183], v245 offset:1024
    v_fmac_f32 v254, v22, v150
    v_fmac_f32 v254, v23, v151
    v_mfma_f32_32x32x8_bf16 v[0:15], v[80:81], v[184:185], v[0:15]
    v_fma_f32 v202, v24, -v160, v202
    v_fma_f32 v202, v25, -v161, v202
    v_permlane32_swap_b32 v254, v200
    v_fma_f32 v202, v26, -v162, v202
    v_fma_f32 v202, v27, -v163, v202
    v_fma_f32 v202, v28, -v164, v202
    v_mfma_f32_32x32x8_bf16 v[32:47], v[84:85], v[184:185], v[32:47]
    v_add_u32 v249, s48, v249
    v_add_u32 v250, s49, v250
    v_fma_f32 v202, v29, -v165, v202
    v_fma_f32 v202, v30, -v166, v202
    v_fma_f32 v202, v31, -v167, v202
    v_add_f32 v200, v254, v200
    v_mul_f32_e64 v198, v64, -v112
    v_permlane32_swap_b32 v202, v254
    v_fma_f32 v198, v65, -v113, v198
    v_fma_f32 v198, v66, -v114, v198
    v_fma_f32 v198, v67, -v115, v198
    v_fma_f32 v198, v68, -v116, v198
    v_fma_f32 v198, v69, -v117, v198
    v_fma_f32 v198, v70, -v118, v198
    v_fma_f32 v198, v71, -v119, v198
    v_add_f32 v254, v202, v254
    v_mul_f32 v196, v56, v160
    v_fmac_f32 v196, v57, v161
    v_fmac_f32 v196, v58, v162
    v_fmac_f32 v196, v59, v163
    v_fmac_f32 v196, v60, v164
    v_fmac_f32 v196, v61, v165
    v_fmac_f32 v196, v62, v166
    v_fmac_f32 v196, v63, v167
    s_nop 1
    v_permlane32_swap_b32 v198, v196
    v_add_f32 v196, v198, v196
    v_mul_f32 v255, v0, v152
    v_fmac_f32 v255, v1, v153
    v_fmac_f32 v255, v2, v154
    v_fmac_f32 v255, v3, v155
    v_fmac_f32 v255, v4, v156
    v_fmac_f32 v255, v5, v157
    v_fmac_f32 v255, v6, v158
    v_fmac_f32 v255, v7, v159
    v_fma_f32 v203, v8, -v168, v203
    v_fma_f32 v203, v9, -v169, v203
    v_permlane32_swap_b32 v255, v201
    v_fma_f32 v203, v10, -v170, v203
    v_fma_f32 v203, v11, -v171, v203
    v_fma_f32 v203, v12, -v172, v203
    v_fma_f32 v203, v13, -v173, v203
    v_fma_f32 v203, v14, -v174, v203
    v_fma_f32 v203, v15, -v175, v203
    v_add_f32 v201, v255, v201
    v_mul_f32_e64 v199, v40, -v120
    v_permlane32_swap_b32 v203, v255
    v_fma_f32 v199, v41, -v121, v199
    v_fma_f32 v199, v42, -v122, v199
    v_fma_f32 v199, v43, -v123, v199
    s_waitcnt vmcnt(4)
    ds_read_b64_tr_b16 v[72:73], v249 offset:0
    ds_read_b64_tr_b16 v[76:77], v249 offset:64
    ds_read_b64_tr_b16 v[74:75], v249 offset:256
    ds_read_b64_tr_b16 v[78:79], v249 offset:320
    s_mov_b64 exec, s[54:55]
    ds_read_u16_d16_hi v242, v250 offset:0
    s_mov_b64 exec, -1
    v_fma_f32 v199, v44, -v124, v199
    v_fma_f32 v199, v45, -v125, v199
    v_fma_f32 v199, v46, -v126, v199
    v_fma_f32 v199, v47, -v127, v199
    v_add_f32 v255, v203, v255
    v_mul_f32 v197, v32, v168
    v_fmac_f32 v197, v33, v169
    v_fmac_f32 v197, v34, v170
    v_fmac_f32 v197, v35, v171
    v_fmac_f32 v197, v36, v172
    v_fmac_f32 v197, v37, v173
    v_fmac_f32 v197, v38, v174
    v_fmac_f32 v197, v39, v175
    s_nop 1
    v_permlane32_swap_b32 v199, v197
    v_add_f32 v197, v199, v197
    s_set_gpr_idx_on s51, gpr_idx(DST)
    s_nop 0
    v_cvt_pk_bf16_f32 v207, v200, v201
    v_cvt_pk_bf16_f32 v209, v254, v255
    v_cvt_pk_bf16_f32 v208, v196, v197
    s_set_gpr_idx_off
    s_add_u32 s50, s50, 1
    s_add_u32 s51, s51, 6
    s_cmp_ge_u32 s50, 4
    s_cbranch_scc1 LAST0
    s_add_u32 s53, s53, 4
    s_xor_b32 s66, s53, s20
    s_bitcmp1_b32 s66, 2
    s_setprio 1
    s_cbranch_scc1 PRIO_7
    s_setprio 0
PRIO_7:
    s_cmp_eq_u32 s52, 4
    s_cbranch_scc1 ITEM_0_4
    s_cmp_eq_u32 s52, 5
    s_cbranch_scc1 ITEM_0_5
    s_cmp_eq_u32 s52, 3
    s_cbranch_scc1 ITEM_0_3
    s_cmp_eq_u32 s52, 6
    s_cbranch_scc1 ITEM_0_6
    s_cmp_eq_u32 s52, 8
    s_cbranch_scc1 ITEM_0_8
    s_branch ITEM_0_2
.p2align 6
ITEM_0_6:
    s_mov_b64 exec, s[54:55]
    ds_read_u16_d16_hi v243, v250 offset:128
    s_mov_b64 exec, -1
    ds_read_b64_tr_b16 v[80:81], v249 offset:512
    ds_read_b64_tr_b16 v[84:85], v249 offset:576
    ds_read_b64_tr_b16 v[82:83], v249 offset:768
    ds_read_b64_tr_b16 v[86:87], v249 offset:832
    ds_read_b64_tr_b16 v[88:89], v249 offset:1024
    ds_read_b64_tr_b16 v[92:93], v249 offset:1088
    ds_read_b64_tr_b16 v[90:91], v249 offset:1280
    ds_read_b64_tr_b16 v[94:95], v249 offset:1344
    s_waitcnt lgkmcnt(9)
    v_mul_f32_dpp v196, v242, v72 row_newbcast:0 row_mask:0xf bank_mask:0xf
    v_mul_f32_dpp v197, v242, v73 row_newbcast:1 row_mask:0xf bank_mask:0xf
    v_mul_f32_dpp v198, v242, v72 row_newbcast:8 row_mask:0xf bank_mask:0xf
    v_mul_f32_dpp v199, v242, v73 row_newbcast:9 row_mask:0xf bank_mask:0xf
    v_mul_f32_dpp v200, v242, v76 row_newbcast:2 row_mask:0xf bank_mask:0xf
    v_mul_f32_dpp v201, v242, v77 row_newbcast:3 row_mask:0xf bank_mask:0xf
    v_mul_f32_dpp v202, v242, v76 row_newbcast:10 row_mask:0xf bank_mask:0xf
    v_mul_f32_dpp v203, v242, v77 row_newbcast:11 row_mask:0xf bank_mask:0xf
    v_cvt_pk_bf16_f32 v72, v196, v197
    v_cvt_pk_bf16_f32 v76, v198, v199
    v_cvt_pk_bf16_f32 v73, v200, v201
    v_cvt_pk_bf16_f32 v77, v202, v203
    v_mul_f32_dpp v196, v242, v74 row_newbcast:4 row_mask:0xf bank_mask:0xf
    v_mul_f32_dpp v197, v242, v75 row_newbcast:5 row_mask:0xf bank_mask:0xf
    v_mul_f32_dpp v198, v242, v74 row_newbcast:12 row_mask:0xf bank_mask:0xf
    v_mul_f32_dpp v199, v242, v75 row_newbcast:13 row_mask:0xf bank_mask:0xf
    v_mul_f32_dpp v200, v242, v78 row_newbcast:6 row_mask:0xf bank_mask:0xf
    v_mul_f32_dpp v201, v242, v79 row_newbcast:7 row_mask:0xf bank_mask:0xf
    v_mul_f32_dpp v202, v242, v78 row_newbcast:14 row_mask:0xf bank_mask:0xf
    v_mul_f32_dpp v203, v242, v79 row_newbcast:15 row_mask:0xf bank_mask:0xf
    v_cvt_pk_bf16_f32 v74, v196, v197
    v_cvt_pk_bf16_f32 v78, v198, v199
    v_cvt_pk_bf16_f32 v75, v200, v201
    v_cvt_pk_bf16_f32 v79, v202, v203
    s_mov_b64 exec, s[54:55]
    ds_read_u16_d16_hi v242, v250 offset:256
    s_mov_b64 exec, -1
    s_waitcnt vmcnt(4) lgkmcnt(5)
    v_mfma_f32_32x32x16_bf16 v[56:71], v[72:75], v[176:179], 0
    v_mul_f32_dpp v196, v243, v80 row_newbcast:0 row_mask:0xf bank_mask:0xf
    v_mul_f32_dpp v197, v243, v81 row_newbcast:1 row_mask:0xf bank_mask:0xf
    v_mul_f32_dpp v198, v243, v80 row_newbcast:8 row_mask:0xf bank_mask:0xf
    v_mul_f32_dpp v199, v243, v81 row_newbcast:9 row_mask:0xf bank_mask:0xf
    v_mul_f32_dpp v200, v243, v84 row_newbcast:2 row_mask:0xf bank_mask:0xf
    v_mul_f32_dpp v201, v243, v85 row_newbcast:3 row_mask:0xf bank_mask:0xf
    s_add_u32 m0, s21, 0
    v_mfma_f32_32x32x16_bf16 v[16:31], v[76:79], v[176:179], 0
    buffer_load_dwordx4 v236, s[4:7], s35 offen  lds
    buffer_load_dwordx4 v237, s[8:11], s35 offen offset:1024  lds
    ds_read_b64_tr_b16 v[176:177], v244 offset:2048
    ds_read_b64_tr_b16 v[178:179], v244 offset:3072
    ds_read_b64_tr_b16 v[184:185], v245 offset:2048
    ds_read_b64_tr_b16 v[186:187], v245 offset:3072
    v_mul_f32_dpp v202, v243, v84 row_newbcast:10 row_mask:0xf bank_mask:0xf
    v_mul_f32_dpp v203, v243, v85 row_newbcast:11 row_mask:0xf bank_mask:0xf
    v_cvt_pk_bf16_f32 v80, v196, v197
    v_cvt_pk_bf16_f32 v84, v198, v199
    v_cvt_pk_bf16_f32 v81, v200, v201
    v_cvt_pk_bf16_f32 v85, v202, v203
    v_mul_f32_dpp v196, v243, v82 row_newbcast:4 row_mask:0xf bank_mask:0xf
    v_mul_f32_dpp v197, v243, v83 row_newbcast:5 row_mask:0xf bank_mask:0xf
    v_mul_f32_dpp v198, v243, v82 row_newbcast:12 row_mask:0xf bank_mask:0xf
    v_mul_f32_dpp v199, v243, v83 row_newbcast:13 row_mask:0xf bank_mask:0xf
    v_mul_f32_dpp v200, v243, v86 row_newbcast:6 row_mask:0xf bank_mask:0xf
    v_mul_f32_dpp v201, v243, v87 row_newbcast:7 row_mask:0xf bank_mask:0xf
    v_mul_f32_dpp v202, v243, v86 row_newbcast:14 row_mask:0xf bank_mask:0xf
    v_mul_f32_dpp v203, v243, v87 row_newbcast:15 row_mask:0xf bank_mask:0xf
    v_cvt_pk_bf16_f32 v82, v196, v197
    v_cvt_pk_bf16_f32 v86, v198, v199
    v_cvt_pk_bf16_f32 v83, v200, v201
    v_cvt_pk_bf16_f32 v87, v202, v203
    s_waitcnt vmcnt(4) lgkmcnt(0)
    v_mfma_f32_32x32x16_bf16 v[56:71], v[80:83], v[176:179], v[56:71]
    v_mul_f32_dpp v196, v242, v88 row_newbcast:0 row_mask:0xf bank_mask:0xf
    v_mul_f32_dpp v197, v242, v89 row_newbcast:1 row_mask:0xf bank_mask:0xf
    v_mul_f32_dpp v198, v242, v88 row_newbcast:8 row_mask:0xf bank_mask:0xf
    v_mul_f32_dpp v199, v242, v89 row_newbcast:9 row_mask:0xf bank_mask:0xf
    v_mul_f32_dpp v200, v242, v92 row_newbcast:2 row_mask:0xf bank_mask:0xf
    v_mul_f32_dpp v201, v242, v93 row_newbcast:3 row_mask:0xf bank_mask:0xf
    s_add_u32 m0, s21, 2048
    v_mfma_f32_32x32x16_bf16 v[16:31], v[84:87], v[176:179], v[16:31]
    buffer_load_dwordx4 v238, s[4:7], s35 offen  lds
    buffer_load_dwordx4 v239, s[8:11], s35 offen offset:1024  lds
    ds_read_b64_tr_b16 v[176:177], v244 offset:4096
    ds_read_b64_tr_b16 v[178:179], v244 offset:5120
    ds_read_b64_tr_b16 v[188:189], v245 offset:4096
    ds_read_b64_tr_b16 v[190:191], v245 offset:5120
    v_mul_f32_dpp v202, v242, v92 row_newbcast:10 row_mask:0xf bank_mask:0xf
    v_mul_f32_dpp v203, v242, v93 row_newbcast:11 row_mask:0xf bank_mask:0xf
    v_cvt_pk_bf16_f32 v88, v196, v197
    v_cvt_pk_bf16_f32 v92, v198, v199
    v_cvt_pk_bf16_f32 v89, v200, v201
    v_cvt_pk_bf16_f32 v93, v202, v203
    v_mul_f32_dpp v196, v242, v90 row_newbcast:4 row_mask:0xf bank_mask:0xf
    v_mul_f32_dpp v197, v242, v91 row_newbcast:5 row_mask:0xf bank_mask:0xf
    v_mul_f32_dpp v198, v242, v90 row_newbcast:12 row_mask:0xf bank_mask:0xf
    v_mul_f32_dpp v199, v242, v91 row_newbcast:13 row_mask:0xf bank_mask:0xf
    v_mul_f32_dpp v200, v242, v94 row_newbcast:6 row_mask:0xf bank_mask:0xf
    v_mul_f32_dpp v201, v242, v95 row_newbcast:7 row_mask:0xf bank_mask:0xf
    v_mul_f32_dpp v202, v242, v94 row_newbcast:14 row_mask:0xf bank_mask:0xf
    v_mul_f32_dpp v203, v242, v95 row_newbcast:15 row_mask:0xf bank_mask:0xf
    v_cvt_pk_bf16_f32 v90, v196, v197
    v_cvt_pk_bf16_f32 v94, v198, v199
    v_cvt_pk_bf16_f32 v91, v200, v201
    v_cvt_pk_bf16_f32 v95, v202, v203
    s_waitcnt lgkmcnt(0)
    v_mfma_f32_32x32x16_bf16 v[56:71], v[88:91], v[176:179], v[56:71]
    s_add_u32 m0, s21, 4096
    v_mfma_f32_32x32x16_bf16 v[16:31], v[92:95], v[176:179], v[16:31]
    buffer_load_dwordx4 v234, s[4:7], s36 offen  lds
    buffer_load_dwordx4 v235, s[8:11], s36 offen offset:1024  lds
    s_mov_b32 m0, s50
    s_nop 0
    s_movrels_b32 s71, s23
    s_bfe_u32 s46, s71, 0x30012
    s_mov_b32 m0, s46
    s_and_b32 s66, s71, 0x3ffff
    s_movrels_b32 s68, s57
    s_movrels_b32 s69, s61
    s_sub_u32 s48, s66, s47
    s_mov_b32 s47, s66
    s_lshr_b32 s52, s71, 28
    s_lshl_b32 s67, s46, 9
    s_add_u32 s66, s66, s67
    s_sub_u32 s49, s66, s42
    s_mov_b32 s42, s66
    s_bfe_u32 s66, s68, 655360
    s_add_u32 s43, s42, s66
    s_bfe_u32 s39, s69, 655360
    s_bfe_u32 s66, s68, 655370
    s_add_u32 s44, s42, s66
    s_bfe_u32 s40, s69, 655370
    s_bfe_u32 s66, s68, 655380
    s_add_u32 s45, s42, s66
    s_bfe_u32 s41, s69, 655380
    s_and_b32 s66, s46, s33
    s_cselect_b32 s72, -1, 1
    s_cselect_b32 s76, s47, 163712
    s_cmp_ge_u32 s66, 2
    s_cselect_b32 s73, -1, 0
    s_add_u32 s77, s47, 1024
    s_cmp_ge_u32 s66, 4
    s_cselect_b32 s75, -1, 0
    s_cmp_ge_u32 s66, 3
    s_cselect_b32 s74, -1, 1
    s_cselect_b32 s77, s77, 163712
    v_add_u32 v252, s45, v247
    ds_read2_b32 v[240:241], v252 offset0:0 offset1:16
    v_mfma_f32_32x32x16_bf16 v[32:47], v[72:75], v[180:183], 0
    v_mul_f32 v196, v56, v96
    v_fmac_f32 v196, v57, v97
    v_fmac_f32 v196, v58, v98
    v_fmac_f32 v196, v59, v99
    v_fmac_f32 v196, v60, v100
    v_fmac_f32 v196, v61, v101
    v_mfma_f32_32x32x16_bf16 v[0:15], v[76:79], v[180:183], 0
    v_fmac_f32 v196, v62, v102
    v_fmac_f32 v196, v63, v103
    v_mul_f32 v198, v64, v128
    v_fmac_f32 v198, v65, v129
    v_fmac_f32 v198, v66, v130
    v_fmac_f32 v198, v67, v131
    v_mfma_f32_32x32x16_bf16 v[32:47], v[80:83], v[184:187], v[32:47]
    v_fmac_f32 v198, v68, v132
    v_fmac_f32 v198, v69, v133
    v_fmac_f32 v198, v70, v134
    v_fmac_f32 v198, v71, v135
    v_mul_f32 v200, v16, v128
    v_fmac_f32 v200, v17, v129
    v_mfma_f32_32x32x16_bf16 v[0:15], v[84:87], v[184:187], v[0:15]
    s_waitcnt vmcnt(6)
    ds_read_b64_tr_b16 v[176:177], v244 offset:6144
    ds_read_b64_tr_b16 v[178:179], v244 offset:7168
    ds_read_b64_tr_b16 v[180:181], v245 offset:6144
    ds_read_b64_tr_b16 v[182:183], v245 offset:7168
    v_permlane32_swap_b32 v196, v198
    v_fmac_f32 v200, v18, v130
    v_mfma_f32_32x32x16_bf16 v[32:47], v[88:91], v[188:191], v[32:47]
    v_fmac_f32 v200, v19, v131
    v_fmac_f32 v200, v20, v132
    v_fmac_f32 v200, v21, v133
    v_fmac_f32 v200, v22, v134
    v_fmac_f32 v200, v23, v135
    v_add_f32 v198, v196, v198
    v_mfma_f32_32x32x16_bf16 v[0:15], v[92:95], v[188:191], v[0:15]
    v_mul_f32_e64 v202, v24, -v128
    v_fma_f32 v202, v25, -v129, v202
    v_fma_f32 v202, v26, -v130, v202
    v_fma_f32 v202, v27, -v131, v202
    v_fma_f32 v202, v28, -v132, v202
    v_fma_f32 v202, v29, -v133, v202
    v_fma_f32 v202, v30, -v134, v202
    v_fma_f32 v202, v31, -v135, v202
    s_nop 1
    v_permlane32_swap_b32 v200, v202
    v_add_f32 v202, v200, v202
    s_waitcnt vmcnt(4) lgkmcnt(0)
    v_mfma_f32_32x32x16_bf16 v[56:71], v[72:75], v[176:179], 0
    v_mul_f32 v197, v32, v104
    v_fmac_f32 v197, v33, v105
    v_fmac_f32 v197, v34, v106
    v_fmac_f32 v197, v35, v107
    v_fmac_f32 v197, v36, v108
    v_fmac_f32 v197, v37, v109
    s_add_u32 m0, s21, 6144
    v_mfma_f32_32x32x16_bf16 v[16:31], v[76:79], v[176:179], 0
    buffer_load_dwordx4 v236, s[4:7], s36 offen  lds
    buffer_load_dwordx4 v237, s[8:11], s36 offen offset:1024  lds
    ds_read_b64_tr_b16 v[176:177], v244 offset:0
    ds_read_b64_tr_b16 v[178:179], v244 offset:1024
    ds_read_b64_tr_b16 v[184:185], v245 offset:0
    ds_read_b64_tr_b16 v[186:187], v245 offset:1024
    v_fmac_f32 v197, v38, v110
    v_fmac_f32 v197, v39, v111
    v_mul_f32 v199, v40, v136
    v_fmac_f32 v199, v41, v137
    v_fmac_f32 v199, v42, v138
    v_fmac_f32 v199, v43, v139
    v_fmac_f32 v199, v44, v140
    v_fmac_f32 v199, v45, v141
    v_fmac_f32 v199, v46, v142
    v_fmac_f32 v199, v47, v143
    v_mul_f32 v201, v0, v136
    v_fmac_f32 v201, v1, v137
    v_permlane32_swap_b32 v197, v199
    v_fmac_f32 v201, v2, v138
    v_fmac_f32 v201, v3, v139
    v_fmac_f32 v201, v4, v140
    v_fmac_f32 v201, v5, v141
    v_fmac_f32 v201, v6, v142
    s_waitcnt vmcnt(4) lgkmcnt(0)
    v_mfma_f32_32x32x16_bf16 v[56:71], v[80:83], v[176:179], v[56:71]
    v_fmac_f32 v201, v7, v143
    v_add_f32 v199, v197, v199
    v_mul_f32_e64 v203, v8, -v136
    v_fma_f32 v203, v9, -v137, v203
    v_fma_f32 v203, v10, -v138, v203
    v_fma_f32 v203, v11, -v139, v203
    s_add_u32 m0, s21, 0
    v_mfma_f32_32x32x16_bf16 v[16:31], v[84:87], v[176:179], v[16:31]
    buffer_load_dwordx4 v238, s[4:7], s36 offen  lds
    buffer_load_dwordx4 v239, s[8:11], s36 offen offset:1024  lds
    ds_read_b64_tr_b16 v[176:177], v244 offset:2048
    ds_read_b64_tr_b16 v[178:179], v244 offset:3072
    ds_read_b64_tr_b16 v[188:189], v245 offset:2048
    ds_read_b64_tr_b16 v[190:191], v245 offset:3072
    s_waitcnt lgkmcnt(0)
    v_mfma_f32_32x32x16_bf16 v[56:71], v[88:91], v[176:179], v[56:71]
    v_fma_f32 v203, v12, -v140, v203
    v_fma_f32 v203, v13, -v141, v203
    v_fma_f32 v203, v14, -v142, v203
    v_fma_f32 v203, v15, -v143, v203
    s_nop 1
    v_permlane32_swap_b32 v201, v203
    v_add_f32 v203, v201, v203
    s_add_u32 m0, s21, 2048
    v_mfma_f32_32x32x16_bf16 v[16:31], v[92:95], v[176:179], v[16:31]
    buffer_load_dwordx4 v234, s[4:7], s37 offen  lds
    buffer_load_dwordx4 v235, s[8:11], s37 offen offset:1024  lds
    v_add_u32 v252, s42, v247
    ds_read2_b32 v[234:235], v252 offset0:0 offset1:16
    s_set_gpr_idx_on s51, gpr_idx(DST)
    s_nop 0
    v_cvt_pk_bf16_f32 v204, v198, v199
    v_cvt_pk_bf16_f32 v205, v202, v203
    s_set_gpr_idx_off
    v_mfma_f32_32x32x16_bf16 v[32:47], v[72:75], v[180:183], 0
    v_mul_f32 v196, v56, v144
    v_fmac_f32 v196, v57, v145
    v_fmac_f32 v196, v58, v146
    v_fmac_f32 v196, v59, v147
    v_fmac_f32 v196, v60, v148
    v_fmac_f32 v196, v61, v149
    v_mfma_f32_32x32x16_bf16 v[0:15], v[76:79], v[180:183], 0
    v_fmac_f32 v196, v62, v150
    v_fmac_f32 v196, v63, v151
    v_mul_f32_e64 v200, v16, -v160
    v_fma_f32 v200, v17, -v161, v200
    v_fma_f32 v200, v18, -v162, v200
    v_fma_f32 v200, v19, -v163, v200
    v_mfma_f32_32x32x16_bf16 v[32:47], v[80:83], v[184:187], v[32:47]
    v_fma_f32 v200, v20, -v164, v200
    v_fma_f32 v200, v21, -v165, v200
    v_fma_f32 v200, v22, -v166, v200
    v_fma_f32 v200, v23, -v167, v200
    v_mul_f32_e64 v202, v24, -v160
    v_fma_f32 v202, v25, -v161, v202
    v_mfma_f32_32x32x16_bf16 v[0:15], v[84:87], v[184:187], v[0:15]
    s_waitcnt vmcnt(6)
    ds_read_b64_tr_b16 v[176:177], v244 offset:4096
    ds_read_b64_tr_b16 v[178:179], v244 offset:5120
    ds_read_b64_tr_b16 v[180:181], v245 offset:4096
    ds_read_b64_tr_b16 v[182:183], v245 offset:5120
    v_fma_f32 v202, v26, -v162, v202
    v_fma_f32 v202, v27, -v163, v202
    v_mfma_f32_32x32x16_bf16 v[32:47], v[88:91], v[188:191], v[32:47]
    v_fma_f32 v202, v28, -v164, v202
    v_fma_f32 v202, v29, -v165, v202
    v_fma_f32 v202, v30, -v166, v202
    v_fma_f32 v202, v31, -v167, v202
    v_mfma_f32_32x32x16_bf16 v[0:15], v[92:95], v[188:191], v[0:15]
    s_waitcnt vmcnt(4) lgkmcnt(0)
    v_mfma_f32_32x32x16_bf16 v[16:31], v[72:75], v[176:179], 0
    s_nop 4
    v_mul_f32 v197, v32, v152
    v_fmac_f32 v197, v33, v153
    v_fmac_f32 v197, v34, v154
    v_fmac_f32 v197, v35, v155
    v_fmac_f32 v197, v36, v156
    v_fmac_f32 v197, v37, v157
    s_add_u32 m0, s21, 4096
    v_mfma_f32_32x32x16_bf16 v[48:63], v[76:79], v[176:179], 0
    buffer_load_dwordx4 v236, s[4:7], s37 offen  lds
    buffer_load_dwordx4 v237, s[8:11], s37 offen offset:1024  lds
    ds_read_b64_tr_b16 v[176:177], v244 offset:6144
    ds_read_b64_tr_b16 v[178:179], v244 offset:7168
    ds_read_b64_tr_b16 v[184:185], v245 offset:6144
    ds_read_b64_tr_b16 v[186:187], v245 offset:7168
    v_add_u32 v252, s43, v247
    ds_read2_b32 v[236:237], v252 offset0:0 offset1:16
    v_fmac_f32 v197, v38, v158
    v_fmac_f32 v197, v39, v159
    v_mul_f32_e64 v201, v0, -v168
    v_fma_f32 v201, v1, -v169, v201
    s_waitcnt vmcnt(4) lgkmcnt(1)
    v_mfma_f32_32x32x16_bf16 v[16:31], v[80:83], v[176:179], v[16:31]
    v_fma_f32 v201, v2, -v170, v201
    v_fma_f32 v201, v3, -v171, v201
    v_fma_f32 v201, v4, -v172, v201
    v_fma_f32 v201, v5, -v173, v201
    v_fma_f32 v201, v6, -v174, v201
    v_fma_f32 v201, v7, -v175, v201
    s_add_u32 m0, s21, 6144
    v_mfma_f32_32x32x16_bf16 v[48:63], v[84:87], v[176:179], v[48:63]
    buffer_load_dwordx4 v238, s[4:7], s37 offen  lds
    buffer_load_dwordx4 v239, s[8:11], s37 offen offset:1024  lds
    ds_read_b64_tr_b16 v[176:177], v244 offset:0
    ds_read_b64_tr_b16 v[178:179], v244 offset:1024
    ds_read_b64_tr_b16 v[188:189], v245 offset:0
    ds_read_b64_tr_b16 v[190:191], v245 offset:1024
    v_add_u32 v252, s44, v247
    ds_read2_b32 v[238:239], v252 offset0:0 offset1:16
    s_waitcnt lgkmcnt(1)
    v_mfma_f32_32x32x16_bf16 v[16:31], v[88:91], v[176:179], v[16:31]
    v_mul_f32_e64 v203, v8, -v168
    v_fma_f32 v203, v9, -v169, v203
    v_fma_f32 v203, v10, -v170, v203
    v_fma_f32 v203, v11, -v171, v203
    v_fma_f32 v203, v12, -v172, v203
    v_fma_f32 v203, v13, -v173, v203
    s_add_u32 m0, s21, 0
    v_mfma_f32_32x32x16_bf16 v[48:63], v[92:95], v[176:179], v[48:63]
    v_mad_u32_u16 v234, v234, s3, v246 op_sel:[1,0,0,0]
    v_mad_u32_u16 v235, v235, s3, v246 op_sel:[1,0,0,0]
    buffer_load_dwordx4 v234, s[4:7], s38 offen  lds
    buffer_load_dwordx4 v235, s[8:11], s38 offen offset:1024  lds
    v_fma_f32 v203, v14, -v174, v203
    v_fma_f32 v203, v15, -v175, v203
    v_mfma_f32_32x32x16_bf16 v[0:15], v[72:75], v[180:183], 0
    v_fmac_f32 v200, v24, v160
    v_fmac_f32 v200, v25, v161
    v_fmac_f32 v200, v26, v162
    v_fmac_f32 v200, v27, v163
    v_fmac_f32 v200, v28, v164
    v_fmac_f32 v200, v29, v165
    v_fmac_f32 v200, v30, v166
    v_fmac_f32 v200, v31, v167
    v_mfma_f32_32x32x16_bf16 v[24:39], v[76:79], v[180:183], 0
    v_add_u32 v253, s47, v248
    ds_read_b32 v192, v253
    ds_read_b32 v193, v253 offset:256
    v_mul_f32 v254, v16, v144
    v_fmac_f32 v254, v17, v145
    v_fmac_f32 v254, v18, v146
    v_mfma_f32_32x32x16_bf16 v[0:15], v[80:83], v[184:187], v[0:15]
    v_fmac_f32 v254, v19, v147
    v_fmac_f32 v254, v20, v148
    v_fmac_f32 v254, v21, v149
    v_fmac_f32 v254, v22, v150
    v_fmac_f32 v254, v23, v151
    v_sub_f32_e64 v64, -v48, v64
    v_mfma_f32_32x32x16_bf16 v[24:39], v[84:87], v[184:187], v[24:39]
    s_waitcnt vmcnt(6)
    ds_read_b64_tr_b16 v[176:177], v244 offset:2048
    ds_read_b64_tr_b16 v[178:179], v244 offset:3072
    ds_read_b64_tr_b16 v[180:181], v245 offset:2048
    ds_read_b64_tr_b16 v[182:183], v245 offset:3072
    v_sub_f32_e64 v65, -v49, v65
    v_permlane32_swap_b32 v196, v254
    v_mfma_f32_32x32x16_bf16 v[24:39], v[92:95], v[188:191], v[24:39]
    v_sub_f32_e64 v66, -v50, v66
    v_sub_f32_e64 v67, -v51, v67
    v_sub_f32_e64 v68, -v52, v68
    v_sub_f32_e64 v69, -v53, v69
    v_sub_f32_e64 v70, -v54, v70
    v_sub_f32_e64 v71, -v55, v71
    v_mfma_f32_32x32x16_bf16 v[0:15], v[88:91], v[188:191], v[0:15]
    v_add_f32 v254, v196, v254
    s_waitcnt vmcnt(4) lgkmcnt(0)
    v_mfma_f32_32x32x16_bf16 v[56:71], v[76:79], v[176:179], v[56:71]
    s_nop 1
    v_sub_f32_e64 v40, -v24, v40
    v_sub_f32_e64 v41, -v25, v41
    v_sub_f32_e64 v42, -v26, v42
    v_sub_f32_e64 v43, -v27, v43
    v_sub_f32_e64 v44, -v28, v44
    v_sub_f32_e64 v45, -v29, v45
    v_sub_f32_e64 v46, -v30, v46
    v_sub_f32_e64 v47, -v31, v47
    s_mov_b32 m0, s76
    s_mov_b64 exec, s[72:73]
    buffer_load_dwordx4 v192, s[12:15], 0 offen  lds
    s_mov_b32 m0, s77
    s_mov_b64 exec, s[74:75]
    buffer_load_dwordx4 v193, s[12:15], 0 offen  lds
    s_mov_b64 exec, -1
    s_add_u32 m0, s21, 2048
    v_mfma_f32_32x32x16_bf16 v[16:31], v[72:75], v[176:179], 0
    v_mad_u32_u16 v236, v236, s3, v246 op_sel:[1,0,0,0]
    v_mad_u32_u16 v237, v237, s3, v246 op_sel:[1,0,0,0]
    buffer_load_dwordx4 v236, s[4:7], s39 offen  lds
    buffer_load_dwordx4 v237, s[8:11], s39 offen offset:1024  lds
    ds_read_b64_tr_b16 v[176:177], v244 offset:4096
    ds_read_b64_tr_b16 v[178:179], v244 offset:5120
    ds_read_b64_tr_b16 v[184:185], v245 offset:4096
    ds_read_b64_tr_b16 v[186:187], v245 offset:5120
    v_mul_f32 v255, v0, v152
    v_fmac_f32 v255, v1, v153
    v_fmac_f32 v255, v2, v154
    v_fmac_f32 v255, v3, v155
    v_fmac_f32 v255, v4, v156
    s_waitcnt vmcnt(6) lgkmcnt(0)
    v_mfma_f32_32x32x16_bf16 v[16:31], v[80:83], v[176:179], v[16:31]
    v_fmac_f32 v255, v5, v157
    v_fmac_f32 v255, v6, v158
    v_fmac_f32 v255, v7, v159
    v_fmac_f32 v201, v8, v168
    v_fmac_f32 v201, v9, v169
    v_permlane32_swap_b32 v197, v255
    s_add_u32 m0, s21, 4096
    v_mfma_f32_32x32x16_bf16 v[56:71], v[84:87], v[176:179], v[56:71]
    v_mad_u32_u16 v238, v238, s3, v246 op_sel:[1,0,0,0]
    v_mad_u32_u16 v239, v239, s3, v246 op_sel:[1,0,0,0]
    buffer_load_dwordx4 v238, s[4:7], s40 offen  lds
    buffer_load_dwordx4 v239, s[8:11], s40 offen offset:1024  lds
    ds_read_b64_tr_b16 v[176:177], v244 offset:6144
    ds_read_b64_tr_b16 v[178:179], v244 offset:7168
    ds_read_b64_tr_b16 v[188:189], v245 offset:6144
    ds_read_b64_tr_b16 v[190:191], v245 offset:7168
    s_waitcnt lgkmcnt(0)
    v_mfma_f32_32x32x16_bf16 v[16:31], v[88:91], v[176:179], v[16:31]
    v_fmac_f32 v201, v10, v170
    v_fmac_f32 v201, v11, v171
    v_fmac_f32 v201, v12, v172
    v_fmac_f32 v201, v13, v173
    v_fmac_f32 v201, v14, v174
    v_fmac_f32 v201, v15, v175
    s_add_u32 m0, s21, 6144
    v_mfma_f32_32x32x16_bf16 v[56:71], v[92:95], v[176:179], v[56:71]
    v_mad_u32_u16 v240, v240, s3, v246 op_sel:[1,0,0,0]
    v_mad_u32_u16 v241, v241, s3, v246 op_sel:[1,0,0,0]
    buffer_load_dwordx4 v240, s[4:7], s41 offen  lds
    buffer_load_dwordx4 v241, s[8:11], s41 offen offset:1024  lds
    v_add_f32 v255, v197, v255
    s_set_gpr_idx_on s51, gpr_idx(DST)
    s_nop 0
    v_cvt_pk_bf16_f32 v206, v254, v255
    s_set_gpr_idx_off
    v_mfma_f32_32x32x16_bf16 v[0:15], v[72:75], v[180:183], 0
    v_mul_f32 v254, v16, v144
    v_fmac_f32 v254, v17, v145
    v_fmac_f32 v254, v18, v146
    v_fmac_f32 v254, v19, v147
    v_fmac_f32 v254, v20, v148
    v_fmac_f32 v254, v21, v149
    v_mfma_f32_32x32x16_bf16 v[32:47], v[76:79], v[180:183], v[32:47]
    v_fmac_f32 v254, v22, v150
    v_fmac_f32 v254, v23, v151
    v_fma_f32 v202, v24, -v160, v202
    v_fma_f32 v202, v25, -v161, v202
    v_permlane32_swap_b32 v254, v200
    v_fma_f32 v202, v26, -v162, v202
    v_mfma_f32_32x32x16_bf16 v[0:15], v[80:83], v[184:187], v[0:15]
    v_fma_f32 v202, v27, -v163, v202
    v_fma_f32 v202, v28, -v164, v202
    v_fma_f32 v202, v29, -v165, v202
    v_fma_f32 v202, v30, -v166, v202
    v_fma_f32 v202, v31, -v167, v202
    v_add_f32 v200, v254, v200
    v_mfma_f32_32x32x16_bf16 v[32:47], v[84:87], v[184:187], v[32:47]
    s_waitcnt vmcnt(8)
    ds_read_b64_tr_b16 v[176:177], v244 offset:0
    ds_read_b64_tr_b16 v[178:179], v244 offset:1024
    ds_read_b64_tr_b16 v[180:181], v245 offset:0
    ds_read_b64_tr_b16 v[182:183], v245 offset:1024
    v_mul_f32_e64 v198, v64, -v112
    v_permlane32_swap_b32 v202, v254
    v_mfma_f32_32x32x16_bf16 v[0:15], v[88:91], v[188:191], v[0:15]
    v_fma_f32 v198, v65, -v113, v198
    v_fma_f32 v198, v66, -v114, v198
    v_fma_f32 v198, v67, -v115, v198
    v_fma_f32 v198, v68, -v116, v198
    v_fma_f32 v198, v69, -v117, v198
    v_fma_f32 v198, v70, -v118, v198
    v_mfma_f32_32x32x16_bf16 v[32:47], v[92:95], v[188:191], v[32:47]
    v_add_u32 v249, s48, v249
    v_add_u32 v250, s49, v250
    v_fma_f32 v198, v71, -v119, v198
    v_add_f32 v254, v202, v254
    v_mul_f32 v196, v56, v160
    v_fmac_f32 v196, v57, v161
    v_fmac_f32 v196, v58, v162
    v_fmac_f32 v196, v59, v163
    v_fmac_f32 v196, v60, v164
    v_fmac_f32 v196, v61, v165
    v_fmac_f32 v196, v62, v166
    v_fmac_f32 v196, v63, v167
    s_nop 1
    v_permlane32_swap_b32 v198, v196
    v_add_f32 v196, v198, v196
    v_mul_f32 v255, v0, v152
    v_fmac_f32 v255, v1, v153
    v_fmac_f32 v255, v2, v154
    v_fmac_f32 v255, v3, v155
    v_fmac_f32 v255, v4, v156
    v_fmac_f32 v255, v5, v157
    v_fmac_f32 v255, v6, v158
    v_fmac_f32 v255, v7, v159
    v_fma_f32 v203, v8, -v168, v203
    v_fma_f32 v203, v9, -v169, v203
    v_permlane32_swap_b32 v255, v201
    v_fma_f32 v203, v10, -v170, v203
    v_fma_f32 v203, v11, -v171, v203
    v_fma_f32 v203, v12, -v172, v203
    v_fma_f32 v203, v13, -v173, v203
    v_fma_f32 v203, v14, -v174, v203
    v_fma_f32 v203, v15, -v175, v203
    v_add_f32 v201, v255, v201
    v_mul_f32_e64 v199, v40, -v120
    v_permlane32_swap_b32 v203, v255
    v_fma_f32 v199, v41, -v121, v199
    v_fma_f32 v199, v42, -v122, v199
    v_fma_f32 v199, v43, -v123, v199
    s_waitcnt vmcnt(6)
    ds_read_b64_tr_b16 v[72:73], v249 offset:0
    ds_read_b64_tr_b16 v[76:77], v249 offset:64
    ds_read_b64_tr_b16 v[74:75], v249 offset:256
    ds_read_b64_tr_b16 v[78:79], v249 offset:320
    s_mov_b64 exec, s[54:55]
    ds_read_u16_d16_hi v242, v250 offset:0
    s_mov_b64 exec, -1
    v_fma_f32 v199, v44, -v124, v199
    v_fma_f32 v199, v45, -v125, v199
    v_fma_f32 v199, v46, -v126, v199
    v_fma_f32 v199, v47, -v127, v199
    v_add_f32 v255, v203, v255
    v_mul_f32 v197, v32, v168
    v_fmac_f32 v197, v33, v169
    v_fmac_f32 v197, v34, v170
    v_fmac_f32 v197, v35, v171
    v_fmac_f32 v197, v36, v172
    v_fmac_f32 v197, v37, v173
    v_fmac_f32 v197, v38, v174
    v_fmac_f32 v197, v39, v175
    s_nop 1
    v_permlane32_swap_b32 v199, v197
    v_add_f32 v197, v199, v197
    s_set_gpr_idx_on s51, gpr_idx(DST)
    s_nop 0
    v_cvt_pk_bf16_f32 v207, v200, v201
    v_cvt_pk_bf16_f32 v209, v254, v255
    v_cvt_pk_bf16_f32 v208, v196, v197
    s_set_gpr_idx_off
    s_add_u32 s50, s50, 1
    s_add_u32 s51, s51, 6
    s_cmp_ge_u32 s50, 4
    s_cbranch_scc1 LAST0
    s_add_u32 s53, s53, 4
    s_xor_b32 s66, s53, s20
    s_bitcmp1_b32 s66, 2
    s_setprio 1
    s_cbranch_scc1 PRIO_8
    s_setprio 0
PRIO_8:
    s_cmp_eq_u32 s52, 4
    s_cbranch_scc1 ITEM_0_4
    s_cmp_eq_u32 s52, 5
    s_cbranch_scc1 ITEM_0_5
    s_cmp_eq_u32 s52, 3
    s_cbranch_scc1 ITEM_0_3
    s_cmp_eq_u32 s52, 6
    s_cbranch_scc1 ITEM_0_6
    s_cmp_eq_u32 s52, 8
    s_cbranch_scc1 ITEM_0_8
    s_branch ITEM_0_2
.p2align 6
ITEM_0_8:
    s_mov_b64 exec, s[54:55]
    ds_read_u16_d16_hi v243, v250 offset:128
    s_mov_b64 exec, -1
    ds_read_b64_tr_b16 v[80:81], v249 offset:512
    ds_read_b64_tr_b16 v[84:85], v249 offset:576
    ds_read_b64_tr_b16 v[82:83], v249 offset:768
    ds_read_b64_tr_b16 v[86:87], v249 offset:832
    ds_read_b64_tr_b16 v[88:89], v249 offset:1024
    ds_read_b64_tr_b16 v[92:93], v249 offset:1088
    ds_read_b64_tr_b16 v[90:91], v249 offset:1280
    ds_read_b64_tr_b16 v[94:95], v249 offset:1344
    ds_read_b64_tr_b16 v[64:65], v249 offset:1536
    ds_read_b64_tr_b16 v[68:69], v249 offset:1600
    ds_read_b64_tr_b16 v[66:67], v249 offset:1792
    ds_read_b64_tr_b16 v[70:71], v249 offset:1856
    s_waitcnt lgkmcnt(13)
    v_mul_f32_dpp v196, v242, v72 row_newbcast:0 row_mask:0xf bank_mask:0xf
    v_mul_f32_dpp v197, v242, v73 row_newbcast:1 row_mask:0xf bank_mask:0xf
    v_mul_f32_dpp v198, v242, v72 row_newbcast:8 row_mask:0xf bank_mask:0xf
    v_mul_f32_dpp v199, v242, v73 row_newbcast:9 row_mask:0xf bank_mask:0xf
    v_mul_f32_dpp v200, v242, v76 row_newbcast:2 row_mask:0xf bank_mask:0xf
    v_mul_f32_dpp v201, v242, v77 row_newbcast:3 row_mask:0xf bank_mask:0xf
    v_mul_f32_dpp v202, v242, v76 row_newbcast:10 row_mask:0xf bank_mask:0xf
    v_mul_f32_dpp v203, v242, v77 row_newbcast:11 row_mask:0xf bank_mask:0xf
    v_cvt_pk_bf16_f32 v72, v196, v197
    v_cvt_pk_bf16_f32 v76, v198, v199
    v_cvt_pk_bf16_f32 v73, v200, v201
    v_cvt_pk_bf16_f32 v77, v202, v203
    v_mul_f32_dpp v196, v242, v74 row_newbcast:4 row_mask:0xf bank_mask:0xf
    v_mul_f32_dpp v197, v242, v75 row_newbcast:5 row_mask:0xf bank_mask:0xf
    v_mul_f32_dpp v198, v242, v74 row_newbcast:12 row_mask:0xf bank_mask:0xf
    v_mul_f32_dpp v199, v242, v75 row_newbcast:13 row_mask:0xf bank_mask:0xf
    v_mul_f32_dpp v200, v242, v78 row_newbcast:6 row_mask:0xf bank_mask:0xf
    v_mul_f32_dpp v201, v242, v79 row_newbcast:7 row_mask:0xf bank_mask:0xf
    v_mul_f32_dpp v202, v242, v78 row_newbcast:14 row_mask:0xf bank_mask:0xf
    v_mul_f32_dpp v203, v242, v79 row_newbcast:15 row_mask:0xf bank_mask:0xf
    v_cvt_pk_bf16_f32 v74, v196, v197
    v_cvt_pk_bf16_f32 v78, v198, v199
    v_cvt_pk_bf16_f32 v75, v200, v201
    v_cvt_pk_bf16_f32 v79, v202, v203
    s_mov_b64 exec, s[54:55]
    ds_read_u16_d16_hi v242, v250 offset:256
    s_mov_b64 exec, -1
    s_waitcnt vmcnt(4) lgkmcnt(9)
    v_mfma_f32_32x32x16_bf16 v[0:15], v[72:75], v[176:179], 0
    v_mul_f32_dpp v196, v243, v80 row_newbcast:0 row_mask:0xf bank_mask:0xf
    v_mul_f32_dpp v197, v243, v81 row_newbcast:1 row_mask:0xf bank_mask:0xf
    v_mul_f32_dpp v198, v243, v80 row_newbcast:8 row_mask:0xf bank_mask:0xf
    v_mul_f32_dpp v199, v243, v81 row_newbcast:9 row_mask:0xf bank_mask:0xf
    v_mul_f32_dpp v200, v243, v84 row_newbcast:2 row_mask:0xf bank_mask:0xf
    v_mul_f32_dpp v201, v243, v85 row_newbcast:3 row_mask:0xf bank_mask:0xf
    s_add_u32 m0, s21, 0
    v_mfma_f32_32x32x16_bf16 v[48:63], v[76:79], v[176:179], 0
    buffer_load_dwordx4 v234, s[4:7], s35 offen  lds
    buffer_load_dwordx4 v235, s[8:11], s35 offen offset:1024  lds
    ds_read_b64_tr_b16 v[176:177], v244 offset:2048
    ds_read_b64_tr_b16 v[178:179], v244 offset:3072
    ds_read_b64_tr_b16 v[184:185], v245 offset:2048
    ds_read_b64_tr_b16 v[186:187], v245 offset:3072
    v_mul_f32_dpp v202, v243, v84 row_newbcast:10 row_mask:0xf bank_mask:0xf
    v_mul_f32_dpp v203, v243, v85 row_newbcast:11 row_mask:0xf bank_mask:0xf
    v_cvt_pk_bf16_f32 v80, v196, v197
    v_cvt_pk_bf16_f32 v84, v198, v199
    v_cvt_pk_bf16_f32 v81, v200, v201
    v_cvt_pk_bf16_f32 v85, v202, v203
    v_mul_f32_dpp v196, v243, v82 row_newbcast:4 row_mask:0xf bank_mask:0xf
    v_mul_f32_dpp v197, v243, v83 row_newbcast:5 row_mask:0xf bank_mask:0xf
    v_mul_f32_dpp v198, v243, v82 row_newbcast:12 row_mask:0xf bank_mask:0xf
    v_mul_f32_dpp v199, v243, v83 row_newbcast:13 row_mask:0xf bank_mask:0xf
    v_mul_f32_dpp v200, v243, v86 row_newbcast:6 row_mask:0xf bank_mask:0xf
    v_mul_f32_dpp v201, v243, v87 row_newbcast:7 row_mask:0xf bank_mask:0xf
    v_mul_f32_dpp v202, v243, v86 row_newbcast:14 row_mask:0xf bank_mask:0xf
    v_mul_f32_dpp v203, v243, v87 row_newbcast:15 row_mask:0xf bank_mask:0xf
    v_cvt_pk_bf16_f32 v82, v196, v197
    v_cvt_pk_bf16_f32 v86, v198, v199
    v_cvt_pk_bf16_f32 v83, v200, v201
    v_cvt_pk_bf16_f32 v87, v202, v203
    s_mov_b64 exec, s[54:55]
    ds_read_u16_d16_hi v243, v250 offset:384
    s_mov_b64 exec, -1
    s_waitcnt vmcnt(4) lgkmcnt(1)
    v_mfma_f32_32x32x16_bf16 v[0:15], v[80:83], v[176:179], v[0:15]
    v_mul_f32_dpp v196, v242, v88 row_newbcast:0 row_mask:0xf bank_mask:0xf
    v_mul_f32_dpp v197, v242, v89 row_newbcast:1 row_mask:0xf bank_mask:0xf
    v_mul_f32_dpp v198, v242, v88 row_newbcast:8 row_mask:0xf bank_mask:0xf
    v_mul_f32_dpp v199, v242, v89 row_newbcast:9 row_mask:0xf bank_mask:0xf
    v_mul_f32_dpp v200, v242, v92 row_newbcast:2 row_mask:0xf bank_mask:0xf
    v_mul_f32_dpp v201, v242, v93 row_newbcast:3 row_mask:0xf bank_mask:0xf
    s_add_u32 m0, s21, 2048
    v_mfma_f32_32x32x16_bf16 v[48:63], v[84:87], v[176:179], v[48:63]
    buffer_load_dwordx4 v236, s[4:7], s35 offen  lds
    buffer_load_dwordx4 v237, s[8:11], s35 offen offset:1024  lds
    ds_read_b64_tr_b16 v[176:177], v244 offset:4096
    ds_read_b64_tr_b16 v[178:179], v244 offset:5120
    ds_read_b64_tr_b16 v[188:189], v245 offset:4096
    ds_read_b64_tr_b16 v[190:191], v245 offset:5120
    v_mul_f32_dpp v202, v242, v92 row_newbcast:10 row_mask:0xf bank_mask:0xf
    v_mul_f32_dpp v203, v242, v93 row_newbcast:11 row_mask:0xf bank_mask:0xf
    v_cvt_pk_bf16_f32 v88, v196, v197
    v_cvt_pk_bf16_f32 v92, v198, v199
    v_cvt_pk_bf16_f32 v89, v200, v201
    v_cvt_pk_bf16_f32 v93, v202, v203
    v_mul_f32_dpp v196, v242, v90 row_newbcast:4 row_mask:0xf bank_mask:0xf
    v_mul_f32_dpp v197, v242, v91 row_newbcast:5 row_mask:0xf bank_mask:0xf
    v_mul_f32_dpp v198, v242, v90 row_newbcast:12 row_mask:0xf bank_mask:0xf
    v_mul_f32_dpp v199, v242, v91 row_newbcast:13 row_mask:0xf bank_mask:0xf
    v_mul_f32_dpp v200, v242, v94 row_newbcast:6 row_mask:0xf bank_mask:0xf
    v_mul_f32_dpp v201, v242, v95 row_newbcast:7 row_mask:0xf bank_mask:0xf
    v_mul_f32_dpp v202, v242, v94 row_newbcast:14 row_mask:0xf bank_mask:0xf
    v_mul_f32_dpp v203, v242, v95 row_newbcast:15 row_mask:0xf bank_mask:0xf
    v_cvt_pk_bf16_f32 v90, v196, v197
    v_cvt_pk_bf16_f32 v94, v198, v199
    v_cvt_pk_bf16_f32 v91, v200, v201
    v_cvt_pk_bf16_f32 v95, v202, v203
    s_waitcnt vmcnt(4) lgkmcnt(0)
    v_mfma_f32_32x32x16_bf16 v[0:15], v[88:91], v[176:179], v[0:15]
    v_mul_f32_dpp v196, v243, v64 row_newbcast:0 row_mask:0xf bank_mask:0xf
    v_mul_f32_dpp v197, v243, v65 row_newbcast:1 row_mask:0xf bank_mask:0xf
    v_mul_f32_dpp v198, v243, v64 row_newbcast:8 row_mask:0xf bank_mask:0xf
    v_mul_f32_dpp v199, v243, v65 row_newbcast:9 row_mask:0xf bank_mask:0xf
    v_mul_f32_dpp v200, v243, v68 row_newbcast:2 row_mask:0xf bank_mask:0xf
    v_mul_f32_dpp v201, v243, v69 row_newbcast:3 row_mask:0xf bank_mask:0xf
    s_add_u32 m0, s21, 4096
    v_mfma_f32_32x32x16_bf16 v[48:63], v[92:95], v[176:179], v[48:63]
    buffer_load_dwordx4 v238, s[4:7], s35 offen  lds
    buffer_load_dwordx4 v239, s[8:11], s35 offen offset:1024  lds
    ds_read_b64_tr_b16 v[176:177], v244 offset:6144
    ds_read_b64_tr_b16 v[178:179], v244 offset:7168
    ds_read_b64_tr_b16 v[192:193], v245 offset:6144
    ds_read_b64_tr_b16 v[194:195], v245 offset:7168
    v_mul_f32_dpp v202, v243, v68 row_newbcast:10 row_mask:0xf bank_mask:0xf
    v_mul_f32_dpp v203, v243, v69 row_newbcast:11 row_mask:0xf bank_mask:0xf
    v_cvt_pk_bf16_f32 v64, v196, v197
    v_cvt_pk_bf16_f32 v68, v198, v199
    v_cvt_pk_bf16_f32 v65, v200, v201
    v_cvt_pk_bf16_f32 v69, v202, v203
    v_mul_f32_dpp v196, v243, v66 row_newbcast:4 row_mask:0xf bank_mask:0xf
    v_mul_f32_dpp v197, v243, v67 row_newbcast:5 row_mask:0xf bank_mask:0xf
    v_mul_f32_dpp v198, v243, v66 row_newbcast:12 row_mask:0xf bank_mask:0xf
    v_mul_f32_dpp v199, v243, v67 row_newbcast:13 row_mask:0xf bank_mask:0xf
    v_mul_f32_dpp v200, v243, v70 row_newbcast:6 row_mask:0xf bank_mask:0xf
    v_mul_f32_dpp v201, v243, v71 row_newbcast:7 row_mask:0xf bank_mask:0xf
    v_mul_f32_dpp v202, v243, v70 row_newbcast:14 row_mask:0xf bank_mask:0xf
    v_mul_f32_dpp v203, v243, v71 row_newbcast:15 row_mask:0xf bank_mask:0xf
    v_cvt_pk_bf16_f32 v66, v196, v197
    v_cvt_pk_bf16_f32 v70, v198, v199
    v_cvt_pk_bf16_f32 v67, v200, v201
    v_cvt_pk_bf16_f32 v71, v202, v203
    s_waitcnt lgkmcnt(0)
    v_mfma_f32_32x32x16_bf16 v[0:15], v[64:67], v[176:179], v[0:15]
    s_add_u32 m0, s21, 6144
    v_mfma_f32_32x32x16_bf16 v[48:63], v[68:71], v[176:179], v[48:63]
    buffer_load_dwordx4 v240, s[4:7], s35 offen  lds
    buffer_load_dwordx4 v241, s[8:11], s35 offen offset:1024  lds
    s_mov_b32 m0, s50
    s_nop 0
    s_movrels_b32 s71, s23
    s_bfe_u32 s46, s71, 0x30012
    s_mov_b32 m0, s46
    s_and_b32 s66, s71, 0x3ffff
    s_movrels_b32 s68, s57
    s_movrels_b32 s69, s61
    s_sub_u32 s48, s66, s47
    s_mov_b32 s47, s66
    s_lshr_b32 s52, s71, 28
    s_lshl_b32 s67, s46, 9
    s_add_u32 s66, s66, s67
    s_sub_u32 s49, s66, s42
    s_mov_b32 s42, s66
    s_bfe_u32 s66, s68, 655360
    s_add_u32 s43, s42, s66
    s_bfe_u32 s39, s69, 655360
    s_bfe_u32 s66, s68, 655370
    s_add_u32 s44, s42, s66
    s_bfe_u32 s40, s69, 655370
    s_bfe_u32 s66, s68, 655380
    s_add_u32 s45, s42, s66
    s_bfe_u32 s41, s69, 655380
    s_and_b32 s66, s46, s33
    s_cselect_b32 s72, -1, 1
    s_cselect_b32 s76, s47, 163712
    s_cmp_ge_u32 s66, 2
    s_cselect_b32 s73, -1, 0
    s_add_u32 s77, s47, 1024
    s_cmp_ge_u32 s66, 4
    s_cselect_b32 s75, -1, 0
    s_cmp_ge_u32 s66, 3
    s_cselect_b32 s74, -1, 1
    s_cselect_b32 s77, s77, 163712
    v_mfma_f32_32x32x16_bf16 v[16:31], v[72:75], v[180:183], 0
    v_mul_f32 v196, v0, v96
    v_fmac_f32 v196, v1, v97
    v_fmac_f32 v196, v2, v98
    v_fmac_f32 v196, v3, v99
    v_fmac_f32 v196, v4, v100
    v_fmac_f32 v196, v5, v101
    v_mfma_f32_32x32x16_bf16 v[32:47], v[76:79], v[180:183], 0
    v_fmac_f32 v196, v6, v102
    v_fmac_f32 v196, v7, v103
    v_mul_f32 v198, v8, v128
    v_fmac_f32 v198, v9, v129
    v_fmac_f32 v198, v10, v130
    v_fmac_f32 v198, v11, v131
    v_mfma_f32_32x32x16_bf16 v[16:31], v[80:83], v[184:187], v[16:31]
    v_fmac_f32 v198, v12, v132
    v_fmac_f32 v198, v13, v133
    v_fmac_f32 v198, v14, v134
    v_fmac_f32 v198, v15, v135
    v_mul_f32 v200, v48, v128
    v_fmac_f32 v200, v49, v129
    v_mfma_f32_32x32x16_bf16 v[32:47], v[84:87], v[184:187], v[32:47]
    v_permlane32_swap_b32 v196, v198
    v_fmac_f32 v200, v50, v130
    v_fmac_f32 v200, v51, v131
    v_fmac_f32 v200, v52, v132
    v_fmac_f32 v200, v53, v133
    v_fmac_f32 v200, v54, v134
    v_mfma_f32_32x32x16_bf16 v[16:31], v[88:91], v[188:191], v[16:31]
    v_fmac_f32 v200, v55, v135
    v_add_f32 v198, v196, v198
    v_mul_f32_e64 v202, v56, -v128
    v_fma_f32 v202, v57, -v129, v202
    v_fma_f32 v202, v58, -v130, v202
    v_fma_f32 v202, v59, -v131, v202
    v_mfma_f32_32x32x16_bf16 v[32:47], v[92:95], v[188:191], v[32:47]
    s_waitcnt vmcnt(6)
    ds_read_b64_tr_b16 v[176:177], v244 offset:0
    ds_read_b64_tr_b16 v[178:179], v244 offset:1024
    ds_read_b64_tr_b16 v[180:181], v245 offset:0
    ds_read_b64_tr_b16 v[182:183], v245 offset:1024
    v_fma_f32 v202, v60, -v132, v202
    v_fma_f32 v202, v61, -v133, v202
    v_mfma_f32_32x32x16_bf16 v[16:31], v[64:67], v[192:195], v[16:31]
    v_fma_f32 v202, v62, -v134, v202
    v_fma_f32 v202, v63, -v135, v202
    s_nop 1
    v_permlane32_swap_b32 v200, v202
    v_add_f32 v202, v200, v202
    v_mfma_f32_32x32x16_bf16 v[32:47], v[68:71], v[192:195], v[32:47]
    s_waitcnt vmcnt(4) lgkmcnt(0)
    v_mfma_f32_32x32x16_bf16 v[0:15], v[72:75], v[176:179], 0
    s_nop 2
    v_mul_f32 v197, v16, v104
    v_fmac_f32 v197, v17, v105
    v_fmac_f32 v197, v18, v106
    v_fmac_f32 v197, v19, v107
    v_fmac_f32 v197, v20, v108
    v_fmac_f32 v197, v21, v109
    s_add_u32 m0, s21, 0
    v_mfma_f32_32x32x16_bf16 v[48:63], v[76:79], v[176:179], 0
    buffer_load_dwordx4 v234, s[4:7], s36 offen  lds
    buffer_load_dwordx4 v235, s[8:11], s36 offen offset:1024  lds
    ds_read_b64_tr_b16 v[176:177], v244 offset:2048
    ds_read_b64_tr_b16 v[178:179], v244 offset:3072
    ds_read_b64_tr_b16 v[184:185], v245 offset:2048
    ds_read_b64_tr_b16 v[186:187], v245 offset:3072
    v_fmac_f32 v197, v22, v110
    v_fmac_f32 v197, v23, v111
    v_mul_f32 v199, v24, v136
    v_fmac_f32 v199, v25, v137
    v_fmac_f32 v199, v26, v138
    v_fmac_f32 v199, v27, v139
    v_fmac_f32 v199, v28, v140
    v_fmac_f32 v199, v29, v141
    v_fmac_f32 v199, v30, v142
    v_fmac_f32 v199, v31, v143
    s_waitcnt vmcnt(4) lgkmcnt(0)
    v_mfma_f32_32x32x16_bf16 v[0:15], v[80:83], v[176:179], v[0:15]
    v_mul_f32 v201, v32, v136
    v_fmac_f32 v201, v33, v137
    v_permlane32_swap_b32 v197, v199
    v_fmac_f32 v201, v34, v138
    v_fmac_f32 v201, v35, v139
    v_fmac_f32 v201, v36, v140
    s_add_u32 m0, s21, 2048
    v_mfma_f32_32x32x16_bf16 v[48:63], v[84:87], v[176:179], v[48:63]
    buffer_load_dwordx4 v236, s[4:7], s36 offen  lds
    buffer_load_dwordx4 v237, s[8:11], s36 offen offset:1024  lds
    ds_read_b64_tr_b16 v[176:177], v244 offset:4096
    ds_read_b64_tr_b16 v[178:179], v244 offset:5120
    ds_read_b64_tr_b16 v[188:189], v245 offset:4096
    ds_read_b64_tr_b16 v[190:191], v245 offset:5120
    s_waitcnt vmcnt(4) lgkmcnt(0)
    v_mfma_f32_32x32x16_bf16 v[0:15], v[88:91], v[176:179], v[0:15]
    v_fmac_f32 v201, v37, v141
    v_fmac_f32 v201, v38, v142
    v_fmac_f32 v201, v39, v143
    v_add_f32 v199, v197, v199
    v_mul_f32_e64 v203, v40, -v136
    v_fma_f32 v203, v41, -v137, v203
    s_add_u32 m0, s21, 4096
    v_mfma_f32_32x32x16_bf16 v[48:63], v[92:95], v[176:179], v[48:63]
    buffer_load_dwordx4 v238, s[4:7], s36 offen  lds
    buffer_load_dwordx4 v239, s[8:11], s36 offen offset:1024  lds
    ds_read_b64_tr_b16 v[176:177], v244 offset:6144
    ds_read_b64_tr_b16 v[178:179], v244 offset:7168
    ds_read_b64_tr_b16 v[192:193], v245 offset:6144
    ds_read_b64_tr_b16 v[194:195], v245 offset:7168
    s_waitcnt lgkmcnt(0)
    v_mfma_f32_32x32x16_bf16 v[0:15], v[64:67], v[176:179], v[0:15]
    v_fma_f32 v203, v42, -v138, v203
    v_fma_f32 v203, v43, -v139, v203
    v_fma_f32 v203, v44, -v140, v203
    v_fma_f32 v203, v45, -v141, v203
    v_fma_f32 v203, v46, -v142, v203
    v_fma_f32 v203, v47, -v143, v203
    s_nop 1
    s_add_u32 m0, s21, 6144
    v_mfma_f32_32x32x16_bf16 v[48:63], v[68:71], v[176:179], v[48:63]
    buffer_load_dwordx4 v240, s[4:7], s36 offen  lds
    buffer_load_dwordx4 v241, s[8:11], s36 offen offset:1024  lds
    v_permlane32_swap_b32 v201, v203
    v_add_f32 v203, v201, v203
    s_set_gpr_idx_on s51, gpr_idx(DST)
    s_nop 0
    v_cvt_pk_bf16_f32 v204, v198, v199
    v_cvt_pk_bf16_f32 v205, v202, v203
    s_set_gpr_idx_off
    v_mfma_f32_32x32x16_bf16 v[16:31], v[72:75], v[180:183], 0
    v_mul_f32 v196, v0, v144
    v_fmac_f32 v196, v1, v145
    v_fmac_f32 v196, v2, v146
    v_fmac_f32 v196, v3, v147
    v_fmac_f32 v196, v4, v148
    v_fmac_f32 v196, v5, v149
    v_mfma_f32_32x32x16_bf16 v[32:47], v[76:79], v[180:183], 0
    v_add_u32 v253, s47, v248
    ds_read_b32 v254, v253
    ds_read_b32 v255, v253 offset:256
    v_fmac_f32 v196, v6, v150
    v_fmac_f32 v196, v7, v151
    v_mul_f32 v198, v8, v112
    v_mfma_f32_32x32x16_bf16 v[16:31], v[80:83], v[184:187], v[16:31]
    v_fmac_f32 v198, v9, v113
    v_fmac_f32 v198, v10, v114
    v_fmac_f32 v198, v11, v115
    v_fmac_f32 v198, v12, v116
    v_fmac_f32 v198, v13, v117
    v_fmac_f32 v198, v14, v118
    v_mfma_f32_32x32x16_bf16 v[32:47], v[84:87], v[184:187], v[32:47]
    v_fmac_f32 v198, v15, v119
    v_mul_f32_e64 v200, v48, -v160
    v_fma_f32 v200, v49, -v161, v200
    v_fma_f32 v200, v50, -v162, v200
    v_fma_f32 v200, v51, -v163, v200
    v_fma_f32 v200, v52, -v164, v200
    v_mfma_f32_32x32x16_bf16 v[16:31], v[88:91], v[188:191], v[16:31]
    v_fma_f32 v200, v53, -v165, v200
    v_fma_f32 v200, v54, -v166, v200
    v_fma_f32 v200, v55, -v167, v200
    v_mul_f32_e64 v202, v56, -v160
    v_fma_f32 v202, v57, -v161, v202
    v_fma_f32 v202, v58, -v162, v202
    v_mfma_f32_32x32x16_bf16 v[32:47], v[92:95], v[188:191], v[32:47]
    s_waitcnt vmcnt(6)
    ds_read_b64_tr_b16 v[176:177], v244 offset:0
    ds_read_b64_tr_b16 v[178:179], v244 offset:1024
    ds_read_b64_tr_b16 v[180:181], v245 offset:0
    ds_read_b64_tr_b16 v[182:183], v245 offset:1024
    v_fma_f32 v202, v59, -v163, v202
    v_fma_f32 v202, v60, -v164, v202
    v_mfma_f32_32x32x16_bf16 v[16:31], v[64:67], v[192:195], v[16:31]
    v_fma_f32 v202, v61, -v165, v202
    v_fma_f32 v202, v62, -v166, v202
    v_fma_f32 v202, v63, -v167, v202
    v_mfma_f32_32x32x16_bf16 v[32:47], v[68:71], v[192:195], v[32:47]
    s_waitcnt vmcnt(4) lgkmcnt(0)
    v_mfma_f32_32x32x16_bf16 v[0:15], v[72:75], v[176:179], 0
    s_nop 5
    v_mul_f32 v197, v16, v152
    v_fmac_f32 v197, v17, v153
    v_fmac_f32 v197, v18, v154
    v_fmac_f32 v197, v19, v155
    v_fmac_f32 v197, v20, v156
    v_fmac_f32 v197, v21, v157
    s_add_u32 m0, s21, 0
    v_mfma_f32_32x32x16_bf16 v[48:63], v[76:79], v[176:179], 0
    buffer_load_dwordx4 v234, s[4:7], s37 offen  lds
    buffer_load_dwordx4 v235, s[8:11], s37 offen offset:1024  lds
    ds_read_b64_tr_b16 v[176:177], v244 offset:2048
    ds_read_b64_tr_b16 v[178:179], v244 offset:3072
    ds_read_b64_tr_b16 v[184:185], v245 offset:2048
    ds_read_b64_tr_b16 v[186:187], v245 offset:3072
    v_add_u32 v252, s42, v247
    ds_read2_b32 v[234:235], v252 offset0:0 offset1:16
    s_mov_b32 m0, s76
    s_mov_b64 exec, s[72:73]
    buffer_load_dwordx4 v254, s[12:15], 0 offen  lds
    s_mov_b32 m0, s77
    s_mov_b64 exec, s[74:75]
    buffer_load_dwordx4 v255, s[12:15], 0 offen  lds
    s_mov_b64 exec, -1
    v_fmac_f32 v197, v22, v158
    v_fmac_f32 v197, v23, v159
    v_mul_f32 v199, v24, v120
    v_fmac_f32 v199, v25, v121
    v_fmac_f32 v199, v26, v122
    v_fmac_f32 v199, v27, v123
    s_waitcnt vmcnt(6) lgkmcnt(1)
    v_mfma_f32_32x32x16_bf16 v[0:15], v[80:83], v[176:179], v[0:15]
    v_fmac_f32 v199, v28, v124
    v_fmac_f32 v199, v29, v125
    v_fmac_f32 v199, v30, v126
    v_fmac_f32 v199, v31, v127
    v_mul_f32_e64 v201, v32, -v168
    v_fma_f32 v201, v33, -v169, v201
    s_add_u32 m0, s21, 2048
    v_mfma_f32_32x32x16_bf16 v[48:63], v[84:87], v[176:179], v[48:63]
    buffer_load_dwordx4 v236, s[4:7], s37 offen  lds
    buffer_load_dwordx4 v237, s[8:11], s37 offen offset:1024  lds
    ds_read_b64_tr_b16 v[176:177], v244 offset:4096
    ds_read_b64_tr_b16 v[178:179], v244 offset:5120
    ds_read_b64_tr_b16 v[188:189], v245 offset:4096
    ds_read_b64_tr_b16 v[190:191], v245 offset:5120
    v_add_u32 v252, s43, v247
    ds_read2_b32 v[236:237], v252 offset0:0 offset1:16
    s_waitcnt vmcnt(6) lgkmcnt(1)
    v_mfma_f32_32x32x16_bf16 v[0:15], v[88:91], v[176:179], v[0:15]
    v_fma_f32 v201, v34, -v170, v201
    v_fma_f32 v201, v35, -v171, v201
    v_fma_f32 v201, v36, -v172, v201
    v_fma_f32 v201, v37, -v173, v201
    v_fma_f32 v201, v38, -v174, v201
    v_fma_f32 v201, v39, -v175, v201
    s_add_u32 m0, s21, 4096
    v_mfma_f32_32x32x16_bf16 v[48:63], v[92:95], v[176:179], v[48:63]
    buffer_load_dwordx4 v238, s[4:7], s37 offen  lds
    buffer_load_dwordx4 v239, s[8:11], s37 offen offset:1024  lds
    ds_read_b64_tr_b16 v[176:177], v244 offset:6144
    ds_read_b64_tr_b16 v[178:179], v244 offset:7168
    ds_read_b64_tr_b16 v[192:193], v245 offset:6144
    ds_read_b64_tr_b16 v[194:195], v245 offset:7168
    v_add_u32 v252, s44, v247
    ds_read2_b32 v[238:239], v252 offset0:0 offset1:16
    s_waitcnt lgkmcnt(1)
    v_mfma_f32_32x32x16_bf16 v[0:15], v[64:67], v[176:179], v[0:15]
    v_mul_f32_e64 v203, v40, -v168
    v_fma_f32 v203, v41, -v169, v203
    v_fma_f32 v203, v42, -v170, v203
    v_fma_f32 v203, v43, -v171, v203
    v_fma_f32 v203, v44, -v172, v203
    v_fma_f32 v203, v45, -v173, v203
    s_add_u32 m0, s21, 6144
    v_mfma_f32_32x32x16_bf16 v[48:63], v[68:71], v[176:179], v[48:63]
    buffer_load_dwordx4 v240, s[4:7], s37 offen  lds
    buffer_load_dwordx4 v241, s[8:11], s37 offen offset:1024  lds
    v_add_u32 v252, s45, v247
    ds_read2_b32 v[240:241], v252 offset0:0 offset1:16
    v_fma_f32 v203, v46, -v174, v203
    v_fma_f32 v203, v47, -v175, v203
    v_mfma_f32_32x32x16_bf16 v[16:31], v[72:75], v[180:183], 0
    v_mul_f32 v254, v0, v144
    v_fmac_f32 v254, v1, v145
    v_fmac_f32 v254, v2, v146
    v_fmac_f32 v254, v3, v147
    v_fmac_f32 v254, v4, v148
    v_fmac_f32 v254, v5, v149
    v_mfma_f32_32x32x16_bf16 v[32:47], v[76:79], v[180:183], 0
    ds_swizzle_b32 v76, v76 offset:0x401F
    ds_swizzle_b32 v77, v77 offset:0x401F
    ds_swizzle_b32 v78, v78 offset:0x401F
    ds_swizzle_b32 v79, v79 offset:0x401F
    v_fmac_f32 v254, v6, v150
    v_fmac_f32 v254, v7, v151
    v_mfma_f32_32x32x16_bf16 v[16:31], v[80:83], v[184:187], v[16:31]
    v_fmac_f32 v200, v8, v160
    v_fmac_f32 v200, v9, v161
    v_permlane32_swap_b32 v196, v254
    v_fmac_f32 v200, v10, v162
    v_fmac_f32 v200, v11, v163
    v_fmac_f32 v200, v12, v164
    v_mfma_f32_32x32x16_bf16 v[32:47], v[84:87], v[184:187], v[32:47]
    ds_swizzle_b32 v84, v84 offset:0x401F
    ds_swizzle_b32 v85, v85 offset:0x401F
    ds_swizzle_b32 v86, v86 offset:0x401F
    ds_swizzle_b32 v87, v87 offset:0x401F
    v_fmac_f32 v200, v13, v165
    v_fmac_f32 v200, v14, v166
    v_mfma_f32_32x32x16_bf16 v[16:31], v[88:91], v[188:191], v[16:31]
    v_fmac_f32 v200, v15, v167
    v_add_f32 v254, v196, v254
    v_mfma_f32_32x32x16_bf16 v[32:47], v[92:95], v[188:191], v[32:47]
    ds_swizzle_b32 v92, v92 offset:0x401F
    ds_swizzle_b32 v93, v93 offset:0x401F
    ds_swizzle_b32 v94, v94 offset:0x401F
    ds_swizzle_b32 v95, v95 offset:0x401F
    s_waitcnt vmcnt(8)
    ds_read_b64_tr_b16 v[176:177], v244 offset:0
    ds_read_b64_tr_b16 v[178:179], v244 offset:1024
    ds_read_b64_tr_b16 v[180:181], v245 offset:0
    ds_read_b64_tr_b16 v[182:183], v245 offset:1024
    v_mfma_f32_32x32x16_bf16 v[16:31], v[64:67], v[192:195], v[16:31]
    v_mfma_f32_32x32x16_bf16 v[32:47], v[68:71], v[192:195], v[32:47]
    ds_swizzle_b32 v68, v68 offset:0x401F
    ds_swizzle_b32 v69, v69 offset:0x401F
    ds_swizzle_b32 v70, v70 offset:0x401F
    ds_swizzle_b32 v71, v71 offset:0x401F
    s_waitcnt lgkmcnt(8)
    s_mov_b64 exec, s[56:57]
    v_xor_b32 v76, 0x80008000, v76
    v_xor_b32 v77, 0x80008000, v77
    v_xor_b32 v78, 0x80008000, v78
    v_xor_b32 v79, 0x80008000, v79
    v_xor_b32 v84, 0x80008000, v84
    v_xor_b32 v85, 0x80008000, v85
    v_xor_b32 v86, 0x80008000, v86
    v_xor_b32 v87, 0x80008000, v87
    v_xor_b32 v92, 0x80008000, v92
    v_xor_b32 v93, 0x80008000, v93
    v_xor_b32 v94, 0x80008000, v94
    v_xor_b32 v95, 0x80008000, v95
    s_mov_b64 exec, -1
    s_waitcnt vmcnt(4) lgkmcnt(4)
    v_mfma_f32_32x32x16_bf16 v[0:15], v[72:75], v[176:179], 0
    v_mul_f32 v255, v16, v152
    v_fmac_f32 v255, v17, v153
    v_fmac_f32 v255, v18, v154
    v_fmac_f32 v255, v19, v155
    v_fmac_f32 v255, v20, v156
    v_fmac_f32 v255, v21, v157
    s_add_u32 m0, s21, 0
    v_mfma_f32_32x32x16_bf16 v[48:63], v[76:79], v[176:179], v[48:63]
    v_mad_u32_u16 v234, v234, s3, v246 op_sel:[1,0,0,0]
    v_mad_u32_u16 v235, v235, s3, v246 op_sel:[1,0,0,0]
    buffer_load_dwordx4 v234, s[4:7], s38 offen  lds
    buffer_load_dwordx4 v235, s[8:11], s38 offen offset:1024  lds
    ds_read_b64_tr_b16 v[176:177], v244 offset:2048
    ds_read_b64_tr_b16 v[178:179], v244 offset:3072
    ds_read_b64_tr_b16 v[184:185], v245 offset:2048
    ds_read_b64_tr_b16 v[186:187], v245 offset:3072
    s_waitcnt vmcnt(4) lgkmcnt(0)
    v_mfma_f32_32x32x16_bf16 v[0:15], v[80:83], v[176:179], v[0:15]
    s_add_u32 m0, s21, 2048
    v_mfma_f32_32x32x16_bf16 v[48:63], v[84:87], v[176:179], v[48:63]
    v_mad_u32_u16 v236, v236, s3, v246 op_sel:[1,0,0,0]
    v_mad_u32_u16 v237, v237, s3, v246 op_sel:[1,0,0,0]
    buffer_load_dwordx4 v236, s[4:7], s39 offen  lds
    buffer_load_dwordx4 v237, s[8:11], s39 offen offset:1024  lds
    ds_read_b64_tr_b16 v[176:177], v244 offset:4096
    ds_read_b64_tr_b16 v[178:179], v244 offset:5120
    ds_read_b64_tr_b16 v[188:189], v245 offset:4096
    ds_read_b64_tr_b16 v[190:191], v245 offset:5120
    s_waitcnt vmcnt(4) lgkmcnt(0)
    v_mfma_f32_32x32x16_bf16 v[0:15], v[88:91], v[176:179], v[0:15]
    v_fmac_f32 v255, v22, v158
    v_fmac_f32 v255, v23, v159
    v_fmac_f32 v201, v24, v168
    v_fmac_f32 v201, v25, v169
    v_permlane32_swap_b32 v197, v255
    s_add_u32 m0, s21, 4096
    v_mfma_f32_32x32x16_bf16 v[48:63], v[92:95], v[176:179], v[48:63]
    v_mad_u32_u16 v238, v238, s3, v246 op_sel:[1,0,0,0]
    v_mad_u32_u16 v239, v239, s3, v246 op_sel:[1,0,0,0]
    buffer_load_dwordx4 v238, s[4:7], s40 offen  lds
    buffer_load_dwordx4 v239, s[8:11], s40 offen offset:1024  lds
    ds_read_b64_tr_b16 v[176:177], v244 offset:6144
    ds_read_b64_tr_b16 v[178:179], v244 offset:7168
    ds_read_b64_tr_b16 v[192:193], v245 offset:6144
    ds_read_b64_tr_b16 v[194:195], v245 offset:7168
    s_waitcnt lgkmcnt(0)
    s_mov_b64 exec, s[56:57]
    v_xor_b32 v68, 0x80008000, v68
    v_xor_b32 v69, 0x80008000, v69
    v_xor_b32 v70, 0x80008000, v70
    v_xor_b32 v71, 0x80008000, v71
    s_mov_b64 exec, -1
    v_mfma_f32_32x32x16_bf16 v[0:15], v[64:67], v[176:179], v[0:15]
    v_fmac_f32 v201, v26, v170
    v_fmac_f32 v201, v27, v171
    v_fmac_f32 v201, v28, v172
    v_fmac_f32 v201, v29, v173
    v_fmac_f32 v201, v30, v174
    v_fmac_f32 v201, v31, v175
    s_add_u32 m0, s21, 6144
    v_mfma_f32_32x32x16_bf16 v[48:63], v[68:71], v[176:179], v[48:63]
    v_mad_u32_u16 v240, v240, s3, v246 op_sel:[1,0,0,0]
    v_mad_u32_u16 v241, v241, s3, v246 op_sel:[1,0,0,0]
    buffer_load_dwordx4 v240, s[4:7], s41 offen  lds
    buffer_load_dwordx4 v241, s[8:11], s41 offen offset:1024  lds
    v_add_f32 v255, v197, v255
    s_set_gpr_idx_on s51, gpr_idx(DST)
    s_nop 0
    v_cvt_pk_bf16_f32 v206, v254, v255
    s_set_gpr_idx_off
    v_mfma_f32_32x32x16_bf16 v[16:31], v[72:75], v[180:183], 0
    v_mul_f32 v254, v0, v144
    v_fmac_f32 v254, v1, v145
    v_fmac_f32 v254, v2, v146
    v_fmac_f32 v254, v3, v147
    v_fmac_f32 v254, v4, v148
    v_fmac_f32 v254, v5, v149
    v_mfma_f32_32x32x16_bf16 v[32:47], v[76:79], v[180:183], v[32:47]
    v_fmac_f32 v254, v6, v150
    v_fmac_f32 v254, v7, v151
    v_fma_f32 v202, v8, -v160, v202
    v_fma_f32 v202, v9, -v161, v202
    v_permlane32_swap_b32 v254, v200
    v_fma_f32 v202, v10, -v162, v202
    v_mfma_f32_32x32x16_bf16 v[16:31], v[80:83], v[184:187], v[16:31]
    v_fma_f32 v202, v11, -v163, v202
    v_fma_f32 v202, v12, -v164, v202
    v_fma_f32 v202, v13, -v165, v202
    v_fma_f32 v202, v14, -v166, v202
    v_fma_f32 v202, v15, -v167, v202
    v_add_f32 v200, v254, v200
    v_mfma_f32_32x32x16_bf16 v[32:47], v[84:87], v[184:187], v[32:47]
    v_fmac_f32 v198, v48, v112
    v_permlane32_swap_b32 v202, v254
    v_fmac_f32 v198, v49, v113
    v_fmac_f32 v198, v50, v114
    v_fmac_f32 v198, v51, v115
    v_fmac_f32 v198, v52, v116
    v_mfma_f32_32x32x16_bf16 v[16:31], v[88:91], v[188:191], v[16:31]
    v_fmac_f32 v198, v53, v117
    v_fmac_f32 v198, v54, v118
    v_fmac_f32 v198, v55, v119
    v_add_f32 v254, v202, v254
    v_mul_f32 v196, v56, v160
    v_fmac_f32 v196, v57, v161
    v_mfma_f32_32x32x16_bf16 v[32:47], v[92:95], v[188:191], v[32:47]
    s_waitcnt vmcnt(6)
    ds_read_b64_tr_b16 v[176:177], v244 offset:0
    ds_read_b64_tr_b16 v[178:179], v244 offset:1024
    ds_read_b64_tr_b16 v[180:181], v245 offset:0
    ds_read_b64_tr_b16 v[182:183], v245 offset:1024
    v_fmac_f32 v196, v58, v162
    v_fmac_f32 v196, v59, v163
    v_mfma_f32_32x32x16_bf16 v[16:31], v[64:67], v[192:195], v[16:31]
    v_fmac_f32 v196, v60, v164
    v_fmac_f32 v196, v61, v165
    v_fmac_f32 v196, v62, v166
    v_fmac_f32 v196, v63, v167
    s_nop 1
    v_permlane32_swap_b32 v198, v196
    v_add_f32 v196, v198, v196
    v_mfma_f32_32x32x16_bf16 v[32:47], v[68:71], v[192:195], v[32:47]
    v_add_u32 v249, s48, v249
    v_add_u32 v250, s49, v250
    s_nop 0
    v_mul_f32 v255, v16, v152
    v_fmac_f32 v255, v17, v153
    v_fmac_f32 v255, v18, v154
    v_fmac_f32 v255, v19, v155
    v_fmac_f32 v255, v20, v156
    v_fmac_f32 v255, v21, v157
    v_fmac_f32 v255, v22, v158
    v_fmac_f32 v255, v23, v159
    v_fma_f32 v203, v24, -v168, v203
    v_fma_f32 v203, v25, -v169, v203
    v_permlane32_swap_b32 v255, v201
    v_fma_f32 v203, v26, -v170, v203
    v_fma_f32 v203, v27, -v171, v203
    v_fma_f32 v203, v28, -v172, v203
    v_fma_f32 v203, v29, -v173, v203
    v_fma_f32 v203, v30, -v174, v203
    v_fma_f32 v203, v31, -v175, v203
    v_add_f32 v201, v255, v201
    v_fmac_f32 v199, v32, v120
    v_permlane32_swap_b32 v203, v255
    v_fmac_f32 v199, v33, v121
    v_fmac_f32 v199, v34, v122
    v_fmac_f32 v199, v35, v123
    ds_read_b64_tr_b16 v[72:73], v249 offset:0
    ds_read_b64_tr_b16 v[76:77], v249 offset:64
    ds_read_b64_tr_b16 v[74:75], v249 offset:256
    ds_read_b64_tr_b16 v[78:79], v249 offset:320
    s_mov_b64 exec, s[54:55]
    ds_read_u16_d16_hi v242, v250 offset:0
    s_mov_b64 exec, -1
    v_fmac_f32 v199, v36, v124
    v_fmac_f32 v199, v37, v125
    v_fmac_f32 v199, v38, v126
    v_fmac_f32 v199, v39, v127
    v_add_f32 v255, v203, v255
    v_mul_f32 v197, v40, v168
    v_fmac_f32 v197, v41, v169
    v_fmac_f32 v197, v42, v170
    v_fmac_f32 v197, v43, v171
    v_fmac_f32 v197, v44, v172
    v_fmac_f32 v197, v45, v173
    v_fmac_f32 v197, v46, v174
    v_fmac_f32 v197, v47, v175
    s_nop 1
    v_permlane32_swap_b32 v199, v197
    v_add_f32 v197, v199, v197
    s_set_gpr_idx_on s51, gpr_idx(DST)
    s_nop 0
    v_cvt_pk_bf16_f32 v207, v200, v201
    v_cvt_pk_bf16_f32 v209, v254, v255
    v_cvt_pk_bf16_f32 v208, v196, v197
    s_set_gpr_idx_off
    s_add_u32 s50, s50, 1
    s_add_u32 s51, s51, 6
    s_cmp_ge_u32 s50, 4
    s_cbranch_scc1 LAST0
    s_add_u32 s53, s53, 4
    s_xor_b32 s66, s53, s20
    s_bitcmp1_b32 s66, 2
    s_setprio 1
    s_cbranch_scc1 PRIO_9
    s_setprio 0
PRIO_9:
    s_cmp_eq_u32 s52, 4
    s_cbranch_scc1 ITEM_0_4
    s_cmp_eq_u32 s52, 5
    s_cbranch_scc1 ITEM_0_5
    s_cmp_eq_u32 s52, 3
    s_cbranch_scc1 ITEM_0_3
    s_cmp_eq_u32 s52, 6
    s_cbranch_scc1 ITEM_0_6
    s_cmp_eq_u32 s52, 8
    s_cbranch_scc1 ITEM_0_8
    s_branch ITEM_0_2
.p2align 6
ITEM_0_2:
    s_mov_b32 m0, s50
    s_nop 0
    s_movrels_b32 s71, s23
    s_bfe_u32 s46, s71, 0x30012
    s_mov_b32 m0, s46
    s_and_b32 s66, s71, 0x3ffff
    s_movrels_b32 s68, s57
    s_movrels_b32 s69, s61
    s_sub_u32 s48, s66, s47
    s_mov_b32 s47, s66
    s_lshr_b32 s52, s71, 28
    s_lshl_b32 s67, s46, 9
    s_add_u32 s66, s66, s67
    s_sub_u32 s49, s66, s42
    s_mov_b32 s42, s66
    s_bfe_u32 s66, s68, 655360
    s_add_u32 s43, s42, s66
    s_bfe_u32 s39, s69, 655360
    s_bfe_u32 s66, s68, 655370
    s_add_u32 s44, s42, s66
    s_bfe_u32 s40, s69, 655370
    s_bfe_u32 s66, s68, 655380
    s_add_u32 s45, s42, s66
    s_bfe_u32 s41, s69, 655380
    s_and_b32 s66, s46, s33
    s_cselect_b32 s72, -1, 1
    s_cselect_b32 s76, s47, 163712
    s_cmp_ge_u32 s66, 2
    s_cselect_b32 s73, -1, 0
    s_add_u32 s77, s47, 1024
    s_cmp_ge_u32 s66, 4
    s_cselect_b32 s75, -1, 0
    s_cmp_ge_u32 s66, 3
    s_cselect_b32 s74, -1, 1
    s_cselect_b32 s77, s77, 163712
    v_add_u32 v252, s42, v247
    ds_read2_b32 v[234:235], v252 offset0:0 offset1:16
    v_add_u32 v252, s43, v247
    ds_read2_b32 v[236:237], v252 offset0:0 offset1:16
    v_add_u32 v252, s44, v247
    ds_read2_b32 v[238:239], v252 offset0:0 offset1:16
    v_add_u32 v252, s45, v247
    ds_read2_b32 v[240:241], v252 offset0:0 offset1:16
    s_waitcnt lgkmcnt(4)
    v_mul_f32_dpp v196, v242, v72 row_newbcast:0 row_mask:0xf bank_mask:0xf
    v_mul_f32_dpp v197, v242, v73 row_newbcast:1 row_mask:0xf bank_mask:0xf
    v_mul_f32_dpp v198, v242, v72 row_newbcast:8 row_mask:0xf bank_mask:0xf
    v_mul_f32_dpp v199, v242, v73 row_newbcast:9 row_mask:0xf bank_mask:0xf
    v_mul_f32_dpp v200, v242, v76 row_newbcast:2 row_mask:0xf bank_mask:0xf
    v_mul_f32_dpp v201, v242, v77 row_newbcast:3 row_mask:0xf bank_mask:0xf
    v_mul_f32_dpp v202, v242, v76 row_newbcast:10 row_mask:0xf bank_mask:0xf
    v_mul_f32_dpp v203, v242, v77 row_newbcast:11 row_mask:0xf bank_mask:0xf
    v_cvt_pk_bf16_f32 v72, v196, v197
    v_cvt_pk_bf16_f32 v76, v198, v199
    v_cvt_pk_bf16_f32 v73, v200, v201
    v_cvt_pk_bf16_f32 v77, v202, v203
    v_mul_f32_dpp v196, v242, v74 row_newbcast:4 row_mask:0xf bank_mask:0xf
    v_mul_f32_dpp v197, v242, v75 row_newbcast:5 row_mask:0xf bank_mask:0xf
    v_mul_f32_dpp v198, v242, v74 row_newbcast:12 row_mask:0xf bank_mask:0xf
    v_mul_f32_dpp v199, v242, v75 row_newbcast:13 row_mask:0xf bank_mask:0xf
    v_mul_f32_dpp v200, v242, v78 row_newbcast:6 row_mask:0xf bank_mask:0xf
    v_mul_f32_dpp v201, v242, v79 row_newbcast:7 row_mask:0xf bank_mask:0xf
    v_mul_f32_dpp v202, v242, v78 row_newbcast:14 row_mask:0xf bank_mask:0xf
    v_mul_f32_dpp v203, v242, v79 row_newbcast:15 row_mask:0xf bank_mask:0xf
    v_cvt_pk_bf16_f32 v74, v196, v197
    v_cvt_pk_bf16_f32 v78, v198, v199
    v_cvt_pk_bf16_f32 v75, v200, v201
    v_cvt_pk_bf16_f32 v79, v202, v203
    s_nop 0
    s_waitcnt lgkmcnt(3)
    v_mfma_f32_32x32x16_bf16 v[56:71], v[72:75], v[176:179], 0
    s_add_u32 m0, s21, 0
    v_mfma_f32_32x32x16_bf16 v[16:31], v[76:79], v[176:179], 0
    v_mad_u32_u16 v234, v234, s3, v246 op_sel:[1,0,0,0]
    v_mad_u32_u16 v235, v235, s3, v246 op_sel:[1,0,0,0]
    buffer_load_dwordx4 v234, s[4:7], s38 offen  lds
    buffer_load_dwordx4 v235, s[8:11], s38 offen offset:1024  lds
    v_mfma_f32_32x32x16_bf16 v[32:47], v[72:75], v[180:183], 0
    s_nop 4
    v_mul_f32 v196, v56, v96
    v_fmac_f32 v196, v57, v97
    v_fmac_f32 v196, v58, v98
    v_fmac_f32 v196, v59, v99
    v_fmac_f32 v196, v60, v100
    v_fmac_f32 v196, v61, v101
    v_mfma_f32_32x32x16_bf16 v[0:15], v[76:79], v[180:183], 0
    s_waitcnt vmcnt(6)
    ds_read_b64_tr_b16 v[176:177], v244 offset:2048
    ds_read_b64_tr_b16 v[178:179], v244 offset:3072
    ds_read_b64_tr_b16 v[180:181], v245 offset:2048
    ds_read_b64_tr_b16 v[182:183], v245 offset:3072
    v_fmac_f32 v196, v62, v102
    v_fmac_f32 v196, v63, v103
    v_mul_f32 v198, v64, v128
    v_fmac_f32 v198, v65, v129
    v_fmac_f32 v198, v66, v130
    v_fmac_f32 v198, v67, v131
    v_fmac_f32 v198, v68, v132
    v_fmac_f32 v198, v69, v133
    v_fmac_f32 v198, v70, v134
    v_fmac_f32 v198, v71, v135
    v_mul_f32 v200, v16, v128
    v_fmac_f32 v200, v17, v129
    v_permlane32_swap_b32 v196, v198
    v_fmac_f32 v200, v18, v130
    v_fmac_f32 v200, v19, v131
    v_fmac_f32 v200, v20, v132
    v_fmac_f32 v200, v21, v133
    v_fmac_f32 v200, v22, v134
    v_fmac_f32 v200, v23, v135
    v_add_f32 v198, v196, v198
    v_mul_f32_e64 v202, v24, -v128
    v_fma_f32 v202, v25, -v129, v202
    v_fma_f32 v202, v26, -v130, v202
    v_fma_f32 v202, v27, -v131, v202
    v_fma_f32 v202, v28, -v132, v202
    v_fma_f32 v202, v29, -v133, v202
    v_fma_f32 v202, v30, -v134, v202
    v_fma_f32 v202, v31, -v135, v202
    s_nop 1
    v_permlane32_swap_b32 v200, v202
    v_add_f32 v202, v200, v202
    s_waitcnt lgkmcnt(0)
    v_mfma_f32_32x32x16_bf16 v[56:71], v[72:75], v[176:179], 0
    v_mul_f32 v197, v32, v104
    v_fmac_f32 v197, v33, v105
    v_fmac_f32 v197, v34, v106
    v_fmac_f32 v197, v35, v107
    v_fmac_f32 v197, v36, v108
    v_fmac_f32 v197, v37, v109
    s_add_u32 m0, s21, 2048
    v_mfma_f32_32x32x16_bf16 v[16:31], v[76:79], v[176:179], 0
    v_mad_u32_u16 v236, v236, s3, v246 op_sel:[1,0,0,0]
    v_mad_u32_u16 v237, v237, s3, v246 op_sel:[1,0,0,0]
    buffer_load_dwordx4 v236, s[4:7], s39 offen  lds
    buffer_load_dwordx4 v237, s[8:11], s39 offen offset:1024  lds
    v_fmac_f32 v197, v38, v110
    v_fmac_f32 v197, v39, v111
    v_mul_f32 v199, v40, v136
    v_fmac_f32 v199, v41, v137
    v_fmac_f32 v199, v42, v138
    v_fmac_f32 v199, v43, v139
    v_fmac_f32 v199, v44, v140
    v_fmac_f32 v199, v45, v141
    v_fmac_f32 v199, v46, v142
    v_fmac_f32 v199, v47, v143
    v_mul_f32 v201, v0, v136
    v_fmac_f32 v201, v1, v137
    v_permlane32_swap_b32 v197, v199
    v_fmac_f32 v201, v2, v138
    v_fmac_f32 v201, v3, v139
    v_fmac_f32 v201, v4, v140
    v_fmac_f32 v201, v5, v141
    v_fmac_f32 v201, v6, v142
    v_fmac_f32 v201, v7, v143
    v_add_f32 v199, v197, v199
    v_mul_f32_e64 v203, v8, -v136
    v_fma_f32 v203, v9, -v137, v203
    v_fma_f32 v203, v10, -v138, v203
    v_fma_f32 v203, v11, -v139, v203
    v_fma_f32 v203, v12, -v140, v203
    v_fma_f32 v203, v13, -v141, v203
    v_fma_f32 v203, v14, -v142, v203
    v_fma_f32 v203, v15, -v143, v203
    s_nop 1
    v_permlane32_swap_b32 v201, v203
    v_add_f32 v203, v201, v203
    s_set_gpr_idx_on s51, gpr_idx(DST)
    s_nop 0
    v_cvt_pk_bf16_f32 v204, v198, v199
    v_cvt_pk_bf16_f32 v205, v202, v203
    s_set_gpr_idx_off
    v_mfma_f32_32x32x16_bf16 v[32:47], v[72:75], v[180:183], 0
    v_mul_f32 v196, v56, v144
    v_fmac_f32 v196, v57, v145
    v_fmac_f32 v196, v58, v146
    v_fmac_f32 v196, v59, v147
    v_fmac_f32 v196, v60, v148
    v_fmac_f32 v196, v61, v149
    v_mfma_f32_32x32x16_bf16 v[0:15], v[76:79], v[180:183], 0
    s_waitcnt vmcnt(6)
    ds_read_b64_tr_b16 v[176:177], v244 offset:4096
    ds_read_b64_tr_b16 v[178:179], v244 offset:5120
    ds_read_b64_tr_b16 v[180:181], v245 offset:4096
    ds_read_b64_tr_b16 v[182:183], v245 offset:5120
    v_fmac_f32 v196, v62, v150
    v_fmac_f32 v196, v63, v151
    v_mul_f32_e64 v200, v16, -v160
    v_fma_f32 v200, v17, -v161, v200
    v_fma_f32 v200, v18, -v162, v200
    v_fma_f32 v200, v19, -v163, v200
    v_fma_f32 v200, v20, -v164, v200
    v_fma_f32 v200, v21, -v165, v200
    v_fma_f32 v200, v22, -v166, v200
    v_fma_f32 v200, v23, -v167, v200
    v_mul_f32_e64 v202, v24, -v160
    v_fma_f32 v202, v25, -v161, v202
    v_fma_f32 v202, v26, -v162, v202
    v_fma_f32 v202, v27, -v163, v202
    v_fma_f32 v202, v28, -v164, v202
    v_fma_f32 v202, v29, -v165, v202
    v_fma_f32 v202, v30, -v166, v202
    v_fma_f32 v202, v31, -v167, v202
    s_waitcnt lgkmcnt(0)
    v_mfma_f32_32x32x16_bf16 v[16:31], v[72:75], v[176:179], 0
    v_mul_f32 v197, v32, v152
    v_fmac_f32 v197, v33, v153
    v_fmac_f32 v197, v34, v154
    v_fmac_f32 v197, v35, v155
    v_fmac_f32 v197, v36, v156
    v_fmac_f32 v197, v37, v157
    s_add_u32 m0, s21, 4096
    v_mfma_f32_32x32x16_bf16 v[48:63], v[76:79], v[176:179], 0
    v_mad_u32_u16 v238, v238, s3, v246 op_sel:[1,0,0,0]
    v_mad_u32_u16 v239, v239, s3, v246 op_sel:[1,0,0,0]
    buffer_load_dwordx4 v238, s[4:7], s40 offen  lds
    buffer_load_dwordx4 v239, s[8:11], s40 offen offset:1024  lds
    v_fmac_f32 v197, v38, v158
    v_fmac_f32 v197, v39, v159
    v_mul_f32_e64 v201, v0, -v168
    v_fma_f32 v201, v1, -v169, v201
    v_fma_f32 v201, v2, -v170, v201
    v_fma_f32 v201, v3, -v171, v201
    v_fma_f32 v201, v4, -v172, v201
    v_fma_f32 v201, v5, -v173, v201
    v_fma_f32 v201, v6, -v174, v201
    v_fma_f32 v201, v7, -v175, v201
    v_mul_f32_e64 v203, v8, -v168
    v_fma_f32 v203, v9, -v169, v203
    v_fma_f32 v203, v10, -v170, v203
    v_fma_f32 v203, v11, -v171, v203
    v_fma_f32 v203, v12, -v172, v203
    v_fma_f32 v203, v13, -v173, v203
    v_fma_f32 v203, v14, -v174, v203
    v_fma_f32 v203, v15, -v175, v203
    v_mfma_f32_32x32x16_bf16 v[0:15], v[72:75], v[180:183], 0
    v_fmac_f32 v200, v24, v160
    v_fmac_f32 v200, v25, v161
    v_fmac_f32 v200, v26, v162
    v_fmac_f32 v200, v27, v163
    v_fmac_f32 v200, v28, v164
    v_fmac_f32 v200, v29, v165
    v_fmac_f32 v200, v30, v166
    v_fmac_f32 v200, v31, v167
    v_mfma_f32_32x32x16_bf16 v[24:39], v[76:79], v[180:183], 0
    v_add_u32 v253, s47, v248
    ds_read_b32 v192, v253
    ds_read_b32 v193, v253 offset:256
    s_waitcnt vmcnt(6)
    ds_read_b64_tr_b16 v[176:177], v244 offset:6144
    ds_read_b64_tr_b16 v[178:179], v244 offset:7168
    ds_read_b64_tr_b16 v[180:181], v245 offset:6144
    ds_read_b64_tr_b16 v[182:183], v245 offset:7168
    v_mul_f32 v254, v16, v144
    v_fmac_f32 v254, v17, v145
    v_fmac_f32 v254, v18, v146
    v_fmac_f32 v254, v19, v147
    v_fmac_f32 v254, v20, v148
    v_fmac_f32 v254, v21, v149
    v_fmac_f32 v254, v22, v150
    v_fmac_f32 v254, v23, v151
    v_sub_f32_e64 v64, -v48, v64
    v_sub_f32_e64 v65, -v49, v65
    v_permlane32_swap_b32 v196, v254
    v_sub_f32_e64 v66, -v50, v66
    v_sub_f32_e64 v67, -v51, v67
    v_sub_f32_e64 v68, -v52, v68
    v_sub_f32_e64 v69, -v53, v69
    v_sub_f32_e64 v70, -v54, v70
    v_sub_f32_e64 v71, -v55, v71
    v_add_f32 v254, v196, v254
    s_waitcnt lgkmcnt(0)
    v_mfma_f32_32x32x16_bf16 v[56:71], v[76:79], v[176:179], v[56:71]
    v_sub_f32_e64 v40, -v24, v40
    v_sub_f32_e64 v41, -v25, v41
    v_sub_f32_e64 v42, -v26, v42
    v_sub_f32_e64 v43, -v27, v43
    v_sub_f32_e64 v44, -v28, v44
    v_sub_f32_e64 v45, -v29, v45
    v_sub_f32_e64 v46, -v30, v46
    v_sub_f32_e64 v47, -v31, v47
    s_mov_b32 m0, s76
    s_mov_b64 exec, s[72:73]
    buffer_load_dwordx4 v192, s[12:15], 0 offen  lds
    s_mov_b32 m0, s77
    s_mov_b64 exec, s[74:75]
    buffer_load_dwordx4 v193, s[12:15], 0 offen  lds
    s_mov_b64 exec, -1
    s_add_u32 m0, s21, 6144
    v_mfma_f32_32x32x16_bf16 v[16:31], v[72:75], v[176:179], 0
    v_mad_u32_u16 v240, v240, s3, v246 op_sel:[1,0,0,0]
    v_mad_u32_u16 v241, v241, s3, v246 op_sel:[1,0,0,0]
    buffer_load_dwordx4 v240, s[4:7], s41 offen  lds
    buffer_load_dwordx4 v241, s[8:11], s41 offen offset:1024  lds
    v_mul_f32 v255, v0, v152
    v_fmac_f32 v255, v1, v153
    v_fmac_f32 v255, v2, v154
    v_fmac_f32 v255, v3, v155
    v_fmac_f32 v255, v4, v156
    v_fmac_f32 v255, v5, v157
    v_fmac_f32 v255, v6, v158
    v_fmac_f32 v255, v7, v159
    v_fmac_f32 v201, v8, v168
    v_fmac_f32 v201, v9, v169
    v_permlane32_swap_b32 v197, v255
    v_fmac_f32 v201, v10, v170
    v_fmac_f32 v201, v11, v171
    v_fmac_f32 v201, v12, v172
    v_fmac_f32 v201, v13, v173
    v_fmac_f32 v201, v14, v174
    v_fmac_f32 v201, v15, v175
    v_add_f32 v255, v197, v255
    s_set_gpr_idx_on s51, gpr_idx(DST)
    s_nop 0
    v_cvt_pk_bf16_f32 v206, v254, v255
    s_set_gpr_idx_off
    v_mfma_f32_32x32x16_bf16 v[0:15], v[72:75], v[180:183], 0
    v_mul_f32 v254, v16, v144
    v_fmac_f32 v254, v17, v145
    v_fmac_f32 v254, v18, v146
    v_fmac_f32 v254, v19, v147
    v_fmac_f32 v254, v20, v148
    v_fmac_f32 v254, v21, v149
    v_mfma_f32_32x32x16_bf16 v[32:47], v[76:79], v[180:183], v[32:47]
    s_waitcnt vmcnt(8)
    ds_read_b64_tr_b16 v[176:177], v244 offset:0
    ds_read_b64_tr_b16 v[178:179], v244 offset:1024
    ds_read_b64_tr_b16 v[180:181], v245 offset:0
    ds_read_b64_tr_b16 v[182:183], v245 offset:1024
    v_add_u32 v249, s48, v249
    v_add_u32 v250, s49, v250
    v_fmac_f32 v254, v22, v150
    v_fmac_f32 v254, v23, v151
    v_fma_f32 v202, v24, -v160, v202
    v_fma_f32 v202, v25, -v161, v202
    v_permlane32_swap_b32 v254, v200
    v_fma_f32 v202, v26, -v162, v202
    v_fma_f32 v202, v27, -v163, v202
    v_fma_f32 v202, v28, -v164, v202
    v_fma_f32 v202, v29, -v165, v202
    v_fma_f32 v202, v30, -v166, v202
    v_fma_f32 v202, v31, -v167, v202
    v_add_f32 v200, v254, v200
    v_mul_f32_e64 v198, v64, -v112
    v_permlane32_swap_b32 v202, v254
    v_fma_f32 v198, v65, -v113, v198
    v_fma_f32 v198, v66, -v114, v198
    v_fma_f32 v198, v67, -v115, v198
    v_fma_f32 v198, v68, -v116, v198
    v_fma_f32 v198, v69, -v117, v198
    v_fma_f32 v198, v70, -v118, v198
    v_fma_f32 v198, v71, -v119, v198
    v_add_f32 v254, v202, v254
    v_mul_f32 v196, v56, v160
    v_fmac_f32 v196, v57, v161
    v_fmac_f32 v196, v58, v162
    v_fmac_f32 v196, v59, v163
    v_fmac_f32 v196, v60, v164
    v_fmac_f32 v196, v61, v165
    v_fmac_f32 v196, v62, v166
    v_fmac_f32 v196, v63, v167
    s_nop 1
    v_permlane32_swap_b32 v198, v196
    v_add_f32 v196, v198, v196
    v_mul_f32 v255, v0, v152
    v_fmac_f32 v255, v1, v153
    v_fmac_f32 v255, v2, v154
    v_fmac_f32 v255, v3, v155
    v_fmac_f32 v255, v4, v156
    v_fmac_f32 v255, v5, v157
    v_fmac_f32 v255, v6, v158
    v_fmac_f32 v255, v7, v159
    v_fma_f32 v203, v8, -v168, v203
    v_fma_f32 v203, v9, -v169, v203
    v_permlane32_swap_b32 v255, v201
    v_fma_f32 v203, v10, -v170, v203
    v_fma_f32 v203, v11, -v171, v203
    v_fma_f32 v203, v12, -v172, v203
    v_fma_f32 v203, v13, -v173, v203
    v_fma_f32 v203, v14, -v174, v203
    v_fma_f32 v203, v15, -v175, v203
    v_add_f32 v201, v255, v201
    v_mul_f32_e64 v199, v40, -v120
    v_permlane32_swap_b32 v203, v255
    v_fma_f32 v199, v41, -v121, v199
    v_fma_f32 v199, v42, -v122, v199
    v_fma_f32 v199, v43, -v123, v199
    s_waitcnt vmcnt(2)
    ds_read_b64_tr_b16 v[72:73], v249 offset:0
    ds_read_b64_tr_b16 v[76:77], v249 offset:64
    ds_read_b64_tr_b16 v[74:75], v249 offset:256
    ds_read_b64_tr_b16 v[78:79], v249 offset:320
    s_mov_b64 exec, s[54:55]
    ds_read_u16_d16_hi v242, v250 offset:0
    s_mov_b64 exec, -1
    v_fma_f32 v199, v44, -v124, v199
    v_fma_f32 v199, v45, -v125, v199
    v_fma_f32 v199, v46, -v126, v199
    v_fma_f32 v199, v47, -v127, v199
    v_add_f32 v255, v203, v255
    v_mul_f32 v197, v32, v168
    v_fmac_f32 v197, v33, v169
    v_fmac_f32 v197, v34, v170
    v_fmac_f32 v197, v35, v171
    v_fmac_f32 v197, v36, v172
    v_fmac_f32 v197, v37, v173
    v_fmac_f32 v197, v38, v174
    v_fmac_f32 v197, v39, v175
    s_nop 1
    v_permlane32_swap_b32 v199, v197
    v_add_f32 v197, v199, v197
    s_set_gpr_idx_on s51, gpr_idx(DST)
    s_nop 0
    v_cvt_pk_bf16_f32 v207, v200, v201
    v_cvt_pk_bf16_f32 v209, v254, v255
    v_cvt_pk_bf16_f32 v208, v196, v197
    s_set_gpr_idx_off
    s_add_u32 s50, s50, 1
    s_add_u32 s51, s51, 6
    s_cmp_ge_u32 s50, 4
    s_cbranch_scc1 LAST0
    s_add_u32 s53, s53, 4
    s_xor_b32 s66, s53, s20
    s_bitcmp1_b32 s66, 2
    s_setprio 1
    s_cbranch_scc1 PRIO_10
    s_setprio 0
PRIO_10:
    s_cmp_eq_u32 s52, 4
    s_cbranch_scc1 ITEM_0_4
    s_cmp_eq_u32 s52, 5
    s_cbranch_scc1 ITEM_0_5
    s_cmp_eq_u32 s52, 3
    s_cbranch_scc1 ITEM_0_3
    s_cmp_eq_u32 s52, 6
    s_cbranch_scc1 ITEM_0_6
    s_cmp_eq_u32 s52, 8
    s_cbranch_scc1 ITEM_0_8
    s_branch ITEM_0_2
.p2align 6
ITEM_1_4:
    s_mov_b64 exec, s[54:55]
    ds_read_u16_d16_hi v243, v250 offset:128
    s_mov_b64 exec, -1
    ds_read_b64_tr_b16 v[80:81], v249 offset:512
    ds_read_b64_tr_b16 v[84:85], v249 offset:576
    ds_read_b64_tr_b16 v[82:83], v249 offset:768
    ds_read_b64_tr_b16 v[86:87], v249 offset:832
    s_waitcnt lgkmcnt(5)
    v_mul_f32_dpp v196, v242, v72 row_newbcast:0 row_mask:0xf bank_mask:0xf
    v_mul_f32_dpp v197, v242, v73 row_newbcast:1 row_mask:0xf bank_mask:0xf
    v_mul_f32_dpp v198, v242, v72 row_newbcast:8 row_mask:0xf bank_mask:0xf
    v_mul_f32_dpp v199, v242, v73 row_newbcast:9 row_mask:0xf bank_mask:0xf
    v_mul_f32_dpp v200, v242, v76 row_newbcast:2 row_mask:0xf bank_mask:0xf
    v_mul_f32_dpp v201, v242, v77 row_newbcast:3 row_mask:0xf bank_mask:0xf
    v_mul_f32_dpp v202, v242, v76 row_newbcast:10 row_mask:0xf bank_mask:0xf
    v_mul_f32_dpp v203, v242, v77 row_newbcast:11 row_mask:0xf bank_mask:0xf
    v_cvt_pk_bf16_f32 v72, v196, v197
    v_cvt_pk_bf16_f32 v76, v198, v199
    v_cvt_pk_bf16_f32 v73, v200, v201
    v_cvt_pk_bf16_f32 v77, v202, v203
    v_mul_f32_dpp v196, v242, v74 row_newbcast:4 row_mask:0xf bank_mask:0xf
    v_mul_f32_dpp v197, v242, v75 row_newbcast:5 row_mask:0xf bank_mask:0xf
    v_mul_f32_dpp v198, v242, v74 row_newbcast:12 row_mask:0xf bank_mask:0xf
    v_mul_f32_dpp v199, v242, v75 row_newbcast:13 row_mask:0xf bank_mask:0xf
    v_mul_f32_dpp v200, v242, v78 row_newbcast:6 row_mask:0xf bank_mask:0xf
    v_mul_f32_dpp v201, v242, v79 row_newbcast:7 row_mask:0xf bank_mask:0xf
    v_mul_f32_dpp v202, v242, v78 row_newbcast:14 row_mask:0xf bank_mask:0xf
    v_mul_f32_dpp v203, v242, v79 row_newbcast:15 row_mask:0xf bank_mask:0xf
    v_cvt_pk_bf16_f32 v74, v196, v197
    v_cvt_pk_bf16_f32 v78, v198, v199
    v_cvt_pk_bf16_f32 v75, v200, v201
    v_cvt_pk_bf16_f32 v79, v202, v203
    s_waitcnt vmcnt(4) lgkmcnt(0)
    v_mfma_f32_32x32x16_bf16 v[56:71], v[72:75], v[176:179], 0
    v_mul_f32_dpp v196, v243, v80 row_newbcast:0 row_mask:0xf bank_mask:0xf
    v_mul_f32_dpp v197, v243, v81 row_newbcast:1 row_mask:0xf bank_mask:0xf
    v_mul_f32_dpp v198, v243, v80 row_newbcast:8 row_mask:0xf bank_mask:0xf
    v_mul_f32_dpp v199, v243, v81 row_newbcast:9 row_mask:0xf bank_mask:0xf
    v_mul_f32_dpp v200, v243, v84 row_newbcast:2 row_mask:0xf bank_mask:0xf
    v_mul_f32_dpp v201, v243, v85 row_newbcast:3 row_mask:0xf bank_mask:0xf
    s_add_u32 m0, s21, 0
    v_mfma_f32_32x32x16_bf16 v[16:31], v[76:79], v[176:179], 0
    buffer_load_dwordx4 v234, s[4:7], s36 offen  lds
    buffer_load_dwordx4 v235, s[8:11], s36 offen offset:1024  lds
    ds_read_b64_tr_b16 v[176:177], v244 offset:2048
    ds_read_b64_tr_b16 v[178:179], v244 offset:3072
    ds_read_b64_tr_b16 v[184:185], v245 offset:2048
    ds_read_b64_tr_b16 v[186:187], v245 offset:3072
    v_mul_f32_dpp v202, v243, v84 row_newbcast:10 row_mask:0xf bank_mask:0xf
    v_mul_f32_dpp v203, v243, v85 row_newbcast:11 row_mask:0xf bank_mask:0xf
    v_cvt_pk_bf16_f32 v80, v196, v197
    v_cvt_pk_bf16_f32 v84, v198, v199
    v_cvt_pk_bf16_f32 v81, v200, v201
    v_cvt_pk_bf16_f32 v85, v202, v203
    v_mul_f32_dpp v196, v243, v82 row_newbcast:4 row_mask:0xf bank_mask:0xf
    v_mul_f32_dpp v197, v243, v83 row_newbcast:5 row_mask:0xf bank_mask:0xf
    v_mul_f32_dpp v198, v243, v82 row_newbcast:12 row_mask:0xf bank_mask:0xf
    v_mul_f32_dpp v199, v243, v83 row_newbcast:13 row_mask:0xf bank_mask:0xf
    v_mul_f32_dpp v200, v243, v86 row_newbcast:6 row_mask:0xf bank_mask:0xf
    v_mul_f32_dpp v201, v243, v87 row_newbcast:7 row_mask:0xf bank_mask:0xf
    v_mul_f32_dpp v202, v243, v86 row_newbcast:14 row_mask:0xf bank_mask:0xf
    v_mul_f32_dpp v203, v243, v87 row_newbcast:15 row_mask:0xf bank_mask:0xf
    v_cvt_pk_bf16_f32 v82, v196, v197
    v_cvt_pk_bf16_f32 v86, v198, v199
    v_cvt_pk_bf16_f32 v83, v200, v201
    v_cvt_pk_bf16_f32 v87, v202, v203
    s_waitcnt lgkmcnt(0)
    v_mfma_f32_32x32x16_bf16 v[56:71], v[80:83], v[176:179], v[56:71]
    s_add_u32 m0, s21, 2048
    v_mfma_f32_32x32x16_bf16 v[16:31], v[84:87], v[176:179], v[16:31]
    buffer_load_dwordx4 v236, s[4:7], s36 offen  lds
    buffer_load_dwordx4 v237, s[8:11], s36 offen offset:1024  lds
    s_mov_b32 m0, s50
    s_nop 0
    s_movrels_b32 s71, s23
    s_movrels_b32 s33, s28
    v_add_u32 v253, s33, v248
    s_bfe_u32 s46, s71, 0x30012
    s_mov_b32 m0, s46
    s_and_b32 s66, s71, 0x3ffff
    s_movrels_b32 s68, s57
    s_movrels_b32 s69, s61
    s_sub_u32 s48, s66, s47
    s_mov_b32 s47, s66
    s_lshr_b32 s52, s71, 28
    s_lshl_b32 s67, s46, 9
    s_add_u32 s66, s66, s67
    s_sub_u32 s49, s66, s42
    s_mov_b32 s42, s66
    s_bfe_u32 s66, s68, 655360
    s_add_u32 s43, s42, s66
    s_bfe_u32 s39, s69, 655360
    s_bfe_u32 s66, s68, 655370
    s_add_u32 s44, s42, s66
    s_bfe_u32 s40, s69, 655370
    s_bfe_u32 s66, s68, 655380
    s_add_u32 s45, s42, s66
    s_bfe_u32 s41, s69, 655380
    v_add_u32 v252, s44, v247
    ds_read2_b32 v[238:239], v252 offset0:0 offset1:16
    v_add_u32 v252, s45, v247
    ds_read2_b32 v[240:241], v252 offset0:0 offset1:16
    v_mfma_f32_32x32x16_bf16 v[32:47], v[72:75], v[180:183], 0
    v_mul_f32 v196, v56, v96
    v_fmac_f32 v196, v57, v97
    v_fmac_f32 v196, v58, v98
    v_fmac_f32 v196, v59, v99
    v_fmac_f32 v196, v60, v100
    v_fmac_f32 v196, v61, v101
    v_mfma_f32_32x32x16_bf16 v[0:15], v[76:79], v[180:183], 0
    s_waitcnt vmcnt(6)
    ds_read_b64_tr_b16 v[176:177], v244 offset:4096
    ds_read_b64_tr_b16 v[178:179], v244 offset:5120
    ds_read_b64_tr_b16 v[180:181], v245 offset:4096
    ds_read_b64_tr_b16 v[182:183], v245 offset:5120
    v_fmac_f32 v196, v62, v102
    v_fmac_f32 v196, v63, v103
    v_mfma_f32_32x32x16_bf16 v[32:47], v[80:83], v[184:187], v[32:47]
    v_mul_f32 v198, v64, v128
    v_fmac_f32 v198, v65, v129
    v_fmac_f32 v198, v66, v130
    v_fmac_f32 v198, v67, v131
    v_fmac_f32 v198, v68, v132
    v_fmac_f32 v198, v69, v133
    v_mfma_f32_32x32x16_bf16 v[0:15], v[84:87], v[184:187], v[0:15]
    v_fmac_f32 v198, v70, v134
    v_fmac_f32 v198, v71, v135
    v_mul_f32 v200, v16, v128
    v_fmac_f32 v200, v17, v129
    v_permlane32_swap_b32 v196, v198
    v_fmac_f32 v200, v18, v130
    v_fmac_f32 v200, v19, v131
    v_fmac_f32 v200, v20, v132
    v_fmac_f32 v200, v21, v133
    v_fmac_f32 v200, v22, v134
    v_fmac_f32 v200, v23, v135
    v_add_f32 v198, v196, v198
    v_mul_f32_e64 v202, v24, -v128
    v_fma_f32 v202, v25, -v129, v202
    v_fma_f32 v202, v26, -v130, v202
    v_fma_f32 v202, v27, -v131, v202
    v_fma_f32 v202, v28, -v132, v202
    v_fma_f32 v202, v29, -v133, v202
    v_fma_f32 v202, v30, -v134, v202
    v_fma_f32 v202, v31, -v135, v202
    s_nop 1
    v_permlane32_swap_b32 v200, v202
    v_add_f32 v202, v200, v202
    s_waitcnt vmcnt(4) lgkmcnt(0)
    v_mfma_f32_32x32x16_bf16 v[56:71], v[72:75], v[176:179], 0
    v_mul_f32 v197, v32, v104
    v_fmac_f32 v197, v33, v105
    v_fmac_f32 v197, v34, v106
    v_fmac_f32 v197, v35, v107
    v_fmac_f32 v197, v36, v108
    v_fmac_f32 v197, v37, v109
    s_add_u32 m0, s21, 4096
    v_mfma_f32_32x32x16_bf16 v[16:31], v[76:79], v[176:179], 0
    buffer_load_dwordx4 v234, s[4:7], s37 offen  lds
    buffer_load_dwordx4 v235, s[8:11], s37 offen offset:1024  lds
    ds_read_b64_tr_b16 v[176:177], v244 offset:6144
    ds_read_b64_tr_b16 v[178:179], v244 offset:7168
    ds_read_b64_tr_b16 v[184:185], v245 offset:6144
    ds_read_b64_tr_b16 v[186:187], v245 offset:7168
    v_add_u32 v252, s42, v247
    ds_read2_b32 v[234:235], v252 offset0:0 offset1:16
    v_fmac_f32 v197, v38, v110
    v_fmac_f32 v197, v39, v111
    v_mul_f32 v199, v40, v136
    v_fmac_f32 v199, v41, v137
    v_fmac_f32 v199, v42, v138
    v_fmac_f32 v199, v43, v139
    v_fmac_f32 v199, v44, v140
    v_fmac_f32 v199, v45, v141
    v_fmac_f32 v199, v46, v142
    v_fmac_f32 v199, v47, v143
    v_mul_f32 v201, v0, v136
    v_fmac_f32 v201, v1, v137
    v_permlane32_swap_b32 v197, v199
    v_fmac_f32 v201, v2, v138
    v_fmac_f32 v201, v3, v139
    v_fmac_f32 v201, v4, v140
    v_fmac_f32 v201, v5, v141
    v_fmac_f32 v201, v6, v142
    v_fmac_f32 v201, v7, v143
    v_add_f32 v199, v197, v199
    v_mul_f32_e64 v203, v8, -v136
    v_fma_f32 v203, v9, -v137, v203
    v_fma_f32 v203, v10, -v138, v203
    v_fma_f32 v203, v11, -v139, v203
    s_waitcnt lgkmcnt(1)
    v_mfma_f32_32x32x16_bf16 v[56:71], v[80:83], v[176:179], v[56:71]
    v_fma_f32 v203, v12, -v140, v203
    v_fma_f32 v203, v13, -v141, v203
    v_fma_f32 v203, v14, -v142, v203
    v_fma_f32 v203, v15, -v143, v203
    s_nop 1
    v_permlane32_swap_b32 v201, v203
    v_add_f32 v203, v201, v203
    s_add_u32 m0, s21, 6144
    v_mfma_f32_32x32x16_bf16 v[16:31], v[84:87], v[176:179], v[16:31]
    buffer_load_dwordx4 v236, s[4:7], s37 offen  lds
    buffer_load_dwordx4 v237, s[8:11], s37 offen offset:1024  lds
    v_add_u32 v252, s43, v247
    ds_read2_b32 v[236:237], v252 offset0:0 offset1:16
    v_cvt_pk_bf16_f32 v192, v198, v199
    v_cvt_pk_bf16_f32 v193, v202, v203
    v_mfma_f32_32x32x16_bf16 v[32:47], v[72:75], v[180:183], 0
    v_mul_f32 v196, v56, v144
    v_fmac_f32 v196, v57, v145
    v_fmac_f32 v196, v58, v146
    v_fmac_f32 v196, v59, v147
    v_fmac_f32 v196, v60, v148
    v_fmac_f32 v196, v61, v149
    v_mfma_f32_32x32x16_bf16 v[0:15], v[76:79], v[180:183], 0
    s_waitcnt vmcnt(6)
    ds_read_b64_tr_b16 v[176:177], v244 offset:0
    ds_read_b64_tr_b16 v[178:179], v244 offset:1024
    ds_read_b64_tr_b16 v[180:181], v245 offset:0
    ds_read_b64_tr_b16 v[182:183], v245 offset:1024
    v_fmac_f32 v196, v62, v150
    v_fmac_f32 v196, v63, v151
    v_mfma_f32_32x32x16_bf16 v[32:47], v[80:83], v[184:187], v[32:47]
    v_mul_f32_e64 v200, v16, -v160
    v_fma_f32 v200, v17, -v161, v200
    v_fma_f32 v200, v18, -v162, v200
    v_fma_f32 v200, v19, -v163, v200
    v_fma_f32 v200, v20, -v164, v200
    v_fma_f32 v200, v21, -v165, v200
    v_mfma_f32_32x32x16_bf16 v[0:15], v[84:87], v[184:187], v[0:15]
    v_fma_f32 v200, v22, -v166, v200
    v_fma_f32 v200, v23, -v167, v200
    v_mul_f32_e64 v202, v24, -v160
    v_fma_f32 v202, v25, -v161, v202
    v_fma_f32 v202, v26, -v162, v202
    v_fma_f32 v202, v27, -v163, v202
    v_fma_f32 v202, v28, -v164, v202
    v_fma_f32 v202, v29, -v165, v202
    v_fma_f32 v202, v30, -v166, v202
    v_fma_f32 v202, v31, -v167, v202
    s_waitcnt vmcnt(4) lgkmcnt(0)
    v_mfma_f32_32x32x16_bf16 v[16:31], v[72:75], v[176:179], 0
    v_mul_f32 v197, v32, v152
    v_fmac_f32 v197, v33, v153
    v_fmac_f32 v197, v34, v154
    v_fmac_f32 v197, v35, v155
    v_fmac_f32 v197, v36, v156
    v_fmac_f32 v197, v37, v157
    s_add_u32 m0, s21, 0
    v_mfma_f32_32x32x16_bf16 v[48:63], v[76:79], v[176:179], 0
    s_cbranch_vccnz WL_4_0
    v_mad_u32_u16 v234, v234, s3, v246 op_sel:[1,0,0,0]
    v_mad_u32_u16 v235, v235, s3, v246 op_sel:[1,0,0,0]
    buffer_load_dwordx4 v234, s[4:7], s38 offen  lds
    buffer_load_dwordx4 v235, s[8:11], s38 offen offset:1024  lds
WR_4_0:
    ds_read_b64_tr_b16 v[176:177], v244 offset:2048
    ds_read_b64_tr_b16 v[178:179], v244 offset:3072
    ds_read_b64_tr_b16 v[184:185], v245 offset:2048
    ds_read_b64_tr_b16 v[186:187], v245 offset:3072
    v_fmac_f32 v197, v38, v158
    v_fmac_f32 v197, v39, v159
    v_mul_f32_e64 v201, v0, -v168
    v_fma_f32 v201, v1, -v169, v201
    v_fma_f32 v201, v2, -v170, v201
    v_fma_f32 v201, v3, -v171, v201
    v_fma_f32 v201, v4, -v172, v201
    v_fma_f32 v201, v5, -v173, v201
    v_fma_f32 v201, v6, -v174, v201
    v_fma_f32 v201, v7, -v175, v201
    s_waitcnt lgkmcnt(0)
    v_mfma_f32_32x32x16_bf16 v[16:31], v[80:83], v[176:179], v[16:31]
    v_mul_f32_e64 v203, v8, -v168
    v_fma_f32 v203, v9, -v169, v203
    v_fma_f32 v203, v10, -v170, v203
    v_fma_f32 v203, v11, -v171, v203
    v_fma_f32 v203, v12, -v172, v203
    v_fma_f32 v203, v13, -v173, v203
    s_add_u32 m0, s21, 2048
    v_mfma_f32_32x32x16_bf16 v[48:63], v[84:87], v[176:179], v[48:63]
    s_cbranch_vccnz WL_4_1
    v_mad_u32_u16 v236, v236, s3, v246 op_sel:[1,0,0,0]
    v_mad_u32_u16 v237, v237, s3, v246 op_sel:[1,0,0,0]
    buffer_load_dwordx4 v236, s[4:7], s39 offen  lds
    buffer_load_dwordx4 v237, s[8:11], s39 offen offset:1024  lds
WR_4_1:
    v_fma_f32 v203, v14, -v174, v203
    v_fma_f32 v203, v15, -v175, v203
    v_mfma_f32_32x32x16_bf16 v[0:15], v[72:75], v[180:183], 0
    v_fmac_f32 v200, v24, v160
    v_fmac_f32 v200, v25, v161
    v_fmac_f32 v200, v26, v162
    v_fmac_f32 v200, v27, v163
    v_fmac_f32 v200, v28, v164
    v_fmac_f32 v200, v29, v165
    v_fmac_f32 v200, v30, v166
    v_fmac_f32 v200, v31, v167
    v_mfma_f32_32x32x16_bf16 v[24:39], v[76:79], v[180:183], 0
    s_waitcnt vmcnt(6)
    ds_read_b64_tr_b16 v[176:177], v244 offset:4096
    ds_read_b64_tr_b16 v[178:179], v244 offset:5120
    ds_read_b64_tr_b16 v[180:181], v245 offset:4096
    ds_read_b64_tr_b16 v[182:183], v245 offset:5120
    v_mul_f32 v254, v16, v144
    v_fmac_f32 v254, v17, v145
    v_mfma_f32_32x32x16_bf16 v[24:39], v[84:87], v[184:187], v[24:39]
    v_fmac_f32 v254, v18, v146
    v_fmac_f32 v254, v19, v147
    v_fmac_f32 v254, v20, v148
    v_fmac_f32 v254, v21, v149
    v_fmac_f32 v254, v22, v150
    v_fmac_f32 v254, v23, v151
    v_mfma_f32_32x32x16_bf16 v[0:15], v[80:83], v[184:187], v[0:15]
    v_sub_f32_e64 v64, -v48, v64
    v_sub_f32_e64 v65, -v49, v65
    v_permlane32_swap_b32 v196, v254
    v_sub_f32_e64 v66, -v50, v66
    v_sub_f32_e64 v67, -v51, v67
    v_sub_f32_e64 v68, -v52, v68
    v_sub_f32_e64 v69, -v53, v69
    v_sub_f32_e64 v70, -v54, v70
    v_sub_f32_e64 v71, -v55, v71
    v_add_f32 v254, v196, v254
    s_waitcnt vmcnt(4) lgkmcnt(0)
    v_mfma_f32_32x32x16_bf16 v[56:71], v[76:79], v[176:179], v[56:71]
    v_sub_f32_e64 v40, -v24, v40
    v_sub_f32_e64 v41, -v25, v41
    v_sub_f32_e64 v42, -v26, v42
    v_sub_f32_e64 v43, -v27, v43
    v_sub_f32_e64 v44, -v28, v44
    v_sub_f32_e64 v45, -v29, v45
    v_sub_f32_e64 v46, -v30, v46
    v_sub_f32_e64 v47, -v31, v47
    s_add_u32 m0, s21, 4096
    v_mfma_f32_32x32x16_bf16 v[16:31], v[72:75], v[176:179], 0
    s_cbranch_vccnz WL_4_2
    v_mad_u32_u16 v238, v238, s3, v246 op_sel:[1,0,0,0]
    v_mad_u32_u16 v239, v239, s3, v246 op_sel:[1,0,0,0]
    buffer_load_dwordx4 v238, s[4:7], s40 offen  lds
    buffer_load_dwordx4 v239, s[8:11], s40 offen offset:1024  lds
WR_4_2:
    ds_read_b64_tr_b16 v[176:177], v244 offset:6144
    ds_read_b64_tr_b16 v[178:179], v244 offset:7168
    ds_read_b64_tr_b16 v[184:185], v245 offset:6144
    ds_read_b64_tr_b16 v[186:187], v245 offset:7168
    v_mul_f32 v255, v0, v152
    v_fmac_f32 v255, v1, v153
    v_fmac_f32 v255, v2, v154
    v_fmac_f32 v255, v3, v155
    v_fmac_f32 v255, v4, v156
    v_fmac_f32 v255, v5, v157
    v_fmac_f32 v255, v6, v158
    v_fmac_f32 v255, v7, v159
    v_fmac_f32 v201, v8, v168
    v_fmac_f32 v201, v9, v169
    v_permlane32_swap_b32 v197, v255
    s_waitcnt lgkmcnt(0)
    v_mfma_f32_32x32x16_bf16 v[16:31], v[80:83], v[176:179], v[16:31]
    v_fmac_f32 v201, v10, v170
    v_fmac_f32 v201, v11, v171
    v_fmac_f32 v201, v12, v172
    v_fmac_f32 v201, v13, v173
    v_fmac_f32 v201, v14, v174
    v_fmac_f32 v201, v15, v175
    s_add_u32 m0, s21, 6144
    v_mfma_f32_32x32x16_bf16 v[56:71], v[84:87], v[176:179], v[56:71]
    s_cbranch_vccnz WL_4_3
    v_mad_u32_u16 v240, v240, s3, v246 op_sel:[1,0,0,0]
    v_mad_u32_u16 v241, v241, s3, v246 op_sel:[1,0,0,0]
    buffer_load_dwordx4 v240, s[4:7], s41 offen  lds
    buffer_load_dwordx4 v241, s[8:11], s41 offen offset:1024  lds
WR_4_3:
    v_add_f32 v255, v197, v255
    v_cvt_pk_bf16_f32 v194, v254, v255
    v_mfma_f32_32x32x16_bf16 v[0:15], v[72:75], v[180:183], 0
    v_mul_f32 v254, v16, v144
    v_fmac_f32 v254, v17, v145
    v_fmac_f32 v254, v18, v146
    v_fmac_f32 v254, v19, v147
    v_fmac_f32 v254, v20, v148
    v_fmac_f32 v254, v21, v149
    v_mfma_f32_32x32x16_bf16 v[32:47], v[76:79], v[180:183], v[32:47]
    s_waitcnt vmcnt(6)
    ds_read_b64_tr_b16 v[176:177], v244 offset:0
    ds_read_b64_tr_b16 v[178:179], v244 offset:1024
    ds_read_b64_tr_b16 v[180:181], v245 offset:0
    ds_read_b64_tr_b16 v[182:183], v245 offset:1024
    v_fmac_f32 v254, v22, v150
    v_fmac_f32 v254, v23, v151
    v_mfma_f32_32x32x16_bf16 v[0:15], v[80:83], v[184:187], v[0:15]
    v_fma_f32 v202, v24, -v160, v202
    v_fma_f32 v202, v25, -v161, v202
    v_permlane32_swap_b32 v254, v200
    v_fma_f32 v202, v26, -v162, v202
    v_fma_f32 v202, v27, -v163, v202
    v_fma_f32 v202, v28, -v164, v202
    v_mfma_f32_32x32x16_bf16 v[32:47], v[84:87], v[184:187], v[32:47]
    v_add_u32 v249, s48, v249
    v_add_u32 v250, s49, v250
    ds_read_b32 v252, v251 offset:16
    ds_read_b64_tr_b16 v[72:73], v249 offset:0
    ds_read_b64_tr_b16 v[76:77], v249 offset:64
    ds_read_b64_tr_b16 v[74:75], v249 offset:256
    ds_read_b64_tr_b16 v[78:79], v249 offset:320
    s_mov_b64 exec, s[54:55]
    ds_read_u16_d16_hi v242, v250 offset:0
    s_mov_b64 exec, -1
    v_fma_f32 v202, v29, -v165, v202
    v_fma_f32 v202, v30, -v166, v202
    v_fma_f32 v202, v31, -v167, v202
    v_add_f32 v200, v254, v200
    v_mul_f32_e64 v198, v64, -v112
    v_permlane32_swap_b32 v202, v254
    v_fma_f32 v198, v65, -v113, v198
    v_fma_f32 v198, v66, -v114, v198
    v_fma_f32 v198, v67, -v115, v198
    v_fma_f32 v198, v68, -v116, v198
    v_fma_f32 v198, v69, -v117, v198
    v_fma_f32 v198, v70, -v118, v198
    v_fma_f32 v198, v71, -v119, v198
    v_add_f32 v254, v202, v254
    v_mul_f32 v196, v56, v160
    v_fmac_f32 v196, v57, v161
    v_fmac_f32 v196, v58, v162
    v_fmac_f32 v196, v59, v163
    v_fmac_f32 v196, v60, v164
    v_fmac_f32 v196, v61, v165
    v_fmac_f32 v196, v62, v166
    v_fmac_f32 v196, v63, v167
    s_nop 1
    v_permlane32_swap_b32 v198, v196
    v_add_f32 v196, v198, v196
    s_cbranch_vccnz LEPI_0
    v_mul_f32 v255, v0, v152
    v_fmac_f32 v255, v1, v153
    v_fmac_f32 v255, v2, v154
    v_fmac_f32 v255, v3, v155
    v_fmac_f32 v255, v4, v156
    v_fmac_f32 v255, v5, v157
    v_fmac_f32 v255, v6, v158
    v_fmac_f32 v255, v7, v159
    v_fma_f32 v203, v8, -v168, v203
    v_fma_f32 v203, v9, -v169, v203
    v_permlane32_swap_b32 v255, v201
    v_fma_f32 v203, v10, -v170, v203
    v_fma_f32 v203, v11, -v171, v203
    v_fma_f32 v203, v12, -v172, v203
    v_fma_f32 v203, v13, -v173, v203
    v_fma_f32 v203, v14, -v174, v203
    v_fma_f32 v203, v15, -v175, v203
    v_add_f32 v201, v255, v201
    v_mul_f32_e64 v199, v40, -v120
    v_permlane32_swap_b32 v203, v255
    v_fma_f32 v199, v41, -v121, v199
    v_fma_f32 v199, v42, -v122, v199
    v_fma_f32 v199, v43, -v123, v199
    v_fma_f32 v199, v44, -v124, v199
    v_fma_f32 v199, v45, -v125, v199
    v_fma_f32 v199, v46, -v126, v199
    v_fma_f32 v199, v47, -v127, v199
    v_add_f32 v255, v203, v255
    v_mul_f32 v197, v32, v168
    v_fmac_f32 v197, v33, v169
    v_fmac_f32 v197, v34, v170
    v_fmac_f32 v197, v35, v171
    v_fmac_f32 v197, v36, v172
    v_fmac_f32 v197, v37, v173
    v_fmac_f32 v197, v38, v174
    v_fmac_f32 v197, v39, v175
    s_nop 1
    v_permlane32_swap_b32 v199, v197
    v_add_f32 v197, v199, v197
    v_cvt_pk_bf16_f32 v200, v200, v201
    v_cvt_pk_bf16_f32 v254, v254, v255
    v_cvt_pk_bf16_f32 v196, v196, v197
    ds_write2st64_b32 v253, v192, v193 offset0:0 offset1:1
    ds_write2st64_b32 v253, v194, v200 offset0:2 offset1:3
    ds_write_b32 v253, v196 offset:1024
    s_mov_b64 exec, 0xffffffff
    ds_write_b32 v253, v254 offset:1280
    s_mov_b64 exec, -1
    s_add_u32 s50, s50, 1
    s_cmp_ge_u32 s50, 4
    s_cbranch_scc1 LAST1
    s_waitcnt lgkmcnt(9)
    v_readfirstlane_b32 s66, v252
    s_add_u32 s53, s53, 1
    v_mov_b32 v252, s53
    s_cmp_le_u32 s53, s66
    ds_write2_b32 v251, v252, v252 offset0:0 offset1:8
    s_setprio 1
    s_cbranch_scc1 PRIO_11
    s_setprio 0
PRIO_11:
    s_cmp_eq_u32 s52, 4
    s_cbranch_scc1 ITEM_1_4
    s_cmp_eq_u32 s52, 5
    s_cbranch_scc1 ITEM_1_5
    s_cmp_eq_u32 s52, 3
    s_cbranch_scc1 ITEM_1_3
    s_cmp_eq_u32 s52, 6
    s_cbranch_scc1 ITEM_1_6
    s_cmp_eq_u32 s52, 8
    s_cbranch_scc1 ITEM_1_8
    s_branch ITEM_1_2
WL_4_0:
    s_add_u32 s66, s51, 0
    buffer_load_dwordx4 v[96:99], v246, s[16:19], s66 offen offset:2048 sc1
    buffer_load_dwordx4 v[100:103], v246, s[16:19], s66 offen offset:3072 sc1
    s_branch WR_4_0
WL_4_1:
    s_add_u32 s66, s51, 4096
    buffer_load_dwordx4 v[104:107], v246, s[16:19], s66 offen offset:2048 sc1
    buffer_load_dwordx4 v[108:111], v246, s[16:19], s66 offen offset:3072 sc1
    s_branch WR_4_1
WL_4_2:
    s_add_u32 s66, s51, 8192
    buffer_load_dwordx4 v[128:131], v246, s[16:19], s66 offen offset:2048 sc1
    buffer_load_dwordx4 v[132:135], v246, s[16:19], s66 offen offset:3072 sc1
    s_branch WR_4_2
WL_4_3:
    s_add_u32 s66, s51, 12288
    buffer_load_dwordx4 v[136:139], v246, s[16:19], s66 offen offset:2048 sc1
    buffer_load_dwordx4 v[140:143], v246, s[16:19], s66 offen offset:3072 sc1
    s_branch WR_4_3
.p2align 6
ITEM_1_5:
    s_mov_b64 exec, s[54:55]
    ds_read_u16_d16_hi v243, v250 offset:128
    s_mov_b64 exec, -1
    ds_read_b64_tr_b16 v[80:81], v249 offset:512
    ds_read_b64_tr_b16 v[84:85], v249 offset:576
    ds_read_b64_tr_b16 v[82:83], v249 offset:768
    ds_read_b64_tr_b16 v[86:87], v249 offset:832
    ds_read_b64_tr_b16 v[88:89], v249 offset:1024
    ds_read_b64_tr_b16 v[92:93], v249 offset:1088
    s_waitcnt lgkmcnt(7)
    v_mul_f32_dpp v196, v242, v72 row_newbcast:0 row_mask:0xf bank_mask:0xf
    v_mul_f32_dpp v197, v242, v73 row_newbcast:1 row_mask:0xf bank_mask:0xf
    v_mul_f32_dpp v198, v242, v72 row_newbcast:8 row_mask:0xf bank_mask:0xf
    v_mul_f32_dpp v199, v242, v73 row_newbcast:9 row_mask:0xf bank_mask:0xf
    v_mul_f32_dpp v200, v242, v76 row_newbcast:2 row_mask:0xf bank_mask:0xf
    v_mul_f32_dpp v201, v242, v77 row_newbcast:3 row_mask:0xf bank_mask:0xf
    v_mul_f32_dpp v202, v242, v76 row_newbcast:10 row_mask:0xf bank_mask:0xf
    v_mul_f32_dpp v203, v242, v77 row_newbcast:11 row_mask:0xf bank_mask:0xf
    v_cvt_pk_bf16_f32 v72, v196, v197
    v_cvt_pk_bf16_f32 v76, v198, v199
    v_cvt_pk_bf16_f32 v73, v200, v201
    v_cvt_pk_bf16_f32 v77, v202, v203
    v_mul_f32_dpp v196, v242, v74 row_newbcast:4 row_mask:0xf bank_mask:0xf
    v_mul_f32_dpp v197, v242, v75 row_newbcast:5 row_mask:0xf bank_mask:0xf
    v_mul_f32_dpp v198, v242, v74 row_newbcast:12 row_mask:0xf bank_mask:0xf
    v_mul_f32_dpp v199, v242, v75 row_newbcast:13 row_mask:0xf bank_mask:0xf
    v_mul_f32_dpp v200, v242, v78 row_newbcast:6 row_mask:0xf bank_mask:0xf
    v_mul_f32_dpp v201, v242, v79 row_newbcast:7 row_mask:0xf bank_mask:0xf
    v_mul_f32_dpp v202, v242, v78 row_newbcast:14 row_mask:0xf bank_mask:0xf
    v_mul_f32_dpp v203, v242, v79 row_newbcast:15 row_mask:0xf bank_mask:0xf
    v_cvt_pk_bf16_f32 v74, v196, v197
    v_cvt_pk_bf16_f32 v78, v198, v199
    v_cvt_pk_bf16_f32 v75, v200, v201
    v_cvt_pk_bf16_f32 v79, v202, v203
    s_mov_b64 exec, s[54:55]
    ds_read_u16_d16_hi v242, v250 offset:256
    s_mov_b64 exec, -1
    s_waitcnt vmcnt(4) lgkmcnt(3)
    v_mfma_f32_32x32x16_bf16 v[56:71], v[72:75], v[176:179], 0
    v_mul_f32_dpp v196, v243, v80 row_newbcast:0 row_mask:0xf bank_mask:0xf
    v_mul_f32_dpp v197, v243, v81 row_newbcast:1 row_mask:0xf bank_mask:0xf
    v_mul_f32_dpp v198, v243, v80 row_newbcast:8 row_mask:0xf bank_mask:0xf
    v_mul_f32_dpp v199, v243, v81 row_newbcast:9 row_mask:0xf bank_mask:0xf
    v_mul_f32_dpp v200, v243, v84 row_newbcast:2 row_mask:0xf bank_mask:0xf
    v_mul_f32_dpp v201, v243, v85 row_newbcast:3 row_mask:0xf bank_mask:0xf
    s_add_u32 m0, s21, 0
    v_mfma_f32_32x32x16_bf16 v[16:31], v[76:79], v[176:179], 0
    buffer_load_dwordx4 v236, s[4:7], s35 offen  lds
    buffer_load_dwordx4 v237, s[8:11], s35 offen offset:1024  lds
    ds_read_b64_tr_b16 v[176:177], v244 offset:2048
    ds_read_b64_tr_b16 v[178:179], v244 offset:3072
    ds_read_b64_tr_b16 v[184:185], v245 offset:2048
    ds_read_b64_tr_b16 v[186:187], v245 offset:3072
    v_mul_f32_dpp v202, v243, v84 row_newbcast:10 row_mask:0xf bank_mask:0xf
    v_mul_f32_dpp v203, v243, v85 row_newbcast:11 row_mask:0xf bank_mask:0xf
    v_cvt_pk_bf16_f32 v80, v196, v197
    v_cvt_pk_bf16_f32 v84, v198, v199
    v_cvt_pk_bf16_f32 v81, v200, v201
    v_cvt_pk_bf16_f32 v85, v202, v203
    v_mul_f32_dpp v196, v243, v82 row_newbcast:4 row_mask:0xf bank_mask:0xf
    v_mul_f32_dpp v197, v243, v83 row_newbcast:5 row_mask:0xf bank_mask:0xf
    v_mul_f32_dpp v198, v243, v82 row_newbcast:12 row_mask:0xf bank_mask:0xf
    v_mul_f32_dpp v199, v243, v83 row_newbcast:13 row_mask:0xf bank_mask:0xf
    v_mul_f32_dpp v200, v243, v86 row_newbcast:6 row_mask:0xf bank_mask:0xf
    v_mul_f32_dpp v201, v243, v87 row_newbcast:7 row_mask:0xf bank_mask:0xf
    v_mul_f32_dpp v202, v243, v86 row_newbcast:14 row_mask:0xf bank_mask:0xf
    v_mul_f32_dpp v203, v243, v87 row_newbcast:15 row_mask:0xf bank_mask:0xf
    v_cvt_pk_bf16_f32 v82, v196, v197
    v_cvt_pk_bf16_f32 v86, v198, v199
    v_cvt_pk_bf16_f32 v83, v200, v201
    v_cvt_pk_bf16_f32 v87, v202, v203
    s_waitcnt vmcnt(4) lgkmcnt(0)
    v_mfma_f32_32x32x16_bf16 v[56:71], v[80:83], v[176:179], v[56:71]
    v_mul_f32_dpp v196, v242, v88 row_newbcast:0 row_mask:0xf bank_mask:0xf
    v_mul_f32_dpp v197, v242, v89 row_newbcast:1 row_mask:0xf bank_mask:0xf
    v_mul_f32_dpp v198, v242, v88 row_newbcast:8 row_mask:0xf bank_mask:0xf
    v_mul_f32_dpp v199, v242, v89 row_newbcast:9 row_mask:0xf bank_mask:0xf
    v_mul_f32_dpp v200, v242, v92 row_newbcast:2 row_mask:0xf bank_mask:0xf
    v_mul_f32_dpp v201, v242, v93 row_newbcast:3 row_mask:0xf bank_mask:0xf
    s_add_u32 m0, s21, 2048
    v_mfma_f32_32x32x16_bf16 v[16:31], v[84:87], v[176:179], v[16:31]
    buffer_load_dwordx4 v238, s[4:7], s35 offen  lds
    ds_read_b64_tr_b16 v[176:177], v244 offset:4096
    ds_read_b64_tr_b16 v[188:189], v245 offset:4096
    v_mul_f32_dpp v202, v242, v92 row_newbcast:10 row_mask:0xf bank_mask:0xf
    v_mul_f32_dpp v203, v242, v93 row_newbcast:11 row_mask:0xf bank_mask:0xf
    v_cvt_pk_bf16_f32 v88, v196, v197
    v_cvt_pk_bf16_f32 v92, v198, v199
    v_cvt_pk_bf16_f32 v89, v200, v201
    v_cvt_pk_bf16_f32 v93, v202, v203
    s_waitcnt lgkmcnt(0)
    v_mfma_f32_32x32x8_bf16 v[56:71], v[88:89], v[176:177], v[56:71]
    s_add_u32 m0, s21, 4096
    v_mfma_f32_32x32x8_bf16 v[16:31], v[92:93], v[176:177], v[16:31]
    buffer_load_dwordx4 v234, s[4:7], s36 offen  lds
    buffer_load_dwordx4 v235, s[8:11], s36 offen offset:1024  lds
    s_mov_b32 m0, s50
    s_nop 0
    s_movrels_b32 s71, s23
    s_movrels_b32 s33, s28
    v_add_u32 v253, s33, v248
    s_bfe_u32 s46, s71, 0x30012
    s_mov_b32 m0, s46
    s_and_b32 s66, s71, 0x3ffff
    s_movrels_b32 s68, s57
    s_movrels_b32 s69, s61
    s_sub_u32 s48, s66, s47
    s_mov_b32 s47, s66
    s_lshr_b32 s52, s71, 28
    s_lshl_b32 s67, s46, 9
    s_add_u32 s66, s66, s67
    s_sub_u32 s49, s66, s42
    s_mov_b32 s42, s66
    s_bfe_u32 s66, s68, 655360
    s_add_u32 s43, s42, s66
    s_bfe_u32 s39, s69, 655360
    s_bfe_u32 s66, s68, 655370
    s_add_u32 s44, s42, s66
    s_bfe_u32 s40, s69, 655370
    s_bfe_u32 s66, s68, 655380
    s_add_u32 s45, s42, s66
    s_bfe_u32 s41, s69, 655380
    v_add_u32 v252, s45, v247
    ds_read2_b32 v[240:241], v252 offset0:0 offset1:16
    v_mfma_f32_32x32x16_bf16 v[32:47], v[72:75], v[180:183], 0
    v_mul_f32 v196, v56, v96
    v_fmac_f32 v196, v57, v97
    v_fmac_f32 v196, v58, v98
    v_fmac_f32 v196, v59, v99
    v_fmac_f32 v196, v60, v100
    v_fmac_f32 v196, v61, v101
    v_mfma_f32_32x32x16_bf16 v[0:15], v[76:79], v[180:183], 0
    v_fmac_f32 v196, v62, v102
    v_fmac_f32 v196, v63, v103
    v_mul_f32 v198, v64, v128
    v_fmac_f32 v198, v65, v129
    v_fmac_f32 v198, v66, v130
    v_fmac_f32 v198, v67, v131
    v_mfma_f32_32x32x16_bf16 v[32:47], v[80:83], v[184:187], v[32:47]
    v_fmac_f32 v198, v68, v132
    v_fmac_f32 v198, v69, v133
    v_fmac_f32 v198, v70, v134
    v_fmac_f32 v198, v71, v135
    v_mul_f32 v200, v16, v128
    v_fmac_f32 v200, v17, v129
    v_mfma_f32_32x32x16_bf16 v[0:15], v[84:87], v[184:187], v[0:15]
    s_waitcnt vmcnt(5)
    ds_read_b64_tr_b16 v[176:177], v244 offset:6144
    ds_read_b64_tr_b16 v[178:179], v244 offset:7168
    ds_read_b64_tr_b16 v[180:181], v245 offset:6144
    ds_read_b64_tr_b16 v[182:183], v245 offset:7168
    v_permlane32_swap_b32 v196, v198
    v_fmac_f32 v200, v18, v130
    v_mfma_f32_32x32x8_bf16 v[32:47], v[88:89], v[188:189], v[32:47]
    v_fmac_f32 v200, v19, v131
    v_fmac_f32 v200, v20, v132
    v_fmac_f32 v200, v21, v133
    v_fmac_f32 v200, v22, v134
    v_fmac_f32 v200, v23, v135
    v_add_f32 v198, v196, v198
    v_mfma_f32_32x32x8_bf16 v[0:15], v[92:93], v[188:189], v[0:15]
    v_mul_f32_e64 v202, v24, -v128
    v_fma_f32 v202, v25, -v129, v202
    v_fma_f32 v202, v26, -v130, v202
    v_fma_f32 v202, v27, -v131, v202
    v_fma_f32 v202, v28, -v132, v202
    v_fma_f32 v202, v29, -v133, v202
    v_fma_f32 v202, v30, -v134, v202
    v_fma_f32 v202, v31, -v135, v202
    s_nop 1
    v_permlane32_swap_b32 v200, v202
    v_add_f32 v202, v200, v202
    s_waitcnt vmcnt(3) lgkmcnt(0)
    v_mfma_f32_32x32x16_bf16 v[56:71], v[72:75], v[176:179], 0
    v_mul_f32 v197, v32, v104
    v_fmac_f32 v197, v33, v105
    v_fmac_f32 v197, v34, v106
    v_fmac_f32 v197, v35, v107
    v_fmac_f32 v197, v36, v108
    v_fmac_f32 v197, v37, v109
    s_add_u32 m0, s21, 6144
    v_mfma_f32_32x32x16_bf16 v[16:31], v[76:79], v[176:179], 0
    buffer_load_dwordx4 v236, s[4:7], s36 offen  lds
    buffer_load_dwordx4 v237, s[8:11], s36 offen offset:1024  lds
    ds_read_b64_tr_b16 v[176:177], v244 offset:0
    ds_read_b64_tr_b16 v[178:179], v244 offset:1024
    ds_read_b64_tr_b16 v[184:185], v245 offset:0
    ds_read_b64_tr_b16 v[186:187], v245 offset:1024
    v_fmac_f32 v197, v38, v110
    v_fmac_f32 v197, v39, v111
    v_mul_f32 v199, v40, v136
    v_fmac_f32 v199, v41, v137
    v_fmac_f32 v199, v42, v138
    v_fmac_f32 v199, v43, v139
    v_fmac_f32 v199, v44, v140
    v_fmac_f32 v199, v45, v141
    v_fmac_f32 v199, v46, v142
    v_fmac_f32 v199, v47, v143
    v_mul_f32 v201, v0, v136
    v_fmac_f32 v201, v1, v137
    v_permlane32_swap_b32 v197, v199
    v_fmac_f32 v201, v2, v138
    v_fmac_f32 v201, v3, v139
    s_waitcnt vmcnt(4) lgkmcnt(0)
    v_mfma_f32_32x32x16_bf16 v[56:71], v[80:83], v[176:179], v[56:71]
    v_fmac_f32 v201, v4, v140
    v_fmac_f32 v201, v5, v141
    v_fmac_f32 v201, v6, v142
    v_fmac_f32 v201, v7, v143
    v_add_f32 v199, v197, v199
    v_mul_f32_e64 v203, v8, -v136
    s_add_u32 m0, s21, 0
    v_mfma_f32_32x32x16_bf16 v[16:31], v[84:87], v[176:179], v[16:31]
    buffer_load_dwordx4 v238, s[4:7], s36 offen  lds
    ds_read_b64_tr_b16 v[176:177], v244 offset:2048
    ds_read_b64_tr_b16 v[188:189], v245 offset:2048
    v_fma_f32 v203, v9, -v137, v203
    v_fma_f32 v203, v10, -v138, v203
    v_fma_f32 v203, v11, -v139, v203
    s_waitcnt lgkmcnt(0)
    v_mfma_f32_32x32x8_bf16 v[56:71], v[88:89], v[176:177], v[56:71]
    v_fma_f32 v203, v12, -v140, v203
    v_fma_f32 v203, v13, -v141, v203
    v_fma_f32 v203, v14, -v142, v203
    v_fma_f32 v203, v15, -v143, v203
    s_nop 1
    v_permlane32_swap_b32 v201, v203
    v_add_f32 v203, v201, v203
    s_add_u32 m0, s21, 2048
    v_mfma_f32_32x32x8_bf16 v[16:31], v[92:93], v[176:177], v[16:31]
    buffer_load_dwordx4 v234, s[4:7], s37 offen  lds
    buffer_load_dwordx4 v235, s[8:11], s37 offen offset:1024  lds
    v_add_u32 v252, s42, v247
    ds_read2_b32 v[234:235], v252 offset0:0 offset1:16
    v_cvt_pk_bf16_f32 v192, v198, v199
    v_cvt_pk_bf16_f32 v193, v202, v203
    v_mfma_f32_32x32x16_bf16 v[32:47], v[72:75], v[180:183], 0
    v_mul_f32 v196, v56, v144
    v_fmac_f32 v196, v57, v145
    v_fmac_f32 v196, v58, v146
    v_fmac_f32 v196, v59, v147
    v_fmac_f32 v196, v60, v148
    v_fmac_f32 v196, v61, v149
    v_mfma_f32_32x32x16_bf16 v[0:15], v[76:79], v[180:183], 0
    v_fmac_f32 v196, v62, v150
    v_fmac_f32 v196, v63, v151
    v_mul_f32_e64 v200, v16, -v160
    v_fma_f32 v200, v17, -v161, v200
    v_fma_f32 v200, v18, -v162, v200
    v_fma_f32 v200, v19, -v163, v200
    v_mfma_f32_32x32x16_bf16 v[32:47], v[80:83], v[184:187], v[32:47]
    v_fma_f32 v200, v20, -v164, v200
    v_fma_f32 v200, v21, -v165, v200
    v_fma_f32 v200, v22, -v166, v200
    v_fma_f32 v200, v23, -v167, v200
    v_mul_f32_e64 v202, v24, -v160
    v_fma_f32 v202, v25, -v161, v202
    v_mfma_f32_32x32x16_bf16 v[0:15], v[84:87], v[184:187], v[0:15]
    s_waitcnt vmcnt(5)
    ds_read_b64_tr_b16 v[176:177], v244 offset:4096
    ds_read_b64_tr_b16 v[178:179], v244 offset:5120
    ds_read_b64_tr_b16 v[180:181], v245 offset:4096
    ds_read_b64_tr_b16 v[182:183], v245 offset:5120
    v_fma_f32 v202, v26, -v162, v202
    v_fma_f32 v202, v27, -v163, v202
    v_mfma_f32_32x32x8_bf16 v[32:47], v[88:89], v[188:189], v[32:47]
    v_fma_f32 v202, v28, -v164, v202
    v_fma_f32 v202, v29, -v165, v202
    v_fma_f32 v202, v30, -v166, v202
    v_fma_f32 v202, v31, -v167, v202
    v_mfma_f32_32x32x8_bf16 v[0:15], v[92:93], v[188:189], v[0:15]
    s_waitcnt vmcnt(3) lgkmcnt(0)
    v_mfma_f32_32x32x16_bf16 v[16:31], v[72:75], v[176:179], 0
    s_nop 4
    v_mul_f32 v197, v32, v152
    v_fmac_f32 v197, v33, v153
    v_fmac_f32 v197, v34, v154
    v_fmac_f32 v197, v35, v155
    v_fmac_f32 v197, v36, v156
    v_fmac_f32 v197, v37, v157
    s_add_u32 m0, s21, 4096
    v_mfma_f32_32x32x16_bf16 v[48:63], v[76:79], v[176:179], 0
    buffer_load_dwordx4 v236, s[4:7], s37 offen  lds
    buffer_load_dwordx4 v237, s[8:11], s37 offen offset:1024  lds
    ds_read_b64_tr_b16 v[176:177], v244 offset:6144
    ds_read_b64_tr_b16 v[178:179], v244 offset:7168
    ds_read_b64_tr_b16 v[184:185], v245 offset:6144
    ds_read_b64_tr_b16 v[186:187], v245 offset:7168
    v_add_u32 v252, s43, v247
    ds_read2_b32 v[236:237], v252 offset0:0 offset1:16
    v_fmac_f32 v197, v38, v158
    v_fmac_f32 v197, v39, v159
    v_mul_f32_e64 v201, v0, -v168
    s_waitcnt vmcnt(4) lgkmcnt(1)
    v_mfma_f32_32x32x16_bf16 v[16:31], v[80:83], v[176:179], v[16:31]
    v_fma_f32 v201, v1, -v169, v201
    v_fma_f32 v201, v2, -v170, v201
    v_fma_f32 v201, v3, -v171, v201
    v_fma_f32 v201, v4, -v172, v201
    v_fma_f32 v201, v5, -v173, v201
    v_fma_f32 v201, v6, -v174, v201
    s_add_u32 m0, s21, 6144
    v_mfma_f32_32x32x16_bf16 v[48:63], v[84:87], v[176:179], v[48:63]
    buffer_load_dwordx4 v238, s[4:7], s37 offen  lds
    ds_read_b64_tr_b16 v[176:177], v244 offset:0
    ds_read_b64_tr_b16 v[188:189], v245 offset:0
    v_add_u32 v252, s44, v247
    ds_read2_b32 v[238:239], v252 offset0:0 offset1:16
    v_fma_f32 v201, v7, -v175, v201
    s_waitcnt lgkmcnt(1)
    v_mfma_f32_32x32x8_bf16 v[16:31], v[88:89], v[176:177], v[16:31]
    v_mul_f32_e64 v203, v8, -v168
    v_fma_f32 v203, v9, -v169, v203
    v_fma_f32 v203, v10, -v170, v203
    v_fma_f32 v203, v11, -v171, v203
    v_fma_f32 v203, v12, -v172, v203
    v_fma_f32 v203, v13, -v173, v203
    s_add_u32 m0, s21, 0
    v_mfma_f32_32x32x8_bf16 v[48:63], v[92:93], v[176:177], v[48:63]
    s_cbranch_vccnz WL_5_0
    v_mad_u32_u16 v234, v234, s3, v246 op_sel:[1,0,0,0]
    v_mad_u32_u16 v235, v235, s3, v246 op_sel:[1,0,0,0]
    buffer_load_dwordx4 v234, s[4:7], s38 offen  lds
    buffer_load_dwordx4 v235, s[8:11], s38 offen offset:1024  lds
WR_5_0:
    v_fma_f32 v203, v14, -v174, v203
    v_fma_f32 v203, v15, -v175, v203
    v_mfma_f32_32x32x16_bf16 v[0:15], v[72:75], v[180:183], 0
    v_fmac_f32 v200, v24, v160
    v_fmac_f32 v200, v25, v161
    v_fmac_f32 v200, v26, v162
    v_fmac_f32 v200, v27, v163
    v_fmac_f32 v200, v28, v164
    v_fmac_f32 v200, v29, v165
    v_fmac_f32 v200, v30, v166
    v_fmac_f32 v200, v31, v167
    v_mfma_f32_32x32x16_bf16 v[24:39], v[76:79], v[180:183], 0
    v_mul_f32 v254, v16, v144
    v_fmac_f32 v254, v17, v145
    v_fmac_f32 v254, v18, v146
    v_fmac_f32 v254, v19, v147
    v_fmac_f32 v254, v20, v148
    v_fmac_f32 v254, v21, v149
    v_mfma_f32_32x32x16_bf16 v[0:15], v[80:83], v[184:187], v[0:15]
    v_fmac_f32 v254, v22, v150
    v_fmac_f32 v254, v23, v151
    v_sub_f32_e64 v64, -v48, v64
    v_sub_f32_e64 v65, -v49, v65
    v_permlane32_swap_b32 v196, v254
    v_sub_f32_e64 v66, -v50, v66
    v_mfma_f32_32x32x16_bf16 v[24:39], v[84:87], v[184:187], v[24:39]
    s_waitcnt vmcnt(5)
    ds_read_b64_tr_b16 v[176:177], v244 offset:2048
    ds_read_b64_tr_b16 v[178:179], v244 offset:3072
    ds_read_b64_tr_b16 v[180:181], v245 offset:2048
    ds_read_b64_tr_b16 v[182:183], v245 offset:3072
    v_sub_f32_e64 v67, -v51, v67
    v_sub_f32_e64 v68, -v52, v68
    v_mfma_f32_32x32x8_bf16 v[24:39], v[92:93], v[188:189], v[24:39]
    v_sub_f32_e64 v69, -v53, v69
    v_sub_f32_e64 v70, -v54, v70
    v_sub_f32_e64 v71, -v55, v71
    v_add_f32 v254, v196, v254
    v_mfma_f32_32x32x8_bf16 v[0:15], v[88:89], v[188:189], v[0:15]
    s_waitcnt vmcnt(3) lgkmcnt(0)
    v_mfma_f32_32x32x16_bf16 v[56:71], v[76:79], v[176:179], v[56:71]
    s_nop 4
    v_sub_f32_e64 v40, -v24, v40
    v_sub_f32_e64 v41, -v25, v41
    v_sub_f32_e64 v42, -v26, v42
    v_sub_f32_e64 v43, -v27, v43
    v_sub_f32_e64 v44, -v28, v44
    v_sub_f32_e64 v45, -v29, v45
    v_sub_f32_e64 v46, -v30, v46
    v_sub_f32_e64 v47, -v31, v47
    s_add_u32 m0, s21, 2048
    v_mfma_f32_32x32x16_bf16 v[16:31], v[72:75], v[176:179], 0
    s_cbranch_vccnz WL_5_1
    v_mad_u32_u16 v236, v236, s3, v246 op_sel:[1,0,0,0]
    v_mad_u32_u16 v237, v237, s3, v246 op_sel:[1,0,0,0]
    buffer_load_dwordx4 v236, s[4:7], s39 offen  lds
    buffer_load_dwordx4 v237, s[8:11], s39 offen offset:1024  lds
WR_5_1:
    ds_read_b64_tr_b16 v[176:177], v244 offset:4096
    ds_read_b64_tr_b16 v[178:179], v244 offset:5120
    ds_read_b64_tr_b16 v[184:185], v245 offset:4096
    ds_read_b64_tr_b16 v[186:187], v245 offset:5120
    v_mul_f32 v255, v0, v152
    v_fmac_f32 v255, v1, v153
    v_fmac_f32 v255, v2, v154
    v_fmac_f32 v255, v3, v155
    v_fmac_f32 v255, v4, v156
    s_waitcnt vmcnt(4) lgkmcnt(0)
    v_mfma_f32_32x32x16_bf16 v[16:31], v[80:83], v[176:179], v[16:31]
    v_fmac_f32 v255, v5, v157
    v_fmac_f32 v255, v6, v158
    v_fmac_f32 v255, v7, v159
    v_fmac_f32 v201, v8, v168
    v_fmac_f32 v201, v9, v169
    v_permlane32_swap_b32 v197, v255
    s_add_u32 m0, s21, 4096
    v_mfma_f32_32x32x16_bf16 v[56:71], v[84:87], v[176:179], v[56:71]
    s_cbranch_vccnz WL_5_2
    v_mad_u32_u16 v238, v238, s3, v246 op_sel:[1,0,0,0]
    v_mad_u32_u16 v239, v239, s3, v246 op_sel:[1,0,0,0]
    buffer_load_dwordx4 v238, s[4:7], s40 offen  lds
    buffer_load_dwordx4 v239, s[8:11], s40 offen offset:1024  lds
WR_5_2:
    ds_read_b64_tr_b16 v[176:177], v244 offset:6144
    ds_read_b64_tr_b16 v[188:189], v245 offset:6144
    s_waitcnt lgkmcnt(0)
    v_mfma_f32_32x32x8_bf16 v[16:31], v[88:89], v[176:177], v[16:31]
    v_fmac_f32 v201, v10, v170
    v_fmac_f32 v201, v11, v171
    v_fmac_f32 v201, v12, v172
    v_fmac_f32 v201, v13, v173
    v_fmac_f32 v201, v14, v174
    v_fmac_f32 v201, v15, v175
    s_add_u32 m0, s21, 6144
    v_mfma_f32_32x32x8_bf16 v[56:71], v[92:93], v[176:177], v[56:71]
    s_cbranch_vccnz WL_5_3
    v_mad_u32_u16 v240, v240, s3, v246 op_sel:[1,0,0,0]
    v_mad_u32_u16 v241, v241, s3, v246 op_sel:[1,0,0,0]
    buffer_load_dwordx4 v240, s[4:7], s41 offen  lds
    buffer_load_dwordx4 v241, s[8:11], s41 offen offset:1024  lds
WR_5_3:
    v_add_f32 v255, v197, v255
    v_cvt_pk_bf16_f32 v194, v254, v255
    v_mfma_f32_32x32x16_bf16 v[0:15], v[72:75], v[180:183], 0
    v_mul_f32 v254, v16, v144
    v_fmac_f32 v254, v17, v145
    v_fmac_f32 v254, v18, v146
    v_fmac_f32 v254, v19, v147
    v_fmac_f32 v254, v20, v148
    v_fmac_f32 v254, v21, v149
    v_mfma_f32_32x32x16_bf16 v[32:47], v[76:79], v[180:183], v[32:47]
    v_fmac_f32 v254, v22, v150
    v_fmac_f32 v254, v23, v151
    v_fma_f32 v202, v24, -v160, v202
    v_fma_f32 v202, v25, -v161, v202
    v_permlane32_swap_b32 v254, v200
    v_fma_f32 v202, v26, -v162, v202
    v_mfma_f32_32x32x16_bf16 v[0:15], v[80:83], v[184:187], v[0:15]
    v_fma_f32 v202, v27, -v163, v202
    v_fma_f32 v202, v28, -v164, v202
    v_fma_f32 v202, v29, -v165, v202
    v_fma_f32 v202, v30, -v166, v202
    v_fma_f32 v202, v31, -v167, v202
    v_add_f32 v200, v254, v200
    v_mfma_f32_32x32x16_bf16 v[32:47], v[84:87], v[184:187], v[32:47]
    s_waitcnt vmcnt(6)
    ds_read_b64_tr_b16 v[176:177], v244 offset:0
    ds_read_b64_tr_b16 v[178:179], v244 offset:1024
    ds_read_b64_tr_b16 v[180:181], v245 offset:0
    ds_read_b64_tr_b16 v[182:183], v245 offset:1024
    v_mul_f32_e64 v198, v64, -v112
    v_permlane32_swap_b32 v202, v254
    v_mfma_f32_32x32x8_bf16 v[0:15], v[88:89], v[188:189], v[0:15]
    v_fma_f32 v198, v65, -v113, v198
    v_fma_f32 v198, v66, -v114, v198
    v_fma_f32 v198, v67, -v115, v198
    v_fma_f32 v198, v68, -v116, v198
    v_fma_f32 v198, v69, -v117, v198
    v_fma_f32 v198, v70, -v118, v198
    v_mfma_f32_32x32x8_bf16 v[32:47], v[92:93], v[188:189], v[32:47]
    v_add_u32 v249, s48, v249
    v_add_u32 v250, s49, v250
    ds_read_b32 v252, v251 offset:16
    ds_read_b64_tr_b16 v[72:73], v249 offset:0
    ds_read_b64_tr_b16 v[76:77], v249 offset:64
    ds_read_b64_tr_b16 v[74:75], v249 offset:256
    ds_read_b64_tr_b16 v[78:79], v249 offset:320
    s_mov_b64 exec, s[54:55]
    ds_read_u16_d16_hi v242, v250 offset:0
    s_mov_b64 exec, -1
    v_fma_f32 v198, v71, -v119, v198
    v_add_f32 v254, v202, v254
    v_mul_f32 v196, v56, v160
    v_fmac_f32 v196, v57, v161
    v_fmac_f32 v196, v58, v162
    v_fmac_f32 v196, v59, v163
    v_fmac_f32 v196, v60, v164
    v_fmac_f32 v196, v61, v165
    v_fmac_f32 v196, v62, v166
    v_fmac_f32 v196, v63, v167
    s_nop 1
    v_permlane32_swap_b32 v198, v196
    v_add_f32 v196, v198, v196
    s_cbranch_vccnz LEPI_0
    v_mul_f32 v255, v0, v152
    v_fmac_f32 v255, v1, v153
    v_fmac_f32 v255, v2, v154
    v_fmac_f32 v255, v3, v155
    v_fmac_f32 v255, v4, v156
    v_fmac_f32 v255, v5, v157
    v_fmac_f32 v255, v6, v158
    v_fmac_f32 v255, v7, v159
    v_fma_f32 v203, v8, -v168, v203
    v_fma_f32 v203, v9, -v169, v203
    v_permlane32_swap_b32 v255, v201
    v_fma_f32 v203, v10, -v170, v203
    v_fma_f32 v203, v11, -v171, v203
    v_fma_f32 v203, v12, -v172, v203
    v_fma_f32 v203, v13, -v173, v203
    v_fma_f32 v203, v14, -v174, v203
    v_fma_f32 v203, v15, -v175, v203
    v_add_f32 v201, v255, v201
    v_mul_f32_e64 v199, v40, -v120
    v_permlane32_swap_b32 v203, v255
    v_fma_f32 v199, v41, -v121, v199
    v_fma_f32 v199, v42, -v122, v199
    v_fma_f32 v199, v43, -v123, v199
    v_fma_f32 v199, v44, -v124, v199
    v_fma_f32 v199, v45, -v125, v199
    v_fma_f32 v199, v46, -v126, v199
    v_fma_f32 v199, v47, -v127, v199
    v_add_f32 v255, v203, v255
    v_mul_f32 v197, v32, v168
    v_fmac_f32 v197, v33, v169
    v_fmac_f32 v197, v34, v170
    v_fmac_f32 v197, v35, v171
    v_fmac_f32 v197, v36, v172
    v_fmac_f32 v197, v37, v173
    v_fmac_f32 v197, v38, v174
    v_fmac_f32 v197, v39, v175
    s_nop 1
    v_permlane32_swap_b32 v199, v197
    v_add_f32 v197, v199, v197
    v_cvt_pk_bf16_f32 v200, v200, v201
    v_cvt_pk_bf16_f32 v254, v254, v255
    v_cvt_pk_bf16_f32 v196, v196, v197
    ds_write2st64_b32 v253, v192, v193 offset0:0 offset1:1
    ds_write2st64_b32 v253, v194, v200 offset0:2 offset1:3
    ds_write_b32 v253, v196 offset:1024
    s_mov_b64 exec, 0xffffffff
    ds_write_b32 v253, v254 offset:1280
    s_mov_b64 exec, -1
    s_add_u32 s50, s50, 1
    s_cmp_ge_u32 s50, 4
    s_cbranch_scc1 LAST1
    s_waitcnt lgkmcnt(9)
    v_readfirstlane_b32 s66, v252
    s_add_u32 s53, s53, 1
    v_mov_b32 v252, s53
    s_cmp_le_u32 s53, s66
    ds_write2_b32 v251, v252, v252 offset0:0 offset1:8
    s_setprio 1
    s_cbranch_scc1 PRIO_12
    s_setprio 0
PRIO_12:
    s_cmp_eq_u32 s52, 4
    s_cbranch_scc1 ITEM_1_4
    s_cmp_eq_u32 s52, 5
    s_cbranch_scc1 ITEM_1_5
    s_cmp_eq_u32 s52, 3
    s_cbranch_scc1 ITEM_1_3
    s_cmp_eq_u32 s52, 6
    s_cbranch_scc1 ITEM_1_6
    s_cmp_eq_u32 s52, 8
    s_cbranch_scc1 ITEM_1_8
    s_branch ITEM_1_2
WL_5_0:
    s_add_u32 s66, s51, 0
    buffer_load_dwordx4 v[96:99], v246, s[16:19], s66 offen offset:2048 sc1
    buffer_load_dwordx4 v[100:103], v246, s[16:19], s66 offen offset:3072 sc1
    s_branch WR_5_0
WL_5_1:
    s_add_u32 s66, s51, 4096
    buffer_load_dwordx4 v[104:107], v246, s[16:19], s66 offen offset:2048 sc1
    buffer_load_dwordx4 v[108:111], v246, s[16:19], s66 offen offset:3072 sc1
    s_branch WR_5_1
WL_5_2:
    s_add_u32 s66, s51, 8192
    buffer_load_dwordx4 v[128:131], v246, s[16:19], s66 offen offset:2048 sc1
    buffer_load_dwordx4 v[132:135], v246, s[16:19], s66 offen offset:3072 sc1
    s_branch WR_5_2
WL_5_3:
    s_add_u32 s66, s51, 12288
    buffer_load_dwordx4 v[136:139], v246, s[16:19], s66 offen offset:2048 sc1
    buffer_load_dwordx4 v[140:143], v246, s[16:19], s66 offen offset:3072 sc1
    s_branch WR_5_3
.p2align 6
ITEM_1_3:
    s_mov_b64 exec, s[54:55]
    ds_read_u16_d16_hi v243, v250 offset:128
    s_mov_b64 exec, -1
    ds_read_b64_tr_b16 v[80:81], v249 offset:512
    ds_read_b64_tr_b16 v[84:85], v249 offset:576
    s_waitcnt lgkmcnt(3)
    v_mul_f32_dpp v196, v242, v72 row_newbcast:0 row_mask:0xf bank_mask:0xf
    v_mul_f32_dpp v197, v242, v73 row_newbcast:1 row_mask:0xf bank_mask:0xf
    v_mul_f32_dpp v198, v242, v72 row_newbcast:8 row_mask:0xf bank_mask:0xf
    v_mul_f32_dpp v199, v242, v73 row_newbcast:9 row_mask:0xf bank_mask:0xf
    v_mul_f32_dpp v200, v242, v76 row_newbcast:2 row_mask:0xf bank_mask:0xf
    v_mul_f32_dpp v201, v242, v77 row_newbcast:3 row_mask:0xf bank_mask:0xf
    v_mul_f32_dpp v202, v242, v76 row_newbcast:10 row_mask:0xf bank_mask:0xf
    v_mul_f32_dpp v203, v242, v77 row_newbcast:11 row_mask:0xf bank_mask:0xf
    v_cvt_pk_bf16_f32 v72, v196, v197
    v_cvt_pk_bf16_f32 v76, v198, v199
    v_cvt_pk_bf16_f32 v73, v200, v201
    v_cvt_pk_bf16_f32 v77, v202, v203
    v_mul_f32_dpp v196, v242, v74 row_newbcast:4 row_mask:0xf bank_mask:0xf
    v_mul_f32_dpp v197, v242, v75 row_newbcast:5 row_mask:0xf bank_mask:0xf
    v_mul_f32_dpp v198, v242, v74 row_newbcast:12 row_mask:0xf bank_mask:0xf
    v_mul_f32_dpp v199, v242, v75 row_newbcast:13 row_mask:0xf bank_mask:0xf
    v_mul_f32_dpp v200, v242, v78 row_newbcast:6 row_mask:0xf bank_mask:0xf
    v_mul_f32_dpp v201, v242, v79 row_newbcast:7 row_mask:0xf bank_mask:0xf
    v_mul_f32_dpp v202, v242, v78 row_newbcast:14 row_mask:0xf bank_mask:0xf
    v_mul_f32_dpp v203, v242, v79 row_newbcast:15 row_mask:0xf bank_mask:0xf
    v_cvt_pk_bf16_f32 v74, v196, v197
    v_cvt_pk_bf16_f32 v78, v198, v199
    v_cvt_pk_bf16_f32 v75, v200, v201
    v_cvt_pk_bf16_f32 v79, v202, v203
    s_waitcnt vmcnt(4) lgkmcnt(0)
    v_mfma_f32_32x32x16_bf16 v[56:71], v[72:75], v[176:179], 0
    v_mul_f32_dpp v196, v243, v80 row_newbcast:0 row_mask:0xf bank_mask:0xf
    v_mul_f32_dpp v197, v243, v81 row_newbcast:1 row_mask:0xf bank_mask:0xf
    v_mul_f32_dpp v198, v243, v80 row_newbcast:8 row_mask:0xf bank_mask:0xf
    v_mul_f32_dpp v199, v243, v81 row_newbcast:9 row_mask:0xf bank_mask:0xf
    v_mul_f32_dpp v200, v243, v84 row_newbcast:2 row_mask:0xf bank_mask:0xf
    v_mul_f32_dpp v201, v243, v85 row_newbcast:3 row_mask:0xf bank_mask:0xf
    s_add_u32 m0, s21, 0
    v_mfma_f32_32x32x16_bf16 v[16:31], v[76:79], v[176:179], 0
    buffer_load_dwordx4 v234, s[4:7], s36 offen  lds
    buffer_load_dwordx4 v235, s[8:11], s36 offen offset:1024  lds
    ds_read_b64_tr_b16 v[176:177], v244 offset:2048
    ds_read_b64_tr_b16 v[184:185], v245 offset:2048
    v_mul_f32_dpp v202, v243, v84 row_newbcast:10 row_mask:0xf bank_mask:0xf
    v_mul_f32_dpp v203, v243, v85 row_newbcast:11 row_mask:0xf bank_mask:0xf
    v_cvt_pk_bf16_f32 v80, v196, v197
    v_cvt_pk_bf16_f32 v84, v198, v199
    v_cvt_pk_bf16_f32 v81, v200, v201
    v_cvt_pk_bf16_f32 v85, v202, v203
    s_waitcnt lgkmcnt(0)
    v_mfma_f32_32x32x8_bf16 v[56:71], v[80:81], v[176:177], v[56:71]
    s_add_u32 m0, s21, 2048
    v_mfma_f32_32x32x8_bf16 v[16:31], v[84:85], v[176:177], v[16:31]
    buffer_load_dwordx4 v236, s[4:7], s36 offen  lds
    s_mov_b32 m0, s50
    s_nop 0
    s_movrels_b32 s71, s23
    s_movrels_b32 s33, s28
    v_add_u32 v253, s33, v248
    s_bfe_u32 s46, s71, 0x30012
    s_mov_b32 m0, s46
    s_and_b32 s66, s71, 0x3ffff
    s_movrels_b32 s68, s57
    s_movrels_b32 s69, s61
    s_sub_u32 s48, s66, s47
    s_mov_b32 s47, s66
    s_lshr_b32 s52, s71, 28
    s_lshl_b32 s67, s46, 9
    s_add_u32 s66, s66, s67
    s_sub_u32 s49, s66, s42
    s_mov_b32 s42, s66
    s_bfe_u32 s66, s68, 655360
    s_add_u32 s43, s42, s66
    s_bfe_u32 s39, s69, 655360
    s_bfe_u32 s66, s68, 655370
    s_add_u32 s44, s42, s66
    s_bfe_u32 s40, s69, 655370
    s_bfe_u32 s66, s68, 655380
    s_add_u32 s45, s42, s66
    s_bfe_u32 s41, s69, 655380
    v_add_u32 v252, s44, v247
    ds_read2_b32 v[238:239], v252 offset0:0 offset1:16
    v_add_u32 v252, s45, v247
    ds_read2_b32 v[240:241], v252 offset0:0 offset1:16
    v_mfma_f32_32x32x16_bf16 v[32:47], v[72:75], v[180:183], 0
    v_mul_f32 v196, v56, v96
    v_fmac_f32 v196, v57, v97
    v_fmac_f32 v196, v58, v98
    v_fmac_f32 v196, v59, v99
    v_fmac_f32 v196, v60, v100
    v_fmac_f32 v196, v61, v101
    v_mfma_f32_32x32x16_bf16 v[0:15], v[76:79], v[180:183], 0
    s_waitcnt vmcnt(5)
    ds_read_b64_tr_b16 v[176:177], v244 offset:4096
    ds_read_b64_tr_b16 v[178:179], v244 offset:5120
    ds_read_b64_tr_b16 v[180:181], v245 offset:4096
    ds_read_b64_tr_b16 v[182:183], v245 offset:5120
    v_fmac_f32 v196, v62, v102
    v_fmac_f32 v196, v63, v103
    v_mfma_f32_32x32x8_bf16 v[32:47], v[80:81], v[184:185], v[32:47]
    v_mul_f32 v198, v64, v128
    v_fmac_f32 v198, v65, v129
    v_fmac_f32 v198, v66, v130
    v_fmac_f32 v198, v67, v131
    v_fmac_f32 v198, v68, v132
    v_fmac_f32 v198, v69, v133
    v_mfma_f32_32x32x8_bf16 v[0:15], v[84:85], v[184:185], v[0:15]
    v_fmac_f32 v198, v70, v134
    v_fmac_f32 v198, v71, v135
    v_mul_f32 v200, v16, v128
    v_fmac_f32 v200, v17, v129
    v_permlane32_swap_b32 v196, v198
    v_fmac_f32 v200, v18, v130
    v_fmac_f32 v200, v19, v131
    v_fmac_f32 v200, v20, v132
    v_fmac_f32 v200, v21, v133
    v_fmac_f32 v200, v22, v134
    v_fmac_f32 v200, v23, v135
    v_add_f32 v198, v196, v198
    v_mul_f32_e64 v202, v24, -v128
    v_fma_f32 v202, v25, -v129, v202
    v_fma_f32 v202, v26, -v130, v202
    v_fma_f32 v202, v27, -v131, v202
    v_fma_f32 v202, v28, -v132, v202
    v_fma_f32 v202, v29, -v133, v202
    v_fma_f32 v202, v30, -v134, v202
    v_fma_f32 v202, v31, -v135, v202
    s_nop 1
    v_permlane32_swap_b32 v200, v202
    v_add_f32 v202, v200, v202
    s_waitcnt vmcnt(3) lgkmcnt(0)
    v_mfma_f32_32x32x16_bf16 v[56:71], v[72:75], v[176:179], 0
    v_mul_f32 v197, v32, v104
    v_fmac_f32 v197, v33, v105
    v_fmac_f32 v197, v34, v106
    v_fmac_f32 v197, v35, v107
    v_fmac_f32 v197, v36, v108
    v_fmac_f32 v197, v37, v109
    s_add_u32 m0, s21, 4096
    v_mfma_f32_32x32x16_bf16 v[16:31], v[76:79], v[176:179], 0
    buffer_load_dwordx4 v234, s[4:7], s37 offen  lds
    buffer_load_dwordx4 v235, s[8:11], s37 offen offset:1024  lds
    ds_read_b64_tr_b16 v[176:177], v244 offset:6144
    ds_read_b64_tr_b16 v[184:185], v245 offset:6144
    v_add_u32 v252, s42, v247
    ds_read2_b32 v[234:235], v252 offset0:0 offset1:16
    v_fmac_f32 v197, v38, v110
    v_fmac_f32 v197, v39, v111
    v_mul_f32 v199, v40, v136
    v_fmac_f32 v199, v41, v137
    v_fmac_f32 v199, v42, v138
    v_fmac_f32 v199, v43, v139
    v_fmac_f32 v199, v44, v140
    v_fmac_f32 v199, v45, v141
    v_fmac_f32 v199, v46, v142
    v_fmac_f32 v199, v47, v143
    v_mul_f32 v201, v0, v136
    v_fmac_f32 v201, v1, v137
    v_permlane32_swap_b32 v197, v199
    v_fmac_f32 v201, v2, v138
    v_fmac_f32 v201, v3, v139
    v_fmac_f32 v201, v4, v140
    v_fmac_f32 v201, v5, v141
    v_fmac_f32 v201, v6, v142
    v_fmac_f32 v201, v7, v143
    v_add_f32 v199, v197, v199
    v_mul_f32_e64 v203, v8, -v136
    v_fma_f32 v203, v9, -v137, v203
    v_fma_f32 v203, v10, -v138, v203
    s_waitcnt lgkmcnt(1)
    v_mfma_f32_32x32x8_bf16 v[56:71], v[80:81], v[176:177], v[56:71]
    v_fma_f32 v203, v11, -v139, v203
    v_fma_f32 v203, v12, -v140, v203
    v_fma_f32 v203, v13, -v141, v203
    v_fma_f32 v203, v14, -v142, v203
    v_fma_f32 v203, v15, -v143, v203
    s_nop 1
    v_permlane32_swap_b32 v201, v203
    s_add_u32 m0, s21, 6144
    v_mfma_f32_32x32x8_bf16 v[16:31], v[84:85], v[176:177], v[16:31]
    buffer_load_dwordx4 v236, s[4:7], s37 offen  lds
    v_add_u32 v252, s43, v247
    ds_read2_b32 v[236:237], v252 offset0:0 offset1:16
    v_add_f32 v203, v201, v203
    v_cvt_pk_bf16_f32 v192, v198, v199
    v_cvt_pk_bf16_f32 v193, v202, v203
    v_mfma_f32_32x32x16_bf16 v[32:47], v[72:75], v[180:183], 0
    v_mul_f32 v196, v56, v144
    v_fmac_f32 v196, v57, v145
    v_fmac_f32 v196, v58, v146
    v_fmac_f32 v196, v59, v147
    v_fmac_f32 v196, v60, v148
    v_fmac_f32 v196, v61, v149
    v_mfma_f32_32x32x16_bf16 v[0:15], v[76:79], v[180:183], 0
    s_waitcnt vmcnt(4)
    ds_read_b64_tr_b16 v[176:177], v244 offset:0
    ds_read_b64_tr_b16 v[178:179], v244 offset:1024
    ds_read_b64_tr_b16 v[180:181], v245 offset:0
    ds_read_b64_tr_b16 v[182:183], v245 offset:1024
    v_fmac_f32 v196, v62, v150
    v_fmac_f32 v196, v63, v151
    v_mfma_f32_32x32x8_bf16 v[32:47], v[80:81], v[184:185], v[32:47]
    v_mul_f32_e64 v200, v16, -v160
    v_fma_f32 v200, v17, -v161, v200
    v_fma_f32 v200, v18, -v162, v200
    v_fma_f32 v200, v19, -v163, v200
    v_fma_f32 v200, v20, -v164, v200
    v_fma_f32 v200, v21, -v165, v200
    v_mfma_f32_32x32x8_bf16 v[0:15], v[84:85], v[184:185], v[0:15]
    v_fma_f32 v200, v22, -v166, v200
    v_fma_f32 v200, v23, -v167, v200
    v_mul_f32_e64 v202, v24, -v160
    v_fma_f32 v202, v25, -v161, v202
    v_fma_f32 v202, v26, -v162, v202
    v_fma_f32 v202, v27, -v163, v202
    v_fma_f32 v202, v28, -v164, v202
    v_fma_f32 v202, v29, -v165, v202
    v_fma_f32 v202, v30, -v166, v202
    v_fma_f32 v202, v31, -v167, v202
    s_waitcnt vmcnt(3) lgkmcnt(0)
    v_mfma_f32_32x32x16_bf16 v[16:31], v[72:75], v[176:179], 0
    v_mul_f32 v197, v32, v152
    v_fmac_f32 v197, v33, v153
    v_fmac_f32 v197, v34, v154
    v_fmac_f32 v197, v35, v155
    v_fmac_f32 v197, v36, v156
    v_fmac_f32 v197, v37, v157
    s_add_u32 m0, s21, 0
    v_mfma_f32_32x32x16_bf16 v[48:63], v[76:79], v[176:179], 0
    s_cbranch_vccnz WL_3_0
    v_mad_u32_u16 v234, v234, s3, v246 op_sel:[1,0,0,0]
    v_mad_u32_u16 v235, v235, s3, v246 op_sel:[1,0,0,0]
    buffer_load_dwordx4 v234, s[4:7], s38 offen  lds
    buffer_load_dwordx4 v235, s[8:11], s38 offen offset:1024  lds
WR_3_0:
    ds_read_b64_tr_b16 v[176:177], v244 offset:2048
    ds_read_b64_tr_b16 v[184:185], v245 offset:2048
    v_fmac_f32 v197, v38, v158
    v_fmac_f32 v197, v39, v159
    v_mul_f32_e64 v201, v0, -v168
    v_fma_f32 v201, v1, -v169, v201
    v_fma_f32 v201, v2, -v170, v201
    v_fma_f32 v201, v3, -v171, v201
    v_fma_f32 v201, v4, -v172, v201
    v_fma_f32 v201, v5, -v173, v201
    v_fma_f32 v201, v6, -v174, v201
    v_fma_f32 v201, v7, -v175, v201
    s_waitcnt lgkmcnt(0)
    v_mfma_f32_32x32x8_bf16 v[16:31], v[80:81], v[176:177], v[16:31]
    v_mul_f32_e64 v203, v8, -v168
    v_fma_f32 v203, v9, -v169, v203
    v_fma_f32 v203, v10, -v170, v203
    v_fma_f32 v203, v11, -v171, v203
    v_fma_f32 v203, v12, -v172, v203
    v_fma_f32 v203, v13, -v173, v203
    s_add_u32 m0, s21, 2048
    v_mfma_f32_32x32x8_bf16 v[48:63], v[84:85], v[176:177], v[48:63]
    s_cbranch_vccnz WL_3_1
    v_mad_u32_u16 v236, v236, s3, v246 op_sel:[1,0,0,0]
    v_mad_u32_u16 v237, v237, s3, v246 op_sel:[1,0,0,0]
    buffer_load_dwordx4 v236, s[4:7], s39 offen  lds
    buffer_load_dwordx4 v237, s[8:11], s39 offen offset:1024  lds
WR_3_1:
    v_fma_f32 v203, v14, -v174, v203
    v_fma_f32 v203, v15, -v175, v203
    v_mfma_f32_32x32x16_bf16 v[0:15], v[72:75], v[180:183], 0
    v_fmac_f32 v200, v24, v160
    v_fmac_f32 v200, v25, v161
    v_fmac_f32 v200, v26, v162
    v_fmac_f32 v200, v27, v163
    v_fmac_f32 v200, v28, v164
    v_fmac_f32 v200, v29, v165
    v_fmac_f32 v200, v30, v166
    v_fmac_f32 v200, v31, v167
    v_mfma_f32_32x32x16_bf16 v[24:39], v[76:79], v[180:183], 0
    s_waitcnt vmcnt(5)
    ds_read_b64_tr_b16 v[176:177], v244 offset:4096
    ds_read_b64_tr_b16 v[178:179], v244 offset:5120
    ds_read_b64_tr_b16 v[180:181], v245 offset:4096
    ds_read_b64_tr_b16 v[182:183], v245 offset:5120
    v_mul_f32 v254, v16, v144
    v_fmac_f32 v254, v17, v145
    v_mfma_f32_32x32x8_bf16 v[24:39], v[84:85], v[184:185], v[24:39]
    v_fmac_f32 v254, v18, v146
    v_fmac_f32 v254, v19, v147
    v_fmac_f32 v254, v20, v148
    v_fmac_f32 v254, v21, v149
    v_fmac_f32 v254, v22, v150
    v_fmac_f32 v254, v23, v151
    v_mfma_f32_32x32x8_bf16 v[0:15], v[80:81], v[184:185], v[0:15]
    v_sub_f32_e64 v64, -v48, v64
    v_sub_f32_e64 v65, -v49, v65
    v_permlane32_swap_b32 v196, v254
    v_sub_f32_e64 v66, -v50, v66
    v_sub_f32_e64 v67, -v51, v67
    v_sub_f32_e64 v68, -v52, v68
    v_sub_f32_e64 v69, -v53, v69
    v_sub_f32_e64 v70, -v54, v70
    v_sub_f32_e64 v71, -v55, v71
    v_add_f32 v254, v196, v254
    s_waitcnt vmcnt(4) lgkmcnt(0)
    v_mfma_f32_32x32x16_bf16 v[56:71], v[76:79], v[176:179], v[56:71]
    v_sub_f32_e64 v40, -v24, v40
    v_sub_f32_e64 v41, -v25, v41
    v_sub_f32_e64 v42, -v26, v42
    v_sub_f32_e64 v43, -v27, v43
    v_sub_f32_e64 v44, -v28, v44
    v_sub_f32_e64 v45, -v29, v45
    v_sub_f32_e64 v46, -v30, v46
    v_sub_f32_e64 v47, -v31, v47
    s_add_u32 m0, s21, 4096
    v_mfma_f32_32x32x16_bf16 v[16:31], v[72:75], v[176:179], 0
    s_cbranch_vccnz WL_3_2
    v_mad_u32_u16 v238, v238, s3, v246 op_sel:[1,0,0,0]
    v_mad_u32_u16 v239, v239, s3, v246 op_sel:[1,0,0,0]
    buffer_load_dwordx4 v238, s[4:7], s40 offen  lds
    buffer_load_dwordx4 v239, s[8:11], s40 offen offset:1024  lds
WR_3_2:
    ds_read_b64_tr_b16 v[176:177], v244 offset:6144
    ds_read_b64_tr_b16 v[184:185], v245 offset:6144
    v_mul_f32 v255, v0, v152
    v_fmac_f32 v255, v1, v153
    v_fmac_f32 v255, v2, v154
    v_fmac_f32 v255, v3, v155
    v_fmac_f32 v255, v4, v156
    v_fmac_f32 v255, v5, v157
    v_fmac_f32 v255, v6, v158
    v_fmac_f32 v255, v7, v159
    v_fmac_f32 v201, v8, v168
    v_fmac_f32 v201, v9, v169
    v_permlane32_swap_b32 v197, v255
    s_waitcnt lgkmcnt(0)
    v_mfma_f32_32x32x8_bf16 v[16:31], v[80:81], v[176:177], v[16:31]
    v_fmac_f32 v201, v10, v170
    v_fmac_f32 v201, v11, v171
    v_fmac_f32 v201, v12, v172
    v_fmac_f32 v201, v13, v173
    v_fmac_f32 v201, v14, v174
    v_fmac_f32 v201, v15, v175
    s_add_u32 m0, s21, 6144
    v_mfma_f32_32x32x8_bf16 v[56:71], v[84:85], v[176:177], v[56:71]
    s_cbranch_vccnz WL_3_3
    v_mad_u32_u16 v240, v240, s3, v246 op_sel:[1,0,0,0]
    v_mad_u32_u16 v241, v241, s3, v246 op_sel:[1,0,0,0]
    buffer_load_dwordx4 v240, s[4:7], s41 offen  lds
    buffer_load_dwordx4 v241, s[8:11], s41 offen offset:1024  lds
WR_3_3:
    v_add_f32 v255, v197, v255
    v_cvt_pk_bf16_f32 v194, v254, v255
    v_mfma_f32_32x32x16_bf16 v[0:15], v[72:75], v[180:183], 0
    v_mul_f32 v254, v16, v144
    v_fmac_f32 v254, v17, v145
    v_fmac_f32 v254, v18, v146
    v_fmac_f32 v254, v19, v147
    v_fmac_f32 v254, v20, v148
    v_fmac_f32 v254, v21, v149
    v_mfma_f32_32x32x16_bf16 v[32:47], v[76:79], v[180:183], v[32:47]
    s_waitcnt vmcnt(6)
    ds_read_b64_tr_b16 v[176:177], v244 offset:0
    ds_read_b64_tr_b16 v[178:179], v244 offset:1024
    ds_read_b64_tr_b16 v[180:181], v245 offset:0
    ds_read_b64_tr_b16 v[182:183], v245 offset:1024
    v_fmac_f32 v254, v22, v150
    v_fmac_f32 v254, v23, v151
    v_mfma_f32_32x32x8_bf16 v[0:15], v[80:81], v[184:185], v[0:15]
    v_fma_f32 v202, v24, -v160, v202
    v_fma_f32 v202, v25, -v161, v202
    v_permlane32_swap_b32 v254, v200
    v_fma_f32 v202, v26, -v162, v202
    v_fma_f32 v202, v27, -v163, v202
    v_fma_f32 v202, v28, -v164, v202
    v_mfma_f32_32x32x8_bf16 v[32:47], v[84:85], v[184:185], v[32:47]
    v_add_u32 v249, s48, v249
    v_add_u32 v250, s49, v250
    ds_read_b32 v252, v251 offset:16
    ds_read_b64_tr_b16 v[72:73], v249 offset:0
    ds_read_b64_tr_b16 v[76:77], v249 offset:64
    ds_read_b64_tr_b16 v[74:75], v249 offset:256
    ds_read_b64_tr_b16 v[78:79], v249 offset:320
    s_mov_b64 exec, s[54:55]
    ds_read_u16_d16_hi v242, v250 offset:0
    s_mov_b64 exec, -1
    v_fma_f32 v202, v29, -v165, v202
    v_fma_f32 v202, v30, -v166, v202
    v_fma_f32 v202, v31, -v167, v202
    v_add_f32 v200, v254, v200
    v_mul_f32_e64 v198, v64, -v112
    v_permlane32_swap_b32 v202, v254
    v_fma_f32 v198, v65, -v113, v198
    v_fma_f32 v198, v66, -v114, v198
    v_fma_f32 v198, v67, -v115, v198
    v_fma_f32 v198, v68, -v116, v198
    v_fma_f32 v198, v69, -v117, v198
    v_fma_f32 v198, v70, -v118, v198
    v_fma_f32 v198, v71, -v119, v198
    v_add_f32 v254, v202, v254
    v_mul_f32 v196, v56, v160
    v_fmac_f32 v196, v57, v161
    v_fmac_f32 v196, v58, v162
    v_fmac_f32 v196, v59, v163
    v_fmac_f32 v196, v60, v164
    v_fmac_f32 v196, v61, v165
    v_fmac_f32 v196, v62, v166
    v_fmac_f32 v196, v63, v167
    s_nop 1
    v_permlane32_swap_b32 v198, v196
    v_add_f32 v196, v198, v196
    s_cbranch_vccnz LEPI_0
    v_mul_f32 v255, v0, v152
    v_fmac_f32 v255, v1, v153
    v_fmac_f32 v255, v2, v154
    v_fmac_f32 v255, v3, v155
    v_fmac_f32 v255, v4, v156
    v_fmac_f32 v255, v5, v157
    v_fmac_f32 v255, v6, v158
    v_fmac_f32 v255, v7, v159
    v_fma_f32 v203, v8, -v168, v203
    v_fma_f32 v203, v9, -v169, v203
    v_permlane32_swap_b32 v255, v201
    v_fma_f32 v203, v10, -v170, v203
    v_fma_f32 v203, v11, -v171, v203
    v_fma_f32 v203, v12, -v172, v203
    v_fma_f32 v203, v13, -v173, v203
    v_fma_f32 v203, v14, -v174, v203
    v_fma_f32 v203, v15, -v175, v203
    v_add_f32 v201, v255, v201
    v_mul_f32_e64 v199, v40, -v120
    v_permlane32_swap_b32 v203, v255
    v_fma_f32 v199, v41, -v121, v199
    v_fma_f32 v199, v42, -v122, v199
    v_fma_f32 v199, v43, -v123, v199
    v_fma_f32 v199, v44, -v124, v199
    v_fma_f32 v199, v45, -v125, v199
    v_fma_f32 v199, v46, -v126, v199
    v_fma_f32 v199, v47, -v127, v199
    v_add_f32 v255, v203, v255
    v_mul_f32 v197, v32, v168
    v_fmac_f32 v197, v33, v169
    v_fmac_f32 v197, v34, v170
    v_fmac_f32 v197, v35, v171
    v_fmac_f32 v197, v36, v172
    v_fmac_f32 v197, v37, v173
    v_fmac_f32 v197, v38, v174
    v_fmac_f32 v197, v39, v175
    s_nop 1
    v_permlane32_swap_b32 v199, v197
    v_add_f32 v197, v199, v197
    v_cvt_pk_bf16_f32 v200, v200, v201
    v_cvt_pk_bf16_f32 v254, v254, v255
    v_cvt_pk_bf16_f32 v196, v196, v197
    ds_write2st64_b32 v253, v192, v193 offset0:0 offset1:1
    ds_write2st64_b32 v253, v194, v200 offset0:2 offset1:3
    ds_write_b32 v253, v196 offset:1024
    s_mov_b64 exec, 0xffffffff
    ds_write_b32 v253, v254 offset:1280
    s_mov_b64 exec, -1
    s_add_u32 s50, s50, 1
    s_cmp_ge_u32 s50, 4
    s_cbranch_scc1 LAST1
    s_waitcnt lgkmcnt(9)
    v_readfirstlane_b32 s66, v252
    s_add_u32 s53, s53, 1
    v_mov_b32 v252, s53
    s_cmp_le_u32 s53, s66
    ds_write2_b32 v251, v252, v252 offset0:0 offset1:8
    s_setprio 1
    s_cbranch_scc1 PRIO_13
    s_setprio 0
PRIO_13:
    s_cmp_eq_u32 s52, 4
    s_cbranch_scc1 ITEM_1_4
    s_cmp_eq_u32 s52, 5
    s_cbranch_scc1 ITEM_1_5
    s_cmp_eq_u32 s52, 3
    s_cbranch_scc1 ITEM_1_3
    s_cmp_eq_u32 s52, 6
    s_cbranch_scc1 ITEM_1_6
    s_cmp_eq_u32 s52, 8
    s_cbranch_scc1 ITEM_1_8
    s_branch ITEM_1_2
WL_3_0:
    s_add_u32 s66, s51, 0
    buffer_load_dwordx4 v[96:99], v246, s[16:19], s66 offen offset:2048 sc1
    buffer_load_dwordx4 v[100:103], v246, s[16:19], s66 offen offset:3072 sc1
    s_branch WR_3_0
WL_3_1:
    s_add_u32 s66, s51, 4096
    buffer_load_dwordx4 v[104:107], v246, s[16:19], s66 offen offset:2048 sc1
    buffer_load_dwordx4 v[108:111], v246, s[16:19], s66 offen offset:3072 sc1
    s_branch WR_3_1
WL_3_2:
    s_add_u32 s66, s51, 8192
    buffer_load_dwordx4 v[128:131], v246, s[16:19], s66 offen offset:2048 sc1
    buffer_load_dwordx4 v[132:135], v246, s[16:19], s66 offen offset:3072 sc1
    s_branch WR_3_2
WL_3_3:
    s_add_u32 s66, s51, 12288
    buffer_load_dwordx4 v[136:139], v246, s[16:19], s66 offen offset:2048 sc1
    buffer_load_dwordx4 v[140:143], v246, s[16:19], s66 offen offset:3072 sc1
    s_branch WR_3_3
.p2align 6
ITEM_1_6:
    s_mov_b64 exec, s[54:55]
    ds_read_u16_d16_hi v243, v250 offset:128
    s_mov_b64 exec, -1
    ds_read_b64_tr_b16 v[80:81], v249 offset:512
    ds_read_b64_tr_b16 v[84:85], v249 offset:576
    ds_read_b64_tr_b16 v[82:83], v249 offset:768
    ds_read_b64_tr_b16 v[86:87], v249 offset:832
    ds_read_b64_tr_b16 v[88:89], v249 offset:1024
    ds_read_b64_tr_b16 v[92:93], v249 offset:1088
    ds_read_b64_tr_b16 v[90:91], v249 offset:1280
    ds_read_b64_tr_b16 v[94:95], v249 offset:1344
    s_waitcnt lgkmcnt(9)
    v_mul_f32_dpp v196, v242, v72 row_newbcast:0 row_mask:0xf bank_mask:0xf
    v_mul_f32_dpp v197, v242, v73 row_newbcast:1 row_mask:0xf bank_mask:0xf
    v_mul_f32_dpp v198, v242, v72 row_newbcast:8 row_mask:0xf bank_mask:0xf
    v_mul_f32_dpp v199, v242, v73 row_newbcast:9 row_mask:0xf bank_mask:0xf
    v_mul_f32_dpp v200, v242, v76 row_newbcast:2 row_mask:0xf bank_mask:0xf
    v_mul_f32_dpp v201, v242, v77 row_newbcast:3 row_mask:0xf bank_mask:0xf
    v_mul_f32_dpp v202, v242, v76 row_newbcast:10 row_mask:0xf bank_mask:0xf
    v_mul_f32_dpp v203, v242, v77 row_newbcast:11 row_mask:0xf bank_mask:0xf
    v_cvt_pk_bf16_f32 v72, v196, v197
    v_cvt_pk_bf16_f32 v76, v198, v199
    v_cvt_pk_bf16_f32 v73, v200, v201
    v_cvt_pk_bf16_f32 v77, v202, v203
    v_mul_f32_dpp v196, v242, v74 row_newbcast:4 row_mask:0xf bank_mask:0xf
    v_mul_f32_dpp v197, v242, v75 row_newbcast:5 row_mask:0xf bank_mask:0xf
    v_mul_f32_dpp v198, v242, v74 row_newbcast:12 row_mask:0xf bank_mask:0xf
    v_mul_f32_dpp v199, v242, v75 row_newbcast:13 row_mask:0xf bank_mask:0xf
    v_mul_f32_dpp v200, v242, v78 row_newbcast:6 row_mask:0xf bank_mask:0xf
    v_mul_f32_dpp v201, v242, v79 row_newbcast:7 row_mask:0xf bank_mask:0xf
    v_mul_f32_dpp v202, v242, v78 row_newbcast:14 row_mask:0xf bank_mask:0xf
    v_mul_f32_dpp v203, v242, v79 row_newbcast:15 row_mask:0xf bank_mask:0xf
    v_cvt_pk_bf16_f32 v74, v196, v197
    v_cvt_pk_bf16_f32 v78, v198, v199
    v_cvt_pk_bf16_f32 v75, v200, v201
    v_cvt_pk_bf16_f32 v79, v202, v203
    s_mov_b64 exec, s[54:55]
    ds_read_u16_d16_hi v242, v250 offset:256
    s_mov_b64 exec, -1
    s_waitcnt vmcnt(4) lgkmcnt(5)
    v_mfma_f32_32x32x16_bf16 v[56:71], v[72:75], v[176:179], 0
    v_mul_f32_dpp v196, v243, v80 row_newbcast:0 row_mask:0xf bank_mask:0xf
    v_mul_f32_dpp v197, v243, v81 row_newbcast:1 row_mask:0xf bank_mask:0xf
    v_mul_f32_dpp v198, v243, v80 row_newbcast:8 row_mask:0xf bank_mask:0xf
    v_mul_f32_dpp v199, v243, v81 row_newbcast:9 row_mask:0xf bank_mask:0xf
    v_mul_f32_dpp v200, v243, v84 row_newbcast:2 row_mask:0xf bank_mask:0xf
    v_mul_f32_dpp v201, v243, v85 row_newbcast:3 row_mask:0xf bank_mask:0xf
    s_add_u32 m0, s21, 0
    v_mfma_f32_32x32x16_bf16 v[16:31], v[76:79], v[176:179], 0
    buffer_load_dwordx4 v236, s[4:7], s35 offen  lds
    buffer_load_dwordx4 v237, s[8:11], s35 offen offset:1024  lds
    ds_read_b64_tr_b16 v[176:177], v244 offset:2048
    ds_read_b64_tr_b16 v[178:179], v244 offset:3072
    ds_read_b64_tr_b16 v[184:185], v245 offset:2048
    ds_read_b64_tr_b16 v[186:187], v245 offset:3072
    v_mul_f32_dpp v202, v243, v84 row_newbcast:10 row_mask:0xf bank_mask:0xf
    v_mul_f32_dpp v203, v243, v85 row_newbcast:11 row_mask:0xf bank_mask:0xf
    v_cvt_pk_bf16_f32 v80, v196, v197
    v_cvt_pk_bf16_f32 v84, v198, v199
    v_cvt_pk_bf16_f32 v81, v200, v201
    v_cvt_pk_bf16_f32 v85, v202, v203
    v_mul_f32_dpp v196, v243, v82 row_newbcast:4 row_mask:0xf bank_mask:0xf
    v_mul_f32_dpp v197, v243, v83 row_newbcast:5 row_mask:0xf bank_mask:0xf
    v_mul_f32_dpp v198, v243, v82 row_newbcast:12 row_mask:0xf bank_mask:0xf
    v_mul_f32_dpp v199, v243, v83 row_newbcast:13 row_mask:0xf bank_mask:0xf
    v_mul_f32_dpp v200, v243, v86 row_newbcast:6 row_mask:0xf bank_mask:0xf
    v_mul_f32_dpp v201, v243, v87 row_newbcast:7 row_mask:0xf bank_mask:0xf
    v_mul_f32_dpp v202, v243, v86 row_newbcast:14 row_mask:0xf bank_mask:0xf
    v_mul_f32_dpp v203, v243, v87 row_newbcast:15 row_mask:0xf bank_mask:0xf
    v_cvt_pk_bf16_f32 v82, v196, v197
    v_cvt_pk_bf16_f32 v86, v198, v199
    v_cvt_pk_bf16_f32 v83, v200, v201
    v_cvt_pk_bf16_f32 v87, v202, v203
    s_waitcnt vmcnt(4) lgkmcnt(0)
    v_mfma_f32_32x32x16_bf16 v[56:71], v[80:83], v[176:179], v[56:71]
    v_mul_f32_dpp v196, v242, v88 row_newbcast:0 row_mask:0xf bank_mask:0xf
    v_mul_f32_dpp v197, v242, v89 row_newbcast:1 row_mask:0xf bank_mask:0xf
    v_mul_f32_dpp v198, v242, v88 row_newbcast:8 row_mask:0xf bank_mask:0xf
    v_mul_f32_dpp v199, v242, v89 row_newbcast:9 row_mask:0xf bank_mask:0xf
    v_mul_f32_dpp v200, v242, v92 row_newbcast:2 row_mask:0xf bank_mask:0xf
    v_mul_f32_dpp v201, v242, v93 row_newbcast:3 row_mask:0xf bank_mask:0xf
    s_add_u32 m0, s21, 2048
    v_mfma_f32_32x32x16_bf16 v[16:31], v[84:87], v[176:179], v[16:31]
    buffer_load_dwordx4 v238, s[4:7], s35 offen  lds
    buffer_load_dwordx4 v239, s[8:11], s35 offen offset:1024  lds
    ds_read_b64_tr_b16 v[176:177], v244 offset:4096
    ds_read_b64_tr_b16 v[178:179], v244 offset:5120
    ds_read_b64_tr_b16 v[188:189], v245 offset:4096
    ds_read_b64_tr_b16 v[190:191], v245 offset:5120
    v_mul_f32_dpp v202, v242, v92 row_newbcast:10 row_mask:0xf bank_mask:0xf
    v_mul_f32_dpp v203, v242, v93 row_newbcast:11 row_mask:0xf bank_mask:0xf
    v_cvt_pk_bf16_f32 v88, v196, v197
    v_cvt_pk_bf16_f32 v92, v198, v199
    v_cvt_pk_bf16_f32 v89, v200, v201
    v_cvt_pk_bf16_f32 v93, v202, v203
    v_mul_f32_dpp v196, v242, v90 row_newbcast:4 row_mask:0xf bank_mask:0xf
    v_mul_f32_dpp v197, v242, v91 row_newbcast:5 row_mask:0xf bank_mask:0xf
    v_mul_f32_dpp v198, v242, v90 row_newbcast:12 row_mask:0xf bank_mask:0xf
    v_mul_f32_dpp v199, v242, v91 row_newbcast:13 row_mask:0xf bank_mask:0xf
    v_mul_f32_dpp v200, v242, v94 row_newbcast:6 row_mask:0xf bank_mask:0xf
    v_mul_f32_dpp v201, v242, v95 row_newbcast:7 row_mask:0xf bank_mask:0xf
    v_mul_f32_dpp v202, v242, v94 row_newbcast:14 row_mask:0xf bank_mask:0xf
    v_mul_f32_dpp v203, v242, v95 row_newbcast:15 row_mask:0xf bank_mask:0xf
    v_cvt_pk_bf16_f32 v90, v196, v197
    v_cvt_pk_bf16_f32 v94, v198, v199
    v_cvt_pk_bf16_f32 v91, v200, v201
    v_cvt_pk_bf16_f32 v95, v202, v203
    s_waitcnt lgkmcnt(0)
    v_mfma_f32_32x32x16_bf16 v[56:71], v[88:91], v[176:179], v[56:71]
    s_add_u32 m0, s21, 4096
    v_mfma_f32_32x32x16_bf16 v[16:31], v[92:95], v[176:179], v[16:31]
    buffer_load_dwordx4 v234, s[4:7], s36 offen  lds
    buffer_load_dwordx4 v235, s[8:11], s36 offen offset:1024  lds
    s_mov_b32 m0, s50
    s_nop 0
    s_movrels_b32 s71, s23
    s_movrels_b32 s33, s28
    v_add_u32 v253, s33, v248
    s_bfe_u32 s46, s71, 0x30012
    s_mov_b32 m0, s46
    s_and_b32 s66, s71, 0x3ffff
    s_movrels_b32 s68, s57
    s_movrels_b32 s69, s61
    s_sub_u32 s48, s66, s47
    s_mov_b32 s47, s66
    s_lshr_b32 s52, s71, 28
    s_lshl_b32 s67, s46, 9
    s_add_u32 s66, s66, s67
    s_sub_u32 s49, s66, s42
    s_mov_b32 s42, s66
    s_bfe_u32 s66, s68, 655360
    s_add_u32 s43, s42, s66
    s_bfe_u32 s39, s69, 655360
    s_bfe_u32 s66, s68, 655370
    s_add_u32 s44, s42, s66
    s_bfe_u32 s40, s69, 655370
    s_bfe_u32 s66, s68, 655380
    s_add_u32 s45, s42, s66
    s_bfe_u32 s41, s69, 655380
    v_add_u32 v252, s45, v247
    ds_read2_b32 v[240:241], v252 offset0:0 offset1:16
    v_mfma_f32_32x32x16_bf16 v[32:47], v[72:75], v[180:183], 0
    v_mul_f32 v196, v56, v96
    v_fmac_f32 v196, v57, v97
    v_fmac_f32 v196, v58, v98
    v_fmac_f32 v196, v59, v99
    v_fmac_f32 v196, v60, v100
    v_fmac_f32 v196, v61, v101
    v_mfma_f32_32x32x16_bf16 v[0:15], v[76:79], v[180:183], 0
    v_fmac_f32 v196, v62, v102
    v_fmac_f32 v196, v63, v103
    v_mul_f32 v198, v64, v128
    v_fmac_f32 v198, v65, v129
    v_fmac_f32 v198, v66, v130
    v_fmac_f32 v198, v67, v131
    v_mfma_f32_32x32x16_bf16 v[32:47], v[80:83], v[184:187], v[32:47]
    v_fmac_f32 v198, v68, v132
    v_fmac_f32 v198, v69, v133
    v_fmac_f32 v198, v70, v134
    v_fmac_f32 v198, v71, v135
    v_mul_f32 v200, v16, v128
    v_fmac_f32 v200, v17, v129
    v_mfma_f32_32x32x16_bf16 v[0:15], v[84:87], v[184:187], v[0:15]
    s_waitcnt vmcnt(6)
    ds_read_b64_tr_b16 v[176:177], v244 offset:6144
    ds_read_b64_tr_b16 v[178:179], v244 offset:7168
    ds_read_b64_tr_b16 v[180:181], v245 offset:6144
    ds_read_b64_tr_b16 v[182:183], v245 offset:7168
    v_permlane32_swap_b32 v196, v198
    v_fmac_f32 v200, v18, v130
    v_mfma_f32_32x32x16_bf16 v[32:47], v[88:91], v[188:191], v[32:47]
    v_fmac_f32 v200, v19, v131
    v_fmac_f32 v200, v20, v132
    v_fmac_f32 v200, v21, v133
    v_fmac_f32 v200, v22, v134
    v_fmac_f32 v200, v23, v135
    v_add_f32 v198, v196, v198
    v_mfma_f32_32x32x16_bf16 v[0:15], v[92:95], v[188:191], v[0:15]
    v_mul_f32_e64 v202, v24, -v128
    v_fma_f32 v202, v25, -v129, v202
    v_fma_f32 v202, v26, -v130, v202
    v_fma_f32 v202, v27, -v131, v202
    v_fma_f32 v202, v28, -v132, v202
    v_fma_f32 v202, v29, -v133, v202
    v_fma_f32 v202, v30, -v134, v202
    v_fma_f32 v202, v31, -v135, v202
    s_nop 1
    v_permlane32_swap_b32 v200, v202
    v_add_f32 v202, v200, v202
    s_waitcnt vmcnt(4) lgkmcnt(0)
    v_mfma_f32_32x32x16_bf16 v[56:71], v[72:75], v[176:179], 0
    v_mul_f32 v197, v32, v104
    v_fmac_f32 v197, v33, v105
    v_fmac_f32 v197, v34, v106
    v_fmac_f32 v197, v35, v107
    v_fmac_f32 v197, v36, v108
    v_fmac_f32 v197, v37, v109
    s_add_u32 m0, s21, 6144
    v_mfma_f32_32x32x16_bf16 v[16:31], v[76:79], v[176:179], 0
    buffer_load_dwordx4 v236, s[4:7], s36 offen  lds
    buffer_load_dwordx4 v237, s[8:11], s36 offen offset:1024  lds
    ds_read_b64_tr_b16 v[176:177], v244 offset:0
    ds_read_b64_tr_b16 v[178:179], v244 offset:1024
    ds_read_b64_tr_b16 v[184:185], v245 offset:0
    ds_read_b64_tr_b16 v[186:187], v245 offset:1024
    v_fmac_f32 v197, v38, v110
    v_fmac_f32 v197, v39, v111
    v_mul_f32 v199, v40, v136
    v_fmac_f32 v199, v41, v137
    v_fmac_f32 v199, v42, v138
    v_fmac_f32 v199, v43, v139
    v_fmac_f32 v199, v44, v140
    v_fmac_f32 v199, v45, v141
    v_fmac_f32 v199, v46, v142
    v_fmac_f32 v199, v47, v143
    v_mul_f32 v201, v0, v136
    v_fmac_f32 v201, v1, v137
    v_permlane32_swap_b32 v197, v199
    v_fmac_f32 v201, v2, v138
    v_fmac_f32 v201, v3, v139
    v_fmac_f32 v201, v4, v140
    v_fmac_f32 v201, v5, v141
    v_fmac_f32 v201, v6, v142
    s_waitcnt vmcnt(4) lgkmcnt(0)
    v_mfma_f32_32x32x16_bf16 v[56:71], v[80:83], v[176:179], v[56:71]
    v_fmac_f32 v201, v7, v143
    v_add_f32 v199, v197, v199
    v_mul_f32_e64 v203, v8, -v136
    v_fma_f32 v203, v9, -v137, v203
    v_fma_f32 v203, v10, -v138, v203
    v_fma_f32 v203, v11, -v139, v203
    s_add_u32 m0, s21, 0
    v_mfma_f32_32x32x16_bf16 v[16:31], v[84:87], v[176:179], v[16:31]
    buffer_load_dwordx4 v238, s[4:7], s36 offen  lds
    buffer_load_dwordx4 v239, s[8:11], s36 offen offset:1024  lds
    ds_read_b64_tr_b16 v[176:177], v244 offset:2048
    ds_read_b64_tr_b16 v[178:179], v244 offset:3072
    ds_read_b64_tr_b16 v[188:189], v245 offset:2048
    ds_read_b64_tr_b16 v[190:191], v245 offset:3072
    s_waitcnt lgkmcnt(0)
    v_mfma_f32_32x32x16_bf16 v[56:71], v[88:91], v[176:179], v[56:71]
    v_fma_f32 v203, v12, -v140, v203
    v_fma_f32 v203, v13, -v141, v203
    v_fma_f32 v203, v14, -v142, v203
    v_fma_f32 v203, v15, -v143, v203
    s_nop 1
    v_permlane32_swap_b32 v201, v203
    v_add_f32 v203, v201, v203
    s_add_u32 m0, s21, 2048
    v_mfma_f32_32x32x16_bf16 v[16:31], v[92:95], v[176:179], v[16:31]
    buffer_load_dwordx4 v234, s[4:7], s37 offen  lds
    buffer_load_dwordx4 v235, s[8:11], s37 offen offset:1024  lds
    v_add_u32 v252, s42, v247
    ds_read2_b32 v[234:235], v252 offset0:0 offset1:16
    v_cvt_pk_bf16_f32 v192, v198, v199
    v_cvt_pk_bf16_f32 v193, v202, v203
    v_mfma_f32_32x32x16_bf16 v[32:47], v[72:75], v[180:183], 0
    v_mul_f32 v196, v56, v144
    v_fmac_f32 v196, v57, v145
    v_fmac_f32 v196, v58, v146
    v_fmac_f32 v196, v59, v147
    v_fmac_f32 v196, v60, v148
    v_fmac_f32 v196, v61, v149
    v_mfma_f32_32x32x16_bf16 v[0:15], v[76:79], v[180:183], 0
    v_fmac_f32 v196, v62, v150
    v_fmac_f32 v196, v63, v151
    v_mul_f32_e64 v200, v16, -v160
    v_fma_f32 v200, v17, -v161, v200
    v_fma_f32 v200, v18, -v162, v200
    v_fma_f32 v200, v19, -v163, v200
    v_mfma_f32_32x32x16_bf16 v[32:47], v[80:83], v[184:187], v[32:47]
    v_fma_f32 v200, v20, -v164, v200
    v_fma_f32 v200, v21, -v165, v200
    v_fma_f32 v200, v22, -v166, v200
    v_fma_f32 v200, v23, -v167, v200
    v_mul_f32_e64 v202, v24, -v160
    v_fma_f32 v202, v25, -v161, v202
    v_mfma_f32_32x32x16_bf16 v[0:15], v[84:87], v[184:187], v[0:15]
    s_waitcnt vmcnt(6)
    ds_read_b64_tr_b16 v[176:177], v244 offset:4096
    ds_read_b64_tr_b16 v[178:179], v244 offset:5120
    ds_read_b64_tr_b16 v[180:181], v245 offset:4096
    ds_read_b64_tr_b16 v[182:183], v245 offset:5120
    v_fma_f32 v202, v26, -v162, v202
    v_fma_f32 v202, v27, -v163, v202
    v_mfma_f32_32x32x16_bf16 v[32:47], v[88:91], v[188:191], v[32:47]
    v_fma_f32 v202, v28, -v164, v202
    v_fma_f32 v202, v29, -v165, v202
    v_fma_f32 v202, v30, -v166, v202
    v_fma_f32 v202, v31, -v167, v202
    v_mfma_f32_32x32x16_bf16 v[0:15], v[92:95], v[188:191], v[0:15]
    s_waitcnt vmcnt(4) lgkmcnt(0)
    v_mfma_f32_32x32x16_bf16 v[16:31], v[72:75], v[176:179], 0
    s_nop 4
    v_mul_f32 v197, v32, v152
    v_fmac_f32 v197, v33, v153
    v_fmac_f32 v197, v34, v154
    v_fmac_f32 v197, v35, v155
    v_fmac_f32 v197, v36, v156
    v_fmac_f32 v197, v37, v157
    s_add_u32 m0, s21, 4096
    v_mfma_f32_32x32x16_bf16 v[48:63], v[76:79], v[176:179], 0
    buffer_load_dwordx4 v236, s[4:7], s37 offen  lds
    buffer_load_dwordx4 v237, s[8:11], s37 offen offset:1024  lds
    ds_read_b64_tr_b16 v[176:177], v244 offset:6144
    ds_read_b64_tr_b16 v[178:179], v244 offset:7168
    ds_read_b64_tr_b16 v[184:185], v245 offset:6144
    ds_read_b64_tr_b16 v[186:187], v245 offset:7168
    v_add_u32 v252, s43, v247
    ds_read2_b32 v[236:237], v252 offset0:0 offset1:16
    v_fmac_f32 v197, v38, v158
    v_fmac_f32 v197, v39, v159
    v_mul_f32_e64 v201, v0, -v168
    v_fma_f32 v201, v1, -v169, v201
    s_waitcnt vmcnt(4) lgkmcnt(1)
    v_mfma_f32_32x32x16_bf16 v[16:31], v[80:83], v[176:179], v[16:31]
    v_fma_f32 v201, v2, -v170, v201
    v_fma_f32 v201, v3, -v171, v201
    v_fma_f32 v201, v4, -v172, v201
    v_fma_f32 v201, v5, -v173, v201
    v_fma_f32 v201, v6, -v174, v201
    v_fma_f32 v201, v7, -v175, v201
    s_add_u32 m0, s21, 6144
    v_mfma_f32_32x32x16_bf16 v[48:63], v[84:87], v[176:179], v[48:63]
    buffer_load_dwordx4 v238, s[4:7], s37 offen  lds
    buffer_load_dwordx4 v239, s[8:11], s37 offen offset:1024  lds
    ds_read_b64_tr_b16 v[176:177], v244 offset:0
    ds_read_b64_tr_b16 v[178:179], v244 offset:1024
    ds_read_b64_tr_b16 v[188:189], v245 offset:0
    ds_read_b64_tr_b16 v[190:191], v245 offset:1024
    v_add_u32 v252, s44, v247
    ds_read2_b32 v[238:239], v252 offset0:0 offset1:16
    s_waitcnt lgkmcnt(1)
    v_mfma_f32_32x32x16_bf16 v[16:31], v[88:91], v[176:179], v[16:31]
    v_mul_f32_e64 v203, v8, -v168
    v_fma_f32 v203, v9, -v169, v203
    v_fma_f32 v203, v10, -v170, v203
    v_fma_f32 v203, v11, -v171, v203
    v_fma_f32 v203, v12, -v172, v203
    v_fma_f32 v203, v13, -v173, v203
    s_add_u32 m0, s21, 0
    v_mfma_f32_32x32x16_bf16 v[48:63], v[92:95], v[176:179], v[48:63]
    s_cbranch_vccnz WL_6_0
    v_mad_u32_u16 v234, v234, s3, v246 op_sel:[1,0,0,0]
    v_mad_u32_u16 v235, v235, s3, v246 op_sel:[1,0,0,0]
    buffer_load_dwordx4 v234, s[4:7], s38 offen  lds
    buffer_load_dwordx4 v235, s[8:11], s38 offen offset:1024  lds
WR_6_0:
    v_fma_f32 v203, v14, -v174, v203
    v_fma_f32 v203, v15, -v175, v203
    v_mfma_f32_32x32x16_bf16 v[0:15], v[72:75], v[180:183], 0
    v_fmac_f32 v200, v24, v160
    v_fmac_f32 v200, v25, v161
    v_fmac_f32 v200, v26, v162
    v_fmac_f32 v200, v27, v163
    v_fmac_f32 v200, v28, v164
    v_fmac_f32 v200, v29, v165
    v_fmac_f32 v200, v30, v166
    v_fmac_f32 v200, v31, v167
    v_mfma_f32_32x32x16_bf16 v[24:39], v[76:79], v[180:183], 0
    v_mul_f32 v254, v16, v144
    v_fmac_f32 v254, v17, v145
    v_fmac_f32 v254, v18, v146
    v_fmac_f32 v254, v19, v147
    v_fmac_f32 v254, v20, v148
    v_fmac_f32 v254, v21, v149
    v_mfma_f32_32x32x16_bf16 v[0:15], v[80:83], v[184:187], v[0:15]
    v_fmac_f32 v254, v22, v150
    v_fmac_f32 v254, v23, v151
    v_sub_f32_e64 v64, -v48, v64
    v_sub_f32_e64 v65, -v49, v65
    v_permlane32_swap_b32 v196, v254
    v_sub_f32_e64 v66, -v50, v66
    v_mfma_f32_32x32x16_bf16 v[24:39], v[84:87], v[184:187], v[24:39]
    s_waitcnt vmcnt(6)
    ds_read_b64_tr_b16 v[176:177], v244 offset:2048
    ds_read_b64_tr_b16 v[178:179], v244 offset:3072
    ds_read_b64_tr_b16 v[180:181], v245 offset:2048
    ds_read_b64_tr_b16 v[182:183], v245 offset:3072
    v_sub_f32_e64 v67, -v51, v67
    v_sub_f32_e64 v68, -v52, v68
    v_mfma_f32_32x32x16_bf16 v[24:39], v[92:95], v[188:191], v[24:39]
    v_sub_f32_e64 v69, -v53, v69
    v_sub_f32_e64 v70, -v54, v70
    v_sub_f32_e64 v71, -v55, v71
    v_add_f32 v254, v196, v254
    v_mfma_f32_32x32x16_bf16 v[0:15], v[88:91], v[188:191], v[0:15]
    s_waitcnt vmcnt(4) lgkmcnt(0)
    v_mfma_f32_32x32x16_bf16 v[56:71], v[76:79], v[176:179], v[56:71]
    s_nop 4
    v_sub_f32_e64 v40, -v24, v40
    v_sub_f32_e64 v41, -v25, v41
    v_sub_f32_e64 v42, -v26, v42
    v_sub_f32_e64 v43, -v27, v43
    v_sub_f32_e64 v44, -v28, v44
    v_sub_f32_e64 v45, -v29, v45
    v_sub_f32_e64 v46, -v30, v46
    v_sub_f32_e64 v47, -v31, v47
    s_add_u32 m0, s21, 2048
    v_mfma_f32_32x32x16_bf16 v[16:31], v[72:75], v[176:179], 0
    s_cbranch_vccnz WL_6_1
    v_mad_u32_u16 v236, v236, s3, v246 op_sel:[1,0,0,0]
    v_mad_u32_u16 v237, v237, s3, v246 op_sel:[1,0,0,0]
    buffer_load_dwordx4 v236, s[4:7], s39 offen  lds
    buffer_load_dwordx4 v237, s[8:11], s39 offen offset:1024  lds
WR_6_1:
    ds_read_b64_tr_b16 v[176:177], v244 offset:4096
    ds_read_b64_tr_b16 v[178:179], v244 offset:5120
    ds_read_b64_tr_b16 v[184:185], v245 offset:4096
    ds_read_b64_tr_b16 v[186:187], v245 offset:5120
    v_mul_f32 v255, v0, v152
    v_fmac_f32 v255, v1, v153
    v_fmac_f32 v255, v2, v154
    v_fmac_f32 v255, v3, v155
    v_fmac_f32 v255, v4, v156
    s_waitcnt vmcnt(4) lgkmcnt(0)
    v_mfma_f32_32x32x16_bf16 v[16:31], v[80:83], v[176:179], v[16:31]
    v_fmac_f32 v255, v5, v157
    v_fmac_f32 v255, v6, v158
    v_fmac_f32 v255, v7, v159
    v_fmac_f32 v201, v8, v168
    v_fmac_f32 v201, v9, v169
    v_permlane32_swap_b32 v197, v255
    s_add_u32 m0, s21, 4096
    v_mfma_f32_32x32x16_bf16 v[56:71], v[84:87], v[176:179], v[56:71]
    s_cbranch_vccnz WL_6_2
    v_mad_u32_u16 v238, v238, s3, v246 op_sel:[1,0,0,0]
    v_mad_u32_u16 v239, v239, s3, v246 op_sel:[1,0,0,0]
    buffer_load_dwordx4 v238, s[4:7], s40 offen  lds
    buffer_load_dwordx4 v239, s[8:11], s40 offen offset:1024  lds
WR_6_2:
    ds_read_b64_tr_b16 v[176:177], v244 offset:6144
    ds_read_b64_tr_b16 v[178:179], v244 offset:7168
    ds_read_b64_tr_b16 v[188:189], v245 offset:6144
    ds_read_b64_tr_b16 v[190:191], v245 offset:7168
    s_waitcnt lgkmcnt(0)
    v_mfma_f32_32x32x16_bf16 v[16:31], v[88:91], v[176:179], v[16:31]
    v_fmac_f32 v201, v10, v170
    v_fmac_f32 v201, v11, v171
    v_fmac_f32 v201, v12, v172
    v_fmac_f32 v201, v13, v173
    v_fmac_f32 v201, v14, v174
    v_fmac_f32 v201, v15, v175
    s_add_u32 m0, s21, 6144
    v_mfma_f32_32x32x16_bf16 v[56:71], v[92:95], v[176:179], v[56:71]
    s_cbranch_vccnz WL_6_3
    v_mad_u32_u16 v240, v240, s3, v246 op_sel:[1,0,0,0]
    v_mad_u32_u16 v241, v241, s3, v246 op_sel:[1,0,0,0]
    buffer_load_dwordx4 v240, s[4:7], s41 offen  lds
    buffer_load_dwordx4 v241, s[8:11], s41 offen offset:1024  lds
WR_6_3:
    v_add_f32 v255, v197, v255
    v_cvt_pk_bf16_f32 v194, v254, v255
    v_mfma_f32_32x32x16_bf16 v[0:15], v[72:75], v[180:183], 0
    v_mul_f32 v254, v16, v144
    v_fmac_f32 v254, v17, v145
    v_fmac_f32 v254, v18, v146
    v_fmac_f32 v254, v19, v147
    v_fmac_f32 v254, v20, v148
    v_fmac_f32 v254, v21, v149
    v_mfma_f32_32x32x16_bf16 v[32:47], v[76:79], v[180:183], v[32:47]
    v_fmac_f32 v254, v22, v150
    v_fmac_f32 v254, v23, v151
    v_fma_f32 v202, v24, -v160, v202
    v_fma_f32 v202, v25, -v161, v202
    v_permlane32_swap_b32 v254, v200
    v_fma_f32 v202, v26, -v162, v202
    v_mfma_f32_32x32x16_bf16 v[0:15], v[80:83], v[184:187], v[0:15]
    v_fma_f32 v202, v27, -v163, v202
    v_fma_f32 v202, v28, -v164, v202
    v_fma_f32 v202, v29, -v165, v202
    v_fma_f32 v202, v30, -v166, v202
    v_fma_f32 v202, v31, -v167, v202
    v_add_f32 v200, v254, v200
    v_mfma_f32_32x32x16_bf16 v[32:47], v[84:87], v[184:187], v[32:47]
    s_waitcnt vmcnt(6)
    ds_read_b64_tr_b16 v[176:177], v244 offset:0
    ds_read_b64_tr_b16 v[178:179], v244 offset:1024
    ds_read_b64_tr_b16 v[180:181], v245 offset:0
    ds_read_b64_tr_b16 v[182:183], v245 offset:1024
    v_mul_f32_e64 v198, v64, -v112
    v_permlane32_swap_b32 v202, v254
    v_mfma_f32_32x32x16_bf16 v[0:15], v[88:91], v[188:191], v[0:15]
    v_fma_f32 v198, v65, -v113, v198
    v_fma_f32 v198, v66, -v114, v198
    v_fma_f32 v198, v67, -v115, v198
    v_fma_f32 v198, v68, -v116, v198
    v_fma_f32 v198, v69, -v117, v198
    v_fma_f32 v198, v70, -v118, v198
    v_mfma_f32_32x32x16_bf16 v[32:47], v[92:95], v[188:191], v[32:47]
    v_add_u32 v249, s48, v249
    v_add_u32 v250, s49, v250
    ds_read_b32 v252, v251 offset:16
    ds_read_b64_tr_b16 v[72:73], v249 offset:0
    ds_read_b64_tr_b16 v[76:77], v249 offset:64
    ds_read_b64_tr_b16 v[74:75], v249 offset:256
    ds_read_b64_tr_b16 v[78:79], v249 offset:320
    s_mov_b64 exec, s[54:55]
    ds_read_u16_d16_hi v242, v250 offset:0
    s_mov_b64 exec, -1
    v_fma_f32 v198, v71, -v119, v198
    v_add_f32 v254, v202, v254
    v_mul_f32 v196, v56, v160
    v_fmac_f32 v196, v57, v161
    v_fmac_f32 v196, v58, v162
    v_fmac_f32 v196, v59, v163
    v_fmac_f32 v196, v60, v164
    v_fmac_f32 v196, v61, v165
    v_fmac_f32 v196, v62, v166
    v_fmac_f32 v196, v63, v167
    s_nop 1
    v_permlane32_swap_b32 v198, v196
    v_add_f32 v196, v198, v196
    s_cbranch_vccnz LEPI_0
    v_mul_f32 v255, v0, v152
    v_fmac_f32 v255, v1, v153
    v_fmac_f32 v255, v2, v154
    v_fmac_f32 v255, v3, v155
    v_fmac_f32 v255, v4, v156
    v_fmac_f32 v255, v5, v157
    v_fmac_f32 v255, v6, v158
    v_fmac_f32 v255, v7, v159
    v_fma_f32 v203, v8, -v168, v203
    v_fma_f32 v203, v9, -v169, v203
    v_permlane32_swap_b32 v255, v201
    v_fma_f32 v203, v10, -v170, v203
    v_fma_f32 v203, v11, -v171, v203
    v_fma_f32 v203, v12, -v172, v203
    v_fma_f32 v203, v13, -v173, v203
    v_fma_f32 v203, v14, -v174, v203
    v_fma_f32 v203, v15, -v175, v203
    v_add_f32 v201, v255, v201
    v_mul_f32_e64 v199, v40, -v120
    v_permlane32_swap_b32 v203, v255
    v_fma_f32 v199, v41, -v121, v199
    v_fma_f32 v199, v42, -v122, v199
    v_fma_f32 v199, v43, -v123, v199
    v_fma_f32 v199, v44, -v124, v199
    v_fma_f32 v199, v45, -v125, v199
    v_fma_f32 v199, v46, -v126, v199
    v_fma_f32 v199, v47, -v127, v199
    v_add_f32 v255, v203, v255
    v_mul_f32 v197, v32, v168
    v_fmac_f32 v197, v33, v169
    v_fmac_f32 v197, v34, v170
    v_fmac_f32 v197, v35, v171
    v_fmac_f32 v197, v36, v172
    v_fmac_f32 v197, v37, v173
    v_fmac_f32 v197, v38, v174
    v_fmac_f32 v197, v39, v175
    s_nop 1
    v_permlane32_swap_b32 v199, v197
    v_add_f32 v197, v199, v197
    v_cvt_pk_bf16_f32 v200, v200, v201
    v_cvt_pk_bf16_f32 v254, v254, v255
    v_cvt_pk_bf16_f32 v196, v196, v197
    ds_write2st64_b32 v253, v192, v193 offset0:0 offset1:1
    ds_write2st64_b32 v253, v194, v200 offset0:2 offset1:3
    ds_write_b32 v253, v196 offset:1024
    s_mov_b64 exec, 0xffffffff
    ds_write_b32 v253, v254 offset:1280
    s_mov_b64 exec, -1
    s_add_u32 s50, s50, 1
    s_cmp_ge_u32 s50, 4
    s_cbranch_scc1 LAST1
    s_waitcnt lgkmcnt(9)
    v_readfirstlane_b32 s66, v252
    s_add_u32 s53, s53, 1
    v_mov_b32 v252, s53
    s_cmp_le_u32 s53, s66
    ds_write2_b32 v251, v252, v252 offset0:0 offset1:8
    s_setprio 1
    s_cbranch_scc1 PRIO_14
    s_setprio 0
PRIO_14:
    s_cmp_eq_u32 s52, 4
    s_cbranch_scc1 ITEM_1_4
    s_cmp_eq_u32 s52, 5
    s_cbranch_scc1 ITEM_1_5
    s_cmp_eq_u32 s52, 3
    s_cbranch_scc1 ITEM_1_3
    s_cmp_eq_u32 s52, 6
    s_cbranch_scc1 ITEM_1_6
    s_cmp_eq_u32 s52, 8
    s_cbranch_scc1 ITEM_1_8
    s_branch ITEM_1_2
WL_6_0:
    s_add_u32 s66, s51, 0
    buffer_load_dwordx4 v[96:99], v246, s[16:19], s66 offen offset:2048 sc1
    buffer_load_dwordx4 v[100:103], v246, s[16:19], s66 offen offset:3072 sc1
    s_branch WR_6_0
WL_6_1:
    s_add_u32 s66, s51, 4096
    buffer_load_dwordx4 v[104:107], v246, s[16:19], s66 offen offset:2048 sc1
    buffer_load_dwordx4 v[108:111], v246, s[16:19], s66 offen offset:3072 sc1
    s_branch WR_6_1
WL_6_2:
    s_add_u32 s66, s51, 8192
    buffer_load_dwordx4 v[128:131], v246, s[16:19], s66 offen offset:2048 sc1
    buffer_load_dwordx4 v[132:135], v246, s[16:19], s66 offen offset:3072 sc1
    s_branch WR_6_2
WL_6_3:
    s_add_u32 s66, s51, 12288
    buffer_load_dwordx4 v[136:139], v246, s[16:19], s66 offen offset:2048 sc1
    buffer_load_dwordx4 v[140:143], v246, s[16:19], s66 offen offset:3072 sc1
    s_branch WR_6_3
.p2align 6
ITEM_1_8:
    s_mov_b64 exec, s[54:55]
    ds_read_u16_d16_hi v243, v250 offset:128
    s_mov_b64 exec, -1
    ds_read_b64_tr_b16 v[80:81], v249 offset:512
    ds_read_b64_tr_b16 v[84:85], v249 offset:576
    ds_read_b64_tr_b16 v[82:83], v249 offset:768
    ds_read_b64_tr_b16 v[86:87], v249 offset:832
    ds_read_b64_tr_b16 v[88:89], v249 offset:1024
    ds_read_b64_tr_b16 v[92:93], v249 offset:1088
    ds_read_b64_tr_b16 v[90:91], v249 offset:1280
    ds_read_b64_tr_b16 v[94:95], v249 offset:1344
    ds_read_b64_tr_b16 v[64:65], v249 offset:1536
    ds_read_b64_tr_b16 v[68:69], v249 offset:1600
    ds_read_b64_tr_b16 v[66:67], v249 offset:1792
    ds_read_b64_tr_b16 v[70:71], v249 offset:1856
    s_waitcnt lgkmcnt(13)
    v_mul_f32_dpp v196, v242, v72 row_newbcast:0 row_mask:0xf bank_mask:0xf
    v_mul_f32_dpp v197, v242, v73 row_newbcast:1 row_mask:0xf bank_mask:0xf
    v_mul_f32_dpp v198, v242, v72 row_newbcast:8 row_mask:0xf bank_mask:0xf
    v_mul_f32_dpp v199, v242, v73 row_newbcast:9 row_mask:0xf bank_mask:0xf
    v_mul_f32_dpp v200, v242, v76 row_newbcast:2 row_mask:0xf bank_mask:0xf
    v_mul_f32_dpp v201, v242, v77 row_newbcast:3 row_mask:0xf bank_mask:0xf
    v_mul_f32_dpp v202, v242, v76 row_newbcast:10 row_mask:0xf bank_mask:0xf
    v_mul_f32_dpp v203, v242, v77 row_newbcast:11 row_mask:0xf bank_mask:0xf
    v_cvt_pk_bf16_f32 v72, v196, v197
    v_cvt_pk_bf16_f32 v76, v198, v199
    v_cvt_pk_bf16_f32 v73, v200, v201
    v_cvt_pk_bf16_f32 v77, v202, v203
    v_mul_f32_dpp v196, v242, v74 row_newbcast:4 row_mask:0xf bank_mask:0xf
    v_mul_f32_dpp v197, v242, v75 row_newbcast:5 row_mask:0xf bank_mask:0xf
    v_mul_f32_dpp v198, v242, v74 row_newbcast:12 row_mask:0xf bank_mask:0xf
    v_mul_f32_dpp v199, v242, v75 row_newbcast:13 row_mask:0xf bank_mask:0xf
    v_mul_f32_dpp v200, v242, v78 row_newbcast:6 row_mask:0xf bank_mask:0xf
    v_mul_f32_dpp v201, v242, v79 row_newbcast:7 row_mask:0xf bank_mask:0xf
    v_mul_f32_dpp v202, v242, v78 row_newbcast:14 row_mask:0xf bank_mask:0xf
    v_mul_f32_dpp v203, v242, v79 row_newbcast:15 row_mask:0xf bank_mask:0xf
    v_cvt_pk_bf16_f32 v74, v196, v197
    v_cvt_pk_bf16_f32 v78, v198, v199
    v_cvt_pk_bf16_f32 v75, v200, v201
    v_cvt_pk_bf16_f32 v79, v202, v203
    s_mov_b64 exec, s[54:55]
    ds_read_u16_d16_hi v242, v250 offset:256
    s_mov_b64 exec, -1
    s_waitcnt vmcnt(4) lgkmcnt(9)
    v_mfma_f32_32x32x16_bf16 v[0:15], v[72:75], v[176:179], 0
    v_mul_f32_dpp v196, v243, v80 row_newbcast:0 row_mask:0xf bank_mask:0xf
    v_mul_f32_dpp v197, v243, v81 row_newbcast:1 row_mask:0xf bank_mask:0xf
    v_mul_f32_dpp v198, v243, v80 row_newbcast:8 row_mask:0xf bank_mask:0xf
    v_mul_f32_dpp v199, v243, v81 row_newbcast:9 row_mask:0xf bank_mask:0xf
    v_mul_f32_dpp v200, v243, v84 row_newbcast:2 row_mask:0xf bank_mask:0xf
    v_mul_f32_dpp v201, v243, v85 row_newbcast:3 row_mask:0xf bank_mask:0xf
    s_add_u32 m0, s21, 0
    v_mfma_f32_32x32x16_bf16 v[48:63], v[76:79], v[176:179], 0
    buffer_load_dwordx4 v234, s[4:7], s35 offen  lds
    buffer_load_dwordx4 v235, s[8:11], s35 offen offset:1024  lds
    ds_read_b64_tr_b16 v[176:177], v244 offset:2048
    ds_read_b64_tr_b16 v[178:179], v244 offset:3072
    ds_read_b64_tr_b16 v[184:185], v245 offset:2048
    ds_read_b64_tr_b16 v[186:187], v245 offset:3072
    v_mul_f32_dpp v202, v243, v84 row_newbcast:10 row_mask:0xf bank_mask:0xf
    v_mul_f32_dpp v203, v243, v85 row_newbcast:11 row_mask:0xf bank_mask:0xf
    v_cvt_pk_bf16_f32 v80, v196, v197
    v_cvt_pk_bf16_f32 v84, v198, v199
    v_cvt_pk_bf16_f32 v81, v200, v201
    v_cvt_pk_bf16_f32 v85, v202, v203
    v_mul_f32_dpp v196, v243, v82 row_newbcast:4 row_mask:0xf bank_mask:0xf
    v_mul_f32_dpp v197, v243, v83 row_newbcast:5 row_mask:0xf bank_mask:0xf
    v_mul_f32_dpp v198, v243, v82 row_newbcast:12 row_mask:0xf bank_mask:0xf
    v_mul_f32_dpp v199, v243, v83 row_newbcast:13 row_mask:0xf bank_mask:0xf
    v_mul_f32_dpp v200, v243, v86 row_newbcast:6 row_mask:0xf bank_mask:0xf
    v_mul_f32_dpp v201, v243, v87 row_newbcast:7 row_mask:0xf bank_mask:0xf
    v_mul_f32_dpp v202, v243, v86 row_newbcast:14 row_mask:0xf bank_mask:0xf
    v_mul_f32_dpp v203, v243, v87 row_newbcast:15 row_mask:0xf bank_mask:0xf
    v_cvt_pk_bf16_f32 v82, v196, v197
    v_cvt_pk_bf16_f32 v86, v198, v199
    v_cvt_pk_bf16_f32 v83, v200, v201
    v_cvt_pk_bf16_f32 v87, v202, v203
    s_mov_b64 exec, s[54:55]
    ds_read_u16_d16_hi v243, v250 offset:384
    s_mov_b64 exec, -1
    s_waitcnt vmcnt(4) lgkmcnt(1)
    v_mfma_f32_32x32x16_bf16 v[0:15], v[80:83], v[176:179], v[0:15]
    v_mul_f32_dpp v196, v242, v88 row_newbcast:0 row_mask:0xf bank_mask:0xf
    v_mul_f32_dpp v197, v242, v89 row_newbcast:1 row_mask:0xf bank_mask:0xf
    v_mul_f32_dpp v198, v242, v88 row_newbcast:8 row_mask:0xf bank_mask:0xf
    v_mul_f32_dpp v199, v242, v89 row_newbcast:9 row_mask:0xf bank_mask:0xf
    v_mul_f32_dpp v200, v242, v92 row_newbcast:2 row_mask:0xf bank_mask:0xf
    v_mul_f32_dpp v201, v242, v93 row_newbcast:3 row_mask:0xf bank_mask:0xf
    s_add_u32 m0, s21, 2048
    v_mfma_f32_32x32x16_bf16 v[48:63], v[84:87], v[176:179], v[48:63]
    buffer_load_dwordx4 v236, s[4:7], s35 offen  lds
    buffer_load_dwordx4 v237, s[8:11], s35 offen offset:1024  lds
    ds_read_b64_tr_b16 v[176:177], v244 offset:4096
    ds_read_b64_tr_b16 v[178:179], v244 offset:5120
    ds_read_b64_tr_b16 v[188:189], v245 offset:4096
    ds_read_b64_tr_b16 v[190:191], v245 offset:5120
    v_mul_f32_dpp v202, v242, v92 row_newbcast:10 row_mask:0xf bank_mask:0xf
    v_mul_f32_dpp v203, v242, v93 row_newbcast:11 row_mask:0xf bank_mask:0xf
    v_cvt_pk_bf16_f32 v88, v196, v197
    v_cvt_pk_bf16_f32 v92, v198, v199
    v_cvt_pk_bf16_f32 v89, v200, v201
    v_cvt_pk_bf16_f32 v93, v202, v203
    v_mul_f32_dpp v196, v242, v90 row_newbcast:4 row_mask:0xf bank_mask:0xf
    v_mul_f32_dpp v197, v242, v91 row_newbcast:5 row_mask:0xf bank_mask:0xf
    v_mul_f32_dpp v198, v242, v90 row_newbcast:12 row_mask:0xf bank_mask:0xf
    v_mul_f32_dpp v199, v242, v91 row_newbcast:13 row_mask:0xf bank_mask:0xf
    v_mul_f32_dpp v200, v242, v94 row_newbcast:6 row_mask:0xf bank_mask:0xf
    v_mul_f32_dpp v201, v242, v95 row_newbcast:7 row_mask:0xf bank_mask:0xf
    v_mul_f32_dpp v202, v242, v94 row_newbcast:14 row_mask:0xf bank_mask:0xf
    v_mul_f32_dpp v203, v242, v95 row_newbcast:15 row_mask:0xf bank_mask:0xf
    v_cvt_pk_bf16_f32 v90, v196, v197
    v_cvt_pk_bf16_f32 v94, v198, v199
    v_cvt_pk_bf16_f32 v91, v200, v201
    v_cvt_pk_bf16_f32 v95, v202, v203
    s_waitcnt vmcnt(4) lgkmcnt(0)
    v_mfma_f32_32x32x16_bf16 v[0:15], v[88:91], v[176:179], v[0:15]
    v_mul_f32_dpp v196, v243, v64 row_newbcast:0 row_mask:0xf bank_mask:0xf
    v_mul_f32_dpp v197, v243, v65 row_newbcast:1 row_mask:0xf bank_mask:0xf
    v_mul_f32_dpp v198, v243, v64 row_newbcast:8 row_mask:0xf bank_mask:0xf
    v_mul_f32_dpp v199, v243, v65 row_newbcast:9 row_mask:0xf bank_mask:0xf
    v_mul_f32_dpp v200, v243, v68 row_newbcast:2 row_mask:0xf bank_mask:0xf
    v_mul_f32_dpp v201, v243, v69 row_newbcast:3 row_mask:0xf bank_mask:0xf
    s_add_u32 m0, s21, 4096
    v_mfma_f32_32x32x16_bf16 v[48:63], v[92:95], v[176:179], v[48:63]
    buffer_load_dwordx4 v238, s[4:7], s35 offen  lds
    buffer_load_dwordx4 v239, s[8:11], s35 offen offset:1024  lds
    ds_read_b64_tr_b16 v[176:177], v244 offset:6144
    ds_read_b64_tr_b16 v[178:179], v244 offset:7168
    ds_read_b64_tr_b16 v[192:193], v245 offset:6144
    ds_read_b64_tr_b16 v[194:195], v245 offset:7168
    v_mul_f32_dpp v202, v243, v68 row_newbcast:10 row_mask:0xf bank_mask:0xf
    v_mul_f32_dpp v203, v243, v69 row_newbcast:11 row_mask:0xf bank_mask:0xf
    v_cvt_pk_bf16_f32 v64, v196, v197
    v_cvt_pk_bf16_f32 v68, v198, v199
    v_cvt_pk_bf16_f32 v65, v200, v201
    v_cvt_pk_bf16_f32 v69, v202, v203
    v_mul_f32_dpp v196, v243, v66 row_newbcast:4 row_mask:0xf bank_mask:0xf
    v_mul_f32_dpp v197, v243, v67 row_newbcast:5 row_mask:0xf bank_mask:0xf
    v_mul_f32_dpp v198, v243, v66 row_newbcast:12 row_mask:0xf bank_mask:0xf
    v_mul_f32_dpp v199, v243, v67 row_newbcast:13 row_mask:0xf bank_mask:0xf
    v_mul_f32_dpp v200, v243, v70 row_newbcast:6 row_mask:0xf bank_mask:0xf
    v_mul_f32_dpp v201, v243, v71 row_newbcast:7 row_mask:0xf bank_mask:0xf
    v_mul_f32_dpp v202, v243, v70 row_newbcast:14 row_mask:0xf bank_mask:0xf
    v_mul_f32_dpp v203, v243, v71 row_newbcast:15 row_mask:0xf bank_mask:0xf
    v_cvt_pk_bf16_f32 v66, v196, v197
    v_cvt_pk_bf16_f32 v70, v198, v199
    v_cvt_pk_bf16_f32 v67, v200, v201
    v_cvt_pk_bf16_f32 v71, v202, v203
    s_waitcnt lgkmcnt(0)
    v_mfma_f32_32x32x16_bf16 v[0:15], v[64:67], v[176:179], v[0:15]
    s_add_u32 m0, s21, 6144
    v_mfma_f32_32x32x16_bf16 v[48:63], v[68:71], v[176:179], v[48:63]
    buffer_load_dwordx4 v240, s[4:7], s35 offen  lds
    buffer_load_dwordx4 v241, s[8:11], s35 offen offset:1024  lds
    s_mov_b32 m0, s50
    s_nop 0
    s_movrels_b32 s71, s23
    s_movrels_b32 s33, s28
    v_add_u32 v253, s33, v248
    s_bfe_u32 s46, s71, 0x30012
    s_mov_b32 m0, s46
    s_and_b32 s66, s71, 0x3ffff
    s_movrels_b32 s68, s57
    s_movrels_b32 s69, s61
    s_sub_u32 s48, s66, s47
    s_mov_b32 s47, s66
    s_lshr_b32 s52, s71, 28
    s_lshl_b32 s67, s46, 9
    s_add_u32 s66, s66, s67
    s_sub_u32 s49, s66, s42
    s_mov_b32 s42, s66
    s_bfe_u32 s66, s68, 655360
    s_add_u32 s43, s42, s66
    s_bfe_u32 s39, s69, 655360
    s_bfe_u32 s66, s68, 655370
    s_add_u32 s44, s42, s66
    s_bfe_u32 s40, s69, 655370
    s_bfe_u32 s66, s68, 655380
    s_add_u32 s45, s42, s66
    s_bfe_u32 s41, s69, 655380
    v_mfma_f32_32x32x16_bf16 v[16:31], v[72:75], v[180:183], 0
    v_mul_f32 v196, v0, v96
    v_fmac_f32 v196, v1, v97
    v_fmac_f32 v196, v2, v98
    v_fmac_f32 v196, v3, v99
    v_fmac_f32 v196, v4, v100
    v_fmac_f32 v196, v5, v101
    v_mfma_f32_32x32x16_bf16 v[32:47], v[76:79], v[180:183], 0
    v_fmac_f32 v196, v6, v102
    v_fmac_f32 v196, v7, v103
    v_mul_f32 v198, v8, v128
    v_fmac_f32 v198, v9, v129
    v_fmac_f32 v198, v10, v130
    v_fmac_f32 v198, v11, v131
    v_mfma_f32_32x32x16_bf16 v[16:31], v[80:83], v[184:187], v[16:31]
    v_fmac_f32 v198, v12, v132
    v_fmac_f32 v198, v13, v133
    v_fmac_f32 v198, v14, v134
    v_fmac_f32 v198, v15, v135
    v_mul_f32 v200, v48, v128
    v_fmac_f32 v200, v49, v129
    v_mfma_f32_32x32x16_bf16 v[32:47], v[84:87], v[184:187], v[32:47]
    v_permlane32_swap_b32 v196, v198
    v_fmac_f32 v200, v50, v130
    v_fmac_f32 v200, v51, v131
    v_fmac_f32 v200, v52, v132
    v_fmac_f32 v200, v53, v133
    v_fmac_f32 v200, v54, v134
    v_mfma_f32_32x32x16_bf16 v[16:31], v[88:91], v[188:191], v[16:31]
    v_fmac_f32 v200, v55, v135
    v_add_f32 v198, v196, v198
    v_mul_f32_e64 v202, v56, -v128
    v_fma_f32 v202, v57, -v129, v202
    v_fma_f32 v202, v58, -v130, v202
    v_fma_f32 v202, v59, -v131, v202
    v_mfma_f32_32x32x16_bf16 v[32:47], v[92:95], v[188:191], v[32:47]
    s_waitcnt vmcnt(6)
    ds_read_b64_tr_b16 v[176:177], v244 offset:0
    ds_read_b64_tr_b16 v[178:179], v244 offset:1024
    ds_read_b64_tr_b16 v[180:181], v245 offset:0
    ds_read_b64_tr_b16 v[182:183], v245 offset:1024
    v_fma_f32 v202, v60, -v132, v202
    v_fma_f32 v202, v61, -v133, v202
    v_mfma_f32_32x32x16_bf16 v[16:31], v[64:67], v[192:195], v[16:31]
    v_fma_f32 v202, v62, -v134, v202
    v_fma_f32 v202, v63, -v135, v202
    s_nop 1
    v_permlane32_swap_b32 v200, v202
    v_add_f32 v202, v200, v202
    v_mfma_f32_32x32x16_bf16 v[32:47], v[68:71], v[192:195], v[32:47]
    s_waitcnt vmcnt(4) lgkmcnt(0)
    v_mfma_f32_32x32x16_bf16 v[0:15], v[72:75], v[176:179], 0
    s_nop 2
    v_mul_f32 v197, v16, v104
    v_fmac_f32 v197, v17, v105
    v_fmac_f32 v197, v18, v106
    v_fmac_f32 v197, v19, v107
    v_fmac_f32 v197, v20, v108
    v_fmac_f32 v197, v21, v109
    s_add_u32 m0, s21, 0
    v_mfma_f32_32x32x16_bf16 v[48:63], v[76:79], v[176:179], 0
    buffer_load_dwordx4 v234, s[4:7], s36 offen  lds
    buffer_load_dwordx4 v235, s[8:11], s36 offen offset:1024  lds
    ds_read_b64_tr_b16 v[176:177], v244 offset:2048
    ds_read_b64_tr_b16 v[178:179], v244 offset:3072
    ds_read_b64_tr_b16 v[184:185], v245 offset:2048
    ds_read_b64_tr_b16 v[186:187], v245 offset:3072
    v_fmac_f32 v197, v22, v110
    v_fmac_f32 v197, v23, v111
    v_mul_f32 v199, v24, v136
    v_fmac_f32 v199, v25, v137
    v_fmac_f32 v199, v26, v138
    v_fmac_f32 v199, v27, v139
    v_fmac_f32 v199, v28, v140
    v_fmac_f32 v199, v29, v141
    v_fmac_f32 v199, v30, v142
    v_fmac_f32 v199, v31, v143
    v_mul_f32 v201, v32, v136
    s_waitcnt vmcnt(4) lgkmcnt(0)
    v_mfma_f32_32x32x16_bf16 v[0:15], v[80:83], v[176:179], v[0:15]
    v_fmac_f32 v201, v33, v137
    v_permlane32_swap_b32 v197, v199
    v_fmac_f32 v201, v34, v138
    v_fmac_f32 v201, v35, v139
    v_fmac_f32 v201, v36, v140
    v_fmac_f32 v201, v37, v141
    s_add_u32 m0, s21, 2048
    v_mfma_f32_32x32x16_bf16 v[48:63], v[84:87], v[176:179], v[48:63]
    buffer_load_dwordx4 v236, s[4:7], s36 offen  lds
    buffer_load_dwordx4 v237, s[8:11], s36 offen offset:1024  lds
    ds_read_b64_tr_b16 v[176:177], v244 offset:4096
    ds_read_b64_tr_b16 v[178:179], v244 offset:5120
    ds_read_b64_tr_b16 v[188:189], v245 offset:4096
    ds_read_b64_tr_b16 v[190:191], v245 offset:5120
    s_waitcnt vmcnt(4) lgkmcnt(0)
    v_mfma_f32_32x32x16_bf16 v[0:15], v[88:91], v[176:179], v[0:15]
    v_fmac_f32 v201, v38, v142
    v_fmac_f32 v201, v39, v143
    v_add_f32 v199, v197, v199
    v_mul_f32_e64 v203, v40, -v136
    v_fma_f32 v203, v41, -v137, v203
    v_fma_f32 v203, v42, -v138, v203
    s_add_u32 m0, s21, 4096
    v_mfma_f32_32x32x16_bf16 v[48:63], v[92:95], v[176:179], v[48:63]
    buffer_load_dwordx4 v238, s[4:7], s36 offen  lds
    buffer_load_dwordx4 v239, s[8:11], s36 offen offset:1024  lds
    ds_read_b64_tr_b16 v[176:177], v244 offset:6144
    ds_read_b64_tr_b16 v[178:179], v244 offset:7168
    ds_read_b64_tr_b16 v[192:193], v245 offset:6144
    ds_read_b64_tr_b16 v[194:195], v245 offset:7168
    s_waitcnt lgkmcnt(0)
    v_mfma_f32_32x32x16_bf16 v[0:15], v[64:67], v[176:179], v[0:15]
    v_fma_f32 v203, v43, -v139, v203
    v_fma_f32 v203, v44, -v140, v203
    v_fma_f32 v203, v45, -v141, v203
    v_fma_f32 v203, v46, -v142, v203
    v_fma_f32 v203, v47, -v143, v203
    s_nop 1
    v_permlane32_swap_b32 v201, v203
    s_add_u32 m0, s21, 6144
    v_mfma_f32_32x32x16_bf16 v[48:63], v[68:71], v[176:179], v[48:63]
    buffer_load_dwordx4 v240, s[4:7], s36 offen  lds
    buffer_load_dwordx4 v241, s[8:11], s36 offen offset:1024  lds
    v_add_f32 v203, v201, v203
    v_cvt_pk_bf16_f32 v198, v198, v199
    v_cvt_pk_bf16_f32 v202, v202, v203
    ds_write2st64_b32 v253, v198, v202 offset0:0 offset1:1
    v_mfma_f32_32x32x16_bf16 v[16:31], v[72:75], v[180:183], 0
    v_mul_f32 v196, v0, v144
    v_fmac_f32 v196, v1, v145
    v_fmac_f32 v196, v2, v146
    v_fmac_f32 v196, v3, v147
    v_fmac_f32 v196, v4, v148
    v_fmac_f32 v196, v5, v149
    v_mfma_f32_32x32x16_bf16 v[32:47], v[76:79], v[180:183], 0
    v_fmac_f32 v196, v6, v150
    v_fmac_f32 v196, v7, v151
    v_mul_f32 v198, v8, v112
    v_fmac_f32 v198, v9, v113
    v_fmac_f32 v198, v10, v114
    v_fmac_f32 v198, v11, v115
    v_mfma_f32_32x32x16_bf16 v[16:31], v[80:83], v[184:187], v[16:31]
    v_fmac_f32 v198, v12, v116
    v_fmac_f32 v198, v13, v117
    v_fmac_f32 v198, v14, v118
    v_fmac_f32 v198, v15, v119
    v_mul_f32_e64 v200, v48, -v160
    v_fma_f32 v200, v49, -v161, v200
    v_mfma_f32_32x32x16_bf16 v[32:47], v[84:87], v[184:187], v[32:47]
    v_fma_f32 v200, v50, -v162, v200
    v_fma_f32 v200, v51, -v163, v200
    v_fma_f32 v200, v52, -v164, v200
    v_fma_f32 v200, v53, -v165, v200
    v_fma_f32 v200, v54, -v166, v200
    v_fma_f32 v200, v55, -v167, v200
    v_mfma_f32_32x32x16_bf16 v[16:31], v[88:91], v[188:191], v[16:31]
    v_mul_f32_e64 v202, v56, -v160
    v_fma_f32 v202, v57, -v161, v202
    v_fma_f32 v202, v58, -v162, v202
    v_fma_f32 v202, v59, -v163, v202
    v_fma_f32 v202, v60, -v164, v202
    v_fma_f32 v202, v61, -v165, v202
    v_mfma_f32_32x32x16_bf16 v[32:47], v[92:95], v[188:191], v[32:47]
    s_waitcnt vmcnt(6)
    ds_read_b64_tr_b16 v[176:177], v244 offset:0
    ds_read_b64_tr_b16 v[178:179], v244 offset:1024
    ds_read_b64_tr_b16 v[180:181], v245 offset:0
    ds_read_b64_tr_b16 v[182:183], v245 offset:1024
    v_fma_f32 v202, v62, -v166, v202
    v_fma_f32 v202, v63, -v167, v202
    v_mfma_f32_32x32x16_bf16 v[16:31], v[64:67], v[192:195], v[16:31]
    v_mfma_f32_32x32x16_bf16 v[32:47], v[68:71], v[192:195], v[32:47]
    s_waitcnt vmcnt(4) lgkmcnt(0)
    v_mfma_f32_32x32x16_bf16 v[0:15], v[72:75], v[176:179], 0
    s_nop 8
    v_mul_f32 v197, v16, v152
    v_fmac_f32 v197, v17, v153
    v_fmac_f32 v197, v18, v154
    v_fmac_f32 v197, v19, v155
    v_fmac_f32 v197, v20, v156
    v_fmac_f32 v197, v21, v157
    s_add_u32 m0, s21, 0
    v_mfma_f32_32x32x16_bf16 v[48:63], v[76:79], v[176:179], 0
    buffer_load_dwordx4 v234, s[4:7], s37 offen  lds
    buffer_load_dwordx4 v235, s[8:11], s37 offen offset:1024  lds
    ds_read_b64_tr_b16 v[176:177], v244 offset:2048
    ds_read_b64_tr_b16 v[178:179], v244 offset:3072
    ds_read_b64_tr_b16 v[184:185], v245 offset:2048
    ds_read_b64_tr_b16 v[186:187], v245 offset:3072
    v_add_u32 v252, s42, v247
    ds_read2_b32 v[234:235], v252 offset0:0 offset1:16
    v_fmac_f32 v197, v22, v158
    v_fmac_f32 v197, v23, v159
    v_mul_f32 v199, v24, v120
    v_fmac_f32 v199, v25, v121
    v_fmac_f32 v199, v26, v122
    v_fmac_f32 v199, v27, v123
    s_waitcnt vmcnt(4) lgkmcnt(1)
    v_mfma_f32_32x32x16_bf16 v[0:15], v[80:83], v[176:179], v[0:15]
    v_fmac_f32 v199, v28, v124
    v_fmac_f32 v199, v29, v125
    v_fmac_f32 v199, v30, v126
    v_fmac_f32 v199, v31, v127
    v_mul_f32_e64 v201, v32, -v168
    v_fma_f32 v201, v33, -v169, v201
    s_add_u32 m0, s21, 2048
    v_mfma_f32_32x32x16_bf16 v[48:63], v[84:87], v[176:179], v[48:63]
    buffer_load_dwordx4 v236, s[4:7], s37 offen  lds
    buffer_load_dwordx4 v237, s[8:11], s37 offen offset:1024  lds
    ds_read_b64_tr_b16 v[176:177], v244 offset:4096
    ds_read_b64_tr_b16 v[178:179], v244 offset:5120
    ds_read_b64_tr_b16 v[188:189], v245 offset:4096
    ds_read_b64_tr_b16 v[190:191], v245 offset:5120
    v_add_u32 v252, s43, v247
    ds_read2_b32 v[236:237], v252 offset0:0 offset1:16
    s_waitcnt vmcnt(4) lgkmcnt(1)
    v_mfma_f32_32x32x16_bf16 v[0:15], v[88:91], v[176:179], v[0:15]
    v_fma_f32 v201, v34, -v170, v201
    v_fma_f32 v201, v35, -v171, v201
    v_fma_f32 v201, v36, -v172, v201
    v_fma_f32 v201, v37, -v173, v201
    v_fma_f32 v201, v38, -v174, v201
    v_fma_f32 v201, v39, -v175, v201
    s_add_u32 m0, s21, 4096
    v_mfma_f32_32x32x16_bf16 v[48:63], v[92:95], v[176:179], v[48:63]
    buffer_load_dwordx4 v238, s[4:7], s37 offen  lds
    buffer_load_dwordx4 v239, s[8:11], s37 offen offset:1024  lds
    ds_read_b64_tr_b16 v[176:177], v244 offset:6144
    ds_read_b64_tr_b16 v[178:179], v244 offset:7168
    ds_read_b64_tr_b16 v[192:193], v245 offset:6144
    ds_read_b64_tr_b16 v[194:195], v245 offset:7168
    v_add_u32 v252, s44, v247
    ds_read2_b32 v[238:239], v252 offset0:0 offset1:16
    s_waitcnt lgkmcnt(1)
    v_mfma_f32_32x32x16_bf16 v[0:15], v[64:67], v[176:179], v[0:15]
    v_mul_f32_e64 v203, v40, -v168
    v_fma_f32 v203, v41, -v169, v203
    v_fma_f32 v203, v42, -v170, v203
    v_fma_f32 v203, v43, -v171, v203
    v_fma_f32 v203, v44, -v172, v203
    v_fma_f32 v203, v45, -v173, v203
    s_add_u32 m0, s21, 6144
    v_mfma_f32_32x32x16_bf16 v[48:63], v[68:71], v[176:179], v[48:63]
    buffer_load_dwordx4 v240, s[4:7], s37 offen  lds
    buffer_load_dwordx4 v241, s[8:11], s37 offen offset:1024  lds
    v_add_u32 v252, s45, v247
    ds_read2_b32 v[240:241], v252 offset0:0 offset1:16
    v_fma_f32 v203, v46, -v174, v203
    v_fma_f32 v203, v47, -v175, v203
    v_mfma_f32_32x32x16_bf16 v[16:31], v[72:75], v[180:183], 0
    v_mul_f32 v254, v0, v144
    v_fmac_f32 v254, v1, v145
    v_fmac_f32 v254, v2, v146
    v_fmac_f32 v254, v3, v147
    v_fmac_f32 v254, v4, v148
    v_fmac_f32 v254, v5, v149
    v_mfma_f32_32x32x16_bf16 v[32:47], v[76:79], v[180:183], 0
    ds_swizzle_b32 v76, v76 offset:0x401F
    ds_swizzle_b32 v77, v77 offset:0x401F
    ds_swizzle_b32 v78, v78 offset:0x401F
    ds_swizzle_b32 v79, v79 offset:0x401F
    v_fmac_f32 v254, v6, v150
    v_fmac_f32 v254, v7, v151
    v_mfma_f32_32x32x16_bf16 v[16:31], v[80:83], v[184:187], v[16:31]
    v_fmac_f32 v200, v8, v160
    v_fmac_f32 v200, v9, v161
    v_permlane32_swap_b32 v196, v254
    v_fmac_f32 v200, v10, v162
    v_fmac_f32 v200, v11, v163
    v_fmac_f32 v200, v12, v164
    v_mfma_f32_32x32x16_bf16 v[32:47], v[84:87], v[184:187], v[32:47]
    ds_swizzle_b32 v84, v84 offset:0x401F
    ds_swizzle_b32 v85, v85 offset:0x401F
    ds_swizzle_b32 v86, v86 offset:0x401F
    ds_swizzle_b32 v87, v87 offset:0x401F
    v_fmac_f32 v200, v13, v165
    v_fmac_f32 v200, v14, v166
    v_mfma_f32_32x32x16_bf16 v[16:31], v[88:91], v[188:191], v[16:31]
    v_fmac_f32 v200, v15, v167
    v_add_f32 v254, v196, v254
    v_mfma_f32_32x32x16_bf16 v[32:47], v[92:95], v[188:191], v[32:47]
    ds_swizzle_b32 v92, v92 offset:0x401F
    ds_swizzle_b32 v93, v93 offset:0x401F
    ds_swizzle_b32 v94, v94 offset:0x401F
    ds_swizzle_b32 v95, v95 offset:0x401F
    s_waitcnt vmcnt(6)
    ds_read_b64_tr_b16 v[176:177], v244 offset:0
    ds_read_b64_tr_b16 v[178:179], v244 offset:1024
    ds_read_b64_tr_b16 v[180:181], v245 offset:0
    ds_read_b64_tr_b16 v[182:183], v245 offset:1024
    v_mfma_f32_32x32x16_bf16 v[16:31], v[64:67], v[192:195], v[16:31]
    v_mfma_f32_32x32x16_bf16 v[32:47], v[68:71], v[192:195], v[32:47]
    ds_swizzle_b32 v68, v68 offset:0x401F
    ds_swizzle_b32 v69, v69 offset:0x401F
    ds_swizzle_b32 v70, v70 offset:0x401F
    ds_swizzle_b32 v71, v71 offset:0x401F
    s_waitcnt lgkmcnt(8)
    s_mov_b64 exec, s[56:57]
    v_xor_b32 v76, 0x80008000, v76
    v_xor_b32 v77, 0x80008000, v77
    v_xor_b32 v78, 0x80008000, v78
    v_xor_b32 v79, 0x80008000, v79
    v_xor_b32 v84, 0x80008000, v84
    v_xor_b32 v85, 0x80008000, v85
    v_xor_b32 v86, 0x80008000, v86
    v_xor_b32 v87, 0x80008000, v87
    v_xor_b32 v92, 0x80008000, v92
    v_xor_b32 v93, 0x80008000, v93
    v_xor_b32 v94, 0x80008000, v94
    v_xor_b32 v95, 0x80008000, v95
    s_mov_b64 exec, -1
    s_waitcnt vmcnt(4) lgkmcnt(4)
    v_mfma_f32_32x32x16_bf16 v[0:15], v[72:75], v[176:179], 0
    v_mul_f32 v255, v16, v152
    v_fmac_f32 v255, v17, v153
    v_fmac_f32 v255, v18, v154
    v_fmac_f32 v255, v19, v155
    v_fmac_f32 v255, v20, v156
    v_fmac_f32 v255, v21, v157
    s_add_u32 m0, s21, 0
    v_mfma_f32_32x32x16_bf16 v[48:63], v[76:79], v[176:179], v[48:63]
    s_cbranch_vccnz WL_8_0
    v_mad_u32_u16 v234, v234, s3, v246 op_sel:[1,0,0,0]
    v_mad_u32_u16 v235, v235, s3, v246 op_sel:[1,0,0,0]
    buffer_load_dwordx4 v234, s[4:7], s38 offen  lds
    buffer_load_dwordx4 v235, s[8:11], s38 offen offset:1024  lds
WR_8_0:
    ds_read_b64_tr_b16 v[176:177], v244 offset:2048
    ds_read_b64_tr_b16 v[178:179], v244 offset:3072
    ds_read_b64_tr_b16 v[184:185], v245 offset:2048
    ds_read_b64_tr_b16 v[186:187], v245 offset:3072
    s_waitcnt vmcnt(4) lgkmcnt(0)
    v_mfma_f32_32x32x16_bf16 v[0:15], v[80:83], v[176:179], v[0:15]
    s_add_u32 m0, s21, 2048
    v_mfma_f32_32x32x16_bf16 v[48:63], v[84:87], v[176:179], v[48:63]
    s_cbranch_vccnz WL_8_1
    v_mad_u32_u16 v236, v236, s3, v246 op_sel:[1,0,0,0]
    v_mad_u32_u16 v237, v237, s3, v246 op_sel:[1,0,0,0]
    buffer_load_dwordx4 v236, s[4:7], s39 offen  lds
    buffer_load_dwordx4 v237, s[8:11], s39 offen offset:1024  lds
WR_8_1:
    ds_read_b64_tr_b16 v[176:177], v244 offset:4096
    ds_read_b64_tr_b16 v[178:179], v244 offset:5120
    ds_read_b64_tr_b16 v[188:189], v245 offset:4096
    ds_read_b64_tr_b16 v[190:191], v245 offset:5120
    s_waitcnt vmcnt(4) lgkmcnt(0)
    v_mfma_f32_32x32x16_bf16 v[0:15], v[88:91], v[176:179], v[0:15]
    v_fmac_f32 v255, v22, v158
    v_fmac_f32 v255, v23, v159
    v_fmac_f32 v201, v24, v168
    v_fmac_f32 v201, v25, v169
    v_permlane32_swap_b32 v197, v255
    v_fmac_f32 v201, v26, v170
    s_add_u32 m0, s21, 4096
    v_mfma_f32_32x32x16_bf16 v[48:63], v[92:95], v[176:179], v[48:63]
    s_cbranch_vccnz WL_8_2
    v_mad_u32_u16 v238, v238, s3, v246 op_sel:[1,0,0,0]
    v_mad_u32_u16 v239, v239, s3, v246 op_sel:[1,0,0,0]
    buffer_load_dwordx4 v238, s[4:7], s40 offen  lds
    buffer_load_dwordx4 v239, s[8:11], s40 offen offset:1024  lds
WR_8_2:
    ds_read_b64_tr_b16 v[176:177], v244 offset:6144
    ds_read_b64_tr_b16 v[178:179], v244 offset:7168
    ds_read_b64_tr_b16 v[192:193], v245 offset:6144
    ds_read_b64_tr_b16 v[194:195], v245 offset:7168
    s_waitcnt lgkmcnt(0)
    s_mov_b64 exec, s[56:57]
    v_xor_b32 v68, 0x80008000, v68
    v_xor_b32 v69, 0x80008000, v69
    v_xor_b32 v70, 0x80008000, v70
    v_xor_b32 v71, 0x80008000, v71
    s_mov_b64 exec, -1
    v_mfma_f32_32x32x16_bf16 v[0:15], v[64:67], v[176:179], v[0:15]
    v_fmac_f32 v201, v27, v171
    v_fmac_f32 v201, v28, v172
    v_fmac_f32 v201, v29, v173
    v_fmac_f32 v201, v30, v174
    v_fmac_f32 v201, v31, v175
    v_add_f32 v255, v197, v255
    s_add_u32 m0, s21, 6144
    v_mfma_f32_32x32x16_bf16 v[48:63], v[68:71], v[176:179], v[48:63]
    s_cbranch_vccnz WL_8_3
    v_mad_u32_u16 v240, v240, s3, v246 op_sel:[1,0,0,0]
    v_mad_u32_u16 v241, v241, s3, v246 op_sel:[1,0,0,0]
    buffer_load_dwordx4 v240, s[4:7], s41 offen  lds
    buffer_load_dwordx4 v241, s[8:11], s41 offen offset:1024  lds
WR_8_3:
    v_cvt_pk_bf16_f32 v254, v254, v255
    ds_write_b32 v253, v254 offset:512
    v_mfma_f32_32x32x16_bf16 v[16:31], v[72:75], v[180:183], 0
    v_mul_f32 v254, v0, v144
    v_fmac_f32 v254, v1, v145
    v_fmac_f32 v254, v2, v146
    v_fmac_f32 v254, v3, v147
    v_fmac_f32 v254, v4, v148
    v_fmac_f32 v254, v5, v149
    v_mfma_f32_32x32x16_bf16 v[32:47], v[76:79], v[180:183], v[32:47]
    v_fmac_f32 v254, v6, v150
    v_fmac_f32 v254, v7, v151
    v_fma_f32 v202, v8, -v160, v202
    v_fma_f32 v202, v9, -v161, v202
    v_permlane32_swap_b32 v254, v200
    v_fma_f32 v202, v10, -v162, v202
    v_mfma_f32_32x32x16_bf16 v[16:31], v[80:83], v[184:187], v[16:31]
    v_fma_f32 v202, v11, -v163, v202
    v_fma_f32 v202, v12, -v164, v202
    v_fma_f32 v202, v13, -v165, v202
    v_fma_f32 v202, v14, -v166, v202
    v_fma_f32 v202, v15, -v167, v202
    v_add_f32 v200, v254, v200
    v_mfma_f32_32x32x16_bf16 v[32:47], v[84:87], v[184:187], v[32:47]
    v_fmac_f32 v198, v48, v112
    v_permlane32_swap_b32 v202, v254
    v_fmac_f32 v198, v49, v113
    v_fmac_f32 v198, v50, v114
    v_fmac_f32 v198, v51, v115
    v_fmac_f32 v198, v52, v116
    v_mfma_f32_32x32x16_bf16 v[16:31], v[88:91], v[188:191], v[16:31]
    v_fmac_f32 v198, v53, v117
    v_fmac_f32 v198, v54, v118
    v_fmac_f32 v198, v55, v119
    v_add_f32 v254, v202, v254
    v_mul_f32 v196, v56, v160
    v_fmac_f32 v196, v57, v161
    v_mfma_f32_32x32x16_bf16 v[32:47], v[92:95], v[188:191], v[32:47]
    s_waitcnt vmcnt(6)
    ds_read_b64_tr_b16 v[176:177], v244 offset:0
    ds_read_b64_tr_b16 v[178:179], v244 offset:1024
    ds_read_b64_tr_b16 v[180:181], v245 offset:0
    ds_read_b64_tr_b16 v[182:183], v245 offset:1024
    v_fmac_f32 v196, v58, v162
    v_fmac_f32 v196, v59, v163
    v_mfma_f32_32x32x16_bf16 v[16:31], v[64:67], v[192:195], v[16:31]
    v_fmac_f32 v196, v60, v164
    v_fmac_f32 v196, v61, v165
    v_fmac_f32 v196, v62, v166
    v_fmac_f32 v196, v63, v167
    s_nop 1
    v_permlane32_swap_b32 v198, v196
    v_add_f32 v196, v198, v196
    v_mfma_f32_32x32x16_bf16 v[32:47], v[68:71], v[192:195], v[32:47]
    v_add_u32 v249, s48, v249
    v_add_u32 v250, s49, v250
    ds_read_b32 v252, v251 offset:16
    ds_read_b64_tr_b16 v[72:73], v249 offset:0
    ds_read_b64_tr_b16 v[76:77], v249 offset:64
    ds_read_b64_tr_b16 v[74:75], v249 offset:256
    ds_read_b64_tr_b16 v[78:79], v249 offset:320
    s_mov_b64 exec, s[54:55]
    ds_read_u16_d16_hi v242, v250 offset:0
    s_mov_b64 exec, -1
    s_cbranch_vccnz LEPI_1
    v_mul_f32 v255, v16, v152
    v_fmac_f32 v255, v17, v153
    v_fmac_f32 v255, v18, v154
    v_fmac_f32 v255, v19, v155
    v_fmac_f32 v255, v20, v156
    v_fmac_f32 v255, v21, v157
    v_fmac_f32 v255, v22, v158
    v_fmac_f32 v255, v23, v159
    v_fma_f32 v203, v24, -v168, v203
    v_fma_f32 v203, v25, -v169, v203
    v_permlane32_swap_b32 v255, v201
    v_fma_f32 v203, v26, -v170, v203
    v_fma_f32 v203, v27, -v171, v203
    v_fma_f32 v203, v28, -v172, v203
    v_fma_f32 v203, v29, -v173, v203
    v_fma_f32 v203, v30, -v174, v203
    v_fma_f32 v203, v31, -v175, v203
    v_add_f32 v201, v255, v201
    v_fmac_f32 v199, v32, v120
    v_permlane32_swap_b32 v203, v255
    v_fmac_f32 v199, v33, v121
    v_fmac_f32 v199, v34, v122
    v_fmac_f32 v199, v35, v123
    v_fmac_f32 v199, v36, v124
    v_fmac_f32 v199, v37, v125
    v_fmac_f32 v199, v38, v126
    v_fmac_f32 v199, v39, v127
    v_add_f32 v255, v203, v255
    v_mul_f32 v197, v40, v168
    v_fmac_f32 v197, v41, v169
    v_fmac_f32 v197, v42, v170
    v_fmac_f32 v197, v43, v171
    v_fmac_f32 v197, v44, v172
    v_fmac_f32 v197, v45, v173
    v_fmac_f32 v197, v46, v174
    v_fmac_f32 v197, v47, v175
    s_nop 1
    v_permlane32_swap_b32 v199, v197
    v_add_f32 v197, v199, v197
    v_cvt_pk_bf16_f32 v200, v200, v201
    v_cvt_pk_bf16_f32 v254, v254, v255
    v_cvt_pk_bf16_f32 v196, v196, v197
    ds_write2st64_b32 v253, v200, v196 offset0:3 offset1:4
    s_mov_b64 exec, 0xffffffff
    ds_write_b32 v253, v254 offset:1280
    s_mov_b64 exec, -1
    s_add_u32 s50, s50, 1
    s_cmp_ge_u32 s50, 4
    s_cbranch_scc1 LAST1
    s_waitcnt lgkmcnt(7)
    v_readfirstlane_b32 s66, v252
    s_add_u32 s53, s53, 1
    v_mov_b32 v252, s53
    s_cmp_le_u32 s53, s66
    ds_write2_b32 v251, v252, v252 offset0:0 offset1:8
    s_setprio 1
    s_cbranch_scc1 PRIO_15
    s_setprio 0
PRIO_15:
    s_cmp_eq_u32 s52, 4
    s_cbranch_scc1 ITEM_1_4
    s_cmp_eq_u32 s52, 5
    s_cbranch_scc1 ITEM_1_5
    s_cmp_eq_u32 s52, 3
    s_cbranch_scc1 ITEM_1_3
    s_cmp_eq_u32 s52, 6
    s_cbranch_scc1 ITEM_1_6
    s_cmp_eq_u32 s52, 8
    s_cbranch_scc1 ITEM_1_8
    s_branch ITEM_1_2
WL_8_0:
    s_add_u32 s66, s51, 0
    buffer_load_dwordx4 v[96:99], v246, s[16:19], s66 offen offset:2048 sc1
    buffer_load_dwordx4 v[100:103], v246, s[16:19], s66 offen offset:3072 sc1
    s_branch WR_8_0
WL_8_1:
    s_add_u32 s66, s51, 4096
    buffer_load_dwordx4 v[104:107], v246, s[16:19], s66 offen offset:2048 sc1
    buffer_load_dwordx4 v[108:111], v246, s[16:19], s66 offen offset:3072 sc1
    s_branch WR_8_1
WL_8_2:
    s_add_u32 s66, s51, 8192
    buffer_load_dwordx4 v[128:131], v246, s[16:19], s66 offen offset:2048 sc1
    buffer_load_dwordx4 v[132:135], v246, s[16:19], s66 offen offset:3072 sc1
    s_branch WR_8_2
WL_8_3:
    s_add_u32 s66, s51, 12288
    buffer_load_dwordx4 v[136:139], v246, s[16:19], s66 offen offset:2048 sc1
    buffer_load_dwordx4 v[140:143], v246, s[16:19], s66 offen offset:3072 sc1
    s_branch WR_8_3
.p2align 6
ITEM_1_2:
    s_mov_b32 m0, s50
    s_nop 0
    s_movrels_b32 s71, s23
    s_movrels_b32 s33, s28
    v_add_u32 v253, s33, v248
    s_bfe_u32 s46, s71, 0x30012
    s_mov_b32 m0, s46
    s_and_b32 s66, s71, 0x3ffff
    s_movrels_b32 s68, s57
    s_movrels_b32 s69, s61
    s_sub_u32 s48, s66, s47
    s_mov_b32 s47, s66
    s_lshr_b32 s52, s71, 28
    s_lshl_b32 s67, s46, 9
    s_add_u32 s66, s66, s67
    s_sub_u32 s49, s66, s42
    s_mov_b32 s42, s66
    s_bfe_u32 s66, s68, 655360
    s_add_u32 s43, s42, s66
    s_bfe_u32 s39, s69, 655360
    s_bfe_u32 s66, s68, 655370
    s_add_u32 s44, s42, s66
    s_bfe_u32 s40, s69, 655370
    s_bfe_u32 s66, s68, 655380
    s_add_u32 s45, s42, s66
    s_bfe_u32 s41, s69, 655380
    v_add_u32 v252, s42, v247
    ds_read2_b32 v[234:235], v252 offset0:0 offset1:16
    v_add_u32 v252, s43, v247
    ds_read2_b32 v[236:237], v252 offset0:0 offset1:16
    v_add_u32 v252, s44, v247
    ds_read2_b32 v[238:239], v252 offset0:0 offset1:16
    v_add_u32 v252, s45, v247
    ds_read2_b32 v[240:241], v252 offset0:0 offset1:16
    s_waitcnt lgkmcnt(4)
    v_mul_f32_dpp v196, v242, v72 row_newbcast:0 row_mask:0xf bank_mask:0xf
    v_mul_f32_dpp v197, v242, v73 row_newbcast:1 row_mask:0xf bank_mask:0xf
    v_mul_f32_dpp v198, v242, v72 row_newbcast:8 row_mask:0xf bank_mask:0xf
    v_mul_f32_dpp v199, v242, v73 row_newbcast:9 row_mask:0xf bank_mask:0xf
    v_mul_f32_dpp v200, v242, v76 row_newbcast:2 row_mask:0xf bank_mask:0xf
    v_mul_f32_dpp v201, v242, v77 row_newbcast:3 row_mask:0xf bank_mask:0xf
    v_mul_f32_dpp v202, v242, v76 row_newbcast:10 row_mask:0xf bank_mask:0xf
    v_mul_f32_dpp v203, v242, v77 row_newbcast:11 row_mask:0xf bank_mask:0xf
    v_cvt_pk_bf16_f32 v72, v196, v197
    v_cvt_pk_bf16_f32 v76, v198, v199
    v_cvt_pk_bf16_f32 v73, v200, v201
    v_cvt_pk_bf16_f32 v77, v202, v203
    v_mul_f32_dpp v196, v242, v74 row_newbcast:4 row_mask:0xf bank_mask:0xf
    v_mul_f32_dpp v197, v242, v75 row_newbcast:5 row_mask:0xf bank_mask:0xf
    v_mul_f32_dpp v198, v242, v74 row_newbcast:12 row_mask:0xf bank_mask:0xf
    v_mul_f32_dpp v199, v242, v75 row_newbcast:13 row_mask:0xf bank_mask:0xf
    v_mul_f32_dpp v200, v242, v78 row_newbcast:6 row_mask:0xf bank_mask:0xf
    v_mul_f32_dpp v201, v242, v79 row_newbcast:7 row_mask:0xf bank_mask:0xf
    v_mul_f32_dpp v202, v242, v78 row_newbcast:14 row_mask:0xf bank_mask:0xf
    v_mul_f32_dpp v203, v242, v79 row_newbcast:15 row_mask:0xf bank_mask:0xf
    v_cvt_pk_bf16_f32 v74, v196, v197
    v_cvt_pk_bf16_f32 v78, v198, v199
    v_cvt_pk_bf16_f32 v75, v200, v201
    v_cvt_pk_bf16_f32 v79, v202, v203
    s_nop 0
    s_waitcnt lgkmcnt(3)
    v_mfma_f32_32x32x16_bf16 v[56:71], v[72:75], v[176:179], 0
    s_add_u32 m0, s21, 0
    v_mfma_f32_32x32x16_bf16 v[16:31], v[76:79], v[176:179], 0
    s_cbranch_vccnz WL_2_0
    v_mad_u32_u16 v234, v234, s3, v246 op_sel:[1,0,0,0]
    v_mad_u32_u16 v235, v235, s3, v246 op_sel:[1,0,0,0]
    buffer_load_dwordx4 v234, s[4:7], s38 offen  lds
    buffer_load_dwordx4 v235, s[8:11], s38 offen offset:1024  lds
WR_2_0:
    v_mfma_f32_32x32x16_bf16 v[32:47], v[72:75], v[180:183], 0
    s_nop 3
    v_mul_f32 v196, v56, v96
    v_fmac_f32 v196, v57, v97
    v_fmac_f32 v196, v58, v98
    v_fmac_f32 v196, v59, v99
    v_fmac_f32 v196, v60, v100
    v_fmac_f32 v196, v61, v101
    v_mfma_f32_32x32x16_bf16 v[0:15], v[76:79], v[180:183], 0
    s_waitcnt vmcnt(6)
    ds_read_b64_tr_b16 v[176:177], v244 offset:2048
    ds_read_b64_tr_b16 v[178:179], v244 offset:3072
    ds_read_b64_tr_b16 v[180:181], v245 offset:2048
    ds_read_b64_tr_b16 v[182:183], v245 offset:3072
    v_fmac_f32 v196, v62, v102
    v_fmac_f32 v196, v63, v103
    v_mul_f32 v198, v64, v128
    v_fmac_f32 v198, v65, v129
    v_fmac_f32 v198, v66, v130
    v_fmac_f32 v198, v67, v131
    v_fmac_f32 v198, v68, v132
    v_fmac_f32 v198, v69, v133
    v_fmac_f32 v198, v70, v134
    v_fmac_f32 v198, v71, v135
    v_mul_f32 v200, v16, v128
    v_fmac_f32 v200, v17, v129
    v_permlane32_swap_b32 v196, v198
    v_fmac_f32 v200, v18, v130
    v_fmac_f32 v200, v19, v131
    v_fmac_f32 v200, v20, v132
    v_fmac_f32 v200, v21, v133
    v_fmac_f32 v200, v22, v134
    v_fmac_f32 v200, v23, v135
    v_add_f32 v198, v196, v198
    v_mul_f32_e64 v202, v24, -v128
    v_fma_f32 v202, v25, -v129, v202
    v_fma_f32 v202, v26, -v130, v202
    v_fma_f32 v202, v27, -v131, v202
    v_fma_f32 v202, v28, -v132, v202
    v_fma_f32 v202, v29, -v133, v202
    v_fma_f32 v202, v30, -v134, v202
    v_fma_f32 v202, v31, -v135, v202
    s_nop 1
    v_permlane32_swap_b32 v200, v202
    v_add_f32 v202, v200, v202
    s_waitcnt lgkmcnt(0)
    v_mfma_f32_32x32x16_bf16 v[56:71], v[72:75], v[176:179], 0
    v_mul_f32 v197, v32, v104
    v_fmac_f32 v197, v33, v105
    v_fmac_f32 v197, v34, v106
    v_fmac_f32 v197, v35, v107
    v_fmac_f32 v197, v36, v108
    v_fmac_f32 v197, v37, v109
    s_add_u32 m0, s21, 2048
    v_mfma_f32_32x32x16_bf16 v[16:31], v[76:79], v[176:179], 0
    s_cbranch_vccnz WL_2_1
    v_mad_u32_u16 v236, v236, s3, v246 op_sel:[1,0,0,0]
    v_mad_u32_u16 v237, v237, s3, v246 op_sel:[1,0,0,0]
    buffer_load_dwordx4 v236, s[4:7], s39 offen  lds
    buffer_load_dwordx4 v237, s[8:11], s39 offen offset:1024  lds
WR_2_1:
    v_fmac_f32 v197, v38, v110
    v_fmac_f32 v197, v39, v111
    v_mul_f32 v199, v40, v136
    v_fmac_f32 v199, v41, v137
    v_fmac_f32 v199, v42, v138
    v_fmac_f32 v199, v43, v139
    v_fmac_f32 v199, v44, v140
    v_fmac_f32 v199, v45, v141
    v_fmac_f32 v199, v46, v142
    v_fmac_f32 v199, v47, v143
    v_mul_f32 v201, v0, v136
    v_fmac_f32 v201, v1, v137
    v_permlane32_swap_b32 v197, v199
    v_fmac_f32 v201, v2, v138
    v_fmac_f32 v201, v3, v139
    v_fmac_f32 v201, v4, v140
    v_fmac_f32 v201, v5, v141
    v_fmac_f32 v201, v6, v142
    v_fmac_f32 v201, v7, v143
    v_add_f32 v199, v197, v199
    v_mul_f32_e64 v203, v8, -v136
    v_fma_f32 v203, v9, -v137, v203
    v_fma_f32 v203, v10, -v138, v203
    v_fma_f32 v203, v11, -v139, v203
    v_fma_f32 v203, v12, -v140, v203
    v_fma_f32 v203, v13, -v141, v203
    v_fma_f32 v203, v14, -v142, v203
    v_fma_f32 v203, v15, -v143, v203
    s_nop 1
    v_permlane32_swap_b32 v201, v203
    v_add_f32 v203, v201, v203
    v_cvt_pk_bf16_f32 v192, v198, v199
    v_cvt_pk_bf16_f32 v193, v202, v203
    v_mfma_f32_32x32x16_bf16 v[32:47], v[72:75], v[180:183], 0
    v_mul_f32 v196, v56, v144
    v_fmac_f32 v196, v57, v145
    v_fmac_f32 v196, v58, v146
    v_fmac_f32 v196, v59, v147
    v_fmac_f32 v196, v60, v148
    v_fmac_f32 v196, v61, v149
    v_mfma_f32_32x32x16_bf16 v[0:15], v[76:79], v[180:183], 0
    s_waitcnt vmcnt(6)
    ds_read_b64_tr_b16 v[176:177], v244 offset:4096
    ds_read_b64_tr_b16 v[178:179], v244 offset:5120
    ds_read_b64_tr_b16 v[180:181], v245 offset:4096
    ds_read_b64_tr_b16 v[182:183], v245 offset:5120
    v_fmac_f32 v196, v62, v150
    v_fmac_f32 v196, v63, v151
    v_mul_f32_e64 v200, v16, -v160
    v_fma_f32 v200, v17, -v161, v200
    v_fma_f32 v200, v18, -v162, v200
    v_fma_f32 v200, v19, -v163, v200
    v_fma_f32 v200, v20, -v164, v200
    v_fma_f32 v200, v21, -v165, v200
    v_fma_f32 v200, v22, -v166, v200
    v_fma_f32 v200, v23, -v167, v200
    v_mul_f32_e64 v202, v24, -v160
    v_fma_f32 v202, v25, -v161, v202
    v_fma_f32 v202, v26, -v162, v202
    v_fma_f32 v202, v27, -v163, v202
    v_fma_f32 v202, v28, -v164, v202
    v_fma_f32 v202, v29, -v165, v202
    v_fma_f32 v202, v30, -v166, v202
    v_fma_f32 v202, v31, -v167, v202
    s_waitcnt lgkmcnt(0)
    v_mfma_f32_32x32x16_bf16 v[16:31], v[72:75], v[176:179], 0
    v_mul_f32 v197, v32, v152
    v_fmac_f32 v197, v33, v153
    v_fmac_f32 v197, v34, v154
    v_fmac_f32 v197, v35, v155
    v_fmac_f32 v197, v36, v156
    v_fmac_f32 v197, v37, v157
    s_add_u32 m0, s21, 4096
    v_mfma_f32_32x32x16_bf16 v[48:63], v[76:79], v[176:179], 0
    s_cbranch_vccnz WL_2_2
    v_mad_u32_u16 v238, v238, s3, v246 op_sel:[1,0,0,0]
    v_mad_u32_u16 v239, v239, s3, v246 op_sel:[1,0,0,0]
    buffer_load_dwordx4 v238, s[4:7], s40 offen  lds
    buffer_load_dwordx4 v239, s[8:11], s40 offen offset:1024  lds
WR_2_2:
    v_fmac_f32 v197, v38, v158
    v_fmac_f32 v197, v39, v159
    v_mul_f32_e64 v201, v0, -v168
    v_fma_f32 v201, v1, -v169, v201
    v_fma_f32 v201, v2, -v170, v201
    v_fma_f32 v201, v3, -v171, v201
    v_fma_f32 v201, v4, -v172, v201
    v_fma_f32 v201, v5, -v173, v201
    v_fma_f32 v201, v6, -v174, v201
    v_fma_f32 v201, v7, -v175, v201
    v_mul_f32_e64 v203, v8, -v168
    v_fma_f32 v203, v9, -v169, v203
    v_fma_f32 v203, v10, -v170, v203
    v_fma_f32 v203, v11, -v171, v203
    v_fma_f32 v203, v12, -v172, v203
    v_fma_f32 v203, v13, -v173, v203
    v_fma_f32 v203, v14, -v174, v203
    v_fma_f32 v203, v15, -v175, v203
    v_mfma_f32_32x32x16_bf16 v[0:15], v[72:75], v[180:183], 0
    v_fmac_f32 v200, v24, v160
    v_fmac_f32 v200, v25, v161
    v_fmac_f32 v200, v26, v162
    v_fmac_f32 v200, v27, v163
    v_fmac_f32 v200, v28, v164
    v_fmac_f32 v200, v29, v165
    v_fmac_f32 v200, v30, v166
    v_fmac_f32 v200, v31, v167
    v_mfma_f32_32x32x16_bf16 v[24:39], v[76:79], v[180:183], 0
    s_waitcnt vmcnt(6)
    ds_read_b64_tr_b16 v[176:177], v244 offset:6144
    ds_read_b64_tr_b16 v[178:179], v244 offset:7168
    ds_read_b64_tr_b16 v[180:181], v245 offset:6144
    ds_read_b64_tr_b16 v[182:183], v245 offset:7168
    v_mul_f32 v254, v16, v144
    v_fmac_f32 v254, v17, v145
    v_fmac_f32 v254, v18, v146
    v_fmac_f32 v254, v19, v147
    v_fmac_f32 v254, v20, v148
    v_fmac_f32 v254, v21, v149
    v_fmac_f32 v254, v22, v150
    v_fmac_f32 v254, v23, v151
    v_sub_f32_e64 v64, -v48, v64
    v_sub_f32_e64 v65, -v49, v65
    v_permlane32_swap_b32 v196, v254
    v_sub_f32_e64 v66, -v50, v66
    v_sub_f32_e64 v67, -v51, v67
    v_sub_f32_e64 v68, -v52, v68
    v_sub_f32_e64 v69, -v53, v69
    v_sub_f32_e64 v70, -v54, v70
    v_sub_f32_e64 v71, -v55, v71
    v_add_f32 v254, v196, v254
    s_waitcnt lgkmcnt(0)
    v_mfma_f32_32x32x16_bf16 v[56:71], v[76:79], v[176:179], v[56:71]
    v_sub_f32_e64 v40, -v24, v40
    v_sub_f32_e64 v41, -v25, v41
    v_sub_f32_e64 v42, -v26, v42
    v_sub_f32_e64 v43, -v27, v43
    v_sub_f32_e64 v44, -v28, v44
    v_sub_f32_e64 v45, -v29, v45
    v_sub_f32_e64 v46, -v30, v46
    v_sub_f32_e64 v47, -v31, v47
    s_add_u32 m0, s21, 6144
    v_mfma_f32_32x32x16_bf16 v[16:31], v[72:75], v[176:179], 0
    s_cbranch_vccnz WL_2_3
    v_mad_u32_u16 v240, v240, s3, v246 op_sel:[1,0,0,0]
    v_mad_u32_u16 v241, v241, s3, v246 op_sel:[1,0,0,0]
    buffer_load_dwordx4 v240, s[4:7], s41 offen  lds
    buffer_load_dwordx4 v241, s[8:11], s41 offen offset:1024  lds
WR_2_3:
    v_mul_f32 v255, v0, v152
    v_fmac_f32 v255, v1, v153
    v_fmac_f32 v255, v2, v154
    v_fmac_f32 v255, v3, v155
    v_fmac_f32 v255, v4, v156
    v_fmac_f32 v255, v5, v157
    v_fmac_f32 v255, v6, v158
    v_fmac_f32 v255, v7, v159
    v_fmac_f32 v201, v8, v168
    v_fmac_f32 v201, v9, v169
    v_permlane32_swap_b32 v197, v255
    v_fmac_f32 v201, v10, v170
    v_fmac_f32 v201, v11, v171
    v_fmac_f32 v201, v12, v172
    v_fmac_f32 v201, v13, v173
    v_fmac_f32 v201, v14, v174
    v_fmac_f32 v201, v15, v175
    v_add_f32 v255, v197, v255
    v_cvt_pk_bf16_f32 v194, v254, v255
    v_mfma_f32_32x32x16_bf16 v[0:15], v[72:75], v[180:183], 0
    v_mul_f32 v254, v16, v144
    v_fmac_f32 v254, v17, v145
    v_fmac_f32 v254, v18, v146
    v_fmac_f32 v254, v19, v147
    v_fmac_f32 v254, v20, v148
    v_fmac_f32 v254, v21, v149
    v_mfma_f32_32x32x16_bf16 v[32:47], v[76:79], v[180:183], v[32:47]
    s_waitcnt vmcnt(6)
    ds_read_b64_tr_b16 v[176:177], v244 offset:0
    ds_read_b64_tr_b16 v[178:179], v244 offset:1024
    ds_read_b64_tr_b16 v[180:181], v245 offset:0
    ds_read_b64_tr_b16 v[182:183], v245 offset:1024
    v_add_u32 v249, s48, v249
    v_add_u32 v250, s49, v250
    ds_read_b32 v252, v251 offset:16
    ds_read_b64_tr_b16 v[72:73], v249 offset:0
    ds_read_b64_tr_b16 v[76:77], v249 offset:64
    ds_read_b64_tr_b16 v[74:75], v249 offset:256
    ds_read_b64_tr_b16 v[78:79], v249 offset:320
    s_mov_b64 exec, s[54:55]
    ds_read_u16_d16_hi v242, v250 offset:0
    s_mov_b64 exec, -1
    v_fmac_f32 v254, v22, v150
    v_fmac_f32 v254, v23, v151
    v_fma_f32 v202, v24, -v160, v202
    v_fma_f32 v202, v25, -v161, v202
    v_permlane32_swap_b32 v254, v200
    v_fma_f32 v202, v26, -v162, v202
    v_fma_f32 v202, v27, -v163, v202
    v_fma_f32 v202, v28, -v164, v202
    v_fma_f32 v202, v29, -v165, v202
    v_fma_f32 v202, v30, -v166, v202
    v_fma_f32 v202, v31, -v167, v202
    v_add_f32 v200, v254, v200
    v_mul_f32_e64 v198, v64, -v112
    v_permlane32_swap_b32 v202, v254
    v_fma_f32 v198, v65, -v113, v198
    v_fma_f32 v198, v66, -v114, v198
    v_fma_f32 v198, v67, -v115, v198
    v_fma_f32 v198, v68, -v116, v198
    v_fma_f32 v198, v69, -v117, v198
    v_fma_f32 v198, v70, -v118, v198
    v_fma_f32 v198, v71, -v119, v198
    v_add_f32 v254, v202, v254
    v_mul_f32 v196, v56, v160
    v_fmac_f32 v196, v57, v161
    v_fmac_f32 v196, v58, v162
    v_fmac_f32 v196, v59, v163
    v_fmac_f32 v196, v60, v164
    v_fmac_f32 v196, v61, v165
    v_fmac_f32 v196, v62, v166
    v_fmac_f32 v196, v63, v167
    s_nop 1
    v_permlane32_swap_b32 v198, v196
    v_add_f32 v196, v198, v196
    s_cbranch_vccnz LEPI_2
    v_mul_f32 v255, v0, v152
    v_fmac_f32 v255, v1, v153
    v_fmac_f32 v255, v2, v154
    v_fmac_f32 v255, v3, v155
    v_fmac_f32 v255, v4, v156
    v_fmac_f32 v255, v5, v157
    v_fmac_f32 v255, v6, v158
    v_fmac_f32 v255, v7, v159
    v_fma_f32 v203, v8, -v168, v203
    v_fma_f32 v203, v9, -v169, v203
    v_permlane32_swap_b32 v255, v201
    v_fma_f32 v203, v10, -v170, v203
    v_fma_f32 v203, v11, -v171, v203
    v_fma_f32 v203, v12, -v172, v203
    v_fma_f32 v203, v13, -v173, v203
    v_fma_f32 v203, v14, -v174, v203
    v_fma_f32 v203, v15, -v175, v203
    v_add_f32 v201, v255, v201
    v_mul_f32_e64 v199, v40, -v120
    v_permlane32_swap_b32 v203, v255
    v_fma_f32 v199, v41, -v121, v199
    v_fma_f32 v199, v42, -v122, v199
    v_fma_f32 v199, v43, -v123, v199
    v_fma_f32 v199, v44, -v124, v199
    v_fma_f32 v199, v45, -v125, v199
    v_fma_f32 v199, v46, -v126, v199
    v_fma_f32 v199, v47, -v127, v199
    v_add_f32 v255, v203, v255
    v_mul_f32 v197, v32, v168
    v_fmac_f32 v197, v33, v169
    v_fmac_f32 v197, v34, v170
    v_fmac_f32 v197, v35, v171
    v_fmac_f32 v197, v36, v172
    v_fmac_f32 v197, v37, v173
    v_fmac_f32 v197, v38, v174
    v_fmac_f32 v197, v39, v175
    s_nop 1
    v_permlane32_swap_b32 v199, v197
    v_add_f32 v197, v199, v197
    v_cvt_pk_bf16_f32 v200, v200, v201
    v_cvt_pk_bf16_f32 v254, v254, v255
    v_cvt_pk_bf16_f32 v196, v196, v197
    ds_write2st64_b32 v253, v192, v193 offset0:0 offset1:1
    ds_write2st64_b32 v253, v194, v200 offset0:2 offset1:3
    ds_write_b32 v253, v196 offset:1024
    s_mov_b64 exec, 0xffffffff
    ds_write_b32 v253, v254 offset:1280
    s_mov_b64 exec, -1
    s_add_u32 s50, s50, 1
    s_cmp_ge_u32 s50, 4
    s_cbranch_scc1 LAST1
    s_waitcnt lgkmcnt(9)
    v_readfirstlane_b32 s66, v252
    s_add_u32 s53, s53, 1
    v_mov_b32 v252, s53
    s_cmp_le_u32 s53, s66
    ds_write2_b32 v251, v252, v252 offset0:0 offset1:8
    s_setprio 1
    s_cbranch_scc1 PRIO_16
    s_setprio 0
PRIO_16:
    s_cmp_eq_u32 s52, 4
    s_cbranch_scc1 ITEM_1_4
    s_cmp_eq_u32 s52, 5
    s_cbranch_scc1 ITEM_1_5
    s_cmp_eq_u32 s52, 3
    s_cbranch_scc1 ITEM_1_3
    s_cmp_eq_u32 s52, 6
    s_cbranch_scc1 ITEM_1_6
    s_cmp_eq_u32 s52, 8
    s_cbranch_scc1 ITEM_1_8
    s_branch ITEM_1_2
WL_2_0:
    s_add_u32 s66, s51, 0
    buffer_load_dword v195, v246, s[16:19], s66 offen
    buffer_load_dword v195, v246, s[16:19], s66 offen
    s_branch WR_2_0
WL_2_1:
    s_add_u32 s66, s51, 4096
    buffer_load_dword v195, v246, s[16:19], s66 offen
    buffer_load_dword v195, v246, s[16:19], s66 offen
    s_branch WR_2_1
WL_2_2:
    s_add_u32 s66, s51, 8192
    buffer_load_dword v195, v246, s[16:19], s66 offen
    buffer_load_dword v195, v246, s[16:19], s66 offen
    s_branch WR_2_2
WL_2_3:
    s_add_u32 s66, s51, 12288
    buffer_load_dword v195, v246, s[16:19], s66 offen
    buffer_load_dword v195, v246, s[16:19], s66 offen
    s_branch WR_2_3
.p2align 6
.p2align 6
LEPI_2:
    s_lshl_b32 s71, s20, 4
    s_add_u32 s67, s51, 4096
    s_add_u32 s68, s51, 8192
    s_add_u32 s69, s51, 12288
    s_add_u32 s70, s51, 16384
    s_waitcnt lgkmcnt(0)
    buffer_load_dwordx4 v[96:99], v246, s[16:19], s51 offen offset:2048 sc1
    s_mov_b32 s52, 163072
    v_bfe_u32 v177, v246, 4, 4
    v_bfe_u32 v179, v246, 4, 3
    v_lshl_add_u32 v180, v177, 3, s52
    v_lshl_add_u32 v190, v177, 4, s52
    v_lshl_add_u32 v181, v179, 3, s52
    ds_read2_b64 v[182:185], v180 offset0:32 offset1:48
    ds_read_b32 v191, v190
    ds_read_b64 v[186:187], v181 offset:512
    v_lshrrev_b32 v178, 8, v246
    buffer_load_dwordx4 v[100:103], v246, s[16:19], s51 offen offset:3072 sc1
    v_add_u32 v234, s21, v248
    v_add_u32 v235, 128, v234
    v_mul_f32 v255, v0, v152
    buffer_load_dwordx4 v[104:107], v246, s[16:19], s67 offen offset:2048 sc1
    v_fmac_f32 v255, v1, v153
    v_fmac_f32 v255, v2, v154
    ds_write2st64_b32 v234, v204, v205 offset0:0 offset1:1
    v_fmac_f32 v255, v3, v155
    buffer_load_dwordx4 v[108:111], v246, s[16:19], s67 offen offset:3072 sc1
    v_fmac_f32 v255, v4, v156
    v_fmac_f32 v255, v5, v157
    ds_write2st64_b32 v234, v206, v207 offset0:2 offset1:3
    v_fmac_f32 v255, v6, v158
    buffer_load_dwordx4 v[128:131], v246, s[16:19], s68 offen offset:2048 sc1
    v_fmac_f32 v255, v7, v159
    v_fma_f32 v203, v8, -v168, v203
    ds_write2st64_b32 v234, v208, v209 offset0:4 offset1:5
    v_fma_f32 v203, v9, -v169, v203
    buffer_load_dwordx4 v[132:135], v246, s[16:19], s68 offen offset:3072 sc1
    v_permlane32_swap_b32 v255, v201
    v_fma_f32 v203, v10, -v170, v203
    ds_write2st64_b32 v235, v210, v211 offset0:6 offset1:7
    v_fma_f32 v203, v11, -v171, v203
    v_fma_f32 v203, v12, -v172, v203
    buffer_load_dwordx4 v[136:139], v246, s[16:19], s69 offen offset:2048 sc1
    v_fma_f32 v203, v13, -v173, v203
    ds_write2st64_b32 v235, v212, v213 offset0:8 offset1:9
    v_fma_f32 v203, v14, -v174, v203
    v_fma_f32 v203, v15, -v175, v203
    buffer_load_dwordx4 v[140:143], v246, s[16:19], s69 offen offset:3072 sc1
    v_add_f32 v201, v255, v201
    ds_write2st64_b32 v235, v214, v215 offset0:10 offset1:11
    v_mul_f32_e64 v199, v40, -v120
    v_permlane32_swap_b32 v203, v255
    buffer_load_dwordx4 v[112:115], v246, s[16:19], s70 offen offset:2048 sc1
    v_fma_f32 v199, v41, -v121, v199
    ds_write2st64_b32 v234, v216, v217 offset0:12 offset1:13
    v_fma_f32 v199, v42, -v122, v199
    v_fma_f32 v199, v43, -v123, v199
    buffer_load_dwordx4 v[116:119], v246, s[16:19], s70 offen offset:3072 sc1
    v_fma_f32 v199, v44, -v124, v199
    ds_write2st64_b32 v234, v218, v219 offset0:14 offset1:15
    v_fma_f32 v199, v45, -v125, v199
    v_fma_f32 v199, v46, -v126, v199
    buffer_load_dwordx4 v[144:147], v246, s[16:19], s51 offen offset:0 sc1
    v_fma_f32 v199, v47, -v127, v199
    v_add_f32 v255, v203, v255
    ds_write2st64_b32 v234, v220, v221 offset0:16 offset1:17
    v_mul_f32 v197, v32, v168
    buffer_load_dwordx4 v[148:151], v246, s[16:19], s51 offen offset:1024 sc1
    v_fmac_f32 v197, v33, v169
    v_fmac_f32 v197, v34, v170
    ds_write2st64_b32 v235, v222, v223 offset0:18 offset1:19
    v_fmac_f32 v197, v35, v171
    buffer_load_dwordx4 v[160:163], v246, s[16:19], s67 offen offset:0 sc1
    v_fmac_f32 v197, v36, v172
    v_fmac_f32 v197, v37, v173
    ds_write2st64_b32 v235, v224, v225 offset0:20 offset1:21
    v_fmac_f32 v197, v38, v174
    buffer_load_dwordx4 v[164:167], v246, s[16:19], s67 offen offset:1024 sc1
    v_fmac_f32 v197, v39, v175
    s_nop 1
    ds_write2st64_b32 v235, v226, v227 offset0:22 offset1:23
    v_permlane32_swap_b32 v199, v197
    ds_write2st64_b32 v234, v228, v229 offset0:24 offset1:25
    v_add_f32 v197, v199, v197
    v_cvt_pk_bf16_f32 v200, v200, v201
    ds_write2st64_b32 v234, v230, v231 offset0:26 offset1:27
    v_cvt_pk_bf16_f32 v254, v254, v255
    v_cvt_pk_bf16_f32 v196, v196, v197
    ds_write2st64_b32 v234, v232, v233 offset0:28 offset1:29
    ds_write2st64_b32 v253, v192, v193 offset0:0 offset1:1
    ds_write2st64_b32 v253, v194, v200 offset0:2 offset1:3
    ds_write_b32 v253, v196 offset:1024
    s_mov_b64 exec, 0xffffffff
    ds_write_b32 v253, v254 offset:1280
    s_mov_b64 exec, -1
    s_add_u32 s50, s53, 1
    v_mov_b32 v234, s50
    ds_write2_b32 v251, v234, v234 offset0:0 offset1:8
    s_waitcnt lgkmcnt(15)
    s_branch TAIL
.p2align 6
LEPI_1:
    s_lshl_b32 s71, s20, 4
    s_add_u32 s67, s51, 4096
    s_add_u32 s68, s51, 8192
    s_add_u32 s69, s51, 12288
    s_add_u32 s70, s51, 16384
    s_waitcnt lgkmcnt(0)
    buffer_load_dwordx4 v[112:115], v246, s[16:19], s70 offen offset:2048 sc1
    s_mov_b32 s52, 163072
    v_bfe_u32 v177, v246, 4, 4
    v_bfe_u32 v179, v246, 4, 3
    v_lshl_add_u32 v180, v177, 3, s52
    v_lshl_add_u32 v190, v177, 4, s52
    v_lshl_add_u32 v181, v179, 3, s52
    ds_read2_b64 v[182:185], v180 offset0:32 offset1:48
    ds_read_b32 v191, v190
    ds_read_b64 v[186:187], v181 offset:512
    v_lshrrev_b32 v178, 8, v246
    buffer_load_dwordx4 v[116:119], v246, s[16:19], s70 offen offset:3072 sc1
    v_add_u32 v234, s21, v248
    v_add_u32 v235, 128, v234
    v_mul_f32 v255, v16, v152
    v_fmac_f32 v255, v17, v153
    buffer_load_dwordx4 v[144:147], v246, s[16:19], s51 offen offset:0 sc1
    v_fmac_f32 v255, v18, v154
    v_fmac_f32 v255, v19, v155
    ds_write2st64_b32 v234, v204, v205 offset0:0 offset1:1
    v_fmac_f32 v255, v20, v156
    v_fmac_f32 v255, v21, v157
    buffer_load_dwordx4 v[148:151], v246, s[16:19], s51 offen offset:1024 sc1
    v_fmac_f32 v255, v22, v158
    v_fmac_f32 v255, v23, v159
    ds_write2st64_b32 v234, v206, v207 offset0:2 offset1:3
    v_fma_f32 v203, v24, -v168, v203
    v_fma_f32 v203, v25, -v169, v203
    v_permlane32_swap_b32 v255, v201
    buffer_load_dwordx4 v[160:163], v246, s[16:19], s67 offen offset:0 sc1
    v_fma_f32 v203, v26, -v170, v203
    v_fma_f32 v203, v27, -v171, v203
    ds_write2st64_b32 v234, v208, v209 offset0:4 offset1:5
    v_fma_f32 v203, v28, -v172, v203
    v_fma_f32 v203, v29, -v173, v203
    buffer_load_dwordx4 v[164:167], v246, s[16:19], s67 offen offset:1024 sc1
    v_fma_f32 v203, v30, -v174, v203
    v_fma_f32 v203, v31, -v175, v203
    ds_write2st64_b32 v235, v210, v211 offset0:6 offset1:7
    v_add_f32 v201, v255, v201
    v_fmac_f32 v199, v32, v120
    ds_write2st64_b32 v235, v212, v213 offset0:8 offset1:9
    v_permlane32_swap_b32 v203, v255
    v_fmac_f32 v199, v33, v121
    v_fmac_f32 v199, v34, v122
    ds_write2st64_b32 v235, v214, v215 offset0:10 offset1:11
    v_fmac_f32 v199, v35, v123
    v_fmac_f32 v199, v36, v124
    ds_write2st64_b32 v234, v216, v217 offset0:12 offset1:13
    v_fmac_f32 v199, v37, v125
    v_fmac_f32 v199, v38, v126
    ds_write2st64_b32 v234, v218, v219 offset0:14 offset1:15
    v_fmac_f32 v199, v39, v127
    v_add_f32 v255, v203, v255
    ds_write2st64_b32 v234, v220, v221 offset0:16 offset1:17
    v_mul_f32 v197, v40, v168
    v_fmac_f32 v197, v41, v169
    ds_write2st64_b32 v235, v222, v223 offset0:18 offset1:19
    v_fmac_f32 v197, v42, v170
    v_fmac_f32 v197, v43, v171
    v_fmac_f32 v197, v44, v172
    ds_write2st64_b32 v235, v224, v225 offset0:20 offset1:21
    v_fmac_f32 v197, v45, v173
    v_fmac_f32 v197, v46, v174
    ds_write2st64_b32 v235, v226, v227 offset0:22 offset1:23
    v_fmac_f32 v197, v47, v175
    s_nop 1
    ds_write2st64_b32 v234, v228, v229 offset0:24 offset1:25
    v_permlane32_swap_b32 v199, v197
    v_add_f32 v197, v199, v197
    ds_write2st64_b32 v234, v230, v231 offset0:26 offset1:27
    v_cvt_pk_bf16_f32 v200, v200, v201
    v_cvt_pk_bf16_f32 v254, v254, v255
    v_cvt_pk_bf16_f32 v196, v196, v197
    ds_write2st64_b32 v234, v232, v233 offset0:28 offset1:29
    ds_write2st64_b32 v253, v200, v196 offset0:3 offset1:4
    s_mov_b64 exec, 0xffffffff
    ds_write_b32 v253, v254 offset:1280
    s_mov_b64 exec, -1
    s_add_u32 s50, s53, 1
    v_mov_b32 v234, s50
    ds_write2_b32 v251, v234, v234 offset0:0 offset1:8
    s_waitcnt lgkmcnt(15)
    s_branch TAIL
.p2align 6
LEPI_0:
    s_lshl_b32 s71, s20, 4
    s_add_u32 s67, s51, 4096
    s_add_u32 s68, s51, 8192
    s_add_u32 s69, s51, 12288
    s_add_u32 s70, s51, 16384
    s_waitcnt lgkmcnt(0)
    buffer_load_dwordx4 v[112:115], v246, s[16:19], s70 offen offset:2048 sc1
    s_mov_b32 s52, 163072
    v_bfe_u32 v177, v246, 4, 4
    v_bfe_u32 v179, v246, 4, 3
    v_lshl_add_u32 v180, v177, 3, s52
    v_lshl_add_u32 v190, v177, 4, s52
    v_lshl_add_u32 v181, v179, 3, s52
    ds_read2_b64 v[182:185], v180 offset0:32 offset1:48
    ds_read_b32 v191, v190
    ds_read_b64 v[186:187], v181 offset:512
    v_lshrrev_b32 v178, 8, v246
    buffer_load_dwordx4 v[116:119], v246, s[16:19], s70 offen offset:3072 sc1
    v_add_u32 v234, s21, v248
    v_add_u32 v235, 128, v234
    v_mul_f32 v255, v0, v152
    v_fmac_f32 v255, v1, v153
    buffer_load_dwordx4 v[144:147], v246, s[16:19], s51 offen offset:0 sc1
    v_fmac_f32 v255, v2, v154
    v_fmac_f32 v255, v3, v155
    ds_write2st64_b32 v234, v204, v205 offset0:0 offset1:1
    v_fmac_f32 v255, v4, v156
    v_fmac_f32 v255, v5, v157
    buffer_load_dwordx4 v[148:151], v246, s[16:19], s51 offen offset:1024 sc1
    v_fmac_f32 v255, v6, v158
    v_fmac_f32 v255, v7, v159
    ds_write2st64_b32 v234, v206, v207 offset0:2 offset1:3
    v_fma_f32 v203, v8, -v168, v203
    v_fma_f32 v203, v9, -v169, v203
    v_permlane32_swap_b32 v255, v201
    buffer_load_dwordx4 v[160:163], v246, s[16:19], s67 offen offset:0 sc1
    v_fma_f32 v203, v10, -v170, v203
    v_fma_f32 v203, v11, -v171, v203
    ds_write2st64_b32 v234, v208, v209 offset0:4 offset1:5
    v_fma_f32 v203, v12, -v172, v203
    v_fma_f32 v203, v13, -v173, v203
    buffer_load_dwordx4 v[164:167], v246, s[16:19], s67 offen offset:1024 sc1
    v_fma_f32 v203, v14, -v174, v203
    v_fma_f32 v203, v15, -v175, v203
    ds_write2st64_b32 v235, v210, v211 offset0:6 offset1:7
    v_add_f32 v201, v255, v201
    v_mul_f32_e64 v199, v40, -v120
    ds_write2st64_b32 v235, v212, v213 offset0:8 offset1:9
    v_permlane32_swap_b32 v203, v255
    v_fma_f32 v199, v41, -v121, v199
    v_fma_f32 v199, v42, -v122, v199
    ds_write2st64_b32 v235, v214, v215 offset0:10 offset1:11
    v_fma_f32 v199, v43, -v123, v199
    v_fma_f32 v199, v44, -v124, v199
    ds_write2st64_b32 v234, v216, v217 offset0:12 offset1:13
    v_fma_f32 v199, v45, -v125, v199
    v_fma_f32 v199, v46, -v126, v199
    ds_write2st64_b32 v234, v218, v219 offset0:14 offset1:15
    v_fma_f32 v199, v47, -v127, v199
    v_add_f32 v255, v203, v255
    ds_write2st64_b32 v234, v220, v221 offset0:16 offset1:17
    v_mul_f32 v197, v32, v168
    v_fmac_f32 v197, v33, v169
    ds_write2st64_b32 v235, v222, v223 offset0:18 offset1:19
    v_fmac_f32 v197, v34, v170
    v_fmac_f32 v197, v35, v171
    v_fmac_f32 v197, v36, v172
    ds_write2st64_b32 v235, v224, v225 offset0:20 offset1:21
    v_fmac_f32 v197, v37, v173
    v_fmac_f32 v197, v38, v174
    ds_write2st64_b32 v235, v226, v227 offset0:22 offset1:23
    v_fmac_f32 v197, v39, v175
    s_nop 1
    ds_write2st64_b32 v234, v228, v229 offset0:24 offset1:25
    v_permlane32_swap_b32 v199, v197
    v_add_f32 v197, v199, v197
    ds_write2st64_b32 v234, v230, v231 offset0:26 offset1:27
    v_cvt_pk_bf16_f32 v200, v200, v201
    v_cvt_pk_bf16_f32 v254, v254, v255
    v_cvt_pk_bf16_f32 v196, v196, v197
    ds_write2st64_b32 v234, v232, v233 offset0:28 offset1:29
    ds_write2st64_b32 v253, v192, v193 offset0:0 offset1:1
    ds_write2st64_b32 v253, v194, v200 offset0:2 offset1:3
    ds_write_b32 v253, v196 offset:1024
    s_mov_b64 exec, 0xffffffff
    ds_write_b32 v253, v254 offset:1280
    s_mov_b64 exec, -1
    s_add_u32 s50, s53, 1
    v_mov_b32 v234, s50
    ds_write2_b32 v251, v234, v234 offset0:0 offset1:8
    s_waitcnt lgkmcnt(15)
TAIL:
    s_and_b32 s71, s20, 3
    s_lshl_b32 s71, s71, 2
    s_bitcmp0_b32 s20, 2
    s_addc_u32 s71, s71, 0
    v_readlane_b32 s71, v191, s71
    buffer_load_dwordx4 v[120:123], v246, s[16:19], s68 offen offset:0 sc1
    buffer_load_dwordx4 v[124:127], v246, s[16:19], s68 offen offset:1024 sc1
    s_cmp_ge_u32 s71, s50
    s_setprio 1
    s_cbranch_scc1 T_second
    s_setprio 0
T_second:
    buffer_load_dwordx4 v[152:155], v246, s[16:19], s69 offen offset:0 sc1
    buffer_load_dwordx4 v[156:159], v246, s[16:19], s69 offen offset:1024 sc1
    buffer_load_dwordx4 v[168:171], v246, s[16:19], s70 offen offset:0 sc1
    buffer_load_dwordx4 v[172:175], v246, s[16:19], s70 offen offset:1024 sc1
GEMM:
    v_cmp_gt_u32 vcc, s53, v191
    v_xor_b32 v180, v179, v178
    v_xor_b32 v188, 4, v180
    v_lshl_add_u32 v66, v180, 4, v183
    v_lshl_add_u32 v67, v188, 4, v183
    v_lshl_add_u32 v70, v180, 4, v185
    v_lshl_add_u32 v71, v188, 4, v185
    s_mov_b32 s4, s72
    s_and_b32 s5, s73, 0xffff
    s_mov_b32 s6, 10240000
    s_mov_b32 s7, 0x20000
    s_cbranch_vccnz T_pw
T_pwr:
    ds_read_b128 v[76:79], v66 offset:0
    ds_read_b128 v[80:83], v70 offset:0
    ds_read_b128 v[84:87], v67 offset:0
    ds_read_b128 v[88:91], v71 offset:0
    ds_read_b128 v[92:95], v66 offset:1024
    s_waitcnt vmcnt(19) lgkmcnt(4)
    v_mfma_f32_16x16x32_bf16 v[0:3], v[96:99], v[76:79], 0
    v_and_b32 v181, 8, v177
    v_add_u32 v189, v188, v181
    ds_read_b128 v[76:79], v70 offset:1024
    s_waitcnt lgkmcnt(4)
    v_mfma_f32_16x16x32_bf16 v[4:7], v[96:99], v[80:83], 0
    v_add_u32 v181, v180, v181
    v_lshl_add_u32 v64, v180, 4, v182
    ds_read_b128 v[80:83], v67 offset:1024
    s_waitcnt vmcnt(18) lgkmcnt(4)
    v_mfma_f32_16x16x32_bf16 v[0:3], v[100:103], v[84:87], v[0:3]
    v_lshl_add_u32 v65, v188, 4, v182
    v_lshl_add_u32 v68, v180, 4, v184
    ds_read_b128 v[84:87], v71 offset:1024
    s_waitcnt lgkmcnt(4)
    v_mfma_f32_16x16x32_bf16 v[4:7], v[100:103], v[88:91], v[4:7]
    v_lshl_add_u32 v69, v188, 4, v184
    v_lshl_add_u32 v72, v181, 4, v186
    ds_read_b128 v[88:91], v66 offset:128
    s_waitcnt vmcnt(17) lgkmcnt(4)
    v_mfma_f32_16x16x32_bf16 v[0:3], v[104:107], v[92:95], v[0:3]
    v_lshl_add_u32 v73, v189, 4, v186
    v_lshl_add_u32 v74, v181, 4, v187
    ds_read_b128 v[92:95], v66 offset:256
    s_waitcnt lgkmcnt(4)
    v_mfma_f32_16x16x32_bf16 v[4:7], v[104:107], v[76:79], v[4:7]
    v_lshl_add_u32 v75, v189, 4, v187
    s_mov_b32 s67, 0xbfb8aa3b
    ds_read_b128 v[76:79], v66 offset:384
    s_waitcnt vmcnt(16) lgkmcnt(4)
    v_mfma_f32_16x16x32_bf16 v[0:3], v[108:111], v[80:83], v[0:3]
    v_lshrrev_b32 v205, 1, v178
    v_lshl_add_u32 v205, s20, 1, v205
    ds_read_b128 v[80:83], v70 offset:128
    s_waitcnt lgkmcnt(4)
    v_mfma_f32_16x16x32_bf16 v[4:7], v[108:111], v[84:87], v[4:7]
    v_xor_b32 v205, v205, v179
    v_and_b32 v204, 1, v178
    ds_read_b128 v[84:87], v70 offset:256
    s_waitcnt vmcnt(15) lgkmcnt(4)
    v_mfma_f32_16x16x32_bf16 v[12:15], v[128:131], v[88:91], 0
    v_lshlrev_b32 v204, 3, v204
    v_lshl_add_u32 v205, v205, 4, v204
    ds_read_b128 v[88:91], v70 offset:384
    s_waitcnt lgkmcnt(4)
    v_mfma_f32_16x16x32_bf16 v[24:27], v[128:131], v[92:95], 0
    v_and_b32 v220, 8, v177
    v_lshl_add_u32 v204, v220, 4, v205
    ds_read_b128 v[92:95], v67 offset:128
    s_waitcnt lgkmcnt(4)
    v_mfma_f32_16x16x32_bf16 v[36:39], v[128:131], v[76:79], 0
    v_lshl_add_u32 v204, v177, 10, v204
    v_add_u32 v204, 65536, v204
    ds_read_b128 v[76:79], v67 offset:256
    s_waitcnt lgkmcnt(4)
    v_mfma_f32_16x16x32_bf16 v[16:19], v[128:131], v[80:83], 0
    v_add_u32 v205, v205, v182
    v_mul_u32_u24 v220, 1008, v220
    ds_read_b128 v[80:83], v67 offset:384
    s_waitcnt lgkmcnt(4)
    v_mfma_f32_16x16x32_bf16 v[28:31], v[128:131], v[84:87], 0
    v_sub_u32 v220, v204, v220
    s_lshl_b32 s70, s20, 4
    ds_read_b128 v[84:87], v71 offset:128
    s_waitcnt lgkmcnt(4)
    v_mfma_f32_16x16x32_bf16 v[40:43], v[128:131], v[88:91], 0
    v_xor_b32 v206, s70, v246
    s_lshl_b32 s70, s20, 10
    ds_read_b128 v[88:91], v71 offset:256
    s_waitcnt vmcnt(14) lgkmcnt(4)
    v_mfma_f32_16x16x32_bf16 v[12:15], v[132:135], v[92:95], v[12:15]
    s_add_u32 s70, s70, 65536
    v_add_u32 v207, s21, v206
    ds_read_b128 v[92:95], v71 offset:384
    s_waitcnt lgkmcnt(4)
    v_mfma_f32_16x16x32_bf16 v[24:27], v[132:135], v[76:79], v[24:27]
    v_add_u32 v206, s70, v206
    s_mul_i32 s66, s2, 40960
    ds_read_b128 v[76:79], v66 offset:512
    s_waitcnt lgkmcnt(4)
    v_mfma_f32_16x16x32_bf16 v[36:39], v[132:135], v[80:83], v[36:39]
    s_bfe_u32 s22, s22, 393237
    s_lshl_b32 s22, s22, 10
    ds_read_b128 v[80:83], v66 offset:640
    s_waitcnt lgkmcnt(4)
    v_mfma_f32_16x16x32_bf16 v[16:19], v[132:135], v[84:87], v[16:19]
    s_add_u32 s22, s22, s66
    s_bfe_u32 s23, s23, 393237
    ds_read_b128 v[84:87], v66 offset:768
    s_waitcnt lgkmcnt(4)
    v_mfma_f32_16x16x32_bf16 v[28:31], v[132:135], v[88:91], v[28:31]
    s_lshl_b32 s23, s23, 10
    s_add_u32 s23, s23, s66
    ds_read_b128 v[88:91], v70 offset:512
    s_waitcnt lgkmcnt(4)
    v_mfma_f32_16x16x32_bf16 v[40:43], v[132:135], v[92:95], v[40:43]
    s_bfe_u32 s24, s24, 393237
    s_lshl_b32 s24, s24, 10
    ds_read_b128 v[92:95], v70 offset:640
    s_waitcnt vmcnt(13) lgkmcnt(4)
    v_mfma_f32_16x16x32_bf16 v[12:15], v[136:139], v[76:79], v[12:15]
    s_add_u32 s24, s24, s66
    s_bfe_u32 s25, s25, 393237
    ds_read_b128 v[76:79], v70 offset:768
    s_waitcnt lgkmcnt(4)
    v_mfma_f32_16x16x32_bf16 v[24:27], v[136:139], v[80:83], v[24:27]
    s_lshl_b32 s25, s25, 10
    s_add_u32 s25, s25, s66
    ds_read_b128 v[80:83], v67 offset:512
    s_waitcnt lgkmcnt(4)
    v_mfma_f32_16x16x32_bf16 v[36:39], v[136:139], v[84:87], v[36:39]
    s_bfe_u32 s26, s26, 393237
    s_lshl_b32 s26, s26, 10
    ds_read_b128 v[84:87], v67 offset:640
    s_waitcnt lgkmcnt(4)
    v_mfma_f32_16x16x32_bf16 v[16:19], v[136:139], v[88:91], v[16:19]
    s_add_u32 s26, s26, s66
    ds_read_b128 v[88:91], v67 offset:768
    s_waitcnt lgkmcnt(4)
    v_mfma_f32_16x16x32_bf16 v[28:31], v[136:139], v[92:95], v[28:31]
    ds_read_b128 v[92:95], v71 offset:512
    s_waitcnt lgkmcnt(4)
    v_mfma_f32_16x16x32_bf16 v[40:43], v[136:139], v[76:79], v[40:43]
    ds_read_b128 v[76:79], v71 offset:640
    s_waitcnt vmcnt(12) lgkmcnt(4)
    v_mfma_f32_16x16x32_bf16 v[12:15], v[140:143], v[80:83], v[12:15]
    ds_read_b128 v[80:83], v71 offset:768
    s_waitcnt lgkmcnt(4)
    v_mfma_f32_16x16x32_bf16 v[24:27], v[140:143], v[84:87], v[24:27]
    ds_read_b128 v[84:87], v66 offset:1152
    s_waitcnt lgkmcnt(4)
    v_mfma_f32_16x16x32_bf16 v[36:39], v[140:143], v[88:91], v[36:39]
    ds_read_b128 v[88:91], v66 offset:1280
    s_waitcnt lgkmcnt(4)
    v_mfma_f32_16x16x32_bf16 v[16:19], v[140:143], v[92:95], v[16:19]
    ds_read_b128 v[92:95], v66 offset:896
    s_waitcnt lgkmcnt(4)
    v_mfma_f32_16x16x32_bf16 v[28:31], v[140:143], v[76:79], v[28:31]
    ds_read_b128 v[76:79], v70 offset:1152
    s_waitcnt lgkmcnt(4)
    v_mfma_f32_16x16x32_bf16 v[40:43], v[140:143], v[80:83], v[40:43]
    ds_read_b128 v[80:83], v70 offset:1280
    s_waitcnt vmcnt(11) lgkmcnt(4)
    v_mfma_f32_16x16x32_bf16 v[12:15], v[112:115], v[84:87], v[12:15]
    ds_read_b128 v[84:87], v70 offset:896
    s_waitcnt lgkmcnt(4)
    v_mfma_f32_16x16x32_bf16 v[24:27], v[112:115], v[88:91], v[24:27]
    ds_read_b128 v[88:91], v67 offset:1152
    s_waitcnt lgkmcnt(4)
    v_mfma_f32_16x16x32_bf16 v[36:39], v[112:115], v[92:95], v[36:39]
    ds_read_b128 v[92:95], v67 offset:1280
    s_waitcnt lgkmcnt(4)
    v_mfma_f32_16x16x32_bf16 v[16:19], v[112:115], v[76:79], v[16:19]
    ds_read_b128 v[76:79], v67 offset:896
    s_waitcnt lgkmcnt(4)
    v_mfma_f32_16x16x32_bf16 v[28:31], v[112:115], v[80:83], v[28:31]
    ds_read_b32 v191, v190
    ds_read_b128 v[80:83], v71 offset:1152
    s_waitcnt lgkmcnt(5)
    v_mfma_f32_16x16x32_bf16 v[40:43], v[112:115], v[84:87], v[40:43]
    ds_read_b128 v[84:87], v71 offset:1280
    s_waitcnt vmcnt(10) lgkmcnt(5)
    v_mfma_f32_16x16x32_bf16 v[12:15], v[116:119], v[88:91], v[12:15]
    ds_read_b128 v[88:91], v71 offset:896
    s_waitcnt lgkmcnt(5)
    v_mfma_f32_16x16x32_bf16 v[24:27], v[116:119], v[92:95], v[24:27]
    s_waitcnt lgkmcnt(3)
    v_cmp_gt_u32 vcc, s50, v191
    s_cbranch_vccnz T_aw
T_awr:
    ds_read_b128 v[92:95], v64 offset:0
    v_mfma_f32_16x16x32_bf16 v[36:39], v[116:119], v[76:79], v[36:39]
    ds_read_b128 v[76:79], v68 offset:0
    s_waitcnt lgkmcnt(4)
    v_mfma_f32_16x16x32_bf16 v[16:19], v[116:119], v[80:83], v[16:19]
    ds_read_b128 v[80:83], v65 offset:0
    s_waitcnt lgkmcnt(4)
    v_mfma_f32_16x16x32_bf16 v[28:31], v[116:119], v[84:87], v[28:31]
    ds_read_b128 v[84:87], v69 offset:0
    s_waitcnt lgkmcnt(4)
    v_mfma_f32_16x16x32_bf16 v[40:43], v[116:119], v[88:91], v[40:43]
    ds_read_b128 v[88:91], v64 offset:1024
    s_waitcnt vmcnt(9) lgkmcnt(4)
    v_mfma_f32_16x16x32_bf16 v[0:3], v[144:147], v[92:95], v[0:3]
    ds_read_b128 v[92:95], v68 offset:1024
    s_waitcnt lgkmcnt(4)
    v_mfma_f32_16x16x32_bf16 v[4:7], v[144:147], v[76:79], v[4:7]
    ds_read_b128 v[76:79], v65 offset:1024
    s_waitcnt vmcnt(8) lgkmcnt(4)
    v_mfma_f32_16x16x32_bf16 v[0:3], v[148:151], v[80:83], v[0:3]
    ds_read_b128 v[80:83], v69 offset:1024
    s_waitcnt lgkmcnt(4)
    v_mfma_f32_16x16x32_bf16 v[4:7], v[148:151], v[84:87], v[4:7]
    ds_read_b128 v[84:87], v72 offset:0
    s_waitcnt vmcnt(7) lgkmcnt(4)
    v_mfma_f32_16x16x32_bf16 v[0:3], v[160:163], v[88:91], v[0:3]
    ds_read_b128 v[88:91], v73 offset:0
    s_waitcnt lgkmcnt(4)
    v_mfma_f32_16x16x32_bf16 v[4:7], v[160:163], v[92:95], v[4:7]
    ds_read_b128 v[92:95], v74 offset:0
    s_waitcnt vmcnt(6) lgkmcnt(4)
    v_mfma_f32_16x16x32_bf16 v[0:3], v[164:167], v[76:79], v[0:3]
    ds_read_b128 v[76:79], v75 offset:0
    s_waitcnt lgkmcnt(4)
    v_mfma_f32_16x16x32_bf16 v[4:7], v[164:167], v[80:83], v[4:7]
    ds_read_b128 v[80:83], v72 offset:1024
    s_waitcnt lgkmcnt(4)
    v_mfma_f32_16x16x32_bf16 v[8:11], v[144:147], v[84:87], 0
    ds_read_b128 v[84:87], v73 offset:1024
    s_waitcnt lgkmcnt(4)
    v_mfma_f32_16x16x32_bf16 v[8:11], v[148:151], v[88:91], v[8:11]
    v_mul_f32 v192, s67, v0
    v_mul_f32 v193, s67, v1
    ds_read_b128 v[88:91], v74 offset:1024
    s_waitcnt lgkmcnt(4)
    v_mfma_f32_16x16x32_bf16 v[8:11], v[96:99], v[92:95], v[8:11]
    v_mul_f32 v194, s67, v2
    v_mul_f32 v195, s67, v3
    ds_read_b128 v[92:95], v75 offset:1024
    s_waitcnt lgkmcnt(4)
    v_mfma_f32_16x16x32_bf16 v[8:11], v[100:103], v[76:79], v[8:11]
    v_exp_f32 v192, v192
    v_exp_f32 v193, v193
    ds_read_b128 v[76:79], v64 offset:128
    s_waitcnt lgkmcnt(4)
    v_mfma_f32_16x16x32_bf16 v[8:11], v[160:163], v[80:83], v[8:11]
    v_exp_f32 v194, v194
    v_exp_f32 v195, v195
    ds_read_b128 v[80:83], v65 offset:128
    s_waitcnt lgkmcnt(4)
    v_mfma_f32_16x16x32_bf16 v[8:11], v[164:167], v[84:87], v[8:11]
    v_add_f32 v192, 1.0, v192
    v_add_f32 v193, 1.0, v193
    ds_read_b128 v[84:87], v64 offset:512
    s_waitcnt lgkmcnt(4)
    v_mfma_f32_16x16x32_bf16 v[8:11], v[104:107], v[88:91], v[8:11]
    v_add_f32 v194, 1.0, v194
    v_add_f32 v195, 1.0, v195
    ds_read_b128 v[88:91], v65 offset:512
    s_waitcnt lgkmcnt(4)
    v_mfma_f32_16x16x32_bf16 v[8:11], v[108:111], v[92:95], v[8:11]
    v_rcp_f32 v192, v192
    v_rcp_f32 v193, v193
    ds_read_b128 v[92:95], v64 offset:1152
    s_waitcnt vmcnt(5) lgkmcnt(4)
    v_mfma_f32_16x16x32_bf16 v[12:15], v[120:123], v[76:79], v[12:15]
    v_rcp_f32 v194, v194
    v_rcp_f32 v195, v195
    ds_read_b128 v[76:79], v65 offset:1152
    s_waitcnt vmcnt(4) lgkmcnt(4)
    v_mfma_f32_16x16x32_bf16 v[12:15], v[124:127], v[80:83], v[12:15]
    v_cvt_pk_bf16_f32 v0, v0, v1
    v_cvt_pk_bf16_f32 v1, v2, v3
    ds_read_b128 v[80:83], v64 offset:256
    s_waitcnt vmcnt(3) lgkmcnt(4)
    v_mfma_f32_16x16x32_bf16 v[12:15], v[152:155], v[84:87], v[12:15]
    ds_write_b64 v204, v[0:1] offset:0
    v_mul_f32 v196, s67, v4
    ds_read_b128 v[84:87], v65 offset:256
    s_waitcnt vmcnt(2) lgkmcnt(5)
    v_mfma_f32_16x16x32_bf16 v[12:15], v[156:159], v[88:91], v[12:15]
    v_mul_f32 v197, s67, v5
    v_mul_f32 v198, s67, v6
    ds_read_b128 v[88:91], v64 offset:640
    s_waitcnt vmcnt(1) lgkmcnt(5)
    v_mfma_f32_16x16x32_bf16 v[12:15], v[168:171], v[92:95], v[12:15]
    v_mul_f32 v199, s67, v7
    v_exp_f32 v196, v196
    ds_read_b128 v[92:95], v65 offset:640
    s_waitcnt vmcnt(0) lgkmcnt(5)
    v_mfma_f32_16x16x32_bf16 v[12:15], v[172:175], v[76:79], v[12:15]
    v_exp_f32 v197, v197
    v_exp_f32 v198, v198
    ds_read_b128 v[76:79], v64 offset:1280
    s_waitcnt lgkmcnt(5)
    v_mfma_f32_16x16x32_bf16 v[24:27], v[120:123], v[80:83], v[24:27]
    v_exp_f32 v199, v199
    v_add_f32 v196, 1.0, v196
    ds_read_b128 v[80:83], v65 offset:1280
    s_waitcnt lgkmcnt(4)
    v_mfma_f32_16x16x32_bf16 v[24:27], v[124:127], v[84:87], v[24:27]
    v_mul_f32 v12, v12, v192
    v_mul_f32 v13, v13, v193
    ds_read_b128 v[84:87], v64 offset:384
    s_waitcnt lgkmcnt(4)
    v_mfma_f32_16x16x32_bf16 v[24:27], v[152:155], v[88:91], v[24:27]
    v_mul_f32 v14, v14, v194
    v_mul_f32 v15, v15, v195
    ds_read_b128 v[88:91], v65 offset:384
    s_waitcnt lgkmcnt(4)
    v_mfma_f32_16x16x32_bf16 v[24:27], v[156:159], v[92:95], v[24:27]
    v_cvt_pk_bf16_f32 v12, v12, v13
    v_cvt_pk_bf16_f32 v13, v14, v15
    ds_read_b128 v[92:95], v64 offset:768
    s_waitcnt lgkmcnt(4)
    v_mfma_f32_16x16x32_bf16 v[24:27], v[168:171], v[76:79], v[24:27]
    ds_write_b64 v204, v[12:13] offset:256
    v_add_f32 v197, 1.0, v197
    ds_read_b128 v[76:79], v65 offset:768
    s_waitcnt lgkmcnt(5)
    v_mfma_f32_16x16x32_bf16 v[24:27], v[172:175], v[80:83], v[24:27]
    v_add_f32 v198, 1.0, v198
    v_add_f32 v199, 1.0, v199
    ds_read_b128 v[80:83], v64 offset:896
    s_waitcnt lgkmcnt(5)
    v_mfma_f32_16x16x32_bf16 v[36:39], v[120:123], v[84:87], v[36:39]
    v_rcp_f32 v196, v196
    v_rcp_f32 v197, v197
    ds_read_b128 v[84:87], v65 offset:896
    s_waitcnt lgkmcnt(5)
    v_mfma_f32_16x16x32_bf16 v[36:39], v[124:127], v[88:91], v[36:39]
    v_rcp_f32 v198, v198
    v_rcp_f32 v199, v199
    ds_read_b128 v[88:91], v68 offset:128
    s_waitcnt lgkmcnt(5)
    v_mfma_f32_16x16x32_bf16 v[36:39], v[152:155], v[92:95], v[36:39]
    v_mul_f32 v24, v24, v192
    v_mul_f32 v25, v25, v193
    ds_read_b128 v[92:95], v69 offset:128
    s_waitcnt lgkmcnt(4)
    v_mfma_f32_16x16x32_bf16 v[36:39], v[156:159], v[76:79], v[36:39]
    v_mul_f32 v26, v26, v194
    v_mul_f32 v27, v27, v195
    ds_read_b128 v[76:79], v68 offset:512
    s_waitcnt lgkmcnt(4)
    v_mfma_f32_16x16x32_bf16 v[36:39], v[168:171], v[80:83], v[36:39]
    v_cvt_pk_bf16_f32 v24, v24, v25
    v_cvt_pk_bf16_f32 v25, v26, v27
    ds_read_b128 v[80:83], v69 offset:512
    s_waitcnt lgkmcnt(4)
    v_mfma_f32_16x16x32_bf16 v[36:39], v[172:175], v[84:87], v[36:39]
    ds_write_b64 v204, v[24:25] offset:512
    v_mul_f32 v200, s67, v8
    ds_read_b128 v[84:87], v68 offset:1152
    s_waitcnt lgkmcnt(5)
    v_mfma_f32_16x16x32_bf16 v[16:19], v[120:123], v[88:91], v[16:19]
    v_mul_f32 v201, s67, v9
    v_mul_f32 v202, s67, v10
    ds_read_b128 v[88:91], v69 offset:1152
    s_waitcnt lgkmcnt(5)
    v_mfma_f32_16x16x32_bf16 v[16:19], v[124:127], v[92:95], v[16:19]
    v_mul_f32 v203, s67, v11
    v_exp_f32 v200, v200
    ds_read_b128 v[92:95], v68 offset:256
    s_waitcnt lgkmcnt(5)
    v_mfma_f32_16x16x32_bf16 v[16:19], v[152:155], v[76:79], v[16:19]
    v_mul_f32 v36, v36, v192
    v_mul_f32 v37, v37, v193
    ds_read_b128 v[76:79], v69 offset:256
    s_waitcnt lgkmcnt(5)
    v_mfma_f32_16x16x32_bf16 v[16:19], v[156:159], v[80:83], v[16:19]
    v_mul_f32 v38, v38, v194
    v_mul_f32 v39, v39, v195
    ds_read_b128 v[80:83], v68 offset:640
    s_waitcnt lgkmcnt(4)
    v_mfma_f32_16x16x32_bf16 v[16:19], v[168:171], v[84:87], v[16:19]
    v_cvt_pk_bf16_f32 v36, v36, v37
    v_cvt_pk_bf16_f32 v37, v38, v39
    ds_read_b128 v[84:87], v69 offset:640
    s_waitcnt lgkmcnt(4)
    v_mfma_f32_16x16x32_bf16 v[16:19], v[172:175], v[88:91], v[16:19]
    ds_write_b64 v204, v[36:37] offset:768
    v_exp_f32 v201, v201
    ds_read_b128 v[88:91], v68 offset:1280
    s_waitcnt lgkmcnt(5)
    v_mfma_f32_16x16x32_bf16 v[28:31], v[120:123], v[92:95], v[28:31]
    v_exp_f32 v202, v202
    v_exp_f32 v203, v203
    ds_read_b128 v[92:95], v69 offset:1280
    s_waitcnt lgkmcnt(5)
    v_mfma_f32_16x16x32_bf16 v[28:31], v[124:127], v[76:79], v[28:31]
    v_add_f32 v200, 1.0, v200
    v_add_f32 v201, 1.0, v201
    ds_read_b128 v[76:79], v68 offset:384
    s_waitcnt lgkmcnt(5)
    v_mfma_f32_16x16x32_bf16 v[28:31], v[152:155], v[80:83], v[28:31]
    v_add_f32 v202, 1.0, v202
    v_add_f32 v203, 1.0, v203
    ds_read_b128 v[80:83], v69 offset:384
    s_waitcnt lgkmcnt(5)
    v_mfma_f32_16x16x32_bf16 v[28:31], v[156:159], v[84:87], v[28:31]
    v_rcp_f32 v200, v200
    v_rcp_f32 v201, v201
    ds_read_b128 v[84:87], v68 offset:768
    s_waitcnt lgkmcnt(4)
    v_mfma_f32_16x16x32_bf16 v[28:31], v[168:171], v[88:91], v[28:31]
    v_rcp_f32 v202, v202
    v_rcp_f32 v203, v203
    ds_read_b128 v[88:91], v69 offset:768
    s_waitcnt lgkmcnt(4)
    v_mfma_f32_16x16x32_bf16 v[28:31], v[172:175], v[92:95], v[28:31]
    v_mov_b32_dpp v200, v200 row_ror:8 row_mask:0xf bank_mask:0xc
    ds_read_b128 v[92:95], v68 offset:896
    s_waitcnt lgkmcnt(4)
    v_mfma_f32_16x16x32_bf16 v[40:43], v[120:123], v[76:79], v[40:43]
    v_mov_b32_dpp v201, v201 row_ror:8 row_mask:0xf bank_mask:0xc
    v_mov_b32_dpp v202, v202 row_ror:8 row_mask:0xf bank_mask:0xc
    ds_read_b128 v[76:79], v69 offset:896
    s_waitcnt lgkmcnt(4)
    v_mfma_f32_16x16x32_bf16 v[40:43], v[124:127], v[80:83], v[40:43]
    v_mov_b32_dpp v203, v203 row_ror:8 row_mask:0xf bank_mask:0xc
    ds_read_b128 v[80:83], v72 offset:128
    s_waitcnt lgkmcnt(4)
    v_mfma_f32_16x16x32_bf16 v[40:43], v[152:155], v[84:87], v[40:43]
    s_barrier
    ds_read_b128 v[212:215], v206 offset:0
    ds_read_b128 v[84:87], v73 offset:128
    s_waitcnt lgkmcnt(5)
    v_mfma_f32_16x16x32_bf16 v[40:43], v[156:159], v[88:91], v[40:43]
    ds_read_b128 v[216:219], v206 offset:8320
    v_cvt_pk_bf16_f32 v4, v4, v5
    ds_read_b128 v[88:91], v74 offset:128
    s_waitcnt lgkmcnt(6)
    v_mfma_f32_16x16x32_bf16 v[40:43], v[168:171], v[92:95], v[40:43]
    v_cvt_pk_bf16_f32 v5, v6, v7
    ds_write_b64 v205, v[4:5] offset:0
    ds_read_b128 v[92:95], v75 offset:128
    s_waitcnt lgkmcnt(7)
    v_mfma_f32_16x16x32_bf16 v[40:43], v[172:175], v[76:79], v[40:43]
    v_mul_f32 v16, v16, v196
    v_mul_f32 v17, v17, v197
    ds_read_b128 v[76:79], v72 offset:512
    s_waitcnt lgkmcnt(7)
    v_mfma_f32_16x16x32_bf16 v[20:23], v[120:123], v[80:83], 0
    v_mul_f32 v18, v18, v198
    v_mul_f32 v19, v19, v199
    ds_read_b128 v[80:83], v73 offset:512
    s_waitcnt lgkmcnt(6)
    v_mfma_f32_16x16x32_bf16 v[20:23], v[124:127], v[84:87], v[20:23]
    v_cvt_pk_bf16_f32 v16, v16, v17
    v_cvt_pk_bf16_f32 v17, v18, v19
    ds_read_b128 v[84:87], v74 offset:512
    s_waitcnt lgkmcnt(5)
    v_mfma_f32_16x16x32_bf16 v[20:23], v[128:131], v[88:91], v[20:23]
    ds_write_b64 v205, v[16:17] offset:256
    ds_read_b128 v[88:91], v75 offset:512
    s_waitcnt lgkmcnt(5)
    v_mfma_f32_16x16x32_bf16 v[20:23], v[132:135], v[92:95], v[20:23]
    buffer_store_dwordx4 v[212:215], v246, s[4:7], s22 offen sc1
    ds_read_b128 v[92:95], v72 offset:1152
    s_waitcnt lgkmcnt(5)
    v_mfma_f32_16x16x32_bf16 v[20:23], v[152:155], v[76:79], v[20:23]
    buffer_store_dwordx4 v[216:219], v246, s[4:7], s23 offen sc1
    v_mul_f32 v28, v28, v196
    ds_read_b128 v[76:79], v73 offset:1152
    s_waitcnt lgkmcnt(5)
    v_mfma_f32_16x16x32_bf16 v[20:23], v[156:159], v[80:83], v[20:23]
    v_mul_f32 v29, v29, v197
    v_mul_f32 v30, v30, v198
    ds_read_b128 v[80:83], v74 offset:1152
    s_waitcnt lgkmcnt(5)
    v_mfma_f32_16x16x32_bf16 v[20:23], v[136:139], v[84:87], v[20:23]
    v_mul_f32 v31, v31, v199
    v_cvt_pk_bf16_f32 v28, v28, v29
    ds_read_b128 v[84:87], v75 offset:1152
    s_waitcnt lgkmcnt(4)
    v_mfma_f32_16x16x32_bf16 v[20:23], v[140:143], v[88:91], v[20:23]
    v_cvt_pk_bf16_f32 v29, v30, v31
    ds_write_b64 v205, v[28:29] offset:512
    ds_read_b128 v[88:91], v72 offset:384
    s_waitcnt lgkmcnt(5)
    v_mfma_f32_16x16x32_bf16 v[20:23], v[168:171], v[92:95], v[20:23]
    v_mul_f32 v40, v40, v196
    v_mul_f32 v41, v41, v197
    ds_read_b128 v[92:95], v73 offset:384
    s_waitcnt lgkmcnt(5)
    v_mfma_f32_16x16x32_bf16 v[20:23], v[172:175], v[76:79], v[20:23]
    v_mul_f32 v42, v42, v198
    v_mul_f32 v43, v43, v199
    ds_read_b128 v[76:79], v74 offset:384
    s_waitcnt lgkmcnt(5)
    v_mfma_f32_16x16x32_bf16 v[20:23], v[112:115], v[80:83], v[20:23]
    v_cvt_pk_bf16_f32 v40, v40, v41
    v_cvt_pk_bf16_f32 v41, v42, v43
    ds_read_b128 v[80:83], v75 offset:384
    s_waitcnt lgkmcnt(5)
    v_mfma_f32_16x16x32_bf16 v[20:23], v[116:119], v[84:87], v[20:23]
    ds_write_b64 v205, v[40:41] offset:768
    ds_read_b128 v[84:87], v72 offset:768
    s_waitcnt lgkmcnt(5)
    v_mfma_f32_16x16x32_bf16 v[44:47], v[120:123], v[88:91], 0
    ds_read_b128 v[88:91], v73 offset:768
    s_waitcnt lgkmcnt(5)
    v_mfma_f32_16x16x32_bf16 v[44:47], v[124:127], v[92:95], v[44:47]
    s_waitcnt lgkmcnt(2)
    s_barrier
    ds_read_b128 v[92:95], v74 offset:768
    v_mfma_f32_16x16x32_bf16 v[44:47], v[128:131], v[76:79], v[44:47]
    ds_read_b128 v[212:215], v207 offset:0
    ds_read_b128 v[216:219], v207 offset:1664
    ds_read_b128 v[76:79], v75 offset:768
    v_mfma_f32_16x16x32_bf16 v[44:47], v[132:135], v[80:83], v[44:47]
    ds_read_b128 v[80:83], v72 offset:896
    s_waitcnt lgkmcnt(6)
    v_mfma_f32_16x16x32_bf16 v[44:47], v[152:155], v[84:87], v[44:47]
    ds_read_b128 v[84:87], v73 offset:896
    s_waitcnt lgkmcnt(6)
    v_mfma_f32_16x16x32_bf16 v[44:47], v[156:159], v[88:91], v[44:47]
    ds_read_b128 v[88:91], v74 offset:896
    s_waitcnt lgkmcnt(6)
    v_mfma_f32_16x16x32_bf16 v[44:47], v[136:139], v[92:95], v[44:47]
    s_waitcnt lgkmcnt(5)
    buffer_store_dwordx4 v[212:215], v246, s[4:7], s24 offen sc1
    ds_read_b128 v[92:95], v75 offset:896
    s_waitcnt lgkmcnt(4)
    v_mfma_f32_16x16x32_bf16 v[44:47], v[140:143], v[76:79], v[44:47]
    buffer_store_dwordx4 v[216:219], v246, s[4:7], s25 offen sc1
    s_waitcnt lgkmcnt(3)
    v_mfma_f32_16x16x32_bf16 v[44:47], v[168:171], v[80:83], v[44:47]
    v_cvt_pk_bf16_f32 v8, v8, v9
    v_cvt_pk_bf16_f32 v9, v10, v11
    s_waitcnt lgkmcnt(2)
    v_mfma_f32_16x16x32_bf16 v[44:47], v[172:175], v[84:87], v[44:47]
    ds_write_b64 v204, v[8:9] offset:0
    v_mul_f32 v20, v20, v200
    s_waitcnt lgkmcnt(2)
    v_mfma_f32_16x16x32_bf16 v[44:47], v[112:115], v[88:91], v[44:47]
    v_mul_f32 v21, v21, v201
    v_mul_f32 v22, v22, v202
    s_waitcnt lgkmcnt(1)
    v_mfma_f32_16x16x32_bf16 v[44:47], v[116:119], v[92:95], v[44:47]
    v_mul_f32 v23, v23, v203
    v_cvt_pk_bf16_f32 v20, v20, v21
    v_cvt_pk_bf16_f32 v21, v22, v23
    ds_write_b64 v220, v[20:21] offset:256
    s_nop 3
    v_mul_f32 v44, v44, v200
    v_mul_f32 v45, v45, v201
    v_mul_f32 v46, v46, v202
    v_mul_f32 v47, v47, v203
    v_cvt_pk_bf16_f32 v44, v44, v45
    v_cvt_pk_bf16_f32 v45, v46, v47
    ds_write_b64 v204, v[44:45] offset:768
    s_waitcnt lgkmcnt(0)
    s_barrier
    ds_read_b128 v[212:215], v206 offset:0
    s_waitcnt lgkmcnt(0)
    buffer_store_dwordx4 v[212:215], v246, s[4:7], s26 offen sc1
    s_cmp_lg_u64 s[90:91], 0
    s_cbranch_scc1 FIX
    s_or_b32 s89, s89, s20
    s_cbranch_scc1 K2_end
    v_mov_b32 v0, 0
    v_mov_b32 v1, s88
    s_mov_b64 exec, 1
    buffer_store_dword v1, v0, s[16:19], 0 offen
    s_endpgm
T_pw:
    ds_read_b32 v191, v190
    s_waitcnt lgkmcnt(0)
    v_cmp_gt_u32 vcc, s53, v191
    s_cbranch_vccnz T_pw
    s_branch T_pwr
T_aw:
    ds_read_b32 v191, v190
    s_waitcnt lgkmcnt(0)
    v_cmp_gt_u32 vcc, s50, v191
    s_cbranch_vccnz T_aw
    s_branch T_awr
K2_end:
K2_last:
    s_endpgm
SLOW:
    v_readlane_b32 s89, v4, 62
    s_mov_b32 s46, -1
    s_mov_b32 s47, 256
    s_mov_b64 s[90:91], 0
    s_branch SL_go
FIX:
    s_ff1_i32_b64 s46, s[90:91]
    s_bitset0_b64 s[90:91], s46
    s_mov_b32 s47, 2048
    s_setprio 0
SL_go:
    s_waitcnt vmcnt(0) lgkmcnt(0)
    s_barrier
    s_load_dwordx2 s[22:23], s[0:1], 8
    s_load_dwordx2 s[24:25], s[0:1], 24
    s_load_dwordx2 s[26:27], s[0:1], 32
    s_load_dwordx2 s[28:29], s[0:1], 40
    s_load_dwordx2 s[30:31], s[0:1], 0
    v_mbcnt_lo_u32_b32 v240, -1, 0
    v_mbcnt_hi_u32_b32 v240, -1, v240
    v_lshrrev_b32 v229, 5, v240
    v_and_b32 v230, 31, v240
    v_lshlrev_b32 v241, 7, v229
    v_lshl_add_u32 v241, v230, 1, v241
    v_lshlrev_b32 v245, 4, v240
    v_mov_b32 v242, 0
    s_waitcnt lgkmcnt(0)
    s_mov_b32 s80, s22
    s_and_b32 s81, s23, 0xffff
    s_mov_b32 s82, 1920000
    s_mov_b32 s83, 0x20000
    s_mov_b32 s76, s24
    s_and_b32 s77, s25, 0xffff
    s_mov_b32 s78, 1280000
    s_mov_b32 s79, 0x20000
    s_mov_b32 s72, s26
    s_and_b32 s73, s27, 0xffff
    s_mov_b32 s74, 1280000
    s_mov_b32 s75, 0x20000
    s_mov_b32 s84, s28
    s_and_b32 s85, s29, 0xffff
    s_mov_b32 s86, 20480
    s_mov_b32 s87, 0x20000
    s_mov_b32 s4, s30
    s_and_b32 s5, s31, 0xffff
    s_mov_b32 s6, 10240000
    s_mov_b32 s7, 0x20000
    s_mov_b32 s66, 0
    buffer_load_ushort v0, v241, s[84:87], s66 offen offset:0
    buffer_load_ushort v1, v241, s[84:87], s66 offen offset:64
    buffer_load_ushort v2, v241, s[84:87], s66 offen offset:256
    buffer_load_ushort v3, v241, s[84:87], s66 offen offset:320
    buffer_load_ushort v4, v241, s[84:87], s66 offen offset:512
    buffer_load_ushort v5, v241, s[84:87], s66 offen offset:576
    buffer_load_ushort v6, v241, s[84:87], s66 offen offset:768
    buffer_load_ushort v7, v241, s[84:87], s66 offen offset:832
    buffer_load_ushort v8, v241, s[84:87], s66 offen offset:1024
    buffer_load_ushort v9, v241, s[84:87], s66 offen offset:1088
    s_mov_b32 s66, 1280
    buffer_load_ushort v10, v241, s[84:87], s66 offen offset:0
    buffer_load_ushort v11, v241, s[84:87], s66 offen offset:64
    buffer_load_ushort v12, v241, s[84:87], s66 offen offset:256
    buffer_load_ushort v13, v241, s[84:87], s66 offen offset:320
    buffer_load_ushort v14, v241, s[84:87], s66 offen offset:512
    buffer_load_ushort v15, v241, s[84:87], s66 offen offset:576
    buffer_load_ushort v16, v241, s[84:87], s66 offen offset:768
    buffer_load_ushort v17, v241, s[84:87], s66 offen offset:832
    buffer_load_ushort v18, v241, s[84:87], s66 offen offset:1024
    buffer_load_ushort v19, v241, s[84:87], s66 offen offset:1088
    s_mov_b32 s66, 2560
    buffer_load_ushort v20, v241, s[84:87], s66 offen offset:0
    buffer_load_ushort v21, v241, s[84:87], s66 offen offset:64
    buffer_load_ushort v22, v241, s[84:87], s66 offen offset:256
    buffer_load_ushort v23, v241, s[84:87], s66 offen offset:320
    buffer_load_ushort v24, v241, s[84:87], s66 offen offset:512
    buffer_load_ushort v25, v241, s[84:87], s66 offen offset:576
    buffer_load_ushort v26, v241, s[84:87], s66 offen offset:768
    buffer_load_ushort v27, v241, s[84:87], s66 offen offset:832
    buffer_load_ushort v28, v241, s[84:87], s66 offen offset:1024
    buffer_load_ushort v29, v241, s[84:87], s66 offen offset:1088
    s_mov_b32 s66, 3840
    buffer_load_ushort v30, v241, s[84:87], s66 offen offset:0
    buffer_load_ushort v31, v241, s[84:87], s66 offen offset:64
    buffer_load_ushort v32, v241, s[84:87], s66 offen offset:256
    buffer_load_ushort v33, v241, s[84:87], s66 offen offset:320
    buffer_load_ushort v34, v241, s[84:87], s66 offen offset:512
    buffer_load_ushort v35, v241, s[84:87], s66 offen offset:576
    buffer_load_ushort v36, v241, s[84:87], s66 offen offset:768
    buffer_load_ushort v37, v241, s[84:87], s66 offen offset:832
    buffer_load_ushort v38, v241, s[84:87], s66 offen offset:1024
    buffer_load_ushort v39, v241, s[84:87], s66 offen offset:1088
    s_waitcnt vmcnt(0)
    s_mov_b32 s66, 5120
    buffer_load_ushort v40, v241, s[84:87], s66 offen offset:0
    buffer_load_ushort v41, v241, s[84:87], s66 offen offset:64
    buffer_load_ushort v42, v241, s[84:87], s66 offen offset:256
    buffer_load_ushort v43, v241, s[84:87], s66 offen offset:320
    buffer_load_ushort v44, v241, s[84:87], s66 offen offset:512
    buffer_load_ushort v45, v241, s[84:87], s66 offen offset:576
    buffer_load_ushort v46, v241, s[84:87], s66 offen offset:768
    buffer_load_ushort v47, v241, s[84:87], s66 offen offset:832
    buffer_load_ushort v48, v241, s[84:87], s66 offen offset:1024
    buffer_load_ushort v49, v241, s[84:87], s66 offen offset:1088
    s_mov_b32 s66, 6400
    buffer_load_ushort v50, v241, s[84:87], s66 offen offset:0
    buffer_load_ushort v51, v241, s[84:87], s66 offen offset:64
    buffer_load_ushort v52, v241, s[84:87], s66 offen offset:256
    buffer_load_ushort v53, v241, s[84:87], s66 offen offset:320
    buffer_load_ushort v54, v241, s[84:87], s66 offen offset:512
    buffer_load_ushort v55, v241, s[84:87], s66 offen offset:576
    buffer_load_ushort v56, v241, s[84:87], s66 offen offset:768
    buffer_load_ushort v57, v241, s[84:87], s66 offen offset:832
    buffer_load_ushort v58, v241, s[84:87], s66 offen offset:1024
    buffer_load_ushort v59, v241, s[84:87], s66 offen offset:1088
    s_mov_b32 s66, 7680
    buffer_load_ushort v60, v241, s[84:87], s66 offen offset:0
    buffer_load_ushort v61, v241, s[84:87], s66 offen offset:64
    buffer_load_ushort v62, v241, s[84:87], s66 offen offset:256
    buffer_load_ushort v63, v241, s[84:87], s66 offen offset:320
    buffer_load_ushort v64, v241, s[84:87], s66 offen offset:512
    buffer_load_ushort v65, v241, s[84:87], s66 offen offset:576
    buffer_load_ushort v66, v241, s[84:87], s66 offen offset:768
    buffer_load_ushort v67, v241, s[84:87], s66 offen offset:832
    buffer_load_ushort v68, v241, s[84:87], s66 offen offset:1024
    buffer_load_ushort v69, v241, s[84:87], s66 offen offset:1088
    s_mov_b32 s66, 8960
    buffer_load_ushort v70, v241, s[84:87], s66 offen offset:0
    buffer_load_ushort v71, v241, s[84:87], s66 offen offset:64
    buffer_load_ushort v72, v241, s[84:87], s66 offen offset:256
    buffer_load_ushort v73, v241, s[84:87], s66 offen offset:320
    buffer_load_ushort v74, v241, s[84:87], s66 offen offset:512
    buffer_load_ushort v75, v241, s[84:87], s66 offen offset:576
    buffer_load_ushort v76, v241, s[84:87], s66 offen offset:768
    buffer_load_ushort v77, v241, s[84:87], s66 offen offset:832
    buffer_load_ushort v78, v241, s[84:87], s66 offen offset:1024
    buffer_load_ushort v79, v241, s[84:87], s66 offen offset:1088
    s_waitcnt vmcnt(0)
    s_mov_b32 s66, 10240
    buffer_load_ushort v80, v241, s[84:87], s66 offen offset:0
    buffer_load_ushort v81, v241, s[84:87], s66 offen offset:64
    buffer_load_ushort v82, v241, s[84:87], s66 offen offset:256
    buffer_load_ushort v83, v241, s[84:87], s66 offen offset:320
    buffer_load_ushort v84, v241, s[84:87], s66 offen offset:512
    buffer_load_ushort v85, v241, s[84:87], s66 offen offset:576
    buffer_load_ushort v86, v241, s[84:87], s66 offen offset:768
    buffer_load_ushort v87, v241, s[84:87], s66 offen offset:832
    buffer_load_ushort v88, v241, s[84:87], s66 offen offset:1024
    buffer_load_ushort v89, v241, s[84:87], s66 offen offset:1088
    s_mov_b32 s66, 11520
    buffer_load_ushort v90, v241, s[84:87], s66 offen offset:0
    buffer_load_ushort v91, v241, s[84:87], s66 offen offset:64
    buffer_load_ushort v92, v241, s[84:87], s66 offen offset:256
    buffer_load_ushort v93, v241, s[84:87], s66 offen offset:320
    buffer_load_ushort v94, v241, s[84:87], s66 offen offset:512
    buffer_load_ushort v95, v241, s[84:87], s66 offen offset:576
    buffer_load_ushort v96, v241, s[84:87], s66 offen offset:768
    buffer_load_ushort v97, v241, s[84:87], s66 offen offset:832
    buffer_load_ushort v98, v241, s[84:87], s66 offen offset:1024
    buffer_load_ushort v99, v241, s[84:87], s66 offen offset:1088
    s_mov_b32 s66, 12800
    buffer_load_ushort v100, v241, s[84:87], s66 offen offset:0
    buffer_load_ushort v101, v241, s[84:87], s66 offen offset:64
    buffer_load_ushort v102, v241, s[84:87], s66 offen offset:256
    buffer_load_ushort v103, v241, s[84:87], s66 offen offset:320
    buffer_load_ushort v104, v241, s[84:87], s66 offen offset:512
    buffer_load_ushort v105, v241, s[84:87], s66 offen offset:576
    buffer_load_ushort v106, v241, s[84:87], s66 offen offset:768
    buffer_load_ushort v107, v241, s[84:87], s66 offen offset:832
    buffer_load_ushort v108, v241, s[84:87], s66 offen offset:1024
    buffer_load_ushort v109, v241, s[84:87], s66 offen offset:1088
    s_mov_b32 s66, 14080
    buffer_load_ushort v110, v241, s[84:87], s66 offen offset:0
    buffer_load_ushort v111, v241, s[84:87], s66 offen offset:64
    buffer_load_ushort v112, v241, s[84:87], s66 offen offset:256
    buffer_load_ushort v113, v241, s[84:87], s66 offen offset:320
    buffer_load_ushort v114, v241, s[84:87], s66 offen offset:512
    buffer_load_ushort v115, v241, s[84:87], s66 offen offset:576
    buffer_load_ushort v116, v241, s[84:87], s66 offen offset:768
    buffer_load_ushort v117, v241, s[84:87], s66 offen offset:832
    buffer_load_ushort v118, v241, s[84:87], s66 offen offset:1024
    buffer_load_ushort v119, v241, s[84:87], s66 offen offset:1088
    s_waitcnt vmcnt(0)
    s_mov_b32 s66, 15360
    buffer_load_ushort v120, v241, s[84:87], s66 offen offset:0
    buffer_load_ushort v121, v241, s[84:87], s66 offen offset:64
    buffer_load_ushort v122, v241, s[84:87], s66 offen offset:256
    buffer_load_ushort v123, v241, s[84:87], s66 offen offset:320
    buffer_load_ushort v124, v241, s[84:87], s66 offen offset:512
    buffer_load_ushort v125, v241, s[84:87], s66 offen offset:576
    buffer_load_ushort v126, v241, s[84:87], s66 offen offset:768
    buffer_load_ushort v127, v241, s[84:87], s66 offen offset:832
    buffer_load_ushort v128, v241, s[84:87], s66 offen offset:1024
    buffer_load_ushort v129, v241, s[84:87], s66 offen offset:1088
    s_mov_b32 s66, 16640
    buffer_load_ushort v130, v241, s[84:87], s66 offen offset:0
    buffer_load_ushort v131, v241, s[84:87], s66 offen offset:64
    buffer_load_ushort v132, v241, s[84:87], s66 offen offset:256
    buffer_load_ushort v133, v241, s[84:87], s66 offen offset:320
    buffer_load_ushort v134, v241, s[84:87], s66 offen offset:512
    buffer_load_ushort v135, v241, s[84:87], s66 offen offset:576
    buffer_load_ushort v136, v241, s[84:87], s66 offen offset:768
    buffer_load_ushort v137, v241, s[84:87], s66 offen offset:832
    buffer_load_ushort v138, v241, s[84:87], s66 offen offset:1024
    buffer_load_ushort v139, v241, s[84:87], s66 offen offset:1088
    s_mov_b32 s66, 17920
    buffer_load_ushort v140, v241, s[84:87], s66 offen offset:0
    buffer_load_ushort v141, v241, s[84:87], s66 offen offset:64
    buffer_load_ushort v142, v241, s[84:87], s66 offen offset:256
    buffer_load_ushort v143, v241, s[84:87], s66 offen offset:320
    buffer_load_ushort v144, v241, s[84:87], s66 offen offset:512
    buffer_load_ushort v145, v241, s[84:87], s66 offen offset:576
    buffer_load_ushort v146, v241, s[84:87], s66 offen offset:768
    buffer_load_ushort v147, v241, s[84:87], s66 offen offset:832
    buffer_load_ushort v148, v241, s[84:87], s66 offen offset:1024
    buffer_load_ushort v149, v241, s[84:87], s66 offen offset:1088
    s_mov_b32 s66, 19200
    buffer_load_ushort v150, v241, s[84:87], s66 offen offset:0
    buffer_load_ushort v151, v241, s[84:87], s66 offen offset:64
    buffer_load_ushort v152, v241, s[84:87], s66 offen offset:256
    buffer_load_ushort v153, v241, s[84:87], s66 offen offset:320
    buffer_load_ushort v154, v241, s[84:87], s66 offen offset:512
    buffer_load_ushort v155, v241, s[84:87], s66 offen offset:576
    buffer_load_ushort v156, v241, s[84:87], s66 offen offset:768
    buffer_load_ushort v157, v241, s[84:87], s66 offen offset:832
    buffer_load_ushort v158, v241, s[84:87], s66 offen offset:1024
    buffer_load_ushort v159, v241, s[84:87], s66 offen offset:1088
    s_waitcnt vmcnt(0)
    v_lshlrev_b32 v0, 16, v0
    v_lshlrev_b32 v1, 16, v1
    v_lshlrev_b32 v2, 16, v2
    v_lshlrev_b32 v3, 16, v3
    v_lshlrev_b32 v4, 16, v4
    v_lshlrev_b32 v5, 16, v5
    v_lshlrev_b32 v6, 16, v6
    v_lshlrev_b32 v7, 16, v7
    v_lshlrev_b32 v8, 16, v8
    v_lshlrev_b32 v9, 16, v9
    v_lshlrev_b32 v10, 16, v10
    v_lshlrev_b32 v11, 16, v11
    v_lshlrev_b32 v12, 16, v12
    v_lshlrev_b32 v13, 16, v13
    v_lshlrev_b32 v14, 16, v14
    v_lshlrev_b32 v15, 16, v15
    v_lshlrev_b32 v16, 16, v16
    v_lshlrev_b32 v17, 16, v17
    v_lshlrev_b32 v18, 16, v18
    v_lshlrev_b32 v19, 16, v19
    v_lshlrev_b32 v20, 16, v20
    v_lshlrev_b32 v21, 16, v21
    v_lshlrev_b32 v22, 16, v22
    v_lshlrev_b32 v23, 16, v23
    v_lshlrev_b32 v24, 16, v24
    v_lshlrev_b32 v25, 16, v25
    v_lshlrev_b32 v26, 16, v26
    v_lshlrev_b32 v27, 16, v27
    v_lshlrev_b32 v28, 16, v28
    v_lshlrev_b32 v29, 16, v29
    v_lshlrev_b32 v30, 16, v30
    v_lshlrev_b32 v31, 16, v31
    v_lshlrev_b32 v32, 16, v32
    v_lshlrev_b32 v33, 16, v33
    v_lshlrev_b32 v34, 16, v34
    v_lshlrev_b32 v35, 16, v35
    v_lshlrev_b32 v36, 16, v36
    v_lshlrev_b32 v37, 16, v37
    v_lshlrev_b32 v38, 16, v38
    v_lshlrev_b32 v39, 16, v39
    v_lshlrev_b32 v40, 16, v40
    v_lshlrev_b32 v41, 16, v41
    v_lshlrev_b32 v42, 16, v42
    v_lshlrev_b32 v43, 16, v43
    v_lshlrev_b32 v44, 16, v44
    v_lshlrev_b32 v45, 16, v45
    v_lshlrev_b32 v46, 16, v46
    v_lshlrev_b32 v47, 16, v47
    v_lshlrev_b32 v48, 16, v48
    v_lshlrev_b32 v49, 16, v49
    v_lshlrev_b32 v50, 16, v50
    v_lshlrev_b32 v51, 16, v51
    v_lshlrev_b32 v52, 16, v52
    v_lshlrev_b32 v53, 16, v53
    v_lshlrev_b32 v54, 16, v54
    v_lshlrev_b32 v55, 16, v55
    v_lshlrev_b32 v56, 16, v56
    v_lshlrev_b32 v57, 16, v57
    v_lshlrev_b32 v58, 16, v58
    v_lshlrev_b32 v59, 16, v59
    v_lshlrev_b32 v60, 16, v60
    v_lshlrev_b32 v61, 16, v61
    v_lshlrev_b32 v62, 16, v62
    v_lshlrev_b32 v63, 16, v63
    v_lshlrev_b32 v64, 16, v64
    v_lshlrev_b32 v65, 16, v65
    v_lshlrev_b32 v66, 16, v66
    v_lshlrev_b32 v67, 16, v67
    v_lshlrev_b32 v68, 16, v68
    v_lshlrev_b32 v69, 16, v69
    v_lshlrev_b32 v70, 16, v70
    v_lshlrev_b32 v71, 16, v71
    v_lshlrev_b32 v72, 16, v72
    v_lshlrev_b32 v73, 16, v73
    v_lshlrev_b32 v74, 16, v74
    v_lshlrev_b32 v75, 16, v75
    v_lshlrev_b32 v76, 16, v76
    v_lshlrev_b32 v77, 16, v77
    v_lshlrev_b32 v78, 16, v78
    v_lshlrev_b32 v79, 16, v79
    v_lshlrev_b32 v80, 16, v80
    v_lshlrev_b32 v81, 16, v81
    v_lshlrev_b32 v82, 16, v82
    v_lshlrev_b32 v83, 16, v83
    v_lshlrev_b32 v84, 16, v84
    v_lshlrev_b32 v85, 16, v85
    v_lshlrev_b32 v86, 16, v86
    v_lshlrev_b32 v87, 16, v87
    v_lshlrev_b32 v88, 16, v88
    v_lshlrev_b32 v89, 16, v89
    v_lshlrev_b32 v90, 16, v90
    v_lshlrev_b32 v91, 16, v91
    v_lshlrev_b32 v92, 16, v92
    v_lshlrev_b32 v93, 16, v93
    v_lshlrev_b32 v94, 16, v94
    v_lshlrev_b32 v95, 16, v95
    v_lshlrev_b32 v96, 16, v96
    v_lshlrev_b32 v97, 16, v97
    v_lshlrev_b32 v98, 16, v98
    v_lshlrev_b32 v99, 16, v99
    v_lshlrev_b32 v100, 16, v100
    v_lshlrev_b32 v101, 16, v101
    v_lshlrev_b32 v102, 16, v102
    v_lshlrev_b32 v103, 16, v103
    v_lshlrev_b32 v104, 16, v104
    v_lshlrev_b32 v105, 16, v105
    v_lshlrev_b32 v106, 16, v106
    v_lshlrev_b32 v107, 16, v107
    v_lshlrev_b32 v108, 16, v108
    v_lshlrev_b32 v109, 16, v109
    v_lshlrev_b32 v110, 16, v110
    v_lshlrev_b32 v111, 16, v111
    v_lshlrev_b32 v112, 16, v112
    v_lshlrev_b32 v113, 16, v113
    v_lshlrev_b32 v114, 16, v114
    v_lshlrev_b32 v115, 16, v115
    v_lshlrev_b32 v116, 16, v116
    v_lshlrev_b32 v117, 16, v117
    v_lshlrev_b32 v118, 16, v118
    v_lshlrev_b32 v119, 16, v119
    v_lshlrev_b32 v120, 16, v120
    v_lshlrev_b32 v121, 16, v121
    v_lshlrev_b32 v122, 16, v122
    v_lshlrev_b32 v123, 16, v123
    v_lshlrev_b32 v124, 16, v124
    v_lshlrev_b32 v125, 16, v125
    v_lshlrev_b32 v126, 16, v126
    v_lshlrev_b32 v127, 16, v127
    v_lshlrev_b32 v128, 16, v128
    v_lshlrev_b32 v129, 16, v129
    v_lshlrev_b32 v130, 16, v130
    v_lshlrev_b32 v131, 16, v131
    v_lshlrev_b32 v132, 16, v132
    v_lshlrev_b32 v133, 16, v133
    v_lshlrev_b32 v134, 16, v134
    v_lshlrev_b32 v135, 16, v135
    v_lshlrev_b32 v136, 16, v136
    v_lshlrev_b32 v137, 16, v137
    v_lshlrev_b32 v138, 16, v138
    v_lshlrev_b32 v139, 16, v139
    v_lshlrev_b32 v140, 16, v140
    v_lshlrev_b32 v141, 16, v141
    v_lshlrev_b32 v142, 16, v142
    v_lshlrev_b32 v143, 16, v143
    v_lshlrev_b32 v144, 16, v144
    v_lshlrev_b32 v145, 16, v145
    v_lshlrev_b32 v146, 16, v146
    v_lshlrev_b32 v147, 16, v147
    v_lshlrev_b32 v148, 16, v148
    v_lshlrev_b32 v149, 16, v149
    v_lshlrev_b32 v150, 16, v150
    v_lshlrev_b32 v151, 16, v151
    v_lshlrev_b32 v152, 16, v152
    v_lshlrev_b32 v153, 16, v153
    v_lshlrev_b32 v154, 16, v154
    v_lshlrev_b32 v155, 16, v155
    v_lshlrev_b32 v156, 16, v156
    v_lshlrev_b32 v157, 16, v157
    v_lshlrev_b32 v158, 16, v158
    v_lshlrev_b32 v159, 16, v159
    s_mov_b32 s50, 0
SL_node:
    s_mul_i32 s34, s2, 40
    s_lshl_b32 s66, s50, 3
    s_add_u32 s66, s66, s20
    s_mov_b32 s35, 0
    s_cmp_lt_i32 s46, 0
    s_cbranch_scc1 SL_own
    s_cmp_lg_u32 s50, 0
    s_cbranch_scc1 SL_rows
    s_mov_b32 s66, s46
    s_lshl_b32 s35, s20, 8
SL_own:
    s_add_u32 s34, s34, s66
    v_mov_b32 v160, 0
    v_mov_b32 v161, 0
    v_mov_b32 v162, 0
    v_mov_b32 v163, 0
    v_mov_b32 v164, 0
    v_mov_b32 v165, 0
    v_mov_b32 v166, 0
    v_mov_b32 v167, 0
    v_mov_b32 v168, 0
    v_mov_b32 v169, 0
    v_mov_b32 v170, 0
    v_mov_b32 v171, 0
    v_mov_b32 v172, 0
    v_mov_b32 v173, 0
    v_mov_b32 v174, 0
    v_mov_b32 v175, 0
    v_mov_b32 v176, 0
    v_mov_b32 v177, 0
    v_mov_b32 v178, 0
    v_mov_b32 v179, 0
    v_mov_b32 v180, 0
    v_mov_b32 v181, 0
SL_scan:
    s_lshl_b32 s66, s35, 2
    s_lshl_b32 s67, s47, 2
    v_add_u32 v229, s66, v245
    buffer_load_dwordx4 v[232:235], v229, s[72:75], 0 offen
    v_add_u32 v229, s67, v229
    buffer_load_dwordx4 v[236:239], v229, s[72:75], 0 offen
    v_add_u32 v229, s67, v229
    buffer_load_dwordx4 v[248:251], v229, s[72:75], 0 offen
    v_add_u32 v229, s67, v229
    buffer_load_dwordx4 v[252:255], v229, s[72:75], 0 offen
    s_mov_b32 s48, 0
    s_waitcnt vmcnt(3)
    v_cmpx_ne_u32 vcc, s34, v232
    v_cmpx_ne_u32 vcc, s34, v233
    v_cmpx_ne_u32 vcc, s34, v234
    v_cmpx_ne_u32 vcc, s34, v235
    s_waitcnt vmcnt(2)
    v_cmpx_ne_u32 vcc, s34, v236
    v_cmpx_ne_u32 vcc, s34, v237
    v_cmpx_ne_u32 vcc, s34, v238
    v_cmpx_ne_u32 vcc, s34, v239
    s_waitcnt vmcnt(1)
    v_cmpx_ne_u32 vcc, s34, v248
    v_cmpx_ne_u32 vcc, s34, v249
    v_cmpx_ne_u32 vcc, s34, v250
    v_cmpx_ne_u32 vcc, s34, v251
    s_waitcnt vmcnt(0)
    v_cmpx_ne_u32 vcc, s34, v252
    v_cmpx_ne_u32 vcc, s34, v253
    v_cmpx_ne_u32 vcc, s34, v254
    v_cmpx_ne_u32 vcc, s34, v255
    s_nop 0
    s_cmp_eq_u64 exec, -1
    s_mov_b64 exec, -1
    s_cbranch_scc0 SL_piece
    s_add_u32 s35, s35, s67
    s_cmp_lt_u32 s35, 320000
    s_cbranch_scc1 SL_scan
    s_branch SL_done
SL_piece:
    v_cmp_eq_u32 s[38:39], s34, v232
    v_cmp_eq_u32 s[40:41], s34, v233
    v_cmp_eq_u32 s[42:43], s34, v234
    v_cmp_eq_u32 s[44:45], s34, v235
    s_mov_b32 s36, 0
SL_bits:
    s_cmp_eq_u64 s[38:39], 0
    s_cbranch_scc1 SL_nexti
    s_ff1_i32_b64 s66, s[38:39]
    s_bitset0_b64 s[38:39], s66
    s_lshl_b32 s66, s66, 2
    s_add_u32 s37, s66, s36
    s_add_u32 s37, s37, s35
    s_lshl_b32 s66, s37, 2
    s_lshl_b32 s67, s37, 5
    s_mul_i32 s68, s37, 6
    buffer_load_dword v243, v242, s[76:79], s66 offen
    buffer_load_dwordx4 v[184:187], v242, s[12:15], s67 offen
    buffer_load_dwordx4 v[188:191], v242, s[12:15], s67 offen offset:16
    buffer_load_ushort v226, v242, s[80:83], s68 offen offset:0
    buffer_load_ushort v227, v242, s[80:83], s68 offen offset:2
    buffer_load_ushort v228, v242, s[80:83], s68 offen offset:4
    s_waitcnt vmcnt(5)
    v_lshl_add_u32 v243, v243, 10, v241
    buffer_load_ushort v208, v243, s[4:7], 0 offen offset:0
    buffer_load_ushort v209, v243, s[4:7], 0 offen offset:64
    buffer_load_ushort v210, v243, s[4:7], 0 offen offset:256
    buffer_load_ushort v211, v243, s[4:7], 0 offen offset:320
    buffer_load_ushort v212, v243, s[4:7], 0 offen offset:512
    buffer_load_ushort v213, v243, s[4:7], 0 offen offset:576
    buffer_load_ushort v214, v243, s[4:7], 0 offen offset:768
    buffer_load_ushort v215, v243, s[4:7], 0 offen offset:832
    s_waitcnt vmcnt(8)
    v_lshlrev_b32 v192, 16, v184
    v_and_b32 v193, 0xffff0000, v184
    v_lshlrev_b32 v194, 16, v185
    v_and_b32 v195, 0xffff0000, v185
    v_lshlrev_b32 v196, 16, v186
    v_and_b32 v197, 0xffff0000, v186
    v_lshlrev_b32 v198, 16, v187
    v_and_b32 v199, 0xffff0000, v187
    v_lshlrev_b32 v200, 16, v188
    v_and_b32 v201, 0xffff0000, v188
    v_lshlrev_b32 v202, 16, v189
    v_and_b32 v203, 0xffff0000, v189
    v_lshlrev_b32 v204, 16, v190
    v_and_b32 v205, 0xffff0000, v190
    v_lshlrev_b32 v206, 16, v191
    v_and_b32 v207, 0xffff0000, v191
    v_lshlrev_b32 v226, 16, v226
    v_lshlrev_b32 v227, 16, v227
    v_lshlrev_b32 v228, 16, v228
    v_mul_f32 v216, v192, v0
    v_mul_f32 v217, v192, v1
    v_mul_f32 v218, v192, v2
    v_mul_f32 v219, v192, v3
    v_mul_f32 v220, v192, v4
    v_mul_f32 v221, v192, v5
    v_mul_f32 v222, v192, v6
    v_mul_f32 v223, v192, v7
    v_mul_f32 v224, v192, v8
    v_mul_f32 v225, v192, v9
    v_fmac_f32 v216, v193, v10
    v_fmac_f32 v217, v193, v11
    v_fmac_f32 v218, v193, v12
    v_fmac_f32 v219, v193, v13
    v_fmac_f32 v220, v193, v14
    v_fmac_f32 v221, v193, v15
    v_fmac_f32 v222, v193, v16
    v_fmac_f32 v223, v193, v17
    v_fmac_f32 v224, v193, v18
    v_fmac_f32 v225, v193, v19
    v_fmac_f32 v216, v194, v20
    v_fmac_f32 v217, v194, v21
    v_fmac_f32 v218, v194, v22
    v_fmac_f32 v219, v194, v23
    v_fmac_f32 v220, v194, v24
    v_fmac_f32 v221, v194, v25
    v_fmac_f32 v222, v194, v26
    v_fmac_f32 v223, v194, v27
    v_fmac_f32 v224, v194, v28
    v_fmac_f32 v225, v194, v29
    v_fmac_f32 v216, v195, v30
    v_fmac_f32 v217, v195, v31
    v_fmac_f32 v218, v195, v32
    v_fmac_f32 v219, v195, v33
    v_fmac_f32 v220, v195, v34
    v_fmac_f32 v221, v195, v35
    v_fmac_f32 v222, v195, v36
    v_fmac_f32 v223, v195, v37
    v_fmac_f32 v224, v195, v38
    v_fmac_f32 v225, v195, v39
    v_fmac_f32 v216, v196, v40
    v_fmac_f32 v217, v196, v41
    v_fmac_f32 v218, v196, v42
    v_fmac_f32 v219, v196, v43
    v_fmac_f32 v220, v196, v44
    v_fmac_f32 v221, v196, v45
    v_fmac_f32 v222, v196, v46
    v_fmac_f32 v223, v196, v47
    v_fmac_f32 v224, v196, v48
    v_fmac_f32 v225, v196, v49
    v_fmac_f32 v216, v197, v50
    v_fmac_f32 v217, v197, v51
    v_fmac_f32 v218, v197, v52
    v_fmac_f32 v219, v197, v53
    v_fmac_f32 v220, v197, v54
    v_fmac_f32 v221, v197, v55
    v_fmac_f32 v222, v197, v56
    v_fmac_f32 v223, v197, v57
    v_fmac_f32 v224, v197, v58
    v_fmac_f32 v225, v197, v59
    v_fmac_f32 v216, v198, v60
    v_fmac_f32 v217, v198, v61
    v_fmac_f32 v218, v198, v62
    v_fmac_f32 v219, v198, v63
    v_fmac_f32 v220, v198, v64
    v_fmac_f32 v221, v198, v65
    v_fmac_f32 v222, v198, v66
    v_fmac_f32 v223, v198, v67
    v_fmac_f32 v224, v198, v68
    v_fmac_f32 v225, v198, v69
    v_fmac_f32 v216, v199, v70
    v_fmac_f32 v217, v199, v71
    v_fmac_f32 v218, v199, v72
    v_fmac_f32 v219, v199, v73
    v_fmac_f32 v220, v199, v74
    v_fmac_f32 v221, v199, v75
    v_fmac_f32 v222, v199, v76
    v_fmac_f32 v223, v199, v77
    v_fmac_f32 v224, v199, v78
    v_fmac_f32 v225, v199, v79
    v_fmac_f32 v216, v200, v80
    v_fmac_f32 v217, v200, v81
    v_fmac_f32 v218, v200, v82
    v_fmac_f32 v219, v200, v83
    v_fmac_f32 v220, v200, v84
    v_fmac_f32 v221, v200, v85
    v_fmac_f32 v222, v200, v86
    v_fmac_f32 v223, v200, v87
    v_fmac_f32 v224, v200, v88
    v_fmac_f32 v225, v200, v89
    v_fmac_f32 v216, v201, v90
    v_fmac_f32 v217, v201, v91
    v_fmac_f32 v218, v201, v92
    v_fmac_f32 v219, v201, v93
    v_fmac_f32 v220, v201, v94
    v_fmac_f32 v221, v201, v95
    v_fmac_f32 v222, v201, v96
    v_fmac_f32 v223, v201, v97
    v_fmac_f32 v224, v201, v98
    v_fmac_f32 v225, v201, v99
    v_fmac_f32 v216, v202, v100
    v_fmac_f32 v217, v202, v101
    v_fmac_f32 v218, v202, v102
    v_fmac_f32 v219, v202, v103
    v_fmac_f32 v220, v202, v104
    v_fmac_f32 v221, v202, v105
    v_fmac_f32 v222, v202, v106
    v_fmac_f32 v223, v202, v107
    v_fmac_f32 v224, v202, v108
    v_fmac_f32 v225, v202, v109
    v_fmac_f32 v216, v203, v110
    v_fmac_f32 v217, v203, v111
    v_fmac_f32 v218, v203, v112
    v_fmac_f32 v219, v203, v113
    v_fmac_f32 v220, v203, v114
    v_fmac_f32 v221, v203, v115
    v_fmac_f32 v222, v203, v116
    v_fmac_f32 v223, v203, v117
    v_fmac_f32 v224, v203, v118
    v_fmac_f32 v225, v203, v119
    v_fmac_f32 v216, v204, v120
    v_fmac_f32 v217, v204, v121
    v_fmac_f32 v218, v204, v122
    v_fmac_f32 v219, v204, v123
    v_fmac_f32 v220, v204, v124
    v_fmac_f32 v221, v204, v125
    v_fmac_f32 v222, v204, v126
    v_fmac_f32 v223, v204, v127
    v_fmac_f32 v224, v204, v128
    v_fmac_f32 v225, v204, v129
    v_fmac_f32 v216, v205, v130
    v_fmac_f32 v217, v205, v131
    v_fmac_f32 v218, v205, v132
    v_fmac_f32 v219, v205, v133
    v_fmac_f32 v220, v205, v134
    v_fmac_f32 v221, v205, v135
    v_fmac_f32 v222, v205, v136
    v_fmac_f32 v223, v205, v137
    v_fmac_f32 v224, v205, v138
    v_fmac_f32 v225, v205, v139
    v_fmac_f32 v216, v206, v140
    v_fmac_f32 v217, v206, v141
    v_fmac_f32 v218, v206, v142
    v_fmac_f32 v219, v206, v143
    v_fmac_f32 v220, v206, v144
    v_fmac_f32 v221, v206, v145
    v_fmac_f32 v222, v206, v146
    v_fmac_f32 v223, v206, v147
    v_fmac_f32 v224, v206, v148
    v_fmac_f32 v225, v206, v149
    v_fmac_f32 v216, v207, v150
    v_fmac_f32 v217, v207, v151
    v_fmac_f32 v218, v207, v152
    v_fmac_f32 v219, v207, v153
    v_fmac_f32 v220, v207, v154
    v_fmac_f32 v221, v207, v155
    v_fmac_f32 v222, v207, v156
    v_fmac_f32 v223, v207, v157
    v_fmac_f32 v224, v207, v158
    v_fmac_f32 v225, v207, v159
    s_waitcnt vmcnt(0)
    v_lshlrev_b32 v208, 16, v208
    v_lshlrev_b32 v209, 16, v209
    v_lshlrev_b32 v210, 16, v210
    v_lshlrev_b32 v211, 16, v211
    v_lshlrev_b32 v212, 16, v212
    v_lshlrev_b32 v213, 16, v213
    v_lshlrev_b32 v214, 16, v214
    v_lshlrev_b32 v215, 16, v215
    v_fmac_f32 v160, v208, v216
    v_mul_f32 v229, v210, v226
    v_fmac_f32 v229, v212, v227
    v_fmac_f32 v229, v214, v228
    v_fmac_f32 v176, v229, v218
    v_mul_f32 v229, v208, v220
    v_fmac_f32 v162, v229, v226
    v_fmac_f32 v168, v210, v222
    v_mul_f32 v230, v227, v214
    v_fma_f32 v230, -v228, v212, v230
    v_fmac_f32 v178, v230, v224
    v_fmac_f32 v164, v229, v227
    v_fmac_f32 v170, v212, v222
    v_mul_f32 v230, v228, v210
    v_fma_f32 v230, -v226, v214, v230
    v_fmac_f32 v180, v230, v224
    v_fmac_f32 v166, v229, v228
    v_fmac_f32 v172, v214, v222
    v_mul_f32 v230, v226, v212
    v_fma_f32 v230, -v227, v210, v230
    v_fmac_f32 v174, v230, v224
    v_fmac_f32 v161, v209, v217
    v_mul_f32 v229, v211, v226
    v_fmac_f32 v229, v213, v227
    v_fmac_f32 v229, v215, v228
    v_fmac_f32 v177, v229, v219
    v_mul_f32 v229, v209, v221
    v_fmac_f32 v163, v229, v226
    v_fmac_f32 v169, v211, v223
    v_mul_f32 v230, v227, v215
    v_fma_f32 v230, -v228, v213, v230
    v_fmac_f32 v179, v230, v225
    v_fmac_f32 v165, v229, v227
    v_fmac_f32 v171, v213, v223
    v_mul_f32 v230, v228, v211
    v_fma_f32 v230, -v226, v215, v230
    v_fmac_f32 v181, v230, v225
    v_fmac_f32 v167, v229, v228
    v_fmac_f32 v173, v215, v223
    v_mul_f32 v230, v226, v213
    v_fma_f32 v230, -v227, v211, v230
    v_fmac_f32 v175, v230, v225
    s_branch SL_bits
SL_nexti:
    s_mov_b64 s[38:39], s[40:41]
    s_mov_b64 s[40:41], s[42:43]
    s_mov_b64 s[42:43], s[44:45]
    s_add_u32 s36, s36, 1
    s_cmp_lt_u32 s36, 4
    s_cbranch_scc1 SL_bits
    s_add_u32 s35, s35, s47
    s_cmp_ge_u32 s35, 320000
    s_cbranch_scc1 SL_done
    s_add_u32 s48, s48, 1
    s_cmp_eq_u32 s48, 4
    s_cbranch_scc1 SL_scan
    v_mov_b32 v232, v236
    v_mov_b32 v233, v237
    v_mov_b32 v234, v238
    v_mov_b32 v235, v239
    v_mov_b32 v236, v248
    v_mov_b32 v237, v249
    v_mov_b32 v238, v250
    v_mov_b32 v239, v251
    v_mov_b32 v248, v252
    v_mov_b32 v249, v253
    v_mov_b32 v250, v254
    v_mov_b32 v251, v255
    s_branch SL_piece
SL_done:
    s_cmp_lt_i32 s46, 0
    s_cbranch_scc1 SL_rows
    s_mul_i32 s66, s20, 5632
    v_lshlrev_b32 v229, 2, v240
    v_add_u32 v229, 86016, v229
    v_add_u32 v230, s66, v229
    ds_write_b32 v230, v160 offset:0
    ds_write_b32 v230, v161 offset:256
    ds_write_b32 v230, v162 offset:512
    ds_write_b32 v230, v163 offset:768
    ds_write_b32 v230, v164 offset:1024
    ds_write_b32 v230, v165 offset:1280
    ds_write_b32 v230, v166 offset:1536
    ds_write_b32 v230, v167 offset:1792
    ds_write_b32 v230, v168 offset:2048
    ds_write_b32 v230, v169 offset:2304
    ds_write_b32 v230, v170 offset:2560
    ds_write_b32 v230, v171 offset:2816
    ds_write_b32 v230, v172 offset:3072
    ds_write_b32 v230, v173 offset:3328
    ds_write_b32 v230, v174 offset:3584
    ds_write_b32 v230, v175 offset:3840
    ds_write_b32 v230, v176 offset:4096
    ds_write_b32 v230, v177 offset:4352
    ds_write_b32 v230, v178 offset:4608
    ds_write_b32 v230, v179 offset:4864
    ds_write_b32 v230, v180 offset:5120
    ds_write_b32 v230, v181 offset:5376
    s_waitcnt lgkmcnt(0)
    s_barrier
    ds_read_b32 v160, v229 offset:0
    ds_read_b32 v161, v229 offset:256
    ds_read_b32 v162, v229 offset:512
    ds_read_b32 v163, v229 offset:768
    ds_read_b32 v164, v229 offset:1024
    ds_read_b32 v165, v229 offset:1280
    ds_read_b32 v166, v229 offset:1536
    ds_read_b32 v167, v229 offset:1792
    ds_read_b32 v168, v229 offset:2048
    ds_read_b32 v169, v229 offset:2304
    ds_read_b32 v170, v229 offset:2560
    ds_read_b32 v171, v229 offset:2816
    ds_read_b32 v172, v229 offset:3072
    ds_read_b32 v173, v229 offset:3328
    ds_read_b32 v174, v229 offset:3584
    ds_read_b32 v175, v229 offset:3840
    ds_read_b32 v176, v229 offset:4096
    ds_read_b32 v177, v229 offset:4352
    ds_read_b32 v178, v229 offset:4608
    ds_read_b32 v179, v229 offset:4864
    ds_read_b32 v180, v229 offset:5120
    ds_read_b32 v181, v229 offset:5376
    s_waitcnt lgkmcnt(0)
    ds_read_b32 v184, v229 offset:5632
    ds_read_b32 v185, v229 offset:5888
    ds_read_b32 v186, v229 offset:6144
    ds_read_b32 v187, v229 offset:6400
    ds_read_b32 v188, v229 offset:6656
    ds_read_b32 v189, v229 offset:6912
    ds_read_b32 v190, v229 offset:7168
    ds_read_b32 v191, v229 offset:7424
    ds_read_b32 v192, v229 offset:7680
    ds_read_b32 v193, v229 offset:7936
    ds_read_b32 v194, v229 offset:8192
    ds_read_b32 v195, v229 offset:8448
    ds_read_b32 v196, v229 offset:8704
    ds_read_b32 v197, v229 offset:8960
    ds_read_b32 v198, v229 offset:9216
    ds_read_b32 v199, v229 offset:9472
    ds_read_b32 v200, v229 offset:9728
    ds_read_b32 v201, v229 offset:9984
    ds_read_b32 v202, v229 offset:10240
    ds_read_b32 v203, v229 offset:10496
    ds_read_b32 v204, v229 offset:10752
    ds_read_b32 v205, v229 offset:11008
    s_waitcnt lgkmcnt(0)
    v_add_f32 v160, v160, v184
    v_add_f32 v161, v161, v185
    v_add_f32 v162, v162, v186
    v_add_f32 v163, v163, v187
    v_add_f32 v164, v164, v188
    v_add_f32 v165, v165, v189
    v_add_f32 v166, v166, v190
    v_add_f32 v167, v167, v191
    v_add_f32 v168, v168, v192
    v_add_f32 v169, v169, v193
    v_add_f32 v170, v170, v194
    v_add_f32 v171, v171, v195
    v_add_f32 v172, v172, v196
    v_add_f32 v173, v173, v197
    v_add_f32 v174, v174, v198
    v_add_f32 v175, v175, v199
    v_add_f32 v176, v176, v200
    v_add_f32 v177, v177, v201
    v_add_f32 v178, v178, v202
    v_add_f32 v179, v179, v203
    v_add_f32 v180, v180, v204
    v_add_f32 v181, v181, v205
    ds_read_b32 v184, v229 offset:11264
    ds_read_b32 v185, v229 offset:11520
    ds_read_b32 v186, v229 offset:11776
    ds_read_b32 v187, v229 offset:12032
    ds_read_b32 v188, v229 offset:12288
    ds_read_b32 v189, v229 offset:12544
    ds_read_b32 v190, v229 offset:12800
    ds_read_b32 v191, v229 offset:13056
    ds_read_b32 v192, v229 offset:13312
    ds_read_b32 v193, v229 offset:13568
    ds_read_b32 v194, v229 offset:13824
    ds_read_b32 v195, v229 offset:14080
    ds_read_b32 v196, v229 offset:14336
    ds_read_b32 v197, v229 offset:14592
    ds_read_b32 v198, v229 offset:14848
    ds_read_b32 v199, v229 offset:15104
    ds_read_b32 v200, v229 offset:15360
    ds_read_b32 v201, v229 offset:15616
    ds_read_b32 v202, v229 offset:15872
    ds_read_b32 v203, v229 offset:16128
    ds_read_b32 v204, v229 offset:16384
    ds_read_b32 v205, v229 offset:16640
    s_waitcnt lgkmcnt(0)
    v_add_f32 v160, v160, v184
    v_add_f32 v161, v161, v185
    v_add_f32 v162, v162, v186
    v_add_f32 v163, v163, v187
    v_add_f32 v164, v164, v188
    v_add_f32 v165, v165, v189
    v_add_f32 v166, v166, v190
    v_add_f32 v167, v167, v191
    v_add_f32 v168, v168, v192
    v_add_f32 v169, v169, v193
    v_add_f32 v170, v170, v194
    v_add_f32 v171, v171, v195
    v_add_f32 v172, v172, v196
    v_add_f32 v173, v173, v197
    v_add_f32 v174, v174, v198
    v_add_f32 v175, v175, v199
    v_add_f32 v176, v176, v200
    v_add_f32 v177, v177, v201
    v_add_f32 v178, v178, v202
    v_add_f32 v179, v179, v203
    v_add_f32 v180, v180, v204
    v_add_f32 v181, v181, v205
    ds_read_b32 v184, v229 offset:16896
    ds_read_b32 v185, v229 offset:17152
    ds_read_b32 v186, v229 offset:17408
    ds_read_b32 v187, v229 offset:17664
    ds_read_b32 v188, v229 offset:17920
    ds_read_b32 v189, v229 offset:18176
    ds_read_b32 v190, v229 offset:18432
    ds_read_b32 v191, v229 offset:18688
    ds_read_b32 v192, v229 offset:18944
    ds_read_b32 v193, v229 offset:19200
    ds_read_b32 v194, v229 offset:19456
    ds_read_b32 v195, v229 offset:19712
    ds_read_b32 v196, v229 offset:19968
    ds_read_b32 v197, v229 offset:20224
    ds_read_b32 v198, v229 offset:20480
    ds_read_b32 v199, v229 offset:20736
    ds_read_b32 v200, v229 offset:20992
    ds_read_b32 v201, v229 offset:21248
    ds_read_b32 v202, v229 offset:21504
    ds_read_b32 v203, v229 offset:21760
    ds_read_b32 v204, v229 offset:22016
    ds_read_b32 v205, v229 offset:22272
    s_waitcnt lgkmcnt(0)
    v_add_f32 v160, v160, v184
    v_add_f32 v161, v161, v185
    v_add_f32 v162, v162, v186
    v_add_f32 v163, v163, v187
    v_add_f32 v164, v164, v188
    v_add_f32 v165, v165, v189
    v_add_f32 v166, v166, v190
    v_add_f32 v167, v167, v191
    v_add_f32 v168, v168, v192
    v_add_f32 v169, v169, v193
    v_add_f32 v170, v170, v194
    v_add_f32 v171, v171, v195
    v_add_f32 v172, v172, v196
    v_add_f32 v173, v173, v197
    v_add_f32 v174, v174, v198
    v_add_f32 v175, v175, v199
    v_add_f32 v176, v176, v200
    v_add_f32 v177, v177, v201
    v_add_f32 v178, v178, v202
    v_add_f32 v179, v179, v203
    v_add_f32 v180, v180, v204
    v_add_f32 v181, v181, v205
    ds_read_b32 v184, v229 offset:22528
    ds_read_b32 v185, v229 offset:22784
    ds_read_b32 v186, v229 offset:23040
    ds_read_b32 v187, v229 offset:23296
    ds_read_b32 v188, v229 offset:23552
    ds_read_b32 v189, v229 offset:23808
    ds_read_b32 v190, v229 offset:24064
    ds_read_b32 v191, v229 offset:24320
    ds_read_b32 v192, v229 offset:24576
    ds_read_b32 v193, v229 offset:24832
    ds_read_b32 v194, v229 offset:25088
    ds_read_b32 v195, v229 offset:25344
    ds_read_b32 v196, v229 offset:25600
    ds_read_b32 v197, v229 offset:25856
    ds_read_b32 v198, v229 offset:26112
    ds_read_b32 v199, v229 offset:26368
    ds_read_b32 v200, v229 offset:26624
    ds_read_b32 v201, v229 offset:26880
    ds_read_b32 v202, v229 offset:27136
    ds_read_b32 v203, v229 offset:27392
    ds_read_b32 v204, v229 offset:27648
    ds_read_b32 v205, v229 offset:27904
    s_waitcnt lgkmcnt(0)
    v_add_f32 v160, v160, v184
    v_add_f32 v161, v161, v185
    v_add_f32 v162, v162, v186
    v_add_f32 v163, v163, v187
    v_add_f32 v164, v164, v188
    v_add_f32 v165, v165, v189
    v_add_f32 v166, v166, v190
    v_add_f32 v167, v167, v191
    v_add_f32 v168, v168, v192
    v_add_f32 v169, v169, v193
    v_add_f32 v170, v170, v194
    v_add_f32 v171, v171, v195
    v_add_f32 v172, v172, v196
    v_add_f32 v173, v173, v197
    v_add_f32 v174, v174, v198
    v_add_f32 v175, v175, v199
    v_add_f32 v176, v176, v200
    v_add_f32 v177, v177, v201
    v_add_f32 v178, v178, v202
    v_add_f32 v179, v179, v203
    v_add_f32 v180, v180, v204
    v_add_f32 v181, v181, v205
    ds_read_b32 v184, v229 offset:28160
    ds_read_b32 v185, v229 offset:28416
    ds_read_b32 v186, v229 offset:28672
    ds_read_b32 v187, v229 offset:28928
    ds_read_b32 v188, v229 offset:29184
    ds_read_b32 v189, v229 offset:29440
    ds_read_b32 v190, v229 offset:29696
    ds_read_b32 v191, v229 offset:29952
    ds_read_b32 v192, v229 offset:30208
    ds_read_b32 v193, v229 offset:30464
    ds_read_b32 v194, v229 offset:30720
    ds_read_b32 v195, v229 offset:30976
    ds_read_b32 v196, v229 offset:31232
    ds_read_b32 v197, v229 offset:31488
    ds_read_b32 v198, v229 offset:31744
    ds_read_b32 v199, v229 offset:32000
    ds_read_b32 v200, v229 offset:32256
    ds_read_b32 v201, v229 offset:32512
    ds_read_b32 v202, v229 offset:32768
    ds_read_b32 v203, v229 offset:33024
    ds_read_b32 v204, v229 offset:33280
    ds_read_b32 v205, v229 offset:33536
    s_waitcnt lgkmcnt(0)
    v_add_f32 v160, v160, v184
    v_add_f32 v161, v161, v185
    v_add_f32 v162, v162, v186
    v_add_f32 v163, v163, v187
    v_add_f32 v164, v164, v188
    v_add_f32 v165, v165, v189
    v_add_f32 v166, v166, v190
    v_add_f32 v167, v167, v191
    v_add_f32 v168, v168, v192
    v_add_f32 v169, v169, v193
    v_add_f32 v170, v170, v194
    v_add_f32 v171, v171, v195
    v_add_f32 v172, v172, v196
    v_add_f32 v173, v173, v197
    v_add_f32 v174, v174, v198
    v_add_f32 v175, v175, v199
    v_add_f32 v176, v176, v200
    v_add_f32 v177, v177, v201
    v_add_f32 v178, v178, v202
    v_add_f32 v179, v179, v203
    v_add_f32 v180, v180, v204
    v_add_f32 v181, v181, v205
    ds_read_b32 v184, v229 offset:33792
    ds_read_b32 v185, v229 offset:34048
    ds_read_b32 v186, v229 offset:34304
    ds_read_b32 v187, v229 offset:34560
    ds_read_b32 v188, v229 offset:34816
    ds_read_b32 v189, v229 offset:35072
    ds_read_b32 v190, v229 offset:35328
    ds_read_b32 v191, v229 offset:35584
    ds_read_b32 v192, v229 offset:35840
    ds_read_b32 v193, v229 offset:36096
    ds_read_b32 v194, v229 offset:36352
    ds_read_b32 v195, v229 offset:36608
    ds_read_b32 v196, v229 offset:36864
    ds_read_b32 v197, v229 offset:37120
    ds_read_b32 v198, v229 offset:37376
    ds_read_b32 v199, v229 offset:37632
    ds_read_b32 v200, v229 offset:37888
    ds_read_b32 v201, v229 offset:38144
    ds_read_b32 v202, v229 offset:38400
    ds_read_b32 v203, v229 offset:38656
    ds_read_b32 v204, v229 offset:38912
    ds_read_b32 v205, v229 offset:39168
    s_waitcnt lgkmcnt(0)
    v_add_f32 v160, v160, v184
    v_add_f32 v161, v161, v185
    v_add_f32 v162, v162, v186
    v_add_f32 v163, v163, v187
    v_add_f32 v164, v164, v188
    v_add_f32 v165, v165, v189
    v_add_f32 v166, v166, v190
    v_add_f32 v167, v167, v191
    v_add_f32 v168, v168, v192
    v_add_f32 v169, v169, v193
    v_add_f32 v170, v170, v194
    v_add_f32 v171, v171, v195
    v_add_f32 v172, v172, v196
    v_add_f32 v173, v173, v197
    v_add_f32 v174, v174, v198
    v_add_f32 v175, v175, v199
    v_add_f32 v176, v176, v200
    v_add_f32 v177, v177, v201
    v_add_f32 v178, v178, v202
    v_add_f32 v179, v179, v203
    v_add_f32 v180, v180, v204
    v_add_f32 v181, v181, v205
    ds_read_b32 v184, v229 offset:39424
    ds_read_b32 v185, v229 offset:39680
    ds_read_b32 v186, v229 offset:39936
    ds_read_b32 v187, v229 offset:40192
    ds_read_b32 v188, v229 offset:40448
    ds_read_b32 v189, v229 offset:40704
    ds_read_b32 v190, v229 offset:40960
    ds_read_b32 v191, v229 offset:41216
    ds_read_b32 v192, v229 offset:41472
    ds_read_b32 v193, v229 offset:41728
    ds_read_b32 v194, v229 offset:41984
    ds_read_b32 v195, v229 offset:42240
    ds_read_b32 v196, v229 offset:42496
    ds_read_b32 v197, v229 offset:42752
    ds_read_b32 v198, v229 offset:43008
    ds_read_b32 v199, v229 offset:43264
    ds_read_b32 v200, v229 offset:43520
    ds_read_b32 v201, v229 offset:43776
    ds_read_b32 v202, v229 offset:44032
    ds_read_b32 v203, v229 offset:44288
    ds_read_b32 v204, v229 offset:44544
    ds_read_b32 v205, v229 offset:44800
    s_waitcnt lgkmcnt(0)
    v_add_f32 v160, v160, v184
    v_add_f32 v161, v161, v185
    v_add_f32 v162, v162, v186
    v_add_f32 v163, v163, v187
    v_add_f32 v164, v164, v188
    v_add_f32 v165, v165, v189
    v_add_f32 v166, v166, v190
    v_add_f32 v167, v167, v191
    v_add_f32 v168, v168, v192
    v_add_f32 v169, v169, v193
    v_add_f32 v170, v170, v194
    v_add_f32 v171, v171, v195
    v_add_f32 v172, v172, v196
    v_add_f32 v173, v173, v197
    v_add_f32 v174, v174, v198
    v_add_f32 v175, v175, v199
    v_add_f32 v176, v176, v200
    v_add_f32 v177, v177, v201
    v_add_f32 v178, v178, v202
    v_add_f32 v179, v179, v203
    v_add_f32 v180, v180, v204
    v_add_f32 v181, v181, v205
    s_barrier
SL_rows:
    s_lshl_b32 s66, s50, 3
    s_add_u32 s66, s66, s20
    s_lshl_b32 s67, s66, 4
    s_and_b32 s68, s67, 128
    s_and_b32 s67, s67, 0x70
    s_mul_i32 s69, s50, 1536
    s_add_u32 s69, s69, s21
    s_add_u32 s69, s69, s68
    s_mul_i32 s70, s66, 1536
    s_add_u32 s70, s70, 86016
    s_add_u32 s70, s70, s68
    v_mov_b32 v230, s69
    v_mov_b32 v231, s70
    v_cmp_gt_u32 vcc, 32, v240
    v_and_b32 v229, 31, v240
    v_lshlrev_b32 v229, 2, v229
    v_xor_b32 v229, s67, v229
    v_cndmask_b32 v244, v231, v230, vcc
    v_add_u32 v244, v244, v229
    v_cvt_pk_bf16_f32 v192, v160, v161
    ds_write_b32 v244, v192 offset:0
    v_cvt_pk_bf16_f32 v193, v162, v163
    ds_write_b32 v244, v193 offset:128
    v_cvt_pk_bf16_f32 v194, v164, v165
    ds_write_b32 v244, v194 offset:256
    v_cvt_pk_bf16_f32 v195, v166, v167
    ds_write_b32 v244, v195 offset:384
    v_cvt_pk_bf16_f32 v196, v168, v169
    ds_write_b32 v244, v196 offset:512
    v_cvt_pk_bf16_f32 v197, v170, v171
    ds_write_b32 v244, v197 offset:640
    v_cvt_pk_bf16_f32 v198, v172, v173
    ds_write_b32 v244, v198 offset:768
    v_cvt_pk_bf16_f32 v199, v174, v175
    ds_write_b32 v244, v199 offset:896
    v_cvt_pk_bf16_f32 v200, v176, v177
    ds_write_b32 v244, v200 offset:1024
    v_cvt_pk_bf16_f32 v201, v178, v179
    ds_write_b32 v244, v201 offset:1152
    v_cvt_pk_bf16_f32 v202, v180, v181
    ds_write_b32 v244, v202 offset:1280
    s_lshl_b32 s66, s66, 3
    s_add_u32 s66, s66, 163328
    v_mov_b32 v229, s66
    ds_write_b64 v229, v[230:231]
    s_add_u32 s50, s50, 1
    s_cmp_lt_u32 s50, 5
    s_cbranch_scc1 SL_node
    s_waitcnt lgkmcnt(0)
    s_barrier
    v_mov_b32 v176, v240
    s_load_dwordx4 s[84:87], s[0:1], 48
    s_mul_i32 s22, s20, 20
    s_waitcnt lgkmcnt(0)
    v_mov_b32 v4, 0
    v_mov_b32 v5, 0
    v_mov_b32 v6, 0
    v_mov_b32 v7, 0
    v_mov_b32 v8, 0
    v_mov_b32 v9, 0
    v_mov_b32 v10, 0
    v_mov_b32 v11, 0
    v_mov_b32 v12, 0
    v_mov_b32 v13, 0
    v_mov_b32 v14, 0
    v_mov_b32 v15, 0
    v_mov_b32 v16, 0
    v_mov_b32 v17, 0
    v_mov_b32 v18, 0
    v_mov_b32 v19, 0
    v_mov_b32 v20, 0
    v_mov_b32 v21, 0
    v_mov_b32 v22, 0
    v_mov_b32 v23, 0
    s_mul_i32 s24, s22, 3277
    s_lshr_b32 s24, s24, 16
    s_mul_i32 s68, s24, 20
    s_sub_u32 s68, s22, s68
    s_cmp_lt_u32 s68, 8
    s_cselect_b64 s[66:67], s[84:85], s[86:87]
    s_cselect_b32 s25, 0, 8
    s_sub_u32 s68, s68, s25
    s_and_b32 s25, s68, 1
    s_lshr_b32 s68, s68, 1
    s_lshl_b32 s68, s68, 14
    s_lshl_b32 s25, s25, 12
    s_add_u32 s68, s68, s25
    s_lshl_b32 s24, s24, 5
    s_add_u32 s68, s68, s24
    v_lshrrev_b32 v2, 4, v176
    v_lshlrev_b32 v2, 10, v2
    v_and_b32 v3, 15, v176
    v_lshl_add_u32 v2, v3, 1, v2
    v_add_u32 v2, s68, v2
    v_add_u32 v3, 8192, v2
    global_load_ushort v144, v2, s[66:67] offset:0
    global_load_short_d16_hi v4, v3, s[66:67] offset:0
    global_load_ushort v145, v2, s[66:67] offset:256
    global_load_short_d16_hi v5, v3, s[66:67] offset:256
    global_load_ushort v146, v2, s[66:67] offset:512
    global_load_short_d16_hi v6, v3, s[66:67] offset:512
    global_load_ushort v147, v2, s[66:67] offset:768
    global_load_short_d16_hi v7, v3, s[66:67] offset:768
    s_add_u32 s22, s22, 1
    s_mul_i32 s24, s22, 3277
    s_lshr_b32 s24, s24, 16
    s_mul_i32 s68, s24, 20
    s_sub_u32 s68, s22, s68
    s_cmp_lt_u32 s68, 8
    s_cselect_b64 s[66:67], s[84:85], s[86:87]
    s_cselect_b32 s25, 0, 8
    s_sub_u32 s68, s68, s25
    s_and_b32 s25, s68, 1
    s_lshr_b32 s68, s68, 1
    s_lshl_b32 s68, s68, 14
    s_lshl_b32 s25, s25, 12
    s_add_u32 s68, s68, s25
    s_lshl_b32 s24, s24, 5
    s_add_u32 s68, s68, s24
    v_lshrrev_b32 v2, 4, v176
    v_lshlrev_b32 v2, 10, v2
    v_and_b32 v3, 15, v176
    v_lshl_add_u32 v2, v3, 1, v2
    v_add_u32 v2, s68, v2
    v_add_u32 v3, 8192, v2
    global_load_ushort v148, v2, s[66:67] offset:0
    global_load_short_d16_hi v8, v3, s[66:67] offset:0
    global_load_ushort v149, v2, s[66:67] offset:256
    global_load_short_d16_hi v9, v3, s[66:67] offset:256
    global_load_ushort v150, v2, s[66:67] offset:512
    global_load_short_d16_hi v10, v3, s[66:67] offset:512
    global_load_ushort v151, v2, s[66:67] offset:768
    global_load_short_d16_hi v11, v3, s[66:67] offset:768
    s_add_u32 s22, s22, 1
    s_mul_i32 s24, s22, 3277
    s_lshr_b32 s24, s24, 16
    s_mul_i32 s68, s24, 20
    s_sub_u32 s68, s22, s68
    s_cmp_lt_u32 s68, 8
    s_cselect_b64 s[66:67], s[84:85], s[86:87]
    s_cselect_b32 s25, 0, 8
    s_sub_u32 s68, s68, s25
    s_and_b32 s25, s68, 1
    s_lshr_b32 s68, s68, 1
    s_lshl_b32 s68, s68, 14
    s_lshl_b32 s25, s25, 12
    s_add_u32 s68, s68, s25
    s_lshl_b32 s24, s24, 5
    s_add_u32 s68, s68, s24
    v_lshrrev_b32 v2, 4, v176
    v_lshlrev_b32 v2, 10, v2
    v_and_b32 v3, 15, v176
    v_lshl_add_u32 v2, v3, 1, v2
    v_add_u32 v2, s68, v2
    v_add_u32 v3, 8192, v2
    global_load_ushort v96, v2, s[66:67] offset:0
    global_load_short_d16_hi v12, v3, s[66:67] offset:0
    global_load_ushort v97, v2, s[66:67] offset:256
    global_load_short_d16_hi v13, v3, s[66:67] offset:256
    global_load_ushort v98, v2, s[66:67] offset:512
    global_load_short_d16_hi v14, v3, s[66:67] offset:512
    global_load_ushort v99, v2, s[66:67] offset:768
    global_load_short_d16_hi v15, v3, s[66:67] offset:768
    s_add_u32 s22, s22, 1
    s_mul_i32 s24, s22, 3277
    s_lshr_b32 s24, s24, 16
    s_mul_i32 s68, s24, 20
    s_sub_u32 s68, s22, s68
    s_cmp_lt_u32 s68, 8
    s_cselect_b64 s[66:67], s[84:85], s[86:87]
    s_cselect_b32 s25, 0, 8
    s_sub_u32 s68, s68, s25
    s_and_b32 s25, s68, 1
    s_lshr_b32 s68, s68, 1
    s_lshl_b32 s68, s68, 14
    s_lshl_b32 s25, s25, 12
    s_add_u32 s68, s68, s25
    s_lshl_b32 s24, s24, 5
    s_add_u32 s68, s68, s24
    v_lshrrev_b32 v2, 4, v176
    v_lshlrev_b32 v2, 10, v2
    v_and_b32 v3, 15, v176
    v_lshl_add_u32 v2, v3, 1, v2
    v_add_u32 v2, s68, v2
    v_add_u32 v3, 8192, v2
    global_load_ushort v100, v2, s[66:67] offset:0
    global_load_short_d16_hi v16, v3, s[66:67] offset:0
    global_load_ushort v101, v2, s[66:67] offset:256
    global_load_short_d16_hi v17, v3, s[66:67] offset:256
    global_load_ushort v102, v2, s[66:67] offset:512
    global_load_short_d16_hi v18, v3, s[66:67] offset:512
    global_load_ushort v103, v2, s[66:67] offset:768
    global_load_short_d16_hi v19, v3, s[66:67] offset:768
    s_add_u32 s22, s22, 1
    s_mul_i32 s24, s22, 3277
    s_lshr_b32 s24, s24, 16
    s_mul_i32 s68, s24, 20
    s_sub_u32 s68, s22, s68
    s_cmp_lt_u32 s68, 8
    s_cselect_b64 s[66:67], s[84:85], s[86:87]
    s_cselect_b32 s25, 0, 8
    s_sub_u32 s68, s68, s25
    s_and_b32 s25, s68, 1
    s_lshr_b32 s68, s68, 1
    s_lshl_b32 s68, s68, 14
    s_lshl_b32 s25, s25, 12
    s_add_u32 s68, s68, s25
    s_lshl_b32 s24, s24, 5
    s_add_u32 s68, s68, s24
    v_lshrrev_b32 v2, 4, v176
    v_lshlrev_b32 v2, 10, v2
    v_and_b32 v3, 15, v176
    v_lshl_add_u32 v2, v3, 1, v2
    v_add_u32 v2, s68, v2
    v_add_u32 v3, 8192, v2
    global_load_ushort v160, v2, s[66:67] offset:0
    global_load_short_d16_hi v20, v3, s[66:67] offset:0
    global_load_ushort v161, v2, s[66:67] offset:256
    global_load_short_d16_hi v21, v3, s[66:67] offset:256
    global_load_ushort v162, v2, s[66:67] offset:512
    global_load_short_d16_hi v22, v3, s[66:67] offset:512
    global_load_ushort v163, v2, s[66:67] offset:768
    global_load_short_d16_hi v23, v3, s[66:67] offset:768
    s_add_u32 s22, s22, 1
    s_waitcnt vmcnt(0)
    v_or_b32 v144, v144, v4
    v_or_b32 v145, v145, v5
    v_or_b32 v146, v146, v6
    v_or_b32 v147, v147, v7
    v_or_b32 v148, v148, v8
    v_or_b32 v149, v149, v9
    v_or_b32 v150, v150, v10
    v_or_b32 v151, v151, v11
    v_or_b32 v96, v96, v12
    v_or_b32 v97, v97, v13
    v_or_b32 v98, v98, v14
    v_or_b32 v99, v99, v15
    v_or_b32 v100, v100, v16
    v_or_b32 v101, v101, v17
    v_or_b32 v102, v102, v18
    v_or_b32 v103, v103, v19
    v_or_b32 v160, v160, v20
    v_or_b32 v161, v161, v21
    v_or_b32 v162, v162, v22
    v_or_b32 v163, v163, v23
    v_mov_b32 v4, 0
    v_mov_b32 v5, 0
    v_mov_b32 v6, 0
    v_mov_b32 v7, 0
    v_mov_b32 v8, 0
    v_mov_b32 v9, 0
    v_mov_b32 v10, 0
    v_mov_b32 v11, 0
    v_mov_b32 v12, 0
    v_mov_b32 v13, 0
    v_mov_b32 v14, 0
    v_mov_b32 v15, 0
    v_mov_b32 v16, 0
    v_mov_b32 v17, 0
    v_mov_b32 v18, 0
    v_mov_b32 v19, 0
    v_mov_b32 v20, 0
    v_mov_b32 v21, 0
    v_mov_b32 v22, 0
    v_mov_b32 v23, 0
    s_mul_i32 s24, s22, 3277
    s_lshr_b32 s24, s24, 16
    s_mul_i32 s68, s24, 20
    s_sub_u32 s68, s22, s68
    s_cmp_lt_u32 s68, 8
    s_cselect_b64 s[66:67], s[84:85], s[86:87]
    s_cselect_b32 s25, 0, 8
    s_sub_u32 s68, s68, s25
    s_and_b32 s25, s68, 1
    s_lshr_b32 s68, s68, 1
    s_lshl_b32 s68, s68, 14
    s_lshl_b32 s25, s25, 12
    s_add_u32 s68, s68, s25
    s_lshl_b32 s24, s24, 5
    s_add_u32 s68, s68, s24
    v_lshrrev_b32 v2, 4, v176
    v_lshlrev_b32 v2, 10, v2
    v_and_b32 v3, 15, v176
    v_lshl_add_u32 v2, v3, 1, v2
    v_add_u32 v2, s68, v2
    v_add_u32 v3, 8192, v2
    global_load_ushort v164, v2, s[66:67] offset:0
    global_load_short_d16_hi v4, v3, s[66:67] offset:0
    global_load_ushort v165, v2, s[66:67] offset:256
    global_load_short_d16_hi v5, v3, s[66:67] offset:256
    global_load_ushort v166, v2, s[66:67] offset:512
    global_load_short_d16_hi v6, v3, s[66:67] offset:512
    global_load_ushort v167, v2, s[66:67] offset:768
    global_load_short_d16_hi v7, v3, s[66:67] offset:768
    s_add_u32 s22, s22, 1
    s_mul_i32 s24, s22, 3277
    s_lshr_b32 s24, s24, 16
    s_mul_i32 s68, s24, 20
    s_sub_u32 s68, s22, s68
    s_cmp_lt_u32 s68, 8
    s_cselect_b64 s[66:67], s[84:85], s[86:87]
    s_cselect_b32 s25, 0, 8
    s_sub_u32 s68, s68, s25
    s_and_b32 s25, s68, 1
    s_lshr_b32 s68, s68, 1
    s_lshl_b32 s68, s68, 14
    s_lshl_b32 s25, s25, 12
    s_add_u32 s68, s68, s25
    s_lshl_b32 s24, s24, 5
    s_add_u32 s68, s68, s24
    v_lshrrev_b32 v2, 4, v176
    v_lshlrev_b32 v2, 10, v2
    v_and_b32 v3, 15, v176
    v_lshl_add_u32 v2, v3, 1, v2
    v_add_u32 v2, s68, v2
    v_add_u32 v3, 8192, v2
    global_load_ushort v104, v2, s[66:67] offset:0
    global_load_short_d16_hi v8, v3, s[66:67] offset:0
    global_load_ushort v105, v2, s[66:67] offset:256
    global_load_short_d16_hi v9, v3, s[66:67] offset:256
    global_load_ushort v106, v2, s[66:67] offset:512
    global_load_short_d16_hi v10, v3, s[66:67] offset:512
    global_load_ushort v107, v2, s[66:67] offset:768
    global_load_short_d16_hi v11, v3, s[66:67] offset:768
    s_add_u32 s22, s22, 1
    s_mul_i32 s24, s22, 3277
    s_lshr_b32 s24, s24, 16
    s_mul_i32 s68, s24, 20
    s_sub_u32 s68, s22, s68
    s_cmp_lt_u32 s68, 8
    s_cselect_b64 s[66:67], s[84:85], s[86:87]
    s_cselect_b32 s25, 0, 8
    s_sub_u32 s68, s68, s25
    s_and_b32 s25, s68, 1
    s_lshr_b32 s68, s68, 1
    s_lshl_b32 s68, s68, 14
    s_lshl_b32 s25, s25, 12
    s_add_u32 s68, s68, s25
    s_lshl_b32 s24, s24, 5
    s_add_u32 s68, s68, s24
    v_lshrrev_b32 v2, 4, v176
    v_lshlrev_b32 v2, 10, v2
    v_and_b32 v3, 15, v176
    v_lshl_add_u32 v2, v3, 1, v2
    v_add_u32 v2, s68, v2
    v_add_u32 v3, 8192, v2
    global_load_ushort v108, v2, s[66:67] offset:0
    global_load_short_d16_hi v12, v3, s[66:67] offset:0
    global_load_ushort v109, v2, s[66:67] offset:256
    global_load_short_d16_hi v13, v3, s[66:67] offset:256
    global_load_ushort v110, v2, s[66:67] offset:512
    global_load_short_d16_hi v14, v3, s[66:67] offset:512
    global_load_ushort v111, v2, s[66:67] offset:768
    global_load_short_d16_hi v15, v3, s[66:67] offset:768
    s_add_u32 s22, s22, 1
    s_mul_i32 s24, s22, 3277
    s_lshr_b32 s24, s24, 16
    s_mul_i32 s68, s24, 20
    s_sub_u32 s68, s22, s68
    s_cmp_lt_u32 s68, 8
    s_cselect_b64 s[66:67], s[84:85], s[86:87]
    s_cselect_b32 s25, 0, 8
    s_sub_u32 s68, s68, s25
    s_and_b32 s25, s68, 1
    s_lshr_b32 s68, s68, 1
    s_lshl_b32 s68, s68, 14
    s_lshl_b32 s25, s25, 12
    s_add_u32 s68, s68, s25
    s_lshl_b32 s24, s24, 5
    s_add_u32 s68, s68, s24
    v_lshrrev_b32 v2, 4, v176
    v_lshlrev_b32 v2, 10, v2
    v_and_b32 v3, 15, v176
    v_lshl_add_u32 v2, v3, 1, v2
    v_add_u32 v2, s68, v2
    v_add_u32 v3, 8192, v2
    global_load_ushort v120, v2, s[66:67] offset:0
    global_load_short_d16_hi v16, v3, s[66:67] offset:0
    global_load_ushort v121, v2, s[66:67] offset:256
    global_load_short_d16_hi v17, v3, s[66:67] offset:256
    global_load_ushort v122, v2, s[66:67] offset:512
    global_load_short_d16_hi v18, v3, s[66:67] offset:512
    global_load_ushort v123, v2, s[66:67] offset:768
    global_load_short_d16_hi v19, v3, s[66:67] offset:768
    s_add_u32 s22, s22, 1
    s_mul_i32 s24, s22, 3277
    s_lshr_b32 s24, s24, 16
    s_mul_i32 s68, s24, 20
    s_sub_u32 s68, s22, s68
    s_cmp_lt_u32 s68, 8
    s_cselect_b64 s[66:67], s[84:85], s[86:87]
    s_cselect_b32 s25, 0, 8
    s_sub_u32 s68, s68, s25
    s_and_b32 s25, s68, 1
    s_lshr_b32 s68, s68, 1
    s_lshl_b32 s68, s68, 14
    s_lshl_b32 s25, s25, 12
    s_add_u32 s68, s68, s25
    s_lshl_b32 s24, s24, 5
    s_add_u32 s68, s68, s24
    v_lshrrev_b32 v2, 4, v176
    v_lshlrev_b32 v2, 10, v2
    v_and_b32 v3, 15, v176
    v_lshl_add_u32 v2, v3, 1, v2
    v_add_u32 v2, s68, v2
    v_add_u32 v3, 8192, v2
    global_load_ushort v124, v2, s[66:67] offset:0
    global_load_short_d16_hi v20, v3, s[66:67] offset:0
    global_load_ushort v125, v2, s[66:67] offset:256
    global_load_short_d16_hi v21, v3, s[66:67] offset:256
    global_load_ushort v126, v2, s[66:67] offset:512
    global_load_short_d16_hi v22, v3, s[66:67] offset:512
    global_load_ushort v127, v2, s[66:67] offset:768
    global_load_short_d16_hi v23, v3, s[66:67] offset:768
    s_add_u32 s22, s22, 1
    s_waitcnt vmcnt(0)
    v_or_b32 v164, v164, v4
    v_or_b32 v165, v165, v5
    v_or_b32 v166, v166, v6
    v_or_b32 v167, v167, v7
    v_or_b32 v104, v104, v8
    v_or_b32 v105, v105, v9
    v_or_b32 v106, v106, v10
    v_or_b32 v107, v107, v11
    v_or_b32 v108, v108, v12
    v_or_b32 v109, v109, v13
    v_or_b32 v110, v110, v14
    v_or_b32 v111, v111, v15
    v_or_b32 v120, v120, v16
    v_or_b32 v121, v121, v17
    v_or_b32 v122, v122, v18
    v_or_b32 v123, v123, v19
    v_or_b32 v124, v124, v20
    v_or_b32 v125, v125, v21
    v_or_b32 v126, v126, v22
    v_or_b32 v127, v127, v23
    v_mov_b32 v4, 0
    v_mov_b32 v5, 0
    v_mov_b32 v6, 0
    v_mov_b32 v7, 0
    v_mov_b32 v8, 0
    v_mov_b32 v9, 0
    v_mov_b32 v10, 0
    v_mov_b32 v11, 0
    v_mov_b32 v12, 0
    v_mov_b32 v13, 0
    v_mov_b32 v14, 0
    v_mov_b32 v15, 0
    v_mov_b32 v16, 0
    v_mov_b32 v17, 0
    v_mov_b32 v18, 0
    v_mov_b32 v19, 0
    v_mov_b32 v20, 0
    v_mov_b32 v21, 0
    v_mov_b32 v22, 0
    v_mov_b32 v23, 0
    s_mul_i32 s24, s22, 3277
    s_lshr_b32 s24, s24, 16
    s_mul_i32 s68, s24, 20
    s_sub_u32 s68, s22, s68
    s_cmp_lt_u32 s68, 8
    s_cselect_b64 s[66:67], s[84:85], s[86:87]
    s_cselect_b32 s25, 0, 8
    s_sub_u32 s68, s68, s25
    s_and_b32 s25, s68, 1
    s_lshr_b32 s68, s68, 1
    s_lshl_b32 s68, s68, 14
    s_lshl_b32 s25, s25, 12
    s_add_u32 s68, s68, s25
    s_lshl_b32 s24, s24, 5
    s_add_u32 s68, s68, s24
    v_lshrrev_b32 v2, 4, v176
    v_lshlrev_b32 v2, 10, v2
    v_and_b32 v3, 15, v176
    v_lshl_add_u32 v2, v3, 1, v2
    v_add_u32 v2, s68, v2
    v_add_u32 v3, 8192, v2
    global_load_ushort v128, v2, s[66:67] offset:0
    global_load_short_d16_hi v4, v3, s[66:67] offset:0
    global_load_ushort v129, v2, s[66:67] offset:256
    global_load_short_d16_hi v5, v3, s[66:67] offset:256
    global_load_ushort v130, v2, s[66:67] offset:512
    global_load_short_d16_hi v6, v3, s[66:67] offset:512
    global_load_ushort v131, v2, s[66:67] offset:768
    global_load_short_d16_hi v7, v3, s[66:67] offset:768
    s_add_u32 s22, s22, 1
    s_mul_i32 s24, s22, 3277
    s_lshr_b32 s24, s24, 16
    s_mul_i32 s68, s24, 20
    s_sub_u32 s68, s22, s68
    s_cmp_lt_u32 s68, 8
    s_cselect_b64 s[66:67], s[84:85], s[86:87]
    s_cselect_b32 s25, 0, 8
    s_sub_u32 s68, s68, s25
    s_and_b32 s25, s68, 1
    s_lshr_b32 s68, s68, 1
    s_lshl_b32 s68, s68, 14
    s_lshl_b32 s25, s25, 12
    s_add_u32 s68, s68, s25
    s_lshl_b32 s24, s24, 5
    s_add_u32 s68, s68, s24
    v_lshrrev_b32 v2, 4, v176
    v_lshlrev_b32 v2, 10, v2
    v_and_b32 v3, 15, v176
    v_lshl_add_u32 v2, v3, 1, v2
    v_add_u32 v2, s68, v2
    v_add_u32 v3, 8192, v2
    global_load_ushort v132, v2, s[66:67] offset:0
    global_load_short_d16_hi v8, v3, s[66:67] offset:0
    global_load_ushort v133, v2, s[66:67] offset:256
    global_load_short_d16_hi v9, v3, s[66:67] offset:256
    global_load_ushort v134, v2, s[66:67] offset:512
    global_load_short_d16_hi v10, v3, s[66:67] offset:512
    global_load_ushort v135, v2, s[66:67] offset:768
    global_load_short_d16_hi v11, v3, s[66:67] offset:768
    s_add_u32 s22, s22, 1
    s_mul_i32 s24, s22, 3277
    s_lshr_b32 s24, s24, 16
    s_mul_i32 s68, s24, 20
    s_sub_u32 s68, s22, s68
    s_cmp_lt_u32 s68, 8
    s_cselect_b64 s[66:67], s[84:85], s[86:87]
    s_cselect_b32 s25, 0, 8
    s_sub_u32 s68, s68, s25
    s_and_b32 s25, s68, 1
    s_lshr_b32 s68, s68, 1
    s_lshl_b32 s68, s68, 14
    s_lshl_b32 s25, s25, 12
    s_add_u32 s68, s68, s25
    s_lshl_b32 s24, s24, 5
    s_add_u32 s68, s68, s24
    v_lshrrev_b32 v2, 4, v176
    v_lshlrev_b32 v2, 10, v2
    v_and_b32 v3, 15, v176
    v_lshl_add_u32 v2, v3, 1, v2
    v_add_u32 v2, s68, v2
    v_add_u32 v3, 8192, v2
    global_load_ushort v152, v2, s[66:67] offset:0
    global_load_short_d16_hi v12, v3, s[66:67] offset:0
    global_load_ushort v153, v2, s[66:67] offset:256
    global_load_short_d16_hi v13, v3, s[66:67] offset:256
    global_load_ushort v154, v2, s[66:67] offset:512
    global_load_short_d16_hi v14, v3, s[66:67] offset:512
    global_load_ushort v155, v2, s[66:67] offset:768
    global_load_short_d16_hi v15, v3, s[66:67] offset:768
    s_add_u32 s22, s22, 1
    s_mul_i32 s24, s22, 3277
    s_lshr_b32 s24, s24, 16
    s_mul_i32 s68, s24, 20
    s_sub_u32 s68, s22, s68
    s_cmp_lt_u32 s68, 8
    s_cselect_b64 s[66:67], s[84:85], s[86:87]
    s_cselect_b32 s25, 0, 8
    s_sub_u32 s68, s68, s25
    s_and_b32 s25, s68, 1
    s_lshr_b32 s68, s68, 1
    s_lshl_b32 s68, s68, 14
    s_lshl_b32 s25, s25, 12
    s_add_u32 s68, s68, s25
    s_lshl_b32 s24, s24, 5
    s_add_u32 s68, s68, s24
    v_lshrrev_b32 v2, 4, v176
    v_lshlrev_b32 v2, 10, v2
    v_and_b32 v3, 15, v176
    v_lshl_add_u32 v2, v3, 1, v2
    v_add_u32 v2, s68, v2
    v_add_u32 v3, 8192, v2
    global_load_ushort v156, v2, s[66:67] offset:0
    global_load_short_d16_hi v16, v3, s[66:67] offset:0
    global_load_ushort v157, v2, s[66:67] offset:256
    global_load_short_d16_hi v17, v3, s[66:67] offset:256
    global_load_ushort v158, v2, s[66:67] offset:512
    global_load_short_d16_hi v18, v3, s[66:67] offset:512
    global_load_ushort v159, v2, s[66:67] offset:768
    global_load_short_d16_hi v19, v3, s[66:67] offset:768
    s_add_u32 s22, s22, 1
    s_mul_i32 s24, s22, 3277
    s_lshr_b32 s24, s24, 16
    s_mul_i32 s68, s24, 20
    s_sub_u32 s68, s22, s68
    s_cmp_lt_u32 s68, 8
    s_cselect_b64 s[66:67], s[84:85], s[86:87]
    s_cselect_b32 s25, 0, 8
    s_sub_u32 s68, s68, s25
    s_and_b32 s25, s68, 1
    s_lshr_b32 s68, s68, 1
    s_lshl_b32 s68, s68, 14
    s_lshl_b32 s25, s25, 12
    s_add_u32 s68, s68, s25
    s_lshl_b32 s24, s24, 5
    s_add_u32 s68, s68, s24
    v_lshrrev_b32 v2, 4, v176
    v_lshlrev_b32 v2, 10, v2
    v_and_b32 v3, 15, v176
    v_lshl_add_u32 v2, v3, 1, v2
    v_add_u32 v2, s68, v2
    v_add_u32 v3, 8192, v2
    global_load_ushort v136, v2, s[66:67] offset:0
    global_load_short_d16_hi v20, v3, s[66:67] offset:0
    global_load_ushort v137, v2, s[66:67] offset:256
    global_load_short_d16_hi v21, v3, s[66:67] offset:256
    global_load_ushort v138, v2, s[66:67] offset:512
    global_load_short_d16_hi v22, v3, s[66:67] offset:512
    global_load_ushort v139, v2, s[66:67] offset:768
    global_load_short_d16_hi v23, v3, s[66:67] offset:768
    s_add_u32 s22, s22, 1
    s_waitcnt vmcnt(0)
    v_or_b32 v128, v128, v4
    v_or_b32 v129, v129, v5
    v_or_b32 v130, v130, v6
    v_or_b32 v131, v131, v7
    v_or_b32 v132, v132, v8
    v_or_b32 v133, v133, v9
    v_or_b32 v134, v134, v10
    v_or_b32 v135, v135, v11
    v_or_b32 v152, v152, v12
    v_or_b32 v153, v153, v13
    v_or_b32 v154, v154, v14
    v_or_b32 v155, v155, v15
    v_or_b32 v156, v156, v16
    v_or_b32 v157, v157, v17
    v_or_b32 v158, v158, v18
    v_or_b32 v159, v159, v19
    v_or_b32 v136, v136, v20
    v_or_b32 v137, v137, v21
    v_or_b32 v138, v138, v22
    v_or_b32 v139, v139, v23
    v_mov_b32 v4, 0
    v_mov_b32 v5, 0
    v_mov_b32 v6, 0
    v_mov_b32 v7, 0
    v_mov_b32 v8, 0
    v_mov_b32 v9, 0
    v_mov_b32 v10, 0
    v_mov_b32 v11, 0
    v_mov_b32 v12, 0
    v_mov_b32 v13, 0
    v_mov_b32 v14, 0
    v_mov_b32 v15, 0
    v_mov_b32 v16, 0
    v_mov_b32 v17, 0
    v_mov_b32 v18, 0
    v_mov_b32 v19, 0
    v_mov_b32 v20, 0
    v_mov_b32 v21, 0
    v_mov_b32 v22, 0
    v_mov_b32 v23, 0
    s_mul_i32 s24, s22, 3277
    s_lshr_b32 s24, s24, 16
    s_mul_i32 s68, s24, 20
    s_sub_u32 s68, s22, s68
    s_cmp_lt_u32 s68, 8
    s_cselect_b64 s[66:67], s[84:85], s[86:87]
    s_cselect_b32 s25, 0, 8
    s_sub_u32 s68, s68, s25
    s_and_b32 s25, s68, 1
    s_lshr_b32 s68, s68, 1
    s_lshl_b32 s68, s68, 14
    s_lshl_b32 s25, s25, 12
    s_add_u32 s68, s68, s25
    s_lshl_b32 s24, s24, 5
    s_add_u32 s68, s68, s24
    v_lshrrev_b32 v2, 4, v176
    v_lshlrev_b32 v2, 10, v2
    v_and_b32 v3, 15, v176
    v_lshl_add_u32 v2, v3, 1, v2
    v_add_u32 v2, s68, v2
    v_add_u32 v3, 8192, v2
    global_load_ushort v140, v2, s[66:67] offset:0
    global_load_short_d16_hi v4, v3, s[66:67] offset:0
    global_load_ushort v141, v2, s[66:67] offset:256
    global_load_short_d16_hi v5, v3, s[66:67] offset:256
    global_load_ushort v142, v2, s[66:67] offset:512
    global_load_short_d16_hi v6, v3, s[66:67] offset:512
    global_load_ushort v143, v2, s[66:67] offset:768
    global_load_short_d16_hi v7, v3, s[66:67] offset:768
    s_add_u32 s22, s22, 1
    s_mul_i32 s24, s22, 3277
    s_lshr_b32 s24, s24, 16
    s_mul_i32 s68, s24, 20
    s_sub_u32 s68, s22, s68
    s_cmp_lt_u32 s68, 8
    s_cselect_b64 s[66:67], s[84:85], s[86:87]
    s_cselect_b32 s25, 0, 8
    s_sub_u32 s68, s68, s25
    s_and_b32 s25, s68, 1
    s_lshr_b32 s68, s68, 1
    s_lshl_b32 s68, s68, 14
    s_lshl_b32 s25, s25, 12
    s_add_u32 s68, s68, s25
    s_lshl_b32 s24, s24, 5
    s_add_u32 s68, s68, s24
    v_lshrrev_b32 v2, 4, v176
    v_lshlrev_b32 v2, 10, v2
    v_and_b32 v3, 15, v176
    v_lshl_add_u32 v2, v3, 1, v2
    v_add_u32 v2, s68, v2
    v_add_u32 v3, 8192, v2
    global_load_ushort v168, v2, s[66:67] offset:0
    global_load_short_d16_hi v8, v3, s[66:67] offset:0
    global_load_ushort v169, v2, s[66:67] offset:256
    global_load_short_d16_hi v9, v3, s[66:67] offset:256
    global_load_ushort v170, v2, s[66:67] offset:512
    global_load_short_d16_hi v10, v3, s[66:67] offset:512
    global_load_ushort v171, v2, s[66:67] offset:768
    global_load_short_d16_hi v11, v3, s[66:67] offset:768
    s_add_u32 s22, s22, 1
    s_mul_i32 s24, s22, 3277
    s_lshr_b32 s24, s24, 16
    s_mul_i32 s68, s24, 20
    s_sub_u32 s68, s22, s68
    s_cmp_lt_u32 s68, 8
    s_cselect_b64 s[66:67], s[84:85], s[86:87]
    s_cselect_b32 s25, 0, 8
    s_sub_u32 s68, s68, s25
    s_and_b32 s25, s68, 1
    s_lshr_b32 s68, s68, 1
    s_lshl_b32 s68, s68, 14
    s_lshl_b32 s25, s25, 12
    s_add_u32 s68, s68, s25
    s_lshl_b32 s24, s24, 5
    s_add_u32 s68, s68, s24
    v_lshrrev_b32 v2, 4, v176
    v_lshlrev_b32 v2, 10, v2
    v_and_b32 v3, 15, v176
    v_lshl_add_u32 v2, v3, 1, v2
    v_add_u32 v2, s68, v2
    v_add_u32 v3, 8192, v2
    global_load_ushort v172, v2, s[66:67] offset:0
    global_load_short_d16_hi v12, v3, s[66:67] offset:0
    global_load_ushort v173, v2, s[66:67] offset:256
    global_load_short_d16_hi v13, v3, s[66:67] offset:256
    global_load_ushort v174, v2, s[66:67] offset:512
    global_load_short_d16_hi v14, v3, s[66:67] offset:512
    global_load_ushort v175, v2, s[66:67] offset:768
    global_load_short_d16_hi v15, v3, s[66:67] offset:768
    s_add_u32 s22, s22, 1
    s_mul_i32 s24, s22, 3277
    s_lshr_b32 s24, s24, 16
    s_mul_i32 s68, s24, 20
    s_sub_u32 s68, s22, s68
    s_cmp_lt_u32 s68, 8
    s_cselect_b64 s[66:67], s[84:85], s[86:87]
    s_cselect_b32 s25, 0, 8
    s_sub_u32 s68, s68, s25
    s_and_b32 s25, s68, 1
    s_lshr_b32 s68, s68, 1
    s_lshl_b32 s68, s68, 14
    s_lshl_b32 s25, s25, 12
    s_add_u32 s68, s68, s25
    s_lshl_b32 s24, s24, 5
    s_add_u32 s68, s68, s24
    v_lshrrev_b32 v2, 4, v176
    v_lshlrev_b32 v2, 10, v2
    v_and_b32 v3, 15, v176
    v_lshl_add_u32 v2, v3, 1, v2
    v_add_u32 v2, s68, v2
    v_add_u32 v3, 8192, v2
    global_load_ushort v112, v2, s[66:67] offset:0
    global_load_short_d16_hi v16, v3, s[66:67] offset:0
    global_load_ushort v113, v2, s[66:67] offset:256
    global_load_short_d16_hi v17, v3, s[66:67] offset:256
    global_load_ushort v114, v2, s[66:67] offset:512
    global_load_short_d16_hi v18, v3, s[66:67] offset:512
    global_load_ushort v115, v2, s[66:67] offset:768
    global_load_short_d16_hi v19, v3, s[66:67] offset:768
    s_add_u32 s22, s22, 1
    s_mul_i32 s24, s22, 3277
    s_lshr_b32 s24, s24, 16
    s_mul_i32 s68, s24, 20
    s_sub_u32 s68, s22, s68
    s_cmp_lt_u32 s68, 8
    s_cselect_b64 s[66:67], s[84:85], s[86:87]
    s_cselect_b32 s25, 0, 8
    s_sub_u32 s68, s68, s25
    s_and_b32 s25, s68, 1
    s_lshr_b32 s68, s68, 1
    s_lshl_b32 s68, s68, 14
    s_lshl_b32 s25, s25, 12
    s_add_u32 s68, s68, s25
    s_lshl_b32 s24, s24, 5
    s_add_u32 s68, s68, s24
    v_lshrrev_b32 v2, 4, v176
    v_lshlrev_b32 v2, 10, v2
    v_and_b32 v3, 15, v176
    v_lshl_add_u32 v2, v3, 1, v2
    v_add_u32 v2, s68, v2
    v_add_u32 v3, 8192, v2
    global_load_ushort v116, v2, s[66:67] offset:0
    global_load_short_d16_hi v20, v3, s[66:67] offset:0
    global_load_ushort v117, v2, s[66:67] offset:256
    global_load_short_d16_hi v21, v3, s[66:67] offset:256
    global_load_ushort v118, v2, s[66:67] offset:512
    global_load_short_d16_hi v22, v3, s[66:67] offset:512
    global_load_ushort v119, v2, s[66:67] offset:768
    global_load_short_d16_hi v23, v3, s[66:67] offset:768
    s_add_u32 s22, s22, 1
    s_waitcnt vmcnt(0)
    v_or_b32 v140, v140, v4
    v_or_b32 v141, v141, v5
    v_or_b32 v142, v142, v6
    v_or_b32 v143, v143, v7
    v_or_b32 v168, v168, v8
    v_or_b32 v169, v169, v9
    v_or_b32 v170, v170, v10
    v_or_b32 v171, v171, v11
    v_or_b32 v172, v172, v12
    v_or_b32 v173, v173, v13
    v_or_b32 v174, v174, v14
    v_or_b32 v175, v175, v15
    v_or_b32 v112, v112, v16
    v_or_b32 v113, v113, v17
    v_or_b32 v114, v114, v18
    v_or_b32 v115, v115, v19
    v_or_b32 v116, v116, v20
    v_or_b32 v117, v117, v21
    v_or_b32 v118, v118, v22
    v_or_b32 v119, v119, v23
    s_load_dwordx2 s[72:73], s[0:1], 72
    v_lshlrev_b32 v246, 4, v176
    s_mov_b32 s52, 163072
    v_bfe_u32 v177, v246, 4, 4
    v_bfe_u32 v179, v246, 4, 3
    v_lshl_add_u32 v180, v177, 3, s52
    v_lshl_add_u32 v190, v177, 4, s52
    v_lshl_add_u32 v181, v179, 3, s52
    ds_read2_b64 v[182:185], v180 offset0:32 offset1:48
    ds_read_b32 v191, v190
    ds_read_b64 v[186:187], v181 offset:512
    v_lshrrev_b32 v178, 8, v246
    s_add_u32 s22, s20, 0
    s_mul_i32 s28, s22, 1536
    s_add_u32 s28, s28, 86016
    s_cmp_lt_i32 s46, 0
    s_cselect_b32 s22, s22, s46
    s_lshl_b32 s22, s22, 21
    s_add_u32 s23, s20, 8
    s_mul_i32 s29, s23, 1536
    s_add_u32 s29, s29, 86144
    s_cmp_lt_i32 s46, 0
    s_cselect_b32 s23, s23, s46
    s_lshl_b32 s23, s23, 21
    s_add_u32 s24, s20, 16
    s_mul_i32 s30, s24, 1536
    s_add_u32 s30, s30, 86016
    s_cmp_lt_i32 s46, 0
    s_cselect_b32 s24, s24, s46
    s_lshl_b32 s24, s24, 21
    s_add_u32 s25, s20, 24
    s_cmp_lt_i32 s46, 0
    s_cselect_b32 s25, s25, s46
    s_lshl_b32 s25, s25, 21
    s_add_u32 s26, s20, 32
    s_cmp_lt_i32 s46, 0
    s_cselect_b32 s26, s26, s46
    s_lshl_b32 s26, s26, 21
    s_mov_b32 s53, 0
    s_mov_b32 s50, 0
    s_waitcnt lgkmcnt(0)
    s_branch GEMM
.section .rodata,"a"
.p2align 6
.amdhsa_kernel standalone__tensor_product_equiv_equiformer__graph_kernel
  .amdhsa_next_free_vgpr 256
  .amdhsa_next_free_sgpr 92
  .amdhsa_accum_offset 256
  .amdhsa_group_segment_fixed_size 0
  .amdhsa_kernarg_size 96
  .amdhsa_user_sgpr_count 2
  .amdhsa_user_sgpr_kernarg_segment_ptr 1
  .amdhsa_system_sgpr_workgroup_id_x 1
.end_amdhsa_kernel
```

```asm
; @launch grid=(250,1,1) block=(512,1,1) lds=163840
.amdgcn_target "amdgcn-amd-amdhsa--gfx950"
.text
.globl standalone__tensor_product_equiv_equiformer__graph_kernel
.p2align 8
.type standalone__tensor_product_equiv_equiformer__graph_kernel,@function
standalone__tensor_product_equiv_equiformer__graph_kernel:
    s_cmp_ge_u32 s2, 250
    s_cbranch_scc1 K2_end
    s_load_dwordx16 s[72:87], s[0:1], 0
    s_load_dwordx2 s[70:71], s[0:1], 88
    v_lshrrev_b32 v2, 6, v0
    v_and_b32 v1, 63, v0
    v_readfirstlane_b32 s20, v2
    s_getpc_b64 s[66:67]
    v_lshlrev_b32 v95, 7, v1
    s_cmp_eq_u32 s20, 6
    s_cbranch_scc0 F_nopf0
    global_load_dword v95, v95, s[66:67]
F_nopf0:
    s_mul_i32 s66, s2, 5120
    s_mul_i32 s67, s2, 7680
    v_lshl_add_u32 v3, v0, 4, s66
    v_mul_u32_u24 v4, 24, v0
    v_add_u32 v4, s67, v4
    v_lshlrev_b32 v5, 2, v0
    v_mov_b32 v89, 0
    v_add_u32 v6, 98304, v5
    ds_write_b32 v6, v89
    s_cmp_ge_u32 s20, 5
    s_waitcnt lgkmcnt(0)
    s_cbranch_scc1 F_noload
    global_load_dwordx4 v[8:11], v3, s[80:81] nt
    global_load_dwordx4 v[12:15], v3, s[78:79] nt
    global_load_dwordx4 v[16:19], v4, s[74:75] nt
    global_load_dwordx2 v[20:21], v4, s[74:75] offset:16 nt
F_noload:
    s_load_dword s88, s[70:71], 0
    s_barrier
    v_lshlrev_b32 v248, 2, v1
    v_add_u32 v88, 162816, v248
    ds_write_b32 v88, v89
    ds_write_b32 v88, v89 offset:256
    v_lshlrev_b32 v86, 4, v1
    s_lshl_b32 s21, s20, 13
    s_lshl_b32 s66, s20, 10
    s_add_u32 s66, s66, 0
    v_add_u32 v96, s66, v86
    v_lshrrev_b32 v6, 8, v96
    v_mul_u32_u24 v6, 205, v6
    v_bfe_u32 v7, v6, 12, 1
    v_bfe_u32 v6, v6, 10, 1
    v_lshl_or_b32 v6, v7, 1, v6
    v_lshlrev_b32 v6, 6, v6
    v_xor_b32 v96, v96, v6
    s_lshl_b32 s66, s20, 10
    s_add_u32 s66, s66, 8192
    v_add_u32 v97, s66, v86
    v_lshrrev_b32 v6, 8, v97
    v_mul_u32_u24 v6, 205, v6
    v_bfe_u32 v7, v6, 12, 1
    v_bfe_u32 v6, v6, 10, 1
    v_lshl_or_b32 v6, v7, 1, v6
    v_lshlrev_b32 v6, 6, v6
    v_xor_b32 v97, v97, v6
    s_lshl_b32 s66, s20, 10
    s_add_u32 s66, s66, 16384
    v_add_u32 v98, s66, v86
    v_lshrrev_b32 v6, 8, v98
    v_mul_u32_u24 v6, 205, v6
    v_bfe_u32 v7, v6, 12, 1
    v_bfe_u32 v6, v6, 10, 1
    v_lshl_or_b32 v6, v7, 1, v6
    v_lshlrev_b32 v6, 6, v6
    v_xor_b32 v98, v98, v6
    v_mov_b32 v180, 0
    v_mov_b32 v181, 0
    v_mov_b32 v182, 0
    v_mov_b32 v183, 0
    s_mov_b32 s16, s70
    s_and_b32 s17, s71, 0xffff
    s_mov_b32 s18, 24165888
    s_mov_b32 s19, 0x20000
    v_lshrrev_b32 v2, 3, v1
    v_lshl_add_u32 v2, s20, 5, v2
    v_and_b32 v91, 7, v1
    v_mul_u32_u24 v94, 384, v2
    v_lshl_add_u32 v94, v91, 4, v94
    v_lshlrev_b32 v93, 2, v2
    v_add_u32 v93, 98304, v93
    v_mul_u32_u24 v92, 32000, v2
    v_lshl_add_u32 v92, v91, 4, v92
    v_mul_u32_u24 v90, 40960, v2
    s_mov_b32 s32, s82
    s_and_b32 s33, s83, 0xffff
    s_mov_b32 s34, 20480
    s_mov_b32 s35, 0x20000
    s_cmp_ge_u32 s20, 5
    s_cbranch_scc1 F_helper
    s_mov_b32 s22, 52429
    s_mov_b32 s23, 0x05040100
    s_mov_b32 s66, 98304
    s_movk_i32 s67, -40
    v_mov_b32 v7, 1
    v_add_u32 v31, 1, v5
    v_add_u32 v32, 2, v5
    v_add_u32 v33, 3, v5
    s_waitcnt vmcnt(3)
    v_mul_u32_u24 v22, s22, v8
    v_mul_u32_u24 v23, s22, v9
    v_mul_u32_u24 v24, s22, v10
    v_mul_u32_u24 v25, s22, v11
    v_lshrrev_b32 v22, 21, v22
    v_lshrrev_b32 v23, 21, v23
    v_lshrrev_b32 v24, 21, v24
    v_lshrrev_b32 v25, 21, v25
    v_lshl_add_u32 v34, v22, 2, s66
    ds_add_rtn_u32 v26, v34, v7
    v_lshl_add_u32 v35, v23, 2, s66
    ds_add_rtn_u32 v27, v35, v7
    v_lshl_add_u32 v36, v24, 2, s66
    ds_add_rtn_u32 v28, v36, v7
    v_lshl_add_u32 v37, v25, 2, s66
    ds_add_rtn_u32 v29, v37, v7
    v_mad_i32_i24 v2, v22, s67, v8
    v_mul_u32_u24 v22, 384, v22
    v_lshl_or_b32 v42, v2, 11, v5
    v_mad_i32_i24 v2, v23, s67, v9
    v_mul_u32_u24 v23, 384, v23
    v_lshl_or_b32 v46, v2, 11, v31
    v_mad_i32_i24 v2, v24, s67, v10
    v_mul_u32_u24 v24, 384, v24
    v_lshl_or_b32 v50, v2, 11, v32
    v_mad_i32_i24 v2, v25, s67, v11
    v_mul_u32_u24 v25, 384, v25
    v_lshl_or_b32 v54, v2, 11, v33
    s_waitcnt vmcnt(0)
    v_mov_b32 v40, v16
    v_perm_b32 v41, v12, v17, s23
    v_alignbit_b32 v44, v18, v17, 16
    v_alignbit_b32 v45, v13, v18, 16
    v_mov_b32 v48, v19
    v_perm_b32 v49, v14, v20, s23
    v_alignbit_b32 v52, v21, v20, 16
    v_alignbit_b32 v53, v15, v21, 16
    v_xor_b32 v41, 0x8000, v41
    v_xor_b32 v45, 0x8000, v45
    v_xor_b32 v49, 0x8000, v49
    v_xor_b32 v53, 0x8000, v53
    s_waitcnt lgkmcnt(0)
    v_min_u32 v26, 23, v26
    v_lshl_add_u32 v34, v26, 4, v22
    ds_write_b128 v34, v[40:43]
    v_min_u32 v27, 23, v27
    v_lshl_add_u32 v35, v27, 4, v23
    ds_write_b128 v35, v[44:47]
    v_min_u32 v28, 23, v28
    v_lshl_add_u32 v36, v28, 4, v24
    ds_write_b128 v36, v[48:51]
    v_min_u32 v29, 23, v29
    v_lshl_add_u32 v37, v29, 4, v25
    ds_write_b128 v37, v[52:55]
    s_branch F_staged
F_helper:
    s_cmp_eq_u32 s20, 5
    s_cbranch_scc0 F_nowp
    v_lshlrev_b32 v2, 7, v1
    s_movk_i32 s66, 0
    buffer_load_dword v95, v2, s[32:35], s66 offen
    s_movk_i32 s66, 8192
    buffer_load_dword v95, v2, s[32:35], s66 offen
    s_movk_i32 s66, 16384
    v_min_u32 v2, 3968, v2
    buffer_load_dword v95, v2, s[32:35], s66 offen
F_nowp:
    s_cmp_eq_u32 s20, 6
    s_cbranch_scc0 F_nopf
    s_getpc_b64 s[66:67]
F_pc:
    s_lshr_b32 s68, s2, 3
    s_mul_i32 s68, s68, ((K2_last-F_pc)/128/31+1)*128
    v_lshl_add_u32 v2, v1, 7, s68
    v_min_u32 v2, K2_last-F_pc-4, v2
    v_cmp_gt_u32 vcc, (K2_last-F_pc)/128/31+1, v1
    s_mov_b64 exec, vcc
    global_load_dword v95, v2, s[66:67]
    s_mov_b64 exec, -1
F_nopf:
    s_cmp_eq_u32 s20, 7
    s_cbranch_scc0 F_staged
    s_cmp_lt_u32 s2, 160
    s_cbranch_scc0 F_staged
    s_mul_i32 s22, s2, 3277
    s_lshr_b32 s22, s22, 16
    s_mul_i32 s68, s22, 20
    s_sub_u32 s68, s2, s68
    s_cmp_lt_u32 s68, 8
    s_cselect_b64 s[66:67], s[84:85], s[86:87]
    s_cselect_b32 s23, 0, 8
    s_sub_u32 s68, s68, s23
    s_and_b32 s23, s68, 1
    s_lshr_b32 s68, s68, 1
    s_lshl_b32 s68, s68, 14
    s_lshl_b32 s23, s23, 12
    s_add_u32 s68, s68, s23
    s_lshl_b32 s22, s22, 5
    s_add_u32 s68, s68, s22
    v_lshrrev_b32 v2, 4, v1
    v_lshlrev_b32 v2, 10, v2
    v_and_b32 v3, 15, v1
    v_lshl_add_u32 v2, v3, 1, v2
    v_add_u32 v2, s68, v2
    v_add_u32 v3, 8192, v2
    global_load_ushort v176, v2, s[66:67] offset:0
    global_load_short_d16_hi v180, v3, s[66:67] offset:0
    global_load_ushort v177, v2, s[66:67] offset:256
    global_load_short_d16_hi v181, v3, s[66:67] offset:256
    global_load_ushort v178, v2, s[66:67] offset:512
    global_load_short_d16_hi v182, v3, s[66:67] offset:512
    global_load_ushort v179, v2, s[66:67] offset:768
    global_load_short_d16_hi v183, v3, s[66:67] offset:768
F_staged:
    s_lshl_b32 s66, s2, 7
    s_add_u32 s66, s66, 164864
    s_cmp_eq_u32 s20, 7
    s_cselect_b32 s22, 0xffff, -1
    s_cselect_b32 s23, 0, -1
    s_waitcnt lgkmcnt(0)
    s_add_u32 s88, s88, 1
    s_barrier
    s_setprio 1
    ds_read_b32 v40, v93 offset:0
    ds_read_b128 v[8:11], v94 offset:0
    ds_read_b32 v14, v94 offset:136
    ds_read_b32 v41, v93 offset:32
    ds_read_b128 v[16:19], v94 offset:3072
    ds_read_b32 v22, v94 offset:3208
    ds_read_b32 v42, v93 offset:64
    ds_read_b128 v[24:27], v94 offset:6144
    ds_read_b32 v30, v94 offset:6280
    ds_read_b32 v43, v93 offset:96
    ds_read_b128 v[32:35], v94 offset:9216
    ds_read_b32 v38, v94 offset:9352
    s_add_u32 s28, s66, 0
    s_add_u32 s29, s66, 256000
    s_add_u32 s30, s66, 512000
    s_add_u32 s31, s66, 768000
    s_waitcnt lgkmcnt(9)
    v_min_u32 v5, 31, v40
    v_bfe_u32 v6, v14, 11, 6
    v_and_b32 v10, 0x1ffff, v10
    v_lshl_or_b32 v6, v5, 6, v6
    v_mov_b32 v11, s88
    v_lshl_or_b32 v10, v6, 17, v10
    buffer_store_dwordx4 v[8:11], v92, s[16:19], s28 offen sc1
    s_waitcnt lgkmcnt(6)
    v_min_u32 v5, 31, v41
    v_bfe_u32 v6, v22, 11, 6
    v_and_b32 v18, 0x1ffff, v18
    v_lshl_or_b32 v6, v5, 6, v6
    v_mov_b32 v19, s88
    v_lshl_or_b32 v18, v6, 17, v18
    buffer_store_dwordx4 v[16:19], v92, s[16:19], s29 offen sc1
    s_waitcnt lgkmcnt(3)
    v_min_u32 v5, 31, v42
    v_bfe_u32 v6, v30, 11, 6
    v_and_b32 v26, 0x1ffff, v26
    v_lshl_or_b32 v6, v5, 6, v6
    v_mov_b32 v27, s88
    v_lshl_or_b32 v26, v6, 17, v26
    buffer_store_dwordx4 v[24:27], v92, s[16:19], s30 offen sc1
    s_waitcnt lgkmcnt(0)
    v_min_u32 v5, 31, v43
    v_bfe_u32 v6, v38, 11, 6
    v_and_b32 v34, 0x1ffff, v34
    v_lshl_or_b32 v6, v5, 6, v6
    v_mov_b32 v35, s88
    v_lshl_or_b32 v34, v6, 17, v34
    s_mov_b64 exec, s[22:23]
    buffer_store_dwordx4 v[32:35], v92, s[16:19], s31 offen sc1
    s_mov_b64 exec, -1
    s_setprio 0
    ds_read_b128 v[12:15], v94 offset:128
    ds_read_b128 v[20:23], v94 offset:3200
    ds_read_b128 v[28:31], v94 offset:6272
    ds_read_b128 v[36:39], v94 offset:9344
    s_waitcnt vmcnt(4)
F_now:
    v_cmp_lt_u32 vcc, 8, v40
    s_add_u32 s67, s28, 8000000
    s_waitcnt lgkmcnt(3)
    v_mov_b32 v15, s88
    s_mov_b64 exec, vcc
    s_cbranch_execz F_w0
    buffer_store_dwordx4 v[12:15], v92, s[16:19], s67 offen sc1
    v_cmp_lt_u32 vcc, 16, v40
    s_add_u32 s67, s67, 8000000
    s_mov_b64 exec, vcc
    s_cbranch_execz F_w0
    ds_read_b128 v[44:47], v94 offset:256
    s_waitcnt lgkmcnt(0)
    v_mov_b32 v47, s88
    buffer_store_dwordx4 v[44:47], v92, s[16:19], s67 offen sc1
    s_nop 1
F_w0:
    s_mov_b64 exec, -1
    v_cmp_lt_u32 vcc, 8, v41
    s_add_u32 s67, s29, 8000000
    s_waitcnt lgkmcnt(2)
    v_mov_b32 v23, s88
    s_mov_b64 exec, vcc
    s_cbranch_execz F_w1
    buffer_store_dwordx4 v[20:23], v92, s[16:19], s67 offen sc1
    v_cmp_lt_u32 vcc, 16, v41
    s_add_u32 s67, s67, 8000000
    s_mov_b64 exec, vcc
    s_cbranch_execz F_w1
    ds_read_b128 v[44:47], v94 offset:3328
    s_waitcnt lgkmcnt(0)
    v_mov_b32 v47, s88
    buffer_store_dwordx4 v[44:47], v92, s[16:19], s67 offen sc1
    s_nop 1
F_w1:
    s_mov_b64 exec, -1
    v_cmp_lt_u32 vcc, 8, v42
    s_add_u32 s67, s30, 8000000
    s_waitcnt lgkmcnt(1)
    v_mov_b32 v31, s88
    s_mov_b64 exec, vcc
    s_cbranch_execz F_w2
    buffer_store_dwordx4 v[28:31], v92, s[16:19], s67 offen sc1
    v_cmp_lt_u32 vcc, 16, v42
    s_add_u32 s67, s67, 8000000
    s_mov_b64 exec, vcc
    s_cbranch_execz F_w2
    ds_read_b128 v[44:47], v94 offset:6400
    s_waitcnt lgkmcnt(0)
    v_mov_b32 v47, s88
    buffer_store_dwordx4 v[44:47], v92, s[16:19], s67 offen sc1
    s_nop 1
F_w2:
    s_mov_b64 exec, -1
    v_cmp_lt_u32 vcc, 8, v43
    s_add_u32 s67, s31, 8000000
    s_and_b64 vcc, vcc, s[22:23]
    s_waitcnt lgkmcnt(0)
    v_mov_b32 v39, s88
    s_mov_b64 exec, vcc
    s_cbranch_execz F_w3
    buffer_store_dwordx4 v[36:39], v92, s[16:19], s67 offen sc1
    v_cmp_lt_u32 vcc, 16, v43
    s_add_u32 s67, s67, 8000000
    s_mov_b64 exec, vcc
    s_cbranch_execz F_w3
    ds_read_b128 v[44:47], v94 offset:9472
    s_waitcnt lgkmcnt(0)
    v_mov_b32 v47, s88
    buffer_store_dwordx4 v[44:47], v92, s[16:19], s67 offen sc1
    s_nop 1
F_w3:
    s_mov_b64 exec, -1
    s_cmp_eq_u32 s20, 7
    s_cbranch_scc0 F_nofrag
    s_cmp_lt_u32 s2, 160
    s_cbranch_scc0 F_nofrag
    v_or_b32 v176, v176, v180
    v_or_b32 v177, v177, v181
    v_or_b32 v178, v178, v182
    v_or_b32 v179, v179, v183
    s_lshl_b32 s66, s2, 10
    s_add_u32 s66, s66, 1024
    buffer_store_dwordx4 v[176:179], v86, s[16:19], s66 offen sc1
F_nofrag:
    s_barrier
    s_mul_i32 s24, s2, 32000
    s_lshl_b32 s25, s20, 12
    s_add_u32 s24, s24, s25
    s_add_u32 s24, s24, 164864
    s_add_u32 s25, s24, 8000000
    s_add_u32 s26, s25, 8000000
    v_mov_b32 v22, 0
    v_mov_b32 v23, s88
    s_lshl_b32 s68, s20, 10
    s_add_u32 m0, s68, 65536
    s_nop 0
    buffer_load_dwordx4 v96, s[32:35], 0 offen lds
    s_add_u32 m0, s68, 73728
    s_nop 0
    buffer_load_dwordx4 v97, s[32:35], 0 offen lds
    s_cmp_ge_u32 s20, 4
    s_cbranch_scc1 F_now2
    s_add_u32 m0, s68, 81920
    s_nop 0
    buffer_load_dwordx4 v98, s[32:35], 0 offen lds
F_now2:
    v_mov_b32 v4, 2130738944
    v_mov_b32 v5, 2130738944
    v_mov_b32 v6, 2130738944
    v_mov_b32 v7, 2130738944
    v_lshlrev_b32 v2, 4, v0
    v_add_u32 v3, 86016, v2
    ds_write_b128 v3, v[4:7] offset:0
    ds_write_b128 v3, v[4:7] offset:8192
    ds_write_b128 v3, v[4:7] offset:16384
    ds_write_b128 v3, v[4:7] offset:24576
    ds_write_b128 v3, v[4:7] offset:32768
    ds_write_b128 v3, v[4:7] offset:40960
    ds_write_b128 v3, v[4:7] offset:49152
    ds_write_b128 v3, v[4:7] offset:57344
    v_add_u32 v3, 0x10000, v3
    ds_write_b128 v3, v[4:7] offset:0
    v_min_u32 v2, 3056, v2
    v_add_u32 v2, 159744, v2
    ds_write_b128 v2, v[4:7]
    s_sub_u32 s72, s72, 128
    s_subb_u32 s73, s73, 0
    s_mov_b32 s4, s72
    s_and_b32 s5, s73, 0xffff
    s_mov_b32 s6, 10240000
    s_mov_b32 s7, 0x20000
    s_sub_u32 s72, s72, 1024
    s_subb_u32 s73, s73, 0
    s_mov_b32 s8, s72
    s_and_b32 s9, s73, 0xffff
    s_mov_b32 s10, 10241024
    s_mov_b32 s11, 0x20000
    s_mov_b32 s12, s76
    s_and_b32 s13, s77, 0xffff
    s_mov_b32 s14, 10240000
    s_mov_b32 s15, 0x20000
    v_lshrrev_b32 v2, 5, v1
    v_bfe_u32 v3, v1, 2, 2
    v_and_b32 v4, 3, v1
    v_bfe_u32 v5, v1, 4, 1
    v_lshlrev_b32 v6, 9, v2
    v_lshl_add_u32 v6, v3, 7, v6
    v_lshl_add_u32 v6, v5, 5, v6
    v_lshl_add_u32 v6, v4, 3, v6
    v_lshrrev_b32 v7, 1, v3
    v_lshl_add_u32 v6, v7, 6, v6
    v_add_u32 v244, s21, v6
    v_xor_b32 v245, 64, v244
    v_lshlrev_b32 v6, 7, v2
    v_lshl_add_u32 v6, v7, 5, v6
    v_and_b32 v7, 1, v3
    v_xor_b32 v7, 1, v7
    v_mul_u32_u24 v7, 90112, v7
    v_add_u32 v6, v6, v7
    v_lshl_add_u32 v249, v4, 3, v6
    v_lshl_add_u32 v6, v2, 2, v4
    v_bfe_u32 v7, v1, 2, 1
    v_lshl_add_u32 v6, v7, 3, v6
    v_lshlrev_b32 v6, 3, v6
    v_bfe_u32 v7, v1, 3, 1
    v_add_u32 v5, 1, v5
    v_mul_u32_u24 v7, v7, v5
    v_lshl_add_u32 v250, v7, 1, v6
    v_and_b32 v6, 0x38, v1
    v_add_u32 v247, 4, v6
    v_lshrrev_b32 v6, 2, v1
    v_lshrrev_b32 v7, 4, v1
    v_xor_b32 v6, v6, v7
    v_and_b32 v6, 1, v6
    v_lshlrev_b32 v6, 6, v6
    v_lshl_add_u32 v246, v4, 4, v6
    v_mov_b32 v242, 1.0
    v_mov_b32 v243, 1.0
    s_mov_b32 s54, 0xffffff00
    s_mov_b32 s55, 0xffffff00
    s_mov_b32 s56, 0xffff
    s_mov_b32 s57, 0xffff
    s_mov_b32 s58, 0
    s_mov_b32 s59, 134217856
    s_mov_b32 s60, 262272
    s_mov_b32 s61, 402915456
    s_mov_b32 s62, 940179840
    s_mov_b32 s63, 403046528
    s_mov_b32 s64, 402784384
    s_mov_b32 s65, 134348928
    s_mov_b32 s38, 128
    s_mov_b32 s33, -1
    s_and_b32 s68, s20, 3
    s_lshl_b32 s68, s68, 2
    s_lshr_b32 s69, s20, 2
    s_add_u32 s68, s68, s69
    s_lshl_b32 s68, s68, 4
    s_add_u32 s68, s68, 163072
    v_mov_b32 v251, s68
    s_mov_b32 s53, 0
    s_mov_b32 s50, 0
    s_mov_b32 s51, 0
    s_mov_b32 s47, 0
    s_mov_b32 s42, 0
    s_mov_b32 s3, 0
    s_mov_b32 s89, 0
    s_mov_b32 s34, 128
    s_mov_b32 s35, 384
    s_mov_b32 s36, 640
    s_mov_b32 s37, 896
    s_movk_i32 s3, 1024
    s_waitcnt lgkmcnt(0)
    s_waitcnt vmcnt(0)
    s_barrier
    s_mov_b32 s27, 4096
    s_mov_b32 s71, 162816
    v_mov_b32 v3, 8
    s_cmp_eq_u32 s20, 7
    s_cselect_b32 s52, 160, 0
    v_cmp_gt_u32 s[68:69], 40, v1
    s_mov_b64 s[28:29], 0xff
    s_lshr_b32 s66, s2, 3
    s_lshl_b32 s66, s66, 3
    s_add_u32 s66, s66, s20
    s_mul_i32 s66, s66, 14
    v_min_u32 v93, 13, v1
    v_add_u32 v93, s66, v93
    v_lshlrev_b32 v93, 10, v93
    v_mov_b32 v94, 0x7f000000
    s_waitcnt lgkmcnt(0)
    buffer_load_dwordx4 v[8:11], v86, s[16:19], s24 offen offset:0 sc1
    buffer_load_dwordx4 v[12:15], v86, s[16:19], s24 offen offset:1024 sc1
    buffer_load_dwordx4 v[16:19], v86, s[16:19], s24 offen offset:2048 sc1
    s_mov_b64 exec, s[22:23]
    buffer_load_dwordx4 v[20:23], v86, s[16:19], s24 offen offset:3072 sc1
    s_mov_b64 exec, -1
    v_bfe_u32 v4, v248, 5, 1
    v_bfe_u32 v6, v248, 7, 1
    v_lshl_or_b32 v5, v6, 1, v4
    v_lshl_or_b32 v4, v6, 2, v4
    v_mul_u32_u24 v4, 1280, v4
    v_lshl_add_u32 v4, v5, 6, v4
    v_bfe_u32 v6, v248, 6, 1
    v_lshl_add_u32 v4, v6, 5, v4
    v_and_b32 v6, 12, v248
    v_lshl_add_u32 v4, v6, 1, v4
    v_and_b32 v6, 16, v248
    v_xor_b32 v6, 16, v6
    v_lshl_add_u32 v4, v6, 13, v4
    v_add_u32 v4, 65536, v4
    v_xor_b32 v5, 64, v4
    ds_read_b64_tr_b16 v[96:97], v4 offset:0
    ds_read_b64_tr_b16 v[98:99], v4 offset:2560
    ds_read_b64_tr_b16 v[100:101], v4 offset:10240
    ds_read_b64_tr_b16 v[102:103], v4 offset:12800
    ds_read_b64_tr_b16 v[104:105], v5 offset:0
    ds_read_b64_tr_b16 v[106:107], v5 offset:2560
    ds_read_b64_tr_b16 v[108:109], v5 offset:10240
    ds_read_b64_tr_b16 v[110:111], v5 offset:12800
    ds_read_b64_tr_b16 v[128:129], v4 offset:512
    ds_read_b64_tr_b16 v[130:131], v4 offset:3072
    ds_read_b64_tr_b16 v[132:133], v4 offset:10752
    ds_read_b64_tr_b16 v[134:135], v4 offset:13312
    ds_read_b64_tr_b16 v[136:137], v5 offset:512
    ds_read_b64_tr_b16 v[138:139], v5 offset:3072
    ds_read_b64_tr_b16 v[140:141], v5 offset:10752
    ds_read_b64_tr_b16 v[142:143], v5 offset:13312
    ds_read_b64_tr_b16 v[144:145], v4 offset:768
    ds_read_b64_tr_b16 v[146:147], v4 offset:3328
    ds_read_b64_tr_b16 v[148:149], v4 offset:11008
    ds_read_b64_tr_b16 v[150:151], v4 offset:13568
    ds_read_b64_tr_b16 v[152:153], v5 offset:768
    ds_read_b64_tr_b16 v[154:155], v5 offset:3328
    ds_read_b64_tr_b16 v[156:157], v5 offset:11008
    ds_read_b64_tr_b16 v[158:159], v5 offset:13568
    ds_read_b64_tr_b16 v[160:161], v4 offset:1024
    ds_read_b64_tr_b16 v[162:163], v4 offset:3584
    ds_read_b64_tr_b16 v[164:165], v4 offset:11264
    ds_read_b64_tr_b16 v[166:167], v4 offset:13824
    ds_read_b64_tr_b16 v[168:169], v5 offset:1024
    ds_read_b64_tr_b16 v[170:171], v5 offset:3584
    ds_read_b64_tr_b16 v[172:173], v5 offset:11264
    ds_read_b64_tr_b16 v[174:175], v5 offset:13824
    ds_read_b64_tr_b16 v[112:113], v4 offset:256
    ds_read_b64_tr_b16 v[114:115], v4 offset:2816
    ds_read_b64_tr_b16 v[116:117], v4 offset:10496
    ds_read_b64_tr_b16 v[118:119], v4 offset:13056
    ds_read_b64_tr_b16 v[120:121], v5 offset:256
    ds_read_b64_tr_b16 v[122:123], v5 offset:2816
    ds_read_b64_tr_b16 v[124:125], v5 offset:10496
    ds_read_b64_tr_b16 v[126:127], v5 offset:13056
F_poll:
    s_waitcnt vmcnt(0)
F_poll1:
    v_cmp_ne_u32 s[72:73], s88, v11
    v_cmp_ne_u32 s[74:75], s88, v15
    v_cmp_ne_u32 s[76:77], s88, v19
    v_cmp_ne_u32 s[78:79], s88, v23
    s_or_b64 s[80:81], s[72:73], s[74:75]
    s_or_b64 s[82:83], s[76:77], s[78:79]
    s_or_b64 s[80:81], s[80:81], s[82:83]
    s_cbranch_scc1 F_again
F_got:
    v_bfe_u32 v2, v10, 23, 5
    v_bfe_u32 v60, v10, 11, 6
    v_cmp_gt_u32 s[80:81], v2, v91
    v_lshl_add_u32 v60, v60, 2, s71
    v_cmp_lt_u32 s[72:73], 8, v2
    v_max_u32 v89, v89, v2
    s_mov_b64 exec, s[80:81]
    ds_add_rtn_u32 v72, v60, v3
    s_mov_b64 exec, s[72:73]
    s_cbranch_execz F_h0
    buffer_load_dwordx4 v[24:27], v86, s[16:19], s25 offen offset:0 sc1
    v_sub_u32 v56, v2, v91
    v_bfe_u32 v64, v10, 17, 6
    v_cmp_lt_u32 vcc, 8, v56
    v_lshl_add_u32 v64, v64, 2, s71
    s_mov_b64 exec, vcc
    ds_add_rtn_u32 v76, v64, v3
F_h0:
    s_mov_b64 exec, -1
    v_bfe_u32 v2, v14, 23, 5
    v_bfe_u32 v61, v14, 11, 6
    v_cmp_gt_u32 s[82:83], v2, v91
    v_lshl_add_u32 v61, v61, 2, s71
    v_cmp_lt_u32 s[74:75], 8, v2
    v_max_u32 v89, v89, v2
    s_mov_b64 exec, s[82:83]
    ds_add_rtn_u32 v73, v61, v3
    s_mov_b64 exec, s[74:75]
    s_cbranch_execz F_h1
    buffer_load_dwordx4 v[28:31], v86, s[16:19], s25 offen offset:1024 sc1
    v_sub_u32 v57, v2, v91
    v_bfe_u32 v65, v14, 17, 6
    v_cmp_lt_u32 vcc, 8, v57
    v_lshl_add_u32 v65, v65, 2, s71
    s_mov_b64 exec, vcc
    ds_add_rtn_u32 v77, v65, v3
F_h1:
    s_mov_b64 exec, -1
    v_bfe_u32 v2, v18, 23, 5
    v_bfe_u32 v62, v18, 11, 6
    v_cmp_gt_u32 s[84:85], v2, v91
    v_lshl_add_u32 v62, v62, 2, s71
    v_cmp_lt_u32 s[76:77], 8, v2
    v_max_u32 v89, v89, v2
    s_mov_b64 exec, s[84:85]
    ds_add_rtn_u32 v74, v62, v3
    s_mov_b64 exec, s[76:77]
    s_cbranch_execz F_h2
    buffer_load_dwordx4 v[32:35], v86, s[16:19], s25 offen offset:2048 sc1
    v_sub_u32 v58, v2, v91
    v_bfe_u32 v66, v18, 17, 6
    v_cmp_lt_u32 vcc, 8, v58
    v_lshl_add_u32 v66, v66, 2, s71
    s_mov_b64 exec, vcc
    ds_add_rtn_u32 v78, v66, v3
F_h2:
    s_mov_b64 exec, -1
    v_bfe_u32 v2, v22, 23, 5
    v_bfe_u32 v63, v22, 11, 6
    v_cmp_gt_u32 s[86:87], v2, v91
    v_lshl_add_u32 v63, v63, 2, s71
    v_cmp_lt_u32 s[78:79], 8, v2
    v_max_u32 v89, v89, v2
    s_mov_b64 exec, s[86:87]
    ds_add_rtn_u32 v75, v63, v3
    s_mov_b64 exec, s[78:79]
    s_cbranch_execz F_h3
    buffer_load_dwordx4 v[36:39], v86, s[16:19], s25 offen offset:3072 sc1
    v_sub_u32 v59, v2, v91
    v_bfe_u32 v67, v22, 17, 6
    v_cmp_lt_u32 vcc, 8, v59
    v_lshl_add_u32 v67, v67, 2, s71
    s_mov_b64 exec, vcc
    ds_add_rtn_u32 v79, v67, v3
F_h3:
    s_mov_b64 exec, -1
    v_cmp_lt_u32 s[30:31], 16, v89
    s_mov_b32 s27, 262144
    s_cmp_lg_u64 s[30:31], 0
    s_cbranch_scc1 F_l3
F_l3r:
    s_cmp_lt_u32 s2, s52
    s_cbranch_scc1 F_flag
F_flagr:
    s_waitcnt lgkmcnt(0)
    s_barrier
    ds_read_b32 v4, v88
    buffer_load_dword v95, v93, s[4:7], 0 offen offset:128
    v_and_b32 v10, 0x7ff, v10
    v_lshl_add_u32 v10, v10, 5, v90
    v_or_b32 v11, 16, v10
    v_and_b32 v14, 0x7ff, v14
    v_lshl_add_u32 v14, v14, 5, v90
    v_add_u32 v14, 327680, v14
    v_or_b32 v15, 16, v14
    v_and_b32 v18, 0x7ff, v18
    v_lshl_add_u32 v18, v18, 5, v90
    v_add_u32 v18, 655360, v18
    v_or_b32 v19, 16, v18
    v_and_b32 v22, 0x7ff, v22
    v_lshl_add_u32 v22, v22, 5, v90
    v_add_u32 v22, 983040, v22
    v_or_b32 v23, 16, v22
    s_waitcnt lgkmcnt(0)
    v_add_u32 v2, 56, v4
    v_cmp_lt_u32 vcc, 512, v4
    v_lshrrev_b32 v2, 6, v2
    v_max_u32 v2, 2, v2
    s_and_b64 s[90:91], vcc, vcc
    s_cbranch_scc1 F_big
F_bigr:
    v_med3_u32 v3, v2, 3, 7
    v_cmp_eq_u32 vcc, 7, v2
    v_mad_u32_u24 v3, v3, 6, 14
    v_lshlrev_b32_e64 v6, v3, 1
    v_cndmask_b32 v6, 0, v6, s[68:69]
    v_addc_co_u32 v2, vcc, 0, v2, vcc
    v_mov_b32 v7, v6
    v_add_u32 v5, 1, v2
    v_lshrrev_b32 v5, 1, v5
    v_add_u32_dpp v7, v7, v7 row_shr:1 row_mask:0xf bank_mask:0xf
    v_lshlrev_b32 v92, 22, v5
    v_lshlrev_b32 v5, 18, v5
    v_add_u32_dpp v7, v7, v7 row_shr:2 row_mask:0xf bank_mask:0xf
    v_lshl_or_b32 v5, v1, 21, v5
    v_lshl_or_b32 v5, v2, 28, v5
    v_add_u32_dpp v7, v7, v7 row_shr:4 row_mask:0xf bank_mask:0xf
    s_mov_b32 s26, 86016
    s_mov_b32 s24, 0x2000
    v_add_u32_dpp v7, v7, v7 row_shr:8 row_mask:0xf bank_mask:0xf
    s_nop 1
    v_add_u32_dpp v7, v7, v7 row_bcast:15 row_mask:0xa bank_mask:0xf
    s_nop 1
    v_add_u32_dpp v7, v7, v7 row_bcast:31 row_mask:0xc bank_mask:0xf
    s_nop 0
    v_readlane_b32 s71, v7, 63
    v_sub_u32 v7, v7, v6
    s_lshr_b32 s66, s71, 24
    s_lshr_b32 s67, s71, 6
    s_lshr_b32 s70, s71, 12
    s_lshr_b32 s71, s71, 18
    s_add_u32 s67, s67, s70
    s_add_u32 s71, s71, s66
    s_add_u32 s71, s71, s67
    v_add_u32 v7, s71, v7
    s_bfe_u32 s70, s71, 393222
    v_bfe_u32 v7, v7, v3, 6
    s_bfe_u32 s67, s71, 393228
    v_cndmask_b32 v84, 63, v7, s[68:69]
    s_mul_i32 s68, s70, 3
    v_min_u32 v2, s70, v7
    s_mul_i32 s69, s66, 5
    v_min_u32 v3, s66, v7
    s_add_u32 s68, s68, s69
    v_mul_u32_u24 v7, 12, v7
    s_cmp_gt_u32 s68, 120
    v_mad_u32_u24 v7, v2, 3, v7
    s_cbranch_scc1 SLOW
    v_mad_u32_u24 v7, v3, 5, v7
    v_lshl_add_u32 v7, v7, 7, s26
    v_lshrrev_b32 v6, 3, v7
    v_mad_u32_u24 v92, v7, s24, v92
    v_or_b32 v92, v92, v6
    v_or_b32 v6, v5, v7
    s_add_u32 s71, s70, s66
    s_add_u32 s68, s71, s67
    s_andn2_b32 s70, s70, 3
    s_add_u32 s69, s70, 4
    s_andn2_b32 s67, s67, 3
    v_lshrrev_b32 v3, 1, v84
    v_mov_b32 v2, s68
    v_xor_b32 v3, v3, v84
    v_bfi_b32 v3, 4, v3, v84
    v_cmpx_gt_u32 vcc, s69, v84
    v_mov_b32 v2, s66
    v_cmpx_gt_u32 vcc, s70, v84
    v_mov_b32 v2, s71
    v_cmpx_gt_u32 vcc, s67, v84
    v_mov_b32 v2, 0
    s_mov_b64 exec, -1
    v_add_u32 v2, v2, v84
    v_bfi_b32 v84, 3, v2, v3
    s_lshr_b32 s66, s2, 3
    v_cmp_gt_u32 vcc, 32, v84
    v_add_u32 v2, s66, v84
    v_lshl_add_u32 v2, v2, 3, v84
    v_bfi_b32 v2, 24, v2, v84
    v_cndmask_b32 v84, v84, v2, vcc
    v_subrev_u32 v2, 6, v84
    v_and_b32 v2, 0x80000000, v2
    v_or_b32 v92, v92, v2
    ds_bpermute_b32 v60, v60, v92
    ds_bpermute_b32 v61, v61, v92
    ds_bpermute_b32 v62, v62, v92
    ds_bpermute_b32 v63, v63, v92
    ds_bpermute_b32 v64, v64, v92
    ds_bpermute_b32 v65, v65, v92
    ds_bpermute_b32 v66, v66, v92
    ds_bpermute_b32 v67, v67, v92
    v_cmp_eq_u32 vcc, s20, v84
    s_ff1_i32_b64 s67, vcc
    v_readlane_b32 s71, v6, s67
    s_mov_b32 s22, s71
    s_bfe_u32 s46, s71, 0x30012
    s_mov_b32 m0, s46
    s_and_b32 s66, s71, 0x3ffff
    s_movrels_b32 s68, s57
    s_movrels_b32 s69, s61
    s_sub_u32 s48, s66, s47
    s_mov_b32 s47, s66
    s_lshr_b32 s52, s71, 28
    s_lshl_b32 s67, s46, 9
    s_add_u32 s66, s66, s67
    s_sub_u32 s49, s66, s42
    s_mov_b32 s42, s66
    s_bfe_u32 s66, s68, 655360
    s_add_u32 s43, s42, s66
    s_bfe_u32 s39, s69, 655360
    s_bfe_u32 s66, s68, 655370
    s_add_u32 s44, s42, s66
    s_bfe_u32 s40, s69, 655370
    s_bfe_u32 s66, s68, 655380
    s_add_u32 s45, s42, s66
    s_bfe_u32 s41, s69, 655380
    s_waitcnt lgkmcnt(7)
    v_cmp_gt_i32 vcc, 0, v60
    v_and_b32 v60, 0x7fffffff, v60
    s_and_b64 exec, vcc, s[80:81]
    buffer_load_dword v95, v10, s[12:15], 0 offen
    s_mov_b64 exec, -1
    v_mad_u32_u16 v2, v60, 8, v72
    v_mad_u32_u16 v3, v60, 8, v72 op_sel:[1,0,0,0]
    s_mov_b64 exec, s[80:81]
    ds_write_b64 v2, v[10:11]
    ds_write_b64 v3, v[8:9]
    s_mov_b64 exec, -1
    s_waitcnt lgkmcnt(8)
    v_cmp_gt_i32 vcc, 0, v61
    v_and_b32 v61, 0x7fffffff, v61
    s_and_b64 exec, vcc, s[82:83]
    buffer_load_dword v95, v14, s[12:15], 0 offen
    s_mov_b64 exec, -1
    v_mad_u32_u16 v2, v61, 8, v73
    v_mad_u32_u16 v3, v61, 8, v73 op_sel:[1,0,0,0]
    s_mov_b64 exec, s[82:83]
    ds_write_b64 v2, v[14:15]
    ds_write_b64 v3, v[12:13]
    s_mov_b64 exec, -1
    s_waitcnt lgkmcnt(9)
    v_cmp_gt_i32 vcc, 0, v62
    v_and_b32 v62, 0x7fffffff, v62
    s_and_b64 exec, vcc, s[84:85]
    buffer_load_dword v95, v18, s[12:15], 0 offen
    s_mov_b64 exec, -1
    v_mad_u32_u16 v2, v62, 8, v74
    v_mad_u32_u16 v3, v62, 8, v74 op_sel:[1,0,0,0]
    s_mov_b64 exec, s[84:85]
    ds_write_b64 v2, v[18:19]
    ds_write_b64 v3, v[16:17]
    s_mov_b64 exec, -1
    s_waitcnt lgkmcnt(10)
    v_cmp_gt_i32 vcc, 0, v63
    v_and_b32 v63, 0x7fffffff, v63
    s_and_b64 exec, vcc, s[86:87]
    buffer_load_dword v95, v22, s[12:15], 0 offen
    s_mov_b64 exec, -1
    v_mad_u32_u16 v2, v63, 8, v75
    v_mad_u32_u16 v3, v63, 8, v75 op_sel:[1,0,0,0]
    s_mov_b64 exec, s[86:87]
    ds_write_b64 v2, v[22:23]
    ds_write_b64 v3, v[20:21]
    s_mov_b64 exec, -1
    s_waitcnt vmcnt(5) lgkmcnt(8)
    s_mov_b64 exec, s[72:73]
    s_cbranch_execz F_s0
F_sp0:
    v_cmp_ne_u32 vcc, s88, v27
    s_cbranch_vccnz F_sa0
F_sg0:
    v_cmpx_lt_u32 vcc, 8, v56
    v_and_b32 v26, 0x7ff, v26
    v_lshl_add_u32 v26, v26, 5, v90
    v_or_b32 v27, 16, v26
    v_cmp_gt_i32 vcc, 0, v64
    v_and_b32 v64, 0x7fffffff, v64
    s_and_saveexec_b64 s[82:83], vcc
    s_cbranch_execz F_x0
    buffer_load_dword v95, v26, s[12:15], 0 offen
F_x0:
    s_mov_b64 exec, s[82:83]
    v_mad_u32_u16 v2, v64, 8, v76
    v_mad_u32_u16 v3, v64, 8, v76 op_sel:[1,0,0,0]
    ds_write_b64 v2, v[26:27]
    ds_write_b64 v3, v[24:25]
F_s0:
    s_mov_b64 exec, s[74:75]
    s_cbranch_execz F_s1
F_sp1:
    v_cmp_ne_u32 vcc, s88, v31
    s_cbranch_vccnz F_sa1
F_sg1:
    v_cmpx_lt_u32 vcc, 8, v57
    v_and_b32 v30, 0x7ff, v30
    v_lshl_add_u32 v30, v30, 5, v90
    v_add_u32 v30, 327680, v30
    v_or_b32 v31, 16, v30
    v_cmp_gt_i32 vcc, 0, v65
    v_and_b32 v65, 0x7fffffff, v65
    s_and_saveexec_b64 s[82:83], vcc
    s_cbranch_execz F_x1
    buffer_load_dword v95, v30, s[12:15], 0 offen
F_x1:
    s_mov_b64 exec, s[82:83]
    v_mad_u32_u16 v2, v65, 8, v77
    v_mad_u32_u16 v3, v65, 8, v77 op_sel:[1,0,0,0]
    ds_write_b64 v2, v[30:31]
    ds_write_b64 v3, v[28:29]
F_s1:
    s_mov_b64 exec, s[76:77]
    s_cbranch_execz F_s2
F_sp2:
    v_cmp_ne_u32 vcc, s88, v35
    s_cbranch_vccnz F_sa2
F_sg2:
    v_cmpx_lt_u32 vcc, 8, v58
    v_and_b32 v34, 0x7ff, v34
    v_lshl_add_u32 v34, v34, 5, v90
    v_add_u32 v34, 655360, v34
    v_or_b32 v35, 16, v34
    v_cmp_gt_i32 vcc, 0, v66
    v_and_b32 v66, 0x7fffffff, v66
    s_and_saveexec_b64 s[82:83], vcc
    s_cbranch_execz F_x2
    buffer_load_dword v95, v34, s[12:15], 0 offen
F_x2:
    s_mov_b64 exec, s[82:83]
    v_mad_u32_u16 v2, v66, 8, v78
    v_mad_u32_u16 v3, v66, 8, v78 op_sel:[1,0,0,0]
    ds_write_b64 v2, v[34:35]
    ds_write_b64 v3, v[32:33]
F_s2:
    s_mov_b64 exec, s[78:79]
    s_cbranch_execz F_s3
F_sp3:
    v_cmp_ne_u32 vcc, s88, v39
    s_cbranch_vccnz F_sa3
F_sg3:
    v_cmpx_lt_u32 vcc, 8, v59
    v_and_b32 v38, 0x7ff, v38
    v_lshl_add_u32 v38, v38, 5, v90
    v_add_u32 v38, 983040, v38
    v_or_b32 v39, 16, v38
    v_cmp_gt_i32 vcc, 0, v67
    v_and_b32 v67, 0x7fffffff, v67
    s_and_saveexec_b64 s[82:83], vcc
    s_cbranch_execz F_x3
    buffer_load_dword v95, v38, s[12:15], 0 offen
F_x3:
    s_mov_b64 exec, s[82:83]
    v_mad_u32_u16 v2, v67, 8, v79
    v_mad_u32_u16 v3, v67, 8, v79 op_sel:[1,0,0,0]
    ds_write_b64 v2, v[38:39]
    ds_write_b64 v3, v[36:37]
F_s3:
    s_mov_b64 exec, -1
    s_cmp_lg_u64 s[30:31], 0
    s_cbranch_scc1 F_u
F_ur:
    s_mov_b32 s27, s22
    s_and_b32 s66, s46, s33
    s_cselect_b32 s72, -1, 1
    s_cselect_b32 s76, s47, 163712
    s_cmp_ge_u32 s66, 2
    s_cselect_b32 s73, -1, 0
    s_add_u32 s77, s47, 1024
    s_cmp_ge_u32 s66, 4
    s_cselect_b32 s75, -1, 0
    s_cmp_ge_u32 s66, 3
    s_cselect_b32 s74, -1, 1
    s_cselect_b32 s77, s77, 163712
    s_mul_i32 s66, s20, 80
    v_min_u32 v2, 76, v248
    s_waitcnt lgkmcnt(0)
    s_barrier
    v_add_u32 v253, s47, v248
    ds_read_b32 v254, v253
    ds_read_b32 v255, v253 offset:256
    v_add_u32 v252, s42, v247
    ds_read2_b32 v[234:235], v252 offset0:0 offset1:16
    v_add_u32 v252, s43, v247
    ds_read2_b32 v[236:237], v252 offset0:0 offset1:16
    v_add_u32 v252, s44, v247
    ds_read2_b32 v[238:239], v252 offset0:0 offset1:16
    v_add_u32 v252, s45, v247
    ds_read2_b32 v[240:241], v252 offset0:0 offset1:16
    buffer_load_dword v3, v2, s[16:19], s66 offen offset:128 sc1
    v_add_u32 v249, s48, v249
    v_add_u32 v250, s49, v250
    s_waitcnt lgkmcnt(4)
    s_mov_b32 m0, s76
    s_mov_b64 exec, s[72:73]
    buffer_load_dwordx4 v254, s[12:15], 0 offen  lds
    s_mov_b32 m0, s77
    s_mov_b64 exec, s[74:75]
    buffer_load_dwordx4 v255, s[12:15], 0 offen  lds
    s_mov_b64 exec, -1
    s_waitcnt lgkmcnt(0)
    s_add_u32 m0, s21, 0
    v_mad_u32_u16 v234, v234, s3, v246 op_sel:[1,0,0,0]
    v_mad_u32_u16 v235, v235, s3, v246 op_sel:[1,0,0,0]
    buffer_load_dwordx4 v234, s[4:7], s38 offen  lds
    buffer_load_dwordx4 v235, s[8:11], s38 offen offset:1024  lds
    s_add_u32 m0, s21, 2048
    v_mad_u32_u16 v236, v236, s3, v246 op_sel:[1,0,0,0]
    v_mad_u32_u16 v237, v237, s3, v246 op_sel:[1,0,0,0]
    buffer_load_dwordx4 v236, s[4:7], s39 offen  lds
    buffer_load_dwordx4 v237, s[8:11], s39 offen offset:1024  lds
    s_add_u32 m0, s21, 4096
    v_mad_u32_u16 v238, v238, s3, v246 op_sel:[1,0,0,0]
    v_mad_u32_u16 v239, v239, s3, v246 op_sel:[1,0,0,0]
    buffer_load_dwordx4 v238, s[4:7], s40 offen  lds
    buffer_load_dwordx4 v239, s[8:11], s40 offen offset:1024  lds
    s_add_u32 m0, s21, 6144
    v_mad_u32_u16 v240, v240, s3, v246 op_sel:[1,0,0,0]
    v_mad_u32_u16 v241, v241, s3, v246 op_sel:[1,0,0,0]
    buffer_load_dwordx4 v240, s[4:7], s41 offen  lds
    buffer_load_dwordx4 v241, s[8:11], s41 offen offset:1024  lds
    v_lshrrev_b32 v8, 3, v84
    v_and_b32 v9, 7, v84
    v_lshlrev_b32 v9, 13, v9
    v_mul_u32_u24 v8, 1536, v8
    v_lshlrev_b32 v10, 4, v84
    v_and_b32 v5, 128, v10
    v_add3_u32 v8, v8, v9, v5
    v_xor_b32 v9, v10, v7
    v_and_b32 v9, 128, v9
    v_add_u32 v9, v9, v7
    v_mov_b32 v5, v9
    s_add_u32 s66, s20, 0
    v_cmp_eq_u32 vcc, s66, v84
    s_ff1_i32_b64 s67, vcc
    v_readlane_b32 s28, v5, s67
    s_add_u32 s66, s20, 8
    v_cmp_eq_u32 vcc, s66, v84
    s_ff1_i32_b64 s67, vcc
    v_readlane_b32 s29, v5, s67
    v_readlane_b32 s23, v6, s67
    s_add_u32 s66, s20, 16
    v_cmp_eq_u32 vcc, s66, v84
    s_ff1_i32_b64 s67, vcc
    v_readlane_b32 s30, v5, s67
    v_readlane_b32 s24, v6, s67
    s_add_u32 s66, s20, 24
    v_cmp_eq_u32 vcc, s66, v84
    s_ff1_i32_b64 s67, vcc
    v_readlane_b32 s31, v5, s67
    v_readlane_b32 s25, v6, s67
    s_add_u32 s66, s20, 32
    v_cmp_eq_u32 vcc, s66, v84
    s_ff1_i32_b64 s67, vcc
    v_readlane_b32 s32, v5, s67
    v_readlane_b32 s26, v6, s67
    v_lshlrev_b32 v4, 3, v84
    v_add_u32 v4, 163328, v4
    s_mov_b32 exec_hi, 0xff
    ds_write_b64 v4, v[8:9]
    s_mov_b32 exec_hi, -1
    s_waitcnt lgkmcnt(0)
    v_mov_b32 v252, 0
    s_waitcnt vmcnt(6)
    v_cmp_ne_u32 vcc, s88, v3
    ds_read_b64_tr_b16 v[176:177], v244 offset:0
    ds_read_b64_tr_b16 v[178:179], v244 offset:1024
    ds_read_b64_tr_b16 v[180:181], v245 offset:0
    ds_read_b64_tr_b16 v[182:183], v245 offset:1024
    ds_read_b64_tr_b16 v[72:73], v249 offset:0
    ds_read_b64_tr_b16 v[76:77], v249 offset:64
    ds_read_b64_tr_b16 v[74:75], v249 offset:256
    ds_read_b64_tr_b16 v[78:79], v249 offset:320
    s_mov_b64 exec, s[54:55]
    ds_read_u16_d16_hi v242, v250 offset:0
    s_mov_b64 exec, -1
    s_or_b32 s89, vcc_lo, vcc_hi
    s_add_u32 s53, s53, 4
    s_xor_b32 s66, s53, s20
    s_bitcmp1_b32 s66, 2
    s_setprio 1
    s_cbranch_scc1 PRIO_1
    s_setprio 0
PRIO_1:
    s_cmp_eq_u32 s52, 4
    s_cbranch_scc1 ITEM_0_4
    s_cmp_eq_u32 s52, 5
    s_cbranch_scc1 ITEM_0_5
    s_cmp_eq_u32 s52, 3
    s_cbranch_scc1 ITEM_0_3
    s_cmp_eq_u32 s52, 6
    s_cbranch_scc1 ITEM_0_6
    s_cmp_eq_u32 s52, 8
    s_cbranch_scc1 ITEM_0_8
    s_branch ITEM_0_2
F_again:
    s_sub_u32 s27, s27, 1
    s_cbranch_scc1 F_late
    s_cmp_eq_u64 s[72:73], 0
    s_cbranch_scc1 F_p0
    s_mov_b64 exec, s[72:73]
    s_cmp_gt_u32 s27, 4092
    s_cbranch_scc1 F_nd0
    v_mov_b32 v2, 0
    buffer_atomic_or v2, v86, s[16:19], s24 offen offset:12 sc1
    s_waitcnt vmcnt(0)
F_nd0:
    buffer_load_dwordx4 v[8:11], v86, s[16:19], s24 offen offset:0 sc1
    s_mov_b64 exec, -1
F_p0:
    s_cmp_eq_u64 s[74:75], 0
    s_cbranch_scc1 F_p1
    s_mov_b64 exec, s[74:75]
    s_cmp_gt_u32 s27, 4092
    s_cbranch_scc1 F_nd1
    v_mov_b32 v2, 0
    buffer_atomic_or v2, v86, s[16:19], s24 offen offset:1036 sc1
    s_waitcnt vmcnt(0)
F_nd1:
    buffer_load_dwordx4 v[12:15], v86, s[16:19], s24 offen offset:1024 sc1
    s_mov_b64 exec, -1
F_p1:
    s_cmp_eq_u64 s[76:77], 0
    s_cbranch_scc1 F_p2
    s_mov_b64 exec, s[76:77]
    s_cmp_gt_u32 s27, 4092
    s_cbranch_scc1 F_nd2
    v_mov_b32 v2, 0
    buffer_atomic_or v2, v86, s[16:19], s24 offen offset:2060 sc1
    s_waitcnt vmcnt(0)
F_nd2:
    buffer_load_dwordx4 v[16:19], v86, s[16:19], s24 offen offset:2048 sc1
    s_mov_b64 exec, -1
F_p2:
    s_cmp_eq_u64 s[78:79], 0
    s_cbranch_scc1 F_p3
    s_mov_b64 exec, s[78:79]
    s_cmp_gt_u32 s27, 4092
    s_cbranch_scc1 F_nd3
    v_mov_b32 v2, 0
    buffer_atomic_or v2, v86, s[16:19], s24 offen offset:3084 sc1
    s_waitcnt vmcnt(0)
F_nd3:
    buffer_load_dwordx4 v[20:23], v86, s[16:19], s24 offen offset:3072 sc1
    s_mov_b64 exec, -1
F_p3:
    s_branch F_poll
F_late:
    v_mov_b32 v2, 163064
    v_mov_b32 v4, 1000
    ds_write_b32 v2, v4
    v_mov_b32 v10, 0
    v_mov_b32 v14, 0
    v_mov_b32 v18, 0
    v_mov_b32 v22, 0
    s_branch F_got
F_l3:
    v_bfe_u32 v2, v10, 23, 5
    v_sub_u32 v56, v2, v91
    v_cmp_lt_u32 vcc, 16, v2
    s_mov_b64 exec, vcc
    s_cbranch_execz F_t0
F_tp0:
    buffer_load_dwordx4 v[40:43], v86, s[16:19], s26 offen offset:0 sc1
    s_waitcnt vmcnt(0)
    v_cmp_ne_u32 vcc, s88, v43
    s_sub_u32 s27, s27, 1
    s_cselect_b64 vcc, 0, vcc
    s_cmp_eq_u64 vcc, 0
    s_cbranch_scc0 F_tp0
    v_bfe_u32 v68, v42, 11, 6
    v_lshl_add_u32 v68, v68, 2, s71
    v_cmp_lt_i32 vcc, 16, v56
    s_mov_b64 exec, vcc
    ds_add_rtn_u32 v80, v68, v3
F_t0:
    s_mov_b64 exec, -1
    v_bfe_u32 v2, v14, 23, 5
    v_sub_u32 v57, v2, v91
    v_cmp_lt_u32 vcc, 16, v2
    s_mov_b64 exec, vcc
    s_cbranch_execz F_t1
F_tp1:
    buffer_load_dwordx4 v[44:47], v86, s[16:19], s26 offen offset:1024 sc1
    s_waitcnt vmcnt(0)
    v_cmp_ne_u32 vcc, s88, v47
    s_sub_u32 s27, s27, 1
    s_cselect_b64 vcc, 0, vcc
    s_cmp_eq_u64 vcc, 0
    s_cbranch_scc0 F_tp1
    v_bfe_u32 v69, v46, 11, 6
    v_lshl_add_u32 v69, v69, 2, s71
    v_cmp_lt_i32 vcc, 16, v57
    s_mov_b64 exec, vcc
    ds_add_rtn_u32 v81, v69, v3
F_t1:
    s_mov_b64 exec, -1
    v_bfe_u32 v2, v18, 23, 5
    v_sub_u32 v58, v2, v91
    v_cmp_lt_u32 vcc, 16, v2
    s_mov_b64 exec, vcc
    s_cbranch_execz F_t2
F_tp2:
    buffer_load_dwordx4 v[48:51], v86, s[16:19], s26 offen offset:2048 sc1
    s_waitcnt vmcnt(0)
    v_cmp_ne_u32 vcc, s88, v51
    s_sub_u32 s27, s27, 1
    s_cselect_b64 vcc, 0, vcc
    s_cmp_eq_u64 vcc, 0
    s_cbranch_scc0 F_tp2
    v_bfe_u32 v70, v50, 11, 6
    v_lshl_add_u32 v70, v70, 2, s71
    v_cmp_lt_i32 vcc, 16, v58
    s_mov_b64 exec, vcc
    ds_add_rtn_u32 v82, v70, v3
F_t2:
    s_mov_b64 exec, -1
    v_bfe_u32 v2, v22, 23, 5
    v_sub_u32 v59, v2, v91
    v_cmp_lt_u32 vcc, 16, v2
    s_mov_b64 exec, vcc
    s_cbranch_execz F_t3
F_tp3:
    buffer_load_dwordx4 v[52:55], v86, s[16:19], s26 offen offset:3072 sc1
    s_waitcnt vmcnt(0)
    v_cmp_ne_u32 vcc, s88, v55
    s_sub_u32 s27, s27, 1
    s_cselect_b64 vcc, 0, vcc
    s_cmp_eq_u64 vcc, 0
    s_cbranch_scc0 F_tp3
    v_bfe_u32 v71, v54, 11, 6
    v_lshl_add_u32 v71, v71, 2, s71
    v_cmp_lt_i32 vcc, 16, v59
    s_mov_b64 exec, vcc
    ds_add_rtn_u32 v83, v71, v3
F_t3:
    s_mov_b64 exec, -1
    v_mov_b32 v2, 163068
    v_mov_b32 v4, 1000
    v_cmp_lt_u32 vcc, 24, v89
    s_mov_b64 exec, vcc
    ds_write_b32 v2, v4
    s_mov_b64 exec, -1
    s_branch F_l3r
F_flag:
    s_lshl_b32 s66, s2, 2
    v_mov_b32 v2, 128
    v_mov_b32 v4, s88
    s_mov_b64 exec, 1
    buffer_store_dword v4, v2, s[16:19], s66 offen sc1
    s_mov_b64 exec, -1
    s_branch F_flagr
F_sa0:
    s_sub_u32 s27, s27, 1
    s_cbranch_scc1 F_sg0
    buffer_load_dwordx4 v[24:27], v86, s[16:19], s25 offen offset:0 sc1
    s_waitcnt vmcnt(0)
    s_branch F_sp0
F_sa1:
    s_sub_u32 s27, s27, 1
    s_cbranch_scc1 F_sg1
    buffer_load_dwordx4 v[28:31], v86, s[16:19], s25 offen offset:1024 sc1
    s_waitcnt vmcnt(0)
    s_branch F_sp1
F_sa2:
    s_sub_u32 s27, s27, 1
    s_cbranch_scc1 F_sg2
    buffer_load_dwordx4 v[32:35], v86, s[16:19], s25 offen offset:2048 sc1
    s_waitcnt vmcnt(0)
    s_branch F_sp2
F_sa3:
    s_sub_u32 s27, s27, 1
    s_cbranch_scc1 F_sg3
    buffer_load_dwordx4 v[36:39], v86, s[16:19], s25 offen offset:3072 sc1
    s_waitcnt vmcnt(0)
    s_branch F_sp3
F_u:
    ds_bpermute_b32 v68, v68, v92
    ds_bpermute_b32 v69, v69, v92
    ds_bpermute_b32 v70, v70, v92
    ds_bpermute_b32 v71, v71, v92
    s_waitcnt lgkmcnt(0)
    v_cmp_lt_i32 vcc, 16, v56
    s_mov_b64 exec, vcc
    s_cbranch_execz F_u0
    v_and_b32 v42, 0x7ff, v42
    v_lshl_add_u32 v42, v42, 5, v90
    v_or_b32 v43, 16, v42
    v_and_b32 v68, 0x7fffffff, v68
    v_mad_u32_u16 v2, v68, 8, v80
    v_mad_u32_u16 v3, v68, 8, v80 op_sel:[1,0,0,0]
    ds_write_b64 v2, v[42:43]
    ds_write_b64 v3, v[40:41]
F_u0:
    s_mov_b64 exec, -1
    v_cmp_lt_i32 vcc, 16, v57
    s_mov_b64 exec, vcc
    s_cbranch_execz F_u1
    v_and_b32 v46, 0x7ff, v46
    v_lshl_add_u32 v46, v46, 5, v90
    v_add_u32 v46, 327680, v46
    v_or_b32 v47, 16, v46
    v_and_b32 v69, 0x7fffffff, v69
    v_mad_u32_u16 v2, v69, 8, v81
    v_mad_u32_u16 v3, v69, 8, v81 op_sel:[1,0,0,0]
    ds_write_b64 v2, v[46:47]
    ds_write_b64 v3, v[44:45]
F_u1:
    s_mov_b64 exec, -1
    v_cmp_lt_i32 vcc, 16, v58
    s_mov_b64 exec, vcc
    s_cbranch_execz F_u2
    v_and_b32 v50, 0x7ff, v50
    v_lshl_add_u32 v50, v50, 5, v90
    v_add_u32 v50, 655360, v50
    v_or_b32 v51, 16, v50
    v_and_b32 v70, 0x7fffffff, v70
    v_mad_u32_u16 v2, v70, 8, v82
    v_mad_u32_u16 v3, v70, 8, v82 op_sel:[1,0,0,0]
    ds_write_b64 v2, v[50:51]
    ds_write_b64 v3, v[48:49]
F_u2:
    s_mov_b64 exec, -1
    v_cmp_lt_i32 vcc, 16, v59
    s_mov_b64 exec, vcc
    s_cbranch_execz F_u3
    v_and_b32 v54, 0x7ff, v54
    v_lshl_add_u32 v54, v54, 5, v90
    v_add_u32 v54, 983040, v54
    v_or_b32 v55, 16, v54
    v_and_b32 v71, 0x7fffffff, v71
    v_mad_u32_u16 v2, v71, 8, v83
    v_mad_u32_u16 v3, v71, 8, v83 op_sel:[1,0,0,0]
    ds_write_b64 v2, v[54:55]
    ds_write_b64 v3, v[52:53]
F_u3:
    s_mov_b64 exec, -1
    s_branch F_ur
LAST0:
    s_cmp_eq_u32 s50, 5
    s_cbranch_scc1 TO_PHASE1
    s_add_u32 s4, s4, 128
    s_addc_u32 s5, s5, 0
    s_add_u32 s8, s8, 128
    s_addc_u32 s9, s9, 0
    s_mov_b32 s34, 0
    s_mov_b32 s35, 256
    s_mov_b32 s36, 512
    s_mov_b32 s37, 768
    s_mov_b32 s33, 0
    s_add_u32 s53, s53, 4
    s_xor_b32 s66, s53, s20
    s_bitcmp1_b32 s66, 2
    s_setprio 1
    s_cbranch_scc1 PRIO_2
    s_setprio 0
PRIO_2:
    s_cmp_eq_u32 s52, 4
    s_cbranch_scc1 ITEM_0_4
    s_cmp_eq_u32 s52, 5
    s_cbranch_scc1 ITEM_0_5
    s_cmp_eq_u32 s52, 3
    s_cbranch_scc1 ITEM_0_3
    s_cmp_eq_u32 s52, 6
    s_cbranch_scc1 ITEM_0_6
    s_cmp_eq_u32 s52, 8
    s_cbranch_scc1 ITEM_0_8
    s_branch ITEM_0_2
TO_PHASE1:
    ds_read_b32 v252, v251 offset:16
    v_bfe_u32 v253, v248, 5, 1
    v_bfe_u32 v255, v248, 7, 1
    v_lshl_or_b32 v254, v255, 1, v253
    v_lshl_or_b32 v253, v255, 2, v253
    v_mul_u32_u24 v253, 1280, v253
    v_xor_b32 v254, 2, v254
    v_lshl_add_u32 v253, v254, 6, v253
    v_bfe_u32 v255, v248, 6, 1
    v_lshl_add_u32 v253, v255, 5, v253
    v_and_b32 v255, 12, v248
    v_lshl_add_u32 v253, v255, 1, v253
    v_and_b32 v255, 16, v248
    v_xor_b32 v255, 16, v255
    v_lshl_add_u32 v253, v255, 13, v253
    v_add_u32 v253, 65536, v253
    v_xor_b32 v254, 64, v253
    ds_read_b64_tr_b16 v[96:97], v253 offset:0
    ds_read_b64_tr_b16 v[98:99], v253 offset:2560
    ds_read_b64_tr_b16 v[100:101], v253 offset:10240
    ds_read_b64_tr_b16 v[102:103], v253 offset:12800
    ds_read_b64_tr_b16 v[104:105], v254 offset:0
    ds_read_b64_tr_b16 v[106:107], v254 offset:2560
    ds_read_b64_tr_b16 v[108:109], v254 offset:10240
    ds_read_b64_tr_b16 v[110:111], v254 offset:12800
    ds_read_b64_tr_b16 v[128:129], v253 offset:512
    ds_read_b64_tr_b16 v[130:131], v253 offset:3072
    ds_read_b64_tr_b16 v[132:133], v253 offset:10752
    ds_read_b64_tr_b16 v[134:135], v253 offset:13312
    ds_read_b64_tr_b16 v[136:137], v254 offset:512
    ds_read_b64_tr_b16 v[138:139], v254 offset:3072
    ds_read_b64_tr_b16 v[140:141], v254 offset:10752
    ds_read_b64_tr_b16 v[142:143], v254 offset:13312
    ds_read_b64_tr_b16 v[144:145], v253 offset:768
    ds_read_b64_tr_b16 v[146:147], v253 offset:3328
    ds_read_b64_tr_b16 v[148:149], v253 offset:11008
    ds_read_b64_tr_b16 v[150:151], v253 offset:13568
    ds_read_b64_tr_b16 v[152:153], v254 offset:768
    ds_read_b64_tr_b16 v[154:155], v254 offset:3328
    ds_read_b64_tr_b16 v[156:157], v254 offset:11008
    ds_read_b64_tr_b16 v[158:159], v254 offset:13568
    ds_read_b64_tr_b16 v[160:161], v253 offset:1024
    ds_read_b64_tr_b16 v[162:163], v253 offset:3584
    ds_read_b64_tr_b16 v[164:165], v253 offset:11264
    ds_read_b64_tr_b16 v[166:167], v253 offset:13824
    ds_read_b64_tr_b16 v[168:169], v254 offset:1024
    ds_read_b64_tr_b16 v[170:171], v254 offset:3584
    ds_read_b64_tr_b16 v[172:173], v254 offset:11264
    ds_read_b64_tr_b16 v[174:175], v254 offset:13824
    ds_read_b64_tr_b16 v[112:113], v253 offset:256
    ds_read_b64_tr_b16 v[114:115], v253 offset:2816
    ds_read_b64_tr_b16 v[116:117], v253 offset:10496
    ds_read_b64_tr_b16 v[118:119], v253 offset:13056
    ds_read_b64_tr_b16 v[120:121], v254 offset:256
    ds_read_b64_tr_b16 v[122:123], v254 offset:2816
    ds_read_b64_tr_b16 v[124:125], v254 offset:10496
    ds_read_b64_tr_b16 v[126:127], v254 offset:13056
    s_lshl_b32 s66, s20, 4
    v_xor_b32 v248, s66, v248
    s_mov_b32 s34, 128
    s_mov_b32 s35, 384
    s_mov_b32 s36, 640
    s_mov_b32 s37, 896
    s_mov_b32 s50, 0
    s_mov_b64 vcc, 0
    s_waitcnt lgkmcnt(0)
    s_waitcnt lgkmcnt(0)
    v_readfirstlane_b32 s66, v252
    s_add_u32 s53, s53, 1
    v_mov_b32 v252, s53
    s_cmp_le_u32 s53, s66
    ds_write2_b32 v251, v252, v252 offset0:0 offset1:8
    s_setprio 1
    s_cbranch_scc1 PRIO_3
    s_setprio 0
PRIO_3:
    s_cmp_eq_u32 s52, 4
    s_cbranch_scc1 ITEM_1_4
    s_cmp_eq_u32 s52, 5
    s_cbranch_scc1 ITEM_1_5
    s_cmp_eq_u32 s52, 3
    s_cbranch_scc1 ITEM_1_3
    s_cmp_eq_u32 s52, 6
    s_cbranch_scc1 ITEM_1_6
    s_cmp_eq_u32 s52, 8
    s_cbranch_scc1 ITEM_1_8
    s_branch ITEM_1_2
LAST1:
    s_cmp_eq_u32 s89, 0
    s_cbranch_scc1 T_flagsL
    s_mul_i32 s66, s20, 80
    v_min_u32 v2, 76, v248
    s_mov_b32 s67, 262144
T_pollL:
    buffer_load_dword v3, v2, s[16:19], s66 offen offset:128 sc1
    s_waitcnt vmcnt(0)
    v_cmp_ne_u32 vcc, s88, v3
    s_sub_u32 s67, s67, 1
    s_cselect_b64 vcc, 0, vcc
    s_cmp_eq_u64 vcc, 0
    s_cbranch_scc0 T_pollL
    s_mov_b32 s89, 0
T_flagsL:
    s_lshl_b32 s66, s20, 4
    v_xor_b32 v246, s66, v248
    v_lshlrev_b32 v246, 2, v246
    s_mul_i32 s51, s20, 20480
    s_add_u32 s51, s51, 1024
    s_mov_b64 vcc, -1
    s_load_dwordx2 s[72:73], s[0:1], 72
    s_waitcnt lgkmcnt(7)
    v_readfirstlane_b32 s66, v252
    s_add_u32 s53, s53, 1
    v_mov_b32 v252, s53
    s_cmp_le_u32 s53, s66
    ds_write2_b32 v251, v252, v252 offset0:0 offset1:8
    s_setprio 3
    s_cbranch_scc1 PRIO_4
    s_setprio 2
PRIO_4:
    s_cmp_eq_u32 s52, 4
    s_cbranch_scc1 ITEM_1_4
    s_cmp_eq_u32 s52, 5
    s_cbranch_scc1 ITEM_1_5
    s_cmp_eq_u32 s52, 3
    s_cbranch_scc1 ITEM_1_3
    s_cmp_eq_u32 s52, 6
    s_cbranch_scc1 ITEM_1_6
    s_cmp_eq_u32 s52, 8
    s_cbranch_scc1 ITEM_1_8
    s_branch ITEM_1_2
.p2align 6
ITEM_0_4:
    s_mov_b64 exec, s[54:55]
    ds_read_u16_d16_hi v243, v250 offset:128
    s_mov_b64 exec, -1
    ds_read_b64_tr_b16 v[80:81], v249 offset:512
    ds_read_b64_tr_b16 v[84:85], v249 offset:576
    ds_read_b64_tr_b16 v[82:83], v249 offset:768
    ds_read_b64_tr_b16 v[86:87], v249 offset:832
    s_waitcnt lgkmcnt(5)
    v_mul_f32_dpp v196, v242, v72 row_newbcast:0 row_mask:0xf bank_mask:0xf
    v_mul_f32_dpp v197, v242, v73 row_newbcast:1 row_mask:0xf bank_mask:0xf
    v_mul_f32_dpp v198, v242, v72 row_newbcast:8 row_mask:0xf bank_mask:0xf
    v_mul_f32_dpp v199, v242, v73 row_newbcast:9 row_mask:0xf bank_mask:0xf
    v_mul_f32_dpp v200, v242, v76 row_newbcast:2 row_mask:0xf bank_mask:0xf
    v_mul_f32_dpp v201, v242, v77 row_newbcast:3 row_mask:0xf bank_mask:0xf
    v_mul_f32_dpp v202, v242, v76 row_newbcast:10 row_mask:0xf bank_mask:0xf
    v_mul_f32_dpp v203, v242, v77 row_newbcast:11 row_mask:0xf bank_mask:0xf
    v_cvt_pk_bf16_f32 v72, v196, v197
    v_cvt_pk_bf16_f32 v76, v198, v199
    v_cvt_pk_bf16_f32 v73, v200, v201
    v_cvt_pk_bf16_f32 v77, v202, v203
    v_mul_f32_dpp v196, v242, v74 row_newbcast:4 row_mask:0xf bank_mask:0xf
    v_mul_f32_dpp v197, v242, v75 row_newbcast:5 row_mask:0xf bank_mask:0xf
    v_mul_f32_dpp v198, v242, v74 row_newbcast:12 row_mask:0xf bank_mask:0xf
    v_mul_f32_dpp v199, v242, v75 row_newbcast:13 row_mask:0xf bank_mask:0xf
    v_mul_f32_dpp v200, v242, v78 row_newbcast:6 row_mask:0xf bank_mask:0xf
    v_mul_f32_dpp v201, v242, v79 row_newbcast:7 row_mask:0xf bank_mask:0xf
    v_mul_f32_dpp v202, v242, v78 row_newbcast:14 row_mask:0xf bank_mask:0xf
    v_mul_f32_dpp v203, v242, v79 row_newbcast:15 row_mask:0xf bank_mask:0xf
    v_cvt_pk_bf16_f32 v74, v196, v197
    v_cvt_pk_bf16_f32 v78, v198, v199
    v_cvt_pk_bf16_f32 v75, v200, v201
    v_cvt_pk_bf16_f32 v79, v202, v203
    s_waitcnt vmcnt(4) lgkmcnt(0)
    v_mfma_f32_32x32x16_bf16 v[56:71], v[72:75], v[176:179], 0
    v_mul_f32_dpp v196, v243, v80 row_newbcast:0 row_mask:0xf bank_mask:0xf
    v_mul_f32_dpp v197, v243, v81 row_newbcast:1 row_mask:0xf bank_mask:0xf
    v_mul_f32_dpp v198, v243, v80 row_newbcast:8 row_mask:0xf bank_mask:0xf
    v_mul_f32_dpp v199, v243, v81 row_newbcast:9 row_mask:0xf bank_mask:0xf
    v_mul_f32_dpp v200, v243, v84 row_newbcast:2 row_mask:0xf bank_mask:0xf
    v_mul_f32_dpp v201, v243, v85 row_newbcast:3 row_mask:0xf bank_mask:0xf
    s_add_u32 m0, s21, 0
    v_mfma_f32_32x32x16_bf16 v[16:31], v[76:79], v[176:179], 0
    buffer_load_dwordx4 v234, s[4:7], s36 offen  lds
    buffer_load_dwordx4 v235, s[8:11], s36 offen offset:1024  lds
    ds_read_b64_tr_b16 v[176:177], v244 offset:2048
    ds_read_b64_tr_b16 v[178:179], v244 offset:3072
    ds_read_b64_tr_b16 v[184:185], v245 offset:2048
    ds_read_b64_tr_b16 v[186:187], v245 offset:3072
    v_mul_f32_dpp v202, v243, v84 row_newbcast:10 row_mask:0xf bank_mask:0xf
    v_mul_f32_dpp v203, v243, v85 row_newbcast:11 row_mask:0xf bank_mask:0xf
    v_cvt_pk_bf16_f32 v80, v196, v197
    v_cvt_pk_bf16_f32 v84, v198, v199
    v_cvt_pk_bf16_f32 v81, v200, v201
    v_cvt_pk_bf16_f32 v85, v202, v203
    v_mul_f32_dpp v196, v243, v82 row_newbcast:4 row_mask:0xf bank_mask:0xf
    v_mul_f32_dpp v197, v243, v83 row_newbcast:5 row_mask:0xf bank_mask:0xf
    v_mul_f32_dpp v198, v243, v82 row_newbcast:12 row_mask:0xf bank_mask:0xf
    v_mul_f32_dpp v199, v243, v83 row_newbcast:13 row_mask:0xf bank_mask:0xf
    v_mul_f32_dpp v200, v243, v86 row_newbcast:6 row_mask:0xf bank_mask:0xf
    v_mul_f32_dpp v201, v243, v87 row_newbcast:7 row_mask:0xf bank_mask:0xf
    v_mul_f32_dpp v202, v243, v86 row_newbcast:14 row_mask:0xf bank_mask:0xf
    v_mul_f32_dpp v203, v243, v87 row_newbcast:15 row_mask:0xf bank_mask:0xf
    v_cvt_pk_bf16_f32 v82, v196, v197
    v_cvt_pk_bf16_f32 v86, v198, v199
    v_cvt_pk_bf16_f32 v83, v200, v201
    v_cvt_pk_bf16_f32 v87, v202, v203
    s_waitcnt lgkmcnt(0)
    v_mfma_f32_32x32x16_bf16 v[56:71], v[80:83], v[176:179], v[56:71]
    s_add_u32 m0, s21, 2048
    v_mfma_f32_32x32x16_bf16 v[16:31], v[84:87], v[176:179], v[16:31]
    buffer_load_dwordx4 v236, s[4:7], s36 offen  lds
    buffer_load_dwordx4 v237, s[8:11], s36 offen offset:1024  lds
    s_mov_b32 m0, s50
    s_nop 0
    s_movrels_b32 s71, s23
    s_bfe_u32 s46, s71, 0x30012
    s_mov_b32 m0, s46
    s_and_b32 s66, s71, 0x3ffff
    s_movrels_b32 s68, s57
    s_movrels_b32 s69, s61
    s_sub_u32 s48, s66, s47
    s_mov_b32 s47, s66
    s_lshr_b32 s52, s71, 28
    s_lshl_b32 s67, s46, 9
    s_add_u32 s66, s66, s67
    s_sub_u32 s49, s66, s42
    s_mov_b32 s42, s66
    s_bfe_u32 s66, s68, 655360
    s_add_u32 s43, s42, s66
    s_bfe_u32 s39, s69, 655360
    s_bfe_u32 s66, s68, 655370
    s_add_u32 s44, s42, s66
    s_bfe_u32 s40, s69, 655370
    s_bfe_u32 s66, s68, 655380
    s_add_u32 s45, s42, s66
    s_bfe_u32 s41, s69, 655380
    s_and_b32 s66, s46, s33
    s_cselect_b32 s72, -1, 1
    s_cselect_b32 s76, s47, 163712
    s_cmp_ge_u32 s66, 2
    s_cselect_b32 s73, -1, 0
    s_add_u32 s77, s47, 1024
    s_cmp_ge_u32 s66, 4
    s_cselect_b32 s75, -1, 0
    s_cmp_ge_u32 s66, 3
    s_cselect_b32 s74, -1, 1
    s_cselect_b32 s77, s77, 163712
    v_add_u32 v252, s44, v247
    ds_read2_b32 v[238:239], v252 offset0:0 offset1:16
    v_add_u32 v252, s45, v247
    ds_read2_b32 v[240:241], v252 offset0:0 offset1:16
    v_mfma_f32_32x32x16_bf16 v[32:47], v[72:75], v[180:183], 0
    v_mul_f32 v196, v56, v96
    v_fmac_f32 v196, v57, v97
    v_fmac_f32 v196, v58, v98
    v_fmac_f32 v196, v59, v99
    v_fmac_f32 v196, v60, v100
    v_fmac_f32 v196, v61, v101
    v_mfma_f32_32x32x16_bf16 v[0:15], v[76:79], v[180:183], 0
    s_waitcnt vmcnt(6)
    ds_read_b64_tr_b16 v[176:177], v244 offset:4096
    ds_read_b64_tr_b16 v[178:179], v244 offset:5120
    ds_read_b64_tr_b16 v[180:181], v245 offset:4096
    ds_read_b64_tr_b16 v[182:183], v245 offset:5120
    v_fmac_f32 v196, v62, v102
    v_fmac_f32 v196, v63, v103
    v_mfma_f32_32x32x16_bf16 v[32:47], v[80:83], v[184:187], v[32:47]
    v_mul_f32 v198, v64, v128
    v_fmac_f32 v198, v65, v129
    v_fmac_f32 v198, v66, v130
    v_fmac_f32 v198, v67, v131
    v_fmac_f32 v198, v68, v132
    v_fmac_f32 v198, v69, v133
    v_mfma_f32_32x32x16_bf16 v[0:15], v[84:87], v[184:187], v[0:15]
    v_fmac_f32 v198, v70, v134
    v_fmac_f32 v198, v71, v135
    v_mul_f32 v200, v16, v128
    v_fmac_f32 v200, v17, v129
    v_permlane32_swap_b32 v196, v198
    v_fmac_f32 v200, v18, v130
    v_fmac_f32 v200, v19, v131
    v_fmac_f32 v200, v20, v132
    v_fmac_f32 v200, v21, v133
    v_fmac_f32 v200, v22, v134
    v_fmac_f32 v200, v23, v135
    v_add_f32 v198, v196, v198
    v_mul_f32_e64 v202, v24, -v128
    v_fma_f32 v202, v25, -v129, v202
    v_fma_f32 v202, v26, -v130, v202
    v_fma_f32 v202, v27, -v131, v202
    v_fma_f32 v202, v28, -v132, v202
    v_fma_f32 v202, v29, -v133, v202
    v_fma_f32 v202, v30, -v134, v202
    v_fma_f32 v202, v31, -v135, v202
    s_nop 1
    v_permlane32_swap_b32 v200, v202
    v_add_f32 v202, v200, v202
    s_waitcnt vmcnt(4) lgkmcnt(0)
    v_mfma_f32_32x32x16_bf16 v[56:71], v[72:75], v[176:179], 0
    v_mul_f32 v197, v32, v104
    v_fmac_f32 v197, v33, v105
    v_fmac_f32 v197, v34, v106
    v_fmac_f32 v197, v35, v107
    v_fmac_f32 v197, v36, v108
    v_fmac_f32 v197, v37, v109
    s_add_u32 m0, s21, 4096
    v_mfma_f32_32x32x16_bf16 v[16:31], v[76:79], v[176:179], 0
    buffer_load_dwordx4 v234, s[4:7], s37 offen  lds
    buffer_load_dwordx4 v235, s[8:11], s37 offen offset:1024  lds
    ds_read_b64_tr_b16 v[176:177], v244 offset:6144
    ds_read_b64_tr_b16 v[178:179], v244 offset:7168
    ds_read_b64_tr_b16 v[184:185], v245 offset:6144
    ds_read_b64_tr_b16 v[186:187], v245 offset:7168
    v_add_u32 v252, s42, v247
    ds_read2_b32 v[234:235], v252 offset0:0 offset1:16
    v_fmac_f32 v197, v38, v110
    v_fmac_f32 v197, v39, v111
    v_mul_f32 v199, v40, v136
    v_fmac_f32 v199, v41, v137
    v_fmac_f32 v199, v42, v138
    v_fmac_f32 v199, v43, v139
    v_fmac_f32 v199, v44, v140
    v_fmac_f32 v199, v45, v141
    v_fmac_f32 v199, v46, v142
    v_fmac_f32 v199, v47, v143
    v_mul_f32 v201, v0, v136
    v_fmac_f32 v201, v1, v137
    v_permlane32_swap_b32 v197, v199
    v_fmac_f32 v201, v2, v138
    v_fmac_f32 v201, v3, v139
    v_fmac_f32 v201, v4, v140
    v_fmac_f32 v201, v5, v141
    v_fmac_f32 v201, v6, v142
    v_fmac_f32 v201, v7, v143
    v_add_f32 v199, v197, v199
    v_mul_f32_e64 v203, v8, -v136
    v_fma_f32 v203, v9, -v137, v203
    v_fma_f32 v203, v10, -v138, v203
    v_fma_f32 v203, v11, -v139, v203
    s_waitcnt lgkmcnt(1)
    v_mfma_f32_32x32x16_bf16 v[56:71], v[80:83], v[176:179], v[56:71]
    v_fma_f32 v203, v12, -v140, v203
    v_fma_f32 v203, v13, -v141, v203
    v_fma_f32 v203, v14, -v142, v203
    v_fma_f32 v203, v15, -v143, v203
    s_nop 1
    v_permlane32_swap_b32 v201, v203
    v_add_f32 v203, v201, v203
    s_add_u32 m0, s21, 6144
    v_mfma_f32_32x32x16_bf16 v[16:31], v[84:87], v[176:179], v[16:31]
    buffer_load_dwordx4 v236, s[4:7], s37 offen  lds
    buffer_load_dwordx4 v237, s[8:11], s37 offen offset:1024  lds
    v_add_u32 v252, s43, v247
    ds_read2_b32 v[236:237], v252 offset0:0 offset1:16
    s_set_gpr_idx_on s51, gpr_idx(DST)
    s_nop 0
    v_cvt_pk_bf16_f32 v204, v198, v199
    v_cvt_pk_bf16_f32 v205, v202, v203
    s_set_gpr_idx_off
    v_mfma_f32_32x32x16_bf16 v[32:47], v[72:75], v[180:183], 0
    v_mul_f32 v196, v56, v144
    v_fmac_f32 v196, v57, v145
    v_fmac_f32 v196, v58, v146
    v_fmac_f32 v196, v59, v147
    v_fmac_f32 v196, v60, v148
    v_fmac_f32 v196, v61, v149
    v_mfma_f32_32x32x16_bf16 v[0:15], v[76:79], v[180:183], 0
    s_waitcnt vmcnt(6)
    ds_read_b64_tr_b16 v[176:177], v244 offset:0
    ds_read_b64_tr_b16 v[178:179], v244 offset:1024
    ds_read_b64_tr_b16 v[180:181], v245 offset:0
    ds_read_b64_tr_b16 v[182:183], v245 offset:1024
    v_fmac_f32 v196, v62, v150
    v_fmac_f32 v196, v63, v151
    v_mfma_f32_32x32x16_bf16 v[32:47], v[80:83], v[184:187], v[32:47]
    v_mul_f32_e64 v200, v16, -v160
    v_fma_f32 v200, v17, -v161, v200
    v_fma_f32 v200, v18, -v162, v200
    v_fma_f32 v200, v19, -v163, v200
    v_fma_f32 v200, v20, -v164, v200
    v_fma_f32 v200, v21, -v165, v200
    v_mfma_f32_32x32x16_bf16 v[0:15], v[84:87], v[184:187], v[0:15]
    v_fma_f32 v200, v22, -v166, v200
    v_fma_f32 v200, v23, -v167, v200
    v_mul_f32_e64 v202, v24, -v160
    v_fma_f32 v202, v25, -v161, v202
    v_fma_f32 v202, v26, -v162, v202
    v_fma_f32 v202, v27, -v163, v202
    v_fma_f32 v202, v28, -v164, v202
    v_fma_f32 v202, v29, -v165, v202
    v_fma_f32 v202, v30, -v166, v202
    v_fma_f32 v202, v31, -v167, v202
    s_waitcnt vmcnt(4) lgkmcnt(0)
    v_mfma_f32_32x32x16_bf16 v[16:31], v[72:75], v[176:179], 0
    v_mul_f32 v197, v32, v152
    v_fmac_f32 v197, v33, v153
    v_fmac_f32 v197, v34, v154
    v_fmac_f32 v197, v35, v155
    v_fmac_f32 v197, v36, v156
    v_fmac_f32 v197, v37, v157
    s_add_u32 m0, s21, 0
    v_mfma_f32_32x32x16_bf16 v[48:63], v[76:79], v[176:179], 0
    v_mad_u32_u16 v234, v234, s3, v246 op_sel:[1,0,0,0]
    v_mad_u32_u16 v235, v235, s3, v246 op_sel:[1,0,0,0]
    buffer_load_dwordx4 v234, s[4:7], s38 offen  lds
    buffer_load_dwordx4 v235, s[8:11], s38 offen offset:1024  lds
    ds_read_b64_tr_b16 v[176:177], v244 offset:2048
    ds_read_b64_tr_b16 v[178:179], v244 offset:3072
    ds_read_b64_tr_b16 v[184:185], v245 offset:2048
    ds_read_b64_tr_b16 v[186:187], v245 offset:3072
    v_fmac_f32 v197, v38, v158
    v_fmac_f32 v197, v39, v159
    v_mul_f32_e64 v201, v0, -v168
    v_fma_f32 v201, v1, -v169, v201
    v_fma_f32 v201, v2, -v170, v201
    v_fma_f32 v201, v3, -v171, v201
    v_fma_f32 v201, v4, -v172, v201
    v_fma_f32 v201, v5, -v173, v201
    v_fma_f32 v201, v6, -v174, v201
    v_fma_f32 v201, v7, -v175, v201
    s_waitcnt lgkmcnt(0)
    v_mfma_f32_32x32x16_bf16 v[16:31], v[80:83], v[176:179], v[16:31]
    v_mul_f32_e64 v203, v8, -v168
    v_fma_f32 v203, v9, -v169, v203
    v_fma_f32 v203, v10, -v170, v203
    v_fma_f32 v203, v11, -v171, v203
    v_fma_f32 v203, v12, -v172, v203
    v_fma_f32 v203, v13, -v173, v203
    s_add_u32 m0, s21, 2048
    v_mfma_f32_32x32x16_bf16 v[48:63], v[84:87], v[176:179], v[48:63]
    v_mad_u32_u16 v236, v236, s3, v246 op_sel:[1,0,0,0]
    v_mad_u32_u16 v237, v237, s3, v246 op_sel:[1,0,0,0]
    buffer_load_dwordx4 v236, s[4:7], s39 offen  lds
    buffer_load_dwordx4 v237, s[8:11], s39 offen offset:1024  lds
    v_fma_f32 v203, v14, -v174, v203
    v_fma_f32 v203, v15, -v175, v203
    v_mfma_f32_32x32x16_bf16 v[0:15], v[72:75], v[180:183], 0
    v_fmac_f32 v200, v24, v160
    v_fmac_f32 v200, v25, v161
    v_fmac_f32 v200, v26, v162
    v_fmac_f32 v200, v27, v163
    v_fmac_f32 v200, v28, v164
    v_fmac_f32 v200, v29, v165
    v_fmac_f32 v200, v30, v166
    v_fmac_f32 v200, v31, v167
    v_mfma_f32_32x32x16_bf16 v[24:39], v[76:79], v[180:183], 0
    v_add_u32 v253, s47, v248
    ds_read_b32 v192, v253
    ds_read_b32 v193, v253 offset:256
    s_waitcnt vmcnt(6)
    ds_read_b64_tr_b16 v[176:177], v244 offset:4096
    ds_read_b64_tr_b16 v[178:179], v244 offset:5120
    ds_read_b64_tr_b16 v[180:181], v245 offset:4096
    ds_read_b64_tr_b16 v[182:183], v245 offset:5120
    v_mfma_f32_32x32x16_bf16 v[24:39], v[84:87], v[184:187], v[24:39]
    v_mul_f32 v254, v16, v144
    v_fmac_f32 v254, v17, v145
    v_fmac_f32 v254, v18, v146
    v_fmac_f32 v254, v19, v147
    v_fmac_f32 v254, v20, v148
    v_fmac_f32 v254, v21, v149
    v_mfma_f32_32x32x16_bf16 v[0:15], v[80:83], v[184:187], v[0:15]
    v_fmac_f32 v254, v22, v150
    v_fmac_f32 v254, v23, v151
    v_sub_f32_e64 v64, -v48, v64
    v_sub_f32_e64 v65, -v49, v65
    v_permlane32_swap_b32 v196, v254
    v_sub_f32_e64 v66, -v50, v66
    v_sub_f32_e64 v67, -v51, v67
    v_sub_f32_e64 v68, -v52, v68
    v_sub_f32_e64 v69, -v53, v69
    v_sub_f32_e64 v70, -v54, v70
    v_sub_f32_e64 v71, -v55, v71
    v_add_f32 v254, v196, v254
    s_waitcnt vmcnt(4) lgkmcnt(0)
    v_mfma_f32_32x32x16_bf16 v[56:71], v[76:79], v[176:179], v[56:71]
    v_sub_f32_e64 v40, -v24, v40
    v_sub_f32_e64 v41, -v25, v41
    v_sub_f32_e64 v42, -v26, v42
    v_sub_f32_e64 v43, -v27, v43
    v_sub_f32_e64 v44, -v28, v44
    v_sub_f32_e64 v45, -v29, v45
    v_sub_f32_e64 v46, -v30, v46
    v_sub_f32_e64 v47, -v31, v47
    s_mov_b32 m0, s76
    s_mov_b64 exec, s[72:73]
    buffer_load_dwordx4 v192, s[12:15], 0 offen  lds
    s_mov_b32 m0, s77
    s_mov_b64 exec, s[74:75]
    buffer_load_dwordx4 v193, s[12:15], 0 offen  lds
    s_mov_b64 exec, -1
    s_add_u32 m0, s21, 4096
    v_mfma_f32_32x32x16_bf16 v[16:31], v[72:75], v[176:179], 0
    v_mad_u32_u16 v238, v238, s3, v246 op_sel:[1,0,0,0]
    v_mad_u32_u16 v239, v239, s3, v246 op_sel:[1,0,0,0]
    buffer_load_dwordx4 v238, s[4:7], s40 offen  lds
    buffer_load_dwordx4 v239, s[8:11], s40 offen offset:1024  lds
    ds_read_b64_tr_b16 v[176:177], v244 offset:6144
    ds_read_b64_tr_b16 v[178:179], v244 offset:7168
    ds_read_b64_tr_b16 v[184:185], v245 offset:6144
    ds_read_b64_tr_b16 v[186:187], v245 offset:7168
    v_mul_f32 v255, v0, v152
    v_fmac_f32 v255, v1, v153
    v_fmac_f32 v255, v2, v154
    v_fmac_f32 v255, v3, v155
    v_fmac_f32 v255, v4, v156
    v_fmac_f32 v255, v5, v157
    v_fmac_f32 v255, v6, v158
    v_fmac_f32 v255, v7, v159
    v_fmac_f32 v201, v8, v168
    v_fmac_f32 v201, v9, v169
    v_permlane32_swap_b32 v197, v255
    s_waitcnt lgkmcnt(0)
    v_mfma_f32_32x32x16_bf16 v[16:31], v[80:83], v[176:179], v[16:31]
    v_fmac_f32 v201, v10, v170
    v_fmac_f32 v201, v11, v171
    v_fmac_f32 v201, v12, v172
    v_fmac_f32 v201, v13, v173
    v_fmac_f32 v201, v14, v174
    v_fmac_f32 v201, v15, v175
    s_add_u32 m0, s21, 6144
    v_mfma_f32_32x32x16_bf16 v[56:71], v[84:87], v[176:179], v[56:71]
    v_mad_u32_u16 v240, v240, s3, v246 op_sel:[1,0,0,0]
    v_mad_u32_u16 v241, v241, s3, v246 op_sel:[1,0,0,0]
    buffer_load_dwordx4 v240, s[4:7], s41 offen  lds
    buffer_load_dwordx4 v241, s[8:11], s41 offen offset:1024  lds
    v_add_f32 v255, v197, v255
    s_set_gpr_idx_on s51, gpr_idx(DST)
    s_nop 0
    v_cvt_pk_bf16_f32 v206, v254, v255
    s_set_gpr_idx_off
    v_mfma_f32_32x32x16_bf16 v[0:15], v[72:75], v[180:183], 0
    v_mul_f32 v254, v16, v144
    v_fmac_f32 v254, v17, v145
    v_fmac_f32 v254, v18, v146
    v_fmac_f32 v254, v19, v147
    v_fmac_f32 v254, v20, v148
    v_fmac_f32 v254, v21, v149
    v_mfma_f32_32x32x16_bf16 v[32:47], v[76:79], v[180:183], v[32:47]
    s_waitcnt vmcnt(8)
    ds_read_b64_tr_b16 v[176:177], v244 offset:0
    ds_read_b64_tr_b16 v[178:179], v244 offset:1024
    ds_read_b64_tr_b16 v[180:181], v245 offset:0
    ds_read_b64_tr_b16 v[182:183], v245 offset:1024
    v_fmac_f32 v254, v22, v150
    v_fmac_f32 v254, v23, v151
    v_mfma_f32_32x32x16_bf16 v[0:15], v[80:83], v[184:187], v[0:15]
    v_fma_f32 v202, v24, -v160, v202
    v_fma_f32 v202, v25, -v161, v202
    v_permlane32_swap_b32 v254, v200
    v_fma_f32 v202, v26, -v162, v202
    v_fma_f32 v202, v27, -v163, v202
    v_fma_f32 v202, v28, -v164, v202
    v_mfma_f32_32x32x16_bf16 v[32:47], v[84:87], v[184:187], v[32:47]
    v_add_u32 v249, s48, v249
    v_add_u32 v250, s49, v250
    v_fma_f32 v202, v29, -v165, v202
    v_fma_f32 v202, v30, -v166, v202
    v_fma_f32 v202, v31, -v167, v202
    v_add_f32 v200, v254, v200
    v_mul_f32_e64 v198, v64, -v112
    v_permlane32_swap_b32 v202, v254
    v_fma_f32 v198, v65, -v113, v198
    v_fma_f32 v198, v66, -v114, v198
    v_fma_f32 v198, v67, -v115, v198
    v_fma_f32 v198, v68, -v116, v198
    v_fma_f32 v198, v69, -v117, v198
    v_fma_f32 v198, v70, -v118, v198
    v_fma_f32 v198, v71, -v119, v198
    v_add_f32 v254, v202, v254
    v_mul_f32 v196, v56, v160
    v_fmac_f32 v196, v57, v161
    v_fmac_f32 v196, v58, v162
    v_fmac_f32 v196, v59, v163
    v_fmac_f32 v196, v60, v164
    v_fmac_f32 v196, v61, v165
    v_fmac_f32 v196, v62, v166
    v_fmac_f32 v196, v63, v167
    s_nop 1
    v_permlane32_swap_b32 v198, v196
    v_add_f32 v196, v198, v196
    v_mul_f32 v255, v0, v152
    v_fmac_f32 v255, v1, v153
    v_fmac_f32 v255, v2, v154
    v_fmac_f32 v255, v3, v155
    v_fmac_f32 v255, v4, v156
    v_fmac_f32 v255, v5, v157
    v_fmac_f32 v255, v6, v158
    v_fmac_f32 v255, v7, v159
    v_fma_f32 v203, v8, -v168, v203
    v_fma_f32 v203, v9, -v169, v203
    v_permlane32_swap_b32 v255, v201
    v_fma_f32 v203, v10, -v170, v203
    v_fma_f32 v203, v11, -v171, v203
    v_fma_f32 v203, v12, -v172, v203
    v_fma_f32 v203, v13, -v173, v203
    v_fma_f32 v203, v14, -v174, v203
    v_fma_f32 v203, v15, -v175, v203
    v_add_f32 v201, v255, v201
    v_mul_f32_e64 v199, v40, -v120
    v_permlane32_swap_b32 v203, v255
    v_fma_f32 v199, v41, -v121, v199
    v_fma_f32 v199, v42, -v122, v199
    v_fma_f32 v199, v43, -v123, v199
    s_waitcnt vmcnt(4)
    ds_read_b64_tr_b16 v[72:73], v249 offset:0
    ds_read_b64_tr_b16 v[76:77], v249 offset:64
    ds_read_b64_tr_b16 v[74:75], v249 offset:256
    ds_read_b64_tr_b16 v[78:79], v249 offset:320
    s_mov_b64 exec, s[54:55]
    ds_read_u16_d16_hi v242, v250 offset:0
    s_mov_b64 exec, -1
    v_fma_f32 v199, v44, -v124, v199
    v_fma_f32 v199, v45, -v125, v199
    v_fma_f32 v199, v46, -v126, v199
    v_fma_f32 v199, v47, -v127, v199
    v_add_f32 v255, v203, v255
    v_mul_f32 v197, v32, v168
    v_fmac_f32 v197, v33, v169
    v_fmac_f32 v197, v34, v170
    v_fmac_f32 v197, v35, v171
    v_fmac_f32 v197, v36, v172
    v_fmac_f32 v197, v37, v173
    v_fmac_f32 v197, v38, v174
    v_fmac_f32 v197, v39, v175
    s_nop 1
    v_permlane32_swap_b32 v199, v197
    v_add_f32 v197, v199, v197
    s_set_gpr_idx_on s51, gpr_idx(DST)
    s_nop 0
    v_cvt_pk_bf16_f32 v207, v200, v201
    v_cvt_pk_bf16_f32 v209, v254, v255
    v_cvt_pk_bf16_f32 v208, v196, v197
    s_set_gpr_idx_off
    s_add_u32 s50, s50, 1
    s_add_u32 s51, s51, 6
    s_cmp_ge_u32 s50, 4
    s_cbranch_scc1 LAST0
    s_add_u32 s53, s53, 4
    s_xor_b32 s66, s53, s20
    s_bitcmp1_b32 s66, 2
    s_setprio 1
    s_cbranch_scc1 PRIO_5
    s_setprio 0
PRIO_5:
    s_cmp_eq_u32 s52, 4
    s_cbranch_scc1 ITEM_0_4
    s_cmp_eq_u32 s52, 5
    s_cbranch_scc1 ITEM_0_5
    s_cmp_eq_u32 s52, 3
    s_cbranch_scc1 ITEM_0_3
    s_cmp_eq_u32 s52, 6
    s_cbranch_scc1 ITEM_0_6
    s_cmp_eq_u32 s52, 8
    s_cbranch_scc1 ITEM_0_8
    s_branch ITEM_0_2
.p2align 6
ITEM_0_5:
    s_mov_b64 exec, s[54:55]
    ds_read_u16_d16_hi v243, v250 offset:128
    s_mov_b64 exec, -1
    ds_read_b64_tr_b16 v[80:81], v249 offset:512
    ds_read_b64_tr_b16 v[84:85], v249 offset:576
    ds_read_b64_tr_b16 v[82:83], v249 offset:768
    ds_read_b64_tr_b16 v[86:87], v249 offset:832
    ds_read_b64_tr_b16 v[88:89], v249 offset:1024
    ds_read_b64_tr_b16 v[92:93], v249 offset:1088
    s_waitcnt lgkmcnt(7)
    v_mul_f32_dpp v196, v242, v72 row_newbcast:0 row_mask:0xf bank_mask:0xf
    v_mul_f32_dpp v197, v242, v73 row_newbcast:1 row_mask:0xf bank_mask:0xf
    v_mul_f32_dpp v198, v242, v72 row_newbcast:8 row_mask:0xf bank_mask:0xf
    v_mul_f32_dpp v199, v242, v73 row_newbcast:9 row_mask:0xf bank_mask:0xf
    v_mul_f32_dpp v200, v242, v76 row_newbcast:2 row_mask:0xf bank_mask:0xf
    v_mul_f32_dpp v201, v242, v77 row_newbcast:3 row_mask:0xf bank_mask:0xf
    v_mul_f32_dpp v202, v242, v76 row_newbcast:10 row_mask:0xf bank_mask:0xf
    v_mul_f32_dpp v203, v242, v77 row_newbcast:11 row_mask:0xf bank_mask:0xf
    v_cvt_pk_bf16_f32 v72, v196, v197
    v_cvt_pk_bf16_f32 v76, v198, v199
    v_cvt_pk_bf16_f32 v73, v200, v201
    v_cvt_pk_bf16_f32 v77, v202, v203
    v_mul_f32_dpp v196, v242, v74 row_newbcast:4 row_mask:0xf bank_mask:0xf
    v_mul_f32_dpp v197, v242, v75 row_newbcast:5 row_mask:0xf bank_mask:0xf
    v_mul_f32_dpp v198, v242, v74 row_newbcast:12 row_mask:0xf bank_mask:0xf
    v_mul_f32_dpp v199, v242, v75 row_newbcast:13 row_mask:0xf bank_mask:0xf
    v_mul_f32_dpp v200, v242, v78 row_newbcast:6 row_mask:0xf bank_mask:0xf
    v_mul_f32_dpp v201, v242, v79 row_newbcast:7 row_mask:0xf bank_mask:0xf
    v_mul_f32_dpp v202, v242, v78 row_newbcast:14 row_mask:0xf bank_mask:0xf
    v_mul_f32_dpp v203, v242, v79 row_newbcast:15 row_mask:0xf bank_mask:0xf
    v_cvt_pk_bf16_f32 v74, v196, v197
    v_cvt_pk_bf16_f32 v78, v198, v199
    v_cvt_pk_bf16_f32 v75, v200, v201
    v_cvt_pk_bf16_f32 v79, v202, v203
    s_mov_b64 exec, s[54:55]
    ds_read_u16_d16_hi v242, v250 offset:256
    s_mov_b64 exec, -1
    s_waitcnt vmcnt(4) lgkmcnt(3)
    v_mfma_f32_32x32x16_bf16 v[56:71], v[72:75], v[176:179], 0
    v_mul_f32_dpp v196, v243, v80 row_newbcast:0 row_mask:0xf bank_mask:0xf
    v_mul_f32_dpp v197, v243, v81 row_newbcast:1 row_mask:0xf bank_mask:0xf
    v_mul_f32_dpp v198, v243, v80 row_newbcast:8 row_mask:0xf bank_mask:0xf
    v_mul_f32_dpp v199, v243, v81 row_newbcast:9 row_mask:0xf bank_mask:0xf
    v_mul_f32_dpp v200, v243, v84 row_newbcast:2 row_mask:0xf bank_mask:0xf
    v_mul_f32_dpp v201, v243, v85 row_newbcast:3 row_mask:0xf bank_mask:0xf
    s_add_u32 m0, s21, 0
    v_mfma_f32_32x32x16_bf16 v[16:31], v[76:79], v[176:179], 0
    buffer_load_dwordx4 v236, s[4:7], s35 offen  lds
    buffer_load_dwordx4 v237, s[8:11], s35 offen offset:1024  lds
    ds_read_b64_tr_b16 v[176:177], v244 offset:2048
    ds_read_b64_tr_b16 v[178:179], v244 offset:3072
    ds_read_b64_tr_b16 v[184:185], v245 offset:2048
    ds_read_b64_tr_b16 v[186:187], v245 offset:3072
    v_mul_f32_dpp v202, v243, v84 row_newbcast:10 row_mask:0xf bank_mask:0xf
    v_mul_f32_dpp v203, v243, v85 row_newbcast:11 row_mask:0xf bank_mask:0xf
    v_cvt_pk_bf16_f32 v80, v196, v197
    v_cvt_pk_bf16_f32 v84, v198, v199
    v_cvt_pk_bf16_f32 v81, v200, v201
    v_cvt_pk_bf16_f32 v85, v202, v203
    v_mul_f32_dpp v196, v243, v82 row_newbcast:4 row_mask:0xf bank_mask:0xf
    v_mul_f32_dpp v197, v243, v83 row_newbcast:5 row_mask:0xf bank_mask:0xf
    v_mul_f32_dpp v198, v243, v82 row_newbcast:12 row_mask:0xf bank_mask:0xf
    v_mul_f32_dpp v199, v243, v83 row_newbcast:13 row_mask:0xf bank_mask:0xf
    v_mul_f32_dpp v200, v243, v86 row_newbcast:6 row_mask:0xf bank_mask:0xf
    v_mul_f32_dpp v201, v243, v87 row_newbcast:7 row_mask:0xf bank_mask:0xf
    v_mul_f32_dpp v202, v243, v86 row_newbcast:14 row_mask:0xf bank_mask:0xf
    v_mul_f32_dpp v203, v243, v87 row_newbcast:15 row_mask:0xf bank_mask:0xf
    v_cvt_pk_bf16_f32 v82, v196, v197
    v_cvt_pk_bf16_f32 v86, v198, v199
    v_cvt_pk_bf16_f32 v83, v200, v201
    v_cvt_pk_bf16_f32 v87, v202, v203
    s_waitcnt vmcnt(4) lgkmcnt(0)
    v_mfma_f32_32x32x16_bf16 v[56:71], v[80:83], v[176:179], v[56:71]
    v_mul_f32_dpp v196, v242, v88 row_newbcast:0 row_mask:0xf bank_mask:0xf
    v_mul_f32_dpp v197, v242, v89 row_newbcast:1 row_mask:0xf bank_mask:0xf
    v_mul_f32_dpp v198, v242, v88 row_newbcast:8 row_mask:0xf bank_mask:0xf
    v_mul_f32_dpp v199, v242, v89 row_newbcast:9 row_mask:0xf bank_mask:0xf
    v_mul_f32_dpp v200, v242, v92 row_newbcast:2 row_mask:0xf bank_mask:0xf
    v_mul_f32_dpp v201, v242, v93 row_newbcast:3 row_mask:0xf bank_mask:0xf
    s_add_u32 m0, s21, 2048
    v_mfma_f32_32x32x16_bf16 v[16:31], v[84:87], v[176:179], v[16:31]
    buffer_load_dwordx4 v238, s[4:7], s35 offen  lds
    ds_read_b64_tr_b16 v[176:177], v244 offset:4096
    ds_read_b64_tr_b16 v[188:189], v245 offset:4096
    v_mul_f32_dpp v202, v242, v92 row_newbcast:10 row_mask:0xf bank_mask:0xf
    v_mul_f32_dpp v203, v242, v93 row_newbcast:11 row_mask:0xf bank_mask:0xf
    v_cvt_pk_bf16_f32 v88, v196, v197
    v_cvt_pk_bf16_f32 v92, v198, v199
    v_cvt_pk_bf16_f32 v89, v200, v201
    v_cvt_pk_bf16_f32 v93, v202, v203
    s_waitcnt lgkmcnt(0)
    v_mfma_f32_32x32x8_bf16 v[56:71], v[88:89], v[176:177], v[56:71]
    s_add_u32 m0, s21, 4096
    v_mfma_f32_32x32x8_bf16 v[16:31], v[92:93], v[176:177], v[16:31]
    buffer_load_dwordx4 v234, s[4:7], s36 offen  lds
    buffer_load_dwordx4 v235, s[8:11], s36 offen offset:1024  lds
    s_mov_b32 m0, s50
    s_nop 0
    s_movrels_b32 s71, s23
    s_bfe_u32 s46, s71, 0x30012
    s_mov_b32 m0, s46
    s_and_b32 s66, s71, 0x3ffff
    s_movrels_b32 s68, s57
    s_movrels_b32 s69, s61
    s_sub_u32 s48, s66, s47
    s_mov_b32 s47, s66
    s_lshr_b32 s52, s71, 28
    s_lshl_b32 s67, s46, 9
    s_add_u32 s66, s66, s67
    s_sub_u32 s49, s66, s42
    s_mov_b32 s42, s66
    s_bfe_u32 s66, s68, 655360
    s_add_u32 s43, s42, s66
    s_bfe_u32 s39, s69, 655360
    s_bfe_u32 s66, s68, 655370
    s_add_u32 s44, s42, s66
    s_bfe_u32 s40, s69, 655370
    s_bfe_u32 s66, s68, 655380
    s_add_u32 s45, s42, s66
    s_bfe_u32 s41, s69, 655380
    s_and_b32 s66, s46, s33
    s_cselect_b32 s72, -1, 1
    s_cselect_b32 s76, s47, 163712
    s_cmp_ge_u32 s66, 2
    s_cselect_b32 s73, -1, 0
    s_add_u32 s77, s47, 1024
    s_cmp_ge_u32 s66, 4
    s_cselect_b32 s75, -1, 0
    s_cmp_ge_u32 s66, 3
    s_cselect_b32 s74, -1, 1
    s_cselect_b32 s77, s77, 163712
    v_add_u32 v252, s45, v247
    ds_read2_b32 v[240:241], v252 offset0:0 offset1:16
    v_mfma_f32_32x32x16_bf16 v[32:47], v[72:75], v[180:183], 0
    v_mul_f32 v196, v56, v96
    v_fmac_f32 v196, v57, v97
    v_fmac_f32 v196, v58, v98
    v_fmac_f32 v196, v59, v99
    v_fmac_f32 v196, v60, v100
    v_fmac_f32 v196, v61, v101
    v_mfma_f32_32x32x16_bf16 v[0:15], v[76:79], v[180:183], 0
    v_fmac_f32 v196, v62, v102
    v_fmac_f32 v196, v63, v103
    v_mul_f32 v198, v64, v128
    v_fmac_f32 v198, v65, v129
    v_fmac_f32 v198, v66, v130
    v_fmac_f32 v198, v67, v131
    v_mfma_f32_32x32x16_bf16 v[32:47], v[80:83], v[184:187], v[32:47]
    v_fmac_f32 v198, v68, v132
    v_fmac_f32 v198, v69, v133
    v_fmac_f32 v198, v70, v134
    v_fmac_f32 v198, v71, v135
    v_mul_f32 v200, v16, v128
    v_fmac_f32 v200, v17, v129
    v_mfma_f32_32x32x16_bf16 v[0:15], v[84:87], v[184:187], v[0:15]
    s_waitcnt vmcnt(5)
    ds_read_b64_tr_b16 v[176:177], v244 offset:6144
    ds_read_b64_tr_b16 v[178:179], v244 offset:7168
    ds_read_b64_tr_b16 v[180:181], v245 offset:6144
    ds_read_b64_tr_b16 v[182:183], v245 offset:7168
    v_permlane32_swap_b32 v196, v198
    v_fmac_f32 v200, v18, v130
    v_mfma_f32_32x32x8_bf16 v[32:47], v[88:89], v[188:189], v[32:47]
    v_fmac_f32 v200, v19, v131
    v_fmac_f32 v200, v20, v132
    v_fmac_f32 v200, v21, v133
    v_fmac_f32 v200, v22, v134
    v_fmac_f32 v200, v23, v135
    v_add_f32 v198, v196, v198
    v_mfma_f32_32x32x8_bf16 v[0:15], v[92:93], v[188:189], v[0:15]
    v_mul_f32_e64 v202, v24, -v128
    v_fma_f32 v202, v25, -v129, v202
    v_fma_f32 v202, v26, -v130, v202
    v_fma_f32 v202, v27, -v131, v202
    v_fma_f32 v202, v28, -v132, v202
    v_fma_f32 v202, v29, -v133, v202
    v_fma_f32 v202, v30, -v134, v202
    v_fma_f32 v202, v31, -v135, v202
    s_nop 1
    v_permlane32_swap_b32 v200, v202
    v_add_f32 v202, v200, v202
    s_waitcnt vmcnt(3) lgkmcnt(0)
    v_mfma_f32_32x32x16_bf16 v[56:71], v[72:75], v[176:179], 0
    v_mul_f32 v197, v32, v104
    v_fmac_f32 v197, v33, v105
    v_fmac_f32 v197, v34, v106
    v_fmac_f32 v197, v35, v107
    v_fmac_f32 v197, v36, v108
    v_fmac_f32 v197, v37, v109
    s_add_u32 m0, s21, 6144
    v_mfma_f32_32x32x16_bf16 v[16:31], v[76:79], v[176:179], 0
    buffer_load_dwordx4 v236, s[4:7], s36 offen  lds
    buffer_load_dwordx4 v237, s[8:11], s36 offen offset:1024  lds
    ds_read_b64_tr_b16 v[176:177], v244 offset:0
    ds_read_b64_tr_b16 v[178:179], v244 offset:1024
    ds_read_b64_tr_b16 v[184:185], v245 offset:0
    ds_read_b64_tr_b16 v[186:187], v245 offset:1024
    v_fmac_f32 v197, v38, v110
    v_fmac_f32 v197, v39, v111
    v_mul_f32 v199, v40, v136
    v_fmac_f32 v199, v41, v137
    v_fmac_f32 v199, v42, v138
    v_fmac_f32 v199, v43, v139
    v_fmac_f32 v199, v44, v140
    v_fmac_f32 v199, v45, v141
    v_fmac_f32 v199, v46, v142
    v_fmac_f32 v199, v47, v143
    v_mul_f32 v201, v0, v136
    v_fmac_f32 v201, v1, v137
    v_permlane32_swap_b32 v197, v199
    v_fmac_f32 v201, v2, v138
    v_fmac_f32 v201, v3, v139
    s_waitcnt vmcnt(4) lgkmcnt(0)
    v_mfma_f32_32x32x16_bf16 v[56:71], v[80:83], v[176:179], v[56:71]
    v_fmac_f32 v201, v4, v140
    v_fmac_f32 v201, v5, v141
    v_fmac_f32 v201, v6, v142
    v_fmac_f32 v201, v7, v143
    v_add_f32 v199, v197, v199
    v_mul_f32_e64 v203, v8, -v136
    s_add_u32 m0, s21, 0
    v_mfma_f32_32x32x16_bf16 v[16:31], v[84:87], v[176:179], v[16:31]
    buffer_load_dwordx4 v238, s[4:7], s36 offen  lds
    ds_read_b64_tr_b16 v[176:177], v244 offset:2048
    ds_read_b64_tr_b16 v[188:189], v245 offset:2048
    v_fma_f32 v203, v9, -v137, v203
    v_fma_f32 v203, v10, -v138, v203
    v_fma_f32 v203, v11, -v139, v203
    s_waitcnt lgkmcnt(0)
    v_mfma_f32_32x32x8_bf16 v[56:71], v[88:89], v[176:177], v[56:71]
    v_fma_f32 v203, v12, -v140, v203
    v_fma_f32 v203, v13, -v141, v203
    v_fma_f32 v203, v14, -v142, v203
    v_fma_f32 v203, v15, -v143, v203
    s_nop 1
    v_permlane32_swap_b32 v201, v203
    v_add_f32 v203, v201, v203
    s_add_u32 m0, s21, 2048
    v_mfma_f32_32x32x8_bf16 v[16:31], v[92:93], v[176:177], v[16:31]
    buffer_load_dwordx4 v234, s[4:7], s37 offen  lds
    buffer_load_dwordx4 v235, s[8:11], s37 offen offset:1024  lds
    v_add_u32 v252, s42, v247
    ds_read2_b32 v[234:235], v252 offset0:0 offset1:16
    s_set_gpr_idx_on s51, gpr_idx(DST)
    s_nop 0
    v_cvt_pk_bf16_f32 v204, v198, v199
    v_cvt_pk_bf16_f32 v205, v202, v203
    s_set_gpr_idx_off
    v_mfma_f32_32x32x16_bf16 v[32:47], v[72:75], v[180:183], 0
    v_mul_f32 v196, v56, v144
    v_fmac_f32 v196, v57, v145
    v_fmac_f32 v196, v58, v146
    v_fmac_f32 v196, v59, v147
    v_fmac_f32 v196, v60, v148
    v_fmac_f32 v196, v61, v149
    v_mfma_f32_32x32x16_bf16 v[0:15], v[76:79], v[180:183], 0
    v_fmac_f32 v196, v62, v150
    v_fmac_f32 v196, v63, v151
    v_mul_f32_e64 v200, v16, -v160
    v_fma_f32 v200, v17, -v161, v200
    v_fma_f32 v200, v18, -v162, v200
    v_fma_f32 v200, v19, -v163, v200
    v_mfma_f32_32x32x16_bf16 v[32:47], v[80:83], v[184:187], v[32:47]
    v_fma_f32 v200, v20, -v164, v200
    v_fma_f32 v200, v21, -v165, v200
    v_fma_f32 v200, v22, -v166, v200
    v_fma_f32 v200, v23, -v167, v200
    v_mul_f32_e64 v202, v24, -v160
    v_fma_f32 v202, v25, -v161, v202
    v_mfma_f32_32x32x16_bf16 v[0:15], v[84:87], v[184:187], v[0:15]
    s_waitcnt vmcnt(5)
    ds_read_b64_tr_b16 v[176:177], v244 offset:4096
    ds_read_b64_tr_b16 v[178:179], v244 offset:5120
    ds_read_b64_tr_b16 v[180:181], v245 offset:4096
    ds_read_b64_tr_b16 v[182:183], v245 offset:5120
    v_fma_f32 v202, v26, -v162, v202
    v_fma_f32 v202, v27, -v163, v202
    v_mfma_f32_32x32x8_bf16 v[32:47], v[88:89], v[188:189], v[32:47]
    v_fma_f32 v202, v28, -v164, v202
    v_fma_f32 v202, v29, -v165, v202
    v_fma_f32 v202, v30, -v166, v202
    v_fma_f32 v202, v31, -v167, v202
    v_mfma_f32_32x32x8_bf16 v[0:15], v[92:93], v[188:189], v[0:15]
    s_waitcnt vmcnt(3) lgkmcnt(0)
    v_mfma_f32_32x32x16_bf16 v[16:31], v[72:75], v[176:179], 0
    s_nop 4
    v_mul_f32 v197, v32, v152
    v_fmac_f32 v197, v33, v153
    v_fmac_f32 v197, v34, v154
    v_fmac_f32 v197, v35, v155
    v_fmac_f32 v197, v36, v156
    v_fmac_f32 v197, v37, v157
    s_add_u32 m0, s21, 4096
    v_mfma_f32_32x32x16_bf16 v[48:63], v[76:79], v[176:179], 0
    buffer_load_dwordx4 v236, s[4:7], s37 offen  lds
    buffer_load_dwordx4 v237, s[8:11], s37 offen offset:1024  lds
    ds_read_b64_tr_b16 v[176:177], v244 offset:6144
    ds_read_b64_tr_b16 v[178:179], v244 offset:7168
    ds_read_b64_tr_b16 v[184:185], v245 offset:6144
    ds_read_b64_tr_b16 v[186:187], v245 offset:7168
    v_add_u32 v252, s43, v247
    ds_read2_b32 v[236:237], v252 offset0:0 offset1:16
    v_fmac_f32 v197, v38, v158
    v_fmac_f32 v197, v39, v159
    v_mul_f32_e64 v201, v0, -v168
    s_waitcnt vmcnt(4) lgkmcnt(1)
    v_mfma_f32_32x32x16_bf16 v[16:31], v[80:83], v[176:179], v[16:31]
    v_fma_f32 v201, v1, -v169, v201
    v_fma_f32 v201, v2, -v170, v201
    v_fma_f32 v201, v3, -v171, v201
    v_fma_f32 v201, v4, -v172, v201
    v_fma_f32 v201, v5, -v173, v201
    v_fma_f32 v201, v6, -v174, v201
    s_add_u32 m0, s21, 6144
    v_mfma_f32_32x32x16_bf16 v[48:63], v[84:87], v[176:179], v[48:63]
    buffer_load_dwordx4 v238, s[4:7], s37 offen  lds
    ds_read_b64_tr_b16 v[176:177], v244 offset:0
    ds_read_b64_tr_b16 v[188:189], v245 offset:0
    v_add_u32 v252, s44, v247
    ds_read2_b32 v[238:239], v252 offset0:0 offset1:16
    v_fma_f32 v201, v7, -v175, v201
    s_waitcnt lgkmcnt(1)
    v_mfma_f32_32x32x8_bf16 v[16:31], v[88:89], v[176:177], v[16:31]
    v_mul_f32_e64 v203, v8, -v168
    v_fma_f32 v203, v9, -v169, v203
    v_fma_f32 v203, v10, -v170, v203
    v_fma_f32 v203, v11, -v171, v203
    v_fma_f32 v203, v12, -v172, v203
    v_fma_f32 v203, v13, -v173, v203
    s_add_u32 m0, s21, 0
    v_mfma_f32_32x32x8_bf16 v[48:63], v[92:93], v[176:177], v[48:63]
    v_mad_u32_u16 v234, v234, s3, v246 op_sel:[1,0,0,0]
    v_mad_u32_u16 v235, v235, s3, v246 op_sel:[1,0,0,0]
    buffer_load_dwordx4 v234, s[4:7], s38 offen  lds
    buffer_load_dwordx4 v235, s[8:11], s38 offen offset:1024  lds
    v_fma_f32 v203, v14, -v174, v203
    v_fma_f32 v203, v15, -v175, v203
    v_mfma_f32_32x32x16_bf16 v[0:15], v[72:75], v[180:183], 0
    v_fmac_f32 v200, v24, v160
    v_fmac_f32 v200, v25, v161
    v_fmac_f32 v200, v26, v162
    v_fmac_f32 v200, v27, v163
    v_fmac_f32 v200, v28, v164
    v_fmac_f32 v200, v29, v165
    v_fmac_f32 v200, v30, v166
    v_fmac_f32 v200, v31, v167
    v_mfma_f32_32x32x16_bf16 v[24:39], v[76:79], v[180:183], 0
    v_add_u32 v253, s47, v248
    ds_read_b32 v192, v253
    ds_read_b32 v193, v253 offset:256
    v_mul_f32 v254, v16, v144
    v_fmac_f32 v254, v17, v145
    v_fmac_f32 v254, v18, v146
    v_mfma_f32_32x32x16_bf16 v[0:15], v[80:83], v[184:187], v[0:15]
    v_fmac_f32 v254, v19, v147
    v_fmac_f32 v254, v20, v148
    v_fmac_f32 v254, v21, v149
    v_fmac_f32 v254, v22, v150
    v_fmac_f32 v254, v23, v151
    v_sub_f32_e64 v64, -v48, v64
    v_mfma_f32_32x32x16_bf16 v[24:39], v[84:87], v[184:187], v[24:39]
    s_waitcnt vmcnt(5)
    ds_read_b64_tr_b16 v[176:177], v244 offset:2048
    ds_read_b64_tr_b16 v[178:179], v244 offset:3072
    ds_read_b64_tr_b16 v[180:181], v245 offset:2048
    ds_read_b64_tr_b16 v[182:183], v245 offset:3072
    v_sub_f32_e64 v65, -v49, v65
    v_permlane32_swap_b32 v196, v254
    v_mfma_f32_32x32x8_bf16 v[24:39], v[92:93], v[188:189], v[24:39]
    v_sub_f32_e64 v66, -v50, v66
    v_sub_f32_e64 v67, -v51, v67
    v_sub_f32_e64 v68, -v52, v68
    v_sub_f32_e64 v69, -v53, v69
    v_sub_f32_e64 v70, -v54, v70
    v_sub_f32_e64 v71, -v55, v71
    v_mfma_f32_32x32x8_bf16 v[0:15], v[88:89], v[188:189], v[0:15]
    v_add_f32 v254, v196, v254
    s_waitcnt vmcnt(3) lgkmcnt(0)
    v_mfma_f32_32x32x16_bf16 v[56:71], v[76:79], v[176:179], v[56:71]
    s_nop 1
    v_sub_f32_e64 v40, -v24, v40
    v_sub_f32_e64 v41, -v25, v41
    v_sub_f32_e64 v42, -v26, v42
    v_sub_f32_e64 v43, -v27, v43
    v_sub_f32_e64 v44, -v28, v44
    v_sub_f32_e64 v45, -v29, v45
    v_sub_f32_e64 v46, -v30, v46
    v_sub_f32_e64 v47, -v31, v47
    s_mov_b32 m0, s76
    s_mov_b64 exec, s[72:73]
    buffer_load_dwordx4 v192, s[12:15], 0 offen  lds
    s_mov_b32 m0, s77
    s_mov_b64 exec, s[74:75]
    buffer_load_dwordx4 v193, s[12:15], 0 offen  lds
    s_mov_b64 exec, -1
    s_add_u32 m0, s21, 2048
    v_mfma_f32_32x32x16_bf16 v[16:31], v[72:75], v[176:179], 0
    v_mad_u32_u16 v236, v236, s3, v246 op_sel:[1,0,0,0]
    v_mad_u32_u16 v237, v237, s3, v246 op_sel:[1,0,0,0]
    buffer_load_dwordx4 v236, s[4:7], s39 offen  lds
    buffer_load_dwordx4 v237, s[8:11], s39 offen offset:1024  lds
    ds_read_b64_tr_b16 v[176:177], v244 offset:4096
    ds_read_b64_tr_b16 v[178:179], v244 offset:5120
    ds_read_b64_tr_b16 v[184:185], v245 offset:4096
    ds_read_b64_tr_b16 v[186:187], v245 offset:5120
    v_mul_f32 v255, v0, v152
    v_fmac_f32 v255, v1, v153
    v_fmac_f32 v255, v2, v154
    v_fmac_f32 v255, v3, v155
    v_fmac_f32 v255, v4, v156
    s_waitcnt vmcnt(6) lgkmcnt(0)
    v_mfma_f32_32x32x16_bf16 v[16:31], v[80:83], v[176:179], v[16:31]
    v_fmac_f32 v255, v5, v157
    v_fmac_f32 v255, v6, v158
    v_fmac_f32 v255, v7, v159
    v_fmac_f32 v201, v8, v168
    v_fmac_f32 v201, v9, v169
    v_permlane32_swap_b32 v197, v255
    s_add_u32 m0, s21, 4096
    v_mfma_f32_32x32x16_bf16 v[56:71], v[84:87], v[176:179], v[56:71]
    v_mad_u32_u16 v238, v238, s3, v246 op_sel:[1,0,0,0]
    v_mad_u32_u16 v239, v239, s3, v246 op_sel:[1,0,0,0]
    buffer_load_dwordx4 v238, s[4:7], s40 offen  lds
    buffer_load_dwordx4 v239, s[8:11], s40 offen offset:1024  lds
    ds_read_b64_tr_b16 v[176:177], v244 offset:6144
    ds_read_b64_tr_b16 v[188:189], v245 offset:6144
    s_waitcnt lgkmcnt(0)
    v_mfma_f32_32x32x8_bf16 v[16:31], v[88:89], v[176:177], v[16:31]
    v_fmac_f32 v201, v10, v170
    v_fmac_f32 v201, v11, v171
    v_fmac_f32 v201, v12, v172
    v_fmac_f32 v201, v13, v173
    v_fmac_f32 v201, v14, v174
    v_fmac_f32 v201, v15, v175
    s_add_u32 m0, s21, 6144
    v_mfma_f32_32x32x8_bf16 v[56:71], v[92:93], v[176:177], v[56:71]
    v_mad_u32_u16 v240, v240, s3, v246 op_sel:[1,0,0,0]
    v_mad_u32_u16 v241, v241, s3, v246 op_sel:[1,0,0,0]
    buffer_load_dwordx4 v240, s[4:7], s41 offen  lds
    buffer_load_dwordx4 v241, s[8:11], s41 offen offset:1024  lds
    v_add_f32 v255, v197, v255
    s_set_gpr_idx_on s51, gpr_idx(DST)
    s_nop 0
    v_cvt_pk_bf16_f32 v206, v254, v255
    s_set_gpr_idx_off
    v_mfma_f32_32x32x16_bf16 v[0:15], v[72:75], v[180:183], 0
    v_mul_f32 v254, v16, v144
    v_fmac_f32 v254, v17, v145
    v_fmac_f32 v254, v18, v146
    v_fmac_f32 v254, v19, v147
    v_fmac_f32 v254, v20, v148
    v_fmac_f32 v254, v21, v149
    v_mfma_f32_32x32x16_bf16 v[32:47], v[76:79], v[180:183], v[32:47]
    v_fmac_f32 v254, v22, v150
    v_fmac_f32 v254, v23, v151
    v_fma_f32 v202, v24, -v160, v202
    v_fma_f32 v202, v25, -v161, v202
    v_permlane32_swap_b32 v254, v200
    v_fma_f32 v202, v26, -v162, v202
    v_mfma_f32_32x32x16_bf16 v[0:15], v[80:83], v[184:187], v[0:15]
    v_fma_f32 v202, v27, -v163, v202
    v_fma_f32 v202, v28, -v164, v202
    v_fma_f32 v202, v29, -v165, v202
    v_fma_f32 v202, v30, -v166, v202
    v_fma_f32 v202, v31, -v167, v202
    v_add_f32 v200, v254, v200
    v_mfma_f32_32x32x16_bf16 v[32:47], v[84:87], v[184:187], v[32:47]
    s_waitcnt vmcnt(8)
    ds_read_b64_tr_b16 v[176:177], v244 offset:0
    ds_read_b64_tr_b16 v[178:179], v244 offset:1024
    ds_read_b64_tr_b16 v[180:181], v245 offset:0
    ds_read_b64_tr_b16 v[182:183], v245 offset:1024
    v_mul_f32_e64 v198, v64, -v112
    v_permlane32_swap_b32 v202, v254
    v_mfma_f32_32x32x8_bf16 v[0:15], v[88:89], v[188:189], v[0:15]
    v_fma_f32 v198, v65, -v113, v198
    v_fma_f32 v198, v66, -v114, v198
    v_fma_f32 v198, v67, -v115, v198
    v_fma_f32 v198, v68, -v116, v198
    v_fma_f32 v198, v69, -v117, v198
    v_fma_f32 v198, v70, -v118, v198
    v_mfma_f32_32x32x8_bf16 v[32:47], v[92:93], v[188:189], v[32:47]
    v_add_u32 v249, s48, v249
    v_add_u32 v250, s49, v250
    v_fma_f32 v198, v71, -v119, v198
    v_add_f32 v254, v202, v254
    v_mul_f32 v196, v56, v160
    v_fmac_f32 v196, v57, v161
    v_fmac_f32 v196, v58, v162
    v_fmac_f32 v196, v59, v163
    v_fmac_f32 v196, v60, v164
    v_fmac_f32 v196, v61, v165
    v_fmac_f32 v196, v62, v166
    v_fmac_f32 v196, v63, v167
    s_nop 1
    v_permlane32_swap_b32 v198, v196
    v_add_f32 v196, v198, v196
    v_mul_f32 v255, v0, v152
    v_fmac_f32 v255, v1, v153
    v_fmac_f32 v255, v2, v154
    v_fmac_f32 v255, v3, v155
    v_fmac_f32 v255, v4, v156
    v_fmac_f32 v255, v5, v157
    v_fmac_f32 v255, v6, v158
    v_fmac_f32 v255, v7, v159
    v_fma_f32 v203, v8, -v168, v203
    v_fma_f32 v203, v9, -v169, v203
    v_permlane32_swap_b32 v255, v201
    v_fma_f32 v203, v10, -v170, v203
    v_fma_f32 v203, v11, -v171, v203
    v_fma_f32 v203, v12, -v172, v203
    v_fma_f32 v203, v13, -v173, v203
    v_fma_f32 v203, v14, -v174, v203
    v_fma_f32 v203, v15, -v175, v203
    v_add_f32 v201, v255, v201
    v_mul_f32_e64 v199, v40, -v120
    v_permlane32_swap_b32 v203, v255
    v_fma_f32 v199, v41, -v121, v199
    v_fma_f32 v199, v42, -v122, v199
    v_fma_f32 v199, v43, -v123, v199
    s_waitcnt vmcnt(6)
    ds_read_b64_tr_b16 v[72:73], v249 offset:0
    ds_read_b64_tr_b16 v[76:77], v249 offset:64
    ds_read_b64_tr_b16 v[74:75], v249 offset:256
    ds_read_b64_tr_b16 v[78:79], v249 offset:320
    s_mov_b64 exec, s[54:55]
    ds_read_u16_d16_hi v242, v250 offset:0
    s_mov_b64 exec, -1
    v_fma_f32 v199, v44, -v124, v199
    v_fma_f32 v199, v45, -v125, v199
    v_fma_f32 v199, v46, -v126, v199
    v_fma_f32 v199, v47, -v127, v199
    v_add_f32 v255, v203, v255
    v_mul_f32 v197, v32, v168
    v_fmac_f32 v197, v33, v169
    v_fmac_f32 v197, v34, v170
    v_fmac_f32 v197, v35, v171
    v_fmac_f32 v197, v36, v172
    v_fmac_f32 v197, v37, v173
    v_fmac_f32 v197, v38, v174
    v_fmac_f32 v197, v39, v175
    s_nop 1
    v_permlane32_swap_b32 v199, v197
    v_add_f32 v197, v199, v197
    s_set_gpr_idx_on s51, gpr_idx(DST)
    s_nop 0
    v_cvt_pk_bf16_f32 v207, v200, v201
    v_cvt_pk_bf16_f32 v209, v254, v255
    v_cvt_pk_bf16_f32 v208, v196, v197
    s_set_gpr_idx_off
    s_add_u32 s50, s50, 1
    s_add_u32 s51, s51, 6
    s_cmp_ge_u32 s50, 4
    s_cbranch_scc1 LAST0
    s_add_u32 s53, s53, 4
    s_xor_b32 s66, s53, s20
    s_bitcmp1_b32 s66, 2
    s_setprio 1
    s_cbranch_scc1 PRIO_6
    s_setprio 0
PRIO_6:
    s_cmp_eq_u32 s52, 4
    s_cbranch_scc1 ITEM_0_4
    s_cmp_eq_u32 s52, 5
    s_cbranch_scc1 ITEM_0_5
    s_cmp_eq_u32 s52, 3
    s_cbranch_scc1 ITEM_0_3
    s_cmp_eq_u32 s52, 6
    s_cbranch_scc1 ITEM_0_6
    s_cmp_eq_u32 s52, 8
    s_cbranch_scc1 ITEM_0_8
    s_branch ITEM_0_2
.p2align 6
ITEM_0_3:
    s_mov_b64 exec, s[54:55]
    ds_read_u16_d16_hi v243, v250 offset:128
    s_mov_b64 exec, -1
    ds_read_b64_tr_b16 v[80:81], v249 offset:512
    ds_read_b64_tr_b16 v[84:85], v249 offset:576
    s_waitcnt lgkmcnt(3)
    v_mul_f32_dpp v196, v242, v72 row_newbcast:0 row_mask:0xf bank_mask:0xf
    v_mul_f32_dpp v197, v242, v73 row_newbcast:1 row_mask:0xf bank_mask:0xf
    v_mul_f32_dpp v198, v242, v72 row_newbcast:8 row_mask:0xf bank_mask:0xf
    v_mul_f32_dpp v199, v242, v73 row_newbcast:9 row_mask:0xf bank_mask:0xf
    v_mul_f32_dpp v200, v242, v76 row_newbcast:2 row_mask:0xf bank_mask:0xf
    v_mul_f32_dpp v201, v242, v77 row_newbcast:3 row_mask:0xf bank_mask:0xf
    v_mul_f32_dpp v202, v242, v76 row_newbcast:10 row_mask:0xf bank_mask:0xf
    v_mul_f32_dpp v203, v242, v77 row_newbcast:11 row_mask:0xf bank_mask:0xf
    v_cvt_pk_bf16_f32 v72, v196, v197
    v_cvt_pk_bf16_f32 v76, v198, v199
    v_cvt_pk_bf16_f32 v73, v200, v201
    v_cvt_pk_bf16_f32 v77, v202, v203
    v_mul_f32_dpp v196, v242, v74 row_newbcast:4 row_mask:0xf bank_mask:0xf
    v_mul_f32_dpp v197, v242, v75 row_newbcast:5 row_mask:0xf bank_mask:0xf
    v_mul_f32_dpp v198, v242, v74 row_newbcast:12 row_mask:0xf bank_mask:0xf
    v_mul_f32_dpp v199, v242, v75 row_newbcast:13 row_mask:0xf bank_mask:0xf
    v_mul_f32_dpp v200, v242, v78 row_newbcast:6 row_mask:0xf bank_mask:0xf
    v_mul_f32_dpp v201, v242, v79 row_newbcast:7 row_mask:0xf bank_mask:0xf
    v_mul_f32_dpp v202, v242, v78 row_newbcast:14 row_mask:0xf bank_mask:0xf
    v_mul_f32_dpp v203, v242, v79 row_newbcast:15 row_mask:0xf bank_mask:0xf
    v_cvt_pk_bf16_f32 v74, v196, v197
    v_cvt_pk_bf16_f32 v78, v198, v199
    v_cvt_pk_bf16_f32 v75, v200, v201
    v_cvt_pk_bf16_f32 v79, v202, v203
    s_waitcnt vmcnt(4) lgkmcnt(0)
    v_mfma_f32_32x32x16_bf16 v[56:71], v[72:75], v[176:179], 0
    v_mul_f32_dpp v196, v243, v80 row_newbcast:0 row_mask:0xf bank_mask:0xf
    v_mul_f32_dpp v197, v243, v81 row_newbcast:1 row_mask:0xf bank_mask:0xf
    v_mul_f32_dpp v198, v243, v80 row_newbcast:8 row_mask:0xf bank_mask:0xf
    v_mul_f32_dpp v199, v243, v81 row_newbcast:9 row_mask:0xf bank_mask:0xf
    v_mul_f32_dpp v200, v243, v84 row_newbcast:2 row_mask:0xf bank_mask:0xf
    v_mul_f32_dpp v201, v243, v85 row_newbcast:3 row_mask:0xf bank_mask:0xf
    s_add_u32 m0, s21, 0
    v_mfma_f32_32x32x16_bf16 v[16:31], v[76:79], v[176:179], 0
    buffer_load_dwordx4 v234, s[4:7], s36 offen  lds
    buffer_load_dwordx4 v235, s[8:11], s36 offen offset:1024  lds
    ds_read_b64_tr_b16 v[176:177], v244 offset:2048
    ds_read_b64_tr_b16 v[184:185], v245 offset:2048
    v_mul_f32_dpp v202, v243, v84 row_newbcast:10 row_mask:0xf bank_mask:0xf
    v_mul_f32_dpp v203, v243, v85 row_newbcast:11 row_mask:0xf bank_mask:0xf
    v_cvt_pk_bf16_f32 v80, v196, v197
    v_cvt_pk_bf16_f32 v84, v198, v199
    v_cvt_pk_bf16_f32 v81, v200, v201
    v_cvt_pk_bf16_f32 v85, v202, v203
    s_waitcnt lgkmcnt(0)
    v_mfma_f32_32x32x8_bf16 v[56:71], v[80:81], v[176:177], v[56:71]
    s_add_u32 m0, s21, 2048
    v_mfma_f32_32x32x8_bf16 v[16:31], v[84:85], v[176:177], v[16:31]
    buffer_load_dwordx4 v236, s[4:7], s36 offen  lds
    s_mov_b32 m0, s50
    s_nop 0
    s_movrels_b32 s71, s23
    s_bfe_u32 s46, s71, 0x30012
    s_mov_b32 m0, s46
    s_and_b32 s66, s71, 0x3ffff
    s_movrels_b32 s68, s57
    s_movrels_b32 s69, s61
    s_sub_u32 s48, s66, s47
    s_mov_b32 s47, s66
    s_lshr_b32 s52, s71, 28
    s_lshl_b32 s67, s46, 9
    s_add_u32 s66, s66, s67
    s_sub_u32 s49, s66, s42
    s_mov_b32 s42, s66
    s_bfe_u32 s66, s68, 655360
    s_add_u32 s43, s42, s66
    s_bfe_u32 s39, s69, 655360
    s_bfe_u32 s66, s68, 655370
    s_add_u32 s44, s42, s66
    s_bfe_u32 s40, s69, 655370
    s_bfe_u32 s66, s68, 655380
    s_add_u32 s45, s42, s66
    s_bfe_u32 s41, s69, 655380
    s_and_b32 s66, s46, s33
    s_cselect_b32 s72, -1, 1
    s_cselect_b32 s76, s47, 163712
    s_cmp_ge_u32 s66, 2
    s_cselect_b32 s73, -1, 0
    s_add_u32 s77, s47, 1024
    s_cmp_ge_u32 s66, 4
    s_cselect_b32 s75, -1, 0
    s_cmp_ge_u32 s66, 3
    s_cselect_b32 s74, -1, 1
    s_cselect_b32 s77, s77, 163712
    v_add_u32 v252, s44, v247
    ds_read2_b32 v[238:239], v252 offset0:0 offset1:16
    v_add_u32 v252, s45, v247
    ds_read2_b32 v[240:241], v252 offset0:0 offset1:16
    v_mfma_f32_32x32x16_bf16 v[32:47], v[72:75], v[180:183], 0
    v_mul_f32 v196, v56, v96
    v_fmac_f32 v196, v57, v97
    v_fmac_f32 v196, v58, v98
    v_fmac_f32 v196, v59, v99
    v_fmac_f32 v196, v60, v100
    v_fmac_f32 v196, v61, v101
    v_mfma_f32_32x32x16_bf16 v[0:15], v[76:79], v[180:183], 0
    s_waitcnt vmcnt(5)
    ds_read_b64_tr_b16 v[176:177], v244 offset:4096
    ds_read_b64_tr_b16 v[178:179], v244 offset:5120
    ds_read_b64_tr_b16 v[180:181], v245 offset:4096
    ds_read_b64_tr_b16 v[182:183], v245 offset:5120
    v_fmac_f32 v196, v62, v102
    v_fmac_f32 v196, v63, v103
    v_mfma_f32_32x32x8_bf16 v[32:47], v[80:81], v[184:185], v[32:47]
    v_mul_f32 v198, v64, v128
    v_fmac_f32 v198, v65, v129
    v_fmac_f32 v198, v66, v130
    v_fmac_f32 v198, v67, v131
    v_fmac_f32 v198, v68, v132
    v_fmac_f32 v198, v69, v133
    v_mfma_f32_32x32x8_bf16 v[0:15], v[84:85], v[184:185], v[0:15]
    v_fmac_f32 v198, v70, v134
    v_fmac_f32 v198, v71, v135
    v_mul_f32 v200, v16, v128
    v_fmac_f32 v200, v17, v129
    v_permlane32_swap_b32 v196, v198
    v_fmac_f32 v200, v18, v130
    v_fmac_f32 v200, v19, v131
    v_fmac_f32 v200, v20, v132
    v_fmac_f32 v200, v21, v133
    v_fmac_f32 v200, v22, v134
    v_fmac_f32 v200, v23, v135
    v_add_f32 v198, v196, v198
    v_mul_f32_e64 v202, v24, -v128
    v_fma_f32 v202, v25, -v129, v202
    v_fma_f32 v202, v26, -v130, v202
    v_fma_f32 v202, v27, -v131, v202
    v_fma_f32 v202, v28, -v132, v202
    v_fma_f32 v202, v29, -v133, v202
    v_fma_f32 v202, v30, -v134, v202
    v_fma_f32 v202, v31, -v135, v202
    s_nop 1
    v_permlane32_swap_b32 v200, v202
    v_add_f32 v202, v200, v202
    s_waitcnt vmcnt(3) lgkmcnt(0)
    v_mfma_f32_32x32x16_bf16 v[56:71], v[72:75], v[176:179], 0
    v_mul_f32 v197, v32, v104
    v_fmac_f32 v197, v33, v105
    v_fmac_f32 v197, v34, v106
    v_fmac_f32 v197, v35, v107
    v_fmac_f32 v197, v36, v108
    v_fmac_f32 v197, v37, v109
    s_add_u32 m0, s21, 4096
    v_mfma_f32_32x32x16_bf16 v[16:31], v[76:79], v[176:179], 0
    buffer_load_dwordx4 v234, s[4:7], s37 offen  lds
    buffer_load_dwordx4 v235, s[8:11], s37 offen offset:1024  lds
    ds_read_b64_tr_b16 v[176:177], v244 offset:6144
    ds_read_b64_tr_b16 v[184:185], v245 offset:6144
    v_add_u32 v252, s42, v247
    ds_read2_b32 v[234:235], v252 offset0:0 offset1:16
    v_fmac_f32 v197, v38, v110
    v_fmac_f32 v197, v39, v111
    v_mul_f32 v199, v40, v136
    v_fmac_f32 v199, v41, v137
    v_fmac_f32 v199, v42, v138
    v_fmac_f32 v199, v43, v139
    v_fmac_f32 v199, v44, v140
    v_fmac_f32 v199, v45, v141
    v_fmac_f32 v199, v46, v142
    v_fmac_f32 v199, v47, v143
    v_mul_f32 v201, v0, v136
    v_fmac_f32 v201, v1, v137
    v_permlane32_swap_b32 v197, v199
    v_fmac_f32 v201, v2, v138
    v_fmac_f32 v201, v3, v139
    v_fmac_f32 v201, v4, v140
    v_fmac_f32 v201, v5, v141
    v_fmac_f32 v201, v6, v142
    v_fmac_f32 v201, v7, v143
    v_add_f32 v199, v197, v199
    v_mul_f32_e64 v203, v8, -v136
    v_fma_f32 v203, v9, -v137, v203
    v_fma_f32 v203, v10, -v138, v203
    s_waitcnt lgkmcnt(1)
    v_mfma_f32_32x32x8_bf16 v[56:71], v[80:81], v[176:177], v[56:71]
    v_fma_f32 v203, v11, -v139, v203
    v_fma_f32 v203, v12, -v140, v203
    v_fma_f32 v203, v13, -v141, v203
    v_fma_f32 v203, v14, -v142, v203
    v_fma_f32 v203, v15, -v143, v203
    s_nop 1
    v_permlane32_swap_b32 v201, v203
    s_add_u32 m0, s21, 6144
    v_mfma_f32_32x32x8_bf16 v[16:31], v[84:85], v[176:177], v[16:31]
    buffer_load_dwordx4 v236, s[4:7], s37 offen  lds
    v_add_u32 v252, s43, v247
    ds_read2_b32 v[236:237], v252 offset0:0 offset1:16
    v_add_f32 v203, v201, v203
    s_set_gpr_idx_on s51, gpr_idx(DST)
    s_nop 0
    v_cvt_pk_bf16_f32 v204, v198, v199
    v_cvt_pk_bf16_f32 v205, v202, v203
    s_set_gpr_idx_off
    v_mfma_f32_32x32x16_bf16 v[32:47], v[72:75], v[180:183], 0
    v_mul_f32 v196, v56, v144
    v_fmac_f32 v196, v57, v145
    v_fmac_f32 v196, v58, v146
    v_fmac_f32 v196, v59, v147
    v_fmac_f32 v196, v60, v148
    v_fmac_f32 v196, v61, v149
    v_mfma_f32_32x32x16_bf16 v[0:15], v[76:79], v[180:183], 0
    s_waitcnt vmcnt(4)
    ds_read_b64_tr_b16 v[176:177], v244 offset:0
    ds_read_b64_tr_b16 v[178:179], v244 offset:1024
    ds_read_b64_tr_b16 v[180:181], v245 offset:0
    ds_read_b64_tr_b16 v[182:183], v245 offset:1024
    v_fmac_f32 v196, v62, v150
    v_fmac_f32 v196, v63, v151
    v_mfma_f32_32x32x8_bf16 v[32:47], v[80:81], v[184:185], v[32:47]
    v_mul_f32_e64 v200, v16, -v160
    v_fma_f32 v200, v17, -v161, v200
    v_fma_f32 v200, v18, -v162, v200
    v_fma_f32 v200, v19, -v163, v200
    v_fma_f32 v200, v20, -v164, v200
    v_fma_f32 v200, v21, -v165, v200
    v_mfma_f32_32x32x8_bf16 v[0:15], v[84:85], v[184:185], v[0:15]
    v_fma_f32 v200, v22, -v166, v200
    v_fma_f32 v200, v23, -v167, v200
    v_mul_f32_e64 v202, v24, -v160
    v_fma_f32 v202, v25, -v161, v202
    v_fma_f32 v202, v26, -v162, v202
    v_fma_f32 v202, v27, -v163, v202
    v_fma_f32 v202, v28, -v164, v202
    v_fma_f32 v202, v29, -v165, v202
    v_fma_f32 v202, v30, -v166, v202
    v_fma_f32 v202, v31, -v167, v202
    s_waitcnt vmcnt(3) lgkmcnt(0)
    v_mfma_f32_32x32x16_bf16 v[16:31], v[72:75], v[176:179], 0
    v_mul_f32 v197, v32, v152
    v_fmac_f32 v197, v33, v153
    v_fmac_f32 v197, v34, v154
    v_fmac_f32 v197, v35, v155
    v_fmac_f32 v197, v36, v156
    v_fmac_f32 v197, v37, v157
    s_add_u32 m0, s21, 0
    v_mfma_f32_32x32x16_bf16 v[48:63], v[76:79], v[176:179], 0
    v_mad_u32_u16 v234, v234, s3, v246 op_sel:[1,0,0,0]
    v_mad_u32_u16 v235, v235, s3, v246 op_sel:[1,0,0,0]
    buffer_load_dwordx4 v234, s[4:7], s38 offen  lds
    buffer_load_dwordx4 v235, s[8:11], s38 offen offset:1024  lds
    ds_read_b64_tr_b16 v[176:177], v244 offset:2048
    ds_read_b64_tr_b16 v[184:185], v245 offset:2048
    v_fmac_f32 v197, v38, v158
    v_fmac_f32 v197, v39, v159
    v_mul_f32_e64 v201, v0, -v168
    v_fma_f32 v201, v1, -v169, v201
    v_fma_f32 v201, v2, -v170, v201
    v_fma_f32 v201, v3, -v171, v201
    v_fma_f32 v201, v4, -v172, v201
    v_fma_f32 v201, v5, -v173, v201
    v_fma_f32 v201, v6, -v174, v201
    v_fma_f32 v201, v7, -v175, v201
    s_waitcnt lgkmcnt(0)
    v_mfma_f32_32x32x8_bf16 v[16:31], v[80:81], v[176:177], v[16:31]
    v_mul_f32_e64 v203, v8, -v168
    v_fma_f32 v203, v9, -v169, v203
    v_fma_f32 v203, v10, -v170, v203
    v_fma_f32 v203, v11, -v171, v203
    v_fma_f32 v203, v12, -v172, v203
    v_fma_f32 v203, v13, -v173, v203
    s_add_u32 m0, s21, 2048
    v_mfma_f32_32x32x8_bf16 v[48:63], v[84:85], v[176:177], v[48:63]
    v_mad_u32_u16 v236, v236, s3, v246 op_sel:[1,0,0,0]
    v_mad_u32_u16 v237, v237, s3, v246 op_sel:[1,0,0,0]
    buffer_load_dwordx4 v236, s[4:7], s39 offen  lds
    buffer_load_dwordx4 v237, s[8:11], s39 offen offset:1024  lds
    v_fma_f32 v203, v14, -v174, v203
    v_fma_f32 v203, v15, -v175, v203
    v_mfma_f32_32x32x16_bf16 v[0:15], v[72:75], v[180:183], 0
    v_fmac_f32 v200, v24, v160
    v_fmac_f32 v200, v25, v161
    v_fmac_f32 v200, v26, v162
    v_fmac_f32 v200, v27, v163
    v_fmac_f32 v200, v28, v164
    v_fmac_f32 v200, v29, v165
    v_fmac_f32 v200, v30, v166
    v_fmac_f32 v200, v31, v167
    v_mfma_f32_32x32x16_bf16 v[24:39], v[76:79], v[180:183], 0
    v_add_u32 v253, s47, v248
    ds_read_b32 v192, v253
    ds_read_b32 v193, v253 offset:256
    s_waitcnt vmcnt(5)
    ds_read_b64_tr_b16 v[176:177], v244 offset:4096
    ds_read_b64_tr_b16 v[178:179], v244 offset:5120
    ds_read_b64_tr_b16 v[180:181], v245 offset:4096
    ds_read_b64_tr_b16 v[182:183], v245 offset:5120
    v_mfma_f32_32x32x8_bf16 v[24:39], v[84:85], v[184:185], v[24:39]
    v_mul_f32 v254, v16, v144
    v_fmac_f32 v254, v17, v145
    v_fmac_f32 v254, v18, v146
    v_fmac_f32 v254, v19, v147
    v_fmac_f32 v254, v20, v148
    v_fmac_f32 v254, v21, v149
    v_mfma_f32_32x32x8_bf16 v[0:15], v[80:81], v[184:185], v[0:15]
    v_fmac_f32 v254, v22, v150
    v_fmac_f32 v254, v23, v151
    v_sub_f32_e64 v64, -v48, v64
    v_sub_f32_e64 v65, -v49, v65
    v_permlane32_swap_b32 v196, v254
    v_sub_f32_e64 v66, -v50, v66
    v_sub_f32_e64 v67, -v51, v67
    v_sub_f32_e64 v68, -v52, v68
    v_sub_f32_e64 v69, -v53, v69
    v_sub_f32_e64 v70, -v54, v70
    v_sub_f32_e64 v71, -v55, v71
    v_add_f32 v254, v196, v254
    s_waitcnt vmcnt(4) lgkmcnt(0)
    v_mfma_f32_32x32x16_bf16 v[56:71], v[76:79], v[176:179], v[56:71]
    v_sub_f32_e64 v40, -v24, v40
    v_sub_f32_e64 v41, -v25, v41
    v_sub_f32_e64 v42, -v26, v42
    v_sub_f32_e64 v43, -v27, v43
    v_sub_f32_e64 v44, -v28, v44
    v_sub_f32_e64 v45, -v29, v45
    v_sub_f32_e64 v46, -v30, v46
    v_sub_f32_e64 v47, -v31, v47
    s_mov_b32 m0, s76
    s_mov_b64 exec, s[72:73]
    buffer_load_dwordx4 v192, s[12:15], 0 offen  lds
    s_mov_b32 m0, s77
    s_mov_b64 exec, s[74:75]
    buffer_load_dwordx4 v193, s[12:15], 0 offen  lds
    s_mov_b64 exec, -1
    s_add_u32 m0, s21, 4096
    v_mfma_f32_32x32x16_bf16 v[16:31], v[72:75], v[176:179], 0
    v_mad_u32_u16 v238, v238, s3, v246 op_sel:[1,0,0,0]
    v_mad_u32_u16 v239, v239, s3, v246 op_sel:[1,0,0,0]
    buffer_load_dwordx4 v238, s[4:7], s40 offen  lds
    buffer_load_dwordx4 v239, s[8:11], s40 offen offset:1024  lds
    ds_read_b64_tr_b16 v[176:177], v244 offset:6144
    ds_read_b64_tr_b16 v[184:185], v245 offset:6144
    v_mul_f32 v255, v0, v152
    v_fmac_f32 v255, v1, v153
    v_fmac_f32 v255, v2, v154
    v_fmac_f32 v255, v3, v155
    v_fmac_f32 v255, v4, v156
    v_fmac_f32 v255, v5, v157
    v_fmac_f32 v255, v6, v158
    v_fmac_f32 v255, v7, v159
    v_fmac_f32 v201, v8, v168
    v_fmac_f32 v201, v9, v169
    v_permlane32_swap_b32 v197, v255
    s_waitcnt lgkmcnt(0)
    v_mfma_f32_32x32x8_bf16 v[16:31], v[80:81], v[176:177], v[16:31]
    v_fmac_f32 v201, v10, v170
    v_fmac_f32 v201, v11, v171
    v_fmac_f32 v201, v12, v172
    v_fmac_f32 v201, v13, v173
    v_fmac_f32 v201, v14, v174
    v_fmac_f32 v201, v15, v175
    s_add_u32 m0, s21, 6144
    v_mfma_f32_32x32x8_bf16 v[56:71], v[84:85], v[176:177], v[56:71]
    v_mad_u32_u16 v240, v240, s3, v246 op_sel:[1,0,0,0]
    v_mad_u32_u16 v241, v241, s3, v246 op_sel:[1,0,0,0]
    buffer_load_dwordx4 v240, s[4:7], s41 offen  lds
    buffer_load_dwordx4 v241, s[8:11], s41 offen offset:1024  lds
    v_add_f32 v255, v197, v255
    s_set_gpr_idx_on s51, gpr_idx(DST)
    s_nop 0
    v_cvt_pk_bf16_f32 v206, v254, v255
    s_set_gpr_idx_off
    v_mfma_f32_32x32x16_bf16 v[0:15], v[72:75], v[180:183], 0
    v_mul_f32 v254, v16, v144
    v_fmac_f32 v254, v17, v145
    v_fmac_f32 v254, v18, v146
    v_fmac_f32 v254, v19, v147
    v_fmac_f32 v254, v20, v148
    v_fmac_f32 v254, v21, v149
    v_mfma_f32_32x32x16_bf16 v[32:47], v[76:79], v[180:183], v[32:47]
    s_waitcnt vmcnt(8)
    ds_read_b64_tr_b16 v[176:177], v244 offset:0
    ds_read_b64_tr_b16 v[178:179], v244 offset:1024
    ds_read_b64_tr_b16 v[180:181], v245 offset:0
    ds_read_b64_tr_b16 v[182:183], v245 offset:1024
    v_fmac_f32 v254, v22, v150
    v_fmac_f32 v254, v23, v151
    v_mfma_f32_32x32x8_bf16 v[0:15], v[80:81], v[184:185], v[0:15]
    v_fma_f32 v202, v24, -v160, v202
    v_fma_f32 v202, v25, -v161, v202
    v_permlane32_swap_b32 v254, v200
    v_fma_f32 v202, v26, -v162, v202
    v_fma_f32 v202, v27, -v163, v202
    v_fma_f32 v202, v28, -v164, v202
    v_mfma_f32_32x32x8_bf16 v[32:47], v[84:85], v[184:185], v[32:47]
    v_add_u32 v249, s48, v249
    v_add_u32 v250, s49, v250
    v_fma_f32 v202, v29, -v165, v202
    v_fma_f32 v202, v30, -v166, v202
    v_fma_f32 v202, v31, -v167, v202
    v_add_f32 v200, v254, v200
    v_mul_f32_e64 v198, v64, -v112
    v_permlane32_swap_b32 v202, v254
    v_fma_f32 v198, v65, -v113, v198
    v_fma_f32 v198, v66, -v114, v198
    v_fma_f32 v198, v67, -v115, v198
    v_fma_f32 v198, v68, -v116, v198
    v_fma_f32 v198, v69, -v117, v198
    v_fma_f32 v198, v70, -v118, v198
    v_fma_f32 v198, v71, -v119, v198
    v_add_f32 v254, v202, v254
    v_mul_f32 v196, v56, v160
    v_fmac_f32 v196, v57, v161
    v_fmac_f32 v196, v58, v162
    v_fmac_f32 v196, v59, v163
    v_fmac_f32 v196, v60, v164
    v_fmac_f32 v196, v61, v165
    v_fmac_f32 v196, v62, v166
    v_fmac_f32 v196, v63, v167
    s_nop 1
    v_permlane32_swap_b32 v198, v196
    v_add_f32 v196, v198, v196
    v_mul_f32 v255, v0, v152
    v_fmac_f32 v255, v1, v153
    v_fmac_f32 v255, v2, v154
    v_fmac_f32 v255, v3, v155
    v_fmac_f32 v255, v4, v156
    v_fmac_f32 v255, v5, v157
    v_fmac_f32 v255, v6, v158
    v_fmac_f32 v255, v7, v159
    v_fma_f32 v203, v8, -v168, v203
    v_fma_f32 v203, v9, -v169, v203
    v_permlane32_swap_b32 v255, v201
    v_fma_f32 v203, v10, -v170, v203
    v_fma_f32 v203, v11, -v171, v203
    v_fma_f32 v203, v12, -v172, v203
    v_fma_f32 v203, v13, -v173, v203
    v_fma_f32 v203, v14, -v174, v203
    v_fma_f32 v203, v15, -v175, v203
    v_add_f32 v201, v255, v201
    v_mul_f32_e64 v199, v40, -v120
    v_permlane32_swap_b32 v203, v255
    v_fma_f32 v199, v41, -v121, v199
    v_fma_f32 v199, v42, -v122, v199
    v_fma_f32 v199, v43, -v123, v199
    s_waitcnt vmcnt(4)
    ds_read_b64_tr_b16 v[72:73], v249 offset:0
    ds_read_b64_tr_b16 v[76:77], v249 offset:64
    ds_read_b64_tr_b16 v[74:75], v249 offset:256
    ds_read_b64_tr_b16 v[78:79], v249 offset:320
    s_mov_b64 exec, s[54:55]
    ds_read_u16_d16_hi v242, v250 offset:0
    s_mov_b64 exec, -1
    v_fma_f32 v199, v44, -v124, v199
    v_fma_f32 v199, v45, -v125, v199
    v_fma_f32 v199, v46, -v126, v199
    v_fma_f32 v199, v47, -v127, v199
    v_add_f32 v255, v203, v255
    v_mul_f32 v197, v32, v168
    v_fmac_f32 v197, v33, v169
    v_fmac_f32 v197, v34, v170
    v_fmac_f32 v197, v35, v171
    v_fmac_f32 v197, v36, v172
    v_fmac_f32 v197, v37, v173
    v_fmac_f32 v197, v38, v174
    v_fmac_f32 v197, v39, v175
    s_nop 1
    v_permlane32_swap_b32 v199, v197
    v_add_f32 v197, v199, v197
    s_set_gpr_idx_on s51, gpr_idx(DST)
    s_nop 0
    v_cvt_pk_bf16_f32 v207, v200, v201
    v_cvt_pk_bf16_f32 v209, v254, v255
    v_cvt_pk_bf16_f32 v208, v196, v197
    s_set_gpr_idx_off
    s_add_u32 s50, s50, 1
    s_add_u32 s51, s51, 6
    s_cmp_ge_u32 s50, 4
    s_cbranch_scc1 LAST0
    s_add_u32 s53, s53, 4
    s_xor_b32 s66, s53, s20
    s_bitcmp1_b32 s66, 2
    s_setprio 1
    s_cbranch_scc1 PRIO_7
    s_setprio 0
PRIO_7:
    s_cmp_eq_u32 s52, 4
    s_cbranch_scc1 ITEM_0_4
    s_cmp_eq_u32 s52, 5
    s_cbranch_scc1 ITEM_0_5
    s_cmp_eq_u32 s52, 3
    s_cbranch_scc1 ITEM_0_3
    s_cmp_eq_u32 s52, 6
    s_cbranch_scc1 ITEM_0_6
    s_cmp_eq_u32 s52, 8
    s_cbranch_scc1 ITEM_0_8
    s_branch ITEM_0_2
.p2align 6
ITEM_0_6:
    s_mov_b64 exec, s[54:55]
    ds_read_u16_d16_hi v243, v250 offset:128
    s_mov_b64 exec, -1
    ds_read_b64_tr_b16 v[80:81], v249 offset:512
    ds_read_b64_tr_b16 v[84:85], v249 offset:576
    ds_read_b64_tr_b16 v[82:83], v249 offset:768
    ds_read_b64_tr_b16 v[86:87], v249 offset:832
    ds_read_b64_tr_b16 v[88:89], v249 offset:1024
    ds_read_b64_tr_b16 v[92:93], v249 offset:1088
    ds_read_b64_tr_b16 v[90:91], v249 offset:1280
    ds_read_b64_tr_b16 v[94:95], v249 offset:1344
    s_waitcnt lgkmcnt(9)
    v_mul_f32_dpp v196, v242, v72 row_newbcast:0 row_mask:0xf bank_mask:0xf
    v_mul_f32_dpp v197, v242, v73 row_newbcast:1 row_mask:0xf bank_mask:0xf
    v_mul_f32_dpp v198, v242, v72 row_newbcast:8 row_mask:0xf bank_mask:0xf
    v_mul_f32_dpp v199, v242, v73 row_newbcast:9 row_mask:0xf bank_mask:0xf
    v_mul_f32_dpp v200, v242, v76 row_newbcast:2 row_mask:0xf bank_mask:0xf
    v_mul_f32_dpp v201, v242, v77 row_newbcast:3 row_mask:0xf bank_mask:0xf
    v_mul_f32_dpp v202, v242, v76 row_newbcast:10 row_mask:0xf bank_mask:0xf
    v_mul_f32_dpp v203, v242, v77 row_newbcast:11 row_mask:0xf bank_mask:0xf
    v_cvt_pk_bf16_f32 v72, v196, v197
    v_cvt_pk_bf16_f32 v76, v198, v199
    v_cvt_pk_bf16_f32 v73, v200, v201
    v_cvt_pk_bf16_f32 v77, v202, v203
    v_mul_f32_dpp v196, v242, v74 row_newbcast:4 row_mask:0xf bank_mask:0xf
    v_mul_f32_dpp v197, v242, v75 row_newbcast:5 row_mask:0xf bank_mask:0xf
    v_mul_f32_dpp v198, v242, v74 row_newbcast:12 row_mask:0xf bank_mask:0xf
    v_mul_f32_dpp v199, v242, v75 row_newbcast:13 row_mask:0xf bank_mask:0xf
    v_mul_f32_dpp v200, v242, v78 row_newbcast:6 row_mask:0xf bank_mask:0xf
    v_mul_f32_dpp v201, v242, v79 row_newbcast:7 row_mask:0xf bank_mask:0xf
    v_mul_f32_dpp v202, v242, v78 row_newbcast:14 row_mask:0xf bank_mask:0xf
    v_mul_f32_dpp v203, v242, v79 row_newbcast:15 row_mask:0xf bank_mask:0xf
    v_cvt_pk_bf16_f32 v74, v196, v197
    v_cvt_pk_bf16_f32 v78, v198, v199
    v_cvt_pk_bf16_f32 v75, v200, v201
    v_cvt_pk_bf16_f32 v79, v202, v203
    s_mov_b64 exec, s[54:55]
    ds_read_u16_d16_hi v242, v250 offset:256
    s_mov_b64 exec, -1
    s_waitcnt vmcnt(4) lgkmcnt(5)
    v_mfma_f32_32x32x16_bf16 v[56:71], v[72:75], v[176:179], 0
    v_mul_f32_dpp v196, v243, v80 row_newbcast:0 row_mask:0xf bank_mask:0xf
    v_mul_f32_dpp v197, v243, v81 row_newbcast:1 row_mask:0xf bank_mask:0xf
    v_mul_f32_dpp v198, v243, v80 row_newbcast:8 row_mask:0xf bank_mask:0xf
    v_mul_f32_dpp v199, v243, v81 row_newbcast:9 row_mask:0xf bank_mask:0xf
    v_mul_f32_dpp v200, v243, v84 row_newbcast:2 row_mask:0xf bank_mask:0xf
    v_mul_f32_dpp v201, v243, v85 row_newbcast:3 row_mask:0xf bank_mask:0xf
    s_add_u32 m0, s21, 0
    v_mfma_f32_32x32x16_bf16 v[16:31], v[76:79], v[176:179], 0
    buffer_load_dwordx4 v236, s[4:7], s35 offen  lds
    buffer_load_dwordx4 v237, s[8:11], s35 offen offset:1024  lds
    ds_read_b64_tr_b16 v[176:177], v244 offset:2048
    ds_read_b64_tr_b16 v[178:179], v244 offset:3072
    ds_read_b64_tr_b16 v[184:185], v245 offset:2048
    ds_read_b64_tr_b16 v[186:187], v245 offset:3072
    v_mul_f32_dpp v202, v243, v84 row_newbcast:10 row_mask:0xf bank_mask:0xf
    v_mul_f32_dpp v203, v243, v85 row_newbcast:11 row_mask:0xf bank_mask:0xf
    v_cvt_pk_bf16_f32 v80, v196, v197
    v_cvt_pk_bf16_f32 v84, v198, v199
    v_cvt_pk_bf16_f32 v81, v200, v201
    v_cvt_pk_bf16_f32 v85, v202, v203
    v_mul_f32_dpp v196, v243, v82 row_newbcast:4 row_mask:0xf bank_mask:0xf
    v_mul_f32_dpp v197, v243, v83 row_newbcast:5 row_mask:0xf bank_mask:0xf
    v_mul_f32_dpp v198, v243, v82 row_newbcast:12 row_mask:0xf bank_mask:0xf
    v_mul_f32_dpp v199, v243, v83 row_newbcast:13 row_mask:0xf bank_mask:0xf
    v_mul_f32_dpp v200, v243, v86 row_newbcast:6 row_mask:0xf bank_mask:0xf
    v_mul_f32_dpp v201, v243, v87 row_newbcast:7 row_mask:0xf bank_mask:0xf
    v_mul_f32_dpp v202, v243, v86 row_newbcast:14 row_mask:0xf bank_mask:0xf
    v_mul_f32_dpp v203, v243, v87 row_newbcast:15 row_mask:0xf bank_mask:0xf
    v_cvt_pk_bf16_f32 v82, v196, v197
    v_cvt_pk_bf16_f32 v86, v198, v199
    v_cvt_pk_bf16_f32 v83, v200, v201
    v_cvt_pk_bf16_f32 v87, v202, v203
    s_waitcnt vmcnt(4) lgkmcnt(0)
    v_mfma_f32_32x32x16_bf16 v[56:71], v[80:83], v[176:179], v[56:71]
    v_mul_f32_dpp v196, v242, v88 row_newbcast:0 row_mask:0xf bank_mask:0xf
    v_mul_f32_dpp v197, v242, v89 row_newbcast:1 row_mask:0xf bank_mask:0xf
    v_mul_f32_dpp v198, v242, v88 row_newbcast:8 row_mask:0xf bank_mask:0xf
    v_mul_f32_dpp v199, v242, v89 row_newbcast:9 row_mask:0xf bank_mask:0xf
    v_mul_f32_dpp v200, v242, v92 row_newbcast:2 row_mask:0xf bank_mask:0xf
    v_mul_f32_dpp v201, v242, v93 row_newbcast:3 row_mask:0xf bank_mask:0xf
    s_add_u32 m0, s21, 2048
    v_mfma_f32_32x32x16_bf16 v[16:31], v[84:87], v[176:179], v[16:31]
    buffer_load_dwordx4 v238, s[4:7], s35 offen  lds
    buffer_load_dwordx4 v239, s[8:11], s35 offen offset:1024  lds
    ds_read_b64_tr_b16 v[176:177], v244 offset:4096
    ds_read_b64_tr_b16 v[178:179], v244 offset:5120
    ds_read_b64_tr_b16 v[188:189], v245 offset:4096
    ds_read_b64_tr_b16 v[190:191], v245 offset:5120
    v_mul_f32_dpp v202, v242, v92 row_newbcast:10 row_mask:0xf bank_mask:0xf
    v_mul_f32_dpp v203, v242, v93 row_newbcast:11 row_mask:0xf bank_mask:0xf
    v_cvt_pk_bf16_f32 v88, v196, v197
    v_cvt_pk_bf16_f32 v92, v198, v199
    v_cvt_pk_bf16_f32 v89, v200, v201
    v_cvt_pk_bf16_f32 v93, v202, v203
    v_mul_f32_dpp v196, v242, v90 row_newbcast:4 row_mask:0xf bank_mask:0xf
    v_mul_f32_dpp v197, v242, v91 row_newbcast:5 row_mask:0xf bank_mask:0xf
    v_mul_f32_dpp v198, v242, v90 row_newbcast:12 row_mask:0xf bank_mask:0xf
    v_mul_f32_dpp v199, v242, v91 row_newbcast:13 row_mask:0xf bank_mask:0xf
    v_mul_f32_dpp v200, v242, v94 row_newbcast:6 row_mask:0xf bank_mask:0xf
    v_mul_f32_dpp v201, v242, v95 row_newbcast:7 row_mask:0xf bank_mask:0xf
    v_mul_f32_dpp v202, v242, v94 row_newbcast:14 row_mask:0xf bank_mask:0xf
    v_mul_f32_dpp v203, v242, v95 row_newbcast:15 row_mask:0xf bank_mask:0xf
    v_cvt_pk_bf16_f32 v90, v196, v197
    v_cvt_pk_bf16_f32 v94, v198, v199
    v_cvt_pk_bf16_f32 v91, v200, v201
    v_cvt_pk_bf16_f32 v95, v202, v203
    s_waitcnt lgkmcnt(0)
    v_mfma_f32_32x32x16_bf16 v[56:71], v[88:91], v[176:179], v[56:71]
    s_add_u32 m0, s21, 4096
    v_mfma_f32_32x32x16_bf16 v[16:31], v[92:95], v[176:179], v[16:31]
    buffer_load_dwordx4 v234, s[4:7], s36 offen  lds
    buffer_load_dwordx4 v235, s[8:11], s36 offen offset:1024  lds
    s_mov_b32 m0, s50
    s_nop 0
    s_movrels_b32 s71, s23
    s_bfe_u32 s46, s71, 0x30012
    s_mov_b32 m0, s46
    s_and_b32 s66, s71, 0x3ffff
    s_movrels_b32 s68, s57
    s_movrels_b32 s69, s61
    s_sub_u32 s48, s66, s47
    s_mov_b32 s47, s66
    s_lshr_b32 s52, s71, 28
    s_lshl_b32 s67, s46, 9
    s_add_u32 s66, s66, s67
    s_sub_u32 s49, s66, s42
    s_mov_b32 s42, s66
    s_bfe_u32 s66, s68, 655360
    s_add_u32 s43, s42, s66
    s_bfe_u32 s39, s69, 655360
    s_bfe_u32 s66, s68, 655370
    s_add_u32 s44, s42, s66
    s_bfe_u32 s40, s69, 655370
    s_bfe_u32 s66, s68, 655380
    s_add_u32 s45, s42, s66
    s_bfe_u32 s41, s69, 655380
    s_and_b32 s66, s46, s33
    s_cselect_b32 s72, -1, 1
    s_cselect_b32 s76, s47, 163712
    s_cmp_ge_u32 s66, 2
    s_cselect_b32 s73, -1, 0
    s_add_u32 s77, s47, 1024
    s_cmp_ge_u32 s66, 4
    s_cselect_b32 s75, -1, 0
    s_cmp_ge_u32 s66, 3
    s_cselect_b32 s74, -1, 1
    s_cselect_b32 s77, s77, 163712
    v_add_u32 v252, s45, v247
    ds_read2_b32 v[240:241], v252 offset0:0 offset1:16
    v_mfma_f32_32x32x16_bf16 v[32:47], v[72:75], v[180:183], 0
    v_mul_f32 v196, v56, v96
    v_fmac_f32 v196, v57, v97
    v_fmac_f32 v196, v58, v98
    v_fmac_f32 v196, v59, v99
    v_fmac_f32 v196, v60, v100
    v_fmac_f32 v196, v61, v101
    v_mfma_f32_32x32x16_bf16 v[0:15], v[76:79], v[180:183], 0
    v_fmac_f32 v196, v62, v102
    v_fmac_f32 v196, v63, v103
    v_mul_f32 v198, v64, v128
    v_fmac_f32 v198, v65, v129
    v_fmac_f32 v198, v66, v130
    v_fmac_f32 v198, v67, v131
    v_mfma_f32_32x32x16_bf16 v[32:47], v[80:83], v[184:187], v[32:47]
    v_fmac_f32 v198, v68, v132
    v_fmac_f32 v198, v69, v133
    v_fmac_f32 v198, v70, v134
    v_fmac_f32 v198, v71, v135
    v_mul_f32 v200, v16, v128
    v_fmac_f32 v200, v17, v129
    v_mfma_f32_32x32x16_bf16 v[0:15], v[84:87], v[184:187], v[0:15]
    s_waitcnt vmcnt(6)
    ds_read_b64_tr_b16 v[176:177], v244 offset:6144
    ds_read_b64_tr_b16 v[178:179], v244 offset:7168
    ds_read_b64_tr_b16 v[180:181], v245 offset:6144
    ds_read_b64_tr_b16 v[182:183], v245 offset:7168
    v_permlane32_swap_b32 v196, v198
    v_fmac_f32 v200, v18, v130
    v_mfma_f32_32x32x16_bf16 v[32:47], v[88:91], v[188:191], v[32:47]
    v_fmac_f32 v200, v19, v131
    v_fmac_f32 v200, v20, v132
    v_fmac_f32 v200, v21, v133
    v_fmac_f32 v200, v22, v134
    v_fmac_f32 v200, v23, v135
    v_add_f32 v198, v196, v198
    v_mfma_f32_32x32x16_bf16 v[0:15], v[92:95], v[188:191], v[0:15]
    v_mul_f32_e64 v202, v24, -v128
    v_fma_f32 v202, v25, -v129, v202
    v_fma_f32 v202, v26, -v130, v202
    v_fma_f32 v202, v27, -v131, v202
    v_fma_f32 v202, v28, -v132, v202
    v_fma_f32 v202, v29, -v133, v202
    v_fma_f32 v202, v30, -v134, v202
    v_fma_f32 v202, v31, -v135, v202
    s_nop 1
    v_permlane32_swap_b32 v200, v202
    v_add_f32 v202, v200, v202
    s_waitcnt vmcnt(4) lgkmcnt(0)
    v_mfma_f32_32x32x16_bf16 v[56:71], v[72:75], v[176:179], 0
    v_mul_f32 v197, v32, v104
    v_fmac_f32 v197, v33, v105
    v_fmac_f32 v197, v34, v106
    v_fmac_f32 v197, v35, v107
    v_fmac_f32 v197, v36, v108
    v_fmac_f32 v197, v37, v109
    s_add_u32 m0, s21, 6144
    v_mfma_f32_32x32x16_bf16 v[16:31], v[76:79], v[176:179], 0
    buffer_load_dwordx4 v236, s[4:7], s36 offen  lds
    buffer_load_dwordx4 v237, s[8:11], s36 offen offset:1024  lds
    ds_read_b64_tr_b16 v[176:177], v244 offset:0
    ds_read_b64_tr_b16 v[178:179], v244 offset:1024
    ds_read_b64_tr_b16 v[184:185], v245 offset:0
    ds_read_b64_tr_b16 v[186:187], v245 offset:1024
    v_fmac_f32 v197, v38, v110
    v_fmac_f32 v197, v39, v111
    v_mul_f32 v199, v40, v136
    v_fmac_f32 v199, v41, v137
    v_fmac_f32 v199, v42, v138
    v_fmac_f32 v199, v43, v139
    v_fmac_f32 v199, v44, v140
    v_fmac_f32 v199, v45, v141
    v_fmac_f32 v199, v46, v142
    v_fmac_f32 v199, v47, v143
    v_mul_f32 v201, v0, v136
    v_fmac_f32 v201, v1, v137
    v_permlane32_swap_b32 v197, v199
    v_fmac_f32 v201, v2, v138
    v_fmac_f32 v201, v3, v139
    v_fmac_f32 v201, v4, v140
    v_fmac_f32 v201, v5, v141
    v_fmac_f32 v201, v6, v142
    s_waitcnt vmcnt(4) lgkmcnt(0)
    v_mfma_f32_32x32x16_bf16 v[56:71], v[80:83], v[176:179], v[56:71]
    v_fmac_f32 v201, v7, v143
    v_add_f32 v199, v197, v199
    v_mul_f32_e64 v203, v8, -v136
    v_fma_f32 v203, v9, -v137, v203
    v_fma_f32 v203, v10, -v138, v203
    v_fma_f32 v203, v11, -v139, v203
    s_add_u32 m0, s21, 0
    v_mfma_f32_32x32x16_bf16 v[16:31], v[84:87], v[176:179], v[16:31]
    buffer_load_dwordx4 v238, s[4:7], s36 offen  lds
    buffer_load_dwordx4 v239, s[8:11], s36 offen offset:1024  lds
    ds_read_b64_tr_b16 v[176:177], v244 offset:2048
    ds_read_b64_tr_b16 v[178:179], v244 offset:3072
    ds_read_b64_tr_b16 v[188:189], v245 offset:2048
    ds_read_b64_tr_b16 v[190:191], v245 offset:3072
    s_waitcnt lgkmcnt(0)
    v_mfma_f32_32x32x16_bf16 v[56:71], v[88:91], v[176:179], v[56:71]
    v_fma_f32 v203, v12, -v140, v203
    v_fma_f32 v203, v13, -v141, v203
    v_fma_f32 v203, v14, -v142, v203
    v_fma_f32 v203, v15, -v143, v203
    s_nop 1
    v_permlane32_swap_b32 v201, v203
    v_add_f32 v203, v201, v203
    s_add_u32 m0, s21, 2048
    v_mfma_f32_32x32x16_bf16 v[16:31], v[92:95], v[176:179], v[16:31]
    buffer_load_dwordx4 v234, s[4:7], s37 offen  lds
    buffer_load_dwordx4 v235, s[8:11], s37 offen offset:1024  lds
    v_add_u32 v252, s42, v247
    ds_read2_b32 v[234:235], v252 offset0:0 offset1:16
    s_set_gpr_idx_on s51, gpr_idx(DST)
    s_nop 0
    v_cvt_pk_bf16_f32 v204, v198, v199
    v_cvt_pk_bf16_f32 v205, v202, v203
    s_set_gpr_idx_off
    v_mfma_f32_32x32x16_bf16 v[32:47], v[72:75], v[180:183], 0
    v_mul_f32 v196, v56, v144
    v_fmac_f32 v196, v57, v145
    v_fmac_f32 v196, v58, v146
    v_fmac_f32 v196, v59, v147
    v_fmac_f32 v196, v60, v148
    v_fmac_f32 v196, v61, v149
    v_mfma_f32_32x32x16_bf16 v[0:15], v[76:79], v[180:183], 0
    v_fmac_f32 v196, v62, v150
    v_fmac_f32 v196, v63, v151
    v_mul_f32_e64 v200, v16, -v160
    v_fma_f32 v200, v17, -v161, v200
    v_fma_f32 v200, v18, -v162, v200
    v_fma_f32 v200, v19, -v163, v200
    v_mfma_f32_32x32x16_bf16 v[32:47], v[80:83], v[184:187], v[32:47]
    v_fma_f32 v200, v20, -v164, v200
    v_fma_f32 v200, v21, -v165, v200
    v_fma_f32 v200, v22, -v166, v200
    v_fma_f32 v200, v23, -v167, v200
    v_mul_f32_e64 v202, v24, -v160
    v_fma_f32 v202, v25, -v161, v202
    v_mfma_f32_32x32x16_bf16 v[0:15], v[84:87], v[184:187], v[0:15]
    s_waitcnt vmcnt(6)
    ds_read_b64_tr_b16 v[176:177], v244 offset:4096
    ds_read_b64_tr_b16 v[178:179], v244 offset:5120
    ds_read_b64_tr_b16 v[180:181], v245 offset:4096
    ds_read_b64_tr_b16 v[182:183], v245 offset:5120
    v_fma_f32 v202, v26, -v162, v202
    v_fma_f32 v202, v27, -v163, v202
    v_mfma_f32_32x32x16_bf16 v[32:47], v[88:91], v[188:191], v[32:47]
    v_fma_f32 v202, v28, -v164, v202
    v_fma_f32 v202, v29, -v165, v202
    v_fma_f32 v202, v30, -v166, v202
    v_fma_f32 v202, v31, -v167, v202
    v_mfma_f32_32x32x16_bf16 v[0:15], v[92:95], v[188:191], v[0:15]
    s_waitcnt vmcnt(4) lgkmcnt(0)
    v_mfma_f32_32x32x16_bf16 v[16:31], v[72:75], v[176:179], 0
    s_nop 4
    v_mul_f32 v197, v32, v152
    v_fmac_f32 v197, v33, v153
    v_fmac_f32 v197, v34, v154
    v_fmac_f32 v197, v35, v155
    v_fmac_f32 v197, v36, v156
    v_fmac_f32 v197, v37, v157
    s_add_u32 m0, s21, 4096
    v_mfma_f32_32x32x16_bf16 v[48:63], v[76:79], v[176:179], 0
    buffer_load_dwordx4 v236, s[4:7], s37 offen  lds
    buffer_load_dwordx4 v237, s[8:11], s37 offen offset:1024  lds
    ds_read_b64_tr_b16 v[176:177], v244 offset:6144
    ds_read_b64_tr_b16 v[178:179], v244 offset:7168
    ds_read_b64_tr_b16 v[184:185], v245 offset:6144
    ds_read_b64_tr_b16 v[186:187], v245 offset:7168
    v_add_u32 v252, s43, v247
    ds_read2_b32 v[236:237], v252 offset0:0 offset1:16
    v_fmac_f32 v197, v38, v158
    v_fmac_f32 v197, v39, v159
    v_mul_f32_e64 v201, v0, -v168
    v_fma_f32 v201, v1, -v169, v201
    s_waitcnt vmcnt(4) lgkmcnt(1)
    v_mfma_f32_32x32x16_bf16 v[16:31], v[80:83], v[176:179], v[16:31]
    v_fma_f32 v201, v2, -v170, v201
    v_fma_f32 v201, v3, -v171, v201
    v_fma_f32 v201, v4, -v172, v201
    v_fma_f32 v201, v5, -v173, v201
    v_fma_f32 v201, v6, -v174, v201
    v_fma_f32 v201, v7, -v175, v201
    s_add_u32 m0, s21, 6144
    v_mfma_f32_32x32x16_bf16 v[48:63], v[84:87], v[176:179], v[48:63]
    buffer_load_dwordx4 v238, s[4:7], s37 offen  lds
    buffer_load_dwordx4 v239, s[8:11], s37 offen offset:1024  lds
    ds_read_b64_tr_b16 v[176:177], v244 offset:0
    ds_read_b64_tr_b16 v[178:179], v244 offset:1024
    ds_read_b64_tr_b16 v[188:189], v245 offset:0
    ds_read_b64_tr_b16 v[190:191], v245 offset:1024
    v_add_u32 v252, s44, v247
    ds_read2_b32 v[238:239], v252 offset0:0 offset1:16
    s_waitcnt lgkmcnt(1)
    v_mfma_f32_32x32x16_bf16 v[16:31], v[88:91], v[176:179], v[16:31]
    v_mul_f32_e64 v203, v8, -v168
    v_fma_f32 v203, v9, -v169, v203
    v_fma_f32 v203, v10, -v170, v203
    v_fma_f32 v203, v11, -v171, v203
    v_fma_f32 v203, v12, -v172, v203
    v_fma_f32 v203, v13, -v173, v203
    s_add_u32 m0, s21, 0
    v_mfma_f32_32x32x16_bf16 v[48:63], v[92:95], v[176:179], v[48:63]
    v_mad_u32_u16 v234, v234, s3, v246 op_sel:[1,0,0,0]
    v_mad_u32_u16 v235, v235, s3, v246 op_sel:[1,0,0,0]
    buffer_load_dwordx4 v234, s[4:7], s38 offen  lds
    buffer_load_dwordx4 v235, s[8:11], s38 offen offset:1024  lds
    v_fma_f32 v203, v14, -v174, v203
    v_fma_f32 v203, v15, -v175, v203
    v_mfma_f32_32x32x16_bf16 v[0:15], v[72:75], v[180:183], 0
    v_fmac_f32 v200, v24, v160
    v_fmac_f32 v200, v25, v161
    v_fmac_f32 v200, v26, v162
    v_fmac_f32 v200, v27, v163
    v_fmac_f32 v200, v28, v164
    v_fmac_f32 v200, v29, v165
    v_fmac_f32 v200, v30, v166
    v_fmac_f32 v200, v31, v167
    v_mfma_f32_32x32x16_bf16 v[24:39], v[76:79], v[180:183], 0
    v_add_u32 v253, s47, v248
    ds_read_b32 v192, v253
    ds_read_b32 v193, v253 offset:256
    v_mul_f32 v254, v16, v144
    v_fmac_f32 v254, v17, v145
    v_fmac_f32 v254, v18, v146
    v_mfma_f32_32x32x16_bf16 v[0:15], v[80:83], v[184:187], v[0:15]
    v_fmac_f32 v254, v19, v147
    v_fmac_f32 v254, v20, v148
    v_fmac_f32 v254, v21, v149
    v_fmac_f32 v254, v22, v150
    v_fmac_f32 v254, v23, v151
    v_sub_f32_e64 v64, -v48, v64
    v_mfma_f32_32x32x16_bf16 v[24:39], v[84:87], v[184:187], v[24:39]
    s_waitcnt vmcnt(6)
    ds_read_b64_tr_b16 v[176:177], v244 offset:2048
    ds_read_b64_tr_b16 v[178:179], v244 offset:3072
    ds_read_b64_tr_b16 v[180:181], v245 offset:2048
    ds_read_b64_tr_b16 v[182:183], v245 offset:3072
    v_sub_f32_e64 v65, -v49, v65
    v_permlane32_swap_b32 v196, v254
    v_mfma_f32_32x32x16_bf16 v[24:39], v[92:95], v[188:191], v[24:39]
    v_sub_f32_e64 v66, -v50, v66
    v_sub_f32_e64 v67, -v51, v67
    v_sub_f32_e64 v68, -v52, v68
    v_sub_f32_e64 v69, -v53, v69
    v_sub_f32_e64 v70, -v54, v70
    v_sub_f32_e64 v71, -v55, v71
    v_mfma_f32_32x32x16_bf16 v[0:15], v[88:91], v[188:191], v[0:15]
    v_add_f32 v254, v196, v254
    s_waitcnt vmcnt(4) lgkmcnt(0)
    v_mfma_f32_32x32x16_bf16 v[56:71], v[76:79], v[176:179], v[56:71]
    s_nop 1
    v_sub_f32_e64 v40, -v24, v40
    v_sub_f32_e64 v41, -v25, v41
    v_sub_f32_e64 v42, -v26, v42
    v_sub_f32_e64 v43, -v27, v43
    v_sub_f32_e64 v44, -v28, v44
    v_sub_f32_e64 v45, -v29, v45
    v_sub_f32_e64 v46, -v30, v46
    v_sub_f32_e64 v47, -v31, v47
    s_mov_b32 m0, s76
    s_mov_b64 exec, s[72:73]
    buffer_load_dwordx4 v192, s[12:15], 0 offen  lds
    s_mov_b32 m0, s77
    s_mov_b64 exec, s[74:75]
    buffer_load_dwordx4 v193, s[12:15], 0 offen  lds
    s_mov_b64 exec, -1
    s_add_u32 m0, s21, 2048
    v_mfma_f32_32x32x16_bf16 v[16:31], v[72:75], v[176:179], 0
    v_mad_u32_u16 v236, v236, s3, v246 op_sel:[1,0,0,0]
    v_mad_u32_u16 v237, v237, s3, v246 op_sel:[1,0,0,0]
    buffer_load_dwordx4 v236, s[4:7], s39 offen  lds
    buffer_load_dwordx4 v237, s[8:11], s39 offen offset:1024  lds
    ds_read_b64_tr_b16 v[176:177], v244 offset:4096
    ds_read_b64_tr_b16 v[178:179], v244 offset:5120
    ds_read_b64_tr_b16 v[184:185], v245 offset:4096
    ds_read_b64_tr_b16 v[186:187], v245 offset:5120
    v_mul_f32 v255, v0, v152
    v_fmac_f32 v255, v1, v153
    v_fmac_f32 v255, v2, v154
    v_fmac_f32 v255, v3, v155
    v_fmac_f32 v255, v4, v156
    s_waitcnt vmcnt(6) lgkmcnt(0)
    v_mfma_f32_32x32x16_bf16 v[16:31], v[80:83], v[176:179], v[16:31]
    v_fmac_f32 v255, v5, v157
    v_fmac_f32 v255, v6, v158
    v_fmac_f32 v255, v7, v159
    v_fmac_f32 v201, v8, v168
    v_fmac_f32 v201, v9, v169
    v_permlane32_swap_b32 v197, v255
    s_add_u32 m0, s21, 4096
    v_mfma_f32_32x32x16_bf16 v[56:71], v[84:87], v[176:179], v[56:71]
    v_mad_u32_u16 v238, v238, s3, v246 op_sel:[1,0,0,0]
    v_mad_u32_u16 v239, v239, s3, v246 op_sel:[1,0,0,0]
    buffer_load_dwordx4 v238, s[4:7], s40 offen  lds
    buffer_load_dwordx4 v239, s[8:11], s40 offen offset:1024  lds
    ds_read_b64_tr_b16 v[176:177], v244 offset:6144
    ds_read_b64_tr_b16 v[178:179], v244 offset:7168
    ds_read_b64_tr_b16 v[188:189], v245 offset:6144
    ds_read_b64_tr_b16 v[190:191], v245 offset:7168
    s_waitcnt lgkmcnt(0)
    v_mfma_f32_32x32x16_bf16 v[16:31], v[88:91], v[176:179], v[16:31]
    v_fmac_f32 v201, v10, v170
    v_fmac_f32 v201, v11, v171
    v_fmac_f32 v201, v12, v172
    v_fmac_f32 v201, v13, v173
    v_fmac_f32 v201, v14, v174
    v_fmac_f32 v201, v15, v175
    s_add_u32 m0, s21, 6144
    v_mfma_f32_32x32x16_bf16 v[56:71], v[92:95], v[176:179], v[56:71]
    v_mad_u32_u16 v240, v240, s3, v246 op_sel:[1,0,0,0]
    v_mad_u32_u16 v241, v241, s3, v246 op_sel:[1,0,0,0]
    buffer_load_dwordx4 v240, s[4:7], s41 offen  lds
    buffer_load_dwordx4 v241, s[8:11], s41 offen offset:1024  lds
    v_add_f32 v255, v197, v255
    s_set_gpr_idx_on s51, gpr_idx(DST)
    s_nop 0
    v_cvt_pk_bf16_f32 v206, v254, v255
    s_set_gpr_idx_off
    v_mfma_f32_32x32x16_bf16 v[0:15], v[72:75], v[180:183], 0
    v_mul_f32 v254, v16, v144
    v_fmac_f32 v254, v17, v145
    v_fmac_f32 v254, v18, v146
    v_fmac_f32 v254, v19, v147
    v_fmac_f32 v254, v20, v148
    v_fmac_f32 v254, v21, v149
    v_mfma_f32_32x32x16_bf16 v[32:47], v[76:79], v[180:183], v[32:47]
    v_fmac_f32 v254, v22, v150
    v_fmac_f32 v254, v23, v151
    v_fma_f32 v202, v24, -v160, v202
    v_fma_f32 v202, v25, -v161, v202
    v_permlane32_swap_b32 v254, v200
    v_fma_f32 v202, v26, -v162, v202
    v_mfma_f32_32x32x16_bf16 v[0:15], v[80:83], v[184:187], v[0:15]
    v_fma_f32 v202, v27, -v163, v202
    v_fma_f32 v202, v28, -v164, v202
    v_fma_f32 v202, v29, -v165, v202
    v_fma_f32 v202, v30, -v166, v202
    v_fma_f32 v202, v31, -v167, v202
    v_add_f32 v200, v254, v200
    v_mfma_f32_32x32x16_bf16 v[32:47], v[84:87], v[184:187], v[32:47]
    s_waitcnt vmcnt(8)
    ds_read_b64_tr_b16 v[176:177], v244 offset:0
    ds_read_b64_tr_b16 v[178:179], v244 offset:1024
    ds_read_b64_tr_b16 v[180:181], v245 offset:0
    ds_read_b64_tr_b16 v[182:183], v245 offset:1024
    v_mul_f32_e64 v198, v64, -v112
    v_permlane32_swap_b32 v202, v254
    v_mfma_f32_32x32x16_bf16 v[0:15], v[88:91], v[188:191], v[0:15]
    v_fma_f32 v198, v65, -v113, v198
    v_fma_f32 v198, v66, -v114, v198
    v_fma_f32 v198, v67, -v115, v198
    v_fma_f32 v198, v68, -v116, v198
    v_fma_f32 v198, v69, -v117, v198
    v_fma_f32 v198, v70, -v118, v198
    v_mfma_f32_32x32x16_bf16 v[32:47], v[92:95], v[188:191], v[32:47]
    v_add_u32 v249, s48, v249
    v_add_u32 v250, s49, v250
    v_fma_f32 v198, v71, -v119, v198
    v_add_f32 v254, v202, v254
    v_mul_f32 v196, v56, v160
    v_fmac_f32 v196, v57, v161
    v_fmac_f32 v196, v58, v162
    v_fmac_f32 v196, v59, v163
    v_fmac_f32 v196, v60, v164
    v_fmac_f32 v196, v61, v165
    v_fmac_f32 v196, v62, v166
    v_fmac_f32 v196, v63, v167
    s_nop 1
    v_permlane32_swap_b32 v198, v196
    v_add_f32 v196, v198, v196
    v_mul_f32 v255, v0, v152
    v_fmac_f32 v255, v1, v153
    v_fmac_f32 v255, v2, v154
    v_fmac_f32 v255, v3, v155
    v_fmac_f32 v255, v4, v156
    v_fmac_f32 v255, v5, v157
    v_fmac_f32 v255, v6, v158
    v_fmac_f32 v255, v7, v159
    v_fma_f32 v203, v8, -v168, v203
    v_fma_f32 v203, v9, -v169, v203
    v_permlane32_swap_b32 v255, v201
    v_fma_f32 v203, v10, -v170, v203
    v_fma_f32 v203, v11, -v171, v203
    v_fma_f32 v203, v12, -v172, v203
    v_fma_f32 v203, v13, -v173, v203
    v_fma_f32 v203, v14, -v174, v203
    v_fma_f32 v203, v15, -v175, v203
    v_add_f32 v201, v255, v201
    v_mul_f32_e64 v199, v40, -v120
    v_permlane32_swap_b32 v203, v255
    v_fma_f32 v199, v41, -v121, v199
    v_fma_f32 v199, v42, -v122, v199
    v_fma_f32 v199, v43, -v123, v199
    s_waitcnt vmcnt(6)
    ds_read_b64_tr_b16 v[72:73], v249 offset:0
    ds_read_b64_tr_b16 v[76:77], v249 offset:64
    ds_read_b64_tr_b16 v[74:75], v249 offset:256
    ds_read_b64_tr_b16 v[78:79], v249 offset:320
    s_mov_b64 exec, s[54:55]
    ds_read_u16_d16_hi v242, v250 offset:0
    s_mov_b64 exec, -1
    v_fma_f32 v199, v44, -v124, v199
    v_fma_f32 v199, v45, -v125, v199
    v_fma_f32 v199, v46, -v126, v199
    v_fma_f32 v199, v47, -v127, v199
    v_add_f32 v255, v203, v255
    v_mul_f32 v197, v32, v168
    v_fmac_f32 v197, v33, v169
    v_fmac_f32 v197, v34, v170
    v_fmac_f32 v197, v35, v171
    v_fmac_f32 v197, v36, v172
    v_fmac_f32 v197, v37, v173
    v_fmac_f32 v197, v38, v174
    v_fmac_f32 v197, v39, v175
    s_nop 1
    v_permlane32_swap_b32 v199, v197
    v_add_f32 v197, v199, v197
    s_set_gpr_idx_on s51, gpr_idx(DST)
    s_nop 0
    v_cvt_pk_bf16_f32 v207, v200, v201
    v_cvt_pk_bf16_f32 v209, v254, v255
    v_cvt_pk_bf16_f32 v208, v196, v197
    s_set_gpr_idx_off
    s_add_u32 s50, s50, 1
    s_add_u32 s51, s51, 6
    s_cmp_ge_u32 s50, 4
    s_cbranch_scc1 LAST0
    s_add_u32 s53, s53, 4
    s_xor_b32 s66, s53, s20
    s_bitcmp1_b32 s66, 2
    s_setprio 1
    s_cbranch_scc1 PRIO_8
    s_setprio 0
PRIO_8:
    s_cmp_eq_u32 s52, 4
    s_cbranch_scc1 ITEM_0_4
    s_cmp_eq_u32 s52, 5
    s_cbranch_scc1 ITEM_0_5
    s_cmp_eq_u32 s52, 3
    s_cbranch_scc1 ITEM_0_3
    s_cmp_eq_u32 s52, 6
    s_cbranch_scc1 ITEM_0_6
    s_cmp_eq_u32 s52, 8
    s_cbranch_scc1 ITEM_0_8
    s_branch ITEM_0_2
.p2align 6
ITEM_0_8:
    s_mov_b64 exec, s[54:55]
    ds_read_u16_d16_hi v243, v250 offset:128
    s_mov_b64 exec, -1
    ds_read_b64_tr_b16 v[80:81], v249 offset:512
    ds_read_b64_tr_b16 v[84:85], v249 offset:576
    ds_read_b64_tr_b16 v[82:83], v249 offset:768
    ds_read_b64_tr_b16 v[86:87], v249 offset:832
    ds_read_b64_tr_b16 v[88:89], v249 offset:1024
    ds_read_b64_tr_b16 v[92:93], v249 offset:1088
    ds_read_b64_tr_b16 v[90:91], v249 offset:1280
    ds_read_b64_tr_b16 v[94:95], v249 offset:1344
    ds_read_b64_tr_b16 v[64:65], v249 offset:1536
    ds_read_b64_tr_b16 v[68:69], v249 offset:1600
    ds_read_b64_tr_b16 v[66:67], v249 offset:1792
    ds_read_b64_tr_b16 v[70:71], v249 offset:1856
    s_waitcnt lgkmcnt(13)
    v_mul_f32_dpp v196, v242, v72 row_newbcast:0 row_mask:0xf bank_mask:0xf
    v_mul_f32_dpp v197, v242, v73 row_newbcast:1 row_mask:0xf bank_mask:0xf
    v_mul_f32_dpp v198, v242, v72 row_newbcast:8 row_mask:0xf bank_mask:0xf
    v_mul_f32_dpp v199, v242, v73 row_newbcast:9 row_mask:0xf bank_mask:0xf
    v_mul_f32_dpp v200, v242, v76 row_newbcast:2 row_mask:0xf bank_mask:0xf
    v_mul_f32_dpp v201, v242, v77 row_newbcast:3 row_mask:0xf bank_mask:0xf
    v_mul_f32_dpp v202, v242, v76 row_newbcast:10 row_mask:0xf bank_mask:0xf
    v_mul_f32_dpp v203, v242, v77 row_newbcast:11 row_mask:0xf bank_mask:0xf
    v_cvt_pk_bf16_f32 v72, v196, v197
    v_cvt_pk_bf16_f32 v76, v198, v199
    v_cvt_pk_bf16_f32 v73, v200, v201
    v_cvt_pk_bf16_f32 v77, v202, v203
    v_mul_f32_dpp v196, v242, v74 row_newbcast:4 row_mask:0xf bank_mask:0xf
    v_mul_f32_dpp v197, v242, v75 row_newbcast:5 row_mask:0xf bank_mask:0xf
    v_mul_f32_dpp v198, v242, v74 row_newbcast:12 row_mask:0xf bank_mask:0xf
    v_mul_f32_dpp v199, v242, v75 row_newbcast:13 row_mask:0xf bank_mask:0xf
    v_mul_f32_dpp v200, v242, v78 row_newbcast:6 row_mask:0xf bank_mask:0xf
    v_mul_f32_dpp v201, v242, v79 row_newbcast:7 row_mask:0xf bank_mask:0xf
    v_mul_f32_dpp v202, v242, v78 row_newbcast:14 row_mask:0xf bank_mask:0xf
    v_mul_f32_dpp v203, v242, v79 row_newbcast:15 row_mask:0xf bank_mask:0xf
    v_cvt_pk_bf16_f32 v74, v196, v197
    v_cvt_pk_bf16_f32 v78, v198, v199
    v_cvt_pk_bf16_f32 v75, v200, v201
    v_cvt_pk_bf16_f32 v79, v202, v203
    s_mov_b64 exec, s[54:55]
    ds_read_u16_d16_hi v242, v250 offset:256
    s_mov_b64 exec, -1
    s_waitcnt vmcnt(4) lgkmcnt(9)
    v_mfma_f32_32x32x16_bf16 v[0:15], v[72:75], v[176:179], 0
    v_mul_f32_dpp v196, v243, v80 row_newbcast:0 row_mask:0xf bank_mask:0xf
    v_mul_f32_dpp v197, v243, v81 row_newbcast:1 row_mask:0xf bank_mask:0xf
    v_mul_f32_dpp v198, v243, v80 row_newbcast:8 row_mask:0xf bank_mask:0xf
    v_mul_f32_dpp v199, v243, v81 row_newbcast:9 row_mask:0xf bank_mask:0xf
    v_mul_f32_dpp v200, v243, v84 row_newbcast:2 row_mask:0xf bank_mask:0xf
    v_mul_f32_dpp v201, v243, v85 row_newbcast:3 row_mask:0xf bank_mask:0xf
    s_add_u32 m0, s21, 0
    v_mfma_f32_32x32x16_bf16 v[48:63], v[76:79], v[176:179], 0
    buffer_load_dwordx4 v234, s[4:7], s35 offen  lds
    buffer_load_dwordx4 v235, s[8:11], s35 offen offset:1024  lds
    ds_read_b64_tr_b16 v[176:177], v244 offset:2048
    ds_read_b64_tr_b16 v[178:179], v244 offset:3072
    ds_read_b64_tr_b16 v[184:185], v245 offset:2048
    ds_read_b64_tr_b16 v[186:187], v245 offset:3072
    v_mul_f32_dpp v202, v243, v84 row_newbcast:10 row_mask:0xf bank_mask:0xf
    v_mul_f32_dpp v203, v243, v85 row_newbcast:11 row_mask:0xf bank_mask:0xf
    v_cvt_pk_bf16_f32 v80, v196, v197
    v_cvt_pk_bf16_f32 v84, v198, v199
    v_cvt_pk_bf16_f32 v81, v200, v201
    v_cvt_pk_bf16_f32 v85, v202, v203
    v_mul_f32_dpp v196, v243, v82 row_newbcast:4 row_mask:0xf bank_mask:0xf
    v_mul_f32_dpp v197, v243, v83 row_newbcast:5 row_mask:0xf bank_mask:0xf
    v_mul_f32_dpp v198, v243, v82 row_newbcast:12 row_mask:0xf bank_mask:0xf
    v_mul_f32_dpp v199, v243, v83 row_newbcast:13 row_mask:0xf bank_mask:0xf
    v_mul_f32_dpp v200, v243, v86 row_newbcast:6 row_mask:0xf bank_mask:0xf
    v_mul_f32_dpp v201, v243, v87 row_newbcast:7 row_mask:0xf bank_mask:0xf
    v_mul_f32_dpp v202, v243, v86 row_newbcast:14 row_mask:0xf bank_mask:0xf
    v_mul_f32_dpp v203, v243, v87 row_newbcast:15 row_mask:0xf bank_mask:0xf
    v_cvt_pk_bf16_f32 v82, v196, v197
    v_cvt_pk_bf16_f32 v86, v198, v199
    v_cvt_pk_bf16_f32 v83, v200, v201
    v_cvt_pk_bf16_f32 v87, v202, v203
    s_mov_b64 exec, s[54:55]
    ds_read_u16_d16_hi v243, v250 offset:384
    s_mov_b64 exec, -1
    s_waitcnt vmcnt(4) lgkmcnt(1)
    v_mfma_f32_32x32x16_bf16 v[0:15], v[80:83], v[176:179], v[0:15]
    v_mul_f32_dpp v196, v242, v88 row_newbcast:0 row_mask:0xf bank_mask:0xf
    v_mul_f32_dpp v197, v242, v89 row_newbcast:1 row_mask:0xf bank_mask:0xf
    v_mul_f32_dpp v198, v242, v88 row_newbcast:8 row_mask:0xf bank_mask:0xf
    v_mul_f32_dpp v199, v242, v89 row_newbcast:9 row_mask:0xf bank_mask:0xf
    v_mul_f32_dpp v200, v242, v92 row_newbcast:2 row_mask:0xf bank_mask:0xf
    v_mul_f32_dpp v201, v242, v93 row_newbcast:3 row_mask:0xf bank_mask:0xf
    s_add_u32 m0, s21, 2048
    v_mfma_f32_32x32x16_bf16 v[48:63], v[84:87], v[176:179], v[48:63]
    buffer_load_dwordx4 v236, s[4:7], s35 offen  lds
    buffer_load_dwordx4 v237, s[8:11], s35 offen offset:1024  lds
    ds_read_b64_tr_b16 v[176:177], v244 offset:4096
    ds_read_b64_tr_b16 v[178:179], v244 offset:5120
    ds_read_b64_tr_b16 v[188:189], v245 offset:4096
    ds_read_b64_tr_b16 v[190:191], v245 offset:5120
    v_mul_f32_dpp v202, v242, v92 row_newbcast:10 row_mask:0xf bank_mask:0xf
    v_mul_f32_dpp v203, v242, v93 row_newbcast:11 row_mask:0xf bank_mask:0xf
    v_cvt_pk_bf16_f32 v88, v196, v197
    v_cvt_pk_bf16_f32 v92, v198, v199
    v_cvt_pk_bf16_f32 v89, v200, v201
    v_cvt_pk_bf16_f32 v93, v202, v203
    v_mul_f32_dpp v196, v242, v90 row_newbcast:4 row_mask:0xf bank_mask:0xf
    v_mul_f32_dpp v197, v242, v91 row_newbcast:5 row_mask:0xf bank_mask:0xf
    v_mul_f32_dpp v198, v242, v90 row_newbcast:12 row_mask:0xf bank_mask:0xf
    v_mul_f32_dpp v199, v242, v91 row_newbcast:13 row_mask:0xf bank_mask:0xf
    v_mul_f32_dpp v200, v242, v94 row_newbcast:6 row_mask:0xf bank_mask:0xf
    v_mul_f32_dpp v201, v242, v95 row_newbcast:7 row_mask:0xf bank_mask:0xf
    v_mul_f32_dpp v202, v242, v94 row_newbcast:14 row_mask:0xf bank_mask:0xf
    v_mul_f32_dpp v203, v242, v95 row_newbcast:15 row_mask:0xf bank_mask:0xf
    v_cvt_pk_bf16_f32 v90, v196, v197
    v_cvt_pk_bf16_f32 v94, v198, v199
    v_cvt_pk_bf16_f32 v91, v200, v201
    v_cvt_pk_bf16_f32 v95, v202, v203
    s_waitcnt vmcnt(4) lgkmcnt(0)
    v_mfma_f32_32x32x16_bf16 v[0:15], v[88:91], v[176:179], v[0:15]
    v_mul_f32_dpp v196, v243, v64 row_newbcast:0 row_mask:0xf bank_mask:0xf
    v_mul_f32_dpp v197, v243, v65 row_newbcast:1 row_mask:0xf bank_mask:0xf
    v_mul_f32_dpp v198, v243, v64 row_newbcast:8 row_mask:0xf bank_mask:0xf
    v_mul_f32_dpp v199, v243, v65 row_newbcast:9 row_mask:0xf bank_mask:0xf
    v_mul_f32_dpp v200, v243, v68 row_newbcast:2 row_mask:0xf bank_mask:0xf
    v_mul_f32_dpp v201, v243, v69 row_newbcast:3 row_mask:0xf bank_mask:0xf
    s_add_u32 m0, s21, 4096
    v_mfma_f32_32x32x16_bf16 v[48:63], v[92:95], v[176:179], v[48:63]
    buffer_load_dwordx4 v238, s[4:7], s35 offen  lds
    buffer_load_dwordx4 v239, s[8:11], s35 offen offset:1024  lds
    ds_read_b64_tr_b16 v[176:177], v244 offset:6144
    ds_read_b64_tr_b16 v[178:179], v244 offset:7168
    ds_read_b64_tr_b16 v[192:193], v245 offset:6144
    ds_read_b64_tr_b16 v[194:195], v245 offset:7168
    v_mul_f32_dpp v202, v243, v68 row_newbcast:10 row_mask:0xf bank_mask:0xf
    v_mul_f32_dpp v203, v243, v69 row_newbcast:11 row_mask:0xf bank_mask:0xf
    v_cvt_pk_bf16_f32 v64, v196, v197
    v_cvt_pk_bf16_f32 v68, v198, v199
    v_cvt_pk_bf16_f32 v65, v200, v201
    v_cvt_pk_bf16_f32 v69, v202, v203
    v_mul_f32_dpp v196, v243, v66 row_newbcast:4 row_mask:0xf bank_mask:0xf
    v_mul_f32_dpp v197, v243, v67 row_newbcast:5 row_mask:0xf bank_mask:0xf
    v_mul_f32_dpp v198, v243, v66 row_newbcast:12 row_mask:0xf bank_mask:0xf
    v_mul_f32_dpp v199, v243, v67 row_newbcast:13 row_mask:0xf bank_mask:0xf
    v_mul_f32_dpp v200, v243, v70 row_newbcast:6 row_mask:0xf bank_mask:0xf
    v_mul_f32_dpp v201, v243, v71 row_newbcast:7 row_mask:0xf bank_mask:0xf
    v_mul_f32_dpp v202, v243, v70 row_newbcast:14 row_mask:0xf bank_mask:0xf
    v_mul_f32_dpp v203, v243, v71 row_newbcast:15 row_mask:0xf bank_mask:0xf
    v_cvt_pk_bf16_f32 v66, v196, v197
    v_cvt_pk_bf16_f32 v70, v198, v199
    v_cvt_pk_bf16_f32 v67, v200, v201
    v_cvt_pk_bf16_f32 v71, v202, v203
    s_waitcnt lgkmcnt(0)
    v_mfma_f32_32x32x16_bf16 v[0:15], v[64:67], v[176:179], v[0:15]
    s_add_u32 m0, s21, 6144
    v_mfma_f32_32x32x16_bf16 v[48:63], v[68:71], v[176:179], v[48:63]
    buffer_load_dwordx4 v240, s[4:7], s35 offen  lds
    buffer_load_dwordx4 v241, s[8:11], s35 offen offset:1024  lds
    s_mov_b32 m0, s50
    s_nop 0
    s_movrels_b32 s71, s23
    s_bfe_u32 s46, s71, 0x30012
    s_mov_b32 m0, s46
    s_and_b32 s66, s71, 0x3ffff
    s_movrels_b32 s68, s57
    s_movrels_b32 s69, s61
    s_sub_u32 s48, s66, s47
    s_mov_b32 s47, s66
    s_lshr_b32 s52, s71, 28
    s_lshl_b32 s67, s46, 9
    s_add_u32 s66, s66, s67
    s_sub_u32 s49, s66, s42
    s_mov_b32 s42, s66
    s_bfe_u32 s66, s68, 655360
    s_add_u32 s43, s42, s66
    s_bfe_u32 s39, s69, 655360
    s_bfe_u32 s66, s68, 655370
    s_add_u32 s44, s42, s66
    s_bfe_u32 s40, s69, 655370
    s_bfe_u32 s66, s68, 655380
    s_add_u32 s45, s42, s66
    s_bfe_u32 s41, s69, 655380
    s_and_b32 s66, s46, s33
    s_cselect_b32 s72, -1, 1
    s_cselect_b32 s76, s47, 163712
    s_cmp_ge_u32 s66, 2
    s_cselect_b32 s73, -1, 0
    s_add_u32 s77, s47, 1024
    s_cmp_ge_u32 s66, 4
    s_cselect_b32 s75, -1, 0
    s_cmp_ge_u32 s66, 3
    s_cselect_b32 s74, -1, 1
    s_cselect_b32 s77, s77, 163712
    v_mfma_f32_32x32x16_bf16 v[16:31], v[72:75], v[180:183], 0
    v_mul_f32 v196, v0, v96
    v_fmac_f32 v196, v1, v97
    v_fmac_f32 v196, v2, v98
    v_fmac_f32 v196, v3, v99
    v_fmac_f32 v196, v4, v100
    v_fmac_f32 v196, v5, v101
    v_mfma_f32_32x32x16_bf16 v[32:47], v[76:79], v[180:183], 0
    v_fmac_f32 v196, v6, v102
    v_fmac_f32 v196, v7, v103
    v_mul_f32 v198, v8, v128
    v_fmac_f32 v198, v9, v129
    v_fmac_f32 v198, v10, v130
    v_fmac_f32 v198, v11, v131
    v_mfma_f32_32x32x16_bf16 v[16:31], v[80:83], v[184:187], v[16:31]
    v_fmac_f32 v198, v12, v132
    v_fmac_f32 v198, v13, v133
    v_fmac_f32 v198, v14, v134
    v_fmac_f32 v198, v15, v135
    v_mul_f32 v200, v48, v128
    v_fmac_f32 v200, v49, v129
    v_mfma_f32_32x32x16_bf16 v[32:47], v[84:87], v[184:187], v[32:47]
    v_permlane32_swap_b32 v196, v198
    v_fmac_f32 v200, v50, v130
    v_fmac_f32 v200, v51, v131
    v_fmac_f32 v200, v52, v132
    v_fmac_f32 v200, v53, v133
    v_fmac_f32 v200, v54, v134
    v_mfma_f32_32x32x16_bf16 v[16:31], v[88:91], v[188:191], v[16:31]
    v_fmac_f32 v200, v55, v135
    v_add_f32 v198, v196, v198
    v_mul_f32_e64 v202, v56, -v128
    v_fma_f32 v202, v57, -v129, v202
    v_fma_f32 v202, v58, -v130, v202
    v_fma_f32 v202, v59, -v131, v202
    v_mfma_f32_32x32x16_bf16 v[32:47], v[92:95], v[188:191], v[32:47]
    s_waitcnt vmcnt(6)
    ds_read_b64_tr_b16 v[176:177], v244 offset:0
    ds_read_b64_tr_b16 v[178:179], v244 offset:1024
    ds_read_b64_tr_b16 v[180:181], v245 offset:0
    ds_read_b64_tr_b16 v[182:183], v245 offset:1024
    v_fma_f32 v202, v60, -v132, v202
    v_fma_f32 v202, v61, -v133, v202
    v_mfma_f32_32x32x16_bf16 v[16:31], v[64:67], v[192:195], v[16:31]
    v_fma_f32 v202, v62, -v134, v202
    v_fma_f32 v202, v63, -v135, v202
    s_nop 1
    v_permlane32_swap_b32 v200, v202
    v_add_f32 v202, v200, v202
    v_mfma_f32_32x32x16_bf16 v[32:47], v[68:71], v[192:195], v[32:47]
    s_waitcnt vmcnt(4) lgkmcnt(0)
    v_mfma_f32_32x32x16_bf16 v[0:15], v[72:75], v[176:179], 0
    s_nop 2
    v_mul_f32 v197, v16, v104
    v_fmac_f32 v197, v17, v105
    v_fmac_f32 v197, v18, v106
    v_fmac_f32 v197, v19, v107
    v_fmac_f32 v197, v20, v108
    v_fmac_f32 v197, v21, v109
    s_add_u32 m0, s21, 0
    v_mfma_f32_32x32x16_bf16 v[48:63], v[76:79], v[176:179], 0
    buffer_load_dwordx4 v234, s[4:7], s36 offen  lds
    buffer_load_dwordx4 v235, s[8:11], s36 offen offset:1024  lds
    ds_read_b64_tr_b16 v[176:177], v244 offset:2048
    ds_read_b64_tr_b16 v[178:179], v244 offset:3072
    ds_read_b64_tr_b16 v[184:185], v245 offset:2048
    ds_read_b64_tr_b16 v[186:187], v245 offset:3072
    v_fmac_f32 v197, v22, v110
    v_fmac_f32 v197, v23, v111
    v_mul_f32 v199, v24, v136
    v_fmac_f32 v199, v25, v137
    v_fmac_f32 v199, v26, v138
    v_fmac_f32 v199, v27, v139
    v_fmac_f32 v199, v28, v140
    v_fmac_f32 v199, v29, v141
    v_fmac_f32 v199, v30, v142
    v_fmac_f32 v199, v31, v143
    s_waitcnt vmcnt(4) lgkmcnt(0)
    v_mfma_f32_32x32x16_bf16 v[0:15], v[80:83], v[176:179], v[0:15]
    v_mul_f32 v201, v32, v136
    v_fmac_f32 v201, v33, v137
    v_permlane32_swap_b32 v197, v199
    v_fmac_f32 v201, v34, v138
    v_fmac_f32 v201, v35, v139
    v_fmac_f32 v201, v36, v140
    s_add_u32 m0, s21, 2048
    v_mfma_f32_32x32x16_bf16 v[48:63], v[84:87], v[176:179], v[48:63]
    buffer_load_dwordx4 v236, s[4:7], s36 offen  lds
    buffer_load_dwordx4 v237, s[8:11], s36 offen offset:1024  lds
    ds_read_b64_tr_b16 v[176:177], v244 offset:4096
    ds_read_b64_tr_b16 v[178:179], v244 offset:5120
    ds_read_b64_tr_b16 v[188:189], v245 offset:4096
    ds_read_b64_tr_b16 v[190:191], v245 offset:5120
    s_waitcnt vmcnt(4) lgkmcnt(0)
    v_mfma_f32_32x32x16_bf16 v[0:15], v[88:91], v[176:179], v[0:15]
    v_fmac_f32 v201, v37, v141
    v_fmac_f32 v201, v38, v142
    v_fmac_f32 v201, v39, v143
    v_add_f32 v199, v197, v199
    v_mul_f32_e64 v203, v40, -v136
    v_fma_f32 v203, v41, -v137, v203
    s_add_u32 m0, s21, 4096
    v_mfma_f32_32x32x16_bf16 v[48:63], v[92:95], v[176:179], v[48:63]
    buffer_load_dwordx4 v238, s[4:7], s36 offen  lds
    buffer_load_dwordx4 v239, s[8:11], s36 offen offset:1024  lds
    ds_read_b64_tr_b16 v[176:177], v244 offset:6144
    ds_read_b64_tr_b16 v[178:179], v244 offset:7168
    ds_read_b64_tr_b16 v[192:193], v245 offset:6144
    ds_read_b64_tr_b16 v[194:195], v245 offset:7168
    s_waitcnt lgkmcnt(0)
    v_mfma_f32_32x32x16_bf16 v[0:15], v[64:67], v[176:179], v[0:15]
    v_fma_f32 v203, v42, -v138, v203
    v_fma_f32 v203, v43, -v139, v203
    v_fma_f32 v203, v44, -v140, v203
    v_fma_f32 v203, v45, -v141, v203
    v_fma_f32 v203, v46, -v142, v203
    v_fma_f32 v203, v47, -v143, v203
    s_nop 1
    s_add_u32 m0, s21, 6144
    v_mfma_f32_32x32x16_bf16 v[48:63], v[68:71], v[176:179], v[48:63]
    buffer_load_dwordx4 v240, s[4:7], s36 offen  lds
    buffer_load_dwordx4 v241, s[8:11], s36 offen offset:1024  lds
    v_permlane32_swap_b32 v201, v203
    v_add_f32 v203, v201, v203
    s_set_gpr_idx_on s51, gpr_idx(DST)
    s_nop 0
    v_cvt_pk_bf16_f32 v204, v198, v199
    v_cvt_pk_bf16_f32 v205, v202, v203
    s_set_gpr_idx_off
    v_mfma_f32_32x32x16_bf16 v[16:31], v[72:75], v[180:183], 0
    v_mul_f32 v196, v0, v144
    v_fmac_f32 v196, v1, v145
    v_fmac_f32 v196, v2, v146
    v_fmac_f32 v196, v3, v147
    v_fmac_f32 v196, v4, v148
    v_fmac_f32 v196, v5, v149
    v_mfma_f32_32x32x16_bf16 v[32:47], v[76:79], v[180:183], 0
    v_add_u32 v253, s47, v248
    ds_read_b32 v254, v253
    ds_read_b32 v255, v253 offset:256
    v_fmac_f32 v196, v6, v150
    v_fmac_f32 v196, v7, v151
    v_mul_f32 v198, v8, v112
    v_mfma_f32_32x32x16_bf16 v[16:31], v[80:83], v[184:187], v[16:31]
    v_fmac_f32 v198, v9, v113
    v_fmac_f32 v198, v10, v114
    v_fmac_f32 v198, v11, v115
    v_fmac_f32 v198, v12, v116
    v_fmac_f32 v198, v13, v117
    v_fmac_f32 v198, v14, v118
    v_mfma_f32_32x32x16_bf16 v[32:47], v[84:87], v[184:187], v[32:47]
    v_fmac_f32 v198, v15, v119
    v_mul_f32_e64 v200, v48, -v160
    v_fma_f32 v200, v49, -v161, v200
    v_fma_f32 v200, v50, -v162, v200
    v_fma_f32 v200, v51, -v163, v200
    v_fma_f32 v200, v52, -v164, v200
    v_mfma_f32_32x32x16_bf16 v[16:31], v[88:91], v[188:191], v[16:31]
    v_fma_f32 v200, v53, -v165, v200
    v_fma_f32 v200, v54, -v166, v200
    v_fma_f32 v200, v55, -v167, v200
    v_mul_f32_e64 v202, v56, -v160
    v_fma_f32 v202, v57, -v161, v202
    v_fma_f32 v202, v58, -v162, v202
    v_mfma_f32_32x32x16_bf16 v[32:47], v[92:95], v[188:191], v[32:47]
    s_waitcnt vmcnt(6)
    ds_read_b64_tr_b16 v[176:177], v244 offset:0
    ds_read_b64_tr_b16 v[178:179], v244 offset:1024
    ds_read_b64_tr_b16 v[180:181], v245 offset:0
    ds_read_b64_tr_b16 v[182:183], v245 offset:1024
    v_fma_f32 v202, v59, -v163, v202
    v_fma_f32 v202, v60, -v164, v202
    v_mfma_f32_32x32x16_bf16 v[16:31], v[64:67], v[192:195], v[16:31]
    v_fma_f32 v202, v61, -v165, v202
    v_fma_f32 v202, v62, -v166, v202
    v_fma_f32 v202, v63, -v167, v202
    v_mfma_f32_32x32x16_bf16 v[32:47], v[68:71], v[192:195], v[32:47]
    s_waitcnt vmcnt(4) lgkmcnt(0)
    v_mfma_f32_32x32x16_bf16 v[0:15], v[72:75], v[176:179], 0
    s_nop 5
    v_mul_f32 v197, v16, v152
    v_fmac_f32 v197, v17, v153
    v_fmac_f32 v197, v18, v154
    v_fmac_f32 v197, v19, v155
    v_fmac_f32 v197, v20, v156
    v_fmac_f32 v197, v21, v157
    s_add_u32 m0, s21, 0
    v_mfma_f32_32x32x16_bf16 v[48:63], v[76:79], v[176:179], 0
    buffer_load_dwordx4 v234, s[4:7], s37 offen  lds
    buffer_load_dwordx4 v235, s[8:11], s37 offen offset:1024  lds
    ds_read_b64_tr_b16 v[176:177], v244 offset:2048
    ds_read_b64_tr_b16 v[178:179], v244 offset:3072
    ds_read_b64_tr_b16 v[184:185], v245 offset:2048
    ds_read_b64_tr_b16 v[186:187], v245 offset:3072
    v_add_u32 v252, s42, v247
    ds_read2_b32 v[234:235], v252 offset0:0 offset1:16
    s_mov_b32 m0, s76
    s_mov_b64 exec, s[72:73]
    buffer_load_dwordx4 v254, s[12:15], 0 offen  lds
    s_mov_b32 m0, s77
    s_mov_b64 exec, s[74:75]
    buffer_load_dwordx4 v255, s[12:15], 0 offen  lds
    s_mov_b64 exec, -1
    v_fmac_f32 v197, v22, v158
    v_fmac_f32 v197, v23, v159
    v_mul_f32 v199, v24, v120
    v_fmac_f32 v199, v25, v121
    v_fmac_f32 v199, v26, v122
    v_fmac_f32 v199, v27, v123
    s_waitcnt vmcnt(6) lgkmcnt(1)
    v_mfma_f32_32x32x16_bf16 v[0:15], v[80:83], v[176:179], v[0:15]
    v_fmac_f32 v199, v28, v124
    v_fmac_f32 v199, v29, v125
    v_fmac_f32 v199, v30, v126
    v_fmac_f32 v199, v31, v127
    v_mul_f32_e64 v201, v32, -v168
    v_fma_f32 v201, v33, -v169, v201
    s_add_u32 m0, s21, 2048
    v_mfma_f32_32x32x16_bf16 v[48:63], v[84:87], v[176:179], v[48:63]
    buffer_load_dwordx4 v236, s[4:7], s37 offen  lds
    buffer_load_dwordx4 v237, s[8:11], s37 offen offset:1024  lds
    ds_read_b64_tr_b16 v[176:177], v244 offset:4096
    ds_read_b64_tr_b16 v[178:179], v244 offset:5120
    ds_read_b64_tr_b16 v[188:189], v245 offset:4096
    ds_read_b64_tr_b16 v[190:191], v245 offset:5120
    v_add_u32 v252, s43, v247
    ds_read2_b32 v[236:237], v252 offset0:0 offset1:16
    s_waitcnt vmcnt(6) lgkmcnt(1)
    v_mfma_f32_32x32x16_bf16 v[0:15], v[88:91], v[176:179], v[0:15]
    v_fma_f32 v201, v34, -v170, v201
    v_fma_f32 v201, v35, -v171, v201
    v_fma_f32 v201, v36, -v172, v201
    v_fma_f32 v201, v37, -v173, v201
    v_fma_f32 v201, v38, -v174, v201
    v_fma_f32 v201, v39, -v175, v201
    s_add_u32 m0, s21, 4096
    v_mfma_f32_32x32x16_bf16 v[48:63], v[92:95], v[176:179], v[48:63]
    buffer_load_dwordx4 v238, s[4:7], s37 offen  lds
    buffer_load_dwordx4 v239, s[8:11], s37 offen offset:1024  lds
    ds_read_b64_tr_b16 v[176:177], v244 offset:6144
    ds_read_b64_tr_b16 v[178:179], v244 offset:7168
    ds_read_b64_tr_b16 v[192:193], v245 offset:6144
    ds_read_b64_tr_b16 v[194:195], v245 offset:7168
    v_add_u32 v252, s44, v247
    ds_read2_b32 v[238:239], v252 offset0:0 offset1:16
    s_waitcnt lgkmcnt(1)
    v_mfma_f32_32x32x16_bf16 v[0:15], v[64:67], v[176:179], v[0:15]
    v_mul_f32_e64 v203, v40, -v168
    v_fma_f32 v203, v41, -v169, v203
    v_fma_f32 v203, v42, -v170, v203
    v_fma_f32 v203, v43, -v171, v203
    v_fma_f32 v203, v44, -v172, v203
    v_fma_f32 v203, v45, -v173, v203
    s_add_u32 m0, s21, 6144
    v_mfma_f32_32x32x16_bf16 v[48:63], v[68:71], v[176:179], v[48:63]
    buffer_load_dwordx4 v240, s[4:7], s37 offen  lds
    buffer_load_dwordx4 v241, s[8:11], s37 offen offset:1024  lds
    v_add_u32 v252, s45, v247
    ds_read2_b32 v[240:241], v252 offset0:0 offset1:16
    v_fma_f32 v203, v46, -v174, v203
    v_fma_f32 v203, v47, -v175, v203
    v_mfma_f32_32x32x16_bf16 v[16:31], v[72:75], v[180:183], 0
    v_mul_f32 v254, v0, v144
    v_fmac_f32 v254, v1, v145
    v_fmac_f32 v254, v2, v146
    v_fmac_f32 v254, v3, v147
    v_fmac_f32 v254, v4, v148
    v_fmac_f32 v254, v5, v149
    v_mfma_f32_32x32x16_bf16 v[32:47], v[76:79], v[180:183], 0
    ds_swizzle_b32 v76, v76 offset:0x401F
    ds_swizzle_b32 v77, v77 offset:0x401F
    ds_swizzle_b32 v78, v78 offset:0x401F
    ds_swizzle_b32 v79, v79 offset:0x401F
    v_fmac_f32 v254, v6, v150
    v_fmac_f32 v254, v7, v151
    v_mfma_f32_32x32x16_bf16 v[16:31], v[80:83], v[184:187], v[16:31]
    v_fmac_f32 v200, v8, v160
    v_fmac_f32 v200, v9, v161
    v_permlane32_swap_b32 v196, v254
    v_fmac_f32 v200, v10, v162
    v_fmac_f32 v200, v11, v163
    v_fmac_f32 v200, v12, v164
    v_mfma_f32_32x32x16_bf16 v[32:47], v[84:87], v[184:187], v[32:47]
    ds_swizzle_b32 v84, v84 offset:0x401F
    ds_swizzle_b32 v85, v85 offset:0x401F
    ds_swizzle_b32 v86, v86 offset:0x401F
    ds_swizzle_b32 v87, v87 offset:0x401F
    v_fmac_f32 v200, v13, v165
    v_fmac_f32 v200, v14, v166
    v_mfma_f32_32x32x16_bf16 v[16:31], v[88:91], v[188:191], v[16:31]
    v_fmac_f32 v200, v15, v167
    v_add_f32 v254, v196, v254
    v_mfma_f32_32x32x16_bf16 v[32:47], v[92:95], v[188:191], v[32:47]
    ds_swizzle_b32 v92, v92 offset:0x401F
    ds_swizzle_b32 v93, v93 offset:0x401F
    ds_swizzle_b32 v94, v94 offset:0x401F
    ds_swizzle_b32 v95, v95 offset:0x401F
    s_waitcnt vmcnt(8)
    ds_read_b64_tr_b16 v[176:177], v244 offset:0
    ds_read_b64_tr_b16 v[178:179], v244 offset:1024
    ds_read_b64_tr_b16 v[180:181], v245 offset:0
    ds_read_b64_tr_b16 v[182:183], v245 offset:1024
    v_mfma_f32_32x32x16_bf16 v[16:31], v[64:67], v[192:195], v[16:31]
    v_mfma_f32_32x32x16_bf16 v[32:47], v[68:71], v[192:195], v[32:47]
    ds_swizzle_b32 v68, v68 offset:0x401F
    ds_swizzle_b32 v69, v69 offset:0x401F
    ds_swizzle_b32 v70, v70 offset:0x401F
    ds_swizzle_b32 v71, v71 offset:0x401F
    s_waitcnt lgkmcnt(8)
    s_mov_b64 exec, s[56:57]
    v_xor_b32 v76, 0x80008000, v76
    v_xor_b32 v77, 0x80008000, v77
    v_xor_b32 v78, 0x80008000, v78
    v_xor_b32 v79, 0x80008000, v79
    v_xor_b32 v84, 0x80008000, v84
    v_xor_b32 v85, 0x80008000, v85
    v_xor_b32 v86, 0x80008000, v86
    v_xor_b32 v87, 0x80008000, v87
    v_xor_b32 v92, 0x80008000, v92
    v_xor_b32 v93, 0x80008000, v93
    v_xor_b32 v94, 0x80008000, v94
    v_xor_b32 v95, 0x80008000, v95
    s_mov_b64 exec, -1
    s_waitcnt vmcnt(4) lgkmcnt(4)
    v_mfma_f32_32x32x16_bf16 v[0:15], v[72:75], v[176:179], 0
    v_mul_f32 v255, v16, v152
    v_fmac_f32 v255, v17, v153
    v_fmac_f32 v255, v18, v154
    v_fmac_f32 v255, v19, v155
    v_fmac_f32 v255, v20, v156
    v_fmac_f32 v255, v21, v157
    s_add_u32 m0, s21, 0
    v_mfma_f32_32x32x16_bf16 v[48:63], v[76:79], v[176:179], v[48:63]
    v_mad_u32_u16 v234, v234, s3, v246 op_sel:[1,0,0,0]
    v_mad_u32_u16 v235, v235, s3, v246 op_sel:[1,0,0,0]
    buffer_load_dwordx4 v234, s[4:7], s38 offen  lds
    buffer_load_dwordx4 v235, s[8:11], s38 offen offset:1024  lds
    ds_read_b64_tr_b16 v[176:177], v244 offset:2048
    ds_read_b64_tr_b16 v[178:179], v244 offset:3072
    ds_read_b64_tr_b16 v[184:185], v245 offset:2048
    ds_read_b64_tr_b16 v[186:187], v245 offset:3072
    s_waitcnt vmcnt(4) lgkmcnt(0)
    v_mfma_f32_32x32x16_bf16 v[0:15], v[80:83], v[176:179], v[0:15]
    s_add_u32 m0, s21, 2048
    v_mfma_f32_32x32x16_bf16 v[48:63], v[84:87], v[176:179], v[48:63]
    v_mad_u32_u16 v236, v236, s3, v246 op_sel:[1,0,0,0]
    v_mad_u32_u16 v237, v237, s3, v246 op_sel:[1,0,0,0]
    buffer_load_dwordx4 v236, s[4:7], s39 offen  lds
    buffer_load_dwordx4 v237, s[8:11], s39 offen offset:1024  lds
    ds_read_b64_tr_b16 v[176:177], v244 offset:4096
    ds_read_b64_tr_b16 v[178:179], v244 offset:5120
    ds_read_b64_tr_b16 v[188:189], v245 offset:4096
    ds_read_b64_tr_b16 v[190:191], v245 offset:5120
    s_waitcnt vmcnt(4) lgkmcnt(0)
    v_mfma_f32_32x32x16_bf16 v[0:15], v[88:91], v[176:179], v[0:15]
    v_fmac_f32 v255, v22, v158
    v_fmac_f32 v255, v23, v159
    v_fmac_f32 v201, v24, v168
    v_fmac_f32 v201, v25, v169
    v_permlane32_swap_b32 v197, v255
    s_add_u32 m0, s21, 4096
    v_mfma_f32_32x32x16_bf16 v[48:63], v[92:95], v[176:179], v[48:63]
    v_mad_u32_u16 v238, v238, s3, v246 op_sel:[1,0,0,0]
    v_mad_u32_u16 v239, v239, s3, v246 op_sel:[1,0,0,0]
    buffer_load_dwordx4 v238, s[4:7], s40 offen  lds
    buffer_load_dwordx4 v239, s[8:11], s40 offen offset:1024  lds
    ds_read_b64_tr_b16 v[176:177], v244 offset:6144
    ds_read_b64_tr_b16 v[178:179], v244 offset:7168
    ds_read_b64_tr_b16 v[192:193], v245 offset:6144
    ds_read_b64_tr_b16 v[194:195], v245 offset:7168
    s_waitcnt lgkmcnt(0)
    s_mov_b64 exec, s[56:57]
    v_xor_b32 v68, 0x80008000, v68
    v_xor_b32 v69, 0x80008000, v69
    v_xor_b32 v70, 0x80008000, v70
    v_xor_b32 v71, 0x80008000, v71
    s_mov_b64 exec, -1
    v_mfma_f32_32x32x16_bf16 v[0:15], v[64:67], v[176:179], v[0:15]
    v_fmac_f32 v201, v26, v170
    v_fmac_f32 v201, v27, v171
    v_fmac_f32 v201, v28, v172
    v_fmac_f32 v201, v29, v173
    v_fmac_f32 v201, v30, v174
    v_fmac_f32 v201, v31, v175
    s_add_u32 m0, s21, 6144
    v_mfma_f32_32x32x16_bf16 v[48:63], v[68:71], v[176:179], v[48:63]
    v_mad_u32_u16 v240, v240, s3, v246 op_sel:[1,0,0,0]
    v_mad_u32_u16 v241, v241, s3, v246 op_sel:[1,0,0,0]
    buffer_load_dwordx4 v240, s[4:7], s41 offen  lds
    buffer_load_dwordx4 v241, s[8:11], s41 offen offset:1024  lds
    v_add_f32 v255, v197, v255
    s_set_gpr_idx_on s51, gpr_idx(DST)
    s_nop 0
    v_cvt_pk_bf16_f32 v206, v254, v255
    s_set_gpr_idx_off
    v_mfma_f32_32x32x16_bf16 v[16:31], v[72:75], v[180:183], 0
    v_mul_f32 v254, v0, v144
    v_fmac_f32 v254, v1, v145
    v_fmac_f32 v254, v2, v146
    v_fmac_f32 v254, v3, v147
    v_fmac_f32 v254, v4, v148
    v_fmac_f32 v254, v5, v149
    v_mfma_f32_32x32x16_bf16 v[32:47], v[76:79], v[180:183], v[32:47]
    v_fmac_f32 v254, v6, v150
    v_fmac_f32 v254, v7, v151
    v_fma_f32 v202, v8, -v160, v202
    v_fma_f32 v202, v9, -v161, v202
    v_permlane32_swap_b32 v254, v200
    v_fma_f32 v202, v10, -v162, v202
    v_mfma_f32_32x32x16_bf16 v[16:31], v[80:83], v[184:187], v[16:31]
    v_fma_f32 v202, v11, -v163, v202
    v_fma_f32 v202, v12, -v164, v202
    v_fma_f32 v202, v13, -v165, v202
    v_fma_f32 v202, v14, -v166, v202
    v_fma_f32 v202, v15, -v167, v202
    v_add_f32 v200, v254, v200
    v_mfma_f32_32x32x16_bf16 v[32:47], v[84:87], v[184:187], v[32:47]
    v_fmac_f32 v198, v48, v112
    v_permlane32_swap_b32 v202, v254
    v_fmac_f32 v198, v49, v113
    v_fmac_f32 v198, v50, v114
    v_fmac_f32 v198, v51, v115
    v_fmac_f32 v198, v52, v116
    v_mfma_f32_32x32x16_bf16 v[16:31], v[88:91], v[188:191], v[16:31]
    v_fmac_f32 v198, v53, v117
    v_fmac_f32 v198, v54, v118
    v_fmac_f32 v198, v55, v119
    v_add_f32 v254, v202, v254
    v_mul_f32 v196, v56, v160
    v_fmac_f32 v196, v57, v161
    v_mfma_f32_32x32x16_bf16 v[32:47], v[92:95], v[188:191], v[32:47]
    s_waitcnt vmcnt(6)
    ds_read_b64_tr_b16 v[176:177], v244 offset:0
    ds_read_b64_tr_b16 v[178:179], v244 offset:1024
    ds_read_b64_tr_b16 v[180:181], v245 offset:0
    ds_read_b64_tr_b16 v[182:183], v245 offset:1024
    v_fmac_f32 v196, v58, v162
    v_fmac_f32 v196, v59, v163
    v_mfma_f32_32x32x16_bf16 v[16:31], v[64:67], v[192:195], v[16:31]
    v_fmac_f32 v196, v60, v164
    v_fmac_f32 v196, v61, v165
    v_fmac_f32 v196, v62, v166
    v_fmac_f32 v196, v63, v167
    s_nop 1
    v_permlane32_swap_b32 v198, v196
    v_add_f32 v196, v198, v196
    v_mfma_f32_32x32x16_bf16 v[32:47], v[68:71], v[192:195], v[32:47]
    v_add_u32 v249, s48, v249
    v_add_u32 v250, s49, v250
    s_nop 0
    v_mul_f32 v255, v16, v152
    v_fmac_f32 v255, v17, v153
    v_fmac_f32 v255, v18, v154
    v_fmac_f32 v255, v19, v155
    v_fmac_f32 v255, v20, v156
    v_fmac_f32 v255, v21, v157
    v_fmac_f32 v255, v22, v158
    v_fmac_f32 v255, v23, v159
    v_fma_f32 v203, v24, -v168, v203
    v_fma_f32 v203, v25, -v169, v203
    v_permlane32_swap_b32 v255, v201
    v_fma_f32 v203, v26, -v170, v203
    v_fma_f32 v203, v27, -v171, v203
    v_fma_f32 v203, v28, -v172, v203
    v_fma_f32 v203, v29, -v173, v203
    v_fma_f32 v203, v30, -v174, v203
    v_fma_f32 v203, v31, -v175, v203
    v_add_f32 v201, v255, v201
    v_fmac_f32 v199, v32, v120
    v_permlane32_swap_b32 v203, v255
    v_fmac_f32 v199, v33, v121
    v_fmac_f32 v199, v34, v122
    v_fmac_f32 v199, v35, v123
    ds_read_b64_tr_b16 v[72:73], v249 offset:0
    ds_read_b64_tr_b16 v[76:77], v249 offset:64
    ds_read_b64_tr_b16 v[74:75], v249 offset:256
    ds_read_b64_tr_b16 v[78:79], v249 offset:320
    s_mov_b64 exec, s[54:55]
    ds_read_u16_d16_hi v242, v250 offset:0
    s_mov_b64 exec, -1
    v_fmac_f32 v199, v36, v124
    v_fmac_f32 v199, v37, v125
    v_fmac_f32 v199, v38, v126
    v_fmac_f32 v199, v39, v127
    v_add_f32 v255, v203, v255
    v_mul_f32 v197, v40, v168
    v_fmac_f32 v197, v41, v169
    v_fmac_f32 v197, v42, v170
    v_fmac_f32 v197, v43, v171
    v_fmac_f32 v197, v44, v172
    v_fmac_f32 v197, v45, v173
    v_fmac_f32 v197, v46, v174
    v_fmac_f32 v197, v47, v175
    s_nop 1
    v_permlane32_swap_b32 v199, v197
    v_add_f32 v197, v199, v197
    s_set_gpr_idx_on s51, gpr_idx(DST)
    s_nop 0
    v_cvt_pk_bf16_f32 v207, v200, v201
    v_cvt_pk_bf16_f32 v209, v254, v255
    v_cvt_pk_bf16_f32 v208, v196, v197
    s_set_gpr_idx_off
    s_add_u32 s50, s50, 1
    s_add_u32 s51, s51, 6
    s_cmp_ge_u32 s50, 4
    s_cbranch_scc1 LAST0
    s_add_u32 s53, s53, 4
    s_xor_b32 s66, s53, s20
    s_bitcmp1_b32 s66, 2
    s_setprio 1
    s_cbranch_scc1 PRIO_9
    s_setprio 0
PRIO_9:
    s_cmp_eq_u32 s52, 4
    s_cbranch_scc1 ITEM_0_4
    s_cmp_eq_u32 s52, 5
    s_cbranch_scc1 ITEM_0_5
    s_cmp_eq_u32 s52, 3
    s_cbranch_scc1 ITEM_0_3
    s_cmp_eq_u32 s52, 6
    s_cbranch_scc1 ITEM_0_6
    s_cmp_eq_u32 s52, 8
    s_cbranch_scc1 ITEM_0_8
    s_branch ITEM_0_2
.p2align 6
ITEM_0_2:
    s_mov_b32 m0, s50
    s_nop 0
    s_movrels_b32 s71, s23
    s_bfe_u32 s46, s71, 0x30012
    s_mov_b32 m0, s46
    s_and_b32 s66, s71, 0x3ffff
    s_movrels_b32 s68, s57
    s_movrels_b32 s69, s61
    s_sub_u32 s48, s66, s47
    s_mov_b32 s47, s66
    s_lshr_b32 s52, s71, 28
    s_lshl_b32 s67, s46, 9
    s_add_u32 s66, s66, s67
    s_sub_u32 s49, s66, s42
    s_mov_b32 s42, s66
    s_bfe_u32 s66, s68, 655360
    s_add_u32 s43, s42, s66
    s_bfe_u32 s39, s69, 655360
    s_bfe_u32 s66, s68, 655370
    s_add_u32 s44, s42, s66
    s_bfe_u32 s40, s69, 655370
    s_bfe_u32 s66, s68, 655380
    s_add_u32 s45, s42, s66
    s_bfe_u32 s41, s69, 655380
    s_and_b32 s66, s46, s33
    s_cselect_b32 s72, -1, 1
    s_cselect_b32 s76, s47, 163712
    s_cmp_ge_u32 s66, 2
    s_cselect_b32 s73, -1, 0
    s_add_u32 s77, s47, 1024
    s_cmp_ge_u32 s66, 4
    s_cselect_b32 s75, -1, 0
    s_cmp_ge_u32 s66, 3
    s_cselect_b32 s74, -1, 1
    s_cselect_b32 s77, s77, 163712
    v_add_u32 v252, s42, v247
    ds_read2_b32 v[234:235], v252 offset0:0 offset1:16
    v_add_u32 v252, s43, v247
    ds_read2_b32 v[236:237], v252 offset0:0 offset1:16
    v_add_u32 v252, s44, v247
    ds_read2_b32 v[238:239], v252 offset0:0 offset1:16
    v_add_u32 v252, s45, v247
    ds_read2_b32 v[240:241], v252 offset0:0 offset1:16
    s_waitcnt lgkmcnt(4)
    v_mul_f32_dpp v196, v242, v72 row_newbcast:0 row_mask:0xf bank_mask:0xf
    v_mul_f32_dpp v197, v242, v73 row_newbcast:1 row_mask:0xf bank_mask:0xf
    v_mul_f32_dpp v198, v242, v72 row_newbcast:8 row_mask:0xf bank_mask:0xf
    v_mul_f32_dpp v199, v242, v73 row_newbcast:9 row_mask:0xf bank_mask:0xf
    v_mul_f32_dpp v200, v242, v76 row_newbcast:2 row_mask:0xf bank_mask:0xf
    v_mul_f32_dpp v201, v242, v77 row_newbcast:3 row_mask:0xf bank_mask:0xf
    v_mul_f32_dpp v202, v242, v76 row_newbcast:10 row_mask:0xf bank_mask:0xf
    v_mul_f32_dpp v203, v242, v77 row_newbcast:11 row_mask:0xf bank_mask:0xf
    v_cvt_pk_bf16_f32 v72, v196, v197
    v_cvt_pk_bf16_f32 v76, v198, v199
    v_cvt_pk_bf16_f32 v73, v200, v201
    v_cvt_pk_bf16_f32 v77, v202, v203
    v_mul_f32_dpp v196, v242, v74 row_newbcast:4 row_mask:0xf bank_mask:0xf
    v_mul_f32_dpp v197, v242, v75 row_newbcast:5 row_mask:0xf bank_mask:0xf
    v_mul_f32_dpp v198, v242, v74 row_newbcast:12 row_mask:0xf bank_mask:0xf
    v_mul_f32_dpp v199, v242, v75 row_newbcast:13 row_mask:0xf bank_mask:0xf
    v_mul_f32_dpp v200, v242, v78 row_newbcast:6 row_mask:0xf bank_mask:0xf
    v_mul_f32_dpp v201, v242, v79 row_newbcast:7 row_mask:0xf bank_mask:0xf
    v_mul_f32_dpp v202, v242, v78 row_newbcast:14 row_mask:0xf bank_mask:0xf
    v_mul_f32_dpp v203, v242, v79 row_newbcast:15 row_mask:0xf bank_mask:0xf
    v_cvt_pk_bf16_f32 v74, v196, v197
    v_cvt_pk_bf16_f32 v78, v198, v199
    v_cvt_pk_bf16_f32 v75, v200, v201
    v_cvt_pk_bf16_f32 v79, v202, v203
    s_nop 0
    s_waitcnt lgkmcnt(3)
    v_mfma_f32_32x32x16_bf16 v[56:71], v[72:75], v[176:179], 0
    s_add_u32 m0, s21, 0
    v_mfma_f32_32x32x16_bf16 v[16:31], v[76:79], v[176:179], 0
    v_mad_u32_u16 v234, v234, s3, v246 op_sel:[1,0,0,0]
    v_mad_u32_u16 v235, v235, s3, v246 op_sel:[1,0,0,0]
    buffer_load_dwordx4 v234, s[4:7], s38 offen  lds
    buffer_load_dwordx4 v235, s[8:11], s38 offen offset:1024  lds
    v_mfma_f32_32x32x16_bf16 v[32:47], v[72:75], v[180:183], 0
    s_nop 4
    v_mul_f32 v196, v56, v96
    v_fmac_f32 v196, v57, v97
    v_fmac_f32 v196, v58, v98
    v_fmac_f32 v196, v59, v99
    v_fmac_f32 v196, v60, v100
    v_fmac_f32 v196, v61, v101
    v_mfma_f32_32x32x16_bf16 v[0:15], v[76:79], v[180:183], 0
    s_waitcnt vmcnt(6)
    ds_read_b64_tr_b16 v[176:177], v244 offset:2048
    ds_read_b64_tr_b16 v[178:179], v244 offset:3072
    ds_read_b64_tr_b16 v[180:181], v245 offset:2048
    ds_read_b64_tr_b16 v[182:183], v245 offset:3072
    v_fmac_f32 v196, v62, v102
    v_fmac_f32 v196, v63, v103
    v_mul_f32 v198, v64, v128
    v_fmac_f32 v198, v65, v129
    v_fmac_f32 v198, v66, v130
    v_fmac_f32 v198, v67, v131
    v_fmac_f32 v198, v68, v132
    v_fmac_f32 v198, v69, v133
    v_fmac_f32 v198, v70, v134
    v_fmac_f32 v198, v71, v135
    v_mul_f32 v200, v16, v128
    v_fmac_f32 v200, v17, v129
    v_permlane32_swap_b32 v196, v198
    v_fmac_f32 v200, v18, v130
    v_fmac_f32 v200, v19, v131
    v_fmac_f32 v200, v20, v132
    v_fmac_f32 v200, v21, v133
    v_fmac_f32 v200, v22, v134
    v_fmac_f32 v200, v23, v135
    v_add_f32 v198, v196, v198
    v_mul_f32_e64 v202, v24, -v128
    v_fma_f32 v202, v25, -v129, v202
    v_fma_f32 v202, v26, -v130, v202
    v_fma_f32 v202, v27, -v131, v202
    v_fma_f32 v202, v28, -v132, v202
    v_fma_f32 v202, v29, -v133, v202
    v_fma_f32 v202, v30, -v134, v202
    v_fma_f32 v202, v31, -v135, v202
    s_nop 1
    v_permlane32_swap_b32 v200, v202
    v_add_f32 v202, v200, v202
    s_waitcnt lgkmcnt(0)
    v_mfma_f32_32x32x16_bf16 v[56:71], v[72:75], v[176:179], 0
    v_mul_f32 v197, v32, v104
    v_fmac_f32 v197, v33, v105
    v_fmac_f32 v197, v34, v106
    v_fmac_f32 v197, v35, v107
    v_fmac_f32 v197, v36, v108
    v_fmac_f32 v197, v37, v109
    s_add_u32 m0, s21, 2048
    v_mfma_f32_32x32x16_bf16 v[16:31], v[76:79], v[176:179], 0
    v_mad_u32_u16 v236, v236, s3, v246 op_sel:[1,0,0,0]
    v_mad_u32_u16 v237, v237, s3, v246 op_sel:[1,0,0,0]
    buffer_load_dwordx4 v236, s[4:7], s39 offen  lds
    buffer_load_dwordx4 v237, s[8:11], s39 offen offset:1024  lds
    v_fmac_f32 v197, v38, v110
    v_fmac_f32 v197, v39, v111
    v_mul_f32 v199, v40, v136
    v_fmac_f32 v199, v41, v137
    v_fmac_f32 v199, v42, v138
    v_fmac_f32 v199, v43, v139
    v_fmac_f32 v199, v44, v140
    v_fmac_f32 v199, v45, v141
    v_fmac_f32 v199, v46, v142
    v_fmac_f32 v199, v47, v143
    v_mul_f32 v201, v0, v136
    v_fmac_f32 v201, v1, v137
    v_permlane32_swap_b32 v197, v199
    v_fmac_f32 v201, v2, v138
    v_fmac_f32 v201, v3, v139
    v_fmac_f32 v201, v4, v140
    v_fmac_f32 v201, v5, v141
    v_fmac_f32 v201, v6, v142
    v_fmac_f32 v201, v7, v143
    v_add_f32 v199, v197, v199
    v_mul_f32_e64 v203, v8, -v136
    v_fma_f32 v203, v9, -v137, v203
    v_fma_f32 v203, v10, -v138, v203
    v_fma_f32 v203, v11, -v139, v203
    v_fma_f32 v203, v12, -v140, v203
    v_fma_f32 v203, v13, -v141, v203
    v_fma_f32 v203, v14, -v142, v203
    v_fma_f32 v203, v15, -v143, v203
    s_nop 1
    v_permlane32_swap_b32 v201, v203
    v_add_f32 v203, v201, v203
    s_set_gpr_idx_on s51, gpr_idx(DST)
    s_nop 0
    v_cvt_pk_bf16_f32 v204, v198, v199
    v_cvt_pk_bf16_f32 v205, v202, v203
    s_set_gpr_idx_off
    v_mfma_f32_32x32x16_bf16 v[32:47], v[72:75], v[180:183], 0
    v_mul_f32 v196, v56, v144
    v_fmac_f32 v196, v57, v145
    v_fmac_f32 v196, v58, v146
    v_fmac_f32 v196, v59, v147
    v_fmac_f32 v196, v60, v148
    v_fmac_f32 v196, v61, v149
    v_mfma_f32_32x32x16_bf16 v[0:15], v[76:79], v[180:183], 0
    s_waitcnt vmcnt(6)
    ds_read_b64_tr_b16 v[176:177], v244 offset:4096
    ds_read_b64_tr_b16 v[178:179], v244 offset:5120
    ds_read_b64_tr_b16 v[180:181], v245 offset:4096
    ds_read_b64_tr_b16 v[182:183], v245 offset:5120
    v_fmac_f32 v196, v62, v150
    v_fmac_f32 v196, v63, v151
    v_mul_f32_e64 v200, v16, -v160
    v_fma_f32 v200, v17, -v161, v200
    v_fma_f32 v200, v18, -v162, v200
    v_fma_f32 v200, v19, -v163, v200
    v_fma_f32 v200, v20, -v164, v200
    v_fma_f32 v200, v21, -v165, v200
    v_fma_f32 v200, v22, -v166, v200
    v_fma_f32 v200, v23, -v167, v200
    v_mul_f32_e64 v202, v24, -v160
    v_fma_f32 v202, v25, -v161, v202
    v_fma_f32 v202, v26, -v162, v202
    v_fma_f32 v202, v27, -v163, v202
    v_fma_f32 v202, v28, -v164, v202
    v_fma_f32 v202, v29, -v165, v202
    v_fma_f32 v202, v30, -v166, v202
    v_fma_f32 v202, v31, -v167, v202
    s_waitcnt lgkmcnt(0)
    v_mfma_f32_32x32x16_bf16 v[16:31], v[72:75], v[176:179], 0
    v_mul_f32 v197, v32, v152
    v_fmac_f32 v197, v33, v153
    v_fmac_f32 v197, v34, v154
    v_fmac_f32 v197, v35, v155
    v_fmac_f32 v197, v36, v156
    v_fmac_f32 v197, v37, v157
    s_add_u32 m0, s21, 4096
    v_mfma_f32_32x32x16_bf16 v[48:63], v[76:79], v[176:179], 0
    v_mad_u32_u16 v238, v238, s3, v246 op_sel:[1,0,0,0]
    v_mad_u32_u16 v239, v239, s3, v246 op_sel:[1,0,0,0]
    buffer_load_dwordx4 v238, s[4:7], s40 offen  lds
    buffer_load_dwordx4 v239, s[8:11], s40 offen offset:1024  lds
    v_fmac_f32 v197, v38, v158
    v_fmac_f32 v197, v39, v159
    v_mul_f32_e64 v201, v0, -v168
    v_fma_f32 v201, v1, -v169, v201
    v_fma_f32 v201, v2, -v170, v201
    v_fma_f32 v201, v3, -v171, v201
    v_fma_f32 v201, v4, -v172, v201
    v_fma_f32 v201, v5, -v173, v201
    v_fma_f32 v201, v6, -v174, v201
    v_fma_f32 v201, v7, -v175, v201
    v_mul_f32_e64 v203, v8, -v168
    v_fma_f32 v203, v9, -v169, v203
    v_fma_f32 v203, v10, -v170, v203
    v_fma_f32 v203, v11, -v171, v203
    v_fma_f32 v203, v12, -v172, v203
    v_fma_f32 v203, v13, -v173, v203
    v_fma_f32 v203, v14, -v174, v203
    v_fma_f32 v203, v15, -v175, v203
    v_mfma_f32_32x32x16_bf16 v[0:15], v[72:75], v[180:183], 0
    v_fmac_f32 v200, v24, v160
    v_fmac_f32 v200, v25, v161
    v_fmac_f32 v200, v26, v162
    v_fmac_f32 v200, v27, v163
    v_fmac_f32 v200, v28, v164
    v_fmac_f32 v200, v29, v165
    v_fmac_f32 v200, v30, v166
    v_fmac_f32 v200, v31, v167
    v_mfma_f32_32x32x16_bf16 v[24:39], v[76:79], v[180:183], 0
    v_add_u32 v253, s47, v248
    ds_read_b32 v192, v253
    ds_read_b32 v193, v253 offset:256
    s_waitcnt vmcnt(6)
    ds_read_b64_tr_b16 v[176:177], v244 offset:6144
    ds_read_b64_tr_b16 v[178:179], v244 offset:7168
    ds_read_b64_tr_b16 v[180:181], v245 offset:6144
    ds_read_b64_tr_b16 v[182:183], v245 offset:7168
    v_mul_f32 v254, v16, v144
    v_fmac_f32 v254, v17, v145
    v_fmac_f32 v254, v18, v146
    v_fmac_f32 v254, v19, v147
    v_fmac_f32 v254, v20, v148
    v_fmac_f32 v254, v21, v149
    v_fmac_f32 v254, v22, v150
    v_fmac_f32 v254, v23, v151
    v_sub_f32_e64 v64, -v48, v64
    v_sub_f32_e64 v65, -v49, v65
    v_permlane32_swap_b32 v196, v254
    v_sub_f32_e64 v66, -v50, v66
    v_sub_f32_e64 v67, -v51, v67
    v_sub_f32_e64 v68, -v52, v68
    v_sub_f32_e64 v69, -v53, v69
    v_sub_f32_e64 v70, -v54, v70
    v_sub_f32_e64 v71, -v55, v71
    v_add_f32 v254, v196, v254
    s_waitcnt lgkmcnt(0)
    v_mfma_f32_32x32x16_bf16 v[56:71], v[76:79], v[176:179], v[56:71]
    v_sub_f32_e64 v40, -v24, v40
    v_sub_f32_e64 v41, -v25, v41
    v_sub_f32_e64 v42, -v26, v42
    v_sub_f32_e64 v43, -v27, v43
    v_sub_f32_e64 v44, -v28, v44
    v_sub_f32_e64 v45, -v29, v45
    v_sub_f32_e64 v46, -v30, v46
    v_sub_f32_e64 v47, -v31, v47
    s_mov_b32 m0, s76
    s_mov_b64 exec, s[72:73]
    buffer_load_dwordx4 v192, s[12:15], 0 offen  lds
    s_mov_b32 m0, s77
    s_mov_b64 exec, s[74:75]
    buffer_load_dwordx4 v193, s[12:15], 0 offen  lds
    s_mov_b64 exec, -1
    s_add_u32 m0, s21, 6144
    v_mfma_f32_32x32x16_bf16 v[16:31], v[72:75], v[176:179], 0
    v_mad_u32_u16 v240, v240, s3, v246 op_sel:[1,0,0,0]
    v_mad_u32_u16 v241, v241, s3, v246 op_sel:[1,0,0,0]
    buffer_load_dwordx4 v240, s[4:7], s41 offen  lds
    buffer_load_dwordx4 v241, s[8:11], s41 offen offset:1024  lds
    v_mul_f32 v255, v0, v152
    v_fmac_f32 v255, v1, v153
    v_fmac_f32 v255, v2, v154
    v_fmac_f32 v255, v3, v155
    v_fmac_f32 v255, v4, v156
    v_fmac_f32 v255, v5, v157
    v_fmac_f32 v255, v6, v158
    v_fmac_f32 v255, v7, v159
    v_fmac_f32 v201, v8, v168
    v_fmac_f32 v201, v9, v169
    v_permlane32_swap_b32 v197, v255
    v_fmac_f32 v201, v10, v170
    v_fmac_f32 v201, v11, v171
    v_fmac_f32 v201, v12, v172
    v_fmac_f32 v201, v13, v173
    v_fmac_f32 v201, v14, v174
    v_fmac_f32 v201, v15, v175
    v_add_f32 v255, v197, v255
    s_set_gpr_idx_on s51, gpr_idx(DST)
    s_nop 0
    v_cvt_pk_bf16_f32 v206, v254, v255
    s_set_gpr_idx_off
    v_mfma_f32_32x32x16_bf16 v[0:15], v[72:75], v[180:183], 0
    v_mul_f32 v254, v16, v144
    v_fmac_f32 v254, v17, v145
    v_fmac_f32 v254, v18, v146
    v_fmac_f32 v254, v19, v147
    v_fmac_f32 v254, v20, v148
    v_fmac_f32 v254, v21, v149
    v_mfma_f32_32x32x16_bf16 v[32:47], v[76:79], v[180:183], v[32:47]
    s_waitcnt vmcnt(8)
    ds_read_b64_tr_b16 v[176:177], v244 offset:0
    ds_read_b64_tr_b16 v[178:179], v244 offset:1024
    ds_read_b64_tr_b16 v[180:181], v245 offset:0
    ds_read_b64_tr_b16 v[182:183], v245 offset:1024
    v_add_u32 v249, s48, v249
    v_add_u32 v250, s49, v250
    v_fmac_f32 v254, v22, v150
    v_fmac_f32 v254, v23, v151
    v_fma_f32 v202, v24, -v160, v202
    v_fma_f32 v202, v25, -v161, v202
    v_permlane32_swap_b32 v254, v200
    v_fma_f32 v202, v26, -v162, v202
    v_fma_f32 v202, v27, -v163, v202
    v_fma_f32 v202, v28, -v164, v202
    v_fma_f32 v202, v29, -v165, v202
    v_fma_f32 v202, v30, -v166, v202
    v_fma_f32 v202, v31, -v167, v202
    v_add_f32 v200, v254, v200
    v_mul_f32_e64 v198, v64, -v112
    v_permlane32_swap_b32 v202, v254
    v_fma_f32 v198, v65, -v113, v198
    v_fma_f32 v198, v66, -v114, v198
    v_fma_f32 v198, v67, -v115, v198
    v_fma_f32 v198, v68, -v116, v198
    v_fma_f32 v198, v69, -v117, v198
    v_fma_f32 v198, v70, -v118, v198
    v_fma_f32 v198, v71, -v119, v198
    v_add_f32 v254, v202, v254
    v_mul_f32 v196, v56, v160
    v_fmac_f32 v196, v57, v161
    v_fmac_f32 v196, v58, v162
    v_fmac_f32 v196, v59, v163
    v_fmac_f32 v196, v60, v164
    v_fmac_f32 v196, v61, v165
    v_fmac_f32 v196, v62, v166
    v_fmac_f32 v196, v63, v167
    s_nop 1
    v_permlane32_swap_b32 v198, v196
    v_add_f32 v196, v198, v196
    v_mul_f32 v255, v0, v152
    v_fmac_f32 v255, v1, v153
    v_fmac_f32 v255, v2, v154
    v_fmac_f32 v255, v3, v155
    v_fmac_f32 v255, v4, v156
    v_fmac_f32 v255, v5, v157
    v_fmac_f32 v255, v6, v158
    v_fmac_f32 v255, v7, v159
    v_fma_f32 v203, v8, -v168, v203
    v_fma_f32 v203, v9, -v169, v203
    v_permlane32_swap_b32 v255, v201
    v_fma_f32 v203, v10, -v170, v203
    v_fma_f32 v203, v11, -v171, v203
    v_fma_f32 v203, v12, -v172, v203
    v_fma_f32 v203, v13, -v173, v203
    v_fma_f32 v203, v14, -v174, v203
    v_fma_f32 v203, v15, -v175, v203
    v_add_f32 v201, v255, v201
    v_mul_f32_e64 v199, v40, -v120
    v_permlane32_swap_b32 v203, v255
    v_fma_f32 v199, v41, -v121, v199
    v_fma_f32 v199, v42, -v122, v199
    v_fma_f32 v199, v43, -v123, v199
    s_waitcnt vmcnt(2)
    ds_read_b64_tr_b16 v[72:73], v249 offset:0
    ds_read_b64_tr_b16 v[76:77], v249 offset:64
    ds_read_b64_tr_b16 v[74:75], v249 offset:256
    ds_read_b64_tr_b16 v[78:79], v249 offset:320
    s_mov_b64 exec, s[54:55]
    ds_read_u16_d16_hi v242, v250 offset:0
    s_mov_b64 exec, -1
    v_fma_f32 v199, v44, -v124, v199
    v_fma_f32 v199, v45, -v125, v199
    v_fma_f32 v199, v46, -v126, v199
    v_fma_f32 v199, v47, -v127, v199
    v_add_f32 v255, v203, v255
    v_mul_f32 v197, v32, v168
    v_fmac_f32 v197, v33, v169
    v_fmac_f32 v197, v34, v170
    v_fmac_f32 v197, v35, v171
    v_fmac_f32 v197, v36, v172
    v_fmac_f32 v197, v37, v173
    v_fmac_f32 v197, v38, v174
    v_fmac_f32 v197, v39, v175
    s_nop 1
    v_permlane32_swap_b32 v199, v197
    v_add_f32 v197, v199, v197
    s_set_gpr_idx_on s51, gpr_idx(DST)
    s_nop 0
    v_cvt_pk_bf16_f32 v207, v200, v201
    v_cvt_pk_bf16_f32 v209, v254, v255
    v_cvt_pk_bf16_f32 v208, v196, v197
    s_set_gpr_idx_off
    s_add_u32 s50, s50, 1
    s_add_u32 s51, s51, 6
    s_cmp_ge_u32 s50, 4
    s_cbranch_scc1 LAST0
    s_add_u32 s53, s53, 4
    s_xor_b32 s66, s53, s20
    s_bitcmp1_b32 s66, 2
    s_setprio 1
    s_cbranch_scc1 PRIO_10
    s_setprio 0
PRIO_10:
    s_cmp_eq_u32 s52, 4
    s_cbranch_scc1 ITEM_0_4
    s_cmp_eq_u32 s52, 5
    s_cbranch_scc1 ITEM_0_5
    s_cmp_eq_u32 s52, 3
    s_cbranch_scc1 ITEM_0_3
    s_cmp_eq_u32 s52, 6
    s_cbranch_scc1 ITEM_0_6
    s_cmp_eq_u32 s52, 8
    s_cbranch_scc1 ITEM_0_8
    s_branch ITEM_0_2
.p2align 6
ITEM_1_4:
    s_mov_b64 exec, s[54:55]
    ds_read_u16_d16_hi v243, v250 offset:128
    s_mov_b64 exec, -1
    ds_read_b64_tr_b16 v[80:81], v249 offset:512
    ds_read_b64_tr_b16 v[84:85], v249 offset:576
    ds_read_b64_tr_b16 v[82:83], v249 offset:768
    ds_read_b64_tr_b16 v[86:87], v249 offset:832
    s_waitcnt lgkmcnt(5)
    v_mul_f32_dpp v196, v242, v72 row_newbcast:0 row_mask:0xf bank_mask:0xf
    v_mul_f32_dpp v197, v242, v73 row_newbcast:1 row_mask:0xf bank_mask:0xf
    v_mul_f32_dpp v198, v242, v72 row_newbcast:8 row_mask:0xf bank_mask:0xf
    v_mul_f32_dpp v199, v242, v73 row_newbcast:9 row_mask:0xf bank_mask:0xf
    v_mul_f32_dpp v200, v242, v76 row_newbcast:2 row_mask:0xf bank_mask:0xf
    v_mul_f32_dpp v201, v242, v77 row_newbcast:3 row_mask:0xf bank_mask:0xf
    v_mul_f32_dpp v202, v242, v76 row_newbcast:10 row_mask:0xf bank_mask:0xf
    v_mul_f32_dpp v203, v242, v77 row_newbcast:11 row_mask:0xf bank_mask:0xf
    v_cvt_pk_bf16_f32 v72, v196, v197
    v_cvt_pk_bf16_f32 v76, v198, v199
    v_cvt_pk_bf16_f32 v73, v200, v201
    v_cvt_pk_bf16_f32 v77, v202, v203
    v_mul_f32_dpp v196, v242, v74 row_newbcast:4 row_mask:0xf bank_mask:0xf
    v_mul_f32_dpp v197, v242, v75 row_newbcast:5 row_mask:0xf bank_mask:0xf
    v_mul_f32_dpp v198, v242, v74 row_newbcast:12 row_mask:0xf bank_mask:0xf
    v_mul_f32_dpp v199, v242, v75 row_newbcast:13 row_mask:0xf bank_mask:0xf
    v_mul_f32_dpp v200, v242, v78 row_newbcast:6 row_mask:0xf bank_mask:0xf
    v_mul_f32_dpp v201, v242, v79 row_newbcast:7 row_mask:0xf bank_mask:0xf
    v_mul_f32_dpp v202, v242, v78 row_newbcast:14 row_mask:0xf bank_mask:0xf
    v_mul_f32_dpp v203, v242, v79 row_newbcast:15 row_mask:0xf bank_mask:0xf
    v_cvt_pk_bf16_f32 v74, v196, v197
    v_cvt_pk_bf16_f32 v78, v198, v199
    v_cvt_pk_bf16_f32 v75, v200, v201
    v_cvt_pk_bf16_f32 v79, v202, v203
    s_waitcnt vmcnt(4) lgkmcnt(0)
    v_mfma_f32_32x32x16_bf16 v[56:71], v[72:75], v[176:179], 0
    v_mul_f32_dpp v196, v243, v80 row_newbcast:0 row_mask:0xf bank_mask:0xf
    v_mul_f32_dpp v197, v243, v81 row_newbcast:1 row_mask:0xf bank_mask:0xf
    v_mul_f32_dpp v198, v243, v80 row_newbcast:8 row_mask:0xf bank_mask:0xf
    v_mul_f32_dpp v199, v243, v81 row_newbcast:9 row_mask:0xf bank_mask:0xf
    v_mul_f32_dpp v200, v243, v84 row_newbcast:2 row_mask:0xf bank_mask:0xf
    v_mul_f32_dpp v201, v243, v85 row_newbcast:3 row_mask:0xf bank_mask:0xf
    s_add_u32 m0, s21, 0
    v_mfma_f32_32x32x16_bf16 v[16:31], v[76:79], v[176:179], 0
    buffer_load_dwordx4 v234, s[4:7], s36 offen  lds
    buffer_load_dwordx4 v235, s[8:11], s36 offen offset:1024  lds
    ds_read_b64_tr_b16 v[176:177], v244 offset:2048
    ds_read_b64_tr_b16 v[178:179], v244 offset:3072
    ds_read_b64_tr_b16 v[184:185], v245 offset:2048
    ds_read_b64_tr_b16 v[186:187], v245 offset:3072
    v_mul_f32_dpp v202, v243, v84 row_newbcast:10 row_mask:0xf bank_mask:0xf
    v_mul_f32_dpp v203, v243, v85 row_newbcast:11 row_mask:0xf bank_mask:0xf
    v_cvt_pk_bf16_f32 v80, v196, v197
    v_cvt_pk_bf16_f32 v84, v198, v199
    v_cvt_pk_bf16_f32 v81, v200, v201
    v_cvt_pk_bf16_f32 v85, v202, v203
    v_mul_f32_dpp v196, v243, v82 row_newbcast:4 row_mask:0xf bank_mask:0xf
    v_mul_f32_dpp v197, v243, v83 row_newbcast:5 row_mask:0xf bank_mask:0xf
    v_mul_f32_dpp v198, v243, v82 row_newbcast:12 row_mask:0xf bank_mask:0xf
    v_mul_f32_dpp v199, v243, v83 row_newbcast:13 row_mask:0xf bank_mask:0xf
    v_mul_f32_dpp v200, v243, v86 row_newbcast:6 row_mask:0xf bank_mask:0xf
    v_mul_f32_dpp v201, v243, v87 row_newbcast:7 row_mask:0xf bank_mask:0xf
    v_mul_f32_dpp v202, v243, v86 row_newbcast:14 row_mask:0xf bank_mask:0xf
    v_mul_f32_dpp v203, v243, v87 row_newbcast:15 row_mask:0xf bank_mask:0xf
    v_cvt_pk_bf16_f32 v82, v196, v197
    v_cvt_pk_bf16_f32 v86, v198, v199
    v_cvt_pk_bf16_f32 v83, v200, v201
    v_cvt_pk_bf16_f32 v87, v202, v203
    s_waitcnt lgkmcnt(0)
    v_mfma_f32_32x32x16_bf16 v[56:71], v[80:83], v[176:179], v[56:71]
    s_add_u32 m0, s21, 2048
    v_mfma_f32_32x32x16_bf16 v[16:31], v[84:87], v[176:179], v[16:31]
    buffer_load_dwordx4 v236, s[4:7], s36 offen  lds
    buffer_load_dwordx4 v237, s[8:11], s36 offen offset:1024  lds
    s_mov_b32 m0, s50
    s_nop 0
    s_movrels_b32 s71, s23
    s_movrels_b32 s33, s28
    v_add_u32 v253, s33, v248
    s_bfe_u32 s46, s71, 0x30012
    s_mov_b32 m0, s46
    s_and_b32 s66, s71, 0x3ffff
    s_movrels_b32 s68, s57
    s_movrels_b32 s69, s61
    s_sub_u32 s48, s66, s47
    s_mov_b32 s47, s66
    s_lshr_b32 s52, s71, 28
    s_lshl_b32 s67, s46, 9
    s_add_u32 s66, s66, s67
    s_sub_u32 s49, s66, s42
    s_mov_b32 s42, s66
    s_bfe_u32 s66, s68, 655360
    s_add_u32 s43, s42, s66
    s_bfe_u32 s39, s69, 655360
    s_bfe_u32 s66, s68, 655370
    s_add_u32 s44, s42, s66
    s_bfe_u32 s40, s69, 655370
    s_bfe_u32 s66, s68, 655380
    s_add_u32 s45, s42, s66
    s_bfe_u32 s41, s69, 655380
    v_add_u32 v252, s44, v247
    ds_read2_b32 v[238:239], v252 offset0:0 offset1:16
    v_add_u32 v252, s45, v247
    ds_read2_b32 v[240:241], v252 offset0:0 offset1:16
    v_mfma_f32_32x32x16_bf16 v[32:47], v[72:75], v[180:183], 0
    v_mul_f32 v196, v56, v96
    v_fmac_f32 v196, v57, v97
    v_fmac_f32 v196, v58, v98
    v_fmac_f32 v196, v59, v99
    v_fmac_f32 v196, v60, v100
    v_fmac_f32 v196, v61, v101
    v_mfma_f32_32x32x16_bf16 v[0:15], v[76:79], v[180:183], 0
    s_waitcnt vmcnt(6)
    ds_read_b64_tr_b16 v[176:177], v244 offset:4096
    ds_read_b64_tr_b16 v[178:179], v244 offset:5120
    ds_read_b64_tr_b16 v[180:181], v245 offset:4096
    ds_read_b64_tr_b16 v[182:183], v245 offset:5120
    v_fmac_f32 v196, v62, v102
    v_fmac_f32 v196, v63, v103
    v_mfma_f32_32x32x16_bf16 v[32:47], v[80:83], v[184:187], v[32:47]
    v_mul_f32 v198, v64, v128
    v_fmac_f32 v198, v65, v129
    v_fmac_f32 v198, v66, v130
    v_fmac_f32 v198, v67, v131
    v_fmac_f32 v198, v68, v132
    v_fmac_f32 v198, v69, v133
    v_mfma_f32_32x32x16_bf16 v[0:15], v[84:87], v[184:187], v[0:15]
    v_fmac_f32 v198, v70, v134
    v_fmac_f32 v198, v71, v135
    v_mul_f32 v200, v16, v128
    v_fmac_f32 v200, v17, v129
    v_permlane32_swap_b32 v196, v198
    v_fmac_f32 v200, v18, v130
    v_fmac_f32 v200, v19, v131
    v_fmac_f32 v200, v20, v132
    v_fmac_f32 v200, v21, v133
    v_fmac_f32 v200, v22, v134
    v_fmac_f32 v200, v23, v135
    v_add_f32 v198, v196, v198
    v_mul_f32_e64 v202, v24, -v128
    v_fma_f32 v202, v25, -v129, v202
    v_fma_f32 v202, v26, -v130, v202
    v_fma_f32 v202, v27, -v131, v202
    v_fma_f32 v202, v28, -v132, v202
    v_fma_f32 v202, v29, -v133, v202
    v_fma_f32 v202, v30, -v134, v202
    v_fma_f32 v202, v31, -v135, v202
    s_nop 1
    v_permlane32_swap_b32 v200, v202
    v_add_f32 v202, v200, v202
    s_waitcnt vmcnt(4) lgkmcnt(0)
    v_mfma_f32_32x32x16_bf16 v[56:71], v[72:75], v[176:179], 0
    v_mul_f32 v197, v32, v104
    v_fmac_f32 v197, v33, v105
    v_fmac_f32 v197, v34, v106
    v_fmac_f32 v197, v35, v107
    v_fmac_f32 v197, v36, v108
    v_fmac_f32 v197, v37, v109
    s_add_u32 m0, s21, 4096
    v_mfma_f32_32x32x16_bf16 v[16:31], v[76:79], v[176:179], 0
    buffer_load_dwordx4 v234, s[4:7], s37 offen  lds
    buffer_load_dwordx4 v235, s[8:11], s37 offen offset:1024  lds
    ds_read_b64_tr_b16 v[176:177], v244 offset:6144
    ds_read_b64_tr_b16 v[178:179], v244 offset:7168
    ds_read_b64_tr_b16 v[184:185], v245 offset:6144
    ds_read_b64_tr_b16 v[186:187], v245 offset:7168
    v_add_u32 v252, s42, v247
    ds_read2_b32 v[234:235], v252 offset0:0 offset1:16
    v_fmac_f32 v197, v38, v110
    v_fmac_f32 v197, v39, v111
    v_mul_f32 v199, v40, v136
    v_fmac_f32 v199, v41, v137
    v_fmac_f32 v199, v42, v138
    v_fmac_f32 v199, v43, v139
    v_fmac_f32 v199, v44, v140
    v_fmac_f32 v199, v45, v141
    v_fmac_f32 v199, v46, v142
    v_fmac_f32 v199, v47, v143
    v_mul_f32 v201, v0, v136
    v_fmac_f32 v201, v1, v137
    v_permlane32_swap_b32 v197, v199
    v_fmac_f32 v201, v2, v138
    v_fmac_f32 v201, v3, v139
    v_fmac_f32 v201, v4, v140
    v_fmac_f32 v201, v5, v141
    v_fmac_f32 v201, v6, v142
    v_fmac_f32 v201, v7, v143
    v_add_f32 v199, v197, v199
    v_mul_f32_e64 v203, v8, -v136
    v_fma_f32 v203, v9, -v137, v203
    v_fma_f32 v203, v10, -v138, v203
    v_fma_f32 v203, v11, -v139, v203
    s_waitcnt lgkmcnt(1)
    v_mfma_f32_32x32x16_bf16 v[56:71], v[80:83], v[176:179], v[56:71]
    v_fma_f32 v203, v12, -v140, v203
    v_fma_f32 v203, v13, -v141, v203
    v_fma_f32 v203, v14, -v142, v203
    v_fma_f32 v203, v15, -v143, v203
    s_nop 1
    v_permlane32_swap_b32 v201, v203
    v_add_f32 v203, v201, v203
    s_add_u32 m0, s21, 6144
    v_mfma_f32_32x32x16_bf16 v[16:31], v[84:87], v[176:179], v[16:31]
    buffer_load_dwordx4 v236, s[4:7], s37 offen  lds
    buffer_load_dwordx4 v237, s[8:11], s37 offen offset:1024  lds
    v_add_u32 v252, s43, v247
    ds_read2_b32 v[236:237], v252 offset0:0 offset1:16
    v_cvt_pk_bf16_f32 v192, v198, v199
    v_cvt_pk_bf16_f32 v193, v202, v203
    v_mfma_f32_32x32x16_bf16 v[32:47], v[72:75], v[180:183], 0
    v_mul_f32 v196, v56, v144
    v_fmac_f32 v196, v57, v145
    v_fmac_f32 v196, v58, v146
    v_fmac_f32 v196, v59, v147
    v_fmac_f32 v196, v60, v148
    v_fmac_f32 v196, v61, v149
    v_mfma_f32_32x32x16_bf16 v[0:15], v[76:79], v[180:183], 0
    s_waitcnt vmcnt(6)
    ds_read_b64_tr_b16 v[176:177], v244 offset:0
    ds_read_b64_tr_b16 v[178:179], v244 offset:1024
    ds_read_b64_tr_b16 v[180:181], v245 offset:0
    ds_read_b64_tr_b16 v[182:183], v245 offset:1024
    v_fmac_f32 v196, v62, v150
    v_fmac_f32 v196, v63, v151
    v_mfma_f32_32x32x16_bf16 v[32:47], v[80:83], v[184:187], v[32:47]
    v_mul_f32_e64 v200, v16, -v160
    v_fma_f32 v200, v17, -v161, v200
    v_fma_f32 v200, v18, -v162, v200
    v_fma_f32 v200, v19, -v163, v200
    v_fma_f32 v200, v20, -v164, v200
    v_fma_f32 v200, v21, -v165, v200
    v_mfma_f32_32x32x16_bf16 v[0:15], v[84:87], v[184:187], v[0:15]
    v_fma_f32 v200, v22, -v166, v200
    v_fma_f32 v200, v23, -v167, v200
    v_mul_f32_e64 v202, v24, -v160
    v_fma_f32 v202, v25, -v161, v202
    v_fma_f32 v202, v26, -v162, v202
    v_fma_f32 v202, v27, -v163, v202
    v_fma_f32 v202, v28, -v164, v202
    v_fma_f32 v202, v29, -v165, v202
    v_fma_f32 v202, v30, -v166, v202
    v_fma_f32 v202, v31, -v167, v202
    s_waitcnt vmcnt(4) lgkmcnt(0)
    v_mfma_f32_32x32x16_bf16 v[16:31], v[72:75], v[176:179], 0
    v_mul_f32 v197, v32, v152
    v_fmac_f32 v197, v33, v153
    v_fmac_f32 v197, v34, v154
    v_fmac_f32 v197, v35, v155
    v_fmac_f32 v197, v36, v156
    v_fmac_f32 v197, v37, v157
    s_add_u32 m0, s21, 0
    v_mfma_f32_32x32x16_bf16 v[48:63], v[76:79], v[176:179], 0
    s_cbranch_vccnz WL_4_0
    v_mad_u32_u16 v234, v234, s3, v246 op_sel:[1,0,0,0]
    v_mad_u32_u16 v235, v235, s3, v246 op_sel:[1,0,0,0]
    buffer_load_dwordx4 v234, s[4:7], s38 offen  lds
    buffer_load_dwordx4 v235, s[8:11], s38 offen offset:1024  lds
WR_4_0:
    ds_read_b64_tr_b16 v[176:177], v244 offset:2048
    ds_read_b64_tr_b16 v[178:179], v244 offset:3072
    ds_read_b64_tr_b16 v[184:185], v245 offset:2048
    ds_read_b64_tr_b16 v[186:187], v245 offset:3072
    v_fmac_f32 v197, v38, v158
    v_fmac_f32 v197, v39, v159
    v_mul_f32_e64 v201, v0, -v168
    v_fma_f32 v201, v1, -v169, v201
    v_fma_f32 v201, v2, -v170, v201
    v_fma_f32 v201, v3, -v171, v201
    v_fma_f32 v201, v4, -v172, v201
    v_fma_f32 v201, v5, -v173, v201
    v_fma_f32 v201, v6, -v174, v201
    v_fma_f32 v201, v7, -v175, v201
    s_waitcnt lgkmcnt(0)
    v_mfma_f32_32x32x16_bf16 v[16:31], v[80:83], v[176:179], v[16:31]
    v_mul_f32_e64 v203, v8, -v168
    v_fma_f32 v203, v9, -v169, v203
    v_fma_f32 v203, v10, -v170, v203
    v_fma_f32 v203, v11, -v171, v203
    v_fma_f32 v203, v12, -v172, v203
    v_fma_f32 v203, v13, -v173, v203
    s_add_u32 m0, s21, 2048
    v_mfma_f32_32x32x16_bf16 v[48:63], v[84:87], v[176:179], v[48:63]
    s_cbranch_vccnz WL_4_1
    v_mad_u32_u16 v236, v236, s3, v246 op_sel:[1,0,0,0]
    v_mad_u32_u16 v237, v237, s3, v246 op_sel:[1,0,0,0]
    buffer_load_dwordx4 v236, s[4:7], s39 offen  lds
    buffer_load_dwordx4 v237, s[8:11], s39 offen offset:1024  lds
WR_4_1:
    v_fma_f32 v203, v14, -v174, v203
    v_fma_f32 v203, v15, -v175, v203
    v_mfma_f32_32x32x16_bf16 v[0:15], v[72:75], v[180:183], 0
    v_fmac_f32 v200, v24, v160
    v_fmac_f32 v200, v25, v161
    v_fmac_f32 v200, v26, v162
    v_fmac_f32 v200, v27, v163
    v_fmac_f32 v200, v28, v164
    v_fmac_f32 v200, v29, v165
    v_fmac_f32 v200, v30, v166
    v_fmac_f32 v200, v31, v167
    v_mfma_f32_32x32x16_bf16 v[24:39], v[76:79], v[180:183], 0
    s_waitcnt vmcnt(6)
    ds_read_b64_tr_b16 v[176:177], v244 offset:4096
    ds_read_b64_tr_b16 v[178:179], v244 offset:5120
    ds_read_b64_tr_b16 v[180:181], v245 offset:4096
    ds_read_b64_tr_b16 v[182:183], v245 offset:5120
    v_mul_f32 v254, v16, v144
    v_fmac_f32 v254, v17, v145
    v_mfma_f32_32x32x16_bf16 v[24:39], v[84:87], v[184:187], v[24:39]
    v_fmac_f32 v254, v18, v146
    v_fmac_f32 v254, v19, v147
    v_fmac_f32 v254, v20, v148
    v_fmac_f32 v254, v21, v149
    v_fmac_f32 v254, v22, v150
    v_fmac_f32 v254, v23, v151
    v_mfma_f32_32x32x16_bf16 v[0:15], v[80:83], v[184:187], v[0:15]
    v_sub_f32_e64 v64, -v48, v64
    v_sub_f32_e64 v65, -v49, v65
    v_permlane32_swap_b32 v196, v254
    v_sub_f32_e64 v66, -v50, v66
    v_sub_f32_e64 v67, -v51, v67
    v_sub_f32_e64 v68, -v52, v68
    v_sub_f32_e64 v69, -v53, v69
    v_sub_f32_e64 v70, -v54, v70
    v_sub_f32_e64 v71, -v55, v71
    v_add_f32 v254, v196, v254
    s_waitcnt vmcnt(4) lgkmcnt(0)
    v_mfma_f32_32x32x16_bf16 v[56:71], v[76:79], v[176:179], v[56:71]
    v_sub_f32_e64 v40, -v24, v40
    v_sub_f32_e64 v41, -v25, v41
    v_sub_f32_e64 v42, -v26, v42
    v_sub_f32_e64 v43, -v27, v43
    v_sub_f32_e64 v44, -v28, v44
    v_sub_f32_e64 v45, -v29, v45
    v_sub_f32_e64 v46, -v30, v46
    v_sub_f32_e64 v47, -v31, v47
    s_add_u32 m0, s21, 4096
    v_mfma_f32_32x32x16_bf16 v[16:31], v[72:75], v[176:179], 0
    s_cbranch_vccnz WL_4_2
    v_mad_u32_u16 v238, v238, s3, v246 op_sel:[1,0,0,0]
    v_mad_u32_u16 v239, v239, s3, v246 op_sel:[1,0,0,0]
    buffer_load_dwordx4 v238, s[4:7], s40 offen  lds
    buffer_load_dwordx4 v239, s[8:11], s40 offen offset:1024  lds
WR_4_2:
    ds_read_b64_tr_b16 v[176:177], v244 offset:6144
    ds_read_b64_tr_b16 v[178:179], v244 offset:7168
    ds_read_b64_tr_b16 v[184:185], v245 offset:6144
    ds_read_b64_tr_b16 v[186:187], v245 offset:7168
    v_mul_f32 v255, v0, v152
    v_fmac_f32 v255, v1, v153
    v_fmac_f32 v255, v2, v154
    v_fmac_f32 v255, v3, v155
    v_fmac_f32 v255, v4, v156
    v_fmac_f32 v255, v5, v157
    v_fmac_f32 v255, v6, v158
    v_fmac_f32 v255, v7, v159
    v_fmac_f32 v201, v8, v168
    v_fmac_f32 v201, v9, v169
    v_permlane32_swap_b32 v197, v255
    s_waitcnt lgkmcnt(0)
    v_mfma_f32_32x32x16_bf16 v[16:31], v[80:83], v[176:179], v[16:31]
    v_fmac_f32 v201, v10, v170
    v_fmac_f32 v201, v11, v171
    v_fmac_f32 v201, v12, v172
    v_fmac_f32 v201, v13, v173
    v_fmac_f32 v201, v14, v174
    v_fmac_f32 v201, v15, v175
    s_add_u32 m0, s21, 6144
    v_mfma_f32_32x32x16_bf16 v[56:71], v[84:87], v[176:179], v[56:71]
    s_cbranch_vccnz WL_4_3
    v_mad_u32_u16 v240, v240, s3, v246 op_sel:[1,0,0,0]
    v_mad_u32_u16 v241, v241, s3, v246 op_sel:[1,0,0,0]
    buffer_load_dwordx4 v240, s[4:7], s41 offen  lds
    buffer_load_dwordx4 v241, s[8:11], s41 offen offset:1024  lds
WR_4_3:
    v_add_f32 v255, v197, v255
    v_cvt_pk_bf16_f32 v194, v254, v255
    v_mfma_f32_32x32x16_bf16 v[0:15], v[72:75], v[180:183], 0
    v_mul_f32 v254, v16, v144
    v_fmac_f32 v254, v17, v145
    v_fmac_f32 v254, v18, v146
    v_fmac_f32 v254, v19, v147
    v_fmac_f32 v254, v20, v148
    v_fmac_f32 v254, v21, v149
    v_mfma_f32_32x32x16_bf16 v[32:47], v[76:79], v[180:183], v[32:47]
    s_waitcnt vmcnt(6)
    ds_read_b64_tr_b16 v[176:177], v244 offset:0
    ds_read_b64_tr_b16 v[178:179], v244 offset:1024
    ds_read_b64_tr_b16 v[180:181], v245 offset:0
    ds_read_b64_tr_b16 v[182:183], v245 offset:1024
    v_fmac_f32 v254, v22, v150
    v_fmac_f32 v254, v23, v151
    v_mfma_f32_32x32x16_bf16 v[0:15], v[80:83], v[184:187], v[0:15]
    v_fma_f32 v202, v24, -v160, v202
    v_fma_f32 v202, v25, -v161, v202
    v_permlane32_swap_b32 v254, v200
    v_fma_f32 v202, v26, -v162, v202
    v_fma_f32 v202, v27, -v163, v202
    v_fma_f32 v202, v28, -v164, v202
    v_mfma_f32_32x32x16_bf16 v[32:47], v[84:87], v[184:187], v[32:47]
    v_add_u32 v249, s48, v249
    v_add_u32 v250, s49, v250
    ds_read_b32 v252, v251 offset:16
    ds_read_b64_tr_b16 v[72:73], v249 offset:0
    ds_read_b64_tr_b16 v[76:77], v249 offset:64
    ds_read_b64_tr_b16 v[74:75], v249 offset:256
    ds_read_b64_tr_b16 v[78:79], v249 offset:320
    s_mov_b64 exec, s[54:55]
    ds_read_u16_d16_hi v242, v250 offset:0
    s_mov_b64 exec, -1
    v_fma_f32 v202, v29, -v165, v202
    v_fma_f32 v202, v30, -v166, v202
    v_fma_f32 v202, v31, -v167, v202
    v_add_f32 v200, v254, v200
    v_mul_f32_e64 v198, v64, -v112
    v_permlane32_swap_b32 v202, v254
    v_fma_f32 v198, v65, -v113, v198
    v_fma_f32 v198, v66, -v114, v198
    v_fma_f32 v198, v67, -v115, v198
    v_fma_f32 v198, v68, -v116, v198
    v_fma_f32 v198, v69, -v117, v198
    v_fma_f32 v198, v70, -v118, v198
    v_fma_f32 v198, v71, -v119, v198
    v_add_f32 v254, v202, v254
    v_mul_f32 v196, v56, v160
    v_fmac_f32 v196, v57, v161
    v_fmac_f32 v196, v58, v162
    v_fmac_f32 v196, v59, v163
    v_fmac_f32 v196, v60, v164
    v_fmac_f32 v196, v61, v165
    v_fmac_f32 v196, v62, v166
    v_fmac_f32 v196, v63, v167
    s_nop 1
    v_permlane32_swap_b32 v198, v196
    v_add_f32 v196, v198, v196
    s_cbranch_vccnz LEPI_0
    v_mul_f32 v255, v0, v152
    v_fmac_f32 v255, v1, v153
    v_fmac_f32 v255, v2, v154
    v_fmac_f32 v255, v3, v155
    v_fmac_f32 v255, v4, v156
    v_fmac_f32 v255, v5, v157
    v_fmac_f32 v255, v6, v158
    v_fmac_f32 v255, v7, v159
    v_fma_f32 v203, v8, -v168, v203
    v_fma_f32 v203, v9, -v169, v203
    v_permlane32_swap_b32 v255, v201
    v_fma_f32 v203, v10, -v170, v203
    v_fma_f32 v203, v11, -v171, v203
    v_fma_f32 v203, v12, -v172, v203
    v_fma_f32 v203, v13, -v173, v203
    v_fma_f32 v203, v14, -v174, v203
    v_fma_f32 v203, v15, -v175, v203
    v_add_f32 v201, v255, v201
    v_mul_f32_e64 v199, v40, -v120
    v_permlane32_swap_b32 v203, v255
    v_fma_f32 v199, v41, -v121, v199
    v_fma_f32 v199, v42, -v122, v199
    v_fma_f32 v199, v43, -v123, v199
    v_fma_f32 v199, v44, -v124, v199
    v_fma_f32 v199, v45, -v125, v199
    v_fma_f32 v199, v46, -v126, v199
    v_fma_f32 v199, v47, -v127, v199
    v_add_f32 v255, v203, v255
    v_mul_f32 v197, v32, v168
    v_fmac_f32 v197, v33, v169
    v_fmac_f32 v197, v34, v170
    v_fmac_f32 v197, v35, v171
    v_fmac_f32 v197, v36, v172
    v_fmac_f32 v197, v37, v173
    v_fmac_f32 v197, v38, v174
    v_fmac_f32 v197, v39, v175
    s_nop 1
    v_permlane32_swap_b32 v199, v197
    v_add_f32 v197, v199, v197
    v_cvt_pk_bf16_f32 v200, v200, v201
    v_cvt_pk_bf16_f32 v254, v254, v255
    v_cvt_pk_bf16_f32 v196, v196, v197
    ds_write2st64_b32 v253, v192, v193 offset0:0 offset1:1
    ds_write2st64_b32 v253, v194, v200 offset0:2 offset1:3
    ds_write_b32 v253, v196 offset:1024
    s_mov_b64 exec, 0xffffffff
    ds_write_b32 v253, v254 offset:1280
    s_mov_b64 exec, -1
    s_add_u32 s50, s50, 1
    s_cmp_ge_u32 s50, 4
    s_cbranch_scc1 LAST1
    s_waitcnt lgkmcnt(9)
    v_readfirstlane_b32 s66, v252
    s_add_u32 s53, s53, 1
    v_mov_b32 v252, s53
    s_cmp_le_u32 s53, s66
    ds_write2_b32 v251, v252, v252 offset0:0 offset1:8
    s_setprio 1
    s_cbranch_scc1 PRIO_11
    s_setprio 0
PRIO_11:
    s_cmp_eq_u32 s52, 4
    s_cbranch_scc1 ITEM_1_4
    s_cmp_eq_u32 s52, 5
    s_cbranch_scc1 ITEM_1_5
    s_cmp_eq_u32 s52, 3
    s_cbranch_scc1 ITEM_1_3
    s_cmp_eq_u32 s52, 6
    s_cbranch_scc1 ITEM_1_6
    s_cmp_eq_u32 s52, 8
    s_cbranch_scc1 ITEM_1_8
    s_branch ITEM_1_2
WL_4_0:
    s_add_u32 s66, s51, 0
    buffer_load_dwordx4 v[96:99], v246, s[16:19], s66 offen offset:2048 sc1
    buffer_load_dwordx4 v[100:103], v246, s[16:19], s66 offen offset:3072 sc1
    s_branch WR_4_0
WL_4_1:
    s_add_u32 s66, s51, 4096
    buffer_load_dwordx4 v[104:107], v246, s[16:19], s66 offen offset:2048 sc1
    buffer_load_dwordx4 v[108:111], v246, s[16:19], s66 offen offset:3072 sc1
    s_branch WR_4_1
WL_4_2:
    s_add_u32 s66, s51, 8192
    buffer_load_dwordx4 v[128:131], v246, s[16:19], s66 offen offset:2048 sc1
    buffer_load_dwordx4 v[132:135], v246, s[16:19], s66 offen offset:3072 sc1
    s_branch WR_4_2
WL_4_3:
    s_add_u32 s66, s51, 12288
    buffer_load_dwordx4 v[136:139], v246, s[16:19], s66 offen offset:2048 sc1
    buffer_load_dwordx4 v[140:143], v246, s[16:19], s66 offen offset:3072 sc1
    s_branch WR_4_3
.p2align 6
ITEM_1_5:
    s_mov_b64 exec, s[54:55]
    ds_read_u16_d16_hi v243, v250 offset:128
    s_mov_b64 exec, -1
    ds_read_b64_tr_b16 v[80:81], v249 offset:512
    ds_read_b64_tr_b16 v[84:85], v249 offset:576
    ds_read_b64_tr_b16 v[82:83], v249 offset:768
    ds_read_b64_tr_b16 v[86:87], v249 offset:832
    ds_read_b64_tr_b16 v[88:89], v249 offset:1024
    ds_read_b64_tr_b16 v[92:93], v249 offset:1088
    s_waitcnt lgkmcnt(7)
    v_mul_f32_dpp v196, v242, v72 row_newbcast:0 row_mask:0xf bank_mask:0xf
    v_mul_f32_dpp v197, v242, v73 row_newbcast:1 row_mask:0xf bank_mask:0xf
    v_mul_f32_dpp v198, v242, v72 row_newbcast:8 row_mask:0xf bank_mask:0xf
    v_mul_f32_dpp v199, v242, v73 row_newbcast:9 row_mask:0xf bank_mask:0xf
    v_mul_f32_dpp v200, v242, v76 row_newbcast:2 row_mask:0xf bank_mask:0xf
    v_mul_f32_dpp v201, v242, v77 row_newbcast:3 row_mask:0xf bank_mask:0xf
    v_mul_f32_dpp v202, v242, v76 row_newbcast:10 row_mask:0xf bank_mask:0xf
    v_mul_f32_dpp v203, v242, v77 row_newbcast:11 row_mask:0xf bank_mask:0xf
    v_cvt_pk_bf16_f32 v72, v196, v197
    v_cvt_pk_bf16_f32 v76, v198, v199
    v_cvt_pk_bf16_f32 v73, v200, v201
    v_cvt_pk_bf16_f32 v77, v202, v203
    v_mul_f32_dpp v196, v242, v74 row_newbcast:4 row_mask:0xf bank_mask:0xf
    v_mul_f32_dpp v197, v242, v75 row_newbcast:5 row_mask:0xf bank_mask:0xf
    v_mul_f32_dpp v198, v242, v74 row_newbcast:12 row_mask:0xf bank_mask:0xf
    v_mul_f32_dpp v199, v242, v75 row_newbcast:13 row_mask:0xf bank_mask:0xf
    v_mul_f32_dpp v200, v242, v78 row_newbcast:6 row_mask:0xf bank_mask:0xf
    v_mul_f32_dpp v201, v242, v79 row_newbcast:7 row_mask:0xf bank_mask:0xf
    v_mul_f32_dpp v202, v242, v78 row_newbcast:14 row_mask:0xf bank_mask:0xf
    v_mul_f32_dpp v203, v242, v79 row_newbcast:15 row_mask:0xf bank_mask:0xf
    v_cvt_pk_bf16_f32 v74, v196, v197
    v_cvt_pk_bf16_f32 v78, v198, v199
    v_cvt_pk_bf16_f32 v75, v200, v201
    v_cvt_pk_bf16_f32 v79, v202, v203
    s_mov_b64 exec, s[54:55]
    ds_read_u16_d16_hi v242, v250 offset:256
    s_mov_b64 exec, -1
    s_waitcnt vmcnt(4) lgkmcnt(3)
    v_mfma_f32_32x32x16_bf16 v[56:71], v[72:75], v[176:179], 0
    v_mul_f32_dpp v196, v243, v80 row_newbcast:0 row_mask:0xf bank_mask:0xf
    v_mul_f32_dpp v197, v243, v81 row_newbcast:1 row_mask:0xf bank_mask:0xf
    v_mul_f32_dpp v198, v243, v80 row_newbcast:8 row_mask:0xf bank_mask:0xf
    v_mul_f32_dpp v199, v243, v81 row_newbcast:9 row_mask:0xf bank_mask:0xf
    v_mul_f32_dpp v200, v243, v84 row_newbcast:2 row_mask:0xf bank_mask:0xf
    v_mul_f32_dpp v201, v243, v85 row_newbcast:3 row_mask:0xf bank_mask:0xf
    s_add_u32 m0, s21, 0
    v_mfma_f32_32x32x16_bf16 v[16:31], v[76:79], v[176:179], 0
    buffer_load_dwordx4 v236, s[4:7], s35 offen  lds
    buffer_load_dwordx4 v237, s[8:11], s35 offen offset:1024  lds
    ds_read_b64_tr_b16 v[176:177], v244 offset:2048
    ds_read_b64_tr_b16 v[178:179], v244 offset:3072
    ds_read_b64_tr_b16 v[184:185], v245 offset:2048
    ds_read_b64_tr_b16 v[186:187], v245 offset:3072
    v_mul_f32_dpp v202, v243, v84 row_newbcast:10 row_mask:0xf bank_mask:0xf
    v_mul_f32_dpp v203, v243, v85 row_newbcast:11 row_mask:0xf bank_mask:0xf
    v_cvt_pk_bf16_f32 v80, v196, v197
    v_cvt_pk_bf16_f32 v84, v198, v199
    v_cvt_pk_bf16_f32 v81, v200, v201
    v_cvt_pk_bf16_f32 v85, v202, v203
    v_mul_f32_dpp v196, v243, v82 row_newbcast:4 row_mask:0xf bank_mask:0xf
    v_mul_f32_dpp v197, v243, v83 row_newbcast:5 row_mask:0xf bank_mask:0xf
    v_mul_f32_dpp v198, v243, v82 row_newbcast:12 row_mask:0xf bank_mask:0xf
    v_mul_f32_dpp v199, v243, v83 row_newbcast:13 row_mask:0xf bank_mask:0xf
    v_mul_f32_dpp v200, v243, v86 row_newbcast:6 row_mask:0xf bank_mask:0xf
    v_mul_f32_dpp v201, v243, v87 row_newbcast:7 row_mask:0xf bank_mask:0xf
    v_mul_f32_dpp v202, v243, v86 row_newbcast:14 row_mask:0xf bank_mask:0xf
    v_mul_f32_dpp v203, v243, v87 row_newbcast:15 row_mask:0xf bank_mask:0xf
    v_cvt_pk_bf16_f32 v82, v196, v197
    v_cvt_pk_bf16_f32 v86, v198, v199
    v_cvt_pk_bf16_f32 v83, v200, v201
    v_cvt_pk_bf16_f32 v87, v202, v203
    s_waitcnt vmcnt(4) lgkmcnt(0)
    v_mfma_f32_32x32x16_bf16 v[56:71], v[80:83], v[176:179], v[56:71]
    v_mul_f32_dpp v196, v242, v88 row_newbcast:0 row_mask:0xf bank_mask:0xf
    v_mul_f32_dpp v197, v242, v89 row_newbcast:1 row_mask:0xf bank_mask:0xf
    v_mul_f32_dpp v198, v242, v88 row_newbcast:8 row_mask:0xf bank_mask:0xf
    v_mul_f32_dpp v199, v242, v89 row_newbcast:9 row_mask:0xf bank_mask:0xf
    v_mul_f32_dpp v200, v242, v92 row_newbcast:2 row_mask:0xf bank_mask:0xf
    v_mul_f32_dpp v201, v242, v93 row_newbcast:3 row_mask:0xf bank_mask:0xf
    s_add_u32 m0, s21, 2048
    v_mfma_f32_32x32x16_bf16 v[16:31], v[84:87], v[176:179], v[16:31]
    buffer_load_dwordx4 v238, s[4:7], s35 offen  lds
    ds_read_b64_tr_b16 v[176:177], v244 offset:4096
    ds_read_b64_tr_b16 v[188:189], v245 offset:4096
    v_mul_f32_dpp v202, v242, v92 row_newbcast:10 row_mask:0xf bank_mask:0xf
    v_mul_f32_dpp v203, v242, v93 row_newbcast:11 row_mask:0xf bank_mask:0xf
    v_cvt_pk_bf16_f32 v88, v196, v197
    v_cvt_pk_bf16_f32 v92, v198, v199
    v_cvt_pk_bf16_f32 v89, v200, v201
    v_cvt_pk_bf16_f32 v93, v202, v203
    s_waitcnt lgkmcnt(0)
    v_mfma_f32_32x32x8_bf16 v[56:71], v[88:89], v[176:177], v[56:71]
    s_add_u32 m0, s21, 4096
    v_mfma_f32_32x32x8_bf16 v[16:31], v[92:93], v[176:177], v[16:31]
    buffer_load_dwordx4 v234, s[4:7], s36 offen  lds
    buffer_load_dwordx4 v235, s[8:11], s36 offen offset:1024  lds
    s_mov_b32 m0, s50
    s_nop 0
    s_movrels_b32 s71, s23
    s_movrels_b32 s33, s28
    v_add_u32 v253, s33, v248
    s_bfe_u32 s46, s71, 0x30012
    s_mov_b32 m0, s46
    s_and_b32 s66, s71, 0x3ffff
    s_movrels_b32 s68, s57
    s_movrels_b32 s69, s61
    s_sub_u32 s48, s66, s47
    s_mov_b32 s47, s66
    s_lshr_b32 s52, s71, 28
    s_lshl_b32 s67, s46, 9
    s_add_u32 s66, s66, s67
    s_sub_u32 s49, s66, s42
    s_mov_b32 s42, s66
    s_bfe_u32 s66, s68, 655360
    s_add_u32 s43, s42, s66
    s_bfe_u32 s39, s69, 655360
    s_bfe_u32 s66, s68, 655370
    s_add_u32 s44, s42, s66
    s_bfe_u32 s40, s69, 655370
    s_bfe_u32 s66, s68, 655380
    s_add_u32 s45, s42, s66
    s_bfe_u32 s41, s69, 655380
    v_add_u32 v252, s45, v247
    ds_read2_b32 v[240:241], v252 offset0:0 offset1:16
    v_mfma_f32_32x32x16_bf16 v[32:47], v[72:75], v[180:183], 0
    v_mul_f32 v196, v56, v96
    v_fmac_f32 v196, v57, v97
    v_fmac_f32 v196, v58, v98
    v_fmac_f32 v196, v59, v99
    v_fmac_f32 v196, v60, v100
    v_fmac_f32 v196, v61, v101
    v_mfma_f32_32x32x16_bf16 v[0:15], v[76:79], v[180:183], 0
    v_fmac_f32 v196, v62, v102
    v_fmac_f32 v196, v63, v103
    v_mul_f32 v198, v64, v128
    v_fmac_f32 v198, v65, v129
    v_fmac_f32 v198, v66, v130
    v_fmac_f32 v198, v67, v131
    v_mfma_f32_32x32x16_bf16 v[32:47], v[80:83], v[184:187], v[32:47]
    v_fmac_f32 v198, v68, v132
    v_fmac_f32 v198, v69, v133
    v_fmac_f32 v198, v70, v134
    v_fmac_f32 v198, v71, v135
    v_mul_f32 v200, v16, v128
    v_fmac_f32 v200, v17, v129
    v_mfma_f32_32x32x16_bf16 v[0:15], v[84:87], v[184:187], v[0:15]
    s_waitcnt vmcnt(5)
    ds_read_b64_tr_b16 v[176:177], v244 offset:6144
    ds_read_b64_tr_b16 v[178:179], v244 offset:7168
    ds_read_b64_tr_b16 v[180:181], v245 offset:6144
    ds_read_b64_tr_b16 v[182:183], v245 offset:7168
    v_permlane32_swap_b32 v196, v198
    v_fmac_f32 v200, v18, v130
    v_mfma_f32_32x32x8_bf16 v[32:47], v[88:89], v[188:189], v[32:47]
    v_fmac_f32 v200, v19, v131
    v_fmac_f32 v200, v20, v132
    v_fmac_f32 v200, v21, v133
    v_fmac_f32 v200, v22, v134
    v_fmac_f32 v200, v23, v135
    v_add_f32 v198, v196, v198
    v_mfma_f32_32x32x8_bf16 v[0:15], v[92:93], v[188:189], v[0:15]
    v_mul_f32_e64 v202, v24, -v128
    v_fma_f32 v202, v25, -v129, v202
    v_fma_f32 v202, v26, -v130, v202
    v_fma_f32 v202, v27, -v131, v202
    v_fma_f32 v202, v28, -v132, v202
    v_fma_f32 v202, v29, -v133, v202
    v_fma_f32 v202, v30, -v134, v202
    v_fma_f32 v202, v31, -v135, v202
    s_nop 1
    v_permlane32_swap_b32 v200, v202
    v_add_f32 v202, v200, v202
    s_waitcnt vmcnt(3) lgkmcnt(0)
    v_mfma_f32_32x32x16_bf16 v[56:71], v[72:75], v[176:179], 0
    v_mul_f32 v197, v32, v104
    v_fmac_f32 v197, v33, v105
    v_fmac_f32 v197, v34, v106
    v_fmac_f32 v197, v35, v107
    v_fmac_f32 v197, v36, v108
    v_fmac_f32 v197, v37, v109
    s_add_u32 m0, s21, 6144
    v_mfma_f32_32x32x16_bf16 v[16:31], v[76:79], v[176:179], 0
    buffer_load_dwordx4 v236, s[4:7], s36 offen  lds
    buffer_load_dwordx4 v237, s[8:11], s36 offen offset:1024  lds
    ds_read_b64_tr_b16 v[176:177], v244 offset:0
    ds_read_b64_tr_b16 v[178:179], v244 offset:1024
    ds_read_b64_tr_b16 v[184:185], v245 offset:0
    ds_read_b64_tr_b16 v[186:187], v245 offset:1024
    v_fmac_f32 v197, v38, v110
    v_fmac_f32 v197, v39, v111
    v_mul_f32 v199, v40, v136
    v_fmac_f32 v199, v41, v137
    v_fmac_f32 v199, v42, v138
    v_fmac_f32 v199, v43, v139
    v_fmac_f32 v199, v44, v140
    v_fmac_f32 v199, v45, v141
    v_fmac_f32 v199, v46, v142
    v_fmac_f32 v199, v47, v143
    v_mul_f32 v201, v0, v136
    v_fmac_f32 v201, v1, v137
    v_permlane32_swap_b32 v197, v199
    v_fmac_f32 v201, v2, v138
    v_fmac_f32 v201, v3, v139
    s_waitcnt vmcnt(4) lgkmcnt(0)
    v_mfma_f32_32x32x16_bf16 v[56:71], v[80:83], v[176:179], v[56:71]
    v_fmac_f32 v201, v4, v140
    v_fmac_f32 v201, v5, v141
    v_fmac_f32 v201, v6, v142
    v_fmac_f32 v201, v7, v143
    v_add_f32 v199, v197, v199
    v_mul_f32_e64 v203, v8, -v136
    s_add_u32 m0, s21, 0
    v_mfma_f32_32x32x16_bf16 v[16:31], v[84:87], v[176:179], v[16:31]
    buffer_load_dwordx4 v238, s[4:7], s36 offen  lds
    ds_read_b64_tr_b16 v[176:177], v244 offset:2048
    ds_read_b64_tr_b16 v[188:189], v245 offset:2048
    v_fma_f32 v203, v9, -v137, v203
    v_fma_f32 v203, v10, -v138, v203
    v_fma_f32 v203, v11, -v139, v203
    s_waitcnt lgkmcnt(0)
    v_mfma_f32_32x32x8_bf16 v[56:71], v[88:89], v[176:177], v[56:71]
    v_fma_f32 v203, v12, -v140, v203
    v_fma_f32 v203, v13, -v141, v203
    v_fma_f32 v203, v14, -v142, v203
    v_fma_f32 v203, v15, -v143, v203
    s_nop 1
    v_permlane32_swap_b32 v201, v203
    v_add_f32 v203, v201, v203
    s_add_u32 m0, s21, 2048
    v_mfma_f32_32x32x8_bf16 v[16:31], v[92:93], v[176:177], v[16:31]
    buffer_load_dwordx4 v234, s[4:7], s37 offen  lds
    buffer_load_dwordx4 v235, s[8:11], s37 offen offset:1024  lds
    v_add_u32 v252, s42, v247
    ds_read2_b32 v[234:235], v252 offset0:0 offset1:16
    v_cvt_pk_bf16_f32 v192, v198, v199
    v_cvt_pk_bf16_f32 v193, v202, v203
    v_mfma_f32_32x32x16_bf16 v[32:47], v[72:75], v[180:183], 0
    v_mul_f32 v196, v56, v144
    v_fmac_f32 v196, v57, v145
    v_fmac_f32 v196, v58, v146
    v_fmac_f32 v196, v59, v147
    v_fmac_f32 v196, v60, v148
    v_fmac_f32 v196, v61, v149
    v_mfma_f32_32x32x16_bf16 v[0:15], v[76:79], v[180:183], 0
    v_fmac_f32 v196, v62, v150
    v_fmac_f32 v196, v63, v151
    v_mul_f32_e64 v200, v16, -v160
    v_fma_f32 v200, v17, -v161, v200
    v_fma_f32 v200, v18, -v162, v200
    v_fma_f32 v200, v19, -v163, v200
    v_mfma_f32_32x32x16_bf16 v[32:47], v[80:83], v[184:187], v[32:47]
    v_fma_f32 v200, v20, -v164, v200
    v_fma_f32 v200, v21, -v165, v200
    v_fma_f32 v200, v22, -v166, v200
    v_fma_f32 v200, v23, -v167, v200
    v_mul_f32_e64 v202, v24, -v160
    v_fma_f32 v202, v25, -v161, v202
    v_mfma_f32_32x32x16_bf16 v[0:15], v[84:87], v[184:187], v[0:15]
    s_waitcnt vmcnt(5)
    ds_read_b64_tr_b16 v[176:177], v244 offset:4096
    ds_read_b64_tr_b16 v[178:179], v244 offset:5120
    ds_read_b64_tr_b16 v[180:181], v245 offset:4096
    ds_read_b64_tr_b16 v[182:183], v245 offset:5120
    v_fma_f32 v202, v26, -v162, v202
    v_fma_f32 v202, v27, -v163, v202
    v_mfma_f32_32x32x8_bf16 v[32:47], v[88:89], v[188:189], v[32:47]
    v_fma_f32 v202, v28, -v164, v202
    v_fma_f32 v202, v29, -v165, v202
    v_fma_f32 v202, v30, -v166, v202
    v_fma_f32 v202, v31, -v167, v202
    v_mfma_f32_32x32x8_bf16 v[0:15], v[92:93], v[188:189], v[0:15]
    s_waitcnt vmcnt(3) lgkmcnt(0)
    v_mfma_f32_32x32x16_bf16 v[16:31], v[72:75], v[176:179], 0
    s_nop 4
    v_mul_f32 v197, v32, v152
    v_fmac_f32 v197, v33, v153
    v_fmac_f32 v197, v34, v154
    v_fmac_f32 v197, v35, v155
    v_fmac_f32 v197, v36, v156
    v_fmac_f32 v197, v37, v157
    s_add_u32 m0, s21, 4096
    v_mfma_f32_32x32x16_bf16 v[48:63], v[76:79], v[176:179], 0
    buffer_load_dwordx4 v236, s[4:7], s37 offen  lds
    buffer_load_dwordx4 v237, s[8:11], s37 offen offset:1024  lds
    ds_read_b64_tr_b16 v[176:177], v244 offset:6144
    ds_read_b64_tr_b16 v[178:179], v244 offset:7168
    ds_read_b64_tr_b16 v[184:185], v245 offset:6144
    ds_read_b64_tr_b16 v[186:187], v245 offset:7168
    v_add_u32 v252, s43, v247
    ds_read2_b32 v[236:237], v252 offset0:0 offset1:16
    v_fmac_f32 v197, v38, v158
    v_fmac_f32 v197, v39, v159
    v_mul_f32_e64 v201, v0, -v168
    s_waitcnt vmcnt(4) lgkmcnt(1)
    v_mfma_f32_32x32x16_bf16 v[16:31], v[80:83], v[176:179], v[16:31]
    v_fma_f32 v201, v1, -v169, v201
    v_fma_f32 v201, v2, -v170, v201
    v_fma_f32 v201, v3, -v171, v201
    v_fma_f32 v201, v4, -v172, v201
    v_fma_f32 v201, v5, -v173, v201
    v_fma_f32 v201, v6, -v174, v201
    s_add_u32 m0, s21, 6144
    v_mfma_f32_32x32x16_bf16 v[48:63], v[84:87], v[176:179], v[48:63]
    buffer_load_dwordx4 v238, s[4:7], s37 offen  lds
    ds_read_b64_tr_b16 v[176:177], v244 offset:0
    ds_read_b64_tr_b16 v[188:189], v245 offset:0
    v_add_u32 v252, s44, v247
    ds_read2_b32 v[238:239], v252 offset0:0 offset1:16
    v_fma_f32 v201, v7, -v175, v201
    s_waitcnt lgkmcnt(1)
    v_mfma_f32_32x32x8_bf16 v[16:31], v[88:89], v[176:177], v[16:31]
    v_mul_f32_e64 v203, v8, -v168
    v_fma_f32 v203, v9, -v169, v203
    v_fma_f32 v203, v10, -v170, v203
    v_fma_f32 v203, v11, -v171, v203
    v_fma_f32 v203, v12, -v172, v203
    v_fma_f32 v203, v13, -v173, v203
    s_add_u32 m0, s21, 0
    v_mfma_f32_32x32x8_bf16 v[48:63], v[92:93], v[176:177], v[48:63]
    s_cbranch_vccnz WL_5_0
    v_mad_u32_u16 v234, v234, s3, v246 op_sel:[1,0,0,0]
    v_mad_u32_u16 v235, v235, s3, v246 op_sel:[1,0,0,0]
    buffer_load_dwordx4 v234, s[4:7], s38 offen  lds
    buffer_load_dwordx4 v235, s[8:11], s38 offen offset:1024  lds
WR_5_0:
    v_fma_f32 v203, v14, -v174, v203
    v_fma_f32 v203, v15, -v175, v203
    v_mfma_f32_32x32x16_bf16 v[0:15], v[72:75], v[180:183], 0
    v_fmac_f32 v200, v24, v160
    v_fmac_f32 v200, v25, v161
    v_fmac_f32 v200, v26, v162
    v_fmac_f32 v200, v27, v163
    v_fmac_f32 v200, v28, v164
    v_fmac_f32 v200, v29, v165
    v_fmac_f32 v200, v30, v166
    v_fmac_f32 v200, v31, v167
    v_mfma_f32_32x32x16_bf16 v[24:39], v[76:79], v[180:183], 0
    v_mul_f32 v254, v16, v144
    v_fmac_f32 v254, v17, v145
    v_fmac_f32 v254, v18, v146
    v_fmac_f32 v254, v19, v147
    v_fmac_f32 v254, v20, v148
    v_fmac_f32 v254, v21, v149
    v_mfma_f32_32x32x16_bf16 v[0:15], v[80:83], v[184:187], v[0:15]
    v_fmac_f32 v254, v22, v150
    v_fmac_f32 v254, v23, v151
    v_sub_f32_e64 v64, -v48, v64
    v_sub_f32_e64 v65, -v49, v65
    v_permlane32_swap_b32 v196, v254
    v_sub_f32_e64 v66, -v50, v66
    v_mfma_f32_32x32x16_bf16 v[24:39], v[84:87], v[184:187], v[24:39]
    s_waitcnt vmcnt(5)
    ds_read_b64_tr_b16 v[176:177], v244 offset:2048
    ds_read_b64_tr_b16 v[178:179], v244 offset:3072
    ds_read_b64_tr_b16 v[180:181], v245 offset:2048
    ds_read_b64_tr_b16 v[182:183], v245 offset:3072
    v_sub_f32_e64 v67, -v51, v67
    v_sub_f32_e64 v68, -v52, v68
    v_mfma_f32_32x32x8_bf16 v[24:39], v[92:93], v[188:189], v[24:39]
    v_sub_f32_e64 v69, -v53, v69
    v_sub_f32_e64 v70, -v54, v70
    v_sub_f32_e64 v71, -v55, v71
    v_add_f32 v254, v196, v254
    v_mfma_f32_32x32x8_bf16 v[0:15], v[88:89], v[188:189], v[0:15]
    s_waitcnt vmcnt(3) lgkmcnt(0)
    v_mfma_f32_32x32x16_bf16 v[56:71], v[76:79], v[176:179], v[56:71]
    s_nop 4
    v_sub_f32_e64 v40, -v24, v40
    v_sub_f32_e64 v41, -v25, v41
    v_sub_f32_e64 v42, -v26, v42
    v_sub_f32_e64 v43, -v27, v43
    v_sub_f32_e64 v44, -v28, v44
    v_sub_f32_e64 v45, -v29, v45
    v_sub_f32_e64 v46, -v30, v46
    v_sub_f32_e64 v47, -v31, v47
    s_add_u32 m0, s21, 2048
    v_mfma_f32_32x32x16_bf16 v[16:31], v[72:75], v[176:179], 0
    s_cbranch_vccnz WL_5_1
    v_mad_u32_u16 v236, v236, s3, v246 op_sel:[1,0,0,0]
    v_mad_u32_u16 v237, v237, s3, v246 op_sel:[1,0,0,0]
    buffer_load_dwordx4 v236, s[4:7], s39 offen  lds
    buffer_load_dwordx4 v237, s[8:11], s39 offen offset:1024  lds
WR_5_1:
    ds_read_b64_tr_b16 v[176:177], v244 offset:4096
    ds_read_b64_tr_b16 v[178:179], v244 offset:5120
    ds_read_b64_tr_b16 v[184:185], v245 offset:4096
    ds_read_b64_tr_b16 v[186:187], v245 offset:5120
    v_mul_f32 v255, v0, v152
    v_fmac_f32 v255, v1, v153
    v_fmac_f32 v255, v2, v154
    v_fmac_f32 v255, v3, v155
    v_fmac_f32 v255, v4, v156
    s_waitcnt vmcnt(4) lgkmcnt(0)
    v_mfma_f32_32x32x16_bf16 v[16:31], v[80:83], v[176:179], v[16:31]
    v_fmac_f32 v255, v5, v157
    v_fmac_f32 v255, v6, v158
    v_fmac_f32 v255, v7, v159
    v_fmac_f32 v201, v8, v168
    v_fmac_f32 v201, v9, v169
    v_permlane32_swap_b32 v197, v255
    s_add_u32 m0, s21, 4096
    v_mfma_f32_32x32x16_bf16 v[56:71], v[84:87], v[176:179], v[56:71]
    s_cbranch_vccnz WL_5_2
    v_mad_u32_u16 v238, v238, s3, v246 op_sel:[1,0,0,0]
    v_mad_u32_u16 v239, v239, s3, v246 op_sel:[1,0,0,0]
    buffer_load_dwordx4 v238, s[4:7], s40 offen  lds
    buffer_load_dwordx4 v239, s[8:11], s40 offen offset:1024  lds
WR_5_2:
    ds_read_b64_tr_b16 v[176:177], v244 offset:6144
    ds_read_b64_tr_b16 v[188:189], v245 offset:6144
    s_waitcnt lgkmcnt(0)
    v_mfma_f32_32x32x8_bf16 v[16:31], v[88:89], v[176:177], v[16:31]
    v_fmac_f32 v201, v10, v170
    v_fmac_f32 v201, v11, v171
    v_fmac_f32 v201, v12, v172
    v_fmac_f32 v201, v13, v173
    v_fmac_f32 v201, v14, v174
    v_fmac_f32 v201, v15, v175
    s_add_u32 m0, s21, 6144
    v_mfma_f32_32x32x8_bf16 v[56:71], v[92:93], v[176:177], v[56:71]
    s_cbranch_vccnz WL_5_3
    v_mad_u32_u16 v240, v240, s3, v246 op_sel:[1,0,0,0]
    v_mad_u32_u16 v241, v241, s3, v246 op_sel:[1,0,0,0]
    buffer_load_dwordx4 v240, s[4:7], s41 offen  lds
    buffer_load_dwordx4 v241, s[8:11], s41 offen offset:1024  lds
WR_5_3:
    v_add_f32 v255, v197, v255
    v_cvt_pk_bf16_f32 v194, v254, v255
    v_mfma_f32_32x32x16_bf16 v[0:15], v[72:75], v[180:183], 0
    v_mul_f32 v254, v16, v144
    v_fmac_f32 v254, v17, v145
    v_fmac_f32 v254, v18, v146
    v_fmac_f32 v254, v19, v147
    v_fmac_f32 v254, v20, v148
    v_fmac_f32 v254, v21, v149
    v_mfma_f32_32x32x16_bf16 v[32:47], v[76:79], v[180:183], v[32:47]
    v_fmac_f32 v254, v22, v150
    v_fmac_f32 v254, v23, v151
    v_fma_f32 v202, v24, -v160, v202
    v_fma_f32 v202, v25, -v161, v202
    v_permlane32_swap_b32 v254, v200
    v_fma_f32 v202, v26, -v162, v202
    v_mfma_f32_32x32x16_bf16 v[0:15], v[80:83], v[184:187], v[0:15]
    v_fma_f32 v202, v27, -v163, v202
    v_fma_f32 v202, v28, -v164, v202
    v_fma_f32 v202, v29, -v165, v202
    v_fma_f32 v202, v30, -v166, v202
    v_fma_f32 v202, v31, -v167, v202
    v_add_f32 v200, v254, v200
    v_mfma_f32_32x32x16_bf16 v[32:47], v[84:87], v[184:187], v[32:47]
    s_waitcnt vmcnt(6)
    ds_read_b64_tr_b16 v[176:177], v244 offset:0
    ds_read_b64_tr_b16 v[178:179], v244 offset:1024
    ds_read_b64_tr_b16 v[180:181], v245 offset:0
    ds_read_b64_tr_b16 v[182:183], v245 offset:1024
    v_mul_f32_e64 v198, v64, -v112
    v_permlane32_swap_b32 v202, v254
    v_mfma_f32_32x32x8_bf16 v[0:15], v[88:89], v[188:189], v[0:15]
    v_fma_f32 v198, v65, -v113, v198
    v_fma_f32 v198, v66, -v114, v198
    v_fma_f32 v198, v67, -v115, v198
    v_fma_f32 v198, v68, -v116, v198
    v_fma_f32 v198, v69, -v117, v198
    v_fma_f32 v198, v70, -v118, v198
    v_mfma_f32_32x32x8_bf16 v[32:47], v[92:93], v[188:189], v[32:47]
    v_add_u32 v249, s48, v249
    v_add_u32 v250, s49, v250
    ds_read_b32 v252, v251 offset:16
    ds_read_b64_tr_b16 v[72:73], v249 offset:0
    ds_read_b64_tr_b16 v[76:77], v249 offset:64
    ds_read_b64_tr_b16 v[74:75], v249 offset:256
    ds_read_b64_tr_b16 v[78:79], v249 offset:320
    s_mov_b64 exec, s[54:55]
    ds_read_u16_d16_hi v242, v250 offset:0
    s_mov_b64 exec, -1
    v_fma_f32 v198, v71, -v119, v198
    v_add_f32 v254, v202, v254
    v_mul_f32 v196, v56, v160
    v_fmac_f32 v196, v57, v161
    v_fmac_f32 v196, v58, v162
    v_fmac_f32 v196, v59, v163
    v_fmac_f32 v196, v60, v164
    v_fmac_f32 v196, v61, v165
    v_fmac_f32 v196, v62, v166
    v_fmac_f32 v196, v63, v167
    s_nop 1
    v_permlane32_swap_b32 v198, v196
    v_add_f32 v196, v198, v196
    s_cbranch_vccnz LEPI_0
    v_mul_f32 v255, v0, v152
    v_fmac_f32 v255, v1, v153
    v_fmac_f32 v255, v2, v154
    v_fmac_f32 v255, v3, v155
    v_fmac_f32 v255, v4, v156
    v_fmac_f32 v255, v5, v157
    v_fmac_f32 v255, v6, v158
    v_fmac_f32 v255, v7, v159
    v_fma_f32 v203, v8, -v168, v203
    v_fma_f32 v203, v9, -v169, v203
    v_permlane32_swap_b32 v255, v201
    v_fma_f32 v203, v10, -v170, v203
    v_fma_f32 v203, v11, -v171, v203
    v_fma_f32 v203, v12, -v172, v203
    v_fma_f32 v203, v13, -v173, v203
    v_fma_f32 v203, v14, -v174, v203
    v_fma_f32 v203, v15, -v175, v203
    v_add_f32 v201, v255, v201
    v_mul_f32_e64 v199, v40, -v120
    v_permlane32_swap_b32 v203, v255
    v_fma_f32 v199, v41, -v121, v199
    v_fma_f32 v199, v42, -v122, v199
    v_fma_f32 v199, v43, -v123, v199
    v_fma_f32 v199, v44, -v124, v199
    v_fma_f32 v199, v45, -v125, v199
    v_fma_f32 v199, v46, -v126, v199
    v_fma_f32 v199, v47, -v127, v199
    v_add_f32 v255, v203, v255
    v_mul_f32 v197, v32, v168
    v_fmac_f32 v197, v33, v169
    v_fmac_f32 v197, v34, v170
    v_fmac_f32 v197, v35, v171
    v_fmac_f32 v197, v36, v172
    v_fmac_f32 v197, v37, v173
    v_fmac_f32 v197, v38, v174
    v_fmac_f32 v197, v39, v175
    s_nop 1
    v_permlane32_swap_b32 v199, v197
    v_add_f32 v197, v199, v197
    v_cvt_pk_bf16_f32 v200, v200, v201
    v_cvt_pk_bf16_f32 v254, v254, v255
    v_cvt_pk_bf16_f32 v196, v196, v197
    ds_write2st64_b32 v253, v192, v193 offset0:0 offset1:1
    ds_write2st64_b32 v253, v194, v200 offset0:2 offset1:3
    ds_write_b32 v253, v196 offset:1024
    s_mov_b64 exec, 0xffffffff
    ds_write_b32 v253, v254 offset:1280
    s_mov_b64 exec, -1
    s_add_u32 s50, s50, 1
    s_cmp_ge_u32 s50, 4
    s_cbranch_scc1 LAST1
    s_waitcnt lgkmcnt(9)
    v_readfirstlane_b32 s66, v252
    s_add_u32 s53, s53, 1
    v_mov_b32 v252, s53
    s_cmp_le_u32 s53, s66
    ds_write2_b32 v251, v252, v252 offset0:0 offset1:8
    s_setprio 1
    s_cbranch_scc1 PRIO_12
    s_setprio 0
PRIO_12:
    s_cmp_eq_u32 s52, 4
    s_cbranch_scc1 ITEM_1_4
    s_cmp_eq_u32 s52, 5
    s_cbranch_scc1 ITEM_1_5
    s_cmp_eq_u32 s52, 3
    s_cbranch_scc1 ITEM_1_3
    s_cmp_eq_u32 s52, 6
    s_cbranch_scc1 ITEM_1_6
    s_cmp_eq_u32 s52, 8
    s_cbranch_scc1 ITEM_1_8
    s_branch ITEM_1_2
WL_5_0:
    s_add_u32 s66, s51, 0
    buffer_load_dwordx4 v[96:99], v246, s[16:19], s66 offen offset:2048 sc1
    buffer_load_dwordx4 v[100:103], v246, s[16:19], s66 offen offset:3072 sc1
    s_branch WR_5_0
WL_5_1:
    s_add_u32 s66, s51, 4096
    buffer_load_dwordx4 v[104:107], v246, s[16:19], s66 offen offset:2048 sc1
    buffer_load_dwordx4 v[108:111], v246, s[16:19], s66 offen offset:3072 sc1
    s_branch WR_5_1
WL_5_2:
    s_add_u32 s66, s51, 8192
    buffer_load_dwordx4 v[128:131], v246, s[16:19], s66 offen offset:2048 sc1
    buffer_load_dwordx4 v[132:135], v246, s[16:19], s66 offen offset:3072 sc1
    s_branch WR_5_2
WL_5_3:
    s_add_u32 s66, s51, 12288
    buffer_load_dwordx4 v[136:139], v246, s[16:19], s66 offen offset:2048 sc1
    buffer_load_dwordx4 v[140:143], v246, s[16:19], s66 offen offset:3072 sc1
    s_branch WR_5_3
.p2align 6
ITEM_1_3:
    s_mov_b64 exec, s[54:55]
    ds_read_u16_d16_hi v243, v250 offset:128
    s_mov_b64 exec, -1
    ds_read_b64_tr_b16 v[80:81], v249 offset:512
    ds_read_b64_tr_b16 v[84:85], v249 offset:576
    s_waitcnt lgkmcnt(3)
    v_mul_f32_dpp v196, v242, v72 row_newbcast:0 row_mask:0xf bank_mask:0xf
    v_mul_f32_dpp v197, v242, v73 row_newbcast:1 row_mask:0xf bank_mask:0xf
    v_mul_f32_dpp v198, v242, v72 row_newbcast:8 row_mask:0xf bank_mask:0xf
    v_mul_f32_dpp v199, v242, v73 row_newbcast:9 row_mask:0xf bank_mask:0xf
    v_mul_f32_dpp v200, v242, v76 row_newbcast:2 row_mask:0xf bank_mask:0xf
    v_mul_f32_dpp v201, v242, v77 row_newbcast:3 row_mask:0xf bank_mask:0xf
    v_mul_f32_dpp v202, v242, v76 row_newbcast:10 row_mask:0xf bank_mask:0xf
    v_mul_f32_dpp v203, v242, v77 row_newbcast:11 row_mask:0xf bank_mask:0xf
    v_cvt_pk_bf16_f32 v72, v196, v197
    v_cvt_pk_bf16_f32 v76, v198, v199
    v_cvt_pk_bf16_f32 v73, v200, v201
    v_cvt_pk_bf16_f32 v77, v202, v203
    v_mul_f32_dpp v196, v242, v74 row_newbcast:4 row_mask:0xf bank_mask:0xf
    v_mul_f32_dpp v197, v242, v75 row_newbcast:5 row_mask:0xf bank_mask:0xf
    v_mul_f32_dpp v198, v242, v74 row_newbcast:12 row_mask:0xf bank_mask:0xf
    v_mul_f32_dpp v199, v242, v75 row_newbcast:13 row_mask:0xf bank_mask:0xf
    v_mul_f32_dpp v200, v242, v78 row_newbcast:6 row_mask:0xf bank_mask:0xf
    v_mul_f32_dpp v201, v242, v79 row_newbcast:7 row_mask:0xf bank_mask:0xf
    v_mul_f32_dpp v202, v242, v78 row_newbcast:14 row_mask:0xf bank_mask:0xf
    v_mul_f32_dpp v203, v242, v79 row_newbcast:15 row_mask:0xf bank_mask:0xf
    v_cvt_pk_bf16_f32 v74, v196, v197
    v_cvt_pk_bf16_f32 v78, v198, v199
    v_cvt_pk_bf16_f32 v75, v200, v201
    v_cvt_pk_bf16_f32 v79, v202, v203
    s_waitcnt vmcnt(4) lgkmcnt(0)
    v_mfma_f32_32x32x16_bf16 v[56:71], v[72:75], v[176:179], 0
    v_mul_f32_dpp v196, v243, v80 row_newbcast:0 row_mask:0xf bank_mask:0xf
    v_mul_f32_dpp v197, v243, v81 row_newbcast:1 row_mask:0xf bank_mask:0xf
    v_mul_f32_dpp v198, v243, v80 row_newbcast:8 row_mask:0xf bank_mask:0xf
    v_mul_f32_dpp v199, v243, v81 row_newbcast:9 row_mask:0xf bank_mask:0xf
    v_mul_f32_dpp v200, v243, v84 row_newbcast:2 row_mask:0xf bank_mask:0xf
    v_mul_f32_dpp v201, v243, v85 row_newbcast:3 row_mask:0xf bank_mask:0xf
    s_add_u32 m0, s21, 0
    v_mfma_f32_32x32x16_bf16 v[16:31], v[76:79], v[176:179], 0
    buffer_load_dwordx4 v234, s[4:7], s36 offen  lds
    buffer_load_dwordx4 v235, s[8:11], s36 offen offset:1024  lds
    ds_read_b64_tr_b16 v[176:177], v244 offset:2048
    ds_read_b64_tr_b16 v[184:185], v245 offset:2048
    v_mul_f32_dpp v202, v243, v84 row_newbcast:10 row_mask:0xf bank_mask:0xf
    v_mul_f32_dpp v203, v243, v85 row_newbcast:11 row_mask:0xf bank_mask:0xf
    v_cvt_pk_bf16_f32 v80, v196, v197
    v_cvt_pk_bf16_f32 v84, v198, v199
    v_cvt_pk_bf16_f32 v81, v200, v201
    v_cvt_pk_bf16_f32 v85, v202, v203
    s_waitcnt lgkmcnt(0)
    v_mfma_f32_32x32x8_bf16 v[56:71], v[80:81], v[176:177], v[56:71]
    s_add_u32 m0, s21, 2048
    v_mfma_f32_32x32x8_bf16 v[16:31], v[84:85], v[176:177], v[16:31]
    buffer_load_dwordx4 v236, s[4:7], s36 offen  lds
    s_mov_b32 m0, s50
    s_nop 0
    s_movrels_b32 s71, s23
    s_movrels_b32 s33, s28
    v_add_u32 v253, s33, v248
    s_bfe_u32 s46, s71, 0x30012
    s_mov_b32 m0, s46
    s_and_b32 s66, s71, 0x3ffff
    s_movrels_b32 s68, s57
    s_movrels_b32 s69, s61
    s_sub_u32 s48, s66, s47
    s_mov_b32 s47, s66
    s_lshr_b32 s52, s71, 28
    s_lshl_b32 s67, s46, 9
    s_add_u32 s66, s66, s67
    s_sub_u32 s49, s66, s42
    s_mov_b32 s42, s66
    s_bfe_u32 s66, s68, 655360
    s_add_u32 s43, s42, s66
    s_bfe_u32 s39, s69, 655360
    s_bfe_u32 s66, s68, 655370
    s_add_u32 s44, s42, s66
    s_bfe_u32 s40, s69, 655370
    s_bfe_u32 s66, s68, 655380
    s_add_u32 s45, s42, s66
    s_bfe_u32 s41, s69, 655380
    v_add_u32 v252, s44, v247
    ds_read2_b32 v[238:239], v252 offset0:0 offset1:16
    v_add_u32 v252, s45, v247
    ds_read2_b32 v[240:241], v252 offset0:0 offset1:16
    v_mfma_f32_32x32x16_bf16 v[32:47], v[72:75], v[180:183], 0
    v_mul_f32 v196, v56, v96
    v_fmac_f32 v196, v57, v97
    v_fmac_f32 v196, v58, v98
    v_fmac_f32 v196, v59, v99
    v_fmac_f32 v196, v60, v100
    v_fmac_f32 v196, v61, v101
    v_mfma_f32_32x32x16_bf16 v[0:15], v[76:79], v[180:183], 0
    s_waitcnt vmcnt(5)
    ds_read_b64_tr_b16 v[176:177], v244 offset:4096
    ds_read_b64_tr_b16 v[178:179], v244 offset:5120
    ds_read_b64_tr_b16 v[180:181], v245 offset:4096
    ds_read_b64_tr_b16 v[182:183], v245 offset:5120
    v_fmac_f32 v196, v62, v102
    v_fmac_f32 v196, v63, v103
    v_mfma_f32_32x32x8_bf16 v[32:47], v[80:81], v[184:185], v[32:47]
    v_mul_f32 v198, v64, v128
    v_fmac_f32 v198, v65, v129
    v_fmac_f32 v198, v66, v130
    v_fmac_f32 v198, v67, v131
    v_fmac_f32 v198, v68, v132
    v_fmac_f32 v198, v69, v133
    v_mfma_f32_32x32x8_bf16 v[0:15], v[84:85], v[184:185], v[0:15]
    v_fmac_f32 v198, v70, v134
    v_fmac_f32 v198, v71, v135
    v_mul_f32 v200, v16, v128
    v_fmac_f32 v200, v17, v129
    v_permlane32_swap_b32 v196, v198
    v_fmac_f32 v200, v18, v130
    v_fmac_f32 v200, v19, v131
    v_fmac_f32 v200, v20, v132
    v_fmac_f32 v200, v21, v133
    v_fmac_f32 v200, v22, v134
    v_fmac_f32 v200, v23, v135
    v_add_f32 v198, v196, v198
    v_mul_f32_e64 v202, v24, -v128
    v_fma_f32 v202, v25, -v129, v202
    v_fma_f32 v202, v26, -v130, v202
    v_fma_f32 v202, v27, -v131, v202
    v_fma_f32 v202, v28, -v132, v202
    v_fma_f32 v202, v29, -v133, v202
    v_fma_f32 v202, v30, -v134, v202
    v_fma_f32 v202, v31, -v135, v202
    s_nop 1
    v_permlane32_swap_b32 v200, v202
    v_add_f32 v202, v200, v202
    s_waitcnt vmcnt(3) lgkmcnt(0)
    v_mfma_f32_32x32x16_bf16 v[56:71], v[72:75], v[176:179], 0
    v_mul_f32 v197, v32, v104
    v_fmac_f32 v197, v33, v105
    v_fmac_f32 v197, v34, v106
    v_fmac_f32 v197, v35, v107
    v_fmac_f32 v197, v36, v108
    v_fmac_f32 v197, v37, v109
    s_add_u32 m0, s21, 4096
    v_mfma_f32_32x32x16_bf16 v[16:31], v[76:79], v[176:179], 0
    buffer_load_dwordx4 v234, s[4:7], s37 offen  lds
    buffer_load_dwordx4 v235, s[8:11], s37 offen offset:1024  lds
    ds_read_b64_tr_b16 v[176:177], v244 offset:6144
    ds_read_b64_tr_b16 v[184:185], v245 offset:6144
    v_add_u32 v252, s42, v247
    ds_read2_b32 v[234:235], v252 offset0:0 offset1:16
    v_fmac_f32 v197, v38, v110
    v_fmac_f32 v197, v39, v111
    v_mul_f32 v199, v40, v136
    v_fmac_f32 v199, v41, v137
    v_fmac_f32 v199, v42, v138
    v_fmac_f32 v199, v43, v139
    v_fmac_f32 v199, v44, v140
    v_fmac_f32 v199, v45, v141
    v_fmac_f32 v199, v46, v142
    v_fmac_f32 v199, v47, v143
    v_mul_f32 v201, v0, v136
    v_fmac_f32 v201, v1, v137
    v_permlane32_swap_b32 v197, v199
    v_fmac_f32 v201, v2, v138
    v_fmac_f32 v201, v3, v139
    v_fmac_f32 v201, v4, v140
    v_fmac_f32 v201, v5, v141
    v_fmac_f32 v201, v6, v142
    v_fmac_f32 v201, v7, v143
    v_add_f32 v199, v197, v199
    v_mul_f32_e64 v203, v8, -v136
    v_fma_f32 v203, v9, -v137, v203
    v_fma_f32 v203, v10, -v138, v203
    s_waitcnt lgkmcnt(1)
    v_mfma_f32_32x32x8_bf16 v[56:71], v[80:81], v[176:177], v[56:71]
    v_fma_f32 v203, v11, -v139, v203
    v_fma_f32 v203, v12, -v140, v203
    v_fma_f32 v203, v13, -v141, v203
    v_fma_f32 v203, v14, -v142, v203
    v_fma_f32 v203, v15, -v143, v203
    s_nop 1
    v_permlane32_swap_b32 v201, v203
    s_add_u32 m0, s21, 6144
    v_mfma_f32_32x32x8_bf16 v[16:31], v[84:85], v[176:177], v[16:31]
    buffer_load_dwordx4 v236, s[4:7], s37 offen  lds
    v_add_u32 v252, s43, v247
    ds_read2_b32 v[236:237], v252 offset0:0 offset1:16
    v_add_f32 v203, v201, v203
    v_cvt_pk_bf16_f32 v192, v198, v199
    v_cvt_pk_bf16_f32 v193, v202, v203
    v_mfma_f32_32x32x16_bf16 v[32:47], v[72:75], v[180:183], 0
    v_mul_f32 v196, v56, v144
    v_fmac_f32 v196, v57, v145
    v_fmac_f32 v196, v58, v146
    v_fmac_f32 v196, v59, v147
    v_fmac_f32 v196, v60, v148
    v_fmac_f32 v196, v61, v149
    v_mfma_f32_32x32x16_bf16 v[0:15], v[76:79], v[180:183], 0
    s_waitcnt vmcnt(4)
    ds_read_b64_tr_b16 v[176:177], v244 offset:0
    ds_read_b64_tr_b16 v[178:179], v244 offset:1024
    ds_read_b64_tr_b16 v[180:181], v245 offset:0
    ds_read_b64_tr_b16 v[182:183], v245 offset:1024
    v_fmac_f32 v196, v62, v150
    v_fmac_f32 v196, v63, v151
    v_mfma_f32_32x32x8_bf16 v[32:47], v[80:81], v[184:185], v[32:47]
    v_mul_f32_e64 v200, v16, -v160
    v_fma_f32 v200, v17, -v161, v200
    v_fma_f32 v200, v18, -v162, v200
    v_fma_f32 v200, v19, -v163, v200
    v_fma_f32 v200, v20, -v164, v200
    v_fma_f32 v200, v21, -v165, v200
    v_mfma_f32_32x32x8_bf16 v[0:15], v[84:85], v[184:185], v[0:15]
    v_fma_f32 v200, v22, -v166, v200
    v_fma_f32 v200, v23, -v167, v200
    v_mul_f32_e64 v202, v24, -v160
    v_fma_f32 v202, v25, -v161, v202
    v_fma_f32 v202, v26, -v162, v202
    v_fma_f32 v202, v27, -v163, v202
    v_fma_f32 v202, v28, -v164, v202
    v_fma_f32 v202, v29, -v165, v202
    v_fma_f32 v202, v30, -v166, v202
    v_fma_f32 v202, v31, -v167, v202
    s_waitcnt vmcnt(3) lgkmcnt(0)
    v_mfma_f32_32x32x16_bf16 v[16:31], v[72:75], v[176:179], 0
    v_mul_f32 v197, v32, v152
    v_fmac_f32 v197, v33, v153
    v_fmac_f32 v197, v34, v154
    v_fmac_f32 v197, v35, v155
    v_fmac_f32 v197, v36, v156
    v_fmac_f32 v197, v37, v157
    s_add_u32 m0, s21, 0
    v_mfma_f32_32x32x16_bf16 v[48:63], v[76:79], v[176:179], 0
    s_cbranch_vccnz WL_3_0
    v_mad_u32_u16 v234, v234, s3, v246 op_sel:[1,0,0,0]
    v_mad_u32_u16 v235, v235, s3, v246 op_sel:[1,0,0,0]
    buffer_load_dwordx4 v234, s[4:7], s38 offen  lds
    buffer_load_dwordx4 v235, s[8:11], s38 offen offset:1024  lds
WR_3_0:
    ds_read_b64_tr_b16 v[176:177], v244 offset:2048
    ds_read_b64_tr_b16 v[184:185], v245 offset:2048
    v_fmac_f32 v197, v38, v158
    v_fmac_f32 v197, v39, v159
    v_mul_f32_e64 v201, v0, -v168
    v_fma_f32 v201, v1, -v169, v201
    v_fma_f32 v201, v2, -v170, v201
    v_fma_f32 v201, v3, -v171, v201
    v_fma_f32 v201, v4, -v172, v201
    v_fma_f32 v201, v5, -v173, v201
    v_fma_f32 v201, v6, -v174, v201
    v_fma_f32 v201, v7, -v175, v201
    s_waitcnt lgkmcnt(0)
    v_mfma_f32_32x32x8_bf16 v[16:31], v[80:81], v[176:177], v[16:31]
    v_mul_f32_e64 v203, v8, -v168
    v_fma_f32 v203, v9, -v169, v203
    v_fma_f32 v203, v10, -v170, v203
    v_fma_f32 v203, v11, -v171, v203
    v_fma_f32 v203, v12, -v172, v203
    v_fma_f32 v203, v13, -v173, v203
    s_add_u32 m0, s21, 2048
    v_mfma_f32_32x32x8_bf16 v[48:63], v[84:85], v[176:177], v[48:63]
    s_cbranch_vccnz WL_3_1
    v_mad_u32_u16 v236, v236, s3, v246 op_sel:[1,0,0,0]
    v_mad_u32_u16 v237, v237, s3, v246 op_sel:[1,0,0,0]
    buffer_load_dwordx4 v236, s[4:7], s39 offen  lds
    buffer_load_dwordx4 v237, s[8:11], s39 offen offset:1024  lds
WR_3_1:
    v_fma_f32 v203, v14, -v174, v203
    v_fma_f32 v203, v15, -v175, v203
    v_mfma_f32_32x32x16_bf16 v[0:15], v[72:75], v[180:183], 0
    v_fmac_f32 v200, v24, v160
    v_fmac_f32 v200, v25, v161
    v_fmac_f32 v200, v26, v162
    v_fmac_f32 v200, v27, v163
    v_fmac_f32 v200, v28, v164
    v_fmac_f32 v200, v29, v165
    v_fmac_f32 v200, v30, v166
    v_fmac_f32 v200, v31, v167
    v_mfma_f32_32x32x16_bf16 v[24:39], v[76:79], v[180:183], 0
    s_waitcnt vmcnt(5)
    ds_read_b64_tr_b16 v[176:177], v244 offset:4096
    ds_read_b64_tr_b16 v[178:179], v244 offset:5120
    ds_read_b64_tr_b16 v[180:181], v245 offset:4096
    ds_read_b64_tr_b16 v[182:183], v245 offset:5120
    v_mul_f32 v254, v16, v144
    v_fmac_f32 v254, v17, v145
    v_mfma_f32_32x32x8_bf16 v[24:39], v[84:85], v[184:185], v[24:39]
    v_fmac_f32 v254, v18, v146
    v_fmac_f32 v254, v19, v147
    v_fmac_f32 v254, v20, v148
    v_fmac_f32 v254, v21, v149
    v_fmac_f32 v254, v22, v150
    v_fmac_f32 v254, v23, v151
    v_mfma_f32_32x32x8_bf16 v[0:15], v[80:81], v[184:185], v[0:15]
    v_sub_f32_e64 v64, -v48, v64
    v_sub_f32_e64 v65, -v49, v65
    v_permlane32_swap_b32 v196, v254
    v_sub_f32_e64 v66, -v50, v66
    v_sub_f32_e64 v67, -v51, v67
    v_sub_f32_e64 v68, -v52, v68
    v_sub_f32_e64 v69, -v53, v69
    v_sub_f32_e64 v70, -v54, v70
    v_sub_f32_e64 v71, -v55, v71
    v_add_f32 v254, v196, v254
    s_waitcnt vmcnt(4) lgkmcnt(0)
    v_mfma_f32_32x32x16_bf16 v[56:71], v[76:79], v[176:179], v[56:71]
    v_sub_f32_e64 v40, -v24, v40
    v_sub_f32_e64 v41, -v25, v41
    v_sub_f32_e64 v42, -v26, v42
    v_sub_f32_e64 v43, -v27, v43
    v_sub_f32_e64 v44, -v28, v44
    v_sub_f32_e64 v45, -v29, v45
    v_sub_f32_e64 v46, -v30, v46
    v_sub_f32_e64 v47, -v31, v47
    s_add_u32 m0, s21, 4096
    v_mfma_f32_32x32x16_bf16 v[16:31], v[72:75], v[176:179], 0
    s_cbranch_vccnz WL_3_2
    v_mad_u32_u16 v238, v238, s3, v246 op_sel:[1,0,0,0]
    v_mad_u32_u16 v239, v239, s3, v246 op_sel:[1,0,0,0]
    buffer_load_dwordx4 v238, s[4:7], s40 offen  lds
    buffer_load_dwordx4 v239, s[8:11], s40 offen offset:1024  lds
WR_3_2:
    ds_read_b64_tr_b16 v[176:177], v244 offset:6144
    ds_read_b64_tr_b16 v[184:185], v245 offset:6144
    v_mul_f32 v255, v0, v152
    v_fmac_f32 v255, v1, v153
    v_fmac_f32 v255, v2, v154
    v_fmac_f32 v255, v3, v155
    v_fmac_f32 v255, v4, v156
    v_fmac_f32 v255, v5, v157
    v_fmac_f32 v255, v6, v158
    v_fmac_f32 v255, v7, v159
    v_fmac_f32 v201, v8, v168
    v_fmac_f32 v201, v9, v169
    v_permlane32_swap_b32 v197, v255
    s_waitcnt lgkmcnt(0)
    v_mfma_f32_32x32x8_bf16 v[16:31], v[80:81], v[176:177], v[16:31]
    v_fmac_f32 v201, v10, v170
    v_fmac_f32 v201, v11, v171
    v_fmac_f32 v201, v12, v172
    v_fmac_f32 v201, v13, v173
    v_fmac_f32 v201, v14, v174
    v_fmac_f32 v201, v15, v175
    s_add_u32 m0, s21, 6144
    v_mfma_f32_32x32x8_bf16 v[56:71], v[84:85], v[176:177], v[56:71]
    s_cbranch_vccnz WL_3_3
    v_mad_u32_u16 v240, v240, s3, v246 op_sel:[1,0,0,0]
    v_mad_u32_u16 v241, v241, s3, v246 op_sel:[1,0,0,0]
    buffer_load_dwordx4 v240, s[4:7], s41 offen  lds
    buffer_load_dwordx4 v241, s[8:11], s41 offen offset:1024  lds
WR_3_3:
    v_add_f32 v255, v197, v255
    v_cvt_pk_bf16_f32 v194, v254, v255
    v_mfma_f32_32x32x16_bf16 v[0:15], v[72:75], v[180:183], 0
    v_mul_f32 v254, v16, v144
    v_fmac_f32 v254, v17, v145
    v_fmac_f32 v254, v18, v146
    v_fmac_f32 v254, v19, v147
    v_fmac_f32 v254, v20, v148
    v_fmac_f32 v254, v21, v149
    v_mfma_f32_32x32x16_bf16 v[32:47], v[76:79], v[180:183], v[32:47]
    s_waitcnt vmcnt(6)
    ds_read_b64_tr_b16 v[176:177], v244 offset:0
    ds_read_b64_tr_b16 v[178:179], v244 offset:1024
    ds_read_b64_tr_b16 v[180:181], v245 offset:0
    ds_read_b64_tr_b16 v[182:183], v245 offset:1024
    v_fmac_f32 v254, v22, v150
    v_fmac_f32 v254, v23, v151
    v_mfma_f32_32x32x8_bf16 v[0:15], v[80:81], v[184:185], v[0:15]
    v_fma_f32 v202, v24, -v160, v202
    v_fma_f32 v202, v25, -v161, v202
    v_permlane32_swap_b32 v254, v200
    v_fma_f32 v202, v26, -v162, v202
    v_fma_f32 v202, v27, -v163, v202
    v_fma_f32 v202, v28, -v164, v202
    v_mfma_f32_32x32x8_bf16 v[32:47], v[84:85], v[184:185], v[32:47]
    v_add_u32 v249, s48, v249
    v_add_u32 v250, s49, v250
    ds_read_b32 v252, v251 offset:16
    ds_read_b64_tr_b16 v[72:73], v249 offset:0
    ds_read_b64_tr_b16 v[76:77], v249 offset:64
    ds_read_b64_tr_b16 v[74:75], v249 offset:256
    ds_read_b64_tr_b16 v[78:79], v249 offset:320
    s_mov_b64 exec, s[54:55]
    ds_read_u16_d16_hi v242, v250 offset:0
    s_mov_b64 exec, -1
    v_fma_f32 v202, v29, -v165, v202
    v_fma_f32 v202, v30, -v166, v202
    v_fma_f32 v202, v31, -v167, v202
    v_add_f32 v200, v254, v200
    v_mul_f32_e64 v198, v64, -v112
    v_permlane32_swap_b32 v202, v254
    v_fma_f32 v198, v65, -v113, v198
    v_fma_f32 v198, v66, -v114, v198
    v_fma_f32 v198, v67, -v115, v198
    v_fma_f32 v198, v68, -v116, v198
    v_fma_f32 v198, v69, -v117, v198
    v_fma_f32 v198, v70, -v118, v198
    v_fma_f32 v198, v71, -v119, v198
    v_add_f32 v254, v202, v254
    v_mul_f32 v196, v56, v160
    v_fmac_f32 v196, v57, v161
    v_fmac_f32 v196, v58, v162
    v_fmac_f32 v196, v59, v163
    v_fmac_f32 v196, v60, v164
    v_fmac_f32 v196, v61, v165
    v_fmac_f32 v196, v62, v166
    v_fmac_f32 v196, v63, v167
    s_nop 1
    v_permlane32_swap_b32 v198, v196
    v_add_f32 v196, v198, v196
    s_cbranch_vccnz LEPI_0
    v_mul_f32 v255, v0, v152
    v_fmac_f32 v255, v1, v153
    v_fmac_f32 v255, v2, v154
    v_fmac_f32 v255, v3, v155
    v_fmac_f32 v255, v4, v156
    v_fmac_f32 v255, v5, v157
    v_fmac_f32 v255, v6, v158
    v_fmac_f32 v255, v7, v159
    v_fma_f32 v203, v8, -v168, v203
    v_fma_f32 v203, v9, -v169, v203
    v_permlane32_swap_b32 v255, v201
    v_fma_f32 v203, v10, -v170, v203
    v_fma_f32 v203, v11, -v171, v203
    v_fma_f32 v203, v12, -v172, v203
    v_fma_f32 v203, v13, -v173, v203
    v_fma_f32 v203, v14, -v174, v203
    v_fma_f32 v203, v15, -v175, v203
    v_add_f32 v201, v255, v201
    v_mul_f32_e64 v199, v40, -v120
    v_permlane32_swap_b32 v203, v255
    v_fma_f32 v199, v41, -v121, v199
    v_fma_f32 v199, v42, -v122, v199
    v_fma_f32 v199, v43, -v123, v199
    v_fma_f32 v199, v44, -v124, v199
    v_fma_f32 v199, v45, -v125, v199
    v_fma_f32 v199, v46, -v126, v199
    v_fma_f32 v199, v47, -v127, v199
    v_add_f32 v255, v203, v255
    v_mul_f32 v197, v32, v168
    v_fmac_f32 v197, v33, v169
    v_fmac_f32 v197, v34, v170
    v_fmac_f32 v197, v35, v171
    v_fmac_f32 v197, v36, v172
    v_fmac_f32 v197, v37, v173
    v_fmac_f32 v197, v38, v174
    v_fmac_f32 v197, v39, v175
    s_nop 1
    v_permlane32_swap_b32 v199, v197
    v_add_f32 v197, v199, v197
    v_cvt_pk_bf16_f32 v200, v200, v201
    v_cvt_pk_bf16_f32 v254, v254, v255
    v_cvt_pk_bf16_f32 v196, v196, v197
    ds_write2st64_b32 v253, v192, v193 offset0:0 offset1:1
    ds_write2st64_b32 v253, v194, v200 offset0:2 offset1:3
    ds_write_b32 v253, v196 offset:1024
    s_mov_b64 exec, 0xffffffff
    ds_write_b32 v253, v254 offset:1280
    s_mov_b64 exec, -1
    s_add_u32 s50, s50, 1
    s_cmp_ge_u32 s50, 4
    s_cbranch_scc1 LAST1
    s_waitcnt lgkmcnt(9)
    v_readfirstlane_b32 s66, v252
    s_add_u32 s53, s53, 1
    v_mov_b32 v252, s53
    s_cmp_le_u32 s53, s66
    ds_write2_b32 v251, v252, v252 offset0:0 offset1:8
    s_setprio 1
    s_cbranch_scc1 PRIO_13
    s_setprio 0
PRIO_13:
    s_cmp_eq_u32 s52, 4
    s_cbranch_scc1 ITEM_1_4
    s_cmp_eq_u32 s52, 5
    s_cbranch_scc1 ITEM_1_5
    s_cmp_eq_u32 s52, 3
    s_cbranch_scc1 ITEM_1_3
    s_cmp_eq_u32 s52, 6
    s_cbranch_scc1 ITEM_1_6
    s_cmp_eq_u32 s52, 8
    s_cbranch_scc1 ITEM_1_8
    s_branch ITEM_1_2
WL_3_0:
    s_add_u32 s66, s51, 0
    buffer_load_dwordx4 v[96:99], v246, s[16:19], s66 offen offset:2048 sc1
    buffer_load_dwordx4 v[100:103], v246, s[16:19], s66 offen offset:3072 sc1
    s_branch WR_3_0
WL_3_1:
    s_add_u32 s66, s51, 4096
    buffer_load_dwordx4 v[104:107], v246, s[16:19], s66 offen offset:2048 sc1
    buffer_load_dwordx4 v[108:111], v246, s[16:19], s66 offen offset:3072 sc1
    s_branch WR_3_1
WL_3_2:
    s_add_u32 s66, s51, 8192
    buffer_load_dwordx4 v[128:131], v246, s[16:19], s66 offen offset:2048 sc1
    buffer_load_dwordx4 v[132:135], v246, s[16:19], s66 offen offset:3072 sc1
    s_branch WR_3_2
WL_3_3:
    s_add_u32 s66, s51, 12288
    buffer_load_dwordx4 v[136:139], v246, s[16:19], s66 offen offset:2048 sc1
    buffer_load_dwordx4 v[140:143], v246, s[16:19], s66 offen offset:3072 sc1
    s_branch WR_3_3
.p2align 6
ITEM_1_6:
    s_mov_b64 exec, s[54:55]
    ds_read_u16_d16_hi v243, v250 offset:128
    s_mov_b64 exec, -1
    ds_read_b64_tr_b16 v[80:81], v249 offset:512
    ds_read_b64_tr_b16 v[84:85], v249 offset:576
    ds_read_b64_tr_b16 v[82:83], v249 offset:768
    ds_read_b64_tr_b16 v[86:87], v249 offset:832
    ds_read_b64_tr_b16 v[88:89], v249 offset:1024
    ds_read_b64_tr_b16 v[92:93], v249 offset:1088
    ds_read_b64_tr_b16 v[90:91], v249 offset:1280
    ds_read_b64_tr_b16 v[94:95], v249 offset:1344
    s_waitcnt lgkmcnt(9)
    v_mul_f32_dpp v196, v242, v72 row_newbcast:0 row_mask:0xf bank_mask:0xf
    v_mul_f32_dpp v197, v242, v73 row_newbcast:1 row_mask:0xf bank_mask:0xf
    v_mul_f32_dpp v198, v242, v72 row_newbcast:8 row_mask:0xf bank_mask:0xf
    v_mul_f32_dpp v199, v242, v73 row_newbcast:9 row_mask:0xf bank_mask:0xf
    v_mul_f32_dpp v200, v242, v76 row_newbcast:2 row_mask:0xf bank_mask:0xf
    v_mul_f32_dpp v201, v242, v77 row_newbcast:3 row_mask:0xf bank_mask:0xf
    v_mul_f32_dpp v202, v242, v76 row_newbcast:10 row_mask:0xf bank_mask:0xf
    v_mul_f32_dpp v203, v242, v77 row_newbcast:11 row_mask:0xf bank_mask:0xf
    v_cvt_pk_bf16_f32 v72, v196, v197
    v_cvt_pk_bf16_f32 v76, v198, v199
    v_cvt_pk_bf16_f32 v73, v200, v201
    v_cvt_pk_bf16_f32 v77, v202, v203
    v_mul_f32_dpp v196, v242, v74 row_newbcast:4 row_mask:0xf bank_mask:0xf
    v_mul_f32_dpp v197, v242, v75 row_newbcast:5 row_mask:0xf bank_mask:0xf
    v_mul_f32_dpp v198, v242, v74 row_newbcast:12 row_mask:0xf bank_mask:0xf
    v_mul_f32_dpp v199, v242, v75 row_newbcast:13 row_mask:0xf bank_mask:0xf
    v_mul_f32_dpp v200, v242, v78 row_newbcast:6 row_mask:0xf bank_mask:0xf
    v_mul_f32_dpp v201, v242, v79 row_newbcast:7 row_mask:0xf bank_mask:0xf
    v_mul_f32_dpp v202, v242, v78 row_newbcast:14 row_mask:0xf bank_mask:0xf
    v_mul_f32_dpp v203, v242, v79 row_newbcast:15 row_mask:0xf bank_mask:0xf
    v_cvt_pk_bf16_f32 v74, v196, v197
    v_cvt_pk_bf16_f32 v78, v198, v199
    v_cvt_pk_bf16_f32 v75, v200, v201
    v_cvt_pk_bf16_f32 v79, v202, v203
    s_mov_b64 exec, s[54:55]
    ds_read_u16_d16_hi v242, v250 offset:256
    s_mov_b64 exec, -1
    s_waitcnt vmcnt(4) lgkmcnt(5)
    v_mfma_f32_32x32x16_bf16 v[56:71], v[72:75], v[176:179], 0
    v_mul_f32_dpp v196, v243, v80 row_newbcast:0 row_mask:0xf bank_mask:0xf
    v_mul_f32_dpp v197, v243, v81 row_newbcast:1 row_mask:0xf bank_mask:0xf
    v_mul_f32_dpp v198, v243, v80 row_newbcast:8 row_mask:0xf bank_mask:0xf
    v_mul_f32_dpp v199, v243, v81 row_newbcast:9 row_mask:0xf bank_mask:0xf
    v_mul_f32_dpp v200, v243, v84 row_newbcast:2 row_mask:0xf bank_mask:0xf
    v_mul_f32_dpp v201, v243, v85 row_newbcast:3 row_mask:0xf bank_mask:0xf
    s_add_u32 m0, s21, 0
    v_mfma_f32_32x32x16_bf16 v[16:31], v[76:79], v[176:179], 0
    buffer_load_dwordx4 v236, s[4:7], s35 offen  lds
    buffer_load_dwordx4 v237, s[8:11], s35 offen offset:1024  lds
    ds_read_b64_tr_b16 v[176:177], v244 offset:2048
    ds_read_b64_tr_b16 v[178:179], v244 offset:3072
    ds_read_b64_tr_b16 v[184:185], v245 offset:2048
    ds_read_b64_tr_b16 v[186:187], v245 offset:3072
    v_mul_f32_dpp v202, v243, v84 row_newbcast:10 row_mask:0xf bank_mask:0xf
    v_mul_f32_dpp v203, v243, v85 row_newbcast:11 row_mask:0xf bank_mask:0xf
    v_cvt_pk_bf16_f32 v80, v196, v197
    v_cvt_pk_bf16_f32 v84, v198, v199
    v_cvt_pk_bf16_f32 v81, v200, v201
    v_cvt_pk_bf16_f32 v85, v202, v203
    v_mul_f32_dpp v196, v243, v82 row_newbcast:4 row_mask:0xf bank_mask:0xf
    v_mul_f32_dpp v197, v243, v83 row_newbcast:5 row_mask:0xf bank_mask:0xf
    v_mul_f32_dpp v198, v243, v82 row_newbcast:12 row_mask:0xf bank_mask:0xf
    v_mul_f32_dpp v199, v243, v83 row_newbcast:13 row_mask:0xf bank_mask:0xf
    v_mul_f32_dpp v200, v243, v86 row_newbcast:6 row_mask:0xf bank_mask:0xf
    v_mul_f32_dpp v201, v243, v87 row_newbcast:7 row_mask:0xf bank_mask:0xf
    v_mul_f32_dpp v202, v243, v86 row_newbcast:14 row_mask:0xf bank_mask:0xf
    v_mul_f32_dpp v203, v243, v87 row_newbcast:15 row_mask:0xf bank_mask:0xf
    v_cvt_pk_bf16_f32 v82, v196, v197
    v_cvt_pk_bf16_f32 v86, v198, v199
    v_cvt_pk_bf16_f32 v83, v200, v201
    v_cvt_pk_bf16_f32 v87, v202, v203
    s_waitcnt vmcnt(4) lgkmcnt(0)
    v_mfma_f32_32x32x16_bf16 v[56:71], v[80:83], v[176:179], v[56:71]
    v_mul_f32_dpp v196, v242, v88 row_newbcast:0 row_mask:0xf bank_mask:0xf
    v_mul_f32_dpp v197, v242, v89 row_newbcast:1 row_mask:0xf bank_mask:0xf
    v_mul_f32_dpp v198, v242, v88 row_newbcast:8 row_mask:0xf bank_mask:0xf
    v_mul_f32_dpp v199, v242, v89 row_newbcast:9 row_mask:0xf bank_mask:0xf
    v_mul_f32_dpp v200, v242, v92 row_newbcast:2 row_mask:0xf bank_mask:0xf
    v_mul_f32_dpp v201, v242, v93 row_newbcast:3 row_mask:0xf bank_mask:0xf
    s_add_u32 m0, s21, 2048
    v_mfma_f32_32x32x16_bf16 v[16:31], v[84:87], v[176:179], v[16:31]
    buffer_load_dwordx4 v238, s[4:7], s35 offen  lds
    buffer_load_dwordx4 v239, s[8:11], s35 offen offset:1024  lds
    ds_read_b64_tr_b16 v[176:177], v244 offset:4096
    ds_read_b64_tr_b16 v[178:179], v244 offset:5120
    ds_read_b64_tr_b16 v[188:189], v245 offset:4096
    ds_read_b64_tr_b16 v[190:191], v245 offset:5120
    v_mul_f32_dpp v202, v242, v92 row_newbcast:10 row_mask:0xf bank_mask:0xf
    v_mul_f32_dpp v203, v242, v93 row_newbcast:11 row_mask:0xf bank_mask:0xf
    v_cvt_pk_bf16_f32 v88, v196, v197
    v_cvt_pk_bf16_f32 v92, v198, v199
    v_cvt_pk_bf16_f32 v89, v200, v201
    v_cvt_pk_bf16_f32 v93, v202, v203
    v_mul_f32_dpp v196, v242, v90 row_newbcast:4 row_mask:0xf bank_mask:0xf
    v_mul_f32_dpp v197, v242, v91 row_newbcast:5 row_mask:0xf bank_mask:0xf
    v_mul_f32_dpp v198, v242, v90 row_newbcast:12 row_mask:0xf bank_mask:0xf
    v_mul_f32_dpp v199, v242, v91 row_newbcast:13 row_mask:0xf bank_mask:0xf
    v_mul_f32_dpp v200, v242, v94 row_newbcast:6 row_mask:0xf bank_mask:0xf
    v_mul_f32_dpp v201, v242, v95 row_newbcast:7 row_mask:0xf bank_mask:0xf
    v_mul_f32_dpp v202, v242, v94 row_newbcast:14 row_mask:0xf bank_mask:0xf
    v_mul_f32_dpp v203, v242, v95 row_newbcast:15 row_mask:0xf bank_mask:0xf
    v_cvt_pk_bf16_f32 v90, v196, v197
    v_cvt_pk_bf16_f32 v94, v198, v199
    v_cvt_pk_bf16_f32 v91, v200, v201
    v_cvt_pk_bf16_f32 v95, v202, v203
    s_waitcnt lgkmcnt(0)
    v_mfma_f32_32x32x16_bf16 v[56:71], v[88:91], v[176:179], v[56:71]
    s_add_u32 m0, s21, 4096
    v_mfma_f32_32x32x16_bf16 v[16:31], v[92:95], v[176:179], v[16:31]
    buffer_load_dwordx4 v234, s[4:7], s36 offen  lds
    buffer_load_dwordx4 v235, s[8:11], s36 offen offset:1024  lds
    s_mov_b32 m0, s50
    s_nop 0
    s_movrels_b32 s71, s23
    s_movrels_b32 s33, s28
    v_add_u32 v253, s33, v248
    s_bfe_u32 s46, s71, 0x30012
    s_mov_b32 m0, s46
    s_and_b32 s66, s71, 0x3ffff
    s_movrels_b32 s68, s57
    s_movrels_b32 s69, s61
    s_sub_u32 s48, s66, s47
    s_mov_b32 s47, s66
    s_lshr_b32 s52, s71, 28
    s_lshl_b32 s67, s46, 9
    s_add_u32 s66, s66, s67
    s_sub_u32 s49, s66, s42
    s_mov_b32 s42, s66
    s_bfe_u32 s66, s68, 655360
    s_add_u32 s43, s42, s66
    s_bfe_u32 s39, s69, 655360
    s_bfe_u32 s66, s68, 655370
    s_add_u32 s44, s42, s66
    s_bfe_u32 s40, s69, 655370
    s_bfe_u32 s66, s68, 655380
    s_add_u32 s45, s42, s66
    s_bfe_u32 s41, s69, 655380
    v_add_u32 v252, s45, v247
    ds_read2_b32 v[240:241], v252 offset0:0 offset1:16
    v_mfma_f32_32x32x16_bf16 v[32:47], v[72:75], v[180:183], 0
    v_mul_f32 v196, v56, v96
    v_fmac_f32 v196, v57, v97
    v_fmac_f32 v196, v58, v98
    v_fmac_f32 v196, v59, v99
    v_fmac_f32 v196, v60, v100
    v_fmac_f32 v196, v61, v101
    v_mfma_f32_32x32x16_bf16 v[0:15], v[76:79], v[180:183], 0
    v_fmac_f32 v196, v62, v102
    v_fmac_f32 v196, v63, v103
    v_mul_f32 v198, v64, v128
    v_fmac_f32 v198, v65, v129
    v_fmac_f32 v198, v66, v130
    v_fmac_f32 v198, v67, v131
    v_mfma_f32_32x32x16_bf16 v[32:47], v[80:83], v[184:187], v[32:47]
    v_fmac_f32 v198, v68, v132
    v_fmac_f32 v198, v69, v133
    v_fmac_f32 v198, v70, v134
    v_fmac_f32 v198, v71, v135
    v_mul_f32 v200, v16, v128
    v_fmac_f32 v200, v17, v129
    v_mfma_f32_32x32x16_bf16 v[0:15], v[84:87], v[184:187], v[0:15]
    s_waitcnt vmcnt(6)
    ds_read_b64_tr_b16 v[176:177], v244 offset:6144
    ds_read_b64_tr_b16 v[178:179], v244 offset:7168
    ds_read_b64_tr_b16 v[180:181], v245 offset:6144
    ds_read_b64_tr_b16 v[182:183], v245 offset:7168
    v_permlane32_swap_b32 v196, v198
    v_fmac_f32 v200, v18, v130
    v_mfma_f32_32x32x16_bf16 v[32:47], v[88:91], v[188:191], v[32:47]
    v_fmac_f32 v200, v19, v131
    v_fmac_f32 v200, v20, v132
    v_fmac_f32 v200, v21, v133
    v_fmac_f32 v200, v22, v134
    v_fmac_f32 v200, v23, v135
    v_add_f32 v198, v196, v198
    v_mfma_f32_32x32x16_bf16 v[0:15], v[92:95], v[188:191], v[0:15]
    v_mul_f32_e64 v202, v24, -v128
    v_fma_f32 v202, v25, -v129, v202
    v_fma_f32 v202, v26, -v130, v202
    v_fma_f32 v202, v27, -v131, v202
    v_fma_f32 v202, v28, -v132, v202
    v_fma_f32 v202, v29, -v133, v202
    v_fma_f32 v202, v30, -v134, v202
    v_fma_f32 v202, v31, -v135, v202
    s_nop 1
    v_permlane32_swap_b32 v200, v202
    v_add_f32 v202, v200, v202
    s_waitcnt vmcnt(4) lgkmcnt(0)
    v_mfma_f32_32x32x16_bf16 v[56:71], v[72:75], v[176:179], 0
    v_mul_f32 v197, v32, v104
    v_fmac_f32 v197, v33, v105
    v_fmac_f32 v197, v34, v106
    v_fmac_f32 v197, v35, v107
    v_fmac_f32 v197, v36, v108
    v_fmac_f32 v197, v37, v109
    s_add_u32 m0, s21, 6144
    v_mfma_f32_32x32x16_bf16 v[16:31], v[76:79], v[176:179], 0
    buffer_load_dwordx4 v236, s[4:7], s36 offen  lds
    buffer_load_dwordx4 v237, s[8:11], s36 offen offset:1024  lds
    ds_read_b64_tr_b16 v[176:177], v244 offset:0
    ds_read_b64_tr_b16 v[178:179], v244 offset:1024
    ds_read_b64_tr_b16 v[184:185], v245 offset:0
    ds_read_b64_tr_b16 v[186:187], v245 offset:1024
    v_fmac_f32 v197, v38, v110
    v_fmac_f32 v197, v39, v111
    v_mul_f32 v199, v40, v136
    v_fmac_f32 v199, v41, v137
    v_fmac_f32 v199, v42, v138
    v_fmac_f32 v199, v43, v139
    v_fmac_f32 v199, v44, v140
    v_fmac_f32 v199, v45, v141
    v_fmac_f32 v199, v46, v142
    v_fmac_f32 v199, v47, v143
    v_mul_f32 v201, v0, v136
    v_fmac_f32 v201, v1, v137
    v_permlane32_swap_b32 v197, v199
    v_fmac_f32 v201, v2, v138
    v_fmac_f32 v201, v3, v139
    v_fmac_f32 v201, v4, v140
    v_fmac_f32 v201, v5, v141
    v_fmac_f32 v201, v6, v142
    s_waitcnt vmcnt(4) lgkmcnt(0)
    v_mfma_f32_32x32x16_bf16 v[56:71], v[80:83], v[176:179], v[56:71]
    v_fmac_f32 v201, v7, v143
    v_add_f32 v199, v197, v199
    v_mul_f32_e64 v203, v8, -v136
    v_fma_f32 v203, v9, -v137, v203
    v_fma_f32 v203, v10, -v138, v203
    v_fma_f32 v203, v11, -v139, v203
    s_add_u32 m0, s21, 0
    v_mfma_f32_32x32x16_bf16 v[16:31], v[84:87], v[176:179], v[16:31]
    buffer_load_dwordx4 v238, s[4:7], s36 offen  lds
    buffer_load_dwordx4 v239, s[8:11], s36 offen offset:1024  lds
    ds_read_b64_tr_b16 v[176:177], v244 offset:2048
    ds_read_b64_tr_b16 v[178:179], v244 offset:3072
    ds_read_b64_tr_b16 v[188:189], v245 offset:2048
    ds_read_b64_tr_b16 v[190:191], v245 offset:3072
    s_waitcnt lgkmcnt(0)
    v_mfma_f32_32x32x16_bf16 v[56:71], v[88:91], v[176:179], v[56:71]
    v_fma_f32 v203, v12, -v140, v203
    v_fma_f32 v203, v13, -v141, v203
    v_fma_f32 v203, v14, -v142, v203
    v_fma_f32 v203, v15, -v143, v203
    s_nop 1
    v_permlane32_swap_b32 v201, v203
    v_add_f32 v203, v201, v203
    s_add_u32 m0, s21, 2048
    v_mfma_f32_32x32x16_bf16 v[16:31], v[92:95], v[176:179], v[16:31]
    buffer_load_dwordx4 v234, s[4:7], s37 offen  lds
    buffer_load_dwordx4 v235, s[8:11], s37 offen offset:1024  lds
    v_add_u32 v252, s42, v247
    ds_read2_b32 v[234:235], v252 offset0:0 offset1:16
    v_cvt_pk_bf16_f32 v192, v198, v199
    v_cvt_pk_bf16_f32 v193, v202, v203
    v_mfma_f32_32x32x16_bf16 v[32:47], v[72:75], v[180:183], 0
    v_mul_f32 v196, v56, v144
    v_fmac_f32 v196, v57, v145
    v_fmac_f32 v196, v58, v146
    v_fmac_f32 v196, v59, v147
    v_fmac_f32 v196, v60, v148
    v_fmac_f32 v196, v61, v149
    v_mfma_f32_32x32x16_bf16 v[0:15], v[76:79], v[180:183], 0
    v_fmac_f32 v196, v62, v150
    v_fmac_f32 v196, v63, v151
    v_mul_f32_e64 v200, v16, -v160
    v_fma_f32 v200, v17, -v161, v200
    v_fma_f32 v200, v18, -v162, v200
    v_fma_f32 v200, v19, -v163, v200
    v_mfma_f32_32x32x16_bf16 v[32:47], v[80:83], v[184:187], v[32:47]
    v_fma_f32 v200, v20, -v164, v200
    v_fma_f32 v200, v21, -v165, v200
    v_fma_f32 v200, v22, -v166, v200
    v_fma_f32 v200, v23, -v167, v200
    v_mul_f32_e64 v202, v24, -v160
    v_fma_f32 v202, v25, -v161, v202
    v_mfma_f32_32x32x16_bf16 v[0:15], v[84:87], v[184:187], v[0:15]
    s_waitcnt vmcnt(6)
    ds_read_b64_tr_b16 v[176:177], v244 offset:4096
    ds_read_b64_tr_b16 v[178:179], v244 offset:5120
    ds_read_b64_tr_b16 v[180:181], v245 offset:4096
    ds_read_b64_tr_b16 v[182:183], v245 offset:5120
    v_fma_f32 v202, v26, -v162, v202
    v_fma_f32 v202, v27, -v163, v202
    v_mfma_f32_32x32x16_bf16 v[32:47], v[88:91], v[188:191], v[32:47]
    v_fma_f32 v202, v28, -v164, v202
    v_fma_f32 v202, v29, -v165, v202
    v_fma_f32 v202, v30, -v166, v202
    v_fma_f32 v202, v31, -v167, v202
    v_mfma_f32_32x32x16_bf16 v[0:15], v[92:95], v[188:191], v[0:15]
    s_waitcnt vmcnt(4) lgkmcnt(0)
    v_mfma_f32_32x32x16_bf16 v[16:31], v[72:75], v[176:179], 0
    s_nop 4
    v_mul_f32 v197, v32, v152
    v_fmac_f32 v197, v33, v153
    v_fmac_f32 v197, v34, v154
    v_fmac_f32 v197, v35, v155
    v_fmac_f32 v197, v36, v156
    v_fmac_f32 v197, v37, v157
    s_add_u32 m0, s21, 4096
    v_mfma_f32_32x32x16_bf16 v[48:63], v[76:79], v[176:179], 0
    buffer_load_dwordx4 v236, s[4:7], s37 offen  lds
    buffer_load_dwordx4 v237, s[8:11], s37 offen offset:1024  lds
    ds_read_b64_tr_b16 v[176:177], v244 offset:6144
    ds_read_b64_tr_b16 v[178:179], v244 offset:7168
    ds_read_b64_tr_b16 v[184:185], v245 offset:6144
    ds_read_b64_tr_b16 v[186:187], v245 offset:7168
    v_add_u32 v252, s43, v247
    ds_read2_b32 v[236:237], v252 offset0:0 offset1:16
    v_fmac_f32 v197, v38, v158
    v_fmac_f32 v197, v39, v159
    v_mul_f32_e64 v201, v0, -v168
    v_fma_f32 v201, v1, -v169, v201
    s_waitcnt vmcnt(4) lgkmcnt(1)
    v_mfma_f32_32x32x16_bf16 v[16:31], v[80:83], v[176:179], v[16:31]
    v_fma_f32 v201, v2, -v170, v201
    v_fma_f32 v201, v3, -v171, v201
    v_fma_f32 v201, v4, -v172, v201
    v_fma_f32 v201, v5, -v173, v201
    v_fma_f32 v201, v6, -v174, v201
    v_fma_f32 v201, v7, -v175, v201
    s_add_u32 m0, s21, 6144
    v_mfma_f32_32x32x16_bf16 v[48:63], v[84:87], v[176:179], v[48:63]
    buffer_load_dwordx4 v238, s[4:7], s37 offen  lds
    buffer_load_dwordx4 v239, s[8:11], s37 offen offset:1024  lds
    ds_read_b64_tr_b16 v[176:177], v244 offset:0
    ds_read_b64_tr_b16 v[178:179], v244 offset:1024
    ds_read_b64_tr_b16 v[188:189], v245 offset:0
    ds_read_b64_tr_b16 v[190:191], v245 offset:1024
    v_add_u32 v252, s44, v247
    ds_read2_b32 v[238:239], v252 offset0:0 offset1:16
    s_waitcnt lgkmcnt(1)
    v_mfma_f32_32x32x16_bf16 v[16:31], v[88:91], v[176:179], v[16:31]
    v_mul_f32_e64 v203, v8, -v168
    v_fma_f32 v203, v9, -v169, v203
    v_fma_f32 v203, v10, -v170, v203
    v_fma_f32 v203, v11, -v171, v203
    v_fma_f32 v203, v12, -v172, v203
    v_fma_f32 v203, v13, -v173, v203
    s_add_u32 m0, s21, 0
    v_mfma_f32_32x32x16_bf16 v[48:63], v[92:95], v[176:179], v[48:63]
    s_cbranch_vccnz WL_6_0
    v_mad_u32_u16 v234, v234, s3, v246 op_sel:[1,0,0,0]
    v_mad_u32_u16 v235, v235, s3, v246 op_sel:[1,0,0,0]
    buffer_load_dwordx4 v234, s[4:7], s38 offen  lds
    buffer_load_dwordx4 v235, s[8:11], s38 offen offset:1024  lds
WR_6_0:
    v_fma_f32 v203, v14, -v174, v203
    v_fma_f32 v203, v15, -v175, v203
    v_mfma_f32_32x32x16_bf16 v[0:15], v[72:75], v[180:183], 0
    v_fmac_f32 v200, v24, v160
    v_fmac_f32 v200, v25, v161
    v_fmac_f32 v200, v26, v162
    v_fmac_f32 v200, v27, v163
    v_fmac_f32 v200, v28, v164
    v_fmac_f32 v200, v29, v165
    v_fmac_f32 v200, v30, v166
    v_fmac_f32 v200, v31, v167
    v_mfma_f32_32x32x16_bf16 v[24:39], v[76:79], v[180:183], 0
    v_mul_f32 v254, v16, v144
    v_fmac_f32 v254, v17, v145
    v_fmac_f32 v254, v18, v146
    v_fmac_f32 v254, v19, v147
    v_fmac_f32 v254, v20, v148
    v_fmac_f32 v254, v21, v149
    v_mfma_f32_32x32x16_bf16 v[0:15], v[80:83], v[184:187], v[0:15]
    v_fmac_f32 v254, v22, v150
    v_fmac_f32 v254, v23, v151
    v_sub_f32_e64 v64, -v48, v64
    v_sub_f32_e64 v65, -v49, v65
    v_permlane32_swap_b32 v196, v254
    v_sub_f32_e64 v66, -v50, v66
    v_mfma_f32_32x32x16_bf16 v[24:39], v[84:87], v[184:187], v[24:39]
    s_waitcnt vmcnt(6)
    ds_read_b64_tr_b16 v[176:177], v244 offset:2048
    ds_read_b64_tr_b16 v[178:179], v244 offset:3072
    ds_read_b64_tr_b16 v[180:181], v245 offset:2048
    ds_read_b64_tr_b16 v[182:183], v245 offset:3072
    v_sub_f32_e64 v67, -v51, v67
    v_sub_f32_e64 v68, -v52, v68
    v_mfma_f32_32x32x16_bf16 v[24:39], v[92:95], v[188:191], v[24:39]
    v_sub_f32_e64 v69, -v53, v69
    v_sub_f32_e64 v70, -v54, v70
    v_sub_f32_e64 v71, -v55, v71
    v_add_f32 v254, v196, v254
    v_mfma_f32_32x32x16_bf16 v[0:15], v[88:91], v[188:191], v[0:15]
    s_waitcnt vmcnt(4) lgkmcnt(0)
    v_mfma_f32_32x32x16_bf16 v[56:71], v[76:79], v[176:179], v[56:71]
    s_nop 4
    v_sub_f32_e64 v40, -v24, v40
    v_sub_f32_e64 v41, -v25, v41
    v_sub_f32_e64 v42, -v26, v42
    v_sub_f32_e64 v43, -v27, v43
    v_sub_f32_e64 v44, -v28, v44
    v_sub_f32_e64 v45, -v29, v45
    v_sub_f32_e64 v46, -v30, v46
    v_sub_f32_e64 v47, -v31, v47
    s_add_u32 m0, s21, 2048
    v_mfma_f32_32x32x16_bf16 v[16:31], v[72:75], v[176:179], 0
    s_cbranch_vccnz WL_6_1
    v_mad_u32_u16 v236, v236, s3, v246 op_sel:[1,0,0,0]
    v_mad_u32_u16 v237, v237, s3, v246 op_sel:[1,0,0,0]
    buffer_load_dwordx4 v236, s[4:7], s39 offen  lds
    buffer_load_dwordx4 v237, s[8:11], s39 offen offset:1024  lds
WR_6_1:
    ds_read_b64_tr_b16 v[176:177], v244 offset:4096
    ds_read_b64_tr_b16 v[178:179], v244 offset:5120
    ds_read_b64_tr_b16 v[184:185], v245 offset:4096
    ds_read_b64_tr_b16 v[186:187], v245 offset:5120
    v_mul_f32 v255, v0, v152
    v_fmac_f32 v255, v1, v153
    v_fmac_f32 v255, v2, v154
    v_fmac_f32 v255, v3, v155
    v_fmac_f32 v255, v4, v156
    s_waitcnt vmcnt(4) lgkmcnt(0)
    v_mfma_f32_32x32x16_bf16 v[16:31], v[80:83], v[176:179], v[16:31]
    v_fmac_f32 v255, v5, v157
    v_fmac_f32 v255, v6, v158
    v_fmac_f32 v255, v7, v159
    v_fmac_f32 v201, v8, v168
    v_fmac_f32 v201, v9, v169
    v_permlane32_swap_b32 v197, v255
    s_add_u32 m0, s21, 4096
    v_mfma_f32_32x32x16_bf16 v[56:71], v[84:87], v[176:179], v[56:71]
    s_cbranch_vccnz WL_6_2
    v_mad_u32_u16 v238, v238, s3, v246 op_sel:[1,0,0,0]
    v_mad_u32_u16 v239, v239, s3, v246 op_sel:[1,0,0,0]
    buffer_load_dwordx4 v238, s[4:7], s40 offen  lds
    buffer_load_dwordx4 v239, s[8:11], s40 offen offset:1024  lds
WR_6_2:
    ds_read_b64_tr_b16 v[176:177], v244 offset:6144
    ds_read_b64_tr_b16 v[178:179], v244 offset:7168
    ds_read_b64_tr_b16 v[188:189], v245 offset:6144
    ds_read_b64_tr_b16 v[190:191], v245 offset:7168
    s_waitcnt lgkmcnt(0)
    v_mfma_f32_32x32x16_bf16 v[16:31], v[88:91], v[176:179], v[16:31]
    v_fmac_f32 v201, v10, v170
    v_fmac_f32 v201, v11, v171
    v_fmac_f32 v201, v12, v172
    v_fmac_f32 v201, v13, v173
    v_fmac_f32 v201, v14, v174
    v_fmac_f32 v201, v15, v175
    s_add_u32 m0, s21, 6144
    v_mfma_f32_32x32x16_bf16 v[56:71], v[92:95], v[176:179], v[56:71]
    s_cbranch_vccnz WL_6_3
    v_mad_u32_u16 v240, v240, s3, v246 op_sel:[1,0,0,0]
    v_mad_u32_u16 v241, v241, s3, v246 op_sel:[1,0,0,0]
    buffer_load_dwordx4 v240, s[4:7], s41 offen  lds
    buffer_load_dwordx4 v241, s[8:11], s41 offen offset:1024  lds
WR_6_3:
    v_add_f32 v255, v197, v255
    v_cvt_pk_bf16_f32 v194, v254, v255
    v_mfma_f32_32x32x16_bf16 v[0:15], v[72:75], v[180:183], 0
    v_mul_f32 v254, v16, v144
    v_fmac_f32 v254, v17, v145
    v_fmac_f32 v254, v18, v146
    v_fmac_f32 v254, v19, v147
    v_fmac_f32 v254, v20, v148
    v_fmac_f32 v254, v21, v149
    v_mfma_f32_32x32x16_bf16 v[32:47], v[76:79], v[180:183], v[32:47]
    v_fmac_f32 v254, v22, v150
    v_fmac_f32 v254, v23, v151
    v_fma_f32 v202, v24, -v160, v202
    v_fma_f32 v202, v25, -v161, v202
    v_permlane32_swap_b32 v254, v200
    v_fma_f32 v202, v26, -v162, v202
    v_mfma_f32_32x32x16_bf16 v[0:15], v[80:83], v[184:187], v[0:15]
    v_fma_f32 v202, v27, -v163, v202
    v_fma_f32 v202, v28, -v164, v202
    v_fma_f32 v202, v29, -v165, v202
    v_fma_f32 v202, v30, -v166, v202
    v_fma_f32 v202, v31, -v167, v202
    v_add_f32 v200, v254, v200
    v_mfma_f32_32x32x16_bf16 v[32:47], v[84:87], v[184:187], v[32:47]
    s_waitcnt vmcnt(6)
    ds_read_b64_tr_b16 v[176:177], v244 offset:0
    ds_read_b64_tr_b16 v[178:179], v244 offset:1024
    ds_read_b64_tr_b16 v[180:181], v245 offset:0
    ds_read_b64_tr_b16 v[182:183], v245 offset:1024
    v_mul_f32_e64 v198, v64, -v112
    v_permlane32_swap_b32 v202, v254
    v_mfma_f32_32x32x16_bf16 v[0:15], v[88:91], v[188:191], v[0:15]
    v_fma_f32 v198, v65, -v113, v198
    v_fma_f32 v198, v66, -v114, v198
    v_fma_f32 v198, v67, -v115, v198
    v_fma_f32 v198, v68, -v116, v198
    v_fma_f32 v198, v69, -v117, v198
    v_fma_f32 v198, v70, -v118, v198
    v_mfma_f32_32x32x16_bf16 v[32:47], v[92:95], v[188:191], v[32:47]
    v_add_u32 v249, s48, v249
    v_add_u32 v250, s49, v250
    ds_read_b32 v252, v251 offset:16
    ds_read_b64_tr_b16 v[72:73], v249 offset:0
    ds_read_b64_tr_b16 v[76:77], v249 offset:64
    ds_read_b64_tr_b16 v[74:75], v249 offset:256
    ds_read_b64_tr_b16 v[78:79], v249 offset:320
    s_mov_b64 exec, s[54:55]
    ds_read_u16_d16_hi v242, v250 offset:0
    s_mov_b64 exec, -1
    v_fma_f32 v198, v71, -v119, v198
    v_add_f32 v254, v202, v254
    v_mul_f32 v196, v56, v160
    v_fmac_f32 v196, v57, v161
    v_fmac_f32 v196, v58, v162
    v_fmac_f32 v196, v59, v163
    v_fmac_f32 v196, v60, v164
    v_fmac_f32 v196, v61, v165
    v_fmac_f32 v196, v62, v166
    v_fmac_f32 v196, v63, v167
    s_nop 1
    v_permlane32_swap_b32 v198, v196
    v_add_f32 v196, v198, v196
    s_cbranch_vccnz LEPI_0
    v_mul_f32 v255, v0, v152
    v_fmac_f32 v255, v1, v153
    v_fmac_f32 v255, v2, v154
    v_fmac_f32 v255, v3, v155
    v_fmac_f32 v255, v4, v156
    v_fmac_f32 v255, v5, v157
    v_fmac_f32 v255, v6, v158
    v_fmac_f32 v255, v7, v159
    v_fma_f32 v203, v8, -v168, v203
    v_fma_f32 v203, v9, -v169, v203
    v_permlane32_swap_b32 v255, v201
    v_fma_f32 v203, v10, -v170, v203
    v_fma_f32 v203, v11, -v171, v203
    v_fma_f32 v203, v12, -v172, v203
    v_fma_f32 v203, v13, -v173, v203
    v_fma_f32 v203, v14, -v174, v203
    v_fma_f32 v203, v15, -v175, v203
    v_add_f32 v201, v255, v201
    v_mul_f32_e64 v199, v40, -v120
    v_permlane32_swap_b32 v203, v255
    v_fma_f32 v199, v41, -v121, v199
    v_fma_f32 v199, v42, -v122, v199
    v_fma_f32 v199, v43, -v123, v199
    v_fma_f32 v199, v44, -v124, v199
    v_fma_f32 v199, v45, -v125, v199
    v_fma_f32 v199, v46, -v126, v199
    v_fma_f32 v199, v47, -v127, v199
    v_add_f32 v255, v203, v255
    v_mul_f32 v197, v32, v168
    v_fmac_f32 v197, v33, v169
    v_fmac_f32 v197, v34, v170
    v_fmac_f32 v197, v35, v171
    v_fmac_f32 v197, v36, v172
    v_fmac_f32 v197, v37, v173
    v_fmac_f32 v197, v38, v174
    v_fmac_f32 v197, v39, v175
    s_nop 1
    v_permlane32_swap_b32 v199, v197
    v_add_f32 v197, v199, v197
    v_cvt_pk_bf16_f32 v200, v200, v201
    v_cvt_pk_bf16_f32 v254, v254, v255
    v_cvt_pk_bf16_f32 v196, v196, v197
    ds_write2st64_b32 v253, v192, v193 offset0:0 offset1:1
    ds_write2st64_b32 v253, v194, v200 offset0:2 offset1:3
    ds_write_b32 v253, v196 offset:1024
    s_mov_b64 exec, 0xffffffff
    ds_write_b32 v253, v254 offset:1280
    s_mov_b64 exec, -1
    s_add_u32 s50, s50, 1
    s_cmp_ge_u32 s50, 4
    s_cbranch_scc1 LAST1
    s_waitcnt lgkmcnt(9)
    v_readfirstlane_b32 s66, v252
    s_add_u32 s53, s53, 1
    v_mov_b32 v252, s53
    s_cmp_le_u32 s53, s66
    ds_write2_b32 v251, v252, v252 offset0:0 offset1:8
    s_setprio 1
    s_cbranch_scc1 PRIO_14
    s_setprio 0
PRIO_14:
    s_cmp_eq_u32 s52, 4
    s_cbranch_scc1 ITEM_1_4
    s_cmp_eq_u32 s52, 5
    s_cbranch_scc1 ITEM_1_5
    s_cmp_eq_u32 s52, 3
    s_cbranch_scc1 ITEM_1_3
    s_cmp_eq_u32 s52, 6
    s_cbranch_scc1 ITEM_1_6
    s_cmp_eq_u32 s52, 8
    s_cbranch_scc1 ITEM_1_8
    s_branch ITEM_1_2
WL_6_0:
    s_add_u32 s66, s51, 0
    buffer_load_dwordx4 v[96:99], v246, s[16:19], s66 offen offset:2048 sc1
    buffer_load_dwordx4 v[100:103], v246, s[16:19], s66 offen offset:3072 sc1
    s_branch WR_6_0
WL_6_1:
    s_add_u32 s66, s51, 4096
    buffer_load_dwordx4 v[104:107], v246, s[16:19], s66 offen offset:2048 sc1
    buffer_load_dwordx4 v[108:111], v246, s[16:19], s66 offen offset:3072 sc1
    s_branch WR_6_1
WL_6_2:
    s_add_u32 s66, s51, 8192
    buffer_load_dwordx4 v[128:131], v246, s[16:19], s66 offen offset:2048 sc1
    buffer_load_dwordx4 v[132:135], v246, s[16:19], s66 offen offset:3072 sc1
    s_branch WR_6_2
WL_6_3:
    s_add_u32 s66, s51, 12288
    buffer_load_dwordx4 v[136:139], v246, s[16:19], s66 offen offset:2048 sc1
    buffer_load_dwordx4 v[140:143], v246, s[16:19], s66 offen offset:3072 sc1
    s_branch WR_6_3
.p2align 6
ITEM_1_8:
    s_mov_b64 exec, s[54:55]
    ds_read_u16_d16_hi v243, v250 offset:128
    s_mov_b64 exec, -1
    ds_read_b64_tr_b16 v[80:81], v249 offset:512
    ds_read_b64_tr_b16 v[84:85], v249 offset:576
    ds_read_b64_tr_b16 v[82:83], v249 offset:768
    ds_read_b64_tr_b16 v[86:87], v249 offset:832
    ds_read_b64_tr_b16 v[88:89], v249 offset:1024
    ds_read_b64_tr_b16 v[92:93], v249 offset:1088
    ds_read_b64_tr_b16 v[90:91], v249 offset:1280
    ds_read_b64_tr_b16 v[94:95], v249 offset:1344
    ds_read_b64_tr_b16 v[64:65], v249 offset:1536
    ds_read_b64_tr_b16 v[68:69], v249 offset:1600
    ds_read_b64_tr_b16 v[66:67], v249 offset:1792
    ds_read_b64_tr_b16 v[70:71], v249 offset:1856
    s_waitcnt lgkmcnt(13)
    v_mul_f32_dpp v196, v242, v72 row_newbcast:0 row_mask:0xf bank_mask:0xf
    v_mul_f32_dpp v197, v242, v73 row_newbcast:1 row_mask:0xf bank_mask:0xf
    v_mul_f32_dpp v198, v242, v72 row_newbcast:8 row_mask:0xf bank_mask:0xf
    v_mul_f32_dpp v199, v242, v73 row_newbcast:9 row_mask:0xf bank_mask:0xf
    v_mul_f32_dpp v200, v242, v76 row_newbcast:2 row_mask:0xf bank_mask:0xf
    v_mul_f32_dpp v201, v242, v77 row_newbcast:3 row_mask:0xf bank_mask:0xf
    v_mul_f32_dpp v202, v242, v76 row_newbcast:10 row_mask:0xf bank_mask:0xf
    v_mul_f32_dpp v203, v242, v77 row_newbcast:11 row_mask:0xf bank_mask:0xf
    v_cvt_pk_bf16_f32 v72, v196, v197
    v_cvt_pk_bf16_f32 v76, v198, v199
    v_cvt_pk_bf16_f32 v73, v200, v201
    v_cvt_pk_bf16_f32 v77, v202, v203
    v_mul_f32_dpp v196, v242, v74 row_newbcast:4 row_mask:0xf bank_mask:0xf
    v_mul_f32_dpp v197, v242, v75 row_newbcast:5 row_mask:0xf bank_mask:0xf
    v_mul_f32_dpp v198, v242, v74 row_newbcast:12 row_mask:0xf bank_mask:0xf
    v_mul_f32_dpp v199, v242, v75 row_newbcast:13 row_mask:0xf bank_mask:0xf
    v_mul_f32_dpp v200, v242, v78 row_newbcast:6 row_mask:0xf bank_mask:0xf
    v_mul_f32_dpp v201, v242, v79 row_newbcast:7 row_mask:0xf bank_mask:0xf
    v_mul_f32_dpp v202, v242, v78 row_newbcast:14 row_mask:0xf bank_mask:0xf
    v_mul_f32_dpp v203, v242, v79 row_newbcast:15 row_mask:0xf bank_mask:0xf
    v_cvt_pk_bf16_f32 v74, v196, v197
    v_cvt_pk_bf16_f32 v78, v198, v199
    v_cvt_pk_bf16_f32 v75, v200, v201
    v_cvt_pk_bf16_f32 v79, v202, v203
    s_mov_b64 exec, s[54:55]
    ds_read_u16_d16_hi v242, v250 offset:256
    s_mov_b64 exec, -1
    s_waitcnt vmcnt(4) lgkmcnt(9)
    v_mfma_f32_32x32x16_bf16 v[0:15], v[72:75], v[176:179], 0
    v_mul_f32_dpp v196, v243, v80 row_newbcast:0 row_mask:0xf bank_mask:0xf
    v_mul_f32_dpp v197, v243, v81 row_newbcast:1 row_mask:0xf bank_mask:0xf
    v_mul_f32_dpp v198, v243, v80 row_newbcast:8 row_mask:0xf bank_mask:0xf
    v_mul_f32_dpp v199, v243, v81 row_newbcast:9 row_mask:0xf bank_mask:0xf
    v_mul_f32_dpp v200, v243, v84 row_newbcast:2 row_mask:0xf bank_mask:0xf
    v_mul_f32_dpp v201, v243, v85 row_newbcast:3 row_mask:0xf bank_mask:0xf
    s_add_u32 m0, s21, 0
    v_mfma_f32_32x32x16_bf16 v[48:63], v[76:79], v[176:179], 0
    buffer_load_dwordx4 v234, s[4:7], s35 offen  lds
    buffer_load_dwordx4 v235, s[8:11], s35 offen offset:1024  lds
    ds_read_b64_tr_b16 v[176:177], v244 offset:2048
    ds_read_b64_tr_b16 v[178:179], v244 offset:3072
    ds_read_b64_tr_b16 v[184:185], v245 offset:2048
    ds_read_b64_tr_b16 v[186:187], v245 offset:3072
    v_mul_f32_dpp v202, v243, v84 row_newbcast:10 row_mask:0xf bank_mask:0xf
    v_mul_f32_dpp v203, v243, v85 row_newbcast:11 row_mask:0xf bank_mask:0xf
    v_cvt_pk_bf16_f32 v80, v196, v197
    v_cvt_pk_bf16_f32 v84, v198, v199
    v_cvt_pk_bf16_f32 v81, v200, v201
    v_cvt_pk_bf16_f32 v85, v202, v203
    v_mul_f32_dpp v196, v243, v82 row_newbcast:4 row_mask:0xf bank_mask:0xf
    v_mul_f32_dpp v197, v243, v83 row_newbcast:5 row_mask:0xf bank_mask:0xf
    v_mul_f32_dpp v198, v243, v82 row_newbcast:12 row_mask:0xf bank_mask:0xf
    v_mul_f32_dpp v199, v243, v83 row_newbcast:13 row_mask:0xf bank_mask:0xf
    v_mul_f32_dpp v200, v243, v86 row_newbcast:6 row_mask:0xf bank_mask:0xf
    v_mul_f32_dpp v201, v243, v87 row_newbcast:7 row_mask:0xf bank_mask:0xf
    v_mul_f32_dpp v202, v243, v86 row_newbcast:14 row_mask:0xf bank_mask:0xf
    v_mul_f32_dpp v203, v243, v87 row_newbcast:15 row_mask:0xf bank_mask:0xf
    v_cvt_pk_bf16_f32 v82, v196, v197
    v_cvt_pk_bf16_f32 v86, v198, v199
    v_cvt_pk_bf16_f32 v83, v200, v201
    v_cvt_pk_bf16_f32 v87, v202, v203
    s_mov_b64 exec, s[54:55]
    ds_read_u16_d16_hi v243, v250 offset:384
    s_mov_b64 exec, -1
    s_waitcnt vmcnt(4) lgkmcnt(1)
    v_mfma_f32_32x32x16_bf16 v[0:15], v[80:83], v[176:179], v[0:15]
    v_mul_f32_dpp v196, v242, v88 row_newbcast:0 row_mask:0xf bank_mask:0xf
    v_mul_f32_dpp v197, v242, v89 row_newbcast:1 row_mask:0xf bank_mask:0xf
    v_mul_f32_dpp v198, v242, v88 row_newbcast:8 row_mask:0xf bank_mask:0xf
    v_mul_f32_dpp v199, v242, v89 row_newbcast:9 row_mask:0xf bank_mask:0xf
    v_mul_f32_dpp v200, v242, v92 row_newbcast:2 row_mask:0xf bank_mask:0xf
    v_mul_f32_dpp v201, v242, v93 row_newbcast:3 row_mask:0xf bank_mask:0xf
    s_add_u32 m0, s21, 2048
    v_mfma_f32_32x32x16_bf16 v[48:63], v[84:87], v[176:179], v[48:63]
    buffer_load_dwordx4 v236, s[4:7], s35 offen  lds
    buffer_load_dwordx4 v237, s[8:11], s35 offen offset:1024  lds
    ds_read_b64_tr_b16 v[176:177], v244 offset:4096
    ds_read_b64_tr_b16 v[178:179], v244 offset:5120
    ds_read_b64_tr_b16 v[188:189], v245 offset:4096
    ds_read_b64_tr_b16 v[190:191], v245 offset:5120
    v_mul_f32_dpp v202, v242, v92 row_newbcast:10 row_mask:0xf bank_mask:0xf
    v_mul_f32_dpp v203, v242, v93 row_newbcast:11 row_mask:0xf bank_mask:0xf
    v_cvt_pk_bf16_f32 v88, v196, v197
    v_cvt_pk_bf16_f32 v92, v198, v199
    v_cvt_pk_bf16_f32 v89, v200, v201
    v_cvt_pk_bf16_f32 v93, v202, v203
    v_mul_f32_dpp v196, v242, v90 row_newbcast:4 row_mask:0xf bank_mask:0xf
    v_mul_f32_dpp v197, v242, v91 row_newbcast:5 row_mask:0xf bank_mask:0xf
    v_mul_f32_dpp v198, v242, v90 row_newbcast:12 row_mask:0xf bank_mask:0xf
    v_mul_f32_dpp v199, v242, v91 row_newbcast:13 row_mask:0xf bank_mask:0xf
    v_mul_f32_dpp v200, v242, v94 row_newbcast:6 row_mask:0xf bank_mask:0xf
    v_mul_f32_dpp v201, v242, v95 row_newbcast:7 row_mask:0xf bank_mask:0xf
    v_mul_f32_dpp v202, v242, v94 row_newbcast:14 row_mask:0xf bank_mask:0xf
    v_mul_f32_dpp v203, v242, v95 row_newbcast:15 row_mask:0xf bank_mask:0xf
    v_cvt_pk_bf16_f32 v90, v196, v197
    v_cvt_pk_bf16_f32 v94, v198, v199
    v_cvt_pk_bf16_f32 v91, v200, v201
    v_cvt_pk_bf16_f32 v95, v202, v203
    s_waitcnt vmcnt(4) lgkmcnt(0)
    v_mfma_f32_32x32x16_bf16 v[0:15], v[88:91], v[176:179], v[0:15]
    v_mul_f32_dpp v196, v243, v64 row_newbcast:0 row_mask:0xf bank_mask:0xf
    v_mul_f32_dpp v197, v243, v65 row_newbcast:1 row_mask:0xf bank_mask:0xf
    v_mul_f32_dpp v198, v243, v64 row_newbcast:8 row_mask:0xf bank_mask:0xf
    v_mul_f32_dpp v199, v243, v65 row_newbcast:9 row_mask:0xf bank_mask:0xf
    v_mul_f32_dpp v200, v243, v68 row_newbcast:2 row_mask:0xf bank_mask:0xf
    v_mul_f32_dpp v201, v243, v69 row_newbcast:3 row_mask:0xf bank_mask:0xf
    s_add_u32 m0, s21, 4096
    v_mfma_f32_32x32x16_bf16 v[48:63], v[92:95], v[176:179], v[48:63]
    buffer_load_dwordx4 v238, s[4:7], s35 offen  lds
    buffer_load_dwordx4 v239, s[8:11], s35 offen offset:1024  lds
    ds_read_b64_tr_b16 v[176:177], v244 offset:6144
    ds_read_b64_tr_b16 v[178:179], v244 offset:7168
    ds_read_b64_tr_b16 v[192:193], v245 offset:6144
    ds_read_b64_tr_b16 v[194:195], v245 offset:7168
    v_mul_f32_dpp v202, v243, v68 row_newbcast:10 row_mask:0xf bank_mask:0xf
    v_mul_f32_dpp v203, v243, v69 row_newbcast:11 row_mask:0xf bank_mask:0xf
    v_cvt_pk_bf16_f32 v64, v196, v197
    v_cvt_pk_bf16_f32 v68, v198, v199
    v_cvt_pk_bf16_f32 v65, v200, v201
    v_cvt_pk_bf16_f32 v69, v202, v203
    v_mul_f32_dpp v196, v243, v66 row_newbcast:4 row_mask:0xf bank_mask:0xf
    v_mul_f32_dpp v197, v243, v67 row_newbcast:5 row_mask:0xf bank_mask:0xf
    v_mul_f32_dpp v198, v243, v66 row_newbcast:12 row_mask:0xf bank_mask:0xf
    v_mul_f32_dpp v199, v243, v67 row_newbcast:13 row_mask:0xf bank_mask:0xf
    v_mul_f32_dpp v200, v243, v70 row_newbcast:6 row_mask:0xf bank_mask:0xf
    v_mul_f32_dpp v201, v243, v71 row_newbcast:7 row_mask:0xf bank_mask:0xf
    v_mul_f32_dpp v202, v243, v70 row_newbcast:14 row_mask:0xf bank_mask:0xf
    v_mul_f32_dpp v203, v243, v71 row_newbcast:15 row_mask:0xf bank_mask:0xf
    v_cvt_pk_bf16_f32 v66, v196, v197
    v_cvt_pk_bf16_f32 v70, v198, v199
    v_cvt_pk_bf16_f32 v67, v200, v201
    v_cvt_pk_bf16_f32 v71, v202, v203
    s_waitcnt lgkmcnt(0)
    v_mfma_f32_32x32x16_bf16 v[0:15], v[64:67], v[176:179], v[0:15]
    s_add_u32 m0, s21, 6144
    v_mfma_f32_32x32x16_bf16 v[48:63], v[68:71], v[176:179], v[48:63]
    buffer_load_dwordx4 v240, s[4:7], s35 offen  lds
    buffer_load_dwordx4 v241, s[8:11], s35 offen offset:1024  lds
    s_mov_b32 m0, s50
    s_nop 0
    s_movrels_b32 s71, s23
    s_movrels_b32 s33, s28
    v_add_u32 v253, s33, v248
    s_bfe_u32 s46, s71, 0x30012
    s_mov_b32 m0, s46
    s_and_b32 s66, s71, 0x3ffff
    s_movrels_b32 s68, s57
    s_movrels_b32 s69, s61
    s_sub_u32 s48, s66, s47
    s_mov_b32 s47, s66
    s_lshr_b32 s52, s71, 28
    s_lshl_b32 s67, s46, 9
    s_add_u32 s66, s66, s67
    s_sub_u32 s49, s66, s42
    s_mov_b32 s42, s66
    s_bfe_u32 s66, s68, 655360
    s_add_u32 s43, s42, s66
    s_bfe_u32 s39, s69, 655360
    s_bfe_u32 s66, s68, 655370
    s_add_u32 s44, s42, s66
    s_bfe_u32 s40, s69, 655370
    s_bfe_u32 s66, s68, 655380
    s_add_u32 s45, s42, s66
    s_bfe_u32 s41, s69, 655380
    v_mfma_f32_32x32x16_bf16 v[16:31], v[72:75], v[180:183], 0
    v_mul_f32 v196, v0, v96
    v_fmac_f32 v196, v1, v97
    v_fmac_f32 v196, v2, v98
    v_fmac_f32 v196, v3, v99
    v_fmac_f32 v196, v4, v100
    v_fmac_f32 v196, v5, v101
    v_mfma_f32_32x32x16_bf16 v[32:47], v[76:79], v[180:183], 0
    v_fmac_f32 v196, v6, v102
    v_fmac_f32 v196, v7, v103
    v_mul_f32 v198, v8, v128
    v_fmac_f32 v198, v9, v129
    v_fmac_f32 v198, v10, v130
    v_fmac_f32 v198, v11, v131
    v_mfma_f32_32x32x16_bf16 v[16:31], v[80:83], v[184:187], v[16:31]
    v_fmac_f32 v198, v12, v132
    v_fmac_f32 v198, v13, v133
    v_fmac_f32 v198, v14, v134
    v_fmac_f32 v198, v15, v135
    v_mul_f32 v200, v48, v128
    v_fmac_f32 v200, v49, v129
    v_mfma_f32_32x32x16_bf16 v[32:47], v[84:87], v[184:187], v[32:47]
    v_permlane32_swap_b32 v196, v198
    v_fmac_f32 v200, v50, v130
    v_fmac_f32 v200, v51, v131
    v_fmac_f32 v200, v52, v132
    v_fmac_f32 v200, v53, v133
    v_fmac_f32 v200, v54, v134
    v_mfma_f32_32x32x16_bf16 v[16:31], v[88:91], v[188:191], v[16:31]
    v_fmac_f32 v200, v55, v135
    v_add_f32 v198, v196, v198
    v_mul_f32_e64 v202, v56, -v128
    v_fma_f32 v202, v57, -v129, v202
    v_fma_f32 v202, v58, -v130, v202
    v_fma_f32 v202, v59, -v131, v202
    v_mfma_f32_32x32x16_bf16 v[32:47], v[92:95], v[188:191], v[32:47]
    s_waitcnt vmcnt(6)
    ds_read_b64_tr_b16 v[176:177], v244 offset:0
    ds_read_b64_tr_b16 v[178:179], v244 offset:1024
    ds_read_b64_tr_b16 v[180:181], v245 offset:0
    ds_read_b64_tr_b16 v[182:183], v245 offset:1024
    v_fma_f32 v202, v60, -v132, v202
    v_fma_f32 v202, v61, -v133, v202
    v_mfma_f32_32x32x16_bf16 v[16:31], v[64:67], v[192:195], v[16:31]
    v_fma_f32 v202, v62, -v134, v202
    v_fma_f32 v202, v63, -v135, v202
    s_nop 1
    v_permlane32_swap_b32 v200, v202
    v_add_f32 v202, v200, v202
    v_mfma_f32_32x32x16_bf16 v[32:47], v[68:71], v[192:195], v[32:47]
    s_waitcnt vmcnt(4) lgkmcnt(0)
    v_mfma_f32_32x32x16_bf16 v[0:15], v[72:75], v[176:179], 0
    s_nop 2
    v_mul_f32 v197, v16, v104
    v_fmac_f32 v197, v17, v105
    v_fmac_f32 v197, v18, v106
    v_fmac_f32 v197, v19, v107
    v_fmac_f32 v197, v20, v108
    v_fmac_f32 v197, v21, v109
    s_add_u32 m0, s21, 0
    v_mfma_f32_32x32x16_bf16 v[48:63], v[76:79], v[176:179], 0
    buffer_load_dwordx4 v234, s[4:7], s36 offen  lds
    buffer_load_dwordx4 v235, s[8:11], s36 offen offset:1024  lds
    ds_read_b64_tr_b16 v[176:177], v244 offset:2048
    ds_read_b64_tr_b16 v[178:179], v244 offset:3072
    ds_read_b64_tr_b16 v[184:185], v245 offset:2048
    ds_read_b64_tr_b16 v[186:187], v245 offset:3072
    v_fmac_f32 v197, v22, v110
    v_fmac_f32 v197, v23, v111
    v_mul_f32 v199, v24, v136
    v_fmac_f32 v199, v25, v137
    v_fmac_f32 v199, v26, v138
    v_fmac_f32 v199, v27, v139
    v_fmac_f32 v199, v28, v140
    v_fmac_f32 v199, v29, v141
    v_fmac_f32 v199, v30, v142
    v_fmac_f32 v199, v31, v143
    v_mul_f32 v201, v32, v136
    s_waitcnt vmcnt(4) lgkmcnt(0)
    v_mfma_f32_32x32x16_bf16 v[0:15], v[80:83], v[176:179], v[0:15]
    v_fmac_f32 v201, v33, v137
    v_permlane32_swap_b32 v197, v199
    v_fmac_f32 v201, v34, v138
    v_fmac_f32 v201, v35, v139
    v_fmac_f32 v201, v36, v140
    v_fmac_f32 v201, v37, v141
    s_add_u32 m0, s21, 2048
    v_mfma_f32_32x32x16_bf16 v[48:63], v[84:87], v[176:179], v[48:63]
    buffer_load_dwordx4 v236, s[4:7], s36 offen  lds
    buffer_load_dwordx4 v237, s[8:11], s36 offen offset:1024  lds
    ds_read_b64_tr_b16 v[176:177], v244 offset:4096
    ds_read_b64_tr_b16 v[178:179], v244 offset:5120
    ds_read_b64_tr_b16 v[188:189], v245 offset:4096
    ds_read_b64_tr_b16 v[190:191], v245 offset:5120
    s_waitcnt vmcnt(4) lgkmcnt(0)
    v_mfma_f32_32x32x16_bf16 v[0:15], v[88:91], v[176:179], v[0:15]
    v_fmac_f32 v201, v38, v142
    v_fmac_f32 v201, v39, v143
    v_add_f32 v199, v197, v199
    v_mul_f32_e64 v203, v40, -v136
    v_fma_f32 v203, v41, -v137, v203
    v_fma_f32 v203, v42, -v138, v203
    s_add_u32 m0, s21, 4096
    v_mfma_f32_32x32x16_bf16 v[48:63], v[92:95], v[176:179], v[48:63]
    buffer_load_dwordx4 v238, s[4:7], s36 offen  lds
    buffer_load_dwordx4 v239, s[8:11], s36 offen offset:1024  lds
    ds_read_b64_tr_b16 v[176:177], v244 offset:6144
    ds_read_b64_tr_b16 v[178:179], v244 offset:7168
    ds_read_b64_tr_b16 v[192:193], v245 offset:6144
    ds_read_b64_tr_b16 v[194:195], v245 offset:7168
    s_waitcnt lgkmcnt(0)
    v_mfma_f32_32x32x16_bf16 v[0:15], v[64:67], v[176:179], v[0:15]
    v_fma_f32 v203, v43, -v139, v203
    v_fma_f32 v203, v44, -v140, v203
    v_fma_f32 v203, v45, -v141, v203
    v_fma_f32 v203, v46, -v142, v203
    v_fma_f32 v203, v47, -v143, v203
    s_nop 1
    v_permlane32_swap_b32 v201, v203
    s_add_u32 m0, s21, 6144
    v_mfma_f32_32x32x16_bf16 v[48:63], v[68:71], v[176:179], v[48:63]
    buffer_load_dwordx4 v240, s[4:7], s36 offen  lds
    buffer_load_dwordx4 v241, s[8:11], s36 offen offset:1024  lds
    v_add_f32 v203, v201, v203
    v_cvt_pk_bf16_f32 v198, v198, v199
    v_cvt_pk_bf16_f32 v202, v202, v203
    ds_write2st64_b32 v253, v198, v202 offset0:0 offset1:1
    v_mfma_f32_32x32x16_bf16 v[16:31], v[72:75], v[180:183], 0
    v_mul_f32 v196, v0, v144
    v_fmac_f32 v196, v1, v145
    v_fmac_f32 v196, v2, v146
    v_fmac_f32 v196, v3, v147
    v_fmac_f32 v196, v4, v148
    v_fmac_f32 v196, v5, v149
    v_mfma_f32_32x32x16_bf16 v[32:47], v[76:79], v[180:183], 0
    v_fmac_f32 v196, v6, v150
    v_fmac_f32 v196, v7, v151
    v_mul_f32 v198, v8, v112
    v_fmac_f32 v198, v9, v113
    v_fmac_f32 v198, v10, v114
    v_fmac_f32 v198, v11, v115
    v_mfma_f32_32x32x16_bf16 v[16:31], v[80:83], v[184:187], v[16:31]
    v_fmac_f32 v198, v12, v116
    v_fmac_f32 v198, v13, v117
    v_fmac_f32 v198, v14, v118
    v_fmac_f32 v198, v15, v119
    v_mul_f32_e64 v200, v48, -v160
    v_fma_f32 v200, v49, -v161, v200
    v_mfma_f32_32x32x16_bf16 v[32:47], v[84:87], v[184:187], v[32:47]
    v_fma_f32 v200, v50, -v162, v200
    v_fma_f32 v200, v51, -v163, v200
    v_fma_f32 v200, v52, -v164, v200
    v_fma_f32 v200, v53, -v165, v200
    v_fma_f32 v200, v54, -v166, v200
    v_fma_f32 v200, v55, -v167, v200
    v_mfma_f32_32x32x16_bf16 v[16:31], v[88:91], v[188:191], v[16:31]
    v_mul_f32_e64 v202, v56, -v160
    v_fma_f32 v202, v57, -v161, v202
    v_fma_f32 v202, v58, -v162, v202
    v_fma_f32 v202, v59, -v163, v202
    v_fma_f32 v202, v60, -v164, v202
    v_fma_f32 v202, v61, -v165, v202
    v_mfma_f32_32x32x16_bf16 v[32:47], v[92:95], v[188:191], v[32:47]
    s_waitcnt vmcnt(6)
    ds_read_b64_tr_b16 v[176:177], v244 offset:0
    ds_read_b64_tr_b16 v[178:179], v244 offset:1024
    ds_read_b64_tr_b16 v[180:181], v245 offset:0
    ds_read_b64_tr_b16 v[182:183], v245 offset:1024
    v_fma_f32 v202, v62, -v166, v202
    v_fma_f32 v202, v63, -v167, v202
    v_mfma_f32_32x32x16_bf16 v[16:31], v[64:67], v[192:195], v[16:31]
    v_mfma_f32_32x32x16_bf16 v[32:47], v[68:71], v[192:195], v[32:47]
    s_waitcnt vmcnt(4) lgkmcnt(0)
    v_mfma_f32_32x32x16_bf16 v[0:15], v[72:75], v[176:179], 0
    s_nop 8
    v_mul_f32 v197, v16, v152
    v_fmac_f32 v197, v17, v153
    v_fmac_f32 v197, v18, v154
    v_fmac_f32 v197, v19, v155
    v_fmac_f32 v197, v20, v156
    v_fmac_f32 v197, v21, v157
    s_add_u32 m0, s21, 0
    v_mfma_f32_32x32x16_bf16 v[48:63], v[76:79], v[176:179], 0
    buffer_load_dwordx4 v234, s[4:7], s37 offen  lds
    buffer_load_dwordx4 v235, s[8:11], s37 offen offset:1024  lds
    ds_read_b64_tr_b16 v[176:177], v244 offset:2048
    ds_read_b64_tr_b16 v[178:179], v244 offset:3072
    ds_read_b64_tr_b16 v[184:185], v245 offset:2048
    ds_read_b64_tr_b16 v[186:187], v245 offset:3072
    v_add_u32 v252, s42, v247
    ds_read2_b32 v[234:235], v252 offset0:0 offset1:16
    v_fmac_f32 v197, v22, v158
    v_fmac_f32 v197, v23, v159
    v_mul_f32 v199, v24, v120
    v_fmac_f32 v199, v25, v121
    v_fmac_f32 v199, v26, v122
    v_fmac_f32 v199, v27, v123
    s_waitcnt vmcnt(4) lgkmcnt(1)
    v_mfma_f32_32x32x16_bf16 v[0:15], v[80:83], v[176:179], v[0:15]
    v_fmac_f32 v199, v28, v124
    v_fmac_f32 v199, v29, v125
    v_fmac_f32 v199, v30, v126
    v_fmac_f32 v199, v31, v127
    v_mul_f32_e64 v201, v32, -v168
    v_fma_f32 v201, v33, -v169, v201
    s_add_u32 m0, s21, 2048
    v_mfma_f32_32x32x16_bf16 v[48:63], v[84:87], v[176:179], v[48:63]
    buffer_load_dwordx4 v236, s[4:7], s37 offen  lds
    buffer_load_dwordx4 v237, s[8:11], s37 offen offset:1024  lds
    ds_read_b64_tr_b16 v[176:177], v244 offset:4096
    ds_read_b64_tr_b16 v[178:179], v244 offset:5120
    ds_read_b64_tr_b16 v[188:189], v245 offset:4096
    ds_read_b64_tr_b16 v[190:191], v245 offset:5120
    v_add_u32 v252, s43, v247
    ds_read2_b32 v[236:237], v252 offset0:0 offset1:16
    s_waitcnt vmcnt(4) lgkmcnt(1)
    v_mfma_f32_32x32x16_bf16 v[0:15], v[88:91], v[176:179], v[0:15]
    v_fma_f32 v201, v34, -v170, v201
    v_fma_f32 v201, v35, -v171, v201
    v_fma_f32 v201, v36, -v172, v201
    v_fma_f32 v201, v37, -v173, v201
    v_fma_f32 v201, v38, -v174, v201
    v_fma_f32 v201, v39, -v175, v201
    s_add_u32 m0, s21, 4096
    v_mfma_f32_32x32x16_bf16 v[48:63], v[92:95], v[176:179], v[48:63]
    buffer_load_dwordx4 v238, s[4:7], s37 offen  lds
    buffer_load_dwordx4 v239, s[8:11], s37 offen offset:1024  lds
    ds_read_b64_tr_b16 v[176:177], v244 offset:6144
    ds_read_b64_tr_b16 v[178:179], v244 offset:7168
    ds_read_b64_tr_b16 v[192:193], v245 offset:6144
    ds_read_b64_tr_b16 v[194:195], v245 offset:7168
    v_add_u32 v252, s44, v247
    ds_read2_b32 v[238:239], v252 offset0:0 offset1:16
    s_waitcnt lgkmcnt(1)
    v_mfma_f32_32x32x16_bf16 v[0:15], v[64:67], v[176:179], v[0:15]
    v_mul_f32_e64 v203, v40, -v168
    v_fma_f32 v203, v41, -v169, v203
    v_fma_f32 v203, v42, -v170, v203
    v_fma_f32 v203, v43, -v171, v203
    v_fma_f32 v203, v44, -v172, v203
    v_fma_f32 v203, v45, -v173, v203
    s_add_u32 m0, s21, 6144
    v_mfma_f32_32x32x16_bf16 v[48:63], v[68:71], v[176:179], v[48:63]
    buffer_load_dwordx4 v240, s[4:7], s37 offen  lds
    buffer_load_dwordx4 v241, s[8:11], s37 offen offset:1024  lds
    v_add_u32 v252, s45, v247
    ds_read2_b32 v[240:241], v252 offset0:0 offset1:16
    v_fma_f32 v203, v46, -v174, v203
    v_fma_f32 v203, v47, -v175, v203
    v_mfma_f32_32x32x16_bf16 v[16:31], v[72:75], v[180:183], 0
    v_mul_f32 v254, v0, v144
    v_fmac_f32 v254, v1, v145
    v_fmac_f32 v254, v2, v146
    v_fmac_f32 v254, v3, v147
    v_fmac_f32 v254, v4, v148
    v_fmac_f32 v254, v5, v149
    v_mfma_f32_32x32x16_bf16 v[32:47], v[76:79], v[180:183], 0
    ds_swizzle_b32 v76, v76 offset:0x401F
    ds_swizzle_b32 v77, v77 offset:0x401F
    ds_swizzle_b32 v78, v78 offset:0x401F
    ds_swizzle_b32 v79, v79 offset:0x401F
    v_fmac_f32 v254, v6, v150
    v_fmac_f32 v254, v7, v151
    v_mfma_f32_32x32x16_bf16 v[16:31], v[80:83], v[184:187], v[16:31]
    v_fmac_f32 v200, v8, v160
    v_fmac_f32 v200, v9, v161
    v_permlane32_swap_b32 v196, v254
    v_fmac_f32 v200, v10, v162
    v_fmac_f32 v200, v11, v163
    v_fmac_f32 v200, v12, v164
    v_mfma_f32_32x32x16_bf16 v[32:47], v[84:87], v[184:187], v[32:47]
    ds_swizzle_b32 v84, v84 offset:0x401F
    ds_swizzle_b32 v85, v85 offset:0x401F
    ds_swizzle_b32 v86, v86 offset:0x401F
    ds_swizzle_b32 v87, v87 offset:0x401F
    v_fmac_f32 v200, v13, v165
    v_fmac_f32 v200, v14, v166
    v_mfma_f32_32x32x16_bf16 v[16:31], v[88:91], v[188:191], v[16:31]
    v_fmac_f32 v200, v15, v167
    v_add_f32 v254, v196, v254
    v_mfma_f32_32x32x16_bf16 v[32:47], v[92:95], v[188:191], v[32:47]
    ds_swizzle_b32 v92, v92 offset:0x401F
    ds_swizzle_b32 v93, v93 offset:0x401F
    ds_swizzle_b32 v94, v94 offset:0x401F
    ds_swizzle_b32 v95, v95 offset:0x401F
    s_waitcnt vmcnt(6)
    ds_read_b64_tr_b16 v[176:177], v244 offset:0
    ds_read_b64_tr_b16 v[178:179], v244 offset:1024
    ds_read_b64_tr_b16 v[180:181], v245 offset:0
    ds_read_b64_tr_b16 v[182:183], v245 offset:1024
    v_mfma_f32_32x32x16_bf16 v[16:31], v[64:67], v[192:195], v[16:31]
    v_mfma_f32_32x32x16_bf16 v[32:47], v[68:71], v[192:195], v[32:47]
    ds_swizzle_b32 v68, v68 offset:0x401F
    ds_swizzle_b32 v69, v69 offset:0x401F
    ds_swizzle_b32 v70, v70 offset:0x401F
    ds_swizzle_b32 v71, v71 offset:0x401F
    s_waitcnt lgkmcnt(8)
    s_mov_b64 exec, s[56:57]
    v_xor_b32 v76, 0x80008000, v76
    v_xor_b32 v77, 0x80008000, v77
    v_xor_b32 v78, 0x80008000, v78
    v_xor_b32 v79, 0x80008000, v79
    v_xor_b32 v84, 0x80008000, v84
    v_xor_b32 v85, 0x80008000, v85
    v_xor_b32 v86, 0x80008000, v86
    v_xor_b32 v87, 0x80008000, v87
    v_xor_b32 v92, 0x80008000, v92
    v_xor_b32 v93, 0x80008000, v93
    v_xor_b32 v94, 0x80008000, v94
    v_xor_b32 v95, 0x80008000, v95
    s_mov_b64 exec, -1
    s_waitcnt vmcnt(4) lgkmcnt(4)
    v_mfma_f32_32x32x16_bf16 v[0:15], v[72:75], v[176:179], 0
    v_mul_f32 v255, v16, v152
    v_fmac_f32 v255, v17, v153
    v_fmac_f32 v255, v18, v154
    v_fmac_f32 v255, v19, v155
    v_fmac_f32 v255, v20, v156
    v_fmac_f32 v255, v21, v157
    s_add_u32 m0, s21, 0
    v_mfma_f32_32x32x16_bf16 v[48:63], v[76:79], v[176:179], v[48:63]
    s_cbranch_vccnz WL_8_0
    v_mad_u32_u16 v234, v234, s3, v246 op_sel:[1,0,0,0]
    v_mad_u32_u16 v235, v235, s3, v246 op_sel:[1,0,0,0]
    buffer_load_dwordx4 v234, s[4:7], s38 offen  lds
    buffer_load_dwordx4 v235, s[8:11], s38 offen offset:1024  lds
WR_8_0:
    ds_read_b64_tr_b16 v[176:177], v244 offset:2048
    ds_read_b64_tr_b16 v[178:179], v244 offset:3072
    ds_read_b64_tr_b16 v[184:185], v245 offset:2048
    ds_read_b64_tr_b16 v[186:187], v245 offset:3072
    s_waitcnt vmcnt(4) lgkmcnt(0)
    v_mfma_f32_32x32x16_bf16 v[0:15], v[80:83], v[176:179], v[0:15]
    s_add_u32 m0, s21, 2048
    v_mfma_f32_32x32x16_bf16 v[48:63], v[84:87], v[176:179], v[48:63]
    s_cbranch_vccnz WL_8_1
    v_mad_u32_u16 v236, v236, s3, v246 op_sel:[1,0,0,0]
    v_mad_u32_u16 v237, v237, s3, v246 op_sel:[1,0,0,0]
    buffer_load_dwordx4 v236, s[4:7], s39 offen  lds
    buffer_load_dwordx4 v237, s[8:11], s39 offen offset:1024  lds
WR_8_1:
    ds_read_b64_tr_b16 v[176:177], v244 offset:4096
    ds_read_b64_tr_b16 v[178:179], v244 offset:5120
    ds_read_b64_tr_b16 v[188:189], v245 offset:4096
    ds_read_b64_tr_b16 v[190:191], v245 offset:5120
    s_waitcnt vmcnt(4) lgkmcnt(0)
    v_mfma_f32_32x32x16_bf16 v[0:15], v[88:91], v[176:179], v[0:15]
    v_fmac_f32 v255, v22, v158
    v_fmac_f32 v255, v23, v159
    v_fmac_f32 v201, v24, v168
    v_fmac_f32 v201, v25, v169
    v_permlane32_swap_b32 v197, v255
    v_fmac_f32 v201, v26, v170
    s_add_u32 m0, s21, 4096
    v_mfma_f32_32x32x16_bf16 v[48:63], v[92:95], v[176:179], v[48:63]
    s_cbranch_vccnz WL_8_2
    v_mad_u32_u16 v238, v238, s3, v246 op_sel:[1,0,0,0]
    v_mad_u32_u16 v239, v239, s3, v246 op_sel:[1,0,0,0]
    buffer_load_dwordx4 v238, s[4:7], s40 offen  lds
    buffer_load_dwordx4 v239, s[8:11], s40 offen offset:1024  lds
WR_8_2:
    ds_read_b64_tr_b16 v[176:177], v244 offset:6144
    ds_read_b64_tr_b16 v[178:179], v244 offset:7168
    ds_read_b64_tr_b16 v[192:193], v245 offset:6144
    ds_read_b64_tr_b16 v[194:195], v245 offset:7168
    s_waitcnt lgkmcnt(0)
    s_mov_b64 exec, s[56:57]
    v_xor_b32 v68, 0x80008000, v68
    v_xor_b32 v69, 0x80008000, v69
    v_xor_b32 v70, 0x80008000, v70
    v_xor_b32 v71, 0x80008000, v71
    s_mov_b64 exec, -1
    v_mfma_f32_32x32x16_bf16 v[0:15], v[64:67], v[176:179], v[0:15]
    v_fmac_f32 v201, v27, v171
    v_fmac_f32 v201, v28, v172
    v_fmac_f32 v201, v29, v173
    v_fmac_f32 v201, v30, v174
    v_fmac_f32 v201, v31, v175
    v_add_f32 v255, v197, v255
    s_add_u32 m0, s21, 6144
    v_mfma_f32_32x32x16_bf16 v[48:63], v[68:71], v[176:179], v[48:63]
    s_cbranch_vccnz WL_8_3
    v_mad_u32_u16 v240, v240, s3, v246 op_sel:[1,0,0,0]
    v_mad_u32_u16 v241, v241, s3, v246 op_sel:[1,0,0,0]
    buffer_load_dwordx4 v240, s[4:7], s41 offen  lds
    buffer_load_dwordx4 v241, s[8:11], s41 offen offset:1024  lds
WR_8_3:
    v_cvt_pk_bf16_f32 v254, v254, v255
    ds_write_b32 v253, v254 offset:512
    v_mfma_f32_32x32x16_bf16 v[16:31], v[72:75], v[180:183], 0
    v_mul_f32 v254, v0, v144
    v_fmac_f32 v254, v1, v145
    v_fmac_f32 v254, v2, v146
    v_fmac_f32 v254, v3, v147
    v_fmac_f32 v254, v4, v148
    v_fmac_f32 v254, v5, v149
    v_mfma_f32_32x32x16_bf16 v[32:47], v[76:79], v[180:183], v[32:47]
    v_fmac_f32 v254, v6, v150
    v_fmac_f32 v254, v7, v151
    v_fma_f32 v202, v8, -v160, v202
    v_fma_f32 v202, v9, -v161, v202
    v_permlane32_swap_b32 v254, v200
    v_fma_f32 v202, v10, -v162, v202
    v_mfma_f32_32x32x16_bf16 v[16:31], v[80:83], v[184:187], v[16:31]
    v_fma_f32 v202, v11, -v163, v202
    v_fma_f32 v202, v12, -v164, v202
    v_fma_f32 v202, v13, -v165, v202
    v_fma_f32 v202, v14, -v166, v202
    v_fma_f32 v202, v15, -v167, v202
    v_add_f32 v200, v254, v200
    v_mfma_f32_32x32x16_bf16 v[32:47], v[84:87], v[184:187], v[32:47]
    v_fmac_f32 v198, v48, v112
    v_permlane32_swap_b32 v202, v254
    v_fmac_f32 v198, v49, v113
    v_fmac_f32 v198, v50, v114
    v_fmac_f32 v198, v51, v115
    v_fmac_f32 v198, v52, v116
    v_mfma_f32_32x32x16_bf16 v[16:31], v[88:91], v[188:191], v[16:31]
    v_fmac_f32 v198, v53, v117
    v_fmac_f32 v198, v54, v118
    v_fmac_f32 v198, v55, v119
    v_add_f32 v254, v202, v254
    v_mul_f32 v196, v56, v160
    v_fmac_f32 v196, v57, v161
    v_mfma_f32_32x32x16_bf16 v[32:47], v[92:95], v[188:191], v[32:47]
    s_waitcnt vmcnt(6)
    ds_read_b64_tr_b16 v[176:177], v244 offset:0
    ds_read_b64_tr_b16 v[178:179], v244 offset:1024
    ds_read_b64_tr_b16 v[180:181], v245 offset:0
    ds_read_b64_tr_b16 v[182:183], v245 offset:1024
    v_fmac_f32 v196, v58, v162
    v_fmac_f32 v196, v59, v163
    v_mfma_f32_32x32x16_bf16 v[16:31], v[64:67], v[192:195], v[16:31]
    v_fmac_f32 v196, v60, v164
    v_fmac_f32 v196, v61, v165
    v_fmac_f32 v196, v62, v166
    v_fmac_f32 v196, v63, v167
    s_nop 1
    v_permlane32_swap_b32 v198, v196
    v_add_f32 v196, v198, v196
    v_mfma_f32_32x32x16_bf16 v[32:47], v[68:71], v[192:195], v[32:47]
    v_add_u32 v249, s48, v249
    v_add_u32 v250, s49, v250
    ds_read_b32 v252, v251 offset:16
    ds_read_b64_tr_b16 v[72:73], v249 offset:0
    ds_read_b64_tr_b16 v[76:77], v249 offset:64
    ds_read_b64_tr_b16 v[74:75], v249 offset:256
    ds_read_b64_tr_b16 v[78:79], v249 offset:320
    s_mov_b64 exec, s[54:55]
    ds_read_u16_d16_hi v242, v250 offset:0
    s_mov_b64 exec, -1
    s_cbranch_vccnz LEPI_1
    v_mul_f32 v255, v16, v152
    v_fmac_f32 v255, v17, v153
    v_fmac_f32 v255, v18, v154
    v_fmac_f32 v255, v19, v155
    v_fmac_f32 v255, v20, v156
    v_fmac_f32 v255, v21, v157
    v_fmac_f32 v255, v22, v158
    v_fmac_f32 v255, v23, v159
    v_fma_f32 v203, v24, -v168, v203
    v_fma_f32 v203, v25, -v169, v203
    v_permlane32_swap_b32 v255, v201
    v_fma_f32 v203, v26, -v170, v203
    v_fma_f32 v203, v27, -v171, v203
    v_fma_f32 v203, v28, -v172, v203
    v_fma_f32 v203, v29, -v173, v203
    v_fma_f32 v203, v30, -v174, v203
    v_fma_f32 v203, v31, -v175, v203
    v_add_f32 v201, v255, v201
    v_fmac_f32 v199, v32, v120
    v_permlane32_swap_b32 v203, v255
    v_fmac_f32 v199, v33, v121
    v_fmac_f32 v199, v34, v122
    v_fmac_f32 v199, v35, v123
    v_fmac_f32 v199, v36, v124
    v_fmac_f32 v199, v37, v125
    v_fmac_f32 v199, v38, v126
    v_fmac_f32 v199, v39, v127
    v_add_f32 v255, v203, v255
    v_mul_f32 v197, v40, v168
    v_fmac_f32 v197, v41, v169
    v_fmac_f32 v197, v42, v170
    v_fmac_f32 v197, v43, v171
    v_fmac_f32 v197, v44, v172
    v_fmac_f32 v197, v45, v173
    v_fmac_f32 v197, v46, v174
    v_fmac_f32 v197, v47, v175
    s_nop 1
    v_permlane32_swap_b32 v199, v197
    v_add_f32 v197, v199, v197
    v_cvt_pk_bf16_f32 v200, v200, v201
    v_cvt_pk_bf16_f32 v254, v254, v255
    v_cvt_pk_bf16_f32 v196, v196, v197
    ds_write2st64_b32 v253, v200, v196 offset0:3 offset1:4
    s_mov_b64 exec, 0xffffffff
    ds_write_b32 v253, v254 offset:1280
    s_mov_b64 exec, -1
    s_add_u32 s50, s50, 1
    s_cmp_ge_u32 s50, 4
    s_cbranch_scc1 LAST1
    s_waitcnt lgkmcnt(7)
    v_readfirstlane_b32 s66, v252
    s_add_u32 s53, s53, 1
    v_mov_b32 v252, s53
    s_cmp_le_u32 s53, s66
    ds_write2_b32 v251, v252, v252 offset0:0 offset1:8
    s_setprio 1
    s_cbranch_scc1 PRIO_15
    s_setprio 0
PRIO_15:
    s_cmp_eq_u32 s52, 4
    s_cbranch_scc1 ITEM_1_4
    s_cmp_eq_u32 s52, 5
    s_cbranch_scc1 ITEM_1_5
    s_cmp_eq_u32 s52, 3
    s_cbranch_scc1 ITEM_1_3
    s_cmp_eq_u32 s52, 6
    s_cbranch_scc1 ITEM_1_6
    s_cmp_eq_u32 s52, 8
    s_cbranch_scc1 ITEM_1_8
    s_branch ITEM_1_2
WL_8_0:
    s_add_u32 s66, s51, 0
    buffer_load_dwordx4 v[96:99], v246, s[16:19], s66 offen offset:2048 sc1
    buffer_load_dwordx4 v[100:103], v246, s[16:19], s66 offen offset:3072 sc1
    s_branch WR_8_0
WL_8_1:
    s_add_u32 s66, s51, 4096
    buffer_load_dwordx4 v[104:107], v246, s[16:19], s66 offen offset:2048 sc1
    buffer_load_dwordx4 v[108:111], v246, s[16:19], s66 offen offset:3072 sc1
    s_branch WR_8_1
WL_8_2:
    s_add_u32 s66, s51, 8192
    buffer_load_dwordx4 v[128:131], v246, s[16:19], s66 offen offset:2048 sc1
    buffer_load_dwordx4 v[132:135], v246, s[16:19], s66 offen offset:3072 sc1
    s_branch WR_8_2
WL_8_3:
    s_add_u32 s66, s51, 12288
    buffer_load_dwordx4 v[136:139], v246, s[16:19], s66 offen offset:2048 sc1
    buffer_load_dwordx4 v[140:143], v246, s[16:19], s66 offen offset:3072 sc1
    s_branch WR_8_3
.p2align 6
ITEM_1_2:
    s_mov_b32 m0, s50
    s_nop 0
    s_movrels_b32 s71, s23
    s_movrels_b32 s33, s28
    v_add_u32 v253, s33, v248
    s_bfe_u32 s46, s71, 0x30012
    s_mov_b32 m0, s46
    s_and_b32 s66, s71, 0x3ffff
    s_movrels_b32 s68, s57
    s_movrels_b32 s69, s61
    s_sub_u32 s48, s66, s47
    s_mov_b32 s47, s66
    s_lshr_b32 s52, s71, 28
    s_lshl_b32 s67, s46, 9
    s_add_u32 s66, s66, s67
    s_sub_u32 s49, s66, s42
    s_mov_b32 s42, s66
    s_bfe_u32 s66, s68, 655360
    s_add_u32 s43, s42, s66
    s_bfe_u32 s39, s69, 655360
    s_bfe_u32 s66, s68, 655370
    s_add_u32 s44, s42, s66
    s_bfe_u32 s40, s69, 655370
    s_bfe_u32 s66, s68, 655380
    s_add_u32 s45, s42, s66
    s_bfe_u32 s41, s69, 655380
    v_add_u32 v252, s42, v247
    ds_read2_b32 v[234:235], v252 offset0:0 offset1:16
    v_add_u32 v252, s43, v247
    ds_read2_b32 v[236:237], v252 offset0:0 offset1:16
    v_add_u32 v252, s44, v247
    ds_read2_b32 v[238:239], v252 offset0:0 offset1:16
    v_add_u32 v252, s45, v247
    ds_read2_b32 v[240:241], v252 offset0:0 offset1:16
    s_waitcnt lgkmcnt(4)
    v_mul_f32_dpp v196, v242, v72 row_newbcast:0 row_mask:0xf bank_mask:0xf
    v_mul_f32_dpp v197, v242, v73 row_newbcast:1 row_mask:0xf bank_mask:0xf
    v_mul_f32_dpp v198, v242, v72 row_newbcast:8 row_mask:0xf bank_mask:0xf
    v_mul_f32_dpp v199, v242, v73 row_newbcast:9 row_mask:0xf bank_mask:0xf
    v_mul_f32_dpp v200, v242, v76 row_newbcast:2 row_mask:0xf bank_mask:0xf
    v_mul_f32_dpp v201, v242, v77 row_newbcast:3 row_mask:0xf bank_mask:0xf
    v_mul_f32_dpp v202, v242, v76 row_newbcast:10 row_mask:0xf bank_mask:0xf
    v_mul_f32_dpp v203, v242, v77 row_newbcast:11 row_mask:0xf bank_mask:0xf
    v_cvt_pk_bf16_f32 v72, v196, v197
    v_cvt_pk_bf16_f32 v76, v198, v199
    v_cvt_pk_bf16_f32 v73, v200, v201
    v_cvt_pk_bf16_f32 v77, v202, v203
    v_mul_f32_dpp v196, v242, v74 row_newbcast:4 row_mask:0xf bank_mask:0xf
    v_mul_f32_dpp v197, v242, v75 row_newbcast:5 row_mask:0xf bank_mask:0xf
    v_mul_f32_dpp v198, v242, v74 row_newbcast:12 row_mask:0xf bank_mask:0xf
    v_mul_f32_dpp v199, v242, v75 row_newbcast:13 row_mask:0xf bank_mask:0xf
    v_mul_f32_dpp v200, v242, v78 row_newbcast:6 row_mask:0xf bank_mask:0xf
    v_mul_f32_dpp v201, v242, v79 row_newbcast:7 row_mask:0xf bank_mask:0xf
    v_mul_f32_dpp v202, v242, v78 row_newbcast:14 row_mask:0xf bank_mask:0xf
    v_mul_f32_dpp v203, v242, v79 row_newbcast:15 row_mask:0xf bank_mask:0xf
    v_cvt_pk_bf16_f32 v74, v196, v197
    v_cvt_pk_bf16_f32 v78, v198, v199
    v_cvt_pk_bf16_f32 v75, v200, v201
    v_cvt_pk_bf16_f32 v79, v202, v203
    s_nop 0
    s_waitcnt lgkmcnt(3)
    v_mfma_f32_32x32x16_bf16 v[56:71], v[72:75], v[176:179], 0
    s_add_u32 m0, s21, 0
    v_mfma_f32_32x32x16_bf16 v[16:31], v[76:79], v[176:179], 0
    s_cbranch_vccnz WL_2_0
    v_mad_u32_u16 v234, v234, s3, v246 op_sel:[1,0,0,0]
    v_mad_u32_u16 v235, v235, s3, v246 op_sel:[1,0,0,0]
    buffer_load_dwordx4 v234, s[4:7], s38 offen  lds
    buffer_load_dwordx4 v235, s[8:11], s38 offen offset:1024  lds
WR_2_0:
    v_mfma_f32_32x32x16_bf16 v[32:47], v[72:75], v[180:183], 0
    s_nop 3
    v_mul_f32 v196, v56, v96
    v_fmac_f32 v196, v57, v97
    v_fmac_f32 v196, v58, v98
    v_fmac_f32 v196, v59, v99
    v_fmac_f32 v196, v60, v100
    v_fmac_f32 v196, v61, v101
    v_mfma_f32_32x32x16_bf16 v[0:15], v[76:79], v[180:183], 0
    s_waitcnt vmcnt(6)
    ds_read_b64_tr_b16 v[176:177], v244 offset:2048
    ds_read_b64_tr_b16 v[178:179], v244 offset:3072
    ds_read_b64_tr_b16 v[180:181], v245 offset:2048
    ds_read_b64_tr_b16 v[182:183], v245 offset:3072
    v_fmac_f32 v196, v62, v102
    v_fmac_f32 v196, v63, v103
    v_mul_f32 v198, v64, v128
    v_fmac_f32 v198, v65, v129
    v_fmac_f32 v198, v66, v130
    v_fmac_f32 v198, v67, v131
    v_fmac_f32 v198, v68, v132
    v_fmac_f32 v198, v69, v133
    v_fmac_f32 v198, v70, v134
    v_fmac_f32 v198, v71, v135
    v_mul_f32 v200, v16, v128
    v_fmac_f32 v200, v17, v129
    v_permlane32_swap_b32 v196, v198
    v_fmac_f32 v200, v18, v130
    v_fmac_f32 v200, v19, v131
    v_fmac_f32 v200, v20, v132
    v_fmac_f32 v200, v21, v133
    v_fmac_f32 v200, v22, v134
    v_fmac_f32 v200, v23, v135
    v_add_f32 v198, v196, v198
    v_mul_f32_e64 v202, v24, -v128
    v_fma_f32 v202, v25, -v129, v202
    v_fma_f32 v202, v26, -v130, v202
    v_fma_f32 v202, v27, -v131, v202
    v_fma_f32 v202, v28, -v132, v202
    v_fma_f32 v202, v29, -v133, v202
    v_fma_f32 v202, v30, -v134, v202
    v_fma_f32 v202, v31, -v135, v202
    s_nop 1
    v_permlane32_swap_b32 v200, v202
    v_add_f32 v202, v200, v202
    s_waitcnt lgkmcnt(0)
    v_mfma_f32_32x32x16_bf16 v[56:71], v[72:75], v[176:179], 0
    v_mul_f32 v197, v32, v104
    v_fmac_f32 v197, v33, v105
    v_fmac_f32 v197, v34, v106
    v_fmac_f32 v197, v35, v107
    v_fmac_f32 v197, v36, v108
    v_fmac_f32 v197, v37, v109
    s_add_u32 m0, s21, 2048
    v_mfma_f32_32x32x16_bf16 v[16:31], v[76:79], v[176:179], 0
    s_cbranch_vccnz WL_2_1
    v_mad_u32_u16 v236, v236, s3, v246 op_sel:[1,0,0,0]
    v_mad_u32_u16 v237, v237, s3, v246 op_sel:[1,0,0,0]
    buffer_load_dwordx4 v236, s[4:7], s39 offen  lds
    buffer_load_dwordx4 v237, s[8:11], s39 offen offset:1024  lds
WR_2_1:
    v_fmac_f32 v197, v38, v110
    v_fmac_f32 v197, v39, v111
    v_mul_f32 v199, v40, v136
    v_fmac_f32 v199, v41, v137
    v_fmac_f32 v199, v42, v138
    v_fmac_f32 v199, v43, v139
    v_fmac_f32 v199, v44, v140
    v_fmac_f32 v199, v45, v141
    v_fmac_f32 v199, v46, v142
    v_fmac_f32 v199, v47, v143
    v_mul_f32 v201, v0, v136
    v_fmac_f32 v201, v1, v137
    v_permlane32_swap_b32 v197, v199
    v_fmac_f32 v201, v2, v138
    v_fmac_f32 v201, v3, v139
    v_fmac_f32 v201, v4, v140
    v_fmac_f32 v201, v5, v141
    v_fmac_f32 v201, v6, v142
    v_fmac_f32 v201, v7, v143
    v_add_f32 v199, v197, v199
    v_mul_f32_e64 v203, v8, -v136
    v_fma_f32 v203, v9, -v137, v203
    v_fma_f32 v203, v10, -v138, v203
    v_fma_f32 v203, v11, -v139, v203
    v_fma_f32 v203, v12, -v140, v203
    v_fma_f32 v203, v13, -v141, v203
    v_fma_f32 v203, v14, -v142, v203
    v_fma_f32 v203, v15, -v143, v203
    s_nop 1
    v_permlane32_swap_b32 v201, v203
    v_add_f32 v203, v201, v203
    v_cvt_pk_bf16_f32 v192, v198, v199
    v_cvt_pk_bf16_f32 v193, v202, v203
    v_mfma_f32_32x32x16_bf16 v[32:47], v[72:75], v[180:183], 0
    v_mul_f32 v196, v56, v144
    v_fmac_f32 v196, v57, v145
    v_fmac_f32 v196, v58, v146
    v_fmac_f32 v196, v59, v147
    v_fmac_f32 v196, v60, v148
    v_fmac_f32 v196, v61, v149
    v_mfma_f32_32x32x16_bf16 v[0:15], v[76:79], v[180:183], 0
    s_waitcnt vmcnt(6)
    ds_read_b64_tr_b16 v[176:177], v244 offset:4096
    ds_read_b64_tr_b16 v[178:179], v244 offset:5120
    ds_read_b64_tr_b16 v[180:181], v245 offset:4096
    ds_read_b64_tr_b16 v[182:183], v245 offset:5120
    v_fmac_f32 v196, v62, v150
    v_fmac_f32 v196, v63, v151
    v_mul_f32_e64 v200, v16, -v160
    v_fma_f32 v200, v17, -v161, v200
    v_fma_f32 v200, v18, -v162, v200
    v_fma_f32 v200, v19, -v163, v200
    v_fma_f32 v200, v20, -v164, v200
    v_fma_f32 v200, v21, -v165, v200
    v_fma_f32 v200, v22, -v166, v200
    v_fma_f32 v200, v23, -v167, v200
    v_mul_f32_e64 v202, v24, -v160
    v_fma_f32 v202, v25, -v161, v202
    v_fma_f32 v202, v26, -v162, v202
    v_fma_f32 v202, v27, -v163, v202
    v_fma_f32 v202, v28, -v164, v202
    v_fma_f32 v202, v29, -v165, v202
    v_fma_f32 v202, v30, -v166, v202
    v_fma_f32 v202, v31, -v167, v202
    s_waitcnt lgkmcnt(0)
    v_mfma_f32_32x32x16_bf16 v[16:31], v[72:75], v[176:179], 0
    v_mul_f32 v197, v32, v152
    v_fmac_f32 v197, v33, v153
    v_fmac_f32 v197, v34, v154
    v_fmac_f32 v197, v35, v155
    v_fmac_f32 v197, v36, v156
    v_fmac_f32 v197, v37, v157
    s_add_u32 m0, s21, 4096
    v_mfma_f32_32x32x16_bf16 v[48:63], v[76:79], v[176:179], 0
    s_cbranch_vccnz WL_2_2
    v_mad_u32_u16 v238, v238, s3, v246 op_sel:[1,0,0,0]
    v_mad_u32_u16 v239, v239, s3, v246 op_sel:[1,0,0,0]
    buffer_load_dwordx4 v238, s[4:7], s40 offen  lds
    buffer_load_dwordx4 v239, s[8:11], s40 offen offset:1024  lds
WR_2_2:
    v_fmac_f32 v197, v38, v158
    v_fmac_f32 v197, v39, v159
    v_mul_f32_e64 v201, v0, -v168
    v_fma_f32 v201, v1, -v169, v201
    v_fma_f32 v201, v2, -v170, v201
    v_fma_f32 v201, v3, -v171, v201
    v_fma_f32 v201, v4, -v172, v201
    v_fma_f32 v201, v5, -v173, v201
    v_fma_f32 v201, v6, -v174, v201
    v_fma_f32 v201, v7, -v175, v201
    v_mul_f32_e64 v203, v8, -v168
    v_fma_f32 v203, v9, -v169, v203
    v_fma_f32 v203, v10, -v170, v203
    v_fma_f32 v203, v11, -v171, v203
    v_fma_f32 v203, v12, -v172, v203
    v_fma_f32 v203, v13, -v173, v203
    v_fma_f32 v203, v14, -v174, v203
    v_fma_f32 v203, v15, -v175, v203
    v_mfma_f32_32x32x16_bf16 v[0:15], v[72:75], v[180:183], 0
    v_fmac_f32 v200, v24, v160
    v_fmac_f32 v200, v25, v161
    v_fmac_f32 v200, v26, v162
    v_fmac_f32 v200, v27, v163
    v_fmac_f32 v200, v28, v164
    v_fmac_f32 v200, v29, v165
    v_fmac_f32 v200, v30, v166
    v_fmac_f32 v200, v31, v167
    v_mfma_f32_32x32x16_bf16 v[24:39], v[76:79], v[180:183], 0
    s_waitcnt vmcnt(6)
    ds_read_b64_tr_b16 v[176:177], v244 offset:6144
    ds_read_b64_tr_b16 v[178:179], v244 offset:7168
    ds_read_b64_tr_b16 v[180:181], v245 offset:6144
    ds_read_b64_tr_b16 v[182:183], v245 offset:7168
    v_mul_f32 v254, v16, v144
    v_fmac_f32 v254, v17, v145
    v_fmac_f32 v254, v18, v146
    v_fmac_f32 v254, v19, v147
    v_fmac_f32 v254, v20, v148
    v_fmac_f32 v254, v21, v149
    v_fmac_f32 v254, v22, v150
    v_fmac_f32 v254, v23, v151
    v_sub_f32_e64 v64, -v48, v64
    v_sub_f32_e64 v65, -v49, v65
    v_permlane32_swap_b32 v196, v254
    v_sub_f32_e64 v66, -v50, v66
    v_sub_f32_e64 v67, -v51, v67
    v_sub_f32_e64 v68, -v52, v68
    v_sub_f32_e64 v69, -v53, v69
    v_sub_f32_e64 v70, -v54, v70
    v_sub_f32_e64 v71, -v55, v71
    v_add_f32 v254, v196, v254
    s_waitcnt lgkmcnt(0)
    v_mfma_f32_32x32x16_bf16 v[56:71], v[76:79], v[176:179], v[56:71]
    v_sub_f32_e64 v40, -v24, v40
    v_sub_f32_e64 v41, -v25, v41
    v_sub_f32_e64 v42, -v26, v42
    v_sub_f32_e64 v43, -v27, v43
    v_sub_f32_e64 v44, -v28, v44
    v_sub_f32_e64 v45, -v29, v45
    v_sub_f32_e64 v46, -v30, v46
    v_sub_f32_e64 v47, -v31, v47
    s_add_u32 m0, s21, 6144
    v_mfma_f32_32x32x16_bf16 v[16:31], v[72:75], v[176:179], 0
    s_cbranch_vccnz WL_2_3
    v_mad_u32_u16 v240, v240, s3, v246 op_sel:[1,0,0,0]
    v_mad_u32_u16 v241, v241, s3, v246 op_sel:[1,0,0,0]
    buffer_load_dwordx4 v240, s[4:7], s41 offen  lds
    buffer_load_dwordx4 v241, s[8:11], s41 offen offset:1024  lds
WR_2_3:
    v_mul_f32 v255, v0, v152
    v_fmac_f32 v255, v1, v153
    v_fmac_f32 v255, v2, v154
    v_fmac_f32 v255, v3, v155
    v_fmac_f32 v255, v4, v156
    v_fmac_f32 v255, v5, v157
    v_fmac_f32 v255, v6, v158
    v_fmac_f32 v255, v7, v159
    v_fmac_f32 v201, v8, v168
    v_fmac_f32 v201, v9, v169
    v_permlane32_swap_b32 v197, v255
    v_fmac_f32 v201, v10, v170
    v_fmac_f32 v201, v11, v171
    v_fmac_f32 v201, v12, v172
    v_fmac_f32 v201, v13, v173
    v_fmac_f32 v201, v14, v174
    v_fmac_f32 v201, v15, v175
    v_add_f32 v255, v197, v255
    v_cvt_pk_bf16_f32 v194, v254, v255
    v_mfma_f32_32x32x16_bf16 v[0:15], v[72:75], v[180:183], 0
    v_mul_f32 v254, v16, v144
    v_fmac_f32 v254, v17, v145
    v_fmac_f32 v254, v18, v146
    v_fmac_f32 v254, v19, v147
    v_fmac_f32 v254, v20, v148
    v_fmac_f32 v254, v21, v149
    v_mfma_f32_32x32x16_bf16 v[32:47], v[76:79], v[180:183], v[32:47]
    s_waitcnt vmcnt(6)
    ds_read_b64_tr_b16 v[176:177], v244 offset:0
    ds_read_b64_tr_b16 v[178:179], v244 offset:1024
    ds_read_b64_tr_b16 v[180:181], v245 offset:0
    ds_read_b64_tr_b16 v[182:183], v245 offset:1024
    v_add_u32 v249, s48, v249
    v_add_u32 v250, s49, v250
    ds_read_b32 v252, v251 offset:16
    ds_read_b64_tr_b16 v[72:73], v249 offset:0
    ds_read_b64_tr_b16 v[76:77], v249 offset:64
    ds_read_b64_tr_b16 v[74:75], v249 offset:256
    ds_read_b64_tr_b16 v[78:79], v249 offset:320
    s_mov_b64 exec, s[54:55]
    ds_read_u16_d16_hi v242, v250 offset:0
    s_mov_b64 exec, -1
    v_fmac_f32 v254, v22, v150
    v_fmac_f32 v254, v23, v151
    v_fma_f32 v202, v24, -v160, v202
    v_fma_f32 v202, v25, -v161, v202
    v_permlane32_swap_b32 v254, v200
    v_fma_f32 v202, v26, -v162, v202
    v_fma_f32 v202, v27, -v163, v202
    v_fma_f32 v202, v28, -v164, v202
    v_fma_f32 v202, v29, -v165, v202
    v_fma_f32 v202, v30, -v166, v202
    v_fma_f32 v202, v31, -v167, v202
    v_add_f32 v200, v254, v200
    v_mul_f32_e64 v198, v64, -v112
    v_permlane32_swap_b32 v202, v254
    v_fma_f32 v198, v65, -v113, v198
    v_fma_f32 v198, v66, -v114, v198
    v_fma_f32 v198, v67, -v115, v198
    v_fma_f32 v198, v68, -v116, v198
    v_fma_f32 v198, v69, -v117, v198
    v_fma_f32 v198, v70, -v118, v198
    v_fma_f32 v198, v71, -v119, v198
    v_add_f32 v254, v202, v254
    v_mul_f32 v196, v56, v160
    v_fmac_f32 v196, v57, v161
    v_fmac_f32 v196, v58, v162
    v_fmac_f32 v196, v59, v163
    v_fmac_f32 v196, v60, v164
    v_fmac_f32 v196, v61, v165
    v_fmac_f32 v196, v62, v166
    v_fmac_f32 v196, v63, v167
    s_nop 1
    v_permlane32_swap_b32 v198, v196
    v_add_f32 v196, v198, v196
    s_cbranch_vccnz LEPI_2
    v_mul_f32 v255, v0, v152
    v_fmac_f32 v255, v1, v153
    v_fmac_f32 v255, v2, v154
    v_fmac_f32 v255, v3, v155
    v_fmac_f32 v255, v4, v156
    v_fmac_f32 v255, v5, v157
    v_fmac_f32 v255, v6, v158
    v_fmac_f32 v255, v7, v159
    v_fma_f32 v203, v8, -v168, v203
    v_fma_f32 v203, v9, -v169, v203
    v_permlane32_swap_b32 v255, v201
    v_fma_f32 v203, v10, -v170, v203
    v_fma_f32 v203, v11, -v171, v203
    v_fma_f32 v203, v12, -v172, v203
    v_fma_f32 v203, v13, -v173, v203
    v_fma_f32 v203, v14, -v174, v203
    v_fma_f32 v203, v15, -v175, v203
    v_add_f32 v201, v255, v201
    v_mul_f32_e64 v199, v40, -v120
    v_permlane32_swap_b32 v203, v255
    v_fma_f32 v199, v41, -v121, v199
    v_fma_f32 v199, v42, -v122, v199
    v_fma_f32 v199, v43, -v123, v199
    v_fma_f32 v199, v44, -v124, v199
    v_fma_f32 v199, v45, -v125, v199
    v_fma_f32 v199, v46, -v126, v199
    v_fma_f32 v199, v47, -v127, v199
    v_add_f32 v255, v203, v255
    v_mul_f32 v197, v32, v168
    v_fmac_f32 v197, v33, v169
    v_fmac_f32 v197, v34, v170
    v_fmac_f32 v197, v35, v171
    v_fmac_f32 v197, v36, v172
    v_fmac_f32 v197, v37, v173
    v_fmac_f32 v197, v38, v174
    v_fmac_f32 v197, v39, v175
    s_nop 1
    v_permlane32_swap_b32 v199, v197
    v_add_f32 v197, v199, v197
    v_cvt_pk_bf16_f32 v200, v200, v201
    v_cvt_pk_bf16_f32 v254, v254, v255
    v_cvt_pk_bf16_f32 v196, v196, v197
    ds_write2st64_b32 v253, v192, v193 offset0:0 offset1:1
    ds_write2st64_b32 v253, v194, v200 offset0:2 offset1:3
    ds_write_b32 v253, v196 offset:1024
    s_mov_b64 exec, 0xffffffff
    ds_write_b32 v253, v254 offset:1280
    s_mov_b64 exec, -1
    s_add_u32 s50, s50, 1
    s_cmp_ge_u32 s50, 4
    s_cbranch_scc1 LAST1
    s_waitcnt lgkmcnt(9)
    v_readfirstlane_b32 s66, v252
    s_add_u32 s53, s53, 1
    v_mov_b32 v252, s53
    s_cmp_le_u32 s53, s66
    ds_write2_b32 v251, v252, v252 offset0:0 offset1:8
    s_setprio 1
    s_cbranch_scc1 PRIO_16
    s_setprio 0
PRIO_16:
    s_cmp_eq_u32 s52, 4
    s_cbranch_scc1 ITEM_1_4
    s_cmp_eq_u32 s52, 5
    s_cbranch_scc1 ITEM_1_5
    s_cmp_eq_u32 s52, 3
    s_cbranch_scc1 ITEM_1_3
    s_cmp_eq_u32 s52, 6
    s_cbranch_scc1 ITEM_1_6
    s_cmp_eq_u32 s52, 8
    s_cbranch_scc1 ITEM_1_8
    s_branch ITEM_1_2
WL_2_0:
    s_add_u32 s66, s51, 0
    buffer_load_dword v195, v246, s[16:19], s66 offen
    buffer_load_dword v195, v246, s[16:19], s66 offen
    s_branch WR_2_0
WL_2_1:
    s_add_u32 s66, s51, 4096
    buffer_load_dword v195, v246, s[16:19], s66 offen
    buffer_load_dword v195, v246, s[16:19], s66 offen
    s_branch WR_2_1
WL_2_2:
    s_add_u32 s66, s51, 8192
    buffer_load_dword v195, v246, s[16:19], s66 offen
    buffer_load_dword v195, v246, s[16:19], s66 offen
    s_branch WR_2_2
WL_2_3:
    s_add_u32 s66, s51, 12288
    buffer_load_dword v195, v246, s[16:19], s66 offen
    buffer_load_dword v195, v246, s[16:19], s66 offen
    s_branch WR_2_3
.p2align 6
.p2align 6
LEPI_2:
    s_lshl_b32 s71, s20, 4
    s_add_u32 s67, s51, 4096
    s_add_u32 s68, s51, 8192
    s_add_u32 s69, s51, 12288
    s_add_u32 s70, s51, 16384
    s_waitcnt lgkmcnt(0)
    buffer_load_dwordx4 v[96:99], v246, s[16:19], s51 offen offset:2048 sc1
    s_mov_b32 s52, 163072
    v_bfe_u32 v177, v246, 4, 4
    v_bfe_u32 v179, v246, 4, 3
    v_lshl_add_u32 v180, v177, 3, s52
    v_lshl_add_u32 v190, v177, 4, s52
    v_lshl_add_u32 v181, v179, 3, s52
    ds_read2_b64 v[182:185], v180 offset0:32 offset1:48
    ds_read_b32 v191, v190
    ds_read_b64 v[186:187], v181 offset:512
    v_lshrrev_b32 v178, 8, v246
    buffer_load_dwordx4 v[100:103], v246, s[16:19], s51 offen offset:3072 sc1
    v_add_u32 v234, s21, v248
    v_add_u32 v235, 128, v234
    v_mul_f32 v255, v0, v152
    buffer_load_dwordx4 v[104:107], v246, s[16:19], s67 offen offset:2048 sc1
    v_fmac_f32 v255, v1, v153
    v_fmac_f32 v255, v2, v154
    ds_write2st64_b32 v234, v204, v205 offset0:0 offset1:1
    v_fmac_f32 v255, v3, v155
    buffer_load_dwordx4 v[108:111], v246, s[16:19], s67 offen offset:3072 sc1
    v_fmac_f32 v255, v4, v156
    v_fmac_f32 v255, v5, v157
    ds_write2st64_b32 v234, v206, v207 offset0:2 offset1:3
    v_fmac_f32 v255, v6, v158
    buffer_load_dwordx4 v[128:131], v246, s[16:19], s68 offen offset:2048 sc1
    v_fmac_f32 v255, v7, v159
    v_fma_f32 v203, v8, -v168, v203
    ds_write2st64_b32 v234, v208, v209 offset0:4 offset1:5
    v_fma_f32 v203, v9, -v169, v203
    buffer_load_dwordx4 v[132:135], v246, s[16:19], s68 offen offset:3072 sc1
    v_permlane32_swap_b32 v255, v201
    v_fma_f32 v203, v10, -v170, v203
    ds_write2st64_b32 v235, v210, v211 offset0:6 offset1:7
    v_fma_f32 v203, v11, -v171, v203
    v_fma_f32 v203, v12, -v172, v203
    buffer_load_dwordx4 v[136:139], v246, s[16:19], s69 offen offset:2048 sc1
    v_fma_f32 v203, v13, -v173, v203
    ds_write2st64_b32 v235, v212, v213 offset0:8 offset1:9
    v_fma_f32 v203, v14, -v174, v203
    v_fma_f32 v203, v15, -v175, v203
    buffer_load_dwordx4 v[140:143], v246, s[16:19], s69 offen offset:3072 sc1
    v_add_f32 v201, v255, v201
    ds_write2st64_b32 v235, v214, v215 offset0:10 offset1:11
    v_mul_f32_e64 v199, v40, -v120
    v_permlane32_swap_b32 v203, v255
    buffer_load_dwordx4 v[112:115], v246, s[16:19], s70 offen offset:2048 sc1
    v_fma_f32 v199, v41, -v121, v199
    ds_write2st64_b32 v234, v216, v217 offset0:12 offset1:13
    v_fma_f32 v199, v42, -v122, v199
    v_fma_f32 v199, v43, -v123, v199
    buffer_load_dwordx4 v[116:119], v246, s[16:19], s70 offen offset:3072 sc1
    v_fma_f32 v199, v44, -v124, v199
    ds_write2st64_b32 v234, v218, v219 offset0:14 offset1:15
    v_fma_f32 v199, v45, -v125, v199
    v_fma_f32 v199, v46, -v126, v199
    buffer_load_dwordx4 v[144:147], v246, s[16:19], s51 offen offset:0 sc1
    v_fma_f32 v199, v47, -v127, v199
    v_add_f32 v255, v203, v255
    ds_write2st64_b32 v234, v220, v221 offset0:16 offset1:17
    v_mul_f32 v197, v32, v168
    buffer_load_dwordx4 v[148:151], v246, s[16:19], s51 offen offset:1024 sc1
    v_fmac_f32 v197, v33, v169
    v_fmac_f32 v197, v34, v170
    ds_write2st64_b32 v235, v222, v223 offset0:18 offset1:19
    v_fmac_f32 v197, v35, v171
    buffer_load_dwordx4 v[160:163], v246, s[16:19], s67 offen offset:0 sc1
    v_fmac_f32 v197, v36, v172
    v_fmac_f32 v197, v37, v173
    ds_write2st64_b32 v235, v224, v225 offset0:20 offset1:21
    v_fmac_f32 v197, v38, v174
    buffer_load_dwordx4 v[164:167], v246, s[16:19], s67 offen offset:1024 sc1
    v_fmac_f32 v197, v39, v175
    s_nop 1
    ds_write2st64_b32 v235, v226, v227 offset0:22 offset1:23
    v_permlane32_swap_b32 v199, v197
    ds_write2st64_b32 v234, v228, v229 offset0:24 offset1:25
    v_add_f32 v197, v199, v197
    v_cvt_pk_bf16_f32 v200, v200, v201
    ds_write2st64_b32 v234, v230, v231 offset0:26 offset1:27
    v_cvt_pk_bf16_f32 v254, v254, v255
    v_cvt_pk_bf16_f32 v196, v196, v197
    ds_write2st64_b32 v234, v232, v233 offset0:28 offset1:29
    ds_write2st64_b32 v253, v192, v193 offset0:0 offset1:1
    ds_write2st64_b32 v253, v194, v200 offset0:2 offset1:3
    ds_write_b32 v253, v196 offset:1024
    s_mov_b64 exec, 0xffffffff
    ds_write_b32 v253, v254 offset:1280
    s_mov_b64 exec, -1
    s_add_u32 s50, s53, 1
    v_mov_b32 v234, s50
    ds_write2_b32 v251, v234, v234 offset0:0 offset1:8
    s_waitcnt lgkmcnt(15)
    s_branch TAIL
.p2align 6
LEPI_1:
    s_lshl_b32 s71, s20, 4
    s_add_u32 s67, s51, 4096
    s_add_u32 s68, s51, 8192
    s_add_u32 s69, s51, 12288
    s_add_u32 s70, s51, 16384
    s_waitcnt lgkmcnt(0)
    buffer_load_dwordx4 v[112:115], v246, s[16:19], s70 offen offset:2048 sc1
    s_mov_b32 s52, 163072
    v_bfe_u32 v177, v246, 4, 4
    v_bfe_u32 v179, v246, 4, 3
    v_lshl_add_u32 v180, v177, 3, s52
    v_lshl_add_u32 v190, v177, 4, s52
    v_lshl_add_u32 v181, v179, 3, s52
    ds_read2_b64 v[182:185], v180 offset0:32 offset1:48
    ds_read_b32 v191, v190
    ds_read_b64 v[186:187], v181 offset:512
    v_lshrrev_b32 v178, 8, v246
    buffer_load_dwordx4 v[116:119], v246, s[16:19], s70 offen offset:3072 sc1
    v_add_u32 v234, s21, v248
    v_add_u32 v235, 128, v234
    v_mul_f32 v255, v16, v152
    v_fmac_f32 v255, v17, v153
    buffer_load_dwordx4 v[144:147], v246, s[16:19], s51 offen offset:0 sc1
    v_fmac_f32 v255, v18, v154
    v_fmac_f32 v255, v19, v155
    ds_write2st64_b32 v234, v204, v205 offset0:0 offset1:1
    v_fmac_f32 v255, v20, v156
    v_fmac_f32 v255, v21, v157
    buffer_load_dwordx4 v[148:151], v246, s[16:19], s51 offen offset:1024 sc1
    v_fmac_f32 v255, v22, v158
    v_fmac_f32 v255, v23, v159
    ds_write2st64_b32 v234, v206, v207 offset0:2 offset1:3
    v_fma_f32 v203, v24, -v168, v203
    v_fma_f32 v203, v25, -v169, v203
    v_permlane32_swap_b32 v255, v201
    buffer_load_dwordx4 v[160:163], v246, s[16:19], s67 offen offset:0 sc1
    v_fma_f32 v203, v26, -v170, v203
    v_fma_f32 v203, v27, -v171, v203
    ds_write2st64_b32 v234, v208, v209 offset0:4 offset1:5
    v_fma_f32 v203, v28, -v172, v203
    v_fma_f32 v203, v29, -v173, v203
    buffer_load_dwordx4 v[164:167], v246, s[16:19], s67 offen offset:1024 sc1
    v_fma_f32 v203, v30, -v174, v203
    v_fma_f32 v203, v31, -v175, v203
    ds_write2st64_b32 v235, v210, v211 offset0:6 offset1:7
    v_add_f32 v201, v255, v201
    v_fmac_f32 v199, v32, v120
    ds_write2st64_b32 v235, v212, v213 offset0:8 offset1:9
    v_permlane32_swap_b32 v203, v255
    v_fmac_f32 v199, v33, v121
    v_fmac_f32 v199, v34, v122
    ds_write2st64_b32 v235, v214, v215 offset0:10 offset1:11
    v_fmac_f32 v199, v35, v123
    v_fmac_f32 v199, v36, v124
    ds_write2st64_b32 v234, v216, v217 offset0:12 offset1:13
    v_fmac_f32 v199, v37, v125
    v_fmac_f32 v199, v38, v126
    ds_write2st64_b32 v234, v218, v219 offset0:14 offset1:15
    v_fmac_f32 v199, v39, v127
    v_add_f32 v255, v203, v255
    ds_write2st64_b32 v234, v220, v221 offset0:16 offset1:17
    v_mul_f32 v197, v40, v168
    v_fmac_f32 v197, v41, v169
    ds_write2st64_b32 v235, v222, v223 offset0:18 offset1:19
    v_fmac_f32 v197, v42, v170
    v_fmac_f32 v197, v43, v171
    v_fmac_f32 v197, v44, v172
    ds_write2st64_b32 v235, v224, v225 offset0:20 offset1:21
    v_fmac_f32 v197, v45, v173
    v_fmac_f32 v197, v46, v174
    ds_write2st64_b32 v235, v226, v227 offset0:22 offset1:23
    v_fmac_f32 v197, v47, v175
    s_nop 1
    ds_write2st64_b32 v234, v228, v229 offset0:24 offset1:25
    v_permlane32_swap_b32 v199, v197
    v_add_f32 v197, v199, v197
    ds_write2st64_b32 v234, v230, v231 offset0:26 offset1:27
    v_cvt_pk_bf16_f32 v200, v200, v201
    v_cvt_pk_bf16_f32 v254, v254, v255
    v_cvt_pk_bf16_f32 v196, v196, v197
    ds_write2st64_b32 v234, v232, v233 offset0:28 offset1:29
    ds_write2st64_b32 v253, v200, v196 offset0:3 offset1:4
    s_mov_b64 exec, 0xffffffff
    ds_write_b32 v253, v254 offset:1280
    s_mov_b64 exec, -1
    s_add_u32 s50, s53, 1
    v_mov_b32 v234, s50
    ds_write2_b32 v251, v234, v234 offset0:0 offset1:8
    s_waitcnt lgkmcnt(15)
    s_branch TAIL
.p2align 6
LEPI_0:
    s_lshl_b32 s71, s20, 4
    s_add_u32 s67, s51, 4096
    s_add_u32 s68, s51, 8192
    s_add_u32 s69, s51, 12288
    s_add_u32 s70, s51, 16384
    s_waitcnt lgkmcnt(0)
    buffer_load_dwordx4 v[112:115], v246, s[16:19], s70 offen offset:2048 sc1
    s_mov_b32 s52, 163072
    v_bfe_u32 v177, v246, 4, 4
    v_bfe_u32 v179, v246, 4, 3
    v_lshl_add_u32 v180, v177, 3, s52
    v_lshl_add_u32 v190, v177, 4, s52
    v_lshl_add_u32 v181, v179, 3, s52
    ds_read2_b64 v[182:185], v180 offset0:32 offset1:48
    ds_read_b32 v191, v190
    ds_read_b64 v[186:187], v181 offset:512
    v_lshrrev_b32 v178, 8, v246
    buffer_load_dwordx4 v[116:119], v246, s[16:19], s70 offen offset:3072 sc1
    v_add_u32 v234, s21, v248
    v_add_u32 v235, 128, v234
    v_mul_f32 v255, v0, v152
    v_fmac_f32 v255, v1, v153
    buffer_load_dwordx4 v[144:147], v246, s[16:19], s51 offen offset:0 sc1
    v_fmac_f32 v255, v2, v154
    v_fmac_f32 v255, v3, v155
    ds_write2st64_b32 v234, v204, v205 offset0:0 offset1:1
    v_fmac_f32 v255, v4, v156
    v_fmac_f32 v255, v5, v157
    buffer_load_dwordx4 v[148:151], v246, s[16:19], s51 offen offset:1024 sc1
    v_fmac_f32 v255, v6, v158
    v_fmac_f32 v255, v7, v159
    ds_write2st64_b32 v234, v206, v207 offset0:2 offset1:3
    v_fma_f32 v203, v8, -v168, v203
    v_fma_f32 v203, v9, -v169, v203
    v_permlane32_swap_b32 v255, v201
    buffer_load_dwordx4 v[160:163], v246, s[16:19], s67 offen offset:0 sc1
    v_fma_f32 v203, v10, -v170, v203
    v_fma_f32 v203, v11, -v171, v203
    ds_write2st64_b32 v234, v208, v209 offset0:4 offset1:5
    v_fma_f32 v203, v12, -v172, v203
    v_fma_f32 v203, v13, -v173, v203
    buffer_load_dwordx4 v[164:167], v246, s[16:19], s67 offen offset:1024 sc1
    v_fma_f32 v203, v14, -v174, v203
    v_fma_f32 v203, v15, -v175, v203
    ds_write2st64_b32 v235, v210, v211 offset0:6 offset1:7
    v_add_f32 v201, v255, v201
    v_mul_f32_e64 v199, v40, -v120
    ds_write2st64_b32 v235, v212, v213 offset0:8 offset1:9
    v_permlane32_swap_b32 v203, v255
    v_fma_f32 v199, v41, -v121, v199
    v_fma_f32 v199, v42, -v122, v199
    ds_write2st64_b32 v235, v214, v215 offset0:10 offset1:11
    v_fma_f32 v199, v43, -v123, v199
    v_fma_f32 v199, v44, -v124, v199
    ds_write2st64_b32 v234, v216, v217 offset0:12 offset1:13
    v_fma_f32 v199, v45, -v125, v199
    v_fma_f32 v199, v46, -v126, v199
    ds_write2st64_b32 v234, v218, v219 offset0:14 offset1:15
    v_fma_f32 v199, v47, -v127, v199
    v_add_f32 v255, v203, v255
    ds_write2st64_b32 v234, v220, v221 offset0:16 offset1:17
    v_mul_f32 v197, v32, v168
    v_fmac_f32 v197, v33, v169
    ds_write2st64_b32 v235, v222, v223 offset0:18 offset1:19
    v_fmac_f32 v197, v34, v170
    v_fmac_f32 v197, v35, v171
    v_fmac_f32 v197, v36, v172
    ds_write2st64_b32 v235, v224, v225 offset0:20 offset1:21
    v_fmac_f32 v197, v37, v173
    v_fmac_f32 v197, v38, v174
    ds_write2st64_b32 v235, v226, v227 offset0:22 offset1:23
    v_fmac_f32 v197, v39, v175
    s_nop 1
    ds_write2st64_b32 v234, v228, v229 offset0:24 offset1:25
    v_permlane32_swap_b32 v199, v197
    v_add_f32 v197, v199, v197
    ds_write2st64_b32 v234, v230, v231 offset0:26 offset1:27
    v_cvt_pk_bf16_f32 v200, v200, v201
    v_cvt_pk_bf16_f32 v254, v254, v255
    v_cvt_pk_bf16_f32 v196, v196, v197
    ds_write2st64_b32 v234, v232, v233 offset0:28 offset1:29
    ds_write2st64_b32 v253, v192, v193 offset0:0 offset1:1
    ds_write2st64_b32 v253, v194, v200 offset0:2 offset1:3
    ds_write_b32 v253, v196 offset:1024
    s_mov_b64 exec, 0xffffffff
    ds_write_b32 v253, v254 offset:1280
    s_mov_b64 exec, -1
    s_add_u32 s50, s53, 1
    v_mov_b32 v234, s50
    ds_write2_b32 v251, v234, v234 offset0:0 offset1:8
    s_waitcnt lgkmcnt(15)
TAIL:
    s_and_b32 s71, s20, 3
    s_lshl_b32 s71, s71, 2
    s_bitcmp0_b32 s20, 2
    s_addc_u32 s71, s71, 0
    v_readlane_b32 s71, v191, s71
    buffer_load_dwordx4 v[120:123], v246, s[16:19], s68 offen offset:0 sc1
    buffer_load_dwordx4 v[124:127], v246, s[16:19], s68 offen offset:1024 sc1
    s_cmp_ge_u32 s71, s50
    s_setprio 1
    s_cbranch_scc1 T_second
    s_setprio 0
T_second:
    buffer_load_dwordx4 v[152:155], v246, s[16:19], s69 offen offset:0 sc1
    buffer_load_dwordx4 v[156:159], v246, s[16:19], s69 offen offset:1024 sc1
    buffer_load_dwordx4 v[168:171], v246, s[16:19], s70 offen offset:0 sc1
    buffer_load_dwordx4 v[172:175], v246, s[16:19], s70 offen offset:1024 sc1
GEMM:
    v_cmp_gt_u32 vcc, s53, v191
    v_xor_b32 v180, v179, v178
    v_xor_b32 v188, 4, v180
    v_lshl_add_u32 v66, v180, 4, v183
    v_lshl_add_u32 v67, v188, 4, v183
    v_lshl_add_u32 v70, v180, 4, v185
    v_lshl_add_u32 v71, v188, 4, v185
    s_mov_b32 s4, s72
    s_and_b32 s5, s73, 0xffff
    s_mov_b32 s6, 10240000
    s_mov_b32 s7, 0x20000
    s_cbranch_vccnz T_pw
T_pwr:
    ds_read_b128 v[76:79], v66 offset:0
    ds_read_b128 v[80:83], v70 offset:0
    ds_read_b128 v[84:87], v67 offset:0
    ds_read_b128 v[88:91], v71 offset:0
    ds_read_b128 v[92:95], v66 offset:1024
    s_waitcnt vmcnt(19) lgkmcnt(4)
    v_mfma_f32_16x16x32_bf16 v[0:3], v[96:99], v[76:79], 0
    v_and_b32 v181, 8, v177
    v_add_u32 v189, v188, v181
    ds_read_b128 v[76:79], v70 offset:1024
    s_waitcnt lgkmcnt(4)
    v_mfma_f32_16x16x32_bf16 v[4:7], v[96:99], v[80:83], 0
    v_add_u32 v181, v180, v181
    v_lshl_add_u32 v64, v180, 4, v182
    ds_read_b128 v[80:83], v67 offset:1024
    s_waitcnt vmcnt(18) lgkmcnt(4)
    v_mfma_f32_16x16x32_bf16 v[0:3], v[100:103], v[84:87], v[0:3]
    v_lshl_add_u32 v65, v188, 4, v182
    v_lshl_add_u32 v68, v180, 4, v184
    ds_read_b128 v[84:87], v71 offset:1024
    s_waitcnt lgkmcnt(4)
    v_mfma_f32_16x16x32_bf16 v[4:7], v[100:103], v[88:91], v[4:7]
    v_lshl_add_u32 v69, v188, 4, v184
    v_lshl_add_u32 v72, v181, 4, v186
    ds_read_b128 v[88:91], v66 offset:128
    s_waitcnt vmcnt(17) lgkmcnt(4)
    v_mfma_f32_16x16x32_bf16 v[0:3], v[104:107], v[92:95], v[0:3]
    v_lshl_add_u32 v73, v189, 4, v186
    v_lshl_add_u32 v74, v181, 4, v187
    ds_read_b128 v[92:95], v66 offset:256
    s_waitcnt lgkmcnt(4)
    v_mfma_f32_16x16x32_bf16 v[4:7], v[104:107], v[76:79], v[4:7]
    v_lshl_add_u32 v75, v189, 4, v187
    s_mov_b32 s67, 0xbfb8aa3b
    ds_read_b128 v[76:79], v66 offset:384
    s_waitcnt vmcnt(16) lgkmcnt(4)
    v_mfma_f32_16x16x32_bf16 v[0:3], v[108:111], v[80:83], v[0:3]
    v_lshrrev_b32 v205, 1, v178
    v_lshl_add_u32 v205, s20, 1, v205
    ds_read_b128 v[80:83], v70 offset:128
    s_waitcnt lgkmcnt(4)
    v_mfma_f32_16x16x32_bf16 v[4:7], v[108:111], v[84:87], v[4:7]
    v_xor_b32 v205, v205, v179
    v_and_b32 v204, 1, v178
    ds_read_b128 v[84:87], v70 offset:256
    s_waitcnt vmcnt(15) lgkmcnt(4)
    v_mfma_f32_16x16x32_bf16 v[12:15], v[128:131], v[88:91], 0
    v_lshlrev_b32 v204, 3, v204
    v_lshl_add_u32 v205, v205, 4, v204
    ds_read_b128 v[88:91], v70 offset:384
    s_waitcnt lgkmcnt(4)
    v_mfma_f32_16x16x32_bf16 v[24:27], v[128:131], v[92:95], 0
    v_and_b32 v220, 8, v177
    v_lshl_add_u32 v204, v220, 4, v205
    ds_read_b128 v[92:95], v67 offset:128
    s_waitcnt lgkmcnt(4)
    v_mfma_f32_16x16x32_bf16 v[36:39], v[128:131], v[76:79], 0
    v_lshl_add_u32 v204, v177, 10, v204
    v_add_u32 v204, 65536, v204
    ds_read_b128 v[76:79], v67 offset:256
    s_waitcnt lgkmcnt(4)
    v_mfma_f32_16x16x32_bf16 v[16:19], v[128:131], v[80:83], 0
    v_add_u32 v205, v205, v182
    v_mul_u32_u24 v220, 1008, v220
    ds_read_b128 v[80:83], v67 offset:384
    s_waitcnt lgkmcnt(4)
    v_mfma_f32_16x16x32_bf16 v[28:31], v[128:131], v[84:87], 0
    v_sub_u32 v220, v204, v220
    s_lshl_b32 s70, s20, 4
    ds_read_b128 v[84:87], v71 offset:128
    s_waitcnt lgkmcnt(4)
    v_mfma_f32_16x16x32_bf16 v[40:43], v[128:131], v[88:91], 0
    v_xor_b32 v206, s70, v246
    s_lshl_b32 s70, s20, 10
    ds_read_b128 v[88:91], v71 offset:256
    s_waitcnt vmcnt(14) lgkmcnt(4)
    v_mfma_f32_16x16x32_bf16 v[12:15], v[132:135], v[92:95], v[12:15]
    s_add_u32 s70, s70, 65536
    v_add_u32 v207, s21, v206
    ds_read_b128 v[92:95], v71 offset:384
    s_waitcnt lgkmcnt(4)
    v_mfma_f32_16x16x32_bf16 v[24:27], v[132:135], v[76:79], v[24:27]
    v_add_u32 v206, s70, v206
    s_mul_i32 s66, s2, 40960
    ds_read_b128 v[76:79], v66 offset:512
    s_waitcnt lgkmcnt(4)
    v_mfma_f32_16x16x32_bf16 v[36:39], v[132:135], v[80:83], v[36:39]
    s_bfe_u32 s22, s22, 393237
    s_lshl_b32 s22, s22, 10
    ds_read_b128 v[80:83], v66 offset:640
    s_waitcnt lgkmcnt(4)
    v_mfma_f32_16x16x32_bf16 v[16:19], v[132:135], v[84:87], v[16:19]
    s_add_u32 s22, s22, s66
    s_bfe_u32 s23, s23, 393237
    ds_read_b128 v[84:87], v66 offset:768
    s_waitcnt lgkmcnt(4)
    v_mfma_f32_16x16x32_bf16 v[28:31], v[132:135], v[88:91], v[28:31]
    s_lshl_b32 s23, s23, 10
    s_add_u32 s23, s23, s66
    ds_read_b128 v[88:91], v70 offset:512
    s_waitcnt lgkmcnt(4)
    v_mfma_f32_16x16x32_bf16 v[40:43], v[132:135], v[92:95], v[40:43]
    s_bfe_u32 s24, s24, 393237
    s_lshl_b32 s24, s24, 10
    ds_read_b128 v[92:95], v70 offset:640
    s_waitcnt vmcnt(13) lgkmcnt(4)
    v_mfma_f32_16x16x32_bf16 v[12:15], v[136:139], v[76:79], v[12:15]
    s_add_u32 s24, s24, s66
    s_bfe_u32 s25, s25, 393237
    ds_read_b128 v[76:79], v70 offset:768
    s_waitcnt lgkmcnt(4)
    v_mfma_f32_16x16x32_bf16 v[24:27], v[136:139], v[80:83], v[24:27]
    s_lshl_b32 s25, s25, 10
    s_add_u32 s25, s25, s66
    ds_read_b128 v[80:83], v67 offset:512
    s_waitcnt lgkmcnt(4)
    v_mfma_f32_16x16x32_bf16 v[36:39], v[136:139], v[84:87], v[36:39]
    s_bfe_u32 s26, s26, 393237
    s_lshl_b32 s26, s26, 10
    ds_read_b128 v[84:87], v67 offset:640
    s_waitcnt lgkmcnt(4)
    v_mfma_f32_16x16x32_bf16 v[16:19], v[136:139], v[88:91], v[16:19]
    s_add_u32 s26, s26, s66
    ds_read_b128 v[88:91], v67 offset:768
    s_waitcnt lgkmcnt(4)
    v_mfma_f32_16x16x32_bf16 v[28:31], v[136:139], v[92:95], v[28:31]
    ds_read_b128 v[92:95], v71 offset:512
    s_waitcnt lgkmcnt(4)
    v_mfma_f32_16x16x32_bf16 v[40:43], v[136:139], v[76:79], v[40:43]
    ds_read_b128 v[76:79], v71 offset:640
    s_waitcnt vmcnt(12) lgkmcnt(4)
    v_mfma_f32_16x16x32_bf16 v[12:15], v[140:143], v[80:83], v[12:15]
    ds_read_b128 v[80:83], v71 offset:768
    s_waitcnt lgkmcnt(4)
    v_mfma_f32_16x16x32_bf16 v[24:27], v[140:143], v[84:87], v[24:27]
    ds_read_b128 v[84:87], v66 offset:1152
    s_waitcnt lgkmcnt(4)
    v_mfma_f32_16x16x32_bf16 v[36:39], v[140:143], v[88:91], v[36:39]
    ds_read_b128 v[88:91], v66 offset:1280
    s_waitcnt lgkmcnt(4)
    v_mfma_f32_16x16x32_bf16 v[16:19], v[140:143], v[92:95], v[16:19]
    ds_read_b128 v[92:95], v66 offset:896
    s_waitcnt lgkmcnt(4)
    v_mfma_f32_16x16x32_bf16 v[28:31], v[140:143], v[76:79], v[28:31]
    ds_read_b128 v[76:79], v70 offset:1152
    s_waitcnt lgkmcnt(4)
    v_mfma_f32_16x16x32_bf16 v[40:43], v[140:143], v[80:83], v[40:43]
    ds_read_b128 v[80:83], v70 offset:1280
    s_waitcnt vmcnt(11) lgkmcnt(4)
    v_mfma_f32_16x16x32_bf16 v[12:15], v[112:115], v[84:87], v[12:15]
    ds_read_b128 v[84:87], v70 offset:896
    s_waitcnt lgkmcnt(4)
    v_mfma_f32_16x16x32_bf16 v[24:27], v[112:115], v[88:91], v[24:27]
    ds_read_b128 v[88:91], v67 offset:1152
    s_waitcnt lgkmcnt(4)
    v_mfma_f32_16x16x32_bf16 v[36:39], v[112:115], v[92:95], v[36:39]
    ds_read_b128 v[92:95], v67 offset:1280
    s_waitcnt lgkmcnt(4)
    v_mfma_f32_16x16x32_bf16 v[16:19], v[112:115], v[76:79], v[16:19]
    ds_read_b128 v[76:79], v67 offset:896
    s_waitcnt lgkmcnt(4)
    v_mfma_f32_16x16x32_bf16 v[28:31], v[112:115], v[80:83], v[28:31]
    ds_read_b32 v191, v190
    ds_read_b128 v[80:83], v71 offset:1152
    s_waitcnt lgkmcnt(5)
    v_mfma_f32_16x16x32_bf16 v[40:43], v[112:115], v[84:87], v[40:43]
    ds_read_b128 v[84:87], v71 offset:1280
    s_waitcnt vmcnt(10) lgkmcnt(5)
    v_mfma_f32_16x16x32_bf16 v[12:15], v[116:119], v[88:91], v[12:15]
    ds_read_b128 v[88:91], v71 offset:896
    s_waitcnt lgkmcnt(5)
    v_mfma_f32_16x16x32_bf16 v[24:27], v[116:119], v[92:95], v[24:27]
    s_waitcnt lgkmcnt(3)
    v_cmp_gt_u32 vcc, s50, v191
    s_cbranch_vccnz T_aw
T_awr:
    ds_read_b128 v[92:95], v64 offset:0
    v_mfma_f32_16x16x32_bf16 v[36:39], v[116:119], v[76:79], v[36:39]
    ds_read_b128 v[76:79], v68 offset:0
    s_waitcnt lgkmcnt(4)
    v_mfma_f32_16x16x32_bf16 v[16:19], v[116:119], v[80:83], v[16:19]
    ds_read_b128 v[80:83], v65 offset:0
    s_waitcnt lgkmcnt(4)
    v_mfma_f32_16x16x32_bf16 v[28:31], v[116:119], v[84:87], v[28:31]
    ds_read_b128 v[84:87], v69 offset:0
    s_waitcnt lgkmcnt(4)
    v_mfma_f32_16x16x32_bf16 v[40:43], v[116:119], v[88:91], v[40:43]
    ds_read_b128 v[88:91], v64 offset:1024
    s_waitcnt vmcnt(9) lgkmcnt(4)
    v_mfma_f32_16x16x32_bf16 v[0:3], v[144:147], v[92:95], v[0:3]
    ds_read_b128 v[92:95], v68 offset:1024
    s_waitcnt lgkmcnt(4)
    v_mfma_f32_16x16x32_bf16 v[4:7], v[144:147], v[76:79], v[4:7]
    ds_read_b128 v[76:79], v65 offset:1024
    s_waitcnt vmcnt(8) lgkmcnt(4)
    v_mfma_f32_16x16x32_bf16 v[0:3], v[148:151], v[80:83], v[0:3]
    ds_read_b128 v[80:83], v69 offset:1024
    s_waitcnt lgkmcnt(4)
    v_mfma_f32_16x16x32_bf16 v[4:7], v[148:151], v[84:87], v[4:7]
    ds_read_b128 v[84:87], v72 offset:0
    s_waitcnt vmcnt(7) lgkmcnt(4)
    v_mfma_f32_16x16x32_bf16 v[0:3], v[160:163], v[88:91], v[0:3]
    ds_read_b128 v[88:91], v73 offset:0
    s_waitcnt lgkmcnt(4)
    v_mfma_f32_16x16x32_bf16 v[4:7], v[160:163], v[92:95], v[4:7]
    ds_read_b128 v[92:95], v74 offset:0
    s_waitcnt vmcnt(6) lgkmcnt(4)
    v_mfma_f32_16x16x32_bf16 v[0:3], v[164:167], v[76:79], v[0:3]
    ds_read_b128 v[76:79], v75 offset:0
    s_waitcnt lgkmcnt(4)
    v_mfma_f32_16x16x32_bf16 v[4:7], v[164:167], v[80:83], v[4:7]
    ds_read_b128 v[80:83], v72 offset:1024
    s_waitcnt lgkmcnt(4)
    v_mfma_f32_16x16x32_bf16 v[8:11], v[144:147], v[84:87], 0
    ds_read_b128 v[84:87], v73 offset:1024
    s_waitcnt lgkmcnt(4)
    v_mfma_f32_16x16x32_bf16 v[8:11], v[148:151], v[88:91], v[8:11]
    v_mul_f32 v192, s67, v0
    v_mul_f32 v193, s67, v1
    ds_read_b128 v[88:91], v74 offset:1024
    s_waitcnt lgkmcnt(4)
    v_mfma_f32_16x16x32_bf16 v[8:11], v[96:99], v[92:95], v[8:11]
    v_mul_f32 v194, s67, v2
    v_mul_f32 v195, s67, v3
    ds_read_b128 v[92:95], v75 offset:1024
    s_waitcnt lgkmcnt(4)
    v_mfma_f32_16x16x32_bf16 v[8:11], v[100:103], v[76:79], v[8:11]
    v_exp_f32 v192, v192
    v_exp_f32 v193, v193
    ds_read_b128 v[76:79], v64 offset:128
    s_waitcnt lgkmcnt(4)
    v_mfma_f32_16x16x32_bf16 v[8:11], v[160:163], v[80:83], v[8:11]
    v_exp_f32 v194, v194
    v_exp_f32 v195, v195
    ds_read_b128 v[80:83], v65 offset:128
    s_waitcnt lgkmcnt(4)
    v_mfma_f32_16x16x32_bf16 v[8:11], v[164:167], v[84:87], v[8:11]
    v_add_f32 v192, 1.0, v192
    v_add_f32 v193, 1.0, v193
    ds_read_b128 v[84:87], v64 offset:512
    s_waitcnt lgkmcnt(4)
    v_mfma_f32_16x16x32_bf16 v[8:11], v[104:107], v[88:91], v[8:11]
    v_add_f32 v194, 1.0, v194
    v_add_f32 v195, 1.0, v195
    ds_read_b128 v[88:91], v65 offset:512
    s_waitcnt lgkmcnt(4)
    v_mfma_f32_16x16x32_bf16 v[8:11], v[108:111], v[92:95], v[8:11]
    v_rcp_f32 v192, v192
    v_rcp_f32 v193, v193
    ds_read_b128 v[92:95], v64 offset:1152
    s_waitcnt vmcnt(5) lgkmcnt(4)
    v_mfma_f32_16x16x32_bf16 v[12:15], v[120:123], v[76:79], v[12:15]
    v_rcp_f32 v194, v194
    v_rcp_f32 v195, v195
    ds_read_b128 v[76:79], v65 offset:1152
    s_waitcnt vmcnt(4) lgkmcnt(4)
    v_mfma_f32_16x16x32_bf16 v[12:15], v[124:127], v[80:83], v[12:15]
    v_cvt_pk_bf16_f32 v0, v0, v1
    v_cvt_pk_bf16_f32 v1, v2, v3
    ds_read_b128 v[80:83], v64 offset:256
    s_waitcnt vmcnt(3) lgkmcnt(4)
    v_mfma_f32_16x16x32_bf16 v[12:15], v[152:155], v[84:87], v[12:15]
    ds_write_b64 v204, v[0:1] offset:0
    v_mul_f32 v196, s67, v4
    ds_read_b128 v[84:87], v65 offset:256
    s_waitcnt vmcnt(2) lgkmcnt(5)
    v_mfma_f32_16x16x32_bf16 v[12:15], v[156:159], v[88:91], v[12:15]
    v_mul_f32 v197, s67, v5
    v_mul_f32 v198, s67, v6
    ds_read_b128 v[88:91], v64 offset:640
    s_waitcnt vmcnt(1) lgkmcnt(5)
    v_mfma_f32_16x16x32_bf16 v[12:15], v[168:171], v[92:95], v[12:15]
    v_mul_f32 v199, s67, v7
    v_exp_f32 v196, v196
    ds_read_b128 v[92:95], v65 offset:640
    s_waitcnt vmcnt(0) lgkmcnt(5)
    v_mfma_f32_16x16x32_bf16 v[12:15], v[172:175], v[76:79], v[12:15]
    v_exp_f32 v197, v197
    v_exp_f32 v198, v198
    ds_read_b128 v[76:79], v64 offset:1280
    s_waitcnt lgkmcnt(5)
    v_mfma_f32_16x16x32_bf16 v[24:27], v[120:123], v[80:83], v[24:27]
    v_exp_f32 v199, v199
    v_add_f32 v196, 1.0, v196
    ds_read_b128 v[80:83], v65 offset:1280
    s_waitcnt lgkmcnt(4)
    v_mfma_f32_16x16x32_bf16 v[24:27], v[124:127], v[84:87], v[24:27]
    v_mul_f32 v12, v12, v192
    v_mul_f32 v13, v13, v193
    ds_read_b128 v[84:87], v64 offset:384
    s_waitcnt lgkmcnt(4)
    v_mfma_f32_16x16x32_bf16 v[24:27], v[152:155], v[88:91], v[24:27]
    v_mul_f32 v14, v14, v194
    v_mul_f32 v15, v15, v195
    ds_read_b128 v[88:91], v65 offset:384
    s_waitcnt lgkmcnt(4)
    v_mfma_f32_16x16x32_bf16 v[24:27], v[156:159], v[92:95], v[24:27]
    v_cvt_pk_bf16_f32 v12, v12, v13
    v_cvt_pk_bf16_f32 v13, v14, v15
    ds_read_b128 v[92:95], v64 offset:768
    s_waitcnt lgkmcnt(4)
    v_mfma_f32_16x16x32_bf16 v[24:27], v[168:171], v[76:79], v[24:27]
    ds_write_b64 v204, v[12:13] offset:256
    v_add_f32 v197, 1.0, v197
    ds_read_b128 v[76:79], v65 offset:768
    s_waitcnt lgkmcnt(5)
    v_mfma_f32_16x16x32_bf16 v[24:27], v[172:175], v[80:83], v[24:27]
    v_add_f32 v198, 1.0, v198
    v_add_f32 v199, 1.0, v199
    ds_read_b128 v[80:83], v64 offset:896
    s_waitcnt lgkmcnt(5)
    v_mfma_f32_16x16x32_bf16 v[36:39], v[120:123], v[84:87], v[36:39]
    v_rcp_f32 v196, v196
    v_rcp_f32 v197, v197
    ds_read_b128 v[84:87], v65 offset:896
    s_waitcnt lgkmcnt(5)
    v_mfma_f32_16x16x32_bf16 v[36:39], v[124:127], v[88:91], v[36:39]
    v_rcp_f32 v198, v198
    v_rcp_f32 v199, v199
    ds_read_b128 v[88:91], v68 offset:128
    s_waitcnt lgkmcnt(5)
    v_mfma_f32_16x16x32_bf16 v[36:39], v[152:155], v[92:95], v[36:39]
    v_mul_f32 v24, v24, v192
    v_mul_f32 v25, v25, v193
    ds_read_b128 v[92:95], v69 offset:128
    s_waitcnt lgkmcnt(4)
    v_mfma_f32_16x16x32_bf16 v[36:39], v[156:159], v[76:79], v[36:39]
    v_mul_f32 v26, v26, v194
    v_mul_f32 v27, v27, v195
    ds_read_b128 v[76:79], v68 offset:512
    s_waitcnt lgkmcnt(4)
    v_mfma_f32_16x16x32_bf16 v[36:39], v[168:171], v[80:83], v[36:39]
    v_cvt_pk_bf16_f32 v24, v24, v25
    v_cvt_pk_bf16_f32 v25, v26, v27
    ds_read_b128 v[80:83], v69 offset:512
    s_waitcnt lgkmcnt(4)
    v_mfma_f32_16x16x32_bf16 v[36:39], v[172:175], v[84:87], v[36:39]
    ds_write_b64 v204, v[24:25] offset:512
    v_mul_f32 v200, s67, v8
    ds_read_b128 v[84:87], v68 offset:1152
    s_waitcnt lgkmcnt(5)
    v_mfma_f32_16x16x32_bf16 v[16:19], v[120:123], v[88:91], v[16:19]
    v_mul_f32 v201, s67, v9
    v_mul_f32 v202, s67, v10
    ds_read_b128 v[88:91], v69 offset:1152
    s_waitcnt lgkmcnt(5)
    v_mfma_f32_16x16x32_bf16 v[16:19], v[124:127], v[92:95], v[16:19]
    v_mul_f32 v203, s67, v11
    v_exp_f32 v200, v200
    ds_read_b128 v[92:95], v68 offset:256
    s_waitcnt lgkmcnt(5)
    v_mfma_f32_16x16x32_bf16 v[16:19], v[152:155], v[76:79], v[16:19]
    v_mul_f32 v36, v36, v192
    v_mul_f32 v37, v37, v193
    ds_read_b128 v[76:79], v69 offset:256
    s_waitcnt lgkmcnt(5)
    v_mfma_f32_16x16x32_bf16 v[16:19], v[156:159], v[80:83], v[16:19]
    v_mul_f32 v38, v38, v194
    v_mul_f32 v39, v39, v195
    ds_read_b128 v[80:83], v68 offset:640
    s_waitcnt lgkmcnt(4)
    v_mfma_f32_16x16x32_bf16 v[16:19], v[168:171], v[84:87], v[16:19]
    v_cvt_pk_bf16_f32 v36, v36, v37
    v_cvt_pk_bf16_f32 v37, v38, v39
    ds_read_b128 v[84:87], v69 offset:640
    s_waitcnt lgkmcnt(4)
    v_mfma_f32_16x16x32_bf16 v[16:19], v[172:175], v[88:91], v[16:19]
    ds_write_b64 v204, v[36:37] offset:768
    v_exp_f32 v201, v201
    ds_read_b128 v[88:91], v68 offset:1280
    s_waitcnt lgkmcnt(5)
    v_mfma_f32_16x16x32_bf16 v[28:31], v[120:123], v[92:95], v[28:31]
    v_exp_f32 v202, v202
    v_exp_f32 v203, v203
    ds_read_b128 v[92:95], v69 offset:1280
    s_waitcnt lgkmcnt(5)
    v_mfma_f32_16x16x32_bf16 v[28:31], v[124:127], v[76:79], v[28:31]
    v_add_f32 v200, 1.0, v200
    v_add_f32 v201, 1.0, v201
    ds_read_b128 v[76:79], v68 offset:384
    s_waitcnt lgkmcnt(5)
    v_mfma_f32_16x16x32_bf16 v[28:31], v[152:155], v[80:83], v[28:31]
    v_add_f32 v202, 1.0, v202
    v_add_f32 v203, 1.0, v203
    ds_read_b128 v[80:83], v69 offset:384
    s_waitcnt lgkmcnt(5)
    v_mfma_f32_16x16x32_bf16 v[28:31], v[156:159], v[84:87], v[28:31]
    v_rcp_f32 v200, v200
    v_rcp_f32 v201, v201
    ds_read_b128 v[84:87], v68 offset:768
    s_waitcnt lgkmcnt(4)
    v_mfma_f32_16x16x32_bf16 v[28:31], v[168:171], v[88:91], v[28:31]
    v_rcp_f32 v202, v202
    v_rcp_f32 v203, v203
    ds_read_b128 v[88:91], v69 offset:768
    s_waitcnt lgkmcnt(4)
    v_mfma_f32_16x16x32_bf16 v[28:31], v[172:175], v[92:95], v[28:31]
    v_mov_b32_dpp v200, v200 row_ror:8 row_mask:0xf bank_mask:0xc
    ds_read_b128 v[92:95], v68 offset:896
    s_waitcnt lgkmcnt(4)
    v_mfma_f32_16x16x32_bf16 v[40:43], v[120:123], v[76:79], v[40:43]
    v_mov_b32_dpp v201, v201 row_ror:8 row_mask:0xf bank_mask:0xc
    v_mov_b32_dpp v202, v202 row_ror:8 row_mask:0xf bank_mask:0xc
    ds_read_b128 v[76:79], v69 offset:896
    s_waitcnt lgkmcnt(4)
    v_mfma_f32_16x16x32_bf16 v[40:43], v[124:127], v[80:83], v[40:43]
    v_mov_b32_dpp v203, v203 row_ror:8 row_mask:0xf bank_mask:0xc
    ds_read_b128 v[80:83], v72 offset:128
    s_waitcnt lgkmcnt(4)
    v_mfma_f32_16x16x32_bf16 v[40:43], v[152:155], v[84:87], v[40:43]
    s_barrier
    ds_read_b128 v[212:215], v206 offset:0
    ds_read_b128 v[84:87], v73 offset:128
    s_waitcnt lgkmcnt(5)
    v_mfma_f32_16x16x32_bf16 v[40:43], v[156:159], v[88:91], v[40:43]
    ds_read_b128 v[216:219], v206 offset:8320
    v_cvt_pk_bf16_f32 v4, v4, v5
    ds_read_b128 v[88:91], v74 offset:128
    s_waitcnt lgkmcnt(6)
    v_mfma_f32_16x16x32_bf16 v[40:43], v[168:171], v[92:95], v[40:43]
    v_cvt_pk_bf16_f32 v5, v6, v7
    ds_write_b64 v205, v[4:5] offset:0
    ds_read_b128 v[92:95], v75 offset:128
    s_waitcnt lgkmcnt(7)
    v_mfma_f32_16x16x32_bf16 v[40:43], v[172:175], v[76:79], v[40:43]
    v_mul_f32 v16, v16, v196
    v_mul_f32 v17, v17, v197
    ds_read_b128 v[76:79], v72 offset:512
    s_waitcnt lgkmcnt(7)
    v_mfma_f32_16x16x32_bf16 v[20:23], v[120:123], v[80:83], 0
    v_mul_f32 v18, v18, v198
    v_mul_f32 v19, v19, v199
    ds_read_b128 v[80:83], v73 offset:512
    s_waitcnt lgkmcnt(6)
    v_mfma_f32_16x16x32_bf16 v[20:23], v[124:127], v[84:87], v[20:23]
    v_cvt_pk_bf16_f32 v16, v16, v17
    v_cvt_pk_bf16_f32 v17, v18, v19
    ds_read_b128 v[84:87], v74 offset:512
    s_waitcnt lgkmcnt(5)
    v_mfma_f32_16x16x32_bf16 v[20:23], v[128:131], v[88:91], v[20:23]
    ds_write_b64 v205, v[16:17] offset:256
    ds_read_b128 v[88:91], v75 offset:512
    s_waitcnt lgkmcnt(5)
    v_mfma_f32_16x16x32_bf16 v[20:23], v[132:135], v[92:95], v[20:23]
    buffer_store_dwordx4 v[212:215], v246, s[4:7], s22 offen sc1
    ds_read_b128 v[92:95], v72 offset:1152
    s_waitcnt lgkmcnt(5)
    v_mfma_f32_16x16x32_bf16 v[20:23], v[152:155], v[76:79], v[20:23]
    buffer_store_dwordx4 v[216:219], v246, s[4:7], s23 offen sc1
    v_mul_f32 v28, v28, v196
    ds_read_b128 v[76:79], v73 offset:1152
    s_waitcnt lgkmcnt(5)
    v_mfma_f32_16x16x32_bf16 v[20:23], v[156:159], v[80:83], v[20:23]
    v_mul_f32 v29, v29, v197
    v_mul_f32 v30, v30, v198
    ds_read_b128 v[80:83], v74 offset:1152
    s_waitcnt lgkmcnt(5)
    v_mfma_f32_16x16x32_bf16 v[20:23], v[136:139], v[84:87], v[20:23]
    v_mul_f32 v31, v31, v199
    v_cvt_pk_bf16_f32 v28, v28, v29
    ds_read_b128 v[84:87], v75 offset:1152
    s_waitcnt lgkmcnt(4)
    v_mfma_f32_16x16x32_bf16 v[20:23], v[140:143], v[88:91], v[20:23]
    v_cvt_pk_bf16_f32 v29, v30, v31
    ds_write_b64 v205, v[28:29] offset:512
    ds_read_b128 v[88:91], v72 offset:384
    s_waitcnt lgkmcnt(5)
    v_mfma_f32_16x16x32_bf16 v[20:23], v[168:171], v[92:95], v[20:23]
    v_mul_f32 v40, v40, v196
    v_mul_f32 v41, v41, v197
    ds_read_b128 v[92:95], v73 offset:384
    s_waitcnt lgkmcnt(5)
    v_mfma_f32_16x16x32_bf16 v[20:23], v[172:175], v[76:79], v[20:23]
    v_mul_f32 v42, v42, v198
    v_mul_f32 v43, v43, v199
    ds_read_b128 v[76:79], v74 offset:384
    s_waitcnt lgkmcnt(5)
    v_mfma_f32_16x16x32_bf16 v[20:23], v[112:115], v[80:83], v[20:23]
    v_cvt_pk_bf16_f32 v40, v40, v41
    v_cvt_pk_bf16_f32 v41, v42, v43
    ds_read_b128 v[80:83], v75 offset:384
    s_waitcnt lgkmcnt(5)
    v_mfma_f32_16x16x32_bf16 v[20:23], v[116:119], v[84:87], v[20:23]
    ds_write_b64 v205, v[40:41] offset:768
    ds_read_b128 v[84:87], v72 offset:768
    s_waitcnt lgkmcnt(5)
    v_mfma_f32_16x16x32_bf16 v[44:47], v[120:123], v[88:91], 0
    ds_read_b128 v[88:91], v73 offset:768
    s_waitcnt lgkmcnt(5)
    v_mfma_f32_16x16x32_bf16 v[44:47], v[124:127], v[92:95], v[44:47]
    s_waitcnt lgkmcnt(2)
    s_barrier
    ds_read_b128 v[92:95], v74 offset:768
    v_mfma_f32_16x16x32_bf16 v[44:47], v[128:131], v[76:79], v[44:47]
    ds_read_b128 v[212:215], v207 offset:0
    ds_read_b128 v[216:219], v207 offset:1664
    ds_read_b128 v[76:79], v75 offset:768
    v_mfma_f32_16x16x32_bf16 v[44:47], v[132:135], v[80:83], v[44:47]
    ds_read_b128 v[80:83], v72 offset:896
    s_waitcnt lgkmcnt(6)
    v_mfma_f32_16x16x32_bf16 v[44:47], v[152:155], v[84:87], v[44:47]
    ds_read_b128 v[84:87], v73 offset:896
    s_waitcnt lgkmcnt(6)
    v_mfma_f32_16x16x32_bf16 v[44:47], v[156:159], v[88:91], v[44:47]
    ds_read_b128 v[88:91], v74 offset:896
    s_waitcnt lgkmcnt(6)
    v_mfma_f32_16x16x32_bf16 v[44:47], v[136:139], v[92:95], v[44:47]
    s_waitcnt lgkmcnt(5)
    buffer_store_dwordx4 v[212:215], v246, s[4:7], s24 offen sc1
    ds_read_b128 v[92:95], v75 offset:896
    s_waitcnt lgkmcnt(4)
    v_mfma_f32_16x16x32_bf16 v[44:47], v[140:143], v[76:79], v[44:47]
    buffer_store_dwordx4 v[216:219], v246, s[4:7], s25 offen sc1
    s_waitcnt lgkmcnt(3)
    v_mfma_f32_16x16x32_bf16 v[44:47], v[168:171], v[80:83], v[44:47]
    v_cvt_pk_bf16_f32 v8, v8, v9
    v_cvt_pk_bf16_f32 v9, v10, v11
    s_waitcnt lgkmcnt(2)
    v_mfma_f32_16x16x32_bf16 v[44:47], v[172:175], v[84:87], v[44:47]
    ds_write_b64 v204, v[8:9] offset:0
    v_mul_f32 v20, v20, v200
    s_waitcnt lgkmcnt(2)
    v_mfma_f32_16x16x32_bf16 v[44:47], v[112:115], v[88:91], v[44:47]
    v_mul_f32 v21, v21, v201
    v_mul_f32 v22, v22, v202
    s_waitcnt lgkmcnt(1)
    v_mfma_f32_16x16x32_bf16 v[44:47], v[116:119], v[92:95], v[44:47]
    v_mul_f32 v23, v23, v203
    v_cvt_pk_bf16_f32 v20, v20, v21
    v_cvt_pk_bf16_f32 v21, v22, v23
    ds_write_b64 v220, v[20:21] offset:256
    s_nop 3
    v_mul_f32 v44, v44, v200
    v_mul_f32 v45, v45, v201
    v_mul_f32 v46, v46, v202
    v_mul_f32 v47, v47, v203
    v_cvt_pk_bf16_f32 v44, v44, v45
    v_cvt_pk_bf16_f32 v45, v46, v47
    ds_write_b64 v204, v[44:45] offset:768
    s_waitcnt lgkmcnt(0)
    s_barrier
    ds_read_b128 v[212:215], v206 offset:0
    s_waitcnt lgkmcnt(0)
    buffer_store_dwordx4 v[212:215], v246, s[4:7], s26 offen sc1
    s_cmp_lg_u64 s[90:91], 0
    s_cbranch_scc1 FIX
    s_or_b32 s89, s89, s20
    s_cbranch_scc1 K2_end
    v_mov_b32 v0, 0
    v_mov_b32 v1, s88
    s_mov_b64 exec, 1
    buffer_store_dword v1, v0, s[16:19], 0 offen
    s_endpgm
T_pw:
    ds_read_b32 v191, v190
    s_waitcnt lgkmcnt(0)
    v_cmp_gt_u32 vcc, s53, v191
    s_cbranch_vccnz T_pw
    s_branch T_pwr
T_aw:
    ds_read_b32 v191, v190
    s_waitcnt lgkmcnt(0)
    v_cmp_gt_u32 vcc, s50, v191
    s_cbranch_vccnz T_aw
    s_branch T_awr
K2_end:
K2_last:
    s_endpgm
SLOW:
    v_readlane_b32 s89, v4, 62
    s_mov_b32 s46, -1
    s_mov_b32 s47, 256
    s_mov_b64 s[90:91], 0
    s_branch SL_go
FIX:
    s_ff1_i32_b64 s46, s[90:91]
    s_bitset0_b64 s[90:91], s46
    s_mov_b32 s47, 2048
    s_setprio 0
SL_go:
    s_waitcnt vmcnt(0) lgkmcnt(0)
    s_barrier
    s_load_dwordx2 s[22:23], s[0:1], 8
    s_load_dwordx2 s[24:25], s[0:1], 24
    s_load_dwordx2 s[26:27], s[0:1], 32
    s_load_dwordx2 s[28:29], s[0:1], 40
    s_load_dwordx2 s[30:31], s[0:1], 0
    v_mbcnt_lo_u32_b32 v240, -1, 0
    v_mbcnt_hi_u32_b32 v240, -1, v240
    v_lshrrev_b32 v229, 5, v240
    v_and_b32 v230, 31, v240
    v_lshlrev_b32 v241, 7, v229
    v_lshl_add_u32 v241, v230, 1, v241
    v_lshlrev_b32 v245, 4, v240
    v_mov_b32 v242, 0
    s_waitcnt lgkmcnt(0)
    s_mov_b32 s80, s22
    s_and_b32 s81, s23, 0xffff
    s_mov_b32 s82, 1920000
    s_mov_b32 s83, 0x20000
    s_mov_b32 s76, s24
    s_and_b32 s77, s25, 0xffff
    s_mov_b32 s78, 1280000
    s_mov_b32 s79, 0x20000
    s_mov_b32 s72, s26
    s_and_b32 s73, s27, 0xffff
    s_mov_b32 s74, 1280000
    s_mov_b32 s75, 0x20000
    s_mov_b32 s84, s28
    s_and_b32 s85, s29, 0xffff
    s_mov_b32 s86, 20480
    s_mov_b32 s87, 0x20000
    s_mov_b32 s4, s30
    s_and_b32 s5, s31, 0xffff
    s_mov_b32 s6, 10240000
    s_mov_b32 s7, 0x20000
    s_mov_b32 s66, 0
    buffer_load_ushort v0, v241, s[84:87], s66 offen offset:0
    buffer_load_ushort v1, v241, s[84:87], s66 offen offset:64
    buffer_load_ushort v2, v241, s[84:87], s66 offen offset:256
    buffer_load_ushort v3, v241, s[84:87], s66 offen offset:320
    buffer_load_ushort v4, v241, s[84:87], s66 offen offset:512
    buffer_load_ushort v5, v241, s[84:87], s66 offen offset:576
    buffer_load_ushort v6, v241, s[84:87], s66 offen offset:768
    buffer_load_ushort v7, v241, s[84:87], s66 offen offset:832
    buffer_load_ushort v8, v241, s[84:87], s66 offen offset:1024
    buffer_load_ushort v9, v241, s[84:87], s66 offen offset:1088
    s_mov_b32 s66, 1280
    buffer_load_ushort v10, v241, s[84:87], s66 offen offset:0
    buffer_load_ushort v11, v241, s[84:87], s66 offen offset:64
    buffer_load_ushort v12, v241, s[84:87], s66 offen offset:256
    buffer_load_ushort v13, v241, s[84:87], s66 offen offset:320
    buffer_load_ushort v14, v241, s[84:87], s66 offen offset:512
    buffer_load_ushort v15, v241, s[84:87], s66 offen offset:576
    buffer_load_ushort v16, v241, s[84:87], s66 offen offset:768
    buffer_load_ushort v17, v241, s[84:87], s66 offen offset:832
    buffer_load_ushort v18, v241, s[84:87], s66 offen offset:1024
    buffer_load_ushort v19, v241, s[84:87], s66 offen offset:1088
    s_mov_b32 s66, 2560
    buffer_load_ushort v20, v241, s[84:87], s66 offen offset:0
    buffer_load_ushort v21, v241, s[84:87], s66 offen offset:64
    buffer_load_ushort v22, v241, s[84:87], s66 offen offset:256
    buffer_load_ushort v23, v241, s[84:87], s66 offen offset:320
    buffer_load_ushort v24, v241, s[84:87], s66 offen offset:512
    buffer_load_ushort v25, v241, s[84:87], s66 offen offset:576
    buffer_load_ushort v26, v241, s[84:87], s66 offen offset:768
    buffer_load_ushort v27, v241, s[84:87], s66 offen offset:832
    buffer_load_ushort v28, v241, s[84:87], s66 offen offset:1024
    buffer_load_ushort v29, v241, s[84:87], s66 offen offset:1088
    s_mov_b32 s66, 3840
    buffer_load_ushort v30, v241, s[84:87], s66 offen offset:0
    buffer_load_ushort v31, v241, s[84:87], s66 offen offset:64
    buffer_load_ushort v32, v241, s[84:87], s66 offen offset:256
    buffer_load_ushort v33, v241, s[84:87], s66 offen offset:320
    buffer_load_ushort v34, v241, s[84:87], s66 offen offset:512
    buffer_load_ushort v35, v241, s[84:87], s66 offen offset:576
    buffer_load_ushort v36, v241, s[84:87], s66 offen offset:768
    buffer_load_ushort v37, v241, s[84:87], s66 offen offset:832
    buffer_load_ushort v38, v241, s[84:87], s66 offen offset:1024
    buffer_load_ushort v39, v241, s[84:87], s66 offen offset:1088
    s_waitcnt vmcnt(0)
    s_mov_b32 s66, 5120
    buffer_load_ushort v40, v241, s[84:87], s66 offen offset:0
    buffer_load_ushort v41, v241, s[84:87], s66 offen offset:64
    buffer_load_ushort v42, v241, s[84:87], s66 offen offset:256
    buffer_load_ushort v43, v241, s[84:87], s66 offen offset:320
    buffer_load_ushort v44, v241, s[84:87], s66 offen offset:512
    buffer_load_ushort v45, v241, s[84:87], s66 offen offset:576
    buffer_load_ushort v46, v241, s[84:87], s66 offen offset:768
    buffer_load_ushort v47, v241, s[84:87], s66 offen offset:832
    buffer_load_ushort v48, v241, s[84:87], s66 offen offset:1024
    buffer_load_ushort v49, v241, s[84:87], s66 offen offset:1088
    s_mov_b32 s66, 6400
    buffer_load_ushort v50, v241, s[84:87], s66 offen offset:0
    buffer_load_ushort v51, v241, s[84:87], s66 offen offset:64
    buffer_load_ushort v52, v241, s[84:87], s66 offen offset:256
    buffer_load_ushort v53, v241, s[84:87], s66 offen offset:320
    buffer_load_ushort v54, v241, s[84:87], s66 offen offset:512
    buffer_load_ushort v55, v241, s[84:87], s66 offen offset:576
    buffer_load_ushort v56, v241, s[84:87], s66 offen offset:768
    buffer_load_ushort v57, v241, s[84:87], s66 offen offset:832
    buffer_load_ushort v58, v241, s[84:87], s66 offen offset:1024
    buffer_load_ushort v59, v241, s[84:87], s66 offen offset:1088
    s_mov_b32 s66, 7680
    buffer_load_ushort v60, v241, s[84:87], s66 offen offset:0
    buffer_load_ushort v61, v241, s[84:87], s66 offen offset:64
    buffer_load_ushort v62, v241, s[84:87], s66 offen offset:256
    buffer_load_ushort v63, v241, s[84:87], s66 offen offset:320
    buffer_load_ushort v64, v241, s[84:87], s66 offen offset:512
    buffer_load_ushort v65, v241, s[84:87], s66 offen offset:576
    buffer_load_ushort v66, v241, s[84:87], s66 offen offset:768
    buffer_load_ushort v67, v241, s[84:87], s66 offen offset:832
    buffer_load_ushort v68, v241, s[84:87], s66 offen offset:1024
    buffer_load_ushort v69, v241, s[84:87], s66 offen offset:1088
    s_mov_b32 s66, 8960
    buffer_load_ushort v70, v241, s[84:87], s66 offen offset:0
    buffer_load_ushort v71, v241, s[84:87], s66 offen offset:64
    buffer_load_ushort v72, v241, s[84:87], s66 offen offset:256
    buffer_load_ushort v73, v241, s[84:87], s66 offen offset:320
    buffer_load_ushort v74, v241, s[84:87], s66 offen offset:512
    buffer_load_ushort v75, v241, s[84:87], s66 offen offset:576
    buffer_load_ushort v76, v241, s[84:87], s66 offen offset:768
    buffer_load_ushort v77, v241, s[84:87], s66 offen offset:832
    buffer_load_ushort v78, v241, s[84:87], s66 offen offset:1024
    buffer_load_ushort v79, v241, s[84:87], s66 offen offset:1088
    s_waitcnt vmcnt(0)
    s_mov_b32 s66, 10240
    buffer_load_ushort v80, v241, s[84:87], s66 offen offset:0
    buffer_load_ushort v81, v241, s[84:87], s66 offen offset:64
    buffer_load_ushort v82, v241, s[84:87], s66 offen offset:256
    buffer_load_ushort v83, v241, s[84:87], s66 offen offset:320
    buffer_load_ushort v84, v241, s[84:87], s66 offen offset:512
    buffer_load_ushort v85, v241, s[84:87], s66 offen offset:576
    buffer_load_ushort v86, v241, s[84:87], s66 offen offset:768
    buffer_load_ushort v87, v241, s[84:87], s66 offen offset:832
    buffer_load_ushort v88, v241, s[84:87], s66 offen offset:1024
    buffer_load_ushort v89, v241, s[84:87], s66 offen offset:1088
    s_mov_b32 s66, 11520
    buffer_load_ushort v90, v241, s[84:87], s66 offen offset:0
    buffer_load_ushort v91, v241, s[84:87], s66 offen offset:64
    buffer_load_ushort v92, v241, s[84:87], s66 offen offset:256
    buffer_load_ushort v93, v241, s[84:87], s66 offen offset:320
    buffer_load_ushort v94, v241, s[84:87], s66 offen offset:512
    buffer_load_ushort v95, v241, s[84:87], s66 offen offset:576
    buffer_load_ushort v96, v241, s[84:87], s66 offen offset:768
    buffer_load_ushort v97, v241, s[84:87], s66 offen offset:832
    buffer_load_ushort v98, v241, s[84:87], s66 offen offset:1024
    buffer_load_ushort v99, v241, s[84:87], s66 offen offset:1088
    s_mov_b32 s66, 12800
    buffer_load_ushort v100, v241, s[84:87], s66 offen offset:0
    buffer_load_ushort v101, v241, s[84:87], s66 offen offset:64
    buffer_load_ushort v102, v241, s[84:87], s66 offen offset:256
    buffer_load_ushort v103, v241, s[84:87], s66 offen offset:320
    buffer_load_ushort v104, v241, s[84:87], s66 offen offset:512
    buffer_load_ushort v105, v241, s[84:87], s66 offen offset:576
    buffer_load_ushort v106, v241, s[84:87], s66 offen offset:768
    buffer_load_ushort v107, v241, s[84:87], s66 offen offset:832
    buffer_load_ushort v108, v241, s[84:87], s66 offen offset:1024
    buffer_load_ushort v109, v241, s[84:87], s66 offen offset:1088
    s_mov_b32 s66, 14080
    buffer_load_ushort v110, v241, s[84:87], s66 offen offset:0
    buffer_load_ushort v111, v241, s[84:87], s66 offen offset:64
    buffer_load_ushort v112, v241, s[84:87], s66 offen offset:256
    buffer_load_ushort v113, v241, s[84:87], s66 offen offset:320
    buffer_load_ushort v114, v241, s[84:87], s66 offen offset:512
    buffer_load_ushort v115, v241, s[84:87], s66 offen offset:576
    buffer_load_ushort v116, v241, s[84:87], s66 offen offset:768
    buffer_load_ushort v117, v241, s[84:87], s66 offen offset:832
    buffer_load_ushort v118, v241, s[84:87], s66 offen offset:1024
    buffer_load_ushort v119, v241, s[84:87], s66 offen offset:1088
    s_waitcnt vmcnt(0)
    s_mov_b32 s66, 15360
    buffer_load_ushort v120, v241, s[84:87], s66 offen offset:0
    buffer_load_ushort v121, v241, s[84:87], s66 offen offset:64
    buffer_load_ushort v122, v241, s[84:87], s66 offen offset:256
    buffer_load_ushort v123, v241, s[84:87], s66 offen offset:320
    buffer_load_ushort v124, v241, s[84:87], s66 offen offset:512
    buffer_load_ushort v125, v241, s[84:87], s66 offen offset:576
    buffer_load_ushort v126, v241, s[84:87], s66 offen offset:768
    buffer_load_ushort v127, v241, s[84:87], s66 offen offset:832
    buffer_load_ushort v128, v241, s[84:87], s66 offen offset:1024
    buffer_load_ushort v129, v241, s[84:87], s66 offen offset:1088
    s_mov_b32 s66, 16640
    buffer_load_ushort v130, v241, s[84:87], s66 offen offset:0
    buffer_load_ushort v131, v241, s[84:87], s66 offen offset:64
    buffer_load_ushort v132, v241, s[84:87], s66 offen offset:256
    buffer_load_ushort v133, v241, s[84:87], s66 offen offset:320
    buffer_load_ushort v134, v241, s[84:87], s66 offen offset:512
    buffer_load_ushort v135, v241, s[84:87], s66 offen offset:576
    buffer_load_ushort v136, v241, s[84:87], s66 offen offset:768
    buffer_load_ushort v137, v241, s[84:87], s66 offen offset:832
    buffer_load_ushort v138, v241, s[84:87], s66 offen offset:1024
    buffer_load_ushort v139, v241, s[84:87], s66 offen offset:1088
    s_mov_b32 s66, 17920
    buffer_load_ushort v140, v241, s[84:87], s66 offen offset:0
    buffer_load_ushort v141, v241, s[84:87], s66 offen offset:64
    buffer_load_ushort v142, v241, s[84:87], s66 offen offset:256
    buffer_load_ushort v143, v241, s[84:87], s66 offen offset:320
    buffer_load_ushort v144, v241, s[84:87], s66 offen offset:512
    buffer_load_ushort v145, v241, s[84:87], s66 offen offset:576
    buffer_load_ushort v146, v241, s[84:87], s66 offen offset:768
    buffer_load_ushort v147, v241, s[84:87], s66 offen offset:832
    buffer_load_ushort v148, v241, s[84:87], s66 offen offset:1024
    buffer_load_ushort v149, v241, s[84:87], s66 offen offset:1088
    s_mov_b32 s66, 19200
    buffer_load_ushort v150, v241, s[84:87], s66 offen offset:0
    buffer_load_ushort v151, v241, s[84:87], s66 offen offset:64
    buffer_load_ushort v152, v241, s[84:87], s66 offen offset:256
    buffer_load_ushort v153, v241, s[84:87], s66 offen offset:320
    buffer_load_ushort v154, v241, s[84:87], s66 offen offset:512
    buffer_load_ushort v155, v241, s[84:87], s66 offen offset:576
    buffer_load_ushort v156, v241, s[84:87], s66 offen offset:768
    buffer_load_ushort v157, v241, s[84:87], s66 offen offset:832
    buffer_load_ushort v158, v241, s[84:87], s66 offen offset:1024
    buffer_load_ushort v159, v241, s[84:87], s66 offen offset:1088
    s_waitcnt vmcnt(0)
    v_lshlrev_b32 v0, 16, v0
    v_lshlrev_b32 v1, 16, v1
    v_lshlrev_b32 v2, 16, v2
    v_lshlrev_b32 v3, 16, v3
    v_lshlrev_b32 v4, 16, v4
    v_lshlrev_b32 v5, 16, v5
    v_lshlrev_b32 v6, 16, v6
    v_lshlrev_b32 v7, 16, v7
    v_lshlrev_b32 v8, 16, v8
    v_lshlrev_b32 v9, 16, v9
    v_lshlrev_b32 v10, 16, v10
    v_lshlrev_b32 v11, 16, v11
    v_lshlrev_b32 v12, 16, v12
    v_lshlrev_b32 v13, 16, v13
    v_lshlrev_b32 v14, 16, v14
    v_lshlrev_b32 v15, 16, v15
    v_lshlrev_b32 v16, 16, v16
    v_lshlrev_b32 v17, 16, v17
    v_lshlrev_b32 v18, 16, v18
    v_lshlrev_b32 v19, 16, v19
    v_lshlrev_b32 v20, 16, v20
    v_lshlrev_b32 v21, 16, v21
    v_lshlrev_b32 v22, 16, v22
    v_lshlrev_b32 v23, 16, v23
    v_lshlrev_b32 v24, 16, v24
    v_lshlrev_b32 v25, 16, v25
    v_lshlrev_b32 v26, 16, v26
    v_lshlrev_b32 v27, 16, v27
    v_lshlrev_b32 v28, 16, v28
    v_lshlrev_b32 v29, 16, v29
    v_lshlrev_b32 v30, 16, v30
    v_lshlrev_b32 v31, 16, v31
    v_lshlrev_b32 v32, 16, v32
    v_lshlrev_b32 v33, 16, v33
    v_lshlrev_b32 v34, 16, v34
    v_lshlrev_b32 v35, 16, v35
    v_lshlrev_b32 v36, 16, v36
    v_lshlrev_b32 v37, 16, v37
    v_lshlrev_b32 v38, 16, v38
    v_lshlrev_b32 v39, 16, v39
    v_lshlrev_b32 v40, 16, v40
    v_lshlrev_b32 v41, 16, v41
    v_lshlrev_b32 v42, 16, v42
    v_lshlrev_b32 v43, 16, v43
    v_lshlrev_b32 v44, 16, v44
    v_lshlrev_b32 v45, 16, v45
    v_lshlrev_b32 v46, 16, v46
    v_lshlrev_b32 v47, 16, v47
    v_lshlrev_b32 v48, 16, v48
    v_lshlrev_b32 v49, 16, v49
    v_lshlrev_b32 v50, 16, v50
    v_lshlrev_b32 v51, 16, v51
    v_lshlrev_b32 v52, 16, v52
    v_lshlrev_b32 v53, 16, v53
    v_lshlrev_b32 v54, 16, v54
    v_lshlrev_b32 v55, 16, v55
    v_lshlrev_b32 v56, 16, v56
    v_lshlrev_b32 v57, 16, v57
    v_lshlrev_b32 v58, 16, v58
    v_lshlrev_b32 v59, 16, v59
    v_lshlrev_b32 v60, 16, v60
    v_lshlrev_b32 v61, 16, v61
    v_lshlrev_b32 v62, 16, v62
    v_lshlrev_b32 v63, 16, v63
    v_lshlrev_b32 v64, 16, v64
    v_lshlrev_b32 v65, 16, v65
    v_lshlrev_b32 v66, 16, v66
    v_lshlrev_b32 v67, 16, v67
    v_lshlrev_b32 v68, 16, v68
    v_lshlrev_b32 v69, 16, v69
    v_lshlrev_b32 v70, 16, v70
    v_lshlrev_b32 v71, 16, v71
    v_lshlrev_b32 v72, 16, v72
    v_lshlrev_b32 v73, 16, v73
    v_lshlrev_b32 v74, 16, v74
    v_lshlrev_b32 v75, 16, v75
    v_lshlrev_b32 v76, 16, v76
    v_lshlrev_b32 v77, 16, v77
    v_lshlrev_b32 v78, 16, v78
    v_lshlrev_b32 v79, 16, v79
    v_lshlrev_b32 v80, 16, v80
    v_lshlrev_b32 v81, 16, v81
    v_lshlrev_b32 v82, 16, v82
    v_lshlrev_b32 v83, 16, v83
    v_lshlrev_b32 v84, 16, v84
    v_lshlrev_b32 v85, 16, v85
    v_lshlrev_b32 v86, 16, v86
    v_lshlrev_b32 v87, 16, v87
    v_lshlrev_b32 v88, 16, v88
    v_lshlrev_b32 v89, 16, v89
    v_lshlrev_b32 v90, 16, v90
    v_lshlrev_b32 v91, 16, v91
    v_lshlrev_b32 v92, 16, v92
    v_lshlrev_b32 v93, 16, v93
    v_lshlrev_b32 v94, 16, v94
    v_lshlrev_b32 v95, 16, v95
    v_lshlrev_b32 v96, 16, v96
    v_lshlrev_b32 v97, 16, v97
    v_lshlrev_b32 v98, 16, v98
    v_lshlrev_b32 v99, 16, v99
    v_lshlrev_b32 v100, 16, v100
    v_lshlrev_b32 v101, 16, v101
    v_lshlrev_b32 v102, 16, v102
    v_lshlrev_b32 v103, 16, v103
    v_lshlrev_b32 v104, 16, v104
    v_lshlrev_b32 v105, 16, v105
    v_lshlrev_b32 v106, 16, v106
    v_lshlrev_b32 v107, 16, v107
    v_lshlrev_b32 v108, 16, v108
    v_lshlrev_b32 v109, 16, v109
    v_lshlrev_b32 v110, 16, v110
    v_lshlrev_b32 v111, 16, v111
    v_lshlrev_b32 v112, 16, v112
    v_lshlrev_b32 v113, 16, v113
    v_lshlrev_b32 v114, 16, v114
    v_lshlrev_b32 v115, 16, v115
    v_lshlrev_b32 v116, 16, v116
    v_lshlrev_b32 v117, 16, v117
    v_lshlrev_b32 v118, 16, v118
    v_lshlrev_b32 v119, 16, v119
    v_lshlrev_b32 v120, 16, v120
    v_lshlrev_b32 v121, 16, v121
    v_lshlrev_b32 v122, 16, v122
    v_lshlrev_b32 v123, 16, v123
    v_lshlrev_b32 v124, 16, v124
    v_lshlrev_b32 v125, 16, v125
    v_lshlrev_b32 v126, 16, v126
    v_lshlrev_b32 v127, 16, v127
    v_lshlrev_b32 v128, 16, v128
    v_lshlrev_b32 v129, 16, v129
    v_lshlrev_b32 v130, 16, v130
    v_lshlrev_b32 v131, 16, v131
    v_lshlrev_b32 v132, 16, v132
    v_lshlrev_b32 v133, 16, v133
    v_lshlrev_b32 v134, 16, v134
    v_lshlrev_b32 v135, 16, v135
    v_lshlrev_b32 v136, 16, v136
    v_lshlrev_b32 v137, 16, v137
    v_lshlrev_b32 v138, 16, v138
    v_lshlrev_b32 v139, 16, v139
    v_lshlrev_b32 v140, 16, v140
    v_lshlrev_b32 v141, 16, v141
    v_lshlrev_b32 v142, 16, v142
    v_lshlrev_b32 v143, 16, v143
    v_lshlrev_b32 v144, 16, v144
    v_lshlrev_b32 v145, 16, v145
    v_lshlrev_b32 v146, 16, v146
    v_lshlrev_b32 v147, 16, v147
    v_lshlrev_b32 v148, 16, v148
    v_lshlrev_b32 v149, 16, v149
    v_lshlrev_b32 v150, 16, v150
    v_lshlrev_b32 v151, 16, v151
    v_lshlrev_b32 v152, 16, v152
    v_lshlrev_b32 v153, 16, v153
    v_lshlrev_b32 v154, 16, v154
    v_lshlrev_b32 v155, 16, v155
    v_lshlrev_b32 v156, 16, v156
    v_lshlrev_b32 v157, 16, v157
    v_lshlrev_b32 v158, 16, v158
    v_lshlrev_b32 v159, 16, v159
    s_mov_b32 s50, 0
SL_node:
    s_mul_i32 s34, s2, 40
    s_lshl_b32 s66, s50, 3
    s_add_u32 s66, s66, s20
    s_mov_b32 s35, 0
    s_cmp_lt_i32 s46, 0
    s_cbranch_scc1 SL_own
    s_cmp_lg_u32 s50, 0
    s_cbranch_scc1 SL_rows
    s_mov_b32 s66, s46
    s_lshl_b32 s35, s20, 8
SL_own:
    s_add_u32 s34, s34, s66
    v_mov_b32 v160, 0
    v_mov_b32 v161, 0
    v_mov_b32 v162, 0
    v_mov_b32 v163, 0
    v_mov_b32 v164, 0
    v_mov_b32 v165, 0
    v_mov_b32 v166, 0
    v_mov_b32 v167, 0
    v_mov_b32 v168, 0
    v_mov_b32 v169, 0
    v_mov_b32 v170, 0
    v_mov_b32 v171, 0
    v_mov_b32 v172, 0
    v_mov_b32 v173, 0
    v_mov_b32 v174, 0
    v_mov_b32 v175, 0
    v_mov_b32 v176, 0
    v_mov_b32 v177, 0
    v_mov_b32 v178, 0
    v_mov_b32 v179, 0
    v_mov_b32 v180, 0
    v_mov_b32 v181, 0
SL_scan:
    s_lshl_b32 s66, s35, 2
    s_lshl_b32 s67, s47, 2
    v_add_u32 v229, s66, v245
    buffer_load_dwordx4 v[232:235], v229, s[72:75], 0 offen
    v_add_u32 v229, s67, v229
    buffer_load_dwordx4 v[236:239], v229, s[72:75], 0 offen
    v_add_u32 v229, s67, v229
    buffer_load_dwordx4 v[248:251], v229, s[72:75], 0 offen
    v_add_u32 v229, s67, v229
    buffer_load_dwordx4 v[252:255], v229, s[72:75], 0 offen
    s_mov_b32 s48, 0
    s_waitcnt vmcnt(3)
    v_cmpx_ne_u32 vcc, s34, v232
    v_cmpx_ne_u32 vcc, s34, v233
    v_cmpx_ne_u32 vcc, s34, v234
    v_cmpx_ne_u32 vcc, s34, v235
    s_waitcnt vmcnt(2)
    v_cmpx_ne_u32 vcc, s34, v236
    v_cmpx_ne_u32 vcc, s34, v237
    v_cmpx_ne_u32 vcc, s34, v238
    v_cmpx_ne_u32 vcc, s34, v239
    s_waitcnt vmcnt(1)
    v_cmpx_ne_u32 vcc, s34, v248
    v_cmpx_ne_u32 vcc, s34, v249
    v_cmpx_ne_u32 vcc, s34, v250
    v_cmpx_ne_u32 vcc, s34, v251
    s_waitcnt vmcnt(0)
    v_cmpx_ne_u32 vcc, s34, v252
    v_cmpx_ne_u32 vcc, s34, v253
    v_cmpx_ne_u32 vcc, s34, v254
    v_cmpx_ne_u32 vcc, s34, v255
    s_nop 0
    s_cmp_eq_u64 exec, -1
    s_mov_b64 exec, -1
    s_cbranch_scc0 SL_piece
    s_add_u32 s35, s35, s67
    s_cmp_lt_u32 s35, 320000
    s_cbranch_scc1 SL_scan
    s_branch SL_done
SL_piece:
    v_cmp_eq_u32 s[38:39], s34, v232
    v_cmp_eq_u32 s[40:41], s34, v233
    v_cmp_eq_u32 s[42:43], s34, v234
    v_cmp_eq_u32 s[44:45], s34, v235
    s_mov_b32 s36, 0
SL_bits:
    s_cmp_eq_u64 s[38:39], 0
    s_cbranch_scc1 SL_nexti
    s_ff1_i32_b64 s66, s[38:39]
    s_bitset0_b64 s[38:39], s66
    s_lshl_b32 s66, s66, 2
    s_add_u32 s37, s66, s36
    s_add_u32 s37, s37, s35
    s_lshl_b32 s66, s37, 2
    s_lshl_b32 s67, s37, 5
    s_mul_i32 s68, s37, 6
    buffer_load_dword v243, v242, s[76:79], s66 offen
    buffer_load_dwordx4 v[184:187], v242, s[12:15], s67 offen
    buffer_load_dwordx4 v[188:191], v242, s[12:15], s67 offen offset:16
    buffer_load_ushort v226, v242, s[80:83], s68 offen offset:0
    buffer_load_ushort v227, v242, s[80:83], s68 offen offset:2
    buffer_load_ushort v228, v242, s[80:83], s68 offen offset:4
    s_waitcnt vmcnt(5)
    v_lshl_add_u32 v243, v243, 10, v241
    buffer_load_ushort v208, v243, s[4:7], 0 offen offset:0
    buffer_load_ushort v209, v243, s[4:7], 0 offen offset:64
    buffer_load_ushort v210, v243, s[4:7], 0 offen offset:256
    buffer_load_ushort v211, v243, s[4:7], 0 offen offset:320
    buffer_load_ushort v212, v243, s[4:7], 0 offen offset:512
    buffer_load_ushort v213, v243, s[4:7], 0 offen offset:576
    buffer_load_ushort v214, v243, s[4:7], 0 offen offset:768
    buffer_load_ushort v215, v243, s[4:7], 0 offen offset:832
    s_waitcnt vmcnt(8)
    v_lshlrev_b32 v192, 16, v184
    v_and_b32 v193, 0xffff0000, v184
    v_lshlrev_b32 v194, 16, v185
    v_and_b32 v195, 0xffff0000, v185
    v_lshlrev_b32 v196, 16, v186
    v_and_b32 v197, 0xffff0000, v186
    v_lshlrev_b32 v198, 16, v187
    v_and_b32 v199, 0xffff0000, v187
    v_lshlrev_b32 v200, 16, v188
    v_and_b32 v201, 0xffff0000, v188
    v_lshlrev_b32 v202, 16, v189
    v_and_b32 v203, 0xffff0000, v189
    v_lshlrev_b32 v204, 16, v190
    v_and_b32 v205, 0xffff0000, v190
    v_lshlrev_b32 v206, 16, v191
    v_and_b32 v207, 0xffff0000, v191
    v_lshlrev_b32 v226, 16, v226
    v_lshlrev_b32 v227, 16, v227
    v_lshlrev_b32 v228, 16, v228
    v_mul_f32 v216, v192, v0
    v_mul_f32 v217, v192, v1
    v_mul_f32 v218, v192, v2
    v_mul_f32 v219, v192, v3
    v_mul_f32 v220, v192, v4
    v_mul_f32 v221, v192, v5
    v_mul_f32 v222, v192, v6
    v_mul_f32 v223, v192, v7
    v_mul_f32 v224, v192, v8
    v_mul_f32 v225, v192, v9
    v_fmac_f32 v216, v193, v10
    v_fmac_f32 v217, v193, v11
    v_fmac_f32 v218, v193, v12
    v_fmac_f32 v219, v193, v13
    v_fmac_f32 v220, v193, v14
    v_fmac_f32 v221, v193, v15
    v_fmac_f32 v222, v193, v16
    v_fmac_f32 v223, v193, v17
    v_fmac_f32 v224, v193, v18
    v_fmac_f32 v225, v193, v19
    v_fmac_f32 v216, v194, v20
    v_fmac_f32 v217, v194, v21
    v_fmac_f32 v218, v194, v22
    v_fmac_f32 v219, v194, v23
    v_fmac_f32 v220, v194, v24
    v_fmac_f32 v221, v194, v25
    v_fmac_f32 v222, v194, v26
    v_fmac_f32 v223, v194, v27
    v_fmac_f32 v224, v194, v28
    v_fmac_f32 v225, v194, v29
    v_fmac_f32 v216, v195, v30
    v_fmac_f32 v217, v195, v31
    v_fmac_f32 v218, v195, v32
    v_fmac_f32 v219, v195, v33
    v_fmac_f32 v220, v195, v34
    v_fmac_f32 v221, v195, v35
    v_fmac_f32 v222, v195, v36
    v_fmac_f32 v223, v195, v37
    v_fmac_f32 v224, v195, v38
    v_fmac_f32 v225, v195, v39
    v_fmac_f32 v216, v196, v40
    v_fmac_f32 v217, v196, v41
    v_fmac_f32 v218, v196, v42
    v_fmac_f32 v219, v196, v43
    v_fmac_f32 v220, v196, v44
    v_fmac_f32 v221, v196, v45
    v_fmac_f32 v222, v196, v46
    v_fmac_f32 v223, v196, v47
    v_fmac_f32 v224, v196, v48
    v_fmac_f32 v225, v196, v49
    v_fmac_f32 v216, v197, v50
    v_fmac_f32 v217, v197, v51
    v_fmac_f32 v218, v197, v52
    v_fmac_f32 v219, v197, v53
    v_fmac_f32 v220, v197, v54
    v_fmac_f32 v221, v197, v55
    v_fmac_f32 v222, v197, v56
    v_fmac_f32 v223, v197, v57
    v_fmac_f32 v224, v197, v58
    v_fmac_f32 v225, v197, v59
    v_fmac_f32 v216, v198, v60
    v_fmac_f32 v217, v198, v61
    v_fmac_f32 v218, v198, v62
    v_fmac_f32 v219, v198, v63
    v_fmac_f32 v220, v198, v64
    v_fmac_f32 v221, v198, v65
    v_fmac_f32 v222, v198, v66
    v_fmac_f32 v223, v198, v67
    v_fmac_f32 v224, v198, v68
    v_fmac_f32 v225, v198, v69
    v_fmac_f32 v216, v199, v70
    v_fmac_f32 v217, v199, v71
    v_fmac_f32 v218, v199, v72
    v_fmac_f32 v219, v199, v73
    v_fmac_f32 v220, v199, v74
    v_fmac_f32 v221, v199, v75
    v_fmac_f32 v222, v199, v76
    v_fmac_f32 v223, v199, v77
    v_fmac_f32 v224, v199, v78
    v_fmac_f32 v225, v199, v79
    v_fmac_f32 v216, v200, v80
    v_fmac_f32 v217, v200, v81
    v_fmac_f32 v218, v200, v82
    v_fmac_f32 v219, v200, v83
    v_fmac_f32 v220, v200, v84
    v_fmac_f32 v221, v200, v85
    v_fmac_f32 v222, v200, v86
    v_fmac_f32 v223, v200, v87
    v_fmac_f32 v224, v200, v88
    v_fmac_f32 v225, v200, v89
    v_fmac_f32 v216, v201, v90
    v_fmac_f32 v217, v201, v91
    v_fmac_f32 v218, v201, v92
    v_fmac_f32 v219, v201, v93
    v_fmac_f32 v220, v201, v94
    v_fmac_f32 v221, v201, v95
    v_fmac_f32 v222, v201, v96
    v_fmac_f32 v223, v201, v97
    v_fmac_f32 v224, v201, v98
    v_fmac_f32 v225, v201, v99
    v_fmac_f32 v216, v202, v100
    v_fmac_f32 v217, v202, v101
    v_fmac_f32 v218, v202, v102
    v_fmac_f32 v219, v202, v103
    v_fmac_f32 v220, v202, v104
    v_fmac_f32 v221, v202, v105
    v_fmac_f32 v222, v202, v106
    v_fmac_f32 v223, v202, v107
    v_fmac_f32 v224, v202, v108
    v_fmac_f32 v225, v202, v109
    v_fmac_f32 v216, v203, v110
    v_fmac_f32 v217, v203, v111
    v_fmac_f32 v218, v203, v112
    v_fmac_f32 v219, v203, v113
    v_fmac_f32 v220, v203, v114
    v_fmac_f32 v221, v203, v115
    v_fmac_f32 v222, v203, v116
    v_fmac_f32 v223, v203, v117
    v_fmac_f32 v224, v203, v118
    v_fmac_f32 v225, v203, v119
    v_fmac_f32 v216, v204, v120
    v_fmac_f32 v217, v204, v121
    v_fmac_f32 v218, v204, v122
    v_fmac_f32 v219, v204, v123
    v_fmac_f32 v220, v204, v124
    v_fmac_f32 v221, v204, v125
    v_fmac_f32 v222, v204, v126
    v_fmac_f32 v223, v204, v127
    v_fmac_f32 v224, v204, v128
    v_fmac_f32 v225, v204, v129
    v_fmac_f32 v216, v205, v130
    v_fmac_f32 v217, v205, v131
    v_fmac_f32 v218, v205, v132
    v_fmac_f32 v219, v205, v133
    v_fmac_f32 v220, v205, v134
    v_fmac_f32 v221, v205, v135
    v_fmac_f32 v222, v205, v136
    v_fmac_f32 v223, v205, v137
    v_fmac_f32 v224, v205, v138
    v_fmac_f32 v225, v205, v139
    v_fmac_f32 v216, v206, v140
    v_fmac_f32 v217, v206, v141
    v_fmac_f32 v218, v206, v142
    v_fmac_f32 v219, v206, v143
    v_fmac_f32 v220, v206, v144
    v_fmac_f32 v221, v206, v145
    v_fmac_f32 v222, v206, v146
    v_fmac_f32 v223, v206, v147
    v_fmac_f32 v224, v206, v148
    v_fmac_f32 v225, v206, v149
    v_fmac_f32 v216, v207, v150
    v_fmac_f32 v217, v207, v151
    v_fmac_f32 v218, v207, v152
    v_fmac_f32 v219, v207, v153
    v_fmac_f32 v220, v207, v154
    v_fmac_f32 v221, v207, v155
    v_fmac_f32 v222, v207, v156
    v_fmac_f32 v223, v207, v157
    v_fmac_f32 v224, v207, v158
    v_fmac_f32 v225, v207, v159
    s_waitcnt vmcnt(0)
    v_lshlrev_b32 v208, 16, v208
    v_lshlrev_b32 v209, 16, v209
    v_lshlrev_b32 v210, 16, v210
    v_lshlrev_b32 v211, 16, v211
    v_lshlrev_b32 v212, 16, v212
    v_lshlrev_b32 v213, 16, v213
    v_lshlrev_b32 v214, 16, v214
    v_lshlrev_b32 v215, 16, v215
    v_fmac_f32 v160, v208, v216
    v_mul_f32 v229, v210, v226
    v_fmac_f32 v229, v212, v227
    v_fmac_f32 v229, v214, v228
    v_fmac_f32 v176, v229, v218
    v_mul_f32 v229, v208, v220
    v_fmac_f32 v162, v229, v226
    v_fmac_f32 v168, v210, v222
    v_mul_f32 v230, v227, v214
    v_fma_f32 v230, -v228, v212, v230
    v_fmac_f32 v178, v230, v224
    v_fmac_f32 v164, v229, v227
    v_fmac_f32 v170, v212, v222
    v_mul_f32 v230, v228, v210
    v_fma_f32 v230, -v226, v214, v230
    v_fmac_f32 v180, v230, v224
    v_fmac_f32 v166, v229, v228
    v_fmac_f32 v172, v214, v222
    v_mul_f32 v230, v226, v212
    v_fma_f32 v230, -v227, v210, v230
    v_fmac_f32 v174, v230, v224
    v_fmac_f32 v161, v209, v217
    v_mul_f32 v229, v211, v226
    v_fmac_f32 v229, v213, v227
    v_fmac_f32 v229, v215, v228
    v_fmac_f32 v177, v229, v219
    v_mul_f32 v229, v209, v221
    v_fmac_f32 v163, v229, v226
    v_fmac_f32 v169, v211, v223
    v_mul_f32 v230, v227, v215
    v_fma_f32 v230, -v228, v213, v230
    v_fmac_f32 v179, v230, v225
    v_fmac_f32 v165, v229, v227
    v_fmac_f32 v171, v213, v223
    v_mul_f32 v230, v228, v211
    v_fma_f32 v230, -v226, v215, v230
    v_fmac_f32 v181, v230, v225
    v_fmac_f32 v167, v229, v228
    v_fmac_f32 v173, v215, v223
    v_mul_f32 v230, v226, v213
    v_fma_f32 v230, -v227, v211, v230
    v_fmac_f32 v175, v230, v225
    s_branch SL_bits
SL_nexti:
    s_mov_b64 s[38:39], s[40:41]
    s_mov_b64 s[40:41], s[42:43]
    s_mov_b64 s[42:43], s[44:45]
    s_add_u32 s36, s36, 1
    s_cmp_lt_u32 s36, 4
    s_cbranch_scc1 SL_bits
    s_add_u32 s35, s35, s47
    s_cmp_ge_u32 s35, 320000
    s_cbranch_scc1 SL_done
    s_add_u32 s48, s48, 1
    s_cmp_eq_u32 s48, 4
    s_cbranch_scc1 SL_scan
    v_mov_b32 v232, v236
    v_mov_b32 v233, v237
    v_mov_b32 v234, v238
    v_mov_b32 v235, v239
    v_mov_b32 v236, v248
    v_mov_b32 v237, v249
    v_mov_b32 v238, v250
    v_mov_b32 v239, v251
    v_mov_b32 v248, v252
    v_mov_b32 v249, v253
    v_mov_b32 v250, v254
    v_mov_b32 v251, v255
    s_branch SL_piece
SL_done:
    s_cmp_lt_i32 s46, 0
    s_cbranch_scc1 SL_rows
    s_mul_i32 s66, s20, 5632
    v_lshlrev_b32 v229, 2, v240
    v_add_u32 v229, 86016, v229
    v_add_u32 v230, s66, v229
    ds_write_b32 v230, v160 offset:0
    ds_write_b32 v230, v161 offset:256
    ds_write_b32 v230, v162 offset:512
    ds_write_b32 v230, v163 offset:768
    ds_write_b32 v230, v164 offset:1024
    ds_write_b32 v230, v165 offset:1280
    ds_write_b32 v230, v166 offset:1536
    ds_write_b32 v230, v167 offset:1792
    ds_write_b32 v230, v168 offset:2048
    ds_write_b32 v230, v169 offset:2304
    ds_write_b32 v230, v170 offset:2560
    ds_write_b32 v230, v171 offset:2816
    ds_write_b32 v230, v172 offset:3072
    ds_write_b32 v230, v173 offset:3328
    ds_write_b32 v230, v174 offset:3584
    ds_write_b32 v230, v175 offset:3840
    ds_write_b32 v230, v176 offset:4096
    ds_write_b32 v230, v177 offset:4352
    ds_write_b32 v230, v178 offset:4608
    ds_write_b32 v230, v179 offset:4864
    ds_write_b32 v230, v180 offset:5120
    ds_write_b32 v230, v181 offset:5376
    s_waitcnt lgkmcnt(0)
    s_barrier
    ds_read_b32 v160, v229 offset:0
    ds_read_b32 v161, v229 offset:256
    ds_read_b32 v162, v229 offset:512
    ds_read_b32 v163, v229 offset:768
    ds_read_b32 v164, v229 offset:1024
    ds_read_b32 v165, v229 offset:1280
    ds_read_b32 v166, v229 offset:1536
    ds_read_b32 v167, v229 offset:1792
    ds_read_b32 v168, v229 offset:2048
    ds_read_b32 v169, v229 offset:2304
    ds_read_b32 v170, v229 offset:2560
    ds_read_b32 v171, v229 offset:2816
    ds_read_b32 v172, v229 offset:3072
    ds_read_b32 v173, v229 offset:3328
    ds_read_b32 v174, v229 offset:3584
    ds_read_b32 v175, v229 offset:3840
    ds_read_b32 v176, v229 offset:4096
    ds_read_b32 v177, v229 offset:4352
    ds_read_b32 v178, v229 offset:4608
    ds_read_b32 v179, v229 offset:4864
    ds_read_b32 v180, v229 offset:5120
    ds_read_b32 v181, v229 offset:5376
    s_waitcnt lgkmcnt(0)
    ds_read_b32 v184, v229 offset:5632
    ds_read_b32 v185, v229 offset:5888
    ds_read_b32 v186, v229 offset:6144
    ds_read_b32 v187, v229 offset:6400
    ds_read_b32 v188, v229 offset:6656
    ds_read_b32 v189, v229 offset:6912
    ds_read_b32 v190, v229 offset:7168
    ds_read_b32 v191, v229 offset:7424
    ds_read_b32 v192, v229 offset:7680
    ds_read_b32 v193, v229 offset:7936
    ds_read_b32 v194, v229 offset:8192
    ds_read_b32 v195, v229 offset:8448
    ds_read_b32 v196, v229 offset:8704
    ds_read_b32 v197, v229 offset:8960
    ds_read_b32 v198, v229 offset:9216
    ds_read_b32 v199, v229 offset:9472
    ds_read_b32 v200, v229 offset:9728
    ds_read_b32 v201, v229 offset:9984
    ds_read_b32 v202, v229 offset:10240
    ds_read_b32 v203, v229 offset:10496
    ds_read_b32 v204, v229 offset:10752
    ds_read_b32 v205, v229 offset:11008
    s_waitcnt lgkmcnt(0)
    v_add_f32 v160, v160, v184
    v_add_f32 v161, v161, v185
    v_add_f32 v162, v162, v186
    v_add_f32 v163, v163, v187
    v_add_f32 v164, v164, v188
    v_add_f32 v165, v165, v189
    v_add_f32 v166, v166, v190
    v_add_f32 v167, v167, v191
    v_add_f32 v168, v168, v192
    v_add_f32 v169, v169, v193
    v_add_f32 v170, v170, v194
    v_add_f32 v171, v171, v195
    v_add_f32 v172, v172, v196
    v_add_f32 v173, v173, v197
    v_add_f32 v174, v174, v198
    v_add_f32 v175, v175, v199
    v_add_f32 v176, v176, v200
    v_add_f32 v177, v177, v201
    v_add_f32 v178, v178, v202
    v_add_f32 v179, v179, v203
    v_add_f32 v180, v180, v204
    v_add_f32 v181, v181, v205
    ds_read_b32 v184, v229 offset:11264
    ds_read_b32 v185, v229 offset:11520
    ds_read_b32 v186, v229 offset:11776
    ds_read_b32 v187, v229 offset:12032
    ds_read_b32 v188, v229 offset:12288
    ds_read_b32 v189, v229 offset:12544
    ds_read_b32 v190, v229 offset:12800
    ds_read_b32 v191, v229 offset:13056
    ds_read_b32 v192, v229 offset:13312
    ds_read_b32 v193, v229 offset:13568
    ds_read_b32 v194, v229 offset:13824
    ds_read_b32 v195, v229 offset:14080
    ds_read_b32 v196, v229 offset:14336
    ds_read_b32 v197, v229 offset:14592
    ds_read_b32 v198, v229 offset:14848
    ds_read_b32 v199, v229 offset:15104
    ds_read_b32 v200, v229 offset:15360
    ds_read_b32 v201, v229 offset:15616
    ds_read_b32 v202, v229 offset:15872
    ds_read_b32 v203, v229 offset:16128
    ds_read_b32 v204, v229 offset:16384
    ds_read_b32 v205, v229 offset:16640
    s_waitcnt lgkmcnt(0)
    v_add_f32 v160, v160, v184
    v_add_f32 v161, v161, v185
    v_add_f32 v162, v162, v186
    v_add_f32 v163, v163, v187
    v_add_f32 v164, v164, v188
    v_add_f32 v165, v165, v189
    v_add_f32 v166, v166, v190
    v_add_f32 v167, v167, v191
    v_add_f32 v168, v168, v192
    v_add_f32 v169, v169, v193
    v_add_f32 v170, v170, v194
    v_add_f32 v171, v171, v195
    v_add_f32 v172, v172, v196
    v_add_f32 v173, v173, v197
    v_add_f32 v174, v174, v198
    v_add_f32 v175, v175, v199
    v_add_f32 v176, v176, v200
    v_add_f32 v177, v177, v201
    v_add_f32 v178, v178, v202
    v_add_f32 v179, v179, v203
    v_add_f32 v180, v180, v204
    v_add_f32 v181, v181, v205
    ds_read_b32 v184, v229 offset:16896
    ds_read_b32 v185, v229 offset:17152
    ds_read_b32 v186, v229 offset:17408
    ds_read_b32 v187, v229 offset:17664
    ds_read_b32 v188, v229 offset:17920
    ds_read_b32 v189, v229 offset:18176
    ds_read_b32 v190, v229 offset:18432
    ds_read_b32 v191, v229 offset:18688
    ds_read_b32 v192, v229 offset:18944
    ds_read_b32 v193, v229 offset:19200
    ds_read_b32 v194, v229 offset:19456
    ds_read_b32 v195, v229 offset:19712
    ds_read_b32 v196, v229 offset:19968
    ds_read_b32 v197, v229 offset:20224
    ds_read_b32 v198, v229 offset:20480
    ds_read_b32 v199, v229 offset:20736
    ds_read_b32 v200, v229 offset:20992
    ds_read_b32 v201, v229 offset:21248
    ds_read_b32 v202, v229 offset:21504
    ds_read_b32 v203, v229 offset:21760
    ds_read_b32 v204, v229 offset:22016
    ds_read_b32 v205, v229 offset:22272
    s_waitcnt lgkmcnt(0)
    v_add_f32 v160, v160, v184
    v_add_f32 v161, v161, v185
    v_add_f32 v162, v162, v186
    v_add_f32 v163, v163, v187
    v_add_f32 v164, v164, v188
    v_add_f32 v165, v165, v189
    v_add_f32 v166, v166, v190
    v_add_f32 v167, v167, v191
    v_add_f32 v168, v168, v192
    v_add_f32 v169, v169, v193
    v_add_f32 v170, v170, v194
    v_add_f32 v171, v171, v195
    v_add_f32 v172, v172, v196
    v_add_f32 v173, v173, v197
    v_add_f32 v174, v174, v198
    v_add_f32 v175, v175, v199
    v_add_f32 v176, v176, v200
    v_add_f32 v177, v177, v201
    v_add_f32 v178, v178, v202
    v_add_f32 v179, v179, v203
    v_add_f32 v180, v180, v204
    v_add_f32 v181, v181, v205
    ds_read_b32 v184, v229 offset:22528
    ds_read_b32 v185, v229 offset:22784
    ds_read_b32 v186, v229 offset:23040
    ds_read_b32 v187, v229 offset:23296
    ds_read_b32 v188, v229 offset:23552
    ds_read_b32 v189, v229 offset:23808
    ds_read_b32 v190, v229 offset:24064
    ds_read_b32 v191, v229 offset:24320
    ds_read_b32 v192, v229 offset:24576
    ds_read_b32 v193, v229 offset:24832
    ds_read_b32 v194, v229 offset:25088
    ds_read_b32 v195, v229 offset:25344
    ds_read_b32 v196, v229 offset:25600
    ds_read_b32 v197, v229 offset:25856
    ds_read_b32 v198, v229 offset:26112
    ds_read_b32 v199, v229 offset:26368
    ds_read_b32 v200, v229 offset:26624
    ds_read_b32 v201, v229 offset:26880
    ds_read_b32 v202, v229 offset:27136
    ds_read_b32 v203, v229 offset:27392
    ds_read_b32 v204, v229 offset:27648
    ds_read_b32 v205, v229 offset:27904
    s_waitcnt lgkmcnt(0)
    v_add_f32 v160, v160, v184
    v_add_f32 v161, v161, v185
    v_add_f32 v162, v162, v186
    v_add_f32 v163, v163, v187
    v_add_f32 v164, v164, v188
    v_add_f32 v165, v165, v189
    v_add_f32 v166, v166, v190
    v_add_f32 v167, v167, v191
    v_add_f32 v168, v168, v192
    v_add_f32 v169, v169, v193
    v_add_f32 v170, v170, v194
    v_add_f32 v171, v171, v195
    v_add_f32 v172, v172, v196
    v_add_f32 v173, v173, v197
    v_add_f32 v174, v174, v198
    v_add_f32 v175, v175, v199
    v_add_f32 v176, v176, v200
    v_add_f32 v177, v177, v201
    v_add_f32 v178, v178, v202
    v_add_f32 v179, v179, v203
    v_add_f32 v180, v180, v204
    v_add_f32 v181, v181, v205
    ds_read_b32 v184, v229 offset:28160
    ds_read_b32 v185, v229 offset:28416
    ds_read_b32 v186, v229 offset:28672
    ds_read_b32 v187, v229 offset:28928
    ds_read_b32 v188, v229 offset:29184
    ds_read_b32 v189, v229 offset:29440
    ds_read_b32 v190, v229 offset:29696
    ds_read_b32 v191, v229 offset:29952
    ds_read_b32 v192, v229 offset:30208
    ds_read_b32 v193, v229 offset:30464
    ds_read_b32 v194, v229 offset:30720
    ds_read_b32 v195, v229 offset:30976
    ds_read_b32 v196, v229 offset:31232
    ds_read_b32 v197, v229 offset:31488
    ds_read_b32 v198, v229 offset:31744
    ds_read_b32 v199, v229 offset:32000
    ds_read_b32 v200, v229 offset:32256
    ds_read_b32 v201, v229 offset:32512
    ds_read_b32 v202, v229 offset:32768
    ds_read_b32 v203, v229 offset:33024
    ds_read_b32 v204, v229 offset:33280
    ds_read_b32 v205, v229 offset:33536
    s_waitcnt lgkmcnt(0)
    v_add_f32 v160, v160, v184
    v_add_f32 v161, v161, v185
    v_add_f32 v162, v162, v186
    v_add_f32 v163, v163, v187
    v_add_f32 v164, v164, v188
    v_add_f32 v165, v165, v189
    v_add_f32 v166, v166, v190
    v_add_f32 v167, v167, v191
    v_add_f32 v168, v168, v192
    v_add_f32 v169, v169, v193
    v_add_f32 v170, v170, v194
    v_add_f32 v171, v171, v195
    v_add_f32 v172, v172, v196
    v_add_f32 v173, v173, v197
    v_add_f32 v174, v174, v198
    v_add_f32 v175, v175, v199
    v_add_f32 v176, v176, v200
    v_add_f32 v177, v177, v201
    v_add_f32 v178, v178, v202
    v_add_f32 v179, v179, v203
    v_add_f32 v180, v180, v204
    v_add_f32 v181, v181, v205
    ds_read_b32 v184, v229 offset:33792
    ds_read_b32 v185, v229 offset:34048
    ds_read_b32 v186, v229 offset:34304
    ds_read_b32 v187, v229 offset:34560
    ds_read_b32 v188, v229 offset:34816
    ds_read_b32 v189, v229 offset:35072
    ds_read_b32 v190, v229 offset:35328
    ds_read_b32 v191, v229 offset:35584
    ds_read_b32 v192, v229 offset:35840
    ds_read_b32 v193, v229 offset:36096
    ds_read_b32 v194, v229 offset:36352
    ds_read_b32 v195, v229 offset:36608
    ds_read_b32 v196, v229 offset:36864
    ds_read_b32 v197, v229 offset:37120
    ds_read_b32 v198, v229 offset:37376
    ds_read_b32 v199, v229 offset:37632
    ds_read_b32 v200, v229 offset:37888
    ds_read_b32 v201, v229 offset:38144
    ds_read_b32 v202, v229 offset:38400
    ds_read_b32 v203, v229 offset:38656
    ds_read_b32 v204, v229 offset:38912
    ds_read_b32 v205, v229 offset:39168
    s_waitcnt lgkmcnt(0)
    v_add_f32 v160, v160, v184
    v_add_f32 v161, v161, v185
    v_add_f32 v162, v162, v186
    v_add_f32 v163, v163, v187
    v_add_f32 v164, v164, v188
    v_add_f32 v165, v165, v189
    v_add_f32 v166, v166, v190
    v_add_f32 v167, v167, v191
    v_add_f32 v168, v168, v192
    v_add_f32 v169, v169, v193
    v_add_f32 v170, v170, v194
    v_add_f32 v171, v171, v195
    v_add_f32 v172, v172, v196
    v_add_f32 v173, v173, v197
    v_add_f32 v174, v174, v198
    v_add_f32 v175, v175, v199
    v_add_f32 v176, v176, v200
    v_add_f32 v177, v177, v201
    v_add_f32 v178, v178, v202
    v_add_f32 v179, v179, v203
    v_add_f32 v180, v180, v204
    v_add_f32 v181, v181, v205
    ds_read_b32 v184, v229 offset:39424
    ds_read_b32 v185, v229 offset:39680
    ds_read_b32 v186, v229 offset:39936
    ds_read_b32 v187, v229 offset:40192
    ds_read_b32 v188, v229 offset:40448
    ds_read_b32 v189, v229 offset:40704
    ds_read_b32 v190, v229 offset:40960
    ds_read_b32 v191, v229 offset:41216
    ds_read_b32 v192, v229 offset:41472
    ds_read_b32 v193, v229 offset:41728
    ds_read_b32 v194, v229 offset:41984
    ds_read_b32 v195, v229 offset:42240
    ds_read_b32 v196, v229 offset:42496
    ds_read_b32 v197, v229 offset:42752
    ds_read_b32 v198, v229 offset:43008
    ds_read_b32 v199, v229 offset:43264
    ds_read_b32 v200, v229 offset:43520
    ds_read_b32 v201, v229 offset:43776
    ds_read_b32 v202, v229 offset:44032
    ds_read_b32 v203, v229 offset:44288
    ds_read_b32 v204, v229 offset:44544
    ds_read_b32 v205, v229 offset:44800
    s_waitcnt lgkmcnt(0)
    v_add_f32 v160, v160, v184
    v_add_f32 v161, v161, v185
    v_add_f32 v162, v162, v186
    v_add_f32 v163, v163, v187
    v_add_f32 v164, v164, v188
    v_add_f32 v165, v165, v189
    v_add_f32 v166, v166, v190
    v_add_f32 v167, v167, v191
    v_add_f32 v168, v168, v192
    v_add_f32 v169, v169, v193
    v_add_f32 v170, v170, v194
    v_add_f32 v171, v171, v195
    v_add_f32 v172, v172, v196
    v_add_f32 v173, v173, v197
    v_add_f32 v174, v174, v198
    v_add_f32 v175, v175, v199
    v_add_f32 v176, v176, v200
    v_add_f32 v177, v177, v201
    v_add_f32 v178, v178, v202
    v_add_f32 v179, v179, v203
    v_add_f32 v180, v180, v204
    v_add_f32 v181, v181, v205
    s_barrier
SL_rows:
    s_lshl_b32 s66, s50, 3
    s_add_u32 s66, s66, s20
    s_lshl_b32 s67, s66, 4
    s_and_b32 s68, s67, 128
    s_and_b32 s67, s67, 0x70
    s_mul_i32 s69, s50, 1536
    s_add_u32 s69, s69, s21
    s_add_u32 s69, s69, s68
    s_mul_i32 s70, s66, 1536
    s_add_u32 s70, s70, 86016
    s_add_u32 s70, s70, s68
    v_mov_b32 v230, s69
    v_mov_b32 v231, s70
    v_cmp_gt_u32 vcc, 32, v240
    v_and_b32 v229, 31, v240
    v_lshlrev_b32 v229, 2, v229
    v_xor_b32 v229, s67, v229
    v_cndmask_b32 v244, v231, v230, vcc
    v_add_u32 v244, v244, v229
    v_cvt_pk_bf16_f32 v192, v160, v161
    ds_write_b32 v244, v192 offset:0
    v_cvt_pk_bf16_f32 v193, v162, v163
    ds_write_b32 v244, v193 offset:128
    v_cvt_pk_bf16_f32 v194, v164, v165
    ds_write_b32 v244, v194 offset:256
    v_cvt_pk_bf16_f32 v195, v166, v167
    ds_write_b32 v244, v195 offset:384
    v_cvt_pk_bf16_f32 v196, v168, v169
    ds_write_b32 v244, v196 offset:512
    v_cvt_pk_bf16_f32 v197, v170, v171
    ds_write_b32 v244, v197 offset:640
    v_cvt_pk_bf16_f32 v198, v172, v173
    ds_write_b32 v244, v198 offset:768
    v_cvt_pk_bf16_f32 v199, v174, v175
    ds_write_b32 v244, v199 offset:896
    v_cvt_pk_bf16_f32 v200, v176, v177
    ds_write_b32 v244, v200 offset:1024
    v_cvt_pk_bf16_f32 v201, v178, v179
    ds_write_b32 v244, v201 offset:1152
    v_cvt_pk_bf16_f32 v202, v180, v181
    ds_write_b32 v244, v202 offset:1280
    s_lshl_b32 s66, s66, 3
    s_add_u32 s66, s66, 163328
    v_mov_b32 v229, s66
    ds_write_b64 v229, v[230:231]
    s_add_u32 s50, s50, 1
    s_cmp_lt_u32 s50, 5
    s_cbranch_scc1 SL_node
    s_waitcnt lgkmcnt(0)
    s_barrier
    v_mov_b32 v176, v240
    s_load_dwordx4 s[84:87], s[0:1], 48
    s_mul_i32 s22, s20, 20
    s_waitcnt lgkmcnt(0)
    v_mov_b32 v4, 0
    v_mov_b32 v5, 0
    v_mov_b32 v6, 0
    v_mov_b32 v7, 0
    v_mov_b32 v8, 0
    v_mov_b32 v9, 0
    v_mov_b32 v10, 0
    v_mov_b32 v11, 0
    v_mov_b32 v12, 0
    v_mov_b32 v13, 0
    v_mov_b32 v14, 0
    v_mov_b32 v15, 0
    v_mov_b32 v16, 0
    v_mov_b32 v17, 0
    v_mov_b32 v18, 0
    v_mov_b32 v19, 0
    v_mov_b32 v20, 0
    v_mov_b32 v21, 0
    v_mov_b32 v22, 0
    v_mov_b32 v23, 0
    s_mul_i32 s24, s22, 3277
    s_lshr_b32 s24, s24, 16
    s_mul_i32 s68, s24, 20
    s_sub_u32 s68, s22, s68
    s_cmp_lt_u32 s68, 8
    s_cselect_b64 s[66:67], s[84:85], s[86:87]
    s_cselect_b32 s25, 0, 8
    s_sub_u32 s68, s68, s25
    s_and_b32 s25, s68, 1
    s_lshr_b32 s68, s68, 1
    s_lshl_b32 s68, s68, 14
    s_lshl_b32 s25, s25, 12
    s_add_u32 s68, s68, s25
    s_lshl_b32 s24, s24, 5
    s_add_u32 s68, s68, s24
    v_lshrrev_b32 v2, 4, v176
    v_lshlrev_b32 v2, 10, v2
    v_and_b32 v3, 15, v176
    v_lshl_add_u32 v2, v3, 1, v2
    v_add_u32 v2, s68, v2
    v_add_u32 v3, 8192, v2
    global_load_ushort v144, v2, s[66:67] offset:0
    global_load_short_d16_hi v4, v3, s[66:67] offset:0
    global_load_ushort v145, v2, s[66:67] offset:256
    global_load_short_d16_hi v5, v3, s[66:67] offset:256
    global_load_ushort v146, v2, s[66:67] offset:512
    global_load_short_d16_hi v6, v3, s[66:67] offset:512
    global_load_ushort v147, v2, s[66:67] offset:768
    global_load_short_d16_hi v7, v3, s[66:67] offset:768
    s_add_u32 s22, s22, 1
    s_mul_i32 s24, s22, 3277
    s_lshr_b32 s24, s24, 16
    s_mul_i32 s68, s24, 20
    s_sub_u32 s68, s22, s68
    s_cmp_lt_u32 s68, 8
    s_cselect_b64 s[66:67], s[84:85], s[86:87]
    s_cselect_b32 s25, 0, 8
    s_sub_u32 s68, s68, s25
    s_and_b32 s25, s68, 1
    s_lshr_b32 s68, s68, 1
    s_lshl_b32 s68, s68, 14
    s_lshl_b32 s25, s25, 12
    s_add_u32 s68, s68, s25
    s_lshl_b32 s24, s24, 5
    s_add_u32 s68, s68, s24
    v_lshrrev_b32 v2, 4, v176
    v_lshlrev_b32 v2, 10, v2
    v_and_b32 v3, 15, v176
    v_lshl_add_u32 v2, v3, 1, v2
    v_add_u32 v2, s68, v2
    v_add_u32 v3, 8192, v2
    global_load_ushort v148, v2, s[66:67] offset:0
    global_load_short_d16_hi v8, v3, s[66:67] offset:0
    global_load_ushort v149, v2, s[66:67] offset:256
    global_load_short_d16_hi v9, v3, s[66:67] offset:256
    global_load_ushort v150, v2, s[66:67] offset:512
    global_load_short_d16_hi v10, v3, s[66:67] offset:512
    global_load_ushort v151, v2, s[66:67] offset:768
    global_load_short_d16_hi v11, v3, s[66:67] offset:768
    s_add_u32 s22, s22, 1
    s_mul_i32 s24, s22, 3277
    s_lshr_b32 s24, s24, 16
    s_mul_i32 s68, s24, 20
    s_sub_u32 s68, s22, s68
    s_cmp_lt_u32 s68, 8
    s_cselect_b64 s[66:67], s[84:85], s[86:87]
    s_cselect_b32 s25, 0, 8
    s_sub_u32 s68, s68, s25
    s_and_b32 s25, s68, 1
    s_lshr_b32 s68, s68, 1
    s_lshl_b32 s68, s68, 14
    s_lshl_b32 s25, s25, 12
    s_add_u32 s68, s68, s25
    s_lshl_b32 s24, s24, 5
    s_add_u32 s68, s68, s24
    v_lshrrev_b32 v2, 4, v176
    v_lshlrev_b32 v2, 10, v2
    v_and_b32 v3, 15, v176
    v_lshl_add_u32 v2, v3, 1, v2
    v_add_u32 v2, s68, v2
    v_add_u32 v3, 8192, v2
    global_load_ushort v96, v2, s[66:67] offset:0
    global_load_short_d16_hi v12, v3, s[66:67] offset:0
    global_load_ushort v97, v2, s[66:67] offset:256
    global_load_short_d16_hi v13, v3, s[66:67] offset:256
    global_load_ushort v98, v2, s[66:67] offset:512
    global_load_short_d16_hi v14, v3, s[66:67] offset:512
    global_load_ushort v99, v2, s[66:67] offset:768
    global_load_short_d16_hi v15, v3, s[66:67] offset:768
    s_add_u32 s22, s22, 1
    s_mul_i32 s24, s22, 3277
    s_lshr_b32 s24, s24, 16
    s_mul_i32 s68, s24, 20
    s_sub_u32 s68, s22, s68
    s_cmp_lt_u32 s68, 8
    s_cselect_b64 s[66:67], s[84:85], s[86:87]
    s_cselect_b32 s25, 0, 8
    s_sub_u32 s68, s68, s25
    s_and_b32 s25, s68, 1
    s_lshr_b32 s68, s68, 1
    s_lshl_b32 s68, s68, 14
    s_lshl_b32 s25, s25, 12
    s_add_u32 s68, s68, s25
    s_lshl_b32 s24, s24, 5
    s_add_u32 s68, s68, s24
    v_lshrrev_b32 v2, 4, v176
    v_lshlrev_b32 v2, 10, v2
    v_and_b32 v3, 15, v176
    v_lshl_add_u32 v2, v3, 1, v2
    v_add_u32 v2, s68, v2
    v_add_u32 v3, 8192, v2
    global_load_ushort v100, v2, s[66:67] offset:0
    global_load_short_d16_hi v16, v3, s[66:67] offset:0
    global_load_ushort v101, v2, s[66:67] offset:256
    global_load_short_d16_hi v17, v3, s[66:67] offset:256
    global_load_ushort v102, v2, s[66:67] offset:512
    global_load_short_d16_hi v18, v3, s[66:67] offset:512
    global_load_ushort v103, v2, s[66:67] offset:768
    global_load_short_d16_hi v19, v3, s[66:67] offset:768
    s_add_u32 s22, s22, 1
    s_mul_i32 s24, s22, 3277
    s_lshr_b32 s24, s24, 16
    s_mul_i32 s68, s24, 20
    s_sub_u32 s68, s22, s68
    s_cmp_lt_u32 s68, 8
    s_cselect_b64 s[66:67], s[84:85], s[86:87]
    s_cselect_b32 s25, 0, 8
    s_sub_u32 s68, s68, s25
    s_and_b32 s25, s68, 1
    s_lshr_b32 s68, s68, 1
    s_lshl_b32 s68, s68, 14
    s_lshl_b32 s25, s25, 12
    s_add_u32 s68, s68, s25
    s_lshl_b32 s24, s24, 5
    s_add_u32 s68, s68, s24
    v_lshrrev_b32 v2, 4, v176
    v_lshlrev_b32 v2, 10, v2
    v_and_b32 v3, 15, v176
    v_lshl_add_u32 v2, v3, 1, v2
    v_add_u32 v2, s68, v2
    v_add_u32 v3, 8192, v2
    global_load_ushort v160, v2, s[66:67] offset:0
    global_load_short_d16_hi v20, v3, s[66:67] offset:0
    global_load_ushort v161, v2, s[66:67] offset:256
    global_load_short_d16_hi v21, v3, s[66:67] offset:256
    global_load_ushort v162, v2, s[66:67] offset:512
    global_load_short_d16_hi v22, v3, s[66:67] offset:512
    global_load_ushort v163, v2, s[66:67] offset:768
    global_load_short_d16_hi v23, v3, s[66:67] offset:768
    s_add_u32 s22, s22, 1
    s_waitcnt vmcnt(0)
    v_or_b32 v144, v144, v4
    v_or_b32 v145, v145, v5
    v_or_b32 v146, v146, v6
    v_or_b32 v147, v147, v7
    v_or_b32 v148, v148, v8
    v_or_b32 v149, v149, v9
    v_or_b32 v150, v150, v10
    v_or_b32 v151, v151, v11
    v_or_b32 v96, v96, v12
    v_or_b32 v97, v97, v13
    v_or_b32 v98, v98, v14
    v_or_b32 v99, v99, v15
    v_or_b32 v100, v100, v16
    v_or_b32 v101, v101, v17
    v_or_b32 v102, v102, v18
    v_or_b32 v103, v103, v19
    v_or_b32 v160, v160, v20
    v_or_b32 v161, v161, v21
    v_or_b32 v162, v162, v22
    v_or_b32 v163, v163, v23
    v_mov_b32 v4, 0
    v_mov_b32 v5, 0
    v_mov_b32 v6, 0
    v_mov_b32 v7, 0
    v_mov_b32 v8, 0
    v_mov_b32 v9, 0
    v_mov_b32 v10, 0
    v_mov_b32 v11, 0
    v_mov_b32 v12, 0
    v_mov_b32 v13, 0
    v_mov_b32 v14, 0
    v_mov_b32 v15, 0
    v_mov_b32 v16, 0
    v_mov_b32 v17, 0
    v_mov_b32 v18, 0
    v_mov_b32 v19, 0
    v_mov_b32 v20, 0
    v_mov_b32 v21, 0
    v_mov_b32 v22, 0
    v_mov_b32 v23, 0
    s_mul_i32 s24, s22, 3277
    s_lshr_b32 s24, s24, 16
    s_mul_i32 s68, s24, 20
    s_sub_u32 s68, s22, s68
    s_cmp_lt_u32 s68, 8
    s_cselect_b64 s[66:67], s[84:85], s[86:87]
    s_cselect_b32 s25, 0, 8
    s_sub_u32 s68, s68, s25
    s_and_b32 s25, s68, 1
    s_lshr_b32 s68, s68, 1
    s_lshl_b32 s68, s68, 14
    s_lshl_b32 s25, s25, 12
    s_add_u32 s68, s68, s25
    s_lshl_b32 s24, s24, 5
    s_add_u32 s68, s68, s24
    v_lshrrev_b32 v2, 4, v176
    v_lshlrev_b32 v2, 10, v2
    v_and_b32 v3, 15, v176
    v_lshl_add_u32 v2, v3, 1, v2
    v_add_u32 v2, s68, v2
    v_add_u32 v3, 8192, v2
    global_load_ushort v164, v2, s[66:67] offset:0
    global_load_short_d16_hi v4, v3, s[66:67] offset:0
    global_load_ushort v165, v2, s[66:67] offset:256
    global_load_short_d16_hi v5, v3, s[66:67] offset:256
    global_load_ushort v166, v2, s[66:67] offset:512
    global_load_short_d16_hi v6, v3, s[66:67] offset:512
    global_load_ushort v167, v2, s[66:67] offset:768
    global_load_short_d16_hi v7, v3, s[66:67] offset:768
    s_add_u32 s22, s22, 1
    s_mul_i32 s24, s22, 3277
    s_lshr_b32 s24, s24, 16
    s_mul_i32 s68, s24, 20
    s_sub_u32 s68, s22, s68
    s_cmp_lt_u32 s68, 8
    s_cselect_b64 s[66:67], s[84:85], s[86:87]
    s_cselect_b32 s25, 0, 8
    s_sub_u32 s68, s68, s25
    s_and_b32 s25, s68, 1
    s_lshr_b32 s68, s68, 1
    s_lshl_b32 s68, s68, 14
    s_lshl_b32 s25, s25, 12
    s_add_u32 s68, s68, s25
    s_lshl_b32 s24, s24, 5
    s_add_u32 s68, s68, s24
    v_lshrrev_b32 v2, 4, v176
    v_lshlrev_b32 v2, 10, v2
    v_and_b32 v3, 15, v176
    v_lshl_add_u32 v2, v3, 1, v2
    v_add_u32 v2, s68, v2
    v_add_u32 v3, 8192, v2
    global_load_ushort v104, v2, s[66:67] offset:0
    global_load_short_d16_hi v8, v3, s[66:67] offset:0
    global_load_ushort v105, v2, s[66:67] offset:256
    global_load_short_d16_hi v9, v3, s[66:67] offset:256
    global_load_ushort v106, v2, s[66:67] offset:512
    global_load_short_d16_hi v10, v3, s[66:67] offset:512
    global_load_ushort v107, v2, s[66:67] offset:768
    global_load_short_d16_hi v11, v3, s[66:67] offset:768
    s_add_u32 s22, s22, 1
    s_mul_i32 s24, s22, 3277
    s_lshr_b32 s24, s24, 16
    s_mul_i32 s68, s24, 20
    s_sub_u32 s68, s22, s68
    s_cmp_lt_u32 s68, 8
    s_cselect_b64 s[66:67], s[84:85], s[86:87]
    s_cselect_b32 s25, 0, 8
    s_sub_u32 s68, s68, s25
    s_and_b32 s25, s68, 1
    s_lshr_b32 s68, s68, 1
    s_lshl_b32 s68, s68, 14
    s_lshl_b32 s25, s25, 12
    s_add_u32 s68, s68, s25
    s_lshl_b32 s24, s24, 5
    s_add_u32 s68, s68, s24
    v_lshrrev_b32 v2, 4, v176
    v_lshlrev_b32 v2, 10, v2
    v_and_b32 v3, 15, v176
    v_lshl_add_u32 v2, v3, 1, v2
    v_add_u32 v2, s68, v2
    v_add_u32 v3, 8192, v2
    global_load_ushort v108, v2, s[66:67] offset:0
    global_load_short_d16_hi v12, v3, s[66:67] offset:0
    global_load_ushort v109, v2, s[66:67] offset:256
    global_load_short_d16_hi v13, v3, s[66:67] offset:256
    global_load_ushort v110, v2, s[66:67] offset:512
    global_load_short_d16_hi v14, v3, s[66:67] offset:512
    global_load_ushort v111, v2, s[66:67] offset:768
    global_load_short_d16_hi v15, v3, s[66:67] offset:768
    s_add_u32 s22, s22, 1
    s_mul_i32 s24, s22, 3277
    s_lshr_b32 s24, s24, 16
    s_mul_i32 s68, s24, 20
    s_sub_u32 s68, s22, s68
    s_cmp_lt_u32 s68, 8
    s_cselect_b64 s[66:67], s[84:85], s[86:87]
    s_cselect_b32 s25, 0, 8
    s_sub_u32 s68, s68, s25
    s_and_b32 s25, s68, 1
    s_lshr_b32 s68, s68, 1
    s_lshl_b32 s68, s68, 14
    s_lshl_b32 s25, s25, 12
    s_add_u32 s68, s68, s25
    s_lshl_b32 s24, s24, 5
    s_add_u32 s68, s68, s24
    v_lshrrev_b32 v2, 4, v176
    v_lshlrev_b32 v2, 10, v2
    v_and_b32 v3, 15, v176
    v_lshl_add_u32 v2, v3, 1, v2
    v_add_u32 v2, s68, v2
    v_add_u32 v3, 8192, v2
    global_load_ushort v120, v2, s[66:67] offset:0
    global_load_short_d16_hi v16, v3, s[66:67] offset:0
    global_load_ushort v121, v2, s[66:67] offset:256
    global_load_short_d16_hi v17, v3, s[66:67] offset:256
    global_load_ushort v122, v2, s[66:67] offset:512
    global_load_short_d16_hi v18, v3, s[66:67] offset:512
    global_load_ushort v123, v2, s[66:67] offset:768
    global_load_short_d16_hi v19, v3, s[66:67] offset:768
    s_add_u32 s22, s22, 1
    s_mul_i32 s24, s22, 3277
    s_lshr_b32 s24, s24, 16
    s_mul_i32 s68, s24, 20
    s_sub_u32 s68, s22, s68
    s_cmp_lt_u32 s68, 8
    s_cselect_b64 s[66:67], s[84:85], s[86:87]
    s_cselect_b32 s25, 0, 8
    s_sub_u32 s68, s68, s25
    s_and_b32 s25, s68, 1
    s_lshr_b32 s68, s68, 1
    s_lshl_b32 s68, s68, 14
    s_lshl_b32 s25, s25, 12
    s_add_u32 s68, s68, s25
    s_lshl_b32 s24, s24, 5
    s_add_u32 s68, s68, s24
    v_lshrrev_b32 v2, 4, v176
    v_lshlrev_b32 v2, 10, v2
    v_and_b32 v3, 15, v176
    v_lshl_add_u32 v2, v3, 1, v2
    v_add_u32 v2, s68, v2
    v_add_u32 v3, 8192, v2
    global_load_ushort v124, v2, s[66:67] offset:0
    global_load_short_d16_hi v20, v3, s[66:67] offset:0
    global_load_ushort v125, v2, s[66:67] offset:256
    global_load_short_d16_hi v21, v3, s[66:67] offset:256
    global_load_ushort v126, v2, s[66:67] offset:512
    global_load_short_d16_hi v22, v3, s[66:67] offset:512
    global_load_ushort v127, v2, s[66:67] offset:768
    global_load_short_d16_hi v23, v3, s[66:67] offset:768
    s_add_u32 s22, s22, 1
    s_waitcnt vmcnt(0)
    v_or_b32 v164, v164, v4
    v_or_b32 v165, v165, v5
    v_or_b32 v166, v166, v6
    v_or_b32 v167, v167, v7
    v_or_b32 v104, v104, v8
    v_or_b32 v105, v105, v9
    v_or_b32 v106, v106, v10
    v_or_b32 v107, v107, v11
    v_or_b32 v108, v108, v12
    v_or_b32 v109, v109, v13
    v_or_b32 v110, v110, v14
    v_or_b32 v111, v111, v15
    v_or_b32 v120, v120, v16
    v_or_b32 v121, v121, v17
    v_or_b32 v122, v122, v18
    v_or_b32 v123, v123, v19
    v_or_b32 v124, v124, v20
    v_or_b32 v125, v125, v21
    v_or_b32 v126, v126, v22
    v_or_b32 v127, v127, v23
    v_mov_b32 v4, 0
    v_mov_b32 v5, 0
    v_mov_b32 v6, 0
    v_mov_b32 v7, 0
    v_mov_b32 v8, 0
    v_mov_b32 v9, 0
    v_mov_b32 v10, 0
    v_mov_b32 v11, 0
    v_mov_b32 v12, 0
    v_mov_b32 v13, 0
    v_mov_b32 v14, 0
    v_mov_b32 v15, 0
    v_mov_b32 v16, 0
    v_mov_b32 v17, 0
    v_mov_b32 v18, 0
    v_mov_b32 v19, 0
    v_mov_b32 v20, 0
    v_mov_b32 v21, 0
    v_mov_b32 v22, 0
    v_mov_b32 v23, 0
    s_mul_i32 s24, s22, 3277
    s_lshr_b32 s24, s24, 16
    s_mul_i32 s68, s24, 20
    s_sub_u32 s68, s22, s68
    s_cmp_lt_u32 s68, 8
    s_cselect_b64 s[66:67], s[84:85], s[86:87]
    s_cselect_b32 s25, 0, 8
    s_sub_u32 s68, s68, s25
    s_and_b32 s25, s68, 1
    s_lshr_b32 s68, s68, 1
    s_lshl_b32 s68, s68, 14
    s_lshl_b32 s25, s25, 12
    s_add_u32 s68, s68, s25
    s_lshl_b32 s24, s24, 5
    s_add_u32 s68, s68, s24
    v_lshrrev_b32 v2, 4, v176
    v_lshlrev_b32 v2, 10, v2
    v_and_b32 v3, 15, v176
    v_lshl_add_u32 v2, v3, 1, v2
    v_add_u32 v2, s68, v2
    v_add_u32 v3, 8192, v2
    global_load_ushort v128, v2, s[66:67] offset:0
    global_load_short_d16_hi v4, v3, s[66:67] offset:0
    global_load_ushort v129, v2, s[66:67] offset:256
    global_load_short_d16_hi v5, v3, s[66:67] offset:256
    global_load_ushort v130, v2, s[66:67] offset:512
    global_load_short_d16_hi v6, v3, s[66:67] offset:512
    global_load_ushort v131, v2, s[66:67] offset:768
    global_load_short_d16_hi v7, v3, s[66:67] offset:768
    s_add_u32 s22, s22, 1
    s_mul_i32 s24, s22, 3277
    s_lshr_b32 s24, s24, 16
    s_mul_i32 s68, s24, 20
    s_sub_u32 s68, s22, s68
    s_cmp_lt_u32 s68, 8
    s_cselect_b64 s[66:67], s[84:85], s[86:87]
    s_cselect_b32 s25, 0, 8
    s_sub_u32 s68, s68, s25
    s_and_b32 s25, s68, 1
    s_lshr_b32 s68, s68, 1
    s_lshl_b32 s68, s68, 14
    s_lshl_b32 s25, s25, 12
    s_add_u32 s68, s68, s25
    s_lshl_b32 s24, s24, 5
    s_add_u32 s68, s68, s24
    v_lshrrev_b32 v2, 4, v176
    v_lshlrev_b32 v2, 10, v2
    v_and_b32 v3, 15, v176
    v_lshl_add_u32 v2, v3, 1, v2
    v_add_u32 v2, s68, v2
    v_add_u32 v3, 8192, v2
    global_load_ushort v132, v2, s[66:67] offset:0
    global_load_short_d16_hi v8, v3, s[66:67] offset:0
    global_load_ushort v133, v2, s[66:67] offset:256
    global_load_short_d16_hi v9, v3, s[66:67] offset:256
    global_load_ushort v134, v2, s[66:67] offset:512
    global_load_short_d16_hi v10, v3, s[66:67] offset:512
    global_load_ushort v135, v2, s[66:67] offset:768
    global_load_short_d16_hi v11, v3, s[66:67] offset:768
    s_add_u32 s22, s22, 1
    s_mul_i32 s24, s22, 3277
    s_lshr_b32 s24, s24, 16
    s_mul_i32 s68, s24, 20
    s_sub_u32 s68, s22, s68
    s_cmp_lt_u32 s68, 8
    s_cselect_b64 s[66:67], s[84:85], s[86:87]
    s_cselect_b32 s25, 0, 8
    s_sub_u32 s68, s68, s25
    s_and_b32 s25, s68, 1
    s_lshr_b32 s68, s68, 1
    s_lshl_b32 s68, s68, 14
    s_lshl_b32 s25, s25, 12
    s_add_u32 s68, s68, s25
    s_lshl_b32 s24, s24, 5
    s_add_u32 s68, s68, s24
    v_lshrrev_b32 v2, 4, v176
    v_lshlrev_b32 v2, 10, v2
    v_and_b32 v3, 15, v176
    v_lshl_add_u32 v2, v3, 1, v2
    v_add_u32 v2, s68, v2
    v_add_u32 v3, 8192, v2
    global_load_ushort v152, v2, s[66:67] offset:0
    global_load_short_d16_hi v12, v3, s[66:67] offset:0
    global_load_ushort v153, v2, s[66:67] offset:256
    global_load_short_d16_hi v13, v3, s[66:67] offset:256
    global_load_ushort v154, v2, s[66:67] offset:512
    global_load_short_d16_hi v14, v3, s[66:67] offset:512
    global_load_ushort v155, v2, s[66:67] offset:768
    global_load_short_d16_hi v15, v3, s[66:67] offset:768
    s_add_u32 s22, s22, 1
    s_mul_i32 s24, s22, 3277
    s_lshr_b32 s24, s24, 16
    s_mul_i32 s68, s24, 20
    s_sub_u32 s68, s22, s68
    s_cmp_lt_u32 s68, 8
    s_cselect_b64 s[66:67], s[84:85], s[86:87]
    s_cselect_b32 s25, 0, 8
    s_sub_u32 s68, s68, s25
    s_and_b32 s25, s68, 1
    s_lshr_b32 s68, s68, 1
    s_lshl_b32 s68, s68, 14
    s_lshl_b32 s25, s25, 12
    s_add_u32 s68, s68, s25
    s_lshl_b32 s24, s24, 5
    s_add_u32 s68, s68, s24
    v_lshrrev_b32 v2, 4, v176
    v_lshlrev_b32 v2, 10, v2
    v_and_b32 v3, 15, v176
    v_lshl_add_u32 v2, v3, 1, v2
    v_add_u32 v2, s68, v2
    v_add_u32 v3, 8192, v2
    global_load_ushort v156, v2, s[66:67] offset:0
    global_load_short_d16_hi v16, v3, s[66:67] offset:0
    global_load_ushort v157, v2, s[66:67] offset:256
    global_load_short_d16_hi v17, v3, s[66:67] offset:256
    global_load_ushort v158, v2, s[66:67] offset:512
    global_load_short_d16_hi v18, v3, s[66:67] offset:512
    global_load_ushort v159, v2, s[66:67] offset:768
    global_load_short_d16_hi v19, v3, s[66:67] offset:768
    s_add_u32 s22, s22, 1
    s_mul_i32 s24, s22, 3277
    s_lshr_b32 s24, s24, 16
    s_mul_i32 s68, s24, 20
    s_sub_u32 s68, s22, s68
    s_cmp_lt_u32 s68, 8
    s_cselect_b64 s[66:67], s[84:85], s[86:87]
    s_cselect_b32 s25, 0, 8
    s_sub_u32 s68, s68, s25
    s_and_b32 s25, s68, 1
    s_lshr_b32 s68, s68, 1
    s_lshl_b32 s68, s68, 14
    s_lshl_b32 s25, s25, 12
    s_add_u32 s68, s68, s25
    s_lshl_b32 s24, s24, 5
    s_add_u32 s68, s68, s24
    v_lshrrev_b32 v2, 4, v176
    v_lshlrev_b32 v2, 10, v2
    v_and_b32 v3, 15, v176
    v_lshl_add_u32 v2, v3, 1, v2
    v_add_u32 v2, s68, v2
    v_add_u32 v3, 8192, v2
    global_load_ushort v136, v2, s[66:67] offset:0
    global_load_short_d16_hi v20, v3, s[66:67] offset:0
    global_load_ushort v137, v2, s[66:67] offset:256
    global_load_short_d16_hi v21, v3, s[66:67] offset:256
    global_load_ushort v138, v2, s[66:67] offset:512
    global_load_short_d16_hi v22, v3, s[66:67] offset:512
    global_load_ushort v139, v2, s[66:67] offset:768
    global_load_short_d16_hi v23, v3, s[66:67] offset:768
    s_add_u32 s22, s22, 1
    s_waitcnt vmcnt(0)
    v_or_b32 v128, v128, v4
    v_or_b32 v129, v129, v5
    v_or_b32 v130, v130, v6
    v_or_b32 v131, v131, v7
    v_or_b32 v132, v132, v8
    v_or_b32 v133, v133, v9
    v_or_b32 v134, v134, v10
    v_or_b32 v135, v135, v11
    v_or_b32 v152, v152, v12
    v_or_b32 v153, v153, v13
    v_or_b32 v154, v154, v14
    v_or_b32 v155, v155, v15
    v_or_b32 v156, v156, v16
    v_or_b32 v157, v157, v17
    v_or_b32 v158, v158, v18
    v_or_b32 v159, v159, v19
    v_or_b32 v136, v136, v20
    v_or_b32 v137, v137, v21
    v_or_b32 v138, v138, v22
    v_or_b32 v139, v139, v23
    v_mov_b32 v4, 0
    v_mov_b32 v5, 0
    v_mov_b32 v6, 0
    v_mov_b32 v7, 0
    v_mov_b32 v8, 0
    v_mov_b32 v9, 0
    v_mov_b32 v10, 0
    v_mov_b32 v11, 0
    v_mov_b32 v12, 0
    v_mov_b32 v13, 0
    v_mov_b32 v14, 0
    v_mov_b32 v15, 0
    v_mov_b32 v16, 0
    v_mov_b32 v17, 0
    v_mov_b32 v18, 0
    v_mov_b32 v19, 0
    v_mov_b32 v20, 0
    v_mov_b32 v21, 0
    v_mov_b32 v22, 0
    v_mov_b32 v23, 0
    s_mul_i32 s24, s22, 3277
    s_lshr_b32 s24, s24, 16
    s_mul_i32 s68, s24, 20
    s_sub_u32 s68, s22, s68
    s_cmp_lt_u32 s68, 8
    s_cselect_b64 s[66:67], s[84:85], s[86:87]
    s_cselect_b32 s25, 0, 8
    s_sub_u32 s68, s68, s25
    s_and_b32 s25, s68, 1
    s_lshr_b32 s68, s68, 1
    s_lshl_b32 s68, s68, 14
    s_lshl_b32 s25, s25, 12
    s_add_u32 s68, s68, s25
    s_lshl_b32 s24, s24, 5
    s_add_u32 s68, s68, s24
    v_lshrrev_b32 v2, 4, v176
    v_lshlrev_b32 v2, 10, v2
    v_and_b32 v3, 15, v176
    v_lshl_add_u32 v2, v3, 1, v2
    v_add_u32 v2, s68, v2
    v_add_u32 v3, 8192, v2
    global_load_ushort v140, v2, s[66:67] offset:0
    global_load_short_d16_hi v4, v3, s[66:67] offset:0
    global_load_ushort v141, v2, s[66:67] offset:256
    global_load_short_d16_hi v5, v3, s[66:67] offset:256
    global_load_ushort v142, v2, s[66:67] offset:512
    global_load_short_d16_hi v6, v3, s[66:67] offset:512
    global_load_ushort v143, v2, s[66:67] offset:768
    global_load_short_d16_hi v7, v3, s[66:67] offset:768
    s_add_u32 s22, s22, 1
    s_mul_i32 s24, s22, 3277
    s_lshr_b32 s24, s24, 16
    s_mul_i32 s68, s24, 20
    s_sub_u32 s68, s22, s68
    s_cmp_lt_u32 s68, 8
    s_cselect_b64 s[66:67], s[84:85], s[86:87]
    s_cselect_b32 s25, 0, 8
    s_sub_u32 s68, s68, s25
    s_and_b32 s25, s68, 1
    s_lshr_b32 s68, s68, 1
    s_lshl_b32 s68, s68, 14
    s_lshl_b32 s25, s25, 12
    s_add_u32 s68, s68, s25
    s_lshl_b32 s24, s24, 5
    s_add_u32 s68, s68, s24
    v_lshrrev_b32 v2, 4, v176
    v_lshlrev_b32 v2, 10, v2
    v_and_b32 v3, 15, v176
    v_lshl_add_u32 v2, v3, 1, v2
    v_add_u32 v2, s68, v2
    v_add_u32 v3, 8192, v2
    global_load_ushort v168, v2, s[66:67] offset:0
    global_load_short_d16_hi v8, v3, s[66:67] offset:0
    global_load_ushort v169, v2, s[66:67] offset:256
    global_load_short_d16_hi v9, v3, s[66:67] offset:256
    global_load_ushort v170, v2, s[66:67] offset:512
    global_load_short_d16_hi v10, v3, s[66:67] offset:512
    global_load_ushort v171, v2, s[66:67] offset:768
    global_load_short_d16_hi v11, v3, s[66:67] offset:768
    s_add_u32 s22, s22, 1
    s_mul_i32 s24, s22, 3277
    s_lshr_b32 s24, s24, 16
    s_mul_i32 s68, s24, 20
    s_sub_u32 s68, s22, s68
    s_cmp_lt_u32 s68, 8
    s_cselect_b64 s[66:67], s[84:85], s[86:87]
    s_cselect_b32 s25, 0, 8
    s_sub_u32 s68, s68, s25
    s_and_b32 s25, s68, 1
    s_lshr_b32 s68, s68, 1
    s_lshl_b32 s68, s68, 14
    s_lshl_b32 s25, s25, 12
    s_add_u32 s68, s68, s25
    s_lshl_b32 s24, s24, 5
    s_add_u32 s68, s68, s24
    v_lshrrev_b32 v2, 4, v176
    v_lshlrev_b32 v2, 10, v2
    v_and_b32 v3, 15, v176
    v_lshl_add_u32 v2, v3, 1, v2
    v_add_u32 v2, s68, v2
    v_add_u32 v3, 8192, v2
    global_load_ushort v172, v2, s[66:67] offset:0
    global_load_short_d16_hi v12, v3, s[66:67] offset:0
    global_load_ushort v173, v2, s[66:67] offset:256
    global_load_short_d16_hi v13, v3, s[66:67] offset:256
    global_load_ushort v174, v2, s[66:67] offset:512
    global_load_short_d16_hi v14, v3, s[66:67] offset:512
    global_load_ushort v175, v2, s[66:67] offset:768
    global_load_short_d16_hi v15, v3, s[66:67] offset:768
    s_add_u32 s22, s22, 1
    s_mul_i32 s24, s22, 3277
    s_lshr_b32 s24, s24, 16
    s_mul_i32 s68, s24, 20
    s_sub_u32 s68, s22, s68
    s_cmp_lt_u32 s68, 8
    s_cselect_b64 s[66:67], s[84:85], s[86:87]
    s_cselect_b32 s25, 0, 8
    s_sub_u32 s68, s68, s25
    s_and_b32 s25, s68, 1
    s_lshr_b32 s68, s68, 1
    s_lshl_b32 s68, s68, 14
    s_lshl_b32 s25, s25, 12
    s_add_u32 s68, s68, s25
    s_lshl_b32 s24, s24, 5
    s_add_u32 s68, s68, s24
    v_lshrrev_b32 v2, 4, v176
    v_lshlrev_b32 v2, 10, v2
    v_and_b32 v3, 15, v176
    v_lshl_add_u32 v2, v3, 1, v2
    v_add_u32 v2, s68, v2
    v_add_u32 v3, 8192, v2
    global_load_ushort v112, v2, s[66:67] offset:0
    global_load_short_d16_hi v16, v3, s[66:67] offset:0
    global_load_ushort v113, v2, s[66:67] offset:256
    global_load_short_d16_hi v17, v3, s[66:67] offset:256
    global_load_ushort v114, v2, s[66:67] offset:512
    global_load_short_d16_hi v18, v3, s[66:67] offset:512
    global_load_ushort v115, v2, s[66:67] offset:768
    global_load_short_d16_hi v19, v3, s[66:67] offset:768
    s_add_u32 s22, s22, 1
    s_mul_i32 s24, s22, 3277
    s_lshr_b32 s24, s24, 16
    s_mul_i32 s68, s24, 20
    s_sub_u32 s68, s22, s68
    s_cmp_lt_u32 s68, 8
    s_cselect_b64 s[66:67], s[84:85], s[86:87]
    s_cselect_b32 s25, 0, 8
    s_sub_u32 s68, s68, s25
    s_and_b32 s25, s68, 1
    s_lshr_b32 s68, s68, 1
    s_lshl_b32 s68, s68, 14
    s_lshl_b32 s25, s25, 12
    s_add_u32 s68, s68, s25
    s_lshl_b32 s24, s24, 5
    s_add_u32 s68, s68, s24
    v_lshrrev_b32 v2, 4, v176
    v_lshlrev_b32 v2, 10, v2
    v_and_b32 v3, 15, v176
    v_lshl_add_u32 v2, v3, 1, v2
    v_add_u32 v2, s68, v2
    v_add_u32 v3, 8192, v2
    global_load_ushort v116, v2, s[66:67] offset:0
    global_load_short_d16_hi v20, v3, s[66:67] offset:0
    global_load_ushort v117, v2, s[66:67] offset:256
    global_load_short_d16_hi v21, v3, s[66:67] offset:256
    global_load_ushort v118, v2, s[66:67] offset:512
    global_load_short_d16_hi v22, v3, s[66:67] offset:512
    global_load_ushort v119, v2, s[66:67] offset:768
    global_load_short_d16_hi v23, v3, s[66:67] offset:768
    s_add_u32 s22, s22, 1
    s_waitcnt vmcnt(0)
    v_or_b32 v140, v140, v4
    v_or_b32 v141, v141, v5
    v_or_b32 v142, v142, v6
    v_or_b32 v143, v143, v7
    v_or_b32 v168, v168, v8
    v_or_b32 v169, v169, v9
    v_or_b32 v170, v170, v10
    v_or_b32 v171, v171, v11
    v_or_b32 v172, v172, v12
    v_or_b32 v173, v173, v13
    v_or_b32 v174, v174, v14
    v_or_b32 v175, v175, v15
    v_or_b32 v112, v112, v16
    v_or_b32 v113, v113, v17
    v_or_b32 v114, v114, v18
    v_or_b32 v115, v115, v19
    v_or_b32 v116, v116, v20
    v_or_b32 v117, v117, v21
    v_or_b32 v118, v118, v22
    v_or_b32 v119, v119, v23
    s_load_dwordx2 s[72:73], s[0:1], 72
    v_lshlrev_b32 v246, 4, v176
    s_mov_b32 s52, 163072
    v_bfe_u32 v177, v246, 4, 4
    v_bfe_u32 v179, v246, 4, 3
    v_lshl_add_u32 v180, v177, 3, s52
    v_lshl_add_u32 v190, v177, 4, s52
    v_lshl_add_u32 v181, v179, 3, s52
    ds_read2_b64 v[182:185], v180 offset0:32 offset1:48
    ds_read_b32 v191, v190
    ds_read_b64 v[186:187], v181 offset:512
    v_lshrrev_b32 v178, 8, v246
    s_add_u32 s22, s20, 0
    s_mul_i32 s28, s22, 1536
    s_add_u32 s28, s28, 86016
    s_cmp_lt_i32 s46, 0
    s_cselect_b32 s22, s22, s46
    s_lshl_b32 s22, s22, 21
    s_add_u32 s23, s20, 8
    s_mul_i32 s29, s23, 1536
    s_add_u32 s29, s29, 86144
    s_cmp_lt_i32 s46, 0
    s_cselect_b32 s23, s23, s46
    s_lshl_b32 s23, s23, 21
    s_add_u32 s24, s20, 16
    s_mul_i32 s30, s24, 1536
    s_add_u32 s30, s30, 86016
    s_cmp_lt_i32 s46, 0
    s_cselect_b32 s24, s24, s46
    s_lshl_b32 s24, s24, 21
    s_add_u32 s25, s20, 24
    s_cmp_lt_i32 s46, 0
    s_cselect_b32 s25, s25, s46
    s_lshl_b32 s25, s25, 21
    s_add_u32 s26, s20, 32
    s_cmp_lt_i32 s46, 0
    s_cselect_b32 s26, s26, s46
    s_lshl_b32 s26, s26, 21
    s_mov_b32 s53, 0
    s_mov_b32 s50, 0
    s_waitcnt lgkmcnt(0)
    s_branch GEMM
F_big:
    s_lshr_b64 s[66:67], vcc, 40
    s_cbranch_scc1 SLOW
    v_min_u32 v4, 512, v4
    v_min_u32 v2, 8, v2
    v_min_u32 v72, 504, v72
    v_min_u32 v73, 504, v73
    v_min_u32 v74, 504, v74
    v_min_u32 v75, 504, v75
    v_min_u32 v76, 504, v76
    v_min_u32 v77, 504, v77
    v_min_u32 v78, 504, v78
    v_min_u32 v79, 504, v79
    v_min_u32 v80, 504, v80
    v_min_u32 v81, 504, v81
    v_min_u32 v82, 504, v82
    v_min_u32 v83, 504, v83
    s_branch F_bigr
.section .rodata,"a"
.p2align 6
.amdhsa_kernel standalone__tensor_product_equiv_equiformer__graph_kernel
  .amdhsa_next_free_vgpr 256
  .amdhsa_next_free_sgpr 92
  .amdhsa_accum_offset 256
  .amdhsa_group_segment_fixed_size 0
  .amdhsa_kernarg_size 96
  .amdhsa_user_sgpr_count 2
  .amdhsa_user_sgpr_kernarg_segment_ptr 1
  .amdhsa_system_sgpr_workgroup_id_x 1
.end_amdhsa_kernel
```
